```python
import torch

def _softmax(x, axis=-1):
    return torch.softmax(x, dim=axis)
def _gelu(x):
    return torch.nn.functional.gelu(x, approximate="tanh")
def _silu(x):
    return torch.nn.functional.silu(x)
def _sigmoid(x):
    return torch.sigmoid(x)
def _layernorm(x, axis=-1, eps=1e-5):
    m = x.mean(dim=axis, keepdim=True)
    v = x.var(dim=axis, keepdim=True, unbiased=False)
    return (x - m) / torch.sqrt(v + eps)
def _scatter_add(tgt, idx, src, axis=0):
    return tgt.clone().index_add_(axis, idx, src)
def _segment_sum(src, seg, n):
    out = torch.zeros((n,) + src.shape[1:], dtype=src.dtype)
    return out.index_add_(0, seg, src)
def _pad(x, pw):
    flat = tuple(v for pair in reversed(pw) for v in pair)
    return torch.nn.functional.pad(x, flat)

kernel_name = 'interleave_layers__sliding_local_dilated__linear_kernel_hedgehog__prompt'

def setup_inputs():

    _w = (lambda a: (lambda t: t.to(torch.bfloat16) if t.is_floating_point() else t)(torch.as_tensor(a)))
    def _A_setup():
        B, S, D = 1, 2048, 1024
        return {
            "x": _w((lambda *s: torch.randn(*s, dtype=torch.bfloat16) * 0.05)(B, S, D)),
            "wqkv": _w((lambda *s: torch.randn(*s, dtype=torch.bfloat16) * 0.05)(D, 3 * D)),
            "wo": _w((lambda *s: torch.randn(*s, dtype=torch.bfloat16) * 0.05)(D, D)),
        }
    _A_in = _A_setup()

    def _B_setup():
        B, S, D, H = 1, 2048, 1024, 32
        Dh = D // H
        return {
            "x": _w((lambda *s: torch.randn(*s, dtype=torch.bfloat16) * 0.05)(B, S, D)),
            "wqkv": _w((lambda *s: torch.randn(*s, dtype=torch.bfloat16) * 0.4)(D, 3 * D)),
            "w_phi": _w((lambda *s: torch.randn(*s, dtype=torch.bfloat16) * 0.4)(H, Dh, Dh) * (Dh ** -0.5)),
            "wo": _w((lambda *s: torch.randn(*s, dtype=torch.bfloat16) * 0.1)(D, D)),
        }
    _B_in = _B_setup()

    return {
        "A_x": _A_in["x"],
        "A_wqkv": _A_in["wqkv"],
        "A_wo": _A_in["wo"],
        "B_x": _B_in["x"],
        "B_wqkv": _B_in["wqkv"],
        "B_w_phi": _B_in["w_phi"],
        "B_wo": _B_in["wo"],
    }

def reference(A_x, A_wqkv, A_wo, B_x, B_wqkv, B_w_phi, B_wo):
    def _A_ref(x, wqkv, wo):
        B, S, D = x.shape
        H = 32; Dh = D // H
        W, dil = 8, 2
        qkv = (lambda x, *d: x.permute(*d))((x @ wqkv).reshape(B, S, 3, H, Dh), 2, 0, 3, 1, 4)
        q, k, v = qkv[0], qkv[1], qkv[2]
        scale = Dh ** -0.5
        pos = torch.arange(S)
        off = torch.arange(W) * dil
        idx = pos[:, None] - off[None, :]
        mask = idx >= 0
        idx_c = torch.where(mask, idx, 0).reshape(-1)
        kg = k[:, :, idx_c, :].reshape(B, H, S, W, Dh)
        vg = v[:, :, idx_c, :].reshape(B, H, S, W, Dh)
        logits = torch.einsum("bhsd,bhswd->bhsw", q, kg) * scale
        logits = torch.where(mask[None, None, :, :], logits, -1e9)
        attn = _softmax(logits, axis=-1)
        o = torch.einsum("bhsw,bhswd->bhsd", attn, vg)
        return (lambda x, *d: x.permute(*d))(o, 0, 2, 1, 3).reshape(B, S, D) @ wo

    def _B_ref(x, wqkv, w_phi, wo):
        B, S, D = x.shape
        H = 32; Dh = D // H
        qkv = (lambda x, *d: x.permute(*d))((x @ wqkv).reshape(B, S, 3, H, Dh), 2, 0, 3, 1, 4)
        q, k, v = qkv[0], qkv[1], qkv[2]
        pq = torch.einsum("bhsd,hdf->bhsf", q, w_phi)
        pk = torch.einsum("bhsd,hdf->bhsf", k, w_phi)
        phi_q = torch.concatenate([_softmax(pq, axis=-1), _softmax(-pq, axis=-1)], axis=-1)
        phi_k = torch.concatenate([_softmax(pk, axis=-1), _softmax(-pk, axis=-1)], axis=-1)
        kv = torch.einsum("bhsf,bhsd->bhfd", phi_k, v)
        z  = torch.einsum("bhsf->bhf", phi_k)
        num = torch.einsum("bhqf,bhfd->bhqd", phi_q, kv)
        den = torch.einsum("bhqf,bhf->bhq", phi_q, z)[..., None] + 1e-6
        o = num / den
        return (lambda x, *d: x.permute(*d))(o, 0, 2, 1, 3).reshape(B, S, D) @ wo

    x = A_x
    x = x + _A_ref(_layernorm(x, axis=-1), A_wqkv, A_wo)
    x = x + _B_ref(_layernorm(x, axis=-1), B_wqkv, B_w_phi, B_wo)
    x = x + _A_ref(_layernorm(x, axis=-1), A_wqkv, A_wo)
    x = x + _B_ref(_layernorm(x, axis=-1), B_wqkv, B_w_phi, B_wo)
    return x
```

```asm
; @launch grid=(256,1,1) block=(256,1,1) lds=163840
.amdgcn_target "amdgcn-amd-amdhsa--gfx950"
.text
.globl interleave_layers__sliding_local_dilated__linear_kernel_hedgehog__prompt_kernel
.p2align 8
.type interleave_layers__sliding_local_dilated__linear_kernel_hedgehog__prompt_kernel,@function
interleave_layers__sliding_local_dilated__linear_kernel_hedgehog__prompt_kernel:
    s_cmp_ge_u32 s2, 256
    s_cbranch_scc1 L_end
    s_load_dwordx16 s[64:79], s[0:1], 0
    s_load_dwordx4 s[80:83], s[0:1], 64
    s_getpc_b64 s[24:25]
    v_lshrrev_b32 v1, 6, v0
    v_and_b32 v0, 63, v0
    v_readfirstlane_b32 s28, v1
    s_and_b32 s36, s2, 7
    s_lshr_b32 s37, s2, 3
    s_and_b32 s38, s37, 3
    s_lshr_b32 s39, s37, 2
    s_and_b32 s29, s36, 1
    s_lshl_b32 s32, s29, 3
    s_lshl_b32 s29, s29, 2
    s_add_u32 s29, s29, s38
    s_add_u32 s32, s32, s39
    s_lshr_b32 s36, s36, 1
    s_lshl_b32 s30, s36, 3
    s_add_u32 s30, s30, s39
    s_lshl_b32 s31, s36, 2
    s_add_u32 s31, s31, s38
    s_mul_i32 s33, s39, 16
    s_and_b32 s33, s33, 31
    s_mul_i32 s34, s39, 4
    s_and_b32 s34, s34, 31
    v_lshlrev_b32 v1, 4, v0
    v_lshrrev_b32 v233, 4, v0
    v_and_b32 v234, 15, v0
    s_and_b32 s36, s31, 7
    s_lshl_b32 s36, s36, 7
    s_lshl_b32 s37, s28, 5
    s_add_u32 s36, s36, s37
    s_lshl_b32 s36, s36, 1
    s_lshr_b32 s37, s31, 3
    s_add_u32 s36, s36, s37
    s_lshl_b32 s36, s36, 11
    s_lshl_b32 s37, s32, 7
    s_add_u32 s36, s36, s37
    v_lshl_add_u32 v232, v234, 12, s36
    v_lshl_add_u32 v232, v233, 4, v232
    v_lshrrev_b32 v235, 3, v0
    v_and_b32 v236, 7, v0
    v_lshlrev_b32 v236, 4, v236
    v_lshl_add_u32 v237, v235, 11, v236
    v_mul_u32_u24 v235, 6144, v235
    v_add_u32 v235, v235, v236
    s_waitcnt lgkmcnt(0)
    s_mov_b32 s8, s64
    s_mov_b32 s9, s65
    s_mov_b32 s10, 0x400000
    s_mov_b32 s11, 0x20000
    s_mov_b32 s36, 0x10000
    buffer_load_dwordx4 v[32:35], v232, s[8:11], 0 offen offset:0
    buffer_load_dwordx4 v[36:39], v232, s[8:11], 0 offen offset:64
    buffer_load_dwordx4 v[40:43], v232, s[8:11], s36 offen offset:0
    buffer_load_dwordx4 v[44:47], v232, s[8:11], s36 offen offset:64
    s_mov_b32 s20, s66
    s_mov_b32 s21, s67
    s_mov_b32 s22, 0x600000
    s_mov_b32 s23, 0x20000
    s_lshr_b32 s36, s2, 4
    s_lshl_b32 s36, s36, 2
    s_add_u32 s36, s36, s28
    s_mul_i32 s36, s36, 98304
    s_and_b32 s37, s2, 15
    s_lshl_b32 s37, s37, 7
    s_add_u32 s36, s36, s37
    s_lshl_b32 s37, s28, 11
    s_add_u32 s38, s36, 0
    s_add_u32 m0, s37, 0
    s_nop 0
    buffer_load_dwordx4 v235, s[20:23], s38 offen lds
    s_add_u32 s38, s36, 49152
    s_add_u32 m0, s37, 1024
    s_nop 0
    buffer_load_dwordx4 v235, s[20:23], s38 offen lds
    s_add_u32 s38, s36, 2048
    s_add_u32 m0, s37, 8192
    s_nop 0
    buffer_load_dwordx4 v235, s[20:23], s38 offen lds
    s_add_u32 s38, s36, 51200
    s_add_u32 m0, s37, 9216
    s_nop 0
    buffer_load_dwordx4 v235, s[20:23], s38 offen lds
    s_add_u32 s38, s36, 4096
    s_add_u32 m0, s37, 16384
    s_nop 0
    buffer_load_dwordx4 v235, s[20:23], s38 offen lds
    s_add_u32 s38, s36, 53248
    s_add_u32 m0, s37, 17408
    s_nop 0
    buffer_load_dwordx4 v235, s[20:23], s38 offen lds
    s_mov_b32 s4, s82
    s_mov_b32 s5, s83
    s_mov_b32 s6, 0x10000000
    s_mov_b32 s7, 0x20000
    s_mov_b32 s16, s80
    s_mov_b32 s17, s81
    s_mov_b32 s18, 0x100
    s_mov_b32 s19, 0x20000
    s_mov_b32 s12, s78
    s_mov_b32 s13, s79
    s_mov_b32 s14, 0x400000
    s_mov_b32 s15, 0x20000
    s_mov_b32 s42, 0x400000
    s_mov_b32 s43, 0x20000
    s_add_u32 s40, s4, 0x1a00000
    s_addc_u32 s41, s5, 0
    s_mov_b32 s26, (L_code_end - interleave_layers__sliding_local_dilated__linear_kernel_hedgehog__prompt_kernel - 64)
    s_mov_b32 s27, 0x20000
    s_lshr_b32 s36, s2, 3
    s_lshl_b32 s36, s36, 2
    s_add_u32 s36, s36, s28
    s_lshl_b32 s36, s36, 10
    buffer_load_dword v238, v1, s[24:27], s36 offen
    v_mov_b32 v240, 0
    v_mov_b32 v241, 0
    v_mov_b32 v242, 0
    v_mov_b32 v243, 0
    v_lshrrev_b32 v11, 3, v0
    v_lshlrev_b32 v11, 16, v11
    v_add_u32 v11, v11, v236
    s_mul_i32 s36, s28, 196608
    s_lshl_b32 s37, s2, 8
    s_add_u32 s36, s36, s37
    s_mov_b32 exec_lo, 0xffffff
    s_mov_b32 exec_hi, 0
    buffer_store_dwordx4 v[240:243], v11, s[4:7], s36 offen sc1
    s_mov_b64 exec, -1
    v_mov_b32 v16, 0x3f803f80
    v_mov_b32 v17, 0x3f803f80
    v_mov_b32 v18, 0x3f803f80
    v_mov_b32 v19, 0x3f803f80
    v_mov_b32 v12, 1
    s_mov_b32 s46, 0xaaaaaaaa
    s_mov_b32 s47, 0xaaaaaaaa
    s_mov_b32 s48, 0xcccccccc
    s_mov_b32 s49, 0xcccccccc
    s_mov_b32 s56, 0x11111111
    s_mov_b32 s57, 0x11111111
    s_mov_b32 s58, 0x22222222
    s_mov_b32 s59, 0x22222222
    s_mul_i32 s50, s30, 196608
    s_lshl_b32 s51, s32, 17
    s_lshl_b32 s36, s29, 2
    s_add_u32 s36, s36, s28
    s_lshl_b32 s37, s36, 17
    v_add_u32 v2, s37, v1
    v_lshlrev_b32 v244, 9, v233
    v_lshl_add_u32 v244, v234, 3, v244
    s_lshl_b32 s37, s36, 13
    v_add_u32 v14, s37, v244
    s_and_b32 s38, s29, 3
    s_cmp_eq_u32 s38, 0
    s_cselect_b32 s38, 0, 0x1f400
    s_cselect_b32 s39, 0, 2048
    s_lshl_b32 s37, s29, 19
    s_sub_u32 s37, s37, s38
    v_add_u32 v3, s37, v1
    v_mov_b32 v245, 0x80000000
    v_cmp_gt_u32 vcc, 8, v234
    s_nop 1
    v_cndmask_b32 v3, v3, v245, vcc
    s_lshl_b32 s37, s29, 15
    s_sub_u32 s37, s37, s39
    v_add_u32 v15, s37, v244
    s_lshl_b32 s36, s31, 1
    s_lshr_b32 s37, s28, 1
    s_add_u32 s36, s36, s37
    s_lshl_b32 s36, s36, 17
    s_and_b32 s37, s28, 1
    s_lshl_b32 s37, s37, 11
    s_add_u32 s36, s36, s37
    v_add_u32 v4, s36, v1
    v_and_b32 v244, 1, v233
    v_lshl_add_u32 v244, v244, 3, v234
    v_and_b32 v244, 15, v244
    v_lshrrev_b32 v245, 1, v233
    v_lshl_add_u32 v244, v245, 4, v244
    v_lshrrev_b32 v245, 3, v234
    v_lshl_add_u32 v244, v245, 5, v244
    v_lshlrev_b32 v7, 3, v244
    v_lshrrev_b32 v246, 2, v0
    v_and_b32 v247, 3, v0
    v_and_b32 v244, 1, v247
    v_lshl_add_u32 v244, v244, 3, v246
    v_and_b32 v244, 15, v244
    v_lshrrev_b32 v245, 1, v247
    v_lshl_add_u32 v244, v245, 4, v244
    v_lshrrev_b32 v245, 3, v246
    v_lshl_add_u32 v244, v245, 5, v244
    v_lshlrev_b32 v8, 3, v244
    s_and_b32 s36, s28, 1
    s_lshl_b32 s37, s36, 3
    s_add_u32 s37, s37, 20480
    s_lshl_b32 s36, s36, 9
    v_add_u32 v244, s37, v1
    v_add_u32 v245, s36, v7
    s_cmp_lt_u32 s28, 2
    s_cselect_b64 vcc, -1, 0
    v_cndmask_b32 v9, v245, v244, vcc
    s_lshl_b32 s36, s32, 13
    s_add_u32 s36, s36, 0x1a00000
    s_add_u32 s37, s36, 4096
    s_lshl_b32 s38, s31, 2
    s_add_u32 s38, s38, s28
    s_lshl_b32 s38, s38, 12
    s_lshl_b32 s39, s32, 7
    s_add_u32 s38, s38, s39
    s_add_u32 s38, s38, 0x200000
    v_and_b32 v252, 15, v0
    v_lshrrev_b32 v253, 2, v252
    v_lshrrev_b32 v254, 4, v0
    v_cmp_eq_u32 vcc, v253, v254
    v_lshlrev_b32 v252, 3, v252
    v_mov_b32 v253, 0x80000000
    v_cndmask_b32 v252, v253, v252, vcc
    s_waitcnt vmcnt(11)
    buffer_store_dwordx4 v[32:35], v4, s[4:7], s36 offen offset:0 sc1
    s_waitcnt vmcnt(11)
    buffer_store_dwordx4 v[36:39], v4, s[4:7], s37 offen offset:0 sc1
    s_waitcnt vmcnt(11)
    buffer_store_dwordx4 v[40:43], v4, s[4:7], s36 offen offset:1024 sc1
    s_waitcnt vmcnt(11)
    buffer_store_dwordx4 v[44:47], v4, s[4:7], s37 offen offset:1024 sc1
    v_mfma_f32_16x16x32_bf16 v[96:99], v[32:35], v[32:35], 0
    v_mfma_f32_16x16x32_bf16 v[92:95], v[16:19], v[32:35], 0
    v_mfma_f32_16x16x32_bf16 v[104:107], v[40:43], v[40:43], 0
    v_mfma_f32_16x16x32_bf16 v[100:103], v[16:19], v[40:43], 0
    v_mfma_f32_16x16x32_bf16 v[96:99], v[36:39], v[36:39], v[96:99]
    v_mfma_f32_16x16x32_bf16 v[92:95], v[16:19], v[36:39], v[92:95]
    v_mfma_f32_16x16x32_bf16 v[104:107], v[44:47], v[44:47], v[104:107]
    v_mfma_f32_16x16x32_bf16 v[100:103], v[16:19], v[44:47], v[100:103]
    s_nop 4
    v_cndmask_b32 v96, v96, v97, s[46:47]
    v_cndmask_b32 v98, v98, v99, s[46:47]
    v_cndmask_b32 v93, v96, v98, s[48:49]
    buffer_store_dwordx2 v[92:93], v252, s[4:7], s38 offen offset:0 sc1
    v_cndmask_b32 v104, v104, v105, s[46:47]
    v_cndmask_b32 v106, v106, v107, s[46:47]
    v_cndmask_b32 v101, v104, v106, s[48:49]
    buffer_store_dwordx2 v[100:101], v252, s[4:7], s38 offen offset:2048 sc1
    s_waitcnt vmcnt(7)
    s_barrier
    v_lshrrev_b32 v248, 4, v0
    v_lshlrev_b32 v248, 10, v248
    v_bfe_u32 v249, v0, 2, 2
    v_lshl_add_u32 v248, v249, 7, v248
    v_and_b32 v249, 3, v0
    v_lshl_add_u32 v248, v249, 3, v248
    s_lshr_b32 s36, s28, 1
    s_lshl_b32 s36, s36, 6
    s_and_b32 s37, s28, 1
    s_mul_i32 s38, s37, 8224
    s_add_u32 s38, s38, s36
    s_mul_i32 s39, s37, 16352
    s_add_u32 s39, s39, s36
    v_add_u32 v249, s39, v248
    v_add_u32 v248, s38, v248
    s_and_b32 s38, s2, 15
    s_lshl_b32 s38, s38, 1
    s_lshr_b32 s36, s28, 1
    s_add_u32 s38, s38, s36
    s_lshr_b32 s36, s2, 4
    s_mul_i32 s39, s38, 196608
    s_mul_i32 s44, s36, 12288
    s_add_u32 s39, s39, s44
    s_mul_i32 s44, s37, 3072
    s_add_u32 s39, s39, s44
    s_add_u32 s39, s39, 0xe00000
    s_add_u32 s44, s39, 6144
    s_mul_i32 s38, s38, 6
    s_mul_i32 s37, s37, 3
    s_add_u32 s38, s38, s37
    s_lshl_b32 s38, s38, 11
    s_lshl_b32 s36, s36, 7
    s_add_u32 s38, s38, s36
    s_add_u32 s38, s38, 0x300000
    s_add_u32 s37, s38, 4096
    v_lshrrev_b32 v250, 4, v0
    v_lshlrev_b32 v250, 4, v250
    v_and_b32 v11, 15, v0
    v_lshl_add_u32 v250, v11, 6, v250
    v_cmp_gt_u32 vcc, 2, v11
    v_mov_b32 v11, 0x80000000
    s_nop 0
    v_cndmask_b32 v250, v11, v250, vcc
    ds_read_b64_tr_b16 a[0:1], v248 offset:0
    ds_read_b64_tr_b16 a[2:3], v248 offset:512
    ds_read_b64_tr_b16 a[4:5], v248 offset:4096
    ds_read_b64_tr_b16 a[6:7], v248 offset:4608
    ds_read_b64_tr_b16 a[8:9], v249 offset:32
    ds_read_b64_tr_b16 a[10:11], v249 offset:544
    ds_read_b64_tr_b16 a[12:13], v249 offset:4128
    ds_read_b64_tr_b16 a[14:15], v249 offset:4640
    ds_read_b64_tr_b16 a[16:17], v248 offset:8192
    ds_read_b64_tr_b16 a[18:19], v248 offset:8704
    ds_read_b64_tr_b16 a[20:21], v248 offset:12288
    ds_read_b64_tr_b16 a[22:23], v248 offset:12800
    s_waitcnt lgkmcnt(10)
    buffer_store_dwordx4 a[0:3], v1, s[4:7], s39 offen offset:0 sc1
    s_waitcnt lgkmcnt(8)
    buffer_store_dwordx4 a[4:7], v1, s[4:7], s44 offen offset:0 sc1
    s_waitcnt lgkmcnt(6)
    buffer_store_dwordx4 a[8:11], v1, s[4:7], s39 offen offset:1024 sc1
    s_waitcnt lgkmcnt(4)
    buffer_store_dwordx4 a[12:15], v1, s[4:7], s44 offen offset:1024 sc1
    s_waitcnt lgkmcnt(2)
    buffer_store_dwordx4 a[16:19], v1, s[4:7], s39 offen offset:2048 sc1
    s_waitcnt lgkmcnt(0)
    buffer_store_dwordx4 a[20:23], v1, s[4:7], s44 offen offset:2048 sc1
    v_mfma_f32_16x16x32_bf16 v[92:95], a[0:3], v[16:19], 0
    v_mfma_f32_16x16x32_bf16 v[96:99], a[8:11], v[16:19], 0
    v_mfma_f32_16x16x32_bf16 v[100:103], a[16:19], v[16:19], 0
    v_mfma_f32_16x16x32_bf16 v[92:95], a[4:7], v[16:19], v[92:95]
    v_mfma_f32_16x16x32_bf16 v[96:99], a[12:15], v[16:19], v[96:99]
    v_mfma_f32_16x16x32_bf16 v[100:103], a[20:23], v[16:19], v[100:103]
    s_nop 5
    buffer_store_dwordx4 v[92:95], v250, s[4:7], s38 offen offset:0 sc1
    buffer_store_dwordx4 v[96:99], v250, s[4:7], s38 offen offset:2048 sc1
    buffer_store_dwordx4 v[100:103], v250, s[4:7], s37 offen offset:0 sc1
    s_mov_b32 s20, s72
    s_mov_b32 s21, s73
    s_mov_b32 s22, 0x600000
    s_mov_b32 s23, 0x20000
    s_lshr_b32 s36, s2, 4
    s_lshl_b32 s36, s36, 2
    s_add_u32 s36, s36, s28
    s_mul_i32 s36, s36, 98304
    s_and_b32 s37, s2, 15
    s_lshl_b32 s37, s37, 7
    s_add_u32 s36, s36, s37
    s_lshl_b32 s37, s28, 11
    s_add_u32 s38, s36, 0
    s_add_u32 m0, s37, 24576
    s_nop 0
    buffer_load_dwordx4 v235, s[20:23], s38 offen lds
    s_add_u32 s38, s36, 49152
    s_add_u32 m0, s37, 25600
    s_nop 0
    buffer_load_dwordx4 v235, s[20:23], s38 offen lds
    s_add_u32 s38, s36, 2048
    s_add_u32 m0, s37, 32768
    s_nop 0
    buffer_load_dwordx4 v235, s[20:23], s38 offen lds
    s_add_u32 s38, s36, 51200
    s_add_u32 m0, s37, 33792
    s_nop 0
    buffer_load_dwordx4 v235, s[20:23], s38 offen lds
    s_add_u32 s38, s36, 4096
    s_add_u32 m0, s37, 40960
    s_nop 0
    buffer_load_dwordx4 v235, s[20:23], s38 offen lds
    s_add_u32 s38, s36, 53248
    s_add_u32 m0, s37, 41984
    s_nop 0
    buffer_load_dwordx4 v235, s[20:23], s38 offen lds
    s_mov_b32 s20, s68
    s_mov_b32 s21, s69
    s_mov_b32 s22, 0x200000
    s_mov_b32 s23, 0x20000
    s_lshr_b32 s36, s2, 4
    s_lshl_b32 s36, s36, 2
    s_add_u32 s36, s36, s28
    s_lshl_b32 s36, s36, 15
    s_and_b32 s37, s2, 15
    s_lshl_b32 s37, s37, 7
    s_add_u32 s36, s36, s37
    s_lshl_b32 s37, s28, 11
    s_add_u32 s38, s36, 0
    s_add_u32 m0, s37, 49152
    s_nop 0
    buffer_load_dwordx4 v237, s[20:23], s38 offen lds
    s_add_u32 s38, s36, 16384
    s_add_u32 m0, s37, 50176
    s_nop 0
    buffer_load_dwordx4 v237, s[20:23], s38 offen lds
    s_mov_b32 s20, s76
    s_mov_b32 s21, s77
    s_mov_b32 s22, 0x200000
    s_mov_b32 s23, 0x20000
    s_lshr_b32 s36, s2, 4
    s_lshl_b32 s36, s36, 2
    s_add_u32 s36, s36, s28
    s_lshl_b32 s36, s36, 15
    s_and_b32 s37, s2, 15
    s_lshl_b32 s37, s37, 7
    s_add_u32 s36, s36, s37
    s_lshl_b32 s37, s28, 11
    s_add_u32 s38, s36, 0
    s_add_u32 m0, s37, 57344
    s_nop 0
    buffer_load_dwordx4 v237, s[20:23], s38 offen lds
    s_add_u32 s38, s36, 16384
    s_add_u32 m0, s37, 58368
    s_nop 0
    buffer_load_dwordx4 v237, s[20:23], s38 offen lds
    s_mov_b32 s20, s74
    s_mov_b32 s21, s75
    s_mov_b32 s22, 0x10000
    s_mov_b32 s23, 0x20000
    s_and_b32 s36, s28, 1
    s_lshl_b32 s36, s36, 10
    s_add_u32 m0, s36, 65536
    s_lshl_b32 s37, s30, 11
    s_add_u32 s36, s36, s37
    buffer_load_dwordx4 v1, s[20:23], s36 offen lds
    s_and_b32 s36, s2, 31
    s_lshl_b32 s36, s36, 2
    v_mov_b32 v10, s36
    s_waitcnt vmcnt(11)
    s_barrier
    s_cmp_lg_u32 s28, 0
    s_cbranch_scc1 Lsig_1
    s_mov_b32 exec_lo, 0x1
    s_mov_b32 exec_hi, 0
    s_mov_b32 s36, 0x0
    buffer_atomic_add v12, v10, s[16:19], s36 offen sc1
    s_mov_b64 exec, -1
Lsig_1:
    v_lshrrev_b32 v233, 4, v0
    v_and_b32 v234, 15, v0
    v_lshlrev_b32 v233, 2, v233
    v_sub_u32 v233, v233, v234
    v_mov_b32 v237, 0xf149f2ca
    v_add_u32 v235, 7, v233
    v_cmp_gt_u32 vcc, 8, v235
    s_nop 1
    v_cndmask_b32 v24, v237, 0, vcc
    v_mov_b32 v236, 0xffff
    v_cndmask_b32 v236, 0, v236, vcc
    v_mov_b32 v30, v236
    v_add_u32 v235, 0, v233
    v_cmp_le_i32 vcc, 9, v235
    s_nop 1
    v_cndmask_b32 v20, v237, 0, vcc
    v_mov_b32 v236, 0xffff
    v_cndmask_b32 v236, 0, v236, vcc
    v_mov_b32 v28, v236
    v_add_u32 v235, 8, v233
    v_cmp_gt_u32 vcc, 8, v235
    s_nop 1
    v_cndmask_b32 v25, v237, 0, vcc
    v_mov_b32 v236, 0xffff0000
    v_cndmask_b32 v236, 0, v236, vcc
    v_or_b32 v30, v30, v236
    v_add_u32 v235, 1, v233
    v_cmp_le_i32 vcc, 9, v235
    s_nop 1
    v_cndmask_b32 v21, v237, 0, vcc
    v_mov_b32 v236, 0xffff0000
    v_cndmask_b32 v236, 0, v236, vcc
    v_or_b32 v28, v28, v236
    v_add_u32 v235, 9, v233
    v_cmp_gt_u32 vcc, 8, v235
    s_nop 1
    v_cndmask_b32 v26, v237, 0, vcc
    v_mov_b32 v236, 0xffff
    v_cndmask_b32 v236, 0, v236, vcc
    v_mov_b32 v31, v236
    v_add_u32 v235, 2, v233
    v_cmp_le_i32 vcc, 9, v235
    s_nop 1
    v_cndmask_b32 v22, v237, 0, vcc
    v_mov_b32 v236, 0xffff
    v_cndmask_b32 v236, 0, v236, vcc
    v_mov_b32 v29, v236
    v_add_u32 v235, 10, v233
    v_cmp_gt_u32 vcc, 8, v235
    s_nop 1
    v_cndmask_b32 v27, v237, 0, vcc
    v_mov_b32 v236, 0xffff0000
    v_cndmask_b32 v236, 0, v236, vcc
    v_or_b32 v31, v31, v236
    v_add_u32 v235, 3, v233
    v_cmp_le_i32 vcc, 9, v235
    s_nop 1
    v_cndmask_b32 v23, v237, 0, vcc
    v_mov_b32 v236, 0xffff0000
    v_cndmask_b32 v236, 0, v236, vcc
    v_or_b32 v29, v29, v236
    s_and_b32 s36, s29, 3
    s_or_b32 s36, s36, s28
    s_cmp_eq_u32 s36, 0
    s_cselect_b64 vcc, -1, 0
    v_cndmask_b32 v76, v20, v237, vcc
    v_cndmask_b32 v77, v21, v237, vcc
    v_cndmask_b32 v78, v22, v237, vcc
    v_cndmask_b32 v79, v23, v237, vcc
    v_cndmask_b32 v80, v28, 0, vcc
    v_cndmask_b32 v81, v29, 0, vcc
    s_waitcnt vmcnt(0)
    s_barrier
    v_lshrrev_b32 v248, 4, v0
    v_lshlrev_b32 v248, 10, v248
    v_bfe_u32 v249, v0, 2, 2
    v_lshl_add_u32 v248, v249, 7, v248
    v_and_b32 v249, 3, v0
    v_lshl_add_u32 v248, v249, 3, v248
    s_lshr_b32 s36, s28, 1
    s_lshl_b32 s36, s36, 6
    s_and_b32 s37, s28, 1
    s_mul_i32 s38, s37, 8224
    s_add_u32 s38, s38, s36
    s_mul_i32 s39, s37, 16352
    s_add_u32 s39, s39, s36
    v_add_u32 v249, s39, v248
    v_add_u32 v248, s38, v248
    s_and_b32 s38, s2, 15
    s_lshl_b32 s38, s38, 1
    s_lshr_b32 s36, s28, 1
    s_add_u32 s38, s38, s36
    s_lshr_b32 s36, s2, 4
    s_mul_i32 s39, s38, 196608
    s_mul_i32 s44, s36, 12288
    s_add_u32 s39, s39, s44
    s_mul_i32 s44, s37, 3072
    s_add_u32 s39, s39, s44
    s_add_u32 s39, s39, 0x1400000
    s_add_u32 s44, s39, 6144
    s_mul_i32 s38, s38, 6
    s_mul_i32 s37, s37, 3
    s_add_u32 s38, s38, s37
    s_lshl_b32 s38, s38, 11
    s_lshl_b32 s36, s36, 7
    s_add_u32 s38, s38, s36
    s_add_u32 s38, s38, 0x380000
    s_add_u32 s37, s38, 4096
    v_lshrrev_b32 v250, 4, v0
    v_lshlrev_b32 v250, 4, v250
    v_and_b32 v11, 15, v0
    v_lshl_add_u32 v250, v11, 6, v250
    v_cmp_gt_u32 vcc, 2, v11
    v_mov_b32 v11, 0x80000000
    s_nop 0
    v_cndmask_b32 v250, v11, v250, vcc
    ds_read_b64_tr_b16 a[0:1], v248 offset:24576
    ds_read_b64_tr_b16 a[2:3], v248 offset:25088
    ds_read_b64_tr_b16 a[4:5], v248 offset:28672
    ds_read_b64_tr_b16 a[6:7], v248 offset:29184
    ds_read_b64_tr_b16 a[8:9], v249 offset:24608
    ds_read_b64_tr_b16 a[10:11], v249 offset:25120
    ds_read_b64_tr_b16 a[12:13], v249 offset:28704
    ds_read_b64_tr_b16 a[14:15], v249 offset:29216
    ds_read_b64_tr_b16 a[16:17], v248 offset:32768
    ds_read_b64_tr_b16 a[18:19], v248 offset:33280
    ds_read_b64_tr_b16 a[20:21], v248 offset:36864
    ds_read_b64_tr_b16 a[22:23], v248 offset:37376
    s_waitcnt lgkmcnt(10)
    buffer_store_dwordx4 a[0:3], v1, s[4:7], s39 offen offset:0 sc1
    s_waitcnt lgkmcnt(8)
    buffer_store_dwordx4 a[4:7], v1, s[4:7], s44 offen offset:0 sc1
    s_waitcnt lgkmcnt(6)
    buffer_store_dwordx4 a[8:11], v1, s[4:7], s39 offen offset:1024 sc1
    s_waitcnt lgkmcnt(4)
    buffer_store_dwordx4 a[12:15], v1, s[4:7], s44 offen offset:1024 sc1
    s_waitcnt lgkmcnt(2)
    buffer_store_dwordx4 a[16:19], v1, s[4:7], s39 offen offset:2048 sc1
    s_waitcnt lgkmcnt(0)
    buffer_store_dwordx4 a[20:23], v1, s[4:7], s44 offen offset:2048 sc1
    v_mfma_f32_16x16x32_bf16 v[92:95], a[0:3], v[16:19], 0
    v_mfma_f32_16x16x32_bf16 v[96:99], a[8:11], v[16:19], 0
    v_mfma_f32_16x16x32_bf16 v[100:103], a[16:19], v[16:19], 0
    v_mfma_f32_16x16x32_bf16 v[92:95], a[4:7], v[16:19], v[92:95]
    v_mfma_f32_16x16x32_bf16 v[96:99], a[12:15], v[16:19], v[96:99]
    v_mfma_f32_16x16x32_bf16 v[100:103], a[20:23], v[16:19], v[100:103]
    s_nop 5
    buffer_store_dwordx4 v[92:95], v250, s[4:7], s38 offen offset:0 sc1
    buffer_store_dwordx4 v[96:99], v250, s[4:7], s38 offen offset:2048 sc1
    buffer_store_dwordx4 v[100:103], v250, s[4:7], s37 offen offset:0 sc1
    v_lshrrev_b32 v248, 2, v0
    v_lshlrev_b32 v248, 7, v248
    v_and_b32 v249, 3, v0
    v_lshl_add_u32 v248, v249, 4, v248
    s_lshr_b32 s36, s28, 1
    s_lshl_b32 s36, s36, 12
    s_and_b32 s37, s28, 1
    s_lshl_b32 s37, s37, 6
    s_add_u32 s36, s36, s37
    v_add_u32 v248, s36, v248
    s_and_b32 s36, s2, 15
    s_lshl_b32 s36, s36, 17
    s_lshr_b32 s37, s2, 4
    s_lshl_b32 s37, s37, 13
    s_add_u32 s36, s36, s37
    s_lshl_b32 s37, s28, 11
    s_add_u32 s36, s36, s37
    s_add_u32 s36, s36, 0xa00000
    ds_read_b64_tr_b16 a[32:33], v248 offset:49152
    ds_read_b64_tr_b16 a[34:35], v248 offset:51200
    ds_read_b64_tr_b16 a[36:37], v248 offset:49160
    ds_read_b64_tr_b16 a[38:39], v248 offset:51208
    s_waitcnt lgkmcnt(2)
    buffer_store_dwordx4 a[32:35], v1, s[4:7], s36 offen offset:0 sc1
    s_waitcnt lgkmcnt(0)
    buffer_store_dwordx4 a[36:39], v1, s[4:7], s36 offen offset:1024 sc1
    v_lshrrev_b32 v248, 2, v0
    v_lshlrev_b32 v248, 7, v248
    v_and_b32 v249, 3, v0
    v_lshl_add_u32 v248, v249, 4, v248
    s_lshr_b32 s36, s28, 1
    s_lshl_b32 s36, s36, 12
    s_and_b32 s37, s28, 1
    s_lshl_b32 s37, s37, 6
    s_add_u32 s36, s36, s37
    v_add_u32 v248, s36, v248
    s_and_b32 s36, s2, 15
    s_lshl_b32 s36, s36, 17
    s_lshr_b32 s37, s2, 4
    s_lshl_b32 s37, s37, 13
    s_add_u32 s36, s36, s37
    s_lshl_b32 s37, s28, 11
    s_add_u32 s36, s36, s37
    s_add_u32 s36, s36, 0xc00000
    ds_read_b64_tr_b16 a[40:41], v248 offset:57344
    ds_read_b64_tr_b16 a[42:43], v248 offset:59392
    ds_read_b64_tr_b16 a[44:45], v248 offset:57352
    ds_read_b64_tr_b16 a[46:47], v248 offset:59400
    s_waitcnt lgkmcnt(2)
    buffer_store_dwordx4 a[40:43], v1, s[4:7], s36 offen offset:0 sc1
    s_waitcnt lgkmcnt(0)
    buffer_store_dwordx4 a[44:47], v1, s[4:7], s36 offen offset:1024 sc1
    v_lshrrev_b32 v248, 2, v0
    v_lshlrev_b32 v248, 6, v248
    v_and_b32 v249, 3, v0
    v_lshl_add_u32 v248, v249, 3, v248
    v_add_u32 v248, 65536, v248
    ds_read_b64_tr_b16 a[192:193], v248 offset:0
    ds_read_b64_tr_b16 a[194:195], v248 offset:1024
    ds_read_b64_tr_b16 a[196:197], v248 offset:32
    ds_read_b64_tr_b16 a[198:199], v248 offset:1056
    s_waitcnt lgkmcnt(0)
    v_mov_b32 v232, v10
    v_and_b32 v10, 31, v0
    v_lshlrev_b32 v10, 2, v10
    s_cmp_lg_u32 s28, 0
    s_cbranch_scc1 Lpe_3
    s_mov_b32 s36, 0x0
    s_mov_b32 s37, 0
Lpoll_2:
    buffer_load_dword v11, v10, s[16:19], s36 offen sc1
    s_add_u32 s37, s37, 1
    s_waitcnt vmcnt(0)
    v_cmp_gt_u32 vcc, 8, v11
    s_cbranch_vccz Lpe_3
    s_cmp_lt_u32 s37, 0x100000
    s_cbranch_scc1 Lpoll_2
Lpe_3:
    s_waitcnt vmcnt(0)
    s_barrier
    v_mov_b32 v10, v232
    s_cmp_lg_u32 s28, 0
    s_cbranch_scc1 Lsig_4
    s_mov_b32 exec_lo, 0x1
    s_mov_b32 exec_hi, 0
    s_mov_b32 s36, 0x80
    buffer_atomic_add v12, v10, s[16:19], s36 offen sc1
    s_mov_b64 exec, -1
Lsig_4:
    s_lshl_b32 s35, s33, 12
    s_add_u32 s39, s28, 2
    s_lshl_b32 s39, s39, 10
    s_lshl_b32 s44, s28, 1
    s_add_u32 s44, s44, s33
    s_add_u32 s44, s44, 0
    s_and_b32 s44, s44, 31
    s_mul_i32 s44, s44, 6144
    s_add_u32 s44, s44, s50
    s_add_u32 s44, s44, 0xe00000
    s_mul_i32 s45, s28, 12288
    s_add_u32 m0, s45, 0
    s_nop 0
    buffer_load_dwordx4 v1, s[4:7], s44 offen offset:0 sc1 lds
    buffer_load_dwordx4 v1, s[4:7], s44 offen offset:1024 sc1 lds
    buffer_load_dwordx4 v1, s[4:7], s44 offen offset:2048 sc1 lds
    buffer_load_dwordx4 v1, s[4:7], s44 offen offset:3072 sc1 lds
    s_add_u32 s44, s44, 4096
    s_add_u32 m0, m0, 4096
    s_nop 0
    buffer_load_dwordx4 v1, s[4:7], s44 offen offset:0 sc1 lds
    buffer_load_dwordx4 v1, s[4:7], s44 offen offset:1024 sc1 lds
    buffer_load_dwordx4 v1, s[4:7], s44 offen offset:2048 sc1 lds
    buffer_load_dwordx4 v1, s[4:7], s44 offen offset:3072 sc1 lds
    s_add_u32 s44, s44, 4096
    s_add_u32 m0, m0, 4096
    s_nop 0
    buffer_load_dwordx4 v1, s[4:7], s44 offen offset:0 sc1 lds
    buffer_load_dwordx4 v1, s[4:7], s44 offen offset:1024 sc1 lds
    buffer_load_dwordx4 v1, s[4:7], s44 offen offset:2048 sc1 lds
    buffer_load_dwordx4 v1, s[4:7], s44 offen offset:3072 sc1 lds
    buffer_load_dwordx4 a[0:3], v2, s[40:43], s35 offen offset:0 sc1
    buffer_load_dwordx4 a[4:7], v2, s[40:43], s35 offen offset:1024 sc1
    buffer_load_dwordx4 a[8:11], v2, s[40:43], s35 offen offset:2048 sc1
    buffer_load_dwordx4 a[12:15], v2, s[40:43], s35 offen offset:3072 sc1
    buffer_load_dwordx4 a[16:19], v3, s[40:43], s35 offen sc1
    s_add_u32 s35, s35, 4096
    s_and_b32 s35, s35, 0x1ffff
    buffer_load_dwordx4 a[20:23], v2, s[40:43], s35 offen offset:0 sc1
    buffer_load_dwordx4 a[24:27], v2, s[40:43], s35 offen offset:1024 sc1
    buffer_load_dwordx4 a[28:31], v2, s[40:43], s35 offen offset:2048 sc1
    buffer_load_dwordx4 a[32:35], v2, s[40:43], s35 offen offset:3072 sc1
    buffer_load_dwordx4 a[36:39], v3, s[40:43], s35 offen sc1
    s_add_u32 s35, s35, 4096
    s_and_b32 s35, s35, 0x1ffff
    buffer_load_dwordx4 a[40:43], v2, s[40:43], s35 offen offset:0 sc1
    buffer_load_dwordx4 a[44:47], v2, s[40:43], s35 offen offset:1024 sc1
    buffer_load_dwordx4 a[48:51], v2, s[40:43], s35 offen offset:2048 sc1
    buffer_load_dwordx4 a[52:55], v2, s[40:43], s35 offen offset:3072 sc1
    buffer_load_dwordx4 a[56:59], v3, s[40:43], s35 offen sc1
    s_add_u32 s35, s35, 4096
    s_and_b32 s35, s35, 0x1ffff
    v_and_b32 v232, 15, v0
    v_lshlrev_b32 v232, 7, v232
    v_lshrrev_b32 v233, 4, v0
    v_lshl_add_u32 v232, v233, 4, v232
    v_and_b32 v10, 31, v0
    v_lshlrev_b32 v10, 2, v10
    s_waitcnt vmcnt(15)
    s_barrier
    v_add_u32 v5, 0, v1
    ds_read_b128 a[80:83], v5 offset:0
    v_add_u32 v6, s39, v5
    ds_read_b128 a[84:87], v5 offset:1024
    ds_read_b128 a[88:91], v5 offset:2048
    ds_read_b128 a[92:95], v5 offset:3072
    ds_read_b128 a[96:99], v5 offset:4096
    ds_read_b128 a[100:103], v5 offset:5120
    ds_read_b128 a[104:107], v6 offset:0
    s_waitcnt vmcnt(10) lgkmcnt(0)
    v_mfma_f32_16x16x32_bf16 v[132:135], a[80:83], a[0:3], 0
    ds_read_b128 a[108:111], v5 offset:6144
    v_mfma_f32_16x16x32_bf16 v[156:159], a[80:83], a[4:7], 0
    buffer_load_dwordx4 a[60:63], v2, s[40:43], s35 offen offset:0 sc1
    v_mfma_f32_16x16x32_bf16 v[180:183], a[80:83], a[8:11], 0
    ds_read_b128 a[112:115], v5 offset:7168
    v_mfma_f32_16x16x32_bf16 v[204:207], a[80:83], a[12:15], 0
    v_mfma_f32_16x16x32_bf16 v[136:139], a[84:87], a[0:3], 0
    buffer_load_dwordx4 a[64:67], v2, s[40:43], s35 offen offset:1024 sc1
    v_mfma_f32_16x16x32_bf16 v[160:163], a[84:87], a[4:7], 0
    ds_read_b128 a[116:119], v5 offset:8192
    v_mfma_f32_16x16x32_bf16 v[184:187], a[84:87], a[8:11], 0
    v_mfma_f32_16x16x32_bf16 v[208:211], a[84:87], a[12:15], 0
    ds_read_b128 a[120:123], v5 offset:9216
    buffer_load_dwordx4 a[68:71], v2, s[40:43], s35 offen offset:2048 sc1
    v_mfma_f32_16x16x32_bf16 v[140:143], a[88:91], a[0:3], 0
    v_mfma_f32_16x16x32_bf16 v[164:167], a[88:91], a[4:7], 0
    v_mfma_f32_16x16x32_bf16 v[188:191], a[88:91], a[8:11], 0
    ds_read_b128 a[124:127], v5 offset:10240
    buffer_load_dwordx4 a[72:75], v2, s[40:43], s35 offen offset:3072 sc1
    v_mfma_f32_16x16x32_bf16 v[212:215], a[88:91], a[12:15], 0
    v_mfma_f32_16x16x32_bf16 v[144:147], a[92:95], a[0:3], 0
    ds_read_b128 a[128:131], v5 offset:11264
    v_mfma_f32_16x16x32_bf16 v[168:171], a[92:95], a[4:7], 0
    buffer_load_dwordx4 a[76:79], v3, s[40:43], s35 offen sc1
    s_add_u32 s35, s35, 4096
    s_and_b32 s35, s35, 0x1ffff
    v_mfma_f32_16x16x32_bf16 v[192:195], a[92:95], a[8:11], 0
    v_mfma_f32_16x16x32_bf16 v[216:219], a[92:95], a[12:15], 0
    ds_read_b128 a[132:135], v6 offset:6144
    v_mfma_f32_16x16x32_bf16 v[148:151], a[96:99], a[0:3], 0
    s_lshl_b32 s44, s28, 1
    s_add_u32 s44, s44, s33
    s_add_u32 s44, s44, 8
    s_and_b32 s44, s44, 31
    s_mul_i32 s44, s44, 6144
    s_add_u32 s44, s44, s50
    s_add_u32 s44, s44, 0xe00000
    s_mul_i32 s45, s28, 12288
    s_add_u32 m0, s45, 49152
    s_nop 0
    buffer_load_dwordx4 v1, s[4:7], s44 offen offset:0 sc1 lds
    v_mfma_f32_16x16x32_bf16 v[172:175], a[96:99], a[4:7], 0
    v_mfma_f32_16x16x32_bf16 v[196:199], a[96:99], a[8:11], 0
    v_mfma_f32_16x16x32_bf16 v[220:223], a[96:99], a[12:15], 0
    buffer_load_dwordx4 v1, s[4:7], s44 offen offset:1024 sc1 lds
    v_mfma_f32_16x16x32_bf16 v[152:155], a[100:103], a[0:3], 0
    v_mfma_f32_16x16x32_bf16 v[176:179], a[100:103], a[4:7], 0
    v_mfma_f32_16x16x32_bf16 v[200:203], a[100:103], a[8:11], 0
    buffer_load_dwordx4 v1, s[4:7], s44 offen offset:2048 sc1 lds
    v_mfma_f32_16x16x32_bf16 v[224:227], a[100:103], a[12:15], 0
    v_mfma_f32_16x16x32_bf16 v[228:231], a[104:107], a[16:19], 0
    s_waitcnt vmcnt(13) lgkmcnt(0)
    v_mfma_f32_16x16x32_bf16 v[132:135], a[108:111], a[20:23], v[132:135]
    ds_read_b128 a[80:83], v5 offset:12288
    v_mfma_f32_16x16x32_bf16 v[156:159], a[108:111], a[24:27], v[156:159]
    buffer_load_dwordx4 a[0:3], v2, s[40:43], s35 offen offset:0 sc1
    v_mfma_f32_16x16x32_bf16 v[180:183], a[108:111], a[28:31], v[180:183]
    ds_read_b128 a[84:87], v5 offset:13312
    v_mfma_f32_16x16x32_bf16 v[204:207], a[108:111], a[32:35], v[204:207]
    v_mfma_f32_16x16x32_bf16 v[136:139], a[112:115], a[20:23], v[136:139]
    buffer_load_dwordx4 a[4:7], v2, s[40:43], s35 offen offset:1024 sc1
    v_mfma_f32_16x16x32_bf16 v[160:163], a[112:115], a[24:27], v[160:163]
    ds_read_b128 a[88:91], v5 offset:14336
    v_mfma_f32_16x16x32_bf16 v[184:187], a[112:115], a[28:31], v[184:187]
    v_mfma_f32_16x16x32_bf16 v[208:211], a[112:115], a[32:35], v[208:211]
    ds_read_b128 a[92:95], v5 offset:15360
    buffer_load_dwordx4 a[8:11], v2, s[40:43], s35 offen offset:2048 sc1
    v_mfma_f32_16x16x32_bf16 v[140:143], a[116:119], a[20:23], v[140:143]
    v_mfma_f32_16x16x32_bf16 v[164:167], a[116:119], a[24:27], v[164:167]
    v_mfma_f32_16x16x32_bf16 v[188:191], a[116:119], a[28:31], v[188:191]
    ds_read_b128 a[96:99], v5 offset:16384
    buffer_load_dwordx4 a[12:15], v2, s[40:43], s35 offen offset:3072 sc1
    v_mfma_f32_16x16x32_bf16 v[212:215], a[116:119], a[32:35], v[212:215]
    v_mfma_f32_16x16x32_bf16 v[144:147], a[120:123], a[20:23], v[144:147]
    ds_read_b128 a[100:103], v5 offset:17408
    v_mfma_f32_16x16x32_bf16 v[168:171], a[120:123], a[24:27], v[168:171]
    buffer_load_dwordx4 a[16:19], v3, s[40:43], s35 offen sc1
    s_add_u32 s35, s35, 4096
    s_and_b32 s35, s35, 0x1ffff
    v_mfma_f32_16x16x32_bf16 v[192:195], a[120:123], a[28:31], v[192:195]
    v_mfma_f32_16x16x32_bf16 v[216:219], a[120:123], a[32:35], v[216:219]
    ds_read_b128 a[104:107], v6 offset:12288
    v_mfma_f32_16x16x32_bf16 v[148:151], a[124:127], a[20:23], v[148:151]
    buffer_load_dwordx4 v1, s[4:7], s44 offen offset:3072 sc1 lds
    v_mfma_f32_16x16x32_bf16 v[172:175], a[124:127], a[24:27], v[172:175]
    v_mfma_f32_16x16x32_bf16 v[196:199], a[124:127], a[28:31], v[196:199]
    v_mfma_f32_16x16x32_bf16 v[220:223], a[124:127], a[32:35], v[220:223]
    s_add_u32 s44, s44, 4096
    s_add_u32 m0, m0, 4096
    s_nop 0
    buffer_load_dwordx4 v1, s[4:7], s44 offen offset:0 sc1 lds
    v_mfma_f32_16x16x32_bf16 v[152:155], a[128:131], a[20:23], v[152:155]
    v_mfma_f32_16x16x32_bf16 v[176:179], a[128:131], a[24:27], v[176:179]
    v_mfma_f32_16x16x32_bf16 v[200:203], a[128:131], a[28:31], v[200:203]
    buffer_load_dwordx4 v1, s[4:7], s44 offen offset:1024 sc1 lds
    v_mfma_f32_16x16x32_bf16 v[224:227], a[128:131], a[32:35], v[224:227]
    v_mfma_f32_16x16x32_bf16 v[228:231], a[132:135], a[36:39], v[228:231]
    s_waitcnt vmcnt(16) lgkmcnt(0)
    v_mfma_f32_16x16x32_bf16 v[132:135], a[80:83], a[40:43], v[132:135]
    ds_read_b128 a[108:111], v5 offset:18432
    v_mfma_f32_16x16x32_bf16 v[156:159], a[80:83], a[44:47], v[156:159]
    buffer_load_dwordx4 a[20:23], v2, s[40:43], s35 offen offset:0 sc1
    v_mfma_f32_16x16x32_bf16 v[180:183], a[80:83], a[48:51], v[180:183]
    ds_read_b128 a[112:115], v5 offset:19456
    v_mfma_f32_16x16x32_bf16 v[204:207], a[80:83], a[52:55], v[204:207]
    v_mfma_f32_16x16x32_bf16 v[136:139], a[84:87], a[40:43], v[136:139]
    buffer_load_dwordx4 a[24:27], v2, s[40:43], s35 offen offset:1024 sc1
    v_mfma_f32_16x16x32_bf16 v[160:163], a[84:87], a[44:47], v[160:163]
    ds_read_b128 a[116:119], v5 offset:20480
    v_mfma_f32_16x16x32_bf16 v[184:187], a[84:87], a[48:51], v[184:187]
    v_mfma_f32_16x16x32_bf16 v[208:211], a[84:87], a[52:55], v[208:211]
    ds_read_b128 a[120:123], v5 offset:21504
    buffer_load_dwordx4 a[28:31], v2, s[40:43], s35 offen offset:2048 sc1
    v_mfma_f32_16x16x32_bf16 v[140:143], a[88:91], a[40:43], v[140:143]
    v_mfma_f32_16x16x32_bf16 v[164:167], a[88:91], a[44:47], v[164:167]
    v_mfma_f32_16x16x32_bf16 v[188:191], a[88:91], a[48:51], v[188:191]
    ds_read_b128 a[124:127], v5 offset:22528
    buffer_load_dwordx4 a[32:35], v2, s[40:43], s35 offen offset:3072 sc1
    v_mfma_f32_16x16x32_bf16 v[212:215], a[88:91], a[52:55], v[212:215]
    v_mfma_f32_16x16x32_bf16 v[144:147], a[92:95], a[40:43], v[144:147]
    ds_read_b128 a[128:131], v5 offset:23552
    v_mfma_f32_16x16x32_bf16 v[168:171], a[92:95], a[44:47], v[168:171]
    buffer_load_dwordx4 a[36:39], v3, s[40:43], s35 offen sc1
    s_add_u32 s35, s35, 4096
    s_and_b32 s35, s35, 0x1ffff
    v_mfma_f32_16x16x32_bf16 v[192:195], a[92:95], a[48:51], v[192:195]
    v_mfma_f32_16x16x32_bf16 v[216:219], a[92:95], a[52:55], v[216:219]
    ds_read_b128 a[132:135], v6 offset:18432
    v_mfma_f32_16x16x32_bf16 v[148:151], a[96:99], a[40:43], v[148:151]
    buffer_load_dwordx4 v1, s[4:7], s44 offen offset:2048 sc1 lds
    v_mfma_f32_16x16x32_bf16 v[172:175], a[96:99], a[44:47], v[172:175]
    v_mfma_f32_16x16x32_bf16 v[196:199], a[96:99], a[48:51], v[196:199]
    v_mfma_f32_16x16x32_bf16 v[220:223], a[96:99], a[52:55], v[220:223]
    buffer_load_dwordx4 v1, s[4:7], s44 offen offset:3072 sc1 lds
    v_mfma_f32_16x16x32_bf16 v[152:155], a[100:103], a[40:43], v[152:155]
    v_mfma_f32_16x16x32_bf16 v[176:179], a[100:103], a[44:47], v[176:179]
    v_mfma_f32_16x16x32_bf16 v[200:203], a[100:103], a[48:51], v[200:203]
    s_add_u32 s44, s44, 4096
    s_add_u32 m0, m0, 4096
    s_nop 0
    buffer_load_dwordx4 v1, s[4:7], s44 offen offset:0 sc1 lds
    v_mfma_f32_16x16x32_bf16 v[224:227], a[100:103], a[52:55], v[224:227]
    v_mfma_f32_16x16x32_bf16 v[228:231], a[104:107], a[56:59], v[228:231]
    s_waitcnt vmcnt(19) lgkmcnt(0)
    v_mfma_f32_16x16x32_bf16 v[132:135], a[108:111], a[60:63], v[132:135]
    ds_read_b128 a[80:83], v5 offset:24576
    v_mfma_f32_16x16x32_bf16 v[156:159], a[108:111], a[64:67], v[156:159]
    buffer_load_dwordx4 a[40:43], v2, s[40:43], s35 offen offset:0 sc1
    v_mfma_f32_16x16x32_bf16 v[180:183], a[108:111], a[68:71], v[180:183]
    ds_read_b128 a[84:87], v5 offset:25600
    v_mfma_f32_16x16x32_bf16 v[204:207], a[108:111], a[72:75], v[204:207]
    v_mfma_f32_16x16x32_bf16 v[136:139], a[112:115], a[60:63], v[136:139]
    buffer_load_dwordx4 a[44:47], v2, s[40:43], s35 offen offset:1024 sc1
    v_mfma_f32_16x16x32_bf16 v[160:163], a[112:115], a[64:67], v[160:163]
    ds_read_b128 a[88:91], v5 offset:26624
    v_mfma_f32_16x16x32_bf16 v[184:187], a[112:115], a[68:71], v[184:187]
    v_mfma_f32_16x16x32_bf16 v[208:211], a[112:115], a[72:75], v[208:211]
    ds_read_b128 a[92:95], v5 offset:27648
    buffer_load_dwordx4 a[48:51], v2, s[40:43], s35 offen offset:2048 sc1
    v_mfma_f32_16x16x32_bf16 v[140:143], a[116:119], a[60:63], v[140:143]
    v_mfma_f32_16x16x32_bf16 v[164:167], a[116:119], a[64:67], v[164:167]
    v_mfma_f32_16x16x32_bf16 v[188:191], a[116:119], a[68:71], v[188:191]
    ds_read_b128 a[96:99], v5 offset:28672
    buffer_load_dwordx4 a[52:55], v2, s[40:43], s35 offen offset:3072 sc1
    v_mfma_f32_16x16x32_bf16 v[212:215], a[116:119], a[72:75], v[212:215]
    v_mfma_f32_16x16x32_bf16 v[144:147], a[120:123], a[60:63], v[144:147]
    ds_read_b128 a[100:103], v5 offset:29696
    v_mfma_f32_16x16x32_bf16 v[168:171], a[120:123], a[64:67], v[168:171]
    buffer_load_dwordx4 a[56:59], v3, s[40:43], s35 offen sc1
    s_add_u32 s35, s35, 4096
    s_and_b32 s35, s35, 0x1ffff
    v_mfma_f32_16x16x32_bf16 v[192:195], a[120:123], a[68:71], v[192:195]
    v_mfma_f32_16x16x32_bf16 v[216:219], a[120:123], a[72:75], v[216:219]
    ds_read_b128 a[104:107], v6 offset:24576
    v_mfma_f32_16x16x32_bf16 v[148:151], a[124:127], a[60:63], v[148:151]
    buffer_load_dwordx4 v1, s[4:7], s44 offen offset:1024 sc1 lds
    v_mfma_f32_16x16x32_bf16 v[172:175], a[124:127], a[64:67], v[172:175]
    v_mfma_f32_16x16x32_bf16 v[196:199], a[124:127], a[68:71], v[196:199]
    v_mfma_f32_16x16x32_bf16 v[220:223], a[124:127], a[72:75], v[220:223]
    buffer_load_dwordx4 v1, s[4:7], s44 offen offset:2048 sc1 lds
    v_mfma_f32_16x16x32_bf16 v[152:155], a[128:131], a[60:63], v[152:155]
    v_mfma_f32_16x16x32_bf16 v[176:179], a[128:131], a[64:67], v[176:179]
    v_mfma_f32_16x16x32_bf16 v[200:203], a[128:131], a[68:71], v[200:203]
    buffer_load_dwordx4 v1, s[4:7], s44 offen offset:3072 sc1 lds
    v_mfma_f32_16x16x32_bf16 v[224:227], a[128:131], a[72:75], v[224:227]
    v_mfma_f32_16x16x32_bf16 v[228:231], a[132:135], a[76:79], v[228:231]
    s_waitcnt vmcnt(19) lgkmcnt(0)
    v_mfma_f32_16x16x32_bf16 v[132:135], a[80:83], a[0:3], v[132:135]
    ds_read_b128 a[108:111], v5 offset:30720
    v_mfma_f32_16x16x32_bf16 v[156:159], a[80:83], a[4:7], v[156:159]
    buffer_load_dwordx4 a[60:63], v2, s[40:43], s35 offen offset:0 sc1
    v_mfma_f32_16x16x32_bf16 v[180:183], a[80:83], a[8:11], v[180:183]
    ds_read_b128 a[112:115], v5 offset:31744
    v_mfma_f32_16x16x32_bf16 v[204:207], a[80:83], a[12:15], v[204:207]
    v_mfma_f32_16x16x32_bf16 v[136:139], a[84:87], a[0:3], v[136:139]
    v_mfma_f32_16x16x32_bf16 v[160:163], a[84:87], a[4:7], v[160:163]
    ds_read_b128 a[116:119], v5 offset:32768
    buffer_load_dwordx4 a[64:67], v2, s[40:43], s35 offen offset:1024 sc1
    v_mfma_f32_16x16x32_bf16 v[184:187], a[84:87], a[8:11], v[184:187]
    v_mfma_f32_16x16x32_bf16 v[208:211], a[84:87], a[12:15], v[208:211]
    ds_read_b128 a[120:123], v5 offset:33792
    v_mfma_f32_16x16x32_bf16 v[140:143], a[88:91], a[0:3], v[140:143]
    v_mfma_f32_16x16x32_bf16 v[164:167], a[88:91], a[4:7], v[164:167]
    v_mfma_f32_16x16x32_bf16 v[188:191], a[88:91], a[8:11], v[188:191]
    ds_read_b128 a[124:127], v5 offset:34816
    buffer_load_dwordx4 a[68:71], v2, s[40:43], s35 offen offset:2048 sc1
    v_mfma_f32_16x16x32_bf16 v[212:215], a[88:91], a[12:15], v[212:215]
    v_mfma_f32_16x16x32_bf16 v[144:147], a[92:95], a[0:3], v[144:147]
    ds_read_b128 a[128:131], v5 offset:35840
    v_mfma_f32_16x16x32_bf16 v[168:171], a[92:95], a[4:7], v[168:171]
    v_mfma_f32_16x16x32_bf16 v[192:195], a[92:95], a[8:11], v[192:195]
    v_mfma_f32_16x16x32_bf16 v[216:219], a[92:95], a[12:15], v[216:219]
    ds_read_b128 a[132:135], v6 offset:30720
    buffer_load_dwordx4 a[72:75], v2, s[40:43], s35 offen offset:3072 sc1
    v_mfma_f32_16x16x32_bf16 v[148:151], a[96:99], a[0:3], v[148:151]
    v_mfma_f32_16x16x32_bf16 v[172:175], a[96:99], a[4:7], v[172:175]
    v_mfma_f32_16x16x32_bf16 v[196:199], a[96:99], a[8:11], v[196:199]
    v_mfma_f32_16x16x32_bf16 v[220:223], a[96:99], a[12:15], v[220:223]
    v_mfma_f32_16x16x32_bf16 v[152:155], a[100:103], a[0:3], v[152:155]
    buffer_load_dwordx4 a[76:79], v3, s[40:43], s35 offen sc1
    s_add_u32 s35, s35, 4096
    s_and_b32 s35, s35, 0x1ffff
    v_mfma_f32_16x16x32_bf16 v[176:179], a[100:103], a[4:7], v[176:179]
    v_mfma_f32_16x16x32_bf16 v[200:203], a[100:103], a[8:11], v[200:203]
    v_mfma_f32_16x16x32_bf16 v[224:227], a[100:103], a[12:15], v[224:227]
    v_mfma_f32_16x16x32_bf16 v[228:231], a[104:107], a[16:19], v[228:231]
    s_waitcnt vmcnt(16) lgkmcnt(0)
    v_mfma_f32_16x16x32_bf16 v[132:135], a[108:111], a[20:23], v[132:135]
    ds_read_b128 a[80:83], v5 offset:36864
    v_mfma_f32_16x16x32_bf16 v[156:159], a[108:111], a[24:27], v[156:159]
    buffer_load_dwordx4 a[0:3], v2, s[40:43], s35 offen offset:0 sc1
    v_mfma_f32_16x16x32_bf16 v[180:183], a[108:111], a[28:31], v[180:183]
    ds_read_b128 a[84:87], v5 offset:37888
    v_mfma_f32_16x16x32_bf16 v[204:207], a[108:111], a[32:35], v[204:207]
    v_mfma_f32_16x16x32_bf16 v[136:139], a[112:115], a[20:23], v[136:139]
    buffer_load_dwordx4 a[4:7], v2, s[40:43], s35 offen offset:1024 sc1
    v_mfma_f32_16x16x32_bf16 v[160:163], a[112:115], a[24:27], v[160:163]
    ds_read_b128 a[88:91], v5 offset:38912
    v_mfma_f32_16x16x32_bf16 v[184:187], a[112:115], a[28:31], v[184:187]
    v_mfma_f32_16x16x32_bf16 v[208:211], a[112:115], a[32:35], v[208:211]
    ds_read_b128 a[92:95], v5 offset:39936
    buffer_load_dwordx4 a[8:11], v2, s[40:43], s35 offen offset:2048 sc1
    v_mfma_f32_16x16x32_bf16 v[140:143], a[116:119], a[20:23], v[140:143]
    v_mfma_f32_16x16x32_bf16 v[164:167], a[116:119], a[24:27], v[164:167]
    v_mfma_f32_16x16x32_bf16 v[188:191], a[116:119], a[28:31], v[188:191]
    ds_read_b128 a[96:99], v5 offset:40960
    v_mfma_f32_16x16x32_bf16 v[212:215], a[116:119], a[32:35], v[212:215]
    buffer_load_dwordx4 a[12:15], v2, s[40:43], s35 offen offset:3072 sc1
    v_mfma_f32_16x16x32_bf16 v[144:147], a[120:123], a[20:23], v[144:147]
    ds_read_b128 a[100:103], v5 offset:41984
    v_mfma_f32_16x16x32_bf16 v[168:171], a[120:123], a[24:27], v[168:171]
    v_mfma_f32_16x16x32_bf16 v[192:195], a[120:123], a[28:31], v[192:195]
    buffer_load_dwordx4 a[16:19], v3, s[40:43], s35 offen sc1
    s_add_u32 s35, s35, 4096
    s_and_b32 s35, s35, 0x1ffff
    v_mfma_f32_16x16x32_bf16 v[216:219], a[120:123], a[32:35], v[216:219]
    ds_read_b128 a[104:107], v6 offset:36864
    v_mfma_f32_16x16x32_bf16 v[148:151], a[124:127], a[20:23], v[148:151]
    v_mfma_f32_16x16x32_bf16 v[172:175], a[124:127], a[24:27], v[172:175]
    v_mfma_f32_16x16x32_bf16 v[196:199], a[124:127], a[28:31], v[196:199]
    s_lshl_b32 s44, s28, 1
    s_add_u32 s44, s44, s33
    s_add_u32 s44, s44, 16
    s_and_b32 s44, s44, 31
    s_mul_i32 s44, s44, 6144
    s_add_u32 s44, s44, s50
    s_add_u32 s44, s44, 0xe00000
    s_mul_i32 s45, s28, 12288
    s_add_u32 m0, s45, 98304
    s_nop 0
    buffer_load_dwordx4 v1, s[4:7], s44 offen offset:0 sc1 lds
    v_mfma_f32_16x16x32_bf16 v[220:223], a[124:127], a[32:35], v[220:223]
    v_mfma_f32_16x16x32_bf16 v[152:155], a[128:131], a[20:23], v[152:155]
    v_mfma_f32_16x16x32_bf16 v[176:179], a[128:131], a[24:27], v[176:179]
    buffer_load_dwordx4 v1, s[4:7], s44 offen offset:1024 sc1 lds
    v_mfma_f32_16x16x32_bf16 v[200:203], a[128:131], a[28:31], v[200:203]
    v_mfma_f32_16x16x32_bf16 v[224:227], a[128:131], a[32:35], v[224:227]
    v_mfma_f32_16x16x32_bf16 v[228:231], a[132:135], a[36:39], v[228:231]
    s_waitcnt vmcnt(15) lgkmcnt(0)
    v_mfma_f32_16x16x32_bf16 v[132:135], a[80:83], a[40:43], v[132:135]
    ds_read_b128 a[108:111], v5 offset:43008
    v_mfma_f32_16x16x32_bf16 v[156:159], a[80:83], a[44:47], v[156:159]
    buffer_load_dwordx4 a[20:23], v2, s[40:43], s35 offen offset:0 sc1
    v_mfma_f32_16x16x32_bf16 v[180:183], a[80:83], a[48:51], v[180:183]
    ds_read_b128 a[112:115], v5 offset:44032
    v_mfma_f32_16x16x32_bf16 v[204:207], a[80:83], a[52:55], v[204:207]
    v_mfma_f32_16x16x32_bf16 v[136:139], a[84:87], a[40:43], v[136:139]
    buffer_load_dwordx4 a[24:27], v2, s[40:43], s35 offen offset:1024 sc1
    v_mfma_f32_16x16x32_bf16 v[160:163], a[84:87], a[44:47], v[160:163]
    ds_read_b128 a[116:119], v5 offset:45056
    v_mfma_f32_16x16x32_bf16 v[184:187], a[84:87], a[48:51], v[184:187]
    v_mfma_f32_16x16x32_bf16 v[208:211], a[84:87], a[52:55], v[208:211]
    ds_read_b128 a[120:123], v5 offset:46080
    buffer_load_dwordx4 a[28:31], v2, s[40:43], s35 offen offset:2048 sc1
    v_mfma_f32_16x16x32_bf16 v[140:143], a[88:91], a[40:43], v[140:143]
    v_mfma_f32_16x16x32_bf16 v[164:167], a[88:91], a[44:47], v[164:167]
    v_mfma_f32_16x16x32_bf16 v[188:191], a[88:91], a[48:51], v[188:191]
    ds_read_b128 a[124:127], v5 offset:47104
    v_mfma_f32_16x16x32_bf16 v[212:215], a[88:91], a[52:55], v[212:215]
    buffer_load_dwordx4 a[32:35], v2, s[40:43], s35 offen offset:3072 sc1
    v_mfma_f32_16x16x32_bf16 v[144:147], a[92:95], a[40:43], v[144:147]
    ds_read_b128 a[128:131], v5 offset:48128
    v_mfma_f32_16x16x32_bf16 v[168:171], a[92:95], a[44:47], v[168:171]
    v_mfma_f32_16x16x32_bf16 v[192:195], a[92:95], a[48:51], v[192:195]
    buffer_load_dwordx4 a[36:39], v3, s[40:43], s35 offen sc1
    s_add_u32 s35, s35, 4096
    s_and_b32 s35, s35, 0x1ffff
    v_mfma_f32_16x16x32_bf16 v[216:219], a[92:95], a[52:55], v[216:219]
    ds_read_b128 a[132:135], v6 offset:43008
    v_mfma_f32_16x16x32_bf16 v[148:151], a[96:99], a[40:43], v[148:151]
    v_mfma_f32_16x16x32_bf16 v[172:175], a[96:99], a[44:47], v[172:175]
    v_mfma_f32_16x16x32_bf16 v[196:199], a[96:99], a[48:51], v[196:199]
    buffer_load_dwordx4 v1, s[4:7], s44 offen offset:2048 sc1 lds
    v_mfma_f32_16x16x32_bf16 v[220:223], a[96:99], a[52:55], v[220:223]
    v_mfma_f32_16x16x32_bf16 v[152:155], a[100:103], a[40:43], v[152:155]
    v_mfma_f32_16x16x32_bf16 v[176:179], a[100:103], a[44:47], v[176:179]
    buffer_load_dwordx4 v1, s[4:7], s44 offen offset:3072 sc1 lds
    v_mfma_f32_16x16x32_bf16 v[200:203], a[100:103], a[48:51], v[200:203]
    v_mfma_f32_16x16x32_bf16 v[224:227], a[100:103], a[52:55], v[224:227]
    v_mfma_f32_16x16x32_bf16 v[228:231], a[104:107], a[56:59], v[228:231]
    s_waitcnt vmcnt(14) lgkmcnt(0)
    s_barrier
    v_mfma_f32_16x16x32_bf16 v[132:135], a[108:111], a[60:63], v[132:135]
    v_add_u32 v5, 49152, v1
    ds_read_b128 a[80:83], v5 offset:0
    v_mfma_f32_16x16x32_bf16 v[156:159], a[108:111], a[64:67], v[156:159]
    buffer_load_dwordx4 a[40:43], v2, s[40:43], s35 offen offset:0 sc1
    v_mfma_f32_16x16x32_bf16 v[180:183], a[108:111], a[68:71], v[180:183]
    v_add_u32 v6, s39, v5
    ds_read_b128 a[84:87], v5 offset:1024
    v_mfma_f32_16x16x32_bf16 v[204:207], a[108:111], a[72:75], v[204:207]
    v_mfma_f32_16x16x32_bf16 v[136:139], a[112:115], a[60:63], v[136:139]
    buffer_load_dwordx4 a[44:47], v2, s[40:43], s35 offen offset:1024 sc1
    v_mfma_f32_16x16x32_bf16 v[160:163], a[112:115], a[64:67], v[160:163]
    ds_read_b128 a[88:91], v5 offset:2048
    v_mfma_f32_16x16x32_bf16 v[184:187], a[112:115], a[68:71], v[184:187]
    v_mfma_f32_16x16x32_bf16 v[208:211], a[112:115], a[72:75], v[208:211]
    ds_read_b128 a[92:95], v5 offset:3072
    buffer_load_dwordx4 a[48:51], v2, s[40:43], s35 offen offset:2048 sc1
    v_mfma_f32_16x16x32_bf16 v[140:143], a[116:119], a[60:63], v[140:143]
    v_mfma_f32_16x16x32_bf16 v[164:167], a[116:119], a[64:67], v[164:167]
    v_mfma_f32_16x16x32_bf16 v[188:191], a[116:119], a[68:71], v[188:191]
    ds_read_b128 a[96:99], v5 offset:4096
    v_mfma_f32_16x16x32_bf16 v[212:215], a[116:119], a[72:75], v[212:215]
    buffer_load_dwordx4 a[52:55], v2, s[40:43], s35 offen offset:3072 sc1
    v_mfma_f32_16x16x32_bf16 v[144:147], a[120:123], a[60:63], v[144:147]
    ds_read_b128 a[100:103], v5 offset:5120
    v_mfma_f32_16x16x32_bf16 v[168:171], a[120:123], a[64:67], v[168:171]
    v_mfma_f32_16x16x32_bf16 v[192:195], a[120:123], a[68:71], v[192:195]
    buffer_load_dwordx4 a[56:59], v3, s[40:43], s35 offen sc1
    s_add_u32 s35, s35, 4096
    s_and_b32 s35, s35, 0x1ffff
    v_mfma_f32_16x16x32_bf16 v[216:219], a[120:123], a[72:75], v[216:219]
    ds_read_b128 a[104:107], v6 offset:0
    v_mfma_f32_16x16x32_bf16 v[148:151], a[124:127], a[60:63], v[148:151]
    v_mfma_f32_16x16x32_bf16 v[172:175], a[124:127], a[64:67], v[172:175]
    v_mfma_f32_16x16x32_bf16 v[196:199], a[124:127], a[68:71], v[196:199]
    s_add_u32 s44, s44, 4096
    s_add_u32 m0, m0, 4096
    s_nop 0
    buffer_load_dwordx4 v1, s[4:7], s44 offen offset:0 sc1 lds
    v_mfma_f32_16x16x32_bf16 v[220:223], a[124:127], a[72:75], v[220:223]
    v_mfma_f32_16x16x32_bf16 v[152:155], a[128:131], a[60:63], v[152:155]
    v_mfma_f32_16x16x32_bf16 v[176:179], a[128:131], a[64:67], v[176:179]
    buffer_load_dwordx4 v1, s[4:7], s44 offen offset:1024 sc1 lds
    v_mfma_f32_16x16x32_bf16 v[200:203], a[128:131], a[68:71], v[200:203]
    v_mfma_f32_16x16x32_bf16 v[224:227], a[128:131], a[72:75], v[224:227]
    v_mfma_f32_16x16x32_bf16 v[228:231], a[132:135], a[76:79], v[228:231]
    s_waitcnt vmcnt(16) lgkmcnt(0)
    v_mfma_f32_16x16x32_bf16 v[132:135], a[80:83], a[0:3], v[132:135]
    ds_read_b128 a[108:111], v5 offset:6144
    v_mfma_f32_16x16x32_bf16 v[156:159], a[80:83], a[4:7], v[156:159]
    buffer_load_dwordx4 a[60:63], v2, s[40:43], s35 offen offset:0 sc1
    v_mfma_f32_16x16x32_bf16 v[180:183], a[80:83], a[8:11], v[180:183]
    ds_read_b128 a[112:115], v5 offset:7168
    v_mfma_f32_16x16x32_bf16 v[204:207], a[80:83], a[12:15], v[204:207]
    v_mfma_f32_16x16x32_bf16 v[136:139], a[84:87], a[0:3], v[136:139]
    v_mfma_f32_16x16x32_bf16 v[160:163], a[84:87], a[4:7], v[160:163]
    ds_read_b128 a[116:119], v5 offset:8192
    buffer_load_dwordx4 a[64:67], v2, s[40:43], s35 offen offset:1024 sc1
    v_mfma_f32_16x16x32_bf16 v[184:187], a[84:87], a[8:11], v[184:187]
    v_mfma_f32_16x16x32_bf16 v[208:211], a[84:87], a[12:15], v[208:211]
    ds_read_b128 a[120:123], v5 offset:9216
    v_mfma_f32_16x16x32_bf16 v[140:143], a[88:91], a[0:3], v[140:143]
    v_mfma_f32_16x16x32_bf16 v[164:167], a[88:91], a[4:7], v[164:167]
    buffer_load_dwordx4 a[68:71], v2, s[40:43], s35 offen offset:2048 sc1
    v_mfma_f32_16x16x32_bf16 v[188:191], a[88:91], a[8:11], v[188:191]
    ds_read_b128 a[124:127], v5 offset:10240
    v_mfma_f32_16x16x32_bf16 v[212:215], a[88:91], a[12:15], v[212:215]
    v_mfma_f32_16x16x32_bf16 v[144:147], a[92:95], a[0:3], v[144:147]
    ds_read_b128 a[128:131], v5 offset:11264
    v_mfma_f32_16x16x32_bf16 v[168:171], a[92:95], a[4:7], v[168:171]
    buffer_load_dwordx4 a[72:75], v2, s[40:43], s35 offen offset:3072 sc1
    v_mfma_f32_16x16x32_bf16 v[192:195], a[92:95], a[8:11], v[192:195]
    v_mfma_f32_16x16x32_bf16 v[216:219], a[92:95], a[12:15], v[216:219]
    ds_read_b128 a[132:135], v6 offset:6144
    v_mfma_f32_16x16x32_bf16 v[148:151], a[96:99], a[0:3], v[148:151]
    v_mfma_f32_16x16x32_bf16 v[172:175], a[96:99], a[4:7], v[172:175]
    buffer_load_dwordx4 a[76:79], v3, s[40:43], s35 offen sc1
    s_add_u32 s35, s35, 4096
    s_and_b32 s35, s35, 0x1ffff
    v_mfma_f32_16x16x32_bf16 v[196:199], a[96:99], a[8:11], v[196:199]
    v_mfma_f32_16x16x32_bf16 v[220:223], a[96:99], a[12:15], v[220:223]
    v_mfma_f32_16x16x32_bf16 v[152:155], a[100:103], a[0:3], v[152:155]
    v_mfma_f32_16x16x32_bf16 v[176:179], a[100:103], a[4:7], v[176:179]
    buffer_load_dwordx4 v1, s[4:7], s44 offen offset:2048 sc1 lds
    v_mfma_f32_16x16x32_bf16 v[200:203], a[100:103], a[8:11], v[200:203]
    v_mfma_f32_16x16x32_bf16 v[224:227], a[100:103], a[12:15], v[224:227]
    v_mfma_f32_16x16x32_bf16 v[228:231], a[104:107], a[16:19], v[228:231]
    s_waitcnt vmcnt(15) lgkmcnt(0)
    v_mfma_f32_16x16x32_bf16 v[132:135], a[108:111], a[20:23], v[132:135]
    ds_read_b128 a[80:83], v5 offset:12288
    v_mfma_f32_16x16x32_bf16 v[156:159], a[108:111], a[24:27], v[156:159]
    buffer_load_dwordx4 a[0:3], v2, s[40:43], s35 offen offset:0 sc1
    v_mfma_f32_16x16x32_bf16 v[180:183], a[108:111], a[28:31], v[180:183]
    ds_read_b128 a[84:87], v5 offset:13312
    v_mfma_f32_16x16x32_bf16 v[204:207], a[108:111], a[32:35], v[204:207]
    v_mfma_f32_16x16x32_bf16 v[136:139], a[112:115], a[20:23], v[136:139]
    buffer_load_dwordx4 a[4:7], v2, s[40:43], s35 offen offset:1024 sc1
    v_mfma_f32_16x16x32_bf16 v[160:163], a[112:115], a[24:27], v[160:163]
    ds_read_b128 a[88:91], v5 offset:14336
    v_mfma_f32_16x16x32_bf16 v[184:187], a[112:115], a[28:31], v[184:187]
    v_mfma_f32_16x16x32_bf16 v[208:211], a[112:115], a[32:35], v[208:211]
    ds_read_b128 a[92:95], v5 offset:15360
    buffer_load_dwordx4 a[8:11], v2, s[40:43], s35 offen offset:2048 sc1
    v_mfma_f32_16x16x32_bf16 v[140:143], a[116:119], a[20:23], v[140:143]
    v_mfma_f32_16x16x32_bf16 v[164:167], a[116:119], a[24:27], v[164:167]
    v_mfma_f32_16x16x32_bf16 v[188:191], a[116:119], a[28:31], v[188:191]
    ds_read_b128 a[96:99], v5 offset:16384
    v_mfma_f32_16x16x32_bf16 v[212:215], a[116:119], a[32:35], v[212:215]
    buffer_load_dwordx4 a[12:15], v2, s[40:43], s35 offen offset:3072 sc1
    v_mfma_f32_16x16x32_bf16 v[144:147], a[120:123], a[20:23], v[144:147]
    ds_read_b128 a[100:103], v5 offset:17408
    v_mfma_f32_16x16x32_bf16 v[168:171], a[120:123], a[24:27], v[168:171]
    v_mfma_f32_16x16x32_bf16 v[192:195], a[120:123], a[28:31], v[192:195]
    buffer_load_dwordx4 a[16:19], v3, s[40:43], s35 offen sc1
    s_add_u32 s35, s35, 4096
    s_and_b32 s35, s35, 0x1ffff
    v_mfma_f32_16x16x32_bf16 v[216:219], a[120:123], a[32:35], v[216:219]
    ds_read_b128 a[104:107], v6 offset:12288
    v_mfma_f32_16x16x32_bf16 v[148:151], a[124:127], a[20:23], v[148:151]
    v_mfma_f32_16x16x32_bf16 v[172:175], a[124:127], a[24:27], v[172:175]
    v_mfma_f32_16x16x32_bf16 v[196:199], a[124:127], a[28:31], v[196:199]
    buffer_load_dwordx4 v1, s[4:7], s44 offen offset:3072 sc1 lds
    v_mfma_f32_16x16x32_bf16 v[220:223], a[124:127], a[32:35], v[220:223]
    v_mfma_f32_16x16x32_bf16 v[152:155], a[128:131], a[20:23], v[152:155]
    v_mfma_f32_16x16x32_bf16 v[176:179], a[128:131], a[24:27], v[176:179]
    s_add_u32 s44, s44, 4096
    s_add_u32 m0, m0, 4096
    s_nop 0
    buffer_load_dwordx4 v1, s[4:7], s44 offen offset:0 sc1 lds
    v_mfma_f32_16x16x32_bf16 v[200:203], a[128:131], a[28:31], v[200:203]
    v_mfma_f32_16x16x32_bf16 v[224:227], a[128:131], a[32:35], v[224:227]
    v_mfma_f32_16x16x32_bf16 v[228:231], a[132:135], a[36:39], v[228:231]
    s_waitcnt vmcnt(15) lgkmcnt(0)
    v_mfma_f32_16x16x32_bf16 v[132:135], a[80:83], a[40:43], v[132:135]
    ds_read_b128 a[108:111], v5 offset:18432
    v_mfma_f32_16x16x32_bf16 v[156:159], a[80:83], a[44:47], v[156:159]
    buffer_load_dwordx4 a[20:23], v2, s[40:43], s35 offen offset:0 sc1
    v_mfma_f32_16x16x32_bf16 v[180:183], a[80:83], a[48:51], v[180:183]
    ds_read_b128 a[112:115], v5 offset:19456
    v_mfma_f32_16x16x32_bf16 v[204:207], a[80:83], a[52:55], v[204:207]
    v_mfma_f32_16x16x32_bf16 v[136:139], a[84:87], a[40:43], v[136:139]
    buffer_load_dwordx4 a[24:27], v2, s[40:43], s35 offen offset:1024 sc1
    v_mfma_f32_16x16x32_bf16 v[160:163], a[84:87], a[44:47], v[160:163]
    ds_read_b128 a[116:119], v5 offset:20480
    v_mfma_f32_16x16x32_bf16 v[184:187], a[84:87], a[48:51], v[184:187]
    v_mfma_f32_16x16x32_bf16 v[208:211], a[84:87], a[52:55], v[208:211]
    ds_read_b128 a[120:123], v5 offset:21504
    buffer_load_dwordx4 a[28:31], v2, s[40:43], s35 offen offset:2048 sc1
    v_mfma_f32_16x16x32_bf16 v[140:143], a[88:91], a[40:43], v[140:143]
    v_mfma_f32_16x16x32_bf16 v[164:167], a[88:91], a[44:47], v[164:167]
    v_mfma_f32_16x16x32_bf16 v[188:191], a[88:91], a[48:51], v[188:191]
    ds_read_b128 a[124:127], v5 offset:22528
    v_mfma_f32_16x16x32_bf16 v[212:215], a[88:91], a[52:55], v[212:215]
    buffer_load_dwordx4 a[32:35], v2, s[40:43], s35 offen offset:3072 sc1
    v_mfma_f32_16x16x32_bf16 v[144:147], a[92:95], a[40:43], v[144:147]
    ds_read_b128 a[128:131], v5 offset:23552
    v_mfma_f32_16x16x32_bf16 v[168:171], a[92:95], a[44:47], v[168:171]
    v_mfma_f32_16x16x32_bf16 v[192:195], a[92:95], a[48:51], v[192:195]
    buffer_load_dwordx4 a[36:39], v3, s[40:43], s35 offen sc1
    s_add_u32 s35, s35, 4096
    s_and_b32 s35, s35, 0x1ffff
    v_mfma_f32_16x16x32_bf16 v[216:219], a[92:95], a[52:55], v[216:219]
    ds_read_b128 a[132:135], v6 offset:18432
    v_mfma_f32_16x16x32_bf16 v[148:151], a[96:99], a[40:43], v[148:151]
    v_mfma_f32_16x16x32_bf16 v[172:175], a[96:99], a[44:47], v[172:175]
    v_mfma_f32_16x16x32_bf16 v[196:199], a[96:99], a[48:51], v[196:199]
    buffer_load_dwordx4 v1, s[4:7], s44 offen offset:1024 sc1 lds
    v_mfma_f32_16x16x32_bf16 v[220:223], a[96:99], a[52:55], v[220:223]
    v_mfma_f32_16x16x32_bf16 v[152:155], a[100:103], a[40:43], v[152:155]
    v_mfma_f32_16x16x32_bf16 v[176:179], a[100:103], a[44:47], v[176:179]
    buffer_load_dwordx4 v1, s[4:7], s44 offen offset:2048 sc1 lds
    v_mfma_f32_16x16x32_bf16 v[200:203], a[100:103], a[48:51], v[200:203]
    v_mfma_f32_16x16x32_bf16 v[224:227], a[100:103], a[52:55], v[224:227]
    v_mfma_f32_16x16x32_bf16 v[228:231], a[104:107], a[56:59], v[228:231]
    s_waitcnt vmcnt(15) lgkmcnt(0)
    v_mfma_f32_16x16x32_bf16 v[132:135], a[108:111], a[60:63], v[132:135]
    ds_read_b128 a[80:83], v5 offset:24576
    v_mfma_f32_16x16x32_bf16 v[156:159], a[108:111], a[64:67], v[156:159]
    buffer_load_dwordx4 a[40:43], v2, s[40:43], s35 offen offset:0 sc1
    v_mfma_f32_16x16x32_bf16 v[180:183], a[108:111], a[68:71], v[180:183]
    ds_read_b128 a[84:87], v5 offset:25600
    v_mfma_f32_16x16x32_bf16 v[204:207], a[108:111], a[72:75], v[204:207]
    v_mfma_f32_16x16x32_bf16 v[136:139], a[112:115], a[60:63], v[136:139]
    v_mfma_f32_16x16x32_bf16 v[160:163], a[112:115], a[64:67], v[160:163]
    ds_read_b128 a[88:91], v5 offset:26624
    buffer_load_dwordx4 a[44:47], v2, s[40:43], s35 offen offset:1024 sc1
    v_mfma_f32_16x16x32_bf16 v[184:187], a[112:115], a[68:71], v[184:187]
    v_mfma_f32_16x16x32_bf16 v[208:211], a[112:115], a[72:75], v[208:211]
    ds_read_b128 a[92:95], v5 offset:27648
    v_mfma_f32_16x16x32_bf16 v[140:143], a[116:119], a[60:63], v[140:143]
    v_mfma_f32_16x16x32_bf16 v[164:167], a[116:119], a[64:67], v[164:167]
    buffer_load_dwordx4 a[48:51], v2, s[40:43], s35 offen offset:2048 sc1
    v_mfma_f32_16x16x32_bf16 v[188:191], a[116:119], a[68:71], v[188:191]
    ds_read_b128 a[96:99], v5 offset:28672
    v_mfma_f32_16x16x32_bf16 v[212:215], a[116:119], a[72:75], v[212:215]
    v_mfma_f32_16x16x32_bf16 v[144:147], a[120:123], a[60:63], v[144:147]
    ds_read_b128 a[100:103], v5 offset:29696
    v_mfma_f32_16x16x32_bf16 v[168:171], a[120:123], a[64:67], v[168:171]
    buffer_load_dwordx4 a[52:55], v2, s[40:43], s35 offen offset:3072 sc1
    v_mfma_f32_16x16x32_bf16 v[192:195], a[120:123], a[68:71], v[192:195]
    v_mfma_f32_16x16x32_bf16 v[216:219], a[120:123], a[72:75], v[216:219]
    ds_read_b128 a[104:107], v6 offset:24576
    v_mfma_f32_16x16x32_bf16 v[148:151], a[124:127], a[60:63], v[148:151]
    v_mfma_f32_16x16x32_bf16 v[172:175], a[124:127], a[64:67], v[172:175]
    buffer_load_dwordx4 a[56:59], v3, s[40:43], s35 offen sc1
    s_add_u32 s35, s35, 4096
    s_and_b32 s35, s35, 0x1ffff
    v_mfma_f32_16x16x32_bf16 v[196:199], a[124:127], a[68:71], v[196:199]
    v_mfma_f32_16x16x32_bf16 v[220:223], a[124:127], a[72:75], v[220:223]
    v_mfma_f32_16x16x32_bf16 v[152:155], a[128:131], a[60:63], v[152:155]
    v_mfma_f32_16x16x32_bf16 v[176:179], a[128:131], a[64:67], v[176:179]
    buffer_load_dwordx4 v1, s[4:7], s44 offen offset:3072 sc1 lds
    v_mfma_f32_16x16x32_bf16 v[200:203], a[128:131], a[68:71], v[200:203]
    v_mfma_f32_16x16x32_bf16 v[224:227], a[128:131], a[72:75], v[224:227]
    v_mfma_f32_16x16x32_bf16 v[228:231], a[132:135], a[76:79], v[228:231]
    s_waitcnt vmcnt(15) lgkmcnt(0)
    v_mfma_f32_16x16x32_bf16 v[132:135], a[80:83], a[0:3], v[132:135]
    ds_read_b128 a[108:111], v5 offset:30720
    v_mfma_f32_16x16x32_bf16 v[156:159], a[80:83], a[4:7], v[156:159]
    buffer_load_dwordx4 a[60:63], v2, s[40:43], s35 offen offset:0 sc1
    v_mfma_f32_16x16x32_bf16 v[180:183], a[80:83], a[8:11], v[180:183]
    ds_read_b128 a[112:115], v5 offset:31744
    v_mfma_f32_16x16x32_bf16 v[204:207], a[80:83], a[12:15], v[204:207]
    v_mfma_f32_16x16x32_bf16 v[136:139], a[84:87], a[0:3], v[136:139]
    v_mfma_f32_16x16x32_bf16 v[160:163], a[84:87], a[4:7], v[160:163]
    ds_read_b128 a[116:119], v5 offset:32768
    buffer_load_dwordx4 a[64:67], v2, s[40:43], s35 offen offset:1024 sc1
    v_mfma_f32_16x16x32_bf16 v[184:187], a[84:87], a[8:11], v[184:187]
    v_mfma_f32_16x16x32_bf16 v[208:211], a[84:87], a[12:15], v[208:211]
    ds_read_b128 a[120:123], v5 offset:33792
    v_mfma_f32_16x16x32_bf16 v[140:143], a[88:91], a[0:3], v[140:143]
    v_mfma_f32_16x16x32_bf16 v[164:167], a[88:91], a[4:7], v[164:167]
    v_mfma_f32_16x16x32_bf16 v[188:191], a[88:91], a[8:11], v[188:191]
    ds_read_b128 a[124:127], v5 offset:34816
    buffer_load_dwordx4 a[68:71], v2, s[40:43], s35 offen offset:2048 sc1
    v_mfma_f32_16x16x32_bf16 v[212:215], a[88:91], a[12:15], v[212:215]
    v_mfma_f32_16x16x32_bf16 v[144:147], a[92:95], a[0:3], v[144:147]
    ds_read_b128 a[128:131], v5 offset:35840
    v_mfma_f32_16x16x32_bf16 v[168:171], a[92:95], a[4:7], v[168:171]
    v_mfma_f32_16x16x32_bf16 v[192:195], a[92:95], a[8:11], v[192:195]
    v_mfma_f32_16x16x32_bf16 v[216:219], a[92:95], a[12:15], v[216:219]
    ds_read_b128 a[132:135], v6 offset:30720
    buffer_load_dwordx4 a[72:75], v2, s[40:43], s35 offen offset:3072 sc1
    v_mfma_f32_16x16x32_bf16 v[148:151], a[96:99], a[0:3], v[148:151]
    v_mfma_f32_16x16x32_bf16 v[172:175], a[96:99], a[4:7], v[172:175]
    v_mfma_f32_16x16x32_bf16 v[196:199], a[96:99], a[8:11], v[196:199]
    v_mfma_f32_16x16x32_bf16 v[220:223], a[96:99], a[12:15], v[220:223]
    v_mfma_f32_16x16x32_bf16 v[152:155], a[100:103], a[0:3], v[152:155]
    buffer_load_dwordx4 a[76:79], v3, s[40:43], s35 offen sc1
    s_add_u32 s35, s35, 4096
    s_and_b32 s35, s35, 0x1ffff
    v_mfma_f32_16x16x32_bf16 v[176:179], a[100:103], a[4:7], v[176:179]
    v_mfma_f32_16x16x32_bf16 v[200:203], a[100:103], a[8:11], v[200:203]
    v_mfma_f32_16x16x32_bf16 v[224:227], a[100:103], a[12:15], v[224:227]
    v_mfma_f32_16x16x32_bf16 v[228:231], a[104:107], a[16:19], v[228:231]
    s_waitcnt vmcnt(13) lgkmcnt(0)
    v_mfma_f32_16x16x32_bf16 v[132:135], a[108:111], a[20:23], v[132:135]
    ds_read_b128 a[80:83], v5 offset:36864
    v_mfma_f32_16x16x32_bf16 v[156:159], a[108:111], a[24:27], v[156:159]
    buffer_load_dwordx4 a[0:3], v2, s[40:43], s35 offen offset:0 sc1
    v_mfma_f32_16x16x32_bf16 v[180:183], a[108:111], a[28:31], v[180:183]
    ds_read_b128 a[84:87], v5 offset:37888
    v_mfma_f32_16x16x32_bf16 v[204:207], a[108:111], a[32:35], v[204:207]
    v_mfma_f32_16x16x32_bf16 v[136:139], a[112:115], a[20:23], v[136:139]
    buffer_load_dwordx4 a[4:7], v2, s[40:43], s35 offen offset:1024 sc1
    v_mfma_f32_16x16x32_bf16 v[160:163], a[112:115], a[24:27], v[160:163]
    ds_read_b128 a[88:91], v5 offset:38912
    v_mfma_f32_16x16x32_bf16 v[184:187], a[112:115], a[28:31], v[184:187]
    v_mfma_f32_16x16x32_bf16 v[208:211], a[112:115], a[32:35], v[208:211]
    ds_read_b128 a[92:95], v5 offset:39936
    buffer_load_dwordx4 a[8:11], v2, s[40:43], s35 offen offset:2048 sc1
    v_mfma_f32_16x16x32_bf16 v[140:143], a[116:119], a[20:23], v[140:143]
    v_mfma_f32_16x16x32_bf16 v[164:167], a[116:119], a[24:27], v[164:167]
    v_mfma_f32_16x16x32_bf16 v[188:191], a[116:119], a[28:31], v[188:191]
    ds_read_b128 a[96:99], v5 offset:40960
    v_mfma_f32_16x16x32_bf16 v[212:215], a[116:119], a[32:35], v[212:215]
    buffer_load_dwordx4 a[12:15], v2, s[40:43], s35 offen offset:3072 sc1
    v_mfma_f32_16x16x32_bf16 v[144:147], a[120:123], a[20:23], v[144:147]
    ds_read_b128 a[100:103], v5 offset:41984
    v_mfma_f32_16x16x32_bf16 v[168:171], a[120:123], a[24:27], v[168:171]
    v_mfma_f32_16x16x32_bf16 v[192:195], a[120:123], a[28:31], v[192:195]
    buffer_load_dwordx4 a[16:19], v3, s[40:43], s35 offen sc1
    s_add_u32 s35, s35, 4096
    s_and_b32 s35, s35, 0x1ffff
    v_mfma_f32_16x16x32_bf16 v[216:219], a[120:123], a[32:35], v[216:219]
    ds_read_b128 a[104:107], v6 offset:36864
    v_mfma_f32_16x16x32_bf16 v[148:151], a[124:127], a[20:23], v[148:151]
    v_mfma_f32_16x16x32_bf16 v[172:175], a[124:127], a[24:27], v[172:175]
    v_mfma_f32_16x16x32_bf16 v[196:199], a[124:127], a[28:31], v[196:199]
    s_lshl_b32 s44, s28, 1
    s_add_u32 s44, s44, s33
    s_add_u32 s44, s44, 24
    s_and_b32 s44, s44, 31
    s_mul_i32 s44, s44, 6144
    s_add_u32 s44, s44, s50
    s_add_u32 s44, s44, 0xe00000
    s_mul_i32 s45, s28, 12288
    s_add_u32 m0, s45, 0
    s_nop 0
    buffer_load_dwordx4 v1, s[4:7], s44 offen offset:0 sc1 lds
    v_mfma_f32_16x16x32_bf16 v[220:223], a[124:127], a[32:35], v[220:223]
    v_mfma_f32_16x16x32_bf16 v[152:155], a[128:131], a[20:23], v[152:155]
    v_mfma_f32_16x16x32_bf16 v[176:179], a[128:131], a[24:27], v[176:179]
    buffer_load_dwordx4 v1, s[4:7], s44 offen offset:1024 sc1 lds
    v_mfma_f32_16x16x32_bf16 v[200:203], a[128:131], a[28:31], v[200:203]
    v_mfma_f32_16x16x32_bf16 v[224:227], a[128:131], a[32:35], v[224:227]
    v_mfma_f32_16x16x32_bf16 v[228:231], a[132:135], a[36:39], v[228:231]
    s_waitcnt vmcnt(13) lgkmcnt(0)
    v_mfma_f32_16x16x32_bf16 v[132:135], a[80:83], a[40:43], v[132:135]
    ds_read_b128 a[108:111], v5 offset:43008
    v_mfma_f32_16x16x32_bf16 v[156:159], a[80:83], a[44:47], v[156:159]
    buffer_load_dwordx4 a[20:23], v2, s[40:43], s35 offen offset:0 sc1
    v_mfma_f32_16x16x32_bf16 v[180:183], a[80:83], a[48:51], v[180:183]
    ds_read_b128 a[112:115], v5 offset:44032
    v_mfma_f32_16x16x32_bf16 v[204:207], a[80:83], a[52:55], v[204:207]
    v_mfma_f32_16x16x32_bf16 v[136:139], a[84:87], a[40:43], v[136:139]
    buffer_load_dwordx4 a[24:27], v2, s[40:43], s35 offen offset:1024 sc1
    v_mfma_f32_16x16x32_bf16 v[160:163], a[84:87], a[44:47], v[160:163]
    ds_read_b128 a[116:119], v5 offset:45056
    v_mfma_f32_16x16x32_bf16 v[184:187], a[84:87], a[48:51], v[184:187]
    v_mfma_f32_16x16x32_bf16 v[208:211], a[84:87], a[52:55], v[208:211]
    ds_read_b128 a[120:123], v5 offset:46080
    buffer_load_dwordx4 a[28:31], v2, s[40:43], s35 offen offset:2048 sc1
    v_mfma_f32_16x16x32_bf16 v[140:143], a[88:91], a[40:43], v[140:143]
    v_mfma_f32_16x16x32_bf16 v[164:167], a[88:91], a[44:47], v[164:167]
    v_mfma_f32_16x16x32_bf16 v[188:191], a[88:91], a[48:51], v[188:191]
    ds_read_b128 a[124:127], v5 offset:47104
    v_mfma_f32_16x16x32_bf16 v[212:215], a[88:91], a[52:55], v[212:215]
    buffer_load_dwordx4 a[32:35], v2, s[40:43], s35 offen offset:3072 sc1
    v_mfma_f32_16x16x32_bf16 v[144:147], a[92:95], a[40:43], v[144:147]
    ds_read_b128 a[128:131], v5 offset:48128
    v_mfma_f32_16x16x32_bf16 v[168:171], a[92:95], a[44:47], v[168:171]
    v_mfma_f32_16x16x32_bf16 v[192:195], a[92:95], a[48:51], v[192:195]
    buffer_load_dwordx4 a[36:39], v3, s[40:43], s35 offen sc1
    s_add_u32 s35, s35, 4096
    s_and_b32 s35, s35, 0x1ffff
    v_mfma_f32_16x16x32_bf16 v[216:219], a[92:95], a[52:55], v[216:219]
    ds_read_b128 a[132:135], v6 offset:43008
    v_mfma_f32_16x16x32_bf16 v[148:151], a[96:99], a[40:43], v[148:151]
    v_mfma_f32_16x16x32_bf16 v[172:175], a[96:99], a[44:47], v[172:175]
    v_mfma_f32_16x16x32_bf16 v[196:199], a[96:99], a[48:51], v[196:199]
    buffer_load_dwordx4 v1, s[4:7], s44 offen offset:2048 sc1 lds
    v_mfma_f32_16x16x32_bf16 v[220:223], a[96:99], a[52:55], v[220:223]
    v_mfma_f32_16x16x32_bf16 v[152:155], a[100:103], a[40:43], v[152:155]
    v_mfma_f32_16x16x32_bf16 v[176:179], a[100:103], a[44:47], v[176:179]
    buffer_load_dwordx4 v1, s[4:7], s44 offen offset:3072 sc1 lds
    v_mfma_f32_16x16x32_bf16 v[200:203], a[100:103], a[48:51], v[200:203]
    v_mfma_f32_16x16x32_bf16 v[224:227], a[100:103], a[52:55], v[224:227]
    v_mfma_f32_16x16x32_bf16 v[228:231], a[104:107], a[56:59], v[228:231]
    s_waitcnt vmcnt(14) lgkmcnt(0)
    s_barrier
    v_mfma_f32_16x16x32_bf16 v[132:135], a[108:111], a[60:63], v[132:135]
    v_add_u32 v5, 98304, v1
    ds_read_b128 a[80:83], v5 offset:0
    v_mfma_f32_16x16x32_bf16 v[156:159], a[108:111], a[64:67], v[156:159]
    buffer_load_dwordx4 a[40:43], v2, s[40:43], s35 offen offset:0 sc1
    v_mfma_f32_16x16x32_bf16 v[180:183], a[108:111], a[68:71], v[180:183]
    v_add_u32 v6, s39, v5
    ds_read_b128 a[84:87], v5 offset:1024
    v_mfma_f32_16x16x32_bf16 v[204:207], a[108:111], a[72:75], v[204:207]
    v_mfma_f32_16x16x32_bf16 v[136:139], a[112:115], a[60:63], v[136:139]
    buffer_load_dwordx4 a[44:47], v2, s[40:43], s35 offen offset:1024 sc1
    v_mfma_f32_16x16x32_bf16 v[160:163], a[112:115], a[64:67], v[160:163]
    ds_read_b128 a[88:91], v5 offset:2048
    v_mfma_f32_16x16x32_bf16 v[184:187], a[112:115], a[68:71], v[184:187]
    v_mfma_f32_16x16x32_bf16 v[208:211], a[112:115], a[72:75], v[208:211]
    ds_read_b128 a[92:95], v5 offset:3072
    buffer_load_dwordx4 a[48:51], v2, s[40:43], s35 offen offset:2048 sc1
    v_mfma_f32_16x16x32_bf16 v[140:143], a[116:119], a[60:63], v[140:143]
    v_mfma_f32_16x16x32_bf16 v[164:167], a[116:119], a[64:67], v[164:167]
    v_mfma_f32_16x16x32_bf16 v[188:191], a[116:119], a[68:71], v[188:191]
    ds_read_b128 a[96:99], v5 offset:4096
    v_mfma_f32_16x16x32_bf16 v[212:215], a[116:119], a[72:75], v[212:215]
    buffer_load_dwordx4 a[52:55], v2, s[40:43], s35 offen offset:3072 sc1
    v_mfma_f32_16x16x32_bf16 v[144:147], a[120:123], a[60:63], v[144:147]
    ds_read_b128 a[100:103], v5 offset:5120
    v_mfma_f32_16x16x32_bf16 v[168:171], a[120:123], a[64:67], v[168:171]
    v_mfma_f32_16x16x32_bf16 v[192:195], a[120:123], a[68:71], v[192:195]
    buffer_load_dwordx4 a[56:59], v3, s[40:43], s35 offen sc1
    s_add_u32 s35, s35, 4096
    s_and_b32 s35, s35, 0x1ffff
    v_mfma_f32_16x16x32_bf16 v[216:219], a[120:123], a[72:75], v[216:219]
    ds_read_b128 a[104:107], v6 offset:0
    v_mfma_f32_16x16x32_bf16 v[148:151], a[124:127], a[60:63], v[148:151]
    v_mfma_f32_16x16x32_bf16 v[172:175], a[124:127], a[64:67], v[172:175]
    v_mfma_f32_16x16x32_bf16 v[196:199], a[124:127], a[68:71], v[196:199]
    s_add_u32 s44, s44, 4096
    s_add_u32 m0, m0, 4096
    s_nop 0
    buffer_load_dwordx4 v1, s[4:7], s44 offen offset:0 sc1 lds
    v_mfma_f32_16x16x32_bf16 v[220:223], a[124:127], a[72:75], v[220:223]
    v_mfma_f32_16x16x32_bf16 v[152:155], a[128:131], a[60:63], v[152:155]
    v_mfma_f32_16x16x32_bf16 v[176:179], a[128:131], a[64:67], v[176:179]
    buffer_load_dwordx4 v1, s[4:7], s44 offen offset:1024 sc1 lds
    v_mfma_f32_16x16x32_bf16 v[200:203], a[128:131], a[68:71], v[200:203]
    v_mfma_f32_16x16x32_bf16 v[224:227], a[128:131], a[72:75], v[224:227]
    v_mfma_f32_16x16x32_bf16 v[228:231], a[132:135], a[76:79], v[228:231]
    s_waitcnt vmcnt(16) lgkmcnt(0)
    v_mfma_f32_16x16x32_bf16 v[132:135], a[80:83], a[0:3], v[132:135]
    ds_read_b128 a[108:111], v5 offset:6144
    v_mfma_f32_16x16x32_bf16 v[156:159], a[80:83], a[4:7], v[156:159]
    buffer_load_dwordx4 a[60:63], v2, s[40:43], s35 offen offset:0 sc1
    v_mfma_f32_16x16x32_bf16 v[180:183], a[80:83], a[8:11], v[180:183]
    ds_read_b128 a[112:115], v5 offset:7168
    v_mfma_f32_16x16x32_bf16 v[204:207], a[80:83], a[12:15], v[204:207]
    v_mfma_f32_16x16x32_bf16 v[136:139], a[84:87], a[0:3], v[136:139]
    v_mfma_f32_16x16x32_bf16 v[160:163], a[84:87], a[4:7], v[160:163]
    ds_read_b128 a[116:119], v5 offset:8192
    buffer_load_dwordx4 a[64:67], v2, s[40:43], s35 offen offset:1024 sc1
    v_mfma_f32_16x16x32_bf16 v[184:187], a[84:87], a[8:11], v[184:187]
    v_mfma_f32_16x16x32_bf16 v[208:211], a[84:87], a[12:15], v[208:211]
    ds_read_b128 a[120:123], v5 offset:9216
    v_mfma_f32_16x16x32_bf16 v[140:143], a[88:91], a[0:3], v[140:143]
    v_mfma_f32_16x16x32_bf16 v[164:167], a[88:91], a[4:7], v[164:167]
    buffer_load_dwordx4 a[68:71], v2, s[40:43], s35 offen offset:2048 sc1
    v_mfma_f32_16x16x32_bf16 v[188:191], a[88:91], a[8:11], v[188:191]
    ds_read_b128 a[124:127], v5 offset:10240
    v_mfma_f32_16x16x32_bf16 v[212:215], a[88:91], a[12:15], v[212:215]
    v_mfma_f32_16x16x32_bf16 v[144:147], a[92:95], a[0:3], v[144:147]
    ds_read_b128 a[128:131], v5 offset:11264
    v_mfma_f32_16x16x32_bf16 v[168:171], a[92:95], a[4:7], v[168:171]
    buffer_load_dwordx4 a[72:75], v2, s[40:43], s35 offen offset:3072 sc1
    v_mfma_f32_16x16x32_bf16 v[192:195], a[92:95], a[8:11], v[192:195]
    v_mfma_f32_16x16x32_bf16 v[216:219], a[92:95], a[12:15], v[216:219]
    ds_read_b128 a[132:135], v6 offset:6144
    v_mfma_f32_16x16x32_bf16 v[148:151], a[96:99], a[0:3], v[148:151]
    v_mfma_f32_16x16x32_bf16 v[172:175], a[96:99], a[4:7], v[172:175]
    buffer_load_dwordx4 a[76:79], v3, s[40:43], s35 offen sc1
    s_add_u32 s35, s35, 4096
    s_and_b32 s35, s35, 0x1ffff
    v_mfma_f32_16x16x32_bf16 v[196:199], a[96:99], a[8:11], v[196:199]
    v_mfma_f32_16x16x32_bf16 v[220:223], a[96:99], a[12:15], v[220:223]
    v_mfma_f32_16x16x32_bf16 v[152:155], a[100:103], a[0:3], v[152:155]
    v_mfma_f32_16x16x32_bf16 v[176:179], a[100:103], a[4:7], v[176:179]
    buffer_load_dwordx4 v1, s[4:7], s44 offen offset:2048 sc1 lds
    v_mfma_f32_16x16x32_bf16 v[200:203], a[100:103], a[8:11], v[200:203]
    v_mfma_f32_16x16x32_bf16 v[224:227], a[100:103], a[12:15], v[224:227]
    v_mfma_f32_16x16x32_bf16 v[228:231], a[104:107], a[16:19], v[228:231]
    s_waitcnt vmcnt(15) lgkmcnt(0)
    v_mfma_f32_16x16x32_bf16 v[132:135], a[108:111], a[20:23], v[132:135]
    ds_read_b128 a[80:83], v5 offset:12288
    v_mfma_f32_16x16x32_bf16 v[156:159], a[108:111], a[24:27], v[156:159]
    buffer_load_dwordx4 a[0:3], v2, s[40:43], s35 offen offset:0 sc1
    v_mfma_f32_16x16x32_bf16 v[180:183], a[108:111], a[28:31], v[180:183]
    ds_read_b128 a[84:87], v5 offset:13312
    v_mfma_f32_16x16x32_bf16 v[204:207], a[108:111], a[32:35], v[204:207]
    v_mfma_f32_16x16x32_bf16 v[136:139], a[112:115], a[20:23], v[136:139]
    buffer_load_dwordx4 a[4:7], v2, s[40:43], s35 offen offset:1024 sc1
    v_mfma_f32_16x16x32_bf16 v[160:163], a[112:115], a[24:27], v[160:163]
    ds_read_b128 a[88:91], v5 offset:14336
    v_mfma_f32_16x16x32_bf16 v[184:187], a[112:115], a[28:31], v[184:187]
    v_mfma_f32_16x16x32_bf16 v[208:211], a[112:115], a[32:35], v[208:211]
    ds_read_b128 a[92:95], v5 offset:15360
    buffer_load_dwordx4 a[8:11], v2, s[40:43], s35 offen offset:2048 sc1
    v_mfma_f32_16x16x32_bf16 v[140:143], a[116:119], a[20:23], v[140:143]
    v_mfma_f32_16x16x32_bf16 v[164:167], a[116:119], a[24:27], v[164:167]
    v_mfma_f32_16x16x32_bf16 v[188:191], a[116:119], a[28:31], v[188:191]
    ds_read_b128 a[96:99], v5 offset:16384
    v_mfma_f32_16x16x32_bf16 v[212:215], a[116:119], a[32:35], v[212:215]
    buffer_load_dwordx4 a[12:15], v2, s[40:43], s35 offen offset:3072 sc1
    v_mfma_f32_16x16x32_bf16 v[144:147], a[120:123], a[20:23], v[144:147]
    ds_read_b128 a[100:103], v5 offset:17408
    v_mfma_f32_16x16x32_bf16 v[168:171], a[120:123], a[24:27], v[168:171]
    v_mfma_f32_16x16x32_bf16 v[192:195], a[120:123], a[28:31], v[192:195]
    buffer_load_dwordx4 a[16:19], v3, s[40:43], s35 offen sc1
    s_add_u32 s35, s35, 4096
    s_and_b32 s35, s35, 0x1ffff
    v_mfma_f32_16x16x32_bf16 v[216:219], a[120:123], a[32:35], v[216:219]
    ds_read_b128 a[104:107], v6 offset:12288
    v_mfma_f32_16x16x32_bf16 v[148:151], a[124:127], a[20:23], v[148:151]
    v_mfma_f32_16x16x32_bf16 v[172:175], a[124:127], a[24:27], v[172:175]
    v_mfma_f32_16x16x32_bf16 v[196:199], a[124:127], a[28:31], v[196:199]
    buffer_load_dwordx4 v1, s[4:7], s44 offen offset:3072 sc1 lds
    v_mfma_f32_16x16x32_bf16 v[220:223], a[124:127], a[32:35], v[220:223]
    v_mfma_f32_16x16x32_bf16 v[152:155], a[128:131], a[20:23], v[152:155]
    v_mfma_f32_16x16x32_bf16 v[176:179], a[128:131], a[24:27], v[176:179]
    s_add_u32 s44, s44, 4096
    s_add_u32 m0, m0, 4096
    s_nop 0
    buffer_load_dwordx4 v1, s[4:7], s44 offen offset:0 sc1 lds
    v_mfma_f32_16x16x32_bf16 v[200:203], a[128:131], a[28:31], v[200:203]
    v_mfma_f32_16x16x32_bf16 v[224:227], a[128:131], a[32:35], v[224:227]
    v_mfma_f32_16x16x32_bf16 v[228:231], a[132:135], a[36:39], v[228:231]
    s_waitcnt vmcnt(15) lgkmcnt(0)
    v_mfma_f32_16x16x32_bf16 v[132:135], a[80:83], a[40:43], v[132:135]
    ds_read_b128 a[108:111], v5 offset:18432
    v_mfma_f32_16x16x32_bf16 v[156:159], a[80:83], a[44:47], v[156:159]
    buffer_load_dwordx4 a[20:23], v2, s[40:43], s35 offen offset:0 sc1
    v_mfma_f32_16x16x32_bf16 v[180:183], a[80:83], a[48:51], v[180:183]
    ds_read_b128 a[112:115], v5 offset:19456
    v_mfma_f32_16x16x32_bf16 v[204:207], a[80:83], a[52:55], v[204:207]
    v_mfma_f32_16x16x32_bf16 v[136:139], a[84:87], a[40:43], v[136:139]
    buffer_load_dwordx4 a[24:27], v2, s[40:43], s35 offen offset:1024 sc1
    v_mfma_f32_16x16x32_bf16 v[160:163], a[84:87], a[44:47], v[160:163]
    ds_read_b128 a[116:119], v5 offset:20480
    v_mfma_f32_16x16x32_bf16 v[184:187], a[84:87], a[48:51], v[184:187]
    v_mfma_f32_16x16x32_bf16 v[208:211], a[84:87], a[52:55], v[208:211]
    ds_read_b128 a[120:123], v5 offset:21504
    buffer_load_dwordx4 a[28:31], v2, s[40:43], s35 offen offset:2048 sc1
    v_mfma_f32_16x16x32_bf16 v[140:143], a[88:91], a[40:43], v[140:143]
    v_mfma_f32_16x16x32_bf16 v[164:167], a[88:91], a[44:47], v[164:167]
    v_mfma_f32_16x16x32_bf16 v[188:191], a[88:91], a[48:51], v[188:191]
    ds_read_b128 a[124:127], v5 offset:22528
    v_mfma_f32_16x16x32_bf16 v[212:215], a[88:91], a[52:55], v[212:215]
    buffer_load_dwordx4 a[32:35], v2, s[40:43], s35 offen offset:3072 sc1
    v_mfma_f32_16x16x32_bf16 v[144:147], a[92:95], a[40:43], v[144:147]
    ds_read_b128 a[128:131], v5 offset:23552
    v_mfma_f32_16x16x32_bf16 v[168:171], a[92:95], a[44:47], v[168:171]
    v_mfma_f32_16x16x32_bf16 v[192:195], a[92:95], a[48:51], v[192:195]
    buffer_load_dwordx4 a[36:39], v3, s[40:43], s35 offen sc1
    s_add_u32 s35, s35, 4096
    s_and_b32 s35, s35, 0x1ffff
    v_mfma_f32_16x16x32_bf16 v[216:219], a[92:95], a[52:55], v[216:219]
    ds_read_b128 a[132:135], v6 offset:18432
    v_mfma_f32_16x16x32_bf16 v[148:151], a[96:99], a[40:43], v[148:151]
    v_mfma_f32_16x16x32_bf16 v[172:175], a[96:99], a[44:47], v[172:175]
    v_mfma_f32_16x16x32_bf16 v[196:199], a[96:99], a[48:51], v[196:199]
    buffer_load_dwordx4 v1, s[4:7], s44 offen offset:1024 sc1 lds
    v_mfma_f32_16x16x32_bf16 v[220:223], a[96:99], a[52:55], v[220:223]
    v_mfma_f32_16x16x32_bf16 v[152:155], a[100:103], a[40:43], v[152:155]
    v_mfma_f32_16x16x32_bf16 v[176:179], a[100:103], a[44:47], v[176:179]
    buffer_load_dwordx4 v1, s[4:7], s44 offen offset:2048 sc1 lds
    v_mfma_f32_16x16x32_bf16 v[200:203], a[100:103], a[48:51], v[200:203]
    v_mfma_f32_16x16x32_bf16 v[224:227], a[100:103], a[52:55], v[224:227]
    v_mfma_f32_16x16x32_bf16 v[228:231], a[104:107], a[56:59], v[228:231]
    s_waitcnt vmcnt(15) lgkmcnt(0)
    v_mfma_f32_16x16x32_bf16 v[132:135], a[108:111], a[60:63], v[132:135]
    ds_read_b128 a[80:83], v5 offset:24576
    v_mfma_f32_16x16x32_bf16 v[156:159], a[108:111], a[64:67], v[156:159]
    buffer_load_dwordx4 a[40:43], v2, s[40:43], s35 offen offset:0 sc1
    v_mfma_f32_16x16x32_bf16 v[180:183], a[108:111], a[68:71], v[180:183]
    ds_read_b128 a[84:87], v5 offset:25600
    v_mfma_f32_16x16x32_bf16 v[204:207], a[108:111], a[72:75], v[204:207]
    v_mfma_f32_16x16x32_bf16 v[136:139], a[112:115], a[60:63], v[136:139]
    v_mfma_f32_16x16x32_bf16 v[160:163], a[112:115], a[64:67], v[160:163]
    ds_read_b128 a[88:91], v5 offset:26624
    buffer_load_dwordx4 a[44:47], v2, s[40:43], s35 offen offset:1024 sc1
    v_mfma_f32_16x16x32_bf16 v[184:187], a[112:115], a[68:71], v[184:187]
    v_mfma_f32_16x16x32_bf16 v[208:211], a[112:115], a[72:75], v[208:211]
    ds_read_b128 a[92:95], v5 offset:27648
    v_mfma_f32_16x16x32_bf16 v[140:143], a[116:119], a[60:63], v[140:143]
    v_mfma_f32_16x16x32_bf16 v[164:167], a[116:119], a[64:67], v[164:167]
    buffer_load_dwordx4 a[48:51], v2, s[40:43], s35 offen offset:2048 sc1
    v_mfma_f32_16x16x32_bf16 v[188:191], a[116:119], a[68:71], v[188:191]
    ds_read_b128 a[96:99], v5 offset:28672
    v_mfma_f32_16x16x32_bf16 v[212:215], a[116:119], a[72:75], v[212:215]
    v_mfma_f32_16x16x32_bf16 v[144:147], a[120:123], a[60:63], v[144:147]
    ds_read_b128 a[100:103], v5 offset:29696
    v_mfma_f32_16x16x32_bf16 v[168:171], a[120:123], a[64:67], v[168:171]
    buffer_load_dwordx4 a[52:55], v2, s[40:43], s35 offen offset:3072 sc1
    v_mfma_f32_16x16x32_bf16 v[192:195], a[120:123], a[68:71], v[192:195]
    v_mfma_f32_16x16x32_bf16 v[216:219], a[120:123], a[72:75], v[216:219]
    ds_read_b128 a[104:107], v6 offset:24576
    v_mfma_f32_16x16x32_bf16 v[148:151], a[124:127], a[60:63], v[148:151]
    v_mfma_f32_16x16x32_bf16 v[172:175], a[124:127], a[64:67], v[172:175]
    buffer_load_dwordx4 a[56:59], v3, s[40:43], s35 offen sc1
    s_add_u32 s35, s35, 4096
    s_and_b32 s35, s35, 0x1ffff
    v_mfma_f32_16x16x32_bf16 v[196:199], a[124:127], a[68:71], v[196:199]
    v_mfma_f32_16x16x32_bf16 v[220:223], a[124:127], a[72:75], v[220:223]
    v_mfma_f32_16x16x32_bf16 v[152:155], a[128:131], a[60:63], v[152:155]
    v_mfma_f32_16x16x32_bf16 v[176:179], a[128:131], a[64:67], v[176:179]
    buffer_load_dwordx4 v1, s[4:7], s44 offen offset:3072 sc1 lds
    v_mfma_f32_16x16x32_bf16 v[200:203], a[128:131], a[68:71], v[200:203]
    v_mfma_f32_16x16x32_bf16 v[224:227], a[128:131], a[72:75], v[224:227]
    v_mfma_f32_16x16x32_bf16 v[228:231], a[132:135], a[76:79], v[228:231]
    s_waitcnt vmcnt(15) lgkmcnt(0)
    v_mfma_f32_16x16x32_bf16 v[132:135], a[80:83], a[0:3], v[132:135]
    ds_read_b128 a[108:111], v5 offset:30720
    v_mfma_f32_16x16x32_bf16 v[156:159], a[80:83], a[4:7], v[156:159]
    buffer_load_dwordx4 a[60:63], v2, s[40:43], s35 offen offset:0 sc1
    v_mfma_f32_16x16x32_bf16 v[180:183], a[80:83], a[8:11], v[180:183]
    ds_read_b128 a[112:115], v5 offset:31744
    v_mfma_f32_16x16x32_bf16 v[204:207], a[80:83], a[12:15], v[204:207]
    buffer_load_dwordx4 a[64:67], v2, s[40:43], s35 offen offset:1024 sc1
    v_mfma_f32_16x16x32_bf16 v[136:139], a[84:87], a[0:3], v[136:139]
    v_mfma_f32_16x16x32_bf16 v[160:163], a[84:87], a[4:7], v[160:163]
    ds_read_b128 a[116:119], v5 offset:32768
    v_mfma_f32_16x16x32_bf16 v[184:187], a[84:87], a[8:11], v[184:187]
    buffer_load_dwordx4 a[68:71], v2, s[40:43], s35 offen offset:2048 sc1
    v_mfma_f32_16x16x32_bf16 v[208:211], a[84:87], a[12:15], v[208:211]
    ds_read_b128 a[120:123], v5 offset:33792
    v_mfma_f32_16x16x32_bf16 v[140:143], a[88:91], a[0:3], v[140:143]
    v_mfma_f32_16x16x32_bf16 v[164:167], a[88:91], a[4:7], v[164:167]
    buffer_load_dwordx4 a[72:75], v2, s[40:43], s35 offen offset:3072 sc1
    v_mfma_f32_16x16x32_bf16 v[188:191], a[88:91], a[8:11], v[188:191]
    ds_read_b128 a[124:127], v5 offset:34816
    v_mfma_f32_16x16x32_bf16 v[212:215], a[88:91], a[12:15], v[212:215]
    buffer_load_dwordx4 a[76:79], v3, s[40:43], s35 offen sc1
    s_add_u32 s35, s35, 4096
    s_and_b32 s35, s35, 0x1ffff
    v_mfma_f32_16x16x32_bf16 v[144:147], a[92:95], a[0:3], v[144:147]
    ds_read_b128 a[128:131], v5 offset:35840
    v_mfma_f32_16x16x32_bf16 v[168:171], a[92:95], a[4:7], v[168:171]
    v_mfma_f32_16x16x32_bf16 v[192:195], a[92:95], a[8:11], v[192:195]
    s_mov_b32 s36, 0x200000
    s_mov_b32 s37, 0x201000
    buffer_load_dwordx2 v[92:93], v14, s[4:7], s36 offen offset:0 sc1
    v_mfma_f32_16x16x32_bf16 v[216:219], a[92:95], a[12:15], v[216:219]
    ds_read_b128 a[132:135], v6 offset:30720
    v_mfma_f32_16x16x32_bf16 v[148:151], a[96:99], a[0:3], v[148:151]
    v_mfma_f32_16x16x32_bf16 v[172:175], a[96:99], a[4:7], v[172:175]
    buffer_load_dwordx2 v[94:95], v14, s[4:7], s36 offen offset:128 sc1
    v_mfma_f32_16x16x32_bf16 v[196:199], a[96:99], a[8:11], v[196:199]
    v_mfma_f32_16x16x32_bf16 v[220:223], a[96:99], a[12:15], v[220:223]
    buffer_load_dwordx2 v[96:97], v14, s[4:7], s36 offen offset:256 sc1
    v_mfma_f32_16x16x32_bf16 v[152:155], a[100:103], a[0:3], v[152:155]
    v_mfma_f32_16x16x32_bf16 v[176:179], a[100:103], a[4:7], v[176:179]
    v_mfma_f32_16x16x32_bf16 v[200:203], a[100:103], a[8:11], v[200:203]
    buffer_load_dwordx2 v[98:99], v14, s[4:7], s36 offen offset:384 sc1
    v_mfma_f32_16x16x32_bf16 v[224:227], a[100:103], a[12:15], v[224:227]
    v_mfma_f32_16x16x32_bf16 v[228:231], a[104:107], a[16:19], v[228:231]
    s_waitcnt vmcnt(17) lgkmcnt(0)
    v_mfma_f32_16x16x32_bf16 v[132:135], a[108:111], a[20:23], v[132:135]
    ds_read_b128 a[80:83], v5 offset:36864
    v_mfma_f32_16x16x32_bf16 v[156:159], a[108:111], a[24:27], v[156:159]
    buffer_load_dwordx4 a[0:3], v2, s[40:43], s35 offen offset:0 sc1
    v_mfma_f32_16x16x32_bf16 v[180:183], a[108:111], a[28:31], v[180:183]
    ds_read_b128 a[84:87], v5 offset:37888
    v_mfma_f32_16x16x32_bf16 v[204:207], a[108:111], a[32:35], v[204:207]
    v_mfma_f32_16x16x32_bf16 v[136:139], a[112:115], a[20:23], v[136:139]
    buffer_load_dwordx4 a[4:7], v2, s[40:43], s35 offen offset:1024 sc1
    v_mfma_f32_16x16x32_bf16 v[160:163], a[112:115], a[24:27], v[160:163]
    ds_read_b128 a[88:91], v5 offset:38912
    v_mfma_f32_16x16x32_bf16 v[184:187], a[112:115], a[28:31], v[184:187]
    v_mfma_f32_16x16x32_bf16 v[208:211], a[112:115], a[32:35], v[208:211]
    ds_read_b128 a[92:95], v5 offset:39936
    buffer_load_dwordx4 a[8:11], v2, s[40:43], s35 offen offset:2048 sc1
    v_mfma_f32_16x16x32_bf16 v[140:143], a[116:119], a[20:23], v[140:143]
    v_mfma_f32_16x16x32_bf16 v[164:167], a[116:119], a[24:27], v[164:167]
    v_mfma_f32_16x16x32_bf16 v[188:191], a[116:119], a[28:31], v[188:191]
    ds_read_b128 a[96:99], v5 offset:40960
    buffer_load_dwordx4 a[12:15], v2, s[40:43], s35 offen offset:3072 sc1
    v_mfma_f32_16x16x32_bf16 v[212:215], a[116:119], a[32:35], v[212:215]
    v_mfma_f32_16x16x32_bf16 v[144:147], a[120:123], a[20:23], v[144:147]
    ds_read_b128 a[100:103], v5 offset:41984
    v_mfma_f32_16x16x32_bf16 v[168:171], a[120:123], a[24:27], v[168:171]
    buffer_load_dwordx4 a[16:19], v3, s[40:43], s35 offen sc1
    s_add_u32 s35, s35, 4096
    s_and_b32 s35, s35, 0x1ffff
    v_mfma_f32_16x16x32_bf16 v[192:195], a[120:123], a[28:31], v[192:195]
    v_mfma_f32_16x16x32_bf16 v[216:219], a[120:123], a[32:35], v[216:219]
    ds_read_b128 a[104:107], v6 offset:36864
    v_mfma_f32_16x16x32_bf16 v[148:151], a[124:127], a[20:23], v[148:151]
    buffer_load_dwordx2 v[100:101], v14, s[4:7], s36 offen offset:2048 sc1
    v_mfma_f32_16x16x32_bf16 v[172:175], a[124:127], a[24:27], v[172:175]
    v_mfma_f32_16x16x32_bf16 v[196:199], a[124:127], a[28:31], v[196:199]
    v_mfma_f32_16x16x32_bf16 v[220:223], a[124:127], a[32:35], v[220:223]
    buffer_load_dwordx2 v[102:103], v14, s[4:7], s36 offen offset:2176 sc1
    v_mfma_f32_16x16x32_bf16 v[152:155], a[128:131], a[20:23], v[152:155]
    v_mfma_f32_16x16x32_bf16 v[176:179], a[128:131], a[24:27], v[176:179]
    v_mfma_f32_16x16x32_bf16 v[200:203], a[128:131], a[28:31], v[200:203]
    buffer_load_dwordx2 v[104:105], v14, s[4:7], s36 offen offset:2304 sc1
    v_mfma_f32_16x16x32_bf16 v[224:227], a[128:131], a[32:35], v[224:227]
    v_mfma_f32_16x16x32_bf16 v[228:231], a[132:135], a[36:39], v[228:231]
    s_waitcnt vmcnt(18) lgkmcnt(0)
    v_mfma_f32_16x16x32_bf16 v[132:135], a[80:83], a[40:43], v[132:135]
    ds_read_b128 a[108:111], v5 offset:43008
    v_mfma_f32_16x16x32_bf16 v[156:159], a[80:83], a[44:47], v[156:159]
    buffer_load_dwordx4 a[20:23], v2, s[40:43], s35 offen offset:0 sc1
    v_mfma_f32_16x16x32_bf16 v[180:183], a[80:83], a[48:51], v[180:183]
    ds_read_b128 a[112:115], v5 offset:44032
    v_mfma_f32_16x16x32_bf16 v[204:207], a[80:83], a[52:55], v[204:207]
    v_mfma_f32_16x16x32_bf16 v[136:139], a[84:87], a[40:43], v[136:139]
    buffer_load_dwordx4 a[24:27], v2, s[40:43], s35 offen offset:1024 sc1
    v_mfma_f32_16x16x32_bf16 v[160:163], a[84:87], a[44:47], v[160:163]
    ds_read_b128 a[116:119], v5 offset:45056
    v_mfma_f32_16x16x32_bf16 v[184:187], a[84:87], a[48:51], v[184:187]
    v_mfma_f32_16x16x32_bf16 v[208:211], a[84:87], a[52:55], v[208:211]
    ds_read_b128 a[120:123], v5 offset:46080
    buffer_load_dwordx4 a[28:31], v2, s[40:43], s35 offen offset:2048 sc1
    v_mfma_f32_16x16x32_bf16 v[140:143], a[88:91], a[40:43], v[140:143]
    v_mfma_f32_16x16x32_bf16 v[164:167], a[88:91], a[44:47], v[164:167]
    v_mfma_f32_16x16x32_bf16 v[188:191], a[88:91], a[48:51], v[188:191]
    ds_read_b128 a[124:127], v5 offset:47104
    buffer_load_dwordx4 a[32:35], v2, s[40:43], s35 offen offset:3072 sc1
    v_mfma_f32_16x16x32_bf16 v[212:215], a[88:91], a[52:55], v[212:215]
    v_mfma_f32_16x16x32_bf16 v[144:147], a[92:95], a[40:43], v[144:147]
    ds_read_b128 a[128:131], v5 offset:48128
    v_mfma_f32_16x16x32_bf16 v[168:171], a[92:95], a[44:47], v[168:171]
    buffer_load_dwordx4 a[36:39], v3, s[40:43], s35 offen sc1
    s_add_u32 s35, s35, 4096
    s_and_b32 s35, s35, 0x1ffff
    v_mfma_f32_16x16x32_bf16 v[192:195], a[92:95], a[48:51], v[192:195]
    v_mfma_f32_16x16x32_bf16 v[216:219], a[92:95], a[52:55], v[216:219]
    ds_read_b128 a[132:135], v6 offset:43008
    v_mfma_f32_16x16x32_bf16 v[148:151], a[96:99], a[40:43], v[148:151]
    buffer_load_dwordx2 v[106:107], v14, s[4:7], s36 offen offset:2432 sc1
    v_mfma_f32_16x16x32_bf16 v[172:175], a[96:99], a[44:47], v[172:175]
    v_mfma_f32_16x16x32_bf16 v[196:199], a[96:99], a[48:51], v[196:199]
    v_mfma_f32_16x16x32_bf16 v[220:223], a[96:99], a[52:55], v[220:223]
    buffer_load_dwordx2 v[108:109], v14, s[4:7], s37 offen offset:0 sc1
    v_mfma_f32_16x16x32_bf16 v[152:155], a[100:103], a[40:43], v[152:155]
    v_mfma_f32_16x16x32_bf16 v[176:179], a[100:103], a[44:47], v[176:179]
    v_mfma_f32_16x16x32_bf16 v[200:203], a[100:103], a[48:51], v[200:203]
    buffer_load_dwordx2 v[110:111], v14, s[4:7], s37 offen offset:128 sc1
    v_mfma_f32_16x16x32_bf16 v[224:227], a[100:103], a[52:55], v[224:227]
    v_mfma_f32_16x16x32_bf16 v[228:231], a[104:107], a[56:59], v[228:231]
    s_waitcnt vmcnt(20) lgkmcnt(0)
    s_barrier
    v_mfma_f32_16x16x32_bf16 v[132:135], a[108:111], a[60:63], v[132:135]
    v_add_u32 v5, 0, v1
    ds_read_b128 a[80:83], v5 offset:0
    v_mfma_f32_16x16x32_bf16 v[156:159], a[108:111], a[64:67], v[156:159]
    buffer_load_dwordx4 a[40:43], v2, s[40:43], s35 offen offset:0 sc1
    v_mfma_f32_16x16x32_bf16 v[180:183], a[108:111], a[68:71], v[180:183]
    v_add_u32 v6, s39, v5
    ds_read_b128 a[84:87], v5 offset:1024
    v_mfma_f32_16x16x32_bf16 v[204:207], a[108:111], a[72:75], v[204:207]
    v_mfma_f32_16x16x32_bf16 v[136:139], a[112:115], a[60:63], v[136:139]
    buffer_load_dwordx4 a[44:47], v2, s[40:43], s35 offen offset:1024 sc1
    v_mfma_f32_16x16x32_bf16 v[160:163], a[112:115], a[64:67], v[160:163]
    ds_read_b128 a[88:91], v5 offset:2048
    v_mfma_f32_16x16x32_bf16 v[184:187], a[112:115], a[68:71], v[184:187]
    v_mfma_f32_16x16x32_bf16 v[208:211], a[112:115], a[72:75], v[208:211]
    ds_read_b128 a[92:95], v5 offset:3072
    buffer_load_dwordx4 a[48:51], v2, s[40:43], s35 offen offset:2048 sc1
    v_mfma_f32_16x16x32_bf16 v[140:143], a[116:119], a[60:63], v[140:143]
    v_mfma_f32_16x16x32_bf16 v[164:167], a[116:119], a[64:67], v[164:167]
    v_mfma_f32_16x16x32_bf16 v[188:191], a[116:119], a[68:71], v[188:191]
    ds_read_b128 a[96:99], v5 offset:4096
    buffer_load_dwordx4 a[52:55], v2, s[40:43], s35 offen offset:3072 sc1
    v_mfma_f32_16x16x32_bf16 v[212:215], a[116:119], a[72:75], v[212:215]
    v_mfma_f32_16x16x32_bf16 v[144:147], a[120:123], a[60:63], v[144:147]
    ds_read_b128 a[100:103], v5 offset:5120
    v_mfma_f32_16x16x32_bf16 v[168:171], a[120:123], a[64:67], v[168:171]
    buffer_load_dwordx4 a[56:59], v3, s[40:43], s35 offen sc1
    s_add_u32 s35, s35, 4096
    s_and_b32 s35, s35, 0x1ffff
    v_mfma_f32_16x16x32_bf16 v[192:195], a[120:123], a[68:71], v[192:195]
    v_mfma_f32_16x16x32_bf16 v[216:219], a[120:123], a[72:75], v[216:219]
    ds_read_b128 a[104:107], v6 offset:0
    v_mfma_f32_16x16x32_bf16 v[148:151], a[124:127], a[60:63], v[148:151]
    buffer_load_dwordx2 v[112:113], v14, s[4:7], s37 offen offset:256 sc1
    v_mfma_f32_16x16x32_bf16 v[172:175], a[124:127], a[64:67], v[172:175]
    v_mfma_f32_16x16x32_bf16 v[196:199], a[124:127], a[68:71], v[196:199]
    v_mfma_f32_16x16x32_bf16 v[220:223], a[124:127], a[72:75], v[220:223]
    buffer_load_dwordx2 v[114:115], v14, s[4:7], s37 offen offset:384 sc1
    v_mfma_f32_16x16x32_bf16 v[152:155], a[128:131], a[60:63], v[152:155]
    v_mfma_f32_16x16x32_bf16 v[176:179], a[128:131], a[64:67], v[176:179]
    v_mfma_f32_16x16x32_bf16 v[200:203], a[128:131], a[68:71], v[200:203]
    buffer_load_dwordx2 v[116:117], v14, s[4:7], s37 offen offset:2048 sc1
    v_mfma_f32_16x16x32_bf16 v[224:227], a[128:131], a[72:75], v[224:227]
    v_mfma_f32_16x16x32_bf16 v[228:231], a[132:135], a[76:79], v[228:231]
    s_waitcnt vmcnt(19) lgkmcnt(0)
    v_mfma_f32_16x16x32_bf16 v[132:135], a[80:83], a[0:3], v[132:135]
    ds_read_b128 a[108:111], v5 offset:6144
    v_mfma_f32_16x16x32_bf16 v[156:159], a[80:83], a[4:7], v[156:159]
    buffer_load_dwordx4 a[60:63], v2, s[40:43], s35 offen offset:0 sc1
    v_mfma_f32_16x16x32_bf16 v[180:183], a[80:83], a[8:11], v[180:183]
    ds_read_b128 a[112:115], v5 offset:7168
    v_mfma_f32_16x16x32_bf16 v[204:207], a[80:83], a[12:15], v[204:207]
    v_mfma_f32_16x16x32_bf16 v[136:139], a[84:87], a[0:3], v[136:139]
    buffer_load_dwordx4 a[64:67], v2, s[40:43], s35 offen offset:1024 sc1
    v_mfma_f32_16x16x32_bf16 v[160:163], a[84:87], a[4:7], v[160:163]
    ds_read_b128 a[116:119], v5 offset:8192
    v_mfma_f32_16x16x32_bf16 v[184:187], a[84:87], a[8:11], v[184:187]
    v_mfma_f32_16x16x32_bf16 v[208:211], a[84:87], a[12:15], v[208:211]
    ds_read_b128 a[120:123], v5 offset:9216
    buffer_load_dwordx4 a[68:71], v2, s[40:43], s35 offen offset:2048 sc1
    v_mfma_f32_16x16x32_bf16 v[140:143], a[88:91], a[0:3], v[140:143]
    v_mfma_f32_16x16x32_bf16 v[164:167], a[88:91], a[4:7], v[164:167]
    v_mfma_f32_16x16x32_bf16 v[188:191], a[88:91], a[8:11], v[188:191]
    ds_read_b128 a[124:127], v5 offset:10240
    buffer_load_dwordx4 a[72:75], v2, s[40:43], s35 offen offset:3072 sc1
    v_mfma_f32_16x16x32_bf16 v[212:215], a[88:91], a[12:15], v[212:215]
    v_mfma_f32_16x16x32_bf16 v[144:147], a[92:95], a[0:3], v[144:147]
    ds_read_b128 a[128:131], v5 offset:11264
    v_mfma_f32_16x16x32_bf16 v[168:171], a[92:95], a[4:7], v[168:171]
    buffer_load_dwordx4 a[76:79], v3, s[40:43], s35 offen sc1
    s_add_u32 s35, s35, 4096
    s_and_b32 s35, s35, 0x1ffff
    v_mfma_f32_16x16x32_bf16 v[192:195], a[92:95], a[8:11], v[192:195]
    v_mfma_f32_16x16x32_bf16 v[216:219], a[92:95], a[12:15], v[216:219]
    ds_read_b128 a[132:135], v6 offset:6144
    v_mfma_f32_16x16x32_bf16 v[148:151], a[96:99], a[0:3], v[148:151]
    buffer_load_dwordx2 v[118:119], v14, s[4:7], s37 offen offset:2176 sc1
    v_mfma_f32_16x16x32_bf16 v[172:175], a[96:99], a[4:7], v[172:175]
    v_mfma_f32_16x16x32_bf16 v[196:199], a[96:99], a[8:11], v[196:199]
    v_mfma_f32_16x16x32_bf16 v[220:223], a[96:99], a[12:15], v[220:223]
    buffer_load_dwordx2 v[120:121], v14, s[4:7], s37 offen offset:2304 sc1
    v_mfma_f32_16x16x32_bf16 v[152:155], a[100:103], a[0:3], v[152:155]
    v_mfma_f32_16x16x32_bf16 v[176:179], a[100:103], a[4:7], v[176:179]
    v_mfma_f32_16x16x32_bf16 v[200:203], a[100:103], a[8:11], v[200:203]
    buffer_load_dwordx2 v[122:123], v14, s[4:7], s37 offen offset:2432 sc1
    v_mfma_f32_16x16x32_bf16 v[224:227], a[100:103], a[12:15], v[224:227]
    v_mfma_f32_16x16x32_bf16 v[228:231], a[104:107], a[16:19], v[228:231]
    s_waitcnt vmcnt(19) lgkmcnt(0)
    v_mfma_f32_16x16x32_bf16 v[132:135], a[108:111], a[20:23], v[132:135]
    ds_read_b128 a[80:83], v5 offset:12288
    v_mfma_f32_16x16x32_bf16 v[156:159], a[108:111], a[24:27], v[156:159]
    buffer_load_dwordx4 a[0:3], v2, s[40:43], s35 offen offset:0 sc1
    v_mfma_f32_16x16x32_bf16 v[180:183], a[108:111], a[28:31], v[180:183]
    ds_read_b128 a[84:87], v5 offset:13312
    v_mfma_f32_16x16x32_bf16 v[204:207], a[108:111], a[32:35], v[204:207]
    v_mfma_f32_16x16x32_bf16 v[136:139], a[112:115], a[20:23], v[136:139]
    buffer_load_dwordx4 a[4:7], v2, s[40:43], s35 offen offset:1024 sc1
    v_mfma_f32_16x16x32_bf16 v[160:163], a[112:115], a[24:27], v[160:163]
    ds_read_b128 a[88:91], v5 offset:14336
    v_mfma_f32_16x16x32_bf16 v[184:187], a[112:115], a[28:31], v[184:187]
    v_mfma_f32_16x16x32_bf16 v[208:211], a[112:115], a[32:35], v[208:211]
    ds_read_b128 a[92:95], v5 offset:15360
    buffer_load_dwordx4 a[8:11], v2, s[40:43], s35 offen offset:2048 sc1
    v_mfma_f32_16x16x32_bf16 v[140:143], a[116:119], a[20:23], v[140:143]
    v_mfma_f32_16x16x32_bf16 v[164:167], a[116:119], a[24:27], v[164:167]
    v_mfma_f32_16x16x32_bf16 v[188:191], a[116:119], a[28:31], v[188:191]
    ds_read_b128 a[96:99], v5 offset:16384
    buffer_load_dwordx4 a[12:15], v2, s[40:43], s35 offen offset:3072 sc1
    v_mfma_f32_16x16x32_bf16 v[212:215], a[116:119], a[32:35], v[212:215]
    v_mfma_f32_16x16x32_bf16 v[144:147], a[120:123], a[20:23], v[144:147]
    ds_read_b128 a[100:103], v5 offset:17408
    v_mfma_f32_16x16x32_bf16 v[168:171], a[120:123], a[24:27], v[168:171]
    buffer_load_dwordx4 a[16:19], v3, s[40:43], s35 offen sc1
    s_add_u32 s35, s35, 4096
    s_and_b32 s35, s35, 0x1ffff
    v_mfma_f32_16x16x32_bf16 v[192:195], a[120:123], a[28:31], v[192:195]
    v_mfma_f32_16x16x32_bf16 v[216:219], a[120:123], a[32:35], v[216:219]
    ds_read_b128 a[104:107], v6 offset:12288
    v_mfma_f32_16x16x32_bf16 v[148:151], a[124:127], a[20:23], v[148:151]
    buffer_load_dwordx2 v[124:125], v15, s[4:7], s36 offen offset:0 sc1
    v_mfma_f32_16x16x32_bf16 v[172:175], a[124:127], a[24:27], v[172:175]
    v_mfma_f32_16x16x32_bf16 v[196:199], a[124:127], a[28:31], v[196:199]
    v_mfma_f32_16x16x32_bf16 v[220:223], a[124:127], a[32:35], v[220:223]
    buffer_load_dwordx2 v[126:127], v15, s[4:7], s36 offen offset:128 sc1
    v_mfma_f32_16x16x32_bf16 v[152:155], a[128:131], a[20:23], v[152:155]
    v_mfma_f32_16x16x32_bf16 v[176:179], a[128:131], a[24:27], v[176:179]
    v_mfma_f32_16x16x32_bf16 v[200:203], a[128:131], a[28:31], v[200:203]
    buffer_load_dwordx2 v[128:129], v15, s[4:7], s36 offen offset:256 sc1
    v_mfma_f32_16x16x32_bf16 v[224:227], a[128:131], a[32:35], v[224:227]
    v_mfma_f32_16x16x32_bf16 v[228:231], a[132:135], a[36:39], v[228:231]
    s_waitcnt vmcnt(19) lgkmcnt(0)
    v_mfma_f32_16x16x32_bf16 v[132:135], a[80:83], a[40:43], v[132:135]
    ds_read_b128 a[108:111], v5 offset:18432
    v_mfma_f32_16x16x32_bf16 v[156:159], a[80:83], a[44:47], v[156:159]
    buffer_load_dwordx4 a[20:23], v2, s[40:43], s35 offen offset:0 sc1
    v_mfma_f32_16x16x32_bf16 v[180:183], a[80:83], a[48:51], v[180:183]
    ds_read_b128 a[112:115], v5 offset:19456
    v_mfma_f32_16x16x32_bf16 v[204:207], a[80:83], a[52:55], v[204:207]
    v_mfma_f32_16x16x32_bf16 v[136:139], a[84:87], a[40:43], v[136:139]
    buffer_load_dwordx4 a[24:27], v2, s[40:43], s35 offen offset:1024 sc1
    v_mfma_f32_16x16x32_bf16 v[160:163], a[84:87], a[44:47], v[160:163]
    ds_read_b128 a[116:119], v5 offset:20480
    v_mfma_f32_16x16x32_bf16 v[184:187], a[84:87], a[48:51], v[184:187]
    v_mfma_f32_16x16x32_bf16 v[208:211], a[84:87], a[52:55], v[208:211]
    ds_read_b128 a[120:123], v5 offset:21504
    buffer_load_dwordx4 a[28:31], v2, s[40:43], s35 offen offset:2048 sc1
    v_mfma_f32_16x16x32_bf16 v[140:143], a[88:91], a[40:43], v[140:143]
    v_mfma_f32_16x16x32_bf16 v[164:167], a[88:91], a[44:47], v[164:167]
    v_mfma_f32_16x16x32_bf16 v[188:191], a[88:91], a[48:51], v[188:191]
    ds_read_b128 a[124:127], v5 offset:22528
    buffer_load_dwordx4 a[32:35], v2, s[40:43], s35 offen offset:3072 sc1
    v_mfma_f32_16x16x32_bf16 v[212:215], a[88:91], a[52:55], v[212:215]
    v_mfma_f32_16x16x32_bf16 v[144:147], a[92:95], a[40:43], v[144:147]
    ds_read_b128 a[128:131], v5 offset:23552
    v_mfma_f32_16x16x32_bf16 v[168:171], a[92:95], a[44:47], v[168:171]
    buffer_load_dwordx4 a[36:39], v3, s[40:43], s35 offen sc1
    s_add_u32 s35, s35, 4096
    s_and_b32 s35, s35, 0x1ffff
    v_mfma_f32_16x16x32_bf16 v[192:195], a[92:95], a[48:51], v[192:195]
    v_mfma_f32_16x16x32_bf16 v[216:219], a[92:95], a[52:55], v[216:219]
    ds_read_b128 a[132:135], v6 offset:18432
    v_mfma_f32_16x16x32_bf16 v[148:151], a[96:99], a[40:43], v[148:151]
    buffer_load_dwordx2 v[130:131], v15, s[4:7], s36 offen offset:384 sc1
    v_mfma_f32_16x16x32_bf16 v[172:175], a[96:99], a[44:47], v[172:175]
    v_mfma_f32_16x16x32_bf16 v[196:199], a[96:99], a[48:51], v[196:199]
    v_mfma_f32_16x16x32_bf16 v[220:223], a[96:99], a[52:55], v[220:223]
    s_mul_i32 s38, s30, 12288
    s_add_u32 s38, s38, 0x300000
    buffer_load_dwordx4 v[48:51], v232, s[4:7], s38 offen sc1
    v_mfma_f32_16x16x32_bf16 v[152:155], a[100:103], a[40:43], v[152:155]
    v_mfma_f32_16x16x32_bf16 v[176:179], a[100:103], a[44:47], v[176:179]
    v_mfma_f32_16x16x32_bf16 v[200:203], a[100:103], a[48:51], v[200:203]
    s_add_u32 s38, s38, 2048
    buffer_load_dwordx4 v[52:55], v232, s[4:7], s38 offen sc1
    v_mfma_f32_16x16x32_bf16 v[224:227], a[100:103], a[52:55], v[224:227]
    v_mfma_f32_16x16x32_bf16 v[228:231], a[104:107], a[56:59], v[228:231]
    s_waitcnt vmcnt(19) lgkmcnt(0)
    v_mfma_f32_16x16x32_bf16 v[132:135], a[108:111], a[60:63], v[132:135]
    ds_read_b128 a[80:83], v5 offset:24576
    v_mfma_f32_16x16x32_bf16 v[156:159], a[108:111], a[64:67], v[156:159]
    buffer_load_dwordx4 a[40:43], v2, s[40:43], s35 offen offset:0 sc1
    v_mfma_f32_16x16x32_bf16 v[180:183], a[108:111], a[68:71], v[180:183]
    ds_read_b128 a[84:87], v5 offset:25600
    v_mfma_f32_16x16x32_bf16 v[204:207], a[108:111], a[72:75], v[204:207]
    v_mfma_f32_16x16x32_bf16 v[136:139], a[112:115], a[60:63], v[136:139]
    buffer_load_dwordx4 a[44:47], v2, s[40:43], s35 offen offset:1024 sc1
    v_mfma_f32_16x16x32_bf16 v[160:163], a[112:115], a[64:67], v[160:163]
    ds_read_b128 a[88:91], v5 offset:26624
    v_mfma_f32_16x16x32_bf16 v[184:187], a[112:115], a[68:71], v[184:187]
    v_mfma_f32_16x16x32_bf16 v[208:211], a[112:115], a[72:75], v[208:211]
    ds_read_b128 a[92:95], v5 offset:27648
    buffer_load_dwordx4 a[48:51], v2, s[40:43], s35 offen offset:2048 sc1
    v_mfma_f32_16x16x32_bf16 v[140:143], a[116:119], a[60:63], v[140:143]
    v_mfma_f32_16x16x32_bf16 v[164:167], a[116:119], a[64:67], v[164:167]
    v_mfma_f32_16x16x32_bf16 v[188:191], a[116:119], a[68:71], v[188:191]
    ds_read_b128 a[96:99], v5 offset:28672
    buffer_load_dwordx4 a[52:55], v2, s[40:43], s35 offen offset:3072 sc1
    v_mfma_f32_16x16x32_bf16 v[212:215], a[116:119], a[72:75], v[212:215]
    v_mfma_f32_16x16x32_bf16 v[144:147], a[120:123], a[60:63], v[144:147]
    ds_read_b128 a[100:103], v5 offset:29696
    v_mfma_f32_16x16x32_bf16 v[168:171], a[120:123], a[64:67], v[168:171]
    buffer_load_dwordx4 a[56:59], v3, s[40:43], s35 offen sc1
    s_add_u32 s35, s35, 4096
    s_and_b32 s35, s35, 0x1ffff
    v_mfma_f32_16x16x32_bf16 v[192:195], a[120:123], a[68:71], v[192:195]
    v_mfma_f32_16x16x32_bf16 v[216:219], a[120:123], a[72:75], v[216:219]
    ds_read_b128 a[104:107], v6 offset:24576
    v_mfma_f32_16x16x32_bf16 v[148:151], a[124:127], a[60:63], v[148:151]
    s_add_u32 s38, s38, 2048
    buffer_load_dwordx4 v[56:59], v232, s[4:7], s38 offen sc1
    v_mfma_f32_16x16x32_bf16 v[172:175], a[124:127], a[64:67], v[172:175]
    v_mfma_f32_16x16x32_bf16 v[196:199], a[124:127], a[68:71], v[196:199]
    v_mfma_f32_16x16x32_bf16 v[220:223], a[124:127], a[72:75], v[220:223]
    s_add_u32 s38, s38, 2048
    buffer_load_dwordx4 v[60:63], v232, s[4:7], s38 offen sc1
    v_mfma_f32_16x16x32_bf16 v[152:155], a[128:131], a[60:63], v[152:155]
    v_mfma_f32_16x16x32_bf16 v[176:179], a[128:131], a[64:67], v[176:179]
    v_mfma_f32_16x16x32_bf16 v[200:203], a[128:131], a[68:71], v[200:203]
    s_add_u32 s38, s38, 2048
    buffer_load_dwordx4 v[64:67], v232, s[4:7], s38 offen sc1
    v_mfma_f32_16x16x32_bf16 v[224:227], a[128:131], a[72:75], v[224:227]
    v_mfma_f32_16x16x32_bf16 v[228:231], a[132:135], a[76:79], v[228:231]
    s_waitcnt vmcnt(19) lgkmcnt(0)
    v_mfma_f32_16x16x32_bf16 v[132:135], a[80:83], a[0:3], v[132:135]
    ds_read_b128 a[108:111], v5 offset:30720
    v_mfma_f32_16x16x32_bf16 v[156:159], a[80:83], a[4:7], v[156:159]
    buffer_load_dwordx4 a[60:63], v2, s[40:43], s35 offen offset:0 sc1
    v_mfma_f32_16x16x32_bf16 v[180:183], a[80:83], a[8:11], v[180:183]
    ds_read_b128 a[112:115], v5 offset:31744
    v_mfma_f32_16x16x32_bf16 v[204:207], a[80:83], a[12:15], v[204:207]
    v_mfma_f32_16x16x32_bf16 v[136:139], a[84:87], a[0:3], v[136:139]
    buffer_load_dwordx4 a[64:67], v2, s[40:43], s35 offen offset:1024 sc1
    v_mfma_f32_16x16x32_bf16 v[160:163], a[84:87], a[4:7], v[160:163]
    ds_read_b128 a[116:119], v5 offset:32768
    v_mfma_f32_16x16x32_bf16 v[184:187], a[84:87], a[8:11], v[184:187]
    v_mfma_f32_16x16x32_bf16 v[208:211], a[84:87], a[12:15], v[208:211]
    ds_read_b128 a[120:123], v5 offset:33792
    buffer_load_dwordx4 a[68:71], v2, s[40:43], s35 offen offset:2048 sc1
    v_mfma_f32_16x16x32_bf16 v[140:143], a[88:91], a[0:3], v[140:143]
    v_mfma_f32_16x16x32_bf16 v[164:167], a[88:91], a[4:7], v[164:167]
    v_mfma_f32_16x16x32_bf16 v[188:191], a[88:91], a[8:11], v[188:191]
    ds_read_b128 a[124:127], v5 offset:34816
    buffer_load_dwordx4 a[72:75], v2, s[40:43], s35 offen offset:3072 sc1
    v_mfma_f32_16x16x32_bf16 v[212:215], a[88:91], a[12:15], v[212:215]
    v_mfma_f32_16x16x32_bf16 v[144:147], a[92:95], a[0:3], v[144:147]
    ds_read_b128 a[128:131], v5 offset:35840
    v_mfma_f32_16x16x32_bf16 v[168:171], a[92:95], a[4:7], v[168:171]
    buffer_load_dwordx4 a[76:79], v3, s[40:43], s35 offen sc1
    s_add_u32 s35, s35, 4096
    s_and_b32 s35, s35, 0x1ffff
    v_mfma_f32_16x16x32_bf16 v[192:195], a[92:95], a[8:11], v[192:195]
    v_mfma_f32_16x16x32_bf16 v[216:219], a[92:95], a[12:15], v[216:219]
    ds_read_b128 a[132:135], v6 offset:30720
    v_mfma_f32_16x16x32_bf16 v[148:151], a[96:99], a[0:3], v[148:151]
    s_add_u32 s38, s38, 2048
    buffer_load_dwordx4 v[68:71], v232, s[4:7], s38 offen sc1
    v_mfma_f32_16x16x32_bf16 v[172:175], a[96:99], a[4:7], v[172:175]
    v_mfma_f32_16x16x32_bf16 v[196:199], a[96:99], a[8:11], v[196:199]
    v_mfma_f32_16x16x32_bf16 v[220:223], a[96:99], a[12:15], v[220:223]
    s_lshl_b32 s45, s28, 11
    s_add_u32 s38, s38, s45
    s_sub_u32 s38, s38, 6144
    buffer_load_dwordx4 v[72:75], v232, s[4:7], s38 offen sc1
    v_mfma_f32_16x16x32_bf16 v[152:155], a[100:103], a[0:3], v[152:155]
    v_mfma_f32_16x16x32_bf16 v[176:179], a[100:103], a[4:7], v[176:179]
    v_mfma_f32_16x16x32_bf16 v[200:203], a[100:103], a[8:11], v[200:203]
    s_mov_b32 s38, 128
    buffer_load_dword v11, v10, s[16:19], s38 offen sc1
    v_mfma_f32_16x16x32_bf16 v[224:227], a[100:103], a[12:15], v[224:227]
    v_mfma_f32_16x16x32_bf16 v[228:231], a[104:107], a[16:19], v[228:231]
    s_waitcnt vmcnt(19) lgkmcnt(0)
    v_mfma_f32_16x16x32_bf16 v[132:135], a[108:111], a[20:23], v[132:135]
    ds_read_b128 a[80:83], v5 offset:36864
    v_mfma_f32_16x16x32_bf16 v[156:159], a[108:111], a[24:27], v[156:159]
    v_mfma_f32_16x16x32_bf16 v[180:183], a[108:111], a[28:31], v[180:183]
    ds_read_b128 a[84:87], v5 offset:37888
    v_mfma_f32_16x16x32_bf16 v[204:207], a[108:111], a[32:35], v[204:207]
    v_mfma_f32_16x16x32_bf16 v[136:139], a[112:115], a[20:23], v[136:139]
    v_mfma_f32_16x16x32_bf16 v[160:163], a[112:115], a[24:27], v[160:163]
    ds_read_b128 a[88:91], v5 offset:38912
    v_mfma_f32_16x16x32_bf16 v[184:187], a[112:115], a[28:31], v[184:187]
    v_mfma_f32_16x16x32_bf16 v[208:211], a[112:115], a[32:35], v[208:211]
    ds_read_b128 a[92:95], v5 offset:39936
    v_mfma_f32_16x16x32_bf16 v[140:143], a[116:119], a[20:23], v[140:143]
    v_mfma_f32_16x16x32_bf16 v[164:167], a[116:119], a[24:27], v[164:167]
    v_mfma_f32_16x16x32_bf16 v[188:191], a[116:119], a[28:31], v[188:191]
    ds_read_b128 a[96:99], v5 offset:40960
    v_mfma_f32_16x16x32_bf16 v[212:215], a[116:119], a[32:35], v[212:215]
    v_mfma_f32_16x16x32_bf16 v[144:147], a[120:123], a[20:23], v[144:147]
    ds_read_b128 a[100:103], v5 offset:41984
    v_mfma_f32_16x16x32_bf16 v[168:171], a[120:123], a[24:27], v[168:171]
    v_mfma_f32_16x16x32_bf16 v[192:195], a[120:123], a[28:31], v[192:195]
    v_mfma_f32_16x16x32_bf16 v[216:219], a[120:123], a[32:35], v[216:219]
    ds_read_b128 a[104:107], v6 offset:36864
    v_mfma_f32_16x16x32_bf16 v[148:151], a[124:127], a[20:23], v[148:151]
    v_mfma_f32_16x16x32_bf16 v[172:175], a[124:127], a[24:27], v[172:175]
    v_mfma_f32_16x16x32_bf16 v[196:199], a[124:127], a[28:31], v[196:199]
    v_mfma_f32_16x16x32_bf16 v[220:223], a[124:127], a[32:35], v[220:223]
    v_mfma_f32_16x16x32_bf16 v[152:155], a[128:131], a[20:23], v[152:155]
    v_mfma_f32_16x16x32_bf16 v[176:179], a[128:131], a[24:27], v[176:179]
    v_mfma_f32_16x16x32_bf16 v[200:203], a[128:131], a[28:31], v[200:203]
    v_mfma_f32_16x16x32_bf16 v[224:227], a[128:131], a[32:35], v[224:227]
    v_mfma_f32_16x16x32_bf16 v[228:231], a[132:135], a[36:39], v[228:231]
    s_waitcnt vmcnt(11) lgkmcnt(0)
    v_mfma_f32_16x16x32_bf16 v[132:135], a[80:83], a[40:43], v[132:135]
    ds_read_b128 a[108:111], v5 offset:43008
    v_mfma_f32_16x16x32_bf16 v[156:159], a[80:83], a[44:47], v[156:159]
    v_mfma_f32_16x16x32_bf16 v[180:183], a[80:83], a[48:51], v[180:183]
    ds_read_b128 a[112:115], v5 offset:44032
    v_mfma_f32_16x16x32_bf16 v[204:207], a[80:83], a[52:55], v[204:207]
    v_mfma_f32_16x16x32_bf16 v[136:139], a[84:87], a[40:43], v[136:139]
    v_mfma_f32_16x16x32_bf16 v[160:163], a[84:87], a[44:47], v[160:163]
    ds_read_b128 a[116:119], v5 offset:45056
    v_mfma_f32_16x16x32_bf16 v[184:187], a[84:87], a[48:51], v[184:187]
    v_mfma_f32_16x16x32_bf16 v[208:211], a[84:87], a[52:55], v[208:211]
    ds_read_b128 a[120:123], v5 offset:46080
    v_mfma_f32_16x16x32_bf16 v[140:143], a[88:91], a[40:43], v[140:143]
    v_mfma_f32_16x16x32_bf16 v[164:167], a[88:91], a[44:47], v[164:167]
    v_mfma_f32_16x16x32_bf16 v[188:191], a[88:91], a[48:51], v[188:191]
    ds_read_b128 a[124:127], v5 offset:47104
    v_mfma_f32_16x16x32_bf16 v[212:215], a[88:91], a[52:55], v[212:215]
    v_mfma_f32_16x16x32_bf16 v[144:147], a[92:95], a[40:43], v[144:147]
    ds_read_b128 a[128:131], v5 offset:48128
    v_mfma_f32_16x16x32_bf16 v[168:171], a[92:95], a[44:47], v[168:171]
    v_mfma_f32_16x16x32_bf16 v[192:195], a[92:95], a[48:51], v[192:195]
    v_mfma_f32_16x16x32_bf16 v[216:219], a[92:95], a[52:55], v[216:219]
    ds_read_b128 a[132:135], v6 offset:43008
    v_mfma_f32_16x16x32_bf16 v[148:151], a[96:99], a[40:43], v[148:151]
    v_mfma_f32_16x16x32_bf16 v[172:175], a[96:99], a[44:47], v[172:175]
    v_mfma_f32_16x16x32_bf16 v[196:199], a[96:99], a[48:51], v[196:199]
    v_mfma_f32_16x16x32_bf16 v[220:223], a[96:99], a[52:55], v[220:223]
    v_mfma_f32_16x16x32_bf16 v[152:155], a[100:103], a[40:43], v[152:155]
    v_mfma_f32_16x16x32_bf16 v[176:179], a[100:103], a[44:47], v[176:179]
    v_mfma_f32_16x16x32_bf16 v[200:203], a[100:103], a[48:51], v[200:203]
    v_mfma_f32_16x16x32_bf16 v[224:227], a[100:103], a[52:55], v[224:227]
    v_mfma_f32_16x16x32_bf16 v[228:231], a[104:107], a[56:59], v[228:231]
    s_waitcnt vmcnt(3) lgkmcnt(0)
    s_barrier
    v_mfma_f32_16x16x32_bf16 v[132:135], a[108:111], a[60:63], v[132:135]
    v_mfma_f32_16x16x32_bf16 v[156:159], a[108:111], a[64:67], v[156:159]
    v_mfma_f32_16x16x32_bf16 v[180:183], a[108:111], a[68:71], v[180:183]
    v_mfma_f32_16x16x32_bf16 v[204:207], a[108:111], a[72:75], v[204:207]
    v_mfma_f32_16x16x32_bf16 v[136:139], a[112:115], a[60:63], v[136:139]
    v_mfma_f32_16x16x32_bf16 v[160:163], a[112:115], a[64:67], v[160:163]
    v_mfma_f32_16x16x32_bf16 v[184:187], a[112:115], a[68:71], v[184:187]
    v_mfma_f32_16x16x32_bf16 v[208:211], a[112:115], a[72:75], v[208:211]
    v_mfma_f32_16x16x32_bf16 v[140:143], a[116:119], a[60:63], v[140:143]
    v_mfma_f32_16x16x32_bf16 v[164:167], a[116:119], a[64:67], v[164:167]
    v_mfma_f32_16x16x32_bf16 v[188:191], a[116:119], a[68:71], v[188:191]
    v_mfma_f32_16x16x32_bf16 v[212:215], a[116:119], a[72:75], v[212:215]
    v_mfma_f32_16x16x32_bf16 v[144:147], a[120:123], a[60:63], v[144:147]
    v_mfma_f32_16x16x32_bf16 v[168:171], a[120:123], a[64:67], v[168:171]
    v_mfma_f32_16x16x32_bf16 v[192:195], a[120:123], a[68:71], v[192:195]
    v_mfma_f32_16x16x32_bf16 v[216:219], a[120:123], a[72:75], v[216:219]
    v_mfma_f32_16x16x32_bf16 v[148:151], a[124:127], a[60:63], v[148:151]
    v_mfma_f32_16x16x32_bf16 v[172:175], a[124:127], a[64:67], v[172:175]
    v_mfma_f32_16x16x32_bf16 v[196:199], a[124:127], a[68:71], v[196:199]
    v_mfma_f32_16x16x32_bf16 v[220:223], a[124:127], a[72:75], v[220:223]
    v_mfma_f32_16x16x32_bf16 v[152:155], a[128:131], a[60:63], v[152:155]
    v_mfma_f32_16x16x32_bf16 v[176:179], a[128:131], a[64:67], v[176:179]
    v_mfma_f32_16x16x32_bf16 v[200:203], a[128:131], a[68:71], v[200:203]
    v_mfma_f32_16x16x32_bf16 v[224:227], a[128:131], a[72:75], v[224:227]
    v_mfma_f32_16x16x32_bf16 v[228:231], a[132:135], a[76:79], v[228:231]
    s_mov_b32 s36, 0x80
    s_mov_b32 s37, 0
    s_waitcnt vmcnt(0)
    v_cmp_gt_u32 vcc, 8, v11
    s_cbranch_vccz Lpe_6
Lpoll_5:
    buffer_load_dword v11, v10, s[16:19], s36 offen sc1
    s_add_u32 s37, s37, 1
    s_waitcnt vmcnt(0)
    v_cmp_gt_u32 vcc, 8, v11
    s_cbranch_vccz Lpe_6
    s_cmp_lt_u32 s37, 0x100000
    s_cbranch_scc1 Lpoll_5
Lpe_6:
    v_pk_add_f32 v[92:93], v[92:93], v[94:95]
    v_pk_add_f32 v[96:97], v[96:97], v[98:99]
    v_pk_add_f32 v[100:101], v[100:101], v[102:103]
    v_pk_add_f32 v[104:105], v[104:105], v[106:107]
    v_pk_add_f32 v[108:109], v[108:109], v[110:111]
    v_pk_add_f32 v[112:113], v[112:113], v[114:115]
    v_pk_add_f32 v[116:117], v[116:117], v[118:119]
    v_pk_add_f32 v[120:121], v[120:121], v[122:123]
    v_pk_add_f32 v[124:125], v[124:125], v[126:127]
    v_pk_add_f32 v[128:129], v[128:129], v[130:131]
    v_pk_add_f32 v[92:93], v[92:93], v[96:97]
    v_pk_add_f32 v[100:101], v[100:101], v[104:105]
    v_pk_add_f32 v[108:109], v[108:109], v[112:113]
    v_pk_add_f32 v[116:117], v[116:117], v[120:121]
    v_pk_add_f32 v[124:125], v[124:125], v[128:129]
    v_permlane32_swap_b32 v92, v93
    v_permlane32_swap_b32 v100, v101
    v_permlane32_swap_b32 v108, v109
    v_permlane32_swap_b32 v116, v117
    v_permlane32_swap_b32 v124, v125
    v_add_f32 v92, v92, v93
    v_add_f32 v100, v100, v101
    v_add_f32 v108, v108, v109
    v_add_f32 v116, v116, v117
    v_add_f32 v124, v124, v125
    v_mov_b32 v94, v92
    v_mov_b32 v102, v100
    v_mov_b32 v110, v108
    v_mov_b32 v118, v116
    v_mov_b32 v126, v124
    v_permlane16_swap_b32 v92, v94
    v_permlane16_swap_b32 v100, v102
    v_permlane16_swap_b32 v108, v110
    v_permlane16_swap_b32 v116, v118
    v_permlane16_swap_b32 v124, v126
    v_add_f32 v92, v92, v94
    v_add_f32 v100, v100, v102
    v_add_f32 v108, v108, v110
    v_add_f32 v116, v116, v118
    v_add_f32 v124, v124, v126
    v_mov_b32 v94, v92
    v_mov_b32 v102, v100
    v_mov_b32 v110, v108
    v_mov_b32 v118, v116
    v_mov_b32 v126, v124
    v_permlane32_swap_b32 v92, v94
    v_permlane32_swap_b32 v100, v102
    v_permlane32_swap_b32 v108, v110
    v_permlane32_swap_b32 v116, v118
    v_permlane32_swap_b32 v124, v126
    v_mul_f32 v82, 0xba800000, v92
    v_mul_f32 v94, 0x3a800000, v94
    v_mul_f32 v84, 0xba800000, v100
    v_mul_f32 v102, 0x3a800000, v102
    v_mul_f32 v86, 0xba800000, v108
    v_mul_f32 v110, 0x3a800000, v110
    v_mul_f32 v88, 0xba800000, v116
    v_mul_f32 v118, 0x3a800000, v118
    v_mul_f32 v90, 0xba800000, v124
    v_mul_f32 v126, 0x3a800000, v126
    v_add_f32_dpp v56, v56, v56 row_ror:8 row_mask:0xf bank_mask:0xf
    v_add_f32_dpp v57, v57, v57 row_ror:8 row_mask:0xf bank_mask:0xf
    v_add_f32_dpp v64, v64, v64 row_ror:8 row_mask:0xf bank_mask:0xf
    v_add_f32_dpp v65, v65, v65 row_ror:8 row_mask:0xf bank_mask:0xf
    v_fma_f32 v94, -v82, v82, v94
    v_fma_f32 v102, -v84, v84, v102
    v_fma_f32 v110, -v86, v86, v110
    v_fma_f32 v118, -v88, v88, v118
    v_add_f32_dpp v58, v58, v58 row_ror:8 row_mask:0xf bank_mask:0xf
    v_add_f32_dpp v59, v59, v59 row_ror:8 row_mask:0xf bank_mask:0xf
    v_add_f32_dpp v66, v66, v66 row_ror:8 row_mask:0xf bank_mask:0xf
    v_add_f32_dpp v67, v67, v67 row_ror:8 row_mask:0xf bank_mask:0xf
    v_add_f32_dpp v72, v72, v72 row_ror:8 row_mask:0xf bank_mask:0xf
    v_add_f32_dpp v73, v73, v73 row_ror:8 row_mask:0xf bank_mask:0xf
    v_fma_f32 v126, -v90, v90, v126
    v_add_f32_dpp v60, v60, v60 row_ror:8 row_mask:0xf bank_mask:0xf
    v_add_f32_dpp v61, v61, v61 row_ror:8 row_mask:0xf bank_mask:0xf
    v_add_f32_dpp v62, v62, v62 row_ror:8 row_mask:0xf bank_mask:0xf
    v_add_f32_dpp v63, v63, v63 row_ror:8 row_mask:0xf bank_mask:0xf
    v_add_f32_dpp v68, v68, v68 row_ror:8 row_mask:0xf bank_mask:0xf
    v_add_f32_dpp v69, v69, v69 row_ror:8 row_mask:0xf bank_mask:0xf
    v_add_f32_dpp v70, v70, v70 row_ror:8 row_mask:0xf bank_mask:0xf
    v_add_f32_dpp v71, v71, v71 row_ror:8 row_mask:0xf bank_mask:0xf
    v_add_f32_dpp v74, v74, v74 row_ror:8 row_mask:0xf bank_mask:0xf
    v_add_f32_dpp v75, v75, v75 row_ror:8 row_mask:0xf bank_mask:0xf
    v_max_f32 v94, 0, v94
    v_max_f32 v102, 0, v102
    v_max_f32 v110, 0, v110
    v_max_f32 v118, 0, v118
    v_add_f32_dpp v56, v56, v56 row_ror:4 row_mask:0xf bank_mask:0xf
    v_add_f32_dpp v57, v57, v57 row_ror:4 row_mask:0xf bank_mask:0xf
    v_add_f32_dpp v64, v64, v64 row_ror:4 row_mask:0xf bank_mask:0xf
    v_add_f32_dpp v65, v65, v65 row_ror:4 row_mask:0xf bank_mask:0xf
    v_max_f32 v126, 0, v126
    v_add_f32_dpp v58, v58, v58 row_ror:4 row_mask:0xf bank_mask:0xf
    v_add_f32_dpp v59, v59, v59 row_ror:4 row_mask:0xf bank_mask:0xf
    v_add_f32_dpp v66, v66, v66 row_ror:4 row_mask:0xf bank_mask:0xf
    v_add_f32_dpp v67, v67, v67 row_ror:4 row_mask:0xf bank_mask:0xf
    v_add_f32_dpp v72, v72, v72 row_ror:4 row_mask:0xf bank_mask:0xf
    v_add_f32_dpp v73, v73, v73 row_ror:4 row_mask:0xf bank_mask:0xf
    v_add_f32 v94, 0x3727c5ac, v94
    v_add_f32 v102, 0x3727c5ac, v102
    v_add_f32 v110, 0x3727c5ac, v110
    v_add_f32 v118, 0x3727c5ac, v118
    v_add_f32_dpp v60, v60, v60 row_ror:4 row_mask:0xf bank_mask:0xf
    v_add_f32_dpp v61, v61, v61 row_ror:4 row_mask:0xf bank_mask:0xf
    v_add_f32_dpp v62, v62, v62 row_ror:4 row_mask:0xf bank_mask:0xf
    v_add_f32_dpp v63, v63, v63 row_ror:4 row_mask:0xf bank_mask:0xf
    v_add_f32_dpp v68, v68, v68 row_ror:4 row_mask:0xf bank_mask:0xf
    v_add_f32_dpp v69, v69, v69 row_ror:4 row_mask:0xf bank_mask:0xf
    v_add_f32_dpp v70, v70, v70 row_ror:4 row_mask:0xf bank_mask:0xf
    v_add_f32_dpp v71, v71, v71 row_ror:4 row_mask:0xf bank_mask:0xf
    v_add_f32_dpp v74, v74, v74 row_ror:4 row_mask:0xf bank_mask:0xf
    v_add_f32_dpp v75, v75, v75 row_ror:4 row_mask:0xf bank_mask:0xf
    v_add_f32 v126, 0x3727c5ac, v126
    v_add_f32_dpp v56, v56, v56 row_ror:2 row_mask:0xf bank_mask:0xf
    v_add_f32_dpp v57, v57, v57 row_ror:2 row_mask:0xf bank_mask:0xf
    v_add_f32_dpp v64, v64, v64 row_ror:2 row_mask:0xf bank_mask:0xf
    v_add_f32_dpp v65, v65, v65 row_ror:2 row_mask:0xf bank_mask:0xf
    v_rsq_f32 v83, v94
    v_rsq_f32 v85, v102
    v_rsq_f32 v87, v110
    v_rsq_f32 v89, v118
    v_add_f32_dpp v58, v58, v58 row_ror:2 row_mask:0xf bank_mask:0xf
    v_add_f32_dpp v59, v59, v59 row_ror:2 row_mask:0xf bank_mask:0xf
    v_add_f32_dpp v66, v66, v66 row_ror:2 row_mask:0xf bank_mask:0xf
    v_add_f32_dpp v67, v67, v67 row_ror:2 row_mask:0xf bank_mask:0xf
    v_add_f32_dpp v72, v72, v72 row_ror:2 row_mask:0xf bank_mask:0xf
    v_add_f32_dpp v73, v73, v73 row_ror:2 row_mask:0xf bank_mask:0xf
    v_rsq_f32 v91, v126
    v_add_f32_dpp v60, v60, v60 row_ror:2 row_mask:0xf bank_mask:0xf
    v_add_f32_dpp v61, v61, v61 row_ror:2 row_mask:0xf bank_mask:0xf
    v_add_f32_dpp v62, v62, v62 row_ror:2 row_mask:0xf bank_mask:0xf
    v_add_f32_dpp v63, v63, v63 row_ror:2 row_mask:0xf bank_mask:0xf
    v_add_f32_dpp v68, v68, v68 row_ror:2 row_mask:0xf bank_mask:0xf
    v_add_f32_dpp v69, v69, v69 row_ror:2 row_mask:0xf bank_mask:0xf
    v_add_f32_dpp v70, v70, v70 row_ror:2 row_mask:0xf bank_mask:0xf
    v_add_f32_dpp v71, v71, v71 row_ror:2 row_mask:0xf bank_mask:0xf
    v_add_f32_dpp v74, v74, v74 row_ror:2 row_mask:0xf bank_mask:0xf
    v_add_f32_dpp v75, v75, v75 row_ror:2 row_mask:0xf bank_mask:0xf
    v_add_f32_dpp v56, v56, v56 row_ror:1 row_mask:0xf bank_mask:0xf
    v_add_f32_dpp v57, v57, v57 row_ror:1 row_mask:0xf bank_mask:0xf
    v_add_f32_dpp v64, v64, v64 row_ror:1 row_mask:0xf bank_mask:0xf
    v_add_f32_dpp v65, v65, v65 row_ror:1 row_mask:0xf bank_mask:0xf
    v_add_f32_dpp v48, v48, v48 row_ror:8 row_mask:0xf bank_mask:0xf
    v_add_f32_dpp v49, v49, v49 row_ror:8 row_mask:0xf bank_mask:0xf
    v_add_f32_dpp v50, v50, v50 row_ror:8 row_mask:0xf bank_mask:0xf
    v_add_f32_dpp v51, v51, v51 row_ror:8 row_mask:0xf bank_mask:0xf
    v_add_f32_dpp v52, v52, v52 row_ror:8 row_mask:0xf bank_mask:0xf
    v_add_f32_dpp v53, v53, v53 row_ror:8 row_mask:0xf bank_mask:0xf
    v_add_f32_dpp v54, v54, v54 row_ror:8 row_mask:0xf bank_mask:0xf
    v_add_f32_dpp v55, v55, v55 row_ror:8 row_mask:0xf bank_mask:0xf
    v_add_f32_dpp v58, v58, v58 row_ror:1 row_mask:0xf bank_mask:0xf
    v_add_f32_dpp v59, v59, v59 row_ror:1 row_mask:0xf bank_mask:0xf
    v_add_f32_dpp v66, v66, v66 row_ror:1 row_mask:0xf bank_mask:0xf
    v_add_f32_dpp v67, v67, v67 row_ror:1 row_mask:0xf bank_mask:0xf
    v_add_f32_dpp v72, v72, v72 row_ror:1 row_mask:0xf bank_mask:0xf
    v_add_f32_dpp v73, v73, v73 row_ror:1 row_mask:0xf bank_mask:0xf
    v_add_f32_dpp v60, v60, v60 row_ror:1 row_mask:0xf bank_mask:0xf
    v_add_f32_dpp v61, v61, v61 row_ror:1 row_mask:0xf bank_mask:0xf
    v_add_f32_dpp v62, v62, v62 row_ror:1 row_mask:0xf bank_mask:0xf
    v_add_f32_dpp v63, v63, v63 row_ror:1 row_mask:0xf bank_mask:0xf
    v_add_f32_dpp v68, v68, v68 row_ror:1 row_mask:0xf bank_mask:0xf
    v_add_f32_dpp v69, v69, v69 row_ror:1 row_mask:0xf bank_mask:0xf
    v_add_f32_dpp v70, v70, v70 row_ror:1 row_mask:0xf bank_mask:0xf
    v_add_f32_dpp v71, v71, v71 row_ror:1 row_mask:0xf bank_mask:0xf
    v_add_f32_dpp v74, v74, v74 row_ror:1 row_mask:0xf bank_mask:0xf
    v_add_f32_dpp v75, v75, v75 row_ror:1 row_mask:0xf bank_mask:0xf
    v_pk_fma_f32 v[212:213], v[56:57], v[88:89], v[212:213] op_sel:[0,0,0] op_sel_hi:[1,0,1]
    v_pk_fma_f32 v[220:221], v[64:65], v[88:89], v[220:221] op_sel:[0,0,0] op_sel_hi:[1,0,1]
    v_pk_fma_f32 v[196:197], v[64:65], v[86:87], v[196:197] op_sel:[0,0,0] op_sel_hi:[1,0,1]
    v_pk_fma_f32 v[172:173], v[64:65], v[84:85], v[172:173] op_sel:[0,0,0] op_sel_hi:[1,0,1]
    v_pk_fma_f32 v[148:149], v[64:65], v[82:83], v[148:149] op_sel:[0,0,0] op_sel_hi:[1,0,1]
    v_pk_fma_f32 v[228:229], v[72:73], v[90:91], v[228:229] op_sel:[0,0,0] op_sel_hi:[1,0,1]
    v_pk_fma_f32 v[214:215], v[58:59], v[88:89], v[214:215] op_sel:[0,0,0] op_sel_hi:[1,0,1]
    v_pk_fma_f32 v[222:223], v[66:67], v[88:89], v[222:223] op_sel:[0,0,0] op_sel_hi:[1,0,1]
    v_pk_fma_f32 v[198:199], v[66:67], v[86:87], v[198:199] op_sel:[0,0,0] op_sel_hi:[1,0,1]
    v_pk_fma_f32 v[174:175], v[66:67], v[84:85], v[174:175] op_sel:[0,0,0] op_sel_hi:[1,0,1]
    v_pk_fma_f32 v[150:151], v[66:67], v[82:83], v[150:151] op_sel:[0,0,0] op_sel_hi:[1,0,1]
    v_add_f32_dpp v48, v48, v48 row_ror:4 row_mask:0xf bank_mask:0xf
    v_add_f32_dpp v49, v49, v49 row_ror:4 row_mask:0xf bank_mask:0xf
    v_add_f32_dpp v50, v50, v50 row_ror:4 row_mask:0xf bank_mask:0xf
    v_add_f32_dpp v51, v51, v51 row_ror:4 row_mask:0xf bank_mask:0xf
    v_add_f32_dpp v52, v52, v52 row_ror:4 row_mask:0xf bank_mask:0xf
    v_add_f32_dpp v53, v53, v53 row_ror:4 row_mask:0xf bank_mask:0xf
    v_add_f32_dpp v54, v54, v54 row_ror:4 row_mask:0xf bank_mask:0xf
    v_add_f32_dpp v55, v55, v55 row_ror:4 row_mask:0xf bank_mask:0xf
    v_pk_fma_f32 v[230:231], v[74:75], v[90:91], v[230:231] op_sel:[0,0,0] op_sel_hi:[1,0,1]
    v_pk_fma_f32 v[216:217], v[60:61], v[88:89], v[216:217] op_sel:[0,0,0] op_sel_hi:[1,0,1]
    v_pk_fma_f32 v[218:219], v[62:63], v[88:89], v[218:219] op_sel:[0,0,0] op_sel_hi:[1,0,1]
    v_pk_fma_f32 v[224:225], v[68:69], v[88:89], v[224:225] op_sel:[0,0,0] op_sel_hi:[1,0,1]
    v_pk_fma_f32 v[226:227], v[70:71], v[88:89], v[226:227] op_sel:[0,0,0] op_sel_hi:[1,0,1]
    v_pk_fma_f32 v[200:201], v[68:69], v[86:87], v[200:201] op_sel:[0,0,0] op_sel_hi:[1,0,1]
    v_pk_fma_f32 v[202:203], v[70:71], v[86:87], v[202:203] op_sel:[0,0,0] op_sel_hi:[1,0,1]
    v_pk_fma_f32 v[176:177], v[68:69], v[84:85], v[176:177] op_sel:[0,0,0] op_sel_hi:[1,0,1]
    v_pk_fma_f32 v[178:179], v[70:71], v[84:85], v[178:179] op_sel:[0,0,0] op_sel_hi:[1,0,1]
    v_pk_fma_f32 v[152:153], v[68:69], v[82:83], v[152:153] op_sel:[0,0,0] op_sel_hi:[1,0,1]
    v_pk_fma_f32 v[154:155], v[70:71], v[82:83], v[154:155] op_sel:[0,0,0] op_sel_hi:[1,0,1]
    v_pk_mul_f32 v[212:213], v[212:213], v[88:89] op_sel:[0,1] op_sel_hi:[1,1]
    v_pk_mul_f32 v[220:221], v[220:221], v[88:89] op_sel:[0,1] op_sel_hi:[1,1]
    v_pk_mul_f32 v[196:197], v[196:197], v[86:87] op_sel:[0,1] op_sel_hi:[1,1]
    v_pk_mul_f32 v[172:173], v[172:173], v[84:85] op_sel:[0,1] op_sel_hi:[1,1]
    v_pk_mul_f32 v[148:149], v[148:149], v[82:83] op_sel:[0,1] op_sel_hi:[1,1]
    v_pk_fma_f32 v[188:189], v[56:57], v[86:87], v[188:189] op_sel:[0,0,0] op_sel_hi:[1,0,1]
    v_pk_fma_f32 v[164:165], v[56:57], v[84:85], v[164:165] op_sel:[0,0,0] op_sel_hi:[1,0,1]
    v_pk_fma_f32 v[140:141], v[56:57], v[82:83], v[140:141] op_sel:[0,0,0] op_sel_hi:[1,0,1]
    v_pk_mul_f32 v[228:229], v[228:229], v[90:91] op_sel:[0,1] op_sel_hi:[1,1]
    v_pk_mul_f32 v[214:215], v[214:215], v[88:89] op_sel:[0,1] op_sel_hi:[1,1]
    v_pk_mul_f32 v[222:223], v[222:223], v[88:89] op_sel:[0,1] op_sel_hi:[1,1]
    v_pk_mul_f32 v[198:199], v[198:199], v[86:87] op_sel:[0,1] op_sel_hi:[1,1]
    v_pk_mul_f32 v[174:175], v[174:175], v[84:85] op_sel:[0,1] op_sel_hi:[1,1]
    v_pk_mul_f32 v[150:151], v[150:151], v[82:83] op_sel:[0,1] op_sel_hi:[1,1]
    s_lshl_b32 s36, s28, 12
    v_pk_fma_f32 v[190:191], v[58:59], v[86:87], v[190:191] op_sel:[0,0,0] op_sel_hi:[1,0,1]
    v_pk_fma_f32 v[166:167], v[58:59], v[84:85], v[166:167] op_sel:[0,0,0] op_sel_hi:[1,0,1]
    v_pk_fma_f32 v[142:143], v[58:59], v[82:83], v[142:143] op_sel:[0,0,0] op_sel_hi:[1,0,1]
    v_add_f32_dpp v48, v48, v48 row_ror:2 row_mask:0xf bank_mask:0xf
    v_add_f32_dpp v49, v49, v49 row_ror:2 row_mask:0xf bank_mask:0xf
    v_add_f32_dpp v50, v50, v50 row_ror:2 row_mask:0xf bank_mask:0xf
    v_add_f32_dpp v51, v51, v51 row_ror:2 row_mask:0xf bank_mask:0xf
    v_add_f32_dpp v52, v52, v52 row_ror:2 row_mask:0xf bank_mask:0xf
    v_add_f32_dpp v53, v53, v53 row_ror:2 row_mask:0xf bank_mask:0xf
    v_add_f32_dpp v54, v54, v54 row_ror:2 row_mask:0xf bank_mask:0xf
    v_add_f32_dpp v55, v55, v55 row_ror:2 row_mask:0xf bank_mask:0xf
    v_pk_mul_f32 v[230:231], v[230:231], v[90:91] op_sel:[0,1] op_sel_hi:[1,1]
    v_pk_mul_f32 v[216:217], v[216:217], v[88:89] op_sel:[0,1] op_sel_hi:[1,1]
    v_pk_mul_f32 v[218:219], v[218:219], v[88:89] op_sel:[0,1] op_sel_hi:[1,1]
    v_pk_mul_f32 v[224:225], v[224:225], v[88:89] op_sel:[0,1] op_sel_hi:[1,1]
    v_pk_mul_f32 v[226:227], v[226:227], v[88:89] op_sel:[0,1] op_sel_hi:[1,1]
    v_pk_mul_f32 v[200:201], v[200:201], v[86:87] op_sel:[0,1] op_sel_hi:[1,1]
    v_pk_mul_f32 v[202:203], v[202:203], v[86:87] op_sel:[0,1] op_sel_hi:[1,1]
    v_pk_mul_f32 v[176:177], v[176:177], v[84:85] op_sel:[0,1] op_sel_hi:[1,1]
    v_pk_mul_f32 v[178:179], v[178:179], v[84:85] op_sel:[0,1] op_sel_hi:[1,1]
    v_pk_mul_f32 v[152:153], v[152:153], v[82:83] op_sel:[0,1] op_sel_hi:[1,1]
    v_pk_mul_f32 v[154:155], v[154:155], v[82:83] op_sel:[0,1] op_sel_hi:[1,1]
    v_cvt_pk_bf16_f32 v212, v212, v213
    v_cvt_pk_bf16_f32 v220, v220, v221
    v_cvt_pk_bf16_f32 v196, v196, v197
    v_cvt_pk_bf16_f32 v172, v172, v173
    v_cvt_pk_bf16_f32 v148, v148, v149
    s_lshl_b32 s37, s28, 10
    v_pk_fma_f32 v[192:193], v[60:61], v[86:87], v[192:193] op_sel:[0,0,0] op_sel_hi:[1,0,1]
    v_pk_fma_f32 v[194:195], v[62:63], v[86:87], v[194:195] op_sel:[0,0,0] op_sel_hi:[1,0,1]
    v_pk_fma_f32 v[168:169], v[60:61], v[84:85], v[168:169] op_sel:[0,0,0] op_sel_hi:[1,0,1]
    v_pk_fma_f32 v[170:171], v[62:63], v[84:85], v[170:171] op_sel:[0,0,0] op_sel_hi:[1,0,1]
    v_pk_fma_f32 v[144:145], v[60:61], v[82:83], v[144:145] op_sel:[0,0,0] op_sel_hi:[1,0,1]
    v_pk_fma_f32 v[146:147], v[62:63], v[82:83], v[146:147] op_sel:[0,0,0] op_sel_hi:[1,0,1]
    v_pk_mul_f32 v[188:189], v[188:189], v[86:87] op_sel:[0,1] op_sel_hi:[1,1]
    v_pk_mul_f32 v[164:165], v[164:165], v[84:85] op_sel:[0,1] op_sel_hi:[1,1]
    v_pk_mul_f32 v[140:141], v[140:141], v[82:83] op_sel:[0,1] op_sel_hi:[1,1]
    v_cvt_pk_bf16_f32 v228, v228, v229
    v_cvt_pk_bf16_f32 v213, v214, v215
    v_cvt_pk_bf16_f32 v221, v222, v223
    v_cvt_pk_bf16_f32 v197, v198, v199
    v_cvt_pk_bf16_f32 v173, v174, v175
    v_cvt_pk_bf16_f32 v149, v150, v151
    v_pk_mul_f32 v[190:191], v[190:191], v[86:87] op_sel:[0,1] op_sel_hi:[1,1]
    v_pk_mul_f32 v[166:167], v[166:167], v[84:85] op_sel:[0,1] op_sel_hi:[1,1]
    v_pk_mul_f32 v[142:143], v[142:143], v[82:83] op_sel:[0,1] op_sel_hi:[1,1]
    v_add_u32 v232, s36, v7
    v_add_u32 v233, s37, v1
    v_cvt_pk_bf16_f32 v229, v230, v231
    v_cvt_pk_bf16_f32 v214, v216, v217
    v_cvt_pk_bf16_f32 v215, v218, v219
    v_cvt_pk_bf16_f32 v222, v224, v225
    v_cvt_pk_bf16_f32 v223, v226, v227
    v_cvt_pk_bf16_f32 v198, v200, v201
    v_cvt_pk_bf16_f32 v199, v202, v203
    v_cvt_pk_bf16_f32 v174, v176, v177
    v_cvt_pk_bf16_f32 v175, v178, v179
    v_cvt_pk_bf16_f32 v150, v152, v153
    v_cvt_pk_bf16_f32 v151, v154, v155
    v_add_f32_dpp v48, v48, v48 row_ror:1 row_mask:0xf bank_mask:0xf
    v_add_f32_dpp v49, v49, v49 row_ror:1 row_mask:0xf bank_mask:0xf
    v_add_f32_dpp v50, v50, v50 row_ror:1 row_mask:0xf bank_mask:0xf
    v_add_f32_dpp v51, v51, v51 row_ror:1 row_mask:0xf bank_mask:0xf
    v_add_f32_dpp v52, v52, v52 row_ror:1 row_mask:0xf bank_mask:0xf
    v_add_f32_dpp v53, v53, v53 row_ror:1 row_mask:0xf bank_mask:0xf
    v_add_f32_dpp v54, v54, v54 row_ror:1 row_mask:0xf bank_mask:0xf
    v_add_f32_dpp v55, v55, v55 row_ror:1 row_mask:0xf bank_mask:0xf
    v_pk_mul_f32 v[192:193], v[192:193], v[86:87] op_sel:[0,1] op_sel_hi:[1,1]
    v_pk_mul_f32 v[194:195], v[194:195], v[86:87] op_sel:[0,1] op_sel_hi:[1,1]
    v_pk_mul_f32 v[168:169], v[168:169], v[84:85] op_sel:[0,1] op_sel_hi:[1,1]
    v_pk_mul_f32 v[170:171], v[170:171], v[84:85] op_sel:[0,1] op_sel_hi:[1,1]
    v_pk_mul_f32 v[144:145], v[144:145], v[82:83] op_sel:[0,1] op_sel_hi:[1,1]
    v_pk_mul_f32 v[146:147], v[146:147], v[82:83] op_sel:[0,1] op_sel_hi:[1,1]
    v_cvt_pk_bf16_f32 v188, v188, v189
    v_cvt_pk_bf16_f32 v164, v164, v165
    v_cvt_pk_bf16_f32 v140, v140, v141
    v_cvt_pk_bf16_f32 v189, v190, v191
    v_cvt_pk_bf16_f32 v165, v166, v167
    v_cvt_pk_bf16_f32 v141, v142, v143
    ds_write_b64 v9, v[228:229]
    ds_write_b64 v232, v[220:221] offset:4096
    ds_write_b64 v232, v[222:223] offset:4608
    ds_write_b64 v232, v[196:197] offset:3072
    ds_write_b64 v232, v[198:199] offset:3584
    ds_write_b64 v232, v[172:173] offset:2048
    ds_write_b64 v232, v[174:175] offset:2560
    ds_write_b64 v232, v[148:149] offset:1024
    ds_write_b64 v232, v[150:151] offset:1536
    ds_write_b128 v233, v[212:215] offset:21504
    v_accvgpr_write_b32 a136, v48
    v_accvgpr_write_b32 a137, v49
    v_accvgpr_write_b32 a138, v50
    v_accvgpr_write_b32 a139, v51
    v_accvgpr_write_b32 a140, v52
    v_accvgpr_write_b32 a141, v53
    v_accvgpr_write_b32 a142, v54
    v_accvgpr_write_b32 a143, v55
    v_accvgpr_write_b32 a144, v56
    v_accvgpr_write_b32 a145, v57
    v_accvgpr_write_b32 a146, v58
    v_accvgpr_write_b32 a147, v59
    v_accvgpr_write_b32 a148, v60
    v_accvgpr_write_b32 a149, v61
    v_accvgpr_write_b32 a150, v62
    v_accvgpr_write_b32 a151, v63
    v_accvgpr_write_b32 a152, v64
    v_accvgpr_write_b32 a153, v65
    v_accvgpr_write_b32 a154, v66
    v_accvgpr_write_b32 a155, v67
    v_accvgpr_write_b32 a156, v68
    v_accvgpr_write_b32 a157, v69
    v_accvgpr_write_b32 a158, v70
    v_accvgpr_write_b32 a159, v71
    v_accvgpr_write_b32 a160, v72
    v_accvgpr_write_b32 a161, v73
    v_accvgpr_write_b32 a162, v74
    v_accvgpr_write_b32 a163, v75
    v_cvt_pk_bf16_f32 v190, v192, v193
    v_cvt_pk_bf16_f32 v191, v194, v195
    v_cvt_pk_bf16_f32 v166, v168, v169
    v_cvt_pk_bf16_f32 v167, v170, v171
    v_cvt_pk_bf16_f32 v142, v144, v145
    v_cvt_pk_bf16_f32 v143, v146, v147
    s_waitcnt lgkmcnt(0)
    s_barrier
    ds_read_b128 a[0:3], v233 offset:20480
    v_pk_fma_f32 v[132:133], v[48:49], v[82:83], v[132:133] op_sel:[0,0,0] op_sel_hi:[1,0,1]
    v_pk_fma_f32 v[156:157], v[48:49], v[84:85], v[156:157] op_sel:[0,0,0] op_sel_hi:[1,0,1]
    v_pk_fma_f32 v[134:135], v[50:51], v[82:83], v[134:135] op_sel:[0,0,0] op_sel_hi:[1,0,1]
    v_pk_fma_f32 v[158:159], v[50:51], v[84:85], v[158:159] op_sel:[0,0,0] op_sel_hi:[1,0,1]
    v_pk_fma_f32 v[136:137], v[52:53], v[82:83], v[136:137] op_sel:[0,0,0] op_sel_hi:[1,0,1]
    v_pk_fma_f32 v[138:139], v[54:55], v[82:83], v[138:139] op_sel:[0,0,0] op_sel_hi:[1,0,1]
    v_pk_fma_f32 v[160:161], v[52:53], v[84:85], v[160:161] op_sel:[0,0,0] op_sel_hi:[1,0,1]
    v_pk_fma_f32 v[162:163], v[54:55], v[84:85], v[162:163] op_sel:[0,0,0] op_sel_hi:[1,0,1]
    v_cvt_pk_bf16_f32 v132, v132, v133
    v_cvt_pk_bf16_f32 v156, v156, v157
    v_cvt_pk_bf16_f32 v133, v134, v135
    v_cvt_pk_bf16_f32 v157, v158, v159
    v_pk_fma_f32 v[180:181], v[48:49], v[86:87], v[180:181] op_sel:[0,0,0] op_sel_hi:[1,0,1]
    v_pk_fma_f32 v[204:205], v[48:49], v[88:89], v[204:205] op_sel:[0,0,0] op_sel_hi:[1,0,1]
    v_cvt_pk_bf16_f32 v134, v136, v137
    v_cvt_pk_bf16_f32 v135, v138, v139
    v_cvt_pk_bf16_f32 v158, v160, v161
    v_cvt_pk_bf16_f32 v159, v162, v163
    v_pk_fma_f32 v[182:183], v[50:51], v[86:87], v[182:183] op_sel:[0,0,0] op_sel_hi:[1,0,1]
    v_cvt_pk_bf16_f32 v180, v180, v181
    v_pk_fma_f32 v[206:207], v[50:51], v[88:89], v[206:207] op_sel:[0,0,0] op_sel_hi:[1,0,1]
    v_cvt_pk_bf16_f32 v204, v204, v205
    v_pk_fma_f32 v[184:185], v[52:53], v[86:87], v[184:185] op_sel:[0,0,0] op_sel_hi:[1,0,1]
    v_cvt_pk_bf16_f32 v181, v182, v183
    v_pk_fma_f32 v[186:187], v[54:55], v[86:87], v[186:187] op_sel:[0,0,0] op_sel_hi:[1,0,1]
    v_cvt_pk_bf16_f32 v205, v206, v207
    v_pk_fma_f32 v[208:209], v[52:53], v[88:89], v[208:209] op_sel:[0,0,0] op_sel_hi:[1,0,1]
    v_cvt_pk_bf16_f32 v182, v184, v185
    v_pk_fma_f32 v[210:211], v[54:55], v[88:89], v[210:211] op_sel:[0,0,0] op_sel_hi:[1,0,1]
    v_cvt_pk_bf16_f32 v183, v186, v187
    s_waitcnt lgkmcnt(0)
    v_mfma_f32_16x16x32_bf16 v[136:139], a[0:3], v[132:135], v[76:79]
    v_cvt_pk_bf16_f32 v206, v208, v209
    v_cvt_pk_bf16_f32 v207, v210, v211
    v_mfma_f32_16x16x32_bf16 v[152:155], v[140:143], v[132:135], v[24:27]
    v_add_u32 v234, s36, v8
    v_mul_f32 v82, 0x3e8293ee, v83
    v_mfma_f32_16x16x32_bf16 v[160:163], v[140:143], v[156:159], v[20:23]
    ds_read_b64_tr_b16 a[4:5], v234 offset:0
    ds_read_b64_tr_b16 a[6:7], v234 offset:1024
    v_mfma_f32_16x16x32_bf16 v[176:179], v[164:167], v[156:159], v[24:27]
    v_mul_f32 v84, 0x3e8293ee, v85
    s_nop 0
    v_max_f32 v152, v152, v136
    v_mfma_f32_16x16x32_bf16 v[184:187], v[164:167], v[180:183], v[20:23]
    v_max_f32 v153, v153, v137
    v_max_f32 v154, v154, v138
    v_mfma_f32_16x16x32_bf16 v[200:203], v[188:191], v[180:183], v[24:27]
    v_max_f32 v155, v155, v139
    v_max_f32 v176, v176, v160
    v_mfma_f32_16x16x32_bf16 v[208:211], v[188:191], v[204:207], v[20:23]
    v_max_f32 v177, v177, v161
    v_max_f32 v178, v178, v162
    v_mfma_f32_16x16x32_bf16 v[224:227], v[212:215], v[204:207], v[24:27]
    v_max3_f32 v236, v152, v153, v154
    v_max_f32 v179, v179, v163
    v_max3_f32 v237, v176, v177, v178
    v_max_f32 v200, v200, v184
    v_max_f32 v201, v201, v185
    v_max_f32 v202, v202, v186
    v_max_f32 v236, v236, v155
    v_max_f32 v237, v237, v179
    v_max_f32 v203, v203, v187
    v_max_f32 v224, v224, v208
    v_max_f32 v225, v225, v209
    v_max_f32 v226, v226, v210
    v_max3_f32 v238, v200, v201, v202
    v_max_f32 v227, v227, v211
    v_max3_f32 v239, v224, v225, v226
    v_permlane32_swap_b32 v236, v237
    v_max_f32 v238, v238, v203
    v_max_f32 v239, v239, v227
    v_max_f32 v236, v236, v237
    ds_read_b64_tr_b16 a[8:9], v234 offset:2048
    v_permlane32_swap_b32 v238, v239
    v_mov_b32 v240, v236
    v_max_f32 v238, v238, v239
    ds_read_b64_tr_b16 a[16:17], v234 offset:512
    v_permlane16_swap_b32 v236, v240
    v_mov_b32 v241, v238
    v_max_f32 v236, v236, v240
    ds_read_b64_tr_b16 a[18:19], v234 offset:1536
    v_permlane16_swap_b32 v238, v241
    v_mov_b32 v240, v236
    v_max_f32 v238, v238, v241
    v_mul_f32 v86, 0x3e8293ee, v87
    v_permlane32_swap_b32 v236, v240
    v_mov_b32 v241, v238
    v_mul_f32_e64 v83, -v236, v82
    ds_read_b64_tr_b16 a[10:11], v234 offset:3072
    v_permlane32_swap_b32 v238, v241
    v_mul_f32_e64 v85, -v240, v84
    ds_read_b64_tr_b16 a[20:21], v234 offset:2560
    v_pk_fma_f32 v[152:153], v[152:153], v[82:83], v[82:83] op_sel:[0,0,1] op_sel_hi:[1,0,1]
    v_mul_f32 v88, 0x3e8293ee, v89
    v_pk_fma_f32 v[154:155], v[154:155], v[82:83], v[82:83] op_sel:[0,0,1] op_sel_hi:[1,0,1]
    ds_read_b64_tr_b16 a[12:13], v234 offset:4096
    v_mul_f32_e64 v87, -v238, v86
    ds_read_b64_tr_b16 a[22:23], v234 offset:3584
    v_pk_fma_f32 v[176:177], v[176:177], v[84:85], v[84:85] op_sel:[0,0,1] op_sel_hi:[1,0,1]
    v_exp_f32 v152, v152
    v_exp_f32 v153, v153
    v_pk_fma_f32 v[178:179], v[178:179], v[84:85], v[84:85] op_sel:[0,0,1] op_sel_hi:[1,0,1]
    v_mul_f32_e64 v89, -v241, v88
    ds_read_b64_tr_b16 a[24:25], v234 offset:4608
    v_exp_f32 v154, v154
    v_exp_f32 v155, v155
    v_pk_fma_f32 v[200:201], v[200:201], v[86:87], v[86:87] op_sel:[0,0,1] op_sel_hi:[1,0,1]
    v_exp_f32 v176, v176
    v_exp_f32 v177, v177
    v_pk_fma_f32 v[202:203], v[202:203], v[86:87], v[86:87] op_sel:[0,0,1] op_sel_hi:[1,0,1]
    v_exp_f32 v178, v178
    v_exp_f32 v179, v179
    v_pk_fma_f32 v[224:225], v[224:225], v[88:89], v[88:89] op_sel:[0,0,1] op_sel_hi:[1,0,1]
    v_exp_f32 v200, v200
    v_exp_f32 v201, v201
    v_pk_fma_f32 v[226:227], v[226:227], v[88:89], v[88:89] op_sel:[0,0,1] op_sel_hi:[1,0,1]
    v_exp_f32 v202, v202
    v_exp_f32 v203, v203
    v_cvt_pk_bf16_f32 v152, v152, v153
    v_exp_f32 v224, v224
    v_exp_f32 v225, v225
    v_cvt_pk_bf16_f32 v153, v154, v155
    v_exp_f32 v226, v226
    v_exp_f32 v227, v227
    v_cvt_pk_bf16_f32 v176, v176, v177
    v_cvt_pk_bf16_f32 v177, v178, v179
    v_and_b32 v136, v152, v80
    v_and_b32 v137, v153, v81
    v_and_b32 v138, v152, v30
    v_and_b32 v139, v153, v31
    v_cvt_pk_bf16_f32 v200, v200, v201
    v_cvt_pk_bf16_f32 v201, v202, v203
    v_and_b32 v160, v176, v28
    v_and_b32 v161, v177, v29
    v_and_b32 v162, v176, v30
    v_and_b32 v163, v177, v31
    v_cvt_pk_bf16_f32 v224, v224, v225
    v_cvt_pk_bf16_f32 v225, v226, v227
    v_mfma_f32_16x16x32_bf16 v[144:147], v[16:19], v[136:139], 0
    v_and_b32 v184, v200, v28
    v_and_b32 v185, v201, v29
    v_and_b32 v186, v200, v30
    v_and_b32 v187, v201, v31
    v_mfma_f32_16x16x32_bf16 v[168:171], v[16:19], v[160:163], 0
    v_and_b32 v208, v224, v28
    v_and_b32 v209, v225, v29
    v_and_b32 v210, v224, v30
    v_and_b32 v211, v225, v31
    v_mfma_f32_16x16x32_bf16 v[192:195], v[16:19], v[184:187], 0
    v_rcp_f32 v144, v144
    s_waitcnt lgkmcnt(8)
    v_mfma_f32_16x16x32_bf16 v[92:95], a[4:7], v[136:139], 0
    v_rcp_f32 v168, v168
    v_mfma_f32_16x16x32_bf16 v[216:219], v[16:19], v[208:211], 0
    s_lshl_b32 s35, s30, 12
    s_nop 1
    v_rcp_f32 v192, v192
    s_waitcnt lgkmcnt(7)
    v_mfma_f32_16x16x32_bf16 v[100:103], a[6:9], v[160:163], 0
    v_pk_mul_f32 v[92:93], v[92:93], v[144:145] op_sel:[0,0] op_sel_hi:[1,0]
    v_pk_mul_f32 v[94:95], v[94:95], v[144:145] op_sel:[0,0] op_sel_hi:[1,0]
    v_cvt_pk_bf16_f32 v92, v92, v93
    s_waitcnt lgkmcnt(5)
    v_mfma_f32_16x16x32_bf16 v[96:99], a[16:19], v[136:139], 0
    v_rcp_f32 v216, v216
    s_waitcnt lgkmcnt(4)
    v_mfma_f32_16x16x32_bf16 v[108:111], a[8:11], v[184:187], 0
    v_pk_mul_f32 v[100:101], v[100:101], v[168:169] op_sel:[0,0] op_sel_hi:[1,0]
    v_pk_mul_f32 v[102:103], v[102:103], v[168:169] op_sel:[0,0] op_sel_hi:[1,0]
    v_cvt_pk_bf16_f32 v93, v94, v95
    s_waitcnt lgkmcnt(3)
    v_mfma_f32_16x16x32_bf16 v[104:107], a[18:21], v[160:163], 0
    v_pk_mul_f32 v[96:97], v[96:97], v[144:145] op_sel:[0,0] op_sel_hi:[1,0]
    v_pk_mul_f32 v[98:99], v[98:99], v[144:145] op_sel:[0,0] op_sel_hi:[1,0]
    v_cvt_pk_bf16_f32 v100, v100, v101
    s_waitcnt lgkmcnt(2)
    v_mfma_f32_16x16x32_bf16 v[116:119], a[10:13], v[208:211], 0
    v_pk_mul_f32 v[108:109], v[108:109], v[192:193] op_sel:[0,0] op_sel_hi:[1,0]
    v_cvt_pk_bf16_f32 v94, v96, v97
    s_waitcnt lgkmcnt(1)
    v_mfma_f32_16x16x32_bf16 v[112:115], a[20:23], v[184:187], 0
    v_pk_mul_f32 v[104:105], v[104:105], v[168:169] op_sel:[0,0] op_sel_hi:[1,0]
    v_pk_mul_f32 v[106:107], v[106:107], v[168:169] op_sel:[0,0] op_sel_hi:[1,0]
    v_cvt_pk_bf16_f32 v95, v98, v99
    s_waitcnt lgkmcnt(0)
    v_mfma_f32_16x16x32_bf16 v[120:123], a[22:25], v[208:211], 0
    v_pk_mul_f32 v[110:111], v[110:111], v[192:193] op_sel:[0,0] op_sel_hi:[1,0]
    s_add_u32 s35, s35, 0x1e00000
    v_cvt_pk_bf16_f32 v101, v102, v103
    v_pk_mul_f32 v[116:117], v[116:117], v[216:217] op_sel:[0,0] op_sel_hi:[1,0]
    v_pk_mul_f32 v[112:113], v[112:113], v[192:193] op_sel:[0,0] op_sel_hi:[1,0]
    v_pk_mul_f32 v[114:115], v[114:115], v[192:193] op_sel:[0,0] op_sel_hi:[1,0]
    v_cvt_pk_bf16_f32 v108, v108, v109
    v_cvt_pk_bf16_f32 v102, v104, v105
    v_cvt_pk_bf16_f32 v103, v106, v107
    v_pk_mul_f32 v[118:119], v[118:119], v[216:217] op_sel:[0,0] op_sel_hi:[1,0]
    buffer_store_dwordx4 v[92:95], v2, s[4:7], s35 offen offset:0 sc1
    v_cvt_pk_bf16_f32 v109, v110, v111
    v_pk_mul_f32 v[120:121], v[120:121], v[216:217] op_sel:[0,0] op_sel_hi:[1,0]
    v_pk_mul_f32 v[122:123], v[122:123], v[216:217] op_sel:[0,0] op_sel_hi:[1,0]
    v_cvt_pk_bf16_f32 v116, v116, v117
    v_cvt_pk_bf16_f32 v110, v112, v113
    v_cvt_pk_bf16_f32 v111, v114, v115
    buffer_store_dwordx4 v[100:103], v2, s[4:7], s35 offen offset:1024 sc1
    v_cvt_pk_bf16_f32 v117, v118, v119
    v_cvt_pk_bf16_f32 v118, v120, v121
    v_cvt_pk_bf16_f32 v119, v122, v123
    buffer_store_dwordx4 v[108:111], v2, s[4:7], s35 offen offset:2048 sc1
    buffer_store_dwordx4 v[116:119], v2, s[4:7], s35 offen offset:3072 sc1
    s_lshl_b32 s36, s29, 13
    v_lshl_add_u32 v10, v0, 8, s36
    s_waitcnt vmcnt(0)
    s_barrier
    s_cmp_lg_u32 s28, 0
    s_cbranch_scc1 Lsig_7
    s_mov_b32 exec_lo, 0xffffffff
    s_mov_b32 exec_hi, 0
    s_mov_b32 s36, 0x0
    buffer_atomic_add v12, v10, s[4:7], s36 offen sc1
    s_mov_b64 exec, -1
Lsig_7:
    s_add_u32 s45, s28, 0
    s_add_u32 s44, s45, s34
    s_and_b32 s44, s44, 31
    s_lshl_b32 s44, s44, 12
    s_add_u32 s44, s44, s51
    s_add_u32 s44, s44, 0xa00000
    s_lshl_b32 s45, s45, 12
    s_add_u32 m0, s45, 32768
    s_nop 0
    buffer_load_dwordx4 v1, s[4:7], s44 offen offset:0 sc1 lds
    buffer_load_dwordx4 v1, s[4:7], s44 offen offset:1024 sc1 lds
    buffer_load_dwordx4 v1, s[4:7], s44 offen offset:2048 sc1 lds
    buffer_load_dwordx4 v1, s[4:7], s44 offen offset:3072 sc1 lds
    s_add_u32 s45, s28, 4
    s_add_u32 s44, s45, s34
    s_and_b32 s44, s44, 31
    s_lshl_b32 s44, s44, 12
    s_add_u32 s44, s44, s51
    s_add_u32 s44, s44, 0xa00000
    s_lshl_b32 s45, s45, 12
    s_add_u32 m0, s45, 32768
    s_nop 0
    buffer_load_dwordx4 v1, s[4:7], s44 offen offset:0 sc1 lds
    buffer_load_dwordx4 v1, s[4:7], s44 offen offset:1024 sc1 lds
    buffer_load_dwordx4 v1, s[4:7], s44 offen offset:2048 sc1 lds
    buffer_load_dwordx4 v1, s[4:7], s44 offen offset:3072 sc1 lds
    s_add_u32 s45, s28, 8
    s_add_u32 s44, s45, s34
    s_and_b32 s44, s44, 31
    s_lshl_b32 s44, s44, 12
    s_add_u32 s44, s44, s51
    s_add_u32 s44, s44, 0xa00000
    s_lshl_b32 s45, s45, 12
    s_add_u32 m0, s45, 32768
    s_nop 0
    buffer_load_dwordx4 v1, s[4:7], s44 offen offset:0 sc1 lds
    buffer_load_dwordx4 v1, s[4:7], s44 offen offset:1024 sc1 lds
    buffer_load_dwordx4 v1, s[4:7], s44 offen offset:2048 sc1 lds
    buffer_load_dwordx4 v1, s[4:7], s44 offen offset:3072 sc1 lds
    s_add_u32 s45, s28, 12
    s_add_u32 s44, s45, s34
    s_and_b32 s44, s44, 31
    s_lshl_b32 s44, s44, 12
    s_add_u32 s44, s44, s51
    s_add_u32 s44, s44, 0xa00000
    s_lshl_b32 s45, s45, 12
    s_add_u32 m0, s45, 32768
    s_nop 0
    buffer_load_dwordx4 v1, s[4:7], s44 offen offset:0 sc1 lds
    buffer_load_dwordx4 v1, s[4:7], s44 offen offset:1024 sc1 lds
    buffer_load_dwordx4 v1, s[4:7], s44 offen offset:2048 sc1 lds
    buffer_load_dwordx4 v1, s[4:7], s44 offen offset:3072 sc1 lds
    s_add_u32 s45, s28, 16
    s_add_u32 s44, s45, s34
    s_and_b32 s44, s44, 31
    s_lshl_b32 s44, s44, 12
    s_add_u32 s44, s44, s51
    s_add_u32 s44, s44, 0xa00000
    s_lshl_b32 s45, s45, 12
    s_add_u32 m0, s45, 32768
    s_nop 0
    buffer_load_dwordx4 v1, s[4:7], s44 offen offset:0 sc1 lds
    buffer_load_dwordx4 v1, s[4:7], s44 offen offset:1024 sc1 lds
    buffer_load_dwordx4 v1, s[4:7], s44 offen offset:2048 sc1 lds
    buffer_load_dwordx4 v1, s[4:7], s44 offen offset:3072 sc1 lds
    s_add_u32 s45, s28, 20
    s_add_u32 s44, s45, s34
    s_and_b32 s44, s44, 31
    s_lshl_b32 s44, s44, 12
    s_add_u32 s44, s44, s51
    s_add_u32 s44, s44, 0xa00000
    s_lshl_b32 s45, s45, 12
    s_add_u32 m0, s45, 32768
    s_nop 0
    buffer_load_dwordx4 v1, s[4:7], s44 offen offset:0 sc1 lds
    buffer_load_dwordx4 v1, s[4:7], s44 offen offset:1024 sc1 lds
    buffer_load_dwordx4 v1, s[4:7], s44 offen offset:2048 sc1 lds
    buffer_load_dwordx4 v1, s[4:7], s44 offen offset:3072 sc1 lds
    s_add_u32 s45, s28, 24
    s_add_u32 s44, s45, s34
    s_and_b32 s44, s44, 31
    s_lshl_b32 s44, s44, 12
    s_add_u32 s44, s44, s51
    s_add_u32 s44, s44, 0xa00000
    s_lshl_b32 s45, s45, 12
    s_add_u32 m0, s45, 32768
    s_nop 0
    buffer_load_dwordx4 v1, s[4:7], s44 offen offset:0 sc1 lds
    buffer_load_dwordx4 v1, s[4:7], s44 offen offset:1024 sc1 lds
    buffer_load_dwordx4 v1, s[4:7], s44 offen offset:2048 sc1 lds
    buffer_load_dwordx4 v1, s[4:7], s44 offen offset:3072 sc1 lds
    s_add_u32 s45, s28, 28
    s_add_u32 s44, s45, s34
    s_and_b32 s44, s44, 31
    s_lshl_b32 s44, s44, 12
    s_add_u32 s44, s44, s51
    s_add_u32 s44, s44, 0xa00000
    s_lshl_b32 s45, s45, 12
    s_add_u32 m0, s45, 32768
    s_nop 0
    buffer_load_dwordx4 v1, s[4:7], s44 offen offset:0 sc1 lds
    buffer_load_dwordx4 v1, s[4:7], s44 offen offset:1024 sc1 lds
    buffer_load_dwordx4 v1, s[4:7], s44 offen offset:2048 sc1 lds
    buffer_load_dwordx4 v1, s[4:7], s44 offen offset:3072 sc1 lds
    s_add_u32 s40, s4, 0x1e00000
    s_addc_u32 s41, s5, 0
    s_lshl_b32 s35, s34, 12
    v_add_u32 v5, 32768, v1
    v_add_u32 v6, 98304, v1
    v_lshlrev_b32 v132, 16, v32
    v_and_b32 v133, 0xffff0000, v32
    v_lshlrev_b32 v134, 16, v33
    v_and_b32 v135, 0xffff0000, v33
    v_lshlrev_b32 v136, 16, v34
    v_and_b32 v137, 0xffff0000, v34
    v_lshlrev_b32 v138, 16, v35
    v_and_b32 v139, 0xffff0000, v35
    v_lshlrev_b32 v140, 16, v36
    v_and_b32 v141, 0xffff0000, v36
    v_lshlrev_b32 v142, 16, v37
    v_and_b32 v143, 0xffff0000, v37
    v_lshlrev_b32 v144, 16, v38
    v_and_b32 v145, 0xffff0000, v38
    v_lshlrev_b32 v146, 16, v39
    v_and_b32 v147, 0xffff0000, v39
    v_lshlrev_b32 v148, 16, v40
    v_and_b32 v149, 0xffff0000, v40
    v_lshlrev_b32 v150, 16, v41
    v_and_b32 v151, 0xffff0000, v41
    v_lshlrev_b32 v152, 16, v42
    v_and_b32 v153, 0xffff0000, v42
    v_lshlrev_b32 v154, 16, v43
    v_and_b32 v155, 0xffff0000, v43
    v_lshlrev_b32 v156, 16, v44
    v_and_b32 v157, 0xffff0000, v44
    v_lshlrev_b32 v158, 16, v45
    v_and_b32 v159, 0xffff0000, v45
    v_lshlrev_b32 v160, 16, v46
    v_and_b32 v161, 0xffff0000, v46
    v_lshlrev_b32 v162, 16, v47
    v_and_b32 v163, 0xffff0000, v47
    s_lshl_b32 s36, s31, 4
    s_add_u32 s36, s36, s32
    s_lshl_b32 s36, s36, 8
    v_mov_b32 v10, s36
    s_cmp_lg_u32 s28, 0
    s_cbranch_scc1 Lpe_9
    s_mov_b32 s36, 0x0
    s_mov_b32 s37, 0
Lpoll_8:
    buffer_load_dword v11, v10, s[4:7], s36 offen sc1
    s_add_u32 s37, s37, 1
    s_waitcnt vmcnt(0)
    v_cmp_gt_u32 vcc, 32, v11
    s_cbranch_vccz Lpe_9
    s_cmp_lt_u32 s37, 0x100000
    s_cbranch_scc1 Lpoll_8
Lpe_9:
    s_waitcnt vmcnt(0)
    s_barrier
    buffer_load_dwordx4 a[0:3], v4, s[40:43], s35 offen offset:0 sc1
    buffer_load_dwordx4 a[4:7], v4, s[40:43], s35 offen offset:1024 sc1
    s_add_u32 s35, s35, 4096
    s_and_b32 s35, s35, 0x1ffff
    buffer_load_dwordx4 a[8:11], v4, s[40:43], s35 offen offset:0 sc1
    buffer_load_dwordx4 a[12:15], v4, s[40:43], s35 offen offset:1024 sc1
    s_add_u32 s35, s35, 4096
    s_and_b32 s35, s35, 0x1ffff
    buffer_load_dwordx4 a[16:19], v4, s[40:43], s35 offen offset:0 sc1
    buffer_load_dwordx4 a[20:23], v4, s[40:43], s35 offen offset:1024 sc1
    s_add_u32 s35, s35, 4096
    s_and_b32 s35, s35, 0x1ffff
    buffer_load_dwordx4 a[24:27], v4, s[40:43], s35 offen offset:0 sc1
    buffer_load_dwordx4 a[28:31], v4, s[40:43], s35 offen offset:1024 sc1
    s_add_u32 s35, s35, 4096
    s_and_b32 s35, s35, 0x1ffff
    buffer_load_dwordx4 a[32:35], v4, s[40:43], s35 offen offset:0 sc1
    buffer_load_dwordx4 a[36:39], v4, s[40:43], s35 offen offset:1024 sc1
    s_add_u32 s35, s35, 4096
    s_and_b32 s35, s35, 0x1ffff
    ds_read_b128 a[80:83], v5 offset:0
    ds_read_b128 a[84:87], v5 offset:1024
    ds_read_b128 a[88:91], v5 offset:2048
    ds_read_b128 a[92:95], v5 offset:3072
    s_waitcnt vmcnt(8) lgkmcnt(0)
    v_mfma_f32_16x16x32_bf16 v[132:135], a[80:83], a[0:3], v[132:135]
    ds_read_b128 a[96:99], v5 offset:4096
    v_mfma_f32_16x16x32_bf16 v[148:151], a[80:83], a[4:7], v[148:151]
    ds_read_b128 a[100:103], v5 offset:5120
    v_mfma_f32_16x16x32_bf16 v[136:139], a[84:87], a[0:3], v[136:139]
    ds_read_b128 a[104:107], v5 offset:6144
    v_mfma_f32_16x16x32_bf16 v[152:155], a[84:87], a[4:7], v[152:155]
    ds_read_b128 a[108:111], v5 offset:7168
    v_mfma_f32_16x16x32_bf16 v[140:143], a[88:91], a[0:3], v[140:143]
    buffer_load_dwordx4 a[40:43], v4, s[40:43], s35 offen offset:0 sc1
    v_mfma_f32_16x16x32_bf16 v[156:159], a[88:91], a[4:7], v[156:159]
    v_mfma_f32_16x16x32_bf16 v[144:147], a[92:95], a[0:3], v[144:147]
    buffer_load_dwordx4 a[44:47], v4, s[40:43], s35 offen offset:1024 sc1
    s_add_u32 s35, s35, 4096
    s_and_b32 s35, s35, 0x1ffff
    v_mfma_f32_16x16x32_bf16 v[160:163], a[92:95], a[4:7], v[160:163]
    s_waitcnt vmcnt(8) lgkmcnt(0)
    v_mfma_f32_16x16x32_bf16 v[132:135], a[96:99], a[8:11], v[132:135]
    ds_read_b128 a[80:83], v5 offset:8192
    v_mfma_f32_16x16x32_bf16 v[148:151], a[96:99], a[12:15], v[148:151]
    ds_read_b128 a[84:87], v5 offset:9216
    v_mfma_f32_16x16x32_bf16 v[136:139], a[100:103], a[8:11], v[136:139]
    ds_read_b128 a[88:91], v5 offset:10240
    v_mfma_f32_16x16x32_bf16 v[152:155], a[100:103], a[12:15], v[152:155]
    ds_read_b128 a[92:95], v5 offset:11264
    v_mfma_f32_16x16x32_bf16 v[140:143], a[104:107], a[8:11], v[140:143]
    buffer_load_dwordx4 a[0:3], v4, s[40:43], s35 offen offset:0 sc1
    v_mfma_f32_16x16x32_bf16 v[156:159], a[104:107], a[12:15], v[156:159]
    v_mfma_f32_16x16x32_bf16 v[144:147], a[108:111], a[8:11], v[144:147]
    buffer_load_dwordx4 a[4:7], v4, s[40:43], s35 offen offset:1024 sc1
    s_add_u32 s35, s35, 4096
    s_and_b32 s35, s35, 0x1ffff
    v_mfma_f32_16x16x32_bf16 v[160:163], a[108:111], a[12:15], v[160:163]
    s_waitcnt vmcnt(8) lgkmcnt(0)
    v_mfma_f32_16x16x32_bf16 v[132:135], a[80:83], a[16:19], v[132:135]
    ds_read_b128 a[96:99], v5 offset:12288
    v_mfma_f32_16x16x32_bf16 v[148:151], a[80:83], a[20:23], v[148:151]
    ds_read_b128 a[100:103], v5 offset:13312
    v_mfma_f32_16x16x32_bf16 v[136:139], a[84:87], a[16:19], v[136:139]
    ds_read_b128 a[104:107], v5 offset:14336
    v_mfma_f32_16x16x32_bf16 v[152:155], a[84:87], a[20:23], v[152:155]
    ds_read_b128 a[108:111], v5 offset:15360
    v_mfma_f32_16x16x32_bf16 v[140:143], a[88:91], a[16:19], v[140:143]
    buffer_load_dwordx4 a[8:11], v4, s[40:43], s35 offen offset:0 sc1
    v_mfma_f32_16x16x32_bf16 v[156:159], a[88:91], a[20:23], v[156:159]
    v_mfma_f32_16x16x32_bf16 v[144:147], a[92:95], a[16:19], v[144:147]
    buffer_load_dwordx4 a[12:15], v4, s[40:43], s35 offen offset:1024 sc1
    s_add_u32 s35, s35, 4096
    s_and_b32 s35, s35, 0x1ffff
    v_mfma_f32_16x16x32_bf16 v[160:163], a[92:95], a[20:23], v[160:163]
    s_waitcnt vmcnt(8) lgkmcnt(0)
    v_mfma_f32_16x16x32_bf16 v[132:135], a[96:99], a[24:27], v[132:135]
    ds_read_b128 a[80:83], v5 offset:16384
    v_mfma_f32_16x16x32_bf16 v[148:151], a[96:99], a[28:31], v[148:151]
    ds_read_b128 a[84:87], v5 offset:17408
    v_mfma_f32_16x16x32_bf16 v[136:139], a[100:103], a[24:27], v[136:139]
    ds_read_b128 a[88:91], v5 offset:18432
    v_mfma_f32_16x16x32_bf16 v[152:155], a[100:103], a[28:31], v[152:155]
    ds_read_b128 a[92:95], v5 offset:19456
    v_mfma_f32_16x16x32_bf16 v[140:143], a[104:107], a[24:27], v[140:143]
    buffer_load_dwordx4 a[16:19], v4, s[40:43], s35 offen offset:0 sc1
    v_mfma_f32_16x16x32_bf16 v[156:159], a[104:107], a[28:31], v[156:159]
    v_mfma_f32_16x16x32_bf16 v[144:147], a[108:111], a[24:27], v[144:147]
    buffer_load_dwordx4 a[20:23], v4, s[40:43], s35 offen offset:1024 sc1
    s_add_u32 s35, s35, 4096
    s_and_b32 s35, s35, 0x1ffff
    v_mfma_f32_16x16x32_bf16 v[160:163], a[108:111], a[28:31], v[160:163]
    s_waitcnt vmcnt(8) lgkmcnt(0)
    v_mfma_f32_16x16x32_bf16 v[132:135], a[80:83], a[32:35], v[132:135]
    ds_read_b128 a[96:99], v5 offset:20480
    v_mfma_f32_16x16x32_bf16 v[148:151], a[80:83], a[36:39], v[148:151]
    ds_read_b128 a[100:103], v5 offset:21504
    v_mfma_f32_16x16x32_bf16 v[136:139], a[84:87], a[32:35], v[136:139]
    ds_read_b128 a[104:107], v5 offset:22528
    v_mfma_f32_16x16x32_bf16 v[152:155], a[84:87], a[36:39], v[152:155]
    ds_read_b128 a[108:111], v5 offset:23552
    v_mfma_f32_16x16x32_bf16 v[140:143], a[88:91], a[32:35], v[140:143]
    buffer_load_dwordx4 a[24:27], v4, s[40:43], s35 offen offset:0 sc1
    v_mfma_f32_16x16x32_bf16 v[156:159], a[88:91], a[36:39], v[156:159]
    v_mfma_f32_16x16x32_bf16 v[144:147], a[92:95], a[32:35], v[144:147]
    buffer_load_dwordx4 a[28:31], v4, s[40:43], s35 offen offset:1024 sc1
    s_add_u32 s35, s35, 4096
    s_and_b32 s35, s35, 0x1ffff
    v_mfma_f32_16x16x32_bf16 v[160:163], a[92:95], a[36:39], v[160:163]
    s_waitcnt vmcnt(8) lgkmcnt(0)
    v_mfma_f32_16x16x32_bf16 v[132:135], a[96:99], a[40:43], v[132:135]
    ds_read_b128 a[80:83], v5 offset:24576
    v_mfma_f32_16x16x32_bf16 v[148:151], a[96:99], a[44:47], v[148:151]
    ds_read_b128 a[84:87], v5 offset:25600
    v_mfma_f32_16x16x32_bf16 v[136:139], a[100:103], a[40:43], v[136:139]
    ds_read_b128 a[88:91], v5 offset:26624
    v_mfma_f32_16x16x32_bf16 v[152:155], a[100:103], a[44:47], v[152:155]
    ds_read_b128 a[92:95], v5 offset:27648
    v_mfma_f32_16x16x32_bf16 v[140:143], a[104:107], a[40:43], v[140:143]
    buffer_load_dwordx4 a[32:35], v4, s[40:43], s35 offen offset:0 sc1
    v_mfma_f32_16x16x32_bf16 v[156:159], a[104:107], a[44:47], v[156:159]
    v_mfma_f32_16x16x32_bf16 v[144:147], a[108:111], a[40:43], v[144:147]
    buffer_load_dwordx4 a[36:39], v4, s[40:43], s35 offen offset:1024 sc1
    s_add_u32 s35, s35, 4096
    s_and_b32 s35, s35, 0x1ffff
    v_mfma_f32_16x16x32_bf16 v[160:163], a[108:111], a[44:47], v[160:163]
    s_waitcnt vmcnt(8) lgkmcnt(0)
    v_mfma_f32_16x16x32_bf16 v[132:135], a[80:83], a[0:3], v[132:135]
    ds_read_b128 a[96:99], v5 offset:28672
    v_mfma_f32_16x16x32_bf16 v[148:151], a[80:83], a[4:7], v[148:151]
    ds_read_b128 a[100:103], v5 offset:29696
    v_mfma_f32_16x16x32_bf16 v[136:139], a[84:87], a[0:3], v[136:139]
    ds_read_b128 a[104:107], v5 offset:30720
    v_mfma_f32_16x16x32_bf16 v[152:155], a[84:87], a[4:7], v[152:155]
    ds_read_b128 a[108:111], v5 offset:31744
    v_mfma_f32_16x16x32_bf16 v[140:143], a[88:91], a[0:3], v[140:143]
    buffer_load_dwordx4 a[40:43], v4, s[40:43], s35 offen offset:0 sc1
    v_mfma_f32_16x16x32_bf16 v[156:159], a[88:91], a[4:7], v[156:159]
    v_mfma_f32_16x16x32_bf16 v[144:147], a[92:95], a[0:3], v[144:147]
    buffer_load_dwordx4 a[44:47], v4, s[40:43], s35 offen offset:1024 sc1
    s_add_u32 s35, s35, 4096
    s_and_b32 s35, s35, 0x1ffff
    v_mfma_f32_16x16x32_bf16 v[160:163], a[92:95], a[4:7], v[160:163]
    s_waitcnt vmcnt(8) lgkmcnt(0)
    v_mfma_f32_16x16x32_bf16 v[132:135], a[96:99], a[8:11], v[132:135]
    ds_read_b128 a[80:83], v5 offset:32768
    v_mfma_f32_16x16x32_bf16 v[148:151], a[96:99], a[12:15], v[148:151]
    ds_read_b128 a[84:87], v5 offset:33792
    v_mfma_f32_16x16x32_bf16 v[136:139], a[100:103], a[8:11], v[136:139]
    ds_read_b128 a[88:91], v5 offset:34816
    v_mfma_f32_16x16x32_bf16 v[152:155], a[100:103], a[12:15], v[152:155]
    ds_read_b128 a[92:95], v5 offset:35840
    v_mfma_f32_16x16x32_bf16 v[140:143], a[104:107], a[8:11], v[140:143]
    buffer_load_dwordx4 a[0:3], v4, s[40:43], s35 offen offset:0 sc1
    v_mfma_f32_16x16x32_bf16 v[156:159], a[104:107], a[12:15], v[156:159]
    v_mfma_f32_16x16x32_bf16 v[144:147], a[108:111], a[8:11], v[144:147]
    buffer_load_dwordx4 a[4:7], v4, s[40:43], s35 offen offset:1024 sc1
    s_add_u32 s35, s35, 4096
    s_and_b32 s35, s35, 0x1ffff
    v_mfma_f32_16x16x32_bf16 v[160:163], a[108:111], a[12:15], v[160:163]
    s_waitcnt vmcnt(8) lgkmcnt(0)
    v_mfma_f32_16x16x32_bf16 v[132:135], a[80:83], a[16:19], v[132:135]
    ds_read_b128 a[96:99], v5 offset:36864
    v_mfma_f32_16x16x32_bf16 v[148:151], a[80:83], a[20:23], v[148:151]
    ds_read_b128 a[100:103], v5 offset:37888
    v_mfma_f32_16x16x32_bf16 v[136:139], a[84:87], a[16:19], v[136:139]
    ds_read_b128 a[104:107], v5 offset:38912
    v_mfma_f32_16x16x32_bf16 v[152:155], a[84:87], a[20:23], v[152:155]
    ds_read_b128 a[108:111], v5 offset:39936
    v_mfma_f32_16x16x32_bf16 v[140:143], a[88:91], a[16:19], v[140:143]
    buffer_load_dwordx4 a[8:11], v4, s[40:43], s35 offen offset:0 sc1
    v_mfma_f32_16x16x32_bf16 v[156:159], a[88:91], a[20:23], v[156:159]
    v_mfma_f32_16x16x32_bf16 v[144:147], a[92:95], a[16:19], v[144:147]
    buffer_load_dwordx4 a[12:15], v4, s[40:43], s35 offen offset:1024 sc1
    s_add_u32 s35, s35, 4096
    s_and_b32 s35, s35, 0x1ffff
    v_mfma_f32_16x16x32_bf16 v[160:163], a[92:95], a[20:23], v[160:163]
    s_waitcnt vmcnt(8) lgkmcnt(0)
    v_mfma_f32_16x16x32_bf16 v[132:135], a[96:99], a[24:27], v[132:135]
    ds_read_b128 a[80:83], v5 offset:40960
    v_mfma_f32_16x16x32_bf16 v[148:151], a[96:99], a[28:31], v[148:151]
    ds_read_b128 a[84:87], v5 offset:41984
    v_mfma_f32_16x16x32_bf16 v[136:139], a[100:103], a[24:27], v[136:139]
    ds_read_b128 a[88:91], v5 offset:43008
    v_mfma_f32_16x16x32_bf16 v[152:155], a[100:103], a[28:31], v[152:155]
    ds_read_b128 a[92:95], v5 offset:44032
    v_mfma_f32_16x16x32_bf16 v[140:143], a[104:107], a[24:27], v[140:143]
    buffer_load_dwordx4 a[16:19], v4, s[40:43], s35 offen offset:0 sc1
    v_mfma_f32_16x16x32_bf16 v[156:159], a[104:107], a[28:31], v[156:159]
    v_mfma_f32_16x16x32_bf16 v[144:147], a[108:111], a[24:27], v[144:147]
    buffer_load_dwordx4 a[20:23], v4, s[40:43], s35 offen offset:1024 sc1
    s_add_u32 s35, s35, 4096
    s_and_b32 s35, s35, 0x1ffff
    v_mfma_f32_16x16x32_bf16 v[160:163], a[108:111], a[28:31], v[160:163]
    s_waitcnt vmcnt(8) lgkmcnt(0)
    v_mfma_f32_16x16x32_bf16 v[132:135], a[80:83], a[32:35], v[132:135]
    ds_read_b128 a[96:99], v5 offset:45056
    v_mfma_f32_16x16x32_bf16 v[148:151], a[80:83], a[36:39], v[148:151]
    ds_read_b128 a[100:103], v5 offset:46080
    v_mfma_f32_16x16x32_bf16 v[136:139], a[84:87], a[32:35], v[136:139]
    ds_read_b128 a[104:107], v5 offset:47104
    v_mfma_f32_16x16x32_bf16 v[152:155], a[84:87], a[36:39], v[152:155]
    ds_read_b128 a[108:111], v5 offset:48128
    v_mfma_f32_16x16x32_bf16 v[140:143], a[88:91], a[32:35], v[140:143]
    buffer_load_dwordx4 a[24:27], v4, s[40:43], s35 offen offset:0 sc1
    v_mfma_f32_16x16x32_bf16 v[156:159], a[88:91], a[36:39], v[156:159]
    v_mfma_f32_16x16x32_bf16 v[144:147], a[92:95], a[32:35], v[144:147]
    buffer_load_dwordx4 a[28:31], v4, s[40:43], s35 offen offset:1024 sc1
    s_add_u32 s35, s35, 4096
    s_and_b32 s35, s35, 0x1ffff
    v_mfma_f32_16x16x32_bf16 v[160:163], a[92:95], a[36:39], v[160:163]
    s_waitcnt vmcnt(8) lgkmcnt(0)
    v_mfma_f32_16x16x32_bf16 v[132:135], a[96:99], a[40:43], v[132:135]
    ds_read_b128 a[80:83], v5 offset:49152
    v_mfma_f32_16x16x32_bf16 v[148:151], a[96:99], a[44:47], v[148:151]
    ds_read_b128 a[84:87], v5 offset:50176
    v_mfma_f32_16x16x32_bf16 v[136:139], a[100:103], a[40:43], v[136:139]
    ds_read_b128 a[88:91], v5 offset:51200
    v_mfma_f32_16x16x32_bf16 v[152:155], a[100:103], a[44:47], v[152:155]
    ds_read_b128 a[92:95], v5 offset:52224
    v_mfma_f32_16x16x32_bf16 v[140:143], a[104:107], a[40:43], v[140:143]
    buffer_load_dwordx4 a[32:35], v4, s[40:43], s35 offen offset:0 sc1
    v_mfma_f32_16x16x32_bf16 v[156:159], a[104:107], a[44:47], v[156:159]
    v_mfma_f32_16x16x32_bf16 v[144:147], a[108:111], a[40:43], v[144:147]
    buffer_load_dwordx4 a[36:39], v4, s[40:43], s35 offen offset:1024 sc1
    s_add_u32 s35, s35, 4096
    s_and_b32 s35, s35, 0x1ffff
    v_mfma_f32_16x16x32_bf16 v[160:163], a[108:111], a[44:47], v[160:163]
    s_waitcnt vmcnt(8) lgkmcnt(0)
    v_mfma_f32_16x16x32_bf16 v[132:135], a[80:83], a[0:3], v[132:135]
    ds_read_b128 a[96:99], v5 offset:53248
    v_mfma_f32_16x16x32_bf16 v[148:151], a[80:83], a[4:7], v[148:151]
    ds_read_b128 a[100:103], v5 offset:54272
    v_mfma_f32_16x16x32_bf16 v[136:139], a[84:87], a[0:3], v[136:139]
    ds_read_b128 a[104:107], v5 offset:55296
    v_mfma_f32_16x16x32_bf16 v[152:155], a[84:87], a[4:7], v[152:155]
    ds_read_b128 a[108:111], v5 offset:56320
    v_mfma_f32_16x16x32_bf16 v[140:143], a[88:91], a[0:3], v[140:143]
    buffer_load_dwordx4 a[40:43], v4, s[40:43], s35 offen offset:0 sc1
    v_mfma_f32_16x16x32_bf16 v[156:159], a[88:91], a[4:7], v[156:159]
    v_mfma_f32_16x16x32_bf16 v[144:147], a[92:95], a[0:3], v[144:147]
    buffer_load_dwordx4 a[44:47], v4, s[40:43], s35 offen offset:1024 sc1
    s_add_u32 s35, s35, 4096
    s_and_b32 s35, s35, 0x1ffff
    v_mfma_f32_16x16x32_bf16 v[160:163], a[92:95], a[4:7], v[160:163]
    s_waitcnt vmcnt(8) lgkmcnt(0)
    v_mfma_f32_16x16x32_bf16 v[132:135], a[96:99], a[8:11], v[132:135]
    ds_read_b128 a[80:83], v5 offset:57344
    v_mfma_f32_16x16x32_bf16 v[148:151], a[96:99], a[12:15], v[148:151]
    ds_read_b128 a[84:87], v5 offset:58368
    v_mfma_f32_16x16x32_bf16 v[136:139], a[100:103], a[8:11], v[136:139]
    ds_read_b128 a[88:91], v5 offset:59392
    v_mfma_f32_16x16x32_bf16 v[152:155], a[100:103], a[12:15], v[152:155]
    ds_read_b128 a[92:95], v5 offset:60416
    v_mfma_f32_16x16x32_bf16 v[140:143], a[104:107], a[8:11], v[140:143]
    buffer_load_dwordx4 a[0:3], v4, s[40:43], s35 offen offset:0 sc1
    v_mfma_f32_16x16x32_bf16 v[156:159], a[104:107], a[12:15], v[156:159]
    v_mfma_f32_16x16x32_bf16 v[144:147], a[108:111], a[8:11], v[144:147]
    buffer_load_dwordx4 a[4:7], v4, s[40:43], s35 offen offset:1024 sc1
    s_add_u32 s35, s35, 4096
    s_and_b32 s35, s35, 0x1ffff
    v_mfma_f32_16x16x32_bf16 v[160:163], a[108:111], a[12:15], v[160:163]
    s_waitcnt vmcnt(8) lgkmcnt(0)
    v_mfma_f32_16x16x32_bf16 v[132:135], a[80:83], a[16:19], v[132:135]
    ds_read_b128 a[96:99], v5 offset:61440
    v_mfma_f32_16x16x32_bf16 v[148:151], a[80:83], a[20:23], v[148:151]
    ds_read_b128 a[100:103], v5 offset:62464
    v_mfma_f32_16x16x32_bf16 v[136:139], a[84:87], a[16:19], v[136:139]
    ds_read_b128 a[104:107], v5 offset:63488
    v_mfma_f32_16x16x32_bf16 v[152:155], a[84:87], a[20:23], v[152:155]
    ds_read_b128 a[108:111], v5 offset:64512
    v_mfma_f32_16x16x32_bf16 v[140:143], a[88:91], a[16:19], v[140:143]
    buffer_load_dwordx4 a[8:11], v4, s[40:43], s35 offen offset:0 sc1
    v_mfma_f32_16x16x32_bf16 v[156:159], a[88:91], a[20:23], v[156:159]
    v_mfma_f32_16x16x32_bf16 v[144:147], a[92:95], a[16:19], v[144:147]
    buffer_load_dwordx4 a[12:15], v4, s[40:43], s35 offen offset:1024 sc1
    s_add_u32 s35, s35, 4096
    s_and_b32 s35, s35, 0x1ffff
    v_mfma_f32_16x16x32_bf16 v[160:163], a[92:95], a[20:23], v[160:163]
    s_waitcnt vmcnt(8) lgkmcnt(0)
    v_mfma_f32_16x16x32_bf16 v[132:135], a[96:99], a[24:27], v[132:135]
    ds_read_b128 a[80:83], v6 offset:0
    v_mfma_f32_16x16x32_bf16 v[148:151], a[96:99], a[28:31], v[148:151]
    ds_read_b128 a[84:87], v6 offset:1024
    v_mfma_f32_16x16x32_bf16 v[136:139], a[100:103], a[24:27], v[136:139]
    ds_read_b128 a[88:91], v6 offset:2048
    v_mfma_f32_16x16x32_bf16 v[152:155], a[100:103], a[28:31], v[152:155]
    ds_read_b128 a[92:95], v6 offset:3072
    v_mfma_f32_16x16x32_bf16 v[140:143], a[104:107], a[24:27], v[140:143]
    buffer_load_dwordx4 a[16:19], v4, s[40:43], s35 offen offset:0 sc1
    v_mfma_f32_16x16x32_bf16 v[156:159], a[104:107], a[28:31], v[156:159]
    v_mfma_f32_16x16x32_bf16 v[144:147], a[108:111], a[24:27], v[144:147]
    buffer_load_dwordx4 a[20:23], v4, s[40:43], s35 offen offset:1024 sc1
    s_add_u32 s35, s35, 4096
    s_and_b32 s35, s35, 0x1ffff
    v_mfma_f32_16x16x32_bf16 v[160:163], a[108:111], a[28:31], v[160:163]
    s_waitcnt vmcnt(8) lgkmcnt(0)
    v_mfma_f32_16x16x32_bf16 v[132:135], a[80:83], a[32:35], v[132:135]
    ds_read_b128 a[96:99], v6 offset:4096
    v_mfma_f32_16x16x32_bf16 v[148:151], a[80:83], a[36:39], v[148:151]
    ds_read_b128 a[100:103], v6 offset:5120
    v_mfma_f32_16x16x32_bf16 v[136:139], a[84:87], a[32:35], v[136:139]
    ds_read_b128 a[104:107], v6 offset:6144
    v_mfma_f32_16x16x32_bf16 v[152:155], a[84:87], a[36:39], v[152:155]
    ds_read_b128 a[108:111], v6 offset:7168
    v_mfma_f32_16x16x32_bf16 v[140:143], a[88:91], a[32:35], v[140:143]
    buffer_load_dwordx4 a[24:27], v4, s[40:43], s35 offen offset:0 sc1
    v_mfma_f32_16x16x32_bf16 v[156:159], a[88:91], a[36:39], v[156:159]
    v_mfma_f32_16x16x32_bf16 v[144:147], a[92:95], a[32:35], v[144:147]
    buffer_load_dwordx4 a[28:31], v4, s[40:43], s35 offen offset:1024 sc1
    s_add_u32 s35, s35, 4096
    s_and_b32 s35, s35, 0x1ffff
    v_mfma_f32_16x16x32_bf16 v[160:163], a[92:95], a[36:39], v[160:163]
    s_waitcnt vmcnt(8) lgkmcnt(0)
    v_mfma_f32_16x16x32_bf16 v[132:135], a[96:99], a[40:43], v[132:135]
    ds_read_b128 a[80:83], v6 offset:8192
    v_mfma_f32_16x16x32_bf16 v[148:151], a[96:99], a[44:47], v[148:151]
    ds_read_b128 a[84:87], v6 offset:9216
    v_mfma_f32_16x16x32_bf16 v[136:139], a[100:103], a[40:43], v[136:139]
    ds_read_b128 a[88:91], v6 offset:10240
    v_mfma_f32_16x16x32_bf16 v[152:155], a[100:103], a[44:47], v[152:155]
    ds_read_b128 a[92:95], v6 offset:11264
    v_mfma_f32_16x16x32_bf16 v[140:143], a[104:107], a[40:43], v[140:143]
    buffer_load_dwordx4 a[32:35], v4, s[40:43], s35 offen offset:0 sc1
    v_mfma_f32_16x16x32_bf16 v[156:159], a[104:107], a[44:47], v[156:159]
    v_mfma_f32_16x16x32_bf16 v[144:147], a[108:111], a[40:43], v[144:147]
    buffer_load_dwordx4 a[36:39], v4, s[40:43], s35 offen offset:1024 sc1
    s_add_u32 s35, s35, 4096
    s_and_b32 s35, s35, 0x1ffff
    v_mfma_f32_16x16x32_bf16 v[160:163], a[108:111], a[44:47], v[160:163]
    s_waitcnt vmcnt(8) lgkmcnt(0)
    v_mfma_f32_16x16x32_bf16 v[132:135], a[80:83], a[0:3], v[132:135]
    ds_read_b128 a[96:99], v6 offset:12288
    v_mfma_f32_16x16x32_bf16 v[148:151], a[80:83], a[4:7], v[148:151]
    ds_read_b128 a[100:103], v6 offset:13312
    v_mfma_f32_16x16x32_bf16 v[136:139], a[84:87], a[0:3], v[136:139]
    ds_read_b128 a[104:107], v6 offset:14336
    v_mfma_f32_16x16x32_bf16 v[152:155], a[84:87], a[4:7], v[152:155]
    ds_read_b128 a[108:111], v6 offset:15360
    v_mfma_f32_16x16x32_bf16 v[140:143], a[88:91], a[0:3], v[140:143]
    buffer_load_dwordx4 a[40:43], v4, s[40:43], s35 offen offset:0 sc1
    v_mfma_f32_16x16x32_bf16 v[156:159], a[88:91], a[4:7], v[156:159]
    v_mfma_f32_16x16x32_bf16 v[144:147], a[92:95], a[0:3], v[144:147]
    buffer_load_dwordx4 a[44:47], v4, s[40:43], s35 offen offset:1024 sc1
    s_add_u32 s35, s35, 4096
    s_and_b32 s35, s35, 0x1ffff
    v_mfma_f32_16x16x32_bf16 v[160:163], a[92:95], a[4:7], v[160:163]
    s_waitcnt vmcnt(8) lgkmcnt(0)
    v_mfma_f32_16x16x32_bf16 v[132:135], a[96:99], a[8:11], v[132:135]
    ds_read_b128 a[80:83], v6 offset:16384
    v_mfma_f32_16x16x32_bf16 v[148:151], a[96:99], a[12:15], v[148:151]
    ds_read_b128 a[84:87], v6 offset:17408
    v_mfma_f32_16x16x32_bf16 v[136:139], a[100:103], a[8:11], v[136:139]
    ds_read_b128 a[88:91], v6 offset:18432
    v_mfma_f32_16x16x32_bf16 v[152:155], a[100:103], a[12:15], v[152:155]
    ds_read_b128 a[92:95], v6 offset:19456
    v_mfma_f32_16x16x32_bf16 v[140:143], a[104:107], a[8:11], v[140:143]
    buffer_load_dwordx4 a[0:3], v4, s[40:43], s35 offen offset:0 sc1
    v_mfma_f32_16x16x32_bf16 v[156:159], a[104:107], a[12:15], v[156:159]
    v_mfma_f32_16x16x32_bf16 v[144:147], a[108:111], a[8:11], v[144:147]
    buffer_load_dwordx4 a[4:7], v4, s[40:43], s35 offen offset:1024 sc1
    s_add_u32 s35, s35, 4096
    s_and_b32 s35, s35, 0x1ffff
    v_mfma_f32_16x16x32_bf16 v[160:163], a[108:111], a[12:15], v[160:163]
    s_waitcnt vmcnt(8) lgkmcnt(0)
    v_mfma_f32_16x16x32_bf16 v[132:135], a[80:83], a[16:19], v[132:135]
    ds_read_b128 a[96:99], v6 offset:20480
    v_mfma_f32_16x16x32_bf16 v[148:151], a[80:83], a[20:23], v[148:151]
    ds_read_b128 a[100:103], v6 offset:21504
    v_mfma_f32_16x16x32_bf16 v[136:139], a[84:87], a[16:19], v[136:139]
    ds_read_b128 a[104:107], v6 offset:22528
    v_mfma_f32_16x16x32_bf16 v[152:155], a[84:87], a[20:23], v[152:155]
    ds_read_b128 a[108:111], v6 offset:23552
    v_mfma_f32_16x16x32_bf16 v[140:143], a[88:91], a[16:19], v[140:143]
    buffer_load_dwordx4 a[8:11], v4, s[40:43], s35 offen offset:0 sc1
    v_mfma_f32_16x16x32_bf16 v[156:159], a[88:91], a[20:23], v[156:159]
    v_mfma_f32_16x16x32_bf16 v[144:147], a[92:95], a[16:19], v[144:147]
    buffer_load_dwordx4 a[12:15], v4, s[40:43], s35 offen offset:1024 sc1
    s_add_u32 s35, s35, 4096
    s_and_b32 s35, s35, 0x1ffff
    v_mfma_f32_16x16x32_bf16 v[160:163], a[92:95], a[20:23], v[160:163]
    s_waitcnt vmcnt(8) lgkmcnt(0)
    v_mfma_f32_16x16x32_bf16 v[132:135], a[96:99], a[24:27], v[132:135]
    ds_read_b128 a[80:83], v6 offset:24576
    v_mfma_f32_16x16x32_bf16 v[148:151], a[96:99], a[28:31], v[148:151]
    ds_read_b128 a[84:87], v6 offset:25600
    v_mfma_f32_16x16x32_bf16 v[136:139], a[100:103], a[24:27], v[136:139]
    ds_read_b128 a[88:91], v6 offset:26624
    v_mfma_f32_16x16x32_bf16 v[152:155], a[100:103], a[28:31], v[152:155]
    ds_read_b128 a[92:95], v6 offset:27648
    v_mfma_f32_16x16x32_bf16 v[140:143], a[104:107], a[24:27], v[140:143]
    buffer_load_dwordx4 a[16:19], v4, s[40:43], s35 offen offset:0 sc1
    v_mfma_f32_16x16x32_bf16 v[156:159], a[104:107], a[28:31], v[156:159]
    v_mfma_f32_16x16x32_bf16 v[144:147], a[108:111], a[24:27], v[144:147]
    buffer_load_dwordx4 a[20:23], v4, s[40:43], s35 offen offset:1024 sc1
    s_add_u32 s35, s35, 4096
    s_and_b32 s35, s35, 0x1ffff
    v_mfma_f32_16x16x32_bf16 v[160:163], a[108:111], a[28:31], v[160:163]
    s_waitcnt vmcnt(8) lgkmcnt(0)
    v_mfma_f32_16x16x32_bf16 v[132:135], a[80:83], a[32:35], v[132:135]
    ds_read_b128 a[96:99], v6 offset:28672
    v_mfma_f32_16x16x32_bf16 v[148:151], a[80:83], a[36:39], v[148:151]
    ds_read_b128 a[100:103], v6 offset:29696
    v_mfma_f32_16x16x32_bf16 v[136:139], a[84:87], a[32:35], v[136:139]
    ds_read_b128 a[104:107], v6 offset:30720
    v_mfma_f32_16x16x32_bf16 v[152:155], a[84:87], a[36:39], v[152:155]
    ds_read_b128 a[108:111], v6 offset:31744
    v_mfma_f32_16x16x32_bf16 v[140:143], a[88:91], a[32:35], v[140:143]
    buffer_load_dwordx4 a[24:27], v4, s[40:43], s35 offen offset:0 sc1
    v_mfma_f32_16x16x32_bf16 v[156:159], a[88:91], a[36:39], v[156:159]
    v_mfma_f32_16x16x32_bf16 v[144:147], a[92:95], a[32:35], v[144:147]
    buffer_load_dwordx4 a[28:31], v4, s[40:43], s35 offen offset:1024 sc1
    s_add_u32 s35, s35, 4096
    s_and_b32 s35, s35, 0x1ffff
    v_mfma_f32_16x16x32_bf16 v[160:163], a[92:95], a[36:39], v[160:163]
    s_waitcnt vmcnt(8) lgkmcnt(0)
    v_mfma_f32_16x16x32_bf16 v[132:135], a[96:99], a[40:43], v[132:135]
    ds_read_b128 a[80:83], v6 offset:32768
    v_mfma_f32_16x16x32_bf16 v[148:151], a[96:99], a[44:47], v[148:151]
    ds_read_b128 a[84:87], v6 offset:33792
    v_mfma_f32_16x16x32_bf16 v[136:139], a[100:103], a[40:43], v[136:139]
    ds_read_b128 a[88:91], v6 offset:34816
    v_mfma_f32_16x16x32_bf16 v[152:155], a[100:103], a[44:47], v[152:155]
    ds_read_b128 a[92:95], v6 offset:35840
    v_mfma_f32_16x16x32_bf16 v[140:143], a[104:107], a[40:43], v[140:143]
    buffer_load_dwordx4 a[32:35], v4, s[40:43], s35 offen offset:0 sc1
    v_mfma_f32_16x16x32_bf16 v[156:159], a[104:107], a[44:47], v[156:159]
    v_mfma_f32_16x16x32_bf16 v[144:147], a[108:111], a[40:43], v[144:147]
    buffer_load_dwordx4 a[36:39], v4, s[40:43], s35 offen offset:1024 sc1
    s_add_u32 s35, s35, 4096
    s_and_b32 s35, s35, 0x1ffff
    v_mfma_f32_16x16x32_bf16 v[160:163], a[108:111], a[44:47], v[160:163]
    s_waitcnt vmcnt(8) lgkmcnt(0)
    v_mfma_f32_16x16x32_bf16 v[132:135], a[80:83], a[0:3], v[132:135]
    ds_read_b128 a[96:99], v6 offset:36864
    v_mfma_f32_16x16x32_bf16 v[148:151], a[80:83], a[4:7], v[148:151]
    ds_read_b128 a[100:103], v6 offset:37888
    v_mfma_f32_16x16x32_bf16 v[136:139], a[84:87], a[0:3], v[136:139]
    ds_read_b128 a[104:107], v6 offset:38912
    v_mfma_f32_16x16x32_bf16 v[152:155], a[84:87], a[4:7], v[152:155]
    ds_read_b128 a[108:111], v6 offset:39936
    v_mfma_f32_16x16x32_bf16 v[140:143], a[88:91], a[0:3], v[140:143]
    buffer_load_dwordx4 a[40:43], v4, s[40:43], s35 offen offset:0 sc1
    v_mfma_f32_16x16x32_bf16 v[156:159], a[88:91], a[4:7], v[156:159]
    v_mfma_f32_16x16x32_bf16 v[144:147], a[92:95], a[0:3], v[144:147]
    buffer_load_dwordx4 a[44:47], v4, s[40:43], s35 offen offset:1024 sc1
    s_add_u32 s35, s35, 4096
    s_and_b32 s35, s35, 0x1ffff
    v_mfma_f32_16x16x32_bf16 v[160:163], a[92:95], a[4:7], v[160:163]
    s_waitcnt vmcnt(8) lgkmcnt(0)
    v_mfma_f32_16x16x32_bf16 v[132:135], a[96:99], a[8:11], v[132:135]
    ds_read_b128 a[80:83], v6 offset:40960
    v_mfma_f32_16x16x32_bf16 v[148:151], a[96:99], a[12:15], v[148:151]
    ds_read_b128 a[84:87], v6 offset:41984
    v_mfma_f32_16x16x32_bf16 v[136:139], a[100:103], a[8:11], v[136:139]
    ds_read_b128 a[88:91], v6 offset:43008
    v_mfma_f32_16x16x32_bf16 v[152:155], a[100:103], a[12:15], v[152:155]
    ds_read_b128 a[92:95], v6 offset:44032
    v_mfma_f32_16x16x32_bf16 v[140:143], a[104:107], a[8:11], v[140:143]
    buffer_load_dwordx4 a[0:3], v4, s[40:43], s35 offen offset:0 sc1
    v_mfma_f32_16x16x32_bf16 v[156:159], a[104:107], a[12:15], v[156:159]
    v_mfma_f32_16x16x32_bf16 v[144:147], a[108:111], a[8:11], v[144:147]
    buffer_load_dwordx4 a[4:7], v4, s[40:43], s35 offen offset:1024 sc1
    s_add_u32 s35, s35, 4096
    s_and_b32 s35, s35, 0x1ffff
    v_mfma_f32_16x16x32_bf16 v[160:163], a[108:111], a[12:15], v[160:163]
    s_waitcnt vmcnt(8) lgkmcnt(0)
    v_mfma_f32_16x16x32_bf16 v[132:135], a[80:83], a[16:19], v[132:135]
    ds_read_b128 a[96:99], v6 offset:45056
    v_mfma_f32_16x16x32_bf16 v[148:151], a[80:83], a[20:23], v[148:151]
    ds_read_b128 a[100:103], v6 offset:46080
    v_mfma_f32_16x16x32_bf16 v[136:139], a[84:87], a[16:19], v[136:139]
    ds_read_b128 a[104:107], v6 offset:47104
    v_mfma_f32_16x16x32_bf16 v[152:155], a[84:87], a[20:23], v[152:155]
    ds_read_b128 a[108:111], v6 offset:48128
    v_mfma_f32_16x16x32_bf16 v[140:143], a[88:91], a[16:19], v[140:143]
    buffer_load_dwordx4 a[8:11], v4, s[40:43], s35 offen offset:0 sc1
    v_mfma_f32_16x16x32_bf16 v[156:159], a[88:91], a[20:23], v[156:159]
    v_mfma_f32_16x16x32_bf16 v[144:147], a[92:95], a[16:19], v[144:147]
    buffer_load_dwordx4 a[12:15], v4, s[40:43], s35 offen offset:1024 sc1
    s_add_u32 s35, s35, 4096
    s_and_b32 s35, s35, 0x1ffff
    v_mfma_f32_16x16x32_bf16 v[160:163], a[92:95], a[20:23], v[160:163]
    s_waitcnt vmcnt(8) lgkmcnt(0)
    v_mfma_f32_16x16x32_bf16 v[132:135], a[96:99], a[24:27], v[132:135]
    ds_read_b128 a[80:83], v6 offset:49152
    v_mfma_f32_16x16x32_bf16 v[148:151], a[96:99], a[28:31], v[148:151]
    ds_read_b128 a[84:87], v6 offset:50176
    v_mfma_f32_16x16x32_bf16 v[136:139], a[100:103], a[24:27], v[136:139]
    ds_read_b128 a[88:91], v6 offset:51200
    v_mfma_f32_16x16x32_bf16 v[152:155], a[100:103], a[28:31], v[152:155]
    ds_read_b128 a[92:95], v6 offset:52224
    v_mfma_f32_16x16x32_bf16 v[140:143], a[104:107], a[24:27], v[140:143]
    v_mfma_f32_16x16x32_bf16 v[156:159], a[104:107], a[28:31], v[156:159]
    v_mfma_f32_16x16x32_bf16 v[144:147], a[108:111], a[24:27], v[144:147]
    v_mfma_f32_16x16x32_bf16 v[160:163], a[108:111], a[28:31], v[160:163]
    s_waitcnt vmcnt(6) lgkmcnt(0)
    v_mfma_f32_16x16x32_bf16 v[132:135], a[80:83], a[32:35], v[132:135]
    ds_read_b128 a[96:99], v6 offset:53248
    v_mfma_f32_16x16x32_bf16 v[148:151], a[80:83], a[36:39], v[148:151]
    ds_read_b128 a[100:103], v6 offset:54272
    v_mfma_f32_16x16x32_bf16 v[136:139], a[84:87], a[32:35], v[136:139]
    ds_read_b128 a[104:107], v6 offset:55296
    v_mfma_f32_16x16x32_bf16 v[152:155], a[84:87], a[36:39], v[152:155]
    ds_read_b128 a[108:111], v6 offset:56320
    v_mfma_f32_16x16x32_bf16 v[140:143], a[88:91], a[32:35], v[140:143]
    v_mfma_f32_16x16x32_bf16 v[156:159], a[88:91], a[36:39], v[156:159]
    v_mfma_f32_16x16x32_bf16 v[144:147], a[92:95], a[32:35], v[144:147]
    v_mfma_f32_16x16x32_bf16 v[160:163], a[92:95], a[36:39], v[160:163]
    s_waitcnt vmcnt(4) lgkmcnt(0)
    v_mfma_f32_16x16x32_bf16 v[132:135], a[96:99], a[40:43], v[132:135]
    ds_read_b128 a[80:83], v6 offset:57344
    v_mfma_f32_16x16x32_bf16 v[148:151], a[96:99], a[44:47], v[148:151]
    ds_read_b128 a[84:87], v6 offset:58368
    v_mfma_f32_16x16x32_bf16 v[136:139], a[100:103], a[40:43], v[136:139]
    ds_read_b128 a[88:91], v6 offset:59392
    v_mfma_f32_16x16x32_bf16 v[152:155], a[100:103], a[44:47], v[152:155]
    ds_read_b128 a[92:95], v6 offset:60416
    v_mfma_f32_16x16x32_bf16 v[140:143], a[104:107], a[40:43], v[140:143]
    v_mfma_f32_16x16x32_bf16 v[156:159], a[104:107], a[44:47], v[156:159]
    v_mfma_f32_16x16x32_bf16 v[144:147], a[108:111], a[40:43], v[144:147]
    v_mfma_f32_16x16x32_bf16 v[160:163], a[108:111], a[44:47], v[160:163]
    s_waitcnt vmcnt(2) lgkmcnt(0)
    v_mfma_f32_16x16x32_bf16 v[132:135], a[80:83], a[0:3], v[132:135]
    ds_read_b128 a[96:99], v6 offset:61440
    v_mfma_f32_16x16x32_bf16 v[148:151], a[80:83], a[4:7], v[148:151]
    ds_read_b128 a[100:103], v6 offset:62464
    v_mfma_f32_16x16x32_bf16 v[136:139], a[84:87], a[0:3], v[136:139]
    ds_read_b128 a[104:107], v6 offset:63488
    v_mfma_f32_16x16x32_bf16 v[152:155], a[84:87], a[4:7], v[152:155]
    ds_read_b128 a[108:111], v6 offset:64512
    v_mfma_f32_16x16x32_bf16 v[140:143], a[88:91], a[0:3], v[140:143]
    v_mfma_f32_16x16x32_bf16 v[156:159], a[88:91], a[4:7], v[156:159]
    v_mfma_f32_16x16x32_bf16 v[144:147], a[92:95], a[0:3], v[144:147]
    v_mfma_f32_16x16x32_bf16 v[160:163], a[92:95], a[4:7], v[160:163]
    s_waitcnt vmcnt(0) lgkmcnt(0)
    s_barrier
    v_mfma_f32_16x16x32_bf16 v[132:135], a[96:99], a[8:11], v[132:135]
    v_mfma_f32_16x16x32_bf16 v[148:151], a[96:99], a[12:15], v[148:151]
    v_mfma_f32_16x16x32_bf16 v[136:139], a[100:103], a[8:11], v[136:139]
    v_mfma_f32_16x16x32_bf16 v[152:155], a[100:103], a[12:15], v[152:155]
    v_mfma_f32_16x16x32_bf16 v[140:143], a[104:107], a[8:11], v[140:143]
    v_mfma_f32_16x16x32_bf16 v[156:159], a[104:107], a[12:15], v[156:159]
    v_mfma_f32_16x16x32_bf16 v[144:147], a[108:111], a[8:11], v[144:147]
    v_mfma_f32_16x16x32_bf16 v[160:163], a[108:111], a[12:15], v[160:163]
    s_nop 0
    v_cvt_pk_bf16_f32 v32, v132, v133
    v_cvt_pk_bf16_f32 v33, v134, v135
    v_cvt_pk_bf16_f32 v34, v136, v137
    v_cvt_pk_bf16_f32 v35, v138, v139
    v_cvt_pk_bf16_f32 v36, v140, v141
    v_cvt_pk_bf16_f32 v37, v142, v143
    v_cvt_pk_bf16_f32 v38, v144, v145
    v_cvt_pk_bf16_f32 v39, v146, v147
    v_cvt_pk_bf16_f32 v40, v148, v149
    v_cvt_pk_bf16_f32 v41, v150, v151
    v_cvt_pk_bf16_f32 v42, v152, v153
    v_cvt_pk_bf16_f32 v43, v154, v155
    v_cvt_pk_bf16_f32 v44, v156, v157
    v_cvt_pk_bf16_f32 v45, v158, v159
    v_cvt_pk_bf16_f32 v46, v160, v161
    v_cvt_pk_bf16_f32 v47, v162, v163
    s_lshl_b32 s36, s32, 13
    s_add_u32 s36, s36, 0x2200000
    s_add_u32 s37, s36, 4096
    s_lshl_b32 s38, s31, 2
    s_add_u32 s38, s38, s28
    s_lshl_b32 s38, s38, 12
    s_lshl_b32 s39, s32, 7
    s_add_u32 s38, s38, s39
    s_add_u32 s38, s38, 0x240000
    v_and_b32 v252, 15, v0
    v_lshrrev_b32 v253, 2, v252
    v_lshrrev_b32 v254, 4, v0
    v_cmp_eq_u32 vcc, v253, v254
    v_lshlrev_b32 v252, 3, v252
    v_mov_b32 v253, 0x80000000
    v_cndmask_b32 v252, v253, v252, vcc
    buffer_store_dwordx4 v[32:35], v4, s[4:7], s36 offen offset:0 sc1
    buffer_store_dwordx4 v[36:39], v4, s[4:7], s37 offen offset:0 sc1
    buffer_store_dwordx4 v[40:43], v4, s[4:7], s36 offen offset:1024 sc1
    buffer_store_dwordx4 v[44:47], v4, s[4:7], s37 offen offset:1024 sc1
    v_mfma_f32_16x16x32_bf16 v[96:99], v[32:35], v[32:35], 0
    v_mfma_f32_16x16x32_bf16 v[92:95], v[16:19], v[32:35], 0
    v_mfma_f32_16x16x32_bf16 v[104:107], v[40:43], v[40:43], 0
    v_mfma_f32_16x16x32_bf16 v[100:103], v[16:19], v[40:43], 0
    v_mfma_f32_16x16x32_bf16 v[96:99], v[36:39], v[36:39], v[96:99]
    v_mfma_f32_16x16x32_bf16 v[92:95], v[16:19], v[36:39], v[92:95]
    v_mfma_f32_16x16x32_bf16 v[104:107], v[44:47], v[44:47], v[104:107]
    v_mfma_f32_16x16x32_bf16 v[100:103], v[16:19], v[44:47], v[100:103]
    s_nop 4
    v_cndmask_b32 v96, v96, v97, s[46:47]
    v_cndmask_b32 v98, v98, v99, s[46:47]
    v_cndmask_b32 v93, v96, v98, s[48:49]
    buffer_store_dwordx2 v[92:93], v252, s[4:7], s38 offen offset:0 sc1
    v_cndmask_b32 v104, v104, v105, s[46:47]
    v_cndmask_b32 v106, v106, v107, s[46:47]
    v_cndmask_b32 v101, v104, v106, s[48:49]
    buffer_store_dwordx2 v[100:101], v252, s[4:7], s38 offen offset:2048 sc1
    s_lshr_b32 s36, s31, 1
    s_lshl_b32 s36, s36, 13
    v_lshl_add_u32 v10, v0, 8, s36
    s_mov_b32 s38, 0
    s_mov_b32 s54, 32
    s_waitcnt vmcnt(0)
    s_barrier
    s_cmp_lg_u32 s28, 0
    s_cbranch_scc1 Lsig_10
    s_mov_b32 exec_hi, s38
    s_mov_b32 s36, 0x40000
    buffer_atomic_add v12, v10, s[4:7], s36 offen sc1
    s_mov_b64 exec, -1
Lsig_10:
    s_lshl_b32 s44, s28, 1
    s_add_u32 s44, s44, s33
    s_add_u32 s44, s44, 0
    s_and_b32 s44, s44, 31
    s_mul_i32 s44, s44, 6144
    s_add_u32 s44, s44, s50
    s_add_u32 s44, s44, 0x1400000
    s_mul_i32 s45, s28, 12288
    s_add_u32 m0, s45, 0
    s_nop 0
    buffer_load_dwordx4 v1, s[4:7], s44 offen offset:0 sc1 lds
    buffer_load_dwordx4 v1, s[4:7], s44 offen offset:1024 sc1 lds
    buffer_load_dwordx4 v1, s[4:7], s44 offen offset:2048 sc1 lds
    buffer_load_dwordx4 v1, s[4:7], s44 offen offset:3072 sc1 lds
    s_add_u32 s44, s44, 4096
    s_add_u32 m0, m0, 4096
    s_nop 0
    buffer_load_dwordx4 v1, s[4:7], s44 offen offset:0 sc1 lds
    buffer_load_dwordx4 v1, s[4:7], s44 offen offset:1024 sc1 lds
    buffer_load_dwordx4 v1, s[4:7], s44 offen offset:2048 sc1 lds
    buffer_load_dwordx4 v1, s[4:7], s44 offen offset:3072 sc1 lds
    s_add_u32 s44, s44, 4096
    s_add_u32 m0, m0, 4096
    s_nop 0
    buffer_load_dwordx4 v1, s[4:7], s44 offen offset:0 sc1 lds
    buffer_load_dwordx4 v1, s[4:7], s44 offen offset:1024 sc1 lds
    buffer_load_dwordx4 v1, s[4:7], s44 offen offset:2048 sc1 lds
    buffer_load_dwordx4 v1, s[4:7], s44 offen offset:3072 sc1 lds
    s_lshl_b32 s44, s28, 1
    s_add_u32 s44, s44, s33
    s_add_u32 s44, s44, 8
    s_and_b32 s44, s44, 31
    s_mul_i32 s44, s44, 6144
    s_add_u32 s44, s44, s50
    s_add_u32 s44, s44, 0x1400000
    s_mul_i32 s45, s28, 12288
    s_add_u32 m0, s45, 49152
    s_nop 0
    buffer_load_dwordx4 v1, s[4:7], s44 offen offset:0 sc1 lds
    buffer_load_dwordx4 v1, s[4:7], s44 offen offset:1024 sc1 lds
    buffer_load_dwordx4 v1, s[4:7], s44 offen offset:2048 sc1 lds
    buffer_load_dwordx4 v1, s[4:7], s44 offen offset:3072 sc1 lds
    s_add_u32 s44, s44, 4096
    s_add_u32 m0, m0, 4096
    s_nop 0
    buffer_load_dwordx4 v1, s[4:7], s44 offen offset:0 sc1 lds
    buffer_load_dwordx4 v1, s[4:7], s44 offen offset:1024 sc1 lds
    buffer_load_dwordx4 v1, s[4:7], s44 offen offset:2048 sc1 lds
    buffer_load_dwordx4 v1, s[4:7], s44 offen offset:3072 sc1 lds
    s_add_u32 s44, s44, 4096
    s_add_u32 m0, m0, 4096
    s_nop 0
    buffer_load_dwordx4 v1, s[4:7], s44 offen offset:0 sc1 lds
    buffer_load_dwordx4 v1, s[4:7], s44 offen offset:1024 sc1 lds
    buffer_load_dwordx4 v1, s[4:7], s44 offen offset:2048 sc1 lds
    buffer_load_dwordx4 v1, s[4:7], s44 offen offset:3072 sc1 lds
    s_add_u32 s40, s4, 0x2200000
    s_addc_u32 s41, s5, 0
    s_lshl_b32 s36, s29, 5
    s_add_u32 s36, s36, s30
    s_lshl_b32 s36, s36, 8
    v_mov_b32 v10, s36
    s_cmp_lg_u32 s28, 0
    s_cbranch_scc1 Lpe_12
    s_mov_b32 s36, 0x40000
    s_mov_b32 s37, 0
Lpoll_11:
    buffer_load_dword v11, v10, s[4:7], s36 offen sc1
    s_add_u32 s37, s37, 1
    s_waitcnt vmcnt(0)
    v_cmp_gt_u32 vcc, s54, v11
    s_cbranch_vccz Lpe_12
    s_cmp_lt_u32 s37, 0x100000
    s_cbranch_scc1 Lpoll_11
Lpe_12:
    s_waitcnt vmcnt(0)
    s_barrier
    s_lshl_b32 s35, s33, 12
    s_add_u32 s39, s28, 2
    s_lshl_b32 s39, s39, 10
    buffer_load_dwordx4 a[0:3], v2, s[40:43], s35 offen offset:0 sc1
    buffer_load_dwordx4 a[4:7], v2, s[40:43], s35 offen offset:1024 sc1
    buffer_load_dwordx4 a[8:11], v2, s[40:43], s35 offen offset:2048 sc1
    buffer_load_dwordx4 a[12:15], v2, s[40:43], s35 offen offset:3072 sc1
    s_add_u32 s35, s35, 4096
    s_and_b32 s35, s35, 0x1ffff
    buffer_load_dwordx4 a[20:23], v2, s[40:43], s35 offen offset:0 sc1
    buffer_load_dwordx4 a[24:27], v2, s[40:43], s35 offen offset:1024 sc1
    buffer_load_dwordx4 a[28:31], v2, s[40:43], s35 offen offset:2048 sc1
    buffer_load_dwordx4 a[32:35], v2, s[40:43], s35 offen offset:3072 sc1
    s_add_u32 s35, s35, 4096
    s_and_b32 s35, s35, 0x1ffff
    buffer_load_dwordx4 a[40:43], v2, s[40:43], s35 offen offset:0 sc1
    buffer_load_dwordx4 a[44:47], v2, s[40:43], s35 offen offset:1024 sc1
    buffer_load_dwordx4 a[48:51], v2, s[40:43], s35 offen offset:2048 sc1
    buffer_load_dwordx4 a[52:55], v2, s[40:43], s35 offen offset:3072 sc1
    s_add_u32 s35, s35, 4096
    s_and_b32 s35, s35, 0x1ffff
    v_and_b32 v232, 15, v0
    v_lshlrev_b32 v232, 7, v232
    v_lshrrev_b32 v233, 4, v0
    v_lshl_add_u32 v232, v233, 4, v232
    v_add_u32 v5, 0, v1
    ds_read_b128 a[80:83], v5 offset:0
    ds_read_b128 a[84:87], v5 offset:1024
    ds_read_b128 a[88:91], v5 offset:2048
    ds_read_b128 a[92:95], v5 offset:3072
    ds_read_b128 a[96:99], v5 offset:4096
    ds_read_b128 a[100:103], v5 offset:5120
    s_waitcnt vmcnt(8) lgkmcnt(0)
    v_mfma_f32_16x16x32_bf16 v[132:135], a[80:83], a[0:3], 0
    ds_read_b128 a[108:111], v5 offset:6144
    v_mfma_f32_16x16x32_bf16 v[156:159], a[80:83], a[4:7], 0
    buffer_load_dwordx4 a[60:63], v2, s[40:43], s35 offen offset:0 sc1
    v_mfma_f32_16x16x32_bf16 v[180:183], a[80:83], a[8:11], 0
    ds_read_b128 a[112:115], v5 offset:7168
    v_mfma_f32_16x16x32_bf16 v[204:207], a[80:83], a[12:15], 0
    v_mfma_f32_16x16x32_bf16 v[136:139], a[84:87], a[0:3], 0
    buffer_load_dwordx4 a[64:67], v2, s[40:43], s35 offen offset:1024 sc1
    v_mfma_f32_16x16x32_bf16 v[160:163], a[84:87], a[4:7], 0
    ds_read_b128 a[116:119], v5 offset:8192
    v_mfma_f32_16x16x32_bf16 v[184:187], a[84:87], a[8:11], 0
    v_mfma_f32_16x16x32_bf16 v[208:211], a[84:87], a[12:15], 0
    v_mfma_f32_16x16x32_bf16 v[140:143], a[88:91], a[0:3], 0
    ds_read_b128 a[120:123], v5 offset:9216
    buffer_load_dwordx4 a[68:71], v2, s[40:43], s35 offen offset:2048 sc1
    v_mfma_f32_16x16x32_bf16 v[164:167], a[88:91], a[4:7], 0
    v_mfma_f32_16x16x32_bf16 v[188:191], a[88:91], a[8:11], 0
    v_mfma_f32_16x16x32_bf16 v[212:215], a[88:91], a[12:15], 0
    ds_read_b128 a[124:127], v5 offset:10240
    v_mfma_f32_16x16x32_bf16 v[144:147], a[92:95], a[0:3], 0
    buffer_load_dwordx4 a[72:75], v2, s[40:43], s35 offen offset:3072 sc1
    s_add_u32 s35, s35, 4096
    s_and_b32 s35, s35, 0x1ffff
    v_mfma_f32_16x16x32_bf16 v[168:171], a[92:95], a[4:7], 0
    v_mfma_f32_16x16x32_bf16 v[192:195], a[92:95], a[8:11], 0
    ds_read_b128 a[128:131], v5 offset:11264
    v_mfma_f32_16x16x32_bf16 v[216:219], a[92:95], a[12:15], 0
    v_mfma_f32_16x16x32_bf16 v[148:151], a[96:99], a[0:3], 0
    s_lshl_b32 s44, s28, 1
    s_add_u32 s44, s44, s33
    s_add_u32 s44, s44, 16
    s_and_b32 s44, s44, 31
    s_mul_i32 s44, s44, 6144
    s_add_u32 s44, s44, s50
    s_add_u32 s44, s44, 0x1400000
    s_mul_i32 s45, s28, 12288
    s_add_u32 m0, s45, 98304
    s_nop 0
    buffer_load_dwordx4 v1, s[4:7], s44 offen offset:0 sc1 lds
    v_mfma_f32_16x16x32_bf16 v[172:175], a[96:99], a[4:7], 0
    v_mfma_f32_16x16x32_bf16 v[196:199], a[96:99], a[8:11], 0
    v_mfma_f32_16x16x32_bf16 v[220:223], a[96:99], a[12:15], 0
    v_mfma_f32_16x16x32_bf16 v[152:155], a[100:103], a[0:3], 0
    buffer_load_dwordx4 v1, s[4:7], s44 offen offset:1024 sc1 lds
    v_mfma_f32_16x16x32_bf16 v[176:179], a[100:103], a[4:7], 0
    v_mfma_f32_16x16x32_bf16 v[200:203], a[100:103], a[8:11], 0
    v_mfma_f32_16x16x32_bf16 v[224:227], a[100:103], a[12:15], 0
    s_waitcnt vmcnt(10) lgkmcnt(0)
    v_mfma_f32_16x16x32_bf16 v[132:135], a[108:111], a[20:23], v[132:135]
    ds_read_b128 a[80:83], v5 offset:12288
    v_mfma_f32_16x16x32_bf16 v[156:159], a[108:111], a[24:27], v[156:159]
    buffer_load_dwordx4 a[0:3], v2, s[40:43], s35 offen offset:0 sc1
    v_mfma_f32_16x16x32_bf16 v[180:183], a[108:111], a[28:31], v[180:183]
    ds_read_b128 a[84:87], v5 offset:13312
    v_mfma_f32_16x16x32_bf16 v[204:207], a[108:111], a[32:35], v[204:207]
    v_mfma_f32_16x16x32_bf16 v[136:139], a[112:115], a[20:23], v[136:139]
    buffer_load_dwordx4 a[4:7], v2, s[40:43], s35 offen offset:1024 sc1
    v_mfma_f32_16x16x32_bf16 v[160:163], a[112:115], a[24:27], v[160:163]
    ds_read_b128 a[88:91], v5 offset:14336
    v_mfma_f32_16x16x32_bf16 v[184:187], a[112:115], a[28:31], v[184:187]
    v_mfma_f32_16x16x32_bf16 v[208:211], a[112:115], a[32:35], v[208:211]
    v_mfma_f32_16x16x32_bf16 v[140:143], a[116:119], a[20:23], v[140:143]
    ds_read_b128 a[92:95], v5 offset:15360
    buffer_load_dwordx4 a[8:11], v2, s[40:43], s35 offen offset:2048 sc1
    v_mfma_f32_16x16x32_bf16 v[164:167], a[116:119], a[24:27], v[164:167]
    v_mfma_f32_16x16x32_bf16 v[188:191], a[116:119], a[28:31], v[188:191]
    v_mfma_f32_16x16x32_bf16 v[212:215], a[116:119], a[32:35], v[212:215]
    ds_read_b128 a[96:99], v5 offset:16384
    v_mfma_f32_16x16x32_bf16 v[144:147], a[120:123], a[20:23], v[144:147]
    buffer_load_dwordx4 a[12:15], v2, s[40:43], s35 offen offset:3072 sc1
    s_add_u32 s35, s35, 4096
    s_and_b32 s35, s35, 0x1ffff
    v_mfma_f32_16x16x32_bf16 v[168:171], a[120:123], a[24:27], v[168:171]
    v_mfma_f32_16x16x32_bf16 v[192:195], a[120:123], a[28:31], v[192:195]
    ds_read_b128 a[100:103], v5 offset:17408
    v_mfma_f32_16x16x32_bf16 v[216:219], a[120:123], a[32:35], v[216:219]
    v_mfma_f32_16x16x32_bf16 v[148:151], a[124:127], a[20:23], v[148:151]
    buffer_load_dwordx4 v1, s[4:7], s44 offen offset:2048 sc1 lds
    v_mfma_f32_16x16x32_bf16 v[172:175], a[124:127], a[24:27], v[172:175]
    v_mfma_f32_16x16x32_bf16 v[196:199], a[124:127], a[28:31], v[196:199]
    v_mfma_f32_16x16x32_bf16 v[220:223], a[124:127], a[32:35], v[220:223]
    v_mfma_f32_16x16x32_bf16 v[152:155], a[128:131], a[20:23], v[152:155]
    buffer_load_dwordx4 v1, s[4:7], s44 offen offset:3072 sc1 lds
    v_mfma_f32_16x16x32_bf16 v[176:179], a[128:131], a[24:27], v[176:179]
    v_mfma_f32_16x16x32_bf16 v[200:203], a[128:131], a[28:31], v[200:203]
    v_mfma_f32_16x16x32_bf16 v[224:227], a[128:131], a[32:35], v[224:227]
    s_waitcnt vmcnt(12) lgkmcnt(0)
    v_mfma_f32_16x16x32_bf16 v[132:135], a[80:83], a[40:43], v[132:135]
    ds_read_b128 a[108:111], v5 offset:18432
    v_mfma_f32_16x16x32_bf16 v[156:159], a[80:83], a[44:47], v[156:159]
    buffer_load_dwordx4 a[20:23], v2, s[40:43], s35 offen offset:0 sc1
    v_mfma_f32_16x16x32_bf16 v[180:183], a[80:83], a[48:51], v[180:183]
    ds_read_b128 a[112:115], v5 offset:19456
    v_mfma_f32_16x16x32_bf16 v[204:207], a[80:83], a[52:55], v[204:207]
    v_mfma_f32_16x16x32_bf16 v[136:139], a[84:87], a[40:43], v[136:139]
    buffer_load_dwordx4 a[24:27], v2, s[40:43], s35 offen offset:1024 sc1
    v_mfma_f32_16x16x32_bf16 v[160:163], a[84:87], a[44:47], v[160:163]
    ds_read_b128 a[116:119], v5 offset:20480
    v_mfma_f32_16x16x32_bf16 v[184:187], a[84:87], a[48:51], v[184:187]
    v_mfma_f32_16x16x32_bf16 v[208:211], a[84:87], a[52:55], v[208:211]
    v_mfma_f32_16x16x32_bf16 v[140:143], a[88:91], a[40:43], v[140:143]
    ds_read_b128 a[120:123], v5 offset:21504
    buffer_load_dwordx4 a[28:31], v2, s[40:43], s35 offen offset:2048 sc1
    v_mfma_f32_16x16x32_bf16 v[164:167], a[88:91], a[44:47], v[164:167]
    v_mfma_f32_16x16x32_bf16 v[188:191], a[88:91], a[48:51], v[188:191]
    v_mfma_f32_16x16x32_bf16 v[212:215], a[88:91], a[52:55], v[212:215]
    ds_read_b128 a[124:127], v5 offset:22528
    v_mfma_f32_16x16x32_bf16 v[144:147], a[92:95], a[40:43], v[144:147]
    buffer_load_dwordx4 a[32:35], v2, s[40:43], s35 offen offset:3072 sc1
    s_add_u32 s35, s35, 4096
    s_and_b32 s35, s35, 0x1ffff
    v_mfma_f32_16x16x32_bf16 v[168:171], a[92:95], a[44:47], v[168:171]
    v_mfma_f32_16x16x32_bf16 v[192:195], a[92:95], a[48:51], v[192:195]
    ds_read_b128 a[128:131], v5 offset:23552
    v_mfma_f32_16x16x32_bf16 v[216:219], a[92:95], a[52:55], v[216:219]
    v_mfma_f32_16x16x32_bf16 v[148:151], a[96:99], a[40:43], v[148:151]
    s_add_u32 s44, s44, 4096
    s_add_u32 m0, m0, 4096
    s_nop 0
    buffer_load_dwordx4 v1, s[4:7], s44 offen offset:0 sc1 lds
    v_mfma_f32_16x16x32_bf16 v[172:175], a[96:99], a[44:47], v[172:175]
    v_mfma_f32_16x16x32_bf16 v[196:199], a[96:99], a[48:51], v[196:199]
    v_mfma_f32_16x16x32_bf16 v[220:223], a[96:99], a[52:55], v[220:223]
    v_mfma_f32_16x16x32_bf16 v[152:155], a[100:103], a[40:43], v[152:155]
    buffer_load_dwordx4 v1, s[4:7], s44 offen offset:1024 sc1 lds
    v_mfma_f32_16x16x32_bf16 v[176:179], a[100:103], a[44:47], v[176:179]
    v_mfma_f32_16x16x32_bf16 v[200:203], a[100:103], a[48:51], v[200:203]
    v_mfma_f32_16x16x32_bf16 v[224:227], a[100:103], a[52:55], v[224:227]
    s_waitcnt vmcnt(14) lgkmcnt(0)
    v_mfma_f32_16x16x32_bf16 v[132:135], a[108:111], a[60:63], v[132:135]
    ds_read_b128 a[80:83], v5 offset:24576
    v_mfma_f32_16x16x32_bf16 v[156:159], a[108:111], a[64:67], v[156:159]
    buffer_load_dwordx4 a[40:43], v2, s[40:43], s35 offen offset:0 sc1
    v_mfma_f32_16x16x32_bf16 v[180:183], a[108:111], a[68:71], v[180:183]
    ds_read_b128 a[84:87], v5 offset:25600
    v_mfma_f32_16x16x32_bf16 v[204:207], a[108:111], a[72:75], v[204:207]
    v_mfma_f32_16x16x32_bf16 v[136:139], a[112:115], a[60:63], v[136:139]
    v_mfma_f32_16x16x32_bf16 v[160:163], a[112:115], a[64:67], v[160:163]
    ds_read_b128 a[88:91], v5 offset:26624
    buffer_load_dwordx4 a[44:47], v2, s[40:43], s35 offen offset:1024 sc1
    v_mfma_f32_16x16x32_bf16 v[184:187], a[112:115], a[68:71], v[184:187]
    v_mfma_f32_16x16x32_bf16 v[208:211], a[112:115], a[72:75], v[208:211]
    v_mfma_f32_16x16x32_bf16 v[140:143], a[116:119], a[60:63], v[140:143]
    ds_read_b128 a[92:95], v5 offset:27648
    v_mfma_f32_16x16x32_bf16 v[164:167], a[116:119], a[64:67], v[164:167]
    v_mfma_f32_16x16x32_bf16 v[188:191], a[116:119], a[68:71], v[188:191]
    buffer_load_dwordx4 a[48:51], v2, s[40:43], s35 offen offset:2048 sc1
    v_mfma_f32_16x16x32_bf16 v[212:215], a[116:119], a[72:75], v[212:215]
    ds_read_b128 a[96:99], v5 offset:28672
    v_mfma_f32_16x16x32_bf16 v[144:147], a[120:123], a[60:63], v[144:147]
    v_mfma_f32_16x16x32_bf16 v[168:171], a[120:123], a[64:67], v[168:171]
    v_mfma_f32_16x16x32_bf16 v[192:195], a[120:123], a[68:71], v[192:195]
    ds_read_b128 a[100:103], v5 offset:29696
    buffer_load_dwordx4 a[52:55], v2, s[40:43], s35 offen offset:3072 sc1
    s_add_u32 s35, s35, 4096
    s_and_b32 s35, s35, 0x1ffff
    v_mfma_f32_16x16x32_bf16 v[216:219], a[120:123], a[72:75], v[216:219]
    v_mfma_f32_16x16x32_bf16 v[148:151], a[124:127], a[60:63], v[148:151]
    v_mfma_f32_16x16x32_bf16 v[172:175], a[124:127], a[64:67], v[172:175]
    v_mfma_f32_16x16x32_bf16 v[196:199], a[124:127], a[68:71], v[196:199]
    v_mfma_f32_16x16x32_bf16 v[220:223], a[124:127], a[72:75], v[220:223]
    buffer_load_dwordx4 v1, s[4:7], s44 offen offset:2048 sc1 lds
    v_mfma_f32_16x16x32_bf16 v[152:155], a[128:131], a[60:63], v[152:155]
    v_mfma_f32_16x16x32_bf16 v[176:179], a[128:131], a[64:67], v[176:179]
    v_mfma_f32_16x16x32_bf16 v[200:203], a[128:131], a[68:71], v[200:203]
    v_mfma_f32_16x16x32_bf16 v[224:227], a[128:131], a[72:75], v[224:227]
    s_waitcnt vmcnt(13) lgkmcnt(0)
    v_mfma_f32_16x16x32_bf16 v[132:135], a[80:83], a[0:3], v[132:135]
    ds_read_b128 a[108:111], v5 offset:30720
    v_mfma_f32_16x16x32_bf16 v[156:159], a[80:83], a[4:7], v[156:159]
    buffer_load_dwordx4 a[60:63], v2, s[40:43], s35 offen offset:0 sc1
    v_mfma_f32_16x16x32_bf16 v[180:183], a[80:83], a[8:11], v[180:183]
    ds_read_b128 a[112:115], v5 offset:31744
    v_mfma_f32_16x16x32_bf16 v[204:207], a[80:83], a[12:15], v[204:207]
    v_mfma_f32_16x16x32_bf16 v[136:139], a[84:87], a[0:3], v[136:139]
    buffer_load_dwordx4 a[64:67], v2, s[40:43], s35 offen offset:1024 sc1
    v_mfma_f32_16x16x32_bf16 v[160:163], a[84:87], a[4:7], v[160:163]
    ds_read_b128 a[116:119], v5 offset:32768
    v_mfma_f32_16x16x32_bf16 v[184:187], a[84:87], a[8:11], v[184:187]
    v_mfma_f32_16x16x32_bf16 v[208:211], a[84:87], a[12:15], v[208:211]
    v_mfma_f32_16x16x32_bf16 v[140:143], a[88:91], a[0:3], v[140:143]
    ds_read_b128 a[120:123], v5 offset:33792
    buffer_load_dwordx4 a[68:71], v2, s[40:43], s35 offen offset:2048 sc1
    v_mfma_f32_16x16x32_bf16 v[164:167], a[88:91], a[4:7], v[164:167]
    v_mfma_f32_16x16x32_bf16 v[188:191], a[88:91], a[8:11], v[188:191]
    v_mfma_f32_16x16x32_bf16 v[212:215], a[88:91], a[12:15], v[212:215]
    ds_read_b128 a[124:127], v5 offset:34816
    v_mfma_f32_16x16x32_bf16 v[144:147], a[92:95], a[0:3], v[144:147]
    buffer_load_dwordx4 a[72:75], v2, s[40:43], s35 offen offset:3072 sc1
    s_add_u32 s35, s35, 4096
    s_and_b32 s35, s35, 0x1ffff
    v_mfma_f32_16x16x32_bf16 v[168:171], a[92:95], a[4:7], v[168:171]
    v_mfma_f32_16x16x32_bf16 v[192:195], a[92:95], a[8:11], v[192:195]
    ds_read_b128 a[128:131], v5 offset:35840
    v_mfma_f32_16x16x32_bf16 v[216:219], a[92:95], a[12:15], v[216:219]
    v_mfma_f32_16x16x32_bf16 v[148:151], a[96:99], a[0:3], v[148:151]
    buffer_load_dwordx4 v1, s[4:7], s44 offen offset:3072 sc1 lds
    v_mfma_f32_16x16x32_bf16 v[172:175], a[96:99], a[4:7], v[172:175]
    v_mfma_f32_16x16x32_bf16 v[196:199], a[96:99], a[8:11], v[196:199]
    v_mfma_f32_16x16x32_bf16 v[220:223], a[96:99], a[12:15], v[220:223]
    v_mfma_f32_16x16x32_bf16 v[152:155], a[100:103], a[0:3], v[152:155]
    s_add_u32 s44, s44, 4096
    s_add_u32 m0, m0, 4096
    s_nop 0
    buffer_load_dwordx4 v1, s[4:7], s44 offen offset:0 sc1 lds
    v_mfma_f32_16x16x32_bf16 v[176:179], a[100:103], a[4:7], v[176:179]
    v_mfma_f32_16x16x32_bf16 v[200:203], a[100:103], a[8:11], v[200:203]
    v_mfma_f32_16x16x32_bf16 v[224:227], a[100:103], a[12:15], v[224:227]
    s_waitcnt vmcnt(13) lgkmcnt(0)
    v_mfma_f32_16x16x32_bf16 v[132:135], a[108:111], a[20:23], v[132:135]
    ds_read_b128 a[80:83], v5 offset:36864
    v_mfma_f32_16x16x32_bf16 v[156:159], a[108:111], a[24:27], v[156:159]
    buffer_load_dwordx4 a[0:3], v2, s[40:43], s35 offen offset:0 sc1
    v_mfma_f32_16x16x32_bf16 v[180:183], a[108:111], a[28:31], v[180:183]
    ds_read_b128 a[84:87], v5 offset:37888
    v_mfma_f32_16x16x32_bf16 v[204:207], a[108:111], a[32:35], v[204:207]
    v_mfma_f32_16x16x32_bf16 v[136:139], a[112:115], a[20:23], v[136:139]
    buffer_load_dwordx4 a[4:7], v2, s[40:43], s35 offen offset:1024 sc1
    v_mfma_f32_16x16x32_bf16 v[160:163], a[112:115], a[24:27], v[160:163]
    ds_read_b128 a[88:91], v5 offset:38912
    v_mfma_f32_16x16x32_bf16 v[184:187], a[112:115], a[28:31], v[184:187]
    v_mfma_f32_16x16x32_bf16 v[208:211], a[112:115], a[32:35], v[208:211]
    v_mfma_f32_16x16x32_bf16 v[140:143], a[116:119], a[20:23], v[140:143]
    ds_read_b128 a[92:95], v5 offset:39936
    buffer_load_dwordx4 a[8:11], v2, s[40:43], s35 offen offset:2048 sc1
    v_mfma_f32_16x16x32_bf16 v[164:167], a[116:119], a[24:27], v[164:167]
    v_mfma_f32_16x16x32_bf16 v[188:191], a[116:119], a[28:31], v[188:191]
    v_mfma_f32_16x16x32_bf16 v[212:215], a[116:119], a[32:35], v[212:215]
    ds_read_b128 a[96:99], v5 offset:40960
    v_mfma_f32_16x16x32_bf16 v[144:147], a[120:123], a[20:23], v[144:147]
    buffer_load_dwordx4 a[12:15], v2, s[40:43], s35 offen offset:3072 sc1
    s_add_u32 s35, s35, 4096
    s_and_b32 s35, s35, 0x1ffff
    v_mfma_f32_16x16x32_bf16 v[168:171], a[120:123], a[24:27], v[168:171]
    v_mfma_f32_16x16x32_bf16 v[192:195], a[120:123], a[28:31], v[192:195]
    ds_read_b128 a[100:103], v5 offset:41984
    v_mfma_f32_16x16x32_bf16 v[216:219], a[120:123], a[32:35], v[216:219]
    v_mfma_f32_16x16x32_bf16 v[148:151], a[124:127], a[20:23], v[148:151]
    buffer_load_dwordx4 v1, s[4:7], s44 offen offset:1024 sc1 lds
    v_mfma_f32_16x16x32_bf16 v[172:175], a[124:127], a[24:27], v[172:175]
    v_mfma_f32_16x16x32_bf16 v[196:199], a[124:127], a[28:31], v[196:199]
    v_mfma_f32_16x16x32_bf16 v[220:223], a[124:127], a[32:35], v[220:223]
    v_mfma_f32_16x16x32_bf16 v[152:155], a[128:131], a[20:23], v[152:155]
    buffer_load_dwordx4 v1, s[4:7], s44 offen offset:2048 sc1 lds
    v_mfma_f32_16x16x32_bf16 v[176:179], a[128:131], a[24:27], v[176:179]
    v_mfma_f32_16x16x32_bf16 v[200:203], a[128:131], a[28:31], v[200:203]
    v_mfma_f32_16x16x32_bf16 v[224:227], a[128:131], a[32:35], v[224:227]
    s_waitcnt vmcnt(13) lgkmcnt(0)
    v_mfma_f32_16x16x32_bf16 v[132:135], a[80:83], a[40:43], v[132:135]
    ds_read_b128 a[108:111], v5 offset:43008
    v_mfma_f32_16x16x32_bf16 v[156:159], a[80:83], a[44:47], v[156:159]
    buffer_load_dwordx4 a[20:23], v2, s[40:43], s35 offen offset:0 sc1
    v_mfma_f32_16x16x32_bf16 v[180:183], a[80:83], a[48:51], v[180:183]
    ds_read_b128 a[112:115], v5 offset:44032
    v_mfma_f32_16x16x32_bf16 v[204:207], a[80:83], a[52:55], v[204:207]
    v_mfma_f32_16x16x32_bf16 v[136:139], a[84:87], a[40:43], v[136:139]
    v_mfma_f32_16x16x32_bf16 v[160:163], a[84:87], a[44:47], v[160:163]
    ds_read_b128 a[116:119], v5 offset:45056
    buffer_load_dwordx4 a[24:27], v2, s[40:43], s35 offen offset:1024 sc1
    v_mfma_f32_16x16x32_bf16 v[184:187], a[84:87], a[48:51], v[184:187]
    v_mfma_f32_16x16x32_bf16 v[208:211], a[84:87], a[52:55], v[208:211]
    v_mfma_f32_16x16x32_bf16 v[140:143], a[88:91], a[40:43], v[140:143]
    ds_read_b128 a[120:123], v5 offset:46080
    v_mfma_f32_16x16x32_bf16 v[164:167], a[88:91], a[44:47], v[164:167]
    v_mfma_f32_16x16x32_bf16 v[188:191], a[88:91], a[48:51], v[188:191]
    buffer_load_dwordx4 a[28:31], v2, s[40:43], s35 offen offset:2048 sc1
    v_mfma_f32_16x16x32_bf16 v[212:215], a[88:91], a[52:55], v[212:215]
    ds_read_b128 a[124:127], v5 offset:47104
    v_mfma_f32_16x16x32_bf16 v[144:147], a[92:95], a[40:43], v[144:147]
    v_mfma_f32_16x16x32_bf16 v[168:171], a[92:95], a[44:47], v[168:171]
    v_mfma_f32_16x16x32_bf16 v[192:195], a[92:95], a[48:51], v[192:195]
    ds_read_b128 a[128:131], v5 offset:48128
    buffer_load_dwordx4 a[32:35], v2, s[40:43], s35 offen offset:3072 sc1
    s_add_u32 s35, s35, 4096
    s_and_b32 s35, s35, 0x1ffff
    v_mfma_f32_16x16x32_bf16 v[216:219], a[92:95], a[52:55], v[216:219]
    v_mfma_f32_16x16x32_bf16 v[148:151], a[96:99], a[40:43], v[148:151]
    v_mfma_f32_16x16x32_bf16 v[172:175], a[96:99], a[44:47], v[172:175]
    v_mfma_f32_16x16x32_bf16 v[196:199], a[96:99], a[48:51], v[196:199]
    v_mfma_f32_16x16x32_bf16 v[220:223], a[96:99], a[52:55], v[220:223]
    buffer_load_dwordx4 v1, s[4:7], s44 offen offset:3072 sc1 lds
    v_mfma_f32_16x16x32_bf16 v[152:155], a[100:103], a[40:43], v[152:155]
    v_mfma_f32_16x16x32_bf16 v[176:179], a[100:103], a[44:47], v[176:179]
    v_mfma_f32_16x16x32_bf16 v[200:203], a[100:103], a[48:51], v[200:203]
    v_mfma_f32_16x16x32_bf16 v[224:227], a[100:103], a[52:55], v[224:227]
    s_waitcnt vmcnt(13) lgkmcnt(0)
    s_barrier
    v_mfma_f32_16x16x32_bf16 v[132:135], a[108:111], a[60:63], v[132:135]
    v_add_u32 v5, 49152, v1
    ds_read_b128 a[80:83], v5 offset:0
    v_mfma_f32_16x16x32_bf16 v[156:159], a[108:111], a[64:67], v[156:159]
    buffer_load_dwordx4 a[40:43], v2, s[40:43], s35 offen offset:0 sc1
    v_mfma_f32_16x16x32_bf16 v[180:183], a[108:111], a[68:71], v[180:183]
    ds_read_b128 a[84:87], v5 offset:1024
    v_mfma_f32_16x16x32_bf16 v[204:207], a[108:111], a[72:75], v[204:207]
    v_mfma_f32_16x16x32_bf16 v[136:139], a[112:115], a[60:63], v[136:139]
    buffer_load_dwordx4 a[44:47], v2, s[40:43], s35 offen offset:1024 sc1
    v_mfma_f32_16x16x32_bf16 v[160:163], a[112:115], a[64:67], v[160:163]
    ds_read_b128 a[88:91], v5 offset:2048
    v_mfma_f32_16x16x32_bf16 v[184:187], a[112:115], a[68:71], v[184:187]
    v_mfma_f32_16x16x32_bf16 v[208:211], a[112:115], a[72:75], v[208:211]
    v_mfma_f32_16x16x32_bf16 v[140:143], a[116:119], a[60:63], v[140:143]
    ds_read_b128 a[92:95], v5 offset:3072
    buffer_load_dwordx4 a[48:51], v2, s[40:43], s35 offen offset:2048 sc1
    v_mfma_f32_16x16x32_bf16 v[164:167], a[116:119], a[64:67], v[164:167]
    v_mfma_f32_16x16x32_bf16 v[188:191], a[116:119], a[68:71], v[188:191]
    v_mfma_f32_16x16x32_bf16 v[212:215], a[116:119], a[72:75], v[212:215]
    ds_read_b128 a[96:99], v5 offset:4096
    v_mfma_f32_16x16x32_bf16 v[144:147], a[120:123], a[60:63], v[144:147]
    buffer_load_dwordx4 a[52:55], v2, s[40:43], s35 offen offset:3072 sc1
    s_add_u32 s35, s35, 4096
    s_and_b32 s35, s35, 0x1ffff
    v_mfma_f32_16x16x32_bf16 v[168:171], a[120:123], a[64:67], v[168:171]
    v_mfma_f32_16x16x32_bf16 v[192:195], a[120:123], a[68:71], v[192:195]
    ds_read_b128 a[100:103], v5 offset:5120
    v_mfma_f32_16x16x32_bf16 v[216:219], a[120:123], a[72:75], v[216:219]
    v_mfma_f32_16x16x32_bf16 v[148:151], a[124:127], a[60:63], v[148:151]
    s_lshl_b32 s44, s28, 1
    s_add_u32 s44, s44, s33
    s_add_u32 s44, s44, 24
    s_and_b32 s44, s44, 31
    s_mul_i32 s44, s44, 6144
    s_add_u32 s44, s44, s50
    s_add_u32 s44, s44, 0x1400000
    s_mul_i32 s45, s28, 12288
    s_add_u32 m0, s45, 0
    s_nop 0
    buffer_load_dwordx4 v1, s[4:7], s44 offen offset:0 sc1 lds
    v_mfma_f32_16x16x32_bf16 v[172:175], a[124:127], a[64:67], v[172:175]
    v_mfma_f32_16x16x32_bf16 v[196:199], a[124:127], a[68:71], v[196:199]
    v_mfma_f32_16x16x32_bf16 v[220:223], a[124:127], a[72:75], v[220:223]
    v_mfma_f32_16x16x32_bf16 v[152:155], a[128:131], a[60:63], v[152:155]
    buffer_load_dwordx4 v1, s[4:7], s44 offen offset:1024 sc1 lds
    v_mfma_f32_16x16x32_bf16 v[176:179], a[128:131], a[64:67], v[176:179]
    v_mfma_f32_16x16x32_bf16 v[200:203], a[128:131], a[68:71], v[200:203]
    v_mfma_f32_16x16x32_bf16 v[224:227], a[128:131], a[72:75], v[224:227]
    s_waitcnt vmcnt(13) lgkmcnt(0)
    v_mfma_f32_16x16x32_bf16 v[132:135], a[80:83], a[0:3], v[132:135]
    ds_read_b128 a[108:111], v5 offset:6144
    v_mfma_f32_16x16x32_bf16 v[156:159], a[80:83], a[4:7], v[156:159]
    buffer_load_dwordx4 a[60:63], v2, s[40:43], s35 offen offset:0 sc1
    v_mfma_f32_16x16x32_bf16 v[180:183], a[80:83], a[8:11], v[180:183]
    ds_read_b128 a[112:115], v5 offset:7168
    v_mfma_f32_16x16x32_bf16 v[204:207], a[80:83], a[12:15], v[204:207]
    v_mfma_f32_16x16x32_bf16 v[136:139], a[84:87], a[0:3], v[136:139]
    v_mfma_f32_16x16x32_bf16 v[160:163], a[84:87], a[4:7], v[160:163]
    ds_read_b128 a[116:119], v5 offset:8192
    buffer_load_dwordx4 a[64:67], v2, s[40:43], s35 offen offset:1024 sc1
    v_mfma_f32_16x16x32_bf16 v[184:187], a[84:87], a[8:11], v[184:187]
    v_mfma_f32_16x16x32_bf16 v[208:211], a[84:87], a[12:15], v[208:211]
    v_mfma_f32_16x16x32_bf16 v[140:143], a[88:91], a[0:3], v[140:143]
    ds_read_b128 a[120:123], v5 offset:9216
    v_mfma_f32_16x16x32_bf16 v[164:167], a[88:91], a[4:7], v[164:167]
    v_mfma_f32_16x16x32_bf16 v[188:191], a[88:91], a[8:11], v[188:191]
    buffer_load_dwordx4 a[68:71], v2, s[40:43], s35 offen offset:2048 sc1
    v_mfma_f32_16x16x32_bf16 v[212:215], a[88:91], a[12:15], v[212:215]
    ds_read_b128 a[124:127], v5 offset:10240
    v_mfma_f32_16x16x32_bf16 v[144:147], a[92:95], a[0:3], v[144:147]
    v_mfma_f32_16x16x32_bf16 v[168:171], a[92:95], a[4:7], v[168:171]
    v_mfma_f32_16x16x32_bf16 v[192:195], a[92:95], a[8:11], v[192:195]
    ds_read_b128 a[128:131], v5 offset:11264
    buffer_load_dwordx4 a[72:75], v2, s[40:43], s35 offen offset:3072 sc1
    s_add_u32 s35, s35, 4096
    s_and_b32 s35, s35, 0x1ffff
    v_mfma_f32_16x16x32_bf16 v[216:219], a[92:95], a[12:15], v[216:219]
    v_mfma_f32_16x16x32_bf16 v[148:151], a[96:99], a[0:3], v[148:151]
    v_mfma_f32_16x16x32_bf16 v[172:175], a[96:99], a[4:7], v[172:175]
    v_mfma_f32_16x16x32_bf16 v[196:199], a[96:99], a[8:11], v[196:199]
    v_mfma_f32_16x16x32_bf16 v[220:223], a[96:99], a[12:15], v[220:223]
    buffer_load_dwordx4 v1, s[4:7], s44 offen offset:2048 sc1 lds
    v_mfma_f32_16x16x32_bf16 v[152:155], a[100:103], a[0:3], v[152:155]
    v_mfma_f32_16x16x32_bf16 v[176:179], a[100:103], a[4:7], v[176:179]
    v_mfma_f32_16x16x32_bf16 v[200:203], a[100:103], a[8:11], v[200:203]
    v_mfma_f32_16x16x32_bf16 v[224:227], a[100:103], a[12:15], v[224:227]
    s_waitcnt vmcnt(12) lgkmcnt(0)
    v_mfma_f32_16x16x32_bf16 v[132:135], a[108:111], a[20:23], v[132:135]
    ds_read_b128 a[80:83], v5 offset:12288
    v_mfma_f32_16x16x32_bf16 v[156:159], a[108:111], a[24:27], v[156:159]
    buffer_load_dwordx4 a[0:3], v2, s[40:43], s35 offen offset:0 sc1
    v_mfma_f32_16x16x32_bf16 v[180:183], a[108:111], a[28:31], v[180:183]
    ds_read_b128 a[84:87], v5 offset:13312
    v_mfma_f32_16x16x32_bf16 v[204:207], a[108:111], a[32:35], v[204:207]
    v_mfma_f32_16x16x32_bf16 v[136:139], a[112:115], a[20:23], v[136:139]
    buffer_load_dwordx4 a[4:7], v2, s[40:43], s35 offen offset:1024 sc1
    v_mfma_f32_16x16x32_bf16 v[160:163], a[112:115], a[24:27], v[160:163]
    ds_read_b128 a[88:91], v5 offset:14336
    v_mfma_f32_16x16x32_bf16 v[184:187], a[112:115], a[28:31], v[184:187]
    v_mfma_f32_16x16x32_bf16 v[208:211], a[112:115], a[32:35], v[208:211]
    v_mfma_f32_16x16x32_bf16 v[140:143], a[116:119], a[20:23], v[140:143]
    ds_read_b128 a[92:95], v5 offset:15360
    buffer_load_dwordx4 a[8:11], v2, s[40:43], s35 offen offset:2048 sc1
    v_mfma_f32_16x16x32_bf16 v[164:167], a[116:119], a[24:27], v[164:167]
    v_mfma_f32_16x16x32_bf16 v[188:191], a[116:119], a[28:31], v[188:191]
    v_mfma_f32_16x16x32_bf16 v[212:215], a[116:119], a[32:35], v[212:215]
    ds_read_b128 a[96:99], v5 offset:16384
    v_mfma_f32_16x16x32_bf16 v[144:147], a[120:123], a[20:23], v[144:147]
    buffer_load_dwordx4 a[12:15], v2, s[40:43], s35 offen offset:3072 sc1
    s_add_u32 s35, s35, 4096
    s_and_b32 s35, s35, 0x1ffff
    v_mfma_f32_16x16x32_bf16 v[168:171], a[120:123], a[24:27], v[168:171]
    v_mfma_f32_16x16x32_bf16 v[192:195], a[120:123], a[28:31], v[192:195]
    ds_read_b128 a[100:103], v5 offset:17408
    v_mfma_f32_16x16x32_bf16 v[216:219], a[120:123], a[32:35], v[216:219]
    v_mfma_f32_16x16x32_bf16 v[148:151], a[124:127], a[20:23], v[148:151]
    buffer_load_dwordx4 v1, s[4:7], s44 offen offset:3072 sc1 lds
    v_mfma_f32_16x16x32_bf16 v[172:175], a[124:127], a[24:27], v[172:175]
    v_mfma_f32_16x16x32_bf16 v[196:199], a[124:127], a[28:31], v[196:199]
    v_mfma_f32_16x16x32_bf16 v[220:223], a[124:127], a[32:35], v[220:223]
    v_mfma_f32_16x16x32_bf16 v[152:155], a[128:131], a[20:23], v[152:155]
    s_add_u32 s44, s44, 4096
    s_add_u32 m0, m0, 4096
    s_nop 0
    buffer_load_dwordx4 v1, s[4:7], s44 offen offset:0 sc1 lds
    v_mfma_f32_16x16x32_bf16 v[176:179], a[128:131], a[24:27], v[176:179]
    v_mfma_f32_16x16x32_bf16 v[200:203], a[128:131], a[28:31], v[200:203]
    v_mfma_f32_16x16x32_bf16 v[224:227], a[128:131], a[32:35], v[224:227]
    s_waitcnt vmcnt(13) lgkmcnt(0)
    v_mfma_f32_16x16x32_bf16 v[132:135], a[80:83], a[40:43], v[132:135]
    ds_read_b128 a[108:111], v5 offset:18432
    v_mfma_f32_16x16x32_bf16 v[156:159], a[80:83], a[44:47], v[156:159]
    buffer_load_dwordx4 a[20:23], v2, s[40:43], s35 offen offset:0 sc1
    v_mfma_f32_16x16x32_bf16 v[180:183], a[80:83], a[48:51], v[180:183]
    ds_read_b128 a[112:115], v5 offset:19456
    v_mfma_f32_16x16x32_bf16 v[204:207], a[80:83], a[52:55], v[204:207]
    v_mfma_f32_16x16x32_bf16 v[136:139], a[84:87], a[40:43], v[136:139]
    v_mfma_f32_16x16x32_bf16 v[160:163], a[84:87], a[44:47], v[160:163]
    ds_read_b128 a[116:119], v5 offset:20480
    buffer_load_dwordx4 a[24:27], v2, s[40:43], s35 offen offset:1024 sc1
    v_mfma_f32_16x16x32_bf16 v[184:187], a[84:87], a[48:51], v[184:187]
    v_mfma_f32_16x16x32_bf16 v[208:211], a[84:87], a[52:55], v[208:211]
    v_mfma_f32_16x16x32_bf16 v[140:143], a[88:91], a[40:43], v[140:143]
    ds_read_b128 a[120:123], v5 offset:21504
    v_mfma_f32_16x16x32_bf16 v[164:167], a[88:91], a[44:47], v[164:167]
    v_mfma_f32_16x16x32_bf16 v[188:191], a[88:91], a[48:51], v[188:191]
    buffer_load_dwordx4 a[28:31], v2, s[40:43], s35 offen offset:2048 sc1
    v_mfma_f32_16x16x32_bf16 v[212:215], a[88:91], a[52:55], v[212:215]
    ds_read_b128 a[124:127], v5 offset:22528
    v_mfma_f32_16x16x32_bf16 v[144:147], a[92:95], a[40:43], v[144:147]
    v_mfma_f32_16x16x32_bf16 v[168:171], a[92:95], a[44:47], v[168:171]
    v_mfma_f32_16x16x32_bf16 v[192:195], a[92:95], a[48:51], v[192:195]
    ds_read_b128 a[128:131], v5 offset:23552
    buffer_load_dwordx4 a[32:35], v2, s[40:43], s35 offen offset:3072 sc1
    s_add_u32 s35, s35, 4096
    s_and_b32 s35, s35, 0x1ffff
    v_mfma_f32_16x16x32_bf16 v[216:219], a[92:95], a[52:55], v[216:219]
    v_mfma_f32_16x16x32_bf16 v[148:151], a[96:99], a[40:43], v[148:151]
    v_mfma_f32_16x16x32_bf16 v[172:175], a[96:99], a[44:47], v[172:175]
    v_mfma_f32_16x16x32_bf16 v[196:199], a[96:99], a[48:51], v[196:199]
    v_mfma_f32_16x16x32_bf16 v[220:223], a[96:99], a[52:55], v[220:223]
    buffer_load_dwordx4 v1, s[4:7], s44 offen offset:1024 sc1 lds
    v_mfma_f32_16x16x32_bf16 v[152:155], a[100:103], a[40:43], v[152:155]
    v_mfma_f32_16x16x32_bf16 v[176:179], a[100:103], a[44:47], v[176:179]
    v_mfma_f32_16x16x32_bf16 v[200:203], a[100:103], a[48:51], v[200:203]
    v_mfma_f32_16x16x32_bf16 v[224:227], a[100:103], a[52:55], v[224:227]
    s_waitcnt vmcnt(12) lgkmcnt(0)
    v_mfma_f32_16x16x32_bf16 v[132:135], a[108:111], a[60:63], v[132:135]
    ds_read_b128 a[80:83], v5 offset:24576
    v_mfma_f32_16x16x32_bf16 v[156:159], a[108:111], a[64:67], v[156:159]
    buffer_load_dwordx4 a[40:43], v2, s[40:43], s35 offen offset:0 sc1
    v_mfma_f32_16x16x32_bf16 v[180:183], a[108:111], a[68:71], v[180:183]
    ds_read_b128 a[84:87], v5 offset:25600
    v_mfma_f32_16x16x32_bf16 v[204:207], a[108:111], a[72:75], v[204:207]
    v_mfma_f32_16x16x32_bf16 v[136:139], a[112:115], a[60:63], v[136:139]
    buffer_load_dwordx4 a[44:47], v2, s[40:43], s35 offen offset:1024 sc1
    v_mfma_f32_16x16x32_bf16 v[160:163], a[112:115], a[64:67], v[160:163]
    ds_read_b128 a[88:91], v5 offset:26624
    v_mfma_f32_16x16x32_bf16 v[184:187], a[112:115], a[68:71], v[184:187]
    v_mfma_f32_16x16x32_bf16 v[208:211], a[112:115], a[72:75], v[208:211]
    v_mfma_f32_16x16x32_bf16 v[140:143], a[116:119], a[60:63], v[140:143]
    ds_read_b128 a[92:95], v5 offset:27648
    buffer_load_dwordx4 a[48:51], v2, s[40:43], s35 offen offset:2048 sc1
    v_mfma_f32_16x16x32_bf16 v[164:167], a[116:119], a[64:67], v[164:167]
    v_mfma_f32_16x16x32_bf16 v[188:191], a[116:119], a[68:71], v[188:191]
    v_mfma_f32_16x16x32_bf16 v[212:215], a[116:119], a[72:75], v[212:215]
    ds_read_b128 a[96:99], v5 offset:28672
    v_mfma_f32_16x16x32_bf16 v[144:147], a[120:123], a[60:63], v[144:147]
    buffer_load_dwordx4 a[52:55], v2, s[40:43], s35 offen offset:3072 sc1
    s_add_u32 s35, s35, 4096
    s_and_b32 s35, s35, 0x1ffff
    v_mfma_f32_16x16x32_bf16 v[168:171], a[120:123], a[64:67], v[168:171]
    v_mfma_f32_16x16x32_bf16 v[192:195], a[120:123], a[68:71], v[192:195]
    ds_read_b128 a[100:103], v5 offset:29696
    v_mfma_f32_16x16x32_bf16 v[216:219], a[120:123], a[72:75], v[216:219]
    v_mfma_f32_16x16x32_bf16 v[148:151], a[124:127], a[60:63], v[148:151]
    buffer_load_dwordx4 v1, s[4:7], s44 offen offset:2048 sc1 lds
    v_mfma_f32_16x16x32_bf16 v[172:175], a[124:127], a[64:67], v[172:175]
    v_mfma_f32_16x16x32_bf16 v[196:199], a[124:127], a[68:71], v[196:199]
    v_mfma_f32_16x16x32_bf16 v[220:223], a[124:127], a[72:75], v[220:223]
    v_mfma_f32_16x16x32_bf16 v[152:155], a[128:131], a[60:63], v[152:155]
    buffer_load_dwordx4 v1, s[4:7], s44 offen offset:3072 sc1 lds
    v_mfma_f32_16x16x32_bf16 v[176:179], a[128:131], a[64:67], v[176:179]
    v_mfma_f32_16x16x32_bf16 v[200:203], a[128:131], a[68:71], v[200:203]
    v_mfma_f32_16x16x32_bf16 v[224:227], a[128:131], a[72:75], v[224:227]
    s_waitcnt vmcnt(13) lgkmcnt(0)
    v_mfma_f32_16x16x32_bf16 v[132:135], a[80:83], a[0:3], v[132:135]
    ds_read_b128 a[108:111], v5 offset:30720
    v_mfma_f32_16x16x32_bf16 v[156:159], a[80:83], a[4:7], v[156:159]
    buffer_load_dwordx4 a[60:63], v2, s[40:43], s35 offen offset:0 sc1
    v_mfma_f32_16x16x32_bf16 v[180:183], a[80:83], a[8:11], v[180:183]
    ds_read_b128 a[112:115], v5 offset:31744
    v_mfma_f32_16x16x32_bf16 v[204:207], a[80:83], a[12:15], v[204:207]
    v_mfma_f32_16x16x32_bf16 v[136:139], a[84:87], a[0:3], v[136:139]
    v_mfma_f32_16x16x32_bf16 v[160:163], a[84:87], a[4:7], v[160:163]
    ds_read_b128 a[116:119], v5 offset:32768
    buffer_load_dwordx4 a[64:67], v2, s[40:43], s35 offen offset:1024 sc1
    v_mfma_f32_16x16x32_bf16 v[184:187], a[84:87], a[8:11], v[184:187]
    v_mfma_f32_16x16x32_bf16 v[208:211], a[84:87], a[12:15], v[208:211]
    v_mfma_f32_16x16x32_bf16 v[140:143], a[88:91], a[0:3], v[140:143]
    ds_read_b128 a[120:123], v5 offset:33792
    v_mfma_f32_16x16x32_bf16 v[164:167], a[88:91], a[4:7], v[164:167]
    v_mfma_f32_16x16x32_bf16 v[188:191], a[88:91], a[8:11], v[188:191]
    buffer_load_dwordx4 a[68:71], v2, s[40:43], s35 offen offset:2048 sc1
    v_mfma_f32_16x16x32_bf16 v[212:215], a[88:91], a[12:15], v[212:215]
    ds_read_b128 a[124:127], v5 offset:34816
    v_mfma_f32_16x16x32_bf16 v[144:147], a[92:95], a[0:3], v[144:147]
    v_mfma_f32_16x16x32_bf16 v[168:171], a[92:95], a[4:7], v[168:171]
    v_mfma_f32_16x16x32_bf16 v[192:195], a[92:95], a[8:11], v[192:195]
    ds_read_b128 a[128:131], v5 offset:35840
    buffer_load_dwordx4 a[72:75], v2, s[40:43], s35 offen offset:3072 sc1
    s_add_u32 s35, s35, 4096
    s_and_b32 s35, s35, 0x1ffff
    v_mfma_f32_16x16x32_bf16 v[216:219], a[92:95], a[12:15], v[216:219]
    v_mfma_f32_16x16x32_bf16 v[148:151], a[96:99], a[0:3], v[148:151]
    v_mfma_f32_16x16x32_bf16 v[172:175], a[96:99], a[4:7], v[172:175]
    v_mfma_f32_16x16x32_bf16 v[196:199], a[96:99], a[8:11], v[196:199]
    v_mfma_f32_16x16x32_bf16 v[220:223], a[96:99], a[12:15], v[220:223]
    s_add_u32 s44, s44, 4096
    s_add_u32 m0, m0, 4096
    s_nop 0
    buffer_load_dwordx4 v1, s[4:7], s44 offen offset:0 sc1 lds
    v_mfma_f32_16x16x32_bf16 v[152:155], a[100:103], a[0:3], v[152:155]
    v_mfma_f32_16x16x32_bf16 v[176:179], a[100:103], a[4:7], v[176:179]
    v_mfma_f32_16x16x32_bf16 v[200:203], a[100:103], a[8:11], v[200:203]
    v_mfma_f32_16x16x32_bf16 v[224:227], a[100:103], a[12:15], v[224:227]
    s_waitcnt vmcnt(12) lgkmcnt(0)
    v_mfma_f32_16x16x32_bf16 v[132:135], a[108:111], a[20:23], v[132:135]
    ds_read_b128 a[80:83], v5 offset:36864
    v_mfma_f32_16x16x32_bf16 v[156:159], a[108:111], a[24:27], v[156:159]
    buffer_load_dwordx4 a[0:3], v2, s[40:43], s35 offen offset:0 sc1
    v_mfma_f32_16x16x32_bf16 v[180:183], a[108:111], a[28:31], v[180:183]
    ds_read_b128 a[84:87], v5 offset:37888
    v_mfma_f32_16x16x32_bf16 v[204:207], a[108:111], a[32:35], v[204:207]
    v_mfma_f32_16x16x32_bf16 v[136:139], a[112:115], a[20:23], v[136:139]
    buffer_load_dwordx4 a[4:7], v2, s[40:43], s35 offen offset:1024 sc1
    v_mfma_f32_16x16x32_bf16 v[160:163], a[112:115], a[24:27], v[160:163]
    ds_read_b128 a[88:91], v5 offset:38912
    v_mfma_f32_16x16x32_bf16 v[184:187], a[112:115], a[28:31], v[184:187]
    v_mfma_f32_16x16x32_bf16 v[208:211], a[112:115], a[32:35], v[208:211]
    v_mfma_f32_16x16x32_bf16 v[140:143], a[116:119], a[20:23], v[140:143]
    ds_read_b128 a[92:95], v5 offset:39936
    buffer_load_dwordx4 a[8:11], v2, s[40:43], s35 offen offset:2048 sc1
    v_mfma_f32_16x16x32_bf16 v[164:167], a[116:119], a[24:27], v[164:167]
    v_mfma_f32_16x16x32_bf16 v[188:191], a[116:119], a[28:31], v[188:191]
    v_mfma_f32_16x16x32_bf16 v[212:215], a[116:119], a[32:35], v[212:215]
    ds_read_b128 a[96:99], v5 offset:40960
    v_mfma_f32_16x16x32_bf16 v[144:147], a[120:123], a[20:23], v[144:147]
    buffer_load_dwordx4 a[12:15], v2, s[40:43], s35 offen offset:3072 sc1
    s_add_u32 s35, s35, 4096
    s_and_b32 s35, s35, 0x1ffff
    v_mfma_f32_16x16x32_bf16 v[168:171], a[120:123], a[24:27], v[168:171]
    v_mfma_f32_16x16x32_bf16 v[192:195], a[120:123], a[28:31], v[192:195]
    ds_read_b128 a[100:103], v5 offset:41984
    v_mfma_f32_16x16x32_bf16 v[216:219], a[120:123], a[32:35], v[216:219]
    v_mfma_f32_16x16x32_bf16 v[148:151], a[124:127], a[20:23], v[148:151]
    buffer_load_dwordx4 v1, s[4:7], s44 offen offset:1024 sc1 lds
    v_mfma_f32_16x16x32_bf16 v[172:175], a[124:127], a[24:27], v[172:175]
    v_mfma_f32_16x16x32_bf16 v[196:199], a[124:127], a[28:31], v[196:199]
    v_mfma_f32_16x16x32_bf16 v[220:223], a[124:127], a[32:35], v[220:223]
    v_mfma_f32_16x16x32_bf16 v[152:155], a[128:131], a[20:23], v[152:155]
    buffer_load_dwordx4 v1, s[4:7], s44 offen offset:2048 sc1 lds
    v_mfma_f32_16x16x32_bf16 v[176:179], a[128:131], a[24:27], v[176:179]
    v_mfma_f32_16x16x32_bf16 v[200:203], a[128:131], a[28:31], v[200:203]
    v_mfma_f32_16x16x32_bf16 v[224:227], a[128:131], a[32:35], v[224:227]
    s_waitcnt vmcnt(13) lgkmcnt(0)
    v_mfma_f32_16x16x32_bf16 v[132:135], a[80:83], a[40:43], v[132:135]
    ds_read_b128 a[108:111], v5 offset:43008
    v_mfma_f32_16x16x32_bf16 v[156:159], a[80:83], a[44:47], v[156:159]
    buffer_load_dwordx4 a[20:23], v2, s[40:43], s35 offen offset:0 sc1
    v_mfma_f32_16x16x32_bf16 v[180:183], a[80:83], a[48:51], v[180:183]
    ds_read_b128 a[112:115], v5 offset:44032
    v_mfma_f32_16x16x32_bf16 v[204:207], a[80:83], a[52:55], v[204:207]
    v_mfma_f32_16x16x32_bf16 v[136:139], a[84:87], a[40:43], v[136:139]
    v_mfma_f32_16x16x32_bf16 v[160:163], a[84:87], a[44:47], v[160:163]
    ds_read_b128 a[116:119], v5 offset:45056
    buffer_load_dwordx4 a[24:27], v2, s[40:43], s35 offen offset:1024 sc1
    v_mfma_f32_16x16x32_bf16 v[184:187], a[84:87], a[48:51], v[184:187]
    v_mfma_f32_16x16x32_bf16 v[208:211], a[84:87], a[52:55], v[208:211]
    v_mfma_f32_16x16x32_bf16 v[140:143], a[88:91], a[40:43], v[140:143]
    ds_read_b128 a[120:123], v5 offset:46080
    v_mfma_f32_16x16x32_bf16 v[164:167], a[88:91], a[44:47], v[164:167]
    v_mfma_f32_16x16x32_bf16 v[188:191], a[88:91], a[48:51], v[188:191]
    buffer_load_dwordx4 a[28:31], v2, s[40:43], s35 offen offset:2048 sc1
    v_mfma_f32_16x16x32_bf16 v[212:215], a[88:91], a[52:55], v[212:215]
    ds_read_b128 a[124:127], v5 offset:47104
    v_mfma_f32_16x16x32_bf16 v[144:147], a[92:95], a[40:43], v[144:147]
    v_mfma_f32_16x16x32_bf16 v[168:171], a[92:95], a[44:47], v[168:171]
    v_mfma_f32_16x16x32_bf16 v[192:195], a[92:95], a[48:51], v[192:195]
    ds_read_b128 a[128:131], v5 offset:48128
    buffer_load_dwordx4 a[32:35], v2, s[40:43], s35 offen offset:3072 sc1
    s_add_u32 s35, s35, 4096
    s_and_b32 s35, s35, 0x1ffff
    v_mfma_f32_16x16x32_bf16 v[216:219], a[92:95], a[52:55], v[216:219]
    v_mfma_f32_16x16x32_bf16 v[148:151], a[96:99], a[40:43], v[148:151]
    v_mfma_f32_16x16x32_bf16 v[172:175], a[96:99], a[44:47], v[172:175]
    v_mfma_f32_16x16x32_bf16 v[196:199], a[96:99], a[48:51], v[196:199]
    v_mfma_f32_16x16x32_bf16 v[220:223], a[96:99], a[52:55], v[220:223]
    buffer_load_dwordx4 v1, s[4:7], s44 offen offset:3072 sc1 lds
    v_mfma_f32_16x16x32_bf16 v[152:155], a[100:103], a[40:43], v[152:155]
    v_mfma_f32_16x16x32_bf16 v[176:179], a[100:103], a[44:47], v[176:179]
    v_mfma_f32_16x16x32_bf16 v[200:203], a[100:103], a[48:51], v[200:203]
    v_mfma_f32_16x16x32_bf16 v[224:227], a[100:103], a[52:55], v[224:227]
    s_waitcnt vmcnt(12) lgkmcnt(0)
    s_barrier
    v_mfma_f32_16x16x32_bf16 v[132:135], a[108:111], a[60:63], v[132:135]
    v_add_u32 v5, 98304, v1
    ds_read_b128 a[80:83], v5 offset:0
    v_mfma_f32_16x16x32_bf16 v[156:159], a[108:111], a[64:67], v[156:159]
    buffer_load_dwordx4 a[40:43], v2, s[40:43], s35 offen offset:0 sc1
    v_mfma_f32_16x16x32_bf16 v[180:183], a[108:111], a[68:71], v[180:183]
    ds_read_b128 a[84:87], v5 offset:1024
    v_mfma_f32_16x16x32_bf16 v[204:207], a[108:111], a[72:75], v[204:207]
    v_mfma_f32_16x16x32_bf16 v[136:139], a[112:115], a[60:63], v[136:139]
    v_mfma_f32_16x16x32_bf16 v[160:163], a[112:115], a[64:67], v[160:163]
    ds_read_b128 a[88:91], v5 offset:2048
    v_mfma_f32_16x16x32_bf16 v[184:187], a[112:115], a[68:71], v[184:187]
    buffer_load_dwordx4 a[44:47], v2, s[40:43], s35 offen offset:1024 sc1
    v_mfma_f32_16x16x32_bf16 v[208:211], a[112:115], a[72:75], v[208:211]
    v_mfma_f32_16x16x32_bf16 v[140:143], a[116:119], a[60:63], v[140:143]
    ds_read_b128 a[92:95], v5 offset:3072
    v_mfma_f32_16x16x32_bf16 v[164:167], a[116:119], a[64:67], v[164:167]
    v_mfma_f32_16x16x32_bf16 v[188:191], a[116:119], a[68:71], v[188:191]
    v_mfma_f32_16x16x32_bf16 v[212:215], a[116:119], a[72:75], v[212:215]
    ds_read_b128 a[96:99], v5 offset:4096
    v_mfma_f32_16x16x32_bf16 v[144:147], a[120:123], a[60:63], v[144:147]
    buffer_load_dwordx4 a[48:51], v2, s[40:43], s35 offen offset:2048 sc1
    v_mfma_f32_16x16x32_bf16 v[168:171], a[120:123], a[64:67], v[168:171]
    v_mfma_f32_16x16x32_bf16 v[192:195], a[120:123], a[68:71], v[192:195]
    ds_read_b128 a[100:103], v5 offset:5120
    v_mfma_f32_16x16x32_bf16 v[216:219], a[120:123], a[72:75], v[216:219]
    v_mfma_f32_16x16x32_bf16 v[148:151], a[124:127], a[60:63], v[148:151]
    v_mfma_f32_16x16x32_bf16 v[172:175], a[124:127], a[64:67], v[172:175]
    v_mfma_f32_16x16x32_bf16 v[196:199], a[124:127], a[68:71], v[196:199]
    buffer_load_dwordx4 a[52:55], v2, s[40:43], s35 offen offset:3072 sc1
    s_add_u32 s35, s35, 4096
    s_and_b32 s35, s35, 0x1ffff
    v_mfma_f32_16x16x32_bf16 v[220:223], a[124:127], a[72:75], v[220:223]
    v_mfma_f32_16x16x32_bf16 v[152:155], a[128:131], a[60:63], v[152:155]
    v_mfma_f32_16x16x32_bf16 v[176:179], a[128:131], a[64:67], v[176:179]
    v_mfma_f32_16x16x32_bf16 v[200:203], a[128:131], a[68:71], v[200:203]
    v_mfma_f32_16x16x32_bf16 v[224:227], a[128:131], a[72:75], v[224:227]
    s_waitcnt vmcnt(11) lgkmcnt(0)
    v_mfma_f32_16x16x32_bf16 v[132:135], a[80:83], a[0:3], v[132:135]
    ds_read_b128 a[108:111], v5 offset:6144
    v_mfma_f32_16x16x32_bf16 v[156:159], a[80:83], a[4:7], v[156:159]
    buffer_load_dwordx4 a[60:63], v2, s[40:43], s35 offen offset:0 sc1
    v_mfma_f32_16x16x32_bf16 v[180:183], a[80:83], a[8:11], v[180:183]
    ds_read_b128 a[112:115], v5 offset:7168
    v_mfma_f32_16x16x32_bf16 v[204:207], a[80:83], a[12:15], v[204:207]
    v_mfma_f32_16x16x32_bf16 v[136:139], a[84:87], a[0:3], v[136:139]
    v_mfma_f32_16x16x32_bf16 v[160:163], a[84:87], a[4:7], v[160:163]
    ds_read_b128 a[116:119], v5 offset:8192
    v_mfma_f32_16x16x32_bf16 v[184:187], a[84:87], a[8:11], v[184:187]
    buffer_load_dwordx4 a[64:67], v2, s[40:43], s35 offen offset:1024 sc1
    v_mfma_f32_16x16x32_bf16 v[208:211], a[84:87], a[12:15], v[208:211]
    v_mfma_f32_16x16x32_bf16 v[140:143], a[88:91], a[0:3], v[140:143]
    ds_read_b128 a[120:123], v5 offset:9216
    v_mfma_f32_16x16x32_bf16 v[164:167], a[88:91], a[4:7], v[164:167]
    v_mfma_f32_16x16x32_bf16 v[188:191], a[88:91], a[8:11], v[188:191]
    v_mfma_f32_16x16x32_bf16 v[212:215], a[88:91], a[12:15], v[212:215]
    ds_read_b128 a[124:127], v5 offset:10240
    v_mfma_f32_16x16x32_bf16 v[144:147], a[92:95], a[0:3], v[144:147]
    buffer_load_dwordx4 a[68:71], v2, s[40:43], s35 offen offset:2048 sc1
    v_mfma_f32_16x16x32_bf16 v[168:171], a[92:95], a[4:7], v[168:171]
    v_mfma_f32_16x16x32_bf16 v[192:195], a[92:95], a[8:11], v[192:195]
    ds_read_b128 a[128:131], v5 offset:11264
    v_mfma_f32_16x16x32_bf16 v[216:219], a[92:95], a[12:15], v[216:219]
    v_mfma_f32_16x16x32_bf16 v[148:151], a[96:99], a[0:3], v[148:151]
    v_mfma_f32_16x16x32_bf16 v[172:175], a[96:99], a[4:7], v[172:175]
    v_mfma_f32_16x16x32_bf16 v[196:199], a[96:99], a[8:11], v[196:199]
    buffer_load_dwordx4 a[72:75], v2, s[40:43], s35 offen offset:3072 sc1
    s_add_u32 s35, s35, 4096
    s_and_b32 s35, s35, 0x1ffff
    v_mfma_f32_16x16x32_bf16 v[220:223], a[96:99], a[12:15], v[220:223]
    v_mfma_f32_16x16x32_bf16 v[152:155], a[100:103], a[0:3], v[152:155]
    v_mfma_f32_16x16x32_bf16 v[176:179], a[100:103], a[4:7], v[176:179]
    v_mfma_f32_16x16x32_bf16 v[200:203], a[100:103], a[8:11], v[200:203]
    v_mfma_f32_16x16x32_bf16 v[224:227], a[100:103], a[12:15], v[224:227]
    s_waitcnt vmcnt(9) lgkmcnt(0)
    v_mfma_f32_16x16x32_bf16 v[132:135], a[108:111], a[20:23], v[132:135]
    ds_read_b128 a[80:83], v5 offset:12288
    v_mfma_f32_16x16x32_bf16 v[156:159], a[108:111], a[24:27], v[156:159]
    buffer_load_dwordx4 a[0:3], v2, s[40:43], s35 offen offset:0 sc1
    v_mfma_f32_16x16x32_bf16 v[180:183], a[108:111], a[28:31], v[180:183]
    ds_read_b128 a[84:87], v5 offset:13312
    v_mfma_f32_16x16x32_bf16 v[204:207], a[108:111], a[32:35], v[204:207]
    v_mfma_f32_16x16x32_bf16 v[136:139], a[112:115], a[20:23], v[136:139]
    v_mfma_f32_16x16x32_bf16 v[160:163], a[112:115], a[24:27], v[160:163]
    ds_read_b128 a[88:91], v5 offset:14336
    v_mfma_f32_16x16x32_bf16 v[184:187], a[112:115], a[28:31], v[184:187]
    buffer_load_dwordx4 a[4:7], v2, s[40:43], s35 offen offset:1024 sc1
    v_mfma_f32_16x16x32_bf16 v[208:211], a[112:115], a[32:35], v[208:211]
    v_mfma_f32_16x16x32_bf16 v[140:143], a[116:119], a[20:23], v[140:143]
    ds_read_b128 a[92:95], v5 offset:15360
    v_mfma_f32_16x16x32_bf16 v[164:167], a[116:119], a[24:27], v[164:167]
    v_mfma_f32_16x16x32_bf16 v[188:191], a[116:119], a[28:31], v[188:191]
    v_mfma_f32_16x16x32_bf16 v[212:215], a[116:119], a[32:35], v[212:215]
    ds_read_b128 a[96:99], v5 offset:16384
    v_mfma_f32_16x16x32_bf16 v[144:147], a[120:123], a[20:23], v[144:147]
    buffer_load_dwordx4 a[8:11], v2, s[40:43], s35 offen offset:2048 sc1
    v_mfma_f32_16x16x32_bf16 v[168:171], a[120:123], a[24:27], v[168:171]
    v_mfma_f32_16x16x32_bf16 v[192:195], a[120:123], a[28:31], v[192:195]
    ds_read_b128 a[100:103], v5 offset:17408
    v_mfma_f32_16x16x32_bf16 v[216:219], a[120:123], a[32:35], v[216:219]
    v_mfma_f32_16x16x32_bf16 v[148:151], a[124:127], a[20:23], v[148:151]
    v_mfma_f32_16x16x32_bf16 v[172:175], a[124:127], a[24:27], v[172:175]
    v_mfma_f32_16x16x32_bf16 v[196:199], a[124:127], a[28:31], v[196:199]
    buffer_load_dwordx4 a[12:15], v2, s[40:43], s35 offen offset:3072 sc1
    s_add_u32 s35, s35, 4096
    s_and_b32 s35, s35, 0x1ffff
    v_mfma_f32_16x16x32_bf16 v[220:223], a[124:127], a[32:35], v[220:223]
    v_mfma_f32_16x16x32_bf16 v[152:155], a[128:131], a[20:23], v[152:155]
    v_mfma_f32_16x16x32_bf16 v[176:179], a[128:131], a[24:27], v[176:179]
    v_mfma_f32_16x16x32_bf16 v[200:203], a[128:131], a[28:31], v[200:203]
    v_mfma_f32_16x16x32_bf16 v[224:227], a[128:131], a[32:35], v[224:227]
    s_waitcnt vmcnt(8) lgkmcnt(0)
    v_mfma_f32_16x16x32_bf16 v[132:135], a[80:83], a[40:43], v[132:135]
    ds_read_b128 a[108:111], v5 offset:18432
    v_mfma_f32_16x16x32_bf16 v[156:159], a[80:83], a[44:47], v[156:159]
    buffer_load_dwordx4 a[20:23], v2, s[40:43], s35 offen offset:0 sc1
    v_mfma_f32_16x16x32_bf16 v[180:183], a[80:83], a[48:51], v[180:183]
    ds_read_b128 a[112:115], v5 offset:19456
    v_mfma_f32_16x16x32_bf16 v[204:207], a[80:83], a[52:55], v[204:207]
    v_mfma_f32_16x16x32_bf16 v[136:139], a[84:87], a[40:43], v[136:139]
    v_mfma_f32_16x16x32_bf16 v[160:163], a[84:87], a[44:47], v[160:163]
    ds_read_b128 a[116:119], v5 offset:20480
    v_mfma_f32_16x16x32_bf16 v[184:187], a[84:87], a[48:51], v[184:187]
    buffer_load_dwordx4 a[24:27], v2, s[40:43], s35 offen offset:1024 sc1
    v_mfma_f32_16x16x32_bf16 v[208:211], a[84:87], a[52:55], v[208:211]
    v_mfma_f32_16x16x32_bf16 v[140:143], a[88:91], a[40:43], v[140:143]
    ds_read_b128 a[120:123], v5 offset:21504
    v_mfma_f32_16x16x32_bf16 v[164:167], a[88:91], a[44:47], v[164:167]
    v_mfma_f32_16x16x32_bf16 v[188:191], a[88:91], a[48:51], v[188:191]
    v_mfma_f32_16x16x32_bf16 v[212:215], a[88:91], a[52:55], v[212:215]
    ds_read_b128 a[124:127], v5 offset:22528
    v_mfma_f32_16x16x32_bf16 v[144:147], a[92:95], a[40:43], v[144:147]
    buffer_load_dwordx4 a[28:31], v2, s[40:43], s35 offen offset:2048 sc1
    v_mfma_f32_16x16x32_bf16 v[168:171], a[92:95], a[44:47], v[168:171]
    v_mfma_f32_16x16x32_bf16 v[192:195], a[92:95], a[48:51], v[192:195]
    ds_read_b128 a[128:131], v5 offset:23552
    v_mfma_f32_16x16x32_bf16 v[216:219], a[92:95], a[52:55], v[216:219]
    v_mfma_f32_16x16x32_bf16 v[148:151], a[96:99], a[40:43], v[148:151]
    v_mfma_f32_16x16x32_bf16 v[172:175], a[96:99], a[44:47], v[172:175]
    v_mfma_f32_16x16x32_bf16 v[196:199], a[96:99], a[48:51], v[196:199]
    buffer_load_dwordx4 a[32:35], v2, s[40:43], s35 offen offset:3072 sc1
    s_add_u32 s35, s35, 4096
    s_and_b32 s35, s35, 0x1ffff
    v_mfma_f32_16x16x32_bf16 v[220:223], a[96:99], a[52:55], v[220:223]
    v_mfma_f32_16x16x32_bf16 v[152:155], a[100:103], a[40:43], v[152:155]
    v_mfma_f32_16x16x32_bf16 v[176:179], a[100:103], a[44:47], v[176:179]
    v_mfma_f32_16x16x32_bf16 v[200:203], a[100:103], a[48:51], v[200:203]
    v_mfma_f32_16x16x32_bf16 v[224:227], a[100:103], a[52:55], v[224:227]
    s_waitcnt vmcnt(8) lgkmcnt(0)
    v_mfma_f32_16x16x32_bf16 v[132:135], a[108:111], a[60:63], v[132:135]
    ds_read_b128 a[80:83], v5 offset:24576
    v_mfma_f32_16x16x32_bf16 v[156:159], a[108:111], a[64:67], v[156:159]
    buffer_load_dwordx4 a[40:43], v2, s[40:43], s35 offen offset:0 sc1
    v_mfma_f32_16x16x32_bf16 v[180:183], a[108:111], a[68:71], v[180:183]
    ds_read_b128 a[84:87], v5 offset:25600
    v_mfma_f32_16x16x32_bf16 v[204:207], a[108:111], a[72:75], v[204:207]
    v_mfma_f32_16x16x32_bf16 v[136:139], a[112:115], a[60:63], v[136:139]
    v_mfma_f32_16x16x32_bf16 v[160:163], a[112:115], a[64:67], v[160:163]
    ds_read_b128 a[88:91], v5 offset:26624
    v_mfma_f32_16x16x32_bf16 v[184:187], a[112:115], a[68:71], v[184:187]
    buffer_load_dwordx4 a[44:47], v2, s[40:43], s35 offen offset:1024 sc1
    v_mfma_f32_16x16x32_bf16 v[208:211], a[112:115], a[72:75], v[208:211]
    v_mfma_f32_16x16x32_bf16 v[140:143], a[116:119], a[60:63], v[140:143]
    ds_read_b128 a[92:95], v5 offset:27648
    v_mfma_f32_16x16x32_bf16 v[164:167], a[116:119], a[64:67], v[164:167]
    v_mfma_f32_16x16x32_bf16 v[188:191], a[116:119], a[68:71], v[188:191]
    v_mfma_f32_16x16x32_bf16 v[212:215], a[116:119], a[72:75], v[212:215]
    ds_read_b128 a[96:99], v5 offset:28672
    v_mfma_f32_16x16x32_bf16 v[144:147], a[120:123], a[60:63], v[144:147]
    buffer_load_dwordx4 a[48:51], v2, s[40:43], s35 offen offset:2048 sc1
    v_mfma_f32_16x16x32_bf16 v[168:171], a[120:123], a[64:67], v[168:171]
    v_mfma_f32_16x16x32_bf16 v[192:195], a[120:123], a[68:71], v[192:195]
    ds_read_b128 a[100:103], v5 offset:29696
    v_mfma_f32_16x16x32_bf16 v[216:219], a[120:123], a[72:75], v[216:219]
    v_mfma_f32_16x16x32_bf16 v[148:151], a[124:127], a[60:63], v[148:151]
    v_mfma_f32_16x16x32_bf16 v[172:175], a[124:127], a[64:67], v[172:175]
    v_mfma_f32_16x16x32_bf16 v[196:199], a[124:127], a[68:71], v[196:199]
    buffer_load_dwordx4 a[52:55], v2, s[40:43], s35 offen offset:3072 sc1
    s_add_u32 s35, s35, 4096
    s_and_b32 s35, s35, 0x1ffff
    v_mfma_f32_16x16x32_bf16 v[220:223], a[124:127], a[72:75], v[220:223]
    v_mfma_f32_16x16x32_bf16 v[152:155], a[128:131], a[60:63], v[152:155]
    v_mfma_f32_16x16x32_bf16 v[176:179], a[128:131], a[64:67], v[176:179]
    v_mfma_f32_16x16x32_bf16 v[200:203], a[128:131], a[68:71], v[200:203]
    v_mfma_f32_16x16x32_bf16 v[224:227], a[128:131], a[72:75], v[224:227]
    s_waitcnt vmcnt(8) lgkmcnt(0)
    v_mfma_f32_16x16x32_bf16 v[132:135], a[80:83], a[0:3], v[132:135]
    ds_read_b128 a[108:111], v5 offset:30720
    v_mfma_f32_16x16x32_bf16 v[156:159], a[80:83], a[4:7], v[156:159]
    buffer_load_dwordx4 a[60:63], v2, s[40:43], s35 offen offset:0 sc1
    v_mfma_f32_16x16x32_bf16 v[180:183], a[80:83], a[8:11], v[180:183]
    ds_read_b128 a[112:115], v5 offset:31744
    v_mfma_f32_16x16x32_bf16 v[204:207], a[80:83], a[12:15], v[204:207]
    v_mfma_f32_16x16x32_bf16 v[136:139], a[84:87], a[0:3], v[136:139]
    buffer_load_dwordx4 a[64:67], v2, s[40:43], s35 offen offset:1024 sc1
    v_mfma_f32_16x16x32_bf16 v[160:163], a[84:87], a[4:7], v[160:163]
    ds_read_b128 a[116:119], v5 offset:32768
    v_mfma_f32_16x16x32_bf16 v[184:187], a[84:87], a[8:11], v[184:187]
    v_mfma_f32_16x16x32_bf16 v[208:211], a[84:87], a[12:15], v[208:211]
    buffer_load_dwordx4 a[68:71], v2, s[40:43], s35 offen offset:2048 sc1
    v_mfma_f32_16x16x32_bf16 v[140:143], a[88:91], a[0:3], v[140:143]
    ds_read_b128 a[120:123], v5 offset:33792
    v_mfma_f32_16x16x32_bf16 v[164:167], a[88:91], a[4:7], v[164:167]
    v_mfma_f32_16x16x32_bf16 v[188:191], a[88:91], a[8:11], v[188:191]
    buffer_load_dwordx4 a[72:75], v2, s[40:43], s35 offen offset:3072 sc1
    s_add_u32 s35, s35, 4096
    s_and_b32 s35, s35, 0x1ffff
    v_mfma_f32_16x16x32_bf16 v[212:215], a[88:91], a[12:15], v[212:215]
    ds_read_b128 a[124:127], v5 offset:34816
    v_mfma_f32_16x16x32_bf16 v[144:147], a[92:95], a[0:3], v[144:147]
    v_mfma_f32_16x16x32_bf16 v[168:171], a[92:95], a[4:7], v[168:171]
    v_mfma_f32_16x16x32_bf16 v[192:195], a[92:95], a[8:11], v[192:195]
    ds_read_b128 a[128:131], v5 offset:35840
    s_mov_b32 s36, 0x240000
    s_mov_b32 s37, 0x241000
    buffer_load_dwordx2 v[92:93], v14, s[4:7], s36 offen offset:0 sc1
    v_mfma_f32_16x16x32_bf16 v[216:219], a[92:95], a[12:15], v[216:219]
    v_mfma_f32_16x16x32_bf16 v[148:151], a[96:99], a[0:3], v[148:151]
    v_mfma_f32_16x16x32_bf16 v[172:175], a[96:99], a[4:7], v[172:175]
    buffer_load_dwordx2 v[94:95], v14, s[4:7], s36 offen offset:128 sc1
    v_mfma_f32_16x16x32_bf16 v[196:199], a[96:99], a[8:11], v[196:199]
    v_mfma_f32_16x16x32_bf16 v[220:223], a[96:99], a[12:15], v[220:223]
    v_mfma_f32_16x16x32_bf16 v[152:155], a[100:103], a[0:3], v[152:155]
    buffer_load_dwordx2 v[96:97], v14, s[4:7], s36 offen offset:256 sc1
    v_mfma_f32_16x16x32_bf16 v[176:179], a[100:103], a[4:7], v[176:179]
    v_mfma_f32_16x16x32_bf16 v[200:203], a[100:103], a[8:11], v[200:203]
    v_mfma_f32_16x16x32_bf16 v[224:227], a[100:103], a[12:15], v[224:227]
    s_waitcnt vmcnt(11) lgkmcnt(0)
    v_mfma_f32_16x16x32_bf16 v[132:135], a[108:111], a[20:23], v[132:135]
    ds_read_b128 a[80:83], v5 offset:36864
    v_mfma_f32_16x16x32_bf16 v[156:159], a[108:111], a[24:27], v[156:159]
    buffer_load_dwordx4 a[0:3], v2, s[40:43], s35 offen offset:0 sc1
    v_mfma_f32_16x16x32_bf16 v[180:183], a[108:111], a[28:31], v[180:183]
    ds_read_b128 a[84:87], v5 offset:37888
    v_mfma_f32_16x16x32_bf16 v[204:207], a[108:111], a[32:35], v[204:207]
    v_mfma_f32_16x16x32_bf16 v[136:139], a[112:115], a[20:23], v[136:139]
    buffer_load_dwordx4 a[4:7], v2, s[40:43], s35 offen offset:1024 sc1
    v_mfma_f32_16x16x32_bf16 v[160:163], a[112:115], a[24:27], v[160:163]
    ds_read_b128 a[88:91], v5 offset:38912
    v_mfma_f32_16x16x32_bf16 v[184:187], a[112:115], a[28:31], v[184:187]
    v_mfma_f32_16x16x32_bf16 v[208:211], a[112:115], a[32:35], v[208:211]
    v_mfma_f32_16x16x32_bf16 v[140:143], a[116:119], a[20:23], v[140:143]
    ds_read_b128 a[92:95], v5 offset:39936
    buffer_load_dwordx4 a[8:11], v2, s[40:43], s35 offen offset:2048 sc1
    v_mfma_f32_16x16x32_bf16 v[164:167], a[116:119], a[24:27], v[164:167]
    v_mfma_f32_16x16x32_bf16 v[188:191], a[116:119], a[28:31], v[188:191]
    v_mfma_f32_16x16x32_bf16 v[212:215], a[116:119], a[32:35], v[212:215]
    ds_read_b128 a[96:99], v5 offset:40960
    v_mfma_f32_16x16x32_bf16 v[144:147], a[120:123], a[20:23], v[144:147]
    buffer_load_dwordx4 a[12:15], v2, s[40:43], s35 offen offset:3072 sc1
    s_add_u32 s35, s35, 4096
    s_and_b32 s35, s35, 0x1ffff
    v_mfma_f32_16x16x32_bf16 v[168:171], a[120:123], a[24:27], v[168:171]
    v_mfma_f32_16x16x32_bf16 v[192:195], a[120:123], a[28:31], v[192:195]
    ds_read_b128 a[100:103], v5 offset:41984
    v_mfma_f32_16x16x32_bf16 v[216:219], a[120:123], a[32:35], v[216:219]
    v_mfma_f32_16x16x32_bf16 v[148:151], a[124:127], a[20:23], v[148:151]
    buffer_load_dwordx2 v[98:99], v14, s[4:7], s36 offen offset:384 sc1
    v_mfma_f32_16x16x32_bf16 v[172:175], a[124:127], a[24:27], v[172:175]
    v_mfma_f32_16x16x32_bf16 v[196:199], a[124:127], a[28:31], v[196:199]
    v_mfma_f32_16x16x32_bf16 v[220:223], a[124:127], a[32:35], v[220:223]
    v_mfma_f32_16x16x32_bf16 v[152:155], a[128:131], a[20:23], v[152:155]
    buffer_load_dwordx2 v[100:101], v14, s[4:7], s36 offen offset:2048 sc1
    v_mfma_f32_16x16x32_bf16 v[176:179], a[128:131], a[24:27], v[176:179]
    v_mfma_f32_16x16x32_bf16 v[200:203], a[128:131], a[28:31], v[200:203]
    v_mfma_f32_16x16x32_bf16 v[224:227], a[128:131], a[32:35], v[224:227]
    s_waitcnt vmcnt(13) lgkmcnt(0)
    v_mfma_f32_16x16x32_bf16 v[132:135], a[80:83], a[40:43], v[132:135]
    ds_read_b128 a[108:111], v5 offset:43008
    v_mfma_f32_16x16x32_bf16 v[156:159], a[80:83], a[44:47], v[156:159]
    buffer_load_dwordx4 a[20:23], v2, s[40:43], s35 offen offset:0 sc1
    v_mfma_f32_16x16x32_bf16 v[180:183], a[80:83], a[48:51], v[180:183]
    ds_read_b128 a[112:115], v5 offset:44032
    v_mfma_f32_16x16x32_bf16 v[204:207], a[80:83], a[52:55], v[204:207]
    v_mfma_f32_16x16x32_bf16 v[136:139], a[84:87], a[40:43], v[136:139]
    buffer_load_dwordx4 a[24:27], v2, s[40:43], s35 offen offset:1024 sc1
    v_mfma_f32_16x16x32_bf16 v[160:163], a[84:87], a[44:47], v[160:163]
    ds_read_b128 a[116:119], v5 offset:45056
    v_mfma_f32_16x16x32_bf16 v[184:187], a[84:87], a[48:51], v[184:187]
    v_mfma_f32_16x16x32_bf16 v[208:211], a[84:87], a[52:55], v[208:211]
    buffer_load_dwordx4 a[28:31], v2, s[40:43], s35 offen offset:2048 sc1
    v_mfma_f32_16x16x32_bf16 v[140:143], a[88:91], a[40:43], v[140:143]
    ds_read_b128 a[120:123], v5 offset:46080
    v_mfma_f32_16x16x32_bf16 v[164:167], a[88:91], a[44:47], v[164:167]
    v_mfma_f32_16x16x32_bf16 v[188:191], a[88:91], a[48:51], v[188:191]
    buffer_load_dwordx4 a[32:35], v2, s[40:43], s35 offen offset:3072 sc1
    s_add_u32 s35, s35, 4096
    s_and_b32 s35, s35, 0x1ffff
    v_mfma_f32_16x16x32_bf16 v[212:215], a[88:91], a[52:55], v[212:215]
    ds_read_b128 a[124:127], v5 offset:47104
    v_mfma_f32_16x16x32_bf16 v[144:147], a[92:95], a[40:43], v[144:147]
    v_mfma_f32_16x16x32_bf16 v[168:171], a[92:95], a[44:47], v[168:171]
    v_mfma_f32_16x16x32_bf16 v[192:195], a[92:95], a[48:51], v[192:195]
    ds_read_b128 a[128:131], v5 offset:48128
    buffer_load_dwordx2 v[102:103], v14, s[4:7], s36 offen offset:2176 sc1
    v_mfma_f32_16x16x32_bf16 v[216:219], a[92:95], a[52:55], v[216:219]
    v_mfma_f32_16x16x32_bf16 v[148:151], a[96:99], a[40:43], v[148:151]
    v_mfma_f32_16x16x32_bf16 v[172:175], a[96:99], a[44:47], v[172:175]
    buffer_load_dwordx2 v[104:105], v14, s[4:7], s36 offen offset:2304 sc1
    v_mfma_f32_16x16x32_bf16 v[196:199], a[96:99], a[48:51], v[196:199]
    v_mfma_f32_16x16x32_bf16 v[220:223], a[96:99], a[52:55], v[220:223]
    v_mfma_f32_16x16x32_bf16 v[152:155], a[100:103], a[40:43], v[152:155]
    buffer_load_dwordx2 v[106:107], v14, s[4:7], s36 offen offset:2432 sc1
    v_mfma_f32_16x16x32_bf16 v[176:179], a[100:103], a[44:47], v[176:179]
    v_mfma_f32_16x16x32_bf16 v[200:203], a[100:103], a[48:51], v[200:203]
    v_mfma_f32_16x16x32_bf16 v[224:227], a[100:103], a[52:55], v[224:227]
    s_waitcnt vmcnt(16) lgkmcnt(0)
    s_barrier
    v_mfma_f32_16x16x32_bf16 v[132:135], a[108:111], a[60:63], v[132:135]
    v_add_u32 v5, 0, v1
    ds_read_b128 a[80:83], v5 offset:0
    v_mfma_f32_16x16x32_bf16 v[156:159], a[108:111], a[64:67], v[156:159]
    buffer_load_dwordx4 a[40:43], v2, s[40:43], s35 offen offset:0 sc1
    v_mfma_f32_16x16x32_bf16 v[180:183], a[108:111], a[68:71], v[180:183]
    ds_read_b128 a[84:87], v5 offset:1024
    v_mfma_f32_16x16x32_bf16 v[204:207], a[108:111], a[72:75], v[204:207]
    v_mfma_f32_16x16x32_bf16 v[136:139], a[112:115], a[60:63], v[136:139]
    buffer_load_dwordx4 a[44:47], v2, s[40:43], s35 offen offset:1024 sc1
    v_mfma_f32_16x16x32_bf16 v[160:163], a[112:115], a[64:67], v[160:163]
    ds_read_b128 a[88:91], v5 offset:2048
    v_mfma_f32_16x16x32_bf16 v[184:187], a[112:115], a[68:71], v[184:187]
    v_mfma_f32_16x16x32_bf16 v[208:211], a[112:115], a[72:75], v[208:211]
    v_mfma_f32_16x16x32_bf16 v[140:143], a[116:119], a[60:63], v[140:143]
    ds_read_b128 a[92:95], v5 offset:3072
    buffer_load_dwordx4 a[48:51], v2, s[40:43], s35 offen offset:2048 sc1
    v_mfma_f32_16x16x32_bf16 v[164:167], a[116:119], a[64:67], v[164:167]
    v_mfma_f32_16x16x32_bf16 v[188:191], a[116:119], a[68:71], v[188:191]
    v_mfma_f32_16x16x32_bf16 v[212:215], a[116:119], a[72:75], v[212:215]
    ds_read_b128 a[96:99], v5 offset:4096
    v_mfma_f32_16x16x32_bf16 v[144:147], a[120:123], a[60:63], v[144:147]
    buffer_load_dwordx4 a[52:55], v2, s[40:43], s35 offen offset:3072 sc1
    s_add_u32 s35, s35, 4096
    s_and_b32 s35, s35, 0x1ffff
    v_mfma_f32_16x16x32_bf16 v[168:171], a[120:123], a[64:67], v[168:171]
    v_mfma_f32_16x16x32_bf16 v[192:195], a[120:123], a[68:71], v[192:195]
    ds_read_b128 a[100:103], v5 offset:5120
    v_mfma_f32_16x16x32_bf16 v[216:219], a[120:123], a[72:75], v[216:219]
    v_mfma_f32_16x16x32_bf16 v[148:151], a[124:127], a[60:63], v[148:151]
    buffer_load_dwordx2 v[108:109], v14, s[4:7], s37 offen offset:0 sc1
    v_mfma_f32_16x16x32_bf16 v[172:175], a[124:127], a[64:67], v[172:175]
    v_mfma_f32_16x16x32_bf16 v[196:199], a[124:127], a[68:71], v[196:199]
    v_mfma_f32_16x16x32_bf16 v[220:223], a[124:127], a[72:75], v[220:223]
    v_mfma_f32_16x16x32_bf16 v[152:155], a[128:131], a[60:63], v[152:155]
    buffer_load_dwordx2 v[110:111], v14, s[4:7], s37 offen offset:128 sc1
    v_mfma_f32_16x16x32_bf16 v[176:179], a[128:131], a[64:67], v[176:179]
    v_mfma_f32_16x16x32_bf16 v[200:203], a[128:131], a[68:71], v[200:203]
    v_mfma_f32_16x16x32_bf16 v[224:227], a[128:131], a[72:75], v[224:227]
    s_waitcnt vmcnt(15) lgkmcnt(0)
    v_mfma_f32_16x16x32_bf16 v[132:135], a[80:83], a[0:3], v[132:135]
    ds_read_b128 a[108:111], v5 offset:6144
    v_mfma_f32_16x16x32_bf16 v[156:159], a[80:83], a[4:7], v[156:159]
    buffer_load_dwordx4 a[60:63], v2, s[40:43], s35 offen offset:0 sc1
    v_mfma_f32_16x16x32_bf16 v[180:183], a[80:83], a[8:11], v[180:183]
    ds_read_b128 a[112:115], v5 offset:7168
    v_mfma_f32_16x16x32_bf16 v[204:207], a[80:83], a[12:15], v[204:207]
    v_mfma_f32_16x16x32_bf16 v[136:139], a[84:87], a[0:3], v[136:139]
    buffer_load_dwordx4 a[64:67], v2, s[40:43], s35 offen offset:1024 sc1
    v_mfma_f32_16x16x32_bf16 v[160:163], a[84:87], a[4:7], v[160:163]
    ds_read_b128 a[116:119], v5 offset:8192
    v_mfma_f32_16x16x32_bf16 v[184:187], a[84:87], a[8:11], v[184:187]
    v_mfma_f32_16x16x32_bf16 v[208:211], a[84:87], a[12:15], v[208:211]
    buffer_load_dwordx4 a[68:71], v2, s[40:43], s35 offen offset:2048 sc1
    v_mfma_f32_16x16x32_bf16 v[140:143], a[88:91], a[0:3], v[140:143]
    ds_read_b128 a[120:123], v5 offset:9216
    v_mfma_f32_16x16x32_bf16 v[164:167], a[88:91], a[4:7], v[164:167]
    v_mfma_f32_16x16x32_bf16 v[188:191], a[88:91], a[8:11], v[188:191]
    buffer_load_dwordx4 a[72:75], v2, s[40:43], s35 offen offset:3072 sc1
    s_add_u32 s35, s35, 4096
    s_and_b32 s35, s35, 0x1ffff
    v_mfma_f32_16x16x32_bf16 v[212:215], a[88:91], a[12:15], v[212:215]
    ds_read_b128 a[124:127], v5 offset:10240
    v_mfma_f32_16x16x32_bf16 v[144:147], a[92:95], a[0:3], v[144:147]
    v_mfma_f32_16x16x32_bf16 v[168:171], a[92:95], a[4:7], v[168:171]
    v_mfma_f32_16x16x32_bf16 v[192:195], a[92:95], a[8:11], v[192:195]
    ds_read_b128 a[128:131], v5 offset:11264
    buffer_load_dwordx2 v[112:113], v14, s[4:7], s37 offen offset:256 sc1
    v_mfma_f32_16x16x32_bf16 v[216:219], a[92:95], a[12:15], v[216:219]
    v_mfma_f32_16x16x32_bf16 v[148:151], a[96:99], a[0:3], v[148:151]
    v_mfma_f32_16x16x32_bf16 v[172:175], a[96:99], a[4:7], v[172:175]
    buffer_load_dwordx2 v[114:115], v14, s[4:7], s37 offen offset:384 sc1
    v_mfma_f32_16x16x32_bf16 v[196:199], a[96:99], a[8:11], v[196:199]
    v_mfma_f32_16x16x32_bf16 v[220:223], a[96:99], a[12:15], v[220:223]
    v_mfma_f32_16x16x32_bf16 v[152:155], a[100:103], a[0:3], v[152:155]
    buffer_load_dwordx2 v[116:117], v14, s[4:7], s37 offen offset:2048 sc1
    v_mfma_f32_16x16x32_bf16 v[176:179], a[100:103], a[4:7], v[176:179]
    v_mfma_f32_16x16x32_bf16 v[200:203], a[100:103], a[8:11], v[200:203]
    v_mfma_f32_16x16x32_bf16 v[224:227], a[100:103], a[12:15], v[224:227]
    s_waitcnt vmcnt(16) lgkmcnt(0)
    v_mfma_f32_16x16x32_bf16 v[132:135], a[108:111], a[20:23], v[132:135]
    ds_read_b128 a[80:83], v5 offset:12288
    v_mfma_f32_16x16x32_bf16 v[156:159], a[108:111], a[24:27], v[156:159]
    buffer_load_dwordx4 a[0:3], v2, s[40:43], s35 offen offset:0 sc1
    v_mfma_f32_16x16x32_bf16 v[180:183], a[108:111], a[28:31], v[180:183]
    ds_read_b128 a[84:87], v5 offset:13312
    v_mfma_f32_16x16x32_bf16 v[204:207], a[108:111], a[32:35], v[204:207]
    v_mfma_f32_16x16x32_bf16 v[136:139], a[112:115], a[20:23], v[136:139]
    buffer_load_dwordx4 a[4:7], v2, s[40:43], s35 offen offset:1024 sc1
    v_mfma_f32_16x16x32_bf16 v[160:163], a[112:115], a[24:27], v[160:163]
    ds_read_b128 a[88:91], v5 offset:14336
    v_mfma_f32_16x16x32_bf16 v[184:187], a[112:115], a[28:31], v[184:187]
    v_mfma_f32_16x16x32_bf16 v[208:211], a[112:115], a[32:35], v[208:211]
    v_mfma_f32_16x16x32_bf16 v[140:143], a[116:119], a[20:23], v[140:143]
    ds_read_b128 a[92:95], v5 offset:15360
    buffer_load_dwordx4 a[8:11], v2, s[40:43], s35 offen offset:2048 sc1
    v_mfma_f32_16x16x32_bf16 v[164:167], a[116:119], a[24:27], v[164:167]
    v_mfma_f32_16x16x32_bf16 v[188:191], a[116:119], a[28:31], v[188:191]
    v_mfma_f32_16x16x32_bf16 v[212:215], a[116:119], a[32:35], v[212:215]
    ds_read_b128 a[96:99], v5 offset:16384
    v_mfma_f32_16x16x32_bf16 v[144:147], a[120:123], a[20:23], v[144:147]
    buffer_load_dwordx4 a[12:15], v2, s[40:43], s35 offen offset:3072 sc1
    s_add_u32 s35, s35, 4096
    s_and_b32 s35, s35, 0x1ffff
    v_mfma_f32_16x16x32_bf16 v[168:171], a[120:123], a[24:27], v[168:171]
    v_mfma_f32_16x16x32_bf16 v[192:195], a[120:123], a[28:31], v[192:195]
    ds_read_b128 a[100:103], v5 offset:17408
    v_mfma_f32_16x16x32_bf16 v[216:219], a[120:123], a[32:35], v[216:219]
    v_mfma_f32_16x16x32_bf16 v[148:151], a[124:127], a[20:23], v[148:151]
    buffer_load_dwordx2 v[118:119], v14, s[4:7], s37 offen offset:2176 sc1
    v_mfma_f32_16x16x32_bf16 v[172:175], a[124:127], a[24:27], v[172:175]
    v_mfma_f32_16x16x32_bf16 v[196:199], a[124:127], a[28:31], v[196:199]
    v_mfma_f32_16x16x32_bf16 v[220:223], a[124:127], a[32:35], v[220:223]
    v_mfma_f32_16x16x32_bf16 v[152:155], a[128:131], a[20:23], v[152:155]
    buffer_load_dwordx2 v[120:121], v14, s[4:7], s37 offen offset:2304 sc1
    v_mfma_f32_16x16x32_bf16 v[176:179], a[128:131], a[24:27], v[176:179]
    v_mfma_f32_16x16x32_bf16 v[200:203], a[128:131], a[28:31], v[200:203]
    v_mfma_f32_16x16x32_bf16 v[224:227], a[128:131], a[32:35], v[224:227]
    s_waitcnt vmcnt(15) lgkmcnt(0)
    v_mfma_f32_16x16x32_bf16 v[132:135], a[80:83], a[40:43], v[132:135]
    ds_read_b128 a[108:111], v5 offset:18432
    v_mfma_f32_16x16x32_bf16 v[156:159], a[80:83], a[44:47], v[156:159]
    buffer_load_dwordx4 a[20:23], v2, s[40:43], s35 offen offset:0 sc1
    v_mfma_f32_16x16x32_bf16 v[180:183], a[80:83], a[48:51], v[180:183]
    ds_read_b128 a[112:115], v5 offset:19456
    v_mfma_f32_16x16x32_bf16 v[204:207], a[80:83], a[52:55], v[204:207]
    v_mfma_f32_16x16x32_bf16 v[136:139], a[84:87], a[40:43], v[136:139]
    buffer_load_dwordx4 a[24:27], v2, s[40:43], s35 offen offset:1024 sc1
    v_mfma_f32_16x16x32_bf16 v[160:163], a[84:87], a[44:47], v[160:163]
    ds_read_b128 a[116:119], v5 offset:20480
    v_mfma_f32_16x16x32_bf16 v[184:187], a[84:87], a[48:51], v[184:187]
    v_mfma_f32_16x16x32_bf16 v[208:211], a[84:87], a[52:55], v[208:211]
    buffer_load_dwordx4 a[28:31], v2, s[40:43], s35 offen offset:2048 sc1
    v_mfma_f32_16x16x32_bf16 v[140:143], a[88:91], a[40:43], v[140:143]
    ds_read_b128 a[120:123], v5 offset:21504
    v_mfma_f32_16x16x32_bf16 v[164:167], a[88:91], a[44:47], v[164:167]
    v_mfma_f32_16x16x32_bf16 v[188:191], a[88:91], a[48:51], v[188:191]
    buffer_load_dwordx4 a[32:35], v2, s[40:43], s35 offen offset:3072 sc1
    s_add_u32 s35, s35, 4096
    s_and_b32 s35, s35, 0x1ffff
    v_mfma_f32_16x16x32_bf16 v[212:215], a[88:91], a[52:55], v[212:215]
    ds_read_b128 a[124:127], v5 offset:22528
    v_mfma_f32_16x16x32_bf16 v[144:147], a[92:95], a[40:43], v[144:147]
    v_mfma_f32_16x16x32_bf16 v[168:171], a[92:95], a[44:47], v[168:171]
    v_mfma_f32_16x16x32_bf16 v[192:195], a[92:95], a[48:51], v[192:195]
    ds_read_b128 a[128:131], v5 offset:23552
    buffer_load_dwordx2 v[122:123], v14, s[4:7], s37 offen offset:2432 sc1
    v_mfma_f32_16x16x32_bf16 v[216:219], a[92:95], a[52:55], v[216:219]
    v_mfma_f32_16x16x32_bf16 v[148:151], a[96:99], a[40:43], v[148:151]
    v_mfma_f32_16x16x32_bf16 v[172:175], a[96:99], a[44:47], v[172:175]
    s_mul_i32 s38, s30, 12288
    s_add_u32 s38, s38, 0x380000
    buffer_load_dwordx4 v[48:51], v232, s[4:7], s38 offen sc1
    v_mfma_f32_16x16x32_bf16 v[196:199], a[96:99], a[48:51], v[196:199]
    v_mfma_f32_16x16x32_bf16 v[220:223], a[96:99], a[52:55], v[220:223]
    v_mfma_f32_16x16x32_bf16 v[152:155], a[100:103], a[40:43], v[152:155]
    s_add_u32 s38, s38, 2048
    buffer_load_dwordx4 v[52:55], v232, s[4:7], s38 offen sc1
    v_mfma_f32_16x16x32_bf16 v[176:179], a[100:103], a[44:47], v[176:179]
    v_mfma_f32_16x16x32_bf16 v[200:203], a[100:103], a[48:51], v[200:203]
    v_mfma_f32_16x16x32_bf16 v[224:227], a[100:103], a[52:55], v[224:227]
    s_waitcnt vmcnt(16) lgkmcnt(0)
    v_mfma_f32_16x16x32_bf16 v[132:135], a[108:111], a[60:63], v[132:135]
    ds_read_b128 a[80:83], v5 offset:24576
    v_mfma_f32_16x16x32_bf16 v[156:159], a[108:111], a[64:67], v[156:159]
    buffer_load_dwordx4 a[40:43], v2, s[40:43], s35 offen offset:0 sc1
    v_mfma_f32_16x16x32_bf16 v[180:183], a[108:111], a[68:71], v[180:183]
    ds_read_b128 a[84:87], v5 offset:25600
    v_mfma_f32_16x16x32_bf16 v[204:207], a[108:111], a[72:75], v[204:207]
    v_mfma_f32_16x16x32_bf16 v[136:139], a[112:115], a[60:63], v[136:139]
    buffer_load_dwordx4 a[44:47], v2, s[40:43], s35 offen offset:1024 sc1
    v_mfma_f32_16x16x32_bf16 v[160:163], a[112:115], a[64:67], v[160:163]
    ds_read_b128 a[88:91], v5 offset:26624
    v_mfma_f32_16x16x32_bf16 v[184:187], a[112:115], a[68:71], v[184:187]
    v_mfma_f32_16x16x32_bf16 v[208:211], a[112:115], a[72:75], v[208:211]
    v_mfma_f32_16x16x32_bf16 v[140:143], a[116:119], a[60:63], v[140:143]
    ds_read_b128 a[92:95], v5 offset:27648
    buffer_load_dwordx4 a[48:51], v2, s[40:43], s35 offen offset:2048 sc1
    v_mfma_f32_16x16x32_bf16 v[164:167], a[116:119], a[64:67], v[164:167]
    v_mfma_f32_16x16x32_bf16 v[188:191], a[116:119], a[68:71], v[188:191]
    v_mfma_f32_16x16x32_bf16 v[212:215], a[116:119], a[72:75], v[212:215]
    ds_read_b128 a[96:99], v5 offset:28672
    v_mfma_f32_16x16x32_bf16 v[144:147], a[120:123], a[60:63], v[144:147]
    buffer_load_dwordx4 a[52:55], v2, s[40:43], s35 offen offset:3072 sc1
    s_add_u32 s35, s35, 4096
    s_and_b32 s35, s35, 0x1ffff
    v_mfma_f32_16x16x32_bf16 v[168:171], a[120:123], a[64:67], v[168:171]
    v_mfma_f32_16x16x32_bf16 v[192:195], a[120:123], a[68:71], v[192:195]
    ds_read_b128 a[100:103], v5 offset:29696
    v_mfma_f32_16x16x32_bf16 v[216:219], a[120:123], a[72:75], v[216:219]
    v_mfma_f32_16x16x32_bf16 v[148:151], a[124:127], a[60:63], v[148:151]
    s_add_u32 s38, s38, 2048
    buffer_load_dwordx4 v[56:59], v232, s[4:7], s38 offen sc1
    v_mfma_f32_16x16x32_bf16 v[172:175], a[124:127], a[64:67], v[172:175]
    v_mfma_f32_16x16x32_bf16 v[196:199], a[124:127], a[68:71], v[196:199]
    v_mfma_f32_16x16x32_bf16 v[220:223], a[124:127], a[72:75], v[220:223]
    v_mfma_f32_16x16x32_bf16 v[152:155], a[128:131], a[60:63], v[152:155]
    s_add_u32 s38, s38, 2048
    buffer_load_dwordx4 v[60:63], v232, s[4:7], s38 offen sc1
    v_mfma_f32_16x16x32_bf16 v[176:179], a[128:131], a[64:67], v[176:179]
    v_mfma_f32_16x16x32_bf16 v[200:203], a[128:131], a[68:71], v[200:203]
    v_mfma_f32_16x16x32_bf16 v[224:227], a[128:131], a[72:75], v[224:227]
    s_waitcnt vmcnt(15) lgkmcnt(0)
    v_mfma_f32_16x16x32_bf16 v[132:135], a[80:83], a[0:3], v[132:135]
    ds_read_b128 a[108:111], v5 offset:30720
    v_mfma_f32_16x16x32_bf16 v[156:159], a[80:83], a[4:7], v[156:159]
    buffer_load_dwordx4 a[60:63], v2, s[40:43], s35 offen offset:0 sc1
    v_mfma_f32_16x16x32_bf16 v[180:183], a[80:83], a[8:11], v[180:183]
    ds_read_b128 a[112:115], v5 offset:31744
    v_mfma_f32_16x16x32_bf16 v[204:207], a[80:83], a[12:15], v[204:207]
    v_mfma_f32_16x16x32_bf16 v[136:139], a[84:87], a[0:3], v[136:139]
    buffer_load_dwordx4 a[64:67], v2, s[40:43], s35 offen offset:1024 sc1
    v_mfma_f32_16x16x32_bf16 v[160:163], a[84:87], a[4:7], v[160:163]
    ds_read_b128 a[116:119], v5 offset:32768
    v_mfma_f32_16x16x32_bf16 v[184:187], a[84:87], a[8:11], v[184:187]
    v_mfma_f32_16x16x32_bf16 v[208:211], a[84:87], a[12:15], v[208:211]
    v_mfma_f32_16x16x32_bf16 v[140:143], a[88:91], a[0:3], v[140:143]
    ds_read_b128 a[120:123], v5 offset:33792
    buffer_load_dwordx4 a[68:71], v2, s[40:43], s35 offen offset:2048 sc1
    v_mfma_f32_16x16x32_bf16 v[164:167], a[88:91], a[4:7], v[164:167]
    v_mfma_f32_16x16x32_bf16 v[188:191], a[88:91], a[8:11], v[188:191]
    v_mfma_f32_16x16x32_bf16 v[212:215], a[88:91], a[12:15], v[212:215]
    ds_read_b128 a[124:127], v5 offset:34816
    v_mfma_f32_16x16x32_bf16 v[144:147], a[92:95], a[0:3], v[144:147]
    buffer_load_dwordx4 a[72:75], v2, s[40:43], s35 offen offset:3072 sc1
    s_add_u32 s35, s35, 4096
    s_and_b32 s35, s35, 0x1ffff
    v_mfma_f32_16x16x32_bf16 v[168:171], a[92:95], a[4:7], v[168:171]
    v_mfma_f32_16x16x32_bf16 v[192:195], a[92:95], a[8:11], v[192:195]
    ds_read_b128 a[128:131], v5 offset:35840
    v_mfma_f32_16x16x32_bf16 v[216:219], a[92:95], a[12:15], v[216:219]
    v_mfma_f32_16x16x32_bf16 v[148:151], a[96:99], a[0:3], v[148:151]
    s_add_u32 s38, s38, 2048
    buffer_load_dwordx4 v[64:67], v232, s[4:7], s38 offen sc1
    v_mfma_f32_16x16x32_bf16 v[172:175], a[96:99], a[4:7], v[172:175]
    v_mfma_f32_16x16x32_bf16 v[196:199], a[96:99], a[8:11], v[196:199]
    v_mfma_f32_16x16x32_bf16 v[220:223], a[96:99], a[12:15], v[220:223]
    v_mfma_f32_16x16x32_bf16 v[152:155], a[100:103], a[0:3], v[152:155]
    s_add_u32 s38, s38, 2048
    buffer_load_dwordx4 v[68:71], v232, s[4:7], s38 offen sc1
    v_mfma_f32_16x16x32_bf16 v[176:179], a[100:103], a[4:7], v[176:179]
    v_mfma_f32_16x16x32_bf16 v[200:203], a[100:103], a[8:11], v[200:203]
    v_mfma_f32_16x16x32_bf16 v[224:227], a[100:103], a[12:15], v[224:227]
    s_waitcnt vmcnt(15) lgkmcnt(0)
    v_mfma_f32_16x16x32_bf16 v[132:135], a[108:111], a[20:23], v[132:135]
    ds_read_b128 a[80:83], v5 offset:36864
    v_mfma_f32_16x16x32_bf16 v[156:159], a[108:111], a[24:27], v[156:159]
    v_mfma_f32_16x16x32_bf16 v[180:183], a[108:111], a[28:31], v[180:183]
    ds_read_b128 a[84:87], v5 offset:37888
    v_mfma_f32_16x16x32_bf16 v[204:207], a[108:111], a[32:35], v[204:207]
    v_mfma_f32_16x16x32_bf16 v[136:139], a[112:115], a[20:23], v[136:139]
    v_mfma_f32_16x16x32_bf16 v[160:163], a[112:115], a[24:27], v[160:163]
    ds_read_b128 a[88:91], v5 offset:38912
    v_mfma_f32_16x16x32_bf16 v[184:187], a[112:115], a[28:31], v[184:187]
    v_mfma_f32_16x16x32_bf16 v[208:211], a[112:115], a[32:35], v[208:211]
    v_mfma_f32_16x16x32_bf16 v[140:143], a[116:119], a[20:23], v[140:143]
    ds_read_b128 a[92:95], v5 offset:39936
    v_mfma_f32_16x16x32_bf16 v[164:167], a[116:119], a[24:27], v[164:167]
    v_mfma_f32_16x16x32_bf16 v[188:191], a[116:119], a[28:31], v[188:191]
    v_mfma_f32_16x16x32_bf16 v[212:215], a[116:119], a[32:35], v[212:215]
    ds_read_b128 a[96:99], v5 offset:40960
    v_mfma_f32_16x16x32_bf16 v[144:147], a[120:123], a[20:23], v[144:147]
    v_mfma_f32_16x16x32_bf16 v[168:171], a[120:123], a[24:27], v[168:171]
    v_mfma_f32_16x16x32_bf16 v[192:195], a[120:123], a[28:31], v[192:195]
    ds_read_b128 a[100:103], v5 offset:41984
    v_mfma_f32_16x16x32_bf16 v[216:219], a[120:123], a[32:35], v[216:219]
    v_mfma_f32_16x16x32_bf16 v[148:151], a[124:127], a[20:23], v[148:151]
    v_mfma_f32_16x16x32_bf16 v[172:175], a[124:127], a[24:27], v[172:175]
    v_mfma_f32_16x16x32_bf16 v[196:199], a[124:127], a[28:31], v[196:199]
    v_mfma_f32_16x16x32_bf16 v[220:223], a[124:127], a[32:35], v[220:223]
    v_mfma_f32_16x16x32_bf16 v[152:155], a[128:131], a[20:23], v[152:155]
    v_mfma_f32_16x16x32_bf16 v[176:179], a[128:131], a[24:27], v[176:179]
    v_mfma_f32_16x16x32_bf16 v[200:203], a[128:131], a[28:31], v[200:203]
    v_mfma_f32_16x16x32_bf16 v[224:227], a[128:131], a[32:35], v[224:227]
    s_waitcnt vmcnt(8) lgkmcnt(0)
    v_mfma_f32_16x16x32_bf16 v[132:135], a[80:83], a[40:43], v[132:135]
    ds_read_b128 a[108:111], v5 offset:43008
    v_mfma_f32_16x16x32_bf16 v[156:159], a[80:83], a[44:47], v[156:159]
    v_mfma_f32_16x16x32_bf16 v[180:183], a[80:83], a[48:51], v[180:183]
    ds_read_b128 a[112:115], v5 offset:44032
    v_mfma_f32_16x16x32_bf16 v[204:207], a[80:83], a[52:55], v[204:207]
    v_mfma_f32_16x16x32_bf16 v[136:139], a[84:87], a[40:43], v[136:139]
    v_mfma_f32_16x16x32_bf16 v[160:163], a[84:87], a[44:47], v[160:163]
    ds_read_b128 a[116:119], v5 offset:45056
    v_mfma_f32_16x16x32_bf16 v[184:187], a[84:87], a[48:51], v[184:187]
    v_mfma_f32_16x16x32_bf16 v[208:211], a[84:87], a[52:55], v[208:211]
    v_mfma_f32_16x16x32_bf16 v[140:143], a[88:91], a[40:43], v[140:143]
    ds_read_b128 a[120:123], v5 offset:46080
    v_mfma_f32_16x16x32_bf16 v[164:167], a[88:91], a[44:47], v[164:167]
    v_mfma_f32_16x16x32_bf16 v[188:191], a[88:91], a[48:51], v[188:191]
    v_mfma_f32_16x16x32_bf16 v[212:215], a[88:91], a[52:55], v[212:215]
    ds_read_b128 a[124:127], v5 offset:47104
    v_mfma_f32_16x16x32_bf16 v[144:147], a[92:95], a[40:43], v[144:147]
    v_mfma_f32_16x16x32_bf16 v[168:171], a[92:95], a[44:47], v[168:171]
    v_mfma_f32_16x16x32_bf16 v[192:195], a[92:95], a[48:51], v[192:195]
    ds_read_b128 a[128:131], v5 offset:48128
    v_mfma_f32_16x16x32_bf16 v[216:219], a[92:95], a[52:55], v[216:219]
    v_mfma_f32_16x16x32_bf16 v[148:151], a[96:99], a[40:43], v[148:151]
    v_mfma_f32_16x16x32_bf16 v[172:175], a[96:99], a[44:47], v[172:175]
    v_mfma_f32_16x16x32_bf16 v[196:199], a[96:99], a[48:51], v[196:199]
    v_mfma_f32_16x16x32_bf16 v[220:223], a[96:99], a[52:55], v[220:223]
    v_mfma_f32_16x16x32_bf16 v[152:155], a[100:103], a[40:43], v[152:155]
    v_mfma_f32_16x16x32_bf16 v[176:179], a[100:103], a[44:47], v[176:179]
    v_mfma_f32_16x16x32_bf16 v[200:203], a[100:103], a[48:51], v[200:203]
    v_mfma_f32_16x16x32_bf16 v[224:227], a[100:103], a[52:55], v[224:227]
    s_waitcnt vmcnt(2) lgkmcnt(0)
    s_barrier
    v_mfma_f32_16x16x32_bf16 v[132:135], a[108:111], a[60:63], v[132:135]
    v_mfma_f32_16x16x32_bf16 v[156:159], a[108:111], a[64:67], v[156:159]
    v_mfma_f32_16x16x32_bf16 v[180:183], a[108:111], a[68:71], v[180:183]
    v_mfma_f32_16x16x32_bf16 v[204:207], a[108:111], a[72:75], v[204:207]
    v_mfma_f32_16x16x32_bf16 v[136:139], a[112:115], a[60:63], v[136:139]
    v_mfma_f32_16x16x32_bf16 v[160:163], a[112:115], a[64:67], v[160:163]
    v_mfma_f32_16x16x32_bf16 v[184:187], a[112:115], a[68:71], v[184:187]
    v_mfma_f32_16x16x32_bf16 v[208:211], a[112:115], a[72:75], v[208:211]
    v_mfma_f32_16x16x32_bf16 v[140:143], a[116:119], a[60:63], v[140:143]
    v_mfma_f32_16x16x32_bf16 v[164:167], a[116:119], a[64:67], v[164:167]
    v_mfma_f32_16x16x32_bf16 v[188:191], a[116:119], a[68:71], v[188:191]
    v_mfma_f32_16x16x32_bf16 v[212:215], a[116:119], a[72:75], v[212:215]
    v_mfma_f32_16x16x32_bf16 v[144:147], a[120:123], a[60:63], v[144:147]
    v_mfma_f32_16x16x32_bf16 v[168:171], a[120:123], a[64:67], v[168:171]
    v_mfma_f32_16x16x32_bf16 v[192:195], a[120:123], a[68:71], v[192:195]
    v_mfma_f32_16x16x32_bf16 v[216:219], a[120:123], a[72:75], v[216:219]
    v_mfma_f32_16x16x32_bf16 v[148:151], a[124:127], a[60:63], v[148:151]
    v_mfma_f32_16x16x32_bf16 v[172:175], a[124:127], a[64:67], v[172:175]
    v_mfma_f32_16x16x32_bf16 v[196:199], a[124:127], a[68:71], v[196:199]
    v_mfma_f32_16x16x32_bf16 v[220:223], a[124:127], a[72:75], v[220:223]
    v_mfma_f32_16x16x32_bf16 v[152:155], a[128:131], a[60:63], v[152:155]
    v_mfma_f32_16x16x32_bf16 v[176:179], a[128:131], a[64:67], v[176:179]
    v_mfma_f32_16x16x32_bf16 v[200:203], a[128:131], a[68:71], v[200:203]
    v_mfma_f32_16x16x32_bf16 v[224:227], a[128:131], a[72:75], v[224:227]
    v_pk_add_f32 v[92:93], v[92:93], v[94:95]
    v_pk_add_f32 v[96:97], v[96:97], v[98:99]
    v_pk_add_f32 v[100:101], v[100:101], v[102:103]
    v_pk_add_f32 v[104:105], v[104:105], v[106:107]
    v_pk_add_f32 v[92:93], v[92:93], v[96:97]
    v_pk_add_f32 v[100:101], v[100:101], v[104:105]
    v_pk_add_f32 v[108:109], v[108:109], v[110:111]
    v_permlane32_swap_b32 v92, v93
    v_permlane32_swap_b32 v100, v101
    v_add_f32 v92, v92, v93
    v_add_f32 v100, v100, v101
    v_pk_add_f32 v[112:113], v[112:113], v[114:115]
    v_mov_b32 v94, v92
    v_mov_b32 v102, v100
    v_pk_add_f32 v[108:109], v[108:109], v[112:113]
    v_permlane16_swap_b32 v92, v94
    v_permlane16_swap_b32 v100, v102
    v_permlane32_swap_b32 v108, v109
    v_add_f32 v92, v92, v94
    v_add_f32 v100, v100, v102
    v_add_f32 v108, v108, v109
    v_mov_b32 v94, v92
    v_mov_b32 v102, v100
    v_mov_b32 v110, v108
    v_permlane32_swap_b32 v92, v94
    v_permlane32_swap_b32 v100, v102
    v_permlane16_swap_b32 v108, v110
    v_mul_f32 v82, 0xba800000, v92
    v_mul_f32 v94, 0x3a800000, v94
    v_mul_f32 v84, 0xba800000, v100
    v_mul_f32 v102, 0x3a800000, v102
    v_add_f32 v108, v108, v110
    v_add_f32_dpp v56, v56, v56 row_ror:8 row_mask:0xf bank_mask:0xf
    v_add_f32_dpp v57, v57, v57 row_ror:8 row_mask:0xf bank_mask:0xf
    v_fma_f32 v94, -v82, v82, v94
    v_fma_f32 v102, -v84, v84, v102
    v_add_f32_dpp v58, v58, v58 row_ror:8 row_mask:0xf bank_mask:0xf
    v_add_f32_dpp v59, v59, v59 row_ror:8 row_mask:0xf bank_mask:0xf
    v_mov_b32 v110, v108
    v_add_f32_dpp v60, v60, v60 row_ror:8 row_mask:0xf bank_mask:0xf
    v_add_f32_dpp v61, v61, v61 row_ror:8 row_mask:0xf bank_mask:0xf
    v_add_f32_dpp v62, v62, v62 row_ror:8 row_mask:0xf bank_mask:0xf
    v_add_f32_dpp v63, v63, v63 row_ror:8 row_mask:0xf bank_mask:0xf
    v_max_f32 v94, 0, v94
    v_max_f32 v102, 0, v102
    v_add_f32_dpp v56, v56, v56 row_ror:4 row_mask:0xf bank_mask:0xf
    v_add_f32_dpp v57, v57, v57 row_ror:4 row_mask:0xf bank_mask:0xf
    v_add_f32_dpp v58, v58, v58 row_ror:4 row_mask:0xf bank_mask:0xf
    v_add_f32_dpp v59, v59, v59 row_ror:4 row_mask:0xf bank_mask:0xf
    v_permlane32_swap_b32 v108, v110
    v_add_f32 v94, 0x3727c5ac, v94
    v_add_f32 v102, 0x3727c5ac, v102
    v_add_f32_dpp v60, v60, v60 row_ror:4 row_mask:0xf bank_mask:0xf
    v_add_f32_dpp v61, v61, v61 row_ror:4 row_mask:0xf bank_mask:0xf
    v_add_f32_dpp v62, v62, v62 row_ror:4 row_mask:0xf bank_mask:0xf
    v_add_f32_dpp v63, v63, v63 row_ror:4 row_mask:0xf bank_mask:0xf
    v_add_f32_dpp v56, v56, v56 row_ror:2 row_mask:0xf bank_mask:0xf
    v_add_f32_dpp v57, v57, v57 row_ror:2 row_mask:0xf bank_mask:0xf
    v_rsq_f32 v83, v94
    v_rsq_f32 v85, v102
    v_add_f32_dpp v58, v58, v58 row_ror:2 row_mask:0xf bank_mask:0xf
    v_add_f32_dpp v59, v59, v59 row_ror:2 row_mask:0xf bank_mask:0xf
    v_mul_f32 v86, 0xba800000, v108
    v_mul_f32 v110, 0x3a800000, v110
    v_add_f32_dpp v60, v60, v60 row_ror:2 row_mask:0xf bank_mask:0xf
    v_add_f32_dpp v61, v61, v61 row_ror:2 row_mask:0xf bank_mask:0xf
    v_add_f32_dpp v62, v62, v62 row_ror:2 row_mask:0xf bank_mask:0xf
    v_add_f32_dpp v63, v63, v63 row_ror:2 row_mask:0xf bank_mask:0xf
    v_add_f32_dpp v56, v56, v56 row_ror:1 row_mask:0xf bank_mask:0xf
    v_add_f32_dpp v57, v57, v57 row_ror:1 row_mask:0xf bank_mask:0xf
    v_add_f32_dpp v58, v58, v58 row_ror:1 row_mask:0xf bank_mask:0xf
    v_add_f32_dpp v59, v59, v59 row_ror:1 row_mask:0xf bank_mask:0xf
    v_fma_f32 v110, -v86, v86, v110
    v_add_f32_dpp v60, v60, v60 row_ror:1 row_mask:0xf bank_mask:0xf
    v_add_f32_dpp v61, v61, v61 row_ror:1 row_mask:0xf bank_mask:0xf
    v_add_f32_dpp v62, v62, v62 row_ror:1 row_mask:0xf bank_mask:0xf
    v_add_f32_dpp v63, v63, v63 row_ror:1 row_mask:0xf bank_mask:0xf
    v_pk_fma_f32 v[140:141], v[56:57], v[82:83], v[140:141] op_sel:[0,0,0] op_sel_hi:[1,0,1]
    v_pk_fma_f32 v[164:165], v[56:57], v[84:85], v[164:165] op_sel:[0,0,0] op_sel_hi:[1,0,1]
    v_max_f32 v110, 0, v110
    v_pk_fma_f32 v[142:143], v[58:59], v[82:83], v[142:143] op_sel:[0,0,0] op_sel_hi:[1,0,1]
    v_pk_fma_f32 v[166:167], v[58:59], v[84:85], v[166:167] op_sel:[0,0,0] op_sel_hi:[1,0,1]
    v_pk_fma_f32 v[144:145], v[60:61], v[82:83], v[144:145] op_sel:[0,0,0] op_sel_hi:[1,0,1]
    v_pk_fma_f32 v[146:147], v[62:63], v[82:83], v[146:147] op_sel:[0,0,0] op_sel_hi:[1,0,1]
    v_pk_fma_f32 v[168:169], v[60:61], v[84:85], v[168:169] op_sel:[0,0,0] op_sel_hi:[1,0,1]
    v_pk_fma_f32 v[170:171], v[62:63], v[84:85], v[170:171] op_sel:[0,0,0] op_sel_hi:[1,0,1]
    v_cvt_pk_bf16_f32 v140, v140, v141
    v_cvt_pk_bf16_f32 v164, v164, v165
    v_add_f32 v110, 0x3727c5ac, v110
    v_cvt_pk_bf16_f32 v141, v142, v143
    v_cvt_pk_bf16_f32 v165, v166, v167
    v_cvt_pk_bf16_f32 v142, v144, v145
    v_cvt_pk_bf16_f32 v143, v146, v147
    v_cvt_pk_bf16_f32 v166, v168, v169
    v_cvt_pk_bf16_f32 v167, v170, v171
    v_rsq_f32 v87, v110
    v_mfma_f32_16x16x32_bf16 v[92:95], a[192:195], v[140:143], 0
    v_pk_add_f32 v[116:117], v[116:117], v[118:119]
    v_pk_add_f32 v[120:121], v[120:121], v[122:123]
    s_waitcnt vmcnt(1)
    v_add_f32_dpp v64, v64, v64 row_ror:8 row_mask:0xf bank_mask:0xf
    v_mfma_f32_16x16x32_bf16 v[108:111], a[192:195], v[164:167], 0
    v_pk_add_f32 v[116:117], v[116:117], v[120:121]
    v_add_f32_dpp v65, v65, v65 row_ror:8 row_mask:0xf bank_mask:0xf
    v_mfma_f32_16x16x32_bf16 v[96:99], a[196:199], v[140:143], 0
    v_max3_f32 v236, v92, v93, v94
    v_max3_f32 v237, -v92, -v93, -v94
    v_mfma_f32_16x16x32_bf16 v[112:115], a[196:199], v[164:167], 0
    v_permlane32_swap_b32 v116, v117
    s_nop 0
    v_max3_f32 v242, v108, v109, v110
    v_max3_f32 v243, -v108, -v109, -v110
    v_add_f32 v116, v116, v117
    v_max3_f32 v236, v236, v95, v96
    v_max3_f32 v237, v237, -v95, -v96
    v_max3_f32 v236, v236, v97, v98
    v_max3_f32 v237, v237, -v97, -v98
    v_max3_f32 v242, v242, v111, v112
    v_max3_f32 v243, v243, -v111, -v112
    v_max3_f32 v242, v242, v113, v114
    v_max3_f32 v243, v243, -v113, -v114
    v_max_f32 v236, v236, v99
    v_max_f32_e64 v237, v237, -v99
    v_max_f32 v242, v242, v115
    v_max_f32_e64 v243, v243, -v115
    v_mov_b32 v118, v116
    v_permlane32_swap_b32 v236, v237
    v_permlane32_swap_b32 v242, v243
    v_permlane16_swap_b32 v116, v118
    v_max_f32 v236, v236, v237
    v_max_f32 v242, v242, v243
    v_add_f32 v116, v116, v118
    v_mov_b32 v238, v236
    v_mov_b32 v244, v242
    v_mov_b32 v118, v116
    v_permlane16_swap_b32 v236, v238
    v_permlane16_swap_b32 v242, v244
    v_permlane32_swap_b32 v116, v118
    v_max_f32 v236, v236, v238
    v_max_f32 v242, v242, v244
    v_mul_f32 v88, 0xba800000, v116
    v_mul_f32 v118, 0x3a800000, v118
    v_mov_b32 v238, v236
    v_mov_b32 v244, v242
    v_fma_f32 v118, -v88, v88, v118
    v_add_f32_dpp v66, v66, v66 row_ror:8 row_mask:0xf bank_mask:0xf
    v_add_f32_dpp v67, v67, v67 row_ror:8 row_mask:0xf bank_mask:0xf
    v_max_f32 v118, 0, v118
    s_waitcnt vmcnt(0)
    v_add_f32_dpp v68, v68, v68 row_ror:8 row_mask:0xf bank_mask:0xf
    v_add_f32_dpp v69, v69, v69 row_ror:8 row_mask:0xf bank_mask:0xf
    v_add_f32_dpp v70, v70, v70 row_ror:8 row_mask:0xf bank_mask:0xf
    v_add_f32_dpp v71, v71, v71 row_ror:8 row_mask:0xf bank_mask:0xf
    v_permlane32_swap_b32 v236, v238
    v_permlane32_swap_b32 v242, v244
    v_add_f32_dpp v64, v64, v64 row_ror:4 row_mask:0xf bank_mask:0xf
    v_add_f32_dpp v65, v65, v65 row_ror:4 row_mask:0xf bank_mask:0xf
    v_mul_f32 v240, 0x3fb8aa3b, v83
    v_mul_f32 v246, 0x3fb8aa3b, v85
    v_add_f32_dpp v66, v66, v66 row_ror:4 row_mask:0xf bank_mask:0xf
    v_add_f32_dpp v67, v67, v67 row_ror:4 row_mask:0xf bank_mask:0xf
    v_add_f32 v118, 0x3727c5ac, v118
    v_add_f32_dpp v68, v68, v68 row_ror:4 row_mask:0xf bank_mask:0xf
    v_add_f32_dpp v69, v69, v69 row_ror:4 row_mask:0xf bank_mask:0xf
    v_add_f32_dpp v70, v70, v70 row_ror:4 row_mask:0xf bank_mask:0xf
    v_add_f32_dpp v71, v71, v71 row_ror:4 row_mask:0xf bank_mask:0xf
    v_mul_f32_e64 v236, -v236, v240
    v_mul_f32_e64 v237, -v238, v240
    v_mul_f32_e64 v242, -v242, v246
    v_mul_f32_e64 v243, -v244, v246
    v_add_f32_dpp v64, v64, v64 row_ror:2 row_mask:0xf bank_mask:0xf
    v_add_f32_dpp v65, v65, v65 row_ror:2 row_mask:0xf bank_mask:0xf
    v_rsq_f32 v89, v118
    v_add_f32_dpp v66, v66, v66 row_ror:2 row_mask:0xf bank_mask:0xf
    v_add_f32_dpp v67, v67, v67 row_ror:2 row_mask:0xf bank_mask:0xf
    v_add_f32_dpp v68, v68, v68 row_ror:2 row_mask:0xf bank_mask:0xf
    v_add_f32_dpp v69, v69, v69 row_ror:2 row_mask:0xf bank_mask:0xf
    v_add_f32_dpp v70, v70, v70 row_ror:2 row_mask:0xf bank_mask:0xf
    v_add_f32_dpp v71, v71, v71 row_ror:2 row_mask:0xf bank_mask:0xf
    v_pk_fma_f32 v[100:101], v[92:93], v[240:241], v[236:237] op_sel:[0,0,0] op_sel_hi:[1,0,0]
    v_pk_fma_f32 v[102:103], v[94:95], v[240:241], v[236:237] op_sel:[0,0,0] op_sel_hi:[1,0,0]
    v_pk_fma_f32 v[104:105], v[96:97], v[240:241], v[236:237] op_sel:[0,0,0] op_sel_hi:[1,0,0]
    v_pk_fma_f32 v[106:107], v[98:99], v[240:241], v[236:237] op_sel:[0,0,0] op_sel_hi:[1,0,0]
    v_pk_fma_f32 v[116:117], v[108:109], v[246:247], v[242:243] op_sel:[0,0,0] op_sel_hi:[1,0,0]
    v_pk_fma_f32 v[118:119], v[110:111], v[246:247], v[242:243] op_sel:[0,0,0] op_sel_hi:[1,0,0]
    v_pk_fma_f32 v[120:121], v[112:113], v[246:247], v[242:243] op_sel:[0,0,0] op_sel_hi:[1,0,0]
    v_pk_fma_f32 v[122:123], v[114:115], v[246:247], v[242:243] op_sel:[0,0,0] op_sel_hi:[1,0,0]
    v_pk_fma_f32 v[92:93], v[92:93], v[240:241], v[236:237] op_sel:[0,0,1] op_sel_hi:[1,0,1] neg_lo:[1,0,0] neg_hi:[1,0,0]
    v_pk_fma_f32 v[94:95], v[94:95], v[240:241], v[236:237] op_sel:[0,0,1] op_sel_hi:[1,0,1] neg_lo:[1,0,0] neg_hi:[1,0,0]
    v_pk_fma_f32 v[96:97], v[96:97], v[240:241], v[236:237] op_sel:[0,0,1] op_sel_hi:[1,0,1] neg_lo:[1,0,0] neg_hi:[1,0,0]
    v_pk_fma_f32 v[98:99], v[98:99], v[240:241], v[236:237] op_sel:[0,0,1] op_sel_hi:[1,0,1] neg_lo:[1,0,0] neg_hi:[1,0,0]
    v_pk_fma_f32 v[108:109], v[108:109], v[246:247], v[242:243] op_sel:[0,0,1] op_sel_hi:[1,0,1] neg_lo:[1,0,0] neg_hi:[1,0,0]
    v_pk_fma_f32 v[110:111], v[110:111], v[246:247], v[242:243] op_sel:[0,0,1] op_sel_hi:[1,0,1] neg_lo:[1,0,0] neg_hi:[1,0,0]
    v_pk_fma_f32 v[112:113], v[112:113], v[246:247], v[242:243] op_sel:[0,0,1] op_sel_hi:[1,0,1] neg_lo:[1,0,0] neg_hi:[1,0,0]
    v_pk_fma_f32 v[114:115], v[114:115], v[246:247], v[242:243] op_sel:[0,0,1] op_sel_hi:[1,0,1] neg_lo:[1,0,0] neg_hi:[1,0,0]
    v_add_f32_dpp v64, v64, v64 row_ror:1 row_mask:0xf bank_mask:0xf
    v_add_f32_dpp v65, v65, v65 row_ror:1 row_mask:0xf bank_mask:0xf
    v_add_f32_dpp v66, v66, v66 row_ror:1 row_mask:0xf bank_mask:0xf
    v_add_f32_dpp v67, v67, v67 row_ror:1 row_mask:0xf bank_mask:0xf
    v_add_f32_dpp v68, v68, v68 row_ror:1 row_mask:0xf bank_mask:0xf
    v_add_f32_dpp v69, v69, v69 row_ror:1 row_mask:0xf bank_mask:0xf
    v_add_f32_dpp v70, v70, v70 row_ror:1 row_mask:0xf bank_mask:0xf
    v_add_f32_dpp v71, v71, v71 row_ror:1 row_mask:0xf bank_mask:0xf
    v_exp_f32 v92, v92
    v_exp_f32 v93, v93
    v_exp_f32 v94, v94
    v_exp_f32 v95, v95
    v_exp_f32 v96, v96
    v_exp_f32 v97, v97
    v_exp_f32 v98, v98
    v_exp_f32 v99, v99
    v_exp_f32 v108, v108
    v_exp_f32 v109, v109
    v_exp_f32 v110, v110
    v_exp_f32 v111, v111
    v_exp_f32 v112, v112
    v_exp_f32 v113, v113
    v_exp_f32 v114, v114
    v_exp_f32 v115, v115
    v_pk_fma_f32 v[148:149], v[64:65], v[82:83], v[148:149] op_sel:[0,0,0] op_sel_hi:[1,0,1]
    v_pk_fma_f32 v[172:173], v[64:65], v[84:85], v[172:173] op_sel:[0,0,0] op_sel_hi:[1,0,1]
    v_pk_fma_f32 v[150:151], v[66:67], v[82:83], v[150:151] op_sel:[0,0,0] op_sel_hi:[1,0,1]
    v_pk_fma_f32 v[174:175], v[66:67], v[84:85], v[174:175] op_sel:[0,0,0] op_sel_hi:[1,0,1]
    v_pk_fma_f32 v[152:153], v[68:69], v[82:83], v[152:153] op_sel:[0,0,0] op_sel_hi:[1,0,1]
    v_pk_fma_f32 v[154:155], v[70:71], v[82:83], v[154:155] op_sel:[0,0,0] op_sel_hi:[1,0,1]
    v_pk_fma_f32 v[176:177], v[68:69], v[84:85], v[176:177] op_sel:[0,0,0] op_sel_hi:[1,0,1]
    v_pk_fma_f32 v[178:179], v[70:71], v[84:85], v[178:179] op_sel:[0,0,0] op_sel_hi:[1,0,1]
    v_pk_mul_f32 v[148:149], v[148:149], v[82:83] op_sel:[0,1] op_sel_hi:[1,1]
    v_pk_mul_f32 v[172:173], v[172:173], v[84:85] op_sel:[0,1] op_sel_hi:[1,1]
    v_pk_mul_f32 v[150:151], v[150:151], v[82:83] op_sel:[0,1] op_sel_hi:[1,1]
    v_pk_mul_f32 v[174:175], v[174:175], v[84:85] op_sel:[0,1] op_sel_hi:[1,1]
    v_pk_mul_f32 v[152:153], v[152:153], v[82:83] op_sel:[0,1] op_sel_hi:[1,1]
    v_pk_mul_f32 v[154:155], v[154:155], v[82:83] op_sel:[0,1] op_sel_hi:[1,1]
    v_pk_mul_f32 v[176:177], v[176:177], v[84:85] op_sel:[0,1] op_sel_hi:[1,1]
    v_pk_mul_f32 v[178:179], v[178:179], v[84:85] op_sel:[0,1] op_sel_hi:[1,1]
    v_cvt_pk_bf16_f32 v144, v92, v93
    v_cvt_pk_bf16_f32 v145, v94, v95
    v_cvt_pk_bf16_f32 v146, v96, v97
    v_cvt_pk_bf16_f32 v147, v98, v99
    v_cvt_pk_bf16_f32 v168, v108, v109
    v_cvt_pk_bf16_f32 v169, v110, v111
    v_cvt_pk_bf16_f32 v170, v112, v113
    v_cvt_pk_bf16_f32 v171, v114, v115
    v_cvt_pk_bf16_f32 v148, v148, v149
    v_cvt_pk_bf16_f32 v172, v172, v173
    v_cvt_pk_bf16_f32 v149, v150, v151
    v_cvt_pk_bf16_f32 v173, v174, v175
    v_cvt_pk_bf16_f32 v150, v152, v153
    v_cvt_pk_bf16_f32 v151, v154, v155
    v_cvt_pk_bf16_f32 v174, v176, v177
    v_cvt_pk_bf16_f32 v175, v178, v179
    v_mfma_f32_16x16x32_bf16 v[152:155], v[16:19], v[144:147], 0
    v_pk_fma_f32 v[188:189], v[56:57], v[86:87], v[188:189] op_sel:[0,0,0] op_sel_hi:[1,0,1]
    v_pk_fma_f32 v[212:213], v[56:57], v[88:89], v[212:213] op_sel:[0,0,0] op_sel_hi:[1,0,1]
    v_cvt_pk_bf16_f32 v188, v188, v189
    v_mfma_f32_16x16x32_bf16 v[176:179], v[16:19], v[168:171], 0
    v_pk_fma_f32 v[190:191], v[58:59], v[86:87], v[190:191] op_sel:[0,0,0] op_sel_hi:[1,0,1]
    v_pk_fma_f32 v[214:215], v[58:59], v[88:89], v[214:215] op_sel:[0,0,0] op_sel_hi:[1,0,1]
    v_pk_fma_f32 v[192:193], v[60:61], v[86:87], v[192:193] op_sel:[0,0,0] op_sel_hi:[1,0,1]
    v_pk_fma_f32 v[194:195], v[62:63], v[86:87], v[194:195] op_sel:[0,0,0] op_sel_hi:[1,0,1]
    v_rcp_f32 v152, v152
    v_pk_fma_f32 v[216:217], v[60:61], v[88:89], v[216:217] op_sel:[0,0,0] op_sel_hi:[1,0,1]
    v_pk_fma_f32 v[218:219], v[62:63], v[88:89], v[218:219] op_sel:[0,0,0] op_sel_hi:[1,0,1]
    v_cvt_pk_bf16_f32 v212, v212, v213
    v_rcp_f32 v176, v176
    v_cvt_pk_bf16_f32 v189, v190, v191
    v_cvt_pk_bf16_f32 v213, v214, v215
    v_pk_mul_f32 v[92:93], v[92:93], v[152:153] op_sel:[0,0] op_sel_hi:[1,0]
    v_pk_mul_f32 v[94:95], v[94:95], v[152:153] op_sel:[0,0] op_sel_hi:[1,0]
    v_pk_mul_f32 v[108:109], v[108:109], v[176:177] op_sel:[0,0] op_sel_hi:[1,0]
    v_pk_mul_f32 v[110:111], v[110:111], v[176:177] op_sel:[0,0] op_sel_hi:[1,0]
    v_cvt_pk_bf16_f32 v190, v192, v193
    v_cvt_pk_bf16_f32 v191, v194, v195
    v_cvt_pk_bf16_f32 v214, v216, v217
    v_cvt_pk_bf16_f32 v215, v218, v219
    v_pk_mul_f32 v[96:97], v[96:97], v[152:153] op_sel:[0,0] op_sel_hi:[1,0]
    v_pk_mul_f32 v[98:99], v[98:99], v[152:153] op_sel:[0,0] op_sel_hi:[1,0]
    v_cvt_pk_bf16_f32 v144, v92, v93
    v_cvt_pk_bf16_f32 v145, v94, v95
    v_pk_mul_f32 v[112:113], v[112:113], v[176:177] op_sel:[0,0] op_sel_hi:[1,0]
    v_cvt_pk_bf16_f32 v168, v108, v109
    v_pk_mul_f32 v[114:115], v[114:115], v[176:177] op_sel:[0,0] op_sel_hi:[1,0]
    v_cvt_pk_bf16_f32 v169, v110, v111
    v_mfma_f32_16x16x32_bf16 v[92:95], a[192:195], v[188:191], 0
    v_cvt_pk_bf16_f32 v146, v96, v97
    v_cvt_pk_bf16_f32 v147, v98, v99
    v_mfma_f32_16x16x32_bf16 v[108:111], a[192:195], v[212:215], 0
    v_cvt_pk_bf16_f32 v170, v112, v113
    v_cvt_pk_bf16_f32 v171, v114, v115
    v_mfma_f32_16x16x32_bf16 v[96:99], a[196:199], v[188:191], 0
    v_exp_f32 v100, v100
    v_mfma_f32_16x16x32_bf16 v[112:115], a[196:199], v[212:215], 0
    v_max3_f32 v236, v92, v93, v94
    v_max3_f32 v237, -v92, -v93, -v94
    s_nop 0
    v_max3_f32 v242, v108, v109, v110
    v_max3_f32 v243, -v108, -v109, -v110
    v_exp_f32 v101, v101
    v_max3_f32 v236, v236, v95, v96
    v_max3_f32 v237, v237, -v95, -v96
    v_max3_f32 v236, v236, v97, v98
    v_max3_f32 v242, v242, v111, v112
    v_max3_f32 v243, v243, -v111, -v112
    v_max3_f32 v237, v237, -v97, -v98
    v_max3_f32 v242, v242, v113, v114
    v_max3_f32 v243, v243, -v113, -v114
    v_max_f32 v236, v236, v99
    v_max_f32_e64 v237, v237, -v99
    v_max_f32 v242, v242, v115
    v_max_f32_e64 v243, v243, -v115
    v_exp_f32 v102, v102
    v_exp_f32 v103, v103
    v_exp_f32 v104, v104
    v_exp_f32 v105, v105
    v_exp_f32 v106, v106
    v_exp_f32 v107, v107
    v_exp_f32 v116, v116
    v_exp_f32 v117, v117
    v_exp_f32 v118, v118
    v_exp_f32 v119, v119
    v_exp_f32 v120, v120
    v_exp_f32 v121, v121
    v_exp_f32 v122, v122
    v_exp_f32 v123, v123
    v_permlane32_swap_b32 v236, v237
    v_permlane32_swap_b32 v242, v243
    s_lshl_b32 s36, s28, 12
    v_add_u32 v232, s36, v7
    v_cvt_pk_bf16_f32 v140, v100, v101
    v_cvt_pk_bf16_f32 v141, v102, v103
    v_cvt_pk_bf16_f32 v142, v104, v105
    v_cvt_pk_bf16_f32 v143, v106, v107
    v_cvt_pk_bf16_f32 v164, v116, v117
    v_cvt_pk_bf16_f32 v165, v118, v119
    v_cvt_pk_bf16_f32 v166, v120, v121
    v_cvt_pk_bf16_f32 v167, v122, v123
    v_max_f32 v236, v236, v237
    v_max_f32 v242, v242, v243
    ds_write_b64 v232, v[148:149] offset:0
    ds_write_b64 v232, v[150:151] offset:512
    ds_write_b64 v232, v[172:173] offset:1024
    ds_write_b64 v232, v[174:175] offset:1536
    v_mov_b32 v238, v236
    v_mov_b32 v244, v242
    v_mfma_f32_16x16x32_bf16 v[148:151], v[16:19], v[140:143], 0
    v_permlane16_swap_b32 v236, v238
    v_mfma_f32_16x16x32_bf16 v[172:175], v[16:19], v[164:167], 0
    v_permlane16_swap_b32 v242, v244
    v_max_f32 v236, v236, v238
    v_max_f32 v242, v242, v244
    v_mov_b32 v238, v236
    v_mov_b32 v244, v242
    s_nop 0
    v_rcp_f32 v148, v148
    v_permlane32_swap_b32 v236, v238
    v_rcp_f32 v172, v172
    v_permlane32_swap_b32 v242, v244
    v_mul_f32 v240, 0x3fb8aa3b, v87
    v_mul_f32 v246, 0x3fb8aa3b, v89
    v_pk_mul_f32 v[100:101], v[100:101], v[148:149] op_sel:[0,0] op_sel_hi:[1,0]
    v_pk_mul_f32 v[102:103], v[102:103], v[148:149] op_sel:[0,0] op_sel_hi:[1,0]
    v_pk_mul_f32 v[104:105], v[104:105], v[148:149] op_sel:[0,0] op_sel_hi:[1,0]
    v_pk_mul_f32 v[106:107], v[106:107], v[148:149] op_sel:[0,0] op_sel_hi:[1,0]
    v_pk_mul_f32 v[116:117], v[116:117], v[172:173] op_sel:[0,0] op_sel_hi:[1,0]
    v_pk_mul_f32 v[118:119], v[118:119], v[172:173] op_sel:[0,0] op_sel_hi:[1,0]
    v_pk_mul_f32 v[120:121], v[120:121], v[172:173] op_sel:[0,0] op_sel_hi:[1,0]
    v_pk_mul_f32 v[122:123], v[122:123], v[172:173] op_sel:[0,0] op_sel_hi:[1,0]
    v_mul_f32_e64 v236, -v236, v240
    v_mul_f32_e64 v237, -v238, v240
    v_mul_f32_e64 v242, -v242, v246
    v_mul_f32_e64 v243, -v244, v246
    v_cvt_pk_bf16_f32 v140, v100, v101
    v_cvt_pk_bf16_f32 v141, v102, v103
    v_cvt_pk_bf16_f32 v142, v104, v105
    v_cvt_pk_bf16_f32 v143, v106, v107
    v_cvt_pk_bf16_f32 v164, v116, v117
    v_cvt_pk_bf16_f32 v165, v118, v119
    v_cvt_pk_bf16_f32 v166, v120, v121
    v_cvt_pk_bf16_f32 v167, v122, v123
    v_pk_fma_f32 v[100:101], v[92:93], v[240:241], v[236:237] op_sel:[0,0,0] op_sel_hi:[1,0,0]
    v_pk_fma_f32 v[102:103], v[94:95], v[240:241], v[236:237] op_sel:[0,0,0] op_sel_hi:[1,0,0]
    v_pk_fma_f32 v[104:105], v[96:97], v[240:241], v[236:237] op_sel:[0,0,0] op_sel_hi:[1,0,0]
    v_pk_fma_f32 v[106:107], v[98:99], v[240:241], v[236:237] op_sel:[0,0,0] op_sel_hi:[1,0,0]
    v_pk_fma_f32 v[116:117], v[108:109], v[246:247], v[242:243] op_sel:[0,0,0] op_sel_hi:[1,0,0]
    v_pk_fma_f32 v[118:119], v[110:111], v[246:247], v[242:243] op_sel:[0,0,0] op_sel_hi:[1,0,0]
    v_pk_fma_f32 v[120:121], v[112:113], v[246:247], v[242:243] op_sel:[0,0,0] op_sel_hi:[1,0,0]
    v_pk_fma_f32 v[122:123], v[114:115], v[246:247], v[242:243] op_sel:[0,0,0] op_sel_hi:[1,0,0]
    v_pk_fma_f32 v[196:197], v[64:65], v[86:87], v[196:197] op_sel:[0,0,0] op_sel_hi:[1,0,1]
    v_pk_fma_f32 v[220:221], v[64:65], v[88:89], v[220:221] op_sel:[0,0,0] op_sel_hi:[1,0,1]
    v_pk_fma_f32 v[92:93], v[92:93], v[240:241], v[236:237] op_sel:[0,0,1] op_sel_hi:[1,0,1] neg_lo:[1,0,0] neg_hi:[1,0,0]
    v_pk_fma_f32 v[94:95], v[94:95], v[240:241], v[236:237] op_sel:[0,0,1] op_sel_hi:[1,0,1] neg_lo:[1,0,0] neg_hi:[1,0,0]
    v_pk_fma_f32 v[96:97], v[96:97], v[240:241], v[236:237] op_sel:[0,0,1] op_sel_hi:[1,0,1] neg_lo:[1,0,0] neg_hi:[1,0,0]
    v_pk_fma_f32 v[98:99], v[98:99], v[240:241], v[236:237] op_sel:[0,0,1] op_sel_hi:[1,0,1] neg_lo:[1,0,0] neg_hi:[1,0,0]
    v_pk_fma_f32 v[108:109], v[108:109], v[246:247], v[242:243] op_sel:[0,0,1] op_sel_hi:[1,0,1] neg_lo:[1,0,0] neg_hi:[1,0,0]
    v_pk_fma_f32 v[110:111], v[110:111], v[246:247], v[242:243] op_sel:[0,0,1] op_sel_hi:[1,0,1] neg_lo:[1,0,0] neg_hi:[1,0,0]
    v_pk_fma_f32 v[112:113], v[112:113], v[246:247], v[242:243] op_sel:[0,0,1] op_sel_hi:[1,0,1] neg_lo:[1,0,0] neg_hi:[1,0,0]
    v_pk_fma_f32 v[114:115], v[114:115], v[246:247], v[242:243] op_sel:[0,0,1] op_sel_hi:[1,0,1] neg_lo:[1,0,0] neg_hi:[1,0,0]
    v_pk_fma_f32 v[198:199], v[66:67], v[86:87], v[198:199] op_sel:[0,0,0] op_sel_hi:[1,0,1]
    v_pk_fma_f32 v[222:223], v[66:67], v[88:89], v[222:223] op_sel:[0,0,0] op_sel_hi:[1,0,1]
    v_pk_fma_f32 v[200:201], v[68:69], v[86:87], v[200:201] op_sel:[0,0,0] op_sel_hi:[1,0,1]
    v_pk_fma_f32 v[202:203], v[70:71], v[86:87], v[202:203] op_sel:[0,0,0] op_sel_hi:[1,0,1]
    v_pk_fma_f32 v[224:225], v[68:69], v[88:89], v[224:225] op_sel:[0,0,0] op_sel_hi:[1,0,1]
    v_pk_fma_f32 v[226:227], v[70:71], v[88:89], v[226:227] op_sel:[0,0,0] op_sel_hi:[1,0,1]
    v_pk_mul_f32 v[196:197], v[196:197], v[86:87] op_sel:[0,1] op_sel_hi:[1,1]
    v_pk_mul_f32 v[220:221], v[220:221], v[88:89] op_sel:[0,1] op_sel_hi:[1,1]
    v_exp_f32 v100, v100
    v_exp_f32 v92, v92
    v_exp_f32 v101, v101
    v_exp_f32 v93, v93
    v_exp_f32 v102, v102
    v_exp_f32 v94, v94
    v_exp_f32 v103, v103
    v_exp_f32 v95, v95
    v_exp_f32 v104, v104
    v_exp_f32 v96, v96
    v_exp_f32 v105, v105
    v_exp_f32 v97, v97
    v_exp_f32 v106, v106
    v_exp_f32 v98, v98
    v_exp_f32 v107, v107
    v_exp_f32 v99, v99
    v_exp_f32 v116, v116
    v_exp_f32 v108, v108
    v_exp_f32 v117, v117
    v_exp_f32 v109, v109
    v_exp_f32 v118, v118
    v_exp_f32 v110, v110
    v_exp_f32 v119, v119
    v_exp_f32 v111, v111
    v_exp_f32 v120, v120
    v_exp_f32 v112, v112
    v_exp_f32 v121, v121
    v_exp_f32 v113, v113
    v_exp_f32 v122, v122
    v_exp_f32 v114, v114
    v_exp_f32 v123, v123
    v_exp_f32 v115, v115
    v_pk_mul_f32 v[198:199], v[198:199], v[86:87] op_sel:[0,1] op_sel_hi:[1,1]
    v_pk_mul_f32 v[222:223], v[222:223], v[88:89] op_sel:[0,1] op_sel_hi:[1,1]
    v_pk_mul_f32 v[200:201], v[200:201], v[86:87] op_sel:[0,1] op_sel_hi:[1,1]
    v_pk_mul_f32 v[202:203], v[202:203], v[86:87] op_sel:[0,1] op_sel_hi:[1,1]
    v_pk_mul_f32 v[224:225], v[224:225], v[88:89] op_sel:[0,1] op_sel_hi:[1,1]
    v_pk_mul_f32 v[226:227], v[226:227], v[88:89] op_sel:[0,1] op_sel_hi:[1,1]
    v_cvt_pk_bf16_f32 v196, v196, v197
    v_cvt_pk_bf16_f32 v220, v220, v221
    v_cvt_pk_bf16_f32 v197, v198, v199
    v_cvt_pk_bf16_f32 v221, v222, v223
    v_cvt_pk_bf16_f32 v198, v200, v201
    v_cvt_pk_bf16_f32 v199, v202, v203
    v_cvt_pk_bf16_f32 v222, v224, v225
    v_cvt_pk_bf16_f32 v223, v226, v227
    v_cvt_pk_bf16_f32 v188, v100, v101
    v_cvt_pk_bf16_f32 v189, v102, v103
    v_cvt_pk_bf16_f32 v190, v104, v105
    v_cvt_pk_bf16_f32 v191, v106, v107
    v_cvt_pk_bf16_f32 v192, v92, v93
    v_cvt_pk_bf16_f32 v193, v94, v95
    v_cvt_pk_bf16_f32 v194, v96, v97
    v_cvt_pk_bf16_f32 v195, v98, v99
    v_cvt_pk_bf16_f32 v212, v116, v117
    v_cvt_pk_bf16_f32 v213, v118, v119
    v_cvt_pk_bf16_f32 v214, v120, v121
    v_cvt_pk_bf16_f32 v215, v122, v123
    v_cvt_pk_bf16_f32 v216, v108, v109
    v_cvt_pk_bf16_f32 v217, v110, v111
    v_cvt_pk_bf16_f32 v218, v112, v113
    v_cvt_pk_bf16_f32 v219, v114, v115
    ds_write_b64 v232, v[196:197] offset:2048
    ds_write_b64 v232, v[198:199] offset:2560
    ds_write_b64 v232, v[220:221] offset:3072
    ds_write_b64 v232, v[222:223] offset:3584
    v_mfma_f32_16x16x32_bf16 v[196:199], v[16:19], v[188:191], 0
    v_add_f32_dpp v48, v48, v48 row_ror:8 row_mask:0xf bank_mask:0xf
    v_add_f32_dpp v49, v49, v49 row_ror:8 row_mask:0xf bank_mask:0xf
    v_mfma_f32_16x16x32_bf16 v[200:203], v[16:19], v[192:195], 0
    v_add_f32_dpp v50, v50, v50 row_ror:8 row_mask:0xf bank_mask:0xf
    v_add_f32_dpp v51, v51, v51 row_ror:8 row_mask:0xf bank_mask:0xf
    v_mfma_f32_16x16x32_bf16 v[220:223], v[16:19], v[212:215], 0
    v_add_f32_dpp v52, v52, v52 row_ror:8 row_mask:0xf bank_mask:0xf
    v_add_f32_dpp v53, v53, v53 row_ror:8 row_mask:0xf bank_mask:0xf
    v_mfma_f32_16x16x32_bf16 v[224:227], v[16:19], v[216:219], 0
    v_add_f32_dpp v54, v54, v54 row_ror:8 row_mask:0xf bank_mask:0xf
    v_add_f32_dpp v55, v55, v55 row_ror:8 row_mask:0xf bank_mask:0xf
    v_rcp_f32 v196, v196
    v_rcp_f32 v200, v200
    s_nop 0
    v_rcp_f32 v220, v220
    v_add_f32_dpp v48, v48, v48 row_ror:4 row_mask:0xf bank_mask:0xf
    s_nop 0
    v_rcp_f32 v224, v224
    v_add_f32_dpp v49, v49, v49 row_ror:4 row_mask:0xf bank_mask:0xf
    v_add_f32_dpp v50, v50, v50 row_ror:4 row_mask:0xf bank_mask:0xf
    v_add_f32_dpp v51, v51, v51 row_ror:4 row_mask:0xf bank_mask:0xf
    v_add_f32_dpp v52, v52, v52 row_ror:4 row_mask:0xf bank_mask:0xf
    v_add_f32_dpp v53, v53, v53 row_ror:4 row_mask:0xf bank_mask:0xf
    v_add_f32_dpp v54, v54, v54 row_ror:4 row_mask:0xf bank_mask:0xf
    v_add_f32_dpp v55, v55, v55 row_ror:4 row_mask:0xf bank_mask:0xf
    v_add_f32_dpp v48, v48, v48 row_ror:2 row_mask:0xf bank_mask:0xf
    v_add_f32_dpp v49, v49, v49 row_ror:2 row_mask:0xf bank_mask:0xf
    v_add_f32_dpp v50, v50, v50 row_ror:2 row_mask:0xf bank_mask:0xf
    v_add_f32_dpp v51, v51, v51 row_ror:2 row_mask:0xf bank_mask:0xf
    v_add_f32_dpp v52, v52, v52 row_ror:2 row_mask:0xf bank_mask:0xf
    v_add_f32_dpp v53, v53, v53 row_ror:2 row_mask:0xf bank_mask:0xf
    v_add_f32_dpp v54, v54, v54 row_ror:2 row_mask:0xf bank_mask:0xf
    v_add_f32_dpp v55, v55, v55 row_ror:2 row_mask:0xf bank_mask:0xf
    v_pk_mul_f32 v[100:101], v[100:101], v[196:197] op_sel:[0,0] op_sel_hi:[1,0]
    v_pk_mul_f32 v[102:103], v[102:103], v[196:197] op_sel:[0,0] op_sel_hi:[1,0]
    v_pk_mul_f32 v[104:105], v[104:105], v[196:197] op_sel:[0,0] op_sel_hi:[1,0]
    v_pk_mul_f32 v[106:107], v[106:107], v[196:197] op_sel:[0,0] op_sel_hi:[1,0]
    v_pk_mul_f32 v[92:93], v[92:93], v[200:201] op_sel:[0,0] op_sel_hi:[1,0]
    v_pk_mul_f32 v[94:95], v[94:95], v[200:201] op_sel:[0,0] op_sel_hi:[1,0]
    v_pk_mul_f32 v[96:97], v[96:97], v[200:201] op_sel:[0,0] op_sel_hi:[1,0]
    v_pk_mul_f32 v[98:99], v[98:99], v[200:201] op_sel:[0,0] op_sel_hi:[1,0]
    v_pk_mul_f32 v[116:117], v[116:117], v[220:221] op_sel:[0,0] op_sel_hi:[1,0]
    v_pk_mul_f32 v[118:119], v[118:119], v[220:221] op_sel:[0,0] op_sel_hi:[1,0]
    v_pk_mul_f32 v[120:121], v[120:121], v[220:221] op_sel:[0,0] op_sel_hi:[1,0]
    v_pk_mul_f32 v[122:123], v[122:123], v[220:221] op_sel:[0,0] op_sel_hi:[1,0]
    v_pk_mul_f32 v[108:109], v[108:109], v[224:225] op_sel:[0,0] op_sel_hi:[1,0]
    v_pk_mul_f32 v[110:111], v[110:111], v[224:225] op_sel:[0,0] op_sel_hi:[1,0]
    v_pk_mul_f32 v[112:113], v[112:113], v[224:225] op_sel:[0,0] op_sel_hi:[1,0]
    v_pk_mul_f32 v[114:115], v[114:115], v[224:225] op_sel:[0,0] op_sel_hi:[1,0]
    v_add_u32 v233, s36, v232
    v_cvt_pk_bf16_f32 v188, v100, v101
    v_cvt_pk_bf16_f32 v189, v102, v103
    v_cvt_pk_bf16_f32 v190, v104, v105
    v_cvt_pk_bf16_f32 v191, v106, v107
    v_cvt_pk_bf16_f32 v192, v92, v93
    v_cvt_pk_bf16_f32 v193, v94, v95
    v_cvt_pk_bf16_f32 v194, v96, v97
    v_cvt_pk_bf16_f32 v195, v98, v99
    v_cvt_pk_bf16_f32 v212, v116, v117
    v_cvt_pk_bf16_f32 v213, v118, v119
    v_cvt_pk_bf16_f32 v214, v120, v121
    v_cvt_pk_bf16_f32 v215, v122, v123
    v_cvt_pk_bf16_f32 v216, v108, v109
    v_cvt_pk_bf16_f32 v217, v110, v111
    v_cvt_pk_bf16_f32 v218, v112, v113
    v_cvt_pk_bf16_f32 v219, v114, v115
    v_add_f32_dpp v48, v48, v48 row_ror:1 row_mask:0xf bank_mask:0xf
    v_add_f32_dpp v49, v49, v49 row_ror:1 row_mask:0xf bank_mask:0xf
    v_add_f32_dpp v50, v50, v50 row_ror:1 row_mask:0xf bank_mask:0xf
    v_add_f32_dpp v51, v51, v51 row_ror:1 row_mask:0xf bank_mask:0xf
    v_add_f32_dpp v52, v52, v52 row_ror:1 row_mask:0xf bank_mask:0xf
    v_add_f32_dpp v53, v53, v53 row_ror:1 row_mask:0xf bank_mask:0xf
    v_add_f32_dpp v54, v54, v54 row_ror:1 row_mask:0xf bank_mask:0xf
    v_add_f32_dpp v55, v55, v55 row_ror:1 row_mask:0xf bank_mask:0xf
    ds_write_b64 v233, v[140:141] offset:16384
    ds_write_b64 v233, v[142:143] offset:16896
    ds_write_b64 v233, v[144:145] offset:17408
    ds_write_b64 v233, v[146:147] offset:17920
    ds_write_b64 v233, v[164:165] offset:18432
    ds_write_b64 v233, v[166:167] offset:18944
    ds_write_b64 v233, v[168:169] offset:19456
    ds_write_b64 v233, v[170:171] offset:19968
    ds_write_b64 v233, v[188:189] offset:20480
    ds_write_b64 v233, v[190:191] offset:20992
    ds_write_b64 v233, v[192:193] offset:21504
    ds_write_b64 v233, v[194:195] offset:22016
    ds_write_b64 v233, v[212:213] offset:22528
    ds_write_b64 v233, v[214:215] offset:23040
    ds_write_b64 v233, v[216:217] offset:23552
    ds_write_b64 v233, v[218:219] offset:24064
    v_accvgpr_write_b32 a164, v48
    v_accvgpr_write_b32 a165, v49
    v_accvgpr_write_b32 a166, v50
    v_accvgpr_write_b32 a167, v51
    v_accvgpr_write_b32 a168, v52
    v_accvgpr_write_b32 a169, v53
    v_accvgpr_write_b32 a170, v54
    v_accvgpr_write_b32 a171, v55
    v_accvgpr_write_b32 a172, v56
    v_accvgpr_write_b32 a173, v57
    v_accvgpr_write_b32 a174, v58
    v_accvgpr_write_b32 a175, v59
    v_accvgpr_write_b32 a176, v60
    v_accvgpr_write_b32 a177, v61
    v_accvgpr_write_b32 a178, v62
    v_accvgpr_write_b32 a179, v63
    v_accvgpr_write_b32 a180, v64
    v_accvgpr_write_b32 a181, v65
    v_accvgpr_write_b32 a182, v66
    v_accvgpr_write_b32 a183, v67
    v_accvgpr_write_b32 a184, v68
    v_accvgpr_write_b32 a185, v69
    v_accvgpr_write_b32 a186, v70
    v_accvgpr_write_b32 a187, v71
    s_waitcnt lgkmcnt(0)
    s_barrier
    s_lshl_b32 s36, s28, 9
    v_add_u32 v234, s36, v8
    ds_read_b64_tr_b16 a[4:5], v8 offset:0
    ds_read_b64_tr_b16 a[0:1], v234 offset:16384
    ds_read_b64_tr_b16 a[2:3], v234 offset:18432
    ds_read_b64_tr_b16 a[6:7], v8 offset:1024
    ds_read_b64_tr_b16 a[8:9], v8 offset:512
    ds_read_b64_tr_b16 a[10:11], v8 offset:1536
    ds_read_b64_tr_b16 a[12:13], v234 offset:20480
    ds_read_b64_tr_b16 a[16:17], v8 offset:2048
    ds_read_b64_tr_b16 a[14:15], v234 offset:22528
    ds_read_b64_tr_b16 a[18:19], v8 offset:3072
    ds_read_b64_tr_b16 a[20:21], v8 offset:2560
    ds_read_b64_tr_b16 a[22:23], v8 offset:3584
    v_pk_fma_f32 v[132:133], v[48:49], v[82:83], v[132:133] op_sel:[0,0,0] op_sel_hi:[1,0,1]
    v_pk_fma_f32 v[156:157], v[48:49], v[84:85], v[156:157] op_sel:[0,0,0] op_sel_hi:[1,0,1]
    ds_read_b64_tr_b16 a[24:25], v234 offset:24576
    ds_read_b64_tr_b16 a[28:29], v8 offset:4096
    ds_read_b64_tr_b16 a[26:27], v234 offset:26624
    ds_read_b64_tr_b16 a[30:31], v8 offset:5120
    v_pk_fma_f32 v[134:135], v[50:51], v[82:83], v[134:135] op_sel:[0,0,0] op_sel_hi:[1,0,1]
    v_pk_fma_f32 v[158:159], v[50:51], v[84:85], v[158:159] op_sel:[0,0,0] op_sel_hi:[1,0,1]
    v_pk_fma_f32 v[136:137], v[52:53], v[82:83], v[136:137] op_sel:[0,0,0] op_sel_hi:[1,0,1]
    v_pk_fma_f32 v[138:139], v[54:55], v[82:83], v[138:139] op_sel:[0,0,0] op_sel_hi:[1,0,1]
    v_pk_fma_f32 v[160:161], v[52:53], v[84:85], v[160:161] op_sel:[0,0,0] op_sel_hi:[1,0,1]
    v_pk_fma_f32 v[162:163], v[54:55], v[84:85], v[162:163] op_sel:[0,0,0] op_sel_hi:[1,0,1]
    ds_read_b64_tr_b16 a[32:33], v8 offset:4608
    ds_read_b64_tr_b16 a[34:35], v8 offset:5632
    v_cvt_pk_bf16_f32 v132, v132, v133
    v_cvt_pk_bf16_f32 v156, v156, v157
    v_cvt_pk_bf16_f32 v133, v134, v135
    v_cvt_pk_bf16_f32 v157, v158, v159
    v_cvt_pk_bf16_f32 v134, v136, v137
    v_cvt_pk_bf16_f32 v135, v138, v139
    v_cvt_pk_bf16_f32 v158, v160, v161
    v_cvt_pk_bf16_f32 v159, v162, v163
    ds_read_b64_tr_b16 a[36:37], v234 offset:28672
    ds_read_b64_tr_b16 a[40:41], v8 offset:6144
    ds_read_b64_tr_b16 a[38:39], v234 offset:30720
    ds_read_b64_tr_b16 a[42:43], v8 offset:7168
    ds_read_b64_tr_b16 a[44:45], v8 offset:6656
    ds_read_b64_tr_b16 a[46:47], v8 offset:7680
    v_mfma_f32_16x16x32_bf16 v[108:111], a[192:195], v[132:135], 0
    ds_read_b64_tr_b16 a[48:49], v234 offset:32768
    ds_read_b64_tr_b16 a[52:53], v8 offset:8192
    v_mfma_f32_16x16x32_bf16 v[172:175], a[192:195], v[156:159], 0
    ds_read_b64_tr_b16 a[50:51], v234 offset:34816
    ds_read_b64_tr_b16 a[54:55], v8 offset:9216
    v_mfma_f32_16x16x32_bf16 v[112:115], a[196:199], v[132:135], 0
    ds_read_b64_tr_b16 a[56:57], v8 offset:8704
    ds_read_b64_tr_b16 a[58:59], v8 offset:9728
    v_mfma_f32_16x16x32_bf16 v[176:179], a[196:199], v[156:159], 0
    ds_read_b64_tr_b16 a[60:61], v234 offset:36864
    ds_read_b64_tr_b16 a[64:65], v8 offset:10240
    s_waitcnt lgkmcnt(14)
    v_mfma_f32_16x16x32_bf16 v[92:95], a[0:3], a[4:7], 0
    ds_read_b64_tr_b16 a[62:63], v234 offset:38912
    ds_read_b64_tr_b16 a[66:67], v8 offset:11264
    v_mfma_f32_16x16x32_bf16 v[96:99], a[0:3], a[8:11], 0
    ds_read_b64_tr_b16 a[68:69], v8 offset:10752
    ds_read_b64_tr_b16 a[70:71], v8 offset:11776
    v_mfma_f32_16x16x32_bf16 v[100:103], a[0:3], v[16:19], 0
    v_max3_f32 v236, v108, v109, v110
    v_max3_f32 v237, -v108, -v109, -v110
    v_max3_f32 v242, v172, v173, v174
    v_max3_f32 v243, -v172, -v173, -v174
    v_mfma_f32_16x16x32_bf16 v[92:95], a[12:15], a[16:19], v[92:95]
    ds_read_b64_tr_b16 a[72:73], v234 offset:40960
    ds_read_b64_tr_b16 a[76:77], v8 offset:12288
    ds_read_b64_tr_b16 a[74:75], v234 offset:43008
    ds_read_b64_tr_b16 a[78:79], v8 offset:13312
    v_mfma_f32_16x16x32_bf16 v[96:99], a[12:15], a[20:23], v[96:99]
    v_max3_f32 v236, v236, v111, v112
    v_max3_f32 v237, v237, -v111, -v112
    v_max3_f32 v242, v242, v175, v176
    v_max3_f32 v243, v243, -v175, -v176
    ds_read_b64_tr_b16 a[80:81], v8 offset:12800
    ds_read_b64_tr_b16 a[82:83], v8 offset:13824
    v_mfma_f32_16x16x32_bf16 v[100:103], a[12:15], v[16:19], v[100:103]
    v_max3_f32 v236, v236, v113, v114
    v_max3_f32 v237, v237, -v113, -v114
    v_max3_f32 v242, v242, v177, v178
    v_max3_f32 v243, v243, -v177, -v178
    v_mfma_f32_16x16x32_bf16 v[92:95], a[24:27], a[28:31], v[92:95]
    ds_read_b64_tr_b16 a[84:85], v234 offset:45056
    ds_read_b64_tr_b16 a[88:89], v8 offset:14336
    ds_read_b64_tr_b16 a[86:87], v234 offset:47104
    ds_read_b64_tr_b16 a[90:91], v8 offset:15360
    v_mfma_f32_16x16x32_bf16 v[96:99], a[24:27], a[32:35], v[96:99]
    v_max_f32 v236, v236, v115
    v_max_f32_e64 v237, v237, -v115
    v_max_f32 v242, v242, v179
    v_max_f32_e64 v243, v243, -v179
    ds_read_b64_tr_b16 a[92:93], v8 offset:14848
    ds_read_b64_tr_b16 a[94:95], v8 offset:15872
    v_mfma_f32_16x16x32_bf16 v[100:103], a[24:27], v[16:19], v[100:103]
    v_permlane32_swap_b32 v236, v237
    s_waitcnt lgkmcnt(14)
    v_mfma_f32_16x16x32_bf16 v[92:95], a[36:39], a[40:43], v[92:95]
    v_permlane32_swap_b32 v242, v243
    v_mfma_f32_16x16x32_bf16 v[96:99], a[36:39], a[44:47], v[96:99]
    v_max_f32 v236, v236, v237
    v_max_f32 v242, v242, v243
    v_mfma_f32_16x16x32_bf16 v[100:103], a[36:39], v[16:19], v[100:103]
    v_mov_b32 v238, v236
    v_mov_b32 v244, v242
    v_mfma_f32_16x16x32_bf16 v[92:95], a[48:51], a[52:55], v[92:95]
    v_permlane16_swap_b32 v236, v238
    v_mfma_f32_16x16x32_bf16 v[96:99], a[48:51], a[56:59], v[96:99]
    v_permlane16_swap_b32 v242, v244
    v_mfma_f32_16x16x32_bf16 v[100:103], a[48:51], v[16:19], v[100:103]
    v_max_f32 v236, v236, v238
    v_max_f32 v242, v242, v244
    v_mfma_f32_16x16x32_bf16 v[92:95], a[60:63], a[64:67], v[92:95]
    v_mov_b32 v238, v236
    v_mov_b32 v244, v242
    s_waitcnt lgkmcnt(12)
    v_mfma_f32_16x16x32_bf16 v[96:99], a[60:63], a[68:71], v[96:99]
    s_lshl_b32 s37, s30, 2
    s_add_u32 s37, s37, s28
    v_mfma_f32_16x16x32_bf16 v[100:103], a[60:63], v[16:19], v[100:103]
    v_permlane32_swap_b32 v236, v238
    s_waitcnt lgkmcnt(8)
    v_mfma_f32_16x16x32_bf16 v[92:95], a[72:75], a[76:79], v[92:95]
    v_permlane32_swap_b32 v242, v244
    s_waitcnt lgkmcnt(6)
    v_mfma_f32_16x16x32_bf16 v[96:99], a[72:75], a[80:83], v[96:99]
    s_lshl_b32 s37, s37, 3
    v_mul_f32 v240, 0x3fb8aa3b, v83
    v_mfma_f32_16x16x32_bf16 v[100:103], a[72:75], v[16:19], v[100:103]
    v_mul_f32 v246, 0x3fb8aa3b, v85
    s_add_u32 s38, s37, s29
    s_waitcnt lgkmcnt(2)
    v_mfma_f32_16x16x32_bf16 v[92:95], a[84:87], a[88:91], v[92:95]
    v_lshrrev_b32 v235, 4, v0
    v_mul_f32_e64 v236, -v236, v240
    s_waitcnt lgkmcnt(0)
    v_mfma_f32_16x16x32_bf16 v[96:99], a[84:87], a[92:95], v[96:99]
    v_mul_f32_e64 v237, -v238, v240
    v_mul_f32_e64 v242, -v242, v246
    v_mfma_f32_16x16x32_bf16 v[100:103], a[84:87], v[16:19], v[100:103]
    v_mul_f32_e64 v243, -v244, v246
    s_lshl_b32 s39, s38, 7
    v_lshlrev_b32 v235, 4, v235
    v_and_b32 v11, 15, v0
    s_add_u32 s39, s39, 0x800000
    v_pk_fma_f32 v[116:117], v[108:109], v[240:241], v[236:237] op_sel:[0,0,0] op_sel_hi:[1,0,0]
    v_pk_fma_f32 v[118:119], v[110:111], v[240:241], v[236:237] op_sel:[0,0,0] op_sel_hi:[1,0,0]
    v_pk_fma_f32 v[120:121], v[112:113], v[240:241], v[236:237] op_sel:[0,0,0] op_sel_hi:[1,0,0]
    v_pk_fma_f32 v[122:123], v[114:115], v[240:241], v[236:237] op_sel:[0,0,0] op_sel_hi:[1,0,0]
    v_pk_fma_f32 v[148:149], v[172:173], v[246:247], v[242:243] op_sel:[0,0,0] op_sel_hi:[1,0,0]
    v_pk_fma_f32 v[150:151], v[174:175], v[246:247], v[242:243] op_sel:[0,0,0] op_sel_hi:[1,0,0]
    v_pk_fma_f32 v[152:153], v[176:177], v[246:247], v[242:243] op_sel:[0,0,0] op_sel_hi:[1,0,0]
    v_pk_fma_f32 v[154:155], v[178:179], v[246:247], v[242:243] op_sel:[0,0,0] op_sel_hi:[1,0,0]
    s_lshl_b32 s38, s38, 11
    v_pk_fma_f32 v[108:109], v[108:109], v[240:241], v[236:237] op_sel:[0,0,1] op_sel_hi:[1,0,1] neg_lo:[1,0,0] neg_hi:[1,0,0]
    v_pk_fma_f32 v[110:111], v[110:111], v[240:241], v[236:237] op_sel:[0,0,1] op_sel_hi:[1,0,1] neg_lo:[1,0,0] neg_hi:[1,0,0]
    v_pk_fma_f32 v[112:113], v[112:113], v[240:241], v[236:237] op_sel:[0,0,1] op_sel_hi:[1,0,1] neg_lo:[1,0,0] neg_hi:[1,0,0]
    v_pk_fma_f32 v[114:115], v[114:115], v[240:241], v[236:237] op_sel:[0,0,1] op_sel_hi:[1,0,1] neg_lo:[1,0,0] neg_hi:[1,0,0]
    v_pk_fma_f32 v[172:173], v[172:173], v[246:247], v[242:243] op_sel:[0,0,1] op_sel_hi:[1,0,1] neg_lo:[1,0,0] neg_hi:[1,0,0]
    v_pk_fma_f32 v[174:175], v[174:175], v[246:247], v[242:243] op_sel:[0,0,1] op_sel_hi:[1,0,1] neg_lo:[1,0,0] neg_hi:[1,0,0]
    v_pk_fma_f32 v[176:177], v[176:177], v[246:247], v[242:243] op_sel:[0,0,1] op_sel_hi:[1,0,1] neg_lo:[1,0,0] neg_hi:[1,0,0]
    v_pk_fma_f32 v[178:179], v[178:179], v[246:247], v[242:243] op_sel:[0,0,1] op_sel_hi:[1,0,1] neg_lo:[1,0,0] neg_hi:[1,0,0]
    v_lshl_add_u32 v235, v11, 6, v235
    v_cmp_gt_u32 vcc, 2, v11
    s_add_u32 s38, s38, 0x400000
    v_mov_b32 v11, 0x80000000
    v_exp_f32 v116, v116
    v_exp_f32 v108, v108
    v_exp_f32 v117, v117
    v_exp_f32 v109, v109
    v_exp_f32 v118, v118
    v_exp_f32 v110, v110
    v_exp_f32 v119, v119
    v_exp_f32 v111, v111
    v_exp_f32 v120, v120
    v_exp_f32 v112, v112
    v_exp_f32 v121, v121
    v_exp_f32 v113, v113
    v_exp_f32 v122, v122
    v_exp_f32 v114, v114
    v_exp_f32 v123, v123
    v_exp_f32 v115, v115
    v_exp_f32 v148, v148
    v_exp_f32 v172, v172
    v_exp_f32 v149, v149
    v_exp_f32 v173, v173
    v_exp_f32 v150, v150
    v_exp_f32 v174, v174
    v_exp_f32 v151, v151
    v_exp_f32 v175, v175
    v_exp_f32 v152, v152
    v_exp_f32 v176, v176
    v_exp_f32 v153, v153
    v_exp_f32 v177, v177
    v_exp_f32 v154, v154
    v_exp_f32 v178, v178
    v_exp_f32 v155, v155
    v_exp_f32 v179, v179
    buffer_store_dwordx4 v[92:95], v1, s[4:7], s38 offen offset:0 sc1
    v_pk_fma_f32 v[180:181], v[48:49], v[86:87], v[180:181] op_sel:[0,0,0] op_sel_hi:[1,0,1]
    v_pk_fma_f32 v[204:205], v[48:49], v[88:89], v[204:205] op_sel:[0,0,0] op_sel_hi:[1,0,1]
    v_pk_fma_f32 v[182:183], v[50:51], v[86:87], v[182:183] op_sel:[0,0,0] op_sel_hi:[1,0,1]
    v_pk_fma_f32 v[206:207], v[50:51], v[88:89], v[206:207] op_sel:[0,0,0] op_sel_hi:[1,0,1]
    v_cndmask_b32 v235, v11, v235, vcc
    buffer_store_dwordx4 v[96:99], v1, s[4:7], s38 offen offset:1024 sc1
    v_lshlrev_b32 v10, 13, v0
    v_pk_fma_f32 v[184:185], v[52:53], v[86:87], v[184:185] op_sel:[0,0,0] op_sel_hi:[1,0,1]
    v_pk_fma_f32 v[186:187], v[54:55], v[86:87], v[186:187] op_sel:[0,0,0] op_sel_hi:[1,0,1]
    v_pk_fma_f32 v[208:209], v[52:53], v[88:89], v[208:209] op_sel:[0,0,0] op_sel_hi:[1,0,1]
    v_pk_fma_f32 v[210:211], v[54:55], v[88:89], v[210:211] op_sel:[0,0,0] op_sel_hi:[1,0,1]
    v_cvt_pk_bf16_f32 v180, v180, v181
    v_cvt_pk_bf16_f32 v204, v204, v205
    s_lshl_b32 s36, s30, 8
    v_cvt_pk_bf16_f32 v181, v182, v183
    v_cvt_pk_bf16_f32 v205, v206, v207
    buffer_store_dwordx4 v[100:103], v235, s[4:7], s39 offen sc1
    v_add_u32 v10, s36, v10
    v_cvt_pk_bf16_f32 v182, v184, v185
    v_cvt_pk_bf16_f32 v183, v186, v187
    v_cvt_pk_bf16_f32 v206, v208, v209
    v_cvt_pk_bf16_f32 v207, v210, v211
    v_cvt_pk_bf16_f32 v140, v116, v117
    v_cvt_pk_bf16_f32 v141, v118, v119
    v_cvt_pk_bf16_f32 v142, v120, v121
    v_cvt_pk_bf16_f32 v143, v122, v123
    v_cvt_pk_bf16_f32 v144, v108, v109
    v_cvt_pk_bf16_f32 v145, v110, v111
    v_cvt_pk_bf16_f32 v146, v112, v113
    v_cvt_pk_bf16_f32 v147, v114, v115
    v_cvt_pk_bf16_f32 v164, v148, v149
    v_cvt_pk_bf16_f32 v165, v150, v151
    v_cvt_pk_bf16_f32 v166, v152, v153
    v_cvt_pk_bf16_f32 v167, v154, v155
    v_cvt_pk_bf16_f32 v168, v172, v173
    v_cvt_pk_bf16_f32 v169, v174, v175
    v_cvt_pk_bf16_f32 v170, v176, v177
    v_cvt_pk_bf16_f32 v171, v178, v179
    s_waitcnt vmcnt(0)
    s_barrier
    s_cmp_lg_u32 s28, 0
    s_cbranch_scc1 Lsig_13
    s_mov_b32 exec_lo, 0xff
    s_mov_b32 exec_hi, 0
    s_mov_b32 s36, 0x70000
    buffer_atomic_add v12, v10, s[4:7], s36 offen sc1
    s_mov_b64 exec, -1
Lsig_13:
    v_mfma_f32_16x16x32_bf16 v[108:111], a[192:195], v[180:183], 0
    v_mul_f32 v240, 0x3fb8aa3b, v87
    v_mul_f32 v246, 0x3fb8aa3b, v89
    v_mfma_f32_16x16x32_bf16 v[220:223], a[192:195], v[204:207], 0
    v_mfma_f32_16x16x32_bf16 v[112:115], a[196:199], v[180:183], 0
    s_nop 3
    v_max3_f32 v236, v108, v109, v110
    v_mfma_f32_16x16x32_bf16 v[224:227], a[196:199], v[204:207], 0
    v_max3_f32 v237, -v108, -v109, -v110
    v_max3_f32 v242, v220, v221, v222
    v_max3_f32 v243, -v220, -v221, -v222
    v_max3_f32 v236, v236, v111, v112
    v_max3_f32 v237, v237, -v111, -v112
    v_max3_f32 v236, v236, v113, v114
    v_max3_f32 v237, v237, -v113, -v114
    s_nop 0
    v_max3_f32 v242, v242, v223, v224
    v_max3_f32 v243, v243, -v223, -v224
    v_max3_f32 v242, v242, v225, v226
    v_max3_f32 v243, v243, -v225, -v226
    v_max_f32 v236, v236, v115
    v_max_f32_e64 v237, v237, -v115
    v_max_f32 v242, v242, v227
    v_max_f32_e64 v243, v243, -v227
    v_permlane32_swap_b32 v236, v237
    s_nop 0
    v_permlane32_swap_b32 v242, v243
    v_max_f32 v236, v236, v237
    v_max_f32 v242, v242, v243
    v_mov_b32 v238, v236
    v_mov_b32 v244, v242
    s_nop 0
    v_permlane16_swap_b32 v236, v238
    v_permlane16_swap_b32 v242, v244
    v_max_f32 v236, v236, v238
    v_max_f32 v242, v242, v244
    v_mov_b32 v238, v236
    v_mov_b32 v244, v242
    s_nop 0
    v_permlane32_swap_b32 v236, v238
    v_permlane32_swap_b32 v242, v244
    v_mul_f32_e64 v236, -v236, v240
    v_mul_f32_e64 v237, -v238, v240
    v_mul_f32_e64 v242, -v242, v246
    v_mul_f32_e64 v243, -v244, v246
    v_pk_fma_f32 v[116:117], v[108:109], v[240:241], v[236:237] op_sel:[0,0,0] op_sel_hi:[1,0,0]
    v_pk_fma_f32 v[118:119], v[110:111], v[240:241], v[236:237] op_sel:[0,0,0] op_sel_hi:[1,0,0]
    v_pk_fma_f32 v[120:121], v[112:113], v[240:241], v[236:237] op_sel:[0,0,0] op_sel_hi:[1,0,0]
    v_pk_fma_f32 v[122:123], v[114:115], v[240:241], v[236:237] op_sel:[0,0,0] op_sel_hi:[1,0,0]
    v_pk_fma_f32 v[196:197], v[220:221], v[246:247], v[242:243] op_sel:[0,0,0] op_sel_hi:[1,0,0]
    v_pk_fma_f32 v[198:199], v[222:223], v[246:247], v[242:243] op_sel:[0,0,0] op_sel_hi:[1,0,0]
    v_pk_fma_f32 v[200:201], v[224:225], v[246:247], v[242:243] op_sel:[0,0,0] op_sel_hi:[1,0,0]
    v_pk_fma_f32 v[202:203], v[226:227], v[246:247], v[242:243] op_sel:[0,0,0] op_sel_hi:[1,0,0]
    v_pk_fma_f32 v[108:109], v[108:109], v[240:241], v[236:237] op_sel:[0,0,1] op_sel_hi:[1,0,1] neg_lo:[1,0,0] neg_hi:[1,0,0]
    v_pk_fma_f32 v[110:111], v[110:111], v[240:241], v[236:237] op_sel:[0,0,1] op_sel_hi:[1,0,1] neg_lo:[1,0,0] neg_hi:[1,0,0]
    v_pk_fma_f32 v[112:113], v[112:113], v[240:241], v[236:237] op_sel:[0,0,1] op_sel_hi:[1,0,1] neg_lo:[1,0,0] neg_hi:[1,0,0]
    v_pk_fma_f32 v[114:115], v[114:115], v[240:241], v[236:237] op_sel:[0,0,1] op_sel_hi:[1,0,1] neg_lo:[1,0,0] neg_hi:[1,0,0]
    v_pk_fma_f32 v[220:221], v[220:221], v[246:247], v[242:243] op_sel:[0,0,1] op_sel_hi:[1,0,1] neg_lo:[1,0,0] neg_hi:[1,0,0]
    v_pk_fma_f32 v[222:223], v[222:223], v[246:247], v[242:243] op_sel:[0,0,1] op_sel_hi:[1,0,1] neg_lo:[1,0,0] neg_hi:[1,0,0]
    v_pk_fma_f32 v[224:225], v[224:225], v[246:247], v[242:243] op_sel:[0,0,1] op_sel_hi:[1,0,1] neg_lo:[1,0,0] neg_hi:[1,0,0]
    v_pk_fma_f32 v[226:227], v[226:227], v[246:247], v[242:243] op_sel:[0,0,1] op_sel_hi:[1,0,1] neg_lo:[1,0,0] neg_hi:[1,0,0]
    v_exp_f32 v116, v116
    v_exp_f32 v108, v108
    v_exp_f32 v117, v117
    v_exp_f32 v109, v109
    v_exp_f32 v118, v118
    v_exp_f32 v110, v110
    v_exp_f32 v119, v119
    v_exp_f32 v111, v111
    v_exp_f32 v120, v120
    v_exp_f32 v112, v112
    v_exp_f32 v121, v121
    v_exp_f32 v113, v113
    v_exp_f32 v122, v122
    v_exp_f32 v114, v114
    v_exp_f32 v123, v123
    v_exp_f32 v115, v115
    v_exp_f32 v196, v196
    v_exp_f32 v220, v220
    v_exp_f32 v197, v197
    v_exp_f32 v221, v221
    v_exp_f32 v198, v198
    v_exp_f32 v222, v222
    v_exp_f32 v199, v199
    v_exp_f32 v223, v223
    v_exp_f32 v200, v200
    v_exp_f32 v224, v224
    v_exp_f32 v201, v201
    v_exp_f32 v225, v225
    v_exp_f32 v202, v202
    v_exp_f32 v226, v226
    v_exp_f32 v203, v203
    v_exp_f32 v227, v227
    v_cvt_pk_bf16_f32 v188, v116, v117
    v_cvt_pk_bf16_f32 v189, v118, v119
    v_cvt_pk_bf16_f32 v190, v120, v121
    v_cvt_pk_bf16_f32 v191, v122, v123
    v_cvt_pk_bf16_f32 v192, v108, v109
    v_cvt_pk_bf16_f32 v193, v110, v111
    v_cvt_pk_bf16_f32 v194, v112, v113
    v_cvt_pk_bf16_f32 v195, v114, v115
    v_cvt_pk_bf16_f32 v212, v196, v197
    v_cvt_pk_bf16_f32 v213, v198, v199
    v_cvt_pk_bf16_f32 v214, v200, v201
    v_cvt_pk_bf16_f32 v215, v202, v203
    v_cvt_pk_bf16_f32 v216, v220, v221
    v_cvt_pk_bf16_f32 v217, v222, v223
    v_cvt_pk_bf16_f32 v218, v224, v225
    v_cvt_pk_bf16_f32 v219, v226, v227
    s_add_u32 s45, s28, 0
    s_add_u32 s44, s45, s34
    s_and_b32 s44, s44, 31
    s_lshl_b32 s44, s44, 12
    s_add_u32 s44, s44, s51
    s_add_u32 s44, s44, 0xc00000
    s_lshl_b32 s45, s45, 12
    s_add_u32 m0, s45, 32768
    s_nop 0
    buffer_load_dwordx4 v1, s[4:7], s44 offen offset:0 sc1 lds
    buffer_load_dwordx4 v1, s[4:7], s44 offen offset:1024 sc1 lds
    buffer_load_dwordx4 v1, s[4:7], s44 offen offset:2048 sc1 lds
    buffer_load_dwordx4 v1, s[4:7], s44 offen offset:3072 sc1 lds
    s_add_u32 s45, s28, 4
    s_add_u32 s44, s45, s34
    s_and_b32 s44, s44, 31
    s_lshl_b32 s44, s44, 12
    s_add_u32 s44, s44, s51
    s_add_u32 s44, s44, 0xc00000
    s_lshl_b32 s45, s45, 12
    s_add_u32 m0, s45, 32768
    s_nop 0
    buffer_load_dwordx4 v1, s[4:7], s44 offen offset:0 sc1 lds
    buffer_load_dwordx4 v1, s[4:7], s44 offen offset:1024 sc1 lds
    buffer_load_dwordx4 v1, s[4:7], s44 offen offset:2048 sc1 lds
    buffer_load_dwordx4 v1, s[4:7], s44 offen offset:3072 sc1 lds
    s_add_u32 s45, s28, 8
    s_add_u32 s44, s45, s34
    s_and_b32 s44, s44, 31
    s_lshl_b32 s44, s44, 12
    s_add_u32 s44, s44, s51
    s_add_u32 s44, s44, 0xc00000
    s_lshl_b32 s45, s45, 12
    s_add_u32 m0, s45, 32768
    s_nop 0
    buffer_load_dwordx4 v1, s[4:7], s44 offen offset:0 sc1 lds
    buffer_load_dwordx4 v1, s[4:7], s44 offen offset:1024 sc1 lds
    buffer_load_dwordx4 v1, s[4:7], s44 offen offset:2048 sc1 lds
    buffer_load_dwordx4 v1, s[4:7], s44 offen offset:3072 sc1 lds
    s_add_u32 s45, s28, 12
    s_add_u32 s44, s45, s34
    s_and_b32 s44, s44, 31
    s_lshl_b32 s44, s44, 12
    s_add_u32 s44, s44, s51
    s_add_u32 s44, s44, 0xc00000
    s_lshl_b32 s45, s45, 12
    s_add_u32 m0, s45, 32768
    s_nop 0
    buffer_load_dwordx4 v1, s[4:7], s44 offen offset:0 sc1 lds
    buffer_load_dwordx4 v1, s[4:7], s44 offen offset:1024 sc1 lds
    buffer_load_dwordx4 v1, s[4:7], s44 offen offset:2048 sc1 lds
    buffer_load_dwordx4 v1, s[4:7], s44 offen offset:3072 sc1 lds
    s_add_u32 s45, s28, 16
    s_add_u32 s44, s45, s34
    s_and_b32 s44, s44, 31
    s_lshl_b32 s44, s44, 12
    s_add_u32 s44, s44, s51
    s_add_u32 s44, s44, 0xc00000
    s_lshl_b32 s45, s45, 12
    s_add_u32 m0, s45, 32768
    s_nop 0
    buffer_load_dwordx4 v1, s[4:7], s44 offen offset:0 sc1 lds
    buffer_load_dwordx4 v1, s[4:7], s44 offen offset:1024 sc1 lds
    buffer_load_dwordx4 v1, s[4:7], s44 offen offset:2048 sc1 lds
    buffer_load_dwordx4 v1, s[4:7], s44 offen offset:3072 sc1 lds
    s_add_u32 s45, s28, 20
    s_add_u32 s44, s45, s34
    s_and_b32 s44, s44, 31
    s_lshl_b32 s44, s44, 12
    s_add_u32 s44, s44, s51
    s_add_u32 s44, s44, 0xc00000
    s_lshl_b32 s45, s45, 12
    s_add_u32 m0, s45, 32768
    s_nop 0
    buffer_load_dwordx4 v1, s[4:7], s44 offen offset:0 sc1 lds
    buffer_load_dwordx4 v1, s[4:7], s44 offen offset:1024 sc1 lds
    buffer_load_dwordx4 v1, s[4:7], s44 offen offset:2048 sc1 lds
    buffer_load_dwordx4 v1, s[4:7], s44 offen offset:3072 sc1 lds
    s_add_u32 s45, s28, 24
    s_add_u32 s44, s45, s34
    s_and_b32 s44, s44, 31
    s_lshl_b32 s44, s44, 12
    s_add_u32 s44, s44, s51
    s_add_u32 s44, s44, 0xc00000
    s_lshl_b32 s45, s45, 12
    s_add_u32 m0, s45, 32768
    s_nop 0
    buffer_load_dwordx4 v1, s[4:7], s44 offen offset:0 sc1 lds
    buffer_load_dwordx4 v1, s[4:7], s44 offen offset:1024 sc1 lds
    buffer_load_dwordx4 v1, s[4:7], s44 offen offset:2048 sc1 lds
    buffer_load_dwordx4 v1, s[4:7], s44 offen offset:3072 sc1 lds
    s_add_u32 s45, s28, 28
    s_add_u32 s44, s45, s34
    s_and_b32 s44, s44, 31
    s_lshl_b32 s44, s44, 12
    s_add_u32 s44, s44, s51
    s_add_u32 s44, s44, 0xc00000
    s_lshl_b32 s45, s45, 12
    s_add_u32 m0, s45, 32768
    s_nop 0
    buffer_load_dwordx4 v1, s[4:7], s44 offen offset:0 sc1 lds
    buffer_load_dwordx4 v1, s[4:7], s44 offen offset:1024 sc1 lds
    buffer_load_dwordx4 v1, s[4:7], s44 offen offset:2048 sc1 lds
    buffer_load_dwordx4 v1, s[4:7], s44 offen offset:3072 sc1 lds
    s_lshl_b32 s36, s29, 5
    s_add_u32 s36, s36, s30
    s_lshl_b32 s36, s36, 8
    v_mov_b32 v10, s36
    s_cmp_lg_u32 s28, 0
    s_cbranch_scc1 Lpe_15
    s_mov_b32 s36, 0x70000
    s_mov_b32 s37, 0
Lpoll_14:
    buffer_load_dword v11, v10, s[4:7], s36 offen sc1
    s_add_u32 s37, s37, 1
    s_waitcnt vmcnt(0)
    v_cmp_gt_u32 vcc, 8, v11
    s_cbranch_vccz Lpe_15
    s_cmp_lt_u32 s37, 0x100000
    s_cbranch_scc1 Lpoll_14
Lpe_15:
    s_barrier
    s_lshl_b32 s37, s30, 2
    v_and_b32 v234, 7, v0
    s_add_u32 s37, s37, s28
    v_lshlrev_b32 v234, 7, v234
    v_lshrrev_b32 v235, 4, v0
    s_lshl_b32 s39, s37, 10
    s_add_u32 s39, s39, 0x800000
    v_lshl_add_u32 v234, v235, 4, v234
    s_lshl_b32 s38, s37, 14
    buffer_load_dwordx4 v[124:127], v234, s[4:7], s39 offen sc1
    s_add_u32 s38, s38, 0x400000
    buffer_load_dwordx4 v[92:95], v1, s[4:7], s38 offen offset:0 sc1
    buffer_load_dwordx4 v[96:99], v1, s[4:7], s38 offen offset:1024 sc1
    buffer_load_dwordx4 v[100:103], v1, s[4:7], s38 offen offset:2048 sc1
    buffer_load_dwordx4 v[104:107], v1, s[4:7], s38 offen offset:3072 sc1
    s_add_u32 s38, s38, 4096
    buffer_load_dwordx4 v[108:111], v1, s[4:7], s38 offen offset:0 sc1
    buffer_load_dwordx4 v[112:115], v1, s[4:7], s38 offen offset:1024 sc1
    buffer_load_dwordx4 v[116:119], v1, s[4:7], s38 offen offset:2048 sc1
    buffer_load_dwordx4 v[120:123], v1, s[4:7], s38 offen offset:3072 sc1
    s_add_u32 s38, s38, 4096
    buffer_load_dwordx4 v[148:151], v1, s[4:7], s38 offen offset:0 sc1
    buffer_load_dwordx4 v[152:155], v1, s[4:7], s38 offen offset:1024 sc1
    buffer_load_dwordx4 v[172:175], v1, s[4:7], s38 offen offset:2048 sc1
    buffer_load_dwordx4 v[176:179], v1, s[4:7], s38 offen offset:3072 sc1
    s_add_u32 s38, s38, 4096
    buffer_load_dwordx4 v[196:199], v1, s[4:7], s38 offen offset:0 sc1
    buffer_load_dwordx4 v[200:203], v1, s[4:7], s38 offen offset:1024 sc1
    buffer_load_dwordx4 v[220:223], v1, s[4:7], s38 offen offset:2048 sc1
    buffer_load_dwordx4 v[224:227], v1, s[4:7], s38 offen offset:3072 sc1
    s_lshr_b32 s36, s28, 1
    s_and_b32 s37, s28, 1
    s_mul_i32 s36, s36, 3072
    s_lshl_b32 s37, s37, 3
    s_add_u32 s36, s36, s37
    v_add_u32 v236, s36, v1
    s_waitcnt vmcnt(16)
    v_add_f32_dpp v124, v124, v124 row_ror:4 row_mask:0xf bank_mask:0xf
    v_add_f32_dpp v125, v125, v125 row_ror:4 row_mask:0xf bank_mask:0xf
    v_add_f32_dpp v126, v126, v126 row_ror:4 row_mask:0xf bank_mask:0xf
    v_add_f32_dpp v127, v127, v127 row_ror:4 row_mask:0xf bank_mask:0xf
    v_add_f32_dpp v124, v124, v124 row_ror:2 row_mask:0xf bank_mask:0xf
    v_add_f32_dpp v125, v125, v125 row_ror:2 row_mask:0xf bank_mask:0xf
    v_add_f32_dpp v126, v126, v126 row_ror:2 row_mask:0xf bank_mask:0xf
    s_waitcnt vmcnt(13)
    v_pk_add_f32 v[92:93], v[92:93], v[100:101]
    v_pk_add_f32 v[94:95], v[94:95], v[102:103]
    s_waitcnt vmcnt(12)
    v_pk_add_f32 v[96:97], v[96:97], v[104:105]
    v_pk_add_f32 v[98:99], v[98:99], v[106:107]
    v_add_f32_dpp v127, v127, v127 row_ror:2 row_mask:0xf bank_mask:0xf
    s_waitcnt vmcnt(11)
    v_pk_add_f32 v[92:93], v[92:93], v[108:109]
    v_pk_add_f32 v[94:95], v[94:95], v[110:111]
    s_waitcnt vmcnt(10)
    v_pk_add_f32 v[96:97], v[96:97], v[112:113]
    v_pk_add_f32 v[98:99], v[98:99], v[114:115]
    s_waitcnt vmcnt(9)
    v_pk_add_f32 v[92:93], v[92:93], v[116:117]
    v_pk_add_f32 v[94:95], v[94:95], v[118:119]
    s_waitcnt vmcnt(8)
    v_pk_add_f32 v[96:97], v[96:97], v[120:121]
    v_pk_add_f32 v[98:99], v[98:99], v[122:123]
    v_add_f32_dpp v124, v124, v124 row_ror:1 row_mask:0xf bank_mask:0xf
    s_waitcnt vmcnt(7)
    v_pk_add_f32 v[92:93], v[92:93], v[148:149]
    v_pk_add_f32 v[94:95], v[94:95], v[150:151]
    s_waitcnt vmcnt(6)
    v_pk_add_f32 v[96:97], v[96:97], v[152:153]
    v_pk_add_f32 v[98:99], v[98:99], v[154:155]
    s_waitcnt vmcnt(5)
    v_pk_add_f32 v[92:93], v[92:93], v[172:173]
    v_add_f32_dpp v125, v125, v125 row_ror:1 row_mask:0xf bank_mask:0xf
    v_pk_add_f32 v[94:95], v[94:95], v[174:175]
    v_add_f32_dpp v126, v126, v126 row_ror:1 row_mask:0xf bank_mask:0xf
    v_add_f32_dpp v127, v127, v127 row_ror:1 row_mask:0xf bank_mask:0xf
    s_waitcnt vmcnt(4)
    v_pk_add_f32 v[96:97], v[96:97], v[176:177]
    v_pk_add_f32 v[98:99], v[98:99], v[178:179]
    s_waitcnt vmcnt(3)
    v_pk_add_f32 v[92:93], v[92:93], v[196:197]
    v_pk_add_f32 v[94:95], v[94:95], v[198:199]
    v_cvt_pk_bf16_f32 v124, v124, v125
    s_waitcnt vmcnt(2)
    v_pk_add_f32 v[96:97], v[96:97], v[200:201]
    v_pk_add_f32 v[98:99], v[98:99], v[202:203]
    v_cvt_pk_bf16_f32 v125, v126, v127
    s_waitcnt vmcnt(1)
    v_pk_add_f32 v[92:93], v[92:93], v[220:221]
    v_pk_add_f32 v[94:95], v[94:95], v[222:223]
    s_waitcnt vmcnt(0)
    v_pk_add_f32 v[96:97], v[96:97], v[224:225]
    v_pk_add_f32 v[98:99], v[98:99], v[226:227]
    v_cndmask_b32 v124, 0, v124, s[56:57]
    v_cndmask_b32 v125, 0, v125, s[56:57]
    v_cvt_pk_bf16_f32 v92, v92, v93
    v_cvt_pk_bf16_f32 v93, v94, v95
    v_cvt_pk_bf16_f32 v94, v96, v97
    v_cvt_pk_bf16_f32 v95, v98, v99
    v_cndmask_b32 v124, v124, v16, s[58:59]
    v_cndmask_b32 v125, v125, v16, s[58:59]
    ds_write_b64 v236, v[92:93] offset:0
    ds_write_b64 v236, v[94:95] offset:1024
    ds_write_b64 v236, v[124:125] offset:2048
    s_waitcnt lgkmcnt(0)
    s_barrier
    ds_read_b128 a[8:11], v1 offset:2048
    ds_read_b128 a[20:23], v1 offset:5120
    ds_read_b128 a[0:3], v1 offset:0
    ds_read_b128 a[4:7], v1 offset:1024
    ds_read_b128 a[12:15], v1 offset:3072
    ds_read_b128 a[16:19], v1 offset:4096
    s_lshl_b32 s35, s30, 12
    s_add_u32 s35, s35, 0x2600000
    s_waitcnt lgkmcnt(5)
    v_mfma_f32_16x16x32_bf16 v[92:95], a[8:11], v[140:143], 0
    v_mfma_f32_16x16x32_bf16 v[100:103], a[8:11], v[164:167], 0
    s_waitcnt lgkmcnt(4)
    v_mfma_f32_16x16x32_bf16 v[96:99], a[20:23], v[144:147], 0
    s_nop 4
    v_rcp_f32 v94, v93
    v_mfma_f32_16x16x32_bf16 v[108:111], a[8:11], v[188:191], 0
    v_rcp_f32 v102, v101
    v_mfma_f32_16x16x32_bf16 v[104:107], a[20:23], v[168:171], 0
    v_rcp_f32 v95, v97
    v_mfma_f32_16x16x32_bf16 v[116:119], a[8:11], v[212:215], 0
    v_mul_f32 v92, v92, v94
    s_nop 2
    v_rcp_f32 v110, v109
    v_mfma_f32_16x16x32_bf16 v[112:115], a[20:23], v[192:195], 0
    v_rcp_f32 v103, v105
    v_mfma_f32_16x16x32_bf16 v[120:123], a[20:23], v[216:219], 0
    v_rcp_f32 v118, v117
    v_mul_f32 v100, v100, v102
    v_fmac_f32 v92, v96, v95
    v_mul_f32 v108, v108, v110
    s_nop 1
    v_rcp_f32 v111, v113
    s_waitcnt lgkmcnt(3)
    v_mfma_f32_16x16x32_bf16 v[132:135], a[0:3], v[140:143], 0
    v_rcp_f32 v119, v121
    v_fmac_f32 v100, v104, v103
    v_add_f32 v92, 0x358637bd, v92
    v_mul_f32 v116, v116, v118
    v_mfma_f32_16x16x32_bf16 v[156:159], a[0:3], v[164:167], 0
    v_fmac_f32 v108, v112, v111
    v_add_f32 v100, 0x358637bd, v100
    s_waitcnt lgkmcnt(2)
    v_mfma_f32_16x16x32_bf16 v[136:139], a[4:7], v[140:143], 0
    v_rcp_f32 v92, v92
    s_waitcnt lgkmcnt(1)
    v_mfma_f32_16x16x32_bf16 v[148:151], a[12:15], v[144:147], 0
    v_fmac_f32 v116, v120, v119
    v_add_f32 v108, 0x358637bd, v108
    v_mfma_f32_16x16x32_bf16 v[180:183], a[0:3], v[188:191], 0
    v_rcp_f32 v100, v100
    v_mfma_f32_16x16x32_bf16 v[160:163], a[4:7], v[164:167], 0
    v_add_f32 v116, 0x358637bd, v116
    v_rcp_f32 v108, v108
    v_mfma_f32_16x16x32_bf16 v[172:175], a[12:15], v[168:171], 0
    v_pk_mul_f32 v[94:95], v[94:95], v[92:93] op_sel:[0,0] op_sel_hi:[1,0]
    v_rcp_f32 v116, v116
    s_waitcnt lgkmcnt(0)
    v_mfma_f32_16x16x32_bf16 v[152:155], a[16:19], v[144:147], 0
    v_pk_mul_f32 v[102:103], v[102:103], v[100:101] op_sel:[0,0] op_sel_hi:[1,0]
    v_pk_mul_f32 v[132:133], v[132:133], v[94:95] op_sel:[0,0] op_sel_hi:[1,0]
    s_nop 0
    v_mfma_f32_16x16x32_bf16 v[204:207], a[0:3], v[212:215], 0
    v_pk_mul_f32 v[134:135], v[134:135], v[94:95] op_sel:[0,0] op_sel_hi:[1,0]
    v_pk_mul_f32 v[110:111], v[110:111], v[108:109] op_sel:[0,0] op_sel_hi:[1,0]
    s_nop 0
    v_mfma_f32_16x16x32_bf16 v[184:187], a[4:7], v[188:191], 0
    v_pk_mul_f32 v[156:157], v[156:157], v[102:103] op_sel:[0,0] op_sel_hi:[1,0]
    v_pk_mul_f32 v[136:137], v[136:137], v[94:95] op_sel:[0,0] op_sel_hi:[1,0]
    s_nop 0
    v_mfma_f32_16x16x32_bf16 v[196:199], a[12:15], v[192:195], 0
    v_pk_mul_f32 v[138:139], v[138:139], v[94:95] op_sel:[0,0] op_sel_hi:[1,0]
    v_pk_fma_f32 v[132:133], v[148:149], v[94:95], v[132:133] op_sel:[0,1,0] op_sel_hi:[1,1,1]
    s_nop 0
    v_mfma_f32_16x16x32_bf16 v[176:179], a[16:19], v[168:171], 0
    v_pk_mul_f32 v[158:159], v[158:159], v[102:103] op_sel:[0,0] op_sel_hi:[1,0]
    v_pk_mul_f32 v[118:119], v[118:119], v[116:117] op_sel:[0,0] op_sel_hi:[1,0]
    v_cvt_pk_bf16_f32 v132, v132, v133
    v_mfma_f32_16x16x32_bf16 v[208:211], a[4:7], v[212:215], 0
    v_pk_fma_f32 v[134:135], v[150:151], v[94:95], v[134:135] op_sel:[0,1,0] op_sel_hi:[1,1,1]
    v_pk_mul_f32 v[180:181], v[180:181], v[110:111] op_sel:[0,0] op_sel_hi:[1,0]
    v_cvt_pk_bf16_f32 v133, v134, v135
    v_mfma_f32_16x16x32_bf16 v[220:223], a[12:15], v[216:219], 0
    v_pk_mul_f32 v[160:161], v[160:161], v[102:103] op_sel:[0,0] op_sel_hi:[1,0]
    v_pk_mul_f32 v[162:163], v[162:163], v[102:103] op_sel:[0,0] op_sel_hi:[1,0]
    s_nop 0
    v_mfma_f32_16x16x32_bf16 v[200:203], a[16:19], v[192:195], 0
    v_pk_fma_f32 v[156:157], v[172:173], v[102:103], v[156:157] op_sel:[0,1,0] op_sel_hi:[1,1,1]
    v_pk_fma_f32 v[136:137], v[152:153], v[94:95], v[136:137] op_sel:[0,1,0] op_sel_hi:[1,1,1]
    v_cvt_pk_bf16_f32 v156, v156, v157
    v_mfma_f32_16x16x32_bf16 v[224:227], a[16:19], v[216:219], 0
    v_pk_fma_f32 v[138:139], v[154:155], v[94:95], v[138:139] op_sel:[0,1,0] op_sel_hi:[1,1,1]
    v_pk_mul_f32 v[182:183], v[182:183], v[110:111] op_sel:[0,0] op_sel_hi:[1,0]
    v_pk_fma_f32 v[158:159], v[174:175], v[102:103], v[158:159] op_sel:[0,1,0] op_sel_hi:[1,1,1]
    v_pk_mul_f32 v[204:205], v[204:205], v[118:119] op_sel:[0,0] op_sel_hi:[1,0]
    v_pk_mul_f32 v[184:185], v[184:185], v[110:111] op_sel:[0,0] op_sel_hi:[1,0]
    v_pk_mul_f32 v[186:187], v[186:187], v[110:111] op_sel:[0,0] op_sel_hi:[1,0]
    v_pk_fma_f32 v[180:181], v[196:197], v[110:111], v[180:181] op_sel:[0,1,0] op_sel_hi:[1,1,1]
    v_pk_fma_f32 v[160:161], v[176:177], v[102:103], v[160:161] op_sel:[0,1,0] op_sel_hi:[1,1,1]
    v_pk_fma_f32 v[162:163], v[178:179], v[102:103], v[162:163] op_sel:[0,1,0] op_sel_hi:[1,1,1]
    v_pk_mul_f32 v[206:207], v[206:207], v[118:119] op_sel:[0,0] op_sel_hi:[1,0]
    v_cvt_pk_bf16_f32 v134, v136, v137
    v_cvt_pk_bf16_f32 v135, v138, v139
    v_pk_fma_f32 v[182:183], v[198:199], v[110:111], v[182:183] op_sel:[0,1,0] op_sel_hi:[1,1,1]
    v_pk_mul_f32 v[208:209], v[208:209], v[118:119] op_sel:[0,0] op_sel_hi:[1,0]
    v_pk_mul_f32 v[210:211], v[210:211], v[118:119] op_sel:[0,0] op_sel_hi:[1,0]
    v_cvt_pk_bf16_f32 v157, v158, v159
    v_pk_fma_f32 v[204:205], v[220:221], v[118:119], v[204:205] op_sel:[0,1,0] op_sel_hi:[1,1,1]
    v_pk_fma_f32 v[184:185], v[200:201], v[110:111], v[184:185] op_sel:[0,1,0] op_sel_hi:[1,1,1]
    v_pk_fma_f32 v[186:187], v[202:203], v[110:111], v[186:187] op_sel:[0,1,0] op_sel_hi:[1,1,1]
    v_cvt_pk_bf16_f32 v180, v180, v181
    v_cvt_pk_bf16_f32 v158, v160, v161
    v_cvt_pk_bf16_f32 v159, v162, v163
    v_pk_fma_f32 v[206:207], v[222:223], v[118:119], v[206:207] op_sel:[0,1,0] op_sel_hi:[1,1,1]
    buffer_store_dwordx4 v[132:135], v2, s[4:7], s35 offen offset:0 sc1
    v_cvt_pk_bf16_f32 v181, v182, v183
    v_pk_fma_f32 v[208:209], v[224:225], v[118:119], v[208:209] op_sel:[0,1,0] op_sel_hi:[1,1,1]
    v_pk_fma_f32 v[210:211], v[226:227], v[118:119], v[210:211] op_sel:[0,1,0] op_sel_hi:[1,1,1]
    v_cvt_pk_bf16_f32 v204, v204, v205
    v_cvt_pk_bf16_f32 v182, v184, v185
    v_cvt_pk_bf16_f32 v183, v186, v187
    buffer_store_dwordx4 v[156:159], v2, s[4:7], s35 offen offset:1024 sc1
    v_cvt_pk_bf16_f32 v205, v206, v207
    v_cvt_pk_bf16_f32 v206, v208, v209
    v_cvt_pk_bf16_f32 v207, v210, v211
    buffer_store_dwordx4 v[180:183], v2, s[4:7], s35 offen offset:2048 sc1
    buffer_store_dwordx4 v[204:207], v2, s[4:7], s35 offen offset:3072 sc1
    s_lshl_b32 s36, s29, 13
    v_lshl_add_u32 v10, v0, 8, s36
    s_waitcnt vmcnt(0)
    s_barrier
    s_cmp_lg_u32 s28, 0
    s_cbranch_scc1 Lsig_16
    s_mov_b32 exec_lo, 0xffffffff
    s_mov_b32 exec_hi, 0
    s_mov_b32 s36, 0x10000
    buffer_atomic_add v12, v10, s[4:7], s36 offen sc1
    s_mov_b64 exec, -1
Lsig_16:
    s_add_u32 s40, s4, 0x2600000
    s_addc_u32 s41, s5, 0
    s_lshl_b32 s35, s34, 12
    v_add_u32 v5, 32768, v1
    v_add_u32 v6, 98304, v1
    v_lshlrev_b32 v132, 16, v32
    v_and_b32 v133, 0xffff0000, v32
    v_lshlrev_b32 v134, 16, v33
    v_and_b32 v135, 0xffff0000, v33
    v_lshlrev_b32 v136, 16, v34
    v_and_b32 v137, 0xffff0000, v34
    v_lshlrev_b32 v138, 16, v35
    v_and_b32 v139, 0xffff0000, v35
    v_lshlrev_b32 v140, 16, v36
    v_and_b32 v141, 0xffff0000, v36
    v_lshlrev_b32 v142, 16, v37
    v_and_b32 v143, 0xffff0000, v37
    v_lshlrev_b32 v144, 16, v38
    v_and_b32 v145, 0xffff0000, v38
    v_lshlrev_b32 v146, 16, v39
    v_and_b32 v147, 0xffff0000, v39
    v_lshlrev_b32 v148, 16, v40
    v_and_b32 v149, 0xffff0000, v40
    v_lshlrev_b32 v150, 16, v41
    v_and_b32 v151, 0xffff0000, v41
    v_lshlrev_b32 v152, 16, v42
    v_and_b32 v153, 0xffff0000, v42
    v_lshlrev_b32 v154, 16, v43
    v_and_b32 v155, 0xffff0000, v43
    v_lshlrev_b32 v156, 16, v44
    v_and_b32 v157, 0xffff0000, v44
    v_lshlrev_b32 v158, 16, v45
    v_and_b32 v159, 0xffff0000, v45
    v_lshlrev_b32 v160, 16, v46
    v_and_b32 v161, 0xffff0000, v46
    v_lshlrev_b32 v162, 16, v47
    v_and_b32 v163, 0xffff0000, v47
    s_lshl_b32 s36, s31, 4
    s_add_u32 s36, s36, s32
    s_lshl_b32 s36, s36, 8
    v_mov_b32 v10, s36
    s_cmp_lg_u32 s28, 0
    s_cbranch_scc1 Lpe_18
    s_mov_b32 s36, 0x10000
    s_mov_b32 s37, 0
Lpoll_17:
    buffer_load_dword v11, v10, s[4:7], s36 offen sc1
    s_add_u32 s37, s37, 1
    s_waitcnt vmcnt(0)
    v_cmp_gt_u32 vcc, 32, v11
    s_cbranch_vccz Lpe_18
    s_cmp_lt_u32 s37, 0x100000
    s_cbranch_scc1 Lpoll_17
Lpe_18:
    s_waitcnt vmcnt(0)
    s_barrier
    buffer_load_dwordx4 a[0:3], v4, s[40:43], s35 offen offset:0 sc1
    buffer_load_dwordx4 a[4:7], v4, s[40:43], s35 offen offset:1024 sc1
    s_add_u32 s35, s35, 4096
    s_and_b32 s35, s35, 0x1ffff
    buffer_load_dwordx4 a[8:11], v4, s[40:43], s35 offen offset:0 sc1
    buffer_load_dwordx4 a[12:15], v4, s[40:43], s35 offen offset:1024 sc1
    s_add_u32 s35, s35, 4096
    s_and_b32 s35, s35, 0x1ffff
    buffer_load_dwordx4 a[16:19], v4, s[40:43], s35 offen offset:0 sc1
    buffer_load_dwordx4 a[20:23], v4, s[40:43], s35 offen offset:1024 sc1
    s_add_u32 s35, s35, 4096
    s_and_b32 s35, s35, 0x1ffff
    buffer_load_dwordx4 a[24:27], v4, s[40:43], s35 offen offset:0 sc1
    buffer_load_dwordx4 a[28:31], v4, s[40:43], s35 offen offset:1024 sc1
    s_add_u32 s35, s35, 4096
    s_and_b32 s35, s35, 0x1ffff
    buffer_load_dwordx4 a[32:35], v4, s[40:43], s35 offen offset:0 sc1
    buffer_load_dwordx4 a[36:39], v4, s[40:43], s35 offen offset:1024 sc1
    s_add_u32 s35, s35, 4096
    s_and_b32 s35, s35, 0x1ffff
    ds_read_b128 a[80:83], v5 offset:0
    ds_read_b128 a[84:87], v5 offset:1024
    ds_read_b128 a[88:91], v5 offset:2048
    ds_read_b128 a[92:95], v5 offset:3072
    s_waitcnt vmcnt(8) lgkmcnt(0)
    v_mfma_f32_16x16x32_bf16 v[132:135], a[80:83], a[0:3], v[132:135]
    ds_read_b128 a[96:99], v5 offset:4096
    v_mfma_f32_16x16x32_bf16 v[148:151], a[80:83], a[4:7], v[148:151]
    ds_read_b128 a[100:103], v5 offset:5120
    v_mfma_f32_16x16x32_bf16 v[136:139], a[84:87], a[0:3], v[136:139]
    ds_read_b128 a[104:107], v5 offset:6144
    v_mfma_f32_16x16x32_bf16 v[152:155], a[84:87], a[4:7], v[152:155]
    ds_read_b128 a[108:111], v5 offset:7168
    v_mfma_f32_16x16x32_bf16 v[140:143], a[88:91], a[0:3], v[140:143]
    buffer_load_dwordx4 a[40:43], v4, s[40:43], s35 offen offset:0 sc1
    v_mfma_f32_16x16x32_bf16 v[156:159], a[88:91], a[4:7], v[156:159]
    v_mfma_f32_16x16x32_bf16 v[144:147], a[92:95], a[0:3], v[144:147]
    buffer_load_dwordx4 a[44:47], v4, s[40:43], s35 offen offset:1024 sc1
    s_add_u32 s35, s35, 4096
    s_and_b32 s35, s35, 0x1ffff
    v_mfma_f32_16x16x32_bf16 v[160:163], a[92:95], a[4:7], v[160:163]
    s_waitcnt vmcnt(8) lgkmcnt(0)
    v_mfma_f32_16x16x32_bf16 v[132:135], a[96:99], a[8:11], v[132:135]
    ds_read_b128 a[80:83], v5 offset:8192
    v_mfma_f32_16x16x32_bf16 v[148:151], a[96:99], a[12:15], v[148:151]
    ds_read_b128 a[84:87], v5 offset:9216
    v_mfma_f32_16x16x32_bf16 v[136:139], a[100:103], a[8:11], v[136:139]
    ds_read_b128 a[88:91], v5 offset:10240
    v_mfma_f32_16x16x32_bf16 v[152:155], a[100:103], a[12:15], v[152:155]
    ds_read_b128 a[92:95], v5 offset:11264
    v_mfma_f32_16x16x32_bf16 v[140:143], a[104:107], a[8:11], v[140:143]
    buffer_load_dwordx4 a[0:3], v4, s[40:43], s35 offen offset:0 sc1
    v_mfma_f32_16x16x32_bf16 v[156:159], a[104:107], a[12:15], v[156:159]
    v_mfma_f32_16x16x32_bf16 v[144:147], a[108:111], a[8:11], v[144:147]
    buffer_load_dwordx4 a[4:7], v4, s[40:43], s35 offen offset:1024 sc1
    s_add_u32 s35, s35, 4096
    s_and_b32 s35, s35, 0x1ffff
    v_mfma_f32_16x16x32_bf16 v[160:163], a[108:111], a[12:15], v[160:163]
    s_waitcnt vmcnt(8) lgkmcnt(0)
    v_mfma_f32_16x16x32_bf16 v[132:135], a[80:83], a[16:19], v[132:135]
    ds_read_b128 a[96:99], v5 offset:12288
    v_mfma_f32_16x16x32_bf16 v[148:151], a[80:83], a[20:23], v[148:151]
    ds_read_b128 a[100:103], v5 offset:13312
    v_mfma_f32_16x16x32_bf16 v[136:139], a[84:87], a[16:19], v[136:139]
    ds_read_b128 a[104:107], v5 offset:14336
    v_mfma_f32_16x16x32_bf16 v[152:155], a[84:87], a[20:23], v[152:155]
    ds_read_b128 a[108:111], v5 offset:15360
    v_mfma_f32_16x16x32_bf16 v[140:143], a[88:91], a[16:19], v[140:143]
    buffer_load_dwordx4 a[8:11], v4, s[40:43], s35 offen offset:0 sc1
    v_mfma_f32_16x16x32_bf16 v[156:159], a[88:91], a[20:23], v[156:159]
    v_mfma_f32_16x16x32_bf16 v[144:147], a[92:95], a[16:19], v[144:147]
    buffer_load_dwordx4 a[12:15], v4, s[40:43], s35 offen offset:1024 sc1
    s_add_u32 s35, s35, 4096
    s_and_b32 s35, s35, 0x1ffff
    v_mfma_f32_16x16x32_bf16 v[160:163], a[92:95], a[20:23], v[160:163]
    s_waitcnt vmcnt(8) lgkmcnt(0)
    v_mfma_f32_16x16x32_bf16 v[132:135], a[96:99], a[24:27], v[132:135]
    ds_read_b128 a[80:83], v5 offset:16384
    v_mfma_f32_16x16x32_bf16 v[148:151], a[96:99], a[28:31], v[148:151]
    ds_read_b128 a[84:87], v5 offset:17408
    v_mfma_f32_16x16x32_bf16 v[136:139], a[100:103], a[24:27], v[136:139]
    ds_read_b128 a[88:91], v5 offset:18432
    v_mfma_f32_16x16x32_bf16 v[152:155], a[100:103], a[28:31], v[152:155]
    ds_read_b128 a[92:95], v5 offset:19456
    v_mfma_f32_16x16x32_bf16 v[140:143], a[104:107], a[24:27], v[140:143]
    buffer_load_dwordx4 a[16:19], v4, s[40:43], s35 offen offset:0 sc1
    v_mfma_f32_16x16x32_bf16 v[156:159], a[104:107], a[28:31], v[156:159]
    v_mfma_f32_16x16x32_bf16 v[144:147], a[108:111], a[24:27], v[144:147]
    buffer_load_dwordx4 a[20:23], v4, s[40:43], s35 offen offset:1024 sc1
    s_add_u32 s35, s35, 4096
    s_and_b32 s35, s35, 0x1ffff
    v_mfma_f32_16x16x32_bf16 v[160:163], a[108:111], a[28:31], v[160:163]
    s_waitcnt vmcnt(8) lgkmcnt(0)
    v_mfma_f32_16x16x32_bf16 v[132:135], a[80:83], a[32:35], v[132:135]
    ds_read_b128 a[96:99], v5 offset:20480
    v_mfma_f32_16x16x32_bf16 v[148:151], a[80:83], a[36:39], v[148:151]
    ds_read_b128 a[100:103], v5 offset:21504
    v_mfma_f32_16x16x32_bf16 v[136:139], a[84:87], a[32:35], v[136:139]
    ds_read_b128 a[104:107], v5 offset:22528
    v_mfma_f32_16x16x32_bf16 v[152:155], a[84:87], a[36:39], v[152:155]
    ds_read_b128 a[108:111], v5 offset:23552
    v_mfma_f32_16x16x32_bf16 v[140:143], a[88:91], a[32:35], v[140:143]
    buffer_load_dwordx4 a[24:27], v4, s[40:43], s35 offen offset:0 sc1
    v_mfma_f32_16x16x32_bf16 v[156:159], a[88:91], a[36:39], v[156:159]
    v_mfma_f32_16x16x32_bf16 v[144:147], a[92:95], a[32:35], v[144:147]
    buffer_load_dwordx4 a[28:31], v4, s[40:43], s35 offen offset:1024 sc1
    s_add_u32 s35, s35, 4096
    s_and_b32 s35, s35, 0x1ffff
    v_mfma_f32_16x16x32_bf16 v[160:163], a[92:95], a[36:39], v[160:163]
    s_waitcnt vmcnt(8) lgkmcnt(0)
    v_mfma_f32_16x16x32_bf16 v[132:135], a[96:99], a[40:43], v[132:135]
    ds_read_b128 a[80:83], v5 offset:24576
    v_mfma_f32_16x16x32_bf16 v[148:151], a[96:99], a[44:47], v[148:151]
    ds_read_b128 a[84:87], v5 offset:25600
    v_mfma_f32_16x16x32_bf16 v[136:139], a[100:103], a[40:43], v[136:139]
    ds_read_b128 a[88:91], v5 offset:26624
    v_mfma_f32_16x16x32_bf16 v[152:155], a[100:103], a[44:47], v[152:155]
    ds_read_b128 a[92:95], v5 offset:27648
    v_mfma_f32_16x16x32_bf16 v[140:143], a[104:107], a[40:43], v[140:143]
    buffer_load_dwordx4 a[32:35], v4, s[40:43], s35 offen offset:0 sc1
    v_mfma_f32_16x16x32_bf16 v[156:159], a[104:107], a[44:47], v[156:159]
    v_mfma_f32_16x16x32_bf16 v[144:147], a[108:111], a[40:43], v[144:147]
    buffer_load_dwordx4 a[36:39], v4, s[40:43], s35 offen offset:1024 sc1
    s_add_u32 s35, s35, 4096
    s_and_b32 s35, s35, 0x1ffff
    v_mfma_f32_16x16x32_bf16 v[160:163], a[108:111], a[44:47], v[160:163]
    s_waitcnt vmcnt(8) lgkmcnt(0)
    v_mfma_f32_16x16x32_bf16 v[132:135], a[80:83], a[0:3], v[132:135]
    ds_read_b128 a[96:99], v5 offset:28672
    v_mfma_f32_16x16x32_bf16 v[148:151], a[80:83], a[4:7], v[148:151]
    ds_read_b128 a[100:103], v5 offset:29696
    v_mfma_f32_16x16x32_bf16 v[136:139], a[84:87], a[0:3], v[136:139]
    ds_read_b128 a[104:107], v5 offset:30720
    v_mfma_f32_16x16x32_bf16 v[152:155], a[84:87], a[4:7], v[152:155]
    ds_read_b128 a[108:111], v5 offset:31744
    v_mfma_f32_16x16x32_bf16 v[140:143], a[88:91], a[0:3], v[140:143]
    buffer_load_dwordx4 a[40:43], v4, s[40:43], s35 offen offset:0 sc1
    v_mfma_f32_16x16x32_bf16 v[156:159], a[88:91], a[4:7], v[156:159]
    v_mfma_f32_16x16x32_bf16 v[144:147], a[92:95], a[0:3], v[144:147]
    buffer_load_dwordx4 a[44:47], v4, s[40:43], s35 offen offset:1024 sc1
    s_add_u32 s35, s35, 4096
    s_and_b32 s35, s35, 0x1ffff
    v_mfma_f32_16x16x32_bf16 v[160:163], a[92:95], a[4:7], v[160:163]
    s_waitcnt vmcnt(8) lgkmcnt(0)
    v_mfma_f32_16x16x32_bf16 v[132:135], a[96:99], a[8:11], v[132:135]
    ds_read_b128 a[80:83], v5 offset:32768
    v_mfma_f32_16x16x32_bf16 v[148:151], a[96:99], a[12:15], v[148:151]
    ds_read_b128 a[84:87], v5 offset:33792
    v_mfma_f32_16x16x32_bf16 v[136:139], a[100:103], a[8:11], v[136:139]
    ds_read_b128 a[88:91], v5 offset:34816
    v_mfma_f32_16x16x32_bf16 v[152:155], a[100:103], a[12:15], v[152:155]
    ds_read_b128 a[92:95], v5 offset:35840
    v_mfma_f32_16x16x32_bf16 v[140:143], a[104:107], a[8:11], v[140:143]
    buffer_load_dwordx4 a[0:3], v4, s[40:43], s35 offen offset:0 sc1
    v_mfma_f32_16x16x32_bf16 v[156:159], a[104:107], a[12:15], v[156:159]
    v_mfma_f32_16x16x32_bf16 v[144:147], a[108:111], a[8:11], v[144:147]
    buffer_load_dwordx4 a[4:7], v4, s[40:43], s35 offen offset:1024 sc1
    s_add_u32 s35, s35, 4096
    s_and_b32 s35, s35, 0x1ffff
    v_mfma_f32_16x16x32_bf16 v[160:163], a[108:111], a[12:15], v[160:163]
    s_waitcnt vmcnt(8) lgkmcnt(0)
    v_mfma_f32_16x16x32_bf16 v[132:135], a[80:83], a[16:19], v[132:135]
    ds_read_b128 a[96:99], v5 offset:36864
    v_mfma_f32_16x16x32_bf16 v[148:151], a[80:83], a[20:23], v[148:151]
    ds_read_b128 a[100:103], v5 offset:37888
    v_mfma_f32_16x16x32_bf16 v[136:139], a[84:87], a[16:19], v[136:139]
    ds_read_b128 a[104:107], v5 offset:38912
    v_mfma_f32_16x16x32_bf16 v[152:155], a[84:87], a[20:23], v[152:155]
    ds_read_b128 a[108:111], v5 offset:39936
    v_mfma_f32_16x16x32_bf16 v[140:143], a[88:91], a[16:19], v[140:143]
    buffer_load_dwordx4 a[8:11], v4, s[40:43], s35 offen offset:0 sc1
    v_mfma_f32_16x16x32_bf16 v[156:159], a[88:91], a[20:23], v[156:159]
    v_mfma_f32_16x16x32_bf16 v[144:147], a[92:95], a[16:19], v[144:147]
    buffer_load_dwordx4 a[12:15], v4, s[40:43], s35 offen offset:1024 sc1
    s_add_u32 s35, s35, 4096
    s_and_b32 s35, s35, 0x1ffff
    v_mfma_f32_16x16x32_bf16 v[160:163], a[92:95], a[20:23], v[160:163]
    s_waitcnt vmcnt(8) lgkmcnt(0)
    v_mfma_f32_16x16x32_bf16 v[132:135], a[96:99], a[24:27], v[132:135]
    ds_read_b128 a[80:83], v5 offset:40960
    v_mfma_f32_16x16x32_bf16 v[148:151], a[96:99], a[28:31], v[148:151]
    ds_read_b128 a[84:87], v5 offset:41984
    v_mfma_f32_16x16x32_bf16 v[136:139], a[100:103], a[24:27], v[136:139]
    ds_read_b128 a[88:91], v5 offset:43008
    v_mfma_f32_16x16x32_bf16 v[152:155], a[100:103], a[28:31], v[152:155]
    ds_read_b128 a[92:95], v5 offset:44032
    v_mfma_f32_16x16x32_bf16 v[140:143], a[104:107], a[24:27], v[140:143]
    buffer_load_dwordx4 a[16:19], v4, s[40:43], s35 offen offset:0 sc1
    v_mfma_f32_16x16x32_bf16 v[156:159], a[104:107], a[28:31], v[156:159]
    v_mfma_f32_16x16x32_bf16 v[144:147], a[108:111], a[24:27], v[144:147]
    buffer_load_dwordx4 a[20:23], v4, s[40:43], s35 offen offset:1024 sc1
    s_add_u32 s35, s35, 4096
    s_and_b32 s35, s35, 0x1ffff
    v_mfma_f32_16x16x32_bf16 v[160:163], a[108:111], a[28:31], v[160:163]
    s_waitcnt vmcnt(8) lgkmcnt(0)
    v_mfma_f32_16x16x32_bf16 v[132:135], a[80:83], a[32:35], v[132:135]
    ds_read_b128 a[96:99], v5 offset:45056
    v_mfma_f32_16x16x32_bf16 v[148:151], a[80:83], a[36:39], v[148:151]
    ds_read_b128 a[100:103], v5 offset:46080
    v_mfma_f32_16x16x32_bf16 v[136:139], a[84:87], a[32:35], v[136:139]
    ds_read_b128 a[104:107], v5 offset:47104
    v_mfma_f32_16x16x32_bf16 v[152:155], a[84:87], a[36:39], v[152:155]
    ds_read_b128 a[108:111], v5 offset:48128
    v_mfma_f32_16x16x32_bf16 v[140:143], a[88:91], a[32:35], v[140:143]
    buffer_load_dwordx4 a[24:27], v4, s[40:43], s35 offen offset:0 sc1
    v_mfma_f32_16x16x32_bf16 v[156:159], a[88:91], a[36:39], v[156:159]
    v_mfma_f32_16x16x32_bf16 v[144:147], a[92:95], a[32:35], v[144:147]
    buffer_load_dwordx4 a[28:31], v4, s[40:43], s35 offen offset:1024 sc1
    s_add_u32 s35, s35, 4096
    s_and_b32 s35, s35, 0x1ffff
    v_mfma_f32_16x16x32_bf16 v[160:163], a[92:95], a[36:39], v[160:163]
    s_waitcnt vmcnt(8) lgkmcnt(0)
    v_mfma_f32_16x16x32_bf16 v[132:135], a[96:99], a[40:43], v[132:135]
    ds_read_b128 a[80:83], v5 offset:49152
    v_mfma_f32_16x16x32_bf16 v[148:151], a[96:99], a[44:47], v[148:151]
    ds_read_b128 a[84:87], v5 offset:50176
    v_mfma_f32_16x16x32_bf16 v[136:139], a[100:103], a[40:43], v[136:139]
    ds_read_b128 a[88:91], v5 offset:51200
    v_mfma_f32_16x16x32_bf16 v[152:155], a[100:103], a[44:47], v[152:155]
    ds_read_b128 a[92:95], v5 offset:52224
    v_mfma_f32_16x16x32_bf16 v[140:143], a[104:107], a[40:43], v[140:143]
    buffer_load_dwordx4 a[32:35], v4, s[40:43], s35 offen offset:0 sc1
    v_mfma_f32_16x16x32_bf16 v[156:159], a[104:107], a[44:47], v[156:159]
    v_mfma_f32_16x16x32_bf16 v[144:147], a[108:111], a[40:43], v[144:147]
    buffer_load_dwordx4 a[36:39], v4, s[40:43], s35 offen offset:1024 sc1
    s_add_u32 s35, s35, 4096
    s_and_b32 s35, s35, 0x1ffff
    v_mfma_f32_16x16x32_bf16 v[160:163], a[108:111], a[44:47], v[160:163]
    s_waitcnt vmcnt(8) lgkmcnt(0)
    v_mfma_f32_16x16x32_bf16 v[132:135], a[80:83], a[0:3], v[132:135]
    ds_read_b128 a[96:99], v5 offset:53248
    v_mfma_f32_16x16x32_bf16 v[148:151], a[80:83], a[4:7], v[148:151]
    ds_read_b128 a[100:103], v5 offset:54272
    v_mfma_f32_16x16x32_bf16 v[136:139], a[84:87], a[0:3], v[136:139]
    ds_read_b128 a[104:107], v5 offset:55296
    v_mfma_f32_16x16x32_bf16 v[152:155], a[84:87], a[4:7], v[152:155]
    ds_read_b128 a[108:111], v5 offset:56320
    v_mfma_f32_16x16x32_bf16 v[140:143], a[88:91], a[0:3], v[140:143]
    buffer_load_dwordx4 a[40:43], v4, s[40:43], s35 offen offset:0 sc1
    v_mfma_f32_16x16x32_bf16 v[156:159], a[88:91], a[4:7], v[156:159]
    v_mfma_f32_16x16x32_bf16 v[144:147], a[92:95], a[0:3], v[144:147]
    buffer_load_dwordx4 a[44:47], v4, s[40:43], s35 offen offset:1024 sc1
    s_add_u32 s35, s35, 4096
    s_and_b32 s35, s35, 0x1ffff
    v_mfma_f32_16x16x32_bf16 v[160:163], a[92:95], a[4:7], v[160:163]
    s_waitcnt vmcnt(8) lgkmcnt(0)
    v_mfma_f32_16x16x32_bf16 v[132:135], a[96:99], a[8:11], v[132:135]
    ds_read_b128 a[80:83], v5 offset:57344
    v_mfma_f32_16x16x32_bf16 v[148:151], a[96:99], a[12:15], v[148:151]
    ds_read_b128 a[84:87], v5 offset:58368
    v_mfma_f32_16x16x32_bf16 v[136:139], a[100:103], a[8:11], v[136:139]
    ds_read_b128 a[88:91], v5 offset:59392
    v_mfma_f32_16x16x32_bf16 v[152:155], a[100:103], a[12:15], v[152:155]
    ds_read_b128 a[92:95], v5 offset:60416
    v_mfma_f32_16x16x32_bf16 v[140:143], a[104:107], a[8:11], v[140:143]
    buffer_load_dwordx4 a[0:3], v4, s[40:43], s35 offen offset:0 sc1
    v_mfma_f32_16x16x32_bf16 v[156:159], a[104:107], a[12:15], v[156:159]
    v_mfma_f32_16x16x32_bf16 v[144:147], a[108:111], a[8:11], v[144:147]
    buffer_load_dwordx4 a[4:7], v4, s[40:43], s35 offen offset:1024 sc1
    s_add_u32 s35, s35, 4096
    s_and_b32 s35, s35, 0x1ffff
    v_mfma_f32_16x16x32_bf16 v[160:163], a[108:111], a[12:15], v[160:163]
    s_waitcnt vmcnt(8) lgkmcnt(0)
    v_mfma_f32_16x16x32_bf16 v[132:135], a[80:83], a[16:19], v[132:135]
    ds_read_b128 a[96:99], v5 offset:61440
    v_mfma_f32_16x16x32_bf16 v[148:151], a[80:83], a[20:23], v[148:151]
    ds_read_b128 a[100:103], v5 offset:62464
    v_mfma_f32_16x16x32_bf16 v[136:139], a[84:87], a[16:19], v[136:139]
    ds_read_b128 a[104:107], v5 offset:63488
    v_mfma_f32_16x16x32_bf16 v[152:155], a[84:87], a[20:23], v[152:155]
    ds_read_b128 a[108:111], v5 offset:64512
    v_mfma_f32_16x16x32_bf16 v[140:143], a[88:91], a[16:19], v[140:143]
    buffer_load_dwordx4 a[8:11], v4, s[40:43], s35 offen offset:0 sc1
    v_mfma_f32_16x16x32_bf16 v[156:159], a[88:91], a[20:23], v[156:159]
    v_mfma_f32_16x16x32_bf16 v[144:147], a[92:95], a[16:19], v[144:147]
    buffer_load_dwordx4 a[12:15], v4, s[40:43], s35 offen offset:1024 sc1
    s_add_u32 s35, s35, 4096
    s_and_b32 s35, s35, 0x1ffff
    v_mfma_f32_16x16x32_bf16 v[160:163], a[92:95], a[20:23], v[160:163]
    s_waitcnt vmcnt(8) lgkmcnt(0)
    v_mfma_f32_16x16x32_bf16 v[132:135], a[96:99], a[24:27], v[132:135]
    ds_read_b128 a[80:83], v6 offset:0
    v_mfma_f32_16x16x32_bf16 v[148:151], a[96:99], a[28:31], v[148:151]
    ds_read_b128 a[84:87], v6 offset:1024
    v_mfma_f32_16x16x32_bf16 v[136:139], a[100:103], a[24:27], v[136:139]
    ds_read_b128 a[88:91], v6 offset:2048
    v_mfma_f32_16x16x32_bf16 v[152:155], a[100:103], a[28:31], v[152:155]
    ds_read_b128 a[92:95], v6 offset:3072
    v_mfma_f32_16x16x32_bf16 v[140:143], a[104:107], a[24:27], v[140:143]
    buffer_load_dwordx4 a[16:19], v4, s[40:43], s35 offen offset:0 sc1
    v_mfma_f32_16x16x32_bf16 v[156:159], a[104:107], a[28:31], v[156:159]
    v_mfma_f32_16x16x32_bf16 v[144:147], a[108:111], a[24:27], v[144:147]
    buffer_load_dwordx4 a[20:23], v4, s[40:43], s35 offen offset:1024 sc1
    s_add_u32 s35, s35, 4096
    s_and_b32 s35, s35, 0x1ffff
    v_mfma_f32_16x16x32_bf16 v[160:163], a[108:111], a[28:31], v[160:163]
    s_waitcnt vmcnt(8) lgkmcnt(0)
    v_mfma_f32_16x16x32_bf16 v[132:135], a[80:83], a[32:35], v[132:135]
    ds_read_b128 a[96:99], v6 offset:4096
    v_mfma_f32_16x16x32_bf16 v[148:151], a[80:83], a[36:39], v[148:151]
    ds_read_b128 a[100:103], v6 offset:5120
    v_mfma_f32_16x16x32_bf16 v[136:139], a[84:87], a[32:35], v[136:139]
    ds_read_b128 a[104:107], v6 offset:6144
    v_mfma_f32_16x16x32_bf16 v[152:155], a[84:87], a[36:39], v[152:155]
    ds_read_b128 a[108:111], v6 offset:7168
    v_mfma_f32_16x16x32_bf16 v[140:143], a[88:91], a[32:35], v[140:143]
    buffer_load_dwordx4 a[24:27], v4, s[40:43], s35 offen offset:0 sc1
    v_mfma_f32_16x16x32_bf16 v[156:159], a[88:91], a[36:39], v[156:159]
    v_mfma_f32_16x16x32_bf16 v[144:147], a[92:95], a[32:35], v[144:147]
    buffer_load_dwordx4 a[28:31], v4, s[40:43], s35 offen offset:1024 sc1
    s_add_u32 s35, s35, 4096
    s_and_b32 s35, s35, 0x1ffff
    v_mfma_f32_16x16x32_bf16 v[160:163], a[92:95], a[36:39], v[160:163]
    s_waitcnt vmcnt(8) lgkmcnt(0)
    v_mfma_f32_16x16x32_bf16 v[132:135], a[96:99], a[40:43], v[132:135]
    ds_read_b128 a[80:83], v6 offset:8192
    v_mfma_f32_16x16x32_bf16 v[148:151], a[96:99], a[44:47], v[148:151]
    ds_read_b128 a[84:87], v6 offset:9216
    v_mfma_f32_16x16x32_bf16 v[136:139], a[100:103], a[40:43], v[136:139]
    ds_read_b128 a[88:91], v6 offset:10240
    v_mfma_f32_16x16x32_bf16 v[152:155], a[100:103], a[44:47], v[152:155]
    ds_read_b128 a[92:95], v6 offset:11264
    v_mfma_f32_16x16x32_bf16 v[140:143], a[104:107], a[40:43], v[140:143]
    buffer_load_dwordx4 a[32:35], v4, s[40:43], s35 offen offset:0 sc1
    v_mfma_f32_16x16x32_bf16 v[156:159], a[104:107], a[44:47], v[156:159]
    v_mfma_f32_16x16x32_bf16 v[144:147], a[108:111], a[40:43], v[144:147]
    buffer_load_dwordx4 a[36:39], v4, s[40:43], s35 offen offset:1024 sc1
    s_add_u32 s35, s35, 4096
    s_and_b32 s35, s35, 0x1ffff
    v_mfma_f32_16x16x32_bf16 v[160:163], a[108:111], a[44:47], v[160:163]
    s_waitcnt vmcnt(8) lgkmcnt(0)
    v_mfma_f32_16x16x32_bf16 v[132:135], a[80:83], a[0:3], v[132:135]
    ds_read_b128 a[96:99], v6 offset:12288
    v_mfma_f32_16x16x32_bf16 v[148:151], a[80:83], a[4:7], v[148:151]
    ds_read_b128 a[100:103], v6 offset:13312
    v_mfma_f32_16x16x32_bf16 v[136:139], a[84:87], a[0:3], v[136:139]
    ds_read_b128 a[104:107], v6 offset:14336
    v_mfma_f32_16x16x32_bf16 v[152:155], a[84:87], a[4:7], v[152:155]
    ds_read_b128 a[108:111], v6 offset:15360
    v_mfma_f32_16x16x32_bf16 v[140:143], a[88:91], a[0:3], v[140:143]
    buffer_load_dwordx4 a[40:43], v4, s[40:43], s35 offen offset:0 sc1
    v_mfma_f32_16x16x32_bf16 v[156:159], a[88:91], a[4:7], v[156:159]
    v_mfma_f32_16x16x32_bf16 v[144:147], a[92:95], a[0:3], v[144:147]
    buffer_load_dwordx4 a[44:47], v4, s[40:43], s35 offen offset:1024 sc1
    s_add_u32 s35, s35, 4096
    s_and_b32 s35, s35, 0x1ffff
    v_mfma_f32_16x16x32_bf16 v[160:163], a[92:95], a[4:7], v[160:163]
    s_waitcnt vmcnt(8) lgkmcnt(0)
    v_mfma_f32_16x16x32_bf16 v[132:135], a[96:99], a[8:11], v[132:135]
    ds_read_b128 a[80:83], v6 offset:16384
    v_mfma_f32_16x16x32_bf16 v[148:151], a[96:99], a[12:15], v[148:151]
    ds_read_b128 a[84:87], v6 offset:17408
    v_mfma_f32_16x16x32_bf16 v[136:139], a[100:103], a[8:11], v[136:139]
    ds_read_b128 a[88:91], v6 offset:18432
    v_mfma_f32_16x16x32_bf16 v[152:155], a[100:103], a[12:15], v[152:155]
    ds_read_b128 a[92:95], v6 offset:19456
    v_mfma_f32_16x16x32_bf16 v[140:143], a[104:107], a[8:11], v[140:143]
    buffer_load_dwordx4 a[0:3], v4, s[40:43], s35 offen offset:0 sc1
    v_mfma_f32_16x16x32_bf16 v[156:159], a[104:107], a[12:15], v[156:159]
    v_mfma_f32_16x16x32_bf16 v[144:147], a[108:111], a[8:11], v[144:147]
    buffer_load_dwordx4 a[4:7], v4, s[40:43], s35 offen offset:1024 sc1
    s_add_u32 s35, s35, 4096
    s_and_b32 s35, s35, 0x1ffff
    v_mfma_f32_16x16x32_bf16 v[160:163], a[108:111], a[12:15], v[160:163]
    s_waitcnt vmcnt(8) lgkmcnt(0)
    v_mfma_f32_16x16x32_bf16 v[132:135], a[80:83], a[16:19], v[132:135]
    ds_read_b128 a[96:99], v6 offset:20480
    v_mfma_f32_16x16x32_bf16 v[148:151], a[80:83], a[20:23], v[148:151]
    ds_read_b128 a[100:103], v6 offset:21504
    v_mfma_f32_16x16x32_bf16 v[136:139], a[84:87], a[16:19], v[136:139]
    ds_read_b128 a[104:107], v6 offset:22528
    v_mfma_f32_16x16x32_bf16 v[152:155], a[84:87], a[20:23], v[152:155]
    ds_read_b128 a[108:111], v6 offset:23552
    v_mfma_f32_16x16x32_bf16 v[140:143], a[88:91], a[16:19], v[140:143]
    buffer_load_dwordx4 a[8:11], v4, s[40:43], s35 offen offset:0 sc1
    v_mfma_f32_16x16x32_bf16 v[156:159], a[88:91], a[20:23], v[156:159]
    v_mfma_f32_16x16x32_bf16 v[144:147], a[92:95], a[16:19], v[144:147]
    buffer_load_dwordx4 a[12:15], v4, s[40:43], s35 offen offset:1024 sc1
    s_add_u32 s35, s35, 4096
    s_and_b32 s35, s35, 0x1ffff
    v_mfma_f32_16x16x32_bf16 v[160:163], a[92:95], a[20:23], v[160:163]
    s_waitcnt vmcnt(8) lgkmcnt(0)
    v_mfma_f32_16x16x32_bf16 v[132:135], a[96:99], a[24:27], v[132:135]
    ds_read_b128 a[80:83], v6 offset:24576
    v_mfma_f32_16x16x32_bf16 v[148:151], a[96:99], a[28:31], v[148:151]
    ds_read_b128 a[84:87], v6 offset:25600
    v_mfma_f32_16x16x32_bf16 v[136:139], a[100:103], a[24:27], v[136:139]
    ds_read_b128 a[88:91], v6 offset:26624
    v_mfma_f32_16x16x32_bf16 v[152:155], a[100:103], a[28:31], v[152:155]
    ds_read_b128 a[92:95], v6 offset:27648
    v_mfma_f32_16x16x32_bf16 v[140:143], a[104:107], a[24:27], v[140:143]
    buffer_load_dwordx4 a[16:19], v4, s[40:43], s35 offen offset:0 sc1
    v_mfma_f32_16x16x32_bf16 v[156:159], a[104:107], a[28:31], v[156:159]
    v_mfma_f32_16x16x32_bf16 v[144:147], a[108:111], a[24:27], v[144:147]
    buffer_load_dwordx4 a[20:23], v4, s[40:43], s35 offen offset:1024 sc1
    s_add_u32 s35, s35, 4096
    s_and_b32 s35, s35, 0x1ffff
    v_mfma_f32_16x16x32_bf16 v[160:163], a[108:111], a[28:31], v[160:163]
    s_waitcnt vmcnt(8) lgkmcnt(0)
    v_mfma_f32_16x16x32_bf16 v[132:135], a[80:83], a[32:35], v[132:135]
    ds_read_b128 a[96:99], v6 offset:28672
    v_mfma_f32_16x16x32_bf16 v[148:151], a[80:83], a[36:39], v[148:151]
    ds_read_b128 a[100:103], v6 offset:29696
    v_mfma_f32_16x16x32_bf16 v[136:139], a[84:87], a[32:35], v[136:139]
    ds_read_b128 a[104:107], v6 offset:30720
    v_mfma_f32_16x16x32_bf16 v[152:155], a[84:87], a[36:39], v[152:155]
    ds_read_b128 a[108:111], v6 offset:31744
    v_mfma_f32_16x16x32_bf16 v[140:143], a[88:91], a[32:35], v[140:143]
    buffer_load_dwordx4 a[24:27], v4, s[40:43], s35 offen offset:0 sc1
    v_mfma_f32_16x16x32_bf16 v[156:159], a[88:91], a[36:39], v[156:159]
    v_mfma_f32_16x16x32_bf16 v[144:147], a[92:95], a[32:35], v[144:147]
    buffer_load_dwordx4 a[28:31], v4, s[40:43], s35 offen offset:1024 sc1
    s_add_u32 s35, s35, 4096
    s_and_b32 s35, s35, 0x1ffff
    v_mfma_f32_16x16x32_bf16 v[160:163], a[92:95], a[36:39], v[160:163]
    s_waitcnt vmcnt(8) lgkmcnt(0)
    v_mfma_f32_16x16x32_bf16 v[132:135], a[96:99], a[40:43], v[132:135]
    ds_read_b128 a[80:83], v6 offset:32768
    v_mfma_f32_16x16x32_bf16 v[148:151], a[96:99], a[44:47], v[148:151]
    ds_read_b128 a[84:87], v6 offset:33792
    v_mfma_f32_16x16x32_bf16 v[136:139], a[100:103], a[40:43], v[136:139]
    ds_read_b128 a[88:91], v6 offset:34816
    v_mfma_f32_16x16x32_bf16 v[152:155], a[100:103], a[44:47], v[152:155]
    ds_read_b128 a[92:95], v6 offset:35840
    v_mfma_f32_16x16x32_bf16 v[140:143], a[104:107], a[40:43], v[140:143]
    buffer_load_dwordx4 a[32:35], v4, s[40:43], s35 offen offset:0 sc1
    v_mfma_f32_16x16x32_bf16 v[156:159], a[104:107], a[44:47], v[156:159]
    v_mfma_f32_16x16x32_bf16 v[144:147], a[108:111], a[40:43], v[144:147]
    buffer_load_dwordx4 a[36:39], v4, s[40:43], s35 offen offset:1024 sc1
    s_add_u32 s35, s35, 4096
    s_and_b32 s35, s35, 0x1ffff
    v_mfma_f32_16x16x32_bf16 v[160:163], a[108:111], a[44:47], v[160:163]
    s_waitcnt vmcnt(8) lgkmcnt(0)
    v_mfma_f32_16x16x32_bf16 v[132:135], a[80:83], a[0:3], v[132:135]
    ds_read_b128 a[96:99], v6 offset:36864
    v_mfma_f32_16x16x32_bf16 v[148:151], a[80:83], a[4:7], v[148:151]
    ds_read_b128 a[100:103], v6 offset:37888
    v_mfma_f32_16x16x32_bf16 v[136:139], a[84:87], a[0:3], v[136:139]
    ds_read_b128 a[104:107], v6 offset:38912
    v_mfma_f32_16x16x32_bf16 v[152:155], a[84:87], a[4:7], v[152:155]
    ds_read_b128 a[108:111], v6 offset:39936
    v_mfma_f32_16x16x32_bf16 v[140:143], a[88:91], a[0:3], v[140:143]
    buffer_load_dwordx4 a[40:43], v4, s[40:43], s35 offen offset:0 sc1
    v_mfma_f32_16x16x32_bf16 v[156:159], a[88:91], a[4:7], v[156:159]
    v_mfma_f32_16x16x32_bf16 v[144:147], a[92:95], a[0:3], v[144:147]
    buffer_load_dwordx4 a[44:47], v4, s[40:43], s35 offen offset:1024 sc1
    s_add_u32 s35, s35, 4096
    s_and_b32 s35, s35, 0x1ffff
    v_mfma_f32_16x16x32_bf16 v[160:163], a[92:95], a[4:7], v[160:163]
    s_waitcnt vmcnt(8) lgkmcnt(0)
    v_mfma_f32_16x16x32_bf16 v[132:135], a[96:99], a[8:11], v[132:135]
    ds_read_b128 a[80:83], v6 offset:40960
    v_mfma_f32_16x16x32_bf16 v[148:151], a[96:99], a[12:15], v[148:151]
    ds_read_b128 a[84:87], v6 offset:41984
    v_mfma_f32_16x16x32_bf16 v[136:139], a[100:103], a[8:11], v[136:139]
    ds_read_b128 a[88:91], v6 offset:43008
    v_mfma_f32_16x16x32_bf16 v[152:155], a[100:103], a[12:15], v[152:155]
    ds_read_b128 a[92:95], v6 offset:44032
    v_mfma_f32_16x16x32_bf16 v[140:143], a[104:107], a[8:11], v[140:143]
    buffer_load_dwordx4 a[0:3], v4, s[40:43], s35 offen offset:0 sc1
    v_mfma_f32_16x16x32_bf16 v[156:159], a[104:107], a[12:15], v[156:159]
    v_mfma_f32_16x16x32_bf16 v[144:147], a[108:111], a[8:11], v[144:147]
    buffer_load_dwordx4 a[4:7], v4, s[40:43], s35 offen offset:1024 sc1
    s_add_u32 s35, s35, 4096
    s_and_b32 s35, s35, 0x1ffff
    v_mfma_f32_16x16x32_bf16 v[160:163], a[108:111], a[12:15], v[160:163]
    s_waitcnt vmcnt(8) lgkmcnt(0)
    v_mfma_f32_16x16x32_bf16 v[132:135], a[80:83], a[16:19], v[132:135]
    ds_read_b128 a[96:99], v6 offset:45056
    v_mfma_f32_16x16x32_bf16 v[148:151], a[80:83], a[20:23], v[148:151]
    ds_read_b128 a[100:103], v6 offset:46080
    v_mfma_f32_16x16x32_bf16 v[136:139], a[84:87], a[16:19], v[136:139]
    ds_read_b128 a[104:107], v6 offset:47104
    v_mfma_f32_16x16x32_bf16 v[152:155], a[84:87], a[20:23], v[152:155]
    ds_read_b128 a[108:111], v6 offset:48128
    v_mfma_f32_16x16x32_bf16 v[140:143], a[88:91], a[16:19], v[140:143]
    buffer_load_dwordx4 a[8:11], v4, s[40:43], s35 offen offset:0 sc1
    v_mfma_f32_16x16x32_bf16 v[156:159], a[88:91], a[20:23], v[156:159]
    v_mfma_f32_16x16x32_bf16 v[144:147], a[92:95], a[16:19], v[144:147]
    buffer_load_dwordx4 a[12:15], v4, s[40:43], s35 offen offset:1024 sc1
    s_add_u32 s35, s35, 4096
    s_and_b32 s35, s35, 0x1ffff
    v_mfma_f32_16x16x32_bf16 v[160:163], a[92:95], a[20:23], v[160:163]
    s_waitcnt vmcnt(8) lgkmcnt(0)
    v_mfma_f32_16x16x32_bf16 v[132:135], a[96:99], a[24:27], v[132:135]
    ds_read_b128 a[80:83], v6 offset:49152
    v_mfma_f32_16x16x32_bf16 v[148:151], a[96:99], a[28:31], v[148:151]
    ds_read_b128 a[84:87], v6 offset:50176
    v_mfma_f32_16x16x32_bf16 v[136:139], a[100:103], a[24:27], v[136:139]
    ds_read_b128 a[88:91], v6 offset:51200
    v_mfma_f32_16x16x32_bf16 v[152:155], a[100:103], a[28:31], v[152:155]
    ds_read_b128 a[92:95], v6 offset:52224
    v_mfma_f32_16x16x32_bf16 v[140:143], a[104:107], a[24:27], v[140:143]
    v_mfma_f32_16x16x32_bf16 v[156:159], a[104:107], a[28:31], v[156:159]
    v_mfma_f32_16x16x32_bf16 v[144:147], a[108:111], a[24:27], v[144:147]
    v_mfma_f32_16x16x32_bf16 v[160:163], a[108:111], a[28:31], v[160:163]
    s_waitcnt vmcnt(6) lgkmcnt(0)
    v_mfma_f32_16x16x32_bf16 v[132:135], a[80:83], a[32:35], v[132:135]
    ds_read_b128 a[96:99], v6 offset:53248
    v_mfma_f32_16x16x32_bf16 v[148:151], a[80:83], a[36:39], v[148:151]
    ds_read_b128 a[100:103], v6 offset:54272
    v_mfma_f32_16x16x32_bf16 v[136:139], a[84:87], a[32:35], v[136:139]
    ds_read_b128 a[104:107], v6 offset:55296
    v_mfma_f32_16x16x32_bf16 v[152:155], a[84:87], a[36:39], v[152:155]
    ds_read_b128 a[108:111], v6 offset:56320
    v_mfma_f32_16x16x32_bf16 v[140:143], a[88:91], a[32:35], v[140:143]
    v_mfma_f32_16x16x32_bf16 v[156:159], a[88:91], a[36:39], v[156:159]
    v_mfma_f32_16x16x32_bf16 v[144:147], a[92:95], a[32:35], v[144:147]
    v_mfma_f32_16x16x32_bf16 v[160:163], a[92:95], a[36:39], v[160:163]
    s_waitcnt vmcnt(4) lgkmcnt(0)
    v_mfma_f32_16x16x32_bf16 v[132:135], a[96:99], a[40:43], v[132:135]
    ds_read_b128 a[80:83], v6 offset:57344
    v_mfma_f32_16x16x32_bf16 v[148:151], a[96:99], a[44:47], v[148:151]
    ds_read_b128 a[84:87], v6 offset:58368
    v_mfma_f32_16x16x32_bf16 v[136:139], a[100:103], a[40:43], v[136:139]
    ds_read_b128 a[88:91], v6 offset:59392
    v_mfma_f32_16x16x32_bf16 v[152:155], a[100:103], a[44:47], v[152:155]
    ds_read_b128 a[92:95], v6 offset:60416
    v_mfma_f32_16x16x32_bf16 v[140:143], a[104:107], a[40:43], v[140:143]
    v_mfma_f32_16x16x32_bf16 v[156:159], a[104:107], a[44:47], v[156:159]
    v_mfma_f32_16x16x32_bf16 v[144:147], a[108:111], a[40:43], v[144:147]
    v_mfma_f32_16x16x32_bf16 v[160:163], a[108:111], a[44:47], v[160:163]
    s_waitcnt vmcnt(2) lgkmcnt(0)
    v_mfma_f32_16x16x32_bf16 v[132:135], a[80:83], a[0:3], v[132:135]
    ds_read_b128 a[96:99], v6 offset:61440
    v_mfma_f32_16x16x32_bf16 v[148:151], a[80:83], a[4:7], v[148:151]
    ds_read_b128 a[100:103], v6 offset:62464
    v_mfma_f32_16x16x32_bf16 v[136:139], a[84:87], a[0:3], v[136:139]
    ds_read_b128 a[104:107], v6 offset:63488
    v_mfma_f32_16x16x32_bf16 v[152:155], a[84:87], a[4:7], v[152:155]
    ds_read_b128 a[108:111], v6 offset:64512
    v_mfma_f32_16x16x32_bf16 v[140:143], a[88:91], a[0:3], v[140:143]
    v_mfma_f32_16x16x32_bf16 v[156:159], a[88:91], a[4:7], v[156:159]
    v_mfma_f32_16x16x32_bf16 v[144:147], a[92:95], a[0:3], v[144:147]
    v_mfma_f32_16x16x32_bf16 v[160:163], a[92:95], a[4:7], v[160:163]
    s_waitcnt vmcnt(0) lgkmcnt(0)
    s_barrier
    v_mfma_f32_16x16x32_bf16 v[132:135], a[96:99], a[8:11], v[132:135]
    v_mfma_f32_16x16x32_bf16 v[148:151], a[96:99], a[12:15], v[148:151]
    v_mfma_f32_16x16x32_bf16 v[136:139], a[100:103], a[8:11], v[136:139]
    v_mfma_f32_16x16x32_bf16 v[152:155], a[100:103], a[12:15], v[152:155]
    v_mfma_f32_16x16x32_bf16 v[140:143], a[104:107], a[8:11], v[140:143]
    v_mfma_f32_16x16x32_bf16 v[156:159], a[104:107], a[12:15], v[156:159]
    v_mfma_f32_16x16x32_bf16 v[144:147], a[108:111], a[8:11], v[144:147]
    v_mfma_f32_16x16x32_bf16 v[160:163], a[108:111], a[12:15], v[160:163]
    s_nop 0
    v_cvt_pk_bf16_f32 v32, v132, v133
    v_cvt_pk_bf16_f32 v33, v134, v135
    v_cvt_pk_bf16_f32 v34, v136, v137
    v_cvt_pk_bf16_f32 v35, v138, v139
    v_cvt_pk_bf16_f32 v36, v140, v141
    v_cvt_pk_bf16_f32 v37, v142, v143
    v_cvt_pk_bf16_f32 v38, v144, v145
    v_cvt_pk_bf16_f32 v39, v146, v147
    v_cvt_pk_bf16_f32 v40, v148, v149
    v_cvt_pk_bf16_f32 v41, v150, v151
    v_cvt_pk_bf16_f32 v42, v152, v153
    v_cvt_pk_bf16_f32 v43, v154, v155
    v_cvt_pk_bf16_f32 v44, v156, v157
    v_cvt_pk_bf16_f32 v45, v158, v159
    v_cvt_pk_bf16_f32 v46, v160, v161
    v_cvt_pk_bf16_f32 v47, v162, v163
    s_lshl_b32 s36, s32, 13
    s_add_u32 s36, s36, 0x2a00000
    s_add_u32 s37, s36, 4096
    s_lshl_b32 s38, s31, 2
    s_add_u32 s38, s38, s28
    s_lshl_b32 s38, s38, 12
    s_lshl_b32 s39, s32, 7
    s_add_u32 s38, s38, s39
    s_add_u32 s38, s38, 0x280000
    v_and_b32 v252, 15, v0
    v_lshrrev_b32 v253, 2, v252
    v_lshrrev_b32 v254, 4, v0
    v_cmp_eq_u32 vcc, v253, v254
    v_lshlrev_b32 v252, 3, v252
    v_mov_b32 v253, 0x80000000
    v_cndmask_b32 v252, v253, v252, vcc
    buffer_store_dwordx4 v[32:35], v4, s[4:7], s36 offen offset:0 sc1
    buffer_store_dwordx4 v[36:39], v4, s[4:7], s37 offen offset:0 sc1
    buffer_store_dwordx4 v[40:43], v4, s[4:7], s36 offen offset:1024 sc1
    buffer_store_dwordx4 v[44:47], v4, s[4:7], s37 offen offset:1024 sc1
    v_mfma_f32_16x16x32_bf16 v[96:99], v[32:35], v[32:35], 0
    v_mfma_f32_16x16x32_bf16 v[92:95], v[16:19], v[32:35], 0
    v_mfma_f32_16x16x32_bf16 v[104:107], v[40:43], v[40:43], 0
    v_mfma_f32_16x16x32_bf16 v[100:103], v[16:19], v[40:43], 0
    v_mfma_f32_16x16x32_bf16 v[96:99], v[36:39], v[36:39], v[96:99]
    v_mfma_f32_16x16x32_bf16 v[92:95], v[16:19], v[36:39], v[92:95]
    v_mfma_f32_16x16x32_bf16 v[104:107], v[44:47], v[44:47], v[104:107]
    v_mfma_f32_16x16x32_bf16 v[100:103], v[16:19], v[44:47], v[100:103]
    s_nop 4
    v_cndmask_b32 v96, v96, v97, s[46:47]
    v_cndmask_b32 v98, v98, v99, s[46:47]
    v_cndmask_b32 v93, v96, v98, s[48:49]
    buffer_store_dwordx2 v[92:93], v252, s[4:7], s38 offen offset:0 sc1
    v_cndmask_b32 v104, v104, v105, s[46:47]
    v_cndmask_b32 v106, v106, v107, s[46:47]
    v_cndmask_b32 v101, v104, v106, s[48:49]
    buffer_store_dwordx2 v[100:101], v252, s[4:7], s38 offen offset:2048 sc1
    s_lshr_b32 s36, s31, 1
    s_lshl_b32 s36, s36, 13
    v_lshl_add_u32 v10, v0, 8, s36
    s_and_b32 s37, s31, 1
    s_sub_u32 s37, 0, s37
    s_and_b32 s38, s31, 7
    s_cmp_eq_u32 s38, 7
    s_cselect_b32 s38, 0, s37
    s_and_b32 s37, s29, 3
    s_cmp_eq_u32 s37, 0
    s_cselect_b32 s54, 32, 48
    s_waitcnt vmcnt(0)
    s_barrier
    s_cmp_lg_u32 s28, 0
    s_cbranch_scc1 Lsig_19
    s_mov_b32 exec_hi, s38
    s_mov_b32 s36, 0x50000
    buffer_atomic_add v12, v10, s[4:7], s36 offen sc1
    s_mov_b64 exec, -1
Lsig_19:
    s_lshl_b32 s44, s28, 1
    s_add_u32 s44, s44, s33
    s_add_u32 s44, s44, 0
    s_and_b32 s44, s44, 31
    s_mul_i32 s44, s44, 6144
    s_add_u32 s44, s44, s50
    s_add_u32 s44, s44, 0xe00000
    s_mul_i32 s45, s28, 12288
    s_add_u32 m0, s45, 0
    s_nop 0
    buffer_load_dwordx4 v1, s[4:7], s44 offen offset:0 sc1 lds
    buffer_load_dwordx4 v1, s[4:7], s44 offen offset:1024 sc1 lds
    buffer_load_dwordx4 v1, s[4:7], s44 offen offset:2048 sc1 lds
    buffer_load_dwordx4 v1, s[4:7], s44 offen offset:3072 sc1 lds
    s_add_u32 s44, s44, 4096
    s_add_u32 m0, m0, 4096
    s_nop 0
    buffer_load_dwordx4 v1, s[4:7], s44 offen offset:0 sc1 lds
    buffer_load_dwordx4 v1, s[4:7], s44 offen offset:1024 sc1 lds
    buffer_load_dwordx4 v1, s[4:7], s44 offen offset:2048 sc1 lds
    buffer_load_dwordx4 v1, s[4:7], s44 offen offset:3072 sc1 lds
    s_add_u32 s44, s44, 4096
    s_add_u32 m0, m0, 4096
    s_nop 0
    buffer_load_dwordx4 v1, s[4:7], s44 offen offset:0 sc1 lds
    buffer_load_dwordx4 v1, s[4:7], s44 offen offset:1024 sc1 lds
    buffer_load_dwordx4 v1, s[4:7], s44 offen offset:2048 sc1 lds
    buffer_load_dwordx4 v1, s[4:7], s44 offen offset:3072 sc1 lds
    s_lshl_b32 s44, s28, 1
    s_add_u32 s44, s44, s33
    s_add_u32 s44, s44, 8
    s_and_b32 s44, s44, 31
    s_mul_i32 s44, s44, 6144
    s_add_u32 s44, s44, s50
    s_add_u32 s44, s44, 0xe00000
    s_mul_i32 s45, s28, 12288
    s_add_u32 m0, s45, 49152
    s_nop 0
    buffer_load_dwordx4 v1, s[4:7], s44 offen offset:0 sc1 lds
    buffer_load_dwordx4 v1, s[4:7], s44 offen offset:1024 sc1 lds
    buffer_load_dwordx4 v1, s[4:7], s44 offen offset:2048 sc1 lds
    buffer_load_dwordx4 v1, s[4:7], s44 offen offset:3072 sc1 lds
    s_add_u32 s44, s44, 4096
    s_add_u32 m0, m0, 4096
    s_nop 0
    buffer_load_dwordx4 v1, s[4:7], s44 offen offset:0 sc1 lds
    buffer_load_dwordx4 v1, s[4:7], s44 offen offset:1024 sc1 lds
    buffer_load_dwordx4 v1, s[4:7], s44 offen offset:2048 sc1 lds
    buffer_load_dwordx4 v1, s[4:7], s44 offen offset:3072 sc1 lds
    s_add_u32 s44, s44, 4096
    s_add_u32 m0, m0, 4096
    s_nop 0
    buffer_load_dwordx4 v1, s[4:7], s44 offen offset:0 sc1 lds
    buffer_load_dwordx4 v1, s[4:7], s44 offen offset:1024 sc1 lds
    buffer_load_dwordx4 v1, s[4:7], s44 offen offset:2048 sc1 lds
    buffer_load_dwordx4 v1, s[4:7], s44 offen offset:3072 sc1 lds
    s_add_u32 s40, s4, 0x2a00000
    s_addc_u32 s41, s5, 0
    s_lshl_b32 s36, s29, 5
    s_add_u32 s36, s36, s30
    s_lshl_b32 s36, s36, 8
    v_mov_b32 v10, s36
    s_cmp_lg_u32 s28, 0
    s_cbranch_scc1 Lpe_21
    s_mov_b32 s36, 0x50000
    s_mov_b32 s37, 0
Lpoll_20:
    buffer_load_dword v11, v10, s[4:7], s36 offen sc1
    s_add_u32 s37, s37, 1
    s_waitcnt vmcnt(0)
    v_cmp_gt_u32 vcc, s54, v11
    s_cbranch_vccz Lpe_21
    s_cmp_lt_u32 s37, 0x100000
    s_cbranch_scc1 Lpoll_20
Lpe_21:
    s_waitcnt vmcnt(0)
    s_barrier
    s_lshl_b32 s35, s33, 12
    s_add_u32 s39, s28, 2
    s_lshl_b32 s39, s39, 10
    buffer_load_dwordx4 a[0:3], v2, s[40:43], s35 offen offset:0 sc1
    buffer_load_dwordx4 a[4:7], v2, s[40:43], s35 offen offset:1024 sc1
    buffer_load_dwordx4 a[8:11], v2, s[40:43], s35 offen offset:2048 sc1
    buffer_load_dwordx4 a[12:15], v2, s[40:43], s35 offen offset:3072 sc1
    buffer_load_dwordx4 a[16:19], v3, s[40:43], s35 offen sc1
    s_add_u32 s35, s35, 4096
    s_and_b32 s35, s35, 0x1ffff
    buffer_load_dwordx4 a[20:23], v2, s[40:43], s35 offen offset:0 sc1
    buffer_load_dwordx4 a[24:27], v2, s[40:43], s35 offen offset:1024 sc1
    buffer_load_dwordx4 a[28:31], v2, s[40:43], s35 offen offset:2048 sc1
    buffer_load_dwordx4 a[32:35], v2, s[40:43], s35 offen offset:3072 sc1
    buffer_load_dwordx4 a[36:39], v3, s[40:43], s35 offen sc1
    s_add_u32 s35, s35, 4096
    s_and_b32 s35, s35, 0x1ffff
    buffer_load_dwordx4 a[40:43], v2, s[40:43], s35 offen offset:0 sc1
    buffer_load_dwordx4 a[44:47], v2, s[40:43], s35 offen offset:1024 sc1
    buffer_load_dwordx4 a[48:51], v2, s[40:43], s35 offen offset:2048 sc1
    buffer_load_dwordx4 a[52:55], v2, s[40:43], s35 offen offset:3072 sc1
    buffer_load_dwordx4 a[56:59], v3, s[40:43], s35 offen sc1
    s_add_u32 s35, s35, 4096
    s_and_b32 s35, s35, 0x1ffff
    v_accvgpr_read_b32 v48, a136
    v_accvgpr_read_b32 v49, a137
    v_accvgpr_read_b32 v50, a138
    v_accvgpr_read_b32 v51, a139
    v_accvgpr_read_b32 v52, a140
    v_accvgpr_read_b32 v53, a141
    v_accvgpr_read_b32 v54, a142
    v_accvgpr_read_b32 v55, a143
    v_accvgpr_read_b32 v56, a144
    v_accvgpr_read_b32 v57, a145
    v_accvgpr_read_b32 v58, a146
    v_accvgpr_read_b32 v59, a147
    v_accvgpr_read_b32 v60, a148
    v_accvgpr_read_b32 v61, a149
    v_accvgpr_read_b32 v62, a150
    v_accvgpr_read_b32 v63, a151
    v_accvgpr_read_b32 v64, a152
    v_accvgpr_read_b32 v65, a153
    v_accvgpr_read_b32 v66, a154
    v_accvgpr_read_b32 v67, a155
    v_accvgpr_read_b32 v68, a156
    v_accvgpr_read_b32 v69, a157
    v_accvgpr_read_b32 v70, a158
    v_accvgpr_read_b32 v71, a159
    v_accvgpr_read_b32 v72, a160
    v_accvgpr_read_b32 v73, a161
    v_accvgpr_read_b32 v74, a162
    v_accvgpr_read_b32 v75, a163
    v_add_u32 v5, 0, v1
    ds_read_b128 a[80:83], v5 offset:0
    v_add_u32 v6, s39, v5
    ds_read_b128 a[84:87], v5 offset:1024
    ds_read_b128 a[88:91], v5 offset:2048
    ds_read_b128 a[92:95], v5 offset:3072
    ds_read_b128 a[96:99], v5 offset:4096
    ds_read_b128 a[100:103], v5 offset:5120
    ds_read_b128 a[104:107], v6 offset:0
    s_waitcnt vmcnt(10) lgkmcnt(0)
    v_mfma_f32_16x16x32_bf16 v[132:135], a[80:83], a[0:3], 0
    ds_read_b128 a[108:111], v5 offset:6144
    v_mfma_f32_16x16x32_bf16 v[156:159], a[80:83], a[4:7], 0
    buffer_load_dwordx4 a[60:63], v2, s[40:43], s35 offen offset:0 sc1
    v_mfma_f32_16x16x32_bf16 v[180:183], a[80:83], a[8:11], 0
    ds_read_b128 a[112:115], v5 offset:7168
    v_mfma_f32_16x16x32_bf16 v[204:207], a[80:83], a[12:15], 0
    v_mfma_f32_16x16x32_bf16 v[136:139], a[84:87], a[0:3], 0
    buffer_load_dwordx4 a[64:67], v2, s[40:43], s35 offen offset:1024 sc1
    v_mfma_f32_16x16x32_bf16 v[160:163], a[84:87], a[4:7], 0
    ds_read_b128 a[116:119], v5 offset:8192
    v_mfma_f32_16x16x32_bf16 v[184:187], a[84:87], a[8:11], 0
    v_mfma_f32_16x16x32_bf16 v[208:211], a[84:87], a[12:15], 0
    ds_read_b128 a[120:123], v5 offset:9216
    buffer_load_dwordx4 a[68:71], v2, s[40:43], s35 offen offset:2048 sc1
    v_mfma_f32_16x16x32_bf16 v[140:143], a[88:91], a[0:3], 0
    v_mfma_f32_16x16x32_bf16 v[164:167], a[88:91], a[4:7], 0
    v_mfma_f32_16x16x32_bf16 v[188:191], a[88:91], a[8:11], 0
    ds_read_b128 a[124:127], v5 offset:10240
    v_mfma_f32_16x16x32_bf16 v[212:215], a[88:91], a[12:15], 0
    buffer_load_dwordx4 a[72:75], v2, s[40:43], s35 offen offset:3072 sc1
    v_mfma_f32_16x16x32_bf16 v[144:147], a[92:95], a[0:3], 0
    ds_read_b128 a[128:131], v5 offset:11264
    v_mfma_f32_16x16x32_bf16 v[168:171], a[92:95], a[4:7], 0
    v_mfma_f32_16x16x32_bf16 v[192:195], a[92:95], a[8:11], 0
    buffer_load_dwordx4 a[76:79], v3, s[40:43], s35 offen sc1
    s_add_u32 s35, s35, 4096
    s_and_b32 s35, s35, 0x1ffff
    v_mfma_f32_16x16x32_bf16 v[216:219], a[92:95], a[12:15], 0
    ds_read_b128 a[132:135], v6 offset:6144
    v_mfma_f32_16x16x32_bf16 v[148:151], a[96:99], a[0:3], 0
    v_mfma_f32_16x16x32_bf16 v[172:175], a[96:99], a[4:7], 0
    v_mfma_f32_16x16x32_bf16 v[196:199], a[96:99], a[8:11], 0
    s_lshl_b32 s44, s28, 1
    s_add_u32 s44, s44, s33
    s_add_u32 s44, s44, 16
    s_and_b32 s44, s44, 31
    s_mul_i32 s44, s44, 6144
    s_add_u32 s44, s44, s50
    s_add_u32 s44, s44, 0xe00000
    s_mul_i32 s45, s28, 12288
    s_add_u32 m0, s45, 98304
    s_nop 0
    buffer_load_dwordx4 v1, s[4:7], s44 offen offset:0 sc1 lds
    v_mfma_f32_16x16x32_bf16 v[220:223], a[96:99], a[12:15], 0
    v_mfma_f32_16x16x32_bf16 v[152:155], a[100:103], a[0:3], 0
    v_mfma_f32_16x16x32_bf16 v[176:179], a[100:103], a[4:7], 0
    buffer_load_dwordx4 v1, s[4:7], s44 offen offset:1024 sc1 lds
    v_mfma_f32_16x16x32_bf16 v[200:203], a[100:103], a[8:11], 0
    v_mfma_f32_16x16x32_bf16 v[224:227], a[100:103], a[12:15], 0
    v_mfma_f32_16x16x32_bf16 v[228:231], a[104:107], a[16:19], 0
    s_waitcnt vmcnt(12) lgkmcnt(0)
    v_mfma_f32_16x16x32_bf16 v[132:135], a[108:111], a[20:23], v[132:135]
    ds_read_b128 a[80:83], v5 offset:12288
    v_mfma_f32_16x16x32_bf16 v[156:159], a[108:111], a[24:27], v[156:159]
    buffer_load_dwordx4 a[0:3], v2, s[40:43], s35 offen offset:0 sc1
    v_mfma_f32_16x16x32_bf16 v[180:183], a[108:111], a[28:31], v[180:183]
    ds_read_b128 a[84:87], v5 offset:13312
    v_mfma_f32_16x16x32_bf16 v[204:207], a[108:111], a[32:35], v[204:207]
    v_mfma_f32_16x16x32_bf16 v[136:139], a[112:115], a[20:23], v[136:139]
    buffer_load_dwordx4 a[4:7], v2, s[40:43], s35 offen offset:1024 sc1
    v_mfma_f32_16x16x32_bf16 v[160:163], a[112:115], a[24:27], v[160:163]
    ds_read_b128 a[88:91], v5 offset:14336
    v_mfma_f32_16x16x32_bf16 v[184:187], a[112:115], a[28:31], v[184:187]
    v_mfma_f32_16x16x32_bf16 v[208:211], a[112:115], a[32:35], v[208:211]
    ds_read_b128 a[92:95], v5 offset:15360
    buffer_load_dwordx4 a[8:11], v2, s[40:43], s35 offen offset:2048 sc1
    v_mfma_f32_16x16x32_bf16 v[140:143], a[116:119], a[20:23], v[140:143]
    v_mfma_f32_16x16x32_bf16 v[164:167], a[116:119], a[24:27], v[164:167]
    v_mfma_f32_16x16x32_bf16 v[188:191], a[116:119], a[28:31], v[188:191]
    ds_read_b128 a[96:99], v5 offset:16384
    v_mfma_f32_16x16x32_bf16 v[212:215], a[116:119], a[32:35], v[212:215]
    buffer_load_dwordx4 a[12:15], v2, s[40:43], s35 offen offset:3072 sc1
    v_mfma_f32_16x16x32_bf16 v[144:147], a[120:123], a[20:23], v[144:147]
    ds_read_b128 a[100:103], v5 offset:17408
    v_mfma_f32_16x16x32_bf16 v[168:171], a[120:123], a[24:27], v[168:171]
    v_mfma_f32_16x16x32_bf16 v[192:195], a[120:123], a[28:31], v[192:195]
    buffer_load_dwordx4 a[16:19], v3, s[40:43], s35 offen sc1
    s_add_u32 s35, s35, 4096
    s_and_b32 s35, s35, 0x1ffff
    v_mfma_f32_16x16x32_bf16 v[216:219], a[120:123], a[32:35], v[216:219]
    ds_read_b128 a[104:107], v6 offset:12288
    v_mfma_f32_16x16x32_bf16 v[148:151], a[124:127], a[20:23], v[148:151]
    v_mfma_f32_16x16x32_bf16 v[172:175], a[124:127], a[24:27], v[172:175]
    v_mfma_f32_16x16x32_bf16 v[196:199], a[124:127], a[28:31], v[196:199]
    buffer_load_dwordx4 v1, s[4:7], s44 offen offset:2048 sc1 lds
    v_mfma_f32_16x16x32_bf16 v[220:223], a[124:127], a[32:35], v[220:223]
    v_mfma_f32_16x16x32_bf16 v[152:155], a[128:131], a[20:23], v[152:155]
    v_mfma_f32_16x16x32_bf16 v[176:179], a[128:131], a[24:27], v[176:179]
    buffer_load_dwordx4 v1, s[4:7], s44 offen offset:3072 sc1 lds
    v_mfma_f32_16x16x32_bf16 v[200:203], a[128:131], a[28:31], v[200:203]
    v_mfma_f32_16x16x32_bf16 v[224:227], a[128:131], a[32:35], v[224:227]
    v_mfma_f32_16x16x32_bf16 v[228:231], a[132:135], a[36:39], v[228:231]
    s_waitcnt vmcnt(14) lgkmcnt(0)
    v_mfma_f32_16x16x32_bf16 v[132:135], a[80:83], a[40:43], v[132:135]
    ds_read_b128 a[108:111], v5 offset:18432
    v_mfma_f32_16x16x32_bf16 v[156:159], a[80:83], a[44:47], v[156:159]
    buffer_load_dwordx4 a[20:23], v2, s[40:43], s35 offen offset:0 sc1
    v_mfma_f32_16x16x32_bf16 v[180:183], a[80:83], a[48:51], v[180:183]
    ds_read_b128 a[112:115], v5 offset:19456
    v_mfma_f32_16x16x32_bf16 v[204:207], a[80:83], a[52:55], v[204:207]
    v_mfma_f32_16x16x32_bf16 v[136:139], a[84:87], a[40:43], v[136:139]
    buffer_load_dwordx4 a[24:27], v2, s[40:43], s35 offen offset:1024 sc1
    v_mfma_f32_16x16x32_bf16 v[160:163], a[84:87], a[44:47], v[160:163]
    ds_read_b128 a[116:119], v5 offset:20480
    v_mfma_f32_16x16x32_bf16 v[184:187], a[84:87], a[48:51], v[184:187]
    v_mfma_f32_16x16x32_bf16 v[208:211], a[84:87], a[52:55], v[208:211]
    ds_read_b128 a[120:123], v5 offset:21504
    buffer_load_dwordx4 a[28:31], v2, s[40:43], s35 offen offset:2048 sc1
    v_mfma_f32_16x16x32_bf16 v[140:143], a[88:91], a[40:43], v[140:143]
    v_mfma_f32_16x16x32_bf16 v[164:167], a[88:91], a[44:47], v[164:167]
    v_mfma_f32_16x16x32_bf16 v[188:191], a[88:91], a[48:51], v[188:191]
    ds_read_b128 a[124:127], v5 offset:22528
    v_mfma_f32_16x16x32_bf16 v[212:215], a[88:91], a[52:55], v[212:215]
    buffer_load_dwordx4 a[32:35], v2, s[40:43], s35 offen offset:3072 sc1
    v_mfma_f32_16x16x32_bf16 v[144:147], a[92:95], a[40:43], v[144:147]
    ds_read_b128 a[128:131], v5 offset:23552
    v_mfma_f32_16x16x32_bf16 v[168:171], a[92:95], a[44:47], v[168:171]
    v_mfma_f32_16x16x32_bf16 v[192:195], a[92:95], a[48:51], v[192:195]
    buffer_load_dwordx4 a[36:39], v3, s[40:43], s35 offen sc1
    s_add_u32 s35, s35, 4096
    s_and_b32 s35, s35, 0x1ffff
    v_mfma_f32_16x16x32_bf16 v[216:219], a[92:95], a[52:55], v[216:219]
    ds_read_b128 a[132:135], v6 offset:18432
    v_mfma_f32_16x16x32_bf16 v[148:151], a[96:99], a[40:43], v[148:151]
    v_mfma_f32_16x16x32_bf16 v[172:175], a[96:99], a[44:47], v[172:175]
    v_mfma_f32_16x16x32_bf16 v[196:199], a[96:99], a[48:51], v[196:199]
    s_add_u32 s44, s44, 4096
    s_add_u32 m0, m0, 4096
    s_nop 0
    buffer_load_dwordx4 v1, s[4:7], s44 offen offset:0 sc1 lds
    v_mfma_f32_16x16x32_bf16 v[220:223], a[96:99], a[52:55], v[220:223]
    v_mfma_f32_16x16x32_bf16 v[152:155], a[100:103], a[40:43], v[152:155]
    v_mfma_f32_16x16x32_bf16 v[176:179], a[100:103], a[44:47], v[176:179]
    buffer_load_dwordx4 v1, s[4:7], s44 offen offset:1024 sc1 lds
    v_mfma_f32_16x16x32_bf16 v[200:203], a[100:103], a[48:51], v[200:203]
    v_mfma_f32_16x16x32_bf16 v[224:227], a[100:103], a[52:55], v[224:227]
    v_mfma_f32_16x16x32_bf16 v[228:231], a[104:107], a[56:59], v[228:231]
    s_waitcnt vmcnt(16) lgkmcnt(0)
    v_mfma_f32_16x16x32_bf16 v[132:135], a[108:111], a[60:63], v[132:135]
    ds_read_b128 a[80:83], v5 offset:24576
    v_mfma_f32_16x16x32_bf16 v[156:159], a[108:111], a[64:67], v[156:159]
    buffer_load_dwordx4 a[40:43], v2, s[40:43], s35 offen offset:0 sc1
    v_mfma_f32_16x16x32_bf16 v[180:183], a[108:111], a[68:71], v[180:183]
    ds_read_b128 a[84:87], v5 offset:25600
    v_mfma_f32_16x16x32_bf16 v[204:207], a[108:111], a[72:75], v[204:207]
    v_mfma_f32_16x16x32_bf16 v[136:139], a[112:115], a[60:63], v[136:139]
    v_mfma_f32_16x16x32_bf16 v[160:163], a[112:115], a[64:67], v[160:163]
    ds_read_b128 a[88:91], v5 offset:26624
    buffer_load_dwordx4 a[44:47], v2, s[40:43], s35 offen offset:1024 sc1
    v_mfma_f32_16x16x32_bf16 v[184:187], a[112:115], a[68:71], v[184:187]
    v_mfma_f32_16x16x32_bf16 v[208:211], a[112:115], a[72:75], v[208:211]
    ds_read_b128 a[92:95], v5 offset:27648
    v_mfma_f32_16x16x32_bf16 v[140:143], a[116:119], a[60:63], v[140:143]
    v_mfma_f32_16x16x32_bf16 v[164:167], a[116:119], a[64:67], v[164:167]
    buffer_load_dwordx4 a[48:51], v2, s[40:43], s35 offen offset:2048 sc1
    v_mfma_f32_16x16x32_bf16 v[188:191], a[116:119], a[68:71], v[188:191]
    ds_read_b128 a[96:99], v5 offset:28672
    v_mfma_f32_16x16x32_bf16 v[212:215], a[116:119], a[72:75], v[212:215]
    v_mfma_f32_16x16x32_bf16 v[144:147], a[120:123], a[60:63], v[144:147]
    ds_read_b128 a[100:103], v5 offset:29696
    v_mfma_f32_16x16x32_bf16 v[168:171], a[120:123], a[64:67], v[168:171]
    buffer_load_dwordx4 a[52:55], v2, s[40:43], s35 offen offset:3072 sc1
    v_mfma_f32_16x16x32_bf16 v[192:195], a[120:123], a[68:71], v[192:195]
    v_mfma_f32_16x16x32_bf16 v[216:219], a[120:123], a[72:75], v[216:219]
    ds_read_b128 a[104:107], v6 offset:24576
    v_mfma_f32_16x16x32_bf16 v[148:151], a[124:127], a[60:63], v[148:151]
    v_mfma_f32_16x16x32_bf16 v[172:175], a[124:127], a[64:67], v[172:175]
    buffer_load_dwordx4 a[56:59], v3, s[40:43], s35 offen sc1
    s_add_u32 s35, s35, 4096
    s_and_b32 s35, s35, 0x1ffff
    v_mfma_f32_16x16x32_bf16 v[196:199], a[124:127], a[68:71], v[196:199]
    v_mfma_f32_16x16x32_bf16 v[220:223], a[124:127], a[72:75], v[220:223]
    v_mfma_f32_16x16x32_bf16 v[152:155], a[128:131], a[60:63], v[152:155]
    v_mfma_f32_16x16x32_bf16 v[176:179], a[128:131], a[64:67], v[176:179]
    buffer_load_dwordx4 v1, s[4:7], s44 offen offset:2048 sc1 lds
    v_mfma_f32_16x16x32_bf16 v[200:203], a[128:131], a[68:71], v[200:203]
    v_mfma_f32_16x16x32_bf16 v[224:227], a[128:131], a[72:75], v[224:227]
    v_mfma_f32_16x16x32_bf16 v[228:231], a[132:135], a[76:79], v[228:231]
    s_waitcnt vmcnt(15) lgkmcnt(0)
    v_mfma_f32_16x16x32_bf16 v[132:135], a[80:83], a[0:3], v[132:135]
    ds_read_b128 a[108:111], v5 offset:30720
    v_mfma_f32_16x16x32_bf16 v[156:159], a[80:83], a[4:7], v[156:159]
    buffer_load_dwordx4 a[60:63], v2, s[40:43], s35 offen offset:0 sc1
    v_mfma_f32_16x16x32_bf16 v[180:183], a[80:83], a[8:11], v[180:183]
    ds_read_b128 a[112:115], v5 offset:31744
    v_mfma_f32_16x16x32_bf16 v[204:207], a[80:83], a[12:15], v[204:207]
    v_mfma_f32_16x16x32_bf16 v[136:139], a[84:87], a[0:3], v[136:139]
    buffer_load_dwordx4 a[64:67], v2, s[40:43], s35 offen offset:1024 sc1
    v_mfma_f32_16x16x32_bf16 v[160:163], a[84:87], a[4:7], v[160:163]
    ds_read_b128 a[116:119], v5 offset:32768
    v_mfma_f32_16x16x32_bf16 v[184:187], a[84:87], a[8:11], v[184:187]
    v_mfma_f32_16x16x32_bf16 v[208:211], a[84:87], a[12:15], v[208:211]
    ds_read_b128 a[120:123], v5 offset:33792
    buffer_load_dwordx4 a[68:71], v2, s[40:43], s35 offen offset:2048 sc1
    v_mfma_f32_16x16x32_bf16 v[140:143], a[88:91], a[0:3], v[140:143]
    v_mfma_f32_16x16x32_bf16 v[164:167], a[88:91], a[4:7], v[164:167]
    v_mfma_f32_16x16x32_bf16 v[188:191], a[88:91], a[8:11], v[188:191]
    ds_read_b128 a[124:127], v5 offset:34816
    v_mfma_f32_16x16x32_bf16 v[212:215], a[88:91], a[12:15], v[212:215]
    buffer_load_dwordx4 a[72:75], v2, s[40:43], s35 offen offset:3072 sc1
    v_mfma_f32_16x16x32_bf16 v[144:147], a[92:95], a[0:3], v[144:147]
    ds_read_b128 a[128:131], v5 offset:35840
    v_mfma_f32_16x16x32_bf16 v[168:171], a[92:95], a[4:7], v[168:171]
    v_mfma_f32_16x16x32_bf16 v[192:195], a[92:95], a[8:11], v[192:195]
    buffer_load_dwordx4 a[76:79], v3, s[40:43], s35 offen sc1
    s_add_u32 s35, s35, 4096
    s_and_b32 s35, s35, 0x1ffff
    v_mfma_f32_16x16x32_bf16 v[216:219], a[92:95], a[12:15], v[216:219]
    ds_read_b128 a[132:135], v6 offset:30720
    v_mfma_f32_16x16x32_bf16 v[148:151], a[96:99], a[0:3], v[148:151]
    v_mfma_f32_16x16x32_bf16 v[172:175], a[96:99], a[4:7], v[172:175]
    v_mfma_f32_16x16x32_bf16 v[196:199], a[96:99], a[8:11], v[196:199]
    buffer_load_dwordx4 v1, s[4:7], s44 offen offset:3072 sc1 lds
    v_mfma_f32_16x16x32_bf16 v[220:223], a[96:99], a[12:15], v[220:223]
    v_mfma_f32_16x16x32_bf16 v[152:155], a[100:103], a[0:3], v[152:155]
    v_mfma_f32_16x16x32_bf16 v[176:179], a[100:103], a[4:7], v[176:179]
    s_add_u32 s44, s44, 4096
    s_add_u32 m0, m0, 4096
    s_nop 0
    buffer_load_dwordx4 v1, s[4:7], s44 offen offset:0 sc1 lds
    v_mfma_f32_16x16x32_bf16 v[200:203], a[100:103], a[8:11], v[200:203]
    v_mfma_f32_16x16x32_bf16 v[224:227], a[100:103], a[12:15], v[224:227]
    v_mfma_f32_16x16x32_bf16 v[228:231], a[104:107], a[16:19], v[228:231]
    s_waitcnt vmcnt(15) lgkmcnt(0)
    v_mfma_f32_16x16x32_bf16 v[132:135], a[108:111], a[20:23], v[132:135]
    ds_read_b128 a[80:83], v5 offset:36864
    v_mfma_f32_16x16x32_bf16 v[156:159], a[108:111], a[24:27], v[156:159]
    buffer_load_dwordx4 a[0:3], v2, s[40:43], s35 offen offset:0 sc1
    v_mfma_f32_16x16x32_bf16 v[180:183], a[108:111], a[28:31], v[180:183]
    ds_read_b128 a[84:87], v5 offset:37888
    v_mfma_f32_16x16x32_bf16 v[204:207], a[108:111], a[32:35], v[204:207]
    v_mfma_f32_16x16x32_bf16 v[136:139], a[112:115], a[20:23], v[136:139]
    buffer_load_dwordx4 a[4:7], v2, s[40:43], s35 offen offset:1024 sc1
    v_mfma_f32_16x16x32_bf16 v[160:163], a[112:115], a[24:27], v[160:163]
    ds_read_b128 a[88:91], v5 offset:38912
    v_mfma_f32_16x16x32_bf16 v[184:187], a[112:115], a[28:31], v[184:187]
    v_mfma_f32_16x16x32_bf16 v[208:211], a[112:115], a[32:35], v[208:211]
    ds_read_b128 a[92:95], v5 offset:39936
    buffer_load_dwordx4 a[8:11], v2, s[40:43], s35 offen offset:2048 sc1
    v_mfma_f32_16x16x32_bf16 v[140:143], a[116:119], a[20:23], v[140:143]
    v_mfma_f32_16x16x32_bf16 v[164:167], a[116:119], a[24:27], v[164:167]
    v_mfma_f32_16x16x32_bf16 v[188:191], a[116:119], a[28:31], v[188:191]
    ds_read_b128 a[96:99], v5 offset:40960
    v_mfma_f32_16x16x32_bf16 v[212:215], a[116:119], a[32:35], v[212:215]
    buffer_load_dwordx4 a[12:15], v2, s[40:43], s35 offen offset:3072 sc1
    v_mfma_f32_16x16x32_bf16 v[144:147], a[120:123], a[20:23], v[144:147]
    ds_read_b128 a[100:103], v5 offset:41984
    v_mfma_f32_16x16x32_bf16 v[168:171], a[120:123], a[24:27], v[168:171]
    v_mfma_f32_16x16x32_bf16 v[192:195], a[120:123], a[28:31], v[192:195]
    buffer_load_dwordx4 a[16:19], v3, s[40:43], s35 offen sc1
    s_add_u32 s35, s35, 4096
    s_and_b32 s35, s35, 0x1ffff
    v_mfma_f32_16x16x32_bf16 v[216:219], a[120:123], a[32:35], v[216:219]
    ds_read_b128 a[104:107], v6 offset:36864
    v_mfma_f32_16x16x32_bf16 v[148:151], a[124:127], a[20:23], v[148:151]
    v_mfma_f32_16x16x32_bf16 v[172:175], a[124:127], a[24:27], v[172:175]
    v_mfma_f32_16x16x32_bf16 v[196:199], a[124:127], a[28:31], v[196:199]
    buffer_load_dwordx4 v1, s[4:7], s44 offen offset:1024 sc1 lds
    v_mfma_f32_16x16x32_bf16 v[220:223], a[124:127], a[32:35], v[220:223]
    v_mfma_f32_16x16x32_bf16 v[152:155], a[128:131], a[20:23], v[152:155]
    v_mfma_f32_16x16x32_bf16 v[176:179], a[128:131], a[24:27], v[176:179]
    buffer_load_dwordx4 v1, s[4:7], s44 offen offset:2048 sc1 lds
    v_mfma_f32_16x16x32_bf16 v[200:203], a[128:131], a[28:31], v[200:203]
    v_mfma_f32_16x16x32_bf16 v[224:227], a[128:131], a[32:35], v[224:227]
    v_mfma_f32_16x16x32_bf16 v[228:231], a[132:135], a[36:39], v[228:231]
    s_waitcnt vmcnt(15) lgkmcnt(0)
    v_mfma_f32_16x16x32_bf16 v[132:135], a[80:83], a[40:43], v[132:135]
    ds_read_b128 a[108:111], v5 offset:43008
    v_mfma_f32_16x16x32_bf16 v[156:159], a[80:83], a[44:47], v[156:159]
    buffer_load_dwordx4 a[20:23], v2, s[40:43], s35 offen offset:0 sc1
    v_mfma_f32_16x16x32_bf16 v[180:183], a[80:83], a[48:51], v[180:183]
    ds_read_b128 a[112:115], v5 offset:44032
    v_mfma_f32_16x16x32_bf16 v[204:207], a[80:83], a[52:55], v[204:207]
    v_mfma_f32_16x16x32_bf16 v[136:139], a[84:87], a[40:43], v[136:139]
    v_mfma_f32_16x16x32_bf16 v[160:163], a[84:87], a[44:47], v[160:163]
    ds_read_b128 a[116:119], v5 offset:45056
    buffer_load_dwordx4 a[24:27], v2, s[40:43], s35 offen offset:1024 sc1
    v_mfma_f32_16x16x32_bf16 v[184:187], a[84:87], a[48:51], v[184:187]
    v_mfma_f32_16x16x32_bf16 v[208:211], a[84:87], a[52:55], v[208:211]
    ds_read_b128 a[120:123], v5 offset:46080
    v_mfma_f32_16x16x32_bf16 v[140:143], a[88:91], a[40:43], v[140:143]
    v_mfma_f32_16x16x32_bf16 v[164:167], a[88:91], a[44:47], v[164:167]
    buffer_load_dwordx4 a[28:31], v2, s[40:43], s35 offen offset:2048 sc1
    v_mfma_f32_16x16x32_bf16 v[188:191], a[88:91], a[48:51], v[188:191]
    ds_read_b128 a[124:127], v5 offset:47104
    v_mfma_f32_16x16x32_bf16 v[212:215], a[88:91], a[52:55], v[212:215]
    v_mfma_f32_16x16x32_bf16 v[144:147], a[92:95], a[40:43], v[144:147]
    ds_read_b128 a[128:131], v5 offset:48128
    v_mfma_f32_16x16x32_bf16 v[168:171], a[92:95], a[44:47], v[168:171]
    buffer_load_dwordx4 a[32:35], v2, s[40:43], s35 offen offset:3072 sc1
    v_mfma_f32_16x16x32_bf16 v[192:195], a[92:95], a[48:51], v[192:195]
    v_mfma_f32_16x16x32_bf16 v[216:219], a[92:95], a[52:55], v[216:219]
    ds_read_b128 a[132:135], v6 offset:43008
    v_mfma_f32_16x16x32_bf16 v[148:151], a[96:99], a[40:43], v[148:151]
    v_mfma_f32_16x16x32_bf16 v[172:175], a[96:99], a[44:47], v[172:175]
    buffer_load_dwordx4 a[36:39], v3, s[40:43], s35 offen sc1
    s_add_u32 s35, s35, 4096
    s_and_b32 s35, s35, 0x1ffff
    v_mfma_f32_16x16x32_bf16 v[196:199], a[96:99], a[48:51], v[196:199]
    v_mfma_f32_16x16x32_bf16 v[220:223], a[96:99], a[52:55], v[220:223]
    v_mfma_f32_16x16x32_bf16 v[152:155], a[100:103], a[40:43], v[152:155]
    v_mfma_f32_16x16x32_bf16 v[176:179], a[100:103], a[44:47], v[176:179]
    buffer_load_dwordx4 v1, s[4:7], s44 offen offset:3072 sc1 lds
    v_mfma_f32_16x16x32_bf16 v[200:203], a[100:103], a[48:51], v[200:203]
    v_mfma_f32_16x16x32_bf16 v[224:227], a[100:103], a[52:55], v[224:227]
    v_mfma_f32_16x16x32_bf16 v[228:231], a[104:107], a[56:59], v[228:231]
    s_waitcnt vmcnt(15) lgkmcnt(0)
    s_barrier
    v_mfma_f32_16x16x32_bf16 v[132:135], a[108:111], a[60:63], v[132:135]
    v_add_u32 v5, 49152, v1
    ds_read_b128 a[80:83], v5 offset:0
    v_mfma_f32_16x16x32_bf16 v[156:159], a[108:111], a[64:67], v[156:159]
    buffer_load_dwordx4 a[40:43], v2, s[40:43], s35 offen offset:0 sc1
    v_mfma_f32_16x16x32_bf16 v[180:183], a[108:111], a[68:71], v[180:183]
    v_add_u32 v6, s39, v5
    ds_read_b128 a[84:87], v5 offset:1024
    v_mfma_f32_16x16x32_bf16 v[204:207], a[108:111], a[72:75], v[204:207]
    v_mfma_f32_16x16x32_bf16 v[136:139], a[112:115], a[60:63], v[136:139]
    buffer_load_dwordx4 a[44:47], v2, s[40:43], s35 offen offset:1024 sc1
    v_mfma_f32_16x16x32_bf16 v[160:163], a[112:115], a[64:67], v[160:163]
    ds_read_b128 a[88:91], v5 offset:2048
    v_mfma_f32_16x16x32_bf16 v[184:187], a[112:115], a[68:71], v[184:187]
    v_mfma_f32_16x16x32_bf16 v[208:211], a[112:115], a[72:75], v[208:211]
    ds_read_b128 a[92:95], v5 offset:3072
    buffer_load_dwordx4 a[48:51], v2, s[40:43], s35 offen offset:2048 sc1
    v_mfma_f32_16x16x32_bf16 v[140:143], a[116:119], a[60:63], v[140:143]
    v_mfma_f32_16x16x32_bf16 v[164:167], a[116:119], a[64:67], v[164:167]
    v_mfma_f32_16x16x32_bf16 v[188:191], a[116:119], a[68:71], v[188:191]
    ds_read_b128 a[96:99], v5 offset:4096
    v_mfma_f32_16x16x32_bf16 v[212:215], a[116:119], a[72:75], v[212:215]
    buffer_load_dwordx4 a[52:55], v2, s[40:43], s35 offen offset:3072 sc1
    v_mfma_f32_16x16x32_bf16 v[144:147], a[120:123], a[60:63], v[144:147]
    ds_read_b128 a[100:103], v5 offset:5120
    v_mfma_f32_16x16x32_bf16 v[168:171], a[120:123], a[64:67], v[168:171]
    v_mfma_f32_16x16x32_bf16 v[192:195], a[120:123], a[68:71], v[192:195]
    buffer_load_dwordx4 a[56:59], v3, s[40:43], s35 offen sc1
    s_add_u32 s35, s35, 4096
    s_and_b32 s35, s35, 0x1ffff
    v_mfma_f32_16x16x32_bf16 v[216:219], a[120:123], a[72:75], v[216:219]
    ds_read_b128 a[104:107], v6 offset:0
    v_mfma_f32_16x16x32_bf16 v[148:151], a[124:127], a[60:63], v[148:151]
    v_mfma_f32_16x16x32_bf16 v[172:175], a[124:127], a[64:67], v[172:175]
    v_mfma_f32_16x16x32_bf16 v[196:199], a[124:127], a[68:71], v[196:199]
    s_lshl_b32 s44, s28, 1
    s_add_u32 s44, s44, s33
    s_add_u32 s44, s44, 24
    s_and_b32 s44, s44, 31
    s_mul_i32 s44, s44, 6144
    s_add_u32 s44, s44, s50
    s_add_u32 s44, s44, 0xe00000
    s_mul_i32 s45, s28, 12288
    s_add_u32 m0, s45, 0
    s_nop 0
    buffer_load_dwordx4 v1, s[4:7], s44 offen offset:0 sc1 lds
    v_mfma_f32_16x16x32_bf16 v[220:223], a[124:127], a[72:75], v[220:223]
    v_mfma_f32_16x16x32_bf16 v[152:155], a[128:131], a[60:63], v[152:155]
    v_mfma_f32_16x16x32_bf16 v[176:179], a[128:131], a[64:67], v[176:179]
    buffer_load_dwordx4 v1, s[4:7], s44 offen offset:1024 sc1 lds
    v_mfma_f32_16x16x32_bf16 v[200:203], a[128:131], a[68:71], v[200:203]
    v_mfma_f32_16x16x32_bf16 v[224:227], a[128:131], a[72:75], v[224:227]
    v_mfma_f32_16x16x32_bf16 v[228:231], a[132:135], a[76:79], v[228:231]
    s_waitcnt vmcnt(15) lgkmcnt(0)
    v_mfma_f32_16x16x32_bf16 v[132:135], a[80:83], a[0:3], v[132:135]
    ds_read_b128 a[108:111], v5 offset:6144
    v_mfma_f32_16x16x32_bf16 v[156:159], a[80:83], a[4:7], v[156:159]
    buffer_load_dwordx4 a[60:63], v2, s[40:43], s35 offen offset:0 sc1
    v_mfma_f32_16x16x32_bf16 v[180:183], a[80:83], a[8:11], v[180:183]
    ds_read_b128 a[112:115], v5 offset:7168
    v_mfma_f32_16x16x32_bf16 v[204:207], a[80:83], a[12:15], v[204:207]
    v_mfma_f32_16x16x32_bf16 v[136:139], a[84:87], a[0:3], v[136:139]
    v_mfma_f32_16x16x32_bf16 v[160:163], a[84:87], a[4:7], v[160:163]
    ds_read_b128 a[116:119], v5 offset:8192
    buffer_load_dwordx4 a[64:67], v2, s[40:43], s35 offen offset:1024 sc1
    v_mfma_f32_16x16x32_bf16 v[184:187], a[84:87], a[8:11], v[184:187]
    v_mfma_f32_16x16x32_bf16 v[208:211], a[84:87], a[12:15], v[208:211]
    ds_read_b128 a[120:123], v5 offset:9216
    v_mfma_f32_16x16x32_bf16 v[140:143], a[88:91], a[0:3], v[140:143]
    v_mfma_f32_16x16x32_bf16 v[164:167], a[88:91], a[4:7], v[164:167]
    buffer_load_dwordx4 a[68:71], v2, s[40:43], s35 offen offset:2048 sc1
    v_mfma_f32_16x16x32_bf16 v[188:191], a[88:91], a[8:11], v[188:191]
    ds_read_b128 a[124:127], v5 offset:10240
    v_mfma_f32_16x16x32_bf16 v[212:215], a[88:91], a[12:15], v[212:215]
    v_mfma_f32_16x16x32_bf16 v[144:147], a[92:95], a[0:3], v[144:147]
    ds_read_b128 a[128:131], v5 offset:11264
    v_mfma_f32_16x16x32_bf16 v[168:171], a[92:95], a[4:7], v[168:171]
    buffer_load_dwordx4 a[72:75], v2, s[40:43], s35 offen offset:3072 sc1
    v_mfma_f32_16x16x32_bf16 v[192:195], a[92:95], a[8:11], v[192:195]
    v_mfma_f32_16x16x32_bf16 v[216:219], a[92:95], a[12:15], v[216:219]
    ds_read_b128 a[132:135], v6 offset:6144
    v_mfma_f32_16x16x32_bf16 v[148:151], a[96:99], a[0:3], v[148:151]
    v_mfma_f32_16x16x32_bf16 v[172:175], a[96:99], a[4:7], v[172:175]
    buffer_load_dwordx4 a[76:79], v3, s[40:43], s35 offen sc1
    s_add_u32 s35, s35, 4096
    s_and_b32 s35, s35, 0x1ffff
    v_mfma_f32_16x16x32_bf16 v[196:199], a[96:99], a[8:11], v[196:199]
    v_mfma_f32_16x16x32_bf16 v[220:223], a[96:99], a[12:15], v[220:223]
    v_mfma_f32_16x16x32_bf16 v[152:155], a[100:103], a[0:3], v[152:155]
    v_mfma_f32_16x16x32_bf16 v[176:179], a[100:103], a[4:7], v[176:179]
    buffer_load_dwordx4 v1, s[4:7], s44 offen offset:2048 sc1 lds
    v_mfma_f32_16x16x32_bf16 v[200:203], a[100:103], a[8:11], v[200:203]
    v_mfma_f32_16x16x32_bf16 v[224:227], a[100:103], a[12:15], v[224:227]
    v_mfma_f32_16x16x32_bf16 v[228:231], a[104:107], a[16:19], v[228:231]
    s_waitcnt vmcnt(14) lgkmcnt(0)
    v_mfma_f32_16x16x32_bf16 v[132:135], a[108:111], a[20:23], v[132:135]
    ds_read_b128 a[80:83], v5 offset:12288
    v_mfma_f32_16x16x32_bf16 v[156:159], a[108:111], a[24:27], v[156:159]
    buffer_load_dwordx4 a[0:3], v2, s[40:43], s35 offen offset:0 sc1
    v_mfma_f32_16x16x32_bf16 v[180:183], a[108:111], a[28:31], v[180:183]
    ds_read_b128 a[84:87], v5 offset:13312
    v_mfma_f32_16x16x32_bf16 v[204:207], a[108:111], a[32:35], v[204:207]
    v_mfma_f32_16x16x32_bf16 v[136:139], a[112:115], a[20:23], v[136:139]
    buffer_load_dwordx4 a[4:7], v2, s[40:43], s35 offen offset:1024 sc1
    v_mfma_f32_16x16x32_bf16 v[160:163], a[112:115], a[24:27], v[160:163]
    ds_read_b128 a[88:91], v5 offset:14336
    v_mfma_f32_16x16x32_bf16 v[184:187], a[112:115], a[28:31], v[184:187]
    v_mfma_f32_16x16x32_bf16 v[208:211], a[112:115], a[32:35], v[208:211]
    ds_read_b128 a[92:95], v5 offset:15360
    buffer_load_dwordx4 a[8:11], v2, s[40:43], s35 offen offset:2048 sc1
    v_mfma_f32_16x16x32_bf16 v[140:143], a[116:119], a[20:23], v[140:143]
    v_mfma_f32_16x16x32_bf16 v[164:167], a[116:119], a[24:27], v[164:167]
    v_mfma_f32_16x16x32_bf16 v[188:191], a[116:119], a[28:31], v[188:191]
    ds_read_b128 a[96:99], v5 offset:16384
    v_mfma_f32_16x16x32_bf16 v[212:215], a[116:119], a[32:35], v[212:215]
    buffer_load_dwordx4 a[12:15], v2, s[40:43], s35 offen offset:3072 sc1
    v_mfma_f32_16x16x32_bf16 v[144:147], a[120:123], a[20:23], v[144:147]
    ds_read_b128 a[100:103], v5 offset:17408
    v_mfma_f32_16x16x32_bf16 v[168:171], a[120:123], a[24:27], v[168:171]
    v_mfma_f32_16x16x32_bf16 v[192:195], a[120:123], a[28:31], v[192:195]
    buffer_load_dwordx4 a[16:19], v3, s[40:43], s35 offen sc1
    s_add_u32 s35, s35, 4096
    s_and_b32 s35, s35, 0x1ffff
    v_mfma_f32_16x16x32_bf16 v[216:219], a[120:123], a[32:35], v[216:219]
    ds_read_b128 a[104:107], v6 offset:12288
    v_mfma_f32_16x16x32_bf16 v[148:151], a[124:127], a[20:23], v[148:151]
    v_mfma_f32_16x16x32_bf16 v[172:175], a[124:127], a[24:27], v[172:175]
    v_mfma_f32_16x16x32_bf16 v[196:199], a[124:127], a[28:31], v[196:199]
    buffer_load_dwordx4 v1, s[4:7], s44 offen offset:3072 sc1 lds
    v_mfma_f32_16x16x32_bf16 v[220:223], a[124:127], a[32:35], v[220:223]
    v_mfma_f32_16x16x32_bf16 v[152:155], a[128:131], a[20:23], v[152:155]
    v_mfma_f32_16x16x32_bf16 v[176:179], a[128:131], a[24:27], v[176:179]
    s_add_u32 s44, s44, 4096
    s_add_u32 m0, m0, 4096
    s_nop 0
    buffer_load_dwordx4 v1, s[4:7], s44 offen offset:0 sc1 lds
    v_mfma_f32_16x16x32_bf16 v[200:203], a[128:131], a[28:31], v[200:203]
    v_mfma_f32_16x16x32_bf16 v[224:227], a[128:131], a[32:35], v[224:227]
    v_mfma_f32_16x16x32_bf16 v[228:231], a[132:135], a[36:39], v[228:231]
    s_waitcnt vmcnt(15) lgkmcnt(0)
    v_mfma_f32_16x16x32_bf16 v[132:135], a[80:83], a[40:43], v[132:135]
    ds_read_b128 a[108:111], v5 offset:18432
    v_mfma_f32_16x16x32_bf16 v[156:159], a[80:83], a[44:47], v[156:159]
    buffer_load_dwordx4 a[20:23], v2, s[40:43], s35 offen offset:0 sc1
    v_mfma_f32_16x16x32_bf16 v[180:183], a[80:83], a[48:51], v[180:183]
    ds_read_b128 a[112:115], v5 offset:19456
    v_mfma_f32_16x16x32_bf16 v[204:207], a[80:83], a[52:55], v[204:207]
    v_mfma_f32_16x16x32_bf16 v[136:139], a[84:87], a[40:43], v[136:139]
    v_mfma_f32_16x16x32_bf16 v[160:163], a[84:87], a[44:47], v[160:163]
    ds_read_b128 a[116:119], v5 offset:20480
    buffer_load_dwordx4 a[24:27], v2, s[40:43], s35 offen offset:1024 sc1
    v_mfma_f32_16x16x32_bf16 v[184:187], a[84:87], a[48:51], v[184:187]
    v_mfma_f32_16x16x32_bf16 v[208:211], a[84:87], a[52:55], v[208:211]
    ds_read_b128 a[120:123], v5 offset:21504
    v_mfma_f32_16x16x32_bf16 v[140:143], a[88:91], a[40:43], v[140:143]
    v_mfma_f32_16x16x32_bf16 v[164:167], a[88:91], a[44:47], v[164:167]
    buffer_load_dwordx4 a[28:31], v2, s[40:43], s35 offen offset:2048 sc1
    v_mfma_f32_16x16x32_bf16 v[188:191], a[88:91], a[48:51], v[188:191]
    ds_read_b128 a[124:127], v5 offset:22528
    v_mfma_f32_16x16x32_bf16 v[212:215], a[88:91], a[52:55], v[212:215]
    v_mfma_f32_16x16x32_bf16 v[144:147], a[92:95], a[40:43], v[144:147]
    ds_read_b128 a[128:131], v5 offset:23552
    v_mfma_f32_16x16x32_bf16 v[168:171], a[92:95], a[44:47], v[168:171]
    buffer_load_dwordx4 a[32:35], v2, s[40:43], s35 offen offset:3072 sc1
    v_mfma_f32_16x16x32_bf16 v[192:195], a[92:95], a[48:51], v[192:195]
    v_mfma_f32_16x16x32_bf16 v[216:219], a[92:95], a[52:55], v[216:219]
    ds_read_b128 a[132:135], v6 offset:18432
    v_mfma_f32_16x16x32_bf16 v[148:151], a[96:99], a[40:43], v[148:151]
    v_mfma_f32_16x16x32_bf16 v[172:175], a[96:99], a[44:47], v[172:175]
    buffer_load_dwordx4 a[36:39], v3, s[40:43], s35 offen sc1
    s_add_u32 s35, s35, 4096
    s_and_b32 s35, s35, 0x1ffff
    v_mfma_f32_16x16x32_bf16 v[196:199], a[96:99], a[48:51], v[196:199]
    v_mfma_f32_16x16x32_bf16 v[220:223], a[96:99], a[52:55], v[220:223]
    v_mfma_f32_16x16x32_bf16 v[152:155], a[100:103], a[40:43], v[152:155]
    v_mfma_f32_16x16x32_bf16 v[176:179], a[100:103], a[44:47], v[176:179]
    buffer_load_dwordx4 v1, s[4:7], s44 offen offset:1024 sc1 lds
    v_mfma_f32_16x16x32_bf16 v[200:203], a[100:103], a[48:51], v[200:203]
    v_mfma_f32_16x16x32_bf16 v[224:227], a[100:103], a[52:55], v[224:227]
    v_mfma_f32_16x16x32_bf16 v[228:231], a[104:107], a[56:59], v[228:231]
    s_waitcnt vmcnt(14) lgkmcnt(0)
    v_mfma_f32_16x16x32_bf16 v[132:135], a[108:111], a[60:63], v[132:135]
    ds_read_b128 a[80:83], v5 offset:24576
    v_mfma_f32_16x16x32_bf16 v[156:159], a[108:111], a[64:67], v[156:159]
    buffer_load_dwordx4 a[40:43], v2, s[40:43], s35 offen offset:0 sc1
    v_mfma_f32_16x16x32_bf16 v[180:183], a[108:111], a[68:71], v[180:183]
    ds_read_b128 a[84:87], v5 offset:25600
    v_mfma_f32_16x16x32_bf16 v[204:207], a[108:111], a[72:75], v[204:207]
    v_mfma_f32_16x16x32_bf16 v[136:139], a[112:115], a[60:63], v[136:139]
    buffer_load_dwordx4 a[44:47], v2, s[40:43], s35 offen offset:1024 sc1
    v_mfma_f32_16x16x32_bf16 v[160:163], a[112:115], a[64:67], v[160:163]
    ds_read_b128 a[88:91], v5 offset:26624
    v_mfma_f32_16x16x32_bf16 v[184:187], a[112:115], a[68:71], v[184:187]
    v_mfma_f32_16x16x32_bf16 v[208:211], a[112:115], a[72:75], v[208:211]
    ds_read_b128 a[92:95], v5 offset:27648
    buffer_load_dwordx4 a[48:51], v2, s[40:43], s35 offen offset:2048 sc1
    v_mfma_f32_16x16x32_bf16 v[140:143], a[116:119], a[60:63], v[140:143]
    v_mfma_f32_16x16x32_bf16 v[164:167], a[116:119], a[64:67], v[164:167]
    v_mfma_f32_16x16x32_bf16 v[188:191], a[116:119], a[68:71], v[188:191]
    ds_read_b128 a[96:99], v5 offset:28672
    v_mfma_f32_16x16x32_bf16 v[212:215], a[116:119], a[72:75], v[212:215]
    buffer_load_dwordx4 a[52:55], v2, s[40:43], s35 offen offset:3072 sc1
    v_mfma_f32_16x16x32_bf16 v[144:147], a[120:123], a[60:63], v[144:147]
    ds_read_b128 a[100:103], v5 offset:29696
    v_mfma_f32_16x16x32_bf16 v[168:171], a[120:123], a[64:67], v[168:171]
    v_mfma_f32_16x16x32_bf16 v[192:195], a[120:123], a[68:71], v[192:195]
    buffer_load_dwordx4 a[56:59], v3, s[40:43], s35 offen sc1
    s_add_u32 s35, s35, 4096
    s_and_b32 s35, s35, 0x1ffff
    v_mfma_f32_16x16x32_bf16 v[216:219], a[120:123], a[72:75], v[216:219]
    ds_read_b128 a[104:107], v6 offset:24576
    v_mfma_f32_16x16x32_bf16 v[148:151], a[124:127], a[60:63], v[148:151]
    v_mfma_f32_16x16x32_bf16 v[172:175], a[124:127], a[64:67], v[172:175]
    v_mfma_f32_16x16x32_bf16 v[196:199], a[124:127], a[68:71], v[196:199]
    buffer_load_dwordx4 v1, s[4:7], s44 offen offset:2048 sc1 lds
    v_mfma_f32_16x16x32_bf16 v[220:223], a[124:127], a[72:75], v[220:223]
    v_mfma_f32_16x16x32_bf16 v[152:155], a[128:131], a[60:63], v[152:155]
    v_mfma_f32_16x16x32_bf16 v[176:179], a[128:131], a[64:67], v[176:179]
    buffer_load_dwordx4 v1, s[4:7], s44 offen offset:3072 sc1 lds
    v_mfma_f32_16x16x32_bf16 v[200:203], a[128:131], a[68:71], v[200:203]
    v_mfma_f32_16x16x32_bf16 v[224:227], a[128:131], a[72:75], v[224:227]
    v_mfma_f32_16x16x32_bf16 v[228:231], a[132:135], a[76:79], v[228:231]
    s_waitcnt vmcnt(15) lgkmcnt(0)
    v_mfma_f32_16x16x32_bf16 v[132:135], a[80:83], a[0:3], v[132:135]
    ds_read_b128 a[108:111], v5 offset:30720
    v_mfma_f32_16x16x32_bf16 v[156:159], a[80:83], a[4:7], v[156:159]
    buffer_load_dwordx4 a[60:63], v2, s[40:43], s35 offen offset:0 sc1
    v_mfma_f32_16x16x32_bf16 v[180:183], a[80:83], a[8:11], v[180:183]
    ds_read_b128 a[112:115], v5 offset:31744
    v_mfma_f32_16x16x32_bf16 v[204:207], a[80:83], a[12:15], v[204:207]
    v_mfma_f32_16x16x32_bf16 v[136:139], a[84:87], a[0:3], v[136:139]
    v_mfma_f32_16x16x32_bf16 v[160:163], a[84:87], a[4:7], v[160:163]
    ds_read_b128 a[116:119], v5 offset:32768
    buffer_load_dwordx4 a[64:67], v2, s[40:43], s35 offen offset:1024 sc1
    v_mfma_f32_16x16x32_bf16 v[184:187], a[84:87], a[8:11], v[184:187]
    v_mfma_f32_16x16x32_bf16 v[208:211], a[84:87], a[12:15], v[208:211]
    ds_read_b128 a[120:123], v5 offset:33792
    v_mfma_f32_16x16x32_bf16 v[140:143], a[88:91], a[0:3], v[140:143]
    v_mfma_f32_16x16x32_bf16 v[164:167], a[88:91], a[4:7], v[164:167]
    buffer_load_dwordx4 a[68:71], v2, s[40:43], s35 offen offset:2048 sc1
    v_mfma_f32_16x16x32_bf16 v[188:191], a[88:91], a[8:11], v[188:191]
    ds_read_b128 a[124:127], v5 offset:34816
    v_mfma_f32_16x16x32_bf16 v[212:215], a[88:91], a[12:15], v[212:215]
    v_mfma_f32_16x16x32_bf16 v[144:147], a[92:95], a[0:3], v[144:147]
    ds_read_b128 a[128:131], v5 offset:35840
    v_mfma_f32_16x16x32_bf16 v[168:171], a[92:95], a[4:7], v[168:171]
    buffer_load_dwordx4 a[72:75], v2, s[40:43], s35 offen offset:3072 sc1
    v_mfma_f32_16x16x32_bf16 v[192:195], a[92:95], a[8:11], v[192:195]
    v_mfma_f32_16x16x32_bf16 v[216:219], a[92:95], a[12:15], v[216:219]
    ds_read_b128 a[132:135], v6 offset:30720
    v_mfma_f32_16x16x32_bf16 v[148:151], a[96:99], a[0:3], v[148:151]
    v_mfma_f32_16x16x32_bf16 v[172:175], a[96:99], a[4:7], v[172:175]
    buffer_load_dwordx4 a[76:79], v3, s[40:43], s35 offen sc1
    s_add_u32 s35, s35, 4096
    s_and_b32 s35, s35, 0x1ffff
    v_mfma_f32_16x16x32_bf16 v[196:199], a[96:99], a[8:11], v[196:199]
    v_mfma_f32_16x16x32_bf16 v[220:223], a[96:99], a[12:15], v[220:223]
    v_mfma_f32_16x16x32_bf16 v[152:155], a[100:103], a[0:3], v[152:155]
    v_mfma_f32_16x16x32_bf16 v[176:179], a[100:103], a[4:7], v[176:179]
    s_add_u32 s44, s44, 4096
    s_add_u32 m0, m0, 4096
    s_nop 0
    buffer_load_dwordx4 v1, s[4:7], s44 offen offset:0 sc1 lds
    v_mfma_f32_16x16x32_bf16 v[200:203], a[100:103], a[8:11], v[200:203]
    v_mfma_f32_16x16x32_bf16 v[224:227], a[100:103], a[12:15], v[224:227]
    v_mfma_f32_16x16x32_bf16 v[228:231], a[104:107], a[16:19], v[228:231]
    s_waitcnt vmcnt(14) lgkmcnt(0)
    v_mfma_f32_16x16x32_bf16 v[132:135], a[108:111], a[20:23], v[132:135]
    ds_read_b128 a[80:83], v5 offset:36864
    v_mfma_f32_16x16x32_bf16 v[156:159], a[108:111], a[24:27], v[156:159]
    buffer_load_dwordx4 a[0:3], v2, s[40:43], s35 offen offset:0 sc1
    v_mfma_f32_16x16x32_bf16 v[180:183], a[108:111], a[28:31], v[180:183]
    ds_read_b128 a[84:87], v5 offset:37888
    v_mfma_f32_16x16x32_bf16 v[204:207], a[108:111], a[32:35], v[204:207]
    v_mfma_f32_16x16x32_bf16 v[136:139], a[112:115], a[20:23], v[136:139]
    buffer_load_dwordx4 a[4:7], v2, s[40:43], s35 offen offset:1024 sc1
    v_mfma_f32_16x16x32_bf16 v[160:163], a[112:115], a[24:27], v[160:163]
    ds_read_b128 a[88:91], v5 offset:38912
    v_mfma_f32_16x16x32_bf16 v[184:187], a[112:115], a[28:31], v[184:187]
    v_mfma_f32_16x16x32_bf16 v[208:211], a[112:115], a[32:35], v[208:211]
    ds_read_b128 a[92:95], v5 offset:39936
    buffer_load_dwordx4 a[8:11], v2, s[40:43], s35 offen offset:2048 sc1
    v_mfma_f32_16x16x32_bf16 v[140:143], a[116:119], a[20:23], v[140:143]
    v_mfma_f32_16x16x32_bf16 v[164:167], a[116:119], a[24:27], v[164:167]
    v_mfma_f32_16x16x32_bf16 v[188:191], a[116:119], a[28:31], v[188:191]
    ds_read_b128 a[96:99], v5 offset:40960
    v_mfma_f32_16x16x32_bf16 v[212:215], a[116:119], a[32:35], v[212:215]
    buffer_load_dwordx4 a[12:15], v2, s[40:43], s35 offen offset:3072 sc1
    v_mfma_f32_16x16x32_bf16 v[144:147], a[120:123], a[20:23], v[144:147]
    ds_read_b128 a[100:103], v5 offset:41984
    v_mfma_f32_16x16x32_bf16 v[168:171], a[120:123], a[24:27], v[168:171]
    v_mfma_f32_16x16x32_bf16 v[192:195], a[120:123], a[28:31], v[192:195]
    buffer_load_dwordx4 a[16:19], v3, s[40:43], s35 offen sc1
    s_add_u32 s35, s35, 4096
    s_and_b32 s35, s35, 0x1ffff
    v_mfma_f32_16x16x32_bf16 v[216:219], a[120:123], a[32:35], v[216:219]
    ds_read_b128 a[104:107], v6 offset:36864
    v_mfma_f32_16x16x32_bf16 v[148:151], a[124:127], a[20:23], v[148:151]
    v_mfma_f32_16x16x32_bf16 v[172:175], a[124:127], a[24:27], v[172:175]
    v_mfma_f32_16x16x32_bf16 v[196:199], a[124:127], a[28:31], v[196:199]
    buffer_load_dwordx4 v1, s[4:7], s44 offen offset:1024 sc1 lds
    v_mfma_f32_16x16x32_bf16 v[220:223], a[124:127], a[32:35], v[220:223]
    v_mfma_f32_16x16x32_bf16 v[152:155], a[128:131], a[20:23], v[152:155]
    v_mfma_f32_16x16x32_bf16 v[176:179], a[128:131], a[24:27], v[176:179]
    buffer_load_dwordx4 v1, s[4:7], s44 offen offset:2048 sc1 lds
    v_mfma_f32_16x16x32_bf16 v[200:203], a[128:131], a[28:31], v[200:203]
    v_mfma_f32_16x16x32_bf16 v[224:227], a[128:131], a[32:35], v[224:227]
    v_mfma_f32_16x16x32_bf16 v[228:231], a[132:135], a[36:39], v[228:231]
    s_waitcnt vmcnt(15) lgkmcnt(0)
    v_mfma_f32_16x16x32_bf16 v[132:135], a[80:83], a[40:43], v[132:135]
    ds_read_b128 a[108:111], v5 offset:43008
    v_mfma_f32_16x16x32_bf16 v[156:159], a[80:83], a[44:47], v[156:159]
    buffer_load_dwordx4 a[20:23], v2, s[40:43], s35 offen offset:0 sc1
    v_mfma_f32_16x16x32_bf16 v[180:183], a[80:83], a[48:51], v[180:183]
    ds_read_b128 a[112:115], v5 offset:44032
    v_mfma_f32_16x16x32_bf16 v[204:207], a[80:83], a[52:55], v[204:207]
    v_mfma_f32_16x16x32_bf16 v[136:139], a[84:87], a[40:43], v[136:139]
    v_mfma_f32_16x16x32_bf16 v[160:163], a[84:87], a[44:47], v[160:163]
    ds_read_b128 a[116:119], v5 offset:45056
    buffer_load_dwordx4 a[24:27], v2, s[40:43], s35 offen offset:1024 sc1
    v_mfma_f32_16x16x32_bf16 v[184:187], a[84:87], a[48:51], v[184:187]
    v_mfma_f32_16x16x32_bf16 v[208:211], a[84:87], a[52:55], v[208:211]
    ds_read_b128 a[120:123], v5 offset:46080
    v_mfma_f32_16x16x32_bf16 v[140:143], a[88:91], a[40:43], v[140:143]
    v_mfma_f32_16x16x32_bf16 v[164:167], a[88:91], a[44:47], v[164:167]
    buffer_load_dwordx4 a[28:31], v2, s[40:43], s35 offen offset:2048 sc1
    v_mfma_f32_16x16x32_bf16 v[188:191], a[88:91], a[48:51], v[188:191]
    ds_read_b128 a[124:127], v5 offset:47104
    v_mfma_f32_16x16x32_bf16 v[212:215], a[88:91], a[52:55], v[212:215]
    v_mfma_f32_16x16x32_bf16 v[144:147], a[92:95], a[40:43], v[144:147]
    ds_read_b128 a[128:131], v5 offset:48128
    v_mfma_f32_16x16x32_bf16 v[168:171], a[92:95], a[44:47], v[168:171]
    buffer_load_dwordx4 a[32:35], v2, s[40:43], s35 offen offset:3072 sc1
    v_mfma_f32_16x16x32_bf16 v[192:195], a[92:95], a[48:51], v[192:195]
    v_mfma_f32_16x16x32_bf16 v[216:219], a[92:95], a[52:55], v[216:219]
    ds_read_b128 a[132:135], v6 offset:43008
    v_mfma_f32_16x16x32_bf16 v[148:151], a[96:99], a[40:43], v[148:151]
    v_mfma_f32_16x16x32_bf16 v[172:175], a[96:99], a[44:47], v[172:175]
    buffer_load_dwordx4 a[36:39], v3, s[40:43], s35 offen sc1
    s_add_u32 s35, s35, 4096
    s_and_b32 s35, s35, 0x1ffff
    v_mfma_f32_16x16x32_bf16 v[196:199], a[96:99], a[48:51], v[196:199]
    v_mfma_f32_16x16x32_bf16 v[220:223], a[96:99], a[52:55], v[220:223]
    v_mfma_f32_16x16x32_bf16 v[152:155], a[100:103], a[40:43], v[152:155]
    v_mfma_f32_16x16x32_bf16 v[176:179], a[100:103], a[44:47], v[176:179]
    buffer_load_dwordx4 v1, s[4:7], s44 offen offset:3072 sc1 lds
    v_mfma_f32_16x16x32_bf16 v[200:203], a[100:103], a[48:51], v[200:203]
    v_mfma_f32_16x16x32_bf16 v[224:227], a[100:103], a[52:55], v[224:227]
    v_mfma_f32_16x16x32_bf16 v[228:231], a[104:107], a[56:59], v[228:231]
    s_waitcnt vmcnt(14) lgkmcnt(0)
    s_barrier
    v_mfma_f32_16x16x32_bf16 v[132:135], a[108:111], a[60:63], v[132:135]
    v_add_u32 v5, 98304, v1
    ds_read_b128 a[80:83], v5 offset:0
    v_mfma_f32_16x16x32_bf16 v[156:159], a[108:111], a[64:67], v[156:159]
    buffer_load_dwordx4 a[40:43], v2, s[40:43], s35 offen offset:0 sc1
    v_mfma_f32_16x16x32_bf16 v[180:183], a[108:111], a[68:71], v[180:183]
    v_add_u32 v6, s39, v5
    ds_read_b128 a[84:87], v5 offset:1024
    v_mfma_f32_16x16x32_bf16 v[204:207], a[108:111], a[72:75], v[204:207]
    v_mfma_f32_16x16x32_bf16 v[136:139], a[112:115], a[60:63], v[136:139]
    v_mfma_f32_16x16x32_bf16 v[160:163], a[112:115], a[64:67], v[160:163]
    ds_read_b128 a[88:91], v5 offset:2048
    buffer_load_dwordx4 a[44:47], v2, s[40:43], s35 offen offset:1024 sc1
    v_mfma_f32_16x16x32_bf16 v[184:187], a[112:115], a[68:71], v[184:187]
    v_mfma_f32_16x16x32_bf16 v[208:211], a[112:115], a[72:75], v[208:211]
    ds_read_b128 a[92:95], v5 offset:3072
    v_mfma_f32_16x16x32_bf16 v[140:143], a[116:119], a[60:63], v[140:143]
    v_mfma_f32_16x16x32_bf16 v[164:167], a[116:119], a[64:67], v[164:167]
    v_mfma_f32_16x16x32_bf16 v[188:191], a[116:119], a[68:71], v[188:191]
    ds_read_b128 a[96:99], v5 offset:4096
    buffer_load_dwordx4 a[48:51], v2, s[40:43], s35 offen offset:2048 sc1
    v_mfma_f32_16x16x32_bf16 v[212:215], a[116:119], a[72:75], v[212:215]
    v_mfma_f32_16x16x32_bf16 v[144:147], a[120:123], a[60:63], v[144:147]
    ds_read_b128 a[100:103], v5 offset:5120
    v_mfma_f32_16x16x32_bf16 v[168:171], a[120:123], a[64:67], v[168:171]
    v_mfma_f32_16x16x32_bf16 v[192:195], a[120:123], a[68:71], v[192:195]
    v_mfma_f32_16x16x32_bf16 v[216:219], a[120:123], a[72:75], v[216:219]
    ds_read_b128 a[104:107], v6 offset:0
    buffer_load_dwordx4 a[52:55], v2, s[40:43], s35 offen offset:3072 sc1
    v_mfma_f32_16x16x32_bf16 v[148:151], a[124:127], a[60:63], v[148:151]
    v_mfma_f32_16x16x32_bf16 v[172:175], a[124:127], a[64:67], v[172:175]
    v_mfma_f32_16x16x32_bf16 v[196:199], a[124:127], a[68:71], v[196:199]
    v_mfma_f32_16x16x32_bf16 v[220:223], a[124:127], a[72:75], v[220:223]
    v_mfma_f32_16x16x32_bf16 v[152:155], a[128:131], a[60:63], v[152:155]
    buffer_load_dwordx4 a[56:59], v3, s[40:43], s35 offen sc1
    s_add_u32 s35, s35, 4096
    s_and_b32 s35, s35, 0x1ffff
    v_mfma_f32_16x16x32_bf16 v[176:179], a[128:131], a[64:67], v[176:179]
    v_mfma_f32_16x16x32_bf16 v[200:203], a[128:131], a[68:71], v[200:203]
    v_mfma_f32_16x16x32_bf16 v[224:227], a[128:131], a[72:75], v[224:227]
    v_mfma_f32_16x16x32_bf16 v[228:231], a[132:135], a[76:79], v[228:231]
    s_waitcnt vmcnt(13) lgkmcnt(0)
    v_mfma_f32_16x16x32_bf16 v[132:135], a[80:83], a[0:3], v[132:135]
    ds_read_b128 a[108:111], v5 offset:6144
    v_mfma_f32_16x16x32_bf16 v[156:159], a[80:83], a[4:7], v[156:159]
    buffer_load_dwordx4 a[60:63], v2, s[40:43], s35 offen offset:0 sc1
    v_mfma_f32_16x16x32_bf16 v[180:183], a[80:83], a[8:11], v[180:183]
    ds_read_b128 a[112:115], v5 offset:7168
    v_mfma_f32_16x16x32_bf16 v[204:207], a[80:83], a[12:15], v[204:207]
    v_mfma_f32_16x16x32_bf16 v[136:139], a[84:87], a[0:3], v[136:139]
    v_mfma_f32_16x16x32_bf16 v[160:163], a[84:87], a[4:7], v[160:163]
    ds_read_b128 a[116:119], v5 offset:8192
    buffer_load_dwordx4 a[64:67], v2, s[40:43], s35 offen offset:1024 sc1
    v_mfma_f32_16x16x32_bf16 v[184:187], a[84:87], a[8:11], v[184:187]
    v_mfma_f32_16x16x32_bf16 v[208:211], a[84:87], a[12:15], v[208:211]
    ds_read_b128 a[120:123], v5 offset:9216
    v_mfma_f32_16x16x32_bf16 v[140:143], a[88:91], a[0:3], v[140:143]
    v_mfma_f32_16x16x32_bf16 v[164:167], a[88:91], a[4:7], v[164:167]
    v_mfma_f32_16x16x32_bf16 v[188:191], a[88:91], a[8:11], v[188:191]
    ds_read_b128 a[124:127], v5 offset:10240
    buffer_load_dwordx4 a[68:71], v2, s[40:43], s35 offen offset:2048 sc1
    v_mfma_f32_16x16x32_bf16 v[212:215], a[88:91], a[12:15], v[212:215]
    v_mfma_f32_16x16x32_bf16 v[144:147], a[92:95], a[0:3], v[144:147]
    ds_read_b128 a[128:131], v5 offset:11264
    v_mfma_f32_16x16x32_bf16 v[168:171], a[92:95], a[4:7], v[168:171]
    v_mfma_f32_16x16x32_bf16 v[192:195], a[92:95], a[8:11], v[192:195]
    v_mfma_f32_16x16x32_bf16 v[216:219], a[92:95], a[12:15], v[216:219]
    ds_read_b128 a[132:135], v6 offset:6144
    buffer_load_dwordx4 a[72:75], v2, s[40:43], s35 offen offset:3072 sc1
    v_mfma_f32_16x16x32_bf16 v[148:151], a[96:99], a[0:3], v[148:151]
    v_mfma_f32_16x16x32_bf16 v[172:175], a[96:99], a[4:7], v[172:175]
    v_mfma_f32_16x16x32_bf16 v[196:199], a[96:99], a[8:11], v[196:199]
    v_mfma_f32_16x16x32_bf16 v[220:223], a[96:99], a[12:15], v[220:223]
    v_mfma_f32_16x16x32_bf16 v[152:155], a[100:103], a[0:3], v[152:155]
    buffer_load_dwordx4 a[76:79], v3, s[40:43], s35 offen sc1
    s_add_u32 s35, s35, 4096
    s_and_b32 s35, s35, 0x1ffff
    v_mfma_f32_16x16x32_bf16 v[176:179], a[100:103], a[4:7], v[176:179]
    v_mfma_f32_16x16x32_bf16 v[200:203], a[100:103], a[8:11], v[200:203]
    v_mfma_f32_16x16x32_bf16 v[224:227], a[100:103], a[12:15], v[224:227]
    v_mfma_f32_16x16x32_bf16 v[228:231], a[104:107], a[16:19], v[228:231]
    s_waitcnt vmcnt(11) lgkmcnt(0)
    v_mfma_f32_16x16x32_bf16 v[132:135], a[108:111], a[20:23], v[132:135]
    ds_read_b128 a[80:83], v5 offset:12288
    v_mfma_f32_16x16x32_bf16 v[156:159], a[108:111], a[24:27], v[156:159]
    buffer_load_dwordx4 a[0:3], v2, s[40:43], s35 offen offset:0 sc1
    v_mfma_f32_16x16x32_bf16 v[180:183], a[108:111], a[28:31], v[180:183]
    ds_read_b128 a[84:87], v5 offset:13312
    v_mfma_f32_16x16x32_bf16 v[204:207], a[108:111], a[32:35], v[204:207]
    v_mfma_f32_16x16x32_bf16 v[136:139], a[112:115], a[20:23], v[136:139]
    v_mfma_f32_16x16x32_bf16 v[160:163], a[112:115], a[24:27], v[160:163]
    ds_read_b128 a[88:91], v5 offset:14336
    buffer_load_dwordx4 a[4:7], v2, s[40:43], s35 offen offset:1024 sc1
    v_mfma_f32_16x16x32_bf16 v[184:187], a[112:115], a[28:31], v[184:187]
    v_mfma_f32_16x16x32_bf16 v[208:211], a[112:115], a[32:35], v[208:211]
    ds_read_b128 a[92:95], v5 offset:15360
    v_mfma_f32_16x16x32_bf16 v[140:143], a[116:119], a[20:23], v[140:143]
    v_mfma_f32_16x16x32_bf16 v[164:167], a[116:119], a[24:27], v[164:167]
    v_mfma_f32_16x16x32_bf16 v[188:191], a[116:119], a[28:31], v[188:191]
    ds_read_b128 a[96:99], v5 offset:16384
    buffer_load_dwordx4 a[8:11], v2, s[40:43], s35 offen offset:2048 sc1
    v_mfma_f32_16x16x32_bf16 v[212:215], a[116:119], a[32:35], v[212:215]
    v_mfma_f32_16x16x32_bf16 v[144:147], a[120:123], a[20:23], v[144:147]
    ds_read_b128 a[100:103], v5 offset:17408
    v_mfma_f32_16x16x32_bf16 v[168:171], a[120:123], a[24:27], v[168:171]
    v_mfma_f32_16x16x32_bf16 v[192:195], a[120:123], a[28:31], v[192:195]
    v_mfma_f32_16x16x32_bf16 v[216:219], a[120:123], a[32:35], v[216:219]
    ds_read_b128 a[104:107], v6 offset:12288
    buffer_load_dwordx4 a[12:15], v2, s[40:43], s35 offen offset:3072 sc1
    v_mfma_f32_16x16x32_bf16 v[148:151], a[124:127], a[20:23], v[148:151]
    v_mfma_f32_16x16x32_bf16 v[172:175], a[124:127], a[24:27], v[172:175]
    v_mfma_f32_16x16x32_bf16 v[196:199], a[124:127], a[28:31], v[196:199]
    v_mfma_f32_16x16x32_bf16 v[220:223], a[124:127], a[32:35], v[220:223]
    v_mfma_f32_16x16x32_bf16 v[152:155], a[128:131], a[20:23], v[152:155]
    buffer_load_dwordx4 a[16:19], v3, s[40:43], s35 offen sc1
    s_add_u32 s35, s35, 4096
    s_and_b32 s35, s35, 0x1ffff
    v_mfma_f32_16x16x32_bf16 v[176:179], a[128:131], a[24:27], v[176:179]
    v_mfma_f32_16x16x32_bf16 v[200:203], a[128:131], a[28:31], v[200:203]
    v_mfma_f32_16x16x32_bf16 v[224:227], a[128:131], a[32:35], v[224:227]
    v_mfma_f32_16x16x32_bf16 v[228:231], a[132:135], a[36:39], v[228:231]
    s_waitcnt vmcnt(10) lgkmcnt(0)
    v_mfma_f32_16x16x32_bf16 v[132:135], a[80:83], a[40:43], v[132:135]
    ds_read_b128 a[108:111], v5 offset:18432
    v_mfma_f32_16x16x32_bf16 v[156:159], a[80:83], a[44:47], v[156:159]
    buffer_load_dwordx4 a[20:23], v2, s[40:43], s35 offen offset:0 sc1
    v_mfma_f32_16x16x32_bf16 v[180:183], a[80:83], a[48:51], v[180:183]
    ds_read_b128 a[112:115], v5 offset:19456
    v_mfma_f32_16x16x32_bf16 v[204:207], a[80:83], a[52:55], v[204:207]
    v_mfma_f32_16x16x32_bf16 v[136:139], a[84:87], a[40:43], v[136:139]
    v_mfma_f32_16x16x32_bf16 v[160:163], a[84:87], a[44:47], v[160:163]
    ds_read_b128 a[116:119], v5 offset:20480
    buffer_load_dwordx4 a[24:27], v2, s[40:43], s35 offen offset:1024 sc1
    v_mfma_f32_16x16x32_bf16 v[184:187], a[84:87], a[48:51], v[184:187]
    v_mfma_f32_16x16x32_bf16 v[208:211], a[84:87], a[52:55], v[208:211]
    ds_read_b128 a[120:123], v5 offset:21504
    v_mfma_f32_16x16x32_bf16 v[140:143], a[88:91], a[40:43], v[140:143]
    v_mfma_f32_16x16x32_bf16 v[164:167], a[88:91], a[44:47], v[164:167]
    v_mfma_f32_16x16x32_bf16 v[188:191], a[88:91], a[48:51], v[188:191]
    ds_read_b128 a[124:127], v5 offset:22528
    buffer_load_dwordx4 a[28:31], v2, s[40:43], s35 offen offset:2048 sc1
    v_mfma_f32_16x16x32_bf16 v[212:215], a[88:91], a[52:55], v[212:215]
    v_mfma_f32_16x16x32_bf16 v[144:147], a[92:95], a[40:43], v[144:147]
    ds_read_b128 a[128:131], v5 offset:23552
    v_mfma_f32_16x16x32_bf16 v[168:171], a[92:95], a[44:47], v[168:171]
    v_mfma_f32_16x16x32_bf16 v[192:195], a[92:95], a[48:51], v[192:195]
    v_mfma_f32_16x16x32_bf16 v[216:219], a[92:95], a[52:55], v[216:219]
    ds_read_b128 a[132:135], v6 offset:18432
    buffer_load_dwordx4 a[32:35], v2, s[40:43], s35 offen offset:3072 sc1
    v_mfma_f32_16x16x32_bf16 v[148:151], a[96:99], a[40:43], v[148:151]
    v_mfma_f32_16x16x32_bf16 v[172:175], a[96:99], a[44:47], v[172:175]
    v_mfma_f32_16x16x32_bf16 v[196:199], a[96:99], a[48:51], v[196:199]
    v_mfma_f32_16x16x32_bf16 v[220:223], a[96:99], a[52:55], v[220:223]
    v_mfma_f32_16x16x32_bf16 v[152:155], a[100:103], a[40:43], v[152:155]
    buffer_load_dwordx4 a[36:39], v3, s[40:43], s35 offen sc1
    s_add_u32 s35, s35, 4096
    s_and_b32 s35, s35, 0x1ffff
    v_mfma_f32_16x16x32_bf16 v[176:179], a[100:103], a[44:47], v[176:179]
    v_mfma_f32_16x16x32_bf16 v[200:203], a[100:103], a[48:51], v[200:203]
    v_mfma_f32_16x16x32_bf16 v[224:227], a[100:103], a[52:55], v[224:227]
    v_mfma_f32_16x16x32_bf16 v[228:231], a[104:107], a[56:59], v[228:231]
    s_waitcnt vmcnt(10) lgkmcnt(0)
    v_mfma_f32_16x16x32_bf16 v[132:135], a[108:111], a[60:63], v[132:135]
    ds_read_b128 a[80:83], v5 offset:24576
    v_mfma_f32_16x16x32_bf16 v[156:159], a[108:111], a[64:67], v[156:159]
    buffer_load_dwordx4 a[40:43], v2, s[40:43], s35 offen offset:0 sc1
    v_mfma_f32_16x16x32_bf16 v[180:183], a[108:111], a[68:71], v[180:183]
    ds_read_b128 a[84:87], v5 offset:25600
    v_mfma_f32_16x16x32_bf16 v[204:207], a[108:111], a[72:75], v[204:207]
    v_mfma_f32_16x16x32_bf16 v[136:139], a[112:115], a[60:63], v[136:139]
    v_mfma_f32_16x16x32_bf16 v[160:163], a[112:115], a[64:67], v[160:163]
    ds_read_b128 a[88:91], v5 offset:26624
    buffer_load_dwordx4 a[44:47], v2, s[40:43], s35 offen offset:1024 sc1
    v_mfma_f32_16x16x32_bf16 v[184:187], a[112:115], a[68:71], v[184:187]
    v_mfma_f32_16x16x32_bf16 v[208:211], a[112:115], a[72:75], v[208:211]
    ds_read_b128 a[92:95], v5 offset:27648
    v_mfma_f32_16x16x32_bf16 v[140:143], a[116:119], a[60:63], v[140:143]
    v_mfma_f32_16x16x32_bf16 v[164:167], a[116:119], a[64:67], v[164:167]
    v_mfma_f32_16x16x32_bf16 v[188:191], a[116:119], a[68:71], v[188:191]
    ds_read_b128 a[96:99], v5 offset:28672
    buffer_load_dwordx4 a[48:51], v2, s[40:43], s35 offen offset:2048 sc1
    v_mfma_f32_16x16x32_bf16 v[212:215], a[116:119], a[72:75], v[212:215]
    v_mfma_f32_16x16x32_bf16 v[144:147], a[120:123], a[60:63], v[144:147]
    ds_read_b128 a[100:103], v5 offset:29696
    v_mfma_f32_16x16x32_bf16 v[168:171], a[120:123], a[64:67], v[168:171]
    v_mfma_f32_16x16x32_bf16 v[192:195], a[120:123], a[68:71], v[192:195]
    v_mfma_f32_16x16x32_bf16 v[216:219], a[120:123], a[72:75], v[216:219]
    ds_read_b128 a[104:107], v6 offset:24576
    buffer_load_dwordx4 a[52:55], v2, s[40:43], s35 offen offset:3072 sc1
    v_mfma_f32_16x16x32_bf16 v[148:151], a[124:127], a[60:63], v[148:151]
    v_mfma_f32_16x16x32_bf16 v[172:175], a[124:127], a[64:67], v[172:175]
    v_mfma_f32_16x16x32_bf16 v[196:199], a[124:127], a[68:71], v[196:199]
    v_mfma_f32_16x16x32_bf16 v[220:223], a[124:127], a[72:75], v[220:223]
    v_mfma_f32_16x16x32_bf16 v[152:155], a[128:131], a[60:63], v[152:155]
    buffer_load_dwordx4 a[56:59], v3, s[40:43], s35 offen sc1
    s_add_u32 s35, s35, 4096
    s_and_b32 s35, s35, 0x1ffff
    v_mfma_f32_16x16x32_bf16 v[176:179], a[128:131], a[64:67], v[176:179]
    v_mfma_f32_16x16x32_bf16 v[200:203], a[128:131], a[68:71], v[200:203]
    v_mfma_f32_16x16x32_bf16 v[224:227], a[128:131], a[72:75], v[224:227]
    v_mfma_f32_16x16x32_bf16 v[228:231], a[132:135], a[76:79], v[228:231]
    s_waitcnt vmcnt(10) lgkmcnt(0)
    v_mfma_f32_16x16x32_bf16 v[132:135], a[80:83], a[0:3], v[132:135]
    ds_read_b128 a[108:111], v5 offset:30720
    v_mfma_f32_16x16x32_bf16 v[156:159], a[80:83], a[4:7], v[156:159]
    buffer_load_dwordx4 a[60:63], v2, s[40:43], s35 offen offset:0 sc1
    v_mfma_f32_16x16x32_bf16 v[180:183], a[80:83], a[8:11], v[180:183]
    ds_read_b128 a[112:115], v5 offset:31744
    v_mfma_f32_16x16x32_bf16 v[204:207], a[80:83], a[12:15], v[204:207]
    v_mfma_f32_16x16x32_bf16 v[136:139], a[84:87], a[0:3], v[136:139]
    buffer_load_dwordx4 a[64:67], v2, s[40:43], s35 offen offset:1024 sc1
    v_mfma_f32_16x16x32_bf16 v[160:163], a[84:87], a[4:7], v[160:163]
    ds_read_b128 a[116:119], v5 offset:32768
    v_mfma_f32_16x16x32_bf16 v[184:187], a[84:87], a[8:11], v[184:187]
    v_mfma_f32_16x16x32_bf16 v[208:211], a[84:87], a[12:15], v[208:211]
    ds_read_b128 a[120:123], v5 offset:33792
    buffer_load_dwordx4 a[68:71], v2, s[40:43], s35 offen offset:2048 sc1
    v_mfma_f32_16x16x32_bf16 v[140:143], a[88:91], a[0:3], v[140:143]
    v_mfma_f32_16x16x32_bf16 v[164:167], a[88:91], a[4:7], v[164:167]
    v_mfma_f32_16x16x32_bf16 v[188:191], a[88:91], a[8:11], v[188:191]
    ds_read_b128 a[124:127], v5 offset:34816
    buffer_load_dwordx4 a[72:75], v2, s[40:43], s35 offen offset:3072 sc1
    v_mfma_f32_16x16x32_bf16 v[212:215], a[88:91], a[12:15], v[212:215]
    v_mfma_f32_16x16x32_bf16 v[144:147], a[92:95], a[0:3], v[144:147]
    ds_read_b128 a[128:131], v5 offset:35840
    v_mfma_f32_16x16x32_bf16 v[168:171], a[92:95], a[4:7], v[168:171]
    buffer_load_dwordx4 a[76:79], v3, s[40:43], s35 offen sc1
    s_add_u32 s35, s35, 4096
    s_and_b32 s35, s35, 0x1ffff
    v_mfma_f32_16x16x32_bf16 v[192:195], a[92:95], a[8:11], v[192:195]
    v_mfma_f32_16x16x32_bf16 v[216:219], a[92:95], a[12:15], v[216:219]
    ds_read_b128 a[132:135], v6 offset:30720
    v_mfma_f32_16x16x32_bf16 v[148:151], a[96:99], a[0:3], v[148:151]
    s_mov_b32 s36, 0x280000
    s_mov_b32 s37, 0x281000
    buffer_load_dwordx2 v[92:93], v14, s[4:7], s36 offen offset:0 sc1
    v_mfma_f32_16x16x32_bf16 v[172:175], a[96:99], a[4:7], v[172:175]
    v_mfma_f32_16x16x32_bf16 v[196:199], a[96:99], a[8:11], v[196:199]
    v_mfma_f32_16x16x32_bf16 v[220:223], a[96:99], a[12:15], v[220:223]
    buffer_load_dwordx2 v[94:95], v14, s[4:7], s36 offen offset:128 sc1
    v_mfma_f32_16x16x32_bf16 v[152:155], a[100:103], a[0:3], v[152:155]
    v_mfma_f32_16x16x32_bf16 v[176:179], a[100:103], a[4:7], v[176:179]
    v_mfma_f32_16x16x32_bf16 v[200:203], a[100:103], a[8:11], v[200:203]
    buffer_load_dwordx2 v[96:97], v14, s[4:7], s36 offen offset:256 sc1
    v_mfma_f32_16x16x32_bf16 v[224:227], a[100:103], a[12:15], v[224:227]
    v_mfma_f32_16x16x32_bf16 v[228:231], a[104:107], a[16:19], v[228:231]
    s_waitcnt vmcnt(13) lgkmcnt(0)
    v_mfma_f32_16x16x32_bf16 v[132:135], a[108:111], a[20:23], v[132:135]
    ds_read_b128 a[80:83], v5 offset:36864
    v_mfma_f32_16x16x32_bf16 v[156:159], a[108:111], a[24:27], v[156:159]
    buffer_load_dwordx4 a[0:3], v2, s[40:43], s35 offen offset:0 sc1
    v_mfma_f32_16x16x32_bf16 v[180:183], a[108:111], a[28:31], v[180:183]
    ds_read_b128 a[84:87], v5 offset:37888
    v_mfma_f32_16x16x32_bf16 v[204:207], a[108:111], a[32:35], v[204:207]
    v_mfma_f32_16x16x32_bf16 v[136:139], a[112:115], a[20:23], v[136:139]
    buffer_load_dwordx4 a[4:7], v2, s[40:43], s35 offen offset:1024 sc1
    v_mfma_f32_16x16x32_bf16 v[160:163], a[112:115], a[24:27], v[160:163]
    ds_read_b128 a[88:91], v5 offset:38912
    v_mfma_f32_16x16x32_bf16 v[184:187], a[112:115], a[28:31], v[184:187]
    v_mfma_f32_16x16x32_bf16 v[208:211], a[112:115], a[32:35], v[208:211]
    ds_read_b128 a[92:95], v5 offset:39936
    buffer_load_dwordx4 a[8:11], v2, s[40:43], s35 offen offset:2048 sc1
    v_mfma_f32_16x16x32_bf16 v[140:143], a[116:119], a[20:23], v[140:143]
    v_mfma_f32_16x16x32_bf16 v[164:167], a[116:119], a[24:27], v[164:167]
    v_mfma_f32_16x16x32_bf16 v[188:191], a[116:119], a[28:31], v[188:191]
    ds_read_b128 a[96:99], v5 offset:40960
    v_mfma_f32_16x16x32_bf16 v[212:215], a[116:119], a[32:35], v[212:215]
    buffer_load_dwordx4 a[12:15], v2, s[40:43], s35 offen offset:3072 sc1
    v_mfma_f32_16x16x32_bf16 v[144:147], a[120:123], a[20:23], v[144:147]
    ds_read_b128 a[100:103], v5 offset:41984
    v_mfma_f32_16x16x32_bf16 v[168:171], a[120:123], a[24:27], v[168:171]
    v_mfma_f32_16x16x32_bf16 v[192:195], a[120:123], a[28:31], v[192:195]
    buffer_load_dwordx4 a[16:19], v3, s[40:43], s35 offen sc1
    s_add_u32 s35, s35, 4096
    s_and_b32 s35, s35, 0x1ffff
    v_mfma_f32_16x16x32_bf16 v[216:219], a[120:123], a[32:35], v[216:219]
    ds_read_b128 a[104:107], v6 offset:36864
    v_mfma_f32_16x16x32_bf16 v[148:151], a[124:127], a[20:23], v[148:151]
    v_mfma_f32_16x16x32_bf16 v[172:175], a[124:127], a[24:27], v[172:175]
    v_mfma_f32_16x16x32_bf16 v[196:199], a[124:127], a[28:31], v[196:199]
    buffer_load_dwordx2 v[98:99], v14, s[4:7], s36 offen offset:384 sc1
    v_mfma_f32_16x16x32_bf16 v[220:223], a[124:127], a[32:35], v[220:223]
    v_mfma_f32_16x16x32_bf16 v[152:155], a[128:131], a[20:23], v[152:155]
    v_mfma_f32_16x16x32_bf16 v[176:179], a[128:131], a[24:27], v[176:179]
    buffer_load_dwordx2 v[100:101], v14, s[4:7], s36 offen offset:2048 sc1
    v_mfma_f32_16x16x32_bf16 v[200:203], a[128:131], a[28:31], v[200:203]
    v_mfma_f32_16x16x32_bf16 v[224:227], a[128:131], a[32:35], v[224:227]
    v_mfma_f32_16x16x32_bf16 v[228:231], a[132:135], a[36:39], v[228:231]
    s_waitcnt vmcnt(15) lgkmcnt(0)
    v_mfma_f32_16x16x32_bf16 v[132:135], a[80:83], a[40:43], v[132:135]
    ds_read_b128 a[108:111], v5 offset:43008
    v_mfma_f32_16x16x32_bf16 v[156:159], a[80:83], a[44:47], v[156:159]
    buffer_load_dwordx4 a[20:23], v2, s[40:43], s35 offen offset:0 sc1
    v_mfma_f32_16x16x32_bf16 v[180:183], a[80:83], a[48:51], v[180:183]
    ds_read_b128 a[112:115], v5 offset:44032
    v_mfma_f32_16x16x32_bf16 v[204:207], a[80:83], a[52:55], v[204:207]
    v_mfma_f32_16x16x32_bf16 v[136:139], a[84:87], a[40:43], v[136:139]
    buffer_load_dwordx4 a[24:27], v2, s[40:43], s35 offen offset:1024 sc1
    v_mfma_f32_16x16x32_bf16 v[160:163], a[84:87], a[44:47], v[160:163]
    ds_read_b128 a[116:119], v5 offset:45056
    v_mfma_f32_16x16x32_bf16 v[184:187], a[84:87], a[48:51], v[184:187]
    v_mfma_f32_16x16x32_bf16 v[208:211], a[84:87], a[52:55], v[208:211]
    ds_read_b128 a[120:123], v5 offset:46080
    buffer_load_dwordx4 a[28:31], v2, s[40:43], s35 offen offset:2048 sc1
    v_mfma_f32_16x16x32_bf16 v[140:143], a[88:91], a[40:43], v[140:143]
    v_mfma_f32_16x16x32_bf16 v[164:167], a[88:91], a[44:47], v[164:167]
    v_mfma_f32_16x16x32_bf16 v[188:191], a[88:91], a[48:51], v[188:191]
    ds_read_b128 a[124:127], v5 offset:47104
    v_mfma_f32_16x16x32_bf16 v[212:215], a[88:91], a[52:55], v[212:215]
    buffer_load_dwordx4 a[32:35], v2, s[40:43], s35 offen offset:3072 sc1
    v_mfma_f32_16x16x32_bf16 v[144:147], a[92:95], a[40:43], v[144:147]
    ds_read_b128 a[128:131], v5 offset:48128
    v_mfma_f32_16x16x32_bf16 v[168:171], a[92:95], a[44:47], v[168:171]
    v_mfma_f32_16x16x32_bf16 v[192:195], a[92:95], a[48:51], v[192:195]
    buffer_load_dwordx4 a[36:39], v3, s[40:43], s35 offen sc1
    s_add_u32 s35, s35, 4096
    s_and_b32 s35, s35, 0x1ffff
    v_mfma_f32_16x16x32_bf16 v[216:219], a[92:95], a[52:55], v[216:219]
    ds_read_b128 a[132:135], v6 offset:43008
    v_mfma_f32_16x16x32_bf16 v[148:151], a[96:99], a[40:43], v[148:151]
    v_mfma_f32_16x16x32_bf16 v[172:175], a[96:99], a[44:47], v[172:175]
    v_mfma_f32_16x16x32_bf16 v[196:199], a[96:99], a[48:51], v[196:199]
    buffer_load_dwordx2 v[102:103], v14, s[4:7], s36 offen offset:2176 sc1
    v_mfma_f32_16x16x32_bf16 v[220:223], a[96:99], a[52:55], v[220:223]
    v_mfma_f32_16x16x32_bf16 v[152:155], a[100:103], a[40:43], v[152:155]
    v_mfma_f32_16x16x32_bf16 v[176:179], a[100:103], a[44:47], v[176:179]
    buffer_load_dwordx2 v[104:105], v14, s[4:7], s36 offen offset:2304 sc1
    v_mfma_f32_16x16x32_bf16 v[200:203], a[100:103], a[48:51], v[200:203]
    v_mfma_f32_16x16x32_bf16 v[224:227], a[100:103], a[52:55], v[224:227]
    v_mfma_f32_16x16x32_bf16 v[228:231], a[104:107], a[56:59], v[228:231]
    s_waitcnt vmcnt(17) lgkmcnt(0)
    s_barrier
    v_mfma_f32_16x16x32_bf16 v[132:135], a[108:111], a[60:63], v[132:135]
    v_add_u32 v5, 0, v1
    ds_read_b128 a[80:83], v5 offset:0
    v_mfma_f32_16x16x32_bf16 v[156:159], a[108:111], a[64:67], v[156:159]
    buffer_load_dwordx4 a[40:43], v2, s[40:43], s35 offen offset:0 sc1
    v_mfma_f32_16x16x32_bf16 v[180:183], a[108:111], a[68:71], v[180:183]
    v_add_u32 v6, s39, v5
    ds_read_b128 a[84:87], v5 offset:1024
    v_mfma_f32_16x16x32_bf16 v[204:207], a[108:111], a[72:75], v[204:207]
    v_mfma_f32_16x16x32_bf16 v[136:139], a[112:115], a[60:63], v[136:139]
    buffer_load_dwordx4 a[44:47], v2, s[40:43], s35 offen offset:1024 sc1
    v_mfma_f32_16x16x32_bf16 v[160:163], a[112:115], a[64:67], v[160:163]
    ds_read_b128 a[88:91], v5 offset:2048
    v_mfma_f32_16x16x32_bf16 v[184:187], a[112:115], a[68:71], v[184:187]
    v_mfma_f32_16x16x32_bf16 v[208:211], a[112:115], a[72:75], v[208:211]
    ds_read_b128 a[92:95], v5 offset:3072
    buffer_load_dwordx4 a[48:51], v2, s[40:43], s35 offen offset:2048 sc1
    v_mfma_f32_16x16x32_bf16 v[140:143], a[116:119], a[60:63], v[140:143]
    v_mfma_f32_16x16x32_bf16 v[164:167], a[116:119], a[64:67], v[164:167]
    v_mfma_f32_16x16x32_bf16 v[188:191], a[116:119], a[68:71], v[188:191]
    ds_read_b128 a[96:99], v5 offset:4096
    v_mfma_f32_16x16x32_bf16 v[212:215], a[116:119], a[72:75], v[212:215]
    buffer_load_dwordx4 a[52:55], v2, s[40:43], s35 offen offset:3072 sc1
    v_mfma_f32_16x16x32_bf16 v[144:147], a[120:123], a[60:63], v[144:147]
    ds_read_b128 a[100:103], v5 offset:5120
    v_mfma_f32_16x16x32_bf16 v[168:171], a[120:123], a[64:67], v[168:171]
    v_mfma_f32_16x16x32_bf16 v[192:195], a[120:123], a[68:71], v[192:195]
    buffer_load_dwordx4 a[56:59], v3, s[40:43], s35 offen sc1
    s_add_u32 s35, s35, 4096
    s_and_b32 s35, s35, 0x1ffff
    v_mfma_f32_16x16x32_bf16 v[216:219], a[120:123], a[72:75], v[216:219]
    ds_read_b128 a[104:107], v6 offset:0
    v_mfma_f32_16x16x32_bf16 v[148:151], a[124:127], a[60:63], v[148:151]
    v_mfma_f32_16x16x32_bf16 v[172:175], a[124:127], a[64:67], v[172:175]
    v_mfma_f32_16x16x32_bf16 v[196:199], a[124:127], a[68:71], v[196:199]
    buffer_load_dwordx2 v[106:107], v14, s[4:7], s36 offen offset:2432 sc1
    v_mfma_f32_16x16x32_bf16 v[220:223], a[124:127], a[72:75], v[220:223]
    v_mfma_f32_16x16x32_bf16 v[152:155], a[128:131], a[60:63], v[152:155]
    v_mfma_f32_16x16x32_bf16 v[176:179], a[128:131], a[64:67], v[176:179]
    buffer_load_dwordx2 v[108:109], v14, s[4:7], s37 offen offset:0 sc1
    v_mfma_f32_16x16x32_bf16 v[200:203], a[128:131], a[68:71], v[200:203]
    v_mfma_f32_16x16x32_bf16 v[224:227], a[128:131], a[72:75], v[224:227]
    v_mfma_f32_16x16x32_bf16 v[228:231], a[132:135], a[76:79], v[228:231]
    s_waitcnt vmcnt(16) lgkmcnt(0)
    v_mfma_f32_16x16x32_bf16 v[132:135], a[80:83], a[0:3], v[132:135]
    ds_read_b128 a[108:111], v5 offset:6144
    v_mfma_f32_16x16x32_bf16 v[156:159], a[80:83], a[4:7], v[156:159]
    buffer_load_dwordx4 a[60:63], v2, s[40:43], s35 offen offset:0 sc1
    v_mfma_f32_16x16x32_bf16 v[180:183], a[80:83], a[8:11], v[180:183]
    ds_read_b128 a[112:115], v5 offset:7168
    v_mfma_f32_16x16x32_bf16 v[204:207], a[80:83], a[12:15], v[204:207]
    v_mfma_f32_16x16x32_bf16 v[136:139], a[84:87], a[0:3], v[136:139]
    buffer_load_dwordx4 a[64:67], v2, s[40:43], s35 offen offset:1024 sc1
    v_mfma_f32_16x16x32_bf16 v[160:163], a[84:87], a[4:7], v[160:163]
    ds_read_b128 a[116:119], v5 offset:8192
    v_mfma_f32_16x16x32_bf16 v[184:187], a[84:87], a[8:11], v[184:187]
    v_mfma_f32_16x16x32_bf16 v[208:211], a[84:87], a[12:15], v[208:211]
    ds_read_b128 a[120:123], v5 offset:9216
    buffer_load_dwordx4 a[68:71], v2, s[40:43], s35 offen offset:2048 sc1
    v_mfma_f32_16x16x32_bf16 v[140:143], a[88:91], a[0:3], v[140:143]
    v_mfma_f32_16x16x32_bf16 v[164:167], a[88:91], a[4:7], v[164:167]
    v_mfma_f32_16x16x32_bf16 v[188:191], a[88:91], a[8:11], v[188:191]
    ds_read_b128 a[124:127], v5 offset:10240
    buffer_load_dwordx4 a[72:75], v2, s[40:43], s35 offen offset:3072 sc1
    v_mfma_f32_16x16x32_bf16 v[212:215], a[88:91], a[12:15], v[212:215]
    v_mfma_f32_16x16x32_bf16 v[144:147], a[92:95], a[0:3], v[144:147]
    ds_read_b128 a[128:131], v5 offset:11264
    v_mfma_f32_16x16x32_bf16 v[168:171], a[92:95], a[4:7], v[168:171]
    buffer_load_dwordx4 a[76:79], v3, s[40:43], s35 offen sc1
    s_add_u32 s35, s35, 4096
    s_and_b32 s35, s35, 0x1ffff
    v_mfma_f32_16x16x32_bf16 v[192:195], a[92:95], a[8:11], v[192:195]
    v_mfma_f32_16x16x32_bf16 v[216:219], a[92:95], a[12:15], v[216:219]
    ds_read_b128 a[132:135], v6 offset:6144
    v_mfma_f32_16x16x32_bf16 v[148:151], a[96:99], a[0:3], v[148:151]
    buffer_load_dwordx2 v[110:111], v14, s[4:7], s37 offen offset:128 sc1
    v_mfma_f32_16x16x32_bf16 v[172:175], a[96:99], a[4:7], v[172:175]
    v_mfma_f32_16x16x32_bf16 v[196:199], a[96:99], a[8:11], v[196:199]
    v_mfma_f32_16x16x32_bf16 v[220:223], a[96:99], a[12:15], v[220:223]
    buffer_load_dwordx2 v[112:113], v14, s[4:7], s37 offen offset:256 sc1
    v_mfma_f32_16x16x32_bf16 v[152:155], a[100:103], a[0:3], v[152:155]
    v_mfma_f32_16x16x32_bf16 v[176:179], a[100:103], a[4:7], v[176:179]
    v_mfma_f32_16x16x32_bf16 v[200:203], a[100:103], a[8:11], v[200:203]
    buffer_load_dwordx2 v[114:115], v14, s[4:7], s37 offen offset:384 sc1
    v_mfma_f32_16x16x32_bf16 v[224:227], a[100:103], a[12:15], v[224:227]
    v_mfma_f32_16x16x32_bf16 v[228:231], a[104:107], a[16:19], v[228:231]
    s_waitcnt vmcnt(17) lgkmcnt(0)
    v_mfma_f32_16x16x32_bf16 v[132:135], a[108:111], a[20:23], v[132:135]
    ds_read_b128 a[80:83], v5 offset:12288
    v_mfma_f32_16x16x32_bf16 v[156:159], a[108:111], a[24:27], v[156:159]
    buffer_load_dwordx4 a[0:3], v2, s[40:43], s35 offen offset:0 sc1
    v_mfma_f32_16x16x32_bf16 v[180:183], a[108:111], a[28:31], v[180:183]
    ds_read_b128 a[84:87], v5 offset:13312
    v_mfma_f32_16x16x32_bf16 v[204:207], a[108:111], a[32:35], v[204:207]
    v_mfma_f32_16x16x32_bf16 v[136:139], a[112:115], a[20:23], v[136:139]
    buffer_load_dwordx4 a[4:7], v2, s[40:43], s35 offen offset:1024 sc1
    v_mfma_f32_16x16x32_bf16 v[160:163], a[112:115], a[24:27], v[160:163]
    ds_read_b128 a[88:91], v5 offset:14336
    v_mfma_f32_16x16x32_bf16 v[184:187], a[112:115], a[28:31], v[184:187]
    v_mfma_f32_16x16x32_bf16 v[208:211], a[112:115], a[32:35], v[208:211]
    ds_read_b128 a[92:95], v5 offset:15360
    buffer_load_dwordx4 a[8:11], v2, s[40:43], s35 offen offset:2048 sc1
    v_mfma_f32_16x16x32_bf16 v[140:143], a[116:119], a[20:23], v[140:143]
    v_mfma_f32_16x16x32_bf16 v[164:167], a[116:119], a[24:27], v[164:167]
    v_mfma_f32_16x16x32_bf16 v[188:191], a[116:119], a[28:31], v[188:191]
    ds_read_b128 a[96:99], v5 offset:16384
    v_mfma_f32_16x16x32_bf16 v[212:215], a[116:119], a[32:35], v[212:215]
    buffer_load_dwordx4 a[12:15], v2, s[40:43], s35 offen offset:3072 sc1
    v_mfma_f32_16x16x32_bf16 v[144:147], a[120:123], a[20:23], v[144:147]
    ds_read_b128 a[100:103], v5 offset:17408
    v_mfma_f32_16x16x32_bf16 v[168:171], a[120:123], a[24:27], v[168:171]
    v_mfma_f32_16x16x32_bf16 v[192:195], a[120:123], a[28:31], v[192:195]
    buffer_load_dwordx4 a[16:19], v3, s[40:43], s35 offen sc1
    s_add_u32 s35, s35, 4096
    s_and_b32 s35, s35, 0x1ffff
    v_mfma_f32_16x16x32_bf16 v[216:219], a[120:123], a[32:35], v[216:219]
    ds_read_b128 a[104:107], v6 offset:12288
    v_mfma_f32_16x16x32_bf16 v[148:151], a[124:127], a[20:23], v[148:151]
    v_mfma_f32_16x16x32_bf16 v[172:175], a[124:127], a[24:27], v[172:175]
    v_mfma_f32_16x16x32_bf16 v[196:199], a[124:127], a[28:31], v[196:199]
    buffer_load_dwordx2 v[116:117], v14, s[4:7], s37 offen offset:2048 sc1
    v_mfma_f32_16x16x32_bf16 v[220:223], a[124:127], a[32:35], v[220:223]
    v_mfma_f32_16x16x32_bf16 v[152:155], a[128:131], a[20:23], v[152:155]
    v_mfma_f32_16x16x32_bf16 v[176:179], a[128:131], a[24:27], v[176:179]
    buffer_load_dwordx2 v[118:119], v14, s[4:7], s37 offen offset:2176 sc1
    v_mfma_f32_16x16x32_bf16 v[200:203], a[128:131], a[28:31], v[200:203]
    v_mfma_f32_16x16x32_bf16 v[224:227], a[128:131], a[32:35], v[224:227]
    v_mfma_f32_16x16x32_bf16 v[228:231], a[132:135], a[36:39], v[228:231]
    s_waitcnt vmcnt(17) lgkmcnt(0)
    v_mfma_f32_16x16x32_bf16 v[132:135], a[80:83], a[40:43], v[132:135]
    ds_read_b128 a[108:111], v5 offset:18432
    v_mfma_f32_16x16x32_bf16 v[156:159], a[80:83], a[44:47], v[156:159]
    buffer_load_dwordx4 a[20:23], v2, s[40:43], s35 offen offset:0 sc1
    v_mfma_f32_16x16x32_bf16 v[180:183], a[80:83], a[48:51], v[180:183]
    ds_read_b128 a[112:115], v5 offset:19456
    v_mfma_f32_16x16x32_bf16 v[204:207], a[80:83], a[52:55], v[204:207]
    v_mfma_f32_16x16x32_bf16 v[136:139], a[84:87], a[40:43], v[136:139]
    buffer_load_dwordx4 a[24:27], v2, s[40:43], s35 offen offset:1024 sc1
    v_mfma_f32_16x16x32_bf16 v[160:163], a[84:87], a[44:47], v[160:163]
    ds_read_b128 a[116:119], v5 offset:20480
    v_mfma_f32_16x16x32_bf16 v[184:187], a[84:87], a[48:51], v[184:187]
    v_mfma_f32_16x16x32_bf16 v[208:211], a[84:87], a[52:55], v[208:211]
    ds_read_b128 a[120:123], v5 offset:21504
    buffer_load_dwordx4 a[28:31], v2, s[40:43], s35 offen offset:2048 sc1
    v_mfma_f32_16x16x32_bf16 v[140:143], a[88:91], a[40:43], v[140:143]
    v_mfma_f32_16x16x32_bf16 v[164:167], a[88:91], a[44:47], v[164:167]
    v_mfma_f32_16x16x32_bf16 v[188:191], a[88:91], a[48:51], v[188:191]
    ds_read_b128 a[124:127], v5 offset:22528
    v_mfma_f32_16x16x32_bf16 v[212:215], a[88:91], a[52:55], v[212:215]
    buffer_load_dwordx4 a[32:35], v2, s[40:43], s35 offen offset:3072 sc1
    v_mfma_f32_16x16x32_bf16 v[144:147], a[92:95], a[40:43], v[144:147]
    ds_read_b128 a[128:131], v5 offset:23552
    v_mfma_f32_16x16x32_bf16 v[168:171], a[92:95], a[44:47], v[168:171]
    v_mfma_f32_16x16x32_bf16 v[192:195], a[92:95], a[48:51], v[192:195]
    buffer_load_dwordx4 a[36:39], v3, s[40:43], s35 offen sc1
    s_add_u32 s35, s35, 4096
    s_and_b32 s35, s35, 0x1ffff
    v_mfma_f32_16x16x32_bf16 v[216:219], a[92:95], a[52:55], v[216:219]
    ds_read_b128 a[132:135], v6 offset:18432
    v_mfma_f32_16x16x32_bf16 v[148:151], a[96:99], a[40:43], v[148:151]
    v_mfma_f32_16x16x32_bf16 v[172:175], a[96:99], a[44:47], v[172:175]
    v_mfma_f32_16x16x32_bf16 v[196:199], a[96:99], a[48:51], v[196:199]
    buffer_load_dwordx2 v[120:121], v14, s[4:7], s37 offen offset:2304 sc1
    v_mfma_f32_16x16x32_bf16 v[220:223], a[96:99], a[52:55], v[220:223]
    v_mfma_f32_16x16x32_bf16 v[152:155], a[100:103], a[40:43], v[152:155]
    v_mfma_f32_16x16x32_bf16 v[176:179], a[100:103], a[44:47], v[176:179]
    buffer_load_dwordx2 v[122:123], v14, s[4:7], s37 offen offset:2432 sc1
    v_mfma_f32_16x16x32_bf16 v[200:203], a[100:103], a[48:51], v[200:203]
    v_mfma_f32_16x16x32_bf16 v[224:227], a[100:103], a[52:55], v[224:227]
    v_mfma_f32_16x16x32_bf16 v[228:231], a[104:107], a[56:59], v[228:231]
    s_waitcnt vmcnt(17) lgkmcnt(0)
    v_mfma_f32_16x16x32_bf16 v[132:135], a[108:111], a[60:63], v[132:135]
    ds_read_b128 a[80:83], v5 offset:24576
    v_mfma_f32_16x16x32_bf16 v[156:159], a[108:111], a[64:67], v[156:159]
    buffer_load_dwordx4 a[40:43], v2, s[40:43], s35 offen offset:0 sc1
    v_mfma_f32_16x16x32_bf16 v[180:183], a[108:111], a[68:71], v[180:183]
    ds_read_b128 a[84:87], v5 offset:25600
    v_mfma_f32_16x16x32_bf16 v[204:207], a[108:111], a[72:75], v[204:207]
    v_mfma_f32_16x16x32_bf16 v[136:139], a[112:115], a[60:63], v[136:139]
    buffer_load_dwordx4 a[44:47], v2, s[40:43], s35 offen offset:1024 sc1
    v_mfma_f32_16x16x32_bf16 v[160:163], a[112:115], a[64:67], v[160:163]
    ds_read_b128 a[88:91], v5 offset:26624
    v_mfma_f32_16x16x32_bf16 v[184:187], a[112:115], a[68:71], v[184:187]
    v_mfma_f32_16x16x32_bf16 v[208:211], a[112:115], a[72:75], v[208:211]
    ds_read_b128 a[92:95], v5 offset:27648
    buffer_load_dwordx4 a[48:51], v2, s[40:43], s35 offen offset:2048 sc1
    v_mfma_f32_16x16x32_bf16 v[140:143], a[116:119], a[60:63], v[140:143]
    v_mfma_f32_16x16x32_bf16 v[164:167], a[116:119], a[64:67], v[164:167]
    v_mfma_f32_16x16x32_bf16 v[188:191], a[116:119], a[68:71], v[188:191]
    ds_read_b128 a[96:99], v5 offset:28672
    v_mfma_f32_16x16x32_bf16 v[212:215], a[116:119], a[72:75], v[212:215]
    buffer_load_dwordx4 a[52:55], v2, s[40:43], s35 offen offset:3072 sc1
    v_mfma_f32_16x16x32_bf16 v[144:147], a[120:123], a[60:63], v[144:147]
    ds_read_b128 a[100:103], v5 offset:29696
    v_mfma_f32_16x16x32_bf16 v[168:171], a[120:123], a[64:67], v[168:171]
    v_mfma_f32_16x16x32_bf16 v[192:195], a[120:123], a[68:71], v[192:195]
    buffer_load_dwordx4 a[56:59], v3, s[40:43], s35 offen sc1
    s_add_u32 s35, s35, 4096
    s_and_b32 s35, s35, 0x1ffff
    v_mfma_f32_16x16x32_bf16 v[216:219], a[120:123], a[72:75], v[216:219]
    ds_read_b128 a[104:107], v6 offset:24576
    v_mfma_f32_16x16x32_bf16 v[148:151], a[124:127], a[60:63], v[148:151]
    v_mfma_f32_16x16x32_bf16 v[172:175], a[124:127], a[64:67], v[172:175]
    v_mfma_f32_16x16x32_bf16 v[196:199], a[124:127], a[68:71], v[196:199]
    buffer_load_dwordx2 v[124:125], v15, s[4:7], s36 offen offset:0 sc1
    v_mfma_f32_16x16x32_bf16 v[220:223], a[124:127], a[72:75], v[220:223]
    v_mfma_f32_16x16x32_bf16 v[152:155], a[128:131], a[60:63], v[152:155]
    v_mfma_f32_16x16x32_bf16 v[176:179], a[128:131], a[64:67], v[176:179]
    buffer_load_dwordx2 v[126:127], v15, s[4:7], s36 offen offset:128 sc1
    v_mfma_f32_16x16x32_bf16 v[200:203], a[128:131], a[68:71], v[200:203]
    v_mfma_f32_16x16x32_bf16 v[224:227], a[128:131], a[72:75], v[224:227]
    v_mfma_f32_16x16x32_bf16 v[228:231], a[132:135], a[76:79], v[228:231]
    s_waitcnt vmcnt(16) lgkmcnt(0)
    v_mfma_f32_16x16x32_bf16 v[132:135], a[80:83], a[0:3], v[132:135]
    ds_read_b128 a[108:111], v5 offset:30720
    v_mfma_f32_16x16x32_bf16 v[156:159], a[80:83], a[4:7], v[156:159]
    buffer_load_dwordx4 a[60:63], v2, s[40:43], s35 offen offset:0 sc1
    v_mfma_f32_16x16x32_bf16 v[180:183], a[80:83], a[8:11], v[180:183]
    ds_read_b128 a[112:115], v5 offset:31744
    v_mfma_f32_16x16x32_bf16 v[204:207], a[80:83], a[12:15], v[204:207]
    v_mfma_f32_16x16x32_bf16 v[136:139], a[84:87], a[0:3], v[136:139]
    buffer_load_dwordx4 a[64:67], v2, s[40:43], s35 offen offset:1024 sc1
    v_mfma_f32_16x16x32_bf16 v[160:163], a[84:87], a[4:7], v[160:163]
    ds_read_b128 a[116:119], v5 offset:32768
    v_mfma_f32_16x16x32_bf16 v[184:187], a[84:87], a[8:11], v[184:187]
    v_mfma_f32_16x16x32_bf16 v[208:211], a[84:87], a[12:15], v[208:211]
    ds_read_b128 a[120:123], v5 offset:33792
    buffer_load_dwordx4 a[68:71], v2, s[40:43], s35 offen offset:2048 sc1
    v_mfma_f32_16x16x32_bf16 v[140:143], a[88:91], a[0:3], v[140:143]
    v_mfma_f32_16x16x32_bf16 v[164:167], a[88:91], a[4:7], v[164:167]
    v_mfma_f32_16x16x32_bf16 v[188:191], a[88:91], a[8:11], v[188:191]
    ds_read_b128 a[124:127], v5 offset:34816
    v_mfma_f32_16x16x32_bf16 v[212:215], a[88:91], a[12:15], v[212:215]
    buffer_load_dwordx4 a[72:75], v2, s[40:43], s35 offen offset:3072 sc1
    v_mfma_f32_16x16x32_bf16 v[144:147], a[92:95], a[0:3], v[144:147]
    ds_read_b128 a[128:131], v5 offset:35840
    v_mfma_f32_16x16x32_bf16 v[168:171], a[92:95], a[4:7], v[168:171]
    v_mfma_f32_16x16x32_bf16 v[192:195], a[92:95], a[8:11], v[192:195]
    buffer_load_dwordx4 a[76:79], v3, s[40:43], s35 offen sc1
    s_add_u32 s35, s35, 4096
    s_and_b32 s35, s35, 0x1ffff
    v_mfma_f32_16x16x32_bf16 v[216:219], a[92:95], a[12:15], v[216:219]
    ds_read_b128 a[132:135], v6 offset:30720
    v_mfma_f32_16x16x32_bf16 v[148:151], a[96:99], a[0:3], v[148:151]
    v_mfma_f32_16x16x32_bf16 v[172:175], a[96:99], a[4:7], v[172:175]
    v_mfma_f32_16x16x32_bf16 v[196:199], a[96:99], a[8:11], v[196:199]
    buffer_load_dwordx2 v[128:129], v15, s[4:7], s36 offen offset:256 sc1
    v_mfma_f32_16x16x32_bf16 v[220:223], a[96:99], a[12:15], v[220:223]
    v_mfma_f32_16x16x32_bf16 v[152:155], a[100:103], a[0:3], v[152:155]
    v_mfma_f32_16x16x32_bf16 v[176:179], a[100:103], a[4:7], v[176:179]
    buffer_load_dwordx2 v[130:131], v15, s[4:7], s36 offen offset:384 sc1
    v_mfma_f32_16x16x32_bf16 v[200:203], a[100:103], a[8:11], v[200:203]
    v_mfma_f32_16x16x32_bf16 v[224:227], a[100:103], a[12:15], v[224:227]
    v_mfma_f32_16x16x32_bf16 v[228:231], a[104:107], a[16:19], v[228:231]
    s_waitcnt vmcnt(16) lgkmcnt(0)
    v_mfma_f32_16x16x32_bf16 v[132:135], a[108:111], a[20:23], v[132:135]
    ds_read_b128 a[80:83], v5 offset:36864
    v_mfma_f32_16x16x32_bf16 v[156:159], a[108:111], a[24:27], v[156:159]
    v_mfma_f32_16x16x32_bf16 v[180:183], a[108:111], a[28:31], v[180:183]
    ds_read_b128 a[84:87], v5 offset:37888
    v_mfma_f32_16x16x32_bf16 v[204:207], a[108:111], a[32:35], v[204:207]
    v_mfma_f32_16x16x32_bf16 v[136:139], a[112:115], a[20:23], v[136:139]
    v_mfma_f32_16x16x32_bf16 v[160:163], a[112:115], a[24:27], v[160:163]
    ds_read_b128 a[88:91], v5 offset:38912
    v_mfma_f32_16x16x32_bf16 v[184:187], a[112:115], a[28:31], v[184:187]
    v_mfma_f32_16x16x32_bf16 v[208:211], a[112:115], a[32:35], v[208:211]
    ds_read_b128 a[92:95], v5 offset:39936
    v_mfma_f32_16x16x32_bf16 v[140:143], a[116:119], a[20:23], v[140:143]
    v_mfma_f32_16x16x32_bf16 v[164:167], a[116:119], a[24:27], v[164:167]
    v_mfma_f32_16x16x32_bf16 v[188:191], a[116:119], a[28:31], v[188:191]
    ds_read_b128 a[96:99], v5 offset:40960
    v_mfma_f32_16x16x32_bf16 v[212:215], a[116:119], a[32:35], v[212:215]
    v_mfma_f32_16x16x32_bf16 v[144:147], a[120:123], a[20:23], v[144:147]
    ds_read_b128 a[100:103], v5 offset:41984
    v_mfma_f32_16x16x32_bf16 v[168:171], a[120:123], a[24:27], v[168:171]
    v_mfma_f32_16x16x32_bf16 v[192:195], a[120:123], a[28:31], v[192:195]
    v_mfma_f32_16x16x32_bf16 v[216:219], a[120:123], a[32:35], v[216:219]
    ds_read_b128 a[104:107], v6 offset:36864
    v_mfma_f32_16x16x32_bf16 v[148:151], a[124:127], a[20:23], v[148:151]
    v_mfma_f32_16x16x32_bf16 v[172:175], a[124:127], a[24:27], v[172:175]
    v_mfma_f32_16x16x32_bf16 v[196:199], a[124:127], a[28:31], v[196:199]
    v_mfma_f32_16x16x32_bf16 v[220:223], a[124:127], a[32:35], v[220:223]
    v_mfma_f32_16x16x32_bf16 v[152:155], a[128:131], a[20:23], v[152:155]
    v_mfma_f32_16x16x32_bf16 v[176:179], a[128:131], a[24:27], v[176:179]
    v_mfma_f32_16x16x32_bf16 v[200:203], a[128:131], a[28:31], v[200:203]
    v_mfma_f32_16x16x32_bf16 v[224:227], a[128:131], a[32:35], v[224:227]
    v_mfma_f32_16x16x32_bf16 v[228:231], a[132:135], a[36:39], v[228:231]
    s_waitcnt vmcnt(9) lgkmcnt(0)
    v_mfma_f32_16x16x32_bf16 v[132:135], a[80:83], a[40:43], v[132:135]
    ds_read_b128 a[108:111], v5 offset:43008
    v_mfma_f32_16x16x32_bf16 v[156:159], a[80:83], a[44:47], v[156:159]
    v_mfma_f32_16x16x32_bf16 v[180:183], a[80:83], a[48:51], v[180:183]
    ds_read_b128 a[112:115], v5 offset:44032
    v_mfma_f32_16x16x32_bf16 v[204:207], a[80:83], a[52:55], v[204:207]
    v_mfma_f32_16x16x32_bf16 v[136:139], a[84:87], a[40:43], v[136:139]
    v_mfma_f32_16x16x32_bf16 v[160:163], a[84:87], a[44:47], v[160:163]
    ds_read_b128 a[116:119], v5 offset:45056
    v_mfma_f32_16x16x32_bf16 v[184:187], a[84:87], a[48:51], v[184:187]
    v_mfma_f32_16x16x32_bf16 v[208:211], a[84:87], a[52:55], v[208:211]
    ds_read_b128 a[120:123], v5 offset:46080
    v_mfma_f32_16x16x32_bf16 v[140:143], a[88:91], a[40:43], v[140:143]
    v_mfma_f32_16x16x32_bf16 v[164:167], a[88:91], a[44:47], v[164:167]
    v_mfma_f32_16x16x32_bf16 v[188:191], a[88:91], a[48:51], v[188:191]
    ds_read_b128 a[124:127], v5 offset:47104
    v_mfma_f32_16x16x32_bf16 v[212:215], a[88:91], a[52:55], v[212:215]
    v_mfma_f32_16x16x32_bf16 v[144:147], a[92:95], a[40:43], v[144:147]
    ds_read_b128 a[128:131], v5 offset:48128
    v_mfma_f32_16x16x32_bf16 v[168:171], a[92:95], a[44:47], v[168:171]
    v_mfma_f32_16x16x32_bf16 v[192:195], a[92:95], a[48:51], v[192:195]
    v_mfma_f32_16x16x32_bf16 v[216:219], a[92:95], a[52:55], v[216:219]
    ds_read_b128 a[132:135], v6 offset:43008
    v_mfma_f32_16x16x32_bf16 v[148:151], a[96:99], a[40:43], v[148:151]
    v_mfma_f32_16x16x32_bf16 v[172:175], a[96:99], a[44:47], v[172:175]
    v_mfma_f32_16x16x32_bf16 v[196:199], a[96:99], a[48:51], v[196:199]
    v_mfma_f32_16x16x32_bf16 v[220:223], a[96:99], a[52:55], v[220:223]
    v_mfma_f32_16x16x32_bf16 v[152:155], a[100:103], a[40:43], v[152:155]
    v_mfma_f32_16x16x32_bf16 v[176:179], a[100:103], a[44:47], v[176:179]
    v_mfma_f32_16x16x32_bf16 v[200:203], a[100:103], a[48:51], v[200:203]
    v_mfma_f32_16x16x32_bf16 v[224:227], a[100:103], a[52:55], v[224:227]
    v_mfma_f32_16x16x32_bf16 v[228:231], a[104:107], a[56:59], v[228:231]
    s_waitcnt vmcnt(2) lgkmcnt(0)
    s_barrier
    v_mfma_f32_16x16x32_bf16 v[132:135], a[108:111], a[60:63], v[132:135]
    v_mfma_f32_16x16x32_bf16 v[156:159], a[108:111], a[64:67], v[156:159]
    v_mfma_f32_16x16x32_bf16 v[180:183], a[108:111], a[68:71], v[180:183]
    v_mfma_f32_16x16x32_bf16 v[204:207], a[108:111], a[72:75], v[204:207]
    v_mfma_f32_16x16x32_bf16 v[136:139], a[112:115], a[60:63], v[136:139]
    v_mfma_f32_16x16x32_bf16 v[160:163], a[112:115], a[64:67], v[160:163]
    v_mfma_f32_16x16x32_bf16 v[184:187], a[112:115], a[68:71], v[184:187]
    v_mfma_f32_16x16x32_bf16 v[208:211], a[112:115], a[72:75], v[208:211]
    v_mfma_f32_16x16x32_bf16 v[140:143], a[116:119], a[60:63], v[140:143]
    v_mfma_f32_16x16x32_bf16 v[164:167], a[116:119], a[64:67], v[164:167]
    v_mfma_f32_16x16x32_bf16 v[188:191], a[116:119], a[68:71], v[188:191]
    v_mfma_f32_16x16x32_bf16 v[212:215], a[116:119], a[72:75], v[212:215]
    v_mfma_f32_16x16x32_bf16 v[144:147], a[120:123], a[60:63], v[144:147]
    v_mfma_f32_16x16x32_bf16 v[168:171], a[120:123], a[64:67], v[168:171]
    v_mfma_f32_16x16x32_bf16 v[192:195], a[120:123], a[68:71], v[192:195]
    v_mfma_f32_16x16x32_bf16 v[216:219], a[120:123], a[72:75], v[216:219]
    v_mfma_f32_16x16x32_bf16 v[148:151], a[124:127], a[60:63], v[148:151]
    v_mfma_f32_16x16x32_bf16 v[172:175], a[124:127], a[64:67], v[172:175]
    v_mfma_f32_16x16x32_bf16 v[196:199], a[124:127], a[68:71], v[196:199]
    v_mfma_f32_16x16x32_bf16 v[220:223], a[124:127], a[72:75], v[220:223]
    v_mfma_f32_16x16x32_bf16 v[152:155], a[128:131], a[60:63], v[152:155]
    v_mfma_f32_16x16x32_bf16 v[176:179], a[128:131], a[64:67], v[176:179]
    v_mfma_f32_16x16x32_bf16 v[200:203], a[128:131], a[68:71], v[200:203]
    v_mfma_f32_16x16x32_bf16 v[224:227], a[128:131], a[72:75], v[224:227]
    v_mfma_f32_16x16x32_bf16 v[228:231], a[132:135], a[76:79], v[228:231]
    v_pk_add_f32 v[92:93], v[92:93], v[94:95]
    v_pk_add_f32 v[96:97], v[96:97], v[98:99]
    v_pk_add_f32 v[100:101], v[100:101], v[102:103]
    v_pk_add_f32 v[104:105], v[104:105], v[106:107]
    v_pk_add_f32 v[108:109], v[108:109], v[110:111]
    v_pk_add_f32 v[112:113], v[112:113], v[114:115]
    v_pk_add_f32 v[116:117], v[116:117], v[118:119]
    v_pk_add_f32 v[120:121], v[120:121], v[122:123]
    v_pk_add_f32 v[124:125], v[124:125], v[126:127]
    s_waitcnt vmcnt(0)
    v_pk_add_f32 v[128:129], v[128:129], v[130:131]
    v_pk_add_f32 v[92:93], v[92:93], v[96:97]
    v_pk_add_f32 v[100:101], v[100:101], v[104:105]
    v_pk_add_f32 v[108:109], v[108:109], v[112:113]
    v_pk_add_f32 v[116:117], v[116:117], v[120:121]
    v_pk_add_f32 v[124:125], v[124:125], v[128:129]
    v_permlane32_swap_b32 v92, v93
    v_permlane32_swap_b32 v100, v101
    v_permlane32_swap_b32 v108, v109
    v_permlane32_swap_b32 v116, v117
    v_permlane32_swap_b32 v124, v125
    v_add_f32 v92, v92, v93
    v_add_f32 v100, v100, v101
    v_add_f32 v108, v108, v109
    v_add_f32 v116, v116, v117
    v_add_f32 v124, v124, v125
    v_mov_b32 v94, v92
    v_mov_b32 v102, v100
    v_mov_b32 v110, v108
    v_mov_b32 v118, v116
    v_mov_b32 v126, v124
    v_permlane16_swap_b32 v92, v94
    v_permlane16_swap_b32 v100, v102
    v_permlane16_swap_b32 v108, v110
    v_permlane16_swap_b32 v116, v118
    v_permlane16_swap_b32 v124, v126
    v_add_f32 v92, v92, v94
    v_add_f32 v100, v100, v102
    v_add_f32 v108, v108, v110
    v_add_f32 v116, v116, v118
    v_add_f32 v124, v124, v126
    v_mov_b32 v94, v92
    v_mov_b32 v102, v100
    v_mov_b32 v110, v108
    v_mov_b32 v118, v116
    v_mov_b32 v126, v124
    v_permlane32_swap_b32 v92, v94
    v_permlane32_swap_b32 v100, v102
    v_permlane32_swap_b32 v108, v110
    v_permlane32_swap_b32 v116, v118
    v_permlane32_swap_b32 v124, v126
    v_mul_f32 v82, 0xba800000, v92
    v_mul_f32 v94, 0x3a800000, v94
    v_mul_f32 v84, 0xba800000, v100
    v_mul_f32 v102, 0x3a800000, v102
    v_mul_f32 v86, 0xba800000, v108
    v_mul_f32 v110, 0x3a800000, v110
    v_mul_f32 v88, 0xba800000, v116
    v_mul_f32 v118, 0x3a800000, v118
    v_mul_f32 v90, 0xba800000, v124
    v_mul_f32 v126, 0x3a800000, v126
    v_fma_f32 v94, -v82, v82, v94
    v_fma_f32 v102, -v84, v84, v102
    v_fma_f32 v110, -v86, v86, v110
    v_fma_f32 v118, -v88, v88, v118
    v_fma_f32 v126, -v90, v90, v126
    v_max_f32 v94, 0, v94
    v_max_f32 v102, 0, v102
    v_max_f32 v110, 0, v110
    v_max_f32 v118, 0, v118
    v_max_f32 v126, 0, v126
    v_add_f32 v94, 0x3727c5ac, v94
    v_add_f32 v102, 0x3727c5ac, v102
    v_add_f32 v110, 0x3727c5ac, v110
    v_add_f32 v118, 0x3727c5ac, v118
    v_add_f32 v126, 0x3727c5ac, v126
    v_rsq_f32 v83, v94
    v_rsq_f32 v85, v102
    v_rsq_f32 v87, v110
    v_rsq_f32 v89, v118
    v_rsq_f32 v91, v126
    v_pk_fma_f32 v[212:213], v[56:57], v[88:89], v[212:213] op_sel:[0,0,0] op_sel_hi:[1,0,1]
    v_pk_fma_f32 v[220:221], v[64:65], v[88:89], v[220:221] op_sel:[0,0,0] op_sel_hi:[1,0,1]
    v_pk_fma_f32 v[196:197], v[64:65], v[86:87], v[196:197] op_sel:[0,0,0] op_sel_hi:[1,0,1]
    v_pk_fma_f32 v[172:173], v[64:65], v[84:85], v[172:173] op_sel:[0,0,0] op_sel_hi:[1,0,1]
    v_pk_fma_f32 v[148:149], v[64:65], v[82:83], v[148:149] op_sel:[0,0,0] op_sel_hi:[1,0,1]
    v_pk_fma_f32 v[228:229], v[72:73], v[90:91], v[228:229] op_sel:[0,0,0] op_sel_hi:[1,0,1]
    v_pk_fma_f32 v[214:215], v[58:59], v[88:89], v[214:215] op_sel:[0,0,0] op_sel_hi:[1,0,1]
    v_pk_fma_f32 v[222:223], v[66:67], v[88:89], v[222:223] op_sel:[0,0,0] op_sel_hi:[1,0,1]
    v_pk_fma_f32 v[198:199], v[66:67], v[86:87], v[198:199] op_sel:[0,0,0] op_sel_hi:[1,0,1]
    v_pk_fma_f32 v[174:175], v[66:67], v[84:85], v[174:175] op_sel:[0,0,0] op_sel_hi:[1,0,1]
    v_pk_fma_f32 v[150:151], v[66:67], v[82:83], v[150:151] op_sel:[0,0,0] op_sel_hi:[1,0,1]
    v_pk_fma_f32 v[230:231], v[74:75], v[90:91], v[230:231] op_sel:[0,0,0] op_sel_hi:[1,0,1]
    v_pk_fma_f32 v[216:217], v[60:61], v[88:89], v[216:217] op_sel:[0,0,0] op_sel_hi:[1,0,1]
    v_pk_fma_f32 v[218:219], v[62:63], v[88:89], v[218:219] op_sel:[0,0,0] op_sel_hi:[1,0,1]
    v_pk_fma_f32 v[224:225], v[68:69], v[88:89], v[224:225] op_sel:[0,0,0] op_sel_hi:[1,0,1]
    v_pk_fma_f32 v[226:227], v[70:71], v[88:89], v[226:227] op_sel:[0,0,0] op_sel_hi:[1,0,1]
    v_pk_fma_f32 v[200:201], v[68:69], v[86:87], v[200:201] op_sel:[0,0,0] op_sel_hi:[1,0,1]
    v_pk_fma_f32 v[202:203], v[70:71], v[86:87], v[202:203] op_sel:[0,0,0] op_sel_hi:[1,0,1]
    v_pk_fma_f32 v[176:177], v[68:69], v[84:85], v[176:177] op_sel:[0,0,0] op_sel_hi:[1,0,1]
    v_pk_fma_f32 v[178:179], v[70:71], v[84:85], v[178:179] op_sel:[0,0,0] op_sel_hi:[1,0,1]
    v_pk_fma_f32 v[152:153], v[68:69], v[82:83], v[152:153] op_sel:[0,0,0] op_sel_hi:[1,0,1]
    v_pk_fma_f32 v[154:155], v[70:71], v[82:83], v[154:155] op_sel:[0,0,0] op_sel_hi:[1,0,1]
    v_pk_mul_f32 v[212:213], v[212:213], v[88:89] op_sel:[0,1] op_sel_hi:[1,1]
    v_pk_mul_f32 v[220:221], v[220:221], v[88:89] op_sel:[0,1] op_sel_hi:[1,1]
    v_pk_mul_f32 v[196:197], v[196:197], v[86:87] op_sel:[0,1] op_sel_hi:[1,1]
    v_pk_mul_f32 v[172:173], v[172:173], v[84:85] op_sel:[0,1] op_sel_hi:[1,1]
    v_pk_mul_f32 v[148:149], v[148:149], v[82:83] op_sel:[0,1] op_sel_hi:[1,1]
    v_pk_fma_f32 v[188:189], v[56:57], v[86:87], v[188:189] op_sel:[0,0,0] op_sel_hi:[1,0,1]
    v_pk_fma_f32 v[164:165], v[56:57], v[84:85], v[164:165] op_sel:[0,0,0] op_sel_hi:[1,0,1]
    v_pk_fma_f32 v[140:141], v[56:57], v[82:83], v[140:141] op_sel:[0,0,0] op_sel_hi:[1,0,1]
    v_pk_mul_f32 v[228:229], v[228:229], v[90:91] op_sel:[0,1] op_sel_hi:[1,1]
    v_pk_mul_f32 v[214:215], v[214:215], v[88:89] op_sel:[0,1] op_sel_hi:[1,1]
    v_pk_mul_f32 v[222:223], v[222:223], v[88:89] op_sel:[0,1] op_sel_hi:[1,1]
    v_pk_mul_f32 v[198:199], v[198:199], v[86:87] op_sel:[0,1] op_sel_hi:[1,1]
    v_pk_mul_f32 v[174:175], v[174:175], v[84:85] op_sel:[0,1] op_sel_hi:[1,1]
    v_pk_mul_f32 v[150:151], v[150:151], v[82:83] op_sel:[0,1] op_sel_hi:[1,1]
    s_lshl_b32 s36, s28, 12
    v_pk_fma_f32 v[190:191], v[58:59], v[86:87], v[190:191] op_sel:[0,0,0] op_sel_hi:[1,0,1]
    v_pk_fma_f32 v[166:167], v[58:59], v[84:85], v[166:167] op_sel:[0,0,0] op_sel_hi:[1,0,1]
    v_pk_fma_f32 v[142:143], v[58:59], v[82:83], v[142:143] op_sel:[0,0,0] op_sel_hi:[1,0,1]
    v_pk_mul_f32 v[230:231], v[230:231], v[90:91] op_sel:[0,1] op_sel_hi:[1,1]
    v_pk_mul_f32 v[216:217], v[216:217], v[88:89] op_sel:[0,1] op_sel_hi:[1,1]
    v_pk_mul_f32 v[218:219], v[218:219], v[88:89] op_sel:[0,1] op_sel_hi:[1,1]
    v_pk_mul_f32 v[224:225], v[224:225], v[88:89] op_sel:[0,1] op_sel_hi:[1,1]
    v_pk_mul_f32 v[226:227], v[226:227], v[88:89] op_sel:[0,1] op_sel_hi:[1,1]
    v_pk_mul_f32 v[200:201], v[200:201], v[86:87] op_sel:[0,1] op_sel_hi:[1,1]
    v_pk_mul_f32 v[202:203], v[202:203], v[86:87] op_sel:[0,1] op_sel_hi:[1,1]
    v_pk_mul_f32 v[176:177], v[176:177], v[84:85] op_sel:[0,1] op_sel_hi:[1,1]
    v_pk_mul_f32 v[178:179], v[178:179], v[84:85] op_sel:[0,1] op_sel_hi:[1,1]
    v_pk_mul_f32 v[152:153], v[152:153], v[82:83] op_sel:[0,1] op_sel_hi:[1,1]
    v_pk_mul_f32 v[154:155], v[154:155], v[82:83] op_sel:[0,1] op_sel_hi:[1,1]
    v_cvt_pk_bf16_f32 v212, v212, v213
    v_cvt_pk_bf16_f32 v220, v220, v221
    v_cvt_pk_bf16_f32 v196, v196, v197
    v_cvt_pk_bf16_f32 v172, v172, v173
    v_cvt_pk_bf16_f32 v148, v148, v149
    s_lshl_b32 s37, s28, 10
    v_pk_fma_f32 v[192:193], v[60:61], v[86:87], v[192:193] op_sel:[0,0,0] op_sel_hi:[1,0,1]
    v_pk_fma_f32 v[194:195], v[62:63], v[86:87], v[194:195] op_sel:[0,0,0] op_sel_hi:[1,0,1]
    v_pk_fma_f32 v[168:169], v[60:61], v[84:85], v[168:169] op_sel:[0,0,0] op_sel_hi:[1,0,1]
    v_pk_fma_f32 v[170:171], v[62:63], v[84:85], v[170:171] op_sel:[0,0,0] op_sel_hi:[1,0,1]
    v_pk_fma_f32 v[144:145], v[60:61], v[82:83], v[144:145] op_sel:[0,0,0] op_sel_hi:[1,0,1]
    v_pk_fma_f32 v[146:147], v[62:63], v[82:83], v[146:147] op_sel:[0,0,0] op_sel_hi:[1,0,1]
    v_pk_mul_f32 v[188:189], v[188:189], v[86:87] op_sel:[0,1] op_sel_hi:[1,1]
    v_pk_mul_f32 v[164:165], v[164:165], v[84:85] op_sel:[0,1] op_sel_hi:[1,1]
    v_pk_mul_f32 v[140:141], v[140:141], v[82:83] op_sel:[0,1] op_sel_hi:[1,1]
    v_cvt_pk_bf16_f32 v228, v228, v229
    v_cvt_pk_bf16_f32 v213, v214, v215
    v_cvt_pk_bf16_f32 v221, v222, v223
    v_cvt_pk_bf16_f32 v197, v198, v199
    v_cvt_pk_bf16_f32 v173, v174, v175
    v_cvt_pk_bf16_f32 v149, v150, v151
    v_pk_mul_f32 v[190:191], v[190:191], v[86:87] op_sel:[0,1] op_sel_hi:[1,1]
    v_pk_mul_f32 v[166:167], v[166:167], v[84:85] op_sel:[0,1] op_sel_hi:[1,1]
    v_pk_mul_f32 v[142:143], v[142:143], v[82:83] op_sel:[0,1] op_sel_hi:[1,1]
    v_add_u32 v232, s36, v7
    v_add_u32 v233, s37, v1
    v_cvt_pk_bf16_f32 v229, v230, v231
    v_cvt_pk_bf16_f32 v214, v216, v217
    v_cvt_pk_bf16_f32 v215, v218, v219
    v_cvt_pk_bf16_f32 v222, v224, v225
    v_cvt_pk_bf16_f32 v223, v226, v227
    v_cvt_pk_bf16_f32 v198, v200, v201
    v_cvt_pk_bf16_f32 v199, v202, v203
    v_cvt_pk_bf16_f32 v174, v176, v177
    v_cvt_pk_bf16_f32 v175, v178, v179
    v_cvt_pk_bf16_f32 v150, v152, v153
    v_cvt_pk_bf16_f32 v151, v154, v155
    v_pk_mul_f32 v[192:193], v[192:193], v[86:87] op_sel:[0,1] op_sel_hi:[1,1]
    v_pk_mul_f32 v[194:195], v[194:195], v[86:87] op_sel:[0,1] op_sel_hi:[1,1]
    v_pk_mul_f32 v[168:169], v[168:169], v[84:85] op_sel:[0,1] op_sel_hi:[1,1]
    v_pk_mul_f32 v[170:171], v[170:171], v[84:85] op_sel:[0,1] op_sel_hi:[1,1]
    v_pk_mul_f32 v[144:145], v[144:145], v[82:83] op_sel:[0,1] op_sel_hi:[1,1]
    v_pk_mul_f32 v[146:147], v[146:147], v[82:83] op_sel:[0,1] op_sel_hi:[1,1]
    v_cvt_pk_bf16_f32 v188, v188, v189
    v_cvt_pk_bf16_f32 v164, v164, v165
    v_cvt_pk_bf16_f32 v140, v140, v141
    v_cvt_pk_bf16_f32 v189, v190, v191
    v_cvt_pk_bf16_f32 v165, v166, v167
    v_cvt_pk_bf16_f32 v141, v142, v143
    ds_write_b64 v9, v[228:229]
    ds_write_b64 v232, v[220:221] offset:4096
    ds_write_b64 v232, v[222:223] offset:4608
    ds_write_b64 v232, v[196:197] offset:3072
    ds_write_b64 v232, v[198:199] offset:3584
    ds_write_b64 v232, v[172:173] offset:2048
    ds_write_b64 v232, v[174:175] offset:2560
    ds_write_b64 v232, v[148:149] offset:1024
    ds_write_b64 v232, v[150:151] offset:1536
    ds_write_b128 v233, v[212:215] offset:21504
    v_cvt_pk_bf16_f32 v190, v192, v193
    v_cvt_pk_bf16_f32 v191, v194, v195
    v_cvt_pk_bf16_f32 v166, v168, v169
    v_cvt_pk_bf16_f32 v167, v170, v171
    v_cvt_pk_bf16_f32 v142, v144, v145
    v_cvt_pk_bf16_f32 v143, v146, v147
    s_waitcnt lgkmcnt(0)
    s_barrier
    ds_read_b128 a[0:3], v233 offset:20480
    v_pk_fma_f32 v[132:133], v[48:49], v[82:83], v[132:133] op_sel:[0,0,0] op_sel_hi:[1,0,1]
    v_pk_fma_f32 v[156:157], v[48:49], v[84:85], v[156:157] op_sel:[0,0,0] op_sel_hi:[1,0,1]
    v_pk_fma_f32 v[134:135], v[50:51], v[82:83], v[134:135] op_sel:[0,0,0] op_sel_hi:[1,0,1]
    v_pk_fma_f32 v[158:159], v[50:51], v[84:85], v[158:159] op_sel:[0,0,0] op_sel_hi:[1,0,1]
    v_pk_fma_f32 v[136:137], v[52:53], v[82:83], v[136:137] op_sel:[0,0,0] op_sel_hi:[1,0,1]
    v_pk_fma_f32 v[138:139], v[54:55], v[82:83], v[138:139] op_sel:[0,0,0] op_sel_hi:[1,0,1]
    v_pk_fma_f32 v[160:161], v[52:53], v[84:85], v[160:161] op_sel:[0,0,0] op_sel_hi:[1,0,1]
    v_pk_fma_f32 v[162:163], v[54:55], v[84:85], v[162:163] op_sel:[0,0,0] op_sel_hi:[1,0,1]
    v_cvt_pk_bf16_f32 v132, v132, v133
    v_cvt_pk_bf16_f32 v156, v156, v157
    v_cvt_pk_bf16_f32 v133, v134, v135
    v_cvt_pk_bf16_f32 v157, v158, v159
    v_pk_fma_f32 v[180:181], v[48:49], v[86:87], v[180:181] op_sel:[0,0,0] op_sel_hi:[1,0,1]
    v_pk_fma_f32 v[204:205], v[48:49], v[88:89], v[204:205] op_sel:[0,0,0] op_sel_hi:[1,0,1]
    v_cvt_pk_bf16_f32 v134, v136, v137
    v_cvt_pk_bf16_f32 v135, v138, v139
    v_cvt_pk_bf16_f32 v158, v160, v161
    v_cvt_pk_bf16_f32 v159, v162, v163
    v_pk_fma_f32 v[182:183], v[50:51], v[86:87], v[182:183] op_sel:[0,0,0] op_sel_hi:[1,0,1]
    v_cvt_pk_bf16_f32 v180, v180, v181
    v_pk_fma_f32 v[206:207], v[50:51], v[88:89], v[206:207] op_sel:[0,0,0] op_sel_hi:[1,0,1]
    v_cvt_pk_bf16_f32 v204, v204, v205
    v_pk_fma_f32 v[184:185], v[52:53], v[86:87], v[184:185] op_sel:[0,0,0] op_sel_hi:[1,0,1]
    v_cvt_pk_bf16_f32 v181, v182, v183
    v_pk_fma_f32 v[186:187], v[54:55], v[86:87], v[186:187] op_sel:[0,0,0] op_sel_hi:[1,0,1]
    v_cvt_pk_bf16_f32 v205, v206, v207
    v_pk_fma_f32 v[208:209], v[52:53], v[88:89], v[208:209] op_sel:[0,0,0] op_sel_hi:[1,0,1]
    v_cvt_pk_bf16_f32 v182, v184, v185
    v_pk_fma_f32 v[210:211], v[54:55], v[88:89], v[210:211] op_sel:[0,0,0] op_sel_hi:[1,0,1]
    v_cvt_pk_bf16_f32 v183, v186, v187
    s_waitcnt lgkmcnt(0)
    v_mfma_f32_16x16x32_bf16 v[136:139], a[0:3], v[132:135], v[76:79]
    v_cvt_pk_bf16_f32 v206, v208, v209
    v_cvt_pk_bf16_f32 v207, v210, v211
    v_mfma_f32_16x16x32_bf16 v[152:155], v[140:143], v[132:135], v[24:27]
    v_add_u32 v234, s36, v8
    v_mul_f32 v82, 0x3e8293ee, v83
    v_mfma_f32_16x16x32_bf16 v[160:163], v[140:143], v[156:159], v[20:23]
    ds_read_b64_tr_b16 a[4:5], v234 offset:0
    ds_read_b64_tr_b16 a[6:7], v234 offset:1024
    v_mfma_f32_16x16x32_bf16 v[176:179], v[164:167], v[156:159], v[24:27]
    v_mul_f32 v84, 0x3e8293ee, v85
    s_nop 0
    v_max_f32 v152, v152, v136
    v_mfma_f32_16x16x32_bf16 v[184:187], v[164:167], v[180:183], v[20:23]
    v_max_f32 v153, v153, v137
    v_max_f32 v154, v154, v138
    v_mfma_f32_16x16x32_bf16 v[200:203], v[188:191], v[180:183], v[24:27]
    v_max_f32 v155, v155, v139
    v_max_f32 v176, v176, v160
    v_mfma_f32_16x16x32_bf16 v[208:211], v[188:191], v[204:207], v[20:23]
    v_max_f32 v177, v177, v161
    v_max_f32 v178, v178, v162
    v_mfma_f32_16x16x32_bf16 v[224:227], v[212:215], v[204:207], v[24:27]
    v_max3_f32 v236, v152, v153, v154
    v_max_f32 v179, v179, v163
    v_max3_f32 v237, v176, v177, v178
    v_max_f32 v200, v200, v184
    v_max_f32 v201, v201, v185
    v_max_f32 v202, v202, v186
    v_max_f32 v236, v236, v155
    v_max_f32 v237, v237, v179
    v_max_f32 v203, v203, v187
    v_max_f32 v224, v224, v208
    v_max_f32 v225, v225, v209
    v_max_f32 v226, v226, v210
    v_max3_f32 v238, v200, v201, v202
    v_max_f32 v227, v227, v211
    v_max3_f32 v239, v224, v225, v226
    v_permlane32_swap_b32 v236, v237
    v_max_f32 v238, v238, v203
    v_max_f32 v239, v239, v227
    v_max_f32 v236, v236, v237
    ds_read_b64_tr_b16 a[8:9], v234 offset:2048
    v_permlane32_swap_b32 v238, v239
    v_mov_b32 v240, v236
    v_max_f32 v238, v238, v239
    ds_read_b64_tr_b16 a[16:17], v234 offset:512
    v_permlane16_swap_b32 v236, v240
    v_mov_b32 v241, v238
    v_max_f32 v236, v236, v240
    ds_read_b64_tr_b16 a[18:19], v234 offset:1536
    v_permlane16_swap_b32 v238, v241
    v_mov_b32 v240, v236
    v_max_f32 v238, v238, v241
    v_mul_f32 v86, 0x3e8293ee, v87
    v_permlane32_swap_b32 v236, v240
    v_mov_b32 v241, v238
    v_mul_f32_e64 v83, -v236, v82
    ds_read_b64_tr_b16 a[10:11], v234 offset:3072
    v_permlane32_swap_b32 v238, v241
    v_mul_f32_e64 v85, -v240, v84
    ds_read_b64_tr_b16 a[20:21], v234 offset:2560
    v_pk_fma_f32 v[152:153], v[152:153], v[82:83], v[82:83] op_sel:[0,0,1] op_sel_hi:[1,0,1]
    v_mul_f32 v88, 0x3e8293ee, v89
    v_pk_fma_f32 v[154:155], v[154:155], v[82:83], v[82:83] op_sel:[0,0,1] op_sel_hi:[1,0,1]
    ds_read_b64_tr_b16 a[12:13], v234 offset:4096
    v_mul_f32_e64 v87, -v238, v86
    ds_read_b64_tr_b16 a[22:23], v234 offset:3584
    v_pk_fma_f32 v[176:177], v[176:177], v[84:85], v[84:85] op_sel:[0,0,1] op_sel_hi:[1,0,1]
    v_exp_f32 v152, v152
    v_exp_f32 v153, v153
    v_pk_fma_f32 v[178:179], v[178:179], v[84:85], v[84:85] op_sel:[0,0,1] op_sel_hi:[1,0,1]
    v_mul_f32_e64 v89, -v241, v88
    ds_read_b64_tr_b16 a[24:25], v234 offset:4608
    v_exp_f32 v154, v154
    v_exp_f32 v155, v155
    v_pk_fma_f32 v[200:201], v[200:201], v[86:87], v[86:87] op_sel:[0,0,1] op_sel_hi:[1,0,1]
    v_exp_f32 v176, v176
    v_exp_f32 v177, v177
    v_pk_fma_f32 v[202:203], v[202:203], v[86:87], v[86:87] op_sel:[0,0,1] op_sel_hi:[1,0,1]
    v_exp_f32 v178, v178
    v_exp_f32 v179, v179
    v_pk_fma_f32 v[224:225], v[224:225], v[88:89], v[88:89] op_sel:[0,0,1] op_sel_hi:[1,0,1]
    v_exp_f32 v200, v200
    v_exp_f32 v201, v201
    v_pk_fma_f32 v[226:227], v[226:227], v[88:89], v[88:89] op_sel:[0,0,1] op_sel_hi:[1,0,1]
    v_exp_f32 v202, v202
    v_exp_f32 v203, v203
    v_cvt_pk_bf16_f32 v152, v152, v153
    v_exp_f32 v224, v224
    v_exp_f32 v225, v225
    v_cvt_pk_bf16_f32 v153, v154, v155
    v_exp_f32 v226, v226
    v_exp_f32 v227, v227
    v_cvt_pk_bf16_f32 v176, v176, v177
    v_cvt_pk_bf16_f32 v177, v178, v179
    v_and_b32 v136, v152, v80
    v_and_b32 v137, v153, v81
    v_and_b32 v138, v152, v30
    v_and_b32 v139, v153, v31
    v_cvt_pk_bf16_f32 v200, v200, v201
    v_cvt_pk_bf16_f32 v201, v202, v203
    v_and_b32 v160, v176, v28
    v_and_b32 v161, v177, v29
    v_and_b32 v162, v176, v30
    v_and_b32 v163, v177, v31
    v_cvt_pk_bf16_f32 v224, v224, v225
    v_cvt_pk_bf16_f32 v225, v226, v227
    v_mfma_f32_16x16x32_bf16 v[144:147], v[16:19], v[136:139], 0
    v_and_b32 v184, v200, v28
    v_and_b32 v185, v201, v29
    v_and_b32 v186, v200, v30
    v_and_b32 v187, v201, v31
    v_mfma_f32_16x16x32_bf16 v[168:171], v[16:19], v[160:163], 0
    v_and_b32 v208, v224, v28
    v_and_b32 v209, v225, v29
    v_and_b32 v210, v224, v30
    v_and_b32 v211, v225, v31
    v_mfma_f32_16x16x32_bf16 v[192:195], v[16:19], v[184:187], 0
    v_rcp_f32 v144, v144
    s_waitcnt lgkmcnt(8)
    v_mfma_f32_16x16x32_bf16 v[92:95], a[4:7], v[136:139], 0
    v_rcp_f32 v168, v168
    v_mfma_f32_16x16x32_bf16 v[216:219], v[16:19], v[208:211], 0
    s_lshl_b32 s35, s30, 12
    s_nop 1
    v_rcp_f32 v192, v192
    s_waitcnt lgkmcnt(7)
    v_mfma_f32_16x16x32_bf16 v[100:103], a[6:9], v[160:163], 0
    v_pk_mul_f32 v[92:93], v[92:93], v[144:145] op_sel:[0,0] op_sel_hi:[1,0]
    v_pk_mul_f32 v[94:95], v[94:95], v[144:145] op_sel:[0,0] op_sel_hi:[1,0]
    v_cvt_pk_bf16_f32 v92, v92, v93
    s_waitcnt lgkmcnt(5)
    v_mfma_f32_16x16x32_bf16 v[96:99], a[16:19], v[136:139], 0
    v_rcp_f32 v216, v216
    s_waitcnt lgkmcnt(4)
    v_mfma_f32_16x16x32_bf16 v[108:111], a[8:11], v[184:187], 0
    v_pk_mul_f32 v[100:101], v[100:101], v[168:169] op_sel:[0,0] op_sel_hi:[1,0]
    v_pk_mul_f32 v[102:103], v[102:103], v[168:169] op_sel:[0,0] op_sel_hi:[1,0]
    v_cvt_pk_bf16_f32 v93, v94, v95
    s_waitcnt lgkmcnt(3)
    v_mfma_f32_16x16x32_bf16 v[104:107], a[18:21], v[160:163], 0
    v_pk_mul_f32 v[96:97], v[96:97], v[144:145] op_sel:[0,0] op_sel_hi:[1,0]
    v_pk_mul_f32 v[98:99], v[98:99], v[144:145] op_sel:[0,0] op_sel_hi:[1,0]
    v_cvt_pk_bf16_f32 v100, v100, v101
    s_waitcnt lgkmcnt(2)
    v_mfma_f32_16x16x32_bf16 v[116:119], a[10:13], v[208:211], 0
    v_pk_mul_f32 v[108:109], v[108:109], v[192:193] op_sel:[0,0] op_sel_hi:[1,0]
    v_cvt_pk_bf16_f32 v94, v96, v97
    s_waitcnt lgkmcnt(1)
    v_mfma_f32_16x16x32_bf16 v[112:115], a[20:23], v[184:187], 0
    v_pk_mul_f32 v[104:105], v[104:105], v[168:169] op_sel:[0,0] op_sel_hi:[1,0]
    v_pk_mul_f32 v[106:107], v[106:107], v[168:169] op_sel:[0,0] op_sel_hi:[1,0]
    v_cvt_pk_bf16_f32 v95, v98, v99
    s_waitcnt lgkmcnt(0)
    v_mfma_f32_16x16x32_bf16 v[120:123], a[22:25], v[208:211], 0
    v_pk_mul_f32 v[110:111], v[110:111], v[192:193] op_sel:[0,0] op_sel_hi:[1,0]
    s_add_u32 s35, s35, 0x2e00000
    v_cvt_pk_bf16_f32 v101, v102, v103
    v_pk_mul_f32 v[116:117], v[116:117], v[216:217] op_sel:[0,0] op_sel_hi:[1,0]
    v_pk_mul_f32 v[112:113], v[112:113], v[192:193] op_sel:[0,0] op_sel_hi:[1,0]
    v_pk_mul_f32 v[114:115], v[114:115], v[192:193] op_sel:[0,0] op_sel_hi:[1,0]
    v_cvt_pk_bf16_f32 v108, v108, v109
    v_cvt_pk_bf16_f32 v102, v104, v105
    v_cvt_pk_bf16_f32 v103, v106, v107
    v_pk_mul_f32 v[118:119], v[118:119], v[216:217] op_sel:[0,0] op_sel_hi:[1,0]
    buffer_store_dwordx4 v[92:95], v2, s[4:7], s35 offen offset:0 sc1
    v_cvt_pk_bf16_f32 v109, v110, v111
    v_pk_mul_f32 v[120:121], v[120:121], v[216:217] op_sel:[0,0] op_sel_hi:[1,0]
    v_pk_mul_f32 v[122:123], v[122:123], v[216:217] op_sel:[0,0] op_sel_hi:[1,0]
    v_cvt_pk_bf16_f32 v116, v116, v117
    v_cvt_pk_bf16_f32 v110, v112, v113
    v_cvt_pk_bf16_f32 v111, v114, v115
    buffer_store_dwordx4 v[100:103], v2, s[4:7], s35 offen offset:1024 sc1
    v_cvt_pk_bf16_f32 v117, v118, v119
    v_cvt_pk_bf16_f32 v118, v120, v121
    v_cvt_pk_bf16_f32 v119, v122, v123
    buffer_store_dwordx4 v[108:111], v2, s[4:7], s35 offen offset:2048 sc1
    buffer_store_dwordx4 v[116:119], v2, s[4:7], s35 offen offset:3072 sc1
    s_lshl_b32 s36, s29, 13
    v_lshl_add_u32 v10, v0, 8, s36
    s_waitcnt vmcnt(0)
    s_barrier
    s_cmp_lg_u32 s28, 0
    s_cbranch_scc1 Lsig_22
    s_mov_b32 exec_lo, 0xffffffff
    s_mov_b32 exec_hi, 0
    s_mov_b32 s36, 0x20000
    buffer_atomic_add v12, v10, s[4:7], s36 offen sc1
    s_mov_b64 exec, -1
Lsig_22:
    s_add_u32 s45, s28, 0
    s_add_u32 s44, s45, s34
    s_and_b32 s44, s44, 31
    s_lshl_b32 s44, s44, 12
    s_add_u32 s44, s44, s51
    s_add_u32 s44, s44, 0xa00000
    s_lshl_b32 s45, s45, 12
    s_add_u32 m0, s45, 32768
    s_nop 0
    buffer_load_dwordx4 v1, s[4:7], s44 offen offset:0 sc1 lds
    buffer_load_dwordx4 v1, s[4:7], s44 offen offset:1024 sc1 lds
    buffer_load_dwordx4 v1, s[4:7], s44 offen offset:2048 sc1 lds
    buffer_load_dwordx4 v1, s[4:7], s44 offen offset:3072 sc1 lds
    s_add_u32 s45, s28, 4
    s_add_u32 s44, s45, s34
    s_and_b32 s44, s44, 31
    s_lshl_b32 s44, s44, 12
    s_add_u32 s44, s44, s51
    s_add_u32 s44, s44, 0xa00000
    s_lshl_b32 s45, s45, 12
    s_add_u32 m0, s45, 32768
    s_nop 0
    buffer_load_dwordx4 v1, s[4:7], s44 offen offset:0 sc1 lds
    buffer_load_dwordx4 v1, s[4:7], s44 offen offset:1024 sc1 lds
    buffer_load_dwordx4 v1, s[4:7], s44 offen offset:2048 sc1 lds
    buffer_load_dwordx4 v1, s[4:7], s44 offen offset:3072 sc1 lds
    s_add_u32 s45, s28, 8
    s_add_u32 s44, s45, s34
    s_and_b32 s44, s44, 31
    s_lshl_b32 s44, s44, 12
    s_add_u32 s44, s44, s51
    s_add_u32 s44, s44, 0xa00000
    s_lshl_b32 s45, s45, 12
    s_add_u32 m0, s45, 32768
    s_nop 0
    buffer_load_dwordx4 v1, s[4:7], s44 offen offset:0 sc1 lds
    buffer_load_dwordx4 v1, s[4:7], s44 offen offset:1024 sc1 lds
    buffer_load_dwordx4 v1, s[4:7], s44 offen offset:2048 sc1 lds
    buffer_load_dwordx4 v1, s[4:7], s44 offen offset:3072 sc1 lds
    s_add_u32 s45, s28, 12
    s_add_u32 s44, s45, s34
    s_and_b32 s44, s44, 31
    s_lshl_b32 s44, s44, 12
    s_add_u32 s44, s44, s51
    s_add_u32 s44, s44, 0xa00000
    s_lshl_b32 s45, s45, 12
    s_add_u32 m0, s45, 32768
    s_nop 0
    buffer_load_dwordx4 v1, s[4:7], s44 offen offset:0 sc1 lds
    buffer_load_dwordx4 v1, s[4:7], s44 offen offset:1024 sc1 lds
    buffer_load_dwordx4 v1, s[4:7], s44 offen offset:2048 sc1 lds
    buffer_load_dwordx4 v1, s[4:7], s44 offen offset:3072 sc1 lds
    s_add_u32 s45, s28, 16
    s_add_u32 s44, s45, s34
    s_and_b32 s44, s44, 31
    s_lshl_b32 s44, s44, 12
    s_add_u32 s44, s44, s51
    s_add_u32 s44, s44, 0xa00000
    s_lshl_b32 s45, s45, 12
    s_add_u32 m0, s45, 32768
    s_nop 0
    buffer_load_dwordx4 v1, s[4:7], s44 offen offset:0 sc1 lds
    buffer_load_dwordx4 v1, s[4:7], s44 offen offset:1024 sc1 lds
    buffer_load_dwordx4 v1, s[4:7], s44 offen offset:2048 sc1 lds
    buffer_load_dwordx4 v1, s[4:7], s44 offen offset:3072 sc1 lds
    s_add_u32 s45, s28, 20
    s_add_u32 s44, s45, s34
    s_and_b32 s44, s44, 31
    s_lshl_b32 s44, s44, 12
    s_add_u32 s44, s44, s51
    s_add_u32 s44, s44, 0xa00000
    s_lshl_b32 s45, s45, 12
    s_add_u32 m0, s45, 32768
    s_nop 0
    buffer_load_dwordx4 v1, s[4:7], s44 offen offset:0 sc1 lds
    buffer_load_dwordx4 v1, s[4:7], s44 offen offset:1024 sc1 lds
    buffer_load_dwordx4 v1, s[4:7], s44 offen offset:2048 sc1 lds
    buffer_load_dwordx4 v1, s[4:7], s44 offen offset:3072 sc1 lds
    s_add_u32 s45, s28, 24
    s_add_u32 s44, s45, s34
    s_and_b32 s44, s44, 31
    s_lshl_b32 s44, s44, 12
    s_add_u32 s44, s44, s51
    s_add_u32 s44, s44, 0xa00000
    s_lshl_b32 s45, s45, 12
    s_add_u32 m0, s45, 32768
    s_nop 0
    buffer_load_dwordx4 v1, s[4:7], s44 offen offset:0 sc1 lds
    buffer_load_dwordx4 v1, s[4:7], s44 offen offset:1024 sc1 lds
    buffer_load_dwordx4 v1, s[4:7], s44 offen offset:2048 sc1 lds
    buffer_load_dwordx4 v1, s[4:7], s44 offen offset:3072 sc1 lds
    s_add_u32 s45, s28, 28
    s_add_u32 s44, s45, s34
    s_and_b32 s44, s44, 31
    s_lshl_b32 s44, s44, 12
    s_add_u32 s44, s44, s51
    s_add_u32 s44, s44, 0xa00000
    s_lshl_b32 s45, s45, 12
    s_add_u32 m0, s45, 32768
    s_nop 0
    buffer_load_dwordx4 v1, s[4:7], s44 offen offset:0 sc1 lds
    buffer_load_dwordx4 v1, s[4:7], s44 offen offset:1024 sc1 lds
    buffer_load_dwordx4 v1, s[4:7], s44 offen offset:2048 sc1 lds
    buffer_load_dwordx4 v1, s[4:7], s44 offen offset:3072 sc1 lds
    s_add_u32 s40, s4, 0x2e00000
    s_addc_u32 s41, s5, 0
    s_lshl_b32 s35, s34, 12
    v_add_u32 v5, 32768, v1
    v_add_u32 v6, 98304, v1
    v_lshlrev_b32 v132, 16, v32
    v_and_b32 v133, 0xffff0000, v32
    v_lshlrev_b32 v134, 16, v33
    v_and_b32 v135, 0xffff0000, v33
    v_lshlrev_b32 v136, 16, v34
    v_and_b32 v137, 0xffff0000, v34
    v_lshlrev_b32 v138, 16, v35
    v_and_b32 v139, 0xffff0000, v35
    v_lshlrev_b32 v140, 16, v36
    v_and_b32 v141, 0xffff0000, v36
    v_lshlrev_b32 v142, 16, v37
    v_and_b32 v143, 0xffff0000, v37
    v_lshlrev_b32 v144, 16, v38
    v_and_b32 v145, 0xffff0000, v38
    v_lshlrev_b32 v146, 16, v39
    v_and_b32 v147, 0xffff0000, v39
    v_lshlrev_b32 v148, 16, v40
    v_and_b32 v149, 0xffff0000, v40
    v_lshlrev_b32 v150, 16, v41
    v_and_b32 v151, 0xffff0000, v41
    v_lshlrev_b32 v152, 16, v42
    v_and_b32 v153, 0xffff0000, v42
    v_lshlrev_b32 v154, 16, v43
    v_and_b32 v155, 0xffff0000, v43
    v_lshlrev_b32 v156, 16, v44
    v_and_b32 v157, 0xffff0000, v44
    v_lshlrev_b32 v158, 16, v45
    v_and_b32 v159, 0xffff0000, v45
    v_lshlrev_b32 v160, 16, v46
    v_and_b32 v161, 0xffff0000, v46
    v_lshlrev_b32 v162, 16, v47
    v_and_b32 v163, 0xffff0000, v47
    s_lshl_b32 s36, s31, 4
    s_add_u32 s36, s36, s32
    s_lshl_b32 s36, s36, 8
    v_mov_b32 v10, s36
    s_cmp_lg_u32 s28, 0
    s_cbranch_scc1 Lpe_24
    s_mov_b32 s36, 0x20000
    s_mov_b32 s37, 0
Lpoll_23:
    buffer_load_dword v11, v10, s[4:7], s36 offen sc1
    s_add_u32 s37, s37, 1
    s_waitcnt vmcnt(0)
    v_cmp_gt_u32 vcc, 32, v11
    s_cbranch_vccz Lpe_24
    s_cmp_lt_u32 s37, 0x100000
    s_cbranch_scc1 Lpoll_23
Lpe_24:
    s_waitcnt vmcnt(0)
    s_barrier
    buffer_load_dwordx4 a[0:3], v4, s[40:43], s35 offen offset:0 sc1
    buffer_load_dwordx4 a[4:7], v4, s[40:43], s35 offen offset:1024 sc1
    s_add_u32 s35, s35, 4096
    s_and_b32 s35, s35, 0x1ffff
    buffer_load_dwordx4 a[8:11], v4, s[40:43], s35 offen offset:0 sc1
    buffer_load_dwordx4 a[12:15], v4, s[40:43], s35 offen offset:1024 sc1
    s_add_u32 s35, s35, 4096
    s_and_b32 s35, s35, 0x1ffff
    buffer_load_dwordx4 a[16:19], v4, s[40:43], s35 offen offset:0 sc1
    buffer_load_dwordx4 a[20:23], v4, s[40:43], s35 offen offset:1024 sc1
    s_add_u32 s35, s35, 4096
    s_and_b32 s35, s35, 0x1ffff
    buffer_load_dwordx4 a[24:27], v4, s[40:43], s35 offen offset:0 sc1
    buffer_load_dwordx4 a[28:31], v4, s[40:43], s35 offen offset:1024 sc1
    s_add_u32 s35, s35, 4096
    s_and_b32 s35, s35, 0x1ffff
    buffer_load_dwordx4 a[32:35], v4, s[40:43], s35 offen offset:0 sc1
    buffer_load_dwordx4 a[36:39], v4, s[40:43], s35 offen offset:1024 sc1
    s_add_u32 s35, s35, 4096
    s_and_b32 s35, s35, 0x1ffff
    ds_read_b128 a[80:83], v5 offset:0
    ds_read_b128 a[84:87], v5 offset:1024
    ds_read_b128 a[88:91], v5 offset:2048
    ds_read_b128 a[92:95], v5 offset:3072
    s_waitcnt vmcnt(8) lgkmcnt(0)
    v_mfma_f32_16x16x32_bf16 v[132:135], a[80:83], a[0:3], v[132:135]
    ds_read_b128 a[96:99], v5 offset:4096
    v_mfma_f32_16x16x32_bf16 v[148:151], a[80:83], a[4:7], v[148:151]
    ds_read_b128 a[100:103], v5 offset:5120
    v_mfma_f32_16x16x32_bf16 v[136:139], a[84:87], a[0:3], v[136:139]
    ds_read_b128 a[104:107], v5 offset:6144
    v_mfma_f32_16x16x32_bf16 v[152:155], a[84:87], a[4:7], v[152:155]
    ds_read_b128 a[108:111], v5 offset:7168
    v_mfma_f32_16x16x32_bf16 v[140:143], a[88:91], a[0:3], v[140:143]
    buffer_load_dwordx4 a[40:43], v4, s[40:43], s35 offen offset:0 sc1
    v_mfma_f32_16x16x32_bf16 v[156:159], a[88:91], a[4:7], v[156:159]
    v_mfma_f32_16x16x32_bf16 v[144:147], a[92:95], a[0:3], v[144:147]
    buffer_load_dwordx4 a[44:47], v4, s[40:43], s35 offen offset:1024 sc1
    s_add_u32 s35, s35, 4096
    s_and_b32 s35, s35, 0x1ffff
    v_mfma_f32_16x16x32_bf16 v[160:163], a[92:95], a[4:7], v[160:163]
    s_waitcnt vmcnt(8) lgkmcnt(0)
    v_mfma_f32_16x16x32_bf16 v[132:135], a[96:99], a[8:11], v[132:135]
    ds_read_b128 a[80:83], v5 offset:8192
    v_mfma_f32_16x16x32_bf16 v[148:151], a[96:99], a[12:15], v[148:151]
    ds_read_b128 a[84:87], v5 offset:9216
    v_mfma_f32_16x16x32_bf16 v[136:139], a[100:103], a[8:11], v[136:139]
    ds_read_b128 a[88:91], v5 offset:10240
    v_mfma_f32_16x16x32_bf16 v[152:155], a[100:103], a[12:15], v[152:155]
    ds_read_b128 a[92:95], v5 offset:11264
    v_mfma_f32_16x16x32_bf16 v[140:143], a[104:107], a[8:11], v[140:143]
    buffer_load_dwordx4 a[0:3], v4, s[40:43], s35 offen offset:0 sc1
    v_mfma_f32_16x16x32_bf16 v[156:159], a[104:107], a[12:15], v[156:159]
    v_mfma_f32_16x16x32_bf16 v[144:147], a[108:111], a[8:11], v[144:147]
    buffer_load_dwordx4 a[4:7], v4, s[40:43], s35 offen offset:1024 sc1
    s_add_u32 s35, s35, 4096
    s_and_b32 s35, s35, 0x1ffff
    v_mfma_f32_16x16x32_bf16 v[160:163], a[108:111], a[12:15], v[160:163]
    s_waitcnt vmcnt(8) lgkmcnt(0)
    v_mfma_f32_16x16x32_bf16 v[132:135], a[80:83], a[16:19], v[132:135]
    ds_read_b128 a[96:99], v5 offset:12288
    v_mfma_f32_16x16x32_bf16 v[148:151], a[80:83], a[20:23], v[148:151]
    ds_read_b128 a[100:103], v5 offset:13312
    v_mfma_f32_16x16x32_bf16 v[136:139], a[84:87], a[16:19], v[136:139]
    ds_read_b128 a[104:107], v5 offset:14336
    v_mfma_f32_16x16x32_bf16 v[152:155], a[84:87], a[20:23], v[152:155]
    ds_read_b128 a[108:111], v5 offset:15360
    v_mfma_f32_16x16x32_bf16 v[140:143], a[88:91], a[16:19], v[140:143]
    buffer_load_dwordx4 a[8:11], v4, s[40:43], s35 offen offset:0 sc1
    v_mfma_f32_16x16x32_bf16 v[156:159], a[88:91], a[20:23], v[156:159]
    v_mfma_f32_16x16x32_bf16 v[144:147], a[92:95], a[16:19], v[144:147]
    buffer_load_dwordx4 a[12:15], v4, s[40:43], s35 offen offset:1024 sc1
    s_add_u32 s35, s35, 4096
    s_and_b32 s35, s35, 0x1ffff
    v_mfma_f32_16x16x32_bf16 v[160:163], a[92:95], a[20:23], v[160:163]
    s_waitcnt vmcnt(8) lgkmcnt(0)
    v_mfma_f32_16x16x32_bf16 v[132:135], a[96:99], a[24:27], v[132:135]
    ds_read_b128 a[80:83], v5 offset:16384
    v_mfma_f32_16x16x32_bf16 v[148:151], a[96:99], a[28:31], v[148:151]
    ds_read_b128 a[84:87], v5 offset:17408
    v_mfma_f32_16x16x32_bf16 v[136:139], a[100:103], a[24:27], v[136:139]
    ds_read_b128 a[88:91], v5 offset:18432
    v_mfma_f32_16x16x32_bf16 v[152:155], a[100:103], a[28:31], v[152:155]
    ds_read_b128 a[92:95], v5 offset:19456
    v_mfma_f32_16x16x32_bf16 v[140:143], a[104:107], a[24:27], v[140:143]
    buffer_load_dwordx4 a[16:19], v4, s[40:43], s35 offen offset:0 sc1
    v_mfma_f32_16x16x32_bf16 v[156:159], a[104:107], a[28:31], v[156:159]
    v_mfma_f32_16x16x32_bf16 v[144:147], a[108:111], a[24:27], v[144:147]
    buffer_load_dwordx4 a[20:23], v4, s[40:43], s35 offen offset:1024 sc1
    s_add_u32 s35, s35, 4096
    s_and_b32 s35, s35, 0x1ffff
    v_mfma_f32_16x16x32_bf16 v[160:163], a[108:111], a[28:31], v[160:163]
    s_waitcnt vmcnt(8) lgkmcnt(0)
    v_mfma_f32_16x16x32_bf16 v[132:135], a[80:83], a[32:35], v[132:135]
    ds_read_b128 a[96:99], v5 offset:20480
    v_mfma_f32_16x16x32_bf16 v[148:151], a[80:83], a[36:39], v[148:151]
    ds_read_b128 a[100:103], v5 offset:21504
    v_mfma_f32_16x16x32_bf16 v[136:139], a[84:87], a[32:35], v[136:139]
    ds_read_b128 a[104:107], v5 offset:22528
    v_mfma_f32_16x16x32_bf16 v[152:155], a[84:87], a[36:39], v[152:155]
    ds_read_b128 a[108:111], v5 offset:23552
    v_mfma_f32_16x16x32_bf16 v[140:143], a[88:91], a[32:35], v[140:143]
    buffer_load_dwordx4 a[24:27], v4, s[40:43], s35 offen offset:0 sc1
    v_mfma_f32_16x16x32_bf16 v[156:159], a[88:91], a[36:39], v[156:159]
    v_mfma_f32_16x16x32_bf16 v[144:147], a[92:95], a[32:35], v[144:147]
    buffer_load_dwordx4 a[28:31], v4, s[40:43], s35 offen offset:1024 sc1
    s_add_u32 s35, s35, 4096
    s_and_b32 s35, s35, 0x1ffff
    v_mfma_f32_16x16x32_bf16 v[160:163], a[92:95], a[36:39], v[160:163]
    s_waitcnt vmcnt(8) lgkmcnt(0)
    v_mfma_f32_16x16x32_bf16 v[132:135], a[96:99], a[40:43], v[132:135]
    ds_read_b128 a[80:83], v5 offset:24576
    v_mfma_f32_16x16x32_bf16 v[148:151], a[96:99], a[44:47], v[148:151]
    ds_read_b128 a[84:87], v5 offset:25600
    v_mfma_f32_16x16x32_bf16 v[136:139], a[100:103], a[40:43], v[136:139]
    ds_read_b128 a[88:91], v5 offset:26624
    v_mfma_f32_16x16x32_bf16 v[152:155], a[100:103], a[44:47], v[152:155]
    ds_read_b128 a[92:95], v5 offset:27648
    v_mfma_f32_16x16x32_bf16 v[140:143], a[104:107], a[40:43], v[140:143]
    buffer_load_dwordx4 a[32:35], v4, s[40:43], s35 offen offset:0 sc1
    v_mfma_f32_16x16x32_bf16 v[156:159], a[104:107], a[44:47], v[156:159]
    v_mfma_f32_16x16x32_bf16 v[144:147], a[108:111], a[40:43], v[144:147]
    buffer_load_dwordx4 a[36:39], v4, s[40:43], s35 offen offset:1024 sc1
    s_add_u32 s35, s35, 4096
    s_and_b32 s35, s35, 0x1ffff
    v_mfma_f32_16x16x32_bf16 v[160:163], a[108:111], a[44:47], v[160:163]
    s_waitcnt vmcnt(8) lgkmcnt(0)
    v_mfma_f32_16x16x32_bf16 v[132:135], a[80:83], a[0:3], v[132:135]
    ds_read_b128 a[96:99], v5 offset:28672
    v_mfma_f32_16x16x32_bf16 v[148:151], a[80:83], a[4:7], v[148:151]
    ds_read_b128 a[100:103], v5 offset:29696
    v_mfma_f32_16x16x32_bf16 v[136:139], a[84:87], a[0:3], v[136:139]
    ds_read_b128 a[104:107], v5 offset:30720
    v_mfma_f32_16x16x32_bf16 v[152:155], a[84:87], a[4:7], v[152:155]
    ds_read_b128 a[108:111], v5 offset:31744
    v_mfma_f32_16x16x32_bf16 v[140:143], a[88:91], a[0:3], v[140:143]
    buffer_load_dwordx4 a[40:43], v4, s[40:43], s35 offen offset:0 sc1
    v_mfma_f32_16x16x32_bf16 v[156:159], a[88:91], a[4:7], v[156:159]
    v_mfma_f32_16x16x32_bf16 v[144:147], a[92:95], a[0:3], v[144:147]
    buffer_load_dwordx4 a[44:47], v4, s[40:43], s35 offen offset:1024 sc1
    s_add_u32 s35, s35, 4096
    s_and_b32 s35, s35, 0x1ffff
    v_mfma_f32_16x16x32_bf16 v[160:163], a[92:95], a[4:7], v[160:163]
    s_waitcnt vmcnt(8) lgkmcnt(0)
    v_mfma_f32_16x16x32_bf16 v[132:135], a[96:99], a[8:11], v[132:135]
    ds_read_b128 a[80:83], v5 offset:32768
    v_mfma_f32_16x16x32_bf16 v[148:151], a[96:99], a[12:15], v[148:151]
    ds_read_b128 a[84:87], v5 offset:33792
    v_mfma_f32_16x16x32_bf16 v[136:139], a[100:103], a[8:11], v[136:139]
    ds_read_b128 a[88:91], v5 offset:34816
    v_mfma_f32_16x16x32_bf16 v[152:155], a[100:103], a[12:15], v[152:155]
    ds_read_b128 a[92:95], v5 offset:35840
    v_mfma_f32_16x16x32_bf16 v[140:143], a[104:107], a[8:11], v[140:143]
    buffer_load_dwordx4 a[0:3], v4, s[40:43], s35 offen offset:0 sc1
    v_mfma_f32_16x16x32_bf16 v[156:159], a[104:107], a[12:15], v[156:159]
    v_mfma_f32_16x16x32_bf16 v[144:147], a[108:111], a[8:11], v[144:147]
    buffer_load_dwordx4 a[4:7], v4, s[40:43], s35 offen offset:1024 sc1
    s_add_u32 s35, s35, 4096
    s_and_b32 s35, s35, 0x1ffff
    v_mfma_f32_16x16x32_bf16 v[160:163], a[108:111], a[12:15], v[160:163]
    s_waitcnt vmcnt(8) lgkmcnt(0)
    v_mfma_f32_16x16x32_bf16 v[132:135], a[80:83], a[16:19], v[132:135]
    ds_read_b128 a[96:99], v5 offset:36864
    v_mfma_f32_16x16x32_bf16 v[148:151], a[80:83], a[20:23], v[148:151]
    ds_read_b128 a[100:103], v5 offset:37888
    v_mfma_f32_16x16x32_bf16 v[136:139], a[84:87], a[16:19], v[136:139]
    ds_read_b128 a[104:107], v5 offset:38912
    v_mfma_f32_16x16x32_bf16 v[152:155], a[84:87], a[20:23], v[152:155]
    ds_read_b128 a[108:111], v5 offset:39936
    v_mfma_f32_16x16x32_bf16 v[140:143], a[88:91], a[16:19], v[140:143]
    buffer_load_dwordx4 a[8:11], v4, s[40:43], s35 offen offset:0 sc1
    v_mfma_f32_16x16x32_bf16 v[156:159], a[88:91], a[20:23], v[156:159]
    v_mfma_f32_16x16x32_bf16 v[144:147], a[92:95], a[16:19], v[144:147]
    buffer_load_dwordx4 a[12:15], v4, s[40:43], s35 offen offset:1024 sc1
    s_add_u32 s35, s35, 4096
    s_and_b32 s35, s35, 0x1ffff
    v_mfma_f32_16x16x32_bf16 v[160:163], a[92:95], a[20:23], v[160:163]
    s_waitcnt vmcnt(8) lgkmcnt(0)
    v_mfma_f32_16x16x32_bf16 v[132:135], a[96:99], a[24:27], v[132:135]
    ds_read_b128 a[80:83], v5 offset:40960
    v_mfma_f32_16x16x32_bf16 v[148:151], a[96:99], a[28:31], v[148:151]
    ds_read_b128 a[84:87], v5 offset:41984
    v_mfma_f32_16x16x32_bf16 v[136:139], a[100:103], a[24:27], v[136:139]
    ds_read_b128 a[88:91], v5 offset:43008
    v_mfma_f32_16x16x32_bf16 v[152:155], a[100:103], a[28:31], v[152:155]
    ds_read_b128 a[92:95], v5 offset:44032
    v_mfma_f32_16x16x32_bf16 v[140:143], a[104:107], a[24:27], v[140:143]
    buffer_load_dwordx4 a[16:19], v4, s[40:43], s35 offen offset:0 sc1
    v_mfma_f32_16x16x32_bf16 v[156:159], a[104:107], a[28:31], v[156:159]
    v_mfma_f32_16x16x32_bf16 v[144:147], a[108:111], a[24:27], v[144:147]
    buffer_load_dwordx4 a[20:23], v4, s[40:43], s35 offen offset:1024 sc1
    s_add_u32 s35, s35, 4096
    s_and_b32 s35, s35, 0x1ffff
    v_mfma_f32_16x16x32_bf16 v[160:163], a[108:111], a[28:31], v[160:163]
    s_waitcnt vmcnt(8) lgkmcnt(0)
    v_mfma_f32_16x16x32_bf16 v[132:135], a[80:83], a[32:35], v[132:135]
    ds_read_b128 a[96:99], v5 offset:45056
    v_mfma_f32_16x16x32_bf16 v[148:151], a[80:83], a[36:39], v[148:151]
    ds_read_b128 a[100:103], v5 offset:46080
    v_mfma_f32_16x16x32_bf16 v[136:139], a[84:87], a[32:35], v[136:139]
    ds_read_b128 a[104:107], v5 offset:47104
    v_mfma_f32_16x16x32_bf16 v[152:155], a[84:87], a[36:39], v[152:155]
    ds_read_b128 a[108:111], v5 offset:48128
    v_mfma_f32_16x16x32_bf16 v[140:143], a[88:91], a[32:35], v[140:143]
    buffer_load_dwordx4 a[24:27], v4, s[40:43], s35 offen offset:0 sc1
    v_mfma_f32_16x16x32_bf16 v[156:159], a[88:91], a[36:39], v[156:159]
    v_mfma_f32_16x16x32_bf16 v[144:147], a[92:95], a[32:35], v[144:147]
    buffer_load_dwordx4 a[28:31], v4, s[40:43], s35 offen offset:1024 sc1
    s_add_u32 s35, s35, 4096
    s_and_b32 s35, s35, 0x1ffff
    v_mfma_f32_16x16x32_bf16 v[160:163], a[92:95], a[36:39], v[160:163]
    s_waitcnt vmcnt(8) lgkmcnt(0)
    v_mfma_f32_16x16x32_bf16 v[132:135], a[96:99], a[40:43], v[132:135]
    ds_read_b128 a[80:83], v5 offset:49152
    v_mfma_f32_16x16x32_bf16 v[148:151], a[96:99], a[44:47], v[148:151]
    ds_read_b128 a[84:87], v5 offset:50176
    v_mfma_f32_16x16x32_bf16 v[136:139], a[100:103], a[40:43], v[136:139]
    ds_read_b128 a[88:91], v5 offset:51200
    v_mfma_f32_16x16x32_bf16 v[152:155], a[100:103], a[44:47], v[152:155]
    ds_read_b128 a[92:95], v5 offset:52224
    v_mfma_f32_16x16x32_bf16 v[140:143], a[104:107], a[40:43], v[140:143]
    buffer_load_dwordx4 a[32:35], v4, s[40:43], s35 offen offset:0 sc1
    v_mfma_f32_16x16x32_bf16 v[156:159], a[104:107], a[44:47], v[156:159]
    v_mfma_f32_16x16x32_bf16 v[144:147], a[108:111], a[40:43], v[144:147]
    buffer_load_dwordx4 a[36:39], v4, s[40:43], s35 offen offset:1024 sc1
    s_add_u32 s35, s35, 4096
    s_and_b32 s35, s35, 0x1ffff
    v_mfma_f32_16x16x32_bf16 v[160:163], a[108:111], a[44:47], v[160:163]
    s_waitcnt vmcnt(8) lgkmcnt(0)
    v_mfma_f32_16x16x32_bf16 v[132:135], a[80:83], a[0:3], v[132:135]
    ds_read_b128 a[96:99], v5 offset:53248
    v_mfma_f32_16x16x32_bf16 v[148:151], a[80:83], a[4:7], v[148:151]
    ds_read_b128 a[100:103], v5 offset:54272
    v_mfma_f32_16x16x32_bf16 v[136:139], a[84:87], a[0:3], v[136:139]
    ds_read_b128 a[104:107], v5 offset:55296
    v_mfma_f32_16x16x32_bf16 v[152:155], a[84:87], a[4:7], v[152:155]
    ds_read_b128 a[108:111], v5 offset:56320
    v_mfma_f32_16x16x32_bf16 v[140:143], a[88:91], a[0:3], v[140:143]
    buffer_load_dwordx4 a[40:43], v4, s[40:43], s35 offen offset:0 sc1
    v_mfma_f32_16x16x32_bf16 v[156:159], a[88:91], a[4:7], v[156:159]
    v_mfma_f32_16x16x32_bf16 v[144:147], a[92:95], a[0:3], v[144:147]
    buffer_load_dwordx4 a[44:47], v4, s[40:43], s35 offen offset:1024 sc1
    s_add_u32 s35, s35, 4096
    s_and_b32 s35, s35, 0x1ffff
    v_mfma_f32_16x16x32_bf16 v[160:163], a[92:95], a[4:7], v[160:163]
    s_waitcnt vmcnt(8) lgkmcnt(0)
    v_mfma_f32_16x16x32_bf16 v[132:135], a[96:99], a[8:11], v[132:135]
    ds_read_b128 a[80:83], v5 offset:57344
    v_mfma_f32_16x16x32_bf16 v[148:151], a[96:99], a[12:15], v[148:151]
    ds_read_b128 a[84:87], v5 offset:58368
    v_mfma_f32_16x16x32_bf16 v[136:139], a[100:103], a[8:11], v[136:139]
    ds_read_b128 a[88:91], v5 offset:59392
    v_mfma_f32_16x16x32_bf16 v[152:155], a[100:103], a[12:15], v[152:155]
    ds_read_b128 a[92:95], v5 offset:60416
    v_mfma_f32_16x16x32_bf16 v[140:143], a[104:107], a[8:11], v[140:143]
    buffer_load_dwordx4 a[0:3], v4, s[40:43], s35 offen offset:0 sc1
    v_mfma_f32_16x16x32_bf16 v[156:159], a[104:107], a[12:15], v[156:159]
    v_mfma_f32_16x16x32_bf16 v[144:147], a[108:111], a[8:11], v[144:147]
    buffer_load_dwordx4 a[4:7], v4, s[40:43], s35 offen offset:1024 sc1
    s_add_u32 s35, s35, 4096
    s_and_b32 s35, s35, 0x1ffff
    v_mfma_f32_16x16x32_bf16 v[160:163], a[108:111], a[12:15], v[160:163]
    s_waitcnt vmcnt(8) lgkmcnt(0)
    v_mfma_f32_16x16x32_bf16 v[132:135], a[80:83], a[16:19], v[132:135]
    ds_read_b128 a[96:99], v5 offset:61440
    v_mfma_f32_16x16x32_bf16 v[148:151], a[80:83], a[20:23], v[148:151]
    ds_read_b128 a[100:103], v5 offset:62464
    v_mfma_f32_16x16x32_bf16 v[136:139], a[84:87], a[16:19], v[136:139]
    ds_read_b128 a[104:107], v5 offset:63488
    v_mfma_f32_16x16x32_bf16 v[152:155], a[84:87], a[20:23], v[152:155]
    ds_read_b128 a[108:111], v5 offset:64512
    v_mfma_f32_16x16x32_bf16 v[140:143], a[88:91], a[16:19], v[140:143]
    buffer_load_dwordx4 a[8:11], v4, s[40:43], s35 offen offset:0 sc1
    v_mfma_f32_16x16x32_bf16 v[156:159], a[88:91], a[20:23], v[156:159]
    v_mfma_f32_16x16x32_bf16 v[144:147], a[92:95], a[16:19], v[144:147]
    buffer_load_dwordx4 a[12:15], v4, s[40:43], s35 offen offset:1024 sc1
    s_add_u32 s35, s35, 4096
    s_and_b32 s35, s35, 0x1ffff
    v_mfma_f32_16x16x32_bf16 v[160:163], a[92:95], a[20:23], v[160:163]
    s_waitcnt vmcnt(8) lgkmcnt(0)
    v_mfma_f32_16x16x32_bf16 v[132:135], a[96:99], a[24:27], v[132:135]
    ds_read_b128 a[80:83], v6 offset:0
    v_mfma_f32_16x16x32_bf16 v[148:151], a[96:99], a[28:31], v[148:151]
    ds_read_b128 a[84:87], v6 offset:1024
    v_mfma_f32_16x16x32_bf16 v[136:139], a[100:103], a[24:27], v[136:139]
    ds_read_b128 a[88:91], v6 offset:2048
    v_mfma_f32_16x16x32_bf16 v[152:155], a[100:103], a[28:31], v[152:155]
    ds_read_b128 a[92:95], v6 offset:3072
    v_mfma_f32_16x16x32_bf16 v[140:143], a[104:107], a[24:27], v[140:143]
    buffer_load_dwordx4 a[16:19], v4, s[40:43], s35 offen offset:0 sc1
    v_mfma_f32_16x16x32_bf16 v[156:159], a[104:107], a[28:31], v[156:159]
    v_mfma_f32_16x16x32_bf16 v[144:147], a[108:111], a[24:27], v[144:147]
    buffer_load_dwordx4 a[20:23], v4, s[40:43], s35 offen offset:1024 sc1
    s_add_u32 s35, s35, 4096
    s_and_b32 s35, s35, 0x1ffff
    v_mfma_f32_16x16x32_bf16 v[160:163], a[108:111], a[28:31], v[160:163]
    s_waitcnt vmcnt(8) lgkmcnt(0)
    v_mfma_f32_16x16x32_bf16 v[132:135], a[80:83], a[32:35], v[132:135]
    ds_read_b128 a[96:99], v6 offset:4096
    v_mfma_f32_16x16x32_bf16 v[148:151], a[80:83], a[36:39], v[148:151]
    ds_read_b128 a[100:103], v6 offset:5120
    v_mfma_f32_16x16x32_bf16 v[136:139], a[84:87], a[32:35], v[136:139]
    ds_read_b128 a[104:107], v6 offset:6144
    v_mfma_f32_16x16x32_bf16 v[152:155], a[84:87], a[36:39], v[152:155]
    ds_read_b128 a[108:111], v6 offset:7168
    v_mfma_f32_16x16x32_bf16 v[140:143], a[88:91], a[32:35], v[140:143]
    buffer_load_dwordx4 a[24:27], v4, s[40:43], s35 offen offset:0 sc1
    v_mfma_f32_16x16x32_bf16 v[156:159], a[88:91], a[36:39], v[156:159]
    v_mfma_f32_16x16x32_bf16 v[144:147], a[92:95], a[32:35], v[144:147]
    buffer_load_dwordx4 a[28:31], v4, s[40:43], s35 offen offset:1024 sc1
    s_add_u32 s35, s35, 4096
    s_and_b32 s35, s35, 0x1ffff
    v_mfma_f32_16x16x32_bf16 v[160:163], a[92:95], a[36:39], v[160:163]
    s_waitcnt vmcnt(8) lgkmcnt(0)
    v_mfma_f32_16x16x32_bf16 v[132:135], a[96:99], a[40:43], v[132:135]
    ds_read_b128 a[80:83], v6 offset:8192
    v_mfma_f32_16x16x32_bf16 v[148:151], a[96:99], a[44:47], v[148:151]
    ds_read_b128 a[84:87], v6 offset:9216
    v_mfma_f32_16x16x32_bf16 v[136:139], a[100:103], a[40:43], v[136:139]
    ds_read_b128 a[88:91], v6 offset:10240
    v_mfma_f32_16x16x32_bf16 v[152:155], a[100:103], a[44:47], v[152:155]
    ds_read_b128 a[92:95], v6 offset:11264
    v_mfma_f32_16x16x32_bf16 v[140:143], a[104:107], a[40:43], v[140:143]
    buffer_load_dwordx4 a[32:35], v4, s[40:43], s35 offen offset:0 sc1
    v_mfma_f32_16x16x32_bf16 v[156:159], a[104:107], a[44:47], v[156:159]
    v_mfma_f32_16x16x32_bf16 v[144:147], a[108:111], a[40:43], v[144:147]
    buffer_load_dwordx4 a[36:39], v4, s[40:43], s35 offen offset:1024 sc1
    s_add_u32 s35, s35, 4096
    s_and_b32 s35, s35, 0x1ffff
    v_mfma_f32_16x16x32_bf16 v[160:163], a[108:111], a[44:47], v[160:163]
    s_waitcnt vmcnt(8) lgkmcnt(0)
    v_mfma_f32_16x16x32_bf16 v[132:135], a[80:83], a[0:3], v[132:135]
    ds_read_b128 a[96:99], v6 offset:12288
    v_mfma_f32_16x16x32_bf16 v[148:151], a[80:83], a[4:7], v[148:151]
    ds_read_b128 a[100:103], v6 offset:13312
    v_mfma_f32_16x16x32_bf16 v[136:139], a[84:87], a[0:3], v[136:139]
    ds_read_b128 a[104:107], v6 offset:14336
    v_mfma_f32_16x16x32_bf16 v[152:155], a[84:87], a[4:7], v[152:155]
    ds_read_b128 a[108:111], v6 offset:15360
    v_mfma_f32_16x16x32_bf16 v[140:143], a[88:91], a[0:3], v[140:143]
    buffer_load_dwordx4 a[40:43], v4, s[40:43], s35 offen offset:0 sc1
    v_mfma_f32_16x16x32_bf16 v[156:159], a[88:91], a[4:7], v[156:159]
    v_mfma_f32_16x16x32_bf16 v[144:147], a[92:95], a[0:3], v[144:147]
    buffer_load_dwordx4 a[44:47], v4, s[40:43], s35 offen offset:1024 sc1
    s_add_u32 s35, s35, 4096
    s_and_b32 s35, s35, 0x1ffff
    v_mfma_f32_16x16x32_bf16 v[160:163], a[92:95], a[4:7], v[160:163]
    s_waitcnt vmcnt(8) lgkmcnt(0)
    v_mfma_f32_16x16x32_bf16 v[132:135], a[96:99], a[8:11], v[132:135]
    ds_read_b128 a[80:83], v6 offset:16384
    v_mfma_f32_16x16x32_bf16 v[148:151], a[96:99], a[12:15], v[148:151]
    ds_read_b128 a[84:87], v6 offset:17408
    v_mfma_f32_16x16x32_bf16 v[136:139], a[100:103], a[8:11], v[136:139]
    ds_read_b128 a[88:91], v6 offset:18432
    v_mfma_f32_16x16x32_bf16 v[152:155], a[100:103], a[12:15], v[152:155]
    ds_read_b128 a[92:95], v6 offset:19456
    v_mfma_f32_16x16x32_bf16 v[140:143], a[104:107], a[8:11], v[140:143]
    buffer_load_dwordx4 a[0:3], v4, s[40:43], s35 offen offset:0 sc1
    v_mfma_f32_16x16x32_bf16 v[156:159], a[104:107], a[12:15], v[156:159]
    v_mfma_f32_16x16x32_bf16 v[144:147], a[108:111], a[8:11], v[144:147]
    buffer_load_dwordx4 a[4:7], v4, s[40:43], s35 offen offset:1024 sc1
    s_add_u32 s35, s35, 4096
    s_and_b32 s35, s35, 0x1ffff
    v_mfma_f32_16x16x32_bf16 v[160:163], a[108:111], a[12:15], v[160:163]
    s_waitcnt vmcnt(8) lgkmcnt(0)
    v_mfma_f32_16x16x32_bf16 v[132:135], a[80:83], a[16:19], v[132:135]
    ds_read_b128 a[96:99], v6 offset:20480
    v_mfma_f32_16x16x32_bf16 v[148:151], a[80:83], a[20:23], v[148:151]
    ds_read_b128 a[100:103], v6 offset:21504
    v_mfma_f32_16x16x32_bf16 v[136:139], a[84:87], a[16:19], v[136:139]
    ds_read_b128 a[104:107], v6 offset:22528
    v_mfma_f32_16x16x32_bf16 v[152:155], a[84:87], a[20:23], v[152:155]
    ds_read_b128 a[108:111], v6 offset:23552
    v_mfma_f32_16x16x32_bf16 v[140:143], a[88:91], a[16:19], v[140:143]
    buffer_load_dwordx4 a[8:11], v4, s[40:43], s35 offen offset:0 sc1
    v_mfma_f32_16x16x32_bf16 v[156:159], a[88:91], a[20:23], v[156:159]
    v_mfma_f32_16x16x32_bf16 v[144:147], a[92:95], a[16:19], v[144:147]
    buffer_load_dwordx4 a[12:15], v4, s[40:43], s35 offen offset:1024 sc1
    s_add_u32 s35, s35, 4096
    s_and_b32 s35, s35, 0x1ffff
    v_mfma_f32_16x16x32_bf16 v[160:163], a[92:95], a[20:23], v[160:163]
    s_waitcnt vmcnt(8) lgkmcnt(0)
    v_mfma_f32_16x16x32_bf16 v[132:135], a[96:99], a[24:27], v[132:135]
    ds_read_b128 a[80:83], v6 offset:24576
    v_mfma_f32_16x16x32_bf16 v[148:151], a[96:99], a[28:31], v[148:151]
    ds_read_b128 a[84:87], v6 offset:25600
    v_mfma_f32_16x16x32_bf16 v[136:139], a[100:103], a[24:27], v[136:139]
    ds_read_b128 a[88:91], v6 offset:26624
    v_mfma_f32_16x16x32_bf16 v[152:155], a[100:103], a[28:31], v[152:155]
    ds_read_b128 a[92:95], v6 offset:27648
    v_mfma_f32_16x16x32_bf16 v[140:143], a[104:107], a[24:27], v[140:143]
    buffer_load_dwordx4 a[16:19], v4, s[40:43], s35 offen offset:0 sc1
    v_mfma_f32_16x16x32_bf16 v[156:159], a[104:107], a[28:31], v[156:159]
    v_mfma_f32_16x16x32_bf16 v[144:147], a[108:111], a[24:27], v[144:147]
    buffer_load_dwordx4 a[20:23], v4, s[40:43], s35 offen offset:1024 sc1
    s_add_u32 s35, s35, 4096
    s_and_b32 s35, s35, 0x1ffff
    v_mfma_f32_16x16x32_bf16 v[160:163], a[108:111], a[28:31], v[160:163]
    s_waitcnt vmcnt(8) lgkmcnt(0)
    v_mfma_f32_16x16x32_bf16 v[132:135], a[80:83], a[32:35], v[132:135]
    ds_read_b128 a[96:99], v6 offset:28672
    v_mfma_f32_16x16x32_bf16 v[148:151], a[80:83], a[36:39], v[148:151]
    ds_read_b128 a[100:103], v6 offset:29696
    v_mfma_f32_16x16x32_bf16 v[136:139], a[84:87], a[32:35], v[136:139]
    ds_read_b128 a[104:107], v6 offset:30720
    v_mfma_f32_16x16x32_bf16 v[152:155], a[84:87], a[36:39], v[152:155]
    ds_read_b128 a[108:111], v6 offset:31744
    v_mfma_f32_16x16x32_bf16 v[140:143], a[88:91], a[32:35], v[140:143]
    buffer_load_dwordx4 a[24:27], v4, s[40:43], s35 offen offset:0 sc1
    v_mfma_f32_16x16x32_bf16 v[156:159], a[88:91], a[36:39], v[156:159]
    v_mfma_f32_16x16x32_bf16 v[144:147], a[92:95], a[32:35], v[144:147]
    buffer_load_dwordx4 a[28:31], v4, s[40:43], s35 offen offset:1024 sc1
    s_add_u32 s35, s35, 4096
    s_and_b32 s35, s35, 0x1ffff
    v_mfma_f32_16x16x32_bf16 v[160:163], a[92:95], a[36:39], v[160:163]
    s_waitcnt vmcnt(8) lgkmcnt(0)
    v_mfma_f32_16x16x32_bf16 v[132:135], a[96:99], a[40:43], v[132:135]
    ds_read_b128 a[80:83], v6 offset:32768
    v_mfma_f32_16x16x32_bf16 v[148:151], a[96:99], a[44:47], v[148:151]
    ds_read_b128 a[84:87], v6 offset:33792
    v_mfma_f32_16x16x32_bf16 v[136:139], a[100:103], a[40:43], v[136:139]
    ds_read_b128 a[88:91], v6 offset:34816
    v_mfma_f32_16x16x32_bf16 v[152:155], a[100:103], a[44:47], v[152:155]
    ds_read_b128 a[92:95], v6 offset:35840
    v_mfma_f32_16x16x32_bf16 v[140:143], a[104:107], a[40:43], v[140:143]
    buffer_load_dwordx4 a[32:35], v4, s[40:43], s35 offen offset:0 sc1
    v_mfma_f32_16x16x32_bf16 v[156:159], a[104:107], a[44:47], v[156:159]
    v_mfma_f32_16x16x32_bf16 v[144:147], a[108:111], a[40:43], v[144:147]
    buffer_load_dwordx4 a[36:39], v4, s[40:43], s35 offen offset:1024 sc1
    s_add_u32 s35, s35, 4096
    s_and_b32 s35, s35, 0x1ffff
    v_mfma_f32_16x16x32_bf16 v[160:163], a[108:111], a[44:47], v[160:163]
    s_waitcnt vmcnt(8) lgkmcnt(0)
    v_mfma_f32_16x16x32_bf16 v[132:135], a[80:83], a[0:3], v[132:135]
    ds_read_b128 a[96:99], v6 offset:36864
    v_mfma_f32_16x16x32_bf16 v[148:151], a[80:83], a[4:7], v[148:151]
    ds_read_b128 a[100:103], v6 offset:37888
    v_mfma_f32_16x16x32_bf16 v[136:139], a[84:87], a[0:3], v[136:139]
    ds_read_b128 a[104:107], v6 offset:38912
    v_mfma_f32_16x16x32_bf16 v[152:155], a[84:87], a[4:7], v[152:155]
    ds_read_b128 a[108:111], v6 offset:39936
    v_mfma_f32_16x16x32_bf16 v[140:143], a[88:91], a[0:3], v[140:143]
    buffer_load_dwordx4 a[40:43], v4, s[40:43], s35 offen offset:0 sc1
    v_mfma_f32_16x16x32_bf16 v[156:159], a[88:91], a[4:7], v[156:159]
    v_mfma_f32_16x16x32_bf16 v[144:147], a[92:95], a[0:3], v[144:147]
    buffer_load_dwordx4 a[44:47], v4, s[40:43], s35 offen offset:1024 sc1
    s_add_u32 s35, s35, 4096
    s_and_b32 s35, s35, 0x1ffff
    v_mfma_f32_16x16x32_bf16 v[160:163], a[92:95], a[4:7], v[160:163]
    s_waitcnt vmcnt(8) lgkmcnt(0)
    v_mfma_f32_16x16x32_bf16 v[132:135], a[96:99], a[8:11], v[132:135]
    ds_read_b128 a[80:83], v6 offset:40960
    v_mfma_f32_16x16x32_bf16 v[148:151], a[96:99], a[12:15], v[148:151]
    ds_read_b128 a[84:87], v6 offset:41984
    v_mfma_f32_16x16x32_bf16 v[136:139], a[100:103], a[8:11], v[136:139]
    ds_read_b128 a[88:91], v6 offset:43008
    v_mfma_f32_16x16x32_bf16 v[152:155], a[100:103], a[12:15], v[152:155]
    ds_read_b128 a[92:95], v6 offset:44032
    v_mfma_f32_16x16x32_bf16 v[140:143], a[104:107], a[8:11], v[140:143]
    buffer_load_dwordx4 a[0:3], v4, s[40:43], s35 offen offset:0 sc1
    v_mfma_f32_16x16x32_bf16 v[156:159], a[104:107], a[12:15], v[156:159]
    v_mfma_f32_16x16x32_bf16 v[144:147], a[108:111], a[8:11], v[144:147]
    buffer_load_dwordx4 a[4:7], v4, s[40:43], s35 offen offset:1024 sc1
    s_add_u32 s35, s35, 4096
    s_and_b32 s35, s35, 0x1ffff
    v_mfma_f32_16x16x32_bf16 v[160:163], a[108:111], a[12:15], v[160:163]
    s_waitcnt vmcnt(8) lgkmcnt(0)
    v_mfma_f32_16x16x32_bf16 v[132:135], a[80:83], a[16:19], v[132:135]
    ds_read_b128 a[96:99], v6 offset:45056
    v_mfma_f32_16x16x32_bf16 v[148:151], a[80:83], a[20:23], v[148:151]
    ds_read_b128 a[100:103], v6 offset:46080
    v_mfma_f32_16x16x32_bf16 v[136:139], a[84:87], a[16:19], v[136:139]
    ds_read_b128 a[104:107], v6 offset:47104
    v_mfma_f32_16x16x32_bf16 v[152:155], a[84:87], a[20:23], v[152:155]
    ds_read_b128 a[108:111], v6 offset:48128
    v_mfma_f32_16x16x32_bf16 v[140:143], a[88:91], a[16:19], v[140:143]
    buffer_load_dwordx4 a[8:11], v4, s[40:43], s35 offen offset:0 sc1
    v_mfma_f32_16x16x32_bf16 v[156:159], a[88:91], a[20:23], v[156:159]
    v_mfma_f32_16x16x32_bf16 v[144:147], a[92:95], a[16:19], v[144:147]
    buffer_load_dwordx4 a[12:15], v4, s[40:43], s35 offen offset:1024 sc1
    s_add_u32 s35, s35, 4096
    s_and_b32 s35, s35, 0x1ffff
    v_mfma_f32_16x16x32_bf16 v[160:163], a[92:95], a[20:23], v[160:163]
    s_waitcnt vmcnt(8) lgkmcnt(0)
    v_mfma_f32_16x16x32_bf16 v[132:135], a[96:99], a[24:27], v[132:135]
    ds_read_b128 a[80:83], v6 offset:49152
    v_mfma_f32_16x16x32_bf16 v[148:151], a[96:99], a[28:31], v[148:151]
    ds_read_b128 a[84:87], v6 offset:50176
    v_mfma_f32_16x16x32_bf16 v[136:139], a[100:103], a[24:27], v[136:139]
    ds_read_b128 a[88:91], v6 offset:51200
    v_mfma_f32_16x16x32_bf16 v[152:155], a[100:103], a[28:31], v[152:155]
    ds_read_b128 a[92:95], v6 offset:52224
    v_mfma_f32_16x16x32_bf16 v[140:143], a[104:107], a[24:27], v[140:143]
    v_mfma_f32_16x16x32_bf16 v[156:159], a[104:107], a[28:31], v[156:159]
    v_mfma_f32_16x16x32_bf16 v[144:147], a[108:111], a[24:27], v[144:147]
    v_mfma_f32_16x16x32_bf16 v[160:163], a[108:111], a[28:31], v[160:163]
    s_waitcnt vmcnt(6) lgkmcnt(0)
    v_mfma_f32_16x16x32_bf16 v[132:135], a[80:83], a[32:35], v[132:135]
    ds_read_b128 a[96:99], v6 offset:53248
    v_mfma_f32_16x16x32_bf16 v[148:151], a[80:83], a[36:39], v[148:151]
    ds_read_b128 a[100:103], v6 offset:54272
    v_mfma_f32_16x16x32_bf16 v[136:139], a[84:87], a[32:35], v[136:139]
    ds_read_b128 a[104:107], v6 offset:55296
    v_mfma_f32_16x16x32_bf16 v[152:155], a[84:87], a[36:39], v[152:155]
    ds_read_b128 a[108:111], v6 offset:56320
    v_mfma_f32_16x16x32_bf16 v[140:143], a[88:91], a[32:35], v[140:143]
    v_mfma_f32_16x16x32_bf16 v[156:159], a[88:91], a[36:39], v[156:159]
    v_mfma_f32_16x16x32_bf16 v[144:147], a[92:95], a[32:35], v[144:147]
    v_mfma_f32_16x16x32_bf16 v[160:163], a[92:95], a[36:39], v[160:163]
    s_waitcnt vmcnt(4) lgkmcnt(0)
    v_mfma_f32_16x16x32_bf16 v[132:135], a[96:99], a[40:43], v[132:135]
    ds_read_b128 a[80:83], v6 offset:57344
    v_mfma_f32_16x16x32_bf16 v[148:151], a[96:99], a[44:47], v[148:151]
    ds_read_b128 a[84:87], v6 offset:58368
    v_mfma_f32_16x16x32_bf16 v[136:139], a[100:103], a[40:43], v[136:139]
    ds_read_b128 a[88:91], v6 offset:59392
    v_mfma_f32_16x16x32_bf16 v[152:155], a[100:103], a[44:47], v[152:155]
    ds_read_b128 a[92:95], v6 offset:60416
    v_mfma_f32_16x16x32_bf16 v[140:143], a[104:107], a[40:43], v[140:143]
    v_mfma_f32_16x16x32_bf16 v[156:159], a[104:107], a[44:47], v[156:159]
    v_mfma_f32_16x16x32_bf16 v[144:147], a[108:111], a[40:43], v[144:147]
    v_mfma_f32_16x16x32_bf16 v[160:163], a[108:111], a[44:47], v[160:163]
    s_waitcnt vmcnt(2) lgkmcnt(0)
    v_mfma_f32_16x16x32_bf16 v[132:135], a[80:83], a[0:3], v[132:135]
    ds_read_b128 a[96:99], v6 offset:61440
    v_mfma_f32_16x16x32_bf16 v[148:151], a[80:83], a[4:7], v[148:151]
    ds_read_b128 a[100:103], v6 offset:62464
    v_mfma_f32_16x16x32_bf16 v[136:139], a[84:87], a[0:3], v[136:139]
    ds_read_b128 a[104:107], v6 offset:63488
    v_mfma_f32_16x16x32_bf16 v[152:155], a[84:87], a[4:7], v[152:155]
    ds_read_b128 a[108:111], v6 offset:64512
    v_mfma_f32_16x16x32_bf16 v[140:143], a[88:91], a[0:3], v[140:143]
    v_mfma_f32_16x16x32_bf16 v[156:159], a[88:91], a[4:7], v[156:159]
    v_mfma_f32_16x16x32_bf16 v[144:147], a[92:95], a[0:3], v[144:147]
    v_mfma_f32_16x16x32_bf16 v[160:163], a[92:95], a[4:7], v[160:163]
    s_waitcnt vmcnt(0) lgkmcnt(0)
    s_barrier
    v_mfma_f32_16x16x32_bf16 v[132:135], a[96:99], a[8:11], v[132:135]
    v_mfma_f32_16x16x32_bf16 v[148:151], a[96:99], a[12:15], v[148:151]
    v_mfma_f32_16x16x32_bf16 v[136:139], a[100:103], a[8:11], v[136:139]
    v_mfma_f32_16x16x32_bf16 v[152:155], a[100:103], a[12:15], v[152:155]
    v_mfma_f32_16x16x32_bf16 v[140:143], a[104:107], a[8:11], v[140:143]
    v_mfma_f32_16x16x32_bf16 v[156:159], a[104:107], a[12:15], v[156:159]
    v_mfma_f32_16x16x32_bf16 v[144:147], a[108:111], a[8:11], v[144:147]
    v_mfma_f32_16x16x32_bf16 v[160:163], a[108:111], a[12:15], v[160:163]
    s_nop 0
    v_cvt_pk_bf16_f32 v32, v132, v133
    v_cvt_pk_bf16_f32 v33, v134, v135
    v_cvt_pk_bf16_f32 v34, v136, v137
    v_cvt_pk_bf16_f32 v35, v138, v139
    v_cvt_pk_bf16_f32 v36, v140, v141
    v_cvt_pk_bf16_f32 v37, v142, v143
    v_cvt_pk_bf16_f32 v38, v144, v145
    v_cvt_pk_bf16_f32 v39, v146, v147
    v_cvt_pk_bf16_f32 v40, v148, v149
    v_cvt_pk_bf16_f32 v41, v150, v151
    v_cvt_pk_bf16_f32 v42, v152, v153
    v_cvt_pk_bf16_f32 v43, v154, v155
    v_cvt_pk_bf16_f32 v44, v156, v157
    v_cvt_pk_bf16_f32 v45, v158, v159
    v_cvt_pk_bf16_f32 v46, v160, v161
    v_cvt_pk_bf16_f32 v47, v162, v163
    s_lshl_b32 s36, s32, 13
    s_add_u32 s36, s36, 0x3200000
    s_add_u32 s37, s36, 4096
    s_lshl_b32 s38, s31, 2
    s_add_u32 s38, s38, s28
    s_lshl_b32 s38, s38, 12
    s_lshl_b32 s39, s32, 7
    s_add_u32 s38, s38, s39
    s_add_u32 s38, s38, 0x2c0000
    v_and_b32 v252, 15, v0
    v_lshrrev_b32 v253, 2, v252
    v_lshrrev_b32 v254, 4, v0
    v_cmp_eq_u32 vcc, v253, v254
    v_lshlrev_b32 v252, 3, v252
    v_mov_b32 v253, 0x80000000
    v_cndmask_b32 v252, v253, v252, vcc
    buffer_store_dwordx4 v[32:35], v4, s[4:7], s36 offen offset:0 sc1
    buffer_store_dwordx4 v[36:39], v4, s[4:7], s37 offen offset:0 sc1
    buffer_store_dwordx4 v[40:43], v4, s[4:7], s36 offen offset:1024 sc1
    buffer_store_dwordx4 v[44:47], v4, s[4:7], s37 offen offset:1024 sc1
    v_mfma_f32_16x16x32_bf16 v[96:99], v[32:35], v[32:35], 0
    v_mfma_f32_16x16x32_bf16 v[92:95], v[16:19], v[32:35], 0
    v_mfma_f32_16x16x32_bf16 v[104:107], v[40:43], v[40:43], 0
    v_mfma_f32_16x16x32_bf16 v[100:103], v[16:19], v[40:43], 0
    v_mfma_f32_16x16x32_bf16 v[96:99], v[36:39], v[36:39], v[96:99]
    v_mfma_f32_16x16x32_bf16 v[92:95], v[16:19], v[36:39], v[92:95]
    v_mfma_f32_16x16x32_bf16 v[104:107], v[44:47], v[44:47], v[104:107]
    v_mfma_f32_16x16x32_bf16 v[100:103], v[16:19], v[44:47], v[100:103]
    s_nop 4
    v_cndmask_b32 v96, v96, v97, s[46:47]
    v_cndmask_b32 v98, v98, v99, s[46:47]
    v_cndmask_b32 v93, v96, v98, s[48:49]
    buffer_store_dwordx2 v[92:93], v252, s[4:7], s38 offen offset:0 sc1
    v_cndmask_b32 v104, v104, v105, s[46:47]
    v_cndmask_b32 v106, v106, v107, s[46:47]
    v_cndmask_b32 v101, v104, v106, s[48:49]
    buffer_store_dwordx2 v[100:101], v252, s[4:7], s38 offen offset:2048 sc1
    s_lshr_b32 s36, s31, 1
    s_lshl_b32 s36, s36, 13
    v_lshl_add_u32 v10, v0, 8, s36
    s_mov_b32 s38, 0
    s_mov_b32 s54, 32
    s_waitcnt vmcnt(0)
    s_barrier
    s_cmp_lg_u32 s28, 0
    s_cbranch_scc1 Lsig_25
    s_mov_b32 exec_hi, s38
    s_mov_b32 s36, 0x60000
    buffer_atomic_add v12, v10, s[4:7], s36 offen sc1
    s_mov_b64 exec, -1
Lsig_25:
    s_lshl_b32 s44, s28, 1
    s_add_u32 s44, s44, s33
    s_add_u32 s44, s44, 0
    s_and_b32 s44, s44, 31
    s_mul_i32 s44, s44, 6144
    s_add_u32 s44, s44, s50
    s_add_u32 s44, s44, 0x1400000
    s_mul_i32 s45, s28, 12288
    s_add_u32 m0, s45, 0
    s_nop 0
    buffer_load_dwordx4 v1, s[4:7], s44 offen offset:0 sc1 lds
    buffer_load_dwordx4 v1, s[4:7], s44 offen offset:1024 sc1 lds
    buffer_load_dwordx4 v1, s[4:7], s44 offen offset:2048 sc1 lds
    buffer_load_dwordx4 v1, s[4:7], s44 offen offset:3072 sc1 lds
    s_add_u32 s44, s44, 4096
    s_add_u32 m0, m0, 4096
    s_nop 0
    buffer_load_dwordx4 v1, s[4:7], s44 offen offset:0 sc1 lds
    buffer_load_dwordx4 v1, s[4:7], s44 offen offset:1024 sc1 lds
    buffer_load_dwordx4 v1, s[4:7], s44 offen offset:2048 sc1 lds
    buffer_load_dwordx4 v1, s[4:7], s44 offen offset:3072 sc1 lds
    s_add_u32 s44, s44, 4096
    s_add_u32 m0, m0, 4096
    s_nop 0
    buffer_load_dwordx4 v1, s[4:7], s44 offen offset:0 sc1 lds
    buffer_load_dwordx4 v1, s[4:7], s44 offen offset:1024 sc1 lds
    buffer_load_dwordx4 v1, s[4:7], s44 offen offset:2048 sc1 lds
    buffer_load_dwordx4 v1, s[4:7], s44 offen offset:3072 sc1 lds
    s_lshl_b32 s44, s28, 1
    s_add_u32 s44, s44, s33
    s_add_u32 s44, s44, 8
    s_and_b32 s44, s44, 31
    s_mul_i32 s44, s44, 6144
    s_add_u32 s44, s44, s50
    s_add_u32 s44, s44, 0x1400000
    s_mul_i32 s45, s28, 12288
    s_add_u32 m0, s45, 49152
    s_nop 0
    buffer_load_dwordx4 v1, s[4:7], s44 offen offset:0 sc1 lds
    buffer_load_dwordx4 v1, s[4:7], s44 offen offset:1024 sc1 lds
    buffer_load_dwordx4 v1, s[4:7], s44 offen offset:2048 sc1 lds
    buffer_load_dwordx4 v1, s[4:7], s44 offen offset:3072 sc1 lds
    s_add_u32 s44, s44, 4096
    s_add_u32 m0, m0, 4096
    s_nop 0
    buffer_load_dwordx4 v1, s[4:7], s44 offen offset:0 sc1 lds
    buffer_load_dwordx4 v1, s[4:7], s44 offen offset:1024 sc1 lds
    buffer_load_dwordx4 v1, s[4:7], s44 offen offset:2048 sc1 lds
    buffer_load_dwordx4 v1, s[4:7], s44 offen offset:3072 sc1 lds
    s_add_u32 s44, s44, 4096
    s_add_u32 m0, m0, 4096
    s_nop 0
    buffer_load_dwordx4 v1, s[4:7], s44 offen offset:0 sc1 lds
    buffer_load_dwordx4 v1, s[4:7], s44 offen offset:1024 sc1 lds
    buffer_load_dwordx4 v1, s[4:7], s44 offen offset:2048 sc1 lds
    buffer_load_dwordx4 v1, s[4:7], s44 offen offset:3072 sc1 lds
    s_add_u32 s40, s4, 0x3200000
    s_addc_u32 s41, s5, 0
    s_lshl_b32 s36, s29, 5
    s_add_u32 s36, s36, s30
    s_lshl_b32 s36, s36, 8
    v_mov_b32 v10, s36
    s_cmp_lg_u32 s28, 0
    s_cbranch_scc1 Lpe_27
    s_mov_b32 s36, 0x60000
    s_mov_b32 s37, 0
Lpoll_26:
    buffer_load_dword v11, v10, s[4:7], s36 offen sc1
    s_add_u32 s37, s37, 1
    s_waitcnt vmcnt(0)
    v_cmp_gt_u32 vcc, s54, v11
    s_cbranch_vccz Lpe_27
    s_cmp_lt_u32 s37, 0x100000
    s_cbranch_scc1 Lpoll_26
Lpe_27:
    s_waitcnt vmcnt(0)
    s_barrier
    s_lshl_b32 s35, s33, 12
    s_add_u32 s39, s28, 2
    s_lshl_b32 s39, s39, 10
    buffer_load_dwordx4 a[0:3], v2, s[40:43], s35 offen offset:0 sc1
    buffer_load_dwordx4 a[4:7], v2, s[40:43], s35 offen offset:1024 sc1
    buffer_load_dwordx4 a[8:11], v2, s[40:43], s35 offen offset:2048 sc1
    buffer_load_dwordx4 a[12:15], v2, s[40:43], s35 offen offset:3072 sc1
    s_add_u32 s35, s35, 4096
    s_and_b32 s35, s35, 0x1ffff
    buffer_load_dwordx4 a[20:23], v2, s[40:43], s35 offen offset:0 sc1
    buffer_load_dwordx4 a[24:27], v2, s[40:43], s35 offen offset:1024 sc1
    buffer_load_dwordx4 a[28:31], v2, s[40:43], s35 offen offset:2048 sc1
    buffer_load_dwordx4 a[32:35], v2, s[40:43], s35 offen offset:3072 sc1
    s_add_u32 s35, s35, 4096
    s_and_b32 s35, s35, 0x1ffff
    buffer_load_dwordx4 a[40:43], v2, s[40:43], s35 offen offset:0 sc1
    buffer_load_dwordx4 a[44:47], v2, s[40:43], s35 offen offset:1024 sc1
    buffer_load_dwordx4 a[48:51], v2, s[40:43], s35 offen offset:2048 sc1
    buffer_load_dwordx4 a[52:55], v2, s[40:43], s35 offen offset:3072 sc1
    s_add_u32 s35, s35, 4096
    s_and_b32 s35, s35, 0x1ffff
    v_accvgpr_read_b32 v48, a164
    v_accvgpr_read_b32 v49, a165
    v_accvgpr_read_b32 v50, a166
    v_accvgpr_read_b32 v51, a167
    v_accvgpr_read_b32 v52, a168
    v_accvgpr_read_b32 v53, a169
    v_accvgpr_read_b32 v54, a170
    v_accvgpr_read_b32 v55, a171
    v_accvgpr_read_b32 v56, a172
    v_accvgpr_read_b32 v57, a173
    v_accvgpr_read_b32 v58, a174
    v_accvgpr_read_b32 v59, a175
    v_accvgpr_read_b32 v60, a176
    v_accvgpr_read_b32 v61, a177
    v_accvgpr_read_b32 v62, a178
    v_accvgpr_read_b32 v63, a179
    v_accvgpr_read_b32 v64, a180
    v_accvgpr_read_b32 v65, a181
    v_accvgpr_read_b32 v66, a182
    v_accvgpr_read_b32 v67, a183
    v_accvgpr_read_b32 v68, a184
    v_accvgpr_read_b32 v69, a185
    v_accvgpr_read_b32 v70, a186
    v_accvgpr_read_b32 v71, a187
    v_add_u32 v5, 0, v1
    ds_read_b128 a[80:83], v5 offset:0
    ds_read_b128 a[84:87], v5 offset:1024
    ds_read_b128 a[88:91], v5 offset:2048
    ds_read_b128 a[92:95], v5 offset:3072
    ds_read_b128 a[96:99], v5 offset:4096
    ds_read_b128 a[100:103], v5 offset:5120
    s_waitcnt vmcnt(8) lgkmcnt(0)
    v_mfma_f32_16x16x32_bf16 v[132:135], a[80:83], a[0:3], 0
    ds_read_b128 a[108:111], v5 offset:6144
    v_mfma_f32_16x16x32_bf16 v[156:159], a[80:83], a[4:7], 0
    buffer_load_dwordx4 a[60:63], v2, s[40:43], s35 offen offset:0 sc1
    v_mfma_f32_16x16x32_bf16 v[180:183], a[80:83], a[8:11], 0
    ds_read_b128 a[112:115], v5 offset:7168
    v_mfma_f32_16x16x32_bf16 v[204:207], a[80:83], a[12:15], 0
    v_mfma_f32_16x16x32_bf16 v[136:139], a[84:87], a[0:3], 0
    buffer_load_dwordx4 a[64:67], v2, s[40:43], s35 offen offset:1024 sc1
    v_mfma_f32_16x16x32_bf16 v[160:163], a[84:87], a[4:7], 0
    ds_read_b128 a[116:119], v5 offset:8192
    v_mfma_f32_16x16x32_bf16 v[184:187], a[84:87], a[8:11], 0
    v_mfma_f32_16x16x32_bf16 v[208:211], a[84:87], a[12:15], 0
    v_mfma_f32_16x16x32_bf16 v[140:143], a[88:91], a[0:3], 0
    ds_read_b128 a[120:123], v5 offset:9216
    buffer_load_dwordx4 a[68:71], v2, s[40:43], s35 offen offset:2048 sc1
    v_mfma_f32_16x16x32_bf16 v[164:167], a[88:91], a[4:7], 0
    v_mfma_f32_16x16x32_bf16 v[188:191], a[88:91], a[8:11], 0
    v_mfma_f32_16x16x32_bf16 v[212:215], a[88:91], a[12:15], 0
    ds_read_b128 a[124:127], v5 offset:10240
    v_mfma_f32_16x16x32_bf16 v[144:147], a[92:95], a[0:3], 0
    buffer_load_dwordx4 a[72:75], v2, s[40:43], s35 offen offset:3072 sc1
    s_add_u32 s35, s35, 4096
    s_and_b32 s35, s35, 0x1ffff
    v_mfma_f32_16x16x32_bf16 v[168:171], a[92:95], a[4:7], 0
    v_mfma_f32_16x16x32_bf16 v[192:195], a[92:95], a[8:11], 0
    ds_read_b128 a[128:131], v5 offset:11264
    v_mfma_f32_16x16x32_bf16 v[216:219], a[92:95], a[12:15], 0
    v_mfma_f32_16x16x32_bf16 v[148:151], a[96:99], a[0:3], 0
    s_lshl_b32 s44, s28, 1
    s_add_u32 s44, s44, s33
    s_add_u32 s44, s44, 16
    s_and_b32 s44, s44, 31
    s_mul_i32 s44, s44, 6144
    s_add_u32 s44, s44, s50
    s_add_u32 s44, s44, 0x1400000
    s_mul_i32 s45, s28, 12288
    s_add_u32 m0, s45, 98304
    s_nop 0
    buffer_load_dwordx4 v1, s[4:7], s44 offen offset:0 sc1 lds
    v_mfma_f32_16x16x32_bf16 v[172:175], a[96:99], a[4:7], 0
    v_mfma_f32_16x16x32_bf16 v[196:199], a[96:99], a[8:11], 0
    v_mfma_f32_16x16x32_bf16 v[220:223], a[96:99], a[12:15], 0
    v_mfma_f32_16x16x32_bf16 v[152:155], a[100:103], a[0:3], 0
    buffer_load_dwordx4 v1, s[4:7], s44 offen offset:1024 sc1 lds
    v_mfma_f32_16x16x32_bf16 v[176:179], a[100:103], a[4:7], 0
    v_mfma_f32_16x16x32_bf16 v[200:203], a[100:103], a[8:11], 0
    v_mfma_f32_16x16x32_bf16 v[224:227], a[100:103], a[12:15], 0
    s_waitcnt vmcnt(10) lgkmcnt(0)
    v_mfma_f32_16x16x32_bf16 v[132:135], a[108:111], a[20:23], v[132:135]
    ds_read_b128 a[80:83], v5 offset:12288
    v_mfma_f32_16x16x32_bf16 v[156:159], a[108:111], a[24:27], v[156:159]
    buffer_load_dwordx4 a[0:3], v2, s[40:43], s35 offen offset:0 sc1
    v_mfma_f32_16x16x32_bf16 v[180:183], a[108:111], a[28:31], v[180:183]
    ds_read_b128 a[84:87], v5 offset:13312
    v_mfma_f32_16x16x32_bf16 v[204:207], a[108:111], a[32:35], v[204:207]
    v_mfma_f32_16x16x32_bf16 v[136:139], a[112:115], a[20:23], v[136:139]
    buffer_load_dwordx4 a[4:7], v2, s[40:43], s35 offen offset:1024 sc1
    v_mfma_f32_16x16x32_bf16 v[160:163], a[112:115], a[24:27], v[160:163]
    ds_read_b128 a[88:91], v5 offset:14336
    v_mfma_f32_16x16x32_bf16 v[184:187], a[112:115], a[28:31], v[184:187]
    v_mfma_f32_16x16x32_bf16 v[208:211], a[112:115], a[32:35], v[208:211]
    v_mfma_f32_16x16x32_bf16 v[140:143], a[116:119], a[20:23], v[140:143]
    ds_read_b128 a[92:95], v5 offset:15360
    buffer_load_dwordx4 a[8:11], v2, s[40:43], s35 offen offset:2048 sc1
    v_mfma_f32_16x16x32_bf16 v[164:167], a[116:119], a[24:27], v[164:167]
    v_mfma_f32_16x16x32_bf16 v[188:191], a[116:119], a[28:31], v[188:191]
    v_mfma_f32_16x16x32_bf16 v[212:215], a[116:119], a[32:35], v[212:215]
    ds_read_b128 a[96:99], v5 offset:16384
    v_mfma_f32_16x16x32_bf16 v[144:147], a[120:123], a[20:23], v[144:147]
    buffer_load_dwordx4 a[12:15], v2, s[40:43], s35 offen offset:3072 sc1
    s_add_u32 s35, s35, 4096
    s_and_b32 s35, s35, 0x1ffff
    v_mfma_f32_16x16x32_bf16 v[168:171], a[120:123], a[24:27], v[168:171]
    v_mfma_f32_16x16x32_bf16 v[192:195], a[120:123], a[28:31], v[192:195]
    ds_read_b128 a[100:103], v5 offset:17408
    v_mfma_f32_16x16x32_bf16 v[216:219], a[120:123], a[32:35], v[216:219]
    v_mfma_f32_16x16x32_bf16 v[148:151], a[124:127], a[20:23], v[148:151]
    buffer_load_dwordx4 v1, s[4:7], s44 offen offset:2048 sc1 lds
    v_mfma_f32_16x16x32_bf16 v[172:175], a[124:127], a[24:27], v[172:175]
    v_mfma_f32_16x16x32_bf16 v[196:199], a[124:127], a[28:31], v[196:199]
    v_mfma_f32_16x16x32_bf16 v[220:223], a[124:127], a[32:35], v[220:223]
    v_mfma_f32_16x16x32_bf16 v[152:155], a[128:131], a[20:23], v[152:155]
    buffer_load_dwordx4 v1, s[4:7], s44 offen offset:3072 sc1 lds
    v_mfma_f32_16x16x32_bf16 v[176:179], a[128:131], a[24:27], v[176:179]
    v_mfma_f32_16x16x32_bf16 v[200:203], a[128:131], a[28:31], v[200:203]
    v_mfma_f32_16x16x32_bf16 v[224:227], a[128:131], a[32:35], v[224:227]
    s_waitcnt vmcnt(12) lgkmcnt(0)
    v_mfma_f32_16x16x32_bf16 v[132:135], a[80:83], a[40:43], v[132:135]
    ds_read_b128 a[108:111], v5 offset:18432
    v_mfma_f32_16x16x32_bf16 v[156:159], a[80:83], a[44:47], v[156:159]
    buffer_load_dwordx4 a[20:23], v2, s[40:43], s35 offen offset:0 sc1
    v_mfma_f32_16x16x32_bf16 v[180:183], a[80:83], a[48:51], v[180:183]
    ds_read_b128 a[112:115], v5 offset:19456
    v_mfma_f32_16x16x32_bf16 v[204:207], a[80:83], a[52:55], v[204:207]
    v_mfma_f32_16x16x32_bf16 v[136:139], a[84:87], a[40:43], v[136:139]
    buffer_load_dwordx4 a[24:27], v2, s[40:43], s35 offen offset:1024 sc1
    v_mfma_f32_16x16x32_bf16 v[160:163], a[84:87], a[44:47], v[160:163]
    ds_read_b128 a[116:119], v5 offset:20480
    v_mfma_f32_16x16x32_bf16 v[184:187], a[84:87], a[48:51], v[184:187]
    v_mfma_f32_16x16x32_bf16 v[208:211], a[84:87], a[52:55], v[208:211]
    v_mfma_f32_16x16x32_bf16 v[140:143], a[88:91], a[40:43], v[140:143]
    ds_read_b128 a[120:123], v5 offset:21504
    buffer_load_dwordx4 a[28:31], v2, s[40:43], s35 offen offset:2048 sc1
    v_mfma_f32_16x16x32_bf16 v[164:167], a[88:91], a[44:47], v[164:167]
    v_mfma_f32_16x16x32_bf16 v[188:191], a[88:91], a[48:51], v[188:191]
    v_mfma_f32_16x16x32_bf16 v[212:215], a[88:91], a[52:55], v[212:215]
    ds_read_b128 a[124:127], v5 offset:22528
    v_mfma_f32_16x16x32_bf16 v[144:147], a[92:95], a[40:43], v[144:147]
    buffer_load_dwordx4 a[32:35], v2, s[40:43], s35 offen offset:3072 sc1
    s_add_u32 s35, s35, 4096
    s_and_b32 s35, s35, 0x1ffff
    v_mfma_f32_16x16x32_bf16 v[168:171], a[92:95], a[44:47], v[168:171]
    v_mfma_f32_16x16x32_bf16 v[192:195], a[92:95], a[48:51], v[192:195]
    ds_read_b128 a[128:131], v5 offset:23552
    v_mfma_f32_16x16x32_bf16 v[216:219], a[92:95], a[52:55], v[216:219]
    v_mfma_f32_16x16x32_bf16 v[148:151], a[96:99], a[40:43], v[148:151]
    s_add_u32 s44, s44, 4096
    s_add_u32 m0, m0, 4096
    s_nop 0
    buffer_load_dwordx4 v1, s[4:7], s44 offen offset:0 sc1 lds
    v_mfma_f32_16x16x32_bf16 v[172:175], a[96:99], a[44:47], v[172:175]
    v_mfma_f32_16x16x32_bf16 v[196:199], a[96:99], a[48:51], v[196:199]
    v_mfma_f32_16x16x32_bf16 v[220:223], a[96:99], a[52:55], v[220:223]
    v_mfma_f32_16x16x32_bf16 v[152:155], a[100:103], a[40:43], v[152:155]
    buffer_load_dwordx4 v1, s[4:7], s44 offen offset:1024 sc1 lds
    v_mfma_f32_16x16x32_bf16 v[176:179], a[100:103], a[44:47], v[176:179]
    v_mfma_f32_16x16x32_bf16 v[200:203], a[100:103], a[48:51], v[200:203]
    v_mfma_f32_16x16x32_bf16 v[224:227], a[100:103], a[52:55], v[224:227]
    s_waitcnt vmcnt(14) lgkmcnt(0)
    v_mfma_f32_16x16x32_bf16 v[132:135], a[108:111], a[60:63], v[132:135]
    ds_read_b128 a[80:83], v5 offset:24576
    v_mfma_f32_16x16x32_bf16 v[156:159], a[108:111], a[64:67], v[156:159]
    buffer_load_dwordx4 a[40:43], v2, s[40:43], s35 offen offset:0 sc1
    v_mfma_f32_16x16x32_bf16 v[180:183], a[108:111], a[68:71], v[180:183]
    ds_read_b128 a[84:87], v5 offset:25600
    v_mfma_f32_16x16x32_bf16 v[204:207], a[108:111], a[72:75], v[204:207]
    v_mfma_f32_16x16x32_bf16 v[136:139], a[112:115], a[60:63], v[136:139]
    v_mfma_f32_16x16x32_bf16 v[160:163], a[112:115], a[64:67], v[160:163]
    ds_read_b128 a[88:91], v5 offset:26624
    buffer_load_dwordx4 a[44:47], v2, s[40:43], s35 offen offset:1024 sc1
    v_mfma_f32_16x16x32_bf16 v[184:187], a[112:115], a[68:71], v[184:187]
    v_mfma_f32_16x16x32_bf16 v[208:211], a[112:115], a[72:75], v[208:211]
    v_mfma_f32_16x16x32_bf16 v[140:143], a[116:119], a[60:63], v[140:143]
    ds_read_b128 a[92:95], v5 offset:27648
    v_mfma_f32_16x16x32_bf16 v[164:167], a[116:119], a[64:67], v[164:167]
    v_mfma_f32_16x16x32_bf16 v[188:191], a[116:119], a[68:71], v[188:191]
    buffer_load_dwordx4 a[48:51], v2, s[40:43], s35 offen offset:2048 sc1
    v_mfma_f32_16x16x32_bf16 v[212:215], a[116:119], a[72:75], v[212:215]
    ds_read_b128 a[96:99], v5 offset:28672
    v_mfma_f32_16x16x32_bf16 v[144:147], a[120:123], a[60:63], v[144:147]
    v_mfma_f32_16x16x32_bf16 v[168:171], a[120:123], a[64:67], v[168:171]
    v_mfma_f32_16x16x32_bf16 v[192:195], a[120:123], a[68:71], v[192:195]
    ds_read_b128 a[100:103], v5 offset:29696
    buffer_load_dwordx4 a[52:55], v2, s[40:43], s35 offen offset:3072 sc1
    s_add_u32 s35, s35, 4096
    s_and_b32 s35, s35, 0x1ffff
    v_mfma_f32_16x16x32_bf16 v[216:219], a[120:123], a[72:75], v[216:219]
    v_mfma_f32_16x16x32_bf16 v[148:151], a[124:127], a[60:63], v[148:151]
    v_mfma_f32_16x16x32_bf16 v[172:175], a[124:127], a[64:67], v[172:175]
    v_mfma_f32_16x16x32_bf16 v[196:199], a[124:127], a[68:71], v[196:199]
    v_mfma_f32_16x16x32_bf16 v[220:223], a[124:127], a[72:75], v[220:223]
    buffer_load_dwordx4 v1, s[4:7], s44 offen offset:2048 sc1 lds
    v_mfma_f32_16x16x32_bf16 v[152:155], a[128:131], a[60:63], v[152:155]
    v_mfma_f32_16x16x32_bf16 v[176:179], a[128:131], a[64:67], v[176:179]
    v_mfma_f32_16x16x32_bf16 v[200:203], a[128:131], a[68:71], v[200:203]
    v_mfma_f32_16x16x32_bf16 v[224:227], a[128:131], a[72:75], v[224:227]
    s_waitcnt vmcnt(13) lgkmcnt(0)
    v_mfma_f32_16x16x32_bf16 v[132:135], a[80:83], a[0:3], v[132:135]
    ds_read_b128 a[108:111], v5 offset:30720
    v_mfma_f32_16x16x32_bf16 v[156:159], a[80:83], a[4:7], v[156:159]
    buffer_load_dwordx4 a[60:63], v2, s[40:43], s35 offen offset:0 sc1
    v_mfma_f32_16x16x32_bf16 v[180:183], a[80:83], a[8:11], v[180:183]
    ds_read_b128 a[112:115], v5 offset:31744
    v_mfma_f32_16x16x32_bf16 v[204:207], a[80:83], a[12:15], v[204:207]
    v_mfma_f32_16x16x32_bf16 v[136:139], a[84:87], a[0:3], v[136:139]
    buffer_load_dwordx4 a[64:67], v2, s[40:43], s35 offen offset:1024 sc1
    v_mfma_f32_16x16x32_bf16 v[160:163], a[84:87], a[4:7], v[160:163]
    ds_read_b128 a[116:119], v5 offset:32768
    v_mfma_f32_16x16x32_bf16 v[184:187], a[84:87], a[8:11], v[184:187]
    v_mfma_f32_16x16x32_bf16 v[208:211], a[84:87], a[12:15], v[208:211]
    v_mfma_f32_16x16x32_bf16 v[140:143], a[88:91], a[0:3], v[140:143]
    ds_read_b128 a[120:123], v5 offset:33792
    buffer_load_dwordx4 a[68:71], v2, s[40:43], s35 offen offset:2048 sc1
    v_mfma_f32_16x16x32_bf16 v[164:167], a[88:91], a[4:7], v[164:167]
    v_mfma_f32_16x16x32_bf16 v[188:191], a[88:91], a[8:11], v[188:191]
    v_mfma_f32_16x16x32_bf16 v[212:215], a[88:91], a[12:15], v[212:215]
    ds_read_b128 a[124:127], v5 offset:34816
    v_mfma_f32_16x16x32_bf16 v[144:147], a[92:95], a[0:3], v[144:147]
    buffer_load_dwordx4 a[72:75], v2, s[40:43], s35 offen offset:3072 sc1
    s_add_u32 s35, s35, 4096
    s_and_b32 s35, s35, 0x1ffff
    v_mfma_f32_16x16x32_bf16 v[168:171], a[92:95], a[4:7], v[168:171]
    v_mfma_f32_16x16x32_bf16 v[192:195], a[92:95], a[8:11], v[192:195]
    ds_read_b128 a[128:131], v5 offset:35840
    v_mfma_f32_16x16x32_bf16 v[216:219], a[92:95], a[12:15], v[216:219]
    v_mfma_f32_16x16x32_bf16 v[148:151], a[96:99], a[0:3], v[148:151]
    buffer_load_dwordx4 v1, s[4:7], s44 offen offset:3072 sc1 lds
    v_mfma_f32_16x16x32_bf16 v[172:175], a[96:99], a[4:7], v[172:175]
    v_mfma_f32_16x16x32_bf16 v[196:199], a[96:99], a[8:11], v[196:199]
    v_mfma_f32_16x16x32_bf16 v[220:223], a[96:99], a[12:15], v[220:223]
    v_mfma_f32_16x16x32_bf16 v[152:155], a[100:103], a[0:3], v[152:155]
    s_add_u32 s44, s44, 4096
    s_add_u32 m0, m0, 4096
    s_nop 0
    buffer_load_dwordx4 v1, s[4:7], s44 offen offset:0 sc1 lds
    v_mfma_f32_16x16x32_bf16 v[176:179], a[100:103], a[4:7], v[176:179]
    v_mfma_f32_16x16x32_bf16 v[200:203], a[100:103], a[8:11], v[200:203]
    v_mfma_f32_16x16x32_bf16 v[224:227], a[100:103], a[12:15], v[224:227]
    s_waitcnt vmcnt(13) lgkmcnt(0)
    v_mfma_f32_16x16x32_bf16 v[132:135], a[108:111], a[20:23], v[132:135]
    ds_read_b128 a[80:83], v5 offset:36864
    v_mfma_f32_16x16x32_bf16 v[156:159], a[108:111], a[24:27], v[156:159]
    buffer_load_dwordx4 a[0:3], v2, s[40:43], s35 offen offset:0 sc1
    v_mfma_f32_16x16x32_bf16 v[180:183], a[108:111], a[28:31], v[180:183]
    ds_read_b128 a[84:87], v5 offset:37888
    v_mfma_f32_16x16x32_bf16 v[204:207], a[108:111], a[32:35], v[204:207]
    v_mfma_f32_16x16x32_bf16 v[136:139], a[112:115], a[20:23], v[136:139]
    buffer_load_dwordx4 a[4:7], v2, s[40:43], s35 offen offset:1024 sc1
    v_mfma_f32_16x16x32_bf16 v[160:163], a[112:115], a[24:27], v[160:163]
    ds_read_b128 a[88:91], v5 offset:38912
    v_mfma_f32_16x16x32_bf16 v[184:187], a[112:115], a[28:31], v[184:187]
    v_mfma_f32_16x16x32_bf16 v[208:211], a[112:115], a[32:35], v[208:211]
    v_mfma_f32_16x16x32_bf16 v[140:143], a[116:119], a[20:23], v[140:143]
    ds_read_b128 a[92:95], v5 offset:39936
    buffer_load_dwordx4 a[8:11], v2, s[40:43], s35 offen offset:2048 sc1
    v_mfma_f32_16x16x32_bf16 v[164:167], a[116:119], a[24:27], v[164:167]
    v_mfma_f32_16x16x32_bf16 v[188:191], a[116:119], a[28:31], v[188:191]
    v_mfma_f32_16x16x32_bf16 v[212:215], a[116:119], a[32:35], v[212:215]
    ds_read_b128 a[96:99], v5 offset:40960
    v_mfma_f32_16x16x32_bf16 v[144:147], a[120:123], a[20:23], v[144:147]
    buffer_load_dwordx4 a[12:15], v2, s[40:43], s35 offen offset:3072 sc1
    s_add_u32 s35, s35, 4096
    s_and_b32 s35, s35, 0x1ffff
    v_mfma_f32_16x16x32_bf16 v[168:171], a[120:123], a[24:27], v[168:171]
    v_mfma_f32_16x16x32_bf16 v[192:195], a[120:123], a[28:31], v[192:195]
    ds_read_b128 a[100:103], v5 offset:41984
    v_mfma_f32_16x16x32_bf16 v[216:219], a[120:123], a[32:35], v[216:219]
    v_mfma_f32_16x16x32_bf16 v[148:151], a[124:127], a[20:23], v[148:151]
    buffer_load_dwordx4 v1, s[4:7], s44 offen offset:1024 sc1 lds
    v_mfma_f32_16x16x32_bf16 v[172:175], a[124:127], a[24:27], v[172:175]
    v_mfma_f32_16x16x32_bf16 v[196:199], a[124:127], a[28:31], v[196:199]
    v_mfma_f32_16x16x32_bf16 v[220:223], a[124:127], a[32:35], v[220:223]
    v_mfma_f32_16x16x32_bf16 v[152:155], a[128:131], a[20:23], v[152:155]
    buffer_load_dwordx4 v1, s[4:7], s44 offen offset:2048 sc1 lds
    v_mfma_f32_16x16x32_bf16 v[176:179], a[128:131], a[24:27], v[176:179]
    v_mfma_f32_16x16x32_bf16 v[200:203], a[128:131], a[28:31], v[200:203]
    v_mfma_f32_16x16x32_bf16 v[224:227], a[128:131], a[32:35], v[224:227]
    s_waitcnt vmcnt(13) lgkmcnt(0)
    v_mfma_f32_16x16x32_bf16 v[132:135], a[80:83], a[40:43], v[132:135]
    ds_read_b128 a[108:111], v5 offset:43008
    v_mfma_f32_16x16x32_bf16 v[156:159], a[80:83], a[44:47], v[156:159]
    buffer_load_dwordx4 a[20:23], v2, s[40:43], s35 offen offset:0 sc1
    v_mfma_f32_16x16x32_bf16 v[180:183], a[80:83], a[48:51], v[180:183]
    ds_read_b128 a[112:115], v5 offset:44032
    v_mfma_f32_16x16x32_bf16 v[204:207], a[80:83], a[52:55], v[204:207]
    v_mfma_f32_16x16x32_bf16 v[136:139], a[84:87], a[40:43], v[136:139]
    v_mfma_f32_16x16x32_bf16 v[160:163], a[84:87], a[44:47], v[160:163]
    ds_read_b128 a[116:119], v5 offset:45056
    buffer_load_dwordx4 a[24:27], v2, s[40:43], s35 offen offset:1024 sc1
    v_mfma_f32_16x16x32_bf16 v[184:187], a[84:87], a[48:51], v[184:187]
    v_mfma_f32_16x16x32_bf16 v[208:211], a[84:87], a[52:55], v[208:211]
    v_mfma_f32_16x16x32_bf16 v[140:143], a[88:91], a[40:43], v[140:143]
    ds_read_b128 a[120:123], v5 offset:46080
    v_mfma_f32_16x16x32_bf16 v[164:167], a[88:91], a[44:47], v[164:167]
    v_mfma_f32_16x16x32_bf16 v[188:191], a[88:91], a[48:51], v[188:191]
    buffer_load_dwordx4 a[28:31], v2, s[40:43], s35 offen offset:2048 sc1
    v_mfma_f32_16x16x32_bf16 v[212:215], a[88:91], a[52:55], v[212:215]
    ds_read_b128 a[124:127], v5 offset:47104
    v_mfma_f32_16x16x32_bf16 v[144:147], a[92:95], a[40:43], v[144:147]
    v_mfma_f32_16x16x32_bf16 v[168:171], a[92:95], a[44:47], v[168:171]
    v_mfma_f32_16x16x32_bf16 v[192:195], a[92:95], a[48:51], v[192:195]
    ds_read_b128 a[128:131], v5 offset:48128
    buffer_load_dwordx4 a[32:35], v2, s[40:43], s35 offen offset:3072 sc1
    s_add_u32 s35, s35, 4096
    s_and_b32 s35, s35, 0x1ffff
    v_mfma_f32_16x16x32_bf16 v[216:219], a[92:95], a[52:55], v[216:219]
    v_mfma_f32_16x16x32_bf16 v[148:151], a[96:99], a[40:43], v[148:151]
    v_mfma_f32_16x16x32_bf16 v[172:175], a[96:99], a[44:47], v[172:175]
    v_mfma_f32_16x16x32_bf16 v[196:199], a[96:99], a[48:51], v[196:199]
    v_mfma_f32_16x16x32_bf16 v[220:223], a[96:99], a[52:55], v[220:223]
    buffer_load_dwordx4 v1, s[4:7], s44 offen offset:3072 sc1 lds
    v_mfma_f32_16x16x32_bf16 v[152:155], a[100:103], a[40:43], v[152:155]
    v_mfma_f32_16x16x32_bf16 v[176:179], a[100:103], a[44:47], v[176:179]
    v_mfma_f32_16x16x32_bf16 v[200:203], a[100:103], a[48:51], v[200:203]
    v_mfma_f32_16x16x32_bf16 v[224:227], a[100:103], a[52:55], v[224:227]
    s_waitcnt vmcnt(13) lgkmcnt(0)
    s_barrier
    v_mfma_f32_16x16x32_bf16 v[132:135], a[108:111], a[60:63], v[132:135]
    v_add_u32 v5, 49152, v1
    ds_read_b128 a[80:83], v5 offset:0
    v_mfma_f32_16x16x32_bf16 v[156:159], a[108:111], a[64:67], v[156:159]
    buffer_load_dwordx4 a[40:43], v2, s[40:43], s35 offen offset:0 sc1
    v_mfma_f32_16x16x32_bf16 v[180:183], a[108:111], a[68:71], v[180:183]
    ds_read_b128 a[84:87], v5 offset:1024
    v_mfma_f32_16x16x32_bf16 v[204:207], a[108:111], a[72:75], v[204:207]
    v_mfma_f32_16x16x32_bf16 v[136:139], a[112:115], a[60:63], v[136:139]
    buffer_load_dwordx4 a[44:47], v2, s[40:43], s35 offen offset:1024 sc1
    v_mfma_f32_16x16x32_bf16 v[160:163], a[112:115], a[64:67], v[160:163]
    ds_read_b128 a[88:91], v5 offset:2048
    v_mfma_f32_16x16x32_bf16 v[184:187], a[112:115], a[68:71], v[184:187]
    v_mfma_f32_16x16x32_bf16 v[208:211], a[112:115], a[72:75], v[208:211]
    v_mfma_f32_16x16x32_bf16 v[140:143], a[116:119], a[60:63], v[140:143]
    ds_read_b128 a[92:95], v5 offset:3072
    buffer_load_dwordx4 a[48:51], v2, s[40:43], s35 offen offset:2048 sc1
    v_mfma_f32_16x16x32_bf16 v[164:167], a[116:119], a[64:67], v[164:167]
    v_mfma_f32_16x16x32_bf16 v[188:191], a[116:119], a[68:71], v[188:191]
    v_mfma_f32_16x16x32_bf16 v[212:215], a[116:119], a[72:75], v[212:215]
    ds_read_b128 a[96:99], v5 offset:4096
    v_mfma_f32_16x16x32_bf16 v[144:147], a[120:123], a[60:63], v[144:147]
    buffer_load_dwordx4 a[52:55], v2, s[40:43], s35 offen offset:3072 sc1
    s_add_u32 s35, s35, 4096
    s_and_b32 s35, s35, 0x1ffff
    v_mfma_f32_16x16x32_bf16 v[168:171], a[120:123], a[64:67], v[168:171]
    v_mfma_f32_16x16x32_bf16 v[192:195], a[120:123], a[68:71], v[192:195]
    ds_read_b128 a[100:103], v5 offset:5120
    v_mfma_f32_16x16x32_bf16 v[216:219], a[120:123], a[72:75], v[216:219]
    v_mfma_f32_16x16x32_bf16 v[148:151], a[124:127], a[60:63], v[148:151]
    s_lshl_b32 s44, s28, 1
    s_add_u32 s44, s44, s33
    s_add_u32 s44, s44, 24
    s_and_b32 s44, s44, 31
    s_mul_i32 s44, s44, 6144
    s_add_u32 s44, s44, s50
    s_add_u32 s44, s44, 0x1400000
    s_mul_i32 s45, s28, 12288
    s_add_u32 m0, s45, 0
    s_nop 0
    buffer_load_dwordx4 v1, s[4:7], s44 offen offset:0 sc1 lds
    v_mfma_f32_16x16x32_bf16 v[172:175], a[124:127], a[64:67], v[172:175]
    v_mfma_f32_16x16x32_bf16 v[196:199], a[124:127], a[68:71], v[196:199]
    v_mfma_f32_16x16x32_bf16 v[220:223], a[124:127], a[72:75], v[220:223]
    v_mfma_f32_16x16x32_bf16 v[152:155], a[128:131], a[60:63], v[152:155]
    buffer_load_dwordx4 v1, s[4:7], s44 offen offset:1024 sc1 lds
    v_mfma_f32_16x16x32_bf16 v[176:179], a[128:131], a[64:67], v[176:179]
    v_mfma_f32_16x16x32_bf16 v[200:203], a[128:131], a[68:71], v[200:203]
    v_mfma_f32_16x16x32_bf16 v[224:227], a[128:131], a[72:75], v[224:227]
    s_waitcnt vmcnt(13) lgkmcnt(0)
    v_mfma_f32_16x16x32_bf16 v[132:135], a[80:83], a[0:3], v[132:135]
    ds_read_b128 a[108:111], v5 offset:6144
    v_mfma_f32_16x16x32_bf16 v[156:159], a[80:83], a[4:7], v[156:159]
    buffer_load_dwordx4 a[60:63], v2, s[40:43], s35 offen offset:0 sc1
    v_mfma_f32_16x16x32_bf16 v[180:183], a[80:83], a[8:11], v[180:183]
    ds_read_b128 a[112:115], v5 offset:7168
    v_mfma_f32_16x16x32_bf16 v[204:207], a[80:83], a[12:15], v[204:207]
    v_mfma_f32_16x16x32_bf16 v[136:139], a[84:87], a[0:3], v[136:139]
    v_mfma_f32_16x16x32_bf16 v[160:163], a[84:87], a[4:7], v[160:163]
    ds_read_b128 a[116:119], v5 offset:8192
    buffer_load_dwordx4 a[64:67], v2, s[40:43], s35 offen offset:1024 sc1
    v_mfma_f32_16x16x32_bf16 v[184:187], a[84:87], a[8:11], v[184:187]
    v_mfma_f32_16x16x32_bf16 v[208:211], a[84:87], a[12:15], v[208:211]
    v_mfma_f32_16x16x32_bf16 v[140:143], a[88:91], a[0:3], v[140:143]
    ds_read_b128 a[120:123], v5 offset:9216
    v_mfma_f32_16x16x32_bf16 v[164:167], a[88:91], a[4:7], v[164:167]
    v_mfma_f32_16x16x32_bf16 v[188:191], a[88:91], a[8:11], v[188:191]
    buffer_load_dwordx4 a[68:71], v2, s[40:43], s35 offen offset:2048 sc1
    v_mfma_f32_16x16x32_bf16 v[212:215], a[88:91], a[12:15], v[212:215]
    ds_read_b128 a[124:127], v5 offset:10240
    v_mfma_f32_16x16x32_bf16 v[144:147], a[92:95], a[0:3], v[144:147]
    v_mfma_f32_16x16x32_bf16 v[168:171], a[92:95], a[4:7], v[168:171]
    v_mfma_f32_16x16x32_bf16 v[192:195], a[92:95], a[8:11], v[192:195]
    ds_read_b128 a[128:131], v5 offset:11264
    buffer_load_dwordx4 a[72:75], v2, s[40:43], s35 offen offset:3072 sc1
    s_add_u32 s35, s35, 4096
    s_and_b32 s35, s35, 0x1ffff
    v_mfma_f32_16x16x32_bf16 v[216:219], a[92:95], a[12:15], v[216:219]
    v_mfma_f32_16x16x32_bf16 v[148:151], a[96:99], a[0:3], v[148:151]
    v_mfma_f32_16x16x32_bf16 v[172:175], a[96:99], a[4:7], v[172:175]
    v_mfma_f32_16x16x32_bf16 v[196:199], a[96:99], a[8:11], v[196:199]
    v_mfma_f32_16x16x32_bf16 v[220:223], a[96:99], a[12:15], v[220:223]
    buffer_load_dwordx4 v1, s[4:7], s44 offen offset:2048 sc1 lds
    v_mfma_f32_16x16x32_bf16 v[152:155], a[100:103], a[0:3], v[152:155]
    v_mfma_f32_16x16x32_bf16 v[176:179], a[100:103], a[4:7], v[176:179]
    v_mfma_f32_16x16x32_bf16 v[200:203], a[100:103], a[8:11], v[200:203]
    v_mfma_f32_16x16x32_bf16 v[224:227], a[100:103], a[12:15], v[224:227]
    s_waitcnt vmcnt(12) lgkmcnt(0)
    v_mfma_f32_16x16x32_bf16 v[132:135], a[108:111], a[20:23], v[132:135]
    ds_read_b128 a[80:83], v5 offset:12288
    v_mfma_f32_16x16x32_bf16 v[156:159], a[108:111], a[24:27], v[156:159]
    buffer_load_dwordx4 a[0:3], v2, s[40:43], s35 offen offset:0 sc1
    v_mfma_f32_16x16x32_bf16 v[180:183], a[108:111], a[28:31], v[180:183]
    ds_read_b128 a[84:87], v5 offset:13312
    v_mfma_f32_16x16x32_bf16 v[204:207], a[108:111], a[32:35], v[204:207]
    v_mfma_f32_16x16x32_bf16 v[136:139], a[112:115], a[20:23], v[136:139]
    buffer_load_dwordx4 a[4:7], v2, s[40:43], s35 offen offset:1024 sc1
    v_mfma_f32_16x16x32_bf16 v[160:163], a[112:115], a[24:27], v[160:163]
    ds_read_b128 a[88:91], v5 offset:14336
    v_mfma_f32_16x16x32_bf16 v[184:187], a[112:115], a[28:31], v[184:187]
    v_mfma_f32_16x16x32_bf16 v[208:211], a[112:115], a[32:35], v[208:211]
    v_mfma_f32_16x16x32_bf16 v[140:143], a[116:119], a[20:23], v[140:143]
    ds_read_b128 a[92:95], v5 offset:15360
    buffer_load_dwordx4 a[8:11], v2, s[40:43], s35 offen offset:2048 sc1
    v_mfma_f32_16x16x32_bf16 v[164:167], a[116:119], a[24:27], v[164:167]
    v_mfma_f32_16x16x32_bf16 v[188:191], a[116:119], a[28:31], v[188:191]
    v_mfma_f32_16x16x32_bf16 v[212:215], a[116:119], a[32:35], v[212:215]
    ds_read_b128 a[96:99], v5 offset:16384
    v_mfma_f32_16x16x32_bf16 v[144:147], a[120:123], a[20:23], v[144:147]
    buffer_load_dwordx4 a[12:15], v2, s[40:43], s35 offen offset:3072 sc1
    s_add_u32 s35, s35, 4096
    s_and_b32 s35, s35, 0x1ffff
    v_mfma_f32_16x16x32_bf16 v[168:171], a[120:123], a[24:27], v[168:171]
    v_mfma_f32_16x16x32_bf16 v[192:195], a[120:123], a[28:31], v[192:195]
    ds_read_b128 a[100:103], v5 offset:17408
    v_mfma_f32_16x16x32_bf16 v[216:219], a[120:123], a[32:35], v[216:219]
    v_mfma_f32_16x16x32_bf16 v[148:151], a[124:127], a[20:23], v[148:151]
    buffer_load_dwordx4 v1, s[4:7], s44 offen offset:3072 sc1 lds
    v_mfma_f32_16x16x32_bf16 v[172:175], a[124:127], a[24:27], v[172:175]
    v_mfma_f32_16x16x32_bf16 v[196:199], a[124:127], a[28:31], v[196:199]
    v_mfma_f32_16x16x32_bf16 v[220:223], a[124:127], a[32:35], v[220:223]
    v_mfma_f32_16x16x32_bf16 v[152:155], a[128:131], a[20:23], v[152:155]
    s_add_u32 s44, s44, 4096
    s_add_u32 m0, m0, 4096
    s_nop 0
    buffer_load_dwordx4 v1, s[4:7], s44 offen offset:0 sc1 lds
    v_mfma_f32_16x16x32_bf16 v[176:179], a[128:131], a[24:27], v[176:179]
    v_mfma_f32_16x16x32_bf16 v[200:203], a[128:131], a[28:31], v[200:203]
    v_mfma_f32_16x16x32_bf16 v[224:227], a[128:131], a[32:35], v[224:227]
    s_waitcnt vmcnt(13) lgkmcnt(0)
    v_mfma_f32_16x16x32_bf16 v[132:135], a[80:83], a[40:43], v[132:135]
    ds_read_b128 a[108:111], v5 offset:18432
    v_mfma_f32_16x16x32_bf16 v[156:159], a[80:83], a[44:47], v[156:159]
    buffer_load_dwordx4 a[20:23], v2, s[40:43], s35 offen offset:0 sc1
    v_mfma_f32_16x16x32_bf16 v[180:183], a[80:83], a[48:51], v[180:183]
    ds_read_b128 a[112:115], v5 offset:19456
    v_mfma_f32_16x16x32_bf16 v[204:207], a[80:83], a[52:55], v[204:207]
    v_mfma_f32_16x16x32_bf16 v[136:139], a[84:87], a[40:43], v[136:139]
    v_mfma_f32_16x16x32_bf16 v[160:163], a[84:87], a[44:47], v[160:163]
    ds_read_b128 a[116:119], v5 offset:20480
    buffer_load_dwordx4 a[24:27], v2, s[40:43], s35 offen offset:1024 sc1
    v_mfma_f32_16x16x32_bf16 v[184:187], a[84:87], a[48:51], v[184:187]
    v_mfma_f32_16x16x32_bf16 v[208:211], a[84:87], a[52:55], v[208:211]
    v_mfma_f32_16x16x32_bf16 v[140:143], a[88:91], a[40:43], v[140:143]
    ds_read_b128 a[120:123], v5 offset:21504
    v_mfma_f32_16x16x32_bf16 v[164:167], a[88:91], a[44:47], v[164:167]
    v_mfma_f32_16x16x32_bf16 v[188:191], a[88:91], a[48:51], v[188:191]
    buffer_load_dwordx4 a[28:31], v2, s[40:43], s35 offen offset:2048 sc1
    v_mfma_f32_16x16x32_bf16 v[212:215], a[88:91], a[52:55], v[212:215]
    ds_read_b128 a[124:127], v5 offset:22528
    v_mfma_f32_16x16x32_bf16 v[144:147], a[92:95], a[40:43], v[144:147]
    v_mfma_f32_16x16x32_bf16 v[168:171], a[92:95], a[44:47], v[168:171]
    v_mfma_f32_16x16x32_bf16 v[192:195], a[92:95], a[48:51], v[192:195]
    ds_read_b128 a[128:131], v5 offset:23552
    buffer_load_dwordx4 a[32:35], v2, s[40:43], s35 offen offset:3072 sc1
    s_add_u32 s35, s35, 4096
    s_and_b32 s35, s35, 0x1ffff
    v_mfma_f32_16x16x32_bf16 v[216:219], a[92:95], a[52:55], v[216:219]
    v_mfma_f32_16x16x32_bf16 v[148:151], a[96:99], a[40:43], v[148:151]
    v_mfma_f32_16x16x32_bf16 v[172:175], a[96:99], a[44:47], v[172:175]
    v_mfma_f32_16x16x32_bf16 v[196:199], a[96:99], a[48:51], v[196:199]
    v_mfma_f32_16x16x32_bf16 v[220:223], a[96:99], a[52:55], v[220:223]
    buffer_load_dwordx4 v1, s[4:7], s44 offen offset:1024 sc1 lds
    v_mfma_f32_16x16x32_bf16 v[152:155], a[100:103], a[40:43], v[152:155]
    v_mfma_f32_16x16x32_bf16 v[176:179], a[100:103], a[44:47], v[176:179]
    v_mfma_f32_16x16x32_bf16 v[200:203], a[100:103], a[48:51], v[200:203]
    v_mfma_f32_16x16x32_bf16 v[224:227], a[100:103], a[52:55], v[224:227]
    s_waitcnt vmcnt(12) lgkmcnt(0)
    v_mfma_f32_16x16x32_bf16 v[132:135], a[108:111], a[60:63], v[132:135]
    ds_read_b128 a[80:83], v5 offset:24576
    v_mfma_f32_16x16x32_bf16 v[156:159], a[108:111], a[64:67], v[156:159]
    buffer_load_dwordx4 a[40:43], v2, s[40:43], s35 offen offset:0 sc1
    v_mfma_f32_16x16x32_bf16 v[180:183], a[108:111], a[68:71], v[180:183]
    ds_read_b128 a[84:87], v5 offset:25600
    v_mfma_f32_16x16x32_bf16 v[204:207], a[108:111], a[72:75], v[204:207]
    v_mfma_f32_16x16x32_bf16 v[136:139], a[112:115], a[60:63], v[136:139]
    buffer_load_dwordx4 a[44:47], v2, s[40:43], s35 offen offset:1024 sc1
    v_mfma_f32_16x16x32_bf16 v[160:163], a[112:115], a[64:67], v[160:163]
    ds_read_b128 a[88:91], v5 offset:26624
    v_mfma_f32_16x16x32_bf16 v[184:187], a[112:115], a[68:71], v[184:187]
    v_mfma_f32_16x16x32_bf16 v[208:211], a[112:115], a[72:75], v[208:211]
    v_mfma_f32_16x16x32_bf16 v[140:143], a[116:119], a[60:63], v[140:143]
    ds_read_b128 a[92:95], v5 offset:27648
    buffer_load_dwordx4 a[48:51], v2, s[40:43], s35 offen offset:2048 sc1
    v_mfma_f32_16x16x32_bf16 v[164:167], a[116:119], a[64:67], v[164:167]
    v_mfma_f32_16x16x32_bf16 v[188:191], a[116:119], a[68:71], v[188:191]
    v_mfma_f32_16x16x32_bf16 v[212:215], a[116:119], a[72:75], v[212:215]
    ds_read_b128 a[96:99], v5 offset:28672
    v_mfma_f32_16x16x32_bf16 v[144:147], a[120:123], a[60:63], v[144:147]
    buffer_load_dwordx4 a[52:55], v2, s[40:43], s35 offen offset:3072 sc1
    s_add_u32 s35, s35, 4096
    s_and_b32 s35, s35, 0x1ffff
    v_mfma_f32_16x16x32_bf16 v[168:171], a[120:123], a[64:67], v[168:171]
    v_mfma_f32_16x16x32_bf16 v[192:195], a[120:123], a[68:71], v[192:195]
    ds_read_b128 a[100:103], v5 offset:29696
    v_mfma_f32_16x16x32_bf16 v[216:219], a[120:123], a[72:75], v[216:219]
    v_mfma_f32_16x16x32_bf16 v[148:151], a[124:127], a[60:63], v[148:151]
    buffer_load_dwordx4 v1, s[4:7], s44 offen offset:2048 sc1 lds
    v_mfma_f32_16x16x32_bf16 v[172:175], a[124:127], a[64:67], v[172:175]
    v_mfma_f32_16x16x32_bf16 v[196:199], a[124:127], a[68:71], v[196:199]
    v_mfma_f32_16x16x32_bf16 v[220:223], a[124:127], a[72:75], v[220:223]
    v_mfma_f32_16x16x32_bf16 v[152:155], a[128:131], a[60:63], v[152:155]
    buffer_load_dwordx4 v1, s[4:7], s44 offen offset:3072 sc1 lds
    v_mfma_f32_16x16x32_bf16 v[176:179], a[128:131], a[64:67], v[176:179]
    v_mfma_f32_16x16x32_bf16 v[200:203], a[128:131], a[68:71], v[200:203]
    v_mfma_f32_16x16x32_bf16 v[224:227], a[128:131], a[72:75], v[224:227]
    s_waitcnt vmcnt(13) lgkmcnt(0)
    v_mfma_f32_16x16x32_bf16 v[132:135], a[80:83], a[0:3], v[132:135]
    ds_read_b128 a[108:111], v5 offset:30720
    v_mfma_f32_16x16x32_bf16 v[156:159], a[80:83], a[4:7], v[156:159]
    buffer_load_dwordx4 a[60:63], v2, s[40:43], s35 offen offset:0 sc1
    v_mfma_f32_16x16x32_bf16 v[180:183], a[80:83], a[8:11], v[180:183]
    ds_read_b128 a[112:115], v5 offset:31744
    v_mfma_f32_16x16x32_bf16 v[204:207], a[80:83], a[12:15], v[204:207]
    v_mfma_f32_16x16x32_bf16 v[136:139], a[84:87], a[0:3], v[136:139]
    v_mfma_f32_16x16x32_bf16 v[160:163], a[84:87], a[4:7], v[160:163]
    ds_read_b128 a[116:119], v5 offset:32768
    buffer_load_dwordx4 a[64:67], v2, s[40:43], s35 offen offset:1024 sc1
    v_mfma_f32_16x16x32_bf16 v[184:187], a[84:87], a[8:11], v[184:187]
    v_mfma_f32_16x16x32_bf16 v[208:211], a[84:87], a[12:15], v[208:211]
    v_mfma_f32_16x16x32_bf16 v[140:143], a[88:91], a[0:3], v[140:143]
    ds_read_b128 a[120:123], v5 offset:33792
    v_mfma_f32_16x16x32_bf16 v[164:167], a[88:91], a[4:7], v[164:167]
    v_mfma_f32_16x16x32_bf16 v[188:191], a[88:91], a[8:11], v[188:191]
    buffer_load_dwordx4 a[68:71], v2, s[40:43], s35 offen offset:2048 sc1
    v_mfma_f32_16x16x32_bf16 v[212:215], a[88:91], a[12:15], v[212:215]
    ds_read_b128 a[124:127], v5 offset:34816
    v_mfma_f32_16x16x32_bf16 v[144:147], a[92:95], a[0:3], v[144:147]
    v_mfma_f32_16x16x32_bf16 v[168:171], a[92:95], a[4:7], v[168:171]
    v_mfma_f32_16x16x32_bf16 v[192:195], a[92:95], a[8:11], v[192:195]
    ds_read_b128 a[128:131], v5 offset:35840
    buffer_load_dwordx4 a[72:75], v2, s[40:43], s35 offen offset:3072 sc1
    s_add_u32 s35, s35, 4096
    s_and_b32 s35, s35, 0x1ffff
    v_mfma_f32_16x16x32_bf16 v[216:219], a[92:95], a[12:15], v[216:219]
    v_mfma_f32_16x16x32_bf16 v[148:151], a[96:99], a[0:3], v[148:151]
    v_mfma_f32_16x16x32_bf16 v[172:175], a[96:99], a[4:7], v[172:175]
    v_mfma_f32_16x16x32_bf16 v[196:199], a[96:99], a[8:11], v[196:199]
    v_mfma_f32_16x16x32_bf16 v[220:223], a[96:99], a[12:15], v[220:223]
    s_add_u32 s44, s44, 4096
    s_add_u32 m0, m0, 4096
    s_nop 0
    buffer_load_dwordx4 v1, s[4:7], s44 offen offset:0 sc1 lds
    v_mfma_f32_16x16x32_bf16 v[152:155], a[100:103], a[0:3], v[152:155]
    v_mfma_f32_16x16x32_bf16 v[176:179], a[100:103], a[4:7], v[176:179]
    v_mfma_f32_16x16x32_bf16 v[200:203], a[100:103], a[8:11], v[200:203]
    v_mfma_f32_16x16x32_bf16 v[224:227], a[100:103], a[12:15], v[224:227]
    s_waitcnt vmcnt(12) lgkmcnt(0)
    v_mfma_f32_16x16x32_bf16 v[132:135], a[108:111], a[20:23], v[132:135]
    ds_read_b128 a[80:83], v5 offset:36864
    v_mfma_f32_16x16x32_bf16 v[156:159], a[108:111], a[24:27], v[156:159]
    buffer_load_dwordx4 a[0:3], v2, s[40:43], s35 offen offset:0 sc1
    v_mfma_f32_16x16x32_bf16 v[180:183], a[108:111], a[28:31], v[180:183]
    ds_read_b128 a[84:87], v5 offset:37888
    v_mfma_f32_16x16x32_bf16 v[204:207], a[108:111], a[32:35], v[204:207]
    v_mfma_f32_16x16x32_bf16 v[136:139], a[112:115], a[20:23], v[136:139]
    buffer_load_dwordx4 a[4:7], v2, s[40:43], s35 offen offset:1024 sc1
    v_mfma_f32_16x16x32_bf16 v[160:163], a[112:115], a[24:27], v[160:163]
    ds_read_b128 a[88:91], v5 offset:38912
    v_mfma_f32_16x16x32_bf16 v[184:187], a[112:115], a[28:31], v[184:187]
    v_mfma_f32_16x16x32_bf16 v[208:211], a[112:115], a[32:35], v[208:211]
    v_mfma_f32_16x16x32_bf16 v[140:143], a[116:119], a[20:23], v[140:143]
    ds_read_b128 a[92:95], v5 offset:39936
    buffer_load_dwordx4 a[8:11], v2, s[40:43], s35 offen offset:2048 sc1
    v_mfma_f32_16x16x32_bf16 v[164:167], a[116:119], a[24:27], v[164:167]
    v_mfma_f32_16x16x32_bf16 v[188:191], a[116:119], a[28:31], v[188:191]
    v_mfma_f32_16x16x32_bf16 v[212:215], a[116:119], a[32:35], v[212:215]
    ds_read_b128 a[96:99], v5 offset:40960
    v_mfma_f32_16x16x32_bf16 v[144:147], a[120:123], a[20:23], v[144:147]
    buffer_load_dwordx4 a[12:15], v2, s[40:43], s35 offen offset:3072 sc1
    s_add_u32 s35, s35, 4096
    s_and_b32 s35, s35, 0x1ffff
    v_mfma_f32_16x16x32_bf16 v[168:171], a[120:123], a[24:27], v[168:171]
    v_mfma_f32_16x16x32_bf16 v[192:195], a[120:123], a[28:31], v[192:195]
    ds_read_b128 a[100:103], v5 offset:41984
    v_mfma_f32_16x16x32_bf16 v[216:219], a[120:123], a[32:35], v[216:219]
    v_mfma_f32_16x16x32_bf16 v[148:151], a[124:127], a[20:23], v[148:151]
    buffer_load_dwordx4 v1, s[4:7], s44 offen offset:1024 sc1 lds
    v_mfma_f32_16x16x32_bf16 v[172:175], a[124:127], a[24:27], v[172:175]
    v_mfma_f32_16x16x32_bf16 v[196:199], a[124:127], a[28:31], v[196:199]
    v_mfma_f32_16x16x32_bf16 v[220:223], a[124:127], a[32:35], v[220:223]
    v_mfma_f32_16x16x32_bf16 v[152:155], a[128:131], a[20:23], v[152:155]
    buffer_load_dwordx4 v1, s[4:7], s44 offen offset:2048 sc1 lds
    v_mfma_f32_16x16x32_bf16 v[176:179], a[128:131], a[24:27], v[176:179]
    v_mfma_f32_16x16x32_bf16 v[200:203], a[128:131], a[28:31], v[200:203]
    v_mfma_f32_16x16x32_bf16 v[224:227], a[128:131], a[32:35], v[224:227]
    s_waitcnt vmcnt(13) lgkmcnt(0)
    v_mfma_f32_16x16x32_bf16 v[132:135], a[80:83], a[40:43], v[132:135]
    ds_read_b128 a[108:111], v5 offset:43008
    v_mfma_f32_16x16x32_bf16 v[156:159], a[80:83], a[44:47], v[156:159]
    buffer_load_dwordx4 a[20:23], v2, s[40:43], s35 offen offset:0 sc1
    v_mfma_f32_16x16x32_bf16 v[180:183], a[80:83], a[48:51], v[180:183]
    ds_read_b128 a[112:115], v5 offset:44032
    v_mfma_f32_16x16x32_bf16 v[204:207], a[80:83], a[52:55], v[204:207]
    v_mfma_f32_16x16x32_bf16 v[136:139], a[84:87], a[40:43], v[136:139]
    v_mfma_f32_16x16x32_bf16 v[160:163], a[84:87], a[44:47], v[160:163]
    ds_read_b128 a[116:119], v5 offset:45056
    buffer_load_dwordx4 a[24:27], v2, s[40:43], s35 offen offset:1024 sc1
    v_mfma_f32_16x16x32_bf16 v[184:187], a[84:87], a[48:51], v[184:187]
    v_mfma_f32_16x16x32_bf16 v[208:211], a[84:87], a[52:55], v[208:211]
    v_mfma_f32_16x16x32_bf16 v[140:143], a[88:91], a[40:43], v[140:143]
    ds_read_b128 a[120:123], v5 offset:46080
    v_mfma_f32_16x16x32_bf16 v[164:167], a[88:91], a[44:47], v[164:167]
    v_mfma_f32_16x16x32_bf16 v[188:191], a[88:91], a[48:51], v[188:191]
    buffer_load_dwordx4 a[28:31], v2, s[40:43], s35 offen offset:2048 sc1
    v_mfma_f32_16x16x32_bf16 v[212:215], a[88:91], a[52:55], v[212:215]
    ds_read_b128 a[124:127], v5 offset:47104
    v_mfma_f32_16x16x32_bf16 v[144:147], a[92:95], a[40:43], v[144:147]
    v_mfma_f32_16x16x32_bf16 v[168:171], a[92:95], a[44:47], v[168:171]
    v_mfma_f32_16x16x32_bf16 v[192:195], a[92:95], a[48:51], v[192:195]
    ds_read_b128 a[128:131], v5 offset:48128
    buffer_load_dwordx4 a[32:35], v2, s[40:43], s35 offen offset:3072 sc1
    s_add_u32 s35, s35, 4096
    s_and_b32 s35, s35, 0x1ffff
    v_mfma_f32_16x16x32_bf16 v[216:219], a[92:95], a[52:55], v[216:219]
    v_mfma_f32_16x16x32_bf16 v[148:151], a[96:99], a[40:43], v[148:151]
    v_mfma_f32_16x16x32_bf16 v[172:175], a[96:99], a[44:47], v[172:175]
    v_mfma_f32_16x16x32_bf16 v[196:199], a[96:99], a[48:51], v[196:199]
    v_mfma_f32_16x16x32_bf16 v[220:223], a[96:99], a[52:55], v[220:223]
    buffer_load_dwordx4 v1, s[4:7], s44 offen offset:3072 sc1 lds
    v_mfma_f32_16x16x32_bf16 v[152:155], a[100:103], a[40:43], v[152:155]
    v_mfma_f32_16x16x32_bf16 v[176:179], a[100:103], a[44:47], v[176:179]
    v_mfma_f32_16x16x32_bf16 v[200:203], a[100:103], a[48:51], v[200:203]
    v_mfma_f32_16x16x32_bf16 v[224:227], a[100:103], a[52:55], v[224:227]
    s_waitcnt vmcnt(12) lgkmcnt(0)
    s_barrier
    v_mfma_f32_16x16x32_bf16 v[132:135], a[108:111], a[60:63], v[132:135]
    v_add_u32 v5, 98304, v1
    ds_read_b128 a[80:83], v5 offset:0
    v_mfma_f32_16x16x32_bf16 v[156:159], a[108:111], a[64:67], v[156:159]
    buffer_load_dwordx4 a[40:43], v2, s[40:43], s35 offen offset:0 sc1
    v_mfma_f32_16x16x32_bf16 v[180:183], a[108:111], a[68:71], v[180:183]
    ds_read_b128 a[84:87], v5 offset:1024
    v_mfma_f32_16x16x32_bf16 v[204:207], a[108:111], a[72:75], v[204:207]
    v_mfma_f32_16x16x32_bf16 v[136:139], a[112:115], a[60:63], v[136:139]
    v_mfma_f32_16x16x32_bf16 v[160:163], a[112:115], a[64:67], v[160:163]
    ds_read_b128 a[88:91], v5 offset:2048
    v_mfma_f32_16x16x32_bf16 v[184:187], a[112:115], a[68:71], v[184:187]
    buffer_load_dwordx4 a[44:47], v2, s[40:43], s35 offen offset:1024 sc1
    v_mfma_f32_16x16x32_bf16 v[208:211], a[112:115], a[72:75], v[208:211]
    v_mfma_f32_16x16x32_bf16 v[140:143], a[116:119], a[60:63], v[140:143]
    ds_read_b128 a[92:95], v5 offset:3072
    v_mfma_f32_16x16x32_bf16 v[164:167], a[116:119], a[64:67], v[164:167]
    v_mfma_f32_16x16x32_bf16 v[188:191], a[116:119], a[68:71], v[188:191]
    v_mfma_f32_16x16x32_bf16 v[212:215], a[116:119], a[72:75], v[212:215]
    ds_read_b128 a[96:99], v5 offset:4096
    v_mfma_f32_16x16x32_bf16 v[144:147], a[120:123], a[60:63], v[144:147]
    buffer_load_dwordx4 a[48:51], v2, s[40:43], s35 offen offset:2048 sc1
    v_mfma_f32_16x16x32_bf16 v[168:171], a[120:123], a[64:67], v[168:171]
    v_mfma_f32_16x16x32_bf16 v[192:195], a[120:123], a[68:71], v[192:195]
    ds_read_b128 a[100:103], v5 offset:5120
    v_mfma_f32_16x16x32_bf16 v[216:219], a[120:123], a[72:75], v[216:219]
    v_mfma_f32_16x16x32_bf16 v[148:151], a[124:127], a[60:63], v[148:151]
    v_mfma_f32_16x16x32_bf16 v[172:175], a[124:127], a[64:67], v[172:175]
    v_mfma_f32_16x16x32_bf16 v[196:199], a[124:127], a[68:71], v[196:199]
    buffer_load_dwordx4 a[52:55], v2, s[40:43], s35 offen offset:3072 sc1
    s_add_u32 s35, s35, 4096
    s_and_b32 s35, s35, 0x1ffff
    v_mfma_f32_16x16x32_bf16 v[220:223], a[124:127], a[72:75], v[220:223]
    v_mfma_f32_16x16x32_bf16 v[152:155], a[128:131], a[60:63], v[152:155]
    v_mfma_f32_16x16x32_bf16 v[176:179], a[128:131], a[64:67], v[176:179]
    v_mfma_f32_16x16x32_bf16 v[200:203], a[128:131], a[68:71], v[200:203]
    v_mfma_f32_16x16x32_bf16 v[224:227], a[128:131], a[72:75], v[224:227]
    s_waitcnt vmcnt(11) lgkmcnt(0)
    v_mfma_f32_16x16x32_bf16 v[132:135], a[80:83], a[0:3], v[132:135]
    ds_read_b128 a[108:111], v5 offset:6144
    v_mfma_f32_16x16x32_bf16 v[156:159], a[80:83], a[4:7], v[156:159]
    buffer_load_dwordx4 a[60:63], v2, s[40:43], s35 offen offset:0 sc1
    v_mfma_f32_16x16x32_bf16 v[180:183], a[80:83], a[8:11], v[180:183]
    ds_read_b128 a[112:115], v5 offset:7168
    v_mfma_f32_16x16x32_bf16 v[204:207], a[80:83], a[12:15], v[204:207]
    v_mfma_f32_16x16x32_bf16 v[136:139], a[84:87], a[0:3], v[136:139]
    v_mfma_f32_16x16x32_bf16 v[160:163], a[84:87], a[4:7], v[160:163]
    ds_read_b128 a[116:119], v5 offset:8192
    v_mfma_f32_16x16x32_bf16 v[184:187], a[84:87], a[8:11], v[184:187]
    buffer_load_dwordx4 a[64:67], v2, s[40:43], s35 offen offset:1024 sc1
    v_mfma_f32_16x16x32_bf16 v[208:211], a[84:87], a[12:15], v[208:211]
    v_mfma_f32_16x16x32_bf16 v[140:143], a[88:91], a[0:3], v[140:143]
    ds_read_b128 a[120:123], v5 offset:9216
    v_mfma_f32_16x16x32_bf16 v[164:167], a[88:91], a[4:7], v[164:167]
    v_mfma_f32_16x16x32_bf16 v[188:191], a[88:91], a[8:11], v[188:191]
    v_mfma_f32_16x16x32_bf16 v[212:215], a[88:91], a[12:15], v[212:215]
    ds_read_b128 a[124:127], v5 offset:10240
    v_mfma_f32_16x16x32_bf16 v[144:147], a[92:95], a[0:3], v[144:147]
    buffer_load_dwordx4 a[68:71], v2, s[40:43], s35 offen offset:2048 sc1
    v_mfma_f32_16x16x32_bf16 v[168:171], a[92:95], a[4:7], v[168:171]
    v_mfma_f32_16x16x32_bf16 v[192:195], a[92:95], a[8:11], v[192:195]
    ds_read_b128 a[128:131], v5 offset:11264
    v_mfma_f32_16x16x32_bf16 v[216:219], a[92:95], a[12:15], v[216:219]
    v_mfma_f32_16x16x32_bf16 v[148:151], a[96:99], a[0:3], v[148:151]
    v_mfma_f32_16x16x32_bf16 v[172:175], a[96:99], a[4:7], v[172:175]
    v_mfma_f32_16x16x32_bf16 v[196:199], a[96:99], a[8:11], v[196:199]
    buffer_load_dwordx4 a[72:75], v2, s[40:43], s35 offen offset:3072 sc1
    s_add_u32 s35, s35, 4096
    s_and_b32 s35, s35, 0x1ffff
    v_mfma_f32_16x16x32_bf16 v[220:223], a[96:99], a[12:15], v[220:223]
    v_mfma_f32_16x16x32_bf16 v[152:155], a[100:103], a[0:3], v[152:155]
    v_mfma_f32_16x16x32_bf16 v[176:179], a[100:103], a[4:7], v[176:179]
    v_mfma_f32_16x16x32_bf16 v[200:203], a[100:103], a[8:11], v[200:203]
    v_mfma_f32_16x16x32_bf16 v[224:227], a[100:103], a[12:15], v[224:227]
    s_waitcnt vmcnt(9) lgkmcnt(0)
    v_mfma_f32_16x16x32_bf16 v[132:135], a[108:111], a[20:23], v[132:135]
    ds_read_b128 a[80:83], v5 offset:12288
    v_mfma_f32_16x16x32_bf16 v[156:159], a[108:111], a[24:27], v[156:159]
    buffer_load_dwordx4 a[0:3], v2, s[40:43], s35 offen offset:0 sc1
    v_mfma_f32_16x16x32_bf16 v[180:183], a[108:111], a[28:31], v[180:183]
    ds_read_b128 a[84:87], v5 offset:13312
    v_mfma_f32_16x16x32_bf16 v[204:207], a[108:111], a[32:35], v[204:207]
    v_mfma_f32_16x16x32_bf16 v[136:139], a[112:115], a[20:23], v[136:139]
    v_mfma_f32_16x16x32_bf16 v[160:163], a[112:115], a[24:27], v[160:163]
    ds_read_b128 a[88:91], v5 offset:14336
    v_mfma_f32_16x16x32_bf16 v[184:187], a[112:115], a[28:31], v[184:187]
    buffer_load_dwordx4 a[4:7], v2, s[40:43], s35 offen offset:1024 sc1
    v_mfma_f32_16x16x32_bf16 v[208:211], a[112:115], a[32:35], v[208:211]
    v_mfma_f32_16x16x32_bf16 v[140:143], a[116:119], a[20:23], v[140:143]
    ds_read_b128 a[92:95], v5 offset:15360
    v_mfma_f32_16x16x32_bf16 v[164:167], a[116:119], a[24:27], v[164:167]
    v_mfma_f32_16x16x32_bf16 v[188:191], a[116:119], a[28:31], v[188:191]
    v_mfma_f32_16x16x32_bf16 v[212:215], a[116:119], a[32:35], v[212:215]
    ds_read_b128 a[96:99], v5 offset:16384
    v_mfma_f32_16x16x32_bf16 v[144:147], a[120:123], a[20:23], v[144:147]
    buffer_load_dwordx4 a[8:11], v2, s[40:43], s35 offen offset:2048 sc1
    v_mfma_f32_16x16x32_bf16 v[168:171], a[120:123], a[24:27], v[168:171]
    v_mfma_f32_16x16x32_bf16 v[192:195], a[120:123], a[28:31], v[192:195]
    ds_read_b128 a[100:103], v5 offset:17408
    v_mfma_f32_16x16x32_bf16 v[216:219], a[120:123], a[32:35], v[216:219]
    v_mfma_f32_16x16x32_bf16 v[148:151], a[124:127], a[20:23], v[148:151]
    v_mfma_f32_16x16x32_bf16 v[172:175], a[124:127], a[24:27], v[172:175]
    v_mfma_f32_16x16x32_bf16 v[196:199], a[124:127], a[28:31], v[196:199]
    buffer_load_dwordx4 a[12:15], v2, s[40:43], s35 offen offset:3072 sc1
    s_add_u32 s35, s35, 4096
    s_and_b32 s35, s35, 0x1ffff
    v_mfma_f32_16x16x32_bf16 v[220:223], a[124:127], a[32:35], v[220:223]
    v_mfma_f32_16x16x32_bf16 v[152:155], a[128:131], a[20:23], v[152:155]
    v_mfma_f32_16x16x32_bf16 v[176:179], a[128:131], a[24:27], v[176:179]
    v_mfma_f32_16x16x32_bf16 v[200:203], a[128:131], a[28:31], v[200:203]
    v_mfma_f32_16x16x32_bf16 v[224:227], a[128:131], a[32:35], v[224:227]
    s_waitcnt vmcnt(8) lgkmcnt(0)
    v_mfma_f32_16x16x32_bf16 v[132:135], a[80:83], a[40:43], v[132:135]
    ds_read_b128 a[108:111], v5 offset:18432
    v_mfma_f32_16x16x32_bf16 v[156:159], a[80:83], a[44:47], v[156:159]
    buffer_load_dwordx4 a[20:23], v2, s[40:43], s35 offen offset:0 sc1
    v_mfma_f32_16x16x32_bf16 v[180:183], a[80:83], a[48:51], v[180:183]
    ds_read_b128 a[112:115], v5 offset:19456
    v_mfma_f32_16x16x32_bf16 v[204:207], a[80:83], a[52:55], v[204:207]
    v_mfma_f32_16x16x32_bf16 v[136:139], a[84:87], a[40:43], v[136:139]
    v_mfma_f32_16x16x32_bf16 v[160:163], a[84:87], a[44:47], v[160:163]
    ds_read_b128 a[116:119], v5 offset:20480
    v_mfma_f32_16x16x32_bf16 v[184:187], a[84:87], a[48:51], v[184:187]
    buffer_load_dwordx4 a[24:27], v2, s[40:43], s35 offen offset:1024 sc1
    v_mfma_f32_16x16x32_bf16 v[208:211], a[84:87], a[52:55], v[208:211]
    v_mfma_f32_16x16x32_bf16 v[140:143], a[88:91], a[40:43], v[140:143]
    ds_read_b128 a[120:123], v5 offset:21504
    v_mfma_f32_16x16x32_bf16 v[164:167], a[88:91], a[44:47], v[164:167]
    v_mfma_f32_16x16x32_bf16 v[188:191], a[88:91], a[48:51], v[188:191]
    v_mfma_f32_16x16x32_bf16 v[212:215], a[88:91], a[52:55], v[212:215]
    ds_read_b128 a[124:127], v5 offset:22528
    v_mfma_f32_16x16x32_bf16 v[144:147], a[92:95], a[40:43], v[144:147]
    buffer_load_dwordx4 a[28:31], v2, s[40:43], s35 offen offset:2048 sc1
    v_mfma_f32_16x16x32_bf16 v[168:171], a[92:95], a[44:47], v[168:171]
    v_mfma_f32_16x16x32_bf16 v[192:195], a[92:95], a[48:51], v[192:195]
    ds_read_b128 a[128:131], v5 offset:23552
    v_mfma_f32_16x16x32_bf16 v[216:219], a[92:95], a[52:55], v[216:219]
    v_mfma_f32_16x16x32_bf16 v[148:151], a[96:99], a[40:43], v[148:151]
    v_mfma_f32_16x16x32_bf16 v[172:175], a[96:99], a[44:47], v[172:175]
    v_mfma_f32_16x16x32_bf16 v[196:199], a[96:99], a[48:51], v[196:199]
    buffer_load_dwordx4 a[32:35], v2, s[40:43], s35 offen offset:3072 sc1
    s_add_u32 s35, s35, 4096
    s_and_b32 s35, s35, 0x1ffff
    v_mfma_f32_16x16x32_bf16 v[220:223], a[96:99], a[52:55], v[220:223]
    v_mfma_f32_16x16x32_bf16 v[152:155], a[100:103], a[40:43], v[152:155]
    v_mfma_f32_16x16x32_bf16 v[176:179], a[100:103], a[44:47], v[176:179]
    v_mfma_f32_16x16x32_bf16 v[200:203], a[100:103], a[48:51], v[200:203]
    v_mfma_f32_16x16x32_bf16 v[224:227], a[100:103], a[52:55], v[224:227]
    s_waitcnt vmcnt(8) lgkmcnt(0)
    v_mfma_f32_16x16x32_bf16 v[132:135], a[108:111], a[60:63], v[132:135]
    ds_read_b128 a[80:83], v5 offset:24576
    v_mfma_f32_16x16x32_bf16 v[156:159], a[108:111], a[64:67], v[156:159]
    buffer_load_dwordx4 a[40:43], v2, s[40:43], s35 offen offset:0 sc1
    v_mfma_f32_16x16x32_bf16 v[180:183], a[108:111], a[68:71], v[180:183]
    ds_read_b128 a[84:87], v5 offset:25600
    v_mfma_f32_16x16x32_bf16 v[204:207], a[108:111], a[72:75], v[204:207]
    v_mfma_f32_16x16x32_bf16 v[136:139], a[112:115], a[60:63], v[136:139]
    v_mfma_f32_16x16x32_bf16 v[160:163], a[112:115], a[64:67], v[160:163]
    ds_read_b128 a[88:91], v5 offset:26624
    v_mfma_f32_16x16x32_bf16 v[184:187], a[112:115], a[68:71], v[184:187]
    buffer_load_dwordx4 a[44:47], v2, s[40:43], s35 offen offset:1024 sc1
    v_mfma_f32_16x16x32_bf16 v[208:211], a[112:115], a[72:75], v[208:211]
    v_mfma_f32_16x16x32_bf16 v[140:143], a[116:119], a[60:63], v[140:143]
    ds_read_b128 a[92:95], v5 offset:27648
    v_mfma_f32_16x16x32_bf16 v[164:167], a[116:119], a[64:67], v[164:167]
    v_mfma_f32_16x16x32_bf16 v[188:191], a[116:119], a[68:71], v[188:191]
    v_mfma_f32_16x16x32_bf16 v[212:215], a[116:119], a[72:75], v[212:215]
    ds_read_b128 a[96:99], v5 offset:28672
    v_mfma_f32_16x16x32_bf16 v[144:147], a[120:123], a[60:63], v[144:147]
    buffer_load_dwordx4 a[48:51], v2, s[40:43], s35 offen offset:2048 sc1
    v_mfma_f32_16x16x32_bf16 v[168:171], a[120:123], a[64:67], v[168:171]
    v_mfma_f32_16x16x32_bf16 v[192:195], a[120:123], a[68:71], v[192:195]
    ds_read_b128 a[100:103], v5 offset:29696
    v_mfma_f32_16x16x32_bf16 v[216:219], a[120:123], a[72:75], v[216:219]
    v_mfma_f32_16x16x32_bf16 v[148:151], a[124:127], a[60:63], v[148:151]
    v_mfma_f32_16x16x32_bf16 v[172:175], a[124:127], a[64:67], v[172:175]
    v_mfma_f32_16x16x32_bf16 v[196:199], a[124:127], a[68:71], v[196:199]
    buffer_load_dwordx4 a[52:55], v2, s[40:43], s35 offen offset:3072 sc1
    s_add_u32 s35, s35, 4096
    s_and_b32 s35, s35, 0x1ffff
    v_mfma_f32_16x16x32_bf16 v[220:223], a[124:127], a[72:75], v[220:223]
    v_mfma_f32_16x16x32_bf16 v[152:155], a[128:131], a[60:63], v[152:155]
    v_mfma_f32_16x16x32_bf16 v[176:179], a[128:131], a[64:67], v[176:179]
    v_mfma_f32_16x16x32_bf16 v[200:203], a[128:131], a[68:71], v[200:203]
    v_mfma_f32_16x16x32_bf16 v[224:227], a[128:131], a[72:75], v[224:227]
    s_waitcnt vmcnt(8) lgkmcnt(0)
    v_mfma_f32_16x16x32_bf16 v[132:135], a[80:83], a[0:3], v[132:135]
    ds_read_b128 a[108:111], v5 offset:30720
    v_mfma_f32_16x16x32_bf16 v[156:159], a[80:83], a[4:7], v[156:159]
    buffer_load_dwordx4 a[60:63], v2, s[40:43], s35 offen offset:0 sc1
    v_mfma_f32_16x16x32_bf16 v[180:183], a[80:83], a[8:11], v[180:183]
    ds_read_b128 a[112:115], v5 offset:31744
    v_mfma_f32_16x16x32_bf16 v[204:207], a[80:83], a[12:15], v[204:207]
    v_mfma_f32_16x16x32_bf16 v[136:139], a[84:87], a[0:3], v[136:139]
    buffer_load_dwordx4 a[64:67], v2, s[40:43], s35 offen offset:1024 sc1
    v_mfma_f32_16x16x32_bf16 v[160:163], a[84:87], a[4:7], v[160:163]
    ds_read_b128 a[116:119], v5 offset:32768
    v_mfma_f32_16x16x32_bf16 v[184:187], a[84:87], a[8:11], v[184:187]
    v_mfma_f32_16x16x32_bf16 v[208:211], a[84:87], a[12:15], v[208:211]
    v_mfma_f32_16x16x32_bf16 v[140:143], a[88:91], a[0:3], v[140:143]
    ds_read_b128 a[120:123], v5 offset:33792
    buffer_load_dwordx4 a[68:71], v2, s[40:43], s35 offen offset:2048 sc1
    v_mfma_f32_16x16x32_bf16 v[164:167], a[88:91], a[4:7], v[164:167]
    v_mfma_f32_16x16x32_bf16 v[188:191], a[88:91], a[8:11], v[188:191]
    v_mfma_f32_16x16x32_bf16 v[212:215], a[88:91], a[12:15], v[212:215]
    ds_read_b128 a[124:127], v5 offset:34816
    v_mfma_f32_16x16x32_bf16 v[144:147], a[92:95], a[0:3], v[144:147]
    buffer_load_dwordx4 a[72:75], v2, s[40:43], s35 offen offset:3072 sc1
    s_add_u32 s35, s35, 4096
    s_and_b32 s35, s35, 0x1ffff
    v_mfma_f32_16x16x32_bf16 v[168:171], a[92:95], a[4:7], v[168:171]
    v_mfma_f32_16x16x32_bf16 v[192:195], a[92:95], a[8:11], v[192:195]
    ds_read_b128 a[128:131], v5 offset:35840
    v_mfma_f32_16x16x32_bf16 v[216:219], a[92:95], a[12:15], v[216:219]
    v_mfma_f32_16x16x32_bf16 v[148:151], a[96:99], a[0:3], v[148:151]
    s_mov_b32 s36, 0x2c0000
    s_mov_b32 s37, 0x2c1000
    buffer_load_dwordx2 v[92:93], v14, s[4:7], s36 offen offset:0 sc1
    v_mfma_f32_16x16x32_bf16 v[172:175], a[96:99], a[4:7], v[172:175]
    v_mfma_f32_16x16x32_bf16 v[196:199], a[96:99], a[8:11], v[196:199]
    v_mfma_f32_16x16x32_bf16 v[220:223], a[96:99], a[12:15], v[220:223]
    v_mfma_f32_16x16x32_bf16 v[152:155], a[100:103], a[0:3], v[152:155]
    buffer_load_dwordx2 v[94:95], v14, s[4:7], s36 offen offset:128 sc1
    v_mfma_f32_16x16x32_bf16 v[176:179], a[100:103], a[4:7], v[176:179]
    v_mfma_f32_16x16x32_bf16 v[200:203], a[100:103], a[8:11], v[200:203]
    v_mfma_f32_16x16x32_bf16 v[224:227], a[100:103], a[12:15], v[224:227]
    s_waitcnt vmcnt(10) lgkmcnt(0)
    v_mfma_f32_16x16x32_bf16 v[132:135], a[108:111], a[20:23], v[132:135]
    ds_read_b128 a[80:83], v5 offset:36864
    v_mfma_f32_16x16x32_bf16 v[156:159], a[108:111], a[24:27], v[156:159]
    buffer_load_dwordx4 a[0:3], v2, s[40:43], s35 offen offset:0 sc1
    v_mfma_f32_16x16x32_bf16 v[180:183], a[108:111], a[28:31], v[180:183]
    ds_read_b128 a[84:87], v5 offset:37888
    v_mfma_f32_16x16x32_bf16 v[204:207], a[108:111], a[32:35], v[204:207]
    v_mfma_f32_16x16x32_bf16 v[136:139], a[112:115], a[20:23], v[136:139]
    buffer_load_dwordx4 a[4:7], v2, s[40:43], s35 offen offset:1024 sc1
    v_mfma_f32_16x16x32_bf16 v[160:163], a[112:115], a[24:27], v[160:163]
    ds_read_b128 a[88:91], v5 offset:38912
    v_mfma_f32_16x16x32_bf16 v[184:187], a[112:115], a[28:31], v[184:187]
    v_mfma_f32_16x16x32_bf16 v[208:211], a[112:115], a[32:35], v[208:211]
    v_mfma_f32_16x16x32_bf16 v[140:143], a[116:119], a[20:23], v[140:143]
    ds_read_b128 a[92:95], v5 offset:39936
    buffer_load_dwordx4 a[8:11], v2, s[40:43], s35 offen offset:2048 sc1
    v_mfma_f32_16x16x32_bf16 v[164:167], a[116:119], a[24:27], v[164:167]
    v_mfma_f32_16x16x32_bf16 v[188:191], a[116:119], a[28:31], v[188:191]
    v_mfma_f32_16x16x32_bf16 v[212:215], a[116:119], a[32:35], v[212:215]
    ds_read_b128 a[96:99], v5 offset:40960
    v_mfma_f32_16x16x32_bf16 v[144:147], a[120:123], a[20:23], v[144:147]
    buffer_load_dwordx4 a[12:15], v2, s[40:43], s35 offen offset:3072 sc1
    s_add_u32 s35, s35, 4096
    s_and_b32 s35, s35, 0x1ffff
    v_mfma_f32_16x16x32_bf16 v[168:171], a[120:123], a[24:27], v[168:171]
    v_mfma_f32_16x16x32_bf16 v[192:195], a[120:123], a[28:31], v[192:195]
    ds_read_b128 a[100:103], v5 offset:41984
    v_mfma_f32_16x16x32_bf16 v[216:219], a[120:123], a[32:35], v[216:219]
    v_mfma_f32_16x16x32_bf16 v[148:151], a[124:127], a[20:23], v[148:151]
    buffer_load_dwordx2 v[96:97], v14, s[4:7], s36 offen offset:256 sc1
    v_mfma_f32_16x16x32_bf16 v[172:175], a[124:127], a[24:27], v[172:175]
    v_mfma_f32_16x16x32_bf16 v[196:199], a[124:127], a[28:31], v[196:199]
    v_mfma_f32_16x16x32_bf16 v[220:223], a[124:127], a[32:35], v[220:223]
    v_mfma_f32_16x16x32_bf16 v[152:155], a[128:131], a[20:23], v[152:155]
    buffer_load_dwordx2 v[98:99], v14, s[4:7], s36 offen offset:384 sc1
    v_mfma_f32_16x16x32_bf16 v[176:179], a[128:131], a[24:27], v[176:179]
    v_mfma_f32_16x16x32_bf16 v[200:203], a[128:131], a[28:31], v[200:203]
    v_mfma_f32_16x16x32_bf16 v[224:227], a[128:131], a[32:35], v[224:227]
    s_waitcnt vmcnt(12) lgkmcnt(0)
    v_mfma_f32_16x16x32_bf16 v[132:135], a[80:83], a[40:43], v[132:135]
    ds_read_b128 a[108:111], v5 offset:43008
    v_mfma_f32_16x16x32_bf16 v[156:159], a[80:83], a[44:47], v[156:159]
    buffer_load_dwordx4 a[20:23], v2, s[40:43], s35 offen offset:0 sc1
    v_mfma_f32_16x16x32_bf16 v[180:183], a[80:83], a[48:51], v[180:183]
    ds_read_b128 a[112:115], v5 offset:44032
    v_mfma_f32_16x16x32_bf16 v[204:207], a[80:83], a[52:55], v[204:207]
    v_mfma_f32_16x16x32_bf16 v[136:139], a[84:87], a[40:43], v[136:139]
    buffer_load_dwordx4 a[24:27], v2, s[40:43], s35 offen offset:1024 sc1
    v_mfma_f32_16x16x32_bf16 v[160:163], a[84:87], a[44:47], v[160:163]
    ds_read_b128 a[116:119], v5 offset:45056
    v_mfma_f32_16x16x32_bf16 v[184:187], a[84:87], a[48:51], v[184:187]
    v_mfma_f32_16x16x32_bf16 v[208:211], a[84:87], a[52:55], v[208:211]
    v_mfma_f32_16x16x32_bf16 v[140:143], a[88:91], a[40:43], v[140:143]
    ds_read_b128 a[120:123], v5 offset:46080
    buffer_load_dwordx4 a[28:31], v2, s[40:43], s35 offen offset:2048 sc1
    v_mfma_f32_16x16x32_bf16 v[164:167], a[88:91], a[44:47], v[164:167]
    v_mfma_f32_16x16x32_bf16 v[188:191], a[88:91], a[48:51], v[188:191]
    v_mfma_f32_16x16x32_bf16 v[212:215], a[88:91], a[52:55], v[212:215]
    ds_read_b128 a[124:127], v5 offset:47104
    v_mfma_f32_16x16x32_bf16 v[144:147], a[92:95], a[40:43], v[144:147]
    buffer_load_dwordx4 a[32:35], v2, s[40:43], s35 offen offset:3072 sc1
    s_add_u32 s35, s35, 4096
    s_and_b32 s35, s35, 0x1ffff
    v_mfma_f32_16x16x32_bf16 v[168:171], a[92:95], a[44:47], v[168:171]
    v_mfma_f32_16x16x32_bf16 v[192:195], a[92:95], a[48:51], v[192:195]
    ds_read_b128 a[128:131], v5 offset:48128
    v_mfma_f32_16x16x32_bf16 v[216:219], a[92:95], a[52:55], v[216:219]
    v_mfma_f32_16x16x32_bf16 v[148:151], a[96:99], a[40:43], v[148:151]
    buffer_load_dwordx2 v[100:101], v14, s[4:7], s36 offen offset:2048 sc1
    v_mfma_f32_16x16x32_bf16 v[172:175], a[96:99], a[44:47], v[172:175]
    v_mfma_f32_16x16x32_bf16 v[196:199], a[96:99], a[48:51], v[196:199]
    v_mfma_f32_16x16x32_bf16 v[220:223], a[96:99], a[52:55], v[220:223]
    v_mfma_f32_16x16x32_bf16 v[152:155], a[100:103], a[40:43], v[152:155]
    buffer_load_dwordx2 v[102:103], v14, s[4:7], s36 offen offset:2176 sc1
    v_mfma_f32_16x16x32_bf16 v[176:179], a[100:103], a[44:47], v[176:179]
    v_mfma_f32_16x16x32_bf16 v[200:203], a[100:103], a[48:51], v[200:203]
    v_mfma_f32_16x16x32_bf16 v[224:227], a[100:103], a[52:55], v[224:227]
    s_waitcnt vmcnt(14) lgkmcnt(0)
    s_barrier
    v_mfma_f32_16x16x32_bf16 v[132:135], a[108:111], a[60:63], v[132:135]
    v_add_u32 v5, 0, v1
    ds_read_b128 a[80:83], v5 offset:0
    v_mfma_f32_16x16x32_bf16 v[156:159], a[108:111], a[64:67], v[156:159]
    buffer_load_dwordx4 a[40:43], v2, s[40:43], s35 offen offset:0 sc1
    v_mfma_f32_16x16x32_bf16 v[180:183], a[108:111], a[68:71], v[180:183]
    ds_read_b128 a[84:87], v5 offset:1024
    v_mfma_f32_16x16x32_bf16 v[204:207], a[108:111], a[72:75], v[204:207]
    v_mfma_f32_16x16x32_bf16 v[136:139], a[112:115], a[60:63], v[136:139]
    buffer_load_dwordx4 a[44:47], v2, s[40:43], s35 offen offset:1024 sc1
    v_mfma_f32_16x16x32_bf16 v[160:163], a[112:115], a[64:67], v[160:163]
    ds_read_b128 a[88:91], v5 offset:2048
    v_mfma_f32_16x16x32_bf16 v[184:187], a[112:115], a[68:71], v[184:187]
    v_mfma_f32_16x16x32_bf16 v[208:211], a[112:115], a[72:75], v[208:211]
    v_mfma_f32_16x16x32_bf16 v[140:143], a[116:119], a[60:63], v[140:143]
    ds_read_b128 a[92:95], v5 offset:3072
    buffer_load_dwordx4 a[48:51], v2, s[40:43], s35 offen offset:2048 sc1
    v_mfma_f32_16x16x32_bf16 v[164:167], a[116:119], a[64:67], v[164:167]
    v_mfma_f32_16x16x32_bf16 v[188:191], a[116:119], a[68:71], v[188:191]
    v_mfma_f32_16x16x32_bf16 v[212:215], a[116:119], a[72:75], v[212:215]
    ds_read_b128 a[96:99], v5 offset:4096
    v_mfma_f32_16x16x32_bf16 v[144:147], a[120:123], a[60:63], v[144:147]
    buffer_load_dwordx4 a[52:55], v2, s[40:43], s35 offen offset:3072 sc1
    s_add_u32 s35, s35, 4096
    s_and_b32 s35, s35, 0x1ffff
    v_mfma_f32_16x16x32_bf16 v[168:171], a[120:123], a[64:67], v[168:171]
    v_mfma_f32_16x16x32_bf16 v[192:195], a[120:123], a[68:71], v[192:195]
    ds_read_b128 a[100:103], v5 offset:5120
    v_mfma_f32_16x16x32_bf16 v[216:219], a[120:123], a[72:75], v[216:219]
    v_mfma_f32_16x16x32_bf16 v[148:151], a[124:127], a[60:63], v[148:151]
    buffer_load_dwordx2 v[104:105], v14, s[4:7], s36 offen offset:2304 sc1
    v_mfma_f32_16x16x32_bf16 v[172:175], a[124:127], a[64:67], v[172:175]
    v_mfma_f32_16x16x32_bf16 v[196:199], a[124:127], a[68:71], v[196:199]
    v_mfma_f32_16x16x32_bf16 v[220:223], a[124:127], a[72:75], v[220:223]
    v_mfma_f32_16x16x32_bf16 v[152:155], a[128:131], a[60:63], v[152:155]
    buffer_load_dwordx2 v[106:107], v14, s[4:7], s36 offen offset:2432 sc1
    v_mfma_f32_16x16x32_bf16 v[176:179], a[128:131], a[64:67], v[176:179]
    v_mfma_f32_16x16x32_bf16 v[200:203], a[128:131], a[68:71], v[200:203]
    v_mfma_f32_16x16x32_bf16 v[224:227], a[128:131], a[72:75], v[224:227]
    s_waitcnt vmcnt(14) lgkmcnt(0)
    v_mfma_f32_16x16x32_bf16 v[132:135], a[80:83], a[0:3], v[132:135]
    ds_read_b128 a[108:111], v5 offset:6144
    v_mfma_f32_16x16x32_bf16 v[156:159], a[80:83], a[4:7], v[156:159]
    buffer_load_dwordx4 a[60:63], v2, s[40:43], s35 offen offset:0 sc1
    v_mfma_f32_16x16x32_bf16 v[180:183], a[80:83], a[8:11], v[180:183]
    ds_read_b128 a[112:115], v5 offset:7168
    v_mfma_f32_16x16x32_bf16 v[204:207], a[80:83], a[12:15], v[204:207]
    v_mfma_f32_16x16x32_bf16 v[136:139], a[84:87], a[0:3], v[136:139]
    v_mfma_f32_16x16x32_bf16 v[160:163], a[84:87], a[4:7], v[160:163]
    ds_read_b128 a[116:119], v5 offset:8192
    buffer_load_dwordx4 a[64:67], v2, s[40:43], s35 offen offset:1024 sc1
    v_mfma_f32_16x16x32_bf16 v[184:187], a[84:87], a[8:11], v[184:187]
    v_mfma_f32_16x16x32_bf16 v[208:211], a[84:87], a[12:15], v[208:211]
    v_mfma_f32_16x16x32_bf16 v[140:143], a[88:91], a[0:3], v[140:143]
    ds_read_b128 a[120:123], v5 offset:9216
    v_mfma_f32_16x16x32_bf16 v[164:167], a[88:91], a[4:7], v[164:167]
    v_mfma_f32_16x16x32_bf16 v[188:191], a[88:91], a[8:11], v[188:191]
    buffer_load_dwordx4 a[68:71], v2, s[40:43], s35 offen offset:2048 sc1
    v_mfma_f32_16x16x32_bf16 v[212:215], a[88:91], a[12:15], v[212:215]
    ds_read_b128 a[124:127], v5 offset:10240
    v_mfma_f32_16x16x32_bf16 v[144:147], a[92:95], a[0:3], v[144:147]
    v_mfma_f32_16x16x32_bf16 v[168:171], a[92:95], a[4:7], v[168:171]
    v_mfma_f32_16x16x32_bf16 v[192:195], a[92:95], a[8:11], v[192:195]
    ds_read_b128 a[128:131], v5 offset:11264
    buffer_load_dwordx4 a[72:75], v2, s[40:43], s35 offen offset:3072 sc1
    s_add_u32 s35, s35, 4096
    s_and_b32 s35, s35, 0x1ffff
    v_mfma_f32_16x16x32_bf16 v[216:219], a[92:95], a[12:15], v[216:219]
    v_mfma_f32_16x16x32_bf16 v[148:151], a[96:99], a[0:3], v[148:151]
    v_mfma_f32_16x16x32_bf16 v[172:175], a[96:99], a[4:7], v[172:175]
    v_mfma_f32_16x16x32_bf16 v[196:199], a[96:99], a[8:11], v[196:199]
    v_mfma_f32_16x16x32_bf16 v[220:223], a[96:99], a[12:15], v[220:223]
    buffer_load_dwordx2 v[108:109], v14, s[4:7], s37 offen offset:0 sc1
    v_mfma_f32_16x16x32_bf16 v[152:155], a[100:103], a[0:3], v[152:155]
    v_mfma_f32_16x16x32_bf16 v[176:179], a[100:103], a[4:7], v[176:179]
    v_mfma_f32_16x16x32_bf16 v[200:203], a[100:103], a[8:11], v[200:203]
    v_mfma_f32_16x16x32_bf16 v[224:227], a[100:103], a[12:15], v[224:227]
    s_waitcnt vmcnt(13) lgkmcnt(0)
    v_mfma_f32_16x16x32_bf16 v[132:135], a[108:111], a[20:23], v[132:135]
    ds_read_b128 a[80:83], v5 offset:12288
    v_mfma_f32_16x16x32_bf16 v[156:159], a[108:111], a[24:27], v[156:159]
    buffer_load_dwordx4 a[0:3], v2, s[40:43], s35 offen offset:0 sc1
    v_mfma_f32_16x16x32_bf16 v[180:183], a[108:111], a[28:31], v[180:183]
    ds_read_b128 a[84:87], v5 offset:13312
    v_mfma_f32_16x16x32_bf16 v[204:207], a[108:111], a[32:35], v[204:207]
    v_mfma_f32_16x16x32_bf16 v[136:139], a[112:115], a[20:23], v[136:139]
    buffer_load_dwordx4 a[4:7], v2, s[40:43], s35 offen offset:1024 sc1
    v_mfma_f32_16x16x32_bf16 v[160:163], a[112:115], a[24:27], v[160:163]
    ds_read_b128 a[88:91], v5 offset:14336
    v_mfma_f32_16x16x32_bf16 v[184:187], a[112:115], a[28:31], v[184:187]
    v_mfma_f32_16x16x32_bf16 v[208:211], a[112:115], a[32:35], v[208:211]
    v_mfma_f32_16x16x32_bf16 v[140:143], a[116:119], a[20:23], v[140:143]
    ds_read_b128 a[92:95], v5 offset:15360
    buffer_load_dwordx4 a[8:11], v2, s[40:43], s35 offen offset:2048 sc1
    v_mfma_f32_16x16x32_bf16 v[164:167], a[116:119], a[24:27], v[164:167]
    v_mfma_f32_16x16x32_bf16 v[188:191], a[116:119], a[28:31], v[188:191]
    v_mfma_f32_16x16x32_bf16 v[212:215], a[116:119], a[32:35], v[212:215]
    ds_read_b128 a[96:99], v5 offset:16384
    v_mfma_f32_16x16x32_bf16 v[144:147], a[120:123], a[20:23], v[144:147]
    buffer_load_dwordx4 a[12:15], v2, s[40:43], s35 offen offset:3072 sc1
    s_add_u32 s35, s35, 4096
    s_and_b32 s35, s35, 0x1ffff
    v_mfma_f32_16x16x32_bf16 v[168:171], a[120:123], a[24:27], v[168:171]
    v_mfma_f32_16x16x32_bf16 v[192:195], a[120:123], a[28:31], v[192:195]
    ds_read_b128 a[100:103], v5 offset:17408
    v_mfma_f32_16x16x32_bf16 v[216:219], a[120:123], a[32:35], v[216:219]
    v_mfma_f32_16x16x32_bf16 v[148:151], a[124:127], a[20:23], v[148:151]
    buffer_load_dwordx2 v[110:111], v14, s[4:7], s37 offen offset:128 sc1
    v_mfma_f32_16x16x32_bf16 v[172:175], a[124:127], a[24:27], v[172:175]
    v_mfma_f32_16x16x32_bf16 v[196:199], a[124:127], a[28:31], v[196:199]
    v_mfma_f32_16x16x32_bf16 v[220:223], a[124:127], a[32:35], v[220:223]
    v_mfma_f32_16x16x32_bf16 v[152:155], a[128:131], a[20:23], v[152:155]
    buffer_load_dwordx2 v[112:113], v14, s[4:7], s37 offen offset:256 sc1
    v_mfma_f32_16x16x32_bf16 v[176:179], a[128:131], a[24:27], v[176:179]
    v_mfma_f32_16x16x32_bf16 v[200:203], a[128:131], a[28:31], v[200:203]
    v_mfma_f32_16x16x32_bf16 v[224:227], a[128:131], a[32:35], v[224:227]
    s_waitcnt vmcnt(13) lgkmcnt(0)
    v_mfma_f32_16x16x32_bf16 v[132:135], a[80:83], a[40:43], v[132:135]
    ds_read_b128 a[108:111], v5 offset:18432
    v_mfma_f32_16x16x32_bf16 v[156:159], a[80:83], a[44:47], v[156:159]
    buffer_load_dwordx4 a[20:23], v2, s[40:43], s35 offen offset:0 sc1
    v_mfma_f32_16x16x32_bf16 v[180:183], a[80:83], a[48:51], v[180:183]
    ds_read_b128 a[112:115], v5 offset:19456
    v_mfma_f32_16x16x32_bf16 v[204:207], a[80:83], a[52:55], v[204:207]
    v_mfma_f32_16x16x32_bf16 v[136:139], a[84:87], a[40:43], v[136:139]
    buffer_load_dwordx4 a[24:27], v2, s[40:43], s35 offen offset:1024 sc1
    v_mfma_f32_16x16x32_bf16 v[160:163], a[84:87], a[44:47], v[160:163]
    ds_read_b128 a[116:119], v5 offset:20480
    v_mfma_f32_16x16x32_bf16 v[184:187], a[84:87], a[48:51], v[184:187]
    v_mfma_f32_16x16x32_bf16 v[208:211], a[84:87], a[52:55], v[208:211]
    v_mfma_f32_16x16x32_bf16 v[140:143], a[88:91], a[40:43], v[140:143]
    ds_read_b128 a[120:123], v5 offset:21504
    buffer_load_dwordx4 a[28:31], v2, s[40:43], s35 offen offset:2048 sc1
    v_mfma_f32_16x16x32_bf16 v[164:167], a[88:91], a[44:47], v[164:167]
    v_mfma_f32_16x16x32_bf16 v[188:191], a[88:91], a[48:51], v[188:191]
    v_mfma_f32_16x16x32_bf16 v[212:215], a[88:91], a[52:55], v[212:215]
    ds_read_b128 a[124:127], v5 offset:22528
    v_mfma_f32_16x16x32_bf16 v[144:147], a[92:95], a[40:43], v[144:147]
    buffer_load_dwordx4 a[32:35], v2, s[40:43], s35 offen offset:3072 sc1
    s_add_u32 s35, s35, 4096
    s_and_b32 s35, s35, 0x1ffff
    v_mfma_f32_16x16x32_bf16 v[168:171], a[92:95], a[44:47], v[168:171]
    v_mfma_f32_16x16x32_bf16 v[192:195], a[92:95], a[48:51], v[192:195]
    ds_read_b128 a[128:131], v5 offset:23552
    v_mfma_f32_16x16x32_bf16 v[216:219], a[92:95], a[52:55], v[216:219]
    v_mfma_f32_16x16x32_bf16 v[148:151], a[96:99], a[40:43], v[148:151]
    buffer_load_dwordx2 v[114:115], v14, s[4:7], s37 offen offset:384 sc1
    v_mfma_f32_16x16x32_bf16 v[172:175], a[96:99], a[44:47], v[172:175]
    v_mfma_f32_16x16x32_bf16 v[196:199], a[96:99], a[48:51], v[196:199]
    v_mfma_f32_16x16x32_bf16 v[220:223], a[96:99], a[52:55], v[220:223]
    v_mfma_f32_16x16x32_bf16 v[152:155], a[100:103], a[40:43], v[152:155]
    buffer_load_dwordx2 v[116:117], v14, s[4:7], s37 offen offset:2048 sc1
    v_mfma_f32_16x16x32_bf16 v[176:179], a[100:103], a[44:47], v[176:179]
    v_mfma_f32_16x16x32_bf16 v[200:203], a[100:103], a[48:51], v[200:203]
    v_mfma_f32_16x16x32_bf16 v[224:227], a[100:103], a[52:55], v[224:227]
    s_waitcnt vmcnt(13) lgkmcnt(0)
    v_mfma_f32_16x16x32_bf16 v[132:135], a[108:111], a[60:63], v[132:135]
    ds_read_b128 a[80:83], v5 offset:24576
    v_mfma_f32_16x16x32_bf16 v[156:159], a[108:111], a[64:67], v[156:159]
    buffer_load_dwordx4 a[40:43], v2, s[40:43], s35 offen offset:0 sc1
    v_mfma_f32_16x16x32_bf16 v[180:183], a[108:111], a[68:71], v[180:183]
    ds_read_b128 a[84:87], v5 offset:25600
    v_mfma_f32_16x16x32_bf16 v[204:207], a[108:111], a[72:75], v[204:207]
    v_mfma_f32_16x16x32_bf16 v[136:139], a[112:115], a[60:63], v[136:139]
    buffer_load_dwordx4 a[44:47], v2, s[40:43], s35 offen offset:1024 sc1
    v_mfma_f32_16x16x32_bf16 v[160:163], a[112:115], a[64:67], v[160:163]
    ds_read_b128 a[88:91], v5 offset:26624
    v_mfma_f32_16x16x32_bf16 v[184:187], a[112:115], a[68:71], v[184:187]
    v_mfma_f32_16x16x32_bf16 v[208:211], a[112:115], a[72:75], v[208:211]
    v_mfma_f32_16x16x32_bf16 v[140:143], a[116:119], a[60:63], v[140:143]
    ds_read_b128 a[92:95], v5 offset:27648
    buffer_load_dwordx4 a[48:51], v2, s[40:43], s35 offen offset:2048 sc1
    v_mfma_f32_16x16x32_bf16 v[164:167], a[116:119], a[64:67], v[164:167]
    v_mfma_f32_16x16x32_bf16 v[188:191], a[116:119], a[68:71], v[188:191]
    v_mfma_f32_16x16x32_bf16 v[212:215], a[116:119], a[72:75], v[212:215]
    ds_read_b128 a[96:99], v5 offset:28672
    v_mfma_f32_16x16x32_bf16 v[144:147], a[120:123], a[60:63], v[144:147]
    buffer_load_dwordx4 a[52:55], v2, s[40:43], s35 offen offset:3072 sc1
    s_add_u32 s35, s35, 4096
    s_and_b32 s35, s35, 0x1ffff
    v_mfma_f32_16x16x32_bf16 v[168:171], a[120:123], a[64:67], v[168:171]
    v_mfma_f32_16x16x32_bf16 v[192:195], a[120:123], a[68:71], v[192:195]
    ds_read_b128 a[100:103], v5 offset:29696
    v_mfma_f32_16x16x32_bf16 v[216:219], a[120:123], a[72:75], v[216:219]
    v_mfma_f32_16x16x32_bf16 v[148:151], a[124:127], a[60:63], v[148:151]
    buffer_load_dwordx2 v[118:119], v14, s[4:7], s37 offen offset:2176 sc1
    v_mfma_f32_16x16x32_bf16 v[172:175], a[124:127], a[64:67], v[172:175]
    v_mfma_f32_16x16x32_bf16 v[196:199], a[124:127], a[68:71], v[196:199]
    v_mfma_f32_16x16x32_bf16 v[220:223], a[124:127], a[72:75], v[220:223]
    v_mfma_f32_16x16x32_bf16 v[152:155], a[128:131], a[60:63], v[152:155]
    buffer_load_dwordx2 v[120:121], v14, s[4:7], s37 offen offset:2304 sc1
    v_mfma_f32_16x16x32_bf16 v[176:179], a[128:131], a[64:67], v[176:179]
    v_mfma_f32_16x16x32_bf16 v[200:203], a[128:131], a[68:71], v[200:203]
    v_mfma_f32_16x16x32_bf16 v[224:227], a[128:131], a[72:75], v[224:227]
    s_waitcnt vmcnt(14) lgkmcnt(0)
    v_mfma_f32_16x16x32_bf16 v[132:135], a[80:83], a[0:3], v[132:135]
    ds_read_b128 a[108:111], v5 offset:30720
    v_mfma_f32_16x16x32_bf16 v[156:159], a[80:83], a[4:7], v[156:159]
    buffer_load_dwordx4 a[60:63], v2, s[40:43], s35 offen offset:0 sc1
    v_mfma_f32_16x16x32_bf16 v[180:183], a[80:83], a[8:11], v[180:183]
    ds_read_b128 a[112:115], v5 offset:31744
    v_mfma_f32_16x16x32_bf16 v[204:207], a[80:83], a[12:15], v[204:207]
    v_mfma_f32_16x16x32_bf16 v[136:139], a[84:87], a[0:3], v[136:139]
    v_mfma_f32_16x16x32_bf16 v[160:163], a[84:87], a[4:7], v[160:163]
    ds_read_b128 a[116:119], v5 offset:32768
    buffer_load_dwordx4 a[64:67], v2, s[40:43], s35 offen offset:1024 sc1
    v_mfma_f32_16x16x32_bf16 v[184:187], a[84:87], a[8:11], v[184:187]
    v_mfma_f32_16x16x32_bf16 v[208:211], a[84:87], a[12:15], v[208:211]
    v_mfma_f32_16x16x32_bf16 v[140:143], a[88:91], a[0:3], v[140:143]
    ds_read_b128 a[120:123], v5 offset:33792
    v_mfma_f32_16x16x32_bf16 v[164:167], a[88:91], a[4:7], v[164:167]
    v_mfma_f32_16x16x32_bf16 v[188:191], a[88:91], a[8:11], v[188:191]
    buffer_load_dwordx4 a[68:71], v2, s[40:43], s35 offen offset:2048 sc1
    v_mfma_f32_16x16x32_bf16 v[212:215], a[88:91], a[12:15], v[212:215]
    ds_read_b128 a[124:127], v5 offset:34816
    v_mfma_f32_16x16x32_bf16 v[144:147], a[92:95], a[0:3], v[144:147]
    v_mfma_f32_16x16x32_bf16 v[168:171], a[92:95], a[4:7], v[168:171]
    v_mfma_f32_16x16x32_bf16 v[192:195], a[92:95], a[8:11], v[192:195]
    ds_read_b128 a[128:131], v5 offset:35840
    buffer_load_dwordx4 a[72:75], v2, s[40:43], s35 offen offset:3072 sc1
    s_add_u32 s35, s35, 4096
    s_and_b32 s35, s35, 0x1ffff
    v_mfma_f32_16x16x32_bf16 v[216:219], a[92:95], a[12:15], v[216:219]
    v_mfma_f32_16x16x32_bf16 v[148:151], a[96:99], a[0:3], v[148:151]
    v_mfma_f32_16x16x32_bf16 v[172:175], a[96:99], a[4:7], v[172:175]
    v_mfma_f32_16x16x32_bf16 v[196:199], a[96:99], a[8:11], v[196:199]
    v_mfma_f32_16x16x32_bf16 v[220:223], a[96:99], a[12:15], v[220:223]
    buffer_load_dwordx2 v[122:123], v14, s[4:7], s37 offen offset:2432 sc1
    v_mfma_f32_16x16x32_bf16 v[152:155], a[100:103], a[0:3], v[152:155]
    v_mfma_f32_16x16x32_bf16 v[176:179], a[100:103], a[4:7], v[176:179]
    v_mfma_f32_16x16x32_bf16 v[200:203], a[100:103], a[8:11], v[200:203]
    v_mfma_f32_16x16x32_bf16 v[224:227], a[100:103], a[12:15], v[224:227]
    s_waitcnt vmcnt(13) lgkmcnt(0)
    v_mfma_f32_16x16x32_bf16 v[132:135], a[108:111], a[20:23], v[132:135]
    ds_read_b128 a[80:83], v5 offset:36864
    v_mfma_f32_16x16x32_bf16 v[156:159], a[108:111], a[24:27], v[156:159]
    v_mfma_f32_16x16x32_bf16 v[180:183], a[108:111], a[28:31], v[180:183]
    ds_read_b128 a[84:87], v5 offset:37888
    v_mfma_f32_16x16x32_bf16 v[204:207], a[108:111], a[32:35], v[204:207]
    v_mfma_f32_16x16x32_bf16 v[136:139], a[112:115], a[20:23], v[136:139]
    v_mfma_f32_16x16x32_bf16 v[160:163], a[112:115], a[24:27], v[160:163]
    ds_read_b128 a[88:91], v5 offset:38912
    v_mfma_f32_16x16x32_bf16 v[184:187], a[112:115], a[28:31], v[184:187]
    v_mfma_f32_16x16x32_bf16 v[208:211], a[112:115], a[32:35], v[208:211]
    v_mfma_f32_16x16x32_bf16 v[140:143], a[116:119], a[20:23], v[140:143]
    ds_read_b128 a[92:95], v5 offset:39936
    v_mfma_f32_16x16x32_bf16 v[164:167], a[116:119], a[24:27], v[164:167]
    v_mfma_f32_16x16x32_bf16 v[188:191], a[116:119], a[28:31], v[188:191]
    v_mfma_f32_16x16x32_bf16 v[212:215], a[116:119], a[32:35], v[212:215]
    ds_read_b128 a[96:99], v5 offset:40960
    v_mfma_f32_16x16x32_bf16 v[144:147], a[120:123], a[20:23], v[144:147]
    v_mfma_f32_16x16x32_bf16 v[168:171], a[120:123], a[24:27], v[168:171]
    v_mfma_f32_16x16x32_bf16 v[192:195], a[120:123], a[28:31], v[192:195]
    ds_read_b128 a[100:103], v5 offset:41984
    v_mfma_f32_16x16x32_bf16 v[216:219], a[120:123], a[32:35], v[216:219]
    v_mfma_f32_16x16x32_bf16 v[148:151], a[124:127], a[20:23], v[148:151]
    v_mfma_f32_16x16x32_bf16 v[172:175], a[124:127], a[24:27], v[172:175]
    v_mfma_f32_16x16x32_bf16 v[196:199], a[124:127], a[28:31], v[196:199]
    v_mfma_f32_16x16x32_bf16 v[220:223], a[124:127], a[32:35], v[220:223]
    v_mfma_f32_16x16x32_bf16 v[152:155], a[128:131], a[20:23], v[152:155]
    v_mfma_f32_16x16x32_bf16 v[176:179], a[128:131], a[24:27], v[176:179]
    v_mfma_f32_16x16x32_bf16 v[200:203], a[128:131], a[28:31], v[200:203]
    v_mfma_f32_16x16x32_bf16 v[224:227], a[128:131], a[32:35], v[224:227]
    s_waitcnt vmcnt(7) lgkmcnt(0)
    v_mfma_f32_16x16x32_bf16 v[132:135], a[80:83], a[40:43], v[132:135]
    ds_read_b128 a[108:111], v5 offset:43008
    v_mfma_f32_16x16x32_bf16 v[156:159], a[80:83], a[44:47], v[156:159]
    v_mfma_f32_16x16x32_bf16 v[180:183], a[80:83], a[48:51], v[180:183]
    ds_read_b128 a[112:115], v5 offset:44032
    v_mfma_f32_16x16x32_bf16 v[204:207], a[80:83], a[52:55], v[204:207]
    v_mfma_f32_16x16x32_bf16 v[136:139], a[84:87], a[40:43], v[136:139]
    v_mfma_f32_16x16x32_bf16 v[160:163], a[84:87], a[44:47], v[160:163]
    ds_read_b128 a[116:119], v5 offset:45056
    v_mfma_f32_16x16x32_bf16 v[184:187], a[84:87], a[48:51], v[184:187]
    v_mfma_f32_16x16x32_bf16 v[208:211], a[84:87], a[52:55], v[208:211]
    v_mfma_f32_16x16x32_bf16 v[140:143], a[88:91], a[40:43], v[140:143]
    ds_read_b128 a[120:123], v5 offset:46080
    v_mfma_f32_16x16x32_bf16 v[164:167], a[88:91], a[44:47], v[164:167]
    v_mfma_f32_16x16x32_bf16 v[188:191], a[88:91], a[48:51], v[188:191]
    v_mfma_f32_16x16x32_bf16 v[212:215], a[88:91], a[52:55], v[212:215]
    ds_read_b128 a[124:127], v5 offset:47104
    v_mfma_f32_16x16x32_bf16 v[144:147], a[92:95], a[40:43], v[144:147]
    v_mfma_f32_16x16x32_bf16 v[168:171], a[92:95], a[44:47], v[168:171]
    v_mfma_f32_16x16x32_bf16 v[192:195], a[92:95], a[48:51], v[192:195]
    ds_read_b128 a[128:131], v5 offset:48128
    v_mfma_f32_16x16x32_bf16 v[216:219], a[92:95], a[52:55], v[216:219]
    v_mfma_f32_16x16x32_bf16 v[148:151], a[96:99], a[40:43], v[148:151]
    v_mfma_f32_16x16x32_bf16 v[172:175], a[96:99], a[44:47], v[172:175]
    v_mfma_f32_16x16x32_bf16 v[196:199], a[96:99], a[48:51], v[196:199]
    v_mfma_f32_16x16x32_bf16 v[220:223], a[96:99], a[52:55], v[220:223]
    v_mfma_f32_16x16x32_bf16 v[152:155], a[100:103], a[40:43], v[152:155]
    v_mfma_f32_16x16x32_bf16 v[176:179], a[100:103], a[44:47], v[176:179]
    v_mfma_f32_16x16x32_bf16 v[200:203], a[100:103], a[48:51], v[200:203]
    v_mfma_f32_16x16x32_bf16 v[224:227], a[100:103], a[52:55], v[224:227]
    s_waitcnt vmcnt(1) lgkmcnt(0)
    s_barrier
    v_mfma_f32_16x16x32_bf16 v[132:135], a[108:111], a[60:63], v[132:135]
    v_mfma_f32_16x16x32_bf16 v[156:159], a[108:111], a[64:67], v[156:159]
    v_mfma_f32_16x16x32_bf16 v[180:183], a[108:111], a[68:71], v[180:183]
    v_mfma_f32_16x16x32_bf16 v[204:207], a[108:111], a[72:75], v[204:207]
    v_mfma_f32_16x16x32_bf16 v[136:139], a[112:115], a[60:63], v[136:139]
    v_mfma_f32_16x16x32_bf16 v[160:163], a[112:115], a[64:67], v[160:163]
    v_mfma_f32_16x16x32_bf16 v[184:187], a[112:115], a[68:71], v[184:187]
    v_mfma_f32_16x16x32_bf16 v[208:211], a[112:115], a[72:75], v[208:211]
    v_mfma_f32_16x16x32_bf16 v[140:143], a[116:119], a[60:63], v[140:143]
    v_mfma_f32_16x16x32_bf16 v[164:167], a[116:119], a[64:67], v[164:167]
    v_mfma_f32_16x16x32_bf16 v[188:191], a[116:119], a[68:71], v[188:191]
    v_mfma_f32_16x16x32_bf16 v[212:215], a[116:119], a[72:75], v[212:215]
    v_mfma_f32_16x16x32_bf16 v[144:147], a[120:123], a[60:63], v[144:147]
    v_mfma_f32_16x16x32_bf16 v[168:171], a[120:123], a[64:67], v[168:171]
    v_mfma_f32_16x16x32_bf16 v[192:195], a[120:123], a[68:71], v[192:195]
    v_mfma_f32_16x16x32_bf16 v[216:219], a[120:123], a[72:75], v[216:219]
    v_mfma_f32_16x16x32_bf16 v[148:151], a[124:127], a[60:63], v[148:151]
    v_mfma_f32_16x16x32_bf16 v[172:175], a[124:127], a[64:67], v[172:175]
    v_mfma_f32_16x16x32_bf16 v[196:199], a[124:127], a[68:71], v[196:199]
    v_mfma_f32_16x16x32_bf16 v[220:223], a[124:127], a[72:75], v[220:223]
    v_mfma_f32_16x16x32_bf16 v[152:155], a[128:131], a[60:63], v[152:155]
    v_mfma_f32_16x16x32_bf16 v[176:179], a[128:131], a[64:67], v[176:179]
    v_mfma_f32_16x16x32_bf16 v[200:203], a[128:131], a[68:71], v[200:203]
    v_mfma_f32_16x16x32_bf16 v[224:227], a[128:131], a[72:75], v[224:227]
    v_pk_add_f32 v[92:93], v[92:93], v[94:95]
    v_pk_add_f32 v[96:97], v[96:97], v[98:99]
    v_pk_add_f32 v[100:101], v[100:101], v[102:103]
    v_pk_add_f32 v[104:105], v[104:105], v[106:107]
    v_pk_add_f32 v[92:93], v[92:93], v[96:97]
    v_pk_add_f32 v[100:101], v[100:101], v[104:105]
    v_pk_add_f32 v[108:109], v[108:109], v[110:111]
    v_permlane32_swap_b32 v92, v93
    v_permlane32_swap_b32 v100, v101
    v_add_f32 v92, v92, v93
    v_add_f32 v100, v100, v101
    v_pk_add_f32 v[112:113], v[112:113], v[114:115]
    v_mov_b32 v94, v92
    v_mov_b32 v102, v100
    v_pk_add_f32 v[108:109], v[108:109], v[112:113]
    v_permlane16_swap_b32 v92, v94
    v_permlane16_swap_b32 v100, v102
    v_permlane32_swap_b32 v108, v109
    v_add_f32 v92, v92, v94
    v_add_f32 v100, v100, v102
    v_add_f32 v108, v108, v109
    v_mov_b32 v94, v92
    v_mov_b32 v102, v100
    v_mov_b32 v110, v108
    v_permlane32_swap_b32 v92, v94
    v_permlane32_swap_b32 v100, v102
    v_permlane16_swap_b32 v108, v110
    v_mul_f32 v82, 0xba800000, v92
    v_mul_f32 v94, 0x3a800000, v94
    v_mul_f32 v84, 0xba800000, v100
    v_mul_f32 v102, 0x3a800000, v102
    v_add_f32 v108, v108, v110
    v_fma_f32 v94, -v82, v82, v94
    v_fma_f32 v102, -v84, v84, v102
    v_mov_b32 v110, v108
    v_max_f32 v94, 0, v94
    v_max_f32 v102, 0, v102
    v_permlane32_swap_b32 v108, v110
    v_add_f32 v94, 0x3727c5ac, v94
    v_add_f32 v102, 0x3727c5ac, v102
    v_rsq_f32 v83, v94
    v_rsq_f32 v85, v102
    v_mul_f32 v86, 0xba800000, v108
    v_mul_f32 v110, 0x3a800000, v110
    v_pk_fma_f32 v[140:141], v[56:57], v[82:83], v[140:141] op_sel:[0,0,0] op_sel_hi:[1,0,1]
    v_fma_f32 v110, -v86, v86, v110
    v_pk_fma_f32 v[164:165], v[56:57], v[84:85], v[164:165] op_sel:[0,0,0] op_sel_hi:[1,0,1]
    v_max_f32 v110, 0, v110
    v_pk_fma_f32 v[142:143], v[58:59], v[82:83], v[142:143] op_sel:[0,0,0] op_sel_hi:[1,0,1]
    v_pk_fma_f32 v[166:167], v[58:59], v[84:85], v[166:167] op_sel:[0,0,0] op_sel_hi:[1,0,1]
    v_pk_fma_f32 v[144:145], v[60:61], v[82:83], v[144:145] op_sel:[0,0,0] op_sel_hi:[1,0,1]
    v_pk_fma_f32 v[146:147], v[62:63], v[82:83], v[146:147] op_sel:[0,0,0] op_sel_hi:[1,0,1]
    v_pk_fma_f32 v[168:169], v[60:61], v[84:85], v[168:169] op_sel:[0,0,0] op_sel_hi:[1,0,1]
    v_pk_fma_f32 v[170:171], v[62:63], v[84:85], v[170:171] op_sel:[0,0,0] op_sel_hi:[1,0,1]
    v_cvt_pk_bf16_f32 v140, v140, v141
    v_cvt_pk_bf16_f32 v164, v164, v165
    v_add_f32 v110, 0x3727c5ac, v110
    v_cvt_pk_bf16_f32 v141, v142, v143
    v_cvt_pk_bf16_f32 v165, v166, v167
    v_cvt_pk_bf16_f32 v142, v144, v145
    v_cvt_pk_bf16_f32 v143, v146, v147
    v_cvt_pk_bf16_f32 v166, v168, v169
    v_cvt_pk_bf16_f32 v167, v170, v171
    v_rsq_f32 v87, v110
    v_mfma_f32_16x16x32_bf16 v[92:95], a[192:195], v[140:143], 0
    v_pk_add_f32 v[116:117], v[116:117], v[118:119]
    s_waitcnt vmcnt(0)
    v_pk_add_f32 v[120:121], v[120:121], v[122:123]
    v_mul_f32 v240, 0x3fb8aa3b, v83
    v_mfma_f32_16x16x32_bf16 v[108:111], a[192:195], v[164:167], 0
    v_pk_add_f32 v[116:117], v[116:117], v[120:121]
    v_mul_f32 v246, 0x3fb8aa3b, v85
    v_mfma_f32_16x16x32_bf16 v[96:99], a[196:199], v[140:143], 0
    v_max3_f32 v236, v92, v93, v94
    v_max3_f32 v237, -v92, -v93, -v94
    v_mfma_f32_16x16x32_bf16 v[112:115], a[196:199], v[164:167], 0
    v_permlane32_swap_b32 v116, v117
    s_nop 0
    v_max3_f32 v242, v108, v109, v110
    v_max3_f32 v243, -v108, -v109, -v110
    v_add_f32 v116, v116, v117
    v_max3_f32 v236, v236, v95, v96
    v_max3_f32 v237, v237, -v95, -v96
    v_max3_f32 v236, v236, v97, v98
    v_max3_f32 v237, v237, -v97, -v98
    v_max3_f32 v242, v242, v111, v112
    v_max3_f32 v243, v243, -v111, -v112
    v_max3_f32 v242, v242, v113, v114
    v_max3_f32 v243, v243, -v113, -v114
    v_max_f32 v236, v236, v99
    v_max_f32_e64 v237, v237, -v99
    v_max_f32 v242, v242, v115
    v_max_f32_e64 v243, v243, -v115
    v_mov_b32 v118, v116
    v_permlane32_swap_b32 v236, v237
    v_permlane32_swap_b32 v242, v243
    v_permlane16_swap_b32 v116, v118
    v_max_f32 v236, v236, v237
    v_max_f32 v242, v242, v243
    v_add_f32 v116, v116, v118
    v_mov_b32 v238, v236
    v_mov_b32 v244, v242
    v_mov_b32 v118, v116
    v_permlane16_swap_b32 v236, v238
    v_permlane16_swap_b32 v242, v244
    v_permlane32_swap_b32 v116, v118
    v_max_f32 v236, v236, v238
    v_max_f32 v242, v242, v244
    v_mul_f32 v88, 0xba800000, v116
    v_mul_f32 v118, 0x3a800000, v118
    v_mov_b32 v238, v236
    v_mov_b32 v244, v242
    v_fma_f32 v118, -v88, v88, v118
    v_permlane32_swap_b32 v236, v238
    v_max_f32 v118, 0, v118
    v_permlane32_swap_b32 v242, v244
    v_add_f32 v118, 0x3727c5ac, v118
    v_mul_f32_e64 v236, -v236, v240
    v_mul_f32_e64 v237, -v238, v240
    v_mul_f32_e64 v242, -v242, v246
    v_mul_f32_e64 v243, -v244, v246
    v_rsq_f32 v89, v118
    v_pk_fma_f32 v[100:101], v[92:93], v[240:241], v[236:237] op_sel:[0,0,0] op_sel_hi:[1,0,0]
    v_pk_fma_f32 v[102:103], v[94:95], v[240:241], v[236:237] op_sel:[0,0,0] op_sel_hi:[1,0,0]
    v_pk_fma_f32 v[104:105], v[96:97], v[240:241], v[236:237] op_sel:[0,0,0] op_sel_hi:[1,0,0]
    v_pk_fma_f32 v[106:107], v[98:99], v[240:241], v[236:237] op_sel:[0,0,0] op_sel_hi:[1,0,0]
    v_pk_fma_f32 v[116:117], v[108:109], v[246:247], v[242:243] op_sel:[0,0,0] op_sel_hi:[1,0,0]
    v_pk_fma_f32 v[118:119], v[110:111], v[246:247], v[242:243] op_sel:[0,0,0] op_sel_hi:[1,0,0]
    v_pk_fma_f32 v[120:121], v[112:113], v[246:247], v[242:243] op_sel:[0,0,0] op_sel_hi:[1,0,0]
    v_pk_fma_f32 v[122:123], v[114:115], v[246:247], v[242:243] op_sel:[0,0,0] op_sel_hi:[1,0,0]
    v_pk_fma_f32 v[92:93], v[92:93], v[240:241], v[236:237] op_sel:[0,0,1] op_sel_hi:[1,0,1] neg_lo:[1,0,0] neg_hi:[1,0,0]
    v_pk_fma_f32 v[94:95], v[94:95], v[240:241], v[236:237] op_sel:[0,0,1] op_sel_hi:[1,0,1] neg_lo:[1,0,0] neg_hi:[1,0,0]
    v_pk_fma_f32 v[96:97], v[96:97], v[240:241], v[236:237] op_sel:[0,0,1] op_sel_hi:[1,0,1] neg_lo:[1,0,0] neg_hi:[1,0,0]
    v_pk_fma_f32 v[98:99], v[98:99], v[240:241], v[236:237] op_sel:[0,0,1] op_sel_hi:[1,0,1] neg_lo:[1,0,0] neg_hi:[1,0,0]
    v_pk_fma_f32 v[108:109], v[108:109], v[246:247], v[242:243] op_sel:[0,0,1] op_sel_hi:[1,0,1] neg_lo:[1,0,0] neg_hi:[1,0,0]
    v_pk_fma_f32 v[110:111], v[110:111], v[246:247], v[242:243] op_sel:[0,0,1] op_sel_hi:[1,0,1] neg_lo:[1,0,0] neg_hi:[1,0,0]
    v_pk_fma_f32 v[112:113], v[112:113], v[246:247], v[242:243] op_sel:[0,0,1] op_sel_hi:[1,0,1] neg_lo:[1,0,0] neg_hi:[1,0,0]
    v_pk_fma_f32 v[114:115], v[114:115], v[246:247], v[242:243] op_sel:[0,0,1] op_sel_hi:[1,0,1] neg_lo:[1,0,0] neg_hi:[1,0,0]
    v_exp_f32 v92, v92
    v_exp_f32 v93, v93
    v_exp_f32 v94, v94
    v_exp_f32 v95, v95
    v_exp_f32 v96, v96
    v_exp_f32 v97, v97
    v_exp_f32 v98, v98
    v_exp_f32 v99, v99
    v_exp_f32 v108, v108
    v_exp_f32 v109, v109
    v_exp_f32 v110, v110
    v_exp_f32 v111, v111
    v_exp_f32 v112, v112
    v_exp_f32 v113, v113
    v_exp_f32 v114, v114
    v_exp_f32 v115, v115
    v_pk_fma_f32 v[148:149], v[64:65], v[82:83], v[148:149] op_sel:[0,0,0] op_sel_hi:[1,0,1]
    v_pk_fma_f32 v[172:173], v[64:65], v[84:85], v[172:173] op_sel:[0,0,0] op_sel_hi:[1,0,1]
    v_pk_fma_f32 v[150:151], v[66:67], v[82:83], v[150:151] op_sel:[0,0,0] op_sel_hi:[1,0,1]
    v_pk_fma_f32 v[174:175], v[66:67], v[84:85], v[174:175] op_sel:[0,0,0] op_sel_hi:[1,0,1]
    v_pk_fma_f32 v[152:153], v[68:69], v[82:83], v[152:153] op_sel:[0,0,0] op_sel_hi:[1,0,1]
    v_pk_fma_f32 v[154:155], v[70:71], v[82:83], v[154:155] op_sel:[0,0,0] op_sel_hi:[1,0,1]
    v_pk_fma_f32 v[176:177], v[68:69], v[84:85], v[176:177] op_sel:[0,0,0] op_sel_hi:[1,0,1]
    v_pk_fma_f32 v[178:179], v[70:71], v[84:85], v[178:179] op_sel:[0,0,0] op_sel_hi:[1,0,1]
    v_pk_mul_f32 v[148:149], v[148:149], v[82:83] op_sel:[0,1] op_sel_hi:[1,1]
    v_pk_mul_f32 v[172:173], v[172:173], v[84:85] op_sel:[0,1] op_sel_hi:[1,1]
    v_pk_mul_f32 v[150:151], v[150:151], v[82:83] op_sel:[0,1] op_sel_hi:[1,1]
    v_pk_mul_f32 v[174:175], v[174:175], v[84:85] op_sel:[0,1] op_sel_hi:[1,1]
    v_pk_mul_f32 v[152:153], v[152:153], v[82:83] op_sel:[0,1] op_sel_hi:[1,1]
    v_pk_mul_f32 v[154:155], v[154:155], v[82:83] op_sel:[0,1] op_sel_hi:[1,1]
    v_pk_mul_f32 v[176:177], v[176:177], v[84:85] op_sel:[0,1] op_sel_hi:[1,1]
    v_pk_mul_f32 v[178:179], v[178:179], v[84:85] op_sel:[0,1] op_sel_hi:[1,1]
    v_cvt_pk_bf16_f32 v144, v92, v93
    v_cvt_pk_bf16_f32 v145, v94, v95
    v_cvt_pk_bf16_f32 v146, v96, v97
    v_cvt_pk_bf16_f32 v147, v98, v99
    v_cvt_pk_bf16_f32 v168, v108, v109
    v_cvt_pk_bf16_f32 v169, v110, v111
    v_cvt_pk_bf16_f32 v170, v112, v113
    v_cvt_pk_bf16_f32 v171, v114, v115
    v_cvt_pk_bf16_f32 v148, v148, v149
    v_cvt_pk_bf16_f32 v172, v172, v173
    v_cvt_pk_bf16_f32 v149, v150, v151
    v_cvt_pk_bf16_f32 v173, v174, v175
    v_cvt_pk_bf16_f32 v150, v152, v153
    v_cvt_pk_bf16_f32 v151, v154, v155
    v_cvt_pk_bf16_f32 v174, v176, v177
    v_cvt_pk_bf16_f32 v175, v178, v179
    v_mfma_f32_16x16x32_bf16 v[152:155], v[16:19], v[144:147], 0
    v_pk_fma_f32 v[188:189], v[56:57], v[86:87], v[188:189] op_sel:[0,0,0] op_sel_hi:[1,0,1]
    v_pk_fma_f32 v[212:213], v[56:57], v[88:89], v[212:213] op_sel:[0,0,0] op_sel_hi:[1,0,1]
    v_cvt_pk_bf16_f32 v188, v188, v189
    v_mfma_f32_16x16x32_bf16 v[176:179], v[16:19], v[168:171], 0
    v_pk_fma_f32 v[190:191], v[58:59], v[86:87], v[190:191] op_sel:[0,0,0] op_sel_hi:[1,0,1]
    v_pk_fma_f32 v[214:215], v[58:59], v[88:89], v[214:215] op_sel:[0,0,0] op_sel_hi:[1,0,1]
    v_pk_fma_f32 v[192:193], v[60:61], v[86:87], v[192:193] op_sel:[0,0,0] op_sel_hi:[1,0,1]
    v_pk_fma_f32 v[194:195], v[62:63], v[86:87], v[194:195] op_sel:[0,0,0] op_sel_hi:[1,0,1]
    v_rcp_f32 v152, v152
    v_pk_fma_f32 v[216:217], v[60:61], v[88:89], v[216:217] op_sel:[0,0,0] op_sel_hi:[1,0,1]
    v_pk_fma_f32 v[218:219], v[62:63], v[88:89], v[218:219] op_sel:[0,0,0] op_sel_hi:[1,0,1]
    v_cvt_pk_bf16_f32 v212, v212, v213
    v_rcp_f32 v176, v176
    v_cvt_pk_bf16_f32 v189, v190, v191
    v_cvt_pk_bf16_f32 v213, v214, v215
    v_pk_mul_f32 v[92:93], v[92:93], v[152:153] op_sel:[0,0] op_sel_hi:[1,0]
    v_pk_mul_f32 v[94:95], v[94:95], v[152:153] op_sel:[0,0] op_sel_hi:[1,0]
    v_pk_mul_f32 v[108:109], v[108:109], v[176:177] op_sel:[0,0] op_sel_hi:[1,0]
    v_pk_mul_f32 v[110:111], v[110:111], v[176:177] op_sel:[0,0] op_sel_hi:[1,0]
    v_cvt_pk_bf16_f32 v190, v192, v193
    v_cvt_pk_bf16_f32 v191, v194, v195
    v_cvt_pk_bf16_f32 v214, v216, v217
    v_cvt_pk_bf16_f32 v215, v218, v219
    v_pk_mul_f32 v[96:97], v[96:97], v[152:153] op_sel:[0,0] op_sel_hi:[1,0]
    v_pk_mul_f32 v[98:99], v[98:99], v[152:153] op_sel:[0,0] op_sel_hi:[1,0]
    v_cvt_pk_bf16_f32 v144, v92, v93
    v_cvt_pk_bf16_f32 v145, v94, v95
    v_pk_mul_f32 v[112:113], v[112:113], v[176:177] op_sel:[0,0] op_sel_hi:[1,0]
    v_cvt_pk_bf16_f32 v168, v108, v109
    v_pk_mul_f32 v[114:115], v[114:115], v[176:177] op_sel:[0,0] op_sel_hi:[1,0]
    v_cvt_pk_bf16_f32 v169, v110, v111
    v_mfma_f32_16x16x32_bf16 v[92:95], a[192:195], v[188:191], 0
    v_cvt_pk_bf16_f32 v146, v96, v97
    v_cvt_pk_bf16_f32 v147, v98, v99
    v_mfma_f32_16x16x32_bf16 v[108:111], a[192:195], v[212:215], 0
    v_cvt_pk_bf16_f32 v170, v112, v113
    v_cvt_pk_bf16_f32 v171, v114, v115
    v_mfma_f32_16x16x32_bf16 v[96:99], a[196:199], v[188:191], 0
    v_exp_f32 v100, v100
    v_mfma_f32_16x16x32_bf16 v[112:115], a[196:199], v[212:215], 0
    v_max3_f32 v236, v92, v93, v94
    v_max3_f32 v237, -v92, -v93, -v94
    s_nop 0
    v_max3_f32 v242, v108, v109, v110
    v_max3_f32 v243, -v108, -v109, -v110
    v_exp_f32 v101, v101
    v_max3_f32 v236, v236, v95, v96
    v_max3_f32 v237, v237, -v95, -v96
    v_max3_f32 v236, v236, v97, v98
    v_max3_f32 v242, v242, v111, v112
    v_max3_f32 v243, v243, -v111, -v112
    v_max3_f32 v237, v237, -v97, -v98
    v_max3_f32 v242, v242, v113, v114
    v_max3_f32 v243, v243, -v113, -v114
    v_max_f32 v236, v236, v99
    v_max_f32_e64 v237, v237, -v99
    v_max_f32 v242, v242, v115
    v_max_f32_e64 v243, v243, -v115
    v_exp_f32 v102, v102
    v_exp_f32 v103, v103
    v_exp_f32 v104, v104
    v_exp_f32 v105, v105
    v_exp_f32 v106, v106
    v_exp_f32 v107, v107
    v_exp_f32 v116, v116
    v_exp_f32 v117, v117
    v_exp_f32 v118, v118
    v_exp_f32 v119, v119
    v_exp_f32 v120, v120
    v_exp_f32 v121, v121
    v_exp_f32 v122, v122
    v_exp_f32 v123, v123
    v_permlane32_swap_b32 v236, v237
    v_permlane32_swap_b32 v242, v243
    s_lshl_b32 s36, s28, 12
    v_add_u32 v232, s36, v7
    v_cvt_pk_bf16_f32 v140, v100, v101
    v_cvt_pk_bf16_f32 v141, v102, v103
    v_cvt_pk_bf16_f32 v142, v104, v105
    v_cvt_pk_bf16_f32 v143, v106, v107
    v_cvt_pk_bf16_f32 v164, v116, v117
    v_cvt_pk_bf16_f32 v165, v118, v119
    v_cvt_pk_bf16_f32 v166, v120, v121
    v_cvt_pk_bf16_f32 v167, v122, v123
    v_max_f32 v236, v236, v237
    v_max_f32 v242, v242, v243
    ds_write_b64 v232, v[148:149] offset:0
    ds_write_b64 v232, v[150:151] offset:512
    ds_write_b64 v232, v[172:173] offset:1024
    ds_write_b64 v232, v[174:175] offset:1536
    v_mov_b32 v238, v236
    v_mov_b32 v244, v242
    v_mfma_f32_16x16x32_bf16 v[148:151], v[16:19], v[140:143], 0
    v_permlane16_swap_b32 v236, v238
    v_mfma_f32_16x16x32_bf16 v[172:175], v[16:19], v[164:167], 0
    v_permlane16_swap_b32 v242, v244
    v_max_f32 v236, v236, v238
    v_max_f32 v242, v242, v244
    v_mov_b32 v238, v236
    v_mov_b32 v244, v242
    s_nop 0
    v_rcp_f32 v148, v148
    v_permlane32_swap_b32 v236, v238
    v_rcp_f32 v172, v172
    v_permlane32_swap_b32 v242, v244
    v_mul_f32 v240, 0x3fb8aa3b, v87
    v_mul_f32 v246, 0x3fb8aa3b, v89
    v_pk_mul_f32 v[100:101], v[100:101], v[148:149] op_sel:[0,0] op_sel_hi:[1,0]
    v_pk_mul_f32 v[102:103], v[102:103], v[148:149] op_sel:[0,0] op_sel_hi:[1,0]
    v_pk_mul_f32 v[104:105], v[104:105], v[148:149] op_sel:[0,0] op_sel_hi:[1,0]
    v_pk_mul_f32 v[106:107], v[106:107], v[148:149] op_sel:[0,0] op_sel_hi:[1,0]
    v_pk_mul_f32 v[116:117], v[116:117], v[172:173] op_sel:[0,0] op_sel_hi:[1,0]
    v_pk_mul_f32 v[118:119], v[118:119], v[172:173] op_sel:[0,0] op_sel_hi:[1,0]
    v_pk_mul_f32 v[120:121], v[120:121], v[172:173] op_sel:[0,0] op_sel_hi:[1,0]
    v_pk_mul_f32 v[122:123], v[122:123], v[172:173] op_sel:[0,0] op_sel_hi:[1,0]
    v_mul_f32_e64 v236, -v236, v240
    v_mul_f32_e64 v237, -v238, v240
    v_mul_f32_e64 v242, -v242, v246
    v_mul_f32_e64 v243, -v244, v246
    v_cvt_pk_bf16_f32 v140, v100, v101
    v_cvt_pk_bf16_f32 v141, v102, v103
    v_cvt_pk_bf16_f32 v142, v104, v105
    v_cvt_pk_bf16_f32 v143, v106, v107
    v_cvt_pk_bf16_f32 v164, v116, v117
    v_cvt_pk_bf16_f32 v165, v118, v119
    v_cvt_pk_bf16_f32 v166, v120, v121
    v_cvt_pk_bf16_f32 v167, v122, v123
    v_pk_fma_f32 v[100:101], v[92:93], v[240:241], v[236:237] op_sel:[0,0,0] op_sel_hi:[1,0,0]
    v_pk_fma_f32 v[102:103], v[94:95], v[240:241], v[236:237] op_sel:[0,0,0] op_sel_hi:[1,0,0]
    v_pk_fma_f32 v[104:105], v[96:97], v[240:241], v[236:237] op_sel:[0,0,0] op_sel_hi:[1,0,0]
    v_pk_fma_f32 v[106:107], v[98:99], v[240:241], v[236:237] op_sel:[0,0,0] op_sel_hi:[1,0,0]
    v_pk_fma_f32 v[116:117], v[108:109], v[246:247], v[242:243] op_sel:[0,0,0] op_sel_hi:[1,0,0]
    v_pk_fma_f32 v[118:119], v[110:111], v[246:247], v[242:243] op_sel:[0,0,0] op_sel_hi:[1,0,0]
    v_pk_fma_f32 v[120:121], v[112:113], v[246:247], v[242:243] op_sel:[0,0,0] op_sel_hi:[1,0,0]
    v_pk_fma_f32 v[122:123], v[114:115], v[246:247], v[242:243] op_sel:[0,0,0] op_sel_hi:[1,0,0]
    v_pk_fma_f32 v[196:197], v[64:65], v[86:87], v[196:197] op_sel:[0,0,0] op_sel_hi:[1,0,1]
    v_pk_fma_f32 v[220:221], v[64:65], v[88:89], v[220:221] op_sel:[0,0,0] op_sel_hi:[1,0,1]
    v_pk_fma_f32 v[92:93], v[92:93], v[240:241], v[236:237] op_sel:[0,0,1] op_sel_hi:[1,0,1] neg_lo:[1,0,0] neg_hi:[1,0,0]
    v_pk_fma_f32 v[94:95], v[94:95], v[240:241], v[236:237] op_sel:[0,0,1] op_sel_hi:[1,0,1] neg_lo:[1,0,0] neg_hi:[1,0,0]
    v_pk_fma_f32 v[96:97], v[96:97], v[240:241], v[236:237] op_sel:[0,0,1] op_sel_hi:[1,0,1] neg_lo:[1,0,0] neg_hi:[1,0,0]
    v_pk_fma_f32 v[98:99], v[98:99], v[240:241], v[236:237] op_sel:[0,0,1] op_sel_hi:[1,0,1] neg_lo:[1,0,0] neg_hi:[1,0,0]
    v_pk_fma_f32 v[108:109], v[108:109], v[246:247], v[242:243] op_sel:[0,0,1] op_sel_hi:[1,0,1] neg_lo:[1,0,0] neg_hi:[1,0,0]
    v_pk_fma_f32 v[110:111], v[110:111], v[246:247], v[242:243] op_sel:[0,0,1] op_sel_hi:[1,0,1] neg_lo:[1,0,0] neg_hi:[1,0,0]
    v_pk_fma_f32 v[112:113], v[112:113], v[246:247], v[242:243] op_sel:[0,0,1] op_sel_hi:[1,0,1] neg_lo:[1,0,0] neg_hi:[1,0,0]
    v_pk_fma_f32 v[114:115], v[114:115], v[246:247], v[242:243] op_sel:[0,0,1] op_sel_hi:[1,0,1] neg_lo:[1,0,0] neg_hi:[1,0,0]
    v_pk_fma_f32 v[198:199], v[66:67], v[86:87], v[198:199] op_sel:[0,0,0] op_sel_hi:[1,0,1]
    v_pk_fma_f32 v[222:223], v[66:67], v[88:89], v[222:223] op_sel:[0,0,0] op_sel_hi:[1,0,1]
    v_pk_fma_f32 v[200:201], v[68:69], v[86:87], v[200:201] op_sel:[0,0,0] op_sel_hi:[1,0,1]
    v_pk_fma_f32 v[202:203], v[70:71], v[86:87], v[202:203] op_sel:[0,0,0] op_sel_hi:[1,0,1]
    v_pk_fma_f32 v[224:225], v[68:69], v[88:89], v[224:225] op_sel:[0,0,0] op_sel_hi:[1,0,1]
    v_pk_fma_f32 v[226:227], v[70:71], v[88:89], v[226:227] op_sel:[0,0,0] op_sel_hi:[1,0,1]
    v_pk_mul_f32 v[196:197], v[196:197], v[86:87] op_sel:[0,1] op_sel_hi:[1,1]
    v_pk_mul_f32 v[220:221], v[220:221], v[88:89] op_sel:[0,1] op_sel_hi:[1,1]
    v_exp_f32 v100, v100
    v_exp_f32 v92, v92
    v_exp_f32 v101, v101
    v_exp_f32 v93, v93
    v_exp_f32 v102, v102
    v_exp_f32 v94, v94
    v_exp_f32 v103, v103
    v_exp_f32 v95, v95
    v_exp_f32 v104, v104
    v_exp_f32 v96, v96
    v_exp_f32 v105, v105
    v_exp_f32 v97, v97
    v_exp_f32 v106, v106
    v_exp_f32 v98, v98
    v_exp_f32 v107, v107
    v_exp_f32 v99, v99
    v_exp_f32 v116, v116
    v_exp_f32 v108, v108
    v_exp_f32 v117, v117
    v_exp_f32 v109, v109
    v_exp_f32 v118, v118
    v_exp_f32 v110, v110
    v_exp_f32 v119, v119
    v_exp_f32 v111, v111
    v_exp_f32 v120, v120
    v_exp_f32 v112, v112
    v_exp_f32 v121, v121
    v_exp_f32 v113, v113
    v_exp_f32 v122, v122
    v_exp_f32 v114, v114
    v_exp_f32 v123, v123
    v_exp_f32 v115, v115
    v_pk_mul_f32 v[198:199], v[198:199], v[86:87] op_sel:[0,1] op_sel_hi:[1,1]
    v_pk_mul_f32 v[222:223], v[222:223], v[88:89] op_sel:[0,1] op_sel_hi:[1,1]
    v_pk_mul_f32 v[200:201], v[200:201], v[86:87] op_sel:[0,1] op_sel_hi:[1,1]
    v_pk_mul_f32 v[202:203], v[202:203], v[86:87] op_sel:[0,1] op_sel_hi:[1,1]
    v_pk_mul_f32 v[224:225], v[224:225], v[88:89] op_sel:[0,1] op_sel_hi:[1,1]
    v_pk_mul_f32 v[226:227], v[226:227], v[88:89] op_sel:[0,1] op_sel_hi:[1,1]
    v_cvt_pk_bf16_f32 v196, v196, v197
    v_cvt_pk_bf16_f32 v220, v220, v221
    v_cvt_pk_bf16_f32 v197, v198, v199
    v_cvt_pk_bf16_f32 v221, v222, v223
    v_cvt_pk_bf16_f32 v198, v200, v201
    v_cvt_pk_bf16_f32 v199, v202, v203
    v_cvt_pk_bf16_f32 v222, v224, v225
    v_cvt_pk_bf16_f32 v223, v226, v227
    v_cvt_pk_bf16_f32 v188, v100, v101
    v_cvt_pk_bf16_f32 v189, v102, v103
    v_cvt_pk_bf16_f32 v190, v104, v105
    v_cvt_pk_bf16_f32 v191, v106, v107
    v_cvt_pk_bf16_f32 v192, v92, v93
    v_cvt_pk_bf16_f32 v193, v94, v95
    v_cvt_pk_bf16_f32 v194, v96, v97
    v_cvt_pk_bf16_f32 v195, v98, v99
    v_cvt_pk_bf16_f32 v212, v116, v117
    v_cvt_pk_bf16_f32 v213, v118, v119
    v_cvt_pk_bf16_f32 v214, v120, v121
    v_cvt_pk_bf16_f32 v215, v122, v123
    v_cvt_pk_bf16_f32 v216, v108, v109
    v_cvt_pk_bf16_f32 v217, v110, v111
    v_cvt_pk_bf16_f32 v218, v112, v113
    v_cvt_pk_bf16_f32 v219, v114, v115
    ds_write_b64 v232, v[196:197] offset:2048
    ds_write_b64 v232, v[198:199] offset:2560
    ds_write_b64 v232, v[220:221] offset:3072
    ds_write_b64 v232, v[222:223] offset:3584
    v_mfma_f32_16x16x32_bf16 v[196:199], v[16:19], v[188:191], 0
    v_add_u32 v233, s36, v232
    v_mfma_f32_16x16x32_bf16 v[200:203], v[16:19], v[192:195], 0
    ds_write_b64 v233, v[140:141] offset:16384
    v_mfma_f32_16x16x32_bf16 v[220:223], v[16:19], v[212:215], 0
    ds_write_b64 v233, v[142:143] offset:16896
    v_mfma_f32_16x16x32_bf16 v[224:227], v[16:19], v[216:219], 0
    s_nop 1
    v_rcp_f32 v196, v196
    s_nop 0
    v_rcp_f32 v200, v200
    v_pk_mul_f32 v[100:101], v[100:101], v[196:197] op_sel:[0,0] op_sel_hi:[1,0]
    v_rcp_f32 v220, v220
    v_pk_mul_f32 v[102:103], v[102:103], v[196:197] op_sel:[0,0] op_sel_hi:[1,0]
    v_pk_mul_f32 v[104:105], v[104:105], v[196:197] op_sel:[0,0] op_sel_hi:[1,0]
    v_rcp_f32 v224, v224
    v_pk_mul_f32 v[106:107], v[106:107], v[196:197] op_sel:[0,0] op_sel_hi:[1,0]
    v_pk_mul_f32 v[92:93], v[92:93], v[200:201] op_sel:[0,0] op_sel_hi:[1,0]
    v_pk_mul_f32 v[94:95], v[94:95], v[200:201] op_sel:[0,0] op_sel_hi:[1,0]
    v_pk_mul_f32 v[96:97], v[96:97], v[200:201] op_sel:[0,0] op_sel_hi:[1,0]
    v_pk_mul_f32 v[98:99], v[98:99], v[200:201] op_sel:[0,0] op_sel_hi:[1,0]
    v_pk_mul_f32 v[116:117], v[116:117], v[220:221] op_sel:[0,0] op_sel_hi:[1,0]
    v_pk_mul_f32 v[118:119], v[118:119], v[220:221] op_sel:[0,0] op_sel_hi:[1,0]
    v_pk_mul_f32 v[120:121], v[120:121], v[220:221] op_sel:[0,0] op_sel_hi:[1,0]
    v_pk_mul_f32 v[122:123], v[122:123], v[220:221] op_sel:[0,0] op_sel_hi:[1,0]
    v_pk_mul_f32 v[108:109], v[108:109], v[224:225] op_sel:[0,0] op_sel_hi:[1,0]
    v_pk_mul_f32 v[110:111], v[110:111], v[224:225] op_sel:[0,0] op_sel_hi:[1,0]
    v_pk_mul_f32 v[112:113], v[112:113], v[224:225] op_sel:[0,0] op_sel_hi:[1,0]
    v_pk_mul_f32 v[114:115], v[114:115], v[224:225] op_sel:[0,0] op_sel_hi:[1,0]
    v_cvt_pk_bf16_f32 v188, v100, v101
    v_cvt_pk_bf16_f32 v189, v102, v103
    v_cvt_pk_bf16_f32 v190, v104, v105
    v_cvt_pk_bf16_f32 v191, v106, v107
    v_cvt_pk_bf16_f32 v192, v92, v93
    v_cvt_pk_bf16_f32 v193, v94, v95
    v_cvt_pk_bf16_f32 v194, v96, v97
    v_cvt_pk_bf16_f32 v195, v98, v99
    v_cvt_pk_bf16_f32 v212, v116, v117
    v_cvt_pk_bf16_f32 v213, v118, v119
    v_cvt_pk_bf16_f32 v214, v120, v121
    v_cvt_pk_bf16_f32 v215, v122, v123
    v_cvt_pk_bf16_f32 v216, v108, v109
    v_cvt_pk_bf16_f32 v217, v110, v111
    v_cvt_pk_bf16_f32 v218, v112, v113
    v_cvt_pk_bf16_f32 v219, v114, v115
    ds_write_b64 v233, v[144:145] offset:17408
    ds_write_b64 v233, v[146:147] offset:17920
    ds_write_b64 v233, v[164:165] offset:18432
    ds_write_b64 v233, v[166:167] offset:18944
    ds_write_b64 v233, v[168:169] offset:19456
    ds_write_b64 v233, v[170:171] offset:19968
    ds_write_b64 v233, v[188:189] offset:20480
    ds_write_b64 v233, v[190:191] offset:20992
    ds_write_b64 v233, v[192:193] offset:21504
    ds_write_b64 v233, v[194:195] offset:22016
    ds_write_b64 v233, v[212:213] offset:22528
    ds_write_b64 v233, v[214:215] offset:23040
    ds_write_b64 v233, v[216:217] offset:23552
    ds_write_b64 v233, v[218:219] offset:24064
    s_waitcnt lgkmcnt(0)
    s_barrier
    s_lshl_b32 s36, s28, 9
    v_add_u32 v234, s36, v8
    ds_read_b64_tr_b16 a[4:5], v8 offset:0
    ds_read_b64_tr_b16 a[0:1], v234 offset:16384
    ds_read_b64_tr_b16 a[2:3], v234 offset:18432
    ds_read_b64_tr_b16 a[6:7], v8 offset:1024
    ds_read_b64_tr_b16 a[8:9], v8 offset:512
    ds_read_b64_tr_b16 a[10:11], v8 offset:1536
    ds_read_b64_tr_b16 a[12:13], v234 offset:20480
    ds_read_b64_tr_b16 a[16:17], v8 offset:2048
    ds_read_b64_tr_b16 a[14:15], v234 offset:22528
    ds_read_b64_tr_b16 a[18:19], v8 offset:3072
    ds_read_b64_tr_b16 a[20:21], v8 offset:2560
    ds_read_b64_tr_b16 a[22:23], v8 offset:3584
    v_pk_fma_f32 v[132:133], v[48:49], v[82:83], v[132:133] op_sel:[0,0,0] op_sel_hi:[1,0,1]
    v_pk_fma_f32 v[156:157], v[48:49], v[84:85], v[156:157] op_sel:[0,0,0] op_sel_hi:[1,0,1]
    ds_read_b64_tr_b16 a[24:25], v234 offset:24576
    ds_read_b64_tr_b16 a[28:29], v8 offset:4096
    ds_read_b64_tr_b16 a[26:27], v234 offset:26624
    ds_read_b64_tr_b16 a[30:31], v8 offset:5120
    v_pk_fma_f32 v[134:135], v[50:51], v[82:83], v[134:135] op_sel:[0,0,0] op_sel_hi:[1,0,1]
    v_pk_fma_f32 v[158:159], v[50:51], v[84:85], v[158:159] op_sel:[0,0,0] op_sel_hi:[1,0,1]
    v_pk_fma_f32 v[136:137], v[52:53], v[82:83], v[136:137] op_sel:[0,0,0] op_sel_hi:[1,0,1]
    v_pk_fma_f32 v[138:139], v[54:55], v[82:83], v[138:139] op_sel:[0,0,0] op_sel_hi:[1,0,1]
    v_pk_fma_f32 v[160:161], v[52:53], v[84:85], v[160:161] op_sel:[0,0,0] op_sel_hi:[1,0,1]
    v_pk_fma_f32 v[162:163], v[54:55], v[84:85], v[162:163] op_sel:[0,0,0] op_sel_hi:[1,0,1]
    ds_read_b64_tr_b16 a[32:33], v8 offset:4608
    ds_read_b64_tr_b16 a[34:35], v8 offset:5632
    v_cvt_pk_bf16_f32 v132, v132, v133
    v_cvt_pk_bf16_f32 v156, v156, v157
    v_cvt_pk_bf16_f32 v133, v134, v135
    v_cvt_pk_bf16_f32 v157, v158, v159
    v_cvt_pk_bf16_f32 v134, v136, v137
    v_cvt_pk_bf16_f32 v135, v138, v139
    v_cvt_pk_bf16_f32 v158, v160, v161
    v_cvt_pk_bf16_f32 v159, v162, v163
    ds_read_b64_tr_b16 a[36:37], v234 offset:28672
    ds_read_b64_tr_b16 a[40:41], v8 offset:6144
    ds_read_b64_tr_b16 a[38:39], v234 offset:30720
    ds_read_b64_tr_b16 a[42:43], v8 offset:7168
    ds_read_b64_tr_b16 a[44:45], v8 offset:6656
    ds_read_b64_tr_b16 a[46:47], v8 offset:7680
    v_mfma_f32_16x16x32_bf16 v[108:111], a[192:195], v[132:135], 0
    ds_read_b64_tr_b16 a[48:49], v234 offset:32768
    ds_read_b64_tr_b16 a[52:53], v8 offset:8192
    v_mfma_f32_16x16x32_bf16 v[172:175], a[192:195], v[156:159], 0
    ds_read_b64_tr_b16 a[50:51], v234 offset:34816
    ds_read_b64_tr_b16 a[54:55], v8 offset:9216
    v_mfma_f32_16x16x32_bf16 v[112:115], a[196:199], v[132:135], 0
    ds_read_b64_tr_b16 a[56:57], v8 offset:8704
    ds_read_b64_tr_b16 a[58:59], v8 offset:9728
    v_mfma_f32_16x16x32_bf16 v[176:179], a[196:199], v[156:159], 0
    ds_read_b64_tr_b16 a[60:61], v234 offset:36864
    ds_read_b64_tr_b16 a[64:65], v8 offset:10240
    s_waitcnt lgkmcnt(14)
    v_mfma_f32_16x16x32_bf16 v[92:95], a[0:3], a[4:7], 0
    ds_read_b64_tr_b16 a[62:63], v234 offset:38912
    ds_read_b64_tr_b16 a[66:67], v8 offset:11264
    v_mfma_f32_16x16x32_bf16 v[96:99], a[0:3], a[8:11], 0
    ds_read_b64_tr_b16 a[68:69], v8 offset:10752
    ds_read_b64_tr_b16 a[70:71], v8 offset:11776
    v_mfma_f32_16x16x32_bf16 v[100:103], a[0:3], v[16:19], 0
    v_max3_f32 v236, v108, v109, v110
    v_max3_f32 v237, -v108, -v109, -v110
    v_max3_f32 v242, v172, v173, v174
    v_max3_f32 v243, -v172, -v173, -v174
    v_mfma_f32_16x16x32_bf16 v[92:95], a[12:15], a[16:19], v[92:95]
    ds_read_b64_tr_b16 a[72:73], v234 offset:40960
    ds_read_b64_tr_b16 a[76:77], v8 offset:12288
    ds_read_b64_tr_b16 a[74:75], v234 offset:43008
    ds_read_b64_tr_b16 a[78:79], v8 offset:13312
    v_mfma_f32_16x16x32_bf16 v[96:99], a[12:15], a[20:23], v[96:99]
    v_max3_f32 v236, v236, v111, v112
    v_max3_f32 v237, v237, -v111, -v112
    v_max3_f32 v242, v242, v175, v176
    v_max3_f32 v243, v243, -v175, -v176
    ds_read_b64_tr_b16 a[80:81], v8 offset:12800
    ds_read_b64_tr_b16 a[82:83], v8 offset:13824
    v_mfma_f32_16x16x32_bf16 v[100:103], a[12:15], v[16:19], v[100:103]
    v_max3_f32 v236, v236, v113, v114
    v_max3_f32 v237, v237, -v113, -v114
    v_max3_f32 v242, v242, v177, v178
    v_max3_f32 v243, v243, -v177, -v178
    v_mfma_f32_16x16x32_bf16 v[92:95], a[24:27], a[28:31], v[92:95]
    ds_read_b64_tr_b16 a[84:85], v234 offset:45056
    ds_read_b64_tr_b16 a[88:89], v8 offset:14336
    ds_read_b64_tr_b16 a[86:87], v234 offset:47104
    ds_read_b64_tr_b16 a[90:91], v8 offset:15360
    v_mfma_f32_16x16x32_bf16 v[96:99], a[24:27], a[32:35], v[96:99]
    v_max_f32 v236, v236, v115
    v_max_f32_e64 v237, v237, -v115
    v_max_f32 v242, v242, v179
    v_max_f32_e64 v243, v243, -v179
    ds_read_b64_tr_b16 a[92:93], v8 offset:14848
    ds_read_b64_tr_b16 a[94:95], v8 offset:15872
    v_mfma_f32_16x16x32_bf16 v[100:103], a[24:27], v[16:19], v[100:103]
    v_permlane32_swap_b32 v236, v237
    s_waitcnt lgkmcnt(14)
    v_mfma_f32_16x16x32_bf16 v[92:95], a[36:39], a[40:43], v[92:95]
    v_permlane32_swap_b32 v242, v243
    v_mfma_f32_16x16x32_bf16 v[96:99], a[36:39], a[44:47], v[96:99]
    v_max_f32 v236, v236, v237
    v_max_f32 v242, v242, v243
    v_mfma_f32_16x16x32_bf16 v[100:103], a[36:39], v[16:19], v[100:103]
    v_mov_b32 v238, v236
    v_mov_b32 v244, v242
    v_mfma_f32_16x16x32_bf16 v[92:95], a[48:51], a[52:55], v[92:95]
    v_permlane16_swap_b32 v236, v238
    v_mfma_f32_16x16x32_bf16 v[96:99], a[48:51], a[56:59], v[96:99]
    v_permlane16_swap_b32 v242, v244
    v_mfma_f32_16x16x32_bf16 v[100:103], a[48:51], v[16:19], v[100:103]
    v_max_f32 v236, v236, v238
    v_max_f32 v242, v242, v244
    v_mfma_f32_16x16x32_bf16 v[92:95], a[60:63], a[64:67], v[92:95]
    v_mov_b32 v238, v236
    v_mov_b32 v244, v242
    s_waitcnt lgkmcnt(12)
    v_mfma_f32_16x16x32_bf16 v[96:99], a[60:63], a[68:71], v[96:99]
    s_lshl_b32 s37, s30, 2
    s_add_u32 s37, s37, s28
    v_mfma_f32_16x16x32_bf16 v[100:103], a[60:63], v[16:19], v[100:103]
    v_permlane32_swap_b32 v236, v238
    s_waitcnt lgkmcnt(8)
    v_mfma_f32_16x16x32_bf16 v[92:95], a[72:75], a[76:79], v[92:95]
    v_permlane32_swap_b32 v242, v244
    s_waitcnt lgkmcnt(6)
    v_mfma_f32_16x16x32_bf16 v[96:99], a[72:75], a[80:83], v[96:99]
    s_lshl_b32 s37, s37, 3
    v_mul_f32 v240, 0x3fb8aa3b, v83
    v_mfma_f32_16x16x32_bf16 v[100:103], a[72:75], v[16:19], v[100:103]
    v_mul_f32 v246, 0x3fb8aa3b, v85
    s_add_u32 s38, s37, s29
    s_waitcnt lgkmcnt(2)
    v_mfma_f32_16x16x32_bf16 v[92:95], a[84:87], a[88:91], v[92:95]
    v_lshrrev_b32 v235, 4, v0
    v_mul_f32_e64 v236, -v236, v240
    s_waitcnt lgkmcnt(0)
    v_mfma_f32_16x16x32_bf16 v[96:99], a[84:87], a[92:95], v[96:99]
    v_mul_f32_e64 v237, -v238, v240
    v_mul_f32_e64 v242, -v242, v246
    v_mfma_f32_16x16x32_bf16 v[100:103], a[84:87], v[16:19], v[100:103]
    v_mul_f32_e64 v243, -v244, v246
    s_lshl_b32 s39, s38, 7
    v_lshlrev_b32 v235, 4, v235
    v_and_b32 v11, 15, v0
    s_add_u32 s39, s39, 0x820000
    v_pk_fma_f32 v[116:117], v[108:109], v[240:241], v[236:237] op_sel:[0,0,0] op_sel_hi:[1,0,0]
    v_pk_fma_f32 v[118:119], v[110:111], v[240:241], v[236:237] op_sel:[0,0,0] op_sel_hi:[1,0,0]
    v_pk_fma_f32 v[120:121], v[112:113], v[240:241], v[236:237] op_sel:[0,0,0] op_sel_hi:[1,0,0]
    v_pk_fma_f32 v[122:123], v[114:115], v[240:241], v[236:237] op_sel:[0,0,0] op_sel_hi:[1,0,0]
    v_pk_fma_f32 v[148:149], v[172:173], v[246:247], v[242:243] op_sel:[0,0,0] op_sel_hi:[1,0,0]
    v_pk_fma_f32 v[150:151], v[174:175], v[246:247], v[242:243] op_sel:[0,0,0] op_sel_hi:[1,0,0]
    v_pk_fma_f32 v[152:153], v[176:177], v[246:247], v[242:243] op_sel:[0,0,0] op_sel_hi:[1,0,0]
    v_pk_fma_f32 v[154:155], v[178:179], v[246:247], v[242:243] op_sel:[0,0,0] op_sel_hi:[1,0,0]
    s_lshl_b32 s38, s38, 11
    v_pk_fma_f32 v[108:109], v[108:109], v[240:241], v[236:237] op_sel:[0,0,1] op_sel_hi:[1,0,1] neg_lo:[1,0,0] neg_hi:[1,0,0]
    v_pk_fma_f32 v[110:111], v[110:111], v[240:241], v[236:237] op_sel:[0,0,1] op_sel_hi:[1,0,1] neg_lo:[1,0,0] neg_hi:[1,0,0]
    v_pk_fma_f32 v[112:113], v[112:113], v[240:241], v[236:237] op_sel:[0,0,1] op_sel_hi:[1,0,1] neg_lo:[1,0,0] neg_hi:[1,0,0]
    v_pk_fma_f32 v[114:115], v[114:115], v[240:241], v[236:237] op_sel:[0,0,1] op_sel_hi:[1,0,1] neg_lo:[1,0,0] neg_hi:[1,0,0]
    v_pk_fma_f32 v[172:173], v[172:173], v[246:247], v[242:243] op_sel:[0,0,1] op_sel_hi:[1,0,1] neg_lo:[1,0,0] neg_hi:[1,0,0]
    v_pk_fma_f32 v[174:175], v[174:175], v[246:247], v[242:243] op_sel:[0,0,1] op_sel_hi:[1,0,1] neg_lo:[1,0,0] neg_hi:[1,0,0]
    v_pk_fma_f32 v[176:177], v[176:177], v[246:247], v[242:243] op_sel:[0,0,1] op_sel_hi:[1,0,1] neg_lo:[1,0,0] neg_hi:[1,0,0]
    v_pk_fma_f32 v[178:179], v[178:179], v[246:247], v[242:243] op_sel:[0,0,1] op_sel_hi:[1,0,1] neg_lo:[1,0,0] neg_hi:[1,0,0]
    v_lshl_add_u32 v235, v11, 6, v235
    v_cmp_gt_u32 vcc, 2, v11
    s_add_u32 s38, s38, 0x600000
    v_mov_b32 v11, 0x80000000
    v_exp_f32 v116, v116
    v_exp_f32 v108, v108
    v_exp_f32 v117, v117
    v_exp_f32 v109, v109
    v_exp_f32 v118, v118
    v_exp_f32 v110, v110
    v_exp_f32 v119, v119
    v_exp_f32 v111, v111
    v_exp_f32 v120, v120
    v_exp_f32 v112, v112
    v_exp_f32 v121, v121
    v_exp_f32 v113, v113
    v_exp_f32 v122, v122
    v_exp_f32 v114, v114
    v_exp_f32 v123, v123
    v_exp_f32 v115, v115
    v_exp_f32 v148, v148
    v_exp_f32 v172, v172
    v_exp_f32 v149, v149
    v_exp_f32 v173, v173
    v_exp_f32 v150, v150
    v_exp_f32 v174, v174
    v_exp_f32 v151, v151
    v_exp_f32 v175, v175
    v_exp_f32 v152, v152
    v_exp_f32 v176, v176
    v_exp_f32 v153, v153
    v_exp_f32 v177, v177
    v_exp_f32 v154, v154
    v_exp_f32 v178, v178
    v_exp_f32 v155, v155
    v_exp_f32 v179, v179
    buffer_store_dwordx4 v[92:95], v1, s[4:7], s38 offen offset:0 sc1
    v_pk_fma_f32 v[180:181], v[48:49], v[86:87], v[180:181] op_sel:[0,0,0] op_sel_hi:[1,0,1]
    v_pk_fma_f32 v[204:205], v[48:49], v[88:89], v[204:205] op_sel:[0,0,0] op_sel_hi:[1,0,1]
    v_pk_fma_f32 v[182:183], v[50:51], v[86:87], v[182:183] op_sel:[0,0,0] op_sel_hi:[1,0,1]
    v_pk_fma_f32 v[206:207], v[50:51], v[88:89], v[206:207] op_sel:[0,0,0] op_sel_hi:[1,0,1]
    v_cndmask_b32 v235, v11, v235, vcc
    buffer_store_dwordx4 v[96:99], v1, s[4:7], s38 offen offset:1024 sc1
    v_lshlrev_b32 v10, 13, v0
    v_pk_fma_f32 v[184:185], v[52:53], v[86:87], v[184:185] op_sel:[0,0,0] op_sel_hi:[1,0,1]
    v_pk_fma_f32 v[186:187], v[54:55], v[86:87], v[186:187] op_sel:[0,0,0] op_sel_hi:[1,0,1]
    v_pk_fma_f32 v[208:209], v[52:53], v[88:89], v[208:209] op_sel:[0,0,0] op_sel_hi:[1,0,1]
    v_pk_fma_f32 v[210:211], v[54:55], v[88:89], v[210:211] op_sel:[0,0,0] op_sel_hi:[1,0,1]
    v_cvt_pk_bf16_f32 v180, v180, v181
    v_cvt_pk_bf16_f32 v204, v204, v205
    s_lshl_b32 s36, s30, 8
    v_cvt_pk_bf16_f32 v181, v182, v183
    v_cvt_pk_bf16_f32 v205, v206, v207
    buffer_store_dwordx4 v[100:103], v235, s[4:7], s39 offen sc1
    v_add_u32 v10, s36, v10
    v_cvt_pk_bf16_f32 v182, v184, v185
    v_cvt_pk_bf16_f32 v183, v186, v187
    v_cvt_pk_bf16_f32 v206, v208, v209
    v_cvt_pk_bf16_f32 v207, v210, v211
    v_cvt_pk_bf16_f32 v140, v116, v117
    v_cvt_pk_bf16_f32 v141, v118, v119
    v_cvt_pk_bf16_f32 v142, v120, v121
    v_cvt_pk_bf16_f32 v143, v122, v123
    v_cvt_pk_bf16_f32 v144, v108, v109
    v_cvt_pk_bf16_f32 v145, v110, v111
    v_cvt_pk_bf16_f32 v146, v112, v113
    v_cvt_pk_bf16_f32 v147, v114, v115
    v_cvt_pk_bf16_f32 v164, v148, v149
    v_cvt_pk_bf16_f32 v165, v150, v151
    v_cvt_pk_bf16_f32 v166, v152, v153
    v_cvt_pk_bf16_f32 v167, v154, v155
    v_cvt_pk_bf16_f32 v168, v172, v173
    v_cvt_pk_bf16_f32 v169, v174, v175
    v_cvt_pk_bf16_f32 v170, v176, v177
    v_cvt_pk_bf16_f32 v171, v178, v179
    s_waitcnt vmcnt(0)
    s_barrier
    s_cmp_lg_u32 s28, 0
    s_cbranch_scc1 Lsig_28
    s_mov_b32 exec_lo, 0xff
    s_mov_b32 exec_hi, 0
    s_mov_b32 s36, 0x80000
    buffer_atomic_add v12, v10, s[4:7], s36 offen sc1
    s_mov_b64 exec, -1
Lsig_28:
    v_mfma_f32_16x16x32_bf16 v[108:111], a[192:195], v[180:183], 0
    v_mul_f32 v240, 0x3fb8aa3b, v87
    v_mul_f32 v246, 0x3fb8aa3b, v89
    v_mfma_f32_16x16x32_bf16 v[220:223], a[192:195], v[204:207], 0
    v_mfma_f32_16x16x32_bf16 v[112:115], a[196:199], v[180:183], 0
    s_nop 3
    v_max3_f32 v236, v108, v109, v110
    v_mfma_f32_16x16x32_bf16 v[224:227], a[196:199], v[204:207], 0
    v_max3_f32 v237, -v108, -v109, -v110
    v_max3_f32 v242, v220, v221, v222
    v_max3_f32 v243, -v220, -v221, -v222
    v_max3_f32 v236, v236, v111, v112
    v_max3_f32 v237, v237, -v111, -v112
    v_max3_f32 v236, v236, v113, v114
    v_max3_f32 v237, v237, -v113, -v114
    s_nop 0
    v_max3_f32 v242, v242, v223, v224
    v_max3_f32 v243, v243, -v223, -v224
    v_max3_f32 v242, v242, v225, v226
    v_max3_f32 v243, v243, -v225, -v226
    v_max_f32 v236, v236, v115
    v_max_f32_e64 v237, v237, -v115
    v_max_f32 v242, v242, v227
    v_max_f32_e64 v243, v243, -v227
    v_permlane32_swap_b32 v236, v237
    s_nop 0
    v_permlane32_swap_b32 v242, v243
    v_max_f32 v236, v236, v237
    v_max_f32 v242, v242, v243
    v_mov_b32 v238, v236
    v_mov_b32 v244, v242
    s_nop 0
    v_permlane16_swap_b32 v236, v238
    v_permlane16_swap_b32 v242, v244
    v_max_f32 v236, v236, v238
    v_max_f32 v242, v242, v244
    v_mov_b32 v238, v236
    v_mov_b32 v244, v242
    s_nop 0
    v_permlane32_swap_b32 v236, v238
    v_permlane32_swap_b32 v242, v244
    v_mul_f32_e64 v236, -v236, v240
    v_mul_f32_e64 v237, -v238, v240
    v_mul_f32_e64 v242, -v242, v246
    v_mul_f32_e64 v243, -v244, v246
    v_pk_fma_f32 v[116:117], v[108:109], v[240:241], v[236:237] op_sel:[0,0,0] op_sel_hi:[1,0,0]
    v_pk_fma_f32 v[118:119], v[110:111], v[240:241], v[236:237] op_sel:[0,0,0] op_sel_hi:[1,0,0]
    v_pk_fma_f32 v[120:121], v[112:113], v[240:241], v[236:237] op_sel:[0,0,0] op_sel_hi:[1,0,0]
    v_pk_fma_f32 v[122:123], v[114:115], v[240:241], v[236:237] op_sel:[0,0,0] op_sel_hi:[1,0,0]
    v_pk_fma_f32 v[196:197], v[220:221], v[246:247], v[242:243] op_sel:[0,0,0] op_sel_hi:[1,0,0]
    v_pk_fma_f32 v[198:199], v[222:223], v[246:247], v[242:243] op_sel:[0,0,0] op_sel_hi:[1,0,0]
    v_pk_fma_f32 v[200:201], v[224:225], v[246:247], v[242:243] op_sel:[0,0,0] op_sel_hi:[1,0,0]
    v_pk_fma_f32 v[202:203], v[226:227], v[246:247], v[242:243] op_sel:[0,0,0] op_sel_hi:[1,0,0]
    v_pk_fma_f32 v[108:109], v[108:109], v[240:241], v[236:237] op_sel:[0,0,1] op_sel_hi:[1,0,1] neg_lo:[1,0,0] neg_hi:[1,0,0]
    v_pk_fma_f32 v[110:111], v[110:111], v[240:241], v[236:237] op_sel:[0,0,1] op_sel_hi:[1,0,1] neg_lo:[1,0,0] neg_hi:[1,0,0]
    v_pk_fma_f32 v[112:113], v[112:113], v[240:241], v[236:237] op_sel:[0,0,1] op_sel_hi:[1,0,1] neg_lo:[1,0,0] neg_hi:[1,0,0]
    v_pk_fma_f32 v[114:115], v[114:115], v[240:241], v[236:237] op_sel:[0,0,1] op_sel_hi:[1,0,1] neg_lo:[1,0,0] neg_hi:[1,0,0]
    v_pk_fma_f32 v[220:221], v[220:221], v[246:247], v[242:243] op_sel:[0,0,1] op_sel_hi:[1,0,1] neg_lo:[1,0,0] neg_hi:[1,0,0]
    v_pk_fma_f32 v[222:223], v[222:223], v[246:247], v[242:243] op_sel:[0,0,1] op_sel_hi:[1,0,1] neg_lo:[1,0,0] neg_hi:[1,0,0]
    v_pk_fma_f32 v[224:225], v[224:225], v[246:247], v[242:243] op_sel:[0,0,1] op_sel_hi:[1,0,1] neg_lo:[1,0,0] neg_hi:[1,0,0]
    v_pk_fma_f32 v[226:227], v[226:227], v[246:247], v[242:243] op_sel:[0,0,1] op_sel_hi:[1,0,1] neg_lo:[1,0,0] neg_hi:[1,0,0]
    v_exp_f32 v116, v116
    v_exp_f32 v108, v108
    v_exp_f32 v117, v117
    v_exp_f32 v109, v109
    v_exp_f32 v118, v118
    v_exp_f32 v110, v110
    v_exp_f32 v119, v119
    v_exp_f32 v111, v111
    v_exp_f32 v120, v120
    v_exp_f32 v112, v112
    v_exp_f32 v121, v121
    v_exp_f32 v113, v113
    v_exp_f32 v122, v122
    v_exp_f32 v114, v114
    v_exp_f32 v123, v123
    v_exp_f32 v115, v115
    v_exp_f32 v196, v196
    v_exp_f32 v220, v220
    v_exp_f32 v197, v197
    v_exp_f32 v221, v221
    v_exp_f32 v198, v198
    v_exp_f32 v222, v222
    v_exp_f32 v199, v199
    v_exp_f32 v223, v223
    v_exp_f32 v200, v200
    v_exp_f32 v224, v224
    v_exp_f32 v201, v201
    v_exp_f32 v225, v225
    v_exp_f32 v202, v202
    v_exp_f32 v226, v226
    v_exp_f32 v203, v203
    v_exp_f32 v227, v227
    v_cvt_pk_bf16_f32 v188, v116, v117
    v_cvt_pk_bf16_f32 v189, v118, v119
    v_cvt_pk_bf16_f32 v190, v120, v121
    v_cvt_pk_bf16_f32 v191, v122, v123
    v_cvt_pk_bf16_f32 v192, v108, v109
    v_cvt_pk_bf16_f32 v193, v110, v111
    v_cvt_pk_bf16_f32 v194, v112, v113
    v_cvt_pk_bf16_f32 v195, v114, v115
    v_cvt_pk_bf16_f32 v212, v196, v197
    v_cvt_pk_bf16_f32 v213, v198, v199
    v_cvt_pk_bf16_f32 v214, v200, v201
    v_cvt_pk_bf16_f32 v215, v202, v203
    v_cvt_pk_bf16_f32 v216, v220, v221
    v_cvt_pk_bf16_f32 v217, v222, v223
    v_cvt_pk_bf16_f32 v218, v224, v225
    v_cvt_pk_bf16_f32 v219, v226, v227
    s_add_u32 s45, s28, 0
    s_add_u32 s44, s45, s34
    s_and_b32 s44, s44, 31
    s_lshl_b32 s44, s44, 12
    s_add_u32 s44, s44, s51
    s_add_u32 s44, s44, 0xc00000
    s_lshl_b32 s45, s45, 12
    s_add_u32 m0, s45, 32768
    s_nop 0
    buffer_load_dwordx4 v1, s[4:7], s44 offen offset:0 sc1 lds
    buffer_load_dwordx4 v1, s[4:7], s44 offen offset:1024 sc1 lds
    buffer_load_dwordx4 v1, s[4:7], s44 offen offset:2048 sc1 lds
    buffer_load_dwordx4 v1, s[4:7], s44 offen offset:3072 sc1 lds
    s_add_u32 s45, s28, 4
    s_add_u32 s44, s45, s34
    s_and_b32 s44, s44, 31
    s_lshl_b32 s44, s44, 12
    s_add_u32 s44, s44, s51
    s_add_u32 s44, s44, 0xc00000
    s_lshl_b32 s45, s45, 12
    s_add_u32 m0, s45, 32768
    s_nop 0
    buffer_load_dwordx4 v1, s[4:7], s44 offen offset:0 sc1 lds
    buffer_load_dwordx4 v1, s[4:7], s44 offen offset:1024 sc1 lds
    buffer_load_dwordx4 v1, s[4:7], s44 offen offset:2048 sc1 lds
    buffer_load_dwordx4 v1, s[4:7], s44 offen offset:3072 sc1 lds
    s_add_u32 s45, s28, 8
    s_add_u32 s44, s45, s34
    s_and_b32 s44, s44, 31
    s_lshl_b32 s44, s44, 12
    s_add_u32 s44, s44, s51
    s_add_u32 s44, s44, 0xc00000
    s_lshl_b32 s45, s45, 12
    s_add_u32 m0, s45, 32768
    s_nop 0
    buffer_load_dwordx4 v1, s[4:7], s44 offen offset:0 sc1 lds
    buffer_load_dwordx4 v1, s[4:7], s44 offen offset:1024 sc1 lds
    buffer_load_dwordx4 v1, s[4:7], s44 offen offset:2048 sc1 lds
    buffer_load_dwordx4 v1, s[4:7], s44 offen offset:3072 sc1 lds
    s_add_u32 s45, s28, 12
    s_add_u32 s44, s45, s34
    s_and_b32 s44, s44, 31
    s_lshl_b32 s44, s44, 12
    s_add_u32 s44, s44, s51
    s_add_u32 s44, s44, 0xc00000
    s_lshl_b32 s45, s45, 12
    s_add_u32 m0, s45, 32768
    s_nop 0
    buffer_load_dwordx4 v1, s[4:7], s44 offen offset:0 sc1 lds
    buffer_load_dwordx4 v1, s[4:7], s44 offen offset:1024 sc1 lds
    buffer_load_dwordx4 v1, s[4:7], s44 offen offset:2048 sc1 lds
    buffer_load_dwordx4 v1, s[4:7], s44 offen offset:3072 sc1 lds
    s_add_u32 s45, s28, 16
    s_add_u32 s44, s45, s34
    s_and_b32 s44, s44, 31
    s_lshl_b32 s44, s44, 12
    s_add_u32 s44, s44, s51
    s_add_u32 s44, s44, 0xc00000
    s_lshl_b32 s45, s45, 12
    s_add_u32 m0, s45, 32768
    s_nop 0
    buffer_load_dwordx4 v1, s[4:7], s44 offen offset:0 sc1 lds
    buffer_load_dwordx4 v1, s[4:7], s44 offen offset:1024 sc1 lds
    buffer_load_dwordx4 v1, s[4:7], s44 offen offset:2048 sc1 lds
    buffer_load_dwordx4 v1, s[4:7], s44 offen offset:3072 sc1 lds
    s_add_u32 s45, s28, 20
    s_add_u32 s44, s45, s34
    s_and_b32 s44, s44, 31
    s_lshl_b32 s44, s44, 12
    s_add_u32 s44, s44, s51
    s_add_u32 s44, s44, 0xc00000
    s_lshl_b32 s45, s45, 12
    s_add_u32 m0, s45, 32768
    s_nop 0
    buffer_load_dwordx4 v1, s[4:7], s44 offen offset:0 sc1 lds
    buffer_load_dwordx4 v1, s[4:7], s44 offen offset:1024 sc1 lds
    buffer_load_dwordx4 v1, s[4:7], s44 offen offset:2048 sc1 lds
    buffer_load_dwordx4 v1, s[4:7], s44 offen offset:3072 sc1 lds
    s_add_u32 s45, s28, 24
    s_add_u32 s44, s45, s34
    s_and_b32 s44, s44, 31
    s_lshl_b32 s44, s44, 12
    s_add_u32 s44, s44, s51
    s_add_u32 s44, s44, 0xc00000
    s_lshl_b32 s45, s45, 12
    s_add_u32 m0, s45, 32768
    s_nop 0
    buffer_load_dwordx4 v1, s[4:7], s44 offen offset:0 sc1 lds
    buffer_load_dwordx4 v1, s[4:7], s44 offen offset:1024 sc1 lds
    buffer_load_dwordx4 v1, s[4:7], s44 offen offset:2048 sc1 lds
    buffer_load_dwordx4 v1, s[4:7], s44 offen offset:3072 sc1 lds
    s_add_u32 s45, s28, 28
    s_add_u32 s44, s45, s34
    s_and_b32 s44, s44, 31
    s_lshl_b32 s44, s44, 12
    s_add_u32 s44, s44, s51
    s_add_u32 s44, s44, 0xc00000
    s_lshl_b32 s45, s45, 12
    s_add_u32 m0, s45, 32768
    s_nop 0
    buffer_load_dwordx4 v1, s[4:7], s44 offen offset:0 sc1 lds
    buffer_load_dwordx4 v1, s[4:7], s44 offen offset:1024 sc1 lds
    buffer_load_dwordx4 v1, s[4:7], s44 offen offset:2048 sc1 lds
    buffer_load_dwordx4 v1, s[4:7], s44 offen offset:3072 sc1 lds
    s_lshl_b32 s36, s29, 5
    s_add_u32 s36, s36, s30
    s_lshl_b32 s36, s36, 8
    v_mov_b32 v10, s36
    s_cmp_lg_u32 s28, 0
    s_cbranch_scc1 Lpe_30
    s_mov_b32 s36, 0x80000
    s_mov_b32 s37, 0
Lpoll_29:
    buffer_load_dword v11, v10, s[4:7], s36 offen sc1
    s_add_u32 s37, s37, 1
    s_waitcnt vmcnt(0)
    v_cmp_gt_u32 vcc, 8, v11
    s_cbranch_vccz Lpe_30
    s_cmp_lt_u32 s37, 0x100000
    s_cbranch_scc1 Lpoll_29
Lpe_30:
    s_barrier
    s_lshl_b32 s37, s30, 2
    v_and_b32 v234, 7, v0
    s_add_u32 s37, s37, s28
    v_lshlrev_b32 v234, 7, v234
    v_lshrrev_b32 v235, 4, v0
    s_lshl_b32 s39, s37, 10
    s_add_u32 s39, s39, 0x820000
    v_lshl_add_u32 v234, v235, 4, v234
    s_lshl_b32 s38, s37, 14
    buffer_load_dwordx4 v[124:127], v234, s[4:7], s39 offen sc1
    s_add_u32 s38, s38, 0x600000
    buffer_load_dwordx4 v[92:95], v1, s[4:7], s38 offen offset:0 sc1
    buffer_load_dwordx4 v[96:99], v1, s[4:7], s38 offen offset:1024 sc1
    buffer_load_dwordx4 v[100:103], v1, s[4:7], s38 offen offset:2048 sc1
    buffer_load_dwordx4 v[104:107], v1, s[4:7], s38 offen offset:3072 sc1
    s_add_u32 s38, s38, 4096
    buffer_load_dwordx4 v[108:111], v1, s[4:7], s38 offen offset:0 sc1
    buffer_load_dwordx4 v[112:115], v1, s[4:7], s38 offen offset:1024 sc1
    buffer_load_dwordx4 v[116:119], v1, s[4:7], s38 offen offset:2048 sc1
    buffer_load_dwordx4 v[120:123], v1, s[4:7], s38 offen offset:3072 sc1
    s_add_u32 s38, s38, 4096
    buffer_load_dwordx4 v[148:151], v1, s[4:7], s38 offen offset:0 sc1
    buffer_load_dwordx4 v[152:155], v1, s[4:7], s38 offen offset:1024 sc1
    buffer_load_dwordx4 v[172:175], v1, s[4:7], s38 offen offset:2048 sc1
    buffer_load_dwordx4 v[176:179], v1, s[4:7], s38 offen offset:3072 sc1
    s_add_u32 s38, s38, 4096
    buffer_load_dwordx4 v[196:199], v1, s[4:7], s38 offen offset:0 sc1
    buffer_load_dwordx4 v[200:203], v1, s[4:7], s38 offen offset:1024 sc1
    buffer_load_dwordx4 v[220:223], v1, s[4:7], s38 offen offset:2048 sc1
    buffer_load_dwordx4 v[224:227], v1, s[4:7], s38 offen offset:3072 sc1
    s_lshr_b32 s36, s28, 1
    s_and_b32 s37, s28, 1
    s_mul_i32 s36, s36, 3072
    s_lshl_b32 s37, s37, 3
    s_add_u32 s36, s36, s37
    v_add_u32 v236, s36, v1
    s_waitcnt vmcnt(16)
    v_add_f32_dpp v124, v124, v124 row_ror:4 row_mask:0xf bank_mask:0xf
    v_add_f32_dpp v125, v125, v125 row_ror:4 row_mask:0xf bank_mask:0xf
    v_add_f32_dpp v126, v126, v126 row_ror:4 row_mask:0xf bank_mask:0xf
    v_add_f32_dpp v127, v127, v127 row_ror:4 row_mask:0xf bank_mask:0xf
    v_add_f32_dpp v124, v124, v124 row_ror:2 row_mask:0xf bank_mask:0xf
    v_add_f32_dpp v125, v125, v125 row_ror:2 row_mask:0xf bank_mask:0xf
    v_add_f32_dpp v126, v126, v126 row_ror:2 row_mask:0xf bank_mask:0xf
    s_waitcnt vmcnt(13)
    v_pk_add_f32 v[92:93], v[92:93], v[100:101]
    v_pk_add_f32 v[94:95], v[94:95], v[102:103]
    s_waitcnt vmcnt(12)
    v_pk_add_f32 v[96:97], v[96:97], v[104:105]
    v_pk_add_f32 v[98:99], v[98:99], v[106:107]
    v_add_f32_dpp v127, v127, v127 row_ror:2 row_mask:0xf bank_mask:0xf
    s_waitcnt vmcnt(11)
    v_pk_add_f32 v[92:93], v[92:93], v[108:109]
    v_pk_add_f32 v[94:95], v[94:95], v[110:111]
    s_waitcnt vmcnt(10)
    v_pk_add_f32 v[96:97], v[96:97], v[112:113]
    v_pk_add_f32 v[98:99], v[98:99], v[114:115]
    s_waitcnt vmcnt(9)
    v_pk_add_f32 v[92:93], v[92:93], v[116:117]
    v_pk_add_f32 v[94:95], v[94:95], v[118:119]
    s_waitcnt vmcnt(8)
    v_pk_add_f32 v[96:97], v[96:97], v[120:121]
    v_pk_add_f32 v[98:99], v[98:99], v[122:123]
    v_add_f32_dpp v124, v124, v124 row_ror:1 row_mask:0xf bank_mask:0xf
    s_waitcnt vmcnt(7)
    v_pk_add_f32 v[92:93], v[92:93], v[148:149]
    v_pk_add_f32 v[94:95], v[94:95], v[150:151]
    s_waitcnt vmcnt(6)
    v_pk_add_f32 v[96:97], v[96:97], v[152:153]
    v_pk_add_f32 v[98:99], v[98:99], v[154:155]
    s_waitcnt vmcnt(5)
    v_pk_add_f32 v[92:93], v[92:93], v[172:173]
    v_add_f32_dpp v125, v125, v125 row_ror:1 row_mask:0xf bank_mask:0xf
    v_pk_add_f32 v[94:95], v[94:95], v[174:175]
    v_add_f32_dpp v126, v126, v126 row_ror:1 row_mask:0xf bank_mask:0xf
    v_add_f32_dpp v127, v127, v127 row_ror:1 row_mask:0xf bank_mask:0xf
    s_waitcnt vmcnt(4)
    v_pk_add_f32 v[96:97], v[96:97], v[176:177]
    v_pk_add_f32 v[98:99], v[98:99], v[178:179]
    s_waitcnt vmcnt(3)
    v_pk_add_f32 v[92:93], v[92:93], v[196:197]
    v_pk_add_f32 v[94:95], v[94:95], v[198:199]
    v_cvt_pk_bf16_f32 v124, v124, v125
    s_waitcnt vmcnt(2)
    v_pk_add_f32 v[96:97], v[96:97], v[200:201]
    v_pk_add_f32 v[98:99], v[98:99], v[202:203]
    v_cvt_pk_bf16_f32 v125, v126, v127
    s_waitcnt vmcnt(1)
    v_pk_add_f32 v[92:93], v[92:93], v[220:221]
    v_pk_add_f32 v[94:95], v[94:95], v[222:223]
    s_waitcnt vmcnt(0)
    v_pk_add_f32 v[96:97], v[96:97], v[224:225]
    v_pk_add_f32 v[98:99], v[98:99], v[226:227]
    v_cndmask_b32 v124, 0, v124, s[56:57]
    v_cndmask_b32 v125, 0, v125, s[56:57]
    v_cvt_pk_bf16_f32 v92, v92, v93
    v_cvt_pk_bf16_f32 v93, v94, v95
    v_cvt_pk_bf16_f32 v94, v96, v97
    v_cvt_pk_bf16_f32 v95, v98, v99
    v_cndmask_b32 v124, v124, v16, s[58:59]
    v_cndmask_b32 v125, v125, v16, s[58:59]
    ds_write_b64 v236, v[92:93] offset:0
    ds_write_b64 v236, v[94:95] offset:1024
    ds_write_b64 v236, v[124:125] offset:2048
    s_waitcnt lgkmcnt(0)
    s_barrier
    ds_read_b128 a[8:11], v1 offset:2048
    ds_read_b128 a[20:23], v1 offset:5120
    ds_read_b128 a[0:3], v1 offset:0
    ds_read_b128 a[4:7], v1 offset:1024
    ds_read_b128 a[12:15], v1 offset:3072
    ds_read_b128 a[16:19], v1 offset:4096
    s_lshl_b32 s35, s30, 12
    s_add_u32 s35, s35, 0x3600000
    s_waitcnt lgkmcnt(5)
    v_mfma_f32_16x16x32_bf16 v[92:95], a[8:11], v[140:143], 0
    v_mfma_f32_16x16x32_bf16 v[100:103], a[8:11], v[164:167], 0
    s_waitcnt lgkmcnt(4)
    v_mfma_f32_16x16x32_bf16 v[96:99], a[20:23], v[144:147], 0
    s_nop 4
    v_rcp_f32 v94, v93
    v_mfma_f32_16x16x32_bf16 v[108:111], a[8:11], v[188:191], 0
    v_rcp_f32 v102, v101
    v_mfma_f32_16x16x32_bf16 v[104:107], a[20:23], v[168:171], 0
    v_rcp_f32 v95, v97
    v_mfma_f32_16x16x32_bf16 v[116:119], a[8:11], v[212:215], 0
    v_mul_f32 v92, v92, v94
    s_nop 2
    v_rcp_f32 v110, v109
    v_mfma_f32_16x16x32_bf16 v[112:115], a[20:23], v[192:195], 0
    v_rcp_f32 v103, v105
    v_mfma_f32_16x16x32_bf16 v[120:123], a[20:23], v[216:219], 0
    v_rcp_f32 v118, v117
    v_mul_f32 v100, v100, v102
    v_fmac_f32 v92, v96, v95
    v_mul_f32 v108, v108, v110
    s_nop 1
    v_rcp_f32 v111, v113
    s_waitcnt lgkmcnt(3)
    v_mfma_f32_16x16x32_bf16 v[132:135], a[0:3], v[140:143], 0
    v_rcp_f32 v119, v121
    v_fmac_f32 v100, v104, v103
    v_add_f32 v92, 0x358637bd, v92
    v_mul_f32 v116, v116, v118
    v_mfma_f32_16x16x32_bf16 v[156:159], a[0:3], v[164:167], 0
    v_fmac_f32 v108, v112, v111
    v_add_f32 v100, 0x358637bd, v100
    s_waitcnt lgkmcnt(2)
    v_mfma_f32_16x16x32_bf16 v[136:139], a[4:7], v[140:143], 0
    v_rcp_f32 v92, v92
    s_waitcnt lgkmcnt(1)
    v_mfma_f32_16x16x32_bf16 v[148:151], a[12:15], v[144:147], 0
    v_fmac_f32 v116, v120, v119
    v_add_f32 v108, 0x358637bd, v108
    v_mfma_f32_16x16x32_bf16 v[180:183], a[0:3], v[188:191], 0
    v_rcp_f32 v100, v100
    v_mfma_f32_16x16x32_bf16 v[160:163], a[4:7], v[164:167], 0
    v_add_f32 v116, 0x358637bd, v116
    v_rcp_f32 v108, v108
    v_mfma_f32_16x16x32_bf16 v[172:175], a[12:15], v[168:171], 0
    v_pk_mul_f32 v[94:95], v[94:95], v[92:93] op_sel:[0,0] op_sel_hi:[1,0]
    v_rcp_f32 v116, v116
    s_waitcnt lgkmcnt(0)
    v_mfma_f32_16x16x32_bf16 v[152:155], a[16:19], v[144:147], 0
    v_pk_mul_f32 v[102:103], v[102:103], v[100:101] op_sel:[0,0] op_sel_hi:[1,0]
    v_pk_mul_f32 v[132:133], v[132:133], v[94:95] op_sel:[0,0] op_sel_hi:[1,0]
    s_nop 0
    v_mfma_f32_16x16x32_bf16 v[204:207], a[0:3], v[212:215], 0
    v_pk_mul_f32 v[134:135], v[134:135], v[94:95] op_sel:[0,0] op_sel_hi:[1,0]
    v_pk_mul_f32 v[110:111], v[110:111], v[108:109] op_sel:[0,0] op_sel_hi:[1,0]
    s_nop 0
    v_mfma_f32_16x16x32_bf16 v[184:187], a[4:7], v[188:191], 0
    v_pk_mul_f32 v[156:157], v[156:157], v[102:103] op_sel:[0,0] op_sel_hi:[1,0]
    v_pk_mul_f32 v[136:137], v[136:137], v[94:95] op_sel:[0,0] op_sel_hi:[1,0]
    s_nop 0
    v_mfma_f32_16x16x32_bf16 v[196:199], a[12:15], v[192:195], 0
    v_pk_mul_f32 v[138:139], v[138:139], v[94:95] op_sel:[0,0] op_sel_hi:[1,0]
    v_pk_fma_f32 v[132:133], v[148:149], v[94:95], v[132:133] op_sel:[0,1,0] op_sel_hi:[1,1,1]
    s_nop 0
    v_mfma_f32_16x16x32_bf16 v[176:179], a[16:19], v[168:171], 0
    v_pk_mul_f32 v[158:159], v[158:159], v[102:103] op_sel:[0,0] op_sel_hi:[1,0]
    v_pk_mul_f32 v[118:119], v[118:119], v[116:117] op_sel:[0,0] op_sel_hi:[1,0]
    v_cvt_pk_bf16_f32 v132, v132, v133
    v_mfma_f32_16x16x32_bf16 v[208:211], a[4:7], v[212:215], 0
    v_pk_fma_f32 v[134:135], v[150:151], v[94:95], v[134:135] op_sel:[0,1,0] op_sel_hi:[1,1,1]
    v_pk_mul_f32 v[180:181], v[180:181], v[110:111] op_sel:[0,0] op_sel_hi:[1,0]
    v_cvt_pk_bf16_f32 v133, v134, v135
    v_mfma_f32_16x16x32_bf16 v[220:223], a[12:15], v[216:219], 0
    v_pk_mul_f32 v[160:161], v[160:161], v[102:103] op_sel:[0,0] op_sel_hi:[1,0]
    v_pk_mul_f32 v[162:163], v[162:163], v[102:103] op_sel:[0,0] op_sel_hi:[1,0]
    s_nop 0
    v_mfma_f32_16x16x32_bf16 v[200:203], a[16:19], v[192:195], 0
    v_pk_fma_f32 v[156:157], v[172:173], v[102:103], v[156:157] op_sel:[0,1,0] op_sel_hi:[1,1,1]
    v_pk_fma_f32 v[136:137], v[152:153], v[94:95], v[136:137] op_sel:[0,1,0] op_sel_hi:[1,1,1]
    v_cvt_pk_bf16_f32 v156, v156, v157
    v_mfma_f32_16x16x32_bf16 v[224:227], a[16:19], v[216:219], 0
    v_pk_fma_f32 v[138:139], v[154:155], v[94:95], v[138:139] op_sel:[0,1,0] op_sel_hi:[1,1,1]
    v_pk_mul_f32 v[182:183], v[182:183], v[110:111] op_sel:[0,0] op_sel_hi:[1,0]
    v_pk_fma_f32 v[158:159], v[174:175], v[102:103], v[158:159] op_sel:[0,1,0] op_sel_hi:[1,1,1]
    v_pk_mul_f32 v[204:205], v[204:205], v[118:119] op_sel:[0,0] op_sel_hi:[1,0]
    v_pk_mul_f32 v[184:185], v[184:185], v[110:111] op_sel:[0,0] op_sel_hi:[1,0]
    v_pk_mul_f32 v[186:187], v[186:187], v[110:111] op_sel:[0,0] op_sel_hi:[1,0]
    v_pk_fma_f32 v[180:181], v[196:197], v[110:111], v[180:181] op_sel:[0,1,0] op_sel_hi:[1,1,1]
    v_pk_fma_f32 v[160:161], v[176:177], v[102:103], v[160:161] op_sel:[0,1,0] op_sel_hi:[1,1,1]
    v_pk_fma_f32 v[162:163], v[178:179], v[102:103], v[162:163] op_sel:[0,1,0] op_sel_hi:[1,1,1]
    v_pk_mul_f32 v[206:207], v[206:207], v[118:119] op_sel:[0,0] op_sel_hi:[1,0]
    v_cvt_pk_bf16_f32 v134, v136, v137
    v_cvt_pk_bf16_f32 v135, v138, v139
    v_pk_fma_f32 v[182:183], v[198:199], v[110:111], v[182:183] op_sel:[0,1,0] op_sel_hi:[1,1,1]
    v_pk_mul_f32 v[208:209], v[208:209], v[118:119] op_sel:[0,0] op_sel_hi:[1,0]
    v_pk_mul_f32 v[210:211], v[210:211], v[118:119] op_sel:[0,0] op_sel_hi:[1,0]
    v_cvt_pk_bf16_f32 v157, v158, v159
    v_pk_fma_f32 v[204:205], v[220:221], v[118:119], v[204:205] op_sel:[0,1,0] op_sel_hi:[1,1,1]
    v_pk_fma_f32 v[184:185], v[200:201], v[110:111], v[184:185] op_sel:[0,1,0] op_sel_hi:[1,1,1]
    v_pk_fma_f32 v[186:187], v[202:203], v[110:111], v[186:187] op_sel:[0,1,0] op_sel_hi:[1,1,1]
    v_cvt_pk_bf16_f32 v180, v180, v181
    v_cvt_pk_bf16_f32 v158, v160, v161
    v_cvt_pk_bf16_f32 v159, v162, v163
    v_pk_fma_f32 v[206:207], v[222:223], v[118:119], v[206:207] op_sel:[0,1,0] op_sel_hi:[1,1,1]
    buffer_store_dwordx4 v[132:135], v2, s[4:7], s35 offen offset:0 sc1
    v_cvt_pk_bf16_f32 v181, v182, v183
    v_pk_fma_f32 v[208:209], v[224:225], v[118:119], v[208:209] op_sel:[0,1,0] op_sel_hi:[1,1,1]
    v_pk_fma_f32 v[210:211], v[226:227], v[118:119], v[210:211] op_sel:[0,1,0] op_sel_hi:[1,1,1]
    v_cvt_pk_bf16_f32 v204, v204, v205
    v_cvt_pk_bf16_f32 v182, v184, v185
    v_cvt_pk_bf16_f32 v183, v186, v187
    buffer_store_dwordx4 v[156:159], v2, s[4:7], s35 offen offset:1024 sc1
    v_cvt_pk_bf16_f32 v205, v206, v207
    v_cvt_pk_bf16_f32 v206, v208, v209
    v_cvt_pk_bf16_f32 v207, v210, v211
    buffer_store_dwordx4 v[180:183], v2, s[4:7], s35 offen offset:2048 sc1
    buffer_store_dwordx4 v[204:207], v2, s[4:7], s35 offen offset:3072 sc1
    s_lshl_b32 s36, s29, 13
    v_lshl_add_u32 v10, v0, 8, s36
    s_waitcnt vmcnt(0)
    s_barrier
    s_cmp_lg_u32 s28, 0
    s_cbranch_scc1 Lsig_31
    s_mov_b32 exec_lo, 0xffffffff
    s_mov_b32 exec_hi, 0
    s_mov_b32 s36, 0x30000
    buffer_atomic_add v12, v10, s[4:7], s36 offen sc1
    s_mov_b64 exec, -1
Lsig_31:
    s_add_u32 s40, s4, 0x3600000
    s_addc_u32 s41, s5, 0
    s_lshl_b32 s35, s34, 12
    v_add_u32 v5, 32768, v1
    v_add_u32 v6, 98304, v1
    v_lshlrev_b32 v132, 16, v32
    v_and_b32 v133, 0xffff0000, v32
    v_lshlrev_b32 v134, 16, v33
    v_and_b32 v135, 0xffff0000, v33
    v_lshlrev_b32 v136, 16, v34
    v_and_b32 v137, 0xffff0000, v34
    v_lshlrev_b32 v138, 16, v35
    v_and_b32 v139, 0xffff0000, v35
    v_lshlrev_b32 v140, 16, v36
    v_and_b32 v141, 0xffff0000, v36
    v_lshlrev_b32 v142, 16, v37
    v_and_b32 v143, 0xffff0000, v37
    v_lshlrev_b32 v144, 16, v38
    v_and_b32 v145, 0xffff0000, v38
    v_lshlrev_b32 v146, 16, v39
    v_and_b32 v147, 0xffff0000, v39
    v_lshlrev_b32 v148, 16, v40
    v_and_b32 v149, 0xffff0000, v40
    v_lshlrev_b32 v150, 16, v41
    v_and_b32 v151, 0xffff0000, v41
    v_lshlrev_b32 v152, 16, v42
    v_and_b32 v153, 0xffff0000, v42
    v_lshlrev_b32 v154, 16, v43
    v_and_b32 v155, 0xffff0000, v43
    v_lshlrev_b32 v156, 16, v44
    v_and_b32 v157, 0xffff0000, v44
    v_lshlrev_b32 v158, 16, v45
    v_and_b32 v159, 0xffff0000, v45
    v_lshlrev_b32 v160, 16, v46
    v_and_b32 v161, 0xffff0000, v46
    v_lshlrev_b32 v162, 16, v47
    v_and_b32 v163, 0xffff0000, v47
    s_lshl_b32 s36, s31, 4
    s_add_u32 s36, s36, s32
    s_lshl_b32 s36, s36, 8
    v_mov_b32 v10, s36
    s_cmp_lg_u32 s28, 0
    s_cbranch_scc1 Lpe_33
    s_mov_b32 s36, 0x30000
    s_mov_b32 s37, 0
Lpoll_32:
    buffer_load_dword v11, v10, s[4:7], s36 offen sc1
    s_add_u32 s37, s37, 1
    s_waitcnt vmcnt(0)
    v_cmp_gt_u32 vcc, 32, v11
    s_cbranch_vccz Lpe_33
    s_cmp_lt_u32 s37, 0x100000
    s_cbranch_scc1 Lpoll_32
Lpe_33:
    s_waitcnt vmcnt(0)
    s_barrier
    buffer_load_dwordx4 a[0:3], v4, s[40:43], s35 offen offset:0 sc1
    buffer_load_dwordx4 a[4:7], v4, s[40:43], s35 offen offset:1024 sc1
    s_add_u32 s35, s35, 4096
    s_and_b32 s35, s35, 0x1ffff
    buffer_load_dwordx4 a[8:11], v4, s[40:43], s35 offen offset:0 sc1
    buffer_load_dwordx4 a[12:15], v4, s[40:43], s35 offen offset:1024 sc1
    s_add_u32 s35, s35, 4096
    s_and_b32 s35, s35, 0x1ffff
    buffer_load_dwordx4 a[16:19], v4, s[40:43], s35 offen offset:0 sc1
    buffer_load_dwordx4 a[20:23], v4, s[40:43], s35 offen offset:1024 sc1
    s_add_u32 s35, s35, 4096
    s_and_b32 s35, s35, 0x1ffff
    buffer_load_dwordx4 a[24:27], v4, s[40:43], s35 offen offset:0 sc1
    buffer_load_dwordx4 a[28:31], v4, s[40:43], s35 offen offset:1024 sc1
    s_add_u32 s35, s35, 4096
    s_and_b32 s35, s35, 0x1ffff
    buffer_load_dwordx4 a[32:35], v4, s[40:43], s35 offen offset:0 sc1
    buffer_load_dwordx4 a[36:39], v4, s[40:43], s35 offen offset:1024 sc1
    s_add_u32 s35, s35, 4096
    s_and_b32 s35, s35, 0x1ffff
    ds_read_b128 a[80:83], v5 offset:0
    ds_read_b128 a[84:87], v5 offset:1024
    ds_read_b128 a[88:91], v5 offset:2048
    ds_read_b128 a[92:95], v5 offset:3072
    s_waitcnt vmcnt(8) lgkmcnt(0)
    v_mfma_f32_16x16x32_bf16 v[132:135], a[80:83], a[0:3], v[132:135]
    ds_read_b128 a[96:99], v5 offset:4096
    v_mfma_f32_16x16x32_bf16 v[148:151], a[80:83], a[4:7], v[148:151]
    ds_read_b128 a[100:103], v5 offset:5120
    v_mfma_f32_16x16x32_bf16 v[136:139], a[84:87], a[0:3], v[136:139]
    ds_read_b128 a[104:107], v5 offset:6144
    v_mfma_f32_16x16x32_bf16 v[152:155], a[84:87], a[4:7], v[152:155]
    ds_read_b128 a[108:111], v5 offset:7168
    v_mfma_f32_16x16x32_bf16 v[140:143], a[88:91], a[0:3], v[140:143]
    buffer_load_dwordx4 a[40:43], v4, s[40:43], s35 offen offset:0 sc1
    v_mfma_f32_16x16x32_bf16 v[156:159], a[88:91], a[4:7], v[156:159]
    v_mfma_f32_16x16x32_bf16 v[144:147], a[92:95], a[0:3], v[144:147]
    buffer_load_dwordx4 a[44:47], v4, s[40:43], s35 offen offset:1024 sc1
    s_add_u32 s35, s35, 4096
    s_and_b32 s35, s35, 0x1ffff
    v_mfma_f32_16x16x32_bf16 v[160:163], a[92:95], a[4:7], v[160:163]
    s_waitcnt vmcnt(8) lgkmcnt(0)
    v_mfma_f32_16x16x32_bf16 v[132:135], a[96:99], a[8:11], v[132:135]
    ds_read_b128 a[80:83], v5 offset:8192
    v_mfma_f32_16x16x32_bf16 v[148:151], a[96:99], a[12:15], v[148:151]
    ds_read_b128 a[84:87], v5 offset:9216
    v_mfma_f32_16x16x32_bf16 v[136:139], a[100:103], a[8:11], v[136:139]
    ds_read_b128 a[88:91], v5 offset:10240
    v_mfma_f32_16x16x32_bf16 v[152:155], a[100:103], a[12:15], v[152:155]
    ds_read_b128 a[92:95], v5 offset:11264
    v_mfma_f32_16x16x32_bf16 v[140:143], a[104:107], a[8:11], v[140:143]
    buffer_load_dwordx4 a[0:3], v4, s[40:43], s35 offen offset:0 sc1
    v_mfma_f32_16x16x32_bf16 v[156:159], a[104:107], a[12:15], v[156:159]
    v_mfma_f32_16x16x32_bf16 v[144:147], a[108:111], a[8:11], v[144:147]
    buffer_load_dwordx4 a[4:7], v4, s[40:43], s35 offen offset:1024 sc1
    s_add_u32 s35, s35, 4096
    s_and_b32 s35, s35, 0x1ffff
    v_mfma_f32_16x16x32_bf16 v[160:163], a[108:111], a[12:15], v[160:163]
    s_waitcnt vmcnt(8) lgkmcnt(0)
    v_mfma_f32_16x16x32_bf16 v[132:135], a[80:83], a[16:19], v[132:135]
    ds_read_b128 a[96:99], v5 offset:12288
    v_mfma_f32_16x16x32_bf16 v[148:151], a[80:83], a[20:23], v[148:151]
    ds_read_b128 a[100:103], v5 offset:13312
    v_mfma_f32_16x16x32_bf16 v[136:139], a[84:87], a[16:19], v[136:139]
    ds_read_b128 a[104:107], v5 offset:14336
    v_mfma_f32_16x16x32_bf16 v[152:155], a[84:87], a[20:23], v[152:155]
    ds_read_b128 a[108:111], v5 offset:15360
    v_mfma_f32_16x16x32_bf16 v[140:143], a[88:91], a[16:19], v[140:143]
    buffer_load_dwordx4 a[8:11], v4, s[40:43], s35 offen offset:0 sc1
    v_mfma_f32_16x16x32_bf16 v[156:159], a[88:91], a[20:23], v[156:159]
    v_mfma_f32_16x16x32_bf16 v[144:147], a[92:95], a[16:19], v[144:147]
    buffer_load_dwordx4 a[12:15], v4, s[40:43], s35 offen offset:1024 sc1
    s_add_u32 s35, s35, 4096
    s_and_b32 s35, s35, 0x1ffff
    v_mfma_f32_16x16x32_bf16 v[160:163], a[92:95], a[20:23], v[160:163]
    s_waitcnt vmcnt(8) lgkmcnt(0)
    v_mfma_f32_16x16x32_bf16 v[132:135], a[96:99], a[24:27], v[132:135]
    ds_read_b128 a[80:83], v5 offset:16384
    v_mfma_f32_16x16x32_bf16 v[148:151], a[96:99], a[28:31], v[148:151]
    ds_read_b128 a[84:87], v5 offset:17408
    v_mfma_f32_16x16x32_bf16 v[136:139], a[100:103], a[24:27], v[136:139]
    ds_read_b128 a[88:91], v5 offset:18432
    v_mfma_f32_16x16x32_bf16 v[152:155], a[100:103], a[28:31], v[152:155]
    ds_read_b128 a[92:95], v5 offset:19456
    v_mfma_f32_16x16x32_bf16 v[140:143], a[104:107], a[24:27], v[140:143]
    buffer_load_dwordx4 a[16:19], v4, s[40:43], s35 offen offset:0 sc1
    v_mfma_f32_16x16x32_bf16 v[156:159], a[104:107], a[28:31], v[156:159]
    v_mfma_f32_16x16x32_bf16 v[144:147], a[108:111], a[24:27], v[144:147]
    buffer_load_dwordx4 a[20:23], v4, s[40:43], s35 offen offset:1024 sc1
    s_add_u32 s35, s35, 4096
    s_and_b32 s35, s35, 0x1ffff
    v_mfma_f32_16x16x32_bf16 v[160:163], a[108:111], a[28:31], v[160:163]
    s_waitcnt vmcnt(8) lgkmcnt(0)
    v_mfma_f32_16x16x32_bf16 v[132:135], a[80:83], a[32:35], v[132:135]
    ds_read_b128 a[96:99], v5 offset:20480
    v_mfma_f32_16x16x32_bf16 v[148:151], a[80:83], a[36:39], v[148:151]
    ds_read_b128 a[100:103], v5 offset:21504
    v_mfma_f32_16x16x32_bf16 v[136:139], a[84:87], a[32:35], v[136:139]
    ds_read_b128 a[104:107], v5 offset:22528
    v_mfma_f32_16x16x32_bf16 v[152:155], a[84:87], a[36:39], v[152:155]
    ds_read_b128 a[108:111], v5 offset:23552
    v_mfma_f32_16x16x32_bf16 v[140:143], a[88:91], a[32:35], v[140:143]
    buffer_load_dwordx4 a[24:27], v4, s[40:43], s35 offen offset:0 sc1
    v_mfma_f32_16x16x32_bf16 v[156:159], a[88:91], a[36:39], v[156:159]
    v_mfma_f32_16x16x32_bf16 v[144:147], a[92:95], a[32:35], v[144:147]
    buffer_load_dwordx4 a[28:31], v4, s[40:43], s35 offen offset:1024 sc1
    s_add_u32 s35, s35, 4096
    s_and_b32 s35, s35, 0x1ffff
    v_mfma_f32_16x16x32_bf16 v[160:163], a[92:95], a[36:39], v[160:163]
    s_waitcnt vmcnt(8) lgkmcnt(0)
    v_mfma_f32_16x16x32_bf16 v[132:135], a[96:99], a[40:43], v[132:135]
    ds_read_b128 a[80:83], v5 offset:24576
    v_mfma_f32_16x16x32_bf16 v[148:151], a[96:99], a[44:47], v[148:151]
    ds_read_b128 a[84:87], v5 offset:25600
    v_mfma_f32_16x16x32_bf16 v[136:139], a[100:103], a[40:43], v[136:139]
    ds_read_b128 a[88:91], v5 offset:26624
    v_mfma_f32_16x16x32_bf16 v[152:155], a[100:103], a[44:47], v[152:155]
    ds_read_b128 a[92:95], v5 offset:27648
    v_mfma_f32_16x16x32_bf16 v[140:143], a[104:107], a[40:43], v[140:143]
    buffer_load_dwordx4 a[32:35], v4, s[40:43], s35 offen offset:0 sc1
    v_mfma_f32_16x16x32_bf16 v[156:159], a[104:107], a[44:47], v[156:159]
    v_mfma_f32_16x16x32_bf16 v[144:147], a[108:111], a[40:43], v[144:147]
    buffer_load_dwordx4 a[36:39], v4, s[40:43], s35 offen offset:1024 sc1
    s_add_u32 s35, s35, 4096
    s_and_b32 s35, s35, 0x1ffff
    v_mfma_f32_16x16x32_bf16 v[160:163], a[108:111], a[44:47], v[160:163]
    s_waitcnt vmcnt(8) lgkmcnt(0)
    v_mfma_f32_16x16x32_bf16 v[132:135], a[80:83], a[0:3], v[132:135]
    ds_read_b128 a[96:99], v5 offset:28672
    v_mfma_f32_16x16x32_bf16 v[148:151], a[80:83], a[4:7], v[148:151]
    ds_read_b128 a[100:103], v5 offset:29696
    v_mfma_f32_16x16x32_bf16 v[136:139], a[84:87], a[0:3], v[136:139]
    ds_read_b128 a[104:107], v5 offset:30720
    v_mfma_f32_16x16x32_bf16 v[152:155], a[84:87], a[4:7], v[152:155]
    ds_read_b128 a[108:111], v5 offset:31744
    v_mfma_f32_16x16x32_bf16 v[140:143], a[88:91], a[0:3], v[140:143]
    buffer_load_dwordx4 a[40:43], v4, s[40:43], s35 offen offset:0 sc1
    v_mfma_f32_16x16x32_bf16 v[156:159], a[88:91], a[4:7], v[156:159]
    v_mfma_f32_16x16x32_bf16 v[144:147], a[92:95], a[0:3], v[144:147]
    buffer_load_dwordx4 a[44:47], v4, s[40:43], s35 offen offset:1024 sc1
    s_add_u32 s35, s35, 4096
    s_and_b32 s35, s35, 0x1ffff
    v_mfma_f32_16x16x32_bf16 v[160:163], a[92:95], a[4:7], v[160:163]
    s_waitcnt vmcnt(8) lgkmcnt(0)
    v_mfma_f32_16x16x32_bf16 v[132:135], a[96:99], a[8:11], v[132:135]
    ds_read_b128 a[80:83], v5 offset:32768
    v_mfma_f32_16x16x32_bf16 v[148:151], a[96:99], a[12:15], v[148:151]
    ds_read_b128 a[84:87], v5 offset:33792
    v_mfma_f32_16x16x32_bf16 v[136:139], a[100:103], a[8:11], v[136:139]
    ds_read_b128 a[88:91], v5 offset:34816
    v_mfma_f32_16x16x32_bf16 v[152:155], a[100:103], a[12:15], v[152:155]
    ds_read_b128 a[92:95], v5 offset:35840
    v_mfma_f32_16x16x32_bf16 v[140:143], a[104:107], a[8:11], v[140:143]
    buffer_load_dwordx4 a[0:3], v4, s[40:43], s35 offen offset:0 sc1
    v_mfma_f32_16x16x32_bf16 v[156:159], a[104:107], a[12:15], v[156:159]
    v_mfma_f32_16x16x32_bf16 v[144:147], a[108:111], a[8:11], v[144:147]
    buffer_load_dwordx4 a[4:7], v4, s[40:43], s35 offen offset:1024 sc1
    s_add_u32 s35, s35, 4096
    s_and_b32 s35, s35, 0x1ffff
    v_mfma_f32_16x16x32_bf16 v[160:163], a[108:111], a[12:15], v[160:163]
    s_waitcnt vmcnt(8) lgkmcnt(0)
    v_mfma_f32_16x16x32_bf16 v[132:135], a[80:83], a[16:19], v[132:135]
    ds_read_b128 a[96:99], v5 offset:36864
    v_mfma_f32_16x16x32_bf16 v[148:151], a[80:83], a[20:23], v[148:151]
    ds_read_b128 a[100:103], v5 offset:37888
    v_mfma_f32_16x16x32_bf16 v[136:139], a[84:87], a[16:19], v[136:139]
    ds_read_b128 a[104:107], v5 offset:38912
    v_mfma_f32_16x16x32_bf16 v[152:155], a[84:87], a[20:23], v[152:155]
    ds_read_b128 a[108:111], v5 offset:39936
    v_mfma_f32_16x16x32_bf16 v[140:143], a[88:91], a[16:19], v[140:143]
    buffer_load_dwordx4 a[8:11], v4, s[40:43], s35 offen offset:0 sc1
    v_mfma_f32_16x16x32_bf16 v[156:159], a[88:91], a[20:23], v[156:159]
    v_mfma_f32_16x16x32_bf16 v[144:147], a[92:95], a[16:19], v[144:147]
    buffer_load_dwordx4 a[12:15], v4, s[40:43], s35 offen offset:1024 sc1
    s_add_u32 s35, s35, 4096
    s_and_b32 s35, s35, 0x1ffff
    v_mfma_f32_16x16x32_bf16 v[160:163], a[92:95], a[20:23], v[160:163]
    s_waitcnt vmcnt(8) lgkmcnt(0)
    v_mfma_f32_16x16x32_bf16 v[132:135], a[96:99], a[24:27], v[132:135]
    ds_read_b128 a[80:83], v5 offset:40960
    v_mfma_f32_16x16x32_bf16 v[148:151], a[96:99], a[28:31], v[148:151]
    ds_read_b128 a[84:87], v5 offset:41984
    v_mfma_f32_16x16x32_bf16 v[136:139], a[100:103], a[24:27], v[136:139]
    ds_read_b128 a[88:91], v5 offset:43008
    v_mfma_f32_16x16x32_bf16 v[152:155], a[100:103], a[28:31], v[152:155]
    ds_read_b128 a[92:95], v5 offset:44032
    v_mfma_f32_16x16x32_bf16 v[140:143], a[104:107], a[24:27], v[140:143]
    buffer_load_dwordx4 a[16:19], v4, s[40:43], s35 offen offset:0 sc1
    v_mfma_f32_16x16x32_bf16 v[156:159], a[104:107], a[28:31], v[156:159]
    v_mfma_f32_16x16x32_bf16 v[144:147], a[108:111], a[24:27], v[144:147]
    buffer_load_dwordx4 a[20:23], v4, s[40:43], s35 offen offset:1024 sc1
    s_add_u32 s35, s35, 4096
    s_and_b32 s35, s35, 0x1ffff
    v_mfma_f32_16x16x32_bf16 v[160:163], a[108:111], a[28:31], v[160:163]
    s_waitcnt vmcnt(8) lgkmcnt(0)
    v_mfma_f32_16x16x32_bf16 v[132:135], a[80:83], a[32:35], v[132:135]
    ds_read_b128 a[96:99], v5 offset:45056
    v_mfma_f32_16x16x32_bf16 v[148:151], a[80:83], a[36:39], v[148:151]
    ds_read_b128 a[100:103], v5 offset:46080
    v_mfma_f32_16x16x32_bf16 v[136:139], a[84:87], a[32:35], v[136:139]
    ds_read_b128 a[104:107], v5 offset:47104
    v_mfma_f32_16x16x32_bf16 v[152:155], a[84:87], a[36:39], v[152:155]
    ds_read_b128 a[108:111], v5 offset:48128
    v_mfma_f32_16x16x32_bf16 v[140:143], a[88:91], a[32:35], v[140:143]
    buffer_load_dwordx4 a[24:27], v4, s[40:43], s35 offen offset:0 sc1
    v_mfma_f32_16x16x32_bf16 v[156:159], a[88:91], a[36:39], v[156:159]
    v_mfma_f32_16x16x32_bf16 v[144:147], a[92:95], a[32:35], v[144:147]
    buffer_load_dwordx4 a[28:31], v4, s[40:43], s35 offen offset:1024 sc1
    s_add_u32 s35, s35, 4096
    s_and_b32 s35, s35, 0x1ffff
    v_mfma_f32_16x16x32_bf16 v[160:163], a[92:95], a[36:39], v[160:163]
    s_waitcnt vmcnt(8) lgkmcnt(0)
    v_mfma_f32_16x16x32_bf16 v[132:135], a[96:99], a[40:43], v[132:135]
    ds_read_b128 a[80:83], v5 offset:49152
    v_mfma_f32_16x16x32_bf16 v[148:151], a[96:99], a[44:47], v[148:151]
    ds_read_b128 a[84:87], v5 offset:50176
    v_mfma_f32_16x16x32_bf16 v[136:139], a[100:103], a[40:43], v[136:139]
    ds_read_b128 a[88:91], v5 offset:51200
    v_mfma_f32_16x16x32_bf16 v[152:155], a[100:103], a[44:47], v[152:155]
    ds_read_b128 a[92:95], v5 offset:52224
    v_mfma_f32_16x16x32_bf16 v[140:143], a[104:107], a[40:43], v[140:143]
    buffer_load_dwordx4 a[32:35], v4, s[40:43], s35 offen offset:0 sc1
    v_mfma_f32_16x16x32_bf16 v[156:159], a[104:107], a[44:47], v[156:159]
    v_mfma_f32_16x16x32_bf16 v[144:147], a[108:111], a[40:43], v[144:147]
    buffer_load_dwordx4 a[36:39], v4, s[40:43], s35 offen offset:1024 sc1
    s_add_u32 s35, s35, 4096
    s_and_b32 s35, s35, 0x1ffff
    v_mfma_f32_16x16x32_bf16 v[160:163], a[108:111], a[44:47], v[160:163]
    s_waitcnt vmcnt(8) lgkmcnt(0)
    v_mfma_f32_16x16x32_bf16 v[132:135], a[80:83], a[0:3], v[132:135]
    ds_read_b128 a[96:99], v5 offset:53248
    v_mfma_f32_16x16x32_bf16 v[148:151], a[80:83], a[4:7], v[148:151]
    ds_read_b128 a[100:103], v5 offset:54272
    v_mfma_f32_16x16x32_bf16 v[136:139], a[84:87], a[0:3], v[136:139]
    ds_read_b128 a[104:107], v5 offset:55296
    v_mfma_f32_16x16x32_bf16 v[152:155], a[84:87], a[4:7], v[152:155]
    ds_read_b128 a[108:111], v5 offset:56320
    v_mfma_f32_16x16x32_bf16 v[140:143], a[88:91], a[0:3], v[140:143]
    buffer_load_dwordx4 a[40:43], v4, s[40:43], s35 offen offset:0 sc1
    v_mfma_f32_16x16x32_bf16 v[156:159], a[88:91], a[4:7], v[156:159]
    v_mfma_f32_16x16x32_bf16 v[144:147], a[92:95], a[0:3], v[144:147]
    buffer_load_dwordx4 a[44:47], v4, s[40:43], s35 offen offset:1024 sc1
    s_add_u32 s35, s35, 4096
    s_and_b32 s35, s35, 0x1ffff
    v_mfma_f32_16x16x32_bf16 v[160:163], a[92:95], a[4:7], v[160:163]
    s_waitcnt vmcnt(8) lgkmcnt(0)
    v_mfma_f32_16x16x32_bf16 v[132:135], a[96:99], a[8:11], v[132:135]
    ds_read_b128 a[80:83], v5 offset:57344
    v_mfma_f32_16x16x32_bf16 v[148:151], a[96:99], a[12:15], v[148:151]
    ds_read_b128 a[84:87], v5 offset:58368
    v_mfma_f32_16x16x32_bf16 v[136:139], a[100:103], a[8:11], v[136:139]
    ds_read_b128 a[88:91], v5 offset:59392
    v_mfma_f32_16x16x32_bf16 v[152:155], a[100:103], a[12:15], v[152:155]
    ds_read_b128 a[92:95], v5 offset:60416
    v_mfma_f32_16x16x32_bf16 v[140:143], a[104:107], a[8:11], v[140:143]
    buffer_load_dwordx4 a[0:3], v4, s[40:43], s35 offen offset:0 sc1
    v_mfma_f32_16x16x32_bf16 v[156:159], a[104:107], a[12:15], v[156:159]
    v_mfma_f32_16x16x32_bf16 v[144:147], a[108:111], a[8:11], v[144:147]
    buffer_load_dwordx4 a[4:7], v4, s[40:43], s35 offen offset:1024 sc1
    s_add_u32 s35, s35, 4096
    s_and_b32 s35, s35, 0x1ffff
    v_mfma_f32_16x16x32_bf16 v[160:163], a[108:111], a[12:15], v[160:163]
    s_waitcnt vmcnt(8) lgkmcnt(0)
    v_mfma_f32_16x16x32_bf16 v[132:135], a[80:83], a[16:19], v[132:135]
    ds_read_b128 a[96:99], v5 offset:61440
    v_mfma_f32_16x16x32_bf16 v[148:151], a[80:83], a[20:23], v[148:151]
    ds_read_b128 a[100:103], v5 offset:62464
    v_mfma_f32_16x16x32_bf16 v[136:139], a[84:87], a[16:19], v[136:139]
    ds_read_b128 a[104:107], v5 offset:63488
    v_mfma_f32_16x16x32_bf16 v[152:155], a[84:87], a[20:23], v[152:155]
    ds_read_b128 a[108:111], v5 offset:64512
    v_mfma_f32_16x16x32_bf16 v[140:143], a[88:91], a[16:19], v[140:143]
    buffer_load_dwordx4 a[8:11], v4, s[40:43], s35 offen offset:0 sc1
    v_mfma_f32_16x16x32_bf16 v[156:159], a[88:91], a[20:23], v[156:159]
    v_mfma_f32_16x16x32_bf16 v[144:147], a[92:95], a[16:19], v[144:147]
    buffer_load_dwordx4 a[12:15], v4, s[40:43], s35 offen offset:1024 sc1
    s_add_u32 s35, s35, 4096
    s_and_b32 s35, s35, 0x1ffff
    v_mfma_f32_16x16x32_bf16 v[160:163], a[92:95], a[20:23], v[160:163]
    s_waitcnt vmcnt(8) lgkmcnt(0)
    v_mfma_f32_16x16x32_bf16 v[132:135], a[96:99], a[24:27], v[132:135]
    ds_read_b128 a[80:83], v6 offset:0
    v_mfma_f32_16x16x32_bf16 v[148:151], a[96:99], a[28:31], v[148:151]
    ds_read_b128 a[84:87], v6 offset:1024
    v_mfma_f32_16x16x32_bf16 v[136:139], a[100:103], a[24:27], v[136:139]
    ds_read_b128 a[88:91], v6 offset:2048
    v_mfma_f32_16x16x32_bf16 v[152:155], a[100:103], a[28:31], v[152:155]
    ds_read_b128 a[92:95], v6 offset:3072
    v_mfma_f32_16x16x32_bf16 v[140:143], a[104:107], a[24:27], v[140:143]
    buffer_load_dwordx4 a[16:19], v4, s[40:43], s35 offen offset:0 sc1
    v_mfma_f32_16x16x32_bf16 v[156:159], a[104:107], a[28:31], v[156:159]
    v_mfma_f32_16x16x32_bf16 v[144:147], a[108:111], a[24:27], v[144:147]
    buffer_load_dwordx4 a[20:23], v4, s[40:43], s35 offen offset:1024 sc1
    s_add_u32 s35, s35, 4096
    s_and_b32 s35, s35, 0x1ffff
    v_mfma_f32_16x16x32_bf16 v[160:163], a[108:111], a[28:31], v[160:163]
    s_waitcnt vmcnt(8) lgkmcnt(0)
    v_mfma_f32_16x16x32_bf16 v[132:135], a[80:83], a[32:35], v[132:135]
    ds_read_b128 a[96:99], v6 offset:4096
    v_mfma_f32_16x16x32_bf16 v[148:151], a[80:83], a[36:39], v[148:151]
    ds_read_b128 a[100:103], v6 offset:5120
    v_mfma_f32_16x16x32_bf16 v[136:139], a[84:87], a[32:35], v[136:139]
    ds_read_b128 a[104:107], v6 offset:6144
    v_mfma_f32_16x16x32_bf16 v[152:155], a[84:87], a[36:39], v[152:155]
    ds_read_b128 a[108:111], v6 offset:7168
    v_mfma_f32_16x16x32_bf16 v[140:143], a[88:91], a[32:35], v[140:143]
    buffer_load_dwordx4 a[24:27], v4, s[40:43], s35 offen offset:0 sc1
    v_mfma_f32_16x16x32_bf16 v[156:159], a[88:91], a[36:39], v[156:159]
    v_mfma_f32_16x16x32_bf16 v[144:147], a[92:95], a[32:35], v[144:147]
    buffer_load_dwordx4 a[28:31], v4, s[40:43], s35 offen offset:1024 sc1
    s_add_u32 s35, s35, 4096
    s_and_b32 s35, s35, 0x1ffff
    v_mfma_f32_16x16x32_bf16 v[160:163], a[92:95], a[36:39], v[160:163]
    s_waitcnt vmcnt(8) lgkmcnt(0)
    v_mfma_f32_16x16x32_bf16 v[132:135], a[96:99], a[40:43], v[132:135]
    ds_read_b128 a[80:83], v6 offset:8192
    v_mfma_f32_16x16x32_bf16 v[148:151], a[96:99], a[44:47], v[148:151]
    ds_read_b128 a[84:87], v6 offset:9216
    v_mfma_f32_16x16x32_bf16 v[136:139], a[100:103], a[40:43], v[136:139]
    ds_read_b128 a[88:91], v6 offset:10240
    v_mfma_f32_16x16x32_bf16 v[152:155], a[100:103], a[44:47], v[152:155]
    ds_read_b128 a[92:95], v6 offset:11264
    v_mfma_f32_16x16x32_bf16 v[140:143], a[104:107], a[40:43], v[140:143]
    buffer_load_dwordx4 a[32:35], v4, s[40:43], s35 offen offset:0 sc1
    v_mfma_f32_16x16x32_bf16 v[156:159], a[104:107], a[44:47], v[156:159]
    v_mfma_f32_16x16x32_bf16 v[144:147], a[108:111], a[40:43], v[144:147]
    buffer_load_dwordx4 a[36:39], v4, s[40:43], s35 offen offset:1024 sc1
    s_add_u32 s35, s35, 4096
    s_and_b32 s35, s35, 0x1ffff
    v_mfma_f32_16x16x32_bf16 v[160:163], a[108:111], a[44:47], v[160:163]
    s_waitcnt vmcnt(8) lgkmcnt(0)
    v_mfma_f32_16x16x32_bf16 v[132:135], a[80:83], a[0:3], v[132:135]
    ds_read_b128 a[96:99], v6 offset:12288
    v_mfma_f32_16x16x32_bf16 v[148:151], a[80:83], a[4:7], v[148:151]
    ds_read_b128 a[100:103], v6 offset:13312
    v_mfma_f32_16x16x32_bf16 v[136:139], a[84:87], a[0:3], v[136:139]
    ds_read_b128 a[104:107], v6 offset:14336
    v_mfma_f32_16x16x32_bf16 v[152:155], a[84:87], a[4:7], v[152:155]
    ds_read_b128 a[108:111], v6 offset:15360
    v_mfma_f32_16x16x32_bf16 v[140:143], a[88:91], a[0:3], v[140:143]
    buffer_load_dwordx4 a[40:43], v4, s[40:43], s35 offen offset:0 sc1
    v_mfma_f32_16x16x32_bf16 v[156:159], a[88:91], a[4:7], v[156:159]
    v_mfma_f32_16x16x32_bf16 v[144:147], a[92:95], a[0:3], v[144:147]
    buffer_load_dwordx4 a[44:47], v4, s[40:43], s35 offen offset:1024 sc1
    s_add_u32 s35, s35, 4096
    s_and_b32 s35, s35, 0x1ffff
    v_mfma_f32_16x16x32_bf16 v[160:163], a[92:95], a[4:7], v[160:163]
    s_waitcnt vmcnt(8) lgkmcnt(0)
    v_mfma_f32_16x16x32_bf16 v[132:135], a[96:99], a[8:11], v[132:135]
    ds_read_b128 a[80:83], v6 offset:16384
    v_mfma_f32_16x16x32_bf16 v[148:151], a[96:99], a[12:15], v[148:151]
    ds_read_b128 a[84:87], v6 offset:17408
    v_mfma_f32_16x16x32_bf16 v[136:139], a[100:103], a[8:11], v[136:139]
    ds_read_b128 a[88:91], v6 offset:18432
    v_mfma_f32_16x16x32_bf16 v[152:155], a[100:103], a[12:15], v[152:155]
    ds_read_b128 a[92:95], v6 offset:19456
    v_mfma_f32_16x16x32_bf16 v[140:143], a[104:107], a[8:11], v[140:143]
    buffer_load_dwordx4 a[0:3], v4, s[40:43], s35 offen offset:0 sc1
    v_mfma_f32_16x16x32_bf16 v[156:159], a[104:107], a[12:15], v[156:159]
    v_mfma_f32_16x16x32_bf16 v[144:147], a[108:111], a[8:11], v[144:147]
    buffer_load_dwordx4 a[4:7], v4, s[40:43], s35 offen offset:1024 sc1
    s_add_u32 s35, s35, 4096
    s_and_b32 s35, s35, 0x1ffff
    v_mfma_f32_16x16x32_bf16 v[160:163], a[108:111], a[12:15], v[160:163]
    s_waitcnt vmcnt(8) lgkmcnt(0)
    v_mfma_f32_16x16x32_bf16 v[132:135], a[80:83], a[16:19], v[132:135]
    ds_read_b128 a[96:99], v6 offset:20480
    v_mfma_f32_16x16x32_bf16 v[148:151], a[80:83], a[20:23], v[148:151]
    ds_read_b128 a[100:103], v6 offset:21504
    v_mfma_f32_16x16x32_bf16 v[136:139], a[84:87], a[16:19], v[136:139]
    ds_read_b128 a[104:107], v6 offset:22528
    v_mfma_f32_16x16x32_bf16 v[152:155], a[84:87], a[20:23], v[152:155]
    ds_read_b128 a[108:111], v6 offset:23552
    v_mfma_f32_16x16x32_bf16 v[140:143], a[88:91], a[16:19], v[140:143]
    buffer_load_dwordx4 a[8:11], v4, s[40:43], s35 offen offset:0 sc1
    v_mfma_f32_16x16x32_bf16 v[156:159], a[88:91], a[20:23], v[156:159]
    v_mfma_f32_16x16x32_bf16 v[144:147], a[92:95], a[16:19], v[144:147]
    buffer_load_dwordx4 a[12:15], v4, s[40:43], s35 offen offset:1024 sc1
    s_add_u32 s35, s35, 4096
    s_and_b32 s35, s35, 0x1ffff
    v_mfma_f32_16x16x32_bf16 v[160:163], a[92:95], a[20:23], v[160:163]
    s_waitcnt vmcnt(8) lgkmcnt(0)
    v_mfma_f32_16x16x32_bf16 v[132:135], a[96:99], a[24:27], v[132:135]
    ds_read_b128 a[80:83], v6 offset:24576
    v_mfma_f32_16x16x32_bf16 v[148:151], a[96:99], a[28:31], v[148:151]
    ds_read_b128 a[84:87], v6 offset:25600
    v_mfma_f32_16x16x32_bf16 v[136:139], a[100:103], a[24:27], v[136:139]
    ds_read_b128 a[88:91], v6 offset:26624
    v_mfma_f32_16x16x32_bf16 v[152:155], a[100:103], a[28:31], v[152:155]
    ds_read_b128 a[92:95], v6 offset:27648
    v_mfma_f32_16x16x32_bf16 v[140:143], a[104:107], a[24:27], v[140:143]
    buffer_load_dwordx4 a[16:19], v4, s[40:43], s35 offen offset:0 sc1
    v_mfma_f32_16x16x32_bf16 v[156:159], a[104:107], a[28:31], v[156:159]
    v_mfma_f32_16x16x32_bf16 v[144:147], a[108:111], a[24:27], v[144:147]
    buffer_load_dwordx4 a[20:23], v4, s[40:43], s35 offen offset:1024 sc1
    s_add_u32 s35, s35, 4096
    s_and_b32 s35, s35, 0x1ffff
    v_mfma_f32_16x16x32_bf16 v[160:163], a[108:111], a[28:31], v[160:163]
    s_waitcnt vmcnt(8) lgkmcnt(0)
    v_mfma_f32_16x16x32_bf16 v[132:135], a[80:83], a[32:35], v[132:135]
    ds_read_b128 a[96:99], v6 offset:28672
    v_mfma_f32_16x16x32_bf16 v[148:151], a[80:83], a[36:39], v[148:151]
    ds_read_b128 a[100:103], v6 offset:29696
    v_mfma_f32_16x16x32_bf16 v[136:139], a[84:87], a[32:35], v[136:139]
    ds_read_b128 a[104:107], v6 offset:30720
    v_mfma_f32_16x16x32_bf16 v[152:155], a[84:87], a[36:39], v[152:155]
    ds_read_b128 a[108:111], v6 offset:31744
    v_mfma_f32_16x16x32_bf16 v[140:143], a[88:91], a[32:35], v[140:143]
    buffer_load_dwordx4 a[24:27], v4, s[40:43], s35 offen offset:0 sc1
    v_mfma_f32_16x16x32_bf16 v[156:159], a[88:91], a[36:39], v[156:159]
    v_mfma_f32_16x16x32_bf16 v[144:147], a[92:95], a[32:35], v[144:147]
    buffer_load_dwordx4 a[28:31], v4, s[40:43], s35 offen offset:1024 sc1
    s_add_u32 s35, s35, 4096
    s_and_b32 s35, s35, 0x1ffff
    v_mfma_f32_16x16x32_bf16 v[160:163], a[92:95], a[36:39], v[160:163]
    s_waitcnt vmcnt(8) lgkmcnt(0)
    v_mfma_f32_16x16x32_bf16 v[132:135], a[96:99], a[40:43], v[132:135]
    ds_read_b128 a[80:83], v6 offset:32768
    v_mfma_f32_16x16x32_bf16 v[148:151], a[96:99], a[44:47], v[148:151]
    ds_read_b128 a[84:87], v6 offset:33792
    v_mfma_f32_16x16x32_bf16 v[136:139], a[100:103], a[40:43], v[136:139]
    ds_read_b128 a[88:91], v6 offset:34816
    v_mfma_f32_16x16x32_bf16 v[152:155], a[100:103], a[44:47], v[152:155]
    ds_read_b128 a[92:95], v6 offset:35840
    v_mfma_f32_16x16x32_bf16 v[140:143], a[104:107], a[40:43], v[140:143]
    buffer_load_dwordx4 a[32:35], v4, s[40:43], s35 offen offset:0 sc1
    v_mfma_f32_16x16x32_bf16 v[156:159], a[104:107], a[44:47], v[156:159]
    v_mfma_f32_16x16x32_bf16 v[144:147], a[108:111], a[40:43], v[144:147]
    buffer_load_dwordx4 a[36:39], v4, s[40:43], s35 offen offset:1024 sc1
    s_add_u32 s35, s35, 4096
    s_and_b32 s35, s35, 0x1ffff
    v_mfma_f32_16x16x32_bf16 v[160:163], a[108:111], a[44:47], v[160:163]
    s_waitcnt vmcnt(8) lgkmcnt(0)
    v_mfma_f32_16x16x32_bf16 v[132:135], a[80:83], a[0:3], v[132:135]
    ds_read_b128 a[96:99], v6 offset:36864
    v_mfma_f32_16x16x32_bf16 v[148:151], a[80:83], a[4:7], v[148:151]
    ds_read_b128 a[100:103], v6 offset:37888
    v_mfma_f32_16x16x32_bf16 v[136:139], a[84:87], a[0:3], v[136:139]
    ds_read_b128 a[104:107], v6 offset:38912
    v_mfma_f32_16x16x32_bf16 v[152:155], a[84:87], a[4:7], v[152:155]
    ds_read_b128 a[108:111], v6 offset:39936
    v_mfma_f32_16x16x32_bf16 v[140:143], a[88:91], a[0:3], v[140:143]
    buffer_load_dwordx4 a[40:43], v4, s[40:43], s35 offen offset:0 sc1
    v_mfma_f32_16x16x32_bf16 v[156:159], a[88:91], a[4:7], v[156:159]
    v_mfma_f32_16x16x32_bf16 v[144:147], a[92:95], a[0:3], v[144:147]
    buffer_load_dwordx4 a[44:47], v4, s[40:43], s35 offen offset:1024 sc1
    s_add_u32 s35, s35, 4096
    s_and_b32 s35, s35, 0x1ffff
    v_mfma_f32_16x16x32_bf16 v[160:163], a[92:95], a[4:7], v[160:163]
    s_waitcnt vmcnt(8) lgkmcnt(0)
    v_mfma_f32_16x16x32_bf16 v[132:135], a[96:99], a[8:11], v[132:135]
    ds_read_b128 a[80:83], v6 offset:40960
    v_mfma_f32_16x16x32_bf16 v[148:151], a[96:99], a[12:15], v[148:151]
    ds_read_b128 a[84:87], v6 offset:41984
    v_mfma_f32_16x16x32_bf16 v[136:139], a[100:103], a[8:11], v[136:139]
    ds_read_b128 a[88:91], v6 offset:43008
    v_mfma_f32_16x16x32_bf16 v[152:155], a[100:103], a[12:15], v[152:155]
    ds_read_b128 a[92:95], v6 offset:44032
    v_mfma_f32_16x16x32_bf16 v[140:143], a[104:107], a[8:11], v[140:143]
    buffer_load_dwordx4 a[0:3], v4, s[40:43], s35 offen offset:0 sc1
    v_mfma_f32_16x16x32_bf16 v[156:159], a[104:107], a[12:15], v[156:159]
    v_mfma_f32_16x16x32_bf16 v[144:147], a[108:111], a[8:11], v[144:147]
    buffer_load_dwordx4 a[4:7], v4, s[40:43], s35 offen offset:1024 sc1
    s_add_u32 s35, s35, 4096
    s_and_b32 s35, s35, 0x1ffff
    v_mfma_f32_16x16x32_bf16 v[160:163], a[108:111], a[12:15], v[160:163]
    s_waitcnt vmcnt(8) lgkmcnt(0)
    v_mfma_f32_16x16x32_bf16 v[132:135], a[80:83], a[16:19], v[132:135]
    ds_read_b128 a[96:99], v6 offset:45056
    v_mfma_f32_16x16x32_bf16 v[148:151], a[80:83], a[20:23], v[148:151]
    ds_read_b128 a[100:103], v6 offset:46080
    v_mfma_f32_16x16x32_bf16 v[136:139], a[84:87], a[16:19], v[136:139]
    ds_read_b128 a[104:107], v6 offset:47104
    v_mfma_f32_16x16x32_bf16 v[152:155], a[84:87], a[20:23], v[152:155]
    ds_read_b128 a[108:111], v6 offset:48128
    v_mfma_f32_16x16x32_bf16 v[140:143], a[88:91], a[16:19], v[140:143]
    buffer_load_dwordx4 a[8:11], v4, s[40:43], s35 offen offset:0 sc1
    v_mfma_f32_16x16x32_bf16 v[156:159], a[88:91], a[20:23], v[156:159]
    v_mfma_f32_16x16x32_bf16 v[144:147], a[92:95], a[16:19], v[144:147]
    buffer_load_dwordx4 a[12:15], v4, s[40:43], s35 offen offset:1024 sc1
    s_add_u32 s35, s35, 4096
    s_and_b32 s35, s35, 0x1ffff
    v_mfma_f32_16x16x32_bf16 v[160:163], a[92:95], a[20:23], v[160:163]
    s_waitcnt vmcnt(8) lgkmcnt(0)
    v_mfma_f32_16x16x32_bf16 v[132:135], a[96:99], a[24:27], v[132:135]
    ds_read_b128 a[80:83], v6 offset:49152
    v_mfma_f32_16x16x32_bf16 v[148:151], a[96:99], a[28:31], v[148:151]
    ds_read_b128 a[84:87], v6 offset:50176
    v_mfma_f32_16x16x32_bf16 v[136:139], a[100:103], a[24:27], v[136:139]
    ds_read_b128 a[88:91], v6 offset:51200
    v_mfma_f32_16x16x32_bf16 v[152:155], a[100:103], a[28:31], v[152:155]
    ds_read_b128 a[92:95], v6 offset:52224
    v_mfma_f32_16x16x32_bf16 v[140:143], a[104:107], a[24:27], v[140:143]
    v_mfma_f32_16x16x32_bf16 v[156:159], a[104:107], a[28:31], v[156:159]
    v_mfma_f32_16x16x32_bf16 v[144:147], a[108:111], a[24:27], v[144:147]
    v_mfma_f32_16x16x32_bf16 v[160:163], a[108:111], a[28:31], v[160:163]
    s_waitcnt vmcnt(6) lgkmcnt(0)
    v_mfma_f32_16x16x32_bf16 v[132:135], a[80:83], a[32:35], v[132:135]
    ds_read_b128 a[96:99], v6 offset:53248
    v_mfma_f32_16x16x32_bf16 v[148:151], a[80:83], a[36:39], v[148:151]
    ds_read_b128 a[100:103], v6 offset:54272
    v_mfma_f32_16x16x32_bf16 v[136:139], a[84:87], a[32:35], v[136:139]
    ds_read_b128 a[104:107], v6 offset:55296
    v_mfma_f32_16x16x32_bf16 v[152:155], a[84:87], a[36:39], v[152:155]
    ds_read_b128 a[108:111], v6 offset:56320
    v_mfma_f32_16x16x32_bf16 v[140:143], a[88:91], a[32:35], v[140:143]
    v_mfma_f32_16x16x32_bf16 v[156:159], a[88:91], a[36:39], v[156:159]
    v_mfma_f32_16x16x32_bf16 v[144:147], a[92:95], a[32:35], v[144:147]
    v_mfma_f32_16x16x32_bf16 v[160:163], a[92:95], a[36:39], v[160:163]
    s_waitcnt vmcnt(4) lgkmcnt(0)
    v_mfma_f32_16x16x32_bf16 v[132:135], a[96:99], a[40:43], v[132:135]
    ds_read_b128 a[80:83], v6 offset:57344
    v_mfma_f32_16x16x32_bf16 v[148:151], a[96:99], a[44:47], v[148:151]
    ds_read_b128 a[84:87], v6 offset:58368
    v_mfma_f32_16x16x32_bf16 v[136:139], a[100:103], a[40:43], v[136:139]
    ds_read_b128 a[88:91], v6 offset:59392
    v_mfma_f32_16x16x32_bf16 v[152:155], a[100:103], a[44:47], v[152:155]
    ds_read_b128 a[92:95], v6 offset:60416
    v_mfma_f32_16x16x32_bf16 v[140:143], a[104:107], a[40:43], v[140:143]
    v_mfma_f32_16x16x32_bf16 v[156:159], a[104:107], a[44:47], v[156:159]
    v_mfma_f32_16x16x32_bf16 v[144:147], a[108:111], a[40:43], v[144:147]
    v_mfma_f32_16x16x32_bf16 v[160:163], a[108:111], a[44:47], v[160:163]
    s_waitcnt vmcnt(2) lgkmcnt(0)
    v_mfma_f32_16x16x32_bf16 v[132:135], a[80:83], a[0:3], v[132:135]
    ds_read_b128 a[96:99], v6 offset:61440
    v_mfma_f32_16x16x32_bf16 v[148:151], a[80:83], a[4:7], v[148:151]
    ds_read_b128 a[100:103], v6 offset:62464
    v_mfma_f32_16x16x32_bf16 v[136:139], a[84:87], a[0:3], v[136:139]
    ds_read_b128 a[104:107], v6 offset:63488
    v_mfma_f32_16x16x32_bf16 v[152:155], a[84:87], a[4:7], v[152:155]
    ds_read_b128 a[108:111], v6 offset:64512
    v_mfma_f32_16x16x32_bf16 v[140:143], a[88:91], a[0:3], v[140:143]
    v_mfma_f32_16x16x32_bf16 v[156:159], a[88:91], a[4:7], v[156:159]
    v_mfma_f32_16x16x32_bf16 v[144:147], a[92:95], a[0:3], v[144:147]
    v_mfma_f32_16x16x32_bf16 v[160:163], a[92:95], a[4:7], v[160:163]
    s_waitcnt vmcnt(0) lgkmcnt(0)
    s_barrier
    v_mfma_f32_16x16x32_bf16 v[132:135], a[96:99], a[8:11], v[132:135]
    v_mfma_f32_16x16x32_bf16 v[148:151], a[96:99], a[12:15], v[148:151]
    v_mfma_f32_16x16x32_bf16 v[136:139], a[100:103], a[8:11], v[136:139]
    v_mfma_f32_16x16x32_bf16 v[152:155], a[100:103], a[12:15], v[152:155]
    v_mfma_f32_16x16x32_bf16 v[140:143], a[104:107], a[8:11], v[140:143]
    v_mfma_f32_16x16x32_bf16 v[156:159], a[104:107], a[12:15], v[156:159]
    v_mfma_f32_16x16x32_bf16 v[144:147], a[108:111], a[8:11], v[144:147]
    v_mfma_f32_16x16x32_bf16 v[160:163], a[108:111], a[12:15], v[160:163]
    s_nop 0
    v_cvt_pk_bf16_f32 v32, v132, v133
    v_cvt_pk_bf16_f32 v33, v134, v135
    v_cvt_pk_bf16_f32 v34, v136, v137
    v_cvt_pk_bf16_f32 v35, v138, v139
    v_cvt_pk_bf16_f32 v36, v140, v141
    v_cvt_pk_bf16_f32 v37, v142, v143
    v_cvt_pk_bf16_f32 v38, v144, v145
    v_cvt_pk_bf16_f32 v39, v146, v147
    v_cvt_pk_bf16_f32 v40, v148, v149
    v_cvt_pk_bf16_f32 v41, v150, v151
    v_cvt_pk_bf16_f32 v42, v152, v153
    v_cvt_pk_bf16_f32 v43, v154, v155
    v_cvt_pk_bf16_f32 v44, v156, v157
    v_cvt_pk_bf16_f32 v45, v158, v159
    v_cvt_pk_bf16_f32 v46, v160, v161
    v_cvt_pk_bf16_f32 v47, v162, v163
    v_lshrrev_b32 v233, 4, v0
    v_and_b32 v234, 15, v0
    s_and_b32 s36, s31, 7
    s_lshl_b32 s36, s36, 7
    s_lshl_b32 s37, s28, 5
    s_add_u32 s36, s36, s37
    s_lshl_b32 s36, s36, 1
    s_lshr_b32 s37, s31, 3
    s_add_u32 s36, s36, s37
    s_lshl_b32 s36, s36, 11
    s_lshl_b32 s37, s32, 7
    s_add_u32 s36, s36, s37
    v_lshl_add_u32 v232, v234, 12, s36
    v_lshl_add_u32 v232, v233, 4, v232
    s_mov_b32 s36, 0x10000
    buffer_store_dwordx4 v[32:35], v232, s[12:15], 0 offen offset:0
    buffer_store_dwordx4 v[36:39], v232, s[12:15], 0 offen offset:64
    buffer_store_dwordx4 v[40:43], v232, s[12:15], s36 offen offset:0
    buffer_store_dwordx4 v[44:47], v232, s[12:15], s36 offen offset:64
L_end:
    s_endpgm
L_code_end:
.section .rodata,"a"
.p2align 6
.amdhsa_kernel interleave_layers__sliding_local_dilated__linear_kernel_hedgehog__prompt_kernel
  .amdhsa_next_free_vgpr 512
  .amdhsa_next_free_sgpr 102
  .amdhsa_accum_offset 256
  .amdhsa_group_segment_fixed_size 0
  .amdhsa_kernarg_size 80
  .amdhsa_user_sgpr_count 2
  .amdhsa_user_sgpr_kernarg_segment_ptr 1
  .amdhsa_system_sgpr_workgroup_id_x 1
.end_amdhsa_kernel
```

```asm
; @launch grid=(256,1,1) block=(256,1,1) lds=163840
.amdgcn_target "amdgcn-amd-amdhsa--gfx950"
.text
.globl interleave_layers__sliding_local_dilated__linear_kernel_hedgehog__prompt_kernel
.p2align 8
.type interleave_layers__sliding_local_dilated__linear_kernel_hedgehog__prompt_kernel,@function
interleave_layers__sliding_local_dilated__linear_kernel_hedgehog__prompt_kernel:
s_cmp_ge_u32 s2, 256
s_cbranch_scc1 L_end
s_load_dwordx16 s[64:79], s[0:1], 0
s_load_dwordx4 s[80:83], s[0:1], 64
s_getpc_b64 s[24:25]
s_mov_b32 s26, (L_end - interleave_layers__sliding_local_dilated__linear_kernel_hedgehog__prompt_kernel - 64)
s_mov_b32 s27, 0x20000
v_lshlrev_b32 v1, 5, v0
buffer_load_dword v238, v1, s[24:27], 0 offen
v_lshrrev_b32 v1, 6, v0
v_and_b32 v0, 63, v0
v_readfirstlane_b32 s28, v1
s_and_b32 s36, s2, 7
s_lshr_b32 s37, s2, 3
s_and_b32 s38, s37, 3
s_lshr_b32 s39, s37, 2
s_and_b32 s29, s36, 1
s_lshl_b32 s32, s29, 3
s_lshl_b32 s29, s29, 2
s_add_u32 s29, s29, s38
s_add_u32 s32, s32, s39
s_lshr_b32 s36, s36, 1
s_lshl_b32 s30, s36, 3
s_add_u32 s30, s30, s39
s_lshl_b32 s31, s36, 2
s_add_u32 s31, s31, s38
s_and_b32 s32, s36, 1
s_lshl_b32 s32, s32, 3
s_add_u32 s32, s32, s39
s_and_b32 s31, s2, 1
s_lshl_b32 s31, s31, 3
s_add_u32 s31, s31, s38
s_and_b32 s3, s2, 4
s_add_u32 s31, s31, s3
s_mov_b32 s3, s39
s_and_b32 s35, s2, 7
s_lshl_b32 s35, s35, 5
s_add_u32 s35, s35, s37
s_mul_i32 s33, s39, 16
s_and_b32 s33, s33, 31
s_mul_i32 s34, s39, 16
s_and_b32 s34, s34, 31
v_lshlrev_b32 v1, 4, v0
v_lshrrev_b32 v233, 4, v0
v_and_b32 v234, 15, v0
s_and_b32 s36, s31, 7
s_lshl_b32 s36, s36, 7
s_lshl_b32 s37, s28, 5
s_add_u32 s36, s36, s37
s_lshl_b32 s36, s36, 1
s_lshr_b32 s37, s31, 3
s_add_u32 s36, s36, s37
s_lshl_b32 s36, s36, 11
s_lshl_b32 s37, s32, 7
s_add_u32 s36, s36, s37
v_lshl_add_u32 v232, v234, 12, s36
v_lshl_add_u32 v232, v233, 4, v232
v_lshrrev_b32 v235, 3, v0
v_and_b32 v236, 7, v0
v_lshlrev_b32 v236, 4, v236
v_lshl_add_u32 v237, v235, 11, v236
v_mul_u32_u24 v235, 6144, v235
v_add_u32 v235, v235, v236
s_lshr_b32 s36, s35, 4
s_lshl_b32 s36, s36, 2
s_add_u32 s36, s36, s28
s_mul_i32 s36, s36, 98304
s_and_b32 s37, s35, 15
s_lshl_b32 s37, s37, 7
s_add_u32 s36, s36, s37
s_lshl_b32 s37, s28, 11
s_mov_b32 s39, 0x10000
s_mov_b32 s10, 0x400000
s_mov_b32 s11, 0x20000
s_mov_b32 s22, 0x600000
s_mov_b32 s23, 0x20000
s_mov_b32 s6, 0x10000000
s_mov_b32 s7, 0x20000
s_mov_b32 s44, 0xf0000
s_waitcnt lgkmcnt(0)
s_mov_b64 s[8:9], s[64:65]
s_mov_b64 s[20:21], s[66:67]
buffer_load_dwordx4 v[32:35], v232, s[8:11], 0 offen offset:0 nt
buffer_load_dwordx4 v[36:39], v232, s[8:11], 0 offen offset:64 nt
buffer_load_dwordx4 v[40:43], v232, s[8:11], s39 offen offset:0 nt
buffer_load_dwordx4 v[44:47], v232, s[8:11], s39 offen offset:64 nt
s_add_u32 m0, s37, 0
s_add_u32 s38, s36, 0
buffer_load_dwordx4 v235, s[20:23], s38 offen nt lds
s_add_u32 m0, s37, 1024
s_add_u32 s38, s36, 49152
buffer_load_dwordx4 v235, s[20:23], s38 offen nt lds
s_add_u32 m0, s37, 8192
s_add_u32 s38, s36, 2048
buffer_load_dwordx4 v235, s[20:23], s38 offen nt lds
s_add_u32 m0, s37, 9216
s_add_u32 s38, s36, 51200
buffer_load_dwordx4 v235, s[20:23], s38 offen nt lds
s_add_u32 m0, s37, 16384
s_add_u32 s38, s36, 4096
buffer_load_dwordx4 v235, s[20:23], s38 offen nt lds
s_add_u32 m0, s37, 17408
s_add_u32 s38, s36, 53248
buffer_load_dwordx4 v235, s[20:23], s38 offen nt lds
s_add_u32 s4, s82, 0x0
s_addc_u32 s5, s83, 0
buffer_load_dword v11, off, s[4:7], s44 sc1
s_lshr_b32 s36, s2, 3
s_lshl_b32 s36, s36, 2
s_add_u32 s36, s36, s28
s_lshl_b32 s36, s36, 10
buffer_load_dwordx4 a[0:3], v1, s[24:27], s36 offen
s_mov_b32 s16, s80
s_mov_b32 s17, s81
s_mov_b32 s18, 0x100
s_mov_b32 s19, 0x20000
s_mov_b32 s12, s78
s_mov_b32 s13, s79
s_mov_b32 s14, 0x400000
s_mov_b32 s15, 0x20000
s_mov_b32 s42, 0x400000
s_mov_b32 s43, 0x20000
v_mov_b32 v12, 1
s_mov_b64 s[40:41], s[12:13]
s_mov_b32 s64, 0xff
s_mov_b32 s65, 0
s_and_b32 s81, s29, 3
s_lshl_b32 s66, s31, 4
s_add_u32 s66, s66, s32
s_lshl_b32 s66, s66, 8
s_lshl_b32 s67, s29, 5
s_add_u32 s67, s67, s30
s_lshl_b32 s67, s67, 8
s_lshl_b32 s80, s30, 11
s_lshl_b32 s70, s29, 8
s_add_u32 s70, s70, s80
s_lshl_b32 s71, s29, 13
s_lshr_b32 s78, s31, 1
s_lshl_b32 s78, s78, 13
s_add_u32 s79, s78, 8192
s_bitcmp1_b32 s31, 0
s_cselect_b32 s79, s79, 0x40000000
s_and_b32 s36, s31, 7
s_cmp_eq_u32 s36, 7
s_cselect_b32 s79, 0x40000000, s79
v_mov_b32 v240, 0
v_mov_b32 v241, 0
v_mov_b32 v242, 0
v_mov_b32 v243, 0
v_lshlrev_b32 v239, 16, v233
v_lshl_add_u32 v239, v234, 4, v239
s_cmp_eq_u32 s28, 0
s_cselect_b32 s36, s66, s67
s_cmp_eq_u32 s28, 2
s_cselect_b32 s36, s70, s36
s_lshl_b32 s37, s28, 18
s_add_u32 s36, s36, s37
s_cmp_eq_u32 s28, 3
s_cselect_b32 s36, 0x40000000, s36
buffer_store_dwordx4 v[240:243], v239, s[4:7], s36 offen sc1
v_mov_b32 v16, 0x3f803f80
v_mov_b32 v17, 0x3f803f80
v_mov_b32 v18, 0x3f803f80
v_mov_b32 v19, 0x3f803f80
s_mov_b32 s46, 0xaaaaaaaa
s_mov_b32 s47, 0xaaaaaaaa
s_mov_b32 s48, 0xcccccccc
s_mov_b32 s49, 0xcccccccc
s_lshl_b32 s36, s31, 1
s_lshr_b32 s37, s28, 1
s_add_u32 s36, s36, s37
s_lshl_b32 s36, s36, 17
s_and_b32 s37, s28, 1
s_lshl_b32 s37, s37, 11
s_add_u32 s36, s36, s37
v_add_u32 v4, s36, v1
s_lshl_b32 s38, s31, 2
s_add_u32 s38, s38, s28
s_lshl_b32 s38, s38, 12
s_lshl_b32 s39, s32, 7
s_add_u32 s38, s38, s39
v_lshrrev_b32 v244, 2, v234
v_cmp_eq_u32 vcc, v244, v233
v_and_b32 v244, 7, v234
v_lshl_add_u32 v244, v244, 4, s38
v_and_b32 v245, 8, v234
v_add_u32 v244, v244, v245
v_cndmask_b32 v253, 2.0, v244, vcc
v_lshlrev_b32 v244, 4, v233
v_lshl_add_u32 v244, v234, 6, v244
v_cmp_gt_u32 vcc, 2, v234
s_nop 1
v_cndmask_b32 v254, 2.0, v244, vcc
v_lshrrev_b32 v248, 4, v0
v_lshlrev_b32 v248, 10, v248
v_bfe_u32 v249, v0, 2, 2
v_lshl_add_u32 v248, v249, 7, v248
v_and_b32 v251, 3, v0
v_lshl_add_u32 v248, v251, 3, v248
s_lshr_b32 s36, s28, 1
s_lshl_b32 s36, s36, 6
s_and_b32 s37, s28, 1
s_mul_i32 s38, s37, 8224
s_add_u32 s38, s38, s36
s_mul_i32 s39, s37, 16352
s_add_u32 s39, s39, s36
v_add_u32 v249, s39, v248
v_add_u32 v248, s38, v248
s_and_b32 s38, s35, 15
s_lshl_b32 s38, s38, 1
s_lshr_b32 s36, s28, 1
s_add_u32 s38, s38, s36
s_lshr_b32 s36, s35, 4
s_mul_i32 s96, s38, 196608
s_mul_i32 s44, s36, 12288
s_add_u32 s96, s96, s44
s_mul_i32 s44, s37, 3072
s_add_u32 s96, s96, s44
s_add_u32 s96, s96, 0xe00000
s_add_u32 s97, s96, 6144
s_mul_i32 s38, s38, 6
s_mul_i32 s37, s37, 3
s_add_u32 s38, s38, s37
s_lshl_b32 s38, s38, 11
s_lshl_b32 s36, s36, 7
s_add_u32 s38, s38, s36
s_add_u32 s98, s38, 0x300000
s_add_u32 s99, s98, 4096
s_mov_b32 s56, 0x11111111
s_mov_b32 s57, 0x11111111
s_mov_b32 s58, 0x22222222
s_mov_b32 s59, 0x22222222
s_mul_i32 s50, s30, 196608
s_and_b32 s36, s28, 1
s_mul_i32 s36, s36, 3072
s_add_u32 s50, s50, s36
s_add_u32 s50, s50, 0xe00000
s_lshl_b32 s51, s32, 17
s_add_u32 s51, s51, 0xa00000
s_mul_i32 s55, s28, 6144
v_accvgpr_write_b32 a228, -1
v_accvgpr_write_b32 a229, -1
v_accvgpr_write_b32 a230, -1
v_accvgpr_write_b32 a231, -1
s_lshl_b32 s36, s29, 2
s_add_u32 s36, s36, s28
s_lshl_b32 s37, s36, 17
v_add_u32 v2, s37, v1
s_lshl_b32 s82, s36, 13
s_and_b32 s38, s29, 3
s_cmp_eq_u32 s38, 0
s_cselect_b32 s38, 0, 0x1f400
s_cselect_b32 s39, 0, 2048
s_cselect_b32 s54, 32, 48
s_lshl_b32 s37, s29, 19
s_sub_u32 s37, s37, s38
v_add_u32 v3, s37, v1
v_cmp_le_u32 vcc, 8, v234
s_nop 1
v_cndmask_b32 v3, 2.0, v3, vcc
s_lshl_b32 s37, s29, 15
s_sub_u32 s83, s37, s39
s_cmp_eq_u32 s28, 1
s_cselect_b32 vcc_lo, -1, 0
s_mov_b32 vcc_hi, 0
v_lshlrev_b32 v244, 8, v0
v_cndmask_b32 v10, 2.0, v244, vcc
v_and_b32 v244, 1, v233
v_lshl_add_u32 v244, v244, 3, v234
v_and_b32 v244, 15, v244
v_lshrrev_b32 v245, 1, v233
v_lshl_add_u32 v244, v245, 4, v244
v_lshrrev_b32 v245, 3, v234
v_lshl_add_u32 v244, v245, 5, v244
v_lshlrev_b32 v7, 3, v244
v_lshrrev_b32 v246, 2, v0
v_and_b32 v247, 3, v0
v_and_b32 v244, 1, v247
v_lshl_add_u32 v244, v244, 3, v246
v_and_b32 v244, 15, v244
v_lshrrev_b32 v245, 1, v247
v_lshl_add_u32 v244, v245, 4, v244
v_lshrrev_b32 v245, 3, v246
v_lshl_add_u32 v244, v245, 5, v244
v_lshlrev_b32 v8, 3, v244
s_and_b32 s36, s28, 1
s_lshl_b32 s37, s36, 3
s_add_u32 s37, s37, 20480
s_lshl_b32 s36, s36, 9
v_add_u32 v244, s37, v1
v_add_u32 v245, s36, v7
s_cmp_lt_u32 s28, 2
s_cselect_b64 vcc, -1, 0
v_cndmask_b32 v9, v245, v244, vcc
v_lshlrev_b32 v239, 2, v233
v_sub_u32 v239, v239, v234
v_mov_b32 v247, 0xf149f2ca
v_add_u32 v246, 7, v239
v_cmp_gt_u32 vcc, 8, v246
v_mov_b32 v244, 0xffff
s_nop 0
v_cndmask_b32 v24, v247, 0, vcc
v_cndmask_b32 v244, 0, v244, vcc
v_mov_b32 v30, v244
v_add_u32 v246, 0, v239
v_cmp_le_i32 vcc, 9, v246
v_mov_b32 v244, 0xffff
s_nop 0
v_cndmask_b32 v20, v247, 0, vcc
v_cndmask_b32 v244, 0, v244, vcc
v_mov_b32 v28, v244
v_add_u32 v246, 8, v239
v_cmp_gt_u32 vcc, 8, v246
v_mov_b32 v244, 0xffff0000
s_nop 0
v_cndmask_b32 v25, v247, 0, vcc
v_cndmask_b32 v244, 0, v244, vcc
v_or_b32 v30, v30, v244
v_add_u32 v246, 1, v239
v_cmp_le_i32 vcc, 9, v246
v_mov_b32 v244, 0xffff0000
s_nop 0
v_cndmask_b32 v21, v247, 0, vcc
v_cndmask_b32 v244, 0, v244, vcc
v_or_b32 v28, v28, v244
v_add_u32 v246, 9, v239
v_cmp_gt_u32 vcc, 8, v246
v_mov_b32 v244, 0xffff
s_nop 0
v_cndmask_b32 v26, v247, 0, vcc
v_cndmask_b32 v244, 0, v244, vcc
v_mov_b32 v31, v244
v_add_u32 v246, 2, v239
v_cmp_le_i32 vcc, 9, v246
v_mov_b32 v244, 0xffff
s_nop 0
v_cndmask_b32 v22, v247, 0, vcc
v_cndmask_b32 v244, 0, v244, vcc
v_mov_b32 v29, v244
v_add_u32 v246, 10, v239
v_cmp_gt_u32 vcc, 8, v246
v_mov_b32 v244, 0xffff0000
s_nop 0
v_cndmask_b32 v27, v247, 0, vcc
v_cndmask_b32 v244, 0, v244, vcc
v_or_b32 v31, v31, v244
v_add_u32 v246, 3, v239
v_cmp_le_i32 vcc, 9, v246
v_mov_b32 v244, 0xffff0000
s_nop 0
v_cndmask_b32 v23, v247, 0, vcc
v_cndmask_b32 v244, 0, v244, vcc
v_or_b32 v29, v29, v244
s_and_b32 s36, s29, 3
s_or_b32 s36, s36, s28
s_cmp_eq_u32 s36, 0
s_cselect_b64 vcc, -1, 0
v_cndmask_b32 v76, v20, v247, vcc
v_cndmask_b32 v77, v21, v247, vcc
v_cndmask_b32 v78, v22, v247, vcc
v_cndmask_b32 v79, v23, v247, vcc
v_cndmask_b32 v80, v28, 0, vcc
v_cndmask_b32 v81, v29, 0, vcc
s_lshl_b32 s36, s32, 13
s_add_u32 s36, s36, 0x0
s_add_u32 s37, s36, 4096
s_mov_b32 s38, 0x200000
s_waitcnt vmcnt(12)
v_mfma_f32_16x16x32_bf16 v[96:99], v[32:35], v[32:35], 0
v_mfma_f32_16x16x32_bf16 v[92:95], v[16:19], v[32:35], 0
buffer_store_dwordx4 v[32:35], v4, s[12:15], s36 offen offset:0 sc1
s_waitcnt vmcnt(11)
v_mfma_f32_16x16x32_bf16 v[104:107], v[40:43], v[40:43], 0
v_mfma_f32_16x16x32_bf16 v[100:103], v[16:19], v[40:43], 0
buffer_store_dwordx4 v[40:43], v4, s[12:15], s36 offen offset:1024 sc1
v_mfma_f32_16x16x32_bf16 v[96:99], v[36:39], v[36:39], v[96:99]
v_mfma_f32_16x16x32_bf16 v[92:95], v[16:19], v[36:39], v[92:95]
buffer_store_dwordx4 v[36:39], v4, s[12:15], s37 offen offset:0 sc1
s_waitcnt vmcnt(12)
v_mfma_f32_16x16x32_bf16 v[104:107], v[44:47], v[44:47], v[104:107]
v_mfma_f32_16x16x32_bf16 v[100:103], v[16:19], v[44:47], v[100:103]
buffer_store_dwordx4 v[44:47], v4, s[12:15], s37 offen offset:1024 sc1
s_nop 1
v_cndmask_b32 v96, v96, v97, s[46:47]
v_cndmask_b32 v98, v98, v99, s[46:47]
v_cndmask_b32 v93, v96, v98, s[48:49]
buffer_store_dwordx2 v[92:93], v253, s[4:7], s38 offen offset:0 sc1
v_cndmask_b32 v104, v104, v105, s[46:47]
v_cndmask_b32 v106, v106, v107, s[46:47]
v_cndmask_b32 v101, v104, v106, s[48:49]
buffer_store_dwordx2 v[100:101], v253, s[4:7], s38 offen offset:2048 sc1
s_waitcnt vmcnt(9)
s_barrier
ds_read_b64_tr_b16 a[188:189], v248 offset:0
ds_read_b64_tr_b16 a[190:191], v248 offset:512
ds_read_b64_tr_b16 a[192:193], v248 offset:4096
ds_read_b64_tr_b16 a[194:195], v248 offset:4608
ds_read_b64_tr_b16 a[196:197], v249 offset:32
ds_read_b64_tr_b16 a[198:199], v249 offset:544
ds_read_b64_tr_b16 a[200:201], v249 offset:4128
ds_read_b64_tr_b16 a[202:203], v249 offset:4640
ds_read_b64_tr_b16 a[204:205], v248 offset:8192
ds_read_b64_tr_b16 a[206:207], v248 offset:8704
ds_read_b64_tr_b16 a[208:209], v248 offset:12288
ds_read_b64_tr_b16 a[210:211], v248 offset:12800
s_waitcnt lgkmcnt(10)
v_mfma_f32_16x16x32_bf16 v[92:95], a[188:191], v[16:19], 0
s_waitcnt lgkmcnt(6)
v_mfma_f32_16x16x32_bf16 v[96:99], a[196:199], v[16:19], 0
s_waitcnt lgkmcnt(2)
v_mfma_f32_16x16x32_bf16 v[100:103], a[204:207], v[16:19], 0
v_mfma_f32_16x16x32_bf16 v[92:95], a[192:195], v[16:19], v[92:95]
v_mfma_f32_16x16x32_bf16 v[96:99], a[200:203], v[16:19], v[96:99]
s_waitcnt lgkmcnt(0)
v_mfma_f32_16x16x32_bf16 v[100:103], a[208:211], v[16:19], v[100:103]
buffer_store_dwordx4 a[188:191], v1, s[4:7], s96 offen offset:0 sc1
buffer_store_dwordx4 a[192:195], v1, s[4:7], s97 offen offset:0 sc1
buffer_store_dwordx4 a[196:199], v1, s[4:7], s96 offen offset:1024 sc1
buffer_store_dwordx4 a[200:203], v1, s[4:7], s97 offen offset:1024 sc1
buffer_store_dwordx4 a[204:207], v1, s[4:7], s96 offen offset:2048 sc1
buffer_store_dwordx4 a[208:211], v1, s[4:7], s97 offen offset:2048 sc1
buffer_store_dwordx4 v[92:95], v254, s[4:7], s98 offen offset:0 sc1
buffer_store_dwordx4 v[96:99], v254, s[4:7], s98 offen offset:2048 sc1
buffer_store_dwordx4 v[100:103], v254, s[4:7], s99 offen offset:0 sc1
s_mov_b32 s36, 0x9e3779b1
s_waitcnt vmcnt(17)
v_mul_lo_u32 v242, v11, s36
v_add_u32 v242, 0x7f4a7c15, v242
v_accvgpr_write_b32 a242, v242
s_and_b32 s36, s31, 1
s_lshl_b32 s36, s36, 4
s_add_u32 s36, s36, s32
s_lshl_b32 s36, s36, 2
s_add_u32 s92, s78, s36
s_add_u32 s92, s92, 0xc0000
s_lshl_b32 s36, s32, 2
s_add_u32 s93, s79, s36
s_add_u32 s93, s93, 0xc0080
s_and_b32 s94, s35, 15
s_lshl_b32 s94, s94, 9
s_lshr_b32 s36, s35, 4
s_lshl_b32 s36, s36, 2
s_add_u32 s94, s94, s36
s_add_u32 s94, s94, 0xc00c0
v_lshrrev_b32 v240, 1, v0
v_lshlrev_b32 v240, 13, v240
v_and_b32 v241, 1, v0
v_lshl_add_u32 v240, v241, 8, v240
s_mov_b32 vcc_lo, 0xffff
s_mov_b32 vcc_hi, 0
v_cndmask_b32 v240, 2.0, v240, vcc
v_lshlrev_b32 v241, 2, v0
v_add_u32 v248, 98304, v248
v_add_u32 v249, 98304, v249
s_add_u32 s96, s96, 0x600000
s_add_u32 s98, s98, 0x80000
s_add_u32 s97, s97, 0x600000
s_add_u32 s99, s99, 0x80000
v_lshrrev_b32 v11, 2, v0
v_lshlrev_b32 v250, 7, v11
v_lshl_add_u32 v250, v251, 4, v250
s_lshr_b32 s36, s28, 1
s_lshl_b32 s36, s36, 12
s_and_b32 s37, s28, 1
s_lshl_b32 s37, s37, 6
s_add_u32 s36, s36, s37
s_add_u32 s36, s36, 122880
v_add_u32 v250, s36, v250
s_and_b32 s36, s35, 15
s_lshl_b32 s36, s36, 17
s_lshr_b32 s37, s35, 4
s_lshl_b32 s37, s37, 13
s_add_u32 s36, s36, s37
s_lshl_b32 s37, s28, 11
s_add_u32 s36, s36, s37
s_add_u32 s100, s36, 0xa00000
s_add_u32 s101, s36, 0xc00000
v_lshlrev_b32 v11, 6, v11
v_lshl_add_u32 v251, v251, 3, v11
v_add_u32 v251, 139264, v251
s_mov_b32 s90, s35
s_and_b32 s36, s2, 31
s_lshl_b32 s36, s36, 2
v_mov_b32 v252, s36
v_cmp_eq_u32 vcc, 0, v10
s_nop 1
v_cndmask_b32 v252, 2.0, v252, vcc
v_and_b32 v255, 31, v0
v_lshlrev_b32 v255, 2, v255
s_waitcnt vmcnt(0)
s_barrier
s_cmp_lg_u32 s28, 1
s_cbranch_scc1 Lg1s_1
buffer_store_dword v242, v10, s[4:7], s92 offen sc1
buffer_store_dword v242, v10, s[4:7], s93 offen sc1
buffer_store_dword v242, v240, s[4:7], s94 offen sc1
Lg1s_1:
s_cmp_lg_u32 s28, 0
s_cbranch_scc1 Lg1e_3
s_cmp_eq_u32 s54, 32
s_cselect_b32 s39, 0xffff0000, -1
s_mov_b32 s38, -1
s_add_u32 s36, s67, 0xc0000
s_mov_b32 s37, 0
Lg1p_2:
v_mov_b32 v11, 0
buffer_atomic_add v11, v241, s[4:7], s36 offen sc0 sc1
s_add_u32 s37, s37, 1
s_waitcnt vmcnt(0)
v_cmp_ne_u32 vcc, v11, v242
s_nop 0
s_and_b64 vcc, vcc, s[38:39]
s_cbranch_scc0 Lg1e_3
s_cmp_lt_u32 s37, 0x100000
s_cbranch_scc1 Lg1p_2
Lg1e_3:
s_barrier
s_add_u32 s94, s71, 0x80
s_add_u32 s44, s28, 0
s_mul_i32 s45, s44, 3072
s_add_u32 m0, s45, 0
s_lshr_b32 s44, s44, 1
s_add_u32 s44, s44, 0
s_add_u32 s44, s44, s33
s_and_b32 s44, s44, 31
s_mul_i32 s44, s44, 6144
s_add_u32 s44, s44, s50
buffer_load_dwordx4 v1, s[4:7], s44 offen offset:0 sc1 lds
buffer_load_dwordx4 v1, s[4:7], s44 offen offset:1024 sc1 lds
buffer_load_dwordx4 v1, s[4:7], s44 offen offset:2048 sc1 lds
s_add_u32 s44, s28, 4
s_mul_i32 s45, s44, 3072
s_add_u32 m0, s45, 0
s_lshr_b32 s44, s44, 1
s_add_u32 s44, s44, 0
s_add_u32 s44, s44, s33
s_and_b32 s44, s44, 31
s_mul_i32 s44, s44, 6144
s_add_u32 s44, s44, s50
buffer_load_dwordx4 v1, s[4:7], s44 offen offset:0 sc1 lds
buffer_load_dwordx4 v1, s[4:7], s44 offen offset:1024 sc1 lds
buffer_load_dwordx4 v1, s[4:7], s44 offen offset:2048 sc1 lds
s_add_u32 s44, s28, 8
s_mul_i32 s45, s44, 3072
s_add_u32 m0, s45, 0
s_lshr_b32 s44, s44, 1
s_add_u32 s44, s44, 0
s_add_u32 s44, s44, s33
s_and_b32 s44, s44, 31
s_mul_i32 s44, s44, 6144
s_add_u32 s44, s44, s50
buffer_load_dwordx4 v1, s[4:7], s44 offen offset:0 sc1 lds
buffer_load_dwordx4 v1, s[4:7], s44 offen offset:1024 sc1 lds
buffer_load_dwordx4 v1, s[4:7], s44 offen offset:2048 sc1 lds
s_add_u32 s44, s28, 12
s_mul_i32 s45, s44, 3072
s_add_u32 m0, s45, 0
s_lshr_b32 s44, s44, 1
s_add_u32 s44, s44, 0
s_add_u32 s44, s44, s33
s_and_b32 s44, s44, 31
s_mul_i32 s44, s44, 6144
s_add_u32 s44, s44, s50
buffer_load_dwordx4 v1, s[4:7], s44 offen offset:0 sc1 lds
buffer_load_dwordx4 v1, s[4:7], s44 offen offset:1024 sc1 lds
buffer_load_dwordx4 v1, s[4:7], s44 offen offset:2048 sc1 lds
s_lshl_b32 s35, s33, 12
buffer_load_dwordx4 a[0:3], v2, s[40:43], s35 offen offset:0 sc1
buffer_load_dwordx4 a[4:7], v2, s[40:43], s35 offen offset:1024 sc1
buffer_load_dwordx4 a[8:11], v2, s[40:43], s35 offen offset:2048 sc1
buffer_load_dwordx4 a[12:15], v2, s[40:43], s35 offen offset:3072 sc1
s_add_u32 s35, s35, 4096
s_and_b32 s35, s35, 0x1ffff
s_mov_b32 s91, s90
s_add_u32 s63, s28, 0
s_add_u32 s63, s63, s33
s_and_b32 s63, s63, 31
s_lshl_b32 s63, s63, 12
buffer_load_dwordx4 a[64:67], v3, s[40:43], s63 offen sc1
s_mov_b32 s90, s91
buffer_load_dwordx4 a[16:19], v2, s[40:43], s35 offen offset:0 sc1
buffer_load_dwordx4 a[20:23], v2, s[40:43], s35 offen offset:1024 sc1
buffer_load_dwordx4 a[24:27], v2, s[40:43], s35 offen offset:2048 sc1
buffer_load_dwordx4 a[28:31], v2, s[40:43], s35 offen offset:3072 sc1
s_add_u32 s35, s35, 4096
s_and_b32 s35, s35, 0x1ffff
buffer_load_dwordx4 a[32:35], v2, s[40:43], s35 offen offset:0 sc1
buffer_load_dwordx4 a[36:39], v2, s[40:43], s35 offen offset:1024 sc1
buffer_load_dwordx4 a[40:43], v2, s[40:43], s35 offen offset:2048 sc1
buffer_load_dwordx4 a[44:47], v2, s[40:43], s35 offen offset:3072 sc1
s_add_u32 s35, s35, 4096
s_and_b32 s35, s35, 0x1ffff
s_mov_b64 s[20:21], s[68:69]
s_mov_b32 s22, 0x200000
s_lshr_b32 s36, s90, 4
s_lshl_b32 s36, s36, 2
s_add_u32 s36, s36, s28
s_and_b32 s37, s90, 15
s_lshl_b32 s37, s37, 7
s_lshl_b32 s38, s36, 15
s_add_u32 s38, s38, s37
s_add_u32 s39, s38, 16384
s_lshl_b32 s44, s28, 11
s_add_u32 m0, s44, 122880
s_nop 0
buffer_load_dwordx4 v237, s[20:23], s38 offen nt lds
s_add_u32 m0, s44, 123904
s_nop 0
buffer_load_dwordx4 v237, s[20:23], s39 offen nt lds
s_mov_b64 s[20:21], s[76:77]
s_add_u32 m0, s44, 131072
s_nop 0
buffer_load_dwordx4 v237, s[20:23], s38 offen nt lds
s_add_u32 m0, s44, 132096
s_nop 0
buffer_load_dwordx4 v237, s[20:23], s39 offen nt lds
s_mov_b64 s[20:21], s[72:73]
s_mov_b32 s22, 0x600000
s_mul_i32 s36, s36, 98304
s_add_u32 s36, s36, s37
s_add_u32 m0, s44, 98304
s_add_u32 s38, s36, 0
buffer_load_dwordx4 v235, s[20:23], s38 offen nt lds
s_add_u32 m0, s44, 99328
s_add_u32 s38, s36, 49152
buffer_load_dwordx4 v235, s[20:23], s38 offen nt lds
s_add_u32 m0, s44, 106496
s_add_u32 s38, s36, 2048
buffer_load_dwordx4 v235, s[20:23], s38 offen nt lds
s_add_u32 m0, s44, 107520
s_add_u32 s38, s36, 51200
buffer_load_dwordx4 v235, s[20:23], s38 offen nt lds
s_add_u32 m0, s44, 114688
s_add_u32 s38, s36, 4096
buffer_load_dwordx4 v235, s[20:23], s38 offen nt lds
s_add_u32 m0, s44, 115712
s_add_u32 s38, s36, 53248
buffer_load_dwordx4 v235, s[20:23], s38 offen nt lds
s_mov_b64 s[20:21], s[74:75]
s_mov_b32 s22, 0x10000
s_and_b32 s36, s28, 1
s_lshl_b32 s36, s36, 10
s_add_u32 m0, s36, 139264
s_lshl_b32 s37, s30, 11
s_add_u32 s36, s36, s37
buffer_load_dwordx4 v1, s[20:23], s36 offen lds
s_waitcnt vmcnt(24)
s_barrier
v_add_u32 v5, 0, v1
v_add_u32 v6, s55, v5
ds_read_b128 a[96:99], v5 offset:0
ds_read_b128 a[100:103], v5 offset:1024
ds_read_b128 a[104:107], v5 offset:2048
ds_read_b128 a[108:111], v5 offset:3072
ds_read_b128 a[112:115], v5 offset:4096
ds_read_b128 a[116:119], v5 offset:5120
ds_read_b128 a[120:123], v6 offset:2048
s_waitcnt vmcnt(19) lgkmcnt(0)
v_mfma_f32_16x16x32_bf16 v[132:135], a[96:99], a[0:3], 0
s_add_u32 s44, s28, 0
s_mul_i32 s45, s44, 3072
s_add_u32 m0, s45, 49152
v_mfma_f32_16x16x32_bf16 v[156:159], a[96:99], a[4:7], 0
buffer_load_dwordx4 a[48:51], v2, s[40:43], s35 offen offset:0 sc1
s_lshr_b32 s44, s44, 1
v_mfma_f32_16x16x32_bf16 v[180:183], a[96:99], a[8:11], 0
s_add_u32 s44, s44, 8
s_add_u32 s44, s44, s33
s_and_b32 s44, s44, 31
v_mfma_f32_16x16x32_bf16 v[204:207], a[96:99], a[12:15], 0
s_mul_i32 s44, s44, 6144
s_add_u32 s44, s44, s50
v_mfma_f32_16x16x32_bf16 v[208:211], a[100:103], a[12:15], 0
buffer_load_dwordx4 v1, s[4:7], s44 offen offset:0 sc1 lds
v_mfma_f32_16x16x32_bf16 v[184:187], a[100:103], a[8:11], 0
ds_read_b128 a[128:131], v5 offset:6144
v_mfma_f32_16x16x32_bf16 v[160:163], a[100:103], a[4:7], 0
ds_read_b128 a[132:135], v5 offset:7168
v_mfma_f32_16x16x32_bf16 v[136:139], a[100:103], a[0:3], 0
buffer_load_dwordx4 a[52:55], v2, s[40:43], s35 offen offset:1024 sc1
v_mfma_f32_16x16x32_bf16 v[140:143], a[104:107], a[0:3], 0
ds_read_b128 a[136:139], v5 offset:8192
v_mfma_f32_16x16x32_bf16 v[164:167], a[104:107], a[4:7], 0
ds_read_b128 a[140:143], v5 offset:9216
v_mfma_f32_16x16x32_bf16 v[188:191], a[104:107], a[8:11], 0
buffer_load_dwordx4 v1, s[4:7], s44 offen offset:1024 sc1 lds
v_mfma_f32_16x16x32_bf16 v[212:215], a[104:107], a[12:15], 0
ds_read_b128 a[144:147], v5 offset:10240
v_mfma_f32_16x16x32_bf16 v[216:219], a[108:111], a[12:15], 0
ds_read_b128 a[148:151], v5 offset:11264
v_mfma_f32_16x16x32_bf16 v[192:195], a[108:111], a[8:11], 0
buffer_load_dwordx4 a[56:59], v2, s[40:43], s35 offen offset:2048 sc1
v_mfma_f32_16x16x32_bf16 v[168:171], a[108:111], a[4:7], 0
ds_read_b128 a[152:155], v6 offset:3072
v_mfma_f32_16x16x32_bf16 v[144:147], a[108:111], a[0:3], 0
v_mfma_f32_16x16x32_bf16 v[148:151], a[112:115], a[0:3], 0
buffer_load_dwordx4 v1, s[4:7], s44 offen offset:2048 sc1 lds
s_add_u32 s63, s28, 4
v_mfma_f32_16x16x32_bf16 v[172:175], a[112:115], a[4:7], 0
s_add_u32 s63, s63, s33
s_and_b32 s63, s63, 31
s_lshl_b32 s63, s63, 12
v_mfma_f32_16x16x32_bf16 v[196:199], a[112:115], a[8:11], 0
v_mfma_f32_16x16x32_bf16 v[220:223], a[112:115], a[12:15], 0
buffer_load_dwordx4 a[68:71], v3, s[40:43], s63 offen sc1
s_add_u32 s44, s28, 4
v_mfma_f32_16x16x32_bf16 v[224:227], a[116:119], a[12:15], 0
s_mul_i32 s45, s44, 3072
s_add_u32 m0, s45, 49152
s_lshr_b32 s44, s44, 1
v_mfma_f32_16x16x32_bf16 v[200:203], a[116:119], a[8:11], 0
s_add_u32 s44, s44, 8
s_add_u32 s44, s44, s33
s_and_b32 s44, s44, 31
v_mfma_f32_16x16x32_bf16 v[176:179], a[116:119], a[4:7], 0
buffer_load_dwordx4 a[60:63], v2, s[40:43], s35 offen offset:3072 sc1
s_add_u32 s35, s35, 4096
v_mfma_f32_16x16x32_bf16 v[152:155], a[116:119], a[0:3], 0
s_and_b32 s35, s35, 0x1ffff
s_mul_i32 s44, s44, 6144
s_add_u32 s44, s44, s50
v_mfma_f32_16x16x32_bf16 a[80:83], a[120:123], a[64:67], 0
s_waitcnt vmcnt(23) lgkmcnt(0)
v_mfma_f32_16x16x32_bf16 v[132:135], a[128:131], a[16:19], v[132:135]
ds_read_b128 a[96:99], v5 offset:12288
v_mfma_f32_16x16x32_bf16 v[156:159], a[128:131], a[20:23], v[156:159]
buffer_load_dwordx4 a[0:3], v2, s[40:43], s35 offen offset:0 sc1
v_mfma_f32_16x16x32_bf16 v[180:183], a[128:131], a[24:27], v[180:183]
ds_read_b128 a[100:103], v5 offset:13312
v_mfma_f32_16x16x32_bf16 v[204:207], a[128:131], a[28:31], v[204:207]
v_mfma_f32_16x16x32_bf16 v[208:211], a[132:135], a[28:31], v[208:211]
ds_read_b128 a[104:107], v5 offset:14336
v_mfma_f32_16x16x32_bf16 v[184:187], a[132:135], a[24:27], v[184:187]
buffer_load_dwordx4 v1, s[4:7], s44 offen offset:0 sc1 lds
v_mfma_f32_16x16x32_bf16 v[160:163], a[132:135], a[20:23], v[160:163]
ds_read_b128 a[108:111], v5 offset:15360
v_mfma_f32_16x16x32_bf16 v[136:139], a[132:135], a[16:19], v[136:139]
v_mfma_f32_16x16x32_bf16 v[140:143], a[136:139], a[16:19], v[140:143]
v_mfma_f32_16x16x32_bf16 v[164:167], a[136:139], a[20:23], v[164:167]
buffer_load_dwordx4 a[4:7], v2, s[40:43], s35 offen offset:1024 sc1
v_mfma_f32_16x16x32_bf16 v[188:191], a[136:139], a[24:27], v[188:191]
ds_read_b128 a[112:115], v5 offset:16384
v_mfma_f32_16x16x32_bf16 v[212:215], a[136:139], a[28:31], v[212:215]
ds_read_b128 a[116:119], v5 offset:17408
v_mfma_f32_16x16x32_bf16 v[216:219], a[140:143], a[28:31], v[216:219]
v_mfma_f32_16x16x32_bf16 v[192:195], a[140:143], a[24:27], v[192:195]
buffer_load_dwordx4 a[8:11], v2, s[40:43], s35 offen offset:2048 sc1
v_mfma_f32_16x16x32_bf16 v[168:171], a[140:143], a[20:23], v[168:171]
ds_read_b128 a[120:123], v6 offset:4096
v_mfma_f32_16x16x32_bf16 v[144:147], a[140:143], a[16:19], v[144:147]
v_mfma_f32_16x16x32_bf16 v[148:151], a[144:147], a[16:19], v[148:151]
v_mfma_f32_16x16x32_bf16 v[172:175], a[144:147], a[20:23], v[172:175]
buffer_load_dwordx4 v1, s[4:7], s44 offen offset:1024 sc1 lds
v_mfma_f32_16x16x32_bf16 v[196:199], a[144:147], a[24:27], v[196:199]
v_mfma_f32_16x16x32_bf16 v[220:223], a[144:147], a[28:31], v[220:223]
v_mfma_f32_16x16x32_bf16 v[224:227], a[148:151], a[28:31], v[224:227]
v_mfma_f32_16x16x32_bf16 v[200:203], a[148:151], a[24:27], v[200:203]
buffer_load_dwordx4 a[12:15], v2, s[40:43], s35 offen offset:3072 sc1
s_add_u32 s35, s35, 4096
v_mfma_f32_16x16x32_bf16 v[176:179], a[148:151], a[20:23], v[176:179]
s_and_b32 s35, s35, 0x1ffff
v_mfma_f32_16x16x32_bf16 v[152:155], a[148:151], a[16:19], v[152:155]
v_mfma_f32_16x16x32_bf16 a[84:87], a[152:155], a[64:67], 0
s_waitcnt vmcnt(25) lgkmcnt(0)
v_mfma_f32_16x16x32_bf16 v[132:135], a[96:99], a[32:35], v[132:135]
ds_read_b128 a[128:131], v5 offset:18432
v_mfma_f32_16x16x32_bf16 v[156:159], a[96:99], a[36:39], v[156:159]
buffer_load_dwordx4 a[16:19], v2, s[40:43], s35 offen offset:0 sc1
v_mfma_f32_16x16x32_bf16 v[180:183], a[96:99], a[40:43], v[180:183]
ds_read_b128 a[132:135], v5 offset:19456
v_mfma_f32_16x16x32_bf16 v[204:207], a[96:99], a[44:47], v[204:207]
v_mfma_f32_16x16x32_bf16 v[208:211], a[100:103], a[44:47], v[208:211]
buffer_load_dwordx4 v1, s[4:7], s44 offen offset:2048 sc1 lds
s_add_u32 s44, s28, 8
v_mfma_f32_16x16x32_bf16 v[184:187], a[100:103], a[40:43], v[184:187]
s_mul_i32 s45, s44, 3072
s_add_u32 m0, s45, 49152
s_lshr_b32 s44, s44, 1
v_mfma_f32_16x16x32_bf16 v[160:163], a[100:103], a[36:39], v[160:163]
s_add_u32 s44, s44, 8
s_add_u32 s44, s44, s33
s_and_b32 s44, s44, 31
v_mfma_f32_16x16x32_bf16 v[136:139], a[100:103], a[32:35], v[136:139]
s_mul_i32 s44, s44, 6144
s_add_u32 s44, s44, s50
v_mfma_f32_16x16x32_bf16 v[140:143], a[104:107], a[32:35], v[140:143]
buffer_load_dwordx4 a[20:23], v2, s[40:43], s35 offen offset:1024 sc1
v_mfma_f32_16x16x32_bf16 v[164:167], a[104:107], a[36:39], v[164:167]
ds_read_b128 a[136:139], v5 offset:20480
v_mfma_f32_16x16x32_bf16 v[188:191], a[104:107], a[40:43], v[188:191]
ds_read_b128 a[140:143], v5 offset:21504
v_mfma_f32_16x16x32_bf16 v[212:215], a[104:107], a[44:47], v[212:215]
buffer_load_dwordx4 v1, s[4:7], s44 offen offset:0 sc1 lds
v_mfma_f32_16x16x32_bf16 v[216:219], a[108:111], a[44:47], v[216:219]
ds_read_b128 a[144:147], v5 offset:22528
v_mfma_f32_16x16x32_bf16 v[192:195], a[108:111], a[40:43], v[192:195]
ds_read_b128 a[148:151], v5 offset:23552
v_mfma_f32_16x16x32_bf16 v[168:171], a[108:111], a[36:39], v[168:171]
ds_read_b128 a[152:155], v6 offset:5120
v_mfma_f32_16x16x32_bf16 v[144:147], a[108:111], a[32:35], v[144:147]
buffer_load_dwordx4 a[24:27], v2, s[40:43], s35 offen offset:2048 sc1
v_mfma_f32_16x16x32_bf16 v[148:151], a[112:115], a[32:35], v[148:151]
v_mfma_f32_16x16x32_bf16 v[172:175], a[112:115], a[36:39], v[172:175]
v_mfma_f32_16x16x32_bf16 v[196:199], a[112:115], a[40:43], v[196:199]
buffer_load_dwordx4 v1, s[4:7], s44 offen offset:1024 sc1 lds
v_mfma_f32_16x16x32_bf16 v[220:223], a[112:115], a[44:47], v[220:223]
v_mfma_f32_16x16x32_bf16 v[224:227], a[116:119], a[44:47], v[224:227]
v_mfma_f32_16x16x32_bf16 v[200:203], a[116:119], a[40:43], v[200:203]
v_mfma_f32_16x16x32_bf16 v[176:179], a[116:119], a[36:39], v[176:179]
buffer_load_dwordx4 a[28:31], v2, s[40:43], s35 offen offset:3072 sc1
s_add_u32 s35, s35, 4096
v_mfma_f32_16x16x32_bf16 v[152:155], a[116:119], a[32:35], v[152:155]
s_and_b32 s35, s35, 0x1ffff
v_mfma_f32_16x16x32_bf16 a[88:91], a[120:123], a[64:67], 0
s_waitcnt vmcnt(13) lgkmcnt(0)
s_barrier
v_mfma_f32_16x16x32_bf16 v[132:135], a[128:131], a[48:51], v[132:135]
ds_read_b128 a[96:99], v5 offset:24576
v_mfma_f32_16x16x32_bf16 v[156:159], a[128:131], a[52:55], v[156:159]
buffer_load_dwordx4 a[32:35], v2, s[40:43], s35 offen offset:0 sc1
v_mfma_f32_16x16x32_bf16 v[180:183], a[128:131], a[56:59], v[180:183]
ds_read_b128 a[100:103], v5 offset:25600
v_mfma_f32_16x16x32_bf16 v[204:207], a[128:131], a[60:63], v[204:207]
ds_read_b64_tr_b16 a[212:213], v250 offset:0
v_mfma_f32_16x16x32_bf16 v[208:211], a[132:135], a[60:63], v[208:211]
ds_read_b128 a[104:107], v5 offset:26624
v_mfma_f32_16x16x32_bf16 v[184:187], a[132:135], a[56:59], v[184:187]
buffer_load_dwordx4 v1, s[4:7], s44 offen offset:2048 sc1 lds
s_add_u32 s44, s28, 12
v_mfma_f32_16x16x32_bf16 v[160:163], a[132:135], a[52:55], v[160:163]
s_mul_i32 s45, s44, 3072
s_add_u32 m0, s45, 49152
s_lshr_b32 s44, s44, 1
v_mfma_f32_16x16x32_bf16 v[136:139], a[132:135], a[48:51], v[136:139]
s_add_u32 s44, s44, 8
s_add_u32 s44, s44, s33
s_and_b32 s44, s44, 31
v_mfma_f32_16x16x32_bf16 v[140:143], a[136:139], a[48:51], v[140:143]
s_mul_i32 s44, s44, 6144
s_add_u32 s44, s44, s50
v_mfma_f32_16x16x32_bf16 v[164:167], a[136:139], a[52:55], v[164:167]
buffer_load_dwordx4 a[36:39], v2, s[40:43], s35 offen offset:1024 sc1
v_mfma_f32_16x16x32_bf16 v[188:191], a[136:139], a[56:59], v[188:191]
ds_read_b128 a[108:111], v5 offset:27648
v_mfma_f32_16x16x32_bf16 v[212:215], a[136:139], a[60:63], v[212:215]
ds_read_b128 a[112:115], v5 offset:28672
v_mfma_f32_16x16x32_bf16 v[216:219], a[140:143], a[60:63], v[216:219]
ds_read_b128 a[116:119], v5 offset:29696
v_mfma_f32_16x16x32_bf16 v[192:195], a[140:143], a[56:59], v[192:195]
buffer_load_dwordx4 a[40:43], v2, s[40:43], s35 offen offset:2048 sc1
v_mfma_f32_16x16x32_bf16 v[168:171], a[140:143], a[52:55], v[168:171]
ds_read_b128 a[120:123], v6 offset:26624
v_mfma_f32_16x16x32_bf16 v[144:147], a[140:143], a[48:51], v[144:147]
ds_read_b64_tr_b16 a[214:215], v250 offset:2048
v_mfma_f32_16x16x32_bf16 v[148:151], a[144:147], a[48:51], v[148:151]
ds_read_b64_tr_b16 a[216:217], v250 offset:8
v_mfma_f32_16x16x32_bf16 v[172:175], a[144:147], a[52:55], v[172:175]
buffer_load_dwordx4 v1, s[4:7], s44 offen offset:0 sc1 lds
v_mfma_f32_16x16x32_bf16 v[196:199], a[144:147], a[56:59], v[196:199]
ds_read_b64_tr_b16 a[218:219], v250 offset:2056
v_mfma_f32_16x16x32_bf16 v[220:223], a[144:147], a[60:63], v[220:223]
ds_read_b64_tr_b16 a[220:221], v250 offset:8192
v_mfma_f32_16x16x32_bf16 v[224:227], a[148:151], a[60:63], v[224:227]
ds_read_b64_tr_b16 a[222:223], v250 offset:10240
v_mfma_f32_16x16x32_bf16 v[200:203], a[148:151], a[56:59], v[200:203]
buffer_load_dwordx4 a[44:47], v2, s[40:43], s35 offen offset:3072 sc1
s_add_u32 s35, s35, 4096
v_mfma_f32_16x16x32_bf16 v[176:179], a[148:151], a[52:55], v[176:179]
s_and_b32 s35, s35, 0x1ffff
v_mfma_f32_16x16x32_bf16 v[152:155], a[148:151], a[48:51], v[152:155]
ds_read_b64_tr_b16 a[224:225], v250 offset:8200
v_mfma_f32_16x16x32_bf16 a[92:95], a[152:155], a[64:67], 0
s_waitcnt vmcnt(13) lgkmcnt(6)
v_mfma_f32_16x16x32_bf16 v[132:135], a[96:99], a[0:3], v[132:135]
ds_read_b128 a[128:131], v5 offset:30720
v_mfma_f32_16x16x32_bf16 v[156:159], a[96:99], a[4:7], v[156:159]
buffer_load_dwordx4 a[48:51], v2, s[40:43], s35 offen offset:0 sc1
v_mfma_f32_16x16x32_bf16 v[180:183], a[96:99], a[8:11], v[180:183]
ds_read_b128 a[132:135], v5 offset:31744
v_mfma_f32_16x16x32_bf16 v[204:207], a[96:99], a[12:15], v[204:207]
ds_read_b64_tr_b16 a[226:227], v250 offset:10248
v_mfma_f32_16x16x32_bf16 v[208:211], a[100:103], a[12:15], v[208:211]
buffer_load_dwordx4 v1, s[4:7], s44 offen offset:1024 sc1 lds
v_mfma_f32_16x16x32_bf16 v[184:187], a[100:103], a[8:11], v[184:187]
ds_read_b128 a[136:139], v5 offset:32768
v_mfma_f32_16x16x32_bf16 v[160:163], a[100:103], a[4:7], v[160:163]
ds_read_b128 a[140:143], v5 offset:33792
v_mfma_f32_16x16x32_bf16 v[136:139], a[100:103], a[0:3], v[136:139]
buffer_load_dwordx4 a[52:55], v2, s[40:43], s35 offen offset:1024 sc1
v_mfma_f32_16x16x32_bf16 v[140:143], a[104:107], a[0:3], v[140:143]
ds_read_b64_tr_b16 a[232:233], v251 offset:0
v_mfma_f32_16x16x32_bf16 v[164:167], a[104:107], a[4:7], v[164:167]
ds_read_b128 a[144:147], v5 offset:34816
v_mfma_f32_16x16x32_bf16 v[188:191], a[104:107], a[8:11], v[188:191]
buffer_load_dwordx4 v1, s[4:7], s44 offen offset:2048 sc1 lds
v_mfma_f32_16x16x32_bf16 v[212:215], a[104:107], a[12:15], v[212:215]
v_and_b32 v232, 15, v0
v_lshlrev_b32 v232, 7, v232
v_mfma_f32_16x16x32_bf16 v[216:219], a[108:111], a[12:15], v[216:219]
v_lshrrev_b32 v233, 4, v0
v_lshlrev_b32 v233, 4, v233
v_mfma_f32_16x16x32_bf16 v[192:195], a[108:111], a[8:11], v[192:195]
buffer_load_dwordx4 a[56:59], v2, s[40:43], s35 offen offset:2048 sc1
v_mfma_f32_16x16x32_bf16 v[168:171], a[108:111], a[4:7], v[168:171]
v_add_u32 v232, v233, v232
s_mul_i32 s38, s30, 12288
v_mfma_f32_16x16x32_bf16 v[144:147], a[108:111], a[0:3], v[144:147]
s_add_u32 s38, s38, 0x300000
s_add_u32 s39, s28, 4
s_min_u32 s39, s39, 5
s_lshl_b32 s36, s28, 11
s_add_u32 s36, s36, s38
s_lshl_b32 s37, s39, 11
s_add_u32 s37, s37, s38
v_mfma_f32_16x16x32_bf16 v[148:151], a[112:115], a[0:3], v[148:151]
buffer_load_dwordx4 v[48:51], v232, s[4:7], s36 offen sc1
s_add_u32 s63, s28, 8
v_mfma_f32_16x16x32_bf16 v[172:175], a[112:115], a[4:7], v[172:175]
s_add_u32 s63, s63, s33
s_and_b32 s63, s63, 31
s_lshl_b32 s63, s63, 12
v_mfma_f32_16x16x32_bf16 v[196:199], a[112:115], a[8:11], v[196:199]
ds_read_b128 a[148:151], v5 offset:35840
v_mfma_f32_16x16x32_bf16 v[220:223], a[112:115], a[12:15], v[220:223]
buffer_load_dwordx4 a[72:75], v3, s[40:43], s63 offen sc1
v_mfma_f32_16x16x32_bf16 v[224:227], a[116:119], a[12:15], v[224:227]
ds_read_b128 a[152:155], v6 offset:27648
v_mfma_f32_16x16x32_bf16 v[200:203], a[116:119], a[8:11], v[200:203]
ds_read_b64_tr_b16 a[234:235], v251 offset:1024
v_mfma_f32_16x16x32_bf16 v[176:179], a[116:119], a[4:7], v[176:179]
buffer_load_dwordx4 a[60:63], v2, s[40:43], s35 offen offset:3072 sc1
s_add_u32 s35, s35, 4096
v_mfma_f32_16x16x32_bf16 v[152:155], a[116:119], a[0:3], v[152:155]
s_and_b32 s35, s35, 0x1ffff
ds_read_b64_tr_b16 a[236:237], v251 offset:32
v_mfma_f32_16x16x32_bf16 a[80:83], a[120:123], a[68:71], a[80:83]
ds_read_b64_tr_b16 a[238:239], v251 offset:1056
s_waitcnt vmcnt(14) lgkmcnt(3)
v_mfma_f32_16x16x32_bf16 v[132:135], a[128:131], a[16:19], v[132:135]
ds_read_b128 a[96:99], v5 offset:36864
v_mfma_f32_16x16x32_bf16 v[156:159], a[128:131], a[20:23], v[156:159]
buffer_load_dwordx4 a[0:3], v2, s[40:43], s35 offen offset:0 sc1
v_mfma_f32_16x16x32_bf16 v[180:183], a[128:131], a[24:27], v[180:183]
ds_read_b128 a[100:103], v5 offset:37888
v_mfma_f32_16x16x32_bf16 v[204:207], a[128:131], a[28:31], v[204:207]
ds_read_b64_tr_b16 a[188:189], v248 offset:0
v_mfma_f32_16x16x32_bf16 v[208:211], a[132:135], a[28:31], v[208:211]
ds_read_b128 a[104:107], v5 offset:38912
v_mfma_f32_16x16x32_bf16 v[184:187], a[132:135], a[24:27], v[184:187]
ds_read_b64_tr_b16 a[190:191], v248 offset:512
v_mfma_f32_16x16x32_bf16 v[160:163], a[132:135], a[20:23], v[160:163]
buffer_load_dwordx4 a[4:7], v2, s[40:43], s35 offen offset:1024 sc1
v_mfma_f32_16x16x32_bf16 v[136:139], a[132:135], a[16:19], v[136:139]
ds_read_b128 a[108:111], v5 offset:39936
v_mfma_f32_16x16x32_bf16 v[140:143], a[136:139], a[16:19], v[140:143]
ds_read_b64_tr_b16 a[192:193], v248 offset:4096
v_mfma_f32_16x16x32_bf16 v[164:167], a[136:139], a[20:23], v[164:167]
ds_read_b128 a[112:115], v5 offset:40960
v_mfma_f32_16x16x32_bf16 v[188:191], a[136:139], a[24:27], v[188:191]
ds_read_b64_tr_b16 a[194:195], v248 offset:4608
v_mfma_f32_16x16x32_bf16 v[212:215], a[136:139], a[28:31], v[212:215]
buffer_load_dwordx4 v[52:55], v232, s[4:7], s37 offen sc1
v_mfma_f32_16x16x32_bf16 v[216:219], a[140:143], a[28:31], v[216:219]
ds_read_b128 a[116:119], v5 offset:41984
v_mfma_f32_16x16x32_bf16 v[192:195], a[140:143], a[24:27], v[192:195]
ds_read_b128 a[120:123], v6 offset:28672
v_mfma_f32_16x16x32_bf16 v[168:171], a[140:143], a[20:23], v[168:171]
ds_read_b64_tr_b16 a[196:197], v249 offset:32
v_mfma_f32_16x16x32_bf16 v[144:147], a[140:143], a[16:19], v[144:147]
ds_read_b64_tr_b16 a[198:199], v249 offset:544
v_mfma_f32_16x16x32_bf16 v[148:151], a[144:147], a[16:19], v[148:151]
buffer_load_dwordx4 a[8:11], v2, s[40:43], s35 offen offset:2048 sc1
v_mfma_f32_16x16x32_bf16 v[172:175], a[144:147], a[20:23], v[172:175]
v_mfma_f32_16x16x32_bf16 v[196:199], a[144:147], a[24:27], v[196:199]
v_mfma_f32_16x16x32_bf16 v[220:223], a[144:147], a[28:31], v[220:223]
ds_read_b64_tr_b16 a[200:201], v249 offset:4128
v_mfma_f32_16x16x32_bf16 v[224:227], a[148:151], a[28:31], v[224:227]
v_mfma_f32_16x16x32_bf16 v[200:203], a[148:151], a[24:27], v[200:203]
buffer_load_dwordx4 a[12:15], v2, s[40:43], s35 offen offset:3072 sc1
s_add_u32 s35, s35, 4096
v_mfma_f32_16x16x32_bf16 v[176:179], a[148:151], a[20:23], v[176:179]
s_and_b32 s35, s35, 0x1ffff
ds_read_b64_tr_b16 a[202:203], v249 offset:4640
v_mfma_f32_16x16x32_bf16 v[152:155], a[148:151], a[16:19], v[152:155]
v_mfma_f32_16x16x32_bf16 a[84:87], a[152:155], a[68:71], a[84:87]
s_waitcnt vmcnt(13) lgkmcnt(4)
v_mfma_f32_16x16x32_bf16 v[132:135], a[96:99], a[32:35], v[132:135]
ds_read_b128 a[128:131], v5 offset:43008
v_mfma_f32_16x16x32_bf16 v[156:159], a[96:99], a[36:39], v[156:159]
buffer_load_dwordx4 a[16:19], v2, s[40:43], s35 offen offset:0 sc1
v_mfma_f32_16x16x32_bf16 v[180:183], a[96:99], a[40:43], v[180:183]
ds_read_b128 a[132:135], v5 offset:44032
v_mfma_f32_16x16x32_bf16 v[204:207], a[96:99], a[44:47], v[204:207]
ds_read_b64_tr_b16 a[204:205], v248 offset:8192
v_mfma_f32_16x16x32_bf16 v[208:211], a[100:103], a[44:47], v[208:211]
buffer_store_dwordx4 a[212:215], v1, s[4:7], s100 offen offset:0 sc1
v_mfma_f32_16x16x32_bf16 v[184:187], a[100:103], a[40:43], v[184:187]
ds_read_b128 a[136:139], v5 offset:45056
v_mfma_f32_16x16x32_bf16 v[160:163], a[100:103], a[36:39], v[160:163]
ds_read_b128 a[140:143], v5 offset:46080
v_mfma_f32_16x16x32_bf16 v[136:139], a[100:103], a[32:35], v[136:139]
ds_read_b64_tr_b16 a[206:207], v248 offset:8704
v_mfma_f32_16x16x32_bf16 v[140:143], a[104:107], a[32:35], v[140:143]
v_mfma_f32_16x16x32_bf16 v[164:167], a[104:107], a[36:39], v[164:167]
ds_read_b128 a[144:147], v5 offset:47104
v_mfma_f32_16x16x32_bf16 v[188:191], a[104:107], a[40:43], v[188:191]
buffer_load_dwordx4 a[20:23], v2, s[40:43], s35 offen offset:1024 sc1
v_mfma_f32_16x16x32_bf16 v[212:215], a[104:107], a[44:47], v[212:215]
ds_read_b128 a[148:151], v5 offset:48128
v_mfma_f32_16x16x32_bf16 v[216:219], a[108:111], a[44:47], v[216:219]
ds_read_b64_tr_b16 a[208:209], v248 offset:12288
v_mfma_f32_16x16x32_bf16 v[192:195], a[108:111], a[40:43], v[192:195]
buffer_load_dwordx4 a[24:27], v2, s[40:43], s35 offen offset:2048 sc1
v_mfma_f32_16x16x32_bf16 v[168:171], a[108:111], a[36:39], v[168:171]
ds_read_b128 a[152:155], v6 offset:29696
v_mfma_f32_16x16x32_bf16 v[144:147], a[108:111], a[32:35], v[144:147]
ds_read_b64_tr_b16 a[210:211], v248 offset:12800
v_mfma_f32_16x16x32_bf16 v[148:151], a[112:115], a[32:35], v[148:151]
buffer_store_dwordx4 a[216:219], v1, s[4:7], s100 offen offset:1024 sc1
s_add_u32 s44, s28, 0
v_mfma_f32_16x16x32_bf16 v[172:175], a[112:115], a[36:39], v[172:175]
s_mul_i32 s45, s44, 3072
s_add_u32 m0, s45, 98304
s_lshr_b32 s44, s44, 1
v_mfma_f32_16x16x32_bf16 v[196:199], a[112:115], a[40:43], v[196:199]
s_add_u32 s44, s44, 16
s_add_u32 s44, s44, s33
s_and_b32 s44, s44, 31
v_mfma_f32_16x16x32_bf16 v[220:223], a[112:115], a[44:47], v[220:223]
s_mul_i32 s44, s44, 6144
s_add_u32 s44, s44, s50
v_mfma_f32_16x16x32_bf16 v[224:227], a[116:119], a[44:47], v[224:227]
v_mfma_f32_16x16x32_bf16 v[200:203], a[116:119], a[40:43], v[200:203]
v_mfma_f32_16x16x32_bf16 v[176:179], a[116:119], a[36:39], v[176:179]
buffer_load_dwordx4 a[28:31], v2, s[40:43], s35 offen offset:3072 sc1
s_add_u32 s35, s35, 4096
v_mfma_f32_16x16x32_bf16 v[152:155], a[116:119], a[32:35], v[152:155]
s_and_b32 s35, s35, 0x1ffff
v_mfma_f32_16x16x32_bf16 a[88:91], a[120:123], a[68:71], a[88:91]
s_waitcnt vmcnt(11) lgkmcnt(0)
s_barrier
v_mfma_f32_16x16x32_bf16 v[132:135], a[128:131], a[48:51], v[132:135]
v_add_u32 v5, 49152, v1
v_add_u32 v6, s55, v5
v_mfma_f32_16x16x32_bf16 v[156:159], a[128:131], a[52:55], v[156:159]
buffer_load_dwordx4 a[32:35], v2, s[40:43], s35 offen offset:0 sc1
v_mfma_f32_16x16x32_bf16 v[180:183], a[128:131], a[56:59], v[180:183]
ds_read_b128 a[96:99], v5 offset:0
v_mfma_f32_16x16x32_bf16 v[204:207], a[128:131], a[60:63], v[204:207]
ds_read_b128 a[100:103], v5 offset:1024
v_mfma_f32_16x16x32_bf16 v[208:211], a[132:135], a[60:63], v[208:211]
buffer_load_dwordx4 v1, s[4:7], s44 offen offset:0 sc1 lds
v_mfma_f32_16x16x32_bf16 v[184:187], a[132:135], a[56:59], v[184:187]
ds_read_b128 a[104:107], v5 offset:2048
v_mfma_f32_16x16x32_bf16 v[160:163], a[132:135], a[52:55], v[160:163]
ds_read_b128 a[108:111], v5 offset:3072
v_mfma_f32_16x16x32_bf16 v[136:139], a[132:135], a[48:51], v[136:139]
v_mfma_f32_16x16x32_bf16 v[140:143], a[136:139], a[48:51], v[140:143]
buffer_load_dwordx4 a[36:39], v2, s[40:43], s35 offen offset:1024 sc1
v_mfma_f32_16x16x32_bf16 v[164:167], a[136:139], a[52:55], v[164:167]
ds_read_b128 a[112:115], v5 offset:4096
v_mfma_f32_16x16x32_bf16 v[188:191], a[136:139], a[56:59], v[188:191]
v_mfma_f32_16x16x32_bf16 v[212:215], a[136:139], a[60:63], v[212:215]
buffer_load_dwordx4 v1, s[4:7], s44 offen offset:1024 sc1 lds
v_mfma_f32_16x16x32_bf16 v[216:219], a[140:143], a[60:63], v[216:219]
ds_read_b128 a[116:119], v5 offset:5120
v_mfma_f32_16x16x32_bf16 v[192:195], a[140:143], a[56:59], v[192:195]
ds_read_b128 a[120:123], v6 offset:2048
v_mfma_f32_16x16x32_bf16 v[168:171], a[140:143], a[52:55], v[168:171]
v_mfma_f32_16x16x32_bf16 v[144:147], a[140:143], a[48:51], v[144:147]
buffer_load_dwordx4 a[40:43], v2, s[40:43], s35 offen offset:2048 sc1
v_mfma_f32_16x16x32_bf16 v[148:151], a[144:147], a[48:51], v[148:151]
v_mfma_f32_16x16x32_bf16 v[172:175], a[144:147], a[52:55], v[172:175]
v_mfma_f32_16x16x32_bf16 v[196:199], a[144:147], a[56:59], v[196:199]
buffer_load_dwordx4 v1, s[4:7], s44 offen offset:2048 sc1 lds
s_add_u32 s44, s28, 4
v_mfma_f32_16x16x32_bf16 v[220:223], a[144:147], a[60:63], v[220:223]
s_mul_i32 s45, s44, 3072
s_add_u32 m0, s45, 98304
s_lshr_b32 s44, s44, 1
v_mfma_f32_16x16x32_bf16 v[224:227], a[148:151], a[60:63], v[224:227]
s_add_u32 s44, s44, 16
s_add_u32 s44, s44, s33
s_and_b32 s44, s44, 31
v_mfma_f32_16x16x32_bf16 v[200:203], a[148:151], a[56:59], v[200:203]
s_mul_i32 s44, s44, 6144
s_add_u32 s44, s44, s50
v_mfma_f32_16x16x32_bf16 v[176:179], a[148:151], a[52:55], v[176:179]
buffer_load_dwordx4 a[44:47], v2, s[40:43], s35 offen offset:3072 sc1
s_add_u32 s35, s35, 4096
v_mfma_f32_16x16x32_bf16 v[152:155], a[148:151], a[48:51], v[152:155]
s_and_b32 s35, s35, 0x1ffff
v_mfma_f32_16x16x32_bf16 a[92:95], a[152:155], a[68:71], a[92:95]
s_waitcnt vmcnt(13) lgkmcnt(0)
v_mfma_f32_16x16x32_bf16 v[132:135], a[96:99], a[0:3], v[132:135]
ds_read_b128 a[128:131], v5 offset:6144
v_mfma_f32_16x16x32_bf16 v[156:159], a[96:99], a[4:7], v[156:159]
buffer_load_dwordx4 a[48:51], v2, s[40:43], s35 offen offset:0 sc1
v_mfma_f32_16x16x32_bf16 v[180:183], a[96:99], a[8:11], v[180:183]
ds_read_b128 a[132:135], v5 offset:7168
v_mfma_f32_16x16x32_bf16 v[204:207], a[96:99], a[12:15], v[204:207]
v_mfma_f32_16x16x32_bf16 v[236:239], a[188:191], v[16:19], 0
v_mfma_f32_16x16x32_bf16 v[208:211], a[100:103], a[12:15], v[208:211]
buffer_load_dwordx4 v1, s[4:7], s44 offen offset:0 sc1 lds
v_mfma_f32_16x16x32_bf16 v[184:187], a[100:103], a[8:11], v[184:187]
ds_read_b128 a[136:139], v5 offset:8192
v_mfma_f32_16x16x32_bf16 v[160:163], a[100:103], a[4:7], v[160:163]
ds_read_b128 a[140:143], v5 offset:9216
v_mfma_f32_16x16x32_bf16 v[136:139], a[100:103], a[0:3], v[136:139]
v_mfma_f32_16x16x32_bf16 v[240:243], a[196:199], v[16:19], 0
v_mfma_f32_16x16x32_bf16 v[140:143], a[104:107], a[0:3], v[140:143]
buffer_load_dwordx4 a[52:55], v2, s[40:43], s35 offen offset:1024 sc1
v_mfma_f32_16x16x32_bf16 v[164:167], a[104:107], a[4:7], v[164:167]
ds_read_b128 a[144:147], v5 offset:10240
v_mfma_f32_16x16x32_bf16 v[188:191], a[104:107], a[8:11], v[188:191]
v_mfma_f32_16x16x32_bf16 v[244:247], a[204:207], v[16:19], 0
v_mfma_f32_16x16x32_bf16 v[212:215], a[104:107], a[12:15], v[212:215]
buffer_load_dwordx4 v1, s[4:7], s44 offen offset:1024 sc1 lds
s_add_u32 s63, s28, 12
v_mfma_f32_16x16x32_bf16 v[216:219], a[108:111], a[12:15], v[216:219]
s_add_u32 s63, s63, s33
s_and_b32 s63, s63, 31
s_lshl_b32 s63, s63, 12
v_mfma_f32_16x16x32_bf16 v[192:195], a[108:111], a[8:11], v[192:195]
ds_read_b128 a[148:151], v5 offset:11264
v_mfma_f32_16x16x32_bf16 v[168:171], a[108:111], a[4:7], v[168:171]
ds_read_b128 a[152:155], v6 offset:3072
v_mfma_f32_16x16x32_bf16 v[144:147], a[108:111], a[0:3], v[144:147]
buffer_load_dwordx4 a[56:59], v2, s[40:43], s35 offen offset:2048 sc1
v_mfma_f32_16x16x32_bf16 v[148:151], a[112:115], a[0:3], v[148:151]
v_mfma_f32_16x16x32_bf16 v[236:239], a[192:195], v[16:19], v[236:239]
v_mfma_f32_16x16x32_bf16 v[172:175], a[112:115], a[4:7], v[172:175]
v_mfma_f32_16x16x32_bf16 v[240:243], a[200:203], v[16:19], v[240:243]
v_mfma_f32_16x16x32_bf16 v[196:199], a[112:115], a[8:11], v[196:199]
buffer_load_dwordx4 a[64:67], v3, s[40:43], s63 offen sc1
v_mfma_f32_16x16x32_bf16 v[220:223], a[112:115], a[12:15], v[220:223]
v_mfma_f32_16x16x32_bf16 v[224:227], a[116:119], a[12:15], v[224:227]
v_mfma_f32_16x16x32_bf16 v[244:247], a[208:211], v[16:19], v[244:247]
v_mfma_f32_16x16x32_bf16 v[200:203], a[116:119], a[8:11], v[200:203]
v_mfma_f32_16x16x32_bf16 v[176:179], a[116:119], a[4:7], v[176:179]
buffer_load_dwordx4 a[60:63], v2, s[40:43], s35 offen offset:3072 sc1
s_add_u32 s35, s35, 4096
v_mfma_f32_16x16x32_bf16 v[152:155], a[116:119], a[0:3], v[152:155]
s_and_b32 s35, s35, 0x1ffff
v_mfma_f32_16x16x32_bf16 a[80:83], a[120:123], a[72:75], a[80:83]
s_waitcnt vmcnt(14) lgkmcnt(0)
v_mfma_f32_16x16x32_bf16 v[132:135], a[128:131], a[16:19], v[132:135]
ds_read_b128 a[96:99], v5 offset:12288
v_mfma_f32_16x16x32_bf16 v[156:159], a[128:131], a[20:23], v[156:159]
buffer_load_dwordx4 a[0:3], v2, s[40:43], s35 offen offset:0 sc1
v_mfma_f32_16x16x32_bf16 v[180:183], a[128:131], a[24:27], v[180:183]
ds_read_b128 a[100:103], v5 offset:13312
v_mfma_f32_16x16x32_bf16 v[204:207], a[128:131], a[28:31], v[204:207]
v_mfma_f32_16x16x32_bf16 v[208:211], a[132:135], a[28:31], v[208:211]
buffer_load_dwordx4 v1, s[4:7], s44 offen offset:2048 sc1 lds
s_add_u32 s44, s28, 8
v_mfma_f32_16x16x32_bf16 v[184:187], a[132:135], a[24:27], v[184:187]
s_mul_i32 s45, s44, 3072
s_add_u32 m0, s45, 98304
s_lshr_b32 s44, s44, 1
v_mfma_f32_16x16x32_bf16 v[160:163], a[132:135], a[20:23], v[160:163]
s_add_u32 s44, s44, 16
s_add_u32 s44, s44, s33
s_and_b32 s44, s44, 31
v_mfma_f32_16x16x32_bf16 v[136:139], a[132:135], a[16:19], v[136:139]
s_mul_i32 s44, s44, 6144
s_add_u32 s44, s44, s50
v_mfma_f32_16x16x32_bf16 v[140:143], a[136:139], a[16:19], v[140:143]
buffer_load_dwordx4 a[4:7], v2, s[40:43], s35 offen offset:1024 sc1
v_mfma_f32_16x16x32_bf16 v[164:167], a[136:139], a[20:23], v[164:167]
ds_read_b128 a[104:107], v5 offset:14336
v_mfma_f32_16x16x32_bf16 v[188:191], a[136:139], a[24:27], v[188:191]
ds_read_b128 a[108:111], v5 offset:15360
v_mfma_f32_16x16x32_bf16 v[212:215], a[136:139], a[28:31], v[212:215]
buffer_load_dwordx4 v1, s[4:7], s44 offen offset:0 sc1 lds
v_mfma_f32_16x16x32_bf16 v[216:219], a[140:143], a[28:31], v[216:219]
ds_read_b128 a[112:115], v5 offset:16384
v_mfma_f32_16x16x32_bf16 v[192:195], a[140:143], a[24:27], v[192:195]
ds_read_b128 a[116:119], v5 offset:17408
v_mfma_f32_16x16x32_bf16 v[168:171], a[140:143], a[20:23], v[168:171]
ds_read_b128 a[120:123], v6 offset:4096
v_mfma_f32_16x16x32_bf16 v[144:147], a[140:143], a[16:19], v[144:147]
buffer_load_dwordx4 a[8:11], v2, s[40:43], s35 offen offset:2048 sc1
v_mfma_f32_16x16x32_bf16 v[148:151], a[144:147], a[16:19], v[148:151]
v_mfma_f32_16x16x32_bf16 v[172:175], a[144:147], a[20:23], v[172:175]
v_mfma_f32_16x16x32_bf16 v[196:199], a[144:147], a[24:27], v[196:199]
buffer_load_dwordx4 v1, s[4:7], s44 offen offset:1024 sc1 lds
v_mfma_f32_16x16x32_bf16 v[220:223], a[144:147], a[28:31], v[220:223]
v_mfma_f32_16x16x32_bf16 v[224:227], a[148:151], a[28:31], v[224:227]
v_mfma_f32_16x16x32_bf16 v[200:203], a[148:151], a[24:27], v[200:203]
v_mfma_f32_16x16x32_bf16 v[176:179], a[148:151], a[20:23], v[176:179]
buffer_load_dwordx4 a[12:15], v2, s[40:43], s35 offen offset:3072 sc1
s_add_u32 s35, s35, 4096
v_mfma_f32_16x16x32_bf16 v[152:155], a[148:151], a[16:19], v[152:155]
s_and_b32 s35, s35, 0x1ffff
v_mfma_f32_16x16x32_bf16 a[84:87], a[152:155], a[72:75], a[84:87]
s_waitcnt vmcnt(14) lgkmcnt(0)
v_mfma_f32_16x16x32_bf16 v[132:135], a[96:99], a[32:35], v[132:135]
ds_read_b128 a[128:131], v5 offset:18432
v_mfma_f32_16x16x32_bf16 v[156:159], a[96:99], a[36:39], v[156:159]
buffer_load_dwordx4 a[16:19], v2, s[40:43], s35 offen offset:0 sc1
v_mfma_f32_16x16x32_bf16 v[180:183], a[96:99], a[40:43], v[180:183]
ds_read_b128 a[132:135], v5 offset:19456
v_mfma_f32_16x16x32_bf16 v[204:207], a[96:99], a[44:47], v[204:207]
v_mfma_f32_16x16x32_bf16 v[208:211], a[100:103], a[44:47], v[208:211]
ds_read_b128 a[136:139], v5 offset:20480
v_mfma_f32_16x16x32_bf16 v[184:187], a[100:103], a[40:43], v[184:187]
buffer_load_dwordx4 v1, s[4:7], s44 offen offset:2048 sc1 lds
s_add_u32 s44, s28, 12
v_mfma_f32_16x16x32_bf16 v[160:163], a[100:103], a[36:39], v[160:163]
s_mul_i32 s45, s44, 3072
s_add_u32 m0, s45, 98304
s_lshr_b32 s44, s44, 1
v_mfma_f32_16x16x32_bf16 v[136:139], a[100:103], a[32:35], v[136:139]
s_add_u32 s44, s44, 16
s_add_u32 s44, s44, s33
s_and_b32 s44, s44, 31
v_mfma_f32_16x16x32_bf16 v[140:143], a[104:107], a[32:35], v[140:143]
s_mul_i32 s44, s44, 6144
s_add_u32 s44, s44, s50
v_mfma_f32_16x16x32_bf16 v[164:167], a[104:107], a[36:39], v[164:167]
buffer_load_dwordx4 a[20:23], v2, s[40:43], s35 offen offset:1024 sc1
v_mfma_f32_16x16x32_bf16 v[188:191], a[104:107], a[40:43], v[188:191]
ds_read_b128 a[140:143], v5 offset:21504
v_mfma_f32_16x16x32_bf16 v[212:215], a[104:107], a[44:47], v[212:215]
ds_read_b128 a[144:147], v5 offset:22528
v_mfma_f32_16x16x32_bf16 v[216:219], a[108:111], a[44:47], v[216:219]
ds_read_b128 a[148:151], v5 offset:23552
v_mfma_f32_16x16x32_bf16 v[192:195], a[108:111], a[40:43], v[192:195]
buffer_load_dwordx4 a[24:27], v2, s[40:43], s35 offen offset:2048 sc1
v_mfma_f32_16x16x32_bf16 v[168:171], a[108:111], a[36:39], v[168:171]
ds_read_b128 a[152:155], v6 offset:5120
v_mfma_f32_16x16x32_bf16 v[144:147], a[108:111], a[32:35], v[144:147]
v_mfma_f32_16x16x32_bf16 v[148:151], a[112:115], a[32:35], v[148:151]
v_mfma_f32_16x16x32_bf16 v[172:175], a[112:115], a[36:39], v[172:175]
buffer_load_dwordx4 v1, s[4:7], s44 offen offset:0 sc1 lds
v_mfma_f32_16x16x32_bf16 v[196:199], a[112:115], a[40:43], v[196:199]
v_mfma_f32_16x16x32_bf16 v[220:223], a[112:115], a[44:47], v[220:223]
v_mfma_f32_16x16x32_bf16 v[224:227], a[116:119], a[44:47], v[224:227]
v_mfma_f32_16x16x32_bf16 v[200:203], a[116:119], a[40:43], v[200:203]
buffer_load_dwordx4 a[28:31], v2, s[40:43], s35 offen offset:3072 sc1
s_add_u32 s35, s35, 4096
v_mfma_f32_16x16x32_bf16 v[176:179], a[116:119], a[36:39], v[176:179]
s_and_b32 s35, s35, 0x1ffff
v_mfma_f32_16x16x32_bf16 v[152:155], a[116:119], a[32:35], v[152:155]
v_mfma_f32_16x16x32_bf16 a[88:91], a[120:123], a[72:75], a[88:91]
s_waitcnt vmcnt(13) lgkmcnt(0)
v_mfma_f32_16x16x32_bf16 v[132:135], a[128:131], a[48:51], v[132:135]
ds_read_b128 a[96:99], v5 offset:24576
v_mfma_f32_16x16x32_bf16 v[156:159], a[128:131], a[52:55], v[156:159]
buffer_load_dwordx4 a[32:35], v2, s[40:43], s35 offen offset:0 sc1
v_mfma_f32_16x16x32_bf16 v[180:183], a[128:131], a[56:59], v[180:183]
ds_read_b128 a[100:103], v5 offset:25600
v_mfma_f32_16x16x32_bf16 v[204:207], a[128:131], a[60:63], v[204:207]
v_mfma_f32_16x16x32_bf16 v[208:211], a[132:135], a[60:63], v[208:211]
buffer_load_dwordx4 v1, s[4:7], s44 offen offset:1024 sc1 lds
v_mfma_f32_16x16x32_bf16 v[184:187], a[132:135], a[56:59], v[184:187]
ds_read_b128 a[104:107], v5 offset:26624
v_mfma_f32_16x16x32_bf16 v[160:163], a[132:135], a[52:55], v[160:163]
ds_read_b128 a[108:111], v5 offset:27648
v_mfma_f32_16x16x32_bf16 v[136:139], a[132:135], a[48:51], v[136:139]
v_mfma_f32_16x16x32_bf16 v[140:143], a[136:139], a[48:51], v[140:143]
buffer_load_dwordx4 a[36:39], v2, s[40:43], s35 offen offset:1024 sc1
v_mfma_f32_16x16x32_bf16 v[164:167], a[136:139], a[52:55], v[164:167]
ds_read_b128 a[112:115], v5 offset:28672
v_mfma_f32_16x16x32_bf16 v[188:191], a[136:139], a[56:59], v[188:191]
v_mfma_f32_16x16x32_bf16 v[212:215], a[136:139], a[60:63], v[212:215]
buffer_load_dwordx4 v1, s[4:7], s44 offen offset:2048 sc1 lds
s_add_u32 s88, s82, 0x200000
v_mfma_f32_16x16x32_bf16 v[216:219], a[140:143], a[60:63], v[216:219]
ds_read_b128 a[116:119], v5 offset:29696
v_mfma_f32_16x16x32_bf16 v[192:195], a[140:143], a[56:59], v[192:195]
ds_read_b128 a[120:123], v6 offset:26624
v_mfma_f32_16x16x32_bf16 v[168:171], a[140:143], a[52:55], v[168:171]
v_mfma_f32_16x16x32_bf16 v[144:147], a[140:143], a[48:51], v[144:147]
buffer_load_dwordx4 a[40:43], v2, s[40:43], s35 offen offset:2048 sc1
v_mfma_f32_16x16x32_bf16 v[148:151], a[144:147], a[48:51], v[148:151]
v_mfma_f32_16x16x32_bf16 v[172:175], a[144:147], a[52:55], v[172:175]
v_mfma_f32_16x16x32_bf16 v[196:199], a[144:147], a[56:59], v[196:199]
buffer_load_dwordx4 v[92:95], v1, s[4:7], s88 offen offset:0 sc1
v_mfma_f32_16x16x32_bf16 v[220:223], a[144:147], a[60:63], v[220:223]
v_mfma_f32_16x16x32_bf16 v[224:227], a[148:151], a[60:63], v[224:227]
v_mfma_f32_16x16x32_bf16 v[200:203], a[148:151], a[56:59], v[200:203]
v_mfma_f32_16x16x32_bf16 v[176:179], a[148:151], a[52:55], v[176:179]
buffer_load_dwordx4 a[44:47], v2, s[40:43], s35 offen offset:3072 sc1
s_add_u32 s35, s35, 4096
v_mfma_f32_16x16x32_bf16 v[152:155], a[148:151], a[48:51], v[152:155]
s_and_b32 s35, s35, 0x1ffff
v_mfma_f32_16x16x32_bf16 a[92:95], a[152:155], a[72:75], a[92:95]
s_waitcnt vmcnt(13) lgkmcnt(0)
v_mfma_f32_16x16x32_bf16 v[132:135], a[96:99], a[0:3], v[132:135]
ds_read_b128 a[128:131], v5 offset:30720
v_add_f32_dpp v48, v48, v48 row_ror:8 row_mask:0xf bank_mask:0xf
v_mfma_f32_16x16x32_bf16 v[156:159], a[96:99], a[4:7], v[156:159]
buffer_load_dwordx4 a[48:51], v2, s[40:43], s35 offen offset:0 sc1
v_mfma_f32_16x16x32_bf16 v[180:183], a[96:99], a[8:11], v[180:183]
ds_read_b128 a[132:135], v5 offset:31744
v_add_f32_dpp v49, v49, v49 row_ror:8 row_mask:0xf bank_mask:0xf
v_mfma_f32_16x16x32_bf16 v[204:207], a[96:99], a[12:15], v[204:207]
v_add_f32_dpp v50, v50, v50 row_ror:8 row_mask:0xf bank_mask:0xf
v_add_f32_dpp v51, v51, v51 row_ror:8 row_mask:0xf bank_mask:0xf
v_mfma_f32_16x16x32_bf16 v[208:211], a[100:103], a[12:15], v[208:211]
buffer_load_dwordx4 v[96:99], v1, s[4:7], s88 offen offset:1024 sc1
v_mfma_f32_16x16x32_bf16 v[184:187], a[100:103], a[8:11], v[184:187]
ds_read_b128 a[136:139], v5 offset:32768
v_add_f32_dpp v52, v52, v52 row_ror:8 row_mask:0xf bank_mask:0xf
v_mfma_f32_16x16x32_bf16 v[160:163], a[100:103], a[4:7], v[160:163]
ds_read_b128 a[140:143], v5 offset:33792
v_add_f32_dpp v53, v53, v53 row_ror:8 row_mask:0xf bank_mask:0xf
v_mfma_f32_16x16x32_bf16 v[136:139], a[100:103], a[0:3], v[136:139]
v_add_f32_dpp v54, v54, v54 row_ror:8 row_mask:0xf bank_mask:0xf
v_add_f32_dpp v55, v55, v55 row_ror:8 row_mask:0xf bank_mask:0xf
v_mfma_f32_16x16x32_bf16 v[140:143], a[104:107], a[0:3], v[140:143]
buffer_load_dwordx4 a[52:55], v2, s[40:43], s35 offen offset:1024 sc1
v_mfma_f32_16x16x32_bf16 v[164:167], a[104:107], a[4:7], v[164:167]
ds_read_b128 a[144:147], v5 offset:34816
v_add_f32_dpp v48, v48, v48 row_ror:4 row_mask:0xf bank_mask:0xf
v_mfma_f32_16x16x32_bf16 v[188:191], a[104:107], a[8:11], v[188:191]
v_add_f32_dpp v49, v49, v49 row_ror:4 row_mask:0xf bank_mask:0xf
v_add_f32_dpp v50, v50, v50 row_ror:4 row_mask:0xf bank_mask:0xf
v_mfma_f32_16x16x32_bf16 v[212:215], a[104:107], a[12:15], v[212:215]
buffer_load_dwordx4 v[100:103], v1, s[4:7], s88 offen offset:2048 sc1
s_add_u32 s63, s28, 16
v_mfma_f32_16x16x32_bf16 v[216:219], a[108:111], a[12:15], v[216:219]
s_add_u32 s63, s63, s33
s_and_b32 s63, s63, 31
s_lshl_b32 s63, s63, 12
v_mfma_f32_16x16x32_bf16 v[192:195], a[108:111], a[8:11], v[192:195]
ds_read_b128 a[148:151], v5 offset:35840
v_add_f32_dpp v51, v51, v51 row_ror:4 row_mask:0xf bank_mask:0xf
v_mfma_f32_16x16x32_bf16 v[168:171], a[108:111], a[4:7], v[168:171]
ds_read_b128 a[152:155], v6 offset:27648
v_add_f32_dpp v52, v52, v52 row_ror:4 row_mask:0xf bank_mask:0xf
v_mfma_f32_16x16x32_bf16 v[144:147], a[108:111], a[0:3], v[144:147]
buffer_load_dwordx4 a[56:59], v2, s[40:43], s35 offen offset:2048 sc1
v_mfma_f32_16x16x32_bf16 v[148:151], a[112:115], a[0:3], v[148:151]
v_add_f32_dpp v53, v53, v53 row_ror:4 row_mask:0xf bank_mask:0xf
v_add_f32_dpp v54, v54, v54 row_ror:4 row_mask:0xf bank_mask:0xf
v_mfma_f32_16x16x32_bf16 v[172:175], a[112:115], a[4:7], v[172:175]
v_add_f32_dpp v55, v55, v55 row_ror:4 row_mask:0xf bank_mask:0xf
v_add_f32_dpp v48, v48, v48 row_ror:2 row_mask:0xf bank_mask:0xf
v_mfma_f32_16x16x32_bf16 v[196:199], a[112:115], a[8:11], v[196:199]
buffer_load_dwordx4 a[68:71], v3, s[40:43], s63 offen sc1
v_mfma_f32_16x16x32_bf16 v[220:223], a[112:115], a[12:15], v[220:223]
v_add_f32_dpp v49, v49, v49 row_ror:2 row_mask:0xf bank_mask:0xf
v_add_f32_dpp v50, v50, v50 row_ror:2 row_mask:0xf bank_mask:0xf
v_mfma_f32_16x16x32_bf16 v[224:227], a[116:119], a[12:15], v[224:227]
v_add_f32_dpp v51, v51, v51 row_ror:2 row_mask:0xf bank_mask:0xf
v_add_f32_dpp v52, v52, v52 row_ror:2 row_mask:0xf bank_mask:0xf
v_mfma_f32_16x16x32_bf16 v[200:203], a[116:119], a[8:11], v[200:203]
v_add_f32_dpp v53, v53, v53 row_ror:2 row_mask:0xf bank_mask:0xf
v_add_f32_dpp v54, v54, v54 row_ror:2 row_mask:0xf bank_mask:0xf
v_mfma_f32_16x16x32_bf16 v[176:179], a[116:119], a[4:7], v[176:179]
buffer_load_dwordx4 a[60:63], v2, s[40:43], s35 offen offset:3072 sc1
s_add_u32 s35, s35, 4096
v_mfma_f32_16x16x32_bf16 v[152:155], a[116:119], a[0:3], v[152:155]
s_and_b32 s35, s35, 0x1ffff
v_add_f32_dpp v55, v55, v55 row_ror:2 row_mask:0xf bank_mask:0xf
v_mfma_f32_16x16x32_bf16 a[80:83], a[120:123], a[64:67], a[80:83]
v_add_f32_dpp v48, v48, v48 row_ror:1 row_mask:0xf bank_mask:0xf
s_waitcnt vmcnt(14) lgkmcnt(0)
v_mfma_f32_16x16x32_bf16 v[132:135], a[128:131], a[16:19], v[132:135]
ds_read_b128 a[96:99], v5 offset:36864
v_add_f32_dpp v49, v49, v49 row_ror:1 row_mask:0xf bank_mask:0xf
v_mfma_f32_16x16x32_bf16 v[156:159], a[128:131], a[20:23], v[156:159]
buffer_load_dwordx4 a[0:3], v2, s[40:43], s35 offen offset:0 sc1
v_mfma_f32_16x16x32_bf16 v[180:183], a[128:131], a[24:27], v[180:183]
ds_read_b128 a[100:103], v5 offset:37888
v_add_f32_dpp v50, v50, v50 row_ror:1 row_mask:0xf bank_mask:0xf
v_mfma_f32_16x16x32_bf16 v[204:207], a[128:131], a[28:31], v[204:207]
v_add_f32_dpp v51, v51, v51 row_ror:1 row_mask:0xf bank_mask:0xf
v_add_f32_dpp v52, v52, v52 row_ror:1 row_mask:0xf bank_mask:0xf
v_mfma_f32_16x16x32_bf16 v[208:211], a[132:135], a[28:31], v[208:211]
buffer_load_dwordx4 v[104:107], v1, s[4:7], s88 offen offset:3072 sc1
s_add_u32 s88, s88, 4096
v_mfma_f32_16x16x32_bf16 v[184:187], a[132:135], a[24:27], v[184:187]
ds_read_b128 a[104:107], v5 offset:38912
v_add_f32_dpp v53, v53, v53 row_ror:1 row_mask:0xf bank_mask:0xf
v_mfma_f32_16x16x32_bf16 v[160:163], a[132:135], a[20:23], v[160:163]
ds_read_b128 a[108:111], v5 offset:39936
v_add_f32_dpp v54, v54, v54 row_ror:1 row_mask:0xf bank_mask:0xf
v_mfma_f32_16x16x32_bf16 v[136:139], a[132:135], a[16:19], v[136:139]
v_add_f32_dpp v55, v55, v55 row_ror:1 row_mask:0xf bank_mask:0xf
v_add_u32 v233, 147456, v233
v_mfma_f32_16x16x32_bf16 v[140:143], a[136:139], a[16:19], v[140:143]
buffer_load_dwordx4 a[4:7], v2, s[40:43], s35 offen offset:1024 sc1
s_lshl_b32 s36, s28, 6
v_mfma_f32_16x16x32_bf16 v[164:167], a[136:139], a[20:23], v[164:167]
ds_read_b128 a[112:115], v5 offset:40960
s_lshl_b32 s37, s39, 6
v_mfma_f32_16x16x32_bf16 v[188:191], a[136:139], a[24:27], v[188:191]
v_add_u32 v232, s36, v233
v_add_u32 v235, s37, v233
v_mfma_f32_16x16x32_bf16 v[212:215], a[136:139], a[28:31], v[212:215]
buffer_load_dwordx4 v[108:111], v1, s[4:7], s88 offen offset:0 sc1
v_mfma_f32_16x16x32_bf16 v[216:219], a[140:143], a[28:31], v[216:219]
ds_read_b128 a[116:119], v5 offset:41984
v_mfma_f32_16x16x32_bf16 v[192:195], a[140:143], a[24:27], v[192:195]
ds_read_b128 a[120:123], v6 offset:28672
v_mfma_f32_16x16x32_bf16 v[168:171], a[140:143], a[20:23], v[168:171]
v_mfma_f32_16x16x32_bf16 v[144:147], a[140:143], a[16:19], v[144:147]
buffer_load_dwordx4 a[8:11], v2, s[40:43], s35 offen offset:2048 sc1
v_mfma_f32_16x16x32_bf16 v[148:151], a[144:147], a[16:19], v[148:151]
v_mfma_f32_16x16x32_bf16 v[172:175], a[144:147], a[20:23], v[172:175]
v_mfma_f32_16x16x32_bf16 v[196:199], a[144:147], a[24:27], v[196:199]
buffer_load_dwordx4 v[112:115], v1, s[4:7], s88 offen offset:1024 sc1
v_mfma_f32_16x16x32_bf16 v[220:223], a[144:147], a[28:31], v[220:223]
v_mfma_f32_16x16x32_bf16 v[224:227], a[148:151], a[28:31], v[224:227]
v_mfma_f32_16x16x32_bf16 v[200:203], a[148:151], a[24:27], v[200:203]
v_mfma_f32_16x16x32_bf16 v[176:179], a[148:151], a[20:23], v[176:179]
buffer_load_dwordx4 a[12:15], v2, s[40:43], s35 offen offset:3072 sc1
s_add_u32 s35, s35, 4096
v_mfma_f32_16x16x32_bf16 v[152:155], a[148:151], a[16:19], v[152:155]
s_and_b32 s35, s35, 0x1ffff
v_mfma_f32_16x16x32_bf16 a[84:87], a[152:155], a[64:67], a[84:87]
s_waitcnt vmcnt(14) lgkmcnt(0)
v_mfma_f32_16x16x32_bf16 v[132:135], a[96:99], a[32:35], v[132:135]
ds_read_b128 a[128:131], v5 offset:43008
v_mfma_f32_16x16x32_bf16 v[156:159], a[96:99], a[36:39], v[156:159]
buffer_load_dwordx4 a[16:19], v2, s[40:43], s35 offen offset:0 sc1
v_mfma_f32_16x16x32_bf16 v[180:183], a[96:99], a[40:43], v[180:183]
ds_read_b128 a[132:135], v5 offset:44032
v_mfma_f32_16x16x32_bf16 v[204:207], a[96:99], a[44:47], v[204:207]
ds_write_b128 v232, v[48:51]
v_mfma_f32_16x16x32_bf16 v[208:211], a[100:103], a[44:47], v[208:211]
ds_read_b128 a[136:139], v5 offset:45056
v_mfma_f32_16x16x32_bf16 v[184:187], a[100:103], a[40:43], v[184:187]
buffer_load_dwordx4 v[116:119], v1, s[4:7], s88 offen offset:2048 sc1
v_mfma_f32_16x16x32_bf16 v[160:163], a[100:103], a[36:39], v[160:163]
ds_read_b128 a[140:143], v5 offset:46080
v_mfma_f32_16x16x32_bf16 v[136:139], a[100:103], a[32:35], v[136:139]
ds_write_b128 v235, v[52:55]
v_mfma_f32_16x16x32_bf16 v[140:143], a[104:107], a[32:35], v[140:143]
v_mfma_f32_16x16x32_bf16 v[164:167], a[104:107], a[36:39], v[164:167]
buffer_load_dwordx4 a[20:23], v2, s[40:43], s35 offen offset:1024 sc1
v_mfma_f32_16x16x32_bf16 v[188:191], a[104:107], a[40:43], v[188:191]
ds_read_b128 a[144:147], v5 offset:47104
v_mfma_f32_16x16x32_bf16 v[212:215], a[104:107], a[44:47], v[212:215]
ds_read_b128 a[148:151], v5 offset:48128
v_mfma_f32_16x16x32_bf16 v[216:219], a[108:111], a[44:47], v[216:219]
v_mfma_f32_16x16x32_bf16 v[192:195], a[108:111], a[40:43], v[192:195]
buffer_load_dwordx4 a[24:27], v2, s[40:43], s35 offen offset:2048 sc1
v_mfma_f32_16x16x32_bf16 v[168:171], a[108:111], a[36:39], v[168:171]
ds_read_b128 a[152:155], v6 offset:29696
v_mfma_f32_16x16x32_bf16 v[144:147], a[108:111], a[32:35], v[144:147]
v_mfma_f32_16x16x32_bf16 v[148:151], a[112:115], a[32:35], v[148:151]
v_mfma_f32_16x16x32_bf16 v[172:175], a[112:115], a[36:39], v[172:175]
buffer_load_dwordx4 v[120:123], v1, s[4:7], s88 offen offset:3072 sc1
s_add_u32 s88, s83, 0x200000
v_mfma_f32_16x16x32_bf16 v[196:199], a[112:115], a[40:43], v[196:199]
v_mfma_f32_16x16x32_bf16 v[220:223], a[112:115], a[44:47], v[220:223]
v_mfma_f32_16x16x32_bf16 v[224:227], a[116:119], a[44:47], v[224:227]
v_mfma_f32_16x16x32_bf16 v[200:203], a[116:119], a[40:43], v[200:203]
buffer_load_dwordx4 a[28:31], v2, s[40:43], s35 offen offset:3072 sc1
s_add_u32 s35, s35, 4096
v_mfma_f32_16x16x32_bf16 v[176:179], a[116:119], a[36:39], v[176:179]
s_and_b32 s35, s35, 0x1ffff
v_mfma_f32_16x16x32_bf16 v[152:155], a[116:119], a[32:35], v[152:155]
v_mfma_f32_16x16x32_bf16 a[88:91], a[120:123], a[64:67], a[88:91]
s_waitcnt vmcnt(13) lgkmcnt(0)
s_barrier
v_mfma_f32_16x16x32_bf16 v[132:135], a[128:131], a[48:51], v[132:135]
v_add_u32 v5, 98304, v1
v_add_u32 v6, s55, v5
v_mfma_f32_16x16x32_bf16 v[156:159], a[128:131], a[52:55], v[156:159]
buffer_load_dwordx4 a[32:35], v2, s[40:43], s35 offen offset:0 sc1
v_mfma_f32_16x16x32_bf16 v[180:183], a[128:131], a[56:59], v[180:183]
ds_read_b128 a[96:99], v5 offset:0
v_mfma_f32_16x16x32_bf16 v[204:207], a[128:131], a[60:63], v[204:207]
ds_read_b128 a[100:103], v5 offset:1024
v_mfma_f32_16x16x32_bf16 v[208:211], a[132:135], a[60:63], v[208:211]
buffer_load_dwordx4 v[124:127], v1, s[4:7], s88 offen offset:0 sc1
v_mfma_f32_16x16x32_bf16 v[184:187], a[132:135], a[56:59], v[184:187]
ds_read_b128 a[104:107], v5 offset:2048
v_mfma_f32_16x16x32_bf16 v[160:163], a[132:135], a[52:55], v[160:163]
ds_read_b128 a[108:111], v5 offset:3072
v_mfma_f32_16x16x32_bf16 v[136:139], a[132:135], a[48:51], v[136:139]
buffer_load_dwordx4 a[36:39], v2, s[40:43], s35 offen offset:1024 sc1
v_mfma_f32_16x16x32_bf16 v[140:143], a[136:139], a[48:51], v[140:143]
ds_read_b128 v[48:51], v233 offset:0
v_mfma_f32_16x16x32_bf16 v[164:167], a[136:139], a[52:55], v[164:167]
ds_read_b128 a[112:115], v5 offset:4096
v_mfma_f32_16x16x32_bf16 v[188:191], a[136:139], a[56:59], v[188:191]
buffer_load_dwordx4 v[128:131], v1, s[4:7], s88 offen offset:1024 sc1
v_mfma_f32_16x16x32_bf16 v[212:215], a[136:139], a[60:63], v[212:215]
ds_read_b128 a[116:119], v5 offset:5120
v_mfma_f32_16x16x32_bf16 v[216:219], a[140:143], a[60:63], v[216:219]
ds_read_b128 v[52:55], v233 offset:64
v_mfma_f32_16x16x32_bf16 v[192:195], a[140:143], a[56:59], v[192:195]
buffer_load_dwordx4 a[40:43], v2, s[40:43], s35 offen offset:2048 sc1
v_mfma_f32_16x16x32_bf16 v[168:171], a[140:143], a[52:55], v[168:171]
ds_read_b128 a[120:123], v6 offset:2048
v_mfma_f32_16x16x32_bf16 v[144:147], a[140:143], a[48:51], v[144:147]
v_mfma_f32_16x16x32_bf16 v[148:151], a[144:147], a[48:51], v[148:151]
buffer_atomic_add v12, v252, s[16:19], 0 offen sc1
s_add_u32 s44, s28, 0
v_mfma_f32_16x16x32_bf16 v[172:175], a[144:147], a[52:55], v[172:175]
s_mul_i32 s45, s44, 3072
s_add_u32 m0, s45, 0
s_lshr_b32 s44, s44, 1
v_mfma_f32_16x16x32_bf16 v[196:199], a[144:147], a[56:59], v[196:199]
s_add_u32 s44, s44, 24
s_add_u32 s44, s44, s33
s_and_b32 s44, s44, 31
s_mul_i32 s44, s44, 6144
s_add_u32 s44, s44, s50
v_mfma_f32_16x16x32_bf16 v[220:223], a[144:147], a[60:63], v[220:223]
buffer_load_dwordx4 v1, s[4:7], s44 offen offset:0 sc1 lds
v_mfma_f32_16x16x32_bf16 v[224:227], a[148:151], a[60:63], v[224:227]
ds_read_b128 v[56:59], v233 offset:128
v_mfma_f32_16x16x32_bf16 v[200:203], a[148:151], a[56:59], v[200:203]
v_mfma_f32_16x16x32_bf16 v[176:179], a[148:151], a[52:55], v[176:179]
buffer_load_dwordx4 a[44:47], v2, s[40:43], s35 offen offset:3072 sc1
s_add_u32 s35, s35, 4096
v_mfma_f32_16x16x32_bf16 v[152:155], a[148:151], a[48:51], v[152:155]
s_and_b32 s35, s35, 0x1ffff
v_mfma_f32_16x16x32_bf16 a[92:95], a[152:155], a[64:67], a[92:95]
s_waitcnt vmcnt(14) lgkmcnt(1)
v_mfma_f32_16x16x32_bf16 v[132:135], a[96:99], a[0:3], v[132:135]
ds_read_b128 a[128:131], v5 offset:6144
v_mfma_f32_16x16x32_bf16 v[156:159], a[96:99], a[4:7], v[156:159]
buffer_load_dwordx4 a[48:51], v2, s[40:43], s35 offen offset:0 sc1
v_mfma_f32_16x16x32_bf16 v[180:183], a[96:99], a[8:11], v[180:183]
ds_read_b128 a[132:135], v5 offset:7168
v_mfma_f32_16x16x32_bf16 v[204:207], a[96:99], a[12:15], v[204:207]
ds_read_b128 v[60:63], v233 offset:192
v_mfma_f32_16x16x32_bf16 v[208:211], a[100:103], a[12:15], v[208:211]
buffer_load_dwordx4 v1, s[4:7], s44 offen offset:1024 sc1 lds
v_mfma_f32_16x16x32_bf16 v[184:187], a[100:103], a[8:11], v[184:187]
ds_read_b128 a[136:139], v5 offset:8192
v_mfma_f32_16x16x32_bf16 v[160:163], a[100:103], a[4:7], v[160:163]
ds_read_b128 a[140:143], v5 offset:9216
v_mfma_f32_16x16x32_bf16 v[136:139], a[100:103], a[0:3], v[136:139]
v_mfma_f32_16x16x32_bf16 v[140:143], a[104:107], a[0:3], v[140:143]
buffer_load_dwordx4 a[52:55], v2, s[40:43], s35 offen offset:1024 sc1
v_mfma_f32_16x16x32_bf16 v[164:167], a[104:107], a[4:7], v[164:167]
ds_read_b128 a[144:147], v5 offset:10240
v_mfma_f32_16x16x32_bf16 v[188:191], a[104:107], a[8:11], v[188:191]
v_mfma_f32_16x16x32_bf16 v[212:215], a[104:107], a[12:15], v[212:215]
buffer_load_dwordx4 v1, s[4:7], s44 offen offset:2048 sc1 lds
s_add_u32 s63, s28, 20
v_mfma_f32_16x16x32_bf16 v[216:219], a[108:111], a[12:15], v[216:219]
s_add_u32 s63, s63, s33
s_and_b32 s63, s63, 31
s_lshl_b32 s63, s63, 12
v_mfma_f32_16x16x32_bf16 v[192:195], a[108:111], a[8:11], v[192:195]
ds_read_b128 a[148:151], v5 offset:11264
v_mfma_f32_16x16x32_bf16 v[168:171], a[108:111], a[4:7], v[168:171]
ds_read_b128 a[152:155], v6 offset:3072
v_mfma_f32_16x16x32_bf16 v[144:147], a[108:111], a[0:3], v[144:147]
buffer_load_dwordx4 a[56:59], v2, s[40:43], s35 offen offset:2048 sc1
v_mfma_f32_16x16x32_bf16 v[148:151], a[112:115], a[0:3], v[148:151]
ds_read_b128 v[64:67], v233 offset:256
v_mfma_f32_16x16x32_bf16 v[172:175], a[112:115], a[4:7], v[172:175]
v_mfma_f32_16x16x32_bf16 v[196:199], a[112:115], a[8:11], v[196:199]
buffer_load_dwordx4 a[72:75], v3, s[40:43], s63 offen sc1
s_add_u32 s44, s28, 4
v_mfma_f32_16x16x32_bf16 v[220:223], a[112:115], a[12:15], v[220:223]
s_mul_i32 s45, s44, 3072
s_add_u32 m0, s45, 0
s_lshr_b32 s44, s44, 1
v_mfma_f32_16x16x32_bf16 v[224:227], a[116:119], a[12:15], v[224:227]
s_add_u32 s44, s44, 24
s_add_u32 s44, s44, s33
s_and_b32 s44, s44, 31
v_mfma_f32_16x16x32_bf16 v[200:203], a[116:119], a[8:11], v[200:203]
s_mul_i32 s44, s44, 6144
s_add_u32 s44, s44, s50
v_mfma_f32_16x16x32_bf16 v[176:179], a[116:119], a[4:7], v[176:179]
buffer_load_dwordx4 a[60:63], v2, s[40:43], s35 offen offset:3072 sc1
s_add_u32 s35, s35, 4096
v_mfma_f32_16x16x32_bf16 v[152:155], a[116:119], a[0:3], v[152:155]
s_and_b32 s35, s35, 0x1ffff
ds_read_b128 v[68:71], v233 offset:320
v_mfma_f32_16x16x32_bf16 a[80:83], a[120:123], a[68:71], a[80:83]
s_waitcnt vmcnt(15) lgkmcnt(2)
v_mfma_f32_16x16x32_bf16 v[132:135], a[128:131], a[16:19], v[132:135]
ds_read_b128 a[96:99], v5 offset:12288
v_mfma_f32_16x16x32_bf16 v[156:159], a[128:131], a[20:23], v[156:159]
buffer_load_dwordx4 a[0:3], v2, s[40:43], s35 offen offset:0 sc1
v_mfma_f32_16x16x32_bf16 v[180:183], a[128:131], a[24:27], v[180:183]
ds_read_b128 a[100:103], v5 offset:13312
v_mfma_f32_16x16x32_bf16 v[204:207], a[128:131], a[28:31], v[204:207]
v_mfma_f32_16x16x32_bf16 v[208:211], a[132:135], a[28:31], v[208:211]
buffer_load_dwordx4 v1, s[4:7], s44 offen offset:0 sc1 lds
v_mfma_f32_16x16x32_bf16 v[184:187], a[132:135], a[24:27], v[184:187]
ds_read_b128 a[104:107], v5 offset:14336
v_mfma_f32_16x16x32_bf16 v[160:163], a[132:135], a[20:23], v[160:163]
ds_read_b128 a[108:111], v5 offset:15360
v_mfma_f32_16x16x32_bf16 v[136:139], a[132:135], a[16:19], v[136:139]
ds_read_b128 v[72:75], v232 offset:128
v_mfma_f32_16x16x32_bf16 v[140:143], a[136:139], a[16:19], v[140:143]
buffer_load_dwordx4 a[4:7], v2, s[40:43], s35 offen offset:1024 sc1
v_mfma_f32_16x16x32_bf16 v[164:167], a[136:139], a[20:23], v[164:167]
ds_read_b128 a[112:115], v5 offset:16384
v_mfma_f32_16x16x32_bf16 v[188:191], a[136:139], a[24:27], v[188:191]
v_mfma_f32_16x16x32_bf16 v[212:215], a[136:139], a[28:31], v[212:215]
buffer_load_dwordx4 v1, s[4:7], s44 offen offset:1024 sc1 lds
v_mfma_f32_16x16x32_bf16 v[216:219], a[140:143], a[28:31], v[216:219]
ds_read_b128 a[116:119], v5 offset:17408
v_mfma_f32_16x16x32_bf16 v[192:195], a[140:143], a[24:27], v[192:195]
ds_read_b128 a[120:123], v6 offset:4096
v_mfma_f32_16x16x32_bf16 v[168:171], a[140:143], a[20:23], v[168:171]
v_mfma_f32_16x16x32_bf16 v[144:147], a[140:143], a[16:19], v[144:147]
buffer_load_dwordx4 a[8:11], v2, s[40:43], s35 offen offset:2048 sc1
v_mfma_f32_16x16x32_bf16 v[148:151], a[144:147], a[16:19], v[148:151]
v_mfma_f32_16x16x32_bf16 v[172:175], a[144:147], a[20:23], v[172:175]
v_mfma_f32_16x16x32_bf16 v[196:199], a[144:147], a[24:27], v[196:199]
buffer_load_dwordx4 v1, s[4:7], s44 offen offset:2048 sc1 lds
s_add_u32 s44, s28, 8
v_mfma_f32_16x16x32_bf16 v[220:223], a[144:147], a[28:31], v[220:223]
s_mul_i32 s45, s44, 3072
s_add_u32 m0, s45, 0
s_lshr_b32 s44, s44, 1
v_mfma_f32_16x16x32_bf16 v[224:227], a[148:151], a[28:31], v[224:227]
s_add_u32 s44, s44, 24
s_add_u32 s44, s44, s33
s_and_b32 s44, s44, 31
v_mfma_f32_16x16x32_bf16 v[200:203], a[148:151], a[24:27], v[200:203]
s_mul_i32 s44, s44, 6144
s_add_u32 s44, s44, s50
v_mfma_f32_16x16x32_bf16 v[176:179], a[148:151], a[20:23], v[176:179]
buffer_load_dwordx4 a[12:15], v2, s[40:43], s35 offen offset:3072 sc1
s_add_u32 s35, s35, 4096
v_mfma_f32_16x16x32_bf16 v[152:155], a[148:151], a[16:19], v[152:155]
s_and_b32 s35, s35, 0x1ffff
v_mfma_f32_16x16x32_bf16 a[84:87], a[152:155], a[68:71], a[84:87]
s_waitcnt vmcnt(14) lgkmcnt(0)
v_mfma_f32_16x16x32_bf16 v[132:135], a[96:99], a[32:35], v[132:135]
ds_read_b128 a[128:131], v5 offset:18432
v_mfma_f32_16x16x32_bf16 v[156:159], a[96:99], a[36:39], v[156:159]
buffer_load_dwordx4 a[16:19], v2, s[40:43], s35 offen offset:0 sc1
v_mfma_f32_16x16x32_bf16 v[180:183], a[96:99], a[40:43], v[180:183]
ds_read_b128 a[132:135], v5 offset:19456
v_mfma_f32_16x16x32_bf16 v[204:207], a[96:99], a[44:47], v[204:207]
v_mfma_f32_16x16x32_bf16 v[208:211], a[100:103], a[44:47], v[208:211]
ds_read_b128 a[136:139], v5 offset:20480
v_mfma_f32_16x16x32_bf16 v[184:187], a[100:103], a[40:43], v[184:187]
buffer_load_dwordx4 v1, s[4:7], s44 offen offset:0 sc1 lds
v_mfma_f32_16x16x32_bf16 v[160:163], a[100:103], a[36:39], v[160:163]
ds_read_b128 a[140:143], v5 offset:21504
v_mfma_f32_16x16x32_bf16 v[136:139], a[100:103], a[32:35], v[136:139]
v_mfma_f32_16x16x32_bf16 v[140:143], a[104:107], a[32:35], v[140:143]
v_mfma_f32_16x16x32_bf16 v[164:167], a[104:107], a[36:39], v[164:167]
buffer_load_dwordx4 a[20:23], v2, s[40:43], s35 offen offset:1024 sc1
v_mfma_f32_16x16x32_bf16 v[188:191], a[104:107], a[40:43], v[188:191]
ds_read_b128 a[144:147], v5 offset:22528
v_mfma_f32_16x16x32_bf16 v[212:215], a[104:107], a[44:47], v[212:215]
ds_read_b128 a[148:151], v5 offset:23552
v_mfma_f32_16x16x32_bf16 v[216:219], a[108:111], a[44:47], v[216:219]
v_mfma_f32_16x16x32_bf16 v[192:195], a[108:111], a[40:43], v[192:195]
buffer_load_dwordx4 a[24:27], v2, s[40:43], s35 offen offset:2048 sc1
v_mfma_f32_16x16x32_bf16 v[168:171], a[108:111], a[36:39], v[168:171]
ds_read_b128 a[152:155], v6 offset:5120
v_mfma_f32_16x16x32_bf16 v[144:147], a[108:111], a[32:35], v[144:147]
v_mfma_f32_16x16x32_bf16 v[148:151], a[112:115], a[32:35], v[148:151]
v_mfma_f32_16x16x32_bf16 v[172:175], a[112:115], a[36:39], v[172:175]
buffer_load_dwordx4 v1, s[4:7], s44 offen offset:1024 sc1 lds
v_mfma_f32_16x16x32_bf16 v[196:199], a[112:115], a[40:43], v[196:199]
v_mfma_f32_16x16x32_bf16 v[220:223], a[112:115], a[44:47], v[220:223]
v_mfma_f32_16x16x32_bf16 v[224:227], a[116:119], a[44:47], v[224:227]
v_mfma_f32_16x16x32_bf16 v[200:203], a[116:119], a[40:43], v[200:203]
buffer_load_dwordx4 a[28:31], v2, s[40:43], s35 offen offset:3072 sc1
s_add_u32 s35, s35, 4096
v_mfma_f32_16x16x32_bf16 v[176:179], a[116:119], a[36:39], v[176:179]
s_and_b32 s35, s35, 0x1ffff
v_mfma_f32_16x16x32_bf16 v[152:155], a[116:119], a[32:35], v[152:155]
v_mfma_f32_16x16x32_bf16 a[88:91], a[120:123], a[68:71], a[88:91]
s_waitcnt vmcnt(13) lgkmcnt(0)
v_mfma_f32_16x16x32_bf16 v[132:135], a[128:131], a[48:51], v[132:135]
ds_read_b128 a[96:99], v5 offset:24576
v_accvgpr_write_b32 a160, v48
v_mfma_f32_16x16x32_bf16 v[156:159], a[128:131], a[52:55], v[156:159]
buffer_load_dwordx4 a[32:35], v2, s[40:43], s35 offen offset:0 sc1
v_mfma_f32_16x16x32_bf16 v[180:183], a[128:131], a[56:59], v[180:183]
ds_read_b128 a[100:103], v5 offset:25600
v_accvgpr_write_b32 a161, v49
v_mfma_f32_16x16x32_bf16 v[204:207], a[128:131], a[60:63], v[204:207]
v_mfma_f32_16x16x32_bf16 v[208:211], a[132:135], a[60:63], v[208:211]
buffer_load_dwordx4 v1, s[4:7], s44 offen offset:2048 sc1 lds
s_add_u32 s44, s28, 12
v_mfma_f32_16x16x32_bf16 v[184:187], a[132:135], a[56:59], v[184:187]
s_mul_i32 s45, s44, 3072
s_add_u32 m0, s45, 0
s_lshr_b32 s44, s44, 1
v_mfma_f32_16x16x32_bf16 v[160:163], a[132:135], a[52:55], v[160:163]
s_add_u32 s44, s44, 24
s_add_u32 s44, s44, s33
s_and_b32 s44, s44, 31
v_mfma_f32_16x16x32_bf16 v[136:139], a[132:135], a[48:51], v[136:139]
s_mul_i32 s44, s44, 6144
s_add_u32 s44, s44, s50
v_mfma_f32_16x16x32_bf16 v[140:143], a[136:139], a[48:51], v[140:143]
buffer_load_dwordx4 a[36:39], v2, s[40:43], s35 offen offset:1024 sc1
v_mfma_f32_16x16x32_bf16 v[164:167], a[136:139], a[52:55], v[164:167]
ds_read_b128 a[104:107], v5 offset:26624
v_accvgpr_write_b32 a162, v50
v_mfma_f32_16x16x32_bf16 v[188:191], a[136:139], a[56:59], v[188:191]
ds_read_b128 a[108:111], v5 offset:27648
v_accvgpr_write_b32 a163, v51
v_mfma_f32_16x16x32_bf16 v[212:215], a[136:139], a[60:63], v[212:215]
buffer_load_dwordx4 v1, s[4:7], s44 offen offset:0 sc1 lds
v_mfma_f32_16x16x32_bf16 v[216:219], a[140:143], a[60:63], v[216:219]
ds_read_b128 a[112:115], v5 offset:28672
v_accvgpr_write_b32 a164, v52
v_mfma_f32_16x16x32_bf16 v[192:195], a[140:143], a[56:59], v[192:195]
ds_read_b128 a[116:119], v5 offset:29696
v_accvgpr_write_b32 a165, v53
v_mfma_f32_16x16x32_bf16 v[168:171], a[140:143], a[52:55], v[168:171]
ds_read_b128 a[120:123], v6 offset:26624
v_mfma_f32_16x16x32_bf16 v[144:147], a[140:143], a[48:51], v[144:147]
buffer_load_dwordx4 a[40:43], v2, s[40:43], s35 offen offset:2048 sc1
v_mfma_f32_16x16x32_bf16 v[148:151], a[144:147], a[48:51], v[148:151]
v_accvgpr_write_b32 a166, v54
v_mfma_f32_16x16x32_bf16 v[172:175], a[144:147], a[52:55], v[172:175]
v_mfma_f32_16x16x32_bf16 v[196:199], a[144:147], a[56:59], v[196:199]
buffer_load_dwordx4 v1, s[4:7], s44 offen offset:1024 sc1 lds
v_mfma_f32_16x16x32_bf16 v[220:223], a[144:147], a[60:63], v[220:223]
v_accvgpr_write_b32 a167, v55
v_mfma_f32_16x16x32_bf16 v[224:227], a[148:151], a[60:63], v[224:227]
v_mfma_f32_16x16x32_bf16 v[200:203], a[148:151], a[56:59], v[200:203]
v_accvgpr_write_b32 a168, v56
v_mfma_f32_16x16x32_bf16 v[176:179], a[148:151], a[52:55], v[176:179]
buffer_load_dwordx4 a[44:47], v2, s[40:43], s35 offen offset:3072 sc1
s_add_u32 s35, s35, 4096
v_mfma_f32_16x16x32_bf16 v[152:155], a[148:151], a[48:51], v[152:155]
s_and_b32 s35, s35, 0x1ffff
v_mfma_f32_16x16x32_bf16 a[92:95], a[152:155], a[68:71], a[92:95]
v_accvgpr_write_b32 a169, v57
s_waitcnt vmcnt(13) lgkmcnt(0)
v_mfma_f32_16x16x32_bf16 v[132:135], a[96:99], a[0:3], v[132:135]
ds_read_b128 a[128:131], v5 offset:30720
v_mfma_f32_16x16x32_bf16 v[156:159], a[96:99], a[4:7], v[156:159]
buffer_load_dwordx4 a[48:51], v2, s[40:43], s35 offen offset:0 sc1
v_mfma_f32_16x16x32_bf16 v[180:183], a[96:99], a[8:11], v[180:183]
ds_read_b128 a[132:135], v5 offset:31744
v_accvgpr_write_b32 a170, v58
v_mfma_f32_16x16x32_bf16 v[204:207], a[96:99], a[12:15], v[204:207]
v_mfma_f32_16x16x32_bf16 v[208:211], a[100:103], a[12:15], v[208:211]
ds_read_b128 a[136:139], v5 offset:32768
v_accvgpr_write_b32 a171, v59
v_mfma_f32_16x16x32_bf16 v[184:187], a[100:103], a[8:11], v[184:187]
buffer_load_dwordx4 v1, s[4:7], s44 offen offset:2048 sc1 lds
s_add_u32 s63, s28, 24
v_mfma_f32_16x16x32_bf16 v[160:163], a[100:103], a[4:7], v[160:163]
s_add_u32 s63, s63, s33
s_and_b32 s63, s63, 31
s_lshl_b32 s63, s63, 12
v_mfma_f32_16x16x32_bf16 v[136:139], a[100:103], a[0:3], v[136:139]
ds_read_b128 a[140:143], v5 offset:33792
v_accvgpr_write_b32 a172, v60
v_mfma_f32_16x16x32_bf16 v[140:143], a[104:107], a[0:3], v[140:143]
v_mfma_f32_16x16x32_bf16 v[164:167], a[104:107], a[4:7], v[164:167]
buffer_load_dwordx4 a[52:55], v2, s[40:43], s35 offen offset:1024 sc1
v_mfma_f32_16x16x32_bf16 v[188:191], a[104:107], a[8:11], v[188:191]
ds_read_b128 a[144:147], v5 offset:34816
v_accvgpr_write_b32 a173, v61
v_mfma_f32_16x16x32_bf16 v[212:215], a[104:107], a[12:15], v[212:215]
ds_read_b128 a[148:151], v5 offset:35840
v_mfma_f32_16x16x32_bf16 v[216:219], a[108:111], a[12:15], v[216:219]
v_accvgpr_write_b32 a174, v62
v_mfma_f32_16x16x32_bf16 v[192:195], a[108:111], a[8:11], v[192:195]
buffer_load_dwordx4 a[56:59], v2, s[40:43], s35 offen offset:2048 sc1
v_mfma_f32_16x16x32_bf16 v[168:171], a[108:111], a[4:7], v[168:171]
ds_read_b128 a[152:155], v6 offset:27648
v_mfma_f32_16x16x32_bf16 v[144:147], a[108:111], a[0:3], v[144:147]
v_accvgpr_write_b32 a175, v63
v_mfma_f32_16x16x32_bf16 v[148:151], a[112:115], a[0:3], v[148:151]
v_mfma_f32_16x16x32_bf16 v[172:175], a[112:115], a[4:7], v[172:175]
buffer_load_dwordx4 a[64:67], v3, s[40:43], s63 offen sc1
s_lshr_b32 s89, s2, 3
v_mfma_f32_16x16x32_bf16 v[196:199], a[112:115], a[8:11], v[196:199]
s_lshl_b32 s89, s89, 10
s_add_u32 s89, s89, (L_cpf0 - interleave_layers__sliding_local_dilated__linear_kernel_hedgehog__prompt_kernel + 2048)
v_mfma_f32_16x16x32_bf16 v[220:223], a[112:115], a[12:15], v[220:223]
v_accvgpr_write_b32 a176, v64
v_mfma_f32_16x16x32_bf16 v[224:227], a[116:119], a[12:15], v[224:227]
v_accvgpr_write_b32 a177, v65
v_mfma_f32_16x16x32_bf16 v[200:203], a[116:119], a[8:11], v[200:203]
buffer_load_dwordx4 a[60:63], v2, s[40:43], s35 offen offset:3072 sc1
s_add_u32 s35, s35, 4096
v_mfma_f32_16x16x32_bf16 v[176:179], a[116:119], a[4:7], v[176:179]
s_and_b32 s35, s35, 0x1ffff
v_mfma_f32_16x16x32_bf16 v[152:155], a[116:119], a[0:3], v[152:155]
v_accvgpr_write_b32 a178, v66
v_mfma_f32_16x16x32_bf16 a[80:83], a[120:123], a[72:75], a[80:83]
s_waitcnt vmcnt(13) lgkmcnt(0)
v_mfma_f32_16x16x32_bf16 v[132:135], a[128:131], a[16:19], v[132:135]
ds_read_b128 a[96:99], v5 offset:36864
v_accvgpr_write_b32 a179, v67
v_mfma_f32_16x16x32_bf16 v[156:159], a[128:131], a[20:23], v[156:159]
buffer_load_dwordx4 a[0:3], v2, s[40:43], s35 offen offset:0 sc1
v_mfma_f32_16x16x32_bf16 v[180:183], a[128:131], a[24:27], v[180:183]
ds_read_b128 a[100:103], v5 offset:37888
v_mfma_f32_16x16x32_bf16 v[204:207], a[128:131], a[28:31], v[204:207]
v_accvgpr_write_b32 a180, v68
v_mfma_f32_16x16x32_bf16 v[208:211], a[132:135], a[28:31], v[208:211]
ds_read_b128 a[104:107], v5 offset:38912
v_mfma_f32_16x16x32_bf16 v[184:187], a[132:135], a[24:27], v[184:187]
buffer_load_dwordx4 a[76:79], v1, s[24:27], s89 offen
s_add_u32 s63, s28, 28
v_mfma_f32_16x16x32_bf16 v[160:163], a[132:135], a[20:23], v[160:163]
s_add_u32 s63, s63, s33
s_and_b32 s63, s63, 31
s_lshl_b32 s63, s63, 12
v_mfma_f32_16x16x32_bf16 v[136:139], a[132:135], a[16:19], v[136:139]
ds_read_b128 a[108:111], v5 offset:39936
v_accvgpr_write_b32 a181, v69
v_mfma_f32_16x16x32_bf16 v[140:143], a[136:139], a[16:19], v[140:143]
v_accvgpr_write_b32 a182, v70
v_mfma_f32_16x16x32_bf16 v[164:167], a[136:139], a[20:23], v[164:167]
buffer_load_dwordx4 a[4:7], v2, s[40:43], s35 offen offset:1024 sc1
v_mfma_f32_16x16x32_bf16 v[188:191], a[136:139], a[24:27], v[188:191]
ds_read_b128 a[112:115], v5 offset:40960
v_mfma_f32_16x16x32_bf16 v[212:215], a[136:139], a[28:31], v[212:215]
ds_read_b128 a[116:119], v5 offset:41984
v_accvgpr_write_b32 a183, v71
v_mfma_f32_16x16x32_bf16 v[216:219], a[140:143], a[28:31], v[216:219]
v_mfma_f32_16x16x32_bf16 v[192:195], a[140:143], a[24:27], v[192:195]
buffer_load_dwordx4 a[8:11], v2, s[40:43], s35 offen offset:2048 sc1
v_mfma_f32_16x16x32_bf16 v[168:171], a[140:143], a[20:23], v[168:171]
ds_read_b128 a[120:123], v6 offset:28672
v_accvgpr_write_b32 a184, v72
v_mfma_f32_16x16x32_bf16 v[144:147], a[140:143], a[16:19], v[144:147]
v_mfma_f32_16x16x32_bf16 v[148:151], a[144:147], a[16:19], v[148:151]
v_accvgpr_write_b32 a185, v73
v_mfma_f32_16x16x32_bf16 v[172:175], a[144:147], a[20:23], v[172:175]
buffer_load_dwordx4 a[68:71], v3, s[40:43], s63 offen sc1
v_mfma_f32_16x16x32_bf16 v[196:199], a[144:147], a[24:27], v[196:199]
v_mfma_f32_16x16x32_bf16 v[220:223], a[144:147], a[28:31], v[220:223]
v_accvgpr_write_b32 a186, v74
v_mfma_f32_16x16x32_bf16 v[224:227], a[148:151], a[28:31], v[224:227]
v_mfma_f32_16x16x32_bf16 v[200:203], a[148:151], a[24:27], v[200:203]
buffer_load_dwordx4 a[12:15], v2, s[40:43], s35 offen offset:3072 sc1
s_add_u32 s35, s35, 4096
v_mfma_f32_16x16x32_bf16 v[176:179], a[148:151], a[20:23], v[176:179]
s_and_b32 s35, s35, 0x1ffff
v_accvgpr_write_b32 a187, v75
v_mfma_f32_16x16x32_bf16 v[152:155], a[148:151], a[16:19], v[152:155]
v_mfma_f32_16x16x32_bf16 a[84:87], a[152:155], a[72:75], a[84:87]
s_waitcnt vmcnt(12) lgkmcnt(0)
v_mfma_f32_16x16x32_bf16 v[132:135], a[96:99], a[32:35], v[132:135]
ds_read_b128 a[128:131], v5 offset:43008
v_add_f32 v92, v92, v96
v_mfma_f32_16x16x32_bf16 v[156:159], a[96:99], a[36:39], v[156:159]
buffer_load_dwordx4 a[16:19], v2, s[40:43], s35 offen offset:0 sc1
v_mfma_f32_16x16x32_bf16 v[180:183], a[96:99], a[40:43], v[180:183]
ds_read_b128 a[132:135], v5 offset:44032
v_add_f32 v100, v100, v104
v_mfma_f32_16x16x32_bf16 v[204:207], a[96:99], a[44:47], v[204:207]
v_add_f32 v108, v108, v112
v_add_f32 v116, v116, v120
v_mfma_f32_16x16x32_bf16 v[208:211], a[100:103], a[44:47], v[208:211]
ds_read_b128 a[136:139], v5 offset:45056
v_add_f32 v124, v124, v128
v_mfma_f32_16x16x32_bf16 v[184:187], a[100:103], a[40:43], v[184:187]
buffer_load_dwordx4 a[20:23], v2, s[40:43], s35 offen offset:1024 sc1
v_mfma_f32_16x16x32_bf16 v[160:163], a[100:103], a[36:39], v[160:163]
ds_read_b128 a[140:143], v5 offset:46080
v_add_f32 v93, v93, v97
v_mfma_f32_16x16x32_bf16 v[136:139], a[100:103], a[32:35], v[136:139]
v_add_f32 v101, v101, v105
v_add_f32 v109, v109, v113
v_mfma_f32_16x16x32_bf16 v[140:143], a[104:107], a[32:35], v[140:143]
v_add_f32 v117, v117, v121
v_add_f32 v125, v125, v129
v_mfma_f32_16x16x32_bf16 v[164:167], a[104:107], a[36:39], v[164:167]
buffer_store_dwordx4 v[236:239], v254, s[4:7], s98 offen offset:0 sc1
v_mfma_f32_16x16x32_bf16 v[188:191], a[104:107], a[40:43], v[188:191]
ds_read_b128 a[144:147], v5 offset:47104
v_add_f32 v94, v94, v98
v_mfma_f32_16x16x32_bf16 v[212:215], a[104:107], a[44:47], v[212:215]
ds_read_b128 a[148:151], v5 offset:48128
v_add_f32 v102, v102, v106
v_mfma_f32_16x16x32_bf16 v[216:219], a[108:111], a[44:47], v[216:219]
v_add_f32 v110, v110, v114
v_add_f32 v118, v118, v122
v_mfma_f32_16x16x32_bf16 v[192:195], a[108:111], a[40:43], v[192:195]
ds_read_b128 a[152:155], v6 offset:29696
v_add_f32 v126, v126, v130
v_mfma_f32_16x16x32_bf16 v[168:171], a[108:111], a[36:39], v[168:171]
v_add_f32 v95, v95, v99
v_add_f32 v103, v103, v107
v_mfma_f32_16x16x32_bf16 v[144:147], a[108:111], a[32:35], v[144:147]
v_add_f32 v111, v111, v115
v_add_f32 v119, v119, v123
v_mfma_f32_16x16x32_bf16 v[148:151], a[112:115], a[32:35], v[148:151]
v_add_f32 v127, v127, v131
v_add_f32_dpp v92, v92, v92 row_ror:8 row_mask:0xf bank_mask:0xf
v_mfma_f32_16x16x32_bf16 v[172:175], a[112:115], a[36:39], v[172:175]
buffer_load_dwordx4 a[24:27], v2, s[40:43], s35 offen offset:2048 sc1
v_mfma_f32_16x16x32_bf16 v[196:199], a[112:115], a[40:43], v[196:199]
v_add_f32_dpp v100, v100, v100 row_ror:8 row_mask:0xf bank_mask:0xf
v_add_f32_dpp v108, v108, v108 row_ror:8 row_mask:0xf bank_mask:0xf
v_mfma_f32_16x16x32_bf16 v[220:223], a[112:115], a[44:47], v[220:223]
v_add_f32_dpp v116, v116, v116 row_ror:8 row_mask:0xf bank_mask:0xf
v_add_f32_dpp v124, v124, v124 row_ror:8 row_mask:0xf bank_mask:0xf
v_mfma_f32_16x16x32_bf16 v[224:227], a[116:119], a[44:47], v[224:227]
v_add_f32_dpp v93, v93, v93 row_ror:8 row_mask:0xf bank_mask:0xf
v_mfma_f32_16x16x32_bf16 v[200:203], a[116:119], a[40:43], v[200:203]
buffer_load_dwordx4 a[28:31], v2, s[40:43], s35 offen offset:3072 sc1
s_add_u32 s35, s35, 4096
v_mfma_f32_16x16x32_bf16 v[176:179], a[116:119], a[36:39], v[176:179]
s_and_b32 s35, s35, 0x1ffff
v_add_f32_dpp v101, v101, v101 row_ror:8 row_mask:0xf bank_mask:0xf
v_mfma_f32_16x16x32_bf16 v[152:155], a[116:119], a[32:35], v[152:155]
v_add_f32_dpp v109, v109, v109 row_ror:8 row_mask:0xf bank_mask:0xf
v_add_f32_dpp v117, v117, v117 row_ror:8 row_mask:0xf bank_mask:0xf
v_mfma_f32_16x16x32_bf16 a[88:91], a[120:123], a[72:75], a[88:91]
s_waitcnt vmcnt(11) lgkmcnt(0)
s_barrier
v_mfma_f32_16x16x32_bf16 v[132:135], a[128:131], a[48:51], v[132:135]
v_add_u32 v5, 0, v1
v_add_u32 v6, s55, v5
v_mfma_f32_16x16x32_bf16 v[156:159], a[128:131], a[52:55], v[156:159]
buffer_load_dwordx4 a[32:35], v2, s[40:43], s35 offen offset:0 sc1
v_mfma_f32_16x16x32_bf16 v[180:183], a[128:131], a[56:59], v[180:183]
ds_read_b128 a[96:99], v5 offset:0
v_add_f32_dpp v125, v125, v125 row_ror:8 row_mask:0xf bank_mask:0xf
v_mfma_f32_16x16x32_bf16 v[204:207], a[128:131], a[60:63], v[204:207]
ds_read_b128 a[100:103], v5 offset:1024
v_add_f32_dpp v92, v94, v94 row_ror:8 row_mask:0xf bank_mask:0xc
v_mfma_f32_16x16x32_bf16 v[208:211], a[132:135], a[60:63], v[208:211]
ds_read_b128 a[104:107], v5 offset:2048
v_add_f32_dpp v100, v102, v102 row_ror:8 row_mask:0xf bank_mask:0xc
v_mfma_f32_16x16x32_bf16 v[184:187], a[132:135], a[56:59], v[184:187]
buffer_load_dwordx4 a[36:39], v2, s[40:43], s35 offen offset:1024 sc1
v_mfma_f32_16x16x32_bf16 v[160:163], a[132:135], a[52:55], v[160:163]
ds_read_b128 a[108:111], v5 offset:3072
v_add_f32_dpp v108, v110, v110 row_ror:8 row_mask:0xf bank_mask:0xc
v_mfma_f32_16x16x32_bf16 v[136:139], a[132:135], a[48:51], v[136:139]
v_add_f32_dpp v116, v118, v118 row_ror:8 row_mask:0xf bank_mask:0xc
v_add_f32_dpp v124, v126, v126 row_ror:8 row_mask:0xf bank_mask:0xc
v_mfma_f32_16x16x32_bf16 v[140:143], a[136:139], a[48:51], v[140:143]
ds_read_b128 a[112:115], v5 offset:4096
v_add_f32_dpp v93, v95, v95 row_ror:8 row_mask:0xf bank_mask:0xc
v_mfma_f32_16x16x32_bf16 v[164:167], a[136:139], a[52:55], v[164:167]
buffer_store_dwordx4 v[240:243], v254, s[4:7], s98 offen offset:2048 sc1
v_mfma_f32_16x16x32_bf16 v[188:191], a[136:139], a[56:59], v[188:191]
ds_read_b128 a[116:119], v5 offset:5120
v_add_f32_dpp v101, v103, v103 row_ror:8 row_mask:0xf bank_mask:0xc
v_mfma_f32_16x16x32_bf16 v[212:215], a[136:139], a[60:63], v[212:215]
v_add_f32_dpp v109, v111, v111 row_ror:8 row_mask:0xf bank_mask:0xc
v_add_f32_dpp v117, v119, v119 row_ror:8 row_mask:0xf bank_mask:0xc
v_mfma_f32_16x16x32_bf16 v[216:219], a[140:143], a[60:63], v[216:219]
ds_read_b128 a[120:123], v6 offset:2048
v_add_f32_dpp v125, v127, v127 row_ror:8 row_mask:0xf bank_mask:0xc
v_mfma_f32_16x16x32_bf16 v[192:195], a[140:143], a[56:59], v[192:195]
v_permlane32_swap_b32 v92, v93
v_mfma_f32_16x16x32_bf16 v[168:171], a[140:143], a[52:55], v[168:171]
ds_read_b128 a[124:127], v6 offset:26624
v_mfma_f32_16x16x32_bf16 v[144:147], a[140:143], a[48:51], v[144:147]
v_permlane32_swap_b32 v100, v101
v_mfma_f32_16x16x32_bf16 v[148:151], a[144:147], a[48:51], v[148:151]
v_permlane32_swap_b32 v108, v109
v_mfma_f32_16x16x32_bf16 v[172:175], a[144:147], a[52:55], v[172:175]
buffer_load_dwordx4 a[40:43], v2, s[40:43], s35 offen offset:2048 sc1
v_mfma_f32_16x16x32_bf16 v[196:199], a[144:147], a[56:59], v[196:199]
v_permlane32_swap_b32 v116, v117
v_mfma_f32_16x16x32_bf16 v[220:223], a[144:147], a[60:63], v[220:223]
v_permlane32_swap_b32 v124, v125
v_mfma_f32_16x16x32_bf16 v[224:227], a[148:151], a[60:63], v[224:227]
v_add_f32 v92, v92, v93
v_add_f32 v100, v100, v101
v_mfma_f32_16x16x32_bf16 v[200:203], a[148:151], a[56:59], v[200:203]
buffer_load_dwordx4 a[44:47], v2, s[40:43], s35 offen offset:3072 sc1
s_add_u32 s35, s35, 4096
v_mfma_f32_16x16x32_bf16 v[176:179], a[148:151], a[52:55], v[176:179]
s_and_b32 s35, s35, 0x1ffff
v_add_f32 v108, v108, v109
v_mfma_f32_16x16x32_bf16 v[152:155], a[148:151], a[48:51], v[152:155]
v_add_f32 v116, v116, v117
v_add_f32 v124, v124, v125
v_mfma_f32_16x16x32_bf16 a[92:95], a[152:155], a[72:75], a[92:95]
v_mov_b32 v94, v92
s_waitcnt vmcnt(10) lgkmcnt(0)
v_mfma_f32_16x16x32_bf16 v[132:135], a[96:99], a[0:3], v[132:135]
ds_read_b128 a[128:131], v5 offset:6144
v_mov_b32 v102, v100
v_mfma_f32_16x16x32_bf16 v[156:159], a[96:99], a[4:7], v[156:159]
buffer_load_dwordx4 a[48:51], v2, s[40:43], s35 offen offset:0 sc1
v_mfma_f32_16x16x32_bf16 v[180:183], a[96:99], a[8:11], v[180:183]
ds_read_b128 a[132:135], v5 offset:7168
v_mov_b32 v110, v108
v_mfma_f32_16x16x32_bf16 v[204:207], a[96:99], a[12:15], v[204:207]
v_mov_b32 v118, v116
v_mov_b32 v126, v124
v_mfma_f32_16x16x32_bf16 v[208:211], a[100:103], a[12:15], v[208:211]
ds_read_b128 a[136:139], v5 offset:8192
v_mfma_f32_16x16x32_bf16 v[184:187], a[100:103], a[8:11], v[184:187]
buffer_load_dwordx4 a[52:55], v2, s[40:43], s35 offen offset:1024 sc1
v_mfma_f32_16x16x32_bf16 v[160:163], a[100:103], a[4:7], v[160:163]
ds_read_b128 a[140:143], v5 offset:9216
v_mfma_f32_16x16x32_bf16 v[136:139], a[100:103], a[0:3], v[136:139]
v_permlane16_swap_b32 v92, v94
v_mfma_f32_16x16x32_bf16 v[140:143], a[104:107], a[0:3], v[140:143]
ds_read_b128 a[144:147], v5 offset:10240
v_mfma_f32_16x16x32_bf16 v[164:167], a[104:107], a[4:7], v[164:167]
buffer_store_dwordx4 v[244:247], v254, s[4:7], s99 offen offset:0 sc1
v_mfma_f32_16x16x32_bf16 v[188:191], a[104:107], a[8:11], v[188:191]
ds_read_b128 a[148:151], v5 offset:11264
v_mfma_f32_16x16x32_bf16 v[212:215], a[104:107], a[12:15], v[212:215]
v_permlane16_swap_b32 v100, v102
v_mfma_f32_16x16x32_bf16 v[216:219], a[108:111], a[12:15], v[216:219]
ds_read_b128 a[152:155], v6 offset:3072
v_mfma_f32_16x16x32_bf16 v[192:195], a[108:111], a[8:11], v[192:195]
v_permlane16_swap_b32 v108, v110
v_mfma_f32_16x16x32_bf16 v[168:171], a[108:111], a[4:7], v[168:171]
ds_read_b128 a[156:159], v6 offset:27648
v_mfma_f32_16x16x32_bf16 v[144:147], a[108:111], a[0:3], v[144:147]
v_permlane16_swap_b32 v116, v118
v_mfma_f32_16x16x32_bf16 v[148:151], a[112:115], a[0:3], v[148:151]
v_permlane16_swap_b32 v124, v126
v_mfma_f32_16x16x32_bf16 v[172:175], a[112:115], a[4:7], v[172:175]
v_add_f32 v92, v92, v94
v_add_f32 v100, v100, v102
v_mfma_f32_16x16x32_bf16 v[196:199], a[112:115], a[8:11], v[196:199]
buffer_load_dwordx4 a[56:59], v2, s[40:43], s35 offen offset:2048 sc1
v_mfma_f32_16x16x32_bf16 v[220:223], a[112:115], a[12:15], v[220:223]
v_add_f32 v108, v108, v110
v_add_f32 v116, v116, v118
v_mfma_f32_16x16x32_bf16 v[224:227], a[116:119], a[12:15], v[224:227]
v_add_f32 v124, v124, v126
v_mov_b32 v94, v92
v_mfma_f32_16x16x32_bf16 v[200:203], a[116:119], a[8:11], v[200:203]
v_mov_b32 v102, v100
v_mov_b32 v110, v108
v_mfma_f32_16x16x32_bf16 v[176:179], a[116:119], a[4:7], v[176:179]
buffer_load_dwordx4 a[60:63], v2, s[40:43], s35 offen offset:3072 sc1
s_add_u32 s35, s35, 4096
v_mfma_f32_16x16x32_bf16 v[152:155], a[116:119], a[0:3], v[152:155]
s_and_b32 s35, s35, 0x1ffff
v_mov_b32 v118, v116
v_mfma_f32_16x16x32_bf16 a[80:83], a[120:123], a[64:67], a[80:83]
v_mov_b32 v126, v124
v_mfma_f32_16x16x32_bf16 a[80:83], a[124:127], a[68:71], a[80:83]
s_waitcnt vmcnt(10) lgkmcnt(0)
v_mfma_f32_16x16x32_bf16 v[132:135], a[128:131], a[16:19], v[132:135]
ds_read_b128 a[96:99], v5 offset:12288
v_mfma_f32_16x16x32_bf16 v[156:159], a[128:131], a[20:23], v[156:159]
buffer_load_dwordx4 a[0:3], v2, s[40:43], s35 offen offset:0 sc1
v_mfma_f32_16x16x32_bf16 v[180:183], a[128:131], a[24:27], v[180:183]
ds_read_b128 a[100:103], v5 offset:13312
v_mfma_f32_16x16x32_bf16 v[204:207], a[128:131], a[28:31], v[204:207]
v_permlane32_swap_b32 v92, v94
v_mfma_f32_16x16x32_bf16 v[208:211], a[132:135], a[28:31], v[208:211]
ds_read_b128 a[104:107], v5 offset:14336
v_mfma_f32_16x16x32_bf16 v[184:187], a[132:135], a[24:27], v[184:187]
buffer_load_dwordx4 a[4:7], v2, s[40:43], s35 offen offset:1024 sc1
v_mfma_f32_16x16x32_bf16 v[160:163], a[132:135], a[20:23], v[160:163]
ds_read_b128 a[108:111], v5 offset:15360
v_mfma_f32_16x16x32_bf16 v[136:139], a[132:135], a[16:19], v[136:139]
v_permlane32_swap_b32 v100, v102
v_mfma_f32_16x16x32_bf16 v[140:143], a[136:139], a[16:19], v[140:143]
ds_read_b128 a[112:115], v5 offset:16384
v_mfma_f32_16x16x32_bf16 v[164:167], a[136:139], a[20:23], v[164:167]
buffer_store_dwordx4 a[220:223], v1, s[4:7], s101 offen offset:0 sc1
v_mfma_f32_16x16x32_bf16 v[188:191], a[136:139], a[24:27], v[188:191]
ds_read_b128 a[116:119], v5 offset:17408
v_mfma_f32_16x16x32_bf16 v[212:215], a[136:139], a[28:31], v[212:215]
v_permlane32_swap_b32 v108, v110
v_mfma_f32_16x16x32_bf16 v[216:219], a[140:143], a[28:31], v[216:219]
ds_read_b128 a[120:123], v6 offset:4096
v_mfma_f32_16x16x32_bf16 v[192:195], a[140:143], a[24:27], v[192:195]
v_permlane32_swap_b32 v116, v118
v_mfma_f32_16x16x32_bf16 v[168:171], a[140:143], a[20:23], v[168:171]
ds_read_b128 a[124:127], v6 offset:28672
v_mfma_f32_16x16x32_bf16 v[144:147], a[140:143], a[16:19], v[144:147]
v_permlane32_swap_b32 v124, v126
v_mfma_f32_16x16x32_bf16 v[148:151], a[144:147], a[16:19], v[148:151]
v_mul_f32 v82, 0xba800000, v92
v_mul_f32 v84, 0xba800000, v100
v_mfma_f32_16x16x32_bf16 v[172:175], a[144:147], a[20:23], v[172:175]
v_mul_f32 v86, 0xba800000, v108
v_mul_f32 v88, 0xba800000, v116
v_mfma_f32_16x16x32_bf16 v[196:199], a[144:147], a[24:27], v[196:199]
buffer_load_dwordx4 a[8:11], v2, s[40:43], s35 offen offset:2048 sc1
v_mfma_f32_16x16x32_bf16 v[220:223], a[144:147], a[28:31], v[220:223]
v_mul_f32 v90, 0xba800000, v124
v_mul_f32 v94, 0x3a800000, v94
v_mfma_f32_16x16x32_bf16 v[224:227], a[148:151], a[28:31], v[224:227]
v_mul_f32 v102, 0x3a800000, v102
v_mul_f32 v110, 0x3a800000, v110
v_mfma_f32_16x16x32_bf16 v[200:203], a[148:151], a[24:27], v[200:203]
v_mul_f32 v118, 0x3a800000, v118
v_mul_f32 v126, 0x3a800000, v126
v_mfma_f32_16x16x32_bf16 v[176:179], a[148:151], a[20:23], v[176:179]
buffer_load_dwordx4 a[12:15], v2, s[40:43], s35 offen offset:3072 sc1
s_add_u32 s35, s35, 4096
v_mfma_f32_16x16x32_bf16 v[152:155], a[148:151], a[16:19], v[152:155]
s_and_b32 s35, s35, 0x1ffff
v_fma_f32 v94, -v82, v82, v94
v_mfma_f32_16x16x32_bf16 a[84:87], a[152:155], a[64:67], a[84:87]
v_fma_f32 v102, -v84, v84, v102
v_fma_f32 v110, -v86, v86, v110
v_mfma_f32_16x16x32_bf16 a[84:87], a[156:159], a[68:71], a[84:87]
v_fma_f32 v118, -v88, v88, v118
s_waitcnt vmcnt(10) lgkmcnt(0)
v_mfma_f32_16x16x32_bf16 v[132:135], a[96:99], a[32:35], v[132:135]
ds_read_b128 a[128:131], v5 offset:18432
v_fma_f32 v126, -v90, v90, v126
v_mfma_f32_16x16x32_bf16 v[156:159], a[96:99], a[36:39], v[156:159]
buffer_load_dwordx4 a[16:19], v2, s[40:43], s35 offen offset:0 sc1
v_mfma_f32_16x16x32_bf16 v[180:183], a[96:99], a[40:43], v[180:183]
ds_read_b128 a[132:135], v5 offset:19456
v_max_f32 v94, 0, v94
v_mfma_f32_16x16x32_bf16 v[204:207], a[96:99], a[44:47], v[204:207]
v_max_f32 v102, 0, v102
v_max_f32 v110, 0, v110
v_mfma_f32_16x16x32_bf16 v[208:211], a[100:103], a[44:47], v[208:211]
ds_read_b128 a[136:139], v5 offset:20480
v_max_f32 v118, 0, v118
v_mfma_f32_16x16x32_bf16 v[184:187], a[100:103], a[40:43], v[184:187]
buffer_load_dword v11, v255, s[16:19], 0 offen sc1
v_mfma_f32_16x16x32_bf16 v[160:163], a[100:103], a[36:39], v[160:163]
ds_read_b128 a[140:143], v5 offset:21504
v_max_f32 v126, 0, v126
v_mfma_f32_16x16x32_bf16 v[136:139], a[100:103], a[32:35], v[136:139]
buffer_load_dwordx4 a[20:23], v2, s[40:43], s35 offen offset:1024 sc1
v_add_f32 v94, 0x3727c5ac, v94
v_add_f32 v102, 0x3727c5ac, v102
v_add_f32 v110, 0x3727c5ac, v110
v_add_f32 v118, 0x3727c5ac, v118
v_add_f32 v126, 0x3727c5ac, v126
v_rsq_f32 v83, v94
v_rsq_f32 v85, v102
v_rsq_f32 v87, v110
v_rsq_f32 v89, v118
v_rsq_f32 v91, v126
v_mfma_f32_16x16x32_bf16 v[140:143], a[104:107], a[32:35], v[140:143]
ds_read_b128 a[144:147], v5 offset:22528
v_mfma_f32_16x16x32_bf16 v[164:167], a[104:107], a[36:39], v[164:167]
v_fmac_f32 v132, v48, v82
v_mfma_f32_16x16x32_bf16 v[188:191], a[104:107], a[40:43], v[188:191]
ds_read_b128 a[148:151], v5 offset:23552
v_fmac_f32 v156, v48, v84
v_mfma_f32_16x16x32_bf16 v[212:215], a[104:107], a[44:47], v[212:215]
buffer_load_dwordx4 a[24:27], v2, s[40:43], s35 offen offset:2048 sc1
v_mfma_f32_16x16x32_bf16 v[216:219], a[108:111], a[44:47], v[216:219]
ds_read_b128 a[152:155], v6 offset:5120
v_fmac_f32 v180, v48, v86
v_mfma_f32_16x16x32_bf16 v[192:195], a[108:111], a[40:43], v[192:195]
v_fmac_f32 v204, v48, v88
v_fmac_f32 v208, v52, v88
v_mfma_f32_16x16x32_bf16 v[168:171], a[108:111], a[36:39], v[168:171]
ds_read_b128 a[156:159], v6 offset:29696
v_fmac_f32 v184, v52, v86
v_mfma_f32_16x16x32_bf16 v[144:147], a[108:111], a[32:35], v[144:147]
buffer_store_dwordx4 a[224:227], v1, s[4:7], s101 offen offset:1024 sc1
v_mfma_f32_16x16x32_bf16 v[148:151], a[112:115], a[32:35], v[148:151]
v_fmac_f32 v160, v52, v84
v_fmac_f32 v136, v52, v82
v_mfma_f32_16x16x32_bf16 v[172:175], a[112:115], a[36:39], v[172:175]
v_fmac_f32 v140, v56, v82
v_mfma_f32_16x16x32_bf16 v[196:199], a[112:115], a[40:43], v[196:199]
v_fmac_f32 v164, v56, v84
v_mfma_f32_16x16x32_bf16 v[220:223], a[112:115], a[44:47], v[220:223]
v_fmac_f32 v188, v56, v86
v_mfma_f32_16x16x32_bf16 v[224:227], a[116:119], a[44:47], v[224:227]
v_fmac_f32 v212, v56, v88
v_mfma_f32_16x16x32_bf16 v[200:203], a[116:119], a[40:43], v[200:203]
v_fmac_f32 v216, v60, v88
v_mfma_f32_16x16x32_bf16 v[176:179], a[116:119], a[36:39], v[176:179]
v_fmac_f32 v192, v60, v86
v_mfma_f32_16x16x32_bf16 v[152:155], a[116:119], a[32:35], v[152:155]
buffer_load_dwordx4 a[28:31], v2, s[40:43], s35 offen offset:3072 sc1
s_add_u32 s35, s35, 4096
v_mfma_f32_16x16x32_bf16 a[88:91], a[120:123], a[64:67], a[88:91]
s_and_b32 s35, s35, 0x1ffff
v_fmac_f32 v168, v60, v84
v_mfma_f32_16x16x32_bf16 a[88:91], a[124:127], a[68:71], a[88:91]
v_fmac_f32 v144, v60, v82
s_waitcnt vmcnt(11) lgkmcnt(0)
v_mfma_f32_16x16x32_bf16 v[132:135], a[128:131], a[48:51], v[132:135]
ds_read_b128 a[96:99], v5 offset:24576
v_fmac_f32 v148, v64, v82
v_mfma_f32_16x16x32_bf16 v[156:159], a[128:131], a[52:55], v[156:159]
buffer_load_dwordx4 a[32:35], v2, s[40:43], s35 offen offset:0 sc1
s_lshl_b32 s90, s28, 12
v_mfma_f32_16x16x32_bf16 v[180:183], a[128:131], a[56:59], v[180:183]
ds_read_b128 a[100:103], v5 offset:25600
v_fmac_f32 v172, v64, v84
v_mfma_f32_16x16x32_bf16 v[204:207], a[128:131], a[60:63], v[204:207]
v_fmac_f32 v196, v64, v86
v_fmac_f32 v220, v64, v88
v_mfma_f32_16x16x32_bf16 v[208:211], a[132:135], a[60:63], v[208:211]
v_fmac_f32 v224, v68, v88
v_fmac_f32 v200, v68, v86
v_mfma_f32_16x16x32_bf16 v[184:187], a[132:135], a[56:59], v[184:187]
buffer_load_dwordx4 a[36:39], v2, s[40:43], s35 offen offset:1024 sc1
s_add_u32 s90, s90, 147456
v_mfma_f32_16x16x32_bf16 v[160:163], a[132:135], a[52:55], v[160:163]
ds_read_b128 a[104:107], v5 offset:26624
v_fmac_f32 v176, v68, v84
v_mfma_f32_16x16x32_bf16 v[136:139], a[132:135], a[48:51], v[136:139]
v_fmac_f32 v152, v68, v82
v_add_u32 v234, s90, v1
v_mfma_f32_16x16x32_bf16 v[140:143], a[136:139], a[48:51], v[140:143]
ds_read_b128 a[108:111], v5 offset:27648
s_lshl_b32 s90, s28, 10
v_mfma_f32_16x16x32_bf16 v[164:167], a[136:139], a[52:55], v[164:167]
buffer_store_dwordx4 a[188:191], v1, s[4:7], s96 offen offset:0 sc1
s_add_u32 s90, s90, 147456
v_mfma_f32_16x16x32_bf16 v[188:191], a[136:139], a[56:59], v[188:191]
ds_read_b128 a[112:115], v5 offset:28672
v_fmac_f32 v133, v49, v82
v_mfma_f32_16x16x32_bf16 v[212:215], a[136:139], a[60:63], v[212:215]
v_fmac_f32 v157, v49, v84
v_fmac_f32 v181, v49, v86
v_mfma_f32_16x16x32_bf16 v[216:219], a[140:143], a[60:63], v[216:219]
v_fmac_f32 v205, v49, v88
v_add_u32 v235, s90, v1
v_mfma_f32_16x16x32_bf16 v[192:195], a[140:143], a[56:59], v[192:195]
ds_read_b128 a[116:119], v5 offset:29696
v_fmac_f32 v209, v53, v88
v_mfma_f32_16x16x32_bf16 v[168:171], a[140:143], a[52:55], v[168:171]
v_fmac_f32 v185, v53, v86
v_mfma_f32_16x16x32_bf16 v[144:147], a[140:143], a[48:51], v[144:147]
v_fmac_f32 v161, v53, v84
v_mfma_f32_16x16x32_bf16 v[148:151], a[144:147], a[48:51], v[148:151]
v_fmac_f32 v137, v53, v82
v_mfma_f32_16x16x32_bf16 v[172:175], a[144:147], a[52:55], v[172:175]
v_fmac_f32 v141, v57, v82
v_mfma_f32_16x16x32_bf16 v[196:199], a[144:147], a[56:59], v[196:199]
buffer_load_dwordx4 a[40:43], v2, s[40:43], s35 offen offset:2048 sc1
v_mfma_f32_16x16x32_bf16 v[220:223], a[144:147], a[60:63], v[220:223]
v_fmac_f32 v165, v57, v84
v_fmac_f32 v189, v57, v86
v_mfma_f32_16x16x32_bf16 v[224:227], a[148:151], a[60:63], v[224:227]
v_fmac_f32 v213, v57, v88
v_mfma_f32_16x16x32_bf16 v[200:203], a[148:151], a[56:59], v[200:203]
v_fmac_f32 v217, v61, v88
v_mfma_f32_16x16x32_bf16 v[176:179], a[148:151], a[52:55], v[176:179]
buffer_load_dwordx4 a[44:47], v2, s[40:43], s35 offen offset:3072 sc1
s_add_u32 s35, s35, 4096
v_mfma_f32_16x16x32_bf16 v[152:155], a[148:151], a[48:51], v[152:155]
s_and_b32 s35, s35, 0x1ffff
v_fmac_f32 v193, v61, v86
v_mfma_f32_16x16x32_bf16 a[92:95], a[152:155], a[64:67], a[92:95]
v_fmac_f32 v169, v61, v84
v_fmac_f32 v145, v61, v82
v_mfma_f32_16x16x32_bf16 a[92:95], a[156:159], a[68:71], a[92:95]
v_fmac_f32 v149, v65, v82
s_waitcnt vmcnt(11) lgkmcnt(0)
v_mfma_f32_16x16x32_bf16 v[132:135], a[96:99], a[0:3], v[132:135]
ds_read_b128 a[128:131], v5 offset:30720
v_fmac_f32 v173, v65, v84
v_mfma_f32_16x16x32_bf16 v[156:159], a[96:99], a[4:7], v[156:159]
buffer_load_dwordx4 a[48:51], v2, s[40:43], s35 offen offset:0 sc1
v_mfma_f32_16x16x32_bf16 v[180:183], a[96:99], a[8:11], v[180:183]
ds_read_b128 a[132:135], v5 offset:31744
v_fmac_f32 v197, v65, v86
v_mfma_f32_16x16x32_bf16 v[204:207], a[96:99], a[12:15], v[204:207]
v_fmac_f32 v221, v65, v88
v_fmac_f32 v225, v69, v88
v_mfma_f32_16x16x32_bf16 v[208:211], a[100:103], a[12:15], v[208:211]
v_fmac_f32 v201, v69, v86
v_mfma_f32_16x16x32_bf16 v[184:187], a[100:103], a[8:11], v[184:187]
buffer_load_dwordx4 a[52:55], v2, s[40:43], s35 offen offset:1024 sc1
v_mfma_f32_16x16x32_bf16 v[160:163], a[100:103], a[4:7], v[160:163]
ds_read_b128 a[136:139], v5 offset:32768
v_fmac_f32 v177, v69, v84
v_mfma_f32_16x16x32_bf16 v[136:139], a[100:103], a[0:3], v[136:139]
v_fmac_f32 v153, v69, v82
v_mfma_f32_16x16x32_bf16 v[140:143], a[104:107], a[0:3], v[140:143]
ds_read_b128 a[140:143], v5 offset:33792
v_mfma_f32_16x16x32_bf16 v[164:167], a[104:107], a[4:7], v[164:167]
buffer_store_dwordx4 a[192:195], v1, s[4:7], s97 offen offset:0 sc1
v_mfma_f32_16x16x32_bf16 v[188:191], a[104:107], a[8:11], v[188:191]
ds_read_b128 a[144:147], v5 offset:34816
v_fmac_f32 v134, v50, v82
v_mfma_f32_16x16x32_bf16 v[212:215], a[104:107], a[12:15], v[212:215]
v_fmac_f32 v158, v50, v84
v_fmac_f32 v182, v50, v86
v_mfma_f32_16x16x32_bf16 v[216:219], a[108:111], a[12:15], v[216:219]
v_fmac_f32 v206, v50, v88
v_mfma_f32_16x16x32_bf16 v[192:195], a[108:111], a[8:11], v[192:195]
ds_read_b128 a[148:151], v5 offset:35840
v_fmac_f32 v210, v54, v88
v_mfma_f32_16x16x32_bf16 v[168:171], a[108:111], a[4:7], v[168:171]
v_fmac_f32 v186, v54, v86
v_mfma_f32_16x16x32_bf16 v[144:147], a[108:111], a[0:3], v[144:147]
v_fmac_f32 v162, v54, v84
v_mfma_f32_16x16x32_bf16 v[148:151], a[112:115], a[0:3], v[148:151]
v_fmac_f32 v138, v54, v82
v_mfma_f32_16x16x32_bf16 v[172:175], a[112:115], a[4:7], v[172:175]
buffer_load_dwordx4 a[56:59], v2, s[40:43], s35 offen offset:2048 sc1
v_mfma_f32_16x16x32_bf16 v[196:199], a[112:115], a[8:11], v[196:199]
v_fmac_f32 v142, v58, v82
v_fmac_f32 v166, v58, v84
v_mfma_f32_16x16x32_bf16 v[220:223], a[112:115], a[12:15], v[220:223]
v_fmac_f32 v190, v58, v86
v_mfma_f32_16x16x32_bf16 v[224:227], a[116:119], a[12:15], v[224:227]
v_fmac_f32 v214, v58, v88
v_mfma_f32_16x16x32_bf16 v[200:203], a[116:119], a[8:11], v[200:203]
buffer_load_dwordx4 a[60:63], v2, s[40:43], s35 offen offset:3072 sc1
s_add_u32 s35, s35, 4096
v_mfma_f32_16x16x32_bf16 v[176:179], a[116:119], a[4:7], v[176:179]
s_and_b32 s35, s35, 0x1ffff
v_fmac_f32 v218, v62, v88
v_mfma_f32_16x16x32_bf16 v[152:155], a[116:119], a[0:3], v[152:155]
v_fmac_f32 v194, v62, v86
s_waitcnt vmcnt(10) lgkmcnt(0)
v_mfma_f32_16x16x32_bf16 v[132:135], a[128:131], a[16:19], v[132:135]
ds_read_b128 a[96:99], v5 offset:36864
v_fmac_f32 v170, v62, v84
v_mfma_f32_16x16x32_bf16 v[156:159], a[128:131], a[20:23], v[156:159]
buffer_store_dwordx4 a[196:199], v1, s[4:7], s96 offen offset:1024 sc1
v_mfma_f32_16x16x32_bf16 v[180:183], a[128:131], a[24:27], v[180:183]
ds_read_b128 a[100:103], v5 offset:37888
v_fmac_f32 v146, v62, v82
v_mfma_f32_16x16x32_bf16 v[204:207], a[128:131], a[28:31], v[204:207]
v_fmac_f32 v150, v66, v82
v_fmac_f32 v174, v66, v84
v_mfma_f32_16x16x32_bf16 v[208:211], a[132:135], a[28:31], v[208:211]
v_fmac_f32 v198, v66, v86
v_fmac_f32 v222, v66, v88
v_mfma_f32_16x16x32_bf16 v[184:187], a[132:135], a[24:27], v[184:187]
ds_read_b128 a[104:107], v5 offset:38912
v_fmac_f32 v226, v70, v88
v_mfma_f32_16x16x32_bf16 v[160:163], a[132:135], a[20:23], v[160:163]
v_fmac_f32 v202, v70, v86
v_mfma_f32_16x16x32_bf16 v[136:139], a[132:135], a[16:19], v[136:139]
v_fmac_f32 v178, v70, v84
v_mfma_f32_16x16x32_bf16 v[140:143], a[136:139], a[16:19], v[140:143]
ds_read_b128 a[108:111], v5 offset:39936
v_fmac_f32 v154, v70, v82
v_mfma_f32_16x16x32_bf16 v[164:167], a[136:139], a[20:23], v[164:167]
buffer_store_dwordx4 a[200:203], v1, s[4:7], s97 offen offset:1024 sc1
v_mfma_f32_16x16x32_bf16 v[188:191], a[136:139], a[24:27], v[188:191]
ds_read_b128 a[112:115], v5 offset:40960
v_fmac_f32 v135, v51, v82
v_mfma_f32_16x16x32_bf16 v[212:215], a[136:139], a[28:31], v[212:215]
v_fmac_f32 v159, v51, v84
v_fmac_f32 v183, v51, v86
v_mfma_f32_16x16x32_bf16 v[216:219], a[140:143], a[28:31], v[216:219]
v_fmac_f32 v207, v51, v88
v_mfma_f32_16x16x32_bf16 v[192:195], a[140:143], a[24:27], v[192:195]
ds_read_b128 a[116:119], v5 offset:41984
v_fmac_f32 v211, v55, v88
v_mfma_f32_16x16x32_bf16 v[168:171], a[140:143], a[20:23], v[168:171]
v_fmac_f32 v187, v55, v86
v_mfma_f32_16x16x32_bf16 v[144:147], a[140:143], a[16:19], v[144:147]
v_fmac_f32 v163, v55, v84
v_mfma_f32_16x16x32_bf16 v[148:151], a[144:147], a[16:19], v[148:151]
v_fmac_f32 v139, v55, v82
v_mfma_f32_16x16x32_bf16 v[172:175], a[144:147], a[20:23], v[172:175]
buffer_store_dwordx4 a[204:207], v1, s[4:7], s96 offen offset:2048 sc1
v_mfma_f32_16x16x32_bf16 v[196:199], a[144:147], a[24:27], v[196:199]
v_fmac_f32 v143, v59, v82
v_fmac_f32 v167, v59, v84
v_mfma_f32_16x16x32_bf16 v[220:223], a[144:147], a[28:31], v[220:223]
v_fmac_f32 v191, v59, v86
v_mfma_f32_16x16x32_bf16 v[224:227], a[148:151], a[28:31], v[224:227]
v_fmac_f32 v215, v59, v88
v_mfma_f32_16x16x32_bf16 v[200:203], a[148:151], a[24:27], v[200:203]
v_fmac_f32 v219, v63, v88
v_mfma_f32_16x16x32_bf16 v[176:179], a[148:151], a[20:23], v[176:179]
v_fmac_f32 v195, v63, v86
v_mfma_f32_16x16x32_bf16 v[152:155], a[148:151], a[16:19], v[152:155]
v_fmac_f32 v171, v63, v84
s_waitcnt vmcnt(8) lgkmcnt(0)
v_mfma_f32_16x16x32_bf16 v[132:135], a[96:99], a[32:35], v[132:135]
ds_read_b128 a[128:131], v5 offset:43008
v_fmac_f32 v147, v63, v82
v_mfma_f32_16x16x32_bf16 v[156:159], a[96:99], a[36:39], v[156:159]
buffer_store_dwordx4 a[208:211], v1, s[4:7], s97 offen offset:2048 sc1
v_mfma_f32_16x16x32_bf16 v[180:183], a[96:99], a[40:43], v[180:183]
ds_read_b128 a[132:135], v5 offset:44032
v_fmac_f32 v151, v67, v82
v_mfma_f32_16x16x32_bf16 v[204:207], a[96:99], a[44:47], v[204:207]
v_fmac_f32 v175, v67, v84
v_fmac_f32 v199, v67, v86
v_mfma_f32_16x16x32_bf16 v[208:211], a[100:103], a[44:47], v[208:211]
v_fmac_f32 v223, v67, v88
v_mfma_f32_16x16x32_bf16 v[184:187], a[100:103], a[40:43], v[184:187]
ds_read_b128 a[136:139], v5 offset:45056
v_fmac_f32 v227, v71, v88
v_mfma_f32_16x16x32_bf16 v[160:163], a[100:103], a[36:39], v[160:163]
v_fmac_f32 v203, v71, v86
v_mfma_f32_16x16x32_bf16 v[136:139], a[100:103], a[32:35], v[136:139]
v_fmac_f32 v179, v71, v84
v_mfma_f32_16x16x32_bf16 v[140:143], a[104:107], a[32:35], v[140:143]
ds_read_b128 a[140:143], v5 offset:46080
v_fmac_f32 v155, v71, v82
v_mfma_f32_16x16x32_bf16 v[164:167], a[104:107], a[36:39], v[164:167]
ds_write_b128 v234, a[80:83] offset:0
v_mfma_f32_16x16x32_bf16 v[188:191], a[104:107], a[40:43], v[188:191]
ds_read_b128 a[144:147], v5 offset:47104
v_mfma_f32_16x16x32_bf16 v[212:215], a[104:107], a[44:47], v[212:215]
ds_write_b128 v234, a[84:87] offset:1024
v_mfma_f32_16x16x32_bf16 v[216:219], a[108:111], a[44:47], v[216:219]
ds_write_b128 v234, a[88:91] offset:2048
v_mfma_f32_16x16x32_bf16 v[192:195], a[108:111], a[40:43], v[192:195]
ds_read_b128 a[148:151], v5 offset:48128
v_mfma_f32_16x16x32_bf16 v[168:171], a[108:111], a[36:39], v[168:171]
ds_write_b128 v234, a[92:95] offset:3072
v_mfma_f32_16x16x32_bf16 v[144:147], a[108:111], a[32:35], v[144:147]
v_mfma_f32_16x16x32_bf16 v[148:151], a[112:115], a[32:35], v[148:151]
v_mfma_f32_16x16x32_bf16 v[172:175], a[112:115], a[36:39], v[172:175]
v_mfma_f32_16x16x32_bf16 v[196:199], a[112:115], a[40:43], v[196:199]
v_mfma_f32_16x16x32_bf16 v[220:223], a[112:115], a[44:47], v[220:223]
v_mfma_f32_16x16x32_bf16 v[224:227], a[116:119], a[44:47], v[224:227]
v_mfma_f32_16x16x32_bf16 v[200:203], a[116:119], a[40:43], v[200:203]
v_mfma_f32_16x16x32_bf16 v[176:179], a[116:119], a[36:39], v[176:179]
v_mfma_f32_16x16x32_bf16 v[152:155], a[116:119], a[32:35], v[152:155]
s_waitcnt vmcnt(4) lgkmcnt(0)
s_barrier
v_mfma_f32_16x16x32_bf16 v[132:135], a[128:131], a[48:51], v[132:135]
ds_read_b128 v[92:95], v235 offset:0
v_mfma_f32_16x16x32_bf16 v[156:159], a[128:131], a[52:55], v[156:159]
v_mfma_f32_16x16x32_bf16 v[180:183], a[128:131], a[56:59], v[180:183]
ds_read_b128 v[96:99], v235 offset:4096
v_mfma_f32_16x16x32_bf16 v[204:207], a[128:131], a[60:63], v[204:207]
v_mfma_f32_16x16x32_bf16 v[208:211], a[132:135], a[60:63], v[208:211]
ds_read_b128 v[100:103], v235 offset:8192
v_mfma_f32_16x16x32_bf16 v[184:187], a[132:135], a[56:59], v[184:187]
v_mfma_f32_16x16x32_bf16 v[160:163], a[132:135], a[52:55], v[160:163]
ds_read_b128 v[104:107], v235 offset:12288
v_mfma_f32_16x16x32_bf16 v[136:139], a[132:135], a[48:51], v[136:139]
v_mfma_f32_16x16x32_bf16 v[140:143], a[136:139], a[48:51], v[140:143]
v_mfma_f32_16x16x32_bf16 v[164:167], a[136:139], a[52:55], v[164:167]
v_mfma_f32_16x16x32_bf16 v[188:191], a[136:139], a[56:59], v[188:191]
v_mfma_f32_16x16x32_bf16 v[212:215], a[136:139], a[60:63], v[212:215]
v_mfma_f32_16x16x32_bf16 v[216:219], a[140:143], a[60:63], v[216:219]
v_mfma_f32_16x16x32_bf16 v[192:195], a[140:143], a[56:59], v[192:195]
v_mfma_f32_16x16x32_bf16 v[168:171], a[140:143], a[52:55], v[168:171]
v_mfma_f32_16x16x32_bf16 v[144:147], a[140:143], a[48:51], v[144:147]
v_mfma_f32_16x16x32_bf16 v[148:151], a[144:147], a[48:51], v[148:151]
v_mfma_f32_16x16x32_bf16 v[172:175], a[144:147], a[52:55], v[172:175]
v_mfma_f32_16x16x32_bf16 v[196:199], a[144:147], a[56:59], v[196:199]
v_mfma_f32_16x16x32_bf16 v[220:223], a[144:147], a[60:63], v[220:223]
v_mfma_f32_16x16x32_bf16 v[224:227], a[148:151], a[60:63], v[224:227]
v_mfma_f32_16x16x32_bf16 v[200:203], a[148:151], a[56:59], v[200:203]
v_mfma_f32_16x16x32_bf16 v[176:179], a[148:151], a[52:55], v[176:179]
v_mfma_f32_16x16x32_bf16 v[152:155], a[148:151], a[48:51], v[152:155]
.set L_cpf0, .
s_waitcnt lgkmcnt(0)
v_cmp_gt_u32 vcc, 8, v11
s_cbranch_vccz Lpe_5
s_mov_b32 s36, 0x0
s_mov_b32 s37, 0
Lpoll_4:
s_sleep 16
buffer_load_dword v11, v255, s[16:19], s36 offen sc1
s_add_u32 s37, s37, 1
s_waitcnt vmcnt(0)
v_cmp_gt_u32 vcc, 8, v11
s_cbranch_vccz Lpe_5
s_cmp_lt_u32 s37, 0x100000
s_cbranch_scc1 Lpoll_4
Lpe_5:
s_lshl_b32 s36, s28, 12
s_lshl_b32 s37, s28, 10
s_add_u32 s44, s28, 0
s_lshl_b32 s45, s44, 12
s_add_u32 m0, s45, 32768
s_and_b32 s45, s44, 7
s_cmp_eq_u32 s45, s3
s_cselect_b32 s45, 8, 0
s_add_u32 s44, s44, s45
s_and_b32 s44, s44, 31
s_lshl_b32 s44, s44, 12
s_add_u32 s44, s44, s51
buffer_load_dwordx4 v1, s[4:7], s44 offen offset:0 sc1 lds
v_add_f32 v92, v92, v96
buffer_load_dwordx4 v1, s[4:7], s44 offen offset:1024 sc1 lds
v_add_f32 v100, v100, v104
v_add_f32 v93, v93, v97
v_add_f32 v101, v101, v105
v_add_f32 v94, v94, v98
v_add_f32 v102, v102, v106
v_add_f32 v95, v95, v99
v_add_f32 v103, v103, v107
v_add_f32 v228, v92, v100
v_add_f32 v229, v93, v101
buffer_load_dwordx4 v1, s[4:7], s44 offen offset:2048 sc1 lds
v_add_f32 v230, v94, v102
v_add_f32 v231, v95, v103
v_fmac_f32 v228, v72, v90
v_fmac_f32 v229, v73, v90
v_pk_mul_f32 v[212:213], v[212:213], v[88:89] op_sel:[0,1] op_sel_hi:[1,1]
v_pk_mul_f32 v[220:221], v[220:221], v[88:89] op_sel:[0,1] op_sel_hi:[1,1]
v_pk_mul_f32 v[196:197], v[196:197], v[86:87] op_sel:[0,1] op_sel_hi:[1,1]
v_pk_mul_f32 v[172:173], v[172:173], v[84:85] op_sel:[0,1] op_sel_hi:[1,1]
v_pk_mul_f32 v[148:149], v[148:149], v[82:83] op_sel:[0,1] op_sel_hi:[1,1]
v_fmac_f32 v230, v74, v90
v_fmac_f32 v231, v75, v90
v_pk_mul_f32 v[228:229], v[228:229], v[90:91] op_sel:[0,1] op_sel_hi:[1,1]
v_pk_mul_f32 v[214:215], v[214:215], v[88:89] op_sel:[0,1] op_sel_hi:[1,1]
buffer_load_dwordx4 v1, s[4:7], s44 offen offset:3072 sc1 lds
s_add_u32 s44, s28, 4
s_lshl_b32 s45, s44, 12
s_add_u32 m0, s45, 32768
s_and_b32 s45, s44, 7
s_cmp_eq_u32 s45, s3
s_cselect_b32 s45, 8, 0
s_add_u32 s44, s44, s45
s_and_b32 s44, s44, 31
s_lshl_b32 s44, s44, 12
s_add_u32 s44, s44, s51
v_pk_mul_f32 v[222:223], v[222:223], v[88:89] op_sel:[0,1] op_sel_hi:[1,1]
v_pk_mul_f32 v[198:199], v[198:199], v[86:87] op_sel:[0,1] op_sel_hi:[1,1]
v_pk_mul_f32 v[174:175], v[174:175], v[84:85] op_sel:[0,1] op_sel_hi:[1,1]
buffer_load_dwordx4 v1, s[4:7], s44 offen offset:0 sc1 lds
v_pk_mul_f32 v[150:151], v[150:151], v[82:83] op_sel:[0,1] op_sel_hi:[1,1]
v_cvt_pk_bf16_f32 v212, v212, v213
v_cvt_pk_bf16_f32 v220, v220, v221
v_cvt_pk_bf16_f32 v196, v196, v197
v_cvt_pk_bf16_f32 v172, v172, v173
v_cvt_pk_bf16_f32 v148, v148, v149
v_pk_mul_f32 v[230:231], v[230:231], v[90:91] op_sel:[0,1] op_sel_hi:[1,1]
v_pk_mul_f32 v[216:217], v[216:217], v[88:89] op_sel:[0,1] op_sel_hi:[1,1]
v_pk_mul_f32 v[218:219], v[218:219], v[88:89] op_sel:[0,1] op_sel_hi:[1,1]
v_pk_mul_f32 v[224:225], v[224:225], v[88:89] op_sel:[0,1] op_sel_hi:[1,1]
v_pk_mul_f32 v[226:227], v[226:227], v[88:89] op_sel:[0,1] op_sel_hi:[1,1]
v_pk_mul_f32 v[200:201], v[200:201], v[86:87] op_sel:[0,1] op_sel_hi:[1,1]
v_pk_mul_f32 v[202:203], v[202:203], v[86:87] op_sel:[0,1] op_sel_hi:[1,1]
buffer_load_dwordx4 v1, s[4:7], s44 offen offset:1024 sc1 lds
v_pk_mul_f32 v[176:177], v[176:177], v[84:85] op_sel:[0,1] op_sel_hi:[1,1]
v_pk_mul_f32 v[178:179], v[178:179], v[84:85] op_sel:[0,1] op_sel_hi:[1,1]
v_pk_mul_f32 v[152:153], v[152:153], v[82:83] op_sel:[0,1] op_sel_hi:[1,1]
v_pk_mul_f32 v[154:155], v[154:155], v[82:83] op_sel:[0,1] op_sel_hi:[1,1]
v_cvt_pk_bf16_f32 v228, v228, v229
v_cvt_pk_bf16_f32 v213, v214, v215
v_cvt_pk_bf16_f32 v221, v222, v223
v_cvt_pk_bf16_f32 v197, v198, v199
v_cvt_pk_bf16_f32 v173, v174, v175
v_cvt_pk_bf16_f32 v149, v150, v151
v_pk_mul_f32 v[188:189], v[188:189], v[86:87] op_sel:[0,1] op_sel_hi:[1,1]
v_pk_mul_f32 v[164:165], v[164:165], v[84:85] op_sel:[0,1] op_sel_hi:[1,1]
v_pk_mul_f32 v[140:141], v[140:141], v[82:83] op_sel:[0,1] op_sel_hi:[1,1]
buffer_load_dwordx4 v1, s[4:7], s44 offen offset:2048 sc1 lds
v_add_u32 v232, s36, v7
v_add_u32 v233, s37, v1
v_cvt_pk_bf16_f32 v229, v230, v231
v_cvt_pk_bf16_f32 v214, v216, v217
v_cvt_pk_bf16_f32 v215, v218, v219
v_cvt_pk_bf16_f32 v222, v224, v225
v_cvt_pk_bf16_f32 v223, v226, v227
v_cvt_pk_bf16_f32 v198, v200, v201
v_cvt_pk_bf16_f32 v199, v202, v203
v_cvt_pk_bf16_f32 v174, v176, v177
v_cvt_pk_bf16_f32 v175, v178, v179
v_cvt_pk_bf16_f32 v150, v152, v153
v_cvt_pk_bf16_f32 v151, v154, v155
v_pk_mul_f32 v[190:191], v[190:191], v[86:87] op_sel:[0,1] op_sel_hi:[1,1]
v_pk_mul_f32 v[166:167], v[166:167], v[84:85] op_sel:[0,1] op_sel_hi:[1,1]
v_pk_mul_f32 v[142:143], v[142:143], v[82:83] op_sel:[0,1] op_sel_hi:[1,1]
v_cvt_pk_bf16_f32 v188, v188, v189
v_cvt_pk_bf16_f32 v164, v164, v165
v_cvt_pk_bf16_f32 v140, v140, v141
v_cvt_pk_bf16_f32 v132, v132, v133
v_cvt_pk_bf16_f32 v156, v156, v157
v_cvt_pk_bf16_f32 v180, v180, v181
v_cvt_pk_bf16_f32 v204, v204, v205
ds_write_b64 v9, v[228:229]
ds_write_b64 v232, v[220:221] offset:4096
ds_write_b64 v232, v[222:223] offset:4608
v_pk_mul_f32 v[192:193], v[192:193], v[86:87] op_sel:[0,1] op_sel_hi:[1,1]
v_pk_mul_f32 v[194:195], v[194:195], v[86:87] op_sel:[0,1] op_sel_hi:[1,1]
v_pk_mul_f32 v[168:169], v[168:169], v[84:85] op_sel:[0,1] op_sel_hi:[1,1]
ds_write_b64 v232, v[196:197] offset:3072
v_pk_mul_f32 v[170:171], v[170:171], v[84:85] op_sel:[0,1] op_sel_hi:[1,1]
v_pk_mul_f32 v[144:145], v[144:145], v[82:83] op_sel:[0,1] op_sel_hi:[1,1]
v_pk_mul_f32 v[146:147], v[146:147], v[82:83] op_sel:[0,1] op_sel_hi:[1,1]
ds_write_b64 v232, v[198:199] offset:3584
buffer_load_dwordx4 v1, s[4:7], s44 offen offset:3072 sc1 lds
v_cvt_pk_bf16_f32 v189, v190, v191
ds_write_b64 v232, v[172:173] offset:2048
v_cvt_pk_bf16_f32 v165, v166, v167
v_cvt_pk_bf16_f32 v141, v142, v143
ds_write_b64 v232, v[174:175] offset:2560
v_cvt_pk_bf16_f32 v133, v134, v135
v_cvt_pk_bf16_f32 v157, v158, v159
v_cvt_pk_bf16_f32 v181, v182, v183
ds_write_b64 v232, v[148:149] offset:1024
v_cvt_pk_bf16_f32 v205, v206, v207
v_cvt_pk_bf16_f32 v190, v192, v193
v_cvt_pk_bf16_f32 v191, v194, v195
ds_write_b64 v232, v[150:151] offset:1536
v_cvt_pk_bf16_f32 v166, v168, v169
v_cvt_pk_bf16_f32 v167, v170, v171
v_cvt_pk_bf16_f32 v142, v144, v145
ds_write_b128 v233, v[212:215] offset:21504
v_cvt_pk_bf16_f32 v143, v146, v147
v_cvt_pk_bf16_f32 v134, v136, v137
v_cvt_pk_bf16_f32 v135, v138, v139
v_cvt_pk_bf16_f32 v158, v160, v161
v_cvt_pk_bf16_f32 v159, v162, v163
v_cvt_pk_bf16_f32 v182, v184, v185
v_cvt_pk_bf16_f32 v183, v186, v187
v_cvt_pk_bf16_f32 v206, v208, v209
v_cvt_pk_bf16_f32 v207, v210, v211
s_waitcnt lgkmcnt(0)
s_barrier
ds_read_b128 a[0:3], v233 offset:20480
v_mfma_f32_16x16x32_bf16 v[184:187], v[164:167], v[180:183], v[20:23]
s_lshl_b32 s35, s30, 12
s_add_u32 s35, s35, 0x1e00000
v_mfma_f32_16x16x32_bf16 v[200:203], v[188:191], v[180:183], v[24:27]
s_add_u32 s44, s28, 8
s_lshl_b32 s45, s44, 12
v_mfma_f32_16x16x32_bf16 v[208:211], v[188:191], v[204:207], v[20:23]
s_add_u32 m0, s45, 32768
s_and_b32 s45, s44, 7
v_mfma_f32_16x16x32_bf16 v[224:227], v[212:215], v[204:207], v[24:27]
s_nop 1
v_max_f32 v200, v200, v184
v_max_f32 v201, v201, v185
v_mfma_f32_16x16x32_bf16 v[152:155], v[140:143], v[132:135], v[24:27]
v_max_f32 v202, v202, v186
v_max_f32 v203, v203, v187
v_mfma_f32_16x16x32_bf16 v[160:163], v[140:143], v[156:159], v[20:23]
v_max_f32 v224, v224, v208
v_max_f32 v225, v225, v209
v_mfma_f32_16x16x32_bf16 v[176:179], v[164:167], v[156:159], v[24:27]
v_max_f32 v226, v226, v210
v_max3_f32 v238, v200, v201, v202
s_waitcnt lgkmcnt(0)
v_mfma_f32_16x16x32_bf16 v[136:139], a[0:3], v[132:135], v[76:79]
v_max_f32 v227, v227, v211
v_max3_f32 v239, v224, v225, v226
v_max_f32 v238, v238, v203
v_max_f32 v239, v239, v227
v_max_f32 v176, v176, v160
v_max_f32 v177, v177, v161
v_permlane32_swap_b32 v239, v238
s_nop 0
v_max_f32 v152, v152, v136
v_max_f32 v153, v153, v137
v_max_f32 v154, v154, v138
v_max_f32 v178, v178, v162
v_max_f32 v155, v155, v139
v_max3_f32 v236, v152, v153, v154
v_max_f32 v179, v179, v163
v_max3_f32 v237, v176, v177, v178
v_max_f32 v239, v239, v238
v_max_f32 v236, v236, v155
v_max_f32 v237, v237, v179
v_mov_b32 v242, v239
s_cmp_eq_u32 s45, s3
s_cselect_b32 s45, 8, 0
v_permlane32_swap_b32 v237, v236
v_permlane16_swap_b32 v239, v242
s_add_u32 s44, s44, s45
v_add_u32 v234, s36, v8
s_and_b32 s44, s44, 31
v_max_f32 v237, v237, v236
ds_read_b64_tr_b16 a[10:11], v234 offset:3072
ds_read_b64_tr_b16 a[12:13], v234 offset:4096
v_max_f32 v239, v239, v242
s_lshl_b32 s44, s44, 12
v_mov_b32 v243, v237
ds_read_b64_tr_b16 a[22:23], v234 offset:3584
ds_read_b64_tr_b16 a[24:25], v234 offset:4608
v_mov_b32 v242, v239
s_add_u32 s44, s44, s51
ds_read_b64_tr_b16 a[8:9], v234 offset:2048
buffer_load_dwordx4 v1, s[4:7], s44 offen offset:0 sc1 lds
v_permlane16_swap_b32 v237, v243
ds_read_b64_tr_b16 a[20:21], v234 offset:2560
v_permlane32_swap_b32 v239, v242
ds_read_b64_tr_b16 a[6:7], v234 offset:1024
buffer_load_dwordx4 v1, s[4:7], s44 offen offset:1024 sc1 lds
v_mul_f32 v88, 0x3e8293ee, v89
v_max_f32 v237, v237, v243
v_mul_f32_e64 v89, -v239, v88
ds_read_b64_tr_b16 a[18:19], v234 offset:1536
v_mov_b32 v243, v237
buffer_load_dwordx4 v1, s[4:7], s44 offen offset:2048 sc1 lds
v_fma_f32 v224, v224, v88, v89
ds_read_b64_tr_b16 a[4:5], v234 offset:0
v_fma_f32 v225, v225, v88, v89
v_mul_f32 v86, 0x3e8293ee, v87
v_fma_f32 v226, v226, v88, v89
v_fma_f32 v227, v227, v88, v89
v_exp_f32 v224, v224
v_exp_f32 v225, v225
buffer_load_dwordx4 v1, s[4:7], s44 offen offset:3072 sc1 lds
v_mul_f32_e64 v87, -v242, v86
ds_read_b64_tr_b16 a[16:17], v234 offset:512
v_permlane32_swap_b32 v237, v243
v_exp_f32 v226, v226
v_exp_f32 v227, v227
v_fma_f32 v200, v200, v86, v87
v_fma_f32 v201, v201, v86, v87
v_mul_f32 v84, 0x3e8293ee, v85
s_add_u32 s44, s28, 12
v_fma_f32 v202, v202, v86, v87
v_fma_f32 v203, v203, v86, v87
v_exp_f32 v200, v200
v_exp_f32 v201, v201
v_mul_f32_e64 v85, -v237, v84
v_cvt_pk_bf16_f32 v224, v224, v225
s_lshl_b32 s45, s44, 12
v_exp_f32 v202, v202
v_exp_f32 v203, v203
v_cvt_pk_bf16_f32 v225, v226, v227
v_fma_f32 v176, v176, v84, v85
v_fma_f32 v177, v177, v84, v85
v_mul_f32 v82, 0x3e8293ee, v83
s_add_u32 m0, s45, 32768
v_fma_f32 v178, v178, v84, v85
v_fma_f32 v179, v179, v84, v85
v_and_b32 v208, v224, v28
v_and_b32 v209, v225, v29
v_and_b32 v210, v224, v30
v_and_b32 v211, v225, v31
v_exp_f32 v176, v176
v_exp_f32 v177, v177
s_and_b32 s45, s44, 7
v_mul_f32_e64 v83, -v243, v82
v_cvt_pk_bf16_f32 v200, v200, v201
v_exp_f32 v178, v178
v_exp_f32 v179, v179
v_cvt_pk_bf16_f32 v201, v202, v203
s_cmp_eq_u32 s45, s3
v_fma_f32 v152, v152, v82, v83
v_fma_f32 v153, v153, v82, v83
v_fma_f32 v154, v154, v82, v83
v_fma_f32 v155, v155, v82, v83
v_mfma_f32_16x16x32_bf16 v[216:219], v[16:19], v[208:211], 0
v_and_b32 v184, v200, v28
v_and_b32 v185, v201, v29
v_and_b32 v186, v200, v30
v_and_b32 v187, v201, v31
s_cselect_b32 s45, 8, 0
v_exp_f32 v152, v152
v_exp_f32 v153, v153
v_cvt_pk_bf16_f32 v176, v176, v177
v_exp_f32 v154, v154
v_exp_f32 v155, v155
s_add_u32 s44, s44, s45
v_cvt_pk_bf16_f32 v177, v178, v179
v_mfma_f32_16x16x32_bf16 v[192:195], v[16:19], v[184:187], 0
s_and_b32 s44, s44, 31
v_and_b32 v160, v176, v28
v_and_b32 v161, v177, v29
v_and_b32 v162, v176, v30
v_and_b32 v163, v177, v31
s_waitcnt lgkmcnt(8)
v_mfma_f32_16x16x32_bf16 v[116:119], a[10:13], v[208:211], 0
v_cvt_pk_bf16_f32 v152, v152, v153
s_lshl_b32 s44, s44, 12
v_cvt_pk_bf16_f32 v153, v154, v155
s_waitcnt lgkmcnt(6)
v_mfma_f32_16x16x32_bf16 v[120:123], a[22:25], v[208:211], 0
s_add_u32 s44, s44, s51
v_and_b32 v136, v152, v80
v_mfma_f32_16x16x32_bf16 v[168:171], v[16:19], v[160:163], 0
v_and_b32 v137, v153, v81
v_and_b32 v138, v152, v30
v_and_b32 v139, v153, v31
s_waitcnt lgkmcnt(5)
v_mfma_f32_16x16x32_bf16 v[108:111], a[8:11], v[184:187], 0
buffer_load_dwordx4 v1, s[4:7], s44 offen offset:0 sc1 lds
s_waitcnt lgkmcnt(4)
v_mfma_f32_16x16x32_bf16 v[112:115], a[20:23], v[184:187], 0
v_rcp_f32 v216, v216
v_mfma_f32_16x16x32_bf16 v[144:147], v[16:19], v[136:139], 0
buffer_load_dwordx4 v1, s[4:7], s44 offen offset:1024 sc1 lds
s_waitcnt lgkmcnt(3)
v_mfma_f32_16x16x32_bf16 v[100:103], a[6:9], v[160:163], 0
v_rcp_f32 v192, v192
s_waitcnt lgkmcnt(2)
v_mfma_f32_16x16x32_bf16 v[104:107], a[18:21], v[160:163], 0
buffer_load_dwordx4 v1, s[4:7], s44 offen offset:2048 sc1 lds
s_waitcnt lgkmcnt(1)
v_mfma_f32_16x16x32_bf16 v[92:95], a[4:7], v[136:139], 0
v_rcp_f32 v168, v168
s_waitcnt lgkmcnt(0)
v_mfma_f32_16x16x32_bf16 v[96:99], a[16:19], v[136:139], 0
v_rcp_f32 v144, v144
v_pk_mul_f32 v[116:117], v[116:117], v[216:217] op_sel:[0,0] op_sel_hi:[1,0]
v_pk_mul_f32 v[118:119], v[118:119], v[216:217] op_sel:[0,0] op_sel_hi:[1,0]
v_cvt_pk_bf16_f32 v116, v116, v117
v_pk_mul_f32 v[120:121], v[120:121], v[216:217] op_sel:[0,0] op_sel_hi:[1,0]
v_pk_mul_f32 v[122:123], v[122:123], v[216:217] op_sel:[0,0] op_sel_hi:[1,0]
buffer_load_dwordx4 v1, s[4:7], s44 offen offset:3072 sc1 lds
v_cvt_pk_bf16_f32 v117, v118, v119
v_pk_mul_f32 v[108:109], v[108:109], v[192:193] op_sel:[0,0] op_sel_hi:[1,0]
v_cvt_pk_bf16_f32 v118, v120, v121
v_cvt_pk_bf16_f32 v119, v122, v123
v_pk_mul_f32 v[110:111], v[110:111], v[192:193] op_sel:[0,0] op_sel_hi:[1,0]
v_cvt_pk_bf16_f32 v108, v108, v109
v_pk_mul_f32 v[112:113], v[112:113], v[192:193] op_sel:[0,0] op_sel_hi:[1,0]
v_pk_mul_f32 v[114:115], v[114:115], v[192:193] op_sel:[0,0] op_sel_hi:[1,0]
v_cvt_pk_bf16_f32 v109, v110, v111
buffer_store_dwordx4 v[116:119], v2, s[4:7], s35 offen offset:3072 sc1
v_pk_mul_f32 v[100:101], v[100:101], v[168:169] op_sel:[0,0] op_sel_hi:[1,0]
v_cvt_pk_bf16_f32 v110, v112, v113
v_cvt_pk_bf16_f32 v111, v114, v115
v_pk_mul_f32 v[102:103], v[102:103], v[168:169] op_sel:[0,0] op_sel_hi:[1,0]
v_cvt_pk_bf16_f32 v100, v100, v101
v_pk_mul_f32 v[104:105], v[104:105], v[168:169] op_sel:[0,0] op_sel_hi:[1,0]
v_pk_mul_f32 v[106:107], v[106:107], v[168:169] op_sel:[0,0] op_sel_hi:[1,0]
v_cvt_pk_bf16_f32 v101, v102, v103
v_pk_mul_f32 v[92:93], v[92:93], v[144:145] op_sel:[0,0] op_sel_hi:[1,0]
v_cvt_pk_bf16_f32 v102, v104, v105
v_cvt_pk_bf16_f32 v103, v106, v107
v_pk_mul_f32 v[94:95], v[94:95], v[144:145] op_sel:[0,0] op_sel_hi:[1,0]
buffer_store_dwordx4 v[108:111], v2, s[4:7], s35 offen offset:2048 sc1
v_cvt_pk_bf16_f32 v92, v92, v93
v_pk_mul_f32 v[96:97], v[96:97], v[144:145] op_sel:[0,0] op_sel_hi:[1,0]
v_pk_mul_f32 v[98:99], v[98:99], v[144:145] op_sel:[0,0] op_sel_hi:[1,0]
v_cvt_pk_bf16_f32 v93, v94, v95
v_cvt_pk_bf16_f32 v94, v96, v97
v_cvt_pk_bf16_f32 v95, v98, v99
buffer_store_dwordx4 v[100:103], v2, s[4:7], s35 offen offset:1024 sc1
buffer_store_dwordx4 v[92:95], v2, s[4:7], s35 offen offset:0 sc1
s_add_u32 s92, s71, 0x0
s_add_u32 s44, s28, 16
s_lshl_b32 s45, s44, 12
s_add_u32 m0, s45, 32768
s_and_b32 s45, s44, 7
s_cmp_eq_u32 s45, s3
s_cselect_b32 s45, 8, 0
s_add_u32 s44, s44, s45
s_and_b32 s44, s44, 31
s_lshl_b32 s44, s44, 12
s_add_u32 s44, s44, s51
buffer_load_dwordx4 v1, s[4:7], s44 offen offset:0 sc1 lds
buffer_load_dwordx4 v1, s[4:7], s44 offen offset:1024 sc1 lds
buffer_load_dwordx4 v1, s[4:7], s44 offen offset:2048 sc1 lds
buffer_load_dwordx4 v1, s[4:7], s44 offen offset:3072 sc1 lds
s_add_u32 s44, s28, 20
s_lshl_b32 s45, s44, 12
s_add_u32 m0, s45, 32768
s_and_b32 s45, s44, 7
s_cmp_eq_u32 s45, s3
s_cselect_b32 s45, 8, 0
s_add_u32 s44, s44, s45
s_and_b32 s44, s44, 31
s_lshl_b32 s44, s44, 12
s_add_u32 s44, s44, s51
buffer_load_dwordx4 v1, s[4:7], s44 offen offset:0 sc1 lds
buffer_load_dwordx4 v1, s[4:7], s44 offen offset:1024 sc1 lds
buffer_load_dwordx4 v1, s[4:7], s44 offen offset:2048 sc1 lds
buffer_load_dwordx4 v1, s[4:7], s44 offen offset:3072 sc1 lds
s_add_u32 s40, s4, 0x1e00000
s_addc_u32 s41, s5, 0
v_add_u32 v5, 32768, v1
v_add_u32 v6, 98304, v1
s_cmp_eq_u32 s3, 0
s_cselect_b32 s35, 8, 0
s_lshl_b32 s35, s35, 12
v_lshlrev_b32 v132, 16, v32
v_and_b32 v133, 0xffff0000, v32
v_lshlrev_b32 v134, 16, v33
v_and_b32 v135, 0xffff0000, v33
v_lshlrev_b32 v136, 16, v34
v_and_b32 v137, 0xffff0000, v34
v_lshlrev_b32 v138, 16, v35
v_and_b32 v139, 0xffff0000, v35
v_lshlrev_b32 v140, 16, v36
v_and_b32 v141, 0xffff0000, v36
v_lshlrev_b32 v142, 16, v37
v_and_b32 v143, 0xffff0000, v37
v_lshlrev_b32 v144, 16, v38
v_and_b32 v145, 0xffff0000, v38
v_lshlrev_b32 v146, 16, v39
v_and_b32 v147, 0xffff0000, v39
v_lshlrev_b32 v148, 16, v40
v_and_b32 v149, 0xffff0000, v40
v_lshlrev_b32 v150, 16, v41
v_and_b32 v151, 0xffff0000, v41
v_lshlrev_b32 v152, 16, v42
v_and_b32 v153, 0xffff0000, v42
v_lshlrev_b32 v154, 16, v43
v_and_b32 v155, 0xffff0000, v43
v_lshlrev_b32 v156, 16, v44
v_and_b32 v157, 0xffff0000, v44
v_lshlrev_b32 v158, 16, v45
v_and_b32 v159, 0xffff0000, v45
v_lshlrev_b32 v160, 16, v46
v_and_b32 v161, 0xffff0000, v46
v_lshlrev_b32 v162, 16, v47
v_and_b32 v163, 0xffff0000, v47
s_mov_b32 s93, 128
s_waitcnt vmcnt(8)
s_barrier
buffer_atomic_add v12, v10, s[4:7], s92 offen sc1
s_add_u32 s44, s28, 24
s_lshl_b32 s45, s44, 12
s_add_u32 m0, s45, 32768
s_and_b32 s45, s44, 7
s_cmp_eq_u32 s45, s3
s_cselect_b32 s45, 8, 0
s_add_u32 s44, s44, s45
s_and_b32 s44, s44, 31
s_lshl_b32 s44, s44, 12
s_add_u32 s44, s44, s51
buffer_load_dwordx4 v1, s[4:7], s44 offen offset:0 sc1 lds
buffer_load_dwordx4 v1, s[4:7], s44 offen offset:1024 sc1 lds
buffer_load_dwordx4 v1, s[4:7], s44 offen offset:2048 sc1 lds
buffer_load_dwordx4 v1, s[4:7], s44 offen offset:3072 sc1 lds
s_add_u32 s44, s28, 28
s_lshl_b32 s45, s44, 12
s_add_u32 m0, s45, 32768
s_and_b32 s45, s44, 7
s_cmp_eq_u32 s45, s3
s_cselect_b32 s45, 8, 0
s_add_u32 s44, s44, s45
s_and_b32 s44, s44, 31
s_lshl_b32 s44, s44, 12
s_add_u32 s44, s44, s51
buffer_load_dwordx4 v1, s[4:7], s44 offen offset:0 sc1 lds
buffer_load_dwordx4 v1, s[4:7], s44 offen offset:1024 sc1 lds
buffer_load_dwordx4 v1, s[4:7], s44 offen offset:2048 sc1 lds
buffer_load_dwordx4 v1, s[4:7], s44 offen offset:3072 sc1 lds
s_cmp_lg_u32 s28, 0
s_cbranch_scc1 Lpe_7
s_add_u32 s36, s66, 0x0
s_mov_b32 s37, 0
Lpoll_6:
v_mov_b32 v11, 0
s_mov_b64 exec, 1
buffer_atomic_add v11, off, s[4:7], s36 sc0 sc1
s_waitcnt vmcnt(0)
v_readfirstlane_b32 s38, v11
s_mov_b64 exec, -1
s_nop 0
v_mov_b32 v11, s38
s_add_u32 s37, s37, 1
v_cmp_gt_u32 vcc, 32, v11
s_cbranch_vccz Lpe_7
s_cmp_lt_u32 s37, 0x100000
s_cbranch_scc1 Lpoll_6
Lpe_7:
s_waitcnt vmcnt(0)
s_barrier
L_k2go0:
buffer_load_dwordx4 a[0:3], v4, s[40:43], s35 offen offset:0 sc1
buffer_load_dwordx4 a[4:7], v4, s[40:43], s35 offen offset:1024 sc1
s_cmp_eq_u32 s3, 1
s_cselect_b32 s35, 9, 1
s_lshl_b32 s35, s35, 12
buffer_load_dwordx4 a[8:11], v4, s[40:43], s35 offen offset:0 sc1
buffer_load_dwordx4 a[12:15], v4, s[40:43], s35 offen offset:1024 sc1
s_cmp_eq_u32 s3, 2
s_cselect_b32 s35, 10, 2
s_lshl_b32 s35, s35, 12
buffer_load_dwordx4 a[16:19], v4, s[40:43], s35 offen offset:0 sc1
buffer_load_dwordx4 a[20:23], v4, s[40:43], s35 offen offset:1024 sc1
s_cmp_eq_u32 s3, 3
s_cselect_b32 s35, 11, 3
s_lshl_b32 s35, s35, 12
buffer_load_dwordx4 a[24:27], v4, s[40:43], s35 offen offset:0 sc1
buffer_load_dwordx4 a[28:31], v4, s[40:43], s35 offen offset:1024 sc1
s_cmp_eq_u32 s3, 4
s_cselect_b32 s35, 12, 4
s_lshl_b32 s35, s35, 12
buffer_load_dwordx4 a[32:35], v4, s[40:43], s35 offen offset:0 sc1
buffer_load_dwordx4 a[36:39], v4, s[40:43], s35 offen offset:1024 sc1
s_cmp_eq_u32 s3, 5
s_cselect_b32 s35, 13, 5
s_lshl_b32 s35, s35, 12
ds_read_b128 a[96:99], v5 offset:0
ds_read_b128 a[100:103], v5 offset:1024
ds_read_b128 a[104:107], v5 offset:2048
ds_read_b128 a[108:111], v5 offset:3072
s_waitcnt vmcnt(8) lgkmcnt(0)
v_mfma_f32_16x16x32_bf16 v[132:135], a[96:99], a[0:3], v[132:135]
ds_read_b128 a[112:115], v5 offset:4096
v_mfma_f32_16x16x32_bf16 v[148:151], a[96:99], a[4:7], v[148:151]
ds_read_b128 a[116:119], v5 offset:5120
v_mfma_f32_16x16x32_bf16 v[152:155], a[100:103], a[4:7], v[152:155]
buffer_load_dwordx4 a[40:43], v4, s[40:43], s35 offen offset:0 sc1
v_mfma_f32_16x16x32_bf16 v[136:139], a[100:103], a[0:3], v[136:139]
ds_read_b128 a[120:123], v5 offset:6144
v_mfma_f32_16x16x32_bf16 v[140:143], a[104:107], a[0:3], v[140:143]
ds_read_b128 a[124:127], v5 offset:7168
v_mfma_f32_16x16x32_bf16 v[156:159], a[104:107], a[4:7], v[156:159]
v_mfma_f32_16x16x32_bf16 v[160:163], a[108:111], a[4:7], v[160:163]
buffer_load_dwordx4 a[44:47], v4, s[40:43], s35 offen offset:1024 sc1
v_mfma_f32_16x16x32_bf16 v[144:147], a[108:111], a[0:3], v[144:147]
s_cmp_eq_u32 s3, 6
s_cselect_b32 s35, 14, 6
s_lshl_b32 s35, s35, 12
s_waitcnt vmcnt(8) lgkmcnt(0)
v_mfma_f32_16x16x32_bf16 v[132:135], a[112:115], a[8:11], v[132:135]
ds_read_b128 a[96:99], v5 offset:8192
v_mfma_f32_16x16x32_bf16 v[148:151], a[112:115], a[12:15], v[148:151]
ds_read_b128 a[100:103], v5 offset:9216
v_mfma_f32_16x16x32_bf16 v[152:155], a[116:119], a[12:15], v[152:155]
buffer_load_dwordx4 a[0:3], v4, s[40:43], s35 offen offset:0 sc1
v_mfma_f32_16x16x32_bf16 v[136:139], a[116:119], a[8:11], v[136:139]
ds_read_b128 a[104:107], v5 offset:10240
v_mfma_f32_16x16x32_bf16 v[140:143], a[120:123], a[8:11], v[140:143]
ds_read_b128 a[108:111], v5 offset:11264
v_mfma_f32_16x16x32_bf16 v[156:159], a[120:123], a[12:15], v[156:159]
buffer_atomic_add v12, v252, s[16:19], s93 offen sc1
v_mfma_f32_16x16x32_bf16 v[160:163], a[124:127], a[12:15], v[160:163]
buffer_load_dwordx4 a[4:7], v4, s[40:43], s35 offen offset:1024 sc1
v_mfma_f32_16x16x32_bf16 v[144:147], a[124:127], a[8:11], v[144:147]
s_cmp_eq_u32 s3, 7
s_cselect_b32 s35, 15, 7
s_lshl_b32 s35, s35, 12
s_waitcnt vmcnt(9) lgkmcnt(0)
v_mfma_f32_16x16x32_bf16 v[132:135], a[96:99], a[16:19], v[132:135]
ds_read_b128 a[112:115], v5 offset:12288
v_mfma_f32_16x16x32_bf16 v[148:151], a[96:99], a[20:23], v[148:151]
ds_read_b128 a[116:119], v5 offset:13312
v_mfma_f32_16x16x32_bf16 v[152:155], a[100:103], a[20:23], v[152:155]
buffer_load_dwordx4 a[8:11], v4, s[40:43], s35 offen offset:0 sc1
v_mfma_f32_16x16x32_bf16 v[136:139], a[100:103], a[16:19], v[136:139]
ds_read_b128 a[120:123], v5 offset:14336
v_mfma_f32_16x16x32_bf16 v[140:143], a[104:107], a[16:19], v[140:143]
ds_read_b128 a[124:127], v5 offset:15360
v_mfma_f32_16x16x32_bf16 v[156:159], a[104:107], a[20:23], v[156:159]
v_mfma_f32_16x16x32_bf16 v[160:163], a[108:111], a[20:23], v[160:163]
buffer_load_dwordx4 a[12:15], v4, s[40:43], s35 offen offset:1024 sc1
v_mfma_f32_16x16x32_bf16 v[144:147], a[108:111], a[16:19], v[144:147]
s_cmp_eq_u32 s3, 0
s_cselect_b32 s35, 16, 8
s_lshl_b32 s35, s35, 12
s_waitcnt vmcnt(9) lgkmcnt(0)
v_mfma_f32_16x16x32_bf16 v[132:135], a[112:115], a[24:27], v[132:135]
ds_read_b128 a[96:99], v5 offset:16384
v_mfma_f32_16x16x32_bf16 v[148:151], a[112:115], a[28:31], v[148:151]
ds_read_b128 a[100:103], v5 offset:17408
v_mfma_f32_16x16x32_bf16 v[152:155], a[116:119], a[28:31], v[152:155]
buffer_load_dwordx4 a[16:19], v4, s[40:43], s35 offen offset:0 sc1
v_mfma_f32_16x16x32_bf16 v[136:139], a[116:119], a[24:27], v[136:139]
ds_read_b128 a[104:107], v5 offset:18432
v_mfma_f32_16x16x32_bf16 v[140:143], a[120:123], a[24:27], v[140:143]
ds_read_b128 a[108:111], v5 offset:19456
v_mfma_f32_16x16x32_bf16 v[156:159], a[120:123], a[28:31], v[156:159]
v_mfma_f32_16x16x32_bf16 v[160:163], a[124:127], a[28:31], v[160:163]
buffer_load_dwordx4 a[20:23], v4, s[40:43], s35 offen offset:1024 sc1
v_mfma_f32_16x16x32_bf16 v[144:147], a[124:127], a[24:27], v[144:147]
s_cmp_eq_u32 s3, 1
s_cselect_b32 s35, 17, 9
s_lshl_b32 s35, s35, 12
s_waitcnt vmcnt(9) lgkmcnt(0)
v_mfma_f32_16x16x32_bf16 v[132:135], a[96:99], a[32:35], v[132:135]
ds_read_b128 a[112:115], v5 offset:20480
v_mfma_f32_16x16x32_bf16 v[148:151], a[96:99], a[36:39], v[148:151]
ds_read_b128 a[116:119], v5 offset:21504
v_mfma_f32_16x16x32_bf16 v[152:155], a[100:103], a[36:39], v[152:155]
buffer_load_dwordx4 a[24:27], v4, s[40:43], s35 offen offset:0 sc1
v_mfma_f32_16x16x32_bf16 v[136:139], a[100:103], a[32:35], v[136:139]
ds_read_b128 a[120:123], v5 offset:22528
v_mfma_f32_16x16x32_bf16 v[140:143], a[104:107], a[32:35], v[140:143]
ds_read_b128 a[124:127], v5 offset:23552
v_mfma_f32_16x16x32_bf16 v[156:159], a[104:107], a[36:39], v[156:159]
v_mfma_f32_16x16x32_bf16 v[160:163], a[108:111], a[36:39], v[160:163]
buffer_load_dwordx4 a[28:31], v4, s[40:43], s35 offen offset:1024 sc1
v_mfma_f32_16x16x32_bf16 v[144:147], a[108:111], a[32:35], v[144:147]
s_cmp_eq_u32 s3, 2
s_cselect_b32 s35, 18, 10
s_lshl_b32 s35, s35, 12
s_waitcnt vmcnt(9) lgkmcnt(0)
v_mfma_f32_16x16x32_bf16 v[132:135], a[112:115], a[40:43], v[132:135]
ds_read_b128 a[96:99], v5 offset:24576
v_mfma_f32_16x16x32_bf16 v[148:151], a[112:115], a[44:47], v[148:151]
ds_read_b128 a[100:103], v5 offset:25600
v_mfma_f32_16x16x32_bf16 v[152:155], a[116:119], a[44:47], v[152:155]
buffer_load_dwordx4 a[32:35], v4, s[40:43], s35 offen offset:0 sc1
v_mfma_f32_16x16x32_bf16 v[136:139], a[116:119], a[40:43], v[136:139]
ds_read_b128 a[104:107], v5 offset:26624
v_mfma_f32_16x16x32_bf16 v[140:143], a[120:123], a[40:43], v[140:143]
ds_read_b128 a[108:111], v5 offset:27648
v_mfma_f32_16x16x32_bf16 v[156:159], a[120:123], a[44:47], v[156:159]
v_mfma_f32_16x16x32_bf16 v[160:163], a[124:127], a[44:47], v[160:163]
buffer_load_dwordx4 a[36:39], v4, s[40:43], s35 offen offset:1024 sc1
v_mfma_f32_16x16x32_bf16 v[144:147], a[124:127], a[40:43], v[144:147]
s_cmp_eq_u32 s3, 3
s_cselect_b32 s35, 19, 11
s_lshl_b32 s35, s35, 12
s_waitcnt vmcnt(8) lgkmcnt(0)
v_mfma_f32_16x16x32_bf16 v[132:135], a[96:99], a[0:3], v[132:135]
ds_read_b128 a[112:115], v5 offset:28672
v_mfma_f32_16x16x32_bf16 v[148:151], a[96:99], a[4:7], v[148:151]
ds_read_b128 a[116:119], v5 offset:29696
v_mfma_f32_16x16x32_bf16 v[152:155], a[100:103], a[4:7], v[152:155]
buffer_load_dwordx4 a[40:43], v4, s[40:43], s35 offen offset:0 sc1
v_mfma_f32_16x16x32_bf16 v[136:139], a[100:103], a[0:3], v[136:139]
ds_read_b128 a[120:123], v5 offset:30720
v_mfma_f32_16x16x32_bf16 v[140:143], a[104:107], a[0:3], v[140:143]
ds_read_b128 a[124:127], v5 offset:31744
v_mfma_f32_16x16x32_bf16 v[156:159], a[104:107], a[4:7], v[156:159]
v_mfma_f32_16x16x32_bf16 v[160:163], a[108:111], a[4:7], v[160:163]
buffer_load_dwordx4 a[44:47], v4, s[40:43], s35 offen offset:1024 sc1
v_mfma_f32_16x16x32_bf16 v[144:147], a[108:111], a[0:3], v[144:147]
s_cmp_eq_u32 s3, 4
s_cselect_b32 s35, 20, 12
s_lshl_b32 s35, s35, 12
s_waitcnt vmcnt(8) lgkmcnt(0)
v_mfma_f32_16x16x32_bf16 v[132:135], a[112:115], a[8:11], v[132:135]
ds_read_b128 a[96:99], v5 offset:32768
v_mfma_f32_16x16x32_bf16 v[148:151], a[112:115], a[12:15], v[148:151]
ds_read_b128 a[100:103], v5 offset:33792
v_mfma_f32_16x16x32_bf16 v[152:155], a[116:119], a[12:15], v[152:155]
buffer_load_dwordx4 a[0:3], v4, s[40:43], s35 offen offset:0 sc1
v_mfma_f32_16x16x32_bf16 v[136:139], a[116:119], a[8:11], v[136:139]
ds_read_b128 a[104:107], v5 offset:34816
v_mfma_f32_16x16x32_bf16 v[140:143], a[120:123], a[8:11], v[140:143]
ds_read_b128 a[108:111], v5 offset:35840
v_mfma_f32_16x16x32_bf16 v[156:159], a[120:123], a[12:15], v[156:159]
v_mfma_f32_16x16x32_bf16 v[160:163], a[124:127], a[12:15], v[160:163]
buffer_load_dwordx4 a[4:7], v4, s[40:43], s35 offen offset:1024 sc1
v_mfma_f32_16x16x32_bf16 v[144:147], a[124:127], a[8:11], v[144:147]
s_cmp_eq_u32 s3, 5
s_cselect_b32 s35, 21, 13
s_lshl_b32 s35, s35, 12
s_waitcnt vmcnt(8) lgkmcnt(0)
v_mfma_f32_16x16x32_bf16 v[132:135], a[96:99], a[16:19], v[132:135]
ds_read_b128 a[112:115], v5 offset:36864
v_mfma_f32_16x16x32_bf16 v[148:151], a[96:99], a[20:23], v[148:151]
ds_read_b128 a[116:119], v5 offset:37888
v_mfma_f32_16x16x32_bf16 v[152:155], a[100:103], a[20:23], v[152:155]
buffer_load_dwordx4 a[8:11], v4, s[40:43], s35 offen offset:0 sc1
v_mfma_f32_16x16x32_bf16 v[136:139], a[100:103], a[16:19], v[136:139]
ds_read_b128 a[120:123], v5 offset:38912
v_mfma_f32_16x16x32_bf16 v[140:143], a[104:107], a[16:19], v[140:143]
ds_read_b128 a[124:127], v5 offset:39936
v_mfma_f32_16x16x32_bf16 v[156:159], a[104:107], a[20:23], v[156:159]
v_mfma_f32_16x16x32_bf16 v[160:163], a[108:111], a[20:23], v[160:163]
buffer_load_dwordx4 a[12:15], v4, s[40:43], s35 offen offset:1024 sc1
v_mfma_f32_16x16x32_bf16 v[144:147], a[108:111], a[16:19], v[144:147]
s_cmp_eq_u32 s3, 6
s_cselect_b32 s35, 22, 14
s_lshl_b32 s35, s35, 12
s_waitcnt vmcnt(8) lgkmcnt(0)
v_mfma_f32_16x16x32_bf16 v[132:135], a[112:115], a[24:27], v[132:135]
ds_read_b128 a[96:99], v5 offset:40960
v_mfma_f32_16x16x32_bf16 v[148:151], a[112:115], a[28:31], v[148:151]
ds_read_b128 a[100:103], v5 offset:41984
v_mfma_f32_16x16x32_bf16 v[152:155], a[116:119], a[28:31], v[152:155]
buffer_load_dwordx4 a[16:19], v4, s[40:43], s35 offen offset:0 sc1
v_mfma_f32_16x16x32_bf16 v[136:139], a[116:119], a[24:27], v[136:139]
ds_read_b128 a[104:107], v5 offset:43008
v_mfma_f32_16x16x32_bf16 v[140:143], a[120:123], a[24:27], v[140:143]
ds_read_b128 a[108:111], v5 offset:44032
v_mfma_f32_16x16x32_bf16 v[156:159], a[120:123], a[28:31], v[156:159]
v_mfma_f32_16x16x32_bf16 v[160:163], a[124:127], a[28:31], v[160:163]
buffer_load_dwordx4 a[20:23], v4, s[40:43], s35 offen offset:1024 sc1
v_mfma_f32_16x16x32_bf16 v[144:147], a[124:127], a[24:27], v[144:147]
s_cmp_eq_u32 s3, 7
s_cselect_b32 s35, 23, 15
s_lshl_b32 s35, s35, 12
s_waitcnt vmcnt(8) lgkmcnt(0)
v_mfma_f32_16x16x32_bf16 v[132:135], a[96:99], a[32:35], v[132:135]
ds_read_b128 a[112:115], v5 offset:45056
v_mfma_f32_16x16x32_bf16 v[148:151], a[96:99], a[36:39], v[148:151]
ds_read_b128 a[116:119], v5 offset:46080
v_mfma_f32_16x16x32_bf16 v[152:155], a[100:103], a[36:39], v[152:155]
buffer_load_dwordx4 a[24:27], v4, s[40:43], s35 offen offset:0 sc1
v_mfma_f32_16x16x32_bf16 v[136:139], a[100:103], a[32:35], v[136:139]
ds_read_b128 a[120:123], v5 offset:47104
v_mfma_f32_16x16x32_bf16 v[140:143], a[104:107], a[32:35], v[140:143]
ds_read_b128 a[124:127], v5 offset:48128
v_mfma_f32_16x16x32_bf16 v[156:159], a[104:107], a[36:39], v[156:159]
v_mfma_f32_16x16x32_bf16 v[160:163], a[108:111], a[36:39], v[160:163]
buffer_load_dwordx4 a[28:31], v4, s[40:43], s35 offen offset:1024 sc1
v_mfma_f32_16x16x32_bf16 v[144:147], a[108:111], a[32:35], v[144:147]
s_cmp_eq_u32 s3, 0
s_cselect_b32 s35, 24, 16
s_lshl_b32 s35, s35, 12
s_waitcnt vmcnt(8) lgkmcnt(0)
v_mfma_f32_16x16x32_bf16 v[132:135], a[112:115], a[40:43], v[132:135]
ds_read_b128 a[96:99], v5 offset:49152
v_mfma_f32_16x16x32_bf16 v[148:151], a[112:115], a[44:47], v[148:151]
ds_read_b128 a[100:103], v5 offset:50176
v_mfma_f32_16x16x32_bf16 v[152:155], a[116:119], a[44:47], v[152:155]
buffer_load_dwordx4 a[32:35], v4, s[40:43], s35 offen offset:0 sc1
v_mfma_f32_16x16x32_bf16 v[136:139], a[116:119], a[40:43], v[136:139]
ds_read_b128 a[104:107], v5 offset:51200
v_mfma_f32_16x16x32_bf16 v[140:143], a[120:123], a[40:43], v[140:143]
ds_read_b128 a[108:111], v5 offset:52224
v_mfma_f32_16x16x32_bf16 v[156:159], a[120:123], a[44:47], v[156:159]
v_mfma_f32_16x16x32_bf16 v[160:163], a[124:127], a[44:47], v[160:163]
buffer_load_dwordx4 a[36:39], v4, s[40:43], s35 offen offset:1024 sc1
v_mfma_f32_16x16x32_bf16 v[144:147], a[124:127], a[40:43], v[144:147]
s_cmp_eq_u32 s3, 1
s_cselect_b32 s35, 25, 17
s_lshl_b32 s35, s35, 12
s_waitcnt vmcnt(8) lgkmcnt(0)
v_mfma_f32_16x16x32_bf16 v[132:135], a[96:99], a[0:3], v[132:135]
ds_read_b128 a[112:115], v5 offset:53248
v_mfma_f32_16x16x32_bf16 v[148:151], a[96:99], a[4:7], v[148:151]
ds_read_b128 a[116:119], v5 offset:54272
v_mfma_f32_16x16x32_bf16 v[152:155], a[100:103], a[4:7], v[152:155]
buffer_load_dwordx4 a[40:43], v4, s[40:43], s35 offen offset:0 sc1
v_mfma_f32_16x16x32_bf16 v[136:139], a[100:103], a[0:3], v[136:139]
ds_read_b128 a[120:123], v5 offset:55296
v_mfma_f32_16x16x32_bf16 v[140:143], a[104:107], a[0:3], v[140:143]
ds_read_b128 a[124:127], v5 offset:56320
v_mfma_f32_16x16x32_bf16 v[156:159], a[104:107], a[4:7], v[156:159]
v_mfma_f32_16x16x32_bf16 v[160:163], a[108:111], a[4:7], v[160:163]
buffer_load_dwordx4 a[44:47], v4, s[40:43], s35 offen offset:1024 sc1
v_mfma_f32_16x16x32_bf16 v[144:147], a[108:111], a[0:3], v[144:147]
s_cmp_eq_u32 s3, 2
s_cselect_b32 s35, 26, 18
s_lshl_b32 s35, s35, 12
s_waitcnt vmcnt(8) lgkmcnt(0)
v_mfma_f32_16x16x32_bf16 v[132:135], a[112:115], a[8:11], v[132:135]
ds_read_b128 a[96:99], v5 offset:57344
v_mfma_f32_16x16x32_bf16 v[148:151], a[112:115], a[12:15], v[148:151]
ds_read_b128 a[100:103], v5 offset:58368
v_mfma_f32_16x16x32_bf16 v[152:155], a[116:119], a[12:15], v[152:155]
buffer_load_dwordx4 a[0:3], v4, s[40:43], s35 offen offset:0 sc1
v_mfma_f32_16x16x32_bf16 v[136:139], a[116:119], a[8:11], v[136:139]
ds_read_b128 a[104:107], v5 offset:59392
v_mfma_f32_16x16x32_bf16 v[140:143], a[120:123], a[8:11], v[140:143]
ds_read_b128 a[108:111], v5 offset:60416
v_mfma_f32_16x16x32_bf16 v[156:159], a[120:123], a[12:15], v[156:159]
v_mfma_f32_16x16x32_bf16 v[160:163], a[124:127], a[12:15], v[160:163]
buffer_load_dwordx4 a[4:7], v4, s[40:43], s35 offen offset:1024 sc1
v_mfma_f32_16x16x32_bf16 v[144:147], a[124:127], a[8:11], v[144:147]
s_cmp_eq_u32 s3, 3
s_cselect_b32 s35, 27, 19
s_lshl_b32 s35, s35, 12
s_waitcnt vmcnt(8) lgkmcnt(0)
v_mfma_f32_16x16x32_bf16 v[132:135], a[96:99], a[16:19], v[132:135]
ds_read_b128 a[112:115], v5 offset:61440
v_mfma_f32_16x16x32_bf16 v[148:151], a[96:99], a[20:23], v[148:151]
ds_read_b128 a[116:119], v5 offset:62464
v_mfma_f32_16x16x32_bf16 v[152:155], a[100:103], a[20:23], v[152:155]
buffer_load_dwordx4 a[8:11], v4, s[40:43], s35 offen offset:0 sc1
v_mfma_f32_16x16x32_bf16 v[136:139], a[100:103], a[16:19], v[136:139]
ds_read_b128 a[120:123], v5 offset:63488
v_mfma_f32_16x16x32_bf16 v[140:143], a[104:107], a[16:19], v[140:143]
ds_read_b128 a[124:127], v5 offset:64512
v_mfma_f32_16x16x32_bf16 v[156:159], a[104:107], a[20:23], v[156:159]
v_mfma_f32_16x16x32_bf16 v[160:163], a[108:111], a[20:23], v[160:163]
buffer_load_dwordx4 a[12:15], v4, s[40:43], s35 offen offset:1024 sc1
v_mfma_f32_16x16x32_bf16 v[144:147], a[108:111], a[16:19], v[144:147]
s_cmp_eq_u32 s3, 4
s_cselect_b32 s35, 28, 20
s_lshl_b32 s35, s35, 12
s_waitcnt vmcnt(8) lgkmcnt(0)
v_mfma_f32_16x16x32_bf16 v[132:135], a[112:115], a[24:27], v[132:135]
ds_read_b128 a[96:99], v6 offset:0
v_mfma_f32_16x16x32_bf16 v[148:151], a[112:115], a[28:31], v[148:151]
ds_read_b128 a[100:103], v6 offset:1024
v_mfma_f32_16x16x32_bf16 v[152:155], a[116:119], a[28:31], v[152:155]
buffer_load_dwordx4 a[16:19], v4, s[40:43], s35 offen offset:0 sc1
v_mfma_f32_16x16x32_bf16 v[136:139], a[116:119], a[24:27], v[136:139]
ds_read_b128 a[104:107], v6 offset:2048
v_mfma_f32_16x16x32_bf16 v[140:143], a[120:123], a[24:27], v[140:143]
ds_read_b128 a[108:111], v6 offset:3072
v_mfma_f32_16x16x32_bf16 v[156:159], a[120:123], a[28:31], v[156:159]
v_mfma_f32_16x16x32_bf16 v[160:163], a[124:127], a[28:31], v[160:163]
buffer_load_dwordx4 a[20:23], v4, s[40:43], s35 offen offset:1024 sc1
v_mfma_f32_16x16x32_bf16 v[144:147], a[124:127], a[24:27], v[144:147]
s_cmp_eq_u32 s3, 5
s_cselect_b32 s35, 29, 21
s_lshl_b32 s35, s35, 12
s_waitcnt vmcnt(8) lgkmcnt(0)
v_mfma_f32_16x16x32_bf16 v[132:135], a[96:99], a[32:35], v[132:135]
ds_read_b128 a[112:115], v6 offset:4096
v_mfma_f32_16x16x32_bf16 v[148:151], a[96:99], a[36:39], v[148:151]
ds_read_b128 a[116:119], v6 offset:5120
v_mfma_f32_16x16x32_bf16 v[152:155], a[100:103], a[36:39], v[152:155]
buffer_load_dwordx4 a[24:27], v4, s[40:43], s35 offen offset:0 sc1
v_mfma_f32_16x16x32_bf16 v[136:139], a[100:103], a[32:35], v[136:139]
ds_read_b128 a[120:123], v6 offset:6144
v_mfma_f32_16x16x32_bf16 v[140:143], a[104:107], a[32:35], v[140:143]
ds_read_b128 a[124:127], v6 offset:7168
v_mfma_f32_16x16x32_bf16 v[156:159], a[104:107], a[36:39], v[156:159]
v_mfma_f32_16x16x32_bf16 v[160:163], a[108:111], a[36:39], v[160:163]
buffer_load_dwordx4 a[28:31], v4, s[40:43], s35 offen offset:1024 sc1
v_mfma_f32_16x16x32_bf16 v[144:147], a[108:111], a[32:35], v[144:147]
s_cmp_eq_u32 s3, 6
s_cselect_b32 s35, 30, 22
s_lshl_b32 s35, s35, 12
s_waitcnt vmcnt(8) lgkmcnt(0)
v_mfma_f32_16x16x32_bf16 v[132:135], a[112:115], a[40:43], v[132:135]
ds_read_b128 a[96:99], v6 offset:8192
v_mfma_f32_16x16x32_bf16 v[148:151], a[112:115], a[44:47], v[148:151]
ds_read_b128 a[100:103], v6 offset:9216
v_mfma_f32_16x16x32_bf16 v[152:155], a[116:119], a[44:47], v[152:155]
buffer_load_dwordx4 a[32:35], v4, s[40:43], s35 offen offset:0 sc1
v_mfma_f32_16x16x32_bf16 v[136:139], a[116:119], a[40:43], v[136:139]
ds_read_b128 a[104:107], v6 offset:10240
v_mfma_f32_16x16x32_bf16 v[140:143], a[120:123], a[40:43], v[140:143]
ds_read_b128 a[108:111], v6 offset:11264
v_mfma_f32_16x16x32_bf16 v[156:159], a[120:123], a[44:47], v[156:159]
v_mfma_f32_16x16x32_bf16 v[160:163], a[124:127], a[44:47], v[160:163]
buffer_load_dwordx4 a[36:39], v4, s[40:43], s35 offen offset:1024 sc1
v_mfma_f32_16x16x32_bf16 v[144:147], a[124:127], a[40:43], v[144:147]
s_cmp_eq_u32 s3, 7
s_cselect_b32 s35, 31, 23
s_lshl_b32 s35, s35, 12
s_waitcnt vmcnt(8) lgkmcnt(0)
v_mfma_f32_16x16x32_bf16 v[132:135], a[96:99], a[0:3], v[132:135]
ds_read_b128 a[112:115], v6 offset:12288
v_mfma_f32_16x16x32_bf16 v[148:151], a[96:99], a[4:7], v[148:151]
ds_read_b128 a[116:119], v6 offset:13312
v_mfma_f32_16x16x32_bf16 v[152:155], a[100:103], a[4:7], v[152:155]
buffer_load_dwordx4 a[40:43], v4, s[40:43], s35 offen offset:0 sc1
v_mfma_f32_16x16x32_bf16 v[136:139], a[100:103], a[0:3], v[136:139]
ds_read_b128 a[120:123], v6 offset:14336
v_mfma_f32_16x16x32_bf16 v[140:143], a[104:107], a[0:3], v[140:143]
ds_read_b128 a[124:127], v6 offset:15360
v_mfma_f32_16x16x32_bf16 v[156:159], a[104:107], a[4:7], v[156:159]
v_mfma_f32_16x16x32_bf16 v[160:163], a[108:111], a[4:7], v[160:163]
buffer_load_dwordx4 a[44:47], v4, s[40:43], s35 offen offset:1024 sc1
v_mfma_f32_16x16x32_bf16 v[144:147], a[108:111], a[0:3], v[144:147]
s_cmp_eq_u32 s3, 0
s_cselect_b32 s35, 0, 24
s_lshl_b32 s35, s35, 12
s_waitcnt vmcnt(8) lgkmcnt(0)
v_mfma_f32_16x16x32_bf16 v[132:135], a[112:115], a[8:11], v[132:135]
ds_read_b128 a[96:99], v6 offset:16384
v_mfma_f32_16x16x32_bf16 v[148:151], a[112:115], a[12:15], v[148:151]
ds_read_b128 a[100:103], v6 offset:17408
v_mfma_f32_16x16x32_bf16 v[152:155], a[116:119], a[12:15], v[152:155]
buffer_load_dwordx4 a[0:3], v4, s[40:43], s35 offen offset:0 sc1
v_mfma_f32_16x16x32_bf16 v[136:139], a[116:119], a[8:11], v[136:139]
ds_read_b128 a[104:107], v6 offset:18432
v_mfma_f32_16x16x32_bf16 v[140:143], a[120:123], a[8:11], v[140:143]
ds_read_b128 a[108:111], v6 offset:19456
v_mfma_f32_16x16x32_bf16 v[156:159], a[120:123], a[12:15], v[156:159]
v_mfma_f32_16x16x32_bf16 v[160:163], a[124:127], a[12:15], v[160:163]
buffer_load_dwordx4 a[4:7], v4, s[40:43], s35 offen offset:1024 sc1
v_mfma_f32_16x16x32_bf16 v[144:147], a[124:127], a[8:11], v[144:147]
s_cmp_eq_u32 s3, 1
s_cselect_b32 s35, 1, 25
s_lshl_b32 s35, s35, 12
s_waitcnt vmcnt(8) lgkmcnt(0)
v_mfma_f32_16x16x32_bf16 v[132:135], a[96:99], a[16:19], v[132:135]
ds_read_b128 a[112:115], v6 offset:20480
v_mfma_f32_16x16x32_bf16 v[148:151], a[96:99], a[20:23], v[148:151]
ds_read_b128 a[116:119], v6 offset:21504
v_mfma_f32_16x16x32_bf16 v[152:155], a[100:103], a[20:23], v[152:155]
buffer_load_dwordx4 a[8:11], v4, s[40:43], s35 offen offset:0 sc1
v_mfma_f32_16x16x32_bf16 v[136:139], a[100:103], a[16:19], v[136:139]
ds_read_b128 a[120:123], v6 offset:22528
v_mfma_f32_16x16x32_bf16 v[140:143], a[104:107], a[16:19], v[140:143]
ds_read_b128 a[124:127], v6 offset:23552
v_mfma_f32_16x16x32_bf16 v[156:159], a[104:107], a[20:23], v[156:159]
v_mfma_f32_16x16x32_bf16 v[160:163], a[108:111], a[20:23], v[160:163]
buffer_load_dwordx4 a[12:15], v4, s[40:43], s35 offen offset:1024 sc1
v_mfma_f32_16x16x32_bf16 v[144:147], a[108:111], a[16:19], v[144:147]
s_cmp_eq_u32 s3, 2
s_cselect_b32 s35, 2, 26
s_lshl_b32 s35, s35, 12
s_waitcnt vmcnt(8) lgkmcnt(0)
v_mfma_f32_16x16x32_bf16 v[132:135], a[112:115], a[24:27], v[132:135]
ds_read_b128 a[96:99], v6 offset:24576
v_mfma_f32_16x16x32_bf16 v[148:151], a[112:115], a[28:31], v[148:151]
ds_read_b128 a[100:103], v6 offset:25600
v_mfma_f32_16x16x32_bf16 v[152:155], a[116:119], a[28:31], v[152:155]
buffer_load_dwordx4 a[16:19], v4, s[40:43], s35 offen offset:0 sc1
v_mfma_f32_16x16x32_bf16 v[136:139], a[116:119], a[24:27], v[136:139]
ds_read_b128 a[104:107], v6 offset:26624
v_mfma_f32_16x16x32_bf16 v[140:143], a[120:123], a[24:27], v[140:143]
ds_read_b128 a[108:111], v6 offset:27648
v_mfma_f32_16x16x32_bf16 v[156:159], a[120:123], a[28:31], v[156:159]
v_mfma_f32_16x16x32_bf16 v[160:163], a[124:127], a[28:31], v[160:163]
buffer_load_dwordx4 a[20:23], v4, s[40:43], s35 offen offset:1024 sc1
v_mfma_f32_16x16x32_bf16 v[144:147], a[124:127], a[24:27], v[144:147]
s_cmp_eq_u32 s3, 3
s_cselect_b32 s35, 3, 27
s_lshl_b32 s35, s35, 12
s_waitcnt vmcnt(8) lgkmcnt(0)
v_mfma_f32_16x16x32_bf16 v[132:135], a[96:99], a[32:35], v[132:135]
ds_read_b128 a[112:115], v6 offset:28672
v_mfma_f32_16x16x32_bf16 v[148:151], a[96:99], a[36:39], v[148:151]
ds_read_b128 a[116:119], v6 offset:29696
v_mfma_f32_16x16x32_bf16 v[152:155], a[100:103], a[36:39], v[152:155]
buffer_load_dwordx4 a[24:27], v4, s[40:43], s35 offen offset:0 sc1
v_mfma_f32_16x16x32_bf16 v[136:139], a[100:103], a[32:35], v[136:139]
ds_read_b128 a[120:123], v6 offset:30720
v_mfma_f32_16x16x32_bf16 v[140:143], a[104:107], a[32:35], v[140:143]
ds_read_b128 a[124:127], v6 offset:31744
v_mfma_f32_16x16x32_bf16 v[156:159], a[104:107], a[36:39], v[156:159]
v_mfma_f32_16x16x32_bf16 v[160:163], a[108:111], a[36:39], v[160:163]
buffer_load_dwordx4 a[28:31], v4, s[40:43], s35 offen offset:1024 sc1
v_mfma_f32_16x16x32_bf16 v[144:147], a[108:111], a[32:35], v[144:147]
s_cmp_eq_u32 s3, 4
s_cselect_b32 s35, 4, 28
s_lshl_b32 s35, s35, 12
s_waitcnt vmcnt(8) lgkmcnt(0)
v_mfma_f32_16x16x32_bf16 v[132:135], a[112:115], a[40:43], v[132:135]
ds_read_b128 a[96:99], v6 offset:32768
v_mfma_f32_16x16x32_bf16 v[148:151], a[112:115], a[44:47], v[148:151]
ds_read_b128 a[100:103], v6 offset:33792
v_mfma_f32_16x16x32_bf16 v[152:155], a[116:119], a[44:47], v[152:155]
buffer_load_dwordx4 a[32:35], v4, s[40:43], s35 offen offset:0 sc1
v_mfma_f32_16x16x32_bf16 v[136:139], a[116:119], a[40:43], v[136:139]
ds_read_b128 a[104:107], v6 offset:34816
v_mfma_f32_16x16x32_bf16 v[140:143], a[120:123], a[40:43], v[140:143]
ds_read_b128 a[108:111], v6 offset:35840
v_mfma_f32_16x16x32_bf16 v[156:159], a[120:123], a[44:47], v[156:159]
v_mfma_f32_16x16x32_bf16 v[160:163], a[124:127], a[44:47], v[160:163]
buffer_load_dwordx4 a[36:39], v4, s[40:43], s35 offen offset:1024 sc1
v_mfma_f32_16x16x32_bf16 v[144:147], a[124:127], a[40:43], v[144:147]
s_cmp_eq_u32 s3, 5
s_cselect_b32 s35, 5, 29
s_lshl_b32 s35, s35, 12
s_waitcnt vmcnt(8) lgkmcnt(0)
v_mfma_f32_16x16x32_bf16 v[132:135], a[96:99], a[0:3], v[132:135]
ds_read_b128 a[112:115], v6 offset:36864
v_mfma_f32_16x16x32_bf16 v[148:151], a[96:99], a[4:7], v[148:151]
ds_read_b128 a[116:119], v6 offset:37888
v_mfma_f32_16x16x32_bf16 v[152:155], a[100:103], a[4:7], v[152:155]
buffer_load_dwordx4 a[40:43], v4, s[40:43], s35 offen offset:0 sc1
v_mfma_f32_16x16x32_bf16 v[136:139], a[100:103], a[0:3], v[136:139]
ds_read_b128 a[120:123], v6 offset:38912
v_mfma_f32_16x16x32_bf16 v[140:143], a[104:107], a[0:3], v[140:143]
ds_read_b128 a[124:127], v6 offset:39936
v_mfma_f32_16x16x32_bf16 v[156:159], a[104:107], a[4:7], v[156:159]
v_mfma_f32_16x16x32_bf16 v[160:163], a[108:111], a[4:7], v[160:163]
buffer_load_dwordx4 a[44:47], v4, s[40:43], s35 offen offset:1024 sc1
v_mfma_f32_16x16x32_bf16 v[144:147], a[108:111], a[0:3], v[144:147]
s_cmp_eq_u32 s3, 6
s_cselect_b32 s35, 6, 30
s_lshl_b32 s35, s35, 12
s_waitcnt vmcnt(8) lgkmcnt(0)
v_mfma_f32_16x16x32_bf16 v[132:135], a[112:115], a[8:11], v[132:135]
ds_read_b128 a[96:99], v6 offset:40960
v_mfma_f32_16x16x32_bf16 v[148:151], a[112:115], a[12:15], v[148:151]
ds_read_b128 a[100:103], v6 offset:41984
v_mfma_f32_16x16x32_bf16 v[152:155], a[116:119], a[12:15], v[152:155]
buffer_load_dwordx4 a[0:3], v4, s[40:43], s35 offen offset:0 sc1
v_mfma_f32_16x16x32_bf16 v[136:139], a[116:119], a[8:11], v[136:139]
ds_read_b128 a[104:107], v6 offset:43008
v_mfma_f32_16x16x32_bf16 v[140:143], a[120:123], a[8:11], v[140:143]
ds_read_b128 a[108:111], v6 offset:44032
v_mfma_f32_16x16x32_bf16 v[156:159], a[120:123], a[12:15], v[156:159]
v_mfma_f32_16x16x32_bf16 v[160:163], a[124:127], a[12:15], v[160:163]
buffer_load_dwordx4 a[4:7], v4, s[40:43], s35 offen offset:1024 sc1
v_mfma_f32_16x16x32_bf16 v[144:147], a[124:127], a[8:11], v[144:147]
s_cmp_eq_u32 s3, 7
s_cselect_b32 s35, 7, 31
s_lshl_b32 s35, s35, 12
s_waitcnt vmcnt(8) lgkmcnt(0)
v_mfma_f32_16x16x32_bf16 v[132:135], a[96:99], a[16:19], v[132:135]
ds_read_b128 a[112:115], v6 offset:45056
v_mfma_f32_16x16x32_bf16 v[148:151], a[96:99], a[20:23], v[148:151]
ds_read_b128 a[116:119], v6 offset:46080
v_mfma_f32_16x16x32_bf16 v[152:155], a[100:103], a[20:23], v[152:155]
buffer_load_dwordx4 a[8:11], v4, s[40:43], s35 offen offset:0 sc1
v_mfma_f32_16x16x32_bf16 v[136:139], a[100:103], a[16:19], v[136:139]
ds_read_b128 a[120:123], v6 offset:47104
v_mfma_f32_16x16x32_bf16 v[140:143], a[104:107], a[16:19], v[140:143]
ds_read_b128 a[124:127], v6 offset:48128
v_mfma_f32_16x16x32_bf16 v[156:159], a[104:107], a[20:23], v[156:159]
v_mfma_f32_16x16x32_bf16 v[160:163], a[108:111], a[20:23], v[160:163]
buffer_load_dwordx4 a[12:15], v4, s[40:43], s35 offen offset:1024 sc1
v_mfma_f32_16x16x32_bf16 v[144:147], a[108:111], a[16:19], v[144:147]
s_waitcnt vmcnt(8) lgkmcnt(0)
v_mfma_f32_16x16x32_bf16 v[132:135], a[112:115], a[24:27], v[132:135]
ds_read_b128 a[96:99], v6 offset:49152
v_mfma_f32_16x16x32_bf16 v[148:151], a[112:115], a[28:31], v[148:151]
ds_read_b128 a[100:103], v6 offset:50176
v_mfma_f32_16x16x32_bf16 v[152:155], a[116:119], a[28:31], v[152:155]
ds_read_b128 a[104:107], v6 offset:51200
v_mfma_f32_16x16x32_bf16 v[136:139], a[116:119], a[24:27], v[136:139]
ds_read_b128 a[108:111], v6 offset:52224
v_mfma_f32_16x16x32_bf16 v[140:143], a[120:123], a[24:27], v[140:143]
v_mfma_f32_16x16x32_bf16 v[156:159], a[120:123], a[28:31], v[156:159]
v_mfma_f32_16x16x32_bf16 v[160:163], a[124:127], a[28:31], v[160:163]
v_mfma_f32_16x16x32_bf16 v[144:147], a[124:127], a[24:27], v[144:147]
s_waitcnt vmcnt(6) lgkmcnt(0)
v_mfma_f32_16x16x32_bf16 v[132:135], a[96:99], a[32:35], v[132:135]
ds_read_b128 a[112:115], v6 offset:53248
v_mfma_f32_16x16x32_bf16 v[148:151], a[96:99], a[36:39], v[148:151]
ds_read_b128 a[116:119], v6 offset:54272
v_mfma_f32_16x16x32_bf16 v[152:155], a[100:103], a[36:39], v[152:155]
ds_read_b128 a[120:123], v6 offset:55296
v_mfma_f32_16x16x32_bf16 v[136:139], a[100:103], a[32:35], v[136:139]
ds_read_b128 a[124:127], v6 offset:56320
v_mfma_f32_16x16x32_bf16 v[140:143], a[104:107], a[32:35], v[140:143]
v_mfma_f32_16x16x32_bf16 v[156:159], a[104:107], a[36:39], v[156:159]
buffer_load_dword v11, v255, s[16:19], 0 offen offset:128 sc1
v_mfma_f32_16x16x32_bf16 v[160:163], a[108:111], a[36:39], v[160:163]
v_mfma_f32_16x16x32_bf16 v[144:147], a[108:111], a[32:35], v[144:147]
s_waitcnt vmcnt(5) lgkmcnt(0)
v_mfma_f32_16x16x32_bf16 v[132:135], a[112:115], a[40:43], v[132:135]
ds_read_b128 a[96:99], v6 offset:57344
v_mfma_f32_16x16x32_bf16 v[148:151], a[112:115], a[44:47], v[148:151]
ds_read_b128 a[100:103], v6 offset:58368
v_mfma_f32_16x16x32_bf16 v[152:155], a[116:119], a[44:47], v[152:155]
ds_read_b128 a[104:107], v6 offset:59392
v_mfma_f32_16x16x32_bf16 v[136:139], a[116:119], a[40:43], v[136:139]
ds_read_b128 a[108:111], v6 offset:60416
v_mfma_f32_16x16x32_bf16 v[140:143], a[120:123], a[40:43], v[140:143]
v_mfma_f32_16x16x32_bf16 v[156:159], a[120:123], a[44:47], v[156:159]
v_mfma_f32_16x16x32_bf16 v[160:163], a[124:127], a[44:47], v[160:163]
v_mfma_f32_16x16x32_bf16 v[144:147], a[124:127], a[40:43], v[144:147]
s_waitcnt vmcnt(3) lgkmcnt(0)
v_mfma_f32_16x16x32_bf16 v[132:135], a[96:99], a[0:3], v[132:135]
ds_read_b128 a[112:115], v6 offset:61440
v_mfma_f32_16x16x32_bf16 v[148:151], a[96:99], a[4:7], v[148:151]
ds_read_b128 a[116:119], v6 offset:62464
v_mfma_f32_16x16x32_bf16 v[152:155], a[100:103], a[4:7], v[152:155]
ds_read_b128 a[120:123], v6 offset:63488
v_mfma_f32_16x16x32_bf16 v[136:139], a[100:103], a[0:3], v[136:139]
ds_read_b128 a[124:127], v6 offset:64512
v_mfma_f32_16x16x32_bf16 v[140:143], a[104:107], a[0:3], v[140:143]
v_mfma_f32_16x16x32_bf16 v[156:159], a[104:107], a[4:7], v[156:159]
v_mfma_f32_16x16x32_bf16 v[160:163], a[108:111], a[4:7], v[160:163]
v_mfma_f32_16x16x32_bf16 v[144:147], a[108:111], a[0:3], v[144:147]
s_waitcnt vmcnt(1) lgkmcnt(0)
v_mfma_f32_16x16x32_bf16 v[132:135], a[112:115], a[8:11], v[132:135]
v_mfma_f32_16x16x32_bf16 v[148:151], a[112:115], a[12:15], v[148:151]
v_mfma_f32_16x16x32_bf16 v[152:155], a[116:119], a[12:15], v[152:155]
v_mfma_f32_16x16x32_bf16 v[136:139], a[116:119], a[8:11], v[136:139]
v_mfma_f32_16x16x32_bf16 v[140:143], a[120:123], a[8:11], v[140:143]
v_mfma_f32_16x16x32_bf16 v[156:159], a[120:123], a[12:15], v[156:159]
v_mfma_f32_16x16x32_bf16 v[160:163], a[124:127], a[12:15], v[160:163]
v_mfma_f32_16x16x32_bf16 v[144:147], a[124:127], a[8:11], v[144:147]
s_waitcnt vmcnt(0)
v_cvt_pk_bf16_f32 v32, v132, v133
v_cvt_pk_bf16_f32 v33, v134, v135
s_nop 0
v_cvt_pk_bf16_f32 v34, v136, v137
v_cvt_pk_bf16_f32 v35, v138, v139
v_cvt_pk_bf16_f32 v36, v140, v141
v_cvt_pk_bf16_f32 v37, v142, v143
v_cvt_pk_bf16_f32 v38, v144, v145
v_cvt_pk_bf16_f32 v39, v146, v147
v_cvt_pk_bf16_f32 v40, v148, v149
v_cvt_pk_bf16_f32 v41, v150, v151
v_cvt_pk_bf16_f32 v42, v152, v153
v_cvt_pk_bf16_f32 v43, v154, v155
v_cvt_pk_bf16_f32 v44, v156, v157
v_cvt_pk_bf16_f32 v45, v158, v159
v_cvt_pk_bf16_f32 v46, v160, v161
v_cvt_pk_bf16_f32 v47, v162, v163
s_lshl_b32 s36, s32, 13
s_add_u32 s36, s36, 0x2200000
s_add_u32 s37, s36, 4096
s_mov_b32 s38, 0x240000
v_mfma_f32_16x16x32_bf16 v[96:99], v[32:35], v[32:35], 0
v_mfma_f32_16x16x32_bf16 v[92:95], v[16:19], v[32:35], 0
buffer_store_dwordx4 v[32:35], v4, s[4:7], s36 offen offset:0 sc1
v_mfma_f32_16x16x32_bf16 v[104:107], v[40:43], v[40:43], 0
v_mfma_f32_16x16x32_bf16 v[100:103], v[16:19], v[40:43], 0
buffer_store_dwordx4 v[40:43], v4, s[4:7], s36 offen offset:1024 sc1
v_mfma_f32_16x16x32_bf16 v[96:99], v[36:39], v[36:39], v[96:99]
v_mfma_f32_16x16x32_bf16 v[92:95], v[16:19], v[36:39], v[92:95]
buffer_store_dwordx4 v[36:39], v4, s[4:7], s37 offen offset:0 sc1
v_mfma_f32_16x16x32_bf16 v[104:107], v[44:47], v[44:47], v[104:107]
v_mfma_f32_16x16x32_bf16 v[100:103], v[16:19], v[44:47], v[100:103]
buffer_store_dwordx4 v[44:47], v4, s[4:7], s37 offen offset:1024 sc1
s_nop 2
v_cndmask_b32 v96, v96, v97, s[46:47]
v_cndmask_b32 v98, v98, v99, s[46:47]
v_cndmask_b32 v93, v96, v98, s[48:49]
buffer_store_dwordx2 v[92:93], v253, s[4:7], s38 offen offset:0 sc1
v_cndmask_b32 v104, v104, v105, s[46:47]
v_cndmask_b32 v106, v106, v107, s[46:47]
v_cndmask_b32 v101, v104, v106, s[48:49]
buffer_store_dwordx2 v[100:101], v253, s[4:7], s38 offen offset:2048 sc1
s_add_u32 s92, s78, 0x40000
s_add_u32 s93, s79, 0x40000
s_add_u32 s40, s4, 0x2200000
s_addc_u32 s41, s5, 0
v_cmp_gt_u32 vcc, 8, v11
s_cbranch_vccz Lpe_9
s_mov_b32 s36, 0x80
s_mov_b32 s37, 0
Lpoll_8:
s_sleep 16
buffer_load_dword v11, v255, s[16:19], s36 offen sc1
s_add_u32 s37, s37, 1
s_waitcnt vmcnt(0)
v_cmp_gt_u32 vcc, 8, v11
s_cbranch_vccz Lpe_9
s_cmp_lt_u32 s37, 0x100000
s_cbranch_scc1 Lpoll_8
Lpe_9:
s_barrier
s_add_u32 s44, s28, 0
s_mul_i32 s45, s44, 3072
s_add_u32 m0, s45, 0
s_lshr_b32 s44, s44, 1
s_add_u32 s44, s44, 0
s_add_u32 s44, s44, s33
s_and_b32 s44, s44, 31
s_mul_i32 s44, s44, 6144
s_add_u32 s44, s44, s50
s_add_u32 s44, s44, 0x600000
buffer_load_dwordx4 v1, s[4:7], s44 offen offset:0 sc1 lds
buffer_load_dwordx4 v1, s[4:7], s44 offen offset:1024 sc1 lds
buffer_load_dwordx4 v1, s[4:7], s44 offen offset:2048 sc1 lds
s_add_u32 s44, s28, 4
s_mul_i32 s45, s44, 3072
s_add_u32 m0, s45, 0
s_lshr_b32 s44, s44, 1
s_add_u32 s44, s44, 0
s_add_u32 s44, s44, s33
s_and_b32 s44, s44, 31
s_mul_i32 s44, s44, 6144
s_add_u32 s44, s44, s50
s_add_u32 s44, s44, 0x600000
buffer_load_dwordx4 v1, s[4:7], s44 offen offset:0 sc1 lds
buffer_load_dwordx4 v1, s[4:7], s44 offen offset:1024 sc1 lds
buffer_load_dwordx4 v1, s[4:7], s44 offen offset:2048 sc1 lds
s_add_u32 s44, s28, 8
s_mul_i32 s45, s44, 3072
s_add_u32 m0, s45, 0
s_lshr_b32 s44, s44, 1
s_add_u32 s44, s44, 0
s_add_u32 s44, s44, s33
s_and_b32 s44, s44, 31
s_mul_i32 s44, s44, 6144
s_add_u32 s44, s44, s50
s_add_u32 s44, s44, 0x600000
buffer_load_dwordx4 v1, s[4:7], s44 offen offset:0 sc1 lds
buffer_load_dwordx4 v1, s[4:7], s44 offen offset:1024 sc1 lds
buffer_load_dwordx4 v1, s[4:7], s44 offen offset:2048 sc1 lds
s_add_u32 s44, s28, 12
s_mul_i32 s45, s44, 3072
s_add_u32 m0, s45, 0
s_lshr_b32 s44, s44, 1
s_add_u32 s44, s44, 0
s_add_u32 s44, s44, s33
s_and_b32 s44, s44, 31
s_mul_i32 s44, s44, 6144
s_add_u32 s44, s44, s50
s_add_u32 s44, s44, 0x600000
buffer_load_dwordx4 v1, s[4:7], s44 offen offset:0 sc1 lds
buffer_load_dwordx4 v1, s[4:7], s44 offen offset:1024 sc1 lds
buffer_load_dwordx4 v1, s[4:7], s44 offen offset:2048 sc1 lds
s_waitcnt vmcnt(12)
s_barrier
buffer_atomic_add v12, v10, s[4:7], s92 offen sc1
s_cmp_lt_u32 s28, 2
s_cbranch_scc1 Lwd_10
s_add_u32 s44, s28, 0
s_mul_i32 s45, s44, 3072
s_add_u32 m0, s45, 49152
s_lshr_b32 s44, s44, 1
s_add_u32 s44, s44, 8
s_add_u32 s44, s44, s33
s_and_b32 s44, s44, 31
s_mul_i32 s44, s44, 6144
s_add_u32 s44, s44, s50
s_add_u32 s44, s44, 0x600000
buffer_load_dwordx4 v1, s[4:7], s44 offen offset:0 sc1 lds
buffer_load_dwordx4 v1, s[4:7], s44 offen offset:1024 sc1 lds
buffer_load_dwordx4 v1, s[4:7], s44 offen offset:2048 sc1 lds
s_sub_u32 s44, s28, 2
s_mul_i32 s45, s44, 3072
s_add_u32 m0, s45, 49152
s_lshr_b32 s44, s44, 1
s_add_u32 s44, s44, 8
s_add_u32 s44, s44, s33
s_and_b32 s44, s44, 31
s_mul_i32 s44, s44, 6144
s_add_u32 s44, s44, s50
s_add_u32 s44, s44, 0x600000
buffer_load_dwordx4 v1, s[4:7], s44 offen offset:0 sc1 lds
buffer_load_dwordx4 v1, s[4:7], s44 offen offset:1024 sc1 lds
buffer_load_dwordx4 v1, s[4:7], s44 offen offset:2048 sc1 lds
s_add_u32 s44, s28, 4
s_mul_i32 s45, s44, 3072
s_add_u32 m0, s45, 49152
s_lshr_b32 s44, s44, 1
s_add_u32 s44, s44, 8
s_add_u32 s44, s44, s33
s_and_b32 s44, s44, 31
s_mul_i32 s44, s44, 6144
s_add_u32 s44, s44, s50
s_add_u32 s44, s44, 0x600000
buffer_load_dwordx4 v1, s[4:7], s44 offen offset:0 sc1 lds
buffer_load_dwordx4 v1, s[4:7], s44 offen offset:1024 sc1 lds
buffer_load_dwordx4 v1, s[4:7], s44 offen offset:2048 sc1 lds
s_add_u32 s44, s28, 2
s_mul_i32 s45, s44, 3072
s_add_u32 m0, s45, 49152
s_lshr_b32 s44, s44, 1
s_add_u32 s44, s44, 8
s_add_u32 s44, s44, s33
s_and_b32 s44, s44, 31
s_mul_i32 s44, s44, 6144
s_add_u32 s44, s44, s50
s_add_u32 s44, s44, 0x600000
buffer_load_dwordx4 v1, s[4:7], s44 offen offset:0 sc1 lds
buffer_load_dwordx4 v1, s[4:7], s44 offen offset:1024 sc1 lds
buffer_load_dwordx4 v1, s[4:7], s44 offen offset:2048 sc1 lds
s_add_u32 s44, s28, 8
s_mul_i32 s45, s44, 3072
s_add_u32 m0, s45, 49152
s_lshr_b32 s44, s44, 1
s_add_u32 s44, s44, 8
s_add_u32 s44, s44, s33
s_and_b32 s44, s44, 31
s_mul_i32 s44, s44, 6144
s_add_u32 s44, s44, s50
s_add_u32 s44, s44, 0x600000
buffer_load_dwordx4 v1, s[4:7], s44 offen offset:0 sc1 lds
buffer_load_dwordx4 v1, s[4:7], s44 offen offset:1024 sc1 lds
buffer_load_dwordx4 v1, s[4:7], s44 offen offset:2048 sc1 lds
s_add_u32 s44, s28, 6
s_mul_i32 s45, s44, 3072
s_add_u32 m0, s45, 49152
s_lshr_b32 s44, s44, 1
s_add_u32 s44, s44, 8
s_add_u32 s44, s44, s33
s_and_b32 s44, s44, 31
s_mul_i32 s44, s44, 6144
s_add_u32 s44, s44, s50
s_add_u32 s44, s44, 0x600000
buffer_load_dwordx4 v1, s[4:7], s44 offen offset:0 sc1 lds
buffer_load_dwordx4 v1, s[4:7], s44 offen offset:1024 sc1 lds
buffer_load_dwordx4 v1, s[4:7], s44 offen offset:2048 sc1 lds
s_add_u32 s44, s28, 12
s_mul_i32 s45, s44, 3072
s_add_u32 m0, s45, 49152
s_lshr_b32 s44, s44, 1
s_add_u32 s44, s44, 8
s_add_u32 s44, s44, s33
s_and_b32 s44, s44, 31
s_mul_i32 s44, s44, 6144
s_add_u32 s44, s44, s50
s_add_u32 s44, s44, 0x600000
buffer_load_dwordx4 v1, s[4:7], s44 offen offset:0 sc1 lds
buffer_load_dwordx4 v1, s[4:7], s44 offen offset:1024 sc1 lds
buffer_load_dwordx4 v1, s[4:7], s44 offen offset:2048 sc1 lds
s_add_u32 s44, s28, 10
s_mul_i32 s45, s44, 3072
s_add_u32 m0, s45, 49152
s_lshr_b32 s44, s44, 1
s_add_u32 s44, s44, 8
s_add_u32 s44, s44, s33
s_and_b32 s44, s44, 31
s_mul_i32 s44, s44, 6144
s_add_u32 s44, s44, s50
s_add_u32 s44, s44, 0x600000
buffer_load_dwordx4 v1, s[4:7], s44 offen offset:0 sc1 lds
buffer_load_dwordx4 v1, s[4:7], s44 offen offset:1024 sc1 lds
buffer_load_dwordx4 v1, s[4:7], s44 offen offset:2048 sc1 lds
Lwd_10:
s_cmp_lg_u32 s28, 0
s_cbranch_scc1 Lpe_12
s_add_u32 s36, s67, 0x40000
s_mov_b32 s37, 0
Lpoll_11:
v_mov_b32 v11, 0
s_mov_b64 exec, 1
buffer_atomic_add v11, off, s[4:7], s36 sc0 sc1
s_waitcnt vmcnt(0)
v_readfirstlane_b32 s38, v11
s_mov_b64 exec, -1
s_nop 0
v_mov_b32 v11, s38
s_add_u32 s37, s37, 1
v_cmp_gt_u32 vcc, 32, v11
s_cbranch_vccz Lpe_12
s_cmp_lt_u32 s37, 0x100000
s_cbranch_scc1 Lpoll_11
Lpe_12:
s_waitcnt vmcnt(24)
s_cmp_ge_u32 s28, 2
s_cbranch_scc1 Lw_13
s_waitcnt vmcnt(0)
Lw_13:
s_barrier
s_add_u32 s94, s80, 0x80080
s_lshl_b32 s35, s33, 12
buffer_load_dwordx4 a[0:3], v2, s[40:43], s35 offen offset:0 sc1
buffer_load_dwordx4 a[4:7], v2, s[40:43], s35 offen offset:1024 sc1
buffer_load_dwordx4 a[8:11], v2, s[40:43], s35 offen offset:2048 sc1
buffer_load_dwordx4 a[12:15], v2, s[40:43], s35 offen offset:3072 sc1
s_add_u32 s35, s35, 4096
s_and_b32 s35, s35, 0x1ffff
buffer_load_dwordx4 a[16:19], v2, s[40:43], s35 offen offset:0 sc1
buffer_load_dwordx4 a[20:23], v2, s[40:43], s35 offen offset:1024 sc1
buffer_load_dwordx4 a[24:27], v2, s[40:43], s35 offen offset:2048 sc1
buffer_load_dwordx4 a[28:31], v2, s[40:43], s35 offen offset:3072 sc1
s_add_u32 s35, s35, 4096
s_and_b32 s35, s35, 0x1ffff
buffer_load_dwordx4 a[32:35], v2, s[40:43], s35 offen offset:0 sc1
buffer_load_dwordx4 a[36:39], v2, s[40:43], s35 offen offset:1024 sc1
buffer_load_dwordx4 a[40:43], v2, s[40:43], s35 offen offset:2048 sc1
buffer_load_dwordx4 a[44:47], v2, s[40:43], s35 offen offset:3072 sc1
s_add_u32 s35, s35, 4096
s_and_b32 s35, s35, 0x1ffff
v_add_u32 v5, 0, v1
ds_read_b128 a[96:99], v5 offset:0
ds_read_b128 a[100:103], v5 offset:1024
ds_read_b128 a[104:107], v5 offset:2048
ds_read_b128 a[108:111], v5 offset:3072
ds_read_b128 a[112:115], v5 offset:4096
ds_read_b128 a[116:119], v5 offset:5120
s_waitcnt vmcnt(8) lgkmcnt(0)
v_mfma_f32_16x16x32_bf16 v[132:135], a[96:99], a[0:3], 0
v_and_b32 v232, 15, v0
v_lshlrev_b32 v232, 7, v232
v_mfma_f32_16x16x32_bf16 v[156:159], a[96:99], a[4:7], 0
buffer_load_dwordx4 a[48:51], v2, s[40:43], s35 offen offset:0 sc1
v_mfma_f32_16x16x32_bf16 v[180:183], a[96:99], a[8:11], 0
v_lshrrev_b32 v233, 4, v0
v_lshlrev_b32 v233, 4, v233
v_mfma_f32_16x16x32_bf16 v[204:207], a[96:99], a[12:15], 0
v_add_u32 v232, v233, v232
s_mul_i32 s38, s30, 12288
v_mfma_f32_16x16x32_bf16 v[208:211], a[100:103], a[12:15], 0
s_add_u32 s38, s38, 0x380000
s_add_u32 s39, s28, 4
s_min_u32 s39, s39, 5
s_lshl_b32 s36, s28, 11
s_add_u32 s36, s36, s38
s_lshl_b32 s37, s39, 11
s_add_u32 s37, s37, s38
v_mfma_f32_16x16x32_bf16 v[184:187], a[100:103], a[8:11], 0
buffer_load_dwordx4 v[48:51], v232, s[4:7], s36 offen sc1
v_mfma_f32_16x16x32_bf16 v[160:163], a[100:103], a[4:7], 0
ds_read_b128 a[128:131], v5 offset:6144
v_mfma_f32_16x16x32_bf16 v[136:139], a[100:103], a[0:3], 0
ds_read_b128 a[132:135], v5 offset:7168
v_mfma_f32_16x16x32_bf16 v[140:143], a[104:107], a[0:3], 0
ds_read_b128 a[136:139], v5 offset:8192
v_mfma_f32_16x16x32_bf16 v[164:167], a[104:107], a[4:7], 0
buffer_load_dwordx4 a[52:55], v2, s[40:43], s35 offen offset:1024 sc1
v_mfma_f32_16x16x32_bf16 v[188:191], a[104:107], a[8:11], 0
ds_read_b128 a[140:143], v5 offset:9216
v_mfma_f32_16x16x32_bf16 v[212:215], a[104:107], a[12:15], 0
ds_read_b128 a[144:147], v5 offset:10240
v_mfma_f32_16x16x32_bf16 v[216:219], a[108:111], a[12:15], 0
v_mfma_f32_16x16x32_bf16 v[192:195], a[108:111], a[8:11], 0
buffer_load_dwordx4 a[56:59], v2, s[40:43], s35 offen offset:2048 sc1
v_mfma_f32_16x16x32_bf16 v[168:171], a[108:111], a[4:7], 0
ds_read_b128 a[148:151], v5 offset:11264
v_mfma_f32_16x16x32_bf16 v[144:147], a[108:111], a[0:3], 0
v_mfma_f32_16x16x32_bf16 v[148:151], a[112:115], a[0:3], 0
v_mfma_f32_16x16x32_bf16 v[172:175], a[112:115], a[4:7], 0
buffer_load_dwordx4 v[52:55], v232, s[4:7], s37 offen sc1
s_add_u32 s44, s28, 0
v_mfma_f32_16x16x32_bf16 v[196:199], a[112:115], a[8:11], 0
s_mul_i32 s45, s44, 3072
s_add_u32 m0, s45, 98304
s_lshr_b32 s44, s44, 1
v_mfma_f32_16x16x32_bf16 v[220:223], a[112:115], a[12:15], 0
s_add_u32 s44, s44, 16
s_add_u32 s44, s44, s33
s_and_b32 s44, s44, 31
v_mfma_f32_16x16x32_bf16 v[224:227], a[116:119], a[12:15], 0
s_mul_i32 s44, s44, 6144
s_add_u32 s44, s44, s50
s_add_u32 s44, s44, 0x600000
v_mfma_f32_16x16x32_bf16 v[200:203], a[116:119], a[8:11], 0
buffer_load_dwordx4 a[60:63], v2, s[40:43], s35 offen offset:3072 sc1
s_add_u32 s35, s35, 4096
v_mfma_f32_16x16x32_bf16 v[176:179], a[116:119], a[4:7], 0
s_and_b32 s35, s35, 0x1ffff
v_mfma_f32_16x16x32_bf16 v[152:155], a[116:119], a[0:3], 0
s_waitcnt vmcnt(10) lgkmcnt(0)
v_mfma_f32_16x16x32_bf16 v[132:135], a[128:131], a[16:19], v[132:135]
ds_read_b128 a[96:99], v5 offset:12288
v_mfma_f32_16x16x32_bf16 v[156:159], a[128:131], a[20:23], v[156:159]
buffer_load_dwordx4 a[0:3], v2, s[40:43], s35 offen offset:0 sc1
v_mfma_f32_16x16x32_bf16 v[180:183], a[128:131], a[24:27], v[180:183]
ds_read_b128 a[100:103], v5 offset:13312
v_mfma_f32_16x16x32_bf16 v[204:207], a[128:131], a[28:31], v[204:207]
v_mfma_f32_16x16x32_bf16 v[208:211], a[132:135], a[28:31], v[208:211]
v_mfma_f32_16x16x32_bf16 v[184:187], a[132:135], a[24:27], v[184:187]
buffer_load_dwordx4 v1, s[4:7], s44 offen offset:0 sc1 lds
v_mfma_f32_16x16x32_bf16 v[160:163], a[132:135], a[20:23], v[160:163]
ds_read_b128 a[104:107], v5 offset:14336
v_mfma_f32_16x16x32_bf16 v[136:139], a[132:135], a[16:19], v[136:139]
v_mfma_f32_16x16x32_bf16 v[140:143], a[136:139], a[16:19], v[140:143]
ds_read_b128 a[108:111], v5 offset:15360
v_mfma_f32_16x16x32_bf16 v[164:167], a[136:139], a[20:23], v[164:167]
buffer_load_dwordx4 a[4:7], v2, s[40:43], s35 offen offset:1024 sc1
v_mfma_f32_16x16x32_bf16 v[188:191], a[136:139], a[24:27], v[188:191]
ds_read_b128 a[112:115], v5 offset:16384
v_mfma_f32_16x16x32_bf16 v[212:215], a[136:139], a[28:31], v[212:215]
v_mfma_f32_16x16x32_bf16 v[216:219], a[140:143], a[28:31], v[216:219]
v_mfma_f32_16x16x32_bf16 v[192:195], a[140:143], a[24:27], v[192:195]
buffer_load_dwordx4 a[8:11], v2, s[40:43], s35 offen offset:2048 sc1
v_mfma_f32_16x16x32_bf16 v[168:171], a[140:143], a[20:23], v[168:171]
ds_read_b128 a[116:119], v5 offset:17408
v_mfma_f32_16x16x32_bf16 v[144:147], a[140:143], a[16:19], v[144:147]
v_mfma_f32_16x16x32_bf16 v[148:151], a[144:147], a[16:19], v[148:151]
v_mfma_f32_16x16x32_bf16 v[172:175], a[144:147], a[20:23], v[172:175]
buffer_load_dwordx4 v1, s[4:7], s44 offen offset:1024 sc1 lds
v_mfma_f32_16x16x32_bf16 v[196:199], a[144:147], a[24:27], v[196:199]
v_mfma_f32_16x16x32_bf16 v[220:223], a[144:147], a[28:31], v[220:223]
v_mfma_f32_16x16x32_bf16 v[224:227], a[148:151], a[28:31], v[224:227]
v_mfma_f32_16x16x32_bf16 v[200:203], a[148:151], a[24:27], v[200:203]
buffer_load_dwordx4 a[12:15], v2, s[40:43], s35 offen offset:3072 sc1
s_add_u32 s35, s35, 4096
v_mfma_f32_16x16x32_bf16 v[176:179], a[148:151], a[20:23], v[176:179]
s_and_b32 s35, s35, 0x1ffff
v_mfma_f32_16x16x32_bf16 v[152:155], a[148:151], a[16:19], v[152:155]
s_waitcnt vmcnt(12) lgkmcnt(0)
v_mfma_f32_16x16x32_bf16 v[132:135], a[96:99], a[32:35], v[132:135]
ds_read_b128 a[128:131], v5 offset:18432
v_mfma_f32_16x16x32_bf16 v[156:159], a[96:99], a[36:39], v[156:159]
buffer_load_dwordx4 a[16:19], v2, s[40:43], s35 offen offset:0 sc1
v_mfma_f32_16x16x32_bf16 v[180:183], a[96:99], a[40:43], v[180:183]
ds_read_b128 a[132:135], v5 offset:19456
v_mfma_f32_16x16x32_bf16 v[204:207], a[96:99], a[44:47], v[204:207]
v_mfma_f32_16x16x32_bf16 v[208:211], a[100:103], a[44:47], v[208:211]
v_mfma_f32_16x16x32_bf16 v[184:187], a[100:103], a[40:43], v[184:187]
buffer_load_dwordx4 a[20:23], v2, s[40:43], s35 offen offset:1024 sc1
v_mfma_f32_16x16x32_bf16 v[160:163], a[100:103], a[36:39], v[160:163]
ds_read_b128 a[136:139], v5 offset:20480
v_mfma_f32_16x16x32_bf16 v[136:139], a[100:103], a[32:35], v[136:139]
v_mfma_f32_16x16x32_bf16 v[140:143], a[104:107], a[32:35], v[140:143]
ds_read_b128 a[140:143], v5 offset:21504
v_mfma_f32_16x16x32_bf16 v[164:167], a[104:107], a[36:39], v[164:167]
v_mfma_f32_16x16x32_bf16 v[188:191], a[104:107], a[40:43], v[188:191]
buffer_load_dwordx4 v1, s[4:7], s44 offen offset:2048 sc1 lds
s_add_u32 s44, s28, 4
v_mfma_f32_16x16x32_bf16 v[212:215], a[104:107], a[44:47], v[212:215]
s_mul_i32 s45, s44, 3072
s_add_u32 m0, s45, 98304
s_lshr_b32 s44, s44, 1
v_mfma_f32_16x16x32_bf16 v[216:219], a[108:111], a[44:47], v[216:219]
s_add_u32 s44, s44, 16
s_add_u32 s44, s44, s33
s_and_b32 s44, s44, 31
v_mfma_f32_16x16x32_bf16 v[192:195], a[108:111], a[40:43], v[192:195]
s_mul_i32 s44, s44, 6144
s_add_u32 s44, s44, s50
s_add_u32 s44, s44, 0x600000
v_mfma_f32_16x16x32_bf16 v[168:171], a[108:111], a[36:39], v[168:171]
ds_read_b128 a[144:147], v5 offset:22528
v_mfma_f32_16x16x32_bf16 v[144:147], a[108:111], a[32:35], v[144:147]
buffer_load_dwordx4 a[24:27], v2, s[40:43], s35 offen offset:2048 sc1
v_mfma_f32_16x16x32_bf16 v[148:151], a[112:115], a[32:35], v[148:151]
ds_read_b128 a[148:151], v5 offset:23552
v_mfma_f32_16x16x32_bf16 v[172:175], a[112:115], a[36:39], v[172:175]
v_mfma_f32_16x16x32_bf16 v[196:199], a[112:115], a[40:43], v[196:199]
v_mfma_f32_16x16x32_bf16 v[220:223], a[112:115], a[44:47], v[220:223]
v_mfma_f32_16x16x32_bf16 v[224:227], a[116:119], a[44:47], v[224:227]
buffer_load_dwordx4 a[28:31], v2, s[40:43], s35 offen offset:3072 sc1
s_add_u32 s35, s35, 4096
v_mfma_f32_16x16x32_bf16 v[200:203], a[116:119], a[40:43], v[200:203]
s_and_b32 s35, s35, 0x1ffff
v_mfma_f32_16x16x32_bf16 v[176:179], a[116:119], a[36:39], v[176:179]
v_mfma_f32_16x16x32_bf16 v[152:155], a[116:119], a[32:35], v[152:155]
s_waitcnt vmcnt(11) lgkmcnt(0)
v_mfma_f32_16x16x32_bf16 v[132:135], a[128:131], a[48:51], v[132:135]
ds_read_b128 a[96:99], v5 offset:24576
v_mfma_f32_16x16x32_bf16 v[156:159], a[128:131], a[52:55], v[156:159]
buffer_load_dwordx4 a[32:35], v2, s[40:43], s35 offen offset:0 sc1
v_mfma_f32_16x16x32_bf16 v[180:183], a[128:131], a[56:59], v[180:183]
ds_read_b128 a[100:103], v5 offset:25600
v_mfma_f32_16x16x32_bf16 v[204:207], a[128:131], a[60:63], v[204:207]
v_mfma_f32_16x16x32_bf16 v[208:211], a[132:135], a[60:63], v[208:211]
v_mfma_f32_16x16x32_bf16 v[184:187], a[132:135], a[56:59], v[184:187]
buffer_load_dwordx4 v1, s[4:7], s44 offen offset:0 sc1 lds
v_mfma_f32_16x16x32_bf16 v[160:163], a[132:135], a[52:55], v[160:163]
ds_read_b128 a[104:107], v5 offset:26624
v_mfma_f32_16x16x32_bf16 v[136:139], a[132:135], a[48:51], v[136:139]
v_mfma_f32_16x16x32_bf16 v[140:143], a[136:139], a[48:51], v[140:143]
ds_read_b128 a[108:111], v5 offset:27648
v_mfma_f32_16x16x32_bf16 v[164:167], a[136:139], a[52:55], v[164:167]
buffer_load_dwordx4 a[36:39], v2, s[40:43], s35 offen offset:1024 sc1
v_mfma_f32_16x16x32_bf16 v[188:191], a[136:139], a[56:59], v[188:191]
ds_read_b128 a[112:115], v5 offset:28672
v_mfma_f32_16x16x32_bf16 v[212:215], a[136:139], a[60:63], v[212:215]
v_mfma_f32_16x16x32_bf16 v[216:219], a[140:143], a[60:63], v[216:219]
v_mfma_f32_16x16x32_bf16 v[192:195], a[140:143], a[56:59], v[192:195]
buffer_load_dwordx4 a[40:43], v2, s[40:43], s35 offen offset:2048 sc1
v_mfma_f32_16x16x32_bf16 v[168:171], a[140:143], a[52:55], v[168:171]
ds_read_b128 a[116:119], v5 offset:29696
v_mfma_f32_16x16x32_bf16 v[144:147], a[140:143], a[48:51], v[144:147]
v_mfma_f32_16x16x32_bf16 v[148:151], a[144:147], a[48:51], v[148:151]
v_mfma_f32_16x16x32_bf16 v[172:175], a[144:147], a[52:55], v[172:175]
buffer_load_dwordx4 v1, s[4:7], s44 offen offset:1024 sc1 lds
v_mfma_f32_16x16x32_bf16 v[196:199], a[144:147], a[56:59], v[196:199]
v_mfma_f32_16x16x32_bf16 v[220:223], a[144:147], a[60:63], v[220:223]
v_mfma_f32_16x16x32_bf16 v[224:227], a[148:151], a[60:63], v[224:227]
v_mfma_f32_16x16x32_bf16 v[200:203], a[148:151], a[56:59], v[200:203]
buffer_load_dwordx4 a[44:47], v2, s[40:43], s35 offen offset:3072 sc1
s_add_u32 s35, s35, 4096
v_mfma_f32_16x16x32_bf16 v[176:179], a[148:151], a[52:55], v[176:179]
s_and_b32 s35, s35, 0x1ffff
v_mfma_f32_16x16x32_bf16 v[152:155], a[148:151], a[48:51], v[152:155]
s_waitcnt vmcnt(11) lgkmcnt(0)
v_mfma_f32_16x16x32_bf16 v[132:135], a[96:99], a[0:3], v[132:135]
ds_read_b128 a[128:131], v5 offset:30720
v_mfma_f32_16x16x32_bf16 v[156:159], a[96:99], a[4:7], v[156:159]
buffer_load_dwordx4 a[48:51], v2, s[40:43], s35 offen offset:0 sc1
v_mfma_f32_16x16x32_bf16 v[180:183], a[96:99], a[8:11], v[180:183]
ds_read_b128 a[132:135], v5 offset:31744
v_mfma_f32_16x16x32_bf16 v[204:207], a[96:99], a[12:15], v[204:207]
v_mfma_f32_16x16x32_bf16 v[208:211], a[100:103], a[12:15], v[208:211]
v_mfma_f32_16x16x32_bf16 v[184:187], a[100:103], a[8:11], v[184:187]
buffer_load_dwordx4 v1, s[4:7], s44 offen offset:2048 sc1 lds
s_add_u32 s44, s28, 8
v_mfma_f32_16x16x32_bf16 v[160:163], a[100:103], a[4:7], v[160:163]
s_mul_i32 s45, s44, 3072
s_add_u32 m0, s45, 98304
s_lshr_b32 s44, s44, 1
v_mfma_f32_16x16x32_bf16 v[136:139], a[100:103], a[0:3], v[136:139]
s_add_u32 s44, s44, 16
s_add_u32 s44, s44, s33
s_and_b32 s44, s44, 31
v_mfma_f32_16x16x32_bf16 v[140:143], a[104:107], a[0:3], v[140:143]
s_mul_i32 s44, s44, 6144
s_add_u32 s44, s44, s50
s_add_u32 s44, s44, 0x600000
v_mfma_f32_16x16x32_bf16 v[164:167], a[104:107], a[4:7], v[164:167]
buffer_load_dwordx4 a[52:55], v2, s[40:43], s35 offen offset:1024 sc1
v_mfma_f32_16x16x32_bf16 v[188:191], a[104:107], a[8:11], v[188:191]
ds_read_b128 a[136:139], v5 offset:32768
v_mfma_f32_16x16x32_bf16 v[212:215], a[104:107], a[12:15], v[212:215]
ds_read_b128 a[140:143], v5 offset:33792
v_mfma_f32_16x16x32_bf16 v[216:219], a[108:111], a[12:15], v[216:219]
ds_read_b128 a[144:147], v5 offset:34816
v_mfma_f32_16x16x32_bf16 v[192:195], a[108:111], a[8:11], v[192:195]
buffer_load_dwordx4 a[56:59], v2, s[40:43], s35 offen offset:2048 sc1
v_mfma_f32_16x16x32_bf16 v[168:171], a[108:111], a[4:7], v[168:171]
ds_read_b128 a[148:151], v5 offset:35840
v_mfma_f32_16x16x32_bf16 v[144:147], a[108:111], a[0:3], v[144:147]
v_mfma_f32_16x16x32_bf16 v[148:151], a[112:115], a[0:3], v[148:151]
v_mfma_f32_16x16x32_bf16 v[172:175], a[112:115], a[4:7], v[172:175]
buffer_load_dwordx4 v1, s[4:7], s44 offen offset:0 sc1 lds
v_mfma_f32_16x16x32_bf16 v[196:199], a[112:115], a[8:11], v[196:199]
v_mfma_f32_16x16x32_bf16 v[220:223], a[112:115], a[12:15], v[220:223]
v_mfma_f32_16x16x32_bf16 v[224:227], a[116:119], a[12:15], v[224:227]
v_mfma_f32_16x16x32_bf16 v[200:203], a[116:119], a[8:11], v[200:203]
buffer_load_dwordx4 a[60:63], v2, s[40:43], s35 offen offset:3072 sc1
s_add_u32 s35, s35, 4096
v_mfma_f32_16x16x32_bf16 v[176:179], a[116:119], a[4:7], v[176:179]
s_and_b32 s35, s35, 0x1ffff
v_mfma_f32_16x16x32_bf16 v[152:155], a[116:119], a[0:3], v[152:155]
s_waitcnt vmcnt(12) lgkmcnt(0)
v_mfma_f32_16x16x32_bf16 v[132:135], a[128:131], a[16:19], v[132:135]
ds_read_b128 a[96:99], v5 offset:36864
v_mfma_f32_16x16x32_bf16 v[156:159], a[128:131], a[20:23], v[156:159]
buffer_load_dwordx4 a[0:3], v2, s[40:43], s35 offen offset:0 sc1
v_mfma_f32_16x16x32_bf16 v[180:183], a[128:131], a[24:27], v[180:183]
ds_read_b128 a[100:103], v5 offset:37888
v_mfma_f32_16x16x32_bf16 v[204:207], a[128:131], a[28:31], v[204:207]
v_mfma_f32_16x16x32_bf16 v[208:211], a[132:135], a[28:31], v[208:211]
v_mfma_f32_16x16x32_bf16 v[184:187], a[132:135], a[24:27], v[184:187]
buffer_load_dwordx4 a[4:7], v2, s[40:43], s35 offen offset:1024 sc1
v_mfma_f32_16x16x32_bf16 v[160:163], a[132:135], a[20:23], v[160:163]
ds_read_b128 a[104:107], v5 offset:38912
v_mfma_f32_16x16x32_bf16 v[136:139], a[132:135], a[16:19], v[136:139]
v_mfma_f32_16x16x32_bf16 v[140:143], a[136:139], a[16:19], v[140:143]
ds_read_b128 a[108:111], v5 offset:39936
v_mfma_f32_16x16x32_bf16 v[164:167], a[136:139], a[20:23], v[164:167]
v_mfma_f32_16x16x32_bf16 v[188:191], a[136:139], a[24:27], v[188:191]
buffer_load_dwordx4 v1, s[4:7], s44 offen offset:1024 sc1 lds
v_mfma_f32_16x16x32_bf16 v[212:215], a[136:139], a[28:31], v[212:215]
ds_read_b128 a[112:115], v5 offset:40960
v_mfma_f32_16x16x32_bf16 v[216:219], a[140:143], a[28:31], v[216:219]
v_mfma_f32_16x16x32_bf16 v[192:195], a[140:143], a[24:27], v[192:195]
ds_read_b128 a[116:119], v5 offset:41984
v_mfma_f32_16x16x32_bf16 v[168:171], a[140:143], a[20:23], v[168:171]
v_mfma_f32_16x16x32_bf16 v[144:147], a[140:143], a[16:19], v[144:147]
buffer_load_dwordx4 a[8:11], v2, s[40:43], s35 offen offset:2048 sc1
v_mfma_f32_16x16x32_bf16 v[148:151], a[144:147], a[16:19], v[148:151]
v_mfma_f32_16x16x32_bf16 v[172:175], a[144:147], a[20:23], v[172:175]
v_mfma_f32_16x16x32_bf16 v[196:199], a[144:147], a[24:27], v[196:199]
v_mfma_f32_16x16x32_bf16 v[220:223], a[144:147], a[28:31], v[220:223]
v_mfma_f32_16x16x32_bf16 v[224:227], a[148:151], a[28:31], v[224:227]
buffer_load_dwordx4 a[12:15], v2, s[40:43], s35 offen offset:3072 sc1
s_add_u32 s35, s35, 4096
v_mfma_f32_16x16x32_bf16 v[200:203], a[148:151], a[24:27], v[200:203]
s_and_b32 s35, s35, 0x1ffff
v_mfma_f32_16x16x32_bf16 v[176:179], a[148:151], a[20:23], v[176:179]
v_mfma_f32_16x16x32_bf16 v[152:155], a[148:151], a[16:19], v[152:155]
s_waitcnt vmcnt(11) lgkmcnt(0)
v_mfma_f32_16x16x32_bf16 v[132:135], a[96:99], a[32:35], v[132:135]
ds_read_b128 a[128:131], v5 offset:43008
v_mfma_f32_16x16x32_bf16 v[156:159], a[96:99], a[36:39], v[156:159]
buffer_load_dwordx4 a[16:19], v2, s[40:43], s35 offen offset:0 sc1
v_mfma_f32_16x16x32_bf16 v[180:183], a[96:99], a[40:43], v[180:183]
ds_read_b128 a[132:135], v5 offset:44032
v_mfma_f32_16x16x32_bf16 v[204:207], a[96:99], a[44:47], v[204:207]
v_mfma_f32_16x16x32_bf16 v[208:211], a[100:103], a[44:47], v[208:211]
v_mfma_f32_16x16x32_bf16 v[184:187], a[100:103], a[40:43], v[184:187]
buffer_load_dwordx4 v1, s[4:7], s44 offen offset:2048 sc1 lds
s_add_u32 s44, s28, 12
v_mfma_f32_16x16x32_bf16 v[160:163], a[100:103], a[36:39], v[160:163]
s_mul_i32 s45, s44, 3072
s_add_u32 m0, s45, 98304
s_lshr_b32 s44, s44, 1
v_mfma_f32_16x16x32_bf16 v[136:139], a[100:103], a[32:35], v[136:139]
s_add_u32 s44, s44, 16
s_add_u32 s44, s44, s33
s_and_b32 s44, s44, 31
v_mfma_f32_16x16x32_bf16 v[140:143], a[104:107], a[32:35], v[140:143]
s_mul_i32 s44, s44, 6144
s_add_u32 s44, s44, s50
s_add_u32 s44, s44, 0x600000
v_mfma_f32_16x16x32_bf16 v[164:167], a[104:107], a[36:39], v[164:167]
buffer_load_dwordx4 a[20:23], v2, s[40:43], s35 offen offset:1024 sc1
v_mfma_f32_16x16x32_bf16 v[188:191], a[104:107], a[40:43], v[188:191]
ds_read_b128 a[136:139], v5 offset:45056
v_mfma_f32_16x16x32_bf16 v[212:215], a[104:107], a[44:47], v[212:215]
ds_read_b128 a[140:143], v5 offset:46080
v_mfma_f32_16x16x32_bf16 v[216:219], a[108:111], a[44:47], v[216:219]
ds_read_b128 a[144:147], v5 offset:47104
v_mfma_f32_16x16x32_bf16 v[192:195], a[108:111], a[40:43], v[192:195]
buffer_load_dwordx4 a[24:27], v2, s[40:43], s35 offen offset:2048 sc1
v_mfma_f32_16x16x32_bf16 v[168:171], a[108:111], a[36:39], v[168:171]
ds_read_b128 a[148:151], v5 offset:48128
v_mfma_f32_16x16x32_bf16 v[144:147], a[108:111], a[32:35], v[144:147]
v_mfma_f32_16x16x32_bf16 v[148:151], a[112:115], a[32:35], v[148:151]
v_mfma_f32_16x16x32_bf16 v[172:175], a[112:115], a[36:39], v[172:175]
buffer_load_dwordx4 v1, s[4:7], s44 offen offset:0 sc1 lds
v_mfma_f32_16x16x32_bf16 v[196:199], a[112:115], a[40:43], v[196:199]
v_mfma_f32_16x16x32_bf16 v[220:223], a[112:115], a[44:47], v[220:223]
v_mfma_f32_16x16x32_bf16 v[224:227], a[116:119], a[44:47], v[224:227]
v_mfma_f32_16x16x32_bf16 v[200:203], a[116:119], a[40:43], v[200:203]
buffer_load_dwordx4 a[28:31], v2, s[40:43], s35 offen offset:3072 sc1
s_add_u32 s35, s35, 4096
v_mfma_f32_16x16x32_bf16 v[176:179], a[116:119], a[36:39], v[176:179]
s_and_b32 s35, s35, 0x1ffff
v_mfma_f32_16x16x32_bf16 v[152:155], a[116:119], a[32:35], v[152:155]
s_waitcnt vmcnt(11) lgkmcnt(0)
s_barrier
v_mfma_f32_16x16x32_bf16 v[132:135], a[128:131], a[48:51], v[132:135]
v_add_u32 v5, 49152, v1
v_mfma_f32_16x16x32_bf16 v[156:159], a[128:131], a[52:55], v[156:159]
buffer_load_dwordx4 a[32:35], v2, s[40:43], s35 offen offset:0 sc1
v_mfma_f32_16x16x32_bf16 v[180:183], a[128:131], a[56:59], v[180:183]
ds_read_b128 a[96:99], v5 offset:0
v_mfma_f32_16x16x32_bf16 v[204:207], a[128:131], a[60:63], v[204:207]
ds_read_b128 a[100:103], v5 offset:1024
v_mfma_f32_16x16x32_bf16 v[208:211], a[132:135], a[60:63], v[208:211]
v_mfma_f32_16x16x32_bf16 v[184:187], a[132:135], a[56:59], v[184:187]
buffer_load_dwordx4 v1, s[4:7], s44 offen offset:1024 sc1 lds
v_mfma_f32_16x16x32_bf16 v[160:163], a[132:135], a[52:55], v[160:163]
ds_read_b128 a[104:107], v5 offset:2048
v_mfma_f32_16x16x32_bf16 v[136:139], a[132:135], a[48:51], v[136:139]
v_mfma_f32_16x16x32_bf16 v[140:143], a[136:139], a[48:51], v[140:143]
ds_read_b128 a[108:111], v5 offset:3072
v_mfma_f32_16x16x32_bf16 v[164:167], a[136:139], a[52:55], v[164:167]
buffer_load_dwordx4 a[36:39], v2, s[40:43], s35 offen offset:1024 sc1
v_mfma_f32_16x16x32_bf16 v[188:191], a[136:139], a[56:59], v[188:191]
ds_read_b128 a[112:115], v5 offset:4096
v_mfma_f32_16x16x32_bf16 v[212:215], a[136:139], a[60:63], v[212:215]
v_mfma_f32_16x16x32_bf16 v[216:219], a[140:143], a[60:63], v[216:219]
v_mfma_f32_16x16x32_bf16 v[192:195], a[140:143], a[56:59], v[192:195]
buffer_load_dwordx4 a[40:43], v2, s[40:43], s35 offen offset:2048 sc1
v_mfma_f32_16x16x32_bf16 v[168:171], a[140:143], a[52:55], v[168:171]
ds_read_b128 a[116:119], v5 offset:5120
v_mfma_f32_16x16x32_bf16 v[144:147], a[140:143], a[48:51], v[144:147]
v_mfma_f32_16x16x32_bf16 v[148:151], a[144:147], a[48:51], v[148:151]
v_mfma_f32_16x16x32_bf16 v[172:175], a[144:147], a[52:55], v[172:175]
buffer_load_dwordx4 v1, s[4:7], s44 offen offset:2048 sc1 lds
s_add_u32 s88, s82, 0x240000
v_mfma_f32_16x16x32_bf16 v[196:199], a[144:147], a[56:59], v[196:199]
v_mfma_f32_16x16x32_bf16 v[220:223], a[144:147], a[60:63], v[220:223]
v_mfma_f32_16x16x32_bf16 v[224:227], a[148:151], a[60:63], v[224:227]
v_mfma_f32_16x16x32_bf16 v[200:203], a[148:151], a[56:59], v[200:203]
buffer_load_dwordx4 a[44:47], v2, s[40:43], s35 offen offset:3072 sc1
s_add_u32 s35, s35, 4096
v_mfma_f32_16x16x32_bf16 v[176:179], a[148:151], a[52:55], v[176:179]
s_and_b32 s35, s35, 0x1ffff
v_mfma_f32_16x16x32_bf16 v[152:155], a[148:151], a[48:51], v[152:155]
s_waitcnt vmcnt(12) lgkmcnt(0)
v_mfma_f32_16x16x32_bf16 v[132:135], a[96:99], a[0:3], v[132:135]
ds_read_b128 a[128:131], v5 offset:6144
v_mfma_f32_16x16x32_bf16 v[156:159], a[96:99], a[4:7], v[156:159]
buffer_load_dwordx4 a[48:51], v2, s[40:43], s35 offen offset:0 sc1
v_mfma_f32_16x16x32_bf16 v[180:183], a[96:99], a[8:11], v[180:183]
ds_read_b128 a[132:135], v5 offset:7168
v_mfma_f32_16x16x32_bf16 v[204:207], a[96:99], a[12:15], v[204:207]
v_mfma_f32_16x16x32_bf16 v[208:211], a[100:103], a[12:15], v[208:211]
v_mfma_f32_16x16x32_bf16 v[184:187], a[100:103], a[8:11], v[184:187]
buffer_load_dwordx4 a[52:55], v2, s[40:43], s35 offen offset:1024 sc1
v_mfma_f32_16x16x32_bf16 v[160:163], a[100:103], a[4:7], v[160:163]
ds_read_b128 a[136:139], v5 offset:8192
v_mfma_f32_16x16x32_bf16 v[136:139], a[100:103], a[0:3], v[136:139]
v_mfma_f32_16x16x32_bf16 v[140:143], a[104:107], a[0:3], v[140:143]
ds_read_b128 a[140:143], v5 offset:9216
v_mfma_f32_16x16x32_bf16 v[164:167], a[104:107], a[4:7], v[164:167]
v_mfma_f32_16x16x32_bf16 v[188:191], a[104:107], a[8:11], v[188:191]
buffer_load_dwordx4 v[92:95], v1, s[4:7], s88 offen offset:0 sc1
v_mfma_f32_16x16x32_bf16 v[212:215], a[104:107], a[12:15], v[212:215]
ds_read_b128 a[144:147], v5 offset:10240
v_mfma_f32_16x16x32_bf16 v[216:219], a[108:111], a[12:15], v[216:219]
v_mfma_f32_16x16x32_bf16 v[192:195], a[108:111], a[8:11], v[192:195]
ds_read_b128 a[148:151], v5 offset:11264
v_mfma_f32_16x16x32_bf16 v[168:171], a[108:111], a[4:7], v[168:171]
v_mfma_f32_16x16x32_bf16 v[144:147], a[108:111], a[0:3], v[144:147]
buffer_load_dwordx4 a[56:59], v2, s[40:43], s35 offen offset:2048 sc1
v_mfma_f32_16x16x32_bf16 v[148:151], a[112:115], a[0:3], v[148:151]
v_mfma_f32_16x16x32_bf16 v[172:175], a[112:115], a[4:7], v[172:175]
v_mfma_f32_16x16x32_bf16 v[196:199], a[112:115], a[8:11], v[196:199]
v_mfma_f32_16x16x32_bf16 v[220:223], a[112:115], a[12:15], v[220:223]
v_mfma_f32_16x16x32_bf16 v[224:227], a[116:119], a[12:15], v[224:227]
buffer_load_dwordx4 a[60:63], v2, s[40:43], s35 offen offset:3072 sc1
s_add_u32 s35, s35, 4096
v_mfma_f32_16x16x32_bf16 v[200:203], a[116:119], a[8:11], v[200:203]
s_and_b32 s35, s35, 0x1ffff
v_mfma_f32_16x16x32_bf16 v[176:179], a[116:119], a[4:7], v[176:179]
v_mfma_f32_16x16x32_bf16 v[152:155], a[116:119], a[0:3], v[152:155]
s_waitcnt vmcnt(11) lgkmcnt(0)
v_mfma_f32_16x16x32_bf16 v[132:135], a[128:131], a[16:19], v[132:135]
ds_read_b128 a[96:99], v5 offset:12288
v_mfma_f32_16x16x32_bf16 v[156:159], a[128:131], a[20:23], v[156:159]
buffer_load_dwordx4 a[0:3], v2, s[40:43], s35 offen offset:0 sc1
v_mfma_f32_16x16x32_bf16 v[180:183], a[128:131], a[24:27], v[180:183]
ds_read_b128 a[100:103], v5 offset:13312
v_mfma_f32_16x16x32_bf16 v[204:207], a[128:131], a[28:31], v[204:207]
v_mfma_f32_16x16x32_bf16 v[208:211], a[132:135], a[28:31], v[208:211]
v_mfma_f32_16x16x32_bf16 v[184:187], a[132:135], a[24:27], v[184:187]
buffer_load_dwordx4 v[96:99], v1, s[4:7], s88 offen offset:1024 sc1
v_mfma_f32_16x16x32_bf16 v[160:163], a[132:135], a[20:23], v[160:163]
ds_read_b128 a[104:107], v5 offset:14336
v_mfma_f32_16x16x32_bf16 v[136:139], a[132:135], a[16:19], v[136:139]
v_mfma_f32_16x16x32_bf16 v[140:143], a[136:139], a[16:19], v[140:143]
ds_read_b128 a[108:111], v5 offset:15360
v_mfma_f32_16x16x32_bf16 v[164:167], a[136:139], a[20:23], v[164:167]
buffer_load_dwordx4 a[4:7], v2, s[40:43], s35 offen offset:1024 sc1
v_mfma_f32_16x16x32_bf16 v[188:191], a[136:139], a[24:27], v[188:191]
ds_read_b128 a[112:115], v5 offset:16384
v_mfma_f32_16x16x32_bf16 v[212:215], a[136:139], a[28:31], v[212:215]
v_mfma_f32_16x16x32_bf16 v[216:219], a[140:143], a[28:31], v[216:219]
v_mfma_f32_16x16x32_bf16 v[192:195], a[140:143], a[24:27], v[192:195]
buffer_load_dwordx4 a[8:11], v2, s[40:43], s35 offen offset:2048 sc1
v_mfma_f32_16x16x32_bf16 v[168:171], a[140:143], a[20:23], v[168:171]
ds_read_b128 a[116:119], v5 offset:17408
v_mfma_f32_16x16x32_bf16 v[144:147], a[140:143], a[16:19], v[144:147]
v_mfma_f32_16x16x32_bf16 v[148:151], a[144:147], a[16:19], v[148:151]
v_mfma_f32_16x16x32_bf16 v[172:175], a[144:147], a[20:23], v[172:175]
buffer_load_dwordx4 v[100:103], v1, s[4:7], s88 offen offset:2048 sc1
v_mfma_f32_16x16x32_bf16 v[196:199], a[144:147], a[24:27], v[196:199]
v_mfma_f32_16x16x32_bf16 v[220:223], a[144:147], a[28:31], v[220:223]
v_mfma_f32_16x16x32_bf16 v[224:227], a[148:151], a[28:31], v[224:227]
v_mfma_f32_16x16x32_bf16 v[200:203], a[148:151], a[24:27], v[200:203]
buffer_load_dwordx4 a[12:15], v2, s[40:43], s35 offen offset:3072 sc1
s_add_u32 s35, s35, 4096
v_mfma_f32_16x16x32_bf16 v[176:179], a[148:151], a[20:23], v[176:179]
s_and_b32 s35, s35, 0x1ffff
v_mfma_f32_16x16x32_bf16 v[152:155], a[148:151], a[16:19], v[152:155]
s_waitcnt vmcnt(11) lgkmcnt(0)
v_mfma_f32_16x16x32_bf16 v[132:135], a[96:99], a[32:35], v[132:135]
ds_read_b128 a[128:131], v5 offset:18432
v_mfma_f32_16x16x32_bf16 v[156:159], a[96:99], a[36:39], v[156:159]
buffer_load_dwordx4 a[16:19], v2, s[40:43], s35 offen offset:0 sc1
v_mfma_f32_16x16x32_bf16 v[180:183], a[96:99], a[40:43], v[180:183]
ds_read_b128 a[132:135], v5 offset:19456
v_mfma_f32_16x16x32_bf16 v[204:207], a[96:99], a[44:47], v[204:207]
v_mfma_f32_16x16x32_bf16 v[208:211], a[100:103], a[44:47], v[208:211]
v_mfma_f32_16x16x32_bf16 v[184:187], a[100:103], a[40:43], v[184:187]
buffer_load_dwordx4 v[104:107], v1, s[4:7], s88 offen offset:3072 sc1
s_add_u32 s88, s88, 4096
v_mfma_f32_16x16x32_bf16 v[160:163], a[100:103], a[36:39], v[160:163]
ds_read_b128 a[136:139], v5 offset:20480
v_mfma_f32_16x16x32_bf16 v[136:139], a[100:103], a[32:35], v[136:139]
v_mfma_f32_16x16x32_bf16 v[140:143], a[104:107], a[32:35], v[140:143]
ds_read_b128 a[140:143], v5 offset:21504
v_mfma_f32_16x16x32_bf16 v[164:167], a[104:107], a[36:39], v[164:167]
buffer_load_dwordx4 a[20:23], v2, s[40:43], s35 offen offset:1024 sc1
v_mfma_f32_16x16x32_bf16 v[188:191], a[104:107], a[40:43], v[188:191]
ds_read_b128 a[144:147], v5 offset:22528
v_mfma_f32_16x16x32_bf16 v[212:215], a[104:107], a[44:47], v[212:215]
v_mfma_f32_16x16x32_bf16 v[216:219], a[108:111], a[44:47], v[216:219]
v_mfma_f32_16x16x32_bf16 v[192:195], a[108:111], a[40:43], v[192:195]
buffer_load_dwordx4 a[24:27], v2, s[40:43], s35 offen offset:2048 sc1
v_mfma_f32_16x16x32_bf16 v[168:171], a[108:111], a[36:39], v[168:171]
ds_read_b128 a[148:151], v5 offset:23552
v_mfma_f32_16x16x32_bf16 v[144:147], a[108:111], a[32:35], v[144:147]
v_mfma_f32_16x16x32_bf16 v[148:151], a[112:115], a[32:35], v[148:151]
v_mfma_f32_16x16x32_bf16 v[172:175], a[112:115], a[36:39], v[172:175]
buffer_load_dwordx4 v[108:111], v1, s[4:7], s88 offen offset:0 sc1
v_mfma_f32_16x16x32_bf16 v[196:199], a[112:115], a[40:43], v[196:199]
v_mfma_f32_16x16x32_bf16 v[220:223], a[112:115], a[44:47], v[220:223]
v_mfma_f32_16x16x32_bf16 v[224:227], a[116:119], a[44:47], v[224:227]
v_mfma_f32_16x16x32_bf16 v[200:203], a[116:119], a[40:43], v[200:203]
buffer_load_dwordx4 a[28:31], v2, s[40:43], s35 offen offset:3072 sc1
s_add_u32 s35, s35, 4096
v_mfma_f32_16x16x32_bf16 v[176:179], a[116:119], a[36:39], v[176:179]
s_and_b32 s35, s35, 0x1ffff
v_mfma_f32_16x16x32_bf16 v[152:155], a[116:119], a[32:35], v[152:155]
s_waitcnt vmcnt(12) lgkmcnt(0)
v_mfma_f32_16x16x32_bf16 v[132:135], a[128:131], a[48:51], v[132:135]
ds_read_b128 a[96:99], v5 offset:24576
v_mfma_f32_16x16x32_bf16 v[156:159], a[128:131], a[52:55], v[156:159]
buffer_load_dwordx4 a[32:35], v2, s[40:43], s35 offen offset:0 sc1
v_mfma_f32_16x16x32_bf16 v[180:183], a[128:131], a[56:59], v[180:183]
ds_read_b128 a[100:103], v5 offset:25600
v_mfma_f32_16x16x32_bf16 v[204:207], a[128:131], a[60:63], v[204:207]
v_mfma_f32_16x16x32_bf16 v[208:211], a[132:135], a[60:63], v[208:211]
v_mfma_f32_16x16x32_bf16 v[184:187], a[132:135], a[56:59], v[184:187]
buffer_load_dwordx4 a[36:39], v2, s[40:43], s35 offen offset:1024 sc1
v_mfma_f32_16x16x32_bf16 v[160:163], a[132:135], a[52:55], v[160:163]
ds_read_b128 a[104:107], v5 offset:26624
v_mfma_f32_16x16x32_bf16 v[136:139], a[132:135], a[48:51], v[136:139]
v_mfma_f32_16x16x32_bf16 v[140:143], a[136:139], a[48:51], v[140:143]
ds_read_b128 a[108:111], v5 offset:27648
v_mfma_f32_16x16x32_bf16 v[164:167], a[136:139], a[52:55], v[164:167]
v_mfma_f32_16x16x32_bf16 v[188:191], a[136:139], a[56:59], v[188:191]
buffer_load_dwordx4 v[112:115], v1, s[4:7], s88 offen offset:1024 sc1
v_mfma_f32_16x16x32_bf16 v[212:215], a[136:139], a[60:63], v[212:215]
ds_read_b128 a[112:115], v5 offset:28672
v_mfma_f32_16x16x32_bf16 v[216:219], a[140:143], a[60:63], v[216:219]
v_mfma_f32_16x16x32_bf16 v[192:195], a[140:143], a[56:59], v[192:195]
ds_read_b128 a[116:119], v5 offset:29696
v_mfma_f32_16x16x32_bf16 v[168:171], a[140:143], a[52:55], v[168:171]
v_mfma_f32_16x16x32_bf16 v[144:147], a[140:143], a[48:51], v[144:147]
buffer_load_dwordx4 a[40:43], v2, s[40:43], s35 offen offset:2048 sc1
v_mfma_f32_16x16x32_bf16 v[148:151], a[144:147], a[48:51], v[148:151]
v_mfma_f32_16x16x32_bf16 v[172:175], a[144:147], a[52:55], v[172:175]
v_mfma_f32_16x16x32_bf16 v[196:199], a[144:147], a[56:59], v[196:199]
v_mfma_f32_16x16x32_bf16 v[220:223], a[144:147], a[60:63], v[220:223]
v_mfma_f32_16x16x32_bf16 v[224:227], a[148:151], a[60:63], v[224:227]
buffer_load_dwordx4 a[44:47], v2, s[40:43], s35 offen offset:3072 sc1
s_add_u32 s35, s35, 4096
v_mfma_f32_16x16x32_bf16 v[200:203], a[148:151], a[56:59], v[200:203]
s_and_b32 s35, s35, 0x1ffff
v_mfma_f32_16x16x32_bf16 v[176:179], a[148:151], a[52:55], v[176:179]
v_mfma_f32_16x16x32_bf16 v[152:155], a[148:151], a[48:51], v[152:155]
s_waitcnt vmcnt(11) lgkmcnt(0)
v_mfma_f32_16x16x32_bf16 v[132:135], a[96:99], a[0:3], v[132:135]
ds_read_b128 a[128:131], v5 offset:30720
v_add_f32_dpp v48, v48, v48 row_ror:8 row_mask:0xf bank_mask:0xf
v_mfma_f32_16x16x32_bf16 v[156:159], a[96:99], a[4:7], v[156:159]
buffer_load_dwordx4 a[48:51], v2, s[40:43], s35 offen offset:0 sc1
v_mfma_f32_16x16x32_bf16 v[180:183], a[96:99], a[8:11], v[180:183]
ds_read_b128 a[132:135], v5 offset:31744
v_add_f32_dpp v49, v49, v49 row_ror:8 row_mask:0xf bank_mask:0xf
v_mfma_f32_16x16x32_bf16 v[204:207], a[96:99], a[12:15], v[204:207]
v_add_f32_dpp v50, v50, v50 row_ror:8 row_mask:0xf bank_mask:0xf
v_add_f32_dpp v51, v51, v51 row_ror:8 row_mask:0xf bank_mask:0xf
v_mfma_f32_16x16x32_bf16 v[208:211], a[100:103], a[12:15], v[208:211]
v_add_f32_dpp v52, v52, v52 row_ror:8 row_mask:0xf bank_mask:0xf
v_add_f32_dpp v53, v53, v53 row_ror:8 row_mask:0xf bank_mask:0xf
v_mfma_f32_16x16x32_bf16 v[184:187], a[100:103], a[8:11], v[184:187]
buffer_load_dwordx4 v[116:119], v1, s[4:7], s88 offen offset:2048 sc1
v_mfma_f32_16x16x32_bf16 v[160:163], a[100:103], a[4:7], v[160:163]
ds_read_b128 a[136:139], v5 offset:32768
v_add_f32_dpp v54, v54, v54 row_ror:8 row_mask:0xf bank_mask:0xf
v_mfma_f32_16x16x32_bf16 v[136:139], a[100:103], a[0:3], v[136:139]
v_add_f32_dpp v55, v55, v55 row_ror:8 row_mask:0xf bank_mask:0xf
v_add_f32_dpp v48, v48, v48 row_ror:4 row_mask:0xf bank_mask:0xf
v_mfma_f32_16x16x32_bf16 v[140:143], a[104:107], a[0:3], v[140:143]
ds_read_b128 a[140:143], v5 offset:33792
v_add_f32_dpp v49, v49, v49 row_ror:4 row_mask:0xf bank_mask:0xf
v_mfma_f32_16x16x32_bf16 v[164:167], a[104:107], a[4:7], v[164:167]
buffer_load_dwordx4 a[52:55], v2, s[40:43], s35 offen offset:1024 sc1
v_mfma_f32_16x16x32_bf16 v[188:191], a[104:107], a[8:11], v[188:191]
ds_read_b128 a[144:147], v5 offset:34816
v_add_f32_dpp v50, v50, v50 row_ror:4 row_mask:0xf bank_mask:0xf
v_mfma_f32_16x16x32_bf16 v[212:215], a[104:107], a[12:15], v[212:215]
v_add_f32_dpp v51, v51, v51 row_ror:4 row_mask:0xf bank_mask:0xf
v_add_f32_dpp v52, v52, v52 row_ror:4 row_mask:0xf bank_mask:0xf
v_mfma_f32_16x16x32_bf16 v[216:219], a[108:111], a[12:15], v[216:219]
v_add_f32_dpp v53, v53, v53 row_ror:4 row_mask:0xf bank_mask:0xf
v_mfma_f32_16x16x32_bf16 v[192:195], a[108:111], a[8:11], v[192:195]
buffer_load_dwordx4 a[56:59], v2, s[40:43], s35 offen offset:2048 sc1
v_mfma_f32_16x16x32_bf16 v[168:171], a[108:111], a[4:7], v[168:171]
ds_read_b128 a[148:151], v5 offset:35840
v_add_f32_dpp v54, v54, v54 row_ror:4 row_mask:0xf bank_mask:0xf
v_mfma_f32_16x16x32_bf16 v[144:147], a[108:111], a[0:3], v[144:147]
v_add_f32_dpp v55, v55, v55 row_ror:4 row_mask:0xf bank_mask:0xf
v_add_f32_dpp v48, v48, v48 row_ror:2 row_mask:0xf bank_mask:0xf
v_mfma_f32_16x16x32_bf16 v[148:151], a[112:115], a[0:3], v[148:151]
v_add_f32_dpp v49, v49, v49 row_ror:2 row_mask:0xf bank_mask:0xf
v_mfma_f32_16x16x32_bf16 v[172:175], a[112:115], a[4:7], v[172:175]
buffer_load_dwordx4 v[120:123], v1, s[4:7], s88 offen offset:3072 sc1
s_add_u32 s44, s28, 0
v_mfma_f32_16x16x32_bf16 v[196:199], a[112:115], a[8:11], v[196:199]
s_mul_i32 s45, s44, 3072
s_add_u32 m0, s45, 0
s_lshr_b32 s44, s44, 1
v_mfma_f32_16x16x32_bf16 v[220:223], a[112:115], a[12:15], v[220:223]
s_add_u32 s44, s44, 24
s_add_u32 s44, s44, s33
s_and_b32 s44, s44, 31
v_mfma_f32_16x16x32_bf16 v[224:227], a[116:119], a[12:15], v[224:227]
s_mul_i32 s44, s44, 6144
s_add_u32 s44, s44, s50
s_add_u32 s44, s44, 0x600000
v_mfma_f32_16x16x32_bf16 v[200:203], a[116:119], a[8:11], v[200:203]
buffer_load_dwordx4 a[60:63], v2, s[40:43], s35 offen offset:3072 sc1
s_add_u32 s35, s35, 4096
v_mfma_f32_16x16x32_bf16 v[176:179], a[116:119], a[4:7], v[176:179]
s_and_b32 s35, s35, 0x1ffff
v_add_f32_dpp v50, v50, v50 row_ror:2 row_mask:0xf bank_mask:0xf
v_mfma_f32_16x16x32_bf16 v[152:155], a[116:119], a[0:3], v[152:155]
v_add_f32_dpp v51, v51, v51 row_ror:2 row_mask:0xf bank_mask:0xf
s_waitcnt vmcnt(11) lgkmcnt(0)
v_mfma_f32_16x16x32_bf16 v[132:135], a[128:131], a[16:19], v[132:135]
ds_read_b128 a[96:99], v5 offset:36864
v_add_f32_dpp v52, v52, v52 row_ror:2 row_mask:0xf bank_mask:0xf
v_mfma_f32_16x16x32_bf16 v[156:159], a[128:131], a[20:23], v[156:159]
buffer_load_dwordx4 a[0:3], v2, s[40:43], s35 offen offset:0 sc1
v_mfma_f32_16x16x32_bf16 v[180:183], a[128:131], a[24:27], v[180:183]
ds_read_b128 a[100:103], v5 offset:37888
v_add_f32_dpp v53, v53, v53 row_ror:2 row_mask:0xf bank_mask:0xf
v_mfma_f32_16x16x32_bf16 v[204:207], a[128:131], a[28:31], v[204:207]
v_add_f32_dpp v54, v54, v54 row_ror:2 row_mask:0xf bank_mask:0xf
v_add_f32_dpp v55, v55, v55 row_ror:2 row_mask:0xf bank_mask:0xf
v_mfma_f32_16x16x32_bf16 v[208:211], a[132:135], a[28:31], v[208:211]
v_add_f32_dpp v48, v48, v48 row_ror:1 row_mask:0xf bank_mask:0xf
v_add_f32_dpp v49, v49, v49 row_ror:1 row_mask:0xf bank_mask:0xf
v_mfma_f32_16x16x32_bf16 v[184:187], a[132:135], a[24:27], v[184:187]
buffer_load_dwordx4 v1, s[4:7], s44 offen offset:0 sc1 lds
v_mfma_f32_16x16x32_bf16 v[160:163], a[132:135], a[20:23], v[160:163]
ds_read_b128 a[104:107], v5 offset:38912
v_add_f32_dpp v50, v50, v50 row_ror:1 row_mask:0xf bank_mask:0xf
v_mfma_f32_16x16x32_bf16 v[136:139], a[132:135], a[16:19], v[136:139]
v_add_f32_dpp v51, v51, v51 row_ror:1 row_mask:0xf bank_mask:0xf
v_add_f32_dpp v52, v52, v52 row_ror:1 row_mask:0xf bank_mask:0xf
v_mfma_f32_16x16x32_bf16 v[140:143], a[136:139], a[16:19], v[140:143]
ds_read_b128 a[108:111], v5 offset:39936
v_add_f32_dpp v53, v53, v53 row_ror:1 row_mask:0xf bank_mask:0xf
v_mfma_f32_16x16x32_bf16 v[164:167], a[136:139], a[20:23], v[164:167]
buffer_load_dwordx4 a[4:7], v2, s[40:43], s35 offen offset:1024 sc1
v_mfma_f32_16x16x32_bf16 v[188:191], a[136:139], a[24:27], v[188:191]
ds_read_b128 a[112:115], v5 offset:40960
v_add_f32_dpp v54, v54, v54 row_ror:1 row_mask:0xf bank_mask:0xf
v_mfma_f32_16x16x32_bf16 v[212:215], a[136:139], a[28:31], v[212:215]
v_add_f32_dpp v55, v55, v55 row_ror:1 row_mask:0xf bank_mask:0xf
v_add_u32 v233, 147456, v233
v_mfma_f32_16x16x32_bf16 v[216:219], a[140:143], a[28:31], v[216:219]
s_lshl_b32 s36, s28, 6
s_lshl_b32 s37, s39, 6
v_mfma_f32_16x16x32_bf16 v[192:195], a[140:143], a[24:27], v[192:195]
buffer_load_dwordx4 a[8:11], v2, s[40:43], s35 offen offset:2048 sc1
v_mfma_f32_16x16x32_bf16 v[168:171], a[140:143], a[20:23], v[168:171]
ds_read_b128 a[116:119], v5 offset:41984
v_add_u32 v232, s36, v233
v_mfma_f32_16x16x32_bf16 v[144:147], a[140:143], a[16:19], v[144:147]
v_add_u32 v235, s37, v233
v_mfma_f32_16x16x32_bf16 v[148:151], a[144:147], a[16:19], v[148:151]
v_mfma_f32_16x16x32_bf16 v[172:175], a[144:147], a[20:23], v[172:175]
buffer_load_dwordx4 v1, s[4:7], s44 offen offset:1024 sc1 lds
v_mfma_f32_16x16x32_bf16 v[196:199], a[144:147], a[24:27], v[196:199]
v_mfma_f32_16x16x32_bf16 v[220:223], a[144:147], a[28:31], v[220:223]
v_mfma_f32_16x16x32_bf16 v[224:227], a[148:151], a[28:31], v[224:227]
v_mfma_f32_16x16x32_bf16 v[200:203], a[148:151], a[24:27], v[200:203]
buffer_load_dwordx4 a[12:15], v2, s[40:43], s35 offen offset:3072 sc1
s_add_u32 s35, s35, 4096
v_mfma_f32_16x16x32_bf16 v[176:179], a[148:151], a[20:23], v[176:179]
s_and_b32 s35, s35, 0x1ffff
v_mfma_f32_16x16x32_bf16 v[152:155], a[148:151], a[16:19], v[152:155]
s_waitcnt vmcnt(12) lgkmcnt(0)
v_mfma_f32_16x16x32_bf16 v[132:135], a[96:99], a[32:35], v[132:135]
ds_read_b128 a[128:131], v5 offset:43008
v_mfma_f32_16x16x32_bf16 v[156:159], a[96:99], a[36:39], v[156:159]
buffer_load_dwordx4 a[16:19], v2, s[40:43], s35 offen offset:0 sc1
v_mfma_f32_16x16x32_bf16 v[180:183], a[96:99], a[40:43], v[180:183]
ds_read_b128 a[132:135], v5 offset:44032
v_mfma_f32_16x16x32_bf16 v[204:207], a[96:99], a[44:47], v[204:207]
ds_write_b128 v232, v[48:51]
v_mfma_f32_16x16x32_bf16 v[208:211], a[100:103], a[44:47], v[208:211]
ds_write_b128 v235, v[52:55]
v_mfma_f32_16x16x32_bf16 v[184:187], a[100:103], a[40:43], v[184:187]
buffer_load_dwordx4 a[20:23], v2, s[40:43], s35 offen offset:1024 sc1
v_mfma_f32_16x16x32_bf16 v[160:163], a[100:103], a[36:39], v[160:163]
ds_read_b128 a[136:139], v5 offset:45056
v_mfma_f32_16x16x32_bf16 v[136:139], a[100:103], a[32:35], v[136:139]
v_mfma_f32_16x16x32_bf16 v[140:143], a[104:107], a[32:35], v[140:143]
ds_read_b128 a[140:143], v5 offset:46080
v_mfma_f32_16x16x32_bf16 v[164:167], a[104:107], a[36:39], v[164:167]
v_mfma_f32_16x16x32_bf16 v[188:191], a[104:107], a[40:43], v[188:191]
buffer_load_dwordx4 v1, s[4:7], s44 offen offset:2048 sc1 lds
s_add_u32 s44, s28, 4
v_mfma_f32_16x16x32_bf16 v[212:215], a[104:107], a[44:47], v[212:215]
s_mul_i32 s45, s44, 3072
s_add_u32 m0, s45, 0
s_lshr_b32 s44, s44, 1
v_mfma_f32_16x16x32_bf16 v[216:219], a[108:111], a[44:47], v[216:219]
s_add_u32 s44, s44, 24
s_add_u32 s44, s44, s33
s_and_b32 s44, s44, 31
v_mfma_f32_16x16x32_bf16 v[192:195], a[108:111], a[40:43], v[192:195]
s_mul_i32 s44, s44, 6144
s_add_u32 s44, s44, s50
s_add_u32 s44, s44, 0x600000
v_mfma_f32_16x16x32_bf16 v[168:171], a[108:111], a[36:39], v[168:171]
ds_read_b128 a[144:147], v5 offset:47104
v_mfma_f32_16x16x32_bf16 v[144:147], a[108:111], a[32:35], v[144:147]
buffer_load_dwordx4 a[24:27], v2, s[40:43], s35 offen offset:2048 sc1
v_mfma_f32_16x16x32_bf16 v[148:151], a[112:115], a[32:35], v[148:151]
ds_read_b128 a[148:151], v5 offset:48128
v_mfma_f32_16x16x32_bf16 v[172:175], a[112:115], a[36:39], v[172:175]
v_mfma_f32_16x16x32_bf16 v[196:199], a[112:115], a[40:43], v[196:199]
v_mfma_f32_16x16x32_bf16 v[220:223], a[112:115], a[44:47], v[220:223]
v_mfma_f32_16x16x32_bf16 v[224:227], a[116:119], a[44:47], v[224:227]
buffer_load_dwordx4 a[28:31], v2, s[40:43], s35 offen offset:3072 sc1
s_add_u32 s35, s35, 4096
v_mfma_f32_16x16x32_bf16 v[200:203], a[116:119], a[40:43], v[200:203]
s_and_b32 s35, s35, 0x1ffff
v_mfma_f32_16x16x32_bf16 v[176:179], a[116:119], a[36:39], v[176:179]
v_mfma_f32_16x16x32_bf16 v[152:155], a[116:119], a[32:35], v[152:155]
s_waitcnt vmcnt(11) lgkmcnt(0)
s_barrier
v_mfma_f32_16x16x32_bf16 v[132:135], a[128:131], a[48:51], v[132:135]
v_add_u32 v5, 98304, v1
v_mfma_f32_16x16x32_bf16 v[156:159], a[128:131], a[52:55], v[156:159]
buffer_load_dwordx4 a[32:35], v2, s[40:43], s35 offen offset:0 sc1
v_mfma_f32_16x16x32_bf16 v[180:183], a[128:131], a[56:59], v[180:183]
ds_read_b128 a[96:99], v5 offset:0
v_mfma_f32_16x16x32_bf16 v[204:207], a[128:131], a[60:63], v[204:207]
ds_read_b128 a[100:103], v5 offset:1024
v_mfma_f32_16x16x32_bf16 v[208:211], a[132:135], a[60:63], v[208:211]
ds_read_b128 v[48:51], v233 offset:0
v_mfma_f32_16x16x32_bf16 v[184:187], a[132:135], a[56:59], v[184:187]
buffer_load_dwordx4 v1, s[4:7], s44 offen offset:0 sc1 lds
v_mfma_f32_16x16x32_bf16 v[160:163], a[132:135], a[52:55], v[160:163]
ds_read_b128 a[104:107], v5 offset:2048
v_mfma_f32_16x16x32_bf16 v[136:139], a[132:135], a[48:51], v[136:139]
v_mfma_f32_16x16x32_bf16 v[140:143], a[136:139], a[48:51], v[140:143]
ds_read_b128 a[108:111], v5 offset:3072
v_mfma_f32_16x16x32_bf16 v[164:167], a[136:139], a[52:55], v[164:167]
buffer_load_dwordx4 a[36:39], v2, s[40:43], s35 offen offset:1024 sc1
v_mfma_f32_16x16x32_bf16 v[188:191], a[136:139], a[56:59], v[188:191]
ds_read_b128 a[112:115], v5 offset:4096
v_mfma_f32_16x16x32_bf16 v[212:215], a[136:139], a[60:63], v[212:215]
ds_read_b128 v[52:55], v233 offset:64
v_mfma_f32_16x16x32_bf16 v[216:219], a[140:143], a[60:63], v[216:219]
v_mfma_f32_16x16x32_bf16 v[192:195], a[140:143], a[56:59], v[192:195]
buffer_load_dwordx4 a[40:43], v2, s[40:43], s35 offen offset:2048 sc1
v_mfma_f32_16x16x32_bf16 v[168:171], a[140:143], a[52:55], v[168:171]
ds_read_b128 a[116:119], v5 offset:5120
v_mfma_f32_16x16x32_bf16 v[144:147], a[140:143], a[48:51], v[144:147]
v_mfma_f32_16x16x32_bf16 v[148:151], a[144:147], a[48:51], v[148:151]
v_mfma_f32_16x16x32_bf16 v[172:175], a[144:147], a[52:55], v[172:175]
buffer_load_dwordx4 v1, s[4:7], s44 offen offset:1024 sc1 lds
v_mfma_f32_16x16x32_bf16 v[196:199], a[144:147], a[56:59], v[196:199]
v_mfma_f32_16x16x32_bf16 v[220:223], a[144:147], a[60:63], v[220:223]
v_mfma_f32_16x16x32_bf16 v[224:227], a[148:151], a[60:63], v[224:227]
v_mfma_f32_16x16x32_bf16 v[200:203], a[148:151], a[56:59], v[200:203]
buffer_load_dwordx4 a[44:47], v2, s[40:43], s35 offen offset:3072 sc1
s_add_u32 s35, s35, 4096
v_mfma_f32_16x16x32_bf16 v[176:179], a[148:151], a[52:55], v[176:179]
s_and_b32 s35, s35, 0x1ffff
ds_read_b128 v[56:59], v233 offset:128
v_mfma_f32_16x16x32_bf16 v[152:155], a[148:151], a[48:51], v[152:155]
s_waitcnt vmcnt(11) lgkmcnt(1)
v_mfma_f32_16x16x32_bf16 v[132:135], a[96:99], a[0:3], v[132:135]
ds_read_b128 a[128:131], v5 offset:6144
v_mfma_f32_16x16x32_bf16 v[156:159], a[96:99], a[4:7], v[156:159]
buffer_load_dwordx4 a[48:51], v2, s[40:43], s35 offen offset:0 sc1
v_mfma_f32_16x16x32_bf16 v[180:183], a[96:99], a[8:11], v[180:183]
ds_read_b128 a[132:135], v5 offset:7168
v_mfma_f32_16x16x32_bf16 v[204:207], a[96:99], a[12:15], v[204:207]
v_mfma_f32_16x16x32_bf16 v[208:211], a[100:103], a[12:15], v[208:211]
v_mfma_f32_16x16x32_bf16 v[184:187], a[100:103], a[8:11], v[184:187]
buffer_load_dwordx4 v1, s[4:7], s44 offen offset:2048 sc1 lds
s_add_u32 s44, s28, 8
v_mfma_f32_16x16x32_bf16 v[160:163], a[100:103], a[4:7], v[160:163]
s_mul_i32 s45, s44, 3072
s_add_u32 m0, s45, 0
s_lshr_b32 s44, s44, 1
v_mfma_f32_16x16x32_bf16 v[136:139], a[100:103], a[0:3], v[136:139]
s_add_u32 s44, s44, 24
s_add_u32 s44, s44, s33
s_and_b32 s44, s44, 31
v_mfma_f32_16x16x32_bf16 v[140:143], a[104:107], a[0:3], v[140:143]
s_mul_i32 s44, s44, 6144
s_add_u32 s44, s44, s50
s_add_u32 s44, s44, 0x600000
v_mfma_f32_16x16x32_bf16 v[164:167], a[104:107], a[4:7], v[164:167]
buffer_load_dwordx4 a[52:55], v2, s[40:43], s35 offen offset:1024 sc1
v_mfma_f32_16x16x32_bf16 v[188:191], a[104:107], a[8:11], v[188:191]
ds_read_b128 a[136:139], v5 offset:8192
v_mfma_f32_16x16x32_bf16 v[212:215], a[104:107], a[12:15], v[212:215]
ds_read_b128 a[140:143], v5 offset:9216
v_mfma_f32_16x16x32_bf16 v[216:219], a[108:111], a[12:15], v[216:219]
ds_read_b128 a[144:147], v5 offset:10240
v_mfma_f32_16x16x32_bf16 v[192:195], a[108:111], a[8:11], v[192:195]
buffer_load_dwordx4 a[56:59], v2, s[40:43], s35 offen offset:2048 sc1
v_mfma_f32_16x16x32_bf16 v[168:171], a[108:111], a[4:7], v[168:171]
ds_read_b128 a[148:151], v5 offset:11264
v_mfma_f32_16x16x32_bf16 v[144:147], a[108:111], a[0:3], v[144:147]
ds_read_b128 v[60:63], v233 offset:192
v_mfma_f32_16x16x32_bf16 v[148:151], a[112:115], a[0:3], v[148:151]
v_mfma_f32_16x16x32_bf16 v[172:175], a[112:115], a[4:7], v[172:175]
buffer_load_dwordx4 v1, s[4:7], s44 offen offset:0 sc1 lds
v_mfma_f32_16x16x32_bf16 v[196:199], a[112:115], a[8:11], v[196:199]
ds_read_b128 v[64:67], v233 offset:256
v_mfma_f32_16x16x32_bf16 v[220:223], a[112:115], a[12:15], v[220:223]
v_mfma_f32_16x16x32_bf16 v[224:227], a[116:119], a[12:15], v[224:227]
v_mfma_f32_16x16x32_bf16 v[200:203], a[116:119], a[8:11], v[200:203]
buffer_load_dwordx4 a[60:63], v2, s[40:43], s35 offen offset:3072 sc1
s_add_u32 s35, s35, 4096
v_mfma_f32_16x16x32_bf16 v[176:179], a[116:119], a[4:7], v[176:179]
s_and_b32 s35, s35, 0x1ffff
v_mfma_f32_16x16x32_bf16 v[152:155], a[116:119], a[0:3], v[152:155]
s_waitcnt vmcnt(12) lgkmcnt(2)
v_mfma_f32_16x16x32_bf16 v[132:135], a[128:131], a[16:19], v[132:135]
ds_read_b128 a[96:99], v5 offset:12288
v_mfma_f32_16x16x32_bf16 v[156:159], a[128:131], a[20:23], v[156:159]
buffer_load_dwordx4 a[0:3], v2, s[40:43], s35 offen offset:0 sc1
v_mfma_f32_16x16x32_bf16 v[180:183], a[128:131], a[24:27], v[180:183]
ds_read_b128 a[100:103], v5 offset:13312
v_mfma_f32_16x16x32_bf16 v[204:207], a[128:131], a[28:31], v[204:207]
v_mfma_f32_16x16x32_bf16 v[208:211], a[132:135], a[28:31], v[208:211]
v_mfma_f32_16x16x32_bf16 v[184:187], a[132:135], a[24:27], v[184:187]
buffer_load_dwordx4 a[4:7], v2, s[40:43], s35 offen offset:1024 sc1
v_mfma_f32_16x16x32_bf16 v[160:163], a[132:135], a[20:23], v[160:163]
ds_read_b128 a[104:107], v5 offset:14336
v_mfma_f32_16x16x32_bf16 v[136:139], a[132:135], a[16:19], v[136:139]
ds_read_b128 v[68:71], v233 offset:320
v_mfma_f32_16x16x32_bf16 v[140:143], a[136:139], a[16:19], v[140:143]
ds_read_b128 a[108:111], v5 offset:15360
v_mfma_f32_16x16x32_bf16 v[164:167], a[136:139], a[20:23], v[164:167]
v_mfma_f32_16x16x32_bf16 v[188:191], a[136:139], a[24:27], v[188:191]
buffer_load_dwordx4 v1, s[4:7], s44 offen offset:1024 sc1 lds
v_mfma_f32_16x16x32_bf16 v[212:215], a[136:139], a[28:31], v[212:215]
ds_read_b128 a[112:115], v5 offset:16384
v_mfma_f32_16x16x32_bf16 v[216:219], a[140:143], a[28:31], v[216:219]
v_mfma_f32_16x16x32_bf16 v[192:195], a[140:143], a[24:27], v[192:195]
ds_read_b128 a[116:119], v5 offset:17408
v_mfma_f32_16x16x32_bf16 v[168:171], a[140:143], a[20:23], v[168:171]
v_mfma_f32_16x16x32_bf16 v[144:147], a[140:143], a[16:19], v[144:147]
buffer_load_dwordx4 a[8:11], v2, s[40:43], s35 offen offset:2048 sc1
v_mfma_f32_16x16x32_bf16 v[148:151], a[144:147], a[16:19], v[148:151]
v_mfma_f32_16x16x32_bf16 v[172:175], a[144:147], a[20:23], v[172:175]
v_mfma_f32_16x16x32_bf16 v[196:199], a[144:147], a[24:27], v[196:199]
v_mfma_f32_16x16x32_bf16 v[220:223], a[144:147], a[28:31], v[220:223]
v_mfma_f32_16x16x32_bf16 v[224:227], a[148:151], a[28:31], v[224:227]
buffer_load_dwordx4 a[12:15], v2, s[40:43], s35 offen offset:3072 sc1
s_add_u32 s35, s35, 4096
v_mfma_f32_16x16x32_bf16 v[200:203], a[148:151], a[24:27], v[200:203]
s_and_b32 s35, s35, 0x1ffff
v_mfma_f32_16x16x32_bf16 v[176:179], a[148:151], a[20:23], v[176:179]
v_mfma_f32_16x16x32_bf16 v[152:155], a[148:151], a[16:19], v[152:155]
s_waitcnt vmcnt(11) lgkmcnt(0)
v_mfma_f32_16x16x32_bf16 v[132:135], a[96:99], a[32:35], v[132:135]
ds_read_b128 a[128:131], v5 offset:18432
v_mfma_f32_16x16x32_bf16 v[156:159], a[96:99], a[36:39], v[156:159]
buffer_load_dwordx4 a[16:19], v2, s[40:43], s35 offen offset:0 sc1
v_mfma_f32_16x16x32_bf16 v[180:183], a[96:99], a[40:43], v[180:183]
ds_read_b128 a[132:135], v5 offset:19456
v_mfma_f32_16x16x32_bf16 v[204:207], a[96:99], a[44:47], v[204:207]
v_mfma_f32_16x16x32_bf16 v[208:211], a[100:103], a[44:47], v[208:211]
v_mfma_f32_16x16x32_bf16 v[184:187], a[100:103], a[40:43], v[184:187]
buffer_load_dwordx4 v1, s[4:7], s44 offen offset:2048 sc1 lds
s_add_u32 s44, s28, 12
v_mfma_f32_16x16x32_bf16 v[160:163], a[100:103], a[36:39], v[160:163]
s_mul_i32 s45, s44, 3072
s_add_u32 m0, s45, 0
s_lshr_b32 s44, s44, 1
v_mfma_f32_16x16x32_bf16 v[136:139], a[100:103], a[32:35], v[136:139]
s_add_u32 s44, s44, 24
s_add_u32 s44, s44, s33
s_and_b32 s44, s44, 31
v_mfma_f32_16x16x32_bf16 v[140:143], a[104:107], a[32:35], v[140:143]
s_mul_i32 s44, s44, 6144
s_add_u32 s44, s44, s50
s_add_u32 s44, s44, 0x600000
v_mfma_f32_16x16x32_bf16 v[164:167], a[104:107], a[36:39], v[164:167]
buffer_load_dwordx4 a[20:23], v2, s[40:43], s35 offen offset:1024 sc1
v_mfma_f32_16x16x32_bf16 v[188:191], a[104:107], a[40:43], v[188:191]
ds_read_b128 a[136:139], v5 offset:20480
v_mfma_f32_16x16x32_bf16 v[212:215], a[104:107], a[44:47], v[212:215]
ds_read_b128 a[140:143], v5 offset:21504
v_mfma_f32_16x16x32_bf16 v[216:219], a[108:111], a[44:47], v[216:219]
ds_read_b128 a[144:147], v5 offset:22528
v_mfma_f32_16x16x32_bf16 v[192:195], a[108:111], a[40:43], v[192:195]
buffer_load_dwordx4 a[24:27], v2, s[40:43], s35 offen offset:2048 sc1
v_mfma_f32_16x16x32_bf16 v[168:171], a[108:111], a[36:39], v[168:171]
ds_read_b128 a[148:151], v5 offset:23552
v_mfma_f32_16x16x32_bf16 v[144:147], a[108:111], a[32:35], v[144:147]
v_mfma_f32_16x16x32_bf16 v[148:151], a[112:115], a[32:35], v[148:151]
v_mfma_f32_16x16x32_bf16 v[172:175], a[112:115], a[36:39], v[172:175]
buffer_load_dwordx4 v1, s[4:7], s44 offen offset:0 sc1 lds
v_mfma_f32_16x16x32_bf16 v[196:199], a[112:115], a[40:43], v[196:199]
v_mfma_f32_16x16x32_bf16 v[220:223], a[112:115], a[44:47], v[220:223]
v_mfma_f32_16x16x32_bf16 v[224:227], a[116:119], a[44:47], v[224:227]
v_mfma_f32_16x16x32_bf16 v[200:203], a[116:119], a[40:43], v[200:203]
buffer_load_dwordx4 a[28:31], v2, s[40:43], s35 offen offset:3072 sc1
s_add_u32 s35, s35, 4096
v_mfma_f32_16x16x32_bf16 v[176:179], a[116:119], a[36:39], v[176:179]
s_and_b32 s35, s35, 0x1ffff
v_mfma_f32_16x16x32_bf16 v[152:155], a[116:119], a[32:35], v[152:155]
s_waitcnt vmcnt(11) lgkmcnt(0)
v_mfma_f32_16x16x32_bf16 v[132:135], a[128:131], a[48:51], v[132:135]
ds_read_b128 a[96:99], v5 offset:24576
v_accvgpr_write_b32 a188, v48
v_mfma_f32_16x16x32_bf16 v[156:159], a[128:131], a[52:55], v[156:159]
buffer_load_dwordx4 a[32:35], v2, s[40:43], s35 offen offset:0 sc1
v_mfma_f32_16x16x32_bf16 v[180:183], a[128:131], a[56:59], v[180:183]
ds_read_b128 a[100:103], v5 offset:25600
v_mfma_f32_16x16x32_bf16 v[204:207], a[128:131], a[60:63], v[204:207]
v_accvgpr_write_b32 a189, v49
v_mfma_f32_16x16x32_bf16 v[208:211], a[132:135], a[60:63], v[208:211]
v_mfma_f32_16x16x32_bf16 v[184:187], a[132:135], a[56:59], v[184:187]
buffer_load_dwordx4 v1, s[4:7], s44 offen offset:1024 sc1 lds
v_mfma_f32_16x16x32_bf16 v[160:163], a[132:135], a[52:55], v[160:163]
ds_read_b128 a[104:107], v5 offset:26624
v_accvgpr_write_b32 a190, v50
v_mfma_f32_16x16x32_bf16 v[136:139], a[132:135], a[48:51], v[136:139]
v_mfma_f32_16x16x32_bf16 v[140:143], a[136:139], a[48:51], v[140:143]
ds_read_b128 a[108:111], v5 offset:27648
v_mfma_f32_16x16x32_bf16 v[164:167], a[136:139], a[52:55], v[164:167]
buffer_load_dwordx4 a[36:39], v2, s[40:43], s35 offen offset:1024 sc1
v_mfma_f32_16x16x32_bf16 v[188:191], a[136:139], a[56:59], v[188:191]
ds_read_b128 a[112:115], v5 offset:28672
v_accvgpr_write_b32 a191, v51
v_mfma_f32_16x16x32_bf16 v[212:215], a[136:139], a[60:63], v[212:215]
v_mfma_f32_16x16x32_bf16 v[216:219], a[140:143], a[60:63], v[216:219]
v_accvgpr_write_b32 a192, v52
v_mfma_f32_16x16x32_bf16 v[192:195], a[140:143], a[56:59], v[192:195]
buffer_load_dwordx4 a[40:43], v2, s[40:43], s35 offen offset:2048 sc1
v_mfma_f32_16x16x32_bf16 v[168:171], a[140:143], a[52:55], v[168:171]
ds_read_b128 a[116:119], v5 offset:29696
v_mfma_f32_16x16x32_bf16 v[144:147], a[140:143], a[48:51], v[144:147]
v_accvgpr_write_b32 a193, v53
v_mfma_f32_16x16x32_bf16 v[148:151], a[144:147], a[48:51], v[148:151]
v_mfma_f32_16x16x32_bf16 v[172:175], a[144:147], a[52:55], v[172:175]
buffer_load_dwordx4 v1, s[4:7], s44 offen offset:2048 sc1 lds
s_add_u32 s44, s28, 4
v_mfma_f32_16x16x32_bf16 v[196:199], a[144:147], a[56:59], v[196:199]
s_lshl_b32 s45, s44, 12
s_add_u32 m0, s45, 32768
s_and_b32 s45, s44, 7
v_mfma_f32_16x16x32_bf16 v[220:223], a[144:147], a[60:63], v[220:223]
s_cmp_eq_u32 s45, s3
s_cselect_b32 s45, 8, 0
s_add_u32 s44, s44, s45
v_mfma_f32_16x16x32_bf16 v[224:227], a[148:151], a[60:63], v[224:227]
s_and_b32 s44, s44, 31
s_lshl_b32 s44, s44, 12
s_add_u32 s44, s44, s51
v_mfma_f32_16x16x32_bf16 v[200:203], a[148:151], a[56:59], v[200:203]
buffer_load_dwordx4 a[44:47], v2, s[40:43], s35 offen offset:3072 sc1
s_add_u32 s35, s35, 4096
v_mfma_f32_16x16x32_bf16 v[176:179], a[148:151], a[52:55], v[176:179]
s_and_b32 s35, s35, 0x1ffff
s_add_u32 s44, s44, 0x200000
v_mfma_f32_16x16x32_bf16 v[152:155], a[148:151], a[48:51], v[152:155]
v_accvgpr_write_b32 a194, v54
s_waitcnt vmcnt(12) lgkmcnt(0)
v_mfma_f32_16x16x32_bf16 v[132:135], a[96:99], a[0:3], v[132:135]
ds_read_b128 a[128:131], v5 offset:30720
v_accvgpr_write_b32 a195, v55
v_mfma_f32_16x16x32_bf16 v[156:159], a[96:99], a[4:7], v[156:159]
buffer_load_dwordx4 a[48:51], v2, s[40:43], s35 offen offset:0 sc1
v_mfma_f32_16x16x32_bf16 v[180:183], a[96:99], a[8:11], v[180:183]
ds_read_b128 a[132:135], v5 offset:31744
v_accvgpr_write_b32 a196, v56
v_mfma_f32_16x16x32_bf16 v[204:207], a[96:99], a[12:15], v[204:207]
v_accvgpr_write_b32 a197, v57
v_mfma_f32_16x16x32_bf16 v[208:211], a[100:103], a[12:15], v[208:211]
v_mfma_f32_16x16x32_bf16 v[184:187], a[100:103], a[8:11], v[184:187]
buffer_load_dwordx4 a[52:55], v2, s[40:43], s35 offen offset:1024 sc1
v_mfma_f32_16x16x32_bf16 v[160:163], a[100:103], a[4:7], v[160:163]
ds_read_b128 a[136:139], v5 offset:32768
v_accvgpr_write_b32 a198, v58
v_mfma_f32_16x16x32_bf16 v[136:139], a[100:103], a[0:3], v[136:139]
v_mfma_f32_16x16x32_bf16 v[140:143], a[104:107], a[0:3], v[140:143]
ds_read_b128 a[140:143], v5 offset:33792
v_mfma_f32_16x16x32_bf16 v[164:167], a[104:107], a[4:7], v[164:167]
v_accvgpr_write_b32 a199, v59
v_mfma_f32_16x16x32_bf16 v[188:191], a[104:107], a[8:11], v[188:191]
buffer_load_dwordx4 v1, s[4:7], s44 offen offset:0 sc1 lds
s_lshr_b32 s89, s2, 3
v_mfma_f32_16x16x32_bf16 v[212:215], a[104:107], a[12:15], v[212:215]
s_lshl_b32 s89, s89, 10
s_add_u32 s89, s89, (L_cpf1 - interleave_layers__sliding_local_dilated__linear_kernel_hedgehog__prompt_kernel + 2048)
v_mfma_f32_16x16x32_bf16 v[216:219], a[108:111], a[12:15], v[216:219]
ds_read_b128 a[144:147], v5 offset:34816
v_accvgpr_write_b32 a200, v60
v_mfma_f32_16x16x32_bf16 v[192:195], a[108:111], a[8:11], v[192:195]
ds_read_b128 a[148:151], v5 offset:35840
v_mfma_f32_16x16x32_bf16 v[168:171], a[108:111], a[4:7], v[168:171]
v_mfma_f32_16x16x32_bf16 v[144:147], a[108:111], a[0:3], v[144:147]
buffer_load_dwordx4 a[56:59], v2, s[40:43], s35 offen offset:2048 sc1
v_mfma_f32_16x16x32_bf16 v[148:151], a[112:115], a[0:3], v[148:151]
v_accvgpr_write_b32 a201, v61
v_mfma_f32_16x16x32_bf16 v[172:175], a[112:115], a[4:7], v[172:175]
v_mfma_f32_16x16x32_bf16 v[196:199], a[112:115], a[8:11], v[196:199]
v_accvgpr_write_b32 a202, v62
v_mfma_f32_16x16x32_bf16 v[220:223], a[112:115], a[12:15], v[220:223]
v_mfma_f32_16x16x32_bf16 v[224:227], a[116:119], a[12:15], v[224:227]
buffer_load_dwordx4 a[60:63], v2, s[40:43], s35 offen offset:3072 sc1
s_add_u32 s35, s35, 4096
v_mfma_f32_16x16x32_bf16 v[200:203], a[116:119], a[8:11], v[200:203]
s_and_b32 s35, s35, 0x1ffff
v_accvgpr_write_b32 a203, v63
v_mfma_f32_16x16x32_bf16 v[176:179], a[116:119], a[4:7], v[176:179]
v_mfma_f32_16x16x32_bf16 v[152:155], a[116:119], a[0:3], v[152:155]
s_waitcnt vmcnt(11) lgkmcnt(0)
v_mfma_f32_16x16x32_bf16 v[132:135], a[128:131], a[16:19], v[132:135]
ds_read_b128 a[96:99], v5 offset:36864
v_accvgpr_write_b32 a204, v64
v_mfma_f32_16x16x32_bf16 v[156:159], a[128:131], a[20:23], v[156:159]
buffer_load_dwordx4 a[0:3], v2, s[40:43], s35 offen offset:0 sc1
v_mfma_f32_16x16x32_bf16 v[180:183], a[128:131], a[24:27], v[180:183]
ds_read_b128 a[100:103], v5 offset:37888
v_mfma_f32_16x16x32_bf16 v[204:207], a[128:131], a[28:31], v[204:207]
v_accvgpr_write_b32 a205, v65
v_mfma_f32_16x16x32_bf16 v[208:211], a[132:135], a[28:31], v[208:211]
buffer_load_dwordx4 a[76:79], v1, s[24:27], s89 offen
v_mfma_f32_16x16x32_bf16 v[184:187], a[132:135], a[24:27], v[184:187]
ds_read_b128 a[104:107], v5 offset:38912
v_mfma_f32_16x16x32_bf16 v[160:163], a[132:135], a[20:23], v[160:163]
v_accvgpr_write_b32 a206, v66
v_mfma_f32_16x16x32_bf16 v[136:139], a[132:135], a[16:19], v[136:139]
buffer_load_dwordx4 a[4:7], v2, s[40:43], s35 offen offset:1024 sc1
v_mfma_f32_16x16x32_bf16 v[140:143], a[136:139], a[16:19], v[140:143]
ds_read_b128 a[108:111], v5 offset:39936
v_mfma_f32_16x16x32_bf16 v[164:167], a[136:139], a[20:23], v[164:167]
v_accvgpr_write_b32 a207, v67
v_mfma_f32_16x16x32_bf16 v[188:191], a[136:139], a[24:27], v[188:191]
ds_read_b128 a[112:115], v5 offset:40960
v_mfma_f32_16x16x32_bf16 v[212:215], a[136:139], a[28:31], v[212:215]
buffer_load_dwordx4 v1, s[4:7], s44 offen offset:1024 sc1 lds
v_mfma_f32_16x16x32_bf16 v[216:219], a[140:143], a[28:31], v[216:219]
v_accvgpr_write_b32 a208, v68
v_mfma_f32_16x16x32_bf16 v[192:195], a[140:143], a[24:27], v[192:195]
ds_read_b128 a[116:119], v5 offset:41984
v_mfma_f32_16x16x32_bf16 v[168:171], a[140:143], a[20:23], v[168:171]
buffer_load_dwordx4 a[8:11], v2, s[40:43], s35 offen offset:2048 sc1
v_mfma_f32_16x16x32_bf16 v[144:147], a[140:143], a[16:19], v[144:147]
v_accvgpr_write_b32 a209, v69
v_mfma_f32_16x16x32_bf16 v[148:151], a[144:147], a[16:19], v[148:151]
v_mfma_f32_16x16x32_bf16 v[172:175], a[144:147], a[20:23], v[172:175]
v_mfma_f32_16x16x32_bf16 v[196:199], a[144:147], a[24:27], v[196:199]
buffer_load_dwordx4 v1, s[4:7], s44 offen offset:2048 sc1 lds
v_mfma_f32_16x16x32_bf16 v[220:223], a[144:147], a[28:31], v[220:223]
v_accvgpr_write_b32 a210, v70
v_mfma_f32_16x16x32_bf16 v[224:227], a[148:151], a[28:31], v[224:227]
v_mfma_f32_16x16x32_bf16 v[200:203], a[148:151], a[24:27], v[200:203]
buffer_load_dwordx4 a[12:15], v2, s[40:43], s35 offen offset:3072 sc1
s_add_u32 s35, s35, 4096
v_mfma_f32_16x16x32_bf16 v[176:179], a[148:151], a[20:23], v[176:179]
s_and_b32 s35, s35, 0x1ffff
v_accvgpr_write_b32 a211, v71
v_mfma_f32_16x16x32_bf16 v[152:155], a[148:151], a[16:19], v[152:155]
s_waitcnt vmcnt(12) lgkmcnt(0)
v_mfma_f32_16x16x32_bf16 v[132:135], a[96:99], a[32:35], v[132:135]
ds_read_b128 a[128:131], v5 offset:43008
v_add_f32 v92, v92, v96
v_mfma_f32_16x16x32_bf16 v[156:159], a[96:99], a[36:39], v[156:159]
buffer_load_dwordx4 a[16:19], v2, s[40:43], s35 offen offset:0 sc1
v_mfma_f32_16x16x32_bf16 v[180:183], a[96:99], a[40:43], v[180:183]
ds_read_b128 a[132:135], v5 offset:44032
v_add_f32 v100, v100, v104
v_mfma_f32_16x16x32_bf16 v[204:207], a[96:99], a[44:47], v[204:207]
v_add_f32 v108, v108, v112
v_add_f32 v116, v116, v120
v_mfma_f32_16x16x32_bf16 v[208:211], a[100:103], a[44:47], v[208:211]
v_add_f32 v93, v93, v97
v_add_f32 v101, v101, v105
v_mfma_f32_16x16x32_bf16 v[184:187], a[100:103], a[40:43], v[184:187]
buffer_load_dwordx4 v1, s[4:7], s44 offen offset:3072 sc1 lds
s_add_u32 s44, s28, 8
v_mfma_f32_16x16x32_bf16 v[160:163], a[100:103], a[36:39], v[160:163]
s_lshl_b32 s45, s44, 12
s_add_u32 m0, s45, 32768
s_and_b32 s45, s44, 7
v_mfma_f32_16x16x32_bf16 v[136:139], a[100:103], a[32:35], v[136:139]
s_cmp_eq_u32 s45, s3
s_cselect_b32 s45, 8, 0
s_add_u32 s44, s44, s45
v_mfma_f32_16x16x32_bf16 v[140:143], a[104:107], a[32:35], v[140:143]
s_and_b32 s44, s44, 31
s_lshl_b32 s44, s44, 12
s_add_u32 s44, s44, s51
v_mfma_f32_16x16x32_bf16 v[164:167], a[104:107], a[36:39], v[164:167]
buffer_load_dwordx4 a[20:23], v2, s[40:43], s35 offen offset:1024 sc1
s_add_u32 s44, s44, 0x200000
v_mfma_f32_16x16x32_bf16 v[188:191], a[104:107], a[40:43], v[188:191]
ds_read_b128 a[136:139], v5 offset:45056
v_add_f32 v109, v109, v113
v_mfma_f32_16x16x32_bf16 v[212:215], a[104:107], a[44:47], v[212:215]
ds_read_b128 a[140:143], v5 offset:46080
v_add_f32 v117, v117, v121
v_mfma_f32_16x16x32_bf16 v[216:219], a[108:111], a[44:47], v[216:219]
ds_read_b128 a[144:147], v5 offset:47104
v_add_f32 v94, v94, v98
v_mfma_f32_16x16x32_bf16 v[192:195], a[108:111], a[40:43], v[192:195]
buffer_load_dwordx4 a[24:27], v2, s[40:43], s35 offen offset:2048 sc1
v_mfma_f32_16x16x32_bf16 v[168:171], a[108:111], a[36:39], v[168:171]
ds_read_b128 a[148:151], v5 offset:48128
v_add_f32 v102, v102, v106
v_mfma_f32_16x16x32_bf16 v[144:147], a[108:111], a[32:35], v[144:147]
v_add_f32 v110, v110, v114
v_add_f32 v118, v118, v122
v_mfma_f32_16x16x32_bf16 v[148:151], a[112:115], a[32:35], v[148:151]
v_add_f32 v95, v95, v99
v_add_f32 v103, v103, v107
v_mfma_f32_16x16x32_bf16 v[172:175], a[112:115], a[36:39], v[172:175]
buffer_load_dwordx4 v1, s[4:7], s44 offen offset:0 sc1 lds
v_mfma_f32_16x16x32_bf16 v[196:199], a[112:115], a[40:43], v[196:199]
v_add_f32 v111, v111, v115
v_add_f32 v119, v119, v123
v_mfma_f32_16x16x32_bf16 v[220:223], a[112:115], a[44:47], v[220:223]
v_add_f32_dpp v92, v92, v92 row_ror:8 row_mask:0xf bank_mask:0xf
v_add_f32_dpp v100, v100, v100 row_ror:8 row_mask:0xf bank_mask:0xf
v_mfma_f32_16x16x32_bf16 v[224:227], a[116:119], a[44:47], v[224:227]
v_add_f32_dpp v108, v108, v108 row_ror:8 row_mask:0xf bank_mask:0xf
v_add_f32_dpp v116, v116, v116 row_ror:8 row_mask:0xf bank_mask:0xf
v_mfma_f32_16x16x32_bf16 v[200:203], a[116:119], a[40:43], v[200:203]
buffer_load_dwordx4 a[28:31], v2, s[40:43], s35 offen offset:3072 sc1
s_add_u32 s35, s35, 4096
v_mfma_f32_16x16x32_bf16 v[176:179], a[116:119], a[36:39], v[176:179]
s_and_b32 s35, s35, 0x1ffff
v_add_f32_dpp v93, v93, v93 row_ror:8 row_mask:0xf bank_mask:0xf
v_mfma_f32_16x16x32_bf16 v[152:155], a[116:119], a[32:35], v[152:155]
s_waitcnt vmcnt(13) lgkmcnt(0)
s_barrier
v_mfma_f32_16x16x32_bf16 v[132:135], a[128:131], a[48:51], v[132:135]
v_add_u32 v5, 0, v1
v_add_f32_dpp v101, v101, v101 row_ror:8 row_mask:0xf bank_mask:0xf
v_mfma_f32_16x16x32_bf16 v[156:159], a[128:131], a[52:55], v[156:159]
buffer_load_dwordx4 a[32:35], v2, s[40:43], s35 offen offset:0 sc1
v_mfma_f32_16x16x32_bf16 v[180:183], a[128:131], a[56:59], v[180:183]
ds_read_b128 a[96:99], v5 offset:0
v_add_f32_dpp v109, v109, v109 row_ror:8 row_mask:0xf bank_mask:0xf
v_mfma_f32_16x16x32_bf16 v[204:207], a[128:131], a[60:63], v[204:207]
ds_read_b128 a[100:103], v5 offset:1024
v_add_f32_dpp v117, v117, v117 row_ror:8 row_mask:0xf bank_mask:0xf
v_mfma_f32_16x16x32_bf16 v[208:211], a[132:135], a[60:63], v[208:211]
v_add_f32_dpp v92, v94, v94 row_ror:8 row_mask:0xf bank_mask:0xc
v_add_f32_dpp v100, v102, v102 row_ror:8 row_mask:0xf bank_mask:0xc
v_mfma_f32_16x16x32_bf16 v[184:187], a[132:135], a[56:59], v[184:187]
buffer_load_dwordx4 a[36:39], v2, s[40:43], s35 offen offset:1024 sc1
v_mfma_f32_16x16x32_bf16 v[160:163], a[132:135], a[52:55], v[160:163]
ds_read_b128 a[104:107], v5 offset:2048
v_add_f32_dpp v108, v110, v110 row_ror:8 row_mask:0xf bank_mask:0xc
v_mfma_f32_16x16x32_bf16 v[136:139], a[132:135], a[48:51], v[136:139]
v_add_f32_dpp v116, v118, v118 row_ror:8 row_mask:0xf bank_mask:0xc
v_add_f32_dpp v93, v95, v95 row_ror:8 row_mask:0xf bank_mask:0xc
v_mfma_f32_16x16x32_bf16 v[140:143], a[136:139], a[48:51], v[140:143]
ds_read_b128 a[108:111], v5 offset:3072
v_add_f32_dpp v101, v103, v103 row_ror:8 row_mask:0xf bank_mask:0xc
v_mfma_f32_16x16x32_bf16 v[164:167], a[136:139], a[52:55], v[164:167]
v_add_f32_dpp v109, v111, v111 row_ror:8 row_mask:0xf bank_mask:0xc
v_add_f32_dpp v117, v119, v119 row_ror:8 row_mask:0xf bank_mask:0xc
v_mfma_f32_16x16x32_bf16 v[188:191], a[136:139], a[56:59], v[188:191]
buffer_load_dwordx4 v1, s[4:7], s44 offen offset:1024 sc1 lds
v_mfma_f32_16x16x32_bf16 v[212:215], a[136:139], a[60:63], v[212:215]
ds_read_b128 a[112:115], v5 offset:4096
v_mfma_f32_16x16x32_bf16 v[216:219], a[140:143], a[60:63], v[216:219]
v_permlane32_swap_b32 v92, v93
v_mfma_f32_16x16x32_bf16 v[192:195], a[140:143], a[56:59], v[192:195]
ds_read_b128 a[116:119], v5 offset:5120
v_mfma_f32_16x16x32_bf16 v[168:171], a[140:143], a[52:55], v[168:171]
v_permlane32_swap_b32 v100, v101
v_mfma_f32_16x16x32_bf16 v[144:147], a[140:143], a[48:51], v[144:147]
buffer_load_dwordx4 a[40:43], v2, s[40:43], s35 offen offset:2048 sc1
v_mfma_f32_16x16x32_bf16 v[148:151], a[144:147], a[48:51], v[148:151]
v_permlane32_swap_b32 v108, v109
v_mfma_f32_16x16x32_bf16 v[172:175], a[144:147], a[52:55], v[172:175]
v_permlane32_swap_b32 v116, v117
v_mfma_f32_16x16x32_bf16 v[196:199], a[144:147], a[56:59], v[196:199]
v_add_f32 v92, v92, v93
v_add_f32 v100, v100, v101
v_mfma_f32_16x16x32_bf16 v[220:223], a[144:147], a[60:63], v[220:223]
v_add_f32 v108, v108, v109
v_add_f32 v116, v116, v117
v_mfma_f32_16x16x32_bf16 v[224:227], a[148:151], a[60:63], v[224:227]
buffer_load_dwordx4 a[44:47], v2, s[40:43], s35 offen offset:3072 sc1
s_add_u32 s35, s35, 4096
v_mfma_f32_16x16x32_bf16 v[200:203], a[148:151], a[56:59], v[200:203]
s_and_b32 s35, s35, 0x1ffff
v_mov_b32 v94, v92
v_mfma_f32_16x16x32_bf16 v[176:179], a[148:151], a[52:55], v[176:179]
v_mov_b32 v102, v100
v_mov_b32 v110, v108
v_mfma_f32_16x16x32_bf16 v[152:155], a[148:151], a[48:51], v[152:155]
v_mov_b32 v118, v116
s_waitcnt vmcnt(11) lgkmcnt(0)
v_mfma_f32_16x16x32_bf16 v[132:135], a[96:99], a[0:3], v[132:135]
ds_read_b128 a[128:131], v5 offset:6144
v_mfma_f32_16x16x32_bf16 v[156:159], a[96:99], a[4:7], v[156:159]
buffer_load_dwordx4 a[48:51], v2, s[40:43], s35 offen offset:0 sc1
v_mfma_f32_16x16x32_bf16 v[180:183], a[96:99], a[8:11], v[180:183]
ds_read_b128 a[132:135], v5 offset:7168
v_mfma_f32_16x16x32_bf16 v[204:207], a[96:99], a[12:15], v[204:207]
v_permlane16_swap_b32 v92, v94
v_mfma_f32_16x16x32_bf16 v[208:211], a[100:103], a[12:15], v[208:211]
v_permlane16_swap_b32 v100, v102
v_mfma_f32_16x16x32_bf16 v[184:187], a[100:103], a[8:11], v[184:187]
buffer_load_dwordx4 v1, s[4:7], s44 offen offset:2048 sc1 lds
v_mfma_f32_16x16x32_bf16 v[160:163], a[100:103], a[4:7], v[160:163]
ds_read_b128 a[136:139], v5 offset:8192
v_mfma_f32_16x16x32_bf16 v[136:139], a[100:103], a[0:3], v[136:139]
v_permlane16_swap_b32 v108, v110
v_mfma_f32_16x16x32_bf16 v[140:143], a[104:107], a[0:3], v[140:143]
ds_read_b128 a[140:143], v5 offset:9216
v_mfma_f32_16x16x32_bf16 v[164:167], a[104:107], a[4:7], v[164:167]
buffer_load_dwordx4 a[52:55], v2, s[40:43], s35 offen offset:1024 sc1
v_mfma_f32_16x16x32_bf16 v[188:191], a[104:107], a[8:11], v[188:191]
ds_read_b128 a[144:147], v5 offset:10240
v_mfma_f32_16x16x32_bf16 v[212:215], a[104:107], a[12:15], v[212:215]
v_permlane16_swap_b32 v116, v118
v_mfma_f32_16x16x32_bf16 v[216:219], a[108:111], a[12:15], v[216:219]
v_add_f32 v92, v92, v94
v_add_f32 v100, v100, v102
v_mfma_f32_16x16x32_bf16 v[192:195], a[108:111], a[8:11], v[192:195]
buffer_load_dwordx4 a[56:59], v2, s[40:43], s35 offen offset:2048 sc1
v_mfma_f32_16x16x32_bf16 v[168:171], a[108:111], a[4:7], v[168:171]
ds_read_b128 a[148:151], v5 offset:11264
v_add_f32 v108, v108, v110
v_mfma_f32_16x16x32_bf16 v[144:147], a[108:111], a[0:3], v[144:147]
v_add_f32 v116, v116, v118
v_mov_b32 v94, v92
v_mfma_f32_16x16x32_bf16 v[148:151], a[112:115], a[0:3], v[148:151]
v_mov_b32 v102, v100
v_mov_b32 v110, v108
v_mfma_f32_16x16x32_bf16 v[172:175], a[112:115], a[4:7], v[172:175]
buffer_load_dwordx4 v1, s[4:7], s44 offen offset:3072 sc1 lds
s_add_u32 s44, s28, 12
v_mfma_f32_16x16x32_bf16 v[196:199], a[112:115], a[8:11], v[196:199]
s_lshl_b32 s45, s44, 12
s_add_u32 m0, s45, 32768
s_and_b32 s45, s44, 7
v_mfma_f32_16x16x32_bf16 v[220:223], a[112:115], a[12:15], v[220:223]
s_cmp_eq_u32 s45, s3
s_cselect_b32 s45, 8, 0
s_add_u32 s44, s44, s45
v_mfma_f32_16x16x32_bf16 v[224:227], a[116:119], a[12:15], v[224:227]
s_and_b32 s44, s44, 31
s_lshl_b32 s44, s44, 12
s_add_u32 s44, s44, s51
v_mfma_f32_16x16x32_bf16 v[200:203], a[116:119], a[8:11], v[200:203]
buffer_load_dwordx4 a[60:63], v2, s[40:43], s35 offen offset:3072 sc1
s_add_u32 s35, s35, 4096
v_mfma_f32_16x16x32_bf16 v[176:179], a[116:119], a[4:7], v[176:179]
s_and_b32 s35, s35, 0x1ffff
s_add_u32 s44, s44, 0x200000
v_mfma_f32_16x16x32_bf16 v[152:155], a[116:119], a[0:3], v[152:155]
v_mov_b32 v118, v116
s_waitcnt vmcnt(11) lgkmcnt(0)
v_mfma_f32_16x16x32_bf16 v[132:135], a[128:131], a[16:19], v[132:135]
ds_read_b128 a[96:99], v5 offset:12288
v_mfma_f32_16x16x32_bf16 v[156:159], a[128:131], a[20:23], v[156:159]
buffer_load_dwordx4 a[0:3], v2, s[40:43], s35 offen offset:0 sc1
v_mfma_f32_16x16x32_bf16 v[180:183], a[128:131], a[24:27], v[180:183]
ds_read_b128 a[100:103], v5 offset:13312
v_mfma_f32_16x16x32_bf16 v[204:207], a[128:131], a[28:31], v[204:207]
v_permlane32_swap_b32 v92, v94
v_mfma_f32_16x16x32_bf16 v[208:211], a[132:135], a[28:31], v[208:211]
v_permlane32_swap_b32 v100, v102
v_mfma_f32_16x16x32_bf16 v[184:187], a[132:135], a[24:27], v[184:187]
buffer_load_dwordx4 v1, s[4:7], s44 offen offset:0 sc1 lds
v_mfma_f32_16x16x32_bf16 v[160:163], a[132:135], a[20:23], v[160:163]
ds_read_b128 a[104:107], v5 offset:14336
v_mfma_f32_16x16x32_bf16 v[136:139], a[132:135], a[16:19], v[136:139]
v_permlane32_swap_b32 v108, v110
v_mfma_f32_16x16x32_bf16 v[140:143], a[136:139], a[16:19], v[140:143]
ds_read_b128 a[108:111], v5 offset:15360
v_mfma_f32_16x16x32_bf16 v[164:167], a[136:139], a[20:23], v[164:167]
buffer_load_dwordx4 a[4:7], v2, s[40:43], s35 offen offset:1024 sc1
v_mfma_f32_16x16x32_bf16 v[188:191], a[136:139], a[24:27], v[188:191]
ds_read_b128 a[112:115], v5 offset:16384
v_mfma_f32_16x16x32_bf16 v[212:215], a[136:139], a[28:31], v[212:215]
v_permlane32_swap_b32 v116, v118
v_mfma_f32_16x16x32_bf16 v[216:219], a[140:143], a[28:31], v[216:219]
v_mul_f32 v82, 0xba800000, v92
v_mul_f32 v84, 0xba800000, v100
v_mfma_f32_16x16x32_bf16 v[192:195], a[140:143], a[24:27], v[192:195]
buffer_load_dwordx4 a[8:11], v2, s[40:43], s35 offen offset:2048 sc1
v_mfma_f32_16x16x32_bf16 v[168:171], a[140:143], a[20:23], v[168:171]
ds_read_b128 a[116:119], v5 offset:17408
v_mul_f32 v86, 0xba800000, v108
v_mfma_f32_16x16x32_bf16 v[144:147], a[140:143], a[16:19], v[144:147]
v_mul_f32 v88, 0xba800000, v116
v_mul_f32 v94, 0x3a800000, v94
v_mfma_f32_16x16x32_bf16 v[148:151], a[144:147], a[16:19], v[148:151]
v_mul_f32 v102, 0x3a800000, v102
v_mul_f32 v110, 0x3a800000, v110
v_mfma_f32_16x16x32_bf16 v[172:175], a[144:147], a[20:23], v[172:175]
buffer_load_dwordx4 v1, s[4:7], s44 offen offset:1024 sc1 lds
v_mfma_f32_16x16x32_bf16 v[196:199], a[144:147], a[24:27], v[196:199]
v_mul_f32 v118, 0x3a800000, v118
v_fma_f32 v94, -v82, v82, v94
v_mfma_f32_16x16x32_bf16 v[220:223], a[144:147], a[28:31], v[220:223]
v_fma_f32 v102, -v84, v84, v102
v_fma_f32 v110, -v86, v86, v110
v_mfma_f32_16x16x32_bf16 v[224:227], a[148:151], a[28:31], v[224:227]
v_fma_f32 v118, -v88, v88, v118
v_max_f32 v94, 0, v94
v_mfma_f32_16x16x32_bf16 v[200:203], a[148:151], a[24:27], v[200:203]
buffer_load_dwordx4 a[12:15], v2, s[40:43], s35 offen offset:3072 sc1
s_add_u32 s35, s35, 4096
v_mfma_f32_16x16x32_bf16 v[176:179], a[148:151], a[20:23], v[176:179]
s_and_b32 s35, s35, 0x1ffff
v_max_f32 v102, 0, v102
v_mfma_f32_16x16x32_bf16 v[152:155], a[148:151], a[16:19], v[152:155]
v_max_f32 v110, 0, v110
s_waitcnt vmcnt(12) lgkmcnt(0)
v_mfma_f32_16x16x32_bf16 v[132:135], a[96:99], a[32:35], v[132:135]
ds_read_b128 a[128:131], v5 offset:18432
v_max_f32 v118, 0, v118
v_mfma_f32_16x16x32_bf16 v[156:159], a[96:99], a[36:39], v[156:159]
buffer_load_dwordx4 a[16:19], v2, s[40:43], s35 offen offset:0 sc1
v_mfma_f32_16x16x32_bf16 v[180:183], a[96:99], a[40:43], v[180:183]
ds_read_b128 a[132:135], v5 offset:19456
v_add_f32 v94, 0x3727c5ac, v94
v_mfma_f32_16x16x32_bf16 v[204:207], a[96:99], a[44:47], v[204:207]
v_add_f32 v102, 0x3727c5ac, v102
v_add_f32 v110, 0x3727c5ac, v110
v_mfma_f32_16x16x32_bf16 v[208:211], a[100:103], a[44:47], v[208:211]
v_add_f32 v118, 0x3727c5ac, v118
v_mfma_f32_16x16x32_bf16 v[184:187], a[100:103], a[40:43], v[184:187]
buffer_load_dwordx4 a[20:23], v2, s[40:43], s35 offen offset:1024 sc1
v_mfma_f32_16x16x32_bf16 v[160:163], a[100:103], a[36:39], v[160:163]
ds_read_b128 a[136:139], v5 offset:20480
v_mfma_f32_16x16x32_bf16 v[136:139], a[100:103], a[32:35], v[136:139]
v_rsq_f32 v83, v94
v_rsq_f32 v85, v102
v_rsq_f32 v87, v110
v_rsq_f32 v89, v118
v_mfma_f32_16x16x32_bf16 v[140:143], a[104:107], a[32:35], v[140:143]
ds_read_b128 a[140:143], v5 offset:21504
v_mfma_f32_16x16x32_bf16 v[164:167], a[104:107], a[36:39], v[164:167]
v_fmac_f32 v132, v48, v82
v_mfma_f32_16x16x32_bf16 v[188:191], a[104:107], a[40:43], v[188:191]
buffer_load_dwordx4 v1, s[4:7], s44 offen offset:2048 sc1 lds
v_mfma_f32_16x16x32_bf16 v[212:215], a[104:107], a[44:47], v[212:215]
ds_read_b128 a[144:147], v5 offset:22528
v_fmac_f32 v156, v48, v84
v_mfma_f32_16x16x32_bf16 v[216:219], a[108:111], a[44:47], v[216:219]
v_fmac_f32 v180, v48, v86
v_fmac_f32 v204, v48, v88
v_mfma_f32_16x16x32_bf16 v[192:195], a[108:111], a[40:43], v[192:195]
ds_read_b128 a[148:151], v5 offset:23552
v_fmac_f32 v208, v52, v88
v_mfma_f32_16x16x32_bf16 v[168:171], a[108:111], a[36:39], v[168:171]
v_fmac_f32 v184, v52, v86
v_mfma_f32_16x16x32_bf16 v[144:147], a[108:111], a[32:35], v[144:147]
buffer_load_dwordx4 a[24:27], v2, s[40:43], s35 offen offset:2048 sc1
v_mfma_f32_16x16x32_bf16 v[148:151], a[112:115], a[32:35], v[148:151]
v_fmac_f32 v160, v52, v84
v_fmac_f32 v136, v52, v82
v_mfma_f32_16x16x32_bf16 v[172:175], a[112:115], a[36:39], v[172:175]
v_fmac_f32 v140, v56, v82
v_mfma_f32_16x16x32_bf16 v[196:199], a[112:115], a[40:43], v[196:199]
v_fmac_f32 v164, v56, v84
v_mfma_f32_16x16x32_bf16 v[220:223], a[112:115], a[44:47], v[220:223]
v_fmac_f32 v188, v56, v86
v_mfma_f32_16x16x32_bf16 v[224:227], a[116:119], a[44:47], v[224:227]
buffer_load_dwordx4 a[28:31], v2, s[40:43], s35 offen offset:3072 sc1
s_add_u32 s35, s35, 4096
v_mfma_f32_16x16x32_bf16 v[200:203], a[116:119], a[40:43], v[200:203]
s_and_b32 s35, s35, 0x1ffff
v_fmac_f32 v212, v56, v88
v_mfma_f32_16x16x32_bf16 v[176:179], a[116:119], a[36:39], v[176:179]
v_fmac_f32 v216, v60, v88
v_fmac_f32 v192, v60, v86
v_mfma_f32_16x16x32_bf16 v[152:155], a[116:119], a[32:35], v[152:155]
v_fmac_f32 v168, v60, v84
s_waitcnt vmcnt(11) lgkmcnt(0)
v_mfma_f32_16x16x32_bf16 v[132:135], a[128:131], a[48:51], v[132:135]
ds_read_b128 a[96:99], v5 offset:24576
v_fmac_f32 v144, v60, v82
v_mfma_f32_16x16x32_bf16 v[156:159], a[128:131], a[52:55], v[156:159]
buffer_load_dwordx4 a[32:35], v2, s[40:43], s35 offen offset:0 sc1
v_mfma_f32_16x16x32_bf16 v[180:183], a[128:131], a[56:59], v[180:183]
ds_read_b128 a[100:103], v5 offset:25600
v_fmac_f32 v148, v64, v82
v_mfma_f32_16x16x32_bf16 v[204:207], a[128:131], a[60:63], v[204:207]
v_fmac_f32 v172, v64, v84
v_fmac_f32 v196, v64, v86
v_mfma_f32_16x16x32_bf16 v[208:211], a[132:135], a[60:63], v[208:211]
v_fmac_f32 v220, v64, v88
v_mfma_f32_16x16x32_bf16 v[184:187], a[132:135], a[56:59], v[184:187]
buffer_load_dwordx4 v1, s[4:7], s44 offen offset:3072 sc1 lds
s_add_u32 s44, s28, 28
v_mfma_f32_16x16x32_bf16 v[160:163], a[132:135], a[52:55], v[160:163]
s_lshl_b32 s45, s44, 12
s_add_u32 m0, s45, 32768
s_and_b32 s45, s44, 7
v_mfma_f32_16x16x32_bf16 v[136:139], a[132:135], a[48:51], v[136:139]
s_cmp_eq_u32 s45, s3
s_cselect_b32 s45, 8, 0
s_add_u32 s44, s44, s45
v_mfma_f32_16x16x32_bf16 v[140:143], a[136:139], a[48:51], v[140:143]
s_and_b32 s44, s44, 31
s_lshl_b32 s44, s44, 12
s_add_u32 s44, s44, s51
v_mfma_f32_16x16x32_bf16 v[164:167], a[136:139], a[52:55], v[164:167]
buffer_load_dwordx4 a[36:39], v2, s[40:43], s35 offen offset:1024 sc1
s_add_u32 s44, s44, 0x200000
v_mfma_f32_16x16x32_bf16 v[188:191], a[136:139], a[56:59], v[188:191]
ds_read_b128 a[104:107], v5 offset:26624
v_fmac_f32 v224, v68, v88
v_mfma_f32_16x16x32_bf16 v[212:215], a[136:139], a[60:63], v[212:215]
ds_read_b128 a[108:111], v5 offset:27648
v_fmac_f32 v200, v68, v86
v_mfma_f32_16x16x32_bf16 v[216:219], a[140:143], a[60:63], v[216:219]
ds_read_b128 a[112:115], v5 offset:28672
v_fmac_f32 v176, v68, v84
v_mfma_f32_16x16x32_bf16 v[192:195], a[140:143], a[56:59], v[192:195]
buffer_load_dwordx4 a[40:43], v2, s[40:43], s35 offen offset:2048 sc1
v_mfma_f32_16x16x32_bf16 v[168:171], a[140:143], a[52:55], v[168:171]
ds_read_b128 a[116:119], v5 offset:29696
v_fmac_f32 v152, v68, v82
v_mfma_f32_16x16x32_bf16 v[144:147], a[140:143], a[48:51], v[144:147]
v_fmac_f32 v133, v49, v82
v_fmac_f32 v157, v49, v84
v_mfma_f32_16x16x32_bf16 v[148:151], a[144:147], a[48:51], v[148:151]
v_fmac_f32 v181, v49, v86
v_fmac_f32 v205, v49, v88
v_mfma_f32_16x16x32_bf16 v[172:175], a[144:147], a[52:55], v[172:175]
buffer_load_dwordx4 v1, s[4:7], s44 offen offset:0 sc1 lds
v_mfma_f32_16x16x32_bf16 v[196:199], a[144:147], a[56:59], v[196:199]
v_fmac_f32 v209, v53, v88
v_fmac_f32 v185, v53, v86
v_mfma_f32_16x16x32_bf16 v[220:223], a[144:147], a[60:63], v[220:223]
v_fmac_f32 v161, v53, v84
v_fmac_f32 v137, v53, v82
v_mfma_f32_16x16x32_bf16 v[224:227], a[148:151], a[60:63], v[224:227]
v_fmac_f32 v141, v57, v82
v_fmac_f32 v165, v57, v84
v_mfma_f32_16x16x32_bf16 v[200:203], a[148:151], a[56:59], v[200:203]
buffer_load_dwordx4 a[44:47], v2, s[40:43], s35 offen offset:3072 sc1
s_add_u32 s35, s35, 4096
v_mfma_f32_16x16x32_bf16 v[176:179], a[148:151], a[52:55], v[176:179]
s_and_b32 s35, s35, 0x1ffff
v_fmac_f32 v189, v57, v86
v_mfma_f32_16x16x32_bf16 v[152:155], a[148:151], a[48:51], v[152:155]
v_fmac_f32 v213, v57, v88
s_waitcnt vmcnt(11) lgkmcnt(0)
v_mfma_f32_16x16x32_bf16 v[132:135], a[96:99], a[0:3], v[132:135]
ds_read_b128 a[128:131], v5 offset:30720
v_fmac_f32 v217, v61, v88
v_mfma_f32_16x16x32_bf16 v[156:159], a[96:99], a[4:7], v[156:159]
buffer_load_dwordx4 a[48:51], v2, s[40:43], s35 offen offset:0 sc1
v_mfma_f32_16x16x32_bf16 v[180:183], a[96:99], a[8:11], v[180:183]
ds_read_b128 a[132:135], v5 offset:31744
v_fmac_f32 v193, v61, v86
v_mfma_f32_16x16x32_bf16 v[204:207], a[96:99], a[12:15], v[204:207]
v_fmac_f32 v169, v61, v84
v_fmac_f32 v145, v61, v82
v_mfma_f32_16x16x32_bf16 v[208:211], a[100:103], a[12:15], v[208:211]
v_fmac_f32 v149, v65, v82
v_fmac_f32 v173, v65, v84
v_mfma_f32_16x16x32_bf16 v[184:187], a[100:103], a[8:11], v[184:187]
buffer_load_dwordx4 v1, s[4:7], s44 offen offset:1024 sc1 lds
v_mfma_f32_16x16x32_bf16 v[160:163], a[100:103], a[4:7], v[160:163]
ds_read_b128 a[136:139], v5 offset:32768
v_fmac_f32 v197, v65, v86
v_mfma_f32_16x16x32_bf16 v[136:139], a[100:103], a[0:3], v[136:139]
v_fmac_f32 v221, v65, v88
v_fmac_f32 v225, v69, v88
v_mfma_f32_16x16x32_bf16 v[140:143], a[104:107], a[0:3], v[140:143]
ds_read_b128 a[140:143], v5 offset:33792
v_fmac_f32 v201, v69, v86
v_mfma_f32_16x16x32_bf16 v[164:167], a[104:107], a[4:7], v[164:167]
buffer_load_dwordx4 a[52:55], v2, s[40:43], s35 offen offset:1024 sc1
v_mfma_f32_16x16x32_bf16 v[188:191], a[104:107], a[8:11], v[188:191]
ds_read_b128 a[144:147], v5 offset:34816
v_fmac_f32 v177, v69, v84
v_mfma_f32_16x16x32_bf16 v[212:215], a[104:107], a[12:15], v[212:215]
v_fmac_f32 v153, v69, v82
v_fmac_f32 v134, v50, v82
v_mfma_f32_16x16x32_bf16 v[216:219], a[108:111], a[12:15], v[216:219]
v_fmac_f32 v158, v50, v84
v_fmac_f32 v182, v50, v86
v_mfma_f32_16x16x32_bf16 v[192:195], a[108:111], a[8:11], v[192:195]
buffer_load_dwordx4 a[56:59], v2, s[40:43], s35 offen offset:2048 sc1
v_mfma_f32_16x16x32_bf16 v[168:171], a[108:111], a[4:7], v[168:171]
ds_read_b128 a[148:151], v5 offset:35840
v_fmac_f32 v206, v50, v88
v_mfma_f32_16x16x32_bf16 v[144:147], a[108:111], a[0:3], v[144:147]
v_fmac_f32 v210, v54, v88
v_fmac_f32 v186, v54, v86
v_mfma_f32_16x16x32_bf16 v[148:151], a[112:115], a[0:3], v[148:151]
v_fmac_f32 v162, v54, v84
v_fmac_f32 v138, v54, v82
v_mfma_f32_16x16x32_bf16 v[172:175], a[112:115], a[4:7], v[172:175]
buffer_load_dwordx4 v1, s[4:7], s44 offen offset:2048 sc1 lds
v_mfma_f32_16x16x32_bf16 v[196:199], a[112:115], a[8:11], v[196:199]
v_fmac_f32 v142, v58, v82
v_fmac_f32 v166, v58, v84
v_mfma_f32_16x16x32_bf16 v[220:223], a[112:115], a[12:15], v[220:223]
v_fmac_f32 v190, v58, v86
v_mfma_f32_16x16x32_bf16 v[224:227], a[116:119], a[12:15], v[224:227]
v_fmac_f32 v214, v58, v88
v_mfma_f32_16x16x32_bf16 v[200:203], a[116:119], a[8:11], v[200:203]
buffer_load_dwordx4 a[60:63], v2, s[40:43], s35 offen offset:3072 sc1
s_add_u32 s35, s35, 4096
v_mfma_f32_16x16x32_bf16 v[176:179], a[116:119], a[4:7], v[176:179]
s_and_b32 s35, s35, 0x1ffff
v_fmac_f32 v218, v62, v88
v_mfma_f32_16x16x32_bf16 v[152:155], a[116:119], a[0:3], v[152:155]
v_fmac_f32 v194, v62, v86
s_waitcnt vmcnt(12) lgkmcnt(0)
v_mfma_f32_16x16x32_bf16 v[132:135], a[128:131], a[16:19], v[132:135]
ds_read_b128 a[96:99], v5 offset:36864
v_fmac_f32 v170, v62, v84
v_mfma_f32_16x16x32_bf16 v[156:159], a[128:131], a[20:23], v[156:159]
buffer_load_dwordx4 v1, s[4:7], s44 offen offset:3072 sc1 lds
s_add_u32 s44, s28, 16
v_mfma_f32_16x16x32_bf16 v[180:183], a[128:131], a[24:27], v[180:183]
s_lshl_b32 s45, s44, 12
s_add_u32 m0, s45, 32768
s_and_b32 s45, s44, 7
v_mfma_f32_16x16x32_bf16 v[204:207], a[128:131], a[28:31], v[204:207]
s_cmp_eq_u32 s45, s3
s_cselect_b32 s45, 8, 0
s_add_u32 s44, s44, s45
v_mfma_f32_16x16x32_bf16 v[208:211], a[132:135], a[28:31], v[208:211]
s_and_b32 s44, s44, 31
s_lshl_b32 s44, s44, 12
s_add_u32 s44, s44, s51
s_add_u32 s44, s44, 0x200000
v_mfma_f32_16x16x32_bf16 v[184:187], a[132:135], a[24:27], v[184:187]
buffer_load_dwordx4 v1, s[4:7], s44 offen offset:0 sc1 lds
v_mfma_f32_16x16x32_bf16 v[160:163], a[132:135], a[20:23], v[160:163]
ds_read_b128 a[100:103], v5 offset:37888
v_fmac_f32 v146, v62, v82
v_mfma_f32_16x16x32_bf16 v[136:139], a[132:135], a[16:19], v[136:139]
ds_read_b128 a[104:107], v5 offset:38912
v_fmac_f32 v150, v66, v82
v_mfma_f32_16x16x32_bf16 v[140:143], a[136:139], a[16:19], v[140:143]
ds_read_b128 a[108:111], v5 offset:39936
v_fmac_f32 v174, v66, v84
v_mfma_f32_16x16x32_bf16 v[164:167], a[136:139], a[20:23], v[164:167]
v_fmac_f32 v198, v66, v86
v_fmac_f32 v222, v66, v88
v_mfma_f32_16x16x32_bf16 v[188:191], a[136:139], a[24:27], v[188:191]
buffer_load_dwordx4 v1, s[4:7], s44 offen offset:1024 sc1 lds
v_mfma_f32_16x16x32_bf16 v[212:215], a[136:139], a[28:31], v[212:215]
ds_read_b128 a[112:115], v5 offset:40960
v_fmac_f32 v226, v70, v88
v_mfma_f32_16x16x32_bf16 v[216:219], a[140:143], a[28:31], v[216:219]
v_fmac_f32 v202, v70, v86
v_fmac_f32 v178, v70, v84
v_mfma_f32_16x16x32_bf16 v[192:195], a[140:143], a[24:27], v[192:195]
ds_read_b128 a[116:119], v5 offset:41984
v_fmac_f32 v154, v70, v82
v_mfma_f32_16x16x32_bf16 v[168:171], a[140:143], a[20:23], v[168:171]
v_fmac_f32 v135, v51, v82
v_fmac_f32 v159, v51, v84
v_mfma_f32_16x16x32_bf16 v[144:147], a[140:143], a[16:19], v[144:147]
buffer_load_dwordx4 v1, s[4:7], s44 offen offset:2048 sc1 lds
v_mfma_f32_16x16x32_bf16 v[148:151], a[144:147], a[16:19], v[148:151]
v_fmac_f32 v183, v51, v86
v_fmac_f32 v207, v51, v88
v_mfma_f32_16x16x32_bf16 v[172:175], a[144:147], a[20:23], v[172:175]
v_fmac_f32 v211, v55, v88
v_fmac_f32 v187, v55, v86
v_mfma_f32_16x16x32_bf16 v[196:199], a[144:147], a[24:27], v[196:199]
v_fmac_f32 v163, v55, v84
v_fmac_f32 v139, v55, v82
v_mfma_f32_16x16x32_bf16 v[220:223], a[144:147], a[28:31], v[220:223]
v_fmac_f32 v143, v59, v82
v_fmac_f32 v167, v59, v84
v_mfma_f32_16x16x32_bf16 v[224:227], a[148:151], a[28:31], v[224:227]
buffer_load_dwordx4 v1, s[4:7], s44 offen offset:3072 sc1 lds
s_add_u32 s44, s28, 20
v_mfma_f32_16x16x32_bf16 v[200:203], a[148:151], a[24:27], v[200:203]
s_lshl_b32 s45, s44, 12
s_add_u32 m0, s45, 32768
s_and_b32 s45, s44, 7
v_mfma_f32_16x16x32_bf16 v[176:179], a[148:151], a[20:23], v[176:179]
s_cmp_eq_u32 s45, s3
s_cselect_b32 s45, 8, 0
s_add_u32 s44, s44, s45
v_mfma_f32_16x16x32_bf16 v[152:155], a[148:151], a[16:19], v[152:155]
s_and_b32 s44, s44, 31
s_waitcnt vmcnt(11) lgkmcnt(0)
v_mfma_f32_16x16x32_bf16 v[132:135], a[96:99], a[32:35], v[132:135]
s_lshl_b32 s44, s44, 12
s_add_u32 s44, s44, s51
s_add_u32 s44, s44, 0x200000
v_mfma_f32_16x16x32_bf16 v[156:159], a[96:99], a[36:39], v[156:159]
buffer_load_dwordx4 v1, s[4:7], s44 offen offset:0 sc1 lds
v_mfma_f32_16x16x32_bf16 v[180:183], a[96:99], a[40:43], v[180:183]
ds_read_b128 a[128:131], v5 offset:43008
v_fmac_f32 v191, v59, v86
v_mfma_f32_16x16x32_bf16 v[204:207], a[96:99], a[44:47], v[204:207]
ds_read_b128 a[132:135], v5 offset:44032
v_fmac_f32 v215, v59, v88
v_mfma_f32_16x16x32_bf16 v[208:211], a[100:103], a[44:47], v[208:211]
v_fmac_f32 v219, v63, v88
v_fmac_f32 v195, v63, v86
v_mfma_f32_16x16x32_bf16 v[184:187], a[100:103], a[40:43], v[184:187]
buffer_load_dwordx4 v1, s[4:7], s44 offen offset:1024 sc1 lds
v_mfma_f32_16x16x32_bf16 v[160:163], a[100:103], a[36:39], v[160:163]
ds_read_b128 a[136:139], v5 offset:45056
v_fmac_f32 v171, v63, v84
v_mfma_f32_16x16x32_bf16 v[136:139], a[100:103], a[32:35], v[136:139]
v_fmac_f32 v147, v63, v82
v_fmac_f32 v151, v67, v82
v_mfma_f32_16x16x32_bf16 v[140:143], a[104:107], a[32:35], v[140:143]
ds_read_b128 a[140:143], v5 offset:46080
v_fmac_f32 v175, v67, v84
v_mfma_f32_16x16x32_bf16 v[164:167], a[104:107], a[36:39], v[164:167]
buffer_load_dwordx4 v1, s[4:7], s44 offen offset:2048 sc1 lds
v_mfma_f32_16x16x32_bf16 v[188:191], a[104:107], a[40:43], v[188:191]
ds_read_b128 a[144:147], v5 offset:47104
v_fmac_f32 v199, v67, v86
v_mfma_f32_16x16x32_bf16 v[212:215], a[104:107], a[44:47], v[212:215]
v_fmac_f32 v223, v67, v88
v_fmac_f32 v227, v71, v88
v_mfma_f32_16x16x32_bf16 v[216:219], a[108:111], a[44:47], v[216:219]
v_fmac_f32 v203, v71, v86
v_fmac_f32 v179, v71, v84
v_mfma_f32_16x16x32_bf16 v[192:195], a[108:111], a[40:43], v[192:195]
buffer_load_dwordx4 v1, s[4:7], s44 offen offset:3072 sc1 lds
s_add_u32 s44, s28, 24
v_mfma_f32_16x16x32_bf16 v[168:171], a[108:111], a[36:39], v[168:171]
s_lshl_b32 s45, s44, 12
s_add_u32 m0, s45, 32768
s_and_b32 s45, s44, 7
v_mfma_f32_16x16x32_bf16 v[144:147], a[108:111], a[32:35], v[144:147]
s_cmp_eq_u32 s45, s3
s_cselect_b32 s45, 8, 0
s_add_u32 s44, s44, s45
v_mfma_f32_16x16x32_bf16 v[148:151], a[112:115], a[32:35], v[148:151]
s_and_b32 s44, s44, 31
s_lshl_b32 s44, s44, 12
s_add_u32 s44, s44, s51
s_add_u32 s44, s44, 0x200000
v_mfma_f32_16x16x32_bf16 v[172:175], a[112:115], a[36:39], v[172:175]
buffer_load_dwordx4 v1, s[4:7], s44 offen offset:0 sc1 lds
v_mfma_f32_16x16x32_bf16 v[196:199], a[112:115], a[40:43], v[196:199]
ds_read_b128 a[148:151], v5 offset:48128
v_fmac_f32 v155, v71, v82
v_mfma_f32_16x16x32_bf16 v[220:223], a[112:115], a[44:47], v[220:223]
v_mfma_f32_16x16x32_bf16 v[224:227], a[116:119], a[44:47], v[224:227]
v_mfma_f32_16x16x32_bf16 v[200:203], a[116:119], a[40:43], v[200:203]
buffer_load_dwordx4 v1, s[4:7], s44 offen offset:1024 sc1 lds
v_mfma_f32_16x16x32_bf16 v[176:179], a[116:119], a[36:39], v[176:179]
v_mfma_f32_16x16x32_bf16 v[152:155], a[116:119], a[32:35], v[152:155]
s_waitcnt vmcnt(11) lgkmcnt(0)
s_barrier
v_mfma_f32_16x16x32_bf16 v[132:135], a[128:131], a[48:51], v[132:135]
v_mfma_f32_16x16x32_bf16 v[156:159], a[128:131], a[52:55], v[156:159]
buffer_load_dwordx4 v1, s[4:7], s44 offen offset:2048 sc1 lds
v_mfma_f32_16x16x32_bf16 v[180:183], a[128:131], a[56:59], v[180:183]
v_mfma_f32_16x16x32_bf16 v[204:207], a[128:131], a[60:63], v[204:207]
v_mfma_f32_16x16x32_bf16 v[208:211], a[132:135], a[60:63], v[208:211]
v_mfma_f32_16x16x32_bf16 v[184:187], a[132:135], a[56:59], v[184:187]
v_mfma_f32_16x16x32_bf16 v[160:163], a[132:135], a[52:55], v[160:163]
v_mfma_f32_16x16x32_bf16 v[136:139], a[132:135], a[48:51], v[136:139]
v_mfma_f32_16x16x32_bf16 v[140:143], a[136:139], a[48:51], v[140:143]
v_mfma_f32_16x16x32_bf16 v[164:167], a[136:139], a[52:55], v[164:167]
v_mfma_f32_16x16x32_bf16 v[188:191], a[136:139], a[56:59], v[188:191]
v_mfma_f32_16x16x32_bf16 v[212:215], a[136:139], a[60:63], v[212:215]
v_mfma_f32_16x16x32_bf16 v[216:219], a[140:143], a[60:63], v[216:219]
v_mfma_f32_16x16x32_bf16 v[192:195], a[140:143], a[56:59], v[192:195]
buffer_load_dwordx4 v1, s[4:7], s44 offen offset:3072 sc1 lds
v_mfma_f32_16x16x32_bf16 v[168:171], a[140:143], a[52:55], v[168:171]
v_mfma_f32_16x16x32_bf16 v[144:147], a[140:143], a[48:51], v[144:147]
v_mfma_f32_16x16x32_bf16 v[148:151], a[144:147], a[48:51], v[148:151]
v_mfma_f32_16x16x32_bf16 v[172:175], a[144:147], a[52:55], v[172:175]
v_mfma_f32_16x16x32_bf16 v[196:199], a[144:147], a[56:59], v[196:199]
v_mfma_f32_16x16x32_bf16 v[220:223], a[144:147], a[60:63], v[220:223]
v_mfma_f32_16x16x32_bf16 v[224:227], a[148:151], a[60:63], v[224:227]
v_mfma_f32_16x16x32_bf16 v[200:203], a[148:151], a[56:59], v[200:203]
v_mfma_f32_16x16x32_bf16 v[176:179], a[148:151], a[52:55], v[176:179]
v_mfma_f32_16x16x32_bf16 v[152:155], a[148:151], a[48:51], v[152:155]
.set L_cpf1, .
v_cvt_pk_bf16_f32 v140, v140, v141
v_cvt_pk_bf16_f32 v164, v164, v165
v_cvt_pk_bf16_f32 v141, v142, v143
v_cvt_pk_bf16_f32 v165, v166, v167
v_cvt_pk_bf16_f32 v142, v144, v145
v_cvt_pk_bf16_f32 v143, v146, v147
v_cvt_pk_bf16_f32 v166, v168, v169
v_cvt_pk_bf16_f32 v167, v170, v171
v_mfma_f32_16x16x32_bf16 v[92:95], a[232:235], v[140:143], 0
v_mul_f32 v240, 0x3fb8aa3b, v83
v_mul_f32 v246, 0x3fb8aa3b, v85
v_mfma_f32_16x16x32_bf16 v[108:111], a[232:235], v[164:167], 0
v_cvt_pk_bf16_f32 v188, v188, v189
v_cvt_pk_bf16_f32 v212, v212, v213
v_mfma_f32_16x16x32_bf16 v[96:99], a[236:239], v[140:143], 0
s_nop 1
v_max3_f32 v236, v92, v93, v94
v_max3_f32 v237, -v92, -v93, -v94
v_mfma_f32_16x16x32_bf16 v[112:115], a[236:239], v[164:167], 0
v_max3_f32 v242, v108, v109, v110
v_max3_f32 v243, -v108, -v109, -v110
v_cvt_pk_bf16_f32 v189, v190, v191
v_cvt_pk_bf16_f32 v213, v214, v215
v_max3_f32 v236, v236, v95, v96
v_max3_f32 v237, v237, -v95, -v96
v_max3_f32 v236, v236, v97, v98
v_max3_f32 v237, v237, -v97, -v98
v_max3_f32 v242, v242, v111, v112
v_max3_f32 v243, v243, -v111, -v112
v_max3_f32 v242, v242, v113, v114
v_max3_f32 v243, v243, -v113, -v114
v_max_f32 v236, v236, v99
v_max_f32_e64 v237, v237, -v99
v_max_f32 v242, v242, v115
v_max_f32_e64 v243, v243, -v115
v_permlane32_swap_b32 v236, v237
s_nop 0
v_permlane32_swap_b32 v242, v243
v_max_f32 v236, v236, v237
v_max_f32 v242, v242, v243
v_mov_b32 v238, v236
v_mov_b32 v244, v242
v_pk_mul_f32 v[148:149], v[148:149], v[82:83] op_sel:[0,1] op_sel_hi:[1,1]
v_permlane16_swap_b32 v236, v238
v_permlane16_swap_b32 v242, v244
v_max_f32 v236, v236, v238
v_max_f32 v242, v242, v244
v_mov_b32 v238, v236
v_mov_b32 v244, v242
v_pk_mul_f32 v[172:173], v[172:173], v[84:85] op_sel:[0,1] op_sel_hi:[1,1]
v_permlane32_swap_b32 v236, v238
v_permlane32_swap_b32 v242, v244
v_mul_f32_e64 v236, -v236, v240
v_mul_f32_e64 v237, -v238, v240
v_mul_f32_e64 v242, -v242, v246
v_mul_f32_e64 v243, -v244, v246
v_pk_fma_f32 v[100:101], v[92:93], v[240:241], v[236:237] op_sel:[0,0,0] op_sel_hi:[1,0,0]
v_pk_fma_f32 v[102:103], v[94:95], v[240:241], v[236:237] op_sel:[0,0,0] op_sel_hi:[1,0,0]
v_pk_fma_f32 v[104:105], v[96:97], v[240:241], v[236:237] op_sel:[0,0,0] op_sel_hi:[1,0,0]
v_pk_fma_f32 v[106:107], v[98:99], v[240:241], v[236:237] op_sel:[0,0,0] op_sel_hi:[1,0,0]
v_pk_fma_f32 v[116:117], v[108:109], v[246:247], v[242:243] op_sel:[0,0,0] op_sel_hi:[1,0,0]
v_pk_fma_f32 v[118:119], v[110:111], v[246:247], v[242:243] op_sel:[0,0,0] op_sel_hi:[1,0,0]
v_pk_fma_f32 v[120:121], v[112:113], v[246:247], v[242:243] op_sel:[0,0,0] op_sel_hi:[1,0,0]
v_pk_fma_f32 v[122:123], v[114:115], v[246:247], v[242:243] op_sel:[0,0,0] op_sel_hi:[1,0,0]
v_pk_fma_f32 v[92:93], v[92:93], v[240:241], v[236:237] op_sel:[0,0,1] op_sel_hi:[1,0,1] neg_lo:[1,0,0] neg_hi:[1,0,0]
v_pk_fma_f32 v[94:95], v[94:95], v[240:241], v[236:237] op_sel:[0,0,1] op_sel_hi:[1,0,1] neg_lo:[1,0,0] neg_hi:[1,0,0]
v_pk_fma_f32 v[96:97], v[96:97], v[240:241], v[236:237] op_sel:[0,0,1] op_sel_hi:[1,0,1] neg_lo:[1,0,0] neg_hi:[1,0,0]
v_pk_fma_f32 v[98:99], v[98:99], v[240:241], v[236:237] op_sel:[0,0,1] op_sel_hi:[1,0,1] neg_lo:[1,0,0] neg_hi:[1,0,0]
v_pk_fma_f32 v[108:109], v[108:109], v[246:247], v[242:243] op_sel:[0,0,1] op_sel_hi:[1,0,1] neg_lo:[1,0,0] neg_hi:[1,0,0]
v_pk_fma_f32 v[110:111], v[110:111], v[246:247], v[242:243] op_sel:[0,0,1] op_sel_hi:[1,0,1] neg_lo:[1,0,0] neg_hi:[1,0,0]
v_pk_fma_f32 v[112:113], v[112:113], v[246:247], v[242:243] op_sel:[0,0,1] op_sel_hi:[1,0,1] neg_lo:[1,0,0] neg_hi:[1,0,0]
v_pk_fma_f32 v[114:115], v[114:115], v[246:247], v[242:243] op_sel:[0,0,1] op_sel_hi:[1,0,1] neg_lo:[1,0,0] neg_hi:[1,0,0]
v_exp_f32 v92, v92
v_exp_f32 v93, v93
v_exp_f32 v94, v94
v_exp_f32 v95, v95
v_exp_f32 v96, v96
v_exp_f32 v97, v97
v_exp_f32 v98, v98
v_exp_f32 v99, v99
v_exp_f32 v108, v108
v_exp_f32 v109, v109
v_exp_f32 v110, v110
v_exp_f32 v111, v111
v_exp_f32 v112, v112
v_exp_f32 v113, v113
v_exp_f32 v114, v114
v_exp_f32 v115, v115
v_pk_mul_f32 v[150:151], v[150:151], v[82:83] op_sel:[0,1] op_sel_hi:[1,1]
v_pk_mul_f32 v[174:175], v[174:175], v[84:85] op_sel:[0,1] op_sel_hi:[1,1]
v_cvt_pk_bf16_f32 v144, v92, v93
v_cvt_pk_bf16_f32 v145, v94, v95
v_cvt_pk_bf16_f32 v146, v96, v97
v_cvt_pk_bf16_f32 v147, v98, v99
v_cvt_pk_bf16_f32 v168, v108, v109
v_cvt_pk_bf16_f32 v169, v110, v111
v_cvt_pk_bf16_f32 v170, v112, v113
v_cvt_pk_bf16_f32 v171, v114, v115
v_cvt_pk_bf16_f32 v148, v148, v149
v_cvt_pk_bf16_f32 v172, v172, v173
v_pk_mul_f32 v[152:153], v[152:153], v[82:83] op_sel:[0,1] op_sel_hi:[1,1]
v_pk_mul_f32 v[154:155], v[154:155], v[82:83] op_sel:[0,1] op_sel_hi:[1,1]
v_pk_mul_f32 v[176:177], v[176:177], v[84:85] op_sel:[0,1] op_sel_hi:[1,1]
v_pk_mul_f32 v[178:179], v[178:179], v[84:85] op_sel:[0,1] op_sel_hi:[1,1]
v_cvt_pk_bf16_f32 v149, v150, v151
v_cvt_pk_bf16_f32 v173, v174, v175
v_cvt_pk_bf16_f32 v150, v152, v153
v_cvt_pk_bf16_f32 v151, v154, v155
v_cvt_pk_bf16_f32 v174, v176, v177
v_cvt_pk_bf16_f32 v175, v178, v179
v_mfma_f32_16x16x32_bf16 v[152:155], v[16:19], v[144:147], 0
v_cvt_pk_bf16_f32 v190, v192, v193
v_cvt_pk_bf16_f32 v191, v194, v195
v_mfma_f32_16x16x32_bf16 v[176:179], v[16:19], v[168:171], 0
v_cvt_pk_bf16_f32 v214, v216, v217
v_cvt_pk_bf16_f32 v215, v218, v219
v_exp_f32 v100, v100
s_nop 1
v_rcp_f32 v152, v152
v_exp_f32 v101, v101
s_nop 0
v_rcp_f32 v176, v176
v_pk_mul_f32 v[92:93], v[92:93], v[152:153] op_sel:[0,0] op_sel_hi:[1,0]
v_pk_mul_f32 v[94:95], v[94:95], v[152:153] op_sel:[0,0] op_sel_hi:[1,0]
v_pk_mul_f32 v[108:109], v[108:109], v[176:177] op_sel:[0,0] op_sel_hi:[1,0]
v_pk_mul_f32 v[110:111], v[110:111], v[176:177] op_sel:[0,0] op_sel_hi:[1,0]
v_pk_mul_f32 v[96:97], v[96:97], v[152:153] op_sel:[0,0] op_sel_hi:[1,0]
v_pk_mul_f32 v[98:99], v[98:99], v[152:153] op_sel:[0,0] op_sel_hi:[1,0]
v_cvt_pk_bf16_f32 v144, v92, v93
v_cvt_pk_bf16_f32 v145, v94, v95
v_pk_mul_f32 v[112:113], v[112:113], v[176:177] op_sel:[0,0] op_sel_hi:[1,0]
v_cvt_pk_bf16_f32 v168, v108, v109
v_pk_mul_f32 v[114:115], v[114:115], v[176:177] op_sel:[0,0] op_sel_hi:[1,0]
v_cvt_pk_bf16_f32 v169, v110, v111
v_mfma_f32_16x16x32_bf16 v[92:95], a[232:235], v[188:191], 0
v_cvt_pk_bf16_f32 v146, v96, v97
v_cvt_pk_bf16_f32 v147, v98, v99
v_mfma_f32_16x16x32_bf16 v[108:111], a[232:235], v[212:215], 0
v_cvt_pk_bf16_f32 v170, v112, v113
v_cvt_pk_bf16_f32 v171, v114, v115
v_mfma_f32_16x16x32_bf16 v[96:99], a[236:239], v[188:191], 0
s_nop 1
v_max3_f32 v236, v92, v93, v94
v_max3_f32 v237, -v92, -v93, -v94
v_mfma_f32_16x16x32_bf16 v[112:115], a[236:239], v[212:215], 0
v_max3_f32 v242, v108, v109, v110
v_max3_f32 v243, -v108, -v109, -v110
v_exp_f32 v102, v102
v_max3_f32 v236, v236, v95, v96
v_max3_f32 v237, v237, -v95, -v96
v_max3_f32 v236, v236, v97, v98
v_max3_f32 v237, v237, -v97, -v98
s_nop 0
v_max3_f32 v242, v242, v111, v112
v_max3_f32 v243, v243, -v111, -v112
v_max3_f32 v242, v242, v113, v114
v_max3_f32 v243, v243, -v113, -v114
v_max_f32 v236, v236, v99
v_max_f32_e64 v237, v237, -v99
v_max_f32 v242, v242, v115
v_max_f32_e64 v243, v243, -v115
v_exp_f32 v103, v103
v_exp_f32 v104, v104
v_exp_f32 v105, v105
v_exp_f32 v106, v106
v_exp_f32 v107, v107
v_exp_f32 v116, v116
v_exp_f32 v117, v117
v_exp_f32 v118, v118
v_exp_f32 v119, v119
v_exp_f32 v120, v120
v_exp_f32 v121, v121
v_exp_f32 v122, v122
v_exp_f32 v123, v123
s_lshl_b32 s36, s28, 12
v_permlane32_swap_b32 v236, v237
v_permlane32_swap_b32 v242, v243
v_add_u32 v232, s36, v7
v_cvt_pk_bf16_f32 v140, v100, v101
v_cvt_pk_bf16_f32 v141, v102, v103
v_cvt_pk_bf16_f32 v142, v104, v105
v_cvt_pk_bf16_f32 v143, v106, v107
v_cvt_pk_bf16_f32 v164, v116, v117
v_cvt_pk_bf16_f32 v165, v118, v119
v_cvt_pk_bf16_f32 v166, v120, v121
v_cvt_pk_bf16_f32 v167, v122, v123
ds_write_b64 v232, v[148:149] offset:0
ds_write_b64 v232, v[150:151] offset:512
ds_write_b64 v232, v[172:173] offset:1024
v_max_f32 v236, v236, v237
v_max_f32 v242, v242, v243
v_mfma_f32_16x16x32_bf16 v[148:151], v[16:19], v[140:143], 0
ds_write_b64 v232, v[174:175] offset:1536
v_mfma_f32_16x16x32_bf16 v[172:175], v[16:19], v[164:167], 0
v_mov_b32 v238, v236
v_mov_b32 v244, v242
v_mul_f32 v240, 0x3fb8aa3b, v87
v_permlane16_swap_b32 v236, v238
v_permlane16_swap_b32 v242, v244
v_max_f32 v236, v236, v238
v_max_f32 v242, v242, v244
v_mov_b32 v238, v236
v_mov_b32 v244, v242
v_rcp_f32 v148, v148
v_rcp_f32 v172, v172
v_permlane32_swap_b32 v236, v238
v_permlane32_swap_b32 v242, v244
v_mul_f32 v246, 0x3fb8aa3b, v89
v_pk_mul_f32 v[100:101], v[100:101], v[148:149] op_sel:[0,0] op_sel_hi:[1,0]
v_pk_mul_f32 v[102:103], v[102:103], v[148:149] op_sel:[0,0] op_sel_hi:[1,0]
v_pk_mul_f32 v[104:105], v[104:105], v[148:149] op_sel:[0,0] op_sel_hi:[1,0]
v_pk_mul_f32 v[106:107], v[106:107], v[148:149] op_sel:[0,0] op_sel_hi:[1,0]
v_pk_mul_f32 v[116:117], v[116:117], v[172:173] op_sel:[0,0] op_sel_hi:[1,0]
v_pk_mul_f32 v[118:119], v[118:119], v[172:173] op_sel:[0,0] op_sel_hi:[1,0]
v_pk_mul_f32 v[120:121], v[120:121], v[172:173] op_sel:[0,0] op_sel_hi:[1,0]
v_pk_mul_f32 v[122:123], v[122:123], v[172:173] op_sel:[0,0] op_sel_hi:[1,0]
v_mul_f32_e64 v236, -v236, v240
v_mul_f32_e64 v237, -v238, v240
v_mul_f32_e64 v242, -v242, v246
v_mul_f32_e64 v243, -v244, v246
v_cvt_pk_bf16_f32 v140, v100, v101
v_cvt_pk_bf16_f32 v141, v102, v103
v_cvt_pk_bf16_f32 v142, v104, v105
v_cvt_pk_bf16_f32 v143, v106, v107
v_cvt_pk_bf16_f32 v164, v116, v117
v_cvt_pk_bf16_f32 v165, v118, v119
v_cvt_pk_bf16_f32 v166, v120, v121
v_cvt_pk_bf16_f32 v167, v122, v123
v_pk_fma_f32 v[100:101], v[92:93], v[240:241], v[236:237] op_sel:[0,0,0] op_sel_hi:[1,0,0]
v_pk_fma_f32 v[102:103], v[94:95], v[240:241], v[236:237] op_sel:[0,0,0] op_sel_hi:[1,0,0]
v_pk_fma_f32 v[104:105], v[96:97], v[240:241], v[236:237] op_sel:[0,0,0] op_sel_hi:[1,0,0]
v_pk_fma_f32 v[106:107], v[98:99], v[240:241], v[236:237] op_sel:[0,0,0] op_sel_hi:[1,0,0]
v_pk_fma_f32 v[116:117], v[108:109], v[246:247], v[242:243] op_sel:[0,0,0] op_sel_hi:[1,0,0]
v_pk_fma_f32 v[118:119], v[110:111], v[246:247], v[242:243] op_sel:[0,0,0] op_sel_hi:[1,0,0]
v_pk_fma_f32 v[120:121], v[112:113], v[246:247], v[242:243] op_sel:[0,0,0] op_sel_hi:[1,0,0]
v_pk_fma_f32 v[122:123], v[114:115], v[246:247], v[242:243] op_sel:[0,0,0] op_sel_hi:[1,0,0]
v_pk_fma_f32 v[92:93], v[92:93], v[240:241], v[236:237] op_sel:[0,0,1] op_sel_hi:[1,0,1] neg_lo:[1,0,0] neg_hi:[1,0,0]
v_pk_fma_f32 v[94:95], v[94:95], v[240:241], v[236:237] op_sel:[0,0,1] op_sel_hi:[1,0,1] neg_lo:[1,0,0] neg_hi:[1,0,0]
v_pk_fma_f32 v[96:97], v[96:97], v[240:241], v[236:237] op_sel:[0,0,1] op_sel_hi:[1,0,1] neg_lo:[1,0,0] neg_hi:[1,0,0]
v_pk_fma_f32 v[98:99], v[98:99], v[240:241], v[236:237] op_sel:[0,0,1] op_sel_hi:[1,0,1] neg_lo:[1,0,0] neg_hi:[1,0,0]
v_pk_fma_f32 v[108:109], v[108:109], v[246:247], v[242:243] op_sel:[0,0,1] op_sel_hi:[1,0,1] neg_lo:[1,0,0] neg_hi:[1,0,0]
v_pk_fma_f32 v[110:111], v[110:111], v[246:247], v[242:243] op_sel:[0,0,1] op_sel_hi:[1,0,1] neg_lo:[1,0,0] neg_hi:[1,0,0]
v_pk_fma_f32 v[112:113], v[112:113], v[246:247], v[242:243] op_sel:[0,0,1] op_sel_hi:[1,0,1] neg_lo:[1,0,0] neg_hi:[1,0,0]
v_pk_fma_f32 v[114:115], v[114:115], v[246:247], v[242:243] op_sel:[0,0,1] op_sel_hi:[1,0,1] neg_lo:[1,0,0] neg_hi:[1,0,0]
v_pk_mul_f32 v[196:197], v[196:197], v[86:87] op_sel:[0,1] op_sel_hi:[1,1]
v_pk_mul_f32 v[220:221], v[220:221], v[88:89] op_sel:[0,1] op_sel_hi:[1,1]
v_exp_f32 v100, v100
v_exp_f32 v92, v92
v_exp_f32 v101, v101
v_exp_f32 v93, v93
v_exp_f32 v102, v102
v_exp_f32 v94, v94
v_exp_f32 v103, v103
v_exp_f32 v95, v95
v_exp_f32 v104, v104
v_exp_f32 v96, v96
v_exp_f32 v105, v105
v_exp_f32 v97, v97
v_exp_f32 v106, v106
v_exp_f32 v98, v98
v_exp_f32 v107, v107
v_exp_f32 v99, v99
v_exp_f32 v116, v116
v_exp_f32 v108, v108
v_exp_f32 v117, v117
v_exp_f32 v109, v109
v_exp_f32 v118, v118
v_exp_f32 v110, v110
v_exp_f32 v119, v119
v_exp_f32 v111, v111
v_exp_f32 v120, v120
v_exp_f32 v112, v112
v_exp_f32 v121, v121
v_exp_f32 v113, v113
v_exp_f32 v122, v122
v_exp_f32 v114, v114
v_exp_f32 v123, v123
v_exp_f32 v115, v115
v_pk_mul_f32 v[198:199], v[198:199], v[86:87] op_sel:[0,1] op_sel_hi:[1,1]
v_pk_mul_f32 v[222:223], v[222:223], v[88:89] op_sel:[0,1] op_sel_hi:[1,1]
v_cvt_pk_bf16_f32 v196, v196, v197
v_cvt_pk_bf16_f32 v220, v220, v221
v_pk_mul_f32 v[200:201], v[200:201], v[86:87] op_sel:[0,1] op_sel_hi:[1,1]
v_pk_mul_f32 v[202:203], v[202:203], v[86:87] op_sel:[0,1] op_sel_hi:[1,1]
v_pk_mul_f32 v[224:225], v[224:225], v[88:89] op_sel:[0,1] op_sel_hi:[1,1]
v_pk_mul_f32 v[226:227], v[226:227], v[88:89] op_sel:[0,1] op_sel_hi:[1,1]
v_cvt_pk_bf16_f32 v197, v198, v199
v_cvt_pk_bf16_f32 v221, v222, v223
v_cvt_pk_bf16_f32 v198, v200, v201
v_cvt_pk_bf16_f32 v199, v202, v203
v_cvt_pk_bf16_f32 v222, v224, v225
v_cvt_pk_bf16_f32 v223, v226, v227
v_cvt_pk_bf16_f32 v188, v100, v101
v_cvt_pk_bf16_f32 v189, v102, v103
v_cvt_pk_bf16_f32 v190, v104, v105
v_cvt_pk_bf16_f32 v191, v106, v107
v_cvt_pk_bf16_f32 v192, v92, v93
v_cvt_pk_bf16_f32 v193, v94, v95
v_cvt_pk_bf16_f32 v194, v96, v97
v_cvt_pk_bf16_f32 v195, v98, v99
v_cvt_pk_bf16_f32 v212, v116, v117
v_cvt_pk_bf16_f32 v213, v118, v119
v_cvt_pk_bf16_f32 v214, v120, v121
v_cvt_pk_bf16_f32 v215, v122, v123
v_cvt_pk_bf16_f32 v216, v108, v109
v_cvt_pk_bf16_f32 v217, v110, v111
v_cvt_pk_bf16_f32 v218, v112, v113
v_cvt_pk_bf16_f32 v219, v114, v115
ds_write_b64 v232, v[196:197] offset:2048
ds_write_b64 v232, v[198:199] offset:2560
ds_write_b64 v232, v[220:221] offset:3072
v_mfma_f32_16x16x32_bf16 v[196:199], v[16:19], v[188:191], 0
v_add_u32 v233, s36, v232
ds_write_b64 v232, v[222:223] offset:3584
v_mfma_f32_16x16x32_bf16 v[200:203], v[16:19], v[192:195], 0
ds_write_b64 v233, v[140:141] offset:16384
v_mfma_f32_16x16x32_bf16 v[220:223], v[16:19], v[212:215], 0
s_nop 2
v_rcp_f32 v196, v196
v_mfma_f32_16x16x32_bf16 v[224:227], v[16:19], v[216:219], 0
s_nop 0
v_rcp_f32 v200, v200
ds_write_b64 v233, v[142:143] offset:16896
v_rcp_f32 v220, v220
v_pk_mul_f32 v[100:101], v[100:101], v[196:197] op_sel:[0,0] op_sel_hi:[1,0]
s_nop 2
v_rcp_f32 v224, v224
v_pk_mul_f32 v[102:103], v[102:103], v[196:197] op_sel:[0,0] op_sel_hi:[1,0]
v_pk_mul_f32 v[104:105], v[104:105], v[196:197] op_sel:[0,0] op_sel_hi:[1,0]
v_pk_mul_f32 v[106:107], v[106:107], v[196:197] op_sel:[0,0] op_sel_hi:[1,0]
v_pk_mul_f32 v[92:93], v[92:93], v[200:201] op_sel:[0,0] op_sel_hi:[1,0]
v_pk_mul_f32 v[94:95], v[94:95], v[200:201] op_sel:[0,0] op_sel_hi:[1,0]
v_pk_mul_f32 v[96:97], v[96:97], v[200:201] op_sel:[0,0] op_sel_hi:[1,0]
v_pk_mul_f32 v[98:99], v[98:99], v[200:201] op_sel:[0,0] op_sel_hi:[1,0]
v_pk_mul_f32 v[116:117], v[116:117], v[220:221] op_sel:[0,0] op_sel_hi:[1,0]
v_pk_mul_f32 v[118:119], v[118:119], v[220:221] op_sel:[0,0] op_sel_hi:[1,0]
v_pk_mul_f32 v[120:121], v[120:121], v[220:221] op_sel:[0,0] op_sel_hi:[1,0]
v_pk_mul_f32 v[122:123], v[122:123], v[220:221] op_sel:[0,0] op_sel_hi:[1,0]
v_pk_mul_f32 v[108:109], v[108:109], v[224:225] op_sel:[0,0] op_sel_hi:[1,0]
v_pk_mul_f32 v[110:111], v[110:111], v[224:225] op_sel:[0,0] op_sel_hi:[1,0]
v_pk_mul_f32 v[112:113], v[112:113], v[224:225] op_sel:[0,0] op_sel_hi:[1,0]
v_pk_mul_f32 v[114:115], v[114:115], v[224:225] op_sel:[0,0] op_sel_hi:[1,0]
v_cvt_pk_bf16_f32 v188, v100, v101
v_cvt_pk_bf16_f32 v189, v102, v103
v_cvt_pk_bf16_f32 v190, v104, v105
v_cvt_pk_bf16_f32 v191, v106, v107
v_cvt_pk_bf16_f32 v192, v92, v93
v_cvt_pk_bf16_f32 v193, v94, v95
v_cvt_pk_bf16_f32 v194, v96, v97
v_cvt_pk_bf16_f32 v195, v98, v99
v_cvt_pk_bf16_f32 v212, v116, v117
v_cvt_pk_bf16_f32 v213, v118, v119
v_cvt_pk_bf16_f32 v214, v120, v121
v_cvt_pk_bf16_f32 v215, v122, v123
v_cvt_pk_bf16_f32 v216, v108, v109
v_cvt_pk_bf16_f32 v217, v110, v111
v_cvt_pk_bf16_f32 v218, v112, v113
v_cvt_pk_bf16_f32 v219, v114, v115
ds_write_b64 v233, v[144:145] offset:17408
ds_write_b64 v233, v[146:147] offset:17920
ds_write_b64 v233, v[164:165] offset:18432
ds_write_b64 v233, v[166:167] offset:18944
ds_write_b64 v233, v[168:169] offset:19456
ds_write_b64 v233, v[170:171] offset:19968
ds_write_b64 v233, v[188:189] offset:20480
ds_write_b64 v233, v[190:191] offset:20992
ds_write_b64 v233, v[192:193] offset:21504
ds_write_b64 v233, v[194:195] offset:22016
ds_write_b64 v233, v[212:213] offset:22528
ds_write_b64 v233, v[214:215] offset:23040
ds_write_b64 v233, v[216:217] offset:23552
ds_write_b64 v233, v[218:219] offset:24064
s_waitcnt lgkmcnt(0)
s_barrier
s_lshl_b32 s36, s28, 9
v_add_u32 v234, s36, v8
ds_read_b64_tr_b16 a[0:1], v234 offset:16384
ds_read_b64_tr_b16 a[4:5], v8 offset:0
ds_read_b64_tr_b16 a[2:3], v234 offset:18432
ds_read_b64_tr_b16 a[6:7], v8 offset:1024
ds_read_b64_tr_b16 a[8:9], v8 offset:512
ds_read_b64_tr_b16 a[10:11], v8 offset:1536
ds_read_b64_tr_b16 a[12:13], v234 offset:20480
ds_read_b64_tr_b16 a[16:17], v8 offset:2048
ds_read_b64_tr_b16 a[14:15], v234 offset:22528
ds_read_b64_tr_b16 a[18:19], v8 offset:3072
ds_read_b64_tr_b16 a[20:21], v8 offset:2560
ds_read_b64_tr_b16 a[22:23], v8 offset:3584
ds_read_b64_tr_b16 a[24:25], v234 offset:24576
ds_read_b64_tr_b16 a[28:29], v8 offset:4096
ds_read_b64_tr_b16 a[26:27], v234 offset:26624
ds_read_b64_tr_b16 a[30:31], v8 offset:5120
ds_read_b64_tr_b16 a[32:33], v8 offset:4608
ds_read_b64_tr_b16 a[34:35], v8 offset:5632
ds_read_b64_tr_b16 a[36:37], v234 offset:28672
ds_read_b64_tr_b16 a[40:41], v8 offset:6144
ds_read_b64_tr_b16 a[38:39], v234 offset:30720
ds_read_b64_tr_b16 a[42:43], v8 offset:7168
ds_read_b64_tr_b16 a[44:45], v8 offset:6656
ds_read_b64_tr_b16 a[46:47], v8 offset:7680
ds_read_b64_tr_b16 a[48:49], v234 offset:32768
ds_read_b64_tr_b16 a[52:53], v8 offset:8192
ds_read_b64_tr_b16 a[50:51], v234 offset:34816
ds_read_b64_tr_b16 a[54:55], v8 offset:9216
ds_read_b64_tr_b16 a[56:57], v8 offset:8704
ds_read_b64_tr_b16 a[58:59], v8 offset:9728
ds_read_b64_tr_b16 a[60:61], v234 offset:36864
ds_read_b64_tr_b16 a[64:65], v8 offset:10240
ds_read_b64_tr_b16 a[62:63], v234 offset:38912
ds_read_b64_tr_b16 a[66:67], v8 offset:11264
s_waitcnt lgkmcnt(14)
v_mfma_f32_16x16x32_bf16 v[92:95], a[0:3], a[4:7], 0
ds_read_b64_tr_b16 a[68:69], v8 offset:10752
ds_read_b64_tr_b16 a[70:71], v8 offset:11776
ds_read_b64_tr_b16 a[72:73], v234 offset:40960
ds_read_b64_tr_b16 a[76:77], v8 offset:12288
ds_read_b64_tr_b16 a[74:75], v234 offset:43008
ds_read_b64_tr_b16 a[78:79], v8 offset:13312
v_mfma_f32_16x16x32_bf16 v[96:99], a[0:3], a[8:11], 0
ds_read_b64_tr_b16 a[80:81], v8 offset:12800
v_mfma_f32_16x16x32_bf16 v[92:95], a[12:15], a[16:19], v[92:95]
ds_read_b64_tr_b16 a[82:83], v8 offset:13824
v_mfma_f32_16x16x32_bf16 v[100:103], a[0:3], v[16:19], 0
ds_read_b64_tr_b16 a[84:85], v234 offset:45056
ds_read_b64_tr_b16 a[88:89], v8 offset:14336
ds_read_b64_tr_b16 a[86:87], v234 offset:47104
ds_read_b64_tr_b16 a[90:91], v8 offset:15360
v_mfma_f32_16x16x32_bf16 v[96:99], a[12:15], a[20:23], v[96:99]
ds_read_b64_tr_b16 a[92:93], v8 offset:14848
v_mfma_f32_16x16x32_bf16 v[92:95], a[24:27], a[28:31], v[92:95]
ds_read_b64_tr_b16 a[94:95], v8 offset:15872
v_mfma_f32_16x16x32_bf16 v[100:103], a[12:15], v[16:19], v[100:103]
s_lshl_b32 s37, s30, 2
s_add_u32 s37, s37, s28
v_mfma_f32_16x16x32_bf16 v[96:99], a[24:27], a[32:35], v[96:99]
s_lshl_b32 s37, s37, 3
s_add_u32 s38, s37, s29
s_waitcnt lgkmcnt(14)
v_mfma_f32_16x16x32_bf16 v[92:95], a[36:39], a[40:43], v[92:95]
s_lshl_b32 s39, s38, 7
s_add_u32 s39, s39, 0x800000
v_mfma_f32_16x16x32_bf16 v[100:103], a[24:27], v[16:19], v[100:103]
s_lshl_b32 s38, s38, 11
s_add_u32 s38, s38, 0x400000
v_mfma_f32_16x16x32_bf16 v[96:99], a[36:39], a[44:47], v[96:99]
v_cvt_pk_bf16_f32 v132, v132, v133
v_cvt_pk_bf16_f32 v156, v156, v157
v_mfma_f32_16x16x32_bf16 v[92:95], a[48:51], a[52:55], v[92:95]
v_cvt_pk_bf16_f32 v180, v180, v181
v_cvt_pk_bf16_f32 v204, v204, v205
v_mfma_f32_16x16x32_bf16 v[100:103], a[36:39], v[16:19], v[100:103]
v_cvt_pk_bf16_f32 v133, v134, v135
v_cvt_pk_bf16_f32 v157, v158, v159
v_mfma_f32_16x16x32_bf16 v[96:99], a[48:51], a[56:59], v[96:99]
v_cvt_pk_bf16_f32 v181, v182, v183
v_cvt_pk_bf16_f32 v205, v206, v207
v_mfma_f32_16x16x32_bf16 v[92:95], a[60:63], a[64:67], v[92:95]
v_cvt_pk_bf16_f32 v134, v136, v137
v_cvt_pk_bf16_f32 v135, v138, v139
v_mfma_f32_16x16x32_bf16 v[100:103], a[48:51], v[16:19], v[100:103]
v_cvt_pk_bf16_f32 v158, v160, v161
v_cvt_pk_bf16_f32 v159, v162, v163
s_waitcnt lgkmcnt(12)
v_mfma_f32_16x16x32_bf16 v[96:99], a[60:63], a[68:71], v[96:99]
v_cvt_pk_bf16_f32 v182, v184, v185
v_cvt_pk_bf16_f32 v183, v186, v187
s_waitcnt lgkmcnt(8)
v_mfma_f32_16x16x32_bf16 v[92:95], a[72:75], a[76:79], v[92:95]
v_cvt_pk_bf16_f32 v206, v208, v209
v_cvt_pk_bf16_f32 v207, v210, v211
v_mfma_f32_16x16x32_bf16 v[100:103], a[60:63], v[16:19], v[100:103]
s_waitcnt lgkmcnt(6)
v_mfma_f32_16x16x32_bf16 v[96:99], a[72:75], a[80:83], v[96:99]
s_waitcnt lgkmcnt(2)
v_mfma_f32_16x16x32_bf16 v[92:95], a[84:87], a[88:91], v[92:95]
v_mfma_f32_16x16x32_bf16 v[100:103], a[72:75], v[16:19], v[100:103]
s_waitcnt lgkmcnt(0)
v_mfma_f32_16x16x32_bf16 v[96:99], a[84:87], a[92:95], v[96:99]
s_nop 4
buffer_store_dwordx4 v[92:95], v1, s[4:7], s38 offen offset:0 sc1
v_mfma_f32_16x16x32_bf16 v[100:103], a[84:87], v[16:19], v[100:103]
s_nop 0
buffer_store_dwordx4 v[96:99], v1, s[4:7], s38 offen offset:1024 sc1
s_nop 5
buffer_store_dwordx4 v[100:103], v254, s[4:7], s39 offen sc1
v_cndmask_b32 v235, 2.0, v10, s[64:65]
v_mfma_f32_16x16x32_bf16 v[108:111], a[232:235], v[132:135], 0
v_mul_f32 v240, 0x3fb8aa3b, v83
v_mul_f32 v246, 0x3fb8aa3b, v85
v_mfma_f32_16x16x32_bf16 v[172:175], a[232:235], v[156:159], 0
v_mfma_f32_16x16x32_bf16 v[112:115], a[236:239], v[132:135], 0
s_nop 3
v_max3_f32 v236, v108, v109, v110
v_max3_f32 v237, -v108, -v109, -v110
v_mfma_f32_16x16x32_bf16 v[176:179], a[236:239], v[156:159], 0
v_max3_f32 v242, v172, v173, v174
v_max3_f32 v243, -v172, -v173, -v174
v_max3_f32 v236, v236, v111, v112
v_max3_f32 v237, v237, -v111, -v112
v_max3_f32 v236, v236, v113, v114
v_max3_f32 v237, v237, -v113, -v114
s_nop 1
v_max3_f32 v242, v242, v175, v176
v_max3_f32 v243, v243, -v175, -v176
v_max3_f32 v242, v242, v177, v178
v_max3_f32 v243, v243, -v177, -v178
v_max_f32 v236, v236, v115
v_max_f32_e64 v237, v237, -v115
v_max_f32 v242, v242, v179
v_max_f32_e64 v243, v243, -v179
v_permlane32_swap_b32 v236, v237
s_nop 0
v_permlane32_swap_b32 v242, v243
v_max_f32 v236, v236, v237
v_max_f32 v242, v242, v243
v_mov_b32 v238, v236
v_mov_b32 v244, v242
s_nop 0
v_permlane16_swap_b32 v236, v238
v_permlane16_swap_b32 v242, v244
v_max_f32 v236, v236, v238
v_max_f32 v242, v242, v244
v_mov_b32 v238, v236
v_mov_b32 v244, v242
s_nop 0
v_permlane32_swap_b32 v236, v238
v_permlane32_swap_b32 v242, v244
v_mul_f32_e64 v236, -v236, v240
v_mul_f32_e64 v237, -v238, v240
v_mul_f32_e64 v242, -v242, v246
v_mul_f32_e64 v243, -v244, v246
v_pk_fma_f32 v[116:117], v[108:109], v[240:241], v[236:237] op_sel:[0,0,0] op_sel_hi:[1,0,0]
v_pk_fma_f32 v[118:119], v[110:111], v[240:241], v[236:237] op_sel:[0,0,0] op_sel_hi:[1,0,0]
v_pk_fma_f32 v[120:121], v[112:113], v[240:241], v[236:237] op_sel:[0,0,0] op_sel_hi:[1,0,0]
v_pk_fma_f32 v[122:123], v[114:115], v[240:241], v[236:237] op_sel:[0,0,0] op_sel_hi:[1,0,0]
v_pk_fma_f32 v[148:149], v[172:173], v[246:247], v[242:243] op_sel:[0,0,0] op_sel_hi:[1,0,0]
v_pk_fma_f32 v[150:151], v[174:175], v[246:247], v[242:243] op_sel:[0,0,0] op_sel_hi:[1,0,0]
v_pk_fma_f32 v[152:153], v[176:177], v[246:247], v[242:243] op_sel:[0,0,0] op_sel_hi:[1,0,0]
v_pk_fma_f32 v[154:155], v[178:179], v[246:247], v[242:243] op_sel:[0,0,0] op_sel_hi:[1,0,0]
v_pk_fma_f32 v[108:109], v[108:109], v[240:241], v[236:237] op_sel:[0,0,1] op_sel_hi:[1,0,1] neg_lo:[1,0,0] neg_hi:[1,0,0]
v_pk_fma_f32 v[110:111], v[110:111], v[240:241], v[236:237] op_sel:[0,0,1] op_sel_hi:[1,0,1] neg_lo:[1,0,0] neg_hi:[1,0,0]
v_pk_fma_f32 v[112:113], v[112:113], v[240:241], v[236:237] op_sel:[0,0,1] op_sel_hi:[1,0,1] neg_lo:[1,0,0] neg_hi:[1,0,0]
v_pk_fma_f32 v[114:115], v[114:115], v[240:241], v[236:237] op_sel:[0,0,1] op_sel_hi:[1,0,1] neg_lo:[1,0,0] neg_hi:[1,0,0]
v_pk_fma_f32 v[172:173], v[172:173], v[246:247], v[242:243] op_sel:[0,0,1] op_sel_hi:[1,0,1] neg_lo:[1,0,0] neg_hi:[1,0,0]
v_pk_fma_f32 v[174:175], v[174:175], v[246:247], v[242:243] op_sel:[0,0,1] op_sel_hi:[1,0,1] neg_lo:[1,0,0] neg_hi:[1,0,0]
v_pk_fma_f32 v[176:177], v[176:177], v[246:247], v[242:243] op_sel:[0,0,1] op_sel_hi:[1,0,1] neg_lo:[1,0,0] neg_hi:[1,0,0]
v_pk_fma_f32 v[178:179], v[178:179], v[246:247], v[242:243] op_sel:[0,0,1] op_sel_hi:[1,0,1] neg_lo:[1,0,0] neg_hi:[1,0,0]
v_exp_f32 v116, v116
v_exp_f32 v108, v108
v_exp_f32 v117, v117
v_exp_f32 v109, v109
v_exp_f32 v118, v118
v_exp_f32 v110, v110
v_exp_f32 v119, v119
v_exp_f32 v111, v111
v_exp_f32 v120, v120
v_exp_f32 v112, v112
v_exp_f32 v121, v121
v_exp_f32 v113, v113
v_exp_f32 v122, v122
v_exp_f32 v114, v114
v_exp_f32 v123, v123
v_exp_f32 v115, v115
v_exp_f32 v148, v148
v_exp_f32 v172, v172
v_exp_f32 v149, v149
v_exp_f32 v173, v173
v_exp_f32 v150, v150
v_exp_f32 v174, v174
v_exp_f32 v151, v151
v_exp_f32 v175, v175
v_exp_f32 v152, v152
v_exp_f32 v176, v176
v_exp_f32 v153, v153
v_exp_f32 v177, v177
v_exp_f32 v154, v154
v_exp_f32 v178, v178
v_exp_f32 v155, v155
v_exp_f32 v179, v179
v_cvt_pk_bf16_f32 v140, v116, v117
v_cvt_pk_bf16_f32 v141, v118, v119
v_cvt_pk_bf16_f32 v142, v120, v121
v_cvt_pk_bf16_f32 v143, v122, v123
v_cvt_pk_bf16_f32 v144, v108, v109
v_cvt_pk_bf16_f32 v145, v110, v111
v_cvt_pk_bf16_f32 v146, v112, v113
v_cvt_pk_bf16_f32 v147, v114, v115
v_cvt_pk_bf16_f32 v164, v148, v149
v_cvt_pk_bf16_f32 v165, v150, v151
v_cvt_pk_bf16_f32 v166, v152, v153
v_cvt_pk_bf16_f32 v167, v154, v155
v_cvt_pk_bf16_f32 v168, v172, v173
v_cvt_pk_bf16_f32 v169, v174, v175
v_cvt_pk_bf16_f32 v170, v176, v177
v_cvt_pk_bf16_f32 v171, v178, v179
s_add_u32 s94, s80, 0x80000
s_waitcnt vmcnt(0)
s_barrier
buffer_atomic_add v12, v235, s[4:7], s94 offen sc1
v_mfma_f32_16x16x32_bf16 v[108:111], a[232:235], v[180:183], 0
v_mul_f32 v240, 0x3fb8aa3b, v87
v_mul_f32 v246, 0x3fb8aa3b, v89
v_mfma_f32_16x16x32_bf16 v[172:175], a[232:235], v[204:207], 0
v_mfma_f32_16x16x32_bf16 v[112:115], a[236:239], v[180:183], 0
s_nop 3
v_max3_f32 v236, v108, v109, v110
v_max3_f32 v237, -v108, -v109, -v110
v_mfma_f32_16x16x32_bf16 v[176:179], a[236:239], v[204:207], 0
v_max3_f32 v242, v172, v173, v174
v_max3_f32 v243, -v172, -v173, -v174
v_max3_f32 v236, v236, v111, v112
v_max3_f32 v237, v237, -v111, -v112
v_max3_f32 v236, v236, v113, v114
v_max3_f32 v237, v237, -v113, -v114
s_nop 1
v_max3_f32 v242, v242, v175, v176
v_max3_f32 v243, v243, -v175, -v176
v_max3_f32 v242, v242, v177, v178
v_max3_f32 v243, v243, -v177, -v178
v_max_f32 v236, v236, v115
v_max_f32_e64 v237, v237, -v115
v_max_f32 v242, v242, v179
v_max_f32_e64 v243, v243, -v179
v_permlane32_swap_b32 v236, v237
s_nop 0
v_permlane32_swap_b32 v242, v243
v_max_f32 v236, v236, v237
v_max_f32 v242, v242, v243
v_mov_b32 v238, v236
v_mov_b32 v244, v242
s_nop 0
v_permlane16_swap_b32 v236, v238
v_permlane16_swap_b32 v242, v244
v_max_f32 v236, v236, v238
v_max_f32 v242, v242, v244
v_mov_b32 v238, v236
v_mov_b32 v244, v242
s_nop 0
v_permlane32_swap_b32 v236, v238
v_permlane32_swap_b32 v242, v244
v_mul_f32_e64 v236, -v236, v240
v_mul_f32_e64 v237, -v238, v240
v_mul_f32_e64 v242, -v242, v246
v_mul_f32_e64 v243, -v244, v246
v_pk_fma_f32 v[116:117], v[108:109], v[240:241], v[236:237] op_sel:[0,0,0] op_sel_hi:[1,0,0]
v_pk_fma_f32 v[118:119], v[110:111], v[240:241], v[236:237] op_sel:[0,0,0] op_sel_hi:[1,0,0]
v_pk_fma_f32 v[120:121], v[112:113], v[240:241], v[236:237] op_sel:[0,0,0] op_sel_hi:[1,0,0]
v_pk_fma_f32 v[122:123], v[114:115], v[240:241], v[236:237] op_sel:[0,0,0] op_sel_hi:[1,0,0]
v_pk_fma_f32 v[148:149], v[172:173], v[246:247], v[242:243] op_sel:[0,0,0] op_sel_hi:[1,0,0]
v_pk_fma_f32 v[150:151], v[174:175], v[246:247], v[242:243] op_sel:[0,0,0] op_sel_hi:[1,0,0]
v_pk_fma_f32 v[152:153], v[176:177], v[246:247], v[242:243] op_sel:[0,0,0] op_sel_hi:[1,0,0]
v_pk_fma_f32 v[154:155], v[178:179], v[246:247], v[242:243] op_sel:[0,0,0] op_sel_hi:[1,0,0]
v_pk_fma_f32 v[108:109], v[108:109], v[240:241], v[236:237] op_sel:[0,0,1] op_sel_hi:[1,0,1] neg_lo:[1,0,0] neg_hi:[1,0,0]
v_pk_fma_f32 v[110:111], v[110:111], v[240:241], v[236:237] op_sel:[0,0,1] op_sel_hi:[1,0,1] neg_lo:[1,0,0] neg_hi:[1,0,0]
v_pk_fma_f32 v[112:113], v[112:113], v[240:241], v[236:237] op_sel:[0,0,1] op_sel_hi:[1,0,1] neg_lo:[1,0,0] neg_hi:[1,0,0]
v_pk_fma_f32 v[114:115], v[114:115], v[240:241], v[236:237] op_sel:[0,0,1] op_sel_hi:[1,0,1] neg_lo:[1,0,0] neg_hi:[1,0,0]
v_pk_fma_f32 v[172:173], v[172:173], v[246:247], v[242:243] op_sel:[0,0,1] op_sel_hi:[1,0,1] neg_lo:[1,0,0] neg_hi:[1,0,0]
v_pk_fma_f32 v[174:175], v[174:175], v[246:247], v[242:243] op_sel:[0,0,1] op_sel_hi:[1,0,1] neg_lo:[1,0,0] neg_hi:[1,0,0]
v_pk_fma_f32 v[176:177], v[176:177], v[246:247], v[242:243] op_sel:[0,0,1] op_sel_hi:[1,0,1] neg_lo:[1,0,0] neg_hi:[1,0,0]
v_pk_fma_f32 v[178:179], v[178:179], v[246:247], v[242:243] op_sel:[0,0,1] op_sel_hi:[1,0,1] neg_lo:[1,0,0] neg_hi:[1,0,0]
v_exp_f32 v116, v116
v_exp_f32 v108, v108
v_exp_f32 v117, v117
v_exp_f32 v109, v109
v_exp_f32 v118, v118
v_exp_f32 v110, v110
v_exp_f32 v119, v119
v_exp_f32 v111, v111
v_exp_f32 v120, v120
v_exp_f32 v112, v112
v_exp_f32 v121, v121
v_exp_f32 v113, v113
v_exp_f32 v122, v122
v_exp_f32 v114, v114
v_exp_f32 v123, v123
v_exp_f32 v115, v115
v_exp_f32 v148, v148
v_exp_f32 v172, v172
v_exp_f32 v149, v149
v_exp_f32 v173, v173
v_exp_f32 v150, v150
v_exp_f32 v174, v174
v_exp_f32 v151, v151
v_exp_f32 v175, v175
v_exp_f32 v152, v152
v_exp_f32 v176, v176
v_exp_f32 v153, v153
v_exp_f32 v177, v177
v_exp_f32 v154, v154
v_exp_f32 v178, v178
v_exp_f32 v155, v155
v_exp_f32 v179, v179
v_cvt_pk_bf16_f32 v188, v116, v117
v_cvt_pk_bf16_f32 v189, v118, v119
v_cvt_pk_bf16_f32 v190, v120, v121
v_cvt_pk_bf16_f32 v191, v122, v123
v_cvt_pk_bf16_f32 v192, v108, v109
v_cvt_pk_bf16_f32 v193, v110, v111
v_cvt_pk_bf16_f32 v194, v112, v113
v_cvt_pk_bf16_f32 v195, v114, v115
v_cvt_pk_bf16_f32 v212, v148, v149
v_cvt_pk_bf16_f32 v213, v150, v151
v_cvt_pk_bf16_f32 v214, v152, v153
v_cvt_pk_bf16_f32 v215, v154, v155
v_cvt_pk_bf16_f32 v216, v172, v173
v_cvt_pk_bf16_f32 v217, v174, v175
v_cvt_pk_bf16_f32 v218, v176, v177
v_cvt_pk_bf16_f32 v219, v178, v179
s_cmp_lg_u32 s28, 0
s_cbranch_scc1 Lpe_15
s_add_u32 s36, s70, 0x80000
s_mov_b32 s37, 0
Lpoll_14:
v_mov_b32 v11, 0
s_mov_b64 exec, 1
buffer_atomic_add v11, off, s[4:7], s36 sc0 sc1
s_waitcnt vmcnt(0)
v_readfirstlane_b32 s38, v11
s_mov_b64 exec, -1
s_nop 0
v_mov_b32 v11, s38
s_add_u32 s37, s37, 1
v_cmp_gt_u32 vcc, 8, v11
s_cbranch_vccz Lpe_15
s_cmp_lt_u32 s37, 0x100000
s_cbranch_scc1 Lpoll_14
Lpe_15:
s_barrier
s_lshl_b32 s37, s30, 2
s_add_u32 s37, s37, s28
v_and_b32 v248, 7, v0
s_lshl_b32 s39, s37, 10
v_lshlrev_b32 v248, 7, v248
v_lshrrev_b32 v249, 4, v0
s_add_u32 s39, s39, 0x800000
v_lshl_add_u32 v248, v249, 4, v248
s_lshl_b32 s38, s37, 14
buffer_load_dwordx4 v[156:159], v248, s[4:7], s39 offen sc1
s_add_u32 s38, s38, 0x400000
buffer_load_dwordx4 v[92:95], v1, s[4:7], s38 offen offset:0 sc1
buffer_load_dwordx4 v[96:99], v1, s[4:7], s38 offen offset:1024 sc1
buffer_load_dwordx4 v[100:103], v1, s[4:7], s38 offen offset:2048 sc1
buffer_load_dwordx4 v[104:107], v1, s[4:7], s38 offen offset:3072 sc1
s_add_u32 s38, s38, 4096
buffer_load_dwordx4 v[148:151], v1, s[4:7], s38 offen offset:0 sc1
buffer_load_dwordx4 v[152:155], v1, s[4:7], s38 offen offset:1024 sc1
buffer_load_dwordx4 v[172:175], v1, s[4:7], s38 offen offset:2048 sc1
buffer_load_dwordx4 v[176:179], v1, s[4:7], s38 offen offset:3072 sc1
s_add_u32 s38, s38, 4096
buffer_load_dwordx4 v[48:51], v1, s[4:7], s38 offen offset:0 sc1
buffer_load_dwordx4 v[52:55], v1, s[4:7], s38 offen offset:1024 sc1
buffer_load_dwordx4 v[56:59], v1, s[4:7], s38 offen offset:2048 sc1
buffer_load_dwordx4 v[60:63], v1, s[4:7], s38 offen offset:3072 sc1
s_add_u32 s38, s38, 4096
buffer_load_dwordx4 v[64:67], v1, s[4:7], s38 offen offset:0 sc1
s_waitcnt vmcnt(13)
v_add_f32_dpp v156, v156, v156 row_ror:4 row_mask:0xf bank_mask:0xf
v_add_f32_dpp v157, v157, v157 row_ror:4 row_mask:0xf bank_mask:0xf
v_add_f32_dpp v158, v158, v158 row_ror:4 row_mask:0xf bank_mask:0xf
v_add_f32_dpp v159, v159, v159 row_ror:4 row_mask:0xf bank_mask:0xf
v_add_f32_dpp v156, v156, v156 row_ror:2 row_mask:0xf bank_mask:0xf
v_add_f32_dpp v157, v157, v157 row_ror:2 row_mask:0xf bank_mask:0xf
v_add_f32_dpp v158, v158, v158 row_ror:2 row_mask:0xf bank_mask:0xf
v_add_f32_dpp v159, v159, v159 row_ror:2 row_mask:0xf bank_mask:0xf
buffer_load_dwordx4 v[68:71], v1, s[4:7], s38 offen offset:1024 sc1
v_add_f32_dpp v156, v156, v156 row_ror:1 row_mask:0xf bank_mask:0xf
v_add_f32_dpp v157, v157, v157 row_ror:1 row_mask:0xf bank_mask:0xf
v_add_f32_dpp v158, v158, v158 row_ror:1 row_mask:0xf bank_mask:0xf
v_add_f32_dpp v159, v159, v159 row_ror:1 row_mask:0xf bank_mask:0xf
buffer_load_dwordx4 v[132:135], v1, s[4:7], s38 offen offset:2048 sc1
s_waitcnt vmcnt(12)
v_pk_add_f32 v[92:93], v[92:93], v[100:101]
v_pk_add_f32 v[94:95], v[94:95], v[102:103]
buffer_load_dwordx4 v[136:139], v1, s[4:7], s38 offen offset:3072 sc1
s_waitcnt vmcnt(12)
v_pk_add_f32 v[96:97], v[96:97], v[104:105]
v_pk_add_f32 v[98:99], v[98:99], v[106:107]
s_waitcnt vmcnt(11)
v_pk_add_f32 v[92:93], v[92:93], v[148:149]
v_pk_add_f32 v[94:95], v[94:95], v[150:151]
s_waitcnt vmcnt(10)
v_pk_add_f32 v[96:97], v[96:97], v[152:153]
v_pk_add_f32 v[98:99], v[98:99], v[154:155]
s_waitcnt vmcnt(9)
v_pk_add_f32 v[92:93], v[92:93], v[172:173]
v_pk_add_f32 v[94:95], v[94:95], v[174:175]
s_waitcnt vmcnt(8)
v_pk_add_f32 v[96:97], v[96:97], v[176:177]
v_pk_add_f32 v[98:99], v[98:99], v[178:179]
s_waitcnt vmcnt(7)
v_pk_add_f32 v[92:93], v[92:93], v[48:49]
v_pk_add_f32 v[94:95], v[94:95], v[50:51]
s_waitcnt vmcnt(6)
v_pk_add_f32 v[96:97], v[96:97], v[52:53]
v_pk_add_f32 v[98:99], v[98:99], v[54:55]
s_waitcnt vmcnt(5)
v_pk_add_f32 v[92:93], v[92:93], v[56:57]
v_pk_add_f32 v[94:95], v[94:95], v[58:59]
s_waitcnt vmcnt(4)
v_pk_add_f32 v[96:97], v[96:97], v[60:61]
v_pk_add_f32 v[98:99], v[98:99], v[62:63]
s_waitcnt vmcnt(3)
v_pk_add_f32 v[92:93], v[92:93], v[64:65]
v_pk_add_f32 v[94:95], v[94:95], v[66:67]
s_waitcnt vmcnt(2)
v_pk_add_f32 v[96:97], v[96:97], v[68:69]
v_pk_add_f32 v[98:99], v[98:99], v[70:71]
s_waitcnt vmcnt(1)
v_pk_add_f32 v[92:93], v[92:93], v[132:133]
v_pk_add_f32 v[94:95], v[94:95], v[134:135]
s_waitcnt vmcnt(0)
v_pk_add_f32 v[96:97], v[96:97], v[136:137]
v_pk_add_f32 v[98:99], v[98:99], v[138:139]
s_lshr_b32 s36, s28, 1
s_and_b32 s37, s28, 1
v_cvt_pk_bf16_f32 v156, v156, v157
v_cvt_pk_bf16_f32 v157, v158, v159
s_mul_i32 s36, s36, 3072
s_lshl_b32 s37, s37, 3
v_cvt_pk_bf16_f32 v92, v92, v93
v_cndmask_b32 v156, 0, v156, s[56:57]
v_cndmask_b32 v157, 0, v157, s[56:57]
s_add_u32 s36, s36, s37
v_cvt_pk_bf16_f32 v93, v94, v95
v_cvt_pk_bf16_f32 v94, v96, v97
v_cvt_pk_bf16_f32 v95, v98, v99
v_cndmask_b32 v156, v156, v16, s[58:59]
v_cndmask_b32 v157, v157, v16, s[58:59]
v_add_u32 v236, s36, v1
s_lshl_b32 s35, s30, 12
ds_write_b64 v236, v[92:93] offset:0
ds_write_b64 v236, v[94:95] offset:1024
ds_write_b64 v236, v[156:157] offset:2048
s_add_u32 s35, s35, 0x1e00000
s_add_u32 s94, s71, 0x10080
s_waitcnt lgkmcnt(0)
s_barrier
ds_read_b128 a[8:11], v1 offset:2048
ds_read_b128 a[20:23], v1 offset:5120
ds_read_b128 a[0:3], v1 offset:0
ds_read_b128 a[12:15], v1 offset:3072
s_add_u32 s44, s28, 0
s_lshl_b32 s45, s44, 12
ds_read_b128 a[4:7], v1 offset:1024
s_add_u32 m0, s45, 32768
s_and_b32 s45, s44, 7
ds_read_b128 a[16:19], v1 offset:4096
s_cmp_eq_u32 s45, s3
s_cselect_b32 s45, 8, 0
s_add_u32 s44, s44, s45
s_and_b32 s44, s44, 31
s_lshl_b32 s44, s44, 12
s_add_u32 s44, s44, s51
s_add_u32 s44, s44, 0x200000
buffer_load_dwordx4 v1, s[4:7], s44 offen offset:0 sc1 lds
buffer_load_dwordx4 v1, s[4:7], s44 offen offset:1024 sc1 lds
s_waitcnt lgkmcnt(5)
v_mfma_f32_16x16x32_bf16 v[92:95], a[8:11], v[140:143], 0
s_waitcnt lgkmcnt(4)
v_mfma_f32_16x16x32_bf16 v[96:99], a[20:23], v[144:147], 0
v_mfma_f32_16x16x32_bf16 v[100:103], a[8:11], v[164:167], 0
s_nop 4
v_rcp_f32 v94, v93
v_mfma_f32_16x16x32_bf16 v[104:107], a[20:23], v[168:171], 0
v_rcp_f32 v95, v97
v_mfma_f32_16x16x32_bf16 v[108:111], a[8:11], v[188:191], 0
v_rcp_f32 v102, v101
v_mfma_f32_16x16x32_bf16 v[112:115], a[20:23], v[192:195], 0
v_mul_f32 v92, v92, v94
s_nop 2
v_rcp_f32 v103, v105
v_mfma_f32_16x16x32_bf16 v[116:119], a[8:11], v[212:215], 0
v_fmac_f32 v92, v96, v95
v_rcp_f32 v110, v109
v_mfma_f32_16x16x32_bf16 v[120:123], a[20:23], v[216:219], 0
v_add_f32 v92, 0x358637bd, v92
v_mul_f32 v100, v100, v102
s_waitcnt lgkmcnt(3)
v_mfma_f32_16x16x32_bf16 v[132:135], a[0:3], v[140:143], 0
v_rcp_f32 v111, v113
s_waitcnt lgkmcnt(2)
v_mfma_f32_16x16x32_bf16 v[148:151], a[12:15], v[144:147], 0
v_rcp_f32 v92, v92
s_waitcnt lgkmcnt(1)
v_mfma_f32_16x16x32_bf16 v[136:139], a[4:7], v[140:143], 0
v_fmac_f32 v100, v104, v103
v_rcp_f32 v118, v117
v_mfma_f32_16x16x32_bf16 v[156:159], a[0:3], v[164:167], 0
v_add_f32 v100, 0x358637bd, v100
v_mul_f32 v108, v108, v110
s_waitcnt lgkmcnt(0)
v_mfma_f32_16x16x32_bf16 v[152:155], a[16:19], v[144:147], 0
v_rcp_f32 v119, v121
v_mfma_f32_16x16x32_bf16 v[172:175], a[12:15], v[168:171], 0
v_rcp_f32 v100, v100
v_mfma_f32_16x16x32_bf16 v[160:163], a[4:7], v[164:167], 0
v_fmac_f32 v108, v112, v111
v_mul_f32 v94, v94, v92
v_mfma_f32_16x16x32_bf16 v[180:183], a[0:3], v[188:191], 0
v_add_f32 v108, 0x358637bd, v108
v_mul_f32 v116, v116, v118
v_mfma_f32_16x16x32_bf16 v[176:179], a[16:19], v[168:171], 0
v_mul_f32 v95, v95, v92
v_mul_f32 v132, v132, v94
v_mfma_f32_16x16x32_bf16 v[196:199], a[12:15], v[192:195], 0
v_mul_f32 v133, v133, v94
v_mul_f32 v134, v134, v94
v_mfma_f32_16x16x32_bf16 v[184:187], a[4:7], v[188:191], 0
v_mul_f32 v135, v135, v94
v_rcp_f32 v108, v108
v_mfma_f32_16x16x32_bf16 v[204:207], a[0:3], v[212:215], 0
v_fmac_f32 v116, v120, v119
buffer_load_dwordx4 v1, s[4:7], s44 offen offset:2048 sc1 lds
v_mfma_f32_16x16x32_bf16 v[200:203], a[16:19], v[192:195], 0
v_fmac_f32 v132, v148, v95
v_fmac_f32 v133, v149, v95
v_mul_f32 v102, v102, v100
v_mul_f32 v136, v136, v94
v_mul_f32 v137, v137, v94
v_mul_f32 v138, v138, v94
v_mul_f32 v139, v139, v94
v_mfma_f32_16x16x32_bf16 v[220:223], a[12:15], v[216:219], 0
v_fmac_f32 v134, v150, v95
v_fmac_f32 v135, v151, v95
v_mfma_f32_16x16x32_bf16 v[208:211], a[4:7], v[212:215], 0
v_add_f32 v116, 0x358637bd, v116
v_cvt_pk_bf16_f32 v132, v132, v133
v_mul_f32 v103, v103, v100
v_mul_f32 v156, v156, v102
v_mul_f32 v157, v157, v102
v_fmac_f32 v136, v152, v95
v_fmac_f32 v137, v153, v95
v_fmac_f32 v138, v154, v95
v_fmac_f32 v139, v155, v95
buffer_load_dwordx4 v1, s[4:7], s44 offen offset:3072 sc1 lds
v_cvt_pk_bf16_f32 v133, v134, v135
v_mfma_f32_16x16x32_bf16 v[224:227], a[16:19], v[216:219], 0
v_mul_f32 v158, v158, v102
v_mul_f32 v159, v159, v102
v_rcp_f32 v116, v116
v_fmac_f32 v156, v172, v103
v_fmac_f32 v157, v173, v103
v_cvt_pk_bf16_f32 v134, v136, v137
v_cvt_pk_bf16_f32 v135, v138, v139
v_mul_f32 v110, v110, v108
v_mul_f32 v160, v160, v102
v_mul_f32 v161, v161, v102
v_mul_f32 v162, v162, v102
v_mul_f32 v163, v163, v102
v_fmac_f32 v158, v174, v103
v_fmac_f32 v159, v175, v103
v_cvt_pk_bf16_f32 v156, v156, v157
buffer_store_dwordx4 v[132:135], v2, s[4:7], s35 offen offset:0 sc1
v_mul_f32 v111, v111, v108
v_mul_f32 v180, v180, v110
v_mul_f32 v181, v181, v110
v_fmac_f32 v160, v176, v103
v_fmac_f32 v161, v177, v103
v_fmac_f32 v162, v178, v103
v_fmac_f32 v163, v179, v103
v_cvt_pk_bf16_f32 v157, v158, v159
v_mul_f32 v182, v182, v110
v_mul_f32 v183, v183, v110
v_fmac_f32 v180, v196, v111
v_fmac_f32 v181, v197, v111
v_cvt_pk_bf16_f32 v158, v160, v161
v_cvt_pk_bf16_f32 v159, v162, v163
v_mul_f32 v118, v118, v116
v_mul_f32 v184, v184, v110
v_mul_f32 v185, v185, v110
v_mul_f32 v186, v186, v110
v_mul_f32 v187, v187, v110
v_fmac_f32 v182, v198, v111
v_fmac_f32 v183, v199, v111
v_cvt_pk_bf16_f32 v180, v180, v181
buffer_store_dwordx4 v[156:159], v2, s[4:7], s35 offen offset:1024 sc1
v_mul_f32 v119, v119, v116
v_mul_f32 v204, v204, v118
v_mul_f32 v205, v205, v118
v_fmac_f32 v184, v200, v111
v_fmac_f32 v185, v201, v111
v_fmac_f32 v186, v202, v111
v_fmac_f32 v187, v203, v111
v_cvt_pk_bf16_f32 v181, v182, v183
v_mul_f32 v206, v206, v118
v_mul_f32 v207, v207, v118
v_fmac_f32 v204, v220, v119
v_fmac_f32 v205, v221, v119
v_cvt_pk_bf16_f32 v182, v184, v185
v_cvt_pk_bf16_f32 v183, v186, v187
v_mul_f32 v208, v208, v118
v_mul_f32 v209, v209, v118
v_mul_f32 v210, v210, v118
v_mul_f32 v211, v211, v118
v_fmac_f32 v206, v222, v119
v_fmac_f32 v207, v223, v119
v_cvt_pk_bf16_f32 v204, v204, v205
buffer_store_dwordx4 v[180:183], v2, s[4:7], s35 offen offset:2048 sc1
v_fmac_f32 v208, v224, v119
v_fmac_f32 v209, v225, v119
v_fmac_f32 v210, v226, v119
v_fmac_f32 v211, v227, v119
v_cvt_pk_bf16_f32 v205, v206, v207
v_cvt_pk_bf16_f32 v206, v208, v209
v_cvt_pk_bf16_f32 v207, v210, v211
buffer_store_dwordx4 v[204:207], v2, s[4:7], s35 offen offset:3072 sc1
s_add_u32 s92, s71, 0x10000
s_add_u32 s40, s4, 0x1e00000
s_addc_u32 s41, s5, 0
v_add_u32 v5, 32768, v1
v_add_u32 v6, 98304, v1
s_cmp_eq_u32 s3, 0
s_cselect_b32 s35, 8, 0
s_lshl_b32 s35, s35, 12
v_lshlrev_b32 v132, 16, v32
v_and_b32 v133, 0xffff0000, v32
v_lshlrev_b32 v134, 16, v33
v_and_b32 v135, 0xffff0000, v33
v_lshlrev_b32 v136, 16, v34
v_and_b32 v137, 0xffff0000, v34
v_lshlrev_b32 v138, 16, v35
v_and_b32 v139, 0xffff0000, v35
v_lshlrev_b32 v140, 16, v36
v_and_b32 v141, 0xffff0000, v36
v_lshlrev_b32 v142, 16, v37
v_and_b32 v143, 0xffff0000, v37
v_lshlrev_b32 v144, 16, v38
v_and_b32 v145, 0xffff0000, v38
v_lshlrev_b32 v146, 16, v39
v_and_b32 v147, 0xffff0000, v39
v_lshlrev_b32 v148, 16, v40
v_and_b32 v149, 0xffff0000, v40
v_lshlrev_b32 v150, 16, v41
v_and_b32 v151, 0xffff0000, v41
v_lshlrev_b32 v152, 16, v42
v_and_b32 v153, 0xffff0000, v42
v_lshlrev_b32 v154, 16, v43
v_and_b32 v155, 0xffff0000, v43
v_lshlrev_b32 v156, 16, v44
v_and_b32 v157, 0xffff0000, v44
v_lshlrev_b32 v158, 16, v45
v_and_b32 v159, 0xffff0000, v45
v_lshlrev_b32 v160, 16, v46
v_and_b32 v161, 0xffff0000, v46
v_lshlrev_b32 v162, 16, v47
v_and_b32 v163, 0xffff0000, v47
s_waitcnt vmcnt(0)
s_barrier
buffer_atomic_add v12, v10, s[4:7], s92 offen sc1
s_cmp_lg_u32 s28, 0
s_cbranch_scc1 Lpe_17
s_add_u32 s36, s66, 0x10000
s_mov_b32 s37, 0
Lpoll_16:
v_mov_b32 v11, 0
s_mov_b64 exec, 1
buffer_atomic_add v11, off, s[4:7], s36 sc0 sc1
s_waitcnt vmcnt(0)
v_readfirstlane_b32 s38, v11
s_mov_b64 exec, -1
s_nop 0
v_mov_b32 v11, s38
s_add_u32 s37, s37, 1
v_cmp_gt_u32 vcc, 32, v11
s_cbranch_vccz Lpe_17
s_cmp_lt_u32 s37, 0x100000
s_cbranch_scc1 Lpoll_16
Lpe_17:
s_waitcnt vmcnt(0)
s_barrier
L_k2go1:
buffer_load_dwordx4 a[0:3], v4, s[40:43], s35 offen offset:0 sc1
buffer_load_dwordx4 a[4:7], v4, s[40:43], s35 offen offset:1024 sc1
s_cmp_eq_u32 s3, 1
s_cselect_b32 s35, 9, 1
s_lshl_b32 s35, s35, 12
buffer_load_dwordx4 a[8:11], v4, s[40:43], s35 offen offset:0 sc1
buffer_load_dwordx4 a[12:15], v4, s[40:43], s35 offen offset:1024 sc1
s_cmp_eq_u32 s3, 2
s_cselect_b32 s35, 10, 2
s_lshl_b32 s35, s35, 12
buffer_load_dwordx4 a[16:19], v4, s[40:43], s35 offen offset:0 sc1
buffer_load_dwordx4 a[20:23], v4, s[40:43], s35 offen offset:1024 sc1
s_cmp_eq_u32 s3, 3
s_cselect_b32 s35, 11, 3
s_lshl_b32 s35, s35, 12
buffer_load_dwordx4 a[24:27], v4, s[40:43], s35 offen offset:0 sc1
buffer_load_dwordx4 a[28:31], v4, s[40:43], s35 offen offset:1024 sc1
s_cmp_eq_u32 s3, 4
s_cselect_b32 s35, 12, 4
s_lshl_b32 s35, s35, 12
buffer_load_dwordx4 a[32:35], v4, s[40:43], s35 offen offset:0 sc1
buffer_load_dwordx4 a[36:39], v4, s[40:43], s35 offen offset:1024 sc1
s_cmp_eq_u32 s3, 5
s_cselect_b32 s35, 13, 5
s_lshl_b32 s35, s35, 12
ds_read_b128 a[96:99], v5 offset:0
ds_read_b128 a[100:103], v5 offset:1024
ds_read_b128 a[104:107], v5 offset:2048
ds_read_b128 a[108:111], v5 offset:3072
s_waitcnt vmcnt(8) lgkmcnt(0)
v_mfma_f32_16x16x32_bf16 v[132:135], a[96:99], a[0:3], v[132:135]
ds_read_b128 a[112:115], v5 offset:4096
v_mfma_f32_16x16x32_bf16 v[148:151], a[96:99], a[4:7], v[148:151]
ds_read_b128 a[116:119], v5 offset:5120
v_mfma_f32_16x16x32_bf16 v[152:155], a[100:103], a[4:7], v[152:155]
buffer_load_dwordx4 a[40:43], v4, s[40:43], s35 offen offset:0 sc1
v_mfma_f32_16x16x32_bf16 v[136:139], a[100:103], a[0:3], v[136:139]
ds_read_b128 a[120:123], v5 offset:6144
v_mfma_f32_16x16x32_bf16 v[140:143], a[104:107], a[0:3], v[140:143]
ds_read_b128 a[124:127], v5 offset:7168
v_mfma_f32_16x16x32_bf16 v[156:159], a[104:107], a[4:7], v[156:159]
v_mfma_f32_16x16x32_bf16 v[160:163], a[108:111], a[4:7], v[160:163]
buffer_load_dwordx4 a[44:47], v4, s[40:43], s35 offen offset:1024 sc1
v_mfma_f32_16x16x32_bf16 v[144:147], a[108:111], a[0:3], v[144:147]
s_cmp_eq_u32 s3, 6
s_cselect_b32 s35, 14, 6
s_lshl_b32 s35, s35, 12
s_waitcnt vmcnt(8) lgkmcnt(0)
v_mfma_f32_16x16x32_bf16 v[132:135], a[112:115], a[8:11], v[132:135]
ds_read_b128 a[96:99], v5 offset:8192
v_mfma_f32_16x16x32_bf16 v[148:151], a[112:115], a[12:15], v[148:151]
ds_read_b128 a[100:103], v5 offset:9216
v_mfma_f32_16x16x32_bf16 v[152:155], a[116:119], a[12:15], v[152:155]
buffer_load_dwordx4 a[0:3], v4, s[40:43], s35 offen offset:0 sc1
v_mfma_f32_16x16x32_bf16 v[136:139], a[116:119], a[8:11], v[136:139]
ds_read_b128 a[104:107], v5 offset:10240
v_mfma_f32_16x16x32_bf16 v[140:143], a[120:123], a[8:11], v[140:143]
ds_read_b128 a[108:111], v5 offset:11264
v_mfma_f32_16x16x32_bf16 v[156:159], a[120:123], a[12:15], v[156:159]
v_mfma_f32_16x16x32_bf16 v[160:163], a[124:127], a[12:15], v[160:163]
buffer_load_dwordx4 a[4:7], v4, s[40:43], s35 offen offset:1024 sc1
v_mfma_f32_16x16x32_bf16 v[144:147], a[124:127], a[8:11], v[144:147]
s_cmp_eq_u32 s3, 7
s_cselect_b32 s35, 15, 7
s_lshl_b32 s35, s35, 12
s_waitcnt vmcnt(8) lgkmcnt(0)
v_mfma_f32_16x16x32_bf16 v[132:135], a[96:99], a[16:19], v[132:135]
ds_read_b128 a[112:115], v5 offset:12288
v_mfma_f32_16x16x32_bf16 v[148:151], a[96:99], a[20:23], v[148:151]
ds_read_b128 a[116:119], v5 offset:13312
v_mfma_f32_16x16x32_bf16 v[152:155], a[100:103], a[20:23], v[152:155]
buffer_load_dwordx4 a[8:11], v4, s[40:43], s35 offen offset:0 sc1
v_mfma_f32_16x16x32_bf16 v[136:139], a[100:103], a[16:19], v[136:139]
ds_read_b128 a[120:123], v5 offset:14336
v_mfma_f32_16x16x32_bf16 v[140:143], a[104:107], a[16:19], v[140:143]
ds_read_b128 a[124:127], v5 offset:15360
v_mfma_f32_16x16x32_bf16 v[156:159], a[104:107], a[20:23], v[156:159]
v_mfma_f32_16x16x32_bf16 v[160:163], a[108:111], a[20:23], v[160:163]
buffer_load_dwordx4 a[12:15], v4, s[40:43], s35 offen offset:1024 sc1
v_mfma_f32_16x16x32_bf16 v[144:147], a[108:111], a[16:19], v[144:147]
s_cmp_eq_u32 s3, 0
s_cselect_b32 s35, 16, 8
s_lshl_b32 s35, s35, 12
s_waitcnt vmcnt(8) lgkmcnt(0)
v_mfma_f32_16x16x32_bf16 v[132:135], a[112:115], a[24:27], v[132:135]
ds_read_b128 a[96:99], v5 offset:16384
v_mfma_f32_16x16x32_bf16 v[148:151], a[112:115], a[28:31], v[148:151]
ds_read_b128 a[100:103], v5 offset:17408
v_mfma_f32_16x16x32_bf16 v[152:155], a[116:119], a[28:31], v[152:155]
buffer_load_dwordx4 a[16:19], v4, s[40:43], s35 offen offset:0 sc1
v_mfma_f32_16x16x32_bf16 v[136:139], a[116:119], a[24:27], v[136:139]
ds_read_b128 a[104:107], v5 offset:18432
v_mfma_f32_16x16x32_bf16 v[140:143], a[120:123], a[24:27], v[140:143]
ds_read_b128 a[108:111], v5 offset:19456
v_mfma_f32_16x16x32_bf16 v[156:159], a[120:123], a[28:31], v[156:159]
v_mfma_f32_16x16x32_bf16 v[160:163], a[124:127], a[28:31], v[160:163]
buffer_load_dwordx4 a[20:23], v4, s[40:43], s35 offen offset:1024 sc1
v_mfma_f32_16x16x32_bf16 v[144:147], a[124:127], a[24:27], v[144:147]
s_cmp_eq_u32 s3, 1
s_cselect_b32 s35, 17, 9
s_lshl_b32 s35, s35, 12
s_waitcnt vmcnt(8) lgkmcnt(0)
v_mfma_f32_16x16x32_bf16 v[132:135], a[96:99], a[32:35], v[132:135]
ds_read_b128 a[112:115], v5 offset:20480
v_mfma_f32_16x16x32_bf16 v[148:151], a[96:99], a[36:39], v[148:151]
ds_read_b128 a[116:119], v5 offset:21504
v_mfma_f32_16x16x32_bf16 v[152:155], a[100:103], a[36:39], v[152:155]
buffer_load_dwordx4 a[24:27], v4, s[40:43], s35 offen offset:0 sc1
v_mfma_f32_16x16x32_bf16 v[136:139], a[100:103], a[32:35], v[136:139]
ds_read_b128 a[120:123], v5 offset:22528
v_mfma_f32_16x16x32_bf16 v[140:143], a[104:107], a[32:35], v[140:143]
ds_read_b128 a[124:127], v5 offset:23552
v_mfma_f32_16x16x32_bf16 v[156:159], a[104:107], a[36:39], v[156:159]
v_mfma_f32_16x16x32_bf16 v[160:163], a[108:111], a[36:39], v[160:163]
buffer_load_dwordx4 a[28:31], v4, s[40:43], s35 offen offset:1024 sc1
v_mfma_f32_16x16x32_bf16 v[144:147], a[108:111], a[32:35], v[144:147]
s_cmp_eq_u32 s3, 2
s_cselect_b32 s35, 18, 10
s_lshl_b32 s35, s35, 12
s_waitcnt vmcnt(8) lgkmcnt(0)
v_mfma_f32_16x16x32_bf16 v[132:135], a[112:115], a[40:43], v[132:135]
ds_read_b128 a[96:99], v5 offset:24576
v_mfma_f32_16x16x32_bf16 v[148:151], a[112:115], a[44:47], v[148:151]
ds_read_b128 a[100:103], v5 offset:25600
v_mfma_f32_16x16x32_bf16 v[152:155], a[116:119], a[44:47], v[152:155]
buffer_load_dwordx4 a[32:35], v4, s[40:43], s35 offen offset:0 sc1
v_mfma_f32_16x16x32_bf16 v[136:139], a[116:119], a[40:43], v[136:139]
ds_read_b128 a[104:107], v5 offset:26624
v_mfma_f32_16x16x32_bf16 v[140:143], a[120:123], a[40:43], v[140:143]
ds_read_b128 a[108:111], v5 offset:27648
v_mfma_f32_16x16x32_bf16 v[156:159], a[120:123], a[44:47], v[156:159]
v_mfma_f32_16x16x32_bf16 v[160:163], a[124:127], a[44:47], v[160:163]
buffer_load_dwordx4 a[36:39], v4, s[40:43], s35 offen offset:1024 sc1
v_mfma_f32_16x16x32_bf16 v[144:147], a[124:127], a[40:43], v[144:147]
s_cmp_eq_u32 s3, 3
s_cselect_b32 s35, 19, 11
s_lshl_b32 s35, s35, 12
s_waitcnt vmcnt(8) lgkmcnt(0)
v_mfma_f32_16x16x32_bf16 v[132:135], a[96:99], a[0:3], v[132:135]
ds_read_b128 a[112:115], v5 offset:28672
v_mfma_f32_16x16x32_bf16 v[148:151], a[96:99], a[4:7], v[148:151]
ds_read_b128 a[116:119], v5 offset:29696
v_mfma_f32_16x16x32_bf16 v[152:155], a[100:103], a[4:7], v[152:155]
buffer_load_dwordx4 a[40:43], v4, s[40:43], s35 offen offset:0 sc1
v_mfma_f32_16x16x32_bf16 v[136:139], a[100:103], a[0:3], v[136:139]
ds_read_b128 a[120:123], v5 offset:30720
v_mfma_f32_16x16x32_bf16 v[140:143], a[104:107], a[0:3], v[140:143]
ds_read_b128 a[124:127], v5 offset:31744
v_mfma_f32_16x16x32_bf16 v[156:159], a[104:107], a[4:7], v[156:159]
v_mfma_f32_16x16x32_bf16 v[160:163], a[108:111], a[4:7], v[160:163]
buffer_load_dwordx4 a[44:47], v4, s[40:43], s35 offen offset:1024 sc1
v_mfma_f32_16x16x32_bf16 v[144:147], a[108:111], a[0:3], v[144:147]
s_cmp_eq_u32 s3, 4
s_cselect_b32 s35, 20, 12
s_lshl_b32 s35, s35, 12
s_waitcnt vmcnt(8) lgkmcnt(0)
v_mfma_f32_16x16x32_bf16 v[132:135], a[112:115], a[8:11], v[132:135]
ds_read_b128 a[96:99], v5 offset:32768
v_mfma_f32_16x16x32_bf16 v[148:151], a[112:115], a[12:15], v[148:151]
ds_read_b128 a[100:103], v5 offset:33792
v_mfma_f32_16x16x32_bf16 v[152:155], a[116:119], a[12:15], v[152:155]
buffer_load_dwordx4 a[0:3], v4, s[40:43], s35 offen offset:0 sc1
v_mfma_f32_16x16x32_bf16 v[136:139], a[116:119], a[8:11], v[136:139]
ds_read_b128 a[104:107], v5 offset:34816
v_mfma_f32_16x16x32_bf16 v[140:143], a[120:123], a[8:11], v[140:143]
ds_read_b128 a[108:111], v5 offset:35840
v_mfma_f32_16x16x32_bf16 v[156:159], a[120:123], a[12:15], v[156:159]
v_mfma_f32_16x16x32_bf16 v[160:163], a[124:127], a[12:15], v[160:163]
buffer_load_dwordx4 a[4:7], v4, s[40:43], s35 offen offset:1024 sc1
v_mfma_f32_16x16x32_bf16 v[144:147], a[124:127], a[8:11], v[144:147]
s_cmp_eq_u32 s3, 5
s_cselect_b32 s35, 21, 13
s_lshl_b32 s35, s35, 12
s_waitcnt vmcnt(8) lgkmcnt(0)
v_mfma_f32_16x16x32_bf16 v[132:135], a[96:99], a[16:19], v[132:135]
ds_read_b128 a[112:115], v5 offset:36864
v_mfma_f32_16x16x32_bf16 v[148:151], a[96:99], a[20:23], v[148:151]
ds_read_b128 a[116:119], v5 offset:37888
v_mfma_f32_16x16x32_bf16 v[152:155], a[100:103], a[20:23], v[152:155]
buffer_load_dwordx4 a[8:11], v4, s[40:43], s35 offen offset:0 sc1
v_mfma_f32_16x16x32_bf16 v[136:139], a[100:103], a[16:19], v[136:139]
ds_read_b128 a[120:123], v5 offset:38912
v_mfma_f32_16x16x32_bf16 v[140:143], a[104:107], a[16:19], v[140:143]
ds_read_b128 a[124:127], v5 offset:39936
v_mfma_f32_16x16x32_bf16 v[156:159], a[104:107], a[20:23], v[156:159]
v_mfma_f32_16x16x32_bf16 v[160:163], a[108:111], a[20:23], v[160:163]
buffer_load_dwordx4 a[12:15], v4, s[40:43], s35 offen offset:1024 sc1
v_mfma_f32_16x16x32_bf16 v[144:147], a[108:111], a[16:19], v[144:147]
s_cmp_eq_u32 s3, 6
s_cselect_b32 s35, 22, 14
s_lshl_b32 s35, s35, 12
s_waitcnt vmcnt(8) lgkmcnt(0)
v_mfma_f32_16x16x32_bf16 v[132:135], a[112:115], a[24:27], v[132:135]
ds_read_b128 a[96:99], v5 offset:40960
v_mfma_f32_16x16x32_bf16 v[148:151], a[112:115], a[28:31], v[148:151]
ds_read_b128 a[100:103], v5 offset:41984
v_mfma_f32_16x16x32_bf16 v[152:155], a[116:119], a[28:31], v[152:155]
buffer_load_dwordx4 a[16:19], v4, s[40:43], s35 offen offset:0 sc1
v_mfma_f32_16x16x32_bf16 v[136:139], a[116:119], a[24:27], v[136:139]
ds_read_b128 a[104:107], v5 offset:43008
v_mfma_f32_16x16x32_bf16 v[140:143], a[120:123], a[24:27], v[140:143]
ds_read_b128 a[108:111], v5 offset:44032
v_mfma_f32_16x16x32_bf16 v[156:159], a[120:123], a[28:31], v[156:159]
v_mfma_f32_16x16x32_bf16 v[160:163], a[124:127], a[28:31], v[160:163]
buffer_load_dwordx4 a[20:23], v4, s[40:43], s35 offen offset:1024 sc1
v_mfma_f32_16x16x32_bf16 v[144:147], a[124:127], a[24:27], v[144:147]
s_cmp_eq_u32 s3, 7
s_cselect_b32 s35, 23, 15
s_lshl_b32 s35, s35, 12
s_waitcnt vmcnt(8) lgkmcnt(0)
v_mfma_f32_16x16x32_bf16 v[132:135], a[96:99], a[32:35], v[132:135]
ds_read_b128 a[112:115], v5 offset:45056
v_mfma_f32_16x16x32_bf16 v[148:151], a[96:99], a[36:39], v[148:151]
ds_read_b128 a[116:119], v5 offset:46080
v_mfma_f32_16x16x32_bf16 v[152:155], a[100:103], a[36:39], v[152:155]
buffer_load_dwordx4 a[24:27], v4, s[40:43], s35 offen offset:0 sc1
v_mfma_f32_16x16x32_bf16 v[136:139], a[100:103], a[32:35], v[136:139]
ds_read_b128 a[120:123], v5 offset:47104
v_mfma_f32_16x16x32_bf16 v[140:143], a[104:107], a[32:35], v[140:143]
ds_read_b128 a[124:127], v5 offset:48128
v_mfma_f32_16x16x32_bf16 v[156:159], a[104:107], a[36:39], v[156:159]
v_mfma_f32_16x16x32_bf16 v[160:163], a[108:111], a[36:39], v[160:163]
buffer_load_dwordx4 a[28:31], v4, s[40:43], s35 offen offset:1024 sc1
v_mfma_f32_16x16x32_bf16 v[144:147], a[108:111], a[32:35], v[144:147]
s_cmp_eq_u32 s3, 0
s_cselect_b32 s35, 24, 16
s_lshl_b32 s35, s35, 12
s_waitcnt vmcnt(8) lgkmcnt(0)
v_mfma_f32_16x16x32_bf16 v[132:135], a[112:115], a[40:43], v[132:135]
ds_read_b128 a[96:99], v5 offset:49152
v_mfma_f32_16x16x32_bf16 v[148:151], a[112:115], a[44:47], v[148:151]
ds_read_b128 a[100:103], v5 offset:50176
v_mfma_f32_16x16x32_bf16 v[152:155], a[116:119], a[44:47], v[152:155]
buffer_load_dwordx4 a[32:35], v4, s[40:43], s35 offen offset:0 sc1
v_mfma_f32_16x16x32_bf16 v[136:139], a[116:119], a[40:43], v[136:139]
ds_read_b128 a[104:107], v5 offset:51200
v_mfma_f32_16x16x32_bf16 v[140:143], a[120:123], a[40:43], v[140:143]
ds_read_b128 a[108:111], v5 offset:52224
v_mfma_f32_16x16x32_bf16 v[156:159], a[120:123], a[44:47], v[156:159]
v_mfma_f32_16x16x32_bf16 v[160:163], a[124:127], a[44:47], v[160:163]
buffer_load_dwordx4 a[36:39], v4, s[40:43], s35 offen offset:1024 sc1
v_mfma_f32_16x16x32_bf16 v[144:147], a[124:127], a[40:43], v[144:147]
s_cmp_eq_u32 s3, 1
s_cselect_b32 s35, 25, 17
s_lshl_b32 s35, s35, 12
s_waitcnt vmcnt(8) lgkmcnt(0)
v_mfma_f32_16x16x32_bf16 v[132:135], a[96:99], a[0:3], v[132:135]
ds_read_b128 a[112:115], v5 offset:53248
v_mfma_f32_16x16x32_bf16 v[148:151], a[96:99], a[4:7], v[148:151]
ds_read_b128 a[116:119], v5 offset:54272
v_mfma_f32_16x16x32_bf16 v[152:155], a[100:103], a[4:7], v[152:155]
buffer_load_dwordx4 a[40:43], v4, s[40:43], s35 offen offset:0 sc1
v_mfma_f32_16x16x32_bf16 v[136:139], a[100:103], a[0:3], v[136:139]
ds_read_b128 a[120:123], v5 offset:55296
v_mfma_f32_16x16x32_bf16 v[140:143], a[104:107], a[0:3], v[140:143]
ds_read_b128 a[124:127], v5 offset:56320
v_mfma_f32_16x16x32_bf16 v[156:159], a[104:107], a[4:7], v[156:159]
v_mfma_f32_16x16x32_bf16 v[160:163], a[108:111], a[4:7], v[160:163]
buffer_load_dwordx4 a[44:47], v4, s[40:43], s35 offen offset:1024 sc1
v_mfma_f32_16x16x32_bf16 v[144:147], a[108:111], a[0:3], v[144:147]
s_cmp_eq_u32 s3, 2
s_cselect_b32 s35, 26, 18
s_lshl_b32 s35, s35, 12
s_waitcnt vmcnt(8) lgkmcnt(0)
v_mfma_f32_16x16x32_bf16 v[132:135], a[112:115], a[8:11], v[132:135]
ds_read_b128 a[96:99], v5 offset:57344
v_mfma_f32_16x16x32_bf16 v[148:151], a[112:115], a[12:15], v[148:151]
ds_read_b128 a[100:103], v5 offset:58368
v_mfma_f32_16x16x32_bf16 v[152:155], a[116:119], a[12:15], v[152:155]
buffer_load_dwordx4 a[0:3], v4, s[40:43], s35 offen offset:0 sc1
v_mfma_f32_16x16x32_bf16 v[136:139], a[116:119], a[8:11], v[136:139]
ds_read_b128 a[104:107], v5 offset:59392
v_mfma_f32_16x16x32_bf16 v[140:143], a[120:123], a[8:11], v[140:143]
ds_read_b128 a[108:111], v5 offset:60416
v_mfma_f32_16x16x32_bf16 v[156:159], a[120:123], a[12:15], v[156:159]
v_mfma_f32_16x16x32_bf16 v[160:163], a[124:127], a[12:15], v[160:163]
buffer_load_dwordx4 a[4:7], v4, s[40:43], s35 offen offset:1024 sc1
v_mfma_f32_16x16x32_bf16 v[144:147], a[124:127], a[8:11], v[144:147]
s_cmp_eq_u32 s3, 3
s_cselect_b32 s35, 27, 19
s_lshl_b32 s35, s35, 12
s_waitcnt vmcnt(8) lgkmcnt(0)
v_mfma_f32_16x16x32_bf16 v[132:135], a[96:99], a[16:19], v[132:135]
ds_read_b128 a[112:115], v5 offset:61440
v_mfma_f32_16x16x32_bf16 v[148:151], a[96:99], a[20:23], v[148:151]
ds_read_b128 a[116:119], v5 offset:62464
v_mfma_f32_16x16x32_bf16 v[152:155], a[100:103], a[20:23], v[152:155]
buffer_load_dwordx4 a[8:11], v4, s[40:43], s35 offen offset:0 sc1
v_mfma_f32_16x16x32_bf16 v[136:139], a[100:103], a[16:19], v[136:139]
ds_read_b128 a[120:123], v5 offset:63488
v_mfma_f32_16x16x32_bf16 v[140:143], a[104:107], a[16:19], v[140:143]
ds_read_b128 a[124:127], v5 offset:64512
v_mfma_f32_16x16x32_bf16 v[156:159], a[104:107], a[20:23], v[156:159]
v_mfma_f32_16x16x32_bf16 v[160:163], a[108:111], a[20:23], v[160:163]
buffer_load_dwordx4 a[12:15], v4, s[40:43], s35 offen offset:1024 sc1
v_mfma_f32_16x16x32_bf16 v[144:147], a[108:111], a[16:19], v[144:147]
s_cmp_eq_u32 s3, 4
s_cselect_b32 s35, 28, 20
s_lshl_b32 s35, s35, 12
s_waitcnt vmcnt(8) lgkmcnt(0)
v_mfma_f32_16x16x32_bf16 v[132:135], a[112:115], a[24:27], v[132:135]
ds_read_b128 a[96:99], v6 offset:0
v_mfma_f32_16x16x32_bf16 v[148:151], a[112:115], a[28:31], v[148:151]
ds_read_b128 a[100:103], v6 offset:1024
v_mfma_f32_16x16x32_bf16 v[152:155], a[116:119], a[28:31], v[152:155]
buffer_load_dwordx4 a[16:19], v4, s[40:43], s35 offen offset:0 sc1
v_mfma_f32_16x16x32_bf16 v[136:139], a[116:119], a[24:27], v[136:139]
ds_read_b128 a[104:107], v6 offset:2048
v_mfma_f32_16x16x32_bf16 v[140:143], a[120:123], a[24:27], v[140:143]
ds_read_b128 a[108:111], v6 offset:3072
v_mfma_f32_16x16x32_bf16 v[156:159], a[120:123], a[28:31], v[156:159]
v_mfma_f32_16x16x32_bf16 v[160:163], a[124:127], a[28:31], v[160:163]
buffer_load_dwordx4 a[20:23], v4, s[40:43], s35 offen offset:1024 sc1
v_mfma_f32_16x16x32_bf16 v[144:147], a[124:127], a[24:27], v[144:147]
s_cmp_eq_u32 s3, 5
s_cselect_b32 s35, 29, 21
s_lshl_b32 s35, s35, 12
s_waitcnt vmcnt(8) lgkmcnt(0)
v_mfma_f32_16x16x32_bf16 v[132:135], a[96:99], a[32:35], v[132:135]
ds_read_b128 a[112:115], v6 offset:4096
v_mfma_f32_16x16x32_bf16 v[148:151], a[96:99], a[36:39], v[148:151]
ds_read_b128 a[116:119], v6 offset:5120
v_mfma_f32_16x16x32_bf16 v[152:155], a[100:103], a[36:39], v[152:155]
buffer_load_dwordx4 a[24:27], v4, s[40:43], s35 offen offset:0 sc1
v_mfma_f32_16x16x32_bf16 v[136:139], a[100:103], a[32:35], v[136:139]
ds_read_b128 a[120:123], v6 offset:6144
v_mfma_f32_16x16x32_bf16 v[140:143], a[104:107], a[32:35], v[140:143]
ds_read_b128 a[124:127], v6 offset:7168
v_mfma_f32_16x16x32_bf16 v[156:159], a[104:107], a[36:39], v[156:159]
v_mfma_f32_16x16x32_bf16 v[160:163], a[108:111], a[36:39], v[160:163]
buffer_load_dwordx4 a[28:31], v4, s[40:43], s35 offen offset:1024 sc1
v_mfma_f32_16x16x32_bf16 v[144:147], a[108:111], a[32:35], v[144:147]
s_cmp_eq_u32 s3, 6
s_cselect_b32 s35, 30, 22
s_lshl_b32 s35, s35, 12
s_waitcnt vmcnt(8) lgkmcnt(0)
v_mfma_f32_16x16x32_bf16 v[132:135], a[112:115], a[40:43], v[132:135]
ds_read_b128 a[96:99], v6 offset:8192
v_mfma_f32_16x16x32_bf16 v[148:151], a[112:115], a[44:47], v[148:151]
ds_read_b128 a[100:103], v6 offset:9216
v_mfma_f32_16x16x32_bf16 v[152:155], a[116:119], a[44:47], v[152:155]
buffer_load_dwordx4 a[32:35], v4, s[40:43], s35 offen offset:0 sc1
v_mfma_f32_16x16x32_bf16 v[136:139], a[116:119], a[40:43], v[136:139]
ds_read_b128 a[104:107], v6 offset:10240
v_mfma_f32_16x16x32_bf16 v[140:143], a[120:123], a[40:43], v[140:143]
ds_read_b128 a[108:111], v6 offset:11264
v_mfma_f32_16x16x32_bf16 v[156:159], a[120:123], a[44:47], v[156:159]
v_mfma_f32_16x16x32_bf16 v[160:163], a[124:127], a[44:47], v[160:163]
buffer_load_dwordx4 a[36:39], v4, s[40:43], s35 offen offset:1024 sc1
v_mfma_f32_16x16x32_bf16 v[144:147], a[124:127], a[40:43], v[144:147]
s_cmp_eq_u32 s3, 7
s_cselect_b32 s35, 31, 23
s_lshl_b32 s35, s35, 12
s_waitcnt vmcnt(8) lgkmcnt(0)
v_mfma_f32_16x16x32_bf16 v[132:135], a[96:99], a[0:3], v[132:135]
ds_read_b128 a[112:115], v6 offset:12288
v_mfma_f32_16x16x32_bf16 v[148:151], a[96:99], a[4:7], v[148:151]
ds_read_b128 a[116:119], v6 offset:13312
v_mfma_f32_16x16x32_bf16 v[152:155], a[100:103], a[4:7], v[152:155]
buffer_load_dwordx4 a[40:43], v4, s[40:43], s35 offen offset:0 sc1
v_mfma_f32_16x16x32_bf16 v[136:139], a[100:103], a[0:3], v[136:139]
ds_read_b128 a[120:123], v6 offset:14336
v_mfma_f32_16x16x32_bf16 v[140:143], a[104:107], a[0:3], v[140:143]
ds_read_b128 a[124:127], v6 offset:15360
v_mfma_f32_16x16x32_bf16 v[156:159], a[104:107], a[4:7], v[156:159]
v_mfma_f32_16x16x32_bf16 v[160:163], a[108:111], a[4:7], v[160:163]
buffer_load_dwordx4 a[44:47], v4, s[40:43], s35 offen offset:1024 sc1
v_mfma_f32_16x16x32_bf16 v[144:147], a[108:111], a[0:3], v[144:147]
s_cmp_eq_u32 s3, 0
s_cselect_b32 s35, 0, 24
s_lshl_b32 s35, s35, 12
s_waitcnt vmcnt(8) lgkmcnt(0)
v_mfma_f32_16x16x32_bf16 v[132:135], a[112:115], a[8:11], v[132:135]
ds_read_b128 a[96:99], v6 offset:16384
v_mfma_f32_16x16x32_bf16 v[148:151], a[112:115], a[12:15], v[148:151]
ds_read_b128 a[100:103], v6 offset:17408
v_mfma_f32_16x16x32_bf16 v[152:155], a[116:119], a[12:15], v[152:155]
buffer_load_dwordx4 a[0:3], v4, s[40:43], s35 offen offset:0 sc1
v_mfma_f32_16x16x32_bf16 v[136:139], a[116:119], a[8:11], v[136:139]
ds_read_b128 a[104:107], v6 offset:18432
v_mfma_f32_16x16x32_bf16 v[140:143], a[120:123], a[8:11], v[140:143]
ds_read_b128 a[108:111], v6 offset:19456
v_mfma_f32_16x16x32_bf16 v[156:159], a[120:123], a[12:15], v[156:159]
v_mfma_f32_16x16x32_bf16 v[160:163], a[124:127], a[12:15], v[160:163]
buffer_load_dwordx4 a[4:7], v4, s[40:43], s35 offen offset:1024 sc1
v_mfma_f32_16x16x32_bf16 v[144:147], a[124:127], a[8:11], v[144:147]
s_cmp_eq_u32 s3, 1
s_cselect_b32 s35, 1, 25
s_lshl_b32 s35, s35, 12
s_waitcnt vmcnt(8) lgkmcnt(0)
v_mfma_f32_16x16x32_bf16 v[132:135], a[96:99], a[16:19], v[132:135]
ds_read_b128 a[112:115], v6 offset:20480
v_mfma_f32_16x16x32_bf16 v[148:151], a[96:99], a[20:23], v[148:151]
ds_read_b128 a[116:119], v6 offset:21504
v_mfma_f32_16x16x32_bf16 v[152:155], a[100:103], a[20:23], v[152:155]
buffer_load_dwordx4 a[8:11], v4, s[40:43], s35 offen offset:0 sc1
v_mfma_f32_16x16x32_bf16 v[136:139], a[100:103], a[16:19], v[136:139]
ds_read_b128 a[120:123], v6 offset:22528
v_mfma_f32_16x16x32_bf16 v[140:143], a[104:107], a[16:19], v[140:143]
ds_read_b128 a[124:127], v6 offset:23552
v_mfma_f32_16x16x32_bf16 v[156:159], a[104:107], a[20:23], v[156:159]
v_mfma_f32_16x16x32_bf16 v[160:163], a[108:111], a[20:23], v[160:163]
buffer_load_dwordx4 a[12:15], v4, s[40:43], s35 offen offset:1024 sc1
v_mfma_f32_16x16x32_bf16 v[144:147], a[108:111], a[16:19], v[144:147]
s_cmp_eq_u32 s3, 2
s_cselect_b32 s35, 2, 26
s_lshl_b32 s35, s35, 12
s_waitcnt vmcnt(8) lgkmcnt(0)
v_mfma_f32_16x16x32_bf16 v[132:135], a[112:115], a[24:27], v[132:135]
ds_read_b128 a[96:99], v6 offset:24576
v_mfma_f32_16x16x32_bf16 v[148:151], a[112:115], a[28:31], v[148:151]
ds_read_b128 a[100:103], v6 offset:25600
v_mfma_f32_16x16x32_bf16 v[152:155], a[116:119], a[28:31], v[152:155]
buffer_load_dwordx4 a[16:19], v4, s[40:43], s35 offen offset:0 sc1
v_mfma_f32_16x16x32_bf16 v[136:139], a[116:119], a[24:27], v[136:139]
ds_read_b128 a[104:107], v6 offset:26624
v_mfma_f32_16x16x32_bf16 v[140:143], a[120:123], a[24:27], v[140:143]
ds_read_b128 a[108:111], v6 offset:27648
v_mfma_f32_16x16x32_bf16 v[156:159], a[120:123], a[28:31], v[156:159]
v_mfma_f32_16x16x32_bf16 v[160:163], a[124:127], a[28:31], v[160:163]
buffer_load_dwordx4 a[20:23], v4, s[40:43], s35 offen offset:1024 sc1
v_mfma_f32_16x16x32_bf16 v[144:147], a[124:127], a[24:27], v[144:147]
s_cmp_eq_u32 s3, 3
s_cselect_b32 s35, 3, 27
s_lshl_b32 s35, s35, 12
s_waitcnt vmcnt(8) lgkmcnt(0)
v_mfma_f32_16x16x32_bf16 v[132:135], a[96:99], a[32:35], v[132:135]
ds_read_b128 a[112:115], v6 offset:28672
v_mfma_f32_16x16x32_bf16 v[148:151], a[96:99], a[36:39], v[148:151]
ds_read_b128 a[116:119], v6 offset:29696
v_mfma_f32_16x16x32_bf16 v[152:155], a[100:103], a[36:39], v[152:155]
buffer_load_dwordx4 a[24:27], v4, s[40:43], s35 offen offset:0 sc1
v_mfma_f32_16x16x32_bf16 v[136:139], a[100:103], a[32:35], v[136:139]
ds_read_b128 a[120:123], v6 offset:30720
v_mfma_f32_16x16x32_bf16 v[140:143], a[104:107], a[32:35], v[140:143]
ds_read_b128 a[124:127], v6 offset:31744
v_mfma_f32_16x16x32_bf16 v[156:159], a[104:107], a[36:39], v[156:159]
v_mfma_f32_16x16x32_bf16 v[160:163], a[108:111], a[36:39], v[160:163]
buffer_load_dwordx4 a[28:31], v4, s[40:43], s35 offen offset:1024 sc1
v_mfma_f32_16x16x32_bf16 v[144:147], a[108:111], a[32:35], v[144:147]
s_cmp_eq_u32 s3, 4
s_cselect_b32 s35, 4, 28
s_lshl_b32 s35, s35, 12
s_waitcnt vmcnt(8) lgkmcnt(0)
v_mfma_f32_16x16x32_bf16 v[132:135], a[112:115], a[40:43], v[132:135]
ds_read_b128 a[96:99], v6 offset:32768
v_mfma_f32_16x16x32_bf16 v[148:151], a[112:115], a[44:47], v[148:151]
ds_read_b128 a[100:103], v6 offset:33792
v_mfma_f32_16x16x32_bf16 v[152:155], a[116:119], a[44:47], v[152:155]
buffer_load_dwordx4 a[32:35], v4, s[40:43], s35 offen offset:0 sc1
v_mfma_f32_16x16x32_bf16 v[136:139], a[116:119], a[40:43], v[136:139]
ds_read_b128 a[104:107], v6 offset:34816
v_mfma_f32_16x16x32_bf16 v[140:143], a[120:123], a[40:43], v[140:143]
ds_read_b128 a[108:111], v6 offset:35840
v_mfma_f32_16x16x32_bf16 v[156:159], a[120:123], a[44:47], v[156:159]
v_mfma_f32_16x16x32_bf16 v[160:163], a[124:127], a[44:47], v[160:163]
buffer_load_dwordx4 a[36:39], v4, s[40:43], s35 offen offset:1024 sc1
v_mfma_f32_16x16x32_bf16 v[144:147], a[124:127], a[40:43], v[144:147]
s_cmp_eq_u32 s3, 5
s_cselect_b32 s35, 5, 29
s_lshl_b32 s35, s35, 12
s_waitcnt vmcnt(8) lgkmcnt(0)
v_mfma_f32_16x16x32_bf16 v[132:135], a[96:99], a[0:3], v[132:135]
ds_read_b128 a[112:115], v6 offset:36864
v_mfma_f32_16x16x32_bf16 v[148:151], a[96:99], a[4:7], v[148:151]
ds_read_b128 a[116:119], v6 offset:37888
v_mfma_f32_16x16x32_bf16 v[152:155], a[100:103], a[4:7], v[152:155]
buffer_load_dwordx4 a[40:43], v4, s[40:43], s35 offen offset:0 sc1
v_mfma_f32_16x16x32_bf16 v[136:139], a[100:103], a[0:3], v[136:139]
ds_read_b128 a[120:123], v6 offset:38912
v_mfma_f32_16x16x32_bf16 v[140:143], a[104:107], a[0:3], v[140:143]
ds_read_b128 a[124:127], v6 offset:39936
v_mfma_f32_16x16x32_bf16 v[156:159], a[104:107], a[4:7], v[156:159]
v_mfma_f32_16x16x32_bf16 v[160:163], a[108:111], a[4:7], v[160:163]
buffer_load_dwordx4 a[44:47], v4, s[40:43], s35 offen offset:1024 sc1
v_mfma_f32_16x16x32_bf16 v[144:147], a[108:111], a[0:3], v[144:147]
s_cmp_eq_u32 s3, 6
s_cselect_b32 s35, 6, 30
s_lshl_b32 s35, s35, 12
s_waitcnt vmcnt(8) lgkmcnt(0)
v_mfma_f32_16x16x32_bf16 v[132:135], a[112:115], a[8:11], v[132:135]
ds_read_b128 a[96:99], v6 offset:40960
v_mfma_f32_16x16x32_bf16 v[148:151], a[112:115], a[12:15], v[148:151]
ds_read_b128 a[100:103], v6 offset:41984
v_mfma_f32_16x16x32_bf16 v[152:155], a[116:119], a[12:15], v[152:155]
buffer_load_dwordx4 a[0:3], v4, s[40:43], s35 offen offset:0 sc1
v_mfma_f32_16x16x32_bf16 v[136:139], a[116:119], a[8:11], v[136:139]
ds_read_b128 a[104:107], v6 offset:43008
v_mfma_f32_16x16x32_bf16 v[140:143], a[120:123], a[8:11], v[140:143]
ds_read_b128 a[108:111], v6 offset:44032
v_mfma_f32_16x16x32_bf16 v[156:159], a[120:123], a[12:15], v[156:159]
v_mfma_f32_16x16x32_bf16 v[160:163], a[124:127], a[12:15], v[160:163]
buffer_load_dwordx4 a[4:7], v4, s[40:43], s35 offen offset:1024 sc1
v_mfma_f32_16x16x32_bf16 v[144:147], a[124:127], a[8:11], v[144:147]
s_cmp_eq_u32 s3, 7
s_cselect_b32 s35, 7, 31
s_lshl_b32 s35, s35, 12
s_waitcnt vmcnt(8) lgkmcnt(0)
v_mfma_f32_16x16x32_bf16 v[132:135], a[96:99], a[16:19], v[132:135]
ds_read_b128 a[112:115], v6 offset:45056
v_mfma_f32_16x16x32_bf16 v[148:151], a[96:99], a[20:23], v[148:151]
ds_read_b128 a[116:119], v6 offset:46080
v_mfma_f32_16x16x32_bf16 v[152:155], a[100:103], a[20:23], v[152:155]
buffer_load_dwordx4 a[8:11], v4, s[40:43], s35 offen offset:0 sc1
v_mfma_f32_16x16x32_bf16 v[136:139], a[100:103], a[16:19], v[136:139]
ds_read_b128 a[120:123], v6 offset:47104
v_mfma_f32_16x16x32_bf16 v[140:143], a[104:107], a[16:19], v[140:143]
ds_read_b128 a[124:127], v6 offset:48128
v_mfma_f32_16x16x32_bf16 v[156:159], a[104:107], a[20:23], v[156:159]
v_mfma_f32_16x16x32_bf16 v[160:163], a[108:111], a[20:23], v[160:163]
buffer_load_dwordx4 a[12:15], v4, s[40:43], s35 offen offset:1024 sc1
v_mfma_f32_16x16x32_bf16 v[144:147], a[108:111], a[16:19], v[144:147]
s_waitcnt vmcnt(8) lgkmcnt(0)
v_mfma_f32_16x16x32_bf16 v[132:135], a[112:115], a[24:27], v[132:135]
ds_read_b128 a[96:99], v6 offset:49152
v_mfma_f32_16x16x32_bf16 v[148:151], a[112:115], a[28:31], v[148:151]
ds_read_b128 a[100:103], v6 offset:50176
v_mfma_f32_16x16x32_bf16 v[152:155], a[116:119], a[28:31], v[152:155]
ds_read_b128 a[104:107], v6 offset:51200
v_mfma_f32_16x16x32_bf16 v[136:139], a[116:119], a[24:27], v[136:139]
ds_read_b128 a[108:111], v6 offset:52224
v_mfma_f32_16x16x32_bf16 v[140:143], a[120:123], a[24:27], v[140:143]
v_mfma_f32_16x16x32_bf16 v[156:159], a[120:123], a[28:31], v[156:159]
v_mfma_f32_16x16x32_bf16 v[160:163], a[124:127], a[28:31], v[160:163]
v_mfma_f32_16x16x32_bf16 v[144:147], a[124:127], a[24:27], v[144:147]
s_waitcnt vmcnt(6) lgkmcnt(0)
v_mfma_f32_16x16x32_bf16 v[132:135], a[96:99], a[32:35], v[132:135]
ds_read_b128 a[112:115], v6 offset:53248
v_mfma_f32_16x16x32_bf16 v[148:151], a[96:99], a[36:39], v[148:151]
ds_read_b128 a[116:119], v6 offset:54272
v_mfma_f32_16x16x32_bf16 v[152:155], a[100:103], a[36:39], v[152:155]
ds_read_b128 a[120:123], v6 offset:55296
v_mfma_f32_16x16x32_bf16 v[136:139], a[100:103], a[32:35], v[136:139]
ds_read_b128 a[124:127], v6 offset:56320
v_mfma_f32_16x16x32_bf16 v[140:143], a[104:107], a[32:35], v[140:143]
v_mfma_f32_16x16x32_bf16 v[156:159], a[104:107], a[36:39], v[156:159]
v_mfma_f32_16x16x32_bf16 v[160:163], a[108:111], a[36:39], v[160:163]
v_mfma_f32_16x16x32_bf16 v[144:147], a[108:111], a[32:35], v[144:147]
s_waitcnt vmcnt(4) lgkmcnt(0)
v_mfma_f32_16x16x32_bf16 v[132:135], a[112:115], a[40:43], v[132:135]
ds_read_b128 a[96:99], v6 offset:57344
v_mfma_f32_16x16x32_bf16 v[148:151], a[112:115], a[44:47], v[148:151]
ds_read_b128 a[100:103], v6 offset:58368
v_mfma_f32_16x16x32_bf16 v[152:155], a[116:119], a[44:47], v[152:155]
ds_read_b128 a[104:107], v6 offset:59392
v_mfma_f32_16x16x32_bf16 v[136:139], a[116:119], a[40:43], v[136:139]
ds_read_b128 a[108:111], v6 offset:60416
v_mfma_f32_16x16x32_bf16 v[140:143], a[120:123], a[40:43], v[140:143]
v_mfma_f32_16x16x32_bf16 v[156:159], a[120:123], a[44:47], v[156:159]
v_mfma_f32_16x16x32_bf16 v[160:163], a[124:127], a[44:47], v[160:163]
v_mfma_f32_16x16x32_bf16 v[144:147], a[124:127], a[40:43], v[144:147]
s_waitcnt vmcnt(2) lgkmcnt(0)
v_mfma_f32_16x16x32_bf16 v[132:135], a[96:99], a[0:3], v[132:135]
ds_read_b128 a[112:115], v6 offset:61440
v_mfma_f32_16x16x32_bf16 v[148:151], a[96:99], a[4:7], v[148:151]
ds_read_b128 a[116:119], v6 offset:62464
v_mfma_f32_16x16x32_bf16 v[152:155], a[100:103], a[4:7], v[152:155]
ds_read_b128 a[120:123], v6 offset:63488
v_mfma_f32_16x16x32_bf16 v[136:139], a[100:103], a[0:3], v[136:139]
ds_read_b128 a[124:127], v6 offset:64512
v_mfma_f32_16x16x32_bf16 v[140:143], a[104:107], a[0:3], v[140:143]
v_mfma_f32_16x16x32_bf16 v[156:159], a[104:107], a[4:7], v[156:159]
v_mfma_f32_16x16x32_bf16 v[160:163], a[108:111], a[4:7], v[160:163]
v_mfma_f32_16x16x32_bf16 v[144:147], a[108:111], a[0:3], v[144:147]
s_waitcnt vmcnt(0) lgkmcnt(0)
v_mfma_f32_16x16x32_bf16 v[132:135], a[112:115], a[8:11], v[132:135]
v_mfma_f32_16x16x32_bf16 v[148:151], a[112:115], a[12:15], v[148:151]
v_mfma_f32_16x16x32_bf16 v[152:155], a[116:119], a[12:15], v[152:155]
v_mfma_f32_16x16x32_bf16 v[136:139], a[116:119], a[8:11], v[136:139]
v_mfma_f32_16x16x32_bf16 v[140:143], a[120:123], a[8:11], v[140:143]
v_mfma_f32_16x16x32_bf16 v[156:159], a[120:123], a[12:15], v[156:159]
v_mfma_f32_16x16x32_bf16 v[160:163], a[124:127], a[12:15], v[160:163]
v_mfma_f32_16x16x32_bf16 v[144:147], a[124:127], a[8:11], v[144:147]
s_nop 0
v_cvt_pk_bf16_f32 v32, v132, v133
v_cvt_pk_bf16_f32 v33, v134, v135
s_nop 0
v_cvt_pk_bf16_f32 v34, v136, v137
v_cvt_pk_bf16_f32 v35, v138, v139
v_cvt_pk_bf16_f32 v36, v140, v141
v_cvt_pk_bf16_f32 v37, v142, v143
v_cvt_pk_bf16_f32 v38, v144, v145
v_cvt_pk_bf16_f32 v39, v146, v147
v_cvt_pk_bf16_f32 v40, v148, v149
v_cvt_pk_bf16_f32 v41, v150, v151
v_cvt_pk_bf16_f32 v42, v152, v153
v_cvt_pk_bf16_f32 v43, v154, v155
v_cvt_pk_bf16_f32 v44, v156, v157
v_cvt_pk_bf16_f32 v45, v158, v159
v_cvt_pk_bf16_f32 v46, v160, v161
v_cvt_pk_bf16_f32 v47, v162, v163
s_lshl_b32 s36, s32, 13
s_add_u32 s36, s36, 0x0
s_add_u32 s37, s36, 4096
s_mov_b32 s38, 0x280000
v_mfma_f32_16x16x32_bf16 v[96:99], v[32:35], v[32:35], 0
v_mfma_f32_16x16x32_bf16 v[92:95], v[16:19], v[32:35], 0
buffer_store_dwordx4 v[32:35], v4, s[12:15], s36 offen offset:0 sc1
v_mfma_f32_16x16x32_bf16 v[104:107], v[40:43], v[40:43], 0
v_mfma_f32_16x16x32_bf16 v[100:103], v[16:19], v[40:43], 0
buffer_store_dwordx4 v[40:43], v4, s[12:15], s36 offen offset:1024 sc1
v_mfma_f32_16x16x32_bf16 v[96:99], v[36:39], v[36:39], v[96:99]
v_mfma_f32_16x16x32_bf16 v[92:95], v[16:19], v[36:39], v[92:95]
buffer_store_dwordx4 v[36:39], v4, s[12:15], s37 offen offset:0 sc1
v_mfma_f32_16x16x32_bf16 v[104:107], v[44:47], v[44:47], v[104:107]
v_mfma_f32_16x16x32_bf16 v[100:103], v[16:19], v[44:47], v[100:103]
buffer_store_dwordx4 v[44:47], v4, s[12:15], s37 offen offset:1024 sc1
s_nop 2
v_cndmask_b32 v96, v96, v97, s[46:47]
v_cndmask_b32 v98, v98, v99, s[46:47]
v_cndmask_b32 v93, v96, v98, s[48:49]
buffer_store_dwordx2 v[92:93], v253, s[4:7], s38 offen offset:0 sc1
v_cndmask_b32 v104, v104, v105, s[46:47]
v_cndmask_b32 v106, v106, v107, s[46:47]
v_cndmask_b32 v101, v104, v106, s[48:49]
buffer_store_dwordx2 v[100:101], v253, s[4:7], s38 offen offset:2048 sc1
s_add_u32 s92, s78, 0x50000
s_add_u32 s93, s79, 0x50000
s_mov_b64 s[40:41], s[12:13]
s_barrier
s_add_u32 s44, s28, 0
s_mul_i32 s45, s44, 3072
s_add_u32 m0, s45, 0
s_lshr_b32 s44, s44, 1
s_add_u32 s44, s44, 0
s_add_u32 s44, s44, s33
s_and_b32 s44, s44, 31
s_mul_i32 s44, s44, 6144
s_add_u32 s44, s44, s50
buffer_load_dwordx4 v1, s[4:7], s44 offen offset:0 sc1 lds
buffer_load_dwordx4 v1, s[4:7], s44 offen offset:1024 sc1 lds
buffer_load_dwordx4 v1, s[4:7], s44 offen offset:2048 sc1 lds
s_add_u32 s44, s28, 4
s_mul_i32 s45, s44, 3072
s_add_u32 m0, s45, 0
s_lshr_b32 s44, s44, 1
s_add_u32 s44, s44, 0
s_add_u32 s44, s44, s33
s_and_b32 s44, s44, 31
s_mul_i32 s44, s44, 6144
s_add_u32 s44, s44, s50
buffer_load_dwordx4 v1, s[4:7], s44 offen offset:0 sc1 lds
buffer_load_dwordx4 v1, s[4:7], s44 offen offset:1024 sc1 lds
buffer_load_dwordx4 v1, s[4:7], s44 offen offset:2048 sc1 lds
s_add_u32 s44, s28, 8
s_mul_i32 s45, s44, 3072
s_add_u32 m0, s45, 0
s_lshr_b32 s44, s44, 1
s_add_u32 s44, s44, 0
s_add_u32 s44, s44, s33
s_and_b32 s44, s44, 31
s_mul_i32 s44, s44, 6144
s_add_u32 s44, s44, s50
buffer_load_dwordx4 v1, s[4:7], s44 offen offset:0 sc1 lds
buffer_load_dwordx4 v1, s[4:7], s44 offen offset:1024 sc1 lds
buffer_load_dwordx4 v1, s[4:7], s44 offen offset:2048 sc1 lds
s_add_u32 s44, s28, 12
s_mul_i32 s45, s44, 3072
s_add_u32 m0, s45, 0
s_lshr_b32 s44, s44, 1
s_add_u32 s44, s44, 0
s_add_u32 s44, s44, s33
s_and_b32 s44, s44, 31
s_mul_i32 s44, s44, 6144
s_add_u32 s44, s44, s50
buffer_load_dwordx4 v1, s[4:7], s44 offen offset:0 sc1 lds
buffer_load_dwordx4 v1, s[4:7], s44 offen offset:1024 sc1 lds
buffer_load_dwordx4 v1, s[4:7], s44 offen offset:2048 sc1 lds
s_waitcnt vmcnt(12)
s_barrier
buffer_atomic_add v12, v10, s[4:7], s92 offen sc1
buffer_atomic_add v12, v10, s[4:7], s93 offen sc1
s_cmp_lt_u32 s28, 2
s_cbranch_scc1 Lwd_18
s_add_u32 s44, s28, 0
s_mul_i32 s45, s44, 3072
s_add_u32 m0, s45, 49152
s_lshr_b32 s44, s44, 1
s_add_u32 s44, s44, 8
s_add_u32 s44, s44, s33
s_and_b32 s44, s44, 31
s_mul_i32 s44, s44, 6144
s_add_u32 s44, s44, s50
buffer_load_dwordx4 v1, s[4:7], s44 offen offset:0 sc1 lds
buffer_load_dwordx4 v1, s[4:7], s44 offen offset:1024 sc1 lds
buffer_load_dwordx4 v1, s[4:7], s44 offen offset:2048 sc1 lds
s_sub_u32 s44, s28, 2
s_mul_i32 s45, s44, 3072
s_add_u32 m0, s45, 49152
s_lshr_b32 s44, s44, 1
s_add_u32 s44, s44, 8
s_add_u32 s44, s44, s33
s_and_b32 s44, s44, 31
s_mul_i32 s44, s44, 6144
s_add_u32 s44, s44, s50
buffer_load_dwordx4 v1, s[4:7], s44 offen offset:0 sc1 lds
buffer_load_dwordx4 v1, s[4:7], s44 offen offset:1024 sc1 lds
buffer_load_dwordx4 v1, s[4:7], s44 offen offset:2048 sc1 lds
s_add_u32 s44, s28, 4
s_mul_i32 s45, s44, 3072
s_add_u32 m0, s45, 49152
s_lshr_b32 s44, s44, 1
s_add_u32 s44, s44, 8
s_add_u32 s44, s44, s33
s_and_b32 s44, s44, 31
s_mul_i32 s44, s44, 6144
s_add_u32 s44, s44, s50
buffer_load_dwordx4 v1, s[4:7], s44 offen offset:0 sc1 lds
buffer_load_dwordx4 v1, s[4:7], s44 offen offset:1024 sc1 lds
buffer_load_dwordx4 v1, s[4:7], s44 offen offset:2048 sc1 lds
s_add_u32 s44, s28, 2
s_mul_i32 s45, s44, 3072
s_add_u32 m0, s45, 49152
s_lshr_b32 s44, s44, 1
s_add_u32 s44, s44, 8
s_add_u32 s44, s44, s33
s_and_b32 s44, s44, 31
s_mul_i32 s44, s44, 6144
s_add_u32 s44, s44, s50
buffer_load_dwordx4 v1, s[4:7], s44 offen offset:0 sc1 lds
buffer_load_dwordx4 v1, s[4:7], s44 offen offset:1024 sc1 lds
buffer_load_dwordx4 v1, s[4:7], s44 offen offset:2048 sc1 lds
s_add_u32 s44, s28, 8
s_mul_i32 s45, s44, 3072
s_add_u32 m0, s45, 49152
s_lshr_b32 s44, s44, 1
s_add_u32 s44, s44, 8
s_add_u32 s44, s44, s33
s_and_b32 s44, s44, 31
s_mul_i32 s44, s44, 6144
s_add_u32 s44, s44, s50
buffer_load_dwordx4 v1, s[4:7], s44 offen offset:0 sc1 lds
buffer_load_dwordx4 v1, s[4:7], s44 offen offset:1024 sc1 lds
buffer_load_dwordx4 v1, s[4:7], s44 offen offset:2048 sc1 lds
s_add_u32 s44, s28, 6
s_mul_i32 s45, s44, 3072
s_add_u32 m0, s45, 49152
s_lshr_b32 s44, s44, 1
s_add_u32 s44, s44, 8
s_add_u32 s44, s44, s33
s_and_b32 s44, s44, 31
s_mul_i32 s44, s44, 6144
s_add_u32 s44, s44, s50
buffer_load_dwordx4 v1, s[4:7], s44 offen offset:0 sc1 lds
buffer_load_dwordx4 v1, s[4:7], s44 offen offset:1024 sc1 lds
buffer_load_dwordx4 v1, s[4:7], s44 offen offset:2048 sc1 lds
s_add_u32 s44, s28, 12
s_mul_i32 s45, s44, 3072
s_add_u32 m0, s45, 49152
s_lshr_b32 s44, s44, 1
s_add_u32 s44, s44, 8
s_add_u32 s44, s44, s33
s_and_b32 s44, s44, 31
s_mul_i32 s44, s44, 6144
s_add_u32 s44, s44, s50
buffer_load_dwordx4 v1, s[4:7], s44 offen offset:0 sc1 lds
buffer_load_dwordx4 v1, s[4:7], s44 offen offset:1024 sc1 lds
buffer_load_dwordx4 v1, s[4:7], s44 offen offset:2048 sc1 lds
s_add_u32 s44, s28, 10
s_mul_i32 s45, s44, 3072
s_add_u32 m0, s45, 49152
s_lshr_b32 s44, s44, 1
s_add_u32 s44, s44, 8
s_add_u32 s44, s44, s33
s_and_b32 s44, s44, 31
s_mul_i32 s44, s44, 6144
s_add_u32 s44, s44, s50
buffer_load_dwordx4 v1, s[4:7], s44 offen offset:0 sc1 lds
buffer_load_dwordx4 v1, s[4:7], s44 offen offset:1024 sc1 lds
buffer_load_dwordx4 v1, s[4:7], s44 offen offset:2048 sc1 lds
Lwd_18:
s_cmp_lg_u32 s28, 0
s_cbranch_scc1 Lpe_20
s_add_u32 s36, s67, 0x50000
s_mov_b32 s37, 0
Lpoll_19:
v_mov_b32 v11, 0
s_mov_b64 exec, 1
buffer_atomic_add v11, off, s[4:7], s36 sc0 sc1
s_waitcnt vmcnt(0)
v_readfirstlane_b32 s38, v11
s_mov_b64 exec, -1
s_nop 0
v_mov_b32 v11, s38
s_add_u32 s37, s37, 1
v_cmp_gt_u32 vcc, s54, v11
s_cbranch_vccz Lpe_20
s_cmp_lt_u32 s37, 0x100000
s_cbranch_scc1 Lpoll_19
Lpe_20:
s_waitcnt vmcnt(24)
s_cmp_ge_u32 s28, 2
s_cbranch_scc1 Lw_21
s_waitcnt vmcnt(0)
Lw_21:
s_barrier
s_add_u32 s94, s71, 0x20080
s_lshl_b32 s35, s33, 12
buffer_load_dwordx4 a[0:3], v2, s[40:43], s35 offen offset:0 sc1
buffer_load_dwordx4 a[4:7], v2, s[40:43], s35 offen offset:1024 sc1
buffer_load_dwordx4 a[8:11], v2, s[40:43], s35 offen offset:2048 sc1
buffer_load_dwordx4 a[12:15], v2, s[40:43], s35 offen offset:3072 sc1
s_add_u32 s35, s35, 4096
s_and_b32 s35, s35, 0x1ffff
s_add_u32 s63, s28, 0
s_add_u32 s63, s63, s33
s_and_b32 s63, s63, 31
s_lshl_b32 s63, s63, 12
buffer_load_dwordx4 a[64:67], v3, s[40:43], s63 offen sc1
buffer_load_dwordx4 a[16:19], v2, s[40:43], s35 offen offset:0 sc1
buffer_load_dwordx4 a[20:23], v2, s[40:43], s35 offen offset:1024 sc1
buffer_load_dwordx4 a[24:27], v2, s[40:43], s35 offen offset:2048 sc1
buffer_load_dwordx4 a[28:31], v2, s[40:43], s35 offen offset:3072 sc1
s_add_u32 s35, s35, 4096
s_and_b32 s35, s35, 0x1ffff
buffer_load_dwordx4 a[32:35], v2, s[40:43], s35 offen offset:0 sc1
buffer_load_dwordx4 a[36:39], v2, s[40:43], s35 offen offset:1024 sc1
buffer_load_dwordx4 a[40:43], v2, s[40:43], s35 offen offset:2048 sc1
buffer_load_dwordx4 a[44:47], v2, s[40:43], s35 offen offset:3072 sc1
s_add_u32 s35, s35, 4096
s_and_b32 s35, s35, 0x1ffff
v_add_u32 v5, 0, v1
v_add_u32 v6, s55, v5
ds_read_b128 a[96:99], v5 offset:0
ds_read_b128 a[100:103], v5 offset:1024
ds_read_b128 a[104:107], v5 offset:2048
ds_read_b128 a[108:111], v5 offset:3072
ds_read_b128 a[112:115], v5 offset:4096
ds_read_b128 a[116:119], v5 offset:5120
ds_read_b128 a[120:123], v6 offset:2048
s_waitcnt vmcnt(8) lgkmcnt(0)
v_mfma_f32_16x16x32_bf16 v[132:135], a[96:99], a[0:3], 0
s_add_u32 s44, s28, 0
s_mul_i32 s45, s44, 3072
s_add_u32 m0, s45, 98304
v_mfma_f32_16x16x32_bf16 v[156:159], a[96:99], a[4:7], 0
buffer_load_dwordx4 a[48:51], v2, s[40:43], s35 offen offset:0 sc1
s_lshr_b32 s44, s44, 1
v_mfma_f32_16x16x32_bf16 v[180:183], a[96:99], a[8:11], 0
s_add_u32 s44, s44, 16
s_add_u32 s44, s44, s33
s_and_b32 s44, s44, 31
v_mfma_f32_16x16x32_bf16 v[204:207], a[96:99], a[12:15], 0
s_mul_i32 s44, s44, 6144
s_add_u32 s44, s44, s50
v_mfma_f32_16x16x32_bf16 v[208:211], a[100:103], a[12:15], 0
buffer_load_dwordx4 v1, s[4:7], s44 offen offset:0 sc1 lds
v_mfma_f32_16x16x32_bf16 v[184:187], a[100:103], a[8:11], 0
ds_read_b128 a[128:131], v5 offset:6144
v_mfma_f32_16x16x32_bf16 v[160:163], a[100:103], a[4:7], 0
ds_read_b128 a[132:135], v5 offset:7168
v_mfma_f32_16x16x32_bf16 v[136:139], a[100:103], a[0:3], 0
ds_read_b128 a[136:139], v5 offset:8192
v_mfma_f32_16x16x32_bf16 v[140:143], a[104:107], a[0:3], 0
buffer_load_dwordx4 a[52:55], v2, s[40:43], s35 offen offset:1024 sc1
v_mfma_f32_16x16x32_bf16 v[164:167], a[104:107], a[4:7], 0
ds_read_b128 a[140:143], v5 offset:9216
v_mfma_f32_16x16x32_bf16 v[188:191], a[104:107], a[8:11], 0
ds_read_b128 a[144:147], v5 offset:10240
v_mfma_f32_16x16x32_bf16 v[212:215], a[104:107], a[12:15], 0
buffer_load_dwordx4 v1, s[4:7], s44 offen offset:1024 sc1 lds
s_add_u32 s63, s28, 4
v_mfma_f32_16x16x32_bf16 v[216:219], a[108:111], a[12:15], 0
s_add_u32 s63, s63, s33
s_and_b32 s63, s63, 31
s_lshl_b32 s63, s63, 12
v_mfma_f32_16x16x32_bf16 v[192:195], a[108:111], a[8:11], 0
ds_read_b128 a[148:151], v5 offset:11264
v_mfma_f32_16x16x32_bf16 v[168:171], a[108:111], a[4:7], 0
ds_read_b128 a[152:155], v6 offset:3072
v_mfma_f32_16x16x32_bf16 v[144:147], a[108:111], a[0:3], 0
buffer_load_dwordx4 a[56:59], v2, s[40:43], s35 offen offset:2048 sc1
v_mfma_f32_16x16x32_bf16 v[148:151], a[112:115], a[0:3], 0
v_mfma_f32_16x16x32_bf16 v[172:175], a[112:115], a[4:7], 0
v_mfma_f32_16x16x32_bf16 v[196:199], a[112:115], a[8:11], 0
buffer_load_dwordx4 a[68:71], v3, s[40:43], s63 offen sc1
v_mfma_f32_16x16x32_bf16 v[220:223], a[112:115], a[12:15], 0
v_mfma_f32_16x16x32_bf16 v[224:227], a[116:119], a[12:15], 0
v_mfma_f32_16x16x32_bf16 v[200:203], a[116:119], a[8:11], 0
v_mfma_f32_16x16x32_bf16 v[176:179], a[116:119], a[4:7], 0
buffer_load_dwordx4 a[60:63], v2, s[40:43], s35 offen offset:3072 sc1
s_add_u32 s35, s35, 4096
v_mfma_f32_16x16x32_bf16 v[152:155], a[116:119], a[0:3], 0
s_and_b32 s35, s35, 0x1ffff
v_mfma_f32_16x16x32_bf16 a[80:83], a[120:123], a[64:67], 0
s_waitcnt vmcnt(11) lgkmcnt(0)
v_mfma_f32_16x16x32_bf16 v[132:135], a[128:131], a[16:19], v[132:135]
ds_read_b128 a[96:99], v5 offset:12288
v_mfma_f32_16x16x32_bf16 v[156:159], a[128:131], a[20:23], v[156:159]
buffer_load_dwordx4 a[0:3], v2, s[40:43], s35 offen offset:0 sc1
v_mfma_f32_16x16x32_bf16 v[180:183], a[128:131], a[24:27], v[180:183]
ds_read_b128 a[100:103], v5 offset:13312
v_mfma_f32_16x16x32_bf16 v[204:207], a[128:131], a[28:31], v[204:207]
v_mfma_f32_16x16x32_bf16 v[208:211], a[132:135], a[28:31], v[208:211]
ds_read_b128 a[104:107], v5 offset:14336
v_mfma_f32_16x16x32_bf16 v[184:187], a[132:135], a[24:27], v[184:187]
buffer_load_dwordx4 v1, s[4:7], s44 offen offset:2048 sc1 lds
s_add_u32 s44, s28, 4
v_mfma_f32_16x16x32_bf16 v[160:163], a[132:135], a[20:23], v[160:163]
s_mul_i32 s45, s44, 3072
s_add_u32 m0, s45, 98304
s_lshr_b32 s44, s44, 1
v_mfma_f32_16x16x32_bf16 v[136:139], a[132:135], a[16:19], v[136:139]
s_add_u32 s44, s44, 16
s_add_u32 s44, s44, s33
s_and_b32 s44, s44, 31
v_mfma_f32_16x16x32_bf16 v[140:143], a[136:139], a[16:19], v[140:143]
s_mul_i32 s44, s44, 6144
s_add_u32 s44, s44, s50
v_mfma_f32_16x16x32_bf16 v[164:167], a[136:139], a[20:23], v[164:167]
buffer_load_dwordx4 a[4:7], v2, s[40:43], s35 offen offset:1024 sc1
v_mfma_f32_16x16x32_bf16 v[188:191], a[136:139], a[24:27], v[188:191]
ds_read_b128 a[108:111], v5 offset:15360
v_mfma_f32_16x16x32_bf16 v[212:215], a[136:139], a[28:31], v[212:215]
ds_read_b128 a[112:115], v5 offset:16384
v_mfma_f32_16x16x32_bf16 v[216:219], a[140:143], a[28:31], v[216:219]
ds_read_b128 a[116:119], v5 offset:17408
v_mfma_f32_16x16x32_bf16 v[192:195], a[140:143], a[24:27], v[192:195]
buffer_load_dwordx4 a[8:11], v2, s[40:43], s35 offen offset:2048 sc1
v_mfma_f32_16x16x32_bf16 v[168:171], a[140:143], a[20:23], v[168:171]
ds_read_b128 a[120:123], v6 offset:4096
v_mfma_f32_16x16x32_bf16 v[144:147], a[140:143], a[16:19], v[144:147]
v_mfma_f32_16x16x32_bf16 v[148:151], a[144:147], a[16:19], v[148:151]
v_mfma_f32_16x16x32_bf16 v[172:175], a[144:147], a[20:23], v[172:175]
buffer_load_dwordx4 v1, s[4:7], s44 offen offset:0 sc1 lds
v_mfma_f32_16x16x32_bf16 v[196:199], a[144:147], a[24:27], v[196:199]
v_mfma_f32_16x16x32_bf16 v[220:223], a[144:147], a[28:31], v[220:223]
v_mfma_f32_16x16x32_bf16 v[224:227], a[148:151], a[28:31], v[224:227]
v_mfma_f32_16x16x32_bf16 v[200:203], a[148:151], a[24:27], v[200:203]
buffer_load_dwordx4 a[12:15], v2, s[40:43], s35 offen offset:3072 sc1
s_add_u32 s35, s35, 4096
v_mfma_f32_16x16x32_bf16 v[176:179], a[148:151], a[20:23], v[176:179]
s_and_b32 s35, s35, 0x1ffff
v_mfma_f32_16x16x32_bf16 v[152:155], a[148:151], a[16:19], v[152:155]
v_mfma_f32_16x16x32_bf16 a[84:87], a[152:155], a[64:67], 0
s_waitcnt vmcnt(13) lgkmcnt(0)
v_mfma_f32_16x16x32_bf16 v[132:135], a[96:99], a[32:35], v[132:135]
ds_read_b128 a[128:131], v5 offset:18432
v_mfma_f32_16x16x32_bf16 v[156:159], a[96:99], a[36:39], v[156:159]
buffer_load_dwordx4 a[16:19], v2, s[40:43], s35 offen offset:0 sc1
v_mfma_f32_16x16x32_bf16 v[180:183], a[96:99], a[40:43], v[180:183]
ds_read_b128 a[132:135], v5 offset:19456
v_mfma_f32_16x16x32_bf16 v[204:207], a[96:99], a[44:47], v[204:207]
v_mfma_f32_16x16x32_bf16 v[208:211], a[100:103], a[44:47], v[208:211]
ds_read_b128 a[136:139], v5 offset:20480
v_mfma_f32_16x16x32_bf16 v[184:187], a[100:103], a[40:43], v[184:187]
v_mfma_f32_16x16x32_bf16 v[160:163], a[100:103], a[36:39], v[160:163]
buffer_load_dwordx4 a[20:23], v2, s[40:43], s35 offen offset:1024 sc1
v_mfma_f32_16x16x32_bf16 v[136:139], a[100:103], a[32:35], v[136:139]
ds_read_b128 a[140:143], v5 offset:21504
v_mfma_f32_16x16x32_bf16 v[140:143], a[104:107], a[32:35], v[140:143]
v_mfma_f32_16x16x32_bf16 v[164:167], a[104:107], a[36:39], v[164:167]
ds_read_b128 a[144:147], v5 offset:22528
v_mfma_f32_16x16x32_bf16 v[188:191], a[104:107], a[40:43], v[188:191]
v_mfma_f32_16x16x32_bf16 v[212:215], a[104:107], a[44:47], v[212:215]
buffer_load_dwordx4 v1, s[4:7], s44 offen offset:1024 sc1 lds
v_mfma_f32_16x16x32_bf16 v[216:219], a[108:111], a[44:47], v[216:219]
ds_read_b128 a[148:151], v5 offset:23552
v_mfma_f32_16x16x32_bf16 v[192:195], a[108:111], a[40:43], v[192:195]
ds_read_b128 a[152:155], v6 offset:5120
v_mfma_f32_16x16x32_bf16 v[168:171], a[108:111], a[36:39], v[168:171]
v_mfma_f32_16x16x32_bf16 v[144:147], a[108:111], a[32:35], v[144:147]
v_mfma_f32_16x16x32_bf16 v[148:151], a[112:115], a[32:35], v[148:151]
buffer_load_dwordx4 a[24:27], v2, s[40:43], s35 offen offset:2048 sc1
v_mfma_f32_16x16x32_bf16 v[172:175], a[112:115], a[36:39], v[172:175]
v_mfma_f32_16x16x32_bf16 v[196:199], a[112:115], a[40:43], v[196:199]
v_mfma_f32_16x16x32_bf16 v[220:223], a[112:115], a[44:47], v[220:223]
v_mfma_f32_16x16x32_bf16 v[224:227], a[116:119], a[44:47], v[224:227]
v_mfma_f32_16x16x32_bf16 v[200:203], a[116:119], a[40:43], v[200:203]
buffer_load_dwordx4 a[28:31], v2, s[40:43], s35 offen offset:3072 sc1
s_add_u32 s35, s35, 4096
v_mfma_f32_16x16x32_bf16 v[176:179], a[116:119], a[36:39], v[176:179]
s_and_b32 s35, s35, 0x1ffff
v_mfma_f32_16x16x32_bf16 v[152:155], a[116:119], a[32:35], v[152:155]
v_mfma_f32_16x16x32_bf16 a[88:91], a[120:123], a[64:67], 0
s_waitcnt vmcnt(11) lgkmcnt(0)
v_mfma_f32_16x16x32_bf16 v[132:135], a[128:131], a[48:51], v[132:135]
ds_read_b128 a[96:99], v5 offset:24576
v_mfma_f32_16x16x32_bf16 v[156:159], a[128:131], a[52:55], v[156:159]
buffer_load_dwordx4 a[32:35], v2, s[40:43], s35 offen offset:0 sc1
v_mfma_f32_16x16x32_bf16 v[180:183], a[128:131], a[56:59], v[180:183]
ds_read_b128 a[100:103], v5 offset:25600
v_mfma_f32_16x16x32_bf16 v[204:207], a[128:131], a[60:63], v[204:207]
v_mfma_f32_16x16x32_bf16 v[208:211], a[132:135], a[60:63], v[208:211]
ds_read_b128 a[104:107], v5 offset:26624
v_mfma_f32_16x16x32_bf16 v[184:187], a[132:135], a[56:59], v[184:187]
buffer_load_dwordx4 v1, s[4:7], s44 offen offset:2048 sc1 lds
s_add_u32 s44, s28, 8
v_mfma_f32_16x16x32_bf16 v[160:163], a[132:135], a[52:55], v[160:163]
s_mul_i32 s45, s44, 3072
s_add_u32 m0, s45, 98304
s_lshr_b32 s44, s44, 1
v_mfma_f32_16x16x32_bf16 v[136:139], a[132:135], a[48:51], v[136:139]
s_add_u32 s44, s44, 16
s_add_u32 s44, s44, s33
s_and_b32 s44, s44, 31
v_mfma_f32_16x16x32_bf16 v[140:143], a[136:139], a[48:51], v[140:143]
s_mul_i32 s44, s44, 6144
s_add_u32 s44, s44, s50
v_mfma_f32_16x16x32_bf16 v[164:167], a[136:139], a[52:55], v[164:167]
buffer_load_dwordx4 a[36:39], v2, s[40:43], s35 offen offset:1024 sc1
v_mfma_f32_16x16x32_bf16 v[188:191], a[136:139], a[56:59], v[188:191]
ds_read_b128 a[108:111], v5 offset:27648
v_mfma_f32_16x16x32_bf16 v[212:215], a[136:139], a[60:63], v[212:215]
ds_read_b128 a[112:115], v5 offset:28672
v_mfma_f32_16x16x32_bf16 v[216:219], a[140:143], a[60:63], v[216:219]
ds_read_b128 a[116:119], v5 offset:29696
v_mfma_f32_16x16x32_bf16 v[192:195], a[140:143], a[56:59], v[192:195]
buffer_load_dwordx4 a[40:43], v2, s[40:43], s35 offen offset:2048 sc1
v_mfma_f32_16x16x32_bf16 v[168:171], a[140:143], a[52:55], v[168:171]
ds_read_b128 a[120:123], v6 offset:26624
v_mfma_f32_16x16x32_bf16 v[144:147], a[140:143], a[48:51], v[144:147]
v_mfma_f32_16x16x32_bf16 v[148:151], a[144:147], a[48:51], v[148:151]
v_mfma_f32_16x16x32_bf16 v[172:175], a[144:147], a[52:55], v[172:175]
buffer_load_dwordx4 v1, s[4:7], s44 offen offset:0 sc1 lds
v_mfma_f32_16x16x32_bf16 v[196:199], a[144:147], a[56:59], v[196:199]
v_mfma_f32_16x16x32_bf16 v[220:223], a[144:147], a[60:63], v[220:223]
v_mfma_f32_16x16x32_bf16 v[224:227], a[148:151], a[60:63], v[224:227]
v_mfma_f32_16x16x32_bf16 v[200:203], a[148:151], a[56:59], v[200:203]
buffer_load_dwordx4 a[44:47], v2, s[40:43], s35 offen offset:3072 sc1
s_add_u32 s35, s35, 4096
v_mfma_f32_16x16x32_bf16 v[176:179], a[148:151], a[52:55], v[176:179]
s_and_b32 s35, s35, 0x1ffff
v_mfma_f32_16x16x32_bf16 v[152:155], a[148:151], a[48:51], v[152:155]
v_mfma_f32_16x16x32_bf16 a[92:95], a[152:155], a[64:67], 0
s_waitcnt vmcnt(11) lgkmcnt(0)
v_mfma_f32_16x16x32_bf16 v[132:135], a[96:99], a[0:3], v[132:135]
ds_read_b128 a[128:131], v5 offset:30720
v_accvgpr_read_b32 v48, a160
v_mfma_f32_16x16x32_bf16 v[156:159], a[96:99], a[4:7], v[156:159]
buffer_load_dwordx4 a[48:51], v2, s[40:43], s35 offen offset:0 sc1
v_mfma_f32_16x16x32_bf16 v[180:183], a[96:99], a[8:11], v[180:183]
ds_read_b128 a[132:135], v5 offset:31744
v_mfma_f32_16x16x32_bf16 v[204:207], a[96:99], a[12:15], v[204:207]
v_mfma_f32_16x16x32_bf16 v[208:211], a[100:103], a[12:15], v[208:211]
buffer_load_dwordx4 v1, s[4:7], s44 offen offset:1024 sc1 lds
v_mfma_f32_16x16x32_bf16 v[184:187], a[100:103], a[8:11], v[184:187]
ds_read_b128 a[136:139], v5 offset:32768
v_mfma_f32_16x16x32_bf16 v[160:163], a[100:103], a[4:7], v[160:163]
ds_read_b128 a[140:143], v5 offset:33792
v_accvgpr_read_b32 v49, a161
v_mfma_f32_16x16x32_bf16 v[136:139], a[100:103], a[0:3], v[136:139]
v_mfma_f32_16x16x32_bf16 v[140:143], a[104:107], a[0:3], v[140:143]
buffer_load_dwordx4 a[52:55], v2, s[40:43], s35 offen offset:1024 sc1
v_mfma_f32_16x16x32_bf16 v[164:167], a[104:107], a[4:7], v[164:167]
ds_read_b128 a[144:147], v5 offset:34816
v_mfma_f32_16x16x32_bf16 v[188:191], a[104:107], a[8:11], v[188:191]
v_mfma_f32_16x16x32_bf16 v[212:215], a[104:107], a[12:15], v[212:215]
buffer_load_dwordx4 v1, s[4:7], s44 offen offset:2048 sc1 lds
s_add_u32 s63, s28, 8
v_mfma_f32_16x16x32_bf16 v[216:219], a[108:111], a[12:15], v[216:219]
s_add_u32 s63, s63, s33
s_and_b32 s63, s63, 31
s_lshl_b32 s63, s63, 12
v_mfma_f32_16x16x32_bf16 v[192:195], a[108:111], a[8:11], v[192:195]
ds_read_b128 a[148:151], v5 offset:35840
v_accvgpr_read_b32 v50, a162
v_mfma_f32_16x16x32_bf16 v[168:171], a[108:111], a[4:7], v[168:171]
ds_read_b128 a[152:155], v6 offset:27648
v_mfma_f32_16x16x32_bf16 v[144:147], a[108:111], a[0:3], v[144:147]
buffer_load_dwordx4 a[56:59], v2, s[40:43], s35 offen offset:2048 sc1
v_mfma_f32_16x16x32_bf16 v[148:151], a[112:115], a[0:3], v[148:151]
v_mfma_f32_16x16x32_bf16 v[172:175], a[112:115], a[4:7], v[172:175]
v_mfma_f32_16x16x32_bf16 v[196:199], a[112:115], a[8:11], v[196:199]
buffer_load_dwordx4 a[72:75], v3, s[40:43], s63 offen sc1
s_add_u32 s44, s28, 12
v_mfma_f32_16x16x32_bf16 v[220:223], a[112:115], a[12:15], v[220:223]
s_mul_i32 s45, s44, 3072
s_add_u32 m0, s45, 98304
s_lshr_b32 s44, s44, 1
v_mfma_f32_16x16x32_bf16 v[224:227], a[116:119], a[12:15], v[224:227]
s_add_u32 s44, s44, 16
s_add_u32 s44, s44, s33
s_and_b32 s44, s44, 31
v_mfma_f32_16x16x32_bf16 v[200:203], a[116:119], a[8:11], v[200:203]
s_mul_i32 s44, s44, 6144
s_add_u32 s44, s44, s50
v_mfma_f32_16x16x32_bf16 v[176:179], a[116:119], a[4:7], v[176:179]
buffer_load_dwordx4 a[60:63], v2, s[40:43], s35 offen offset:3072 sc1
s_add_u32 s35, s35, 4096
v_mfma_f32_16x16x32_bf16 v[152:155], a[116:119], a[0:3], v[152:155]
s_and_b32 s35, s35, 0x1ffff
v_accvgpr_read_b32 v51, a163
v_mfma_f32_16x16x32_bf16 a[80:83], a[120:123], a[68:71], a[80:83]
s_waitcnt vmcnt(13) lgkmcnt(0)
v_mfma_f32_16x16x32_bf16 v[132:135], a[128:131], a[16:19], v[132:135]
ds_read_b128 a[96:99], v5 offset:36864
v_accvgpr_read_b32 v52, a164
v_mfma_f32_16x16x32_bf16 v[156:159], a[128:131], a[20:23], v[156:159]
buffer_load_dwordx4 a[0:3], v2, s[40:43], s35 offen offset:0 sc1
v_mfma_f32_16x16x32_bf16 v[180:183], a[128:131], a[24:27], v[180:183]
ds_read_b128 a[100:103], v5 offset:37888
v_mfma_f32_16x16x32_bf16 v[204:207], a[128:131], a[28:31], v[204:207]
v_mfma_f32_16x16x32_bf16 v[208:211], a[132:135], a[28:31], v[208:211]
ds_read_b128 a[104:107], v5 offset:38912
v_mfma_f32_16x16x32_bf16 v[184:187], a[132:135], a[24:27], v[184:187]
v_mfma_f32_16x16x32_bf16 v[160:163], a[132:135], a[20:23], v[160:163]
buffer_load_dwordx4 a[4:7], v2, s[40:43], s35 offen offset:1024 sc1
v_mfma_f32_16x16x32_bf16 v[136:139], a[132:135], a[16:19], v[136:139]
ds_read_b128 a[108:111], v5 offset:39936
v_accvgpr_read_b32 v53, a165
v_mfma_f32_16x16x32_bf16 v[140:143], a[136:139], a[16:19], v[140:143]
v_mfma_f32_16x16x32_bf16 v[164:167], a[136:139], a[20:23], v[164:167]
ds_read_b128 a[112:115], v5 offset:40960
v_mfma_f32_16x16x32_bf16 v[188:191], a[136:139], a[24:27], v[188:191]
v_mfma_f32_16x16x32_bf16 v[212:215], a[136:139], a[28:31], v[212:215]
buffer_load_dwordx4 v1, s[4:7], s44 offen offset:0 sc1 lds
v_mfma_f32_16x16x32_bf16 v[216:219], a[140:143], a[28:31], v[216:219]
ds_read_b128 a[116:119], v5 offset:41984
v_accvgpr_read_b32 v54, a166
v_mfma_f32_16x16x32_bf16 v[192:195], a[140:143], a[24:27], v[192:195]
ds_read_b128 a[120:123], v6 offset:28672
v_mfma_f32_16x16x32_bf16 v[168:171], a[140:143], a[20:23], v[168:171]
v_mfma_f32_16x16x32_bf16 v[144:147], a[140:143], a[16:19], v[144:147]
v_mfma_f32_16x16x32_bf16 v[148:151], a[144:147], a[16:19], v[148:151]
buffer_load_dwordx4 a[8:11], v2, s[40:43], s35 offen offset:2048 sc1
v_mfma_f32_16x16x32_bf16 v[172:175], a[144:147], a[20:23], v[172:175]
v_mfma_f32_16x16x32_bf16 v[196:199], a[144:147], a[24:27], v[196:199]
v_accvgpr_read_b32 v55, a167
v_mfma_f32_16x16x32_bf16 v[220:223], a[144:147], a[28:31], v[220:223]
v_mfma_f32_16x16x32_bf16 v[224:227], a[148:151], a[28:31], v[224:227]
v_mfma_f32_16x16x32_bf16 v[200:203], a[148:151], a[24:27], v[200:203]
buffer_load_dwordx4 a[12:15], v2, s[40:43], s35 offen offset:3072 sc1
s_add_u32 s35, s35, 4096
v_mfma_f32_16x16x32_bf16 v[176:179], a[148:151], a[20:23], v[176:179]
s_and_b32 s35, s35, 0x1ffff
v_mfma_f32_16x16x32_bf16 v[152:155], a[148:151], a[16:19], v[152:155]
v_mfma_f32_16x16x32_bf16 a[84:87], a[152:155], a[68:71], a[84:87]
s_waitcnt vmcnt(12) lgkmcnt(0)
v_mfma_f32_16x16x32_bf16 v[132:135], a[96:99], a[32:35], v[132:135]
ds_read_b128 a[128:131], v5 offset:43008
v_accvgpr_read_b32 v56, a168
v_mfma_f32_16x16x32_bf16 v[156:159], a[96:99], a[36:39], v[156:159]
buffer_load_dwordx4 a[16:19], v2, s[40:43], s35 offen offset:0 sc1
v_mfma_f32_16x16x32_bf16 v[180:183], a[96:99], a[40:43], v[180:183]
ds_read_b128 a[132:135], v5 offset:44032
v_mfma_f32_16x16x32_bf16 v[204:207], a[96:99], a[44:47], v[204:207]
v_mfma_f32_16x16x32_bf16 v[208:211], a[100:103], a[44:47], v[208:211]
ds_read_b128 a[136:139], v5 offset:45056
v_mfma_f32_16x16x32_bf16 v[184:187], a[100:103], a[40:43], v[184:187]
buffer_load_dwordx4 v1, s[4:7], s44 offen offset:1024 sc1 lds
v_mfma_f32_16x16x32_bf16 v[160:163], a[100:103], a[36:39], v[160:163]
ds_read_b128 a[140:143], v5 offset:46080
v_accvgpr_read_b32 v57, a169
v_mfma_f32_16x16x32_bf16 v[136:139], a[100:103], a[32:35], v[136:139]
v_mfma_f32_16x16x32_bf16 v[140:143], a[104:107], a[32:35], v[140:143]
v_mfma_f32_16x16x32_bf16 v[164:167], a[104:107], a[36:39], v[164:167]
buffer_load_dwordx4 a[20:23], v2, s[40:43], s35 offen offset:1024 sc1
v_mfma_f32_16x16x32_bf16 v[188:191], a[104:107], a[40:43], v[188:191]
ds_read_b128 a[144:147], v5 offset:47104
v_mfma_f32_16x16x32_bf16 v[212:215], a[104:107], a[44:47], v[212:215]
ds_read_b128 a[148:151], v5 offset:48128
v_mfma_f32_16x16x32_bf16 v[216:219], a[108:111], a[44:47], v[216:219]
v_accvgpr_read_b32 v58, a170
v_mfma_f32_16x16x32_bf16 v[192:195], a[108:111], a[40:43], v[192:195]
buffer_load_dwordx4 a[24:27], v2, s[40:43], s35 offen offset:2048 sc1
v_mfma_f32_16x16x32_bf16 v[168:171], a[108:111], a[36:39], v[168:171]
ds_read_b128 a[152:155], v6 offset:29696
v_mfma_f32_16x16x32_bf16 v[144:147], a[108:111], a[32:35], v[144:147]
v_mfma_f32_16x16x32_bf16 v[148:151], a[112:115], a[32:35], v[148:151]
v_mfma_f32_16x16x32_bf16 v[172:175], a[112:115], a[36:39], v[172:175]
buffer_load_dwordx4 v1, s[4:7], s44 offen offset:2048 sc1 lds
s_add_u32 s88, s82, 0x280000
v_mfma_f32_16x16x32_bf16 v[196:199], a[112:115], a[40:43], v[196:199]
v_accvgpr_read_b32 v59, a171
v_mfma_f32_16x16x32_bf16 v[220:223], a[112:115], a[44:47], v[220:223]
v_mfma_f32_16x16x32_bf16 v[224:227], a[116:119], a[44:47], v[224:227]
v_mfma_f32_16x16x32_bf16 v[200:203], a[116:119], a[40:43], v[200:203]
buffer_load_dwordx4 a[28:31], v2, s[40:43], s35 offen offset:3072 sc1
s_add_u32 s35, s35, 4096
v_mfma_f32_16x16x32_bf16 v[176:179], a[116:119], a[36:39], v[176:179]
s_and_b32 s35, s35, 0x1ffff
v_mfma_f32_16x16x32_bf16 v[152:155], a[116:119], a[32:35], v[152:155]
v_mfma_f32_16x16x32_bf16 a[88:91], a[120:123], a[68:71], a[88:91]
s_waitcnt vmcnt(11) lgkmcnt(0)
s_barrier
v_mfma_f32_16x16x32_bf16 v[132:135], a[128:131], a[48:51], v[132:135]
v_add_u32 v5, 49152, v1
v_add_u32 v6, s55, v5
v_mfma_f32_16x16x32_bf16 v[156:159], a[128:131], a[52:55], v[156:159]
buffer_load_dwordx4 a[32:35], v2, s[40:43], s35 offen offset:0 sc1
v_mfma_f32_16x16x32_bf16 v[180:183], a[128:131], a[56:59], v[180:183]
ds_read_b128 a[96:99], v5 offset:0
v_accvgpr_read_b32 v60, a172
v_mfma_f32_16x16x32_bf16 v[204:207], a[128:131], a[60:63], v[204:207]
ds_read_b128 a[100:103], v5 offset:1024
v_mfma_f32_16x16x32_bf16 v[208:211], a[132:135], a[60:63], v[208:211]
ds_read_b128 a[104:107], v5 offset:2048
v_mfma_f32_16x16x32_bf16 v[184:187], a[132:135], a[56:59], v[184:187]
buffer_load_dwordx4 v[92:95], v1, s[4:7], s88 offen offset:0 sc1
v_mfma_f32_16x16x32_bf16 v[160:163], a[132:135], a[52:55], v[160:163]
ds_read_b128 a[108:111], v5 offset:3072
v_accvgpr_read_b32 v61, a173
v_mfma_f32_16x16x32_bf16 v[136:139], a[132:135], a[48:51], v[136:139]
v_mfma_f32_16x16x32_bf16 v[140:143], a[136:139], a[48:51], v[140:143]
v_mfma_f32_16x16x32_bf16 v[164:167], a[136:139], a[52:55], v[164:167]
buffer_load_dwordx4 a[36:39], v2, s[40:43], s35 offen offset:1024 sc1
v_mfma_f32_16x16x32_bf16 v[188:191], a[136:139], a[56:59], v[188:191]
ds_read_b128 a[112:115], v5 offset:4096
v_mfma_f32_16x16x32_bf16 v[212:215], a[136:139], a[60:63], v[212:215]
ds_read_b128 a[116:119], v5 offset:5120
v_mfma_f32_16x16x32_bf16 v[216:219], a[140:143], a[60:63], v[216:219]
v_accvgpr_read_b32 v62, a174
v_mfma_f32_16x16x32_bf16 v[192:195], a[140:143], a[56:59], v[192:195]
buffer_load_dwordx4 a[40:43], v2, s[40:43], s35 offen offset:2048 sc1
v_mfma_f32_16x16x32_bf16 v[168:171], a[140:143], a[52:55], v[168:171]
ds_read_b128 a[120:123], v6 offset:2048
v_mfma_f32_16x16x32_bf16 v[144:147], a[140:143], a[48:51], v[144:147]
v_mfma_f32_16x16x32_bf16 v[148:151], a[144:147], a[48:51], v[148:151]
v_mfma_f32_16x16x32_bf16 v[172:175], a[144:147], a[52:55], v[172:175]
buffer_load_dwordx4 v[96:99], v1, s[4:7], s88 offen offset:1024 sc1
v_mfma_f32_16x16x32_bf16 v[196:199], a[144:147], a[56:59], v[196:199]
v_accvgpr_read_b32 v63, a175
v_mfma_f32_16x16x32_bf16 v[220:223], a[144:147], a[60:63], v[220:223]
v_mfma_f32_16x16x32_bf16 v[224:227], a[148:151], a[60:63], v[224:227]
v_mfma_f32_16x16x32_bf16 v[200:203], a[148:151], a[56:59], v[200:203]
buffer_load_dwordx4 a[44:47], v2, s[40:43], s35 offen offset:3072 sc1
s_add_u32 s35, s35, 4096
v_mfma_f32_16x16x32_bf16 v[176:179], a[148:151], a[52:55], v[176:179]
s_and_b32 s35, s35, 0x1ffff
v_mfma_f32_16x16x32_bf16 v[152:155], a[148:151], a[48:51], v[152:155]
v_mfma_f32_16x16x32_bf16 a[92:95], a[152:155], a[68:71], a[92:95]
s_waitcnt vmcnt(12) lgkmcnt(0)
v_mfma_f32_16x16x32_bf16 v[132:135], a[96:99], a[0:3], v[132:135]
ds_read_b128 a[128:131], v5 offset:6144
v_accvgpr_read_b32 v64, a176
v_mfma_f32_16x16x32_bf16 v[156:159], a[96:99], a[4:7], v[156:159]
buffer_load_dwordx4 a[48:51], v2, s[40:43], s35 offen offset:0 sc1
v_mfma_f32_16x16x32_bf16 v[180:183], a[96:99], a[8:11], v[180:183]
ds_read_b128 a[132:135], v5 offset:7168
v_mfma_f32_16x16x32_bf16 v[204:207], a[96:99], a[12:15], v[204:207]
v_mfma_f32_16x16x32_bf16 v[208:211], a[100:103], a[12:15], v[208:211]
ds_read_b128 a[136:139], v5 offset:8192
v_mfma_f32_16x16x32_bf16 v[184:187], a[100:103], a[8:11], v[184:187]
buffer_load_dwordx4 v[100:103], v1, s[4:7], s88 offen offset:2048 sc1
s_add_u32 s63, s28, 12
v_mfma_f32_16x16x32_bf16 v[160:163], a[100:103], a[4:7], v[160:163]
s_add_u32 s63, s63, s33
s_and_b32 s63, s63, 31
s_lshl_b32 s63, s63, 12
v_mfma_f32_16x16x32_bf16 v[136:139], a[100:103], a[0:3], v[136:139]
ds_read_b128 a[140:143], v5 offset:9216
v_accvgpr_read_b32 v65, a177
v_mfma_f32_16x16x32_bf16 v[140:143], a[104:107], a[0:3], v[140:143]
v_mfma_f32_16x16x32_bf16 v[164:167], a[104:107], a[4:7], v[164:167]
buffer_load_dwordx4 a[52:55], v2, s[40:43], s35 offen offset:1024 sc1
v_mfma_f32_16x16x32_bf16 v[188:191], a[104:107], a[8:11], v[188:191]
ds_read_b128 a[144:147], v5 offset:10240
v_mfma_f32_16x16x32_bf16 v[212:215], a[104:107], a[12:15], v[212:215]
ds_read_b128 a[148:151], v5 offset:11264
v_mfma_f32_16x16x32_bf16 v[216:219], a[108:111], a[12:15], v[216:219]
v_accvgpr_read_b32 v66, a178
v_mfma_f32_16x16x32_bf16 v[192:195], a[108:111], a[8:11], v[192:195]
buffer_load_dwordx4 a[56:59], v2, s[40:43], s35 offen offset:2048 sc1
v_mfma_f32_16x16x32_bf16 v[168:171], a[108:111], a[4:7], v[168:171]
ds_read_b128 a[152:155], v6 offset:3072
v_mfma_f32_16x16x32_bf16 v[144:147], a[108:111], a[0:3], v[144:147]
v_mfma_f32_16x16x32_bf16 v[148:151], a[112:115], a[0:3], v[148:151]
v_mfma_f32_16x16x32_bf16 v[172:175], a[112:115], a[4:7], v[172:175]
buffer_load_dwordx4 a[64:67], v3, s[40:43], s63 offen sc1
v_mfma_f32_16x16x32_bf16 v[196:199], a[112:115], a[8:11], v[196:199]
v_accvgpr_read_b32 v67, a179
v_mfma_f32_16x16x32_bf16 v[220:223], a[112:115], a[12:15], v[220:223]
v_mfma_f32_16x16x32_bf16 v[224:227], a[116:119], a[12:15], v[224:227]
v_mfma_f32_16x16x32_bf16 v[200:203], a[116:119], a[8:11], v[200:203]
buffer_load_dwordx4 a[60:63], v2, s[40:43], s35 offen offset:3072 sc1
s_add_u32 s35, s35, 4096
v_mfma_f32_16x16x32_bf16 v[176:179], a[116:119], a[4:7], v[176:179]
s_and_b32 s35, s35, 0x1ffff
v_mfma_f32_16x16x32_bf16 v[152:155], a[116:119], a[0:3], v[152:155]
v_mfma_f32_16x16x32_bf16 a[80:83], a[120:123], a[72:75], a[80:83]
s_waitcnt vmcnt(12) lgkmcnt(0)
v_mfma_f32_16x16x32_bf16 v[132:135], a[128:131], a[16:19], v[132:135]
ds_read_b128 a[96:99], v5 offset:12288
v_accvgpr_read_b32 v68, a180
v_mfma_f32_16x16x32_bf16 v[156:159], a[128:131], a[20:23], v[156:159]
buffer_load_dwordx4 a[0:3], v2, s[40:43], s35 offen offset:0 sc1
v_mfma_f32_16x16x32_bf16 v[180:183], a[128:131], a[24:27], v[180:183]
ds_read_b128 a[100:103], v5 offset:13312
v_mfma_f32_16x16x32_bf16 v[204:207], a[128:131], a[28:31], v[204:207]
v_mfma_f32_16x16x32_bf16 v[208:211], a[132:135], a[28:31], v[208:211]
ds_read_b128 a[104:107], v5 offset:14336
v_mfma_f32_16x16x32_bf16 v[184:187], a[132:135], a[24:27], v[184:187]
buffer_load_dwordx4 v[104:107], v1, s[4:7], s88 offen offset:3072 sc1
s_add_u32 s88, s88, 4096
v_mfma_f32_16x16x32_bf16 v[160:163], a[132:135], a[20:23], v[160:163]
ds_read_b128 a[108:111], v5 offset:15360
v_accvgpr_read_b32 v69, a181
v_mfma_f32_16x16x32_bf16 v[136:139], a[132:135], a[16:19], v[136:139]
v_mfma_f32_16x16x32_bf16 v[140:143], a[136:139], a[16:19], v[140:143]
v_mfma_f32_16x16x32_bf16 v[164:167], a[136:139], a[20:23], v[164:167]
buffer_load_dwordx4 a[4:7], v2, s[40:43], s35 offen offset:1024 sc1
v_mfma_f32_16x16x32_bf16 v[188:191], a[136:139], a[24:27], v[188:191]
ds_read_b128 a[112:115], v5 offset:16384
v_mfma_f32_16x16x32_bf16 v[212:215], a[136:139], a[28:31], v[212:215]
ds_read_b128 a[116:119], v5 offset:17408
v_mfma_f32_16x16x32_bf16 v[216:219], a[140:143], a[28:31], v[216:219]
v_accvgpr_read_b32 v70, a182
v_mfma_f32_16x16x32_bf16 v[192:195], a[140:143], a[24:27], v[192:195]
buffer_load_dwordx4 a[8:11], v2, s[40:43], s35 offen offset:2048 sc1
v_mfma_f32_16x16x32_bf16 v[168:171], a[140:143], a[20:23], v[168:171]
ds_read_b128 a[120:123], v6 offset:4096
v_mfma_f32_16x16x32_bf16 v[144:147], a[140:143], a[16:19], v[144:147]
v_mfma_f32_16x16x32_bf16 v[148:151], a[144:147], a[16:19], v[148:151]
v_mfma_f32_16x16x32_bf16 v[172:175], a[144:147], a[20:23], v[172:175]
buffer_load_dwordx4 v[108:111], v1, s[4:7], s88 offen offset:0 sc1
v_mfma_f32_16x16x32_bf16 v[196:199], a[144:147], a[24:27], v[196:199]
v_accvgpr_read_b32 v71, a183
v_mfma_f32_16x16x32_bf16 v[220:223], a[144:147], a[28:31], v[220:223]
v_mfma_f32_16x16x32_bf16 v[224:227], a[148:151], a[28:31], v[224:227]
v_mfma_f32_16x16x32_bf16 v[200:203], a[148:151], a[24:27], v[200:203]
buffer_load_dwordx4 a[12:15], v2, s[40:43], s35 offen offset:3072 sc1
s_add_u32 s35, s35, 4096
v_mfma_f32_16x16x32_bf16 v[176:179], a[148:151], a[20:23], v[176:179]
s_and_b32 s35, s35, 0x1ffff
v_mfma_f32_16x16x32_bf16 v[152:155], a[148:151], a[16:19], v[152:155]
v_mfma_f32_16x16x32_bf16 a[84:87], a[152:155], a[72:75], a[84:87]
s_waitcnt vmcnt(12) lgkmcnt(0)
v_mfma_f32_16x16x32_bf16 v[132:135], a[96:99], a[32:35], v[132:135]
ds_read_b128 a[128:131], v5 offset:18432
v_accvgpr_read_b32 v72, a184
v_mfma_f32_16x16x32_bf16 v[156:159], a[96:99], a[36:39], v[156:159]
buffer_load_dwordx4 a[16:19], v2, s[40:43], s35 offen offset:0 sc1
v_mfma_f32_16x16x32_bf16 v[180:183], a[96:99], a[40:43], v[180:183]
ds_read_b128 a[132:135], v5 offset:19456
v_mfma_f32_16x16x32_bf16 v[204:207], a[96:99], a[44:47], v[204:207]
v_mfma_f32_16x16x32_bf16 v[208:211], a[100:103], a[44:47], v[208:211]
ds_read_b128 a[136:139], v5 offset:20480
v_mfma_f32_16x16x32_bf16 v[184:187], a[100:103], a[40:43], v[184:187]
buffer_load_dwordx4 v[112:115], v1, s[4:7], s88 offen offset:1024 sc1
v_mfma_f32_16x16x32_bf16 v[160:163], a[100:103], a[36:39], v[160:163]
ds_read_b128 a[140:143], v5 offset:21504
v_accvgpr_read_b32 v73, a185
v_mfma_f32_16x16x32_bf16 v[136:139], a[100:103], a[32:35], v[136:139]
v_mfma_f32_16x16x32_bf16 v[140:143], a[104:107], a[32:35], v[140:143]
v_mfma_f32_16x16x32_bf16 v[164:167], a[104:107], a[36:39], v[164:167]
buffer_load_dwordx4 a[20:23], v2, s[40:43], s35 offen offset:1024 sc1
v_mfma_f32_16x16x32_bf16 v[188:191], a[104:107], a[40:43], v[188:191]
ds_read_b128 a[144:147], v5 offset:22528
v_mfma_f32_16x16x32_bf16 v[212:215], a[104:107], a[44:47], v[212:215]
ds_read_b128 a[148:151], v5 offset:23552
v_mfma_f32_16x16x32_bf16 v[216:219], a[108:111], a[44:47], v[216:219]
v_accvgpr_read_b32 v74, a186
v_mfma_f32_16x16x32_bf16 v[192:195], a[108:111], a[40:43], v[192:195]
buffer_load_dwordx4 a[24:27], v2, s[40:43], s35 offen offset:2048 sc1
v_mfma_f32_16x16x32_bf16 v[168:171], a[108:111], a[36:39], v[168:171]
ds_read_b128 a[152:155], v6 offset:5120
v_mfma_f32_16x16x32_bf16 v[144:147], a[108:111], a[32:35], v[144:147]
v_mfma_f32_16x16x32_bf16 v[148:151], a[112:115], a[32:35], v[148:151]
v_mfma_f32_16x16x32_bf16 v[172:175], a[112:115], a[36:39], v[172:175]
buffer_load_dwordx4 v[116:119], v1, s[4:7], s88 offen offset:2048 sc1
v_mfma_f32_16x16x32_bf16 v[196:199], a[112:115], a[40:43], v[196:199]
v_accvgpr_read_b32 v75, a187
v_mfma_f32_16x16x32_bf16 v[220:223], a[112:115], a[44:47], v[220:223]
v_mfma_f32_16x16x32_bf16 v[224:227], a[116:119], a[44:47], v[224:227]
v_mfma_f32_16x16x32_bf16 v[200:203], a[116:119], a[40:43], v[200:203]
buffer_load_dwordx4 a[28:31], v2, s[40:43], s35 offen offset:3072 sc1
s_add_u32 s35, s35, 4096
v_mfma_f32_16x16x32_bf16 v[176:179], a[116:119], a[36:39], v[176:179]
s_and_b32 s35, s35, 0x1ffff
v_mfma_f32_16x16x32_bf16 v[152:155], a[116:119], a[32:35], v[152:155]
v_mfma_f32_16x16x32_bf16 a[88:91], a[120:123], a[72:75], a[88:91]
s_waitcnt vmcnt(12) lgkmcnt(0)
v_mfma_f32_16x16x32_bf16 v[132:135], a[128:131], a[48:51], v[132:135]
ds_read_b128 a[96:99], v5 offset:24576
v_mfma_f32_16x16x32_bf16 v[156:159], a[128:131], a[52:55], v[156:159]
buffer_load_dwordx4 a[32:35], v2, s[40:43], s35 offen offset:0 sc1
v_mfma_f32_16x16x32_bf16 v[180:183], a[128:131], a[56:59], v[180:183]
ds_read_b128 a[100:103], v5 offset:25600
v_mfma_f32_16x16x32_bf16 v[204:207], a[128:131], a[60:63], v[204:207]
v_mfma_f32_16x16x32_bf16 v[208:211], a[132:135], a[60:63], v[208:211]
ds_read_b128 a[104:107], v5 offset:26624
v_mfma_f32_16x16x32_bf16 v[184:187], a[132:135], a[56:59], v[184:187]
v_mfma_f32_16x16x32_bf16 v[160:163], a[132:135], a[52:55], v[160:163]
buffer_load_dwordx4 a[36:39], v2, s[40:43], s35 offen offset:1024 sc1
v_mfma_f32_16x16x32_bf16 v[136:139], a[132:135], a[48:51], v[136:139]
ds_read_b128 a[108:111], v5 offset:27648
v_mfma_f32_16x16x32_bf16 v[140:143], a[136:139], a[48:51], v[140:143]
v_mfma_f32_16x16x32_bf16 v[164:167], a[136:139], a[52:55], v[164:167]
ds_read_b128 a[112:115], v5 offset:28672
v_mfma_f32_16x16x32_bf16 v[188:191], a[136:139], a[56:59], v[188:191]
v_mfma_f32_16x16x32_bf16 v[212:215], a[136:139], a[60:63], v[212:215]
buffer_load_dwordx4 v[120:123], v1, s[4:7], s88 offen offset:3072 sc1
s_add_u32 s88, s83, 0x280000
v_mfma_f32_16x16x32_bf16 v[216:219], a[140:143], a[60:63], v[216:219]
ds_read_b128 a[116:119], v5 offset:29696
v_mfma_f32_16x16x32_bf16 v[192:195], a[140:143], a[56:59], v[192:195]
ds_read_b128 a[120:123], v6 offset:26624
v_mfma_f32_16x16x32_bf16 v[168:171], a[140:143], a[52:55], v[168:171]
v_mfma_f32_16x16x32_bf16 v[144:147], a[140:143], a[48:51], v[144:147]
v_mfma_f32_16x16x32_bf16 v[148:151], a[144:147], a[48:51], v[148:151]
buffer_load_dwordx4 a[40:43], v2, s[40:43], s35 offen offset:2048 sc1
v_mfma_f32_16x16x32_bf16 v[172:175], a[144:147], a[52:55], v[172:175]
v_mfma_f32_16x16x32_bf16 v[196:199], a[144:147], a[56:59], v[196:199]
v_mfma_f32_16x16x32_bf16 v[220:223], a[144:147], a[60:63], v[220:223]
v_mfma_f32_16x16x32_bf16 v[224:227], a[148:151], a[60:63], v[224:227]
v_mfma_f32_16x16x32_bf16 v[200:203], a[148:151], a[56:59], v[200:203]
buffer_load_dwordx4 a[44:47], v2, s[40:43], s35 offen offset:3072 sc1
s_add_u32 s35, s35, 4096
v_mfma_f32_16x16x32_bf16 v[176:179], a[148:151], a[52:55], v[176:179]
s_and_b32 s35, s35, 0x1ffff
v_mfma_f32_16x16x32_bf16 v[152:155], a[148:151], a[48:51], v[152:155]
v_mfma_f32_16x16x32_bf16 a[92:95], a[152:155], a[72:75], a[92:95]
s_waitcnt vmcnt(11) lgkmcnt(0)
v_mfma_f32_16x16x32_bf16 v[132:135], a[96:99], a[0:3], v[132:135]
ds_read_b128 a[128:131], v5 offset:30720
v_mfma_f32_16x16x32_bf16 v[156:159], a[96:99], a[4:7], v[156:159]
buffer_load_dwordx4 a[48:51], v2, s[40:43], s35 offen offset:0 sc1
v_mfma_f32_16x16x32_bf16 v[180:183], a[96:99], a[8:11], v[180:183]
ds_read_b128 a[132:135], v5 offset:31744
v_mfma_f32_16x16x32_bf16 v[204:207], a[96:99], a[12:15], v[204:207]
v_mfma_f32_16x16x32_bf16 v[208:211], a[100:103], a[12:15], v[208:211]
buffer_load_dwordx4 v[124:127], v1, s[4:7], s88 offen offset:0 sc1
v_mfma_f32_16x16x32_bf16 v[184:187], a[100:103], a[8:11], v[184:187]
ds_read_b128 a[136:139], v5 offset:32768
v_mfma_f32_16x16x32_bf16 v[160:163], a[100:103], a[4:7], v[160:163]
ds_read_b128 a[140:143], v5 offset:33792
v_mfma_f32_16x16x32_bf16 v[136:139], a[100:103], a[0:3], v[136:139]
v_mfma_f32_16x16x32_bf16 v[140:143], a[104:107], a[0:3], v[140:143]
buffer_load_dwordx4 a[52:55], v2, s[40:43], s35 offen offset:1024 sc1
v_mfma_f32_16x16x32_bf16 v[164:167], a[104:107], a[4:7], v[164:167]
ds_read_b128 a[144:147], v5 offset:34816
v_mfma_f32_16x16x32_bf16 v[188:191], a[104:107], a[8:11], v[188:191]
v_mfma_f32_16x16x32_bf16 v[212:215], a[104:107], a[12:15], v[212:215]
buffer_load_dwordx4 v[128:131], v1, s[4:7], s88 offen offset:1024 sc1
s_add_u32 s63, s28, 16
v_mfma_f32_16x16x32_bf16 v[216:219], a[108:111], a[12:15], v[216:219]
s_add_u32 s63, s63, s33
s_and_b32 s63, s63, 31
s_lshl_b32 s63, s63, 12
v_mfma_f32_16x16x32_bf16 v[192:195], a[108:111], a[8:11], v[192:195]
ds_read_b128 a[148:151], v5 offset:35840
v_mfma_f32_16x16x32_bf16 v[168:171], a[108:111], a[4:7], v[168:171]
ds_read_b128 a[152:155], v6 offset:27648
v_mfma_f32_16x16x32_bf16 v[144:147], a[108:111], a[0:3], v[144:147]
buffer_load_dwordx4 a[56:59], v2, s[40:43], s35 offen offset:2048 sc1
v_mfma_f32_16x16x32_bf16 v[148:151], a[112:115], a[0:3], v[148:151]
v_mfma_f32_16x16x32_bf16 v[172:175], a[112:115], a[4:7], v[172:175]
v_mfma_f32_16x16x32_bf16 v[196:199], a[112:115], a[8:11], v[196:199]
buffer_load_dwordx4 a[68:71], v3, s[40:43], s63 offen sc1
s_add_u32 s44, s28, 0
v_mfma_f32_16x16x32_bf16 v[220:223], a[112:115], a[12:15], v[220:223]
s_mul_i32 s45, s44, 3072
s_add_u32 m0, s45, 0
s_lshr_b32 s44, s44, 1
v_mfma_f32_16x16x32_bf16 v[224:227], a[116:119], a[12:15], v[224:227]
s_add_u32 s44, s44, 24
s_add_u32 s44, s44, s33
s_and_b32 s44, s44, 31
v_mfma_f32_16x16x32_bf16 v[200:203], a[116:119], a[8:11], v[200:203]
s_mul_i32 s44, s44, 6144
s_add_u32 s44, s44, s50
v_mfma_f32_16x16x32_bf16 v[176:179], a[116:119], a[4:7], v[176:179]
buffer_load_dwordx4 a[60:63], v2, s[40:43], s35 offen offset:3072 sc1
s_add_u32 s35, s35, 4096
v_mfma_f32_16x16x32_bf16 v[152:155], a[116:119], a[0:3], v[152:155]
s_and_b32 s35, s35, 0x1ffff
v_mfma_f32_16x16x32_bf16 a[80:83], a[120:123], a[64:67], a[80:83]
s_waitcnt vmcnt(12) lgkmcnt(0)
v_mfma_f32_16x16x32_bf16 v[132:135], a[128:131], a[16:19], v[132:135]
ds_read_b128 a[96:99], v5 offset:36864
v_mfma_f32_16x16x32_bf16 v[156:159], a[128:131], a[20:23], v[156:159]
buffer_load_dwordx4 a[0:3], v2, s[40:43], s35 offen offset:0 sc1
v_mfma_f32_16x16x32_bf16 v[180:183], a[128:131], a[24:27], v[180:183]
ds_read_b128 a[100:103], v5 offset:37888
v_mfma_f32_16x16x32_bf16 v[204:207], a[128:131], a[28:31], v[204:207]
v_mfma_f32_16x16x32_bf16 v[208:211], a[132:135], a[28:31], v[208:211]
ds_read_b128 a[104:107], v5 offset:38912
v_mfma_f32_16x16x32_bf16 v[184:187], a[132:135], a[24:27], v[184:187]
buffer_load_dwordx4 v1, s[4:7], s44 offen offset:0 sc1 lds
v_mfma_f32_16x16x32_bf16 v[160:163], a[132:135], a[20:23], v[160:163]
ds_read_b128 a[108:111], v5 offset:39936
v_mfma_f32_16x16x32_bf16 v[136:139], a[132:135], a[16:19], v[136:139]
v_mfma_f32_16x16x32_bf16 v[140:143], a[136:139], a[16:19], v[140:143]
v_mfma_f32_16x16x32_bf16 v[164:167], a[136:139], a[20:23], v[164:167]
buffer_load_dwordx4 a[4:7], v2, s[40:43], s35 offen offset:1024 sc1
v_mfma_f32_16x16x32_bf16 v[188:191], a[136:139], a[24:27], v[188:191]
ds_read_b128 a[112:115], v5 offset:40960
v_mfma_f32_16x16x32_bf16 v[212:215], a[136:139], a[28:31], v[212:215]
ds_read_b128 a[116:119], v5 offset:41984
v_mfma_f32_16x16x32_bf16 v[216:219], a[140:143], a[28:31], v[216:219]
v_mfma_f32_16x16x32_bf16 v[192:195], a[140:143], a[24:27], v[192:195]
buffer_load_dwordx4 a[8:11], v2, s[40:43], s35 offen offset:2048 sc1
v_mfma_f32_16x16x32_bf16 v[168:171], a[140:143], a[20:23], v[168:171]
ds_read_b128 a[120:123], v6 offset:28672
v_mfma_f32_16x16x32_bf16 v[144:147], a[140:143], a[16:19], v[144:147]
v_mfma_f32_16x16x32_bf16 v[148:151], a[144:147], a[16:19], v[148:151]
v_mfma_f32_16x16x32_bf16 v[172:175], a[144:147], a[20:23], v[172:175]
buffer_load_dwordx4 v1, s[4:7], s44 offen offset:1024 sc1 lds
v_mfma_f32_16x16x32_bf16 v[196:199], a[144:147], a[24:27], v[196:199]
v_mfma_f32_16x16x32_bf16 v[220:223], a[144:147], a[28:31], v[220:223]
v_mfma_f32_16x16x32_bf16 v[224:227], a[148:151], a[28:31], v[224:227]
v_mfma_f32_16x16x32_bf16 v[200:203], a[148:151], a[24:27], v[200:203]
buffer_load_dwordx4 a[12:15], v2, s[40:43], s35 offen offset:3072 sc1
s_add_u32 s35, s35, 4096
v_mfma_f32_16x16x32_bf16 v[176:179], a[148:151], a[20:23], v[176:179]
s_and_b32 s35, s35, 0x1ffff
v_mfma_f32_16x16x32_bf16 v[152:155], a[148:151], a[16:19], v[152:155]
v_mfma_f32_16x16x32_bf16 a[84:87], a[152:155], a[64:67], a[84:87]
s_waitcnt vmcnt(13) lgkmcnt(0)
v_mfma_f32_16x16x32_bf16 v[132:135], a[96:99], a[32:35], v[132:135]
ds_read_b128 a[128:131], v5 offset:43008
v_mfma_f32_16x16x32_bf16 v[156:159], a[96:99], a[36:39], v[156:159]
buffer_load_dwordx4 a[16:19], v2, s[40:43], s35 offen offset:0 sc1
v_mfma_f32_16x16x32_bf16 v[180:183], a[96:99], a[40:43], v[180:183]
ds_read_b128 a[132:135], v5 offset:44032
v_mfma_f32_16x16x32_bf16 v[204:207], a[96:99], a[44:47], v[204:207]
v_mfma_f32_16x16x32_bf16 v[208:211], a[100:103], a[44:47], v[208:211]
ds_read_b128 a[136:139], v5 offset:45056
v_mfma_f32_16x16x32_bf16 v[184:187], a[100:103], a[40:43], v[184:187]
v_mfma_f32_16x16x32_bf16 v[160:163], a[100:103], a[36:39], v[160:163]
buffer_load_dwordx4 a[20:23], v2, s[40:43], s35 offen offset:1024 sc1
v_mfma_f32_16x16x32_bf16 v[136:139], a[100:103], a[32:35], v[136:139]
ds_read_b128 a[140:143], v5 offset:46080
v_mfma_f32_16x16x32_bf16 v[140:143], a[104:107], a[32:35], v[140:143]
v_mfma_f32_16x16x32_bf16 v[164:167], a[104:107], a[36:39], v[164:167]
ds_read_b128 a[144:147], v5 offset:47104
v_mfma_f32_16x16x32_bf16 v[188:191], a[104:107], a[40:43], v[188:191]
v_mfma_f32_16x16x32_bf16 v[212:215], a[104:107], a[44:47], v[212:215]
buffer_load_dwordx4 v1, s[4:7], s44 offen offset:2048 sc1 lds
s_add_u32 s44, s28, 4
v_mfma_f32_16x16x32_bf16 v[216:219], a[108:111], a[44:47], v[216:219]
s_mul_i32 s45, s44, 3072
s_add_u32 m0, s45, 0
s_lshr_b32 s44, s44, 1
v_mfma_f32_16x16x32_bf16 v[192:195], a[108:111], a[40:43], v[192:195]
s_add_u32 s44, s44, 24
s_add_u32 s44, s44, s33
s_and_b32 s44, s44, 31
v_mfma_f32_16x16x32_bf16 v[168:171], a[108:111], a[36:39], v[168:171]
s_mul_i32 s44, s44, 6144
s_add_u32 s44, s44, s50
v_mfma_f32_16x16x32_bf16 v[144:147], a[108:111], a[32:35], v[144:147]
ds_read_b128 a[148:151], v5 offset:48128
v_mfma_f32_16x16x32_bf16 v[148:151], a[112:115], a[32:35], v[148:151]
buffer_load_dwordx4 a[24:27], v2, s[40:43], s35 offen offset:2048 sc1
v_mfma_f32_16x16x32_bf16 v[172:175], a[112:115], a[36:39], v[172:175]
ds_read_b128 a[152:155], v6 offset:29696
v_mfma_f32_16x16x32_bf16 v[196:199], a[112:115], a[40:43], v[196:199]
v_mfma_f32_16x16x32_bf16 v[220:223], a[112:115], a[44:47], v[220:223]
v_mfma_f32_16x16x32_bf16 v[224:227], a[116:119], a[44:47], v[224:227]
v_mfma_f32_16x16x32_bf16 v[200:203], a[116:119], a[40:43], v[200:203]
buffer_load_dwordx4 a[28:31], v2, s[40:43], s35 offen offset:3072 sc1
s_add_u32 s35, s35, 4096
v_mfma_f32_16x16x32_bf16 v[176:179], a[116:119], a[36:39], v[176:179]
s_and_b32 s35, s35, 0x1ffff
v_mfma_f32_16x16x32_bf16 v[152:155], a[116:119], a[32:35], v[152:155]
v_mfma_f32_16x16x32_bf16 a[88:91], a[120:123], a[64:67], a[88:91]
s_waitcnt vmcnt(11) lgkmcnt(0)
s_barrier
v_mfma_f32_16x16x32_bf16 v[132:135], a[128:131], a[48:51], v[132:135]
v_add_u32 v5, 98304, v1
v_add_u32 v6, s55, v5
v_mfma_f32_16x16x32_bf16 v[156:159], a[128:131], a[52:55], v[156:159]
buffer_load_dwordx4 a[32:35], v2, s[40:43], s35 offen offset:0 sc1
v_mfma_f32_16x16x32_bf16 v[180:183], a[128:131], a[56:59], v[180:183]
ds_read_b128 a[96:99], v5 offset:0
v_mfma_f32_16x16x32_bf16 v[204:207], a[128:131], a[60:63], v[204:207]
ds_read_b128 a[100:103], v5 offset:1024
v_mfma_f32_16x16x32_bf16 v[208:211], a[132:135], a[60:63], v[208:211]
ds_read_b128 a[104:107], v5 offset:2048
v_mfma_f32_16x16x32_bf16 v[184:187], a[132:135], a[56:59], v[184:187]
buffer_load_dwordx4 v1, s[4:7], s44 offen offset:0 sc1 lds
v_mfma_f32_16x16x32_bf16 v[160:163], a[132:135], a[52:55], v[160:163]
ds_read_b128 a[108:111], v5 offset:3072
v_mfma_f32_16x16x32_bf16 v[136:139], a[132:135], a[48:51], v[136:139]
v_mfma_f32_16x16x32_bf16 v[140:143], a[136:139], a[48:51], v[140:143]
v_mfma_f32_16x16x32_bf16 v[164:167], a[136:139], a[52:55], v[164:167]
buffer_load_dwordx4 a[36:39], v2, s[40:43], s35 offen offset:1024 sc1
v_mfma_f32_16x16x32_bf16 v[188:191], a[136:139], a[56:59], v[188:191]
ds_read_b128 a[112:115], v5 offset:4096
v_mfma_f32_16x16x32_bf16 v[212:215], a[136:139], a[60:63], v[212:215]
ds_read_b128 a[116:119], v5 offset:5120
v_mfma_f32_16x16x32_bf16 v[216:219], a[140:143], a[60:63], v[216:219]
v_mfma_f32_16x16x32_bf16 v[192:195], a[140:143], a[56:59], v[192:195]
buffer_load_dwordx4 a[40:43], v2, s[40:43], s35 offen offset:2048 sc1
v_mfma_f32_16x16x32_bf16 v[168:171], a[140:143], a[52:55], v[168:171]
ds_read_b128 a[120:123], v6 offset:2048
v_mfma_f32_16x16x32_bf16 v[144:147], a[140:143], a[48:51], v[144:147]
v_mfma_f32_16x16x32_bf16 v[148:151], a[144:147], a[48:51], v[148:151]
v_mfma_f32_16x16x32_bf16 v[172:175], a[144:147], a[52:55], v[172:175]
buffer_load_dwordx4 v1, s[4:7], s44 offen offset:1024 sc1 lds
v_mfma_f32_16x16x32_bf16 v[196:199], a[144:147], a[56:59], v[196:199]
v_mfma_f32_16x16x32_bf16 v[220:223], a[144:147], a[60:63], v[220:223]
v_mfma_f32_16x16x32_bf16 v[224:227], a[148:151], a[60:63], v[224:227]
v_mfma_f32_16x16x32_bf16 v[200:203], a[148:151], a[56:59], v[200:203]
buffer_load_dwordx4 a[44:47], v2, s[40:43], s35 offen offset:3072 sc1
s_add_u32 s35, s35, 4096
v_mfma_f32_16x16x32_bf16 v[176:179], a[148:151], a[52:55], v[176:179]
s_and_b32 s35, s35, 0x1ffff
v_mfma_f32_16x16x32_bf16 v[152:155], a[148:151], a[48:51], v[152:155]
v_mfma_f32_16x16x32_bf16 a[92:95], a[152:155], a[64:67], a[92:95]
s_waitcnt vmcnt(11) lgkmcnt(0)
v_mfma_f32_16x16x32_bf16 v[132:135], a[96:99], a[0:3], v[132:135]
ds_read_b128 a[128:131], v5 offset:6144
v_mfma_f32_16x16x32_bf16 v[156:159], a[96:99], a[4:7], v[156:159]
buffer_load_dwordx4 a[48:51], v2, s[40:43], s35 offen offset:0 sc1
v_mfma_f32_16x16x32_bf16 v[180:183], a[96:99], a[8:11], v[180:183]
ds_read_b128 a[132:135], v5 offset:7168
v_mfma_f32_16x16x32_bf16 v[204:207], a[96:99], a[12:15], v[204:207]
v_mfma_f32_16x16x32_bf16 v[208:211], a[100:103], a[12:15], v[208:211]
buffer_load_dwordx4 v1, s[4:7], s44 offen offset:2048 sc1 lds
s_add_u32 s44, s28, 8
v_mfma_f32_16x16x32_bf16 v[184:187], a[100:103], a[8:11], v[184:187]
s_mul_i32 s45, s44, 3072
s_add_u32 m0, s45, 0
s_lshr_b32 s44, s44, 1
v_mfma_f32_16x16x32_bf16 v[160:163], a[100:103], a[4:7], v[160:163]
s_add_u32 s44, s44, 24
s_add_u32 s44, s44, s33
s_and_b32 s44, s44, 31
v_mfma_f32_16x16x32_bf16 v[136:139], a[100:103], a[0:3], v[136:139]
s_mul_i32 s44, s44, 6144
s_add_u32 s44, s44, s50
v_mfma_f32_16x16x32_bf16 v[140:143], a[104:107], a[0:3], v[140:143]
buffer_load_dwordx4 a[52:55], v2, s[40:43], s35 offen offset:1024 sc1
v_mfma_f32_16x16x32_bf16 v[164:167], a[104:107], a[4:7], v[164:167]
ds_read_b128 a[136:139], v5 offset:8192
v_mfma_f32_16x16x32_bf16 v[188:191], a[104:107], a[8:11], v[188:191]
ds_read_b128 a[140:143], v5 offset:9216
v_mfma_f32_16x16x32_bf16 v[212:215], a[104:107], a[12:15], v[212:215]
buffer_load_dwordx4 v1, s[4:7], s44 offen offset:0 sc1 lds
s_add_u32 s63, s28, 20
v_mfma_f32_16x16x32_bf16 v[216:219], a[108:111], a[12:15], v[216:219]
s_add_u32 s63, s63, s33
s_and_b32 s63, s63, 31
s_lshl_b32 s63, s63, 12
v_mfma_f32_16x16x32_bf16 v[192:195], a[108:111], a[8:11], v[192:195]
ds_read_b128 a[144:147], v5 offset:10240
v_mfma_f32_16x16x32_bf16 v[168:171], a[108:111], a[4:7], v[168:171]
ds_read_b128 a[148:151], v5 offset:11264
v_mfma_f32_16x16x32_bf16 v[144:147], a[108:111], a[0:3], v[144:147]
buffer_load_dwordx4 a[56:59], v2, s[40:43], s35 offen offset:2048 sc1
v_mfma_f32_16x16x32_bf16 v[148:151], a[112:115], a[0:3], v[148:151]
ds_read_b128 a[152:155], v6 offset:3072
v_mfma_f32_16x16x32_bf16 v[172:175], a[112:115], a[4:7], v[172:175]
v_mfma_f32_16x16x32_bf16 v[196:199], a[112:115], a[8:11], v[196:199]
buffer_load_dwordx4 a[72:75], v3, s[40:43], s63 offen sc1
v_mfma_f32_16x16x32_bf16 v[220:223], a[112:115], a[12:15], v[220:223]
v_mfma_f32_16x16x32_bf16 v[224:227], a[116:119], a[12:15], v[224:227]
v_mfma_f32_16x16x32_bf16 v[200:203], a[116:119], a[8:11], v[200:203]
v_mfma_f32_16x16x32_bf16 v[176:179], a[116:119], a[4:7], v[176:179]
buffer_load_dwordx4 a[60:63], v2, s[40:43], s35 offen offset:3072 sc1
s_add_u32 s35, s35, 4096
v_mfma_f32_16x16x32_bf16 v[152:155], a[116:119], a[0:3], v[152:155]
s_and_b32 s35, s35, 0x1ffff
v_mfma_f32_16x16x32_bf16 a[80:83], a[120:123], a[68:71], a[80:83]
s_waitcnt vmcnt(13) lgkmcnt(0)
v_mfma_f32_16x16x32_bf16 v[132:135], a[128:131], a[16:19], v[132:135]
ds_read_b128 a[96:99], v5 offset:12288
v_mfma_f32_16x16x32_bf16 v[156:159], a[128:131], a[20:23], v[156:159]
buffer_load_dwordx4 a[0:3], v2, s[40:43], s35 offen offset:0 sc1
v_mfma_f32_16x16x32_bf16 v[180:183], a[128:131], a[24:27], v[180:183]
ds_read_b128 a[100:103], v5 offset:13312
v_mfma_f32_16x16x32_bf16 v[204:207], a[128:131], a[28:31], v[204:207]
v_mfma_f32_16x16x32_bf16 v[208:211], a[132:135], a[28:31], v[208:211]
ds_read_b128 a[104:107], v5 offset:14336
v_mfma_f32_16x16x32_bf16 v[184:187], a[132:135], a[24:27], v[184:187]
v_mfma_f32_16x16x32_bf16 v[160:163], a[132:135], a[20:23], v[160:163]
buffer_load_dwordx4 a[4:7], v2, s[40:43], s35 offen offset:1024 sc1
v_mfma_f32_16x16x32_bf16 v[136:139], a[132:135], a[16:19], v[136:139]
ds_read_b128 a[108:111], v5 offset:15360
v_mfma_f32_16x16x32_bf16 v[140:143], a[136:139], a[16:19], v[140:143]
v_mfma_f32_16x16x32_bf16 v[164:167], a[136:139], a[20:23], v[164:167]
ds_read_b128 a[112:115], v5 offset:16384
v_mfma_f32_16x16x32_bf16 v[188:191], a[136:139], a[24:27], v[188:191]
v_mfma_f32_16x16x32_bf16 v[212:215], a[136:139], a[28:31], v[212:215]
buffer_load_dwordx4 v1, s[4:7], s44 offen offset:1024 sc1 lds
v_mfma_f32_16x16x32_bf16 v[216:219], a[140:143], a[28:31], v[216:219]
ds_read_b128 a[116:119], v5 offset:17408
v_mfma_f32_16x16x32_bf16 v[192:195], a[140:143], a[24:27], v[192:195]
ds_read_b128 a[120:123], v6 offset:4096
v_mfma_f32_16x16x32_bf16 v[168:171], a[140:143], a[20:23], v[168:171]
v_mfma_f32_16x16x32_bf16 v[144:147], a[140:143], a[16:19], v[144:147]
v_mfma_f32_16x16x32_bf16 v[148:151], a[144:147], a[16:19], v[148:151]
buffer_load_dwordx4 a[8:11], v2, s[40:43], s35 offen offset:2048 sc1
v_mfma_f32_16x16x32_bf16 v[172:175], a[144:147], a[20:23], v[172:175]
v_mfma_f32_16x16x32_bf16 v[196:199], a[144:147], a[24:27], v[196:199]
v_mfma_f32_16x16x32_bf16 v[220:223], a[144:147], a[28:31], v[220:223]
v_mfma_f32_16x16x32_bf16 v[224:227], a[148:151], a[28:31], v[224:227]
v_mfma_f32_16x16x32_bf16 v[200:203], a[148:151], a[24:27], v[200:203]
buffer_load_dwordx4 a[12:15], v2, s[40:43], s35 offen offset:3072 sc1
s_add_u32 s35, s35, 4096
v_mfma_f32_16x16x32_bf16 v[176:179], a[148:151], a[20:23], v[176:179]
s_and_b32 s35, s35, 0x1ffff
v_mfma_f32_16x16x32_bf16 v[152:155], a[148:151], a[16:19], v[152:155]
v_mfma_f32_16x16x32_bf16 a[84:87], a[152:155], a[68:71], a[84:87]
s_waitcnt vmcnt(12) lgkmcnt(0)
v_mfma_f32_16x16x32_bf16 v[132:135], a[96:99], a[32:35], v[132:135]
ds_read_b128 a[128:131], v5 offset:18432
v_mfma_f32_16x16x32_bf16 v[156:159], a[96:99], a[36:39], v[156:159]
buffer_load_dwordx4 a[16:19], v2, s[40:43], s35 offen offset:0 sc1
v_mfma_f32_16x16x32_bf16 v[180:183], a[96:99], a[40:43], v[180:183]
ds_read_b128 a[132:135], v5 offset:19456
v_mfma_f32_16x16x32_bf16 v[204:207], a[96:99], a[44:47], v[204:207]
v_mfma_f32_16x16x32_bf16 v[208:211], a[100:103], a[44:47], v[208:211]
ds_read_b128 a[136:139], v5 offset:20480
v_mfma_f32_16x16x32_bf16 v[184:187], a[100:103], a[40:43], v[184:187]
buffer_load_dwordx4 v1, s[4:7], s44 offen offset:2048 sc1 lds
s_add_u32 s44, s28, 12
v_mfma_f32_16x16x32_bf16 v[160:163], a[100:103], a[36:39], v[160:163]
s_mul_i32 s45, s44, 3072
s_add_u32 m0, s45, 0
s_lshr_b32 s44, s44, 1
v_mfma_f32_16x16x32_bf16 v[136:139], a[100:103], a[32:35], v[136:139]
s_add_u32 s44, s44, 24
s_add_u32 s44, s44, s33
s_and_b32 s44, s44, 31
v_mfma_f32_16x16x32_bf16 v[140:143], a[104:107], a[32:35], v[140:143]
s_mul_i32 s44, s44, 6144
s_add_u32 s44, s44, s50
v_mfma_f32_16x16x32_bf16 v[164:167], a[104:107], a[36:39], v[164:167]
buffer_load_dwordx4 a[20:23], v2, s[40:43], s35 offen offset:1024 sc1
v_mfma_f32_16x16x32_bf16 v[188:191], a[104:107], a[40:43], v[188:191]
ds_read_b128 a[140:143], v5 offset:21504
v_mfma_f32_16x16x32_bf16 v[212:215], a[104:107], a[44:47], v[212:215]
ds_read_b128 a[144:147], v5 offset:22528
v_mfma_f32_16x16x32_bf16 v[216:219], a[108:111], a[44:47], v[216:219]
ds_read_b128 a[148:151], v5 offset:23552
v_mfma_f32_16x16x32_bf16 v[192:195], a[108:111], a[40:43], v[192:195]
buffer_load_dwordx4 a[24:27], v2, s[40:43], s35 offen offset:2048 sc1
v_mfma_f32_16x16x32_bf16 v[168:171], a[108:111], a[36:39], v[168:171]
ds_read_b128 a[152:155], v6 offset:5120
v_mfma_f32_16x16x32_bf16 v[144:147], a[108:111], a[32:35], v[144:147]
v_mfma_f32_16x16x32_bf16 v[148:151], a[112:115], a[32:35], v[148:151]
v_mfma_f32_16x16x32_bf16 v[172:175], a[112:115], a[36:39], v[172:175]
buffer_load_dwordx4 v1, s[4:7], s44 offen offset:0 sc1 lds
v_mfma_f32_16x16x32_bf16 v[196:199], a[112:115], a[40:43], v[196:199]
v_mfma_f32_16x16x32_bf16 v[220:223], a[112:115], a[44:47], v[220:223]
v_mfma_f32_16x16x32_bf16 v[224:227], a[116:119], a[44:47], v[224:227]
v_mfma_f32_16x16x32_bf16 v[200:203], a[116:119], a[40:43], v[200:203]
buffer_load_dwordx4 a[28:31], v2, s[40:43], s35 offen offset:3072 sc1
s_add_u32 s35, s35, 4096
v_mfma_f32_16x16x32_bf16 v[176:179], a[116:119], a[36:39], v[176:179]
s_and_b32 s35, s35, 0x1ffff
v_mfma_f32_16x16x32_bf16 v[152:155], a[116:119], a[32:35], v[152:155]
v_mfma_f32_16x16x32_bf16 a[88:91], a[120:123], a[68:71], a[88:91]
s_waitcnt vmcnt(11) lgkmcnt(0)
v_mfma_f32_16x16x32_bf16 v[132:135], a[128:131], a[48:51], v[132:135]
ds_read_b128 a[96:99], v5 offset:24576
v_mfma_f32_16x16x32_bf16 v[156:159], a[128:131], a[52:55], v[156:159]
buffer_load_dwordx4 a[32:35], v2, s[40:43], s35 offen offset:0 sc1
v_mfma_f32_16x16x32_bf16 v[180:183], a[128:131], a[56:59], v[180:183]
ds_read_b128 a[100:103], v5 offset:25600
v_mfma_f32_16x16x32_bf16 v[204:207], a[128:131], a[60:63], v[204:207]
v_mfma_f32_16x16x32_bf16 v[208:211], a[132:135], a[60:63], v[208:211]
ds_read_b128 a[104:107], v5 offset:26624
v_mfma_f32_16x16x32_bf16 v[184:187], a[132:135], a[56:59], v[184:187]
buffer_load_dwordx4 v1, s[4:7], s44 offen offset:1024 sc1 lds
v_mfma_f32_16x16x32_bf16 v[160:163], a[132:135], a[52:55], v[160:163]
ds_read_b128 a[108:111], v5 offset:27648
v_mfma_f32_16x16x32_bf16 v[136:139], a[132:135], a[48:51], v[136:139]
v_mfma_f32_16x16x32_bf16 v[140:143], a[136:139], a[48:51], v[140:143]
v_mfma_f32_16x16x32_bf16 v[164:167], a[136:139], a[52:55], v[164:167]
buffer_load_dwordx4 a[36:39], v2, s[40:43], s35 offen offset:1024 sc1
v_mfma_f32_16x16x32_bf16 v[188:191], a[136:139], a[56:59], v[188:191]
ds_read_b128 a[112:115], v5 offset:28672
v_mfma_f32_16x16x32_bf16 v[212:215], a[136:139], a[60:63], v[212:215]
ds_read_b128 a[116:119], v5 offset:29696
v_mfma_f32_16x16x32_bf16 v[216:219], a[140:143], a[60:63], v[216:219]
v_mfma_f32_16x16x32_bf16 v[192:195], a[140:143], a[56:59], v[192:195]
buffer_load_dwordx4 a[40:43], v2, s[40:43], s35 offen offset:2048 sc1
v_mfma_f32_16x16x32_bf16 v[168:171], a[140:143], a[52:55], v[168:171]
ds_read_b128 a[120:123], v6 offset:26624
v_mfma_f32_16x16x32_bf16 v[144:147], a[140:143], a[48:51], v[144:147]
v_mfma_f32_16x16x32_bf16 v[148:151], a[144:147], a[48:51], v[148:151]
v_mfma_f32_16x16x32_bf16 v[172:175], a[144:147], a[52:55], v[172:175]
buffer_load_dwordx4 v1, s[4:7], s44 offen offset:2048 sc1 lds
s_add_u32 s44, s28, 4
v_mfma_f32_16x16x32_bf16 v[196:199], a[144:147], a[56:59], v[196:199]
s_lshl_b32 s45, s44, 12
s_add_u32 m0, s45, 32768
s_and_b32 s45, s44, 7
v_mfma_f32_16x16x32_bf16 v[220:223], a[144:147], a[60:63], v[220:223]
s_cmp_eq_u32 s45, s3
s_cselect_b32 s45, 8, 0
s_add_u32 s44, s44, s45
v_mfma_f32_16x16x32_bf16 v[224:227], a[148:151], a[60:63], v[224:227]
s_and_b32 s44, s44, 31
s_lshl_b32 s44, s44, 12
s_add_u32 s44, s44, s51
v_mfma_f32_16x16x32_bf16 v[200:203], a[148:151], a[56:59], v[200:203]
buffer_load_dwordx4 a[44:47], v2, s[40:43], s35 offen offset:3072 sc1
s_add_u32 s35, s35, 4096
v_mfma_f32_16x16x32_bf16 v[176:179], a[148:151], a[52:55], v[176:179]
s_and_b32 s35, s35, 0x1ffff
v_mfma_f32_16x16x32_bf16 v[152:155], a[148:151], a[48:51], v[152:155]
v_mfma_f32_16x16x32_bf16 a[92:95], a[152:155], a[68:71], a[92:95]
s_waitcnt vmcnt(12) lgkmcnt(0)
v_mfma_f32_16x16x32_bf16 v[132:135], a[96:99], a[0:3], v[132:135]
ds_read_b128 a[128:131], v5 offset:30720
v_mfma_f32_16x16x32_bf16 v[156:159], a[96:99], a[4:7], v[156:159]
buffer_load_dwordx4 a[48:51], v2, s[40:43], s35 offen offset:0 sc1
v_mfma_f32_16x16x32_bf16 v[180:183], a[96:99], a[8:11], v[180:183]
ds_read_b128 a[132:135], v5 offset:31744
v_mfma_f32_16x16x32_bf16 v[204:207], a[96:99], a[12:15], v[204:207]
v_mfma_f32_16x16x32_bf16 v[208:211], a[100:103], a[12:15], v[208:211]
ds_read_b128 a[136:139], v5 offset:32768
v_mfma_f32_16x16x32_bf16 v[184:187], a[100:103], a[8:11], v[184:187]
buffer_load_dwordx4 v1, s[4:7], s44 offen offset:0 sc1 lds
s_add_u32 s63, s28, 24
v_mfma_f32_16x16x32_bf16 v[160:163], a[100:103], a[4:7], v[160:163]
s_add_u32 s63, s63, s33
s_and_b32 s63, s63, 31
s_lshl_b32 s63, s63, 12
v_mfma_f32_16x16x32_bf16 v[136:139], a[100:103], a[0:3], v[136:139]
ds_read_b128 a[140:143], v5 offset:33792
v_mfma_f32_16x16x32_bf16 v[140:143], a[104:107], a[0:3], v[140:143]
v_mfma_f32_16x16x32_bf16 v[164:167], a[104:107], a[4:7], v[164:167]
buffer_load_dwordx4 a[52:55], v2, s[40:43], s35 offen offset:1024 sc1
v_mfma_f32_16x16x32_bf16 v[188:191], a[104:107], a[8:11], v[188:191]
ds_read_b128 a[144:147], v5 offset:34816
v_mfma_f32_16x16x32_bf16 v[212:215], a[104:107], a[12:15], v[212:215]
ds_read_b128 a[148:151], v5 offset:35840
v_mfma_f32_16x16x32_bf16 v[216:219], a[108:111], a[12:15], v[216:219]
v_mfma_f32_16x16x32_bf16 v[192:195], a[108:111], a[8:11], v[192:195]
buffer_load_dwordx4 a[56:59], v2, s[40:43], s35 offen offset:2048 sc1
v_mfma_f32_16x16x32_bf16 v[168:171], a[108:111], a[4:7], v[168:171]
ds_read_b128 a[152:155], v6 offset:27648
v_mfma_f32_16x16x32_bf16 v[144:147], a[108:111], a[0:3], v[144:147]
v_mfma_f32_16x16x32_bf16 v[148:151], a[112:115], a[0:3], v[148:151]
v_mfma_f32_16x16x32_bf16 v[172:175], a[112:115], a[4:7], v[172:175]
buffer_load_dwordx4 a[64:67], v3, s[40:43], s63 offen sc1
s_lshr_b32 s89, s2, 3
v_mfma_f32_16x16x32_bf16 v[196:199], a[112:115], a[8:11], v[196:199]
s_lshl_b32 s89, s89, 10
s_add_u32 s89, s89, (L_cpf2 - interleave_layers__sliding_local_dilated__linear_kernel_hedgehog__prompt_kernel + 2048)
v_mfma_f32_16x16x32_bf16 v[220:223], a[112:115], a[12:15], v[220:223]
v_mfma_f32_16x16x32_bf16 v[224:227], a[116:119], a[12:15], v[224:227]
v_mfma_f32_16x16x32_bf16 v[200:203], a[116:119], a[8:11], v[200:203]
buffer_load_dwordx4 a[60:63], v2, s[40:43], s35 offen offset:3072 sc1
s_add_u32 s35, s35, 4096
v_mfma_f32_16x16x32_bf16 v[176:179], a[116:119], a[4:7], v[176:179]
s_and_b32 s35, s35, 0x1ffff
v_mfma_f32_16x16x32_bf16 v[152:155], a[116:119], a[0:3], v[152:155]
v_mfma_f32_16x16x32_bf16 a[80:83], a[120:123], a[72:75], a[80:83]
s_waitcnt vmcnt(12) lgkmcnt(0)
v_mfma_f32_16x16x32_bf16 v[132:135], a[128:131], a[16:19], v[132:135]
ds_read_b128 a[96:99], v5 offset:36864
v_mfma_f32_16x16x32_bf16 v[156:159], a[128:131], a[20:23], v[156:159]
buffer_load_dwordx4 a[0:3], v2, s[40:43], s35 offen offset:0 sc1
v_mfma_f32_16x16x32_bf16 v[180:183], a[128:131], a[24:27], v[180:183]
ds_read_b128 a[100:103], v5 offset:37888
v_mfma_f32_16x16x32_bf16 v[204:207], a[128:131], a[28:31], v[204:207]
v_mfma_f32_16x16x32_bf16 v[208:211], a[132:135], a[28:31], v[208:211]
buffer_load_dwordx4 a[76:79], v1, s[24:27], s89 offen
v_mfma_f32_16x16x32_bf16 v[184:187], a[132:135], a[24:27], v[184:187]
ds_read_b128 a[104:107], v5 offset:38912
v_mfma_f32_16x16x32_bf16 v[160:163], a[132:135], a[20:23], v[160:163]
ds_read_b128 a[108:111], v5 offset:39936
v_mfma_f32_16x16x32_bf16 v[136:139], a[132:135], a[16:19], v[136:139]
buffer_load_dwordx4 a[4:7], v2, s[40:43], s35 offen offset:1024 sc1
v_mfma_f32_16x16x32_bf16 v[140:143], a[136:139], a[16:19], v[140:143]
v_mfma_f32_16x16x32_bf16 v[164:167], a[136:139], a[20:23], v[164:167]
ds_read_b128 a[112:115], v5 offset:40960
v_mfma_f32_16x16x32_bf16 v[188:191], a[136:139], a[24:27], v[188:191]
buffer_load_dwordx4 v1, s[4:7], s44 offen offset:1024 sc1 lds
v_mfma_f32_16x16x32_bf16 v[212:215], a[136:139], a[28:31], v[212:215]
ds_read_b128 a[116:119], v5 offset:41984
v_mfma_f32_16x16x32_bf16 v[216:219], a[140:143], a[28:31], v[216:219]
v_mfma_f32_16x16x32_bf16 v[192:195], a[140:143], a[24:27], v[192:195]
buffer_load_dwordx4 a[8:11], v2, s[40:43], s35 offen offset:2048 sc1
v_mfma_f32_16x16x32_bf16 v[168:171], a[140:143], a[20:23], v[168:171]
ds_read_b128 a[120:123], v6 offset:28672
v_mfma_f32_16x16x32_bf16 v[144:147], a[140:143], a[16:19], v[144:147]
v_mfma_f32_16x16x32_bf16 v[148:151], a[144:147], a[16:19], v[148:151]
buffer_load_dwordx4 v1, s[4:7], s44 offen offset:2048 sc1 lds
s_add_u32 s63, s28, 28
v_mfma_f32_16x16x32_bf16 v[172:175], a[144:147], a[20:23], v[172:175]
s_add_u32 s63, s63, s33
s_and_b32 s63, s63, 31
s_lshl_b32 s63, s63, 12
v_mfma_f32_16x16x32_bf16 v[196:199], a[144:147], a[24:27], v[196:199]
v_mfma_f32_16x16x32_bf16 v[220:223], a[144:147], a[28:31], v[220:223]
buffer_load_dwordx4 a[68:71], v3, s[40:43], s63 offen sc1
v_mfma_f32_16x16x32_bf16 v[224:227], a[148:151], a[28:31], v[224:227]
v_mfma_f32_16x16x32_bf16 v[200:203], a[148:151], a[24:27], v[200:203]
v_mfma_f32_16x16x32_bf16 v[176:179], a[148:151], a[20:23], v[176:179]
buffer_load_dwordx4 a[12:15], v2, s[40:43], s35 offen offset:3072 sc1
s_add_u32 s35, s35, 4096
v_mfma_f32_16x16x32_bf16 v[152:155], a[148:151], a[16:19], v[152:155]
s_and_b32 s35, s35, 0x1ffff
v_mfma_f32_16x16x32_bf16 a[84:87], a[152:155], a[72:75], a[84:87]
s_waitcnt vmcnt(14) lgkmcnt(0)
v_mfma_f32_16x16x32_bf16 v[132:135], a[96:99], a[32:35], v[132:135]
ds_read_b128 a[128:131], v5 offset:43008
v_add_f32 v92, v92, v96
v_mfma_f32_16x16x32_bf16 v[156:159], a[96:99], a[36:39], v[156:159]
buffer_load_dwordx4 a[16:19], v2, s[40:43], s35 offen offset:0 sc1
v_mfma_f32_16x16x32_bf16 v[180:183], a[96:99], a[40:43], v[180:183]
ds_read_b128 a[132:135], v5 offset:44032
v_add_f32 v100, v100, v104
v_mfma_f32_16x16x32_bf16 v[204:207], a[96:99], a[44:47], v[204:207]
v_add_f32 v108, v108, v112
v_add_f32 v116, v116, v120
v_mfma_f32_16x16x32_bf16 v[208:211], a[100:103], a[44:47], v[208:211]
ds_read_b128 a[136:139], v5 offset:45056
v_add_f32 v124, v124, v128
v_mfma_f32_16x16x32_bf16 v[184:187], a[100:103], a[40:43], v[184:187]
buffer_load_dwordx4 v1, s[4:7], s44 offen offset:3072 sc1 lds
s_add_u32 s44, s28, 8
v_mfma_f32_16x16x32_bf16 v[160:163], a[100:103], a[36:39], v[160:163]
s_lshl_b32 s45, s44, 12
s_add_u32 m0, s45, 32768
s_and_b32 s45, s44, 7
v_mfma_f32_16x16x32_bf16 v[136:139], a[100:103], a[32:35], v[136:139]
s_cmp_eq_u32 s45, s3
s_cselect_b32 s45, 8, 0
s_add_u32 s44, s44, s45
v_mfma_f32_16x16x32_bf16 v[140:143], a[104:107], a[32:35], v[140:143]
s_and_b32 s44, s44, 31
s_lshl_b32 s44, s44, 12
s_add_u32 s44, s44, s51
v_mfma_f32_16x16x32_bf16 v[164:167], a[104:107], a[36:39], v[164:167]
buffer_load_dwordx4 a[20:23], v2, s[40:43], s35 offen offset:1024 sc1
v_mfma_f32_16x16x32_bf16 v[188:191], a[104:107], a[40:43], v[188:191]
ds_read_b128 a[140:143], v5 offset:46080
v_add_f32 v93, v93, v97
v_mfma_f32_16x16x32_bf16 v[212:215], a[104:107], a[44:47], v[212:215]
ds_read_b128 a[144:147], v5 offset:47104
v_add_f32 v101, v101, v105
v_mfma_f32_16x16x32_bf16 v[216:219], a[108:111], a[44:47], v[216:219]
ds_read_b128 a[148:151], v5 offset:48128
v_add_f32 v109, v109, v113
v_mfma_f32_16x16x32_bf16 v[192:195], a[108:111], a[40:43], v[192:195]
buffer_load_dwordx4 a[24:27], v2, s[40:43], s35 offen offset:2048 sc1
v_mfma_f32_16x16x32_bf16 v[168:171], a[108:111], a[36:39], v[168:171]
ds_read_b128 a[152:155], v6 offset:29696
v_add_f32 v117, v117, v121
v_mfma_f32_16x16x32_bf16 v[144:147], a[108:111], a[32:35], v[144:147]
v_add_f32 v125, v125, v129
v_add_f32 v94, v94, v98
v_mfma_f32_16x16x32_bf16 v[148:151], a[112:115], a[32:35], v[148:151]
v_add_f32 v102, v102, v106
v_add_f32 v110, v110, v114
v_mfma_f32_16x16x32_bf16 v[172:175], a[112:115], a[36:39], v[172:175]
buffer_load_dwordx4 v1, s[4:7], s44 offen offset:0 sc1 lds
v_mfma_f32_16x16x32_bf16 v[196:199], a[112:115], a[40:43], v[196:199]
v_add_f32 v118, v118, v122
v_add_f32 v126, v126, v130
v_mfma_f32_16x16x32_bf16 v[220:223], a[112:115], a[44:47], v[220:223]
v_add_f32 v95, v95, v99
v_add_f32 v103, v103, v107
v_mfma_f32_16x16x32_bf16 v[224:227], a[116:119], a[44:47], v[224:227]
v_add_f32 v111, v111, v115
v_add_f32 v119, v119, v123
v_mfma_f32_16x16x32_bf16 v[200:203], a[116:119], a[40:43], v[200:203]
buffer_load_dwordx4 a[28:31], v2, s[40:43], s35 offen offset:3072 sc1
s_add_u32 s35, s35, 4096
v_mfma_f32_16x16x32_bf16 v[176:179], a[116:119], a[36:39], v[176:179]
s_and_b32 s35, s35, 0x1ffff
v_add_f32 v127, v127, v131
v_mfma_f32_16x16x32_bf16 v[152:155], a[116:119], a[32:35], v[152:155]
v_add_f32_dpp v92, v92, v92 row_ror:8 row_mask:0xf bank_mask:0xf
v_add_f32_dpp v100, v100, v100 row_ror:8 row_mask:0xf bank_mask:0xf
v_mfma_f32_16x16x32_bf16 a[88:91], a[120:123], a[72:75], a[88:91]
s_waitcnt vmcnt(14) lgkmcnt(0)
s_barrier
v_mfma_f32_16x16x32_bf16 v[132:135], a[128:131], a[48:51], v[132:135]
v_add_u32 v5, 0, v1
v_add_u32 v6, s55, v5
v_mfma_f32_16x16x32_bf16 v[156:159], a[128:131], a[52:55], v[156:159]
buffer_load_dwordx4 a[32:35], v2, s[40:43], s35 offen offset:0 sc1
v_mfma_f32_16x16x32_bf16 v[180:183], a[128:131], a[56:59], v[180:183]
ds_read_b128 a[96:99], v5 offset:0
v_add_f32_dpp v108, v108, v108 row_ror:8 row_mask:0xf bank_mask:0xf
v_mfma_f32_16x16x32_bf16 v[204:207], a[128:131], a[60:63], v[204:207]
ds_read_b128 a[100:103], v5 offset:1024
v_add_f32_dpp v116, v116, v116 row_ror:8 row_mask:0xf bank_mask:0xf
v_mfma_f32_16x16x32_bf16 v[208:211], a[132:135], a[60:63], v[208:211]
ds_read_b128 a[104:107], v5 offset:2048
v_add_f32_dpp v124, v124, v124 row_ror:8 row_mask:0xf bank_mask:0xf
v_mfma_f32_16x16x32_bf16 v[184:187], a[132:135], a[56:59], v[184:187]
v_add_f32_dpp v93, v93, v93 row_ror:8 row_mask:0xf bank_mask:0xf
v_add_f32_dpp v101, v101, v101 row_ror:8 row_mask:0xf bank_mask:0xf
v_mfma_f32_16x16x32_bf16 v[160:163], a[132:135], a[52:55], v[160:163]
buffer_load_dwordx4 a[36:39], v2, s[40:43], s35 offen offset:1024 sc1
v_mfma_f32_16x16x32_bf16 v[136:139], a[132:135], a[48:51], v[136:139]
ds_read_b128 a[108:111], v5 offset:3072
v_add_f32_dpp v109, v109, v109 row_ror:8 row_mask:0xf bank_mask:0xf
v_mfma_f32_16x16x32_bf16 v[140:143], a[136:139], a[48:51], v[140:143]
ds_read_b128 a[112:115], v5 offset:4096
v_add_f32_dpp v117, v117, v117 row_ror:8 row_mask:0xf bank_mask:0xf
v_mfma_f32_16x16x32_bf16 v[164:167], a[136:139], a[52:55], v[164:167]
v_add_f32_dpp v125, v125, v125 row_ror:8 row_mask:0xf bank_mask:0xf
v_add_f32_dpp v92, v94, v94 row_ror:8 row_mask:0xf bank_mask:0xc
v_mfma_f32_16x16x32_bf16 v[188:191], a[136:139], a[56:59], v[188:191]
ds_read_b128 a[116:119], v5 offset:5120
v_add_f32_dpp v100, v102, v102 row_ror:8 row_mask:0xf bank_mask:0xc
v_mfma_f32_16x16x32_bf16 v[212:215], a[136:139], a[60:63], v[212:215]
buffer_load_dwordx4 v1, s[4:7], s44 offen offset:1024 sc1 lds
v_mfma_f32_16x16x32_bf16 v[216:219], a[140:143], a[60:63], v[216:219]
ds_read_b128 a[120:123], v6 offset:2048
v_add_f32_dpp v108, v110, v110 row_ror:8 row_mask:0xf bank_mask:0xc
v_mfma_f32_16x16x32_bf16 v[192:195], a[140:143], a[56:59], v[192:195]
v_add_f32_dpp v116, v118, v118 row_ror:8 row_mask:0xf bank_mask:0xc
v_add_f32_dpp v124, v126, v126 row_ror:8 row_mask:0xf bank_mask:0xc
v_mfma_f32_16x16x32_bf16 v[168:171], a[140:143], a[52:55], v[168:171]
ds_read_b128 a[124:127], v6 offset:26624
v_add_f32_dpp v93, v95, v95 row_ror:8 row_mask:0xf bank_mask:0xc
v_mfma_f32_16x16x32_bf16 v[144:147], a[140:143], a[48:51], v[144:147]
v_add_f32_dpp v101, v103, v103 row_ror:8 row_mask:0xf bank_mask:0xc
v_add_f32_dpp v109, v111, v111 row_ror:8 row_mask:0xf bank_mask:0xc
v_mfma_f32_16x16x32_bf16 v[148:151], a[144:147], a[48:51], v[148:151]
buffer_load_dwordx4 a[40:43], v2, s[40:43], s35 offen offset:2048 sc1
v_mfma_f32_16x16x32_bf16 v[172:175], a[144:147], a[52:55], v[172:175]
v_add_f32_dpp v117, v119, v119 row_ror:8 row_mask:0xf bank_mask:0xc
v_add_f32_dpp v125, v127, v127 row_ror:8 row_mask:0xf bank_mask:0xc
v_mfma_f32_16x16x32_bf16 v[196:199], a[144:147], a[56:59], v[196:199]
v_permlane32_swap_b32 v92, v93
v_mfma_f32_16x16x32_bf16 v[220:223], a[144:147], a[60:63], v[220:223]
v_permlane32_swap_b32 v100, v101
v_mfma_f32_16x16x32_bf16 v[224:227], a[148:151], a[60:63], v[224:227]
v_permlane32_swap_b32 v108, v109
v_mfma_f32_16x16x32_bf16 v[200:203], a[148:151], a[56:59], v[200:203]
buffer_load_dwordx4 a[44:47], v2, s[40:43], s35 offen offset:3072 sc1
s_add_u32 s35, s35, 4096
v_mfma_f32_16x16x32_bf16 v[176:179], a[148:151], a[52:55], v[176:179]
s_and_b32 s35, s35, 0x1ffff
v_mfma_f32_16x16x32_bf16 v[152:155], a[148:151], a[48:51], v[152:155]
v_permlane32_swap_b32 v116, v117
v_mfma_f32_16x16x32_bf16 a[92:95], a[152:155], a[72:75], a[92:95]
s_waitcnt vmcnt(11) lgkmcnt(0)
v_mfma_f32_16x16x32_bf16 v[132:135], a[96:99], a[0:3], v[132:135]
ds_read_b128 a[128:131], v5 offset:6144
v_mfma_f32_16x16x32_bf16 v[156:159], a[96:99], a[4:7], v[156:159]
buffer_load_dwordx4 a[48:51], v2, s[40:43], s35 offen offset:0 sc1
v_mfma_f32_16x16x32_bf16 v[180:183], a[96:99], a[8:11], v[180:183]
ds_read_b128 a[132:135], v5 offset:7168
v_mfma_f32_16x16x32_bf16 v[204:207], a[96:99], a[12:15], v[204:207]
v_permlane32_swap_b32 v124, v125
v_mfma_f32_16x16x32_bf16 v[208:211], a[100:103], a[12:15], v[208:211]
ds_read_b128 a[136:139], v5 offset:8192
v_add_f32 v92, v92, v93
v_mfma_f32_16x16x32_bf16 v[184:187], a[100:103], a[8:11], v[184:187]
buffer_load_dwordx4 v1, s[4:7], s44 offen offset:2048 sc1 lds
v_mfma_f32_16x16x32_bf16 v[160:163], a[100:103], a[4:7], v[160:163]
ds_read_b128 a[140:143], v5 offset:9216
v_add_f32 v100, v100, v101
v_mfma_f32_16x16x32_bf16 v[136:139], a[100:103], a[0:3], v[136:139]
v_add_f32 v108, v108, v109
v_add_f32 v116, v116, v117
v_mfma_f32_16x16x32_bf16 v[140:143], a[104:107], a[0:3], v[140:143]
ds_read_b128 a[144:147], v5 offset:10240
v_add_f32 v124, v124, v125
v_mfma_f32_16x16x32_bf16 v[164:167], a[104:107], a[4:7], v[164:167]
buffer_load_dwordx4 a[52:55], v2, s[40:43], s35 offen offset:1024 sc1
v_mfma_f32_16x16x32_bf16 v[188:191], a[104:107], a[8:11], v[188:191]
ds_read_b128 a[148:151], v5 offset:11264
v_mov_b32 v94, v92
v_mfma_f32_16x16x32_bf16 v[212:215], a[104:107], a[12:15], v[212:215]
v_mov_b32 v102, v100
v_mov_b32 v110, v108
v_mfma_f32_16x16x32_bf16 v[216:219], a[108:111], a[12:15], v[216:219]
ds_read_b128 a[152:155], v6 offset:3072
v_mov_b32 v118, v116
v_mfma_f32_16x16x32_bf16 v[192:195], a[108:111], a[8:11], v[192:195]
v_mov_b32 v126, v124
v_mfma_f32_16x16x32_bf16 v[168:171], a[108:111], a[4:7], v[168:171]
buffer_load_dwordx4 a[56:59], v2, s[40:43], s35 offen offset:2048 sc1
v_mfma_f32_16x16x32_bf16 v[144:147], a[108:111], a[0:3], v[144:147]
ds_read_b128 a[156:159], v6 offset:27648
v_mfma_f32_16x16x32_bf16 v[148:151], a[112:115], a[0:3], v[148:151]
v_permlane16_swap_b32 v92, v94
v_mfma_f32_16x16x32_bf16 v[172:175], a[112:115], a[4:7], v[172:175]
v_permlane16_swap_b32 v100, v102
v_mfma_f32_16x16x32_bf16 v[196:199], a[112:115], a[8:11], v[196:199]
buffer_load_dwordx4 v1, s[4:7], s44 offen offset:3072 sc1 lds
s_add_u32 s44, s28, 12
v_mfma_f32_16x16x32_bf16 v[220:223], a[112:115], a[12:15], v[220:223]
s_lshl_b32 s45, s44, 12
s_add_u32 m0, s45, 32768
s_and_b32 s45, s44, 7
v_mfma_f32_16x16x32_bf16 v[224:227], a[116:119], a[12:15], v[224:227]
s_cmp_eq_u32 s45, s3
s_cselect_b32 s45, 8, 0
s_add_u32 s44, s44, s45
v_mfma_f32_16x16x32_bf16 v[200:203], a[116:119], a[8:11], v[200:203]
s_and_b32 s44, s44, 31
s_lshl_b32 s44, s44, 12
s_add_u32 s44, s44, s51
v_mfma_f32_16x16x32_bf16 v[176:179], a[116:119], a[4:7], v[176:179]
buffer_load_dwordx4 a[60:63], v2, s[40:43], s35 offen offset:3072 sc1
s_add_u32 s35, s35, 4096
v_mfma_f32_16x16x32_bf16 v[152:155], a[116:119], a[0:3], v[152:155]
s_and_b32 s35, s35, 0x1ffff
v_mfma_f32_16x16x32_bf16 a[80:83], a[120:123], a[64:67], a[80:83]
v_permlane16_swap_b32 v108, v110
v_mfma_f32_16x16x32_bf16 a[80:83], a[124:127], a[68:71], a[80:83]
s_waitcnt vmcnt(11) lgkmcnt(0)
v_mfma_f32_16x16x32_bf16 v[132:135], a[128:131], a[16:19], v[132:135]
ds_read_b128 a[96:99], v5 offset:12288
v_mfma_f32_16x16x32_bf16 v[156:159], a[128:131], a[20:23], v[156:159]
buffer_load_dwordx4 a[0:3], v2, s[40:43], s35 offen offset:0 sc1
v_mfma_f32_16x16x32_bf16 v[180:183], a[128:131], a[24:27], v[180:183]
ds_read_b128 a[100:103], v5 offset:13312
v_mfma_f32_16x16x32_bf16 v[204:207], a[128:131], a[28:31], v[204:207]
v_permlane16_swap_b32 v116, v118
v_mfma_f32_16x16x32_bf16 v[208:211], a[132:135], a[28:31], v[208:211]
ds_read_b128 a[104:107], v5 offset:14336
v_mfma_f32_16x16x32_bf16 v[184:187], a[132:135], a[24:27], v[184:187]
buffer_load_dwordx4 v1, s[4:7], s44 offen offset:0 sc1 lds
v_mfma_f32_16x16x32_bf16 v[160:163], a[132:135], a[20:23], v[160:163]
ds_read_b128 a[108:111], v5 offset:15360
v_mfma_f32_16x16x32_bf16 v[136:139], a[132:135], a[16:19], v[136:139]
v_permlane16_swap_b32 v124, v126
v_mfma_f32_16x16x32_bf16 v[140:143], a[136:139], a[16:19], v[140:143]
ds_read_b128 a[112:115], v5 offset:16384
v_add_f32 v92, v92, v94
v_mfma_f32_16x16x32_bf16 v[164:167], a[136:139], a[20:23], v[164:167]
buffer_load_dwordx4 a[4:7], v2, s[40:43], s35 offen offset:1024 sc1
v_mfma_f32_16x16x32_bf16 v[188:191], a[136:139], a[24:27], v[188:191]
ds_read_b128 a[116:119], v5 offset:17408
v_add_f32 v100, v100, v102
v_mfma_f32_16x16x32_bf16 v[212:215], a[136:139], a[28:31], v[212:215]
v_add_f32 v108, v108, v110
v_add_f32 v116, v116, v118
v_mfma_f32_16x16x32_bf16 v[216:219], a[140:143], a[28:31], v[216:219]
ds_read_b128 a[120:123], v6 offset:4096
v_add_f32 v124, v124, v126
v_mfma_f32_16x16x32_bf16 v[192:195], a[140:143], a[24:27], v[192:195]
v_mov_b32 v94, v92
v_mov_b32 v102, v100
v_mfma_f32_16x16x32_bf16 v[168:171], a[140:143], a[20:23], v[168:171]
buffer_load_dwordx4 a[8:11], v2, s[40:43], s35 offen offset:2048 sc1
v_mfma_f32_16x16x32_bf16 v[144:147], a[140:143], a[16:19], v[144:147]
ds_read_b128 a[124:127], v6 offset:28672
v_mov_b32 v110, v108
v_mfma_f32_16x16x32_bf16 v[148:151], a[144:147], a[16:19], v[148:151]
v_mov_b32 v118, v116
v_mov_b32 v126, v124
v_mfma_f32_16x16x32_bf16 v[172:175], a[144:147], a[20:23], v[172:175]
v_permlane32_swap_b32 v92, v94
v_mfma_f32_16x16x32_bf16 v[196:199], a[144:147], a[24:27], v[196:199]
buffer_load_dwordx4 v1, s[4:7], s44 offen offset:1024 sc1 lds
v_mfma_f32_16x16x32_bf16 v[220:223], a[144:147], a[28:31], v[220:223]
v_permlane32_swap_b32 v100, v102
v_mfma_f32_16x16x32_bf16 v[224:227], a[148:151], a[28:31], v[224:227]
v_permlane32_swap_b32 v108, v110
v_mfma_f32_16x16x32_bf16 v[200:203], a[148:151], a[24:27], v[200:203]
v_permlane32_swap_b32 v116, v118
v_mfma_f32_16x16x32_bf16 v[176:179], a[148:151], a[20:23], v[176:179]
buffer_load_dwordx4 a[12:15], v2, s[40:43], s35 offen offset:3072 sc1
s_add_u32 s35, s35, 4096
v_mfma_f32_16x16x32_bf16 v[152:155], a[148:151], a[16:19], v[152:155]
s_and_b32 s35, s35, 0x1ffff
v_mfma_f32_16x16x32_bf16 a[84:87], a[152:155], a[64:67], a[84:87]
v_permlane32_swap_b32 v124, v126
v_mfma_f32_16x16x32_bf16 a[84:87], a[156:159], a[68:71], a[84:87]
v_mul_f32 v82, 0xba800000, v92
s_waitcnt vmcnt(12) lgkmcnt(0)
v_mfma_f32_16x16x32_bf16 v[132:135], a[96:99], a[32:35], v[132:135]
ds_read_b128 a[128:131], v5 offset:18432
v_mul_f32 v84, 0xba800000, v100
v_mfma_f32_16x16x32_bf16 v[156:159], a[96:99], a[36:39], v[156:159]
buffer_load_dwordx4 a[16:19], v2, s[40:43], s35 offen offset:0 sc1
v_mfma_f32_16x16x32_bf16 v[180:183], a[96:99], a[40:43], v[180:183]
ds_read_b128 a[132:135], v5 offset:19456
v_mul_f32 v86, 0xba800000, v108
v_mfma_f32_16x16x32_bf16 v[204:207], a[96:99], a[44:47], v[204:207]
v_mul_f32 v88, 0xba800000, v116
v_mul_f32 v90, 0xba800000, v124
v_mfma_f32_16x16x32_bf16 v[208:211], a[100:103], a[44:47], v[208:211]
ds_read_b128 a[136:139], v5 offset:20480
v_mul_f32 v94, 0x3a800000, v94
v_mfma_f32_16x16x32_bf16 v[184:187], a[100:103], a[40:43], v[184:187]
v_mul_f32 v102, 0x3a800000, v102
v_mul_f32 v110, 0x3a800000, v110
v_mfma_f32_16x16x32_bf16 v[160:163], a[100:103], a[36:39], v[160:163]
buffer_load_dwordx4 a[20:23], v2, s[40:43], s35 offen offset:1024 sc1
v_mfma_f32_16x16x32_bf16 v[136:139], a[100:103], a[32:35], v[136:139]
ds_read_b128 a[140:143], v5 offset:21504
v_mul_f32 v118, 0x3a800000, v118
v_mul_f32 v126, 0x3a800000, v126
v_fma_f32 v94, -v82, v82, v94
v_fma_f32 v102, -v84, v84, v102
v_fma_f32 v110, -v86, v86, v110
v_fma_f32 v118, -v88, v88, v118
v_fma_f32 v126, -v90, v90, v126
v_max_f32 v94, 0, v94
v_max_f32 v102, 0, v102
v_max_f32 v110, 0, v110
v_max_f32 v118, 0, v118
v_max_f32 v126, 0, v126
v_add_f32 v94, 0x3727c5ac, v94
v_add_f32 v102, 0x3727c5ac, v102
v_add_f32 v110, 0x3727c5ac, v110
v_add_f32 v118, 0x3727c5ac, v118
v_add_f32 v126, 0x3727c5ac, v126
v_rsq_f32 v83, v94
v_rsq_f32 v85, v102
v_rsq_f32 v87, v110
v_rsq_f32 v89, v118
v_rsq_f32 v91, v126
v_mfma_f32_16x16x32_bf16 v[140:143], a[104:107], a[32:35], v[140:143]
ds_read_b128 a[144:147], v5 offset:22528
v_mfma_f32_16x16x32_bf16 v[164:167], a[104:107], a[36:39], v[164:167]
v_fmac_f32 v132, v48, v82
v_mfma_f32_16x16x32_bf16 v[188:191], a[104:107], a[40:43], v[188:191]
ds_read_b128 a[148:151], v5 offset:23552
v_fmac_f32 v156, v48, v84
v_mfma_f32_16x16x32_bf16 v[212:215], a[104:107], a[44:47], v[212:215]
buffer_load_dwordx4 v1, s[4:7], s44 offen offset:2048 sc1 lds
v_mfma_f32_16x16x32_bf16 v[216:219], a[108:111], a[44:47], v[216:219]
ds_read_b128 a[152:155], v6 offset:5120
v_fmac_f32 v180, v48, v86
v_mfma_f32_16x16x32_bf16 v[192:195], a[108:111], a[40:43], v[192:195]
v_fmac_f32 v204, v48, v88
v_fmac_f32 v208, v52, v88
v_mfma_f32_16x16x32_bf16 v[168:171], a[108:111], a[36:39], v[168:171]
ds_read_b128 a[156:159], v6 offset:29696
v_fmac_f32 v184, v52, v86
v_mfma_f32_16x16x32_bf16 v[144:147], a[108:111], a[32:35], v[144:147]
v_fmac_f32 v160, v52, v84
v_mfma_f32_16x16x32_bf16 v[148:151], a[112:115], a[32:35], v[148:151]
buffer_load_dwordx4 a[24:27], v2, s[40:43], s35 offen offset:2048 sc1
v_mfma_f32_16x16x32_bf16 v[172:175], a[112:115], a[36:39], v[172:175]
v_fmac_f32 v136, v52, v82
v_fmac_f32 v140, v56, v82
v_mfma_f32_16x16x32_bf16 v[196:199], a[112:115], a[40:43], v[196:199]
v_fmac_f32 v164, v56, v84
v_mfma_f32_16x16x32_bf16 v[220:223], a[112:115], a[44:47], v[220:223]
v_fmac_f32 v188, v56, v86
v_mfma_f32_16x16x32_bf16 v[224:227], a[116:119], a[44:47], v[224:227]
v_fmac_f32 v212, v56, v88
v_mfma_f32_16x16x32_bf16 v[200:203], a[116:119], a[40:43], v[200:203]
buffer_load_dwordx4 a[28:31], v2, s[40:43], s35 offen offset:3072 sc1
s_add_u32 s35, s35, 4096
v_mfma_f32_16x16x32_bf16 v[176:179], a[116:119], a[36:39], v[176:179]
s_and_b32 s35, s35, 0x1ffff
v_fmac_f32 v216, v60, v88
v_mfma_f32_16x16x32_bf16 v[152:155], a[116:119], a[32:35], v[152:155]
v_fmac_f32 v192, v60, v86
v_fmac_f32 v168, v60, v84
v_mfma_f32_16x16x32_bf16 a[88:91], a[120:123], a[64:67], a[88:91]
v_fmac_f32 v144, v60, v82
v_mfma_f32_16x16x32_bf16 a[88:91], a[124:127], a[68:71], a[88:91]
v_fmac_f32 v148, v64, v82
s_waitcnt vmcnt(11) lgkmcnt(0)
v_mfma_f32_16x16x32_bf16 v[132:135], a[128:131], a[48:51], v[132:135]
ds_read_b128 a[96:99], v5 offset:24576
v_fmac_f32 v172, v64, v84
v_mfma_f32_16x16x32_bf16 v[156:159], a[128:131], a[52:55], v[156:159]
buffer_load_dwordx4 a[32:35], v2, s[40:43], s35 offen offset:0 sc1
s_lshl_b32 s90, s28, 12
v_mfma_f32_16x16x32_bf16 v[180:183], a[128:131], a[56:59], v[180:183]
ds_read_b128 a[100:103], v5 offset:25600
v_fmac_f32 v196, v64, v86
v_mfma_f32_16x16x32_bf16 v[204:207], a[128:131], a[60:63], v[204:207]
v_fmac_f32 v220, v64, v88
v_fmac_f32 v224, v68, v88
v_mfma_f32_16x16x32_bf16 v[208:211], a[132:135], a[60:63], v[208:211]
v_fmac_f32 v200, v68, v86
s_add_u32 s90, s90, 147456
v_mfma_f32_16x16x32_bf16 v[184:187], a[132:135], a[56:59], v[184:187]
buffer_load_dwordx4 v1, s[4:7], s44 offen offset:3072 sc1 lds
s_add_u32 s44, s28, 16
v_mfma_f32_16x16x32_bf16 v[160:163], a[132:135], a[52:55], v[160:163]
s_lshl_b32 s45, s44, 12
s_add_u32 m0, s45, 32768
s_and_b32 s45, s44, 7
v_mfma_f32_16x16x32_bf16 v[136:139], a[132:135], a[48:51], v[136:139]
s_cmp_eq_u32 s45, s3
s_cselect_b32 s45, 8, 0
s_add_u32 s44, s44, s45
v_mfma_f32_16x16x32_bf16 v[140:143], a[136:139], a[48:51], v[140:143]
s_and_b32 s44, s44, 31
s_lshl_b32 s44, s44, 12
s_add_u32 s44, s44, s51
v_mfma_f32_16x16x32_bf16 v[164:167], a[136:139], a[52:55], v[164:167]
buffer_load_dwordx4 a[36:39], v2, s[40:43], s35 offen offset:1024 sc1
v_mfma_f32_16x16x32_bf16 v[188:191], a[136:139], a[56:59], v[188:191]
ds_read_b128 a[104:107], v5 offset:26624
v_fmac_f32 v176, v68, v84
v_mfma_f32_16x16x32_bf16 v[212:215], a[136:139], a[60:63], v[212:215]
ds_read_b128 a[108:111], v5 offset:27648
v_fmac_f32 v152, v68, v82
v_mfma_f32_16x16x32_bf16 v[216:219], a[140:143], a[60:63], v[216:219]
ds_read_b128 a[112:115], v5 offset:28672
v_fmac_f32 v133, v49, v82
v_mfma_f32_16x16x32_bf16 v[192:195], a[140:143], a[56:59], v[192:195]
ds_read_b128 a[116:119], v5 offset:29696
v_fmac_f32 v157, v49, v84
v_mfma_f32_16x16x32_bf16 v[168:171], a[140:143], a[52:55], v[168:171]
buffer_load_dwordx4 a[40:43], v2, s[40:43], s35 offen offset:2048 sc1
v_mfma_f32_16x16x32_bf16 v[144:147], a[140:143], a[48:51], v[144:147]
v_fmac_f32 v181, v49, v86
v_fmac_f32 v205, v49, v88
v_mfma_f32_16x16x32_bf16 v[148:151], a[144:147], a[48:51], v[148:151]
v_fmac_f32 v209, v53, v88
v_fmac_f32 v185, v53, v86
v_mfma_f32_16x16x32_bf16 v[172:175], a[144:147], a[52:55], v[172:175]
v_fmac_f32 v161, v53, v84
v_fmac_f32 v137, v53, v82
v_mfma_f32_16x16x32_bf16 v[196:199], a[144:147], a[56:59], v[196:199]
buffer_load_dwordx4 v1, s[4:7], s44 offen offset:0 sc1 lds
v_mfma_f32_16x16x32_bf16 v[220:223], a[144:147], a[60:63], v[220:223]
v_fmac_f32 v141, v57, v82
v_fmac_f32 v165, v57, v84
v_mfma_f32_16x16x32_bf16 v[224:227], a[148:151], a[60:63], v[224:227]
v_fmac_f32 v189, v57, v86
v_fmac_f32 v213, v57, v88
v_mfma_f32_16x16x32_bf16 v[200:203], a[148:151], a[56:59], v[200:203]
v_fmac_f32 v217, v61, v88
v_add_u32 v234, s90, v1
v_mfma_f32_16x16x32_bf16 v[176:179], a[148:151], a[52:55], v[176:179]
buffer_load_dwordx4 a[44:47], v2, s[40:43], s35 offen offset:3072 sc1
s_add_u32 s35, s35, 4096
v_mfma_f32_16x16x32_bf16 v[152:155], a[148:151], a[48:51], v[152:155]
s_and_b32 s35, s35, 0x1ffff
v_fmac_f32 v193, v61, v86
v_mfma_f32_16x16x32_bf16 a[92:95], a[152:155], a[64:67], a[92:95]
v_fmac_f32 v169, v61, v84
v_fmac_f32 v145, v61, v82
v_mfma_f32_16x16x32_bf16 a[92:95], a[156:159], a[68:71], a[92:95]
v_fmac_f32 v149, v65, v82
s_lshl_b32 s90, s28, 10
s_add_u32 s90, s90, 147456
v_add_u32 v235, s90, v1
s_waitcnt vmcnt(11) lgkmcnt(0)
v_mfma_f32_16x16x32_bf16 v[132:135], a[96:99], a[0:3], v[132:135]
ds_read_b128 a[128:131], v5 offset:30720
v_fmac_f32 v173, v65, v84
v_mfma_f32_16x16x32_bf16 v[156:159], a[96:99], a[4:7], v[156:159]
buffer_load_dwordx4 a[48:51], v2, s[40:43], s35 offen offset:0 sc1
v_mfma_f32_16x16x32_bf16 v[180:183], a[96:99], a[8:11], v[180:183]
ds_read_b128 a[132:135], v5 offset:31744
v_fmac_f32 v197, v65, v86
v_mfma_f32_16x16x32_bf16 v[204:207], a[96:99], a[12:15], v[204:207]
v_fmac_f32 v221, v65, v88
v_fmac_f32 v225, v69, v88
v_mfma_f32_16x16x32_bf16 v[208:211], a[100:103], a[12:15], v[208:211]
v_fmac_f32 v201, v69, v86
v_mfma_f32_16x16x32_bf16 v[184:187], a[100:103], a[8:11], v[184:187]
buffer_load_dwordx4 v1, s[4:7], s44 offen offset:1024 sc1 lds
v_mfma_f32_16x16x32_bf16 v[160:163], a[100:103], a[4:7], v[160:163]
ds_read_b128 a[136:139], v5 offset:32768
v_fmac_f32 v177, v69, v84
v_mfma_f32_16x16x32_bf16 v[136:139], a[100:103], a[0:3], v[136:139]
v_fmac_f32 v153, v69, v82
v_mfma_f32_16x16x32_bf16 v[140:143], a[104:107], a[0:3], v[140:143]
ds_read_b128 a[140:143], v5 offset:33792
v_mfma_f32_16x16x32_bf16 v[164:167], a[104:107], a[4:7], v[164:167]
buffer_load_dwordx4 a[52:55], v2, s[40:43], s35 offen offset:1024 sc1
v_mfma_f32_16x16x32_bf16 v[188:191], a[104:107], a[8:11], v[188:191]
ds_read_b128 a[144:147], v5 offset:34816
v_fmac_f32 v134, v50, v82
v_mfma_f32_16x16x32_bf16 v[212:215], a[104:107], a[12:15], v[212:215]
v_fmac_f32 v158, v50, v84
v_fmac_f32 v182, v50, v86
v_mfma_f32_16x16x32_bf16 v[216:219], a[108:111], a[12:15], v[216:219]
v_fmac_f32 v206, v50, v88
v_mfma_f32_16x16x32_bf16 v[192:195], a[108:111], a[8:11], v[192:195]
buffer_load_dwordx4 a[56:59], v2, s[40:43], s35 offen offset:2048 sc1
v_mfma_f32_16x16x32_bf16 v[168:171], a[108:111], a[4:7], v[168:171]
ds_read_b128 a[148:151], v5 offset:35840
v_fmac_f32 v210, v54, v88
v_mfma_f32_16x16x32_bf16 v[144:147], a[108:111], a[0:3], v[144:147]
v_fmac_f32 v186, v54, v86
v_fmac_f32 v162, v54, v84
v_mfma_f32_16x16x32_bf16 v[148:151], a[112:115], a[0:3], v[148:151]
v_fmac_f32 v138, v54, v82
v_mfma_f32_16x16x32_bf16 v[172:175], a[112:115], a[4:7], v[172:175]
buffer_load_dwordx4 v1, s[4:7], s44 offen offset:2048 sc1 lds
v_mfma_f32_16x16x32_bf16 v[196:199], a[112:115], a[8:11], v[196:199]
v_fmac_f32 v142, v58, v82
v_fmac_f32 v166, v58, v84
v_mfma_f32_16x16x32_bf16 v[220:223], a[112:115], a[12:15], v[220:223]
v_fmac_f32 v190, v58, v86
v_mfma_f32_16x16x32_bf16 v[224:227], a[116:119], a[12:15], v[224:227]
v_fmac_f32 v214, v58, v88
v_mfma_f32_16x16x32_bf16 v[200:203], a[116:119], a[8:11], v[200:203]
buffer_load_dwordx4 a[60:63], v2, s[40:43], s35 offen offset:3072 sc1
s_add_u32 s35, s35, 4096
v_mfma_f32_16x16x32_bf16 v[176:179], a[116:119], a[4:7], v[176:179]
s_and_b32 s35, s35, 0x1ffff
v_fmac_f32 v218, v62, v88
v_mfma_f32_16x16x32_bf16 v[152:155], a[116:119], a[0:3], v[152:155]
v_fmac_f32 v194, v62, v86
s_waitcnt vmcnt(12) lgkmcnt(0)
v_mfma_f32_16x16x32_bf16 v[132:135], a[128:131], a[16:19], v[132:135]
ds_read_b128 a[96:99], v5 offset:36864
v_fmac_f32 v170, v62, v84
v_mfma_f32_16x16x32_bf16 v[156:159], a[128:131], a[20:23], v[156:159]
buffer_load_dwordx4 v1, s[4:7], s44 offen offset:3072 sc1 lds
s_add_u32 s44, s28, 20
v_mfma_f32_16x16x32_bf16 v[180:183], a[128:131], a[24:27], v[180:183]
s_lshl_b32 s45, s44, 12
s_add_u32 m0, s45, 32768
s_and_b32 s45, s44, 7
v_mfma_f32_16x16x32_bf16 v[204:207], a[128:131], a[28:31], v[204:207]
s_cmp_eq_u32 s45, s3
s_cselect_b32 s45, 8, 0
s_add_u32 s44, s44, s45
v_mfma_f32_16x16x32_bf16 v[208:211], a[132:135], a[28:31], v[208:211]
s_and_b32 s44, s44, 31
s_lshl_b32 s44, s44, 12
s_add_u32 s44, s44, s51
v_mfma_f32_16x16x32_bf16 v[184:187], a[132:135], a[24:27], v[184:187]
buffer_load_dwordx4 v1, s[4:7], s44 offen offset:0 sc1 lds
v_mfma_f32_16x16x32_bf16 v[160:163], a[132:135], a[20:23], v[160:163]
ds_read_b128 a[100:103], v5 offset:37888
v_fmac_f32 v146, v62, v82
v_mfma_f32_16x16x32_bf16 v[136:139], a[132:135], a[16:19], v[136:139]
ds_read_b128 a[104:107], v5 offset:38912
v_fmac_f32 v150, v66, v82
v_mfma_f32_16x16x32_bf16 v[140:143], a[136:139], a[16:19], v[140:143]
ds_read_b128 a[108:111], v5 offset:39936
v_fmac_f32 v174, v66, v84
v_mfma_f32_16x16x32_bf16 v[164:167], a[136:139], a[20:23], v[164:167]
v_fmac_f32 v198, v66, v86
v_fmac_f32 v222, v66, v88
v_mfma_f32_16x16x32_bf16 v[188:191], a[136:139], a[24:27], v[188:191]
buffer_load_dwordx4 v1, s[4:7], s44 offen offset:1024 sc1 lds
v_mfma_f32_16x16x32_bf16 v[212:215], a[136:139], a[28:31], v[212:215]
ds_read_b128 a[112:115], v5 offset:40960
v_fmac_f32 v226, v70, v88
v_mfma_f32_16x16x32_bf16 v[216:219], a[140:143], a[28:31], v[216:219]
v_fmac_f32 v202, v70, v86
v_fmac_f32 v178, v70, v84
v_mfma_f32_16x16x32_bf16 v[192:195], a[140:143], a[24:27], v[192:195]
ds_read_b128 a[116:119], v5 offset:41984
v_fmac_f32 v154, v70, v82
v_mfma_f32_16x16x32_bf16 v[168:171], a[140:143], a[20:23], v[168:171]
v_fmac_f32 v135, v51, v82
v_fmac_f32 v159, v51, v84
v_mfma_f32_16x16x32_bf16 v[144:147], a[140:143], a[16:19], v[144:147]
buffer_load_dwordx4 v1, s[4:7], s44 offen offset:2048 sc1 lds
v_mfma_f32_16x16x32_bf16 v[148:151], a[144:147], a[16:19], v[148:151]
v_fmac_f32 v183, v51, v86
v_fmac_f32 v207, v51, v88
v_mfma_f32_16x16x32_bf16 v[172:175], a[144:147], a[20:23], v[172:175]
v_fmac_f32 v211, v55, v88
v_fmac_f32 v187, v55, v86
v_mfma_f32_16x16x32_bf16 v[196:199], a[144:147], a[24:27], v[196:199]
v_fmac_f32 v163, v55, v84
v_fmac_f32 v139, v55, v82
v_mfma_f32_16x16x32_bf16 v[220:223], a[144:147], a[28:31], v[220:223]
v_fmac_f32 v143, v59, v82
v_fmac_f32 v167, v59, v84
v_mfma_f32_16x16x32_bf16 v[224:227], a[148:151], a[28:31], v[224:227]
buffer_load_dwordx4 v1, s[4:7], s44 offen offset:3072 sc1 lds
s_add_u32 s44, s28, 24
v_mfma_f32_16x16x32_bf16 v[200:203], a[148:151], a[24:27], v[200:203]
s_lshl_b32 s45, s44, 12
s_add_u32 m0, s45, 32768
s_and_b32 s45, s44, 7
v_mfma_f32_16x16x32_bf16 v[176:179], a[148:151], a[20:23], v[176:179]
s_cmp_eq_u32 s45, s3
s_cselect_b32 s45, 8, 0
s_add_u32 s44, s44, s45
v_mfma_f32_16x16x32_bf16 v[152:155], a[148:151], a[16:19], v[152:155]
s_and_b32 s44, s44, 31
s_waitcnt vmcnt(11) lgkmcnt(0)
v_mfma_f32_16x16x32_bf16 v[132:135], a[96:99], a[32:35], v[132:135]
s_lshl_b32 s44, s44, 12
s_add_u32 s44, s44, s51
v_mfma_f32_16x16x32_bf16 v[156:159], a[96:99], a[36:39], v[156:159]
buffer_load_dwordx4 v1, s[4:7], s44 offen offset:0 sc1 lds
v_mfma_f32_16x16x32_bf16 v[180:183], a[96:99], a[40:43], v[180:183]
ds_read_b128 a[128:131], v5 offset:43008
v_fmac_f32 v191, v59, v86
v_mfma_f32_16x16x32_bf16 v[204:207], a[96:99], a[44:47], v[204:207]
ds_read_b128 a[132:135], v5 offset:44032
v_fmac_f32 v215, v59, v88
v_mfma_f32_16x16x32_bf16 v[208:211], a[100:103], a[44:47], v[208:211]
v_fmac_f32 v219, v63, v88
v_fmac_f32 v195, v63, v86
v_mfma_f32_16x16x32_bf16 v[184:187], a[100:103], a[40:43], v[184:187]
ds_read_b128 a[136:139], v5 offset:45056
v_fmac_f32 v171, v63, v84
v_mfma_f32_16x16x32_bf16 v[160:163], a[100:103], a[36:39], v[160:163]
v_fmac_f32 v147, v63, v82
v_fmac_f32 v151, v67, v82
v_mfma_f32_16x16x32_bf16 v[136:139], a[100:103], a[32:35], v[136:139]
buffer_load_dwordx4 v1, s[4:7], s44 offen offset:1024 sc1 lds
v_mfma_f32_16x16x32_bf16 v[140:143], a[104:107], a[32:35], v[140:143]
ds_read_b128 a[140:143], v5 offset:46080
v_fmac_f32 v175, v67, v84
v_mfma_f32_16x16x32_bf16 v[164:167], a[104:107], a[36:39], v[164:167]
v_fmac_f32 v199, v67, v86
v_fmac_f32 v223, v67, v88
v_mfma_f32_16x16x32_bf16 v[188:191], a[104:107], a[40:43], v[188:191]
ds_read_b128 a[144:147], v5 offset:47104
v_fmac_f32 v227, v71, v88
v_mfma_f32_16x16x32_bf16 v[212:215], a[104:107], a[44:47], v[212:215]
v_fmac_f32 v203, v71, v86
v_fmac_f32 v179, v71, v84
v_mfma_f32_16x16x32_bf16 v[216:219], a[108:111], a[44:47], v[216:219]
v_fmac_f32 v155, v71, v82
v_mfma_f32_16x16x32_bf16 v[192:195], a[108:111], a[40:43], v[192:195]
buffer_load_dwordx4 v1, s[4:7], s44 offen offset:2048 sc1 lds
v_mfma_f32_16x16x32_bf16 v[168:171], a[108:111], a[36:39], v[168:171]
ds_read_b128 a[148:151], v5 offset:48128
v_mfma_f32_16x16x32_bf16 v[144:147], a[108:111], a[32:35], v[144:147]
ds_write_b128 v234, a[80:83] offset:0
v_mfma_f32_16x16x32_bf16 v[148:151], a[112:115], a[32:35], v[148:151]
ds_write_b128 v234, a[84:87] offset:1024
v_mfma_f32_16x16x32_bf16 v[172:175], a[112:115], a[36:39], v[172:175]
ds_write_b128 v234, a[88:91] offset:2048
v_mfma_f32_16x16x32_bf16 v[196:199], a[112:115], a[40:43], v[196:199]
ds_write_b128 v234, a[92:95] offset:3072
v_mfma_f32_16x16x32_bf16 v[220:223], a[112:115], a[44:47], v[220:223]
buffer_load_dwordx4 v1, s[4:7], s44 offen offset:3072 sc1 lds
v_mfma_f32_16x16x32_bf16 v[224:227], a[116:119], a[44:47], v[224:227]
v_mfma_f32_16x16x32_bf16 v[200:203], a[116:119], a[40:43], v[200:203]
v_mfma_f32_16x16x32_bf16 v[176:179], a[116:119], a[36:39], v[176:179]
v_mfma_f32_16x16x32_bf16 v[152:155], a[116:119], a[32:35], v[152:155]
s_waitcnt vmcnt(9) lgkmcnt(0)
s_barrier
v_mfma_f32_16x16x32_bf16 v[132:135], a[128:131], a[48:51], v[132:135]
ds_read_b128 v[92:95], v235 offset:0
v_mfma_f32_16x16x32_bf16 v[156:159], a[128:131], a[52:55], v[156:159]
v_mfma_f32_16x16x32_bf16 v[180:183], a[128:131], a[56:59], v[180:183]
ds_read_b128 v[96:99], v235 offset:4096
v_mfma_f32_16x16x32_bf16 v[204:207], a[128:131], a[60:63], v[204:207]
v_mfma_f32_16x16x32_bf16 v[208:211], a[132:135], a[60:63], v[208:211]
ds_read_b128 v[100:103], v235 offset:8192
v_mfma_f32_16x16x32_bf16 v[184:187], a[132:135], a[56:59], v[184:187]
v_mfma_f32_16x16x32_bf16 v[160:163], a[132:135], a[52:55], v[160:163]
ds_read_b128 v[104:107], v235 offset:12288
v_mfma_f32_16x16x32_bf16 v[136:139], a[132:135], a[48:51], v[136:139]
v_mfma_f32_16x16x32_bf16 v[140:143], a[136:139], a[48:51], v[140:143]
v_mfma_f32_16x16x32_bf16 v[164:167], a[136:139], a[52:55], v[164:167]
v_mfma_f32_16x16x32_bf16 v[188:191], a[136:139], a[56:59], v[188:191]
v_mfma_f32_16x16x32_bf16 v[212:215], a[136:139], a[60:63], v[212:215]
v_mfma_f32_16x16x32_bf16 v[216:219], a[140:143], a[60:63], v[216:219]
v_mfma_f32_16x16x32_bf16 v[192:195], a[140:143], a[56:59], v[192:195]
v_mfma_f32_16x16x32_bf16 v[168:171], a[140:143], a[52:55], v[168:171]
v_mfma_f32_16x16x32_bf16 v[144:147], a[140:143], a[48:51], v[144:147]
v_mfma_f32_16x16x32_bf16 v[148:151], a[144:147], a[48:51], v[148:151]
v_mfma_f32_16x16x32_bf16 v[172:175], a[144:147], a[52:55], v[172:175]
v_mfma_f32_16x16x32_bf16 v[196:199], a[144:147], a[56:59], v[196:199]
v_mfma_f32_16x16x32_bf16 v[220:223], a[144:147], a[60:63], v[220:223]
v_mfma_f32_16x16x32_bf16 v[224:227], a[148:151], a[60:63], v[224:227]
v_mfma_f32_16x16x32_bf16 v[200:203], a[148:151], a[56:59], v[200:203]
v_mfma_f32_16x16x32_bf16 v[176:179], a[148:151], a[52:55], v[176:179]
v_mfma_f32_16x16x32_bf16 v[152:155], a[148:151], a[48:51], v[152:155]
.set L_cpf2, .
s_lshl_b32 s36, s28, 12
s_lshl_b32 s37, s28, 10
s_add_u32 s44, s28, 0
s_lshl_b32 s45, s44, 12
s_add_u32 m0, s45, 32768
s_and_b32 s45, s44, 7
s_cmp_eq_u32 s45, s3
s_cselect_b32 s45, 8, 0
s_add_u32 s44, s44, s45
s_and_b32 s44, s44, 31
s_lshl_b32 s44, s44, 12
s_add_u32 s44, s44, s51
s_waitcnt lgkmcnt(2)
v_add_f32 v92, v92, v96
s_waitcnt lgkmcnt(0)
v_add_f32 v100, v100, v104
v_add_f32 v93, v93, v97
v_add_f32 v101, v101, v105
v_add_f32 v94, v94, v98
v_add_f32 v102, v102, v106
v_add_f32 v95, v95, v99
v_add_f32 v103, v103, v107
buffer_load_dwordx4 v1, s[4:7], s44 offen offset:0 sc1 lds
v_add_f32 v228, v92, v100
v_add_f32 v229, v93, v101
v_add_f32 v230, v94, v102
v_add_f32 v231, v95, v103
v_fmac_f32 v228, v72, v90
v_fmac_f32 v229, v73, v90
v_pk_mul_f32 v[212:213], v[212:213], v[88:89] op_sel:[0,1] op_sel_hi:[1,1]
v_pk_mul_f32 v[220:221], v[220:221], v[88:89] op_sel:[0,1] op_sel_hi:[1,1]
v_pk_mul_f32 v[196:197], v[196:197], v[86:87] op_sel:[0,1] op_sel_hi:[1,1]
v_pk_mul_f32 v[172:173], v[172:173], v[84:85] op_sel:[0,1] op_sel_hi:[1,1]
v_pk_mul_f32 v[148:149], v[148:149], v[82:83] op_sel:[0,1] op_sel_hi:[1,1]
buffer_load_dwordx4 v1, s[4:7], s44 offen offset:1024 sc1 lds
v_fmac_f32 v230, v74, v90
v_fmac_f32 v231, v75, v90
v_pk_mul_f32 v[228:229], v[228:229], v[90:91] op_sel:[0,1] op_sel_hi:[1,1]
v_pk_mul_f32 v[214:215], v[214:215], v[88:89] op_sel:[0,1] op_sel_hi:[1,1]
v_pk_mul_f32 v[222:223], v[222:223], v[88:89] op_sel:[0,1] op_sel_hi:[1,1]
v_pk_mul_f32 v[198:199], v[198:199], v[86:87] op_sel:[0,1] op_sel_hi:[1,1]
v_pk_mul_f32 v[174:175], v[174:175], v[84:85] op_sel:[0,1] op_sel_hi:[1,1]
v_pk_mul_f32 v[150:151], v[150:151], v[82:83] op_sel:[0,1] op_sel_hi:[1,1]
v_cvt_pk_bf16_f32 v212, v212, v213
v_cvt_pk_bf16_f32 v220, v220, v221
v_cvt_pk_bf16_f32 v196, v196, v197
v_cvt_pk_bf16_f32 v172, v172, v173
v_cvt_pk_bf16_f32 v148, v148, v149
v_pk_mul_f32 v[230:231], v[230:231], v[90:91] op_sel:[0,1] op_sel_hi:[1,1]
v_pk_mul_f32 v[216:217], v[216:217], v[88:89] op_sel:[0,1] op_sel_hi:[1,1]
v_pk_mul_f32 v[218:219], v[218:219], v[88:89] op_sel:[0,1] op_sel_hi:[1,1]
v_pk_mul_f32 v[224:225], v[224:225], v[88:89] op_sel:[0,1] op_sel_hi:[1,1]
v_pk_mul_f32 v[226:227], v[226:227], v[88:89] op_sel:[0,1] op_sel_hi:[1,1]
v_pk_mul_f32 v[200:201], v[200:201], v[86:87] op_sel:[0,1] op_sel_hi:[1,1]
v_pk_mul_f32 v[202:203], v[202:203], v[86:87] op_sel:[0,1] op_sel_hi:[1,1]
v_pk_mul_f32 v[176:177], v[176:177], v[84:85] op_sel:[0,1] op_sel_hi:[1,1]
v_pk_mul_f32 v[178:179], v[178:179], v[84:85] op_sel:[0,1] op_sel_hi:[1,1]
v_pk_mul_f32 v[152:153], v[152:153], v[82:83] op_sel:[0,1] op_sel_hi:[1,1]
v_pk_mul_f32 v[154:155], v[154:155], v[82:83] op_sel:[0,1] op_sel_hi:[1,1]
v_cvt_pk_bf16_f32 v228, v228, v229
v_cvt_pk_bf16_f32 v213, v214, v215
v_cvt_pk_bf16_f32 v221, v222, v223
v_cvt_pk_bf16_f32 v197, v198, v199
v_cvt_pk_bf16_f32 v173, v174, v175
v_cvt_pk_bf16_f32 v149, v150, v151
buffer_load_dwordx4 v1, s[4:7], s44 offen offset:2048 sc1 lds
v_pk_mul_f32 v[188:189], v[188:189], v[86:87] op_sel:[0,1] op_sel_hi:[1,1]
v_pk_mul_f32 v[164:165], v[164:165], v[84:85] op_sel:[0,1] op_sel_hi:[1,1]
v_pk_mul_f32 v[140:141], v[140:141], v[82:83] op_sel:[0,1] op_sel_hi:[1,1]
v_add_u32 v232, s36, v7
v_add_u32 v233, s37, v1
v_cvt_pk_bf16_f32 v229, v230, v231
v_cvt_pk_bf16_f32 v214, v216, v217
v_cvt_pk_bf16_f32 v215, v218, v219
v_cvt_pk_bf16_f32 v222, v224, v225
v_cvt_pk_bf16_f32 v223, v226, v227
v_cvt_pk_bf16_f32 v198, v200, v201
v_cvt_pk_bf16_f32 v199, v202, v203
v_cvt_pk_bf16_f32 v174, v176, v177
v_cvt_pk_bf16_f32 v175, v178, v179
v_cvt_pk_bf16_f32 v150, v152, v153
v_cvt_pk_bf16_f32 v151, v154, v155
v_pk_mul_f32 v[190:191], v[190:191], v[86:87] op_sel:[0,1] op_sel_hi:[1,1]
v_pk_mul_f32 v[166:167], v[166:167], v[84:85] op_sel:[0,1] op_sel_hi:[1,1]
v_pk_mul_f32 v[142:143], v[142:143], v[82:83] op_sel:[0,1] op_sel_hi:[1,1]
v_cvt_pk_bf16_f32 v188, v188, v189
v_cvt_pk_bf16_f32 v164, v164, v165
v_cvt_pk_bf16_f32 v140, v140, v141
v_cvt_pk_bf16_f32 v132, v132, v133
v_cvt_pk_bf16_f32 v156, v156, v157
v_cvt_pk_bf16_f32 v180, v180, v181
v_cvt_pk_bf16_f32 v204, v204, v205
ds_write_b64 v9, v[228:229]
ds_write_b64 v232, v[220:221] offset:4096
ds_write_b64 v232, v[222:223] offset:4608
v_pk_mul_f32 v[192:193], v[192:193], v[86:87] op_sel:[0,1] op_sel_hi:[1,1]
v_pk_mul_f32 v[194:195], v[194:195], v[86:87] op_sel:[0,1] op_sel_hi:[1,1]
v_pk_mul_f32 v[168:169], v[168:169], v[84:85] op_sel:[0,1] op_sel_hi:[1,1]
ds_write_b64 v232, v[196:197] offset:3072
v_pk_mul_f32 v[170:171], v[170:171], v[84:85] op_sel:[0,1] op_sel_hi:[1,1]
v_pk_mul_f32 v[144:145], v[144:145], v[82:83] op_sel:[0,1] op_sel_hi:[1,1]
v_pk_mul_f32 v[146:147], v[146:147], v[82:83] op_sel:[0,1] op_sel_hi:[1,1]
ds_write_b64 v232, v[198:199] offset:3584
buffer_load_dwordx4 v1, s[4:7], s44 offen offset:3072 sc1 lds
v_cvt_pk_bf16_f32 v189, v190, v191
ds_write_b64 v232, v[172:173] offset:2048
v_cvt_pk_bf16_f32 v165, v166, v167
v_cvt_pk_bf16_f32 v141, v142, v143
ds_write_b64 v232, v[174:175] offset:2560
v_cvt_pk_bf16_f32 v133, v134, v135
v_cvt_pk_bf16_f32 v157, v158, v159
v_cvt_pk_bf16_f32 v181, v182, v183
ds_write_b64 v232, v[148:149] offset:1024
v_cvt_pk_bf16_f32 v205, v206, v207
v_cvt_pk_bf16_f32 v190, v192, v193
v_cvt_pk_bf16_f32 v191, v194, v195
ds_write_b64 v232, v[150:151] offset:1536
v_cvt_pk_bf16_f32 v166, v168, v169
v_cvt_pk_bf16_f32 v167, v170, v171
v_cvt_pk_bf16_f32 v142, v144, v145
ds_write_b128 v233, v[212:215] offset:21504
v_cvt_pk_bf16_f32 v143, v146, v147
v_cvt_pk_bf16_f32 v134, v136, v137
v_cvt_pk_bf16_f32 v135, v138, v139
v_cvt_pk_bf16_f32 v158, v160, v161
v_cvt_pk_bf16_f32 v159, v162, v163
v_cvt_pk_bf16_f32 v182, v184, v185
v_cvt_pk_bf16_f32 v183, v186, v187
v_cvt_pk_bf16_f32 v206, v208, v209
v_cvt_pk_bf16_f32 v207, v210, v211
s_waitcnt lgkmcnt(0)
s_barrier
ds_read_b128 a[0:3], v233 offset:20480
v_mfma_f32_16x16x32_bf16 v[184:187], v[164:167], v[180:183], v[20:23]
v_add_u32 v234, s36, v8
ds_read_b64_tr_b16 a[10:11], v234 offset:3072
v_mfma_f32_16x16x32_bf16 v[200:203], v[188:191], v[180:183], v[24:27]
ds_read_b64_tr_b16 a[12:13], v234 offset:4096
v_mfma_f32_16x16x32_bf16 v[208:211], v[188:191], v[204:207], v[20:23]
ds_read_b64_tr_b16 a[22:23], v234 offset:3584
v_mfma_f32_16x16x32_bf16 v[224:227], v[212:215], v[204:207], v[24:27]
s_nop 3
v_max_f32 v200, v200, v184
v_max_f32 v201, v201, v185
v_mfma_f32_16x16x32_bf16 v[152:155], v[140:143], v[132:135], v[24:27]
v_max_f32 v202, v202, v186
v_max_f32 v203, v203, v187
v_mfma_f32_16x16x32_bf16 v[160:163], v[140:143], v[156:159], v[20:23]
v_max_f32 v224, v224, v208
v_max_f32 v225, v225, v209
v_mfma_f32_16x16x32_bf16 v[176:179], v[164:167], v[156:159], v[24:27]
v_max_f32 v226, v226, v210
v_max3_f32 v238, v200, v201, v202
s_waitcnt lgkmcnt(3)
v_mfma_f32_16x16x32_bf16 v[136:139], a[0:3], v[132:135], v[76:79]
v_max_f32 v227, v227, v211
v_max3_f32 v239, v224, v225, v226
v_max_f32 v238, v238, v203
v_max_f32 v239, v239, v227
v_max_f32 v176, v176, v160
v_max_f32 v177, v177, v161
v_permlane32_swap_b32 v239, v238
s_nop 0
v_max_f32 v152, v152, v136
v_max_f32 v153, v153, v137
v_max_f32 v154, v154, v138
v_max_f32 v178, v178, v162
v_max_f32 v155, v155, v139
v_max3_f32 v236, v152, v153, v154
v_max_f32 v179, v179, v163
v_max3_f32 v237, v176, v177, v178
v_max_f32 v239, v239, v238
v_max_f32 v236, v236, v155
v_max_f32 v237, v237, v179
v_mov_b32 v242, v239
ds_read_b64_tr_b16 a[24:25], v234 offset:4608
v_permlane32_swap_b32 v237, v236
v_permlane16_swap_b32 v239, v242
v_max_f32 v237, v237, v236
v_max_f32 v239, v239, v242
v_mov_b32 v243, v237
v_mov_b32 v242, v239
ds_read_b64_tr_b16 a[8:9], v234 offset:2048
v_permlane16_swap_b32 v237, v243
ds_read_b64_tr_b16 a[20:21], v234 offset:2560
v_permlane32_swap_b32 v239, v242
ds_read_b64_tr_b16 a[6:7], v234 offset:1024
v_mul_f32 v88, 0x3e8293ee, v89
v_max_f32 v237, v237, v243
v_mul_f32_e64 v89, -v239, v88
ds_read_b64_tr_b16 a[18:19], v234 offset:1536
v_mov_b32 v243, v237
ds_read_b64_tr_b16 a[4:5], v234 offset:0
v_fma_f32 v224, v224, v88, v89
v_fma_f32 v225, v225, v88, v89
v_mul_f32 v86, 0x3e8293ee, v87
v_fma_f32 v226, v226, v88, v89
v_fma_f32 v227, v227, v88, v89
v_exp_f32 v224, v224
v_exp_f32 v225, v225
s_lshl_b32 s35, s30, 12
v_mul_f32_e64 v87, -v242, v86
ds_read_b64_tr_b16 a[16:17], v234 offset:512
v_permlane32_swap_b32 v237, v243
v_exp_f32 v226, v226
v_exp_f32 v227, v227
s_add_u32 s35, s35, 0x1e00000
v_fma_f32 v200, v200, v86, v87
v_fma_f32 v201, v201, v86, v87
v_mul_f32 v84, 0x3e8293ee, v85
s_add_u32 s44, s28, 28
v_fma_f32 v202, v202, v86, v87
v_fma_f32 v203, v203, v86, v87
v_exp_f32 v200, v200
v_exp_f32 v201, v201
v_mul_f32_e64 v85, -v237, v84
v_cvt_pk_bf16_f32 v224, v224, v225
s_lshl_b32 s45, s44, 12
v_exp_f32 v202, v202
v_exp_f32 v203, v203
v_cvt_pk_bf16_f32 v225, v226, v227
v_fma_f32 v176, v176, v84, v85
v_fma_f32 v177, v177, v84, v85
v_mul_f32 v82, 0x3e8293ee, v83
s_add_u32 m0, s45, 32768
v_fma_f32 v178, v178, v84, v85
v_fma_f32 v179, v179, v84, v85
v_and_b32 v208, v224, v28
v_and_b32 v209, v225, v29
v_and_b32 v210, v224, v30
v_and_b32 v211, v225, v31
v_exp_f32 v176, v176
v_exp_f32 v177, v177
s_and_b32 s45, s44, 7
v_mul_f32_e64 v83, -v243, v82
v_cvt_pk_bf16_f32 v200, v200, v201
v_exp_f32 v178, v178
v_exp_f32 v179, v179
v_cvt_pk_bf16_f32 v201, v202, v203
s_cmp_eq_u32 s45, s3
v_fma_f32 v152, v152, v82, v83
v_fma_f32 v153, v153, v82, v83
v_fma_f32 v154, v154, v82, v83
v_fma_f32 v155, v155, v82, v83
v_mfma_f32_16x16x32_bf16 v[216:219], v[16:19], v[208:211], 0
v_and_b32 v184, v200, v28
v_and_b32 v185, v201, v29
v_and_b32 v186, v200, v30
v_and_b32 v187, v201, v31
s_cselect_b32 s45, 8, 0
v_exp_f32 v152, v152
v_exp_f32 v153, v153
v_cvt_pk_bf16_f32 v176, v176, v177
v_exp_f32 v154, v154
v_exp_f32 v155, v155
s_add_u32 s44, s44, s45
v_cvt_pk_bf16_f32 v177, v178, v179
v_mfma_f32_16x16x32_bf16 v[192:195], v[16:19], v[184:187], 0
s_and_b32 s44, s44, 31
v_and_b32 v160, v176, v28
v_and_b32 v161, v177, v29
v_and_b32 v162, v176, v30
v_and_b32 v163, v177, v31
s_waitcnt lgkmcnt(8)
v_mfma_f32_16x16x32_bf16 v[116:119], a[10:13], v[208:211], 0
v_cvt_pk_bf16_f32 v152, v152, v153
s_lshl_b32 s44, s44, 12
v_cvt_pk_bf16_f32 v153, v154, v155
s_waitcnt lgkmcnt(6)
v_mfma_f32_16x16x32_bf16 v[120:123], a[22:25], v[208:211], 0
s_add_u32 s44, s44, s51
v_and_b32 v136, v152, v80
v_mfma_f32_16x16x32_bf16 v[168:171], v[16:19], v[160:163], 0
v_and_b32 v137, v153, v81
v_and_b32 v138, v152, v30
v_and_b32 v139, v153, v31
s_waitcnt lgkmcnt(5)
v_mfma_f32_16x16x32_bf16 v[108:111], a[8:11], v[184:187], 0
buffer_load_dwordx4 v1, s[4:7], s44 offen offset:0 sc1 lds
s_waitcnt lgkmcnt(4)
v_mfma_f32_16x16x32_bf16 v[112:115], a[20:23], v[184:187], 0
v_rcp_f32 v216, v216
v_mfma_f32_16x16x32_bf16 v[144:147], v[16:19], v[136:139], 0
buffer_load_dwordx4 v1, s[4:7], s44 offen offset:1024 sc1 lds
s_waitcnt lgkmcnt(3)
v_mfma_f32_16x16x32_bf16 v[100:103], a[6:9], v[160:163], 0
v_rcp_f32 v192, v192
s_waitcnt lgkmcnt(2)
v_mfma_f32_16x16x32_bf16 v[104:107], a[18:21], v[160:163], 0
buffer_load_dwordx4 v1, s[4:7], s44 offen offset:2048 sc1 lds
s_waitcnt lgkmcnt(1)
v_mfma_f32_16x16x32_bf16 v[92:95], a[4:7], v[136:139], 0
v_rcp_f32 v168, v168
s_waitcnt lgkmcnt(0)
v_mfma_f32_16x16x32_bf16 v[96:99], a[16:19], v[136:139], 0
v_rcp_f32 v144, v144
v_pk_mul_f32 v[116:117], v[116:117], v[216:217] op_sel:[0,0] op_sel_hi:[1,0]
v_pk_mul_f32 v[118:119], v[118:119], v[216:217] op_sel:[0,0] op_sel_hi:[1,0]
v_cvt_pk_bf16_f32 v116, v116, v117
v_pk_mul_f32 v[120:121], v[120:121], v[216:217] op_sel:[0,0] op_sel_hi:[1,0]
v_pk_mul_f32 v[122:123], v[122:123], v[216:217] op_sel:[0,0] op_sel_hi:[1,0]
buffer_load_dwordx4 v1, s[4:7], s44 offen offset:3072 sc1 lds
v_cvt_pk_bf16_f32 v117, v118, v119
v_pk_mul_f32 v[108:109], v[108:109], v[192:193] op_sel:[0,0] op_sel_hi:[1,0]
v_cvt_pk_bf16_f32 v118, v120, v121
v_cvt_pk_bf16_f32 v119, v122, v123
v_pk_mul_f32 v[110:111], v[110:111], v[192:193] op_sel:[0,0] op_sel_hi:[1,0]
v_cvt_pk_bf16_f32 v108, v108, v109
v_pk_mul_f32 v[112:113], v[112:113], v[192:193] op_sel:[0,0] op_sel_hi:[1,0]
v_pk_mul_f32 v[114:115], v[114:115], v[192:193] op_sel:[0,0] op_sel_hi:[1,0]
v_cvt_pk_bf16_f32 v109, v110, v111
buffer_store_dwordx4 v[116:119], v2, s[4:7], s35 offen offset:3072 sc1
v_pk_mul_f32 v[100:101], v[100:101], v[168:169] op_sel:[0,0] op_sel_hi:[1,0]
v_cvt_pk_bf16_f32 v110, v112, v113
v_cvt_pk_bf16_f32 v111, v114, v115
v_pk_mul_f32 v[102:103], v[102:103], v[168:169] op_sel:[0,0] op_sel_hi:[1,0]
v_cvt_pk_bf16_f32 v100, v100, v101
v_pk_mul_f32 v[104:105], v[104:105], v[168:169] op_sel:[0,0] op_sel_hi:[1,0]
v_pk_mul_f32 v[106:107], v[106:107], v[168:169] op_sel:[0,0] op_sel_hi:[1,0]
v_cvt_pk_bf16_f32 v101, v102, v103
v_pk_mul_f32 v[92:93], v[92:93], v[144:145] op_sel:[0,0] op_sel_hi:[1,0]
v_cvt_pk_bf16_f32 v102, v104, v105
v_cvt_pk_bf16_f32 v103, v106, v107
v_pk_mul_f32 v[94:95], v[94:95], v[144:145] op_sel:[0,0] op_sel_hi:[1,0]
buffer_store_dwordx4 v[108:111], v2, s[4:7], s35 offen offset:2048 sc1
v_cvt_pk_bf16_f32 v92, v92, v93
v_pk_mul_f32 v[96:97], v[96:97], v[144:145] op_sel:[0,0] op_sel_hi:[1,0]
v_pk_mul_f32 v[98:99], v[98:99], v[144:145] op_sel:[0,0] op_sel_hi:[1,0]
v_cvt_pk_bf16_f32 v93, v94, v95
v_cvt_pk_bf16_f32 v94, v96, v97
v_cvt_pk_bf16_f32 v95, v98, v99
buffer_store_dwordx4 v[100:103], v2, s[4:7], s35 offen offset:1024 sc1
buffer_store_dwordx4 v[92:95], v2, s[4:7], s35 offen offset:0 sc1
s_add_u32 s92, s71, 0x20000
s_add_u32 s40, s4, 0x1e00000
s_addc_u32 s41, s5, 0
v_add_u32 v5, 32768, v1
v_add_u32 v6, 98304, v1
s_cmp_eq_u32 s3, 0
s_cselect_b32 s35, 8, 0
s_lshl_b32 s35, s35, 12
v_lshlrev_b32 v132, 16, v32
v_and_b32 v133, 0xffff0000, v32
v_lshlrev_b32 v134, 16, v33
v_and_b32 v135, 0xffff0000, v33
v_lshlrev_b32 v136, 16, v34
v_and_b32 v137, 0xffff0000, v34
v_lshlrev_b32 v138, 16, v35
v_and_b32 v139, 0xffff0000, v35
v_lshlrev_b32 v140, 16, v36
v_and_b32 v141, 0xffff0000, v36
v_lshlrev_b32 v142, 16, v37
v_and_b32 v143, 0xffff0000, v37
v_lshlrev_b32 v144, 16, v38
v_and_b32 v145, 0xffff0000, v38
v_lshlrev_b32 v146, 16, v39
v_and_b32 v147, 0xffff0000, v39
v_lshlrev_b32 v148, 16, v40
v_and_b32 v149, 0xffff0000, v40
v_lshlrev_b32 v150, 16, v41
v_and_b32 v151, 0xffff0000, v41
v_lshlrev_b32 v152, 16, v42
v_and_b32 v153, 0xffff0000, v42
v_lshlrev_b32 v154, 16, v43
v_and_b32 v155, 0xffff0000, v43
v_lshlrev_b32 v156, 16, v44
v_and_b32 v157, 0xffff0000, v44
v_lshlrev_b32 v158, 16, v45
v_and_b32 v159, 0xffff0000, v45
v_lshlrev_b32 v160, 16, v46
v_and_b32 v161, 0xffff0000, v46
v_lshlrev_b32 v162, 16, v47
v_and_b32 v163, 0xffff0000, v47
s_waitcnt vmcnt(0)
s_barrier
buffer_atomic_add v12, v10, s[4:7], s92 offen sc1
s_cmp_lg_u32 s28, 0
s_cbranch_scc1 Lpe_23
s_add_u32 s36, s66, 0x20000
s_mov_b32 s37, 0
Lpoll_22:
v_mov_b32 v11, 0
s_mov_b64 exec, 1
buffer_atomic_add v11, off, s[4:7], s36 sc0 sc1
s_waitcnt vmcnt(0)
v_readfirstlane_b32 s38, v11
s_mov_b64 exec, -1
s_nop 0
v_mov_b32 v11, s38
s_add_u32 s37, s37, 1
v_cmp_gt_u32 vcc, 32, v11
s_cbranch_vccz Lpe_23
s_cmp_lt_u32 s37, 0x100000
s_cbranch_scc1 Lpoll_22
Lpe_23:
s_waitcnt vmcnt(0)
s_barrier
L_k2go2:
buffer_load_dwordx4 a[0:3], v4, s[40:43], s35 offen offset:0 sc1
buffer_load_dwordx4 a[4:7], v4, s[40:43], s35 offen offset:1024 sc1
s_cmp_eq_u32 s3, 1
s_cselect_b32 s35, 9, 1
s_lshl_b32 s35, s35, 12
buffer_load_dwordx4 a[8:11], v4, s[40:43], s35 offen offset:0 sc1
buffer_load_dwordx4 a[12:15], v4, s[40:43], s35 offen offset:1024 sc1
s_cmp_eq_u32 s3, 2
s_cselect_b32 s35, 10, 2
s_lshl_b32 s35, s35, 12
buffer_load_dwordx4 a[16:19], v4, s[40:43], s35 offen offset:0 sc1
buffer_load_dwordx4 a[20:23], v4, s[40:43], s35 offen offset:1024 sc1
s_cmp_eq_u32 s3, 3
s_cselect_b32 s35, 11, 3
s_lshl_b32 s35, s35, 12
buffer_load_dwordx4 a[24:27], v4, s[40:43], s35 offen offset:0 sc1
buffer_load_dwordx4 a[28:31], v4, s[40:43], s35 offen offset:1024 sc1
s_cmp_eq_u32 s3, 4
s_cselect_b32 s35, 12, 4
s_lshl_b32 s35, s35, 12
buffer_load_dwordx4 a[32:35], v4, s[40:43], s35 offen offset:0 sc1
buffer_load_dwordx4 a[36:39], v4, s[40:43], s35 offen offset:1024 sc1
s_cmp_eq_u32 s3, 5
s_cselect_b32 s35, 13, 5
s_lshl_b32 s35, s35, 12
ds_read_b128 a[96:99], v5 offset:0
ds_read_b128 a[100:103], v5 offset:1024
ds_read_b128 a[104:107], v5 offset:2048
ds_read_b128 a[108:111], v5 offset:3072
s_waitcnt vmcnt(8) lgkmcnt(0)
v_mfma_f32_16x16x32_bf16 v[132:135], a[96:99], a[0:3], v[132:135]
ds_read_b128 a[112:115], v5 offset:4096
v_mfma_f32_16x16x32_bf16 v[148:151], a[96:99], a[4:7], v[148:151]
ds_read_b128 a[116:119], v5 offset:5120
v_mfma_f32_16x16x32_bf16 v[152:155], a[100:103], a[4:7], v[152:155]
buffer_load_dwordx4 a[40:43], v4, s[40:43], s35 offen offset:0 sc1
v_mfma_f32_16x16x32_bf16 v[136:139], a[100:103], a[0:3], v[136:139]
ds_read_b128 a[120:123], v5 offset:6144
v_mfma_f32_16x16x32_bf16 v[140:143], a[104:107], a[0:3], v[140:143]
ds_read_b128 a[124:127], v5 offset:7168
v_mfma_f32_16x16x32_bf16 v[156:159], a[104:107], a[4:7], v[156:159]
v_mfma_f32_16x16x32_bf16 v[160:163], a[108:111], a[4:7], v[160:163]
buffer_load_dwordx4 a[44:47], v4, s[40:43], s35 offen offset:1024 sc1
v_mfma_f32_16x16x32_bf16 v[144:147], a[108:111], a[0:3], v[144:147]
s_cmp_eq_u32 s3, 6
s_cselect_b32 s35, 14, 6
s_lshl_b32 s35, s35, 12
s_waitcnt vmcnt(8) lgkmcnt(0)
v_mfma_f32_16x16x32_bf16 v[132:135], a[112:115], a[8:11], v[132:135]
ds_read_b128 a[96:99], v5 offset:8192
v_mfma_f32_16x16x32_bf16 v[148:151], a[112:115], a[12:15], v[148:151]
ds_read_b128 a[100:103], v5 offset:9216
v_mfma_f32_16x16x32_bf16 v[152:155], a[116:119], a[12:15], v[152:155]
buffer_load_dwordx4 a[0:3], v4, s[40:43], s35 offen offset:0 sc1
v_mfma_f32_16x16x32_bf16 v[136:139], a[116:119], a[8:11], v[136:139]
ds_read_b128 a[104:107], v5 offset:10240
v_mfma_f32_16x16x32_bf16 v[140:143], a[120:123], a[8:11], v[140:143]
ds_read_b128 a[108:111], v5 offset:11264
v_mfma_f32_16x16x32_bf16 v[156:159], a[120:123], a[12:15], v[156:159]
v_mfma_f32_16x16x32_bf16 v[160:163], a[124:127], a[12:15], v[160:163]
buffer_load_dwordx4 a[4:7], v4, s[40:43], s35 offen offset:1024 sc1
v_mfma_f32_16x16x32_bf16 v[144:147], a[124:127], a[8:11], v[144:147]
s_cmp_eq_u32 s3, 7
s_cselect_b32 s35, 15, 7
s_lshl_b32 s35, s35, 12
s_waitcnt vmcnt(8) lgkmcnt(0)
v_mfma_f32_16x16x32_bf16 v[132:135], a[96:99], a[16:19], v[132:135]
ds_read_b128 a[112:115], v5 offset:12288
v_mfma_f32_16x16x32_bf16 v[148:151], a[96:99], a[20:23], v[148:151]
ds_read_b128 a[116:119], v5 offset:13312
v_mfma_f32_16x16x32_bf16 v[152:155], a[100:103], a[20:23], v[152:155]
buffer_load_dwordx4 a[8:11], v4, s[40:43], s35 offen offset:0 sc1
v_mfma_f32_16x16x32_bf16 v[136:139], a[100:103], a[16:19], v[136:139]
ds_read_b128 a[120:123], v5 offset:14336
v_mfma_f32_16x16x32_bf16 v[140:143], a[104:107], a[16:19], v[140:143]
ds_read_b128 a[124:127], v5 offset:15360
v_mfma_f32_16x16x32_bf16 v[156:159], a[104:107], a[20:23], v[156:159]
v_mfma_f32_16x16x32_bf16 v[160:163], a[108:111], a[20:23], v[160:163]
buffer_load_dwordx4 a[12:15], v4, s[40:43], s35 offen offset:1024 sc1
v_mfma_f32_16x16x32_bf16 v[144:147], a[108:111], a[16:19], v[144:147]
s_cmp_eq_u32 s3, 0
s_cselect_b32 s35, 16, 8
s_lshl_b32 s35, s35, 12
s_waitcnt vmcnt(8) lgkmcnt(0)
v_mfma_f32_16x16x32_bf16 v[132:135], a[112:115], a[24:27], v[132:135]
ds_read_b128 a[96:99], v5 offset:16384
v_mfma_f32_16x16x32_bf16 v[148:151], a[112:115], a[28:31], v[148:151]
ds_read_b128 a[100:103], v5 offset:17408
v_mfma_f32_16x16x32_bf16 v[152:155], a[116:119], a[28:31], v[152:155]
buffer_load_dwordx4 a[16:19], v4, s[40:43], s35 offen offset:0 sc1
v_mfma_f32_16x16x32_bf16 v[136:139], a[116:119], a[24:27], v[136:139]
ds_read_b128 a[104:107], v5 offset:18432
v_mfma_f32_16x16x32_bf16 v[140:143], a[120:123], a[24:27], v[140:143]
ds_read_b128 a[108:111], v5 offset:19456
v_mfma_f32_16x16x32_bf16 v[156:159], a[120:123], a[28:31], v[156:159]
v_mfma_f32_16x16x32_bf16 v[160:163], a[124:127], a[28:31], v[160:163]
buffer_load_dwordx4 a[20:23], v4, s[40:43], s35 offen offset:1024 sc1
v_mfma_f32_16x16x32_bf16 v[144:147], a[124:127], a[24:27], v[144:147]
s_cmp_eq_u32 s3, 1
s_cselect_b32 s35, 17, 9
s_lshl_b32 s35, s35, 12
s_waitcnt vmcnt(8) lgkmcnt(0)
v_mfma_f32_16x16x32_bf16 v[132:135], a[96:99], a[32:35], v[132:135]
ds_read_b128 a[112:115], v5 offset:20480
v_mfma_f32_16x16x32_bf16 v[148:151], a[96:99], a[36:39], v[148:151]
ds_read_b128 a[116:119], v5 offset:21504
v_mfma_f32_16x16x32_bf16 v[152:155], a[100:103], a[36:39], v[152:155]
buffer_load_dwordx4 a[24:27], v4, s[40:43], s35 offen offset:0 sc1
v_mfma_f32_16x16x32_bf16 v[136:139], a[100:103], a[32:35], v[136:139]
ds_read_b128 a[120:123], v5 offset:22528
v_mfma_f32_16x16x32_bf16 v[140:143], a[104:107], a[32:35], v[140:143]
ds_read_b128 a[124:127], v5 offset:23552
v_mfma_f32_16x16x32_bf16 v[156:159], a[104:107], a[36:39], v[156:159]
v_mfma_f32_16x16x32_bf16 v[160:163], a[108:111], a[36:39], v[160:163]
buffer_load_dwordx4 a[28:31], v4, s[40:43], s35 offen offset:1024 sc1
v_mfma_f32_16x16x32_bf16 v[144:147], a[108:111], a[32:35], v[144:147]
s_cmp_eq_u32 s3, 2
s_cselect_b32 s35, 18, 10
s_lshl_b32 s35, s35, 12
s_waitcnt vmcnt(8) lgkmcnt(0)
v_mfma_f32_16x16x32_bf16 v[132:135], a[112:115], a[40:43], v[132:135]
ds_read_b128 a[96:99], v5 offset:24576
v_mfma_f32_16x16x32_bf16 v[148:151], a[112:115], a[44:47], v[148:151]
ds_read_b128 a[100:103], v5 offset:25600
v_mfma_f32_16x16x32_bf16 v[152:155], a[116:119], a[44:47], v[152:155]
buffer_load_dwordx4 a[32:35], v4, s[40:43], s35 offen offset:0 sc1
v_mfma_f32_16x16x32_bf16 v[136:139], a[116:119], a[40:43], v[136:139]
ds_read_b128 a[104:107], v5 offset:26624
v_mfma_f32_16x16x32_bf16 v[140:143], a[120:123], a[40:43], v[140:143]
ds_read_b128 a[108:111], v5 offset:27648
v_mfma_f32_16x16x32_bf16 v[156:159], a[120:123], a[44:47], v[156:159]
v_mfma_f32_16x16x32_bf16 v[160:163], a[124:127], a[44:47], v[160:163]
buffer_load_dwordx4 a[36:39], v4, s[40:43], s35 offen offset:1024 sc1
v_mfma_f32_16x16x32_bf16 v[144:147], a[124:127], a[40:43], v[144:147]
s_cmp_eq_u32 s3, 3
s_cselect_b32 s35, 19, 11
s_lshl_b32 s35, s35, 12
s_waitcnt vmcnt(8) lgkmcnt(0)
v_mfma_f32_16x16x32_bf16 v[132:135], a[96:99], a[0:3], v[132:135]
ds_read_b128 a[112:115], v5 offset:28672
v_mfma_f32_16x16x32_bf16 v[148:151], a[96:99], a[4:7], v[148:151]
ds_read_b128 a[116:119], v5 offset:29696
v_mfma_f32_16x16x32_bf16 v[152:155], a[100:103], a[4:7], v[152:155]
buffer_load_dwordx4 a[40:43], v4, s[40:43], s35 offen offset:0 sc1
v_mfma_f32_16x16x32_bf16 v[136:139], a[100:103], a[0:3], v[136:139]
ds_read_b128 a[120:123], v5 offset:30720
v_mfma_f32_16x16x32_bf16 v[140:143], a[104:107], a[0:3], v[140:143]
ds_read_b128 a[124:127], v5 offset:31744
v_mfma_f32_16x16x32_bf16 v[156:159], a[104:107], a[4:7], v[156:159]
v_mfma_f32_16x16x32_bf16 v[160:163], a[108:111], a[4:7], v[160:163]
buffer_load_dwordx4 a[44:47], v4, s[40:43], s35 offen offset:1024 sc1
v_mfma_f32_16x16x32_bf16 v[144:147], a[108:111], a[0:3], v[144:147]
s_cmp_eq_u32 s3, 4
s_cselect_b32 s35, 20, 12
s_lshl_b32 s35, s35, 12
s_waitcnt vmcnt(8) lgkmcnt(0)
v_mfma_f32_16x16x32_bf16 v[132:135], a[112:115], a[8:11], v[132:135]
ds_read_b128 a[96:99], v5 offset:32768
v_mfma_f32_16x16x32_bf16 v[148:151], a[112:115], a[12:15], v[148:151]
ds_read_b128 a[100:103], v5 offset:33792
v_mfma_f32_16x16x32_bf16 v[152:155], a[116:119], a[12:15], v[152:155]
buffer_load_dwordx4 a[0:3], v4, s[40:43], s35 offen offset:0 sc1
v_mfma_f32_16x16x32_bf16 v[136:139], a[116:119], a[8:11], v[136:139]
ds_read_b128 a[104:107], v5 offset:34816
v_mfma_f32_16x16x32_bf16 v[140:143], a[120:123], a[8:11], v[140:143]
ds_read_b128 a[108:111], v5 offset:35840
v_mfma_f32_16x16x32_bf16 v[156:159], a[120:123], a[12:15], v[156:159]
v_mfma_f32_16x16x32_bf16 v[160:163], a[124:127], a[12:15], v[160:163]
buffer_load_dwordx4 a[4:7], v4, s[40:43], s35 offen offset:1024 sc1
v_mfma_f32_16x16x32_bf16 v[144:147], a[124:127], a[8:11], v[144:147]
s_cmp_eq_u32 s3, 5
s_cselect_b32 s35, 21, 13
s_lshl_b32 s35, s35, 12
s_waitcnt vmcnt(8) lgkmcnt(0)
v_mfma_f32_16x16x32_bf16 v[132:135], a[96:99], a[16:19], v[132:135]
ds_read_b128 a[112:115], v5 offset:36864
v_mfma_f32_16x16x32_bf16 v[148:151], a[96:99], a[20:23], v[148:151]
ds_read_b128 a[116:119], v5 offset:37888
v_mfma_f32_16x16x32_bf16 v[152:155], a[100:103], a[20:23], v[152:155]
buffer_load_dwordx4 a[8:11], v4, s[40:43], s35 offen offset:0 sc1
v_mfma_f32_16x16x32_bf16 v[136:139], a[100:103], a[16:19], v[136:139]
ds_read_b128 a[120:123], v5 offset:38912
v_mfma_f32_16x16x32_bf16 v[140:143], a[104:107], a[16:19], v[140:143]
ds_read_b128 a[124:127], v5 offset:39936
v_mfma_f32_16x16x32_bf16 v[156:159], a[104:107], a[20:23], v[156:159]
v_mfma_f32_16x16x32_bf16 v[160:163], a[108:111], a[20:23], v[160:163]
buffer_load_dwordx4 a[12:15], v4, s[40:43], s35 offen offset:1024 sc1
v_mfma_f32_16x16x32_bf16 v[144:147], a[108:111], a[16:19], v[144:147]
s_cmp_eq_u32 s3, 6
s_cselect_b32 s35, 22, 14
s_lshl_b32 s35, s35, 12
s_waitcnt vmcnt(8) lgkmcnt(0)
v_mfma_f32_16x16x32_bf16 v[132:135], a[112:115], a[24:27], v[132:135]
ds_read_b128 a[96:99], v5 offset:40960
v_mfma_f32_16x16x32_bf16 v[148:151], a[112:115], a[28:31], v[148:151]
ds_read_b128 a[100:103], v5 offset:41984
v_mfma_f32_16x16x32_bf16 v[152:155], a[116:119], a[28:31], v[152:155]
buffer_load_dwordx4 a[16:19], v4, s[40:43], s35 offen offset:0 sc1
v_mfma_f32_16x16x32_bf16 v[136:139], a[116:119], a[24:27], v[136:139]
ds_read_b128 a[104:107], v5 offset:43008
v_mfma_f32_16x16x32_bf16 v[140:143], a[120:123], a[24:27], v[140:143]
ds_read_b128 a[108:111], v5 offset:44032
v_mfma_f32_16x16x32_bf16 v[156:159], a[120:123], a[28:31], v[156:159]
v_mfma_f32_16x16x32_bf16 v[160:163], a[124:127], a[28:31], v[160:163]
buffer_load_dwordx4 a[20:23], v4, s[40:43], s35 offen offset:1024 sc1
v_mfma_f32_16x16x32_bf16 v[144:147], a[124:127], a[24:27], v[144:147]
s_cmp_eq_u32 s3, 7
s_cselect_b32 s35, 23, 15
s_lshl_b32 s35, s35, 12
s_waitcnt vmcnt(8) lgkmcnt(0)
v_mfma_f32_16x16x32_bf16 v[132:135], a[96:99], a[32:35], v[132:135]
ds_read_b128 a[112:115], v5 offset:45056
v_mfma_f32_16x16x32_bf16 v[148:151], a[96:99], a[36:39], v[148:151]
ds_read_b128 a[116:119], v5 offset:46080
v_mfma_f32_16x16x32_bf16 v[152:155], a[100:103], a[36:39], v[152:155]
buffer_load_dwordx4 a[24:27], v4, s[40:43], s35 offen offset:0 sc1
v_mfma_f32_16x16x32_bf16 v[136:139], a[100:103], a[32:35], v[136:139]
ds_read_b128 a[120:123], v5 offset:47104
v_mfma_f32_16x16x32_bf16 v[140:143], a[104:107], a[32:35], v[140:143]
ds_read_b128 a[124:127], v5 offset:48128
v_mfma_f32_16x16x32_bf16 v[156:159], a[104:107], a[36:39], v[156:159]
v_mfma_f32_16x16x32_bf16 v[160:163], a[108:111], a[36:39], v[160:163]
buffer_load_dwordx4 a[28:31], v4, s[40:43], s35 offen offset:1024 sc1
v_mfma_f32_16x16x32_bf16 v[144:147], a[108:111], a[32:35], v[144:147]
s_cmp_eq_u32 s3, 0
s_cselect_b32 s35, 24, 16
s_lshl_b32 s35, s35, 12
s_waitcnt vmcnt(8) lgkmcnt(0)
v_mfma_f32_16x16x32_bf16 v[132:135], a[112:115], a[40:43], v[132:135]
ds_read_b128 a[96:99], v5 offset:49152
v_mfma_f32_16x16x32_bf16 v[148:151], a[112:115], a[44:47], v[148:151]
ds_read_b128 a[100:103], v5 offset:50176
v_mfma_f32_16x16x32_bf16 v[152:155], a[116:119], a[44:47], v[152:155]
buffer_load_dwordx4 a[32:35], v4, s[40:43], s35 offen offset:0 sc1
v_mfma_f32_16x16x32_bf16 v[136:139], a[116:119], a[40:43], v[136:139]
ds_read_b128 a[104:107], v5 offset:51200
v_mfma_f32_16x16x32_bf16 v[140:143], a[120:123], a[40:43], v[140:143]
ds_read_b128 a[108:111], v5 offset:52224
v_mfma_f32_16x16x32_bf16 v[156:159], a[120:123], a[44:47], v[156:159]
v_mfma_f32_16x16x32_bf16 v[160:163], a[124:127], a[44:47], v[160:163]
buffer_load_dwordx4 a[36:39], v4, s[40:43], s35 offen offset:1024 sc1
v_mfma_f32_16x16x32_bf16 v[144:147], a[124:127], a[40:43], v[144:147]
s_cmp_eq_u32 s3, 1
s_cselect_b32 s35, 25, 17
s_lshl_b32 s35, s35, 12
s_waitcnt vmcnt(8) lgkmcnt(0)
v_mfma_f32_16x16x32_bf16 v[132:135], a[96:99], a[0:3], v[132:135]
ds_read_b128 a[112:115], v5 offset:53248
v_mfma_f32_16x16x32_bf16 v[148:151], a[96:99], a[4:7], v[148:151]
ds_read_b128 a[116:119], v5 offset:54272
v_mfma_f32_16x16x32_bf16 v[152:155], a[100:103], a[4:7], v[152:155]
buffer_load_dwordx4 a[40:43], v4, s[40:43], s35 offen offset:0 sc1
v_mfma_f32_16x16x32_bf16 v[136:139], a[100:103], a[0:3], v[136:139]
ds_read_b128 a[120:123], v5 offset:55296
v_mfma_f32_16x16x32_bf16 v[140:143], a[104:107], a[0:3], v[140:143]
ds_read_b128 a[124:127], v5 offset:56320
v_mfma_f32_16x16x32_bf16 v[156:159], a[104:107], a[4:7], v[156:159]
v_mfma_f32_16x16x32_bf16 v[160:163], a[108:111], a[4:7], v[160:163]
buffer_load_dwordx4 a[44:47], v4, s[40:43], s35 offen offset:1024 sc1
v_mfma_f32_16x16x32_bf16 v[144:147], a[108:111], a[0:3], v[144:147]
s_cmp_eq_u32 s3, 2
s_cselect_b32 s35, 26, 18
s_lshl_b32 s35, s35, 12
s_waitcnt vmcnt(8) lgkmcnt(0)
v_mfma_f32_16x16x32_bf16 v[132:135], a[112:115], a[8:11], v[132:135]
ds_read_b128 a[96:99], v5 offset:57344
v_mfma_f32_16x16x32_bf16 v[148:151], a[112:115], a[12:15], v[148:151]
ds_read_b128 a[100:103], v5 offset:58368
v_mfma_f32_16x16x32_bf16 v[152:155], a[116:119], a[12:15], v[152:155]
buffer_load_dwordx4 a[0:3], v4, s[40:43], s35 offen offset:0 sc1
v_mfma_f32_16x16x32_bf16 v[136:139], a[116:119], a[8:11], v[136:139]
ds_read_b128 a[104:107], v5 offset:59392
v_mfma_f32_16x16x32_bf16 v[140:143], a[120:123], a[8:11], v[140:143]
ds_read_b128 a[108:111], v5 offset:60416
v_mfma_f32_16x16x32_bf16 v[156:159], a[120:123], a[12:15], v[156:159]
v_mfma_f32_16x16x32_bf16 v[160:163], a[124:127], a[12:15], v[160:163]
buffer_load_dwordx4 a[4:7], v4, s[40:43], s35 offen offset:1024 sc1
v_mfma_f32_16x16x32_bf16 v[144:147], a[124:127], a[8:11], v[144:147]
s_cmp_eq_u32 s3, 3
s_cselect_b32 s35, 27, 19
s_lshl_b32 s35, s35, 12
s_waitcnt vmcnt(8) lgkmcnt(0)
v_mfma_f32_16x16x32_bf16 v[132:135], a[96:99], a[16:19], v[132:135]
ds_read_b128 a[112:115], v5 offset:61440
v_mfma_f32_16x16x32_bf16 v[148:151], a[96:99], a[20:23], v[148:151]
ds_read_b128 a[116:119], v5 offset:62464
v_mfma_f32_16x16x32_bf16 v[152:155], a[100:103], a[20:23], v[152:155]
buffer_load_dwordx4 a[8:11], v4, s[40:43], s35 offen offset:0 sc1
v_mfma_f32_16x16x32_bf16 v[136:139], a[100:103], a[16:19], v[136:139]
ds_read_b128 a[120:123], v5 offset:63488
v_mfma_f32_16x16x32_bf16 v[140:143], a[104:107], a[16:19], v[140:143]
ds_read_b128 a[124:127], v5 offset:64512
v_mfma_f32_16x16x32_bf16 v[156:159], a[104:107], a[20:23], v[156:159]
v_mfma_f32_16x16x32_bf16 v[160:163], a[108:111], a[20:23], v[160:163]
buffer_load_dwordx4 a[12:15], v4, s[40:43], s35 offen offset:1024 sc1
v_mfma_f32_16x16x32_bf16 v[144:147], a[108:111], a[16:19], v[144:147]
s_cmp_eq_u32 s3, 4
s_cselect_b32 s35, 28, 20
s_lshl_b32 s35, s35, 12
s_waitcnt vmcnt(8) lgkmcnt(0)
v_mfma_f32_16x16x32_bf16 v[132:135], a[112:115], a[24:27], v[132:135]
ds_read_b128 a[96:99], v6 offset:0
v_mfma_f32_16x16x32_bf16 v[148:151], a[112:115], a[28:31], v[148:151]
ds_read_b128 a[100:103], v6 offset:1024
v_mfma_f32_16x16x32_bf16 v[152:155], a[116:119], a[28:31], v[152:155]
buffer_load_dwordx4 a[16:19], v4, s[40:43], s35 offen offset:0 sc1
v_mfma_f32_16x16x32_bf16 v[136:139], a[116:119], a[24:27], v[136:139]
ds_read_b128 a[104:107], v6 offset:2048
v_mfma_f32_16x16x32_bf16 v[140:143], a[120:123], a[24:27], v[140:143]
ds_read_b128 a[108:111], v6 offset:3072
v_mfma_f32_16x16x32_bf16 v[156:159], a[120:123], a[28:31], v[156:159]
v_mfma_f32_16x16x32_bf16 v[160:163], a[124:127], a[28:31], v[160:163]
buffer_load_dwordx4 a[20:23], v4, s[40:43], s35 offen offset:1024 sc1
v_mfma_f32_16x16x32_bf16 v[144:147], a[124:127], a[24:27], v[144:147]
s_cmp_eq_u32 s3, 5
s_cselect_b32 s35, 29, 21
s_lshl_b32 s35, s35, 12
s_waitcnt vmcnt(8) lgkmcnt(0)
v_mfma_f32_16x16x32_bf16 v[132:135], a[96:99], a[32:35], v[132:135]
ds_read_b128 a[112:115], v6 offset:4096
v_mfma_f32_16x16x32_bf16 v[148:151], a[96:99], a[36:39], v[148:151]
ds_read_b128 a[116:119], v6 offset:5120
v_mfma_f32_16x16x32_bf16 v[152:155], a[100:103], a[36:39], v[152:155]
buffer_load_dwordx4 a[24:27], v4, s[40:43], s35 offen offset:0 sc1
v_mfma_f32_16x16x32_bf16 v[136:139], a[100:103], a[32:35], v[136:139]
ds_read_b128 a[120:123], v6 offset:6144
v_mfma_f32_16x16x32_bf16 v[140:143], a[104:107], a[32:35], v[140:143]
ds_read_b128 a[124:127], v6 offset:7168
v_mfma_f32_16x16x32_bf16 v[156:159], a[104:107], a[36:39], v[156:159]
v_mfma_f32_16x16x32_bf16 v[160:163], a[108:111], a[36:39], v[160:163]
buffer_load_dwordx4 a[28:31], v4, s[40:43], s35 offen offset:1024 sc1
v_mfma_f32_16x16x32_bf16 v[144:147], a[108:111], a[32:35], v[144:147]
s_cmp_eq_u32 s3, 6
s_cselect_b32 s35, 30, 22
s_lshl_b32 s35, s35, 12
s_waitcnt vmcnt(8) lgkmcnt(0)
v_mfma_f32_16x16x32_bf16 v[132:135], a[112:115], a[40:43], v[132:135]
ds_read_b128 a[96:99], v6 offset:8192
v_mfma_f32_16x16x32_bf16 v[148:151], a[112:115], a[44:47], v[148:151]
ds_read_b128 a[100:103], v6 offset:9216
v_mfma_f32_16x16x32_bf16 v[152:155], a[116:119], a[44:47], v[152:155]
buffer_load_dwordx4 a[32:35], v4, s[40:43], s35 offen offset:0 sc1
v_mfma_f32_16x16x32_bf16 v[136:139], a[116:119], a[40:43], v[136:139]
ds_read_b128 a[104:107], v6 offset:10240
v_mfma_f32_16x16x32_bf16 v[140:143], a[120:123], a[40:43], v[140:143]
ds_read_b128 a[108:111], v6 offset:11264
v_mfma_f32_16x16x32_bf16 v[156:159], a[120:123], a[44:47], v[156:159]
v_mfma_f32_16x16x32_bf16 v[160:163], a[124:127], a[44:47], v[160:163]
buffer_load_dwordx4 a[36:39], v4, s[40:43], s35 offen offset:1024 sc1
v_mfma_f32_16x16x32_bf16 v[144:147], a[124:127], a[40:43], v[144:147]
s_cmp_eq_u32 s3, 7
s_cselect_b32 s35, 31, 23
s_lshl_b32 s35, s35, 12
s_waitcnt vmcnt(8) lgkmcnt(0)
v_mfma_f32_16x16x32_bf16 v[132:135], a[96:99], a[0:3], v[132:135]
ds_read_b128 a[112:115], v6 offset:12288
v_mfma_f32_16x16x32_bf16 v[148:151], a[96:99], a[4:7], v[148:151]
ds_read_b128 a[116:119], v6 offset:13312
v_mfma_f32_16x16x32_bf16 v[152:155], a[100:103], a[4:7], v[152:155]
buffer_load_dwordx4 a[40:43], v4, s[40:43], s35 offen offset:0 sc1
v_mfma_f32_16x16x32_bf16 v[136:139], a[100:103], a[0:3], v[136:139]
ds_read_b128 a[120:123], v6 offset:14336
v_mfma_f32_16x16x32_bf16 v[140:143], a[104:107], a[0:3], v[140:143]
ds_read_b128 a[124:127], v6 offset:15360
v_mfma_f32_16x16x32_bf16 v[156:159], a[104:107], a[4:7], v[156:159]
v_mfma_f32_16x16x32_bf16 v[160:163], a[108:111], a[4:7], v[160:163]
buffer_load_dwordx4 a[44:47], v4, s[40:43], s35 offen offset:1024 sc1
v_mfma_f32_16x16x32_bf16 v[144:147], a[108:111], a[0:3], v[144:147]
s_cmp_eq_u32 s3, 0
s_cselect_b32 s35, 0, 24
s_lshl_b32 s35, s35, 12
s_waitcnt vmcnt(8) lgkmcnt(0)
v_mfma_f32_16x16x32_bf16 v[132:135], a[112:115], a[8:11], v[132:135]
ds_read_b128 a[96:99], v6 offset:16384
v_mfma_f32_16x16x32_bf16 v[148:151], a[112:115], a[12:15], v[148:151]
ds_read_b128 a[100:103], v6 offset:17408
v_mfma_f32_16x16x32_bf16 v[152:155], a[116:119], a[12:15], v[152:155]
buffer_load_dwordx4 a[0:3], v4, s[40:43], s35 offen offset:0 sc1
v_mfma_f32_16x16x32_bf16 v[136:139], a[116:119], a[8:11], v[136:139]
ds_read_b128 a[104:107], v6 offset:18432
v_mfma_f32_16x16x32_bf16 v[140:143], a[120:123], a[8:11], v[140:143]
ds_read_b128 a[108:111], v6 offset:19456
v_mfma_f32_16x16x32_bf16 v[156:159], a[120:123], a[12:15], v[156:159]
v_mfma_f32_16x16x32_bf16 v[160:163], a[124:127], a[12:15], v[160:163]
buffer_load_dwordx4 a[4:7], v4, s[40:43], s35 offen offset:1024 sc1
v_mfma_f32_16x16x32_bf16 v[144:147], a[124:127], a[8:11], v[144:147]
s_cmp_eq_u32 s3, 1
s_cselect_b32 s35, 1, 25
s_lshl_b32 s35, s35, 12
s_waitcnt vmcnt(8) lgkmcnt(0)
v_mfma_f32_16x16x32_bf16 v[132:135], a[96:99], a[16:19], v[132:135]
ds_read_b128 a[112:115], v6 offset:20480
v_mfma_f32_16x16x32_bf16 v[148:151], a[96:99], a[20:23], v[148:151]
ds_read_b128 a[116:119], v6 offset:21504
v_mfma_f32_16x16x32_bf16 v[152:155], a[100:103], a[20:23], v[152:155]
buffer_load_dwordx4 a[8:11], v4, s[40:43], s35 offen offset:0 sc1
v_mfma_f32_16x16x32_bf16 v[136:139], a[100:103], a[16:19], v[136:139]
ds_read_b128 a[120:123], v6 offset:22528
v_mfma_f32_16x16x32_bf16 v[140:143], a[104:107], a[16:19], v[140:143]
ds_read_b128 a[124:127], v6 offset:23552
v_mfma_f32_16x16x32_bf16 v[156:159], a[104:107], a[20:23], v[156:159]
v_mfma_f32_16x16x32_bf16 v[160:163], a[108:111], a[20:23], v[160:163]
buffer_load_dwordx4 a[12:15], v4, s[40:43], s35 offen offset:1024 sc1
v_mfma_f32_16x16x32_bf16 v[144:147], a[108:111], a[16:19], v[144:147]
s_cmp_eq_u32 s3, 2
s_cselect_b32 s35, 2, 26
s_lshl_b32 s35, s35, 12
s_waitcnt vmcnt(8) lgkmcnt(0)
v_mfma_f32_16x16x32_bf16 v[132:135], a[112:115], a[24:27], v[132:135]
ds_read_b128 a[96:99], v6 offset:24576
v_mfma_f32_16x16x32_bf16 v[148:151], a[112:115], a[28:31], v[148:151]
ds_read_b128 a[100:103], v6 offset:25600
v_mfma_f32_16x16x32_bf16 v[152:155], a[116:119], a[28:31], v[152:155]
buffer_load_dwordx4 a[16:19], v4, s[40:43], s35 offen offset:0 sc1
v_mfma_f32_16x16x32_bf16 v[136:139], a[116:119], a[24:27], v[136:139]
ds_read_b128 a[104:107], v6 offset:26624
v_mfma_f32_16x16x32_bf16 v[140:143], a[120:123], a[24:27], v[140:143]
ds_read_b128 a[108:111], v6 offset:27648
v_mfma_f32_16x16x32_bf16 v[156:159], a[120:123], a[28:31], v[156:159]
v_mfma_f32_16x16x32_bf16 v[160:163], a[124:127], a[28:31], v[160:163]
buffer_load_dwordx4 a[20:23], v4, s[40:43], s35 offen offset:1024 sc1
v_mfma_f32_16x16x32_bf16 v[144:147], a[124:127], a[24:27], v[144:147]
s_cmp_eq_u32 s3, 3
s_cselect_b32 s35, 3, 27
s_lshl_b32 s35, s35, 12
s_waitcnt vmcnt(8) lgkmcnt(0)
v_mfma_f32_16x16x32_bf16 v[132:135], a[96:99], a[32:35], v[132:135]
ds_read_b128 a[112:115], v6 offset:28672
v_mfma_f32_16x16x32_bf16 v[148:151], a[96:99], a[36:39], v[148:151]
ds_read_b128 a[116:119], v6 offset:29696
v_mfma_f32_16x16x32_bf16 v[152:155], a[100:103], a[36:39], v[152:155]
buffer_load_dwordx4 a[24:27], v4, s[40:43], s35 offen offset:0 sc1
v_mfma_f32_16x16x32_bf16 v[136:139], a[100:103], a[32:35], v[136:139]
ds_read_b128 a[120:123], v6 offset:30720
v_mfma_f32_16x16x32_bf16 v[140:143], a[104:107], a[32:35], v[140:143]
ds_read_b128 a[124:127], v6 offset:31744
v_mfma_f32_16x16x32_bf16 v[156:159], a[104:107], a[36:39], v[156:159]
v_mfma_f32_16x16x32_bf16 v[160:163], a[108:111], a[36:39], v[160:163]
buffer_load_dwordx4 a[28:31], v4, s[40:43], s35 offen offset:1024 sc1
v_mfma_f32_16x16x32_bf16 v[144:147], a[108:111], a[32:35], v[144:147]
s_cmp_eq_u32 s3, 4
s_cselect_b32 s35, 4, 28
s_lshl_b32 s35, s35, 12
s_waitcnt vmcnt(8) lgkmcnt(0)
v_mfma_f32_16x16x32_bf16 v[132:135], a[112:115], a[40:43], v[132:135]
ds_read_b128 a[96:99], v6 offset:32768
v_mfma_f32_16x16x32_bf16 v[148:151], a[112:115], a[44:47], v[148:151]
ds_read_b128 a[100:103], v6 offset:33792
v_mfma_f32_16x16x32_bf16 v[152:155], a[116:119], a[44:47], v[152:155]
buffer_load_dwordx4 a[32:35], v4, s[40:43], s35 offen offset:0 sc1
v_mfma_f32_16x16x32_bf16 v[136:139], a[116:119], a[40:43], v[136:139]
ds_read_b128 a[104:107], v6 offset:34816
v_mfma_f32_16x16x32_bf16 v[140:143], a[120:123], a[40:43], v[140:143]
ds_read_b128 a[108:111], v6 offset:35840
v_mfma_f32_16x16x32_bf16 v[156:159], a[120:123], a[44:47], v[156:159]
v_mfma_f32_16x16x32_bf16 v[160:163], a[124:127], a[44:47], v[160:163]
buffer_load_dwordx4 a[36:39], v4, s[40:43], s35 offen offset:1024 sc1
v_mfma_f32_16x16x32_bf16 v[144:147], a[124:127], a[40:43], v[144:147]
s_cmp_eq_u32 s3, 5
s_cselect_b32 s35, 5, 29
s_lshl_b32 s35, s35, 12
s_waitcnt vmcnt(8) lgkmcnt(0)
v_mfma_f32_16x16x32_bf16 v[132:135], a[96:99], a[0:3], v[132:135]
ds_read_b128 a[112:115], v6 offset:36864
v_mfma_f32_16x16x32_bf16 v[148:151], a[96:99], a[4:7], v[148:151]
ds_read_b128 a[116:119], v6 offset:37888
v_mfma_f32_16x16x32_bf16 v[152:155], a[100:103], a[4:7], v[152:155]
buffer_load_dwordx4 a[40:43], v4, s[40:43], s35 offen offset:0 sc1
v_mfma_f32_16x16x32_bf16 v[136:139], a[100:103], a[0:3], v[136:139]
ds_read_b128 a[120:123], v6 offset:38912
v_mfma_f32_16x16x32_bf16 v[140:143], a[104:107], a[0:3], v[140:143]
ds_read_b128 a[124:127], v6 offset:39936
v_mfma_f32_16x16x32_bf16 v[156:159], a[104:107], a[4:7], v[156:159]
v_mfma_f32_16x16x32_bf16 v[160:163], a[108:111], a[4:7], v[160:163]
buffer_load_dwordx4 a[44:47], v4, s[40:43], s35 offen offset:1024 sc1
v_mfma_f32_16x16x32_bf16 v[144:147], a[108:111], a[0:3], v[144:147]
s_cmp_eq_u32 s3, 6
s_cselect_b32 s35, 6, 30
s_lshl_b32 s35, s35, 12
s_waitcnt vmcnt(8) lgkmcnt(0)
v_mfma_f32_16x16x32_bf16 v[132:135], a[112:115], a[8:11], v[132:135]
ds_read_b128 a[96:99], v6 offset:40960
v_mfma_f32_16x16x32_bf16 v[148:151], a[112:115], a[12:15], v[148:151]
ds_read_b128 a[100:103], v6 offset:41984
v_mfma_f32_16x16x32_bf16 v[152:155], a[116:119], a[12:15], v[152:155]
buffer_load_dwordx4 a[0:3], v4, s[40:43], s35 offen offset:0 sc1
v_mfma_f32_16x16x32_bf16 v[136:139], a[116:119], a[8:11], v[136:139]
ds_read_b128 a[104:107], v6 offset:43008
v_mfma_f32_16x16x32_bf16 v[140:143], a[120:123], a[8:11], v[140:143]
ds_read_b128 a[108:111], v6 offset:44032
v_mfma_f32_16x16x32_bf16 v[156:159], a[120:123], a[12:15], v[156:159]
v_mfma_f32_16x16x32_bf16 v[160:163], a[124:127], a[12:15], v[160:163]
buffer_load_dwordx4 a[4:7], v4, s[40:43], s35 offen offset:1024 sc1
v_mfma_f32_16x16x32_bf16 v[144:147], a[124:127], a[8:11], v[144:147]
s_cmp_eq_u32 s3, 7
s_cselect_b32 s35, 7, 31
s_lshl_b32 s35, s35, 12
s_waitcnt vmcnt(8) lgkmcnt(0)
v_mfma_f32_16x16x32_bf16 v[132:135], a[96:99], a[16:19], v[132:135]
ds_read_b128 a[112:115], v6 offset:45056
v_mfma_f32_16x16x32_bf16 v[148:151], a[96:99], a[20:23], v[148:151]
ds_read_b128 a[116:119], v6 offset:46080
v_mfma_f32_16x16x32_bf16 v[152:155], a[100:103], a[20:23], v[152:155]
buffer_load_dwordx4 a[8:11], v4, s[40:43], s35 offen offset:0 sc1
v_mfma_f32_16x16x32_bf16 v[136:139], a[100:103], a[16:19], v[136:139]
ds_read_b128 a[120:123], v6 offset:47104
v_mfma_f32_16x16x32_bf16 v[140:143], a[104:107], a[16:19], v[140:143]
ds_read_b128 a[124:127], v6 offset:48128
v_mfma_f32_16x16x32_bf16 v[156:159], a[104:107], a[20:23], v[156:159]
v_mfma_f32_16x16x32_bf16 v[160:163], a[108:111], a[20:23], v[160:163]
buffer_load_dwordx4 a[12:15], v4, s[40:43], s35 offen offset:1024 sc1
v_mfma_f32_16x16x32_bf16 v[144:147], a[108:111], a[16:19], v[144:147]
s_waitcnt vmcnt(8) lgkmcnt(0)
v_mfma_f32_16x16x32_bf16 v[132:135], a[112:115], a[24:27], v[132:135]
ds_read_b128 a[96:99], v6 offset:49152
v_mfma_f32_16x16x32_bf16 v[148:151], a[112:115], a[28:31], v[148:151]
ds_read_b128 a[100:103], v6 offset:50176
v_mfma_f32_16x16x32_bf16 v[152:155], a[116:119], a[28:31], v[152:155]
ds_read_b128 a[104:107], v6 offset:51200
v_mfma_f32_16x16x32_bf16 v[136:139], a[116:119], a[24:27], v[136:139]
ds_read_b128 a[108:111], v6 offset:52224
v_mfma_f32_16x16x32_bf16 v[140:143], a[120:123], a[24:27], v[140:143]
v_mfma_f32_16x16x32_bf16 v[156:159], a[120:123], a[28:31], v[156:159]
v_mfma_f32_16x16x32_bf16 v[160:163], a[124:127], a[28:31], v[160:163]
v_mfma_f32_16x16x32_bf16 v[144:147], a[124:127], a[24:27], v[144:147]
s_waitcnt vmcnt(6) lgkmcnt(0)
v_mfma_f32_16x16x32_bf16 v[132:135], a[96:99], a[32:35], v[132:135]
ds_read_b128 a[112:115], v6 offset:53248
v_mfma_f32_16x16x32_bf16 v[148:151], a[96:99], a[36:39], v[148:151]
ds_read_b128 a[116:119], v6 offset:54272
v_mfma_f32_16x16x32_bf16 v[152:155], a[100:103], a[36:39], v[152:155]
ds_read_b128 a[120:123], v6 offset:55296
v_mfma_f32_16x16x32_bf16 v[136:139], a[100:103], a[32:35], v[136:139]
ds_read_b128 a[124:127], v6 offset:56320
v_mfma_f32_16x16x32_bf16 v[140:143], a[104:107], a[32:35], v[140:143]
v_mfma_f32_16x16x32_bf16 v[156:159], a[104:107], a[36:39], v[156:159]
v_mfma_f32_16x16x32_bf16 v[160:163], a[108:111], a[36:39], v[160:163]
v_mfma_f32_16x16x32_bf16 v[144:147], a[108:111], a[32:35], v[144:147]
s_waitcnt vmcnt(4) lgkmcnt(0)
v_mfma_f32_16x16x32_bf16 v[132:135], a[112:115], a[40:43], v[132:135]
ds_read_b128 a[96:99], v6 offset:57344
v_mfma_f32_16x16x32_bf16 v[148:151], a[112:115], a[44:47], v[148:151]
ds_read_b128 a[100:103], v6 offset:58368
v_mfma_f32_16x16x32_bf16 v[152:155], a[116:119], a[44:47], v[152:155]
ds_read_b128 a[104:107], v6 offset:59392
v_mfma_f32_16x16x32_bf16 v[136:139], a[116:119], a[40:43], v[136:139]
ds_read_b128 a[108:111], v6 offset:60416
v_mfma_f32_16x16x32_bf16 v[140:143], a[120:123], a[40:43], v[140:143]
v_mfma_f32_16x16x32_bf16 v[156:159], a[120:123], a[44:47], v[156:159]
v_mfma_f32_16x16x32_bf16 v[160:163], a[124:127], a[44:47], v[160:163]
v_mfma_f32_16x16x32_bf16 v[144:147], a[124:127], a[40:43], v[144:147]
s_waitcnt vmcnt(2) lgkmcnt(0)
v_mfma_f32_16x16x32_bf16 v[132:135], a[96:99], a[0:3], v[132:135]
ds_read_b128 a[112:115], v6 offset:61440
v_mfma_f32_16x16x32_bf16 v[148:151], a[96:99], a[4:7], v[148:151]
ds_read_b128 a[116:119], v6 offset:62464
v_mfma_f32_16x16x32_bf16 v[152:155], a[100:103], a[4:7], v[152:155]
ds_read_b128 a[120:123], v6 offset:63488
v_mfma_f32_16x16x32_bf16 v[136:139], a[100:103], a[0:3], v[136:139]
ds_read_b128 a[124:127], v6 offset:64512
v_mfma_f32_16x16x32_bf16 v[140:143], a[104:107], a[0:3], v[140:143]
v_mfma_f32_16x16x32_bf16 v[156:159], a[104:107], a[4:7], v[156:159]
v_mfma_f32_16x16x32_bf16 v[160:163], a[108:111], a[4:7], v[160:163]
v_mfma_f32_16x16x32_bf16 v[144:147], a[108:111], a[0:3], v[144:147]
s_waitcnt vmcnt(0) lgkmcnt(0)
v_mfma_f32_16x16x32_bf16 v[132:135], a[112:115], a[8:11], v[132:135]
v_mfma_f32_16x16x32_bf16 v[148:151], a[112:115], a[12:15], v[148:151]
v_mfma_f32_16x16x32_bf16 v[152:155], a[116:119], a[12:15], v[152:155]
v_mfma_f32_16x16x32_bf16 v[136:139], a[116:119], a[8:11], v[136:139]
v_mfma_f32_16x16x32_bf16 v[140:143], a[120:123], a[8:11], v[140:143]
v_mfma_f32_16x16x32_bf16 v[156:159], a[120:123], a[12:15], v[156:159]
v_mfma_f32_16x16x32_bf16 v[160:163], a[124:127], a[12:15], v[160:163]
v_mfma_f32_16x16x32_bf16 v[144:147], a[124:127], a[8:11], v[144:147]
s_nop 0
v_cvt_pk_bf16_f32 v32, v132, v133
v_cvt_pk_bf16_f32 v33, v134, v135
s_nop 0
v_cvt_pk_bf16_f32 v34, v136, v137
v_cvt_pk_bf16_f32 v35, v138, v139
v_cvt_pk_bf16_f32 v36, v140, v141
v_cvt_pk_bf16_f32 v37, v142, v143
v_cvt_pk_bf16_f32 v38, v144, v145
v_cvt_pk_bf16_f32 v39, v146, v147
v_cvt_pk_bf16_f32 v40, v148, v149
v_cvt_pk_bf16_f32 v41, v150, v151
v_cvt_pk_bf16_f32 v42, v152, v153
v_cvt_pk_bf16_f32 v43, v154, v155
v_cvt_pk_bf16_f32 v44, v156, v157
v_cvt_pk_bf16_f32 v45, v158, v159
v_cvt_pk_bf16_f32 v46, v160, v161
v_cvt_pk_bf16_f32 v47, v162, v163
s_lshl_b32 s36, s32, 13
s_add_u32 s36, s36, 0x2200000
s_add_u32 s37, s36, 4096
s_mov_b32 s38, 0x2c0000
v_mfma_f32_16x16x32_bf16 v[96:99], v[32:35], v[32:35], 0
v_mfma_f32_16x16x32_bf16 v[92:95], v[16:19], v[32:35], 0
buffer_store_dwordx4 v[32:35], v4, s[4:7], s36 offen offset:0 sc1
v_mfma_f32_16x16x32_bf16 v[104:107], v[40:43], v[40:43], 0
v_mfma_f32_16x16x32_bf16 v[100:103], v[16:19], v[40:43], 0
buffer_store_dwordx4 v[40:43], v4, s[4:7], s36 offen offset:1024 sc1
v_mfma_f32_16x16x32_bf16 v[96:99], v[36:39], v[36:39], v[96:99]
v_mfma_f32_16x16x32_bf16 v[92:95], v[16:19], v[36:39], v[92:95]
buffer_store_dwordx4 v[36:39], v4, s[4:7], s37 offen offset:0 sc1
v_mfma_f32_16x16x32_bf16 v[104:107], v[44:47], v[44:47], v[104:107]
v_mfma_f32_16x16x32_bf16 v[100:103], v[16:19], v[44:47], v[100:103]
buffer_store_dwordx4 v[44:47], v4, s[4:7], s37 offen offset:1024 sc1
s_nop 2
v_cndmask_b32 v96, v96, v97, s[46:47]
v_cndmask_b32 v98, v98, v99, s[46:47]
v_cndmask_b32 v93, v96, v98, s[48:49]
buffer_store_dwordx2 v[92:93], v253, s[4:7], s38 offen offset:0 sc1
v_cndmask_b32 v104, v104, v105, s[46:47]
v_cndmask_b32 v106, v106, v107, s[46:47]
v_cndmask_b32 v101, v104, v106, s[48:49]
buffer_store_dwordx2 v[100:101], v253, s[4:7], s38 offen offset:2048 sc1
s_add_u32 s92, s78, 0x60000
s_add_u32 s93, s79, 0x60000
s_add_u32 s40, s4, 0x2200000
s_addc_u32 s41, s5, 0
s_barrier
s_add_u32 s44, s28, 0
s_mul_i32 s45, s44, 3072
s_add_u32 m0, s45, 0
s_lshr_b32 s44, s44, 1
s_add_u32 s44, s44, 0
s_add_u32 s44, s44, s33
s_and_b32 s44, s44, 31
s_mul_i32 s44, s44, 6144
s_add_u32 s44, s44, s50
s_add_u32 s44, s44, 0x600000
buffer_load_dwordx4 v1, s[4:7], s44 offen offset:0 sc1 lds
buffer_load_dwordx4 v1, s[4:7], s44 offen offset:1024 sc1 lds
buffer_load_dwordx4 v1, s[4:7], s44 offen offset:2048 sc1 lds
s_add_u32 s44, s28, 4
s_mul_i32 s45, s44, 3072
s_add_u32 m0, s45, 0
s_lshr_b32 s44, s44, 1
s_add_u32 s44, s44, 0
s_add_u32 s44, s44, s33
s_and_b32 s44, s44, 31
s_mul_i32 s44, s44, 6144
s_add_u32 s44, s44, s50
s_add_u32 s44, s44, 0x600000
buffer_load_dwordx4 v1, s[4:7], s44 offen offset:0 sc1 lds
buffer_load_dwordx4 v1, s[4:7], s44 offen offset:1024 sc1 lds
buffer_load_dwordx4 v1, s[4:7], s44 offen offset:2048 sc1 lds
s_add_u32 s44, s28, 8
s_mul_i32 s45, s44, 3072
s_add_u32 m0, s45, 0
s_lshr_b32 s44, s44, 1
s_add_u32 s44, s44, 0
s_add_u32 s44, s44, s33
s_and_b32 s44, s44, 31
s_mul_i32 s44, s44, 6144
s_add_u32 s44, s44, s50
s_add_u32 s44, s44, 0x600000
buffer_load_dwordx4 v1, s[4:7], s44 offen offset:0 sc1 lds
buffer_load_dwordx4 v1, s[4:7], s44 offen offset:1024 sc1 lds
buffer_load_dwordx4 v1, s[4:7], s44 offen offset:2048 sc1 lds
s_add_u32 s44, s28, 12
s_mul_i32 s45, s44, 3072
s_add_u32 m0, s45, 0
s_lshr_b32 s44, s44, 1
s_add_u32 s44, s44, 0
s_add_u32 s44, s44, s33
s_and_b32 s44, s44, 31
s_mul_i32 s44, s44, 6144
s_add_u32 s44, s44, s50
s_add_u32 s44, s44, 0x600000
buffer_load_dwordx4 v1, s[4:7], s44 offen offset:0 sc1 lds
buffer_load_dwordx4 v1, s[4:7], s44 offen offset:1024 sc1 lds
buffer_load_dwordx4 v1, s[4:7], s44 offen offset:2048 sc1 lds
s_waitcnt vmcnt(12)
s_barrier
buffer_atomic_add v12, v10, s[4:7], s92 offen sc1
s_cmp_lt_u32 s28, 2
s_cbranch_scc1 Lwd_24
s_add_u32 s44, s28, 0
s_mul_i32 s45, s44, 3072
s_add_u32 m0, s45, 49152
s_lshr_b32 s44, s44, 1
s_add_u32 s44, s44, 8
s_add_u32 s44, s44, s33
s_and_b32 s44, s44, 31
s_mul_i32 s44, s44, 6144
s_add_u32 s44, s44, s50
s_add_u32 s44, s44, 0x600000
buffer_load_dwordx4 v1, s[4:7], s44 offen offset:0 sc1 lds
buffer_load_dwordx4 v1, s[4:7], s44 offen offset:1024 sc1 lds
buffer_load_dwordx4 v1, s[4:7], s44 offen offset:2048 sc1 lds
s_sub_u32 s44, s28, 2
s_mul_i32 s45, s44, 3072
s_add_u32 m0, s45, 49152
s_lshr_b32 s44, s44, 1
s_add_u32 s44, s44, 8
s_add_u32 s44, s44, s33
s_and_b32 s44, s44, 31
s_mul_i32 s44, s44, 6144
s_add_u32 s44, s44, s50
s_add_u32 s44, s44, 0x600000
buffer_load_dwordx4 v1, s[4:7], s44 offen offset:0 sc1 lds
buffer_load_dwordx4 v1, s[4:7], s44 offen offset:1024 sc1 lds
buffer_load_dwordx4 v1, s[4:7], s44 offen offset:2048 sc1 lds
s_add_u32 s44, s28, 4
s_mul_i32 s45, s44, 3072
s_add_u32 m0, s45, 49152
s_lshr_b32 s44, s44, 1
s_add_u32 s44, s44, 8
s_add_u32 s44, s44, s33
s_and_b32 s44, s44, 31
s_mul_i32 s44, s44, 6144
s_add_u32 s44, s44, s50
s_add_u32 s44, s44, 0x600000
buffer_load_dwordx4 v1, s[4:7], s44 offen offset:0 sc1 lds
buffer_load_dwordx4 v1, s[4:7], s44 offen offset:1024 sc1 lds
buffer_load_dwordx4 v1, s[4:7], s44 offen offset:2048 sc1 lds
s_add_u32 s44, s28, 2
s_mul_i32 s45, s44, 3072
s_add_u32 m0, s45, 49152
s_lshr_b32 s44, s44, 1
s_add_u32 s44, s44, 8
s_add_u32 s44, s44, s33
s_and_b32 s44, s44, 31
s_mul_i32 s44, s44, 6144
s_add_u32 s44, s44, s50
s_add_u32 s44, s44, 0x600000
buffer_load_dwordx4 v1, s[4:7], s44 offen offset:0 sc1 lds
buffer_load_dwordx4 v1, s[4:7], s44 offen offset:1024 sc1 lds
buffer_load_dwordx4 v1, s[4:7], s44 offen offset:2048 sc1 lds
s_add_u32 s44, s28, 8
s_mul_i32 s45, s44, 3072
s_add_u32 m0, s45, 49152
s_lshr_b32 s44, s44, 1
s_add_u32 s44, s44, 8
s_add_u32 s44, s44, s33
s_and_b32 s44, s44, 31
s_mul_i32 s44, s44, 6144
s_add_u32 s44, s44, s50
s_add_u32 s44, s44, 0x600000
buffer_load_dwordx4 v1, s[4:7], s44 offen offset:0 sc1 lds
buffer_load_dwordx4 v1, s[4:7], s44 offen offset:1024 sc1 lds
buffer_load_dwordx4 v1, s[4:7], s44 offen offset:2048 sc1 lds
s_add_u32 s44, s28, 6
s_mul_i32 s45, s44, 3072
s_add_u32 m0, s45, 49152
s_lshr_b32 s44, s44, 1
s_add_u32 s44, s44, 8
s_add_u32 s44, s44, s33
s_and_b32 s44, s44, 31
s_mul_i32 s44, s44, 6144
s_add_u32 s44, s44, s50
s_add_u32 s44, s44, 0x600000
buffer_load_dwordx4 v1, s[4:7], s44 offen offset:0 sc1 lds
buffer_load_dwordx4 v1, s[4:7], s44 offen offset:1024 sc1 lds
buffer_load_dwordx4 v1, s[4:7], s44 offen offset:2048 sc1 lds
s_add_u32 s44, s28, 12
s_mul_i32 s45, s44, 3072
s_add_u32 m0, s45, 49152
s_lshr_b32 s44, s44, 1
s_add_u32 s44, s44, 8
s_add_u32 s44, s44, s33
s_and_b32 s44, s44, 31
s_mul_i32 s44, s44, 6144
s_add_u32 s44, s44, s50
s_add_u32 s44, s44, 0x600000
buffer_load_dwordx4 v1, s[4:7], s44 offen offset:0 sc1 lds
buffer_load_dwordx4 v1, s[4:7], s44 offen offset:1024 sc1 lds
buffer_load_dwordx4 v1, s[4:7], s44 offen offset:2048 sc1 lds
s_add_u32 s44, s28, 10
s_mul_i32 s45, s44, 3072
s_add_u32 m0, s45, 49152
s_lshr_b32 s44, s44, 1
s_add_u32 s44, s44, 8
s_add_u32 s44, s44, s33
s_and_b32 s44, s44, 31
s_mul_i32 s44, s44, 6144
s_add_u32 s44, s44, s50
s_add_u32 s44, s44, 0x600000
buffer_load_dwordx4 v1, s[4:7], s44 offen offset:0 sc1 lds
buffer_load_dwordx4 v1, s[4:7], s44 offen offset:1024 sc1 lds
buffer_load_dwordx4 v1, s[4:7], s44 offen offset:2048 sc1 lds
Lwd_24:
s_cmp_lg_u32 s28, 0
s_cbranch_scc1 Lpe_26
s_add_u32 s36, s67, 0x60000
s_mov_b32 s37, 0
Lpoll_25:
v_mov_b32 v11, 0
s_mov_b64 exec, 1
buffer_atomic_add v11, off, s[4:7], s36 sc0 sc1
s_waitcnt vmcnt(0)
v_readfirstlane_b32 s38, v11
s_mov_b64 exec, -1
s_nop 0
v_mov_b32 v11, s38
s_add_u32 s37, s37, 1
v_cmp_gt_u32 vcc, 32, v11
s_cbranch_vccz Lpe_26
s_cmp_lt_u32 s37, 0x100000
s_cbranch_scc1 Lpoll_25
Lpe_26:
s_waitcnt vmcnt(24)
s_cmp_ge_u32 s28, 2
s_cbranch_scc1 Lw_27
s_waitcnt vmcnt(0)
Lw_27:
s_barrier
s_add_u32 s94, s80, 0x90080
s_lshl_b32 s35, s33, 12
buffer_load_dwordx4 a[0:3], v2, s[40:43], s35 offen offset:0 sc1
buffer_load_dwordx4 a[4:7], v2, s[40:43], s35 offen offset:1024 sc1
buffer_load_dwordx4 a[8:11], v2, s[40:43], s35 offen offset:2048 sc1
buffer_load_dwordx4 a[12:15], v2, s[40:43], s35 offen offset:3072 sc1
s_add_u32 s35, s35, 4096
s_and_b32 s35, s35, 0x1ffff
buffer_load_dwordx4 a[16:19], v2, s[40:43], s35 offen offset:0 sc1
buffer_load_dwordx4 a[20:23], v2, s[40:43], s35 offen offset:1024 sc1
buffer_load_dwordx4 a[24:27], v2, s[40:43], s35 offen offset:2048 sc1
buffer_load_dwordx4 a[28:31], v2, s[40:43], s35 offen offset:3072 sc1
s_add_u32 s35, s35, 4096
s_and_b32 s35, s35, 0x1ffff
buffer_load_dwordx4 a[32:35], v2, s[40:43], s35 offen offset:0 sc1
buffer_load_dwordx4 a[36:39], v2, s[40:43], s35 offen offset:1024 sc1
buffer_load_dwordx4 a[40:43], v2, s[40:43], s35 offen offset:2048 sc1
buffer_load_dwordx4 a[44:47], v2, s[40:43], s35 offen offset:3072 sc1
s_add_u32 s35, s35, 4096
s_and_b32 s35, s35, 0x1ffff
v_add_u32 v5, 0, v1
ds_read_b128 a[96:99], v5 offset:0
ds_read_b128 a[100:103], v5 offset:1024
ds_read_b128 a[104:107], v5 offset:2048
ds_read_b128 a[108:111], v5 offset:3072
ds_read_b128 a[112:115], v5 offset:4096
ds_read_b128 a[116:119], v5 offset:5120
s_waitcnt vmcnt(8) lgkmcnt(0)
v_mfma_f32_16x16x32_bf16 v[132:135], a[96:99], a[0:3], 0
s_add_u32 s44, s28, 0
s_mul_i32 s45, s44, 3072
s_add_u32 m0, s45, 98304
v_mfma_f32_16x16x32_bf16 v[156:159], a[96:99], a[4:7], 0
buffer_load_dwordx4 a[48:51], v2, s[40:43], s35 offen offset:0 sc1
s_lshr_b32 s44, s44, 1
v_mfma_f32_16x16x32_bf16 v[180:183], a[96:99], a[8:11], 0
s_add_u32 s44, s44, 16
s_add_u32 s44, s44, s33
s_and_b32 s44, s44, 31
v_mfma_f32_16x16x32_bf16 v[204:207], a[96:99], a[12:15], 0
s_mul_i32 s44, s44, 6144
s_add_u32 s44, s44, s50
s_add_u32 s44, s44, 0x600000
v_mfma_f32_16x16x32_bf16 v[208:211], a[100:103], a[12:15], 0
ds_read_b128 a[128:131], v5 offset:6144
v_mfma_f32_16x16x32_bf16 v[184:187], a[100:103], a[8:11], 0
buffer_load_dwordx4 v1, s[4:7], s44 offen offset:0 sc1 lds
v_mfma_f32_16x16x32_bf16 v[160:163], a[100:103], a[4:7], 0
ds_read_b128 a[132:135], v5 offset:7168
v_mfma_f32_16x16x32_bf16 v[136:139], a[100:103], a[0:3], 0
ds_read_b128 a[136:139], v5 offset:8192
v_mfma_f32_16x16x32_bf16 v[140:143], a[104:107], a[0:3], 0
ds_read_b128 a[140:143], v5 offset:9216
v_mfma_f32_16x16x32_bf16 v[164:167], a[104:107], a[4:7], 0
buffer_load_dwordx4 a[52:55], v2, s[40:43], s35 offen offset:1024 sc1
v_mfma_f32_16x16x32_bf16 v[188:191], a[104:107], a[8:11], 0
ds_read_b128 a[144:147], v5 offset:10240
v_mfma_f32_16x16x32_bf16 v[212:215], a[104:107], a[12:15], 0
v_mfma_f32_16x16x32_bf16 v[216:219], a[108:111], a[12:15], 0
v_mfma_f32_16x16x32_bf16 v[192:195], a[108:111], a[8:11], 0
buffer_load_dwordx4 a[56:59], v2, s[40:43], s35 offen offset:2048 sc1
v_mfma_f32_16x16x32_bf16 v[168:171], a[108:111], a[4:7], 0
ds_read_b128 a[148:151], v5 offset:11264
v_mfma_f32_16x16x32_bf16 v[144:147], a[108:111], a[0:3], 0
v_mfma_f32_16x16x32_bf16 v[148:151], a[112:115], a[0:3], 0
v_mfma_f32_16x16x32_bf16 v[172:175], a[112:115], a[4:7], 0
buffer_load_dwordx4 v1, s[4:7], s44 offen offset:1024 sc1 lds
v_mfma_f32_16x16x32_bf16 v[196:199], a[112:115], a[8:11], 0
v_mfma_f32_16x16x32_bf16 v[220:223], a[112:115], a[12:15], 0
v_mfma_f32_16x16x32_bf16 v[224:227], a[116:119], a[12:15], 0
v_mfma_f32_16x16x32_bf16 v[200:203], a[116:119], a[8:11], 0
buffer_load_dwordx4 a[60:63], v2, s[40:43], s35 offen offset:3072 sc1
s_add_u32 s35, s35, 4096
v_mfma_f32_16x16x32_bf16 v[176:179], a[116:119], a[4:7], 0
s_and_b32 s35, s35, 0x1ffff
v_mfma_f32_16x16x32_bf16 v[152:155], a[116:119], a[0:3], 0
s_waitcnt vmcnt(10) lgkmcnt(0)
v_mfma_f32_16x16x32_bf16 v[132:135], a[128:131], a[16:19], v[132:135]
ds_read_b128 a[96:99], v5 offset:12288
v_mfma_f32_16x16x32_bf16 v[156:159], a[128:131], a[20:23], v[156:159]
buffer_load_dwordx4 a[0:3], v2, s[40:43], s35 offen offset:0 sc1
v_mfma_f32_16x16x32_bf16 v[180:183], a[128:131], a[24:27], v[180:183]
ds_read_b128 a[100:103], v5 offset:13312
v_mfma_f32_16x16x32_bf16 v[204:207], a[128:131], a[28:31], v[204:207]
v_mfma_f32_16x16x32_bf16 v[208:211], a[132:135], a[28:31], v[208:211]
v_mfma_f32_16x16x32_bf16 v[184:187], a[132:135], a[24:27], v[184:187]
buffer_load_dwordx4 a[4:7], v2, s[40:43], s35 offen offset:1024 sc1
v_mfma_f32_16x16x32_bf16 v[160:163], a[132:135], a[20:23], v[160:163]
ds_read_b128 a[104:107], v5 offset:14336
v_mfma_f32_16x16x32_bf16 v[136:139], a[132:135], a[16:19], v[136:139]
v_mfma_f32_16x16x32_bf16 v[140:143], a[136:139], a[16:19], v[140:143]
ds_read_b128 a[108:111], v5 offset:15360
v_mfma_f32_16x16x32_bf16 v[164:167], a[136:139], a[20:23], v[164:167]
v_mfma_f32_16x16x32_bf16 v[188:191], a[136:139], a[24:27], v[188:191]
buffer_load_dwordx4 v1, s[4:7], s44 offen offset:2048 sc1 lds
s_add_u32 s44, s28, 4
v_mfma_f32_16x16x32_bf16 v[212:215], a[136:139], a[28:31], v[212:215]
s_mul_i32 s45, s44, 3072
s_add_u32 m0, s45, 98304
s_lshr_b32 s44, s44, 1
v_mfma_f32_16x16x32_bf16 v[216:219], a[140:143], a[28:31], v[216:219]
s_add_u32 s44, s44, 16
s_add_u32 s44, s44, s33
s_and_b32 s44, s44, 31
v_mfma_f32_16x16x32_bf16 v[192:195], a[140:143], a[24:27], v[192:195]
s_mul_i32 s44, s44, 6144
s_add_u32 s44, s44, s50
s_add_u32 s44, s44, 0x600000
v_mfma_f32_16x16x32_bf16 v[168:171], a[140:143], a[20:23], v[168:171]
ds_read_b128 a[112:115], v5 offset:16384
v_mfma_f32_16x16x32_bf16 v[144:147], a[140:143], a[16:19], v[144:147]
buffer_load_dwordx4 a[8:11], v2, s[40:43], s35 offen offset:2048 sc1
v_mfma_f32_16x16x32_bf16 v[148:151], a[144:147], a[16:19], v[148:151]
ds_read_b128 a[116:119], v5 offset:17408
v_mfma_f32_16x16x32_bf16 v[172:175], a[144:147], a[20:23], v[172:175]
v_mfma_f32_16x16x32_bf16 v[196:199], a[144:147], a[24:27], v[196:199]
v_mfma_f32_16x16x32_bf16 v[220:223], a[144:147], a[28:31], v[220:223]
v_mfma_f32_16x16x32_bf16 v[224:227], a[148:151], a[28:31], v[224:227]
buffer_load_dwordx4 a[12:15], v2, s[40:43], s35 offen offset:3072 sc1
s_add_u32 s35, s35, 4096
v_mfma_f32_16x16x32_bf16 v[200:203], a[148:151], a[24:27], v[200:203]
s_and_b32 s35, s35, 0x1ffff
v_mfma_f32_16x16x32_bf16 v[176:179], a[148:151], a[20:23], v[176:179]
v_mfma_f32_16x16x32_bf16 v[152:155], a[148:151], a[16:19], v[152:155]
s_waitcnt vmcnt(11) lgkmcnt(0)
v_mfma_f32_16x16x32_bf16 v[132:135], a[96:99], a[32:35], v[132:135]
ds_read_b128 a[128:131], v5 offset:18432
v_mfma_f32_16x16x32_bf16 v[156:159], a[96:99], a[36:39], v[156:159]
buffer_load_dwordx4 a[16:19], v2, s[40:43], s35 offen offset:0 sc1
v_mfma_f32_16x16x32_bf16 v[180:183], a[96:99], a[40:43], v[180:183]
ds_read_b128 a[132:135], v5 offset:19456
v_mfma_f32_16x16x32_bf16 v[204:207], a[96:99], a[44:47], v[204:207]
v_mfma_f32_16x16x32_bf16 v[208:211], a[100:103], a[44:47], v[208:211]
v_mfma_f32_16x16x32_bf16 v[184:187], a[100:103], a[40:43], v[184:187]
buffer_load_dwordx4 v1, s[4:7], s44 offen offset:0 sc1 lds
v_mfma_f32_16x16x32_bf16 v[160:163], a[100:103], a[36:39], v[160:163]
ds_read_b128 a[136:139], v5 offset:20480
v_mfma_f32_16x16x32_bf16 v[136:139], a[100:103], a[32:35], v[136:139]
v_mfma_f32_16x16x32_bf16 v[140:143], a[104:107], a[32:35], v[140:143]
ds_read_b128 a[140:143], v5 offset:21504
v_mfma_f32_16x16x32_bf16 v[164:167], a[104:107], a[36:39], v[164:167]
buffer_load_dwordx4 a[20:23], v2, s[40:43], s35 offen offset:1024 sc1
v_mfma_f32_16x16x32_bf16 v[188:191], a[104:107], a[40:43], v[188:191]
ds_read_b128 a[144:147], v5 offset:22528
v_mfma_f32_16x16x32_bf16 v[212:215], a[104:107], a[44:47], v[212:215]
v_mfma_f32_16x16x32_bf16 v[216:219], a[108:111], a[44:47], v[216:219]
v_mfma_f32_16x16x32_bf16 v[192:195], a[108:111], a[40:43], v[192:195]
buffer_load_dwordx4 a[24:27], v2, s[40:43], s35 offen offset:2048 sc1
v_mfma_f32_16x16x32_bf16 v[168:171], a[108:111], a[36:39], v[168:171]
ds_read_b128 a[148:151], v5 offset:23552
v_mfma_f32_16x16x32_bf16 v[144:147], a[108:111], a[32:35], v[144:147]
v_mfma_f32_16x16x32_bf16 v[148:151], a[112:115], a[32:35], v[148:151]
v_mfma_f32_16x16x32_bf16 v[172:175], a[112:115], a[36:39], v[172:175]
buffer_load_dwordx4 v1, s[4:7], s44 offen offset:1024 sc1 lds
v_mfma_f32_16x16x32_bf16 v[196:199], a[112:115], a[40:43], v[196:199]
v_mfma_f32_16x16x32_bf16 v[220:223], a[112:115], a[44:47], v[220:223]
v_mfma_f32_16x16x32_bf16 v[224:227], a[116:119], a[44:47], v[224:227]
v_mfma_f32_16x16x32_bf16 v[200:203], a[116:119], a[40:43], v[200:203]
buffer_load_dwordx4 a[28:31], v2, s[40:43], s35 offen offset:3072 sc1
s_add_u32 s35, s35, 4096
v_mfma_f32_16x16x32_bf16 v[176:179], a[116:119], a[36:39], v[176:179]
s_and_b32 s35, s35, 0x1ffff
v_mfma_f32_16x16x32_bf16 v[152:155], a[116:119], a[32:35], v[152:155]
s_waitcnt vmcnt(11) lgkmcnt(0)
v_mfma_f32_16x16x32_bf16 v[132:135], a[128:131], a[48:51], v[132:135]
ds_read_b128 a[96:99], v5 offset:24576
v_mfma_f32_16x16x32_bf16 v[156:159], a[128:131], a[52:55], v[156:159]
buffer_load_dwordx4 a[32:35], v2, s[40:43], s35 offen offset:0 sc1
v_mfma_f32_16x16x32_bf16 v[180:183], a[128:131], a[56:59], v[180:183]
ds_read_b128 a[100:103], v5 offset:25600
v_mfma_f32_16x16x32_bf16 v[204:207], a[128:131], a[60:63], v[204:207]
v_mfma_f32_16x16x32_bf16 v[208:211], a[132:135], a[60:63], v[208:211]
v_mfma_f32_16x16x32_bf16 v[184:187], a[132:135], a[56:59], v[184:187]
buffer_load_dwordx4 a[36:39], v2, s[40:43], s35 offen offset:1024 sc1
v_mfma_f32_16x16x32_bf16 v[160:163], a[132:135], a[52:55], v[160:163]
ds_read_b128 a[104:107], v5 offset:26624
v_mfma_f32_16x16x32_bf16 v[136:139], a[132:135], a[48:51], v[136:139]
v_mfma_f32_16x16x32_bf16 v[140:143], a[136:139], a[48:51], v[140:143]
ds_read_b128 a[108:111], v5 offset:27648
v_mfma_f32_16x16x32_bf16 v[164:167], a[136:139], a[52:55], v[164:167]
v_mfma_f32_16x16x32_bf16 v[188:191], a[136:139], a[56:59], v[188:191]
buffer_load_dwordx4 v1, s[4:7], s44 offen offset:2048 sc1 lds
s_add_u32 s44, s28, 8
v_mfma_f32_16x16x32_bf16 v[212:215], a[136:139], a[60:63], v[212:215]
s_mul_i32 s45, s44, 3072
s_add_u32 m0, s45, 98304
s_lshr_b32 s44, s44, 1
v_mfma_f32_16x16x32_bf16 v[216:219], a[140:143], a[60:63], v[216:219]
s_add_u32 s44, s44, 16
s_add_u32 s44, s44, s33
s_and_b32 s44, s44, 31
v_mfma_f32_16x16x32_bf16 v[192:195], a[140:143], a[56:59], v[192:195]
s_mul_i32 s44, s44, 6144
s_add_u32 s44, s44, s50
s_add_u32 s44, s44, 0x600000
v_mfma_f32_16x16x32_bf16 v[168:171], a[140:143], a[52:55], v[168:171]
ds_read_b128 a[112:115], v5 offset:28672
v_mfma_f32_16x16x32_bf16 v[144:147], a[140:143], a[48:51], v[144:147]
buffer_load_dwordx4 a[40:43], v2, s[40:43], s35 offen offset:2048 sc1
v_mfma_f32_16x16x32_bf16 v[148:151], a[144:147], a[48:51], v[148:151]
ds_read_b128 a[116:119], v5 offset:29696
v_mfma_f32_16x16x32_bf16 v[172:175], a[144:147], a[52:55], v[172:175]
v_mfma_f32_16x16x32_bf16 v[196:199], a[144:147], a[56:59], v[196:199]
v_mfma_f32_16x16x32_bf16 v[220:223], a[144:147], a[60:63], v[220:223]
v_mfma_f32_16x16x32_bf16 v[224:227], a[148:151], a[60:63], v[224:227]
buffer_load_dwordx4 a[44:47], v2, s[40:43], s35 offen offset:3072 sc1
s_add_u32 s35, s35, 4096
v_mfma_f32_16x16x32_bf16 v[200:203], a[148:151], a[56:59], v[200:203]
s_and_b32 s35, s35, 0x1ffff
v_mfma_f32_16x16x32_bf16 v[176:179], a[148:151], a[52:55], v[176:179]
v_mfma_f32_16x16x32_bf16 v[152:155], a[148:151], a[48:51], v[152:155]
s_waitcnt vmcnt(11) lgkmcnt(0)
v_mfma_f32_16x16x32_bf16 v[132:135], a[96:99], a[0:3], v[132:135]
ds_read_b128 a[128:131], v5 offset:30720
v_accvgpr_read_b32 v48, a188
v_mfma_f32_16x16x32_bf16 v[156:159], a[96:99], a[4:7], v[156:159]
buffer_load_dwordx4 a[48:51], v2, s[40:43], s35 offen offset:0 sc1
v_mfma_f32_16x16x32_bf16 v[180:183], a[96:99], a[8:11], v[180:183]
ds_read_b128 a[132:135], v5 offset:31744
v_mfma_f32_16x16x32_bf16 v[204:207], a[96:99], a[12:15], v[204:207]
v_mfma_f32_16x16x32_bf16 v[208:211], a[100:103], a[12:15], v[208:211]
v_mfma_f32_16x16x32_bf16 v[184:187], a[100:103], a[8:11], v[184:187]
buffer_load_dwordx4 v1, s[4:7], s44 offen offset:0 sc1 lds
v_mfma_f32_16x16x32_bf16 v[160:163], a[100:103], a[4:7], v[160:163]
ds_read_b128 a[136:139], v5 offset:32768
v_mfma_f32_16x16x32_bf16 v[136:139], a[100:103], a[0:3], v[136:139]
v_accvgpr_read_b32 v49, a189
v_mfma_f32_16x16x32_bf16 v[140:143], a[104:107], a[0:3], v[140:143]
ds_read_b128 a[140:143], v5 offset:33792
v_mfma_f32_16x16x32_bf16 v[164:167], a[104:107], a[4:7], v[164:167]
buffer_load_dwordx4 a[52:55], v2, s[40:43], s35 offen offset:1024 sc1
v_mfma_f32_16x16x32_bf16 v[188:191], a[104:107], a[8:11], v[188:191]
ds_read_b128 a[144:147], v5 offset:34816
v_mfma_f32_16x16x32_bf16 v[212:215], a[104:107], a[12:15], v[212:215]
v_mfma_f32_16x16x32_bf16 v[216:219], a[108:111], a[12:15], v[216:219]
v_mfma_f32_16x16x32_bf16 v[192:195], a[108:111], a[8:11], v[192:195]
buffer_load_dwordx4 a[56:59], v2, s[40:43], s35 offen offset:2048 sc1
v_mfma_f32_16x16x32_bf16 v[168:171], a[108:111], a[4:7], v[168:171]
ds_read_b128 a[148:151], v5 offset:35840
v_accvgpr_read_b32 v50, a190
v_mfma_f32_16x16x32_bf16 v[144:147], a[108:111], a[0:3], v[144:147]
v_mfma_f32_16x16x32_bf16 v[148:151], a[112:115], a[0:3], v[148:151]
v_mfma_f32_16x16x32_bf16 v[172:175], a[112:115], a[4:7], v[172:175]
buffer_load_dwordx4 v1, s[4:7], s44 offen offset:1024 sc1 lds
v_mfma_f32_16x16x32_bf16 v[196:199], a[112:115], a[8:11], v[196:199]
v_mfma_f32_16x16x32_bf16 v[220:223], a[112:115], a[12:15], v[220:223]
v_mfma_f32_16x16x32_bf16 v[224:227], a[116:119], a[12:15], v[224:227]
v_mfma_f32_16x16x32_bf16 v[200:203], a[116:119], a[8:11], v[200:203]
buffer_load_dwordx4 a[60:63], v2, s[40:43], s35 offen offset:3072 sc1
s_add_u32 s35, s35, 4096
v_mfma_f32_16x16x32_bf16 v[176:179], a[116:119], a[4:7], v[176:179]
s_and_b32 s35, s35, 0x1ffff
v_accvgpr_read_b32 v51, a191
v_mfma_f32_16x16x32_bf16 v[152:155], a[116:119], a[0:3], v[152:155]
s_waitcnt vmcnt(11) lgkmcnt(0)
v_mfma_f32_16x16x32_bf16 v[132:135], a[128:131], a[16:19], v[132:135]
ds_read_b128 a[96:99], v5 offset:36864
v_mfma_f32_16x16x32_bf16 v[156:159], a[128:131], a[20:23], v[156:159]
buffer_load_dwordx4 a[0:3], v2, s[40:43], s35 offen offset:0 sc1
v_mfma_f32_16x16x32_bf16 v[180:183], a[128:131], a[24:27], v[180:183]
ds_read_b128 a[100:103], v5 offset:37888
v_mfma_f32_16x16x32_bf16 v[204:207], a[128:131], a[28:31], v[204:207]
v_mfma_f32_16x16x32_bf16 v[208:211], a[132:135], a[28:31], v[208:211]
v_accvgpr_read_b32 v52, a192
v_mfma_f32_16x16x32_bf16 v[184:187], a[132:135], a[24:27], v[184:187]
buffer_load_dwordx4 a[4:7], v2, s[40:43], s35 offen offset:1024 sc1
v_mfma_f32_16x16x32_bf16 v[160:163], a[132:135], a[20:23], v[160:163]
ds_read_b128 a[104:107], v5 offset:38912
v_mfma_f32_16x16x32_bf16 v[136:139], a[132:135], a[16:19], v[136:139]
v_mfma_f32_16x16x32_bf16 v[140:143], a[136:139], a[16:19], v[140:143]
ds_read_b128 a[108:111], v5 offset:39936
v_mfma_f32_16x16x32_bf16 v[164:167], a[136:139], a[20:23], v[164:167]
v_mfma_f32_16x16x32_bf16 v[188:191], a[136:139], a[24:27], v[188:191]
buffer_load_dwordx4 v1, s[4:7], s44 offen offset:2048 sc1 lds
s_add_u32 s44, s28, 12
v_mfma_f32_16x16x32_bf16 v[212:215], a[136:139], a[28:31], v[212:215]
s_mul_i32 s45, s44, 3072
s_add_u32 m0, s45, 98304
s_lshr_b32 s44, s44, 1
v_mfma_f32_16x16x32_bf16 v[216:219], a[140:143], a[28:31], v[216:219]
s_add_u32 s44, s44, 16
s_add_u32 s44, s44, s33
s_and_b32 s44, s44, 31
v_mfma_f32_16x16x32_bf16 v[192:195], a[140:143], a[24:27], v[192:195]
s_mul_i32 s44, s44, 6144
s_add_u32 s44, s44, s50
s_add_u32 s44, s44, 0x600000
v_mfma_f32_16x16x32_bf16 v[168:171], a[140:143], a[20:23], v[168:171]
ds_read_b128 a[112:115], v5 offset:40960
v_accvgpr_read_b32 v53, a193
v_mfma_f32_16x16x32_bf16 v[144:147], a[140:143], a[16:19], v[144:147]
buffer_load_dwordx4 a[8:11], v2, s[40:43], s35 offen offset:2048 sc1
v_mfma_f32_16x16x32_bf16 v[148:151], a[144:147], a[16:19], v[148:151]
ds_read_b128 a[116:119], v5 offset:41984
v_mfma_f32_16x16x32_bf16 v[172:175], a[144:147], a[20:23], v[172:175]
v_mfma_f32_16x16x32_bf16 v[196:199], a[144:147], a[24:27], v[196:199]
v_accvgpr_read_b32 v54, a194
v_mfma_f32_16x16x32_bf16 v[220:223], a[144:147], a[28:31], v[220:223]
v_mfma_f32_16x16x32_bf16 v[224:227], a[148:151], a[28:31], v[224:227]
buffer_load_dwordx4 a[12:15], v2, s[40:43], s35 offen offset:3072 sc1
s_add_u32 s35, s35, 4096
v_mfma_f32_16x16x32_bf16 v[200:203], a[148:151], a[24:27], v[200:203]
s_and_b32 s35, s35, 0x1ffff
v_mfma_f32_16x16x32_bf16 v[176:179], a[148:151], a[20:23], v[176:179]
v_mfma_f32_16x16x32_bf16 v[152:155], a[148:151], a[16:19], v[152:155]
s_waitcnt vmcnt(11) lgkmcnt(0)
v_mfma_f32_16x16x32_bf16 v[132:135], a[96:99], a[32:35], v[132:135]
ds_read_b128 a[128:131], v5 offset:43008
v_mfma_f32_16x16x32_bf16 v[156:159], a[96:99], a[36:39], v[156:159]
buffer_load_dwordx4 a[16:19], v2, s[40:43], s35 offen offset:0 sc1
v_mfma_f32_16x16x32_bf16 v[180:183], a[96:99], a[40:43], v[180:183]
ds_read_b128 a[132:135], v5 offset:44032
v_accvgpr_read_b32 v55, a195
v_mfma_f32_16x16x32_bf16 v[204:207], a[96:99], a[44:47], v[204:207]
v_mfma_f32_16x16x32_bf16 v[208:211], a[100:103], a[44:47], v[208:211]
v_mfma_f32_16x16x32_bf16 v[184:187], a[100:103], a[40:43], v[184:187]
buffer_load_dwordx4 v1, s[4:7], s44 offen offset:0 sc1 lds
v_mfma_f32_16x16x32_bf16 v[160:163], a[100:103], a[36:39], v[160:163]
ds_read_b128 a[136:139], v5 offset:45056
v_mfma_f32_16x16x32_bf16 v[136:139], a[100:103], a[32:35], v[136:139]
v_mfma_f32_16x16x32_bf16 v[140:143], a[104:107], a[32:35], v[140:143]
ds_read_b128 a[140:143], v5 offset:46080
v_accvgpr_read_b32 v56, a196
v_mfma_f32_16x16x32_bf16 v[164:167], a[104:107], a[36:39], v[164:167]
buffer_load_dwordx4 a[20:23], v2, s[40:43], s35 offen offset:1024 sc1
v_mfma_f32_16x16x32_bf16 v[188:191], a[104:107], a[40:43], v[188:191]
ds_read_b128 a[144:147], v5 offset:47104
v_mfma_f32_16x16x32_bf16 v[212:215], a[104:107], a[44:47], v[212:215]
v_mfma_f32_16x16x32_bf16 v[216:219], a[108:111], a[44:47], v[216:219]
v_mfma_f32_16x16x32_bf16 v[192:195], a[108:111], a[40:43], v[192:195]
buffer_load_dwordx4 a[24:27], v2, s[40:43], s35 offen offset:2048 sc1
v_mfma_f32_16x16x32_bf16 v[168:171], a[108:111], a[36:39], v[168:171]
ds_read_b128 a[148:151], v5 offset:48128
v_mfma_f32_16x16x32_bf16 v[144:147], a[108:111], a[32:35], v[144:147]
v_accvgpr_read_b32 v57, a197
v_mfma_f32_16x16x32_bf16 v[148:151], a[112:115], a[32:35], v[148:151]
v_mfma_f32_16x16x32_bf16 v[172:175], a[112:115], a[36:39], v[172:175]
buffer_load_dwordx4 v1, s[4:7], s44 offen offset:1024 sc1 lds
v_mfma_f32_16x16x32_bf16 v[196:199], a[112:115], a[40:43], v[196:199]
v_mfma_f32_16x16x32_bf16 v[220:223], a[112:115], a[44:47], v[220:223]
v_mfma_f32_16x16x32_bf16 v[224:227], a[116:119], a[44:47], v[224:227]
v_mfma_f32_16x16x32_bf16 v[200:203], a[116:119], a[40:43], v[200:203]
buffer_load_dwordx4 a[28:31], v2, s[40:43], s35 offen offset:3072 sc1
s_add_u32 s35, s35, 4096
v_mfma_f32_16x16x32_bf16 v[176:179], a[116:119], a[36:39], v[176:179]
s_and_b32 s35, s35, 0x1ffff
v_accvgpr_read_b32 v58, a198
v_mfma_f32_16x16x32_bf16 v[152:155], a[116:119], a[32:35], v[152:155]
s_waitcnt vmcnt(11) lgkmcnt(0)
s_barrier
v_mfma_f32_16x16x32_bf16 v[132:135], a[128:131], a[48:51], v[132:135]
v_add_u32 v5, 49152, v1
v_mfma_f32_16x16x32_bf16 v[156:159], a[128:131], a[52:55], v[156:159]
buffer_load_dwordx4 a[32:35], v2, s[40:43], s35 offen offset:0 sc1
v_mfma_f32_16x16x32_bf16 v[180:183], a[128:131], a[56:59], v[180:183]
ds_read_b128 a[96:99], v5 offset:0
v_mfma_f32_16x16x32_bf16 v[204:207], a[128:131], a[60:63], v[204:207]
ds_read_b128 a[100:103], v5 offset:1024
v_mfma_f32_16x16x32_bf16 v[208:211], a[132:135], a[60:63], v[208:211]
v_mfma_f32_16x16x32_bf16 v[184:187], a[132:135], a[56:59], v[184:187]
buffer_load_dwordx4 a[36:39], v2, s[40:43], s35 offen offset:1024 sc1
v_mfma_f32_16x16x32_bf16 v[160:163], a[132:135], a[52:55], v[160:163]
ds_read_b128 a[104:107], v5 offset:2048
v_accvgpr_read_b32 v59, a199
v_mfma_f32_16x16x32_bf16 v[136:139], a[132:135], a[48:51], v[136:139]
v_mfma_f32_16x16x32_bf16 v[140:143], a[136:139], a[48:51], v[140:143]
ds_read_b128 a[108:111], v5 offset:3072
v_mfma_f32_16x16x32_bf16 v[164:167], a[136:139], a[52:55], v[164:167]
v_mfma_f32_16x16x32_bf16 v[188:191], a[136:139], a[56:59], v[188:191]
buffer_load_dwordx4 v1, s[4:7], s44 offen offset:2048 sc1 lds
s_add_u32 s88, s82, 0x2c0000
v_mfma_f32_16x16x32_bf16 v[212:215], a[136:139], a[60:63], v[212:215]
ds_read_b128 a[112:115], v5 offset:4096
v_mfma_f32_16x16x32_bf16 v[216:219], a[140:143], a[60:63], v[216:219]
v_accvgpr_read_b32 v60, a200
v_mfma_f32_16x16x32_bf16 v[192:195], a[140:143], a[56:59], v[192:195]
ds_read_b128 a[116:119], v5 offset:5120
v_mfma_f32_16x16x32_bf16 v[168:171], a[140:143], a[52:55], v[168:171]
v_mfma_f32_16x16x32_bf16 v[144:147], a[140:143], a[48:51], v[144:147]
buffer_load_dwordx4 a[40:43], v2, s[40:43], s35 offen offset:2048 sc1
v_mfma_f32_16x16x32_bf16 v[148:151], a[144:147], a[48:51], v[148:151]
v_mfma_f32_16x16x32_bf16 v[172:175], a[144:147], a[52:55], v[172:175]
v_mfma_f32_16x16x32_bf16 v[196:199], a[144:147], a[56:59], v[196:199]
v_mfma_f32_16x16x32_bf16 v[220:223], a[144:147], a[60:63], v[220:223]
v_accvgpr_read_b32 v61, a201
v_mfma_f32_16x16x32_bf16 v[224:227], a[148:151], a[60:63], v[224:227]
buffer_load_dwordx4 a[44:47], v2, s[40:43], s35 offen offset:3072 sc1
s_add_u32 s35, s35, 4096
v_mfma_f32_16x16x32_bf16 v[200:203], a[148:151], a[56:59], v[200:203]
s_and_b32 s35, s35, 0x1ffff
v_mfma_f32_16x16x32_bf16 v[176:179], a[148:151], a[52:55], v[176:179]
v_mfma_f32_16x16x32_bf16 v[152:155], a[148:151], a[48:51], v[152:155]
s_waitcnt vmcnt(11) lgkmcnt(0)
v_mfma_f32_16x16x32_bf16 v[132:135], a[96:99], a[0:3], v[132:135]
ds_read_b128 a[128:131], v5 offset:6144
v_mfma_f32_16x16x32_bf16 v[156:159], a[96:99], a[4:7], v[156:159]
buffer_load_dwordx4 a[48:51], v2, s[40:43], s35 offen offset:0 sc1
v_mfma_f32_16x16x32_bf16 v[180:183], a[96:99], a[8:11], v[180:183]
ds_read_b128 a[132:135], v5 offset:7168
v_accvgpr_read_b32 v62, a202
v_mfma_f32_16x16x32_bf16 v[204:207], a[96:99], a[12:15], v[204:207]
v_mfma_f32_16x16x32_bf16 v[208:211], a[100:103], a[12:15], v[208:211]
v_mfma_f32_16x16x32_bf16 v[184:187], a[100:103], a[8:11], v[184:187]
buffer_load_dwordx4 v[92:95], v1, s[4:7], s88 offen offset:0 sc1
v_mfma_f32_16x16x32_bf16 v[160:163], a[100:103], a[4:7], v[160:163]
ds_read_b128 a[136:139], v5 offset:8192
v_mfma_f32_16x16x32_bf16 v[136:139], a[100:103], a[0:3], v[136:139]
v_mfma_f32_16x16x32_bf16 v[140:143], a[104:107], a[0:3], v[140:143]
ds_read_b128 a[140:143], v5 offset:9216
v_mfma_f32_16x16x32_bf16 v[164:167], a[104:107], a[4:7], v[164:167]
buffer_load_dwordx4 a[52:55], v2, s[40:43], s35 offen offset:1024 sc1
v_mfma_f32_16x16x32_bf16 v[188:191], a[104:107], a[8:11], v[188:191]
ds_read_b128 a[144:147], v5 offset:10240
v_accvgpr_read_b32 v63, a203
v_mfma_f32_16x16x32_bf16 v[212:215], a[104:107], a[12:15], v[212:215]
v_mfma_f32_16x16x32_bf16 v[216:219], a[108:111], a[12:15], v[216:219]
v_mfma_f32_16x16x32_bf16 v[192:195], a[108:111], a[8:11], v[192:195]
buffer_load_dwordx4 a[56:59], v2, s[40:43], s35 offen offset:2048 sc1
v_mfma_f32_16x16x32_bf16 v[168:171], a[108:111], a[4:7], v[168:171]
ds_read_b128 a[148:151], v5 offset:11264
v_mfma_f32_16x16x32_bf16 v[144:147], a[108:111], a[0:3], v[144:147]
v_mfma_f32_16x16x32_bf16 v[148:151], a[112:115], a[0:3], v[148:151]
v_accvgpr_read_b32 v64, a204
v_mfma_f32_16x16x32_bf16 v[172:175], a[112:115], a[4:7], v[172:175]
buffer_load_dwordx4 v[96:99], v1, s[4:7], s88 offen offset:1024 sc1
v_mfma_f32_16x16x32_bf16 v[196:199], a[112:115], a[8:11], v[196:199]
v_mfma_f32_16x16x32_bf16 v[220:223], a[112:115], a[12:15], v[220:223]
v_mfma_f32_16x16x32_bf16 v[224:227], a[116:119], a[12:15], v[224:227]
v_mfma_f32_16x16x32_bf16 v[200:203], a[116:119], a[8:11], v[200:203]
buffer_load_dwordx4 a[60:63], v2, s[40:43], s35 offen offset:3072 sc1
s_add_u32 s35, s35, 4096
v_mfma_f32_16x16x32_bf16 v[176:179], a[116:119], a[4:7], v[176:179]
s_and_b32 s35, s35, 0x1ffff
v_mfma_f32_16x16x32_bf16 v[152:155], a[116:119], a[0:3], v[152:155]
v_accvgpr_read_b32 v65, a205
s_waitcnt vmcnt(11) lgkmcnt(0)
v_mfma_f32_16x16x32_bf16 v[132:135], a[128:131], a[16:19], v[132:135]
ds_read_b128 a[96:99], v5 offset:12288
v_mfma_f32_16x16x32_bf16 v[156:159], a[128:131], a[20:23], v[156:159]
buffer_load_dwordx4 a[0:3], v2, s[40:43], s35 offen offset:0 sc1
v_mfma_f32_16x16x32_bf16 v[180:183], a[128:131], a[24:27], v[180:183]
ds_read_b128 a[100:103], v5 offset:13312
v_mfma_f32_16x16x32_bf16 v[204:207], a[128:131], a[28:31], v[204:207]
v_mfma_f32_16x16x32_bf16 v[208:211], a[132:135], a[28:31], v[208:211]
v_mfma_f32_16x16x32_bf16 v[184:187], a[132:135], a[24:27], v[184:187]
buffer_load_dwordx4 a[4:7], v2, s[40:43], s35 offen offset:1024 sc1
v_mfma_f32_16x16x32_bf16 v[160:163], a[132:135], a[20:23], v[160:163]
ds_read_b128 a[104:107], v5 offset:14336
v_accvgpr_read_b32 v66, a206
v_mfma_f32_16x16x32_bf16 v[136:139], a[132:135], a[16:19], v[136:139]
v_mfma_f32_16x16x32_bf16 v[140:143], a[136:139], a[16:19], v[140:143]
ds_read_b128 a[108:111], v5 offset:15360
v_mfma_f32_16x16x32_bf16 v[164:167], a[136:139], a[20:23], v[164:167]
v_mfma_f32_16x16x32_bf16 v[188:191], a[136:139], a[24:27], v[188:191]
buffer_load_dwordx4 v[100:103], v1, s[4:7], s88 offen offset:2048 sc1
v_mfma_f32_16x16x32_bf16 v[212:215], a[136:139], a[28:31], v[212:215]
ds_read_b128 a[112:115], v5 offset:16384
v_mfma_f32_16x16x32_bf16 v[216:219], a[140:143], a[28:31], v[216:219]
v_mfma_f32_16x16x32_bf16 v[192:195], a[140:143], a[24:27], v[192:195]
ds_read_b128 a[116:119], v5 offset:17408
v_accvgpr_read_b32 v67, a207
v_mfma_f32_16x16x32_bf16 v[168:171], a[140:143], a[20:23], v[168:171]
v_mfma_f32_16x16x32_bf16 v[144:147], a[140:143], a[16:19], v[144:147]
buffer_load_dwordx4 a[8:11], v2, s[40:43], s35 offen offset:2048 sc1
v_mfma_f32_16x16x32_bf16 v[148:151], a[144:147], a[16:19], v[148:151]
v_mfma_f32_16x16x32_bf16 v[172:175], a[144:147], a[20:23], v[172:175]
v_mfma_f32_16x16x32_bf16 v[196:199], a[144:147], a[24:27], v[196:199]
v_mfma_f32_16x16x32_bf16 v[220:223], a[144:147], a[28:31], v[220:223]
v_mfma_f32_16x16x32_bf16 v[224:227], a[148:151], a[28:31], v[224:227]
buffer_load_dwordx4 a[12:15], v2, s[40:43], s35 offen offset:3072 sc1
s_add_u32 s35, s35, 4096
v_mfma_f32_16x16x32_bf16 v[200:203], a[148:151], a[24:27], v[200:203]
s_and_b32 s35, s35, 0x1ffff
v_accvgpr_read_b32 v68, a208
v_mfma_f32_16x16x32_bf16 v[176:179], a[148:151], a[20:23], v[176:179]
v_mfma_f32_16x16x32_bf16 v[152:155], a[148:151], a[16:19], v[152:155]
s_waitcnt vmcnt(11) lgkmcnt(0)
v_mfma_f32_16x16x32_bf16 v[132:135], a[96:99], a[32:35], v[132:135]
ds_read_b128 a[128:131], v5 offset:18432
v_mfma_f32_16x16x32_bf16 v[156:159], a[96:99], a[36:39], v[156:159]
buffer_load_dwordx4 a[16:19], v2, s[40:43], s35 offen offset:0 sc1
v_mfma_f32_16x16x32_bf16 v[180:183], a[96:99], a[40:43], v[180:183]
ds_read_b128 a[132:135], v5 offset:19456
v_mfma_f32_16x16x32_bf16 v[204:207], a[96:99], a[44:47], v[204:207]
v_accvgpr_read_b32 v69, a209
v_mfma_f32_16x16x32_bf16 v[208:211], a[100:103], a[44:47], v[208:211]
v_mfma_f32_16x16x32_bf16 v[184:187], a[100:103], a[40:43], v[184:187]
buffer_load_dwordx4 v[104:107], v1, s[4:7], s88 offen offset:3072 sc1
s_add_u32 s88, s88, 4096
v_mfma_f32_16x16x32_bf16 v[160:163], a[100:103], a[36:39], v[160:163]
ds_read_b128 a[136:139], v5 offset:20480
v_mfma_f32_16x16x32_bf16 v[136:139], a[100:103], a[32:35], v[136:139]
v_mfma_f32_16x16x32_bf16 v[140:143], a[104:107], a[32:35], v[140:143]
ds_read_b128 a[140:143], v5 offset:21504
v_mfma_f32_16x16x32_bf16 v[164:167], a[104:107], a[36:39], v[164:167]
buffer_load_dwordx4 a[20:23], v2, s[40:43], s35 offen offset:1024 sc1
v_mfma_f32_16x16x32_bf16 v[188:191], a[104:107], a[40:43], v[188:191]
ds_read_b128 a[144:147], v5 offset:22528
v_accvgpr_read_b32 v70, a210
v_mfma_f32_16x16x32_bf16 v[212:215], a[104:107], a[44:47], v[212:215]
v_mfma_f32_16x16x32_bf16 v[216:219], a[108:111], a[44:47], v[216:219]
v_mfma_f32_16x16x32_bf16 v[192:195], a[108:111], a[40:43], v[192:195]
buffer_load_dwordx4 a[24:27], v2, s[40:43], s35 offen offset:2048 sc1
v_mfma_f32_16x16x32_bf16 v[168:171], a[108:111], a[36:39], v[168:171]
ds_read_b128 a[148:151], v5 offset:23552
v_mfma_f32_16x16x32_bf16 v[144:147], a[108:111], a[32:35], v[144:147]
v_mfma_f32_16x16x32_bf16 v[148:151], a[112:115], a[32:35], v[148:151]
v_mfma_f32_16x16x32_bf16 v[172:175], a[112:115], a[36:39], v[172:175]
buffer_load_dwordx4 v[108:111], v1, s[4:7], s88 offen offset:0 sc1
v_mfma_f32_16x16x32_bf16 v[196:199], a[112:115], a[40:43], v[196:199]
v_accvgpr_read_b32 v71, a211
v_mfma_f32_16x16x32_bf16 v[220:223], a[112:115], a[44:47], v[220:223]
v_mfma_f32_16x16x32_bf16 v[224:227], a[116:119], a[44:47], v[224:227]
v_mfma_f32_16x16x32_bf16 v[200:203], a[116:119], a[40:43], v[200:203]
buffer_load_dwordx4 a[28:31], v2, s[40:43], s35 offen offset:3072 sc1
s_add_u32 s35, s35, 4096
v_mfma_f32_16x16x32_bf16 v[176:179], a[116:119], a[36:39], v[176:179]
s_and_b32 s35, s35, 0x1ffff
v_mfma_f32_16x16x32_bf16 v[152:155], a[116:119], a[32:35], v[152:155]
s_waitcnt vmcnt(11) lgkmcnt(0)
v_mfma_f32_16x16x32_bf16 v[132:135], a[128:131], a[48:51], v[132:135]
ds_read_b128 a[96:99], v5 offset:24576
v_mfma_f32_16x16x32_bf16 v[156:159], a[128:131], a[52:55], v[156:159]
buffer_load_dwordx4 a[32:35], v2, s[40:43], s35 offen offset:0 sc1
v_mfma_f32_16x16x32_bf16 v[180:183], a[128:131], a[56:59], v[180:183]
ds_read_b128 a[100:103], v5 offset:25600
v_mfma_f32_16x16x32_bf16 v[204:207], a[128:131], a[60:63], v[204:207]
v_mfma_f32_16x16x32_bf16 v[208:211], a[132:135], a[60:63], v[208:211]
v_mfma_f32_16x16x32_bf16 v[184:187], a[132:135], a[56:59], v[184:187]
buffer_load_dwordx4 a[36:39], v2, s[40:43], s35 offen offset:1024 sc1
v_mfma_f32_16x16x32_bf16 v[160:163], a[132:135], a[52:55], v[160:163]
ds_read_b128 a[104:107], v5 offset:26624
v_mfma_f32_16x16x32_bf16 v[136:139], a[132:135], a[48:51], v[136:139]
v_mfma_f32_16x16x32_bf16 v[140:143], a[136:139], a[48:51], v[140:143]
ds_read_b128 a[108:111], v5 offset:27648
v_mfma_f32_16x16x32_bf16 v[164:167], a[136:139], a[52:55], v[164:167]
v_mfma_f32_16x16x32_bf16 v[188:191], a[136:139], a[56:59], v[188:191]
buffer_load_dwordx4 v[112:115], v1, s[4:7], s88 offen offset:1024 sc1
v_mfma_f32_16x16x32_bf16 v[212:215], a[136:139], a[60:63], v[212:215]
ds_read_b128 a[112:115], v5 offset:28672
v_mfma_f32_16x16x32_bf16 v[216:219], a[140:143], a[60:63], v[216:219]
v_mfma_f32_16x16x32_bf16 v[192:195], a[140:143], a[56:59], v[192:195]
ds_read_b128 a[116:119], v5 offset:29696
v_mfma_f32_16x16x32_bf16 v[168:171], a[140:143], a[52:55], v[168:171]
v_mfma_f32_16x16x32_bf16 v[144:147], a[140:143], a[48:51], v[144:147]
buffer_load_dwordx4 a[40:43], v2, s[40:43], s35 offen offset:2048 sc1
v_mfma_f32_16x16x32_bf16 v[148:151], a[144:147], a[48:51], v[148:151]
v_mfma_f32_16x16x32_bf16 v[172:175], a[144:147], a[52:55], v[172:175]
v_mfma_f32_16x16x32_bf16 v[196:199], a[144:147], a[56:59], v[196:199]
v_mfma_f32_16x16x32_bf16 v[220:223], a[144:147], a[60:63], v[220:223]
v_mfma_f32_16x16x32_bf16 v[224:227], a[148:151], a[60:63], v[224:227]
buffer_load_dwordx4 a[44:47], v2, s[40:43], s35 offen offset:3072 sc1
s_add_u32 s35, s35, 4096
v_mfma_f32_16x16x32_bf16 v[200:203], a[148:151], a[56:59], v[200:203]
s_and_b32 s35, s35, 0x1ffff
v_mfma_f32_16x16x32_bf16 v[176:179], a[148:151], a[52:55], v[176:179]
v_mfma_f32_16x16x32_bf16 v[152:155], a[148:151], a[48:51], v[152:155]
s_waitcnt vmcnt(11) lgkmcnt(0)
v_mfma_f32_16x16x32_bf16 v[132:135], a[96:99], a[0:3], v[132:135]
ds_read_b128 a[128:131], v5 offset:30720
v_mfma_f32_16x16x32_bf16 v[156:159], a[96:99], a[4:7], v[156:159]
buffer_load_dwordx4 a[48:51], v2, s[40:43], s35 offen offset:0 sc1
v_mfma_f32_16x16x32_bf16 v[180:183], a[96:99], a[8:11], v[180:183]
ds_read_b128 a[132:135], v5 offset:31744
v_mfma_f32_16x16x32_bf16 v[204:207], a[96:99], a[12:15], v[204:207]
v_mfma_f32_16x16x32_bf16 v[208:211], a[100:103], a[12:15], v[208:211]
v_mfma_f32_16x16x32_bf16 v[184:187], a[100:103], a[8:11], v[184:187]
buffer_load_dwordx4 v[116:119], v1, s[4:7], s88 offen offset:2048 sc1
v_mfma_f32_16x16x32_bf16 v[160:163], a[100:103], a[4:7], v[160:163]
ds_read_b128 a[136:139], v5 offset:32768
v_mfma_f32_16x16x32_bf16 v[136:139], a[100:103], a[0:3], v[136:139]
v_mfma_f32_16x16x32_bf16 v[140:143], a[104:107], a[0:3], v[140:143]
ds_read_b128 a[140:143], v5 offset:33792
v_mfma_f32_16x16x32_bf16 v[164:167], a[104:107], a[4:7], v[164:167]
buffer_load_dwordx4 a[52:55], v2, s[40:43], s35 offen offset:1024 sc1
v_mfma_f32_16x16x32_bf16 v[188:191], a[104:107], a[8:11], v[188:191]
ds_read_b128 a[144:147], v5 offset:34816
v_mfma_f32_16x16x32_bf16 v[212:215], a[104:107], a[12:15], v[212:215]
v_mfma_f32_16x16x32_bf16 v[216:219], a[108:111], a[12:15], v[216:219]
v_mfma_f32_16x16x32_bf16 v[192:195], a[108:111], a[8:11], v[192:195]
buffer_load_dwordx4 a[56:59], v2, s[40:43], s35 offen offset:2048 sc1
v_mfma_f32_16x16x32_bf16 v[168:171], a[108:111], a[4:7], v[168:171]
ds_read_b128 a[148:151], v5 offset:35840
v_mfma_f32_16x16x32_bf16 v[144:147], a[108:111], a[0:3], v[144:147]
v_mfma_f32_16x16x32_bf16 v[148:151], a[112:115], a[0:3], v[148:151]
v_mfma_f32_16x16x32_bf16 v[172:175], a[112:115], a[4:7], v[172:175]
buffer_load_dwordx4 v[120:123], v1, s[4:7], s88 offen offset:3072 sc1
s_add_u32 s44, s28, 0
v_mfma_f32_16x16x32_bf16 v[196:199], a[112:115], a[8:11], v[196:199]
s_mul_i32 s45, s44, 3072
s_add_u32 m0, s45, 0
s_lshr_b32 s44, s44, 1
v_mfma_f32_16x16x32_bf16 v[220:223], a[112:115], a[12:15], v[220:223]
s_add_u32 s44, s44, 24
s_add_u32 s44, s44, s33
s_and_b32 s44, s44, 31
v_mfma_f32_16x16x32_bf16 v[224:227], a[116:119], a[12:15], v[224:227]
s_mul_i32 s44, s44, 6144
s_add_u32 s44, s44, s50
s_add_u32 s44, s44, 0x600000
v_mfma_f32_16x16x32_bf16 v[200:203], a[116:119], a[8:11], v[200:203]
buffer_load_dwordx4 a[60:63], v2, s[40:43], s35 offen offset:3072 sc1
s_add_u32 s35, s35, 4096
v_mfma_f32_16x16x32_bf16 v[176:179], a[116:119], a[4:7], v[176:179]
s_and_b32 s35, s35, 0x1ffff
v_mfma_f32_16x16x32_bf16 v[152:155], a[116:119], a[0:3], v[152:155]
s_waitcnt vmcnt(11) lgkmcnt(0)
v_mfma_f32_16x16x32_bf16 v[132:135], a[128:131], a[16:19], v[132:135]
ds_read_b128 a[96:99], v5 offset:36864
v_mfma_f32_16x16x32_bf16 v[156:159], a[128:131], a[20:23], v[156:159]
buffer_load_dwordx4 a[0:3], v2, s[40:43], s35 offen offset:0 sc1
v_mfma_f32_16x16x32_bf16 v[180:183], a[128:131], a[24:27], v[180:183]
ds_read_b128 a[100:103], v5 offset:37888
v_mfma_f32_16x16x32_bf16 v[204:207], a[128:131], a[28:31], v[204:207]
v_mfma_f32_16x16x32_bf16 v[208:211], a[132:135], a[28:31], v[208:211]
v_mfma_f32_16x16x32_bf16 v[184:187], a[132:135], a[24:27], v[184:187]
buffer_load_dwordx4 a[4:7], v2, s[40:43], s35 offen offset:1024 sc1
v_mfma_f32_16x16x32_bf16 v[160:163], a[132:135], a[20:23], v[160:163]
ds_read_b128 a[104:107], v5 offset:38912
v_mfma_f32_16x16x32_bf16 v[136:139], a[132:135], a[16:19], v[136:139]
v_mfma_f32_16x16x32_bf16 v[140:143], a[136:139], a[16:19], v[140:143]
ds_read_b128 a[108:111], v5 offset:39936
v_mfma_f32_16x16x32_bf16 v[164:167], a[136:139], a[20:23], v[164:167]
v_mfma_f32_16x16x32_bf16 v[188:191], a[136:139], a[24:27], v[188:191]
buffer_load_dwordx4 v1, s[4:7], s44 offen offset:0 sc1 lds
v_mfma_f32_16x16x32_bf16 v[212:215], a[136:139], a[28:31], v[212:215]
ds_read_b128 a[112:115], v5 offset:40960
v_mfma_f32_16x16x32_bf16 v[216:219], a[140:143], a[28:31], v[216:219]
v_mfma_f32_16x16x32_bf16 v[192:195], a[140:143], a[24:27], v[192:195]
ds_read_b128 a[116:119], v5 offset:41984
v_mfma_f32_16x16x32_bf16 v[168:171], a[140:143], a[20:23], v[168:171]
v_mfma_f32_16x16x32_bf16 v[144:147], a[140:143], a[16:19], v[144:147]
buffer_load_dwordx4 a[8:11], v2, s[40:43], s35 offen offset:2048 sc1
v_mfma_f32_16x16x32_bf16 v[148:151], a[144:147], a[16:19], v[148:151]
v_mfma_f32_16x16x32_bf16 v[172:175], a[144:147], a[20:23], v[172:175]
v_mfma_f32_16x16x32_bf16 v[196:199], a[144:147], a[24:27], v[196:199]
v_mfma_f32_16x16x32_bf16 v[220:223], a[144:147], a[28:31], v[220:223]
v_mfma_f32_16x16x32_bf16 v[224:227], a[148:151], a[28:31], v[224:227]
buffer_load_dwordx4 a[12:15], v2, s[40:43], s35 offen offset:3072 sc1
s_add_u32 s35, s35, 4096
v_mfma_f32_16x16x32_bf16 v[200:203], a[148:151], a[24:27], v[200:203]
s_and_b32 s35, s35, 0x1ffff
v_mfma_f32_16x16x32_bf16 v[176:179], a[148:151], a[20:23], v[176:179]
v_mfma_f32_16x16x32_bf16 v[152:155], a[148:151], a[16:19], v[152:155]
s_waitcnt vmcnt(11) lgkmcnt(0)
v_mfma_f32_16x16x32_bf16 v[132:135], a[96:99], a[32:35], v[132:135]
ds_read_b128 a[128:131], v5 offset:43008
v_mfma_f32_16x16x32_bf16 v[156:159], a[96:99], a[36:39], v[156:159]
buffer_load_dwordx4 a[16:19], v2, s[40:43], s35 offen offset:0 sc1
v_mfma_f32_16x16x32_bf16 v[180:183], a[96:99], a[40:43], v[180:183]
ds_read_b128 a[132:135], v5 offset:44032
v_mfma_f32_16x16x32_bf16 v[204:207], a[96:99], a[44:47], v[204:207]
v_mfma_f32_16x16x32_bf16 v[208:211], a[100:103], a[44:47], v[208:211]
v_mfma_f32_16x16x32_bf16 v[184:187], a[100:103], a[40:43], v[184:187]
buffer_load_dwordx4 v1, s[4:7], s44 offen offset:1024 sc1 lds
v_mfma_f32_16x16x32_bf16 v[160:163], a[100:103], a[36:39], v[160:163]
ds_read_b128 a[136:139], v5 offset:45056
v_mfma_f32_16x16x32_bf16 v[136:139], a[100:103], a[32:35], v[136:139]
v_mfma_f32_16x16x32_bf16 v[140:143], a[104:107], a[32:35], v[140:143]
ds_read_b128 a[140:143], v5 offset:46080
v_mfma_f32_16x16x32_bf16 v[164:167], a[104:107], a[36:39], v[164:167]
buffer_load_dwordx4 a[20:23], v2, s[40:43], s35 offen offset:1024 sc1
v_mfma_f32_16x16x32_bf16 v[188:191], a[104:107], a[40:43], v[188:191]
ds_read_b128 a[144:147], v5 offset:47104
v_mfma_f32_16x16x32_bf16 v[212:215], a[104:107], a[44:47], v[212:215]
v_mfma_f32_16x16x32_bf16 v[216:219], a[108:111], a[44:47], v[216:219]
v_mfma_f32_16x16x32_bf16 v[192:195], a[108:111], a[40:43], v[192:195]
buffer_load_dwordx4 a[24:27], v2, s[40:43], s35 offen offset:2048 sc1
v_mfma_f32_16x16x32_bf16 v[168:171], a[108:111], a[36:39], v[168:171]
ds_read_b128 a[148:151], v5 offset:48128
v_mfma_f32_16x16x32_bf16 v[144:147], a[108:111], a[32:35], v[144:147]
v_mfma_f32_16x16x32_bf16 v[148:151], a[112:115], a[32:35], v[148:151]
v_mfma_f32_16x16x32_bf16 v[172:175], a[112:115], a[36:39], v[172:175]
buffer_load_dwordx4 v1, s[4:7], s44 offen offset:2048 sc1 lds
s_add_u32 s44, s28, 4
v_mfma_f32_16x16x32_bf16 v[196:199], a[112:115], a[40:43], v[196:199]
s_mul_i32 s45, s44, 3072
s_add_u32 m0, s45, 0
s_lshr_b32 s44, s44, 1
v_mfma_f32_16x16x32_bf16 v[220:223], a[112:115], a[44:47], v[220:223]
s_add_u32 s44, s44, 24
s_add_u32 s44, s44, s33
s_and_b32 s44, s44, 31
v_mfma_f32_16x16x32_bf16 v[224:227], a[116:119], a[44:47], v[224:227]
s_mul_i32 s44, s44, 6144
s_add_u32 s44, s44, s50
s_add_u32 s44, s44, 0x600000
v_mfma_f32_16x16x32_bf16 v[200:203], a[116:119], a[40:43], v[200:203]
buffer_load_dwordx4 a[28:31], v2, s[40:43], s35 offen offset:3072 sc1
s_add_u32 s35, s35, 4096
v_mfma_f32_16x16x32_bf16 v[176:179], a[116:119], a[36:39], v[176:179]
s_and_b32 s35, s35, 0x1ffff
v_mfma_f32_16x16x32_bf16 v[152:155], a[116:119], a[32:35], v[152:155]
s_waitcnt vmcnt(11) lgkmcnt(0)
s_barrier
v_mfma_f32_16x16x32_bf16 v[132:135], a[128:131], a[48:51], v[132:135]
v_add_u32 v5, 98304, v1
v_mfma_f32_16x16x32_bf16 v[156:159], a[128:131], a[52:55], v[156:159]
buffer_load_dwordx4 a[32:35], v2, s[40:43], s35 offen offset:0 sc1
v_mfma_f32_16x16x32_bf16 v[180:183], a[128:131], a[56:59], v[180:183]
ds_read_b128 a[96:99], v5 offset:0
v_mfma_f32_16x16x32_bf16 v[204:207], a[128:131], a[60:63], v[204:207]
ds_read_b128 a[100:103], v5 offset:1024
v_mfma_f32_16x16x32_bf16 v[208:211], a[132:135], a[60:63], v[208:211]
v_mfma_f32_16x16x32_bf16 v[184:187], a[132:135], a[56:59], v[184:187]
buffer_load_dwordx4 a[36:39], v2, s[40:43], s35 offen offset:1024 sc1
v_mfma_f32_16x16x32_bf16 v[160:163], a[132:135], a[52:55], v[160:163]
ds_read_b128 a[104:107], v5 offset:2048
v_mfma_f32_16x16x32_bf16 v[136:139], a[132:135], a[48:51], v[136:139]
v_mfma_f32_16x16x32_bf16 v[140:143], a[136:139], a[48:51], v[140:143]
ds_read_b128 a[108:111], v5 offset:3072
v_mfma_f32_16x16x32_bf16 v[164:167], a[136:139], a[52:55], v[164:167]
v_mfma_f32_16x16x32_bf16 v[188:191], a[136:139], a[56:59], v[188:191]
buffer_load_dwordx4 v1, s[4:7], s44 offen offset:0 sc1 lds
v_mfma_f32_16x16x32_bf16 v[212:215], a[136:139], a[60:63], v[212:215]
ds_read_b128 a[112:115], v5 offset:4096
v_mfma_f32_16x16x32_bf16 v[216:219], a[140:143], a[60:63], v[216:219]
v_mfma_f32_16x16x32_bf16 v[192:195], a[140:143], a[56:59], v[192:195]
ds_read_b128 a[116:119], v5 offset:5120
v_mfma_f32_16x16x32_bf16 v[168:171], a[140:143], a[52:55], v[168:171]
v_mfma_f32_16x16x32_bf16 v[144:147], a[140:143], a[48:51], v[144:147]
buffer_load_dwordx4 a[40:43], v2, s[40:43], s35 offen offset:2048 sc1
v_mfma_f32_16x16x32_bf16 v[148:151], a[144:147], a[48:51], v[148:151]
v_mfma_f32_16x16x32_bf16 v[172:175], a[144:147], a[52:55], v[172:175]
v_mfma_f32_16x16x32_bf16 v[196:199], a[144:147], a[56:59], v[196:199]
v_mfma_f32_16x16x32_bf16 v[220:223], a[144:147], a[60:63], v[220:223]
v_mfma_f32_16x16x32_bf16 v[224:227], a[148:151], a[60:63], v[224:227]
buffer_load_dwordx4 a[44:47], v2, s[40:43], s35 offen offset:3072 sc1
s_add_u32 s35, s35, 4096
v_mfma_f32_16x16x32_bf16 v[200:203], a[148:151], a[56:59], v[200:203]
s_and_b32 s35, s35, 0x1ffff
v_mfma_f32_16x16x32_bf16 v[176:179], a[148:151], a[52:55], v[176:179]
v_mfma_f32_16x16x32_bf16 v[152:155], a[148:151], a[48:51], v[152:155]
s_waitcnt vmcnt(11) lgkmcnt(0)
v_mfma_f32_16x16x32_bf16 v[132:135], a[96:99], a[0:3], v[132:135]
ds_read_b128 a[128:131], v5 offset:6144
v_mfma_f32_16x16x32_bf16 v[156:159], a[96:99], a[4:7], v[156:159]
buffer_load_dwordx4 a[48:51], v2, s[40:43], s35 offen offset:0 sc1
v_mfma_f32_16x16x32_bf16 v[180:183], a[96:99], a[8:11], v[180:183]
ds_read_b128 a[132:135], v5 offset:7168
v_mfma_f32_16x16x32_bf16 v[204:207], a[96:99], a[12:15], v[204:207]
v_mfma_f32_16x16x32_bf16 v[208:211], a[100:103], a[12:15], v[208:211]
v_mfma_f32_16x16x32_bf16 v[184:187], a[100:103], a[8:11], v[184:187]
buffer_load_dwordx4 v1, s[4:7], s44 offen offset:1024 sc1 lds
v_mfma_f32_16x16x32_bf16 v[160:163], a[100:103], a[4:7], v[160:163]
ds_read_b128 a[136:139], v5 offset:8192
v_mfma_f32_16x16x32_bf16 v[136:139], a[100:103], a[0:3], v[136:139]
v_mfma_f32_16x16x32_bf16 v[140:143], a[104:107], a[0:3], v[140:143]
ds_read_b128 a[140:143], v5 offset:9216
v_mfma_f32_16x16x32_bf16 v[164:167], a[104:107], a[4:7], v[164:167]
buffer_load_dwordx4 a[52:55], v2, s[40:43], s35 offen offset:1024 sc1
v_mfma_f32_16x16x32_bf16 v[188:191], a[104:107], a[8:11], v[188:191]
ds_read_b128 a[144:147], v5 offset:10240
v_mfma_f32_16x16x32_bf16 v[212:215], a[104:107], a[12:15], v[212:215]
v_mfma_f32_16x16x32_bf16 v[216:219], a[108:111], a[12:15], v[216:219]
v_mfma_f32_16x16x32_bf16 v[192:195], a[108:111], a[8:11], v[192:195]
buffer_load_dwordx4 a[56:59], v2, s[40:43], s35 offen offset:2048 sc1
v_mfma_f32_16x16x32_bf16 v[168:171], a[108:111], a[4:7], v[168:171]
ds_read_b128 a[148:151], v5 offset:11264
v_mfma_f32_16x16x32_bf16 v[144:147], a[108:111], a[0:3], v[144:147]
v_mfma_f32_16x16x32_bf16 v[148:151], a[112:115], a[0:3], v[148:151]
v_mfma_f32_16x16x32_bf16 v[172:175], a[112:115], a[4:7], v[172:175]
buffer_load_dwordx4 v1, s[4:7], s44 offen offset:2048 sc1 lds
s_add_u32 s44, s28, 8
v_mfma_f32_16x16x32_bf16 v[196:199], a[112:115], a[8:11], v[196:199]
s_mul_i32 s45, s44, 3072
s_add_u32 m0, s45, 0
s_lshr_b32 s44, s44, 1
v_mfma_f32_16x16x32_bf16 v[220:223], a[112:115], a[12:15], v[220:223]
s_add_u32 s44, s44, 24
s_add_u32 s44, s44, s33
s_and_b32 s44, s44, 31
v_mfma_f32_16x16x32_bf16 v[224:227], a[116:119], a[12:15], v[224:227]
s_mul_i32 s44, s44, 6144
s_add_u32 s44, s44, s50
s_add_u32 s44, s44, 0x600000
v_mfma_f32_16x16x32_bf16 v[200:203], a[116:119], a[8:11], v[200:203]
buffer_load_dwordx4 a[60:63], v2, s[40:43], s35 offen offset:3072 sc1
s_add_u32 s35, s35, 4096
v_mfma_f32_16x16x32_bf16 v[176:179], a[116:119], a[4:7], v[176:179]
s_and_b32 s35, s35, 0x1ffff
v_mfma_f32_16x16x32_bf16 v[152:155], a[116:119], a[0:3], v[152:155]
s_waitcnt vmcnt(11) lgkmcnt(0)
v_mfma_f32_16x16x32_bf16 v[132:135], a[128:131], a[16:19], v[132:135]
ds_read_b128 a[96:99], v5 offset:12288
v_mfma_f32_16x16x32_bf16 v[156:159], a[128:131], a[20:23], v[156:159]
buffer_load_dwordx4 a[0:3], v2, s[40:43], s35 offen offset:0 sc1
v_mfma_f32_16x16x32_bf16 v[180:183], a[128:131], a[24:27], v[180:183]
ds_read_b128 a[100:103], v5 offset:13312
v_mfma_f32_16x16x32_bf16 v[204:207], a[128:131], a[28:31], v[204:207]
v_mfma_f32_16x16x32_bf16 v[208:211], a[132:135], a[28:31], v[208:211]
v_mfma_f32_16x16x32_bf16 v[184:187], a[132:135], a[24:27], v[184:187]
buffer_load_dwordx4 a[4:7], v2, s[40:43], s35 offen offset:1024 sc1
v_mfma_f32_16x16x32_bf16 v[160:163], a[132:135], a[20:23], v[160:163]
ds_read_b128 a[104:107], v5 offset:14336
v_mfma_f32_16x16x32_bf16 v[136:139], a[132:135], a[16:19], v[136:139]
v_mfma_f32_16x16x32_bf16 v[140:143], a[136:139], a[16:19], v[140:143]
ds_read_b128 a[108:111], v5 offset:15360
v_mfma_f32_16x16x32_bf16 v[164:167], a[136:139], a[20:23], v[164:167]
v_mfma_f32_16x16x32_bf16 v[188:191], a[136:139], a[24:27], v[188:191]
buffer_load_dwordx4 v1, s[4:7], s44 offen offset:0 sc1 lds
v_mfma_f32_16x16x32_bf16 v[212:215], a[136:139], a[28:31], v[212:215]
ds_read_b128 a[112:115], v5 offset:16384
v_mfma_f32_16x16x32_bf16 v[216:219], a[140:143], a[28:31], v[216:219]
v_mfma_f32_16x16x32_bf16 v[192:195], a[140:143], a[24:27], v[192:195]
ds_read_b128 a[116:119], v5 offset:17408
v_mfma_f32_16x16x32_bf16 v[168:171], a[140:143], a[20:23], v[168:171]
v_mfma_f32_16x16x32_bf16 v[144:147], a[140:143], a[16:19], v[144:147]
buffer_load_dwordx4 a[8:11], v2, s[40:43], s35 offen offset:2048 sc1
v_mfma_f32_16x16x32_bf16 v[148:151], a[144:147], a[16:19], v[148:151]
v_mfma_f32_16x16x32_bf16 v[172:175], a[144:147], a[20:23], v[172:175]
v_mfma_f32_16x16x32_bf16 v[196:199], a[144:147], a[24:27], v[196:199]
v_mfma_f32_16x16x32_bf16 v[220:223], a[144:147], a[28:31], v[220:223]
v_mfma_f32_16x16x32_bf16 v[224:227], a[148:151], a[28:31], v[224:227]
buffer_load_dwordx4 a[12:15], v2, s[40:43], s35 offen offset:3072 sc1
s_add_u32 s35, s35, 4096
v_mfma_f32_16x16x32_bf16 v[200:203], a[148:151], a[24:27], v[200:203]
s_and_b32 s35, s35, 0x1ffff
v_mfma_f32_16x16x32_bf16 v[176:179], a[148:151], a[20:23], v[176:179]
v_mfma_f32_16x16x32_bf16 v[152:155], a[148:151], a[16:19], v[152:155]
s_waitcnt vmcnt(11) lgkmcnt(0)
v_mfma_f32_16x16x32_bf16 v[132:135], a[96:99], a[32:35], v[132:135]
ds_read_b128 a[128:131], v5 offset:18432
v_mfma_f32_16x16x32_bf16 v[156:159], a[96:99], a[36:39], v[156:159]
buffer_load_dwordx4 a[16:19], v2, s[40:43], s35 offen offset:0 sc1
v_mfma_f32_16x16x32_bf16 v[180:183], a[96:99], a[40:43], v[180:183]
ds_read_b128 a[132:135], v5 offset:19456
v_mfma_f32_16x16x32_bf16 v[204:207], a[96:99], a[44:47], v[204:207]
v_mfma_f32_16x16x32_bf16 v[208:211], a[100:103], a[44:47], v[208:211]
v_mfma_f32_16x16x32_bf16 v[184:187], a[100:103], a[40:43], v[184:187]
buffer_load_dwordx4 v1, s[4:7], s44 offen offset:1024 sc1 lds
v_mfma_f32_16x16x32_bf16 v[160:163], a[100:103], a[36:39], v[160:163]
ds_read_b128 a[136:139], v5 offset:20480
v_mfma_f32_16x16x32_bf16 v[136:139], a[100:103], a[32:35], v[136:139]
v_mfma_f32_16x16x32_bf16 v[140:143], a[104:107], a[32:35], v[140:143]
ds_read_b128 a[140:143], v5 offset:21504
v_mfma_f32_16x16x32_bf16 v[164:167], a[104:107], a[36:39], v[164:167]
buffer_load_dwordx4 a[20:23], v2, s[40:43], s35 offen offset:1024 sc1
v_mfma_f32_16x16x32_bf16 v[188:191], a[104:107], a[40:43], v[188:191]
ds_read_b128 a[144:147], v5 offset:22528
v_mfma_f32_16x16x32_bf16 v[212:215], a[104:107], a[44:47], v[212:215]
v_mfma_f32_16x16x32_bf16 v[216:219], a[108:111], a[44:47], v[216:219]
v_mfma_f32_16x16x32_bf16 v[192:195], a[108:111], a[40:43], v[192:195]
buffer_load_dwordx4 a[24:27], v2, s[40:43], s35 offen offset:2048 sc1
v_mfma_f32_16x16x32_bf16 v[168:171], a[108:111], a[36:39], v[168:171]
ds_read_b128 a[148:151], v5 offset:23552
v_mfma_f32_16x16x32_bf16 v[144:147], a[108:111], a[32:35], v[144:147]
v_mfma_f32_16x16x32_bf16 v[148:151], a[112:115], a[32:35], v[148:151]
v_mfma_f32_16x16x32_bf16 v[172:175], a[112:115], a[36:39], v[172:175]
buffer_load_dwordx4 v1, s[4:7], s44 offen offset:2048 sc1 lds
s_add_u32 s44, s28, 12
v_mfma_f32_16x16x32_bf16 v[196:199], a[112:115], a[40:43], v[196:199]
s_mul_i32 s45, s44, 3072
s_add_u32 m0, s45, 0
s_lshr_b32 s44, s44, 1
v_mfma_f32_16x16x32_bf16 v[220:223], a[112:115], a[44:47], v[220:223]
s_add_u32 s44, s44, 24
s_add_u32 s44, s44, s33
s_and_b32 s44, s44, 31
v_mfma_f32_16x16x32_bf16 v[224:227], a[116:119], a[44:47], v[224:227]
s_mul_i32 s44, s44, 6144
s_add_u32 s44, s44, s50
s_add_u32 s44, s44, 0x600000
v_mfma_f32_16x16x32_bf16 v[200:203], a[116:119], a[40:43], v[200:203]
buffer_load_dwordx4 a[28:31], v2, s[40:43], s35 offen offset:3072 sc1
s_add_u32 s35, s35, 4096
v_mfma_f32_16x16x32_bf16 v[176:179], a[116:119], a[36:39], v[176:179]
s_and_b32 s35, s35, 0x1ffff
v_mfma_f32_16x16x32_bf16 v[152:155], a[116:119], a[32:35], v[152:155]
s_waitcnt vmcnt(11) lgkmcnt(0)
v_mfma_f32_16x16x32_bf16 v[132:135], a[128:131], a[48:51], v[132:135]
ds_read_b128 a[96:99], v5 offset:24576
v_mfma_f32_16x16x32_bf16 v[156:159], a[128:131], a[52:55], v[156:159]
buffer_load_dwordx4 a[32:35], v2, s[40:43], s35 offen offset:0 sc1
v_mfma_f32_16x16x32_bf16 v[180:183], a[128:131], a[56:59], v[180:183]
ds_read_b128 a[100:103], v5 offset:25600
v_mfma_f32_16x16x32_bf16 v[204:207], a[128:131], a[60:63], v[204:207]
v_mfma_f32_16x16x32_bf16 v[208:211], a[132:135], a[60:63], v[208:211]
v_mfma_f32_16x16x32_bf16 v[184:187], a[132:135], a[56:59], v[184:187]
buffer_load_dwordx4 a[36:39], v2, s[40:43], s35 offen offset:1024 sc1
v_mfma_f32_16x16x32_bf16 v[160:163], a[132:135], a[52:55], v[160:163]
ds_read_b128 a[104:107], v5 offset:26624
v_mfma_f32_16x16x32_bf16 v[136:139], a[132:135], a[48:51], v[136:139]
v_mfma_f32_16x16x32_bf16 v[140:143], a[136:139], a[48:51], v[140:143]
ds_read_b128 a[108:111], v5 offset:27648
v_mfma_f32_16x16x32_bf16 v[164:167], a[136:139], a[52:55], v[164:167]
v_mfma_f32_16x16x32_bf16 v[188:191], a[136:139], a[56:59], v[188:191]
buffer_load_dwordx4 v1, s[4:7], s44 offen offset:0 sc1 lds
v_mfma_f32_16x16x32_bf16 v[212:215], a[136:139], a[60:63], v[212:215]
ds_read_b128 a[112:115], v5 offset:28672
v_mfma_f32_16x16x32_bf16 v[216:219], a[140:143], a[60:63], v[216:219]
v_mfma_f32_16x16x32_bf16 v[192:195], a[140:143], a[56:59], v[192:195]
ds_read_b128 a[116:119], v5 offset:29696
v_mfma_f32_16x16x32_bf16 v[168:171], a[140:143], a[52:55], v[168:171]
v_mfma_f32_16x16x32_bf16 v[144:147], a[140:143], a[48:51], v[144:147]
buffer_load_dwordx4 a[40:43], v2, s[40:43], s35 offen offset:2048 sc1
v_mfma_f32_16x16x32_bf16 v[148:151], a[144:147], a[48:51], v[148:151]
v_mfma_f32_16x16x32_bf16 v[172:175], a[144:147], a[52:55], v[172:175]
v_mfma_f32_16x16x32_bf16 v[196:199], a[144:147], a[56:59], v[196:199]
v_mfma_f32_16x16x32_bf16 v[220:223], a[144:147], a[60:63], v[220:223]
v_mfma_f32_16x16x32_bf16 v[224:227], a[148:151], a[60:63], v[224:227]
buffer_load_dwordx4 a[44:47], v2, s[40:43], s35 offen offset:3072 sc1
s_add_u32 s35, s35, 4096
v_mfma_f32_16x16x32_bf16 v[200:203], a[148:151], a[56:59], v[200:203]
s_and_b32 s35, s35, 0x1ffff
v_mfma_f32_16x16x32_bf16 v[176:179], a[148:151], a[52:55], v[176:179]
v_mfma_f32_16x16x32_bf16 v[152:155], a[148:151], a[48:51], v[152:155]
s_waitcnt vmcnt(11) lgkmcnt(0)
v_mfma_f32_16x16x32_bf16 v[132:135], a[96:99], a[0:3], v[132:135]
ds_read_b128 a[128:131], v5 offset:30720
v_mfma_f32_16x16x32_bf16 v[156:159], a[96:99], a[4:7], v[156:159]
buffer_load_dwordx4 a[48:51], v2, s[40:43], s35 offen offset:0 sc1
v_mfma_f32_16x16x32_bf16 v[180:183], a[96:99], a[8:11], v[180:183]
ds_read_b128 a[132:135], v5 offset:31744
v_mfma_f32_16x16x32_bf16 v[204:207], a[96:99], a[12:15], v[204:207]
v_mfma_f32_16x16x32_bf16 v[208:211], a[100:103], a[12:15], v[208:211]
v_mfma_f32_16x16x32_bf16 v[184:187], a[100:103], a[8:11], v[184:187]
buffer_load_dwordx4 v1, s[4:7], s44 offen offset:1024 sc1 lds
v_mfma_f32_16x16x32_bf16 v[160:163], a[100:103], a[4:7], v[160:163]
ds_read_b128 a[136:139], v5 offset:32768
v_mfma_f32_16x16x32_bf16 v[136:139], a[100:103], a[0:3], v[136:139]
v_mfma_f32_16x16x32_bf16 v[140:143], a[104:107], a[0:3], v[140:143]
ds_read_b128 a[140:143], v5 offset:33792
v_mfma_f32_16x16x32_bf16 v[164:167], a[104:107], a[4:7], v[164:167]
buffer_load_dwordx4 a[52:55], v2, s[40:43], s35 offen offset:1024 sc1
v_mfma_f32_16x16x32_bf16 v[188:191], a[104:107], a[8:11], v[188:191]
ds_read_b128 a[144:147], v5 offset:34816
v_mfma_f32_16x16x32_bf16 v[212:215], a[104:107], a[12:15], v[212:215]
v_mfma_f32_16x16x32_bf16 v[216:219], a[108:111], a[12:15], v[216:219]
v_mfma_f32_16x16x32_bf16 v[192:195], a[108:111], a[8:11], v[192:195]
buffer_load_dwordx4 a[56:59], v2, s[40:43], s35 offen offset:2048 sc1
v_mfma_f32_16x16x32_bf16 v[168:171], a[108:111], a[4:7], v[168:171]
ds_read_b128 a[148:151], v5 offset:35840
v_mfma_f32_16x16x32_bf16 v[144:147], a[108:111], a[0:3], v[144:147]
v_mfma_f32_16x16x32_bf16 v[148:151], a[112:115], a[0:3], v[148:151]
v_mfma_f32_16x16x32_bf16 v[172:175], a[112:115], a[4:7], v[172:175]
buffer_load_dwordx4 v1, s[4:7], s44 offen offset:2048 sc1 lds
s_lshr_b32 s89, s2, 3
v_mfma_f32_16x16x32_bf16 v[196:199], a[112:115], a[8:11], v[196:199]
s_lshl_b32 s89, s89, 10
s_add_u32 s89, s89, (L_cpf3 - interleave_layers__sliding_local_dilated__linear_kernel_hedgehog__prompt_kernel + 2048)
v_mfma_f32_16x16x32_bf16 v[220:223], a[112:115], a[12:15], v[220:223]
v_mfma_f32_16x16x32_bf16 v[224:227], a[116:119], a[12:15], v[224:227]
v_mfma_f32_16x16x32_bf16 v[200:203], a[116:119], a[8:11], v[200:203]
buffer_load_dwordx4 a[60:63], v2, s[40:43], s35 offen offset:3072 sc1
s_add_u32 s35, s35, 4096
v_mfma_f32_16x16x32_bf16 v[176:179], a[116:119], a[4:7], v[176:179]
s_and_b32 s35, s35, 0x1ffff
v_mfma_f32_16x16x32_bf16 v[152:155], a[116:119], a[0:3], v[152:155]
s_waitcnt vmcnt(11) lgkmcnt(0)
v_mfma_f32_16x16x32_bf16 v[132:135], a[128:131], a[16:19], v[132:135]
ds_read_b128 a[96:99], v5 offset:36864
v_mfma_f32_16x16x32_bf16 v[156:159], a[128:131], a[20:23], v[156:159]
buffer_load_dwordx4 a[0:3], v2, s[40:43], s35 offen offset:0 sc1
v_mfma_f32_16x16x32_bf16 v[180:183], a[128:131], a[24:27], v[180:183]
ds_read_b128 a[100:103], v5 offset:37888
v_mfma_f32_16x16x32_bf16 v[204:207], a[128:131], a[28:31], v[204:207]
v_mfma_f32_16x16x32_bf16 v[208:211], a[132:135], a[28:31], v[208:211]
v_mfma_f32_16x16x32_bf16 v[184:187], a[132:135], a[24:27], v[184:187]
buffer_load_dwordx4 a[76:79], v1, s[24:27], s89 offen
s_add_u32 s44, s28, 4
v_mfma_f32_16x16x32_bf16 v[160:163], a[132:135], a[20:23], v[160:163]
s_lshl_b32 s45, s44, 12
s_add_u32 m0, s45, 32768
s_and_b32 s45, s44, 7
v_mfma_f32_16x16x32_bf16 v[136:139], a[132:135], a[16:19], v[136:139]
s_cmp_eq_u32 s45, s3
s_cselect_b32 s45, 8, 0
s_add_u32 s44, s44, s45
v_mfma_f32_16x16x32_bf16 v[140:143], a[136:139], a[16:19], v[140:143]
s_and_b32 s44, s44, 31
s_lshl_b32 s44, s44, 12
s_add_u32 s44, s44, s51
v_mfma_f32_16x16x32_bf16 v[164:167], a[136:139], a[20:23], v[164:167]
buffer_load_dwordx4 a[4:7], v2, s[40:43], s35 offen offset:1024 sc1
s_add_u32 s44, s44, 0x200000
v_mfma_f32_16x16x32_bf16 v[188:191], a[136:139], a[24:27], v[188:191]
ds_read_b128 a[104:107], v5 offset:38912
v_mfma_f32_16x16x32_bf16 v[212:215], a[136:139], a[28:31], v[212:215]
ds_read_b128 a[108:111], v5 offset:39936
v_mfma_f32_16x16x32_bf16 v[216:219], a[140:143], a[28:31], v[216:219]
ds_read_b128 a[112:115], v5 offset:40960
v_mfma_f32_16x16x32_bf16 v[192:195], a[140:143], a[24:27], v[192:195]
buffer_load_dwordx4 a[8:11], v2, s[40:43], s35 offen offset:2048 sc1
v_mfma_f32_16x16x32_bf16 v[168:171], a[140:143], a[20:23], v[168:171]
ds_read_b128 a[116:119], v5 offset:41984
v_mfma_f32_16x16x32_bf16 v[144:147], a[140:143], a[16:19], v[144:147]
v_mfma_f32_16x16x32_bf16 v[148:151], a[144:147], a[16:19], v[148:151]
v_mfma_f32_16x16x32_bf16 v[172:175], a[144:147], a[20:23], v[172:175]
buffer_load_dwordx4 v1, s[4:7], s44 offen offset:0 sc1 lds
v_mfma_f32_16x16x32_bf16 v[196:199], a[144:147], a[24:27], v[196:199]
v_mfma_f32_16x16x32_bf16 v[220:223], a[144:147], a[28:31], v[220:223]
v_mfma_f32_16x16x32_bf16 v[224:227], a[148:151], a[28:31], v[224:227]
v_mfma_f32_16x16x32_bf16 v[200:203], a[148:151], a[24:27], v[200:203]
buffer_load_dwordx4 a[12:15], v2, s[40:43], s35 offen offset:3072 sc1
s_add_u32 s35, s35, 4096
v_mfma_f32_16x16x32_bf16 v[176:179], a[148:151], a[20:23], v[176:179]
s_and_b32 s35, s35, 0x1ffff
v_mfma_f32_16x16x32_bf16 v[152:155], a[148:151], a[16:19], v[152:155]
s_waitcnt vmcnt(12) lgkmcnt(0)
v_mfma_f32_16x16x32_bf16 v[132:135], a[96:99], a[32:35], v[132:135]
ds_read_b128 a[128:131], v5 offset:43008
v_add_f32 v92, v92, v96
v_mfma_f32_16x16x32_bf16 v[156:159], a[96:99], a[36:39], v[156:159]
buffer_load_dwordx4 a[16:19], v2, s[40:43], s35 offen offset:0 sc1
v_mfma_f32_16x16x32_bf16 v[180:183], a[96:99], a[40:43], v[180:183]
ds_read_b128 a[132:135], v5 offset:44032
v_add_f32 v100, v100, v104
v_mfma_f32_16x16x32_bf16 v[204:207], a[96:99], a[44:47], v[204:207]
v_add_f32 v108, v108, v112
v_add_f32 v116, v116, v120
v_mfma_f32_16x16x32_bf16 v[208:211], a[100:103], a[44:47], v[208:211]
v_add_f32 v93, v93, v97
v_add_f32 v101, v101, v105
v_mfma_f32_16x16x32_bf16 v[184:187], a[100:103], a[40:43], v[184:187]
buffer_load_dwordx4 v1, s[4:7], s44 offen offset:1024 sc1 lds
v_mfma_f32_16x16x32_bf16 v[160:163], a[100:103], a[36:39], v[160:163]
ds_read_b128 a[136:139], v5 offset:45056
v_add_f32 v109, v109, v113
v_mfma_f32_16x16x32_bf16 v[136:139], a[100:103], a[32:35], v[136:139]
v_add_f32 v117, v117, v121
v_add_f32 v94, v94, v98
v_mfma_f32_16x16x32_bf16 v[140:143], a[104:107], a[32:35], v[140:143]
ds_read_b128 a[140:143], v5 offset:46080
v_add_f32 v102, v102, v106
v_mfma_f32_16x16x32_bf16 v[164:167], a[104:107], a[36:39], v[164:167]
buffer_load_dwordx4 a[20:23], v2, s[40:43], s35 offen offset:1024 sc1
v_mfma_f32_16x16x32_bf16 v[188:191], a[104:107], a[40:43], v[188:191]
ds_read_b128 a[144:147], v5 offset:47104
v_add_f32 v110, v110, v114
v_mfma_f32_16x16x32_bf16 v[212:215], a[104:107], a[44:47], v[212:215]
v_add_f32 v118, v118, v122
v_add_f32 v95, v95, v99
v_mfma_f32_16x16x32_bf16 v[216:219], a[108:111], a[44:47], v[216:219]
v_add_f32 v103, v103, v107
v_mfma_f32_16x16x32_bf16 v[192:195], a[108:111], a[40:43], v[192:195]
buffer_load_dwordx4 a[24:27], v2, s[40:43], s35 offen offset:2048 sc1
v_mfma_f32_16x16x32_bf16 v[168:171], a[108:111], a[36:39], v[168:171]
ds_read_b128 a[148:151], v5 offset:48128
v_add_f32 v111, v111, v115
v_mfma_f32_16x16x32_bf16 v[144:147], a[108:111], a[32:35], v[144:147]
v_add_f32 v119, v119, v123
v_add_f32_dpp v92, v92, v92 row_ror:8 row_mask:0xf bank_mask:0xf
v_mfma_f32_16x16x32_bf16 v[148:151], a[112:115], a[32:35], v[148:151]
v_add_f32_dpp v100, v100, v100 row_ror:8 row_mask:0xf bank_mask:0xf
v_mfma_f32_16x16x32_bf16 v[172:175], a[112:115], a[36:39], v[172:175]
buffer_load_dwordx4 v1, s[4:7], s44 offen offset:2048 sc1 lds
v_mfma_f32_16x16x32_bf16 v[196:199], a[112:115], a[40:43], v[196:199]
v_add_f32_dpp v108, v108, v108 row_ror:8 row_mask:0xf bank_mask:0xf
v_add_f32_dpp v116, v116, v116 row_ror:8 row_mask:0xf bank_mask:0xf
v_mfma_f32_16x16x32_bf16 v[220:223], a[112:115], a[44:47], v[220:223]
v_add_f32_dpp v93, v93, v93 row_ror:8 row_mask:0xf bank_mask:0xf
v_mfma_f32_16x16x32_bf16 v[224:227], a[116:119], a[44:47], v[224:227]
v_add_f32_dpp v101, v101, v101 row_ror:8 row_mask:0xf bank_mask:0xf
v_mfma_f32_16x16x32_bf16 v[200:203], a[116:119], a[40:43], v[200:203]
buffer_load_dwordx4 a[28:31], v2, s[40:43], s35 offen offset:3072 sc1
s_add_u32 s35, s35, 4096
v_mfma_f32_16x16x32_bf16 v[176:179], a[116:119], a[36:39], v[176:179]
s_and_b32 s35, s35, 0x1ffff
v_add_f32_dpp v109, v109, v109 row_ror:8 row_mask:0xf bank_mask:0xf
v_mfma_f32_16x16x32_bf16 v[152:155], a[116:119], a[32:35], v[152:155]
s_waitcnt vmcnt(12) lgkmcnt(0)
s_barrier
v_mfma_f32_16x16x32_bf16 v[132:135], a[128:131], a[48:51], v[132:135]
v_add_u32 v5, 0, v1
v_add_f32_dpp v117, v117, v117 row_ror:8 row_mask:0xf bank_mask:0xf
v_mfma_f32_16x16x32_bf16 v[156:159], a[128:131], a[52:55], v[156:159]
buffer_load_dwordx4 a[32:35], v2, s[40:43], s35 offen offset:0 sc1
v_mfma_f32_16x16x32_bf16 v[180:183], a[128:131], a[56:59], v[180:183]
ds_read_b128 a[96:99], v5 offset:0
v_add_f32_dpp v92, v94, v94 row_ror:8 row_mask:0xf bank_mask:0xc
v_mfma_f32_16x16x32_bf16 v[204:207], a[128:131], a[60:63], v[204:207]
ds_read_b128 a[100:103], v5 offset:1024
v_add_f32_dpp v100, v102, v102 row_ror:8 row_mask:0xf bank_mask:0xc
v_mfma_f32_16x16x32_bf16 v[208:211], a[132:135], a[60:63], v[208:211]
v_add_f32_dpp v108, v110, v110 row_ror:8 row_mask:0xf bank_mask:0xc
v_add_f32_dpp v116, v118, v118 row_ror:8 row_mask:0xf bank_mask:0xc
v_mfma_f32_16x16x32_bf16 v[184:187], a[132:135], a[56:59], v[184:187]
buffer_load_dwordx4 a[36:39], v2, s[40:43], s35 offen offset:1024 sc1
v_mfma_f32_16x16x32_bf16 v[160:163], a[132:135], a[52:55], v[160:163]
ds_read_b128 a[104:107], v5 offset:2048
v_add_f32_dpp v93, v95, v95 row_ror:8 row_mask:0xf bank_mask:0xc
v_mfma_f32_16x16x32_bf16 v[136:139], a[132:135], a[48:51], v[136:139]
v_add_f32_dpp v101, v103, v103 row_ror:8 row_mask:0xf bank_mask:0xc
v_add_f32_dpp v109, v111, v111 row_ror:8 row_mask:0xf bank_mask:0xc
v_mfma_f32_16x16x32_bf16 v[140:143], a[136:139], a[48:51], v[140:143]
ds_read_b128 a[108:111], v5 offset:3072
v_add_f32_dpp v117, v119, v119 row_ror:8 row_mask:0xf bank_mask:0xc
v_mfma_f32_16x16x32_bf16 v[164:167], a[136:139], a[52:55], v[164:167]
v_permlane32_swap_b32 v92, v93
v_mfma_f32_16x16x32_bf16 v[188:191], a[136:139], a[56:59], v[188:191]
buffer_load_dwordx4 v1, s[4:7], s44 offen offset:3072 sc1 lds
s_add_u32 s44, s28, 8
v_mfma_f32_16x16x32_bf16 v[212:215], a[136:139], a[60:63], v[212:215]
s_lshl_b32 s45, s44, 12
s_add_u32 m0, s45, 32768
s_and_b32 s45, s44, 7
v_mfma_f32_16x16x32_bf16 v[216:219], a[140:143], a[60:63], v[216:219]
s_cmp_eq_u32 s45, s3
s_cselect_b32 s45, 8, 0
s_add_u32 s44, s44, s45
v_mfma_f32_16x16x32_bf16 v[192:195], a[140:143], a[56:59], v[192:195]
s_and_b32 s44, s44, 31
s_lshl_b32 s44, s44, 12
s_add_u32 s44, s44, s51
v_mfma_f32_16x16x32_bf16 v[168:171], a[140:143], a[52:55], v[168:171]
s_add_u32 s44, s44, 0x200000
ds_read_b128 a[112:115], v5 offset:4096
v_mfma_f32_16x16x32_bf16 v[144:147], a[140:143], a[48:51], v[144:147]
buffer_load_dwordx4 a[40:43], v2, s[40:43], s35 offen offset:2048 sc1
v_mfma_f32_16x16x32_bf16 v[148:151], a[144:147], a[48:51], v[148:151]
ds_read_b128 a[116:119], v5 offset:5120
v_mfma_f32_16x16x32_bf16 v[172:175], a[144:147], a[52:55], v[172:175]
v_permlane32_swap_b32 v100, v101
v_mfma_f32_16x16x32_bf16 v[196:199], a[144:147], a[56:59], v[196:199]
v_permlane32_swap_b32 v108, v109
v_mfma_f32_16x16x32_bf16 v[220:223], a[144:147], a[60:63], v[220:223]
v_permlane32_swap_b32 v116, v117
v_mfma_f32_16x16x32_bf16 v[224:227], a[148:151], a[60:63], v[224:227]
buffer_load_dwordx4 a[44:47], v2, s[40:43], s35 offen offset:3072 sc1
s_add_u32 s35, s35, 4096
v_mfma_f32_16x16x32_bf16 v[200:203], a[148:151], a[56:59], v[200:203]
s_and_b32 s35, s35, 0x1ffff
v_add_f32 v92, v92, v93
v_mfma_f32_16x16x32_bf16 v[176:179], a[148:151], a[52:55], v[176:179]
v_add_f32 v100, v100, v101
v_add_f32 v108, v108, v109
v_mfma_f32_16x16x32_bf16 v[152:155], a[148:151], a[48:51], v[152:155]
v_add_f32 v116, v116, v117
s_waitcnt vmcnt(11) lgkmcnt(0)
v_mfma_f32_16x16x32_bf16 v[132:135], a[96:99], a[0:3], v[132:135]
ds_read_b128 a[128:131], v5 offset:6144
v_mov_b32 v94, v92
v_mfma_f32_16x16x32_bf16 v[156:159], a[96:99], a[4:7], v[156:159]
buffer_load_dwordx4 a[48:51], v2, s[40:43], s35 offen offset:0 sc1
v_mfma_f32_16x16x32_bf16 v[180:183], a[96:99], a[8:11], v[180:183]
ds_read_b128 a[132:135], v5 offset:7168
v_mov_b32 v102, v100
v_mfma_f32_16x16x32_bf16 v[204:207], a[96:99], a[12:15], v[204:207]
v_mov_b32 v110, v108
v_mov_b32 v118, v116
v_mfma_f32_16x16x32_bf16 v[208:211], a[100:103], a[12:15], v[208:211]
v_permlane16_swap_b32 v92, v94
v_mfma_f32_16x16x32_bf16 v[184:187], a[100:103], a[8:11], v[184:187]
buffer_load_dwordx4 v1, s[4:7], s44 offen offset:0 sc1 lds
v_mfma_f32_16x16x32_bf16 v[160:163], a[100:103], a[4:7], v[160:163]
ds_read_b128 a[136:139], v5 offset:8192
v_mfma_f32_16x16x32_bf16 v[136:139], a[100:103], a[0:3], v[136:139]
v_permlane16_swap_b32 v100, v102
v_mfma_f32_16x16x32_bf16 v[140:143], a[104:107], a[0:3], v[140:143]
ds_read_b128 a[140:143], v5 offset:9216
v_mfma_f32_16x16x32_bf16 v[164:167], a[104:107], a[4:7], v[164:167]
buffer_load_dwordx4 a[52:55], v2, s[40:43], s35 offen offset:1024 sc1
v_mfma_f32_16x16x32_bf16 v[188:191], a[104:107], a[8:11], v[188:191]
ds_read_b128 a[144:147], v5 offset:10240
v_mfma_f32_16x16x32_bf16 v[212:215], a[104:107], a[12:15], v[212:215]
v_permlane16_swap_b32 v108, v110
v_mfma_f32_16x16x32_bf16 v[216:219], a[108:111], a[12:15], v[216:219]
v_permlane16_swap_b32 v116, v118
v_mfma_f32_16x16x32_bf16 v[192:195], a[108:111], a[8:11], v[192:195]
buffer_load_dwordx4 a[56:59], v2, s[40:43], s35 offen offset:2048 sc1
v_mfma_f32_16x16x32_bf16 v[168:171], a[108:111], a[4:7], v[168:171]
ds_read_b128 a[148:151], v5 offset:11264
v_add_f32 v92, v92, v94
v_mfma_f32_16x16x32_bf16 v[144:147], a[108:111], a[0:3], v[144:147]
v_add_f32 v100, v100, v102
v_add_f32 v108, v108, v110
v_mfma_f32_16x16x32_bf16 v[148:151], a[112:115], a[0:3], v[148:151]
v_add_f32 v116, v116, v118
v_mov_b32 v94, v92
v_mfma_f32_16x16x32_bf16 v[172:175], a[112:115], a[4:7], v[172:175]
buffer_load_dwordx4 v1, s[4:7], s44 offen offset:1024 sc1 lds
v_mfma_f32_16x16x32_bf16 v[196:199], a[112:115], a[8:11], v[196:199]
v_mov_b32 v102, v100
v_mov_b32 v110, v108
v_mfma_f32_16x16x32_bf16 v[220:223], a[112:115], a[12:15], v[220:223]
v_mov_b32 v118, v116
v_mfma_f32_16x16x32_bf16 v[224:227], a[116:119], a[12:15], v[224:227]
v_permlane32_swap_b32 v92, v94
v_mfma_f32_16x16x32_bf16 v[200:203], a[116:119], a[8:11], v[200:203]
buffer_load_dwordx4 a[60:63], v2, s[40:43], s35 offen offset:3072 sc1
s_add_u32 s35, s35, 4096
v_mfma_f32_16x16x32_bf16 v[176:179], a[116:119], a[4:7], v[176:179]
s_and_b32 s35, s35, 0x1ffff
v_mfma_f32_16x16x32_bf16 v[152:155], a[116:119], a[0:3], v[152:155]
s_waitcnt vmcnt(11) lgkmcnt(0)
v_mfma_f32_16x16x32_bf16 v[132:135], a[128:131], a[16:19], v[132:135]
ds_read_b128 a[96:99], v5 offset:12288
v_mfma_f32_16x16x32_bf16 v[156:159], a[128:131], a[20:23], v[156:159]
buffer_load_dwordx4 a[0:3], v2, s[40:43], s35 offen offset:0 sc1
v_mfma_f32_16x16x32_bf16 v[180:183], a[128:131], a[24:27], v[180:183]
ds_read_b128 a[100:103], v5 offset:13312
v_mfma_f32_16x16x32_bf16 v[204:207], a[128:131], a[28:31], v[204:207]
v_permlane32_swap_b32 v100, v102
v_mfma_f32_16x16x32_bf16 v[208:211], a[132:135], a[28:31], v[208:211]
v_permlane32_swap_b32 v108, v110
v_mfma_f32_16x16x32_bf16 v[184:187], a[132:135], a[24:27], v[184:187]
buffer_load_dwordx4 a[4:7], v2, s[40:43], s35 offen offset:1024 sc1
v_mfma_f32_16x16x32_bf16 v[160:163], a[132:135], a[20:23], v[160:163]
ds_read_b128 a[104:107], v5 offset:14336
v_mfma_f32_16x16x32_bf16 v[136:139], a[132:135], a[16:19], v[136:139]
v_permlane32_swap_b32 v116, v118
v_mfma_f32_16x16x32_bf16 v[140:143], a[136:139], a[16:19], v[140:143]
ds_read_b128 a[108:111], v5 offset:15360
v_mul_f32 v82, 0xba800000, v92
v_mfma_f32_16x16x32_bf16 v[164:167], a[136:139], a[20:23], v[164:167]
v_mul_f32 v84, 0xba800000, v100
v_mul_f32 v86, 0xba800000, v108
v_mfma_f32_16x16x32_bf16 v[188:191], a[136:139], a[24:27], v[188:191]
buffer_load_dwordx4 v1, s[4:7], s44 offen offset:2048 sc1 lds
v_mfma_f32_16x16x32_bf16 v[212:215], a[136:139], a[28:31], v[212:215]
ds_read_b128 a[112:115], v5 offset:16384
v_mul_f32 v88, 0xba800000, v116
v_mfma_f32_16x16x32_bf16 v[216:219], a[140:143], a[28:31], v[216:219]
v_mul_f32 v94, 0x3a800000, v94
v_mul_f32 v102, 0x3a800000, v102
v_mfma_f32_16x16x32_bf16 v[192:195], a[140:143], a[24:27], v[192:195]
ds_read_b128 a[116:119], v5 offset:17408
v_mul_f32 v110, 0x3a800000, v110
v_mfma_f32_16x16x32_bf16 v[168:171], a[140:143], a[20:23], v[168:171]
v_mul_f32 v118, 0x3a800000, v118
v_fma_f32 v94, -v82, v82, v94
v_mfma_f32_16x16x32_bf16 v[144:147], a[140:143], a[16:19], v[144:147]
buffer_load_dwordx4 a[8:11], v2, s[40:43], s35 offen offset:2048 sc1
v_mfma_f32_16x16x32_bf16 v[148:151], a[144:147], a[16:19], v[148:151]
v_fma_f32 v102, -v84, v84, v102
v_fma_f32 v110, -v86, v86, v110
v_mfma_f32_16x16x32_bf16 v[172:175], a[144:147], a[20:23], v[172:175]
v_fma_f32 v118, -v88, v88, v118
v_max_f32 v94, 0, v94
v_mfma_f32_16x16x32_bf16 v[196:199], a[144:147], a[24:27], v[196:199]
v_max_f32 v102, 0, v102
v_max_f32 v110, 0, v110
v_mfma_f32_16x16x32_bf16 v[220:223], a[144:147], a[28:31], v[220:223]
v_max_f32 v118, 0, v118
v_add_f32 v94, 0x3727c5ac, v94
v_mfma_f32_16x16x32_bf16 v[224:227], a[148:151], a[28:31], v[224:227]
buffer_load_dwordx4 a[12:15], v2, s[40:43], s35 offen offset:3072 sc1
s_add_u32 s35, s35, 4096
v_mfma_f32_16x16x32_bf16 v[200:203], a[148:151], a[24:27], v[200:203]
s_and_b32 s35, s35, 0x1ffff
v_add_f32 v102, 0x3727c5ac, v102
v_mfma_f32_16x16x32_bf16 v[176:179], a[148:151], a[20:23], v[176:179]
v_add_f32 v110, 0x3727c5ac, v110
v_add_f32 v118, 0x3727c5ac, v118
v_mfma_f32_16x16x32_bf16 v[152:155], a[148:151], a[16:19], v[152:155]
s_waitcnt vmcnt(11) lgkmcnt(0)
v_mfma_f32_16x16x32_bf16 v[132:135], a[96:99], a[32:35], v[132:135]
ds_read_b128 a[128:131], v5 offset:18432
v_mfma_f32_16x16x32_bf16 v[156:159], a[96:99], a[36:39], v[156:159]
buffer_load_dwordx4 a[16:19], v2, s[40:43], s35 offen offset:0 sc1
v_mfma_f32_16x16x32_bf16 v[180:183], a[96:99], a[40:43], v[180:183]
ds_read_b128 a[132:135], v5 offset:19456
v_mfma_f32_16x16x32_bf16 v[204:207], a[96:99], a[44:47], v[204:207]
v_rsq_f32 v83, v94
v_mfma_f32_16x16x32_bf16 v[208:211], a[100:103], a[44:47], v[208:211]
v_rsq_f32 v85, v102
v_mfma_f32_16x16x32_bf16 v[184:187], a[100:103], a[40:43], v[184:187]
buffer_load_dwordx4 v1, s[4:7], s44 offen offset:3072 sc1 lds
s_add_u32 s44, s28, 12
v_mfma_f32_16x16x32_bf16 v[160:163], a[100:103], a[36:39], v[160:163]
s_lshl_b32 s45, s44, 12
s_add_u32 m0, s45, 32768
s_and_b32 s45, s44, 7
v_mfma_f32_16x16x32_bf16 v[136:139], a[100:103], a[32:35], v[136:139]
s_cmp_eq_u32 s45, s3
s_cselect_b32 s45, 8, 0
s_add_u32 s44, s44, s45
v_rsq_f32 v87, v110
v_rsq_f32 v89, v118
v_mfma_f32_16x16x32_bf16 v[140:143], a[104:107], a[32:35], v[140:143]
s_and_b32 s44, s44, 31
s_lshl_b32 s44, s44, 12
s_add_u32 s44, s44, s51
v_mfma_f32_16x16x32_bf16 v[164:167], a[104:107], a[36:39], v[164:167]
buffer_load_dwordx4 a[20:23], v2, s[40:43], s35 offen offset:1024 sc1
s_add_u32 s44, s44, 0x200000
v_mfma_f32_16x16x32_bf16 v[188:191], a[104:107], a[40:43], v[188:191]
ds_read_b128 a[136:139], v5 offset:20480
v_fmac_f32 v132, v48, v82
v_mfma_f32_16x16x32_bf16 v[212:215], a[104:107], a[44:47], v[212:215]
ds_read_b128 a[140:143], v5 offset:21504
v_fmac_f32 v156, v48, v84
v_mfma_f32_16x16x32_bf16 v[216:219], a[108:111], a[44:47], v[216:219]
ds_read_b128 a[144:147], v5 offset:22528
v_fmac_f32 v180, v48, v86
v_mfma_f32_16x16x32_bf16 v[192:195], a[108:111], a[40:43], v[192:195]
buffer_load_dwordx4 a[24:27], v2, s[40:43], s35 offen offset:2048 sc1
v_mfma_f32_16x16x32_bf16 v[168:171], a[108:111], a[36:39], v[168:171]
ds_read_b128 a[148:151], v5 offset:23552
v_fmac_f32 v204, v48, v88
v_mfma_f32_16x16x32_bf16 v[144:147], a[108:111], a[32:35], v[144:147]
v_fmac_f32 v208, v52, v88
v_fmac_f32 v184, v52, v86
v_mfma_f32_16x16x32_bf16 v[148:151], a[112:115], a[32:35], v[148:151]
v_fmac_f32 v160, v52, v84
v_fmac_f32 v136, v52, v82
v_mfma_f32_16x16x32_bf16 v[172:175], a[112:115], a[36:39], v[172:175]
buffer_load_dwordx4 v1, s[4:7], s44 offen offset:0 sc1 lds
v_mfma_f32_16x16x32_bf16 v[196:199], a[112:115], a[40:43], v[196:199]
v_fmac_f32 v140, v56, v82
v_fmac_f32 v164, v56, v84
v_mfma_f32_16x16x32_bf16 v[220:223], a[112:115], a[44:47], v[220:223]
v_fmac_f32 v188, v56, v86
v_mfma_f32_16x16x32_bf16 v[224:227], a[116:119], a[44:47], v[224:227]
v_fmac_f32 v212, v56, v88
v_mfma_f32_16x16x32_bf16 v[200:203], a[116:119], a[40:43], v[200:203]
buffer_load_dwordx4 a[28:31], v2, s[40:43], s35 offen offset:3072 sc1
s_add_u32 s35, s35, 4096
v_mfma_f32_16x16x32_bf16 v[176:179], a[116:119], a[36:39], v[176:179]
s_and_b32 s35, s35, 0x1ffff
v_fmac_f32 v216, v60, v88
v_mfma_f32_16x16x32_bf16 v[152:155], a[116:119], a[32:35], v[152:155]
v_fmac_f32 v192, v60, v86
s_waitcnt vmcnt(11) lgkmcnt(0)
v_mfma_f32_16x16x32_bf16 v[132:135], a[128:131], a[48:51], v[132:135]
ds_read_b128 a[96:99], v5 offset:24576
v_fmac_f32 v168, v60, v84
v_mfma_f32_16x16x32_bf16 v[156:159], a[128:131], a[52:55], v[156:159]
buffer_load_dwordx4 a[32:35], v2, s[40:43], s35 offen offset:0 sc1
v_mfma_f32_16x16x32_bf16 v[180:183], a[128:131], a[56:59], v[180:183]
ds_read_b128 a[100:103], v5 offset:25600
v_fmac_f32 v144, v60, v82
v_mfma_f32_16x16x32_bf16 v[204:207], a[128:131], a[60:63], v[204:207]
v_fmac_f32 v148, v64, v82
v_fmac_f32 v172, v64, v84
v_mfma_f32_16x16x32_bf16 v[208:211], a[132:135], a[60:63], v[208:211]
v_fmac_f32 v196, v64, v86
v_fmac_f32 v220, v64, v88
v_mfma_f32_16x16x32_bf16 v[184:187], a[132:135], a[56:59], v[184:187]
buffer_load_dwordx4 a[36:39], v2, s[40:43], s35 offen offset:1024 sc1
v_mfma_f32_16x16x32_bf16 v[160:163], a[132:135], a[52:55], v[160:163]
ds_read_b128 a[104:107], v5 offset:26624
v_fmac_f32 v224, v68, v88
v_mfma_f32_16x16x32_bf16 v[136:139], a[132:135], a[48:51], v[136:139]
v_fmac_f32 v200, v68, v86
v_fmac_f32 v176, v68, v84
v_mfma_f32_16x16x32_bf16 v[140:143], a[136:139], a[48:51], v[140:143]
ds_read_b128 a[108:111], v5 offset:27648
v_fmac_f32 v152, v68, v82
v_mfma_f32_16x16x32_bf16 v[164:167], a[136:139], a[52:55], v[164:167]
v_fmac_f32 v133, v49, v82
v_mfma_f32_16x16x32_bf16 v[188:191], a[136:139], a[56:59], v[188:191]
buffer_load_dwordx4 v1, s[4:7], s44 offen offset:1024 sc1 lds
v_mfma_f32_16x16x32_bf16 v[212:215], a[136:139], a[60:63], v[212:215]
ds_read_b128 a[112:115], v5 offset:28672
v_fmac_f32 v157, v49, v84
v_mfma_f32_16x16x32_bf16 v[216:219], a[140:143], a[60:63], v[216:219]
v_fmac_f32 v181, v49, v86
v_fmac_f32 v205, v49, v88
v_mfma_f32_16x16x32_bf16 v[192:195], a[140:143], a[56:59], v[192:195]
ds_read_b128 a[116:119], v5 offset:29696
v_fmac_f32 v209, v53, v88
v_mfma_f32_16x16x32_bf16 v[168:171], a[140:143], a[52:55], v[168:171]
v_fmac_f32 v185, v53, v86
v_mfma_f32_16x16x32_bf16 v[144:147], a[140:143], a[48:51], v[144:147]
buffer_load_dwordx4 a[40:43], v2, s[40:43], s35 offen offset:2048 sc1
v_mfma_f32_16x16x32_bf16 v[148:151], a[144:147], a[48:51], v[148:151]
v_fmac_f32 v161, v53, v84
v_fmac_f32 v137, v53, v82
v_mfma_f32_16x16x32_bf16 v[172:175], a[144:147], a[52:55], v[172:175]
v_fmac_f32 v141, v57, v82
v_mfma_f32_16x16x32_bf16 v[196:199], a[144:147], a[56:59], v[196:199]
v_fmac_f32 v165, v57, v84
v_mfma_f32_16x16x32_bf16 v[220:223], a[144:147], a[60:63], v[220:223]
v_fmac_f32 v189, v57, v86
v_mfma_f32_16x16x32_bf16 v[224:227], a[148:151], a[60:63], v[224:227]
buffer_load_dwordx4 a[44:47], v2, s[40:43], s35 offen offset:3072 sc1
s_add_u32 s35, s35, 4096
v_mfma_f32_16x16x32_bf16 v[200:203], a[148:151], a[56:59], v[200:203]
s_and_b32 s35, s35, 0x1ffff
v_fmac_f32 v213, v57, v88
v_mfma_f32_16x16x32_bf16 v[176:179], a[148:151], a[52:55], v[176:179]
v_fmac_f32 v217, v61, v88
v_fmac_f32 v193, v61, v86
v_mfma_f32_16x16x32_bf16 v[152:155], a[148:151], a[48:51], v[152:155]
v_fmac_f32 v169, v61, v84
s_waitcnt vmcnt(11) lgkmcnt(0)
v_mfma_f32_16x16x32_bf16 v[132:135], a[96:99], a[0:3], v[132:135]
ds_read_b128 a[128:131], v5 offset:30720
v_fmac_f32 v145, v61, v82
v_mfma_f32_16x16x32_bf16 v[156:159], a[96:99], a[4:7], v[156:159]
buffer_load_dwordx4 a[48:51], v2, s[40:43], s35 offen offset:0 sc1
v_mfma_f32_16x16x32_bf16 v[180:183], a[96:99], a[8:11], v[180:183]
ds_read_b128 a[132:135], v5 offset:31744
v_fmac_f32 v149, v65, v82
v_mfma_f32_16x16x32_bf16 v[204:207], a[96:99], a[12:15], v[204:207]
v_fmac_f32 v173, v65, v84
v_fmac_f32 v197, v65, v86
v_mfma_f32_16x16x32_bf16 v[208:211], a[100:103], a[12:15], v[208:211]
v_fmac_f32 v221, v65, v88
v_mfma_f32_16x16x32_bf16 v[184:187], a[100:103], a[8:11], v[184:187]
buffer_load_dwordx4 v1, s[4:7], s44 offen offset:2048 sc1 lds
v_mfma_f32_16x16x32_bf16 v[160:163], a[100:103], a[4:7], v[160:163]
ds_read_b128 a[136:139], v5 offset:32768
v_fmac_f32 v225, v69, v88
v_mfma_f32_16x16x32_bf16 v[136:139], a[100:103], a[0:3], v[136:139]
v_fmac_f32 v201, v69, v86
v_fmac_f32 v177, v69, v84
v_mfma_f32_16x16x32_bf16 v[140:143], a[104:107], a[0:3], v[140:143]
ds_read_b128 a[140:143], v5 offset:33792
v_fmac_f32 v153, v69, v82
v_mfma_f32_16x16x32_bf16 v[164:167], a[104:107], a[4:7], v[164:167]
buffer_load_dwordx4 a[52:55], v2, s[40:43], s35 offen offset:1024 sc1
v_mfma_f32_16x16x32_bf16 v[188:191], a[104:107], a[8:11], v[188:191]
ds_read_b128 a[144:147], v5 offset:34816
v_fmac_f32 v134, v50, v82
v_mfma_f32_16x16x32_bf16 v[212:215], a[104:107], a[12:15], v[212:215]
v_fmac_f32 v158, v50, v84
v_fmac_f32 v182, v50, v86
v_mfma_f32_16x16x32_bf16 v[216:219], a[108:111], a[12:15], v[216:219]
v_fmac_f32 v206, v50, v88
v_mfma_f32_16x16x32_bf16 v[192:195], a[108:111], a[8:11], v[192:195]
buffer_load_dwordx4 a[56:59], v2, s[40:43], s35 offen offset:2048 sc1
v_mfma_f32_16x16x32_bf16 v[168:171], a[108:111], a[4:7], v[168:171]
ds_read_b128 a[148:151], v5 offset:35840
v_fmac_f32 v210, v54, v88
v_mfma_f32_16x16x32_bf16 v[144:147], a[108:111], a[0:3], v[144:147]
v_fmac_f32 v186, v54, v86
v_fmac_f32 v162, v54, v84
v_mfma_f32_16x16x32_bf16 v[148:151], a[112:115], a[0:3], v[148:151]
v_fmac_f32 v138, v54, v82
v_mfma_f32_16x16x32_bf16 v[172:175], a[112:115], a[4:7], v[172:175]
buffer_load_dwordx4 v1, s[4:7], s44 offen offset:3072 sc1 lds
s_add_u32 s44, s28, 28
v_mfma_f32_16x16x32_bf16 v[196:199], a[112:115], a[8:11], v[196:199]
s_lshl_b32 s45, s44, 12
s_add_u32 m0, s45, 32768
s_and_b32 s45, s44, 7
v_mfma_f32_16x16x32_bf16 v[220:223], a[112:115], a[12:15], v[220:223]
s_cmp_eq_u32 s45, s3
s_cselect_b32 s45, 8, 0
s_add_u32 s44, s44, s45
v_mfma_f32_16x16x32_bf16 v[224:227], a[116:119], a[12:15], v[224:227]
s_and_b32 s44, s44, 31
s_lshl_b32 s44, s44, 12
s_add_u32 s44, s44, s51
v_mfma_f32_16x16x32_bf16 v[200:203], a[116:119], a[8:11], v[200:203]
buffer_load_dwordx4 a[60:63], v2, s[40:43], s35 offen offset:3072 sc1
s_add_u32 s35, s35, 4096
v_mfma_f32_16x16x32_bf16 v[176:179], a[116:119], a[4:7], v[176:179]
s_and_b32 s35, s35, 0x1ffff
s_add_u32 s44, s44, 0x200000
v_mfma_f32_16x16x32_bf16 v[152:155], a[116:119], a[0:3], v[152:155]
v_fmac_f32 v142, v58, v82
s_waitcnt vmcnt(11) lgkmcnt(0)
v_mfma_f32_16x16x32_bf16 v[132:135], a[128:131], a[16:19], v[132:135]
ds_read_b128 a[96:99], v5 offset:36864
v_fmac_f32 v166, v58, v84
v_mfma_f32_16x16x32_bf16 v[156:159], a[128:131], a[20:23], v[156:159]
buffer_load_dwordx4 v1, s[4:7], s44 offen offset:0 sc1 lds
v_mfma_f32_16x16x32_bf16 v[180:183], a[128:131], a[24:27], v[180:183]
ds_read_b128 a[100:103], v5 offset:37888
v_fmac_f32 v190, v58, v86
v_mfma_f32_16x16x32_bf16 v[204:207], a[128:131], a[28:31], v[204:207]
v_fmac_f32 v214, v58, v88
v_fmac_f32 v218, v62, v88
v_mfma_f32_16x16x32_bf16 v[208:211], a[132:135], a[28:31], v[208:211]
v_fmac_f32 v194, v62, v86
v_fmac_f32 v170, v62, v84
v_mfma_f32_16x16x32_bf16 v[184:187], a[132:135], a[24:27], v[184:187]
buffer_load_dwordx4 v1, s[4:7], s44 offen offset:1024 sc1 lds
v_mfma_f32_16x16x32_bf16 v[160:163], a[132:135], a[20:23], v[160:163]
ds_read_b128 a[104:107], v5 offset:38912
v_fmac_f32 v146, v62, v82
v_mfma_f32_16x16x32_bf16 v[136:139], a[132:135], a[16:19], v[136:139]
v_fmac_f32 v150, v66, v82
v_fmac_f32 v174, v66, v84
v_mfma_f32_16x16x32_bf16 v[140:143], a[136:139], a[16:19], v[140:143]
ds_read_b128 a[108:111], v5 offset:39936
v_fmac_f32 v198, v66, v86
v_mfma_f32_16x16x32_bf16 v[164:167], a[136:139], a[20:23], v[164:167]
v_fmac_f32 v222, v66, v88
v_fmac_f32 v226, v70, v88
v_mfma_f32_16x16x32_bf16 v[188:191], a[136:139], a[24:27], v[188:191]
buffer_load_dwordx4 v1, s[4:7], s44 offen offset:2048 sc1 lds
v_mfma_f32_16x16x32_bf16 v[212:215], a[136:139], a[28:31], v[212:215]
ds_read_b128 a[112:115], v5 offset:40960
v_fmac_f32 v202, v70, v86
v_mfma_f32_16x16x32_bf16 v[216:219], a[140:143], a[28:31], v[216:219]
v_fmac_f32 v178, v70, v84
v_fmac_f32 v154, v70, v82
v_mfma_f32_16x16x32_bf16 v[192:195], a[140:143], a[24:27], v[192:195]
ds_read_b128 a[116:119], v5 offset:41984
v_fmac_f32 v135, v51, v82
v_mfma_f32_16x16x32_bf16 v[168:171], a[140:143], a[20:23], v[168:171]
v_fmac_f32 v159, v51, v84
v_fmac_f32 v183, v51, v86
v_mfma_f32_16x16x32_bf16 v[144:147], a[140:143], a[16:19], v[144:147]
buffer_load_dwordx4 v1, s[4:7], s44 offen offset:3072 sc1 lds
s_add_u32 s44, s28, 16
v_mfma_f32_16x16x32_bf16 v[148:151], a[144:147], a[16:19], v[148:151]
s_lshl_b32 s45, s44, 12
s_add_u32 m0, s45, 32768
s_and_b32 s45, s44, 7
v_mfma_f32_16x16x32_bf16 v[172:175], a[144:147], a[20:23], v[172:175]
s_cmp_eq_u32 s45, s3
s_cselect_b32 s45, 8, 0
s_add_u32 s44, s44, s45
v_mfma_f32_16x16x32_bf16 v[196:199], a[144:147], a[24:27], v[196:199]
s_and_b32 s44, s44, 31
s_lshl_b32 s44, s44, 12
s_add_u32 s44, s44, s51
v_mfma_f32_16x16x32_bf16 v[220:223], a[144:147], a[28:31], v[220:223]
s_add_u32 s44, s44, 0x200000
v_fmac_f32 v207, v51, v88
v_mfma_f32_16x16x32_bf16 v[224:227], a[148:151], a[28:31], v[224:227]
buffer_load_dwordx4 v1, s[4:7], s44 offen offset:0 sc1 lds
v_mfma_f32_16x16x32_bf16 v[200:203], a[148:151], a[24:27], v[200:203]
v_fmac_f32 v211, v55, v88
v_fmac_f32 v187, v55, v86
v_mfma_f32_16x16x32_bf16 v[176:179], a[148:151], a[20:23], v[176:179]
v_fmac_f32 v163, v55, v84
v_fmac_f32 v139, v55, v82
v_mfma_f32_16x16x32_bf16 v[152:155], a[148:151], a[16:19], v[152:155]
v_fmac_f32 v143, v59, v82
s_waitcnt vmcnt(11) lgkmcnt(0)
v_mfma_f32_16x16x32_bf16 v[132:135], a[96:99], a[32:35], v[132:135]
ds_read_b128 a[128:131], v5 offset:43008
v_fmac_f32 v167, v59, v84
v_mfma_f32_16x16x32_bf16 v[156:159], a[96:99], a[36:39], v[156:159]
buffer_load_dwordx4 v1, s[4:7], s44 offen offset:1024 sc1 lds
v_mfma_f32_16x16x32_bf16 v[180:183], a[96:99], a[40:43], v[180:183]
ds_read_b128 a[132:135], v5 offset:44032
v_fmac_f32 v191, v59, v86
v_mfma_f32_16x16x32_bf16 v[204:207], a[96:99], a[44:47], v[204:207]
v_fmac_f32 v215, v59, v88
v_fmac_f32 v219, v63, v88
v_mfma_f32_16x16x32_bf16 v[208:211], a[100:103], a[44:47], v[208:211]
v_fmac_f32 v195, v63, v86
v_fmac_f32 v171, v63, v84
v_mfma_f32_16x16x32_bf16 v[184:187], a[100:103], a[40:43], v[184:187]
buffer_load_dwordx4 v1, s[4:7], s44 offen offset:2048 sc1 lds
v_mfma_f32_16x16x32_bf16 v[160:163], a[100:103], a[36:39], v[160:163]
ds_read_b128 a[136:139], v5 offset:45056
v_fmac_f32 v147, v63, v82
v_mfma_f32_16x16x32_bf16 v[136:139], a[100:103], a[32:35], v[136:139]
v_fmac_f32 v151, v67, v82
v_fmac_f32 v175, v67, v84
v_mfma_f32_16x16x32_bf16 v[140:143], a[104:107], a[32:35], v[140:143]
ds_read_b128 a[140:143], v5 offset:46080
v_fmac_f32 v199, v67, v86
v_mfma_f32_16x16x32_bf16 v[164:167], a[104:107], a[36:39], v[164:167]
buffer_load_dwordx4 v1, s[4:7], s44 offen offset:3072 sc1 lds
s_add_u32 s44, s28, 20
v_mfma_f32_16x16x32_bf16 v[188:191], a[104:107], a[40:43], v[188:191]
s_lshl_b32 s45, s44, 12
s_add_u32 m0, s45, 32768
s_and_b32 s45, s44, 7
v_mfma_f32_16x16x32_bf16 v[212:215], a[104:107], a[44:47], v[212:215]
s_cmp_eq_u32 s45, s3
s_cselect_b32 s45, 8, 0
s_add_u32 s44, s44, s45
v_mfma_f32_16x16x32_bf16 v[216:219], a[108:111], a[44:47], v[216:219]
s_and_b32 s44, s44, 31
s_lshl_b32 s44, s44, 12
s_add_u32 s44, s44, s51
s_add_u32 s44, s44, 0x200000
v_mfma_f32_16x16x32_bf16 v[192:195], a[108:111], a[40:43], v[192:195]
buffer_load_dwordx4 v1, s[4:7], s44 offen offset:0 sc1 lds
v_mfma_f32_16x16x32_bf16 v[168:171], a[108:111], a[36:39], v[168:171]
ds_read_b128 a[144:147], v5 offset:47104
v_fmac_f32 v223, v67, v88
v_mfma_f32_16x16x32_bf16 v[144:147], a[108:111], a[32:35], v[144:147]
ds_read_b128 a[148:151], v5 offset:48128
v_fmac_f32 v227, v71, v88
v_mfma_f32_16x16x32_bf16 v[148:151], a[112:115], a[32:35], v[148:151]
v_fmac_f32 v203, v71, v86
v_fmac_f32 v179, v71, v84
v_mfma_f32_16x16x32_bf16 v[172:175], a[112:115], a[36:39], v[172:175]
buffer_load_dwordx4 v1, s[4:7], s44 offen offset:1024 sc1 lds
v_mfma_f32_16x16x32_bf16 v[196:199], a[112:115], a[40:43], v[196:199]
v_fmac_f32 v155, v71, v82
v_mfma_f32_16x16x32_bf16 v[220:223], a[112:115], a[44:47], v[220:223]
v_mfma_f32_16x16x32_bf16 v[224:227], a[116:119], a[44:47], v[224:227]
v_mfma_f32_16x16x32_bf16 v[200:203], a[116:119], a[40:43], v[200:203]
buffer_load_dwordx4 v1, s[4:7], s44 offen offset:2048 sc1 lds
v_mfma_f32_16x16x32_bf16 v[176:179], a[116:119], a[36:39], v[176:179]
v_mfma_f32_16x16x32_bf16 v[152:155], a[116:119], a[32:35], v[152:155]
s_waitcnt vmcnt(11) lgkmcnt(0)
s_barrier
v_mfma_f32_16x16x32_bf16 v[132:135], a[128:131], a[48:51], v[132:135]
v_mfma_f32_16x16x32_bf16 v[156:159], a[128:131], a[52:55], v[156:159]
buffer_load_dwordx4 v1, s[4:7], s44 offen offset:3072 sc1 lds
s_add_u32 s44, s28, 24
v_mfma_f32_16x16x32_bf16 v[180:183], a[128:131], a[56:59], v[180:183]
s_lshl_b32 s45, s44, 12
s_add_u32 m0, s45, 32768
s_and_b32 s45, s44, 7
v_mfma_f32_16x16x32_bf16 v[204:207], a[128:131], a[60:63], v[204:207]
s_cmp_eq_u32 s45, s3
s_cselect_b32 s45, 8, 0
s_add_u32 s44, s44, s45
v_mfma_f32_16x16x32_bf16 v[208:211], a[132:135], a[60:63], v[208:211]
s_and_b32 s44, s44, 31
s_lshl_b32 s44, s44, 12
s_add_u32 s44, s44, s51
s_add_u32 s44, s44, 0x200000
v_mfma_f32_16x16x32_bf16 v[184:187], a[132:135], a[56:59], v[184:187]
buffer_load_dwordx4 v1, s[4:7], s44 offen offset:0 sc1 lds
v_mfma_f32_16x16x32_bf16 v[160:163], a[132:135], a[52:55], v[160:163]
v_mfma_f32_16x16x32_bf16 v[136:139], a[132:135], a[48:51], v[136:139]
v_mfma_f32_16x16x32_bf16 v[140:143], a[136:139], a[48:51], v[140:143]
v_mfma_f32_16x16x32_bf16 v[164:167], a[136:139], a[52:55], v[164:167]
v_mfma_f32_16x16x32_bf16 v[188:191], a[136:139], a[56:59], v[188:191]
buffer_load_dwordx4 v1, s[4:7], s44 offen offset:1024 sc1 lds
v_mfma_f32_16x16x32_bf16 v[212:215], a[136:139], a[60:63], v[212:215]
v_mfma_f32_16x16x32_bf16 v[216:219], a[140:143], a[60:63], v[216:219]
v_mfma_f32_16x16x32_bf16 v[192:195], a[140:143], a[56:59], v[192:195]
v_mfma_f32_16x16x32_bf16 v[168:171], a[140:143], a[52:55], v[168:171]
v_mfma_f32_16x16x32_bf16 v[144:147], a[140:143], a[48:51], v[144:147]
buffer_load_dwordx4 v1, s[4:7], s44 offen offset:2048 sc1 lds
v_mfma_f32_16x16x32_bf16 v[148:151], a[144:147], a[48:51], v[148:151]
v_mfma_f32_16x16x32_bf16 v[172:175], a[144:147], a[52:55], v[172:175]
v_mfma_f32_16x16x32_bf16 v[196:199], a[144:147], a[56:59], v[196:199]
v_mfma_f32_16x16x32_bf16 v[220:223], a[144:147], a[60:63], v[220:223]
v_mfma_f32_16x16x32_bf16 v[224:227], a[148:151], a[60:63], v[224:227]
buffer_load_dwordx4 v1, s[4:7], s44 offen offset:3072 sc1 lds
v_mfma_f32_16x16x32_bf16 v[200:203], a[148:151], a[56:59], v[200:203]
v_mfma_f32_16x16x32_bf16 v[176:179], a[148:151], a[52:55], v[176:179]
v_mfma_f32_16x16x32_bf16 v[152:155], a[148:151], a[48:51], v[152:155]
.set L_cpf3, .
v_cvt_pk_bf16_f32 v140, v140, v141
v_cvt_pk_bf16_f32 v164, v164, v165
v_cvt_pk_bf16_f32 v141, v142, v143
v_cvt_pk_bf16_f32 v165, v166, v167
v_cvt_pk_bf16_f32 v142, v144, v145
v_cvt_pk_bf16_f32 v143, v146, v147
v_cvt_pk_bf16_f32 v166, v168, v169
v_cvt_pk_bf16_f32 v167, v170, v171
v_mfma_f32_16x16x32_bf16 v[92:95], a[232:235], v[140:143], 0
v_mul_f32 v240, 0x3fb8aa3b, v83
v_mul_f32 v246, 0x3fb8aa3b, v85
v_mfma_f32_16x16x32_bf16 v[108:111], a[232:235], v[164:167], 0
v_cvt_pk_bf16_f32 v188, v188, v189
v_cvt_pk_bf16_f32 v212, v212, v213
v_mfma_f32_16x16x32_bf16 v[96:99], a[236:239], v[140:143], 0
s_nop 1
v_max3_f32 v236, v92, v93, v94
v_max3_f32 v237, -v92, -v93, -v94
v_mfma_f32_16x16x32_bf16 v[112:115], a[236:239], v[164:167], 0
v_max3_f32 v242, v108, v109, v110
v_max3_f32 v243, -v108, -v109, -v110
v_cvt_pk_bf16_f32 v189, v190, v191
v_cvt_pk_bf16_f32 v213, v214, v215
v_max3_f32 v236, v236, v95, v96
v_max3_f32 v237, v237, -v95, -v96
v_max3_f32 v236, v236, v97, v98
v_max3_f32 v237, v237, -v97, -v98
v_max3_f32 v242, v242, v111, v112
v_max3_f32 v243, v243, -v111, -v112
v_max3_f32 v242, v242, v113, v114
v_max3_f32 v243, v243, -v113, -v114
v_max_f32 v236, v236, v99
v_max_f32_e64 v237, v237, -v99
v_max_f32 v242, v242, v115
v_max_f32_e64 v243, v243, -v115
v_permlane32_swap_b32 v236, v237
s_nop 0
v_permlane32_swap_b32 v242, v243
v_max_f32 v236, v236, v237
v_max_f32 v242, v242, v243
v_mov_b32 v238, v236
v_mov_b32 v244, v242
v_pk_mul_f32 v[148:149], v[148:149], v[82:83] op_sel:[0,1] op_sel_hi:[1,1]
v_permlane16_swap_b32 v236, v238
v_permlane16_swap_b32 v242, v244
v_max_f32 v236, v236, v238
v_max_f32 v242, v242, v244
v_mov_b32 v238, v236
v_mov_b32 v244, v242
v_pk_mul_f32 v[172:173], v[172:173], v[84:85] op_sel:[0,1] op_sel_hi:[1,1]
v_permlane32_swap_b32 v236, v238
v_permlane32_swap_b32 v242, v244
v_mul_f32_e64 v236, -v236, v240
v_mul_f32_e64 v237, -v238, v240
v_mul_f32_e64 v242, -v242, v246
v_mul_f32_e64 v243, -v244, v246
v_pk_fma_f32 v[100:101], v[92:93], v[240:241], v[236:237] op_sel:[0,0,0] op_sel_hi:[1,0,0]
v_pk_fma_f32 v[102:103], v[94:95], v[240:241], v[236:237] op_sel:[0,0,0] op_sel_hi:[1,0,0]
v_pk_fma_f32 v[104:105], v[96:97], v[240:241], v[236:237] op_sel:[0,0,0] op_sel_hi:[1,0,0]
v_pk_fma_f32 v[106:107], v[98:99], v[240:241], v[236:237] op_sel:[0,0,0] op_sel_hi:[1,0,0]
v_pk_fma_f32 v[116:117], v[108:109], v[246:247], v[242:243] op_sel:[0,0,0] op_sel_hi:[1,0,0]
v_pk_fma_f32 v[118:119], v[110:111], v[246:247], v[242:243] op_sel:[0,0,0] op_sel_hi:[1,0,0]
v_pk_fma_f32 v[120:121], v[112:113], v[246:247], v[242:243] op_sel:[0,0,0] op_sel_hi:[1,0,0]
v_pk_fma_f32 v[122:123], v[114:115], v[246:247], v[242:243] op_sel:[0,0,0] op_sel_hi:[1,0,0]
v_pk_fma_f32 v[92:93], v[92:93], v[240:241], v[236:237] op_sel:[0,0,1] op_sel_hi:[1,0,1] neg_lo:[1,0,0] neg_hi:[1,0,0]
v_pk_fma_f32 v[94:95], v[94:95], v[240:241], v[236:237] op_sel:[0,0,1] op_sel_hi:[1,0,1] neg_lo:[1,0,0] neg_hi:[1,0,0]
v_pk_fma_f32 v[96:97], v[96:97], v[240:241], v[236:237] op_sel:[0,0,1] op_sel_hi:[1,0,1] neg_lo:[1,0,0] neg_hi:[1,0,0]
v_pk_fma_f32 v[98:99], v[98:99], v[240:241], v[236:237] op_sel:[0,0,1] op_sel_hi:[1,0,1] neg_lo:[1,0,0] neg_hi:[1,0,0]
v_pk_fma_f32 v[108:109], v[108:109], v[246:247], v[242:243] op_sel:[0,0,1] op_sel_hi:[1,0,1] neg_lo:[1,0,0] neg_hi:[1,0,0]
v_pk_fma_f32 v[110:111], v[110:111], v[246:247], v[242:243] op_sel:[0,0,1] op_sel_hi:[1,0,1] neg_lo:[1,0,0] neg_hi:[1,0,0]
v_pk_fma_f32 v[112:113], v[112:113], v[246:247], v[242:243] op_sel:[0,0,1] op_sel_hi:[1,0,1] neg_lo:[1,0,0] neg_hi:[1,0,0]
v_pk_fma_f32 v[114:115], v[114:115], v[246:247], v[242:243] op_sel:[0,0,1] op_sel_hi:[1,0,1] neg_lo:[1,0,0] neg_hi:[1,0,0]
v_exp_f32 v92, v92
v_exp_f32 v93, v93
v_exp_f32 v94, v94
v_exp_f32 v95, v95
v_exp_f32 v96, v96
v_exp_f32 v97, v97
v_exp_f32 v98, v98
v_exp_f32 v99, v99
v_exp_f32 v108, v108
v_exp_f32 v109, v109
v_exp_f32 v110, v110
v_exp_f32 v111, v111
v_exp_f32 v112, v112
v_exp_f32 v113, v113
v_exp_f32 v114, v114
v_exp_f32 v115, v115
v_pk_mul_f32 v[150:151], v[150:151], v[82:83] op_sel:[0,1] op_sel_hi:[1,1]
v_pk_mul_f32 v[174:175], v[174:175], v[84:85] op_sel:[0,1] op_sel_hi:[1,1]
v_cvt_pk_bf16_f32 v144, v92, v93
v_cvt_pk_bf16_f32 v145, v94, v95
v_cvt_pk_bf16_f32 v146, v96, v97
v_cvt_pk_bf16_f32 v147, v98, v99
v_cvt_pk_bf16_f32 v168, v108, v109
v_cvt_pk_bf16_f32 v169, v110, v111
v_cvt_pk_bf16_f32 v170, v112, v113
v_cvt_pk_bf16_f32 v171, v114, v115
v_cvt_pk_bf16_f32 v148, v148, v149
v_cvt_pk_bf16_f32 v172, v172, v173
v_pk_mul_f32 v[152:153], v[152:153], v[82:83] op_sel:[0,1] op_sel_hi:[1,1]
v_pk_mul_f32 v[154:155], v[154:155], v[82:83] op_sel:[0,1] op_sel_hi:[1,1]
v_pk_mul_f32 v[176:177], v[176:177], v[84:85] op_sel:[0,1] op_sel_hi:[1,1]
v_pk_mul_f32 v[178:179], v[178:179], v[84:85] op_sel:[0,1] op_sel_hi:[1,1]
v_cvt_pk_bf16_f32 v149, v150, v151
v_cvt_pk_bf16_f32 v173, v174, v175
v_cvt_pk_bf16_f32 v150, v152, v153
v_cvt_pk_bf16_f32 v151, v154, v155
v_cvt_pk_bf16_f32 v174, v176, v177
v_cvt_pk_bf16_f32 v175, v178, v179
v_mfma_f32_16x16x32_bf16 v[152:155], v[16:19], v[144:147], 0
v_cvt_pk_bf16_f32 v190, v192, v193
v_cvt_pk_bf16_f32 v191, v194, v195
v_mfma_f32_16x16x32_bf16 v[176:179], v[16:19], v[168:171], 0
v_cvt_pk_bf16_f32 v214, v216, v217
v_cvt_pk_bf16_f32 v215, v218, v219
v_exp_f32 v100, v100
s_nop 1
v_rcp_f32 v152, v152
v_exp_f32 v101, v101
s_nop 0
v_rcp_f32 v176, v176
v_pk_mul_f32 v[92:93], v[92:93], v[152:153] op_sel:[0,0] op_sel_hi:[1,0]
v_pk_mul_f32 v[94:95], v[94:95], v[152:153] op_sel:[0,0] op_sel_hi:[1,0]
v_pk_mul_f32 v[108:109], v[108:109], v[176:177] op_sel:[0,0] op_sel_hi:[1,0]
v_pk_mul_f32 v[110:111], v[110:111], v[176:177] op_sel:[0,0] op_sel_hi:[1,0]
v_pk_mul_f32 v[96:97], v[96:97], v[152:153] op_sel:[0,0] op_sel_hi:[1,0]
v_pk_mul_f32 v[98:99], v[98:99], v[152:153] op_sel:[0,0] op_sel_hi:[1,0]
v_cvt_pk_bf16_f32 v144, v92, v93
v_cvt_pk_bf16_f32 v145, v94, v95
v_pk_mul_f32 v[112:113], v[112:113], v[176:177] op_sel:[0,0] op_sel_hi:[1,0]
v_cvt_pk_bf16_f32 v168, v108, v109
v_pk_mul_f32 v[114:115], v[114:115], v[176:177] op_sel:[0,0] op_sel_hi:[1,0]
v_cvt_pk_bf16_f32 v169, v110, v111
v_mfma_f32_16x16x32_bf16 v[92:95], a[232:235], v[188:191], 0
v_cvt_pk_bf16_f32 v146, v96, v97
v_cvt_pk_bf16_f32 v147, v98, v99
v_mfma_f32_16x16x32_bf16 v[108:111], a[232:235], v[212:215], 0
v_cvt_pk_bf16_f32 v170, v112, v113
v_cvt_pk_bf16_f32 v171, v114, v115
v_mfma_f32_16x16x32_bf16 v[96:99], a[236:239], v[188:191], 0
s_nop 1
v_max3_f32 v236, v92, v93, v94
v_max3_f32 v237, -v92, -v93, -v94
v_mfma_f32_16x16x32_bf16 v[112:115], a[236:239], v[212:215], 0
v_max3_f32 v242, v108, v109, v110
v_max3_f32 v243, -v108, -v109, -v110
v_exp_f32 v102, v102
v_max3_f32 v236, v236, v95, v96
v_max3_f32 v237, v237, -v95, -v96
v_max3_f32 v236, v236, v97, v98
v_max3_f32 v237, v237, -v97, -v98
s_nop 0
v_max3_f32 v242, v242, v111, v112
v_max3_f32 v243, v243, -v111, -v112
v_max3_f32 v242, v242, v113, v114
v_max3_f32 v243, v243, -v113, -v114
v_max_f32 v236, v236, v99
v_max_f32_e64 v237, v237, -v99
v_max_f32 v242, v242, v115
v_max_f32_e64 v243, v243, -v115
v_exp_f32 v103, v103
v_exp_f32 v104, v104
v_exp_f32 v105, v105
v_exp_f32 v106, v106
v_exp_f32 v107, v107
v_exp_f32 v116, v116
v_exp_f32 v117, v117
v_exp_f32 v118, v118
v_exp_f32 v119, v119
v_exp_f32 v120, v120
v_exp_f32 v121, v121
v_exp_f32 v122, v122
v_exp_f32 v123, v123
s_lshl_b32 s36, s28, 12
v_permlane32_swap_b32 v236, v237
v_permlane32_swap_b32 v242, v243
v_add_u32 v232, s36, v7
v_cvt_pk_bf16_f32 v140, v100, v101
v_cvt_pk_bf16_f32 v141, v102, v103
v_cvt_pk_bf16_f32 v142, v104, v105
v_cvt_pk_bf16_f32 v143, v106, v107
v_cvt_pk_bf16_f32 v164, v116, v117
v_cvt_pk_bf16_f32 v165, v118, v119
v_cvt_pk_bf16_f32 v166, v120, v121
v_cvt_pk_bf16_f32 v167, v122, v123
ds_write_b64 v232, v[148:149] offset:0
ds_write_b64 v232, v[150:151] offset:512
ds_write_b64 v232, v[172:173] offset:1024
v_max_f32 v236, v236, v237
v_max_f32 v242, v242, v243
v_mfma_f32_16x16x32_bf16 v[148:151], v[16:19], v[140:143], 0
ds_write_b64 v232, v[174:175] offset:1536
v_mfma_f32_16x16x32_bf16 v[172:175], v[16:19], v[164:167], 0
v_mov_b32 v238, v236
v_mov_b32 v244, v242
v_mul_f32 v240, 0x3fb8aa3b, v87
v_permlane16_swap_b32 v236, v238
v_permlane16_swap_b32 v242, v244
v_max_f32 v236, v236, v238
v_max_f32 v242, v242, v244
v_mov_b32 v238, v236
v_mov_b32 v244, v242
v_rcp_f32 v148, v148
v_rcp_f32 v172, v172
v_permlane32_swap_b32 v236, v238
v_permlane32_swap_b32 v242, v244
v_mul_f32 v246, 0x3fb8aa3b, v89
v_pk_mul_f32 v[100:101], v[100:101], v[148:149] op_sel:[0,0] op_sel_hi:[1,0]
v_pk_mul_f32 v[102:103], v[102:103], v[148:149] op_sel:[0,0] op_sel_hi:[1,0]
v_pk_mul_f32 v[104:105], v[104:105], v[148:149] op_sel:[0,0] op_sel_hi:[1,0]
v_pk_mul_f32 v[106:107], v[106:107], v[148:149] op_sel:[0,0] op_sel_hi:[1,0]
v_pk_mul_f32 v[116:117], v[116:117], v[172:173] op_sel:[0,0] op_sel_hi:[1,0]
v_pk_mul_f32 v[118:119], v[118:119], v[172:173] op_sel:[0,0] op_sel_hi:[1,0]
v_pk_mul_f32 v[120:121], v[120:121], v[172:173] op_sel:[0,0] op_sel_hi:[1,0]
v_pk_mul_f32 v[122:123], v[122:123], v[172:173] op_sel:[0,0] op_sel_hi:[1,0]
v_mul_f32_e64 v236, -v236, v240
v_mul_f32_e64 v237, -v238, v240
v_mul_f32_e64 v242, -v242, v246
v_mul_f32_e64 v243, -v244, v246
v_cvt_pk_bf16_f32 v140, v100, v101
v_cvt_pk_bf16_f32 v141, v102, v103
v_cvt_pk_bf16_f32 v142, v104, v105
v_cvt_pk_bf16_f32 v143, v106, v107
v_cvt_pk_bf16_f32 v164, v116, v117
v_cvt_pk_bf16_f32 v165, v118, v119
v_cvt_pk_bf16_f32 v166, v120, v121
v_cvt_pk_bf16_f32 v167, v122, v123
v_pk_fma_f32 v[100:101], v[92:93], v[240:241], v[236:237] op_sel:[0,0,0] op_sel_hi:[1,0,0]
v_pk_fma_f32 v[102:103], v[94:95], v[240:241], v[236:237] op_sel:[0,0,0] op_sel_hi:[1,0,0]
v_pk_fma_f32 v[104:105], v[96:97], v[240:241], v[236:237] op_sel:[0,0,0] op_sel_hi:[1,0,0]
v_pk_fma_f32 v[106:107], v[98:99], v[240:241], v[236:237] op_sel:[0,0,0] op_sel_hi:[1,0,0]
v_pk_fma_f32 v[116:117], v[108:109], v[246:247], v[242:243] op_sel:[0,0,0] op_sel_hi:[1,0,0]
v_pk_fma_f32 v[118:119], v[110:111], v[246:247], v[242:243] op_sel:[0,0,0] op_sel_hi:[1,0,0]
v_pk_fma_f32 v[120:121], v[112:113], v[246:247], v[242:243] op_sel:[0,0,0] op_sel_hi:[1,0,0]
v_pk_fma_f32 v[122:123], v[114:115], v[246:247], v[242:243] op_sel:[0,0,0] op_sel_hi:[1,0,0]
v_pk_fma_f32 v[92:93], v[92:93], v[240:241], v[236:237] op_sel:[0,0,1] op_sel_hi:[1,0,1] neg_lo:[1,0,0] neg_hi:[1,0,0]
v_pk_fma_f32 v[94:95], v[94:95], v[240:241], v[236:237] op_sel:[0,0,1] op_sel_hi:[1,0,1] neg_lo:[1,0,0] neg_hi:[1,0,0]
v_pk_fma_f32 v[96:97], v[96:97], v[240:241], v[236:237] op_sel:[0,0,1] op_sel_hi:[1,0,1] neg_lo:[1,0,0] neg_hi:[1,0,0]
v_pk_fma_f32 v[98:99], v[98:99], v[240:241], v[236:237] op_sel:[0,0,1] op_sel_hi:[1,0,1] neg_lo:[1,0,0] neg_hi:[1,0,0]
v_pk_fma_f32 v[108:109], v[108:109], v[246:247], v[242:243] op_sel:[0,0,1] op_sel_hi:[1,0,1] neg_lo:[1,0,0] neg_hi:[1,0,0]
v_pk_fma_f32 v[110:111], v[110:111], v[246:247], v[242:243] op_sel:[0,0,1] op_sel_hi:[1,0,1] neg_lo:[1,0,0] neg_hi:[1,0,0]
v_pk_fma_f32 v[112:113], v[112:113], v[246:247], v[242:243] op_sel:[0,0,1] op_sel_hi:[1,0,1] neg_lo:[1,0,0] neg_hi:[1,0,0]
v_pk_fma_f32 v[114:115], v[114:115], v[246:247], v[242:243] op_sel:[0,0,1] op_sel_hi:[1,0,1] neg_lo:[1,0,0] neg_hi:[1,0,0]
v_pk_mul_f32 v[196:197], v[196:197], v[86:87] op_sel:[0,1] op_sel_hi:[1,1]
v_pk_mul_f32 v[220:221], v[220:221], v[88:89] op_sel:[0,1] op_sel_hi:[1,1]
v_exp_f32 v100, v100
v_exp_f32 v92, v92
v_exp_f32 v101, v101
v_exp_f32 v93, v93
v_exp_f32 v102, v102
v_exp_f32 v94, v94
v_exp_f32 v103, v103
v_exp_f32 v95, v95
v_exp_f32 v104, v104
v_exp_f32 v96, v96
v_exp_f32 v105, v105
v_exp_f32 v97, v97
v_exp_f32 v106, v106
v_exp_f32 v98, v98
v_exp_f32 v107, v107
v_exp_f32 v99, v99
v_exp_f32 v116, v116
v_exp_f32 v108, v108
v_exp_f32 v117, v117
v_exp_f32 v109, v109
v_exp_f32 v118, v118
v_exp_f32 v110, v110
v_exp_f32 v119, v119
v_exp_f32 v111, v111
v_exp_f32 v120, v120
v_exp_f32 v112, v112
v_exp_f32 v121, v121
v_exp_f32 v113, v113
v_exp_f32 v122, v122
v_exp_f32 v114, v114
v_exp_f32 v123, v123
v_exp_f32 v115, v115
v_pk_mul_f32 v[198:199], v[198:199], v[86:87] op_sel:[0,1] op_sel_hi:[1,1]
v_pk_mul_f32 v[222:223], v[222:223], v[88:89] op_sel:[0,1] op_sel_hi:[1,1]
v_cvt_pk_bf16_f32 v196, v196, v197
v_cvt_pk_bf16_f32 v220, v220, v221
v_pk_mul_f32 v[200:201], v[200:201], v[86:87] op_sel:[0,1] op_sel_hi:[1,1]
v_pk_mul_f32 v[202:203], v[202:203], v[86:87] op_sel:[0,1] op_sel_hi:[1,1]
v_pk_mul_f32 v[224:225], v[224:225], v[88:89] op_sel:[0,1] op_sel_hi:[1,1]
v_pk_mul_f32 v[226:227], v[226:227], v[88:89] op_sel:[0,1] op_sel_hi:[1,1]
v_cvt_pk_bf16_f32 v197, v198, v199
v_cvt_pk_bf16_f32 v221, v222, v223
v_cvt_pk_bf16_f32 v198, v200, v201
v_cvt_pk_bf16_f32 v199, v202, v203
v_cvt_pk_bf16_f32 v222, v224, v225
v_cvt_pk_bf16_f32 v223, v226, v227
v_cvt_pk_bf16_f32 v188, v100, v101
v_cvt_pk_bf16_f32 v189, v102, v103
v_cvt_pk_bf16_f32 v190, v104, v105
v_cvt_pk_bf16_f32 v191, v106, v107
v_cvt_pk_bf16_f32 v192, v92, v93
v_cvt_pk_bf16_f32 v193, v94, v95
v_cvt_pk_bf16_f32 v194, v96, v97
v_cvt_pk_bf16_f32 v195, v98, v99
v_cvt_pk_bf16_f32 v212, v116, v117
v_cvt_pk_bf16_f32 v213, v118, v119
v_cvt_pk_bf16_f32 v214, v120, v121
v_cvt_pk_bf16_f32 v215, v122, v123
v_cvt_pk_bf16_f32 v216, v108, v109
v_cvt_pk_bf16_f32 v217, v110, v111
v_cvt_pk_bf16_f32 v218, v112, v113
v_cvt_pk_bf16_f32 v219, v114, v115
ds_write_b64 v232, v[196:197] offset:2048
ds_write_b64 v232, v[198:199] offset:2560
ds_write_b64 v232, v[220:221] offset:3072
v_mfma_f32_16x16x32_bf16 v[196:199], v[16:19], v[188:191], 0
v_add_u32 v233, s36, v232
ds_write_b64 v232, v[222:223] offset:3584
v_mfma_f32_16x16x32_bf16 v[200:203], v[16:19], v[192:195], 0
ds_write_b64 v233, v[140:141] offset:16384
v_mfma_f32_16x16x32_bf16 v[220:223], v[16:19], v[212:215], 0
s_nop 2
v_rcp_f32 v196, v196
v_mfma_f32_16x16x32_bf16 v[224:227], v[16:19], v[216:219], 0
s_nop 0
v_rcp_f32 v200, v200
ds_write_b64 v233, v[142:143] offset:16896
v_rcp_f32 v220, v220
v_pk_mul_f32 v[100:101], v[100:101], v[196:197] op_sel:[0,0] op_sel_hi:[1,0]
s_nop 2
v_rcp_f32 v224, v224
v_pk_mul_f32 v[102:103], v[102:103], v[196:197] op_sel:[0,0] op_sel_hi:[1,0]
v_pk_mul_f32 v[104:105], v[104:105], v[196:197] op_sel:[0,0] op_sel_hi:[1,0]
v_pk_mul_f32 v[106:107], v[106:107], v[196:197] op_sel:[0,0] op_sel_hi:[1,0]
v_pk_mul_f32 v[92:93], v[92:93], v[200:201] op_sel:[0,0] op_sel_hi:[1,0]
v_pk_mul_f32 v[94:95], v[94:95], v[200:201] op_sel:[0,0] op_sel_hi:[1,0]
v_pk_mul_f32 v[96:97], v[96:97], v[200:201] op_sel:[0,0] op_sel_hi:[1,0]
v_pk_mul_f32 v[98:99], v[98:99], v[200:201] op_sel:[0,0] op_sel_hi:[1,0]
v_pk_mul_f32 v[116:117], v[116:117], v[220:221] op_sel:[0,0] op_sel_hi:[1,0]
v_pk_mul_f32 v[118:119], v[118:119], v[220:221] op_sel:[0,0] op_sel_hi:[1,0]
v_pk_mul_f32 v[120:121], v[120:121], v[220:221] op_sel:[0,0] op_sel_hi:[1,0]
v_pk_mul_f32 v[122:123], v[122:123], v[220:221] op_sel:[0,0] op_sel_hi:[1,0]
v_pk_mul_f32 v[108:109], v[108:109], v[224:225] op_sel:[0,0] op_sel_hi:[1,0]
v_pk_mul_f32 v[110:111], v[110:111], v[224:225] op_sel:[0,0] op_sel_hi:[1,0]
v_pk_mul_f32 v[112:113], v[112:113], v[224:225] op_sel:[0,0] op_sel_hi:[1,0]
v_pk_mul_f32 v[114:115], v[114:115], v[224:225] op_sel:[0,0] op_sel_hi:[1,0]
v_cvt_pk_bf16_f32 v188, v100, v101
v_cvt_pk_bf16_f32 v189, v102, v103
v_cvt_pk_bf16_f32 v190, v104, v105
v_cvt_pk_bf16_f32 v191, v106, v107
v_cvt_pk_bf16_f32 v192, v92, v93
v_cvt_pk_bf16_f32 v193, v94, v95
v_cvt_pk_bf16_f32 v194, v96, v97
v_cvt_pk_bf16_f32 v195, v98, v99
v_cvt_pk_bf16_f32 v212, v116, v117
v_cvt_pk_bf16_f32 v213, v118, v119
v_cvt_pk_bf16_f32 v214, v120, v121
v_cvt_pk_bf16_f32 v215, v122, v123
v_cvt_pk_bf16_f32 v216, v108, v109
v_cvt_pk_bf16_f32 v217, v110, v111
v_cvt_pk_bf16_f32 v218, v112, v113
v_cvt_pk_bf16_f32 v219, v114, v115
ds_write_b64 v233, v[144:145] offset:17408
ds_write_b64 v233, v[146:147] offset:17920
ds_write_b64 v233, v[164:165] offset:18432
ds_write_b64 v233, v[166:167] offset:18944
ds_write_b64 v233, v[168:169] offset:19456
ds_write_b64 v233, v[170:171] offset:19968
ds_write_b64 v233, v[188:189] offset:20480
ds_write_b64 v233, v[190:191] offset:20992
ds_write_b64 v233, v[192:193] offset:21504
ds_write_b64 v233, v[194:195] offset:22016
ds_write_b64 v233, v[212:213] offset:22528
ds_write_b64 v233, v[214:215] offset:23040
ds_write_b64 v233, v[216:217] offset:23552
ds_write_b64 v233, v[218:219] offset:24064
s_waitcnt lgkmcnt(0)
s_barrier
s_lshl_b32 s36, s28, 9
v_add_u32 v234, s36, v8
ds_read_b64_tr_b16 a[0:1], v234 offset:16384
ds_read_b64_tr_b16 a[4:5], v8 offset:0
ds_read_b64_tr_b16 a[2:3], v234 offset:18432
ds_read_b64_tr_b16 a[6:7], v8 offset:1024
ds_read_b64_tr_b16 a[8:9], v8 offset:512
ds_read_b64_tr_b16 a[10:11], v8 offset:1536
ds_read_b64_tr_b16 a[12:13], v234 offset:20480
ds_read_b64_tr_b16 a[16:17], v8 offset:2048
ds_read_b64_tr_b16 a[14:15], v234 offset:22528
ds_read_b64_tr_b16 a[18:19], v8 offset:3072
ds_read_b64_tr_b16 a[20:21], v8 offset:2560
ds_read_b64_tr_b16 a[22:23], v8 offset:3584
ds_read_b64_tr_b16 a[24:25], v234 offset:24576
ds_read_b64_tr_b16 a[28:29], v8 offset:4096
ds_read_b64_tr_b16 a[26:27], v234 offset:26624
ds_read_b64_tr_b16 a[30:31], v8 offset:5120
ds_read_b64_tr_b16 a[32:33], v8 offset:4608
ds_read_b64_tr_b16 a[34:35], v8 offset:5632
ds_read_b64_tr_b16 a[36:37], v234 offset:28672
ds_read_b64_tr_b16 a[40:41], v8 offset:6144
ds_read_b64_tr_b16 a[38:39], v234 offset:30720
ds_read_b64_tr_b16 a[42:43], v8 offset:7168
ds_read_b64_tr_b16 a[44:45], v8 offset:6656
ds_read_b64_tr_b16 a[46:47], v8 offset:7680
ds_read_b64_tr_b16 a[48:49], v234 offset:32768
ds_read_b64_tr_b16 a[52:53], v8 offset:8192
ds_read_b64_tr_b16 a[50:51], v234 offset:34816
ds_read_b64_tr_b16 a[54:55], v8 offset:9216
ds_read_b64_tr_b16 a[56:57], v8 offset:8704
ds_read_b64_tr_b16 a[58:59], v8 offset:9728
ds_read_b64_tr_b16 a[60:61], v234 offset:36864
ds_read_b64_tr_b16 a[64:65], v8 offset:10240
ds_read_b64_tr_b16 a[62:63], v234 offset:38912
ds_read_b64_tr_b16 a[66:67], v8 offset:11264
s_waitcnt lgkmcnt(14)
v_mfma_f32_16x16x32_bf16 v[92:95], a[0:3], a[4:7], 0
ds_read_b64_tr_b16 a[68:69], v8 offset:10752
ds_read_b64_tr_b16 a[70:71], v8 offset:11776
ds_read_b64_tr_b16 a[72:73], v234 offset:40960
ds_read_b64_tr_b16 a[76:77], v8 offset:12288
ds_read_b64_tr_b16 a[74:75], v234 offset:43008
ds_read_b64_tr_b16 a[78:79], v8 offset:13312
v_mfma_f32_16x16x32_bf16 v[96:99], a[0:3], a[8:11], 0
ds_read_b64_tr_b16 a[80:81], v8 offset:12800
v_mfma_f32_16x16x32_bf16 v[92:95], a[12:15], a[16:19], v[92:95]
ds_read_b64_tr_b16 a[82:83], v8 offset:13824
v_mfma_f32_16x16x32_bf16 v[100:103], a[0:3], v[16:19], 0
ds_read_b64_tr_b16 a[84:85], v234 offset:45056
ds_read_b64_tr_b16 a[88:89], v8 offset:14336
ds_read_b64_tr_b16 a[86:87], v234 offset:47104
ds_read_b64_tr_b16 a[90:91], v8 offset:15360
v_mfma_f32_16x16x32_bf16 v[96:99], a[12:15], a[20:23], v[96:99]
ds_read_b64_tr_b16 a[92:93], v8 offset:14848
v_mfma_f32_16x16x32_bf16 v[92:95], a[24:27], a[28:31], v[92:95]
ds_read_b64_tr_b16 a[94:95], v8 offset:15872
v_mfma_f32_16x16x32_bf16 v[100:103], a[12:15], v[16:19], v[100:103]
s_lshl_b32 s37, s30, 2
s_add_u32 s37, s37, s28
v_mfma_f32_16x16x32_bf16 v[96:99], a[24:27], a[32:35], v[96:99]
s_lshl_b32 s37, s37, 3
s_add_u32 s38, s37, s29
s_waitcnt lgkmcnt(14)
v_mfma_f32_16x16x32_bf16 v[92:95], a[36:39], a[40:43], v[92:95]
s_lshl_b32 s39, s38, 7
s_add_u32 s39, s39, 0x820000
v_mfma_f32_16x16x32_bf16 v[100:103], a[24:27], v[16:19], v[100:103]
s_lshl_b32 s38, s38, 11
s_add_u32 s38, s38, 0x400000
v_mfma_f32_16x16x32_bf16 v[96:99], a[36:39], a[44:47], v[96:99]
v_cvt_pk_bf16_f32 v132, v132, v133
v_cvt_pk_bf16_f32 v156, v156, v157
v_mfma_f32_16x16x32_bf16 v[92:95], a[48:51], a[52:55], v[92:95]
v_cvt_pk_bf16_f32 v180, v180, v181
v_cvt_pk_bf16_f32 v204, v204, v205
v_mfma_f32_16x16x32_bf16 v[100:103], a[36:39], v[16:19], v[100:103]
v_cvt_pk_bf16_f32 v133, v134, v135
v_cvt_pk_bf16_f32 v157, v158, v159
v_mfma_f32_16x16x32_bf16 v[96:99], a[48:51], a[56:59], v[96:99]
v_cvt_pk_bf16_f32 v181, v182, v183
v_cvt_pk_bf16_f32 v205, v206, v207
v_mfma_f32_16x16x32_bf16 v[92:95], a[60:63], a[64:67], v[92:95]
v_cvt_pk_bf16_f32 v134, v136, v137
v_cvt_pk_bf16_f32 v135, v138, v139
v_mfma_f32_16x16x32_bf16 v[100:103], a[48:51], v[16:19], v[100:103]
v_cvt_pk_bf16_f32 v158, v160, v161
v_cvt_pk_bf16_f32 v159, v162, v163
s_waitcnt lgkmcnt(12)
v_mfma_f32_16x16x32_bf16 v[96:99], a[60:63], a[68:71], v[96:99]
v_cvt_pk_bf16_f32 v182, v184, v185
v_cvt_pk_bf16_f32 v183, v186, v187
s_waitcnt lgkmcnt(8)
v_mfma_f32_16x16x32_bf16 v[92:95], a[72:75], a[76:79], v[92:95]
v_cvt_pk_bf16_f32 v206, v208, v209
v_cvt_pk_bf16_f32 v207, v210, v211
v_mfma_f32_16x16x32_bf16 v[100:103], a[60:63], v[16:19], v[100:103]
s_waitcnt lgkmcnt(6)
v_mfma_f32_16x16x32_bf16 v[96:99], a[72:75], a[80:83], v[96:99]
s_waitcnt lgkmcnt(2)
v_mfma_f32_16x16x32_bf16 v[92:95], a[84:87], a[88:91], v[92:95]
v_mfma_f32_16x16x32_bf16 v[100:103], a[72:75], v[16:19], v[100:103]
s_waitcnt lgkmcnt(0)
v_mfma_f32_16x16x32_bf16 v[96:99], a[84:87], a[92:95], v[96:99]
s_nop 4
buffer_store_dwordx4 v[92:95], v1, s[4:7], s38 offen offset:0 sc1
v_mfma_f32_16x16x32_bf16 v[100:103], a[84:87], v[16:19], v[100:103]
s_nop 0
buffer_store_dwordx4 v[96:99], v1, s[4:7], s38 offen offset:1024 sc1
s_nop 5
buffer_store_dwordx4 v[100:103], v254, s[4:7], s39 offen sc1
v_cndmask_b32 v235, 2.0, v10, s[64:65]
v_mfma_f32_16x16x32_bf16 v[108:111], a[232:235], v[132:135], 0
v_mul_f32 v240, 0x3fb8aa3b, v83
v_mul_f32 v246, 0x3fb8aa3b, v85
v_mfma_f32_16x16x32_bf16 v[172:175], a[232:235], v[156:159], 0
v_mfma_f32_16x16x32_bf16 v[112:115], a[236:239], v[132:135], 0
s_nop 3
v_max3_f32 v236, v108, v109, v110
v_max3_f32 v237, -v108, -v109, -v110
v_mfma_f32_16x16x32_bf16 v[176:179], a[236:239], v[156:159], 0
v_max3_f32 v242, v172, v173, v174
v_max3_f32 v243, -v172, -v173, -v174
v_max3_f32 v236, v236, v111, v112
v_max3_f32 v237, v237, -v111, -v112
v_max3_f32 v236, v236, v113, v114
v_max3_f32 v237, v237, -v113, -v114
s_nop 1
v_max3_f32 v242, v242, v175, v176
v_max3_f32 v243, v243, -v175, -v176
v_max3_f32 v242, v242, v177, v178
v_max3_f32 v243, v243, -v177, -v178
v_max_f32 v236, v236, v115
v_max_f32_e64 v237, v237, -v115
v_max_f32 v242, v242, v179
v_max_f32_e64 v243, v243, -v179
v_permlane32_swap_b32 v236, v237
s_nop 0
v_permlane32_swap_b32 v242, v243
v_max_f32 v236, v236, v237
v_max_f32 v242, v242, v243
v_mov_b32 v238, v236
v_mov_b32 v244, v242
s_nop 0
v_permlane16_swap_b32 v236, v238
v_permlane16_swap_b32 v242, v244
v_max_f32 v236, v236, v238
v_max_f32 v242, v242, v244
v_mov_b32 v238, v236
v_mov_b32 v244, v242
s_nop 0
v_permlane32_swap_b32 v236, v238
v_permlane32_swap_b32 v242, v244
v_mul_f32_e64 v236, -v236, v240
v_mul_f32_e64 v237, -v238, v240
v_mul_f32_e64 v242, -v242, v246
v_mul_f32_e64 v243, -v244, v246
v_pk_fma_f32 v[116:117], v[108:109], v[240:241], v[236:237] op_sel:[0,0,0] op_sel_hi:[1,0,0]
v_pk_fma_f32 v[118:119], v[110:111], v[240:241], v[236:237] op_sel:[0,0,0] op_sel_hi:[1,0,0]
v_pk_fma_f32 v[120:121], v[112:113], v[240:241], v[236:237] op_sel:[0,0,0] op_sel_hi:[1,0,0]
v_pk_fma_f32 v[122:123], v[114:115], v[240:241], v[236:237] op_sel:[0,0,0] op_sel_hi:[1,0,0]
v_pk_fma_f32 v[148:149], v[172:173], v[246:247], v[242:243] op_sel:[0,0,0] op_sel_hi:[1,0,0]
v_pk_fma_f32 v[150:151], v[174:175], v[246:247], v[242:243] op_sel:[0,0,0] op_sel_hi:[1,0,0]
v_pk_fma_f32 v[152:153], v[176:177], v[246:247], v[242:243] op_sel:[0,0,0] op_sel_hi:[1,0,0]
v_pk_fma_f32 v[154:155], v[178:179], v[246:247], v[242:243] op_sel:[0,0,0] op_sel_hi:[1,0,0]
v_pk_fma_f32 v[108:109], v[108:109], v[240:241], v[236:237] op_sel:[0,0,1] op_sel_hi:[1,0,1] neg_lo:[1,0,0] neg_hi:[1,0,0]
v_pk_fma_f32 v[110:111], v[110:111], v[240:241], v[236:237] op_sel:[0,0,1] op_sel_hi:[1,0,1] neg_lo:[1,0,0] neg_hi:[1,0,0]
v_pk_fma_f32 v[112:113], v[112:113], v[240:241], v[236:237] op_sel:[0,0,1] op_sel_hi:[1,0,1] neg_lo:[1,0,0] neg_hi:[1,0,0]
v_pk_fma_f32 v[114:115], v[114:115], v[240:241], v[236:237] op_sel:[0,0,1] op_sel_hi:[1,0,1] neg_lo:[1,0,0] neg_hi:[1,0,0]
v_pk_fma_f32 v[172:173], v[172:173], v[246:247], v[242:243] op_sel:[0,0,1] op_sel_hi:[1,0,1] neg_lo:[1,0,0] neg_hi:[1,0,0]
v_pk_fma_f32 v[174:175], v[174:175], v[246:247], v[242:243] op_sel:[0,0,1] op_sel_hi:[1,0,1] neg_lo:[1,0,0] neg_hi:[1,0,0]
v_pk_fma_f32 v[176:177], v[176:177], v[246:247], v[242:243] op_sel:[0,0,1] op_sel_hi:[1,0,1] neg_lo:[1,0,0] neg_hi:[1,0,0]
v_pk_fma_f32 v[178:179], v[178:179], v[246:247], v[242:243] op_sel:[0,0,1] op_sel_hi:[1,0,1] neg_lo:[1,0,0] neg_hi:[1,0,0]
v_exp_f32 v116, v116
v_exp_f32 v108, v108
v_exp_f32 v117, v117
v_exp_f32 v109, v109
v_exp_f32 v118, v118
v_exp_f32 v110, v110
v_exp_f32 v119, v119
v_exp_f32 v111, v111
v_exp_f32 v120, v120
v_exp_f32 v112, v112
v_exp_f32 v121, v121
v_exp_f32 v113, v113
v_exp_f32 v122, v122
v_exp_f32 v114, v114
v_exp_f32 v123, v123
v_exp_f32 v115, v115
v_exp_f32 v148, v148
v_exp_f32 v172, v172
v_exp_f32 v149, v149
v_exp_f32 v173, v173
v_exp_f32 v150, v150
v_exp_f32 v174, v174
v_exp_f32 v151, v151
v_exp_f32 v175, v175
v_exp_f32 v152, v152
v_exp_f32 v176, v176
v_exp_f32 v153, v153
v_exp_f32 v177, v177
v_exp_f32 v154, v154
v_exp_f32 v178, v178
v_exp_f32 v155, v155
v_exp_f32 v179, v179
v_cvt_pk_bf16_f32 v140, v116, v117
v_cvt_pk_bf16_f32 v141, v118, v119
v_cvt_pk_bf16_f32 v142, v120, v121
v_cvt_pk_bf16_f32 v143, v122, v123
v_cvt_pk_bf16_f32 v144, v108, v109
v_cvt_pk_bf16_f32 v145, v110, v111
v_cvt_pk_bf16_f32 v146, v112, v113
v_cvt_pk_bf16_f32 v147, v114, v115
v_cvt_pk_bf16_f32 v164, v148, v149
v_cvt_pk_bf16_f32 v165, v150, v151
v_cvt_pk_bf16_f32 v166, v152, v153
v_cvt_pk_bf16_f32 v167, v154, v155
v_cvt_pk_bf16_f32 v168, v172, v173
v_cvt_pk_bf16_f32 v169, v174, v175
v_cvt_pk_bf16_f32 v170, v176, v177
v_cvt_pk_bf16_f32 v171, v178, v179
s_add_u32 s94, s80, 0x90000
s_waitcnt vmcnt(0)
s_barrier
buffer_atomic_add v12, v235, s[4:7], s94 offen sc1
v_mfma_f32_16x16x32_bf16 v[108:111], a[232:235], v[180:183], 0
v_mul_f32 v240, 0x3fb8aa3b, v87
v_mul_f32 v246, 0x3fb8aa3b, v89
v_mfma_f32_16x16x32_bf16 v[172:175], a[232:235], v[204:207], 0
v_mfma_f32_16x16x32_bf16 v[112:115], a[236:239], v[180:183], 0
s_nop 3
v_max3_f32 v236, v108, v109, v110
v_max3_f32 v237, -v108, -v109, -v110
v_mfma_f32_16x16x32_bf16 v[176:179], a[236:239], v[204:207], 0
v_max3_f32 v242, v172, v173, v174
v_max3_f32 v243, -v172, -v173, -v174
v_max3_f32 v236, v236, v111, v112
v_max3_f32 v237, v237, -v111, -v112
v_max3_f32 v236, v236, v113, v114
v_max3_f32 v237, v237, -v113, -v114
s_nop 1
v_max3_f32 v242, v242, v175, v176
v_max3_f32 v243, v243, -v175, -v176
v_max3_f32 v242, v242, v177, v178
v_max3_f32 v243, v243, -v177, -v178
v_max_f32 v236, v236, v115
v_max_f32_e64 v237, v237, -v115
v_max_f32 v242, v242, v179
v_max_f32_e64 v243, v243, -v179
v_permlane32_swap_b32 v236, v237
s_nop 0
v_permlane32_swap_b32 v242, v243
v_max_f32 v236, v236, v237
v_max_f32 v242, v242, v243
v_mov_b32 v238, v236
v_mov_b32 v244, v242
s_nop 0
v_permlane16_swap_b32 v236, v238
v_permlane16_swap_b32 v242, v244
v_max_f32 v236, v236, v238
v_max_f32 v242, v242, v244
v_mov_b32 v238, v236
v_mov_b32 v244, v242
s_nop 0
v_permlane32_swap_b32 v236, v238
v_permlane32_swap_b32 v242, v244
v_mul_f32_e64 v236, -v236, v240
v_mul_f32_e64 v237, -v238, v240
v_mul_f32_e64 v242, -v242, v246
v_mul_f32_e64 v243, -v244, v246
v_pk_fma_f32 v[116:117], v[108:109], v[240:241], v[236:237] op_sel:[0,0,0] op_sel_hi:[1,0,0]
v_pk_fma_f32 v[118:119], v[110:111], v[240:241], v[236:237] op_sel:[0,0,0] op_sel_hi:[1,0,0]
v_pk_fma_f32 v[120:121], v[112:113], v[240:241], v[236:237] op_sel:[0,0,0] op_sel_hi:[1,0,0]
v_pk_fma_f32 v[122:123], v[114:115], v[240:241], v[236:237] op_sel:[0,0,0] op_sel_hi:[1,0,0]
v_pk_fma_f32 v[148:149], v[172:173], v[246:247], v[242:243] op_sel:[0,0,0] op_sel_hi:[1,0,0]
v_pk_fma_f32 v[150:151], v[174:175], v[246:247], v[242:243] op_sel:[0,0,0] op_sel_hi:[1,0,0]
v_pk_fma_f32 v[152:153], v[176:177], v[246:247], v[242:243] op_sel:[0,0,0] op_sel_hi:[1,0,0]
v_pk_fma_f32 v[154:155], v[178:179], v[246:247], v[242:243] op_sel:[0,0,0] op_sel_hi:[1,0,0]
v_pk_fma_f32 v[108:109], v[108:109], v[240:241], v[236:237] op_sel:[0,0,1] op_sel_hi:[1,0,1] neg_lo:[1,0,0] neg_hi:[1,0,0]
v_pk_fma_f32 v[110:111], v[110:111], v[240:241], v[236:237] op_sel:[0,0,1] op_sel_hi:[1,0,1] neg_lo:[1,0,0] neg_hi:[1,0,0]
v_pk_fma_f32 v[112:113], v[112:113], v[240:241], v[236:237] op_sel:[0,0,1] op_sel_hi:[1,0,1] neg_lo:[1,0,0] neg_hi:[1,0,0]
v_pk_fma_f32 v[114:115], v[114:115], v[240:241], v[236:237] op_sel:[0,0,1] op_sel_hi:[1,0,1] neg_lo:[1,0,0] neg_hi:[1,0,0]
v_pk_fma_f32 v[172:173], v[172:173], v[246:247], v[242:243] op_sel:[0,0,1] op_sel_hi:[1,0,1] neg_lo:[1,0,0] neg_hi:[1,0,0]
v_pk_fma_f32 v[174:175], v[174:175], v[246:247], v[242:243] op_sel:[0,0,1] op_sel_hi:[1,0,1] neg_lo:[1,0,0] neg_hi:[1,0,0]
v_pk_fma_f32 v[176:177], v[176:177], v[246:247], v[242:243] op_sel:[0,0,1] op_sel_hi:[1,0,1] neg_lo:[1,0,0] neg_hi:[1,0,0]
v_pk_fma_f32 v[178:179], v[178:179], v[246:247], v[242:243] op_sel:[0,0,1] op_sel_hi:[1,0,1] neg_lo:[1,0,0] neg_hi:[1,0,0]
v_exp_f32 v116, v116
v_exp_f32 v108, v108
v_exp_f32 v117, v117
v_exp_f32 v109, v109
v_exp_f32 v118, v118
v_exp_f32 v110, v110
v_exp_f32 v119, v119
v_exp_f32 v111, v111
v_exp_f32 v120, v120
v_exp_f32 v112, v112
v_exp_f32 v121, v121
v_exp_f32 v113, v113
v_exp_f32 v122, v122
v_exp_f32 v114, v114
v_exp_f32 v123, v123
v_exp_f32 v115, v115
v_exp_f32 v148, v148
v_exp_f32 v172, v172
v_exp_f32 v149, v149
v_exp_f32 v173, v173
v_exp_f32 v150, v150
v_exp_f32 v174, v174
v_exp_f32 v151, v151
v_exp_f32 v175, v175
v_exp_f32 v152, v152
v_exp_f32 v176, v176
v_exp_f32 v153, v153
v_exp_f32 v177, v177
v_exp_f32 v154, v154
v_exp_f32 v178, v178
v_exp_f32 v155, v155
v_exp_f32 v179, v179
v_cvt_pk_bf16_f32 v188, v116, v117
v_cvt_pk_bf16_f32 v189, v118, v119
v_cvt_pk_bf16_f32 v190, v120, v121
v_cvt_pk_bf16_f32 v191, v122, v123
v_cvt_pk_bf16_f32 v192, v108, v109
v_cvt_pk_bf16_f32 v193, v110, v111
v_cvt_pk_bf16_f32 v194, v112, v113
v_cvt_pk_bf16_f32 v195, v114, v115
v_cvt_pk_bf16_f32 v212, v148, v149
v_cvt_pk_bf16_f32 v213, v150, v151
v_cvt_pk_bf16_f32 v214, v152, v153
v_cvt_pk_bf16_f32 v215, v154, v155
v_cvt_pk_bf16_f32 v216, v172, v173
v_cvt_pk_bf16_f32 v217, v174, v175
v_cvt_pk_bf16_f32 v218, v176, v177
v_cvt_pk_bf16_f32 v219, v178, v179
s_cmp_lg_u32 s28, 0
s_cbranch_scc1 Lpe_29
s_add_u32 s36, s70, 0x90000
s_mov_b32 s37, 0
Lpoll_28:
v_mov_b32 v11, 0
s_mov_b64 exec, 1
buffer_atomic_add v11, off, s[4:7], s36 sc0 sc1
s_waitcnt vmcnt(0)
v_readfirstlane_b32 s38, v11
s_mov_b64 exec, -1
s_nop 0
v_mov_b32 v11, s38
s_add_u32 s37, s37, 1
v_cmp_gt_u32 vcc, 8, v11
s_cbranch_vccz Lpe_29
s_cmp_lt_u32 s37, 0x100000
s_cbranch_scc1 Lpoll_28
Lpe_29:
s_barrier
s_lshl_b32 s37, s30, 2
s_add_u32 s37, s37, s28
v_and_b32 v248, 7, v0
s_lshl_b32 s39, s37, 10
v_lshlrev_b32 v248, 7, v248
v_lshrrev_b32 v249, 4, v0
s_add_u32 s39, s39, 0x820000
v_lshl_add_u32 v248, v249, 4, v248
s_lshl_b32 s38, s37, 14
buffer_load_dwordx4 v[156:159], v248, s[4:7], s39 offen sc1
s_add_u32 s38, s38, 0x400000
buffer_load_dwordx4 v[92:95], v1, s[4:7], s38 offen offset:0 sc1
buffer_load_dwordx4 v[96:99], v1, s[4:7], s38 offen offset:1024 sc1
buffer_load_dwordx4 v[100:103], v1, s[4:7], s38 offen offset:2048 sc1
buffer_load_dwordx4 v[104:107], v1, s[4:7], s38 offen offset:3072 sc1
s_add_u32 s38, s38, 4096
buffer_load_dwordx4 v[148:151], v1, s[4:7], s38 offen offset:0 sc1
buffer_load_dwordx4 v[152:155], v1, s[4:7], s38 offen offset:1024 sc1
buffer_load_dwordx4 v[172:175], v1, s[4:7], s38 offen offset:2048 sc1
buffer_load_dwordx4 v[176:179], v1, s[4:7], s38 offen offset:3072 sc1
s_add_u32 s38, s38, 4096
buffer_load_dwordx4 v[48:51], v1, s[4:7], s38 offen offset:0 sc1
buffer_load_dwordx4 v[52:55], v1, s[4:7], s38 offen offset:1024 sc1
buffer_load_dwordx4 v[56:59], v1, s[4:7], s38 offen offset:2048 sc1
buffer_load_dwordx4 v[60:63], v1, s[4:7], s38 offen offset:3072 sc1
s_add_u32 s38, s38, 4096
buffer_load_dwordx4 v[64:67], v1, s[4:7], s38 offen offset:0 sc1
s_waitcnt vmcnt(13)
v_add_f32_dpp v156, v156, v156 row_ror:4 row_mask:0xf bank_mask:0xf
v_add_f32_dpp v157, v157, v157 row_ror:4 row_mask:0xf bank_mask:0xf
v_add_f32_dpp v158, v158, v158 row_ror:4 row_mask:0xf bank_mask:0xf
v_add_f32_dpp v159, v159, v159 row_ror:4 row_mask:0xf bank_mask:0xf
v_add_f32_dpp v156, v156, v156 row_ror:2 row_mask:0xf bank_mask:0xf
v_add_f32_dpp v157, v157, v157 row_ror:2 row_mask:0xf bank_mask:0xf
v_add_f32_dpp v158, v158, v158 row_ror:2 row_mask:0xf bank_mask:0xf
v_add_f32_dpp v159, v159, v159 row_ror:2 row_mask:0xf bank_mask:0xf
buffer_load_dwordx4 v[68:71], v1, s[4:7], s38 offen offset:1024 sc1
v_add_f32_dpp v156, v156, v156 row_ror:1 row_mask:0xf bank_mask:0xf
v_add_f32_dpp v157, v157, v157 row_ror:1 row_mask:0xf bank_mask:0xf
v_add_f32_dpp v158, v158, v158 row_ror:1 row_mask:0xf bank_mask:0xf
v_add_f32_dpp v159, v159, v159 row_ror:1 row_mask:0xf bank_mask:0xf
buffer_load_dwordx4 v[132:135], v1, s[4:7], s38 offen offset:2048 sc1
s_waitcnt vmcnt(12)
v_pk_add_f32 v[92:93], v[92:93], v[100:101]
v_pk_add_f32 v[94:95], v[94:95], v[102:103]
buffer_load_dwordx4 v[136:139], v1, s[4:7], s38 offen offset:3072 sc1
s_waitcnt vmcnt(12)
v_pk_add_f32 v[96:97], v[96:97], v[104:105]
v_pk_add_f32 v[98:99], v[98:99], v[106:107]
s_waitcnt vmcnt(11)
v_pk_add_f32 v[92:93], v[92:93], v[148:149]
v_pk_add_f32 v[94:95], v[94:95], v[150:151]
s_waitcnt vmcnt(10)
v_pk_add_f32 v[96:97], v[96:97], v[152:153]
v_pk_add_f32 v[98:99], v[98:99], v[154:155]
s_waitcnt vmcnt(9)
v_pk_add_f32 v[92:93], v[92:93], v[172:173]
v_pk_add_f32 v[94:95], v[94:95], v[174:175]
s_waitcnt vmcnt(8)
v_pk_add_f32 v[96:97], v[96:97], v[176:177]
v_pk_add_f32 v[98:99], v[98:99], v[178:179]
s_waitcnt vmcnt(7)
v_pk_add_f32 v[92:93], v[92:93], v[48:49]
v_pk_add_f32 v[94:95], v[94:95], v[50:51]
s_waitcnt vmcnt(6)
v_pk_add_f32 v[96:97], v[96:97], v[52:53]
v_pk_add_f32 v[98:99], v[98:99], v[54:55]
s_waitcnt vmcnt(5)
v_pk_add_f32 v[92:93], v[92:93], v[56:57]
v_pk_add_f32 v[94:95], v[94:95], v[58:59]
s_waitcnt vmcnt(4)
v_pk_add_f32 v[96:97], v[96:97], v[60:61]
v_pk_add_f32 v[98:99], v[98:99], v[62:63]
s_waitcnt vmcnt(3)
v_pk_add_f32 v[92:93], v[92:93], v[64:65]
v_pk_add_f32 v[94:95], v[94:95], v[66:67]
s_waitcnt vmcnt(2)
v_pk_add_f32 v[96:97], v[96:97], v[68:69]
v_pk_add_f32 v[98:99], v[98:99], v[70:71]
s_waitcnt vmcnt(1)
v_pk_add_f32 v[92:93], v[92:93], v[132:133]
v_pk_add_f32 v[94:95], v[94:95], v[134:135]
s_waitcnt vmcnt(0)
v_pk_add_f32 v[96:97], v[96:97], v[136:137]
v_pk_add_f32 v[98:99], v[98:99], v[138:139]
s_lshr_b32 s36, s28, 1
s_and_b32 s37, s28, 1
v_cvt_pk_bf16_f32 v156, v156, v157
v_cvt_pk_bf16_f32 v157, v158, v159
s_mul_i32 s36, s36, 3072
s_lshl_b32 s37, s37, 3
v_cvt_pk_bf16_f32 v92, v92, v93
v_cndmask_b32 v156, 0, v156, s[56:57]
v_cndmask_b32 v157, 0, v157, s[56:57]
s_add_u32 s36, s36, s37
v_cvt_pk_bf16_f32 v93, v94, v95
v_cvt_pk_bf16_f32 v94, v96, v97
v_cvt_pk_bf16_f32 v95, v98, v99
v_cndmask_b32 v156, v156, v16, s[58:59]
v_cndmask_b32 v157, v157, v16, s[58:59]
v_add_u32 v236, s36, v1
s_lshl_b32 s35, s30, 12
ds_write_b64 v236, v[92:93] offset:0
ds_write_b64 v236, v[94:95] offset:1024
ds_write_b64 v236, v[156:157] offset:2048
s_add_u32 s35, s35, 0x1e00000
s_add_u32 s94, s71, 0x30080
s_waitcnt lgkmcnt(0)
s_barrier
ds_read_b128 a[8:11], v1 offset:2048
ds_read_b128 a[20:23], v1 offset:5120
ds_read_b128 a[0:3], v1 offset:0
ds_read_b128 a[12:15], v1 offset:3072
s_add_u32 s44, s28, 0
s_lshl_b32 s45, s44, 12
ds_read_b128 a[4:7], v1 offset:1024
s_add_u32 m0, s45, 32768
s_and_b32 s45, s44, 7
ds_read_b128 a[16:19], v1 offset:4096
s_cmp_eq_u32 s45, s3
s_cselect_b32 s45, 8, 0
s_add_u32 s44, s44, s45
s_and_b32 s44, s44, 31
s_lshl_b32 s44, s44, 12
s_add_u32 s44, s44, s51
s_add_u32 s44, s44, 0x200000
buffer_load_dwordx4 v1, s[4:7], s44 offen offset:0 sc1 lds
buffer_load_dwordx4 v1, s[4:7], s44 offen offset:1024 sc1 lds
s_waitcnt lgkmcnt(5)
v_mfma_f32_16x16x32_bf16 v[92:95], a[8:11], v[140:143], 0
s_waitcnt lgkmcnt(4)
v_mfma_f32_16x16x32_bf16 v[96:99], a[20:23], v[144:147], 0
v_mfma_f32_16x16x32_bf16 v[100:103], a[8:11], v[164:167], 0
s_nop 4
v_rcp_f32 v94, v93
v_mfma_f32_16x16x32_bf16 v[104:107], a[20:23], v[168:171], 0
v_rcp_f32 v95, v97
v_mfma_f32_16x16x32_bf16 v[108:111], a[8:11], v[188:191], 0
v_rcp_f32 v102, v101
v_mfma_f32_16x16x32_bf16 v[112:115], a[20:23], v[192:195], 0
v_mul_f32 v92, v92, v94
s_nop 2
v_rcp_f32 v103, v105
v_mfma_f32_16x16x32_bf16 v[116:119], a[8:11], v[212:215], 0
v_fmac_f32 v92, v96, v95
v_rcp_f32 v110, v109
v_mfma_f32_16x16x32_bf16 v[120:123], a[20:23], v[216:219], 0
v_add_f32 v92, 0x358637bd, v92
v_mul_f32 v100, v100, v102
s_waitcnt lgkmcnt(3)
v_mfma_f32_16x16x32_bf16 v[132:135], a[0:3], v[140:143], 0
v_rcp_f32 v111, v113
s_waitcnt lgkmcnt(2)
v_mfma_f32_16x16x32_bf16 v[148:151], a[12:15], v[144:147], 0
v_rcp_f32 v92, v92
s_waitcnt lgkmcnt(1)
v_mfma_f32_16x16x32_bf16 v[136:139], a[4:7], v[140:143], 0
v_fmac_f32 v100, v104, v103
v_rcp_f32 v118, v117
v_mfma_f32_16x16x32_bf16 v[156:159], a[0:3], v[164:167], 0
v_add_f32 v100, 0x358637bd, v100
v_mul_f32 v108, v108, v110
s_waitcnt lgkmcnt(0)
v_mfma_f32_16x16x32_bf16 v[152:155], a[16:19], v[144:147], 0
v_rcp_f32 v119, v121
v_mfma_f32_16x16x32_bf16 v[172:175], a[12:15], v[168:171], 0
v_rcp_f32 v100, v100
v_mfma_f32_16x16x32_bf16 v[160:163], a[4:7], v[164:167], 0
v_fmac_f32 v108, v112, v111
v_mul_f32 v94, v94, v92
v_mfma_f32_16x16x32_bf16 v[180:183], a[0:3], v[188:191], 0
v_add_f32 v108, 0x358637bd, v108
v_mul_f32 v116, v116, v118
v_mfma_f32_16x16x32_bf16 v[176:179], a[16:19], v[168:171], 0
v_mul_f32 v95, v95, v92
v_mul_f32 v132, v132, v94
v_mfma_f32_16x16x32_bf16 v[196:199], a[12:15], v[192:195], 0
v_mul_f32 v133, v133, v94
v_mul_f32 v134, v134, v94
v_mfma_f32_16x16x32_bf16 v[184:187], a[4:7], v[188:191], 0
v_mul_f32 v135, v135, v94
v_rcp_f32 v108, v108
v_mfma_f32_16x16x32_bf16 v[204:207], a[0:3], v[212:215], 0
v_fmac_f32 v116, v120, v119
buffer_load_dwordx4 v1, s[4:7], s44 offen offset:2048 sc1 lds
v_mfma_f32_16x16x32_bf16 v[200:203], a[16:19], v[192:195], 0
v_fmac_f32 v132, v148, v95
v_fmac_f32 v133, v149, v95
v_mul_f32 v102, v102, v100
v_mul_f32 v136, v136, v94
v_mul_f32 v137, v137, v94
v_mul_f32 v138, v138, v94
v_mul_f32 v139, v139, v94
v_mfma_f32_16x16x32_bf16 v[220:223], a[12:15], v[216:219], 0
v_fmac_f32 v134, v150, v95
v_fmac_f32 v135, v151, v95
v_mfma_f32_16x16x32_bf16 v[208:211], a[4:7], v[212:215], 0
v_add_f32 v116, 0x358637bd, v116
v_cvt_pk_bf16_f32 v132, v132, v133
v_mul_f32 v103, v103, v100
v_mul_f32 v156, v156, v102
v_mul_f32 v157, v157, v102
v_fmac_f32 v136, v152, v95
v_fmac_f32 v137, v153, v95
v_fmac_f32 v138, v154, v95
v_fmac_f32 v139, v155, v95
buffer_load_dwordx4 v1, s[4:7], s44 offen offset:3072 sc1 lds
v_cvt_pk_bf16_f32 v133, v134, v135
v_mfma_f32_16x16x32_bf16 v[224:227], a[16:19], v[216:219], 0
v_mul_f32 v158, v158, v102
v_mul_f32 v159, v159, v102
v_rcp_f32 v116, v116
v_fmac_f32 v156, v172, v103
v_fmac_f32 v157, v173, v103
v_cvt_pk_bf16_f32 v134, v136, v137
v_cvt_pk_bf16_f32 v135, v138, v139
v_mul_f32 v110, v110, v108
v_mul_f32 v160, v160, v102
v_mul_f32 v161, v161, v102
v_mul_f32 v162, v162, v102
v_mul_f32 v163, v163, v102
v_fmac_f32 v158, v174, v103
v_fmac_f32 v159, v175, v103
v_cvt_pk_bf16_f32 v156, v156, v157
buffer_store_dwordx4 v[132:135], v2, s[4:7], s35 offen offset:0 sc1
v_mul_f32 v111, v111, v108
v_mul_f32 v180, v180, v110
v_mul_f32 v181, v181, v110
v_fmac_f32 v160, v176, v103
v_fmac_f32 v161, v177, v103
v_fmac_f32 v162, v178, v103
v_fmac_f32 v163, v179, v103
v_cvt_pk_bf16_f32 v157, v158, v159
v_mul_f32 v182, v182, v110
v_mul_f32 v183, v183, v110
v_fmac_f32 v180, v196, v111
v_fmac_f32 v181, v197, v111
v_cvt_pk_bf16_f32 v158, v160, v161
v_cvt_pk_bf16_f32 v159, v162, v163
v_mul_f32 v118, v118, v116
v_mul_f32 v184, v184, v110
v_mul_f32 v185, v185, v110
v_mul_f32 v186, v186, v110
v_mul_f32 v187, v187, v110
v_fmac_f32 v182, v198, v111
v_fmac_f32 v183, v199, v111
v_cvt_pk_bf16_f32 v180, v180, v181
buffer_store_dwordx4 v[156:159], v2, s[4:7], s35 offen offset:1024 sc1
v_mul_f32 v119, v119, v116
v_mul_f32 v204, v204, v118
v_mul_f32 v205, v205, v118
v_fmac_f32 v184, v200, v111
v_fmac_f32 v185, v201, v111
v_fmac_f32 v186, v202, v111
v_fmac_f32 v187, v203, v111
v_cvt_pk_bf16_f32 v181, v182, v183
v_mul_f32 v206, v206, v118
v_mul_f32 v207, v207, v118
v_fmac_f32 v204, v220, v119
v_fmac_f32 v205, v221, v119
v_cvt_pk_bf16_f32 v182, v184, v185
v_cvt_pk_bf16_f32 v183, v186, v187
v_mul_f32 v208, v208, v118
v_mul_f32 v209, v209, v118
v_mul_f32 v210, v210, v118
v_mul_f32 v211, v211, v118
v_fmac_f32 v206, v222, v119
v_fmac_f32 v207, v223, v119
v_cvt_pk_bf16_f32 v204, v204, v205
buffer_store_dwordx4 v[180:183], v2, s[4:7], s35 offen offset:2048 sc1
v_fmac_f32 v208, v224, v119
v_fmac_f32 v209, v225, v119
v_fmac_f32 v210, v226, v119
v_fmac_f32 v211, v227, v119
v_cvt_pk_bf16_f32 v205, v206, v207
v_cvt_pk_bf16_f32 v206, v208, v209
v_cvt_pk_bf16_f32 v207, v210, v211
buffer_store_dwordx4 v[204:207], v2, s[4:7], s35 offen offset:3072 sc1
s_add_u32 s92, s71, 0x30000
s_add_u32 s40, s4, 0x1e00000
s_addc_u32 s41, s5, 0
v_add_u32 v5, 32768, v1
v_add_u32 v6, 98304, v1
s_cmp_eq_u32 s3, 0
s_cselect_b32 s35, 8, 0
s_lshl_b32 s35, s35, 12
v_lshlrev_b32 v132, 16, v32
v_and_b32 v133, 0xffff0000, v32
v_lshlrev_b32 v134, 16, v33
v_and_b32 v135, 0xffff0000, v33
v_lshlrev_b32 v136, 16, v34
v_and_b32 v137, 0xffff0000, v34
v_lshlrev_b32 v138, 16, v35
v_and_b32 v139, 0xffff0000, v35
v_lshlrev_b32 v140, 16, v36
v_and_b32 v141, 0xffff0000, v36
v_lshlrev_b32 v142, 16, v37
v_and_b32 v143, 0xffff0000, v37
v_lshlrev_b32 v144, 16, v38
v_and_b32 v145, 0xffff0000, v38
v_lshlrev_b32 v146, 16, v39
v_and_b32 v147, 0xffff0000, v39
v_lshlrev_b32 v148, 16, v40
v_and_b32 v149, 0xffff0000, v40
v_lshlrev_b32 v150, 16, v41
v_and_b32 v151, 0xffff0000, v41
v_lshlrev_b32 v152, 16, v42
v_and_b32 v153, 0xffff0000, v42
v_lshlrev_b32 v154, 16, v43
v_and_b32 v155, 0xffff0000, v43
v_lshlrev_b32 v156, 16, v44
v_and_b32 v157, 0xffff0000, v44
v_lshlrev_b32 v158, 16, v45
v_and_b32 v159, 0xffff0000, v45
v_lshlrev_b32 v160, 16, v46
v_and_b32 v161, 0xffff0000, v46
v_lshlrev_b32 v162, 16, v47
v_and_b32 v163, 0xffff0000, v47
s_waitcnt vmcnt(0)
s_barrier
buffer_atomic_add v12, v10, s[4:7], s92 offen sc1
s_cmp_lg_u32 s28, 0
s_cbranch_scc1 Lpe_31
s_add_u32 s36, s66, 0x30000
s_mov_b32 s37, 0
Lpoll_30:
v_mov_b32 v11, 0
s_mov_b64 exec, 1
buffer_atomic_add v11, off, s[4:7], s36 sc0 sc1
s_waitcnt vmcnt(0)
v_readfirstlane_b32 s38, v11
s_mov_b64 exec, -1
s_nop 0
v_mov_b32 v11, s38
s_add_u32 s37, s37, 1
v_cmp_gt_u32 vcc, 32, v11
s_cbranch_vccz Lpe_31
s_cmp_lt_u32 s37, 0x100000
s_cbranch_scc1 Lpoll_30
Lpe_31:
s_waitcnt vmcnt(0)
s_barrier
L_k2go3:
buffer_load_dwordx4 a[0:3], v4, s[40:43], s35 offen offset:0 sc1
buffer_load_dwordx4 a[4:7], v4, s[40:43], s35 offen offset:1024 sc1
s_cmp_eq_u32 s3, 1
s_cselect_b32 s35, 9, 1
s_lshl_b32 s35, s35, 12
buffer_load_dwordx4 a[8:11], v4, s[40:43], s35 offen offset:0 sc1
buffer_load_dwordx4 a[12:15], v4, s[40:43], s35 offen offset:1024 sc1
s_cmp_eq_u32 s3, 2
s_cselect_b32 s35, 10, 2
s_lshl_b32 s35, s35, 12
buffer_load_dwordx4 a[16:19], v4, s[40:43], s35 offen offset:0 sc1
buffer_load_dwordx4 a[20:23], v4, s[40:43], s35 offen offset:1024 sc1
s_cmp_eq_u32 s3, 3
s_cselect_b32 s35, 11, 3
s_lshl_b32 s35, s35, 12
buffer_load_dwordx4 a[24:27], v4, s[40:43], s35 offen offset:0 sc1
buffer_load_dwordx4 a[28:31], v4, s[40:43], s35 offen offset:1024 sc1
s_cmp_eq_u32 s3, 4
s_cselect_b32 s35, 12, 4
s_lshl_b32 s35, s35, 12
buffer_load_dwordx4 a[32:35], v4, s[40:43], s35 offen offset:0 sc1
buffer_load_dwordx4 a[36:39], v4, s[40:43], s35 offen offset:1024 sc1
s_cmp_eq_u32 s3, 5
s_cselect_b32 s35, 13, 5
s_lshl_b32 s35, s35, 12
ds_read_b128 a[96:99], v5 offset:0
ds_read_b128 a[100:103], v5 offset:1024
ds_read_b128 a[104:107], v5 offset:2048
ds_read_b128 a[108:111], v5 offset:3072
s_waitcnt vmcnt(8) lgkmcnt(0)
v_mfma_f32_16x16x32_bf16 v[132:135], a[96:99], a[0:3], v[132:135]
ds_read_b128 a[112:115], v5 offset:4096
v_mfma_f32_16x16x32_bf16 v[148:151], a[96:99], a[4:7], v[148:151]
ds_read_b128 a[116:119], v5 offset:5120
v_mfma_f32_16x16x32_bf16 v[152:155], a[100:103], a[4:7], v[152:155]
buffer_load_dwordx4 a[40:43], v4, s[40:43], s35 offen offset:0 sc1
v_mfma_f32_16x16x32_bf16 v[136:139], a[100:103], a[0:3], v[136:139]
ds_read_b128 a[120:123], v5 offset:6144
v_mfma_f32_16x16x32_bf16 v[140:143], a[104:107], a[0:3], v[140:143]
ds_read_b128 a[124:127], v5 offset:7168
v_mfma_f32_16x16x32_bf16 v[156:159], a[104:107], a[4:7], v[156:159]
v_mfma_f32_16x16x32_bf16 v[160:163], a[108:111], a[4:7], v[160:163]
buffer_load_dwordx4 a[44:47], v4, s[40:43], s35 offen offset:1024 sc1
v_mfma_f32_16x16x32_bf16 v[144:147], a[108:111], a[0:3], v[144:147]
s_cmp_eq_u32 s3, 6
s_cselect_b32 s35, 14, 6
s_lshl_b32 s35, s35, 12
s_waitcnt vmcnt(8) lgkmcnt(0)
v_mfma_f32_16x16x32_bf16 v[132:135], a[112:115], a[8:11], v[132:135]
ds_read_b128 a[96:99], v5 offset:8192
v_mfma_f32_16x16x32_bf16 v[148:151], a[112:115], a[12:15], v[148:151]
ds_read_b128 a[100:103], v5 offset:9216
v_mfma_f32_16x16x32_bf16 v[152:155], a[116:119], a[12:15], v[152:155]
buffer_load_dwordx4 a[0:3], v4, s[40:43], s35 offen offset:0 sc1
v_mfma_f32_16x16x32_bf16 v[136:139], a[116:119], a[8:11], v[136:139]
ds_read_b128 a[104:107], v5 offset:10240
v_mfma_f32_16x16x32_bf16 v[140:143], a[120:123], a[8:11], v[140:143]
ds_read_b128 a[108:111], v5 offset:11264
v_mfma_f32_16x16x32_bf16 v[156:159], a[120:123], a[12:15], v[156:159]
v_mfma_f32_16x16x32_bf16 v[160:163], a[124:127], a[12:15], v[160:163]
buffer_load_dwordx4 a[4:7], v4, s[40:43], s35 offen offset:1024 sc1
v_mfma_f32_16x16x32_bf16 v[144:147], a[124:127], a[8:11], v[144:147]
s_cmp_eq_u32 s3, 7
s_cselect_b32 s35, 15, 7
s_lshl_b32 s35, s35, 12
s_waitcnt vmcnt(8) lgkmcnt(0)
v_mfma_f32_16x16x32_bf16 v[132:135], a[96:99], a[16:19], v[132:135]
ds_read_b128 a[112:115], v5 offset:12288
v_mfma_f32_16x16x32_bf16 v[148:151], a[96:99], a[20:23], v[148:151]
ds_read_b128 a[116:119], v5 offset:13312
v_mfma_f32_16x16x32_bf16 v[152:155], a[100:103], a[20:23], v[152:155]
buffer_load_dwordx4 a[8:11], v4, s[40:43], s35 offen offset:0 sc1
v_mfma_f32_16x16x32_bf16 v[136:139], a[100:103], a[16:19], v[136:139]
ds_read_b128 a[120:123], v5 offset:14336
v_mfma_f32_16x16x32_bf16 v[140:143], a[104:107], a[16:19], v[140:143]
ds_read_b128 a[124:127], v5 offset:15360
v_mfma_f32_16x16x32_bf16 v[156:159], a[104:107], a[20:23], v[156:159]
v_mfma_f32_16x16x32_bf16 v[160:163], a[108:111], a[20:23], v[160:163]
buffer_load_dwordx4 a[12:15], v4, s[40:43], s35 offen offset:1024 sc1
v_mfma_f32_16x16x32_bf16 v[144:147], a[108:111], a[16:19], v[144:147]
s_cmp_eq_u32 s3, 0
s_cselect_b32 s35, 16, 8
s_lshl_b32 s35, s35, 12
s_waitcnt vmcnt(8) lgkmcnt(0)
v_mfma_f32_16x16x32_bf16 v[132:135], a[112:115], a[24:27], v[132:135]
ds_read_b128 a[96:99], v5 offset:16384
v_mfma_f32_16x16x32_bf16 v[148:151], a[112:115], a[28:31], v[148:151]
ds_read_b128 a[100:103], v5 offset:17408
v_mfma_f32_16x16x32_bf16 v[152:155], a[116:119], a[28:31], v[152:155]
buffer_load_dwordx4 a[16:19], v4, s[40:43], s35 offen offset:0 sc1
v_mfma_f32_16x16x32_bf16 v[136:139], a[116:119], a[24:27], v[136:139]
ds_read_b128 a[104:107], v5 offset:18432
v_mfma_f32_16x16x32_bf16 v[140:143], a[120:123], a[24:27], v[140:143]
ds_read_b128 a[108:111], v5 offset:19456
v_mfma_f32_16x16x32_bf16 v[156:159], a[120:123], a[28:31], v[156:159]
v_mfma_f32_16x16x32_bf16 v[160:163], a[124:127], a[28:31], v[160:163]
buffer_load_dwordx4 a[20:23], v4, s[40:43], s35 offen offset:1024 sc1
v_mfma_f32_16x16x32_bf16 v[144:147], a[124:127], a[24:27], v[144:147]
s_cmp_eq_u32 s3, 1
s_cselect_b32 s35, 17, 9
s_lshl_b32 s35, s35, 12
s_waitcnt vmcnt(8) lgkmcnt(0)
v_mfma_f32_16x16x32_bf16 v[132:135], a[96:99], a[32:35], v[132:135]
ds_read_b128 a[112:115], v5 offset:20480
v_mfma_f32_16x16x32_bf16 v[148:151], a[96:99], a[36:39], v[148:151]
ds_read_b128 a[116:119], v5 offset:21504
v_mfma_f32_16x16x32_bf16 v[152:155], a[100:103], a[36:39], v[152:155]
buffer_load_dwordx4 a[24:27], v4, s[40:43], s35 offen offset:0 sc1
v_mfma_f32_16x16x32_bf16 v[136:139], a[100:103], a[32:35], v[136:139]
ds_read_b128 a[120:123], v5 offset:22528
v_mfma_f32_16x16x32_bf16 v[140:143], a[104:107], a[32:35], v[140:143]
ds_read_b128 a[124:127], v5 offset:23552
v_mfma_f32_16x16x32_bf16 v[156:159], a[104:107], a[36:39], v[156:159]
v_mfma_f32_16x16x32_bf16 v[160:163], a[108:111], a[36:39], v[160:163]
buffer_load_dwordx4 a[28:31], v4, s[40:43], s35 offen offset:1024 sc1
v_mfma_f32_16x16x32_bf16 v[144:147], a[108:111], a[32:35], v[144:147]
s_cmp_eq_u32 s3, 2
s_cselect_b32 s35, 18, 10
s_lshl_b32 s35, s35, 12
s_waitcnt vmcnt(8) lgkmcnt(0)
v_mfma_f32_16x16x32_bf16 v[132:135], a[112:115], a[40:43], v[132:135]
ds_read_b128 a[96:99], v5 offset:24576
v_mfma_f32_16x16x32_bf16 v[148:151], a[112:115], a[44:47], v[148:151]
ds_read_b128 a[100:103], v5 offset:25600
v_mfma_f32_16x16x32_bf16 v[152:155], a[116:119], a[44:47], v[152:155]
buffer_load_dwordx4 a[32:35], v4, s[40:43], s35 offen offset:0 sc1
v_mfma_f32_16x16x32_bf16 v[136:139], a[116:119], a[40:43], v[136:139]
ds_read_b128 a[104:107], v5 offset:26624
v_mfma_f32_16x16x32_bf16 v[140:143], a[120:123], a[40:43], v[140:143]
ds_read_b128 a[108:111], v5 offset:27648
v_mfma_f32_16x16x32_bf16 v[156:159], a[120:123], a[44:47], v[156:159]
v_mfma_f32_16x16x32_bf16 v[160:163], a[124:127], a[44:47], v[160:163]
buffer_load_dwordx4 a[36:39], v4, s[40:43], s35 offen offset:1024 sc1
v_mfma_f32_16x16x32_bf16 v[144:147], a[124:127], a[40:43], v[144:147]
s_cmp_eq_u32 s3, 3
s_cselect_b32 s35, 19, 11
s_lshl_b32 s35, s35, 12
s_waitcnt vmcnt(8) lgkmcnt(0)
v_mfma_f32_16x16x32_bf16 v[132:135], a[96:99], a[0:3], v[132:135]
ds_read_b128 a[112:115], v5 offset:28672
v_mfma_f32_16x16x32_bf16 v[148:151], a[96:99], a[4:7], v[148:151]
ds_read_b128 a[116:119], v5 offset:29696
v_mfma_f32_16x16x32_bf16 v[152:155], a[100:103], a[4:7], v[152:155]
buffer_load_dwordx4 a[40:43], v4, s[40:43], s35 offen offset:0 sc1
v_mfma_f32_16x16x32_bf16 v[136:139], a[100:103], a[0:3], v[136:139]
ds_read_b128 a[120:123], v5 offset:30720
v_mfma_f32_16x16x32_bf16 v[140:143], a[104:107], a[0:3], v[140:143]
ds_read_b128 a[124:127], v5 offset:31744
v_mfma_f32_16x16x32_bf16 v[156:159], a[104:107], a[4:7], v[156:159]
v_mfma_f32_16x16x32_bf16 v[160:163], a[108:111], a[4:7], v[160:163]
buffer_load_dwordx4 a[44:47], v4, s[40:43], s35 offen offset:1024 sc1
v_mfma_f32_16x16x32_bf16 v[144:147], a[108:111], a[0:3], v[144:147]
s_cmp_eq_u32 s3, 4
s_cselect_b32 s35, 20, 12
s_lshl_b32 s35, s35, 12
s_waitcnt vmcnt(8) lgkmcnt(0)
v_mfma_f32_16x16x32_bf16 v[132:135], a[112:115], a[8:11], v[132:135]
ds_read_b128 a[96:99], v5 offset:32768
v_mfma_f32_16x16x32_bf16 v[148:151], a[112:115], a[12:15], v[148:151]
ds_read_b128 a[100:103], v5 offset:33792
v_mfma_f32_16x16x32_bf16 v[152:155], a[116:119], a[12:15], v[152:155]
buffer_load_dwordx4 a[0:3], v4, s[40:43], s35 offen offset:0 sc1
v_mfma_f32_16x16x32_bf16 v[136:139], a[116:119], a[8:11], v[136:139]
ds_read_b128 a[104:107], v5 offset:34816
v_mfma_f32_16x16x32_bf16 v[140:143], a[120:123], a[8:11], v[140:143]
ds_read_b128 a[108:111], v5 offset:35840
v_mfma_f32_16x16x32_bf16 v[156:159], a[120:123], a[12:15], v[156:159]
v_mfma_f32_16x16x32_bf16 v[160:163], a[124:127], a[12:15], v[160:163]
buffer_load_dwordx4 a[4:7], v4, s[40:43], s35 offen offset:1024 sc1
v_mfma_f32_16x16x32_bf16 v[144:147], a[124:127], a[8:11], v[144:147]
s_cmp_eq_u32 s3, 5
s_cselect_b32 s35, 21, 13
s_lshl_b32 s35, s35, 12
s_waitcnt vmcnt(8) lgkmcnt(0)
v_mfma_f32_16x16x32_bf16 v[132:135], a[96:99], a[16:19], v[132:135]
ds_read_b128 a[112:115], v5 offset:36864
v_mfma_f32_16x16x32_bf16 v[148:151], a[96:99], a[20:23], v[148:151]
ds_read_b128 a[116:119], v5 offset:37888
v_mfma_f32_16x16x32_bf16 v[152:155], a[100:103], a[20:23], v[152:155]
buffer_load_dwordx4 a[8:11], v4, s[40:43], s35 offen offset:0 sc1
v_mfma_f32_16x16x32_bf16 v[136:139], a[100:103], a[16:19], v[136:139]
ds_read_b128 a[120:123], v5 offset:38912
v_mfma_f32_16x16x32_bf16 v[140:143], a[104:107], a[16:19], v[140:143]
ds_read_b128 a[124:127], v5 offset:39936
v_mfma_f32_16x16x32_bf16 v[156:159], a[104:107], a[20:23], v[156:159]
v_mfma_f32_16x16x32_bf16 v[160:163], a[108:111], a[20:23], v[160:163]
buffer_load_dwordx4 a[12:15], v4, s[40:43], s35 offen offset:1024 sc1
v_mfma_f32_16x16x32_bf16 v[144:147], a[108:111], a[16:19], v[144:147]
s_cmp_eq_u32 s3, 6
s_cselect_b32 s35, 22, 14
s_lshl_b32 s35, s35, 12
s_waitcnt vmcnt(8) lgkmcnt(0)
v_mfma_f32_16x16x32_bf16 v[132:135], a[112:115], a[24:27], v[132:135]
ds_read_b128 a[96:99], v5 offset:40960
v_mfma_f32_16x16x32_bf16 v[148:151], a[112:115], a[28:31], v[148:151]
ds_read_b128 a[100:103], v5 offset:41984
v_mfma_f32_16x16x32_bf16 v[152:155], a[116:119], a[28:31], v[152:155]
buffer_load_dwordx4 a[16:19], v4, s[40:43], s35 offen offset:0 sc1
v_mfma_f32_16x16x32_bf16 v[136:139], a[116:119], a[24:27], v[136:139]
ds_read_b128 a[104:107], v5 offset:43008
v_mfma_f32_16x16x32_bf16 v[140:143], a[120:123], a[24:27], v[140:143]
ds_read_b128 a[108:111], v5 offset:44032
v_mfma_f32_16x16x32_bf16 v[156:159], a[120:123], a[28:31], v[156:159]
v_mfma_f32_16x16x32_bf16 v[160:163], a[124:127], a[28:31], v[160:163]
buffer_load_dwordx4 a[20:23], v4, s[40:43], s35 offen offset:1024 sc1
v_mfma_f32_16x16x32_bf16 v[144:147], a[124:127], a[24:27], v[144:147]
s_cmp_eq_u32 s3, 7
s_cselect_b32 s35, 23, 15
s_lshl_b32 s35, s35, 12
s_waitcnt vmcnt(8) lgkmcnt(0)
v_mfma_f32_16x16x32_bf16 v[132:135], a[96:99], a[32:35], v[132:135]
ds_read_b128 a[112:115], v5 offset:45056
v_mfma_f32_16x16x32_bf16 v[148:151], a[96:99], a[36:39], v[148:151]
ds_read_b128 a[116:119], v5 offset:46080
v_mfma_f32_16x16x32_bf16 v[152:155], a[100:103], a[36:39], v[152:155]
buffer_load_dwordx4 a[24:27], v4, s[40:43], s35 offen offset:0 sc1
v_mfma_f32_16x16x32_bf16 v[136:139], a[100:103], a[32:35], v[136:139]
ds_read_b128 a[120:123], v5 offset:47104
v_mfma_f32_16x16x32_bf16 v[140:143], a[104:107], a[32:35], v[140:143]
ds_read_b128 a[124:127], v5 offset:48128
v_mfma_f32_16x16x32_bf16 v[156:159], a[104:107], a[36:39], v[156:159]
v_mfma_f32_16x16x32_bf16 v[160:163], a[108:111], a[36:39], v[160:163]
buffer_load_dwordx4 a[28:31], v4, s[40:43], s35 offen offset:1024 sc1
v_mfma_f32_16x16x32_bf16 v[144:147], a[108:111], a[32:35], v[144:147]
s_cmp_eq_u32 s3, 0
s_cselect_b32 s35, 24, 16
s_lshl_b32 s35, s35, 12
s_waitcnt vmcnt(8) lgkmcnt(0)
v_mfma_f32_16x16x32_bf16 v[132:135], a[112:115], a[40:43], v[132:135]
ds_read_b128 a[96:99], v5 offset:49152
v_mfma_f32_16x16x32_bf16 v[148:151], a[112:115], a[44:47], v[148:151]
ds_read_b128 a[100:103], v5 offset:50176
v_mfma_f32_16x16x32_bf16 v[152:155], a[116:119], a[44:47], v[152:155]
buffer_load_dwordx4 a[32:35], v4, s[40:43], s35 offen offset:0 sc1
v_mfma_f32_16x16x32_bf16 v[136:139], a[116:119], a[40:43], v[136:139]
ds_read_b128 a[104:107], v5 offset:51200
v_mfma_f32_16x16x32_bf16 v[140:143], a[120:123], a[40:43], v[140:143]
ds_read_b128 a[108:111], v5 offset:52224
v_mfma_f32_16x16x32_bf16 v[156:159], a[120:123], a[44:47], v[156:159]
v_mfma_f32_16x16x32_bf16 v[160:163], a[124:127], a[44:47], v[160:163]
buffer_load_dwordx4 a[36:39], v4, s[40:43], s35 offen offset:1024 sc1
v_mfma_f32_16x16x32_bf16 v[144:147], a[124:127], a[40:43], v[144:147]
s_cmp_eq_u32 s3, 1
s_cselect_b32 s35, 25, 17
s_lshl_b32 s35, s35, 12
s_waitcnt vmcnt(8) lgkmcnt(0)
v_mfma_f32_16x16x32_bf16 v[132:135], a[96:99], a[0:3], v[132:135]
ds_read_b128 a[112:115], v5 offset:53248
v_mfma_f32_16x16x32_bf16 v[148:151], a[96:99], a[4:7], v[148:151]
ds_read_b128 a[116:119], v5 offset:54272
v_mfma_f32_16x16x32_bf16 v[152:155], a[100:103], a[4:7], v[152:155]
buffer_load_dwordx4 a[40:43], v4, s[40:43], s35 offen offset:0 sc1
v_mfma_f32_16x16x32_bf16 v[136:139], a[100:103], a[0:3], v[136:139]
ds_read_b128 a[120:123], v5 offset:55296
v_mfma_f32_16x16x32_bf16 v[140:143], a[104:107], a[0:3], v[140:143]
ds_read_b128 a[124:127], v5 offset:56320
v_mfma_f32_16x16x32_bf16 v[156:159], a[104:107], a[4:7], v[156:159]
v_mfma_f32_16x16x32_bf16 v[160:163], a[108:111], a[4:7], v[160:163]
buffer_load_dwordx4 a[44:47], v4, s[40:43], s35 offen offset:1024 sc1
v_mfma_f32_16x16x32_bf16 v[144:147], a[108:111], a[0:3], v[144:147]
s_cmp_eq_u32 s3, 2
s_cselect_b32 s35, 26, 18
s_lshl_b32 s35, s35, 12
s_waitcnt vmcnt(8) lgkmcnt(0)
v_mfma_f32_16x16x32_bf16 v[132:135], a[112:115], a[8:11], v[132:135]
ds_read_b128 a[96:99], v5 offset:57344
v_mfma_f32_16x16x32_bf16 v[148:151], a[112:115], a[12:15], v[148:151]
ds_read_b128 a[100:103], v5 offset:58368
v_mfma_f32_16x16x32_bf16 v[152:155], a[116:119], a[12:15], v[152:155]
buffer_load_dwordx4 a[0:3], v4, s[40:43], s35 offen offset:0 sc1
v_mfma_f32_16x16x32_bf16 v[136:139], a[116:119], a[8:11], v[136:139]
ds_read_b128 a[104:107], v5 offset:59392
v_mfma_f32_16x16x32_bf16 v[140:143], a[120:123], a[8:11], v[140:143]
ds_read_b128 a[108:111], v5 offset:60416
v_mfma_f32_16x16x32_bf16 v[156:159], a[120:123], a[12:15], v[156:159]
v_mfma_f32_16x16x32_bf16 v[160:163], a[124:127], a[12:15], v[160:163]
buffer_load_dwordx4 a[4:7], v4, s[40:43], s35 offen offset:1024 sc1
v_mfma_f32_16x16x32_bf16 v[144:147], a[124:127], a[8:11], v[144:147]
s_cmp_eq_u32 s3, 3
s_cselect_b32 s35, 27, 19
s_lshl_b32 s35, s35, 12
s_waitcnt vmcnt(8) lgkmcnt(0)
v_mfma_f32_16x16x32_bf16 v[132:135], a[96:99], a[16:19], v[132:135]
ds_read_b128 a[112:115], v5 offset:61440
v_mfma_f32_16x16x32_bf16 v[148:151], a[96:99], a[20:23], v[148:151]
ds_read_b128 a[116:119], v5 offset:62464
v_mfma_f32_16x16x32_bf16 v[152:155], a[100:103], a[20:23], v[152:155]
buffer_load_dwordx4 a[8:11], v4, s[40:43], s35 offen offset:0 sc1
v_mfma_f32_16x16x32_bf16 v[136:139], a[100:103], a[16:19], v[136:139]
ds_read_b128 a[120:123], v5 offset:63488
v_mfma_f32_16x16x32_bf16 v[140:143], a[104:107], a[16:19], v[140:143]
ds_read_b128 a[124:127], v5 offset:64512
v_mfma_f32_16x16x32_bf16 v[156:159], a[104:107], a[20:23], v[156:159]
v_mfma_f32_16x16x32_bf16 v[160:163], a[108:111], a[20:23], v[160:163]
buffer_load_dwordx4 a[12:15], v4, s[40:43], s35 offen offset:1024 sc1
v_mfma_f32_16x16x32_bf16 v[144:147], a[108:111], a[16:19], v[144:147]
s_cmp_eq_u32 s3, 4
s_cselect_b32 s35, 28, 20
s_lshl_b32 s35, s35, 12
s_waitcnt vmcnt(8) lgkmcnt(0)
v_mfma_f32_16x16x32_bf16 v[132:135], a[112:115], a[24:27], v[132:135]
ds_read_b128 a[96:99], v6 offset:0
v_mfma_f32_16x16x32_bf16 v[148:151], a[112:115], a[28:31], v[148:151]
ds_read_b128 a[100:103], v6 offset:1024
v_mfma_f32_16x16x32_bf16 v[152:155], a[116:119], a[28:31], v[152:155]
buffer_load_dwordx4 a[16:19], v4, s[40:43], s35 offen offset:0 sc1
v_mfma_f32_16x16x32_bf16 v[136:139], a[116:119], a[24:27], v[136:139]
ds_read_b128 a[104:107], v6 offset:2048
v_mfma_f32_16x16x32_bf16 v[140:143], a[120:123], a[24:27], v[140:143]
ds_read_b128 a[108:111], v6 offset:3072
v_mfma_f32_16x16x32_bf16 v[156:159], a[120:123], a[28:31], v[156:159]
v_mfma_f32_16x16x32_bf16 v[160:163], a[124:127], a[28:31], v[160:163]
buffer_load_dwordx4 a[20:23], v4, s[40:43], s35 offen offset:1024 sc1
v_mfma_f32_16x16x32_bf16 v[144:147], a[124:127], a[24:27], v[144:147]
s_cmp_eq_u32 s3, 5
s_cselect_b32 s35, 29, 21
s_lshl_b32 s35, s35, 12
s_waitcnt vmcnt(8) lgkmcnt(0)
v_mfma_f32_16x16x32_bf16 v[132:135], a[96:99], a[32:35], v[132:135]
ds_read_b128 a[112:115], v6 offset:4096
v_mfma_f32_16x16x32_bf16 v[148:151], a[96:99], a[36:39], v[148:151]
ds_read_b128 a[116:119], v6 offset:5120
v_mfma_f32_16x16x32_bf16 v[152:155], a[100:103], a[36:39], v[152:155]
buffer_load_dwordx4 a[24:27], v4, s[40:43], s35 offen offset:0 sc1
v_mfma_f32_16x16x32_bf16 v[136:139], a[100:103], a[32:35], v[136:139]
ds_read_b128 a[120:123], v6 offset:6144
v_mfma_f32_16x16x32_bf16 v[140:143], a[104:107], a[32:35], v[140:143]
ds_read_b128 a[124:127], v6 offset:7168
v_mfma_f32_16x16x32_bf16 v[156:159], a[104:107], a[36:39], v[156:159]
v_mfma_f32_16x16x32_bf16 v[160:163], a[108:111], a[36:39], v[160:163]
buffer_load_dwordx4 a[28:31], v4, s[40:43], s35 offen offset:1024 sc1
v_mfma_f32_16x16x32_bf16 v[144:147], a[108:111], a[32:35], v[144:147]
s_cmp_eq_u32 s3, 6
s_cselect_b32 s35, 30, 22
s_lshl_b32 s35, s35, 12
s_waitcnt vmcnt(8) lgkmcnt(0)
v_mfma_f32_16x16x32_bf16 v[132:135], a[112:115], a[40:43], v[132:135]
ds_read_b128 a[96:99], v6 offset:8192
v_mfma_f32_16x16x32_bf16 v[148:151], a[112:115], a[44:47], v[148:151]
ds_read_b128 a[100:103], v6 offset:9216
v_mfma_f32_16x16x32_bf16 v[152:155], a[116:119], a[44:47], v[152:155]
buffer_load_dwordx4 a[32:35], v4, s[40:43], s35 offen offset:0 sc1
v_mfma_f32_16x16x32_bf16 v[136:139], a[116:119], a[40:43], v[136:139]
ds_read_b128 a[104:107], v6 offset:10240
v_mfma_f32_16x16x32_bf16 v[140:143], a[120:123], a[40:43], v[140:143]
ds_read_b128 a[108:111], v6 offset:11264
v_mfma_f32_16x16x32_bf16 v[156:159], a[120:123], a[44:47], v[156:159]
v_mfma_f32_16x16x32_bf16 v[160:163], a[124:127], a[44:47], v[160:163]
buffer_load_dwordx4 a[36:39], v4, s[40:43], s35 offen offset:1024 sc1
v_mfma_f32_16x16x32_bf16 v[144:147], a[124:127], a[40:43], v[144:147]
s_cmp_eq_u32 s3, 7
s_cselect_b32 s35, 31, 23
s_lshl_b32 s35, s35, 12
s_waitcnt vmcnt(8) lgkmcnt(0)
v_mfma_f32_16x16x32_bf16 v[132:135], a[96:99], a[0:3], v[132:135]
ds_read_b128 a[112:115], v6 offset:12288
v_mfma_f32_16x16x32_bf16 v[148:151], a[96:99], a[4:7], v[148:151]
ds_read_b128 a[116:119], v6 offset:13312
v_mfma_f32_16x16x32_bf16 v[152:155], a[100:103], a[4:7], v[152:155]
buffer_load_dwordx4 a[40:43], v4, s[40:43], s35 offen offset:0 sc1
v_mfma_f32_16x16x32_bf16 v[136:139], a[100:103], a[0:3], v[136:139]
ds_read_b128 a[120:123], v6 offset:14336
v_mfma_f32_16x16x32_bf16 v[140:143], a[104:107], a[0:3], v[140:143]
ds_read_b128 a[124:127], v6 offset:15360
v_mfma_f32_16x16x32_bf16 v[156:159], a[104:107], a[4:7], v[156:159]
v_mfma_f32_16x16x32_bf16 v[160:163], a[108:111], a[4:7], v[160:163]
buffer_load_dwordx4 a[44:47], v4, s[40:43], s35 offen offset:1024 sc1
v_mfma_f32_16x16x32_bf16 v[144:147], a[108:111], a[0:3], v[144:147]
s_cmp_eq_u32 s3, 0
s_cselect_b32 s35, 0, 24
s_lshl_b32 s35, s35, 12
s_waitcnt vmcnt(8) lgkmcnt(0)
v_mfma_f32_16x16x32_bf16 v[132:135], a[112:115], a[8:11], v[132:135]
ds_read_b128 a[96:99], v6 offset:16384
v_mfma_f32_16x16x32_bf16 v[148:151], a[112:115], a[12:15], v[148:151]
ds_read_b128 a[100:103], v6 offset:17408
v_mfma_f32_16x16x32_bf16 v[152:155], a[116:119], a[12:15], v[152:155]
buffer_load_dwordx4 a[0:3], v4, s[40:43], s35 offen offset:0 sc1
v_mfma_f32_16x16x32_bf16 v[136:139], a[116:119], a[8:11], v[136:139]
ds_read_b128 a[104:107], v6 offset:18432
v_mfma_f32_16x16x32_bf16 v[140:143], a[120:123], a[8:11], v[140:143]
ds_read_b128 a[108:111], v6 offset:19456
v_mfma_f32_16x16x32_bf16 v[156:159], a[120:123], a[12:15], v[156:159]
v_mfma_f32_16x16x32_bf16 v[160:163], a[124:127], a[12:15], v[160:163]
buffer_load_dwordx4 a[4:7], v4, s[40:43], s35 offen offset:1024 sc1
v_mfma_f32_16x16x32_bf16 v[144:147], a[124:127], a[8:11], v[144:147]
s_cmp_eq_u32 s3, 1
s_cselect_b32 s35, 1, 25
s_lshl_b32 s35, s35, 12
s_waitcnt vmcnt(8) lgkmcnt(0)
v_mfma_f32_16x16x32_bf16 v[132:135], a[96:99], a[16:19], v[132:135]
ds_read_b128 a[112:115], v6 offset:20480
v_mfma_f32_16x16x32_bf16 v[148:151], a[96:99], a[20:23], v[148:151]
ds_read_b128 a[116:119], v6 offset:21504
v_mfma_f32_16x16x32_bf16 v[152:155], a[100:103], a[20:23], v[152:155]
buffer_load_dwordx4 a[8:11], v4, s[40:43], s35 offen offset:0 sc1
v_mfma_f32_16x16x32_bf16 v[136:139], a[100:103], a[16:19], v[136:139]
ds_read_b128 a[120:123], v6 offset:22528
v_mfma_f32_16x16x32_bf16 v[140:143], a[104:107], a[16:19], v[140:143]
ds_read_b128 a[124:127], v6 offset:23552
v_mfma_f32_16x16x32_bf16 v[156:159], a[104:107], a[20:23], v[156:159]
v_mfma_f32_16x16x32_bf16 v[160:163], a[108:111], a[20:23], v[160:163]
buffer_load_dwordx4 a[12:15], v4, s[40:43], s35 offen offset:1024 sc1
v_mfma_f32_16x16x32_bf16 v[144:147], a[108:111], a[16:19], v[144:147]
s_cmp_eq_u32 s3, 2
s_cselect_b32 s35, 2, 26
s_lshl_b32 s35, s35, 12
s_waitcnt vmcnt(8) lgkmcnt(0)
v_mfma_f32_16x16x32_bf16 v[132:135], a[112:115], a[24:27], v[132:135]
ds_read_b128 a[96:99], v6 offset:24576
v_mfma_f32_16x16x32_bf16 v[148:151], a[112:115], a[28:31], v[148:151]
ds_read_b128 a[100:103], v6 offset:25600
v_mfma_f32_16x16x32_bf16 v[152:155], a[116:119], a[28:31], v[152:155]
buffer_load_dwordx4 a[16:19], v4, s[40:43], s35 offen offset:0 sc1
v_mfma_f32_16x16x32_bf16 v[136:139], a[116:119], a[24:27], v[136:139]
ds_read_b128 a[104:107], v6 offset:26624
v_mfma_f32_16x16x32_bf16 v[140:143], a[120:123], a[24:27], v[140:143]
ds_read_b128 a[108:111], v6 offset:27648
v_mfma_f32_16x16x32_bf16 v[156:159], a[120:123], a[28:31], v[156:159]
v_mfma_f32_16x16x32_bf16 v[160:163], a[124:127], a[28:31], v[160:163]
buffer_load_dwordx4 a[20:23], v4, s[40:43], s35 offen offset:1024 sc1
v_mfma_f32_16x16x32_bf16 v[144:147], a[124:127], a[24:27], v[144:147]
s_cmp_eq_u32 s3, 3
s_cselect_b32 s35, 3, 27
s_lshl_b32 s35, s35, 12
s_waitcnt vmcnt(8) lgkmcnt(0)
v_mfma_f32_16x16x32_bf16 v[132:135], a[96:99], a[32:35], v[132:135]
ds_read_b128 a[112:115], v6 offset:28672
v_mfma_f32_16x16x32_bf16 v[148:151], a[96:99], a[36:39], v[148:151]
ds_read_b128 a[116:119], v6 offset:29696
v_mfma_f32_16x16x32_bf16 v[152:155], a[100:103], a[36:39], v[152:155]
buffer_load_dwordx4 a[24:27], v4, s[40:43], s35 offen offset:0 sc1
v_mfma_f32_16x16x32_bf16 v[136:139], a[100:103], a[32:35], v[136:139]
ds_read_b128 a[120:123], v6 offset:30720
v_mfma_f32_16x16x32_bf16 v[140:143], a[104:107], a[32:35], v[140:143]
ds_read_b128 a[124:127], v6 offset:31744
v_mfma_f32_16x16x32_bf16 v[156:159], a[104:107], a[36:39], v[156:159]
v_mfma_f32_16x16x32_bf16 v[160:163], a[108:111], a[36:39], v[160:163]
buffer_load_dwordx4 a[28:31], v4, s[40:43], s35 offen offset:1024 sc1
v_mfma_f32_16x16x32_bf16 v[144:147], a[108:111], a[32:35], v[144:147]
s_cmp_eq_u32 s3, 4
s_cselect_b32 s35, 4, 28
s_lshl_b32 s35, s35, 12
s_waitcnt vmcnt(8) lgkmcnt(0)
v_mfma_f32_16x16x32_bf16 v[132:135], a[112:115], a[40:43], v[132:135]
ds_read_b128 a[96:99], v6 offset:32768
v_mfma_f32_16x16x32_bf16 v[148:151], a[112:115], a[44:47], v[148:151]
ds_read_b128 a[100:103], v6 offset:33792
v_mfma_f32_16x16x32_bf16 v[152:155], a[116:119], a[44:47], v[152:155]
buffer_load_dwordx4 a[32:35], v4, s[40:43], s35 offen offset:0 sc1
v_mfma_f32_16x16x32_bf16 v[136:139], a[116:119], a[40:43], v[136:139]
ds_read_b128 a[104:107], v6 offset:34816
v_mfma_f32_16x16x32_bf16 v[140:143], a[120:123], a[40:43], v[140:143]
ds_read_b128 a[108:111], v6 offset:35840
v_mfma_f32_16x16x32_bf16 v[156:159], a[120:123], a[44:47], v[156:159]
v_mfma_f32_16x16x32_bf16 v[160:163], a[124:127], a[44:47], v[160:163]
buffer_load_dwordx4 a[36:39], v4, s[40:43], s35 offen offset:1024 sc1
v_mfma_f32_16x16x32_bf16 v[144:147], a[124:127], a[40:43], v[144:147]
s_cmp_eq_u32 s3, 5
s_cselect_b32 s35, 5, 29
s_lshl_b32 s35, s35, 12
s_waitcnt vmcnt(8) lgkmcnt(0)
v_mfma_f32_16x16x32_bf16 v[132:135], a[96:99], a[0:3], v[132:135]
ds_read_b128 a[112:115], v6 offset:36864
v_mfma_f32_16x16x32_bf16 v[148:151], a[96:99], a[4:7], v[148:151]
ds_read_b128 a[116:119], v6 offset:37888
v_mfma_f32_16x16x32_bf16 v[152:155], a[100:103], a[4:7], v[152:155]
buffer_load_dwordx4 a[40:43], v4, s[40:43], s35 offen offset:0 sc1
v_mfma_f32_16x16x32_bf16 v[136:139], a[100:103], a[0:3], v[136:139]
ds_read_b128 a[120:123], v6 offset:38912
v_mfma_f32_16x16x32_bf16 v[140:143], a[104:107], a[0:3], v[140:143]
ds_read_b128 a[124:127], v6 offset:39936
v_mfma_f32_16x16x32_bf16 v[156:159], a[104:107], a[4:7], v[156:159]
v_mfma_f32_16x16x32_bf16 v[160:163], a[108:111], a[4:7], v[160:163]
buffer_load_dwordx4 a[44:47], v4, s[40:43], s35 offen offset:1024 sc1
v_mfma_f32_16x16x32_bf16 v[144:147], a[108:111], a[0:3], v[144:147]
s_cmp_eq_u32 s3, 6
s_cselect_b32 s35, 6, 30
s_lshl_b32 s35, s35, 12
s_waitcnt vmcnt(8) lgkmcnt(0)
v_mfma_f32_16x16x32_bf16 v[132:135], a[112:115], a[8:11], v[132:135]
ds_read_b128 a[96:99], v6 offset:40960
v_mfma_f32_16x16x32_bf16 v[148:151], a[112:115], a[12:15], v[148:151]
ds_read_b128 a[100:103], v6 offset:41984
v_mfma_f32_16x16x32_bf16 v[152:155], a[116:119], a[12:15], v[152:155]
buffer_load_dwordx4 a[0:3], v4, s[40:43], s35 offen offset:0 sc1
v_mfma_f32_16x16x32_bf16 v[136:139], a[116:119], a[8:11], v[136:139]
ds_read_b128 a[104:107], v6 offset:43008
v_mfma_f32_16x16x32_bf16 v[140:143], a[120:123], a[8:11], v[140:143]
ds_read_b128 a[108:111], v6 offset:44032
v_mfma_f32_16x16x32_bf16 v[156:159], a[120:123], a[12:15], v[156:159]
v_mfma_f32_16x16x32_bf16 v[160:163], a[124:127], a[12:15], v[160:163]
buffer_load_dwordx4 a[4:7], v4, s[40:43], s35 offen offset:1024 sc1
v_mfma_f32_16x16x32_bf16 v[144:147], a[124:127], a[8:11], v[144:147]
s_cmp_eq_u32 s3, 7
s_cselect_b32 s35, 7, 31
s_lshl_b32 s35, s35, 12
s_waitcnt vmcnt(8) lgkmcnt(0)
v_mfma_f32_16x16x32_bf16 v[132:135], a[96:99], a[16:19], v[132:135]
ds_read_b128 a[112:115], v6 offset:45056
v_mfma_f32_16x16x32_bf16 v[148:151], a[96:99], a[20:23], v[148:151]
ds_read_b128 a[116:119], v6 offset:46080
v_mfma_f32_16x16x32_bf16 v[152:155], a[100:103], a[20:23], v[152:155]
buffer_load_dwordx4 a[8:11], v4, s[40:43], s35 offen offset:0 sc1
v_mfma_f32_16x16x32_bf16 v[136:139], a[100:103], a[16:19], v[136:139]
ds_read_b128 a[120:123], v6 offset:47104
v_mfma_f32_16x16x32_bf16 v[140:143], a[104:107], a[16:19], v[140:143]
ds_read_b128 a[124:127], v6 offset:48128
v_mfma_f32_16x16x32_bf16 v[156:159], a[104:107], a[20:23], v[156:159]
v_mfma_f32_16x16x32_bf16 v[160:163], a[108:111], a[20:23], v[160:163]
buffer_load_dwordx4 a[12:15], v4, s[40:43], s35 offen offset:1024 sc1
v_mfma_f32_16x16x32_bf16 v[144:147], a[108:111], a[16:19], v[144:147]
s_waitcnt vmcnt(8) lgkmcnt(0)
v_mfma_f32_16x16x32_bf16 v[132:135], a[112:115], a[24:27], v[132:135]
ds_read_b128 a[96:99], v6 offset:49152
v_mfma_f32_16x16x32_bf16 v[148:151], a[112:115], a[28:31], v[148:151]
ds_read_b128 a[100:103], v6 offset:50176
v_mfma_f32_16x16x32_bf16 v[152:155], a[116:119], a[28:31], v[152:155]
ds_read_b128 a[104:107], v6 offset:51200
v_mfma_f32_16x16x32_bf16 v[136:139], a[116:119], a[24:27], v[136:139]
ds_read_b128 a[108:111], v6 offset:52224
v_mfma_f32_16x16x32_bf16 v[140:143], a[120:123], a[24:27], v[140:143]
v_mfma_f32_16x16x32_bf16 v[156:159], a[120:123], a[28:31], v[156:159]
v_mfma_f32_16x16x32_bf16 v[160:163], a[124:127], a[28:31], v[160:163]
v_mfma_f32_16x16x32_bf16 v[144:147], a[124:127], a[24:27], v[144:147]
s_waitcnt vmcnt(6) lgkmcnt(0)
v_mfma_f32_16x16x32_bf16 v[132:135], a[96:99], a[32:35], v[132:135]
ds_read_b128 a[112:115], v6 offset:53248
v_mfma_f32_16x16x32_bf16 v[148:151], a[96:99], a[36:39], v[148:151]
ds_read_b128 a[116:119], v6 offset:54272
v_mfma_f32_16x16x32_bf16 v[152:155], a[100:103], a[36:39], v[152:155]
ds_read_b128 a[120:123], v6 offset:55296
v_mfma_f32_16x16x32_bf16 v[136:139], a[100:103], a[32:35], v[136:139]
ds_read_b128 a[124:127], v6 offset:56320
v_mfma_f32_16x16x32_bf16 v[140:143], a[104:107], a[32:35], v[140:143]
v_mfma_f32_16x16x32_bf16 v[156:159], a[104:107], a[36:39], v[156:159]
v_mfma_f32_16x16x32_bf16 v[160:163], a[108:111], a[36:39], v[160:163]
v_mfma_f32_16x16x32_bf16 v[144:147], a[108:111], a[32:35], v[144:147]
s_waitcnt vmcnt(4) lgkmcnt(0)
v_mfma_f32_16x16x32_bf16 v[132:135], a[112:115], a[40:43], v[132:135]
ds_read_b128 a[96:99], v6 offset:57344
v_mfma_f32_16x16x32_bf16 v[148:151], a[112:115], a[44:47], v[148:151]
ds_read_b128 a[100:103], v6 offset:58368
v_mfma_f32_16x16x32_bf16 v[152:155], a[116:119], a[44:47], v[152:155]
ds_read_b128 a[104:107], v6 offset:59392
v_mfma_f32_16x16x32_bf16 v[136:139], a[116:119], a[40:43], v[136:139]
ds_read_b128 a[108:111], v6 offset:60416
v_mfma_f32_16x16x32_bf16 v[140:143], a[120:123], a[40:43], v[140:143]
v_mfma_f32_16x16x32_bf16 v[156:159], a[120:123], a[44:47], v[156:159]
v_mfma_f32_16x16x32_bf16 v[160:163], a[124:127], a[44:47], v[160:163]
v_mfma_f32_16x16x32_bf16 v[144:147], a[124:127], a[40:43], v[144:147]
s_waitcnt vmcnt(2) lgkmcnt(0)
v_mfma_f32_16x16x32_bf16 v[132:135], a[96:99], a[0:3], v[132:135]
ds_read_b128 a[112:115], v6 offset:61440
v_mfma_f32_16x16x32_bf16 v[148:151], a[96:99], a[4:7], v[148:151]
ds_read_b128 a[116:119], v6 offset:62464
v_mfma_f32_16x16x32_bf16 v[152:155], a[100:103], a[4:7], v[152:155]
ds_read_b128 a[120:123], v6 offset:63488
v_mfma_f32_16x16x32_bf16 v[136:139], a[100:103], a[0:3], v[136:139]
ds_read_b128 a[124:127], v6 offset:64512
v_mfma_f32_16x16x32_bf16 v[140:143], a[104:107], a[0:3], v[140:143]
v_mfma_f32_16x16x32_bf16 v[156:159], a[104:107], a[4:7], v[156:159]
v_mfma_f32_16x16x32_bf16 v[160:163], a[108:111], a[4:7], v[160:163]
v_mfma_f32_16x16x32_bf16 v[144:147], a[108:111], a[0:3], v[144:147]
s_waitcnt vmcnt(0) lgkmcnt(0)
v_mfma_f32_16x16x32_bf16 v[132:135], a[112:115], a[8:11], v[132:135]
v_mfma_f32_16x16x32_bf16 v[148:151], a[112:115], a[12:15], v[148:151]
v_mfma_f32_16x16x32_bf16 v[152:155], a[116:119], a[12:15], v[152:155]
v_mfma_f32_16x16x32_bf16 v[136:139], a[116:119], a[8:11], v[136:139]
v_mfma_f32_16x16x32_bf16 v[140:143], a[120:123], a[8:11], v[140:143]
v_mfma_f32_16x16x32_bf16 v[156:159], a[120:123], a[12:15], v[156:159]
v_mfma_f32_16x16x32_bf16 v[160:163], a[124:127], a[12:15], v[160:163]
v_mfma_f32_16x16x32_bf16 v[144:147], a[124:127], a[8:11], v[144:147]
s_nop 0
v_cvt_pk_bf16_f32 v32, v132, v133
v_cvt_pk_bf16_f32 v33, v134, v135
s_nop 0
v_cvt_pk_bf16_f32 v34, v136, v137
v_cvt_pk_bf16_f32 v35, v138, v139
v_cvt_pk_bf16_f32 v36, v140, v141
v_cvt_pk_bf16_f32 v37, v142, v143
v_cvt_pk_bf16_f32 v38, v144, v145
v_cvt_pk_bf16_f32 v39, v146, v147
v_cvt_pk_bf16_f32 v40, v148, v149
v_cvt_pk_bf16_f32 v41, v150, v151
v_cvt_pk_bf16_f32 v42, v152, v153
v_cvt_pk_bf16_f32 v43, v154, v155
v_cvt_pk_bf16_f32 v44, v156, v157
v_cvt_pk_bf16_f32 v45, v158, v159
v_cvt_pk_bf16_f32 v46, v160, v161
v_cvt_pk_bf16_f32 v47, v162, v163
v_lshrrev_b32 v233, 4, v0
v_and_b32 v234, 15, v0
s_and_b32 s36, s31, 7
s_lshl_b32 s36, s36, 7
s_lshl_b32 s37, s28, 5
s_add_u32 s36, s36, s37
s_lshl_b32 s36, s36, 1
s_lshr_b32 s37, s31, 3
s_add_u32 s36, s36, s37
s_lshl_b32 s36, s36, 11
s_lshl_b32 s37, s32, 7
s_add_u32 s36, s36, s37
v_lshl_add_u32 v232, v234, 12, s36
v_lshl_add_u32 v232, v233, 4, v232
s_mov_b32 s36, 0x10000
buffer_store_dwordx4 v[32:35], v232, s[12:15], 0 offen offset:0
buffer_store_dwordx4 v[36:39], v232, s[12:15], 0 offen offset:64
buffer_store_dwordx4 v[40:43], v232, s[12:15], s36 offen offset:0
buffer_store_dwordx4 v[44:47], v232, s[12:15], s36 offen offset:64
s_or_b32 s36, s2, s28
s_cbranch_scc1 Lep_32
s_mov_b32 s36, 0xf0000
buffer_store_dword a242, off, s[4:7], s36 sc1
Lep_32:
L_end:
s_endpgm
L_code_end:
.section .rodata,"a"
.p2align 6
.amdhsa_kernel interleave_layers__sliding_local_dilated__linear_kernel_hedgehog__prompt_kernel
  .amdhsa_next_free_vgpr 512
  .amdhsa_next_free_sgpr 102
  .amdhsa_accum_offset 256
  .amdhsa_group_segment_fixed_size 0
  .amdhsa_kernarg_size 80
  .amdhsa_user_sgpr_count 2
  .amdhsa_user_sgpr_kernarg_segment_ptr 1
  .amdhsa_system_sgpr_workgroup_id_x 1
.end_amdhsa_kernel
```

```asm
; @launch grid=(256,1,1) block=(256,1,1) lds=163840
.amdgcn_target "amdgcn-amd-amdhsa--gfx950"
.text
.globl interleave_layers__sliding_local_dilated__linear_kernel_hedgehog__prompt_kernel
.p2align 8
.type interleave_layers__sliding_local_dilated__linear_kernel_hedgehog__prompt_kernel,@function
interleave_layers__sliding_local_dilated__linear_kernel_hedgehog__prompt_kernel:
s_cmp_ge_u32 s2, 256
s_cbranch_scc1 L_end
s_load_dwordx16 s[64:79], s[0:1], 0
s_load_dwordx4 s[80:83], s[0:1], 64
s_getpc_b64 s[24:25]
s_mov_b32 s26, (L_end - interleave_layers__sliding_local_dilated__linear_kernel_hedgehog__prompt_kernel - 64)
s_mov_b32 s27, 0x20000
v_lshlrev_b32 v1, 5, v0
buffer_load_dword v238, v1, s[24:27], 0 offen
v_lshrrev_b32 v1, 6, v0
v_and_b32 v0, 63, v0
v_readfirstlane_b32 s28, v1
s_and_b32 s36, s2, 7
s_lshr_b32 s37, s2, 3
s_and_b32 s38, s37, 3
s_lshr_b32 s39, s37, 2
s_and_b32 s29, s36, 1
s_lshl_b32 s32, s29, 3
s_lshl_b32 s29, s29, 2
s_add_u32 s29, s29, s38
s_add_u32 s32, s32, s39
s_lshr_b32 s36, s36, 1
s_lshl_b32 s30, s36, 3
s_add_u32 s30, s30, s39
s_lshl_b32 s31, s36, 2
s_add_u32 s31, s31, s38
s_and_b32 s32, s36, 1
s_lshl_b32 s32, s32, 3
s_add_u32 s32, s32, s39
s_and_b32 s31, s2, 1
s_lshl_b32 s31, s31, 3
s_add_u32 s31, s31, s38
s_and_b32 s3, s2, 4
s_add_u32 s31, s31, s3
s_mov_b32 s3, s39
s_and_b32 s35, s2, 7
s_lshl_b32 s35, s35, 5
s_add_u32 s35, s35, s37
s_mul_i32 s33, s39, 0
s_and_b32 s33, s33, 31
s_mul_i32 s34, s39, 16
s_and_b32 s34, s34, 31
v_lshlrev_b32 v1, 4, v0
v_lshrrev_b32 v233, 4, v0
v_and_b32 v234, 15, v0
s_and_b32 s88, s31, 7
s_lshl_b32 s88, s88, 7
s_lshl_b32 s37, s28, 5
s_add_u32 s88, s88, s37
s_lshl_b32 s88, s88, 1
s_lshr_b32 s37, s31, 3
s_add_u32 s88, s88, s37
s_lshl_b32 s88, s88, 11
s_lshl_b32 s37, s32, 7
s_add_u32 s88, s88, s37
v_lshrrev_b32 v235, 3, v0
v_and_b32 v236, 7, v0
v_xor_b32 v232, v236, v233
v_lshlrev_b32 v232, 4, v232
v_lshl_add_u32 v232, v235, 12, v232
v_xor_b32 v246, 64, v232
v_lshlrev_b32 v236, 4, v236
v_lshl_add_u32 v237, v235, 11, v236
v_mul_u32_u24 v235, 6144, v235
v_add_u32 v235, v235, v236
s_lshr_b32 s36, s35, 4
s_lshl_b32 s36, s36, 2
s_add_u32 s36, s36, s28
s_mul_i32 s36, s36, 98304
s_and_b32 s37, s35, 15
s_lshl_b32 s37, s37, 7
s_add_u32 s36, s36, s37
s_lshl_b32 s37, s28, 11
s_mov_b32 s39, 0x10000
s_mov_b32 s10, 0x400000
s_mov_b32 s11, 0x20000
s_mov_b32 s22, 0x600000
s_mov_b32 s23, 0x20000
s_mov_b32 s6, 0x10000000
s_mov_b32 s7, 0x20000
s_mov_b32 s44, 0xf0000
s_waitcnt lgkmcnt(0)
s_mov_b64 s[8:9], s[64:65]
s_mov_b64 s[20:21], s[66:67]
s_add_u32 m0, s37, 0
s_add_u32 s38, s36, 0
buffer_load_dwordx4 v235, s[20:23], s38 offen nt lds
s_add_u32 m0, s37, 1024
s_add_u32 s38, s36, 49152
buffer_load_dwordx4 v235, s[20:23], s38 offen nt lds
s_add_u32 m0, s37, 8192
s_add_u32 s38, s36, 2048
buffer_load_dwordx4 v235, s[20:23], s38 offen nt lds
s_add_u32 m0, s37, 9216
s_add_u32 s38, s36, 51200
buffer_load_dwordx4 v235, s[20:23], s38 offen nt lds
s_add_u32 m0, s37, 16384
s_add_u32 s38, s36, 4096
buffer_load_dwordx4 v235, s[20:23], s38 offen nt lds
s_add_u32 m0, s37, 17408
s_add_u32 s38, s36, 53248
buffer_load_dwordx4 v235, s[20:23], s38 offen nt lds
s_lshl_b32 s37, s37, 1
s_add_u32 m0, s37, 24576
s_add_u32 s38, s88, 0
buffer_load_dwordx4 v232, s[8:11], s38 offen nt lds
s_add_u32 m0, s37, 25600
s_add_u32 s38, s88, 32768
buffer_load_dwordx4 v246, s[8:11], s38 offen nt lds
s_add_u32 m0, s37, 26624
s_add_u32 s38, s88, 65536
buffer_load_dwordx4 v232, s[8:11], s38 offen nt lds
s_add_u32 m0, s37, 27648
s_add_u32 s38, s88, 98304
buffer_load_dwordx4 v246, s[8:11], s38 offen nt lds
v_lshrrev_b32 v232, 1, v234
v_xor_b32 v232, v232, v233
v_lshlrev_b32 v232, 4, v232
v_lshl_add_u32 v232, v234, 7, v232
v_add_u32 v232, s37, v232
s_add_u32 s4, s82, 0x0
s_addc_u32 s5, s83, 0
buffer_load_dword v11, off, s[4:7], s44 sc1
s_lshr_b32 s36, s2, 3
s_lshl_b32 s36, s36, 2
s_add_u32 s36, s36, s28
s_lshl_b32 s36, s36, 10
buffer_load_dwordx4 a[0:3], v1, s[24:27], s36 offen
s_mov_b32 s12, s78
s_mov_b32 s13, s79
s_mov_b32 s14, 0x400000
s_mov_b32 s15, 0x20000
s_mov_b32 s42, 0x400000
s_mov_b32 s43, 0x20000
v_mov_b32 v12, 1
s_mov_b64 s[40:41], s[12:13]
s_mov_b32 s64, 0xff
s_mov_b32 s65, 0
s_and_b32 s81, s29, 3
s_lshl_b32 s66, s31, 4
s_add_u32 s66, s66, s32
s_lshl_b32 s66, s66, 8
s_lshl_b32 s67, s29, 5
s_add_u32 s67, s67, s30
s_lshl_b32 s67, s67, 8
s_lshl_b32 s80, s30, 11
s_lshl_b32 s70, s29, 8
s_add_u32 s70, s70, s80
s_lshl_b32 s71, s29, 13
s_lshr_b32 s78, s31, 1
s_lshl_b32 s78, s78, 13
s_add_u32 s79, s78, 8192
s_bitcmp1_b32 s31, 0
s_cselect_b32 s79, s79, 0x40000000
s_and_b32 s36, s31, 7
s_cmp_eq_u32 s36, 7
s_cselect_b32 s79, 0x40000000, s79
v_mov_b32 v240, 0
v_mov_b32 v241, 0
v_mov_b32 v242, 0
v_mov_b32 v243, 0
v_lshlrev_b32 v239, 16, v233
v_lshl_add_u32 v239, v234, 4, v239
s_cmp_eq_u32 s28, 0
s_cselect_b32 s36, s66, s67
s_cmp_eq_u32 s28, 2
s_cselect_b32 s36, s70, s36
s_lshl_b32 s37, s28, 18
s_add_u32 s36, s36, s37
s_cmp_eq_u32 s28, 3
s_cselect_b32 s36, 0x40000000, s36
buffer_store_dwordx4 v[240:243], v239, s[4:7], s36 offen sc1
s_add_u32 s36, s67, 0xc0000
s_add_u32 s37, s66, 0xd0000
s_cmp_eq_u32 s28, 2
s_cselect_b32 s36, s37, s36
s_cmp_eq_u32 s28, 1
s_cselect_b32 s37, 128, 0
s_add_u32 s36, s36, s37
s_cmp_eq_u32 s28, 3
s_cselect_b32 s37, 0x20000, 0
s_add_u32 s36, s36, s37
s_mov_b64 exec, 1
buffer_atomic_add v240, off, s[4:7], s36 sc1
s_mov_b64 exec, -1
v_mov_b32 v228, v235
v_mov_b32 v229, v237
s_lshr_b32 s36, s35, 4
s_lshl_b32 s36, s36, 2
s_add_u32 s36, s36, s28
s_and_b32 s37, s35, 15
s_lshl_b32 s37, s37, 7
s_lshl_b32 s16, s36, 15
s_add_u32 s16, s16, s37
s_mul_i32 s17, s36, 98304
s_add_u32 s17, s17, s37
s_mov_b64 s[20:21], s[68:69]
s_mov_b32 s22, 0x200000
s_lshl_b32 s37, s28, 11
s_add_u32 m0, s37, 147456
s_add_u32 s36, s16, 0
buffer_load_dwordx4 v229, s[20:23], s36 offen nt lds
s_add_u32 m0, s37, 148480
s_add_u32 s36, s16, 16384
buffer_load_dwordx4 v229, s[20:23], s36 offen nt lds
s_mov_b64 s[20:21], s[74:75]
s_mov_b32 s22, 0x10000
s_and_b32 s36, s28, 1
s_lshl_b32 s36, s36, 10
s_add_u32 m0, s36, 155648
s_lshl_b32 s37, s30, 11
s_add_u32 s36, s36, s37
buffer_load_dwordx4 v1, s[20:23], s36 offen lds
v_mov_b32 v16, 0x3f803f80
v_mov_b32 v17, 0x3f803f80
v_mov_b32 v18, 0x3f803f80
v_mov_b32 v19, 0x3f803f80
s_mov_b32 s46, 0xaaaaaaaa
s_mov_b32 s47, 0xaaaaaaaa
s_mov_b32 s48, 0xcccccccc
s_mov_b32 s49, 0xcccccccc
s_lshl_b32 s36, s31, 1
s_lshr_b32 s37, s28, 1
s_add_u32 s36, s36, s37
s_lshl_b32 s36, s36, 17
s_and_b32 s37, s28, 1
s_lshl_b32 s37, s37, 11
s_add_u32 s36, s36, s37
v_add_u32 v4, s36, v1
s_lshl_b32 s38, s31, 2
s_add_u32 s38, s38, s28
s_lshl_b32 s38, s38, 12
s_lshl_b32 s39, s32, 7
s_add_u32 s38, s38, s39
v_lshrrev_b32 v244, 2, v234
v_cmp_eq_u32 vcc, v244, v233
v_and_b32 v244, 7, v234
v_lshl_add_u32 v244, v244, 4, s38
v_and_b32 v245, 8, v234
v_add_u32 v244, v244, v245
v_cndmask_b32 v253, 2.0, v244, vcc
v_lshlrev_b32 v244, 4, v233
v_lshl_add_u32 v244, v234, 6, v244
v_cmp_gt_u32 vcc, 2, v234
s_nop 1
v_cndmask_b32 v254, 2.0, v244, vcc
v_lshrrev_b32 v248, 4, v0
v_lshlrev_b32 v248, 10, v248
v_bfe_u32 v249, v0, 2, 2
v_lshl_add_u32 v248, v249, 7, v248
v_and_b32 v251, 3, v0
v_lshl_add_u32 v248, v251, 3, v248
s_lshr_b32 s36, s28, 1
s_lshl_b32 s36, s36, 6
s_and_b32 s37, s28, 1
s_mul_i32 s38, s37, 8224
s_add_u32 s38, s38, s36
s_mul_i32 s39, s37, 16352
s_add_u32 s39, s39, s36
v_add_u32 v249, s39, v248
v_add_u32 v248, s38, v248
s_and_b32 s38, s35, 15
s_lshl_b32 s38, s38, 1
s_lshr_b32 s36, s28, 1
s_add_u32 s38, s38, s36
s_lshr_b32 s36, s35, 4
s_mul_i32 s96, s38, 196608
s_mul_i32 s44, s36, 12288
s_add_u32 s96, s96, s44
s_mul_i32 s44, s37, 3072
s_add_u32 s96, s96, s44
s_add_u32 s96, s96, 0xe00000
s_add_u32 s97, s96, 6144
s_mul_i32 s38, s38, 6
s_mul_i32 s37, s37, 3
s_add_u32 s38, s38, s37
s_lshl_b32 s38, s38, 11
s_lshl_b32 s36, s36, 7
s_add_u32 s38, s38, s36
s_add_u32 s98, s38, 0x300000
s_add_u32 s99, s98, 4096
v_lshrrev_b32 v247, 2, v0
v_lshlrev_b32 v250, 7, v247
v_lshl_add_u32 v250, v251, 4, v250
s_lshr_b32 s36, s28, 1
s_lshl_b32 s36, s36, 12
s_and_b32 s37, s28, 1
s_lshl_b32 s37, s37, 6
s_add_u32 s36, s36, s37
s_add_u32 s36, s36, 147456
v_add_u32 v250, s36, v250
v_subrev_u32 v230, 122880, v250
s_and_b32 s36, s35, 15
s_lshl_b32 s36, s36, 17
s_lshr_b32 s37, s35, 4
s_lshl_b32 s37, s37, 13
s_add_u32 s36, s36, s37
s_lshl_b32 s37, s28, 11
s_add_u32 s36, s36, s37
s_add_u32 s100, s36, 0xa00000
s_add_u32 s101, s36, 0xc00000
v_lshlrev_b32 v247, 6, v247
v_lshl_add_u32 v251, v251, 3, v247
v_add_u32 v251, 155648, v251
s_mov_b32 s56, 0x11111111
s_mov_b32 s57, 0x11111111
s_mov_b32 s58, 0x22222222
s_mov_b32 s59, 0x22222222
s_mul_i32 s50, s30, 196608
s_and_b32 s36, s28, 1
s_mul_i32 s36, s36, 3072
s_add_u32 s50, s50, s36
s_add_u32 s50, s50, 0xe00000
s_lshl_b32 s51, s32, 17
s_add_u32 s51, s51, 0xa00000
s_mul_i32 s55, s28, 6144
v_accvgpr_write_b32 a228, -1
v_accvgpr_write_b32 a229, -1
v_accvgpr_write_b32 a230, -1
v_accvgpr_write_b32 a231, -1
s_lshl_b32 s36, s29, 2
s_add_u32 s36, s36, s28
s_lshl_b32 s37, s36, 17
v_add_u32 v2, s37, v1
s_lshl_b32 s82, s36, 13
s_and_b32 s38, s29, 3
s_cmp_eq_u32 s38, 0
s_cselect_b32 s38, 0, 0x1f400
s_cselect_b32 s39, 0, 2048
s_cselect_b32 s54, 32, 48
s_lshl_b32 s37, s29, 19
s_sub_u32 s37, s37, s38
v_add_u32 v3, s37, v1
v_cmp_le_u32 vcc, 8, v234
s_nop 1
v_cndmask_b32 v3, 2.0, v3, vcc
s_lshl_b32 s37, s29, 15
s_sub_u32 s83, s37, s39
s_cmp_eq_u32 s28, 1
s_cselect_b32 vcc_lo, -1, 0
s_mov_b32 vcc_hi, 0
v_lshlrev_b32 v244, 8, v0
v_cndmask_b32 v10, 2.0, v244, vcc
v_and_b32 v244, 1, v233
v_lshl_add_u32 v244, v244, 3, v234
v_and_b32 v244, 15, v244
v_lshrrev_b32 v245, 1, v233
v_lshl_add_u32 v244, v245, 4, v244
v_lshrrev_b32 v245, 3, v234
v_lshl_add_u32 v244, v245, 5, v244
v_lshlrev_b32 v7, 3, v244
v_lshrrev_b32 v246, 2, v0
v_and_b32 v247, 3, v0
v_and_b32 v244, 1, v247
v_lshl_add_u32 v244, v244, 3, v246
v_and_b32 v244, 15, v244
v_lshrrev_b32 v245, 1, v247
v_lshl_add_u32 v244, v245, 4, v244
v_lshrrev_b32 v245, 3, v246
v_lshl_add_u32 v244, v245, 5, v244
v_lshlrev_b32 v8, 3, v244
s_and_b32 s36, s28, 1
s_lshl_b32 s37, s36, 3
s_add_u32 s37, s37, 20480
s_lshl_b32 s36, s36, 9
v_add_u32 v244, s37, v1
v_add_u32 v245, s36, v7
s_cmp_lt_u32 s28, 2
s_cselect_b64 vcc, -1, 0
v_cndmask_b32 v9, v245, v244, vcc
v_lshlrev_b32 v239, 2, v233
v_sub_u32 v239, v239, v234
v_mov_b32 v247, 0xf149f2ca
v_add_u32 v246, 7, v239
v_cmp_gt_u32 vcc, 8, v246
v_mov_b32 v244, 0xffff
s_nop 0
v_cndmask_b32 v24, v247, 0, vcc
v_cndmask_b32 v244, 0, v244, vcc
v_mov_b32 v30, v244
v_add_u32 v246, 0, v239
v_cmp_le_i32 vcc, 9, v246
v_mov_b32 v244, 0xffff
s_nop 0
v_cndmask_b32 v20, v247, 0, vcc
v_cndmask_b32 v244, 0, v244, vcc
v_mov_b32 v28, v244
v_add_u32 v246, 8, v239
v_cmp_gt_u32 vcc, 8, v246
v_mov_b32 v244, 0xffff0000
s_nop 0
v_cndmask_b32 v25, v247, 0, vcc
v_cndmask_b32 v244, 0, v244, vcc
v_or_b32 v30, v30, v244
v_add_u32 v246, 1, v239
v_cmp_le_i32 vcc, 9, v246
v_mov_b32 v244, 0xffff0000
s_nop 0
v_cndmask_b32 v21, v247, 0, vcc
v_cndmask_b32 v244, 0, v244, vcc
v_or_b32 v28, v28, v244
v_add_u32 v246, 9, v239
v_cmp_gt_u32 vcc, 8, v246
v_mov_b32 v244, 0xffff
s_nop 0
v_cndmask_b32 v26, v247, 0, vcc
v_cndmask_b32 v244, 0, v244, vcc
v_mov_b32 v31, v244
v_add_u32 v246, 2, v239
v_cmp_le_i32 vcc, 9, v246
v_mov_b32 v244, 0xffff
s_nop 0
v_cndmask_b32 v22, v247, 0, vcc
v_cndmask_b32 v244, 0, v244, vcc
v_mov_b32 v29, v244
v_add_u32 v246, 10, v239
v_cmp_gt_u32 vcc, 8, v246
v_mov_b32 v244, 0xffff0000
s_nop 0
v_cndmask_b32 v27, v247, 0, vcc
v_cndmask_b32 v244, 0, v244, vcc
v_or_b32 v31, v31, v244
v_add_u32 v246, 3, v239
v_cmp_le_i32 vcc, 9, v246
v_mov_b32 v244, 0xffff0000
s_nop 0
v_cndmask_b32 v23, v247, 0, vcc
v_cndmask_b32 v244, 0, v244, vcc
v_or_b32 v29, v29, v244
s_and_b32 s36, s29, 3
s_or_b32 s36, s36, s28
s_cmp_eq_u32 s36, 0
s_cselect_b64 vcc, -1, 0
v_cndmask_b32 v76, v20, v247, vcc
v_cndmask_b32 v77, v21, v247, vcc
v_cndmask_b32 v78, v22, v247, vcc
v_cndmask_b32 v79, v23, v247, vcc
v_cndmask_b32 v80, v28, 0, vcc
v_cndmask_b32 v81, v29, 0, vcc
v_xor_b32 v236, 64, v232
s_waitcnt vmcnt(1)
ds_read_b128 v[32:35], v232 offset:24576
ds_read_b128 v[36:39], v236 offset:24576
ds_read_b128 v[40:43], v232 offset:26624
ds_read_b128 v[44:47], v236 offset:26624
s_barrier
ds_read_b64_tr_b16 a[188:189], v248 offset:0
ds_read_b64_tr_b16 a[190:191], v248 offset:512
ds_read_b64_tr_b16 a[192:193], v248 offset:4096
ds_read_b64_tr_b16 a[194:195], v248 offset:4608
ds_read_b64_tr_b16 a[196:197], v249 offset:32
ds_read_b64_tr_b16 a[198:199], v249 offset:544
ds_read_b64_tr_b16 a[200:201], v249 offset:4128
ds_read_b64_tr_b16 a[202:203], v249 offset:4640
ds_read_b64_tr_b16 a[204:205], v248 offset:8192
ds_read_b64_tr_b16 a[206:207], v248 offset:8704
ds_read_b64_tr_b16 a[208:209], v248 offset:12288
ds_read_b64_tr_b16 a[210:211], v248 offset:12800
ds_read_b64_tr_b16 a[212:213], v250 offset:0
ds_read_b64_tr_b16 a[214:215], v250 offset:2048
ds_read_b64_tr_b16 a[216:217], v250 offset:8
ds_read_b64_tr_b16 a[218:219], v250 offset:2056
s_lshl_b32 s36, s32, 13
s_add_u32 s36, s36, 0x0
s_add_u32 s37, s36, 4096
s_mov_b32 s38, 0x200000
s_waitcnt lgkmcnt(14)
v_mfma_f32_16x16x32_bf16 v[96:99], v[32:35], v[32:35], 0
v_mfma_f32_16x16x32_bf16 v[92:95], v[16:19], v[32:35], 0
buffer_store_dwordx4 v[32:35], v4, s[12:15], s36 offen offset:0 sc1
v_mfma_f32_16x16x32_bf16 v[104:107], v[40:43], v[40:43], 0
v_mfma_f32_16x16x32_bf16 v[100:103], v[16:19], v[40:43], 0
buffer_store_dwordx4 v[40:43], v4, s[12:15], s36 offen offset:1024 sc1
v_mfma_f32_16x16x32_bf16 v[96:99], v[36:39], v[36:39], v[96:99]
v_mfma_f32_16x16x32_bf16 v[92:95], v[16:19], v[36:39], v[92:95]
buffer_store_dwordx4 v[36:39], v4, s[12:15], s37 offen offset:0 sc1
v_mfma_f32_16x16x32_bf16 v[104:107], v[44:47], v[44:47], v[104:107]
v_mfma_f32_16x16x32_bf16 v[100:103], v[16:19], v[44:47], v[100:103]
buffer_store_dwordx4 v[44:47], v4, s[12:15], s37 offen offset:1024 sc1
s_nop 2
v_cndmask_b32 v96, v96, v97, s[46:47]
v_cndmask_b32 v98, v98, v99, s[46:47]
v_cndmask_b32 v93, v96, v98, s[48:49]
buffer_store_dwordx2 v[92:93], v253, s[4:7], s38 offen offset:0 sc1
v_cndmask_b32 v104, v104, v105, s[46:47]
v_cndmask_b32 v106, v106, v107, s[46:47]
v_cndmask_b32 v101, v104, v106, s[48:49]
buffer_store_dwordx2 v[100:101], v253, s[4:7], s38 offen offset:2048 sc1
v_mfma_f32_16x16x32_bf16 v[108:111], a[188:191], v[16:19], 0
s_waitcnt lgkmcnt(10)
v_mfma_f32_16x16x32_bf16 v[112:115], a[196:199], v[16:19], 0
s_waitcnt lgkmcnt(6)
v_mfma_f32_16x16x32_bf16 v[116:119], a[204:207], v[16:19], 0
v_mfma_f32_16x16x32_bf16 v[108:111], a[192:195], v[16:19], v[108:111]
v_mfma_f32_16x16x32_bf16 v[112:115], a[200:203], v[16:19], v[112:115]
s_waitcnt lgkmcnt(4)
v_mfma_f32_16x16x32_bf16 v[116:119], a[208:211], v[16:19], v[116:119]
buffer_store_dwordx4 a[188:191], v1, s[4:7], s96 offen offset:0 sc1
buffer_store_dwordx4 a[192:195], v1, s[4:7], s97 offen offset:0 sc1
buffer_store_dwordx4 a[196:199], v1, s[4:7], s96 offen offset:1024 sc1
buffer_store_dwordx4 a[200:203], v1, s[4:7], s97 offen offset:1024 sc1
buffer_store_dwordx4 a[204:207], v1, s[4:7], s96 offen offset:2048 sc1
buffer_store_dwordx4 a[208:211], v1, s[4:7], s97 offen offset:2048 sc1
buffer_store_dwordx4 v[108:111], v254, s[4:7], s98 offen offset:0 sc1
buffer_store_dwordx4 v[112:115], v254, s[4:7], s98 offen offset:2048 sc1
buffer_store_dwordx4 v[116:119], v254, s[4:7], s99 offen offset:0 sc1
s_waitcnt lgkmcnt(2)
buffer_store_dwordx4 a[212:215], v1, s[4:7], s100 offen offset:0 sc1
s_waitcnt lgkmcnt(0)
buffer_store_dwordx4 a[216:219], v1, s[4:7], s100 offen offset:1024 sc1
s_mov_b32 s36, 0x9e3779b1
v_mul_lo_u32 v15, v11, s36
v_add_u32 v15, 0x7f4a7c15, v15
s_and_b32 s36, s31, 1
s_lshl_b32 s36, s36, 4
s_add_u32 s36, s36, s32
s_lshl_b32 s36, s36, 2
s_add_u32 s92, s78, s36
s_add_u32 s92, s92, 0xc0000
s_lshl_b32 s36, s32, 2
s_add_u32 s93, s79, s36
s_add_u32 s93, s93, 0xc0080
s_and_b32 s94, s35, 15
s_lshl_b32 s94, s94, 9
s_lshr_b32 s36, s35, 4
s_lshl_b32 s36, s36, 2
s_add_u32 s94, s94, s36
s_add_u32 s94, s94, 0xc00c0
v_lshrrev_b32 v240, 1, v0
v_lshlrev_b32 v240, 13, v240
v_and_b32 v241, 1, v0
v_lshl_add_u32 v240, v241, 8, v240
s_mov_b32 vcc_lo, 0xffff
s_mov_b32 vcc_hi, 0
v_cndmask_b32 v240, 2.0, v240, vcc
v_lshlrev_b32 v241, 2, v0
v_add_u32 v248, 0, v248
v_add_u32 v249, 0, v249
s_add_u32 s96, s96, 0x600000
s_add_u32 s98, s98, 0x80000
s_add_u32 s97, s97, 0x600000
s_add_u32 s99, s99, 0x80000
s_cmp_eq_u32 s28, 1
s_cselect_b32 vcc_lo, 0xffff, 0
v_lshlrev_b32 v252, 12, v0
v_cndmask_b32 v252, 2.0, v252, vcc
v_cndmask_b32 v14, 2.0, v240, vcc
s_and_b32 s62, s35, 15
s_lshl_b32 s62, s62, 8
s_lshr_b32 s36, s35, 4
s_lshl_b32 s36, s36, 2
s_add_u32 s62, s62, s36
s_add_u32 s62, s62, 0xd0000
s_add_u32 s8, s94, 0x1ff40
v_and_b32 v255, 15, v0
v_lshlrev_b32 v255, 2, v255
s_waitcnt vmcnt(0)
s_barrier
s_cmp_lg_u32 s28, 1
s_cbranch_scc1 Lg1s_1
buffer_atomic_swap v15, v10, s[4:7], s92 offen sc1
buffer_atomic_swap v15, v10, s[4:7], s93 offen sc1
buffer_atomic_swap v15, v240, s[4:7], s94 offen sc1
buffer_atomic_swap v15, v252, s[4:7], s62 offen sc1
Lg1s_1:
s_branch L_aligned
.p2align 12
L_aligned:
s_add_u32 s89, s66, 0xd0000
ds_read_b64_tr_b16 a[232:233], v251 offset:0
ds_read_b64_tr_b16 a[234:235], v251 offset:1024
ds_read_b64_tr_b16 a[236:237], v251 offset:32
ds_read_b64_tr_b16 a[238:239], v251 offset:1056
s_lshl_b32 s36, s28, 11
v_add_u32 v231, s36, v1
s_waitcnt lgkmcnt(0)
v_add_u32 v231, 0, v231
s_cmp_lg_u32 s28, 3
s_cbranch_scc1 L_wskip0
s_mov_b64 exec, 0
s_branch L_stub0
L_wret0:
s_mov_b64 exec, -1
L_wskip0:
s_cmp_lg_u32 s28, 0
s_cbranch_scc1 Lg1e_3
s_cmp_eq_u32 s54, 32
s_cselect_b32 s39, 0xffff0000, -1
s_mov_b32 s38, -1
s_add_u32 s36, s67, 0xc0000
s_mov_b32 s37, 0
Lg1p_2:
v_mov_b32 v11, 0
buffer_atomic_add v11, v241, s[4:7], s36 offen sc0 sc1
s_add_u32 s37, s37, 1
v_mov_b32 v242, v15
s_mov_b64 exec, 0xffff
v_mov_b32 v242, 0
buffer_atomic_add v242, v241, s[4:7], s89 offen sc0 sc1
s_mov_b64 exec, -1
s_waitcnt vmcnt(0)
v_cmp_ne_u32 vcc, v11, v15
v_cmp_ne_u32 s[52:53], v242, v15
s_and_b64 vcc, vcc, s[38:39]
s_or_b64 vcc, vcc, s[52:53]
s_cbranch_scc0 Lg1e_3
s_cmp_lt_u32 s37, 0x100000
s_cbranch_scc1 Lg1p_2
Lg1e_3:
s_barrier
s_add_u32 s94, s71, 0x80
s_add_u32 s44, s28, 0
s_mul_i32 s45, s44, 3072
s_add_u32 m0, s45, 0
s_lshr_b32 s44, s44, 1
s_add_u32 s44, s44, 0
s_mul_i32 s44, s44, 6144
s_add_u32 s44, s44, s50
buffer_load_dwordx4 v1, s[4:7], s44 offen offset:0 sc1 lds
buffer_load_dwordx4 v1, s[4:7], s44 offen offset:1024 sc1 lds
buffer_load_dwordx4 v1, s[4:7], s44 offen offset:2048 sc1 lds
s_add_u32 s44, s28, 4
s_mul_i32 s45, s44, 3072
s_add_u32 m0, s45, 0
s_lshr_b32 s44, s44, 1
s_add_u32 s44, s44, 0
s_mul_i32 s44, s44, 6144
s_add_u32 s44, s44, s50
buffer_load_dwordx4 v1, s[4:7], s44 offen offset:0 sc1 lds
buffer_load_dwordx4 v1, s[4:7], s44 offen offset:1024 sc1 lds
buffer_load_dwordx4 v1, s[4:7], s44 offen offset:2048 sc1 lds
s_add_u32 s44, s28, 8
s_mul_i32 s45, s44, 3072
s_add_u32 m0, s45, 0
s_lshr_b32 s44, s44, 1
s_add_u32 s44, s44, 0
s_mul_i32 s44, s44, 6144
s_add_u32 s44, s44, s50
buffer_load_dwordx4 v1, s[4:7], s44 offen offset:0 sc1 lds
buffer_load_dwordx4 v1, s[4:7], s44 offen offset:1024 sc1 lds
buffer_load_dwordx4 v1, s[4:7], s44 offen offset:2048 sc1 lds
s_add_u32 s44, s28, 12
s_mul_i32 s45, s44, 3072
s_add_u32 m0, s45, 0
s_lshr_b32 s44, s44, 1
s_add_u32 s44, s44, 0
s_mul_i32 s44, s44, 6144
s_add_u32 s44, s44, s50
buffer_load_dwordx4 v1, s[4:7], s44 offen offset:0 sc1 lds
buffer_load_dwordx4 v1, s[4:7], s44 offen offset:1024 sc1 lds
buffer_load_dwordx4 v1, s[4:7], s44 offen offset:2048 sc1 lds
s_lshl_b32 s35, s33, 12
buffer_load_dwordx4 a[0:3], v2, s[40:43], s35 offen offset:0 sc1
buffer_load_dwordx4 a[4:7], v2, s[40:43], s35 offen offset:1024 sc1
buffer_load_dwordx4 a[8:11], v2, s[40:43], s35 offen offset:2048 sc1
buffer_load_dwordx4 a[12:15], v2, s[40:43], s35 offen offset:3072 sc1
s_add_u32 s35, s35, 4096
s_add_u32 s63, s28, 0
s_lshl_b32 s63, s63, 12
buffer_load_dwordx4 a[64:67], v3, s[40:43], s63 offen sc1
buffer_load_dwordx4 a[16:19], v2, s[40:43], s35 offen offset:0 sc1
buffer_load_dwordx4 a[20:23], v2, s[40:43], s35 offen offset:1024 sc1
buffer_load_dwordx4 a[24:27], v2, s[40:43], s35 offen offset:2048 sc1
buffer_load_dwordx4 a[28:31], v2, s[40:43], s35 offen offset:3072 sc1
s_add_u32 s35, s35, 4096
buffer_load_dwordx4 a[32:35], v2, s[40:43], s35 offen offset:0 sc1
buffer_load_dwordx4 a[36:39], v2, s[40:43], s35 offen offset:1024 sc1
buffer_load_dwordx4 a[40:43], v2, s[40:43], s35 offen offset:2048 sc1
buffer_load_dwordx4 a[44:47], v2, s[40:43], s35 offen offset:3072 sc1
s_add_u32 s35, s35, 4096
s_mov_b64 s[20:21], s[76:77]
s_mov_b32 s22, 0x200000
s_add_u32 s89, s16, 0
buffer_load_dwordx4 a[220:223], v229, s[20:23], s89 offen nt
s_mov_b64 s[20:21], s[76:77]
s_mov_b32 s22, 0x200000
s_add_u32 s89, s16, 16384
buffer_load_dwordx4 a[224:227], v229, s[20:23], s89 offen nt
s_mov_b64 s[20:21], s[72:73]
s_mov_b32 s22, 0x600000
s_add_u32 s89, s17, 0
buffer_load_dwordx4 a[188:191], v228, s[20:23], s89 offen nt
s_mov_b64 s[20:21], s[72:73]
s_mov_b32 s22, 0x600000
s_add_u32 s89, s17, 49152
buffer_load_dwordx4 a[192:195], v228, s[20:23], s89 offen nt
s_mov_b64 s[20:21], s[72:73]
s_mov_b32 s22, 0x600000
s_add_u32 s89, s17, 2048
buffer_load_dwordx4 a[196:199], v228, s[20:23], s89 offen nt
s_mov_b64 s[20:21], s[72:73]
s_mov_b32 s22, 0x600000
s_add_u32 s89, s17, 51200
buffer_load_dwordx4 a[200:203], v228, s[20:23], s89 offen nt
s_mov_b64 s[20:21], s[72:73]
s_mov_b32 s22, 0x600000
s_add_u32 s89, s17, 4096
buffer_load_dwordx4 a[204:207], v228, s[20:23], s89 offen nt
s_mov_b64 s[20:21], s[72:73]
s_mov_b32 s22, 0x600000
s_add_u32 s89, s17, 53248
buffer_load_dwordx4 a[208:211], v228, s[20:23], s89 offen nt
s_waitcnt vmcnt(21)
s_barrier
v_add_u32 v5, 0, v1
v_add_u32 v6, s55, v5
ds_read_b128 a[96:99], v5 offset:0
ds_read_b128 a[100:103], v5 offset:1024
ds_read_b128 a[104:107], v5 offset:2048
ds_read_b128 a[108:111], v5 offset:3072
ds_read_b128 a[112:115], v5 offset:4096
ds_read_b128 a[116:119], v5 offset:5120
ds_read_b128 a[120:123], v6 offset:2048
s_waitcnt vmcnt(16) lgkmcnt(0)
v_mfma_f32_16x16x32_bf16 v[132:135], a[96:99], a[0:3], 0
s_add_u32 s44, s28, 0
s_mul_i32 s45, s44, 3072
s_add_u32 m0, s45, 49152
v_mfma_f32_16x16x32_bf16 v[156:159], a[96:99], a[4:7], 0
buffer_load_dwordx4 a[48:51], v2, s[40:43], s35 offen offset:0 sc1
s_lshr_b32 s44, s44, 1
v_mfma_f32_16x16x32_bf16 v[180:183], a[96:99], a[8:11], 0
s_add_u32 s44, s44, 8
s_mul_i32 s44, s44, 6144
s_add_u32 s44, s44, s50
v_mfma_f32_16x16x32_bf16 v[204:207], a[96:99], a[12:15], 0
ds_read_b128 a[128:131], v5 offset:6144
v_mfma_f32_16x16x32_bf16 v[208:211], a[100:103], a[12:15], 0
buffer_load_dwordx4 v1, s[4:7], s44 offen offset:0 sc1 lds
v_mfma_f32_16x16x32_bf16 v[184:187], a[100:103], a[8:11], 0
ds_read_b128 a[132:135], v5 offset:7168
v_mfma_f32_16x16x32_bf16 v[160:163], a[100:103], a[4:7], 0
ds_read_b128 a[136:139], v5 offset:8192
v_mfma_f32_16x16x32_bf16 v[136:139], a[100:103], a[0:3], 0
buffer_load_dwordx4 a[52:55], v2, s[40:43], s35 offen offset:1024 sc1
v_mfma_f32_16x16x32_bf16 v[140:143], a[104:107], a[0:3], 0
ds_read_b128 a[140:143], v5 offset:9216
v_mfma_f32_16x16x32_bf16 v[164:167], a[104:107], a[4:7], 0
ds_read_b128 a[144:147], v5 offset:10240
v_mfma_f32_16x16x32_bf16 v[188:191], a[104:107], a[8:11], 0
buffer_load_dwordx4 v1, s[4:7], s44 offen offset:1024 sc1 lds
v_mfma_f32_16x16x32_bf16 v[212:215], a[104:107], a[12:15], 0
ds_read_b128 a[148:151], v5 offset:11264
v_mfma_f32_16x16x32_bf16 v[216:219], a[108:111], a[12:15], 0
v_mfma_f32_16x16x32_bf16 v[192:195], a[108:111], a[8:11], 0
buffer_load_dwordx4 a[56:59], v2, s[40:43], s35 offen offset:2048 sc1
v_mfma_f32_16x16x32_bf16 v[168:171], a[108:111], a[4:7], 0
ds_read_b128 a[152:155], v6 offset:3072
v_mfma_f32_16x16x32_bf16 v[144:147], a[108:111], a[0:3], 0
v_mfma_f32_16x16x32_bf16 v[148:151], a[112:115], a[0:3], 0
buffer_load_dwordx4 v1, s[4:7], s44 offen offset:2048 sc1 lds
s_add_u32 s63, s28, 4
v_mfma_f32_16x16x32_bf16 v[172:175], a[112:115], a[4:7], 0
s_lshl_b32 s63, s63, 12
v_mfma_f32_16x16x32_bf16 v[196:199], a[112:115], a[8:11], 0
v_mfma_f32_16x16x32_bf16 v[220:223], a[112:115], a[12:15], 0
buffer_load_dwordx4 a[68:71], v3, s[40:43], s63 offen sc1
s_add_u32 s44, s28, 4
v_mfma_f32_16x16x32_bf16 v[224:227], a[116:119], a[12:15], 0
s_mul_i32 s45, s44, 3072
s_add_u32 m0, s45, 49152
s_lshr_b32 s44, s44, 1
v_mfma_f32_16x16x32_bf16 v[200:203], a[116:119], a[8:11], 0
s_add_u32 s44, s44, 8
s_mul_i32 s44, s44, 6144
s_add_u32 s44, s44, s50
v_mfma_f32_16x16x32_bf16 v[176:179], a[116:119], a[4:7], 0
buffer_load_dwordx4 a[60:63], v2, s[40:43], s35 offen offset:3072 sc1
s_add_u32 s35, s35, 4096
v_mfma_f32_16x16x32_bf16 v[152:155], a[116:119], a[0:3], 0
v_mfma_f32_16x16x32_bf16 a[80:83], a[120:123], a[64:67], 0
s_waitcnt vmcnt(20) lgkmcnt(0)
v_mfma_f32_16x16x32_bf16 v[132:135], a[128:131], a[16:19], v[132:135]
ds_read_b128 a[96:99], v5 offset:12288
v_mfma_f32_16x16x32_bf16 v[156:159], a[128:131], a[20:23], v[156:159]
buffer_load_dwordx4 a[0:3], v2, s[40:43], s35 offen offset:0 sc1
v_mfma_f32_16x16x32_bf16 v[180:183], a[128:131], a[24:27], v[180:183]
ds_read_b128 a[100:103], v5 offset:13312
v_mfma_f32_16x16x32_bf16 v[204:207], a[128:131], a[28:31], v[204:207]
v_mfma_f32_16x16x32_bf16 v[208:211], a[132:135], a[28:31], v[208:211]
buffer_load_dwordx4 v1, s[4:7], s44 offen offset:0 sc1 lds
v_mfma_f32_16x16x32_bf16 v[184:187], a[132:135], a[24:27], v[184:187]
ds_read_b128 a[104:107], v5 offset:14336
v_mfma_f32_16x16x32_bf16 v[160:163], a[132:135], a[20:23], v[160:163]
ds_read_b128 a[108:111], v5 offset:15360
v_mfma_f32_16x16x32_bf16 v[136:139], a[132:135], a[16:19], v[136:139]
v_mfma_f32_16x16x32_bf16 v[140:143], a[136:139], a[16:19], v[140:143]
buffer_load_dwordx4 a[4:7], v2, s[40:43], s35 offen offset:1024 sc1
v_mfma_f32_16x16x32_bf16 v[164:167], a[136:139], a[20:23], v[164:167]
ds_read_b128 a[112:115], v5 offset:16384
v_mfma_f32_16x16x32_bf16 v[188:191], a[136:139], a[24:27], v[188:191]
v_mfma_f32_16x16x32_bf16 v[212:215], a[136:139], a[28:31], v[212:215]
buffer_load_dwordx4 v1, s[4:7], s44 offen offset:1024 sc1 lds
v_mfma_f32_16x16x32_bf16 v[216:219], a[140:143], a[28:31], v[216:219]
ds_read_b128 a[116:119], v5 offset:17408
v_mfma_f32_16x16x32_bf16 v[192:195], a[140:143], a[24:27], v[192:195]
ds_read_b128 a[120:123], v6 offset:4096
v_mfma_f32_16x16x32_bf16 v[168:171], a[140:143], a[20:23], v[168:171]
v_mfma_f32_16x16x32_bf16 v[144:147], a[140:143], a[16:19], v[144:147]
buffer_load_dwordx4 a[8:11], v2, s[40:43], s35 offen offset:2048 sc1
v_mfma_f32_16x16x32_bf16 v[148:151], a[144:147], a[16:19], v[148:151]
v_mfma_f32_16x16x32_bf16 v[172:175], a[144:147], a[20:23], v[172:175]
v_mfma_f32_16x16x32_bf16 v[196:199], a[144:147], a[24:27], v[196:199]
buffer_load_dwordx4 v1, s[4:7], s44 offen offset:2048 sc1 lds
s_add_u32 s44, s28, 8
v_mfma_f32_16x16x32_bf16 v[220:223], a[144:147], a[28:31], v[220:223]
s_mul_i32 s45, s44, 3072
s_add_u32 m0, s45, 49152
s_lshr_b32 s44, s44, 1
v_mfma_f32_16x16x32_bf16 v[224:227], a[148:151], a[28:31], v[224:227]
s_add_u32 s44, s44, 8
s_mul_i32 s44, s44, 6144
s_add_u32 s44, s44, s50
v_mfma_f32_16x16x32_bf16 v[200:203], a[148:151], a[24:27], v[200:203]
v_mfma_f32_16x16x32_bf16 v[176:179], a[148:151], a[20:23], v[176:179]
buffer_load_dwordx4 a[12:15], v2, s[40:43], s35 offen offset:3072 sc1
s_add_u32 s35, s35, 4096
v_mfma_f32_16x16x32_bf16 v[152:155], a[148:151], a[16:19], v[152:155]
v_mfma_f32_16x16x32_bf16 a[84:87], a[152:155], a[64:67], 0
s_waitcnt vmcnt(23) lgkmcnt(0)
v_mfma_f32_16x16x32_bf16 v[132:135], a[96:99], a[32:35], v[132:135]
ds_read_b128 a[128:131], v5 offset:18432
v_mfma_f32_16x16x32_bf16 v[156:159], a[96:99], a[36:39], v[156:159]
buffer_load_dwordx4 a[16:19], v2, s[40:43], s35 offen offset:0 sc1
v_mfma_f32_16x16x32_bf16 v[180:183], a[96:99], a[40:43], v[180:183]
ds_read_b128 a[132:135], v5 offset:19456
v_mfma_f32_16x16x32_bf16 v[204:207], a[96:99], a[44:47], v[204:207]
v_mfma_f32_16x16x32_bf16 v[208:211], a[100:103], a[44:47], v[208:211]
buffer_load_dwordx4 v1, s[4:7], s44 offen offset:0 sc1 lds
v_mfma_f32_16x16x32_bf16 v[184:187], a[100:103], a[40:43], v[184:187]
ds_read_b128 a[136:139], v5 offset:20480
v_mfma_f32_16x16x32_bf16 v[160:163], a[100:103], a[36:39], v[160:163]
ds_read_b128 a[140:143], v5 offset:21504
v_mfma_f32_16x16x32_bf16 v[136:139], a[100:103], a[32:35], v[136:139]
v_mfma_f32_16x16x32_bf16 v[140:143], a[104:107], a[32:35], v[140:143]
buffer_load_dwordx4 a[20:23], v2, s[40:43], s35 offen offset:1024 sc1
v_mfma_f32_16x16x32_bf16 v[164:167], a[104:107], a[36:39], v[164:167]
ds_read_b128 a[144:147], v5 offset:22528
v_mfma_f32_16x16x32_bf16 v[188:191], a[104:107], a[40:43], v[188:191]
v_mfma_f32_16x16x32_bf16 v[212:215], a[104:107], a[44:47], v[212:215]
buffer_load_dwordx4 v1, s[4:7], s44 offen offset:1024 sc1 lds
v_mfma_f32_16x16x32_bf16 v[216:219], a[108:111], a[44:47], v[216:219]
ds_read_b128 a[148:151], v5 offset:23552
v_mfma_f32_16x16x32_bf16 v[192:195], a[108:111], a[40:43], v[192:195]
ds_read_b128 a[152:155], v6 offset:5120
v_mfma_f32_16x16x32_bf16 v[168:171], a[108:111], a[36:39], v[168:171]
v_mfma_f32_16x16x32_bf16 v[144:147], a[108:111], a[32:35], v[144:147]
buffer_load_dwordx4 a[24:27], v2, s[40:43], s35 offen offset:2048 sc1
v_mfma_f32_16x16x32_bf16 v[148:151], a[112:115], a[32:35], v[148:151]
v_mfma_f32_16x16x32_bf16 v[172:175], a[112:115], a[36:39], v[172:175]
v_mfma_f32_16x16x32_bf16 v[196:199], a[112:115], a[40:43], v[196:199]
buffer_load_dwordx4 v1, s[4:7], s44 offen offset:2048 sc1 lds
s_add_u32 s44, s28, 12
v_mfma_f32_16x16x32_bf16 v[220:223], a[112:115], a[44:47], v[220:223]
s_mul_i32 s45, s44, 3072
s_add_u32 m0, s45, 49152
s_lshr_b32 s44, s44, 1
v_mfma_f32_16x16x32_bf16 v[224:227], a[116:119], a[44:47], v[224:227]
s_add_u32 s44, s44, 8
s_mul_i32 s44, s44, 6144
s_add_u32 s44, s44, s50
v_mfma_f32_16x16x32_bf16 v[200:203], a[116:119], a[40:43], v[200:203]
v_mfma_f32_16x16x32_bf16 v[176:179], a[116:119], a[36:39], v[176:179]
buffer_load_dwordx4 a[28:31], v2, s[40:43], s35 offen offset:3072 sc1
s_add_u32 s35, s35, 4096
v_mfma_f32_16x16x32_bf16 v[152:155], a[116:119], a[32:35], v[152:155]
v_mfma_f32_16x16x32_bf16 a[88:91], a[120:123], a[64:67], 0
s_waitcnt vmcnt(14) lgkmcnt(0)
v_mfma_f32_16x16x32_bf16 v[132:135], a[128:131], a[48:51], v[132:135]
ds_read_b128 a[96:99], v5 offset:24576
v_mfma_f32_16x16x32_bf16 v[156:159], a[128:131], a[52:55], v[156:159]
buffer_load_dwordx4 a[32:35], v2, s[40:43], s35 offen offset:0 sc1
v_mfma_f32_16x16x32_bf16 v[180:183], a[128:131], a[56:59], v[180:183]
ds_read_b128 a[100:103], v5 offset:25600
v_mfma_f32_16x16x32_bf16 v[204:207], a[128:131], a[60:63], v[204:207]
v_mfma_f32_16x16x32_bf16 v[208:211], a[132:135], a[60:63], v[208:211]
buffer_load_dwordx4 v1, s[4:7], s44 offen offset:0 sc1 lds
v_mfma_f32_16x16x32_bf16 v[184:187], a[132:135], a[56:59], v[184:187]
ds_read_b128 a[104:107], v5 offset:26624
v_mfma_f32_16x16x32_bf16 v[160:163], a[132:135], a[52:55], v[160:163]
ds_read_b128 a[108:111], v5 offset:27648
v_mfma_f32_16x16x32_bf16 v[136:139], a[132:135], a[48:51], v[136:139]
v_mfma_f32_16x16x32_bf16 v[140:143], a[136:139], a[48:51], v[140:143]
buffer_load_dwordx4 a[36:39], v2, s[40:43], s35 offen offset:1024 sc1
v_mfma_f32_16x16x32_bf16 v[164:167], a[136:139], a[52:55], v[164:167]
ds_read_b128 a[112:115], v5 offset:28672
v_mfma_f32_16x16x32_bf16 v[188:191], a[136:139], a[56:59], v[188:191]
v_mfma_f32_16x16x32_bf16 v[212:215], a[136:139], a[60:63], v[212:215]
buffer_load_dwordx4 v1, s[4:7], s44 offen offset:1024 sc1 lds
v_mfma_f32_16x16x32_bf16 v[216:219], a[140:143], a[60:63], v[216:219]
ds_read_b128 a[116:119], v5 offset:29696
v_mfma_f32_16x16x32_bf16 v[192:195], a[140:143], a[56:59], v[192:195]
ds_read_b128 a[120:123], v6 offset:26624
v_mfma_f32_16x16x32_bf16 v[168:171], a[140:143], a[52:55], v[168:171]
v_mfma_f32_16x16x32_bf16 v[144:147], a[140:143], a[48:51], v[144:147]
buffer_load_dwordx4 a[40:43], v2, s[40:43], s35 offen offset:2048 sc1
v_mfma_f32_16x16x32_bf16 v[148:151], a[144:147], a[48:51], v[148:151]
v_mfma_f32_16x16x32_bf16 v[172:175], a[144:147], a[52:55], v[172:175]
v_mfma_f32_16x16x32_bf16 v[196:199], a[144:147], a[56:59], v[196:199]
buffer_load_dwordx4 v1, s[4:7], s44 offen offset:2048 sc1 lds
v_mfma_f32_16x16x32_bf16 v[220:223], a[144:147], a[60:63], v[220:223]
v_and_b32 v232, 15, v0
v_lshlrev_b32 v232, 7, v232
v_mfma_f32_16x16x32_bf16 v[224:227], a[148:151], a[60:63], v[224:227]
v_lshrrev_b32 v233, 4, v0
v_lshlrev_b32 v233, 4, v233
v_mfma_f32_16x16x32_bf16 v[200:203], a[148:151], a[56:59], v[200:203]
v_add_u32 v232, v233, v232
s_mul_i32 s38, s30, 12288
v_mfma_f32_16x16x32_bf16 v[176:179], a[148:151], a[52:55], v[176:179]
buffer_load_dwordx4 a[44:47], v2, s[40:43], s35 offen offset:3072 sc1
s_add_u32 s35, s35, 4096
v_mfma_f32_16x16x32_bf16 v[152:155], a[148:151], a[48:51], v[152:155]
s_add_u32 s38, s38, 0x300000
s_add_u32 s39, s28, 4
s_min_u32 s39, s39, 5
v_mfma_f32_16x16x32_bf16 a[92:95], a[152:155], a[64:67], 0
s_lshl_b32 s36, s28, 11
s_waitcnt vmcnt(14) lgkmcnt(0)
v_mfma_f32_16x16x32_bf16 v[132:135], a[96:99], a[0:3], v[132:135]
s_add_u32 s36, s36, s38
s_lshl_b32 s37, s39, 11
s_add_u32 s37, s37, s38
v_mfma_f32_16x16x32_bf16 v[156:159], a[96:99], a[4:7], v[156:159]
buffer_load_dwordx4 a[48:51], v2, s[40:43], s35 offen offset:0 sc1
v_mfma_f32_16x16x32_bf16 v[180:183], a[96:99], a[8:11], v[180:183]
ds_read_b128 a[128:131], v5 offset:30720
v_mfma_f32_16x16x32_bf16 v[204:207], a[96:99], a[12:15], v[204:207]
ds_read_b128 a[132:135], v5 offset:31744
v_mfma_f32_16x16x32_bf16 v[208:211], a[100:103], a[12:15], v[208:211]
buffer_load_dwordx4 v[48:51], v232, s[4:7], s36 offen sc1
v_mfma_f32_16x16x32_bf16 v[184:187], a[100:103], a[8:11], v[184:187]
ds_read_b128 a[136:139], v5 offset:32768
v_mfma_f32_16x16x32_bf16 v[160:163], a[100:103], a[4:7], v[160:163]
ds_read_b128 a[140:143], v5 offset:33792
v_mfma_f32_16x16x32_bf16 v[136:139], a[100:103], a[0:3], v[136:139]
buffer_load_dwordx4 a[52:55], v2, s[40:43], s35 offen offset:1024 sc1
v_mfma_f32_16x16x32_bf16 v[140:143], a[104:107], a[0:3], v[140:143]
v_mfma_f32_16x16x32_bf16 v[164:167], a[104:107], a[4:7], v[164:167]
ds_read_b128 a[144:147], v5 offset:34816
v_mfma_f32_16x16x32_bf16 v[188:191], a[104:107], a[8:11], v[188:191]
buffer_load_dwordx4 v[52:55], v232, s[4:7], s37 offen sc1
s_add_u32 s44, s28, 0
v_mfma_f32_16x16x32_bf16 v[212:215], a[104:107], a[12:15], v[212:215]
s_mul_i32 s45, s44, 3072
s_add_u32 m0, s45, 98304
s_lshr_b32 s44, s44, 1
v_mfma_f32_16x16x32_bf16 v[216:219], a[108:111], a[12:15], v[216:219]
s_add_u32 s44, s44, 16
s_mul_i32 s44, s44, 6144
s_add_u32 s44, s44, s50
v_mfma_f32_16x16x32_bf16 v[192:195], a[108:111], a[8:11], v[192:195]
buffer_load_dwordx4 a[56:59], v2, s[40:43], s35 offen offset:2048 sc1
v_mfma_f32_16x16x32_bf16 v[168:171], a[108:111], a[4:7], v[168:171]
ds_read_b128 a[148:151], v5 offset:35840
v_mfma_f32_16x16x32_bf16 v[144:147], a[108:111], a[0:3], v[144:147]
ds_read_b128 a[152:155], v6 offset:27648
v_mfma_f32_16x16x32_bf16 v[148:151], a[112:115], a[0:3], v[148:151]
buffer_load_dwordx4 v1, s[4:7], s44 offen offset:0 sc1 lds
s_add_u32 s63, s28, 8
v_mfma_f32_16x16x32_bf16 v[172:175], a[112:115], a[4:7], v[172:175]
s_lshl_b32 s63, s63, 12
v_mfma_f32_16x16x32_bf16 v[196:199], a[112:115], a[8:11], v[196:199]
v_mfma_f32_16x16x32_bf16 v[220:223], a[112:115], a[12:15], v[220:223]
buffer_load_dwordx4 a[72:75], v3, s[40:43], s63 offen sc1
v_mfma_f32_16x16x32_bf16 v[224:227], a[116:119], a[12:15], v[224:227]
v_mfma_f32_16x16x32_bf16 v[200:203], a[116:119], a[8:11], v[200:203]
v_mfma_f32_16x16x32_bf16 v[176:179], a[116:119], a[4:7], v[176:179]
buffer_load_dwordx4 a[60:63], v2, s[40:43], s35 offen offset:3072 sc1
s_add_u32 s35, s35, 4096
v_mfma_f32_16x16x32_bf16 v[152:155], a[116:119], a[0:3], v[152:155]
v_mfma_f32_16x16x32_bf16 a[80:83], a[120:123], a[68:71], a[80:83]
s_waitcnt vmcnt(15) lgkmcnt(0)
v_mfma_f32_16x16x32_bf16 v[132:135], a[128:131], a[16:19], v[132:135]
ds_read_b128 a[96:99], v5 offset:36864
v_mfma_f32_16x16x32_bf16 v[156:159], a[128:131], a[20:23], v[156:159]
buffer_load_dwordx4 a[0:3], v2, s[40:43], s35 offen offset:0 sc1
v_mfma_f32_16x16x32_bf16 v[180:183], a[128:131], a[24:27], v[180:183]
ds_read_b128 a[100:103], v5 offset:37888
v_mfma_f32_16x16x32_bf16 v[204:207], a[128:131], a[28:31], v[204:207]
v_mfma_f32_16x16x32_bf16 v[208:211], a[132:135], a[28:31], v[208:211]
buffer_load_dwordx4 v1, s[4:7], s44 offen offset:1024 sc1 lds
v_mfma_f32_16x16x32_bf16 v[184:187], a[132:135], a[24:27], v[184:187]
ds_read_b128 a[104:107], v5 offset:38912
v_mfma_f32_16x16x32_bf16 v[160:163], a[132:135], a[20:23], v[160:163]
ds_read_b128 a[108:111], v5 offset:39936
v_mfma_f32_16x16x32_bf16 v[136:139], a[132:135], a[16:19], v[136:139]
v_mfma_f32_16x16x32_bf16 v[140:143], a[136:139], a[16:19], v[140:143]
buffer_load_dwordx4 a[4:7], v2, s[40:43], s35 offen offset:1024 sc1
v_mfma_f32_16x16x32_bf16 v[164:167], a[136:139], a[20:23], v[164:167]
ds_read_b128 a[112:115], v5 offset:40960
v_mfma_f32_16x16x32_bf16 v[188:191], a[136:139], a[24:27], v[188:191]
v_mfma_f32_16x16x32_bf16 v[212:215], a[136:139], a[28:31], v[212:215]
buffer_load_dwordx4 v1, s[4:7], s44 offen offset:2048 sc1 lds
s_add_u32 s44, s28, 4
v_mfma_f32_16x16x32_bf16 v[216:219], a[140:143], a[28:31], v[216:219]
s_mul_i32 s45, s44, 3072
s_add_u32 m0, s45, 98304
s_lshr_b32 s44, s44, 1
v_mfma_f32_16x16x32_bf16 v[192:195], a[140:143], a[24:27], v[192:195]
s_add_u32 s44, s44, 16
s_mul_i32 s44, s44, 6144
s_add_u32 s44, s44, s50
v_mfma_f32_16x16x32_bf16 v[168:171], a[140:143], a[20:23], v[168:171]
ds_read_b128 a[116:119], v5 offset:41984
v_mfma_f32_16x16x32_bf16 v[144:147], a[140:143], a[16:19], v[144:147]
buffer_load_dwordx4 a[8:11], v2, s[40:43], s35 offen offset:2048 sc1
v_mfma_f32_16x16x32_bf16 v[148:151], a[144:147], a[16:19], v[148:151]
ds_read_b128 a[120:123], v6 offset:28672
v_mfma_f32_16x16x32_bf16 v[172:175], a[144:147], a[20:23], v[172:175]
v_mfma_f32_16x16x32_bf16 v[196:199], a[144:147], a[24:27], v[196:199]
buffer_load_dwordx4 v1, s[4:7], s44 offen offset:0 sc1 lds
v_mfma_f32_16x16x32_bf16 v[220:223], a[144:147], a[28:31], v[220:223]
v_mfma_f32_16x16x32_bf16 v[224:227], a[148:151], a[28:31], v[224:227]
v_mfma_f32_16x16x32_bf16 v[200:203], a[148:151], a[24:27], v[200:203]
v_mfma_f32_16x16x32_bf16 v[176:179], a[148:151], a[20:23], v[176:179]
buffer_load_dwordx4 a[12:15], v2, s[40:43], s35 offen offset:3072 sc1
s_add_u32 s35, s35, 4096
v_mfma_f32_16x16x32_bf16 v[152:155], a[148:151], a[16:19], v[152:155]
v_mfma_f32_16x16x32_bf16 a[84:87], a[152:155], a[68:71], a[84:87]
s_waitcnt vmcnt(15) lgkmcnt(0)
v_mfma_f32_16x16x32_bf16 v[132:135], a[96:99], a[32:35], v[132:135]
ds_read_b128 a[128:131], v5 offset:43008
v_mfma_f32_16x16x32_bf16 v[156:159], a[96:99], a[36:39], v[156:159]
buffer_load_dwordx4 a[16:19], v2, s[40:43], s35 offen offset:0 sc1
v_mfma_f32_16x16x32_bf16 v[180:183], a[96:99], a[40:43], v[180:183]
ds_read_b128 a[132:135], v5 offset:44032
v_mfma_f32_16x16x32_bf16 v[204:207], a[96:99], a[44:47], v[204:207]
v_mfma_f32_16x16x32_bf16 v[208:211], a[100:103], a[44:47], v[208:211]
buffer_load_dwordx4 v1, s[4:7], s44 offen offset:1024 sc1 lds
v_mfma_f32_16x16x32_bf16 v[184:187], a[100:103], a[40:43], v[184:187]
ds_read_b128 a[136:139], v5 offset:45056
v_mfma_f32_16x16x32_bf16 v[160:163], a[100:103], a[36:39], v[160:163]
ds_read_b128 a[140:143], v5 offset:46080
v_mfma_f32_16x16x32_bf16 v[136:139], a[100:103], a[32:35], v[136:139]
v_mfma_f32_16x16x32_bf16 v[140:143], a[104:107], a[32:35], v[140:143]
buffer_load_dwordx4 a[20:23], v2, s[40:43], s35 offen offset:1024 sc1
v_mfma_f32_16x16x32_bf16 v[164:167], a[104:107], a[36:39], v[164:167]
ds_read_b128 a[144:147], v5 offset:47104
v_mfma_f32_16x16x32_bf16 v[188:191], a[104:107], a[40:43], v[188:191]
v_mfma_f32_16x16x32_bf16 v[212:215], a[104:107], a[44:47], v[212:215]
buffer_load_dwordx4 v1, s[4:7], s44 offen offset:2048 sc1 lds
s_add_u32 s44, s28, 8
v_mfma_f32_16x16x32_bf16 v[216:219], a[108:111], a[44:47], v[216:219]
s_mul_i32 s45, s44, 3072
s_add_u32 m0, s45, 98304
s_lshr_b32 s44, s44, 1
v_mfma_f32_16x16x32_bf16 v[192:195], a[108:111], a[40:43], v[192:195]
s_add_u32 s44, s44, 16
s_mul_i32 s44, s44, 6144
s_add_u32 s44, s44, s50
v_mfma_f32_16x16x32_bf16 v[168:171], a[108:111], a[36:39], v[168:171]
ds_read_b128 a[148:151], v5 offset:48128
v_mfma_f32_16x16x32_bf16 v[144:147], a[108:111], a[32:35], v[144:147]
buffer_load_dwordx4 a[24:27], v2, s[40:43], s35 offen offset:2048 sc1
v_mfma_f32_16x16x32_bf16 v[148:151], a[112:115], a[32:35], v[148:151]
ds_read_b128 a[152:155], v6 offset:29696
v_mfma_f32_16x16x32_bf16 v[172:175], a[112:115], a[36:39], v[172:175]
v_mfma_f32_16x16x32_bf16 v[196:199], a[112:115], a[40:43], v[196:199]
buffer_load_dwordx4 v1, s[4:7], s44 offen offset:0 sc1 lds
v_mfma_f32_16x16x32_bf16 v[220:223], a[112:115], a[44:47], v[220:223]
v_mfma_f32_16x16x32_bf16 v[224:227], a[116:119], a[44:47], v[224:227]
v_mfma_f32_16x16x32_bf16 v[200:203], a[116:119], a[40:43], v[200:203]
v_mfma_f32_16x16x32_bf16 v[176:179], a[116:119], a[36:39], v[176:179]
buffer_load_dwordx4 a[28:31], v2, s[40:43], s35 offen offset:3072 sc1
s_add_u32 s35, s35, 4096
v_mfma_f32_16x16x32_bf16 v[152:155], a[116:119], a[32:35], v[152:155]
v_mfma_f32_16x16x32_bf16 a[88:91], a[120:123], a[68:71], a[88:91]
s_waitcnt vmcnt(14) lgkmcnt(0)
s_barrier
v_mfma_f32_16x16x32_bf16 v[132:135], a[128:131], a[48:51], v[132:135]
v_add_u32 v5, 49152, v1
v_add_u32 v6, s55, v5
v_mfma_f32_16x16x32_bf16 v[156:159], a[128:131], a[52:55], v[156:159]
buffer_load_dwordx4 a[32:35], v2, s[40:43], s35 offen offset:0 sc1
v_mfma_f32_16x16x32_bf16 v[180:183], a[128:131], a[56:59], v[180:183]
ds_read_b128 a[96:99], v5 offset:0
v_mfma_f32_16x16x32_bf16 v[204:207], a[128:131], a[60:63], v[204:207]
ds_read_b128 a[100:103], v5 offset:1024
v_mfma_f32_16x16x32_bf16 v[208:211], a[132:135], a[60:63], v[208:211]
buffer_load_dwordx4 v1, s[4:7], s44 offen offset:1024 sc1 lds
v_mfma_f32_16x16x32_bf16 v[184:187], a[132:135], a[56:59], v[184:187]
ds_read_b128 a[104:107], v5 offset:2048
v_mfma_f32_16x16x32_bf16 v[160:163], a[132:135], a[52:55], v[160:163]
ds_read_b128 a[108:111], v5 offset:3072
v_mfma_f32_16x16x32_bf16 v[136:139], a[132:135], a[48:51], v[136:139]
ds_write_b128 v231, a[220:223] offset:24576
v_mfma_f32_16x16x32_bf16 v[140:143], a[136:139], a[48:51], v[140:143]
buffer_load_dwordx4 a[36:39], v2, s[40:43], s35 offen offset:1024 sc1
v_mfma_f32_16x16x32_bf16 v[164:167], a[136:139], a[52:55], v[164:167]
ds_read_b128 a[112:115], v5 offset:4096
v_mfma_f32_16x16x32_bf16 v[188:191], a[136:139], a[56:59], v[188:191]
v_mfma_f32_16x16x32_bf16 v[212:215], a[136:139], a[60:63], v[212:215]
buffer_load_dwordx4 v1, s[4:7], s44 offen offset:2048 sc1 lds
s_add_u32 s44, s28, 12
v_mfma_f32_16x16x32_bf16 v[216:219], a[140:143], a[60:63], v[216:219]
s_mul_i32 s45, s44, 3072
s_add_u32 m0, s45, 98304
s_lshr_b32 s44, s44, 1
v_mfma_f32_16x16x32_bf16 v[192:195], a[140:143], a[56:59], v[192:195]
s_add_u32 s44, s44, 16
s_mul_i32 s44, s44, 6144
s_add_u32 s44, s44, s50
v_mfma_f32_16x16x32_bf16 v[168:171], a[140:143], a[52:55], v[168:171]
ds_read_b128 a[116:119], v5 offset:5120
v_mfma_f32_16x16x32_bf16 v[144:147], a[140:143], a[48:51], v[144:147]
buffer_load_dwordx4 a[40:43], v2, s[40:43], s35 offen offset:2048 sc1
v_mfma_f32_16x16x32_bf16 v[148:151], a[144:147], a[48:51], v[148:151]
ds_read_b128 a[120:123], v6 offset:2048
v_mfma_f32_16x16x32_bf16 v[172:175], a[144:147], a[52:55], v[172:175]
ds_write_b128 v231, a[224:227] offset:25600
v_mfma_f32_16x16x32_bf16 v[196:199], a[144:147], a[56:59], v[196:199]
buffer_load_dwordx4 v1, s[4:7], s44 offen offset:0 sc1 lds
v_mfma_f32_16x16x32_bf16 v[220:223], a[144:147], a[60:63], v[220:223]
v_mfma_f32_16x16x32_bf16 v[224:227], a[148:151], a[60:63], v[224:227]
v_mfma_f32_16x16x32_bf16 v[200:203], a[148:151], a[56:59], v[200:203]
v_mfma_f32_16x16x32_bf16 v[176:179], a[148:151], a[52:55], v[176:179]
buffer_load_dwordx4 a[44:47], v2, s[40:43], s35 offen offset:3072 sc1
s_add_u32 s35, s35, 4096
v_mfma_f32_16x16x32_bf16 v[152:155], a[148:151], a[48:51], v[152:155]
ds_write_b128 v231, a[188:191] offset:0
v_mfma_f32_16x16x32_bf16 a[92:95], a[152:155], a[68:71], a[92:95]
s_waitcnt vmcnt(14) lgkmcnt(2)
v_mfma_f32_16x16x32_bf16 v[132:135], a[96:99], a[0:3], v[132:135]
ds_read_b128 a[128:131], v5 offset:6144
v_mfma_f32_16x16x32_bf16 v[156:159], a[96:99], a[4:7], v[156:159]
buffer_load_dwordx4 a[48:51], v2, s[40:43], s35 offen offset:0 sc1
v_mfma_f32_16x16x32_bf16 v[180:183], a[96:99], a[8:11], v[180:183]
ds_read_b128 a[132:135], v5 offset:7168
v_mfma_f32_16x16x32_bf16 v[204:207], a[96:99], a[12:15], v[204:207]
v_mfma_f32_16x16x32_bf16 v[208:211], a[100:103], a[12:15], v[208:211]
buffer_load_dwordx4 v1, s[4:7], s44 offen offset:1024 sc1 lds
v_mfma_f32_16x16x32_bf16 v[184:187], a[100:103], a[8:11], v[184:187]
ds_read_b128 a[136:139], v5 offset:8192
v_mfma_f32_16x16x32_bf16 v[160:163], a[100:103], a[4:7], v[160:163]
ds_read_b128 a[140:143], v5 offset:9216
v_mfma_f32_16x16x32_bf16 v[136:139], a[100:103], a[0:3], v[136:139]
buffer_load_dwordx4 a[52:55], v2, s[40:43], s35 offen offset:1024 sc1
v_mfma_f32_16x16x32_bf16 v[140:143], a[104:107], a[0:3], v[140:143]
ds_write_b128 v231, a[192:195] offset:1024
v_mfma_f32_16x16x32_bf16 v[164:167], a[104:107], a[4:7], v[164:167]
ds_read_b128 a[144:147], v5 offset:10240
v_mfma_f32_16x16x32_bf16 v[188:191], a[104:107], a[8:11], v[188:191]
buffer_load_dwordx4 v1, s[4:7], s44 offen offset:2048 sc1 lds
s_add_u32 s88, s82, 0x200000
L_stub0:
s_cbranch_execz L_stub1
v_mfma_f32_16x16x32_bf16 v[212:215], a[104:107], a[12:15], v[212:215]
ds_read_b128 a[148:151], v5 offset:11264
v_mfma_f32_16x16x32_bf16 v[216:219], a[108:111], a[12:15], v[216:219]
v_mfma_f32_16x16x32_bf16 v[192:195], a[108:111], a[8:11], v[192:195]
buffer_load_dwordx4 a[56:59], v2, s[40:43], s35 offen offset:2048 sc1
v_mfma_f32_16x16x32_bf16 v[168:171], a[108:111], a[4:7], v[168:171]
ds_read_b128 a[152:155], v6 offset:3072
v_mfma_f32_16x16x32_bf16 v[144:147], a[108:111], a[0:3], v[144:147]
v_mfma_f32_16x16x32_bf16 v[148:151], a[112:115], a[0:3], v[148:151]
buffer_load_dwordx4 v[92:95], v1, s[4:7], s88 offen offset:0 sc1
s_add_u32 s63, s28, 12
v_mfma_f32_16x16x32_bf16 v[172:175], a[112:115], a[4:7], v[172:175]
s_lshl_b32 s63, s63, 12
v_mfma_f32_16x16x32_bf16 v[196:199], a[112:115], a[8:11], v[196:199]
v_mfma_f32_16x16x32_bf16 v[220:223], a[112:115], a[12:15], v[220:223]
buffer_load_dwordx4 a[64:67], v3, s[40:43], s63 offen sc1
v_mfma_f32_16x16x32_bf16 v[224:227], a[116:119], a[12:15], v[224:227]
ds_write_b128 v231, a[196:199] offset:8192
v_mfma_f32_16x16x32_bf16 v[200:203], a[116:119], a[8:11], v[200:203]
v_mfma_f32_16x16x32_bf16 v[176:179], a[116:119], a[4:7], v[176:179]
buffer_load_dwordx4 a[60:63], v2, s[40:43], s35 offen offset:3072 sc1
s_add_u32 s35, s35, 4096
v_mfma_f32_16x16x32_bf16 v[152:155], a[116:119], a[0:3], v[152:155]
v_mfma_f32_16x16x32_bf16 a[80:83], a[120:123], a[72:75], a[80:83]
s_waitcnt vmcnt(15) lgkmcnt(1)
v_mfma_f32_16x16x32_bf16 v[132:135], a[128:131], a[16:19], v[132:135]
ds_read_b128 a[96:99], v5 offset:12288
v_mfma_f32_16x16x32_bf16 v[156:159], a[128:131], a[20:23], v[156:159]
buffer_load_dwordx4 a[0:3], v2, s[40:43], s35 offen offset:0 sc1
v_mfma_f32_16x16x32_bf16 v[180:183], a[128:131], a[24:27], v[180:183]
ds_read_b128 a[100:103], v5 offset:13312
v_mfma_f32_16x16x32_bf16 v[204:207], a[128:131], a[28:31], v[204:207]
v_mfma_f32_16x16x32_bf16 v[208:211], a[132:135], a[28:31], v[208:211]
buffer_load_dwordx4 v[96:99], v1, s[4:7], s88 offen offset:1024 sc1
v_mfma_f32_16x16x32_bf16 v[184:187], a[132:135], a[24:27], v[184:187]
ds_read_b128 a[104:107], v5 offset:14336
v_mfma_f32_16x16x32_bf16 v[160:163], a[132:135], a[20:23], v[160:163]
ds_read_b128 a[108:111], v5 offset:15360
v_mfma_f32_16x16x32_bf16 v[136:139], a[132:135], a[16:19], v[136:139]
ds_write_b128 v231, a[200:203] offset:9216
v_mfma_f32_16x16x32_bf16 v[140:143], a[136:139], a[16:19], v[140:143]
buffer_load_dwordx4 a[4:7], v2, s[40:43], s35 offen offset:1024 sc1
v_mfma_f32_16x16x32_bf16 v[164:167], a[136:139], a[20:23], v[164:167]
ds_read_b128 a[112:115], v5 offset:16384
v_mfma_f32_16x16x32_bf16 v[188:191], a[136:139], a[24:27], v[188:191]
v_mfma_f32_16x16x32_bf16 v[212:215], a[136:139], a[28:31], v[212:215]
buffer_load_dwordx4 v[100:103], v1, s[4:7], s88 offen offset:2048 sc1
v_mfma_f32_16x16x32_bf16 v[216:219], a[140:143], a[28:31], v[216:219]
ds_read_b128 a[116:119], v5 offset:17408
v_mfma_f32_16x16x32_bf16 v[192:195], a[140:143], a[24:27], v[192:195]
ds_read_b128 a[120:123], v6 offset:4096
v_mfma_f32_16x16x32_bf16 v[168:171], a[140:143], a[20:23], v[168:171]
v_mfma_f32_16x16x32_bf16 v[144:147], a[140:143], a[16:19], v[144:147]
buffer_load_dwordx4 a[8:11], v2, s[40:43], s35 offen offset:2048 sc1
v_mfma_f32_16x16x32_bf16 v[148:151], a[144:147], a[16:19], v[148:151]
ds_write_b128 v231, a[204:207] offset:16384
v_mfma_f32_16x16x32_bf16 v[172:175], a[144:147], a[20:23], v[172:175]
v_mfma_f32_16x16x32_bf16 v[196:199], a[144:147], a[24:27], v[196:199]
buffer_load_dwordx4 v[104:107], v1, s[4:7], s88 offen offset:3072 sc1
s_add_u32 s88, s88, 4096
v_mfma_f32_16x16x32_bf16 v[220:223], a[144:147], a[28:31], v[220:223]
v_mfma_f32_16x16x32_bf16 v[224:227], a[148:151], a[28:31], v[224:227]
v_mfma_f32_16x16x32_bf16 v[200:203], a[148:151], a[24:27], v[200:203]
v_mfma_f32_16x16x32_bf16 v[176:179], a[148:151], a[20:23], v[176:179]
buffer_load_dwordx4 a[12:15], v2, s[40:43], s35 offen offset:3072 sc1
s_add_u32 s35, s35, 4096
v_mfma_f32_16x16x32_bf16 v[152:155], a[148:151], a[16:19], v[152:155]
v_mfma_f32_16x16x32_bf16 a[84:87], a[152:155], a[72:75], a[84:87]
s_waitcnt vmcnt(15) lgkmcnt(1)
v_mfma_f32_16x16x32_bf16 v[132:135], a[96:99], a[32:35], v[132:135]
ds_read_b128 a[128:131], v5 offset:18432
v_mfma_f32_16x16x32_bf16 v[156:159], a[96:99], a[36:39], v[156:159]
buffer_load_dwordx4 a[16:19], v2, s[40:43], s35 offen offset:0 sc1
v_mfma_f32_16x16x32_bf16 v[180:183], a[96:99], a[40:43], v[180:183]
ds_read_b128 a[132:135], v5 offset:19456
v_mfma_f32_16x16x32_bf16 v[204:207], a[96:99], a[44:47], v[204:207]
ds_write_b128 v231, a[208:211] offset:17408
v_mfma_f32_16x16x32_bf16 v[208:211], a[100:103], a[44:47], v[208:211]
buffer_load_dwordx4 v[108:111], v1, s[4:7], s88 offen offset:0 sc1
v_mfma_f32_16x16x32_bf16 v[184:187], a[100:103], a[40:43], v[184:187]
ds_read_b128 a[136:139], v5 offset:20480
v_mfma_f32_16x16x32_bf16 v[160:163], a[100:103], a[36:39], v[160:163]
ds_read_b128 a[140:143], v5 offset:21504
v_mfma_f32_16x16x32_bf16 v[136:139], a[100:103], a[32:35], v[136:139]
v_mfma_f32_16x16x32_bf16 v[140:143], a[104:107], a[32:35], v[140:143]
buffer_load_dwordx4 a[20:23], v2, s[40:43], s35 offen offset:1024 sc1
v_mfma_f32_16x16x32_bf16 v[164:167], a[104:107], a[36:39], v[164:167]
ds_read_b128 a[144:147], v5 offset:22528
v_mfma_f32_16x16x32_bf16 v[188:191], a[104:107], a[40:43], v[188:191]
v_mfma_f32_16x16x32_bf16 v[212:215], a[104:107], a[44:47], v[212:215]
buffer_load_dwordx4 v[112:115], v1, s[4:7], s88 offen offset:1024 sc1
v_mfma_f32_16x16x32_bf16 v[216:219], a[108:111], a[44:47], v[216:219]
ds_read_b128 a[148:151], v5 offset:23552
v_mfma_f32_16x16x32_bf16 v[192:195], a[108:111], a[40:43], v[192:195]
ds_read_b128 a[152:155], v6 offset:5120
v_mfma_f32_16x16x32_bf16 v[168:171], a[108:111], a[36:39], v[168:171]
v_mfma_f32_16x16x32_bf16 v[144:147], a[108:111], a[32:35], v[144:147]
buffer_load_dwordx4 a[24:27], v2, s[40:43], s35 offen offset:2048 sc1
v_mfma_f32_16x16x32_bf16 v[148:151], a[112:115], a[32:35], v[148:151]
v_mfma_f32_16x16x32_bf16 v[172:175], a[112:115], a[36:39], v[172:175]
v_mfma_f32_16x16x32_bf16 v[196:199], a[112:115], a[40:43], v[196:199]
buffer_load_dwordx4 v[116:119], v1, s[4:7], s88 offen offset:2048 sc1
v_mfma_f32_16x16x32_bf16 v[220:223], a[112:115], a[44:47], v[220:223]
v_mfma_f32_16x16x32_bf16 v[224:227], a[116:119], a[44:47], v[224:227]
v_mfma_f32_16x16x32_bf16 v[200:203], a[116:119], a[40:43], v[200:203]
v_mfma_f32_16x16x32_bf16 v[176:179], a[116:119], a[36:39], v[176:179]
buffer_load_dwordx4 a[28:31], v2, s[40:43], s35 offen offset:3072 sc1
s_add_u32 s35, s35, 4096
v_mfma_f32_16x16x32_bf16 v[152:155], a[116:119], a[32:35], v[152:155]
v_mfma_f32_16x16x32_bf16 a[88:91], a[120:123], a[72:75], a[88:91]
s_waitcnt vmcnt(14) lgkmcnt(0)
s_barrier
v_mfma_f32_16x16x32_bf16 v[132:135], a[128:131], a[48:51], v[132:135]
ds_read_b128 a[96:99], v5 offset:24576
v_mfma_f32_16x16x32_bf16 v[156:159], a[128:131], a[52:55], v[156:159]
buffer_load_dwordx4 a[32:35], v2, s[40:43], s35 offen offset:0 sc1
v_mfma_f32_16x16x32_bf16 v[180:183], a[128:131], a[56:59], v[180:183]
ds_read_b128 a[100:103], v5 offset:25600
v_mfma_f32_16x16x32_bf16 v[204:207], a[128:131], a[60:63], v[204:207]
ds_read_b64_tr_b16 a[220:221], v230 offset:0
v_mfma_f32_16x16x32_bf16 v[208:211], a[132:135], a[60:63], v[208:211]
buffer_load_dwordx4 v[120:123], v1, s[4:7], s88 offen offset:3072 sc1
s_add_u32 s88, s83, 0x200000
v_mfma_f32_16x16x32_bf16 v[184:187], a[132:135], a[56:59], v[184:187]
ds_read_b128 a[104:107], v5 offset:26624
v_mfma_f32_16x16x32_bf16 v[160:163], a[132:135], a[52:55], v[160:163]
ds_read_b128 a[108:111], v5 offset:27648
v_mfma_f32_16x16x32_bf16 v[136:139], a[132:135], a[48:51], v[136:139]
ds_read_b64_tr_b16 a[222:223], v230 offset:2048
v_mfma_f32_16x16x32_bf16 v[140:143], a[136:139], a[48:51], v[140:143]
buffer_load_dwordx4 a[36:39], v2, s[40:43], s35 offen offset:1024 sc1
v_mfma_f32_16x16x32_bf16 v[164:167], a[136:139], a[52:55], v[164:167]
ds_read_b128 a[112:115], v5 offset:28672
v_mfma_f32_16x16x32_bf16 v[188:191], a[136:139], a[56:59], v[188:191]
v_mfma_f32_16x16x32_bf16 v[212:215], a[136:139], a[60:63], v[212:215]
buffer_load_dwordx4 v[124:127], v1, s[4:7], s88 offen offset:0 sc1
v_mfma_f32_16x16x32_bf16 v[216:219], a[140:143], a[60:63], v[216:219]
ds_read_b128 a[116:119], v5 offset:29696
v_mfma_f32_16x16x32_bf16 v[192:195], a[140:143], a[56:59], v[192:195]
ds_read_b128 a[120:123], v6 offset:26624
v_mfma_f32_16x16x32_bf16 v[168:171], a[140:143], a[52:55], v[168:171]
ds_read_b64_tr_b16 a[224:225], v230 offset:8
v_mfma_f32_16x16x32_bf16 v[144:147], a[140:143], a[48:51], v[144:147]
buffer_load_dwordx4 a[40:43], v2, s[40:43], s35 offen offset:2048 sc1
v_mfma_f32_16x16x32_bf16 v[148:151], a[144:147], a[48:51], v[148:151]
v_mfma_f32_16x16x32_bf16 v[172:175], a[144:147], a[52:55], v[172:175]
ds_read_b64_tr_b16 a[226:227], v230 offset:2056
v_mfma_f32_16x16x32_bf16 v[196:199], a[144:147], a[56:59], v[196:199]
buffer_load_dwordx4 v[128:131], v1, s[4:7], s88 offen offset:1024 sc1
s_add_u32 s63, s28, 16
v_mfma_f32_16x16x32_bf16 v[220:223], a[144:147], a[60:63], v[220:223]
s_lshl_b32 s63, s63, 12
v_mfma_f32_16x16x32_bf16 v[224:227], a[148:151], a[60:63], v[224:227]
v_mfma_f32_16x16x32_bf16 v[200:203], a[148:151], a[56:59], v[200:203]
v_mfma_f32_16x16x32_bf16 v[176:179], a[148:151], a[52:55], v[176:179]
buffer_load_dwordx4 a[44:47], v2, s[40:43], s35 offen offset:3072 sc1
s_add_u32 s35, s35, 4096
v_mfma_f32_16x16x32_bf16 v[152:155], a[148:151], a[48:51], v[152:155]
ds_read_b64_tr_b16 a[188:189], v248 offset:0
v_mfma_f32_16x16x32_bf16 a[92:95], a[152:155], a[72:75], a[92:95]
s_waitcnt vmcnt(14) lgkmcnt(3)
v_mfma_f32_16x16x32_bf16 v[132:135], a[96:99], a[0:3], v[132:135]
ds_read_b128 a[128:131], v5 offset:30720
v_add_f32_dpp v48, v48, v48 row_ror:8 row_mask:0xf bank_mask:0xf
v_mfma_f32_16x16x32_bf16 v[156:159], a[96:99], a[4:7], v[156:159]
buffer_load_dwordx4 a[48:51], v2, s[40:43], s35 offen offset:0 sc1
v_mfma_f32_16x16x32_bf16 v[180:183], a[96:99], a[8:11], v[180:183]
ds_read_b128 a[132:135], v5 offset:31744
v_add_f32_dpp v49, v49, v49 row_ror:8 row_mask:0xf bank_mask:0xf
v_mfma_f32_16x16x32_bf16 v[204:207], a[96:99], a[12:15], v[204:207]
ds_read_b64_tr_b16 a[190:191], v248 offset:512
v_add_f32_dpp v50, v50, v50 row_ror:8 row_mask:0xf bank_mask:0xf
v_mfma_f32_16x16x32_bf16 v[208:211], a[100:103], a[12:15], v[208:211]
ds_read_b128 a[136:139], v5 offset:32768
v_add_f32_dpp v51, v51, v51 row_ror:8 row_mask:0xf bank_mask:0xf
v_mfma_f32_16x16x32_bf16 v[184:187], a[100:103], a[8:11], v[184:187]
v_add_f32_dpp v52, v52, v52 row_ror:8 row_mask:0xf bank_mask:0xf
v_add_f32_dpp v53, v53, v53 row_ror:8 row_mask:0xf bank_mask:0xf
v_mfma_f32_16x16x32_bf16 v[160:163], a[100:103], a[4:7], v[160:163]
buffer_load_dwordx4 a[52:55], v2, s[40:43], s35 offen offset:1024 sc1
v_mfma_f32_16x16x32_bf16 v[136:139], a[100:103], a[0:3], v[136:139]
ds_read_b128 a[140:143], v5 offset:33792
v_add_f32_dpp v54, v54, v54 row_ror:8 row_mask:0xf bank_mask:0xf
v_mfma_f32_16x16x32_bf16 v[140:143], a[104:107], a[0:3], v[140:143]
v_add_f32_dpp v55, v55, v55 row_ror:8 row_mask:0xf bank_mask:0xf
v_add_f32_dpp v48, v48, v48 row_ror:4 row_mask:0xf bank_mask:0xf
v_mfma_f32_16x16x32_bf16 v[164:167], a[104:107], a[4:7], v[164:167]
ds_read_b128 a[144:147], v5 offset:34816
v_add_f32_dpp v49, v49, v49 row_ror:4 row_mask:0xf bank_mask:0xf
v_mfma_f32_16x16x32_bf16 v[188:191], a[104:107], a[8:11], v[188:191]
ds_read_b64_tr_b16 a[192:193], v248 offset:4096
v_add_f32_dpp v50, v50, v50 row_ror:4 row_mask:0xf bank_mask:0xf
v_mfma_f32_16x16x32_bf16 v[212:215], a[104:107], a[12:15], v[212:215]
buffer_load_dwordx4 a[68:71], v3, s[40:43], s63 offen sc1
s_add_u32 s44, s28, 0
v_mfma_f32_16x16x32_bf16 v[216:219], a[108:111], a[12:15], v[216:219]
s_mul_i32 s45, s44, 3072
s_add_u32 m0, s45, 0
s_lshr_b32 s44, s44, 1
v_mfma_f32_16x16x32_bf16 v[192:195], a[108:111], a[8:11], v[192:195]
s_add_u32 s44, s44, 24
s_mul_i32 s44, s44, 6144
s_add_u32 s44, s44, s50
v_mfma_f32_16x16x32_bf16 v[168:171], a[108:111], a[4:7], v[168:171]
ds_read_b128 a[148:151], v5 offset:35840
v_add_f32_dpp v51, v51, v51 row_ror:4 row_mask:0xf bank_mask:0xf
v_mfma_f32_16x16x32_bf16 v[144:147], a[108:111], a[0:3], v[144:147]
ds_read_b128 a[152:155], v6 offset:27648
v_add_f32_dpp v52, v52, v52 row_ror:4 row_mask:0xf bank_mask:0xf
v_mfma_f32_16x16x32_bf16 v[148:151], a[112:115], a[0:3], v[148:151]
buffer_load_dwordx4 a[56:59], v2, s[40:43], s35 offen offset:2048 sc1
v_mfma_f32_16x16x32_bf16 v[172:175], a[112:115], a[4:7], v[172:175]
ds_read_b64_tr_b16 a[194:195], v248 offset:4608
v_add_f32_dpp v53, v53, v53 row_ror:4 row_mask:0xf bank_mask:0xf
v_mfma_f32_16x16x32_bf16 v[196:199], a[112:115], a[8:11], v[196:199]
v_add_f32_dpp v54, v54, v54 row_ror:4 row_mask:0xf bank_mask:0xf
v_add_f32_dpp v55, v55, v55 row_ror:4 row_mask:0xf bank_mask:0xf
v_mfma_f32_16x16x32_bf16 v[220:223], a[112:115], a[12:15], v[220:223]
v_add_f32_dpp v48, v48, v48 row_ror:2 row_mask:0xf bank_mask:0xf
v_add_f32_dpp v49, v49, v49 row_ror:2 row_mask:0xf bank_mask:0xf
v_mfma_f32_16x16x32_bf16 v[224:227], a[116:119], a[12:15], v[224:227]
v_add_f32_dpp v50, v50, v50 row_ror:2 row_mask:0xf bank_mask:0xf
v_add_f32_dpp v51, v51, v51 row_ror:2 row_mask:0xf bank_mask:0xf
v_mfma_f32_16x16x32_bf16 v[200:203], a[116:119], a[8:11], v[200:203]
buffer_load_dwordx4 a[60:63], v2, s[40:43], s35 offen offset:3072 sc1
s_add_u32 s35, s35, 4096
v_mfma_f32_16x16x32_bf16 v[176:179], a[116:119], a[4:7], v[176:179]
ds_read_b64_tr_b16 a[196:197], v249 offset:32
v_add_f32_dpp v52, v52, v52 row_ror:2 row_mask:0xf bank_mask:0xf
v_mfma_f32_16x16x32_bf16 v[152:155], a[116:119], a[0:3], v[152:155]
v_add_f32_dpp v53, v53, v53 row_ror:2 row_mask:0xf bank_mask:0xf
v_add_f32_dpp v54, v54, v54 row_ror:2 row_mask:0xf bank_mask:0xf
v_mfma_f32_16x16x32_bf16 a[80:83], a[120:123], a[64:67], a[80:83]
v_add_f32_dpp v55, v55, v55 row_ror:2 row_mask:0xf bank_mask:0xf
s_waitcnt vmcnt(12) lgkmcnt(2)
v_mfma_f32_16x16x32_bf16 v[132:135], a[128:131], a[16:19], v[132:135]
ds_read_b128 a[96:99], v5 offset:36864
v_add_f32_dpp v48, v48, v48 row_ror:1 row_mask:0xf bank_mask:0xf
v_mfma_f32_16x16x32_bf16 v[156:159], a[128:131], a[20:23], v[156:159]
buffer_load_dwordx4 a[0:3], v2, s[40:43], s35 offen offset:0 sc1
v_mfma_f32_16x16x32_bf16 v[180:183], a[128:131], a[24:27], v[180:183]
ds_read_b128 a[100:103], v5 offset:37888
v_add_f32_dpp v49, v49, v49 row_ror:1 row_mask:0xf bank_mask:0xf
v_mfma_f32_16x16x32_bf16 v[204:207], a[128:131], a[28:31], v[204:207]
ds_read_b64_tr_b16 a[198:199], v249 offset:544
v_add_f32_dpp v50, v50, v50 row_ror:1 row_mask:0xf bank_mask:0xf
v_mfma_f32_16x16x32_bf16 v[208:211], a[132:135], a[28:31], v[208:211]
ds_read_b128 a[104:107], v5 offset:38912
v_add_f32_dpp v51, v51, v51 row_ror:1 row_mask:0xf bank_mask:0xf
v_mfma_f32_16x16x32_bf16 v[184:187], a[132:135], a[24:27], v[184:187]
v_add_f32_dpp v52, v52, v52 row_ror:1 row_mask:0xf bank_mask:0xf
v_add_f32_dpp v53, v53, v53 row_ror:1 row_mask:0xf bank_mask:0xf
v_mfma_f32_16x16x32_bf16 v[160:163], a[132:135], a[20:23], v[160:163]
ds_read_b128 a[108:111], v5 offset:39936
v_add_f32_dpp v54, v54, v54 row_ror:1 row_mask:0xf bank_mask:0xf
v_mfma_f32_16x16x32_bf16 v[136:139], a[132:135], a[16:19], v[136:139]
buffer_load_dwordx4 a[4:7], v2, s[40:43], s35 offen offset:1024 sc1
v_mfma_f32_16x16x32_bf16 v[140:143], a[136:139], a[16:19], v[140:143]
ds_read_b64_tr_b16 a[200:201], v249 offset:4128
v_add_f32_dpp v55, v55, v55 row_ror:1 row_mask:0xf bank_mask:0xf
v_mfma_f32_16x16x32_bf16 v[164:167], a[136:139], a[20:23], v[164:167]
ds_read_b128 a[112:115], v5 offset:40960
v_add_u32 v233, 159744, v233
v_mfma_f32_16x16x32_bf16 v[188:191], a[136:139], a[24:27], v[188:191]
s_lshl_b32 s36, s28, 6
s_lshl_b32 s37, s39, 6
v_mfma_f32_16x16x32_bf16 v[212:215], a[136:139], a[28:31], v[212:215]
ds_read_b128 a[116:119], v5 offset:41984
v_add_u32 v232, s36, v233
v_mfma_f32_16x16x32_bf16 v[216:219], a[140:143], a[28:31], v[216:219]
v_add_u32 v235, s37, v233
v_mfma_f32_16x16x32_bf16 v[192:195], a[140:143], a[24:27], v[192:195]
buffer_load_dwordx4 a[8:11], v2, s[40:43], s35 offen offset:2048 sc1
v_mfma_f32_16x16x32_bf16 v[168:171], a[140:143], a[20:23], v[168:171]
ds_read_b128 a[120:123], v6 offset:28672
v_mfma_f32_16x16x32_bf16 v[144:147], a[140:143], a[16:19], v[144:147]
ds_read_b64_tr_b16 a[202:203], v249 offset:4640
v_mfma_f32_16x16x32_bf16 v[148:151], a[144:147], a[16:19], v[148:151]
v_mfma_f32_16x16x32_bf16 v[172:175], a[144:147], a[20:23], v[172:175]
v_mfma_f32_16x16x32_bf16 v[196:199], a[144:147], a[24:27], v[196:199]
v_mfma_f32_16x16x32_bf16 v[220:223], a[144:147], a[28:31], v[220:223]
buffer_load_dwordx4 a[12:15], v2, s[40:43], s35 offen offset:3072 sc1
s_add_u32 s35, s35, 4096
v_mfma_f32_16x16x32_bf16 v[224:227], a[148:151], a[28:31], v[224:227]
ds_read_b64_tr_b16 a[204:205], v248 offset:8192
v_mfma_f32_16x16x32_bf16 v[200:203], a[148:151], a[24:27], v[200:203]
v_mfma_f32_16x16x32_bf16 v[176:179], a[148:151], a[20:23], v[176:179]
v_mfma_f32_16x16x32_bf16 v[152:155], a[148:151], a[16:19], v[152:155]
v_mfma_f32_16x16x32_bf16 a[84:87], a[152:155], a[64:67], a[84:87]
ds_read_b64_tr_b16 a[206:207], v248 offset:8704
s_waitcnt vmcnt(9) lgkmcnt(3)
v_mfma_f32_16x16x32_bf16 v[132:135], a[96:99], a[32:35], v[132:135]
ds_read_b128 a[128:131], v5 offset:43008
v_mfma_f32_16x16x32_bf16 v[156:159], a[96:99], a[36:39], v[156:159]
buffer_load_dwordx4 a[16:19], v2, s[40:43], s35 offen offset:0 sc1
v_mfma_f32_16x16x32_bf16 v[180:183], a[96:99], a[40:43], v[180:183]
ds_read_b128 a[132:135], v5 offset:44032
v_mfma_f32_16x16x32_bf16 v[204:207], a[96:99], a[44:47], v[204:207]
ds_write_b128 v232, v[48:51]
v_mfma_f32_16x16x32_bf16 v[208:211], a[100:103], a[44:47], v[208:211]
ds_read_b128 a[136:139], v5 offset:45056
v_mfma_f32_16x16x32_bf16 v[184:187], a[100:103], a[40:43], v[184:187]
ds_read_b64_tr_b16 a[208:209], v248 offset:12288
v_mfma_f32_16x16x32_bf16 v[160:163], a[100:103], a[36:39], v[160:163]
ds_read_b128 a[140:143], v5 offset:46080
v_mfma_f32_16x16x32_bf16 v[136:139], a[100:103], a[32:35], v[136:139]
buffer_load_dwordx4 a[20:23], v2, s[40:43], s35 offen offset:1024 sc1
v_mfma_f32_16x16x32_bf16 v[140:143], a[104:107], a[32:35], v[140:143]
ds_write_b128 v235, v[52:55]
v_mfma_f32_16x16x32_bf16 v[164:167], a[104:107], a[36:39], v[164:167]
ds_read_b128 a[144:147], v5 offset:47104
v_mfma_f32_16x16x32_bf16 v[188:191], a[104:107], a[40:43], v[188:191]
v_mfma_f32_16x16x32_bf16 v[212:215], a[104:107], a[44:47], v[212:215]
ds_read_b128 a[148:151], v5 offset:48128
v_mfma_f32_16x16x32_bf16 v[216:219], a[108:111], a[44:47], v[216:219]
ds_read_b64_tr_b16 a[210:211], v248 offset:12800
v_mfma_f32_16x16x32_bf16 v[192:195], a[108:111], a[40:43], v[192:195]
buffer_load_dwordx4 a[24:27], v2, s[40:43], s35 offen offset:2048 sc1
v_mfma_f32_16x16x32_bf16 v[168:171], a[108:111], a[36:39], v[168:171]
ds_read_b128 a[152:155], v6 offset:29696
v_mfma_f32_16x16x32_bf16 v[144:147], a[108:111], a[32:35], v[144:147]
v_mfma_f32_16x16x32_bf16 v[148:151], a[112:115], a[32:35], v[148:151]
v_mfma_f32_16x16x32_bf16 v[172:175], a[112:115], a[36:39], v[172:175]
v_mfma_f32_16x16x32_bf16 v[196:199], a[112:115], a[40:43], v[196:199]
v_mfma_f32_16x16x32_bf16 v[220:223], a[112:115], a[44:47], v[220:223]
buffer_load_dwordx4 a[28:31], v2, s[40:43], s35 offen offset:3072 sc1
s_add_u32 s35, s35, 4096
v_mfma_f32_16x16x32_bf16 v[224:227], a[116:119], a[44:47], v[224:227]
v_mfma_f32_16x16x32_bf16 v[200:203], a[116:119], a[40:43], v[200:203]
v_mfma_f32_16x16x32_bf16 v[176:179], a[116:119], a[36:39], v[176:179]
v_mfma_f32_16x16x32_bf16 v[152:155], a[116:119], a[32:35], v[152:155]
v_mfma_f32_16x16x32_bf16 a[88:91], a[120:123], a[64:67], a[88:91]
s_waitcnt vmcnt(8) lgkmcnt(0)
s_barrier
v_mfma_f32_16x16x32_bf16 v[132:135], a[128:131], a[48:51], v[132:135]
v_add_u32 v5, 98304, v1
v_add_u32 v6, s55, v5
v_mfma_f32_16x16x32_bf16 v[156:159], a[128:131], a[52:55], v[156:159]
buffer_load_dwordx4 a[32:35], v2, s[40:43], s35 offen offset:0 sc1
v_mfma_f32_16x16x32_bf16 v[180:183], a[128:131], a[56:59], v[180:183]
ds_read_b128 a[96:99], v5 offset:0
v_mfma_f32_16x16x32_bf16 v[204:207], a[128:131], a[60:63], v[204:207]
ds_read_b128 a[100:103], v5 offset:1024
v_mfma_f32_16x16x32_bf16 v[208:211], a[132:135], a[60:63], v[208:211]
buffer_load_dwordx4 v1, s[4:7], s44 offen offset:0 sc1 lds
v_mfma_f32_16x16x32_bf16 v[184:187], a[132:135], a[56:59], v[184:187]
ds_read_b128 a[104:107], v5 offset:2048
v_mfma_f32_16x16x32_bf16 v[160:163], a[132:135], a[52:55], v[160:163]
ds_read_b128 a[108:111], v5 offset:3072
v_mfma_f32_16x16x32_bf16 v[136:139], a[132:135], a[48:51], v[136:139]
ds_read_b128 v[48:51], v233 offset:0
v_mfma_f32_16x16x32_bf16 v[140:143], a[136:139], a[48:51], v[140:143]
buffer_load_dwordx4 a[36:39], v2, s[40:43], s35 offen offset:1024 sc1
v_mfma_f32_16x16x32_bf16 v[164:167], a[136:139], a[52:55], v[164:167]
ds_read_b128 a[112:115], v5 offset:4096
v_mfma_f32_16x16x32_bf16 v[188:191], a[136:139], a[56:59], v[188:191]
ds_read_b128 v[52:55], v233 offset:64
v_mfma_f32_16x16x32_bf16 v[212:215], a[136:139], a[60:63], v[212:215]
buffer_load_dwordx4 v1, s[4:7], s44 offen offset:1024 sc1 lds
v_mfma_f32_16x16x32_bf16 v[216:219], a[140:143], a[60:63], v[216:219]
ds_read_b128 a[116:119], v5 offset:5120
v_mfma_f32_16x16x32_bf16 v[192:195], a[140:143], a[56:59], v[192:195]
ds_read_b128 a[120:123], v6 offset:2048
v_mfma_f32_16x16x32_bf16 v[168:171], a[140:143], a[52:55], v[168:171]
v_mfma_f32_16x16x32_bf16 v[144:147], a[140:143], a[48:51], v[144:147]
buffer_load_dwordx4 a[40:43], v2, s[40:43], s35 offen offset:2048 sc1
v_mfma_f32_16x16x32_bf16 v[148:151], a[144:147], a[48:51], v[148:151]
v_mfma_f32_16x16x32_bf16 v[172:175], a[144:147], a[52:55], v[172:175]
v_mfma_f32_16x16x32_bf16 v[196:199], a[144:147], a[56:59], v[196:199]
buffer_load_dwordx4 v1, s[4:7], s44 offen offset:2048 sc1 lds
s_add_u32 s44, s28, 4
v_mfma_f32_16x16x32_bf16 v[220:223], a[144:147], a[60:63], v[220:223]
s_mul_i32 s45, s44, 3072
s_add_u32 m0, s45, 0
s_lshr_b32 s44, s44, 1
v_mfma_f32_16x16x32_bf16 v[224:227], a[148:151], a[60:63], v[224:227]
s_add_u32 s44, s44, 24
s_mul_i32 s44, s44, 6144
s_add_u32 s44, s44, s50
v_mfma_f32_16x16x32_bf16 v[200:203], a[148:151], a[56:59], v[200:203]
ds_read_b128 v[56:59], v233 offset:128
v_mfma_f32_16x16x32_bf16 v[176:179], a[148:151], a[52:55], v[176:179]
buffer_load_dwordx4 a[44:47], v2, s[40:43], s35 offen offset:3072 sc1
s_add_u32 s35, s35, 4096
v_mfma_f32_16x16x32_bf16 v[152:155], a[148:151], a[48:51], v[152:155]
v_mfma_f32_16x16x32_bf16 a[92:95], a[152:155], a[64:67], a[92:95]
s_waitcnt vmcnt(11) lgkmcnt(1)
v_mfma_f32_16x16x32_bf16 v[132:135], a[96:99], a[0:3], v[132:135]
ds_read_b128 a[128:131], v5 offset:6144
v_mfma_f32_16x16x32_bf16 v[156:159], a[96:99], a[4:7], v[156:159]
buffer_load_dwordx4 a[48:51], v2, s[40:43], s35 offen offset:0 sc1
v_mfma_f32_16x16x32_bf16 v[180:183], a[96:99], a[8:11], v[180:183]
ds_read_b128 a[132:135], v5 offset:7168
v_mfma_f32_16x16x32_bf16 v[204:207], a[96:99], a[12:15], v[204:207]
v_mfma_f32_16x16x32_bf16 v[236:239], a[188:191], v[16:19], 0
v_mfma_f32_16x16x32_bf16 v[208:211], a[100:103], a[12:15], v[208:211]
buffer_load_dwordx4 v1, s[4:7], s44 offen offset:0 sc1 lds
v_mfma_f32_16x16x32_bf16 v[184:187], a[100:103], a[8:11], v[184:187]
ds_read_b128 a[136:139], v5 offset:8192
v_mfma_f32_16x16x32_bf16 v[160:163], a[100:103], a[4:7], v[160:163]
ds_read_b128 a[140:143], v5 offset:9216
v_mfma_f32_16x16x32_bf16 v[136:139], a[100:103], a[0:3], v[136:139]
buffer_load_dwordx4 a[52:55], v2, s[40:43], s35 offen offset:1024 sc1
v_mfma_f32_16x16x32_bf16 v[140:143], a[104:107], a[0:3], v[140:143]
v_mfma_f32_16x16x32_bf16 v[240:243], a[196:199], v[16:19], 0
v_mfma_f32_16x16x32_bf16 v[164:167], a[104:107], a[4:7], v[164:167]
ds_read_b128 a[144:147], v5 offset:10240
v_mfma_f32_16x16x32_bf16 v[188:191], a[104:107], a[8:11], v[188:191]
buffer_load_dwordx4 v1, s[4:7], s44 offen offset:1024 sc1 lds
v_mfma_f32_16x16x32_bf16 v[212:215], a[104:107], a[12:15], v[212:215]
ds_read_b128 a[148:151], v5 offset:11264
v_mfma_f32_16x16x32_bf16 v[216:219], a[108:111], a[12:15], v[216:219]
v_mfma_f32_16x16x32_bf16 v[244:247], a[204:207], v[16:19], 0
v_mfma_f32_16x16x32_bf16 v[192:195], a[108:111], a[8:11], v[192:195]
buffer_load_dwordx4 a[56:59], v2, s[40:43], s35 offen offset:2048 sc1
v_mfma_f32_16x16x32_bf16 v[168:171], a[108:111], a[4:7], v[168:171]
ds_read_b128 a[152:155], v6 offset:3072
v_mfma_f32_16x16x32_bf16 v[144:147], a[108:111], a[0:3], v[144:147]
v_mfma_f32_16x16x32_bf16 v[236:239], a[192:195], v[16:19], v[236:239]
v_mfma_f32_16x16x32_bf16 v[148:151], a[112:115], a[0:3], v[148:151]
buffer_load_dwordx4 v1, s[4:7], s44 offen offset:2048 sc1 lds
s_add_u32 s63, s28, 20
v_mfma_f32_16x16x32_bf16 v[172:175], a[112:115], a[4:7], v[172:175]
s_lshl_b32 s63, s63, 12
ds_read_b128 v[60:63], v233 offset:192
v_mfma_f32_16x16x32_bf16 v[196:199], a[112:115], a[8:11], v[196:199]
v_mfma_f32_16x16x32_bf16 v[240:243], a[200:203], v[16:19], v[240:243]
v_mfma_f32_16x16x32_bf16 v[220:223], a[112:115], a[12:15], v[220:223]
buffer_load_dwordx4 a[72:75], v3, s[40:43], s63 offen sc1
s_add_u32 s44, s28, 8
v_mfma_f32_16x16x32_bf16 v[224:227], a[116:119], a[12:15], v[224:227]
s_mul_i32 s45, s44, 3072
s_add_u32 m0, s45, 0
s_lshr_b32 s44, s44, 1
v_mfma_f32_16x16x32_bf16 v[200:203], a[116:119], a[8:11], v[200:203]
s_add_u32 s44, s44, 24
s_mul_i32 s44, s44, 6144
s_add_u32 s44, s44, s50
v_mfma_f32_16x16x32_bf16 v[176:179], a[116:119], a[4:7], v[176:179]
buffer_load_dwordx4 a[60:63], v2, s[40:43], s35 offen offset:3072 sc1
s_add_u32 s35, s35, 4096
v_mfma_f32_16x16x32_bf16 v[152:155], a[116:119], a[0:3], v[152:155]
v_mfma_f32_16x16x32_bf16 v[244:247], a[208:211], v[16:19], v[244:247]
v_mfma_f32_16x16x32_bf16 a[80:83], a[120:123], a[68:71], a[80:83]
ds_read_b128 v[64:67], v233 offset:256
s_waitcnt vmcnt(15) lgkmcnt(2)
v_mfma_f32_16x16x32_bf16 v[132:135], a[128:131], a[16:19], v[132:135]
ds_read_b128 a[96:99], v5 offset:12288
v_mfma_f32_16x16x32_bf16 v[156:159], a[128:131], a[20:23], v[156:159]
buffer_load_dwordx4 a[0:3], v2, s[40:43], s35 offen offset:0 sc1
v_mfma_f32_16x16x32_bf16 v[180:183], a[128:131], a[24:27], v[180:183]
ds_read_b128 a[100:103], v5 offset:13312
v_mfma_f32_16x16x32_bf16 v[204:207], a[128:131], a[28:31], v[204:207]
ds_read_b128 v[68:71], v233 offset:320
v_mfma_f32_16x16x32_bf16 v[208:211], a[132:135], a[28:31], v[208:211]
buffer_load_dwordx4 v1, s[4:7], s44 offen offset:0 sc1 lds
v_mfma_f32_16x16x32_bf16 v[184:187], a[132:135], a[24:27], v[184:187]
ds_read_b128 a[104:107], v5 offset:14336
v_mfma_f32_16x16x32_bf16 v[160:163], a[132:135], a[20:23], v[160:163]
ds_read_b128 a[108:111], v5 offset:15360
v_mfma_f32_16x16x32_bf16 v[136:139], a[132:135], a[16:19], v[136:139]
ds_read_b128 v[72:75], v232 offset:128
v_mfma_f32_16x16x32_bf16 v[140:143], a[136:139], a[16:19], v[140:143]
buffer_load_dwordx4 a[4:7], v2, s[40:43], s35 offen offset:1024 sc1
v_mfma_f32_16x16x32_bf16 v[164:167], a[136:139], a[20:23], v[164:167]
ds_read_b128 a[112:115], v5 offset:16384
v_mfma_f32_16x16x32_bf16 v[188:191], a[136:139], a[24:27], v[188:191]
v_mfma_f32_16x16x32_bf16 v[212:215], a[136:139], a[28:31], v[212:215]
buffer_load_dwordx4 v1, s[4:7], s44 offen offset:1024 sc1 lds
v_mfma_f32_16x16x32_bf16 v[216:219], a[140:143], a[28:31], v[216:219]
ds_read_b128 a[116:119], v5 offset:17408
v_mfma_f32_16x16x32_bf16 v[192:195], a[140:143], a[24:27], v[192:195]
ds_read_b128 a[120:123], v6 offset:4096
v_mfma_f32_16x16x32_bf16 v[168:171], a[140:143], a[20:23], v[168:171]
v_mfma_f32_16x16x32_bf16 v[144:147], a[140:143], a[16:19], v[144:147]
buffer_load_dwordx4 a[8:11], v2, s[40:43], s35 offen offset:2048 sc1
v_mfma_f32_16x16x32_bf16 v[148:151], a[144:147], a[16:19], v[148:151]
v_mfma_f32_16x16x32_bf16 v[172:175], a[144:147], a[20:23], v[172:175]
v_mfma_f32_16x16x32_bf16 v[196:199], a[144:147], a[24:27], v[196:199]
buffer_load_dwordx4 v1, s[4:7], s44 offen offset:2048 sc1 lds
s_add_u32 s44, s28, 12
v_mfma_f32_16x16x32_bf16 v[220:223], a[144:147], a[28:31], v[220:223]
s_mul_i32 s45, s44, 3072
s_add_u32 m0, s45, 0
s_lshr_b32 s44, s44, 1
v_mfma_f32_16x16x32_bf16 v[224:227], a[148:151], a[28:31], v[224:227]
s_add_u32 s44, s44, 24
s_mul_i32 s44, s44, 6144
s_add_u32 s44, s44, s50
v_mfma_f32_16x16x32_bf16 v[200:203], a[148:151], a[24:27], v[200:203]
v_mfma_f32_16x16x32_bf16 v[176:179], a[148:151], a[20:23], v[176:179]
buffer_load_dwordx4 a[12:15], v2, s[40:43], s35 offen offset:3072 sc1
s_add_u32 s35, s35, 4096
v_mfma_f32_16x16x32_bf16 v[152:155], a[148:151], a[16:19], v[152:155]
v_mfma_f32_16x16x32_bf16 a[84:87], a[152:155], a[68:71], a[84:87]
s_waitcnt vmcnt(15) lgkmcnt(0)
v_mfma_f32_16x16x32_bf16 v[132:135], a[96:99], a[32:35], v[132:135]
ds_read_b128 a[128:131], v5 offset:18432
v_mfma_f32_16x16x32_bf16 v[156:159], a[96:99], a[36:39], v[156:159]
buffer_load_dwordx4 a[16:19], v2, s[40:43], s35 offen offset:0 sc1
v_mfma_f32_16x16x32_bf16 v[180:183], a[96:99], a[40:43], v[180:183]
ds_read_b128 a[132:135], v5 offset:19456
v_mfma_f32_16x16x32_bf16 v[204:207], a[96:99], a[44:47], v[204:207]
v_mfma_f32_16x16x32_bf16 v[208:211], a[100:103], a[44:47], v[208:211]
buffer_load_dwordx4 v1, s[4:7], s44 offen offset:0 sc1 lds
v_mfma_f32_16x16x32_bf16 v[184:187], a[100:103], a[40:43], v[184:187]
ds_read_b128 a[136:139], v5 offset:20480
v_mfma_f32_16x16x32_bf16 v[160:163], a[100:103], a[36:39], v[160:163]
ds_read_b128 a[140:143], v5 offset:21504
v_mfma_f32_16x16x32_bf16 v[136:139], a[100:103], a[32:35], v[136:139]
v_mfma_f32_16x16x32_bf16 v[140:143], a[104:107], a[32:35], v[140:143]
buffer_load_dwordx4 a[20:23], v2, s[40:43], s35 offen offset:1024 sc1
v_mfma_f32_16x16x32_bf16 v[164:167], a[104:107], a[36:39], v[164:167]
ds_read_b128 a[144:147], v5 offset:22528
v_mfma_f32_16x16x32_bf16 v[188:191], a[104:107], a[40:43], v[188:191]
v_mfma_f32_16x16x32_bf16 v[212:215], a[104:107], a[44:47], v[212:215]
buffer_load_dwordx4 v1, s[4:7], s44 offen offset:1024 sc1 lds
v_mfma_f32_16x16x32_bf16 v[216:219], a[108:111], a[44:47], v[216:219]
ds_read_b128 a[148:151], v5 offset:23552
v_mfma_f32_16x16x32_bf16 v[192:195], a[108:111], a[40:43], v[192:195]
ds_read_b128 a[152:155], v6 offset:5120
v_mfma_f32_16x16x32_bf16 v[168:171], a[108:111], a[36:39], v[168:171]
v_mfma_f32_16x16x32_bf16 v[144:147], a[108:111], a[32:35], v[144:147]
buffer_load_dwordx4 a[24:27], v2, s[40:43], s35 offen offset:2048 sc1
v_mfma_f32_16x16x32_bf16 v[148:151], a[112:115], a[32:35], v[148:151]
v_mfma_f32_16x16x32_bf16 v[172:175], a[112:115], a[36:39], v[172:175]
v_mfma_f32_16x16x32_bf16 v[196:199], a[112:115], a[40:43], v[196:199]
buffer_load_dwordx4 v1, s[4:7], s44 offen offset:2048 sc1 lds
v_mfma_f32_16x16x32_bf16 v[220:223], a[112:115], a[44:47], v[220:223]
v_mfma_f32_16x16x32_bf16 v[224:227], a[116:119], a[44:47], v[224:227]
v_mfma_f32_16x16x32_bf16 v[200:203], a[116:119], a[40:43], v[200:203]
v_mfma_f32_16x16x32_bf16 v[176:179], a[116:119], a[36:39], v[176:179]
buffer_load_dwordx4 a[28:31], v2, s[40:43], s35 offen offset:3072 sc1
L_stub1:
s_cbranch_execz L_stub2
s_add_u32 s35, s35, 4096
v_mfma_f32_16x16x32_bf16 v[152:155], a[116:119], a[32:35], v[152:155]
v_mfma_f32_16x16x32_bf16 a[88:91], a[120:123], a[68:71], a[88:91]
s_waitcnt vmcnt(14) lgkmcnt(0)
v_mfma_f32_16x16x32_bf16 v[132:135], a[128:131], a[48:51], v[132:135]
ds_read_b128 a[96:99], v5 offset:24576
v_accvgpr_write_b32 a160, v48
v_mfma_f32_16x16x32_bf16 v[156:159], a[128:131], a[52:55], v[156:159]
buffer_load_dwordx4 a[32:35], v2, s[40:43], s35 offen offset:0 sc1
v_mfma_f32_16x16x32_bf16 v[180:183], a[128:131], a[56:59], v[180:183]
ds_read_b128 a[100:103], v5 offset:25600
v_accvgpr_write_b32 a161, v49
v_mfma_f32_16x16x32_bf16 v[204:207], a[128:131], a[60:63], v[204:207]
v_mfma_f32_16x16x32_bf16 v[208:211], a[132:135], a[60:63], v[208:211]
buffer_store_dwordx4 a[220:223], v1, s[4:7], s101 offen offset:0 sc1
v_mfma_f32_16x16x32_bf16 v[184:187], a[132:135], a[56:59], v[184:187]
ds_read_b128 a[104:107], v5 offset:26624
v_accvgpr_write_b32 a162, v50
v_mfma_f32_16x16x32_bf16 v[160:163], a[132:135], a[52:55], v[160:163]
ds_read_b128 a[108:111], v5 offset:27648
v_mfma_f32_16x16x32_bf16 v[136:139], a[132:135], a[48:51], v[136:139]
v_mfma_f32_16x16x32_bf16 v[140:143], a[136:139], a[48:51], v[140:143]
v_accvgpr_write_b32 a163, v51
v_mfma_f32_16x16x32_bf16 v[164:167], a[136:139], a[52:55], v[164:167]
ds_read_b128 a[112:115], v5 offset:28672
v_mfma_f32_16x16x32_bf16 v[188:191], a[136:139], a[56:59], v[188:191]
buffer_load_dwordx4 a[36:39], v2, s[40:43], s35 offen offset:1024 sc1
v_mfma_f32_16x16x32_bf16 v[212:215], a[136:139], a[60:63], v[212:215]
ds_read_b128 a[116:119], v5 offset:29696
v_accvgpr_write_b32 a164, v52
v_mfma_f32_16x16x32_bf16 v[216:219], a[140:143], a[60:63], v[216:219]
v_mfma_f32_16x16x32_bf16 v[192:195], a[140:143], a[56:59], v[192:195]
buffer_load_dwordx4 a[40:43], v2, s[40:43], s35 offen offset:2048 sc1
v_mfma_f32_16x16x32_bf16 v[168:171], a[140:143], a[52:55], v[168:171]
ds_read_b128 a[120:123], v6 offset:26624
v_accvgpr_write_b32 a165, v53
v_mfma_f32_16x16x32_bf16 v[144:147], a[140:143], a[48:51], v[144:147]
v_mfma_f32_16x16x32_bf16 v[148:151], a[144:147], a[48:51], v[148:151]
buffer_store_dwordx4 a[224:227], v1, s[4:7], s101 offen offset:1024 sc1
v_mfma_f32_16x16x32_bf16 v[172:175], a[144:147], a[52:55], v[172:175]
v_accvgpr_write_b32 a166, v54
v_mfma_f32_16x16x32_bf16 v[196:199], a[144:147], a[56:59], v[196:199]
v_accvgpr_write_b32 a167, v55
v_mfma_f32_16x16x32_bf16 v[220:223], a[144:147], a[60:63], v[220:223]
v_mfma_f32_16x16x32_bf16 v[224:227], a[148:151], a[60:63], v[224:227]
v_mfma_f32_16x16x32_bf16 v[200:203], a[148:151], a[56:59], v[200:203]
v_accvgpr_write_b32 a168, v56
v_mfma_f32_16x16x32_bf16 v[176:179], a[148:151], a[52:55], v[176:179]
buffer_load_dwordx4 a[44:47], v2, s[40:43], s35 offen offset:3072 sc1
s_add_u32 s35, s35, 4096
v_mfma_f32_16x16x32_bf16 v[152:155], a[148:151], a[48:51], v[152:155]
v_mfma_f32_16x16x32_bf16 a[92:95], a[152:155], a[68:71], a[92:95]
v_accvgpr_write_b32 a169, v57
s_waitcnt vmcnt(13) lgkmcnt(0)
v_mfma_f32_16x16x32_bf16 v[132:135], a[96:99], a[0:3], v[132:135]
ds_read_b128 a[128:131], v5 offset:30720
v_mfma_f32_16x16x32_bf16 v[156:159], a[96:99], a[4:7], v[156:159]
buffer_load_dwordx4 a[48:51], v2, s[40:43], s35 offen offset:0 sc1
v_mfma_f32_16x16x32_bf16 v[180:183], a[96:99], a[8:11], v[180:183]
ds_read_b128 a[132:135], v5 offset:31744
v_accvgpr_write_b32 a170, v58
v_mfma_f32_16x16x32_bf16 v[204:207], a[96:99], a[12:15], v[204:207]
v_mfma_f32_16x16x32_bf16 v[208:211], a[100:103], a[12:15], v[208:211]
buffer_store_dwordx4 a[188:191], v1, s[4:7], s96 offen offset:0 sc1
s_add_u32 s63, s28, 24
v_mfma_f32_16x16x32_bf16 v[184:187], a[100:103], a[8:11], v[184:187]
s_lshl_b32 s63, s63, 12
ds_read_b128 a[136:139], v5 offset:32768
v_mfma_f32_16x16x32_bf16 v[160:163], a[100:103], a[4:7], v[160:163]
ds_read_b128 a[140:143], v5 offset:33792
v_accvgpr_write_b32 a171, v59
v_mfma_f32_16x16x32_bf16 v[136:139], a[100:103], a[0:3], v[136:139]
v_accvgpr_write_b32 a172, v60
v_mfma_f32_16x16x32_bf16 v[140:143], a[104:107], a[0:3], v[140:143]
v_mfma_f32_16x16x32_bf16 v[164:167], a[104:107], a[4:7], v[164:167]
ds_read_b128 a[144:147], v5 offset:34816
v_accvgpr_write_b32 a173, v61
v_mfma_f32_16x16x32_bf16 v[188:191], a[104:107], a[8:11], v[188:191]
v_mfma_f32_16x16x32_bf16 v[212:215], a[104:107], a[12:15], v[212:215]
buffer_load_dwordx4 a[52:55], v2, s[40:43], s35 offen offset:1024 sc1
v_mfma_f32_16x16x32_bf16 v[216:219], a[108:111], a[12:15], v[216:219]
ds_read_b128 a[148:151], v5 offset:35840
v_accvgpr_write_b32 a174, v62
v_mfma_f32_16x16x32_bf16 v[192:195], a[108:111], a[8:11], v[192:195]
ds_read_b128 a[152:155], v6 offset:27648
v_mfma_f32_16x16x32_bf16 v[168:171], a[108:111], a[4:7], v[168:171]
v_mfma_f32_16x16x32_bf16 v[144:147], a[108:111], a[0:3], v[144:147]
buffer_load_dwordx4 a[56:59], v2, s[40:43], s35 offen offset:2048 sc1
v_mfma_f32_16x16x32_bf16 v[148:151], a[112:115], a[0:3], v[148:151]
v_accvgpr_write_b32 a175, v63
v_mfma_f32_16x16x32_bf16 v[172:175], a[112:115], a[4:7], v[172:175]
v_accvgpr_write_b32 a176, v64
v_mfma_f32_16x16x32_bf16 v[196:199], a[112:115], a[8:11], v[196:199]
buffer_load_dwordx4 a[64:67], v3, s[40:43], s63 offen sc1
v_mfma_f32_16x16x32_bf16 v[220:223], a[112:115], a[12:15], v[220:223]
v_mfma_f32_16x16x32_bf16 v[224:227], a[116:119], a[12:15], v[224:227]
v_accvgpr_write_b32 a177, v65
v_mfma_f32_16x16x32_bf16 v[200:203], a[116:119], a[8:11], v[200:203]
v_mfma_f32_16x16x32_bf16 v[176:179], a[116:119], a[4:7], v[176:179]
buffer_load_dwordx4 a[60:63], v2, s[40:43], s35 offen offset:3072 sc1
s_add_u32 s35, s35, 4096
v_mfma_f32_16x16x32_bf16 v[152:155], a[116:119], a[0:3], v[152:155]
v_accvgpr_write_b32 a178, v66
v_mfma_f32_16x16x32_bf16 a[80:83], a[120:123], a[72:75], a[80:83]
s_waitcnt vmcnt(12) lgkmcnt(0)
v_mfma_f32_16x16x32_bf16 v[132:135], a[128:131], a[16:19], v[132:135]
ds_read_b128 a[96:99], v5 offset:36864
v_accvgpr_write_b32 a179, v67
v_mfma_f32_16x16x32_bf16 v[156:159], a[128:131], a[20:23], v[156:159]
buffer_load_dwordx4 a[0:3], v2, s[40:43], s35 offen offset:0 sc1
v_mfma_f32_16x16x32_bf16 v[180:183], a[128:131], a[24:27], v[180:183]
ds_read_b128 a[100:103], v5 offset:37888
v_mfma_f32_16x16x32_bf16 v[204:207], a[128:131], a[28:31], v[204:207]
buffer_store_dwordx4 a[192:195], v1, s[4:7], s97 offen offset:0 sc1
v_mfma_f32_16x16x32_bf16 v[208:211], a[132:135], a[28:31], v[208:211]
ds_read_b128 a[104:107], v5 offset:38912
v_accvgpr_write_b32 a180, v68
v_mfma_f32_16x16x32_bf16 v[184:187], a[132:135], a[24:27], v[184:187]
v_mfma_f32_16x16x32_bf16 v[160:163], a[132:135], a[20:23], v[160:163]
ds_read_b128 a[108:111], v5 offset:39936
v_accvgpr_write_b32 a181, v69
v_mfma_f32_16x16x32_bf16 v[136:139], a[132:135], a[16:19], v[136:139]
v_mfma_f32_16x16x32_bf16 v[140:143], a[136:139], a[16:19], v[140:143]
v_accvgpr_write_b32 a182, v70
v_mfma_f32_16x16x32_bf16 v[164:167], a[136:139], a[20:23], v[164:167]
buffer_load_dwordx4 a[4:7], v2, s[40:43], s35 offen offset:1024 sc1
v_mfma_f32_16x16x32_bf16 v[188:191], a[136:139], a[24:27], v[188:191]
ds_read_b128 a[112:115], v5 offset:40960
v_mfma_f32_16x16x32_bf16 v[212:215], a[136:139], a[28:31], v[212:215]
ds_read_b128 a[116:119], v5 offset:41984
v_accvgpr_write_b32 a183, v71
v_mfma_f32_16x16x32_bf16 v[216:219], a[140:143], a[28:31], v[216:219]
buffer_store_dwordx4 a[196:199], v1, s[4:7], s96 offen offset:1024 sc1
s_add_u32 s63, s28, 28
v_mfma_f32_16x16x32_bf16 v[192:195], a[140:143], a[24:27], v[192:195]
s_lshl_b32 s63, s63, 12
ds_read_b128 a[120:123], v6 offset:28672
v_mfma_f32_16x16x32_bf16 v[168:171], a[140:143], a[20:23], v[168:171]
v_accvgpr_write_b32 a184, v72
v_mfma_f32_16x16x32_bf16 v[144:147], a[140:143], a[16:19], v[144:147]
v_mfma_f32_16x16x32_bf16 v[148:151], a[144:147], a[16:19], v[148:151]
v_accvgpr_write_b32 a185, v73
v_mfma_f32_16x16x32_bf16 v[172:175], a[144:147], a[20:23], v[172:175]
buffer_load_dwordx4 a[8:11], v2, s[40:43], s35 offen offset:2048 sc1
v_mfma_f32_16x16x32_bf16 v[196:199], a[144:147], a[24:27], v[196:199]
v_mfma_f32_16x16x32_bf16 v[220:223], a[144:147], a[28:31], v[220:223]
v_accvgpr_write_b32 a186, v74
v_mfma_f32_16x16x32_bf16 v[224:227], a[148:151], a[28:31], v[224:227]
buffer_load_dwordx4 a[68:71], v3, s[40:43], s63 offen sc1
v_mfma_f32_16x16x32_bf16 v[200:203], a[148:151], a[24:27], v[200:203]
v_mfma_f32_16x16x32_bf16 v[176:179], a[148:151], a[20:23], v[176:179]
v_accvgpr_write_b32 a187, v75
v_mfma_f32_16x16x32_bf16 v[152:155], a[148:151], a[16:19], v[152:155]
buffer_load_dwordx4 a[12:15], v2, s[40:43], s35 offen offset:3072 sc1
s_add_u32 s35, s35, 4096
v_mfma_f32_16x16x32_bf16 a[84:87], a[152:155], a[72:75], a[84:87]
s_waitcnt vmcnt(13) lgkmcnt(0)
v_mfma_f32_16x16x32_bf16 v[132:135], a[96:99], a[32:35], v[132:135]
ds_read_b128 a[128:131], v5 offset:43008
v_add_f32 v92, v92, v96
v_mfma_f32_16x16x32_bf16 v[156:159], a[96:99], a[36:39], v[156:159]
buffer_load_dwordx4 a[16:19], v2, s[40:43], s35 offen offset:0 sc1
v_mfma_f32_16x16x32_bf16 v[180:183], a[96:99], a[40:43], v[180:183]
ds_read_b128 a[132:135], v5 offset:44032
v_add_f32 v100, v100, v104
v_mfma_f32_16x16x32_bf16 v[204:207], a[96:99], a[44:47], v[204:207]
v_add_f32 v108, v108, v112
v_add_f32 v116, v116, v120
v_mfma_f32_16x16x32_bf16 v[208:211], a[100:103], a[44:47], v[208:211]
ds_read_b128 a[136:139], v5 offset:45056
v_add_f32 v124, v124, v128
v_mfma_f32_16x16x32_bf16 v[184:187], a[100:103], a[40:43], v[184:187]
buffer_load_dwordx4 a[20:23], v2, s[40:43], s35 offen offset:1024 sc1
v_mfma_f32_16x16x32_bf16 v[160:163], a[100:103], a[36:39], v[160:163]
ds_read_b128 a[140:143], v5 offset:46080
v_add_f32 v93, v93, v97
v_mfma_f32_16x16x32_bf16 v[136:139], a[100:103], a[32:35], v[136:139]
v_add_f32 v101, v101, v105
v_add_f32 v109, v109, v113
v_mfma_f32_16x16x32_bf16 v[140:143], a[104:107], a[32:35], v[140:143]
v_add_f32 v117, v117, v121
v_add_f32 v125, v125, v129
v_mfma_f32_16x16x32_bf16 v[164:167], a[104:107], a[36:39], v[164:167]
buffer_store_dwordx4 a[200:203], v1, s[4:7], s97 offen offset:1024 sc1
v_mfma_f32_16x16x32_bf16 v[188:191], a[104:107], a[40:43], v[188:191]
ds_read_b128 a[144:147], v5 offset:47104
v_add_f32 v94, v94, v98
v_mfma_f32_16x16x32_bf16 v[212:215], a[104:107], a[44:47], v[212:215]
ds_read_b128 a[148:151], v5 offset:48128
v_add_f32 v102, v102, v106
v_mfma_f32_16x16x32_bf16 v[216:219], a[108:111], a[44:47], v[216:219]
v_add_f32 v110, v110, v114
v_add_f32 v118, v118, v122
v_mfma_f32_16x16x32_bf16 v[192:195], a[108:111], a[40:43], v[192:195]
ds_read_b128 a[152:155], v6 offset:29696
v_add_f32 v126, v126, v130
v_mfma_f32_16x16x32_bf16 v[168:171], a[108:111], a[36:39], v[168:171]
v_add_f32 v95, v95, v99
v_add_f32 v103, v103, v107
v_mfma_f32_16x16x32_bf16 v[144:147], a[108:111], a[32:35], v[144:147]
v_add_f32 v111, v111, v115
v_add_f32 v119, v119, v123
v_mfma_f32_16x16x32_bf16 v[148:151], a[112:115], a[32:35], v[148:151]
v_add_f32 v127, v127, v131
v_add_f32_dpp v92, v92, v92 row_ror:8 row_mask:0xf bank_mask:0xf
v_mfma_f32_16x16x32_bf16 v[172:175], a[112:115], a[36:39], v[172:175]
buffer_load_dwordx4 a[24:27], v2, s[40:43], s35 offen offset:2048 sc1
v_mfma_f32_16x16x32_bf16 v[196:199], a[112:115], a[40:43], v[196:199]
v_add_f32_dpp v100, v100, v100 row_ror:8 row_mask:0xf bank_mask:0xf
v_add_f32_dpp v108, v108, v108 row_ror:8 row_mask:0xf bank_mask:0xf
v_mfma_f32_16x16x32_bf16 v[220:223], a[112:115], a[44:47], v[220:223]
v_add_f32_dpp v116, v116, v116 row_ror:8 row_mask:0xf bank_mask:0xf
v_add_f32_dpp v124, v124, v124 row_ror:8 row_mask:0xf bank_mask:0xf
v_mfma_f32_16x16x32_bf16 v[224:227], a[116:119], a[44:47], v[224:227]
v_add_f32_dpp v93, v93, v93 row_ror:8 row_mask:0xf bank_mask:0xf
v_mfma_f32_16x16x32_bf16 v[200:203], a[116:119], a[40:43], v[200:203]
buffer_load_dwordx4 a[28:31], v2, s[40:43], s35 offen offset:3072 sc1
s_add_u32 s35, s35, 4096
v_mfma_f32_16x16x32_bf16 v[176:179], a[116:119], a[36:39], v[176:179]
v_add_f32_dpp v101, v101, v101 row_ror:8 row_mask:0xf bank_mask:0xf
v_add_f32_dpp v109, v109, v109 row_ror:8 row_mask:0xf bank_mask:0xf
v_mfma_f32_16x16x32_bf16 v[152:155], a[116:119], a[32:35], v[152:155]
v_add_f32_dpp v117, v117, v117 row_ror:8 row_mask:0xf bank_mask:0xf
v_add_f32_dpp v125, v125, v125 row_ror:8 row_mask:0xf bank_mask:0xf
v_mfma_f32_16x16x32_bf16 a[88:91], a[120:123], a[72:75], a[88:91]
s_waitcnt vmcnt(12) lgkmcnt(0)
s_barrier
v_mfma_f32_16x16x32_bf16 v[132:135], a[128:131], a[48:51], v[132:135]
v_add_u32 v5, 0, v1
v_add_u32 v6, s55, v5
v_mfma_f32_16x16x32_bf16 v[156:159], a[128:131], a[52:55], v[156:159]
buffer_load_dwordx4 a[32:35], v2, s[40:43], s35 offen offset:0 sc1
v_mfma_f32_16x16x32_bf16 v[180:183], a[128:131], a[56:59], v[180:183]
ds_read_b128 a[96:99], v5 offset:0
v_add_f32_dpp v92, v94, v94 row_ror:8 row_mask:0xf bank_mask:0xc
v_mfma_f32_16x16x32_bf16 v[204:207], a[128:131], a[60:63], v[204:207]
ds_read_b128 a[100:103], v5 offset:1024
v_add_f32_dpp v100, v102, v102 row_ror:8 row_mask:0xf bank_mask:0xc
v_mfma_f32_16x16x32_bf16 v[208:211], a[132:135], a[60:63], v[208:211]
buffer_store_dwordx4 a[204:207], v1, s[4:7], s96 offen offset:2048 sc1
v_mfma_f32_16x16x32_bf16 v[184:187], a[132:135], a[56:59], v[184:187]
ds_read_b128 a[104:107], v5 offset:2048
v_add_f32_dpp v108, v110, v110 row_ror:8 row_mask:0xf bank_mask:0xc
v_mfma_f32_16x16x32_bf16 v[160:163], a[132:135], a[52:55], v[160:163]
ds_read_b128 a[108:111], v5 offset:3072
v_add_f32_dpp v116, v118, v118 row_ror:8 row_mask:0xf bank_mask:0xc
v_mfma_f32_16x16x32_bf16 v[136:139], a[132:135], a[48:51], v[136:139]
v_add_f32_dpp v124, v126, v126 row_ror:8 row_mask:0xf bank_mask:0xc
v_add_f32_dpp v93, v95, v95 row_ror:8 row_mask:0xf bank_mask:0xc
v_mfma_f32_16x16x32_bf16 v[140:143], a[136:139], a[48:51], v[140:143]
ds_read_b128 a[112:115], v5 offset:4096
v_add_f32_dpp v101, v103, v103 row_ror:8 row_mask:0xf bank_mask:0xc
v_mfma_f32_16x16x32_bf16 v[164:167], a[136:139], a[52:55], v[164:167]
v_add_f32_dpp v109, v111, v111 row_ror:8 row_mask:0xf bank_mask:0xc
v_add_f32_dpp v117, v119, v119 row_ror:8 row_mask:0xf bank_mask:0xc
v_mfma_f32_16x16x32_bf16 v[188:191], a[136:139], a[56:59], v[188:191]
buffer_load_dwordx4 a[36:39], v2, s[40:43], s35 offen offset:1024 sc1
v_mfma_f32_16x16x32_bf16 v[212:215], a[136:139], a[60:63], v[212:215]
ds_read_b128 a[116:119], v5 offset:5120
v_add_f32_dpp v125, v127, v127 row_ror:8 row_mask:0xf bank_mask:0xc
v_mfma_f32_16x16x32_bf16 v[216:219], a[140:143], a[60:63], v[216:219]
ds_read_b128 a[120:123], v6 offset:2048
v_mfma_f32_16x16x32_bf16 v[192:195], a[140:143], a[56:59], v[192:195]
buffer_load_dwordx4 a[40:43], v2, s[40:43], s35 offen offset:2048 sc1
v_mfma_f32_16x16x32_bf16 v[168:171], a[140:143], a[52:55], v[168:171]
ds_read_b128 a[124:127], v6 offset:26624
v_mfma_f32_16x16x32_bf16 v[144:147], a[140:143], a[48:51], v[144:147]
v_permlane32_swap_b32 v92, v93
v_mfma_f32_16x16x32_bf16 v[148:151], a[144:147], a[48:51], v[148:151]
buffer_store_dwordx4 a[208:211], v1, s[4:7], s97 offen offset:2048 sc1
v_mfma_f32_16x16x32_bf16 v[172:175], a[144:147], a[52:55], v[172:175]
v_permlane32_swap_b32 v100, v101
v_mfma_f32_16x16x32_bf16 v[196:199], a[144:147], a[56:59], v[196:199]
v_permlane32_swap_b32 v108, v109
v_mfma_f32_16x16x32_bf16 v[220:223], a[144:147], a[60:63], v[220:223]
v_permlane32_swap_b32 v116, v117
v_mfma_f32_16x16x32_bf16 v[224:227], a[148:151], a[60:63], v[224:227]
v_permlane32_swap_b32 v124, v125
v_mfma_f32_16x16x32_bf16 v[200:203], a[148:151], a[56:59], v[200:203]
v_add_f32 v92, v92, v93
v_add_f32 v100, v100, v101
v_mfma_f32_16x16x32_bf16 v[176:179], a[148:151], a[52:55], v[176:179]
buffer_load_dwordx4 a[44:47], v2, s[40:43], s35 offen offset:3072 sc1
s_add_u32 s35, s35, 4096
v_mfma_f32_16x16x32_bf16 v[152:155], a[148:151], a[48:51], v[152:155]
v_add_f32 v108, v108, v109
v_add_f32 v116, v116, v117
v_mfma_f32_16x16x32_bf16 a[92:95], a[152:155], a[72:75], a[92:95]
v_add_f32 v124, v124, v125
s_waitcnt vmcnt(11) lgkmcnt(0)
v_mfma_f32_16x16x32_bf16 v[132:135], a[96:99], a[0:3], v[132:135]
ds_read_b128 a[128:131], v5 offset:6144
v_mov_b32 v94, v92
v_mfma_f32_16x16x32_bf16 v[156:159], a[96:99], a[4:7], v[156:159]
buffer_load_dwordx4 a[48:51], v2, s[40:43], s35 offen offset:0 sc1
v_mfma_f32_16x16x32_bf16 v[180:183], a[96:99], a[8:11], v[180:183]
ds_read_b128 a[132:135], v5 offset:7168
v_mov_b32 v102, v100
v_mfma_f32_16x16x32_bf16 v[204:207], a[96:99], a[12:15], v[204:207]
v_mov_b32 v110, v108
v_mov_b32 v118, v116
v_mfma_f32_16x16x32_bf16 v[208:211], a[100:103], a[12:15], v[208:211]
ds_read_b128 a[136:139], v5 offset:8192
v_mov_b32 v126, v124
v_mfma_f32_16x16x32_bf16 v[184:187], a[100:103], a[8:11], v[184:187]
buffer_load_dwordx4 a[52:55], v2, s[40:43], s35 offen offset:1024 sc1
v_mfma_f32_16x16x32_bf16 v[160:163], a[100:103], a[4:7], v[160:163]
ds_read_b128 a[140:143], v5 offset:9216
v_mfma_f32_16x16x32_bf16 v[136:139], a[100:103], a[0:3], v[136:139]
v_permlane16_swap_b32 v92, v94
v_mfma_f32_16x16x32_bf16 v[140:143], a[104:107], a[0:3], v[140:143]
ds_read_b128 a[144:147], v5 offset:10240
v_mfma_f32_16x16x32_bf16 v[164:167], a[104:107], a[4:7], v[164:167]
buffer_store_dwordx4 v[236:239], v254, s[4:7], s98 offen offset:0 sc1
v_mfma_f32_16x16x32_bf16 v[188:191], a[104:107], a[8:11], v[188:191]
ds_read_b128 a[148:151], v5 offset:11264
v_mfma_f32_16x16x32_bf16 v[212:215], a[104:107], a[12:15], v[212:215]
v_permlane16_swap_b32 v100, v102
v_mfma_f32_16x16x32_bf16 v[216:219], a[108:111], a[12:15], v[216:219]
ds_read_b128 a[152:155], v6 offset:3072
v_mfma_f32_16x16x32_bf16 v[192:195], a[108:111], a[8:11], v[192:195]
v_permlane16_swap_b32 v108, v110
v_mfma_f32_16x16x32_bf16 v[168:171], a[108:111], a[4:7], v[168:171]
ds_read_b128 a[156:159], v6 offset:27648
v_mfma_f32_16x16x32_bf16 v[144:147], a[108:111], a[0:3], v[144:147]
v_permlane16_swap_b32 v116, v118
v_mfma_f32_16x16x32_bf16 v[148:151], a[112:115], a[0:3], v[148:151]
v_permlane16_swap_b32 v124, v126
v_mfma_f32_16x16x32_bf16 v[172:175], a[112:115], a[4:7], v[172:175]
v_add_f32 v92, v92, v94
v_add_f32 v100, v100, v102
v_mfma_f32_16x16x32_bf16 v[196:199], a[112:115], a[8:11], v[196:199]
buffer_load_dwordx4 a[56:59], v2, s[40:43], s35 offen offset:2048 sc1
v_mfma_f32_16x16x32_bf16 v[220:223], a[112:115], a[12:15], v[220:223]
v_add_f32 v108, v108, v110
v_add_f32 v116, v116, v118
v_mfma_f32_16x16x32_bf16 v[224:227], a[116:119], a[12:15], v[224:227]
v_add_f32 v124, v124, v126
v_mov_b32 v94, v92
v_mfma_f32_16x16x32_bf16 v[200:203], a[116:119], a[8:11], v[200:203]
v_mov_b32 v102, v100
v_mov_b32 v110, v108
v_mfma_f32_16x16x32_bf16 v[176:179], a[116:119], a[4:7], v[176:179]
buffer_load_dwordx4 a[60:63], v2, s[40:43], s35 offen offset:3072 sc1
s_add_u32 s35, s35, 4096
v_mfma_f32_16x16x32_bf16 v[152:155], a[116:119], a[0:3], v[152:155]
v_mov_b32 v118, v116
v_mov_b32 v126, v124
v_mfma_f32_16x16x32_bf16 a[80:83], a[120:123], a[64:67], a[80:83]
v_permlane32_swap_b32 v92, v94
v_mfma_f32_16x16x32_bf16 a[80:83], a[124:127], a[68:71], a[80:83]
s_waitcnt vmcnt(11) lgkmcnt(0)
v_mfma_f32_16x16x32_bf16 v[132:135], a[128:131], a[16:19], v[132:135]
ds_read_b128 a[96:99], v5 offset:12288
v_mfma_f32_16x16x32_bf16 v[156:159], a[128:131], a[20:23], v[156:159]
buffer_load_dwordx4 a[0:3], v2, s[40:43], s35 offen offset:0 sc1
v_mfma_f32_16x16x32_bf16 v[180:183], a[128:131], a[24:27], v[180:183]
ds_read_b128 a[100:103], v5 offset:13312
v_mfma_f32_16x16x32_bf16 v[204:207], a[128:131], a[28:31], v[204:207]
v_permlane32_swap_b32 v100, v102
v_mfma_f32_16x16x32_bf16 v[208:211], a[132:135], a[28:31], v[208:211]
buffer_store_dwordx4 v[240:243], v254, s[4:7], s98 offen offset:2048 sc1
v_mfma_f32_16x16x32_bf16 v[184:187], a[132:135], a[24:27], v[184:187]
ds_read_b128 a[104:107], v5 offset:14336
v_mfma_f32_16x16x32_bf16 v[160:163], a[132:135], a[20:23], v[160:163]
ds_read_b128 a[108:111], v5 offset:15360
v_mfma_f32_16x16x32_bf16 v[136:139], a[132:135], a[16:19], v[136:139]
v_permlane32_swap_b32 v108, v110
v_mfma_f32_16x16x32_bf16 v[140:143], a[136:139], a[16:19], v[140:143]
ds_read_b128 a[112:115], v5 offset:16384
v_mfma_f32_16x16x32_bf16 v[164:167], a[136:139], a[20:23], v[164:167]
v_permlane32_swap_b32 v116, v118
v_mfma_f32_16x16x32_bf16 v[188:191], a[136:139], a[24:27], v[188:191]
buffer_load_dwordx4 a[4:7], v2, s[40:43], s35 offen offset:1024 sc1
v_mfma_f32_16x16x32_bf16 v[212:215], a[136:139], a[28:31], v[212:215]
ds_read_b128 a[116:119], v5 offset:17408
v_mfma_f32_16x16x32_bf16 v[216:219], a[140:143], a[28:31], v[216:219]
ds_read_b128 a[120:123], v6 offset:4096
v_mfma_f32_16x16x32_bf16 v[192:195], a[140:143], a[24:27], v[192:195]
v_permlane32_swap_b32 v124, v126
v_mfma_f32_16x16x32_bf16 v[168:171], a[140:143], a[20:23], v[168:171]
buffer_load_dwordx4 a[8:11], v2, s[40:43], s35 offen offset:2048 sc1
v_mfma_f32_16x16x32_bf16 v[144:147], a[140:143], a[16:19], v[144:147]
ds_read_b128 a[124:127], v6 offset:28672
v_mul_f32 v82, 0xba800000, v92
v_mfma_f32_16x16x32_bf16 v[148:151], a[144:147], a[16:19], v[148:151]
v_mul_f32 v84, 0xba800000, v100
v_mul_f32 v86, 0xba800000, v108
v_mfma_f32_16x16x32_bf16 v[172:175], a[144:147], a[20:23], v[172:175]
buffer_store_dwordx4 v[244:247], v254, s[4:7], s99 offen offset:0 sc1
s_add_i32 s44, s28, 4
v_mfma_f32_16x16x32_bf16 v[196:199], a[144:147], a[24:27], v[196:199]
s_lshl_b32 s45, s44, 12
s_add_u32 m0, s45, 32768
s_and_b32 s45, s44, 7
v_mfma_f32_16x16x32_bf16 v[220:223], a[144:147], a[28:31], v[220:223]
s_cmp_eq_u32 s45, s3
s_cselect_b32 s45, 8, 0
s_add_u32 s44, s44, s45
v_mfma_f32_16x16x32_bf16 v[224:227], a[148:151], a[28:31], v[224:227]
s_and_b32 s44, s44, 31
s_lshl_b32 s44, s44, 12
s_add_u32 s44, s44, s51
v_mfma_f32_16x16x32_bf16 v[200:203], a[148:151], a[24:27], v[200:203]
v_mul_f32 v88, 0xba800000, v116
v_mul_f32 v90, 0xba800000, v124
v_mfma_f32_16x16x32_bf16 v[176:179], a[148:151], a[20:23], v[176:179]
v_mul_f32 v94, 0x3a800000, v94
v_mul_f32 v102, 0x3a800000, v102
v_mfma_f32_16x16x32_bf16 v[152:155], a[148:151], a[16:19], v[152:155]
buffer_load_dwordx4 a[12:15], v2, s[40:43], s35 offen offset:3072 sc1
s_add_u32 s35, s35, 4096
v_mfma_f32_16x16x32_bf16 a[84:87], a[152:155], a[64:67], a[84:87]
v_mul_f32 v110, 0x3a800000, v110
v_mul_f32 v118, 0x3a800000, v118
v_mfma_f32_16x16x32_bf16 a[84:87], a[156:159], a[68:71], a[84:87]
v_mul_f32 v126, 0x3a800000, v126
s_waitcnt vmcnt(11) lgkmcnt(0)
v_mfma_f32_16x16x32_bf16 v[132:135], a[96:99], a[32:35], v[132:135]
ds_read_b128 a[128:131], v5 offset:18432
v_fma_f32 v94, -v82, v82, v94
v_mfma_f32_16x16x32_bf16 v[156:159], a[96:99], a[36:39], v[156:159]
buffer_load_dwordx4 a[16:19], v2, s[40:43], s35 offen offset:0 sc1
v_mfma_f32_16x16x32_bf16 v[180:183], a[96:99], a[40:43], v[180:183]
ds_read_b128 a[132:135], v5 offset:19456
v_fma_f32 v102, -v84, v84, v102
v_mfma_f32_16x16x32_bf16 v[204:207], a[96:99], a[44:47], v[204:207]
v_fma_f32 v110, -v86, v86, v110
v_fma_f32 v118, -v88, v88, v118
v_mfma_f32_16x16x32_bf16 v[208:211], a[100:103], a[44:47], v[208:211]
buffer_load_dwordx4 v1, s[4:7], s44 offen offset:0 sc1 lds
v_mfma_f32_16x16x32_bf16 v[184:187], a[100:103], a[40:43], v[184:187]
ds_read_b128 a[136:139], v5 offset:20480
v_fma_f32 v126, -v90, v90, v126
v_mfma_f32_16x16x32_bf16 v[160:163], a[100:103], a[36:39], v[160:163]
ds_read_b128 a[140:143], v5 offset:21504
v_max_f32 v94, 0, v94
v_mfma_f32_16x16x32_bf16 v[136:139], a[100:103], a[32:35], v[136:139]
v_max_f32 v102, 0, v102
v_max_f32 v110, 0, v110
v_max_f32 v118, 0, v118
v_max_f32 v126, 0, v126
v_add_f32 v94, 0x3727c5ac, v94
v_add_f32 v102, 0x3727c5ac, v102
v_add_f32 v110, 0x3727c5ac, v110
v_add_f32 v118, 0x3727c5ac, v118
v_add_f32 v126, 0x3727c5ac, v126
v_rsq_f32 v83, v94
v_rsq_f32 v85, v102
v_rsq_f32 v87, v110
v_rsq_f32 v89, v118
v_rsq_f32 v91, v126
v_mfma_f32_16x16x32_bf16 v[140:143], a[104:107], a[32:35], v[140:143]
buffer_load_dwordx4 a[20:23], v2, s[40:43], s35 offen offset:1024 sc1
v_mfma_f32_16x16x32_bf16 v[164:167], a[104:107], a[36:39], v[164:167]
ds_read_b128 a[144:147], v5 offset:22528
v_fmac_f32 v132, v48, v82
v_mfma_f32_16x16x32_bf16 v[188:191], a[104:107], a[40:43], v[188:191]
ds_read_b128 a[148:151], v5 offset:23552
v_fmac_f32 v156, v48, v84
v_mfma_f32_16x16x32_bf16 v[212:215], a[104:107], a[44:47], v[212:215]
v_fmac_f32 v180, v48, v86
v_mfma_f32_16x16x32_bf16 v[216:219], a[108:111], a[44:47], v[216:219]
buffer_load_dwordx4 v1, s[4:7], s44 offen offset:1024 sc1 lds
v_mfma_f32_16x16x32_bf16 v[192:195], a[108:111], a[40:43], v[192:195]
ds_read_b128 a[152:155], v6 offset:5120
v_fmac_f32 v204, v48, v88
v_mfma_f32_16x16x32_bf16 v[168:171], a[108:111], a[36:39], v[168:171]
ds_read_b128 a[156:159], v6 offset:29696
v_fmac_f32 v208, v52, v88
v_mfma_f32_16x16x32_bf16 v[144:147], a[108:111], a[32:35], v[144:147]
buffer_load_dwordx4 a[24:27], v2, s[40:43], s35 offen offset:2048 sc1
v_mfma_f32_16x16x32_bf16 v[148:151], a[112:115], a[32:35], v[148:151]
v_fmac_f32 v184, v52, v86
v_fmac_f32 v160, v52, v84
v_mfma_f32_16x16x32_bf16 v[172:175], a[112:115], a[36:39], v[172:175]
v_fmac_f32 v136, v52, v82
v_fmac_f32 v140, v56, v82
v_mfma_f32_16x16x32_bf16 v[196:199], a[112:115], a[40:43], v[196:199]
v_fmac_f32 v164, v56, v84
v_mfma_f32_16x16x32_bf16 v[220:223], a[112:115], a[44:47], v[220:223]
buffer_load_dwordx4 v1, s[4:7], s44 offen offset:2048 sc1 lds
v_mfma_f32_16x16x32_bf16 v[224:227], a[116:119], a[44:47], v[224:227]
v_fmac_f32 v188, v56, v86
v_fmac_f32 v212, v56, v88
v_mfma_f32_16x16x32_bf16 v[200:203], a[116:119], a[40:43], v[200:203]
v_fmac_f32 v216, v60, v88
v_mfma_f32_16x16x32_bf16 v[176:179], a[116:119], a[36:39], v[176:179]
v_fmac_f32 v192, v60, v86
v_mfma_f32_16x16x32_bf16 v[152:155], a[116:119], a[32:35], v[152:155]
buffer_load_dwordx4 a[28:31], v2, s[40:43], s35 offen offset:3072 sc1
s_add_u32 s35, s35, 4096
v_mfma_f32_16x16x32_bf16 a[88:91], a[120:123], a[64:67], a[88:91]
v_fmac_f32 v168, v60, v84
v_fmac_f32 v144, v60, v82
v_mfma_f32_16x16x32_bf16 a[88:91], a[124:127], a[68:71], a[88:91]
v_fmac_f32 v148, v64, v82
s_waitcnt vmcnt(13) lgkmcnt(0)
v_mfma_f32_16x16x32_bf16 v[132:135], a[128:131], a[48:51], v[132:135]
ds_read_b128 a[96:99], v5 offset:24576
v_fmac_f32 v172, v64, v84
v_mfma_f32_16x16x32_bf16 v[156:159], a[128:131], a[52:55], v[156:159]
buffer_load_dwordx4 a[32:35], v2, s[40:43], s35 offen offset:0 sc1
s_lshl_b32 s90, s28, 12
v_mfma_f32_16x16x32_bf16 v[180:183], a[128:131], a[56:59], v[180:183]
ds_read_b128 a[100:103], v5 offset:25600
v_fmac_f32 v196, v64, v86
v_mfma_f32_16x16x32_bf16 v[204:207], a[128:131], a[60:63], v[204:207]
v_fmac_f32 v220, v64, v88
v_fmac_f32 v224, v68, v88
v_mfma_f32_16x16x32_bf16 v[208:211], a[132:135], a[60:63], v[208:211]
buffer_load_dwordx4 v1, s[4:7], s44 offen offset:3072 sc1 lds
s_add_i32 s44, s28, 8
v_mfma_f32_16x16x32_bf16 v[184:187], a[132:135], a[56:59], v[184:187]
s_lshl_b32 s45, s44, 12
s_add_u32 m0, s45, 32768
s_and_b32 s45, s44, 7
v_mfma_f32_16x16x32_bf16 v[160:163], a[132:135], a[52:55], v[160:163]
s_cmp_eq_u32 s45, s3
s_cselect_b32 s45, 8, 0
s_add_u32 s44, s44, s45
v_mfma_f32_16x16x32_bf16 v[136:139], a[132:135], a[48:51], v[136:139]
s_and_b32 s44, s44, 31
s_lshl_b32 s44, s44, 12
s_add_u32 s44, s44, s51
v_mfma_f32_16x16x32_bf16 v[140:143], a[136:139], a[48:51], v[140:143]
buffer_load_dwordx4 a[36:39], v2, s[40:43], s35 offen offset:1024 sc1
s_add_u32 s90, s90, 147456
v_mfma_f32_16x16x32_bf16 v[164:167], a[136:139], a[52:55], v[164:167]
ds_read_b128 a[104:107], v5 offset:26624
v_fmac_f32 v200, v68, v86
v_mfma_f32_16x16x32_bf16 v[188:191], a[136:139], a[56:59], v[188:191]
ds_read_b128 a[108:111], v5 offset:27648
v_fmac_f32 v176, v68, v84
v_mfma_f32_16x16x32_bf16 v[212:215], a[136:139], a[60:63], v[212:215]
ds_read_b128 a[112:115], v5 offset:28672
v_fmac_f32 v152, v68, v82
v_mfma_f32_16x16x32_bf16 v[216:219], a[140:143], a[60:63], v[216:219]
buffer_load_dwordx4 v1, s[4:7], s44 offen offset:0 sc1 lds
v_mfma_f32_16x16x32_bf16 v[192:195], a[140:143], a[56:59], v[192:195]
ds_read_b128 a[116:119], v5 offset:29696
v_fmac_f32 v133, v49, v82
v_mfma_f32_16x16x32_bf16 v[168:171], a[140:143], a[52:55], v[168:171]
v_fmac_f32 v157, v49, v84
v_fmac_f32 v181, v49, v86
v_mfma_f32_16x16x32_bf16 v[144:147], a[140:143], a[48:51], v[144:147]
buffer_load_dwordx4 a[40:43], v2, s[40:43], s35 offen offset:2048 sc1
v_mfma_f32_16x16x32_bf16 v[148:151], a[144:147], a[48:51], v[148:151]
v_fmac_f32 v205, v49, v88
v_fmac_f32 v209, v53, v88
v_mfma_f32_16x16x32_bf16 v[172:175], a[144:147], a[52:55], v[172:175]
v_fmac_f32 v185, v53, v86
v_fmac_f32 v161, v53, v84
v_mfma_f32_16x16x32_bf16 v[196:199], a[144:147], a[56:59], v[196:199]
v_fmac_f32 v137, v53, v82
v_fmac_f32 v141, v57, v82
v_mfma_f32_16x16x32_bf16 v[220:223], a[144:147], a[60:63], v[220:223]
buffer_load_dwordx4 v1, s[4:7], s44 offen offset:1024 sc1 lds
v_mfma_f32_16x16x32_bf16 v[224:227], a[148:151], a[60:63], v[224:227]
v_fmac_f32 v165, v57, v84
v_fmac_f32 v189, v57, v86
v_mfma_f32_16x16x32_bf16 v[200:203], a[148:151], a[56:59], v[200:203]
v_fmac_f32 v213, v57, v88
v_fmac_f32 v217, v61, v88
v_mfma_f32_16x16x32_bf16 v[176:179], a[148:151], a[52:55], v[176:179]
v_fmac_f32 v193, v61, v86
v_add_u32 v234, s90, v1
v_mfma_f32_16x16x32_bf16 v[152:155], a[148:151], a[48:51], v[152:155]
buffer_load_dwordx4 a[44:47], v2, s[40:43], s35 offen offset:3072 sc1
s_add_u32 s35, s35, 4096
v_mfma_f32_16x16x32_bf16 a[92:95], a[152:155], a[64:67], a[92:95]
v_fmac_f32 v169, v61, v84
v_fmac_f32 v145, v61, v82
v_mfma_f32_16x16x32_bf16 a[92:95], a[156:159], a[68:71], a[92:95]
v_fmac_f32 v149, v65, v82
s_lshl_b32 s90, s28, 10
s_add_u32 s90, s90, 147456
v_add_u32 v235, s90, v1
s_waitcnt vmcnt(14) lgkmcnt(0)
v_mfma_f32_16x16x32_bf16 v[132:135], a[96:99], a[0:3], v[132:135]
ds_read_b128 a[128:131], v5 offset:30720
v_fmac_f32 v173, v65, v84
v_mfma_f32_16x16x32_bf16 v[156:159], a[96:99], a[4:7], v[156:159]
buffer_load_dwordx4 a[48:51], v2, s[40:43], s35 offen offset:0 sc1
L_stub2:
s_cbranch_execz L_wret0
v_mfma_f32_16x16x32_bf16 v[180:183], a[96:99], a[8:11], v[180:183]
ds_read_b128 a[132:135], v5 offset:31744
v_fmac_f32 v197, v65, v86
v_mfma_f32_16x16x32_bf16 v[204:207], a[96:99], a[12:15], v[204:207]
v_fmac_f32 v221, v65, v88
v_fmac_f32 v225, v69, v88
v_mfma_f32_16x16x32_bf16 v[208:211], a[100:103], a[12:15], v[208:211]
buffer_load_dwordx4 v1, s[4:7], s44 offen offset:2048 sc1 lds
v_mfma_f32_16x16x32_bf16 v[184:187], a[100:103], a[8:11], v[184:187]
ds_read_b128 a[136:139], v5 offset:32768
v_fmac_f32 v201, v69, v86
v_mfma_f32_16x16x32_bf16 v[160:163], a[100:103], a[4:7], v[160:163]
v_fmac_f32 v177, v69, v84
v_fmac_f32 v153, v69, v82
v_mfma_f32_16x16x32_bf16 v[136:139], a[100:103], a[0:3], v[136:139]
buffer_load_dwordx4 a[52:55], v2, s[40:43], s35 offen offset:1024 sc1
v_mfma_f32_16x16x32_bf16 v[140:143], a[104:107], a[0:3], v[140:143]
ds_read_b128 a[140:143], v5 offset:33792
v_mfma_f32_16x16x32_bf16 v[164:167], a[104:107], a[4:7], v[164:167]
v_fmac_f32 v134, v50, v82
v_mfma_f32_16x16x32_bf16 v[188:191], a[104:107], a[8:11], v[188:191]
ds_read_b128 a[144:147], v5 offset:34816
v_fmac_f32 v158, v50, v84
v_mfma_f32_16x16x32_bf16 v[212:215], a[104:107], a[12:15], v[212:215]
buffer_load_dwordx4 v1, s[4:7], s44 offen offset:3072 sc1 lds
s_add_i32 s44, s28, 12
v_mfma_f32_16x16x32_bf16 v[216:219], a[108:111], a[12:15], v[216:219]
s_lshl_b32 s45, s44, 12
s_add_u32 m0, s45, 32768
s_and_b32 s45, s44, 7
v_mfma_f32_16x16x32_bf16 v[192:195], a[108:111], a[8:11], v[192:195]
s_cmp_eq_u32 s45, s3
s_cselect_b32 s45, 8, 0
s_add_u32 s44, s44, s45
v_mfma_f32_16x16x32_bf16 v[168:171], a[108:111], a[4:7], v[168:171]
buffer_load_dwordx4 a[56:59], v2, s[40:43], s35 offen offset:2048 sc1
s_and_b32 s44, s44, 31
v_mfma_f32_16x16x32_bf16 v[144:147], a[108:111], a[0:3], v[144:147]
s_lshl_b32 s44, s44, 12
s_add_u32 s44, s44, s51
v_mfma_f32_16x16x32_bf16 v[148:151], a[112:115], a[0:3], v[148:151]
ds_read_b128 a[148:151], v5 offset:35840
v_fmac_f32 v182, v50, v86
v_mfma_f32_16x16x32_bf16 v[172:175], a[112:115], a[4:7], v[172:175]
v_fmac_f32 v206, v50, v88
v_fmac_f32 v210, v54, v88
v_mfma_f32_16x16x32_bf16 v[196:199], a[112:115], a[8:11], v[196:199]
buffer_load_dwordx4 v1, s[4:7], s44 offen offset:0 sc1 lds
v_mfma_f32_16x16x32_bf16 v[220:223], a[112:115], a[12:15], v[220:223]
v_fmac_f32 v186, v54, v86
v_fmac_f32 v162, v54, v84
v_mfma_f32_16x16x32_bf16 v[224:227], a[116:119], a[12:15], v[224:227]
v_fmac_f32 v138, v54, v82
v_fmac_f32 v142, v58, v82
v_mfma_f32_16x16x32_bf16 v[200:203], a[116:119], a[8:11], v[200:203]
buffer_load_dwordx4 a[60:63], v2, s[40:43], s35 offen offset:3072 sc1
s_add_u32 s35, s35, 4096
v_mfma_f32_16x16x32_bf16 v[176:179], a[116:119], a[4:7], v[176:179]
v_fmac_f32 v166, v58, v84
v_fmac_f32 v190, v58, v86
v_mfma_f32_16x16x32_bf16 v[152:155], a[116:119], a[0:3], v[152:155]
v_fmac_f32 v214, v58, v88
s_waitcnt vmcnt(14) lgkmcnt(0)
v_mfma_f32_16x16x32_bf16 v[132:135], a[128:131], a[16:19], v[132:135]
ds_read_b128 a[96:99], v5 offset:36864
v_fmac_f32 v218, v62, v88
v_mfma_f32_16x16x32_bf16 v[156:159], a[128:131], a[20:23], v[156:159]
buffer_load_dwordx4 v1, s[4:7], s44 offen offset:1024 sc1 lds
v_mfma_f32_16x16x32_bf16 v[180:183], a[128:131], a[24:27], v[180:183]
ds_read_b128 a[100:103], v5 offset:37888
v_fmac_f32 v194, v62, v86
v_mfma_f32_16x16x32_bf16 v[204:207], a[128:131], a[28:31], v[204:207]
v_fmac_f32 v170, v62, v84
v_fmac_f32 v146, v62, v82
v_mfma_f32_16x16x32_bf16 v[208:211], a[132:135], a[28:31], v[208:211]
buffer_load_dwordx4 v1, s[4:7], s44 offen offset:2048 sc1 lds
v_mfma_f32_16x16x32_bf16 v[184:187], a[132:135], a[24:27], v[184:187]
ds_read_b128 a[104:107], v5 offset:38912
v_fmac_f32 v150, v66, v82
v_mfma_f32_16x16x32_bf16 v[160:163], a[132:135], a[20:23], v[160:163]
v_fmac_f32 v174, v66, v84
v_fmac_f32 v198, v66, v86
v_mfma_f32_16x16x32_bf16 v[136:139], a[132:135], a[16:19], v[136:139]
buffer_load_dwordx4 v1, s[4:7], s44 offen offset:3072 sc1 lds
s_add_i32 s44, s28, 16
v_mfma_f32_16x16x32_bf16 v[140:143], a[136:139], a[16:19], v[140:143]
s_lshl_b32 s45, s44, 12
s_add_u32 m0, s45, 32768
s_and_b32 s45, s44, 7
v_mfma_f32_16x16x32_bf16 v[164:167], a[136:139], a[20:23], v[164:167]
s_cmp_eq_u32 s45, s3
s_cselect_b32 s45, 8, 0
s_add_u32 s44, s44, s45
v_mfma_f32_16x16x32_bf16 v[188:191], a[136:139], a[24:27], v[188:191]
s_and_b32 s44, s44, 31
s_lshl_b32 s44, s44, 12
s_add_u32 s44, s44, s51
v_mfma_f32_16x16x32_bf16 v[212:215], a[136:139], a[28:31], v[212:215]
buffer_load_dwordx4 v1, s[4:7], s44 offen offset:0 sc1 lds
v_mfma_f32_16x16x32_bf16 v[216:219], a[140:143], a[28:31], v[216:219]
ds_read_b128 a[108:111], v5 offset:39936
v_fmac_f32 v222, v66, v88
v_mfma_f32_16x16x32_bf16 v[192:195], a[140:143], a[24:27], v[192:195]
ds_read_b128 a[112:115], v5 offset:40960
v_fmac_f32 v226, v70, v88
v_mfma_f32_16x16x32_bf16 v[168:171], a[140:143], a[20:23], v[168:171]
buffer_load_dwordx4 v1, s[4:7], s44 offen offset:1024 sc1 lds
v_mfma_f32_16x16x32_bf16 v[144:147], a[140:143], a[16:19], v[144:147]
ds_read_b128 a[116:119], v5 offset:41984
v_fmac_f32 v202, v70, v86
v_mfma_f32_16x16x32_bf16 v[148:151], a[144:147], a[16:19], v[148:151]
v_fmac_f32 v178, v70, v84
v_fmac_f32 v154, v70, v82
v_mfma_f32_16x16x32_bf16 v[172:175], a[144:147], a[20:23], v[172:175]
v_fmac_f32 v135, v51, v82
v_fmac_f32 v159, v51, v84
v_mfma_f32_16x16x32_bf16 v[196:199], a[144:147], a[24:27], v[196:199]
buffer_load_dwordx4 v1, s[4:7], s44 offen offset:2048 sc1 lds
v_mfma_f32_16x16x32_bf16 v[220:223], a[144:147], a[28:31], v[220:223]
v_fmac_f32 v183, v51, v86
v_fmac_f32 v207, v51, v88
v_mfma_f32_16x16x32_bf16 v[224:227], a[148:151], a[28:31], v[224:227]
v_fmac_f32 v211, v55, v88
v_fmac_f32 v187, v55, v86
v_mfma_f32_16x16x32_bf16 v[200:203], a[148:151], a[24:27], v[200:203]
buffer_load_dwordx4 v1, s[4:7], s44 offen offset:3072 sc1 lds
v_mfma_f32_16x16x32_bf16 v[176:179], a[148:151], a[20:23], v[176:179]
v_fmac_f32 v163, v55, v84
v_fmac_f32 v139, v55, v82
v_mfma_f32_16x16x32_bf16 v[152:155], a[148:151], a[16:19], v[152:155]
v_fmac_f32 v143, v59, v82
s_waitcnt vmcnt(14) lgkmcnt(0)
v_mfma_f32_16x16x32_bf16 v[132:135], a[96:99], a[32:35], v[132:135]
ds_read_b128 a[128:131], v5 offset:43008
v_fmac_f32 v167, v59, v84
v_mfma_f32_16x16x32_bf16 v[156:159], a[96:99], a[36:39], v[156:159]
v_fmac_f32 v191, v59, v86
v_fmac_f32 v215, v59, v88
v_mfma_f32_16x16x32_bf16 v[180:183], a[96:99], a[40:43], v[180:183]
ds_read_b128 a[132:135], v5 offset:44032
v_fmac_f32 v219, v63, v88
v_mfma_f32_16x16x32_bf16 v[204:207], a[96:99], a[44:47], v[204:207]
v_fmac_f32 v195, v63, v86
v_fmac_f32 v171, v63, v84
v_mfma_f32_16x16x32_bf16 v[208:211], a[100:103], a[44:47], v[208:211]
v_fmac_f32 v147, v63, v82
v_fmac_f32 v151, v67, v82
v_mfma_f32_16x16x32_bf16 v[184:187], a[100:103], a[40:43], v[184:187]
ds_read_b128 a[136:139], v5 offset:45056
v_fmac_f32 v175, v67, v84
v_mfma_f32_16x16x32_bf16 v[160:163], a[100:103], a[36:39], v[160:163]
v_fmac_f32 v199, v67, v86
v_fmac_f32 v223, v67, v88
v_mfma_f32_16x16x32_bf16 v[136:139], a[100:103], a[32:35], v[136:139]
v_fmac_f32 v227, v71, v88
v_fmac_f32 v203, v71, v86
v_mfma_f32_16x16x32_bf16 v[140:143], a[104:107], a[32:35], v[140:143]
ds_read_b128 a[140:143], v5 offset:46080
v_fmac_f32 v179, v71, v84
v_mfma_f32_16x16x32_bf16 v[164:167], a[104:107], a[36:39], v[164:167]
v_fmac_f32 v155, v71, v82
v_mfma_f32_16x16x32_bf16 v[188:191], a[104:107], a[40:43], v[188:191]
ds_read_b128 a[144:147], v5 offset:47104
v_mfma_f32_16x16x32_bf16 v[212:215], a[104:107], a[44:47], v[212:215]
ds_write_b128 v234, a[80:83] offset:0
v_mfma_f32_16x16x32_bf16 v[216:219], a[108:111], a[44:47], v[216:219]
ds_write_b128 v234, a[84:87] offset:1024
v_mfma_f32_16x16x32_bf16 v[192:195], a[108:111], a[40:43], v[192:195]
ds_read_b128 a[148:151], v5 offset:48128
v_mfma_f32_16x16x32_bf16 v[168:171], a[108:111], a[36:39], v[168:171]
ds_write_b128 v234, a[88:91] offset:2048
v_mfma_f32_16x16x32_bf16 v[144:147], a[108:111], a[32:35], v[144:147]
ds_write_b128 v234, a[92:95] offset:3072
v_mfma_f32_16x16x32_bf16 v[148:151], a[112:115], a[32:35], v[148:151]
v_mfma_f32_16x16x32_bf16 v[172:175], a[112:115], a[36:39], v[172:175]
v_mfma_f32_16x16x32_bf16 v[196:199], a[112:115], a[40:43], v[196:199]
v_mfma_f32_16x16x32_bf16 v[220:223], a[112:115], a[44:47], v[220:223]
v_mfma_f32_16x16x32_bf16 v[224:227], a[116:119], a[44:47], v[224:227]
v_mfma_f32_16x16x32_bf16 v[200:203], a[116:119], a[40:43], v[200:203]
v_mfma_f32_16x16x32_bf16 v[176:179], a[116:119], a[36:39], v[176:179]
v_mfma_f32_16x16x32_bf16 v[152:155], a[116:119], a[32:35], v[152:155]
s_waitcnt vmcnt(7) lgkmcnt(0)
s_barrier
v_mfma_f32_16x16x32_bf16 v[132:135], a[128:131], a[48:51], v[132:135]
ds_read_b128 v[92:95], v235 offset:0
v_mfma_f32_16x16x32_bf16 v[156:159], a[128:131], a[52:55], v[156:159]
v_mfma_f32_16x16x32_bf16 v[180:183], a[128:131], a[56:59], v[180:183]
ds_read_b128 v[96:99], v235 offset:4096
v_mfma_f32_16x16x32_bf16 v[204:207], a[128:131], a[60:63], v[204:207]
v_mfma_f32_16x16x32_bf16 v[208:211], a[132:135], a[60:63], v[208:211]
ds_read_b128 v[100:103], v235 offset:8192
v_mfma_f32_16x16x32_bf16 v[184:187], a[132:135], a[56:59], v[184:187]
v_mfma_f32_16x16x32_bf16 v[160:163], a[132:135], a[52:55], v[160:163]
ds_read_b128 v[104:107], v235 offset:12288
v_mfma_f32_16x16x32_bf16 v[136:139], a[132:135], a[48:51], v[136:139]
v_mfma_f32_16x16x32_bf16 v[140:143], a[136:139], a[48:51], v[140:143]
v_mfma_f32_16x16x32_bf16 v[164:167], a[136:139], a[52:55], v[164:167]
v_mfma_f32_16x16x32_bf16 v[188:191], a[136:139], a[56:59], v[188:191]
v_mfma_f32_16x16x32_bf16 v[212:215], a[136:139], a[60:63], v[212:215]
v_mfma_f32_16x16x32_bf16 v[216:219], a[140:143], a[60:63], v[216:219]
v_mfma_f32_16x16x32_bf16 v[192:195], a[140:143], a[56:59], v[192:195]
v_mfma_f32_16x16x32_bf16 v[168:171], a[140:143], a[52:55], v[168:171]
v_mfma_f32_16x16x32_bf16 v[144:147], a[140:143], a[48:51], v[144:147]
v_mfma_f32_16x16x32_bf16 v[148:151], a[144:147], a[48:51], v[148:151]
v_mfma_f32_16x16x32_bf16 v[172:175], a[144:147], a[52:55], v[172:175]
v_mfma_f32_16x16x32_bf16 v[196:199], a[144:147], a[56:59], v[196:199]
v_mfma_f32_16x16x32_bf16 v[220:223], a[144:147], a[60:63], v[220:223]
v_mfma_f32_16x16x32_bf16 v[224:227], a[148:151], a[60:63], v[224:227]
v_mfma_f32_16x16x32_bf16 v[200:203], a[148:151], a[56:59], v[200:203]
v_mfma_f32_16x16x32_bf16 v[176:179], a[148:151], a[52:55], v[176:179]
v_mfma_f32_16x16x32_bf16 v[152:155], a[148:151], a[48:51], v[152:155]
.set L_cpf0, .
s_lshl_b32 s36, s28, 12
s_lshl_b32 s37, s28, 10
s_add_i32 s44, s28, 0
s_lshl_b32 s45, s44, 12
s_add_u32 m0, s45, 32768
s_and_b32 s45, s44, 7
s_cmp_eq_u32 s45, s3
s_cselect_b32 s45, 8, 0
s_add_u32 s44, s44, s45
s_and_b32 s44, s44, 31
s_lshl_b32 s44, s44, 12
s_add_u32 s44, s44, s51
buffer_load_dwordx4 v1, s[4:7], s44 offen offset:0 sc1 lds
s_waitcnt lgkmcnt(2)
v_add_f32 v92, v92, v96
s_waitcnt lgkmcnt(0)
v_add_f32 v100, v100, v104
v_add_f32 v93, v93, v97
v_add_f32 v101, v101, v105
v_add_f32 v94, v94, v98
v_add_f32 v102, v102, v106
v_add_f32 v95, v95, v99
v_add_f32 v103, v103, v107
v_add_f32 v228, v92, v100
v_add_f32 v229, v93, v101
v_add_f32 v230, v94, v102
v_add_f32 v231, v95, v103
v_fmac_f32 v228, v72, v90
v_fmac_f32 v229, v73, v90
v_pk_mul_f32 v[212:213], v[212:213], v[88:89] op_sel:[0,1] op_sel_hi:[1,1]
v_pk_mul_f32 v[220:221], v[220:221], v[88:89] op_sel:[0,1] op_sel_hi:[1,1]
v_pk_mul_f32 v[196:197], v[196:197], v[86:87] op_sel:[0,1] op_sel_hi:[1,1]
v_pk_mul_f32 v[172:173], v[172:173], v[84:85] op_sel:[0,1] op_sel_hi:[1,1]
v_pk_mul_f32 v[148:149], v[148:149], v[82:83] op_sel:[0,1] op_sel_hi:[1,1]
v_fmac_f32 v230, v74, v90
v_fmac_f32 v231, v75, v90
v_pk_mul_f32 v[228:229], v[228:229], v[90:91] op_sel:[0,1] op_sel_hi:[1,1]
v_pk_mul_f32 v[214:215], v[214:215], v[88:89] op_sel:[0,1] op_sel_hi:[1,1]
v_pk_mul_f32 v[222:223], v[222:223], v[88:89] op_sel:[0,1] op_sel_hi:[1,1]
v_pk_mul_f32 v[198:199], v[198:199], v[86:87] op_sel:[0,1] op_sel_hi:[1,1]
v_pk_mul_f32 v[174:175], v[174:175], v[84:85] op_sel:[0,1] op_sel_hi:[1,1]
v_pk_mul_f32 v[150:151], v[150:151], v[82:83] op_sel:[0,1] op_sel_hi:[1,1]
v_cvt_pk_bf16_f32 v212, v212, v213
v_cvt_pk_bf16_f32 v220, v220, v221
v_cvt_pk_bf16_f32 v196, v196, v197
buffer_load_dwordx4 v1, s[4:7], s44 offen offset:1024 sc1 lds
v_cvt_pk_bf16_f32 v172, v172, v173
v_cvt_pk_bf16_f32 v148, v148, v149
v_pk_mul_f32 v[230:231], v[230:231], v[90:91] op_sel:[0,1] op_sel_hi:[1,1]
v_pk_mul_f32 v[216:217], v[216:217], v[88:89] op_sel:[0,1] op_sel_hi:[1,1]
v_pk_mul_f32 v[218:219], v[218:219], v[88:89] op_sel:[0,1] op_sel_hi:[1,1]
v_pk_mul_f32 v[224:225], v[224:225], v[88:89] op_sel:[0,1] op_sel_hi:[1,1]
v_pk_mul_f32 v[226:227], v[226:227], v[88:89] op_sel:[0,1] op_sel_hi:[1,1]
v_pk_mul_f32 v[200:201], v[200:201], v[86:87] op_sel:[0,1] op_sel_hi:[1,1]
v_pk_mul_f32 v[202:203], v[202:203], v[86:87] op_sel:[0,1] op_sel_hi:[1,1]
v_pk_mul_f32 v[176:177], v[176:177], v[84:85] op_sel:[0,1] op_sel_hi:[1,1]
v_pk_mul_f32 v[178:179], v[178:179], v[84:85] op_sel:[0,1] op_sel_hi:[1,1]
v_pk_mul_f32 v[152:153], v[152:153], v[82:83] op_sel:[0,1] op_sel_hi:[1,1]
v_pk_mul_f32 v[154:155], v[154:155], v[82:83] op_sel:[0,1] op_sel_hi:[1,1]
v_cvt_pk_bf16_f32 v228, v228, v229
v_cvt_pk_bf16_f32 v213, v214, v215
v_cvt_pk_bf16_f32 v221, v222, v223
v_cvt_pk_bf16_f32 v197, v198, v199
v_cvt_pk_bf16_f32 v173, v174, v175
v_cvt_pk_bf16_f32 v149, v150, v151
v_pk_mul_f32 v[188:189], v[188:189], v[86:87] op_sel:[0,1] op_sel_hi:[1,1]
v_pk_mul_f32 v[164:165], v[164:165], v[84:85] op_sel:[0,1] op_sel_hi:[1,1]
v_pk_mul_f32 v[140:141], v[140:141], v[82:83] op_sel:[0,1] op_sel_hi:[1,1]
v_add_u32 v232, s36, v7
v_add_u32 v233, s37, v1
v_cvt_pk_bf16_f32 v229, v230, v231
v_cvt_pk_bf16_f32 v214, v216, v217
v_cvt_pk_bf16_f32 v215, v218, v219
v_cvt_pk_bf16_f32 v222, v224, v225
v_cvt_pk_bf16_f32 v223, v226, v227
v_cvt_pk_bf16_f32 v198, v200, v201
buffer_load_dwordx4 v1, s[4:7], s44 offen offset:2048 sc1 lds
v_cvt_pk_bf16_f32 v199, v202, v203
v_cvt_pk_bf16_f32 v174, v176, v177
v_cvt_pk_bf16_f32 v175, v178, v179
v_cvt_pk_bf16_f32 v150, v152, v153
v_cvt_pk_bf16_f32 v151, v154, v155
v_pk_mul_f32 v[190:191], v[190:191], v[86:87] op_sel:[0,1] op_sel_hi:[1,1]
v_pk_mul_f32 v[166:167], v[166:167], v[84:85] op_sel:[0,1] op_sel_hi:[1,1]
v_pk_mul_f32 v[142:143], v[142:143], v[82:83] op_sel:[0,1] op_sel_hi:[1,1]
v_cvt_pk_bf16_f32 v188, v188, v189
v_cvt_pk_bf16_f32 v164, v164, v165
v_cvt_pk_bf16_f32 v140, v140, v141
v_cvt_pk_bf16_f32 v132, v132, v133
v_cvt_pk_bf16_f32 v156, v156, v157
v_cvt_pk_bf16_f32 v180, v180, v181
v_cvt_pk_bf16_f32 v204, v204, v205
ds_write_b64 v9, v[228:229]
ds_write_b64 v232, v[220:221] offset:4096
ds_write_b64 v232, v[222:223] offset:4608
v_pk_mul_f32 v[192:193], v[192:193], v[86:87] op_sel:[0,1] op_sel_hi:[1,1]
v_pk_mul_f32 v[194:195], v[194:195], v[86:87] op_sel:[0,1] op_sel_hi:[1,1]
v_pk_mul_f32 v[168:169], v[168:169], v[84:85] op_sel:[0,1] op_sel_hi:[1,1]
ds_write_b64 v232, v[196:197] offset:3072
buffer_load_dwordx4 v1, s[4:7], s44 offen offset:3072 sc1 lds
s_add_i32 s44, s28, 20
s_lshl_b32 s45, s44, 12
s_add_u32 m0, s45, 32768
s_and_b32 s45, s44, 7
s_cmp_eq_u32 s45, s3
s_cselect_b32 s45, 8, 0
s_add_u32 s44, s44, s45
s_and_b32 s44, s44, 31
s_lshl_b32 s44, s44, 12
s_add_u32 s44, s44, s51
ds_write_b64 v232, v[198:199] offset:3584
v_pk_mul_f32 v[170:171], v[170:171], v[84:85] op_sel:[0,1] op_sel_hi:[1,1]
ds_write_b64 v232, v[172:173] offset:2048
ds_write_b64 v232, v[174:175] offset:2560
v_pk_mul_f32 v[144:145], v[144:145], v[82:83] op_sel:[0,1] op_sel_hi:[1,1]
v_pk_mul_f32 v[146:147], v[146:147], v[82:83] op_sel:[0,1] op_sel_hi:[1,1]
ds_write_b64 v232, v[148:149] offset:1024
v_cvt_pk_bf16_f32 v189, v190, v191
v_cvt_pk_bf16_f32 v165, v166, v167
v_cvt_pk_bf16_f32 v141, v142, v143
ds_write_b64 v232, v[150:151] offset:1536
buffer_load_dwordx4 v1, s[4:7], s44 offen offset:0 sc1 lds
v_cvt_pk_bf16_f32 v133, v134, v135
ds_write_b128 v233, v[212:215] offset:21504
v_cvt_pk_bf16_f32 v157, v158, v159
v_cvt_pk_bf16_f32 v181, v182, v183
v_cvt_pk_bf16_f32 v205, v206, v207
v_cvt_pk_bf16_f32 v190, v192, v193
v_cvt_pk_bf16_f32 v191, v194, v195
v_cvt_pk_bf16_f32 v166, v168, v169
v_cvt_pk_bf16_f32 v167, v170, v171
v_cvt_pk_bf16_f32 v142, v144, v145
v_cvt_pk_bf16_f32 v143, v146, v147
v_cvt_pk_bf16_f32 v134, v136, v137
v_cvt_pk_bf16_f32 v135, v138, v139
v_cvt_pk_bf16_f32 v158, v160, v161
v_cvt_pk_bf16_f32 v159, v162, v163
v_cvt_pk_bf16_f32 v182, v184, v185
v_cvt_pk_bf16_f32 v183, v186, v187
v_cvt_pk_bf16_f32 v206, v208, v209
v_cvt_pk_bf16_f32 v207, v210, v211
buffer_load_dwordx4 v1, s[4:7], s44 offen offset:1024 sc1 lds
buffer_load_dwordx4 v1, s[4:7], s44 offen offset:2048 sc1 lds
buffer_load_dwordx4 v1, s[4:7], s44 offen offset:3072 sc1 lds
s_waitcnt lgkmcnt(0)
s_barrier
s_lshl_b32 s35, s30, 12
s_add_u32 s35, s35, 0x1e00000
s_add_i32 s44, s28, 24
s_lshl_b32 s45, s44, 12
s_add_u32 m0, s45, 32768
s_and_b32 s45, s44, 7
s_cmp_eq_u32 s45, s3
s_cselect_b32 s45, 8, 0
s_add_u32 s44, s44, s45
s_and_b32 s44, s44, 31
s_lshl_b32 s44, s44, 12
s_add_u32 s44, s44, s51
buffer_load_dwordx4 v1, s[4:7], s44 offen offset:0 sc1 lds
v_mfma_f32_16x16x32_bf16 v[184:187], v[164:167], v[180:183], v[20:23]
ds_read_b128 a[0:3], v233 offset:20480
v_mfma_f32_16x16x32_bf16 v[200:203], v[188:191], v[180:183], v[24:27]
v_add_u32 v234, s36, v8
ds_read_b64_tr_b16 a[10:11], v234 offset:3072
v_mfma_f32_16x16x32_bf16 v[208:211], v[188:191], v[204:207], v[20:23]
ds_read_b64_tr_b16 a[12:13], v234 offset:4096
v_mfma_f32_16x16x32_bf16 v[224:227], v[212:215], v[204:207], v[24:27]
s_nop 2
v_max_f32 v200, v200, v184
v_max_f32 v201, v201, v185
v_max_f32 v202, v202, v186
v_max_f32 v203, v203, v187
v_max3_f32 v238, v200, v201, v202
v_max_f32 v238, v238, v203
ds_read_b64_tr_b16 a[22:23], v234 offset:3584
v_max_f32 v224, v224, v208
v_max_f32 v225, v225, v209
v_max_f32 v226, v226, v210
v_max_f32 v227, v227, v211
v_max3_f32 v239, v224, v225, v226
v_max_f32 v239, v239, v227
ds_read_b64_tr_b16 a[24:25], v234 offset:4608
buffer_load_dwordx4 v1, s[4:7], s44 offen offset:1024 sc1 lds
v_permlane32_swap_b32 v239, v238
v_max_f32 v239, v239, v238
v_mov_b32 v242, v239
s_waitcnt lgkmcnt(4)
v_mfma_f32_16x16x32_bf16 v[136:139], a[0:3], v[132:135], v[76:79]
v_permlane16_swap_b32 v239, v242
v_max_f32 v239, v239, v242
v_mov_b32 v242, v239
v_mfma_f32_16x16x32_bf16 v[152:155], v[140:143], v[132:135], v[24:27]
s_nop 0
v_permlane32_swap_b32 v239, v242
v_mfma_f32_16x16x32_bf16 v[160:163], v[140:143], v[156:159], v[20:23]
v_mul_f32 v88, 0x3e8293ee, v89
v_mul_f32_e64 v89, -v239, v88
v_mfma_f32_16x16x32_bf16 v[176:179], v[164:167], v[156:159], v[24:27]
v_fma_f32 v224, v224, v88, v89
v_fma_f32 v225, v225, v88, v89
v_fma_f32 v226, v226, v88, v89
v_fma_f32 v227, v227, v88, v89
v_exp_f32 v224, v224
v_exp_f32 v225, v225
v_exp_f32 v226, v226
buffer_load_dwordx4 v1, s[4:7], s44 offen offset:2048 sc1 lds
v_exp_f32 v227, v227
v_max_f32 v152, v152, v136
v_max_f32 v153, v153, v137
v_max_f32 v154, v154, v138
v_max_f32 v176, v176, v160
v_max_f32 v177, v177, v161
v_max_f32 v178, v178, v162
v_cvt_pk_bf16_f32 v224, v224, v225
ds_read_b64_tr_b16 a[8:9], v234 offset:2048
v_max_f32 v155, v155, v139
v_max3_f32 v236, v152, v153, v154
v_max_f32 v179, v179, v163
v_max3_f32 v237, v176, v177, v178
v_cvt_pk_bf16_f32 v225, v226, v227
ds_read_b64_tr_b16 a[20:21], v234 offset:2560
v_max_f32 v236, v236, v155
v_max_f32 v237, v237, v179
v_and_b32 v208, v224, v28
v_and_b32 v209, v225, v29
v_and_b32 v210, v224, v30
v_and_b32 v211, v225, v31
v_permlane32_swap_b32 v237, v236
s_nop 0
v_mfma_f32_16x16x32_bf16 v[216:219], v[16:19], v[208:211], 0
v_mul_f32 v86, 0x3e8293ee, v87
v_max_f32 v237, v237, v236
buffer_load_dwordx4 v1, s[4:7], s44 offen offset:3072 sc1 lds
s_add_i32 s44, s28, 28
s_lshl_b32 s45, s44, 12
s_add_u32 m0, s45, 32768
s_and_b32 s45, s44, 7
s_cmp_eq_u32 s45, s3
s_cselect_b32 s45, 8, 0
s_add_u32 s44, s44, s45
s_and_b32 s44, s44, 31
s_lshl_b32 s44, s44, 12
s_add_u32 s44, s44, s51
v_mul_f32_e64 v87, -v242, v86
s_waitcnt lgkmcnt(4)
v_mfma_f32_16x16x32_bf16 v[116:119], a[10:13], v[208:211], 0
v_mov_b32 v243, v237
v_fma_f32 v200, v200, v86, v87
v_fma_f32 v201, v201, v86, v87
v_fma_f32 v202, v202, v86, v87
v_fma_f32 v203, v203, v86, v87
s_waitcnt lgkmcnt(2)
v_mfma_f32_16x16x32_bf16 v[120:123], a[22:25], v[208:211], 0
v_exp_f32 v200, v200
v_exp_f32 v201, v201
v_exp_f32 v202, v202
v_exp_f32 v203, v203
v_permlane16_swap_b32 v237, v243
buffer_load_dwordx4 v1, s[4:7], s44 offen offset:0 sc1 lds
v_rcp_f32 v216, v216
v_cvt_pk_bf16_f32 v200, v200, v201
ds_read_b64_tr_b16 a[6:7], v234 offset:1024
v_max_f32 v237, v237, v243
v_cvt_pk_bf16_f32 v201, v202, v203
ds_read_b64_tr_b16 a[18:19], v234 offset:1536
v_mov_b32 v243, v237
v_and_b32 v184, v200, v28
v_and_b32 v185, v201, v29
v_and_b32 v186, v200, v30
v_and_b32 v187, v201, v31
v_pk_mul_f32 v[116:117], v[116:117], v[216:217] op_sel:[0,0] op_sel_hi:[1,0]
v_pk_mul_f32 v[118:119], v[118:119], v[216:217] op_sel:[0,0] op_sel_hi:[1,0]
v_cvt_pk_bf16_f32 v116, v116, v117
v_pk_mul_f32 v[120:121], v[120:121], v[216:217] op_sel:[0,0] op_sel_hi:[1,0]
v_permlane32_swap_b32 v237, v243
v_pk_mul_f32 v[122:123], v[122:123], v[216:217] op_sel:[0,0] op_sel_hi:[1,0]
v_cvt_pk_bf16_f32 v117, v118, v119
v_mfma_f32_16x16x32_bf16 v[192:195], v[16:19], v[184:187], 0
v_cvt_pk_bf16_f32 v118, v120, v121
v_cvt_pk_bf16_f32 v119, v122, v123
v_mul_f32 v84, 0x3e8293ee, v85
v_mul_f32_e64 v85, -v237, v84
s_waitcnt lgkmcnt(3)
v_mfma_f32_16x16x32_bf16 v[108:111], a[8:11], v[184:187], 0
buffer_load_dwordx4 v1, s[4:7], s44 offen offset:1024 sc1 lds
v_fma_f32 v176, v176, v84, v85
v_fma_f32 v177, v177, v84, v85
v_fma_f32 v178, v178, v84, v85
v_fma_f32 v179, v179, v84, v85
s_waitcnt lgkmcnt(2)
v_mfma_f32_16x16x32_bf16 v[112:115], a[20:23], v[184:187], 0
v_exp_f32 v176, v176
v_exp_f32 v177, v177
v_exp_f32 v178, v178
v_exp_f32 v179, v179
v_rcp_f32 v192, v192
v_cvt_pk_bf16_f32 v176, v176, v177
ds_read_b64_tr_b16 a[4:5], v234 offset:0
v_cvt_pk_bf16_f32 v177, v178, v179
ds_read_b64_tr_b16 a[16:17], v234 offset:512
v_and_b32 v160, v176, v28
v_and_b32 v161, v177, v29
v_and_b32 v162, v176, v30
v_and_b32 v163, v177, v31
v_pk_mul_f32 v[108:109], v[108:109], v[192:193] op_sel:[0,0] op_sel_hi:[1,0]
v_pk_mul_f32 v[110:111], v[110:111], v[192:193] op_sel:[0,0] op_sel_hi:[1,0]
v_cvt_pk_bf16_f32 v108, v108, v109
v_pk_mul_f32 v[112:113], v[112:113], v[192:193] op_sel:[0,0] op_sel_hi:[1,0]
buffer_load_dwordx4 v1, s[4:7], s44 offen offset:2048 sc1 lds
v_pk_mul_f32 v[114:115], v[114:115], v[192:193] op_sel:[0,0] op_sel_hi:[1,0]
v_cvt_pk_bf16_f32 v109, v110, v111
v_mfma_f32_16x16x32_bf16 v[168:171], v[16:19], v[160:163], 0
v_cvt_pk_bf16_f32 v110, v112, v113
v_cvt_pk_bf16_f32 v111, v114, v115
v_mul_f32 v82, 0x3e8293ee, v83
v_mul_f32_e64 v83, -v243, v82
s_waitcnt lgkmcnt(3)
v_mfma_f32_16x16x32_bf16 v[100:103], a[6:9], v[160:163], 0
v_fma_f32 v152, v152, v82, v83
v_fma_f32 v153, v153, v82, v83
v_fma_f32 v154, v154, v82, v83
v_fma_f32 v155, v155, v82, v83
s_waitcnt lgkmcnt(2)
v_mfma_f32_16x16x32_bf16 v[104:107], a[18:21], v[160:163], 0
v_exp_f32 v152, v152
v_exp_f32 v153, v153
v_exp_f32 v154, v154
v_exp_f32 v155, v155
v_rcp_f32 v168, v168
v_cvt_pk_bf16_f32 v152, v152, v153
v_cvt_pk_bf16_f32 v153, v154, v155
v_and_b32 v136, v152, v80
v_and_b32 v137, v153, v81
buffer_load_dwordx4 v1, s[4:7], s44 offen offset:3072 sc1 lds
v_and_b32 v138, v152, v30
v_and_b32 v139, v153, v31
v_pk_mul_f32 v[100:101], v[100:101], v[168:169] op_sel:[0,0] op_sel_hi:[1,0]
v_pk_mul_f32 v[102:103], v[102:103], v[168:169] op_sel:[0,0] op_sel_hi:[1,0]
v_cvt_pk_bf16_f32 v100, v100, v101
v_pk_mul_f32 v[104:105], v[104:105], v[168:169] op_sel:[0,0] op_sel_hi:[1,0]
v_cvt_pk_bf16_f32 v101, v102, v103
v_pk_mul_f32 v[106:107], v[106:107], v[168:169] op_sel:[0,0] op_sel_hi:[1,0]
v_cvt_pk_bf16_f32 v102, v104, v105
v_mfma_f32_16x16x32_bf16 v[144:147], v[16:19], v[136:139], 0
v_cvt_pk_bf16_f32 v103, v106, v107
s_waitcnt lgkmcnt(1)
v_mfma_f32_16x16x32_bf16 v[92:95], a[4:7], v[136:139], 0
s_waitcnt lgkmcnt(0)
v_mfma_f32_16x16x32_bf16 v[96:99], a[16:19], v[136:139], 0
s_nop 2
v_rcp_f32 v144, v144
s_nop 1
v_pk_mul_f32 v[92:93], v[92:93], v[144:145] op_sel:[0,0] op_sel_hi:[1,0]
v_pk_mul_f32 v[94:95], v[94:95], v[144:145] op_sel:[0,0] op_sel_hi:[1,0]
v_cvt_pk_bf16_f32 v92, v92, v93
v_cvt_pk_bf16_f32 v93, v94, v95
v_pk_mul_f32 v[96:97], v[96:97], v[144:145] op_sel:[0,0] op_sel_hi:[1,0]
v_pk_mul_f32 v[98:99], v[98:99], v[144:145] op_sel:[0,0] op_sel_hi:[1,0]
buffer_store_dwordx4 v[116:119], v2, s[4:7], s35 offen offset:3072 sc1
v_cvt_pk_bf16_f32 v94, v96, v97
v_cvt_pk_bf16_f32 v95, v98, v99
buffer_store_dwordx4 v[108:111], v2, s[4:7], s35 offen offset:2048 sc1
buffer_store_dwordx4 v[100:103], v2, s[4:7], s35 offen offset:1024 sc1
buffer_store_dwordx4 v[92:95], v2, s[4:7], s35 offen offset:0 sc1
s_add_u32 s92, s71, 0x0
s_add_u32 s40, s4, 0x1e00000
s_addc_u32 s41, s5, 0
v_add_u32 v5, 32768, v1
v_add_u32 v6, 98304, v1
s_cmp_eq_u32 s3, 0
s_cselect_b32 s35, 8, 0
s_lshl_b32 s35, s35, 12
v_lshlrev_b32 v132, 16, v32
v_and_b32 v133, 0xffff0000, v32
v_lshlrev_b32 v134, 16, v33
v_and_b32 v135, 0xffff0000, v33
v_lshlrev_b32 v136, 16, v34
v_and_b32 v137, 0xffff0000, v34
v_lshlrev_b32 v138, 16, v35
v_and_b32 v139, 0xffff0000, v35
v_lshlrev_b32 v140, 16, v36
v_and_b32 v141, 0xffff0000, v36
v_lshlrev_b32 v142, 16, v37
v_and_b32 v143, 0xffff0000, v37
v_lshlrev_b32 v144, 16, v38
v_and_b32 v145, 0xffff0000, v38
v_lshlrev_b32 v146, 16, v39
v_and_b32 v147, 0xffff0000, v39
v_lshlrev_b32 v148, 16, v40
v_and_b32 v149, 0xffff0000, v40
v_lshlrev_b32 v150, 16, v41
v_and_b32 v151, 0xffff0000, v41
v_lshlrev_b32 v152, 16, v42
v_and_b32 v153, 0xffff0000, v42
v_lshlrev_b32 v154, 16, v43
v_and_b32 v155, 0xffff0000, v43
v_lshlrev_b32 v156, 16, v44
v_and_b32 v157, 0xffff0000, v44
v_lshlrev_b32 v158, 16, v45
v_and_b32 v159, 0xffff0000, v45
v_lshlrev_b32 v160, 16, v46
v_and_b32 v161, 0xffff0000, v46
v_lshlrev_b32 v162, 16, v47
v_and_b32 v163, 0xffff0000, v47
s_waitcnt vmcnt(0)
s_barrier
s_cmp_lg_u32 s28, 1
s_cbranch_scc1 Lsg_4
buffer_atomic_add v12, v10, s[4:7], s92 offen sc1
buffer_atomic_swap v15, v14, s[4:7], s8 offen sc1
buffer_atomic_swap v15, v252, s[4:7], s62 offen offset:64 sc1
Lsg_4:
s_cmp_lg_u32 s28, 1
s_cbranch_scc1 L_wskip1
s_mov_b64 exec, 0
s_branch L_stub3
L_wret1:
s_mov_b64 exec, -1
L_wskip1:
s_cmp_lg_u32 s28, 0
s_cbranch_scc1 Lpe_6
s_add_u32 s36, s66, 0x0
s_mov_b32 s37, 0
Lpoll_5:
v_mov_b32 v11, 0
s_mov_b64 exec, 1
buffer_atomic_add v11, off, s[4:7], s36 sc0 sc1
s_waitcnt vmcnt(0)
v_readfirstlane_b32 s38, v11
s_mov_b64 exec, -1
s_nop 0
v_mov_b32 v11, s38
s_add_u32 s37, s37, 1
v_cmp_gt_u32 vcc, 32, v11
s_cbranch_vccz Lpe_6
s_cmp_lt_u32 s37, 0x100000
s_cbranch_scc1 Lpoll_5
Lpe_6:
s_waitcnt vmcnt(0)
s_barrier
L_k2go0:
L_stub3:
s_cbranch_execz L_stub4
buffer_load_dwordx4 a[0:3], v4, s[40:43], s35 offen offset:0 sc1
buffer_load_dwordx4 a[4:7], v4, s[40:43], s35 offen offset:1024 sc1
s_cmp_eq_u32 s3, 1
s_cselect_b32 s35, 9, 1
s_lshl_b32 s35, s35, 12
buffer_load_dwordx4 a[8:11], v4, s[40:43], s35 offen offset:0 sc1
buffer_load_dwordx4 a[12:15], v4, s[40:43], s35 offen offset:1024 sc1
s_cmp_eq_u32 s3, 2
s_cselect_b32 s35, 10, 2
s_lshl_b32 s35, s35, 12
buffer_load_dwordx4 a[16:19], v4, s[40:43], s35 offen offset:0 sc1
buffer_load_dwordx4 a[20:23], v4, s[40:43], s35 offen offset:1024 sc1
s_cmp_eq_u32 s3, 3
s_cselect_b32 s35, 11, 3
s_lshl_b32 s35, s35, 12
buffer_load_dwordx4 a[24:27], v4, s[40:43], s35 offen offset:0 sc1
buffer_load_dwordx4 a[28:31], v4, s[40:43], s35 offen offset:1024 sc1
s_cmp_eq_u32 s3, 4
s_cselect_b32 s35, 12, 4
s_lshl_b32 s35, s35, 12
buffer_load_dwordx4 a[32:35], v4, s[40:43], s35 offen offset:0 sc1
buffer_load_dwordx4 a[36:39], v4, s[40:43], s35 offen offset:1024 sc1
s_cmp_eq_u32 s3, 5
s_cselect_b32 s35, 13, 5
s_lshl_b32 s35, s35, 12
ds_read_b128 a[96:99], v5 offset:0
ds_read_b128 a[100:103], v5 offset:1024
ds_read_b128 a[104:107], v5 offset:2048
ds_read_b128 a[108:111], v5 offset:3072
ds_read_b128 a[112:115], v5 offset:4096
ds_read_b128 a[116:119], v5 offset:5120
ds_read_b128 a[120:123], v5 offset:6144
ds_read_b128 a[124:127], v5 offset:7168
s_waitcnt vmcnt(8) lgkmcnt(4)
v_mfma_f32_16x16x32_bf16 v[132:135], a[96:99], a[0:3], v[132:135]
ds_read_b128 a[128:131], v5 offset:8192
v_mfma_f32_16x16x32_bf16 v[148:151], a[96:99], a[4:7], v[148:151]
ds_read_b128 a[132:135], v5 offset:9216
v_mfma_f32_16x16x32_bf16 v[152:155], a[100:103], a[4:7], v[152:155]
buffer_load_dwordx4 a[40:43], v4, s[40:43], s35 offen offset:0 sc1
v_mfma_f32_16x16x32_bf16 v[136:139], a[100:103], a[0:3], v[136:139]
ds_read_b128 a[136:139], v5 offset:10240
v_mfma_f32_16x16x32_bf16 v[140:143], a[104:107], a[0:3], v[140:143]
ds_read_b128 a[140:143], v5 offset:11264
v_mfma_f32_16x16x32_bf16 v[156:159], a[104:107], a[4:7], v[156:159]
v_mfma_f32_16x16x32_bf16 v[160:163], a[108:111], a[4:7], v[160:163]
buffer_load_dwordx4 a[44:47], v4, s[40:43], s35 offen offset:1024 sc1
v_mfma_f32_16x16x32_bf16 v[144:147], a[108:111], a[0:3], v[144:147]
s_waitcnt vmcnt(8) lgkmcnt(4)
v_mfma_f32_16x16x32_bf16 v[132:135], a[112:115], a[8:11], v[132:135]
s_cmp_eq_u32 s3, 6
s_cselect_b32 s35, 14, 6
s_lshl_b32 s35, s35, 12
v_mfma_f32_16x16x32_bf16 v[148:151], a[112:115], a[12:15], v[148:151]
ds_read_b128 a[96:99], v5 offset:12288
v_mfma_f32_16x16x32_bf16 v[152:155], a[116:119], a[12:15], v[152:155]
buffer_load_dwordx4 a[0:3], v4, s[40:43], s35 offen offset:0 sc1
v_mfma_f32_16x16x32_bf16 v[136:139], a[116:119], a[8:11], v[136:139]
ds_read_b128 a[100:103], v5 offset:13312
v_mfma_f32_16x16x32_bf16 v[140:143], a[120:123], a[8:11], v[140:143]
ds_read_b128 a[104:107], v5 offset:14336
v_mfma_f32_16x16x32_bf16 v[156:159], a[120:123], a[12:15], v[156:159]
ds_read_b128 a[108:111], v5 offset:15360
v_mfma_f32_16x16x32_bf16 v[160:163], a[124:127], a[12:15], v[160:163]
buffer_load_dwordx4 a[4:7], v4, s[40:43], s35 offen offset:1024 sc1
v_mfma_f32_16x16x32_bf16 v[144:147], a[124:127], a[8:11], v[144:147]
s_waitcnt vmcnt(8) lgkmcnt(4)
v_mfma_f32_16x16x32_bf16 v[132:135], a[128:131], a[16:19], v[132:135]
s_cmp_eq_u32 s3, 7
s_cselect_b32 s35, 15, 7
s_lshl_b32 s35, s35, 12
v_mfma_f32_16x16x32_bf16 v[148:151], a[128:131], a[20:23], v[148:151]
ds_read_b128 a[112:115], v5 offset:16384
v_mfma_f32_16x16x32_bf16 v[152:155], a[132:135], a[20:23], v[152:155]
buffer_load_dwordx4 a[8:11], v4, s[40:43], s35 offen offset:0 sc1
v_mfma_f32_16x16x32_bf16 v[136:139], a[132:135], a[16:19], v[136:139]
ds_read_b128 a[116:119], v5 offset:17408
v_mfma_f32_16x16x32_bf16 v[140:143], a[136:139], a[16:19], v[140:143]
ds_read_b128 a[120:123], v5 offset:18432
v_mfma_f32_16x16x32_bf16 v[156:159], a[136:139], a[20:23], v[156:159]
ds_read_b128 a[124:127], v5 offset:19456
v_mfma_f32_16x16x32_bf16 v[160:163], a[140:143], a[20:23], v[160:163]
buffer_load_dwordx4 a[12:15], v4, s[40:43], s35 offen offset:1024 sc1
v_mfma_f32_16x16x32_bf16 v[144:147], a[140:143], a[16:19], v[144:147]
s_waitcnt vmcnt(8) lgkmcnt(4)
v_mfma_f32_16x16x32_bf16 v[132:135], a[96:99], a[24:27], v[132:135]
s_cmp_eq_u32 s3, 0
s_cselect_b32 s35, 16, 8
s_lshl_b32 s35, s35, 12
v_mfma_f32_16x16x32_bf16 v[148:151], a[96:99], a[28:31], v[148:151]
ds_read_b128 a[128:131], v5 offset:20480
v_mfma_f32_16x16x32_bf16 v[152:155], a[100:103], a[28:31], v[152:155]
buffer_load_dwordx4 a[16:19], v4, s[40:43], s35 offen offset:0 sc1
v_mfma_f32_16x16x32_bf16 v[136:139], a[100:103], a[24:27], v[136:139]
ds_read_b128 a[132:135], v5 offset:21504
v_mfma_f32_16x16x32_bf16 v[140:143], a[104:107], a[24:27], v[140:143]
ds_read_b128 a[136:139], v5 offset:22528
v_mfma_f32_16x16x32_bf16 v[156:159], a[104:107], a[28:31], v[156:159]
ds_read_b128 a[140:143], v5 offset:23552
v_mfma_f32_16x16x32_bf16 v[160:163], a[108:111], a[28:31], v[160:163]
buffer_load_dwordx4 a[20:23], v4, s[40:43], s35 offen offset:1024 sc1
v_mfma_f32_16x16x32_bf16 v[144:147], a[108:111], a[24:27], v[144:147]
s_waitcnt vmcnt(8) lgkmcnt(4)
v_mfma_f32_16x16x32_bf16 v[132:135], a[112:115], a[32:35], v[132:135]
s_cmp_eq_u32 s3, 1
s_cselect_b32 s35, 17, 9
s_lshl_b32 s35, s35, 12
v_mfma_f32_16x16x32_bf16 v[148:151], a[112:115], a[36:39], v[148:151]
ds_read_b128 a[96:99], v5 offset:24576
v_mfma_f32_16x16x32_bf16 v[152:155], a[116:119], a[36:39], v[152:155]
buffer_load_dwordx4 a[24:27], v4, s[40:43], s35 offen offset:0 sc1
v_mfma_f32_16x16x32_bf16 v[136:139], a[116:119], a[32:35], v[136:139]
ds_read_b128 a[100:103], v5 offset:25600
v_mfma_f32_16x16x32_bf16 v[140:143], a[120:123], a[32:35], v[140:143]
ds_read_b128 a[104:107], v5 offset:26624
v_mfma_f32_16x16x32_bf16 v[156:159], a[120:123], a[36:39], v[156:159]
ds_read_b128 a[108:111], v5 offset:27648
v_mfma_f32_16x16x32_bf16 v[160:163], a[124:127], a[36:39], v[160:163]
buffer_load_dwordx4 a[28:31], v4, s[40:43], s35 offen offset:1024 sc1
v_mfma_f32_16x16x32_bf16 v[144:147], a[124:127], a[32:35], v[144:147]
s_waitcnt vmcnt(8) lgkmcnt(4)
v_mfma_f32_16x16x32_bf16 v[132:135], a[128:131], a[40:43], v[132:135]
s_cmp_eq_u32 s3, 2
s_cselect_b32 s35, 18, 10
s_lshl_b32 s35, s35, 12
v_mfma_f32_16x16x32_bf16 v[148:151], a[128:131], a[44:47], v[148:151]
ds_read_b128 a[112:115], v5 offset:28672
v_mfma_f32_16x16x32_bf16 v[152:155], a[132:135], a[44:47], v[152:155]
buffer_load_dwordx4 a[32:35], v4, s[40:43], s35 offen offset:0 sc1
v_mfma_f32_16x16x32_bf16 v[136:139], a[132:135], a[40:43], v[136:139]
ds_read_b128 a[116:119], v5 offset:29696
v_mfma_f32_16x16x32_bf16 v[140:143], a[136:139], a[40:43], v[140:143]
ds_read_b128 a[120:123], v5 offset:30720
v_mfma_f32_16x16x32_bf16 v[156:159], a[136:139], a[44:47], v[156:159]
ds_read_b128 a[124:127], v5 offset:31744
v_mfma_f32_16x16x32_bf16 v[160:163], a[140:143], a[44:47], v[160:163]
buffer_load_dwordx4 a[36:39], v4, s[40:43], s35 offen offset:1024 sc1
v_mfma_f32_16x16x32_bf16 v[144:147], a[140:143], a[40:43], v[144:147]
s_waitcnt vmcnt(8) lgkmcnt(4)
v_mfma_f32_16x16x32_bf16 v[132:135], a[96:99], a[0:3], v[132:135]
s_cmp_eq_u32 s3, 3
s_cselect_b32 s35, 19, 11
s_lshl_b32 s35, s35, 12
v_mfma_f32_16x16x32_bf16 v[148:151], a[96:99], a[4:7], v[148:151]
ds_read_b128 a[128:131], v5 offset:32768
v_mfma_f32_16x16x32_bf16 v[152:155], a[100:103], a[4:7], v[152:155]
buffer_load_dwordx4 a[40:43], v4, s[40:43], s35 offen offset:0 sc1
v_mfma_f32_16x16x32_bf16 v[136:139], a[100:103], a[0:3], v[136:139]
ds_read_b128 a[132:135], v5 offset:33792
v_mfma_f32_16x16x32_bf16 v[140:143], a[104:107], a[0:3], v[140:143]
ds_read_b128 a[136:139], v5 offset:34816
v_mfma_f32_16x16x32_bf16 v[156:159], a[104:107], a[4:7], v[156:159]
ds_read_b128 a[140:143], v5 offset:35840
v_mfma_f32_16x16x32_bf16 v[160:163], a[108:111], a[4:7], v[160:163]
buffer_load_dwordx4 a[44:47], v4, s[40:43], s35 offen offset:1024 sc1
v_mfma_f32_16x16x32_bf16 v[144:147], a[108:111], a[0:3], v[144:147]
s_waitcnt vmcnt(8) lgkmcnt(4)
v_mfma_f32_16x16x32_bf16 v[132:135], a[112:115], a[8:11], v[132:135]
s_cmp_eq_u32 s3, 4
s_cselect_b32 s35, 20, 12
s_lshl_b32 s35, s35, 12
v_mfma_f32_16x16x32_bf16 v[148:151], a[112:115], a[12:15], v[148:151]
ds_read_b128 a[96:99], v5 offset:36864
v_mfma_f32_16x16x32_bf16 v[152:155], a[116:119], a[12:15], v[152:155]
buffer_load_dwordx4 a[0:3], v4, s[40:43], s35 offen offset:0 sc1
v_mfma_f32_16x16x32_bf16 v[136:139], a[116:119], a[8:11], v[136:139]
ds_read_b128 a[100:103], v5 offset:37888
v_mfma_f32_16x16x32_bf16 v[140:143], a[120:123], a[8:11], v[140:143]
ds_read_b128 a[104:107], v5 offset:38912
v_mfma_f32_16x16x32_bf16 v[156:159], a[120:123], a[12:15], v[156:159]
ds_read_b128 a[108:111], v5 offset:39936
v_mfma_f32_16x16x32_bf16 v[160:163], a[124:127], a[12:15], v[160:163]
buffer_load_dwordx4 a[4:7], v4, s[40:43], s35 offen offset:1024 sc1
v_mfma_f32_16x16x32_bf16 v[144:147], a[124:127], a[8:11], v[144:147]
s_waitcnt vmcnt(8) lgkmcnt(4)
v_mfma_f32_16x16x32_bf16 v[132:135], a[128:131], a[16:19], v[132:135]
s_cmp_eq_u32 s3, 5
s_cselect_b32 s35, 21, 13
s_lshl_b32 s35, s35, 12
v_mfma_f32_16x16x32_bf16 v[148:151], a[128:131], a[20:23], v[148:151]
ds_read_b128 a[112:115], v5 offset:40960
v_mfma_f32_16x16x32_bf16 v[152:155], a[132:135], a[20:23], v[152:155]
buffer_load_dwordx4 a[8:11], v4, s[40:43], s35 offen offset:0 sc1
v_mfma_f32_16x16x32_bf16 v[136:139], a[132:135], a[16:19], v[136:139]
ds_read_b128 a[116:119], v5 offset:41984
v_mfma_f32_16x16x32_bf16 v[140:143], a[136:139], a[16:19], v[140:143]
ds_read_b128 a[120:123], v5 offset:43008
v_mfma_f32_16x16x32_bf16 v[156:159], a[136:139], a[20:23], v[156:159]
ds_read_b128 a[124:127], v5 offset:44032
v_mfma_f32_16x16x32_bf16 v[160:163], a[140:143], a[20:23], v[160:163]
buffer_load_dwordx4 a[12:15], v4, s[40:43], s35 offen offset:1024 sc1
v_mfma_f32_16x16x32_bf16 v[144:147], a[140:143], a[16:19], v[144:147]
s_waitcnt vmcnt(8) lgkmcnt(4)
v_mfma_f32_16x16x32_bf16 v[132:135], a[96:99], a[24:27], v[132:135]
s_cmp_eq_u32 s3, 6
s_cselect_b32 s35, 22, 14
s_lshl_b32 s35, s35, 12
v_mfma_f32_16x16x32_bf16 v[148:151], a[96:99], a[28:31], v[148:151]
ds_read_b128 a[128:131], v5 offset:45056
v_mfma_f32_16x16x32_bf16 v[152:155], a[100:103], a[28:31], v[152:155]
buffer_load_dwordx4 a[16:19], v4, s[40:43], s35 offen offset:0 sc1
v_mfma_f32_16x16x32_bf16 v[136:139], a[100:103], a[24:27], v[136:139]
ds_read_b128 a[132:135], v5 offset:46080
v_mfma_f32_16x16x32_bf16 v[140:143], a[104:107], a[24:27], v[140:143]
ds_read_b128 a[136:139], v5 offset:47104
v_mfma_f32_16x16x32_bf16 v[156:159], a[104:107], a[28:31], v[156:159]
ds_read_b128 a[140:143], v5 offset:48128
v_mfma_f32_16x16x32_bf16 v[160:163], a[108:111], a[28:31], v[160:163]
buffer_load_dwordx4 a[20:23], v4, s[40:43], s35 offen offset:1024 sc1
v_mfma_f32_16x16x32_bf16 v[144:147], a[108:111], a[24:27], v[144:147]
s_waitcnt vmcnt(8) lgkmcnt(4)
v_mfma_f32_16x16x32_bf16 v[132:135], a[112:115], a[32:35], v[132:135]
s_cmp_eq_u32 s3, 7
s_cselect_b32 s35, 23, 15
s_lshl_b32 s35, s35, 12
v_mfma_f32_16x16x32_bf16 v[148:151], a[112:115], a[36:39], v[148:151]
ds_read_b128 a[96:99], v5 offset:49152
v_mfma_f32_16x16x32_bf16 v[152:155], a[116:119], a[36:39], v[152:155]
buffer_load_dwordx4 a[24:27], v4, s[40:43], s35 offen offset:0 sc1
v_mfma_f32_16x16x32_bf16 v[136:139], a[116:119], a[32:35], v[136:139]
ds_read_b128 a[100:103], v5 offset:50176
v_mfma_f32_16x16x32_bf16 v[140:143], a[120:123], a[32:35], v[140:143]
ds_read_b128 a[104:107], v5 offset:51200
v_mfma_f32_16x16x32_bf16 v[156:159], a[120:123], a[36:39], v[156:159]
ds_read_b128 a[108:111], v5 offset:52224
v_mfma_f32_16x16x32_bf16 v[160:163], a[124:127], a[36:39], v[160:163]
buffer_load_dwordx4 a[28:31], v4, s[40:43], s35 offen offset:1024 sc1
v_mfma_f32_16x16x32_bf16 v[144:147], a[124:127], a[32:35], v[144:147]
s_waitcnt vmcnt(8) lgkmcnt(4)
v_mfma_f32_16x16x32_bf16 v[132:135], a[128:131], a[40:43], v[132:135]
s_cmp_eq_u32 s3, 0
s_cselect_b32 s35, 24, 16
s_lshl_b32 s35, s35, 12
v_mfma_f32_16x16x32_bf16 v[148:151], a[128:131], a[44:47], v[148:151]
ds_read_b128 a[112:115], v5 offset:53248
v_mfma_f32_16x16x32_bf16 v[152:155], a[132:135], a[44:47], v[152:155]
buffer_load_dwordx4 a[32:35], v4, s[40:43], s35 offen offset:0 sc1
v_mfma_f32_16x16x32_bf16 v[136:139], a[132:135], a[40:43], v[136:139]
ds_read_b128 a[116:119], v5 offset:54272
v_mfma_f32_16x16x32_bf16 v[140:143], a[136:139], a[40:43], v[140:143]
ds_read_b128 a[120:123], v5 offset:55296
v_mfma_f32_16x16x32_bf16 v[156:159], a[136:139], a[44:47], v[156:159]
ds_read_b128 a[124:127], v5 offset:56320
v_mfma_f32_16x16x32_bf16 v[160:163], a[140:143], a[44:47], v[160:163]
buffer_load_dwordx4 a[36:39], v4, s[40:43], s35 offen offset:1024 sc1
v_mfma_f32_16x16x32_bf16 v[144:147], a[140:143], a[40:43], v[144:147]
s_waitcnt vmcnt(8) lgkmcnt(4)
v_mfma_f32_16x16x32_bf16 v[132:135], a[96:99], a[0:3], v[132:135]
s_cmp_eq_u32 s3, 1
s_cselect_b32 s35, 25, 17
s_lshl_b32 s35, s35, 12
v_mfma_f32_16x16x32_bf16 v[148:151], a[96:99], a[4:7], v[148:151]
ds_read_b128 a[128:131], v5 offset:57344
v_mfma_f32_16x16x32_bf16 v[152:155], a[100:103], a[4:7], v[152:155]
buffer_load_dwordx4 a[40:43], v4, s[40:43], s35 offen offset:0 sc1
v_mfma_f32_16x16x32_bf16 v[136:139], a[100:103], a[0:3], v[136:139]
ds_read_b128 a[132:135], v5 offset:58368
v_mfma_f32_16x16x32_bf16 v[140:143], a[104:107], a[0:3], v[140:143]
ds_read_b128 a[136:139], v5 offset:59392
v_mfma_f32_16x16x32_bf16 v[156:159], a[104:107], a[4:7], v[156:159]
ds_read_b128 a[140:143], v5 offset:60416
v_mfma_f32_16x16x32_bf16 v[160:163], a[108:111], a[4:7], v[160:163]
buffer_load_dwordx4 a[44:47], v4, s[40:43], s35 offen offset:1024 sc1
v_mfma_f32_16x16x32_bf16 v[144:147], a[108:111], a[0:3], v[144:147]
s_waitcnt vmcnt(8) lgkmcnt(4)
v_mfma_f32_16x16x32_bf16 v[132:135], a[112:115], a[8:11], v[132:135]
s_cmp_eq_u32 s3, 2
s_cselect_b32 s35, 26, 18
s_lshl_b32 s35, s35, 12
v_mfma_f32_16x16x32_bf16 v[148:151], a[112:115], a[12:15], v[148:151]
ds_read_b128 a[96:99], v5 offset:61440
v_mfma_f32_16x16x32_bf16 v[152:155], a[116:119], a[12:15], v[152:155]
buffer_load_dwordx4 a[0:3], v4, s[40:43], s35 offen offset:0 sc1
v_mfma_f32_16x16x32_bf16 v[136:139], a[116:119], a[8:11], v[136:139]
ds_read_b128 a[100:103], v5 offset:62464
v_mfma_f32_16x16x32_bf16 v[140:143], a[120:123], a[8:11], v[140:143]
ds_read_b128 a[104:107], v5 offset:63488
v_mfma_f32_16x16x32_bf16 v[156:159], a[120:123], a[12:15], v[156:159]
ds_read_b128 a[108:111], v5 offset:64512
v_mfma_f32_16x16x32_bf16 v[160:163], a[124:127], a[12:15], v[160:163]
buffer_load_dwordx4 a[4:7], v4, s[40:43], s35 offen offset:1024 sc1
v_mfma_f32_16x16x32_bf16 v[144:147], a[124:127], a[8:11], v[144:147]
s_waitcnt vmcnt(8) lgkmcnt(4)
v_mfma_f32_16x16x32_bf16 v[132:135], a[128:131], a[16:19], v[132:135]
s_cmp_eq_u32 s3, 3
s_cselect_b32 s35, 27, 19
s_lshl_b32 s35, s35, 12
v_mfma_f32_16x16x32_bf16 v[148:151], a[128:131], a[20:23], v[148:151]
ds_read_b128 a[112:115], v6 offset:0
v_mfma_f32_16x16x32_bf16 v[152:155], a[132:135], a[20:23], v[152:155]
buffer_load_dwordx4 a[8:11], v4, s[40:43], s35 offen offset:0 sc1
v_mfma_f32_16x16x32_bf16 v[136:139], a[132:135], a[16:19], v[136:139]
ds_read_b128 a[116:119], v6 offset:1024
v_mfma_f32_16x16x32_bf16 v[140:143], a[136:139], a[16:19], v[140:143]
ds_read_b128 a[120:123], v6 offset:2048
v_mfma_f32_16x16x32_bf16 v[156:159], a[136:139], a[20:23], v[156:159]
ds_read_b128 a[124:127], v6 offset:3072
v_mfma_f32_16x16x32_bf16 v[160:163], a[140:143], a[20:23], v[160:163]
buffer_load_dwordx4 a[12:15], v4, s[40:43], s35 offen offset:1024 sc1
v_mfma_f32_16x16x32_bf16 v[144:147], a[140:143], a[16:19], v[144:147]
s_waitcnt vmcnt(8) lgkmcnt(4)
v_mfma_f32_16x16x32_bf16 v[132:135], a[96:99], a[24:27], v[132:135]
s_cmp_eq_u32 s3, 4
s_cselect_b32 s35, 28, 20
s_lshl_b32 s35, s35, 12
v_mfma_f32_16x16x32_bf16 v[148:151], a[96:99], a[28:31], v[148:151]
ds_read_b128 a[128:131], v6 offset:4096
v_mfma_f32_16x16x32_bf16 v[152:155], a[100:103], a[28:31], v[152:155]
buffer_load_dwordx4 a[16:19], v4, s[40:43], s35 offen offset:0 sc1
v_mfma_f32_16x16x32_bf16 v[136:139], a[100:103], a[24:27], v[136:139]
ds_read_b128 a[132:135], v6 offset:5120
v_mfma_f32_16x16x32_bf16 v[140:143], a[104:107], a[24:27], v[140:143]
ds_read_b128 a[136:139], v6 offset:6144
v_mfma_f32_16x16x32_bf16 v[156:159], a[104:107], a[28:31], v[156:159]
ds_read_b128 a[140:143], v6 offset:7168
v_mfma_f32_16x16x32_bf16 v[160:163], a[108:111], a[28:31], v[160:163]
buffer_load_dwordx4 a[20:23], v4, s[40:43], s35 offen offset:1024 sc1
v_mfma_f32_16x16x32_bf16 v[144:147], a[108:111], a[24:27], v[144:147]
s_waitcnt vmcnt(8) lgkmcnt(4)
v_mfma_f32_16x16x32_bf16 v[132:135], a[112:115], a[32:35], v[132:135]
s_cmp_eq_u32 s3, 5
s_cselect_b32 s35, 29, 21
s_lshl_b32 s35, s35, 12
v_mfma_f32_16x16x32_bf16 v[148:151], a[112:115], a[36:39], v[148:151]
ds_read_b128 a[96:99], v6 offset:8192
v_mfma_f32_16x16x32_bf16 v[152:155], a[116:119], a[36:39], v[152:155]
buffer_load_dwordx4 a[24:27], v4, s[40:43], s35 offen offset:0 sc1
v_mfma_f32_16x16x32_bf16 v[136:139], a[116:119], a[32:35], v[136:139]
ds_read_b128 a[100:103], v6 offset:9216
v_mfma_f32_16x16x32_bf16 v[140:143], a[120:123], a[32:35], v[140:143]
ds_read_b128 a[104:107], v6 offset:10240
v_mfma_f32_16x16x32_bf16 v[156:159], a[120:123], a[36:39], v[156:159]
ds_read_b128 a[108:111], v6 offset:11264
v_mfma_f32_16x16x32_bf16 v[160:163], a[124:127], a[36:39], v[160:163]
buffer_load_dwordx4 a[28:31], v4, s[40:43], s35 offen offset:1024 sc1
v_mfma_f32_16x16x32_bf16 v[144:147], a[124:127], a[32:35], v[144:147]
s_waitcnt vmcnt(8) lgkmcnt(4)
v_mfma_f32_16x16x32_bf16 v[132:135], a[128:131], a[40:43], v[132:135]
s_cmp_eq_u32 s3, 6
s_cselect_b32 s35, 30, 22
s_lshl_b32 s35, s35, 12
v_mfma_f32_16x16x32_bf16 v[148:151], a[128:131], a[44:47], v[148:151]
ds_read_b128 a[112:115], v6 offset:12288
v_mfma_f32_16x16x32_bf16 v[152:155], a[132:135], a[44:47], v[152:155]
buffer_load_dwordx4 a[32:35], v4, s[40:43], s35 offen offset:0 sc1
v_mfma_f32_16x16x32_bf16 v[136:139], a[132:135], a[40:43], v[136:139]
ds_read_b128 a[116:119], v6 offset:13312
v_mfma_f32_16x16x32_bf16 v[140:143], a[136:139], a[40:43], v[140:143]
ds_read_b128 a[120:123], v6 offset:14336
v_mfma_f32_16x16x32_bf16 v[156:159], a[136:139], a[44:47], v[156:159]
ds_read_b128 a[124:127], v6 offset:15360
v_mfma_f32_16x16x32_bf16 v[160:163], a[140:143], a[44:47], v[160:163]
buffer_load_dwordx4 a[36:39], v4, s[40:43], s35 offen offset:1024 sc1
v_mfma_f32_16x16x32_bf16 v[144:147], a[140:143], a[40:43], v[144:147]
s_waitcnt vmcnt(8) lgkmcnt(4)
v_mfma_f32_16x16x32_bf16 v[132:135], a[96:99], a[0:3], v[132:135]
s_cmp_eq_u32 s3, 7
s_cselect_b32 s35, 31, 23
s_lshl_b32 s35, s35, 12
v_mfma_f32_16x16x32_bf16 v[148:151], a[96:99], a[4:7], v[148:151]
ds_read_b128 a[128:131], v6 offset:16384
v_mfma_f32_16x16x32_bf16 v[152:155], a[100:103], a[4:7], v[152:155]
buffer_load_dwordx4 a[40:43], v4, s[40:43], s35 offen offset:0 sc1
v_mfma_f32_16x16x32_bf16 v[136:139], a[100:103], a[0:3], v[136:139]
ds_read_b128 a[132:135], v6 offset:17408
v_mfma_f32_16x16x32_bf16 v[140:143], a[104:107], a[0:3], v[140:143]
ds_read_b128 a[136:139], v6 offset:18432
v_mfma_f32_16x16x32_bf16 v[156:159], a[104:107], a[4:7], v[156:159]
ds_read_b128 a[140:143], v6 offset:19456
v_mfma_f32_16x16x32_bf16 v[160:163], a[108:111], a[4:7], v[160:163]
buffer_load_dwordx4 a[44:47], v4, s[40:43], s35 offen offset:1024 sc1
v_mfma_f32_16x16x32_bf16 v[144:147], a[108:111], a[0:3], v[144:147]
s_waitcnt vmcnt(8) lgkmcnt(4)
v_mfma_f32_16x16x32_bf16 v[132:135], a[112:115], a[8:11], v[132:135]
s_cmp_eq_u32 s3, 0
s_cselect_b32 s35, 0, 24
s_lshl_b32 s35, s35, 12
v_mfma_f32_16x16x32_bf16 v[148:151], a[112:115], a[12:15], v[148:151]
ds_read_b128 a[96:99], v6 offset:20480
v_mfma_f32_16x16x32_bf16 v[152:155], a[116:119], a[12:15], v[152:155]
buffer_load_dwordx4 a[0:3], v4, s[40:43], s35 offen offset:0 sc1
v_mfma_f32_16x16x32_bf16 v[136:139], a[116:119], a[8:11], v[136:139]
ds_read_b128 a[100:103], v6 offset:21504
v_mfma_f32_16x16x32_bf16 v[140:143], a[120:123], a[8:11], v[140:143]
ds_read_b128 a[104:107], v6 offset:22528
v_mfma_f32_16x16x32_bf16 v[156:159], a[120:123], a[12:15], v[156:159]
ds_read_b128 a[108:111], v6 offset:23552
v_mfma_f32_16x16x32_bf16 v[160:163], a[124:127], a[12:15], v[160:163]
buffer_load_dwordx4 a[4:7], v4, s[40:43], s35 offen offset:1024 sc1
v_mfma_f32_16x16x32_bf16 v[144:147], a[124:127], a[8:11], v[144:147]
s_waitcnt vmcnt(8) lgkmcnt(4)
v_mfma_f32_16x16x32_bf16 v[132:135], a[128:131], a[16:19], v[132:135]
s_cmp_eq_u32 s3, 1
s_cselect_b32 s35, 1, 25
s_lshl_b32 s35, s35, 12
v_mfma_f32_16x16x32_bf16 v[148:151], a[128:131], a[20:23], v[148:151]
ds_read_b128 a[112:115], v6 offset:24576
s_add_u32 s88, s67, 0xe0000
v_mfma_f32_16x16x32_bf16 v[152:155], a[132:135], a[20:23], v[152:155]
buffer_load_dwordx4 a[8:11], v4, s[40:43], s35 offen offset:0 sc1
s_add_u32 s89, s66, 0xd0000
v_mfma_f32_16x16x32_bf16 v[136:139], a[132:135], a[16:19], v[136:139]
ds_read_b128 a[116:119], v6 offset:25600
v_mfma_f32_16x16x32_bf16 v[140:143], a[136:139], a[16:19], v[140:143]
ds_read_b128 a[120:123], v6 offset:26624
v_mfma_f32_16x16x32_bf16 v[156:159], a[136:139], a[20:23], v[156:159]
ds_read_b128 a[124:127], v6 offset:27648
v_mfma_f32_16x16x32_bf16 v[160:163], a[140:143], a[20:23], v[160:163]
buffer_load_dwordx4 a[12:15], v4, s[40:43], s35 offen offset:1024 sc1
v_mfma_f32_16x16x32_bf16 v[144:147], a[140:143], a[16:19], v[144:147]
buffer_load_dword v11, v255, s[4:7], s88 offen sc1
s_waitcnt vmcnt(9) lgkmcnt(4)
v_mfma_f32_16x16x32_bf16 v[132:135], a[96:99], a[24:27], v[132:135]
s_cmp_eq_u32 s3, 2
s_cselect_b32 s35, 2, 26
s_lshl_b32 s35, s35, 12
v_mfma_f32_16x16x32_bf16 v[148:151], a[96:99], a[28:31], v[148:151]
ds_read_b128 a[128:131], v6 offset:28672
v_mfma_f32_16x16x32_bf16 v[152:155], a[100:103], a[28:31], v[152:155]
buffer_load_dwordx4 a[16:19], v4, s[40:43], s35 offen offset:0 sc1
v_mfma_f32_16x16x32_bf16 v[136:139], a[100:103], a[24:27], v[136:139]
ds_read_b128 a[132:135], v6 offset:29696
v_mfma_f32_16x16x32_bf16 v[140:143], a[104:107], a[24:27], v[140:143]
ds_read_b128 a[136:139], v6 offset:30720
v_mfma_f32_16x16x32_bf16 v[156:159], a[104:107], a[28:31], v[156:159]
ds_read_b128 a[140:143], v6 offset:31744
v_mfma_f32_16x16x32_bf16 v[160:163], a[108:111], a[28:31], v[160:163]
buffer_load_dwordx4 a[20:23], v4, s[40:43], s35 offen offset:1024 sc1
v_mfma_f32_16x16x32_bf16 v[144:147], a[108:111], a[24:27], v[144:147]
buffer_load_dword v232, v255, s[4:7], s89 offen offset:64 sc1
s_waitcnt vmcnt(10) lgkmcnt(4)
v_mfma_f32_16x16x32_bf16 v[132:135], a[112:115], a[32:35], v[132:135]
s_cmp_eq_u32 s3, 3
s_cselect_b32 s35, 3, 27
s_lshl_b32 s35, s35, 12
v_mfma_f32_16x16x32_bf16 v[148:151], a[112:115], a[36:39], v[148:151]
ds_read_b128 a[96:99], v6 offset:32768
v_mfma_f32_16x16x32_bf16 v[152:155], a[116:119], a[36:39], v[152:155]
buffer_load_dwordx4 a[24:27], v4, s[40:43], s35 offen offset:0 sc1
v_mfma_f32_16x16x32_bf16 v[136:139], a[116:119], a[32:35], v[136:139]
ds_read_b128 a[100:103], v6 offset:33792
v_mfma_f32_16x16x32_bf16 v[140:143], a[120:123], a[32:35], v[140:143]
ds_read_b128 a[104:107], v6 offset:34816
v_mfma_f32_16x16x32_bf16 v[156:159], a[120:123], a[36:39], v[156:159]
ds_read_b128 a[108:111], v6 offset:35840
v_mfma_f32_16x16x32_bf16 v[160:163], a[124:127], a[36:39], v[160:163]
buffer_load_dwordx4 a[28:31], v4, s[40:43], s35 offen offset:1024 sc1
v_mfma_f32_16x16x32_bf16 v[144:147], a[124:127], a[32:35], v[144:147]
s_waitcnt vmcnt(10) lgkmcnt(4)
v_mfma_f32_16x16x32_bf16 v[132:135], a[128:131], a[40:43], v[132:135]
s_cmp_eq_u32 s3, 4
s_cselect_b32 s35, 4, 28
s_lshl_b32 s35, s35, 12
v_mfma_f32_16x16x32_bf16 v[148:151], a[128:131], a[44:47], v[148:151]
ds_read_b128 a[112:115], v6 offset:36864
v_mfma_f32_16x16x32_bf16 v[152:155], a[132:135], a[44:47], v[152:155]
buffer_load_dwordx4 a[32:35], v4, s[40:43], s35 offen offset:0 sc1
v_mfma_f32_16x16x32_bf16 v[136:139], a[132:135], a[40:43], v[136:139]
ds_read_b128 a[116:119], v6 offset:37888
v_mfma_f32_16x16x32_bf16 v[140:143], a[136:139], a[40:43], v[140:143]
ds_read_b128 a[120:123], v6 offset:38912
v_mfma_f32_16x16x32_bf16 v[156:159], a[136:139], a[44:47], v[156:159]
ds_read_b128 a[124:127], v6 offset:39936
v_mfma_f32_16x16x32_bf16 v[160:163], a[140:143], a[44:47], v[160:163]
buffer_load_dwordx4 a[36:39], v4, s[40:43], s35 offen offset:1024 sc1
v_mfma_f32_16x16x32_bf16 v[144:147], a[140:143], a[40:43], v[144:147]
s_waitcnt vmcnt(10) lgkmcnt(4)
v_mfma_f32_16x16x32_bf16 v[132:135], a[96:99], a[0:3], v[132:135]
s_cmp_eq_u32 s3, 5
s_cselect_b32 s35, 5, 29
s_lshl_b32 s35, s35, 12
v_mfma_f32_16x16x32_bf16 v[148:151], a[96:99], a[4:7], v[148:151]
ds_read_b128 a[128:131], v6 offset:40960
v_mfma_f32_16x16x32_bf16 v[152:155], a[100:103], a[4:7], v[152:155]
buffer_load_dwordx4 a[40:43], v4, s[40:43], s35 offen offset:0 sc1
v_mfma_f32_16x16x32_bf16 v[136:139], a[100:103], a[0:3], v[136:139]
ds_read_b128 a[132:135], v6 offset:41984
v_mfma_f32_16x16x32_bf16 v[140:143], a[104:107], a[0:3], v[140:143]
ds_read_b128 a[136:139], v6 offset:43008
v_mfma_f32_16x16x32_bf16 v[156:159], a[104:107], a[4:7], v[156:159]
ds_read_b128 a[140:143], v6 offset:44032
v_mfma_f32_16x16x32_bf16 v[160:163], a[108:111], a[4:7], v[160:163]
buffer_load_dwordx4 a[44:47], v4, s[40:43], s35 offen offset:1024 sc1
v_mfma_f32_16x16x32_bf16 v[144:147], a[108:111], a[0:3], v[144:147]
s_waitcnt vmcnt(10) lgkmcnt(4)
v_mfma_f32_16x16x32_bf16 v[132:135], a[112:115], a[8:11], v[132:135]
s_cmp_eq_u32 s3, 6
s_cselect_b32 s35, 6, 30
s_lshl_b32 s35, s35, 12
v_mfma_f32_16x16x32_bf16 v[148:151], a[112:115], a[12:15], v[148:151]
ds_read_b128 a[96:99], v6 offset:45056
v_mfma_f32_16x16x32_bf16 v[152:155], a[116:119], a[12:15], v[152:155]
buffer_load_dwordx4 a[0:3], v4, s[40:43], s35 offen offset:0 sc1
v_mfma_f32_16x16x32_bf16 v[136:139], a[116:119], a[8:11], v[136:139]
ds_read_b128 a[100:103], v6 offset:46080
v_mfma_f32_16x16x32_bf16 v[140:143], a[120:123], a[8:11], v[140:143]
ds_read_b128 a[104:107], v6 offset:47104
v_mfma_f32_16x16x32_bf16 v[156:159], a[120:123], a[12:15], v[156:159]
ds_read_b128 a[108:111], v6 offset:48128
v_mfma_f32_16x16x32_bf16 v[160:163], a[124:127], a[12:15], v[160:163]
buffer_load_dwordx4 a[4:7], v4, s[40:43], s35 offen offset:1024 sc1
v_mfma_f32_16x16x32_bf16 v[144:147], a[124:127], a[8:11], v[144:147]
s_waitcnt vmcnt(9) lgkmcnt(4)
v_mfma_f32_16x16x32_bf16 v[132:135], a[128:131], a[16:19], v[132:135]
s_cmp_eq_u32 s3, 7
s_cselect_b32 s35, 7, 31
s_lshl_b32 s35, s35, 12
v_mfma_f32_16x16x32_bf16 v[148:151], a[128:131], a[20:23], v[148:151]
ds_read_b128 a[112:115], v6 offset:49152
v_mfma_f32_16x16x32_bf16 v[152:155], a[132:135], a[20:23], v[152:155]
buffer_load_dwordx4 a[8:11], v4, s[40:43], s35 offen offset:0 sc1
v_mfma_f32_16x16x32_bf16 v[136:139], a[132:135], a[16:19], v[136:139]
ds_read_b128 a[116:119], v6 offset:50176
v_mfma_f32_16x16x32_bf16 v[140:143], a[136:139], a[16:19], v[140:143]
ds_read_b128 a[120:123], v6 offset:51200
v_mfma_f32_16x16x32_bf16 v[156:159], a[136:139], a[20:23], v[156:159]
ds_read_b128 a[124:127], v6 offset:52224
v_mfma_f32_16x16x32_bf16 v[160:163], a[140:143], a[20:23], v[160:163]
buffer_load_dwordx4 a[12:15], v4, s[40:43], s35 offen offset:1024 sc1
v_mfma_f32_16x16x32_bf16 v[144:147], a[140:143], a[16:19], v[144:147]
s_waitcnt vmcnt(8) lgkmcnt(4)
v_mfma_f32_16x16x32_bf16 v[132:135], a[96:99], a[24:27], v[132:135]
ds_read_b128 a[128:131], v6 offset:53248
v_mfma_f32_16x16x32_bf16 v[148:151], a[96:99], a[28:31], v[148:151]
ds_read_b128 a[132:135], v6 offset:54272
v_mfma_f32_16x16x32_bf16 v[152:155], a[100:103], a[28:31], v[152:155]
ds_read_b128 a[136:139], v6 offset:55296
v_mfma_f32_16x16x32_bf16 v[136:139], a[100:103], a[24:27], v[136:139]
ds_read_b128 a[140:143], v6 offset:56320
v_mfma_f32_16x16x32_bf16 v[140:143], a[104:107], a[24:27], v[140:143]
v_mfma_f32_16x16x32_bf16 v[156:159], a[104:107], a[28:31], v[156:159]
v_mfma_f32_16x16x32_bf16 v[160:163], a[108:111], a[28:31], v[160:163]
v_mfma_f32_16x16x32_bf16 v[144:147], a[108:111], a[24:27], v[144:147]
s_waitcnt vmcnt(6) lgkmcnt(4)
v_mfma_f32_16x16x32_bf16 v[132:135], a[112:115], a[32:35], v[132:135]
ds_read_b128 a[96:99], v6 offset:57344
v_mfma_f32_16x16x32_bf16 v[148:151], a[112:115], a[36:39], v[148:151]
ds_read_b128 a[100:103], v6 offset:58368
v_mfma_f32_16x16x32_bf16 v[152:155], a[116:119], a[36:39], v[152:155]
ds_read_b128 a[104:107], v6 offset:59392
v_mfma_f32_16x16x32_bf16 v[136:139], a[116:119], a[32:35], v[136:139]
ds_read_b128 a[108:111], v6 offset:60416
v_mfma_f32_16x16x32_bf16 v[140:143], a[120:123], a[32:35], v[140:143]
v_mfma_f32_16x16x32_bf16 v[156:159], a[120:123], a[36:39], v[156:159]
v_mfma_f32_16x16x32_bf16 v[160:163], a[124:127], a[36:39], v[160:163]
v_mfma_f32_16x16x32_bf16 v[144:147], a[124:127], a[32:35], v[144:147]
s_waitcnt vmcnt(4) lgkmcnt(4)
v_mfma_f32_16x16x32_bf16 v[132:135], a[128:131], a[40:43], v[132:135]
ds_read_b128 a[112:115], v6 offset:61440
v_mfma_f32_16x16x32_bf16 v[148:151], a[128:131], a[44:47], v[148:151]
ds_read_b128 a[116:119], v6 offset:62464
v_mfma_f32_16x16x32_bf16 v[152:155], a[132:135], a[44:47], v[152:155]
ds_read_b128 a[120:123], v6 offset:63488
v_mfma_f32_16x16x32_bf16 v[136:139], a[132:135], a[40:43], v[136:139]
ds_read_b128 a[124:127], v6 offset:64512
v_mfma_f32_16x16x32_bf16 v[140:143], a[136:139], a[40:43], v[140:143]
v_mfma_f32_16x16x32_bf16 v[156:159], a[136:139], a[44:47], v[156:159]
v_mfma_f32_16x16x32_bf16 v[160:163], a[140:143], a[44:47], v[160:163]
v_mfma_f32_16x16x32_bf16 v[144:147], a[140:143], a[40:43], v[144:147]
s_waitcnt vmcnt(2) lgkmcnt(4)
v_mfma_f32_16x16x32_bf16 v[132:135], a[96:99], a[0:3], v[132:135]
v_mfma_f32_16x16x32_bf16 v[148:151], a[96:99], a[4:7], v[148:151]
v_mfma_f32_16x16x32_bf16 v[152:155], a[100:103], a[4:7], v[152:155]
v_mfma_f32_16x16x32_bf16 v[136:139], a[100:103], a[0:3], v[136:139]
v_mfma_f32_16x16x32_bf16 v[140:143], a[104:107], a[0:3], v[140:143]
v_mfma_f32_16x16x32_bf16 v[156:159], a[104:107], a[4:7], v[156:159]
v_mfma_f32_16x16x32_bf16 v[160:163], a[108:111], a[4:7], v[160:163]
v_mfma_f32_16x16x32_bf16 v[144:147], a[108:111], a[0:3], v[144:147]
s_waitcnt vmcnt(0) lgkmcnt(0)
v_mfma_f32_16x16x32_bf16 v[132:135], a[112:115], a[8:11], v[132:135]
v_mfma_f32_16x16x32_bf16 v[148:151], a[112:115], a[12:15], v[148:151]
v_mfma_f32_16x16x32_bf16 v[152:155], a[116:119], a[12:15], v[152:155]
v_mfma_f32_16x16x32_bf16 v[136:139], a[116:119], a[8:11], v[136:139]
v_mfma_f32_16x16x32_bf16 v[140:143], a[120:123], a[8:11], v[140:143]
L_stub4:
s_cbranch_execz L_wret1
v_mfma_f32_16x16x32_bf16 v[156:159], a[120:123], a[12:15], v[156:159]
v_mfma_f32_16x16x32_bf16 v[160:163], a[124:127], a[12:15], v[160:163]
v_mfma_f32_16x16x32_bf16 v[144:147], a[124:127], a[8:11], v[144:147]
s_nop 0
v_cvt_pk_bf16_f32 v32, v132, v133
v_cvt_pk_bf16_f32 v33, v134, v135
s_nop 0
v_cvt_pk_bf16_f32 v34, v136, v137
v_cvt_pk_bf16_f32 v35, v138, v139
v_cvt_pk_bf16_f32 v36, v140, v141
v_cvt_pk_bf16_f32 v37, v142, v143
v_cvt_pk_bf16_f32 v38, v144, v145
v_cvt_pk_bf16_f32 v39, v146, v147
v_cvt_pk_bf16_f32 v40, v148, v149
v_cvt_pk_bf16_f32 v41, v150, v151
v_cvt_pk_bf16_f32 v42, v152, v153
v_cvt_pk_bf16_f32 v43, v154, v155
v_cvt_pk_bf16_f32 v44, v156, v157
v_cvt_pk_bf16_f32 v45, v158, v159
v_cvt_pk_bf16_f32 v46, v160, v161
v_cvt_pk_bf16_f32 v47, v162, v163
s_lshl_b32 s36, s32, 13
s_add_u32 s36, s36, 0x2200000
s_add_u32 s37, s36, 4096
s_mov_b32 s38, 0x240000
v_mfma_f32_16x16x32_bf16 v[96:99], v[32:35], v[32:35], 0
v_mfma_f32_16x16x32_bf16 v[92:95], v[16:19], v[32:35], 0
buffer_store_dwordx4 v[32:35], v4, s[4:7], s36 offen offset:0 sc1
v_mfma_f32_16x16x32_bf16 v[104:107], v[40:43], v[40:43], 0
v_mfma_f32_16x16x32_bf16 v[100:103], v[16:19], v[40:43], 0
buffer_store_dwordx4 v[40:43], v4, s[4:7], s36 offen offset:1024 sc1
v_mfma_f32_16x16x32_bf16 v[96:99], v[36:39], v[36:39], v[96:99]
v_mfma_f32_16x16x32_bf16 v[92:95], v[16:19], v[36:39], v[92:95]
buffer_store_dwordx4 v[36:39], v4, s[4:7], s37 offen offset:0 sc1
v_mfma_f32_16x16x32_bf16 v[104:107], v[44:47], v[44:47], v[104:107]
v_mfma_f32_16x16x32_bf16 v[100:103], v[16:19], v[44:47], v[100:103]
buffer_store_dwordx4 v[44:47], v4, s[4:7], s37 offen offset:1024 sc1
s_nop 2
v_cndmask_b32 v96, v96, v97, s[46:47]
v_cndmask_b32 v98, v98, v99, s[46:47]
v_cndmask_b32 v93, v96, v98, s[48:49]
buffer_store_dwordx2 v[92:93], v253, s[4:7], s38 offen offset:0 sc1
v_cndmask_b32 v104, v104, v105, s[46:47]
v_cndmask_b32 v106, v106, v107, s[46:47]
v_cndmask_b32 v101, v104, v106, s[48:49]
buffer_store_dwordx2 v[100:101], v253, s[4:7], s38 offen offset:2048 sc1
s_add_u32 s92, s78, 0x40000
s_add_u32 s93, s79, 0x40000
s_add_u32 s40, s4, 0x2200000
s_addc_u32 s41, s5, 0
v_cmp_ne_u32 vcc, v11, v15
s_cbranch_vccnz Ltr_7
Lte_9:
v_cmp_ne_u32 vcc, v232, v15
s_cbranch_vccnz Ltr_10
Lte_12:
s_barrier
s_add_u32 s44, s28, 0
s_mul_i32 s45, s44, 3072
s_add_u32 m0, s45, 0
s_lshr_b32 s44, s44, 1
s_add_u32 s44, s44, 0
s_mul_i32 s44, s44, 6144
s_add_u32 s44, s44, s50
s_add_u32 s44, s44, 0x600000
buffer_load_dwordx4 v1, s[4:7], s44 offen offset:0 sc1 lds
buffer_load_dwordx4 v1, s[4:7], s44 offen offset:1024 sc1 lds
buffer_load_dwordx4 v1, s[4:7], s44 offen offset:2048 sc1 lds
s_add_u32 s44, s28, 4
s_mul_i32 s45, s44, 3072
s_add_u32 m0, s45, 0
s_lshr_b32 s44, s44, 1
s_add_u32 s44, s44, 0
s_mul_i32 s44, s44, 6144
s_add_u32 s44, s44, s50
s_add_u32 s44, s44, 0x600000
buffer_load_dwordx4 v1, s[4:7], s44 offen offset:0 sc1 lds
buffer_load_dwordx4 v1, s[4:7], s44 offen offset:1024 sc1 lds
buffer_load_dwordx4 v1, s[4:7], s44 offen offset:2048 sc1 lds
s_add_u32 s44, s28, 8
s_mul_i32 s45, s44, 3072
s_add_u32 m0, s45, 0
s_lshr_b32 s44, s44, 1
s_add_u32 s44, s44, 0
s_mul_i32 s44, s44, 6144
s_add_u32 s44, s44, s50
s_add_u32 s44, s44, 0x600000
buffer_load_dwordx4 v1, s[4:7], s44 offen offset:0 sc1 lds
buffer_load_dwordx4 v1, s[4:7], s44 offen offset:1024 sc1 lds
buffer_load_dwordx4 v1, s[4:7], s44 offen offset:2048 sc1 lds
s_add_u32 s44, s28, 12
s_mul_i32 s45, s44, 3072
s_add_u32 m0, s45, 0
s_lshr_b32 s44, s44, 1
s_add_u32 s44, s44, 0
s_mul_i32 s44, s44, 6144
s_add_u32 s44, s44, s50
s_add_u32 s44, s44, 0x600000
buffer_load_dwordx4 v1, s[4:7], s44 offen offset:0 sc1 lds
buffer_load_dwordx4 v1, s[4:7], s44 offen offset:1024 sc1 lds
buffer_load_dwordx4 v1, s[4:7], s44 offen offset:2048 sc1 lds
s_waitcnt vmcnt(12)
s_barrier
s_cmp_lg_u32 s28, 1
s_cbranch_scc1 Lsg_13
buffer_atomic_add v12, v10, s[4:7], s92 offen sc1
Lsg_13:
s_cmp_lg_u32 s28, 1
s_cbranch_scc1 L_wskip2
s_mov_b64 exec, 0
s_branch L_stub5
L_wret2:
s_mov_b64 exec, -1
L_wskip2:
s_cmp_lt_u32 s28, 2
s_cbranch_scc1 Lwd_14
s_add_u32 s44, s28, 0
s_mul_i32 s45, s44, 3072
s_add_u32 m0, s45, 49152
s_lshr_b32 s44, s44, 1
s_add_u32 s44, s44, 8
s_mul_i32 s44, s44, 6144
s_add_u32 s44, s44, s50
s_add_u32 s44, s44, 0x600000
buffer_load_dwordx4 v1, s[4:7], s44 offen offset:0 sc1 lds
buffer_load_dwordx4 v1, s[4:7], s44 offen offset:1024 sc1 lds
buffer_load_dwordx4 v1, s[4:7], s44 offen offset:2048 sc1 lds
s_sub_u32 s44, s28, 2
s_mul_i32 s45, s44, 3072
s_add_u32 m0, s45, 49152
s_lshr_b32 s44, s44, 1
s_add_u32 s44, s44, 8
s_mul_i32 s44, s44, 6144
s_add_u32 s44, s44, s50
s_add_u32 s44, s44, 0x600000
buffer_load_dwordx4 v1, s[4:7], s44 offen offset:0 sc1 lds
buffer_load_dwordx4 v1, s[4:7], s44 offen offset:1024 sc1 lds
buffer_load_dwordx4 v1, s[4:7], s44 offen offset:2048 sc1 lds
s_add_u32 s44, s28, 4
s_mul_i32 s45, s44, 3072
s_add_u32 m0, s45, 49152
s_lshr_b32 s44, s44, 1
s_add_u32 s44, s44, 8
s_mul_i32 s44, s44, 6144
s_add_u32 s44, s44, s50
s_add_u32 s44, s44, 0x600000
buffer_load_dwordx4 v1, s[4:7], s44 offen offset:0 sc1 lds
buffer_load_dwordx4 v1, s[4:7], s44 offen offset:1024 sc1 lds
buffer_load_dwordx4 v1, s[4:7], s44 offen offset:2048 sc1 lds
s_add_u32 s44, s28, 2
s_mul_i32 s45, s44, 3072
s_add_u32 m0, s45, 49152
s_lshr_b32 s44, s44, 1
s_add_u32 s44, s44, 8
s_mul_i32 s44, s44, 6144
s_add_u32 s44, s44, s50
s_add_u32 s44, s44, 0x600000
buffer_load_dwordx4 v1, s[4:7], s44 offen offset:0 sc1 lds
buffer_load_dwordx4 v1, s[4:7], s44 offen offset:1024 sc1 lds
buffer_load_dwordx4 v1, s[4:7], s44 offen offset:2048 sc1 lds
s_add_u32 s44, s28, 8
s_mul_i32 s45, s44, 3072
s_add_u32 m0, s45, 49152
s_lshr_b32 s44, s44, 1
s_add_u32 s44, s44, 8
s_mul_i32 s44, s44, 6144
s_add_u32 s44, s44, s50
s_add_u32 s44, s44, 0x600000
buffer_load_dwordx4 v1, s[4:7], s44 offen offset:0 sc1 lds
buffer_load_dwordx4 v1, s[4:7], s44 offen offset:1024 sc1 lds
buffer_load_dwordx4 v1, s[4:7], s44 offen offset:2048 sc1 lds
s_add_u32 s44, s28, 6
s_mul_i32 s45, s44, 3072
s_add_u32 m0, s45, 49152
s_lshr_b32 s44, s44, 1
s_add_u32 s44, s44, 8
s_mul_i32 s44, s44, 6144
s_add_u32 s44, s44, s50
s_add_u32 s44, s44, 0x600000
buffer_load_dwordx4 v1, s[4:7], s44 offen offset:0 sc1 lds
buffer_load_dwordx4 v1, s[4:7], s44 offen offset:1024 sc1 lds
buffer_load_dwordx4 v1, s[4:7], s44 offen offset:2048 sc1 lds
s_add_u32 s44, s28, 12
s_mul_i32 s45, s44, 3072
s_add_u32 m0, s45, 49152
s_lshr_b32 s44, s44, 1
s_add_u32 s44, s44, 8
s_mul_i32 s44, s44, 6144
s_add_u32 s44, s44, s50
s_add_u32 s44, s44, 0x600000
buffer_load_dwordx4 v1, s[4:7], s44 offen offset:0 sc1 lds
buffer_load_dwordx4 v1, s[4:7], s44 offen offset:1024 sc1 lds
buffer_load_dwordx4 v1, s[4:7], s44 offen offset:2048 sc1 lds
s_add_u32 s44, s28, 10
s_mul_i32 s45, s44, 3072
s_add_u32 m0, s45, 49152
s_lshr_b32 s44, s44, 1
s_add_u32 s44, s44, 8
s_mul_i32 s44, s44, 6144
s_add_u32 s44, s44, s50
s_add_u32 s44, s44, 0x600000
buffer_load_dwordx4 v1, s[4:7], s44 offen offset:0 sc1 lds
buffer_load_dwordx4 v1, s[4:7], s44 offen offset:1024 sc1 lds
buffer_load_dwordx4 v1, s[4:7], s44 offen offset:2048 sc1 lds
Lwd_14:
s_cmp_lg_u32 s28, 0
s_cbranch_scc1 Lpe_16
s_add_u32 s36, s67, 0x40000
s_mov_b32 s37, 0
Lpoll_15:
v_mov_b32 v11, 0
s_mov_b64 exec, 1
buffer_atomic_add v11, off, s[4:7], s36 sc0 sc1
s_waitcnt vmcnt(0)
v_readfirstlane_b32 s38, v11
s_mov_b64 exec, -1
s_nop 0
v_mov_b32 v11, s38
s_add_u32 s37, s37, 1
v_cmp_gt_u32 vcc, 32, v11
s_cbranch_vccz Lpe_16
s_cmp_lt_u32 s37, 0x100000
s_cbranch_scc1 Lpoll_15
Lpe_16:
s_waitcnt vmcnt(24)
s_cmp_ge_u32 s28, 2
s_cbranch_scc1 Lw_17
s_waitcnt vmcnt(0)
Lw_17:
s_barrier
s_add_u32 s94, s80, 0x80080
s_lshl_b32 s35, s33, 12
buffer_load_dwordx4 a[0:3], v2, s[40:43], s35 offen offset:0 sc1
buffer_load_dwordx4 a[4:7], v2, s[40:43], s35 offen offset:1024 sc1
buffer_load_dwordx4 a[8:11], v2, s[40:43], s35 offen offset:2048 sc1
buffer_load_dwordx4 a[12:15], v2, s[40:43], s35 offen offset:3072 sc1
s_add_u32 s35, s35, 4096
buffer_load_dwordx4 a[16:19], v2, s[40:43], s35 offen offset:0 sc1
buffer_load_dwordx4 a[20:23], v2, s[40:43], s35 offen offset:1024 sc1
buffer_load_dwordx4 a[24:27], v2, s[40:43], s35 offen offset:2048 sc1
buffer_load_dwordx4 a[28:31], v2, s[40:43], s35 offen offset:3072 sc1
s_add_u32 s35, s35, 4096
buffer_load_dwordx4 a[32:35], v2, s[40:43], s35 offen offset:0 sc1
buffer_load_dwordx4 a[36:39], v2, s[40:43], s35 offen offset:1024 sc1
buffer_load_dwordx4 a[40:43], v2, s[40:43], s35 offen offset:2048 sc1
buffer_load_dwordx4 a[44:47], v2, s[40:43], s35 offen offset:3072 sc1
s_add_u32 s35, s35, 4096
v_add_u32 v5, 0, v1
ds_read_b128 a[96:99], v5 offset:0
ds_read_b128 a[100:103], v5 offset:1024
ds_read_b128 a[104:107], v5 offset:2048
ds_read_b128 a[108:111], v5 offset:3072
ds_read_b128 a[112:115], v5 offset:4096
ds_read_b128 a[116:119], v5 offset:5120
s_waitcnt vmcnt(8) lgkmcnt(0)
v_mfma_f32_16x16x32_bf16 v[132:135], a[96:99], a[0:3], 0
v_and_b32 v232, 15, v0
v_lshlrev_b32 v232, 7, v232
v_mfma_f32_16x16x32_bf16 v[156:159], a[96:99], a[4:7], 0
buffer_load_dwordx4 a[48:51], v2, s[40:43], s35 offen offset:0 sc1
v_mfma_f32_16x16x32_bf16 v[180:183], a[96:99], a[8:11], 0
v_lshrrev_b32 v233, 4, v0
v_lshlrev_b32 v233, 4, v233
v_mfma_f32_16x16x32_bf16 v[204:207], a[96:99], a[12:15], 0
v_add_u32 v232, v233, v232
s_mul_i32 s38, s30, 12288
v_mfma_f32_16x16x32_bf16 v[208:211], a[100:103], a[12:15], 0
s_add_u32 s38, s38, 0x380000
s_add_u32 s39, s28, 4
s_min_u32 s39, s39, 5
s_lshl_b32 s36, s28, 11
s_add_u32 s36, s36, s38
s_lshl_b32 s37, s39, 11
s_add_u32 s37, s37, s38
v_mfma_f32_16x16x32_bf16 v[184:187], a[100:103], a[8:11], 0
buffer_load_dwordx4 v[48:51], v232, s[4:7], s36 offen sc1
v_mfma_f32_16x16x32_bf16 v[160:163], a[100:103], a[4:7], 0
ds_read_b128 a[128:131], v5 offset:6144
v_mfma_f32_16x16x32_bf16 v[136:139], a[100:103], a[0:3], 0
ds_read_b128 a[132:135], v5 offset:7168
v_mfma_f32_16x16x32_bf16 v[140:143], a[104:107], a[0:3], 0
ds_read_b128 a[136:139], v5 offset:8192
v_mfma_f32_16x16x32_bf16 v[164:167], a[104:107], a[4:7], 0
buffer_load_dwordx4 a[52:55], v2, s[40:43], s35 offen offset:1024 sc1
v_mfma_f32_16x16x32_bf16 v[188:191], a[104:107], a[8:11], 0
ds_read_b128 a[140:143], v5 offset:9216
v_mfma_f32_16x16x32_bf16 v[212:215], a[104:107], a[12:15], 0
ds_read_b128 a[144:147], v5 offset:10240
v_mfma_f32_16x16x32_bf16 v[216:219], a[108:111], a[12:15], 0
v_mfma_f32_16x16x32_bf16 v[192:195], a[108:111], a[8:11], 0
buffer_load_dwordx4 a[56:59], v2, s[40:43], s35 offen offset:2048 sc1
v_mfma_f32_16x16x32_bf16 v[168:171], a[108:111], a[4:7], 0
ds_read_b128 a[148:151], v5 offset:11264
v_mfma_f32_16x16x32_bf16 v[144:147], a[108:111], a[0:3], 0
v_mfma_f32_16x16x32_bf16 v[148:151], a[112:115], a[0:3], 0
v_mfma_f32_16x16x32_bf16 v[172:175], a[112:115], a[4:7], 0
buffer_load_dwordx4 v[52:55], v232, s[4:7], s37 offen sc1
s_add_u32 s44, s28, 0
v_mfma_f32_16x16x32_bf16 v[196:199], a[112:115], a[8:11], 0
s_mul_i32 s45, s44, 3072
s_add_u32 m0, s45, 98304
s_lshr_b32 s44, s44, 1
v_mfma_f32_16x16x32_bf16 v[220:223], a[112:115], a[12:15], 0
s_add_u32 s44, s44, 16
s_mul_i32 s44, s44, 6144
s_add_u32 s44, s44, s50
v_mfma_f32_16x16x32_bf16 v[224:227], a[116:119], a[12:15], 0
s_add_u32 s44, s44, 0x600000
v_mfma_f32_16x16x32_bf16 v[200:203], a[116:119], a[8:11], 0
buffer_load_dwordx4 a[60:63], v2, s[40:43], s35 offen offset:3072 sc1
s_add_u32 s35, s35, 4096
v_mfma_f32_16x16x32_bf16 v[176:179], a[116:119], a[4:7], 0
v_mfma_f32_16x16x32_bf16 v[152:155], a[116:119], a[0:3], 0
s_waitcnt vmcnt(10) lgkmcnt(0)
v_mfma_f32_16x16x32_bf16 v[132:135], a[128:131], a[16:19], v[132:135]
ds_read_b128 a[96:99], v5 offset:12288
v_mfma_f32_16x16x32_bf16 v[156:159], a[128:131], a[20:23], v[156:159]
buffer_load_dwordx4 a[0:3], v2, s[40:43], s35 offen offset:0 sc1
v_mfma_f32_16x16x32_bf16 v[180:183], a[128:131], a[24:27], v[180:183]
ds_read_b128 a[100:103], v5 offset:13312
v_mfma_f32_16x16x32_bf16 v[204:207], a[128:131], a[28:31], v[204:207]
v_mfma_f32_16x16x32_bf16 v[208:211], a[132:135], a[28:31], v[208:211]
v_mfma_f32_16x16x32_bf16 v[184:187], a[132:135], a[24:27], v[184:187]
buffer_load_dwordx4 v1, s[4:7], s44 offen offset:0 sc1 lds
v_mfma_f32_16x16x32_bf16 v[160:163], a[132:135], a[20:23], v[160:163]
ds_read_b128 a[104:107], v5 offset:14336
v_mfma_f32_16x16x32_bf16 v[136:139], a[132:135], a[16:19], v[136:139]
v_mfma_f32_16x16x32_bf16 v[140:143], a[136:139], a[16:19], v[140:143]
ds_read_b128 a[108:111], v5 offset:15360
v_mfma_f32_16x16x32_bf16 v[164:167], a[136:139], a[20:23], v[164:167]
buffer_load_dwordx4 a[4:7], v2, s[40:43], s35 offen offset:1024 sc1
v_mfma_f32_16x16x32_bf16 v[188:191], a[136:139], a[24:27], v[188:191]
ds_read_b128 a[112:115], v5 offset:16384
v_mfma_f32_16x16x32_bf16 v[212:215], a[136:139], a[28:31], v[212:215]
v_mfma_f32_16x16x32_bf16 v[216:219], a[140:143], a[28:31], v[216:219]
v_mfma_f32_16x16x32_bf16 v[192:195], a[140:143], a[24:27], v[192:195]
buffer_load_dwordx4 a[8:11], v2, s[40:43], s35 offen offset:2048 sc1
v_mfma_f32_16x16x32_bf16 v[168:171], a[140:143], a[20:23], v[168:171]
ds_read_b128 a[116:119], v5 offset:17408
v_mfma_f32_16x16x32_bf16 v[144:147], a[140:143], a[16:19], v[144:147]
v_mfma_f32_16x16x32_bf16 v[148:151], a[144:147], a[16:19], v[148:151]
v_mfma_f32_16x16x32_bf16 v[172:175], a[144:147], a[20:23], v[172:175]
buffer_load_dwordx4 v1, s[4:7], s44 offen offset:1024 sc1 lds
v_mfma_f32_16x16x32_bf16 v[196:199], a[144:147], a[24:27], v[196:199]
v_mfma_f32_16x16x32_bf16 v[220:223], a[144:147], a[28:31], v[220:223]
v_mfma_f32_16x16x32_bf16 v[224:227], a[148:151], a[28:31], v[224:227]
v_mfma_f32_16x16x32_bf16 v[200:203], a[148:151], a[24:27], v[200:203]
buffer_load_dwordx4 a[12:15], v2, s[40:43], s35 offen offset:3072 sc1
s_add_u32 s35, s35, 4096
v_mfma_f32_16x16x32_bf16 v[176:179], a[148:151], a[20:23], v[176:179]
v_mfma_f32_16x16x32_bf16 v[152:155], a[148:151], a[16:19], v[152:155]
s_waitcnt vmcnt(12) lgkmcnt(0)
v_mfma_f32_16x16x32_bf16 v[132:135], a[96:99], a[32:35], v[132:135]
ds_read_b128 a[128:131], v5 offset:18432
v_mfma_f32_16x16x32_bf16 v[156:159], a[96:99], a[36:39], v[156:159]
buffer_load_dwordx4 a[16:19], v2, s[40:43], s35 offen offset:0 sc1
v_mfma_f32_16x16x32_bf16 v[180:183], a[96:99], a[40:43], v[180:183]
ds_read_b128 a[132:135], v5 offset:19456
v_mfma_f32_16x16x32_bf16 v[204:207], a[96:99], a[44:47], v[204:207]
v_mfma_f32_16x16x32_bf16 v[208:211], a[100:103], a[44:47], v[208:211]
v_mfma_f32_16x16x32_bf16 v[184:187], a[100:103], a[40:43], v[184:187]
buffer_load_dwordx4 a[20:23], v2, s[40:43], s35 offen offset:1024 sc1
v_mfma_f32_16x16x32_bf16 v[160:163], a[100:103], a[36:39], v[160:163]
ds_read_b128 a[136:139], v5 offset:20480
v_mfma_f32_16x16x32_bf16 v[136:139], a[100:103], a[32:35], v[136:139]
v_mfma_f32_16x16x32_bf16 v[140:143], a[104:107], a[32:35], v[140:143]
ds_read_b128 a[140:143], v5 offset:21504
v_mfma_f32_16x16x32_bf16 v[164:167], a[104:107], a[36:39], v[164:167]
v_mfma_f32_16x16x32_bf16 v[188:191], a[104:107], a[40:43], v[188:191]
buffer_load_dwordx4 v1, s[4:7], s44 offen offset:2048 sc1 lds
s_add_u32 s44, s28, 4
v_mfma_f32_16x16x32_bf16 v[212:215], a[104:107], a[44:47], v[212:215]
s_mul_i32 s45, s44, 3072
s_add_u32 m0, s45, 98304
s_lshr_b32 s44, s44, 1
v_mfma_f32_16x16x32_bf16 v[216:219], a[108:111], a[44:47], v[216:219]
s_add_u32 s44, s44, 16
s_mul_i32 s44, s44, 6144
s_add_u32 s44, s44, s50
v_mfma_f32_16x16x32_bf16 v[192:195], a[108:111], a[40:43], v[192:195]
s_add_u32 s44, s44, 0x600000
ds_read_b128 a[144:147], v5 offset:22528
v_mfma_f32_16x16x32_bf16 v[168:171], a[108:111], a[36:39], v[168:171]
ds_read_b128 a[148:151], v5 offset:23552
v_mfma_f32_16x16x32_bf16 v[144:147], a[108:111], a[32:35], v[144:147]
buffer_load_dwordx4 a[24:27], v2, s[40:43], s35 offen offset:2048 sc1
v_mfma_f32_16x16x32_bf16 v[148:151], a[112:115], a[32:35], v[148:151]
v_mfma_f32_16x16x32_bf16 v[172:175], a[112:115], a[36:39], v[172:175]
v_mfma_f32_16x16x32_bf16 v[196:199], a[112:115], a[40:43], v[196:199]
v_mfma_f32_16x16x32_bf16 v[220:223], a[112:115], a[44:47], v[220:223]
v_mfma_f32_16x16x32_bf16 v[224:227], a[116:119], a[44:47], v[224:227]
buffer_load_dwordx4 a[28:31], v2, s[40:43], s35 offen offset:3072 sc1
s_add_u32 s35, s35, 4096
v_mfma_f32_16x16x32_bf16 v[200:203], a[116:119], a[40:43], v[200:203]
v_mfma_f32_16x16x32_bf16 v[176:179], a[116:119], a[36:39], v[176:179]
v_mfma_f32_16x16x32_bf16 v[152:155], a[116:119], a[32:35], v[152:155]
s_waitcnt vmcnt(11) lgkmcnt(0)
v_mfma_f32_16x16x32_bf16 v[132:135], a[128:131], a[48:51], v[132:135]
ds_read_b128 a[96:99], v5 offset:24576
v_mfma_f32_16x16x32_bf16 v[156:159], a[128:131], a[52:55], v[156:159]
buffer_load_dwordx4 a[32:35], v2, s[40:43], s35 offen offset:0 sc1
v_mfma_f32_16x16x32_bf16 v[180:183], a[128:131], a[56:59], v[180:183]
ds_read_b128 a[100:103], v5 offset:25600
v_mfma_f32_16x16x32_bf16 v[204:207], a[128:131], a[60:63], v[204:207]
v_mfma_f32_16x16x32_bf16 v[208:211], a[132:135], a[60:63], v[208:211]
v_mfma_f32_16x16x32_bf16 v[184:187], a[132:135], a[56:59], v[184:187]
buffer_load_dwordx4 v1, s[4:7], s44 offen offset:0 sc1 lds
v_mfma_f32_16x16x32_bf16 v[160:163], a[132:135], a[52:55], v[160:163]
ds_read_b128 a[104:107], v5 offset:26624
v_mfma_f32_16x16x32_bf16 v[136:139], a[132:135], a[48:51], v[136:139]
v_mfma_f32_16x16x32_bf16 v[140:143], a[136:139], a[48:51], v[140:143]
ds_read_b128 a[108:111], v5 offset:27648
v_mfma_f32_16x16x32_bf16 v[164:167], a[136:139], a[52:55], v[164:167]
buffer_load_dwordx4 a[36:39], v2, s[40:43], s35 offen offset:1024 sc1
v_mfma_f32_16x16x32_bf16 v[188:191], a[136:139], a[56:59], v[188:191]
ds_read_b128 a[112:115], v5 offset:28672
v_mfma_f32_16x16x32_bf16 v[212:215], a[136:139], a[60:63], v[212:215]
v_mfma_f32_16x16x32_bf16 v[216:219], a[140:143], a[60:63], v[216:219]
v_mfma_f32_16x16x32_bf16 v[192:195], a[140:143], a[56:59], v[192:195]
buffer_load_dwordx4 a[40:43], v2, s[40:43], s35 offen offset:2048 sc1
v_mfma_f32_16x16x32_bf16 v[168:171], a[140:143], a[52:55], v[168:171]
ds_read_b128 a[116:119], v5 offset:29696
v_mfma_f32_16x16x32_bf16 v[144:147], a[140:143], a[48:51], v[144:147]
v_mfma_f32_16x16x32_bf16 v[148:151], a[144:147], a[48:51], v[148:151]
v_mfma_f32_16x16x32_bf16 v[172:175], a[144:147], a[52:55], v[172:175]
buffer_load_dwordx4 v1, s[4:7], s44 offen offset:1024 sc1 lds
v_mfma_f32_16x16x32_bf16 v[196:199], a[144:147], a[56:59], v[196:199]
v_mfma_f32_16x16x32_bf16 v[220:223], a[144:147], a[60:63], v[220:223]
v_mfma_f32_16x16x32_bf16 v[224:227], a[148:151], a[60:63], v[224:227]
v_mfma_f32_16x16x32_bf16 v[200:203], a[148:151], a[56:59], v[200:203]
buffer_load_dwordx4 a[44:47], v2, s[40:43], s35 offen offset:3072 sc1
s_add_u32 s35, s35, 4096
v_mfma_f32_16x16x32_bf16 v[176:179], a[148:151], a[52:55], v[176:179]
v_mfma_f32_16x16x32_bf16 v[152:155], a[148:151], a[48:51], v[152:155]
s_waitcnt vmcnt(11) lgkmcnt(0)
v_mfma_f32_16x16x32_bf16 v[132:135], a[96:99], a[0:3], v[132:135]
ds_read_b128 a[128:131], v5 offset:30720
v_mfma_f32_16x16x32_bf16 v[156:159], a[96:99], a[4:7], v[156:159]
buffer_load_dwordx4 a[48:51], v2, s[40:43], s35 offen offset:0 sc1
v_mfma_f32_16x16x32_bf16 v[180:183], a[96:99], a[8:11], v[180:183]
ds_read_b128 a[132:135], v5 offset:31744
v_mfma_f32_16x16x32_bf16 v[204:207], a[96:99], a[12:15], v[204:207]
v_mfma_f32_16x16x32_bf16 v[208:211], a[100:103], a[12:15], v[208:211]
v_mfma_f32_16x16x32_bf16 v[184:187], a[100:103], a[8:11], v[184:187]
buffer_load_dwordx4 v1, s[4:7], s44 offen offset:2048 sc1 lds
s_add_u32 s44, s28, 8
v_mfma_f32_16x16x32_bf16 v[160:163], a[100:103], a[4:7], v[160:163]
s_mul_i32 s45, s44, 3072
s_add_u32 m0, s45, 98304
s_lshr_b32 s44, s44, 1
v_mfma_f32_16x16x32_bf16 v[136:139], a[100:103], a[0:3], v[136:139]
s_add_u32 s44, s44, 16
s_mul_i32 s44, s44, 6144
s_add_u32 s44, s44, s50
v_mfma_f32_16x16x32_bf16 v[140:143], a[104:107], a[0:3], v[140:143]
s_add_u32 s44, s44, 0x600000
ds_read_b128 a[136:139], v5 offset:32768
v_mfma_f32_16x16x32_bf16 v[164:167], a[104:107], a[4:7], v[164:167]
buffer_load_dwordx4 a[52:55], v2, s[40:43], s35 offen offset:1024 sc1
v_mfma_f32_16x16x32_bf16 v[188:191], a[104:107], a[8:11], v[188:191]
ds_read_b128 a[140:143], v5 offset:33792
v_mfma_f32_16x16x32_bf16 v[212:215], a[104:107], a[12:15], v[212:215]
ds_read_b128 a[144:147], v5 offset:34816
v_mfma_f32_16x16x32_bf16 v[216:219], a[108:111], a[12:15], v[216:219]
v_mfma_f32_16x16x32_bf16 v[192:195], a[108:111], a[8:11], v[192:195]
buffer_load_dwordx4 a[56:59], v2, s[40:43], s35 offen offset:2048 sc1
v_mfma_f32_16x16x32_bf16 v[168:171], a[108:111], a[4:7], v[168:171]
ds_read_b128 a[148:151], v5 offset:35840
v_mfma_f32_16x16x32_bf16 v[144:147], a[108:111], a[0:3], v[144:147]
v_mfma_f32_16x16x32_bf16 v[148:151], a[112:115], a[0:3], v[148:151]
v_mfma_f32_16x16x32_bf16 v[172:175], a[112:115], a[4:7], v[172:175]
buffer_load_dwordx4 v1, s[4:7], s44 offen offset:0 sc1 lds
v_mfma_f32_16x16x32_bf16 v[196:199], a[112:115], a[8:11], v[196:199]
v_mfma_f32_16x16x32_bf16 v[220:223], a[112:115], a[12:15], v[220:223]
v_mfma_f32_16x16x32_bf16 v[224:227], a[116:119], a[12:15], v[224:227]
v_mfma_f32_16x16x32_bf16 v[200:203], a[116:119], a[8:11], v[200:203]
buffer_load_dwordx4 a[60:63], v2, s[40:43], s35 offen offset:3072 sc1
s_add_u32 s35, s35, 4096
v_mfma_f32_16x16x32_bf16 v[176:179], a[116:119], a[4:7], v[176:179]
v_mfma_f32_16x16x32_bf16 v[152:155], a[116:119], a[0:3], v[152:155]
s_waitcnt vmcnt(12) lgkmcnt(0)
v_mfma_f32_16x16x32_bf16 v[132:135], a[128:131], a[16:19], v[132:135]
ds_read_b128 a[96:99], v5 offset:36864
v_mfma_f32_16x16x32_bf16 v[156:159], a[128:131], a[20:23], v[156:159]
buffer_load_dwordx4 a[0:3], v2, s[40:43], s35 offen offset:0 sc1
v_mfma_f32_16x16x32_bf16 v[180:183], a[128:131], a[24:27], v[180:183]
ds_read_b128 a[100:103], v5 offset:37888
v_mfma_f32_16x16x32_bf16 v[204:207], a[128:131], a[28:31], v[204:207]
v_mfma_f32_16x16x32_bf16 v[208:211], a[132:135], a[28:31], v[208:211]
v_mfma_f32_16x16x32_bf16 v[184:187], a[132:135], a[24:27], v[184:187]
buffer_load_dwordx4 a[4:7], v2, s[40:43], s35 offen offset:1024 sc1
v_mfma_f32_16x16x32_bf16 v[160:163], a[132:135], a[20:23], v[160:163]
ds_read_b128 a[104:107], v5 offset:38912
v_mfma_f32_16x16x32_bf16 v[136:139], a[132:135], a[16:19], v[136:139]
v_mfma_f32_16x16x32_bf16 v[140:143], a[136:139], a[16:19], v[140:143]
ds_read_b128 a[108:111], v5 offset:39936
v_mfma_f32_16x16x32_bf16 v[164:167], a[136:139], a[20:23], v[164:167]
v_mfma_f32_16x16x32_bf16 v[188:191], a[136:139], a[24:27], v[188:191]
buffer_load_dwordx4 v1, s[4:7], s44 offen offset:1024 sc1 lds
v_mfma_f32_16x16x32_bf16 v[212:215], a[136:139], a[28:31], v[212:215]
ds_read_b128 a[112:115], v5 offset:40960
v_mfma_f32_16x16x32_bf16 v[216:219], a[140:143], a[28:31], v[216:219]
v_mfma_f32_16x16x32_bf16 v[192:195], a[140:143], a[24:27], v[192:195]
ds_read_b128 a[116:119], v5 offset:41984
v_mfma_f32_16x16x32_bf16 v[168:171], a[140:143], a[20:23], v[168:171]
v_mfma_f32_16x16x32_bf16 v[144:147], a[140:143], a[16:19], v[144:147]
buffer_load_dwordx4 a[8:11], v2, s[40:43], s35 offen offset:2048 sc1
v_mfma_f32_16x16x32_bf16 v[148:151], a[144:147], a[16:19], v[148:151]
v_mfma_f32_16x16x32_bf16 v[172:175], a[144:147], a[20:23], v[172:175]
v_mfma_f32_16x16x32_bf16 v[196:199], a[144:147], a[24:27], v[196:199]
v_mfma_f32_16x16x32_bf16 v[220:223], a[144:147], a[28:31], v[220:223]
v_mfma_f32_16x16x32_bf16 v[224:227], a[148:151], a[28:31], v[224:227]
buffer_load_dwordx4 a[12:15], v2, s[40:43], s35 offen offset:3072 sc1
s_add_u32 s35, s35, 4096
v_mfma_f32_16x16x32_bf16 v[200:203], a[148:151], a[24:27], v[200:203]
v_mfma_f32_16x16x32_bf16 v[176:179], a[148:151], a[20:23], v[176:179]
v_mfma_f32_16x16x32_bf16 v[152:155], a[148:151], a[16:19], v[152:155]
s_waitcnt vmcnt(11) lgkmcnt(0)
v_mfma_f32_16x16x32_bf16 v[132:135], a[96:99], a[32:35], v[132:135]
ds_read_b128 a[128:131], v5 offset:43008
v_mfma_f32_16x16x32_bf16 v[156:159], a[96:99], a[36:39], v[156:159]
buffer_load_dwordx4 a[16:19], v2, s[40:43], s35 offen offset:0 sc1
v_mfma_f32_16x16x32_bf16 v[180:183], a[96:99], a[40:43], v[180:183]
ds_read_b128 a[132:135], v5 offset:44032
v_mfma_f32_16x16x32_bf16 v[204:207], a[96:99], a[44:47], v[204:207]
v_mfma_f32_16x16x32_bf16 v[208:211], a[100:103], a[44:47], v[208:211]
v_mfma_f32_16x16x32_bf16 v[184:187], a[100:103], a[40:43], v[184:187]
buffer_load_dwordx4 v1, s[4:7], s44 offen offset:2048 sc1 lds
s_add_u32 s44, s28, 12
v_mfma_f32_16x16x32_bf16 v[160:163], a[100:103], a[36:39], v[160:163]
s_mul_i32 s45, s44, 3072
s_add_u32 m0, s45, 98304
s_lshr_b32 s44, s44, 1
v_mfma_f32_16x16x32_bf16 v[136:139], a[100:103], a[32:35], v[136:139]
s_add_u32 s44, s44, 16
s_mul_i32 s44, s44, 6144
s_add_u32 s44, s44, s50
v_mfma_f32_16x16x32_bf16 v[140:143], a[104:107], a[32:35], v[140:143]
s_add_u32 s44, s44, 0x600000
ds_read_b128 a[136:139], v5 offset:45056
v_mfma_f32_16x16x32_bf16 v[164:167], a[104:107], a[36:39], v[164:167]
buffer_load_dwordx4 a[20:23], v2, s[40:43], s35 offen offset:1024 sc1
v_mfma_f32_16x16x32_bf16 v[188:191], a[104:107], a[40:43], v[188:191]
ds_read_b128 a[140:143], v5 offset:46080
v_mfma_f32_16x16x32_bf16 v[212:215], a[104:107], a[44:47], v[212:215]
ds_read_b128 a[144:147], v5 offset:47104
v_mfma_f32_16x16x32_bf16 v[216:219], a[108:111], a[44:47], v[216:219]
v_mfma_f32_16x16x32_bf16 v[192:195], a[108:111], a[40:43], v[192:195]
buffer_load_dwordx4 a[24:27], v2, s[40:43], s35 offen offset:2048 sc1
v_mfma_f32_16x16x32_bf16 v[168:171], a[108:111], a[36:39], v[168:171]
ds_read_b128 a[148:151], v5 offset:48128
v_mfma_f32_16x16x32_bf16 v[144:147], a[108:111], a[32:35], v[144:147]
v_mfma_f32_16x16x32_bf16 v[148:151], a[112:115], a[32:35], v[148:151]
v_mfma_f32_16x16x32_bf16 v[172:175], a[112:115], a[36:39], v[172:175]
buffer_load_dwordx4 v1, s[4:7], s44 offen offset:0 sc1 lds
v_mfma_f32_16x16x32_bf16 v[196:199], a[112:115], a[40:43], v[196:199]
v_mfma_f32_16x16x32_bf16 v[220:223], a[112:115], a[44:47], v[220:223]
v_mfma_f32_16x16x32_bf16 v[224:227], a[116:119], a[44:47], v[224:227]
v_mfma_f32_16x16x32_bf16 v[200:203], a[116:119], a[40:43], v[200:203]
buffer_load_dwordx4 a[28:31], v2, s[40:43], s35 offen offset:3072 sc1
s_add_u32 s35, s35, 4096
v_mfma_f32_16x16x32_bf16 v[176:179], a[116:119], a[36:39], v[176:179]
v_mfma_f32_16x16x32_bf16 v[152:155], a[116:119], a[32:35], v[152:155]
s_waitcnt vmcnt(11) lgkmcnt(0)
s_barrier
v_mfma_f32_16x16x32_bf16 v[132:135], a[128:131], a[48:51], v[132:135]
v_add_u32 v5, 49152, v1
v_mfma_f32_16x16x32_bf16 v[156:159], a[128:131], a[52:55], v[156:159]
buffer_load_dwordx4 a[32:35], v2, s[40:43], s35 offen offset:0 sc1
v_mfma_f32_16x16x32_bf16 v[180:183], a[128:131], a[56:59], v[180:183]
ds_read_b128 a[96:99], v5 offset:0
v_mfma_f32_16x16x32_bf16 v[204:207], a[128:131], a[60:63], v[204:207]
ds_read_b128 a[100:103], v5 offset:1024
v_mfma_f32_16x16x32_bf16 v[208:211], a[132:135], a[60:63], v[208:211]
v_mfma_f32_16x16x32_bf16 v[184:187], a[132:135], a[56:59], v[184:187]
buffer_load_dwordx4 v1, s[4:7], s44 offen offset:1024 sc1 lds
v_mfma_f32_16x16x32_bf16 v[160:163], a[132:135], a[52:55], v[160:163]
ds_read_b128 a[104:107], v5 offset:2048
v_mfma_f32_16x16x32_bf16 v[136:139], a[132:135], a[48:51], v[136:139]
v_mfma_f32_16x16x32_bf16 v[140:143], a[136:139], a[48:51], v[140:143]
ds_read_b128 a[108:111], v5 offset:3072
v_mfma_f32_16x16x32_bf16 v[164:167], a[136:139], a[52:55], v[164:167]
buffer_load_dwordx4 a[36:39], v2, s[40:43], s35 offen offset:1024 sc1
v_mfma_f32_16x16x32_bf16 v[188:191], a[136:139], a[56:59], v[188:191]
ds_read_b128 a[112:115], v5 offset:4096
v_mfma_f32_16x16x32_bf16 v[212:215], a[136:139], a[60:63], v[212:215]
L_stub5:
s_cbranch_execz L_stub6
v_mfma_f32_16x16x32_bf16 v[216:219], a[140:143], a[60:63], v[216:219]
v_mfma_f32_16x16x32_bf16 v[192:195], a[140:143], a[56:59], v[192:195]
buffer_load_dwordx4 a[40:43], v2, s[40:43], s35 offen offset:2048 sc1
v_mfma_f32_16x16x32_bf16 v[168:171], a[140:143], a[52:55], v[168:171]
ds_read_b128 a[116:119], v5 offset:5120
v_mfma_f32_16x16x32_bf16 v[144:147], a[140:143], a[48:51], v[144:147]
v_mfma_f32_16x16x32_bf16 v[148:151], a[144:147], a[48:51], v[148:151]
v_mfma_f32_16x16x32_bf16 v[172:175], a[144:147], a[52:55], v[172:175]
buffer_load_dwordx4 v1, s[4:7], s44 offen offset:2048 sc1 lds
s_add_u32 s88, s82, 0x240000
v_mfma_f32_16x16x32_bf16 v[196:199], a[144:147], a[56:59], v[196:199]
v_mfma_f32_16x16x32_bf16 v[220:223], a[144:147], a[60:63], v[220:223]
v_mfma_f32_16x16x32_bf16 v[224:227], a[148:151], a[60:63], v[224:227]
v_mfma_f32_16x16x32_bf16 v[200:203], a[148:151], a[56:59], v[200:203]
buffer_load_dwordx4 a[44:47], v2, s[40:43], s35 offen offset:3072 sc1
s_add_u32 s35, s35, 4096
v_mfma_f32_16x16x32_bf16 v[176:179], a[148:151], a[52:55], v[176:179]
v_mfma_f32_16x16x32_bf16 v[152:155], a[148:151], a[48:51], v[152:155]
s_waitcnt vmcnt(12) lgkmcnt(0)
v_mfma_f32_16x16x32_bf16 v[132:135], a[96:99], a[0:3], v[132:135]
ds_read_b128 a[128:131], v5 offset:6144
v_mfma_f32_16x16x32_bf16 v[156:159], a[96:99], a[4:7], v[156:159]
buffer_load_dwordx4 a[48:51], v2, s[40:43], s35 offen offset:0 sc1
v_mfma_f32_16x16x32_bf16 v[180:183], a[96:99], a[8:11], v[180:183]
ds_read_b128 a[132:135], v5 offset:7168
v_mfma_f32_16x16x32_bf16 v[204:207], a[96:99], a[12:15], v[204:207]
v_mfma_f32_16x16x32_bf16 v[208:211], a[100:103], a[12:15], v[208:211]
v_mfma_f32_16x16x32_bf16 v[184:187], a[100:103], a[8:11], v[184:187]
buffer_load_dwordx4 a[52:55], v2, s[40:43], s35 offen offset:1024 sc1
v_mfma_f32_16x16x32_bf16 v[160:163], a[100:103], a[4:7], v[160:163]
ds_read_b128 a[136:139], v5 offset:8192
v_mfma_f32_16x16x32_bf16 v[136:139], a[100:103], a[0:3], v[136:139]
v_mfma_f32_16x16x32_bf16 v[140:143], a[104:107], a[0:3], v[140:143]
ds_read_b128 a[140:143], v5 offset:9216
v_mfma_f32_16x16x32_bf16 v[164:167], a[104:107], a[4:7], v[164:167]
v_mfma_f32_16x16x32_bf16 v[188:191], a[104:107], a[8:11], v[188:191]
buffer_load_dwordx4 v[92:95], v1, s[4:7], s88 offen offset:0 sc1
v_mfma_f32_16x16x32_bf16 v[212:215], a[104:107], a[12:15], v[212:215]
ds_read_b128 a[144:147], v5 offset:10240
v_mfma_f32_16x16x32_bf16 v[216:219], a[108:111], a[12:15], v[216:219]
v_mfma_f32_16x16x32_bf16 v[192:195], a[108:111], a[8:11], v[192:195]
ds_read_b128 a[148:151], v5 offset:11264
v_mfma_f32_16x16x32_bf16 v[168:171], a[108:111], a[4:7], v[168:171]
v_mfma_f32_16x16x32_bf16 v[144:147], a[108:111], a[0:3], v[144:147]
buffer_load_dwordx4 a[56:59], v2, s[40:43], s35 offen offset:2048 sc1
v_mfma_f32_16x16x32_bf16 v[148:151], a[112:115], a[0:3], v[148:151]
v_mfma_f32_16x16x32_bf16 v[172:175], a[112:115], a[4:7], v[172:175]
v_mfma_f32_16x16x32_bf16 v[196:199], a[112:115], a[8:11], v[196:199]
v_mfma_f32_16x16x32_bf16 v[220:223], a[112:115], a[12:15], v[220:223]
v_mfma_f32_16x16x32_bf16 v[224:227], a[116:119], a[12:15], v[224:227]
buffer_load_dwordx4 a[60:63], v2, s[40:43], s35 offen offset:3072 sc1
s_add_u32 s35, s35, 4096
v_mfma_f32_16x16x32_bf16 v[200:203], a[116:119], a[8:11], v[200:203]
v_mfma_f32_16x16x32_bf16 v[176:179], a[116:119], a[4:7], v[176:179]
v_mfma_f32_16x16x32_bf16 v[152:155], a[116:119], a[0:3], v[152:155]
s_waitcnt vmcnt(11) lgkmcnt(0)
v_mfma_f32_16x16x32_bf16 v[132:135], a[128:131], a[16:19], v[132:135]
ds_read_b128 a[96:99], v5 offset:12288
v_mfma_f32_16x16x32_bf16 v[156:159], a[128:131], a[20:23], v[156:159]
buffer_load_dwordx4 a[0:3], v2, s[40:43], s35 offen offset:0 sc1
v_mfma_f32_16x16x32_bf16 v[180:183], a[128:131], a[24:27], v[180:183]
ds_read_b128 a[100:103], v5 offset:13312
v_mfma_f32_16x16x32_bf16 v[204:207], a[128:131], a[28:31], v[204:207]
v_mfma_f32_16x16x32_bf16 v[208:211], a[132:135], a[28:31], v[208:211]
v_mfma_f32_16x16x32_bf16 v[184:187], a[132:135], a[24:27], v[184:187]
buffer_load_dwordx4 v[96:99], v1, s[4:7], s88 offen offset:1024 sc1
v_mfma_f32_16x16x32_bf16 v[160:163], a[132:135], a[20:23], v[160:163]
ds_read_b128 a[104:107], v5 offset:14336
v_mfma_f32_16x16x32_bf16 v[136:139], a[132:135], a[16:19], v[136:139]
v_mfma_f32_16x16x32_bf16 v[140:143], a[136:139], a[16:19], v[140:143]
ds_read_b128 a[108:111], v5 offset:15360
v_mfma_f32_16x16x32_bf16 v[164:167], a[136:139], a[20:23], v[164:167]
buffer_load_dwordx4 a[4:7], v2, s[40:43], s35 offen offset:1024 sc1
v_mfma_f32_16x16x32_bf16 v[188:191], a[136:139], a[24:27], v[188:191]
ds_read_b128 a[112:115], v5 offset:16384
v_mfma_f32_16x16x32_bf16 v[212:215], a[136:139], a[28:31], v[212:215]
v_mfma_f32_16x16x32_bf16 v[216:219], a[140:143], a[28:31], v[216:219]
v_mfma_f32_16x16x32_bf16 v[192:195], a[140:143], a[24:27], v[192:195]
buffer_load_dwordx4 a[8:11], v2, s[40:43], s35 offen offset:2048 sc1
v_mfma_f32_16x16x32_bf16 v[168:171], a[140:143], a[20:23], v[168:171]
ds_read_b128 a[116:119], v5 offset:17408
v_mfma_f32_16x16x32_bf16 v[144:147], a[140:143], a[16:19], v[144:147]
v_mfma_f32_16x16x32_bf16 v[148:151], a[144:147], a[16:19], v[148:151]
v_mfma_f32_16x16x32_bf16 v[172:175], a[144:147], a[20:23], v[172:175]
buffer_load_dwordx4 v[100:103], v1, s[4:7], s88 offen offset:2048 sc1
v_mfma_f32_16x16x32_bf16 v[196:199], a[144:147], a[24:27], v[196:199]
v_mfma_f32_16x16x32_bf16 v[220:223], a[144:147], a[28:31], v[220:223]
v_mfma_f32_16x16x32_bf16 v[224:227], a[148:151], a[28:31], v[224:227]
v_mfma_f32_16x16x32_bf16 v[200:203], a[148:151], a[24:27], v[200:203]
buffer_load_dwordx4 a[12:15], v2, s[40:43], s35 offen offset:3072 sc1
s_add_u32 s35, s35, 4096
v_mfma_f32_16x16x32_bf16 v[176:179], a[148:151], a[20:23], v[176:179]
v_mfma_f32_16x16x32_bf16 v[152:155], a[148:151], a[16:19], v[152:155]
s_waitcnt vmcnt(11) lgkmcnt(0)
v_mfma_f32_16x16x32_bf16 v[132:135], a[96:99], a[32:35], v[132:135]
ds_read_b128 a[128:131], v5 offset:18432
v_mfma_f32_16x16x32_bf16 v[156:159], a[96:99], a[36:39], v[156:159]
buffer_load_dwordx4 a[16:19], v2, s[40:43], s35 offen offset:0 sc1
v_mfma_f32_16x16x32_bf16 v[180:183], a[96:99], a[40:43], v[180:183]
ds_read_b128 a[132:135], v5 offset:19456
v_mfma_f32_16x16x32_bf16 v[204:207], a[96:99], a[44:47], v[204:207]
v_mfma_f32_16x16x32_bf16 v[208:211], a[100:103], a[44:47], v[208:211]
v_mfma_f32_16x16x32_bf16 v[184:187], a[100:103], a[40:43], v[184:187]
buffer_load_dwordx4 v[104:107], v1, s[4:7], s88 offen offset:3072 sc1
s_add_u32 s88, s88, 4096
v_mfma_f32_16x16x32_bf16 v[160:163], a[100:103], a[36:39], v[160:163]
ds_read_b128 a[136:139], v5 offset:20480
v_mfma_f32_16x16x32_bf16 v[136:139], a[100:103], a[32:35], v[136:139]
v_mfma_f32_16x16x32_bf16 v[140:143], a[104:107], a[32:35], v[140:143]
ds_read_b128 a[140:143], v5 offset:21504
v_mfma_f32_16x16x32_bf16 v[164:167], a[104:107], a[36:39], v[164:167]
buffer_load_dwordx4 a[20:23], v2, s[40:43], s35 offen offset:1024 sc1
v_mfma_f32_16x16x32_bf16 v[188:191], a[104:107], a[40:43], v[188:191]
ds_read_b128 a[144:147], v5 offset:22528
v_mfma_f32_16x16x32_bf16 v[212:215], a[104:107], a[44:47], v[212:215]
v_mfma_f32_16x16x32_bf16 v[216:219], a[108:111], a[44:47], v[216:219]
v_mfma_f32_16x16x32_bf16 v[192:195], a[108:111], a[40:43], v[192:195]
buffer_load_dwordx4 a[24:27], v2, s[40:43], s35 offen offset:2048 sc1
v_mfma_f32_16x16x32_bf16 v[168:171], a[108:111], a[36:39], v[168:171]
ds_read_b128 a[148:151], v5 offset:23552
v_mfma_f32_16x16x32_bf16 v[144:147], a[108:111], a[32:35], v[144:147]
v_mfma_f32_16x16x32_bf16 v[148:151], a[112:115], a[32:35], v[148:151]
v_mfma_f32_16x16x32_bf16 v[172:175], a[112:115], a[36:39], v[172:175]
buffer_load_dwordx4 v[108:111], v1, s[4:7], s88 offen offset:0 sc1
v_mfma_f32_16x16x32_bf16 v[196:199], a[112:115], a[40:43], v[196:199]
v_mfma_f32_16x16x32_bf16 v[220:223], a[112:115], a[44:47], v[220:223]
v_mfma_f32_16x16x32_bf16 v[224:227], a[116:119], a[44:47], v[224:227]
v_mfma_f32_16x16x32_bf16 v[200:203], a[116:119], a[40:43], v[200:203]
buffer_load_dwordx4 a[28:31], v2, s[40:43], s35 offen offset:3072 sc1
s_add_u32 s35, s35, 4096
v_mfma_f32_16x16x32_bf16 v[176:179], a[116:119], a[36:39], v[176:179]
v_mfma_f32_16x16x32_bf16 v[152:155], a[116:119], a[32:35], v[152:155]
s_waitcnt vmcnt(12) lgkmcnt(0)
v_mfma_f32_16x16x32_bf16 v[132:135], a[128:131], a[48:51], v[132:135]
ds_read_b128 a[96:99], v5 offset:24576
v_mfma_f32_16x16x32_bf16 v[156:159], a[128:131], a[52:55], v[156:159]
buffer_load_dwordx4 a[32:35], v2, s[40:43], s35 offen offset:0 sc1
v_mfma_f32_16x16x32_bf16 v[180:183], a[128:131], a[56:59], v[180:183]
ds_read_b128 a[100:103], v5 offset:25600
v_mfma_f32_16x16x32_bf16 v[204:207], a[128:131], a[60:63], v[204:207]
v_mfma_f32_16x16x32_bf16 v[208:211], a[132:135], a[60:63], v[208:211]
v_mfma_f32_16x16x32_bf16 v[184:187], a[132:135], a[56:59], v[184:187]
buffer_load_dwordx4 a[36:39], v2, s[40:43], s35 offen offset:1024 sc1
v_mfma_f32_16x16x32_bf16 v[160:163], a[132:135], a[52:55], v[160:163]
ds_read_b128 a[104:107], v5 offset:26624
v_mfma_f32_16x16x32_bf16 v[136:139], a[132:135], a[48:51], v[136:139]
v_mfma_f32_16x16x32_bf16 v[140:143], a[136:139], a[48:51], v[140:143]
ds_read_b128 a[108:111], v5 offset:27648
v_mfma_f32_16x16x32_bf16 v[164:167], a[136:139], a[52:55], v[164:167]
v_mfma_f32_16x16x32_bf16 v[188:191], a[136:139], a[56:59], v[188:191]
buffer_load_dwordx4 v[112:115], v1, s[4:7], s88 offen offset:1024 sc1
v_mfma_f32_16x16x32_bf16 v[212:215], a[136:139], a[60:63], v[212:215]
ds_read_b128 a[112:115], v5 offset:28672
v_mfma_f32_16x16x32_bf16 v[216:219], a[140:143], a[60:63], v[216:219]
v_mfma_f32_16x16x32_bf16 v[192:195], a[140:143], a[56:59], v[192:195]
ds_read_b128 a[116:119], v5 offset:29696
v_mfma_f32_16x16x32_bf16 v[168:171], a[140:143], a[52:55], v[168:171]
v_mfma_f32_16x16x32_bf16 v[144:147], a[140:143], a[48:51], v[144:147]
buffer_load_dwordx4 a[40:43], v2, s[40:43], s35 offen offset:2048 sc1
v_mfma_f32_16x16x32_bf16 v[148:151], a[144:147], a[48:51], v[148:151]
v_mfma_f32_16x16x32_bf16 v[172:175], a[144:147], a[52:55], v[172:175]
v_mfma_f32_16x16x32_bf16 v[196:199], a[144:147], a[56:59], v[196:199]
v_mfma_f32_16x16x32_bf16 v[220:223], a[144:147], a[60:63], v[220:223]
v_mfma_f32_16x16x32_bf16 v[224:227], a[148:151], a[60:63], v[224:227]
buffer_load_dwordx4 a[44:47], v2, s[40:43], s35 offen offset:3072 sc1
s_add_u32 s35, s35, 4096
v_mfma_f32_16x16x32_bf16 v[200:203], a[148:151], a[56:59], v[200:203]
v_mfma_f32_16x16x32_bf16 v[176:179], a[148:151], a[52:55], v[176:179]
v_mfma_f32_16x16x32_bf16 v[152:155], a[148:151], a[48:51], v[152:155]
s_waitcnt vmcnt(11) lgkmcnt(0)
v_mfma_f32_16x16x32_bf16 v[132:135], a[96:99], a[0:3], v[132:135]
ds_read_b128 a[128:131], v5 offset:30720
v_add_f32_dpp v48, v48, v48 row_ror:8 row_mask:0xf bank_mask:0xf
v_mfma_f32_16x16x32_bf16 v[156:159], a[96:99], a[4:7], v[156:159]
buffer_load_dwordx4 a[48:51], v2, s[40:43], s35 offen offset:0 sc1
v_mfma_f32_16x16x32_bf16 v[180:183], a[96:99], a[8:11], v[180:183]
ds_read_b128 a[132:135], v5 offset:31744
v_add_f32_dpp v49, v49, v49 row_ror:8 row_mask:0xf bank_mask:0xf
v_mfma_f32_16x16x32_bf16 v[204:207], a[96:99], a[12:15], v[204:207]
v_add_f32_dpp v50, v50, v50 row_ror:8 row_mask:0xf bank_mask:0xf
v_add_f32_dpp v51, v51, v51 row_ror:8 row_mask:0xf bank_mask:0xf
v_mfma_f32_16x16x32_bf16 v[208:211], a[100:103], a[12:15], v[208:211]
v_add_f32_dpp v52, v52, v52 row_ror:8 row_mask:0xf bank_mask:0xf
v_add_f32_dpp v53, v53, v53 row_ror:8 row_mask:0xf bank_mask:0xf
v_mfma_f32_16x16x32_bf16 v[184:187], a[100:103], a[8:11], v[184:187]
buffer_load_dwordx4 v[116:119], v1, s[4:7], s88 offen offset:2048 sc1
v_mfma_f32_16x16x32_bf16 v[160:163], a[100:103], a[4:7], v[160:163]
ds_read_b128 a[136:139], v5 offset:32768
v_add_f32_dpp v54, v54, v54 row_ror:8 row_mask:0xf bank_mask:0xf
v_mfma_f32_16x16x32_bf16 v[136:139], a[100:103], a[0:3], v[136:139]
v_add_f32_dpp v55, v55, v55 row_ror:8 row_mask:0xf bank_mask:0xf
v_add_f32_dpp v48, v48, v48 row_ror:4 row_mask:0xf bank_mask:0xf
v_mfma_f32_16x16x32_bf16 v[140:143], a[104:107], a[0:3], v[140:143]
ds_read_b128 a[140:143], v5 offset:33792
v_add_f32_dpp v49, v49, v49 row_ror:4 row_mask:0xf bank_mask:0xf
v_mfma_f32_16x16x32_bf16 v[164:167], a[104:107], a[4:7], v[164:167]
buffer_load_dwordx4 a[52:55], v2, s[40:43], s35 offen offset:1024 sc1
v_mfma_f32_16x16x32_bf16 v[188:191], a[104:107], a[8:11], v[188:191]
ds_read_b128 a[144:147], v5 offset:34816
v_add_f32_dpp v50, v50, v50 row_ror:4 row_mask:0xf bank_mask:0xf
v_mfma_f32_16x16x32_bf16 v[212:215], a[104:107], a[12:15], v[212:215]
v_add_f32_dpp v51, v51, v51 row_ror:4 row_mask:0xf bank_mask:0xf
v_add_f32_dpp v52, v52, v52 row_ror:4 row_mask:0xf bank_mask:0xf
v_mfma_f32_16x16x32_bf16 v[216:219], a[108:111], a[12:15], v[216:219]
v_add_f32_dpp v53, v53, v53 row_ror:4 row_mask:0xf bank_mask:0xf
v_mfma_f32_16x16x32_bf16 v[192:195], a[108:111], a[8:11], v[192:195]
buffer_load_dwordx4 a[56:59], v2, s[40:43], s35 offen offset:2048 sc1
v_mfma_f32_16x16x32_bf16 v[168:171], a[108:111], a[4:7], v[168:171]
ds_read_b128 a[148:151], v5 offset:35840
v_add_f32_dpp v54, v54, v54 row_ror:4 row_mask:0xf bank_mask:0xf
v_mfma_f32_16x16x32_bf16 v[144:147], a[108:111], a[0:3], v[144:147]
v_add_f32_dpp v55, v55, v55 row_ror:4 row_mask:0xf bank_mask:0xf
v_add_f32_dpp v48, v48, v48 row_ror:2 row_mask:0xf bank_mask:0xf
v_mfma_f32_16x16x32_bf16 v[148:151], a[112:115], a[0:3], v[148:151]
v_add_f32_dpp v49, v49, v49 row_ror:2 row_mask:0xf bank_mask:0xf
v_mfma_f32_16x16x32_bf16 v[172:175], a[112:115], a[4:7], v[172:175]
buffer_load_dwordx4 v[120:123], v1, s[4:7], s88 offen offset:3072 sc1
s_add_u32 s44, s28, 0
v_mfma_f32_16x16x32_bf16 v[196:199], a[112:115], a[8:11], v[196:199]
s_mul_i32 s45, s44, 3072
s_add_u32 m0, s45, 0
s_lshr_b32 s44, s44, 1
v_mfma_f32_16x16x32_bf16 v[220:223], a[112:115], a[12:15], v[220:223]
s_add_u32 s44, s44, 24
s_mul_i32 s44, s44, 6144
s_add_u32 s44, s44, s50
v_mfma_f32_16x16x32_bf16 v[224:227], a[116:119], a[12:15], v[224:227]
s_add_u32 s44, s44, 0x600000
v_add_f32_dpp v50, v50, v50 row_ror:2 row_mask:0xf bank_mask:0xf
v_mfma_f32_16x16x32_bf16 v[200:203], a[116:119], a[8:11], v[200:203]
buffer_load_dwordx4 a[60:63], v2, s[40:43], s35 offen offset:3072 sc1
s_add_u32 s35, s35, 4096
v_mfma_f32_16x16x32_bf16 v[176:179], a[116:119], a[4:7], v[176:179]
v_add_f32_dpp v51, v51, v51 row_ror:2 row_mask:0xf bank_mask:0xf
v_add_f32_dpp v52, v52, v52 row_ror:2 row_mask:0xf bank_mask:0xf
v_mfma_f32_16x16x32_bf16 v[152:155], a[116:119], a[0:3], v[152:155]
v_add_f32_dpp v53, v53, v53 row_ror:2 row_mask:0xf bank_mask:0xf
s_waitcnt vmcnt(11) lgkmcnt(0)
v_mfma_f32_16x16x32_bf16 v[132:135], a[128:131], a[16:19], v[132:135]
ds_read_b128 a[96:99], v5 offset:36864
v_add_f32_dpp v54, v54, v54 row_ror:2 row_mask:0xf bank_mask:0xf
v_mfma_f32_16x16x32_bf16 v[156:159], a[128:131], a[20:23], v[156:159]
buffer_load_dwordx4 a[0:3], v2, s[40:43], s35 offen offset:0 sc1
v_mfma_f32_16x16x32_bf16 v[180:183], a[128:131], a[24:27], v[180:183]
ds_read_b128 a[100:103], v5 offset:37888
v_add_f32_dpp v55, v55, v55 row_ror:2 row_mask:0xf bank_mask:0xf
v_mfma_f32_16x16x32_bf16 v[204:207], a[128:131], a[28:31], v[204:207]
v_add_f32_dpp v48, v48, v48 row_ror:1 row_mask:0xf bank_mask:0xf
v_add_f32_dpp v49, v49, v49 row_ror:1 row_mask:0xf bank_mask:0xf
v_mfma_f32_16x16x32_bf16 v[208:211], a[132:135], a[28:31], v[208:211]
v_add_f32_dpp v50, v50, v50 row_ror:1 row_mask:0xf bank_mask:0xf
v_add_f32_dpp v51, v51, v51 row_ror:1 row_mask:0xf bank_mask:0xf
v_mfma_f32_16x16x32_bf16 v[184:187], a[132:135], a[24:27], v[184:187]
buffer_load_dwordx4 v1, s[4:7], s44 offen offset:0 sc1 lds
v_mfma_f32_16x16x32_bf16 v[160:163], a[132:135], a[20:23], v[160:163]
ds_read_b128 a[104:107], v5 offset:38912
v_add_f32_dpp v52, v52, v52 row_ror:1 row_mask:0xf bank_mask:0xf
v_mfma_f32_16x16x32_bf16 v[136:139], a[132:135], a[16:19], v[136:139]
v_add_f32_dpp v53, v53, v53 row_ror:1 row_mask:0xf bank_mask:0xf
v_add_f32_dpp v54, v54, v54 row_ror:1 row_mask:0xf bank_mask:0xf
v_mfma_f32_16x16x32_bf16 v[140:143], a[136:139], a[16:19], v[140:143]
ds_read_b128 a[108:111], v5 offset:39936
v_add_f32_dpp v55, v55, v55 row_ror:1 row_mask:0xf bank_mask:0xf
v_mfma_f32_16x16x32_bf16 v[164:167], a[136:139], a[20:23], v[164:167]
buffer_load_dwordx4 a[4:7], v2, s[40:43], s35 offen offset:1024 sc1
v_mfma_f32_16x16x32_bf16 v[188:191], a[136:139], a[24:27], v[188:191]
ds_read_b128 a[112:115], v5 offset:40960
v_add_u32 v233, 159744, v233
v_mfma_f32_16x16x32_bf16 v[212:215], a[136:139], a[28:31], v[212:215]
s_lshl_b32 s36, s28, 6
s_lshl_b32 s37, s39, 6
v_mfma_f32_16x16x32_bf16 v[216:219], a[140:143], a[28:31], v[216:219]
v_add_u32 v232, s36, v233
v_add_u32 v235, s37, v233
v_mfma_f32_16x16x32_bf16 v[192:195], a[140:143], a[24:27], v[192:195]
buffer_load_dwordx4 a[8:11], v2, s[40:43], s35 offen offset:2048 sc1
v_mfma_f32_16x16x32_bf16 v[168:171], a[140:143], a[20:23], v[168:171]
ds_read_b128 a[116:119], v5 offset:41984
v_mfma_f32_16x16x32_bf16 v[144:147], a[140:143], a[16:19], v[144:147]
v_mfma_f32_16x16x32_bf16 v[148:151], a[144:147], a[16:19], v[148:151]
v_mfma_f32_16x16x32_bf16 v[172:175], a[144:147], a[20:23], v[172:175]
buffer_load_dwordx4 v1, s[4:7], s44 offen offset:1024 sc1 lds
v_mfma_f32_16x16x32_bf16 v[196:199], a[144:147], a[24:27], v[196:199]
v_mfma_f32_16x16x32_bf16 v[220:223], a[144:147], a[28:31], v[220:223]
v_mfma_f32_16x16x32_bf16 v[224:227], a[148:151], a[28:31], v[224:227]
v_mfma_f32_16x16x32_bf16 v[200:203], a[148:151], a[24:27], v[200:203]
buffer_load_dwordx4 a[12:15], v2, s[40:43], s35 offen offset:3072 sc1
s_add_u32 s35, s35, 4096
v_mfma_f32_16x16x32_bf16 v[176:179], a[148:151], a[20:23], v[176:179]
v_mfma_f32_16x16x32_bf16 v[152:155], a[148:151], a[16:19], v[152:155]
s_waitcnt vmcnt(12) lgkmcnt(0)
v_mfma_f32_16x16x32_bf16 v[132:135], a[96:99], a[32:35], v[132:135]
ds_read_b128 a[128:131], v5 offset:43008
v_mfma_f32_16x16x32_bf16 v[156:159], a[96:99], a[36:39], v[156:159]
buffer_load_dwordx4 a[16:19], v2, s[40:43], s35 offen offset:0 sc1
v_mfma_f32_16x16x32_bf16 v[180:183], a[96:99], a[40:43], v[180:183]
ds_read_b128 a[132:135], v5 offset:44032
v_mfma_f32_16x16x32_bf16 v[204:207], a[96:99], a[44:47], v[204:207]
ds_write_b128 v232, v[48:51]
v_mfma_f32_16x16x32_bf16 v[208:211], a[100:103], a[44:47], v[208:211]
ds_write_b128 v235, v[52:55]
v_mfma_f32_16x16x32_bf16 v[184:187], a[100:103], a[40:43], v[184:187]
buffer_load_dwordx4 a[20:23], v2, s[40:43], s35 offen offset:1024 sc1
v_mfma_f32_16x16x32_bf16 v[160:163], a[100:103], a[36:39], v[160:163]
ds_read_b128 a[136:139], v5 offset:45056
v_mfma_f32_16x16x32_bf16 v[136:139], a[100:103], a[32:35], v[136:139]
v_mfma_f32_16x16x32_bf16 v[140:143], a[104:107], a[32:35], v[140:143]
ds_read_b128 a[140:143], v5 offset:46080
v_mfma_f32_16x16x32_bf16 v[164:167], a[104:107], a[36:39], v[164:167]
v_mfma_f32_16x16x32_bf16 v[188:191], a[104:107], a[40:43], v[188:191]
buffer_load_dwordx4 v1, s[4:7], s44 offen offset:2048 sc1 lds
s_add_u32 s44, s28, 4
v_mfma_f32_16x16x32_bf16 v[212:215], a[104:107], a[44:47], v[212:215]
s_mul_i32 s45, s44, 3072
s_add_u32 m0, s45, 0
s_lshr_b32 s44, s44, 1
v_mfma_f32_16x16x32_bf16 v[216:219], a[108:111], a[44:47], v[216:219]
s_add_u32 s44, s44, 24
s_mul_i32 s44, s44, 6144
s_add_u32 s44, s44, s50
v_mfma_f32_16x16x32_bf16 v[192:195], a[108:111], a[40:43], v[192:195]
s_add_u32 s44, s44, 0x600000
ds_read_b128 a[144:147], v5 offset:47104
v_mfma_f32_16x16x32_bf16 v[168:171], a[108:111], a[36:39], v[168:171]
ds_read_b128 a[148:151], v5 offset:48128
v_mfma_f32_16x16x32_bf16 v[144:147], a[108:111], a[32:35], v[144:147]
buffer_load_dwordx4 a[24:27], v2, s[40:43], s35 offen offset:2048 sc1
v_mfma_f32_16x16x32_bf16 v[148:151], a[112:115], a[32:35], v[148:151]
v_mfma_f32_16x16x32_bf16 v[172:175], a[112:115], a[36:39], v[172:175]
v_mfma_f32_16x16x32_bf16 v[196:199], a[112:115], a[40:43], v[196:199]
v_mfma_f32_16x16x32_bf16 v[220:223], a[112:115], a[44:47], v[220:223]
v_mfma_f32_16x16x32_bf16 v[224:227], a[116:119], a[44:47], v[224:227]
buffer_load_dwordx4 a[28:31], v2, s[40:43], s35 offen offset:3072 sc1
s_add_u32 s35, s35, 4096
v_mfma_f32_16x16x32_bf16 v[200:203], a[116:119], a[40:43], v[200:203]
v_mfma_f32_16x16x32_bf16 v[176:179], a[116:119], a[36:39], v[176:179]
v_mfma_f32_16x16x32_bf16 v[152:155], a[116:119], a[32:35], v[152:155]
s_waitcnt vmcnt(11) lgkmcnt(0)
s_barrier
v_mfma_f32_16x16x32_bf16 v[132:135], a[128:131], a[48:51], v[132:135]
v_add_u32 v5, 98304, v1
v_mfma_f32_16x16x32_bf16 v[156:159], a[128:131], a[52:55], v[156:159]
buffer_load_dwordx4 a[32:35], v2, s[40:43], s35 offen offset:0 sc1
v_mfma_f32_16x16x32_bf16 v[180:183], a[128:131], a[56:59], v[180:183]
ds_read_b128 a[96:99], v5 offset:0
v_mfma_f32_16x16x32_bf16 v[204:207], a[128:131], a[60:63], v[204:207]
ds_read_b128 a[100:103], v5 offset:1024
v_mfma_f32_16x16x32_bf16 v[208:211], a[132:135], a[60:63], v[208:211]
ds_read_b128 v[48:51], v233 offset:0
v_mfma_f32_16x16x32_bf16 v[184:187], a[132:135], a[56:59], v[184:187]
buffer_load_dwordx4 v1, s[4:7], s44 offen offset:0 sc1 lds
v_mfma_f32_16x16x32_bf16 v[160:163], a[132:135], a[52:55], v[160:163]
ds_read_b128 a[104:107], v5 offset:2048
v_mfma_f32_16x16x32_bf16 v[136:139], a[132:135], a[48:51], v[136:139]
v_mfma_f32_16x16x32_bf16 v[140:143], a[136:139], a[48:51], v[140:143]
ds_read_b128 a[108:111], v5 offset:3072
v_mfma_f32_16x16x32_bf16 v[164:167], a[136:139], a[52:55], v[164:167]
buffer_load_dwordx4 a[36:39], v2, s[40:43], s35 offen offset:1024 sc1
v_mfma_f32_16x16x32_bf16 v[188:191], a[136:139], a[56:59], v[188:191]
ds_read_b128 a[112:115], v5 offset:4096
v_mfma_f32_16x16x32_bf16 v[212:215], a[136:139], a[60:63], v[212:215]
ds_read_b128 v[52:55], v233 offset:64
v_mfma_f32_16x16x32_bf16 v[216:219], a[140:143], a[60:63], v[216:219]
v_mfma_f32_16x16x32_bf16 v[192:195], a[140:143], a[56:59], v[192:195]
buffer_load_dwordx4 a[40:43], v2, s[40:43], s35 offen offset:2048 sc1
v_mfma_f32_16x16x32_bf16 v[168:171], a[140:143], a[52:55], v[168:171]
ds_read_b128 a[116:119], v5 offset:5120
v_mfma_f32_16x16x32_bf16 v[144:147], a[140:143], a[48:51], v[144:147]
v_mfma_f32_16x16x32_bf16 v[148:151], a[144:147], a[48:51], v[148:151]
v_mfma_f32_16x16x32_bf16 v[172:175], a[144:147], a[52:55], v[172:175]
buffer_load_dwordx4 v1, s[4:7], s44 offen offset:1024 sc1 lds
v_mfma_f32_16x16x32_bf16 v[196:199], a[144:147], a[56:59], v[196:199]
v_mfma_f32_16x16x32_bf16 v[220:223], a[144:147], a[60:63], v[220:223]
v_mfma_f32_16x16x32_bf16 v[224:227], a[148:151], a[60:63], v[224:227]
v_mfma_f32_16x16x32_bf16 v[200:203], a[148:151], a[56:59], v[200:203]
buffer_load_dwordx4 a[44:47], v2, s[40:43], s35 offen offset:3072 sc1
s_add_u32 s35, s35, 4096
v_mfma_f32_16x16x32_bf16 v[176:179], a[148:151], a[52:55], v[176:179]
ds_read_b128 v[56:59], v233 offset:128
v_mfma_f32_16x16x32_bf16 v[152:155], a[148:151], a[48:51], v[152:155]
s_waitcnt vmcnt(11) lgkmcnt(1)
v_mfma_f32_16x16x32_bf16 v[132:135], a[96:99], a[0:3], v[132:135]
ds_read_b128 a[128:131], v5 offset:6144
v_mfma_f32_16x16x32_bf16 v[156:159], a[96:99], a[4:7], v[156:159]
buffer_load_dwordx4 a[48:51], v2, s[40:43], s35 offen offset:0 sc1
v_mfma_f32_16x16x32_bf16 v[180:183], a[96:99], a[8:11], v[180:183]
ds_read_b128 a[132:135], v5 offset:7168
v_mfma_f32_16x16x32_bf16 v[204:207], a[96:99], a[12:15], v[204:207]
v_mfma_f32_16x16x32_bf16 v[208:211], a[100:103], a[12:15], v[208:211]
v_mfma_f32_16x16x32_bf16 v[184:187], a[100:103], a[8:11], v[184:187]
buffer_load_dwordx4 v1, s[4:7], s44 offen offset:2048 sc1 lds
s_add_u32 s44, s28, 8
v_mfma_f32_16x16x32_bf16 v[160:163], a[100:103], a[4:7], v[160:163]
s_mul_i32 s45, s44, 3072
s_add_u32 m0, s45, 0
s_lshr_b32 s44, s44, 1
v_mfma_f32_16x16x32_bf16 v[136:139], a[100:103], a[0:3], v[136:139]
s_add_u32 s44, s44, 24
s_mul_i32 s44, s44, 6144
s_add_u32 s44, s44, s50
v_mfma_f32_16x16x32_bf16 v[140:143], a[104:107], a[0:3], v[140:143]
s_add_u32 s44, s44, 0x600000
ds_read_b128 a[136:139], v5 offset:8192
v_mfma_f32_16x16x32_bf16 v[164:167], a[104:107], a[4:7], v[164:167]
buffer_load_dwordx4 a[52:55], v2, s[40:43], s35 offen offset:1024 sc1
v_mfma_f32_16x16x32_bf16 v[188:191], a[104:107], a[8:11], v[188:191]
ds_read_b128 a[140:143], v5 offset:9216
v_mfma_f32_16x16x32_bf16 v[212:215], a[104:107], a[12:15], v[212:215]
ds_read_b128 a[144:147], v5 offset:10240
v_mfma_f32_16x16x32_bf16 v[216:219], a[108:111], a[12:15], v[216:219]
ds_read_b128 v[60:63], v233 offset:192
v_mfma_f32_16x16x32_bf16 v[192:195], a[108:111], a[8:11], v[192:195]
buffer_load_dwordx4 a[56:59], v2, s[40:43], s35 offen offset:2048 sc1
v_mfma_f32_16x16x32_bf16 v[168:171], a[108:111], a[4:7], v[168:171]
ds_read_b128 a[148:151], v5 offset:11264
v_mfma_f32_16x16x32_bf16 v[144:147], a[108:111], a[0:3], v[144:147]
v_mfma_f32_16x16x32_bf16 v[148:151], a[112:115], a[0:3], v[148:151]
v_mfma_f32_16x16x32_bf16 v[172:175], a[112:115], a[4:7], v[172:175]
buffer_load_dwordx4 v1, s[4:7], s44 offen offset:0 sc1 lds
v_mfma_f32_16x16x32_bf16 v[196:199], a[112:115], a[8:11], v[196:199]
ds_read_b128 v[64:67], v233 offset:256
v_mfma_f32_16x16x32_bf16 v[220:223], a[112:115], a[12:15], v[220:223]
v_mfma_f32_16x16x32_bf16 v[224:227], a[116:119], a[12:15], v[224:227]
v_mfma_f32_16x16x32_bf16 v[200:203], a[116:119], a[8:11], v[200:203]
buffer_load_dwordx4 a[60:63], v2, s[40:43], s35 offen offset:3072 sc1
s_add_u32 s35, s35, 4096
v_mfma_f32_16x16x32_bf16 v[176:179], a[116:119], a[4:7], v[176:179]
v_mfma_f32_16x16x32_bf16 v[152:155], a[116:119], a[0:3], v[152:155]
s_waitcnt vmcnt(12) lgkmcnt(1)
v_mfma_f32_16x16x32_bf16 v[132:135], a[128:131], a[16:19], v[132:135]
ds_read_b128 a[96:99], v5 offset:12288
v_mfma_f32_16x16x32_bf16 v[156:159], a[128:131], a[20:23], v[156:159]
buffer_load_dwordx4 a[0:3], v2, s[40:43], s35 offen offset:0 sc1
v_mfma_f32_16x16x32_bf16 v[180:183], a[128:131], a[24:27], v[180:183]
ds_read_b128 a[100:103], v5 offset:13312
v_mfma_f32_16x16x32_bf16 v[204:207], a[128:131], a[28:31], v[204:207]
v_mfma_f32_16x16x32_bf16 v[208:211], a[132:135], a[28:31], v[208:211]
v_mfma_f32_16x16x32_bf16 v[184:187], a[132:135], a[24:27], v[184:187]
buffer_load_dwordx4 a[4:7], v2, s[40:43], s35 offen offset:1024 sc1
v_mfma_f32_16x16x32_bf16 v[160:163], a[132:135], a[20:23], v[160:163]
ds_read_b128 a[104:107], v5 offset:14336
v_mfma_f32_16x16x32_bf16 v[136:139], a[132:135], a[16:19], v[136:139]
ds_read_b128 v[68:71], v233 offset:320
v_mfma_f32_16x16x32_bf16 v[140:143], a[136:139], a[16:19], v[140:143]
ds_read_b128 a[108:111], v5 offset:15360
v_mfma_f32_16x16x32_bf16 v[164:167], a[136:139], a[20:23], v[164:167]
v_mfma_f32_16x16x32_bf16 v[188:191], a[136:139], a[24:27], v[188:191]
buffer_load_dwordx4 v1, s[4:7], s44 offen offset:1024 sc1 lds
v_mfma_f32_16x16x32_bf16 v[212:215], a[136:139], a[28:31], v[212:215]
ds_read_b128 a[112:115], v5 offset:16384
v_mfma_f32_16x16x32_bf16 v[216:219], a[140:143], a[28:31], v[216:219]
v_mfma_f32_16x16x32_bf16 v[192:195], a[140:143], a[24:27], v[192:195]
ds_read_b128 a[116:119], v5 offset:17408
v_mfma_f32_16x16x32_bf16 v[168:171], a[140:143], a[20:23], v[168:171]
v_mfma_f32_16x16x32_bf16 v[144:147], a[140:143], a[16:19], v[144:147]
buffer_load_dwordx4 a[8:11], v2, s[40:43], s35 offen offset:2048 sc1
v_mfma_f32_16x16x32_bf16 v[148:151], a[144:147], a[16:19], v[148:151]
v_mfma_f32_16x16x32_bf16 v[172:175], a[144:147], a[20:23], v[172:175]
v_mfma_f32_16x16x32_bf16 v[196:199], a[144:147], a[24:27], v[196:199]
v_mfma_f32_16x16x32_bf16 v[220:223], a[144:147], a[28:31], v[220:223]
v_mfma_f32_16x16x32_bf16 v[224:227], a[148:151], a[28:31], v[224:227]
buffer_load_dwordx4 a[12:15], v2, s[40:43], s35 offen offset:3072 sc1
s_add_u32 s35, s35, 4096
v_mfma_f32_16x16x32_bf16 v[200:203], a[148:151], a[24:27], v[200:203]
v_mfma_f32_16x16x32_bf16 v[176:179], a[148:151], a[20:23], v[176:179]
v_mfma_f32_16x16x32_bf16 v[152:155], a[148:151], a[16:19], v[152:155]
s_waitcnt vmcnt(11) lgkmcnt(0)
v_mfma_f32_16x16x32_bf16 v[132:135], a[96:99], a[32:35], v[132:135]
ds_read_b128 a[128:131], v5 offset:18432
v_mfma_f32_16x16x32_bf16 v[156:159], a[96:99], a[36:39], v[156:159]
buffer_load_dwordx4 a[16:19], v2, s[40:43], s35 offen offset:0 sc1
v_mfma_f32_16x16x32_bf16 v[180:183], a[96:99], a[40:43], v[180:183]
ds_read_b128 a[132:135], v5 offset:19456
v_mfma_f32_16x16x32_bf16 v[204:207], a[96:99], a[44:47], v[204:207]
v_mfma_f32_16x16x32_bf16 v[208:211], a[100:103], a[44:47], v[208:211]
v_mfma_f32_16x16x32_bf16 v[184:187], a[100:103], a[40:43], v[184:187]
buffer_load_dwordx4 v1, s[4:7], s44 offen offset:2048 sc1 lds
s_add_u32 s44, s28, 12
v_mfma_f32_16x16x32_bf16 v[160:163], a[100:103], a[36:39], v[160:163]
s_mul_i32 s45, s44, 3072
s_add_u32 m0, s45, 0
s_lshr_b32 s44, s44, 1
v_mfma_f32_16x16x32_bf16 v[136:139], a[100:103], a[32:35], v[136:139]
s_add_u32 s44, s44, 24
s_mul_i32 s44, s44, 6144
s_add_u32 s44, s44, s50
v_mfma_f32_16x16x32_bf16 v[140:143], a[104:107], a[32:35], v[140:143]
s_add_u32 s44, s44, 0x600000
ds_read_b128 a[136:139], v5 offset:20480
v_mfma_f32_16x16x32_bf16 v[164:167], a[104:107], a[36:39], v[164:167]
buffer_load_dwordx4 a[20:23], v2, s[40:43], s35 offen offset:1024 sc1
v_mfma_f32_16x16x32_bf16 v[188:191], a[104:107], a[40:43], v[188:191]
ds_read_b128 a[140:143], v5 offset:21504
v_mfma_f32_16x16x32_bf16 v[212:215], a[104:107], a[44:47], v[212:215]
ds_read_b128 a[144:147], v5 offset:22528
v_mfma_f32_16x16x32_bf16 v[216:219], a[108:111], a[44:47], v[216:219]
v_mfma_f32_16x16x32_bf16 v[192:195], a[108:111], a[40:43], v[192:195]
buffer_load_dwordx4 a[24:27], v2, s[40:43], s35 offen offset:2048 sc1
v_mfma_f32_16x16x32_bf16 v[168:171], a[108:111], a[36:39], v[168:171]
ds_read_b128 a[148:151], v5 offset:23552
v_mfma_f32_16x16x32_bf16 v[144:147], a[108:111], a[32:35], v[144:147]
v_mfma_f32_16x16x32_bf16 v[148:151], a[112:115], a[32:35], v[148:151]
v_mfma_f32_16x16x32_bf16 v[172:175], a[112:115], a[36:39], v[172:175]
buffer_load_dwordx4 v1, s[4:7], s44 offen offset:0 sc1 lds
v_mfma_f32_16x16x32_bf16 v[196:199], a[112:115], a[40:43], v[196:199]
v_mfma_f32_16x16x32_bf16 v[220:223], a[112:115], a[44:47], v[220:223]
v_mfma_f32_16x16x32_bf16 v[224:227], a[116:119], a[44:47], v[224:227]
v_mfma_f32_16x16x32_bf16 v[200:203], a[116:119], a[40:43], v[200:203]
buffer_load_dwordx4 a[28:31], v2, s[40:43], s35 offen offset:3072 sc1
s_add_u32 s35, s35, 4096
v_mfma_f32_16x16x32_bf16 v[176:179], a[116:119], a[36:39], v[176:179]
v_mfma_f32_16x16x32_bf16 v[152:155], a[116:119], a[32:35], v[152:155]
s_waitcnt vmcnt(11) lgkmcnt(0)
v_mfma_f32_16x16x32_bf16 v[132:135], a[128:131], a[48:51], v[132:135]
ds_read_b128 a[96:99], v5 offset:24576
v_accvgpr_write_b32 a188, v48
v_mfma_f32_16x16x32_bf16 v[156:159], a[128:131], a[52:55], v[156:159]
buffer_load_dwordx4 a[32:35], v2, s[40:43], s35 offen offset:0 sc1
v_mfma_f32_16x16x32_bf16 v[180:183], a[128:131], a[56:59], v[180:183]
ds_read_b128 a[100:103], v5 offset:25600
v_mfma_f32_16x16x32_bf16 v[204:207], a[128:131], a[60:63], v[204:207]
v_accvgpr_write_b32 a189, v49
v_mfma_f32_16x16x32_bf16 v[208:211], a[132:135], a[60:63], v[208:211]
v_mfma_f32_16x16x32_bf16 v[184:187], a[132:135], a[56:59], v[184:187]
buffer_load_dwordx4 v1, s[4:7], s44 offen offset:1024 sc1 lds
v_mfma_f32_16x16x32_bf16 v[160:163], a[132:135], a[52:55], v[160:163]
ds_read_b128 a[104:107], v5 offset:26624
v_accvgpr_write_b32 a190, v50
v_mfma_f32_16x16x32_bf16 v[136:139], a[132:135], a[48:51], v[136:139]
v_mfma_f32_16x16x32_bf16 v[140:143], a[136:139], a[48:51], v[140:143]
L_stub6:
s_cbranch_execz L_stub7
ds_read_b128 a[108:111], v5 offset:27648
v_mfma_f32_16x16x32_bf16 v[164:167], a[136:139], a[52:55], v[164:167]
buffer_load_dwordx4 a[36:39], v2, s[40:43], s35 offen offset:1024 sc1
v_mfma_f32_16x16x32_bf16 v[188:191], a[136:139], a[56:59], v[188:191]
ds_read_b128 a[112:115], v5 offset:28672
v_accvgpr_write_b32 a191, v51
v_mfma_f32_16x16x32_bf16 v[212:215], a[136:139], a[60:63], v[212:215]
v_mfma_f32_16x16x32_bf16 v[216:219], a[140:143], a[60:63], v[216:219]
v_accvgpr_write_b32 a192, v52
v_mfma_f32_16x16x32_bf16 v[192:195], a[140:143], a[56:59], v[192:195]
buffer_load_dwordx4 a[40:43], v2, s[40:43], s35 offen offset:2048 sc1
v_mfma_f32_16x16x32_bf16 v[168:171], a[140:143], a[52:55], v[168:171]
ds_read_b128 a[116:119], v5 offset:29696
v_mfma_f32_16x16x32_bf16 v[144:147], a[140:143], a[48:51], v[144:147]
v_accvgpr_write_b32 a193, v53
v_mfma_f32_16x16x32_bf16 v[148:151], a[144:147], a[48:51], v[148:151]
v_mfma_f32_16x16x32_bf16 v[172:175], a[144:147], a[52:55], v[172:175]
buffer_load_dwordx4 v1, s[4:7], s44 offen offset:2048 sc1 lds
s_add_i32 s44, s28, 4
v_mfma_f32_16x16x32_bf16 v[196:199], a[144:147], a[56:59], v[196:199]
s_lshl_b32 s45, s44, 12
s_add_u32 m0, s45, 32768
s_and_b32 s45, s44, 7
v_mfma_f32_16x16x32_bf16 v[220:223], a[144:147], a[60:63], v[220:223]
s_cmp_eq_u32 s45, s3
s_cselect_b32 s45, 8, 0
s_add_u32 s44, s44, s45
v_mfma_f32_16x16x32_bf16 v[224:227], a[148:151], a[60:63], v[224:227]
s_and_b32 s44, s44, 31
s_lshl_b32 s44, s44, 12
s_add_u32 s44, s44, s51
v_mfma_f32_16x16x32_bf16 v[200:203], a[148:151], a[56:59], v[200:203]
buffer_load_dwordx4 a[44:47], v2, s[40:43], s35 offen offset:3072 sc1
s_add_u32 s35, s35, 4096
v_mfma_f32_16x16x32_bf16 v[176:179], a[148:151], a[52:55], v[176:179]
s_add_u32 s44, s44, 0x200000
v_accvgpr_write_b32 a194, v54
v_mfma_f32_16x16x32_bf16 v[152:155], a[148:151], a[48:51], v[152:155]
v_accvgpr_write_b32 a195, v55
s_waitcnt vmcnt(12) lgkmcnt(0)
v_mfma_f32_16x16x32_bf16 v[132:135], a[96:99], a[0:3], v[132:135]
ds_read_b128 a[128:131], v5 offset:30720
v_accvgpr_write_b32 a196, v56
v_mfma_f32_16x16x32_bf16 v[156:159], a[96:99], a[4:7], v[156:159]
buffer_load_dwordx4 a[48:51], v2, s[40:43], s35 offen offset:0 sc1
v_mfma_f32_16x16x32_bf16 v[180:183], a[96:99], a[8:11], v[180:183]
ds_read_b128 a[132:135], v5 offset:31744
v_mfma_f32_16x16x32_bf16 v[204:207], a[96:99], a[12:15], v[204:207]
v_accvgpr_write_b32 a197, v57
v_mfma_f32_16x16x32_bf16 v[208:211], a[100:103], a[12:15], v[208:211]
v_mfma_f32_16x16x32_bf16 v[184:187], a[100:103], a[8:11], v[184:187]
buffer_load_dwordx4 a[52:55], v2, s[40:43], s35 offen offset:1024 sc1
v_mfma_f32_16x16x32_bf16 v[160:163], a[100:103], a[4:7], v[160:163]
ds_read_b128 a[136:139], v5 offset:32768
v_accvgpr_write_b32 a198, v58
v_mfma_f32_16x16x32_bf16 v[136:139], a[100:103], a[0:3], v[136:139]
v_mfma_f32_16x16x32_bf16 v[140:143], a[104:107], a[0:3], v[140:143]
ds_read_b128 a[140:143], v5 offset:33792
v_mfma_f32_16x16x32_bf16 v[164:167], a[104:107], a[4:7], v[164:167]
v_accvgpr_write_b32 a199, v59
v_mfma_f32_16x16x32_bf16 v[188:191], a[104:107], a[8:11], v[188:191]
buffer_load_dwordx4 v1, s[4:7], s44 offen offset:0 sc1 lds
v_mfma_f32_16x16x32_bf16 v[212:215], a[104:107], a[12:15], v[212:215]
ds_read_b128 a[144:147], v5 offset:34816
v_mfma_f32_16x16x32_bf16 v[216:219], a[108:111], a[12:15], v[216:219]
v_accvgpr_write_b32 a200, v60
v_mfma_f32_16x16x32_bf16 v[192:195], a[108:111], a[8:11], v[192:195]
ds_read_b128 a[148:151], v5 offset:35840
v_mfma_f32_16x16x32_bf16 v[168:171], a[108:111], a[4:7], v[168:171]
v_mfma_f32_16x16x32_bf16 v[144:147], a[108:111], a[0:3], v[144:147]
buffer_load_dwordx4 a[56:59], v2, s[40:43], s35 offen offset:2048 sc1
v_mfma_f32_16x16x32_bf16 v[148:151], a[112:115], a[0:3], v[148:151]
v_accvgpr_write_b32 a201, v61
v_mfma_f32_16x16x32_bf16 v[172:175], a[112:115], a[4:7], v[172:175]
v_mfma_f32_16x16x32_bf16 v[196:199], a[112:115], a[8:11], v[196:199]
v_accvgpr_write_b32 a202, v62
v_mfma_f32_16x16x32_bf16 v[220:223], a[112:115], a[12:15], v[220:223]
v_mfma_f32_16x16x32_bf16 v[224:227], a[116:119], a[12:15], v[224:227]
buffer_load_dwordx4 a[60:63], v2, s[40:43], s35 offen offset:3072 sc1
s_add_u32 s35, s35, 4096
v_mfma_f32_16x16x32_bf16 v[200:203], a[116:119], a[8:11], v[200:203]
v_accvgpr_write_b32 a203, v63
v_mfma_f32_16x16x32_bf16 v[176:179], a[116:119], a[4:7], v[176:179]
v_mfma_f32_16x16x32_bf16 v[152:155], a[116:119], a[0:3], v[152:155]
s_waitcnt vmcnt(11) lgkmcnt(0)
v_mfma_f32_16x16x32_bf16 v[132:135], a[128:131], a[16:19], v[132:135]
ds_read_b128 a[96:99], v5 offset:36864
v_accvgpr_write_b32 a204, v64
v_mfma_f32_16x16x32_bf16 v[156:159], a[128:131], a[20:23], v[156:159]
buffer_load_dwordx4 a[0:3], v2, s[40:43], s35 offen offset:0 sc1
v_mfma_f32_16x16x32_bf16 v[180:183], a[128:131], a[24:27], v[180:183]
ds_read_b128 a[100:103], v5 offset:37888
v_mfma_f32_16x16x32_bf16 v[204:207], a[128:131], a[28:31], v[204:207]
v_accvgpr_write_b32 a205, v65
v_mfma_f32_16x16x32_bf16 v[208:211], a[132:135], a[28:31], v[208:211]
v_mfma_f32_16x16x32_bf16 v[184:187], a[132:135], a[24:27], v[184:187]
buffer_load_dwordx4 v1, s[4:7], s44 offen offset:1024 sc1 lds
v_mfma_f32_16x16x32_bf16 v[160:163], a[132:135], a[20:23], v[160:163]
ds_read_b128 a[104:107], v5 offset:38912
v_accvgpr_write_b32 a206, v66
v_mfma_f32_16x16x32_bf16 v[136:139], a[132:135], a[16:19], v[136:139]
v_mfma_f32_16x16x32_bf16 v[140:143], a[136:139], a[16:19], v[140:143]
ds_read_b128 a[108:111], v5 offset:39936
v_mfma_f32_16x16x32_bf16 v[164:167], a[136:139], a[20:23], v[164:167]
buffer_load_dwordx4 a[4:7], v2, s[40:43], s35 offen offset:1024 sc1
v_mfma_f32_16x16x32_bf16 v[188:191], a[136:139], a[24:27], v[188:191]
ds_read_b128 a[112:115], v5 offset:40960
v_accvgpr_write_b32 a207, v67
v_mfma_f32_16x16x32_bf16 v[212:215], a[136:139], a[28:31], v[212:215]
v_mfma_f32_16x16x32_bf16 v[216:219], a[140:143], a[28:31], v[216:219]
v_accvgpr_write_b32 a208, v68
v_mfma_f32_16x16x32_bf16 v[192:195], a[140:143], a[24:27], v[192:195]
buffer_load_dwordx4 a[8:11], v2, s[40:43], s35 offen offset:2048 sc1
v_mfma_f32_16x16x32_bf16 v[168:171], a[140:143], a[20:23], v[168:171]
ds_read_b128 a[116:119], v5 offset:41984
v_mfma_f32_16x16x32_bf16 v[144:147], a[140:143], a[16:19], v[144:147]
v_accvgpr_write_b32 a209, v69
v_mfma_f32_16x16x32_bf16 v[148:151], a[144:147], a[16:19], v[148:151]
v_mfma_f32_16x16x32_bf16 v[172:175], a[144:147], a[20:23], v[172:175]
buffer_load_dwordx4 v1, s[4:7], s44 offen offset:2048 sc1 lds
v_mfma_f32_16x16x32_bf16 v[196:199], a[144:147], a[24:27], v[196:199]
v_accvgpr_write_b32 a210, v70
v_mfma_f32_16x16x32_bf16 v[220:223], a[144:147], a[28:31], v[220:223]
v_mfma_f32_16x16x32_bf16 v[224:227], a[148:151], a[28:31], v[224:227]
v_mfma_f32_16x16x32_bf16 v[200:203], a[148:151], a[24:27], v[200:203]
buffer_load_dwordx4 a[12:15], v2, s[40:43], s35 offen offset:3072 sc1
s_add_u32 s35, s35, 4096
v_mfma_f32_16x16x32_bf16 v[176:179], a[148:151], a[20:23], v[176:179]
v_accvgpr_write_b32 a211, v71
v_mfma_f32_16x16x32_bf16 v[152:155], a[148:151], a[16:19], v[152:155]
s_waitcnt vmcnt(11) lgkmcnt(0)
v_mfma_f32_16x16x32_bf16 v[132:135], a[96:99], a[32:35], v[132:135]
ds_read_b128 a[128:131], v5 offset:43008
v_add_f32 v92, v92, v96
v_mfma_f32_16x16x32_bf16 v[156:159], a[96:99], a[36:39], v[156:159]
buffer_load_dwordx4 a[16:19], v2, s[40:43], s35 offen offset:0 sc1
v_mfma_f32_16x16x32_bf16 v[180:183], a[96:99], a[40:43], v[180:183]
ds_read_b128 a[132:135], v5 offset:44032
v_add_f32 v100, v100, v104
v_mfma_f32_16x16x32_bf16 v[204:207], a[96:99], a[44:47], v[204:207]
v_add_f32 v108, v108, v112
v_add_f32 v116, v116, v120
v_mfma_f32_16x16x32_bf16 v[208:211], a[100:103], a[44:47], v[208:211]
v_add_f32 v93, v93, v97
v_add_f32 v101, v101, v105
v_mfma_f32_16x16x32_bf16 v[184:187], a[100:103], a[40:43], v[184:187]
buffer_load_dwordx4 v1, s[4:7], s44 offen offset:3072 sc1 lds
s_add_i32 s44, s28, 8
v_mfma_f32_16x16x32_bf16 v[160:163], a[100:103], a[36:39], v[160:163]
s_lshl_b32 s45, s44, 12
s_add_u32 m0, s45, 32768
s_and_b32 s45, s44, 7
v_mfma_f32_16x16x32_bf16 v[136:139], a[100:103], a[32:35], v[136:139]
s_cmp_eq_u32 s45, s3
s_cselect_b32 s45, 8, 0
s_add_u32 s44, s44, s45
v_mfma_f32_16x16x32_bf16 v[140:143], a[104:107], a[32:35], v[140:143]
s_and_b32 s44, s44, 31
s_lshl_b32 s44, s44, 12
s_add_u32 s44, s44, s51
v_mfma_f32_16x16x32_bf16 v[164:167], a[104:107], a[36:39], v[164:167]
buffer_load_dwordx4 a[20:23], v2, s[40:43], s35 offen offset:1024 sc1
s_add_u32 s44, s44, 0x200000
v_mfma_f32_16x16x32_bf16 v[188:191], a[104:107], a[40:43], v[188:191]
ds_read_b128 a[136:139], v5 offset:45056
v_add_f32 v109, v109, v113
v_mfma_f32_16x16x32_bf16 v[212:215], a[104:107], a[44:47], v[212:215]
ds_read_b128 a[140:143], v5 offset:46080
v_add_f32 v117, v117, v121
v_mfma_f32_16x16x32_bf16 v[216:219], a[108:111], a[44:47], v[216:219]
ds_read_b128 a[144:147], v5 offset:47104
v_add_f32 v94, v94, v98
v_mfma_f32_16x16x32_bf16 v[192:195], a[108:111], a[40:43], v[192:195]
buffer_load_dwordx4 a[24:27], v2, s[40:43], s35 offen offset:2048 sc1
v_mfma_f32_16x16x32_bf16 v[168:171], a[108:111], a[36:39], v[168:171]
ds_read_b128 a[148:151], v5 offset:48128
v_add_f32 v102, v102, v106
v_mfma_f32_16x16x32_bf16 v[144:147], a[108:111], a[32:35], v[144:147]
v_add_f32 v110, v110, v114
v_add_f32 v118, v118, v122
v_mfma_f32_16x16x32_bf16 v[148:151], a[112:115], a[32:35], v[148:151]
v_add_f32 v95, v95, v99
v_add_f32 v103, v103, v107
v_mfma_f32_16x16x32_bf16 v[172:175], a[112:115], a[36:39], v[172:175]
buffer_load_dwordx4 v1, s[4:7], s44 offen offset:0 sc1 lds
v_mfma_f32_16x16x32_bf16 v[196:199], a[112:115], a[40:43], v[196:199]
v_add_f32 v111, v111, v115
v_add_f32 v119, v119, v123
v_mfma_f32_16x16x32_bf16 v[220:223], a[112:115], a[44:47], v[220:223]
v_add_f32_dpp v92, v92, v92 row_ror:8 row_mask:0xf bank_mask:0xf
v_add_f32_dpp v100, v100, v100 row_ror:8 row_mask:0xf bank_mask:0xf
v_mfma_f32_16x16x32_bf16 v[224:227], a[116:119], a[44:47], v[224:227]
v_add_f32_dpp v108, v108, v108 row_ror:8 row_mask:0xf bank_mask:0xf
v_add_f32_dpp v116, v116, v116 row_ror:8 row_mask:0xf bank_mask:0xf
v_mfma_f32_16x16x32_bf16 v[200:203], a[116:119], a[40:43], v[200:203]
buffer_load_dwordx4 a[28:31], v2, s[40:43], s35 offen offset:3072 sc1
s_add_u32 s35, s35, 4096
v_mfma_f32_16x16x32_bf16 v[176:179], a[116:119], a[36:39], v[176:179]
v_add_f32_dpp v93, v93, v93 row_ror:8 row_mask:0xf bank_mask:0xf
v_add_f32_dpp v101, v101, v101 row_ror:8 row_mask:0xf bank_mask:0xf
v_mfma_f32_16x16x32_bf16 v[152:155], a[116:119], a[32:35], v[152:155]
s_waitcnt vmcnt(12) lgkmcnt(0)
s_barrier
v_mfma_f32_16x16x32_bf16 v[132:135], a[128:131], a[48:51], v[132:135]
v_add_u32 v5, 0, v1
v_add_f32_dpp v109, v109, v109 row_ror:8 row_mask:0xf bank_mask:0xf
v_mfma_f32_16x16x32_bf16 v[156:159], a[128:131], a[52:55], v[156:159]
buffer_load_dwordx4 a[32:35], v2, s[40:43], s35 offen offset:0 sc1
v_mfma_f32_16x16x32_bf16 v[180:183], a[128:131], a[56:59], v[180:183]
ds_read_b128 a[96:99], v5 offset:0
v_add_f32_dpp v117, v117, v117 row_ror:8 row_mask:0xf bank_mask:0xf
v_mfma_f32_16x16x32_bf16 v[204:207], a[128:131], a[60:63], v[204:207]
ds_read_b128 a[100:103], v5 offset:1024
v_add_f32_dpp v92, v94, v94 row_ror:8 row_mask:0xf bank_mask:0xc
v_mfma_f32_16x16x32_bf16 v[208:211], a[132:135], a[60:63], v[208:211]
v_add_f32_dpp v100, v102, v102 row_ror:8 row_mask:0xf bank_mask:0xc
v_add_f32_dpp v108, v110, v110 row_ror:8 row_mask:0xf bank_mask:0xc
v_mfma_f32_16x16x32_bf16 v[184:187], a[132:135], a[56:59], v[184:187]
buffer_load_dwordx4 a[36:39], v2, s[40:43], s35 offen offset:1024 sc1
v_mfma_f32_16x16x32_bf16 v[160:163], a[132:135], a[52:55], v[160:163]
ds_read_b128 a[104:107], v5 offset:2048
v_add_f32_dpp v116, v118, v118 row_ror:8 row_mask:0xf bank_mask:0xc
v_mfma_f32_16x16x32_bf16 v[136:139], a[132:135], a[48:51], v[136:139]
v_add_f32_dpp v93, v95, v95 row_ror:8 row_mask:0xf bank_mask:0xc
v_add_f32_dpp v101, v103, v103 row_ror:8 row_mask:0xf bank_mask:0xc
v_mfma_f32_16x16x32_bf16 v[140:143], a[136:139], a[48:51], v[140:143]
ds_read_b128 a[108:111], v5 offset:3072
v_add_f32_dpp v109, v111, v111 row_ror:8 row_mask:0xf bank_mask:0xc
v_mfma_f32_16x16x32_bf16 v[164:167], a[136:139], a[52:55], v[164:167]
v_add_f32_dpp v117, v119, v119 row_ror:8 row_mask:0xf bank_mask:0xc
v_mfma_f32_16x16x32_bf16 v[188:191], a[136:139], a[56:59], v[188:191]
buffer_load_dwordx4 v1, s[4:7], s44 offen offset:1024 sc1 lds
v_mfma_f32_16x16x32_bf16 v[212:215], a[136:139], a[60:63], v[212:215]
ds_read_b128 a[112:115], v5 offset:4096
v_mfma_f32_16x16x32_bf16 v[216:219], a[140:143], a[60:63], v[216:219]
v_permlane32_swap_b32 v92, v93
v_mfma_f32_16x16x32_bf16 v[192:195], a[140:143], a[56:59], v[192:195]
ds_read_b128 a[116:119], v5 offset:5120
v_mfma_f32_16x16x32_bf16 v[168:171], a[140:143], a[52:55], v[168:171]
v_permlane32_swap_b32 v100, v101
v_mfma_f32_16x16x32_bf16 v[144:147], a[140:143], a[48:51], v[144:147]
buffer_load_dwordx4 a[40:43], v2, s[40:43], s35 offen offset:2048 sc1
v_mfma_f32_16x16x32_bf16 v[148:151], a[144:147], a[48:51], v[148:151]
v_permlane32_swap_b32 v108, v109
v_mfma_f32_16x16x32_bf16 v[172:175], a[144:147], a[52:55], v[172:175]
v_permlane32_swap_b32 v116, v117
v_mfma_f32_16x16x32_bf16 v[196:199], a[144:147], a[56:59], v[196:199]
v_add_f32 v92, v92, v93
v_add_f32 v100, v100, v101
v_mfma_f32_16x16x32_bf16 v[220:223], a[144:147], a[60:63], v[220:223]
v_add_f32 v108, v108, v109
v_add_f32 v116, v116, v117
v_mfma_f32_16x16x32_bf16 v[224:227], a[148:151], a[60:63], v[224:227]
buffer_load_dwordx4 a[44:47], v2, s[40:43], s35 offen offset:3072 sc1
s_add_u32 s35, s35, 4096
v_mfma_f32_16x16x32_bf16 v[200:203], a[148:151], a[56:59], v[200:203]
v_mov_b32 v94, v92
v_mov_b32 v102, v100
v_mfma_f32_16x16x32_bf16 v[176:179], a[148:151], a[52:55], v[176:179]
v_mov_b32 v110, v108
v_mov_b32 v118, v116
v_mfma_f32_16x16x32_bf16 v[152:155], a[148:151], a[48:51], v[152:155]
s_waitcnt vmcnt(11) lgkmcnt(0)
v_mfma_f32_16x16x32_bf16 v[132:135], a[96:99], a[0:3], v[132:135]
ds_read_b128 a[128:131], v5 offset:6144
v_mfma_f32_16x16x32_bf16 v[156:159], a[96:99], a[4:7], v[156:159]
buffer_load_dwordx4 a[48:51], v2, s[40:43], s35 offen offset:0 sc1
v_mfma_f32_16x16x32_bf16 v[180:183], a[96:99], a[8:11], v[180:183]
ds_read_b128 a[132:135], v5 offset:7168
v_mfma_f32_16x16x32_bf16 v[204:207], a[96:99], a[12:15], v[204:207]
v_permlane16_swap_b32 v92, v94
v_mfma_f32_16x16x32_bf16 v[208:211], a[100:103], a[12:15], v[208:211]
v_permlane16_swap_b32 v100, v102
v_mfma_f32_16x16x32_bf16 v[184:187], a[100:103], a[8:11], v[184:187]
buffer_load_dwordx4 v1, s[4:7], s44 offen offset:2048 sc1 lds
v_mfma_f32_16x16x32_bf16 v[160:163], a[100:103], a[4:7], v[160:163]
ds_read_b128 a[136:139], v5 offset:8192
v_mfma_f32_16x16x32_bf16 v[136:139], a[100:103], a[0:3], v[136:139]
v_permlane16_swap_b32 v108, v110
v_mfma_f32_16x16x32_bf16 v[140:143], a[104:107], a[0:3], v[140:143]
ds_read_b128 a[140:143], v5 offset:9216
v_mfma_f32_16x16x32_bf16 v[164:167], a[104:107], a[4:7], v[164:167]
buffer_load_dwordx4 a[52:55], v2, s[40:43], s35 offen offset:1024 sc1
v_mfma_f32_16x16x32_bf16 v[188:191], a[104:107], a[8:11], v[188:191]
ds_read_b128 a[144:147], v5 offset:10240
v_mfma_f32_16x16x32_bf16 v[212:215], a[104:107], a[12:15], v[212:215]
v_permlane16_swap_b32 v116, v118
v_mfma_f32_16x16x32_bf16 v[216:219], a[108:111], a[12:15], v[216:219]
v_add_f32 v92, v92, v94
v_add_f32 v100, v100, v102
v_mfma_f32_16x16x32_bf16 v[192:195], a[108:111], a[8:11], v[192:195]
buffer_load_dwordx4 a[56:59], v2, s[40:43], s35 offen offset:2048 sc1
v_mfma_f32_16x16x32_bf16 v[168:171], a[108:111], a[4:7], v[168:171]
ds_read_b128 a[148:151], v5 offset:11264
v_add_f32 v108, v108, v110
v_mfma_f32_16x16x32_bf16 v[144:147], a[108:111], a[0:3], v[144:147]
v_add_f32 v116, v116, v118
v_mov_b32 v94, v92
v_mfma_f32_16x16x32_bf16 v[148:151], a[112:115], a[0:3], v[148:151]
v_mov_b32 v102, v100
v_mov_b32 v110, v108
v_mfma_f32_16x16x32_bf16 v[172:175], a[112:115], a[4:7], v[172:175]
buffer_load_dwordx4 v1, s[4:7], s44 offen offset:3072 sc1 lds
s_add_i32 s44, s28, 12
v_mfma_f32_16x16x32_bf16 v[196:199], a[112:115], a[8:11], v[196:199]
s_lshl_b32 s45, s44, 12
s_add_u32 m0, s45, 32768
s_and_b32 s45, s44, 7
v_mfma_f32_16x16x32_bf16 v[220:223], a[112:115], a[12:15], v[220:223]
s_cmp_eq_u32 s45, s3
s_cselect_b32 s45, 8, 0
s_add_u32 s44, s44, s45
v_mfma_f32_16x16x32_bf16 v[224:227], a[116:119], a[12:15], v[224:227]
s_and_b32 s44, s44, 31
s_lshl_b32 s44, s44, 12
s_add_u32 s44, s44, s51
v_mfma_f32_16x16x32_bf16 v[200:203], a[116:119], a[8:11], v[200:203]
buffer_load_dwordx4 a[60:63], v2, s[40:43], s35 offen offset:3072 sc1
s_add_u32 s35, s35, 4096
v_mfma_f32_16x16x32_bf16 v[176:179], a[116:119], a[4:7], v[176:179]
s_add_u32 s44, s44, 0x200000
v_mov_b32 v118, v116
v_mfma_f32_16x16x32_bf16 v[152:155], a[116:119], a[0:3], v[152:155]
s_waitcnt vmcnt(11) lgkmcnt(0)
v_mfma_f32_16x16x32_bf16 v[132:135], a[128:131], a[16:19], v[132:135]
ds_read_b128 a[96:99], v5 offset:12288
v_mfma_f32_16x16x32_bf16 v[156:159], a[128:131], a[20:23], v[156:159]
buffer_load_dwordx4 a[0:3], v2, s[40:43], s35 offen offset:0 sc1
v_mfma_f32_16x16x32_bf16 v[180:183], a[128:131], a[24:27], v[180:183]
ds_read_b128 a[100:103], v5 offset:13312
v_mfma_f32_16x16x32_bf16 v[204:207], a[128:131], a[28:31], v[204:207]
v_permlane32_swap_b32 v92, v94
v_mfma_f32_16x16x32_bf16 v[208:211], a[132:135], a[28:31], v[208:211]
v_permlane32_swap_b32 v100, v102
v_mfma_f32_16x16x32_bf16 v[184:187], a[132:135], a[24:27], v[184:187]
buffer_load_dwordx4 v1, s[4:7], s44 offen offset:0 sc1 lds
v_mfma_f32_16x16x32_bf16 v[160:163], a[132:135], a[20:23], v[160:163]
ds_read_b128 a[104:107], v5 offset:14336
v_mfma_f32_16x16x32_bf16 v[136:139], a[132:135], a[16:19], v[136:139]
v_permlane32_swap_b32 v108, v110
v_mfma_f32_16x16x32_bf16 v[140:143], a[136:139], a[16:19], v[140:143]
ds_read_b128 a[108:111], v5 offset:15360
v_mfma_f32_16x16x32_bf16 v[164:167], a[136:139], a[20:23], v[164:167]
buffer_load_dwordx4 a[4:7], v2, s[40:43], s35 offen offset:1024 sc1
v_mfma_f32_16x16x32_bf16 v[188:191], a[136:139], a[24:27], v[188:191]
ds_read_b128 a[112:115], v5 offset:16384
v_mfma_f32_16x16x32_bf16 v[212:215], a[136:139], a[28:31], v[212:215]
v_permlane32_swap_b32 v116, v118
v_mfma_f32_16x16x32_bf16 v[216:219], a[140:143], a[28:31], v[216:219]
v_mul_f32 v82, 0xba800000, v92
v_mul_f32 v84, 0xba800000, v100
v_mfma_f32_16x16x32_bf16 v[192:195], a[140:143], a[24:27], v[192:195]
buffer_load_dwordx4 a[8:11], v2, s[40:43], s35 offen offset:2048 sc1
v_mfma_f32_16x16x32_bf16 v[168:171], a[140:143], a[20:23], v[168:171]
ds_read_b128 a[116:119], v5 offset:17408
v_mul_f32 v86, 0xba800000, v108
v_mfma_f32_16x16x32_bf16 v[144:147], a[140:143], a[16:19], v[144:147]
v_mul_f32 v88, 0xba800000, v116
v_mul_f32 v94, 0x3a800000, v94
v_mfma_f32_16x16x32_bf16 v[148:151], a[144:147], a[16:19], v[148:151]
v_mul_f32 v102, 0x3a800000, v102
v_mul_f32 v110, 0x3a800000, v110
v_mfma_f32_16x16x32_bf16 v[172:175], a[144:147], a[20:23], v[172:175]
buffer_load_dwordx4 v1, s[4:7], s44 offen offset:1024 sc1 lds
v_mfma_f32_16x16x32_bf16 v[196:199], a[144:147], a[24:27], v[196:199]
v_mul_f32 v118, 0x3a800000, v118
v_fma_f32 v94, -v82, v82, v94
v_mfma_f32_16x16x32_bf16 v[220:223], a[144:147], a[28:31], v[220:223]
v_fma_f32 v102, -v84, v84, v102
v_fma_f32 v110, -v86, v86, v110
v_mfma_f32_16x16x32_bf16 v[224:227], a[148:151], a[28:31], v[224:227]
v_fma_f32 v118, -v88, v88, v118
v_max_f32 v94, 0, v94
v_mfma_f32_16x16x32_bf16 v[200:203], a[148:151], a[24:27], v[200:203]
buffer_load_dwordx4 a[12:15], v2, s[40:43], s35 offen offset:3072 sc1
s_add_u32 s35, s35, 4096
v_mfma_f32_16x16x32_bf16 v[176:179], a[148:151], a[20:23], v[176:179]
v_max_f32 v102, 0, v102
v_max_f32 v110, 0, v110
v_mfma_f32_16x16x32_bf16 v[152:155], a[148:151], a[16:19], v[152:155]
v_max_f32 v118, 0, v118
s_waitcnt vmcnt(12) lgkmcnt(0)
v_mfma_f32_16x16x32_bf16 v[132:135], a[96:99], a[32:35], v[132:135]
ds_read_b128 a[128:131], v5 offset:18432
v_add_f32 v94, 0x3727c5ac, v94
v_mfma_f32_16x16x32_bf16 v[156:159], a[96:99], a[36:39], v[156:159]
buffer_load_dwordx4 a[16:19], v2, s[40:43], s35 offen offset:0 sc1
v_mfma_f32_16x16x32_bf16 v[180:183], a[96:99], a[40:43], v[180:183]
ds_read_b128 a[132:135], v5 offset:19456
v_add_f32 v102, 0x3727c5ac, v102
v_mfma_f32_16x16x32_bf16 v[204:207], a[96:99], a[44:47], v[204:207]
v_add_f32 v110, 0x3727c5ac, v110
v_add_f32 v118, 0x3727c5ac, v118
v_mfma_f32_16x16x32_bf16 v[208:211], a[100:103], a[44:47], v[208:211]
v_rsq_f32 v83, v94
v_mfma_f32_16x16x32_bf16 v[184:187], a[100:103], a[40:43], v[184:187]
buffer_load_dwordx4 a[20:23], v2, s[40:43], s35 offen offset:1024 sc1
v_mfma_f32_16x16x32_bf16 v[160:163], a[100:103], a[36:39], v[160:163]
ds_read_b128 a[136:139], v5 offset:20480
v_mfma_f32_16x16x32_bf16 v[136:139], a[100:103], a[32:35], v[136:139]
v_rsq_f32 v85, v102
v_rsq_f32 v87, v110
v_rsq_f32 v89, v118
v_mfma_f32_16x16x32_bf16 v[140:143], a[104:107], a[32:35], v[140:143]
ds_read_b128 a[140:143], v5 offset:21504
v_mfma_f32_16x16x32_bf16 v[164:167], a[104:107], a[36:39], v[164:167]
v_fmac_f32 v132, v48, v82
v_mfma_f32_16x16x32_bf16 v[188:191], a[104:107], a[40:43], v[188:191]
buffer_load_dwordx4 v1, s[4:7], s44 offen offset:2048 sc1 lds
v_mfma_f32_16x16x32_bf16 v[212:215], a[104:107], a[44:47], v[212:215]
ds_read_b128 a[144:147], v5 offset:22528
v_fmac_f32 v156, v48, v84
v_mfma_f32_16x16x32_bf16 v[216:219], a[108:111], a[44:47], v[216:219]
v_fmac_f32 v180, v48, v86
v_fmac_f32 v204, v48, v88
v_mfma_f32_16x16x32_bf16 v[192:195], a[108:111], a[40:43], v[192:195]
ds_read_b128 a[148:151], v5 offset:23552
v_fmac_f32 v208, v52, v88
v_mfma_f32_16x16x32_bf16 v[168:171], a[108:111], a[36:39], v[168:171]
v_fmac_f32 v184, v52, v86
v_mfma_f32_16x16x32_bf16 v[144:147], a[108:111], a[32:35], v[144:147]
buffer_load_dwordx4 a[24:27], v2, s[40:43], s35 offen offset:2048 sc1
v_mfma_f32_16x16x32_bf16 v[148:151], a[112:115], a[32:35], v[148:151]
v_fmac_f32 v160, v52, v84
v_fmac_f32 v136, v52, v82
v_mfma_f32_16x16x32_bf16 v[172:175], a[112:115], a[36:39], v[172:175]
v_fmac_f32 v140, v56, v82
v_mfma_f32_16x16x32_bf16 v[196:199], a[112:115], a[40:43], v[196:199]
v_fmac_f32 v164, v56, v84
v_mfma_f32_16x16x32_bf16 v[220:223], a[112:115], a[44:47], v[220:223]
v_fmac_f32 v188, v56, v86
v_mfma_f32_16x16x32_bf16 v[224:227], a[116:119], a[44:47], v[224:227]
buffer_load_dwordx4 a[28:31], v2, s[40:43], s35 offen offset:3072 sc1
s_add_u32 s35, s35, 4096
v_mfma_f32_16x16x32_bf16 v[200:203], a[116:119], a[40:43], v[200:203]
v_fmac_f32 v212, v56, v88
v_fmac_f32 v216, v60, v88
v_mfma_f32_16x16x32_bf16 v[176:179], a[116:119], a[36:39], v[176:179]
v_fmac_f32 v192, v60, v86
v_mfma_f32_16x16x32_bf16 v[152:155], a[116:119], a[32:35], v[152:155]
v_fmac_f32 v168, v60, v84
s_waitcnt vmcnt(11) lgkmcnt(0)
v_mfma_f32_16x16x32_bf16 v[132:135], a[128:131], a[48:51], v[132:135]
ds_read_b128 a[96:99], v5 offset:24576
v_fmac_f32 v144, v60, v82
v_mfma_f32_16x16x32_bf16 v[156:159], a[128:131], a[52:55], v[156:159]
buffer_load_dwordx4 a[32:35], v2, s[40:43], s35 offen offset:0 sc1
v_mfma_f32_16x16x32_bf16 v[180:183], a[128:131], a[56:59], v[180:183]
ds_read_b128 a[100:103], v5 offset:25600
v_fmac_f32 v148, v64, v82
v_mfma_f32_16x16x32_bf16 v[204:207], a[128:131], a[60:63], v[204:207]
v_fmac_f32 v172, v64, v84
v_fmac_f32 v196, v64, v86
v_mfma_f32_16x16x32_bf16 v[208:211], a[132:135], a[60:63], v[208:211]
v_fmac_f32 v220, v64, v88
v_mfma_f32_16x16x32_bf16 v[184:187], a[132:135], a[56:59], v[184:187]
buffer_load_dwordx4 v1, s[4:7], s44 offen offset:3072 sc1 lds
s_add_i32 s44, s28, 28
v_mfma_f32_16x16x32_bf16 v[160:163], a[132:135], a[52:55], v[160:163]
s_lshl_b32 s45, s44, 12
s_add_u32 m0, s45, 32768
s_and_b32 s45, s44, 7
v_mfma_f32_16x16x32_bf16 v[136:139], a[132:135], a[48:51], v[136:139]
s_cmp_eq_u32 s45, s3
s_cselect_b32 s45, 8, 0
s_add_u32 s44, s44, s45
v_mfma_f32_16x16x32_bf16 v[140:143], a[136:139], a[48:51], v[140:143]
s_and_b32 s44, s44, 31
s_lshl_b32 s44, s44, 12
s_add_u32 s44, s44, s51
v_mfma_f32_16x16x32_bf16 v[164:167], a[136:139], a[52:55], v[164:167]
buffer_load_dwordx4 a[36:39], v2, s[40:43], s35 offen offset:1024 sc1
s_add_u32 s44, s44, 0x200000
v_mfma_f32_16x16x32_bf16 v[188:191], a[136:139], a[56:59], v[188:191]
ds_read_b128 a[104:107], v5 offset:26624
v_fmac_f32 v224, v68, v88
v_mfma_f32_16x16x32_bf16 v[212:215], a[136:139], a[60:63], v[212:215]
ds_read_b128 a[108:111], v5 offset:27648
v_fmac_f32 v200, v68, v86
v_mfma_f32_16x16x32_bf16 v[216:219], a[140:143], a[60:63], v[216:219]
ds_read_b128 a[112:115], v5 offset:28672
v_fmac_f32 v176, v68, v84
v_mfma_f32_16x16x32_bf16 v[192:195], a[140:143], a[56:59], v[192:195]
buffer_load_dwordx4 a[40:43], v2, s[40:43], s35 offen offset:2048 sc1
v_mfma_f32_16x16x32_bf16 v[168:171], a[140:143], a[52:55], v[168:171]
ds_read_b128 a[116:119], v5 offset:29696
v_fmac_f32 v152, v68, v82
v_mfma_f32_16x16x32_bf16 v[144:147], a[140:143], a[48:51], v[144:147]
v_fmac_f32 v133, v49, v82
v_fmac_f32 v157, v49, v84
v_mfma_f32_16x16x32_bf16 v[148:151], a[144:147], a[48:51], v[148:151]
v_fmac_f32 v181, v49, v86
v_fmac_f32 v205, v49, v88
v_mfma_f32_16x16x32_bf16 v[172:175], a[144:147], a[52:55], v[172:175]
buffer_load_dwordx4 v1, s[4:7], s44 offen offset:0 sc1 lds
v_mfma_f32_16x16x32_bf16 v[196:199], a[144:147], a[56:59], v[196:199]
v_fmac_f32 v209, v53, v88
v_fmac_f32 v185, v53, v86
v_mfma_f32_16x16x32_bf16 v[220:223], a[144:147], a[60:63], v[220:223]
v_fmac_f32 v161, v53, v84
v_fmac_f32 v137, v53, v82
v_mfma_f32_16x16x32_bf16 v[224:227], a[148:151], a[60:63], v[224:227]
v_fmac_f32 v141, v57, v82
v_fmac_f32 v165, v57, v84
v_mfma_f32_16x16x32_bf16 v[200:203], a[148:151], a[56:59], v[200:203]
buffer_load_dwordx4 a[44:47], v2, s[40:43], s35 offen offset:3072 sc1
s_add_u32 s35, s35, 4096
v_mfma_f32_16x16x32_bf16 v[176:179], a[148:151], a[52:55], v[176:179]
v_fmac_f32 v189, v57, v86
v_fmac_f32 v213, v57, v88
v_mfma_f32_16x16x32_bf16 v[152:155], a[148:151], a[48:51], v[152:155]
v_fmac_f32 v217, v61, v88
s_waitcnt vmcnt(11) lgkmcnt(0)
v_mfma_f32_16x16x32_bf16 v[132:135], a[96:99], a[0:3], v[132:135]
ds_read_b128 a[128:131], v5 offset:30720
v_fmac_f32 v193, v61, v86
v_mfma_f32_16x16x32_bf16 v[156:159], a[96:99], a[4:7], v[156:159]
buffer_load_dwordx4 a[48:51], v2, s[40:43], s35 offen offset:0 sc1
v_mfma_f32_16x16x32_bf16 v[180:183], a[96:99], a[8:11], v[180:183]
ds_read_b128 a[132:135], v5 offset:31744
v_fmac_f32 v169, v61, v84
v_mfma_f32_16x16x32_bf16 v[204:207], a[96:99], a[12:15], v[204:207]
v_fmac_f32 v145, v61, v82
v_fmac_f32 v149, v65, v82
v_mfma_f32_16x16x32_bf16 v[208:211], a[100:103], a[12:15], v[208:211]
v_fmac_f32 v173, v65, v84
v_fmac_f32 v197, v65, v86
v_mfma_f32_16x16x32_bf16 v[184:187], a[100:103], a[8:11], v[184:187]
buffer_load_dwordx4 v1, s[4:7], s44 offen offset:1024 sc1 lds
v_mfma_f32_16x16x32_bf16 v[160:163], a[100:103], a[4:7], v[160:163]
ds_read_b128 a[136:139], v5 offset:32768
v_fmac_f32 v221, v65, v88
v_mfma_f32_16x16x32_bf16 v[136:139], a[100:103], a[0:3], v[136:139]
v_fmac_f32 v225, v69, v88
v_fmac_f32 v201, v69, v86
v_mfma_f32_16x16x32_bf16 v[140:143], a[104:107], a[0:3], v[140:143]
ds_read_b128 a[140:143], v5 offset:33792
v_fmac_f32 v177, v69, v84
v_mfma_f32_16x16x32_bf16 v[164:167], a[104:107], a[4:7], v[164:167]
buffer_load_dwordx4 a[52:55], v2, s[40:43], s35 offen offset:1024 sc1
v_mfma_f32_16x16x32_bf16 v[188:191], a[104:107], a[8:11], v[188:191]
ds_read_b128 a[144:147], v5 offset:34816
v_fmac_f32 v153, v69, v82
v_mfma_f32_16x16x32_bf16 v[212:215], a[104:107], a[12:15], v[212:215]
v_fmac_f32 v134, v50, v82
v_fmac_f32 v158, v50, v84
v_mfma_f32_16x16x32_bf16 v[216:219], a[108:111], a[12:15], v[216:219]
v_fmac_f32 v182, v50, v86
v_fmac_f32 v206, v50, v88
v_mfma_f32_16x16x32_bf16 v[192:195], a[108:111], a[8:11], v[192:195]
buffer_load_dwordx4 a[56:59], v2, s[40:43], s35 offen offset:2048 sc1
v_mfma_f32_16x16x32_bf16 v[168:171], a[108:111], a[4:7], v[168:171]
ds_read_b128 a[148:151], v5 offset:35840
v_fmac_f32 v210, v54, v88
v_mfma_f32_16x16x32_bf16 v[144:147], a[108:111], a[0:3], v[144:147]
v_fmac_f32 v186, v54, v86
v_fmac_f32 v162, v54, v84
v_mfma_f32_16x16x32_bf16 v[148:151], a[112:115], a[0:3], v[148:151]
v_fmac_f32 v138, v54, v82
v_mfma_f32_16x16x32_bf16 v[172:175], a[112:115], a[4:7], v[172:175]
buffer_load_dwordx4 v1, s[4:7], s44 offen offset:2048 sc1 lds
v_mfma_f32_16x16x32_bf16 v[196:199], a[112:115], a[8:11], v[196:199]
v_fmac_f32 v142, v58, v82
v_fmac_f32 v166, v58, v84
v_mfma_f32_16x16x32_bf16 v[220:223], a[112:115], a[12:15], v[220:223]
v_fmac_f32 v190, v58, v86
v_mfma_f32_16x16x32_bf16 v[224:227], a[116:119], a[12:15], v[224:227]
v_fmac_f32 v214, v58, v88
v_mfma_f32_16x16x32_bf16 v[200:203], a[116:119], a[8:11], v[200:203]
buffer_load_dwordx4 a[60:63], v2, s[40:43], s35 offen offset:3072 sc1
s_add_u32 s35, s35, 4096
v_mfma_f32_16x16x32_bf16 v[176:179], a[116:119], a[4:7], v[176:179]
v_fmac_f32 v218, v62, v88
v_fmac_f32 v194, v62, v86
v_mfma_f32_16x16x32_bf16 v[152:155], a[116:119], a[0:3], v[152:155]
v_fmac_f32 v170, v62, v84
s_waitcnt vmcnt(12) lgkmcnt(0)
v_mfma_f32_16x16x32_bf16 v[132:135], a[128:131], a[16:19], v[132:135]
ds_read_b128 a[96:99], v5 offset:36864
v_fmac_f32 v146, v62, v82
v_mfma_f32_16x16x32_bf16 v[156:159], a[128:131], a[20:23], v[156:159]
buffer_load_dwordx4 v1, s[4:7], s44 offen offset:3072 sc1 lds
s_add_i32 s44, s28, 16
v_mfma_f32_16x16x32_bf16 v[180:183], a[128:131], a[24:27], v[180:183]
s_lshl_b32 s45, s44, 12
s_add_u32 m0, s45, 32768
s_and_b32 s45, s44, 7
v_mfma_f32_16x16x32_bf16 v[204:207], a[128:131], a[28:31], v[204:207]
s_cmp_eq_u32 s45, s3
s_cselect_b32 s45, 8, 0
s_add_u32 s44, s44, s45
v_mfma_f32_16x16x32_bf16 v[208:211], a[132:135], a[28:31], v[208:211]
s_and_b32 s44, s44, 31
s_lshl_b32 s44, s44, 12
s_add_u32 s44, s44, s51
s_add_u32 s44, s44, 0x200000
v_mfma_f32_16x16x32_bf16 v[184:187], a[132:135], a[24:27], v[184:187]
buffer_load_dwordx4 v1, s[4:7], s44 offen offset:0 sc1 lds
L_stub7:
s_cbranch_execz L_stub8
v_mfma_f32_16x16x32_bf16 v[160:163], a[132:135], a[20:23], v[160:163]
ds_read_b128 a[100:103], v5 offset:37888
v_fmac_f32 v150, v66, v82
v_mfma_f32_16x16x32_bf16 v[136:139], a[132:135], a[16:19], v[136:139]
ds_read_b128 a[104:107], v5 offset:38912
v_fmac_f32 v174, v66, v84
v_mfma_f32_16x16x32_bf16 v[140:143], a[136:139], a[16:19], v[140:143]
ds_read_b128 a[108:111], v5 offset:39936
v_fmac_f32 v198, v66, v86
v_mfma_f32_16x16x32_bf16 v[164:167], a[136:139], a[20:23], v[164:167]
v_fmac_f32 v222, v66, v88
v_fmac_f32 v226, v70, v88
v_mfma_f32_16x16x32_bf16 v[188:191], a[136:139], a[24:27], v[188:191]
buffer_load_dwordx4 v1, s[4:7], s44 offen offset:1024 sc1 lds
v_mfma_f32_16x16x32_bf16 v[212:215], a[136:139], a[28:31], v[212:215]
ds_read_b128 a[112:115], v5 offset:40960
v_fmac_f32 v202, v70, v86
v_mfma_f32_16x16x32_bf16 v[216:219], a[140:143], a[28:31], v[216:219]
v_fmac_f32 v178, v70, v84
v_fmac_f32 v154, v70, v82
v_mfma_f32_16x16x32_bf16 v[192:195], a[140:143], a[24:27], v[192:195]
ds_read_b128 a[116:119], v5 offset:41984
v_fmac_f32 v135, v51, v82
v_mfma_f32_16x16x32_bf16 v[168:171], a[140:143], a[20:23], v[168:171]
v_fmac_f32 v159, v51, v84
v_fmac_f32 v183, v51, v86
v_mfma_f32_16x16x32_bf16 v[144:147], a[140:143], a[16:19], v[144:147]
buffer_load_dwordx4 v1, s[4:7], s44 offen offset:2048 sc1 lds
v_mfma_f32_16x16x32_bf16 v[148:151], a[144:147], a[16:19], v[148:151]
v_fmac_f32 v207, v51, v88
v_fmac_f32 v211, v55, v88
v_mfma_f32_16x16x32_bf16 v[172:175], a[144:147], a[20:23], v[172:175]
v_fmac_f32 v187, v55, v86
v_fmac_f32 v163, v55, v84
v_mfma_f32_16x16x32_bf16 v[196:199], a[144:147], a[24:27], v[196:199]
v_fmac_f32 v139, v55, v82
v_fmac_f32 v143, v59, v82
v_mfma_f32_16x16x32_bf16 v[220:223], a[144:147], a[28:31], v[220:223]
v_fmac_f32 v167, v59, v84
v_fmac_f32 v191, v59, v86
v_mfma_f32_16x16x32_bf16 v[224:227], a[148:151], a[28:31], v[224:227]
buffer_load_dwordx4 v1, s[4:7], s44 offen offset:3072 sc1 lds
s_add_i32 s44, s28, 20
v_mfma_f32_16x16x32_bf16 v[200:203], a[148:151], a[24:27], v[200:203]
s_lshl_b32 s45, s44, 12
s_add_u32 m0, s45, 32768
s_and_b32 s45, s44, 7
v_mfma_f32_16x16x32_bf16 v[176:179], a[148:151], a[20:23], v[176:179]
s_cmp_eq_u32 s45, s3
s_cselect_b32 s45, 8, 0
s_add_u32 s44, s44, s45
v_mfma_f32_16x16x32_bf16 v[152:155], a[148:151], a[16:19], v[152:155]
s_and_b32 s44, s44, 31
s_waitcnt vmcnt(11) lgkmcnt(0)
v_mfma_f32_16x16x32_bf16 v[132:135], a[96:99], a[32:35], v[132:135]
s_lshl_b32 s44, s44, 12
s_add_u32 s44, s44, s51
s_add_u32 s44, s44, 0x200000
v_mfma_f32_16x16x32_bf16 v[156:159], a[96:99], a[36:39], v[156:159]
buffer_load_dwordx4 v1, s[4:7], s44 offen offset:0 sc1 lds
v_mfma_f32_16x16x32_bf16 v[180:183], a[96:99], a[40:43], v[180:183]
ds_read_b128 a[128:131], v5 offset:43008
v_fmac_f32 v215, v59, v88
v_mfma_f32_16x16x32_bf16 v[204:207], a[96:99], a[44:47], v[204:207]
ds_read_b128 a[132:135], v5 offset:44032
v_fmac_f32 v219, v63, v88
v_mfma_f32_16x16x32_bf16 v[208:211], a[100:103], a[44:47], v[208:211]
v_fmac_f32 v195, v63, v86
v_fmac_f32 v171, v63, v84
v_mfma_f32_16x16x32_bf16 v[184:187], a[100:103], a[40:43], v[184:187]
buffer_load_dwordx4 v1, s[4:7], s44 offen offset:1024 sc1 lds
v_mfma_f32_16x16x32_bf16 v[160:163], a[100:103], a[36:39], v[160:163]
ds_read_b128 a[136:139], v5 offset:45056
v_fmac_f32 v147, v63, v82
v_mfma_f32_16x16x32_bf16 v[136:139], a[100:103], a[32:35], v[136:139]
v_fmac_f32 v151, v67, v82
v_fmac_f32 v175, v67, v84
v_mfma_f32_16x16x32_bf16 v[140:143], a[104:107], a[32:35], v[140:143]
ds_read_b128 a[140:143], v5 offset:46080
v_fmac_f32 v199, v67, v86
v_mfma_f32_16x16x32_bf16 v[164:167], a[104:107], a[36:39], v[164:167]
buffer_load_dwordx4 v1, s[4:7], s44 offen offset:2048 sc1 lds
v_mfma_f32_16x16x32_bf16 v[188:191], a[104:107], a[40:43], v[188:191]
ds_read_b128 a[144:147], v5 offset:47104
v_fmac_f32 v223, v67, v88
v_mfma_f32_16x16x32_bf16 v[212:215], a[104:107], a[44:47], v[212:215]
v_fmac_f32 v227, v71, v88
v_fmac_f32 v203, v71, v86
v_mfma_f32_16x16x32_bf16 v[216:219], a[108:111], a[44:47], v[216:219]
v_fmac_f32 v179, v71, v84
v_fmac_f32 v155, v71, v82
v_mfma_f32_16x16x32_bf16 v[192:195], a[108:111], a[40:43], v[192:195]
buffer_load_dwordx4 v1, s[4:7], s44 offen offset:3072 sc1 lds
s_add_i32 s44, s28, 24
v_mfma_f32_16x16x32_bf16 v[168:171], a[108:111], a[36:39], v[168:171]
s_lshl_b32 s45, s44, 12
s_add_u32 m0, s45, 32768
s_and_b32 s45, s44, 7
v_mfma_f32_16x16x32_bf16 v[144:147], a[108:111], a[32:35], v[144:147]
s_cmp_eq_u32 s45, s3
s_cselect_b32 s45, 8, 0
s_add_u32 s44, s44, s45
v_mfma_f32_16x16x32_bf16 v[148:151], a[112:115], a[32:35], v[148:151]
s_and_b32 s44, s44, 31
s_lshl_b32 s44, s44, 12
s_add_u32 s44, s44, s51
s_add_u32 s44, s44, 0x200000
v_mfma_f32_16x16x32_bf16 v[172:175], a[112:115], a[36:39], v[172:175]
buffer_load_dwordx4 v1, s[4:7], s44 offen offset:0 sc1 lds
v_mfma_f32_16x16x32_bf16 v[196:199], a[112:115], a[40:43], v[196:199]
ds_read_b128 a[148:151], v5 offset:48128
v_mfma_f32_16x16x32_bf16 v[220:223], a[112:115], a[44:47], v[220:223]
v_mfma_f32_16x16x32_bf16 v[224:227], a[116:119], a[44:47], v[224:227]
v_mfma_f32_16x16x32_bf16 v[200:203], a[116:119], a[40:43], v[200:203]
buffer_load_dwordx4 v1, s[4:7], s44 offen offset:1024 sc1 lds
v_mfma_f32_16x16x32_bf16 v[176:179], a[116:119], a[36:39], v[176:179]
v_mfma_f32_16x16x32_bf16 v[152:155], a[116:119], a[32:35], v[152:155]
s_waitcnt vmcnt(11) lgkmcnt(0)
s_barrier
v_mfma_f32_16x16x32_bf16 v[132:135], a[128:131], a[48:51], v[132:135]
v_mfma_f32_16x16x32_bf16 v[156:159], a[128:131], a[52:55], v[156:159]
buffer_load_dwordx4 v1, s[4:7], s44 offen offset:2048 sc1 lds
v_mfma_f32_16x16x32_bf16 v[180:183], a[128:131], a[56:59], v[180:183]
v_mfma_f32_16x16x32_bf16 v[204:207], a[128:131], a[60:63], v[204:207]
v_mfma_f32_16x16x32_bf16 v[208:211], a[132:135], a[60:63], v[208:211]
v_mfma_f32_16x16x32_bf16 v[184:187], a[132:135], a[56:59], v[184:187]
v_mfma_f32_16x16x32_bf16 v[160:163], a[132:135], a[52:55], v[160:163]
v_mfma_f32_16x16x32_bf16 v[136:139], a[132:135], a[48:51], v[136:139]
v_mfma_f32_16x16x32_bf16 v[140:143], a[136:139], a[48:51], v[140:143]
v_mfma_f32_16x16x32_bf16 v[164:167], a[136:139], a[52:55], v[164:167]
v_mfma_f32_16x16x32_bf16 v[188:191], a[136:139], a[56:59], v[188:191]
v_mfma_f32_16x16x32_bf16 v[212:215], a[136:139], a[60:63], v[212:215]
v_mfma_f32_16x16x32_bf16 v[216:219], a[140:143], a[60:63], v[216:219]
v_mfma_f32_16x16x32_bf16 v[192:195], a[140:143], a[56:59], v[192:195]
buffer_load_dwordx4 v1, s[4:7], s44 offen offset:3072 sc1 lds
v_mfma_f32_16x16x32_bf16 v[168:171], a[140:143], a[52:55], v[168:171]
v_mfma_f32_16x16x32_bf16 v[144:147], a[140:143], a[48:51], v[144:147]
v_mfma_f32_16x16x32_bf16 v[148:151], a[144:147], a[48:51], v[148:151]
v_mfma_f32_16x16x32_bf16 v[172:175], a[144:147], a[52:55], v[172:175]
v_mfma_f32_16x16x32_bf16 v[196:199], a[144:147], a[56:59], v[196:199]
v_mfma_f32_16x16x32_bf16 v[220:223], a[144:147], a[60:63], v[220:223]
v_mfma_f32_16x16x32_bf16 v[224:227], a[148:151], a[60:63], v[224:227]
v_mfma_f32_16x16x32_bf16 v[200:203], a[148:151], a[56:59], v[200:203]
v_mfma_f32_16x16x32_bf16 v[176:179], a[148:151], a[52:55], v[176:179]
v_mfma_f32_16x16x32_bf16 v[152:155], a[148:151], a[48:51], v[152:155]
.set L_cpf1, .
v_cvt_pk_bf16_f32 v140, v140, v141
v_cvt_pk_bf16_f32 v164, v164, v165
v_cvt_pk_bf16_f32 v141, v142, v143
v_cvt_pk_bf16_f32 v165, v166, v167
v_cvt_pk_bf16_f32 v142, v144, v145
v_cvt_pk_bf16_f32 v143, v146, v147
v_cvt_pk_bf16_f32 v166, v168, v169
v_cvt_pk_bf16_f32 v167, v170, v171
v_mfma_f32_16x16x32_bf16 v[92:95], a[232:235], v[140:143], 0
v_mul_f32 v240, 0x3fb8aa3b, v83
v_mul_f32 v246, 0x3fb8aa3b, v85
v_mfma_f32_16x16x32_bf16 v[108:111], a[232:235], v[164:167], 0
v_cvt_pk_bf16_f32 v188, v188, v189
v_cvt_pk_bf16_f32 v212, v212, v213
v_mfma_f32_16x16x32_bf16 v[96:99], a[236:239], v[140:143], 0
s_nop 1
v_max3_f32 v236, v92, v93, v94
v_max3_f32 v237, -v92, -v93, -v94
v_mfma_f32_16x16x32_bf16 v[112:115], a[236:239], v[164:167], 0
v_max3_f32 v242, v108, v109, v110
v_max3_f32 v243, -v108, -v109, -v110
v_cvt_pk_bf16_f32 v189, v190, v191
v_cvt_pk_bf16_f32 v213, v214, v215
v_max3_f32 v236, v236, v95, v96
v_max3_f32 v237, v237, -v95, -v96
v_max3_f32 v236, v236, v97, v98
v_max3_f32 v237, v237, -v97, -v98
v_max3_f32 v242, v242, v111, v112
v_max3_f32 v243, v243, -v111, -v112
v_max3_f32 v242, v242, v113, v114
v_max3_f32 v243, v243, -v113, -v114
v_max_f32 v236, v236, v99
v_max_f32_e64 v237, v237, -v99
v_max_f32 v242, v242, v115
v_max_f32_e64 v243, v243, -v115
v_permlane32_swap_b32 v236, v237
s_nop 0
v_permlane32_swap_b32 v242, v243
v_max_f32 v236, v236, v237
v_max_f32 v242, v242, v243
v_mov_b32 v238, v236
v_mov_b32 v244, v242
v_pk_mul_f32 v[148:149], v[148:149], v[82:83] op_sel:[0,1] op_sel_hi:[1,1]
v_permlane16_swap_b32 v236, v238
v_permlane16_swap_b32 v242, v244
v_max_f32 v236, v236, v238
v_max_f32 v242, v242, v244
v_mov_b32 v238, v236
v_mov_b32 v244, v242
v_pk_mul_f32 v[172:173], v[172:173], v[84:85] op_sel:[0,1] op_sel_hi:[1,1]
v_permlane32_swap_b32 v236, v238
v_permlane32_swap_b32 v242, v244
v_mul_f32_e64 v236, -v236, v240
v_mul_f32_e64 v237, -v238, v240
v_mul_f32_e64 v242, -v242, v246
v_mul_f32_e64 v243, -v244, v246
v_pk_fma_f32 v[100:101], v[92:93], v[240:241], v[236:237] op_sel:[0,0,0] op_sel_hi:[1,0,0]
v_pk_fma_f32 v[102:103], v[94:95], v[240:241], v[236:237] op_sel:[0,0,0] op_sel_hi:[1,0,0]
v_pk_fma_f32 v[104:105], v[96:97], v[240:241], v[236:237] op_sel:[0,0,0] op_sel_hi:[1,0,0]
v_pk_fma_f32 v[106:107], v[98:99], v[240:241], v[236:237] op_sel:[0,0,0] op_sel_hi:[1,0,0]
v_pk_fma_f32 v[116:117], v[108:109], v[246:247], v[242:243] op_sel:[0,0,0] op_sel_hi:[1,0,0]
v_pk_fma_f32 v[118:119], v[110:111], v[246:247], v[242:243] op_sel:[0,0,0] op_sel_hi:[1,0,0]
v_pk_fma_f32 v[120:121], v[112:113], v[246:247], v[242:243] op_sel:[0,0,0] op_sel_hi:[1,0,0]
v_pk_fma_f32 v[122:123], v[114:115], v[246:247], v[242:243] op_sel:[0,0,0] op_sel_hi:[1,0,0]
v_pk_fma_f32 v[92:93], v[92:93], v[240:241], v[236:237] op_sel:[0,0,1] op_sel_hi:[1,0,1] neg_lo:[1,0,0] neg_hi:[1,0,0]
v_pk_fma_f32 v[94:95], v[94:95], v[240:241], v[236:237] op_sel:[0,0,1] op_sel_hi:[1,0,1] neg_lo:[1,0,0] neg_hi:[1,0,0]
v_pk_fma_f32 v[96:97], v[96:97], v[240:241], v[236:237] op_sel:[0,0,1] op_sel_hi:[1,0,1] neg_lo:[1,0,0] neg_hi:[1,0,0]
v_pk_fma_f32 v[98:99], v[98:99], v[240:241], v[236:237] op_sel:[0,0,1] op_sel_hi:[1,0,1] neg_lo:[1,0,0] neg_hi:[1,0,0]
v_pk_fma_f32 v[108:109], v[108:109], v[246:247], v[242:243] op_sel:[0,0,1] op_sel_hi:[1,0,1] neg_lo:[1,0,0] neg_hi:[1,0,0]
v_pk_fma_f32 v[110:111], v[110:111], v[246:247], v[242:243] op_sel:[0,0,1] op_sel_hi:[1,0,1] neg_lo:[1,0,0] neg_hi:[1,0,0]
v_pk_fma_f32 v[112:113], v[112:113], v[246:247], v[242:243] op_sel:[0,0,1] op_sel_hi:[1,0,1] neg_lo:[1,0,0] neg_hi:[1,0,0]
v_pk_fma_f32 v[114:115], v[114:115], v[246:247], v[242:243] op_sel:[0,0,1] op_sel_hi:[1,0,1] neg_lo:[1,0,0] neg_hi:[1,0,0]
v_exp_f32 v92, v92
v_exp_f32 v93, v93
v_exp_f32 v94, v94
v_exp_f32 v95, v95
v_exp_f32 v96, v96
v_exp_f32 v97, v97
v_exp_f32 v98, v98
v_exp_f32 v99, v99
v_exp_f32 v108, v108
v_exp_f32 v109, v109
v_exp_f32 v110, v110
v_exp_f32 v111, v111
v_exp_f32 v112, v112
v_exp_f32 v113, v113
v_exp_f32 v114, v114
v_exp_f32 v115, v115
v_pk_mul_f32 v[150:151], v[150:151], v[82:83] op_sel:[0,1] op_sel_hi:[1,1]
v_pk_mul_f32 v[174:175], v[174:175], v[84:85] op_sel:[0,1] op_sel_hi:[1,1]
v_cvt_pk_bf16_f32 v144, v92, v93
v_cvt_pk_bf16_f32 v145, v94, v95
v_cvt_pk_bf16_f32 v146, v96, v97
v_cvt_pk_bf16_f32 v147, v98, v99
v_cvt_pk_bf16_f32 v168, v108, v109
v_cvt_pk_bf16_f32 v169, v110, v111
v_cvt_pk_bf16_f32 v170, v112, v113
v_cvt_pk_bf16_f32 v171, v114, v115
v_cvt_pk_bf16_f32 v148, v148, v149
v_cvt_pk_bf16_f32 v172, v172, v173
v_pk_mul_f32 v[152:153], v[152:153], v[82:83] op_sel:[0,1] op_sel_hi:[1,1]
v_pk_mul_f32 v[154:155], v[154:155], v[82:83] op_sel:[0,1] op_sel_hi:[1,1]
v_pk_mul_f32 v[176:177], v[176:177], v[84:85] op_sel:[0,1] op_sel_hi:[1,1]
v_pk_mul_f32 v[178:179], v[178:179], v[84:85] op_sel:[0,1] op_sel_hi:[1,1]
v_cvt_pk_bf16_f32 v149, v150, v151
v_cvt_pk_bf16_f32 v173, v174, v175
v_cvt_pk_bf16_f32 v150, v152, v153
v_cvt_pk_bf16_f32 v151, v154, v155
v_cvt_pk_bf16_f32 v174, v176, v177
v_cvt_pk_bf16_f32 v175, v178, v179
v_mfma_f32_16x16x32_bf16 v[152:155], v[16:19], v[144:147], 0
v_cvt_pk_bf16_f32 v190, v192, v193
v_cvt_pk_bf16_f32 v191, v194, v195
v_mfma_f32_16x16x32_bf16 v[176:179], v[16:19], v[168:171], 0
v_cvt_pk_bf16_f32 v214, v216, v217
v_cvt_pk_bf16_f32 v215, v218, v219
v_exp_f32 v100, v100
s_nop 1
v_rcp_f32 v152, v152
v_exp_f32 v101, v101
s_nop 0
v_rcp_f32 v176, v176
v_pk_mul_f32 v[92:93], v[92:93], v[152:153] op_sel:[0,0] op_sel_hi:[1,0]
v_pk_mul_f32 v[94:95], v[94:95], v[152:153] op_sel:[0,0] op_sel_hi:[1,0]
v_pk_mul_f32 v[108:109], v[108:109], v[176:177] op_sel:[0,0] op_sel_hi:[1,0]
v_pk_mul_f32 v[110:111], v[110:111], v[176:177] op_sel:[0,0] op_sel_hi:[1,0]
v_pk_mul_f32 v[96:97], v[96:97], v[152:153] op_sel:[0,0] op_sel_hi:[1,0]
v_pk_mul_f32 v[98:99], v[98:99], v[152:153] op_sel:[0,0] op_sel_hi:[1,0]
v_cvt_pk_bf16_f32 v144, v92, v93
v_cvt_pk_bf16_f32 v145, v94, v95
v_pk_mul_f32 v[112:113], v[112:113], v[176:177] op_sel:[0,0] op_sel_hi:[1,0]
v_cvt_pk_bf16_f32 v168, v108, v109
v_pk_mul_f32 v[114:115], v[114:115], v[176:177] op_sel:[0,0] op_sel_hi:[1,0]
v_cvt_pk_bf16_f32 v169, v110, v111
v_mfma_f32_16x16x32_bf16 v[92:95], a[232:235], v[188:191], 0
v_cvt_pk_bf16_f32 v146, v96, v97
v_cvt_pk_bf16_f32 v147, v98, v99
v_mfma_f32_16x16x32_bf16 v[108:111], a[232:235], v[212:215], 0
v_cvt_pk_bf16_f32 v170, v112, v113
v_cvt_pk_bf16_f32 v171, v114, v115
v_mfma_f32_16x16x32_bf16 v[96:99], a[236:239], v[188:191], 0
s_nop 1
v_max3_f32 v236, v92, v93, v94
v_max3_f32 v237, -v92, -v93, -v94
v_mfma_f32_16x16x32_bf16 v[112:115], a[236:239], v[212:215], 0
v_max3_f32 v242, v108, v109, v110
v_max3_f32 v243, -v108, -v109, -v110
v_exp_f32 v102, v102
v_max3_f32 v236, v236, v95, v96
v_max3_f32 v237, v237, -v95, -v96
v_max3_f32 v236, v236, v97, v98
v_max3_f32 v237, v237, -v97, -v98
s_nop 0
v_max3_f32 v242, v242, v111, v112
v_max3_f32 v243, v243, -v111, -v112
v_max3_f32 v242, v242, v113, v114
v_max3_f32 v243, v243, -v113, -v114
v_max_f32 v236, v236, v99
v_max_f32_e64 v237, v237, -v99
v_max_f32 v242, v242, v115
v_max_f32_e64 v243, v243, -v115
v_exp_f32 v103, v103
v_exp_f32 v104, v104
v_exp_f32 v105, v105
v_exp_f32 v106, v106
v_exp_f32 v107, v107
v_exp_f32 v116, v116
v_exp_f32 v117, v117
v_exp_f32 v118, v118
v_exp_f32 v119, v119
v_exp_f32 v120, v120
v_exp_f32 v121, v121
v_exp_f32 v122, v122
v_exp_f32 v123, v123
s_lshl_b32 s36, s28, 12
v_permlane32_swap_b32 v236, v237
v_permlane32_swap_b32 v242, v243
v_add_u32 v232, s36, v7
v_cvt_pk_bf16_f32 v140, v100, v101
v_cvt_pk_bf16_f32 v141, v102, v103
v_cvt_pk_bf16_f32 v142, v104, v105
v_cvt_pk_bf16_f32 v143, v106, v107
v_cvt_pk_bf16_f32 v164, v116, v117
v_cvt_pk_bf16_f32 v165, v118, v119
v_cvt_pk_bf16_f32 v166, v120, v121
v_cvt_pk_bf16_f32 v167, v122, v123
ds_write_b64 v232, v[148:149] offset:0
ds_write_b64 v232, v[150:151] offset:512
ds_write_b64 v232, v[172:173] offset:1024
v_max_f32 v236, v236, v237
v_max_f32 v242, v242, v243
v_mfma_f32_16x16x32_bf16 v[148:151], v[16:19], v[140:143], 0
ds_write_b64 v232, v[174:175] offset:1536
v_mfma_f32_16x16x32_bf16 v[172:175], v[16:19], v[164:167], 0
v_mov_b32 v238, v236
v_mov_b32 v244, v242
v_mul_f32 v240, 0x3fb8aa3b, v87
v_permlane16_swap_b32 v236, v238
v_permlane16_swap_b32 v242, v244
v_max_f32 v236, v236, v238
v_max_f32 v242, v242, v244
v_mov_b32 v238, v236
v_mov_b32 v244, v242
v_rcp_f32 v148, v148
v_rcp_f32 v172, v172
v_permlane32_swap_b32 v236, v238
v_permlane32_swap_b32 v242, v244
v_mul_f32 v246, 0x3fb8aa3b, v89
v_pk_mul_f32 v[100:101], v[100:101], v[148:149] op_sel:[0,0] op_sel_hi:[1,0]
v_pk_mul_f32 v[102:103], v[102:103], v[148:149] op_sel:[0,0] op_sel_hi:[1,0]
v_pk_mul_f32 v[104:105], v[104:105], v[148:149] op_sel:[0,0] op_sel_hi:[1,0]
v_pk_mul_f32 v[106:107], v[106:107], v[148:149] op_sel:[0,0] op_sel_hi:[1,0]
v_pk_mul_f32 v[116:117], v[116:117], v[172:173] op_sel:[0,0] op_sel_hi:[1,0]
v_pk_mul_f32 v[118:119], v[118:119], v[172:173] op_sel:[0,0] op_sel_hi:[1,0]
v_pk_mul_f32 v[120:121], v[120:121], v[172:173] op_sel:[0,0] op_sel_hi:[1,0]
v_pk_mul_f32 v[122:123], v[122:123], v[172:173] op_sel:[0,0] op_sel_hi:[1,0]
v_mul_f32_e64 v236, -v236, v240
v_mul_f32_e64 v237, -v238, v240
v_mul_f32_e64 v242, -v242, v246
v_mul_f32_e64 v243, -v244, v246
v_cvt_pk_bf16_f32 v140, v100, v101
v_cvt_pk_bf16_f32 v141, v102, v103
v_cvt_pk_bf16_f32 v142, v104, v105
v_cvt_pk_bf16_f32 v143, v106, v107
v_cvt_pk_bf16_f32 v164, v116, v117
v_cvt_pk_bf16_f32 v165, v118, v119
v_cvt_pk_bf16_f32 v166, v120, v121
v_cvt_pk_bf16_f32 v167, v122, v123
v_pk_fma_f32 v[100:101], v[92:93], v[240:241], v[236:237] op_sel:[0,0,0] op_sel_hi:[1,0,0]
v_pk_fma_f32 v[102:103], v[94:95], v[240:241], v[236:237] op_sel:[0,0,0] op_sel_hi:[1,0,0]
v_pk_fma_f32 v[104:105], v[96:97], v[240:241], v[236:237] op_sel:[0,0,0] op_sel_hi:[1,0,0]
v_pk_fma_f32 v[106:107], v[98:99], v[240:241], v[236:237] op_sel:[0,0,0] op_sel_hi:[1,0,0]
v_pk_fma_f32 v[116:117], v[108:109], v[246:247], v[242:243] op_sel:[0,0,0] op_sel_hi:[1,0,0]
v_pk_fma_f32 v[118:119], v[110:111], v[246:247], v[242:243] op_sel:[0,0,0] op_sel_hi:[1,0,0]
v_pk_fma_f32 v[120:121], v[112:113], v[246:247], v[242:243] op_sel:[0,0,0] op_sel_hi:[1,0,0]
v_pk_fma_f32 v[122:123], v[114:115], v[246:247], v[242:243] op_sel:[0,0,0] op_sel_hi:[1,0,0]
v_pk_fma_f32 v[92:93], v[92:93], v[240:241], v[236:237] op_sel:[0,0,1] op_sel_hi:[1,0,1] neg_lo:[1,0,0] neg_hi:[1,0,0]
v_pk_fma_f32 v[94:95], v[94:95], v[240:241], v[236:237] op_sel:[0,0,1] op_sel_hi:[1,0,1] neg_lo:[1,0,0] neg_hi:[1,0,0]
v_pk_fma_f32 v[96:97], v[96:97], v[240:241], v[236:237] op_sel:[0,0,1] op_sel_hi:[1,0,1] neg_lo:[1,0,0] neg_hi:[1,0,0]
v_pk_fma_f32 v[98:99], v[98:99], v[240:241], v[236:237] op_sel:[0,0,1] op_sel_hi:[1,0,1] neg_lo:[1,0,0] neg_hi:[1,0,0]
v_pk_fma_f32 v[108:109], v[108:109], v[246:247], v[242:243] op_sel:[0,0,1] op_sel_hi:[1,0,1] neg_lo:[1,0,0] neg_hi:[1,0,0]
v_pk_fma_f32 v[110:111], v[110:111], v[246:247], v[242:243] op_sel:[0,0,1] op_sel_hi:[1,0,1] neg_lo:[1,0,0] neg_hi:[1,0,0]
v_pk_fma_f32 v[112:113], v[112:113], v[246:247], v[242:243] op_sel:[0,0,1] op_sel_hi:[1,0,1] neg_lo:[1,0,0] neg_hi:[1,0,0]
v_pk_fma_f32 v[114:115], v[114:115], v[246:247], v[242:243] op_sel:[0,0,1] op_sel_hi:[1,0,1] neg_lo:[1,0,0] neg_hi:[1,0,0]
v_pk_mul_f32 v[196:197], v[196:197], v[86:87] op_sel:[0,1] op_sel_hi:[1,1]
v_pk_mul_f32 v[220:221], v[220:221], v[88:89] op_sel:[0,1] op_sel_hi:[1,1]
v_exp_f32 v100, v100
v_exp_f32 v92, v92
v_exp_f32 v101, v101
v_exp_f32 v93, v93
v_exp_f32 v102, v102
v_exp_f32 v94, v94
v_exp_f32 v103, v103
v_exp_f32 v95, v95
v_exp_f32 v104, v104
v_exp_f32 v96, v96
v_exp_f32 v105, v105
v_exp_f32 v97, v97
v_exp_f32 v106, v106
v_exp_f32 v98, v98
v_exp_f32 v107, v107
v_exp_f32 v99, v99
v_exp_f32 v116, v116
v_exp_f32 v108, v108
v_exp_f32 v117, v117
v_exp_f32 v109, v109
v_exp_f32 v118, v118
v_exp_f32 v110, v110
v_exp_f32 v119, v119
v_exp_f32 v111, v111
v_exp_f32 v120, v120
v_exp_f32 v112, v112
v_exp_f32 v121, v121
v_exp_f32 v113, v113
v_exp_f32 v122, v122
v_exp_f32 v114, v114
v_exp_f32 v123, v123
v_exp_f32 v115, v115
v_pk_mul_f32 v[198:199], v[198:199], v[86:87] op_sel:[0,1] op_sel_hi:[1,1]
v_pk_mul_f32 v[222:223], v[222:223], v[88:89] op_sel:[0,1] op_sel_hi:[1,1]
v_cvt_pk_bf16_f32 v196, v196, v197
v_cvt_pk_bf16_f32 v220, v220, v221
v_pk_mul_f32 v[200:201], v[200:201], v[86:87] op_sel:[0,1] op_sel_hi:[1,1]
v_pk_mul_f32 v[202:203], v[202:203], v[86:87] op_sel:[0,1] op_sel_hi:[1,1]
v_pk_mul_f32 v[224:225], v[224:225], v[88:89] op_sel:[0,1] op_sel_hi:[1,1]
v_pk_mul_f32 v[226:227], v[226:227], v[88:89] op_sel:[0,1] op_sel_hi:[1,1]
v_cvt_pk_bf16_f32 v197, v198, v199
v_cvt_pk_bf16_f32 v221, v222, v223
v_cvt_pk_bf16_f32 v198, v200, v201
v_cvt_pk_bf16_f32 v199, v202, v203
v_cvt_pk_bf16_f32 v222, v224, v225
v_cvt_pk_bf16_f32 v223, v226, v227
v_cvt_pk_bf16_f32 v188, v100, v101
v_cvt_pk_bf16_f32 v189, v102, v103
v_cvt_pk_bf16_f32 v190, v104, v105
v_cvt_pk_bf16_f32 v191, v106, v107
v_cvt_pk_bf16_f32 v192, v92, v93
v_cvt_pk_bf16_f32 v193, v94, v95
v_cvt_pk_bf16_f32 v194, v96, v97
v_cvt_pk_bf16_f32 v195, v98, v99
v_cvt_pk_bf16_f32 v212, v116, v117
v_cvt_pk_bf16_f32 v213, v118, v119
v_cvt_pk_bf16_f32 v214, v120, v121
v_cvt_pk_bf16_f32 v215, v122, v123
v_cvt_pk_bf16_f32 v216, v108, v109
v_cvt_pk_bf16_f32 v217, v110, v111
v_cvt_pk_bf16_f32 v218, v112, v113
v_cvt_pk_bf16_f32 v219, v114, v115
ds_write_b64 v232, v[196:197] offset:2048
ds_write_b64 v232, v[198:199] offset:2560
ds_write_b64 v232, v[220:221] offset:3072
v_mfma_f32_16x16x32_bf16 v[196:199], v[16:19], v[188:191], 0
v_add_u32 v233, s36, v232
ds_write_b64 v232, v[222:223] offset:3584
v_mfma_f32_16x16x32_bf16 v[200:203], v[16:19], v[192:195], 0
ds_write_b64 v233, v[140:141] offset:16384
v_mfma_f32_16x16x32_bf16 v[220:223], v[16:19], v[212:215], 0
s_nop 2
v_rcp_f32 v196, v196
v_mfma_f32_16x16x32_bf16 v[224:227], v[16:19], v[216:219], 0
s_nop 0
v_rcp_f32 v200, v200
ds_write_b64 v233, v[142:143] offset:16896
v_rcp_f32 v220, v220
v_pk_mul_f32 v[100:101], v[100:101], v[196:197] op_sel:[0,0] op_sel_hi:[1,0]
s_nop 2
v_rcp_f32 v224, v224
v_pk_mul_f32 v[102:103], v[102:103], v[196:197] op_sel:[0,0] op_sel_hi:[1,0]
v_pk_mul_f32 v[104:105], v[104:105], v[196:197] op_sel:[0,0] op_sel_hi:[1,0]
v_pk_mul_f32 v[106:107], v[106:107], v[196:197] op_sel:[0,0] op_sel_hi:[1,0]
v_pk_mul_f32 v[92:93], v[92:93], v[200:201] op_sel:[0,0] op_sel_hi:[1,0]
v_pk_mul_f32 v[94:95], v[94:95], v[200:201] op_sel:[0,0] op_sel_hi:[1,0]
v_pk_mul_f32 v[96:97], v[96:97], v[200:201] op_sel:[0,0] op_sel_hi:[1,0]
v_pk_mul_f32 v[98:99], v[98:99], v[200:201] op_sel:[0,0] op_sel_hi:[1,0]
v_pk_mul_f32 v[116:117], v[116:117], v[220:221] op_sel:[0,0] op_sel_hi:[1,0]
v_pk_mul_f32 v[118:119], v[118:119], v[220:221] op_sel:[0,0] op_sel_hi:[1,0]
v_pk_mul_f32 v[120:121], v[120:121], v[220:221] op_sel:[0,0] op_sel_hi:[1,0]
v_pk_mul_f32 v[122:123], v[122:123], v[220:221] op_sel:[0,0] op_sel_hi:[1,0]
v_pk_mul_f32 v[108:109], v[108:109], v[224:225] op_sel:[0,0] op_sel_hi:[1,0]
v_pk_mul_f32 v[110:111], v[110:111], v[224:225] op_sel:[0,0] op_sel_hi:[1,0]
v_pk_mul_f32 v[112:113], v[112:113], v[224:225] op_sel:[0,0] op_sel_hi:[1,0]
v_pk_mul_f32 v[114:115], v[114:115], v[224:225] op_sel:[0,0] op_sel_hi:[1,0]
v_cvt_pk_bf16_f32 v188, v100, v101
v_cvt_pk_bf16_f32 v189, v102, v103
v_cvt_pk_bf16_f32 v190, v104, v105
v_cvt_pk_bf16_f32 v191, v106, v107
v_cvt_pk_bf16_f32 v192, v92, v93
v_cvt_pk_bf16_f32 v193, v94, v95
v_cvt_pk_bf16_f32 v194, v96, v97
v_cvt_pk_bf16_f32 v195, v98, v99
v_cvt_pk_bf16_f32 v212, v116, v117
v_cvt_pk_bf16_f32 v213, v118, v119
v_cvt_pk_bf16_f32 v214, v120, v121
v_cvt_pk_bf16_f32 v215, v122, v123
v_cvt_pk_bf16_f32 v216, v108, v109
v_cvt_pk_bf16_f32 v217, v110, v111
v_cvt_pk_bf16_f32 v218, v112, v113
v_cvt_pk_bf16_f32 v219, v114, v115
ds_write_b64 v233, v[144:145] offset:17408
ds_write_b64 v233, v[146:147] offset:17920
ds_write_b64 v233, v[164:165] offset:18432
ds_write_b64 v233, v[166:167] offset:18944
ds_write_b64 v233, v[168:169] offset:19456
ds_write_b64 v233, v[170:171] offset:19968
ds_write_b64 v233, v[188:189] offset:20480
ds_write_b64 v233, v[190:191] offset:20992
ds_write_b64 v233, v[192:193] offset:21504
ds_write_b64 v233, v[194:195] offset:22016
ds_write_b64 v233, v[212:213] offset:22528
ds_write_b64 v233, v[214:215] offset:23040
ds_write_b64 v233, v[216:217] offset:23552
ds_write_b64 v233, v[218:219] offset:24064
s_waitcnt lgkmcnt(0)
s_barrier
s_lshl_b32 s36, s28, 9
v_add_u32 v234, s36, v8
ds_read_b64_tr_b16 a[0:1], v234 offset:16384
ds_read_b64_tr_b16 a[4:5], v8 offset:0
ds_read_b64_tr_b16 a[2:3], v234 offset:18432
ds_read_b64_tr_b16 a[6:7], v8 offset:1024
ds_read_b64_tr_b16 a[12:13], v234 offset:20480
ds_read_b64_tr_b16 a[16:17], v8 offset:2048
ds_read_b64_tr_b16 a[14:15], v234 offset:22528
ds_read_b64_tr_b16 a[18:19], v8 offset:3072
ds_read_b64_tr_b16 a[24:25], v234 offset:24576
ds_read_b64_tr_b16 a[28:29], v8 offset:4096
ds_read_b64_tr_b16 a[26:27], v234 offset:26624
ds_read_b64_tr_b16 a[30:31], v8 offset:5120
ds_read_b64_tr_b16 a[36:37], v234 offset:28672
ds_read_b64_tr_b16 a[40:41], v8 offset:6144
ds_read_b64_tr_b16 a[38:39], v234 offset:30720
ds_read_b64_tr_b16 a[42:43], v8 offset:7168
ds_read_b64_tr_b16 a[8:9], v8 offset:512
ds_read_b64_tr_b16 a[10:11], v8 offset:1536
ds_read_b64_tr_b16 a[48:49], v234 offset:32768
ds_read_b64_tr_b16 a[52:53], v8 offset:8192
ds_read_b64_tr_b16 a[50:51], v234 offset:34816
ds_read_b64_tr_b16 a[54:55], v8 offset:9216
ds_read_b64_tr_b16 a[20:21], v8 offset:2560
ds_read_b64_tr_b16 a[22:23], v8 offset:3584
ds_read_b64_tr_b16 a[60:61], v234 offset:36864
ds_read_b64_tr_b16 a[64:65], v8 offset:10240
ds_read_b64_tr_b16 a[62:63], v234 offset:38912
ds_read_b64_tr_b16 a[66:67], v8 offset:11264
s_waitcnt lgkmcnt(14)
v_mfma_f32_16x16x32_bf16 v[92:95], a[0:3], a[4:7], 0
ds_read_b64_tr_b16 a[32:33], v8 offset:4608
ds_read_b64_tr_b16 a[34:35], v8 offset:5632
ds_read_b64_tr_b16 a[72:73], v234 offset:40960
ds_read_b64_tr_b16 a[76:77], v8 offset:12288
ds_read_b64_tr_b16 a[74:75], v234 offset:43008
ds_read_b64_tr_b16 a[78:79], v8 offset:13312
v_mfma_f32_16x16x32_bf16 v[92:95], a[12:15], a[16:19], v[92:95]
ds_read_b64_tr_b16 a[44:45], v8 offset:6656
ds_read_b64_tr_b16 a[46:47], v8 offset:7680
ds_read_b64_tr_b16 a[84:85], v234 offset:45056
ds_read_b64_tr_b16 a[88:89], v8 offset:14336
ds_read_b64_tr_b16 a[86:87], v234 offset:47104
ds_read_b64_tr_b16 a[90:91], v8 offset:15360
v_mfma_f32_16x16x32_bf16 v[92:95], a[24:27], a[28:31], v[92:95]
ds_read_b64_tr_b16 a[56:57], v8 offset:8704
ds_read_b64_tr_b16 a[58:59], v8 offset:9728
s_waitcnt lgkmcnt(14)
v_mfma_f32_16x16x32_bf16 v[92:95], a[36:39], a[40:43], v[92:95]
ds_read_b64_tr_b16 a[68:69], v8 offset:10752
ds_read_b64_tr_b16 a[70:71], v8 offset:11776
v_mfma_f32_16x16x32_bf16 v[96:99], a[0:3], a[8:11], 0
ds_read_b64_tr_b16 a[80:81], v8 offset:12800
v_mfma_f32_16x16x32_bf16 v[92:95], a[48:51], a[52:55], v[92:95]
ds_read_b64_tr_b16 a[82:83], v8 offset:13824
v_mfma_f32_16x16x32_bf16 v[96:99], a[12:15], a[20:23], v[96:99]
ds_read_b64_tr_b16 a[92:93], v8 offset:14848
v_mfma_f32_16x16x32_bf16 v[92:95], a[60:63], a[64:67], v[92:95]
ds_read_b64_tr_b16 a[94:95], v8 offset:15872
s_waitcnt lgkmcnt(14)
v_mfma_f32_16x16x32_bf16 v[96:99], a[24:27], a[32:35], v[96:99]
s_lshl_b32 s37, s30, 2
s_add_u32 s37, s37, s28
v_mfma_f32_16x16x32_bf16 v[92:95], a[72:75], a[76:79], v[92:95]
s_lshl_b32 s37, s37, 3
s_add_u32 s38, s37, s29
s_waitcnt lgkmcnt(12)
v_mfma_f32_16x16x32_bf16 v[96:99], a[36:39], a[44:47], v[96:99]
s_lshl_b32 s39, s38, 7
s_add_u32 s39, s39, 0x800000
v_mfma_f32_16x16x32_bf16 v[100:103], a[0:3], v[16:19], 0
s_lshl_b32 s38, s38, 11
s_add_u32 s38, s38, 0x400000
s_waitcnt lgkmcnt(8)
v_mfma_f32_16x16x32_bf16 v[92:95], a[84:87], a[88:91], v[92:95]
v_cvt_pk_bf16_f32 v132, v132, v133
v_cvt_pk_bf16_f32 v156, v156, v157
s_waitcnt lgkmcnt(6)
v_mfma_f32_16x16x32_bf16 v[96:99], a[48:51], a[56:59], v[96:99]
v_cvt_pk_bf16_f32 v180, v180, v181
v_cvt_pk_bf16_f32 v204, v204, v205
v_mfma_f32_16x16x32_bf16 v[100:103], a[12:15], v[16:19], v[100:103]
s_nop 0
buffer_store_dwordx4 v[92:95], v1, s[4:7], s38 offen offset:0 sc1
L_stub8:
s_cbranch_execz L_wret2
s_waitcnt lgkmcnt(4)
v_mfma_f32_16x16x32_bf16 v[96:99], a[60:63], a[68:71], v[96:99]
v_cvt_pk_bf16_f32 v133, v134, v135
v_cvt_pk_bf16_f32 v157, v158, v159
v_mfma_f32_16x16x32_bf16 v[100:103], a[24:27], v[16:19], v[100:103]
v_cvt_pk_bf16_f32 v181, v182, v183
v_cvt_pk_bf16_f32 v205, v206, v207
s_waitcnt lgkmcnt(2)
v_mfma_f32_16x16x32_bf16 v[96:99], a[72:75], a[80:83], v[96:99]
v_cvt_pk_bf16_f32 v134, v136, v137
v_cvt_pk_bf16_f32 v135, v138, v139
v_mfma_f32_16x16x32_bf16 v[100:103], a[36:39], v[16:19], v[100:103]
v_cvt_pk_bf16_f32 v158, v160, v161
v_cvt_pk_bf16_f32 v159, v162, v163
s_waitcnt lgkmcnt(0)
v_mfma_f32_16x16x32_bf16 v[96:99], a[84:87], a[92:95], v[96:99]
v_cvt_pk_bf16_f32 v182, v184, v185
v_cvt_pk_bf16_f32 v183, v186, v187
v_mfma_f32_16x16x32_bf16 v[100:103], a[48:51], v[16:19], v[100:103]
v_cvt_pk_bf16_f32 v206, v208, v209
v_cvt_pk_bf16_f32 v207, v210, v211
v_mfma_f32_16x16x32_bf16 v[100:103], a[60:63], v[16:19], v[100:103]
s_nop 1
buffer_store_dwordx4 v[96:99], v1, s[4:7], s38 offen offset:1024 sc1
v_mfma_f32_16x16x32_bf16 v[100:103], a[72:75], v[16:19], v[100:103]
v_mfma_f32_16x16x32_bf16 v[100:103], a[84:87], v[16:19], v[100:103]
s_nop 7
buffer_store_dwordx4 v[100:103], v254, s[4:7], s39 offen sc1
v_cndmask_b32 v235, 2.0, v10, s[64:65]
v_mfma_f32_16x16x32_bf16 v[108:111], a[232:235], v[132:135], 0
v_mul_f32 v240, 0x3fb8aa3b, v83
v_mul_f32 v246, 0x3fb8aa3b, v85
v_mfma_f32_16x16x32_bf16 v[172:175], a[232:235], v[156:159], 0
v_mfma_f32_16x16x32_bf16 v[112:115], a[236:239], v[132:135], 0
s_nop 3
v_max3_f32 v236, v108, v109, v110
v_max3_f32 v237, -v108, -v109, -v110
v_mfma_f32_16x16x32_bf16 v[176:179], a[236:239], v[156:159], 0
v_max3_f32 v242, v172, v173, v174
v_max3_f32 v243, -v172, -v173, -v174
v_max3_f32 v236, v236, v111, v112
v_max3_f32 v237, v237, -v111, -v112
v_max3_f32 v236, v236, v113, v114
v_max3_f32 v237, v237, -v113, -v114
s_nop 1
v_max3_f32 v242, v242, v175, v176
v_max3_f32 v243, v243, -v175, -v176
v_max3_f32 v242, v242, v177, v178
v_max3_f32 v243, v243, -v177, -v178
v_max_f32 v236, v236, v115
v_max_f32_e64 v237, v237, -v115
v_max_f32 v242, v242, v179
v_max_f32_e64 v243, v243, -v179
v_permlane32_swap_b32 v236, v237
s_nop 0
v_permlane32_swap_b32 v242, v243
v_max_f32 v236, v236, v237
v_max_f32 v242, v242, v243
v_mov_b32 v238, v236
v_mov_b32 v244, v242
s_nop 0
v_permlane16_swap_b32 v236, v238
v_permlane16_swap_b32 v242, v244
v_max_f32 v236, v236, v238
v_max_f32 v242, v242, v244
v_mov_b32 v238, v236
v_mov_b32 v244, v242
s_nop 0
v_permlane32_swap_b32 v236, v238
v_permlane32_swap_b32 v242, v244
v_mul_f32_e64 v236, -v236, v240
v_mul_f32_e64 v237, -v238, v240
v_mul_f32_e64 v242, -v242, v246
v_mul_f32_e64 v243, -v244, v246
v_pk_fma_f32 v[116:117], v[108:109], v[240:241], v[236:237] op_sel:[0,0,0] op_sel_hi:[1,0,0]
v_pk_fma_f32 v[118:119], v[110:111], v[240:241], v[236:237] op_sel:[0,0,0] op_sel_hi:[1,0,0]
v_pk_fma_f32 v[120:121], v[112:113], v[240:241], v[236:237] op_sel:[0,0,0] op_sel_hi:[1,0,0]
v_pk_fma_f32 v[122:123], v[114:115], v[240:241], v[236:237] op_sel:[0,0,0] op_sel_hi:[1,0,0]
v_pk_fma_f32 v[148:149], v[172:173], v[246:247], v[242:243] op_sel:[0,0,0] op_sel_hi:[1,0,0]
v_pk_fma_f32 v[150:151], v[174:175], v[246:247], v[242:243] op_sel:[0,0,0] op_sel_hi:[1,0,0]
v_pk_fma_f32 v[152:153], v[176:177], v[246:247], v[242:243] op_sel:[0,0,0] op_sel_hi:[1,0,0]
v_pk_fma_f32 v[154:155], v[178:179], v[246:247], v[242:243] op_sel:[0,0,0] op_sel_hi:[1,0,0]
v_pk_fma_f32 v[108:109], v[108:109], v[240:241], v[236:237] op_sel:[0,0,1] op_sel_hi:[1,0,1] neg_lo:[1,0,0] neg_hi:[1,0,0]
v_pk_fma_f32 v[110:111], v[110:111], v[240:241], v[236:237] op_sel:[0,0,1] op_sel_hi:[1,0,1] neg_lo:[1,0,0] neg_hi:[1,0,0]
v_pk_fma_f32 v[112:113], v[112:113], v[240:241], v[236:237] op_sel:[0,0,1] op_sel_hi:[1,0,1] neg_lo:[1,0,0] neg_hi:[1,0,0]
v_pk_fma_f32 v[114:115], v[114:115], v[240:241], v[236:237] op_sel:[0,0,1] op_sel_hi:[1,0,1] neg_lo:[1,0,0] neg_hi:[1,0,0]
v_pk_fma_f32 v[172:173], v[172:173], v[246:247], v[242:243] op_sel:[0,0,1] op_sel_hi:[1,0,1] neg_lo:[1,0,0] neg_hi:[1,0,0]
v_pk_fma_f32 v[174:175], v[174:175], v[246:247], v[242:243] op_sel:[0,0,1] op_sel_hi:[1,0,1] neg_lo:[1,0,0] neg_hi:[1,0,0]
v_pk_fma_f32 v[176:177], v[176:177], v[246:247], v[242:243] op_sel:[0,0,1] op_sel_hi:[1,0,1] neg_lo:[1,0,0] neg_hi:[1,0,0]
v_pk_fma_f32 v[178:179], v[178:179], v[246:247], v[242:243] op_sel:[0,0,1] op_sel_hi:[1,0,1] neg_lo:[1,0,0] neg_hi:[1,0,0]
v_exp_f32 v116, v116
v_exp_f32 v108, v108
v_exp_f32 v117, v117
v_exp_f32 v109, v109
v_exp_f32 v118, v118
v_exp_f32 v110, v110
v_exp_f32 v119, v119
v_exp_f32 v111, v111
v_exp_f32 v120, v120
v_exp_f32 v112, v112
v_exp_f32 v121, v121
v_exp_f32 v113, v113
v_exp_f32 v122, v122
v_exp_f32 v114, v114
v_exp_f32 v123, v123
v_exp_f32 v115, v115
v_exp_f32 v148, v148
v_exp_f32 v172, v172
v_exp_f32 v149, v149
v_exp_f32 v173, v173
v_exp_f32 v150, v150
v_exp_f32 v174, v174
v_exp_f32 v151, v151
v_exp_f32 v175, v175
v_exp_f32 v152, v152
v_exp_f32 v176, v176
v_exp_f32 v153, v153
v_exp_f32 v177, v177
v_exp_f32 v154, v154
v_exp_f32 v178, v178
v_exp_f32 v155, v155
v_exp_f32 v179, v179
v_cvt_pk_bf16_f32 v140, v116, v117
v_cvt_pk_bf16_f32 v141, v118, v119
v_cvt_pk_bf16_f32 v142, v120, v121
v_cvt_pk_bf16_f32 v143, v122, v123
v_cvt_pk_bf16_f32 v144, v108, v109
v_cvt_pk_bf16_f32 v145, v110, v111
v_cvt_pk_bf16_f32 v146, v112, v113
v_cvt_pk_bf16_f32 v147, v114, v115
v_cvt_pk_bf16_f32 v164, v148, v149
v_cvt_pk_bf16_f32 v165, v150, v151
v_cvt_pk_bf16_f32 v166, v152, v153
v_cvt_pk_bf16_f32 v167, v154, v155
v_cvt_pk_bf16_f32 v168, v172, v173
v_cvt_pk_bf16_f32 v169, v174, v175
v_cvt_pk_bf16_f32 v170, v176, v177
v_cvt_pk_bf16_f32 v171, v178, v179
s_add_u32 s94, s80, 0x80000
s_waitcnt vmcnt(0)
s_barrier
s_cmp_lg_u32 s28, 1
s_cbranch_scc1 Lsg_18
buffer_atomic_add v12, v235, s[4:7], s94 offen sc1
Lsg_18:
v_mfma_f32_16x16x32_bf16 v[108:111], a[232:235], v[180:183], 0
v_mul_f32 v240, 0x3fb8aa3b, v87
v_mul_f32 v246, 0x3fb8aa3b, v89
v_mfma_f32_16x16x32_bf16 v[172:175], a[232:235], v[204:207], 0
v_mfma_f32_16x16x32_bf16 v[112:115], a[236:239], v[180:183], 0
s_nop 3
v_max3_f32 v236, v108, v109, v110
v_max3_f32 v237, -v108, -v109, -v110
v_mfma_f32_16x16x32_bf16 v[176:179], a[236:239], v[204:207], 0
v_max3_f32 v242, v172, v173, v174
v_max3_f32 v243, -v172, -v173, -v174
v_max3_f32 v236, v236, v111, v112
v_max3_f32 v237, v237, -v111, -v112
v_max3_f32 v236, v236, v113, v114
v_max3_f32 v237, v237, -v113, -v114
s_nop 1
v_max3_f32 v242, v242, v175, v176
v_max3_f32 v243, v243, -v175, -v176
v_max3_f32 v242, v242, v177, v178
v_max3_f32 v243, v243, -v177, -v178
v_max_f32 v236, v236, v115
v_max_f32_e64 v237, v237, -v115
v_max_f32 v242, v242, v179
v_max_f32_e64 v243, v243, -v179
v_permlane32_swap_b32 v236, v237
s_nop 0
v_permlane32_swap_b32 v242, v243
v_max_f32 v236, v236, v237
v_max_f32 v242, v242, v243
v_mov_b32 v238, v236
v_mov_b32 v244, v242
s_nop 0
v_permlane16_swap_b32 v236, v238
v_permlane16_swap_b32 v242, v244
v_max_f32 v236, v236, v238
v_max_f32 v242, v242, v244
v_mov_b32 v238, v236
v_mov_b32 v244, v242
s_nop 0
v_permlane32_swap_b32 v236, v238
v_permlane32_swap_b32 v242, v244
v_mul_f32_e64 v236, -v236, v240
v_mul_f32_e64 v237, -v238, v240
v_mul_f32_e64 v242, -v242, v246
v_mul_f32_e64 v243, -v244, v246
v_pk_fma_f32 v[116:117], v[108:109], v[240:241], v[236:237] op_sel:[0,0,0] op_sel_hi:[1,0,0]
v_pk_fma_f32 v[118:119], v[110:111], v[240:241], v[236:237] op_sel:[0,0,0] op_sel_hi:[1,0,0]
v_pk_fma_f32 v[120:121], v[112:113], v[240:241], v[236:237] op_sel:[0,0,0] op_sel_hi:[1,0,0]
v_pk_fma_f32 v[122:123], v[114:115], v[240:241], v[236:237] op_sel:[0,0,0] op_sel_hi:[1,0,0]
v_pk_fma_f32 v[148:149], v[172:173], v[246:247], v[242:243] op_sel:[0,0,0] op_sel_hi:[1,0,0]
v_pk_fma_f32 v[150:151], v[174:175], v[246:247], v[242:243] op_sel:[0,0,0] op_sel_hi:[1,0,0]
v_pk_fma_f32 v[152:153], v[176:177], v[246:247], v[242:243] op_sel:[0,0,0] op_sel_hi:[1,0,0]
v_pk_fma_f32 v[154:155], v[178:179], v[246:247], v[242:243] op_sel:[0,0,0] op_sel_hi:[1,0,0]
v_pk_fma_f32 v[108:109], v[108:109], v[240:241], v[236:237] op_sel:[0,0,1] op_sel_hi:[1,0,1] neg_lo:[1,0,0] neg_hi:[1,0,0]
v_pk_fma_f32 v[110:111], v[110:111], v[240:241], v[236:237] op_sel:[0,0,1] op_sel_hi:[1,0,1] neg_lo:[1,0,0] neg_hi:[1,0,0]
v_pk_fma_f32 v[112:113], v[112:113], v[240:241], v[236:237] op_sel:[0,0,1] op_sel_hi:[1,0,1] neg_lo:[1,0,0] neg_hi:[1,0,0]
v_pk_fma_f32 v[114:115], v[114:115], v[240:241], v[236:237] op_sel:[0,0,1] op_sel_hi:[1,0,1] neg_lo:[1,0,0] neg_hi:[1,0,0]
v_pk_fma_f32 v[172:173], v[172:173], v[246:247], v[242:243] op_sel:[0,0,1] op_sel_hi:[1,0,1] neg_lo:[1,0,0] neg_hi:[1,0,0]
v_pk_fma_f32 v[174:175], v[174:175], v[246:247], v[242:243] op_sel:[0,0,1] op_sel_hi:[1,0,1] neg_lo:[1,0,0] neg_hi:[1,0,0]
v_pk_fma_f32 v[176:177], v[176:177], v[246:247], v[242:243] op_sel:[0,0,1] op_sel_hi:[1,0,1] neg_lo:[1,0,0] neg_hi:[1,0,0]
v_pk_fma_f32 v[178:179], v[178:179], v[246:247], v[242:243] op_sel:[0,0,1] op_sel_hi:[1,0,1] neg_lo:[1,0,0] neg_hi:[1,0,0]
v_exp_f32 v116, v116
v_exp_f32 v108, v108
v_exp_f32 v117, v117
v_exp_f32 v109, v109
v_exp_f32 v118, v118
v_exp_f32 v110, v110
v_exp_f32 v119, v119
v_exp_f32 v111, v111
v_exp_f32 v120, v120
v_exp_f32 v112, v112
v_exp_f32 v121, v121
v_exp_f32 v113, v113
v_exp_f32 v122, v122
v_exp_f32 v114, v114
v_exp_f32 v123, v123
v_exp_f32 v115, v115
v_exp_f32 v148, v148
v_exp_f32 v172, v172
v_exp_f32 v149, v149
v_exp_f32 v173, v173
v_exp_f32 v150, v150
v_exp_f32 v174, v174
v_exp_f32 v151, v151
v_exp_f32 v175, v175
v_exp_f32 v152, v152
v_exp_f32 v176, v176
v_exp_f32 v153, v153
v_exp_f32 v177, v177
v_exp_f32 v154, v154
v_exp_f32 v178, v178
v_exp_f32 v155, v155
v_exp_f32 v179, v179
v_cvt_pk_bf16_f32 v188, v116, v117
v_cvt_pk_bf16_f32 v189, v118, v119
v_cvt_pk_bf16_f32 v190, v120, v121
v_cvt_pk_bf16_f32 v191, v122, v123
v_cvt_pk_bf16_f32 v192, v108, v109
v_cvt_pk_bf16_f32 v193, v110, v111
v_cvt_pk_bf16_f32 v194, v112, v113
v_cvt_pk_bf16_f32 v195, v114, v115
v_cvt_pk_bf16_f32 v212, v148, v149
v_cvt_pk_bf16_f32 v213, v150, v151
v_cvt_pk_bf16_f32 v214, v152, v153
v_cvt_pk_bf16_f32 v215, v154, v155
v_cvt_pk_bf16_f32 v216, v172, v173
v_cvt_pk_bf16_f32 v217, v174, v175
v_cvt_pk_bf16_f32 v218, v176, v177
v_cvt_pk_bf16_f32 v219, v178, v179
s_cmp_lg_u32 s28, 0
s_cbranch_scc1 Lpe_20
s_add_u32 s36, s70, 0x80000
s_mov_b32 s37, 0
Lpoll_19:
v_mov_b32 v11, 0
s_mov_b64 exec, 1
buffer_atomic_add v11, off, s[4:7], s36 sc0 sc1
s_waitcnt vmcnt(0)
v_readfirstlane_b32 s38, v11
s_mov_b64 exec, -1
s_nop 0
v_mov_b32 v11, s38
s_add_u32 s37, s37, 1
v_cmp_gt_u32 vcc, 8, v11
s_cbranch_vccz Lpe_20
s_cmp_lt_u32 s37, 0x100000
s_cbranch_scc1 Lpoll_19
Lpe_20:
s_barrier
s_lshl_b32 s37, s30, 2
s_add_u32 s37, s37, s28
v_and_b32 v248, 7, v0
s_lshl_b32 s39, s37, 10
v_lshlrev_b32 v248, 7, v248
v_lshrrev_b32 v249, 4, v0
s_add_u32 s39, s39, 0x800000
v_lshl_add_u32 v248, v249, 4, v248
buffer_load_dwordx4 v[156:159], v248, s[4:7], s39 offen sc1
s_lshl_b32 s38, s37, 14
s_add_u32 s38, s38, 0x400000
buffer_load_dwordx4 v[92:95], v1, s[4:7], s38 offen offset:0 sc1
buffer_load_dwordx4 v[96:99], v1, s[4:7], s38 offen offset:1024 sc1
buffer_load_dwordx4 v[100:103], v1, s[4:7], s38 offen offset:2048 sc1
buffer_load_dwordx4 v[104:107], v1, s[4:7], s38 offen offset:3072 sc1
s_add_u32 s38, s38, 4096
buffer_load_dwordx4 v[148:151], v1, s[4:7], s38 offen offset:0 sc1
buffer_load_dwordx4 v[152:155], v1, s[4:7], s38 offen offset:1024 sc1
buffer_load_dwordx4 v[172:175], v1, s[4:7], s38 offen offset:2048 sc1
buffer_load_dwordx4 v[176:179], v1, s[4:7], s38 offen offset:3072 sc1
s_add_u32 s38, s38, 4096
buffer_load_dwordx4 v[48:51], v1, s[4:7], s38 offen offset:0 sc1
buffer_load_dwordx4 v[52:55], v1, s[4:7], s38 offen offset:1024 sc1
buffer_load_dwordx4 v[56:59], v1, s[4:7], s38 offen offset:2048 sc1
buffer_load_dwordx4 v[60:63], v1, s[4:7], s38 offen offset:3072 sc1
s_add_u32 s38, s38, 4096
s_waitcnt vmcnt(12)
v_add_f32_dpp v156, v156, v156 row_ror:4 row_mask:0xf bank_mask:0xf
v_add_f32_dpp v157, v157, v157 row_ror:4 row_mask:0xf bank_mask:0xf
v_add_f32_dpp v158, v158, v158 row_ror:4 row_mask:0xf bank_mask:0xf
v_add_f32_dpp v159, v159, v159 row_ror:4 row_mask:0xf bank_mask:0xf
v_add_f32_dpp v156, v156, v156 row_ror:2 row_mask:0xf bank_mask:0xf
v_add_f32_dpp v157, v157, v157 row_ror:2 row_mask:0xf bank_mask:0xf
v_add_f32_dpp v158, v158, v158 row_ror:2 row_mask:0xf bank_mask:0xf
v_add_f32_dpp v159, v159, v159 row_ror:2 row_mask:0xf bank_mask:0xf
buffer_load_dwordx4 v[64:67], v1, s[4:7], s38 offen offset:0 sc1
v_add_f32_dpp v156, v156, v156 row_ror:1 row_mask:0xf bank_mask:0xf
v_add_f32_dpp v157, v157, v157 row_ror:1 row_mask:0xf bank_mask:0xf
v_add_f32_dpp v158, v158, v158 row_ror:1 row_mask:0xf bank_mask:0xf
v_add_f32_dpp v159, v159, v159 row_ror:1 row_mask:0xf bank_mask:0xf
buffer_load_dwordx4 v[68:71], v1, s[4:7], s38 offen offset:1024 sc1
buffer_load_dwordx4 v[132:135], v1, s[4:7], s38 offen offset:2048 sc1
s_waitcnt vmcnt(12)
v_pk_add_f32 v[92:93], v[92:93], v[100:101]
v_pk_add_f32 v[94:95], v[94:95], v[102:103]
buffer_load_dwordx4 v[136:139], v1, s[4:7], s38 offen offset:3072 sc1
s_waitcnt vmcnt(12)
v_pk_add_f32 v[96:97], v[96:97], v[104:105]
v_pk_add_f32 v[98:99], v[98:99], v[106:107]
s_waitcnt vmcnt(11)
v_pk_add_f32 v[92:93], v[92:93], v[148:149]
v_pk_add_f32 v[94:95], v[94:95], v[150:151]
s_waitcnt vmcnt(10)
v_pk_add_f32 v[96:97], v[96:97], v[152:153]
v_pk_add_f32 v[98:99], v[98:99], v[154:155]
s_waitcnt vmcnt(9)
v_pk_add_f32 v[92:93], v[92:93], v[172:173]
v_pk_add_f32 v[94:95], v[94:95], v[174:175]
s_waitcnt vmcnt(8)
v_pk_add_f32 v[96:97], v[96:97], v[176:177]
v_pk_add_f32 v[98:99], v[98:99], v[178:179]
s_waitcnt vmcnt(7)
v_pk_add_f32 v[92:93], v[92:93], v[48:49]
v_pk_add_f32 v[94:95], v[94:95], v[50:51]
s_waitcnt vmcnt(6)
v_pk_add_f32 v[96:97], v[96:97], v[52:53]
v_pk_add_f32 v[98:99], v[98:99], v[54:55]
s_waitcnt vmcnt(5)
v_pk_add_f32 v[92:93], v[92:93], v[56:57]
v_pk_add_f32 v[94:95], v[94:95], v[58:59]
s_waitcnt vmcnt(4)
v_pk_add_f32 v[96:97], v[96:97], v[60:61]
v_pk_add_f32 v[98:99], v[98:99], v[62:63]
s_waitcnt vmcnt(3)
v_pk_add_f32 v[92:93], v[92:93], v[64:65]
v_pk_add_f32 v[94:95], v[94:95], v[66:67]
s_waitcnt vmcnt(2)
v_pk_add_f32 v[96:97], v[96:97], v[68:69]
v_pk_add_f32 v[98:99], v[98:99], v[70:71]
s_waitcnt vmcnt(1)
v_pk_add_f32 v[92:93], v[92:93], v[132:133]
v_pk_add_f32 v[94:95], v[94:95], v[134:135]
s_waitcnt vmcnt(0)
v_pk_add_f32 v[96:97], v[96:97], v[136:137]
v_pk_add_f32 v[98:99], v[98:99], v[138:139]
s_lshr_b32 s36, s28, 1
s_and_b32 s37, s28, 1
v_cvt_pk_bf16_f32 v156, v156, v157
v_cvt_pk_bf16_f32 v157, v158, v159
s_mul_i32 s36, s36, 3072
s_lshl_b32 s37, s37, 3
v_cvt_pk_bf16_f32 v92, v92, v93
v_cndmask_b32 v156, 0, v156, s[56:57]
v_cndmask_b32 v157, 0, v157, s[56:57]
s_add_u32 s36, s36, s37
v_cvt_pk_bf16_f32 v93, v94, v95
v_cvt_pk_bf16_f32 v94, v96, v97
v_cvt_pk_bf16_f32 v95, v98, v99
v_cndmask_b32 v156, v156, v16, s[58:59]
v_cndmask_b32 v157, v157, v16, s[58:59]
v_add_u32 v236, s36, v1
s_lshl_b32 s35, s30, 12
ds_write_b64 v236, v[92:93] offset:0
ds_write_b64 v236, v[94:95] offset:1024
ds_write_b64 v236, v[156:157] offset:2048
s_add_u32 s35, s35, 0x1e00000
s_add_u32 s94, s71, 0x10080
s_waitcnt lgkmcnt(0)
s_barrier
ds_read_b128 a[8:11], v1 offset:2048
ds_read_b128 a[20:23], v1 offset:5120
ds_read_b128 a[0:3], v1 offset:0
ds_read_b128 a[12:15], v1 offset:3072
ds_read_b128 a[4:7], v1 offset:1024
ds_read_b128 a[16:19], v1 offset:4096
s_waitcnt lgkmcnt(5)
v_mfma_f32_16x16x32_bf16 v[92:95], a[8:11], v[140:143], 0
s_waitcnt lgkmcnt(4)
v_mfma_f32_16x16x32_bf16 v[96:99], a[20:23], v[144:147], 0
s_waitcnt lgkmcnt(3)
v_mfma_f32_16x16x32_bf16 v[132:135], a[0:3], v[140:143], 0
s_nop 3
v_rcp_f32 v94, v93
s_waitcnt lgkmcnt(2)
v_mfma_f32_16x16x32_bf16 v[148:151], a[12:15], v[144:147], 0
v_rcp_f32 v95, v97
v_mul_f32 v92, v92, v94
v_fmac_f32 v92, v96, v95
v_mfma_f32_16x16x32_bf16 v[100:103], a[8:11], v[164:167], 0
v_add_f32 v92, 0x358637bd, v92
v_rcp_f32 v92, v92
s_waitcnt lgkmcnt(1)
v_mfma_f32_16x16x32_bf16 v[136:139], a[4:7], v[140:143], 0
v_mul_f32 v94, v94, v92
v_mul_f32 v95, v95, v92
v_mfma_f32_16x16x32_bf16 v[104:107], a[20:23], v[168:171], 0
v_mul_f32 v132, v132, v94
v_mul_f32 v133, v133, v94
s_waitcnt lgkmcnt(0)
v_mfma_f32_16x16x32_bf16 v[152:155], a[16:19], v[144:147], 0
v_mul_f32 v134, v134, v94
v_mul_f32 v135, v135, v94
v_fmac_f32 v132, v148, v95
v_fmac_f32 v133, v149, v95
v_rcp_f32 v102, v101
v_mul_f32 v136, v136, v94
v_mul_f32 v137, v137, v94
v_mul_f32 v138, v138, v94
v_mul_f32 v139, v139, v94
v_fmac_f32 v134, v150, v95
v_fmac_f32 v135, v151, v95
v_cvt_pk_bf16_f32 v132, v132, v133
v_rcp_f32 v103, v105
v_fmac_f32 v136, v152, v95
v_fmac_f32 v137, v153, v95
v_fmac_f32 v138, v154, v95
v_fmac_f32 v139, v155, v95
v_cvt_pk_bf16_f32 v133, v134, v135
v_cvt_pk_bf16_f32 v134, v136, v137
v_cvt_pk_bf16_f32 v135, v138, v139
v_mul_f32 v100, v100, v102
v_mfma_f32_16x16x32_bf16 v[156:159], a[0:3], v[164:167], 0
buffer_store_dwordx4 v[132:135], v2, s[4:7], s35 offen offset:0 sc1
v_fmac_f32 v100, v104, v103
v_mfma_f32_16x16x32_bf16 v[172:175], a[12:15], v[168:171], 0
v_add_f32 v100, 0x358637bd, v100
v_rcp_f32 v100, v100
v_mfma_f32_16x16x32_bf16 v[108:111], a[8:11], v[188:191], 0
v_mul_f32 v102, v102, v100
v_mul_f32 v103, v103, v100
v_mfma_f32_16x16x32_bf16 v[160:163], a[4:7], v[164:167], 0
v_mul_f32 v156, v156, v102
v_mul_f32 v157, v157, v102
v_mfma_f32_16x16x32_bf16 v[112:115], a[20:23], v[192:195], 0
v_mul_f32 v158, v158, v102
v_mul_f32 v159, v159, v102
v_mfma_f32_16x16x32_bf16 v[176:179], a[16:19], v[168:171], 0
v_fmac_f32 v156, v172, v103
v_fmac_f32 v157, v173, v103
v_rcp_f32 v110, v109
v_mul_f32 v160, v160, v102
v_mul_f32 v161, v161, v102
v_mul_f32 v162, v162, v102
v_mul_f32 v163, v163, v102
v_fmac_f32 v158, v174, v103
v_fmac_f32 v159, v175, v103
v_cvt_pk_bf16_f32 v156, v156, v157
v_rcp_f32 v111, v113
v_fmac_f32 v160, v176, v103
v_fmac_f32 v161, v177, v103
v_fmac_f32 v162, v178, v103
v_fmac_f32 v163, v179, v103
v_cvt_pk_bf16_f32 v157, v158, v159
v_cvt_pk_bf16_f32 v158, v160, v161
v_cvt_pk_bf16_f32 v159, v162, v163
v_mul_f32 v108, v108, v110
v_mfma_f32_16x16x32_bf16 v[180:183], a[0:3], v[188:191], 0
buffer_store_dwordx4 v[156:159], v2, s[4:7], s35 offen offset:1024 sc1
v_fmac_f32 v108, v112, v111
v_mfma_f32_16x16x32_bf16 v[196:199], a[12:15], v[192:195], 0
v_add_f32 v108, 0x358637bd, v108
v_rcp_f32 v108, v108
v_mfma_f32_16x16x32_bf16 v[116:119], a[8:11], v[212:215], 0
v_mul_f32 v110, v110, v108
v_mul_f32 v111, v111, v108
v_mfma_f32_16x16x32_bf16 v[184:187], a[4:7], v[188:191], 0
v_mul_f32 v180, v180, v110
v_mul_f32 v181, v181, v110
v_mfma_f32_16x16x32_bf16 v[120:123], a[20:23], v[216:219], 0
v_mul_f32 v182, v182, v110
v_mul_f32 v183, v183, v110
v_mfma_f32_16x16x32_bf16 v[200:203], a[16:19], v[192:195], 0
v_fmac_f32 v180, v196, v111
v_fmac_f32 v181, v197, v111
v_rcp_f32 v118, v117
v_mul_f32 v184, v184, v110
v_mul_f32 v185, v185, v110
v_mul_f32 v186, v186, v110
v_mul_f32 v187, v187, v110
v_fmac_f32 v182, v198, v111
v_fmac_f32 v183, v199, v111
v_cvt_pk_bf16_f32 v180, v180, v181
v_rcp_f32 v119, v121
v_fmac_f32 v184, v200, v111
v_fmac_f32 v185, v201, v111
v_fmac_f32 v186, v202, v111
v_fmac_f32 v187, v203, v111
v_cvt_pk_bf16_f32 v181, v182, v183
v_cvt_pk_bf16_f32 v182, v184, v185
v_cvt_pk_bf16_f32 v183, v186, v187
v_mul_f32 v116, v116, v118
v_mfma_f32_16x16x32_bf16 v[204:207], a[0:3], v[212:215], 0
buffer_store_dwordx4 v[180:183], v2, s[4:7], s35 offen offset:2048 sc1
v_fmac_f32 v116, v120, v119
v_mfma_f32_16x16x32_bf16 v[220:223], a[12:15], v[216:219], 0
v_add_f32 v116, 0x358637bd, v116
v_rcp_f32 v116, v116
v_mfma_f32_16x16x32_bf16 v[208:211], a[4:7], v[212:215], 0
v_mul_f32 v118, v118, v116
v_mul_f32 v119, v119, v116
v_mfma_f32_16x16x32_bf16 v[224:227], a[16:19], v[216:219], 0
v_mul_f32 v204, v204, v118
v_mul_f32 v205, v205, v118
v_mul_f32 v206, v206, v118
v_mul_f32 v207, v207, v118
v_fmac_f32 v204, v220, v119
v_fmac_f32 v205, v221, v119
v_mul_f32 v208, v208, v118
v_mul_f32 v209, v209, v118
v_mul_f32 v210, v210, v118
v_mul_f32 v211, v211, v118
v_fmac_f32 v206, v222, v119
v_fmac_f32 v207, v223, v119
v_cvt_pk_bf16_f32 v204, v204, v205
v_fmac_f32 v208, v224, v119
v_fmac_f32 v209, v225, v119
v_fmac_f32 v210, v226, v119
v_fmac_f32 v211, v227, v119
v_cvt_pk_bf16_f32 v205, v206, v207
v_cvt_pk_bf16_f32 v206, v208, v209
v_cvt_pk_bf16_f32 v207, v210, v211
buffer_store_dwordx4 v[204:207], v2, s[4:7], s35 offen offset:3072 sc1
s_add_u32 s92, s71, 0x10000
s_add_u32 s40, s4, 0x1e00000
s_addc_u32 s41, s5, 0
v_add_u32 v5, 32768, v1
v_add_u32 v6, 98304, v1
s_cmp_eq_u32 s3, 0
s_cselect_b32 s35, 8, 0
s_lshl_b32 s35, s35, 12
v_lshlrev_b32 v132, 16, v32
v_and_b32 v133, 0xffff0000, v32
v_lshlrev_b32 v134, 16, v33
v_and_b32 v135, 0xffff0000, v33
v_lshlrev_b32 v136, 16, v34
v_and_b32 v137, 0xffff0000, v34
v_lshlrev_b32 v138, 16, v35
v_and_b32 v139, 0xffff0000, v35
v_lshlrev_b32 v140, 16, v36
v_and_b32 v141, 0xffff0000, v36
v_lshlrev_b32 v142, 16, v37
v_and_b32 v143, 0xffff0000, v37
v_lshlrev_b32 v144, 16, v38
v_and_b32 v145, 0xffff0000, v38
v_lshlrev_b32 v146, 16, v39
v_and_b32 v147, 0xffff0000, v39
v_lshlrev_b32 v148, 16, v40
v_and_b32 v149, 0xffff0000, v40
v_lshlrev_b32 v150, 16, v41
v_and_b32 v151, 0xffff0000, v41
v_lshlrev_b32 v152, 16, v42
v_and_b32 v153, 0xffff0000, v42
v_lshlrev_b32 v154, 16, v43
v_and_b32 v155, 0xffff0000, v43
v_lshlrev_b32 v156, 16, v44
v_and_b32 v157, 0xffff0000, v44
v_lshlrev_b32 v158, 16, v45
v_and_b32 v159, 0xffff0000, v45
v_lshlrev_b32 v160, 16, v46
v_and_b32 v161, 0xffff0000, v46
v_lshlrev_b32 v162, 16, v47
v_and_b32 v163, 0xffff0000, v47
s_waitcnt vmcnt(0)
s_barrier
s_cmp_lg_u32 s28, 1
s_cbranch_scc1 Lsg_21
buffer_atomic_add v12, v10, s[4:7], s92 offen sc1
Lsg_21:
s_cmp_lg_u32 s28, 1
s_cbranch_scc1 L_wskip3
s_mov_b64 exec, 0
s_branch L_stub9
L_wret3:
s_mov_b64 exec, -1
L_wskip3:
s_cmp_lt_u32 s28, 2
s_cbranch_scc1 Lwo_22
s_add_i32 s44, s28, 0
s_lshl_b32 s45, s44, 12
s_add_u32 m0, s45, 32768
s_and_b32 s45, s44, 7
s_cmp_eq_u32 s45, s3
s_cselect_b32 s45, 8, 0
s_add_u32 s44, s44, s45
s_and_b32 s44, s44, 31
s_lshl_b32 s44, s44, 12
s_add_u32 s44, s44, s51
s_add_u32 s44, s44, 0x200000
buffer_load_dwordx4 v1, s[4:7], s44 offen offset:0 sc1 lds
buffer_load_dwordx4 v1, s[4:7], s44 offen offset:1024 sc1 lds
buffer_load_dwordx4 v1, s[4:7], s44 offen offset:2048 sc1 lds
buffer_load_dwordx4 v1, s[4:7], s44 offen offset:3072 sc1 lds
s_add_i32 s44, s28, -2
s_lshl_b32 s45, s44, 12
s_add_u32 m0, s45, 32768
s_and_b32 s45, s44, 7
s_cmp_eq_u32 s45, s3
s_cselect_b32 s45, 8, 0
s_add_u32 s44, s44, s45
s_and_b32 s44, s44, 31
s_lshl_b32 s44, s44, 12
s_add_u32 s44, s44, s51
s_add_u32 s44, s44, 0x200000
buffer_load_dwordx4 v1, s[4:7], s44 offen offset:0 sc1 lds
buffer_load_dwordx4 v1, s[4:7], s44 offen offset:1024 sc1 lds
buffer_load_dwordx4 v1, s[4:7], s44 offen offset:2048 sc1 lds
buffer_load_dwordx4 v1, s[4:7], s44 offen offset:3072 sc1 lds
Lwo_22:
s_cmp_lg_u32 s28, 0
s_cbranch_scc1 Lpe_24
s_add_u32 s36, s66, 0x10000
s_mov_b32 s37, 0
Lpoll_23:
v_mov_b32 v11, 0
s_mov_b64 exec, 1
buffer_atomic_add v11, off, s[4:7], s36 sc0 sc1
s_waitcnt vmcnt(0)
v_readfirstlane_b32 s38, v11
s_mov_b64 exec, -1
s_nop 0
v_mov_b32 v11, s38
s_add_u32 s37, s37, 1
v_cmp_gt_u32 vcc, 32, v11
s_cbranch_vccz Lpe_24
s_cmp_lt_u32 s37, 0x100000
s_cbranch_scc1 Lpoll_23
Lpe_24:
s_waitcnt vmcnt(0)
s_barrier
L_k2go1:
buffer_load_dwordx4 a[0:3], v4, s[40:43], s35 offen offset:0 sc1
buffer_load_dwordx4 a[4:7], v4, s[40:43], s35 offen offset:1024 sc1
s_cmp_eq_u32 s3, 1
s_cselect_b32 s35, 9, 1
s_lshl_b32 s35, s35, 12
buffer_load_dwordx4 a[8:11], v4, s[40:43], s35 offen offset:0 sc1
buffer_load_dwordx4 a[12:15], v4, s[40:43], s35 offen offset:1024 sc1
s_cmp_eq_u32 s3, 2
s_cselect_b32 s35, 10, 2
s_lshl_b32 s35, s35, 12
buffer_load_dwordx4 a[16:19], v4, s[40:43], s35 offen offset:0 sc1
buffer_load_dwordx4 a[20:23], v4, s[40:43], s35 offen offset:1024 sc1
s_cmp_eq_u32 s3, 3
s_cselect_b32 s35, 11, 3
s_lshl_b32 s35, s35, 12
buffer_load_dwordx4 a[24:27], v4, s[40:43], s35 offen offset:0 sc1
buffer_load_dwordx4 a[28:31], v4, s[40:43], s35 offen offset:1024 sc1
s_cmp_eq_u32 s3, 4
s_cselect_b32 s35, 12, 4
s_lshl_b32 s35, s35, 12
buffer_load_dwordx4 a[32:35], v4, s[40:43], s35 offen offset:0 sc1
buffer_load_dwordx4 a[36:39], v4, s[40:43], s35 offen offset:1024 sc1
s_cmp_eq_u32 s3, 5
s_cselect_b32 s35, 13, 5
s_lshl_b32 s35, s35, 12
ds_read_b128 a[96:99], v5 offset:0
ds_read_b128 a[100:103], v5 offset:1024
ds_read_b128 a[104:107], v5 offset:2048
ds_read_b128 a[108:111], v5 offset:3072
ds_read_b128 a[112:115], v5 offset:4096
ds_read_b128 a[116:119], v5 offset:5120
ds_read_b128 a[120:123], v5 offset:6144
ds_read_b128 a[124:127], v5 offset:7168
s_waitcnt vmcnt(8) lgkmcnt(4)
v_mfma_f32_16x16x32_bf16 v[132:135], a[96:99], a[0:3], v[132:135]
ds_read_b128 a[128:131], v5 offset:8192
v_mfma_f32_16x16x32_bf16 v[148:151], a[96:99], a[4:7], v[148:151]
ds_read_b128 a[132:135], v5 offset:9216
v_mfma_f32_16x16x32_bf16 v[152:155], a[100:103], a[4:7], v[152:155]
buffer_load_dwordx4 a[40:43], v4, s[40:43], s35 offen offset:0 sc1
v_mfma_f32_16x16x32_bf16 v[136:139], a[100:103], a[0:3], v[136:139]
ds_read_b128 a[136:139], v5 offset:10240
v_mfma_f32_16x16x32_bf16 v[140:143], a[104:107], a[0:3], v[140:143]
ds_read_b128 a[140:143], v5 offset:11264
v_mfma_f32_16x16x32_bf16 v[156:159], a[104:107], a[4:7], v[156:159]
v_mfma_f32_16x16x32_bf16 v[160:163], a[108:111], a[4:7], v[160:163]
buffer_load_dwordx4 a[44:47], v4, s[40:43], s35 offen offset:1024 sc1
v_mfma_f32_16x16x32_bf16 v[144:147], a[108:111], a[0:3], v[144:147]
L_stub9:
s_cbranch_execz L_stub10
s_waitcnt vmcnt(8) lgkmcnt(4)
v_mfma_f32_16x16x32_bf16 v[132:135], a[112:115], a[8:11], v[132:135]
s_cmp_eq_u32 s3, 6
s_cselect_b32 s35, 14, 6
s_lshl_b32 s35, s35, 12
v_mfma_f32_16x16x32_bf16 v[148:151], a[112:115], a[12:15], v[148:151]
ds_read_b128 a[96:99], v5 offset:12288
v_mfma_f32_16x16x32_bf16 v[152:155], a[116:119], a[12:15], v[152:155]
buffer_load_dwordx4 a[0:3], v4, s[40:43], s35 offen offset:0 sc1
v_mfma_f32_16x16x32_bf16 v[136:139], a[116:119], a[8:11], v[136:139]
ds_read_b128 a[100:103], v5 offset:13312
v_mfma_f32_16x16x32_bf16 v[140:143], a[120:123], a[8:11], v[140:143]
ds_read_b128 a[104:107], v5 offset:14336
v_mfma_f32_16x16x32_bf16 v[156:159], a[120:123], a[12:15], v[156:159]
ds_read_b128 a[108:111], v5 offset:15360
v_mfma_f32_16x16x32_bf16 v[160:163], a[124:127], a[12:15], v[160:163]
buffer_load_dwordx4 a[4:7], v4, s[40:43], s35 offen offset:1024 sc1
v_mfma_f32_16x16x32_bf16 v[144:147], a[124:127], a[8:11], v[144:147]
s_waitcnt vmcnt(8) lgkmcnt(4)
v_mfma_f32_16x16x32_bf16 v[132:135], a[128:131], a[16:19], v[132:135]
s_cmp_eq_u32 s3, 7
s_cselect_b32 s35, 15, 7
s_lshl_b32 s35, s35, 12
v_mfma_f32_16x16x32_bf16 v[148:151], a[128:131], a[20:23], v[148:151]
ds_read_b128 a[112:115], v5 offset:16384
v_mfma_f32_16x16x32_bf16 v[152:155], a[132:135], a[20:23], v[152:155]
buffer_load_dwordx4 a[8:11], v4, s[40:43], s35 offen offset:0 sc1
v_mfma_f32_16x16x32_bf16 v[136:139], a[132:135], a[16:19], v[136:139]
ds_read_b128 a[116:119], v5 offset:17408
v_mfma_f32_16x16x32_bf16 v[140:143], a[136:139], a[16:19], v[140:143]
ds_read_b128 a[120:123], v5 offset:18432
v_mfma_f32_16x16x32_bf16 v[156:159], a[136:139], a[20:23], v[156:159]
ds_read_b128 a[124:127], v5 offset:19456
v_mfma_f32_16x16x32_bf16 v[160:163], a[140:143], a[20:23], v[160:163]
buffer_load_dwordx4 a[12:15], v4, s[40:43], s35 offen offset:1024 sc1
v_mfma_f32_16x16x32_bf16 v[144:147], a[140:143], a[16:19], v[144:147]
s_waitcnt vmcnt(8) lgkmcnt(4)
v_mfma_f32_16x16x32_bf16 v[132:135], a[96:99], a[24:27], v[132:135]
s_cmp_eq_u32 s3, 0
s_cselect_b32 s35, 16, 8
s_lshl_b32 s35, s35, 12
v_mfma_f32_16x16x32_bf16 v[148:151], a[96:99], a[28:31], v[148:151]
ds_read_b128 a[128:131], v5 offset:20480
v_mfma_f32_16x16x32_bf16 v[152:155], a[100:103], a[28:31], v[152:155]
buffer_load_dwordx4 a[16:19], v4, s[40:43], s35 offen offset:0 sc1
v_mfma_f32_16x16x32_bf16 v[136:139], a[100:103], a[24:27], v[136:139]
ds_read_b128 a[132:135], v5 offset:21504
v_mfma_f32_16x16x32_bf16 v[140:143], a[104:107], a[24:27], v[140:143]
ds_read_b128 a[136:139], v5 offset:22528
v_mfma_f32_16x16x32_bf16 v[156:159], a[104:107], a[28:31], v[156:159]
ds_read_b128 a[140:143], v5 offset:23552
v_mfma_f32_16x16x32_bf16 v[160:163], a[108:111], a[28:31], v[160:163]
buffer_load_dwordx4 a[20:23], v4, s[40:43], s35 offen offset:1024 sc1
v_mfma_f32_16x16x32_bf16 v[144:147], a[108:111], a[24:27], v[144:147]
s_waitcnt vmcnt(8) lgkmcnt(4)
v_mfma_f32_16x16x32_bf16 v[132:135], a[112:115], a[32:35], v[132:135]
s_cmp_eq_u32 s3, 1
s_cselect_b32 s35, 17, 9
s_lshl_b32 s35, s35, 12
v_mfma_f32_16x16x32_bf16 v[148:151], a[112:115], a[36:39], v[148:151]
ds_read_b128 a[96:99], v5 offset:24576
v_mfma_f32_16x16x32_bf16 v[152:155], a[116:119], a[36:39], v[152:155]
buffer_load_dwordx4 a[24:27], v4, s[40:43], s35 offen offset:0 sc1
v_mfma_f32_16x16x32_bf16 v[136:139], a[116:119], a[32:35], v[136:139]
ds_read_b128 a[100:103], v5 offset:25600
v_mfma_f32_16x16x32_bf16 v[140:143], a[120:123], a[32:35], v[140:143]
ds_read_b128 a[104:107], v5 offset:26624
v_mfma_f32_16x16x32_bf16 v[156:159], a[120:123], a[36:39], v[156:159]
ds_read_b128 a[108:111], v5 offset:27648
v_mfma_f32_16x16x32_bf16 v[160:163], a[124:127], a[36:39], v[160:163]
buffer_load_dwordx4 a[28:31], v4, s[40:43], s35 offen offset:1024 sc1
v_mfma_f32_16x16x32_bf16 v[144:147], a[124:127], a[32:35], v[144:147]
s_waitcnt vmcnt(8) lgkmcnt(4)
v_mfma_f32_16x16x32_bf16 v[132:135], a[128:131], a[40:43], v[132:135]
s_cmp_eq_u32 s3, 2
s_cselect_b32 s35, 18, 10
s_lshl_b32 s35, s35, 12
v_mfma_f32_16x16x32_bf16 v[148:151], a[128:131], a[44:47], v[148:151]
ds_read_b128 a[112:115], v5 offset:28672
v_mfma_f32_16x16x32_bf16 v[152:155], a[132:135], a[44:47], v[152:155]
buffer_load_dwordx4 a[32:35], v4, s[40:43], s35 offen offset:0 sc1
v_mfma_f32_16x16x32_bf16 v[136:139], a[132:135], a[40:43], v[136:139]
ds_read_b128 a[116:119], v5 offset:29696
v_mfma_f32_16x16x32_bf16 v[140:143], a[136:139], a[40:43], v[140:143]
ds_read_b128 a[120:123], v5 offset:30720
v_mfma_f32_16x16x32_bf16 v[156:159], a[136:139], a[44:47], v[156:159]
ds_read_b128 a[124:127], v5 offset:31744
v_mfma_f32_16x16x32_bf16 v[160:163], a[140:143], a[44:47], v[160:163]
buffer_load_dwordx4 a[36:39], v4, s[40:43], s35 offen offset:1024 sc1
v_mfma_f32_16x16x32_bf16 v[144:147], a[140:143], a[40:43], v[144:147]
s_waitcnt vmcnt(8) lgkmcnt(4)
v_mfma_f32_16x16x32_bf16 v[132:135], a[96:99], a[0:3], v[132:135]
s_cmp_eq_u32 s3, 3
s_cselect_b32 s35, 19, 11
s_lshl_b32 s35, s35, 12
v_mfma_f32_16x16x32_bf16 v[148:151], a[96:99], a[4:7], v[148:151]
ds_read_b128 a[128:131], v5 offset:32768
v_mfma_f32_16x16x32_bf16 v[152:155], a[100:103], a[4:7], v[152:155]
buffer_load_dwordx4 a[40:43], v4, s[40:43], s35 offen offset:0 sc1
v_mfma_f32_16x16x32_bf16 v[136:139], a[100:103], a[0:3], v[136:139]
ds_read_b128 a[132:135], v5 offset:33792
v_mfma_f32_16x16x32_bf16 v[140:143], a[104:107], a[0:3], v[140:143]
ds_read_b128 a[136:139], v5 offset:34816
v_mfma_f32_16x16x32_bf16 v[156:159], a[104:107], a[4:7], v[156:159]
ds_read_b128 a[140:143], v5 offset:35840
v_mfma_f32_16x16x32_bf16 v[160:163], a[108:111], a[4:7], v[160:163]
buffer_load_dwordx4 a[44:47], v4, s[40:43], s35 offen offset:1024 sc1
v_mfma_f32_16x16x32_bf16 v[144:147], a[108:111], a[0:3], v[144:147]
s_waitcnt vmcnt(8) lgkmcnt(4)
v_mfma_f32_16x16x32_bf16 v[132:135], a[112:115], a[8:11], v[132:135]
s_cmp_eq_u32 s3, 4
s_cselect_b32 s35, 20, 12
s_lshl_b32 s35, s35, 12
v_mfma_f32_16x16x32_bf16 v[148:151], a[112:115], a[12:15], v[148:151]
ds_read_b128 a[96:99], v5 offset:36864
v_mfma_f32_16x16x32_bf16 v[152:155], a[116:119], a[12:15], v[152:155]
buffer_load_dwordx4 a[0:3], v4, s[40:43], s35 offen offset:0 sc1
v_mfma_f32_16x16x32_bf16 v[136:139], a[116:119], a[8:11], v[136:139]
ds_read_b128 a[100:103], v5 offset:37888
v_mfma_f32_16x16x32_bf16 v[140:143], a[120:123], a[8:11], v[140:143]
ds_read_b128 a[104:107], v5 offset:38912
v_mfma_f32_16x16x32_bf16 v[156:159], a[120:123], a[12:15], v[156:159]
ds_read_b128 a[108:111], v5 offset:39936
v_mfma_f32_16x16x32_bf16 v[160:163], a[124:127], a[12:15], v[160:163]
buffer_load_dwordx4 a[4:7], v4, s[40:43], s35 offen offset:1024 sc1
v_mfma_f32_16x16x32_bf16 v[144:147], a[124:127], a[8:11], v[144:147]
s_waitcnt vmcnt(8) lgkmcnt(4)
v_mfma_f32_16x16x32_bf16 v[132:135], a[128:131], a[16:19], v[132:135]
s_cmp_eq_u32 s3, 5
s_cselect_b32 s35, 21, 13
s_lshl_b32 s35, s35, 12
v_mfma_f32_16x16x32_bf16 v[148:151], a[128:131], a[20:23], v[148:151]
ds_read_b128 a[112:115], v5 offset:40960
v_mfma_f32_16x16x32_bf16 v[152:155], a[132:135], a[20:23], v[152:155]
buffer_load_dwordx4 a[8:11], v4, s[40:43], s35 offen offset:0 sc1
v_mfma_f32_16x16x32_bf16 v[136:139], a[132:135], a[16:19], v[136:139]
ds_read_b128 a[116:119], v5 offset:41984
v_mfma_f32_16x16x32_bf16 v[140:143], a[136:139], a[16:19], v[140:143]
ds_read_b128 a[120:123], v5 offset:43008
v_mfma_f32_16x16x32_bf16 v[156:159], a[136:139], a[20:23], v[156:159]
ds_read_b128 a[124:127], v5 offset:44032
v_mfma_f32_16x16x32_bf16 v[160:163], a[140:143], a[20:23], v[160:163]
buffer_load_dwordx4 a[12:15], v4, s[40:43], s35 offen offset:1024 sc1
v_mfma_f32_16x16x32_bf16 v[144:147], a[140:143], a[16:19], v[144:147]
s_waitcnt vmcnt(8) lgkmcnt(4)
v_mfma_f32_16x16x32_bf16 v[132:135], a[96:99], a[24:27], v[132:135]
s_cmp_eq_u32 s3, 6
s_cselect_b32 s35, 22, 14
s_lshl_b32 s35, s35, 12
v_mfma_f32_16x16x32_bf16 v[148:151], a[96:99], a[28:31], v[148:151]
ds_read_b128 a[128:131], v5 offset:45056
v_mfma_f32_16x16x32_bf16 v[152:155], a[100:103], a[28:31], v[152:155]
buffer_load_dwordx4 a[16:19], v4, s[40:43], s35 offen offset:0 sc1
v_mfma_f32_16x16x32_bf16 v[136:139], a[100:103], a[24:27], v[136:139]
ds_read_b128 a[132:135], v5 offset:46080
v_mfma_f32_16x16x32_bf16 v[140:143], a[104:107], a[24:27], v[140:143]
ds_read_b128 a[136:139], v5 offset:47104
v_mfma_f32_16x16x32_bf16 v[156:159], a[104:107], a[28:31], v[156:159]
ds_read_b128 a[140:143], v5 offset:48128
v_mfma_f32_16x16x32_bf16 v[160:163], a[108:111], a[28:31], v[160:163]
buffer_load_dwordx4 a[20:23], v4, s[40:43], s35 offen offset:1024 sc1
v_mfma_f32_16x16x32_bf16 v[144:147], a[108:111], a[24:27], v[144:147]
s_waitcnt vmcnt(8) lgkmcnt(4)
v_mfma_f32_16x16x32_bf16 v[132:135], a[112:115], a[32:35], v[132:135]
s_cmp_eq_u32 s3, 7
s_cselect_b32 s35, 23, 15
s_lshl_b32 s35, s35, 12
v_mfma_f32_16x16x32_bf16 v[148:151], a[112:115], a[36:39], v[148:151]
ds_read_b128 a[96:99], v5 offset:49152
v_mfma_f32_16x16x32_bf16 v[152:155], a[116:119], a[36:39], v[152:155]
buffer_load_dwordx4 a[24:27], v4, s[40:43], s35 offen offset:0 sc1
v_mfma_f32_16x16x32_bf16 v[136:139], a[116:119], a[32:35], v[136:139]
ds_read_b128 a[100:103], v5 offset:50176
v_mfma_f32_16x16x32_bf16 v[140:143], a[120:123], a[32:35], v[140:143]
ds_read_b128 a[104:107], v5 offset:51200
v_mfma_f32_16x16x32_bf16 v[156:159], a[120:123], a[36:39], v[156:159]
ds_read_b128 a[108:111], v5 offset:52224
v_mfma_f32_16x16x32_bf16 v[160:163], a[124:127], a[36:39], v[160:163]
buffer_load_dwordx4 a[28:31], v4, s[40:43], s35 offen offset:1024 sc1
v_mfma_f32_16x16x32_bf16 v[144:147], a[124:127], a[32:35], v[144:147]
s_waitcnt vmcnt(8) lgkmcnt(4)
v_mfma_f32_16x16x32_bf16 v[132:135], a[128:131], a[40:43], v[132:135]
s_cmp_eq_u32 s3, 0
s_cselect_b32 s35, 24, 16
s_lshl_b32 s35, s35, 12
v_mfma_f32_16x16x32_bf16 v[148:151], a[128:131], a[44:47], v[148:151]
ds_read_b128 a[112:115], v5 offset:53248
v_mfma_f32_16x16x32_bf16 v[152:155], a[132:135], a[44:47], v[152:155]
buffer_load_dwordx4 a[32:35], v4, s[40:43], s35 offen offset:0 sc1
v_mfma_f32_16x16x32_bf16 v[136:139], a[132:135], a[40:43], v[136:139]
ds_read_b128 a[116:119], v5 offset:54272
v_mfma_f32_16x16x32_bf16 v[140:143], a[136:139], a[40:43], v[140:143]
ds_read_b128 a[120:123], v5 offset:55296
v_mfma_f32_16x16x32_bf16 v[156:159], a[136:139], a[44:47], v[156:159]
ds_read_b128 a[124:127], v5 offset:56320
v_mfma_f32_16x16x32_bf16 v[160:163], a[140:143], a[44:47], v[160:163]
buffer_load_dwordx4 a[36:39], v4, s[40:43], s35 offen offset:1024 sc1
v_mfma_f32_16x16x32_bf16 v[144:147], a[140:143], a[40:43], v[144:147]
s_waitcnt vmcnt(8) lgkmcnt(4)
v_mfma_f32_16x16x32_bf16 v[132:135], a[96:99], a[0:3], v[132:135]
s_cmp_eq_u32 s3, 1
s_cselect_b32 s35, 25, 17
s_lshl_b32 s35, s35, 12
v_mfma_f32_16x16x32_bf16 v[148:151], a[96:99], a[4:7], v[148:151]
ds_read_b128 a[128:131], v5 offset:57344
v_mfma_f32_16x16x32_bf16 v[152:155], a[100:103], a[4:7], v[152:155]
buffer_load_dwordx4 a[40:43], v4, s[40:43], s35 offen offset:0 sc1
v_mfma_f32_16x16x32_bf16 v[136:139], a[100:103], a[0:3], v[136:139]
ds_read_b128 a[132:135], v5 offset:58368
v_mfma_f32_16x16x32_bf16 v[140:143], a[104:107], a[0:3], v[140:143]
ds_read_b128 a[136:139], v5 offset:59392
v_mfma_f32_16x16x32_bf16 v[156:159], a[104:107], a[4:7], v[156:159]
ds_read_b128 a[140:143], v5 offset:60416
v_mfma_f32_16x16x32_bf16 v[160:163], a[108:111], a[4:7], v[160:163]
buffer_load_dwordx4 a[44:47], v4, s[40:43], s35 offen offset:1024 sc1
v_mfma_f32_16x16x32_bf16 v[144:147], a[108:111], a[0:3], v[144:147]
s_waitcnt vmcnt(8) lgkmcnt(4)
v_mfma_f32_16x16x32_bf16 v[132:135], a[112:115], a[8:11], v[132:135]
s_cmp_eq_u32 s3, 2
s_cselect_b32 s35, 26, 18
s_lshl_b32 s35, s35, 12
v_mfma_f32_16x16x32_bf16 v[148:151], a[112:115], a[12:15], v[148:151]
ds_read_b128 a[96:99], v5 offset:61440
v_mfma_f32_16x16x32_bf16 v[152:155], a[116:119], a[12:15], v[152:155]
buffer_load_dwordx4 a[0:3], v4, s[40:43], s35 offen offset:0 sc1
v_mfma_f32_16x16x32_bf16 v[136:139], a[116:119], a[8:11], v[136:139]
ds_read_b128 a[100:103], v5 offset:62464
v_mfma_f32_16x16x32_bf16 v[140:143], a[120:123], a[8:11], v[140:143]
ds_read_b128 a[104:107], v5 offset:63488
v_mfma_f32_16x16x32_bf16 v[156:159], a[120:123], a[12:15], v[156:159]
ds_read_b128 a[108:111], v5 offset:64512
v_mfma_f32_16x16x32_bf16 v[160:163], a[124:127], a[12:15], v[160:163]
buffer_load_dwordx4 a[4:7], v4, s[40:43], s35 offen offset:1024 sc1
v_mfma_f32_16x16x32_bf16 v[144:147], a[124:127], a[8:11], v[144:147]
s_waitcnt vmcnt(8) lgkmcnt(4)
v_mfma_f32_16x16x32_bf16 v[132:135], a[128:131], a[16:19], v[132:135]
s_cmp_eq_u32 s3, 3
s_cselect_b32 s35, 27, 19
s_lshl_b32 s35, s35, 12
v_mfma_f32_16x16x32_bf16 v[148:151], a[128:131], a[20:23], v[148:151]
ds_read_b128 a[112:115], v6 offset:0
v_mfma_f32_16x16x32_bf16 v[152:155], a[132:135], a[20:23], v[152:155]
buffer_load_dwordx4 a[8:11], v4, s[40:43], s35 offen offset:0 sc1
v_mfma_f32_16x16x32_bf16 v[136:139], a[132:135], a[16:19], v[136:139]
ds_read_b128 a[116:119], v6 offset:1024
v_mfma_f32_16x16x32_bf16 v[140:143], a[136:139], a[16:19], v[140:143]
ds_read_b128 a[120:123], v6 offset:2048
v_mfma_f32_16x16x32_bf16 v[156:159], a[136:139], a[20:23], v[156:159]
ds_read_b128 a[124:127], v6 offset:3072
v_mfma_f32_16x16x32_bf16 v[160:163], a[140:143], a[20:23], v[160:163]
buffer_load_dwordx4 a[12:15], v4, s[40:43], s35 offen offset:1024 sc1
v_mfma_f32_16x16x32_bf16 v[144:147], a[140:143], a[16:19], v[144:147]
s_waitcnt vmcnt(8) lgkmcnt(4)
v_mfma_f32_16x16x32_bf16 v[132:135], a[96:99], a[24:27], v[132:135]
s_cmp_eq_u32 s3, 4
s_cselect_b32 s35, 28, 20
s_lshl_b32 s35, s35, 12
v_mfma_f32_16x16x32_bf16 v[148:151], a[96:99], a[28:31], v[148:151]
ds_read_b128 a[128:131], v6 offset:4096
v_mfma_f32_16x16x32_bf16 v[152:155], a[100:103], a[28:31], v[152:155]
buffer_load_dwordx4 a[16:19], v4, s[40:43], s35 offen offset:0 sc1
v_mfma_f32_16x16x32_bf16 v[136:139], a[100:103], a[24:27], v[136:139]
ds_read_b128 a[132:135], v6 offset:5120
v_mfma_f32_16x16x32_bf16 v[140:143], a[104:107], a[24:27], v[140:143]
ds_read_b128 a[136:139], v6 offset:6144
v_mfma_f32_16x16x32_bf16 v[156:159], a[104:107], a[28:31], v[156:159]
ds_read_b128 a[140:143], v6 offset:7168
v_mfma_f32_16x16x32_bf16 v[160:163], a[108:111], a[28:31], v[160:163]
buffer_load_dwordx4 a[20:23], v4, s[40:43], s35 offen offset:1024 sc1
v_mfma_f32_16x16x32_bf16 v[144:147], a[108:111], a[24:27], v[144:147]
s_waitcnt vmcnt(8) lgkmcnt(4)
v_mfma_f32_16x16x32_bf16 v[132:135], a[112:115], a[32:35], v[132:135]
s_cmp_eq_u32 s3, 5
s_cselect_b32 s35, 29, 21
s_lshl_b32 s35, s35, 12
v_mfma_f32_16x16x32_bf16 v[148:151], a[112:115], a[36:39], v[148:151]
ds_read_b128 a[96:99], v6 offset:8192
v_mfma_f32_16x16x32_bf16 v[152:155], a[116:119], a[36:39], v[152:155]
buffer_load_dwordx4 a[24:27], v4, s[40:43], s35 offen offset:0 sc1
v_mfma_f32_16x16x32_bf16 v[136:139], a[116:119], a[32:35], v[136:139]
ds_read_b128 a[100:103], v6 offset:9216
v_mfma_f32_16x16x32_bf16 v[140:143], a[120:123], a[32:35], v[140:143]
ds_read_b128 a[104:107], v6 offset:10240
v_mfma_f32_16x16x32_bf16 v[156:159], a[120:123], a[36:39], v[156:159]
ds_read_b128 a[108:111], v6 offset:11264
v_mfma_f32_16x16x32_bf16 v[160:163], a[124:127], a[36:39], v[160:163]
buffer_load_dwordx4 a[28:31], v4, s[40:43], s35 offen offset:1024 sc1
v_mfma_f32_16x16x32_bf16 v[144:147], a[124:127], a[32:35], v[144:147]
s_waitcnt vmcnt(8) lgkmcnt(4)
v_mfma_f32_16x16x32_bf16 v[132:135], a[128:131], a[40:43], v[132:135]
s_cmp_eq_u32 s3, 6
s_cselect_b32 s35, 30, 22
s_lshl_b32 s35, s35, 12
v_mfma_f32_16x16x32_bf16 v[148:151], a[128:131], a[44:47], v[148:151]
ds_read_b128 a[112:115], v6 offset:12288
v_mfma_f32_16x16x32_bf16 v[152:155], a[132:135], a[44:47], v[152:155]
buffer_load_dwordx4 a[32:35], v4, s[40:43], s35 offen offset:0 sc1
v_mfma_f32_16x16x32_bf16 v[136:139], a[132:135], a[40:43], v[136:139]
ds_read_b128 a[116:119], v6 offset:13312
v_mfma_f32_16x16x32_bf16 v[140:143], a[136:139], a[40:43], v[140:143]
ds_read_b128 a[120:123], v6 offset:14336
v_mfma_f32_16x16x32_bf16 v[156:159], a[136:139], a[44:47], v[156:159]
ds_read_b128 a[124:127], v6 offset:15360
v_mfma_f32_16x16x32_bf16 v[160:163], a[140:143], a[44:47], v[160:163]
buffer_load_dwordx4 a[36:39], v4, s[40:43], s35 offen offset:1024 sc1
v_mfma_f32_16x16x32_bf16 v[144:147], a[140:143], a[40:43], v[144:147]
s_waitcnt vmcnt(8) lgkmcnt(4)
v_mfma_f32_16x16x32_bf16 v[132:135], a[96:99], a[0:3], v[132:135]
s_cmp_eq_u32 s3, 7
s_cselect_b32 s35, 31, 23
s_lshl_b32 s35, s35, 12
v_mfma_f32_16x16x32_bf16 v[148:151], a[96:99], a[4:7], v[148:151]
ds_read_b128 a[128:131], v6 offset:16384
v_mfma_f32_16x16x32_bf16 v[152:155], a[100:103], a[4:7], v[152:155]
buffer_load_dwordx4 a[40:43], v4, s[40:43], s35 offen offset:0 sc1
v_mfma_f32_16x16x32_bf16 v[136:139], a[100:103], a[0:3], v[136:139]
ds_read_b128 a[132:135], v6 offset:17408
v_mfma_f32_16x16x32_bf16 v[140:143], a[104:107], a[0:3], v[140:143]
ds_read_b128 a[136:139], v6 offset:18432
v_mfma_f32_16x16x32_bf16 v[156:159], a[104:107], a[4:7], v[156:159]
ds_read_b128 a[140:143], v6 offset:19456
v_mfma_f32_16x16x32_bf16 v[160:163], a[108:111], a[4:7], v[160:163]
buffer_load_dwordx4 a[44:47], v4, s[40:43], s35 offen offset:1024 sc1
v_mfma_f32_16x16x32_bf16 v[144:147], a[108:111], a[0:3], v[144:147]
s_waitcnt vmcnt(8) lgkmcnt(4)
v_mfma_f32_16x16x32_bf16 v[132:135], a[112:115], a[8:11], v[132:135]
s_cmp_eq_u32 s3, 0
s_cselect_b32 s35, 0, 24
s_lshl_b32 s35, s35, 12
v_mfma_f32_16x16x32_bf16 v[148:151], a[112:115], a[12:15], v[148:151]
ds_read_b128 a[96:99], v6 offset:20480
v_mfma_f32_16x16x32_bf16 v[152:155], a[116:119], a[12:15], v[152:155]
buffer_load_dwordx4 a[0:3], v4, s[40:43], s35 offen offset:0 sc1
v_mfma_f32_16x16x32_bf16 v[136:139], a[116:119], a[8:11], v[136:139]
ds_read_b128 a[100:103], v6 offset:21504
v_mfma_f32_16x16x32_bf16 v[140:143], a[120:123], a[8:11], v[140:143]
ds_read_b128 a[104:107], v6 offset:22528
v_mfma_f32_16x16x32_bf16 v[156:159], a[120:123], a[12:15], v[156:159]
ds_read_b128 a[108:111], v6 offset:23552
v_mfma_f32_16x16x32_bf16 v[160:163], a[124:127], a[12:15], v[160:163]
buffer_load_dwordx4 a[4:7], v4, s[40:43], s35 offen offset:1024 sc1
v_mfma_f32_16x16x32_bf16 v[144:147], a[124:127], a[8:11], v[144:147]
s_waitcnt vmcnt(8) lgkmcnt(4)
v_mfma_f32_16x16x32_bf16 v[132:135], a[128:131], a[16:19], v[132:135]
s_cmp_eq_u32 s3, 1
s_cselect_b32 s35, 1, 25
s_lshl_b32 s35, s35, 12
v_mfma_f32_16x16x32_bf16 v[148:151], a[128:131], a[20:23], v[148:151]
ds_read_b128 a[112:115], v6 offset:24576
v_mfma_f32_16x16x32_bf16 v[152:155], a[132:135], a[20:23], v[152:155]
buffer_load_dwordx4 a[8:11], v4, s[40:43], s35 offen offset:0 sc1
v_mfma_f32_16x16x32_bf16 v[136:139], a[132:135], a[16:19], v[136:139]
ds_read_b128 a[116:119], v6 offset:25600
v_mfma_f32_16x16x32_bf16 v[140:143], a[136:139], a[16:19], v[140:143]
ds_read_b128 a[120:123], v6 offset:26624
v_mfma_f32_16x16x32_bf16 v[156:159], a[136:139], a[20:23], v[156:159]
ds_read_b128 a[124:127], v6 offset:27648
v_mfma_f32_16x16x32_bf16 v[160:163], a[140:143], a[20:23], v[160:163]
buffer_load_dwordx4 a[12:15], v4, s[40:43], s35 offen offset:1024 sc1
v_mfma_f32_16x16x32_bf16 v[144:147], a[140:143], a[16:19], v[144:147]
s_waitcnt vmcnt(8) lgkmcnt(4)
v_mfma_f32_16x16x32_bf16 v[132:135], a[96:99], a[24:27], v[132:135]
s_cmp_eq_u32 s3, 2
s_cselect_b32 s35, 2, 26
s_lshl_b32 s35, s35, 12
v_mfma_f32_16x16x32_bf16 v[148:151], a[96:99], a[28:31], v[148:151]
ds_read_b128 a[128:131], v6 offset:28672
v_mfma_f32_16x16x32_bf16 v[152:155], a[100:103], a[28:31], v[152:155]
buffer_load_dwordx4 a[16:19], v4, s[40:43], s35 offen offset:0 sc1
v_mfma_f32_16x16x32_bf16 v[136:139], a[100:103], a[24:27], v[136:139]
ds_read_b128 a[132:135], v6 offset:29696
v_mfma_f32_16x16x32_bf16 v[140:143], a[104:107], a[24:27], v[140:143]
ds_read_b128 a[136:139], v6 offset:30720
v_mfma_f32_16x16x32_bf16 v[156:159], a[104:107], a[28:31], v[156:159]
ds_read_b128 a[140:143], v6 offset:31744
v_mfma_f32_16x16x32_bf16 v[160:163], a[108:111], a[28:31], v[160:163]
buffer_load_dwordx4 a[20:23], v4, s[40:43], s35 offen offset:1024 sc1
v_mfma_f32_16x16x32_bf16 v[144:147], a[108:111], a[24:27], v[144:147]
s_waitcnt vmcnt(8) lgkmcnt(4)
v_mfma_f32_16x16x32_bf16 v[132:135], a[112:115], a[32:35], v[132:135]
s_cmp_eq_u32 s3, 3
s_cselect_b32 s35, 3, 27
s_lshl_b32 s35, s35, 12
v_mfma_f32_16x16x32_bf16 v[148:151], a[112:115], a[36:39], v[148:151]
ds_read_b128 a[96:99], v6 offset:32768
v_mfma_f32_16x16x32_bf16 v[152:155], a[116:119], a[36:39], v[152:155]
buffer_load_dwordx4 a[24:27], v4, s[40:43], s35 offen offset:0 sc1
v_mfma_f32_16x16x32_bf16 v[136:139], a[116:119], a[32:35], v[136:139]
ds_read_b128 a[100:103], v6 offset:33792
v_mfma_f32_16x16x32_bf16 v[140:143], a[120:123], a[32:35], v[140:143]
ds_read_b128 a[104:107], v6 offset:34816
v_mfma_f32_16x16x32_bf16 v[156:159], a[120:123], a[36:39], v[156:159]
ds_read_b128 a[108:111], v6 offset:35840
v_mfma_f32_16x16x32_bf16 v[160:163], a[124:127], a[36:39], v[160:163]
buffer_load_dwordx4 a[28:31], v4, s[40:43], s35 offen offset:1024 sc1
v_mfma_f32_16x16x32_bf16 v[144:147], a[124:127], a[32:35], v[144:147]
s_waitcnt vmcnt(8) lgkmcnt(4)
v_mfma_f32_16x16x32_bf16 v[132:135], a[128:131], a[40:43], v[132:135]
s_cmp_eq_u32 s3, 4
s_cselect_b32 s35, 4, 28
s_lshl_b32 s35, s35, 12
v_mfma_f32_16x16x32_bf16 v[148:151], a[128:131], a[44:47], v[148:151]
ds_read_b128 a[112:115], v6 offset:36864
v_mfma_f32_16x16x32_bf16 v[152:155], a[132:135], a[44:47], v[152:155]
buffer_load_dwordx4 a[32:35], v4, s[40:43], s35 offen offset:0 sc1
v_mfma_f32_16x16x32_bf16 v[136:139], a[132:135], a[40:43], v[136:139]
ds_read_b128 a[116:119], v6 offset:37888
v_mfma_f32_16x16x32_bf16 v[140:143], a[136:139], a[40:43], v[140:143]
ds_read_b128 a[120:123], v6 offset:38912
v_mfma_f32_16x16x32_bf16 v[156:159], a[136:139], a[44:47], v[156:159]
ds_read_b128 a[124:127], v6 offset:39936
v_mfma_f32_16x16x32_bf16 v[160:163], a[140:143], a[44:47], v[160:163]
buffer_load_dwordx4 a[36:39], v4, s[40:43], s35 offen offset:1024 sc1
v_mfma_f32_16x16x32_bf16 v[144:147], a[140:143], a[40:43], v[144:147]
s_waitcnt vmcnt(8) lgkmcnt(4)
v_mfma_f32_16x16x32_bf16 v[132:135], a[96:99], a[0:3], v[132:135]
s_cmp_eq_u32 s3, 5
s_cselect_b32 s35, 5, 29
s_lshl_b32 s35, s35, 12
v_mfma_f32_16x16x32_bf16 v[148:151], a[96:99], a[4:7], v[148:151]
ds_read_b128 a[128:131], v6 offset:40960
v_mfma_f32_16x16x32_bf16 v[152:155], a[100:103], a[4:7], v[152:155]
buffer_load_dwordx4 a[40:43], v4, s[40:43], s35 offen offset:0 sc1
v_mfma_f32_16x16x32_bf16 v[136:139], a[100:103], a[0:3], v[136:139]
ds_read_b128 a[132:135], v6 offset:41984
v_mfma_f32_16x16x32_bf16 v[140:143], a[104:107], a[0:3], v[140:143]
ds_read_b128 a[136:139], v6 offset:43008
v_mfma_f32_16x16x32_bf16 v[156:159], a[104:107], a[4:7], v[156:159]
ds_read_b128 a[140:143], v6 offset:44032
v_mfma_f32_16x16x32_bf16 v[160:163], a[108:111], a[4:7], v[160:163]
buffer_load_dwordx4 a[44:47], v4, s[40:43], s35 offen offset:1024 sc1
v_mfma_f32_16x16x32_bf16 v[144:147], a[108:111], a[0:3], v[144:147]
s_waitcnt vmcnt(8) lgkmcnt(4)
v_mfma_f32_16x16x32_bf16 v[132:135], a[112:115], a[8:11], v[132:135]
s_cmp_eq_u32 s3, 6
s_cselect_b32 s35, 6, 30
s_lshl_b32 s35, s35, 12
v_mfma_f32_16x16x32_bf16 v[148:151], a[112:115], a[12:15], v[148:151]
ds_read_b128 a[96:99], v6 offset:45056
v_mfma_f32_16x16x32_bf16 v[152:155], a[116:119], a[12:15], v[152:155]
buffer_load_dwordx4 a[0:3], v4, s[40:43], s35 offen offset:0 sc1
v_mfma_f32_16x16x32_bf16 v[136:139], a[116:119], a[8:11], v[136:139]
ds_read_b128 a[100:103], v6 offset:46080
v_mfma_f32_16x16x32_bf16 v[140:143], a[120:123], a[8:11], v[140:143]
ds_read_b128 a[104:107], v6 offset:47104
v_mfma_f32_16x16x32_bf16 v[156:159], a[120:123], a[12:15], v[156:159]
ds_read_b128 a[108:111], v6 offset:48128
v_mfma_f32_16x16x32_bf16 v[160:163], a[124:127], a[12:15], v[160:163]
buffer_load_dwordx4 a[4:7], v4, s[40:43], s35 offen offset:1024 sc1
v_mfma_f32_16x16x32_bf16 v[144:147], a[124:127], a[8:11], v[144:147]
s_waitcnt vmcnt(8) lgkmcnt(4)
v_mfma_f32_16x16x32_bf16 v[132:135], a[128:131], a[16:19], v[132:135]
s_cmp_eq_u32 s3, 7
s_cselect_b32 s35, 7, 31
s_lshl_b32 s35, s35, 12
v_mfma_f32_16x16x32_bf16 v[148:151], a[128:131], a[20:23], v[148:151]
ds_read_b128 a[112:115], v6 offset:49152
v_mfma_f32_16x16x32_bf16 v[152:155], a[132:135], a[20:23], v[152:155]
buffer_load_dwordx4 a[8:11], v4, s[40:43], s35 offen offset:0 sc1
v_mfma_f32_16x16x32_bf16 v[136:139], a[132:135], a[16:19], v[136:139]
ds_read_b128 a[116:119], v6 offset:50176
v_mfma_f32_16x16x32_bf16 v[140:143], a[136:139], a[16:19], v[140:143]
ds_read_b128 a[120:123], v6 offset:51200
v_mfma_f32_16x16x32_bf16 v[156:159], a[136:139], a[20:23], v[156:159]
ds_read_b128 a[124:127], v6 offset:52224
v_mfma_f32_16x16x32_bf16 v[160:163], a[140:143], a[20:23], v[160:163]
buffer_load_dwordx4 a[12:15], v4, s[40:43], s35 offen offset:1024 sc1
v_mfma_f32_16x16x32_bf16 v[144:147], a[140:143], a[16:19], v[144:147]
s_waitcnt vmcnt(8) lgkmcnt(4)
v_mfma_f32_16x16x32_bf16 v[132:135], a[96:99], a[24:27], v[132:135]
ds_read_b128 a[128:131], v6 offset:53248
v_mfma_f32_16x16x32_bf16 v[148:151], a[96:99], a[28:31], v[148:151]
ds_read_b128 a[132:135], v6 offset:54272
v_mfma_f32_16x16x32_bf16 v[152:155], a[100:103], a[28:31], v[152:155]
ds_read_b128 a[136:139], v6 offset:55296
v_mfma_f32_16x16x32_bf16 v[136:139], a[100:103], a[24:27], v[136:139]
ds_read_b128 a[140:143], v6 offset:56320
v_mfma_f32_16x16x32_bf16 v[140:143], a[104:107], a[24:27], v[140:143]
v_mfma_f32_16x16x32_bf16 v[156:159], a[104:107], a[28:31], v[156:159]
v_mfma_f32_16x16x32_bf16 v[160:163], a[108:111], a[28:31], v[160:163]
v_mfma_f32_16x16x32_bf16 v[144:147], a[108:111], a[24:27], v[144:147]
s_waitcnt vmcnt(6) lgkmcnt(4)
v_mfma_f32_16x16x32_bf16 v[132:135], a[112:115], a[32:35], v[132:135]
ds_read_b128 a[96:99], v6 offset:57344
v_mfma_f32_16x16x32_bf16 v[148:151], a[112:115], a[36:39], v[148:151]
ds_read_b128 a[100:103], v6 offset:58368
v_mfma_f32_16x16x32_bf16 v[152:155], a[116:119], a[36:39], v[152:155]
ds_read_b128 a[104:107], v6 offset:59392
v_mfma_f32_16x16x32_bf16 v[136:139], a[116:119], a[32:35], v[136:139]
ds_read_b128 a[108:111], v6 offset:60416
v_mfma_f32_16x16x32_bf16 v[140:143], a[120:123], a[32:35], v[140:143]
v_mfma_f32_16x16x32_bf16 v[156:159], a[120:123], a[36:39], v[156:159]
v_mfma_f32_16x16x32_bf16 v[160:163], a[124:127], a[36:39], v[160:163]
v_mfma_f32_16x16x32_bf16 v[144:147], a[124:127], a[32:35], v[144:147]
s_waitcnt vmcnt(4) lgkmcnt(4)
v_mfma_f32_16x16x32_bf16 v[132:135], a[128:131], a[40:43], v[132:135]
ds_read_b128 a[112:115], v6 offset:61440
v_mfma_f32_16x16x32_bf16 v[148:151], a[128:131], a[44:47], v[148:151]
ds_read_b128 a[116:119], v6 offset:62464
v_mfma_f32_16x16x32_bf16 v[152:155], a[132:135], a[44:47], v[152:155]
ds_read_b128 a[120:123], v6 offset:63488
v_mfma_f32_16x16x32_bf16 v[136:139], a[132:135], a[40:43], v[136:139]
ds_read_b128 a[124:127], v6 offset:64512
v_mfma_f32_16x16x32_bf16 v[140:143], a[136:139], a[40:43], v[140:143]
v_mfma_f32_16x16x32_bf16 v[156:159], a[136:139], a[44:47], v[156:159]
v_mfma_f32_16x16x32_bf16 v[160:163], a[140:143], a[44:47], v[160:163]
v_mfma_f32_16x16x32_bf16 v[144:147], a[140:143], a[40:43], v[144:147]
s_waitcnt vmcnt(2) lgkmcnt(4)
v_mfma_f32_16x16x32_bf16 v[132:135], a[96:99], a[0:3], v[132:135]
v_mfma_f32_16x16x32_bf16 v[148:151], a[96:99], a[4:7], v[148:151]
v_mfma_f32_16x16x32_bf16 v[152:155], a[100:103], a[4:7], v[152:155]
v_mfma_f32_16x16x32_bf16 v[136:139], a[100:103], a[0:3], v[136:139]
v_mfma_f32_16x16x32_bf16 v[140:143], a[104:107], a[0:3], v[140:143]
v_mfma_f32_16x16x32_bf16 v[156:159], a[104:107], a[4:7], v[156:159]
v_mfma_f32_16x16x32_bf16 v[160:163], a[108:111], a[4:7], v[160:163]
v_mfma_f32_16x16x32_bf16 v[144:147], a[108:111], a[0:3], v[144:147]
s_waitcnt vmcnt(0) lgkmcnt(0)
v_mfma_f32_16x16x32_bf16 v[132:135], a[112:115], a[8:11], v[132:135]
v_mfma_f32_16x16x32_bf16 v[148:151], a[112:115], a[12:15], v[148:151]
v_mfma_f32_16x16x32_bf16 v[152:155], a[116:119], a[12:15], v[152:155]
v_mfma_f32_16x16x32_bf16 v[136:139], a[116:119], a[8:11], v[136:139]
v_mfma_f32_16x16x32_bf16 v[140:143], a[120:123], a[8:11], v[140:143]
v_mfma_f32_16x16x32_bf16 v[156:159], a[120:123], a[12:15], v[156:159]
v_mfma_f32_16x16x32_bf16 v[160:163], a[124:127], a[12:15], v[160:163]
v_mfma_f32_16x16x32_bf16 v[144:147], a[124:127], a[8:11], v[144:147]
s_nop 0
v_cvt_pk_bf16_f32 v32, v132, v133
v_cvt_pk_bf16_f32 v33, v134, v135
s_nop 0
v_cvt_pk_bf16_f32 v34, v136, v137
v_cvt_pk_bf16_f32 v35, v138, v139
v_cvt_pk_bf16_f32 v36, v140, v141
v_cvt_pk_bf16_f32 v37, v142, v143
v_cvt_pk_bf16_f32 v38, v144, v145
v_cvt_pk_bf16_f32 v39, v146, v147
v_cvt_pk_bf16_f32 v40, v148, v149
v_cvt_pk_bf16_f32 v41, v150, v151
v_cvt_pk_bf16_f32 v42, v152, v153
v_cvt_pk_bf16_f32 v43, v154, v155
v_cvt_pk_bf16_f32 v44, v156, v157
v_cvt_pk_bf16_f32 v45, v158, v159
v_cvt_pk_bf16_f32 v46, v160, v161
v_cvt_pk_bf16_f32 v47, v162, v163
s_lshl_b32 s36, s32, 13
s_add_u32 s36, s36, 0x0
s_add_u32 s37, s36, 4096
s_mov_b32 s38, 0x280000
v_mfma_f32_16x16x32_bf16 v[96:99], v[32:35], v[32:35], 0
v_mfma_f32_16x16x32_bf16 v[92:95], v[16:19], v[32:35], 0
buffer_store_dwordx4 v[32:35], v4, s[12:15], s36 offen offset:0 sc1
v_mfma_f32_16x16x32_bf16 v[104:107], v[40:43], v[40:43], 0
v_mfma_f32_16x16x32_bf16 v[100:103], v[16:19], v[40:43], 0
buffer_store_dwordx4 v[40:43], v4, s[12:15], s36 offen offset:1024 sc1
v_mfma_f32_16x16x32_bf16 v[96:99], v[36:39], v[36:39], v[96:99]
v_mfma_f32_16x16x32_bf16 v[92:95], v[16:19], v[36:39], v[92:95]
buffer_store_dwordx4 v[36:39], v4, s[12:15], s37 offen offset:0 sc1
v_mfma_f32_16x16x32_bf16 v[104:107], v[44:47], v[44:47], v[104:107]
v_mfma_f32_16x16x32_bf16 v[100:103], v[16:19], v[44:47], v[100:103]
buffer_store_dwordx4 v[44:47], v4, s[12:15], s37 offen offset:1024 sc1
s_nop 2
v_cndmask_b32 v96, v96, v97, s[46:47]
v_cndmask_b32 v98, v98, v99, s[46:47]
v_cndmask_b32 v93, v96, v98, s[48:49]
buffer_store_dwordx2 v[92:93], v253, s[4:7], s38 offen offset:0 sc1
v_cndmask_b32 v104, v104, v105, s[46:47]
v_cndmask_b32 v106, v106, v107, s[46:47]
v_cndmask_b32 v101, v104, v106, s[48:49]
buffer_store_dwordx2 v[100:101], v253, s[4:7], s38 offen offset:2048 sc1
L_stub10:
s_cbranch_execz L_wret3
s_add_u32 s92, s78, 0x50000
s_add_u32 s93, s79, 0x50000
s_mov_b64 s[40:41], s[12:13]
s_barrier
s_add_u32 s44, s28, 0
s_mul_i32 s45, s44, 3072
s_add_u32 m0, s45, 0
s_lshr_b32 s44, s44, 1
s_add_u32 s44, s44, 0
s_mul_i32 s44, s44, 6144
s_add_u32 s44, s44, s50
buffer_load_dwordx4 v1, s[4:7], s44 offen offset:0 sc1 lds
buffer_load_dwordx4 v1, s[4:7], s44 offen offset:1024 sc1 lds
buffer_load_dwordx4 v1, s[4:7], s44 offen offset:2048 sc1 lds
s_add_u32 s44, s28, 4
s_mul_i32 s45, s44, 3072
s_add_u32 m0, s45, 0
s_lshr_b32 s44, s44, 1
s_add_u32 s44, s44, 0
s_mul_i32 s44, s44, 6144
s_add_u32 s44, s44, s50
buffer_load_dwordx4 v1, s[4:7], s44 offen offset:0 sc1 lds
buffer_load_dwordx4 v1, s[4:7], s44 offen offset:1024 sc1 lds
buffer_load_dwordx4 v1, s[4:7], s44 offen offset:2048 sc1 lds
s_add_u32 s44, s28, 8
s_mul_i32 s45, s44, 3072
s_add_u32 m0, s45, 0
s_lshr_b32 s44, s44, 1
s_add_u32 s44, s44, 0
s_mul_i32 s44, s44, 6144
s_add_u32 s44, s44, s50
buffer_load_dwordx4 v1, s[4:7], s44 offen offset:0 sc1 lds
buffer_load_dwordx4 v1, s[4:7], s44 offen offset:1024 sc1 lds
buffer_load_dwordx4 v1, s[4:7], s44 offen offset:2048 sc1 lds
s_add_u32 s44, s28, 12
s_mul_i32 s45, s44, 3072
s_add_u32 m0, s45, 0
s_lshr_b32 s44, s44, 1
s_add_u32 s44, s44, 0
s_mul_i32 s44, s44, 6144
s_add_u32 s44, s44, s50
buffer_load_dwordx4 v1, s[4:7], s44 offen offset:0 sc1 lds
buffer_load_dwordx4 v1, s[4:7], s44 offen offset:1024 sc1 lds
buffer_load_dwordx4 v1, s[4:7], s44 offen offset:2048 sc1 lds
s_waitcnt vmcnt(12)
s_barrier
s_cmp_lg_u32 s28, 1
s_cbranch_scc1 Lsg_25
buffer_atomic_add v12, v10, s[4:7], s92 offen sc1
buffer_atomic_add v12, v10, s[4:7], s93 offen sc1
Lsg_25:
s_cmp_lg_u32 s28, 1
s_cbranch_scc1 L_wskip4
s_mov_b64 exec, 0
s_branch L_stub11
L_wret4:
s_mov_b64 exec, -1
L_wskip4:
s_cmp_lt_u32 s28, 2
s_cbranch_scc1 Lwd_26
s_add_u32 s44, s28, 0
s_mul_i32 s45, s44, 3072
s_add_u32 m0, s45, 49152
s_lshr_b32 s44, s44, 1
s_add_u32 s44, s44, 8
s_mul_i32 s44, s44, 6144
s_add_u32 s44, s44, s50
buffer_load_dwordx4 v1, s[4:7], s44 offen offset:0 sc1 lds
buffer_load_dwordx4 v1, s[4:7], s44 offen offset:1024 sc1 lds
buffer_load_dwordx4 v1, s[4:7], s44 offen offset:2048 sc1 lds
s_sub_u32 s44, s28, 2
s_mul_i32 s45, s44, 3072
s_add_u32 m0, s45, 49152
s_lshr_b32 s44, s44, 1
s_add_u32 s44, s44, 8
s_mul_i32 s44, s44, 6144
s_add_u32 s44, s44, s50
buffer_load_dwordx4 v1, s[4:7], s44 offen offset:0 sc1 lds
buffer_load_dwordx4 v1, s[4:7], s44 offen offset:1024 sc1 lds
buffer_load_dwordx4 v1, s[4:7], s44 offen offset:2048 sc1 lds
s_add_u32 s44, s28, 4
s_mul_i32 s45, s44, 3072
s_add_u32 m0, s45, 49152
s_lshr_b32 s44, s44, 1
s_add_u32 s44, s44, 8
s_mul_i32 s44, s44, 6144
s_add_u32 s44, s44, s50
buffer_load_dwordx4 v1, s[4:7], s44 offen offset:0 sc1 lds
buffer_load_dwordx4 v1, s[4:7], s44 offen offset:1024 sc1 lds
buffer_load_dwordx4 v1, s[4:7], s44 offen offset:2048 sc1 lds
s_add_u32 s44, s28, 2
s_mul_i32 s45, s44, 3072
s_add_u32 m0, s45, 49152
s_lshr_b32 s44, s44, 1
s_add_u32 s44, s44, 8
s_mul_i32 s44, s44, 6144
s_add_u32 s44, s44, s50
buffer_load_dwordx4 v1, s[4:7], s44 offen offset:0 sc1 lds
buffer_load_dwordx4 v1, s[4:7], s44 offen offset:1024 sc1 lds
buffer_load_dwordx4 v1, s[4:7], s44 offen offset:2048 sc1 lds
s_add_u32 s44, s28, 8
s_mul_i32 s45, s44, 3072
s_add_u32 m0, s45, 49152
s_lshr_b32 s44, s44, 1
s_add_u32 s44, s44, 8
s_mul_i32 s44, s44, 6144
s_add_u32 s44, s44, s50
buffer_load_dwordx4 v1, s[4:7], s44 offen offset:0 sc1 lds
buffer_load_dwordx4 v1, s[4:7], s44 offen offset:1024 sc1 lds
buffer_load_dwordx4 v1, s[4:7], s44 offen offset:2048 sc1 lds
s_add_u32 s44, s28, 6
s_mul_i32 s45, s44, 3072
s_add_u32 m0, s45, 49152
s_lshr_b32 s44, s44, 1
s_add_u32 s44, s44, 8
s_mul_i32 s44, s44, 6144
s_add_u32 s44, s44, s50
buffer_load_dwordx4 v1, s[4:7], s44 offen offset:0 sc1 lds
buffer_load_dwordx4 v1, s[4:7], s44 offen offset:1024 sc1 lds
buffer_load_dwordx4 v1, s[4:7], s44 offen offset:2048 sc1 lds
s_add_u32 s44, s28, 12
s_mul_i32 s45, s44, 3072
s_add_u32 m0, s45, 49152
s_lshr_b32 s44, s44, 1
s_add_u32 s44, s44, 8
s_mul_i32 s44, s44, 6144
s_add_u32 s44, s44, s50
buffer_load_dwordx4 v1, s[4:7], s44 offen offset:0 sc1 lds
buffer_load_dwordx4 v1, s[4:7], s44 offen offset:1024 sc1 lds
buffer_load_dwordx4 v1, s[4:7], s44 offen offset:2048 sc1 lds
s_add_u32 s44, s28, 10
s_mul_i32 s45, s44, 3072
s_add_u32 m0, s45, 49152
s_lshr_b32 s44, s44, 1
s_add_u32 s44, s44, 8
s_mul_i32 s44, s44, 6144
s_add_u32 s44, s44, s50
buffer_load_dwordx4 v1, s[4:7], s44 offen offset:0 sc1 lds
buffer_load_dwordx4 v1, s[4:7], s44 offen offset:1024 sc1 lds
buffer_load_dwordx4 v1, s[4:7], s44 offen offset:2048 sc1 lds
Lwd_26:
s_cmp_lg_u32 s28, 0
s_cbranch_scc1 Lpe_28
s_add_u32 s36, s67, 0x50000
s_mov_b32 s37, 0
Lpoll_27:
v_mov_b32 v11, 0
s_mov_b64 exec, 1
buffer_atomic_add v11, off, s[4:7], s36 sc0 sc1
s_waitcnt vmcnt(0)
v_readfirstlane_b32 s38, v11
s_mov_b64 exec, -1
s_nop 0
v_mov_b32 v11, s38
s_add_u32 s37, s37, 1
v_cmp_gt_u32 vcc, s54, v11
s_cbranch_vccz Lpe_28
s_cmp_lt_u32 s37, 0x100000
s_cbranch_scc1 Lpoll_27
Lpe_28:
s_waitcnt vmcnt(24)
s_cmp_ge_u32 s28, 2
s_cbranch_scc1 Lw_29
s_waitcnt vmcnt(0)
Lw_29:
s_barrier
s_add_u32 s94, s71, 0x20080
s_lshl_b32 s35, s33, 12
buffer_load_dwordx4 a[0:3], v2, s[40:43], s35 offen offset:0 sc1
buffer_load_dwordx4 a[4:7], v2, s[40:43], s35 offen offset:1024 sc1
buffer_load_dwordx4 a[8:11], v2, s[40:43], s35 offen offset:2048 sc1
buffer_load_dwordx4 a[12:15], v2, s[40:43], s35 offen offset:3072 sc1
s_add_u32 s35, s35, 4096
s_add_u32 s63, s28, 0
s_lshl_b32 s63, s63, 12
buffer_load_dwordx4 a[64:67], v3, s[40:43], s63 offen sc1
buffer_load_dwordx4 a[16:19], v2, s[40:43], s35 offen offset:0 sc1
buffer_load_dwordx4 a[20:23], v2, s[40:43], s35 offen offset:1024 sc1
buffer_load_dwordx4 a[24:27], v2, s[40:43], s35 offen offset:2048 sc1
buffer_load_dwordx4 a[28:31], v2, s[40:43], s35 offen offset:3072 sc1
s_add_u32 s35, s35, 4096
buffer_load_dwordx4 a[32:35], v2, s[40:43], s35 offen offset:0 sc1
buffer_load_dwordx4 a[36:39], v2, s[40:43], s35 offen offset:1024 sc1
buffer_load_dwordx4 a[40:43], v2, s[40:43], s35 offen offset:2048 sc1
buffer_load_dwordx4 a[44:47], v2, s[40:43], s35 offen offset:3072 sc1
s_add_u32 s35, s35, 4096
v_add_u32 v5, 0, v1
v_add_u32 v6, s55, v5
ds_read_b128 a[96:99], v5 offset:0
ds_read_b128 a[100:103], v5 offset:1024
ds_read_b128 a[104:107], v5 offset:2048
ds_read_b128 a[108:111], v5 offset:3072
ds_read_b128 a[112:115], v5 offset:4096
ds_read_b128 a[116:119], v5 offset:5120
ds_read_b128 a[120:123], v6 offset:2048
s_waitcnt vmcnt(8) lgkmcnt(0)
v_mfma_f32_16x16x32_bf16 v[132:135], a[96:99], a[0:3], 0
s_add_u32 s44, s28, 0
s_mul_i32 s45, s44, 3072
s_add_u32 m0, s45, 98304
v_mfma_f32_16x16x32_bf16 v[156:159], a[96:99], a[4:7], 0
buffer_load_dwordx4 a[48:51], v2, s[40:43], s35 offen offset:0 sc1
s_lshr_b32 s44, s44, 1
v_mfma_f32_16x16x32_bf16 v[180:183], a[96:99], a[8:11], 0
s_add_u32 s44, s44, 16
s_mul_i32 s44, s44, 6144
s_add_u32 s44, s44, s50
v_mfma_f32_16x16x32_bf16 v[204:207], a[96:99], a[12:15], 0
ds_read_b128 a[128:131], v5 offset:6144
v_mfma_f32_16x16x32_bf16 v[208:211], a[100:103], a[12:15], 0
buffer_load_dwordx4 v1, s[4:7], s44 offen offset:0 sc1 lds
v_mfma_f32_16x16x32_bf16 v[184:187], a[100:103], a[8:11], 0
ds_read_b128 a[132:135], v5 offset:7168
v_mfma_f32_16x16x32_bf16 v[160:163], a[100:103], a[4:7], 0
ds_read_b128 a[136:139], v5 offset:8192
v_mfma_f32_16x16x32_bf16 v[136:139], a[100:103], a[0:3], 0
ds_read_b128 a[140:143], v5 offset:9216
v_mfma_f32_16x16x32_bf16 v[140:143], a[104:107], a[0:3], 0
buffer_load_dwordx4 a[52:55], v2, s[40:43], s35 offen offset:1024 sc1
v_mfma_f32_16x16x32_bf16 v[164:167], a[104:107], a[4:7], 0
ds_read_b128 a[144:147], v5 offset:10240
v_mfma_f32_16x16x32_bf16 v[188:191], a[104:107], a[8:11], 0
v_mfma_f32_16x16x32_bf16 v[212:215], a[104:107], a[12:15], 0
buffer_load_dwordx4 v1, s[4:7], s44 offen offset:1024 sc1 lds
s_add_u32 s63, s28, 4
v_mfma_f32_16x16x32_bf16 v[216:219], a[108:111], a[12:15], 0
s_lshl_b32 s63, s63, 12
ds_read_b128 a[148:151], v5 offset:11264
v_mfma_f32_16x16x32_bf16 v[192:195], a[108:111], a[8:11], 0
ds_read_b128 a[152:155], v6 offset:3072
v_mfma_f32_16x16x32_bf16 v[168:171], a[108:111], a[4:7], 0
v_mfma_f32_16x16x32_bf16 v[144:147], a[108:111], a[0:3], 0
buffer_load_dwordx4 a[56:59], v2, s[40:43], s35 offen offset:2048 sc1
v_mfma_f32_16x16x32_bf16 v[148:151], a[112:115], a[0:3], 0
v_mfma_f32_16x16x32_bf16 v[172:175], a[112:115], a[4:7], 0
v_mfma_f32_16x16x32_bf16 v[196:199], a[112:115], a[8:11], 0
buffer_load_dwordx4 a[68:71], v3, s[40:43], s63 offen sc1
v_mfma_f32_16x16x32_bf16 v[220:223], a[112:115], a[12:15], 0
v_mfma_f32_16x16x32_bf16 v[224:227], a[116:119], a[12:15], 0
v_mfma_f32_16x16x32_bf16 v[200:203], a[116:119], a[8:11], 0
v_mfma_f32_16x16x32_bf16 v[176:179], a[116:119], a[4:7], 0
buffer_load_dwordx4 a[60:63], v2, s[40:43], s35 offen offset:3072 sc1
s_add_u32 s35, s35, 4096
v_mfma_f32_16x16x32_bf16 v[152:155], a[116:119], a[0:3], 0
v_mfma_f32_16x16x32_bf16 a[80:83], a[120:123], a[64:67], 0
s_waitcnt vmcnt(11) lgkmcnt(0)
v_mfma_f32_16x16x32_bf16 v[132:135], a[128:131], a[16:19], v[132:135]
ds_read_b128 a[96:99], v5 offset:12288
v_mfma_f32_16x16x32_bf16 v[156:159], a[128:131], a[20:23], v[156:159]
buffer_load_dwordx4 a[0:3], v2, s[40:43], s35 offen offset:0 sc1
v_mfma_f32_16x16x32_bf16 v[180:183], a[128:131], a[24:27], v[180:183]
ds_read_b128 a[100:103], v5 offset:13312
v_mfma_f32_16x16x32_bf16 v[204:207], a[128:131], a[28:31], v[204:207]
v_mfma_f32_16x16x32_bf16 v[208:211], a[132:135], a[28:31], v[208:211]
ds_read_b128 a[104:107], v5 offset:14336
v_mfma_f32_16x16x32_bf16 v[184:187], a[132:135], a[24:27], v[184:187]
buffer_load_dwordx4 v1, s[4:7], s44 offen offset:2048 sc1 lds
s_add_u32 s44, s28, 4
v_mfma_f32_16x16x32_bf16 v[160:163], a[132:135], a[20:23], v[160:163]
s_mul_i32 s45, s44, 3072
s_add_u32 m0, s45, 98304
s_lshr_b32 s44, s44, 1
v_mfma_f32_16x16x32_bf16 v[136:139], a[132:135], a[16:19], v[136:139]
s_add_u32 s44, s44, 16
s_mul_i32 s44, s44, 6144
s_add_u32 s44, s44, s50
v_mfma_f32_16x16x32_bf16 v[140:143], a[136:139], a[16:19], v[140:143]
ds_read_b128 a[108:111], v5 offset:15360
v_mfma_f32_16x16x32_bf16 v[164:167], a[136:139], a[20:23], v[164:167]
buffer_load_dwordx4 a[4:7], v2, s[40:43], s35 offen offset:1024 sc1
v_mfma_f32_16x16x32_bf16 v[188:191], a[136:139], a[24:27], v[188:191]
ds_read_b128 a[112:115], v5 offset:16384
v_mfma_f32_16x16x32_bf16 v[212:215], a[136:139], a[28:31], v[212:215]
ds_read_b128 a[116:119], v5 offset:17408
v_mfma_f32_16x16x32_bf16 v[216:219], a[140:143], a[28:31], v[216:219]
v_mfma_f32_16x16x32_bf16 v[192:195], a[140:143], a[24:27], v[192:195]
buffer_load_dwordx4 a[8:11], v2, s[40:43], s35 offen offset:2048 sc1
v_mfma_f32_16x16x32_bf16 v[168:171], a[140:143], a[20:23], v[168:171]
ds_read_b128 a[120:123], v6 offset:4096
v_mfma_f32_16x16x32_bf16 v[144:147], a[140:143], a[16:19], v[144:147]
v_mfma_f32_16x16x32_bf16 v[148:151], a[144:147], a[16:19], v[148:151]
v_mfma_f32_16x16x32_bf16 v[172:175], a[144:147], a[20:23], v[172:175]
buffer_load_dwordx4 v1, s[4:7], s44 offen offset:0 sc1 lds
v_mfma_f32_16x16x32_bf16 v[196:199], a[144:147], a[24:27], v[196:199]
v_mfma_f32_16x16x32_bf16 v[220:223], a[144:147], a[28:31], v[220:223]
v_mfma_f32_16x16x32_bf16 v[224:227], a[148:151], a[28:31], v[224:227]
v_mfma_f32_16x16x32_bf16 v[200:203], a[148:151], a[24:27], v[200:203]
buffer_load_dwordx4 a[12:15], v2, s[40:43], s35 offen offset:3072 sc1
s_add_u32 s35, s35, 4096
v_mfma_f32_16x16x32_bf16 v[176:179], a[148:151], a[20:23], v[176:179]
v_mfma_f32_16x16x32_bf16 v[152:155], a[148:151], a[16:19], v[152:155]
v_mfma_f32_16x16x32_bf16 a[84:87], a[152:155], a[64:67], 0
s_waitcnt vmcnt(13) lgkmcnt(0)
v_mfma_f32_16x16x32_bf16 v[132:135], a[96:99], a[32:35], v[132:135]
ds_read_b128 a[128:131], v5 offset:18432
v_mfma_f32_16x16x32_bf16 v[156:159], a[96:99], a[36:39], v[156:159]
buffer_load_dwordx4 a[16:19], v2, s[40:43], s35 offen offset:0 sc1
v_mfma_f32_16x16x32_bf16 v[180:183], a[96:99], a[40:43], v[180:183]
ds_read_b128 a[132:135], v5 offset:19456
v_mfma_f32_16x16x32_bf16 v[204:207], a[96:99], a[44:47], v[204:207]
v_mfma_f32_16x16x32_bf16 v[208:211], a[100:103], a[44:47], v[208:211]
ds_read_b128 a[136:139], v5 offset:20480
v_mfma_f32_16x16x32_bf16 v[184:187], a[100:103], a[40:43], v[184:187]
v_mfma_f32_16x16x32_bf16 v[160:163], a[100:103], a[36:39], v[160:163]
buffer_load_dwordx4 a[20:23], v2, s[40:43], s35 offen offset:1024 sc1
v_mfma_f32_16x16x32_bf16 v[136:139], a[100:103], a[32:35], v[136:139]
ds_read_b128 a[140:143], v5 offset:21504
v_mfma_f32_16x16x32_bf16 v[140:143], a[104:107], a[32:35], v[140:143]
v_mfma_f32_16x16x32_bf16 v[164:167], a[104:107], a[36:39], v[164:167]
ds_read_b128 a[144:147], v5 offset:22528
v_mfma_f32_16x16x32_bf16 v[188:191], a[104:107], a[40:43], v[188:191]
v_mfma_f32_16x16x32_bf16 v[212:215], a[104:107], a[44:47], v[212:215]
buffer_load_dwordx4 v1, s[4:7], s44 offen offset:1024 sc1 lds
v_mfma_f32_16x16x32_bf16 v[216:219], a[108:111], a[44:47], v[216:219]
ds_read_b128 a[148:151], v5 offset:23552
v_mfma_f32_16x16x32_bf16 v[192:195], a[108:111], a[40:43], v[192:195]
ds_read_b128 a[152:155], v6 offset:5120
v_mfma_f32_16x16x32_bf16 v[168:171], a[108:111], a[36:39], v[168:171]
v_mfma_f32_16x16x32_bf16 v[144:147], a[108:111], a[32:35], v[144:147]
v_mfma_f32_16x16x32_bf16 v[148:151], a[112:115], a[32:35], v[148:151]
buffer_load_dwordx4 a[24:27], v2, s[40:43], s35 offen offset:2048 sc1
v_mfma_f32_16x16x32_bf16 v[172:175], a[112:115], a[36:39], v[172:175]
v_mfma_f32_16x16x32_bf16 v[196:199], a[112:115], a[40:43], v[196:199]
v_mfma_f32_16x16x32_bf16 v[220:223], a[112:115], a[44:47], v[220:223]
v_mfma_f32_16x16x32_bf16 v[224:227], a[116:119], a[44:47], v[224:227]
v_mfma_f32_16x16x32_bf16 v[200:203], a[116:119], a[40:43], v[200:203]
buffer_load_dwordx4 a[28:31], v2, s[40:43], s35 offen offset:3072 sc1
s_add_u32 s35, s35, 4096
v_mfma_f32_16x16x32_bf16 v[176:179], a[116:119], a[36:39], v[176:179]
v_mfma_f32_16x16x32_bf16 v[152:155], a[116:119], a[32:35], v[152:155]
v_mfma_f32_16x16x32_bf16 a[88:91], a[120:123], a[64:67], 0
s_waitcnt vmcnt(11) lgkmcnt(0)
v_mfma_f32_16x16x32_bf16 v[132:135], a[128:131], a[48:51], v[132:135]
ds_read_b128 a[96:99], v5 offset:24576
v_mfma_f32_16x16x32_bf16 v[156:159], a[128:131], a[52:55], v[156:159]
buffer_load_dwordx4 a[32:35], v2, s[40:43], s35 offen offset:0 sc1
v_mfma_f32_16x16x32_bf16 v[180:183], a[128:131], a[56:59], v[180:183]
ds_read_b128 a[100:103], v5 offset:25600
v_mfma_f32_16x16x32_bf16 v[204:207], a[128:131], a[60:63], v[204:207]
v_mfma_f32_16x16x32_bf16 v[208:211], a[132:135], a[60:63], v[208:211]
ds_read_b128 a[104:107], v5 offset:26624
v_mfma_f32_16x16x32_bf16 v[184:187], a[132:135], a[56:59], v[184:187]
buffer_load_dwordx4 v1, s[4:7], s44 offen offset:2048 sc1 lds
s_add_u32 s44, s28, 8
v_mfma_f32_16x16x32_bf16 v[160:163], a[132:135], a[52:55], v[160:163]
s_mul_i32 s45, s44, 3072
s_add_u32 m0, s45, 98304
s_lshr_b32 s44, s44, 1
v_mfma_f32_16x16x32_bf16 v[136:139], a[132:135], a[48:51], v[136:139]
s_add_u32 s44, s44, 16
s_mul_i32 s44, s44, 6144
s_add_u32 s44, s44, s50
v_mfma_f32_16x16x32_bf16 v[140:143], a[136:139], a[48:51], v[140:143]
ds_read_b128 a[108:111], v5 offset:27648
v_mfma_f32_16x16x32_bf16 v[164:167], a[136:139], a[52:55], v[164:167]
buffer_load_dwordx4 a[36:39], v2, s[40:43], s35 offen offset:1024 sc1
v_mfma_f32_16x16x32_bf16 v[188:191], a[136:139], a[56:59], v[188:191]
ds_read_b128 a[112:115], v5 offset:28672
v_mfma_f32_16x16x32_bf16 v[212:215], a[136:139], a[60:63], v[212:215]
ds_read_b128 a[116:119], v5 offset:29696
v_mfma_f32_16x16x32_bf16 v[216:219], a[140:143], a[60:63], v[216:219]
v_mfma_f32_16x16x32_bf16 v[192:195], a[140:143], a[56:59], v[192:195]
buffer_load_dwordx4 a[40:43], v2, s[40:43], s35 offen offset:2048 sc1
v_mfma_f32_16x16x32_bf16 v[168:171], a[140:143], a[52:55], v[168:171]
ds_read_b128 a[120:123], v6 offset:26624
v_mfma_f32_16x16x32_bf16 v[144:147], a[140:143], a[48:51], v[144:147]
v_mfma_f32_16x16x32_bf16 v[148:151], a[144:147], a[48:51], v[148:151]
v_mfma_f32_16x16x32_bf16 v[172:175], a[144:147], a[52:55], v[172:175]
buffer_load_dwordx4 v1, s[4:7], s44 offen offset:0 sc1 lds
v_mfma_f32_16x16x32_bf16 v[196:199], a[144:147], a[56:59], v[196:199]
v_mfma_f32_16x16x32_bf16 v[220:223], a[144:147], a[60:63], v[220:223]
v_mfma_f32_16x16x32_bf16 v[224:227], a[148:151], a[60:63], v[224:227]
v_mfma_f32_16x16x32_bf16 v[200:203], a[148:151], a[56:59], v[200:203]
buffer_load_dwordx4 a[44:47], v2, s[40:43], s35 offen offset:3072 sc1
s_add_u32 s35, s35, 4096
v_mfma_f32_16x16x32_bf16 v[176:179], a[148:151], a[52:55], v[176:179]
v_mfma_f32_16x16x32_bf16 v[152:155], a[148:151], a[48:51], v[152:155]
v_mfma_f32_16x16x32_bf16 a[92:95], a[152:155], a[64:67], 0
s_waitcnt vmcnt(11) lgkmcnt(0)
v_mfma_f32_16x16x32_bf16 v[132:135], a[96:99], a[0:3], v[132:135]
ds_read_b128 a[128:131], v5 offset:30720
v_accvgpr_read_b32 v48, a160
v_mfma_f32_16x16x32_bf16 v[156:159], a[96:99], a[4:7], v[156:159]
buffer_load_dwordx4 a[48:51], v2, s[40:43], s35 offen offset:0 sc1
v_mfma_f32_16x16x32_bf16 v[180:183], a[96:99], a[8:11], v[180:183]
ds_read_b128 a[132:135], v5 offset:31744
v_mfma_f32_16x16x32_bf16 v[204:207], a[96:99], a[12:15], v[204:207]
v_mfma_f32_16x16x32_bf16 v[208:211], a[100:103], a[12:15], v[208:211]
buffer_load_dwordx4 v1, s[4:7], s44 offen offset:1024 sc1 lds
v_mfma_f32_16x16x32_bf16 v[184:187], a[100:103], a[8:11], v[184:187]
ds_read_b128 a[136:139], v5 offset:32768
v_mfma_f32_16x16x32_bf16 v[160:163], a[100:103], a[4:7], v[160:163]
ds_read_b128 a[140:143], v5 offset:33792
v_accvgpr_read_b32 v49, a161
v_mfma_f32_16x16x32_bf16 v[136:139], a[100:103], a[0:3], v[136:139]
v_mfma_f32_16x16x32_bf16 v[140:143], a[104:107], a[0:3], v[140:143]
buffer_load_dwordx4 a[52:55], v2, s[40:43], s35 offen offset:1024 sc1
v_mfma_f32_16x16x32_bf16 v[164:167], a[104:107], a[4:7], v[164:167]
ds_read_b128 a[144:147], v5 offset:34816
v_mfma_f32_16x16x32_bf16 v[188:191], a[104:107], a[8:11], v[188:191]
v_mfma_f32_16x16x32_bf16 v[212:215], a[104:107], a[12:15], v[212:215]
buffer_load_dwordx4 v1, s[4:7], s44 offen offset:2048 sc1 lds
s_add_u32 s63, s28, 8
v_mfma_f32_16x16x32_bf16 v[216:219], a[108:111], a[12:15], v[216:219]
s_lshl_b32 s63, s63, 12
ds_read_b128 a[148:151], v5 offset:35840
v_mfma_f32_16x16x32_bf16 v[192:195], a[108:111], a[8:11], v[192:195]
ds_read_b128 a[152:155], v6 offset:27648
v_accvgpr_read_b32 v50, a162
v_mfma_f32_16x16x32_bf16 v[168:171], a[108:111], a[4:7], v[168:171]
v_mfma_f32_16x16x32_bf16 v[144:147], a[108:111], a[0:3], v[144:147]
buffer_load_dwordx4 a[56:59], v2, s[40:43], s35 offen offset:2048 sc1
v_mfma_f32_16x16x32_bf16 v[148:151], a[112:115], a[0:3], v[148:151]
v_mfma_f32_16x16x32_bf16 v[172:175], a[112:115], a[4:7], v[172:175]
v_mfma_f32_16x16x32_bf16 v[196:199], a[112:115], a[8:11], v[196:199]
buffer_load_dwordx4 a[72:75], v3, s[40:43], s63 offen sc1
s_add_u32 s44, s28, 12
v_mfma_f32_16x16x32_bf16 v[220:223], a[112:115], a[12:15], v[220:223]
s_mul_i32 s45, s44, 3072
s_add_u32 m0, s45, 98304
s_lshr_b32 s44, s44, 1
v_mfma_f32_16x16x32_bf16 v[224:227], a[116:119], a[12:15], v[224:227]
s_add_u32 s44, s44, 16
s_mul_i32 s44, s44, 6144
s_add_u32 s44, s44, s50
v_mfma_f32_16x16x32_bf16 v[200:203], a[116:119], a[8:11], v[200:203]
v_accvgpr_read_b32 v51, a163
v_mfma_f32_16x16x32_bf16 v[176:179], a[116:119], a[4:7], v[176:179]
buffer_load_dwordx4 a[60:63], v2, s[40:43], s35 offen offset:3072 sc1
s_add_u32 s35, s35, 4096
v_mfma_f32_16x16x32_bf16 v[152:155], a[116:119], a[0:3], v[152:155]
v_mfma_f32_16x16x32_bf16 a[80:83], a[120:123], a[68:71], a[80:83]
s_waitcnt vmcnt(13) lgkmcnt(0)
v_mfma_f32_16x16x32_bf16 v[132:135], a[128:131], a[16:19], v[132:135]
ds_read_b128 a[96:99], v5 offset:36864
v_accvgpr_read_b32 v52, a164
v_mfma_f32_16x16x32_bf16 v[156:159], a[128:131], a[20:23], v[156:159]
buffer_load_dwordx4 a[0:3], v2, s[40:43], s35 offen offset:0 sc1
v_mfma_f32_16x16x32_bf16 v[180:183], a[128:131], a[24:27], v[180:183]
ds_read_b128 a[100:103], v5 offset:37888
v_mfma_f32_16x16x32_bf16 v[204:207], a[128:131], a[28:31], v[204:207]
v_mfma_f32_16x16x32_bf16 v[208:211], a[132:135], a[28:31], v[208:211]
ds_read_b128 a[104:107], v5 offset:38912
v_mfma_f32_16x16x32_bf16 v[184:187], a[132:135], a[24:27], v[184:187]
v_mfma_f32_16x16x32_bf16 v[160:163], a[132:135], a[20:23], v[160:163]
buffer_load_dwordx4 a[4:7], v2, s[40:43], s35 offen offset:1024 sc1
v_mfma_f32_16x16x32_bf16 v[136:139], a[132:135], a[16:19], v[136:139]
ds_read_b128 a[108:111], v5 offset:39936
v_accvgpr_read_b32 v53, a165
v_mfma_f32_16x16x32_bf16 v[140:143], a[136:139], a[16:19], v[140:143]
v_mfma_f32_16x16x32_bf16 v[164:167], a[136:139], a[20:23], v[164:167]
ds_read_b128 a[112:115], v5 offset:40960
v_mfma_f32_16x16x32_bf16 v[188:191], a[136:139], a[24:27], v[188:191]
v_mfma_f32_16x16x32_bf16 v[212:215], a[136:139], a[28:31], v[212:215]
buffer_load_dwordx4 v1, s[4:7], s44 offen offset:0 sc1 lds
v_mfma_f32_16x16x32_bf16 v[216:219], a[140:143], a[28:31], v[216:219]
ds_read_b128 a[116:119], v5 offset:41984
v_accvgpr_read_b32 v54, a166
v_mfma_f32_16x16x32_bf16 v[192:195], a[140:143], a[24:27], v[192:195]
ds_read_b128 a[120:123], v6 offset:28672
v_mfma_f32_16x16x32_bf16 v[168:171], a[140:143], a[20:23], v[168:171]
v_mfma_f32_16x16x32_bf16 v[144:147], a[140:143], a[16:19], v[144:147]
v_mfma_f32_16x16x32_bf16 v[148:151], a[144:147], a[16:19], v[148:151]
buffer_load_dwordx4 a[8:11], v2, s[40:43], s35 offen offset:2048 sc1
v_mfma_f32_16x16x32_bf16 v[172:175], a[144:147], a[20:23], v[172:175]
v_mfma_f32_16x16x32_bf16 v[196:199], a[144:147], a[24:27], v[196:199]
v_accvgpr_read_b32 v55, a167
v_mfma_f32_16x16x32_bf16 v[220:223], a[144:147], a[28:31], v[220:223]
v_mfma_f32_16x16x32_bf16 v[224:227], a[148:151], a[28:31], v[224:227]
v_mfma_f32_16x16x32_bf16 v[200:203], a[148:151], a[24:27], v[200:203]
buffer_load_dwordx4 a[12:15], v2, s[40:43], s35 offen offset:3072 sc1
s_add_u32 s35, s35, 4096
v_mfma_f32_16x16x32_bf16 v[176:179], a[148:151], a[20:23], v[176:179]
v_mfma_f32_16x16x32_bf16 v[152:155], a[148:151], a[16:19], v[152:155]
v_mfma_f32_16x16x32_bf16 a[84:87], a[152:155], a[68:71], a[84:87]
s_waitcnt vmcnt(12) lgkmcnt(0)
v_mfma_f32_16x16x32_bf16 v[132:135], a[96:99], a[32:35], v[132:135]
ds_read_b128 a[128:131], v5 offset:43008
v_accvgpr_read_b32 v56, a168
v_mfma_f32_16x16x32_bf16 v[156:159], a[96:99], a[36:39], v[156:159]
buffer_load_dwordx4 a[16:19], v2, s[40:43], s35 offen offset:0 sc1
v_mfma_f32_16x16x32_bf16 v[180:183], a[96:99], a[40:43], v[180:183]
ds_read_b128 a[132:135], v5 offset:44032
v_mfma_f32_16x16x32_bf16 v[204:207], a[96:99], a[44:47], v[204:207]
v_mfma_f32_16x16x32_bf16 v[208:211], a[100:103], a[44:47], v[208:211]
ds_read_b128 a[136:139], v5 offset:45056
v_mfma_f32_16x16x32_bf16 v[184:187], a[100:103], a[40:43], v[184:187]
buffer_load_dwordx4 v1, s[4:7], s44 offen offset:1024 sc1 lds
v_mfma_f32_16x16x32_bf16 v[160:163], a[100:103], a[36:39], v[160:163]
ds_read_b128 a[140:143], v5 offset:46080
v_accvgpr_read_b32 v57, a169
v_mfma_f32_16x16x32_bf16 v[136:139], a[100:103], a[32:35], v[136:139]
v_mfma_f32_16x16x32_bf16 v[140:143], a[104:107], a[32:35], v[140:143]
v_mfma_f32_16x16x32_bf16 v[164:167], a[104:107], a[36:39], v[164:167]
buffer_load_dwordx4 a[20:23], v2, s[40:43], s35 offen offset:1024 sc1
v_mfma_f32_16x16x32_bf16 v[188:191], a[104:107], a[40:43], v[188:191]
ds_read_b128 a[144:147], v5 offset:47104
v_mfma_f32_16x16x32_bf16 v[212:215], a[104:107], a[44:47], v[212:215]
ds_read_b128 a[148:151], v5 offset:48128
v_mfma_f32_16x16x32_bf16 v[216:219], a[108:111], a[44:47], v[216:219]
v_accvgpr_read_b32 v58, a170
v_mfma_f32_16x16x32_bf16 v[192:195], a[108:111], a[40:43], v[192:195]
buffer_load_dwordx4 a[24:27], v2, s[40:43], s35 offen offset:2048 sc1
v_mfma_f32_16x16x32_bf16 v[168:171], a[108:111], a[36:39], v[168:171]
ds_read_b128 a[152:155], v6 offset:29696
v_mfma_f32_16x16x32_bf16 v[144:147], a[108:111], a[32:35], v[144:147]
v_mfma_f32_16x16x32_bf16 v[148:151], a[112:115], a[32:35], v[148:151]
v_mfma_f32_16x16x32_bf16 v[172:175], a[112:115], a[36:39], v[172:175]
buffer_load_dwordx4 v1, s[4:7], s44 offen offset:2048 sc1 lds
s_add_u32 s88, s82, 0x280000
v_mfma_f32_16x16x32_bf16 v[196:199], a[112:115], a[40:43], v[196:199]
v_accvgpr_read_b32 v59, a171
v_mfma_f32_16x16x32_bf16 v[220:223], a[112:115], a[44:47], v[220:223]
v_mfma_f32_16x16x32_bf16 v[224:227], a[116:119], a[44:47], v[224:227]
v_mfma_f32_16x16x32_bf16 v[200:203], a[116:119], a[40:43], v[200:203]
buffer_load_dwordx4 a[28:31], v2, s[40:43], s35 offen offset:3072 sc1
s_add_u32 s35, s35, 4096
v_mfma_f32_16x16x32_bf16 v[176:179], a[116:119], a[36:39], v[176:179]
v_mfma_f32_16x16x32_bf16 v[152:155], a[116:119], a[32:35], v[152:155]
v_mfma_f32_16x16x32_bf16 a[88:91], a[120:123], a[68:71], a[88:91]
s_waitcnt vmcnt(11) lgkmcnt(0)
s_barrier
v_mfma_f32_16x16x32_bf16 v[132:135], a[128:131], a[48:51], v[132:135]
v_add_u32 v5, 49152, v1
v_add_u32 v6, s55, v5
v_mfma_f32_16x16x32_bf16 v[156:159], a[128:131], a[52:55], v[156:159]
buffer_load_dwordx4 a[32:35], v2, s[40:43], s35 offen offset:0 sc1
v_mfma_f32_16x16x32_bf16 v[180:183], a[128:131], a[56:59], v[180:183]
ds_read_b128 a[96:99], v5 offset:0
v_accvgpr_read_b32 v60, a172
v_mfma_f32_16x16x32_bf16 v[204:207], a[128:131], a[60:63], v[204:207]
ds_read_b128 a[100:103], v5 offset:1024
v_mfma_f32_16x16x32_bf16 v[208:211], a[132:135], a[60:63], v[208:211]
ds_read_b128 a[104:107], v5 offset:2048
v_mfma_f32_16x16x32_bf16 v[184:187], a[132:135], a[56:59], v[184:187]
buffer_load_dwordx4 v[92:95], v1, s[4:7], s88 offen offset:0 sc1
v_mfma_f32_16x16x32_bf16 v[160:163], a[132:135], a[52:55], v[160:163]
ds_read_b128 a[108:111], v5 offset:3072
v_accvgpr_read_b32 v61, a173
v_mfma_f32_16x16x32_bf16 v[136:139], a[132:135], a[48:51], v[136:139]
v_mfma_f32_16x16x32_bf16 v[140:143], a[136:139], a[48:51], v[140:143]
v_mfma_f32_16x16x32_bf16 v[164:167], a[136:139], a[52:55], v[164:167]
buffer_load_dwordx4 a[36:39], v2, s[40:43], s35 offen offset:1024 sc1
v_mfma_f32_16x16x32_bf16 v[188:191], a[136:139], a[56:59], v[188:191]
ds_read_b128 a[112:115], v5 offset:4096
v_mfma_f32_16x16x32_bf16 v[212:215], a[136:139], a[60:63], v[212:215]
ds_read_b128 a[116:119], v5 offset:5120
v_mfma_f32_16x16x32_bf16 v[216:219], a[140:143], a[60:63], v[216:219]
v_accvgpr_read_b32 v62, a174
v_mfma_f32_16x16x32_bf16 v[192:195], a[140:143], a[56:59], v[192:195]
buffer_load_dwordx4 a[40:43], v2, s[40:43], s35 offen offset:2048 sc1
v_mfma_f32_16x16x32_bf16 v[168:171], a[140:143], a[52:55], v[168:171]
ds_read_b128 a[120:123], v6 offset:2048
v_mfma_f32_16x16x32_bf16 v[144:147], a[140:143], a[48:51], v[144:147]
v_mfma_f32_16x16x32_bf16 v[148:151], a[144:147], a[48:51], v[148:151]
v_mfma_f32_16x16x32_bf16 v[172:175], a[144:147], a[52:55], v[172:175]
buffer_load_dwordx4 v[96:99], v1, s[4:7], s88 offen offset:1024 sc1
v_mfma_f32_16x16x32_bf16 v[196:199], a[144:147], a[56:59], v[196:199]
v_accvgpr_read_b32 v63, a175
v_mfma_f32_16x16x32_bf16 v[220:223], a[144:147], a[60:63], v[220:223]
v_mfma_f32_16x16x32_bf16 v[224:227], a[148:151], a[60:63], v[224:227]
v_mfma_f32_16x16x32_bf16 v[200:203], a[148:151], a[56:59], v[200:203]
buffer_load_dwordx4 a[44:47], v2, s[40:43], s35 offen offset:3072 sc1
s_add_u32 s35, s35, 4096
v_mfma_f32_16x16x32_bf16 v[176:179], a[148:151], a[52:55], v[176:179]
v_mfma_f32_16x16x32_bf16 v[152:155], a[148:151], a[48:51], v[152:155]
v_mfma_f32_16x16x32_bf16 a[92:95], a[152:155], a[68:71], a[92:95]
s_waitcnt vmcnt(12) lgkmcnt(0)
v_mfma_f32_16x16x32_bf16 v[132:135], a[96:99], a[0:3], v[132:135]
ds_read_b128 a[128:131], v5 offset:6144
v_accvgpr_read_b32 v64, a176
v_mfma_f32_16x16x32_bf16 v[156:159], a[96:99], a[4:7], v[156:159]
buffer_load_dwordx4 a[48:51], v2, s[40:43], s35 offen offset:0 sc1
v_mfma_f32_16x16x32_bf16 v[180:183], a[96:99], a[8:11], v[180:183]
ds_read_b128 a[132:135], v5 offset:7168
v_mfma_f32_16x16x32_bf16 v[204:207], a[96:99], a[12:15], v[204:207]
v_mfma_f32_16x16x32_bf16 v[208:211], a[100:103], a[12:15], v[208:211]
ds_read_b128 a[136:139], v5 offset:8192
v_mfma_f32_16x16x32_bf16 v[184:187], a[100:103], a[8:11], v[184:187]
L_stub11:
s_cbranch_execz L_stub12
buffer_load_dwordx4 v[100:103], v1, s[4:7], s88 offen offset:2048 sc1
s_add_u32 s63, s28, 12
v_mfma_f32_16x16x32_bf16 v[160:163], a[100:103], a[4:7], v[160:163]
s_lshl_b32 s63, s63, 12
ds_read_b128 a[140:143], v5 offset:9216
v_mfma_f32_16x16x32_bf16 v[136:139], a[100:103], a[0:3], v[136:139]
v_accvgpr_read_b32 v65, a177
v_mfma_f32_16x16x32_bf16 v[140:143], a[104:107], a[0:3], v[140:143]
v_mfma_f32_16x16x32_bf16 v[164:167], a[104:107], a[4:7], v[164:167]
buffer_load_dwordx4 a[52:55], v2, s[40:43], s35 offen offset:1024 sc1
v_mfma_f32_16x16x32_bf16 v[188:191], a[104:107], a[8:11], v[188:191]
ds_read_b128 a[144:147], v5 offset:10240
v_mfma_f32_16x16x32_bf16 v[212:215], a[104:107], a[12:15], v[212:215]
ds_read_b128 a[148:151], v5 offset:11264
v_mfma_f32_16x16x32_bf16 v[216:219], a[108:111], a[12:15], v[216:219]
v_accvgpr_read_b32 v66, a178
v_mfma_f32_16x16x32_bf16 v[192:195], a[108:111], a[8:11], v[192:195]
buffer_load_dwordx4 a[56:59], v2, s[40:43], s35 offen offset:2048 sc1
v_mfma_f32_16x16x32_bf16 v[168:171], a[108:111], a[4:7], v[168:171]
ds_read_b128 a[152:155], v6 offset:3072
v_mfma_f32_16x16x32_bf16 v[144:147], a[108:111], a[0:3], v[144:147]
v_mfma_f32_16x16x32_bf16 v[148:151], a[112:115], a[0:3], v[148:151]
v_mfma_f32_16x16x32_bf16 v[172:175], a[112:115], a[4:7], v[172:175]
buffer_load_dwordx4 a[64:67], v3, s[40:43], s63 offen sc1
v_mfma_f32_16x16x32_bf16 v[196:199], a[112:115], a[8:11], v[196:199]
v_accvgpr_read_b32 v67, a179
v_mfma_f32_16x16x32_bf16 v[220:223], a[112:115], a[12:15], v[220:223]
v_mfma_f32_16x16x32_bf16 v[224:227], a[116:119], a[12:15], v[224:227]
v_mfma_f32_16x16x32_bf16 v[200:203], a[116:119], a[8:11], v[200:203]
buffer_load_dwordx4 a[60:63], v2, s[40:43], s35 offen offset:3072 sc1
s_add_u32 s35, s35, 4096
v_mfma_f32_16x16x32_bf16 v[176:179], a[116:119], a[4:7], v[176:179]
v_mfma_f32_16x16x32_bf16 v[152:155], a[116:119], a[0:3], v[152:155]
v_mfma_f32_16x16x32_bf16 a[80:83], a[120:123], a[72:75], a[80:83]
s_waitcnt vmcnt(12) lgkmcnt(0)
v_mfma_f32_16x16x32_bf16 v[132:135], a[128:131], a[16:19], v[132:135]
ds_read_b128 a[96:99], v5 offset:12288
v_accvgpr_read_b32 v68, a180
v_mfma_f32_16x16x32_bf16 v[156:159], a[128:131], a[20:23], v[156:159]
buffer_load_dwordx4 a[0:3], v2, s[40:43], s35 offen offset:0 sc1
v_mfma_f32_16x16x32_bf16 v[180:183], a[128:131], a[24:27], v[180:183]
ds_read_b128 a[100:103], v5 offset:13312
v_mfma_f32_16x16x32_bf16 v[204:207], a[128:131], a[28:31], v[204:207]
v_mfma_f32_16x16x32_bf16 v[208:211], a[132:135], a[28:31], v[208:211]
ds_read_b128 a[104:107], v5 offset:14336
v_mfma_f32_16x16x32_bf16 v[184:187], a[132:135], a[24:27], v[184:187]
buffer_load_dwordx4 v[104:107], v1, s[4:7], s88 offen offset:3072 sc1
s_add_u32 s88, s88, 4096
v_mfma_f32_16x16x32_bf16 v[160:163], a[132:135], a[20:23], v[160:163]
ds_read_b128 a[108:111], v5 offset:15360
v_accvgpr_read_b32 v69, a181
v_mfma_f32_16x16x32_bf16 v[136:139], a[132:135], a[16:19], v[136:139]
v_mfma_f32_16x16x32_bf16 v[140:143], a[136:139], a[16:19], v[140:143]
v_mfma_f32_16x16x32_bf16 v[164:167], a[136:139], a[20:23], v[164:167]
buffer_load_dwordx4 a[4:7], v2, s[40:43], s35 offen offset:1024 sc1
v_mfma_f32_16x16x32_bf16 v[188:191], a[136:139], a[24:27], v[188:191]
ds_read_b128 a[112:115], v5 offset:16384
v_mfma_f32_16x16x32_bf16 v[212:215], a[136:139], a[28:31], v[212:215]
ds_read_b128 a[116:119], v5 offset:17408
v_mfma_f32_16x16x32_bf16 v[216:219], a[140:143], a[28:31], v[216:219]
v_accvgpr_read_b32 v70, a182
v_mfma_f32_16x16x32_bf16 v[192:195], a[140:143], a[24:27], v[192:195]
buffer_load_dwordx4 a[8:11], v2, s[40:43], s35 offen offset:2048 sc1
v_mfma_f32_16x16x32_bf16 v[168:171], a[140:143], a[20:23], v[168:171]
ds_read_b128 a[120:123], v6 offset:4096
v_mfma_f32_16x16x32_bf16 v[144:147], a[140:143], a[16:19], v[144:147]
v_mfma_f32_16x16x32_bf16 v[148:151], a[144:147], a[16:19], v[148:151]
v_mfma_f32_16x16x32_bf16 v[172:175], a[144:147], a[20:23], v[172:175]
buffer_load_dwordx4 v[108:111], v1, s[4:7], s88 offen offset:0 sc1
v_mfma_f32_16x16x32_bf16 v[196:199], a[144:147], a[24:27], v[196:199]
v_accvgpr_read_b32 v71, a183
v_mfma_f32_16x16x32_bf16 v[220:223], a[144:147], a[28:31], v[220:223]
v_mfma_f32_16x16x32_bf16 v[224:227], a[148:151], a[28:31], v[224:227]
v_mfma_f32_16x16x32_bf16 v[200:203], a[148:151], a[24:27], v[200:203]
buffer_load_dwordx4 a[12:15], v2, s[40:43], s35 offen offset:3072 sc1
s_add_u32 s35, s35, 4096
v_mfma_f32_16x16x32_bf16 v[176:179], a[148:151], a[20:23], v[176:179]
v_mfma_f32_16x16x32_bf16 v[152:155], a[148:151], a[16:19], v[152:155]
v_mfma_f32_16x16x32_bf16 a[84:87], a[152:155], a[72:75], a[84:87]
s_waitcnt vmcnt(12) lgkmcnt(0)
v_mfma_f32_16x16x32_bf16 v[132:135], a[96:99], a[32:35], v[132:135]
ds_read_b128 a[128:131], v5 offset:18432
v_accvgpr_read_b32 v72, a184
v_mfma_f32_16x16x32_bf16 v[156:159], a[96:99], a[36:39], v[156:159]
buffer_load_dwordx4 a[16:19], v2, s[40:43], s35 offen offset:0 sc1
v_mfma_f32_16x16x32_bf16 v[180:183], a[96:99], a[40:43], v[180:183]
ds_read_b128 a[132:135], v5 offset:19456
v_mfma_f32_16x16x32_bf16 v[204:207], a[96:99], a[44:47], v[204:207]
v_mfma_f32_16x16x32_bf16 v[208:211], a[100:103], a[44:47], v[208:211]
ds_read_b128 a[136:139], v5 offset:20480
v_mfma_f32_16x16x32_bf16 v[184:187], a[100:103], a[40:43], v[184:187]
buffer_load_dwordx4 v[112:115], v1, s[4:7], s88 offen offset:1024 sc1
v_mfma_f32_16x16x32_bf16 v[160:163], a[100:103], a[36:39], v[160:163]
ds_read_b128 a[140:143], v5 offset:21504
v_accvgpr_read_b32 v73, a185
v_mfma_f32_16x16x32_bf16 v[136:139], a[100:103], a[32:35], v[136:139]
v_mfma_f32_16x16x32_bf16 v[140:143], a[104:107], a[32:35], v[140:143]
v_mfma_f32_16x16x32_bf16 v[164:167], a[104:107], a[36:39], v[164:167]
buffer_load_dwordx4 a[20:23], v2, s[40:43], s35 offen offset:1024 sc1
v_mfma_f32_16x16x32_bf16 v[188:191], a[104:107], a[40:43], v[188:191]
ds_read_b128 a[144:147], v5 offset:22528
v_mfma_f32_16x16x32_bf16 v[212:215], a[104:107], a[44:47], v[212:215]
ds_read_b128 a[148:151], v5 offset:23552
v_mfma_f32_16x16x32_bf16 v[216:219], a[108:111], a[44:47], v[216:219]
v_accvgpr_read_b32 v74, a186
v_mfma_f32_16x16x32_bf16 v[192:195], a[108:111], a[40:43], v[192:195]
buffer_load_dwordx4 a[24:27], v2, s[40:43], s35 offen offset:2048 sc1
v_mfma_f32_16x16x32_bf16 v[168:171], a[108:111], a[36:39], v[168:171]
ds_read_b128 a[152:155], v6 offset:5120
v_mfma_f32_16x16x32_bf16 v[144:147], a[108:111], a[32:35], v[144:147]
v_mfma_f32_16x16x32_bf16 v[148:151], a[112:115], a[32:35], v[148:151]
v_mfma_f32_16x16x32_bf16 v[172:175], a[112:115], a[36:39], v[172:175]
buffer_load_dwordx4 v[116:119], v1, s[4:7], s88 offen offset:2048 sc1
v_mfma_f32_16x16x32_bf16 v[196:199], a[112:115], a[40:43], v[196:199]
v_accvgpr_read_b32 v75, a187
v_mfma_f32_16x16x32_bf16 v[220:223], a[112:115], a[44:47], v[220:223]
v_mfma_f32_16x16x32_bf16 v[224:227], a[116:119], a[44:47], v[224:227]
v_mfma_f32_16x16x32_bf16 v[200:203], a[116:119], a[40:43], v[200:203]
buffer_load_dwordx4 a[28:31], v2, s[40:43], s35 offen offset:3072 sc1
s_add_u32 s35, s35, 4096
v_mfma_f32_16x16x32_bf16 v[176:179], a[116:119], a[36:39], v[176:179]
v_mfma_f32_16x16x32_bf16 v[152:155], a[116:119], a[32:35], v[152:155]
v_mfma_f32_16x16x32_bf16 a[88:91], a[120:123], a[72:75], a[88:91]
s_waitcnt vmcnt(12) lgkmcnt(0)
v_mfma_f32_16x16x32_bf16 v[132:135], a[128:131], a[48:51], v[132:135]
ds_read_b128 a[96:99], v5 offset:24576
v_mfma_f32_16x16x32_bf16 v[156:159], a[128:131], a[52:55], v[156:159]
buffer_load_dwordx4 a[32:35], v2, s[40:43], s35 offen offset:0 sc1
v_mfma_f32_16x16x32_bf16 v[180:183], a[128:131], a[56:59], v[180:183]
ds_read_b128 a[100:103], v5 offset:25600
v_mfma_f32_16x16x32_bf16 v[204:207], a[128:131], a[60:63], v[204:207]
v_mfma_f32_16x16x32_bf16 v[208:211], a[132:135], a[60:63], v[208:211]
ds_read_b128 a[104:107], v5 offset:26624
v_mfma_f32_16x16x32_bf16 v[184:187], a[132:135], a[56:59], v[184:187]
v_mfma_f32_16x16x32_bf16 v[160:163], a[132:135], a[52:55], v[160:163]
buffer_load_dwordx4 a[36:39], v2, s[40:43], s35 offen offset:1024 sc1
v_mfma_f32_16x16x32_bf16 v[136:139], a[132:135], a[48:51], v[136:139]
ds_read_b128 a[108:111], v5 offset:27648
v_mfma_f32_16x16x32_bf16 v[140:143], a[136:139], a[48:51], v[140:143]
v_mfma_f32_16x16x32_bf16 v[164:167], a[136:139], a[52:55], v[164:167]
ds_read_b128 a[112:115], v5 offset:28672
v_mfma_f32_16x16x32_bf16 v[188:191], a[136:139], a[56:59], v[188:191]
v_mfma_f32_16x16x32_bf16 v[212:215], a[136:139], a[60:63], v[212:215]
buffer_load_dwordx4 v[120:123], v1, s[4:7], s88 offen offset:3072 sc1
s_add_u32 s88, s83, 0x280000
v_mfma_f32_16x16x32_bf16 v[216:219], a[140:143], a[60:63], v[216:219]
ds_read_b128 a[116:119], v5 offset:29696
v_mfma_f32_16x16x32_bf16 v[192:195], a[140:143], a[56:59], v[192:195]
ds_read_b128 a[120:123], v6 offset:26624
v_mfma_f32_16x16x32_bf16 v[168:171], a[140:143], a[52:55], v[168:171]
v_mfma_f32_16x16x32_bf16 v[144:147], a[140:143], a[48:51], v[144:147]
v_mfma_f32_16x16x32_bf16 v[148:151], a[144:147], a[48:51], v[148:151]
buffer_load_dwordx4 a[40:43], v2, s[40:43], s35 offen offset:2048 sc1
v_mfma_f32_16x16x32_bf16 v[172:175], a[144:147], a[52:55], v[172:175]
v_mfma_f32_16x16x32_bf16 v[196:199], a[144:147], a[56:59], v[196:199]
v_mfma_f32_16x16x32_bf16 v[220:223], a[144:147], a[60:63], v[220:223]
v_mfma_f32_16x16x32_bf16 v[224:227], a[148:151], a[60:63], v[224:227]
v_mfma_f32_16x16x32_bf16 v[200:203], a[148:151], a[56:59], v[200:203]
buffer_load_dwordx4 a[44:47], v2, s[40:43], s35 offen offset:3072 sc1
s_add_u32 s35, s35, 4096
v_mfma_f32_16x16x32_bf16 v[176:179], a[148:151], a[52:55], v[176:179]
v_mfma_f32_16x16x32_bf16 v[152:155], a[148:151], a[48:51], v[152:155]
v_mfma_f32_16x16x32_bf16 a[92:95], a[152:155], a[72:75], a[92:95]
s_waitcnt vmcnt(11) lgkmcnt(0)
v_mfma_f32_16x16x32_bf16 v[132:135], a[96:99], a[0:3], v[132:135]
ds_read_b128 a[128:131], v5 offset:30720
v_mfma_f32_16x16x32_bf16 v[156:159], a[96:99], a[4:7], v[156:159]
buffer_load_dwordx4 a[48:51], v2, s[40:43], s35 offen offset:0 sc1
v_mfma_f32_16x16x32_bf16 v[180:183], a[96:99], a[8:11], v[180:183]
ds_read_b128 a[132:135], v5 offset:31744
v_mfma_f32_16x16x32_bf16 v[204:207], a[96:99], a[12:15], v[204:207]
v_mfma_f32_16x16x32_bf16 v[208:211], a[100:103], a[12:15], v[208:211]
buffer_load_dwordx4 v[124:127], v1, s[4:7], s88 offen offset:0 sc1
v_mfma_f32_16x16x32_bf16 v[184:187], a[100:103], a[8:11], v[184:187]
ds_read_b128 a[136:139], v5 offset:32768
v_mfma_f32_16x16x32_bf16 v[160:163], a[100:103], a[4:7], v[160:163]
ds_read_b128 a[140:143], v5 offset:33792
v_mfma_f32_16x16x32_bf16 v[136:139], a[100:103], a[0:3], v[136:139]
v_mfma_f32_16x16x32_bf16 v[140:143], a[104:107], a[0:3], v[140:143]
buffer_load_dwordx4 a[52:55], v2, s[40:43], s35 offen offset:1024 sc1
v_mfma_f32_16x16x32_bf16 v[164:167], a[104:107], a[4:7], v[164:167]
ds_read_b128 a[144:147], v5 offset:34816
v_mfma_f32_16x16x32_bf16 v[188:191], a[104:107], a[8:11], v[188:191]
v_mfma_f32_16x16x32_bf16 v[212:215], a[104:107], a[12:15], v[212:215]
buffer_load_dwordx4 v[128:131], v1, s[4:7], s88 offen offset:1024 sc1
s_add_u32 s63, s28, 16
v_mfma_f32_16x16x32_bf16 v[216:219], a[108:111], a[12:15], v[216:219]
s_lshl_b32 s63, s63, 12
ds_read_b128 a[148:151], v5 offset:35840
v_mfma_f32_16x16x32_bf16 v[192:195], a[108:111], a[8:11], v[192:195]
ds_read_b128 a[152:155], v6 offset:27648
v_mfma_f32_16x16x32_bf16 v[168:171], a[108:111], a[4:7], v[168:171]
v_mfma_f32_16x16x32_bf16 v[144:147], a[108:111], a[0:3], v[144:147]
buffer_load_dwordx4 a[56:59], v2, s[40:43], s35 offen offset:2048 sc1
v_mfma_f32_16x16x32_bf16 v[148:151], a[112:115], a[0:3], v[148:151]
v_mfma_f32_16x16x32_bf16 v[172:175], a[112:115], a[4:7], v[172:175]
v_mfma_f32_16x16x32_bf16 v[196:199], a[112:115], a[8:11], v[196:199]
buffer_load_dwordx4 a[68:71], v3, s[40:43], s63 offen sc1
s_add_u32 s44, s28, 0
v_mfma_f32_16x16x32_bf16 v[220:223], a[112:115], a[12:15], v[220:223]
s_mul_i32 s45, s44, 3072
s_add_u32 m0, s45, 0
s_lshr_b32 s44, s44, 1
v_mfma_f32_16x16x32_bf16 v[224:227], a[116:119], a[12:15], v[224:227]
s_add_u32 s44, s44, 24
s_mul_i32 s44, s44, 6144
s_add_u32 s44, s44, s50
v_mfma_f32_16x16x32_bf16 v[200:203], a[116:119], a[8:11], v[200:203]
v_mfma_f32_16x16x32_bf16 v[176:179], a[116:119], a[4:7], v[176:179]
buffer_load_dwordx4 a[60:63], v2, s[40:43], s35 offen offset:3072 sc1
s_add_u32 s35, s35, 4096
v_mfma_f32_16x16x32_bf16 v[152:155], a[116:119], a[0:3], v[152:155]
v_mfma_f32_16x16x32_bf16 a[80:83], a[120:123], a[64:67], a[80:83]
s_waitcnt vmcnt(12) lgkmcnt(0)
v_mfma_f32_16x16x32_bf16 v[132:135], a[128:131], a[16:19], v[132:135]
ds_read_b128 a[96:99], v5 offset:36864
v_mfma_f32_16x16x32_bf16 v[156:159], a[128:131], a[20:23], v[156:159]
buffer_load_dwordx4 a[0:3], v2, s[40:43], s35 offen offset:0 sc1
v_mfma_f32_16x16x32_bf16 v[180:183], a[128:131], a[24:27], v[180:183]
ds_read_b128 a[100:103], v5 offset:37888
v_mfma_f32_16x16x32_bf16 v[204:207], a[128:131], a[28:31], v[204:207]
v_mfma_f32_16x16x32_bf16 v[208:211], a[132:135], a[28:31], v[208:211]
ds_read_b128 a[104:107], v5 offset:38912
v_mfma_f32_16x16x32_bf16 v[184:187], a[132:135], a[24:27], v[184:187]
buffer_load_dwordx4 v1, s[4:7], s44 offen offset:0 sc1 lds
v_mfma_f32_16x16x32_bf16 v[160:163], a[132:135], a[20:23], v[160:163]
ds_read_b128 a[108:111], v5 offset:39936
v_mfma_f32_16x16x32_bf16 v[136:139], a[132:135], a[16:19], v[136:139]
v_mfma_f32_16x16x32_bf16 v[140:143], a[136:139], a[16:19], v[140:143]
v_mfma_f32_16x16x32_bf16 v[164:167], a[136:139], a[20:23], v[164:167]
buffer_load_dwordx4 a[4:7], v2, s[40:43], s35 offen offset:1024 sc1
v_mfma_f32_16x16x32_bf16 v[188:191], a[136:139], a[24:27], v[188:191]
ds_read_b128 a[112:115], v5 offset:40960
v_mfma_f32_16x16x32_bf16 v[212:215], a[136:139], a[28:31], v[212:215]
ds_read_b128 a[116:119], v5 offset:41984
v_mfma_f32_16x16x32_bf16 v[216:219], a[140:143], a[28:31], v[216:219]
v_mfma_f32_16x16x32_bf16 v[192:195], a[140:143], a[24:27], v[192:195]
buffer_load_dwordx4 a[8:11], v2, s[40:43], s35 offen offset:2048 sc1
v_mfma_f32_16x16x32_bf16 v[168:171], a[140:143], a[20:23], v[168:171]
ds_read_b128 a[120:123], v6 offset:28672
v_mfma_f32_16x16x32_bf16 v[144:147], a[140:143], a[16:19], v[144:147]
v_mfma_f32_16x16x32_bf16 v[148:151], a[144:147], a[16:19], v[148:151]
v_mfma_f32_16x16x32_bf16 v[172:175], a[144:147], a[20:23], v[172:175]
buffer_load_dwordx4 v1, s[4:7], s44 offen offset:1024 sc1 lds
v_mfma_f32_16x16x32_bf16 v[196:199], a[144:147], a[24:27], v[196:199]
v_mfma_f32_16x16x32_bf16 v[220:223], a[144:147], a[28:31], v[220:223]
v_mfma_f32_16x16x32_bf16 v[224:227], a[148:151], a[28:31], v[224:227]
v_mfma_f32_16x16x32_bf16 v[200:203], a[148:151], a[24:27], v[200:203]
buffer_load_dwordx4 a[12:15], v2, s[40:43], s35 offen offset:3072 sc1
s_add_u32 s35, s35, 4096
v_mfma_f32_16x16x32_bf16 v[176:179], a[148:151], a[20:23], v[176:179]
v_mfma_f32_16x16x32_bf16 v[152:155], a[148:151], a[16:19], v[152:155]
v_mfma_f32_16x16x32_bf16 a[84:87], a[152:155], a[64:67], a[84:87]
s_waitcnt vmcnt(13) lgkmcnt(0)
v_mfma_f32_16x16x32_bf16 v[132:135], a[96:99], a[32:35], v[132:135]
ds_read_b128 a[128:131], v5 offset:43008
v_mfma_f32_16x16x32_bf16 v[156:159], a[96:99], a[36:39], v[156:159]
buffer_load_dwordx4 a[16:19], v2, s[40:43], s35 offen offset:0 sc1
v_mfma_f32_16x16x32_bf16 v[180:183], a[96:99], a[40:43], v[180:183]
ds_read_b128 a[132:135], v5 offset:44032
v_mfma_f32_16x16x32_bf16 v[204:207], a[96:99], a[44:47], v[204:207]
v_mfma_f32_16x16x32_bf16 v[208:211], a[100:103], a[44:47], v[208:211]
ds_read_b128 a[136:139], v5 offset:45056
v_mfma_f32_16x16x32_bf16 v[184:187], a[100:103], a[40:43], v[184:187]
v_mfma_f32_16x16x32_bf16 v[160:163], a[100:103], a[36:39], v[160:163]
buffer_load_dwordx4 a[20:23], v2, s[40:43], s35 offen offset:1024 sc1
v_mfma_f32_16x16x32_bf16 v[136:139], a[100:103], a[32:35], v[136:139]
ds_read_b128 a[140:143], v5 offset:46080
v_mfma_f32_16x16x32_bf16 v[140:143], a[104:107], a[32:35], v[140:143]
v_mfma_f32_16x16x32_bf16 v[164:167], a[104:107], a[36:39], v[164:167]
ds_read_b128 a[144:147], v5 offset:47104
v_mfma_f32_16x16x32_bf16 v[188:191], a[104:107], a[40:43], v[188:191]
v_mfma_f32_16x16x32_bf16 v[212:215], a[104:107], a[44:47], v[212:215]
buffer_load_dwordx4 v1, s[4:7], s44 offen offset:2048 sc1 lds
s_add_u32 s44, s28, 4
v_mfma_f32_16x16x32_bf16 v[216:219], a[108:111], a[44:47], v[216:219]
s_mul_i32 s45, s44, 3072
s_add_u32 m0, s45, 0
s_lshr_b32 s44, s44, 1
v_mfma_f32_16x16x32_bf16 v[192:195], a[108:111], a[40:43], v[192:195]
s_add_u32 s44, s44, 24
s_mul_i32 s44, s44, 6144
s_add_u32 s44, s44, s50
v_mfma_f32_16x16x32_bf16 v[168:171], a[108:111], a[36:39], v[168:171]
ds_read_b128 a[148:151], v5 offset:48128
v_mfma_f32_16x16x32_bf16 v[144:147], a[108:111], a[32:35], v[144:147]
ds_read_b128 a[152:155], v6 offset:29696
v_mfma_f32_16x16x32_bf16 v[148:151], a[112:115], a[32:35], v[148:151]
buffer_load_dwordx4 a[24:27], v2, s[40:43], s35 offen offset:2048 sc1
v_mfma_f32_16x16x32_bf16 v[172:175], a[112:115], a[36:39], v[172:175]
v_mfma_f32_16x16x32_bf16 v[196:199], a[112:115], a[40:43], v[196:199]
v_mfma_f32_16x16x32_bf16 v[220:223], a[112:115], a[44:47], v[220:223]
v_mfma_f32_16x16x32_bf16 v[224:227], a[116:119], a[44:47], v[224:227]
v_mfma_f32_16x16x32_bf16 v[200:203], a[116:119], a[40:43], v[200:203]
buffer_load_dwordx4 a[28:31], v2, s[40:43], s35 offen offset:3072 sc1
s_add_u32 s35, s35, 4096
v_mfma_f32_16x16x32_bf16 v[176:179], a[116:119], a[36:39], v[176:179]
v_mfma_f32_16x16x32_bf16 v[152:155], a[116:119], a[32:35], v[152:155]
v_mfma_f32_16x16x32_bf16 a[88:91], a[120:123], a[64:67], a[88:91]
s_waitcnt vmcnt(11) lgkmcnt(0)
s_barrier
v_mfma_f32_16x16x32_bf16 v[132:135], a[128:131], a[48:51], v[132:135]
v_add_u32 v5, 98304, v1
v_add_u32 v6, s55, v5
v_mfma_f32_16x16x32_bf16 v[156:159], a[128:131], a[52:55], v[156:159]
buffer_load_dwordx4 a[32:35], v2, s[40:43], s35 offen offset:0 sc1
v_mfma_f32_16x16x32_bf16 v[180:183], a[128:131], a[56:59], v[180:183]
ds_read_b128 a[96:99], v5 offset:0
v_mfma_f32_16x16x32_bf16 v[204:207], a[128:131], a[60:63], v[204:207]
ds_read_b128 a[100:103], v5 offset:1024
v_mfma_f32_16x16x32_bf16 v[208:211], a[132:135], a[60:63], v[208:211]
ds_read_b128 a[104:107], v5 offset:2048
v_mfma_f32_16x16x32_bf16 v[184:187], a[132:135], a[56:59], v[184:187]
buffer_load_dwordx4 v1, s[4:7], s44 offen offset:0 sc1 lds
v_mfma_f32_16x16x32_bf16 v[160:163], a[132:135], a[52:55], v[160:163]
ds_read_b128 a[108:111], v5 offset:3072
v_mfma_f32_16x16x32_bf16 v[136:139], a[132:135], a[48:51], v[136:139]
v_mfma_f32_16x16x32_bf16 v[140:143], a[136:139], a[48:51], v[140:143]
v_mfma_f32_16x16x32_bf16 v[164:167], a[136:139], a[52:55], v[164:167]
buffer_load_dwordx4 a[36:39], v2, s[40:43], s35 offen offset:1024 sc1
v_mfma_f32_16x16x32_bf16 v[188:191], a[136:139], a[56:59], v[188:191]
ds_read_b128 a[112:115], v5 offset:4096
v_mfma_f32_16x16x32_bf16 v[212:215], a[136:139], a[60:63], v[212:215]
ds_read_b128 a[116:119], v5 offset:5120
v_mfma_f32_16x16x32_bf16 v[216:219], a[140:143], a[60:63], v[216:219]
v_mfma_f32_16x16x32_bf16 v[192:195], a[140:143], a[56:59], v[192:195]
buffer_load_dwordx4 a[40:43], v2, s[40:43], s35 offen offset:2048 sc1
v_mfma_f32_16x16x32_bf16 v[168:171], a[140:143], a[52:55], v[168:171]
ds_read_b128 a[120:123], v6 offset:2048
v_mfma_f32_16x16x32_bf16 v[144:147], a[140:143], a[48:51], v[144:147]
v_mfma_f32_16x16x32_bf16 v[148:151], a[144:147], a[48:51], v[148:151]
v_mfma_f32_16x16x32_bf16 v[172:175], a[144:147], a[52:55], v[172:175]
buffer_load_dwordx4 v1, s[4:7], s44 offen offset:1024 sc1 lds
v_mfma_f32_16x16x32_bf16 v[196:199], a[144:147], a[56:59], v[196:199]
v_mfma_f32_16x16x32_bf16 v[220:223], a[144:147], a[60:63], v[220:223]
v_mfma_f32_16x16x32_bf16 v[224:227], a[148:151], a[60:63], v[224:227]
v_mfma_f32_16x16x32_bf16 v[200:203], a[148:151], a[56:59], v[200:203]
buffer_load_dwordx4 a[44:47], v2, s[40:43], s35 offen offset:3072 sc1
s_add_u32 s35, s35, 4096
v_mfma_f32_16x16x32_bf16 v[176:179], a[148:151], a[52:55], v[176:179]
v_mfma_f32_16x16x32_bf16 v[152:155], a[148:151], a[48:51], v[152:155]
v_mfma_f32_16x16x32_bf16 a[92:95], a[152:155], a[64:67], a[92:95]
s_waitcnt vmcnt(11) lgkmcnt(0)
v_mfma_f32_16x16x32_bf16 v[132:135], a[96:99], a[0:3], v[132:135]
ds_read_b128 a[128:131], v5 offset:6144
v_mfma_f32_16x16x32_bf16 v[156:159], a[96:99], a[4:7], v[156:159]
buffer_load_dwordx4 a[48:51], v2, s[40:43], s35 offen offset:0 sc1
v_mfma_f32_16x16x32_bf16 v[180:183], a[96:99], a[8:11], v[180:183]
ds_read_b128 a[132:135], v5 offset:7168
v_mfma_f32_16x16x32_bf16 v[204:207], a[96:99], a[12:15], v[204:207]
v_mfma_f32_16x16x32_bf16 v[208:211], a[100:103], a[12:15], v[208:211]
buffer_load_dwordx4 v1, s[4:7], s44 offen offset:2048 sc1 lds
s_add_u32 s44, s28, 8
v_mfma_f32_16x16x32_bf16 v[184:187], a[100:103], a[8:11], v[184:187]
s_mul_i32 s45, s44, 3072
s_add_u32 m0, s45, 0
s_lshr_b32 s44, s44, 1
v_mfma_f32_16x16x32_bf16 v[160:163], a[100:103], a[4:7], v[160:163]
s_add_u32 s44, s44, 24
s_mul_i32 s44, s44, 6144
s_add_u32 s44, s44, s50
v_mfma_f32_16x16x32_bf16 v[136:139], a[100:103], a[0:3], v[136:139]
ds_read_b128 a[136:139], v5 offset:8192
v_mfma_f32_16x16x32_bf16 v[140:143], a[104:107], a[0:3], v[140:143]
buffer_load_dwordx4 a[52:55], v2, s[40:43], s35 offen offset:1024 sc1
v_mfma_f32_16x16x32_bf16 v[164:167], a[104:107], a[4:7], v[164:167]
ds_read_b128 a[140:143], v5 offset:9216
v_mfma_f32_16x16x32_bf16 v[188:191], a[104:107], a[8:11], v[188:191]
ds_read_b128 a[144:147], v5 offset:10240
v_mfma_f32_16x16x32_bf16 v[212:215], a[104:107], a[12:15], v[212:215]
buffer_load_dwordx4 v1, s[4:7], s44 offen offset:0 sc1 lds
s_add_u32 s63, s28, 20
v_mfma_f32_16x16x32_bf16 v[216:219], a[108:111], a[12:15], v[216:219]
s_lshl_b32 s63, s63, 12
ds_read_b128 a[148:151], v5 offset:11264
v_mfma_f32_16x16x32_bf16 v[192:195], a[108:111], a[8:11], v[192:195]
ds_read_b128 a[152:155], v6 offset:3072
v_mfma_f32_16x16x32_bf16 v[168:171], a[108:111], a[4:7], v[168:171]
v_mfma_f32_16x16x32_bf16 v[144:147], a[108:111], a[0:3], v[144:147]
buffer_load_dwordx4 a[56:59], v2, s[40:43], s35 offen offset:2048 sc1
v_mfma_f32_16x16x32_bf16 v[148:151], a[112:115], a[0:3], v[148:151]
v_mfma_f32_16x16x32_bf16 v[172:175], a[112:115], a[4:7], v[172:175]
v_mfma_f32_16x16x32_bf16 v[196:199], a[112:115], a[8:11], v[196:199]
buffer_load_dwordx4 a[72:75], v3, s[40:43], s63 offen sc1
v_mfma_f32_16x16x32_bf16 v[220:223], a[112:115], a[12:15], v[220:223]
v_mfma_f32_16x16x32_bf16 v[224:227], a[116:119], a[12:15], v[224:227]
v_mfma_f32_16x16x32_bf16 v[200:203], a[116:119], a[8:11], v[200:203]
v_mfma_f32_16x16x32_bf16 v[176:179], a[116:119], a[4:7], v[176:179]
buffer_load_dwordx4 a[60:63], v2, s[40:43], s35 offen offset:3072 sc1
s_add_u32 s35, s35, 4096
v_mfma_f32_16x16x32_bf16 v[152:155], a[116:119], a[0:3], v[152:155]
v_mfma_f32_16x16x32_bf16 a[80:83], a[120:123], a[68:71], a[80:83]
s_waitcnt vmcnt(13) lgkmcnt(0)
v_mfma_f32_16x16x32_bf16 v[132:135], a[128:131], a[16:19], v[132:135]
ds_read_b128 a[96:99], v5 offset:12288
v_mfma_f32_16x16x32_bf16 v[156:159], a[128:131], a[20:23], v[156:159]
buffer_load_dwordx4 a[0:3], v2, s[40:43], s35 offen offset:0 sc1
v_mfma_f32_16x16x32_bf16 v[180:183], a[128:131], a[24:27], v[180:183]
ds_read_b128 a[100:103], v5 offset:13312
v_mfma_f32_16x16x32_bf16 v[204:207], a[128:131], a[28:31], v[204:207]
v_mfma_f32_16x16x32_bf16 v[208:211], a[132:135], a[28:31], v[208:211]
ds_read_b128 a[104:107], v5 offset:14336
v_mfma_f32_16x16x32_bf16 v[184:187], a[132:135], a[24:27], v[184:187]
v_mfma_f32_16x16x32_bf16 v[160:163], a[132:135], a[20:23], v[160:163]
buffer_load_dwordx4 a[4:7], v2, s[40:43], s35 offen offset:1024 sc1
v_mfma_f32_16x16x32_bf16 v[136:139], a[132:135], a[16:19], v[136:139]
ds_read_b128 a[108:111], v5 offset:15360
v_mfma_f32_16x16x32_bf16 v[140:143], a[136:139], a[16:19], v[140:143]
v_mfma_f32_16x16x32_bf16 v[164:167], a[136:139], a[20:23], v[164:167]
ds_read_b128 a[112:115], v5 offset:16384
v_mfma_f32_16x16x32_bf16 v[188:191], a[136:139], a[24:27], v[188:191]
v_mfma_f32_16x16x32_bf16 v[212:215], a[136:139], a[28:31], v[212:215]
buffer_load_dwordx4 v1, s[4:7], s44 offen offset:1024 sc1 lds
v_mfma_f32_16x16x32_bf16 v[216:219], a[140:143], a[28:31], v[216:219]
ds_read_b128 a[116:119], v5 offset:17408
v_mfma_f32_16x16x32_bf16 v[192:195], a[140:143], a[24:27], v[192:195]
ds_read_b128 a[120:123], v6 offset:4096
v_mfma_f32_16x16x32_bf16 v[168:171], a[140:143], a[20:23], v[168:171]
v_mfma_f32_16x16x32_bf16 v[144:147], a[140:143], a[16:19], v[144:147]
v_mfma_f32_16x16x32_bf16 v[148:151], a[144:147], a[16:19], v[148:151]
buffer_load_dwordx4 a[8:11], v2, s[40:43], s35 offen offset:2048 sc1
v_mfma_f32_16x16x32_bf16 v[172:175], a[144:147], a[20:23], v[172:175]
v_mfma_f32_16x16x32_bf16 v[196:199], a[144:147], a[24:27], v[196:199]
v_mfma_f32_16x16x32_bf16 v[220:223], a[144:147], a[28:31], v[220:223]
v_mfma_f32_16x16x32_bf16 v[224:227], a[148:151], a[28:31], v[224:227]
v_mfma_f32_16x16x32_bf16 v[200:203], a[148:151], a[24:27], v[200:203]
buffer_load_dwordx4 a[12:15], v2, s[40:43], s35 offen offset:3072 sc1
s_add_u32 s35, s35, 4096
v_mfma_f32_16x16x32_bf16 v[176:179], a[148:151], a[20:23], v[176:179]
v_mfma_f32_16x16x32_bf16 v[152:155], a[148:151], a[16:19], v[152:155]
v_mfma_f32_16x16x32_bf16 a[84:87], a[152:155], a[68:71], a[84:87]
s_waitcnt vmcnt(12) lgkmcnt(0)
v_mfma_f32_16x16x32_bf16 v[132:135], a[96:99], a[32:35], v[132:135]
ds_read_b128 a[128:131], v5 offset:18432
v_mfma_f32_16x16x32_bf16 v[156:159], a[96:99], a[36:39], v[156:159]
buffer_load_dwordx4 a[16:19], v2, s[40:43], s35 offen offset:0 sc1
v_mfma_f32_16x16x32_bf16 v[180:183], a[96:99], a[40:43], v[180:183]
ds_read_b128 a[132:135], v5 offset:19456
v_mfma_f32_16x16x32_bf16 v[204:207], a[96:99], a[44:47], v[204:207]
v_mfma_f32_16x16x32_bf16 v[208:211], a[100:103], a[44:47], v[208:211]
ds_read_b128 a[136:139], v5 offset:20480
v_mfma_f32_16x16x32_bf16 v[184:187], a[100:103], a[40:43], v[184:187]
buffer_load_dwordx4 v1, s[4:7], s44 offen offset:2048 sc1 lds
s_add_u32 s44, s28, 12
v_mfma_f32_16x16x32_bf16 v[160:163], a[100:103], a[36:39], v[160:163]
s_mul_i32 s45, s44, 3072
s_add_u32 m0, s45, 0
s_lshr_b32 s44, s44, 1
v_mfma_f32_16x16x32_bf16 v[136:139], a[100:103], a[32:35], v[136:139]
s_add_u32 s44, s44, 24
s_mul_i32 s44, s44, 6144
s_add_u32 s44, s44, s50
v_mfma_f32_16x16x32_bf16 v[140:143], a[104:107], a[32:35], v[140:143]
ds_read_b128 a[140:143], v5 offset:21504
v_mfma_f32_16x16x32_bf16 v[164:167], a[104:107], a[36:39], v[164:167]
buffer_load_dwordx4 a[20:23], v2, s[40:43], s35 offen offset:1024 sc1
v_mfma_f32_16x16x32_bf16 v[188:191], a[104:107], a[40:43], v[188:191]
ds_read_b128 a[144:147], v5 offset:22528
v_mfma_f32_16x16x32_bf16 v[212:215], a[104:107], a[44:47], v[212:215]
ds_read_b128 a[148:151], v5 offset:23552
v_mfma_f32_16x16x32_bf16 v[216:219], a[108:111], a[44:47], v[216:219]
v_mfma_f32_16x16x32_bf16 v[192:195], a[108:111], a[40:43], v[192:195]
buffer_load_dwordx4 a[24:27], v2, s[40:43], s35 offen offset:2048 sc1
v_mfma_f32_16x16x32_bf16 v[168:171], a[108:111], a[36:39], v[168:171]
ds_read_b128 a[152:155], v6 offset:5120
v_mfma_f32_16x16x32_bf16 v[144:147], a[108:111], a[32:35], v[144:147]
v_mfma_f32_16x16x32_bf16 v[148:151], a[112:115], a[32:35], v[148:151]
v_mfma_f32_16x16x32_bf16 v[172:175], a[112:115], a[36:39], v[172:175]
buffer_load_dwordx4 v1, s[4:7], s44 offen offset:0 sc1 lds
v_mfma_f32_16x16x32_bf16 v[196:199], a[112:115], a[40:43], v[196:199]
v_mfma_f32_16x16x32_bf16 v[220:223], a[112:115], a[44:47], v[220:223]
v_mfma_f32_16x16x32_bf16 v[224:227], a[116:119], a[44:47], v[224:227]
v_mfma_f32_16x16x32_bf16 v[200:203], a[116:119], a[40:43], v[200:203]
buffer_load_dwordx4 a[28:31], v2, s[40:43], s35 offen offset:3072 sc1
s_add_u32 s35, s35, 4096
v_mfma_f32_16x16x32_bf16 v[176:179], a[116:119], a[36:39], v[176:179]
v_mfma_f32_16x16x32_bf16 v[152:155], a[116:119], a[32:35], v[152:155]
v_mfma_f32_16x16x32_bf16 a[88:91], a[120:123], a[68:71], a[88:91]
s_waitcnt vmcnt(11) lgkmcnt(0)
v_mfma_f32_16x16x32_bf16 v[132:135], a[128:131], a[48:51], v[132:135]
ds_read_b128 a[96:99], v5 offset:24576
v_mfma_f32_16x16x32_bf16 v[156:159], a[128:131], a[52:55], v[156:159]
buffer_load_dwordx4 a[32:35], v2, s[40:43], s35 offen offset:0 sc1
v_mfma_f32_16x16x32_bf16 v[180:183], a[128:131], a[56:59], v[180:183]
ds_read_b128 a[100:103], v5 offset:25600
v_mfma_f32_16x16x32_bf16 v[204:207], a[128:131], a[60:63], v[204:207]
v_mfma_f32_16x16x32_bf16 v[208:211], a[132:135], a[60:63], v[208:211]
ds_read_b128 a[104:107], v5 offset:26624
v_mfma_f32_16x16x32_bf16 v[184:187], a[132:135], a[56:59], v[184:187]
buffer_load_dwordx4 v1, s[4:7], s44 offen offset:1024 sc1 lds
v_mfma_f32_16x16x32_bf16 v[160:163], a[132:135], a[52:55], v[160:163]
ds_read_b128 a[108:111], v5 offset:27648
v_mfma_f32_16x16x32_bf16 v[136:139], a[132:135], a[48:51], v[136:139]
v_mfma_f32_16x16x32_bf16 v[140:143], a[136:139], a[48:51], v[140:143]
v_mfma_f32_16x16x32_bf16 v[164:167], a[136:139], a[52:55], v[164:167]
buffer_load_dwordx4 a[36:39], v2, s[40:43], s35 offen offset:1024 sc1
v_mfma_f32_16x16x32_bf16 v[188:191], a[136:139], a[56:59], v[188:191]
ds_read_b128 a[112:115], v5 offset:28672
v_mfma_f32_16x16x32_bf16 v[212:215], a[136:139], a[60:63], v[212:215]
ds_read_b128 a[116:119], v5 offset:29696
v_mfma_f32_16x16x32_bf16 v[216:219], a[140:143], a[60:63], v[216:219]
v_mfma_f32_16x16x32_bf16 v[192:195], a[140:143], a[56:59], v[192:195]
buffer_load_dwordx4 a[40:43], v2, s[40:43], s35 offen offset:2048 sc1
v_mfma_f32_16x16x32_bf16 v[168:171], a[140:143], a[52:55], v[168:171]
ds_read_b128 a[120:123], v6 offset:26624
v_mfma_f32_16x16x32_bf16 v[144:147], a[140:143], a[48:51], v[144:147]
v_mfma_f32_16x16x32_bf16 v[148:151], a[144:147], a[48:51], v[148:151]
v_mfma_f32_16x16x32_bf16 v[172:175], a[144:147], a[52:55], v[172:175]
buffer_load_dwordx4 v1, s[4:7], s44 offen offset:2048 sc1 lds
s_add_i32 s44, s28, 4
v_mfma_f32_16x16x32_bf16 v[196:199], a[144:147], a[56:59], v[196:199]
s_lshl_b32 s45, s44, 12
s_add_u32 m0, s45, 32768
s_and_b32 s45, s44, 7
v_mfma_f32_16x16x32_bf16 v[220:223], a[144:147], a[60:63], v[220:223]
s_cmp_eq_u32 s45, s3
s_cselect_b32 s45, 8, 0
s_add_u32 s44, s44, s45
v_mfma_f32_16x16x32_bf16 v[224:227], a[148:151], a[60:63], v[224:227]
s_and_b32 s44, s44, 31
s_lshl_b32 s44, s44, 12
s_add_u32 s44, s44, s51
v_mfma_f32_16x16x32_bf16 v[200:203], a[148:151], a[56:59], v[200:203]
buffer_load_dwordx4 a[44:47], v2, s[40:43], s35 offen offset:3072 sc1
s_add_u32 s35, s35, 4096
v_mfma_f32_16x16x32_bf16 v[176:179], a[148:151], a[52:55], v[176:179]
v_mfma_f32_16x16x32_bf16 v[152:155], a[148:151], a[48:51], v[152:155]
v_mfma_f32_16x16x32_bf16 a[92:95], a[152:155], a[68:71], a[92:95]
s_waitcnt vmcnt(12) lgkmcnt(0)
v_mfma_f32_16x16x32_bf16 v[132:135], a[96:99], a[0:3], v[132:135]
ds_read_b128 a[128:131], v5 offset:30720
v_mfma_f32_16x16x32_bf16 v[156:159], a[96:99], a[4:7], v[156:159]
buffer_load_dwordx4 a[48:51], v2, s[40:43], s35 offen offset:0 sc1
v_mfma_f32_16x16x32_bf16 v[180:183], a[96:99], a[8:11], v[180:183]
ds_read_b128 a[132:135], v5 offset:31744
v_mfma_f32_16x16x32_bf16 v[204:207], a[96:99], a[12:15], v[204:207]
L_stub12:
s_cbranch_execz L_stub13
v_mfma_f32_16x16x32_bf16 v[208:211], a[100:103], a[12:15], v[208:211]
ds_read_b128 a[136:139], v5 offset:32768
v_mfma_f32_16x16x32_bf16 v[184:187], a[100:103], a[8:11], v[184:187]
buffer_load_dwordx4 v1, s[4:7], s44 offen offset:0 sc1 lds
s_add_u32 s63, s28, 24
v_mfma_f32_16x16x32_bf16 v[160:163], a[100:103], a[4:7], v[160:163]
s_lshl_b32 s63, s63, 12
ds_read_b128 a[140:143], v5 offset:33792
v_mfma_f32_16x16x32_bf16 v[136:139], a[100:103], a[0:3], v[136:139]
v_mfma_f32_16x16x32_bf16 v[140:143], a[104:107], a[0:3], v[140:143]
v_mfma_f32_16x16x32_bf16 v[164:167], a[104:107], a[4:7], v[164:167]
buffer_load_dwordx4 a[52:55], v2, s[40:43], s35 offen offset:1024 sc1
v_mfma_f32_16x16x32_bf16 v[188:191], a[104:107], a[8:11], v[188:191]
ds_read_b128 a[144:147], v5 offset:34816
v_mfma_f32_16x16x32_bf16 v[212:215], a[104:107], a[12:15], v[212:215]
ds_read_b128 a[148:151], v5 offset:35840
v_mfma_f32_16x16x32_bf16 v[216:219], a[108:111], a[12:15], v[216:219]
v_mfma_f32_16x16x32_bf16 v[192:195], a[108:111], a[8:11], v[192:195]
buffer_load_dwordx4 a[56:59], v2, s[40:43], s35 offen offset:2048 sc1
v_mfma_f32_16x16x32_bf16 v[168:171], a[108:111], a[4:7], v[168:171]
ds_read_b128 a[152:155], v6 offset:27648
v_mfma_f32_16x16x32_bf16 v[144:147], a[108:111], a[0:3], v[144:147]
v_mfma_f32_16x16x32_bf16 v[148:151], a[112:115], a[0:3], v[148:151]
v_mfma_f32_16x16x32_bf16 v[172:175], a[112:115], a[4:7], v[172:175]
buffer_load_dwordx4 a[64:67], v3, s[40:43], s63 offen sc1
v_mfma_f32_16x16x32_bf16 v[196:199], a[112:115], a[8:11], v[196:199]
v_mfma_f32_16x16x32_bf16 v[220:223], a[112:115], a[12:15], v[220:223]
v_mfma_f32_16x16x32_bf16 v[224:227], a[116:119], a[12:15], v[224:227]
v_mfma_f32_16x16x32_bf16 v[200:203], a[116:119], a[8:11], v[200:203]
buffer_load_dwordx4 a[60:63], v2, s[40:43], s35 offen offset:3072 sc1
s_add_u32 s35, s35, 4096
v_mfma_f32_16x16x32_bf16 v[176:179], a[116:119], a[4:7], v[176:179]
v_mfma_f32_16x16x32_bf16 v[152:155], a[116:119], a[0:3], v[152:155]
v_mfma_f32_16x16x32_bf16 a[80:83], a[120:123], a[72:75], a[80:83]
s_waitcnt vmcnt(12) lgkmcnt(0)
v_mfma_f32_16x16x32_bf16 v[132:135], a[128:131], a[16:19], v[132:135]
ds_read_b128 a[96:99], v5 offset:36864
v_mfma_f32_16x16x32_bf16 v[156:159], a[128:131], a[20:23], v[156:159]
buffer_load_dwordx4 a[0:3], v2, s[40:43], s35 offen offset:0 sc1
v_mfma_f32_16x16x32_bf16 v[180:183], a[128:131], a[24:27], v[180:183]
ds_read_b128 a[100:103], v5 offset:37888
v_mfma_f32_16x16x32_bf16 v[204:207], a[128:131], a[28:31], v[204:207]
v_mfma_f32_16x16x32_bf16 v[208:211], a[132:135], a[28:31], v[208:211]
buffer_load_dwordx4 v1, s[4:7], s44 offen offset:1024 sc1 lds
v_mfma_f32_16x16x32_bf16 v[184:187], a[132:135], a[24:27], v[184:187]
ds_read_b128 a[104:107], v5 offset:38912
v_mfma_f32_16x16x32_bf16 v[160:163], a[132:135], a[20:23], v[160:163]
ds_read_b128 a[108:111], v5 offset:39936
v_mfma_f32_16x16x32_bf16 v[136:139], a[132:135], a[16:19], v[136:139]
v_mfma_f32_16x16x32_bf16 v[140:143], a[136:139], a[16:19], v[140:143]
buffer_load_dwordx4 a[4:7], v2, s[40:43], s35 offen offset:1024 sc1
v_mfma_f32_16x16x32_bf16 v[164:167], a[136:139], a[20:23], v[164:167]
ds_read_b128 a[112:115], v5 offset:40960
v_mfma_f32_16x16x32_bf16 v[188:191], a[136:139], a[24:27], v[188:191]
v_mfma_f32_16x16x32_bf16 v[212:215], a[136:139], a[28:31], v[212:215]
buffer_load_dwordx4 v1, s[4:7], s44 offen offset:2048 sc1 lds
s_add_u32 s63, s28, 28
v_mfma_f32_16x16x32_bf16 v[216:219], a[140:143], a[28:31], v[216:219]
s_lshl_b32 s63, s63, 12
ds_read_b128 a[116:119], v5 offset:41984
v_mfma_f32_16x16x32_bf16 v[192:195], a[140:143], a[24:27], v[192:195]
ds_read_b128 a[120:123], v6 offset:28672
v_mfma_f32_16x16x32_bf16 v[168:171], a[140:143], a[20:23], v[168:171]
v_mfma_f32_16x16x32_bf16 v[144:147], a[140:143], a[16:19], v[144:147]
buffer_load_dwordx4 a[8:11], v2, s[40:43], s35 offen offset:2048 sc1
v_mfma_f32_16x16x32_bf16 v[148:151], a[144:147], a[16:19], v[148:151]
v_mfma_f32_16x16x32_bf16 v[172:175], a[144:147], a[20:23], v[172:175]
v_mfma_f32_16x16x32_bf16 v[196:199], a[144:147], a[24:27], v[196:199]
buffer_load_dwordx4 a[68:71], v3, s[40:43], s63 offen sc1
v_mfma_f32_16x16x32_bf16 v[220:223], a[144:147], a[28:31], v[220:223]
v_mfma_f32_16x16x32_bf16 v[224:227], a[148:151], a[28:31], v[224:227]
v_mfma_f32_16x16x32_bf16 v[200:203], a[148:151], a[24:27], v[200:203]
v_mfma_f32_16x16x32_bf16 v[176:179], a[148:151], a[20:23], v[176:179]
buffer_load_dwordx4 a[12:15], v2, s[40:43], s35 offen offset:3072 sc1
s_add_u32 s35, s35, 4096
v_mfma_f32_16x16x32_bf16 v[152:155], a[148:151], a[16:19], v[152:155]
v_mfma_f32_16x16x32_bf16 a[84:87], a[152:155], a[72:75], a[84:87]
s_waitcnt vmcnt(13) lgkmcnt(0)
v_mfma_f32_16x16x32_bf16 v[132:135], a[96:99], a[32:35], v[132:135]
ds_read_b128 a[128:131], v5 offset:43008
v_add_f32 v92, v92, v96
v_mfma_f32_16x16x32_bf16 v[156:159], a[96:99], a[36:39], v[156:159]
buffer_load_dwordx4 a[16:19], v2, s[40:43], s35 offen offset:0 sc1
v_mfma_f32_16x16x32_bf16 v[180:183], a[96:99], a[40:43], v[180:183]
ds_read_b128 a[132:135], v5 offset:44032
v_add_f32 v100, v100, v104
v_mfma_f32_16x16x32_bf16 v[204:207], a[96:99], a[44:47], v[204:207]
v_add_f32 v108, v108, v112
v_add_f32 v116, v116, v120
v_mfma_f32_16x16x32_bf16 v[208:211], a[100:103], a[44:47], v[208:211]
ds_read_b128 a[136:139], v5 offset:45056
v_add_f32 v124, v124, v128
v_mfma_f32_16x16x32_bf16 v[184:187], a[100:103], a[40:43], v[184:187]
buffer_load_dwordx4 v1, s[4:7], s44 offen offset:3072 sc1 lds
s_add_i32 s44, s28, 8
v_mfma_f32_16x16x32_bf16 v[160:163], a[100:103], a[36:39], v[160:163]
s_lshl_b32 s45, s44, 12
s_add_u32 m0, s45, 32768
s_and_b32 s45, s44, 7
v_mfma_f32_16x16x32_bf16 v[136:139], a[100:103], a[32:35], v[136:139]
s_cmp_eq_u32 s45, s3
s_cselect_b32 s45, 8, 0
s_add_u32 s44, s44, s45
v_mfma_f32_16x16x32_bf16 v[140:143], a[104:107], a[32:35], v[140:143]
s_and_b32 s44, s44, 31
s_lshl_b32 s44, s44, 12
s_add_u32 s44, s44, s51
v_mfma_f32_16x16x32_bf16 v[164:167], a[104:107], a[36:39], v[164:167]
buffer_load_dwordx4 a[20:23], v2, s[40:43], s35 offen offset:1024 sc1
v_mfma_f32_16x16x32_bf16 v[188:191], a[104:107], a[40:43], v[188:191]
ds_read_b128 a[140:143], v5 offset:46080
v_add_f32 v93, v93, v97
v_mfma_f32_16x16x32_bf16 v[212:215], a[104:107], a[44:47], v[212:215]
ds_read_b128 a[144:147], v5 offset:47104
v_add_f32 v101, v101, v105
v_mfma_f32_16x16x32_bf16 v[216:219], a[108:111], a[44:47], v[216:219]
ds_read_b128 a[148:151], v5 offset:48128
v_add_f32 v109, v109, v113
v_mfma_f32_16x16x32_bf16 v[192:195], a[108:111], a[40:43], v[192:195]
buffer_load_dwordx4 a[24:27], v2, s[40:43], s35 offen offset:2048 sc1
v_mfma_f32_16x16x32_bf16 v[168:171], a[108:111], a[36:39], v[168:171]
ds_read_b128 a[152:155], v6 offset:29696
v_add_f32 v117, v117, v121
v_mfma_f32_16x16x32_bf16 v[144:147], a[108:111], a[32:35], v[144:147]
v_add_f32 v125, v125, v129
v_add_f32 v94, v94, v98
v_mfma_f32_16x16x32_bf16 v[148:151], a[112:115], a[32:35], v[148:151]
v_add_f32 v102, v102, v106
v_add_f32 v110, v110, v114
v_mfma_f32_16x16x32_bf16 v[172:175], a[112:115], a[36:39], v[172:175]
buffer_load_dwordx4 v1, s[4:7], s44 offen offset:0 sc1 lds
v_mfma_f32_16x16x32_bf16 v[196:199], a[112:115], a[40:43], v[196:199]
v_add_f32 v118, v118, v122
v_add_f32 v126, v126, v130
v_mfma_f32_16x16x32_bf16 v[220:223], a[112:115], a[44:47], v[220:223]
v_add_f32 v95, v95, v99
v_add_f32 v103, v103, v107
v_mfma_f32_16x16x32_bf16 v[224:227], a[116:119], a[44:47], v[224:227]
v_add_f32 v111, v111, v115
v_add_f32 v119, v119, v123
v_mfma_f32_16x16x32_bf16 v[200:203], a[116:119], a[40:43], v[200:203]
buffer_load_dwordx4 a[28:31], v2, s[40:43], s35 offen offset:3072 sc1
s_add_u32 s35, s35, 4096
v_mfma_f32_16x16x32_bf16 v[176:179], a[116:119], a[36:39], v[176:179]
v_add_f32 v127, v127, v131
v_add_f32_dpp v92, v92, v92 row_ror:8 row_mask:0xf bank_mask:0xf
v_mfma_f32_16x16x32_bf16 v[152:155], a[116:119], a[32:35], v[152:155]
v_add_f32_dpp v100, v100, v100 row_ror:8 row_mask:0xf bank_mask:0xf
v_add_f32_dpp v108, v108, v108 row_ror:8 row_mask:0xf bank_mask:0xf
v_mfma_f32_16x16x32_bf16 a[88:91], a[120:123], a[72:75], a[88:91]
s_waitcnt vmcnt(13) lgkmcnt(0)
s_barrier
v_mfma_f32_16x16x32_bf16 v[132:135], a[128:131], a[48:51], v[132:135]
v_add_u32 v5, 0, v1
v_add_u32 v6, s55, v5
v_mfma_f32_16x16x32_bf16 v[156:159], a[128:131], a[52:55], v[156:159]
buffer_load_dwordx4 a[32:35], v2, s[40:43], s35 offen offset:0 sc1
v_mfma_f32_16x16x32_bf16 v[180:183], a[128:131], a[56:59], v[180:183]
ds_read_b128 a[96:99], v5 offset:0
v_add_f32_dpp v116, v116, v116 row_ror:8 row_mask:0xf bank_mask:0xf
v_mfma_f32_16x16x32_bf16 v[204:207], a[128:131], a[60:63], v[204:207]
ds_read_b128 a[100:103], v5 offset:1024
v_add_f32_dpp v124, v124, v124 row_ror:8 row_mask:0xf bank_mask:0xf
v_mfma_f32_16x16x32_bf16 v[208:211], a[132:135], a[60:63], v[208:211]
ds_read_b128 a[104:107], v5 offset:2048
v_add_f32_dpp v93, v93, v93 row_ror:8 row_mask:0xf bank_mask:0xf
v_mfma_f32_16x16x32_bf16 v[184:187], a[132:135], a[56:59], v[184:187]
v_add_f32_dpp v101, v101, v101 row_ror:8 row_mask:0xf bank_mask:0xf
v_add_f32_dpp v109, v109, v109 row_ror:8 row_mask:0xf bank_mask:0xf
v_mfma_f32_16x16x32_bf16 v[160:163], a[132:135], a[52:55], v[160:163]
buffer_load_dwordx4 a[36:39], v2, s[40:43], s35 offen offset:1024 sc1
v_mfma_f32_16x16x32_bf16 v[136:139], a[132:135], a[48:51], v[136:139]
ds_read_b128 a[108:111], v5 offset:3072
v_add_f32_dpp v117, v117, v117 row_ror:8 row_mask:0xf bank_mask:0xf
v_mfma_f32_16x16x32_bf16 v[140:143], a[136:139], a[48:51], v[140:143]
ds_read_b128 a[112:115], v5 offset:4096
v_add_f32_dpp v125, v125, v125 row_ror:8 row_mask:0xf bank_mask:0xf
v_mfma_f32_16x16x32_bf16 v[164:167], a[136:139], a[52:55], v[164:167]
v_add_f32_dpp v92, v94, v94 row_ror:8 row_mask:0xf bank_mask:0xc
v_add_f32_dpp v100, v102, v102 row_ror:8 row_mask:0xf bank_mask:0xc
v_mfma_f32_16x16x32_bf16 v[188:191], a[136:139], a[56:59], v[188:191]
ds_read_b128 a[116:119], v5 offset:5120
v_add_f32_dpp v108, v110, v110 row_ror:8 row_mask:0xf bank_mask:0xc
v_mfma_f32_16x16x32_bf16 v[212:215], a[136:139], a[60:63], v[212:215]
buffer_load_dwordx4 v1, s[4:7], s44 offen offset:1024 sc1 lds
v_mfma_f32_16x16x32_bf16 v[216:219], a[140:143], a[60:63], v[216:219]
ds_read_b128 a[120:123], v6 offset:2048
v_add_f32_dpp v116, v118, v118 row_ror:8 row_mask:0xf bank_mask:0xc
v_mfma_f32_16x16x32_bf16 v[192:195], a[140:143], a[56:59], v[192:195]
v_add_f32_dpp v124, v126, v126 row_ror:8 row_mask:0xf bank_mask:0xc
v_add_f32_dpp v93, v95, v95 row_ror:8 row_mask:0xf bank_mask:0xc
v_mfma_f32_16x16x32_bf16 v[168:171], a[140:143], a[52:55], v[168:171]
ds_read_b128 a[124:127], v6 offset:26624
v_add_f32_dpp v101, v103, v103 row_ror:8 row_mask:0xf bank_mask:0xc
v_mfma_f32_16x16x32_bf16 v[144:147], a[140:143], a[48:51], v[144:147]
v_add_f32_dpp v109, v111, v111 row_ror:8 row_mask:0xf bank_mask:0xc
v_add_f32_dpp v117, v119, v119 row_ror:8 row_mask:0xf bank_mask:0xc
v_mfma_f32_16x16x32_bf16 v[148:151], a[144:147], a[48:51], v[148:151]
buffer_load_dwordx4 a[40:43], v2, s[40:43], s35 offen offset:2048 sc1
v_mfma_f32_16x16x32_bf16 v[172:175], a[144:147], a[52:55], v[172:175]
v_add_f32_dpp v125, v127, v127 row_ror:8 row_mask:0xf bank_mask:0xc
v_mfma_f32_16x16x32_bf16 v[196:199], a[144:147], a[56:59], v[196:199]
v_permlane32_swap_b32 v92, v93
v_mfma_f32_16x16x32_bf16 v[220:223], a[144:147], a[60:63], v[220:223]
v_permlane32_swap_b32 v100, v101
v_mfma_f32_16x16x32_bf16 v[224:227], a[148:151], a[60:63], v[224:227]
v_permlane32_swap_b32 v108, v109
v_mfma_f32_16x16x32_bf16 v[200:203], a[148:151], a[56:59], v[200:203]
buffer_load_dwordx4 a[44:47], v2, s[40:43], s35 offen offset:3072 sc1
s_add_u32 s35, s35, 4096
v_mfma_f32_16x16x32_bf16 v[176:179], a[148:151], a[52:55], v[176:179]
v_permlane32_swap_b32 v116, v117
v_mfma_f32_16x16x32_bf16 v[152:155], a[148:151], a[48:51], v[152:155]
v_permlane32_swap_b32 v124, v125
v_mfma_f32_16x16x32_bf16 a[92:95], a[152:155], a[72:75], a[92:95]
v_add_f32 v92, v92, v93
s_waitcnt vmcnt(11) lgkmcnt(0)
v_mfma_f32_16x16x32_bf16 v[132:135], a[96:99], a[0:3], v[132:135]
ds_read_b128 a[128:131], v5 offset:6144
v_add_f32 v100, v100, v101
v_mfma_f32_16x16x32_bf16 v[156:159], a[96:99], a[4:7], v[156:159]
buffer_load_dwordx4 a[48:51], v2, s[40:43], s35 offen offset:0 sc1
v_mfma_f32_16x16x32_bf16 v[180:183], a[96:99], a[8:11], v[180:183]
ds_read_b128 a[132:135], v5 offset:7168
v_add_f32 v108, v108, v109
v_mfma_f32_16x16x32_bf16 v[204:207], a[96:99], a[12:15], v[204:207]
v_add_f32 v116, v116, v117
v_add_f32 v124, v124, v125
v_mfma_f32_16x16x32_bf16 v[208:211], a[100:103], a[12:15], v[208:211]
ds_read_b128 a[136:139], v5 offset:8192
v_mov_b32 v94, v92
v_mfma_f32_16x16x32_bf16 v[184:187], a[100:103], a[8:11], v[184:187]
buffer_load_dwordx4 v1, s[4:7], s44 offen offset:2048 sc1 lds
v_mfma_f32_16x16x32_bf16 v[160:163], a[100:103], a[4:7], v[160:163]
ds_read_b128 a[140:143], v5 offset:9216
v_mov_b32 v102, v100
v_mfma_f32_16x16x32_bf16 v[136:139], a[100:103], a[0:3], v[136:139]
v_mov_b32 v110, v108
v_mov_b32 v118, v116
v_mfma_f32_16x16x32_bf16 v[140:143], a[104:107], a[0:3], v[140:143]
ds_read_b128 a[144:147], v5 offset:10240
v_mov_b32 v126, v124
v_mfma_f32_16x16x32_bf16 v[164:167], a[104:107], a[4:7], v[164:167]
buffer_load_dwordx4 a[52:55], v2, s[40:43], s35 offen offset:1024 sc1
v_mfma_f32_16x16x32_bf16 v[188:191], a[104:107], a[8:11], v[188:191]
ds_read_b128 a[148:151], v5 offset:11264
v_mfma_f32_16x16x32_bf16 v[212:215], a[104:107], a[12:15], v[212:215]
v_permlane16_swap_b32 v92, v94
v_mfma_f32_16x16x32_bf16 v[216:219], a[108:111], a[12:15], v[216:219]
ds_read_b128 a[152:155], v6 offset:3072
v_mfma_f32_16x16x32_bf16 v[192:195], a[108:111], a[8:11], v[192:195]
v_permlane16_swap_b32 v100, v102
v_mfma_f32_16x16x32_bf16 v[168:171], a[108:111], a[4:7], v[168:171]
buffer_load_dwordx4 a[56:59], v2, s[40:43], s35 offen offset:2048 sc1
v_mfma_f32_16x16x32_bf16 v[144:147], a[108:111], a[0:3], v[144:147]
ds_read_b128 a[156:159], v6 offset:27648
v_mfma_f32_16x16x32_bf16 v[148:151], a[112:115], a[0:3], v[148:151]
v_permlane16_swap_b32 v108, v110
v_mfma_f32_16x16x32_bf16 v[172:175], a[112:115], a[4:7], v[172:175]
v_permlane16_swap_b32 v116, v118
v_mfma_f32_16x16x32_bf16 v[196:199], a[112:115], a[8:11], v[196:199]
buffer_load_dwordx4 v1, s[4:7], s44 offen offset:3072 sc1 lds
s_add_i32 s44, s28, 12
v_mfma_f32_16x16x32_bf16 v[220:223], a[112:115], a[12:15], v[220:223]
s_lshl_b32 s45, s44, 12
s_add_u32 m0, s45, 32768
s_and_b32 s45, s44, 7
v_mfma_f32_16x16x32_bf16 v[224:227], a[116:119], a[12:15], v[224:227]
s_cmp_eq_u32 s45, s3
s_cselect_b32 s45, 8, 0
s_add_u32 s44, s44, s45
v_mfma_f32_16x16x32_bf16 v[200:203], a[116:119], a[8:11], v[200:203]
s_and_b32 s44, s44, 31
s_lshl_b32 s44, s44, 12
s_add_u32 s44, s44, s51
v_mfma_f32_16x16x32_bf16 v[176:179], a[116:119], a[4:7], v[176:179]
buffer_load_dwordx4 a[60:63], v2, s[40:43], s35 offen offset:3072 sc1
s_add_u32 s35, s35, 4096
v_mfma_f32_16x16x32_bf16 v[152:155], a[116:119], a[0:3], v[152:155]
v_permlane16_swap_b32 v124, v126
v_mfma_f32_16x16x32_bf16 a[80:83], a[120:123], a[64:67], a[80:83]
v_add_f32 v92, v92, v94
v_add_f32 v100, v100, v102
v_mfma_f32_16x16x32_bf16 a[80:83], a[124:127], a[68:71], a[80:83]
v_add_f32 v108, v108, v110
s_waitcnt vmcnt(11) lgkmcnt(0)
v_mfma_f32_16x16x32_bf16 v[132:135], a[128:131], a[16:19], v[132:135]
ds_read_b128 a[96:99], v5 offset:12288
v_add_f32 v116, v116, v118
v_mfma_f32_16x16x32_bf16 v[156:159], a[128:131], a[20:23], v[156:159]
buffer_load_dwordx4 a[0:3], v2, s[40:43], s35 offen offset:0 sc1
v_mfma_f32_16x16x32_bf16 v[180:183], a[128:131], a[24:27], v[180:183]
ds_read_b128 a[100:103], v5 offset:13312
v_add_f32 v124, v124, v126
v_mfma_f32_16x16x32_bf16 v[204:207], a[128:131], a[28:31], v[204:207]
v_mov_b32 v94, v92
v_mov_b32 v102, v100
v_mfma_f32_16x16x32_bf16 v[208:211], a[132:135], a[28:31], v[208:211]
ds_read_b128 a[104:107], v5 offset:14336
v_mov_b32 v110, v108
v_mfma_f32_16x16x32_bf16 v[184:187], a[132:135], a[24:27], v[184:187]
buffer_load_dwordx4 v1, s[4:7], s44 offen offset:0 sc1 lds
v_mfma_f32_16x16x32_bf16 v[160:163], a[132:135], a[20:23], v[160:163]
ds_read_b128 a[108:111], v5 offset:15360
v_mov_b32 v118, v116
v_mfma_f32_16x16x32_bf16 v[136:139], a[132:135], a[16:19], v[136:139]
v_mov_b32 v126, v124
v_mfma_f32_16x16x32_bf16 v[140:143], a[136:139], a[16:19], v[140:143]
ds_read_b128 a[112:115], v5 offset:16384
v_mfma_f32_16x16x32_bf16 v[164:167], a[136:139], a[20:23], v[164:167]
buffer_load_dwordx4 a[4:7], v2, s[40:43], s35 offen offset:1024 sc1
v_mfma_f32_16x16x32_bf16 v[188:191], a[136:139], a[24:27], v[188:191]
ds_read_b128 a[116:119], v5 offset:17408
v_mfma_f32_16x16x32_bf16 v[212:215], a[136:139], a[28:31], v[212:215]
v_permlane32_swap_b32 v92, v94
v_mfma_f32_16x16x32_bf16 v[216:219], a[140:143], a[28:31], v[216:219]
ds_read_b128 a[120:123], v6 offset:4096
v_mfma_f32_16x16x32_bf16 v[192:195], a[140:143], a[24:27], v[192:195]
v_permlane32_swap_b32 v100, v102
v_mfma_f32_16x16x32_bf16 v[168:171], a[140:143], a[20:23], v[168:171]
buffer_load_dwordx4 a[8:11], v2, s[40:43], s35 offen offset:2048 sc1
v_mfma_f32_16x16x32_bf16 v[144:147], a[140:143], a[16:19], v[144:147]
ds_read_b128 a[124:127], v6 offset:28672
v_mfma_f32_16x16x32_bf16 v[148:151], a[144:147], a[16:19], v[148:151]
v_permlane32_swap_b32 v108, v110
v_mfma_f32_16x16x32_bf16 v[172:175], a[144:147], a[20:23], v[172:175]
v_permlane32_swap_b32 v116, v118
v_mfma_f32_16x16x32_bf16 v[196:199], a[144:147], a[24:27], v[196:199]
buffer_load_dwordx4 v1, s[4:7], s44 offen offset:1024 sc1 lds
v_mfma_f32_16x16x32_bf16 v[220:223], a[144:147], a[28:31], v[220:223]
v_permlane32_swap_b32 v124, v126
v_mfma_f32_16x16x32_bf16 v[224:227], a[148:151], a[28:31], v[224:227]
v_mul_f32 v82, 0xba800000, v92
v_mul_f32 v84, 0xba800000, v100
v_mfma_f32_16x16x32_bf16 v[200:203], a[148:151], a[24:27], v[200:203]
v_mul_f32 v86, 0xba800000, v108
v_mul_f32 v88, 0xba800000, v116
v_mfma_f32_16x16x32_bf16 v[176:179], a[148:151], a[20:23], v[176:179]
buffer_load_dwordx4 a[12:15], v2, s[40:43], s35 offen offset:3072 sc1
s_add_u32 s35, s35, 4096
v_mfma_f32_16x16x32_bf16 v[152:155], a[148:151], a[16:19], v[152:155]
v_mul_f32 v90, 0xba800000, v124
v_mul_f32 v94, 0x3a800000, v94
v_mfma_f32_16x16x32_bf16 a[84:87], a[152:155], a[64:67], a[84:87]
v_mul_f32 v102, 0x3a800000, v102
v_mul_f32 v110, 0x3a800000, v110
v_mfma_f32_16x16x32_bf16 a[84:87], a[156:159], a[68:71], a[84:87]
v_mul_f32 v118, 0x3a800000, v118
s_waitcnt vmcnt(12) lgkmcnt(0)
v_mfma_f32_16x16x32_bf16 v[132:135], a[96:99], a[32:35], v[132:135]
ds_read_b128 a[128:131], v5 offset:18432
v_mul_f32 v126, 0x3a800000, v126
v_mfma_f32_16x16x32_bf16 v[156:159], a[96:99], a[36:39], v[156:159]
buffer_load_dwordx4 a[16:19], v2, s[40:43], s35 offen offset:0 sc1
v_mfma_f32_16x16x32_bf16 v[180:183], a[96:99], a[40:43], v[180:183]
ds_read_b128 a[132:135], v5 offset:19456
v_fma_f32 v94, -v82, v82, v94
v_mfma_f32_16x16x32_bf16 v[204:207], a[96:99], a[44:47], v[204:207]
v_fma_f32 v102, -v84, v84, v102
v_fma_f32 v110, -v86, v86, v110
v_mfma_f32_16x16x32_bf16 v[208:211], a[100:103], a[44:47], v[208:211]
ds_read_b128 a[136:139], v5 offset:20480
v_fma_f32 v118, -v88, v88, v118
v_mfma_f32_16x16x32_bf16 v[184:187], a[100:103], a[40:43], v[184:187]
v_fma_f32 v126, -v90, v90, v126
v_max_f32 v94, 0, v94
v_mfma_f32_16x16x32_bf16 v[160:163], a[100:103], a[36:39], v[160:163]
buffer_load_dwordx4 a[20:23], v2, s[40:43], s35 offen offset:1024 sc1
v_mfma_f32_16x16x32_bf16 v[136:139], a[100:103], a[32:35], v[136:139]
ds_read_b128 a[140:143], v5 offset:21504
v_max_f32 v102, 0, v102
v_max_f32 v110, 0, v110
v_max_f32 v118, 0, v118
v_max_f32 v126, 0, v126
v_add_f32 v94, 0x3727c5ac, v94
v_add_f32 v102, 0x3727c5ac, v102
v_add_f32 v110, 0x3727c5ac, v110
v_add_f32 v118, 0x3727c5ac, v118
v_add_f32 v126, 0x3727c5ac, v126
v_rsq_f32 v83, v94
v_rsq_f32 v85, v102
v_rsq_f32 v87, v110
v_rsq_f32 v89, v118
v_rsq_f32 v91, v126
v_mfma_f32_16x16x32_bf16 v[140:143], a[104:107], a[32:35], v[140:143]
ds_read_b128 a[144:147], v5 offset:22528
v_mfma_f32_16x16x32_bf16 v[164:167], a[104:107], a[36:39], v[164:167]
v_fmac_f32 v132, v48, v82
v_mfma_f32_16x16x32_bf16 v[188:191], a[104:107], a[40:43], v[188:191]
ds_read_b128 a[148:151], v5 offset:23552
v_fmac_f32 v156, v48, v84
v_mfma_f32_16x16x32_bf16 v[212:215], a[104:107], a[44:47], v[212:215]
buffer_load_dwordx4 v1, s[4:7], s44 offen offset:2048 sc1 lds
v_mfma_f32_16x16x32_bf16 v[216:219], a[108:111], a[44:47], v[216:219]
ds_read_b128 a[152:155], v6 offset:5120
v_fmac_f32 v180, v48, v86
v_mfma_f32_16x16x32_bf16 v[192:195], a[108:111], a[40:43], v[192:195]
v_fmac_f32 v204, v48, v88
v_fmac_f32 v208, v52, v88
v_mfma_f32_16x16x32_bf16 v[168:171], a[108:111], a[36:39], v[168:171]
ds_read_b128 a[156:159], v6 offset:29696
v_fmac_f32 v184, v52, v86
v_mfma_f32_16x16x32_bf16 v[144:147], a[108:111], a[32:35], v[144:147]
v_fmac_f32 v160, v52, v84
v_mfma_f32_16x16x32_bf16 v[148:151], a[112:115], a[32:35], v[148:151]
buffer_load_dwordx4 a[24:27], v2, s[40:43], s35 offen offset:2048 sc1
v_mfma_f32_16x16x32_bf16 v[172:175], a[112:115], a[36:39], v[172:175]
v_fmac_f32 v136, v52, v82
v_fmac_f32 v140, v56, v82
v_mfma_f32_16x16x32_bf16 v[196:199], a[112:115], a[40:43], v[196:199]
v_fmac_f32 v164, v56, v84
v_mfma_f32_16x16x32_bf16 v[220:223], a[112:115], a[44:47], v[220:223]
v_fmac_f32 v188, v56, v86
v_mfma_f32_16x16x32_bf16 v[224:227], a[116:119], a[44:47], v[224:227]
v_fmac_f32 v212, v56, v88
v_mfma_f32_16x16x32_bf16 v[200:203], a[116:119], a[40:43], v[200:203]
buffer_load_dwordx4 a[28:31], v2, s[40:43], s35 offen offset:3072 sc1
s_add_u32 s35, s35, 4096
v_mfma_f32_16x16x32_bf16 v[176:179], a[116:119], a[36:39], v[176:179]
v_fmac_f32 v216, v60, v88
v_fmac_f32 v192, v60, v86
v_mfma_f32_16x16x32_bf16 v[152:155], a[116:119], a[32:35], v[152:155]
v_fmac_f32 v168, v60, v84
v_mfma_f32_16x16x32_bf16 a[88:91], a[120:123], a[64:67], a[88:91]
v_fmac_f32 v144, v60, v82
v_mfma_f32_16x16x32_bf16 a[88:91], a[124:127], a[68:71], a[88:91]
v_fmac_f32 v148, v64, v82
s_waitcnt vmcnt(11) lgkmcnt(0)
v_mfma_f32_16x16x32_bf16 v[132:135], a[128:131], a[48:51], v[132:135]
ds_read_b128 a[96:99], v5 offset:24576
v_fmac_f32 v172, v64, v84
v_mfma_f32_16x16x32_bf16 v[156:159], a[128:131], a[52:55], v[156:159]
buffer_load_dwordx4 a[32:35], v2, s[40:43], s35 offen offset:0 sc1
s_lshl_b32 s90, s28, 12
v_mfma_f32_16x16x32_bf16 v[180:183], a[128:131], a[56:59], v[180:183]
ds_read_b128 a[100:103], v5 offset:25600
v_fmac_f32 v196, v64, v86
v_mfma_f32_16x16x32_bf16 v[204:207], a[128:131], a[60:63], v[204:207]
v_fmac_f32 v220, v64, v88
v_fmac_f32 v224, v68, v88
v_mfma_f32_16x16x32_bf16 v[208:211], a[132:135], a[60:63], v[208:211]
v_fmac_f32 v200, v68, v86
s_add_u32 s90, s90, 147456
v_mfma_f32_16x16x32_bf16 v[184:187], a[132:135], a[56:59], v[184:187]
buffer_load_dwordx4 v1, s[4:7], s44 offen offset:3072 sc1 lds
s_add_i32 s44, s28, 16
v_mfma_f32_16x16x32_bf16 v[160:163], a[132:135], a[52:55], v[160:163]
s_lshl_b32 s45, s44, 12
s_add_u32 m0, s45, 32768
s_and_b32 s45, s44, 7
v_mfma_f32_16x16x32_bf16 v[136:139], a[132:135], a[48:51], v[136:139]
s_cmp_eq_u32 s45, s3
s_cselect_b32 s45, 8, 0
s_add_u32 s44, s44, s45
v_mfma_f32_16x16x32_bf16 v[140:143], a[136:139], a[48:51], v[140:143]
s_and_b32 s44, s44, 31
s_lshl_b32 s44, s44, 12
s_add_u32 s44, s44, s51
v_mfma_f32_16x16x32_bf16 v[164:167], a[136:139], a[52:55], v[164:167]
buffer_load_dwordx4 a[36:39], v2, s[40:43], s35 offen offset:1024 sc1
v_mfma_f32_16x16x32_bf16 v[188:191], a[136:139], a[56:59], v[188:191]
ds_read_b128 a[104:107], v5 offset:26624
v_fmac_f32 v176, v68, v84
v_mfma_f32_16x16x32_bf16 v[212:215], a[136:139], a[60:63], v[212:215]
ds_read_b128 a[108:111], v5 offset:27648
v_fmac_f32 v152, v68, v82
v_mfma_f32_16x16x32_bf16 v[216:219], a[140:143], a[60:63], v[216:219]
ds_read_b128 a[112:115], v5 offset:28672
v_fmac_f32 v133, v49, v82
v_mfma_f32_16x16x32_bf16 v[192:195], a[140:143], a[56:59], v[192:195]
ds_read_b128 a[116:119], v5 offset:29696
v_fmac_f32 v157, v49, v84
v_mfma_f32_16x16x32_bf16 v[168:171], a[140:143], a[52:55], v[168:171]
buffer_load_dwordx4 a[40:43], v2, s[40:43], s35 offen offset:2048 sc1
v_mfma_f32_16x16x32_bf16 v[144:147], a[140:143], a[48:51], v[144:147]
v_fmac_f32 v181, v49, v86
v_fmac_f32 v205, v49, v88
v_mfma_f32_16x16x32_bf16 v[148:151], a[144:147], a[48:51], v[148:151]
v_fmac_f32 v209, v53, v88
v_fmac_f32 v185, v53, v86
v_mfma_f32_16x16x32_bf16 v[172:175], a[144:147], a[52:55], v[172:175]
v_fmac_f32 v161, v53, v84
v_fmac_f32 v137, v53, v82
v_mfma_f32_16x16x32_bf16 v[196:199], a[144:147], a[56:59], v[196:199]
buffer_load_dwordx4 v1, s[4:7], s44 offen offset:0 sc1 lds
v_mfma_f32_16x16x32_bf16 v[220:223], a[144:147], a[60:63], v[220:223]
v_fmac_f32 v141, v57, v82
v_fmac_f32 v165, v57, v84
v_mfma_f32_16x16x32_bf16 v[224:227], a[148:151], a[60:63], v[224:227]
v_fmac_f32 v189, v57, v86
v_fmac_f32 v213, v57, v88
v_mfma_f32_16x16x32_bf16 v[200:203], a[148:151], a[56:59], v[200:203]
v_fmac_f32 v217, v61, v88
v_add_u32 v234, s90, v1
v_mfma_f32_16x16x32_bf16 v[176:179], a[148:151], a[52:55], v[176:179]
buffer_load_dwordx4 a[44:47], v2, s[40:43], s35 offen offset:3072 sc1
s_add_u32 s35, s35, 4096
v_mfma_f32_16x16x32_bf16 v[152:155], a[148:151], a[48:51], v[152:155]
v_fmac_f32 v193, v61, v86
v_fmac_f32 v169, v61, v84
v_mfma_f32_16x16x32_bf16 a[92:95], a[152:155], a[64:67], a[92:95]
v_fmac_f32 v145, v61, v82
s_lshl_b32 s90, s28, 10
v_mfma_f32_16x16x32_bf16 a[92:95], a[156:159], a[68:71], a[92:95]
v_fmac_f32 v149, v65, v82
s_add_u32 s90, s90, 147456
v_add_u32 v235, s90, v1
s_waitcnt vmcnt(11) lgkmcnt(0)
v_mfma_f32_16x16x32_bf16 v[132:135], a[96:99], a[0:3], v[132:135]
ds_read_b128 a[128:131], v5 offset:30720
v_fmac_f32 v173, v65, v84
v_mfma_f32_16x16x32_bf16 v[156:159], a[96:99], a[4:7], v[156:159]
buffer_load_dwordx4 a[48:51], v2, s[40:43], s35 offen offset:0 sc1
v_mfma_f32_16x16x32_bf16 v[180:183], a[96:99], a[8:11], v[180:183]
ds_read_b128 a[132:135], v5 offset:31744
v_fmac_f32 v197, v65, v86
v_mfma_f32_16x16x32_bf16 v[204:207], a[96:99], a[12:15], v[204:207]
v_fmac_f32 v221, v65, v88
v_fmac_f32 v225, v69, v88
v_mfma_f32_16x16x32_bf16 v[208:211], a[100:103], a[12:15], v[208:211]
v_fmac_f32 v201, v69, v86
v_mfma_f32_16x16x32_bf16 v[184:187], a[100:103], a[8:11], v[184:187]
buffer_load_dwordx4 v1, s[4:7], s44 offen offset:1024 sc1 lds
v_mfma_f32_16x16x32_bf16 v[160:163], a[100:103], a[4:7], v[160:163]
ds_read_b128 a[136:139], v5 offset:32768
v_fmac_f32 v177, v69, v84
v_mfma_f32_16x16x32_bf16 v[136:139], a[100:103], a[0:3], v[136:139]
v_fmac_f32 v153, v69, v82
v_mfma_f32_16x16x32_bf16 v[140:143], a[104:107], a[0:3], v[140:143]
ds_read_b128 a[140:143], v5 offset:33792
v_mfma_f32_16x16x32_bf16 v[164:167], a[104:107], a[4:7], v[164:167]
buffer_load_dwordx4 a[52:55], v2, s[40:43], s35 offen offset:1024 sc1
v_mfma_f32_16x16x32_bf16 v[188:191], a[104:107], a[8:11], v[188:191]
ds_read_b128 a[144:147], v5 offset:34816
v_fmac_f32 v134, v50, v82
v_mfma_f32_16x16x32_bf16 v[212:215], a[104:107], a[12:15], v[212:215]
v_fmac_f32 v158, v50, v84
v_fmac_f32 v182, v50, v86
v_mfma_f32_16x16x32_bf16 v[216:219], a[108:111], a[12:15], v[216:219]
v_fmac_f32 v206, v50, v88
v_mfma_f32_16x16x32_bf16 v[192:195], a[108:111], a[8:11], v[192:195]
buffer_load_dwordx4 a[56:59], v2, s[40:43], s35 offen offset:2048 sc1
v_mfma_f32_16x16x32_bf16 v[168:171], a[108:111], a[4:7], v[168:171]
ds_read_b128 a[148:151], v5 offset:35840
v_fmac_f32 v210, v54, v88
v_mfma_f32_16x16x32_bf16 v[144:147], a[108:111], a[0:3], v[144:147]
v_fmac_f32 v186, v54, v86
v_fmac_f32 v162, v54, v84
v_mfma_f32_16x16x32_bf16 v[148:151], a[112:115], a[0:3], v[148:151]
v_fmac_f32 v138, v54, v82
v_mfma_f32_16x16x32_bf16 v[172:175], a[112:115], a[4:7], v[172:175]
buffer_load_dwordx4 v1, s[4:7], s44 offen offset:2048 sc1 lds
v_mfma_f32_16x16x32_bf16 v[196:199], a[112:115], a[8:11], v[196:199]
v_fmac_f32 v142, v58, v82
v_fmac_f32 v166, v58, v84
v_mfma_f32_16x16x32_bf16 v[220:223], a[112:115], a[12:15], v[220:223]
v_fmac_f32 v190, v58, v86
v_mfma_f32_16x16x32_bf16 v[224:227], a[116:119], a[12:15], v[224:227]
v_fmac_f32 v214, v58, v88
v_mfma_f32_16x16x32_bf16 v[200:203], a[116:119], a[8:11], v[200:203]
buffer_load_dwordx4 a[60:63], v2, s[40:43], s35 offen offset:3072 sc1
s_add_u32 s35, s35, 4096
v_mfma_f32_16x16x32_bf16 v[176:179], a[116:119], a[4:7], v[176:179]
v_fmac_f32 v218, v62, v88
v_fmac_f32 v194, v62, v86
v_mfma_f32_16x16x32_bf16 v[152:155], a[116:119], a[0:3], v[152:155]
v_fmac_f32 v170, v62, v84
s_waitcnt vmcnt(12) lgkmcnt(0)
v_mfma_f32_16x16x32_bf16 v[132:135], a[128:131], a[16:19], v[132:135]
ds_read_b128 a[96:99], v5 offset:36864
v_fmac_f32 v146, v62, v82
v_mfma_f32_16x16x32_bf16 v[156:159], a[128:131], a[20:23], v[156:159]
buffer_load_dwordx4 v1, s[4:7], s44 offen offset:3072 sc1 lds
s_add_i32 s44, s28, 20
v_mfma_f32_16x16x32_bf16 v[180:183], a[128:131], a[24:27], v[180:183]
s_lshl_b32 s45, s44, 12
s_add_u32 m0, s45, 32768
s_and_b32 s45, s44, 7
v_mfma_f32_16x16x32_bf16 v[204:207], a[128:131], a[28:31], v[204:207]
s_cmp_eq_u32 s45, s3
s_cselect_b32 s45, 8, 0
s_add_u32 s44, s44, s45
v_mfma_f32_16x16x32_bf16 v[208:211], a[132:135], a[28:31], v[208:211]
s_and_b32 s44, s44, 31
s_lshl_b32 s44, s44, 12
s_add_u32 s44, s44, s51
v_mfma_f32_16x16x32_bf16 v[184:187], a[132:135], a[24:27], v[184:187]
buffer_load_dwordx4 v1, s[4:7], s44 offen offset:0 sc1 lds
v_mfma_f32_16x16x32_bf16 v[160:163], a[132:135], a[20:23], v[160:163]
ds_read_b128 a[100:103], v5 offset:37888
v_fmac_f32 v150, v66, v82
v_mfma_f32_16x16x32_bf16 v[136:139], a[132:135], a[16:19], v[136:139]
ds_read_b128 a[104:107], v5 offset:38912
v_fmac_f32 v174, v66, v84
v_mfma_f32_16x16x32_bf16 v[140:143], a[136:139], a[16:19], v[140:143]
ds_read_b128 a[108:111], v5 offset:39936
v_fmac_f32 v198, v66, v86
v_mfma_f32_16x16x32_bf16 v[164:167], a[136:139], a[20:23], v[164:167]
v_fmac_f32 v222, v66, v88
v_fmac_f32 v226, v70, v88
v_mfma_f32_16x16x32_bf16 v[188:191], a[136:139], a[24:27], v[188:191]
buffer_load_dwordx4 v1, s[4:7], s44 offen offset:1024 sc1 lds
v_mfma_f32_16x16x32_bf16 v[212:215], a[136:139], a[28:31], v[212:215]
ds_read_b128 a[112:115], v5 offset:40960
v_fmac_f32 v202, v70, v86
v_mfma_f32_16x16x32_bf16 v[216:219], a[140:143], a[28:31], v[216:219]
v_fmac_f32 v178, v70, v84
L_stub13:
s_cbranch_execz L_wret4
v_fmac_f32 v154, v70, v82
v_mfma_f32_16x16x32_bf16 v[192:195], a[140:143], a[24:27], v[192:195]
ds_read_b128 a[116:119], v5 offset:41984
v_fmac_f32 v135, v51, v82
v_mfma_f32_16x16x32_bf16 v[168:171], a[140:143], a[20:23], v[168:171]
v_fmac_f32 v159, v51, v84
v_fmac_f32 v183, v51, v86
v_mfma_f32_16x16x32_bf16 v[144:147], a[140:143], a[16:19], v[144:147]
buffer_load_dwordx4 v1, s[4:7], s44 offen offset:2048 sc1 lds
v_mfma_f32_16x16x32_bf16 v[148:151], a[144:147], a[16:19], v[148:151]
v_fmac_f32 v207, v51, v88
v_fmac_f32 v211, v55, v88
v_mfma_f32_16x16x32_bf16 v[172:175], a[144:147], a[20:23], v[172:175]
v_fmac_f32 v187, v55, v86
v_fmac_f32 v163, v55, v84
v_mfma_f32_16x16x32_bf16 v[196:199], a[144:147], a[24:27], v[196:199]
v_fmac_f32 v139, v55, v82
v_fmac_f32 v143, v59, v82
v_mfma_f32_16x16x32_bf16 v[220:223], a[144:147], a[28:31], v[220:223]
v_fmac_f32 v167, v59, v84
v_fmac_f32 v191, v59, v86
v_mfma_f32_16x16x32_bf16 v[224:227], a[148:151], a[28:31], v[224:227]
buffer_load_dwordx4 v1, s[4:7], s44 offen offset:3072 sc1 lds
s_add_i32 s44, s28, 24
v_mfma_f32_16x16x32_bf16 v[200:203], a[148:151], a[24:27], v[200:203]
s_lshl_b32 s45, s44, 12
s_add_u32 m0, s45, 32768
s_and_b32 s45, s44, 7
v_mfma_f32_16x16x32_bf16 v[176:179], a[148:151], a[20:23], v[176:179]
s_cmp_eq_u32 s45, s3
s_cselect_b32 s45, 8, 0
s_add_u32 s44, s44, s45
v_mfma_f32_16x16x32_bf16 v[152:155], a[148:151], a[16:19], v[152:155]
s_and_b32 s44, s44, 31
s_waitcnt vmcnt(11) lgkmcnt(0)
v_mfma_f32_16x16x32_bf16 v[132:135], a[96:99], a[32:35], v[132:135]
s_lshl_b32 s44, s44, 12
s_add_u32 s44, s44, s51
v_mfma_f32_16x16x32_bf16 v[156:159], a[96:99], a[36:39], v[156:159]
buffer_load_dwordx4 v1, s[4:7], s44 offen offset:0 sc1 lds
v_mfma_f32_16x16x32_bf16 v[180:183], a[96:99], a[40:43], v[180:183]
ds_read_b128 a[128:131], v5 offset:43008
v_fmac_f32 v215, v59, v88
v_mfma_f32_16x16x32_bf16 v[204:207], a[96:99], a[44:47], v[204:207]
ds_read_b128 a[132:135], v5 offset:44032
v_fmac_f32 v219, v63, v88
v_mfma_f32_16x16x32_bf16 v[208:211], a[100:103], a[44:47], v[208:211]
v_fmac_f32 v195, v63, v86
v_fmac_f32 v171, v63, v84
v_mfma_f32_16x16x32_bf16 v[184:187], a[100:103], a[40:43], v[184:187]
ds_read_b128 a[136:139], v5 offset:45056
v_fmac_f32 v147, v63, v82
v_mfma_f32_16x16x32_bf16 v[160:163], a[100:103], a[36:39], v[160:163]
v_fmac_f32 v151, v67, v82
v_fmac_f32 v175, v67, v84
v_mfma_f32_16x16x32_bf16 v[136:139], a[100:103], a[32:35], v[136:139]
buffer_load_dwordx4 v1, s[4:7], s44 offen offset:1024 sc1 lds
v_mfma_f32_16x16x32_bf16 v[140:143], a[104:107], a[32:35], v[140:143]
ds_read_b128 a[140:143], v5 offset:46080
v_fmac_f32 v199, v67, v86
v_mfma_f32_16x16x32_bf16 v[164:167], a[104:107], a[36:39], v[164:167]
v_fmac_f32 v223, v67, v88
v_fmac_f32 v227, v71, v88
v_mfma_f32_16x16x32_bf16 v[188:191], a[104:107], a[40:43], v[188:191]
ds_read_b128 a[144:147], v5 offset:47104
v_fmac_f32 v203, v71, v86
v_mfma_f32_16x16x32_bf16 v[212:215], a[104:107], a[44:47], v[212:215]
v_fmac_f32 v179, v71, v84
v_fmac_f32 v155, v71, v82
v_mfma_f32_16x16x32_bf16 v[216:219], a[108:111], a[44:47], v[216:219]
ds_write_b128 v234, a[80:83] offset:0
v_mfma_f32_16x16x32_bf16 v[192:195], a[108:111], a[40:43], v[192:195]
buffer_load_dwordx4 v1, s[4:7], s44 offen offset:2048 sc1 lds
v_mfma_f32_16x16x32_bf16 v[168:171], a[108:111], a[36:39], v[168:171]
ds_read_b128 a[148:151], v5 offset:48128
v_mfma_f32_16x16x32_bf16 v[144:147], a[108:111], a[32:35], v[144:147]
ds_write_b128 v234, a[84:87] offset:1024
v_mfma_f32_16x16x32_bf16 v[148:151], a[112:115], a[32:35], v[148:151]
ds_write_b128 v234, a[88:91] offset:2048
v_mfma_f32_16x16x32_bf16 v[172:175], a[112:115], a[36:39], v[172:175]
ds_write_b128 v234, a[92:95] offset:3072
v_mfma_f32_16x16x32_bf16 v[196:199], a[112:115], a[40:43], v[196:199]
v_mfma_f32_16x16x32_bf16 v[220:223], a[112:115], a[44:47], v[220:223]
buffer_load_dwordx4 v1, s[4:7], s44 offen offset:3072 sc1 lds
v_mfma_f32_16x16x32_bf16 v[224:227], a[116:119], a[44:47], v[224:227]
v_mfma_f32_16x16x32_bf16 v[200:203], a[116:119], a[40:43], v[200:203]
v_mfma_f32_16x16x32_bf16 v[176:179], a[116:119], a[36:39], v[176:179]
v_mfma_f32_16x16x32_bf16 v[152:155], a[116:119], a[32:35], v[152:155]
s_waitcnt vmcnt(9) lgkmcnt(0)
s_barrier
v_mfma_f32_16x16x32_bf16 v[132:135], a[128:131], a[48:51], v[132:135]
ds_read_b128 v[92:95], v235 offset:0
v_mfma_f32_16x16x32_bf16 v[156:159], a[128:131], a[52:55], v[156:159]
v_mfma_f32_16x16x32_bf16 v[180:183], a[128:131], a[56:59], v[180:183]
ds_read_b128 v[96:99], v235 offset:4096
v_mfma_f32_16x16x32_bf16 v[204:207], a[128:131], a[60:63], v[204:207]
v_mfma_f32_16x16x32_bf16 v[208:211], a[132:135], a[60:63], v[208:211]
ds_read_b128 v[100:103], v235 offset:8192
v_mfma_f32_16x16x32_bf16 v[184:187], a[132:135], a[56:59], v[184:187]
v_mfma_f32_16x16x32_bf16 v[160:163], a[132:135], a[52:55], v[160:163]
ds_read_b128 v[104:107], v235 offset:12288
v_mfma_f32_16x16x32_bf16 v[136:139], a[132:135], a[48:51], v[136:139]
v_mfma_f32_16x16x32_bf16 v[140:143], a[136:139], a[48:51], v[140:143]
v_mfma_f32_16x16x32_bf16 v[164:167], a[136:139], a[52:55], v[164:167]
v_mfma_f32_16x16x32_bf16 v[188:191], a[136:139], a[56:59], v[188:191]
v_mfma_f32_16x16x32_bf16 v[212:215], a[136:139], a[60:63], v[212:215]
v_mfma_f32_16x16x32_bf16 v[216:219], a[140:143], a[60:63], v[216:219]
v_mfma_f32_16x16x32_bf16 v[192:195], a[140:143], a[56:59], v[192:195]
v_mfma_f32_16x16x32_bf16 v[168:171], a[140:143], a[52:55], v[168:171]
v_mfma_f32_16x16x32_bf16 v[144:147], a[140:143], a[48:51], v[144:147]
v_mfma_f32_16x16x32_bf16 v[148:151], a[144:147], a[48:51], v[148:151]
v_mfma_f32_16x16x32_bf16 v[172:175], a[144:147], a[52:55], v[172:175]
v_mfma_f32_16x16x32_bf16 v[196:199], a[144:147], a[56:59], v[196:199]
v_mfma_f32_16x16x32_bf16 v[220:223], a[144:147], a[60:63], v[220:223]
v_mfma_f32_16x16x32_bf16 v[224:227], a[148:151], a[60:63], v[224:227]
v_mfma_f32_16x16x32_bf16 v[200:203], a[148:151], a[56:59], v[200:203]
v_mfma_f32_16x16x32_bf16 v[176:179], a[148:151], a[52:55], v[176:179]
v_mfma_f32_16x16x32_bf16 v[152:155], a[148:151], a[48:51], v[152:155]
.set L_cpf2, .
s_lshl_b32 s36, s28, 12
s_lshl_b32 s37, s28, 10
s_add_i32 s44, s28, 0
s_lshl_b32 s45, s44, 12
s_add_u32 m0, s45, 32768
s_and_b32 s45, s44, 7
s_cmp_eq_u32 s45, s3
s_cselect_b32 s45, 8, 0
s_add_u32 s44, s44, s45
s_and_b32 s44, s44, 31
s_lshl_b32 s44, s44, 12
s_add_u32 s44, s44, s51
buffer_load_dwordx4 v1, s[4:7], s44 offen offset:0 sc1 lds
s_waitcnt lgkmcnt(2)
v_add_f32 v92, v92, v96
s_waitcnt lgkmcnt(0)
v_add_f32 v100, v100, v104
v_add_f32 v93, v93, v97
v_add_f32 v101, v101, v105
v_add_f32 v94, v94, v98
v_add_f32 v102, v102, v106
v_add_f32 v95, v95, v99
v_add_f32 v103, v103, v107
v_add_f32 v228, v92, v100
v_add_f32 v229, v93, v101
v_add_f32 v230, v94, v102
v_add_f32 v231, v95, v103
v_fmac_f32 v228, v72, v90
v_fmac_f32 v229, v73, v90
v_pk_mul_f32 v[212:213], v[212:213], v[88:89] op_sel:[0,1] op_sel_hi:[1,1]
v_pk_mul_f32 v[220:221], v[220:221], v[88:89] op_sel:[0,1] op_sel_hi:[1,1]
v_pk_mul_f32 v[196:197], v[196:197], v[86:87] op_sel:[0,1] op_sel_hi:[1,1]
v_pk_mul_f32 v[172:173], v[172:173], v[84:85] op_sel:[0,1] op_sel_hi:[1,1]
v_pk_mul_f32 v[148:149], v[148:149], v[82:83] op_sel:[0,1] op_sel_hi:[1,1]
v_fmac_f32 v230, v74, v90
v_fmac_f32 v231, v75, v90
v_pk_mul_f32 v[228:229], v[228:229], v[90:91] op_sel:[0,1] op_sel_hi:[1,1]
v_pk_mul_f32 v[214:215], v[214:215], v[88:89] op_sel:[0,1] op_sel_hi:[1,1]
v_pk_mul_f32 v[222:223], v[222:223], v[88:89] op_sel:[0,1] op_sel_hi:[1,1]
v_pk_mul_f32 v[198:199], v[198:199], v[86:87] op_sel:[0,1] op_sel_hi:[1,1]
v_pk_mul_f32 v[174:175], v[174:175], v[84:85] op_sel:[0,1] op_sel_hi:[1,1]
v_pk_mul_f32 v[150:151], v[150:151], v[82:83] op_sel:[0,1] op_sel_hi:[1,1]
v_cvt_pk_bf16_f32 v212, v212, v213
v_cvt_pk_bf16_f32 v220, v220, v221
v_cvt_pk_bf16_f32 v196, v196, v197
buffer_load_dwordx4 v1, s[4:7], s44 offen offset:1024 sc1 lds
v_cvt_pk_bf16_f32 v172, v172, v173
v_cvt_pk_bf16_f32 v148, v148, v149
v_pk_mul_f32 v[230:231], v[230:231], v[90:91] op_sel:[0,1] op_sel_hi:[1,1]
v_pk_mul_f32 v[216:217], v[216:217], v[88:89] op_sel:[0,1] op_sel_hi:[1,1]
v_pk_mul_f32 v[218:219], v[218:219], v[88:89] op_sel:[0,1] op_sel_hi:[1,1]
v_pk_mul_f32 v[224:225], v[224:225], v[88:89] op_sel:[0,1] op_sel_hi:[1,1]
v_pk_mul_f32 v[226:227], v[226:227], v[88:89] op_sel:[0,1] op_sel_hi:[1,1]
v_pk_mul_f32 v[200:201], v[200:201], v[86:87] op_sel:[0,1] op_sel_hi:[1,1]
v_pk_mul_f32 v[202:203], v[202:203], v[86:87] op_sel:[0,1] op_sel_hi:[1,1]
v_pk_mul_f32 v[176:177], v[176:177], v[84:85] op_sel:[0,1] op_sel_hi:[1,1]
v_pk_mul_f32 v[178:179], v[178:179], v[84:85] op_sel:[0,1] op_sel_hi:[1,1]
v_pk_mul_f32 v[152:153], v[152:153], v[82:83] op_sel:[0,1] op_sel_hi:[1,1]
v_pk_mul_f32 v[154:155], v[154:155], v[82:83] op_sel:[0,1] op_sel_hi:[1,1]
v_cvt_pk_bf16_f32 v228, v228, v229
v_cvt_pk_bf16_f32 v213, v214, v215
v_cvt_pk_bf16_f32 v221, v222, v223
v_cvt_pk_bf16_f32 v197, v198, v199
v_cvt_pk_bf16_f32 v173, v174, v175
v_cvt_pk_bf16_f32 v149, v150, v151
v_pk_mul_f32 v[188:189], v[188:189], v[86:87] op_sel:[0,1] op_sel_hi:[1,1]
v_pk_mul_f32 v[164:165], v[164:165], v[84:85] op_sel:[0,1] op_sel_hi:[1,1]
v_pk_mul_f32 v[140:141], v[140:141], v[82:83] op_sel:[0,1] op_sel_hi:[1,1]
v_add_u32 v232, s36, v7
v_add_u32 v233, s37, v1
v_cvt_pk_bf16_f32 v229, v230, v231
v_cvt_pk_bf16_f32 v214, v216, v217
v_cvt_pk_bf16_f32 v215, v218, v219
v_cvt_pk_bf16_f32 v222, v224, v225
v_cvt_pk_bf16_f32 v223, v226, v227
v_cvt_pk_bf16_f32 v198, v200, v201
buffer_load_dwordx4 v1, s[4:7], s44 offen offset:2048 sc1 lds
v_cvt_pk_bf16_f32 v199, v202, v203
v_cvt_pk_bf16_f32 v174, v176, v177
v_cvt_pk_bf16_f32 v175, v178, v179
v_cvt_pk_bf16_f32 v150, v152, v153
v_cvt_pk_bf16_f32 v151, v154, v155
v_pk_mul_f32 v[190:191], v[190:191], v[86:87] op_sel:[0,1] op_sel_hi:[1,1]
v_pk_mul_f32 v[166:167], v[166:167], v[84:85] op_sel:[0,1] op_sel_hi:[1,1]
v_pk_mul_f32 v[142:143], v[142:143], v[82:83] op_sel:[0,1] op_sel_hi:[1,1]
v_cvt_pk_bf16_f32 v188, v188, v189
v_cvt_pk_bf16_f32 v164, v164, v165
v_cvt_pk_bf16_f32 v140, v140, v141
v_cvt_pk_bf16_f32 v132, v132, v133
v_cvt_pk_bf16_f32 v156, v156, v157
v_cvt_pk_bf16_f32 v180, v180, v181
v_cvt_pk_bf16_f32 v204, v204, v205
ds_write_b64 v9, v[228:229]
ds_write_b64 v232, v[220:221] offset:4096
ds_write_b64 v232, v[222:223] offset:4608
v_pk_mul_f32 v[192:193], v[192:193], v[86:87] op_sel:[0,1] op_sel_hi:[1,1]
v_pk_mul_f32 v[194:195], v[194:195], v[86:87] op_sel:[0,1] op_sel_hi:[1,1]
v_pk_mul_f32 v[168:169], v[168:169], v[84:85] op_sel:[0,1] op_sel_hi:[1,1]
ds_write_b64 v232, v[196:197] offset:3072
v_pk_mul_f32 v[170:171], v[170:171], v[84:85] op_sel:[0,1] op_sel_hi:[1,1]
v_pk_mul_f32 v[144:145], v[144:145], v[82:83] op_sel:[0,1] op_sel_hi:[1,1]
v_pk_mul_f32 v[146:147], v[146:147], v[82:83] op_sel:[0,1] op_sel_hi:[1,1]
ds_write_b64 v232, v[198:199] offset:3584
buffer_load_dwordx4 v1, s[4:7], s44 offen offset:3072 sc1 lds
v_cvt_pk_bf16_f32 v189, v190, v191
ds_write_b64 v232, v[172:173] offset:2048
v_cvt_pk_bf16_f32 v165, v166, v167
v_cvt_pk_bf16_f32 v141, v142, v143
ds_write_b64 v232, v[174:175] offset:2560
v_cvt_pk_bf16_f32 v133, v134, v135
v_cvt_pk_bf16_f32 v157, v158, v159
v_cvt_pk_bf16_f32 v181, v182, v183
ds_write_b64 v232, v[148:149] offset:1024
v_cvt_pk_bf16_f32 v205, v206, v207
v_cvt_pk_bf16_f32 v190, v192, v193
v_cvt_pk_bf16_f32 v191, v194, v195
ds_write_b64 v232, v[150:151] offset:1536
v_cvt_pk_bf16_f32 v166, v168, v169
v_cvt_pk_bf16_f32 v167, v170, v171
v_cvt_pk_bf16_f32 v142, v144, v145
ds_write_b128 v233, v[212:215] offset:21504
v_cvt_pk_bf16_f32 v143, v146, v147
v_cvt_pk_bf16_f32 v134, v136, v137
v_cvt_pk_bf16_f32 v135, v138, v139
v_cvt_pk_bf16_f32 v158, v160, v161
v_cvt_pk_bf16_f32 v159, v162, v163
v_cvt_pk_bf16_f32 v182, v184, v185
v_cvt_pk_bf16_f32 v183, v186, v187
v_cvt_pk_bf16_f32 v206, v208, v209
v_cvt_pk_bf16_f32 v207, v210, v211
s_waitcnt lgkmcnt(0)
s_barrier
s_lshl_b32 s35, s30, 12
s_add_u32 s35, s35, 0x1e00000
s_add_i32 s44, s28, 28
s_lshl_b32 s45, s44, 12
s_add_u32 m0, s45, 32768
s_and_b32 s45, s44, 7
s_cmp_eq_u32 s45, s3
s_cselect_b32 s45, 8, 0
s_add_u32 s44, s44, s45
s_and_b32 s44, s44, 31
s_lshl_b32 s44, s44, 12
s_add_u32 s44, s44, s51
buffer_load_dwordx4 v1, s[4:7], s44 offen offset:0 sc1 lds
v_mfma_f32_16x16x32_bf16 v[184:187], v[164:167], v[180:183], v[20:23]
ds_read_b128 a[0:3], v233 offset:20480
v_mfma_f32_16x16x32_bf16 v[200:203], v[188:191], v[180:183], v[24:27]
v_add_u32 v234, s36, v8
ds_read_b64_tr_b16 a[10:11], v234 offset:3072
v_mfma_f32_16x16x32_bf16 v[208:211], v[188:191], v[204:207], v[20:23]
ds_read_b64_tr_b16 a[12:13], v234 offset:4096
v_mfma_f32_16x16x32_bf16 v[224:227], v[212:215], v[204:207], v[24:27]
s_nop 2
v_max_f32 v200, v200, v184
v_max_f32 v201, v201, v185
v_max_f32 v202, v202, v186
v_max_f32 v203, v203, v187
v_max3_f32 v238, v200, v201, v202
v_max_f32 v238, v238, v203
ds_read_b64_tr_b16 a[22:23], v234 offset:3584
v_max_f32 v224, v224, v208
v_max_f32 v225, v225, v209
v_max_f32 v226, v226, v210
v_max_f32 v227, v227, v211
v_max3_f32 v239, v224, v225, v226
v_max_f32 v239, v239, v227
ds_read_b64_tr_b16 a[24:25], v234 offset:4608
buffer_load_dwordx4 v1, s[4:7], s44 offen offset:1024 sc1 lds
v_permlane32_swap_b32 v239, v238
v_max_f32 v239, v239, v238
v_mov_b32 v242, v239
s_waitcnt lgkmcnt(4)
v_mfma_f32_16x16x32_bf16 v[136:139], a[0:3], v[132:135], v[76:79]
v_permlane16_swap_b32 v239, v242
v_max_f32 v239, v239, v242
v_mov_b32 v242, v239
v_mfma_f32_16x16x32_bf16 v[152:155], v[140:143], v[132:135], v[24:27]
s_nop 0
v_permlane32_swap_b32 v239, v242
v_mfma_f32_16x16x32_bf16 v[160:163], v[140:143], v[156:159], v[20:23]
v_mul_f32 v88, 0x3e8293ee, v89
v_mul_f32_e64 v89, -v239, v88
v_mfma_f32_16x16x32_bf16 v[176:179], v[164:167], v[156:159], v[24:27]
v_fma_f32 v224, v224, v88, v89
v_fma_f32 v225, v225, v88, v89
v_fma_f32 v226, v226, v88, v89
v_fma_f32 v227, v227, v88, v89
v_exp_f32 v224, v224
v_exp_f32 v225, v225
v_exp_f32 v226, v226
buffer_load_dwordx4 v1, s[4:7], s44 offen offset:2048 sc1 lds
v_exp_f32 v227, v227
v_max_f32 v152, v152, v136
v_max_f32 v153, v153, v137
v_max_f32 v154, v154, v138
v_max_f32 v176, v176, v160
v_max_f32 v177, v177, v161
v_max_f32 v178, v178, v162
v_cvt_pk_bf16_f32 v224, v224, v225
ds_read_b64_tr_b16 a[8:9], v234 offset:2048
v_max_f32 v155, v155, v139
v_max3_f32 v236, v152, v153, v154
v_max_f32 v179, v179, v163
v_max3_f32 v237, v176, v177, v178
v_cvt_pk_bf16_f32 v225, v226, v227
ds_read_b64_tr_b16 a[20:21], v234 offset:2560
v_max_f32 v236, v236, v155
v_max_f32 v237, v237, v179
v_and_b32 v208, v224, v28
v_and_b32 v209, v225, v29
v_and_b32 v210, v224, v30
v_and_b32 v211, v225, v31
v_permlane32_swap_b32 v237, v236
s_nop 0
v_mfma_f32_16x16x32_bf16 v[216:219], v[16:19], v[208:211], 0
v_mul_f32 v86, 0x3e8293ee, v87
v_max_f32 v237, v237, v236
buffer_load_dwordx4 v1, s[4:7], s44 offen offset:3072 sc1 lds
v_mul_f32_e64 v87, -v242, v86
s_waitcnt lgkmcnt(4)
v_mfma_f32_16x16x32_bf16 v[116:119], a[10:13], v[208:211], 0
v_mov_b32 v243, v237
v_fma_f32 v200, v200, v86, v87
v_fma_f32 v201, v201, v86, v87
v_fma_f32 v202, v202, v86, v87
v_fma_f32 v203, v203, v86, v87
s_waitcnt lgkmcnt(2)
v_mfma_f32_16x16x32_bf16 v[120:123], a[22:25], v[208:211], 0
v_exp_f32 v200, v200
v_exp_f32 v201, v201
v_exp_f32 v202, v202
v_exp_f32 v203, v203
v_permlane16_swap_b32 v237, v243
v_rcp_f32 v216, v216
v_cvt_pk_bf16_f32 v200, v200, v201
ds_read_b64_tr_b16 a[6:7], v234 offset:1024
v_max_f32 v237, v237, v243
v_cvt_pk_bf16_f32 v201, v202, v203
ds_read_b64_tr_b16 a[18:19], v234 offset:1536
v_mov_b32 v243, v237
v_and_b32 v184, v200, v28
v_and_b32 v185, v201, v29
v_and_b32 v186, v200, v30
v_and_b32 v187, v201, v31
v_pk_mul_f32 v[116:117], v[116:117], v[216:217] op_sel:[0,0] op_sel_hi:[1,0]
v_pk_mul_f32 v[118:119], v[118:119], v[216:217] op_sel:[0,0] op_sel_hi:[1,0]
v_cvt_pk_bf16_f32 v116, v116, v117
v_pk_mul_f32 v[120:121], v[120:121], v[216:217] op_sel:[0,0] op_sel_hi:[1,0]
v_permlane32_swap_b32 v237, v243
v_pk_mul_f32 v[122:123], v[122:123], v[216:217] op_sel:[0,0] op_sel_hi:[1,0]
v_cvt_pk_bf16_f32 v117, v118, v119
v_mfma_f32_16x16x32_bf16 v[192:195], v[16:19], v[184:187], 0
v_cvt_pk_bf16_f32 v118, v120, v121
v_cvt_pk_bf16_f32 v119, v122, v123
v_mul_f32 v84, 0x3e8293ee, v85
buffer_store_dwordx4 v[116:119], v2, s[4:7], s35 offen offset:3072 sc1
v_mul_f32_e64 v85, -v237, v84
s_waitcnt lgkmcnt(3)
v_mfma_f32_16x16x32_bf16 v[108:111], a[8:11], v[184:187], 0
v_fma_f32 v176, v176, v84, v85
v_fma_f32 v177, v177, v84, v85
v_fma_f32 v178, v178, v84, v85
v_fma_f32 v179, v179, v84, v85
s_waitcnt lgkmcnt(2)
v_mfma_f32_16x16x32_bf16 v[112:115], a[20:23], v[184:187], 0
v_exp_f32 v176, v176
v_exp_f32 v177, v177
v_exp_f32 v178, v178
v_exp_f32 v179, v179
v_rcp_f32 v192, v192
v_cvt_pk_bf16_f32 v176, v176, v177
ds_read_b64_tr_b16 a[4:5], v234 offset:0
v_cvt_pk_bf16_f32 v177, v178, v179
ds_read_b64_tr_b16 a[16:17], v234 offset:512
v_and_b32 v160, v176, v28
v_and_b32 v161, v177, v29
v_and_b32 v162, v176, v30
v_and_b32 v163, v177, v31
v_pk_mul_f32 v[108:109], v[108:109], v[192:193] op_sel:[0,0] op_sel_hi:[1,0]
v_pk_mul_f32 v[110:111], v[110:111], v[192:193] op_sel:[0,0] op_sel_hi:[1,0]
v_cvt_pk_bf16_f32 v108, v108, v109
v_pk_mul_f32 v[112:113], v[112:113], v[192:193] op_sel:[0,0] op_sel_hi:[1,0]
v_cvt_pk_bf16_f32 v109, v110, v111
v_pk_mul_f32 v[114:115], v[114:115], v[192:193] op_sel:[0,0] op_sel_hi:[1,0]
v_cvt_pk_bf16_f32 v110, v112, v113
v_mfma_f32_16x16x32_bf16 v[168:171], v[16:19], v[160:163], 0
v_cvt_pk_bf16_f32 v111, v114, v115
v_mul_f32 v82, 0x3e8293ee, v83
buffer_store_dwordx4 v[108:111], v2, s[4:7], s35 offen offset:2048 sc1
v_mul_f32_e64 v83, -v243, v82
s_waitcnt lgkmcnt(3)
v_mfma_f32_16x16x32_bf16 v[100:103], a[6:9], v[160:163], 0
v_fma_f32 v152, v152, v82, v83
v_fma_f32 v153, v153, v82, v83
v_fma_f32 v154, v154, v82, v83
v_fma_f32 v155, v155, v82, v83
s_waitcnt lgkmcnt(2)
v_mfma_f32_16x16x32_bf16 v[104:107], a[18:21], v[160:163], 0
v_exp_f32 v152, v152
v_exp_f32 v153, v153
v_exp_f32 v154, v154
v_exp_f32 v155, v155
v_rcp_f32 v168, v168
v_cvt_pk_bf16_f32 v152, v152, v153
v_cvt_pk_bf16_f32 v153, v154, v155
v_and_b32 v136, v152, v80
v_and_b32 v137, v153, v81
v_and_b32 v138, v152, v30
v_and_b32 v139, v153, v31
v_pk_mul_f32 v[100:101], v[100:101], v[168:169] op_sel:[0,0] op_sel_hi:[1,0]
v_pk_mul_f32 v[102:103], v[102:103], v[168:169] op_sel:[0,0] op_sel_hi:[1,0]
v_cvt_pk_bf16_f32 v100, v100, v101
v_pk_mul_f32 v[104:105], v[104:105], v[168:169] op_sel:[0,0] op_sel_hi:[1,0]
v_cvt_pk_bf16_f32 v101, v102, v103
v_pk_mul_f32 v[106:107], v[106:107], v[168:169] op_sel:[0,0] op_sel_hi:[1,0]
v_cvt_pk_bf16_f32 v102, v104, v105
v_mfma_f32_16x16x32_bf16 v[144:147], v[16:19], v[136:139], 0
v_cvt_pk_bf16_f32 v103, v106, v107
buffer_store_dwordx4 v[100:103], v2, s[4:7], s35 offen offset:1024 sc1
s_waitcnt lgkmcnt(1)
v_mfma_f32_16x16x32_bf16 v[92:95], a[4:7], v[136:139], 0
s_nop 3
v_rcp_f32 v144, v144
s_waitcnt lgkmcnt(0)
v_mfma_f32_16x16x32_bf16 v[96:99], a[16:19], v[136:139], 0
s_nop 0
v_pk_mul_f32 v[92:93], v[92:93], v[144:145] op_sel:[0,0] op_sel_hi:[1,0]
v_pk_mul_f32 v[94:95], v[94:95], v[144:145] op_sel:[0,0] op_sel_hi:[1,0]
v_cvt_pk_bf16_f32 v92, v92, v93
v_cvt_pk_bf16_f32 v93, v94, v95
s_nop 2
v_pk_mul_f32 v[96:97], v[96:97], v[144:145] op_sel:[0,0] op_sel_hi:[1,0]
v_pk_mul_f32 v[98:99], v[98:99], v[144:145] op_sel:[0,0] op_sel_hi:[1,0]
v_cvt_pk_bf16_f32 v94, v96, v97
v_cvt_pk_bf16_f32 v95, v98, v99
buffer_store_dwordx4 v[92:95], v2, s[4:7], s35 offen offset:0 sc1
s_add_u32 s92, s71, 0x20000
s_add_u32 s40, s4, 0x1e00000
s_addc_u32 s41, s5, 0
v_add_u32 v5, 32768, v1
v_add_u32 v6, 98304, v1
s_cmp_eq_u32 s3, 0
s_cselect_b32 s35, 8, 0
s_lshl_b32 s35, s35, 12
v_lshlrev_b32 v132, 16, v32
v_and_b32 v133, 0xffff0000, v32
v_lshlrev_b32 v134, 16, v33
v_and_b32 v135, 0xffff0000, v33
v_lshlrev_b32 v136, 16, v34
v_and_b32 v137, 0xffff0000, v34
v_lshlrev_b32 v138, 16, v35
v_and_b32 v139, 0xffff0000, v35
v_lshlrev_b32 v140, 16, v36
v_and_b32 v141, 0xffff0000, v36
v_lshlrev_b32 v142, 16, v37
v_and_b32 v143, 0xffff0000, v37
v_lshlrev_b32 v144, 16, v38
v_and_b32 v145, 0xffff0000, v38
v_lshlrev_b32 v146, 16, v39
v_and_b32 v147, 0xffff0000, v39
v_lshlrev_b32 v148, 16, v40
v_and_b32 v149, 0xffff0000, v40
v_lshlrev_b32 v150, 16, v41
v_and_b32 v151, 0xffff0000, v41
v_lshlrev_b32 v152, 16, v42
v_and_b32 v153, 0xffff0000, v42
v_lshlrev_b32 v154, 16, v43
v_and_b32 v155, 0xffff0000, v43
v_lshlrev_b32 v156, 16, v44
v_and_b32 v157, 0xffff0000, v44
v_lshlrev_b32 v158, 16, v45
v_and_b32 v159, 0xffff0000, v45
v_lshlrev_b32 v160, 16, v46
v_and_b32 v161, 0xffff0000, v46
v_lshlrev_b32 v162, 16, v47
v_and_b32 v163, 0xffff0000, v47
s_waitcnt vmcnt(0)
s_barrier
s_cmp_lg_u32 s28, 1
s_cbranch_scc1 Lsg_30
buffer_atomic_add v12, v10, s[4:7], s92 offen sc1
Lsg_30:
s_cmp_lg_u32 s28, 1
s_cbranch_scc1 L_wskip5
s_mov_b64 exec, 0
s_branch L_stub14
L_wret5:
s_mov_b64 exec, -1
L_wskip5:
s_cmp_lg_u32 s28, 0
s_cbranch_scc1 Lpe_32
s_add_u32 s36, s66, 0x20000
s_mov_b32 s37, 0
Lpoll_31:
v_mov_b32 v11, 0
s_mov_b64 exec, 1
buffer_atomic_add v11, off, s[4:7], s36 sc0 sc1
s_waitcnt vmcnt(0)
v_readfirstlane_b32 s38, v11
s_mov_b64 exec, -1
s_nop 0
v_mov_b32 v11, s38
s_add_u32 s37, s37, 1
v_cmp_gt_u32 vcc, 32, v11
s_cbranch_vccz Lpe_32
s_cmp_lt_u32 s37, 0x100000
s_cbranch_scc1 Lpoll_31
Lpe_32:
s_waitcnt vmcnt(0)
s_barrier
L_k2go2:
buffer_load_dwordx4 a[0:3], v4, s[40:43], s35 offen offset:0 sc1
buffer_load_dwordx4 a[4:7], v4, s[40:43], s35 offen offset:1024 sc1
s_cmp_eq_u32 s3, 1
s_cselect_b32 s35, 9, 1
s_lshl_b32 s35, s35, 12
buffer_load_dwordx4 a[8:11], v4, s[40:43], s35 offen offset:0 sc1
buffer_load_dwordx4 a[12:15], v4, s[40:43], s35 offen offset:1024 sc1
s_cmp_eq_u32 s3, 2
s_cselect_b32 s35, 10, 2
s_lshl_b32 s35, s35, 12
buffer_load_dwordx4 a[16:19], v4, s[40:43], s35 offen offset:0 sc1
buffer_load_dwordx4 a[20:23], v4, s[40:43], s35 offen offset:1024 sc1
s_cmp_eq_u32 s3, 3
s_cselect_b32 s35, 11, 3
s_lshl_b32 s35, s35, 12
buffer_load_dwordx4 a[24:27], v4, s[40:43], s35 offen offset:0 sc1
buffer_load_dwordx4 a[28:31], v4, s[40:43], s35 offen offset:1024 sc1
s_cmp_eq_u32 s3, 4
s_cselect_b32 s35, 12, 4
s_lshl_b32 s35, s35, 12
buffer_load_dwordx4 a[32:35], v4, s[40:43], s35 offen offset:0 sc1
buffer_load_dwordx4 a[36:39], v4, s[40:43], s35 offen offset:1024 sc1
s_cmp_eq_u32 s3, 5
s_cselect_b32 s35, 13, 5
s_lshl_b32 s35, s35, 12
ds_read_b128 a[96:99], v5 offset:0
ds_read_b128 a[100:103], v5 offset:1024
ds_read_b128 a[104:107], v5 offset:2048
ds_read_b128 a[108:111], v5 offset:3072
ds_read_b128 a[112:115], v5 offset:4096
ds_read_b128 a[116:119], v5 offset:5120
ds_read_b128 a[120:123], v5 offset:6144
ds_read_b128 a[124:127], v5 offset:7168
s_waitcnt vmcnt(8) lgkmcnt(4)
v_mfma_f32_16x16x32_bf16 v[132:135], a[96:99], a[0:3], v[132:135]
ds_read_b128 a[128:131], v5 offset:8192
v_mfma_f32_16x16x32_bf16 v[148:151], a[96:99], a[4:7], v[148:151]
ds_read_b128 a[132:135], v5 offset:9216
v_mfma_f32_16x16x32_bf16 v[152:155], a[100:103], a[4:7], v[152:155]
buffer_load_dwordx4 a[40:43], v4, s[40:43], s35 offen offset:0 sc1
v_mfma_f32_16x16x32_bf16 v[136:139], a[100:103], a[0:3], v[136:139]
ds_read_b128 a[136:139], v5 offset:10240
v_mfma_f32_16x16x32_bf16 v[140:143], a[104:107], a[0:3], v[140:143]
ds_read_b128 a[140:143], v5 offset:11264
v_mfma_f32_16x16x32_bf16 v[156:159], a[104:107], a[4:7], v[156:159]
v_mfma_f32_16x16x32_bf16 v[160:163], a[108:111], a[4:7], v[160:163]
buffer_load_dwordx4 a[44:47], v4, s[40:43], s35 offen offset:1024 sc1
v_mfma_f32_16x16x32_bf16 v[144:147], a[108:111], a[0:3], v[144:147]
s_waitcnt vmcnt(8) lgkmcnt(4)
v_mfma_f32_16x16x32_bf16 v[132:135], a[112:115], a[8:11], v[132:135]
s_cmp_eq_u32 s3, 6
s_cselect_b32 s35, 14, 6
s_lshl_b32 s35, s35, 12
v_mfma_f32_16x16x32_bf16 v[148:151], a[112:115], a[12:15], v[148:151]
ds_read_b128 a[96:99], v5 offset:12288
v_mfma_f32_16x16x32_bf16 v[152:155], a[116:119], a[12:15], v[152:155]
buffer_load_dwordx4 a[0:3], v4, s[40:43], s35 offen offset:0 sc1
v_mfma_f32_16x16x32_bf16 v[136:139], a[116:119], a[8:11], v[136:139]
ds_read_b128 a[100:103], v5 offset:13312
v_mfma_f32_16x16x32_bf16 v[140:143], a[120:123], a[8:11], v[140:143]
ds_read_b128 a[104:107], v5 offset:14336
v_mfma_f32_16x16x32_bf16 v[156:159], a[120:123], a[12:15], v[156:159]
ds_read_b128 a[108:111], v5 offset:15360
v_mfma_f32_16x16x32_bf16 v[160:163], a[124:127], a[12:15], v[160:163]
buffer_load_dwordx4 a[4:7], v4, s[40:43], s35 offen offset:1024 sc1
v_mfma_f32_16x16x32_bf16 v[144:147], a[124:127], a[8:11], v[144:147]
s_waitcnt vmcnt(8) lgkmcnt(4)
v_mfma_f32_16x16x32_bf16 v[132:135], a[128:131], a[16:19], v[132:135]
s_cmp_eq_u32 s3, 7
s_cselect_b32 s35, 15, 7
s_lshl_b32 s35, s35, 12
v_mfma_f32_16x16x32_bf16 v[148:151], a[128:131], a[20:23], v[148:151]
ds_read_b128 a[112:115], v5 offset:16384
v_mfma_f32_16x16x32_bf16 v[152:155], a[132:135], a[20:23], v[152:155]
buffer_load_dwordx4 a[8:11], v4, s[40:43], s35 offen offset:0 sc1
v_mfma_f32_16x16x32_bf16 v[136:139], a[132:135], a[16:19], v[136:139]
ds_read_b128 a[116:119], v5 offset:17408
v_mfma_f32_16x16x32_bf16 v[140:143], a[136:139], a[16:19], v[140:143]
ds_read_b128 a[120:123], v5 offset:18432
v_mfma_f32_16x16x32_bf16 v[156:159], a[136:139], a[20:23], v[156:159]
ds_read_b128 a[124:127], v5 offset:19456
v_mfma_f32_16x16x32_bf16 v[160:163], a[140:143], a[20:23], v[160:163]
buffer_load_dwordx4 a[12:15], v4, s[40:43], s35 offen offset:1024 sc1
v_mfma_f32_16x16x32_bf16 v[144:147], a[140:143], a[16:19], v[144:147]
s_waitcnt vmcnt(8) lgkmcnt(4)
v_mfma_f32_16x16x32_bf16 v[132:135], a[96:99], a[24:27], v[132:135]
s_cmp_eq_u32 s3, 0
s_cselect_b32 s35, 16, 8
s_lshl_b32 s35, s35, 12
v_mfma_f32_16x16x32_bf16 v[148:151], a[96:99], a[28:31], v[148:151]
ds_read_b128 a[128:131], v5 offset:20480
v_mfma_f32_16x16x32_bf16 v[152:155], a[100:103], a[28:31], v[152:155]
buffer_load_dwordx4 a[16:19], v4, s[40:43], s35 offen offset:0 sc1
v_mfma_f32_16x16x32_bf16 v[136:139], a[100:103], a[24:27], v[136:139]
ds_read_b128 a[132:135], v5 offset:21504
v_mfma_f32_16x16x32_bf16 v[140:143], a[104:107], a[24:27], v[140:143]
ds_read_b128 a[136:139], v5 offset:22528
v_mfma_f32_16x16x32_bf16 v[156:159], a[104:107], a[28:31], v[156:159]
ds_read_b128 a[140:143], v5 offset:23552
v_mfma_f32_16x16x32_bf16 v[160:163], a[108:111], a[28:31], v[160:163]
buffer_load_dwordx4 a[20:23], v4, s[40:43], s35 offen offset:1024 sc1
v_mfma_f32_16x16x32_bf16 v[144:147], a[108:111], a[24:27], v[144:147]
s_waitcnt vmcnt(8) lgkmcnt(4)
v_mfma_f32_16x16x32_bf16 v[132:135], a[112:115], a[32:35], v[132:135]
s_cmp_eq_u32 s3, 1
s_cselect_b32 s35, 17, 9
s_lshl_b32 s35, s35, 12
v_mfma_f32_16x16x32_bf16 v[148:151], a[112:115], a[36:39], v[148:151]
ds_read_b128 a[96:99], v5 offset:24576
L_stub14:
s_cbranch_execz L_wret5
v_mfma_f32_16x16x32_bf16 v[152:155], a[116:119], a[36:39], v[152:155]
buffer_load_dwordx4 a[24:27], v4, s[40:43], s35 offen offset:0 sc1
v_mfma_f32_16x16x32_bf16 v[136:139], a[116:119], a[32:35], v[136:139]
ds_read_b128 a[100:103], v5 offset:25600
v_mfma_f32_16x16x32_bf16 v[140:143], a[120:123], a[32:35], v[140:143]
ds_read_b128 a[104:107], v5 offset:26624
v_mfma_f32_16x16x32_bf16 v[156:159], a[120:123], a[36:39], v[156:159]
ds_read_b128 a[108:111], v5 offset:27648
v_mfma_f32_16x16x32_bf16 v[160:163], a[124:127], a[36:39], v[160:163]
buffer_load_dwordx4 a[28:31], v4, s[40:43], s35 offen offset:1024 sc1
v_mfma_f32_16x16x32_bf16 v[144:147], a[124:127], a[32:35], v[144:147]
s_waitcnt vmcnt(8) lgkmcnt(4)
v_mfma_f32_16x16x32_bf16 v[132:135], a[128:131], a[40:43], v[132:135]
s_cmp_eq_u32 s3, 2
s_cselect_b32 s35, 18, 10
s_lshl_b32 s35, s35, 12
v_mfma_f32_16x16x32_bf16 v[148:151], a[128:131], a[44:47], v[148:151]
ds_read_b128 a[112:115], v5 offset:28672
v_mfma_f32_16x16x32_bf16 v[152:155], a[132:135], a[44:47], v[152:155]
buffer_load_dwordx4 a[32:35], v4, s[40:43], s35 offen offset:0 sc1
v_mfma_f32_16x16x32_bf16 v[136:139], a[132:135], a[40:43], v[136:139]
ds_read_b128 a[116:119], v5 offset:29696
v_mfma_f32_16x16x32_bf16 v[140:143], a[136:139], a[40:43], v[140:143]
ds_read_b128 a[120:123], v5 offset:30720
v_mfma_f32_16x16x32_bf16 v[156:159], a[136:139], a[44:47], v[156:159]
ds_read_b128 a[124:127], v5 offset:31744
v_mfma_f32_16x16x32_bf16 v[160:163], a[140:143], a[44:47], v[160:163]
buffer_load_dwordx4 a[36:39], v4, s[40:43], s35 offen offset:1024 sc1
v_mfma_f32_16x16x32_bf16 v[144:147], a[140:143], a[40:43], v[144:147]
s_waitcnt vmcnt(8) lgkmcnt(4)
v_mfma_f32_16x16x32_bf16 v[132:135], a[96:99], a[0:3], v[132:135]
s_cmp_eq_u32 s3, 3
s_cselect_b32 s35, 19, 11
s_lshl_b32 s35, s35, 12
v_mfma_f32_16x16x32_bf16 v[148:151], a[96:99], a[4:7], v[148:151]
ds_read_b128 a[128:131], v5 offset:32768
v_mfma_f32_16x16x32_bf16 v[152:155], a[100:103], a[4:7], v[152:155]
buffer_load_dwordx4 a[40:43], v4, s[40:43], s35 offen offset:0 sc1
v_mfma_f32_16x16x32_bf16 v[136:139], a[100:103], a[0:3], v[136:139]
ds_read_b128 a[132:135], v5 offset:33792
v_mfma_f32_16x16x32_bf16 v[140:143], a[104:107], a[0:3], v[140:143]
ds_read_b128 a[136:139], v5 offset:34816
v_mfma_f32_16x16x32_bf16 v[156:159], a[104:107], a[4:7], v[156:159]
ds_read_b128 a[140:143], v5 offset:35840
v_mfma_f32_16x16x32_bf16 v[160:163], a[108:111], a[4:7], v[160:163]
buffer_load_dwordx4 a[44:47], v4, s[40:43], s35 offen offset:1024 sc1
v_mfma_f32_16x16x32_bf16 v[144:147], a[108:111], a[0:3], v[144:147]
s_waitcnt vmcnt(8) lgkmcnt(4)
v_mfma_f32_16x16x32_bf16 v[132:135], a[112:115], a[8:11], v[132:135]
s_cmp_eq_u32 s3, 4
s_cselect_b32 s35, 20, 12
s_lshl_b32 s35, s35, 12
v_mfma_f32_16x16x32_bf16 v[148:151], a[112:115], a[12:15], v[148:151]
ds_read_b128 a[96:99], v5 offset:36864
v_mfma_f32_16x16x32_bf16 v[152:155], a[116:119], a[12:15], v[152:155]
buffer_load_dwordx4 a[0:3], v4, s[40:43], s35 offen offset:0 sc1
v_mfma_f32_16x16x32_bf16 v[136:139], a[116:119], a[8:11], v[136:139]
ds_read_b128 a[100:103], v5 offset:37888
v_mfma_f32_16x16x32_bf16 v[140:143], a[120:123], a[8:11], v[140:143]
ds_read_b128 a[104:107], v5 offset:38912
v_mfma_f32_16x16x32_bf16 v[156:159], a[120:123], a[12:15], v[156:159]
ds_read_b128 a[108:111], v5 offset:39936
v_mfma_f32_16x16x32_bf16 v[160:163], a[124:127], a[12:15], v[160:163]
buffer_load_dwordx4 a[4:7], v4, s[40:43], s35 offen offset:1024 sc1
v_mfma_f32_16x16x32_bf16 v[144:147], a[124:127], a[8:11], v[144:147]
s_waitcnt vmcnt(8) lgkmcnt(4)
v_mfma_f32_16x16x32_bf16 v[132:135], a[128:131], a[16:19], v[132:135]
s_cmp_eq_u32 s3, 5
s_cselect_b32 s35, 21, 13
s_lshl_b32 s35, s35, 12
v_mfma_f32_16x16x32_bf16 v[148:151], a[128:131], a[20:23], v[148:151]
ds_read_b128 a[112:115], v5 offset:40960
v_mfma_f32_16x16x32_bf16 v[152:155], a[132:135], a[20:23], v[152:155]
buffer_load_dwordx4 a[8:11], v4, s[40:43], s35 offen offset:0 sc1
v_mfma_f32_16x16x32_bf16 v[136:139], a[132:135], a[16:19], v[136:139]
ds_read_b128 a[116:119], v5 offset:41984
v_mfma_f32_16x16x32_bf16 v[140:143], a[136:139], a[16:19], v[140:143]
ds_read_b128 a[120:123], v5 offset:43008
v_mfma_f32_16x16x32_bf16 v[156:159], a[136:139], a[20:23], v[156:159]
ds_read_b128 a[124:127], v5 offset:44032
v_mfma_f32_16x16x32_bf16 v[160:163], a[140:143], a[20:23], v[160:163]
buffer_load_dwordx4 a[12:15], v4, s[40:43], s35 offen offset:1024 sc1
v_mfma_f32_16x16x32_bf16 v[144:147], a[140:143], a[16:19], v[144:147]
s_waitcnt vmcnt(8) lgkmcnt(4)
v_mfma_f32_16x16x32_bf16 v[132:135], a[96:99], a[24:27], v[132:135]
s_cmp_eq_u32 s3, 6
s_cselect_b32 s35, 22, 14
s_lshl_b32 s35, s35, 12
v_mfma_f32_16x16x32_bf16 v[148:151], a[96:99], a[28:31], v[148:151]
ds_read_b128 a[128:131], v5 offset:45056
v_mfma_f32_16x16x32_bf16 v[152:155], a[100:103], a[28:31], v[152:155]
buffer_load_dwordx4 a[16:19], v4, s[40:43], s35 offen offset:0 sc1
v_mfma_f32_16x16x32_bf16 v[136:139], a[100:103], a[24:27], v[136:139]
ds_read_b128 a[132:135], v5 offset:46080
v_mfma_f32_16x16x32_bf16 v[140:143], a[104:107], a[24:27], v[140:143]
ds_read_b128 a[136:139], v5 offset:47104
v_mfma_f32_16x16x32_bf16 v[156:159], a[104:107], a[28:31], v[156:159]
ds_read_b128 a[140:143], v5 offset:48128
v_mfma_f32_16x16x32_bf16 v[160:163], a[108:111], a[28:31], v[160:163]
buffer_load_dwordx4 a[20:23], v4, s[40:43], s35 offen offset:1024 sc1
v_mfma_f32_16x16x32_bf16 v[144:147], a[108:111], a[24:27], v[144:147]
s_waitcnt vmcnt(8) lgkmcnt(4)
v_mfma_f32_16x16x32_bf16 v[132:135], a[112:115], a[32:35], v[132:135]
s_cmp_eq_u32 s3, 7
s_cselect_b32 s35, 23, 15
s_lshl_b32 s35, s35, 12
v_mfma_f32_16x16x32_bf16 v[148:151], a[112:115], a[36:39], v[148:151]
ds_read_b128 a[96:99], v5 offset:49152
v_mfma_f32_16x16x32_bf16 v[152:155], a[116:119], a[36:39], v[152:155]
buffer_load_dwordx4 a[24:27], v4, s[40:43], s35 offen offset:0 sc1
v_mfma_f32_16x16x32_bf16 v[136:139], a[116:119], a[32:35], v[136:139]
ds_read_b128 a[100:103], v5 offset:50176
v_mfma_f32_16x16x32_bf16 v[140:143], a[120:123], a[32:35], v[140:143]
ds_read_b128 a[104:107], v5 offset:51200
v_mfma_f32_16x16x32_bf16 v[156:159], a[120:123], a[36:39], v[156:159]
ds_read_b128 a[108:111], v5 offset:52224
v_mfma_f32_16x16x32_bf16 v[160:163], a[124:127], a[36:39], v[160:163]
buffer_load_dwordx4 a[28:31], v4, s[40:43], s35 offen offset:1024 sc1
v_mfma_f32_16x16x32_bf16 v[144:147], a[124:127], a[32:35], v[144:147]
s_waitcnt vmcnt(8) lgkmcnt(4)
v_mfma_f32_16x16x32_bf16 v[132:135], a[128:131], a[40:43], v[132:135]
s_cmp_eq_u32 s3, 0
s_cselect_b32 s35, 24, 16
s_lshl_b32 s35, s35, 12
v_mfma_f32_16x16x32_bf16 v[148:151], a[128:131], a[44:47], v[148:151]
ds_read_b128 a[112:115], v5 offset:53248
v_mfma_f32_16x16x32_bf16 v[152:155], a[132:135], a[44:47], v[152:155]
buffer_load_dwordx4 a[32:35], v4, s[40:43], s35 offen offset:0 sc1
v_mfma_f32_16x16x32_bf16 v[136:139], a[132:135], a[40:43], v[136:139]
ds_read_b128 a[116:119], v5 offset:54272
v_mfma_f32_16x16x32_bf16 v[140:143], a[136:139], a[40:43], v[140:143]
ds_read_b128 a[120:123], v5 offset:55296
v_mfma_f32_16x16x32_bf16 v[156:159], a[136:139], a[44:47], v[156:159]
ds_read_b128 a[124:127], v5 offset:56320
v_mfma_f32_16x16x32_bf16 v[160:163], a[140:143], a[44:47], v[160:163]
buffer_load_dwordx4 a[36:39], v4, s[40:43], s35 offen offset:1024 sc1
v_mfma_f32_16x16x32_bf16 v[144:147], a[140:143], a[40:43], v[144:147]
s_waitcnt vmcnt(8) lgkmcnt(4)
v_mfma_f32_16x16x32_bf16 v[132:135], a[96:99], a[0:3], v[132:135]
s_cmp_eq_u32 s3, 1
s_cselect_b32 s35, 25, 17
s_lshl_b32 s35, s35, 12
v_mfma_f32_16x16x32_bf16 v[148:151], a[96:99], a[4:7], v[148:151]
ds_read_b128 a[128:131], v5 offset:57344
v_mfma_f32_16x16x32_bf16 v[152:155], a[100:103], a[4:7], v[152:155]
buffer_load_dwordx4 a[40:43], v4, s[40:43], s35 offen offset:0 sc1
v_mfma_f32_16x16x32_bf16 v[136:139], a[100:103], a[0:3], v[136:139]
ds_read_b128 a[132:135], v5 offset:58368
v_mfma_f32_16x16x32_bf16 v[140:143], a[104:107], a[0:3], v[140:143]
ds_read_b128 a[136:139], v5 offset:59392
v_mfma_f32_16x16x32_bf16 v[156:159], a[104:107], a[4:7], v[156:159]
ds_read_b128 a[140:143], v5 offset:60416
v_mfma_f32_16x16x32_bf16 v[160:163], a[108:111], a[4:7], v[160:163]
buffer_load_dwordx4 a[44:47], v4, s[40:43], s35 offen offset:1024 sc1
v_mfma_f32_16x16x32_bf16 v[144:147], a[108:111], a[0:3], v[144:147]
s_waitcnt vmcnt(8) lgkmcnt(4)
v_mfma_f32_16x16x32_bf16 v[132:135], a[112:115], a[8:11], v[132:135]
s_cmp_eq_u32 s3, 2
s_cselect_b32 s35, 26, 18
s_lshl_b32 s35, s35, 12
v_mfma_f32_16x16x32_bf16 v[148:151], a[112:115], a[12:15], v[148:151]
ds_read_b128 a[96:99], v5 offset:61440
v_mfma_f32_16x16x32_bf16 v[152:155], a[116:119], a[12:15], v[152:155]
buffer_load_dwordx4 a[0:3], v4, s[40:43], s35 offen offset:0 sc1
v_mfma_f32_16x16x32_bf16 v[136:139], a[116:119], a[8:11], v[136:139]
ds_read_b128 a[100:103], v5 offset:62464
v_mfma_f32_16x16x32_bf16 v[140:143], a[120:123], a[8:11], v[140:143]
ds_read_b128 a[104:107], v5 offset:63488
v_mfma_f32_16x16x32_bf16 v[156:159], a[120:123], a[12:15], v[156:159]
ds_read_b128 a[108:111], v5 offset:64512
v_mfma_f32_16x16x32_bf16 v[160:163], a[124:127], a[12:15], v[160:163]
buffer_load_dwordx4 a[4:7], v4, s[40:43], s35 offen offset:1024 sc1
v_mfma_f32_16x16x32_bf16 v[144:147], a[124:127], a[8:11], v[144:147]
s_waitcnt vmcnt(8) lgkmcnt(4)
v_mfma_f32_16x16x32_bf16 v[132:135], a[128:131], a[16:19], v[132:135]
s_cmp_eq_u32 s3, 3
s_cselect_b32 s35, 27, 19
s_lshl_b32 s35, s35, 12
v_mfma_f32_16x16x32_bf16 v[148:151], a[128:131], a[20:23], v[148:151]
ds_read_b128 a[112:115], v6 offset:0
v_mfma_f32_16x16x32_bf16 v[152:155], a[132:135], a[20:23], v[152:155]
buffer_load_dwordx4 a[8:11], v4, s[40:43], s35 offen offset:0 sc1
v_mfma_f32_16x16x32_bf16 v[136:139], a[132:135], a[16:19], v[136:139]
ds_read_b128 a[116:119], v6 offset:1024
v_mfma_f32_16x16x32_bf16 v[140:143], a[136:139], a[16:19], v[140:143]
ds_read_b128 a[120:123], v6 offset:2048
v_mfma_f32_16x16x32_bf16 v[156:159], a[136:139], a[20:23], v[156:159]
ds_read_b128 a[124:127], v6 offset:3072
v_mfma_f32_16x16x32_bf16 v[160:163], a[140:143], a[20:23], v[160:163]
buffer_load_dwordx4 a[12:15], v4, s[40:43], s35 offen offset:1024 sc1
v_mfma_f32_16x16x32_bf16 v[144:147], a[140:143], a[16:19], v[144:147]
s_waitcnt vmcnt(8) lgkmcnt(4)
v_mfma_f32_16x16x32_bf16 v[132:135], a[96:99], a[24:27], v[132:135]
s_cmp_eq_u32 s3, 4
s_cselect_b32 s35, 28, 20
s_lshl_b32 s35, s35, 12
v_mfma_f32_16x16x32_bf16 v[148:151], a[96:99], a[28:31], v[148:151]
ds_read_b128 a[128:131], v6 offset:4096
v_mfma_f32_16x16x32_bf16 v[152:155], a[100:103], a[28:31], v[152:155]
buffer_load_dwordx4 a[16:19], v4, s[40:43], s35 offen offset:0 sc1
v_mfma_f32_16x16x32_bf16 v[136:139], a[100:103], a[24:27], v[136:139]
ds_read_b128 a[132:135], v6 offset:5120
v_mfma_f32_16x16x32_bf16 v[140:143], a[104:107], a[24:27], v[140:143]
ds_read_b128 a[136:139], v6 offset:6144
v_mfma_f32_16x16x32_bf16 v[156:159], a[104:107], a[28:31], v[156:159]
ds_read_b128 a[140:143], v6 offset:7168
v_mfma_f32_16x16x32_bf16 v[160:163], a[108:111], a[28:31], v[160:163]
buffer_load_dwordx4 a[20:23], v4, s[40:43], s35 offen offset:1024 sc1
v_mfma_f32_16x16x32_bf16 v[144:147], a[108:111], a[24:27], v[144:147]
s_waitcnt vmcnt(8) lgkmcnt(4)
v_mfma_f32_16x16x32_bf16 v[132:135], a[112:115], a[32:35], v[132:135]
s_cmp_eq_u32 s3, 5
s_cselect_b32 s35, 29, 21
s_lshl_b32 s35, s35, 12
v_mfma_f32_16x16x32_bf16 v[148:151], a[112:115], a[36:39], v[148:151]
ds_read_b128 a[96:99], v6 offset:8192
v_mfma_f32_16x16x32_bf16 v[152:155], a[116:119], a[36:39], v[152:155]
buffer_load_dwordx4 a[24:27], v4, s[40:43], s35 offen offset:0 sc1
v_mfma_f32_16x16x32_bf16 v[136:139], a[116:119], a[32:35], v[136:139]
ds_read_b128 a[100:103], v6 offset:9216
v_mfma_f32_16x16x32_bf16 v[140:143], a[120:123], a[32:35], v[140:143]
ds_read_b128 a[104:107], v6 offset:10240
v_mfma_f32_16x16x32_bf16 v[156:159], a[120:123], a[36:39], v[156:159]
ds_read_b128 a[108:111], v6 offset:11264
v_mfma_f32_16x16x32_bf16 v[160:163], a[124:127], a[36:39], v[160:163]
buffer_load_dwordx4 a[28:31], v4, s[40:43], s35 offen offset:1024 sc1
v_mfma_f32_16x16x32_bf16 v[144:147], a[124:127], a[32:35], v[144:147]
s_waitcnt vmcnt(8) lgkmcnt(4)
v_mfma_f32_16x16x32_bf16 v[132:135], a[128:131], a[40:43], v[132:135]
s_cmp_eq_u32 s3, 6
s_cselect_b32 s35, 30, 22
s_lshl_b32 s35, s35, 12
v_mfma_f32_16x16x32_bf16 v[148:151], a[128:131], a[44:47], v[148:151]
ds_read_b128 a[112:115], v6 offset:12288
v_mfma_f32_16x16x32_bf16 v[152:155], a[132:135], a[44:47], v[152:155]
buffer_load_dwordx4 a[32:35], v4, s[40:43], s35 offen offset:0 sc1
v_mfma_f32_16x16x32_bf16 v[136:139], a[132:135], a[40:43], v[136:139]
ds_read_b128 a[116:119], v6 offset:13312
v_mfma_f32_16x16x32_bf16 v[140:143], a[136:139], a[40:43], v[140:143]
ds_read_b128 a[120:123], v6 offset:14336
v_mfma_f32_16x16x32_bf16 v[156:159], a[136:139], a[44:47], v[156:159]
ds_read_b128 a[124:127], v6 offset:15360
v_mfma_f32_16x16x32_bf16 v[160:163], a[140:143], a[44:47], v[160:163]
buffer_load_dwordx4 a[36:39], v4, s[40:43], s35 offen offset:1024 sc1
v_mfma_f32_16x16x32_bf16 v[144:147], a[140:143], a[40:43], v[144:147]
s_waitcnt vmcnt(8) lgkmcnt(4)
v_mfma_f32_16x16x32_bf16 v[132:135], a[96:99], a[0:3], v[132:135]
s_cmp_eq_u32 s3, 7
s_cselect_b32 s35, 31, 23
s_lshl_b32 s35, s35, 12
v_mfma_f32_16x16x32_bf16 v[148:151], a[96:99], a[4:7], v[148:151]
ds_read_b128 a[128:131], v6 offset:16384
v_mfma_f32_16x16x32_bf16 v[152:155], a[100:103], a[4:7], v[152:155]
buffer_load_dwordx4 a[40:43], v4, s[40:43], s35 offen offset:0 sc1
v_mfma_f32_16x16x32_bf16 v[136:139], a[100:103], a[0:3], v[136:139]
ds_read_b128 a[132:135], v6 offset:17408
v_mfma_f32_16x16x32_bf16 v[140:143], a[104:107], a[0:3], v[140:143]
ds_read_b128 a[136:139], v6 offset:18432
v_mfma_f32_16x16x32_bf16 v[156:159], a[104:107], a[4:7], v[156:159]
ds_read_b128 a[140:143], v6 offset:19456
v_mfma_f32_16x16x32_bf16 v[160:163], a[108:111], a[4:7], v[160:163]
buffer_load_dwordx4 a[44:47], v4, s[40:43], s35 offen offset:1024 sc1
v_mfma_f32_16x16x32_bf16 v[144:147], a[108:111], a[0:3], v[144:147]
s_waitcnt vmcnt(8) lgkmcnt(4)
v_mfma_f32_16x16x32_bf16 v[132:135], a[112:115], a[8:11], v[132:135]
s_cmp_eq_u32 s3, 0
s_cselect_b32 s35, 0, 24
s_lshl_b32 s35, s35, 12
v_mfma_f32_16x16x32_bf16 v[148:151], a[112:115], a[12:15], v[148:151]
ds_read_b128 a[96:99], v6 offset:20480
v_mfma_f32_16x16x32_bf16 v[152:155], a[116:119], a[12:15], v[152:155]
buffer_load_dwordx4 a[0:3], v4, s[40:43], s35 offen offset:0 sc1
v_mfma_f32_16x16x32_bf16 v[136:139], a[116:119], a[8:11], v[136:139]
ds_read_b128 a[100:103], v6 offset:21504
v_mfma_f32_16x16x32_bf16 v[140:143], a[120:123], a[8:11], v[140:143]
ds_read_b128 a[104:107], v6 offset:22528
v_mfma_f32_16x16x32_bf16 v[156:159], a[120:123], a[12:15], v[156:159]
ds_read_b128 a[108:111], v6 offset:23552
v_mfma_f32_16x16x32_bf16 v[160:163], a[124:127], a[12:15], v[160:163]
buffer_load_dwordx4 a[4:7], v4, s[40:43], s35 offen offset:1024 sc1
v_mfma_f32_16x16x32_bf16 v[144:147], a[124:127], a[8:11], v[144:147]
s_waitcnt vmcnt(8) lgkmcnt(4)
v_mfma_f32_16x16x32_bf16 v[132:135], a[128:131], a[16:19], v[132:135]
s_cmp_eq_u32 s3, 1
s_cselect_b32 s35, 1, 25
s_lshl_b32 s35, s35, 12
v_mfma_f32_16x16x32_bf16 v[148:151], a[128:131], a[20:23], v[148:151]
ds_read_b128 a[112:115], v6 offset:24576
v_mfma_f32_16x16x32_bf16 v[152:155], a[132:135], a[20:23], v[152:155]
buffer_load_dwordx4 a[8:11], v4, s[40:43], s35 offen offset:0 sc1
v_mfma_f32_16x16x32_bf16 v[136:139], a[132:135], a[16:19], v[136:139]
ds_read_b128 a[116:119], v6 offset:25600
v_mfma_f32_16x16x32_bf16 v[140:143], a[136:139], a[16:19], v[140:143]
ds_read_b128 a[120:123], v6 offset:26624
v_mfma_f32_16x16x32_bf16 v[156:159], a[136:139], a[20:23], v[156:159]
ds_read_b128 a[124:127], v6 offset:27648
v_mfma_f32_16x16x32_bf16 v[160:163], a[140:143], a[20:23], v[160:163]
buffer_load_dwordx4 a[12:15], v4, s[40:43], s35 offen offset:1024 sc1
v_mfma_f32_16x16x32_bf16 v[144:147], a[140:143], a[16:19], v[144:147]
s_waitcnt vmcnt(8) lgkmcnt(4)
v_mfma_f32_16x16x32_bf16 v[132:135], a[96:99], a[24:27], v[132:135]
s_cmp_eq_u32 s3, 2
s_cselect_b32 s35, 2, 26
s_lshl_b32 s35, s35, 12
v_mfma_f32_16x16x32_bf16 v[148:151], a[96:99], a[28:31], v[148:151]
ds_read_b128 a[128:131], v6 offset:28672
v_mfma_f32_16x16x32_bf16 v[152:155], a[100:103], a[28:31], v[152:155]
buffer_load_dwordx4 a[16:19], v4, s[40:43], s35 offen offset:0 sc1
v_mfma_f32_16x16x32_bf16 v[136:139], a[100:103], a[24:27], v[136:139]
ds_read_b128 a[132:135], v6 offset:29696
v_mfma_f32_16x16x32_bf16 v[140:143], a[104:107], a[24:27], v[140:143]
ds_read_b128 a[136:139], v6 offset:30720
v_mfma_f32_16x16x32_bf16 v[156:159], a[104:107], a[28:31], v[156:159]
ds_read_b128 a[140:143], v6 offset:31744
v_mfma_f32_16x16x32_bf16 v[160:163], a[108:111], a[28:31], v[160:163]
buffer_load_dwordx4 a[20:23], v4, s[40:43], s35 offen offset:1024 sc1
v_mfma_f32_16x16x32_bf16 v[144:147], a[108:111], a[24:27], v[144:147]
s_waitcnt vmcnt(8) lgkmcnt(4)
v_mfma_f32_16x16x32_bf16 v[132:135], a[112:115], a[32:35], v[132:135]
s_cmp_eq_u32 s3, 3
s_cselect_b32 s35, 3, 27
s_lshl_b32 s35, s35, 12
v_mfma_f32_16x16x32_bf16 v[148:151], a[112:115], a[36:39], v[148:151]
ds_read_b128 a[96:99], v6 offset:32768
v_mfma_f32_16x16x32_bf16 v[152:155], a[116:119], a[36:39], v[152:155]
buffer_load_dwordx4 a[24:27], v4, s[40:43], s35 offen offset:0 sc1
v_mfma_f32_16x16x32_bf16 v[136:139], a[116:119], a[32:35], v[136:139]
ds_read_b128 a[100:103], v6 offset:33792
v_mfma_f32_16x16x32_bf16 v[140:143], a[120:123], a[32:35], v[140:143]
ds_read_b128 a[104:107], v6 offset:34816
v_mfma_f32_16x16x32_bf16 v[156:159], a[120:123], a[36:39], v[156:159]
ds_read_b128 a[108:111], v6 offset:35840
v_mfma_f32_16x16x32_bf16 v[160:163], a[124:127], a[36:39], v[160:163]
buffer_load_dwordx4 a[28:31], v4, s[40:43], s35 offen offset:1024 sc1
v_mfma_f32_16x16x32_bf16 v[144:147], a[124:127], a[32:35], v[144:147]
s_waitcnt vmcnt(8) lgkmcnt(4)
v_mfma_f32_16x16x32_bf16 v[132:135], a[128:131], a[40:43], v[132:135]
s_cmp_eq_u32 s3, 4
s_cselect_b32 s35, 4, 28
s_lshl_b32 s35, s35, 12
v_mfma_f32_16x16x32_bf16 v[148:151], a[128:131], a[44:47], v[148:151]
ds_read_b128 a[112:115], v6 offset:36864
v_mfma_f32_16x16x32_bf16 v[152:155], a[132:135], a[44:47], v[152:155]
buffer_load_dwordx4 a[32:35], v4, s[40:43], s35 offen offset:0 sc1
v_mfma_f32_16x16x32_bf16 v[136:139], a[132:135], a[40:43], v[136:139]
ds_read_b128 a[116:119], v6 offset:37888
v_mfma_f32_16x16x32_bf16 v[140:143], a[136:139], a[40:43], v[140:143]
ds_read_b128 a[120:123], v6 offset:38912
v_mfma_f32_16x16x32_bf16 v[156:159], a[136:139], a[44:47], v[156:159]
ds_read_b128 a[124:127], v6 offset:39936
v_mfma_f32_16x16x32_bf16 v[160:163], a[140:143], a[44:47], v[160:163]
buffer_load_dwordx4 a[36:39], v4, s[40:43], s35 offen offset:1024 sc1
v_mfma_f32_16x16x32_bf16 v[144:147], a[140:143], a[40:43], v[144:147]
s_waitcnt vmcnt(8) lgkmcnt(4)
v_mfma_f32_16x16x32_bf16 v[132:135], a[96:99], a[0:3], v[132:135]
s_cmp_eq_u32 s3, 5
s_cselect_b32 s35, 5, 29
s_lshl_b32 s35, s35, 12
v_mfma_f32_16x16x32_bf16 v[148:151], a[96:99], a[4:7], v[148:151]
ds_read_b128 a[128:131], v6 offset:40960
v_mfma_f32_16x16x32_bf16 v[152:155], a[100:103], a[4:7], v[152:155]
buffer_load_dwordx4 a[40:43], v4, s[40:43], s35 offen offset:0 sc1
v_mfma_f32_16x16x32_bf16 v[136:139], a[100:103], a[0:3], v[136:139]
ds_read_b128 a[132:135], v6 offset:41984
v_mfma_f32_16x16x32_bf16 v[140:143], a[104:107], a[0:3], v[140:143]
ds_read_b128 a[136:139], v6 offset:43008
v_mfma_f32_16x16x32_bf16 v[156:159], a[104:107], a[4:7], v[156:159]
ds_read_b128 a[140:143], v6 offset:44032
v_mfma_f32_16x16x32_bf16 v[160:163], a[108:111], a[4:7], v[160:163]
buffer_load_dwordx4 a[44:47], v4, s[40:43], s35 offen offset:1024 sc1
v_mfma_f32_16x16x32_bf16 v[144:147], a[108:111], a[0:3], v[144:147]
s_waitcnt vmcnt(8) lgkmcnt(4)
v_mfma_f32_16x16x32_bf16 v[132:135], a[112:115], a[8:11], v[132:135]
s_cmp_eq_u32 s3, 6
s_cselect_b32 s35, 6, 30
s_lshl_b32 s35, s35, 12
v_mfma_f32_16x16x32_bf16 v[148:151], a[112:115], a[12:15], v[148:151]
ds_read_b128 a[96:99], v6 offset:45056
v_mfma_f32_16x16x32_bf16 v[152:155], a[116:119], a[12:15], v[152:155]
buffer_load_dwordx4 a[0:3], v4, s[40:43], s35 offen offset:0 sc1
v_mfma_f32_16x16x32_bf16 v[136:139], a[116:119], a[8:11], v[136:139]
ds_read_b128 a[100:103], v6 offset:46080
v_mfma_f32_16x16x32_bf16 v[140:143], a[120:123], a[8:11], v[140:143]
ds_read_b128 a[104:107], v6 offset:47104
v_mfma_f32_16x16x32_bf16 v[156:159], a[120:123], a[12:15], v[156:159]
ds_read_b128 a[108:111], v6 offset:48128
v_mfma_f32_16x16x32_bf16 v[160:163], a[124:127], a[12:15], v[160:163]
buffer_load_dwordx4 a[4:7], v4, s[40:43], s35 offen offset:1024 sc1
v_mfma_f32_16x16x32_bf16 v[144:147], a[124:127], a[8:11], v[144:147]
s_waitcnt vmcnt(8) lgkmcnt(4)
v_mfma_f32_16x16x32_bf16 v[132:135], a[128:131], a[16:19], v[132:135]
s_cmp_eq_u32 s3, 7
s_cselect_b32 s35, 7, 31
s_lshl_b32 s35, s35, 12
v_mfma_f32_16x16x32_bf16 v[148:151], a[128:131], a[20:23], v[148:151]
ds_read_b128 a[112:115], v6 offset:49152
v_mfma_f32_16x16x32_bf16 v[152:155], a[132:135], a[20:23], v[152:155]
buffer_load_dwordx4 a[8:11], v4, s[40:43], s35 offen offset:0 sc1
v_mfma_f32_16x16x32_bf16 v[136:139], a[132:135], a[16:19], v[136:139]
ds_read_b128 a[116:119], v6 offset:50176
v_mfma_f32_16x16x32_bf16 v[140:143], a[136:139], a[16:19], v[140:143]
ds_read_b128 a[120:123], v6 offset:51200
v_mfma_f32_16x16x32_bf16 v[156:159], a[136:139], a[20:23], v[156:159]
ds_read_b128 a[124:127], v6 offset:52224
v_mfma_f32_16x16x32_bf16 v[160:163], a[140:143], a[20:23], v[160:163]
buffer_load_dwordx4 a[12:15], v4, s[40:43], s35 offen offset:1024 sc1
v_mfma_f32_16x16x32_bf16 v[144:147], a[140:143], a[16:19], v[144:147]
s_waitcnt vmcnt(8) lgkmcnt(4)
v_mfma_f32_16x16x32_bf16 v[132:135], a[96:99], a[24:27], v[132:135]
ds_read_b128 a[128:131], v6 offset:53248
v_mfma_f32_16x16x32_bf16 v[148:151], a[96:99], a[28:31], v[148:151]
ds_read_b128 a[132:135], v6 offset:54272
v_mfma_f32_16x16x32_bf16 v[152:155], a[100:103], a[28:31], v[152:155]
ds_read_b128 a[136:139], v6 offset:55296
v_mfma_f32_16x16x32_bf16 v[136:139], a[100:103], a[24:27], v[136:139]
ds_read_b128 a[140:143], v6 offset:56320
v_mfma_f32_16x16x32_bf16 v[140:143], a[104:107], a[24:27], v[140:143]
v_mfma_f32_16x16x32_bf16 v[156:159], a[104:107], a[28:31], v[156:159]
v_mfma_f32_16x16x32_bf16 v[160:163], a[108:111], a[28:31], v[160:163]
v_mfma_f32_16x16x32_bf16 v[144:147], a[108:111], a[24:27], v[144:147]
s_waitcnt vmcnt(6) lgkmcnt(4)
v_mfma_f32_16x16x32_bf16 v[132:135], a[112:115], a[32:35], v[132:135]
ds_read_b128 a[96:99], v6 offset:57344
v_mfma_f32_16x16x32_bf16 v[148:151], a[112:115], a[36:39], v[148:151]
ds_read_b128 a[100:103], v6 offset:58368
v_mfma_f32_16x16x32_bf16 v[152:155], a[116:119], a[36:39], v[152:155]
ds_read_b128 a[104:107], v6 offset:59392
v_mfma_f32_16x16x32_bf16 v[136:139], a[116:119], a[32:35], v[136:139]
ds_read_b128 a[108:111], v6 offset:60416
v_mfma_f32_16x16x32_bf16 v[140:143], a[120:123], a[32:35], v[140:143]
v_mfma_f32_16x16x32_bf16 v[156:159], a[120:123], a[36:39], v[156:159]
v_mfma_f32_16x16x32_bf16 v[160:163], a[124:127], a[36:39], v[160:163]
v_mfma_f32_16x16x32_bf16 v[144:147], a[124:127], a[32:35], v[144:147]
s_waitcnt vmcnt(4) lgkmcnt(4)
v_mfma_f32_16x16x32_bf16 v[132:135], a[128:131], a[40:43], v[132:135]
ds_read_b128 a[112:115], v6 offset:61440
v_mfma_f32_16x16x32_bf16 v[148:151], a[128:131], a[44:47], v[148:151]
ds_read_b128 a[116:119], v6 offset:62464
v_mfma_f32_16x16x32_bf16 v[152:155], a[132:135], a[44:47], v[152:155]
ds_read_b128 a[120:123], v6 offset:63488
v_mfma_f32_16x16x32_bf16 v[136:139], a[132:135], a[40:43], v[136:139]
ds_read_b128 a[124:127], v6 offset:64512
v_mfma_f32_16x16x32_bf16 v[140:143], a[136:139], a[40:43], v[140:143]
v_mfma_f32_16x16x32_bf16 v[156:159], a[136:139], a[44:47], v[156:159]
v_mfma_f32_16x16x32_bf16 v[160:163], a[140:143], a[44:47], v[160:163]
v_mfma_f32_16x16x32_bf16 v[144:147], a[140:143], a[40:43], v[144:147]
s_waitcnt vmcnt(2) lgkmcnt(4)
v_mfma_f32_16x16x32_bf16 v[132:135], a[96:99], a[0:3], v[132:135]
v_mfma_f32_16x16x32_bf16 v[148:151], a[96:99], a[4:7], v[148:151]
v_mfma_f32_16x16x32_bf16 v[152:155], a[100:103], a[4:7], v[152:155]
v_mfma_f32_16x16x32_bf16 v[136:139], a[100:103], a[0:3], v[136:139]
v_mfma_f32_16x16x32_bf16 v[140:143], a[104:107], a[0:3], v[140:143]
v_mfma_f32_16x16x32_bf16 v[156:159], a[104:107], a[4:7], v[156:159]
v_mfma_f32_16x16x32_bf16 v[160:163], a[108:111], a[4:7], v[160:163]
v_mfma_f32_16x16x32_bf16 v[144:147], a[108:111], a[0:3], v[144:147]
s_waitcnt vmcnt(0) lgkmcnt(0)
v_mfma_f32_16x16x32_bf16 v[132:135], a[112:115], a[8:11], v[132:135]
v_mfma_f32_16x16x32_bf16 v[148:151], a[112:115], a[12:15], v[148:151]
v_mfma_f32_16x16x32_bf16 v[152:155], a[116:119], a[12:15], v[152:155]
v_mfma_f32_16x16x32_bf16 v[136:139], a[116:119], a[8:11], v[136:139]
v_mfma_f32_16x16x32_bf16 v[140:143], a[120:123], a[8:11], v[140:143]
v_mfma_f32_16x16x32_bf16 v[156:159], a[120:123], a[12:15], v[156:159]
v_mfma_f32_16x16x32_bf16 v[160:163], a[124:127], a[12:15], v[160:163]
v_mfma_f32_16x16x32_bf16 v[144:147], a[124:127], a[8:11], v[144:147]
s_nop 0
v_cvt_pk_bf16_f32 v32, v132, v133
v_cvt_pk_bf16_f32 v33, v134, v135
s_nop 0
v_cvt_pk_bf16_f32 v34, v136, v137
v_cvt_pk_bf16_f32 v35, v138, v139
v_cvt_pk_bf16_f32 v36, v140, v141
v_cvt_pk_bf16_f32 v37, v142, v143
v_cvt_pk_bf16_f32 v38, v144, v145
v_cvt_pk_bf16_f32 v39, v146, v147
v_cvt_pk_bf16_f32 v40, v148, v149
v_cvt_pk_bf16_f32 v41, v150, v151
v_cvt_pk_bf16_f32 v42, v152, v153
v_cvt_pk_bf16_f32 v43, v154, v155
v_cvt_pk_bf16_f32 v44, v156, v157
v_cvt_pk_bf16_f32 v45, v158, v159
v_cvt_pk_bf16_f32 v46, v160, v161
v_cvt_pk_bf16_f32 v47, v162, v163
s_lshl_b32 s36, s32, 13
s_add_u32 s36, s36, 0x2200000
s_add_u32 s37, s36, 4096
s_mov_b32 s38, 0x2c0000
v_mfma_f32_16x16x32_bf16 v[96:99], v[32:35], v[32:35], 0
v_mfma_f32_16x16x32_bf16 v[92:95], v[16:19], v[32:35], 0
buffer_store_dwordx4 v[32:35], v4, s[4:7], s36 offen offset:0 sc1
v_mfma_f32_16x16x32_bf16 v[104:107], v[40:43], v[40:43], 0
v_mfma_f32_16x16x32_bf16 v[100:103], v[16:19], v[40:43], 0
buffer_store_dwordx4 v[40:43], v4, s[4:7], s36 offen offset:1024 sc1
v_mfma_f32_16x16x32_bf16 v[96:99], v[36:39], v[36:39], v[96:99]
v_mfma_f32_16x16x32_bf16 v[92:95], v[16:19], v[36:39], v[92:95]
buffer_store_dwordx4 v[36:39], v4, s[4:7], s37 offen offset:0 sc1
v_mfma_f32_16x16x32_bf16 v[104:107], v[44:47], v[44:47], v[104:107]
v_mfma_f32_16x16x32_bf16 v[100:103], v[16:19], v[44:47], v[100:103]
buffer_store_dwordx4 v[44:47], v4, s[4:7], s37 offen offset:1024 sc1
s_nop 2
v_cndmask_b32 v96, v96, v97, s[46:47]
v_cndmask_b32 v98, v98, v99, s[46:47]
v_cndmask_b32 v93, v96, v98, s[48:49]
buffer_store_dwordx2 v[92:93], v253, s[4:7], s38 offen offset:0 sc1
v_cndmask_b32 v104, v104, v105, s[46:47]
v_cndmask_b32 v106, v106, v107, s[46:47]
v_cndmask_b32 v101, v104, v106, s[48:49]
buffer_store_dwordx2 v[100:101], v253, s[4:7], s38 offen offset:2048 sc1
s_add_u32 s92, s78, 0x60000
s_add_u32 s93, s79, 0x60000
s_add_u32 s40, s4, 0x2200000
s_addc_u32 s41, s5, 0
s_barrier
s_add_u32 s44, s28, 0
s_mul_i32 s45, s44, 3072
s_add_u32 m0, s45, 0
s_lshr_b32 s44, s44, 1
s_add_u32 s44, s44, 0
s_mul_i32 s44, s44, 6144
s_add_u32 s44, s44, s50
s_add_u32 s44, s44, 0x600000
buffer_load_dwordx4 v1, s[4:7], s44 offen offset:0 sc1 lds
buffer_load_dwordx4 v1, s[4:7], s44 offen offset:1024 sc1 lds
buffer_load_dwordx4 v1, s[4:7], s44 offen offset:2048 sc1 lds
s_add_u32 s44, s28, 4
s_mul_i32 s45, s44, 3072
s_add_u32 m0, s45, 0
s_lshr_b32 s44, s44, 1
s_add_u32 s44, s44, 0
s_mul_i32 s44, s44, 6144
s_add_u32 s44, s44, s50
s_add_u32 s44, s44, 0x600000
buffer_load_dwordx4 v1, s[4:7], s44 offen offset:0 sc1 lds
buffer_load_dwordx4 v1, s[4:7], s44 offen offset:1024 sc1 lds
buffer_load_dwordx4 v1, s[4:7], s44 offen offset:2048 sc1 lds
s_add_u32 s44, s28, 8
s_mul_i32 s45, s44, 3072
s_add_u32 m0, s45, 0
s_lshr_b32 s44, s44, 1
s_add_u32 s44, s44, 0
s_mul_i32 s44, s44, 6144
s_add_u32 s44, s44, s50
s_add_u32 s44, s44, 0x600000
buffer_load_dwordx4 v1, s[4:7], s44 offen offset:0 sc1 lds
buffer_load_dwordx4 v1, s[4:7], s44 offen offset:1024 sc1 lds
buffer_load_dwordx4 v1, s[4:7], s44 offen offset:2048 sc1 lds
s_add_u32 s44, s28, 12
s_mul_i32 s45, s44, 3072
s_add_u32 m0, s45, 0
s_lshr_b32 s44, s44, 1
s_add_u32 s44, s44, 0
s_mul_i32 s44, s44, 6144
s_add_u32 s44, s44, s50
s_add_u32 s44, s44, 0x600000
buffer_load_dwordx4 v1, s[4:7], s44 offen offset:0 sc1 lds
buffer_load_dwordx4 v1, s[4:7], s44 offen offset:1024 sc1 lds
buffer_load_dwordx4 v1, s[4:7], s44 offen offset:2048 sc1 lds
s_waitcnt vmcnt(12)
s_barrier
s_cmp_lg_u32 s28, 1
s_cbranch_scc1 Lsg_33
buffer_atomic_add v12, v10, s[4:7], s92 offen sc1
Lsg_33:
s_cmp_lg_u32 s28, 1
s_cbranch_scc1 L_wskip6
s_mov_b64 exec, 0
s_branch L_stub15
L_wret6:
s_mov_b64 exec, -1
L_wskip6:
s_cmp_lt_u32 s28, 2
s_cbranch_scc1 Lwd_34
s_add_u32 s44, s28, 0
s_mul_i32 s45, s44, 3072
s_add_u32 m0, s45, 49152
s_lshr_b32 s44, s44, 1
s_add_u32 s44, s44, 8
s_mul_i32 s44, s44, 6144
s_add_u32 s44, s44, s50
s_add_u32 s44, s44, 0x600000
buffer_load_dwordx4 v1, s[4:7], s44 offen offset:0 sc1 lds
buffer_load_dwordx4 v1, s[4:7], s44 offen offset:1024 sc1 lds
buffer_load_dwordx4 v1, s[4:7], s44 offen offset:2048 sc1 lds
L_stub15:
s_cbranch_execz L_stub16
s_sub_u32 s44, s28, 2
s_mul_i32 s45, s44, 3072
s_add_u32 m0, s45, 49152
s_lshr_b32 s44, s44, 1
s_add_u32 s44, s44, 8
s_mul_i32 s44, s44, 6144
s_add_u32 s44, s44, s50
s_add_u32 s44, s44, 0x600000
buffer_load_dwordx4 v1, s[4:7], s44 offen offset:0 sc1 lds
buffer_load_dwordx4 v1, s[4:7], s44 offen offset:1024 sc1 lds
buffer_load_dwordx4 v1, s[4:7], s44 offen offset:2048 sc1 lds
s_add_u32 s44, s28, 4
s_mul_i32 s45, s44, 3072
s_add_u32 m0, s45, 49152
s_lshr_b32 s44, s44, 1
s_add_u32 s44, s44, 8
s_mul_i32 s44, s44, 6144
s_add_u32 s44, s44, s50
s_add_u32 s44, s44, 0x600000
buffer_load_dwordx4 v1, s[4:7], s44 offen offset:0 sc1 lds
buffer_load_dwordx4 v1, s[4:7], s44 offen offset:1024 sc1 lds
buffer_load_dwordx4 v1, s[4:7], s44 offen offset:2048 sc1 lds
s_add_u32 s44, s28, 2
s_mul_i32 s45, s44, 3072
s_add_u32 m0, s45, 49152
s_lshr_b32 s44, s44, 1
s_add_u32 s44, s44, 8
s_mul_i32 s44, s44, 6144
s_add_u32 s44, s44, s50
s_add_u32 s44, s44, 0x600000
buffer_load_dwordx4 v1, s[4:7], s44 offen offset:0 sc1 lds
buffer_load_dwordx4 v1, s[4:7], s44 offen offset:1024 sc1 lds
buffer_load_dwordx4 v1, s[4:7], s44 offen offset:2048 sc1 lds
s_add_u32 s44, s28, 8
s_mul_i32 s45, s44, 3072
s_add_u32 m0, s45, 49152
s_lshr_b32 s44, s44, 1
s_add_u32 s44, s44, 8
s_mul_i32 s44, s44, 6144
s_add_u32 s44, s44, s50
s_add_u32 s44, s44, 0x600000
buffer_load_dwordx4 v1, s[4:7], s44 offen offset:0 sc1 lds
buffer_load_dwordx4 v1, s[4:7], s44 offen offset:1024 sc1 lds
buffer_load_dwordx4 v1, s[4:7], s44 offen offset:2048 sc1 lds
s_add_u32 s44, s28, 6
s_mul_i32 s45, s44, 3072
s_add_u32 m0, s45, 49152
s_lshr_b32 s44, s44, 1
s_add_u32 s44, s44, 8
s_mul_i32 s44, s44, 6144
s_add_u32 s44, s44, s50
s_add_u32 s44, s44, 0x600000
buffer_load_dwordx4 v1, s[4:7], s44 offen offset:0 sc1 lds
buffer_load_dwordx4 v1, s[4:7], s44 offen offset:1024 sc1 lds
buffer_load_dwordx4 v1, s[4:7], s44 offen offset:2048 sc1 lds
s_add_u32 s44, s28, 12
s_mul_i32 s45, s44, 3072
s_add_u32 m0, s45, 49152
s_lshr_b32 s44, s44, 1
s_add_u32 s44, s44, 8
s_mul_i32 s44, s44, 6144
s_add_u32 s44, s44, s50
s_add_u32 s44, s44, 0x600000
buffer_load_dwordx4 v1, s[4:7], s44 offen offset:0 sc1 lds
buffer_load_dwordx4 v1, s[4:7], s44 offen offset:1024 sc1 lds
buffer_load_dwordx4 v1, s[4:7], s44 offen offset:2048 sc1 lds
s_add_u32 s44, s28, 10
s_mul_i32 s45, s44, 3072
s_add_u32 m0, s45, 49152
s_lshr_b32 s44, s44, 1
s_add_u32 s44, s44, 8
s_mul_i32 s44, s44, 6144
s_add_u32 s44, s44, s50
s_add_u32 s44, s44, 0x600000
buffer_load_dwordx4 v1, s[4:7], s44 offen offset:0 sc1 lds
buffer_load_dwordx4 v1, s[4:7], s44 offen offset:1024 sc1 lds
buffer_load_dwordx4 v1, s[4:7], s44 offen offset:2048 sc1 lds
Lwd_34:
s_cmp_lg_u32 s28, 0
s_cbranch_scc1 Lpe_36
s_add_u32 s36, s67, 0x60000
s_mov_b32 s37, 0
Lpoll_35:
v_mov_b32 v11, 0
s_mov_b64 exec, 1
buffer_atomic_add v11, off, s[4:7], s36 sc0 sc1
s_waitcnt vmcnt(0)
v_readfirstlane_b32 s38, v11
s_mov_b64 exec, -1
s_nop 0
v_mov_b32 v11, s38
s_add_u32 s37, s37, 1
v_cmp_gt_u32 vcc, 32, v11
s_cbranch_vccz Lpe_36
s_cmp_lt_u32 s37, 0x100000
s_cbranch_scc1 Lpoll_35
Lpe_36:
s_waitcnt vmcnt(24)
s_cmp_ge_u32 s28, 2
s_cbranch_scc1 Lw_37
s_waitcnt vmcnt(0)
Lw_37:
s_barrier
s_add_u32 s94, s80, 0x90080
s_lshl_b32 s35, s33, 12
buffer_load_dwordx4 a[0:3], v2, s[40:43], s35 offen offset:0 sc1
buffer_load_dwordx4 a[4:7], v2, s[40:43], s35 offen offset:1024 sc1
buffer_load_dwordx4 a[8:11], v2, s[40:43], s35 offen offset:2048 sc1
buffer_load_dwordx4 a[12:15], v2, s[40:43], s35 offen offset:3072 sc1
s_add_u32 s35, s35, 4096
buffer_load_dwordx4 a[16:19], v2, s[40:43], s35 offen offset:0 sc1
buffer_load_dwordx4 a[20:23], v2, s[40:43], s35 offen offset:1024 sc1
buffer_load_dwordx4 a[24:27], v2, s[40:43], s35 offen offset:2048 sc1
buffer_load_dwordx4 a[28:31], v2, s[40:43], s35 offen offset:3072 sc1
s_add_u32 s35, s35, 4096
buffer_load_dwordx4 a[32:35], v2, s[40:43], s35 offen offset:0 sc1
buffer_load_dwordx4 a[36:39], v2, s[40:43], s35 offen offset:1024 sc1
buffer_load_dwordx4 a[40:43], v2, s[40:43], s35 offen offset:2048 sc1
buffer_load_dwordx4 a[44:47], v2, s[40:43], s35 offen offset:3072 sc1
s_add_u32 s35, s35, 4096
v_add_u32 v5, 0, v1
ds_read_b128 a[96:99], v5 offset:0
ds_read_b128 a[100:103], v5 offset:1024
ds_read_b128 a[104:107], v5 offset:2048
ds_read_b128 a[108:111], v5 offset:3072
ds_read_b128 a[112:115], v5 offset:4096
ds_read_b128 a[116:119], v5 offset:5120
s_waitcnt vmcnt(8) lgkmcnt(0)
v_mfma_f32_16x16x32_bf16 v[132:135], a[96:99], a[0:3], 0
s_add_u32 s44, s28, 0
s_mul_i32 s45, s44, 3072
s_add_u32 m0, s45, 98304
v_mfma_f32_16x16x32_bf16 v[156:159], a[96:99], a[4:7], 0
buffer_load_dwordx4 a[48:51], v2, s[40:43], s35 offen offset:0 sc1
s_lshr_b32 s44, s44, 1
v_mfma_f32_16x16x32_bf16 v[180:183], a[96:99], a[8:11], 0
s_add_u32 s44, s44, 16
s_mul_i32 s44, s44, 6144
s_add_u32 s44, s44, s50
v_mfma_f32_16x16x32_bf16 v[204:207], a[96:99], a[12:15], 0
s_add_u32 s44, s44, 0x600000
ds_read_b128 a[128:131], v5 offset:6144
v_mfma_f32_16x16x32_bf16 v[208:211], a[100:103], a[12:15], 0
ds_read_b128 a[132:135], v5 offset:7168
v_mfma_f32_16x16x32_bf16 v[184:187], a[100:103], a[8:11], 0
buffer_load_dwordx4 v1, s[4:7], s44 offen offset:0 sc1 lds
v_mfma_f32_16x16x32_bf16 v[160:163], a[100:103], a[4:7], 0
ds_read_b128 a[136:139], v5 offset:8192
v_mfma_f32_16x16x32_bf16 v[136:139], a[100:103], a[0:3], 0
v_mfma_f32_16x16x32_bf16 v[140:143], a[104:107], a[0:3], 0
ds_read_b128 a[140:143], v5 offset:9216
v_mfma_f32_16x16x32_bf16 v[164:167], a[104:107], a[4:7], 0
buffer_load_dwordx4 a[52:55], v2, s[40:43], s35 offen offset:1024 sc1
v_mfma_f32_16x16x32_bf16 v[188:191], a[104:107], a[8:11], 0
ds_read_b128 a[144:147], v5 offset:10240
v_mfma_f32_16x16x32_bf16 v[212:215], a[104:107], a[12:15], 0
v_mfma_f32_16x16x32_bf16 v[216:219], a[108:111], a[12:15], 0
v_mfma_f32_16x16x32_bf16 v[192:195], a[108:111], a[8:11], 0
buffer_load_dwordx4 a[56:59], v2, s[40:43], s35 offen offset:2048 sc1
v_mfma_f32_16x16x32_bf16 v[168:171], a[108:111], a[4:7], 0
ds_read_b128 a[148:151], v5 offset:11264
v_mfma_f32_16x16x32_bf16 v[144:147], a[108:111], a[0:3], 0
v_mfma_f32_16x16x32_bf16 v[148:151], a[112:115], a[0:3], 0
v_mfma_f32_16x16x32_bf16 v[172:175], a[112:115], a[4:7], 0
buffer_load_dwordx4 v1, s[4:7], s44 offen offset:1024 sc1 lds
v_mfma_f32_16x16x32_bf16 v[196:199], a[112:115], a[8:11], 0
v_mfma_f32_16x16x32_bf16 v[220:223], a[112:115], a[12:15], 0
v_mfma_f32_16x16x32_bf16 v[224:227], a[116:119], a[12:15], 0
v_mfma_f32_16x16x32_bf16 v[200:203], a[116:119], a[8:11], 0
buffer_load_dwordx4 a[60:63], v2, s[40:43], s35 offen offset:3072 sc1
s_add_u32 s35, s35, 4096
v_mfma_f32_16x16x32_bf16 v[176:179], a[116:119], a[4:7], 0
v_mfma_f32_16x16x32_bf16 v[152:155], a[116:119], a[0:3], 0
s_waitcnt vmcnt(10) lgkmcnt(0)
v_mfma_f32_16x16x32_bf16 v[132:135], a[128:131], a[16:19], v[132:135]
ds_read_b128 a[96:99], v5 offset:12288
v_mfma_f32_16x16x32_bf16 v[156:159], a[128:131], a[20:23], v[156:159]
buffer_load_dwordx4 a[0:3], v2, s[40:43], s35 offen offset:0 sc1
v_mfma_f32_16x16x32_bf16 v[180:183], a[128:131], a[24:27], v[180:183]
ds_read_b128 a[100:103], v5 offset:13312
v_mfma_f32_16x16x32_bf16 v[204:207], a[128:131], a[28:31], v[204:207]
v_mfma_f32_16x16x32_bf16 v[208:211], a[132:135], a[28:31], v[208:211]
v_mfma_f32_16x16x32_bf16 v[184:187], a[132:135], a[24:27], v[184:187]
buffer_load_dwordx4 a[4:7], v2, s[40:43], s35 offen offset:1024 sc1
v_mfma_f32_16x16x32_bf16 v[160:163], a[132:135], a[20:23], v[160:163]
ds_read_b128 a[104:107], v5 offset:14336
v_mfma_f32_16x16x32_bf16 v[136:139], a[132:135], a[16:19], v[136:139]
v_mfma_f32_16x16x32_bf16 v[140:143], a[136:139], a[16:19], v[140:143]
ds_read_b128 a[108:111], v5 offset:15360
v_mfma_f32_16x16x32_bf16 v[164:167], a[136:139], a[20:23], v[164:167]
v_mfma_f32_16x16x32_bf16 v[188:191], a[136:139], a[24:27], v[188:191]
buffer_load_dwordx4 v1, s[4:7], s44 offen offset:2048 sc1 lds
s_add_u32 s44, s28, 4
v_mfma_f32_16x16x32_bf16 v[212:215], a[136:139], a[28:31], v[212:215]
s_mul_i32 s45, s44, 3072
s_add_u32 m0, s45, 98304
s_lshr_b32 s44, s44, 1
v_mfma_f32_16x16x32_bf16 v[216:219], a[140:143], a[28:31], v[216:219]
s_add_u32 s44, s44, 16
s_mul_i32 s44, s44, 6144
s_add_u32 s44, s44, s50
v_mfma_f32_16x16x32_bf16 v[192:195], a[140:143], a[24:27], v[192:195]
s_add_u32 s44, s44, 0x600000
ds_read_b128 a[112:115], v5 offset:16384
v_mfma_f32_16x16x32_bf16 v[168:171], a[140:143], a[20:23], v[168:171]
ds_read_b128 a[116:119], v5 offset:17408
v_mfma_f32_16x16x32_bf16 v[144:147], a[140:143], a[16:19], v[144:147]
buffer_load_dwordx4 a[8:11], v2, s[40:43], s35 offen offset:2048 sc1
v_mfma_f32_16x16x32_bf16 v[148:151], a[144:147], a[16:19], v[148:151]
v_mfma_f32_16x16x32_bf16 v[172:175], a[144:147], a[20:23], v[172:175]
v_mfma_f32_16x16x32_bf16 v[196:199], a[144:147], a[24:27], v[196:199]
v_mfma_f32_16x16x32_bf16 v[220:223], a[144:147], a[28:31], v[220:223]
v_mfma_f32_16x16x32_bf16 v[224:227], a[148:151], a[28:31], v[224:227]
buffer_load_dwordx4 a[12:15], v2, s[40:43], s35 offen offset:3072 sc1
s_add_u32 s35, s35, 4096
v_mfma_f32_16x16x32_bf16 v[200:203], a[148:151], a[24:27], v[200:203]
v_mfma_f32_16x16x32_bf16 v[176:179], a[148:151], a[20:23], v[176:179]
v_mfma_f32_16x16x32_bf16 v[152:155], a[148:151], a[16:19], v[152:155]
s_waitcnt vmcnt(11) lgkmcnt(0)
v_mfma_f32_16x16x32_bf16 v[132:135], a[96:99], a[32:35], v[132:135]
ds_read_b128 a[128:131], v5 offset:18432
v_mfma_f32_16x16x32_bf16 v[156:159], a[96:99], a[36:39], v[156:159]
buffer_load_dwordx4 a[16:19], v2, s[40:43], s35 offen offset:0 sc1
v_mfma_f32_16x16x32_bf16 v[180:183], a[96:99], a[40:43], v[180:183]
ds_read_b128 a[132:135], v5 offset:19456
v_mfma_f32_16x16x32_bf16 v[204:207], a[96:99], a[44:47], v[204:207]
v_mfma_f32_16x16x32_bf16 v[208:211], a[100:103], a[44:47], v[208:211]
v_mfma_f32_16x16x32_bf16 v[184:187], a[100:103], a[40:43], v[184:187]
buffer_load_dwordx4 v1, s[4:7], s44 offen offset:0 sc1 lds
v_mfma_f32_16x16x32_bf16 v[160:163], a[100:103], a[36:39], v[160:163]
ds_read_b128 a[136:139], v5 offset:20480
v_mfma_f32_16x16x32_bf16 v[136:139], a[100:103], a[32:35], v[136:139]
v_mfma_f32_16x16x32_bf16 v[140:143], a[104:107], a[32:35], v[140:143]
ds_read_b128 a[140:143], v5 offset:21504
v_mfma_f32_16x16x32_bf16 v[164:167], a[104:107], a[36:39], v[164:167]
buffer_load_dwordx4 a[20:23], v2, s[40:43], s35 offen offset:1024 sc1
v_mfma_f32_16x16x32_bf16 v[188:191], a[104:107], a[40:43], v[188:191]
ds_read_b128 a[144:147], v5 offset:22528
v_mfma_f32_16x16x32_bf16 v[212:215], a[104:107], a[44:47], v[212:215]
v_mfma_f32_16x16x32_bf16 v[216:219], a[108:111], a[44:47], v[216:219]
v_mfma_f32_16x16x32_bf16 v[192:195], a[108:111], a[40:43], v[192:195]
buffer_load_dwordx4 a[24:27], v2, s[40:43], s35 offen offset:2048 sc1
v_mfma_f32_16x16x32_bf16 v[168:171], a[108:111], a[36:39], v[168:171]
ds_read_b128 a[148:151], v5 offset:23552
v_mfma_f32_16x16x32_bf16 v[144:147], a[108:111], a[32:35], v[144:147]
v_mfma_f32_16x16x32_bf16 v[148:151], a[112:115], a[32:35], v[148:151]
v_mfma_f32_16x16x32_bf16 v[172:175], a[112:115], a[36:39], v[172:175]
buffer_load_dwordx4 v1, s[4:7], s44 offen offset:1024 sc1 lds
v_mfma_f32_16x16x32_bf16 v[196:199], a[112:115], a[40:43], v[196:199]
v_mfma_f32_16x16x32_bf16 v[220:223], a[112:115], a[44:47], v[220:223]
v_mfma_f32_16x16x32_bf16 v[224:227], a[116:119], a[44:47], v[224:227]
v_mfma_f32_16x16x32_bf16 v[200:203], a[116:119], a[40:43], v[200:203]
buffer_load_dwordx4 a[28:31], v2, s[40:43], s35 offen offset:3072 sc1
s_add_u32 s35, s35, 4096
v_mfma_f32_16x16x32_bf16 v[176:179], a[116:119], a[36:39], v[176:179]
v_mfma_f32_16x16x32_bf16 v[152:155], a[116:119], a[32:35], v[152:155]
s_waitcnt vmcnt(11) lgkmcnt(0)
v_mfma_f32_16x16x32_bf16 v[132:135], a[128:131], a[48:51], v[132:135]
ds_read_b128 a[96:99], v5 offset:24576
v_mfma_f32_16x16x32_bf16 v[156:159], a[128:131], a[52:55], v[156:159]
buffer_load_dwordx4 a[32:35], v2, s[40:43], s35 offen offset:0 sc1
v_mfma_f32_16x16x32_bf16 v[180:183], a[128:131], a[56:59], v[180:183]
ds_read_b128 a[100:103], v5 offset:25600
v_mfma_f32_16x16x32_bf16 v[204:207], a[128:131], a[60:63], v[204:207]
v_mfma_f32_16x16x32_bf16 v[208:211], a[132:135], a[60:63], v[208:211]
v_mfma_f32_16x16x32_bf16 v[184:187], a[132:135], a[56:59], v[184:187]
buffer_load_dwordx4 a[36:39], v2, s[40:43], s35 offen offset:1024 sc1
v_mfma_f32_16x16x32_bf16 v[160:163], a[132:135], a[52:55], v[160:163]
ds_read_b128 a[104:107], v5 offset:26624
v_mfma_f32_16x16x32_bf16 v[136:139], a[132:135], a[48:51], v[136:139]
v_mfma_f32_16x16x32_bf16 v[140:143], a[136:139], a[48:51], v[140:143]
ds_read_b128 a[108:111], v5 offset:27648
v_mfma_f32_16x16x32_bf16 v[164:167], a[136:139], a[52:55], v[164:167]
v_mfma_f32_16x16x32_bf16 v[188:191], a[136:139], a[56:59], v[188:191]
buffer_load_dwordx4 v1, s[4:7], s44 offen offset:2048 sc1 lds
s_add_u32 s44, s28, 8
v_mfma_f32_16x16x32_bf16 v[212:215], a[136:139], a[60:63], v[212:215]
s_mul_i32 s45, s44, 3072
s_add_u32 m0, s45, 98304
s_lshr_b32 s44, s44, 1
v_mfma_f32_16x16x32_bf16 v[216:219], a[140:143], a[60:63], v[216:219]
s_add_u32 s44, s44, 16
s_mul_i32 s44, s44, 6144
s_add_u32 s44, s44, s50
v_mfma_f32_16x16x32_bf16 v[192:195], a[140:143], a[56:59], v[192:195]
s_add_u32 s44, s44, 0x600000
ds_read_b128 a[112:115], v5 offset:28672
v_mfma_f32_16x16x32_bf16 v[168:171], a[140:143], a[52:55], v[168:171]
ds_read_b128 a[116:119], v5 offset:29696
v_mfma_f32_16x16x32_bf16 v[144:147], a[140:143], a[48:51], v[144:147]
buffer_load_dwordx4 a[40:43], v2, s[40:43], s35 offen offset:2048 sc1
v_mfma_f32_16x16x32_bf16 v[148:151], a[144:147], a[48:51], v[148:151]
v_mfma_f32_16x16x32_bf16 v[172:175], a[144:147], a[52:55], v[172:175]
v_mfma_f32_16x16x32_bf16 v[196:199], a[144:147], a[56:59], v[196:199]
v_mfma_f32_16x16x32_bf16 v[220:223], a[144:147], a[60:63], v[220:223]
v_mfma_f32_16x16x32_bf16 v[224:227], a[148:151], a[60:63], v[224:227]
buffer_load_dwordx4 a[44:47], v2, s[40:43], s35 offen offset:3072 sc1
s_add_u32 s35, s35, 4096
v_mfma_f32_16x16x32_bf16 v[200:203], a[148:151], a[56:59], v[200:203]
v_mfma_f32_16x16x32_bf16 v[176:179], a[148:151], a[52:55], v[176:179]
v_mfma_f32_16x16x32_bf16 v[152:155], a[148:151], a[48:51], v[152:155]
s_waitcnt vmcnt(11) lgkmcnt(0)
v_mfma_f32_16x16x32_bf16 v[132:135], a[96:99], a[0:3], v[132:135]
ds_read_b128 a[128:131], v5 offset:30720
v_accvgpr_read_b32 v48, a188
v_mfma_f32_16x16x32_bf16 v[156:159], a[96:99], a[4:7], v[156:159]
buffer_load_dwordx4 a[48:51], v2, s[40:43], s35 offen offset:0 sc1
v_mfma_f32_16x16x32_bf16 v[180:183], a[96:99], a[8:11], v[180:183]
ds_read_b128 a[132:135], v5 offset:31744
v_mfma_f32_16x16x32_bf16 v[204:207], a[96:99], a[12:15], v[204:207]
v_mfma_f32_16x16x32_bf16 v[208:211], a[100:103], a[12:15], v[208:211]
v_mfma_f32_16x16x32_bf16 v[184:187], a[100:103], a[8:11], v[184:187]
buffer_load_dwordx4 v1, s[4:7], s44 offen offset:0 sc1 lds
v_mfma_f32_16x16x32_bf16 v[160:163], a[100:103], a[4:7], v[160:163]
ds_read_b128 a[136:139], v5 offset:32768
v_mfma_f32_16x16x32_bf16 v[136:139], a[100:103], a[0:3], v[136:139]
v_accvgpr_read_b32 v49, a189
v_mfma_f32_16x16x32_bf16 v[140:143], a[104:107], a[0:3], v[140:143]
ds_read_b128 a[140:143], v5 offset:33792
v_mfma_f32_16x16x32_bf16 v[164:167], a[104:107], a[4:7], v[164:167]
buffer_load_dwordx4 a[52:55], v2, s[40:43], s35 offen offset:1024 sc1
v_mfma_f32_16x16x32_bf16 v[188:191], a[104:107], a[8:11], v[188:191]
ds_read_b128 a[144:147], v5 offset:34816
v_mfma_f32_16x16x32_bf16 v[212:215], a[104:107], a[12:15], v[212:215]
v_mfma_f32_16x16x32_bf16 v[216:219], a[108:111], a[12:15], v[216:219]
v_mfma_f32_16x16x32_bf16 v[192:195], a[108:111], a[8:11], v[192:195]
buffer_load_dwordx4 a[56:59], v2, s[40:43], s35 offen offset:2048 sc1
v_mfma_f32_16x16x32_bf16 v[168:171], a[108:111], a[4:7], v[168:171]
ds_read_b128 a[148:151], v5 offset:35840
v_accvgpr_read_b32 v50, a190
v_mfma_f32_16x16x32_bf16 v[144:147], a[108:111], a[0:3], v[144:147]
v_mfma_f32_16x16x32_bf16 v[148:151], a[112:115], a[0:3], v[148:151]
v_mfma_f32_16x16x32_bf16 v[172:175], a[112:115], a[4:7], v[172:175]
buffer_load_dwordx4 v1, s[4:7], s44 offen offset:1024 sc1 lds
v_mfma_f32_16x16x32_bf16 v[196:199], a[112:115], a[8:11], v[196:199]
v_mfma_f32_16x16x32_bf16 v[220:223], a[112:115], a[12:15], v[220:223]
v_mfma_f32_16x16x32_bf16 v[224:227], a[116:119], a[12:15], v[224:227]
v_mfma_f32_16x16x32_bf16 v[200:203], a[116:119], a[8:11], v[200:203]
buffer_load_dwordx4 a[60:63], v2, s[40:43], s35 offen offset:3072 sc1
s_add_u32 s35, s35, 4096
v_mfma_f32_16x16x32_bf16 v[176:179], a[116:119], a[4:7], v[176:179]
v_accvgpr_read_b32 v51, a191
v_mfma_f32_16x16x32_bf16 v[152:155], a[116:119], a[0:3], v[152:155]
s_waitcnt vmcnt(11) lgkmcnt(0)
v_mfma_f32_16x16x32_bf16 v[132:135], a[128:131], a[16:19], v[132:135]
ds_read_b128 a[96:99], v5 offset:36864
v_mfma_f32_16x16x32_bf16 v[156:159], a[128:131], a[20:23], v[156:159]
buffer_load_dwordx4 a[0:3], v2, s[40:43], s35 offen offset:0 sc1
v_mfma_f32_16x16x32_bf16 v[180:183], a[128:131], a[24:27], v[180:183]
ds_read_b128 a[100:103], v5 offset:37888
v_mfma_f32_16x16x32_bf16 v[204:207], a[128:131], a[28:31], v[204:207]
v_mfma_f32_16x16x32_bf16 v[208:211], a[132:135], a[28:31], v[208:211]
v_accvgpr_read_b32 v52, a192
v_mfma_f32_16x16x32_bf16 v[184:187], a[132:135], a[24:27], v[184:187]
buffer_load_dwordx4 a[4:7], v2, s[40:43], s35 offen offset:1024 sc1
v_mfma_f32_16x16x32_bf16 v[160:163], a[132:135], a[20:23], v[160:163]
ds_read_b128 a[104:107], v5 offset:38912
v_mfma_f32_16x16x32_bf16 v[136:139], a[132:135], a[16:19], v[136:139]
v_mfma_f32_16x16x32_bf16 v[140:143], a[136:139], a[16:19], v[140:143]
ds_read_b128 a[108:111], v5 offset:39936
v_mfma_f32_16x16x32_bf16 v[164:167], a[136:139], a[20:23], v[164:167]
v_mfma_f32_16x16x32_bf16 v[188:191], a[136:139], a[24:27], v[188:191]
buffer_load_dwordx4 v1, s[4:7], s44 offen offset:2048 sc1 lds
s_add_u32 s44, s28, 12
v_mfma_f32_16x16x32_bf16 v[212:215], a[136:139], a[28:31], v[212:215]
s_mul_i32 s45, s44, 3072
s_add_u32 m0, s45, 98304
s_lshr_b32 s44, s44, 1
v_mfma_f32_16x16x32_bf16 v[216:219], a[140:143], a[28:31], v[216:219]
s_add_u32 s44, s44, 16
s_mul_i32 s44, s44, 6144
s_add_u32 s44, s44, s50
v_mfma_f32_16x16x32_bf16 v[192:195], a[140:143], a[24:27], v[192:195]
s_add_u32 s44, s44, 0x600000
ds_read_b128 a[112:115], v5 offset:40960
v_mfma_f32_16x16x32_bf16 v[168:171], a[140:143], a[20:23], v[168:171]
ds_read_b128 a[116:119], v5 offset:41984
v_accvgpr_read_b32 v53, a193
v_mfma_f32_16x16x32_bf16 v[144:147], a[140:143], a[16:19], v[144:147]
buffer_load_dwordx4 a[8:11], v2, s[40:43], s35 offen offset:2048 sc1
v_mfma_f32_16x16x32_bf16 v[148:151], a[144:147], a[16:19], v[148:151]
v_mfma_f32_16x16x32_bf16 v[172:175], a[144:147], a[20:23], v[172:175]
v_mfma_f32_16x16x32_bf16 v[196:199], a[144:147], a[24:27], v[196:199]
v_accvgpr_read_b32 v54, a194
v_mfma_f32_16x16x32_bf16 v[220:223], a[144:147], a[28:31], v[220:223]
v_mfma_f32_16x16x32_bf16 v[224:227], a[148:151], a[28:31], v[224:227]
buffer_load_dwordx4 a[12:15], v2, s[40:43], s35 offen offset:3072 sc1
s_add_u32 s35, s35, 4096
v_mfma_f32_16x16x32_bf16 v[200:203], a[148:151], a[24:27], v[200:203]
v_mfma_f32_16x16x32_bf16 v[176:179], a[148:151], a[20:23], v[176:179]
v_mfma_f32_16x16x32_bf16 v[152:155], a[148:151], a[16:19], v[152:155]
s_waitcnt vmcnt(11) lgkmcnt(0)
v_mfma_f32_16x16x32_bf16 v[132:135], a[96:99], a[32:35], v[132:135]
ds_read_b128 a[128:131], v5 offset:43008
v_mfma_f32_16x16x32_bf16 v[156:159], a[96:99], a[36:39], v[156:159]
buffer_load_dwordx4 a[16:19], v2, s[40:43], s35 offen offset:0 sc1
v_mfma_f32_16x16x32_bf16 v[180:183], a[96:99], a[40:43], v[180:183]
ds_read_b128 a[132:135], v5 offset:44032
v_accvgpr_read_b32 v55, a195
v_mfma_f32_16x16x32_bf16 v[204:207], a[96:99], a[44:47], v[204:207]
v_mfma_f32_16x16x32_bf16 v[208:211], a[100:103], a[44:47], v[208:211]
v_mfma_f32_16x16x32_bf16 v[184:187], a[100:103], a[40:43], v[184:187]
buffer_load_dwordx4 v1, s[4:7], s44 offen offset:0 sc1 lds
v_mfma_f32_16x16x32_bf16 v[160:163], a[100:103], a[36:39], v[160:163]
ds_read_b128 a[136:139], v5 offset:45056
v_mfma_f32_16x16x32_bf16 v[136:139], a[100:103], a[32:35], v[136:139]
v_mfma_f32_16x16x32_bf16 v[140:143], a[104:107], a[32:35], v[140:143]
ds_read_b128 a[140:143], v5 offset:46080
v_accvgpr_read_b32 v56, a196
v_mfma_f32_16x16x32_bf16 v[164:167], a[104:107], a[36:39], v[164:167]
buffer_load_dwordx4 a[20:23], v2, s[40:43], s35 offen offset:1024 sc1
v_mfma_f32_16x16x32_bf16 v[188:191], a[104:107], a[40:43], v[188:191]
ds_read_b128 a[144:147], v5 offset:47104
v_mfma_f32_16x16x32_bf16 v[212:215], a[104:107], a[44:47], v[212:215]
v_mfma_f32_16x16x32_bf16 v[216:219], a[108:111], a[44:47], v[216:219]
v_mfma_f32_16x16x32_bf16 v[192:195], a[108:111], a[40:43], v[192:195]
buffer_load_dwordx4 a[24:27], v2, s[40:43], s35 offen offset:2048 sc1
v_mfma_f32_16x16x32_bf16 v[168:171], a[108:111], a[36:39], v[168:171]
ds_read_b128 a[148:151], v5 offset:48128
v_mfma_f32_16x16x32_bf16 v[144:147], a[108:111], a[32:35], v[144:147]
v_accvgpr_read_b32 v57, a197
v_mfma_f32_16x16x32_bf16 v[148:151], a[112:115], a[32:35], v[148:151]
v_mfma_f32_16x16x32_bf16 v[172:175], a[112:115], a[36:39], v[172:175]
buffer_load_dwordx4 v1, s[4:7], s44 offen offset:1024 sc1 lds
v_mfma_f32_16x16x32_bf16 v[196:199], a[112:115], a[40:43], v[196:199]
v_mfma_f32_16x16x32_bf16 v[220:223], a[112:115], a[44:47], v[220:223]
v_mfma_f32_16x16x32_bf16 v[224:227], a[116:119], a[44:47], v[224:227]
v_mfma_f32_16x16x32_bf16 v[200:203], a[116:119], a[40:43], v[200:203]
buffer_load_dwordx4 a[28:31], v2, s[40:43], s35 offen offset:3072 sc1
s_add_u32 s35, s35, 4096
v_mfma_f32_16x16x32_bf16 v[176:179], a[116:119], a[36:39], v[176:179]
v_accvgpr_read_b32 v58, a198
v_mfma_f32_16x16x32_bf16 v[152:155], a[116:119], a[32:35], v[152:155]
s_waitcnt vmcnt(11) lgkmcnt(0)
s_barrier
v_mfma_f32_16x16x32_bf16 v[132:135], a[128:131], a[48:51], v[132:135]
v_add_u32 v5, 49152, v1
v_mfma_f32_16x16x32_bf16 v[156:159], a[128:131], a[52:55], v[156:159]
buffer_load_dwordx4 a[32:35], v2, s[40:43], s35 offen offset:0 sc1
v_mfma_f32_16x16x32_bf16 v[180:183], a[128:131], a[56:59], v[180:183]
ds_read_b128 a[96:99], v5 offset:0
v_mfma_f32_16x16x32_bf16 v[204:207], a[128:131], a[60:63], v[204:207]
ds_read_b128 a[100:103], v5 offset:1024
v_mfma_f32_16x16x32_bf16 v[208:211], a[132:135], a[60:63], v[208:211]
v_mfma_f32_16x16x32_bf16 v[184:187], a[132:135], a[56:59], v[184:187]
buffer_load_dwordx4 a[36:39], v2, s[40:43], s35 offen offset:1024 sc1
v_mfma_f32_16x16x32_bf16 v[160:163], a[132:135], a[52:55], v[160:163]
ds_read_b128 a[104:107], v5 offset:2048
v_accvgpr_read_b32 v59, a199
v_mfma_f32_16x16x32_bf16 v[136:139], a[132:135], a[48:51], v[136:139]
v_mfma_f32_16x16x32_bf16 v[140:143], a[136:139], a[48:51], v[140:143]
ds_read_b128 a[108:111], v5 offset:3072
v_mfma_f32_16x16x32_bf16 v[164:167], a[136:139], a[52:55], v[164:167]
v_mfma_f32_16x16x32_bf16 v[188:191], a[136:139], a[56:59], v[188:191]
buffer_load_dwordx4 v1, s[4:7], s44 offen offset:2048 sc1 lds
s_add_u32 s88, s82, 0x2c0000
v_mfma_f32_16x16x32_bf16 v[212:215], a[136:139], a[60:63], v[212:215]
ds_read_b128 a[112:115], v5 offset:4096
v_mfma_f32_16x16x32_bf16 v[216:219], a[140:143], a[60:63], v[216:219]
v_accvgpr_read_b32 v60, a200
v_mfma_f32_16x16x32_bf16 v[192:195], a[140:143], a[56:59], v[192:195]
ds_read_b128 a[116:119], v5 offset:5120
v_mfma_f32_16x16x32_bf16 v[168:171], a[140:143], a[52:55], v[168:171]
v_mfma_f32_16x16x32_bf16 v[144:147], a[140:143], a[48:51], v[144:147]
buffer_load_dwordx4 a[40:43], v2, s[40:43], s35 offen offset:2048 sc1
v_mfma_f32_16x16x32_bf16 v[148:151], a[144:147], a[48:51], v[148:151]
v_mfma_f32_16x16x32_bf16 v[172:175], a[144:147], a[52:55], v[172:175]
v_mfma_f32_16x16x32_bf16 v[196:199], a[144:147], a[56:59], v[196:199]
v_mfma_f32_16x16x32_bf16 v[220:223], a[144:147], a[60:63], v[220:223]
v_accvgpr_read_b32 v61, a201
v_mfma_f32_16x16x32_bf16 v[224:227], a[148:151], a[60:63], v[224:227]
buffer_load_dwordx4 a[44:47], v2, s[40:43], s35 offen offset:3072 sc1
s_add_u32 s35, s35, 4096
v_mfma_f32_16x16x32_bf16 v[200:203], a[148:151], a[56:59], v[200:203]
v_mfma_f32_16x16x32_bf16 v[176:179], a[148:151], a[52:55], v[176:179]
v_mfma_f32_16x16x32_bf16 v[152:155], a[148:151], a[48:51], v[152:155]
s_waitcnt vmcnt(11) lgkmcnt(0)
v_mfma_f32_16x16x32_bf16 v[132:135], a[96:99], a[0:3], v[132:135]
ds_read_b128 a[128:131], v5 offset:6144
v_mfma_f32_16x16x32_bf16 v[156:159], a[96:99], a[4:7], v[156:159]
buffer_load_dwordx4 a[48:51], v2, s[40:43], s35 offen offset:0 sc1
v_mfma_f32_16x16x32_bf16 v[180:183], a[96:99], a[8:11], v[180:183]
ds_read_b128 a[132:135], v5 offset:7168
v_accvgpr_read_b32 v62, a202
v_mfma_f32_16x16x32_bf16 v[204:207], a[96:99], a[12:15], v[204:207]
v_mfma_f32_16x16x32_bf16 v[208:211], a[100:103], a[12:15], v[208:211]
v_mfma_f32_16x16x32_bf16 v[184:187], a[100:103], a[8:11], v[184:187]
buffer_load_dwordx4 v[92:95], v1, s[4:7], s88 offen offset:0 sc1
v_mfma_f32_16x16x32_bf16 v[160:163], a[100:103], a[4:7], v[160:163]
ds_read_b128 a[136:139], v5 offset:8192
v_mfma_f32_16x16x32_bf16 v[136:139], a[100:103], a[0:3], v[136:139]
v_mfma_f32_16x16x32_bf16 v[140:143], a[104:107], a[0:3], v[140:143]
ds_read_b128 a[140:143], v5 offset:9216
v_mfma_f32_16x16x32_bf16 v[164:167], a[104:107], a[4:7], v[164:167]
buffer_load_dwordx4 a[52:55], v2, s[40:43], s35 offen offset:1024 sc1
v_mfma_f32_16x16x32_bf16 v[188:191], a[104:107], a[8:11], v[188:191]
ds_read_b128 a[144:147], v5 offset:10240
v_accvgpr_read_b32 v63, a203
v_mfma_f32_16x16x32_bf16 v[212:215], a[104:107], a[12:15], v[212:215]
v_mfma_f32_16x16x32_bf16 v[216:219], a[108:111], a[12:15], v[216:219]
v_mfma_f32_16x16x32_bf16 v[192:195], a[108:111], a[8:11], v[192:195]
buffer_load_dwordx4 a[56:59], v2, s[40:43], s35 offen offset:2048 sc1
v_mfma_f32_16x16x32_bf16 v[168:171], a[108:111], a[4:7], v[168:171]
ds_read_b128 a[148:151], v5 offset:11264
v_mfma_f32_16x16x32_bf16 v[144:147], a[108:111], a[0:3], v[144:147]
v_mfma_f32_16x16x32_bf16 v[148:151], a[112:115], a[0:3], v[148:151]
v_accvgpr_read_b32 v64, a204
v_mfma_f32_16x16x32_bf16 v[172:175], a[112:115], a[4:7], v[172:175]
buffer_load_dwordx4 v[96:99], v1, s[4:7], s88 offen offset:1024 sc1
v_mfma_f32_16x16x32_bf16 v[196:199], a[112:115], a[8:11], v[196:199]
v_mfma_f32_16x16x32_bf16 v[220:223], a[112:115], a[12:15], v[220:223]
v_mfma_f32_16x16x32_bf16 v[224:227], a[116:119], a[12:15], v[224:227]
v_mfma_f32_16x16x32_bf16 v[200:203], a[116:119], a[8:11], v[200:203]
buffer_load_dwordx4 a[60:63], v2, s[40:43], s35 offen offset:3072 sc1
s_add_u32 s35, s35, 4096
v_mfma_f32_16x16x32_bf16 v[176:179], a[116:119], a[4:7], v[176:179]
v_mfma_f32_16x16x32_bf16 v[152:155], a[116:119], a[0:3], v[152:155]
v_accvgpr_read_b32 v65, a205
s_waitcnt vmcnt(11) lgkmcnt(0)
v_mfma_f32_16x16x32_bf16 v[132:135], a[128:131], a[16:19], v[132:135]
ds_read_b128 a[96:99], v5 offset:12288
v_mfma_f32_16x16x32_bf16 v[156:159], a[128:131], a[20:23], v[156:159]
buffer_load_dwordx4 a[0:3], v2, s[40:43], s35 offen offset:0 sc1
v_mfma_f32_16x16x32_bf16 v[180:183], a[128:131], a[24:27], v[180:183]
ds_read_b128 a[100:103], v5 offset:13312
v_mfma_f32_16x16x32_bf16 v[204:207], a[128:131], a[28:31], v[204:207]
v_mfma_f32_16x16x32_bf16 v[208:211], a[132:135], a[28:31], v[208:211]
v_mfma_f32_16x16x32_bf16 v[184:187], a[132:135], a[24:27], v[184:187]
buffer_load_dwordx4 a[4:7], v2, s[40:43], s35 offen offset:1024 sc1
v_mfma_f32_16x16x32_bf16 v[160:163], a[132:135], a[20:23], v[160:163]
ds_read_b128 a[104:107], v5 offset:14336
v_accvgpr_read_b32 v66, a206
v_mfma_f32_16x16x32_bf16 v[136:139], a[132:135], a[16:19], v[136:139]
v_mfma_f32_16x16x32_bf16 v[140:143], a[136:139], a[16:19], v[140:143]
ds_read_b128 a[108:111], v5 offset:15360
v_mfma_f32_16x16x32_bf16 v[164:167], a[136:139], a[20:23], v[164:167]
v_mfma_f32_16x16x32_bf16 v[188:191], a[136:139], a[24:27], v[188:191]
buffer_load_dwordx4 v[100:103], v1, s[4:7], s88 offen offset:2048 sc1
v_mfma_f32_16x16x32_bf16 v[212:215], a[136:139], a[28:31], v[212:215]
ds_read_b128 a[112:115], v5 offset:16384
v_mfma_f32_16x16x32_bf16 v[216:219], a[140:143], a[28:31], v[216:219]
v_mfma_f32_16x16x32_bf16 v[192:195], a[140:143], a[24:27], v[192:195]
ds_read_b128 a[116:119], v5 offset:17408
v_accvgpr_read_b32 v67, a207
v_mfma_f32_16x16x32_bf16 v[168:171], a[140:143], a[20:23], v[168:171]
v_mfma_f32_16x16x32_bf16 v[144:147], a[140:143], a[16:19], v[144:147]
buffer_load_dwordx4 a[8:11], v2, s[40:43], s35 offen offset:2048 sc1
v_mfma_f32_16x16x32_bf16 v[148:151], a[144:147], a[16:19], v[148:151]
v_mfma_f32_16x16x32_bf16 v[172:175], a[144:147], a[20:23], v[172:175]
v_mfma_f32_16x16x32_bf16 v[196:199], a[144:147], a[24:27], v[196:199]
v_mfma_f32_16x16x32_bf16 v[220:223], a[144:147], a[28:31], v[220:223]
v_mfma_f32_16x16x32_bf16 v[224:227], a[148:151], a[28:31], v[224:227]
buffer_load_dwordx4 a[12:15], v2, s[40:43], s35 offen offset:3072 sc1
L_stub16:
s_cbranch_execz L_stub17
s_add_u32 s35, s35, 4096
v_mfma_f32_16x16x32_bf16 v[200:203], a[148:151], a[24:27], v[200:203]
v_accvgpr_read_b32 v68, a208
v_mfma_f32_16x16x32_bf16 v[176:179], a[148:151], a[20:23], v[176:179]
v_mfma_f32_16x16x32_bf16 v[152:155], a[148:151], a[16:19], v[152:155]
s_waitcnt vmcnt(11) lgkmcnt(0)
v_mfma_f32_16x16x32_bf16 v[132:135], a[96:99], a[32:35], v[132:135]
ds_read_b128 a[128:131], v5 offset:18432
v_mfma_f32_16x16x32_bf16 v[156:159], a[96:99], a[36:39], v[156:159]
buffer_load_dwordx4 a[16:19], v2, s[40:43], s35 offen offset:0 sc1
v_mfma_f32_16x16x32_bf16 v[180:183], a[96:99], a[40:43], v[180:183]
ds_read_b128 a[132:135], v5 offset:19456
v_mfma_f32_16x16x32_bf16 v[204:207], a[96:99], a[44:47], v[204:207]
v_accvgpr_read_b32 v69, a209
v_mfma_f32_16x16x32_bf16 v[208:211], a[100:103], a[44:47], v[208:211]
v_mfma_f32_16x16x32_bf16 v[184:187], a[100:103], a[40:43], v[184:187]
buffer_load_dwordx4 v[104:107], v1, s[4:7], s88 offen offset:3072 sc1
s_add_u32 s88, s88, 4096
v_mfma_f32_16x16x32_bf16 v[160:163], a[100:103], a[36:39], v[160:163]
ds_read_b128 a[136:139], v5 offset:20480
v_mfma_f32_16x16x32_bf16 v[136:139], a[100:103], a[32:35], v[136:139]
v_mfma_f32_16x16x32_bf16 v[140:143], a[104:107], a[32:35], v[140:143]
ds_read_b128 a[140:143], v5 offset:21504
v_mfma_f32_16x16x32_bf16 v[164:167], a[104:107], a[36:39], v[164:167]
buffer_load_dwordx4 a[20:23], v2, s[40:43], s35 offen offset:1024 sc1
v_mfma_f32_16x16x32_bf16 v[188:191], a[104:107], a[40:43], v[188:191]
ds_read_b128 a[144:147], v5 offset:22528
v_accvgpr_read_b32 v70, a210
v_mfma_f32_16x16x32_bf16 v[212:215], a[104:107], a[44:47], v[212:215]
v_mfma_f32_16x16x32_bf16 v[216:219], a[108:111], a[44:47], v[216:219]
v_mfma_f32_16x16x32_bf16 v[192:195], a[108:111], a[40:43], v[192:195]
buffer_load_dwordx4 a[24:27], v2, s[40:43], s35 offen offset:2048 sc1
v_mfma_f32_16x16x32_bf16 v[168:171], a[108:111], a[36:39], v[168:171]
ds_read_b128 a[148:151], v5 offset:23552
v_mfma_f32_16x16x32_bf16 v[144:147], a[108:111], a[32:35], v[144:147]
v_mfma_f32_16x16x32_bf16 v[148:151], a[112:115], a[32:35], v[148:151]
v_mfma_f32_16x16x32_bf16 v[172:175], a[112:115], a[36:39], v[172:175]
buffer_load_dwordx4 v[108:111], v1, s[4:7], s88 offen offset:0 sc1
v_mfma_f32_16x16x32_bf16 v[196:199], a[112:115], a[40:43], v[196:199]
v_accvgpr_read_b32 v71, a211
v_mfma_f32_16x16x32_bf16 v[220:223], a[112:115], a[44:47], v[220:223]
v_mfma_f32_16x16x32_bf16 v[224:227], a[116:119], a[44:47], v[224:227]
v_mfma_f32_16x16x32_bf16 v[200:203], a[116:119], a[40:43], v[200:203]
buffer_load_dwordx4 a[28:31], v2, s[40:43], s35 offen offset:3072 sc1
s_add_u32 s35, s35, 4096
v_mfma_f32_16x16x32_bf16 v[176:179], a[116:119], a[36:39], v[176:179]
v_mfma_f32_16x16x32_bf16 v[152:155], a[116:119], a[32:35], v[152:155]
s_waitcnt vmcnt(11) lgkmcnt(0)
v_mfma_f32_16x16x32_bf16 v[132:135], a[128:131], a[48:51], v[132:135]
ds_read_b128 a[96:99], v5 offset:24576
v_mfma_f32_16x16x32_bf16 v[156:159], a[128:131], a[52:55], v[156:159]
buffer_load_dwordx4 a[32:35], v2, s[40:43], s35 offen offset:0 sc1
v_mfma_f32_16x16x32_bf16 v[180:183], a[128:131], a[56:59], v[180:183]
ds_read_b128 a[100:103], v5 offset:25600
v_mfma_f32_16x16x32_bf16 v[204:207], a[128:131], a[60:63], v[204:207]
v_mfma_f32_16x16x32_bf16 v[208:211], a[132:135], a[60:63], v[208:211]
v_mfma_f32_16x16x32_bf16 v[184:187], a[132:135], a[56:59], v[184:187]
buffer_load_dwordx4 a[36:39], v2, s[40:43], s35 offen offset:1024 sc1
v_mfma_f32_16x16x32_bf16 v[160:163], a[132:135], a[52:55], v[160:163]
ds_read_b128 a[104:107], v5 offset:26624
v_mfma_f32_16x16x32_bf16 v[136:139], a[132:135], a[48:51], v[136:139]
v_mfma_f32_16x16x32_bf16 v[140:143], a[136:139], a[48:51], v[140:143]
ds_read_b128 a[108:111], v5 offset:27648
v_mfma_f32_16x16x32_bf16 v[164:167], a[136:139], a[52:55], v[164:167]
v_mfma_f32_16x16x32_bf16 v[188:191], a[136:139], a[56:59], v[188:191]
buffer_load_dwordx4 v[112:115], v1, s[4:7], s88 offen offset:1024 sc1
v_mfma_f32_16x16x32_bf16 v[212:215], a[136:139], a[60:63], v[212:215]
ds_read_b128 a[112:115], v5 offset:28672
v_mfma_f32_16x16x32_bf16 v[216:219], a[140:143], a[60:63], v[216:219]
v_mfma_f32_16x16x32_bf16 v[192:195], a[140:143], a[56:59], v[192:195]
ds_read_b128 a[116:119], v5 offset:29696
v_mfma_f32_16x16x32_bf16 v[168:171], a[140:143], a[52:55], v[168:171]
v_mfma_f32_16x16x32_bf16 v[144:147], a[140:143], a[48:51], v[144:147]
buffer_load_dwordx4 a[40:43], v2, s[40:43], s35 offen offset:2048 sc1
v_mfma_f32_16x16x32_bf16 v[148:151], a[144:147], a[48:51], v[148:151]
v_mfma_f32_16x16x32_bf16 v[172:175], a[144:147], a[52:55], v[172:175]
v_mfma_f32_16x16x32_bf16 v[196:199], a[144:147], a[56:59], v[196:199]
v_mfma_f32_16x16x32_bf16 v[220:223], a[144:147], a[60:63], v[220:223]
v_mfma_f32_16x16x32_bf16 v[224:227], a[148:151], a[60:63], v[224:227]
buffer_load_dwordx4 a[44:47], v2, s[40:43], s35 offen offset:3072 sc1
s_add_u32 s35, s35, 4096
v_mfma_f32_16x16x32_bf16 v[200:203], a[148:151], a[56:59], v[200:203]
v_mfma_f32_16x16x32_bf16 v[176:179], a[148:151], a[52:55], v[176:179]
v_mfma_f32_16x16x32_bf16 v[152:155], a[148:151], a[48:51], v[152:155]
s_waitcnt vmcnt(11) lgkmcnt(0)
v_mfma_f32_16x16x32_bf16 v[132:135], a[96:99], a[0:3], v[132:135]
ds_read_b128 a[128:131], v5 offset:30720
v_mfma_f32_16x16x32_bf16 v[156:159], a[96:99], a[4:7], v[156:159]
buffer_load_dwordx4 a[48:51], v2, s[40:43], s35 offen offset:0 sc1
v_mfma_f32_16x16x32_bf16 v[180:183], a[96:99], a[8:11], v[180:183]
ds_read_b128 a[132:135], v5 offset:31744
v_mfma_f32_16x16x32_bf16 v[204:207], a[96:99], a[12:15], v[204:207]
v_mfma_f32_16x16x32_bf16 v[208:211], a[100:103], a[12:15], v[208:211]
v_mfma_f32_16x16x32_bf16 v[184:187], a[100:103], a[8:11], v[184:187]
buffer_load_dwordx4 v[116:119], v1, s[4:7], s88 offen offset:2048 sc1
v_mfma_f32_16x16x32_bf16 v[160:163], a[100:103], a[4:7], v[160:163]
ds_read_b128 a[136:139], v5 offset:32768
v_mfma_f32_16x16x32_bf16 v[136:139], a[100:103], a[0:3], v[136:139]
v_mfma_f32_16x16x32_bf16 v[140:143], a[104:107], a[0:3], v[140:143]
ds_read_b128 a[140:143], v5 offset:33792
v_mfma_f32_16x16x32_bf16 v[164:167], a[104:107], a[4:7], v[164:167]
buffer_load_dwordx4 a[52:55], v2, s[40:43], s35 offen offset:1024 sc1
v_mfma_f32_16x16x32_bf16 v[188:191], a[104:107], a[8:11], v[188:191]
ds_read_b128 a[144:147], v5 offset:34816
v_mfma_f32_16x16x32_bf16 v[212:215], a[104:107], a[12:15], v[212:215]
v_mfma_f32_16x16x32_bf16 v[216:219], a[108:111], a[12:15], v[216:219]
v_mfma_f32_16x16x32_bf16 v[192:195], a[108:111], a[8:11], v[192:195]
buffer_load_dwordx4 a[56:59], v2, s[40:43], s35 offen offset:2048 sc1
v_mfma_f32_16x16x32_bf16 v[168:171], a[108:111], a[4:7], v[168:171]
ds_read_b128 a[148:151], v5 offset:35840
v_mfma_f32_16x16x32_bf16 v[144:147], a[108:111], a[0:3], v[144:147]
v_mfma_f32_16x16x32_bf16 v[148:151], a[112:115], a[0:3], v[148:151]
v_mfma_f32_16x16x32_bf16 v[172:175], a[112:115], a[4:7], v[172:175]
buffer_load_dwordx4 v[120:123], v1, s[4:7], s88 offen offset:3072 sc1
s_add_u32 s44, s28, 0
v_mfma_f32_16x16x32_bf16 v[196:199], a[112:115], a[8:11], v[196:199]
s_mul_i32 s45, s44, 3072
s_add_u32 m0, s45, 0
s_lshr_b32 s44, s44, 1
v_mfma_f32_16x16x32_bf16 v[220:223], a[112:115], a[12:15], v[220:223]
s_add_u32 s44, s44, 24
s_mul_i32 s44, s44, 6144
s_add_u32 s44, s44, s50
v_mfma_f32_16x16x32_bf16 v[224:227], a[116:119], a[12:15], v[224:227]
s_add_u32 s44, s44, 0x600000
v_mfma_f32_16x16x32_bf16 v[200:203], a[116:119], a[8:11], v[200:203]
buffer_load_dwordx4 a[60:63], v2, s[40:43], s35 offen offset:3072 sc1
s_add_u32 s35, s35, 4096
v_mfma_f32_16x16x32_bf16 v[176:179], a[116:119], a[4:7], v[176:179]
v_mfma_f32_16x16x32_bf16 v[152:155], a[116:119], a[0:3], v[152:155]
s_waitcnt vmcnt(11) lgkmcnt(0)
v_mfma_f32_16x16x32_bf16 v[132:135], a[128:131], a[16:19], v[132:135]
ds_read_b128 a[96:99], v5 offset:36864
v_mfma_f32_16x16x32_bf16 v[156:159], a[128:131], a[20:23], v[156:159]
buffer_load_dwordx4 a[0:3], v2, s[40:43], s35 offen offset:0 sc1
v_mfma_f32_16x16x32_bf16 v[180:183], a[128:131], a[24:27], v[180:183]
ds_read_b128 a[100:103], v5 offset:37888
v_mfma_f32_16x16x32_bf16 v[204:207], a[128:131], a[28:31], v[204:207]
v_mfma_f32_16x16x32_bf16 v[208:211], a[132:135], a[28:31], v[208:211]
v_mfma_f32_16x16x32_bf16 v[184:187], a[132:135], a[24:27], v[184:187]
buffer_load_dwordx4 a[4:7], v2, s[40:43], s35 offen offset:1024 sc1
v_mfma_f32_16x16x32_bf16 v[160:163], a[132:135], a[20:23], v[160:163]
ds_read_b128 a[104:107], v5 offset:38912
v_mfma_f32_16x16x32_bf16 v[136:139], a[132:135], a[16:19], v[136:139]
v_mfma_f32_16x16x32_bf16 v[140:143], a[136:139], a[16:19], v[140:143]
ds_read_b128 a[108:111], v5 offset:39936
v_mfma_f32_16x16x32_bf16 v[164:167], a[136:139], a[20:23], v[164:167]
v_mfma_f32_16x16x32_bf16 v[188:191], a[136:139], a[24:27], v[188:191]
buffer_load_dwordx4 v1, s[4:7], s44 offen offset:0 sc1 lds
v_mfma_f32_16x16x32_bf16 v[212:215], a[136:139], a[28:31], v[212:215]
ds_read_b128 a[112:115], v5 offset:40960
v_mfma_f32_16x16x32_bf16 v[216:219], a[140:143], a[28:31], v[216:219]
v_mfma_f32_16x16x32_bf16 v[192:195], a[140:143], a[24:27], v[192:195]
ds_read_b128 a[116:119], v5 offset:41984
v_mfma_f32_16x16x32_bf16 v[168:171], a[140:143], a[20:23], v[168:171]
v_mfma_f32_16x16x32_bf16 v[144:147], a[140:143], a[16:19], v[144:147]
buffer_load_dwordx4 a[8:11], v2, s[40:43], s35 offen offset:2048 sc1
v_mfma_f32_16x16x32_bf16 v[148:151], a[144:147], a[16:19], v[148:151]
v_mfma_f32_16x16x32_bf16 v[172:175], a[144:147], a[20:23], v[172:175]
v_mfma_f32_16x16x32_bf16 v[196:199], a[144:147], a[24:27], v[196:199]
v_mfma_f32_16x16x32_bf16 v[220:223], a[144:147], a[28:31], v[220:223]
v_mfma_f32_16x16x32_bf16 v[224:227], a[148:151], a[28:31], v[224:227]
buffer_load_dwordx4 a[12:15], v2, s[40:43], s35 offen offset:3072 sc1
s_add_u32 s35, s35, 4096
v_mfma_f32_16x16x32_bf16 v[200:203], a[148:151], a[24:27], v[200:203]
v_mfma_f32_16x16x32_bf16 v[176:179], a[148:151], a[20:23], v[176:179]
v_mfma_f32_16x16x32_bf16 v[152:155], a[148:151], a[16:19], v[152:155]
s_waitcnt vmcnt(11) lgkmcnt(0)
v_mfma_f32_16x16x32_bf16 v[132:135], a[96:99], a[32:35], v[132:135]
ds_read_b128 a[128:131], v5 offset:43008
v_mfma_f32_16x16x32_bf16 v[156:159], a[96:99], a[36:39], v[156:159]
buffer_load_dwordx4 a[16:19], v2, s[40:43], s35 offen offset:0 sc1
v_mfma_f32_16x16x32_bf16 v[180:183], a[96:99], a[40:43], v[180:183]
ds_read_b128 a[132:135], v5 offset:44032
v_mfma_f32_16x16x32_bf16 v[204:207], a[96:99], a[44:47], v[204:207]
v_mfma_f32_16x16x32_bf16 v[208:211], a[100:103], a[44:47], v[208:211]
v_mfma_f32_16x16x32_bf16 v[184:187], a[100:103], a[40:43], v[184:187]
buffer_load_dwordx4 v1, s[4:7], s44 offen offset:1024 sc1 lds
v_mfma_f32_16x16x32_bf16 v[160:163], a[100:103], a[36:39], v[160:163]
ds_read_b128 a[136:139], v5 offset:45056
v_mfma_f32_16x16x32_bf16 v[136:139], a[100:103], a[32:35], v[136:139]
v_mfma_f32_16x16x32_bf16 v[140:143], a[104:107], a[32:35], v[140:143]
ds_read_b128 a[140:143], v5 offset:46080
v_mfma_f32_16x16x32_bf16 v[164:167], a[104:107], a[36:39], v[164:167]
buffer_load_dwordx4 a[20:23], v2, s[40:43], s35 offen offset:1024 sc1
v_mfma_f32_16x16x32_bf16 v[188:191], a[104:107], a[40:43], v[188:191]
ds_read_b128 a[144:147], v5 offset:47104
v_mfma_f32_16x16x32_bf16 v[212:215], a[104:107], a[44:47], v[212:215]
v_mfma_f32_16x16x32_bf16 v[216:219], a[108:111], a[44:47], v[216:219]
v_mfma_f32_16x16x32_bf16 v[192:195], a[108:111], a[40:43], v[192:195]
buffer_load_dwordx4 a[24:27], v2, s[40:43], s35 offen offset:2048 sc1
v_mfma_f32_16x16x32_bf16 v[168:171], a[108:111], a[36:39], v[168:171]
ds_read_b128 a[148:151], v5 offset:48128
v_mfma_f32_16x16x32_bf16 v[144:147], a[108:111], a[32:35], v[144:147]
v_mfma_f32_16x16x32_bf16 v[148:151], a[112:115], a[32:35], v[148:151]
v_mfma_f32_16x16x32_bf16 v[172:175], a[112:115], a[36:39], v[172:175]
buffer_load_dwordx4 v1, s[4:7], s44 offen offset:2048 sc1 lds
s_add_u32 s44, s28, 4
v_mfma_f32_16x16x32_bf16 v[196:199], a[112:115], a[40:43], v[196:199]
s_mul_i32 s45, s44, 3072
s_add_u32 m0, s45, 0
s_lshr_b32 s44, s44, 1
v_mfma_f32_16x16x32_bf16 v[220:223], a[112:115], a[44:47], v[220:223]
s_add_u32 s44, s44, 24
s_mul_i32 s44, s44, 6144
s_add_u32 s44, s44, s50
v_mfma_f32_16x16x32_bf16 v[224:227], a[116:119], a[44:47], v[224:227]
s_add_u32 s44, s44, 0x600000
v_mfma_f32_16x16x32_bf16 v[200:203], a[116:119], a[40:43], v[200:203]
buffer_load_dwordx4 a[28:31], v2, s[40:43], s35 offen offset:3072 sc1
s_add_u32 s35, s35, 4096
v_mfma_f32_16x16x32_bf16 v[176:179], a[116:119], a[36:39], v[176:179]
v_mfma_f32_16x16x32_bf16 v[152:155], a[116:119], a[32:35], v[152:155]
s_waitcnt vmcnt(11) lgkmcnt(0)
s_barrier
v_mfma_f32_16x16x32_bf16 v[132:135], a[128:131], a[48:51], v[132:135]
v_add_u32 v5, 98304, v1
v_mfma_f32_16x16x32_bf16 v[156:159], a[128:131], a[52:55], v[156:159]
buffer_load_dwordx4 a[32:35], v2, s[40:43], s35 offen offset:0 sc1
v_mfma_f32_16x16x32_bf16 v[180:183], a[128:131], a[56:59], v[180:183]
ds_read_b128 a[96:99], v5 offset:0
v_mfma_f32_16x16x32_bf16 v[204:207], a[128:131], a[60:63], v[204:207]
ds_read_b128 a[100:103], v5 offset:1024
v_mfma_f32_16x16x32_bf16 v[208:211], a[132:135], a[60:63], v[208:211]
v_mfma_f32_16x16x32_bf16 v[184:187], a[132:135], a[56:59], v[184:187]
buffer_load_dwordx4 a[36:39], v2, s[40:43], s35 offen offset:1024 sc1
v_mfma_f32_16x16x32_bf16 v[160:163], a[132:135], a[52:55], v[160:163]
ds_read_b128 a[104:107], v5 offset:2048
v_mfma_f32_16x16x32_bf16 v[136:139], a[132:135], a[48:51], v[136:139]
v_mfma_f32_16x16x32_bf16 v[140:143], a[136:139], a[48:51], v[140:143]
ds_read_b128 a[108:111], v5 offset:3072
v_mfma_f32_16x16x32_bf16 v[164:167], a[136:139], a[52:55], v[164:167]
v_mfma_f32_16x16x32_bf16 v[188:191], a[136:139], a[56:59], v[188:191]
buffer_load_dwordx4 v1, s[4:7], s44 offen offset:0 sc1 lds
v_mfma_f32_16x16x32_bf16 v[212:215], a[136:139], a[60:63], v[212:215]
ds_read_b128 a[112:115], v5 offset:4096
v_mfma_f32_16x16x32_bf16 v[216:219], a[140:143], a[60:63], v[216:219]
v_mfma_f32_16x16x32_bf16 v[192:195], a[140:143], a[56:59], v[192:195]
ds_read_b128 a[116:119], v5 offset:5120
v_mfma_f32_16x16x32_bf16 v[168:171], a[140:143], a[52:55], v[168:171]
v_mfma_f32_16x16x32_bf16 v[144:147], a[140:143], a[48:51], v[144:147]
buffer_load_dwordx4 a[40:43], v2, s[40:43], s35 offen offset:2048 sc1
v_mfma_f32_16x16x32_bf16 v[148:151], a[144:147], a[48:51], v[148:151]
v_mfma_f32_16x16x32_bf16 v[172:175], a[144:147], a[52:55], v[172:175]
v_mfma_f32_16x16x32_bf16 v[196:199], a[144:147], a[56:59], v[196:199]
v_mfma_f32_16x16x32_bf16 v[220:223], a[144:147], a[60:63], v[220:223]
v_mfma_f32_16x16x32_bf16 v[224:227], a[148:151], a[60:63], v[224:227]
buffer_load_dwordx4 a[44:47], v2, s[40:43], s35 offen offset:3072 sc1
s_add_u32 s35, s35, 4096
v_mfma_f32_16x16x32_bf16 v[200:203], a[148:151], a[56:59], v[200:203]
v_mfma_f32_16x16x32_bf16 v[176:179], a[148:151], a[52:55], v[176:179]
v_mfma_f32_16x16x32_bf16 v[152:155], a[148:151], a[48:51], v[152:155]
s_waitcnt vmcnt(11) lgkmcnt(0)
v_mfma_f32_16x16x32_bf16 v[132:135], a[96:99], a[0:3], v[132:135]
ds_read_b128 a[128:131], v5 offset:6144
v_mfma_f32_16x16x32_bf16 v[156:159], a[96:99], a[4:7], v[156:159]
buffer_load_dwordx4 a[48:51], v2, s[40:43], s35 offen offset:0 sc1
v_mfma_f32_16x16x32_bf16 v[180:183], a[96:99], a[8:11], v[180:183]
ds_read_b128 a[132:135], v5 offset:7168
v_mfma_f32_16x16x32_bf16 v[204:207], a[96:99], a[12:15], v[204:207]
v_mfma_f32_16x16x32_bf16 v[208:211], a[100:103], a[12:15], v[208:211]
v_mfma_f32_16x16x32_bf16 v[184:187], a[100:103], a[8:11], v[184:187]
buffer_load_dwordx4 v1, s[4:7], s44 offen offset:1024 sc1 lds
v_mfma_f32_16x16x32_bf16 v[160:163], a[100:103], a[4:7], v[160:163]
ds_read_b128 a[136:139], v5 offset:8192
v_mfma_f32_16x16x32_bf16 v[136:139], a[100:103], a[0:3], v[136:139]
v_mfma_f32_16x16x32_bf16 v[140:143], a[104:107], a[0:3], v[140:143]
ds_read_b128 a[140:143], v5 offset:9216
v_mfma_f32_16x16x32_bf16 v[164:167], a[104:107], a[4:7], v[164:167]
buffer_load_dwordx4 a[52:55], v2, s[40:43], s35 offen offset:1024 sc1
v_mfma_f32_16x16x32_bf16 v[188:191], a[104:107], a[8:11], v[188:191]
ds_read_b128 a[144:147], v5 offset:10240
v_mfma_f32_16x16x32_bf16 v[212:215], a[104:107], a[12:15], v[212:215]
v_mfma_f32_16x16x32_bf16 v[216:219], a[108:111], a[12:15], v[216:219]
v_mfma_f32_16x16x32_bf16 v[192:195], a[108:111], a[8:11], v[192:195]
buffer_load_dwordx4 a[56:59], v2, s[40:43], s35 offen offset:2048 sc1
v_mfma_f32_16x16x32_bf16 v[168:171], a[108:111], a[4:7], v[168:171]
ds_read_b128 a[148:151], v5 offset:11264
v_mfma_f32_16x16x32_bf16 v[144:147], a[108:111], a[0:3], v[144:147]
v_mfma_f32_16x16x32_bf16 v[148:151], a[112:115], a[0:3], v[148:151]
v_mfma_f32_16x16x32_bf16 v[172:175], a[112:115], a[4:7], v[172:175]
buffer_load_dwordx4 v1, s[4:7], s44 offen offset:2048 sc1 lds
s_add_u32 s44, s28, 8
v_mfma_f32_16x16x32_bf16 v[196:199], a[112:115], a[8:11], v[196:199]
s_mul_i32 s45, s44, 3072
s_add_u32 m0, s45, 0
s_lshr_b32 s44, s44, 1
v_mfma_f32_16x16x32_bf16 v[220:223], a[112:115], a[12:15], v[220:223]
s_add_u32 s44, s44, 24
s_mul_i32 s44, s44, 6144
s_add_u32 s44, s44, s50
v_mfma_f32_16x16x32_bf16 v[224:227], a[116:119], a[12:15], v[224:227]
s_add_u32 s44, s44, 0x600000
v_mfma_f32_16x16x32_bf16 v[200:203], a[116:119], a[8:11], v[200:203]
buffer_load_dwordx4 a[60:63], v2, s[40:43], s35 offen offset:3072 sc1
s_add_u32 s35, s35, 4096
v_mfma_f32_16x16x32_bf16 v[176:179], a[116:119], a[4:7], v[176:179]
v_mfma_f32_16x16x32_bf16 v[152:155], a[116:119], a[0:3], v[152:155]
s_waitcnt vmcnt(11) lgkmcnt(0)
v_mfma_f32_16x16x32_bf16 v[132:135], a[128:131], a[16:19], v[132:135]
ds_read_b128 a[96:99], v5 offset:12288
v_mfma_f32_16x16x32_bf16 v[156:159], a[128:131], a[20:23], v[156:159]
buffer_load_dwordx4 a[0:3], v2, s[40:43], s35 offen offset:0 sc1
v_mfma_f32_16x16x32_bf16 v[180:183], a[128:131], a[24:27], v[180:183]
ds_read_b128 a[100:103], v5 offset:13312
v_mfma_f32_16x16x32_bf16 v[204:207], a[128:131], a[28:31], v[204:207]
v_mfma_f32_16x16x32_bf16 v[208:211], a[132:135], a[28:31], v[208:211]
v_mfma_f32_16x16x32_bf16 v[184:187], a[132:135], a[24:27], v[184:187]
buffer_load_dwordx4 a[4:7], v2, s[40:43], s35 offen offset:1024 sc1
v_mfma_f32_16x16x32_bf16 v[160:163], a[132:135], a[20:23], v[160:163]
ds_read_b128 a[104:107], v5 offset:14336
v_mfma_f32_16x16x32_bf16 v[136:139], a[132:135], a[16:19], v[136:139]
v_mfma_f32_16x16x32_bf16 v[140:143], a[136:139], a[16:19], v[140:143]
ds_read_b128 a[108:111], v5 offset:15360
v_mfma_f32_16x16x32_bf16 v[164:167], a[136:139], a[20:23], v[164:167]
v_mfma_f32_16x16x32_bf16 v[188:191], a[136:139], a[24:27], v[188:191]
buffer_load_dwordx4 v1, s[4:7], s44 offen offset:0 sc1 lds
v_mfma_f32_16x16x32_bf16 v[212:215], a[136:139], a[28:31], v[212:215]
ds_read_b128 a[112:115], v5 offset:16384
v_mfma_f32_16x16x32_bf16 v[216:219], a[140:143], a[28:31], v[216:219]
v_mfma_f32_16x16x32_bf16 v[192:195], a[140:143], a[24:27], v[192:195]
ds_read_b128 a[116:119], v5 offset:17408
v_mfma_f32_16x16x32_bf16 v[168:171], a[140:143], a[20:23], v[168:171]
v_mfma_f32_16x16x32_bf16 v[144:147], a[140:143], a[16:19], v[144:147]
buffer_load_dwordx4 a[8:11], v2, s[40:43], s35 offen offset:2048 sc1
v_mfma_f32_16x16x32_bf16 v[148:151], a[144:147], a[16:19], v[148:151]
v_mfma_f32_16x16x32_bf16 v[172:175], a[144:147], a[20:23], v[172:175]
v_mfma_f32_16x16x32_bf16 v[196:199], a[144:147], a[24:27], v[196:199]
v_mfma_f32_16x16x32_bf16 v[220:223], a[144:147], a[28:31], v[220:223]
v_mfma_f32_16x16x32_bf16 v[224:227], a[148:151], a[28:31], v[224:227]
buffer_load_dwordx4 a[12:15], v2, s[40:43], s35 offen offset:3072 sc1
s_add_u32 s35, s35, 4096
v_mfma_f32_16x16x32_bf16 v[200:203], a[148:151], a[24:27], v[200:203]
v_mfma_f32_16x16x32_bf16 v[176:179], a[148:151], a[20:23], v[176:179]
v_mfma_f32_16x16x32_bf16 v[152:155], a[148:151], a[16:19], v[152:155]
s_waitcnt vmcnt(11) lgkmcnt(0)
v_mfma_f32_16x16x32_bf16 v[132:135], a[96:99], a[32:35], v[132:135]
ds_read_b128 a[128:131], v5 offset:18432
v_mfma_f32_16x16x32_bf16 v[156:159], a[96:99], a[36:39], v[156:159]
buffer_load_dwordx4 a[16:19], v2, s[40:43], s35 offen offset:0 sc1
v_mfma_f32_16x16x32_bf16 v[180:183], a[96:99], a[40:43], v[180:183]
ds_read_b128 a[132:135], v5 offset:19456
v_mfma_f32_16x16x32_bf16 v[204:207], a[96:99], a[44:47], v[204:207]
v_mfma_f32_16x16x32_bf16 v[208:211], a[100:103], a[44:47], v[208:211]
v_mfma_f32_16x16x32_bf16 v[184:187], a[100:103], a[40:43], v[184:187]
buffer_load_dwordx4 v1, s[4:7], s44 offen offset:1024 sc1 lds
v_mfma_f32_16x16x32_bf16 v[160:163], a[100:103], a[36:39], v[160:163]
ds_read_b128 a[136:139], v5 offset:20480
v_mfma_f32_16x16x32_bf16 v[136:139], a[100:103], a[32:35], v[136:139]
v_mfma_f32_16x16x32_bf16 v[140:143], a[104:107], a[32:35], v[140:143]
ds_read_b128 a[140:143], v5 offset:21504
v_mfma_f32_16x16x32_bf16 v[164:167], a[104:107], a[36:39], v[164:167]
buffer_load_dwordx4 a[20:23], v2, s[40:43], s35 offen offset:1024 sc1
v_mfma_f32_16x16x32_bf16 v[188:191], a[104:107], a[40:43], v[188:191]
ds_read_b128 a[144:147], v5 offset:22528
v_mfma_f32_16x16x32_bf16 v[212:215], a[104:107], a[44:47], v[212:215]
v_mfma_f32_16x16x32_bf16 v[216:219], a[108:111], a[44:47], v[216:219]
v_mfma_f32_16x16x32_bf16 v[192:195], a[108:111], a[40:43], v[192:195]
buffer_load_dwordx4 a[24:27], v2, s[40:43], s35 offen offset:2048 sc1
v_mfma_f32_16x16x32_bf16 v[168:171], a[108:111], a[36:39], v[168:171]
ds_read_b128 a[148:151], v5 offset:23552
v_mfma_f32_16x16x32_bf16 v[144:147], a[108:111], a[32:35], v[144:147]
v_mfma_f32_16x16x32_bf16 v[148:151], a[112:115], a[32:35], v[148:151]
v_mfma_f32_16x16x32_bf16 v[172:175], a[112:115], a[36:39], v[172:175]
buffer_load_dwordx4 v1, s[4:7], s44 offen offset:2048 sc1 lds
s_add_u32 s44, s28, 12
v_mfma_f32_16x16x32_bf16 v[196:199], a[112:115], a[40:43], v[196:199]
s_mul_i32 s45, s44, 3072
s_add_u32 m0, s45, 0
s_lshr_b32 s44, s44, 1
v_mfma_f32_16x16x32_bf16 v[220:223], a[112:115], a[44:47], v[220:223]
s_add_u32 s44, s44, 24
s_mul_i32 s44, s44, 6144
s_add_u32 s44, s44, s50
v_mfma_f32_16x16x32_bf16 v[224:227], a[116:119], a[44:47], v[224:227]
s_add_u32 s44, s44, 0x600000
v_mfma_f32_16x16x32_bf16 v[200:203], a[116:119], a[40:43], v[200:203]
buffer_load_dwordx4 a[28:31], v2, s[40:43], s35 offen offset:3072 sc1
s_add_u32 s35, s35, 4096
v_mfma_f32_16x16x32_bf16 v[176:179], a[116:119], a[36:39], v[176:179]
v_mfma_f32_16x16x32_bf16 v[152:155], a[116:119], a[32:35], v[152:155]
s_waitcnt vmcnt(11) lgkmcnt(0)
v_mfma_f32_16x16x32_bf16 v[132:135], a[128:131], a[48:51], v[132:135]
ds_read_b128 a[96:99], v5 offset:24576
v_mfma_f32_16x16x32_bf16 v[156:159], a[128:131], a[52:55], v[156:159]
buffer_load_dwordx4 a[32:35], v2, s[40:43], s35 offen offset:0 sc1
v_mfma_f32_16x16x32_bf16 v[180:183], a[128:131], a[56:59], v[180:183]
ds_read_b128 a[100:103], v5 offset:25600
v_mfma_f32_16x16x32_bf16 v[204:207], a[128:131], a[60:63], v[204:207]
v_mfma_f32_16x16x32_bf16 v[208:211], a[132:135], a[60:63], v[208:211]
v_mfma_f32_16x16x32_bf16 v[184:187], a[132:135], a[56:59], v[184:187]
buffer_load_dwordx4 a[36:39], v2, s[40:43], s35 offen offset:1024 sc1
v_mfma_f32_16x16x32_bf16 v[160:163], a[132:135], a[52:55], v[160:163]
ds_read_b128 a[104:107], v5 offset:26624
v_mfma_f32_16x16x32_bf16 v[136:139], a[132:135], a[48:51], v[136:139]
v_mfma_f32_16x16x32_bf16 v[140:143], a[136:139], a[48:51], v[140:143]
ds_read_b128 a[108:111], v5 offset:27648
v_mfma_f32_16x16x32_bf16 v[164:167], a[136:139], a[52:55], v[164:167]
v_mfma_f32_16x16x32_bf16 v[188:191], a[136:139], a[56:59], v[188:191]
buffer_load_dwordx4 v1, s[4:7], s44 offen offset:0 sc1 lds
v_mfma_f32_16x16x32_bf16 v[212:215], a[136:139], a[60:63], v[212:215]
ds_read_b128 a[112:115], v5 offset:28672
v_mfma_f32_16x16x32_bf16 v[216:219], a[140:143], a[60:63], v[216:219]
v_mfma_f32_16x16x32_bf16 v[192:195], a[140:143], a[56:59], v[192:195]
ds_read_b128 a[116:119], v5 offset:29696
v_mfma_f32_16x16x32_bf16 v[168:171], a[140:143], a[52:55], v[168:171]
v_mfma_f32_16x16x32_bf16 v[144:147], a[140:143], a[48:51], v[144:147]
buffer_load_dwordx4 a[40:43], v2, s[40:43], s35 offen offset:2048 sc1
v_mfma_f32_16x16x32_bf16 v[148:151], a[144:147], a[48:51], v[148:151]
v_mfma_f32_16x16x32_bf16 v[172:175], a[144:147], a[52:55], v[172:175]
v_mfma_f32_16x16x32_bf16 v[196:199], a[144:147], a[56:59], v[196:199]
v_mfma_f32_16x16x32_bf16 v[220:223], a[144:147], a[60:63], v[220:223]
v_mfma_f32_16x16x32_bf16 v[224:227], a[148:151], a[60:63], v[224:227]
buffer_load_dwordx4 a[44:47], v2, s[40:43], s35 offen offset:3072 sc1
s_add_u32 s35, s35, 4096
v_mfma_f32_16x16x32_bf16 v[200:203], a[148:151], a[56:59], v[200:203]
v_mfma_f32_16x16x32_bf16 v[176:179], a[148:151], a[52:55], v[176:179]
v_mfma_f32_16x16x32_bf16 v[152:155], a[148:151], a[48:51], v[152:155]
s_waitcnt vmcnt(11) lgkmcnt(0)
v_mfma_f32_16x16x32_bf16 v[132:135], a[96:99], a[0:3], v[132:135]
ds_read_b128 a[128:131], v5 offset:30720
v_mfma_f32_16x16x32_bf16 v[156:159], a[96:99], a[4:7], v[156:159]
buffer_load_dwordx4 a[48:51], v2, s[40:43], s35 offen offset:0 sc1
v_mfma_f32_16x16x32_bf16 v[180:183], a[96:99], a[8:11], v[180:183]
ds_read_b128 a[132:135], v5 offset:31744
v_mfma_f32_16x16x32_bf16 v[204:207], a[96:99], a[12:15], v[204:207]
v_mfma_f32_16x16x32_bf16 v[208:211], a[100:103], a[12:15], v[208:211]
v_mfma_f32_16x16x32_bf16 v[184:187], a[100:103], a[8:11], v[184:187]
buffer_load_dwordx4 v1, s[4:7], s44 offen offset:1024 sc1 lds
v_mfma_f32_16x16x32_bf16 v[160:163], a[100:103], a[4:7], v[160:163]
ds_read_b128 a[136:139], v5 offset:32768
v_mfma_f32_16x16x32_bf16 v[136:139], a[100:103], a[0:3], v[136:139]
v_mfma_f32_16x16x32_bf16 v[140:143], a[104:107], a[0:3], v[140:143]
ds_read_b128 a[140:143], v5 offset:33792
v_mfma_f32_16x16x32_bf16 v[164:167], a[104:107], a[4:7], v[164:167]
buffer_load_dwordx4 a[52:55], v2, s[40:43], s35 offen offset:1024 sc1
v_mfma_f32_16x16x32_bf16 v[188:191], a[104:107], a[8:11], v[188:191]
ds_read_b128 a[144:147], v5 offset:34816
v_mfma_f32_16x16x32_bf16 v[212:215], a[104:107], a[12:15], v[212:215]
v_mfma_f32_16x16x32_bf16 v[216:219], a[108:111], a[12:15], v[216:219]
v_mfma_f32_16x16x32_bf16 v[192:195], a[108:111], a[8:11], v[192:195]
buffer_load_dwordx4 a[56:59], v2, s[40:43], s35 offen offset:2048 sc1
v_mfma_f32_16x16x32_bf16 v[168:171], a[108:111], a[4:7], v[168:171]
ds_read_b128 a[148:151], v5 offset:35840
v_mfma_f32_16x16x32_bf16 v[144:147], a[108:111], a[0:3], v[144:147]
v_mfma_f32_16x16x32_bf16 v[148:151], a[112:115], a[0:3], v[148:151]
v_mfma_f32_16x16x32_bf16 v[172:175], a[112:115], a[4:7], v[172:175]
buffer_load_dwordx4 v1, s[4:7], s44 offen offset:2048 sc1 lds
s_add_i32 s44, s28, 4
v_mfma_f32_16x16x32_bf16 v[196:199], a[112:115], a[8:11], v[196:199]
s_lshl_b32 s45, s44, 12
s_add_u32 m0, s45, 32768
s_and_b32 s45, s44, 7
v_mfma_f32_16x16x32_bf16 v[220:223], a[112:115], a[12:15], v[220:223]
s_cmp_eq_u32 s45, s3
s_cselect_b32 s45, 8, 0
s_add_u32 s44, s44, s45
v_mfma_f32_16x16x32_bf16 v[224:227], a[116:119], a[12:15], v[224:227]
s_and_b32 s44, s44, 31
s_lshl_b32 s44, s44, 12
s_add_u32 s44, s44, s51
v_mfma_f32_16x16x32_bf16 v[200:203], a[116:119], a[8:11], v[200:203]
buffer_load_dwordx4 a[60:63], v2, s[40:43], s35 offen offset:3072 sc1
s_add_u32 s35, s35, 4096
v_mfma_f32_16x16x32_bf16 v[176:179], a[116:119], a[4:7], v[176:179]
s_add_u32 s44, s44, 0x200000
v_mfma_f32_16x16x32_bf16 v[152:155], a[116:119], a[0:3], v[152:155]
s_waitcnt vmcnt(11) lgkmcnt(0)
v_mfma_f32_16x16x32_bf16 v[132:135], a[128:131], a[16:19], v[132:135]
ds_read_b128 a[96:99], v5 offset:36864
v_mfma_f32_16x16x32_bf16 v[156:159], a[128:131], a[20:23], v[156:159]
buffer_load_dwordx4 a[0:3], v2, s[40:43], s35 offen offset:0 sc1
v_mfma_f32_16x16x32_bf16 v[180:183], a[128:131], a[24:27], v[180:183]
ds_read_b128 a[100:103], v5 offset:37888
v_mfma_f32_16x16x32_bf16 v[204:207], a[128:131], a[28:31], v[204:207]
v_mfma_f32_16x16x32_bf16 v[208:211], a[132:135], a[28:31], v[208:211]
v_mfma_f32_16x16x32_bf16 v[184:187], a[132:135], a[24:27], v[184:187]
buffer_load_dwordx4 a[4:7], v2, s[40:43], s35 offen offset:1024 sc1
v_mfma_f32_16x16x32_bf16 v[160:163], a[132:135], a[20:23], v[160:163]
ds_read_b128 a[104:107], v5 offset:38912
v_mfma_f32_16x16x32_bf16 v[136:139], a[132:135], a[16:19], v[136:139]
v_mfma_f32_16x16x32_bf16 v[140:143], a[136:139], a[16:19], v[140:143]
ds_read_b128 a[108:111], v5 offset:39936
v_mfma_f32_16x16x32_bf16 v[164:167], a[136:139], a[20:23], v[164:167]
v_mfma_f32_16x16x32_bf16 v[188:191], a[136:139], a[24:27], v[188:191]
buffer_load_dwordx4 v1, s[4:7], s44 offen offset:0 sc1 lds
v_mfma_f32_16x16x32_bf16 v[212:215], a[136:139], a[28:31], v[212:215]
ds_read_b128 a[112:115], v5 offset:40960
v_mfma_f32_16x16x32_bf16 v[216:219], a[140:143], a[28:31], v[216:219]
v_mfma_f32_16x16x32_bf16 v[192:195], a[140:143], a[24:27], v[192:195]
ds_read_b128 a[116:119], v5 offset:41984
v_mfma_f32_16x16x32_bf16 v[168:171], a[140:143], a[20:23], v[168:171]
v_mfma_f32_16x16x32_bf16 v[144:147], a[140:143], a[16:19], v[144:147]
buffer_load_dwordx4 a[8:11], v2, s[40:43], s35 offen offset:2048 sc1
v_mfma_f32_16x16x32_bf16 v[148:151], a[144:147], a[16:19], v[148:151]
v_mfma_f32_16x16x32_bf16 v[172:175], a[144:147], a[20:23], v[172:175]
v_mfma_f32_16x16x32_bf16 v[196:199], a[144:147], a[24:27], v[196:199]
v_mfma_f32_16x16x32_bf16 v[220:223], a[144:147], a[28:31], v[220:223]
v_mfma_f32_16x16x32_bf16 v[224:227], a[148:151], a[28:31], v[224:227]
buffer_load_dwordx4 a[12:15], v2, s[40:43], s35 offen offset:3072 sc1
s_add_u32 s35, s35, 4096
v_mfma_f32_16x16x32_bf16 v[200:203], a[148:151], a[24:27], v[200:203]
v_mfma_f32_16x16x32_bf16 v[176:179], a[148:151], a[20:23], v[176:179]
v_mfma_f32_16x16x32_bf16 v[152:155], a[148:151], a[16:19], v[152:155]
s_waitcnt vmcnt(11) lgkmcnt(0)
v_mfma_f32_16x16x32_bf16 v[132:135], a[96:99], a[32:35], v[132:135]
ds_read_b128 a[128:131], v5 offset:43008
v_add_f32 v92, v92, v96
v_mfma_f32_16x16x32_bf16 v[156:159], a[96:99], a[36:39], v[156:159]
buffer_load_dwordx4 a[16:19], v2, s[40:43], s35 offen offset:0 sc1
v_mfma_f32_16x16x32_bf16 v[180:183], a[96:99], a[40:43], v[180:183]
ds_read_b128 a[132:135], v5 offset:44032
v_add_f32 v100, v100, v104
v_mfma_f32_16x16x32_bf16 v[204:207], a[96:99], a[44:47], v[204:207]
v_add_f32 v108, v108, v112
v_add_f32 v116, v116, v120
v_mfma_f32_16x16x32_bf16 v[208:211], a[100:103], a[44:47], v[208:211]
v_add_f32 v93, v93, v97
v_add_f32 v101, v101, v105
v_mfma_f32_16x16x32_bf16 v[184:187], a[100:103], a[40:43], v[184:187]
buffer_load_dwordx4 v1, s[4:7], s44 offen offset:1024 sc1 lds
v_mfma_f32_16x16x32_bf16 v[160:163], a[100:103], a[36:39], v[160:163]
ds_read_b128 a[136:139], v5 offset:45056
v_add_f32 v109, v109, v113
v_mfma_f32_16x16x32_bf16 v[136:139], a[100:103], a[32:35], v[136:139]
v_add_f32 v117, v117, v121
v_add_f32 v94, v94, v98
v_mfma_f32_16x16x32_bf16 v[140:143], a[104:107], a[32:35], v[140:143]
ds_read_b128 a[140:143], v5 offset:46080
v_add_f32 v102, v102, v106
v_mfma_f32_16x16x32_bf16 v[164:167], a[104:107], a[36:39], v[164:167]
buffer_load_dwordx4 a[20:23], v2, s[40:43], s35 offen offset:1024 sc1
v_mfma_f32_16x16x32_bf16 v[188:191], a[104:107], a[40:43], v[188:191]
ds_read_b128 a[144:147], v5 offset:47104
v_add_f32 v110, v110, v114
v_mfma_f32_16x16x32_bf16 v[212:215], a[104:107], a[44:47], v[212:215]
v_add_f32 v118, v118, v122
v_add_f32 v95, v95, v99
v_mfma_f32_16x16x32_bf16 v[216:219], a[108:111], a[44:47], v[216:219]
v_add_f32 v103, v103, v107
L_stub17:
s_cbranch_execz L_stub18
v_mfma_f32_16x16x32_bf16 v[192:195], a[108:111], a[40:43], v[192:195]
buffer_load_dwordx4 a[24:27], v2, s[40:43], s35 offen offset:2048 sc1
v_mfma_f32_16x16x32_bf16 v[168:171], a[108:111], a[36:39], v[168:171]
ds_read_b128 a[148:151], v5 offset:48128
v_add_f32 v111, v111, v115
v_mfma_f32_16x16x32_bf16 v[144:147], a[108:111], a[32:35], v[144:147]
v_add_f32 v119, v119, v123
v_add_f32_dpp v92, v92, v92 row_ror:8 row_mask:0xf bank_mask:0xf
v_mfma_f32_16x16x32_bf16 v[148:151], a[112:115], a[32:35], v[148:151]
v_add_f32_dpp v100, v100, v100 row_ror:8 row_mask:0xf bank_mask:0xf
v_mfma_f32_16x16x32_bf16 v[172:175], a[112:115], a[36:39], v[172:175]
buffer_load_dwordx4 v1, s[4:7], s44 offen offset:2048 sc1 lds
v_mfma_f32_16x16x32_bf16 v[196:199], a[112:115], a[40:43], v[196:199]
v_add_f32_dpp v108, v108, v108 row_ror:8 row_mask:0xf bank_mask:0xf
v_add_f32_dpp v116, v116, v116 row_ror:8 row_mask:0xf bank_mask:0xf
v_mfma_f32_16x16x32_bf16 v[220:223], a[112:115], a[44:47], v[220:223]
v_add_f32_dpp v93, v93, v93 row_ror:8 row_mask:0xf bank_mask:0xf
v_mfma_f32_16x16x32_bf16 v[224:227], a[116:119], a[44:47], v[224:227]
v_add_f32_dpp v101, v101, v101 row_ror:8 row_mask:0xf bank_mask:0xf
v_mfma_f32_16x16x32_bf16 v[200:203], a[116:119], a[40:43], v[200:203]
buffer_load_dwordx4 a[28:31], v2, s[40:43], s35 offen offset:3072 sc1
s_add_u32 s35, s35, 4096
v_mfma_f32_16x16x32_bf16 v[176:179], a[116:119], a[36:39], v[176:179]
v_add_f32_dpp v109, v109, v109 row_ror:8 row_mask:0xf bank_mask:0xf
v_add_f32_dpp v117, v117, v117 row_ror:8 row_mask:0xf bank_mask:0xf
v_mfma_f32_16x16x32_bf16 v[152:155], a[116:119], a[32:35], v[152:155]
s_waitcnt vmcnt(11) lgkmcnt(0)
s_barrier
v_mfma_f32_16x16x32_bf16 v[132:135], a[128:131], a[48:51], v[132:135]
v_add_u32 v5, 0, v1
v_add_f32_dpp v92, v94, v94 row_ror:8 row_mask:0xf bank_mask:0xc
v_mfma_f32_16x16x32_bf16 v[156:159], a[128:131], a[52:55], v[156:159]
buffer_load_dwordx4 a[32:35], v2, s[40:43], s35 offen offset:0 sc1
v_mfma_f32_16x16x32_bf16 v[180:183], a[128:131], a[56:59], v[180:183]
ds_read_b128 a[96:99], v5 offset:0
v_add_f32_dpp v100, v102, v102 row_ror:8 row_mask:0xf bank_mask:0xc
v_mfma_f32_16x16x32_bf16 v[204:207], a[128:131], a[60:63], v[204:207]
ds_read_b128 a[100:103], v5 offset:1024
v_add_f32_dpp v108, v110, v110 row_ror:8 row_mask:0xf bank_mask:0xc
v_mfma_f32_16x16x32_bf16 v[208:211], a[132:135], a[60:63], v[208:211]
v_add_f32_dpp v116, v118, v118 row_ror:8 row_mask:0xf bank_mask:0xc
v_add_f32_dpp v93, v95, v95 row_ror:8 row_mask:0xf bank_mask:0xc
v_mfma_f32_16x16x32_bf16 v[184:187], a[132:135], a[56:59], v[184:187]
buffer_load_dwordx4 a[36:39], v2, s[40:43], s35 offen offset:1024 sc1
v_mfma_f32_16x16x32_bf16 v[160:163], a[132:135], a[52:55], v[160:163]
ds_read_b128 a[104:107], v5 offset:2048
v_add_f32_dpp v101, v103, v103 row_ror:8 row_mask:0xf bank_mask:0xc
v_mfma_f32_16x16x32_bf16 v[136:139], a[132:135], a[48:51], v[136:139]
v_add_f32_dpp v109, v111, v111 row_ror:8 row_mask:0xf bank_mask:0xc
v_add_f32_dpp v117, v119, v119 row_ror:8 row_mask:0xf bank_mask:0xc
v_mfma_f32_16x16x32_bf16 v[140:143], a[136:139], a[48:51], v[140:143]
ds_read_b128 a[108:111], v5 offset:3072
v_mfma_f32_16x16x32_bf16 v[164:167], a[136:139], a[52:55], v[164:167]
v_permlane32_swap_b32 v92, v93
v_mfma_f32_16x16x32_bf16 v[188:191], a[136:139], a[56:59], v[188:191]
buffer_load_dwordx4 v1, s[4:7], s44 offen offset:3072 sc1 lds
s_add_i32 s44, s28, 8
v_mfma_f32_16x16x32_bf16 v[212:215], a[136:139], a[60:63], v[212:215]
s_lshl_b32 s45, s44, 12
s_add_u32 m0, s45, 32768
s_and_b32 s45, s44, 7
v_mfma_f32_16x16x32_bf16 v[216:219], a[140:143], a[60:63], v[216:219]
s_cmp_eq_u32 s45, s3
s_cselect_b32 s45, 8, 0
s_add_u32 s44, s44, s45
v_mfma_f32_16x16x32_bf16 v[192:195], a[140:143], a[56:59], v[192:195]
s_and_b32 s44, s44, 31
s_lshl_b32 s44, s44, 12
s_add_u32 s44, s44, s51
v_mfma_f32_16x16x32_bf16 v[168:171], a[140:143], a[52:55], v[168:171]
s_add_u32 s44, s44, 0x200000
ds_read_b128 a[112:115], v5 offset:4096
v_mfma_f32_16x16x32_bf16 v[144:147], a[140:143], a[48:51], v[144:147]
buffer_load_dwordx4 a[40:43], v2, s[40:43], s35 offen offset:2048 sc1
v_mfma_f32_16x16x32_bf16 v[148:151], a[144:147], a[48:51], v[148:151]
ds_read_b128 a[116:119], v5 offset:5120
v_mfma_f32_16x16x32_bf16 v[172:175], a[144:147], a[52:55], v[172:175]
v_permlane32_swap_b32 v100, v101
v_mfma_f32_16x16x32_bf16 v[196:199], a[144:147], a[56:59], v[196:199]
v_permlane32_swap_b32 v108, v109
v_mfma_f32_16x16x32_bf16 v[220:223], a[144:147], a[60:63], v[220:223]
v_permlane32_swap_b32 v116, v117
v_mfma_f32_16x16x32_bf16 v[224:227], a[148:151], a[60:63], v[224:227]
buffer_load_dwordx4 a[44:47], v2, s[40:43], s35 offen offset:3072 sc1
s_add_u32 s35, s35, 4096
v_mfma_f32_16x16x32_bf16 v[200:203], a[148:151], a[56:59], v[200:203]
v_add_f32 v92, v92, v93
v_add_f32 v100, v100, v101
v_mfma_f32_16x16x32_bf16 v[176:179], a[148:151], a[52:55], v[176:179]
v_add_f32 v108, v108, v109
v_add_f32 v116, v116, v117
v_mfma_f32_16x16x32_bf16 v[152:155], a[148:151], a[48:51], v[152:155]
v_mov_b32 v94, v92
s_waitcnt vmcnt(11) lgkmcnt(0)
v_mfma_f32_16x16x32_bf16 v[132:135], a[96:99], a[0:3], v[132:135]
ds_read_b128 a[128:131], v5 offset:6144
v_mov_b32 v102, v100
v_mfma_f32_16x16x32_bf16 v[156:159], a[96:99], a[4:7], v[156:159]
buffer_load_dwordx4 a[48:51], v2, s[40:43], s35 offen offset:0 sc1
v_mfma_f32_16x16x32_bf16 v[180:183], a[96:99], a[8:11], v[180:183]
ds_read_b128 a[132:135], v5 offset:7168
v_mov_b32 v110, v108
v_mfma_f32_16x16x32_bf16 v[204:207], a[96:99], a[12:15], v[204:207]
v_mov_b32 v118, v116
v_mfma_f32_16x16x32_bf16 v[208:211], a[100:103], a[12:15], v[208:211]
v_permlane16_swap_b32 v92, v94
v_mfma_f32_16x16x32_bf16 v[184:187], a[100:103], a[8:11], v[184:187]
buffer_load_dwordx4 v1, s[4:7], s44 offen offset:0 sc1 lds
v_mfma_f32_16x16x32_bf16 v[160:163], a[100:103], a[4:7], v[160:163]
ds_read_b128 a[136:139], v5 offset:8192
v_mfma_f32_16x16x32_bf16 v[136:139], a[100:103], a[0:3], v[136:139]
v_permlane16_swap_b32 v100, v102
v_mfma_f32_16x16x32_bf16 v[140:143], a[104:107], a[0:3], v[140:143]
ds_read_b128 a[140:143], v5 offset:9216
v_mfma_f32_16x16x32_bf16 v[164:167], a[104:107], a[4:7], v[164:167]
buffer_load_dwordx4 a[52:55], v2, s[40:43], s35 offen offset:1024 sc1
v_mfma_f32_16x16x32_bf16 v[188:191], a[104:107], a[8:11], v[188:191]
ds_read_b128 a[144:147], v5 offset:10240
v_mfma_f32_16x16x32_bf16 v[212:215], a[104:107], a[12:15], v[212:215]
v_permlane16_swap_b32 v108, v110
v_mfma_f32_16x16x32_bf16 v[216:219], a[108:111], a[12:15], v[216:219]
v_permlane16_swap_b32 v116, v118
v_mfma_f32_16x16x32_bf16 v[192:195], a[108:111], a[8:11], v[192:195]
buffer_load_dwordx4 a[56:59], v2, s[40:43], s35 offen offset:2048 sc1
v_mfma_f32_16x16x32_bf16 v[168:171], a[108:111], a[4:7], v[168:171]
ds_read_b128 a[148:151], v5 offset:11264
v_add_f32 v92, v92, v94
v_mfma_f32_16x16x32_bf16 v[144:147], a[108:111], a[0:3], v[144:147]
v_add_f32 v100, v100, v102
v_add_f32 v108, v108, v110
v_mfma_f32_16x16x32_bf16 v[148:151], a[112:115], a[0:3], v[148:151]
v_add_f32 v116, v116, v118
v_mov_b32 v94, v92
v_mfma_f32_16x16x32_bf16 v[172:175], a[112:115], a[4:7], v[172:175]
buffer_load_dwordx4 v1, s[4:7], s44 offen offset:1024 sc1 lds
v_mfma_f32_16x16x32_bf16 v[196:199], a[112:115], a[8:11], v[196:199]
v_mov_b32 v102, v100
v_mov_b32 v110, v108
v_mfma_f32_16x16x32_bf16 v[220:223], a[112:115], a[12:15], v[220:223]
v_mov_b32 v118, v116
v_mfma_f32_16x16x32_bf16 v[224:227], a[116:119], a[12:15], v[224:227]
v_permlane32_swap_b32 v92, v94
v_mfma_f32_16x16x32_bf16 v[200:203], a[116:119], a[8:11], v[200:203]
buffer_load_dwordx4 a[60:63], v2, s[40:43], s35 offen offset:3072 sc1
s_add_u32 s35, s35, 4096
v_mfma_f32_16x16x32_bf16 v[176:179], a[116:119], a[4:7], v[176:179]
v_permlane32_swap_b32 v100, v102
v_mfma_f32_16x16x32_bf16 v[152:155], a[116:119], a[0:3], v[152:155]
s_waitcnt vmcnt(11) lgkmcnt(0)
v_mfma_f32_16x16x32_bf16 v[132:135], a[128:131], a[16:19], v[132:135]
ds_read_b128 a[96:99], v5 offset:12288
v_mfma_f32_16x16x32_bf16 v[156:159], a[128:131], a[20:23], v[156:159]
buffer_load_dwordx4 a[0:3], v2, s[40:43], s35 offen offset:0 sc1
v_mfma_f32_16x16x32_bf16 v[180:183], a[128:131], a[24:27], v[180:183]
ds_read_b128 a[100:103], v5 offset:13312
v_mfma_f32_16x16x32_bf16 v[204:207], a[128:131], a[28:31], v[204:207]
v_permlane32_swap_b32 v108, v110
v_mfma_f32_16x16x32_bf16 v[208:211], a[132:135], a[28:31], v[208:211]
v_permlane32_swap_b32 v116, v118
v_mfma_f32_16x16x32_bf16 v[184:187], a[132:135], a[24:27], v[184:187]
buffer_load_dwordx4 a[4:7], v2, s[40:43], s35 offen offset:1024 sc1
v_mfma_f32_16x16x32_bf16 v[160:163], a[132:135], a[20:23], v[160:163]
ds_read_b128 a[104:107], v5 offset:14336
v_mul_f32 v82, 0xba800000, v92
v_mfma_f32_16x16x32_bf16 v[136:139], a[132:135], a[16:19], v[136:139]
v_mul_f32 v84, 0xba800000, v100
v_mul_f32 v86, 0xba800000, v108
v_mfma_f32_16x16x32_bf16 v[140:143], a[136:139], a[16:19], v[140:143]
ds_read_b128 a[108:111], v5 offset:15360
v_mul_f32 v88, 0xba800000, v116
v_mfma_f32_16x16x32_bf16 v[164:167], a[136:139], a[20:23], v[164:167]
v_mul_f32 v94, 0x3a800000, v94
v_mul_f32 v102, 0x3a800000, v102
v_mfma_f32_16x16x32_bf16 v[188:191], a[136:139], a[24:27], v[188:191]
buffer_load_dwordx4 v1, s[4:7], s44 offen offset:2048 sc1 lds
v_mfma_f32_16x16x32_bf16 v[212:215], a[136:139], a[28:31], v[212:215]
ds_read_b128 a[112:115], v5 offset:16384
v_mul_f32 v110, 0x3a800000, v110
v_mfma_f32_16x16x32_bf16 v[216:219], a[140:143], a[28:31], v[216:219]
v_mul_f32 v118, 0x3a800000, v118
v_fma_f32 v94, -v82, v82, v94
v_mfma_f32_16x16x32_bf16 v[192:195], a[140:143], a[24:27], v[192:195]
ds_read_b128 a[116:119], v5 offset:17408
v_fma_f32 v102, -v84, v84, v102
v_mfma_f32_16x16x32_bf16 v[168:171], a[140:143], a[20:23], v[168:171]
v_fma_f32 v110, -v86, v86, v110
v_fma_f32 v118, -v88, v88, v118
v_mfma_f32_16x16x32_bf16 v[144:147], a[140:143], a[16:19], v[144:147]
buffer_load_dwordx4 a[8:11], v2, s[40:43], s35 offen offset:2048 sc1
v_mfma_f32_16x16x32_bf16 v[148:151], a[144:147], a[16:19], v[148:151]
v_max_f32 v94, 0, v94
v_max_f32 v102, 0, v102
v_mfma_f32_16x16x32_bf16 v[172:175], a[144:147], a[20:23], v[172:175]
v_max_f32 v110, 0, v110
v_max_f32 v118, 0, v118
v_mfma_f32_16x16x32_bf16 v[196:199], a[144:147], a[24:27], v[196:199]
v_add_f32 v94, 0x3727c5ac, v94
v_add_f32 v102, 0x3727c5ac, v102
v_mfma_f32_16x16x32_bf16 v[220:223], a[144:147], a[28:31], v[220:223]
v_add_f32 v110, 0x3727c5ac, v110
v_add_f32 v118, 0x3727c5ac, v118
v_mfma_f32_16x16x32_bf16 v[224:227], a[148:151], a[28:31], v[224:227]
buffer_load_dwordx4 a[12:15], v2, s[40:43], s35 offen offset:3072 sc1
s_add_u32 s35, s35, 4096
v_mfma_f32_16x16x32_bf16 v[200:203], a[148:151], a[24:27], v[200:203]
v_rsq_f32 v83, v94
v_mfma_f32_16x16x32_bf16 v[176:179], a[148:151], a[20:23], v[176:179]
v_rsq_f32 v85, v102
v_mfma_f32_16x16x32_bf16 v[152:155], a[148:151], a[16:19], v[152:155]
s_waitcnt vmcnt(11) lgkmcnt(0)
v_mfma_f32_16x16x32_bf16 v[132:135], a[96:99], a[32:35], v[132:135]
ds_read_b128 a[128:131], v5 offset:18432
v_mfma_f32_16x16x32_bf16 v[156:159], a[96:99], a[36:39], v[156:159]
buffer_load_dwordx4 a[16:19], v2, s[40:43], s35 offen offset:0 sc1
v_mfma_f32_16x16x32_bf16 v[180:183], a[96:99], a[40:43], v[180:183]
ds_read_b128 a[132:135], v5 offset:19456
v_mfma_f32_16x16x32_bf16 v[204:207], a[96:99], a[44:47], v[204:207]
v_rsq_f32 v87, v110
v_mfma_f32_16x16x32_bf16 v[208:211], a[100:103], a[44:47], v[208:211]
v_rsq_f32 v89, v118
v_mfma_f32_16x16x32_bf16 v[184:187], a[100:103], a[40:43], v[184:187]
buffer_load_dwordx4 v1, s[4:7], s44 offen offset:3072 sc1 lds
s_add_i32 s44, s28, 12
v_mfma_f32_16x16x32_bf16 v[160:163], a[100:103], a[36:39], v[160:163]
s_lshl_b32 s45, s44, 12
s_add_u32 m0, s45, 32768
s_and_b32 s45, s44, 7
v_mfma_f32_16x16x32_bf16 v[136:139], a[100:103], a[32:35], v[136:139]
s_cmp_eq_u32 s45, s3
s_cselect_b32 s45, 8, 0
s_add_u32 s44, s44, s45
v_mfma_f32_16x16x32_bf16 v[140:143], a[104:107], a[32:35], v[140:143]
s_and_b32 s44, s44, 31
s_lshl_b32 s44, s44, 12
s_add_u32 s44, s44, s51
v_mfma_f32_16x16x32_bf16 v[164:167], a[104:107], a[36:39], v[164:167]
buffer_load_dwordx4 a[20:23], v2, s[40:43], s35 offen offset:1024 sc1
s_add_u32 s44, s44, 0x200000
v_mfma_f32_16x16x32_bf16 v[188:191], a[104:107], a[40:43], v[188:191]
ds_read_b128 a[136:139], v5 offset:20480
v_fmac_f32 v132, v48, v82
v_mfma_f32_16x16x32_bf16 v[212:215], a[104:107], a[44:47], v[212:215]
ds_read_b128 a[140:143], v5 offset:21504
v_fmac_f32 v156, v48, v84
v_mfma_f32_16x16x32_bf16 v[216:219], a[108:111], a[44:47], v[216:219]
ds_read_b128 a[144:147], v5 offset:22528
v_fmac_f32 v180, v48, v86
v_mfma_f32_16x16x32_bf16 v[192:195], a[108:111], a[40:43], v[192:195]
buffer_load_dwordx4 a[24:27], v2, s[40:43], s35 offen offset:2048 sc1
v_mfma_f32_16x16x32_bf16 v[168:171], a[108:111], a[36:39], v[168:171]
ds_read_b128 a[148:151], v5 offset:23552
v_fmac_f32 v204, v48, v88
v_mfma_f32_16x16x32_bf16 v[144:147], a[108:111], a[32:35], v[144:147]
v_fmac_f32 v208, v52, v88
v_fmac_f32 v184, v52, v86
v_mfma_f32_16x16x32_bf16 v[148:151], a[112:115], a[32:35], v[148:151]
v_fmac_f32 v160, v52, v84
v_fmac_f32 v136, v52, v82
v_mfma_f32_16x16x32_bf16 v[172:175], a[112:115], a[36:39], v[172:175]
buffer_load_dwordx4 v1, s[4:7], s44 offen offset:0 sc1 lds
v_mfma_f32_16x16x32_bf16 v[196:199], a[112:115], a[40:43], v[196:199]
v_fmac_f32 v140, v56, v82
v_fmac_f32 v164, v56, v84
v_mfma_f32_16x16x32_bf16 v[220:223], a[112:115], a[44:47], v[220:223]
v_fmac_f32 v188, v56, v86
v_mfma_f32_16x16x32_bf16 v[224:227], a[116:119], a[44:47], v[224:227]
v_fmac_f32 v212, v56, v88
v_mfma_f32_16x16x32_bf16 v[200:203], a[116:119], a[40:43], v[200:203]
buffer_load_dwordx4 a[28:31], v2, s[40:43], s35 offen offset:3072 sc1
s_add_u32 s35, s35, 4096
v_mfma_f32_16x16x32_bf16 v[176:179], a[116:119], a[36:39], v[176:179]
v_fmac_f32 v216, v60, v88
v_fmac_f32 v192, v60, v86
v_mfma_f32_16x16x32_bf16 v[152:155], a[116:119], a[32:35], v[152:155]
v_fmac_f32 v168, v60, v84
s_waitcnt vmcnt(11) lgkmcnt(0)
v_mfma_f32_16x16x32_bf16 v[132:135], a[128:131], a[48:51], v[132:135]
ds_read_b128 a[96:99], v5 offset:24576
v_fmac_f32 v144, v60, v82
v_mfma_f32_16x16x32_bf16 v[156:159], a[128:131], a[52:55], v[156:159]
buffer_load_dwordx4 a[32:35], v2, s[40:43], s35 offen offset:0 sc1
v_mfma_f32_16x16x32_bf16 v[180:183], a[128:131], a[56:59], v[180:183]
ds_read_b128 a[100:103], v5 offset:25600
v_fmac_f32 v148, v64, v82
v_mfma_f32_16x16x32_bf16 v[204:207], a[128:131], a[60:63], v[204:207]
v_fmac_f32 v172, v64, v84
v_fmac_f32 v196, v64, v86
v_mfma_f32_16x16x32_bf16 v[208:211], a[132:135], a[60:63], v[208:211]
v_fmac_f32 v220, v64, v88
v_mfma_f32_16x16x32_bf16 v[184:187], a[132:135], a[56:59], v[184:187]
buffer_load_dwordx4 a[36:39], v2, s[40:43], s35 offen offset:1024 sc1
v_mfma_f32_16x16x32_bf16 v[160:163], a[132:135], a[52:55], v[160:163]
ds_read_b128 a[104:107], v5 offset:26624
v_fmac_f32 v224, v68, v88
v_mfma_f32_16x16x32_bf16 v[136:139], a[132:135], a[48:51], v[136:139]
v_fmac_f32 v200, v68, v86
v_fmac_f32 v176, v68, v84
v_mfma_f32_16x16x32_bf16 v[140:143], a[136:139], a[48:51], v[140:143]
ds_read_b128 a[108:111], v5 offset:27648
v_fmac_f32 v152, v68, v82
v_mfma_f32_16x16x32_bf16 v[164:167], a[136:139], a[52:55], v[164:167]
v_fmac_f32 v133, v49, v82
v_mfma_f32_16x16x32_bf16 v[188:191], a[136:139], a[56:59], v[188:191]
buffer_load_dwordx4 v1, s[4:7], s44 offen offset:1024 sc1 lds
v_mfma_f32_16x16x32_bf16 v[212:215], a[136:139], a[60:63], v[212:215]
ds_read_b128 a[112:115], v5 offset:28672
v_fmac_f32 v157, v49, v84
v_mfma_f32_16x16x32_bf16 v[216:219], a[140:143], a[60:63], v[216:219]
v_fmac_f32 v181, v49, v86
v_fmac_f32 v205, v49, v88
v_mfma_f32_16x16x32_bf16 v[192:195], a[140:143], a[56:59], v[192:195]
ds_read_b128 a[116:119], v5 offset:29696
v_fmac_f32 v209, v53, v88
v_mfma_f32_16x16x32_bf16 v[168:171], a[140:143], a[52:55], v[168:171]
v_fmac_f32 v185, v53, v86
v_mfma_f32_16x16x32_bf16 v[144:147], a[140:143], a[48:51], v[144:147]
buffer_load_dwordx4 a[40:43], v2, s[40:43], s35 offen offset:2048 sc1
v_mfma_f32_16x16x32_bf16 v[148:151], a[144:147], a[48:51], v[148:151]
v_fmac_f32 v161, v53, v84
v_fmac_f32 v137, v53, v82
v_mfma_f32_16x16x32_bf16 v[172:175], a[144:147], a[52:55], v[172:175]
v_fmac_f32 v141, v57, v82
v_mfma_f32_16x16x32_bf16 v[196:199], a[144:147], a[56:59], v[196:199]
v_fmac_f32 v165, v57, v84
v_mfma_f32_16x16x32_bf16 v[220:223], a[144:147], a[60:63], v[220:223]
v_fmac_f32 v189, v57, v86
v_mfma_f32_16x16x32_bf16 v[224:227], a[148:151], a[60:63], v[224:227]
buffer_load_dwordx4 a[44:47], v2, s[40:43], s35 offen offset:3072 sc1
s_add_u32 s35, s35, 4096
v_mfma_f32_16x16x32_bf16 v[200:203], a[148:151], a[56:59], v[200:203]
v_fmac_f32 v213, v57, v88
v_fmac_f32 v217, v61, v88
v_mfma_f32_16x16x32_bf16 v[176:179], a[148:151], a[52:55], v[176:179]
v_fmac_f32 v193, v61, v86
v_mfma_f32_16x16x32_bf16 v[152:155], a[148:151], a[48:51], v[152:155]
v_fmac_f32 v169, v61, v84
s_waitcnt vmcnt(11) lgkmcnt(0)
v_mfma_f32_16x16x32_bf16 v[132:135], a[96:99], a[0:3], v[132:135]
ds_read_b128 a[128:131], v5 offset:30720
v_fmac_f32 v145, v61, v82
v_mfma_f32_16x16x32_bf16 v[156:159], a[96:99], a[4:7], v[156:159]
buffer_load_dwordx4 a[48:51], v2, s[40:43], s35 offen offset:0 sc1
v_mfma_f32_16x16x32_bf16 v[180:183], a[96:99], a[8:11], v[180:183]
ds_read_b128 a[132:135], v5 offset:31744
v_fmac_f32 v149, v65, v82
v_mfma_f32_16x16x32_bf16 v[204:207], a[96:99], a[12:15], v[204:207]
v_fmac_f32 v173, v65, v84
v_fmac_f32 v197, v65, v86
v_mfma_f32_16x16x32_bf16 v[208:211], a[100:103], a[12:15], v[208:211]
v_fmac_f32 v221, v65, v88
v_mfma_f32_16x16x32_bf16 v[184:187], a[100:103], a[8:11], v[184:187]
buffer_load_dwordx4 v1, s[4:7], s44 offen offset:2048 sc1 lds
v_mfma_f32_16x16x32_bf16 v[160:163], a[100:103], a[4:7], v[160:163]
ds_read_b128 a[136:139], v5 offset:32768
v_fmac_f32 v225, v69, v88
v_mfma_f32_16x16x32_bf16 v[136:139], a[100:103], a[0:3], v[136:139]
v_fmac_f32 v201, v69, v86
v_fmac_f32 v177, v69, v84
v_mfma_f32_16x16x32_bf16 v[140:143], a[104:107], a[0:3], v[140:143]
ds_read_b128 a[140:143], v5 offset:33792
v_fmac_f32 v153, v69, v82
v_mfma_f32_16x16x32_bf16 v[164:167], a[104:107], a[4:7], v[164:167]
buffer_load_dwordx4 a[52:55], v2, s[40:43], s35 offen offset:1024 sc1
v_mfma_f32_16x16x32_bf16 v[188:191], a[104:107], a[8:11], v[188:191]
ds_read_b128 a[144:147], v5 offset:34816
v_fmac_f32 v134, v50, v82
v_mfma_f32_16x16x32_bf16 v[212:215], a[104:107], a[12:15], v[212:215]
v_fmac_f32 v158, v50, v84
v_fmac_f32 v182, v50, v86
v_mfma_f32_16x16x32_bf16 v[216:219], a[108:111], a[12:15], v[216:219]
v_fmac_f32 v206, v50, v88
v_mfma_f32_16x16x32_bf16 v[192:195], a[108:111], a[8:11], v[192:195]
buffer_load_dwordx4 a[56:59], v2, s[40:43], s35 offen offset:2048 sc1
v_mfma_f32_16x16x32_bf16 v[168:171], a[108:111], a[4:7], v[168:171]
ds_read_b128 a[148:151], v5 offset:35840
v_fmac_f32 v210, v54, v88
v_mfma_f32_16x16x32_bf16 v[144:147], a[108:111], a[0:3], v[144:147]
v_fmac_f32 v186, v54, v86
v_fmac_f32 v162, v54, v84
v_mfma_f32_16x16x32_bf16 v[148:151], a[112:115], a[0:3], v[148:151]
v_fmac_f32 v138, v54, v82
v_mfma_f32_16x16x32_bf16 v[172:175], a[112:115], a[4:7], v[172:175]
buffer_load_dwordx4 v1, s[4:7], s44 offen offset:3072 sc1 lds
s_add_i32 s44, s28, 28
v_mfma_f32_16x16x32_bf16 v[196:199], a[112:115], a[8:11], v[196:199]
s_lshl_b32 s45, s44, 12
s_add_u32 m0, s45, 32768
s_and_b32 s45, s44, 7
v_mfma_f32_16x16x32_bf16 v[220:223], a[112:115], a[12:15], v[220:223]
s_cmp_eq_u32 s45, s3
s_cselect_b32 s45, 8, 0
s_add_u32 s44, s44, s45
v_mfma_f32_16x16x32_bf16 v[224:227], a[116:119], a[12:15], v[224:227]
s_and_b32 s44, s44, 31
s_lshl_b32 s44, s44, 12
s_add_u32 s44, s44, s51
v_mfma_f32_16x16x32_bf16 v[200:203], a[116:119], a[8:11], v[200:203]
buffer_load_dwordx4 a[60:63], v2, s[40:43], s35 offen offset:3072 sc1
s_add_u32 s35, s35, 4096
v_mfma_f32_16x16x32_bf16 v[176:179], a[116:119], a[4:7], v[176:179]
s_add_u32 s44, s44, 0x200000
v_fmac_f32 v142, v58, v82
v_mfma_f32_16x16x32_bf16 v[152:155], a[116:119], a[0:3], v[152:155]
v_fmac_f32 v166, v58, v84
s_waitcnt vmcnt(11) lgkmcnt(0)
v_mfma_f32_16x16x32_bf16 v[132:135], a[128:131], a[16:19], v[132:135]
ds_read_b128 a[96:99], v5 offset:36864
v_fmac_f32 v190, v58, v86
v_mfma_f32_16x16x32_bf16 v[156:159], a[128:131], a[20:23], v[156:159]
buffer_load_dwordx4 v1, s[4:7], s44 offen offset:0 sc1 lds
v_mfma_f32_16x16x32_bf16 v[180:183], a[128:131], a[24:27], v[180:183]
ds_read_b128 a[100:103], v5 offset:37888
v_fmac_f32 v214, v58, v88
v_mfma_f32_16x16x32_bf16 v[204:207], a[128:131], a[28:31], v[204:207]
v_fmac_f32 v218, v62, v88
v_fmac_f32 v194, v62, v86
v_mfma_f32_16x16x32_bf16 v[208:211], a[132:135], a[28:31], v[208:211]
v_fmac_f32 v170, v62, v84
v_fmac_f32 v146, v62, v82
v_mfma_f32_16x16x32_bf16 v[184:187], a[132:135], a[24:27], v[184:187]
buffer_load_dwordx4 v1, s[4:7], s44 offen offset:1024 sc1 lds
v_mfma_f32_16x16x32_bf16 v[160:163], a[132:135], a[20:23], v[160:163]
ds_read_b128 a[104:107], v5 offset:38912
v_fmac_f32 v150, v66, v82
v_mfma_f32_16x16x32_bf16 v[136:139], a[132:135], a[16:19], v[136:139]
v_fmac_f32 v174, v66, v84
v_fmac_f32 v198, v66, v86
v_mfma_f32_16x16x32_bf16 v[140:143], a[136:139], a[16:19], v[140:143]
ds_read_b128 a[108:111], v5 offset:39936
v_fmac_f32 v222, v66, v88
v_mfma_f32_16x16x32_bf16 v[164:167], a[136:139], a[20:23], v[164:167]
v_fmac_f32 v226, v70, v88
v_fmac_f32 v202, v70, v86
v_mfma_f32_16x16x32_bf16 v[188:191], a[136:139], a[24:27], v[188:191]
buffer_load_dwordx4 v1, s[4:7], s44 offen offset:2048 sc1 lds
v_mfma_f32_16x16x32_bf16 v[212:215], a[136:139], a[28:31], v[212:215]
ds_read_b128 a[112:115], v5 offset:40960
v_fmac_f32 v178, v70, v84
v_mfma_f32_16x16x32_bf16 v[216:219], a[140:143], a[28:31], v[216:219]
v_fmac_f32 v154, v70, v82
v_fmac_f32 v135, v51, v82
v_mfma_f32_16x16x32_bf16 v[192:195], a[140:143], a[24:27], v[192:195]
ds_read_b128 a[116:119], v5 offset:41984
v_fmac_f32 v159, v51, v84
v_mfma_f32_16x16x32_bf16 v[168:171], a[140:143], a[20:23], v[168:171]
v_fmac_f32 v183, v51, v86
v_fmac_f32 v207, v51, v88
v_mfma_f32_16x16x32_bf16 v[144:147], a[140:143], a[16:19], v[144:147]
buffer_load_dwordx4 v1, s[4:7], s44 offen offset:3072 sc1 lds
s_add_i32 s44, s28, 16
v_mfma_f32_16x16x32_bf16 v[148:151], a[144:147], a[16:19], v[148:151]
s_lshl_b32 s45, s44, 12
s_add_u32 m0, s45, 32768
s_and_b32 s45, s44, 7
v_mfma_f32_16x16x32_bf16 v[172:175], a[144:147], a[20:23], v[172:175]
s_cmp_eq_u32 s45, s3
s_cselect_b32 s45, 8, 0
s_add_u32 s44, s44, s45
v_mfma_f32_16x16x32_bf16 v[196:199], a[144:147], a[24:27], v[196:199]
s_and_b32 s44, s44, 31
s_lshl_b32 s44, s44, 12
s_add_u32 s44, s44, s51
v_mfma_f32_16x16x32_bf16 v[220:223], a[144:147], a[28:31], v[220:223]
s_add_u32 s44, s44, 0x200000
v_fmac_f32 v211, v55, v88
v_mfma_f32_16x16x32_bf16 v[224:227], a[148:151], a[28:31], v[224:227]
buffer_load_dwordx4 v1, s[4:7], s44 offen offset:0 sc1 lds
v_mfma_f32_16x16x32_bf16 v[200:203], a[148:151], a[24:27], v[200:203]
v_fmac_f32 v187, v55, v86
v_fmac_f32 v163, v55, v84
v_mfma_f32_16x16x32_bf16 v[176:179], a[148:151], a[20:23], v[176:179]
v_fmac_f32 v139, v55, v82
v_fmac_f32 v143, v59, v82
v_mfma_f32_16x16x32_bf16 v[152:155], a[148:151], a[16:19], v[152:155]
v_fmac_f32 v167, v59, v84
s_waitcnt vmcnt(11) lgkmcnt(0)
v_mfma_f32_16x16x32_bf16 v[132:135], a[96:99], a[32:35], v[132:135]
ds_read_b128 a[128:131], v5 offset:43008
v_fmac_f32 v191, v59, v86
v_mfma_f32_16x16x32_bf16 v[156:159], a[96:99], a[36:39], v[156:159]
buffer_load_dwordx4 v1, s[4:7], s44 offen offset:1024 sc1 lds
v_mfma_f32_16x16x32_bf16 v[180:183], a[96:99], a[40:43], v[180:183]
ds_read_b128 a[132:135], v5 offset:44032
v_fmac_f32 v215, v59, v88
v_mfma_f32_16x16x32_bf16 v[204:207], a[96:99], a[44:47], v[204:207]
v_fmac_f32 v219, v63, v88
v_fmac_f32 v195, v63, v86
v_mfma_f32_16x16x32_bf16 v[208:211], a[100:103], a[44:47], v[208:211]
v_fmac_f32 v171, v63, v84
v_fmac_f32 v147, v63, v82
v_mfma_f32_16x16x32_bf16 v[184:187], a[100:103], a[40:43], v[184:187]
buffer_load_dwordx4 v1, s[4:7], s44 offen offset:2048 sc1 lds
v_mfma_f32_16x16x32_bf16 v[160:163], a[100:103], a[36:39], v[160:163]
ds_read_b128 a[136:139], v5 offset:45056
v_fmac_f32 v151, v67, v82
v_mfma_f32_16x16x32_bf16 v[136:139], a[100:103], a[32:35], v[136:139]
v_fmac_f32 v175, v67, v84
v_fmac_f32 v199, v67, v86
v_mfma_f32_16x16x32_bf16 v[140:143], a[104:107], a[32:35], v[140:143]
ds_read_b128 a[140:143], v5 offset:46080
v_fmac_f32 v223, v67, v88
v_mfma_f32_16x16x32_bf16 v[164:167], a[104:107], a[36:39], v[164:167]
buffer_load_dwordx4 v1, s[4:7], s44 offen offset:3072 sc1 lds
s_add_i32 s44, s28, 20
v_mfma_f32_16x16x32_bf16 v[188:191], a[104:107], a[40:43], v[188:191]
s_lshl_b32 s45, s44, 12
s_add_u32 m0, s45, 32768
s_and_b32 s45, s44, 7
v_mfma_f32_16x16x32_bf16 v[212:215], a[104:107], a[44:47], v[212:215]
s_cmp_eq_u32 s45, s3
s_cselect_b32 s45, 8, 0
s_add_u32 s44, s44, s45
v_mfma_f32_16x16x32_bf16 v[216:219], a[108:111], a[44:47], v[216:219]
s_and_b32 s44, s44, 31
s_lshl_b32 s44, s44, 12
s_add_u32 s44, s44, s51
s_add_u32 s44, s44, 0x200000
v_mfma_f32_16x16x32_bf16 v[192:195], a[108:111], a[40:43], v[192:195]
buffer_load_dwordx4 v1, s[4:7], s44 offen offset:0 sc1 lds
v_mfma_f32_16x16x32_bf16 v[168:171], a[108:111], a[36:39], v[168:171]
ds_read_b128 a[144:147], v5 offset:47104
v_fmac_f32 v227, v71, v88
v_mfma_f32_16x16x32_bf16 v[144:147], a[108:111], a[32:35], v[144:147]
ds_read_b128 a[148:151], v5 offset:48128
v_fmac_f32 v203, v71, v86
v_mfma_f32_16x16x32_bf16 v[148:151], a[112:115], a[32:35], v[148:151]
v_fmac_f32 v179, v71, v84
v_fmac_f32 v155, v71, v82
v_mfma_f32_16x16x32_bf16 v[172:175], a[112:115], a[36:39], v[172:175]
buffer_load_dwordx4 v1, s[4:7], s44 offen offset:1024 sc1 lds
v_mfma_f32_16x16x32_bf16 v[196:199], a[112:115], a[40:43], v[196:199]
v_mfma_f32_16x16x32_bf16 v[220:223], a[112:115], a[44:47], v[220:223]
v_mfma_f32_16x16x32_bf16 v[224:227], a[116:119], a[44:47], v[224:227]
v_mfma_f32_16x16x32_bf16 v[200:203], a[116:119], a[40:43], v[200:203]
buffer_load_dwordx4 v1, s[4:7], s44 offen offset:2048 sc1 lds
v_mfma_f32_16x16x32_bf16 v[176:179], a[116:119], a[36:39], v[176:179]
v_mfma_f32_16x16x32_bf16 v[152:155], a[116:119], a[32:35], v[152:155]
s_waitcnt vmcnt(11) lgkmcnt(0)
s_barrier
v_mfma_f32_16x16x32_bf16 v[132:135], a[128:131], a[48:51], v[132:135]
v_mfma_f32_16x16x32_bf16 v[156:159], a[128:131], a[52:55], v[156:159]
buffer_load_dwordx4 v1, s[4:7], s44 offen offset:3072 sc1 lds
s_add_i32 s44, s28, 24
v_mfma_f32_16x16x32_bf16 v[180:183], a[128:131], a[56:59], v[180:183]
s_lshl_b32 s45, s44, 12
s_add_u32 m0, s45, 32768
s_and_b32 s45, s44, 7
v_mfma_f32_16x16x32_bf16 v[204:207], a[128:131], a[60:63], v[204:207]
s_cmp_eq_u32 s45, s3
s_cselect_b32 s45, 8, 0
s_add_u32 s44, s44, s45
v_mfma_f32_16x16x32_bf16 v[208:211], a[132:135], a[60:63], v[208:211]
s_and_b32 s44, s44, 31
s_lshl_b32 s44, s44, 12
s_add_u32 s44, s44, s51
s_add_u32 s44, s44, 0x200000
v_mfma_f32_16x16x32_bf16 v[184:187], a[132:135], a[56:59], v[184:187]
buffer_load_dwordx4 v1, s[4:7], s44 offen offset:0 sc1 lds
v_mfma_f32_16x16x32_bf16 v[160:163], a[132:135], a[52:55], v[160:163]
v_mfma_f32_16x16x32_bf16 v[136:139], a[132:135], a[48:51], v[136:139]
v_mfma_f32_16x16x32_bf16 v[140:143], a[136:139], a[48:51], v[140:143]
v_mfma_f32_16x16x32_bf16 v[164:167], a[136:139], a[52:55], v[164:167]
v_mfma_f32_16x16x32_bf16 v[188:191], a[136:139], a[56:59], v[188:191]
buffer_load_dwordx4 v1, s[4:7], s44 offen offset:1024 sc1 lds
v_mfma_f32_16x16x32_bf16 v[212:215], a[136:139], a[60:63], v[212:215]
v_mfma_f32_16x16x32_bf16 v[216:219], a[140:143], a[60:63], v[216:219]
v_mfma_f32_16x16x32_bf16 v[192:195], a[140:143], a[56:59], v[192:195]
v_mfma_f32_16x16x32_bf16 v[168:171], a[140:143], a[52:55], v[168:171]
v_mfma_f32_16x16x32_bf16 v[144:147], a[140:143], a[48:51], v[144:147]
buffer_load_dwordx4 v1, s[4:7], s44 offen offset:2048 sc1 lds
v_mfma_f32_16x16x32_bf16 v[148:151], a[144:147], a[48:51], v[148:151]
v_mfma_f32_16x16x32_bf16 v[172:175], a[144:147], a[52:55], v[172:175]
v_mfma_f32_16x16x32_bf16 v[196:199], a[144:147], a[56:59], v[196:199]
v_mfma_f32_16x16x32_bf16 v[220:223], a[144:147], a[60:63], v[220:223]
v_mfma_f32_16x16x32_bf16 v[224:227], a[148:151], a[60:63], v[224:227]
buffer_load_dwordx4 v1, s[4:7], s44 offen offset:3072 sc1 lds
v_mfma_f32_16x16x32_bf16 v[200:203], a[148:151], a[56:59], v[200:203]
v_mfma_f32_16x16x32_bf16 v[176:179], a[148:151], a[52:55], v[176:179]
v_mfma_f32_16x16x32_bf16 v[152:155], a[148:151], a[48:51], v[152:155]
.set L_cpf3, .
v_cvt_pk_bf16_f32 v140, v140, v141
v_cvt_pk_bf16_f32 v164, v164, v165
v_cvt_pk_bf16_f32 v141, v142, v143
v_cvt_pk_bf16_f32 v165, v166, v167
v_cvt_pk_bf16_f32 v142, v144, v145
v_cvt_pk_bf16_f32 v143, v146, v147
v_cvt_pk_bf16_f32 v166, v168, v169
v_cvt_pk_bf16_f32 v167, v170, v171
v_mfma_f32_16x16x32_bf16 v[92:95], a[232:235], v[140:143], 0
v_mul_f32 v240, 0x3fb8aa3b, v83
v_mul_f32 v246, 0x3fb8aa3b, v85
v_mfma_f32_16x16x32_bf16 v[108:111], a[232:235], v[164:167], 0
v_cvt_pk_bf16_f32 v188, v188, v189
v_cvt_pk_bf16_f32 v212, v212, v213
v_mfma_f32_16x16x32_bf16 v[96:99], a[236:239], v[140:143], 0
s_nop 1
v_max3_f32 v236, v92, v93, v94
v_max3_f32 v237, -v92, -v93, -v94
v_mfma_f32_16x16x32_bf16 v[112:115], a[236:239], v[164:167], 0
v_max3_f32 v242, v108, v109, v110
v_max3_f32 v243, -v108, -v109, -v110
v_cvt_pk_bf16_f32 v189, v190, v191
v_cvt_pk_bf16_f32 v213, v214, v215
v_max3_f32 v236, v236, v95, v96
v_max3_f32 v237, v237, -v95, -v96
v_max3_f32 v236, v236, v97, v98
v_max3_f32 v237, v237, -v97, -v98
v_max3_f32 v242, v242, v111, v112
v_max3_f32 v243, v243, -v111, -v112
v_max3_f32 v242, v242, v113, v114
v_max3_f32 v243, v243, -v113, -v114
v_max_f32 v236, v236, v99
v_max_f32_e64 v237, v237, -v99
v_max_f32 v242, v242, v115
L_stub18:
s_cbranch_execz L_stub19
v_max_f32_e64 v243, v243, -v115
v_permlane32_swap_b32 v236, v237
s_nop 0
v_permlane32_swap_b32 v242, v243
v_max_f32 v236, v236, v237
v_max_f32 v242, v242, v243
v_mov_b32 v238, v236
v_mov_b32 v244, v242
v_pk_mul_f32 v[148:149], v[148:149], v[82:83] op_sel:[0,1] op_sel_hi:[1,1]
v_permlane16_swap_b32 v236, v238
v_permlane16_swap_b32 v242, v244
v_max_f32 v236, v236, v238
v_max_f32 v242, v242, v244
v_mov_b32 v238, v236
v_mov_b32 v244, v242
v_pk_mul_f32 v[172:173], v[172:173], v[84:85] op_sel:[0,1] op_sel_hi:[1,1]
v_permlane32_swap_b32 v236, v238
v_permlane32_swap_b32 v242, v244
v_mul_f32_e64 v236, -v236, v240
v_mul_f32_e64 v237, -v238, v240
v_mul_f32_e64 v242, -v242, v246
v_mul_f32_e64 v243, -v244, v246
v_pk_fma_f32 v[100:101], v[92:93], v[240:241], v[236:237] op_sel:[0,0,0] op_sel_hi:[1,0,0]
v_pk_fma_f32 v[102:103], v[94:95], v[240:241], v[236:237] op_sel:[0,0,0] op_sel_hi:[1,0,0]
v_pk_fma_f32 v[104:105], v[96:97], v[240:241], v[236:237] op_sel:[0,0,0] op_sel_hi:[1,0,0]
v_pk_fma_f32 v[106:107], v[98:99], v[240:241], v[236:237] op_sel:[0,0,0] op_sel_hi:[1,0,0]
v_pk_fma_f32 v[116:117], v[108:109], v[246:247], v[242:243] op_sel:[0,0,0] op_sel_hi:[1,0,0]
v_pk_fma_f32 v[118:119], v[110:111], v[246:247], v[242:243] op_sel:[0,0,0] op_sel_hi:[1,0,0]
v_pk_fma_f32 v[120:121], v[112:113], v[246:247], v[242:243] op_sel:[0,0,0] op_sel_hi:[1,0,0]
v_pk_fma_f32 v[122:123], v[114:115], v[246:247], v[242:243] op_sel:[0,0,0] op_sel_hi:[1,0,0]
v_pk_fma_f32 v[92:93], v[92:93], v[240:241], v[236:237] op_sel:[0,0,1] op_sel_hi:[1,0,1] neg_lo:[1,0,0] neg_hi:[1,0,0]
v_pk_fma_f32 v[94:95], v[94:95], v[240:241], v[236:237] op_sel:[0,0,1] op_sel_hi:[1,0,1] neg_lo:[1,0,0] neg_hi:[1,0,0]
v_pk_fma_f32 v[96:97], v[96:97], v[240:241], v[236:237] op_sel:[0,0,1] op_sel_hi:[1,0,1] neg_lo:[1,0,0] neg_hi:[1,0,0]
v_pk_fma_f32 v[98:99], v[98:99], v[240:241], v[236:237] op_sel:[0,0,1] op_sel_hi:[1,0,1] neg_lo:[1,0,0] neg_hi:[1,0,0]
v_pk_fma_f32 v[108:109], v[108:109], v[246:247], v[242:243] op_sel:[0,0,1] op_sel_hi:[1,0,1] neg_lo:[1,0,0] neg_hi:[1,0,0]
v_pk_fma_f32 v[110:111], v[110:111], v[246:247], v[242:243] op_sel:[0,0,1] op_sel_hi:[1,0,1] neg_lo:[1,0,0] neg_hi:[1,0,0]
v_pk_fma_f32 v[112:113], v[112:113], v[246:247], v[242:243] op_sel:[0,0,1] op_sel_hi:[1,0,1] neg_lo:[1,0,0] neg_hi:[1,0,0]
v_pk_fma_f32 v[114:115], v[114:115], v[246:247], v[242:243] op_sel:[0,0,1] op_sel_hi:[1,0,1] neg_lo:[1,0,0] neg_hi:[1,0,0]
v_exp_f32 v92, v92
v_exp_f32 v93, v93
v_exp_f32 v94, v94
v_exp_f32 v95, v95
v_exp_f32 v96, v96
v_exp_f32 v97, v97
v_exp_f32 v98, v98
v_exp_f32 v99, v99
v_exp_f32 v108, v108
v_exp_f32 v109, v109
v_exp_f32 v110, v110
v_exp_f32 v111, v111
v_exp_f32 v112, v112
v_exp_f32 v113, v113
v_exp_f32 v114, v114
v_exp_f32 v115, v115
v_pk_mul_f32 v[150:151], v[150:151], v[82:83] op_sel:[0,1] op_sel_hi:[1,1]
v_pk_mul_f32 v[174:175], v[174:175], v[84:85] op_sel:[0,1] op_sel_hi:[1,1]
v_cvt_pk_bf16_f32 v144, v92, v93
v_cvt_pk_bf16_f32 v145, v94, v95
v_cvt_pk_bf16_f32 v146, v96, v97
v_cvt_pk_bf16_f32 v147, v98, v99
v_cvt_pk_bf16_f32 v168, v108, v109
v_cvt_pk_bf16_f32 v169, v110, v111
v_cvt_pk_bf16_f32 v170, v112, v113
v_cvt_pk_bf16_f32 v171, v114, v115
v_cvt_pk_bf16_f32 v148, v148, v149
v_cvt_pk_bf16_f32 v172, v172, v173
v_pk_mul_f32 v[152:153], v[152:153], v[82:83] op_sel:[0,1] op_sel_hi:[1,1]
v_pk_mul_f32 v[154:155], v[154:155], v[82:83] op_sel:[0,1] op_sel_hi:[1,1]
v_pk_mul_f32 v[176:177], v[176:177], v[84:85] op_sel:[0,1] op_sel_hi:[1,1]
v_pk_mul_f32 v[178:179], v[178:179], v[84:85] op_sel:[0,1] op_sel_hi:[1,1]
v_cvt_pk_bf16_f32 v149, v150, v151
v_cvt_pk_bf16_f32 v173, v174, v175
v_cvt_pk_bf16_f32 v150, v152, v153
v_cvt_pk_bf16_f32 v151, v154, v155
v_cvt_pk_bf16_f32 v174, v176, v177
v_cvt_pk_bf16_f32 v175, v178, v179
v_mfma_f32_16x16x32_bf16 v[152:155], v[16:19], v[144:147], 0
v_cvt_pk_bf16_f32 v190, v192, v193
v_cvt_pk_bf16_f32 v191, v194, v195
v_mfma_f32_16x16x32_bf16 v[176:179], v[16:19], v[168:171], 0
v_cvt_pk_bf16_f32 v214, v216, v217
v_cvt_pk_bf16_f32 v215, v218, v219
v_exp_f32 v100, v100
s_nop 1
v_rcp_f32 v152, v152
v_exp_f32 v101, v101
s_nop 0
v_rcp_f32 v176, v176
v_pk_mul_f32 v[92:93], v[92:93], v[152:153] op_sel:[0,0] op_sel_hi:[1,0]
v_pk_mul_f32 v[94:95], v[94:95], v[152:153] op_sel:[0,0] op_sel_hi:[1,0]
v_pk_mul_f32 v[108:109], v[108:109], v[176:177] op_sel:[0,0] op_sel_hi:[1,0]
v_pk_mul_f32 v[110:111], v[110:111], v[176:177] op_sel:[0,0] op_sel_hi:[1,0]
v_pk_mul_f32 v[96:97], v[96:97], v[152:153] op_sel:[0,0] op_sel_hi:[1,0]
v_pk_mul_f32 v[98:99], v[98:99], v[152:153] op_sel:[0,0] op_sel_hi:[1,0]
v_cvt_pk_bf16_f32 v144, v92, v93
v_cvt_pk_bf16_f32 v145, v94, v95
v_pk_mul_f32 v[112:113], v[112:113], v[176:177] op_sel:[0,0] op_sel_hi:[1,0]
v_cvt_pk_bf16_f32 v168, v108, v109
v_pk_mul_f32 v[114:115], v[114:115], v[176:177] op_sel:[0,0] op_sel_hi:[1,0]
v_cvt_pk_bf16_f32 v169, v110, v111
v_mfma_f32_16x16x32_bf16 v[92:95], a[232:235], v[188:191], 0
v_cvt_pk_bf16_f32 v146, v96, v97
v_cvt_pk_bf16_f32 v147, v98, v99
v_mfma_f32_16x16x32_bf16 v[108:111], a[232:235], v[212:215], 0
v_cvt_pk_bf16_f32 v170, v112, v113
v_cvt_pk_bf16_f32 v171, v114, v115
v_mfma_f32_16x16x32_bf16 v[96:99], a[236:239], v[188:191], 0
s_nop 1
v_max3_f32 v236, v92, v93, v94
v_max3_f32 v237, -v92, -v93, -v94
v_mfma_f32_16x16x32_bf16 v[112:115], a[236:239], v[212:215], 0
v_max3_f32 v242, v108, v109, v110
v_max3_f32 v243, -v108, -v109, -v110
v_exp_f32 v102, v102
v_max3_f32 v236, v236, v95, v96
v_max3_f32 v237, v237, -v95, -v96
v_max3_f32 v236, v236, v97, v98
v_max3_f32 v237, v237, -v97, -v98
s_nop 0
v_max3_f32 v242, v242, v111, v112
v_max3_f32 v243, v243, -v111, -v112
v_max3_f32 v242, v242, v113, v114
v_max3_f32 v243, v243, -v113, -v114
v_max_f32 v236, v236, v99
v_max_f32_e64 v237, v237, -v99
v_max_f32 v242, v242, v115
v_max_f32_e64 v243, v243, -v115
v_exp_f32 v103, v103
v_exp_f32 v104, v104
v_exp_f32 v105, v105
v_exp_f32 v106, v106
v_exp_f32 v107, v107
v_exp_f32 v116, v116
v_exp_f32 v117, v117
v_exp_f32 v118, v118
v_exp_f32 v119, v119
v_exp_f32 v120, v120
v_exp_f32 v121, v121
v_exp_f32 v122, v122
v_exp_f32 v123, v123
s_lshl_b32 s36, s28, 12
v_permlane32_swap_b32 v236, v237
v_permlane32_swap_b32 v242, v243
v_add_u32 v232, s36, v7
v_cvt_pk_bf16_f32 v140, v100, v101
v_cvt_pk_bf16_f32 v141, v102, v103
v_cvt_pk_bf16_f32 v142, v104, v105
v_cvt_pk_bf16_f32 v143, v106, v107
v_cvt_pk_bf16_f32 v164, v116, v117
v_cvt_pk_bf16_f32 v165, v118, v119
v_cvt_pk_bf16_f32 v166, v120, v121
v_cvt_pk_bf16_f32 v167, v122, v123
ds_write_b64 v232, v[148:149] offset:0
ds_write_b64 v232, v[150:151] offset:512
ds_write_b64 v232, v[172:173] offset:1024
v_max_f32 v236, v236, v237
v_max_f32 v242, v242, v243
v_mfma_f32_16x16x32_bf16 v[148:151], v[16:19], v[140:143], 0
ds_write_b64 v232, v[174:175] offset:1536
v_mfma_f32_16x16x32_bf16 v[172:175], v[16:19], v[164:167], 0
v_mov_b32 v238, v236
v_mov_b32 v244, v242
v_mul_f32 v240, 0x3fb8aa3b, v87
v_permlane16_swap_b32 v236, v238
v_permlane16_swap_b32 v242, v244
v_max_f32 v236, v236, v238
v_max_f32 v242, v242, v244
v_mov_b32 v238, v236
v_mov_b32 v244, v242
v_rcp_f32 v148, v148
v_rcp_f32 v172, v172
v_permlane32_swap_b32 v236, v238
v_permlane32_swap_b32 v242, v244
v_mul_f32 v246, 0x3fb8aa3b, v89
v_pk_mul_f32 v[100:101], v[100:101], v[148:149] op_sel:[0,0] op_sel_hi:[1,0]
v_pk_mul_f32 v[102:103], v[102:103], v[148:149] op_sel:[0,0] op_sel_hi:[1,0]
v_pk_mul_f32 v[104:105], v[104:105], v[148:149] op_sel:[0,0] op_sel_hi:[1,0]
v_pk_mul_f32 v[106:107], v[106:107], v[148:149] op_sel:[0,0] op_sel_hi:[1,0]
v_pk_mul_f32 v[116:117], v[116:117], v[172:173] op_sel:[0,0] op_sel_hi:[1,0]
v_pk_mul_f32 v[118:119], v[118:119], v[172:173] op_sel:[0,0] op_sel_hi:[1,0]
v_pk_mul_f32 v[120:121], v[120:121], v[172:173] op_sel:[0,0] op_sel_hi:[1,0]
v_pk_mul_f32 v[122:123], v[122:123], v[172:173] op_sel:[0,0] op_sel_hi:[1,0]
v_mul_f32_e64 v236, -v236, v240
v_mul_f32_e64 v237, -v238, v240
v_mul_f32_e64 v242, -v242, v246
v_mul_f32_e64 v243, -v244, v246
v_cvt_pk_bf16_f32 v140, v100, v101
v_cvt_pk_bf16_f32 v141, v102, v103
v_cvt_pk_bf16_f32 v142, v104, v105
v_cvt_pk_bf16_f32 v143, v106, v107
v_cvt_pk_bf16_f32 v164, v116, v117
v_cvt_pk_bf16_f32 v165, v118, v119
v_cvt_pk_bf16_f32 v166, v120, v121
v_cvt_pk_bf16_f32 v167, v122, v123
v_pk_fma_f32 v[100:101], v[92:93], v[240:241], v[236:237] op_sel:[0,0,0] op_sel_hi:[1,0,0]
v_pk_fma_f32 v[102:103], v[94:95], v[240:241], v[236:237] op_sel:[0,0,0] op_sel_hi:[1,0,0]
v_pk_fma_f32 v[104:105], v[96:97], v[240:241], v[236:237] op_sel:[0,0,0] op_sel_hi:[1,0,0]
v_pk_fma_f32 v[106:107], v[98:99], v[240:241], v[236:237] op_sel:[0,0,0] op_sel_hi:[1,0,0]
v_pk_fma_f32 v[116:117], v[108:109], v[246:247], v[242:243] op_sel:[0,0,0] op_sel_hi:[1,0,0]
v_pk_fma_f32 v[118:119], v[110:111], v[246:247], v[242:243] op_sel:[0,0,0] op_sel_hi:[1,0,0]
v_pk_fma_f32 v[120:121], v[112:113], v[246:247], v[242:243] op_sel:[0,0,0] op_sel_hi:[1,0,0]
v_pk_fma_f32 v[122:123], v[114:115], v[246:247], v[242:243] op_sel:[0,0,0] op_sel_hi:[1,0,0]
v_pk_fma_f32 v[92:93], v[92:93], v[240:241], v[236:237] op_sel:[0,0,1] op_sel_hi:[1,0,1] neg_lo:[1,0,0] neg_hi:[1,0,0]
v_pk_fma_f32 v[94:95], v[94:95], v[240:241], v[236:237] op_sel:[0,0,1] op_sel_hi:[1,0,1] neg_lo:[1,0,0] neg_hi:[1,0,0]
v_pk_fma_f32 v[96:97], v[96:97], v[240:241], v[236:237] op_sel:[0,0,1] op_sel_hi:[1,0,1] neg_lo:[1,0,0] neg_hi:[1,0,0]
v_pk_fma_f32 v[98:99], v[98:99], v[240:241], v[236:237] op_sel:[0,0,1] op_sel_hi:[1,0,1] neg_lo:[1,0,0] neg_hi:[1,0,0]
v_pk_fma_f32 v[108:109], v[108:109], v[246:247], v[242:243] op_sel:[0,0,1] op_sel_hi:[1,0,1] neg_lo:[1,0,0] neg_hi:[1,0,0]
v_pk_fma_f32 v[110:111], v[110:111], v[246:247], v[242:243] op_sel:[0,0,1] op_sel_hi:[1,0,1] neg_lo:[1,0,0] neg_hi:[1,0,0]
v_pk_fma_f32 v[112:113], v[112:113], v[246:247], v[242:243] op_sel:[0,0,1] op_sel_hi:[1,0,1] neg_lo:[1,0,0] neg_hi:[1,0,0]
v_pk_fma_f32 v[114:115], v[114:115], v[246:247], v[242:243] op_sel:[0,0,1] op_sel_hi:[1,0,1] neg_lo:[1,0,0] neg_hi:[1,0,0]
v_pk_mul_f32 v[196:197], v[196:197], v[86:87] op_sel:[0,1] op_sel_hi:[1,1]
v_pk_mul_f32 v[220:221], v[220:221], v[88:89] op_sel:[0,1] op_sel_hi:[1,1]
v_exp_f32 v100, v100
v_exp_f32 v92, v92
v_exp_f32 v101, v101
v_exp_f32 v93, v93
v_exp_f32 v102, v102
v_exp_f32 v94, v94
v_exp_f32 v103, v103
v_exp_f32 v95, v95
v_exp_f32 v104, v104
v_exp_f32 v96, v96
v_exp_f32 v105, v105
v_exp_f32 v97, v97
v_exp_f32 v106, v106
v_exp_f32 v98, v98
v_exp_f32 v107, v107
v_exp_f32 v99, v99
v_exp_f32 v116, v116
v_exp_f32 v108, v108
v_exp_f32 v117, v117
v_exp_f32 v109, v109
v_exp_f32 v118, v118
v_exp_f32 v110, v110
v_exp_f32 v119, v119
v_exp_f32 v111, v111
v_exp_f32 v120, v120
v_exp_f32 v112, v112
v_exp_f32 v121, v121
v_exp_f32 v113, v113
v_exp_f32 v122, v122
v_exp_f32 v114, v114
v_exp_f32 v123, v123
v_exp_f32 v115, v115
v_pk_mul_f32 v[198:199], v[198:199], v[86:87] op_sel:[0,1] op_sel_hi:[1,1]
v_pk_mul_f32 v[222:223], v[222:223], v[88:89] op_sel:[0,1] op_sel_hi:[1,1]
v_cvt_pk_bf16_f32 v196, v196, v197
v_cvt_pk_bf16_f32 v220, v220, v221
v_pk_mul_f32 v[200:201], v[200:201], v[86:87] op_sel:[0,1] op_sel_hi:[1,1]
v_pk_mul_f32 v[202:203], v[202:203], v[86:87] op_sel:[0,1] op_sel_hi:[1,1]
v_pk_mul_f32 v[224:225], v[224:225], v[88:89] op_sel:[0,1] op_sel_hi:[1,1]
v_pk_mul_f32 v[226:227], v[226:227], v[88:89] op_sel:[0,1] op_sel_hi:[1,1]
v_cvt_pk_bf16_f32 v197, v198, v199
v_cvt_pk_bf16_f32 v221, v222, v223
v_cvt_pk_bf16_f32 v198, v200, v201
v_cvt_pk_bf16_f32 v199, v202, v203
v_cvt_pk_bf16_f32 v222, v224, v225
v_cvt_pk_bf16_f32 v223, v226, v227
v_cvt_pk_bf16_f32 v188, v100, v101
v_cvt_pk_bf16_f32 v189, v102, v103
v_cvt_pk_bf16_f32 v190, v104, v105
v_cvt_pk_bf16_f32 v191, v106, v107
v_cvt_pk_bf16_f32 v192, v92, v93
v_cvt_pk_bf16_f32 v193, v94, v95
v_cvt_pk_bf16_f32 v194, v96, v97
v_cvt_pk_bf16_f32 v195, v98, v99
v_cvt_pk_bf16_f32 v212, v116, v117
v_cvt_pk_bf16_f32 v213, v118, v119
v_cvt_pk_bf16_f32 v214, v120, v121
v_cvt_pk_bf16_f32 v215, v122, v123
v_cvt_pk_bf16_f32 v216, v108, v109
v_cvt_pk_bf16_f32 v217, v110, v111
v_cvt_pk_bf16_f32 v218, v112, v113
v_cvt_pk_bf16_f32 v219, v114, v115
ds_write_b64 v232, v[196:197] offset:2048
ds_write_b64 v232, v[198:199] offset:2560
ds_write_b64 v232, v[220:221] offset:3072
v_mfma_f32_16x16x32_bf16 v[196:199], v[16:19], v[188:191], 0
v_add_u32 v233, s36, v232
ds_write_b64 v232, v[222:223] offset:3584
v_mfma_f32_16x16x32_bf16 v[200:203], v[16:19], v[192:195], 0
ds_write_b64 v233, v[140:141] offset:16384
v_mfma_f32_16x16x32_bf16 v[220:223], v[16:19], v[212:215], 0
s_nop 2
v_rcp_f32 v196, v196
v_mfma_f32_16x16x32_bf16 v[224:227], v[16:19], v[216:219], 0
s_nop 0
v_rcp_f32 v200, v200
ds_write_b64 v233, v[142:143] offset:16896
v_rcp_f32 v220, v220
v_pk_mul_f32 v[100:101], v[100:101], v[196:197] op_sel:[0,0] op_sel_hi:[1,0]
s_nop 2
v_rcp_f32 v224, v224
v_pk_mul_f32 v[102:103], v[102:103], v[196:197] op_sel:[0,0] op_sel_hi:[1,0]
v_pk_mul_f32 v[104:105], v[104:105], v[196:197] op_sel:[0,0] op_sel_hi:[1,0]
v_pk_mul_f32 v[106:107], v[106:107], v[196:197] op_sel:[0,0] op_sel_hi:[1,0]
v_pk_mul_f32 v[92:93], v[92:93], v[200:201] op_sel:[0,0] op_sel_hi:[1,0]
v_pk_mul_f32 v[94:95], v[94:95], v[200:201] op_sel:[0,0] op_sel_hi:[1,0]
v_pk_mul_f32 v[96:97], v[96:97], v[200:201] op_sel:[0,0] op_sel_hi:[1,0]
v_pk_mul_f32 v[98:99], v[98:99], v[200:201] op_sel:[0,0] op_sel_hi:[1,0]
v_pk_mul_f32 v[116:117], v[116:117], v[220:221] op_sel:[0,0] op_sel_hi:[1,0]
v_pk_mul_f32 v[118:119], v[118:119], v[220:221] op_sel:[0,0] op_sel_hi:[1,0]
v_pk_mul_f32 v[120:121], v[120:121], v[220:221] op_sel:[0,0] op_sel_hi:[1,0]
v_pk_mul_f32 v[122:123], v[122:123], v[220:221] op_sel:[0,0] op_sel_hi:[1,0]
v_pk_mul_f32 v[108:109], v[108:109], v[224:225] op_sel:[0,0] op_sel_hi:[1,0]
v_pk_mul_f32 v[110:111], v[110:111], v[224:225] op_sel:[0,0] op_sel_hi:[1,0]
v_pk_mul_f32 v[112:113], v[112:113], v[224:225] op_sel:[0,0] op_sel_hi:[1,0]
v_pk_mul_f32 v[114:115], v[114:115], v[224:225] op_sel:[0,0] op_sel_hi:[1,0]
v_cvt_pk_bf16_f32 v188, v100, v101
v_cvt_pk_bf16_f32 v189, v102, v103
v_cvt_pk_bf16_f32 v190, v104, v105
v_cvt_pk_bf16_f32 v191, v106, v107
v_cvt_pk_bf16_f32 v192, v92, v93
v_cvt_pk_bf16_f32 v193, v94, v95
v_cvt_pk_bf16_f32 v194, v96, v97
v_cvt_pk_bf16_f32 v195, v98, v99
v_cvt_pk_bf16_f32 v212, v116, v117
v_cvt_pk_bf16_f32 v213, v118, v119
v_cvt_pk_bf16_f32 v214, v120, v121
v_cvt_pk_bf16_f32 v215, v122, v123
v_cvt_pk_bf16_f32 v216, v108, v109
v_cvt_pk_bf16_f32 v217, v110, v111
v_cvt_pk_bf16_f32 v218, v112, v113
v_cvt_pk_bf16_f32 v219, v114, v115
ds_write_b64 v233, v[144:145] offset:17408
ds_write_b64 v233, v[146:147] offset:17920
ds_write_b64 v233, v[164:165] offset:18432
ds_write_b64 v233, v[166:167] offset:18944
ds_write_b64 v233, v[168:169] offset:19456
ds_write_b64 v233, v[170:171] offset:19968
ds_write_b64 v233, v[188:189] offset:20480
ds_write_b64 v233, v[190:191] offset:20992
ds_write_b64 v233, v[192:193] offset:21504
ds_write_b64 v233, v[194:195] offset:22016
ds_write_b64 v233, v[212:213] offset:22528
ds_write_b64 v233, v[214:215] offset:23040
ds_write_b64 v233, v[216:217] offset:23552
ds_write_b64 v233, v[218:219] offset:24064
s_waitcnt lgkmcnt(0)
s_barrier
s_lshl_b32 s36, s28, 9
v_add_u32 v234, s36, v8
ds_read_b64_tr_b16 a[0:1], v234 offset:16384
ds_read_b64_tr_b16 a[4:5], v8 offset:0
ds_read_b64_tr_b16 a[2:3], v234 offset:18432
ds_read_b64_tr_b16 a[6:7], v8 offset:1024
ds_read_b64_tr_b16 a[12:13], v234 offset:20480
ds_read_b64_tr_b16 a[16:17], v8 offset:2048
ds_read_b64_tr_b16 a[14:15], v234 offset:22528
ds_read_b64_tr_b16 a[18:19], v8 offset:3072
ds_read_b64_tr_b16 a[24:25], v234 offset:24576
ds_read_b64_tr_b16 a[28:29], v8 offset:4096
ds_read_b64_tr_b16 a[26:27], v234 offset:26624
ds_read_b64_tr_b16 a[30:31], v8 offset:5120
ds_read_b64_tr_b16 a[36:37], v234 offset:28672
ds_read_b64_tr_b16 a[40:41], v8 offset:6144
ds_read_b64_tr_b16 a[38:39], v234 offset:30720
ds_read_b64_tr_b16 a[42:43], v8 offset:7168
ds_read_b64_tr_b16 a[8:9], v8 offset:512
ds_read_b64_tr_b16 a[10:11], v8 offset:1536
ds_read_b64_tr_b16 a[48:49], v234 offset:32768
ds_read_b64_tr_b16 a[52:53], v8 offset:8192
ds_read_b64_tr_b16 a[50:51], v234 offset:34816
ds_read_b64_tr_b16 a[54:55], v8 offset:9216
ds_read_b64_tr_b16 a[20:21], v8 offset:2560
ds_read_b64_tr_b16 a[22:23], v8 offset:3584
ds_read_b64_tr_b16 a[60:61], v234 offset:36864
ds_read_b64_tr_b16 a[64:65], v8 offset:10240
ds_read_b64_tr_b16 a[62:63], v234 offset:38912
ds_read_b64_tr_b16 a[66:67], v8 offset:11264
s_waitcnt lgkmcnt(14)
v_mfma_f32_16x16x32_bf16 v[92:95], a[0:3], a[4:7], 0
ds_read_b64_tr_b16 a[32:33], v8 offset:4608
ds_read_b64_tr_b16 a[34:35], v8 offset:5632
ds_read_b64_tr_b16 a[72:73], v234 offset:40960
ds_read_b64_tr_b16 a[76:77], v8 offset:12288
ds_read_b64_tr_b16 a[74:75], v234 offset:43008
ds_read_b64_tr_b16 a[78:79], v8 offset:13312
v_mfma_f32_16x16x32_bf16 v[92:95], a[12:15], a[16:19], v[92:95]
ds_read_b64_tr_b16 a[44:45], v8 offset:6656
ds_read_b64_tr_b16 a[46:47], v8 offset:7680
ds_read_b64_tr_b16 a[84:85], v234 offset:45056
ds_read_b64_tr_b16 a[88:89], v8 offset:14336
ds_read_b64_tr_b16 a[86:87], v234 offset:47104
ds_read_b64_tr_b16 a[90:91], v8 offset:15360
v_mfma_f32_16x16x32_bf16 v[92:95], a[24:27], a[28:31], v[92:95]
ds_read_b64_tr_b16 a[56:57], v8 offset:8704
ds_read_b64_tr_b16 a[58:59], v8 offset:9728
s_waitcnt lgkmcnt(14)
v_mfma_f32_16x16x32_bf16 v[92:95], a[36:39], a[40:43], v[92:95]
ds_read_b64_tr_b16 a[68:69], v8 offset:10752
ds_read_b64_tr_b16 a[70:71], v8 offset:11776
v_mfma_f32_16x16x32_bf16 v[96:99], a[0:3], a[8:11], 0
ds_read_b64_tr_b16 a[80:81], v8 offset:12800
v_mfma_f32_16x16x32_bf16 v[92:95], a[48:51], a[52:55], v[92:95]
ds_read_b64_tr_b16 a[82:83], v8 offset:13824
v_mfma_f32_16x16x32_bf16 v[96:99], a[12:15], a[20:23], v[96:99]
ds_read_b64_tr_b16 a[92:93], v8 offset:14848
v_mfma_f32_16x16x32_bf16 v[92:95], a[60:63], a[64:67], v[92:95]
ds_read_b64_tr_b16 a[94:95], v8 offset:15872
s_waitcnt lgkmcnt(14)
v_mfma_f32_16x16x32_bf16 v[96:99], a[24:27], a[32:35], v[96:99]
s_lshl_b32 s37, s30, 2
s_add_u32 s37, s37, s28
v_mfma_f32_16x16x32_bf16 v[92:95], a[72:75], a[76:79], v[92:95]
s_lshl_b32 s37, s37, 3
s_add_u32 s38, s37, s29
s_waitcnt lgkmcnt(12)
v_mfma_f32_16x16x32_bf16 v[96:99], a[36:39], a[44:47], v[96:99]
s_lshl_b32 s39, s38, 7
s_add_u32 s39, s39, 0x820000
v_mfma_f32_16x16x32_bf16 v[100:103], a[0:3], v[16:19], 0
s_lshl_b32 s38, s38, 11
s_add_u32 s38, s38, 0x400000
s_waitcnt lgkmcnt(8)
v_mfma_f32_16x16x32_bf16 v[92:95], a[84:87], a[88:91], v[92:95]
v_cvt_pk_bf16_f32 v132, v132, v133
v_cvt_pk_bf16_f32 v156, v156, v157
s_waitcnt lgkmcnt(6)
v_mfma_f32_16x16x32_bf16 v[96:99], a[48:51], a[56:59], v[96:99]
v_cvt_pk_bf16_f32 v180, v180, v181
v_cvt_pk_bf16_f32 v204, v204, v205
v_mfma_f32_16x16x32_bf16 v[100:103], a[12:15], v[16:19], v[100:103]
s_nop 0
buffer_store_dwordx4 v[92:95], v1, s[4:7], s38 offen offset:0 sc1
s_waitcnt lgkmcnt(4)
v_mfma_f32_16x16x32_bf16 v[96:99], a[60:63], a[68:71], v[96:99]
v_cvt_pk_bf16_f32 v133, v134, v135
v_cvt_pk_bf16_f32 v157, v158, v159
v_mfma_f32_16x16x32_bf16 v[100:103], a[24:27], v[16:19], v[100:103]
v_cvt_pk_bf16_f32 v181, v182, v183
v_cvt_pk_bf16_f32 v205, v206, v207
s_waitcnt lgkmcnt(2)
v_mfma_f32_16x16x32_bf16 v[96:99], a[72:75], a[80:83], v[96:99]
v_cvt_pk_bf16_f32 v134, v136, v137
v_cvt_pk_bf16_f32 v135, v138, v139
v_mfma_f32_16x16x32_bf16 v[100:103], a[36:39], v[16:19], v[100:103]
v_cvt_pk_bf16_f32 v158, v160, v161
v_cvt_pk_bf16_f32 v159, v162, v163
s_waitcnt lgkmcnt(0)
v_mfma_f32_16x16x32_bf16 v[96:99], a[84:87], a[92:95], v[96:99]
v_cvt_pk_bf16_f32 v182, v184, v185
v_cvt_pk_bf16_f32 v183, v186, v187
v_mfma_f32_16x16x32_bf16 v[100:103], a[48:51], v[16:19], v[100:103]
v_cvt_pk_bf16_f32 v206, v208, v209
v_cvt_pk_bf16_f32 v207, v210, v211
v_mfma_f32_16x16x32_bf16 v[100:103], a[60:63], v[16:19], v[100:103]
s_nop 1
buffer_store_dwordx4 v[96:99], v1, s[4:7], s38 offen offset:1024 sc1
v_mfma_f32_16x16x32_bf16 v[100:103], a[72:75], v[16:19], v[100:103]
v_mfma_f32_16x16x32_bf16 v[100:103], a[84:87], v[16:19], v[100:103]
s_nop 7
buffer_store_dwordx4 v[100:103], v254, s[4:7], s39 offen sc1
v_cndmask_b32 v235, 2.0, v10, s[64:65]
v_mfma_f32_16x16x32_bf16 v[108:111], a[232:235], v[132:135], 0
v_mul_f32 v240, 0x3fb8aa3b, v83
v_mul_f32 v246, 0x3fb8aa3b, v85
v_mfma_f32_16x16x32_bf16 v[172:175], a[232:235], v[156:159], 0
v_mfma_f32_16x16x32_bf16 v[112:115], a[236:239], v[132:135], 0
s_nop 3
v_max3_f32 v236, v108, v109, v110
v_max3_f32 v237, -v108, -v109, -v110
v_mfma_f32_16x16x32_bf16 v[176:179], a[236:239], v[156:159], 0
v_max3_f32 v242, v172, v173, v174
v_max3_f32 v243, -v172, -v173, -v174
v_max3_f32 v236, v236, v111, v112
v_max3_f32 v237, v237, -v111, -v112
v_max3_f32 v236, v236, v113, v114
v_max3_f32 v237, v237, -v113, -v114
s_nop 1
v_max3_f32 v242, v242, v175, v176
v_max3_f32 v243, v243, -v175, -v176
v_max3_f32 v242, v242, v177, v178
v_max3_f32 v243, v243, -v177, -v178
v_max_f32 v236, v236, v115
v_max_f32_e64 v237, v237, -v115
v_max_f32 v242, v242, v179
v_max_f32_e64 v243, v243, -v179
v_permlane32_swap_b32 v236, v237
s_nop 0
v_permlane32_swap_b32 v242, v243
v_max_f32 v236, v236, v237
v_max_f32 v242, v242, v243
v_mov_b32 v238, v236
v_mov_b32 v244, v242
s_nop 0
v_permlane16_swap_b32 v236, v238
v_permlane16_swap_b32 v242, v244
v_max_f32 v236, v236, v238
v_max_f32 v242, v242, v244
v_mov_b32 v238, v236
v_mov_b32 v244, v242
s_nop 0
v_permlane32_swap_b32 v236, v238
v_permlane32_swap_b32 v242, v244
v_mul_f32_e64 v236, -v236, v240
v_mul_f32_e64 v237, -v238, v240
v_mul_f32_e64 v242, -v242, v246
v_mul_f32_e64 v243, -v244, v246
v_pk_fma_f32 v[116:117], v[108:109], v[240:241], v[236:237] op_sel:[0,0,0] op_sel_hi:[1,0,0]
v_pk_fma_f32 v[118:119], v[110:111], v[240:241], v[236:237] op_sel:[0,0,0] op_sel_hi:[1,0,0]
v_pk_fma_f32 v[120:121], v[112:113], v[240:241], v[236:237] op_sel:[0,0,0] op_sel_hi:[1,0,0]
v_pk_fma_f32 v[122:123], v[114:115], v[240:241], v[236:237] op_sel:[0,0,0] op_sel_hi:[1,0,0]
v_pk_fma_f32 v[148:149], v[172:173], v[246:247], v[242:243] op_sel:[0,0,0] op_sel_hi:[1,0,0]
v_pk_fma_f32 v[150:151], v[174:175], v[246:247], v[242:243] op_sel:[0,0,0] op_sel_hi:[1,0,0]
v_pk_fma_f32 v[152:153], v[176:177], v[246:247], v[242:243] op_sel:[0,0,0] op_sel_hi:[1,0,0]
v_pk_fma_f32 v[154:155], v[178:179], v[246:247], v[242:243] op_sel:[0,0,0] op_sel_hi:[1,0,0]
v_pk_fma_f32 v[108:109], v[108:109], v[240:241], v[236:237] op_sel:[0,0,1] op_sel_hi:[1,0,1] neg_lo:[1,0,0] neg_hi:[1,0,0]
v_pk_fma_f32 v[110:111], v[110:111], v[240:241], v[236:237] op_sel:[0,0,1] op_sel_hi:[1,0,1] neg_lo:[1,0,0] neg_hi:[1,0,0]
v_pk_fma_f32 v[112:113], v[112:113], v[240:241], v[236:237] op_sel:[0,0,1] op_sel_hi:[1,0,1] neg_lo:[1,0,0] neg_hi:[1,0,0]
v_pk_fma_f32 v[114:115], v[114:115], v[240:241], v[236:237] op_sel:[0,0,1] op_sel_hi:[1,0,1] neg_lo:[1,0,0] neg_hi:[1,0,0]
v_pk_fma_f32 v[172:173], v[172:173], v[246:247], v[242:243] op_sel:[0,0,1] op_sel_hi:[1,0,1] neg_lo:[1,0,0] neg_hi:[1,0,0]
v_pk_fma_f32 v[174:175], v[174:175], v[246:247], v[242:243] op_sel:[0,0,1] op_sel_hi:[1,0,1] neg_lo:[1,0,0] neg_hi:[1,0,0]
v_pk_fma_f32 v[176:177], v[176:177], v[246:247], v[242:243] op_sel:[0,0,1] op_sel_hi:[1,0,1] neg_lo:[1,0,0] neg_hi:[1,0,0]
v_pk_fma_f32 v[178:179], v[178:179], v[246:247], v[242:243] op_sel:[0,0,1] op_sel_hi:[1,0,1] neg_lo:[1,0,0] neg_hi:[1,0,0]
v_exp_f32 v116, v116
v_exp_f32 v108, v108
v_exp_f32 v117, v117
v_exp_f32 v109, v109
v_exp_f32 v118, v118
v_exp_f32 v110, v110
v_exp_f32 v119, v119
v_exp_f32 v111, v111
v_exp_f32 v120, v120
v_exp_f32 v112, v112
v_exp_f32 v121, v121
v_exp_f32 v113, v113
v_exp_f32 v122, v122
v_exp_f32 v114, v114
v_exp_f32 v123, v123
v_exp_f32 v115, v115
v_exp_f32 v148, v148
v_exp_f32 v172, v172
v_exp_f32 v149, v149
v_exp_f32 v173, v173
v_exp_f32 v150, v150
v_exp_f32 v174, v174
v_exp_f32 v151, v151
v_exp_f32 v175, v175
v_exp_f32 v152, v152
v_exp_f32 v176, v176
v_exp_f32 v153, v153
v_exp_f32 v177, v177
v_exp_f32 v154, v154
v_exp_f32 v178, v178
v_exp_f32 v155, v155
v_exp_f32 v179, v179
v_cvt_pk_bf16_f32 v140, v116, v117
v_cvt_pk_bf16_f32 v141, v118, v119
v_cvt_pk_bf16_f32 v142, v120, v121
v_cvt_pk_bf16_f32 v143, v122, v123
v_cvt_pk_bf16_f32 v144, v108, v109
v_cvt_pk_bf16_f32 v145, v110, v111
v_cvt_pk_bf16_f32 v146, v112, v113
v_cvt_pk_bf16_f32 v147, v114, v115
v_cvt_pk_bf16_f32 v164, v148, v149
v_cvt_pk_bf16_f32 v165, v150, v151
v_cvt_pk_bf16_f32 v166, v152, v153
v_cvt_pk_bf16_f32 v167, v154, v155
v_cvt_pk_bf16_f32 v168, v172, v173
v_cvt_pk_bf16_f32 v169, v174, v175
v_cvt_pk_bf16_f32 v170, v176, v177
v_cvt_pk_bf16_f32 v171, v178, v179
s_add_u32 s94, s80, 0x90000
s_waitcnt vmcnt(0)
s_barrier
s_cmp_lg_u32 s28, 1
s_cbranch_scc1 Lsg_38
buffer_atomic_add v12, v235, s[4:7], s94 offen sc1
Lsg_38:
v_mfma_f32_16x16x32_bf16 v[108:111], a[232:235], v[180:183], 0
v_mul_f32 v240, 0x3fb8aa3b, v87
v_mul_f32 v246, 0x3fb8aa3b, v89
v_mfma_f32_16x16x32_bf16 v[172:175], a[232:235], v[204:207], 0
v_mfma_f32_16x16x32_bf16 v[112:115], a[236:239], v[180:183], 0
s_nop 3
v_max3_f32 v236, v108, v109, v110
v_max3_f32 v237, -v108, -v109, -v110
v_mfma_f32_16x16x32_bf16 v[176:179], a[236:239], v[204:207], 0
v_max3_f32 v242, v172, v173, v174
v_max3_f32 v243, -v172, -v173, -v174
v_max3_f32 v236, v236, v111, v112
v_max3_f32 v237, v237, -v111, -v112
v_max3_f32 v236, v236, v113, v114
v_max3_f32 v237, v237, -v113, -v114
s_nop 1
v_max3_f32 v242, v242, v175, v176
v_max3_f32 v243, v243, -v175, -v176
v_max3_f32 v242, v242, v177, v178
v_max3_f32 v243, v243, -v177, -v178
v_max_f32 v236, v236, v115
v_max_f32_e64 v237, v237, -v115
v_max_f32 v242, v242, v179
v_max_f32_e64 v243, v243, -v179
v_permlane32_swap_b32 v236, v237
s_nop 0
v_permlane32_swap_b32 v242, v243
v_max_f32 v236, v236, v237
v_max_f32 v242, v242, v243
v_mov_b32 v238, v236
v_mov_b32 v244, v242
s_nop 0
v_permlane16_swap_b32 v236, v238
v_permlane16_swap_b32 v242, v244
v_max_f32 v236, v236, v238
v_max_f32 v242, v242, v244
v_mov_b32 v238, v236
v_mov_b32 v244, v242
s_nop 0
v_permlane32_swap_b32 v236, v238
v_permlane32_swap_b32 v242, v244
v_mul_f32_e64 v236, -v236, v240
v_mul_f32_e64 v237, -v238, v240
v_mul_f32_e64 v242, -v242, v246
v_mul_f32_e64 v243, -v244, v246
v_pk_fma_f32 v[116:117], v[108:109], v[240:241], v[236:237] op_sel:[0,0,0] op_sel_hi:[1,0,0]
v_pk_fma_f32 v[118:119], v[110:111], v[240:241], v[236:237] op_sel:[0,0,0] op_sel_hi:[1,0,0]
v_pk_fma_f32 v[120:121], v[112:113], v[240:241], v[236:237] op_sel:[0,0,0] op_sel_hi:[1,0,0]
v_pk_fma_f32 v[122:123], v[114:115], v[240:241], v[236:237] op_sel:[0,0,0] op_sel_hi:[1,0,0]
L_stub19:
s_cbranch_execz L_wret6
v_pk_fma_f32 v[148:149], v[172:173], v[246:247], v[242:243] op_sel:[0,0,0] op_sel_hi:[1,0,0]
v_pk_fma_f32 v[150:151], v[174:175], v[246:247], v[242:243] op_sel:[0,0,0] op_sel_hi:[1,0,0]
v_pk_fma_f32 v[152:153], v[176:177], v[246:247], v[242:243] op_sel:[0,0,0] op_sel_hi:[1,0,0]
v_pk_fma_f32 v[154:155], v[178:179], v[246:247], v[242:243] op_sel:[0,0,0] op_sel_hi:[1,0,0]
v_pk_fma_f32 v[108:109], v[108:109], v[240:241], v[236:237] op_sel:[0,0,1] op_sel_hi:[1,0,1] neg_lo:[1,0,0] neg_hi:[1,0,0]
v_pk_fma_f32 v[110:111], v[110:111], v[240:241], v[236:237] op_sel:[0,0,1] op_sel_hi:[1,0,1] neg_lo:[1,0,0] neg_hi:[1,0,0]
v_pk_fma_f32 v[112:113], v[112:113], v[240:241], v[236:237] op_sel:[0,0,1] op_sel_hi:[1,0,1] neg_lo:[1,0,0] neg_hi:[1,0,0]
v_pk_fma_f32 v[114:115], v[114:115], v[240:241], v[236:237] op_sel:[0,0,1] op_sel_hi:[1,0,1] neg_lo:[1,0,0] neg_hi:[1,0,0]
v_pk_fma_f32 v[172:173], v[172:173], v[246:247], v[242:243] op_sel:[0,0,1] op_sel_hi:[1,0,1] neg_lo:[1,0,0] neg_hi:[1,0,0]
v_pk_fma_f32 v[174:175], v[174:175], v[246:247], v[242:243] op_sel:[0,0,1] op_sel_hi:[1,0,1] neg_lo:[1,0,0] neg_hi:[1,0,0]
v_pk_fma_f32 v[176:177], v[176:177], v[246:247], v[242:243] op_sel:[0,0,1] op_sel_hi:[1,0,1] neg_lo:[1,0,0] neg_hi:[1,0,0]
v_pk_fma_f32 v[178:179], v[178:179], v[246:247], v[242:243] op_sel:[0,0,1] op_sel_hi:[1,0,1] neg_lo:[1,0,0] neg_hi:[1,0,0]
v_exp_f32 v116, v116
v_exp_f32 v108, v108
v_exp_f32 v117, v117
v_exp_f32 v109, v109
v_exp_f32 v118, v118
v_exp_f32 v110, v110
v_exp_f32 v119, v119
v_exp_f32 v111, v111
v_exp_f32 v120, v120
v_exp_f32 v112, v112
v_exp_f32 v121, v121
v_exp_f32 v113, v113
v_exp_f32 v122, v122
v_exp_f32 v114, v114
v_exp_f32 v123, v123
v_exp_f32 v115, v115
v_exp_f32 v148, v148
v_exp_f32 v172, v172
v_exp_f32 v149, v149
v_exp_f32 v173, v173
v_exp_f32 v150, v150
v_exp_f32 v174, v174
v_exp_f32 v151, v151
v_exp_f32 v175, v175
v_exp_f32 v152, v152
v_exp_f32 v176, v176
v_exp_f32 v153, v153
v_exp_f32 v177, v177
v_exp_f32 v154, v154
v_exp_f32 v178, v178
v_exp_f32 v155, v155
v_exp_f32 v179, v179
v_cvt_pk_bf16_f32 v188, v116, v117
v_cvt_pk_bf16_f32 v189, v118, v119
v_cvt_pk_bf16_f32 v190, v120, v121
v_cvt_pk_bf16_f32 v191, v122, v123
v_cvt_pk_bf16_f32 v192, v108, v109
v_cvt_pk_bf16_f32 v193, v110, v111
v_cvt_pk_bf16_f32 v194, v112, v113
v_cvt_pk_bf16_f32 v195, v114, v115
v_cvt_pk_bf16_f32 v212, v148, v149
v_cvt_pk_bf16_f32 v213, v150, v151
v_cvt_pk_bf16_f32 v214, v152, v153
v_cvt_pk_bf16_f32 v215, v154, v155
v_cvt_pk_bf16_f32 v216, v172, v173
v_cvt_pk_bf16_f32 v217, v174, v175
v_cvt_pk_bf16_f32 v218, v176, v177
v_cvt_pk_bf16_f32 v219, v178, v179
s_cmp_lg_u32 s28, 0
s_cbranch_scc1 Lpe_40
s_add_u32 s36, s70, 0x90000
s_mov_b32 s37, 0
Lpoll_39:
v_mov_b32 v11, 0
s_mov_b64 exec, 1
buffer_atomic_add v11, off, s[4:7], s36 sc0 sc1
s_waitcnt vmcnt(0)
v_readfirstlane_b32 s38, v11
s_mov_b64 exec, -1
s_nop 0
v_mov_b32 v11, s38
s_add_u32 s37, s37, 1
v_cmp_gt_u32 vcc, 8, v11
s_cbranch_vccz Lpe_40
s_cmp_lt_u32 s37, 0x100000
s_cbranch_scc1 Lpoll_39
Lpe_40:
s_barrier
s_lshl_b32 s37, s30, 2
s_add_u32 s37, s37, s28
v_and_b32 v248, 7, v0
s_lshl_b32 s39, s37, 10
v_lshlrev_b32 v248, 7, v248
v_lshrrev_b32 v249, 4, v0
s_add_u32 s39, s39, 0x820000
v_lshl_add_u32 v248, v249, 4, v248
buffer_load_dwordx4 v[156:159], v248, s[4:7], s39 offen sc1
s_lshl_b32 s38, s37, 14
s_add_u32 s38, s38, 0x400000
buffer_load_dwordx4 v[92:95], v1, s[4:7], s38 offen offset:0 sc1
buffer_load_dwordx4 v[96:99], v1, s[4:7], s38 offen offset:1024 sc1
buffer_load_dwordx4 v[100:103], v1, s[4:7], s38 offen offset:2048 sc1
buffer_load_dwordx4 v[104:107], v1, s[4:7], s38 offen offset:3072 sc1
s_add_u32 s38, s38, 4096
buffer_load_dwordx4 v[148:151], v1, s[4:7], s38 offen offset:0 sc1
buffer_load_dwordx4 v[152:155], v1, s[4:7], s38 offen offset:1024 sc1
buffer_load_dwordx4 v[172:175], v1, s[4:7], s38 offen offset:2048 sc1
buffer_load_dwordx4 v[176:179], v1, s[4:7], s38 offen offset:3072 sc1
s_add_u32 s38, s38, 4096
buffer_load_dwordx4 v[48:51], v1, s[4:7], s38 offen offset:0 sc1
buffer_load_dwordx4 v[52:55], v1, s[4:7], s38 offen offset:1024 sc1
buffer_load_dwordx4 v[56:59], v1, s[4:7], s38 offen offset:2048 sc1
buffer_load_dwordx4 v[60:63], v1, s[4:7], s38 offen offset:3072 sc1
s_add_u32 s38, s38, 4096
s_waitcnt vmcnt(12)
v_add_f32_dpp v156, v156, v156 row_ror:4 row_mask:0xf bank_mask:0xf
v_add_f32_dpp v157, v157, v157 row_ror:4 row_mask:0xf bank_mask:0xf
v_add_f32_dpp v158, v158, v158 row_ror:4 row_mask:0xf bank_mask:0xf
v_add_f32_dpp v159, v159, v159 row_ror:4 row_mask:0xf bank_mask:0xf
v_add_f32_dpp v156, v156, v156 row_ror:2 row_mask:0xf bank_mask:0xf
v_add_f32_dpp v157, v157, v157 row_ror:2 row_mask:0xf bank_mask:0xf
v_add_f32_dpp v158, v158, v158 row_ror:2 row_mask:0xf bank_mask:0xf
v_add_f32_dpp v159, v159, v159 row_ror:2 row_mask:0xf bank_mask:0xf
buffer_load_dwordx4 v[64:67], v1, s[4:7], s38 offen offset:0 sc1
v_add_f32_dpp v156, v156, v156 row_ror:1 row_mask:0xf bank_mask:0xf
v_add_f32_dpp v157, v157, v157 row_ror:1 row_mask:0xf bank_mask:0xf
v_add_f32_dpp v158, v158, v158 row_ror:1 row_mask:0xf bank_mask:0xf
v_add_f32_dpp v159, v159, v159 row_ror:1 row_mask:0xf bank_mask:0xf
buffer_load_dwordx4 v[68:71], v1, s[4:7], s38 offen offset:1024 sc1
buffer_load_dwordx4 v[132:135], v1, s[4:7], s38 offen offset:2048 sc1
s_waitcnt vmcnt(12)
v_pk_add_f32 v[92:93], v[92:93], v[100:101]
v_pk_add_f32 v[94:95], v[94:95], v[102:103]
buffer_load_dwordx4 v[136:139], v1, s[4:7], s38 offen offset:3072 sc1
s_waitcnt vmcnt(12)
v_pk_add_f32 v[96:97], v[96:97], v[104:105]
v_pk_add_f32 v[98:99], v[98:99], v[106:107]
s_waitcnt vmcnt(11)
v_pk_add_f32 v[92:93], v[92:93], v[148:149]
v_pk_add_f32 v[94:95], v[94:95], v[150:151]
s_waitcnt vmcnt(10)
v_pk_add_f32 v[96:97], v[96:97], v[152:153]
v_pk_add_f32 v[98:99], v[98:99], v[154:155]
s_waitcnt vmcnt(9)
v_pk_add_f32 v[92:93], v[92:93], v[172:173]
v_pk_add_f32 v[94:95], v[94:95], v[174:175]
s_waitcnt vmcnt(8)
v_pk_add_f32 v[96:97], v[96:97], v[176:177]
v_pk_add_f32 v[98:99], v[98:99], v[178:179]
s_waitcnt vmcnt(7)
v_pk_add_f32 v[92:93], v[92:93], v[48:49]
v_pk_add_f32 v[94:95], v[94:95], v[50:51]
s_waitcnt vmcnt(6)
v_pk_add_f32 v[96:97], v[96:97], v[52:53]
v_pk_add_f32 v[98:99], v[98:99], v[54:55]
s_waitcnt vmcnt(5)
v_pk_add_f32 v[92:93], v[92:93], v[56:57]
v_pk_add_f32 v[94:95], v[94:95], v[58:59]
s_waitcnt vmcnt(4)
v_pk_add_f32 v[96:97], v[96:97], v[60:61]
v_pk_add_f32 v[98:99], v[98:99], v[62:63]
s_waitcnt vmcnt(3)
v_pk_add_f32 v[92:93], v[92:93], v[64:65]
v_pk_add_f32 v[94:95], v[94:95], v[66:67]
s_waitcnt vmcnt(2)
v_pk_add_f32 v[96:97], v[96:97], v[68:69]
v_pk_add_f32 v[98:99], v[98:99], v[70:71]
s_waitcnt vmcnt(1)
v_pk_add_f32 v[92:93], v[92:93], v[132:133]
v_pk_add_f32 v[94:95], v[94:95], v[134:135]
s_waitcnt vmcnt(0)
v_pk_add_f32 v[96:97], v[96:97], v[136:137]
v_pk_add_f32 v[98:99], v[98:99], v[138:139]
s_lshr_b32 s36, s28, 1
s_and_b32 s37, s28, 1
v_cvt_pk_bf16_f32 v156, v156, v157
v_cvt_pk_bf16_f32 v157, v158, v159
s_mul_i32 s36, s36, 3072
s_lshl_b32 s37, s37, 3
v_cvt_pk_bf16_f32 v92, v92, v93
v_cndmask_b32 v156, 0, v156, s[56:57]
v_cndmask_b32 v157, 0, v157, s[56:57]
s_add_u32 s36, s36, s37
v_cvt_pk_bf16_f32 v93, v94, v95
v_cvt_pk_bf16_f32 v94, v96, v97
v_cvt_pk_bf16_f32 v95, v98, v99
v_cndmask_b32 v156, v156, v16, s[58:59]
v_cndmask_b32 v157, v157, v16, s[58:59]
v_add_u32 v236, s36, v1
s_lshl_b32 s35, s30, 12
ds_write_b64 v236, v[92:93] offset:0
ds_write_b64 v236, v[94:95] offset:1024
ds_write_b64 v236, v[156:157] offset:2048
s_add_u32 s35, s35, 0x1e00000
s_add_u32 s94, s71, 0x30080
s_waitcnt lgkmcnt(0)
s_barrier
ds_read_b128 a[8:11], v1 offset:2048
ds_read_b128 a[20:23], v1 offset:5120
ds_read_b128 a[0:3], v1 offset:0
ds_read_b128 a[12:15], v1 offset:3072
ds_read_b128 a[4:7], v1 offset:1024
ds_read_b128 a[16:19], v1 offset:4096
s_waitcnt lgkmcnt(5)
v_mfma_f32_16x16x32_bf16 v[92:95], a[8:11], v[140:143], 0
s_waitcnt lgkmcnt(4)
v_mfma_f32_16x16x32_bf16 v[96:99], a[20:23], v[144:147], 0
s_waitcnt lgkmcnt(3)
v_mfma_f32_16x16x32_bf16 v[132:135], a[0:3], v[140:143], 0
s_nop 3
v_rcp_f32 v94, v93
s_waitcnt lgkmcnt(2)
v_mfma_f32_16x16x32_bf16 v[148:151], a[12:15], v[144:147], 0
v_rcp_f32 v95, v97
v_mul_f32 v92, v92, v94
v_fmac_f32 v92, v96, v95
v_mfma_f32_16x16x32_bf16 v[100:103], a[8:11], v[164:167], 0
v_add_f32 v92, 0x358637bd, v92
v_rcp_f32 v92, v92
s_waitcnt lgkmcnt(1)
v_mfma_f32_16x16x32_bf16 v[136:139], a[4:7], v[140:143], 0
v_mul_f32 v94, v94, v92
v_mul_f32 v95, v95, v92
v_mfma_f32_16x16x32_bf16 v[104:107], a[20:23], v[168:171], 0
v_mul_f32 v132, v132, v94
v_mul_f32 v133, v133, v94
s_waitcnt lgkmcnt(0)
v_mfma_f32_16x16x32_bf16 v[152:155], a[16:19], v[144:147], 0
v_mul_f32 v134, v134, v94
v_mul_f32 v135, v135, v94
v_fmac_f32 v132, v148, v95
v_fmac_f32 v133, v149, v95
v_rcp_f32 v102, v101
v_mul_f32 v136, v136, v94
v_mul_f32 v137, v137, v94
v_mul_f32 v138, v138, v94
v_mul_f32 v139, v139, v94
v_fmac_f32 v134, v150, v95
v_fmac_f32 v135, v151, v95
v_cvt_pk_bf16_f32 v132, v132, v133
v_rcp_f32 v103, v105
v_fmac_f32 v136, v152, v95
v_fmac_f32 v137, v153, v95
v_fmac_f32 v138, v154, v95
v_fmac_f32 v139, v155, v95
v_cvt_pk_bf16_f32 v133, v134, v135
v_cvt_pk_bf16_f32 v134, v136, v137
v_cvt_pk_bf16_f32 v135, v138, v139
v_mul_f32 v100, v100, v102
v_mfma_f32_16x16x32_bf16 v[156:159], a[0:3], v[164:167], 0
buffer_store_dwordx4 v[132:135], v2, s[4:7], s35 offen offset:0 sc1
v_fmac_f32 v100, v104, v103
v_mfma_f32_16x16x32_bf16 v[172:175], a[12:15], v[168:171], 0
v_add_f32 v100, 0x358637bd, v100
v_rcp_f32 v100, v100
v_mfma_f32_16x16x32_bf16 v[108:111], a[8:11], v[188:191], 0
v_mul_f32 v102, v102, v100
v_mul_f32 v103, v103, v100
v_mfma_f32_16x16x32_bf16 v[160:163], a[4:7], v[164:167], 0
v_mul_f32 v156, v156, v102
v_mul_f32 v157, v157, v102
v_mfma_f32_16x16x32_bf16 v[112:115], a[20:23], v[192:195], 0
v_mul_f32 v158, v158, v102
v_mul_f32 v159, v159, v102
v_mfma_f32_16x16x32_bf16 v[176:179], a[16:19], v[168:171], 0
v_fmac_f32 v156, v172, v103
v_fmac_f32 v157, v173, v103
v_rcp_f32 v110, v109
v_mul_f32 v160, v160, v102
v_mul_f32 v161, v161, v102
v_mul_f32 v162, v162, v102
v_mul_f32 v163, v163, v102
v_fmac_f32 v158, v174, v103
v_fmac_f32 v159, v175, v103
v_cvt_pk_bf16_f32 v156, v156, v157
v_rcp_f32 v111, v113
v_fmac_f32 v160, v176, v103
v_fmac_f32 v161, v177, v103
v_fmac_f32 v162, v178, v103
v_fmac_f32 v163, v179, v103
v_cvt_pk_bf16_f32 v157, v158, v159
v_cvt_pk_bf16_f32 v158, v160, v161
v_cvt_pk_bf16_f32 v159, v162, v163
v_mul_f32 v108, v108, v110
v_mfma_f32_16x16x32_bf16 v[180:183], a[0:3], v[188:191], 0
buffer_store_dwordx4 v[156:159], v2, s[4:7], s35 offen offset:1024 sc1
v_fmac_f32 v108, v112, v111
v_mfma_f32_16x16x32_bf16 v[196:199], a[12:15], v[192:195], 0
v_add_f32 v108, 0x358637bd, v108
v_rcp_f32 v108, v108
v_mfma_f32_16x16x32_bf16 v[116:119], a[8:11], v[212:215], 0
v_mul_f32 v110, v110, v108
v_mul_f32 v111, v111, v108
v_mfma_f32_16x16x32_bf16 v[184:187], a[4:7], v[188:191], 0
v_mul_f32 v180, v180, v110
v_mul_f32 v181, v181, v110
v_mfma_f32_16x16x32_bf16 v[120:123], a[20:23], v[216:219], 0
v_mul_f32 v182, v182, v110
v_mul_f32 v183, v183, v110
v_mfma_f32_16x16x32_bf16 v[200:203], a[16:19], v[192:195], 0
v_fmac_f32 v180, v196, v111
v_fmac_f32 v181, v197, v111
v_rcp_f32 v118, v117
v_mul_f32 v184, v184, v110
v_mul_f32 v185, v185, v110
v_mul_f32 v186, v186, v110
v_mul_f32 v187, v187, v110
v_fmac_f32 v182, v198, v111
v_fmac_f32 v183, v199, v111
v_cvt_pk_bf16_f32 v180, v180, v181
v_rcp_f32 v119, v121
v_fmac_f32 v184, v200, v111
v_fmac_f32 v185, v201, v111
v_fmac_f32 v186, v202, v111
v_fmac_f32 v187, v203, v111
v_cvt_pk_bf16_f32 v181, v182, v183
v_cvt_pk_bf16_f32 v182, v184, v185
v_cvt_pk_bf16_f32 v183, v186, v187
v_mul_f32 v116, v116, v118
v_mfma_f32_16x16x32_bf16 v[204:207], a[0:3], v[212:215], 0
buffer_store_dwordx4 v[180:183], v2, s[4:7], s35 offen offset:2048 sc1
v_fmac_f32 v116, v120, v119
v_mfma_f32_16x16x32_bf16 v[220:223], a[12:15], v[216:219], 0
v_add_f32 v116, 0x358637bd, v116
v_rcp_f32 v116, v116
v_mfma_f32_16x16x32_bf16 v[208:211], a[4:7], v[212:215], 0
v_mul_f32 v118, v118, v116
v_mul_f32 v119, v119, v116
v_mfma_f32_16x16x32_bf16 v[224:227], a[16:19], v[216:219], 0
v_mul_f32 v204, v204, v118
v_mul_f32 v205, v205, v118
v_mul_f32 v206, v206, v118
v_mul_f32 v207, v207, v118
v_fmac_f32 v204, v220, v119
v_fmac_f32 v205, v221, v119
v_mul_f32 v208, v208, v118
v_mul_f32 v209, v209, v118
v_mul_f32 v210, v210, v118
v_mul_f32 v211, v211, v118
v_fmac_f32 v206, v222, v119
v_fmac_f32 v207, v223, v119
v_cvt_pk_bf16_f32 v204, v204, v205
v_fmac_f32 v208, v224, v119
v_fmac_f32 v209, v225, v119
v_fmac_f32 v210, v226, v119
v_fmac_f32 v211, v227, v119
v_cvt_pk_bf16_f32 v205, v206, v207
v_cvt_pk_bf16_f32 v206, v208, v209
v_cvt_pk_bf16_f32 v207, v210, v211
buffer_store_dwordx4 v[204:207], v2, s[4:7], s35 offen offset:3072 sc1
s_add_u32 s92, s71, 0x30000
s_add_u32 s40, s4, 0x1e00000
s_addc_u32 s41, s5, 0
v_add_u32 v5, 32768, v1
v_add_u32 v6, 98304, v1
s_cmp_eq_u32 s3, 0
s_cselect_b32 s35, 8, 0
s_lshl_b32 s35, s35, 12
v_lshlrev_b32 v132, 16, v32
v_and_b32 v133, 0xffff0000, v32
v_lshlrev_b32 v134, 16, v33
v_and_b32 v135, 0xffff0000, v33
v_lshlrev_b32 v136, 16, v34
v_and_b32 v137, 0xffff0000, v34
v_lshlrev_b32 v138, 16, v35
v_and_b32 v139, 0xffff0000, v35
v_lshlrev_b32 v140, 16, v36
v_and_b32 v141, 0xffff0000, v36
v_lshlrev_b32 v142, 16, v37
v_and_b32 v143, 0xffff0000, v37
v_lshlrev_b32 v144, 16, v38
v_and_b32 v145, 0xffff0000, v38
v_lshlrev_b32 v146, 16, v39
v_and_b32 v147, 0xffff0000, v39
v_lshlrev_b32 v148, 16, v40
v_and_b32 v149, 0xffff0000, v40
v_lshlrev_b32 v150, 16, v41
v_and_b32 v151, 0xffff0000, v41
v_lshlrev_b32 v152, 16, v42
v_and_b32 v153, 0xffff0000, v42
v_lshlrev_b32 v154, 16, v43
v_and_b32 v155, 0xffff0000, v43
v_lshlrev_b32 v156, 16, v44
v_and_b32 v157, 0xffff0000, v44
v_lshlrev_b32 v158, 16, v45
v_and_b32 v159, 0xffff0000, v45
v_lshlrev_b32 v160, 16, v46
v_and_b32 v161, 0xffff0000, v46
v_lshlrev_b32 v162, 16, v47
v_and_b32 v163, 0xffff0000, v47
s_waitcnt vmcnt(0)
s_barrier
s_cmp_lg_u32 s28, 1
s_cbranch_scc1 Lsg_41
buffer_atomic_add v12, v10, s[4:7], s92 offen sc1
Lsg_41:
s_cmp_lg_u32 s28, 1
s_cbranch_scc1 L_wskip7
s_mov_b64 exec, 0
s_branch L_stub20
L_wret7:
s_mov_b64 exec, -1
L_wskip7:
s_cmp_lt_u32 s28, 2
s_cbranch_scc1 Lwo_42
s_add_i32 s44, s28, 0
s_lshl_b32 s45, s44, 12
s_add_u32 m0, s45, 32768
s_and_b32 s45, s44, 7
s_cmp_eq_u32 s45, s3
s_cselect_b32 s45, 8, 0
s_add_u32 s44, s44, s45
s_and_b32 s44, s44, 31
s_lshl_b32 s44, s44, 12
s_add_u32 s44, s44, s51
s_add_u32 s44, s44, 0x200000
buffer_load_dwordx4 v1, s[4:7], s44 offen offset:0 sc1 lds
buffer_load_dwordx4 v1, s[4:7], s44 offen offset:1024 sc1 lds
buffer_load_dwordx4 v1, s[4:7], s44 offen offset:2048 sc1 lds
buffer_load_dwordx4 v1, s[4:7], s44 offen offset:3072 sc1 lds
s_add_i32 s44, s28, -2
s_lshl_b32 s45, s44, 12
s_add_u32 m0, s45, 32768
s_and_b32 s45, s44, 7
s_cmp_eq_u32 s45, s3
s_cselect_b32 s45, 8, 0
s_add_u32 s44, s44, s45
s_and_b32 s44, s44, 31
s_lshl_b32 s44, s44, 12
s_add_u32 s44, s44, s51
s_add_u32 s44, s44, 0x200000
buffer_load_dwordx4 v1, s[4:7], s44 offen offset:0 sc1 lds
buffer_load_dwordx4 v1, s[4:7], s44 offen offset:1024 sc1 lds
buffer_load_dwordx4 v1, s[4:7], s44 offen offset:2048 sc1 lds
buffer_load_dwordx4 v1, s[4:7], s44 offen offset:3072 sc1 lds
Lwo_42:
s_cmp_lg_u32 s28, 0
s_cbranch_scc1 Lpe_44
s_add_u32 s36, s66, 0x30000
s_mov_b32 s37, 0
Lpoll_43:
v_mov_b32 v11, 0
s_mov_b64 exec, 1
buffer_atomic_add v11, off, s[4:7], s36 sc0 sc1
s_waitcnt vmcnt(0)
v_readfirstlane_b32 s38, v11
s_mov_b64 exec, -1
s_nop 0
v_mov_b32 v11, s38
s_add_u32 s37, s37, 1
v_cmp_gt_u32 vcc, 32, v11
s_cbranch_vccz Lpe_44
s_cmp_lt_u32 s37, 0x100000
s_cbranch_scc1 Lpoll_43
Lpe_44:
s_waitcnt vmcnt(0)
s_barrier
L_k2go3:
buffer_load_dwordx4 a[0:3], v4, s[40:43], s35 offen offset:0 sc1
buffer_load_dwordx4 a[4:7], v4, s[40:43], s35 offen offset:1024 sc1
s_cmp_eq_u32 s3, 1
s_cselect_b32 s35, 9, 1
s_lshl_b32 s35, s35, 12
buffer_load_dwordx4 a[8:11], v4, s[40:43], s35 offen offset:0 sc1
buffer_load_dwordx4 a[12:15], v4, s[40:43], s35 offen offset:1024 sc1
s_cmp_eq_u32 s3, 2
s_cselect_b32 s35, 10, 2
s_lshl_b32 s35, s35, 12
buffer_load_dwordx4 a[16:19], v4, s[40:43], s35 offen offset:0 sc1
buffer_load_dwordx4 a[20:23], v4, s[40:43], s35 offen offset:1024 sc1
s_cmp_eq_u32 s3, 3
s_cselect_b32 s35, 11, 3
s_lshl_b32 s35, s35, 12
buffer_load_dwordx4 a[24:27], v4, s[40:43], s35 offen offset:0 sc1
buffer_load_dwordx4 a[28:31], v4, s[40:43], s35 offen offset:1024 sc1
s_cmp_eq_u32 s3, 4
s_cselect_b32 s35, 12, 4
s_lshl_b32 s35, s35, 12
buffer_load_dwordx4 a[32:35], v4, s[40:43], s35 offen offset:0 sc1
buffer_load_dwordx4 a[36:39], v4, s[40:43], s35 offen offset:1024 sc1
s_cmp_eq_u32 s3, 5
s_cselect_b32 s35, 13, 5
s_lshl_b32 s35, s35, 12
ds_read_b128 a[96:99], v5 offset:0
ds_read_b128 a[100:103], v5 offset:1024
ds_read_b128 a[104:107], v5 offset:2048
ds_read_b128 a[108:111], v5 offset:3072
ds_read_b128 a[112:115], v5 offset:4096
ds_read_b128 a[116:119], v5 offset:5120
ds_read_b128 a[120:123], v5 offset:6144
ds_read_b128 a[124:127], v5 offset:7168
s_waitcnt vmcnt(8) lgkmcnt(4)
v_mfma_f32_16x16x32_bf16 v[132:135], a[96:99], a[0:3], v[132:135]
ds_read_b128 a[128:131], v5 offset:8192
v_mfma_f32_16x16x32_bf16 v[148:151], a[96:99], a[4:7], v[148:151]
ds_read_b128 a[132:135], v5 offset:9216
v_mfma_f32_16x16x32_bf16 v[152:155], a[100:103], a[4:7], v[152:155]
buffer_load_dwordx4 a[40:43], v4, s[40:43], s35 offen offset:0 sc1
v_mfma_f32_16x16x32_bf16 v[136:139], a[100:103], a[0:3], v[136:139]
ds_read_b128 a[136:139], v5 offset:10240
v_mfma_f32_16x16x32_bf16 v[140:143], a[104:107], a[0:3], v[140:143]
ds_read_b128 a[140:143], v5 offset:11264
v_mfma_f32_16x16x32_bf16 v[156:159], a[104:107], a[4:7], v[156:159]
v_mfma_f32_16x16x32_bf16 v[160:163], a[108:111], a[4:7], v[160:163]
buffer_load_dwordx4 a[44:47], v4, s[40:43], s35 offen offset:1024 sc1
v_mfma_f32_16x16x32_bf16 v[144:147], a[108:111], a[0:3], v[144:147]
s_waitcnt vmcnt(8) lgkmcnt(4)
v_mfma_f32_16x16x32_bf16 v[132:135], a[112:115], a[8:11], v[132:135]
s_cmp_eq_u32 s3, 6
s_cselect_b32 s35, 14, 6
s_lshl_b32 s35, s35, 12
v_mfma_f32_16x16x32_bf16 v[148:151], a[112:115], a[12:15], v[148:151]
ds_read_b128 a[96:99], v5 offset:12288
v_mfma_f32_16x16x32_bf16 v[152:155], a[116:119], a[12:15], v[152:155]
buffer_load_dwordx4 a[0:3], v4, s[40:43], s35 offen offset:0 sc1
v_mfma_f32_16x16x32_bf16 v[136:139], a[116:119], a[8:11], v[136:139]
ds_read_b128 a[100:103], v5 offset:13312
v_mfma_f32_16x16x32_bf16 v[140:143], a[120:123], a[8:11], v[140:143]
ds_read_b128 a[104:107], v5 offset:14336
v_mfma_f32_16x16x32_bf16 v[156:159], a[120:123], a[12:15], v[156:159]
ds_read_b128 a[108:111], v5 offset:15360
v_mfma_f32_16x16x32_bf16 v[160:163], a[124:127], a[12:15], v[160:163]
buffer_load_dwordx4 a[4:7], v4, s[40:43], s35 offen offset:1024 sc1
v_mfma_f32_16x16x32_bf16 v[144:147], a[124:127], a[8:11], v[144:147]
s_waitcnt vmcnt(8) lgkmcnt(4)
v_mfma_f32_16x16x32_bf16 v[132:135], a[128:131], a[16:19], v[132:135]
s_cmp_eq_u32 s3, 7
s_cselect_b32 s35, 15, 7
s_lshl_b32 s35, s35, 12
v_mfma_f32_16x16x32_bf16 v[148:151], a[128:131], a[20:23], v[148:151]
ds_read_b128 a[112:115], v5 offset:16384
v_mfma_f32_16x16x32_bf16 v[152:155], a[132:135], a[20:23], v[152:155]
buffer_load_dwordx4 a[8:11], v4, s[40:43], s35 offen offset:0 sc1
v_mfma_f32_16x16x32_bf16 v[136:139], a[132:135], a[16:19], v[136:139]
ds_read_b128 a[116:119], v5 offset:17408
v_mfma_f32_16x16x32_bf16 v[140:143], a[136:139], a[16:19], v[140:143]
ds_read_b128 a[120:123], v5 offset:18432
v_mfma_f32_16x16x32_bf16 v[156:159], a[136:139], a[20:23], v[156:159]
ds_read_b128 a[124:127], v5 offset:19456
v_mfma_f32_16x16x32_bf16 v[160:163], a[140:143], a[20:23], v[160:163]
buffer_load_dwordx4 a[12:15], v4, s[40:43], s35 offen offset:1024 sc1
v_mfma_f32_16x16x32_bf16 v[144:147], a[140:143], a[16:19], v[144:147]
s_waitcnt vmcnt(8) lgkmcnt(4)
v_mfma_f32_16x16x32_bf16 v[132:135], a[96:99], a[24:27], v[132:135]
s_cmp_eq_u32 s3, 0
s_cselect_b32 s35, 16, 8
s_lshl_b32 s35, s35, 12
v_mfma_f32_16x16x32_bf16 v[148:151], a[96:99], a[28:31], v[148:151]
ds_read_b128 a[128:131], v5 offset:20480
v_mfma_f32_16x16x32_bf16 v[152:155], a[100:103], a[28:31], v[152:155]
buffer_load_dwordx4 a[16:19], v4, s[40:43], s35 offen offset:0 sc1
v_mfma_f32_16x16x32_bf16 v[136:139], a[100:103], a[24:27], v[136:139]
ds_read_b128 a[132:135], v5 offset:21504
v_mfma_f32_16x16x32_bf16 v[140:143], a[104:107], a[24:27], v[140:143]
ds_read_b128 a[136:139], v5 offset:22528
v_mfma_f32_16x16x32_bf16 v[156:159], a[104:107], a[28:31], v[156:159]
ds_read_b128 a[140:143], v5 offset:23552
v_mfma_f32_16x16x32_bf16 v[160:163], a[108:111], a[28:31], v[160:163]
buffer_load_dwordx4 a[20:23], v4, s[40:43], s35 offen offset:1024 sc1
v_mfma_f32_16x16x32_bf16 v[144:147], a[108:111], a[24:27], v[144:147]
s_waitcnt vmcnt(8) lgkmcnt(4)
v_mfma_f32_16x16x32_bf16 v[132:135], a[112:115], a[32:35], v[132:135]
s_cmp_eq_u32 s3, 1
s_cselect_b32 s35, 17, 9
s_lshl_b32 s35, s35, 12
v_mfma_f32_16x16x32_bf16 v[148:151], a[112:115], a[36:39], v[148:151]
ds_read_b128 a[96:99], v5 offset:24576
v_mfma_f32_16x16x32_bf16 v[152:155], a[116:119], a[36:39], v[152:155]
buffer_load_dwordx4 a[24:27], v4, s[40:43], s35 offen offset:0 sc1
v_mfma_f32_16x16x32_bf16 v[136:139], a[116:119], a[32:35], v[136:139]
ds_read_b128 a[100:103], v5 offset:25600
v_mfma_f32_16x16x32_bf16 v[140:143], a[120:123], a[32:35], v[140:143]
ds_read_b128 a[104:107], v5 offset:26624
v_mfma_f32_16x16x32_bf16 v[156:159], a[120:123], a[36:39], v[156:159]
ds_read_b128 a[108:111], v5 offset:27648
v_mfma_f32_16x16x32_bf16 v[160:163], a[124:127], a[36:39], v[160:163]
buffer_load_dwordx4 a[28:31], v4, s[40:43], s35 offen offset:1024 sc1
v_mfma_f32_16x16x32_bf16 v[144:147], a[124:127], a[32:35], v[144:147]
s_waitcnt vmcnt(8) lgkmcnt(4)
v_mfma_f32_16x16x32_bf16 v[132:135], a[128:131], a[40:43], v[132:135]
s_cmp_eq_u32 s3, 2
s_cselect_b32 s35, 18, 10
s_lshl_b32 s35, s35, 12
v_mfma_f32_16x16x32_bf16 v[148:151], a[128:131], a[44:47], v[148:151]
ds_read_b128 a[112:115], v5 offset:28672
v_mfma_f32_16x16x32_bf16 v[152:155], a[132:135], a[44:47], v[152:155]
buffer_load_dwordx4 a[32:35], v4, s[40:43], s35 offen offset:0 sc1
v_mfma_f32_16x16x32_bf16 v[136:139], a[132:135], a[40:43], v[136:139]
ds_read_b128 a[116:119], v5 offset:29696
v_mfma_f32_16x16x32_bf16 v[140:143], a[136:139], a[40:43], v[140:143]
ds_read_b128 a[120:123], v5 offset:30720
v_mfma_f32_16x16x32_bf16 v[156:159], a[136:139], a[44:47], v[156:159]
ds_read_b128 a[124:127], v5 offset:31744
v_mfma_f32_16x16x32_bf16 v[160:163], a[140:143], a[44:47], v[160:163]
buffer_load_dwordx4 a[36:39], v4, s[40:43], s35 offen offset:1024 sc1
v_mfma_f32_16x16x32_bf16 v[144:147], a[140:143], a[40:43], v[144:147]
s_waitcnt vmcnt(8) lgkmcnt(4)
v_mfma_f32_16x16x32_bf16 v[132:135], a[96:99], a[0:3], v[132:135]
s_cmp_eq_u32 s3, 3
s_cselect_b32 s35, 19, 11
s_lshl_b32 s35, s35, 12
v_mfma_f32_16x16x32_bf16 v[148:151], a[96:99], a[4:7], v[148:151]
ds_read_b128 a[128:131], v5 offset:32768
v_mfma_f32_16x16x32_bf16 v[152:155], a[100:103], a[4:7], v[152:155]
buffer_load_dwordx4 a[40:43], v4, s[40:43], s35 offen offset:0 sc1
v_mfma_f32_16x16x32_bf16 v[136:139], a[100:103], a[0:3], v[136:139]
ds_read_b128 a[132:135], v5 offset:33792
v_mfma_f32_16x16x32_bf16 v[140:143], a[104:107], a[0:3], v[140:143]
ds_read_b128 a[136:139], v5 offset:34816
v_mfma_f32_16x16x32_bf16 v[156:159], a[104:107], a[4:7], v[156:159]
ds_read_b128 a[140:143], v5 offset:35840
v_mfma_f32_16x16x32_bf16 v[160:163], a[108:111], a[4:7], v[160:163]
buffer_load_dwordx4 a[44:47], v4, s[40:43], s35 offen offset:1024 sc1
v_mfma_f32_16x16x32_bf16 v[144:147], a[108:111], a[0:3], v[144:147]
s_waitcnt vmcnt(8) lgkmcnt(4)
v_mfma_f32_16x16x32_bf16 v[132:135], a[112:115], a[8:11], v[132:135]
s_cmp_eq_u32 s3, 4
s_cselect_b32 s35, 20, 12
s_lshl_b32 s35, s35, 12
v_mfma_f32_16x16x32_bf16 v[148:151], a[112:115], a[12:15], v[148:151]
ds_read_b128 a[96:99], v5 offset:36864
v_mfma_f32_16x16x32_bf16 v[152:155], a[116:119], a[12:15], v[152:155]
buffer_load_dwordx4 a[0:3], v4, s[40:43], s35 offen offset:0 sc1
v_mfma_f32_16x16x32_bf16 v[136:139], a[116:119], a[8:11], v[136:139]
ds_read_b128 a[100:103], v5 offset:37888
v_mfma_f32_16x16x32_bf16 v[140:143], a[120:123], a[8:11], v[140:143]
ds_read_b128 a[104:107], v5 offset:38912
v_mfma_f32_16x16x32_bf16 v[156:159], a[120:123], a[12:15], v[156:159]
ds_read_b128 a[108:111], v5 offset:39936
v_mfma_f32_16x16x32_bf16 v[160:163], a[124:127], a[12:15], v[160:163]
buffer_load_dwordx4 a[4:7], v4, s[40:43], s35 offen offset:1024 sc1
v_mfma_f32_16x16x32_bf16 v[144:147], a[124:127], a[8:11], v[144:147]
s_waitcnt vmcnt(8) lgkmcnt(4)
v_mfma_f32_16x16x32_bf16 v[132:135], a[128:131], a[16:19], v[132:135]
s_cmp_eq_u32 s3, 5
s_cselect_b32 s35, 21, 13
s_lshl_b32 s35, s35, 12
v_mfma_f32_16x16x32_bf16 v[148:151], a[128:131], a[20:23], v[148:151]
ds_read_b128 a[112:115], v5 offset:40960
v_mfma_f32_16x16x32_bf16 v[152:155], a[132:135], a[20:23], v[152:155]
buffer_load_dwordx4 a[8:11], v4, s[40:43], s35 offen offset:0 sc1
v_mfma_f32_16x16x32_bf16 v[136:139], a[132:135], a[16:19], v[136:139]
ds_read_b128 a[116:119], v5 offset:41984
v_mfma_f32_16x16x32_bf16 v[140:143], a[136:139], a[16:19], v[140:143]
ds_read_b128 a[120:123], v5 offset:43008
v_mfma_f32_16x16x32_bf16 v[156:159], a[136:139], a[20:23], v[156:159]
ds_read_b128 a[124:127], v5 offset:44032
v_mfma_f32_16x16x32_bf16 v[160:163], a[140:143], a[20:23], v[160:163]
buffer_load_dwordx4 a[12:15], v4, s[40:43], s35 offen offset:1024 sc1
v_mfma_f32_16x16x32_bf16 v[144:147], a[140:143], a[16:19], v[144:147]
s_waitcnt vmcnt(8) lgkmcnt(4)
v_mfma_f32_16x16x32_bf16 v[132:135], a[96:99], a[24:27], v[132:135]
s_cmp_eq_u32 s3, 6
s_cselect_b32 s35, 22, 14
s_lshl_b32 s35, s35, 12
v_mfma_f32_16x16x32_bf16 v[148:151], a[96:99], a[28:31], v[148:151]
ds_read_b128 a[128:131], v5 offset:45056
v_mfma_f32_16x16x32_bf16 v[152:155], a[100:103], a[28:31], v[152:155]
buffer_load_dwordx4 a[16:19], v4, s[40:43], s35 offen offset:0 sc1
v_mfma_f32_16x16x32_bf16 v[136:139], a[100:103], a[24:27], v[136:139]
ds_read_b128 a[132:135], v5 offset:46080
v_mfma_f32_16x16x32_bf16 v[140:143], a[104:107], a[24:27], v[140:143]
ds_read_b128 a[136:139], v5 offset:47104
v_mfma_f32_16x16x32_bf16 v[156:159], a[104:107], a[28:31], v[156:159]
ds_read_b128 a[140:143], v5 offset:48128
v_mfma_f32_16x16x32_bf16 v[160:163], a[108:111], a[28:31], v[160:163]
buffer_load_dwordx4 a[20:23], v4, s[40:43], s35 offen offset:1024 sc1
v_mfma_f32_16x16x32_bf16 v[144:147], a[108:111], a[24:27], v[144:147]
s_waitcnt vmcnt(8) lgkmcnt(4)
v_mfma_f32_16x16x32_bf16 v[132:135], a[112:115], a[32:35], v[132:135]
s_cmp_eq_u32 s3, 7
s_cselect_b32 s35, 23, 15
s_lshl_b32 s35, s35, 12
v_mfma_f32_16x16x32_bf16 v[148:151], a[112:115], a[36:39], v[148:151]
ds_read_b128 a[96:99], v5 offset:49152
v_mfma_f32_16x16x32_bf16 v[152:155], a[116:119], a[36:39], v[152:155]
buffer_load_dwordx4 a[24:27], v4, s[40:43], s35 offen offset:0 sc1
L_stub20:
s_cbranch_execz L_wret7
v_mfma_f32_16x16x32_bf16 v[136:139], a[116:119], a[32:35], v[136:139]
ds_read_b128 a[100:103], v5 offset:50176
v_mfma_f32_16x16x32_bf16 v[140:143], a[120:123], a[32:35], v[140:143]
ds_read_b128 a[104:107], v5 offset:51200
v_mfma_f32_16x16x32_bf16 v[156:159], a[120:123], a[36:39], v[156:159]
ds_read_b128 a[108:111], v5 offset:52224
v_mfma_f32_16x16x32_bf16 v[160:163], a[124:127], a[36:39], v[160:163]
buffer_load_dwordx4 a[28:31], v4, s[40:43], s35 offen offset:1024 sc1
v_mfma_f32_16x16x32_bf16 v[144:147], a[124:127], a[32:35], v[144:147]
s_waitcnt vmcnt(8) lgkmcnt(4)
v_mfma_f32_16x16x32_bf16 v[132:135], a[128:131], a[40:43], v[132:135]
s_cmp_eq_u32 s3, 0
s_cselect_b32 s35, 24, 16
s_lshl_b32 s35, s35, 12
v_mfma_f32_16x16x32_bf16 v[148:151], a[128:131], a[44:47], v[148:151]
ds_read_b128 a[112:115], v5 offset:53248
v_mfma_f32_16x16x32_bf16 v[152:155], a[132:135], a[44:47], v[152:155]
buffer_load_dwordx4 a[32:35], v4, s[40:43], s35 offen offset:0 sc1
v_mfma_f32_16x16x32_bf16 v[136:139], a[132:135], a[40:43], v[136:139]
ds_read_b128 a[116:119], v5 offset:54272
v_mfma_f32_16x16x32_bf16 v[140:143], a[136:139], a[40:43], v[140:143]
ds_read_b128 a[120:123], v5 offset:55296
v_mfma_f32_16x16x32_bf16 v[156:159], a[136:139], a[44:47], v[156:159]
ds_read_b128 a[124:127], v5 offset:56320
v_mfma_f32_16x16x32_bf16 v[160:163], a[140:143], a[44:47], v[160:163]
buffer_load_dwordx4 a[36:39], v4, s[40:43], s35 offen offset:1024 sc1
v_mfma_f32_16x16x32_bf16 v[144:147], a[140:143], a[40:43], v[144:147]
s_waitcnt vmcnt(8) lgkmcnt(4)
v_mfma_f32_16x16x32_bf16 v[132:135], a[96:99], a[0:3], v[132:135]
s_cmp_eq_u32 s3, 1
s_cselect_b32 s35, 25, 17
s_lshl_b32 s35, s35, 12
v_mfma_f32_16x16x32_bf16 v[148:151], a[96:99], a[4:7], v[148:151]
ds_read_b128 a[128:131], v5 offset:57344
v_mfma_f32_16x16x32_bf16 v[152:155], a[100:103], a[4:7], v[152:155]
buffer_load_dwordx4 a[40:43], v4, s[40:43], s35 offen offset:0 sc1
v_mfma_f32_16x16x32_bf16 v[136:139], a[100:103], a[0:3], v[136:139]
ds_read_b128 a[132:135], v5 offset:58368
v_mfma_f32_16x16x32_bf16 v[140:143], a[104:107], a[0:3], v[140:143]
ds_read_b128 a[136:139], v5 offset:59392
v_mfma_f32_16x16x32_bf16 v[156:159], a[104:107], a[4:7], v[156:159]
ds_read_b128 a[140:143], v5 offset:60416
v_mfma_f32_16x16x32_bf16 v[160:163], a[108:111], a[4:7], v[160:163]
buffer_load_dwordx4 a[44:47], v4, s[40:43], s35 offen offset:1024 sc1
v_mfma_f32_16x16x32_bf16 v[144:147], a[108:111], a[0:3], v[144:147]
s_waitcnt vmcnt(8) lgkmcnt(4)
v_mfma_f32_16x16x32_bf16 v[132:135], a[112:115], a[8:11], v[132:135]
s_cmp_eq_u32 s3, 2
s_cselect_b32 s35, 26, 18
s_lshl_b32 s35, s35, 12
v_mfma_f32_16x16x32_bf16 v[148:151], a[112:115], a[12:15], v[148:151]
ds_read_b128 a[96:99], v5 offset:61440
v_mfma_f32_16x16x32_bf16 v[152:155], a[116:119], a[12:15], v[152:155]
buffer_load_dwordx4 a[0:3], v4, s[40:43], s35 offen offset:0 sc1
v_mfma_f32_16x16x32_bf16 v[136:139], a[116:119], a[8:11], v[136:139]
ds_read_b128 a[100:103], v5 offset:62464
v_mfma_f32_16x16x32_bf16 v[140:143], a[120:123], a[8:11], v[140:143]
ds_read_b128 a[104:107], v5 offset:63488
v_mfma_f32_16x16x32_bf16 v[156:159], a[120:123], a[12:15], v[156:159]
ds_read_b128 a[108:111], v5 offset:64512
v_mfma_f32_16x16x32_bf16 v[160:163], a[124:127], a[12:15], v[160:163]
buffer_load_dwordx4 a[4:7], v4, s[40:43], s35 offen offset:1024 sc1
v_mfma_f32_16x16x32_bf16 v[144:147], a[124:127], a[8:11], v[144:147]
s_waitcnt vmcnt(8) lgkmcnt(4)
v_mfma_f32_16x16x32_bf16 v[132:135], a[128:131], a[16:19], v[132:135]
s_cmp_eq_u32 s3, 3
s_cselect_b32 s35, 27, 19
s_lshl_b32 s35, s35, 12
v_mfma_f32_16x16x32_bf16 v[148:151], a[128:131], a[20:23], v[148:151]
ds_read_b128 a[112:115], v6 offset:0
v_mfma_f32_16x16x32_bf16 v[152:155], a[132:135], a[20:23], v[152:155]
buffer_load_dwordx4 a[8:11], v4, s[40:43], s35 offen offset:0 sc1
v_mfma_f32_16x16x32_bf16 v[136:139], a[132:135], a[16:19], v[136:139]
ds_read_b128 a[116:119], v6 offset:1024
v_mfma_f32_16x16x32_bf16 v[140:143], a[136:139], a[16:19], v[140:143]
ds_read_b128 a[120:123], v6 offset:2048
v_mfma_f32_16x16x32_bf16 v[156:159], a[136:139], a[20:23], v[156:159]
ds_read_b128 a[124:127], v6 offset:3072
v_mfma_f32_16x16x32_bf16 v[160:163], a[140:143], a[20:23], v[160:163]
buffer_load_dwordx4 a[12:15], v4, s[40:43], s35 offen offset:1024 sc1
v_mfma_f32_16x16x32_bf16 v[144:147], a[140:143], a[16:19], v[144:147]
s_waitcnt vmcnt(8) lgkmcnt(4)
v_mfma_f32_16x16x32_bf16 v[132:135], a[96:99], a[24:27], v[132:135]
s_cmp_eq_u32 s3, 4
s_cselect_b32 s35, 28, 20
s_lshl_b32 s35, s35, 12
v_mfma_f32_16x16x32_bf16 v[148:151], a[96:99], a[28:31], v[148:151]
ds_read_b128 a[128:131], v6 offset:4096
v_mfma_f32_16x16x32_bf16 v[152:155], a[100:103], a[28:31], v[152:155]
buffer_load_dwordx4 a[16:19], v4, s[40:43], s35 offen offset:0 sc1
v_mfma_f32_16x16x32_bf16 v[136:139], a[100:103], a[24:27], v[136:139]
ds_read_b128 a[132:135], v6 offset:5120
v_mfma_f32_16x16x32_bf16 v[140:143], a[104:107], a[24:27], v[140:143]
ds_read_b128 a[136:139], v6 offset:6144
v_mfma_f32_16x16x32_bf16 v[156:159], a[104:107], a[28:31], v[156:159]
ds_read_b128 a[140:143], v6 offset:7168
v_mfma_f32_16x16x32_bf16 v[160:163], a[108:111], a[28:31], v[160:163]
buffer_load_dwordx4 a[20:23], v4, s[40:43], s35 offen offset:1024 sc1
v_mfma_f32_16x16x32_bf16 v[144:147], a[108:111], a[24:27], v[144:147]
s_waitcnt vmcnt(8) lgkmcnt(4)
v_mfma_f32_16x16x32_bf16 v[132:135], a[112:115], a[32:35], v[132:135]
s_cmp_eq_u32 s3, 5
s_cselect_b32 s35, 29, 21
s_lshl_b32 s35, s35, 12
v_mfma_f32_16x16x32_bf16 v[148:151], a[112:115], a[36:39], v[148:151]
ds_read_b128 a[96:99], v6 offset:8192
v_mfma_f32_16x16x32_bf16 v[152:155], a[116:119], a[36:39], v[152:155]
buffer_load_dwordx4 a[24:27], v4, s[40:43], s35 offen offset:0 sc1
v_mfma_f32_16x16x32_bf16 v[136:139], a[116:119], a[32:35], v[136:139]
ds_read_b128 a[100:103], v6 offset:9216
v_mfma_f32_16x16x32_bf16 v[140:143], a[120:123], a[32:35], v[140:143]
ds_read_b128 a[104:107], v6 offset:10240
v_mfma_f32_16x16x32_bf16 v[156:159], a[120:123], a[36:39], v[156:159]
ds_read_b128 a[108:111], v6 offset:11264
v_mfma_f32_16x16x32_bf16 v[160:163], a[124:127], a[36:39], v[160:163]
buffer_load_dwordx4 a[28:31], v4, s[40:43], s35 offen offset:1024 sc1
v_mfma_f32_16x16x32_bf16 v[144:147], a[124:127], a[32:35], v[144:147]
s_waitcnt vmcnt(8) lgkmcnt(4)
v_mfma_f32_16x16x32_bf16 v[132:135], a[128:131], a[40:43], v[132:135]
s_cmp_eq_u32 s3, 6
s_cselect_b32 s35, 30, 22
s_lshl_b32 s35, s35, 12
v_mfma_f32_16x16x32_bf16 v[148:151], a[128:131], a[44:47], v[148:151]
ds_read_b128 a[112:115], v6 offset:12288
v_mfma_f32_16x16x32_bf16 v[152:155], a[132:135], a[44:47], v[152:155]
buffer_load_dwordx4 a[32:35], v4, s[40:43], s35 offen offset:0 sc1
v_mfma_f32_16x16x32_bf16 v[136:139], a[132:135], a[40:43], v[136:139]
ds_read_b128 a[116:119], v6 offset:13312
v_mfma_f32_16x16x32_bf16 v[140:143], a[136:139], a[40:43], v[140:143]
ds_read_b128 a[120:123], v6 offset:14336
v_mfma_f32_16x16x32_bf16 v[156:159], a[136:139], a[44:47], v[156:159]
ds_read_b128 a[124:127], v6 offset:15360
v_mfma_f32_16x16x32_bf16 v[160:163], a[140:143], a[44:47], v[160:163]
buffer_load_dwordx4 a[36:39], v4, s[40:43], s35 offen offset:1024 sc1
v_mfma_f32_16x16x32_bf16 v[144:147], a[140:143], a[40:43], v[144:147]
s_waitcnt vmcnt(8) lgkmcnt(4)
v_mfma_f32_16x16x32_bf16 v[132:135], a[96:99], a[0:3], v[132:135]
s_cmp_eq_u32 s3, 7
s_cselect_b32 s35, 31, 23
s_lshl_b32 s35, s35, 12
v_mfma_f32_16x16x32_bf16 v[148:151], a[96:99], a[4:7], v[148:151]
ds_read_b128 a[128:131], v6 offset:16384
v_mfma_f32_16x16x32_bf16 v[152:155], a[100:103], a[4:7], v[152:155]
buffer_load_dwordx4 a[40:43], v4, s[40:43], s35 offen offset:0 sc1
v_mfma_f32_16x16x32_bf16 v[136:139], a[100:103], a[0:3], v[136:139]
ds_read_b128 a[132:135], v6 offset:17408
v_mfma_f32_16x16x32_bf16 v[140:143], a[104:107], a[0:3], v[140:143]
ds_read_b128 a[136:139], v6 offset:18432
v_mfma_f32_16x16x32_bf16 v[156:159], a[104:107], a[4:7], v[156:159]
ds_read_b128 a[140:143], v6 offset:19456
v_mfma_f32_16x16x32_bf16 v[160:163], a[108:111], a[4:7], v[160:163]
buffer_load_dwordx4 a[44:47], v4, s[40:43], s35 offen offset:1024 sc1
v_mfma_f32_16x16x32_bf16 v[144:147], a[108:111], a[0:3], v[144:147]
s_waitcnt vmcnt(8) lgkmcnt(4)
v_mfma_f32_16x16x32_bf16 v[132:135], a[112:115], a[8:11], v[132:135]
s_cmp_eq_u32 s3, 0
s_cselect_b32 s35, 0, 24
s_lshl_b32 s35, s35, 12
v_mfma_f32_16x16x32_bf16 v[148:151], a[112:115], a[12:15], v[148:151]
ds_read_b128 a[96:99], v6 offset:20480
v_mfma_f32_16x16x32_bf16 v[152:155], a[116:119], a[12:15], v[152:155]
buffer_load_dwordx4 a[0:3], v4, s[40:43], s35 offen offset:0 sc1
v_mfma_f32_16x16x32_bf16 v[136:139], a[116:119], a[8:11], v[136:139]
ds_read_b128 a[100:103], v6 offset:21504
v_mfma_f32_16x16x32_bf16 v[140:143], a[120:123], a[8:11], v[140:143]
ds_read_b128 a[104:107], v6 offset:22528
v_mfma_f32_16x16x32_bf16 v[156:159], a[120:123], a[12:15], v[156:159]
ds_read_b128 a[108:111], v6 offset:23552
v_mfma_f32_16x16x32_bf16 v[160:163], a[124:127], a[12:15], v[160:163]
buffer_load_dwordx4 a[4:7], v4, s[40:43], s35 offen offset:1024 sc1
v_mfma_f32_16x16x32_bf16 v[144:147], a[124:127], a[8:11], v[144:147]
s_waitcnt vmcnt(8) lgkmcnt(4)
v_mfma_f32_16x16x32_bf16 v[132:135], a[128:131], a[16:19], v[132:135]
s_cmp_eq_u32 s3, 1
s_cselect_b32 s35, 1, 25
s_lshl_b32 s35, s35, 12
v_mfma_f32_16x16x32_bf16 v[148:151], a[128:131], a[20:23], v[148:151]
ds_read_b128 a[112:115], v6 offset:24576
v_mfma_f32_16x16x32_bf16 v[152:155], a[132:135], a[20:23], v[152:155]
buffer_load_dwordx4 a[8:11], v4, s[40:43], s35 offen offset:0 sc1
v_mfma_f32_16x16x32_bf16 v[136:139], a[132:135], a[16:19], v[136:139]
ds_read_b128 a[116:119], v6 offset:25600
v_mfma_f32_16x16x32_bf16 v[140:143], a[136:139], a[16:19], v[140:143]
ds_read_b128 a[120:123], v6 offset:26624
v_mfma_f32_16x16x32_bf16 v[156:159], a[136:139], a[20:23], v[156:159]
ds_read_b128 a[124:127], v6 offset:27648
v_mfma_f32_16x16x32_bf16 v[160:163], a[140:143], a[20:23], v[160:163]
buffer_load_dwordx4 a[12:15], v4, s[40:43], s35 offen offset:1024 sc1
v_mfma_f32_16x16x32_bf16 v[144:147], a[140:143], a[16:19], v[144:147]
s_waitcnt vmcnt(8) lgkmcnt(4)
v_mfma_f32_16x16x32_bf16 v[132:135], a[96:99], a[24:27], v[132:135]
s_cmp_eq_u32 s3, 2
s_cselect_b32 s35, 2, 26
s_lshl_b32 s35, s35, 12
v_mfma_f32_16x16x32_bf16 v[148:151], a[96:99], a[28:31], v[148:151]
ds_read_b128 a[128:131], v6 offset:28672
v_mfma_f32_16x16x32_bf16 v[152:155], a[100:103], a[28:31], v[152:155]
buffer_load_dwordx4 a[16:19], v4, s[40:43], s35 offen offset:0 sc1
v_mfma_f32_16x16x32_bf16 v[136:139], a[100:103], a[24:27], v[136:139]
ds_read_b128 a[132:135], v6 offset:29696
v_mfma_f32_16x16x32_bf16 v[140:143], a[104:107], a[24:27], v[140:143]
ds_read_b128 a[136:139], v6 offset:30720
v_mfma_f32_16x16x32_bf16 v[156:159], a[104:107], a[28:31], v[156:159]
ds_read_b128 a[140:143], v6 offset:31744
v_mfma_f32_16x16x32_bf16 v[160:163], a[108:111], a[28:31], v[160:163]
buffer_load_dwordx4 a[20:23], v4, s[40:43], s35 offen offset:1024 sc1
v_mfma_f32_16x16x32_bf16 v[144:147], a[108:111], a[24:27], v[144:147]
s_waitcnt vmcnt(8) lgkmcnt(4)
v_mfma_f32_16x16x32_bf16 v[132:135], a[112:115], a[32:35], v[132:135]
s_cmp_eq_u32 s3, 3
s_cselect_b32 s35, 3, 27
s_lshl_b32 s35, s35, 12
v_mfma_f32_16x16x32_bf16 v[148:151], a[112:115], a[36:39], v[148:151]
ds_read_b128 a[96:99], v6 offset:32768
v_mfma_f32_16x16x32_bf16 v[152:155], a[116:119], a[36:39], v[152:155]
buffer_load_dwordx4 a[24:27], v4, s[40:43], s35 offen offset:0 sc1
v_mfma_f32_16x16x32_bf16 v[136:139], a[116:119], a[32:35], v[136:139]
ds_read_b128 a[100:103], v6 offset:33792
v_mfma_f32_16x16x32_bf16 v[140:143], a[120:123], a[32:35], v[140:143]
ds_read_b128 a[104:107], v6 offset:34816
v_mfma_f32_16x16x32_bf16 v[156:159], a[120:123], a[36:39], v[156:159]
ds_read_b128 a[108:111], v6 offset:35840
v_mfma_f32_16x16x32_bf16 v[160:163], a[124:127], a[36:39], v[160:163]
buffer_load_dwordx4 a[28:31], v4, s[40:43], s35 offen offset:1024 sc1
v_mfma_f32_16x16x32_bf16 v[144:147], a[124:127], a[32:35], v[144:147]
s_waitcnt vmcnt(8) lgkmcnt(4)
v_mfma_f32_16x16x32_bf16 v[132:135], a[128:131], a[40:43], v[132:135]
s_cmp_eq_u32 s3, 4
s_cselect_b32 s35, 4, 28
s_lshl_b32 s35, s35, 12
v_mfma_f32_16x16x32_bf16 v[148:151], a[128:131], a[44:47], v[148:151]
ds_read_b128 a[112:115], v6 offset:36864
v_mfma_f32_16x16x32_bf16 v[152:155], a[132:135], a[44:47], v[152:155]
buffer_load_dwordx4 a[32:35], v4, s[40:43], s35 offen offset:0 sc1
v_mfma_f32_16x16x32_bf16 v[136:139], a[132:135], a[40:43], v[136:139]
ds_read_b128 a[116:119], v6 offset:37888
v_mfma_f32_16x16x32_bf16 v[140:143], a[136:139], a[40:43], v[140:143]
ds_read_b128 a[120:123], v6 offset:38912
v_mfma_f32_16x16x32_bf16 v[156:159], a[136:139], a[44:47], v[156:159]
ds_read_b128 a[124:127], v6 offset:39936
v_mfma_f32_16x16x32_bf16 v[160:163], a[140:143], a[44:47], v[160:163]
buffer_load_dwordx4 a[36:39], v4, s[40:43], s35 offen offset:1024 sc1
v_mfma_f32_16x16x32_bf16 v[144:147], a[140:143], a[40:43], v[144:147]
s_waitcnt vmcnt(8) lgkmcnt(4)
v_mfma_f32_16x16x32_bf16 v[132:135], a[96:99], a[0:3], v[132:135]
s_cmp_eq_u32 s3, 5
s_cselect_b32 s35, 5, 29
s_lshl_b32 s35, s35, 12
v_mfma_f32_16x16x32_bf16 v[148:151], a[96:99], a[4:7], v[148:151]
ds_read_b128 a[128:131], v6 offset:40960
v_mfma_f32_16x16x32_bf16 v[152:155], a[100:103], a[4:7], v[152:155]
buffer_load_dwordx4 a[40:43], v4, s[40:43], s35 offen offset:0 sc1
v_mfma_f32_16x16x32_bf16 v[136:139], a[100:103], a[0:3], v[136:139]
ds_read_b128 a[132:135], v6 offset:41984
v_mfma_f32_16x16x32_bf16 v[140:143], a[104:107], a[0:3], v[140:143]
ds_read_b128 a[136:139], v6 offset:43008
v_mfma_f32_16x16x32_bf16 v[156:159], a[104:107], a[4:7], v[156:159]
ds_read_b128 a[140:143], v6 offset:44032
v_mfma_f32_16x16x32_bf16 v[160:163], a[108:111], a[4:7], v[160:163]
buffer_load_dwordx4 a[44:47], v4, s[40:43], s35 offen offset:1024 sc1
v_mfma_f32_16x16x32_bf16 v[144:147], a[108:111], a[0:3], v[144:147]
s_waitcnt vmcnt(8) lgkmcnt(4)
v_mfma_f32_16x16x32_bf16 v[132:135], a[112:115], a[8:11], v[132:135]
s_cmp_eq_u32 s3, 6
s_cselect_b32 s35, 6, 30
s_lshl_b32 s35, s35, 12
v_mfma_f32_16x16x32_bf16 v[148:151], a[112:115], a[12:15], v[148:151]
ds_read_b128 a[96:99], v6 offset:45056
v_mfma_f32_16x16x32_bf16 v[152:155], a[116:119], a[12:15], v[152:155]
buffer_load_dwordx4 a[0:3], v4, s[40:43], s35 offen offset:0 sc1
v_mfma_f32_16x16x32_bf16 v[136:139], a[116:119], a[8:11], v[136:139]
ds_read_b128 a[100:103], v6 offset:46080
v_mfma_f32_16x16x32_bf16 v[140:143], a[120:123], a[8:11], v[140:143]
ds_read_b128 a[104:107], v6 offset:47104
v_mfma_f32_16x16x32_bf16 v[156:159], a[120:123], a[12:15], v[156:159]
ds_read_b128 a[108:111], v6 offset:48128
v_mfma_f32_16x16x32_bf16 v[160:163], a[124:127], a[12:15], v[160:163]
buffer_load_dwordx4 a[4:7], v4, s[40:43], s35 offen offset:1024 sc1
v_mfma_f32_16x16x32_bf16 v[144:147], a[124:127], a[8:11], v[144:147]
s_waitcnt vmcnt(8) lgkmcnt(4)
v_mfma_f32_16x16x32_bf16 v[132:135], a[128:131], a[16:19], v[132:135]
s_cmp_eq_u32 s3, 7
s_cselect_b32 s35, 7, 31
s_lshl_b32 s35, s35, 12
v_mfma_f32_16x16x32_bf16 v[148:151], a[128:131], a[20:23], v[148:151]
ds_read_b128 a[112:115], v6 offset:49152
v_mfma_f32_16x16x32_bf16 v[152:155], a[132:135], a[20:23], v[152:155]
buffer_load_dwordx4 a[8:11], v4, s[40:43], s35 offen offset:0 sc1
v_mfma_f32_16x16x32_bf16 v[136:139], a[132:135], a[16:19], v[136:139]
ds_read_b128 a[116:119], v6 offset:50176
v_mfma_f32_16x16x32_bf16 v[140:143], a[136:139], a[16:19], v[140:143]
ds_read_b128 a[120:123], v6 offset:51200
v_mfma_f32_16x16x32_bf16 v[156:159], a[136:139], a[20:23], v[156:159]
ds_read_b128 a[124:127], v6 offset:52224
v_mfma_f32_16x16x32_bf16 v[160:163], a[140:143], a[20:23], v[160:163]
buffer_load_dwordx4 a[12:15], v4, s[40:43], s35 offen offset:1024 sc1
v_mfma_f32_16x16x32_bf16 v[144:147], a[140:143], a[16:19], v[144:147]
s_waitcnt vmcnt(8) lgkmcnt(4)
v_mfma_f32_16x16x32_bf16 v[132:135], a[96:99], a[24:27], v[132:135]
ds_read_b128 a[128:131], v6 offset:53248
v_mfma_f32_16x16x32_bf16 v[148:151], a[96:99], a[28:31], v[148:151]
ds_read_b128 a[132:135], v6 offset:54272
v_mfma_f32_16x16x32_bf16 v[152:155], a[100:103], a[28:31], v[152:155]
ds_read_b128 a[136:139], v6 offset:55296
v_mfma_f32_16x16x32_bf16 v[136:139], a[100:103], a[24:27], v[136:139]
ds_read_b128 a[140:143], v6 offset:56320
v_mfma_f32_16x16x32_bf16 v[140:143], a[104:107], a[24:27], v[140:143]
v_mfma_f32_16x16x32_bf16 v[156:159], a[104:107], a[28:31], v[156:159]
v_mfma_f32_16x16x32_bf16 v[160:163], a[108:111], a[28:31], v[160:163]
v_mfma_f32_16x16x32_bf16 v[144:147], a[108:111], a[24:27], v[144:147]
s_waitcnt vmcnt(6) lgkmcnt(4)
v_mfma_f32_16x16x32_bf16 v[132:135], a[112:115], a[32:35], v[132:135]
ds_read_b128 a[96:99], v6 offset:57344
v_mfma_f32_16x16x32_bf16 v[148:151], a[112:115], a[36:39], v[148:151]
ds_read_b128 a[100:103], v6 offset:58368
v_mfma_f32_16x16x32_bf16 v[152:155], a[116:119], a[36:39], v[152:155]
ds_read_b128 a[104:107], v6 offset:59392
v_mfma_f32_16x16x32_bf16 v[136:139], a[116:119], a[32:35], v[136:139]
ds_read_b128 a[108:111], v6 offset:60416
v_mfma_f32_16x16x32_bf16 v[140:143], a[120:123], a[32:35], v[140:143]
v_mfma_f32_16x16x32_bf16 v[156:159], a[120:123], a[36:39], v[156:159]
v_mfma_f32_16x16x32_bf16 v[160:163], a[124:127], a[36:39], v[160:163]
v_mfma_f32_16x16x32_bf16 v[144:147], a[124:127], a[32:35], v[144:147]
s_waitcnt vmcnt(4) lgkmcnt(4)
v_mfma_f32_16x16x32_bf16 v[132:135], a[128:131], a[40:43], v[132:135]
ds_read_b128 a[112:115], v6 offset:61440
v_mfma_f32_16x16x32_bf16 v[148:151], a[128:131], a[44:47], v[148:151]
ds_read_b128 a[116:119], v6 offset:62464
v_mfma_f32_16x16x32_bf16 v[152:155], a[132:135], a[44:47], v[152:155]
ds_read_b128 a[120:123], v6 offset:63488
v_mfma_f32_16x16x32_bf16 v[136:139], a[132:135], a[40:43], v[136:139]
ds_read_b128 a[124:127], v6 offset:64512
v_mfma_f32_16x16x32_bf16 v[140:143], a[136:139], a[40:43], v[140:143]
v_mfma_f32_16x16x32_bf16 v[156:159], a[136:139], a[44:47], v[156:159]
v_mfma_f32_16x16x32_bf16 v[160:163], a[140:143], a[44:47], v[160:163]
v_mfma_f32_16x16x32_bf16 v[144:147], a[140:143], a[40:43], v[144:147]
s_waitcnt vmcnt(2) lgkmcnt(4)
v_mfma_f32_16x16x32_bf16 v[132:135], a[96:99], a[0:3], v[132:135]
v_mfma_f32_16x16x32_bf16 v[148:151], a[96:99], a[4:7], v[148:151]
v_mfma_f32_16x16x32_bf16 v[152:155], a[100:103], a[4:7], v[152:155]
v_mfma_f32_16x16x32_bf16 v[136:139], a[100:103], a[0:3], v[136:139]
v_mfma_f32_16x16x32_bf16 v[140:143], a[104:107], a[0:3], v[140:143]
v_mfma_f32_16x16x32_bf16 v[156:159], a[104:107], a[4:7], v[156:159]
v_mfma_f32_16x16x32_bf16 v[160:163], a[108:111], a[4:7], v[160:163]
v_mfma_f32_16x16x32_bf16 v[144:147], a[108:111], a[0:3], v[144:147]
s_waitcnt vmcnt(0) lgkmcnt(0)
v_mfma_f32_16x16x32_bf16 v[132:135], a[112:115], a[8:11], v[132:135]
v_mfma_f32_16x16x32_bf16 v[148:151], a[112:115], a[12:15], v[148:151]
v_mfma_f32_16x16x32_bf16 v[152:155], a[116:119], a[12:15], v[152:155]
v_mfma_f32_16x16x32_bf16 v[136:139], a[116:119], a[8:11], v[136:139]
v_mfma_f32_16x16x32_bf16 v[140:143], a[120:123], a[8:11], v[140:143]
v_mfma_f32_16x16x32_bf16 v[156:159], a[120:123], a[12:15], v[156:159]
v_mfma_f32_16x16x32_bf16 v[160:163], a[124:127], a[12:15], v[160:163]
v_mfma_f32_16x16x32_bf16 v[144:147], a[124:127], a[8:11], v[144:147]
s_nop 0
v_cvt_pk_bf16_f32 v32, v132, v133
v_cvt_pk_bf16_f32 v33, v134, v135
s_nop 0
v_cvt_pk_bf16_f32 v34, v136, v137
v_cvt_pk_bf16_f32 v35, v138, v139
v_cvt_pk_bf16_f32 v36, v140, v141
v_cvt_pk_bf16_f32 v37, v142, v143
v_cvt_pk_bf16_f32 v38, v144, v145
v_cvt_pk_bf16_f32 v39, v146, v147
v_cvt_pk_bf16_f32 v40, v148, v149
v_cvt_pk_bf16_f32 v41, v150, v151
v_cvt_pk_bf16_f32 v42, v152, v153
v_cvt_pk_bf16_f32 v43, v154, v155
v_cvt_pk_bf16_f32 v44, v156, v157
v_cvt_pk_bf16_f32 v45, v158, v159
v_cvt_pk_bf16_f32 v46, v160, v161
v_cvt_pk_bf16_f32 v47, v162, v163
v_lshrrev_b32 v233, 4, v0
v_and_b32 v234, 15, v0
s_and_b32 s36, s31, 7
s_lshl_b32 s36, s36, 7
s_lshl_b32 s37, s28, 5
s_add_u32 s36, s36, s37
s_lshl_b32 s36, s36, 1
s_lshr_b32 s37, s31, 3
s_add_u32 s36, s36, s37
s_lshl_b32 s36, s36, 11
s_lshl_b32 s37, s32, 7
s_add_u32 s36, s36, s37
v_lshl_add_u32 v232, v234, 12, s36
v_lshl_add_u32 v232, v233, 4, v232
s_mov_b32 s36, 0x10000
buffer_store_dwordx4 v[32:35], v232, s[12:15], 0 offen offset:0
buffer_store_dwordx4 v[36:39], v232, s[12:15], 0 offen offset:64
buffer_store_dwordx4 v[40:43], v232, s[12:15], s36 offen offset:0
buffer_store_dwordx4 v[44:47], v232, s[12:15], s36 offen offset:64
s_or_b32 s36, s2, s28
s_cbranch_scc1 Lep_45
s_mov_b32 s36, 0xf0000
buffer_store_dword v15, off, s[4:7], s36 sc1
Lep_45:
L_end:
s_endpgm
Ltr_7:
s_add_u32 s52, s67, 0xe0000
s_mov_b32 s53, 0
Ltp_8:
s_sleep 4
buffer_load_dword v11, v255, s[4:7], s52 offen sc1
s_add_u32 s53, s53, 1
s_waitcnt vmcnt(0)
v_cmp_ne_u32 vcc, v11, v15
s_cbranch_vccz Lte_9
s_cmp_lt_u32 s53, 0x100000
s_cbranch_scc1 Ltp_8
s_branch Lte_9
Ltr_10:
s_add_u32 s52, s66, 0xd0040
s_mov_b32 s53, 0
Ltp_11:
s_sleep 4
buffer_load_dword v232, v255, s[4:7], s52 offen sc1
s_add_u32 s53, s53, 1
s_waitcnt vmcnt(0)
v_cmp_ne_u32 vcc, v232, v15
s_cbranch_vccz Lte_12
s_cmp_lt_u32 s53, 0x100000
s_cbranch_scc1 Ltp_11
s_branch Lte_12
L_code_end:
.section .rodata,"a"
.p2align 6
.amdhsa_kernel interleave_layers__sliding_local_dilated__linear_kernel_hedgehog__prompt_kernel
  .amdhsa_next_free_vgpr 512
  .amdhsa_next_free_sgpr 102
  .amdhsa_accum_offset 256
  .amdhsa_group_segment_fixed_size 0
  .amdhsa_kernarg_size 80
  .amdhsa_user_sgpr_count 2
  .amdhsa_user_sgpr_kernarg_segment_ptr 1
  .amdhsa_system_sgpr_workgroup_id_x 1
.end_amdhsa_kernel
```

```asm
; @launch grid=(256,1,1) block=(256,1,1) lds=163840
.amdgcn_target "amdgcn-amd-amdhsa--gfx950"
.text
.globl interleave_layers__sliding_local_dilated__linear_kernel_hedgehog__prompt_kernel
.p2align 8
.type interleave_layers__sliding_local_dilated__linear_kernel_hedgehog__prompt_kernel,@function
interleave_layers__sliding_local_dilated__linear_kernel_hedgehog__prompt_kernel:
s_cmp_ge_u32 s2, 256
s_cbranch_scc1 L_end
s_load_dwordx16 s[64:79], s[0:1], 0
s_load_dwordx4 s[80:83], s[0:1], 64
s_getpc_b64 s[24:25]
s_mov_b32 s26, (L_end - interleave_layers__sliding_local_dilated__linear_kernel_hedgehog__prompt_kernel - 64)
s_mov_b32 s27, 0x20000
v_lshlrev_b32 v1, 5, v0
buffer_load_dword v238, v1, s[24:27], 0 offen
v_lshrrev_b32 v1, 6, v0
v_and_b32 v0, 63, v0
v_readfirstlane_b32 s28, v1
s_and_b32 s36, s2, 7
s_lshr_b32 s37, s2, 3
s_and_b32 s38, s37, 3
s_lshr_b32 s39, s37, 2
s_and_b32 s29, s36, 1
s_lshl_b32 s32, s29, 3
s_lshl_b32 s29, s29, 2
s_add_u32 s29, s29, s38
s_add_u32 s32, s32, s39
s_lshr_b32 s36, s36, 1
s_lshl_b32 s30, s36, 3
s_add_u32 s30, s30, s39
s_lshl_b32 s31, s36, 2
s_add_u32 s31, s31, s38
s_and_b32 s32, s36, 1
s_lshl_b32 s32, s32, 3
s_add_u32 s32, s32, s39
s_and_b32 s31, s2, 1
s_lshl_b32 s31, s31, 3
s_add_u32 s31, s31, s38
s_and_b32 s3, s2, 4
s_add_u32 s31, s31, s3
s_mov_b32 s3, s39
s_and_b32 s35, s2, 7
s_lshl_b32 s35, s35, 5
s_add_u32 s35, s35, s37
s_mul_i32 s33, s39, 0
s_and_b32 s33, s33, 31
s_mul_i32 s34, s39, 0
s_and_b32 s34, s34, 31
v_lshlrev_b32 v1, 4, v0
v_lshrrev_b32 v233, 4, v0
v_and_b32 v234, 15, v0
s_and_b32 s88, s31, 7
s_lshl_b32 s88, s88, 7
s_lshl_b32 s37, s28, 5
s_add_u32 s88, s88, s37
s_lshl_b32 s88, s88, 1
s_lshr_b32 s37, s31, 3
s_add_u32 s88, s88, s37
s_lshl_b32 s88, s88, 11
s_lshl_b32 s37, s32, 7
s_add_u32 s88, s88, s37
v_lshrrev_b32 v235, 3, v0
v_and_b32 v236, 7, v0
v_xor_b32 v232, v236, v233
v_lshlrev_b32 v232, 4, v232
v_lshl_add_u32 v232, v235, 12, v232
v_xor_b32 v246, 64, v232
v_lshlrev_b32 v236, 4, v236
v_lshl_add_u32 v237, v235, 11, v236
v_mul_u32_u24 v235, 6144, v235
v_add_u32 v235, v235, v236
s_lshr_b32 s36, s35, 4
s_lshl_b32 s36, s36, 2
s_add_u32 s36, s36, s28
s_mul_i32 s36, s36, 98304
s_and_b32 s37, s35, 15
s_lshl_b32 s37, s37, 7
s_add_u32 s36, s36, s37
s_lshl_b32 s37, s28, 11
s_mov_b32 s39, 0x10000
s_mov_b32 s10, 0x400000
s_mov_b32 s11, 0x20000
s_mov_b32 s22, 0x600000
s_mov_b32 s23, 0x20000
s_mov_b32 s6, 0x10000000
s_mov_b32 s7, 0x20000
s_mov_b32 s44, 0xf0000
s_waitcnt lgkmcnt(0)
s_mov_b64 s[8:9], s[64:65]
s_mov_b64 s[20:21], s[66:67]
s_add_u32 m0, s37, 0
s_add_u32 s38, s36, 0
buffer_load_dwordx4 v235, s[20:23], s38 offen nt lds
s_add_u32 m0, s37, 1024
s_add_u32 s38, s36, 49152
buffer_load_dwordx4 v235, s[20:23], s38 offen nt lds
s_add_u32 m0, s37, 8192
s_add_u32 s38, s36, 2048
buffer_load_dwordx4 v235, s[20:23], s38 offen nt lds
s_add_u32 m0, s37, 9216
s_add_u32 s38, s36, 51200
buffer_load_dwordx4 v235, s[20:23], s38 offen nt lds
s_add_u32 m0, s37, 16384
s_add_u32 s38, s36, 4096
buffer_load_dwordx4 v235, s[20:23], s38 offen nt lds
s_add_u32 m0, s37, 17408
s_add_u32 s38, s36, 53248
buffer_load_dwordx4 v235, s[20:23], s38 offen nt lds
s_lshl_b32 s37, s37, 1
s_add_u32 m0, s37, 24576
s_add_u32 s38, s88, 0
buffer_load_dwordx4 v232, s[8:11], s38 offen nt lds
s_add_u32 m0, s37, 25600
s_add_u32 s38, s88, 32768
buffer_load_dwordx4 v246, s[8:11], s38 offen nt lds
s_add_u32 m0, s37, 26624
s_add_u32 s38, s88, 65536
buffer_load_dwordx4 v232, s[8:11], s38 offen nt lds
s_add_u32 m0, s37, 27648
s_add_u32 s38, s88, 98304
buffer_load_dwordx4 v246, s[8:11], s38 offen nt lds
v_lshrrev_b32 v232, 1, v234
v_xor_b32 v232, v232, v233
v_lshlrev_b32 v232, 4, v232
v_lshl_add_u32 v232, v234, 7, v232
v_add_u32 v232, s37, v232
s_add_u32 s4, s82, 0x0
s_addc_u32 s5, s83, 0
buffer_load_dword v11, off, s[4:7], s44 sc1
s_lshr_b32 s36, s2, 3
s_lshl_b32 s36, s36, 2
s_add_u32 s36, s36, s28
s_lshl_b32 s36, s36, 10
buffer_load_dwordx4 a[0:3], v1, s[24:27], s36 offen
s_mov_b32 s12, s78
s_mov_b32 s13, s79
s_mov_b32 s14, 0x400000
s_mov_b32 s15, 0x20000
s_mov_b32 s42, 0x400000
s_mov_b32 s43, 0x20000
v_mov_b32 v12, 1
s_mov_b64 s[40:41], s[12:13]
s_mov_b32 s64, 0xff
s_mov_b32 s65, 0
s_and_b32 s81, s29, 3
s_lshl_b32 s66, s31, 4
s_add_u32 s66, s66, s32
s_lshl_b32 s66, s66, 8
s_lshl_b32 s67, s29, 5
s_add_u32 s67, s67, s30
s_lshl_b32 s67, s67, 8
s_lshl_b32 s80, s30, 11
s_lshl_b32 s70, s29, 8
s_add_u32 s70, s70, s80
s_lshl_b32 s71, s29, 13
s_lshr_b32 s78, s31, 1
s_lshl_b32 s78, s78, 13
s_add_u32 s79, s78, 8192
s_bitcmp1_b32 s31, 0
s_cselect_b32 s79, s79, 0x40000000
s_and_b32 s36, s31, 7
s_cmp_eq_u32 s36, 7
s_cselect_b32 s79, 0x40000000, s79
v_mov_b32 v240, 0
v_mov_b32 v241, 0
v_mov_b32 v242, 0
v_mov_b32 v243, 0
v_lshlrev_b32 v239, 16, v233
v_lshl_add_u32 v239, v234, 4, v239
s_cmp_eq_u32 s28, 0
s_cselect_b32 s36, s66, s67
s_cmp_eq_u32 s28, 2
s_cselect_b32 s36, s70, s36
s_lshl_b32 s37, s28, 18
s_add_u32 s36, s36, s37
s_cmp_eq_u32 s28, 3
s_cselect_b32 s36, 0x40000000, s36
buffer_store_dwordx4 v[240:243], v239, s[4:7], s36 offen sc1
s_add_u32 s36, s67, 0xc0000
s_add_u32 s37, s66, 0xd0000
s_cmp_eq_u32 s28, 2
s_cselect_b32 s36, s37, s36
s_cmp_eq_u32 s28, 1
s_cselect_b32 s37, 128, 0
s_add_u32 s36, s36, s37
s_cmp_eq_u32 s28, 3
s_cselect_b32 s37, 0x20000, 0
s_add_u32 s36, s36, s37
s_mov_b64 exec, 1
buffer_atomic_add v240, off, s[4:7], s36 sc1
s_mov_b64 exec, -1
v_mov_b32 v228, v235
v_mov_b32 v229, v237
s_lshr_b32 s36, s35, 4
s_lshl_b32 s36, s36, 2
s_add_u32 s36, s36, s28
s_and_b32 s37, s35, 15
s_lshl_b32 s37, s37, 7
s_lshl_b32 s16, s36, 15
s_add_u32 s16, s16, s37
s_mul_i32 s17, s36, 98304
s_add_u32 s17, s17, s37
s_mov_b64 s[20:21], s[68:69]
s_mov_b32 s22, 0x200000
s_lshl_b32 s37, s28, 11
s_add_u32 m0, s37, 147456
s_add_u32 s36, s16, 0
buffer_load_dwordx4 v229, s[20:23], s36 offen nt lds
s_add_u32 m0, s37, 148480
s_add_u32 s36, s16, 16384
buffer_load_dwordx4 v229, s[20:23], s36 offen nt lds
s_mov_b64 s[20:21], s[74:75]
s_mov_b32 s22, 0x10000
s_and_b32 s36, s28, 1
s_lshl_b32 s36, s36, 10
s_add_u32 m0, s36, 155648
s_lshl_b32 s37, s30, 11
s_add_u32 s36, s36, s37
buffer_load_dwordx4 v1, s[20:23], s36 offen lds
v_mov_b32 v16, 0x3f803f80
v_mov_b32 v17, 0x3f803f80
v_mov_b32 v18, 0x3f803f80
v_mov_b32 v19, 0x3f803f80
s_mov_b32 s46, 0xaaaaaaaa
s_mov_b32 s47, 0xaaaaaaaa
s_mov_b32 s48, 0xcccccccc
s_mov_b32 s49, 0xcccccccc
s_lshl_b32 s36, s31, 1
s_lshr_b32 s37, s28, 1
s_add_u32 s36, s36, s37
s_lshl_b32 s36, s36, 17
s_and_b32 s37, s28, 1
s_lshl_b32 s37, s37, 11
s_add_u32 s36, s36, s37
v_add_u32 v4, s36, v1
s_lshl_b32 s38, s31, 2
s_add_u32 s38, s38, s28
s_lshl_b32 s38, s38, 12
s_lshl_b32 s39, s32, 7
s_add_u32 s38, s38, s39
v_lshrrev_b32 v244, 2, v234
v_cmp_eq_u32 vcc, v244, v233
v_and_b32 v244, 7, v234
v_lshl_add_u32 v244, v244, 4, s38
v_and_b32 v245, 8, v234
v_add_u32 v244, v244, v245
v_cndmask_b32 v253, 2.0, v244, vcc
v_lshlrev_b32 v244, 4, v233
v_lshl_add_u32 v244, v234, 6, v244
v_cmp_gt_u32 vcc, 2, v234
s_nop 1
v_cndmask_b32 v254, 2.0, v244, vcc
v_lshrrev_b32 v248, 4, v0
v_lshlrev_b32 v248, 10, v248
v_bfe_u32 v249, v0, 2, 2
v_lshl_add_u32 v248, v249, 7, v248
v_and_b32 v251, 3, v0
v_lshl_add_u32 v248, v251, 3, v248
s_lshr_b32 s36, s28, 1
s_lshl_b32 s36, s36, 6
s_and_b32 s37, s28, 1
s_mul_i32 s38, s37, 8224
s_add_u32 s38, s38, s36
s_mul_i32 s39, s37, 16352
s_add_u32 s39, s39, s36
v_add_u32 v249, s39, v248
v_add_u32 v248, s38, v248
s_and_b32 s38, s35, 15
s_lshl_b32 s38, s38, 1
s_lshr_b32 s36, s28, 1
s_add_u32 s38, s38, s36
s_lshr_b32 s36, s35, 4
s_mul_i32 s96, s38, 196608
s_mul_i32 s44, s36, 12288
s_add_u32 s96, s96, s44
s_mul_i32 s44, s37, 3072
s_add_u32 s96, s96, s44
s_add_u32 s96, s96, 0xe00000
s_add_u32 s97, s96, 6144
s_mul_i32 s38, s38, 6
s_mul_i32 s37, s37, 3
s_add_u32 s38, s38, s37
s_lshl_b32 s38, s38, 11
s_lshl_b32 s36, s36, 7
s_add_u32 s38, s38, s36
s_add_u32 s98, s38, 0x300000
s_add_u32 s99, s98, 4096
v_lshrrev_b32 v247, 2, v0
v_lshlrev_b32 v250, 7, v247
v_lshl_add_u32 v250, v251, 4, v250
s_lshr_b32 s36, s28, 1
s_lshl_b32 s36, s36, 12
s_and_b32 s37, s28, 1
s_lshl_b32 s37, s37, 6
s_add_u32 s36, s36, s37
s_add_u32 s36, s36, 147456
v_add_u32 v250, s36, v250
v_subrev_u32 v230, 122880, v250
s_and_b32 s36, s35, 15
s_lshl_b32 s36, s36, 17
s_lshr_b32 s37, s35, 4
s_lshl_b32 s37, s37, 13
s_add_u32 s36, s36, s37
s_lshl_b32 s37, s28, 11
s_add_u32 s36, s36, s37
s_add_u32 s100, s36, 0xa00000
s_add_u32 s101, s36, 0xc00000
v_lshlrev_b32 v247, 6, v247
v_lshl_add_u32 v251, v251, 3, v247
v_add_u32 v251, 155648, v251
s_mov_b32 s56, 0x11111111
s_mov_b32 s57, 0x11111111
s_mov_b32 s58, 0x22222222
s_mov_b32 s59, 0x22222222
s_mul_i32 s18, s28, 3072
s_lshl_b32 s19, s28, 12
s_mul_i32 s50, s30, 196608
s_add_u32 s50, s50, s18
s_lshl_b32 s36, s32, 17
s_add_u32 s36, s36, s19
s_add_u32 s37, s28, 0
s_cmp_eq_u32 s37, s3
s_cselect_b32 s37, 32768, 0
s_add_u32 s84, s36, s37
s_mul_i32 s37, s37, 3
s_sub_u32 s86, s36, s37
s_add_u32 s37, s28, 4
s_cmp_eq_u32 s37, s3
s_cselect_b32 s37, 32768, 0
s_add_u32 s85, s36, s37
s_mul_i32 s37, s37, 3
s_sub_u32 s87, s36, s37
s_mul_i32 s55, s28, 6144
v_accvgpr_write_b32 a228, -1
v_accvgpr_write_b32 a229, -1
v_accvgpr_write_b32 a230, -1
v_accvgpr_write_b32 a231, -1
s_lshl_b32 s36, s29, 2
s_add_u32 s36, s36, s28
s_lshl_b32 s37, s36, 17
v_add_u32 v2, s37, v1
s_lshl_b32 s82, s36, 13
s_and_b32 s38, s29, 3
s_cmp_eq_u32 s38, 0
s_cselect_b32 s38, 0, 0x1f400
s_cselect_b32 s39, 0, 2048
s_cselect_b32 s54, 32, 48
s_lshl_b32 s37, s29, 19
s_sub_u32 s37, s37, s38
v_add_u32 v3, s37, v1
v_cmp_le_u32 vcc, 8, v234
s_nop 1
v_cndmask_b32 v3, 2.0, v3, vcc
s_lshl_b32 s37, s29, 15
s_sub_u32 s83, s37, s39
s_cmp_eq_u32 s28, 1
s_cselect_b32 vcc_lo, -1, 0
s_mov_b32 vcc_hi, 0
v_lshlrev_b32 v244, 8, v0
v_cndmask_b32 v10, 2.0, v244, vcc
v_and_b32 v244, 1, v233
v_lshl_add_u32 v244, v244, 3, v234
v_and_b32 v244, 15, v244
v_lshrrev_b32 v245, 1, v233
v_lshl_add_u32 v244, v245, 4, v244
v_lshrrev_b32 v245, 3, v234
v_lshl_add_u32 v244, v245, 5, v244
v_lshlrev_b32 v7, 3, v244
v_lshrrev_b32 v246, 2, v0
v_and_b32 v247, 3, v0
v_and_b32 v244, 1, v247
v_lshl_add_u32 v244, v244, 3, v246
v_and_b32 v244, 15, v244
v_lshrrev_b32 v245, 1, v247
v_lshl_add_u32 v244, v245, 4, v244
v_lshrrev_b32 v245, 3, v246
v_lshl_add_u32 v244, v245, 5, v244
v_lshlrev_b32 v8, 3, v244
s_and_b32 s36, s28, 1
s_lshl_b32 s37, s36, 3
s_add_u32 s37, s37, 20480
s_lshl_b32 s36, s36, 9
v_add_u32 v244, s37, v1
v_add_u32 v245, s36, v7
s_cmp_lt_u32 s28, 2
s_cselect_b64 vcc, -1, 0
v_cndmask_b32 v9, v245, v244, vcc
v_lshlrev_b32 v239, 2, v233
v_sub_u32 v239, v239, v234
v_mov_b32 v247, 0xf149f2ca
v_add_u32 v246, 7, v239
v_cmp_gt_u32 vcc, 8, v246
v_mov_b32 v244, 0xffff
s_nop 0
v_cndmask_b32 v24, v247, 0, vcc
v_cndmask_b32 v244, 0, v244, vcc
v_mov_b32 v30, v244
v_add_u32 v246, 0, v239
v_cmp_le_i32 vcc, 9, v246
v_mov_b32 v244, 0xffff
s_nop 0
v_cndmask_b32 v20, v247, 0, vcc
v_cndmask_b32 v244, 0, v244, vcc
v_mov_b32 v28, v244
v_add_u32 v246, 8, v239
v_cmp_gt_u32 vcc, 8, v246
v_mov_b32 v244, 0xffff0000
s_nop 0
v_cndmask_b32 v25, v247, 0, vcc
v_cndmask_b32 v244, 0, v244, vcc
v_or_b32 v30, v30, v244
v_add_u32 v246, 1, v239
v_cmp_le_i32 vcc, 9, v246
v_mov_b32 v244, 0xffff0000
s_nop 0
v_cndmask_b32 v21, v247, 0, vcc
v_cndmask_b32 v244, 0, v244, vcc
v_or_b32 v28, v28, v244
v_add_u32 v246, 9, v239
v_cmp_gt_u32 vcc, 8, v246
v_mov_b32 v244, 0xffff
s_nop 0
v_cndmask_b32 v26, v247, 0, vcc
v_cndmask_b32 v244, 0, v244, vcc
v_mov_b32 v31, v244
v_add_u32 v246, 2, v239
v_cmp_le_i32 vcc, 9, v246
v_mov_b32 v244, 0xffff
s_nop 0
v_cndmask_b32 v22, v247, 0, vcc
v_cndmask_b32 v244, 0, v244, vcc
v_mov_b32 v29, v244
v_add_u32 v246, 10, v239
v_cmp_gt_u32 vcc, 8, v246
v_mov_b32 v244, 0xffff0000
s_nop 0
v_cndmask_b32 v27, v247, 0, vcc
v_cndmask_b32 v244, 0, v244, vcc
v_or_b32 v31, v31, v244
v_add_u32 v246, 3, v239
v_cmp_le_i32 vcc, 9, v246
v_mov_b32 v244, 0xffff0000
s_nop 0
v_cndmask_b32 v23, v247, 0, vcc
v_cndmask_b32 v244, 0, v244, vcc
v_or_b32 v29, v29, v244
s_and_b32 s36, s29, 3
s_or_b32 s36, s36, s28
s_cmp_eq_u32 s36, 0
s_cselect_b64 vcc, -1, 0
v_cndmask_b32 v76, v20, v247, vcc
v_cndmask_b32 v77, v21, v247, vcc
v_cndmask_b32 v78, v22, v247, vcc
v_cndmask_b32 v79, v23, v247, vcc
v_cndmask_b32 v80, v28, 0, vcc
v_cndmask_b32 v81, v29, 0, vcc
v_xor_b32 v236, 64, v232
s_waitcnt vmcnt(1)
ds_read_b128 v[32:35], v232 offset:24576
ds_read_b128 v[36:39], v236 offset:24576
ds_read_b128 v[40:43], v232 offset:26624
ds_read_b128 v[44:47], v236 offset:26624
s_barrier
ds_read_b64_tr_b16 a[188:189], v248 offset:0
ds_read_b64_tr_b16 a[190:191], v248 offset:512
ds_read_b64_tr_b16 a[192:193], v248 offset:4096
ds_read_b64_tr_b16 a[194:195], v248 offset:4608
ds_read_b64_tr_b16 a[196:197], v249 offset:32
ds_read_b64_tr_b16 a[198:199], v249 offset:544
ds_read_b64_tr_b16 a[200:201], v249 offset:4128
ds_read_b64_tr_b16 a[202:203], v249 offset:4640
ds_read_b64_tr_b16 a[204:205], v248 offset:8192
ds_read_b64_tr_b16 a[206:207], v248 offset:8704
ds_read_b64_tr_b16 a[208:209], v248 offset:12288
ds_read_b64_tr_b16 a[210:211], v248 offset:12800
ds_read_b64_tr_b16 a[212:213], v250 offset:0
ds_read_b64_tr_b16 a[214:215], v250 offset:2048
ds_read_b64_tr_b16 a[216:217], v250 offset:8
ds_read_b64_tr_b16 a[218:219], v250 offset:2056
s_lshl_b32 s36, s32, 13
s_add_u32 s36, s36, 0x0
s_add_u32 s37, s36, 4096
s_mov_b32 s38, 0x200000
s_waitcnt lgkmcnt(14)
v_mfma_f32_16x16x32_bf16 v[96:99], v[32:35], v[32:35], 0
v_mfma_f32_16x16x32_bf16 v[92:95], v[16:19], v[32:35], 0
buffer_store_dwordx4 v[32:35], v4, s[12:15], s36 offen offset:0 sc1
v_mfma_f32_16x16x32_bf16 v[104:107], v[40:43], v[40:43], 0
v_mfma_f32_16x16x32_bf16 v[100:103], v[16:19], v[40:43], 0
buffer_store_dwordx4 v[40:43], v4, s[12:15], s36 offen offset:1024 sc1
v_mfma_f32_16x16x32_bf16 v[96:99], v[36:39], v[36:39], v[96:99]
v_mfma_f32_16x16x32_bf16 v[92:95], v[16:19], v[36:39], v[92:95]
buffer_store_dwordx4 v[36:39], v4, s[12:15], s37 offen offset:0 sc1
v_mfma_f32_16x16x32_bf16 v[104:107], v[44:47], v[44:47], v[104:107]
v_mfma_f32_16x16x32_bf16 v[100:103], v[16:19], v[44:47], v[100:103]
buffer_store_dwordx4 v[44:47], v4, s[12:15], s37 offen offset:1024 sc1
s_nop 2
v_cndmask_b32 v96, v96, v97, s[46:47]
v_cndmask_b32 v98, v98, v99, s[46:47]
v_cndmask_b32 v93, v96, v98, s[48:49]
buffer_store_dwordx2 v[92:93], v253, s[4:7], s38 offen offset:0 sc1
v_cndmask_b32 v104, v104, v105, s[46:47]
v_cndmask_b32 v106, v106, v107, s[46:47]
v_cndmask_b32 v101, v104, v106, s[48:49]
buffer_store_dwordx2 v[100:101], v253, s[4:7], s38 offen offset:2048 sc1
v_mfma_f32_16x16x32_bf16 v[108:111], a[188:191], v[16:19], 0
s_waitcnt lgkmcnt(10)
v_mfma_f32_16x16x32_bf16 v[112:115], a[196:199], v[16:19], 0
s_waitcnt lgkmcnt(6)
v_mfma_f32_16x16x32_bf16 v[116:119], a[204:207], v[16:19], 0
v_mfma_f32_16x16x32_bf16 v[108:111], a[192:195], v[16:19], v[108:111]
v_mfma_f32_16x16x32_bf16 v[112:115], a[200:203], v[16:19], v[112:115]
s_waitcnt lgkmcnt(4)
v_mfma_f32_16x16x32_bf16 v[116:119], a[208:211], v[16:19], v[116:119]
buffer_store_dwordx4 a[188:191], v1, s[4:7], s96 offen offset:0 sc1
buffer_store_dwordx4 a[192:195], v1, s[4:7], s97 offen offset:0 sc1
buffer_store_dwordx4 a[196:199], v1, s[4:7], s96 offen offset:1024 sc1
buffer_store_dwordx4 a[200:203], v1, s[4:7], s97 offen offset:1024 sc1
buffer_store_dwordx4 a[204:207], v1, s[4:7], s96 offen offset:2048 sc1
buffer_store_dwordx4 a[208:211], v1, s[4:7], s97 offen offset:2048 sc1
buffer_store_dwordx4 v[108:111], v254, s[4:7], s98 offen offset:0 sc1
buffer_store_dwordx4 v[112:115], v254, s[4:7], s98 offen offset:2048 sc1
buffer_store_dwordx4 v[116:119], v254, s[4:7], s99 offen offset:0 sc1
s_waitcnt lgkmcnt(2)
buffer_store_dwordx4 a[212:215], v1, s[4:7], s100 offen offset:0 sc1
s_waitcnt lgkmcnt(0)
buffer_store_dwordx4 a[216:219], v1, s[4:7], s100 offen offset:1024 sc1
s_mov_b32 s36, 0x9e3779b1
v_mul_lo_u32 v15, v11, s36
v_add_u32 v15, 0x7f4a7c15, v15
s_and_b32 s36, s31, 1
s_lshl_b32 s36, s36, 4
s_add_u32 s36, s36, s32
s_lshl_b32 s36, s36, 2
s_add_u32 s92, s78, s36
s_add_u32 s92, s92, 0xc0000
s_lshl_b32 s36, s32, 2
s_add_u32 s93, s79, s36
s_add_u32 s93, s93, 0xc0080
s_and_b32 s94, s35, 15
s_lshl_b32 s94, s94, 9
s_lshr_b32 s36, s35, 4
s_lshl_b32 s36, s36, 2
s_add_u32 s94, s94, s36
s_add_u32 s94, s94, 0xc00c0
v_lshrrev_b32 v240, 1, v0
v_lshlrev_b32 v240, 13, v240
v_and_b32 v241, 1, v0
v_lshl_add_u32 v240, v241, 8, v240
s_mov_b32 vcc_lo, 0xffff
s_mov_b32 vcc_hi, 0
v_cndmask_b32 v240, 2.0, v240, vcc
v_lshlrev_b32 v241, 2, v0
v_add_u32 v248, 0, v248
v_add_u32 v249, 0, v249
s_add_u32 s96, s96, 0x600000
s_add_u32 s98, s98, 0x80000
s_add_u32 s97, s97, 0x600000
s_add_u32 s99, s99, 0x80000
s_cmp_eq_u32 s28, 1
s_cselect_b32 vcc_lo, 0xffff, 0
v_lshlrev_b32 v252, 12, v0
v_cndmask_b32 v252, 2.0, v252, vcc
v_cndmask_b32 v14, 2.0, v240, vcc
s_and_b32 s62, s35, 15
s_lshl_b32 s62, s62, 8
s_lshr_b32 s36, s35, 4
s_lshl_b32 s36, s36, 2
s_add_u32 s62, s62, s36
s_add_u32 s62, s62, 0xd0000
s_add_u32 s8, s94, 0x1ff40
v_and_b32 v255, 15, v0
v_lshlrev_b32 v255, 2, v255
s_waitcnt vmcnt(0)
s_barrier
s_cmp_lg_u32 s28, 1
s_cbranch_scc1 Lg1s_1
buffer_atomic_swap v15, v10, s[4:7], s92 offen sc1
buffer_atomic_swap v15, v10, s[4:7], s93 offen sc1
buffer_atomic_swap v15, v240, s[4:7], s94 offen sc1
buffer_atomic_swap v15, v252, s[4:7], s62 offen sc1
Lg1s_1:
s_branch L_aligned
.p2align 12
L_aligned:
s_add_u32 s89, s66, 0xd0000
ds_read_b64_tr_b16 a[232:233], v251 offset:0
ds_read_b64_tr_b16 a[234:235], v251 offset:1024
ds_read_b64_tr_b16 a[236:237], v251 offset:32
ds_read_b64_tr_b16 a[238:239], v251 offset:1056
s_lshl_b32 s36, s28, 11
v_add_u32 v231, s36, v1
s_waitcnt lgkmcnt(0)
v_add_u32 v231, 0, v231
v_cmp_eq_u32 vcc, 0, v0
s_nop 1
v_cndmask_b32 v251, 2.0, v0, vcc
s_cmp_lg_u32 s28, 3
s_cbranch_scc1 L_wskip0
s_mov_b64 exec, 0
s_branch L_stub0
L_wret0:
s_mov_b64 exec, -1
L_wskip0:
s_cmp_lg_u32 s28, 0
s_cbranch_scc1 Lg1e_3
s_cmp_eq_u32 s54, 32
s_cselect_b32 s39, 0xffff0000, -1
s_mov_b32 s38, -1
s_add_u32 s36, s67, 0xc0000
s_mov_b32 s37, 0
Lg1p_2:
v_mov_b32 v11, 0
buffer_atomic_add v11, v241, s[4:7], s36 offen sc0 sc1
s_add_u32 s37, s37, 1
v_mov_b32 v242, v15
s_mov_b64 exec, 0xffff
v_mov_b32 v242, 0
buffer_atomic_add v242, v241, s[4:7], s89 offen sc0 sc1
s_mov_b64 exec, -1
s_waitcnt vmcnt(0)
v_cmp_ne_u32 vcc, v11, v15
v_cmp_ne_u32 s[52:53], v242, v15
s_and_b64 vcc, vcc, s[38:39]
s_or_b64 vcc, vcc, s[52:53]
s_cbranch_scc0 Lg1e_3
s_cmp_lt_u32 s37, 0x100000
s_cbranch_scc1 Lg1p_2
Lg1e_3:
s_barrier
s_add_u32 s94, s71, 0x80
s_add_u32 m0, s18, 0x0
s_add_u32 s44, s50, 0xe00000
buffer_load_dwordx4 v1, s[4:7], s44 offen offset:0 sc1 lds
buffer_load_dwordx4 v1, s[4:7], s44 offen offset:1024 sc1 lds
buffer_load_dwordx4 v1, s[4:7], s44 offen offset:2048 sc1 lds
s_add_u32 m0, s18, 0x3000
s_add_u32 s44, s50, 0xe03000
buffer_load_dwordx4 v1, s[4:7], s44 offen offset:0 sc1 lds
buffer_load_dwordx4 v1, s[4:7], s44 offen offset:1024 sc1 lds
buffer_load_dwordx4 v1, s[4:7], s44 offen offset:2048 sc1 lds
s_add_u32 m0, s18, 0x6000
s_add_u32 s44, s50, 0xe06000
buffer_load_dwordx4 v1, s[4:7], s44 offen offset:0 sc1 lds
buffer_load_dwordx4 v1, s[4:7], s44 offen offset:1024 sc1 lds
buffer_load_dwordx4 v1, s[4:7], s44 offen offset:2048 sc1 lds
s_add_u32 m0, s18, 0x9000
s_add_u32 s44, s50, 0xe09000
buffer_load_dwordx4 v1, s[4:7], s44 offen offset:0 sc1 lds
buffer_load_dwordx4 v1, s[4:7], s44 offen offset:1024 sc1 lds
buffer_load_dwordx4 v1, s[4:7], s44 offen offset:2048 sc1 lds
s_lshl_b32 s35, s33, 12
buffer_load_dwordx4 a[0:3], v2, s[40:43], s35 offen offset:0 sc1
buffer_load_dwordx4 a[4:7], v2, s[40:43], s35 offen offset:1024 sc1
buffer_load_dwordx4 a[8:11], v2, s[40:43], s35 offen offset:2048 sc1
buffer_load_dwordx4 a[12:15], v2, s[40:43], s35 offen offset:3072 sc1
s_add_u32 s35, s35, 4096
s_add_u32 s63, s28, 0
s_lshl_b32 s63, s63, 12
buffer_load_dwordx4 a[64:67], v3, s[40:43], s63 offen sc1
buffer_load_dwordx4 a[16:19], v2, s[40:43], s35 offen offset:0 sc1
buffer_load_dwordx4 a[20:23], v2, s[40:43], s35 offen offset:1024 sc1
buffer_load_dwordx4 a[24:27], v2, s[40:43], s35 offen offset:2048 sc1
buffer_load_dwordx4 a[28:31], v2, s[40:43], s35 offen offset:3072 sc1
s_add_u32 s35, s35, 4096
buffer_load_dwordx4 a[32:35], v2, s[40:43], s35 offen offset:0 sc1
buffer_load_dwordx4 a[36:39], v2, s[40:43], s35 offen offset:1024 sc1
buffer_load_dwordx4 a[40:43], v2, s[40:43], s35 offen offset:2048 sc1
buffer_load_dwordx4 a[44:47], v2, s[40:43], s35 offen offset:3072 sc1
s_add_u32 s35, s35, 4096
s_mov_b64 s[20:21], s[76:77]
s_mov_b32 s22, 0x200000
s_add_u32 s89, s16, 0
buffer_load_dwordx4 a[220:223], v229, s[20:23], s89 offen nt
s_mov_b64 s[20:21], s[76:77]
s_mov_b32 s22, 0x200000
s_add_u32 s89, s16, 16384
buffer_load_dwordx4 a[224:227], v229, s[20:23], s89 offen nt
s_mov_b64 s[20:21], s[72:73]
s_mov_b32 s22, 0x600000
s_add_u32 s89, s17, 0
buffer_load_dwordx4 a[188:191], v228, s[20:23], s89 offen nt
s_mov_b64 s[20:21], s[72:73]
s_mov_b32 s22, 0x600000
s_add_u32 s89, s17, 49152
buffer_load_dwordx4 a[192:195], v228, s[20:23], s89 offen nt
s_mov_b64 s[20:21], s[72:73]
s_mov_b32 s22, 0x600000
s_add_u32 s89, s17, 2048
buffer_load_dwordx4 a[196:199], v228, s[20:23], s89 offen nt
s_mov_b64 s[20:21], s[72:73]
s_mov_b32 s22, 0x600000
s_add_u32 s89, s17, 51200
buffer_load_dwordx4 a[200:203], v228, s[20:23], s89 offen nt
s_mov_b64 s[20:21], s[72:73]
s_mov_b32 s22, 0x600000
s_add_u32 s89, s17, 4096
buffer_load_dwordx4 a[204:207], v228, s[20:23], s89 offen nt
s_mov_b64 s[20:21], s[72:73]
s_mov_b32 s22, 0x600000
s_add_u32 s89, s17, 53248
buffer_load_dwordx4 a[208:211], v228, s[20:23], s89 offen nt
s_waitcnt vmcnt(21)
s_barrier
v_add_u32 v5, 0, v1
v_add_u32 v6, s55, v5
ds_read_b128 a[96:99], v5 offset:0
ds_read_b128 a[100:103], v5 offset:1024
ds_read_b128 a[104:107], v5 offset:2048
ds_read_b128 a[108:111], v5 offset:3072
ds_read_b128 a[112:115], v5 offset:4096
ds_read_b128 a[116:119], v5 offset:5120
ds_read_b128 a[120:123], v6 offset:2048
s_waitcnt vmcnt(16) lgkmcnt(0)
v_mfma_f32_16x16x32_bf16 v[132:135], a[96:99], a[0:3], 0
s_add_u32 m0, s18, 0xc000
s_add_u32 s44, s50, 0xe0c000
v_mfma_f32_16x16x32_bf16 v[156:159], a[96:99], a[4:7], 0
buffer_load_dwordx4 a[48:51], v2, s[40:43], s35 offen offset:0 sc1
v_mfma_f32_16x16x32_bf16 v[180:183], a[96:99], a[8:11], 0
ds_read_b128 a[128:131], v5 offset:6144
v_mfma_f32_16x16x32_bf16 v[204:207], a[96:99], a[12:15], 0
ds_read_b128 a[132:135], v5 offset:7168
v_mfma_f32_16x16x32_bf16 v[208:211], a[100:103], a[12:15], 0
buffer_load_dwordx4 v1, s[4:7], s44 offen offset:0 sc1 lds
v_mfma_f32_16x16x32_bf16 v[184:187], a[100:103], a[8:11], 0
ds_read_b128 a[136:139], v5 offset:8192
v_mfma_f32_16x16x32_bf16 v[160:163], a[100:103], a[4:7], 0
ds_read_b128 a[140:143], v5 offset:9216
v_mfma_f32_16x16x32_bf16 v[136:139], a[100:103], a[0:3], 0
v_mfma_f32_16x16x32_bf16 v[140:143], a[104:107], a[0:3], 0
buffer_load_dwordx4 a[52:55], v2, s[40:43], s35 offen offset:1024 sc1
v_mfma_f32_16x16x32_bf16 v[164:167], a[104:107], a[4:7], 0
ds_read_b128 a[144:147], v5 offset:10240
v_mfma_f32_16x16x32_bf16 v[188:191], a[104:107], a[8:11], 0
v_mfma_f32_16x16x32_bf16 v[212:215], a[104:107], a[12:15], 0
buffer_load_dwordx4 v1, s[4:7], s44 offen offset:1024 sc1 lds
s_add_u32 s63, s28, 4
v_mfma_f32_16x16x32_bf16 v[216:219], a[108:111], a[12:15], 0
s_lshl_b32 s63, s63, 12
ds_read_b128 a[148:151], v5 offset:11264
v_mfma_f32_16x16x32_bf16 v[192:195], a[108:111], a[8:11], 0
ds_read_b128 a[152:155], v6 offset:3072
v_mfma_f32_16x16x32_bf16 v[168:171], a[108:111], a[4:7], 0
v_mfma_f32_16x16x32_bf16 v[144:147], a[108:111], a[0:3], 0
buffer_load_dwordx4 a[56:59], v2, s[40:43], s35 offen offset:2048 sc1
v_mfma_f32_16x16x32_bf16 v[148:151], a[112:115], a[0:3], 0
v_mfma_f32_16x16x32_bf16 v[172:175], a[112:115], a[4:7], 0
v_mfma_f32_16x16x32_bf16 v[196:199], a[112:115], a[8:11], 0
buffer_load_dwordx4 a[68:71], v3, s[40:43], s63 offen sc1
v_mfma_f32_16x16x32_bf16 v[220:223], a[112:115], a[12:15], 0
v_mfma_f32_16x16x32_bf16 v[224:227], a[116:119], a[12:15], 0
v_mfma_f32_16x16x32_bf16 v[200:203], a[116:119], a[8:11], 0
v_mfma_f32_16x16x32_bf16 v[176:179], a[116:119], a[4:7], 0
buffer_load_dwordx4 a[60:63], v2, s[40:43], s35 offen offset:3072 sc1
s_add_u32 s35, s35, 4096
v_mfma_f32_16x16x32_bf16 v[152:155], a[116:119], a[0:3], 0
v_mfma_f32_16x16x32_bf16 a[80:83], a[120:123], a[64:67], 0
s_waitcnt vmcnt(19) lgkmcnt(0)
v_mfma_f32_16x16x32_bf16 v[132:135], a[128:131], a[16:19], v[132:135]
ds_read_b128 a[96:99], v5 offset:12288
v_mfma_f32_16x16x32_bf16 v[156:159], a[128:131], a[20:23], v[156:159]
buffer_load_dwordx4 a[0:3], v2, s[40:43], s35 offen offset:0 sc1
v_mfma_f32_16x16x32_bf16 v[180:183], a[128:131], a[24:27], v[180:183]
ds_read_b128 a[100:103], v5 offset:13312
v_mfma_f32_16x16x32_bf16 v[204:207], a[128:131], a[28:31], v[204:207]
v_mfma_f32_16x16x32_bf16 v[208:211], a[132:135], a[28:31], v[208:211]
buffer_load_dwordx4 v1, s[4:7], s44 offen offset:2048 sc1 lds
s_add_u32 m0, s18, 0xf000
v_mfma_f32_16x16x32_bf16 v[184:187], a[132:135], a[24:27], v[184:187]
s_add_u32 s44, s50, 0xe0f000
ds_read_b128 a[104:107], v5 offset:14336
v_mfma_f32_16x16x32_bf16 v[160:163], a[132:135], a[20:23], v[160:163]
ds_read_b128 a[108:111], v5 offset:15360
v_mfma_f32_16x16x32_bf16 v[136:139], a[132:135], a[16:19], v[136:139]
v_mfma_f32_16x16x32_bf16 v[140:143], a[136:139], a[16:19], v[140:143]
buffer_load_dwordx4 a[4:7], v2, s[40:43], s35 offen offset:1024 sc1
v_mfma_f32_16x16x32_bf16 v[164:167], a[136:139], a[20:23], v[164:167]
ds_read_b128 a[112:115], v5 offset:16384
v_mfma_f32_16x16x32_bf16 v[188:191], a[136:139], a[24:27], v[188:191]
v_mfma_f32_16x16x32_bf16 v[212:215], a[136:139], a[28:31], v[212:215]
buffer_load_dwordx4 v1, s[4:7], s44 offen offset:0 sc1 lds
v_mfma_f32_16x16x32_bf16 v[216:219], a[140:143], a[28:31], v[216:219]
ds_read_b128 a[116:119], v5 offset:17408
v_mfma_f32_16x16x32_bf16 v[192:195], a[140:143], a[24:27], v[192:195]
ds_read_b128 a[120:123], v6 offset:4096
v_mfma_f32_16x16x32_bf16 v[168:171], a[140:143], a[20:23], v[168:171]
v_mfma_f32_16x16x32_bf16 v[144:147], a[140:143], a[16:19], v[144:147]
buffer_load_dwordx4 a[8:11], v2, s[40:43], s35 offen offset:2048 sc1
v_mfma_f32_16x16x32_bf16 v[148:151], a[144:147], a[16:19], v[148:151]
v_mfma_f32_16x16x32_bf16 v[172:175], a[144:147], a[20:23], v[172:175]
v_mfma_f32_16x16x32_bf16 v[196:199], a[144:147], a[24:27], v[196:199]
buffer_load_dwordx4 v1, s[4:7], s44 offen offset:1024 sc1 lds
v_mfma_f32_16x16x32_bf16 v[220:223], a[144:147], a[28:31], v[220:223]
v_mfma_f32_16x16x32_bf16 v[224:227], a[148:151], a[28:31], v[224:227]
v_mfma_f32_16x16x32_bf16 v[200:203], a[148:151], a[24:27], v[200:203]
v_mfma_f32_16x16x32_bf16 v[176:179], a[148:151], a[20:23], v[176:179]
buffer_load_dwordx4 a[12:15], v2, s[40:43], s35 offen offset:3072 sc1
s_add_u32 s35, s35, 4096
v_mfma_f32_16x16x32_bf16 v[152:155], a[148:151], a[16:19], v[152:155]
v_mfma_f32_16x16x32_bf16 a[84:87], a[152:155], a[64:67], 0
s_waitcnt vmcnt(22) lgkmcnt(0)
v_mfma_f32_16x16x32_bf16 v[132:135], a[96:99], a[32:35], v[132:135]
ds_read_b128 a[128:131], v5 offset:18432
v_mfma_f32_16x16x32_bf16 v[156:159], a[96:99], a[36:39], v[156:159]
buffer_load_dwordx4 a[16:19], v2, s[40:43], s35 offen offset:0 sc1
v_mfma_f32_16x16x32_bf16 v[180:183], a[96:99], a[40:43], v[180:183]
ds_read_b128 a[132:135], v5 offset:19456
v_mfma_f32_16x16x32_bf16 v[204:207], a[96:99], a[44:47], v[204:207]
v_mfma_f32_16x16x32_bf16 v[208:211], a[100:103], a[44:47], v[208:211]
buffer_load_dwordx4 v1, s[4:7], s44 offen offset:2048 sc1 lds
s_add_u32 m0, s18, 0x12000
v_mfma_f32_16x16x32_bf16 v[184:187], a[100:103], a[40:43], v[184:187]
s_add_u32 s44, s50, 0xe12000
ds_read_b128 a[136:139], v5 offset:20480
v_mfma_f32_16x16x32_bf16 v[160:163], a[100:103], a[36:39], v[160:163]
ds_read_b128 a[140:143], v5 offset:21504
v_mfma_f32_16x16x32_bf16 v[136:139], a[100:103], a[32:35], v[136:139]
v_mfma_f32_16x16x32_bf16 v[140:143], a[104:107], a[32:35], v[140:143]
buffer_load_dwordx4 a[20:23], v2, s[40:43], s35 offen offset:1024 sc1
v_mfma_f32_16x16x32_bf16 v[164:167], a[104:107], a[36:39], v[164:167]
ds_read_b128 a[144:147], v5 offset:22528
v_mfma_f32_16x16x32_bf16 v[188:191], a[104:107], a[40:43], v[188:191]
v_mfma_f32_16x16x32_bf16 v[212:215], a[104:107], a[44:47], v[212:215]
buffer_load_dwordx4 v1, s[4:7], s44 offen offset:0 sc1 lds
v_mfma_f32_16x16x32_bf16 v[216:219], a[108:111], a[44:47], v[216:219]
ds_read_b128 a[148:151], v5 offset:23552
v_mfma_f32_16x16x32_bf16 v[192:195], a[108:111], a[40:43], v[192:195]
ds_read_b128 a[152:155], v6 offset:5120
v_mfma_f32_16x16x32_bf16 v[168:171], a[108:111], a[36:39], v[168:171]
v_mfma_f32_16x16x32_bf16 v[144:147], a[108:111], a[32:35], v[144:147]
buffer_load_dwordx4 a[24:27], v2, s[40:43], s35 offen offset:2048 sc1
v_mfma_f32_16x16x32_bf16 v[148:151], a[112:115], a[32:35], v[148:151]
v_mfma_f32_16x16x32_bf16 v[172:175], a[112:115], a[36:39], v[172:175]
v_mfma_f32_16x16x32_bf16 v[196:199], a[112:115], a[40:43], v[196:199]
buffer_load_dwordx4 v1, s[4:7], s44 offen offset:1024 sc1 lds
v_mfma_f32_16x16x32_bf16 v[220:223], a[112:115], a[44:47], v[220:223]
v_mfma_f32_16x16x32_bf16 v[224:227], a[116:119], a[44:47], v[224:227]
v_mfma_f32_16x16x32_bf16 v[200:203], a[116:119], a[40:43], v[200:203]
v_mfma_f32_16x16x32_bf16 v[176:179], a[116:119], a[36:39], v[176:179]
buffer_load_dwordx4 a[28:31], v2, s[40:43], s35 offen offset:3072 sc1
s_add_u32 s35, s35, 4096
v_mfma_f32_16x16x32_bf16 v[152:155], a[116:119], a[32:35], v[152:155]
v_mfma_f32_16x16x32_bf16 a[88:91], a[120:123], a[64:67], 0
s_waitcnt vmcnt(14) lgkmcnt(0)
v_mfma_f32_16x16x32_bf16 v[132:135], a[128:131], a[48:51], v[132:135]
ds_read_b128 a[96:99], v5 offset:24576
v_mfma_f32_16x16x32_bf16 v[156:159], a[128:131], a[52:55], v[156:159]
buffer_load_dwordx4 a[32:35], v2, s[40:43], s35 offen offset:0 sc1
v_mfma_f32_16x16x32_bf16 v[180:183], a[128:131], a[56:59], v[180:183]
ds_read_b128 a[100:103], v5 offset:25600
v_mfma_f32_16x16x32_bf16 v[204:207], a[128:131], a[60:63], v[204:207]
v_mfma_f32_16x16x32_bf16 v[208:211], a[132:135], a[60:63], v[208:211]
buffer_load_dwordx4 v1, s[4:7], s44 offen offset:2048 sc1 lds
s_add_u32 m0, s18, 0x15000
v_mfma_f32_16x16x32_bf16 v[184:187], a[132:135], a[56:59], v[184:187]
s_add_u32 s44, s50, 0xe15000
ds_read_b128 a[104:107], v5 offset:26624
v_mfma_f32_16x16x32_bf16 v[160:163], a[132:135], a[52:55], v[160:163]
ds_read_b128 a[108:111], v5 offset:27648
v_mfma_f32_16x16x32_bf16 v[136:139], a[132:135], a[48:51], v[136:139]
v_mfma_f32_16x16x32_bf16 v[140:143], a[136:139], a[48:51], v[140:143]
buffer_load_dwordx4 a[36:39], v2, s[40:43], s35 offen offset:1024 sc1
v_mfma_f32_16x16x32_bf16 v[164:167], a[136:139], a[52:55], v[164:167]
ds_read_b128 a[112:115], v5 offset:28672
v_mfma_f32_16x16x32_bf16 v[188:191], a[136:139], a[56:59], v[188:191]
v_mfma_f32_16x16x32_bf16 v[212:215], a[136:139], a[60:63], v[212:215]
buffer_load_dwordx4 v1, s[4:7], s44 offen offset:0 sc1 lds
v_mfma_f32_16x16x32_bf16 v[216:219], a[140:143], a[60:63], v[216:219]
ds_read_b128 a[116:119], v5 offset:29696
v_mfma_f32_16x16x32_bf16 v[192:195], a[140:143], a[56:59], v[192:195]
ds_read_b128 a[120:123], v6 offset:26624
v_mfma_f32_16x16x32_bf16 v[168:171], a[140:143], a[52:55], v[168:171]
v_mfma_f32_16x16x32_bf16 v[144:147], a[140:143], a[48:51], v[144:147]
buffer_load_dwordx4 a[40:43], v2, s[40:43], s35 offen offset:2048 sc1
v_mfma_f32_16x16x32_bf16 v[148:151], a[144:147], a[48:51], v[148:151]
v_mfma_f32_16x16x32_bf16 v[172:175], a[144:147], a[52:55], v[172:175]
v_mfma_f32_16x16x32_bf16 v[196:199], a[144:147], a[56:59], v[196:199]
buffer_load_dwordx4 v1, s[4:7], s44 offen offset:1024 sc1 lds
v_mfma_f32_16x16x32_bf16 v[220:223], a[144:147], a[60:63], v[220:223]
v_mfma_f32_16x16x32_bf16 v[224:227], a[148:151], a[60:63], v[224:227]
v_mfma_f32_16x16x32_bf16 v[200:203], a[148:151], a[56:59], v[200:203]
v_mfma_f32_16x16x32_bf16 v[176:179], a[148:151], a[52:55], v[176:179]
buffer_load_dwordx4 a[44:47], v2, s[40:43], s35 offen offset:3072 sc1
s_add_u32 s35, s35, 4096
v_mfma_f32_16x16x32_bf16 v[152:155], a[148:151], a[48:51], v[152:155]
v_mfma_f32_16x16x32_bf16 a[92:95], a[152:155], a[64:67], 0
s_waitcnt vmcnt(14) lgkmcnt(0)
v_mfma_f32_16x16x32_bf16 v[132:135], a[96:99], a[0:3], v[132:135]
ds_read_b128 a[128:131], v5 offset:30720
v_mfma_f32_16x16x32_bf16 v[156:159], a[96:99], a[4:7], v[156:159]
buffer_load_dwordx4 a[48:51], v2, s[40:43], s35 offen offset:0 sc1
v_mfma_f32_16x16x32_bf16 v[180:183], a[96:99], a[8:11], v[180:183]
ds_read_b128 a[132:135], v5 offset:31744
v_mfma_f32_16x16x32_bf16 v[204:207], a[96:99], a[12:15], v[204:207]
v_mfma_f32_16x16x32_bf16 v[208:211], a[100:103], a[12:15], v[208:211]
buffer_load_dwordx4 v1, s[4:7], s44 offen offset:2048 sc1 lds
v_mfma_f32_16x16x32_bf16 v[184:187], a[100:103], a[8:11], v[184:187]
v_and_b32 v232, 15, v0
v_lshlrev_b32 v232, 7, v232
v_mfma_f32_16x16x32_bf16 v[160:163], a[100:103], a[4:7], v[160:163]
v_lshrrev_b32 v233, 4, v0
v_lshlrev_b32 v233, 4, v233
v_mfma_f32_16x16x32_bf16 v[136:139], a[100:103], a[0:3], v[136:139]
v_add_u32 v232, v233, v232
s_mul_i32 s38, s30, 12288
v_mfma_f32_16x16x32_bf16 v[140:143], a[104:107], a[0:3], v[140:143]
buffer_load_dwordx4 a[52:55], v2, s[40:43], s35 offen offset:1024 sc1
s_add_u32 s38, s38, 0x300000
v_mfma_f32_16x16x32_bf16 v[164:167], a[104:107], a[4:7], v[164:167]
s_add_u32 s39, s28, 4
s_min_u32 s39, s39, 5
s_lshl_b32 s36, s28, 11
v_mfma_f32_16x16x32_bf16 v[188:191], a[104:107], a[8:11], v[188:191]
s_add_u32 s36, s36, s38
s_lshl_b32 s37, s39, 11
s_add_u32 s37, s37, s38
v_mfma_f32_16x16x32_bf16 v[212:215], a[104:107], a[12:15], v[212:215]
buffer_load_dwordx4 v[48:51], v232, s[4:7], s36 offen sc1
s_add_u32 s63, s28, 8
v_mfma_f32_16x16x32_bf16 v[216:219], a[108:111], a[12:15], v[216:219]
s_lshl_b32 s63, s63, 12
ds_read_b128 a[136:139], v5 offset:32768
v_mfma_f32_16x16x32_bf16 v[192:195], a[108:111], a[8:11], v[192:195]
ds_read_b128 a[140:143], v5 offset:33792
v_mfma_f32_16x16x32_bf16 v[168:171], a[108:111], a[4:7], v[168:171]
ds_read_b128 a[144:147], v5 offset:34816
v_mfma_f32_16x16x32_bf16 v[144:147], a[108:111], a[0:3], v[144:147]
buffer_load_dwordx4 a[56:59], v2, s[40:43], s35 offen offset:2048 sc1
v_mfma_f32_16x16x32_bf16 v[148:151], a[112:115], a[0:3], v[148:151]
ds_read_b128 a[148:151], v5 offset:35840
v_mfma_f32_16x16x32_bf16 v[172:175], a[112:115], a[4:7], v[172:175]
ds_read_b128 a[152:155], v6 offset:27648
v_mfma_f32_16x16x32_bf16 v[196:199], a[112:115], a[8:11], v[196:199]
buffer_load_dwordx4 a[72:75], v3, s[40:43], s63 offen sc1
v_mfma_f32_16x16x32_bf16 v[220:223], a[112:115], a[12:15], v[220:223]
v_mfma_f32_16x16x32_bf16 v[224:227], a[116:119], a[12:15], v[224:227]
v_mfma_f32_16x16x32_bf16 v[200:203], a[116:119], a[8:11], v[200:203]
v_mfma_f32_16x16x32_bf16 v[176:179], a[116:119], a[4:7], v[176:179]
buffer_load_dwordx4 a[60:63], v2, s[40:43], s35 offen offset:3072 sc1
s_add_u32 s35, s35, 4096
v_mfma_f32_16x16x32_bf16 v[152:155], a[116:119], a[0:3], v[152:155]
v_mfma_f32_16x16x32_bf16 a[80:83], a[120:123], a[68:71], a[80:83]
s_waitcnt vmcnt(14) lgkmcnt(0)
v_mfma_f32_16x16x32_bf16 v[132:135], a[128:131], a[16:19], v[132:135]
ds_read_b128 a[96:99], v5 offset:36864
v_mfma_f32_16x16x32_bf16 v[156:159], a[128:131], a[20:23], v[156:159]
buffer_load_dwordx4 a[0:3], v2, s[40:43], s35 offen offset:0 sc1
v_mfma_f32_16x16x32_bf16 v[180:183], a[128:131], a[24:27], v[180:183]
ds_read_b128 a[100:103], v5 offset:37888
v_mfma_f32_16x16x32_bf16 v[204:207], a[128:131], a[28:31], v[204:207]
v_mfma_f32_16x16x32_bf16 v[208:211], a[132:135], a[28:31], v[208:211]
buffer_load_dwordx4 v[52:55], v232, s[4:7], s37 offen sc1
s_add_u32 m0, s18, 0x18000
v_mfma_f32_16x16x32_bf16 v[184:187], a[132:135], a[24:27], v[184:187]
s_add_u32 s44, s50, 0xe18000
ds_read_b128 a[104:107], v5 offset:38912
v_mfma_f32_16x16x32_bf16 v[160:163], a[132:135], a[20:23], v[160:163]
ds_read_b128 a[108:111], v5 offset:39936
v_mfma_f32_16x16x32_bf16 v[136:139], a[132:135], a[16:19], v[136:139]
v_mfma_f32_16x16x32_bf16 v[140:143], a[136:139], a[16:19], v[140:143]
buffer_load_dwordx4 a[4:7], v2, s[40:43], s35 offen offset:1024 sc1
v_mfma_f32_16x16x32_bf16 v[164:167], a[136:139], a[20:23], v[164:167]
ds_read_b128 a[112:115], v5 offset:40960
v_mfma_f32_16x16x32_bf16 v[188:191], a[136:139], a[24:27], v[188:191]
v_mfma_f32_16x16x32_bf16 v[212:215], a[136:139], a[28:31], v[212:215]
buffer_load_dwordx4 v1, s[4:7], s44 offen offset:0 sc1 lds
v_mfma_f32_16x16x32_bf16 v[216:219], a[140:143], a[28:31], v[216:219]
ds_read_b128 a[116:119], v5 offset:41984
v_mfma_f32_16x16x32_bf16 v[192:195], a[140:143], a[24:27], v[192:195]
ds_read_b128 a[120:123], v6 offset:28672
v_mfma_f32_16x16x32_bf16 v[168:171], a[140:143], a[20:23], v[168:171]
v_mfma_f32_16x16x32_bf16 v[144:147], a[140:143], a[16:19], v[144:147]
buffer_load_dwordx4 a[8:11], v2, s[40:43], s35 offen offset:2048 sc1
v_mfma_f32_16x16x32_bf16 v[148:151], a[144:147], a[16:19], v[148:151]
v_mfma_f32_16x16x32_bf16 v[172:175], a[144:147], a[20:23], v[172:175]
v_mfma_f32_16x16x32_bf16 v[196:199], a[144:147], a[24:27], v[196:199]
buffer_load_dwordx4 v1, s[4:7], s44 offen offset:1024 sc1 lds
v_mfma_f32_16x16x32_bf16 v[220:223], a[144:147], a[28:31], v[220:223]
v_mfma_f32_16x16x32_bf16 v[224:227], a[148:151], a[28:31], v[224:227]
v_mfma_f32_16x16x32_bf16 v[200:203], a[148:151], a[24:27], v[200:203]
v_mfma_f32_16x16x32_bf16 v[176:179], a[148:151], a[20:23], v[176:179]
buffer_load_dwordx4 a[12:15], v2, s[40:43], s35 offen offset:3072 sc1
s_add_u32 s35, s35, 4096
v_mfma_f32_16x16x32_bf16 v[152:155], a[148:151], a[16:19], v[152:155]
v_mfma_f32_16x16x32_bf16 a[84:87], a[152:155], a[68:71], a[84:87]
s_waitcnt vmcnt(14) lgkmcnt(0)
v_mfma_f32_16x16x32_bf16 v[132:135], a[96:99], a[32:35], v[132:135]
ds_read_b128 a[128:131], v5 offset:43008
v_mfma_f32_16x16x32_bf16 v[156:159], a[96:99], a[36:39], v[156:159]
buffer_load_dwordx4 a[16:19], v2, s[40:43], s35 offen offset:0 sc1
v_mfma_f32_16x16x32_bf16 v[180:183], a[96:99], a[40:43], v[180:183]
ds_read_b128 a[132:135], v5 offset:44032
v_mfma_f32_16x16x32_bf16 v[204:207], a[96:99], a[44:47], v[204:207]
v_mfma_f32_16x16x32_bf16 v[208:211], a[100:103], a[44:47], v[208:211]
buffer_load_dwordx4 v1, s[4:7], s44 offen offset:2048 sc1 lds
s_add_u32 m0, s18, 0x1b000
v_mfma_f32_16x16x32_bf16 v[184:187], a[100:103], a[40:43], v[184:187]
s_add_u32 s44, s50, 0xe1b000
ds_read_b128 a[136:139], v5 offset:45056
v_mfma_f32_16x16x32_bf16 v[160:163], a[100:103], a[36:39], v[160:163]
ds_read_b128 a[140:143], v5 offset:46080
v_mfma_f32_16x16x32_bf16 v[136:139], a[100:103], a[32:35], v[136:139]
v_mfma_f32_16x16x32_bf16 v[140:143], a[104:107], a[32:35], v[140:143]
buffer_load_dwordx4 a[20:23], v2, s[40:43], s35 offen offset:1024 sc1
v_mfma_f32_16x16x32_bf16 v[164:167], a[104:107], a[36:39], v[164:167]
ds_read_b128 a[144:147], v5 offset:47104
v_mfma_f32_16x16x32_bf16 v[188:191], a[104:107], a[40:43], v[188:191]
v_mfma_f32_16x16x32_bf16 v[212:215], a[104:107], a[44:47], v[212:215]
buffer_load_dwordx4 v1, s[4:7], s44 offen offset:0 sc1 lds
v_mfma_f32_16x16x32_bf16 v[216:219], a[108:111], a[44:47], v[216:219]
ds_read_b128 a[148:151], v5 offset:48128
v_mfma_f32_16x16x32_bf16 v[192:195], a[108:111], a[40:43], v[192:195]
ds_read_b128 a[152:155], v6 offset:29696
v_mfma_f32_16x16x32_bf16 v[168:171], a[108:111], a[36:39], v[168:171]
v_mfma_f32_16x16x32_bf16 v[144:147], a[108:111], a[32:35], v[144:147]
buffer_load_dwordx4 a[24:27], v2, s[40:43], s35 offen offset:2048 sc1
v_mfma_f32_16x16x32_bf16 v[148:151], a[112:115], a[32:35], v[148:151]
v_mfma_f32_16x16x32_bf16 v[172:175], a[112:115], a[36:39], v[172:175]
v_mfma_f32_16x16x32_bf16 v[196:199], a[112:115], a[40:43], v[196:199]
buffer_load_dwordx4 v1, s[4:7], s44 offen offset:1024 sc1 lds
v_mfma_f32_16x16x32_bf16 v[220:223], a[112:115], a[44:47], v[220:223]
v_mfma_f32_16x16x32_bf16 v[224:227], a[116:119], a[44:47], v[224:227]
v_mfma_f32_16x16x32_bf16 v[200:203], a[116:119], a[40:43], v[200:203]
v_mfma_f32_16x16x32_bf16 v[176:179], a[116:119], a[36:39], v[176:179]
buffer_load_dwordx4 a[28:31], v2, s[40:43], s35 offen offset:3072 sc1
s_add_u32 s35, s35, 4096
v_mfma_f32_16x16x32_bf16 v[152:155], a[116:119], a[32:35], v[152:155]
v_mfma_f32_16x16x32_bf16 a[88:91], a[120:123], a[68:71], a[88:91]
s_waitcnt vmcnt(14) lgkmcnt(0)
s_barrier
v_mfma_f32_16x16x32_bf16 v[132:135], a[128:131], a[48:51], v[132:135]
v_add_u32 v5, 49152, v1
v_add_u32 v6, s55, v5
v_mfma_f32_16x16x32_bf16 v[156:159], a[128:131], a[52:55], v[156:159]
buffer_load_dwordx4 a[32:35], v2, s[40:43], s35 offen offset:0 sc1
v_mfma_f32_16x16x32_bf16 v[180:183], a[128:131], a[56:59], v[180:183]
ds_read_b128 a[96:99], v5 offset:0
v_mfma_f32_16x16x32_bf16 v[204:207], a[128:131], a[60:63], v[204:207]
ds_read_b128 a[100:103], v5 offset:1024
v_mfma_f32_16x16x32_bf16 v[208:211], a[132:135], a[60:63], v[208:211]
ds_read_b128 a[104:107], v5 offset:2048
v_mfma_f32_16x16x32_bf16 v[184:187], a[132:135], a[56:59], v[184:187]
buffer_load_dwordx4 v1, s[4:7], s44 offen offset:2048 sc1 lds
s_add_u32 m0, s18, 0x1e000
v_mfma_f32_16x16x32_bf16 v[160:163], a[132:135], a[52:55], v[160:163]
s_add_u32 s44, s50, 0xe1e000
ds_read_b128 a[108:111], v5 offset:3072
v_mfma_f32_16x16x32_bf16 v[136:139], a[132:135], a[48:51], v[136:139]
ds_write_b128 v231, a[220:223] offset:24576
v_mfma_f32_16x16x32_bf16 v[140:143], a[136:139], a[48:51], v[140:143]
v_mfma_f32_16x16x32_bf16 v[164:167], a[136:139], a[52:55], v[164:167]
buffer_load_dwordx4 a[36:39], v2, s[40:43], s35 offen offset:1024 sc1
v_mfma_f32_16x16x32_bf16 v[188:191], a[136:139], a[56:59], v[188:191]
ds_read_b128 a[112:115], v5 offset:4096
v_mfma_f32_16x16x32_bf16 v[212:215], a[136:139], a[60:63], v[212:215]
ds_read_b128 a[116:119], v5 offset:5120
v_mfma_f32_16x16x32_bf16 v[216:219], a[140:143], a[60:63], v[216:219]
ds_write_b128 v231, a[224:227] offset:25600
v_mfma_f32_16x16x32_bf16 v[192:195], a[140:143], a[56:59], v[192:195]
buffer_load_dwordx4 a[40:43], v2, s[40:43], s35 offen offset:2048 sc1
v_mfma_f32_16x16x32_bf16 v[168:171], a[140:143], a[52:55], v[168:171]
ds_read_b128 a[120:123], v6 offset:2048
v_mfma_f32_16x16x32_bf16 v[144:147], a[140:143], a[48:51], v[144:147]
v_mfma_f32_16x16x32_bf16 v[148:151], a[144:147], a[48:51], v[148:151]
v_mfma_f32_16x16x32_bf16 v[172:175], a[144:147], a[52:55], v[172:175]
buffer_load_dwordx4 v1, s[4:7], s44 offen offset:0 sc1 lds
v_mfma_f32_16x16x32_bf16 v[196:199], a[144:147], a[56:59], v[196:199]
v_mfma_f32_16x16x32_bf16 v[220:223], a[144:147], a[60:63], v[220:223]
v_mfma_f32_16x16x32_bf16 v[224:227], a[148:151], a[60:63], v[224:227]
v_mfma_f32_16x16x32_bf16 v[200:203], a[148:151], a[56:59], v[200:203]
buffer_load_dwordx4 a[44:47], v2, s[40:43], s35 offen offset:3072 sc1
s_add_u32 s35, s35, 4096
v_mfma_f32_16x16x32_bf16 v[176:179], a[148:151], a[52:55], v[176:179]
ds_write_b128 v231, a[188:191] offset:0
v_mfma_f32_16x16x32_bf16 v[152:155], a[148:151], a[48:51], v[152:155]
v_mfma_f32_16x16x32_bf16 a[92:95], a[152:155], a[68:71], a[92:95]
s_waitcnt vmcnt(13) lgkmcnt(1)
v_mfma_f32_16x16x32_bf16 v[132:135], a[96:99], a[0:3], v[132:135]
ds_read_b128 a[128:131], v5 offset:6144
v_mfma_f32_16x16x32_bf16 v[156:159], a[96:99], a[4:7], v[156:159]
buffer_load_dwordx4 a[48:51], v2, s[40:43], s35 offen offset:0 sc1
v_mfma_f32_16x16x32_bf16 v[180:183], a[96:99], a[8:11], v[180:183]
ds_read_b128 a[132:135], v5 offset:7168
v_mfma_f32_16x16x32_bf16 v[204:207], a[96:99], a[12:15], v[204:207]
v_mfma_f32_16x16x32_bf16 v[208:211], a[100:103], a[12:15], v[208:211]
buffer_load_dwordx4 v1, s[4:7], s44 offen offset:1024 sc1 lds
v_mfma_f32_16x16x32_bf16 v[184:187], a[100:103], a[8:11], v[184:187]
ds_read_b128 a[136:139], v5 offset:8192
v_mfma_f32_16x16x32_bf16 v[160:163], a[100:103], a[4:7], v[160:163]
ds_read_b128 a[140:143], v5 offset:9216
v_mfma_f32_16x16x32_bf16 v[136:139], a[100:103], a[0:3], v[136:139]
v_mfma_f32_16x16x32_bf16 v[140:143], a[104:107], a[0:3], v[140:143]
buffer_load_dwordx4 a[52:55], v2, s[40:43], s35 offen offset:1024 sc1
v_mfma_f32_16x16x32_bf16 v[164:167], a[104:107], a[4:7], v[164:167]
ds_read_b128 a[144:147], v5 offset:10240
v_mfma_f32_16x16x32_bf16 v[188:191], a[104:107], a[8:11], v[188:191]
ds_write_b128 v231, a[192:195] offset:1024
v_mfma_f32_16x16x32_bf16 v[212:215], a[104:107], a[12:15], v[212:215]
buffer_load_dwordx4 v1, s[4:7], s44 offen offset:2048 sc1 lds
s_add_u32 s63, s28, 12
v_mfma_f32_16x16x32_bf16 v[216:219], a[108:111], a[12:15], v[216:219]
s_lshl_b32 s63, s63, 12
ds_read_b128 a[148:151], v5 offset:11264
v_mfma_f32_16x16x32_bf16 v[192:195], a[108:111], a[8:11], v[192:195]
ds_read_b128 a[152:155], v6 offset:3072
v_mfma_f32_16x16x32_bf16 v[168:171], a[108:111], a[4:7], v[168:171]
v_mfma_f32_16x16x32_bf16 v[144:147], a[108:111], a[0:3], v[144:147]
buffer_load_dwordx4 a[56:59], v2, s[40:43], s35 offen offset:2048 sc1
v_mfma_f32_16x16x32_bf16 v[148:151], a[112:115], a[0:3], v[148:151]
v_mfma_f32_16x16x32_bf16 v[172:175], a[112:115], a[4:7], v[172:175]
v_mfma_f32_16x16x32_bf16 v[196:199], a[112:115], a[8:11], v[196:199]
buffer_load_dwordx4 a[64:67], v3, s[40:43], s63 offen sc1
s_add_u32 m0, s18, 0x21000
v_mfma_f32_16x16x32_bf16 v[220:223], a[112:115], a[12:15], v[220:223]
s_add_u32 s44, s50, 0xe21000
ds_write_b128 v231, a[196:199] offset:8192
v_mfma_f32_16x16x32_bf16 v[224:227], a[116:119], a[12:15], v[224:227]
v_mfma_f32_16x16x32_bf16 v[200:203], a[116:119], a[8:11], v[200:203]
v_mfma_f32_16x16x32_bf16 v[176:179], a[116:119], a[4:7], v[176:179]
buffer_load_dwordx4 a[60:63], v2, s[40:43], s35 offen offset:3072 sc1
s_add_u32 s35, s35, 4096
v_mfma_f32_16x16x32_bf16 v[152:155], a[116:119], a[0:3], v[152:155]
v_mfma_f32_16x16x32_bf16 a[80:83], a[120:123], a[72:75], a[80:83]
s_waitcnt vmcnt(13) lgkmcnt(1)
v_mfma_f32_16x16x32_bf16 v[132:135], a[128:131], a[16:19], v[132:135]
ds_read_b128 a[96:99], v5 offset:12288
v_mfma_f32_16x16x32_bf16 v[156:159], a[128:131], a[20:23], v[156:159]
buffer_load_dwordx4 a[0:3], v2, s[40:43], s35 offen offset:0 sc1
v_mfma_f32_16x16x32_bf16 v[180:183], a[128:131], a[24:27], v[180:183]
ds_read_b128 a[100:103], v5 offset:13312
v_mfma_f32_16x16x32_bf16 v[204:207], a[128:131], a[28:31], v[204:207]
v_mfma_f32_16x16x32_bf16 v[208:211], a[132:135], a[28:31], v[208:211]
buffer_load_dwordx4 v1, s[4:7], s44 offen offset:0 sc1 lds
v_mfma_f32_16x16x32_bf16 v[184:187], a[132:135], a[24:27], v[184:187]
ds_read_b128 a[104:107], v5 offset:14336
v_mfma_f32_16x16x32_bf16 v[160:163], a[132:135], a[20:23], v[160:163]
ds_read_b128 a[108:111], v5 offset:15360
v_mfma_f32_16x16x32_bf16 v[136:139], a[132:135], a[16:19], v[136:139]
L_stub0:
s_cbranch_execz L_stub1
ds_write_b128 v231, a[200:203] offset:9216
v_mfma_f32_16x16x32_bf16 v[140:143], a[136:139], a[16:19], v[140:143]
buffer_load_dwordx4 a[4:7], v2, s[40:43], s35 offen offset:1024 sc1
v_mfma_f32_16x16x32_bf16 v[164:167], a[136:139], a[20:23], v[164:167]
ds_read_b128 a[112:115], v5 offset:16384
v_mfma_f32_16x16x32_bf16 v[188:191], a[136:139], a[24:27], v[188:191]
v_mfma_f32_16x16x32_bf16 v[212:215], a[136:139], a[28:31], v[212:215]
buffer_load_dwordx4 v1, s[4:7], s44 offen offset:1024 sc1 lds
v_mfma_f32_16x16x32_bf16 v[216:219], a[140:143], a[28:31], v[216:219]
ds_read_b128 a[116:119], v5 offset:17408
v_mfma_f32_16x16x32_bf16 v[192:195], a[140:143], a[24:27], v[192:195]
ds_read_b128 a[120:123], v6 offset:4096
v_mfma_f32_16x16x32_bf16 v[168:171], a[140:143], a[20:23], v[168:171]
v_mfma_f32_16x16x32_bf16 v[144:147], a[140:143], a[16:19], v[144:147]
buffer_load_dwordx4 a[8:11], v2, s[40:43], s35 offen offset:2048 sc1
v_mfma_f32_16x16x32_bf16 v[148:151], a[144:147], a[16:19], v[148:151]
ds_write_b128 v231, a[204:207] offset:16384
v_mfma_f32_16x16x32_bf16 v[172:175], a[144:147], a[20:23], v[172:175]
v_mfma_f32_16x16x32_bf16 v[196:199], a[144:147], a[24:27], v[196:199]
buffer_load_dwordx4 v1, s[4:7], s44 offen offset:2048 sc1 lds
s_add_u32 s88, s82, 0x200000
v_mfma_f32_16x16x32_bf16 v[220:223], a[144:147], a[28:31], v[220:223]
v_mfma_f32_16x16x32_bf16 v[224:227], a[148:151], a[28:31], v[224:227]
v_mfma_f32_16x16x32_bf16 v[200:203], a[148:151], a[24:27], v[200:203]
v_mfma_f32_16x16x32_bf16 v[176:179], a[148:151], a[20:23], v[176:179]
buffer_load_dwordx4 a[12:15], v2, s[40:43], s35 offen offset:3072 sc1
s_add_u32 s35, s35, 4096
v_mfma_f32_16x16x32_bf16 v[152:155], a[148:151], a[16:19], v[152:155]
v_mfma_f32_16x16x32_bf16 a[84:87], a[152:155], a[72:75], a[84:87]
s_waitcnt vmcnt(14) lgkmcnt(1)
v_mfma_f32_16x16x32_bf16 v[132:135], a[96:99], a[32:35], v[132:135]
ds_read_b128 a[128:131], v5 offset:18432
v_mfma_f32_16x16x32_bf16 v[156:159], a[96:99], a[36:39], v[156:159]
buffer_load_dwordx4 a[16:19], v2, s[40:43], s35 offen offset:0 sc1
v_mfma_f32_16x16x32_bf16 v[180:183], a[96:99], a[40:43], v[180:183]
ds_read_b128 a[132:135], v5 offset:19456
v_mfma_f32_16x16x32_bf16 v[204:207], a[96:99], a[44:47], v[204:207]
ds_write_b128 v231, a[208:211] offset:17408
v_mfma_f32_16x16x32_bf16 v[208:211], a[100:103], a[44:47], v[208:211]
buffer_load_dwordx4 v[92:95], v1, s[4:7], s88 offen offset:0 sc1
v_mfma_f32_16x16x32_bf16 v[184:187], a[100:103], a[40:43], v[184:187]
ds_read_b128 a[136:139], v5 offset:20480
v_mfma_f32_16x16x32_bf16 v[160:163], a[100:103], a[36:39], v[160:163]
ds_read_b128 a[140:143], v5 offset:21504
v_mfma_f32_16x16x32_bf16 v[136:139], a[100:103], a[32:35], v[136:139]
v_mfma_f32_16x16x32_bf16 v[140:143], a[104:107], a[32:35], v[140:143]
buffer_load_dwordx4 a[20:23], v2, s[40:43], s35 offen offset:1024 sc1
v_mfma_f32_16x16x32_bf16 v[164:167], a[104:107], a[36:39], v[164:167]
ds_read_b128 a[144:147], v5 offset:22528
v_mfma_f32_16x16x32_bf16 v[188:191], a[104:107], a[40:43], v[188:191]
v_mfma_f32_16x16x32_bf16 v[212:215], a[104:107], a[44:47], v[212:215]
buffer_load_dwordx4 v[96:99], v1, s[4:7], s88 offen offset:1024 sc1
v_mfma_f32_16x16x32_bf16 v[216:219], a[108:111], a[44:47], v[216:219]
ds_read_b128 a[148:151], v5 offset:23552
v_mfma_f32_16x16x32_bf16 v[192:195], a[108:111], a[40:43], v[192:195]
ds_read_b128 a[152:155], v6 offset:5120
v_mfma_f32_16x16x32_bf16 v[168:171], a[108:111], a[36:39], v[168:171]
v_mfma_f32_16x16x32_bf16 v[144:147], a[108:111], a[32:35], v[144:147]
buffer_load_dwordx4 a[24:27], v2, s[40:43], s35 offen offset:2048 sc1
v_mfma_f32_16x16x32_bf16 v[148:151], a[112:115], a[32:35], v[148:151]
v_mfma_f32_16x16x32_bf16 v[172:175], a[112:115], a[36:39], v[172:175]
v_mfma_f32_16x16x32_bf16 v[196:199], a[112:115], a[40:43], v[196:199]
buffer_load_dwordx4 v[100:103], v1, s[4:7], s88 offen offset:2048 sc1
v_mfma_f32_16x16x32_bf16 v[220:223], a[112:115], a[44:47], v[220:223]
v_mfma_f32_16x16x32_bf16 v[224:227], a[116:119], a[44:47], v[224:227]
v_mfma_f32_16x16x32_bf16 v[200:203], a[116:119], a[40:43], v[200:203]
v_mfma_f32_16x16x32_bf16 v[176:179], a[116:119], a[36:39], v[176:179]
buffer_load_dwordx4 a[28:31], v2, s[40:43], s35 offen offset:3072 sc1
s_add_u32 s35, s35, 4096
v_mfma_f32_16x16x32_bf16 v[152:155], a[116:119], a[32:35], v[152:155]
v_mfma_f32_16x16x32_bf16 a[88:91], a[120:123], a[72:75], a[88:91]
s_waitcnt vmcnt(14) lgkmcnt(0)
s_barrier
v_mfma_f32_16x16x32_bf16 v[132:135], a[128:131], a[48:51], v[132:135]
ds_read_b128 a[96:99], v5 offset:24576
v_mfma_f32_16x16x32_bf16 v[156:159], a[128:131], a[52:55], v[156:159]
buffer_load_dwordx4 a[32:35], v2, s[40:43], s35 offen offset:0 sc1
v_mfma_f32_16x16x32_bf16 v[180:183], a[128:131], a[56:59], v[180:183]
ds_read_b128 a[100:103], v5 offset:25600
v_mfma_f32_16x16x32_bf16 v[204:207], a[128:131], a[60:63], v[204:207]
ds_read_b64_tr_b16 a[220:221], v230 offset:0
v_mfma_f32_16x16x32_bf16 v[208:211], a[132:135], a[60:63], v[208:211]
buffer_load_dwordx4 v[104:107], v1, s[4:7], s88 offen offset:3072 sc1
s_add_u32 s88, s88, 4096
v_mfma_f32_16x16x32_bf16 v[184:187], a[132:135], a[56:59], v[184:187]
ds_read_b128 a[104:107], v5 offset:26624
v_mfma_f32_16x16x32_bf16 v[160:163], a[132:135], a[52:55], v[160:163]
ds_read_b128 a[108:111], v5 offset:27648
v_mfma_f32_16x16x32_bf16 v[136:139], a[132:135], a[48:51], v[136:139]
ds_read_b64_tr_b16 a[222:223], v230 offset:2048
v_mfma_f32_16x16x32_bf16 v[140:143], a[136:139], a[48:51], v[140:143]
buffer_load_dwordx4 a[36:39], v2, s[40:43], s35 offen offset:1024 sc1
v_mfma_f32_16x16x32_bf16 v[164:167], a[136:139], a[52:55], v[164:167]
ds_read_b128 a[112:115], v5 offset:28672
v_mfma_f32_16x16x32_bf16 v[188:191], a[136:139], a[56:59], v[188:191]
v_mfma_f32_16x16x32_bf16 v[212:215], a[136:139], a[60:63], v[212:215]
buffer_load_dwordx4 v[108:111], v1, s[4:7], s88 offen offset:0 sc1
v_mfma_f32_16x16x32_bf16 v[216:219], a[140:143], a[60:63], v[216:219]
ds_read_b128 a[116:119], v5 offset:29696
v_mfma_f32_16x16x32_bf16 v[192:195], a[140:143], a[56:59], v[192:195]
ds_read_b128 a[120:123], v6 offset:26624
v_mfma_f32_16x16x32_bf16 v[168:171], a[140:143], a[52:55], v[168:171]
ds_read_b64_tr_b16 a[224:225], v230 offset:8
v_mfma_f32_16x16x32_bf16 v[144:147], a[140:143], a[48:51], v[144:147]
buffer_load_dwordx4 a[40:43], v2, s[40:43], s35 offen offset:2048 sc1
v_mfma_f32_16x16x32_bf16 v[148:151], a[144:147], a[48:51], v[148:151]
v_mfma_f32_16x16x32_bf16 v[172:175], a[144:147], a[52:55], v[172:175]
ds_read_b64_tr_b16 a[226:227], v230 offset:2056
v_mfma_f32_16x16x32_bf16 v[196:199], a[144:147], a[56:59], v[196:199]
buffer_load_dwordx4 v[112:115], v1, s[4:7], s88 offen offset:1024 sc1
v_mfma_f32_16x16x32_bf16 v[220:223], a[144:147], a[60:63], v[220:223]
v_mfma_f32_16x16x32_bf16 v[224:227], a[148:151], a[60:63], v[224:227]
v_mfma_f32_16x16x32_bf16 v[200:203], a[148:151], a[56:59], v[200:203]
v_mfma_f32_16x16x32_bf16 v[176:179], a[148:151], a[52:55], v[176:179]
buffer_load_dwordx4 a[44:47], v2, s[40:43], s35 offen offset:3072 sc1
s_add_u32 s35, s35, 4096
v_mfma_f32_16x16x32_bf16 v[152:155], a[148:151], a[48:51], v[152:155]
ds_read_b64_tr_b16 a[188:189], v248 offset:0
v_mfma_f32_16x16x32_bf16 a[92:95], a[152:155], a[72:75], a[92:95]
s_waitcnt vmcnt(14) lgkmcnt(3)
v_mfma_f32_16x16x32_bf16 v[132:135], a[96:99], a[0:3], v[132:135]
ds_read_b128 a[128:131], v5 offset:30720
v_add_f32_dpp v48, v48, v48 row_ror:8 row_mask:0xf bank_mask:0xf
v_mfma_f32_16x16x32_bf16 v[156:159], a[96:99], a[4:7], v[156:159]
buffer_load_dwordx4 a[48:51], v2, s[40:43], s35 offen offset:0 sc1
v_mfma_f32_16x16x32_bf16 v[180:183], a[96:99], a[8:11], v[180:183]
ds_read_b128 a[132:135], v5 offset:31744
v_add_f32_dpp v49, v49, v49 row_ror:8 row_mask:0xf bank_mask:0xf
v_mfma_f32_16x16x32_bf16 v[204:207], a[96:99], a[12:15], v[204:207]
ds_read_b64_tr_b16 a[190:191], v248 offset:512
v_add_f32_dpp v50, v50, v50 row_ror:8 row_mask:0xf bank_mask:0xf
v_mfma_f32_16x16x32_bf16 v[208:211], a[100:103], a[12:15], v[208:211]
buffer_load_dwordx4 v[116:119], v1, s[4:7], s88 offen offset:2048 sc1
v_mfma_f32_16x16x32_bf16 v[184:187], a[100:103], a[8:11], v[184:187]
ds_read_b128 a[136:139], v5 offset:32768
v_add_f32_dpp v51, v51, v51 row_ror:8 row_mask:0xf bank_mask:0xf
v_mfma_f32_16x16x32_bf16 v[160:163], a[100:103], a[4:7], v[160:163]
ds_read_b128 a[140:143], v5 offset:33792
v_add_f32_dpp v52, v52, v52 row_ror:8 row_mask:0xf bank_mask:0xf
v_mfma_f32_16x16x32_bf16 v[136:139], a[100:103], a[0:3], v[136:139]
v_add_f32_dpp v53, v53, v53 row_ror:8 row_mask:0xf bank_mask:0xf
v_add_f32_dpp v54, v54, v54 row_ror:8 row_mask:0xf bank_mask:0xf
v_mfma_f32_16x16x32_bf16 v[140:143], a[104:107], a[0:3], v[140:143]
buffer_load_dwordx4 a[52:55], v2, s[40:43], s35 offen offset:1024 sc1
v_mfma_f32_16x16x32_bf16 v[164:167], a[104:107], a[4:7], v[164:167]
ds_read_b128 a[144:147], v5 offset:34816
v_add_f32_dpp v55, v55, v55 row_ror:8 row_mask:0xf bank_mask:0xf
v_mfma_f32_16x16x32_bf16 v[188:191], a[104:107], a[8:11], v[188:191]
ds_read_b64_tr_b16 a[192:193], v248 offset:4096
v_add_f32_dpp v48, v48, v48 row_ror:4 row_mask:0xf bank_mask:0xf
v_mfma_f32_16x16x32_bf16 v[212:215], a[104:107], a[12:15], v[212:215]
buffer_load_dwordx4 v[120:123], v1, s[4:7], s88 offen offset:3072 sc1
s_add_u32 s63, s28, 16
v_mfma_f32_16x16x32_bf16 v[216:219], a[108:111], a[12:15], v[216:219]
s_lshl_b32 s63, s63, 12
ds_read_b128 a[148:151], v5 offset:35840
v_mfma_f32_16x16x32_bf16 v[192:195], a[108:111], a[8:11], v[192:195]
ds_read_b128 a[152:155], v6 offset:27648
v_add_f32_dpp v49, v49, v49 row_ror:4 row_mask:0xf bank_mask:0xf
v_mfma_f32_16x16x32_bf16 v[168:171], a[108:111], a[4:7], v[168:171]
v_add_f32_dpp v50, v50, v50 row_ror:4 row_mask:0xf bank_mask:0xf
v_add_f32_dpp v51, v51, v51 row_ror:4 row_mask:0xf bank_mask:0xf
v_mfma_f32_16x16x32_bf16 v[144:147], a[108:111], a[0:3], v[144:147]
buffer_load_dwordx4 a[56:59], v2, s[40:43], s35 offen offset:2048 sc1
v_mfma_f32_16x16x32_bf16 v[148:151], a[112:115], a[0:3], v[148:151]
ds_read_b64_tr_b16 a[194:195], v248 offset:4608
v_add_f32_dpp v52, v52, v52 row_ror:4 row_mask:0xf bank_mask:0xf
v_mfma_f32_16x16x32_bf16 v[172:175], a[112:115], a[4:7], v[172:175]
v_add_f32_dpp v53, v53, v53 row_ror:4 row_mask:0xf bank_mask:0xf
v_add_f32_dpp v54, v54, v54 row_ror:4 row_mask:0xf bank_mask:0xf
v_mfma_f32_16x16x32_bf16 v[196:199], a[112:115], a[8:11], v[196:199]
buffer_load_dwordx4 a[68:71], v3, s[40:43], s63 offen sc1
s_add_u32 s88, s83, 0x200000
v_mfma_f32_16x16x32_bf16 v[220:223], a[112:115], a[12:15], v[220:223]
v_add_f32_dpp v55, v55, v55 row_ror:4 row_mask:0xf bank_mask:0xf
v_add_f32_dpp v48, v48, v48 row_ror:2 row_mask:0xf bank_mask:0xf
v_mfma_f32_16x16x32_bf16 v[224:227], a[116:119], a[12:15], v[224:227]
v_add_f32_dpp v49, v49, v49 row_ror:2 row_mask:0xf bank_mask:0xf
v_add_f32_dpp v50, v50, v50 row_ror:2 row_mask:0xf bank_mask:0xf
v_mfma_f32_16x16x32_bf16 v[200:203], a[116:119], a[8:11], v[200:203]
ds_read_b64_tr_b16 a[196:197], v249 offset:32
v_add_f32_dpp v51, v51, v51 row_ror:2 row_mask:0xf bank_mask:0xf
v_mfma_f32_16x16x32_bf16 v[176:179], a[116:119], a[4:7], v[176:179]
buffer_load_dwordx4 a[60:63], v2, s[40:43], s35 offen offset:3072 sc1
s_add_u32 s35, s35, 4096
v_mfma_f32_16x16x32_bf16 v[152:155], a[116:119], a[0:3], v[152:155]
v_add_f32_dpp v52, v52, v52 row_ror:2 row_mask:0xf bank_mask:0xf
v_add_f32_dpp v53, v53, v53 row_ror:2 row_mask:0xf bank_mask:0xf
v_mfma_f32_16x16x32_bf16 a[80:83], a[120:123], a[64:67], a[80:83]
v_add_f32_dpp v54, v54, v54 row_ror:2 row_mask:0xf bank_mask:0xf
s_waitcnt vmcnt(14) lgkmcnt(2)
v_mfma_f32_16x16x32_bf16 v[132:135], a[128:131], a[16:19], v[132:135]
ds_read_b128 a[96:99], v5 offset:36864
v_add_f32_dpp v55, v55, v55 row_ror:2 row_mask:0xf bank_mask:0xf
v_mfma_f32_16x16x32_bf16 v[156:159], a[128:131], a[20:23], v[156:159]
buffer_load_dwordx4 a[0:3], v2, s[40:43], s35 offen offset:0 sc1
v_mfma_f32_16x16x32_bf16 v[180:183], a[128:131], a[24:27], v[180:183]
ds_read_b128 a[100:103], v5 offset:37888
v_add_f32_dpp v48, v48, v48 row_ror:1 row_mask:0xf bank_mask:0xf
v_mfma_f32_16x16x32_bf16 v[204:207], a[128:131], a[28:31], v[204:207]
ds_read_b64_tr_b16 a[198:199], v249 offset:544
v_add_f32_dpp v49, v49, v49 row_ror:1 row_mask:0xf bank_mask:0xf
v_mfma_f32_16x16x32_bf16 v[208:211], a[132:135], a[28:31], v[208:211]
ds_read_b128 a[104:107], v5 offset:38912
v_add_f32_dpp v50, v50, v50 row_ror:1 row_mask:0xf bank_mask:0xf
v_mfma_f32_16x16x32_bf16 v[184:187], a[132:135], a[24:27], v[184:187]
buffer_load_dwordx4 v[124:127], v1, s[4:7], s88 offen offset:0 sc1
v_mfma_f32_16x16x32_bf16 v[160:163], a[132:135], a[20:23], v[160:163]
ds_read_b128 a[108:111], v5 offset:39936
v_add_f32_dpp v51, v51, v51 row_ror:1 row_mask:0xf bank_mask:0xf
v_mfma_f32_16x16x32_bf16 v[136:139], a[132:135], a[16:19], v[136:139]
ds_read_b64_tr_b16 a[200:201], v249 offset:4128
v_add_f32_dpp v52, v52, v52 row_ror:1 row_mask:0xf bank_mask:0xf
v_mfma_f32_16x16x32_bf16 v[140:143], a[136:139], a[16:19], v[140:143]
v_add_f32_dpp v53, v53, v53 row_ror:1 row_mask:0xf bank_mask:0xf
v_add_f32_dpp v54, v54, v54 row_ror:1 row_mask:0xf bank_mask:0xf
v_mfma_f32_16x16x32_bf16 v[164:167], a[136:139], a[20:23], v[164:167]
buffer_load_dwordx4 a[4:7], v2, s[40:43], s35 offen offset:1024 sc1
v_mfma_f32_16x16x32_bf16 v[188:191], a[136:139], a[24:27], v[188:191]
ds_read_b128 a[112:115], v5 offset:40960
v_add_f32_dpp v55, v55, v55 row_ror:1 row_mask:0xf bank_mask:0xf
v_mfma_f32_16x16x32_bf16 v[212:215], a[136:139], a[28:31], v[212:215]
ds_read_b128 a[116:119], v5 offset:41984
v_add_u32 v233, 159744, v233
v_mfma_f32_16x16x32_bf16 v[216:219], a[140:143], a[28:31], v[216:219]
s_lshl_b32 s36, s28, 6
s_lshl_b32 s37, s39, 6
v_mfma_f32_16x16x32_bf16 v[192:195], a[140:143], a[24:27], v[192:195]
buffer_load_dwordx4 a[8:11], v2, s[40:43], s35 offen offset:2048 sc1
v_mfma_f32_16x16x32_bf16 v[168:171], a[140:143], a[20:23], v[168:171]
ds_read_b128 a[120:123], v6 offset:28672
v_add_u32 v232, s36, v233
v_mfma_f32_16x16x32_bf16 v[144:147], a[140:143], a[16:19], v[144:147]
ds_read_b64_tr_b16 a[202:203], v249 offset:4640
v_add_u32 v235, s37, v233
v_mfma_f32_16x16x32_bf16 v[148:151], a[144:147], a[16:19], v[148:151]
v_mfma_f32_16x16x32_bf16 v[172:175], a[144:147], a[20:23], v[172:175]
buffer_load_dwordx4 v[128:131], v1, s[4:7], s88 offen offset:1024 sc1
s_add_u32 m0, s18, 0x0
v_mfma_f32_16x16x32_bf16 v[196:199], a[144:147], a[24:27], v[196:199]
s_add_u32 s44, s50, 0xe24000
v_mfma_f32_16x16x32_bf16 v[220:223], a[144:147], a[28:31], v[220:223]
ds_read_b64_tr_b16 a[204:205], v248 offset:8192
v_mfma_f32_16x16x32_bf16 v[224:227], a[148:151], a[28:31], v[224:227]
v_mfma_f32_16x16x32_bf16 v[200:203], a[148:151], a[24:27], v[200:203]
buffer_load_dwordx4 a[12:15], v2, s[40:43], s35 offen offset:3072 sc1
s_add_u32 s35, s35, 4096
v_mfma_f32_16x16x32_bf16 v[176:179], a[148:151], a[20:23], v[176:179]
v_mfma_f32_16x16x32_bf16 v[152:155], a[148:151], a[16:19], v[152:155]
v_mfma_f32_16x16x32_bf16 a[84:87], a[152:155], a[64:67], a[84:87]
ds_read_b64_tr_b16 a[206:207], v248 offset:8704
s_waitcnt vmcnt(13) lgkmcnt(3)
v_mfma_f32_16x16x32_bf16 v[132:135], a[96:99], a[32:35], v[132:135]
ds_read_b128 a[128:131], v5 offset:43008
v_mfma_f32_16x16x32_bf16 v[156:159], a[96:99], a[36:39], v[156:159]
buffer_load_dwordx4 a[16:19], v2, s[40:43], s35 offen offset:0 sc1
v_mfma_f32_16x16x32_bf16 v[180:183], a[96:99], a[40:43], v[180:183]
ds_read_b128 a[132:135], v5 offset:44032
v_mfma_f32_16x16x32_bf16 v[204:207], a[96:99], a[44:47], v[204:207]
ds_write_b128 v232, v[48:51]
v_mfma_f32_16x16x32_bf16 v[208:211], a[100:103], a[44:47], v[208:211]
ds_read_b128 a[136:139], v5 offset:45056
v_mfma_f32_16x16x32_bf16 v[184:187], a[100:103], a[40:43], v[184:187]
ds_read_b64_tr_b16 a[208:209], v248 offset:12288
v_mfma_f32_16x16x32_bf16 v[160:163], a[100:103], a[36:39], v[160:163]
ds_read_b128 a[140:143], v5 offset:46080
v_mfma_f32_16x16x32_bf16 v[136:139], a[100:103], a[32:35], v[136:139]
buffer_load_dwordx4 a[20:23], v2, s[40:43], s35 offen offset:1024 sc1
v_mfma_f32_16x16x32_bf16 v[140:143], a[104:107], a[32:35], v[140:143]
ds_write_b128 v235, v[52:55]
v_mfma_f32_16x16x32_bf16 v[164:167], a[104:107], a[36:39], v[164:167]
ds_read_b128 a[144:147], v5 offset:47104
v_mfma_f32_16x16x32_bf16 v[188:191], a[104:107], a[40:43], v[188:191]
v_mfma_f32_16x16x32_bf16 v[212:215], a[104:107], a[44:47], v[212:215]
ds_read_b128 a[148:151], v5 offset:48128
v_mfma_f32_16x16x32_bf16 v[216:219], a[108:111], a[44:47], v[216:219]
ds_read_b64_tr_b16 a[210:211], v248 offset:12800
v_mfma_f32_16x16x32_bf16 v[192:195], a[108:111], a[40:43], v[192:195]
buffer_load_dwordx4 a[24:27], v2, s[40:43], s35 offen offset:2048 sc1
v_mfma_f32_16x16x32_bf16 v[168:171], a[108:111], a[36:39], v[168:171]
ds_read_b128 a[152:155], v6 offset:29696
v_mfma_f32_16x16x32_bf16 v[144:147], a[108:111], a[32:35], v[144:147]
v_mfma_f32_16x16x32_bf16 v[148:151], a[112:115], a[32:35], v[148:151]
v_mfma_f32_16x16x32_bf16 v[172:175], a[112:115], a[36:39], v[172:175]
v_mfma_f32_16x16x32_bf16 v[196:199], a[112:115], a[40:43], v[196:199]
v_mfma_f32_16x16x32_bf16 v[220:223], a[112:115], a[44:47], v[220:223]
buffer_load_dwordx4 a[28:31], v2, s[40:43], s35 offen offset:3072 sc1
s_add_u32 s35, s35, 4096
v_mfma_f32_16x16x32_bf16 v[224:227], a[116:119], a[44:47], v[224:227]
v_mfma_f32_16x16x32_bf16 v[200:203], a[116:119], a[40:43], v[200:203]
v_mfma_f32_16x16x32_bf16 v[176:179], a[116:119], a[36:39], v[176:179]
v_mfma_f32_16x16x32_bf16 v[152:155], a[116:119], a[32:35], v[152:155]
v_mfma_f32_16x16x32_bf16 a[88:91], a[120:123], a[64:67], a[88:91]
s_waitcnt vmcnt(10) lgkmcnt(0)
s_barrier
v_mfma_f32_16x16x32_bf16 v[132:135], a[128:131], a[48:51], v[132:135]
v_add_u32 v5, 98304, v1
v_add_u32 v6, s55, v5
v_mfma_f32_16x16x32_bf16 v[156:159], a[128:131], a[52:55], v[156:159]
buffer_load_dwordx4 a[32:35], v2, s[40:43], s35 offen offset:0 sc1
v_mfma_f32_16x16x32_bf16 v[180:183], a[128:131], a[56:59], v[180:183]
ds_read_b128 a[96:99], v5 offset:0
v_mfma_f32_16x16x32_bf16 v[204:207], a[128:131], a[60:63], v[204:207]
ds_read_b128 a[100:103], v5 offset:1024
v_mfma_f32_16x16x32_bf16 v[208:211], a[132:135], a[60:63], v[208:211]
buffer_load_dwordx4 v1, s[4:7], s44 offen offset:0 sc1 lds
v_mfma_f32_16x16x32_bf16 v[184:187], a[132:135], a[56:59], v[184:187]
ds_read_b128 a[104:107], v5 offset:2048
v_mfma_f32_16x16x32_bf16 v[160:163], a[132:135], a[52:55], v[160:163]
ds_read_b128 a[108:111], v5 offset:3072
v_mfma_f32_16x16x32_bf16 v[136:139], a[132:135], a[48:51], v[136:139]
ds_read_b128 v[48:51], v233 offset:0
v_mfma_f32_16x16x32_bf16 v[140:143], a[136:139], a[48:51], v[140:143]
buffer_load_dwordx4 a[36:39], v2, s[40:43], s35 offen offset:1024 sc1
v_mfma_f32_16x16x32_bf16 v[164:167], a[136:139], a[52:55], v[164:167]
ds_read_b128 a[112:115], v5 offset:4096
v_mfma_f32_16x16x32_bf16 v[188:191], a[136:139], a[56:59], v[188:191]
ds_read_b128 v[52:55], v233 offset:64
v_mfma_f32_16x16x32_bf16 v[212:215], a[136:139], a[60:63], v[212:215]
buffer_load_dwordx4 v1, s[4:7], s44 offen offset:1024 sc1 lds
v_mfma_f32_16x16x32_bf16 v[216:219], a[140:143], a[60:63], v[216:219]
ds_read_b128 a[116:119], v5 offset:5120
v_mfma_f32_16x16x32_bf16 v[192:195], a[140:143], a[56:59], v[192:195]
ds_read_b128 a[120:123], v6 offset:2048
v_mfma_f32_16x16x32_bf16 v[168:171], a[140:143], a[52:55], v[168:171]
v_mfma_f32_16x16x32_bf16 v[144:147], a[140:143], a[48:51], v[144:147]
buffer_load_dwordx4 a[40:43], v2, s[40:43], s35 offen offset:2048 sc1
v_mfma_f32_16x16x32_bf16 v[148:151], a[144:147], a[48:51], v[148:151]
v_mfma_f32_16x16x32_bf16 v[172:175], a[144:147], a[52:55], v[172:175]
v_mfma_f32_16x16x32_bf16 v[196:199], a[144:147], a[56:59], v[196:199]
buffer_load_dwordx4 v1, s[4:7], s44 offen offset:2048 sc1 lds
s_add_u32 m0, s18, 0x3000
v_mfma_f32_16x16x32_bf16 v[220:223], a[144:147], a[60:63], v[220:223]
s_add_u32 s44, s50, 0xe27000
ds_read_b128 v[56:59], v233 offset:128
v_mfma_f32_16x16x32_bf16 v[224:227], a[148:151], a[60:63], v[224:227]
v_mfma_f32_16x16x32_bf16 v[200:203], a[148:151], a[56:59], v[200:203]
v_mfma_f32_16x16x32_bf16 v[176:179], a[148:151], a[52:55], v[176:179]
buffer_load_dwordx4 a[44:47], v2, s[40:43], s35 offen offset:3072 sc1
s_add_u32 s35, s35, 4096
v_mfma_f32_16x16x32_bf16 v[152:155], a[148:151], a[48:51], v[152:155]
v_mfma_f32_16x16x32_bf16 a[92:95], a[152:155], a[64:67], a[92:95]
s_waitcnt vmcnt(11) lgkmcnt(1)
v_mfma_f32_16x16x32_bf16 v[132:135], a[96:99], a[0:3], v[132:135]
ds_read_b128 a[128:131], v5 offset:6144
v_mfma_f32_16x16x32_bf16 v[156:159], a[96:99], a[4:7], v[156:159]
buffer_load_dwordx4 a[48:51], v2, s[40:43], s35 offen offset:0 sc1
v_mfma_f32_16x16x32_bf16 v[180:183], a[96:99], a[8:11], v[180:183]
ds_read_b128 a[132:135], v5 offset:7168
v_mfma_f32_16x16x32_bf16 v[204:207], a[96:99], a[12:15], v[204:207]
v_mfma_f32_16x16x32_bf16 v[236:239], a[188:191], v[16:19], 0
v_mfma_f32_16x16x32_bf16 v[208:211], a[100:103], a[12:15], v[208:211]
buffer_load_dwordx4 v1, s[4:7], s44 offen offset:0 sc1 lds
v_mfma_f32_16x16x32_bf16 v[184:187], a[100:103], a[8:11], v[184:187]
ds_read_b128 a[136:139], v5 offset:8192
v_mfma_f32_16x16x32_bf16 v[160:163], a[100:103], a[4:7], v[160:163]
ds_read_b128 a[140:143], v5 offset:9216
v_mfma_f32_16x16x32_bf16 v[136:139], a[100:103], a[0:3], v[136:139]
v_mfma_f32_16x16x32_bf16 v[240:243], a[196:199], v[16:19], 0
v_mfma_f32_16x16x32_bf16 v[140:143], a[104:107], a[0:3], v[140:143]
buffer_load_dwordx4 a[52:55], v2, s[40:43], s35 offen offset:1024 sc1
v_mfma_f32_16x16x32_bf16 v[164:167], a[104:107], a[4:7], v[164:167]
ds_read_b128 a[144:147], v5 offset:10240
v_mfma_f32_16x16x32_bf16 v[188:191], a[104:107], a[8:11], v[188:191]
v_mfma_f32_16x16x32_bf16 v[244:247], a[204:207], v[16:19], 0
v_mfma_f32_16x16x32_bf16 v[212:215], a[104:107], a[12:15], v[212:215]
buffer_load_dwordx4 v1, s[4:7], s44 offen offset:1024 sc1 lds
s_add_u32 s63, s28, 20
v_mfma_f32_16x16x32_bf16 v[216:219], a[108:111], a[12:15], v[216:219]
s_lshl_b32 s63, s63, 12
ds_read_b128 a[148:151], v5 offset:11264
v_mfma_f32_16x16x32_bf16 v[192:195], a[108:111], a[8:11], v[192:195]
ds_read_b128 a[152:155], v6 offset:3072
v_mfma_f32_16x16x32_bf16 v[168:171], a[108:111], a[4:7], v[168:171]
v_mfma_f32_16x16x32_bf16 v[236:239], a[192:195], v[16:19], v[236:239]
v_mfma_f32_16x16x32_bf16 v[144:147], a[108:111], a[0:3], v[144:147]
buffer_load_dwordx4 a[56:59], v2, s[40:43], s35 offen offset:2048 sc1
v_mfma_f32_16x16x32_bf16 v[148:151], a[112:115], a[0:3], v[148:151]
v_mfma_f32_16x16x32_bf16 v[240:243], a[200:203], v[16:19], v[240:243]
v_mfma_f32_16x16x32_bf16 v[172:175], a[112:115], a[4:7], v[172:175]
ds_read_b128 v[60:63], v233 offset:192
v_mfma_f32_16x16x32_bf16 v[196:199], a[112:115], a[8:11], v[196:199]
buffer_load_dwordx4 a[72:75], v3, s[40:43], s63 offen sc1
v_mfma_f32_16x16x32_bf16 v[220:223], a[112:115], a[12:15], v[220:223]
ds_read_b128 v[64:67], v233 offset:256
v_mfma_f32_16x16x32_bf16 v[224:227], a[116:119], a[12:15], v[224:227]
v_mfma_f32_16x16x32_bf16 v[244:247], a[208:211], v[16:19], v[244:247]
v_mfma_f32_16x16x32_bf16 v[200:203], a[116:119], a[8:11], v[200:203]
v_mfma_f32_16x16x32_bf16 v[176:179], a[116:119], a[4:7], v[176:179]
buffer_load_dwordx4 a[60:63], v2, s[40:43], s35 offen offset:3072 sc1
s_add_u32 s35, s35, 4096
v_mfma_f32_16x16x32_bf16 v[152:155], a[116:119], a[0:3], v[152:155]
ds_read_b128 v[68:71], v233 offset:320
v_mfma_f32_16x16x32_bf16 a[80:83], a[120:123], a[68:71], a[80:83]
s_waitcnt vmcnt(14) lgkmcnt(3)
v_mfma_f32_16x16x32_bf16 v[132:135], a[128:131], a[16:19], v[132:135]
ds_read_b128 a[96:99], v5 offset:12288
v_mfma_f32_16x16x32_bf16 v[156:159], a[128:131], a[20:23], v[156:159]
buffer_load_dwordx4 a[0:3], v2, s[40:43], s35 offen offset:0 sc1
v_mfma_f32_16x16x32_bf16 v[180:183], a[128:131], a[24:27], v[180:183]
ds_read_b128 a[100:103], v5 offset:13312
v_mfma_f32_16x16x32_bf16 v[204:207], a[128:131], a[28:31], v[204:207]
v_mfma_f32_16x16x32_bf16 v[208:211], a[132:135], a[28:31], v[208:211]
buffer_load_dwordx4 v1, s[4:7], s44 offen offset:2048 sc1 lds
s_add_u32 m0, s18, 0x6000
v_mfma_f32_16x16x32_bf16 v[184:187], a[132:135], a[24:27], v[184:187]
s_add_u32 s44, s50, 0xe2a000
ds_read_b128 a[104:107], v5 offset:14336
v_mfma_f32_16x16x32_bf16 v[160:163], a[132:135], a[20:23], v[160:163]
ds_read_b128 a[108:111], v5 offset:15360
v_mfma_f32_16x16x32_bf16 v[136:139], a[132:135], a[16:19], v[136:139]
ds_read_b128 v[72:75], v232 offset:128
v_mfma_f32_16x16x32_bf16 v[140:143], a[136:139], a[16:19], v[140:143]
buffer_load_dwordx4 a[4:7], v2, s[40:43], s35 offen offset:1024 sc1
v_mfma_f32_16x16x32_bf16 v[164:167], a[136:139], a[20:23], v[164:167]
ds_read_b128 a[112:115], v5 offset:16384
v_mfma_f32_16x16x32_bf16 v[188:191], a[136:139], a[24:27], v[188:191]
v_mfma_f32_16x16x32_bf16 v[212:215], a[136:139], a[28:31], v[212:215]
buffer_load_dwordx4 v1, s[4:7], s44 offen offset:0 sc1 lds
v_mfma_f32_16x16x32_bf16 v[216:219], a[140:143], a[28:31], v[216:219]
ds_read_b128 a[116:119], v5 offset:17408
v_mfma_f32_16x16x32_bf16 v[192:195], a[140:143], a[24:27], v[192:195]
ds_read_b128 a[120:123], v6 offset:4096
v_mfma_f32_16x16x32_bf16 v[168:171], a[140:143], a[20:23], v[168:171]
v_mfma_f32_16x16x32_bf16 v[144:147], a[140:143], a[16:19], v[144:147]
buffer_load_dwordx4 a[8:11], v2, s[40:43], s35 offen offset:2048 sc1
v_mfma_f32_16x16x32_bf16 v[148:151], a[144:147], a[16:19], v[148:151]
v_mfma_f32_16x16x32_bf16 v[172:175], a[144:147], a[20:23], v[172:175]
v_mfma_f32_16x16x32_bf16 v[196:199], a[144:147], a[24:27], v[196:199]
buffer_load_dwordx4 v1, s[4:7], s44 offen offset:1024 sc1 lds
v_mfma_f32_16x16x32_bf16 v[220:223], a[144:147], a[28:31], v[220:223]
v_mfma_f32_16x16x32_bf16 v[224:227], a[148:151], a[28:31], v[224:227]
v_mfma_f32_16x16x32_bf16 v[200:203], a[148:151], a[24:27], v[200:203]
v_mfma_f32_16x16x32_bf16 v[176:179], a[148:151], a[20:23], v[176:179]
buffer_load_dwordx4 a[12:15], v2, s[40:43], s35 offen offset:3072 sc1
s_add_u32 s35, s35, 4096
v_mfma_f32_16x16x32_bf16 v[152:155], a[148:151], a[16:19], v[152:155]
v_mfma_f32_16x16x32_bf16 a[84:87], a[152:155], a[68:71], a[84:87]
s_waitcnt vmcnt(14) lgkmcnt(0)
v_mfma_f32_16x16x32_bf16 v[132:135], a[96:99], a[32:35], v[132:135]
ds_read_b128 a[128:131], v5 offset:18432
v_mfma_f32_16x16x32_bf16 v[156:159], a[96:99], a[36:39], v[156:159]
buffer_load_dwordx4 a[16:19], v2, s[40:43], s35 offen offset:0 sc1
v_mfma_f32_16x16x32_bf16 v[180:183], a[96:99], a[40:43], v[180:183]
ds_read_b128 a[132:135], v5 offset:19456
v_mfma_f32_16x16x32_bf16 v[204:207], a[96:99], a[44:47], v[204:207]
v_mfma_f32_16x16x32_bf16 v[208:211], a[100:103], a[44:47], v[208:211]
buffer_load_dwordx4 v1, s[4:7], s44 offen offset:2048 sc1 lds
s_add_u32 m0, s18, 0x9000
v_mfma_f32_16x16x32_bf16 v[184:187], a[100:103], a[40:43], v[184:187]
s_add_u32 s44, s50, 0xe2d000
ds_read_b128 a[136:139], v5 offset:20480
v_mfma_f32_16x16x32_bf16 v[160:163], a[100:103], a[36:39], v[160:163]
ds_read_b128 a[140:143], v5 offset:21504
v_mfma_f32_16x16x32_bf16 v[136:139], a[100:103], a[32:35], v[136:139]
v_mfma_f32_16x16x32_bf16 v[140:143], a[104:107], a[32:35], v[140:143]
buffer_load_dwordx4 a[20:23], v2, s[40:43], s35 offen offset:1024 sc1
v_mfma_f32_16x16x32_bf16 v[164:167], a[104:107], a[36:39], v[164:167]
ds_read_b128 a[144:147], v5 offset:22528
v_mfma_f32_16x16x32_bf16 v[188:191], a[104:107], a[40:43], v[188:191]
v_mfma_f32_16x16x32_bf16 v[212:215], a[104:107], a[44:47], v[212:215]
buffer_load_dwordx4 v1, s[4:7], s44 offen offset:0 sc1 lds
v_mfma_f32_16x16x32_bf16 v[216:219], a[108:111], a[44:47], v[216:219]
ds_read_b128 a[148:151], v5 offset:23552
v_mfma_f32_16x16x32_bf16 v[192:195], a[108:111], a[40:43], v[192:195]
ds_read_b128 a[152:155], v6 offset:5120
v_mfma_f32_16x16x32_bf16 v[168:171], a[108:111], a[36:39], v[168:171]
v_mfma_f32_16x16x32_bf16 v[144:147], a[108:111], a[32:35], v[144:147]
buffer_load_dwordx4 a[24:27], v2, s[40:43], s35 offen offset:2048 sc1
v_mfma_f32_16x16x32_bf16 v[148:151], a[112:115], a[32:35], v[148:151]
v_mfma_f32_16x16x32_bf16 v[172:175], a[112:115], a[36:39], v[172:175]
v_mfma_f32_16x16x32_bf16 v[196:199], a[112:115], a[40:43], v[196:199]
buffer_load_dwordx4 v1, s[4:7], s44 offen offset:1024 sc1 lds
v_mfma_f32_16x16x32_bf16 v[220:223], a[112:115], a[44:47], v[220:223]
v_mfma_f32_16x16x32_bf16 v[224:227], a[116:119], a[44:47], v[224:227]
v_mfma_f32_16x16x32_bf16 v[200:203], a[116:119], a[40:43], v[200:203]
v_mfma_f32_16x16x32_bf16 v[176:179], a[116:119], a[36:39], v[176:179]
buffer_load_dwordx4 a[28:31], v2, s[40:43], s35 offen offset:3072 sc1
s_add_u32 s35, s35, 4096
v_mfma_f32_16x16x32_bf16 v[152:155], a[116:119], a[32:35], v[152:155]
v_mfma_f32_16x16x32_bf16 a[88:91], a[120:123], a[68:71], a[88:91]
s_waitcnt vmcnt(14) lgkmcnt(0)
s_barrier
v_mfma_f32_16x16x32_bf16 v[132:135], a[128:131], a[48:51], v[132:135]
ds_read_b128 a[96:99], v5 offset:24576
v_accvgpr_write_b32 a160, v48
v_mfma_f32_16x16x32_bf16 v[156:159], a[128:131], a[52:55], v[156:159]
buffer_load_dwordx4 a[32:35], v2, s[40:43], s35 offen offset:0 sc1
v_mfma_f32_16x16x32_bf16 v[180:183], a[128:131], a[56:59], v[180:183]
ds_read_b128 a[100:103], v5 offset:25600
v_accvgpr_write_b32 a161, v49
v_mfma_f32_16x16x32_bf16 v[204:207], a[128:131], a[60:63], v[204:207]
v_mfma_f32_16x16x32_bf16 v[208:211], a[132:135], a[60:63], v[208:211]
buffer_load_dwordx4 v1, s[4:7], s44 offen offset:2048 sc1 lds
v_mfma_f32_16x16x32_bf16 v[184:187], a[132:135], a[56:59], v[184:187]
ds_read_b128 a[104:107], v5 offset:26624
v_accvgpr_write_b32 a162, v50
v_mfma_f32_16x16x32_bf16 v[160:163], a[132:135], a[52:55], v[160:163]
ds_read_b128 a[108:111], v5 offset:27648
v_mfma_f32_16x16x32_bf16 v[136:139], a[132:135], a[48:51], v[136:139]
v_mfma_f32_16x16x32_bf16 v[140:143], a[136:139], a[48:51], v[140:143]
buffer_load_dwordx4 a[36:39], v2, s[40:43], s35 offen offset:1024 sc1
v_mfma_f32_16x16x32_bf16 v[164:167], a[136:139], a[52:55], v[164:167]
ds_read_b128 a[112:115], v5 offset:28672
v_accvgpr_write_b32 a163, v51
v_mfma_f32_16x16x32_bf16 v[188:191], a[136:139], a[56:59], v[188:191]
v_accvgpr_write_b32 a164, v52
v_mfma_f32_16x16x32_bf16 v[212:215], a[136:139], a[60:63], v[212:215]
buffer_load_dwordx4 a[40:43], v2, s[40:43], s35 offen offset:2048 sc1
v_mfma_f32_16x16x32_bf16 v[216:219], a[140:143], a[60:63], v[216:219]
ds_read_b128 a[116:119], v5 offset:29696
v_mfma_f32_16x16x32_bf16 v[192:195], a[140:143], a[56:59], v[192:195]
ds_read_b128 a[120:123], v6 offset:26624
v_accvgpr_write_b32 a165, v53
v_mfma_f32_16x16x32_bf16 v[168:171], a[140:143], a[52:55], v[168:171]
v_mfma_f32_16x16x32_bf16 v[144:147], a[140:143], a[48:51], v[144:147]
buffer_store_dwordx4 a[220:223], v1, s[4:7], s101 offen offset:0 sc1
v_mfma_f32_16x16x32_bf16 v[148:151], a[144:147], a[48:51], v[148:151]
v_accvgpr_write_b32 a166, v54
v_mfma_f32_16x16x32_bf16 v[172:175], a[144:147], a[52:55], v[172:175]
v_mfma_f32_16x16x32_bf16 v[196:199], a[144:147], a[56:59], v[196:199]
v_accvgpr_write_b32 a167, v55
v_mfma_f32_16x16x32_bf16 v[220:223], a[144:147], a[60:63], v[220:223]
L_stub1:
s_cbranch_execz L_stub2
v_mfma_f32_16x16x32_bf16 v[224:227], a[148:151], a[60:63], v[224:227]
v_mfma_f32_16x16x32_bf16 v[200:203], a[148:151], a[56:59], v[200:203]
v_accvgpr_write_b32 a168, v56
v_mfma_f32_16x16x32_bf16 v[176:179], a[148:151], a[52:55], v[176:179]
buffer_load_dwordx4 a[44:47], v2, s[40:43], s35 offen offset:3072 sc1
s_add_u32 s35, s35, 4096
v_mfma_f32_16x16x32_bf16 v[152:155], a[148:151], a[48:51], v[152:155]
v_mfma_f32_16x16x32_bf16 a[92:95], a[152:155], a[68:71], a[92:95]
v_accvgpr_write_b32 a169, v57
s_waitcnt vmcnt(13) lgkmcnt(0)
v_mfma_f32_16x16x32_bf16 v[132:135], a[96:99], a[0:3], v[132:135]
ds_read_b128 a[128:131], v5 offset:30720
v_mfma_f32_16x16x32_bf16 v[156:159], a[96:99], a[4:7], v[156:159]
buffer_load_dwordx4 a[48:51], v2, s[40:43], s35 offen offset:0 sc1
v_mfma_f32_16x16x32_bf16 v[180:183], a[96:99], a[8:11], v[180:183]
ds_read_b128 a[132:135], v5 offset:31744
v_accvgpr_write_b32 a170, v58
v_mfma_f32_16x16x32_bf16 v[204:207], a[96:99], a[12:15], v[204:207]
v_mfma_f32_16x16x32_bf16 v[208:211], a[100:103], a[12:15], v[208:211]
buffer_store_dwordx4 a[224:227], v1, s[4:7], s101 offen offset:1024 sc1
s_add_u32 s63, s28, 24
v_mfma_f32_16x16x32_bf16 v[184:187], a[100:103], a[8:11], v[184:187]
s_lshl_b32 s63, s63, 12
ds_read_b128 a[136:139], v5 offset:32768
v_mfma_f32_16x16x32_bf16 v[160:163], a[100:103], a[4:7], v[160:163]
ds_read_b128 a[140:143], v5 offset:33792
v_accvgpr_write_b32 a171, v59
v_mfma_f32_16x16x32_bf16 v[136:139], a[100:103], a[0:3], v[136:139]
v_accvgpr_write_b32 a172, v60
v_mfma_f32_16x16x32_bf16 v[140:143], a[104:107], a[0:3], v[140:143]
v_mfma_f32_16x16x32_bf16 v[164:167], a[104:107], a[4:7], v[164:167]
ds_read_b128 a[144:147], v5 offset:34816
v_accvgpr_write_b32 a173, v61
v_mfma_f32_16x16x32_bf16 v[188:191], a[104:107], a[8:11], v[188:191]
v_mfma_f32_16x16x32_bf16 v[212:215], a[104:107], a[12:15], v[212:215]
buffer_load_dwordx4 a[52:55], v2, s[40:43], s35 offen offset:1024 sc1
v_mfma_f32_16x16x32_bf16 v[216:219], a[108:111], a[12:15], v[216:219]
ds_read_b128 a[148:151], v5 offset:35840
v_accvgpr_write_b32 a174, v62
v_mfma_f32_16x16x32_bf16 v[192:195], a[108:111], a[8:11], v[192:195]
ds_read_b128 a[152:155], v6 offset:27648
v_mfma_f32_16x16x32_bf16 v[168:171], a[108:111], a[4:7], v[168:171]
v_mfma_f32_16x16x32_bf16 v[144:147], a[108:111], a[0:3], v[144:147]
buffer_load_dwordx4 a[56:59], v2, s[40:43], s35 offen offset:2048 sc1
v_mfma_f32_16x16x32_bf16 v[148:151], a[112:115], a[0:3], v[148:151]
v_accvgpr_write_b32 a175, v63
v_mfma_f32_16x16x32_bf16 v[172:175], a[112:115], a[4:7], v[172:175]
v_accvgpr_write_b32 a176, v64
v_mfma_f32_16x16x32_bf16 v[196:199], a[112:115], a[8:11], v[196:199]
buffer_load_dwordx4 a[64:67], v3, s[40:43], s63 offen sc1
v_mfma_f32_16x16x32_bf16 v[220:223], a[112:115], a[12:15], v[220:223]
v_mfma_f32_16x16x32_bf16 v[224:227], a[116:119], a[12:15], v[224:227]
v_accvgpr_write_b32 a177, v65
v_mfma_f32_16x16x32_bf16 v[200:203], a[116:119], a[8:11], v[200:203]
v_mfma_f32_16x16x32_bf16 v[176:179], a[116:119], a[4:7], v[176:179]
buffer_load_dwordx4 a[60:63], v2, s[40:43], s35 offen offset:3072 sc1
s_add_u32 s35, s35, 4096
v_mfma_f32_16x16x32_bf16 v[152:155], a[116:119], a[0:3], v[152:155]
v_accvgpr_write_b32 a178, v66
v_mfma_f32_16x16x32_bf16 a[80:83], a[120:123], a[72:75], a[80:83]
s_waitcnt vmcnt(12) lgkmcnt(0)
v_mfma_f32_16x16x32_bf16 v[132:135], a[128:131], a[16:19], v[132:135]
ds_read_b128 a[96:99], v5 offset:36864
v_accvgpr_write_b32 a179, v67
v_mfma_f32_16x16x32_bf16 v[156:159], a[128:131], a[20:23], v[156:159]
buffer_load_dwordx4 a[0:3], v2, s[40:43], s35 offen offset:0 sc1
v_mfma_f32_16x16x32_bf16 v[180:183], a[128:131], a[24:27], v[180:183]
ds_read_b128 a[100:103], v5 offset:37888
v_mfma_f32_16x16x32_bf16 v[204:207], a[128:131], a[28:31], v[204:207]
v_accvgpr_write_b32 a180, v68
v_mfma_f32_16x16x32_bf16 v[208:211], a[132:135], a[28:31], v[208:211]
buffer_store_dwordx4 a[188:191], v1, s[4:7], s96 offen offset:0 sc1
s_add_u32 s63, s28, 28
v_mfma_f32_16x16x32_bf16 v[184:187], a[132:135], a[24:27], v[184:187]
s_lshl_b32 s63, s63, 12
ds_read_b128 a[104:107], v5 offset:38912
v_mfma_f32_16x16x32_bf16 v[160:163], a[132:135], a[20:23], v[160:163]
ds_read_b128 a[108:111], v5 offset:39936
v_accvgpr_write_b32 a181, v69
v_mfma_f32_16x16x32_bf16 v[136:139], a[132:135], a[16:19], v[136:139]
v_mfma_f32_16x16x32_bf16 v[140:143], a[136:139], a[16:19], v[140:143]
v_accvgpr_write_b32 a182, v70
v_mfma_f32_16x16x32_bf16 v[164:167], a[136:139], a[20:23], v[164:167]
ds_read_b128 a[112:115], v5 offset:40960
v_mfma_f32_16x16x32_bf16 v[188:191], a[136:139], a[24:27], v[188:191]
v_mfma_f32_16x16x32_bf16 v[212:215], a[136:139], a[28:31], v[212:215]
buffer_load_dwordx4 a[4:7], v2, s[40:43], s35 offen offset:1024 sc1
v_mfma_f32_16x16x32_bf16 v[216:219], a[140:143], a[28:31], v[216:219]
ds_read_b128 a[116:119], v5 offset:41984
v_accvgpr_write_b32 a183, v71
v_mfma_f32_16x16x32_bf16 v[192:195], a[140:143], a[24:27], v[192:195]
ds_read_b128 a[120:123], v6 offset:28672
v_mfma_f32_16x16x32_bf16 v[168:171], a[140:143], a[20:23], v[168:171]
v_accvgpr_write_b32 a184, v72
v_mfma_f32_16x16x32_bf16 v[144:147], a[140:143], a[16:19], v[144:147]
buffer_load_dwordx4 a[8:11], v2, s[40:43], s35 offen offset:2048 sc1
v_mfma_f32_16x16x32_bf16 v[148:151], a[144:147], a[16:19], v[148:151]
v_accvgpr_write_b32 a185, v73
v_mfma_f32_16x16x32_bf16 v[172:175], a[144:147], a[20:23], v[172:175]
v_mfma_f32_16x16x32_bf16 v[196:199], a[144:147], a[24:27], v[196:199]
buffer_load_dwordx4 a[68:71], v3, s[40:43], s63 offen sc1
v_mfma_f32_16x16x32_bf16 v[220:223], a[144:147], a[28:31], v[220:223]
v_accvgpr_write_b32 a186, v74
v_mfma_f32_16x16x32_bf16 v[224:227], a[148:151], a[28:31], v[224:227]
v_mfma_f32_16x16x32_bf16 v[200:203], a[148:151], a[24:27], v[200:203]
v_mfma_f32_16x16x32_bf16 v[176:179], a[148:151], a[20:23], v[176:179]
buffer_load_dwordx4 a[12:15], v2, s[40:43], s35 offen offset:3072 sc1
s_add_u32 s35, s35, 4096
v_mfma_f32_16x16x32_bf16 v[152:155], a[148:151], a[16:19], v[152:155]
v_accvgpr_write_b32 a187, v75
v_mfma_f32_16x16x32_bf16 a[84:87], a[152:155], a[72:75], a[84:87]
s_waitcnt vmcnt(12) lgkmcnt(0)
v_mfma_f32_16x16x32_bf16 v[132:135], a[96:99], a[32:35], v[132:135]
ds_read_b128 a[128:131], v5 offset:43008
v_add_f32 v92, v92, v96
v_mfma_f32_16x16x32_bf16 v[156:159], a[96:99], a[36:39], v[156:159]
buffer_load_dwordx4 a[16:19], v2, s[40:43], s35 offen offset:0 sc1
v_mfma_f32_16x16x32_bf16 v[180:183], a[96:99], a[40:43], v[180:183]
ds_read_b128 a[132:135], v5 offset:44032
v_add_f32 v100, v100, v104
v_mfma_f32_16x16x32_bf16 v[204:207], a[96:99], a[44:47], v[204:207]
v_add_f32 v108, v108, v112
v_add_f32 v116, v116, v120
v_mfma_f32_16x16x32_bf16 v[208:211], a[100:103], a[44:47], v[208:211]
ds_read_b128 a[136:139], v5 offset:45056
v_add_f32 v124, v124, v128
v_mfma_f32_16x16x32_bf16 v[184:187], a[100:103], a[40:43], v[184:187]
buffer_load_dwordx4 a[20:23], v2, s[40:43], s35 offen offset:1024 sc1
v_mfma_f32_16x16x32_bf16 v[160:163], a[100:103], a[36:39], v[160:163]
ds_read_b128 a[140:143], v5 offset:46080
v_add_f32 v93, v93, v97
v_mfma_f32_16x16x32_bf16 v[136:139], a[100:103], a[32:35], v[136:139]
v_add_f32 v101, v101, v105
v_add_f32 v109, v109, v113
v_mfma_f32_16x16x32_bf16 v[140:143], a[104:107], a[32:35], v[140:143]
v_add_f32 v117, v117, v121
v_add_f32 v125, v125, v129
v_mfma_f32_16x16x32_bf16 v[164:167], a[104:107], a[36:39], v[164:167]
buffer_store_dwordx4 a[192:195], v1, s[4:7], s97 offen offset:0 sc1
v_mfma_f32_16x16x32_bf16 v[188:191], a[104:107], a[40:43], v[188:191]
ds_read_b128 a[144:147], v5 offset:47104
v_add_f32 v94, v94, v98
v_mfma_f32_16x16x32_bf16 v[212:215], a[104:107], a[44:47], v[212:215]
ds_read_b128 a[148:151], v5 offset:48128
v_add_f32 v102, v102, v106
v_mfma_f32_16x16x32_bf16 v[216:219], a[108:111], a[44:47], v[216:219]
v_add_f32 v110, v110, v114
v_add_f32 v118, v118, v122
v_mfma_f32_16x16x32_bf16 v[192:195], a[108:111], a[40:43], v[192:195]
ds_read_b128 a[152:155], v6 offset:29696
v_add_f32 v126, v126, v130
v_mfma_f32_16x16x32_bf16 v[168:171], a[108:111], a[36:39], v[168:171]
v_add_f32 v95, v95, v99
v_add_f32 v103, v103, v107
v_mfma_f32_16x16x32_bf16 v[144:147], a[108:111], a[32:35], v[144:147]
v_add_f32 v111, v111, v115
v_add_f32 v119, v119, v123
v_mfma_f32_16x16x32_bf16 v[148:151], a[112:115], a[32:35], v[148:151]
v_add_f32 v127, v127, v131
v_add_f32_dpp v92, v92, v92 row_ror:8 row_mask:0xf bank_mask:0xf
v_mfma_f32_16x16x32_bf16 v[172:175], a[112:115], a[36:39], v[172:175]
buffer_load_dwordx4 a[24:27], v2, s[40:43], s35 offen offset:2048 sc1
v_mfma_f32_16x16x32_bf16 v[196:199], a[112:115], a[40:43], v[196:199]
v_add_f32_dpp v100, v100, v100 row_ror:8 row_mask:0xf bank_mask:0xf
v_add_f32_dpp v108, v108, v108 row_ror:8 row_mask:0xf bank_mask:0xf
v_mfma_f32_16x16x32_bf16 v[220:223], a[112:115], a[44:47], v[220:223]
v_add_f32_dpp v116, v116, v116 row_ror:8 row_mask:0xf bank_mask:0xf
v_add_f32_dpp v124, v124, v124 row_ror:8 row_mask:0xf bank_mask:0xf
v_mfma_f32_16x16x32_bf16 v[224:227], a[116:119], a[44:47], v[224:227]
v_add_f32_dpp v93, v93, v93 row_ror:8 row_mask:0xf bank_mask:0xf
v_mfma_f32_16x16x32_bf16 v[200:203], a[116:119], a[40:43], v[200:203]
buffer_load_dwordx4 a[28:31], v2, s[40:43], s35 offen offset:3072 sc1
s_add_u32 s35, s35, 4096
v_mfma_f32_16x16x32_bf16 v[176:179], a[116:119], a[36:39], v[176:179]
v_add_f32_dpp v101, v101, v101 row_ror:8 row_mask:0xf bank_mask:0xf
v_add_f32_dpp v109, v109, v109 row_ror:8 row_mask:0xf bank_mask:0xf
v_mfma_f32_16x16x32_bf16 v[152:155], a[116:119], a[32:35], v[152:155]
v_add_f32_dpp v117, v117, v117 row_ror:8 row_mask:0xf bank_mask:0xf
v_add_f32_dpp v125, v125, v125 row_ror:8 row_mask:0xf bank_mask:0xf
v_mfma_f32_16x16x32_bf16 a[88:91], a[120:123], a[72:75], a[88:91]
s_waitcnt vmcnt(11) lgkmcnt(0)
s_barrier
v_mfma_f32_16x16x32_bf16 v[132:135], a[128:131], a[48:51], v[132:135]
v_add_u32 v5, 0, v1
v_add_u32 v6, s55, v5
v_mfma_f32_16x16x32_bf16 v[156:159], a[128:131], a[52:55], v[156:159]
buffer_load_dwordx4 a[32:35], v2, s[40:43], s35 offen offset:0 sc1
v_mfma_f32_16x16x32_bf16 v[180:183], a[128:131], a[56:59], v[180:183]
ds_read_b128 a[96:99], v5 offset:0
v_add_f32_dpp v92, v94, v94 row_ror:8 row_mask:0xf bank_mask:0xc
v_mfma_f32_16x16x32_bf16 v[204:207], a[128:131], a[60:63], v[204:207]
ds_read_b128 a[100:103], v5 offset:1024
v_add_f32_dpp v100, v102, v102 row_ror:8 row_mask:0xf bank_mask:0xc
v_mfma_f32_16x16x32_bf16 v[208:211], a[132:135], a[60:63], v[208:211]
ds_read_b128 a[104:107], v5 offset:2048
v_add_f32_dpp v108, v110, v110 row_ror:8 row_mask:0xf bank_mask:0xc
v_mfma_f32_16x16x32_bf16 v[184:187], a[132:135], a[56:59], v[184:187]
buffer_load_dwordx4 a[36:39], v2, s[40:43], s35 offen offset:1024 sc1
v_mfma_f32_16x16x32_bf16 v[160:163], a[132:135], a[52:55], v[160:163]
ds_read_b128 a[108:111], v5 offset:3072
v_add_f32_dpp v116, v118, v118 row_ror:8 row_mask:0xf bank_mask:0xc
v_mfma_f32_16x16x32_bf16 v[136:139], a[132:135], a[48:51], v[136:139]
v_add_f32_dpp v124, v126, v126 row_ror:8 row_mask:0xf bank_mask:0xc
v_add_f32_dpp v93, v95, v95 row_ror:8 row_mask:0xf bank_mask:0xc
v_mfma_f32_16x16x32_bf16 v[140:143], a[136:139], a[48:51], v[140:143]
ds_read_b128 a[112:115], v5 offset:4096
v_add_f32_dpp v101, v103, v103 row_ror:8 row_mask:0xf bank_mask:0xc
v_mfma_f32_16x16x32_bf16 v[164:167], a[136:139], a[52:55], v[164:167]
buffer_store_dwordx4 a[196:199], v1, s[4:7], s96 offen offset:1024 sc1
v_mfma_f32_16x16x32_bf16 v[188:191], a[136:139], a[56:59], v[188:191]
ds_read_b128 a[116:119], v5 offset:5120
v_add_f32_dpp v109, v111, v111 row_ror:8 row_mask:0xf bank_mask:0xc
v_mfma_f32_16x16x32_bf16 v[212:215], a[136:139], a[60:63], v[212:215]
v_add_f32_dpp v117, v119, v119 row_ror:8 row_mask:0xf bank_mask:0xc
v_add_f32_dpp v125, v127, v127 row_ror:8 row_mask:0xf bank_mask:0xc
v_mfma_f32_16x16x32_bf16 v[216:219], a[140:143], a[60:63], v[216:219]
ds_read_b128 a[120:123], v6 offset:2048
v_mfma_f32_16x16x32_bf16 v[192:195], a[140:143], a[56:59], v[192:195]
v_permlane32_swap_b32 v92, v93
v_mfma_f32_16x16x32_bf16 v[168:171], a[140:143], a[52:55], v[168:171]
ds_read_b128 a[124:127], v6 offset:26624
v_mfma_f32_16x16x32_bf16 v[144:147], a[140:143], a[48:51], v[144:147]
v_permlane32_swap_b32 v100, v101
v_mfma_f32_16x16x32_bf16 v[148:151], a[144:147], a[48:51], v[148:151]
v_permlane32_swap_b32 v108, v109
v_mfma_f32_16x16x32_bf16 v[172:175], a[144:147], a[52:55], v[172:175]
buffer_load_dwordx4 a[40:43], v2, s[40:43], s35 offen offset:2048 sc1
v_mfma_f32_16x16x32_bf16 v[196:199], a[144:147], a[56:59], v[196:199]
v_permlane32_swap_b32 v116, v117
v_mfma_f32_16x16x32_bf16 v[220:223], a[144:147], a[60:63], v[220:223]
v_permlane32_swap_b32 v124, v125
v_mfma_f32_16x16x32_bf16 v[224:227], a[148:151], a[60:63], v[224:227]
v_add_f32 v92, v92, v93
v_add_f32 v100, v100, v101
v_mfma_f32_16x16x32_bf16 v[200:203], a[148:151], a[56:59], v[200:203]
buffer_load_dwordx4 a[44:47], v2, s[40:43], s35 offen offset:3072 sc1
s_add_u32 s35, s35, 4096
v_mfma_f32_16x16x32_bf16 v[176:179], a[148:151], a[52:55], v[176:179]
v_add_f32 v108, v108, v109
v_add_f32 v116, v116, v117
v_mfma_f32_16x16x32_bf16 v[152:155], a[148:151], a[48:51], v[152:155]
v_add_f32 v124, v124, v125
v_mov_b32 v94, v92
v_mfma_f32_16x16x32_bf16 a[92:95], a[152:155], a[72:75], a[92:95]
v_mov_b32 v102, v100
s_waitcnt vmcnt(10) lgkmcnt(0)
v_mfma_f32_16x16x32_bf16 v[132:135], a[96:99], a[0:3], v[132:135]
ds_read_b128 a[128:131], v5 offset:6144
v_mov_b32 v110, v108
v_mfma_f32_16x16x32_bf16 v[156:159], a[96:99], a[4:7], v[156:159]
buffer_load_dwordx4 a[48:51], v2, s[40:43], s35 offen offset:0 sc1
v_mfma_f32_16x16x32_bf16 v[180:183], a[96:99], a[8:11], v[180:183]
ds_read_b128 a[132:135], v5 offset:7168
v_mov_b32 v118, v116
v_mfma_f32_16x16x32_bf16 v[204:207], a[96:99], a[12:15], v[204:207]
v_mov_b32 v126, v124
v_mfma_f32_16x16x32_bf16 v[208:211], a[100:103], a[12:15], v[208:211]
buffer_store_dwordx4 a[200:203], v1, s[4:7], s97 offen offset:1024 sc1
v_mfma_f32_16x16x32_bf16 v[184:187], a[100:103], a[8:11], v[184:187]
ds_read_b128 a[136:139], v5 offset:8192
v_mfma_f32_16x16x32_bf16 v[160:163], a[100:103], a[4:7], v[160:163]
ds_read_b128 a[140:143], v5 offset:9216
v_mfma_f32_16x16x32_bf16 v[136:139], a[100:103], a[0:3], v[136:139]
v_permlane16_swap_b32 v92, v94
v_mfma_f32_16x16x32_bf16 v[140:143], a[104:107], a[0:3], v[140:143]
ds_read_b128 a[144:147], v5 offset:10240
v_mfma_f32_16x16x32_bf16 v[164:167], a[104:107], a[4:7], v[164:167]
v_permlane16_swap_b32 v100, v102
v_mfma_f32_16x16x32_bf16 v[188:191], a[104:107], a[8:11], v[188:191]
buffer_load_dwordx4 a[52:55], v2, s[40:43], s35 offen offset:1024 sc1
v_mfma_f32_16x16x32_bf16 v[212:215], a[104:107], a[12:15], v[212:215]
ds_read_b128 a[148:151], v5 offset:11264
v_mfma_f32_16x16x32_bf16 v[216:219], a[108:111], a[12:15], v[216:219]
ds_read_b128 a[152:155], v6 offset:3072
v_mfma_f32_16x16x32_bf16 v[192:195], a[108:111], a[8:11], v[192:195]
v_permlane16_swap_b32 v108, v110
v_mfma_f32_16x16x32_bf16 v[168:171], a[108:111], a[4:7], v[168:171]
buffer_load_dwordx4 a[56:59], v2, s[40:43], s35 offen offset:2048 sc1
v_mfma_f32_16x16x32_bf16 v[144:147], a[108:111], a[0:3], v[144:147]
ds_read_b128 a[156:159], v6 offset:27648
v_mfma_f32_16x16x32_bf16 v[148:151], a[112:115], a[0:3], v[148:151]
v_permlane16_swap_b32 v116, v118
v_mfma_f32_16x16x32_bf16 v[172:175], a[112:115], a[4:7], v[172:175]
buffer_store_dwordx4 a[204:207], v1, s[4:7], s96 offen offset:2048 sc1
v_mfma_f32_16x16x32_bf16 v[196:199], a[112:115], a[8:11], v[196:199]
v_permlane16_swap_b32 v124, v126
v_mfma_f32_16x16x32_bf16 v[220:223], a[112:115], a[12:15], v[220:223]
v_add_f32 v92, v92, v94
v_add_f32 v100, v100, v102
v_mfma_f32_16x16x32_bf16 v[224:227], a[116:119], a[12:15], v[224:227]
v_add_f32 v108, v108, v110
v_add_f32 v116, v116, v118
v_mfma_f32_16x16x32_bf16 v[200:203], a[116:119], a[8:11], v[200:203]
v_add_f32 v124, v124, v126
v_mov_b32 v94, v92
v_mfma_f32_16x16x32_bf16 v[176:179], a[116:119], a[4:7], v[176:179]
v_mov_b32 v102, v100
v_mov_b32 v110, v108
v_mfma_f32_16x16x32_bf16 v[152:155], a[116:119], a[0:3], v[152:155]
buffer_load_dwordx4 a[60:63], v2, s[40:43], s35 offen offset:3072 sc1
s_add_u32 s35, s35, 4096
v_mfma_f32_16x16x32_bf16 a[80:83], a[120:123], a[64:67], a[80:83]
v_mov_b32 v118, v116
v_mov_b32 v126, v124
v_mfma_f32_16x16x32_bf16 a[80:83], a[124:127], a[68:71], a[80:83]
s_waitcnt vmcnt(11) lgkmcnt(0)
v_mfma_f32_16x16x32_bf16 v[132:135], a[128:131], a[16:19], v[132:135]
ds_read_b128 a[96:99], v5 offset:12288
v_mfma_f32_16x16x32_bf16 v[156:159], a[128:131], a[20:23], v[156:159]
buffer_load_dwordx4 a[0:3], v2, s[40:43], s35 offen offset:0 sc1
v_mfma_f32_16x16x32_bf16 v[180:183], a[128:131], a[24:27], v[180:183]
ds_read_b128 a[100:103], v5 offset:13312
v_mfma_f32_16x16x32_bf16 v[204:207], a[128:131], a[28:31], v[204:207]
v_permlane32_swap_b32 v92, v94
v_mfma_f32_16x16x32_bf16 v[208:211], a[132:135], a[28:31], v[208:211]
ds_read_b128 a[104:107], v5 offset:14336
v_mfma_f32_16x16x32_bf16 v[184:187], a[132:135], a[24:27], v[184:187]
buffer_load_dwordx4 a[4:7], v2, s[40:43], s35 offen offset:1024 sc1
v_mfma_f32_16x16x32_bf16 v[160:163], a[132:135], a[20:23], v[160:163]
ds_read_b128 a[108:111], v5 offset:15360
v_mfma_f32_16x16x32_bf16 v[136:139], a[132:135], a[16:19], v[136:139]
v_permlane32_swap_b32 v100, v102
v_mfma_f32_16x16x32_bf16 v[140:143], a[136:139], a[16:19], v[140:143]
ds_read_b128 a[112:115], v5 offset:16384
v_mfma_f32_16x16x32_bf16 v[164:167], a[136:139], a[20:23], v[164:167]
buffer_store_dwordx4 a[208:211], v1, s[4:7], s97 offen offset:2048 sc1
v_mfma_f32_16x16x32_bf16 v[188:191], a[136:139], a[24:27], v[188:191]
ds_read_b128 a[116:119], v5 offset:17408
v_mfma_f32_16x16x32_bf16 v[212:215], a[136:139], a[28:31], v[212:215]
v_permlane32_swap_b32 v108, v110
v_mfma_f32_16x16x32_bf16 v[216:219], a[140:143], a[28:31], v[216:219]
ds_read_b128 a[120:123], v6 offset:4096
v_mfma_f32_16x16x32_bf16 v[192:195], a[140:143], a[24:27], v[192:195]
v_permlane32_swap_b32 v116, v118
v_mfma_f32_16x16x32_bf16 v[168:171], a[140:143], a[20:23], v[168:171]
ds_read_b128 a[124:127], v6 offset:28672
v_mfma_f32_16x16x32_bf16 v[144:147], a[140:143], a[16:19], v[144:147]
v_permlane32_swap_b32 v124, v126
v_mfma_f32_16x16x32_bf16 v[148:151], a[144:147], a[16:19], v[148:151]
v_mul_f32 v82, 0xba800000, v92
v_mul_f32 v84, 0xba800000, v100
v_mfma_f32_16x16x32_bf16 v[172:175], a[144:147], a[20:23], v[172:175]
v_mul_f32 v86, 0xba800000, v108
v_mul_f32 v88, 0xba800000, v116
v_mfma_f32_16x16x32_bf16 v[196:199], a[144:147], a[24:27], v[196:199]
buffer_load_dwordx4 a[8:11], v2, s[40:43], s35 offen offset:2048 sc1
v_mfma_f32_16x16x32_bf16 v[220:223], a[144:147], a[28:31], v[220:223]
v_mul_f32 v90, 0xba800000, v124
v_mul_f32 v94, 0x3a800000, v94
v_mfma_f32_16x16x32_bf16 v[224:227], a[148:151], a[28:31], v[224:227]
v_mul_f32 v102, 0x3a800000, v102
v_mul_f32 v110, 0x3a800000, v110
v_mfma_f32_16x16x32_bf16 v[200:203], a[148:151], a[24:27], v[200:203]
v_mul_f32 v118, 0x3a800000, v118
v_mul_f32 v126, 0x3a800000, v126
v_mfma_f32_16x16x32_bf16 v[176:179], a[148:151], a[20:23], v[176:179]
buffer_load_dwordx4 a[12:15], v2, s[40:43], s35 offen offset:3072 sc1
s_add_u32 s35, s35, 4096
v_mfma_f32_16x16x32_bf16 v[152:155], a[148:151], a[16:19], v[152:155]
v_fma_f32 v94, -v82, v82, v94
v_fma_f32 v102, -v84, v84, v102
v_mfma_f32_16x16x32_bf16 a[84:87], a[152:155], a[64:67], a[84:87]
v_fma_f32 v110, -v86, v86, v110
v_fma_f32 v118, -v88, v88, v118
v_mfma_f32_16x16x32_bf16 a[84:87], a[156:159], a[68:71], a[84:87]
v_fma_f32 v126, -v90, v90, v126
s_waitcnt vmcnt(11) lgkmcnt(0)
v_mfma_f32_16x16x32_bf16 v[132:135], a[96:99], a[32:35], v[132:135]
ds_read_b128 a[128:131], v5 offset:18432
v_max_f32 v94, 0, v94
v_mfma_f32_16x16x32_bf16 v[156:159], a[96:99], a[36:39], v[156:159]
buffer_load_dwordx4 a[16:19], v2, s[40:43], s35 offen offset:0 sc1
v_mfma_f32_16x16x32_bf16 v[180:183], a[96:99], a[40:43], v[180:183]
ds_read_b128 a[132:135], v5 offset:19456
v_max_f32 v102, 0, v102
v_mfma_f32_16x16x32_bf16 v[204:207], a[96:99], a[44:47], v[204:207]
v_max_f32 v110, 0, v110
v_max_f32 v118, 0, v118
v_mfma_f32_16x16x32_bf16 v[208:211], a[100:103], a[44:47], v[208:211]
buffer_store_dwordx4 v[236:239], v254, s[4:7], s98 offen offset:0 sc1
v_mfma_f32_16x16x32_bf16 v[184:187], a[100:103], a[40:43], v[184:187]
ds_read_b128 a[136:139], v5 offset:20480
v_max_f32 v126, 0, v126
v_mfma_f32_16x16x32_bf16 v[160:163], a[100:103], a[36:39], v[160:163]
ds_read_b128 a[140:143], v5 offset:21504
v_add_f32 v94, 0x3727c5ac, v94
v_mfma_f32_16x16x32_bf16 v[136:139], a[100:103], a[32:35], v[136:139]
v_add_f32 v102, 0x3727c5ac, v102
v_add_f32 v110, 0x3727c5ac, v110
v_add_f32 v118, 0x3727c5ac, v118
v_add_f32 v126, 0x3727c5ac, v126
v_rsq_f32 v83, v94
v_rsq_f32 v85, v102
v_rsq_f32 v87, v110
v_rsq_f32 v89, v118
v_rsq_f32 v91, v126
v_mfma_f32_16x16x32_bf16 v[140:143], a[104:107], a[32:35], v[140:143]
ds_read_b128 a[144:147], v5 offset:22528
v_mfma_f32_16x16x32_bf16 v[164:167], a[104:107], a[36:39], v[164:167]
v_fmac_f32 v132, v48, v82
v_mfma_f32_16x16x32_bf16 v[188:191], a[104:107], a[40:43], v[188:191]
buffer_load_dwordx4 a[20:23], v2, s[40:43], s35 offen offset:1024 sc1
v_mfma_f32_16x16x32_bf16 v[212:215], a[104:107], a[44:47], v[212:215]
ds_read_b128 a[148:151], v5 offset:23552
v_fmac_f32 v156, v48, v84
v_mfma_f32_16x16x32_bf16 v[216:219], a[108:111], a[44:47], v[216:219]
ds_read_b128 a[152:155], v6 offset:5120
v_fmac_f32 v180, v48, v86
v_mfma_f32_16x16x32_bf16 v[192:195], a[108:111], a[40:43], v[192:195]
v_fmac_f32 v204, v48, v88
v_fmac_f32 v208, v52, v88
v_mfma_f32_16x16x32_bf16 v[168:171], a[108:111], a[36:39], v[168:171]
buffer_load_dwordx4 a[24:27], v2, s[40:43], s35 offen offset:2048 sc1
v_mfma_f32_16x16x32_bf16 v[144:147], a[108:111], a[32:35], v[144:147]
ds_read_b128 a[156:159], v6 offset:29696
v_fmac_f32 v184, v52, v86
v_mfma_f32_16x16x32_bf16 v[148:151], a[112:115], a[32:35], v[148:151]
v_fmac_f32 v160, v52, v84
v_fmac_f32 v136, v52, v82
v_mfma_f32_16x16x32_bf16 v[172:175], a[112:115], a[36:39], v[172:175]
buffer_store_dwordx4 v[240:243], v254, s[4:7], s98 offen offset:2048 sc1
v_mfma_f32_16x16x32_bf16 v[196:199], a[112:115], a[40:43], v[196:199]
v_fmac_f32 v140, v56, v82
v_fmac_f32 v164, v56, v84
v_mfma_f32_16x16x32_bf16 v[220:223], a[112:115], a[44:47], v[220:223]
v_fmac_f32 v188, v56, v86
v_mfma_f32_16x16x32_bf16 v[224:227], a[116:119], a[44:47], v[224:227]
v_fmac_f32 v212, v56, v88
v_mfma_f32_16x16x32_bf16 v[200:203], a[116:119], a[40:43], v[200:203]
v_fmac_f32 v216, v60, v88
v_mfma_f32_16x16x32_bf16 v[176:179], a[116:119], a[36:39], v[176:179]
v_fmac_f32 v192, v60, v86
v_mfma_f32_16x16x32_bf16 v[152:155], a[116:119], a[32:35], v[152:155]
buffer_load_dwordx4 a[28:31], v2, s[40:43], s35 offen offset:3072 sc1
s_add_u32 s35, s35, 4096
v_mfma_f32_16x16x32_bf16 a[88:91], a[120:123], a[64:67], a[88:91]
v_fmac_f32 v168, v60, v84
v_fmac_f32 v144, v60, v82
v_mfma_f32_16x16x32_bf16 a[88:91], a[124:127], a[68:71], a[88:91]
v_fmac_f32 v148, v64, v82
s_waitcnt vmcnt(11) lgkmcnt(0)
v_mfma_f32_16x16x32_bf16 v[132:135], a[128:131], a[48:51], v[132:135]
ds_read_b128 a[96:99], v5 offset:24576
v_fmac_f32 v172, v64, v84
v_mfma_f32_16x16x32_bf16 v[156:159], a[128:131], a[52:55], v[156:159]
buffer_load_dwordx4 a[32:35], v2, s[40:43], s35 offen offset:0 sc1
s_lshl_b32 s90, s28, 12
v_mfma_f32_16x16x32_bf16 v[180:183], a[128:131], a[56:59], v[180:183]
ds_read_b128 a[100:103], v5 offset:25600
v_fmac_f32 v196, v64, v86
v_mfma_f32_16x16x32_bf16 v[204:207], a[128:131], a[60:63], v[204:207]
v_fmac_f32 v220, v64, v88
v_fmac_f32 v224, v68, v88
v_mfma_f32_16x16x32_bf16 v[208:211], a[132:135], a[60:63], v[208:211]
buffer_store_dwordx4 v[244:247], v254, s[4:7], s99 offen offset:0 sc1
s_add_u32 m0, s19, 49152
v_mfma_f32_16x16x32_bf16 v[184:187], a[132:135], a[56:59], v[184:187]
s_add_u32 s44, s85, 0xa04000
ds_read_b128 a[104:107], v5 offset:26624
v_mfma_f32_16x16x32_bf16 v[160:163], a[132:135], a[52:55], v[160:163]
v_fmac_f32 v200, v68, v86
v_fmac_f32 v176, v68, v84
v_mfma_f32_16x16x32_bf16 v[136:139], a[132:135], a[48:51], v[136:139]
v_fmac_f32 v152, v68, v82
s_add_u32 s90, s90, 147456
v_mfma_f32_16x16x32_bf16 v[140:143], a[136:139], a[48:51], v[140:143]
ds_read_b128 a[108:111], v5 offset:27648
v_add_u32 v234, s90, v1
v_mfma_f32_16x16x32_bf16 v[164:167], a[136:139], a[52:55], v[164:167]
v_fmac_f32 v133, v49, v82
s_lshl_b32 s90, s28, 10
v_mfma_f32_16x16x32_bf16 v[188:191], a[136:139], a[56:59], v[188:191]
ds_read_b128 a[112:115], v5 offset:28672
v_fmac_f32 v157, v49, v84
v_mfma_f32_16x16x32_bf16 v[212:215], a[136:139], a[60:63], v[212:215]
v_fmac_f32 v181, v49, v86
s_add_u32 s90, s90, 147456
v_mfma_f32_16x16x32_bf16 v[216:219], a[140:143], a[60:63], v[216:219]
buffer_load_dwordx4 a[36:39], v2, s[40:43], s35 offen offset:1024 sc1
v_mfma_f32_16x16x32_bf16 v[192:195], a[140:143], a[56:59], v[192:195]
ds_read_b128 a[116:119], v5 offset:29696
v_fmac_f32 v205, v49, v88
v_mfma_f32_16x16x32_bf16 v[168:171], a[140:143], a[52:55], v[168:171]
v_fmac_f32 v209, v53, v88
v_fmac_f32 v185, v53, v86
v_mfma_f32_16x16x32_bf16 v[144:147], a[140:143], a[48:51], v[144:147]
buffer_load_dwordx4 a[40:43], v2, s[40:43], s35 offen offset:2048 sc1
v_mfma_f32_16x16x32_bf16 v[148:151], a[144:147], a[48:51], v[148:151]
v_fmac_f32 v161, v53, v84
v_fmac_f32 v137, v53, v82
v_mfma_f32_16x16x32_bf16 v[172:175], a[144:147], a[52:55], v[172:175]
v_fmac_f32 v141, v57, v82
v_add_u32 v235, s90, v1
v_mfma_f32_16x16x32_bf16 v[196:199], a[144:147], a[56:59], v[196:199]
v_fmac_f32 v165, v57, v84
v_mfma_f32_16x16x32_bf16 v[220:223], a[144:147], a[60:63], v[220:223]
buffer_load_dwordx4 v1, s[4:7], s44 offen offset:0 sc1 lds
v_mfma_f32_16x16x32_bf16 v[224:227], a[148:151], a[60:63], v[224:227]
v_fmac_f32 v189, v57, v86
v_fmac_f32 v213, v57, v88
v_mfma_f32_16x16x32_bf16 v[200:203], a[148:151], a[56:59], v[200:203]
v_fmac_f32 v217, v61, v88
v_mfma_f32_16x16x32_bf16 v[176:179], a[148:151], a[52:55], v[176:179]
v_fmac_f32 v193, v61, v86
v_mfma_f32_16x16x32_bf16 v[152:155], a[148:151], a[48:51], v[152:155]
buffer_load_dwordx4 a[44:47], v2, s[40:43], s35 offen offset:3072 sc1
s_add_u32 s35, s35, 4096
v_mfma_f32_16x16x32_bf16 a[92:95], a[152:155], a[64:67], a[92:95]
v_fmac_f32 v169, v61, v84
v_fmac_f32 v145, v61, v82
v_mfma_f32_16x16x32_bf16 a[92:95], a[156:159], a[68:71], a[92:95]
v_fmac_f32 v149, v65, v82
s_waitcnt vmcnt(12) lgkmcnt(0)
v_mfma_f32_16x16x32_bf16 v[132:135], a[96:99], a[0:3], v[132:135]
ds_read_b128 a[128:131], v5 offset:30720
v_fmac_f32 v173, v65, v84
v_mfma_f32_16x16x32_bf16 v[156:159], a[96:99], a[4:7], v[156:159]
buffer_load_dwordx4 a[48:51], v2, s[40:43], s35 offen offset:0 sc1
v_mfma_f32_16x16x32_bf16 v[180:183], a[96:99], a[8:11], v[180:183]
ds_read_b128 a[132:135], v5 offset:31744
v_fmac_f32 v197, v65, v86
v_mfma_f32_16x16x32_bf16 v[204:207], a[96:99], a[12:15], v[204:207]
v_fmac_f32 v221, v65, v88
v_fmac_f32 v225, v69, v88
v_mfma_f32_16x16x32_bf16 v[208:211], a[100:103], a[12:15], v[208:211]
v_fmac_f32 v201, v69, v86
v_mfma_f32_16x16x32_bf16 v[184:187], a[100:103], a[8:11], v[184:187]
buffer_load_dwordx4 a[52:55], v2, s[40:43], s35 offen offset:1024 sc1
v_mfma_f32_16x16x32_bf16 v[160:163], a[100:103], a[4:7], v[160:163]
ds_read_b128 a[136:139], v5 offset:32768
v_fmac_f32 v177, v69, v84
v_mfma_f32_16x16x32_bf16 v[136:139], a[100:103], a[0:3], v[136:139]
v_fmac_f32 v153, v69, v82
v_mfma_f32_16x16x32_bf16 v[140:143], a[104:107], a[0:3], v[140:143]
ds_read_b128 a[140:143], v5 offset:33792
v_mfma_f32_16x16x32_bf16 v[164:167], a[104:107], a[4:7], v[164:167]
v_fmac_f32 v134, v50, v82
v_mfma_f32_16x16x32_bf16 v[188:191], a[104:107], a[8:11], v[188:191]
buffer_load_dwordx4 v1, s[4:7], s44 offen offset:1024 sc1 lds
v_mfma_f32_16x16x32_bf16 v[212:215], a[104:107], a[12:15], v[212:215]
ds_read_b128 a[144:147], v5 offset:34816
v_fmac_f32 v158, v50, v84
v_mfma_f32_16x16x32_bf16 v[216:219], a[108:111], a[12:15], v[216:219]
v_fmac_f32 v182, v50, v86
v_fmac_f32 v206, v50, v88
v_mfma_f32_16x16x32_bf16 v[192:195], a[108:111], a[8:11], v[192:195]
ds_read_b128 a[148:151], v5 offset:35840
v_fmac_f32 v210, v54, v88
v_mfma_f32_16x16x32_bf16 v[168:171], a[108:111], a[4:7], v[168:171]
v_fmac_f32 v186, v54, v86
v_mfma_f32_16x16x32_bf16 v[144:147], a[108:111], a[0:3], v[144:147]
buffer_load_dwordx4 a[56:59], v2, s[40:43], s35 offen offset:2048 sc1
v_mfma_f32_16x16x32_bf16 v[148:151], a[112:115], a[0:3], v[148:151]
v_fmac_f32 v162, v54, v84
v_fmac_f32 v138, v54, v82
v_mfma_f32_16x16x32_bf16 v[172:175], a[112:115], a[4:7], v[172:175]
v_fmac_f32 v142, v58, v82
v_mfma_f32_16x16x32_bf16 v[196:199], a[112:115], a[8:11], v[196:199]
v_fmac_f32 v166, v58, v84
v_mfma_f32_16x16x32_bf16 v[220:223], a[112:115], a[12:15], v[220:223]
v_fmac_f32 v190, v58, v86
v_mfma_f32_16x16x32_bf16 v[224:227], a[116:119], a[12:15], v[224:227]
buffer_load_dwordx4 a[60:63], v2, s[40:43], s35 offen offset:3072 sc1
s_add_u32 s35, s35, 4096
v_mfma_f32_16x16x32_bf16 v[200:203], a[116:119], a[8:11], v[200:203]
v_fmac_f32 v214, v58, v88
v_fmac_f32 v218, v62, v88
v_mfma_f32_16x16x32_bf16 v[176:179], a[116:119], a[4:7], v[176:179]
v_fmac_f32 v194, v62, v86
v_mfma_f32_16x16x32_bf16 v[152:155], a[116:119], a[0:3], v[152:155]
v_fmac_f32 v170, v62, v84
s_waitcnt vmcnt(11) lgkmcnt(0)
v_mfma_f32_16x16x32_bf16 v[132:135], a[128:131], a[16:19], v[132:135]
ds_read_b128 a[96:99], v5 offset:36864
v_fmac_f32 v146, v62, v82
v_mfma_f32_16x16x32_bf16 v[156:159], a[128:131], a[20:23], v[156:159]
buffer_load_dwordx4 v1, s[4:7], s44 offen offset:2048 sc1 lds
v_mfma_f32_16x16x32_bf16 v[180:183], a[128:131], a[24:27], v[180:183]
ds_read_b128 a[100:103], v5 offset:37888
v_fmac_f32 v150, v66, v82
v_mfma_f32_16x16x32_bf16 v[204:207], a[128:131], a[28:31], v[204:207]
v_fmac_f32 v174, v66, v84
v_fmac_f32 v198, v66, v86
v_mfma_f32_16x16x32_bf16 v[208:211], a[132:135], a[28:31], v[208:211]
v_fmac_f32 v222, v66, v88
v_mfma_f32_16x16x32_bf16 v[184:187], a[132:135], a[24:27], v[184:187]
buffer_load_dwordx4 v1, s[4:7], s44 offen offset:3072 sc1 lds
s_add_u32 m0, s19, 65536
v_mfma_f32_16x16x32_bf16 v[160:163], a[132:135], a[20:23], v[160:163]
L_stub2:
s_cbranch_execz L_wret0
s_add_u32 s44, s84, 0xa08000
ds_read_b128 a[104:107], v5 offset:38912
v_mfma_f32_16x16x32_bf16 v[136:139], a[132:135], a[16:19], v[136:139]
v_fmac_f32 v226, v70, v88
v_fmac_f32 v202, v70, v86
v_mfma_f32_16x16x32_bf16 v[140:143], a[136:139], a[16:19], v[140:143]
ds_read_b128 a[108:111], v5 offset:39936
v_fmac_f32 v178, v70, v84
v_mfma_f32_16x16x32_bf16 v[164:167], a[136:139], a[20:23], v[164:167]
v_fmac_f32 v154, v70, v82
v_fmac_f32 v135, v51, v82
v_mfma_f32_16x16x32_bf16 v[188:191], a[136:139], a[24:27], v[188:191]
buffer_load_dwordx4 v1, s[4:7], s44 offen offset:0 sc1 lds
v_mfma_f32_16x16x32_bf16 v[212:215], a[136:139], a[28:31], v[212:215]
ds_read_b128 a[112:115], v5 offset:40960
v_fmac_f32 v159, v51, v84
v_mfma_f32_16x16x32_bf16 v[216:219], a[140:143], a[28:31], v[216:219]
v_fmac_f32 v183, v51, v86
v_fmac_f32 v207, v51, v88
v_mfma_f32_16x16x32_bf16 v[192:195], a[140:143], a[24:27], v[192:195]
ds_read_b128 a[116:119], v5 offset:41984
v_fmac_f32 v211, v55, v88
v_mfma_f32_16x16x32_bf16 v[168:171], a[140:143], a[20:23], v[168:171]
v_fmac_f32 v187, v55, v86
v_mfma_f32_16x16x32_bf16 v[144:147], a[140:143], a[16:19], v[144:147]
buffer_load_dwordx4 v1, s[4:7], s44 offen offset:1024 sc1 lds
v_mfma_f32_16x16x32_bf16 v[148:151], a[144:147], a[16:19], v[148:151]
v_fmac_f32 v163, v55, v84
v_fmac_f32 v139, v55, v82
v_mfma_f32_16x16x32_bf16 v[172:175], a[144:147], a[20:23], v[172:175]
v_fmac_f32 v143, v59, v82
v_mfma_f32_16x16x32_bf16 v[196:199], a[144:147], a[24:27], v[196:199]
v_fmac_f32 v167, v59, v84
v_mfma_f32_16x16x32_bf16 v[220:223], a[144:147], a[28:31], v[220:223]
v_fmac_f32 v191, v59, v86
v_mfma_f32_16x16x32_bf16 v[224:227], a[148:151], a[28:31], v[224:227]
buffer_load_dwordx4 v1, s[4:7], s44 offen offset:2048 sc1 lds
v_mfma_f32_16x16x32_bf16 v[200:203], a[148:151], a[24:27], v[200:203]
v_fmac_f32 v215, v59, v88
v_fmac_f32 v219, v63, v88
v_mfma_f32_16x16x32_bf16 v[176:179], a[148:151], a[20:23], v[176:179]
v_fmac_f32 v195, v63, v86
v_mfma_f32_16x16x32_bf16 v[152:155], a[148:151], a[16:19], v[152:155]
v_fmac_f32 v171, v63, v84
s_waitcnt vmcnt(10) lgkmcnt(0)
v_mfma_f32_16x16x32_bf16 v[132:135], a[96:99], a[32:35], v[132:135]
ds_read_b128 a[128:131], v5 offset:43008
v_fmac_f32 v147, v63, v82
v_mfma_f32_16x16x32_bf16 v[156:159], a[96:99], a[36:39], v[156:159]
buffer_load_dwordx4 v1, s[4:7], s44 offen offset:3072 sc1 lds
s_add_u32 m0, s19, 81920
v_mfma_f32_16x16x32_bf16 v[180:183], a[96:99], a[40:43], v[180:183]
s_add_u32 s44, s85, 0xa0c000
ds_read_b128 a[132:135], v5 offset:44032
v_mfma_f32_16x16x32_bf16 v[204:207], a[96:99], a[44:47], v[204:207]
v_fmac_f32 v151, v67, v82
v_fmac_f32 v175, v67, v84
v_mfma_f32_16x16x32_bf16 v[208:211], a[100:103], a[44:47], v[208:211]
v_fmac_f32 v199, v67, v86
v_fmac_f32 v223, v67, v88
v_mfma_f32_16x16x32_bf16 v[184:187], a[100:103], a[40:43], v[184:187]
buffer_load_dwordx4 v1, s[4:7], s44 offen offset:0 sc1 lds
v_mfma_f32_16x16x32_bf16 v[160:163], a[100:103], a[36:39], v[160:163]
ds_read_b128 a[136:139], v5 offset:45056
v_fmac_f32 v227, v71, v88
v_mfma_f32_16x16x32_bf16 v[136:139], a[100:103], a[32:35], v[136:139]
v_fmac_f32 v203, v71, v86
v_fmac_f32 v179, v71, v84
v_mfma_f32_16x16x32_bf16 v[140:143], a[104:107], a[32:35], v[140:143]
ds_read_b128 a[140:143], v5 offset:46080
v_fmac_f32 v155, v71, v82
v_mfma_f32_16x16x32_bf16 v[164:167], a[104:107], a[36:39], v[164:167]
ds_write_b128 v234, a[80:83] offset:0
v_mfma_f32_16x16x32_bf16 v[188:191], a[104:107], a[40:43], v[188:191]
buffer_load_dwordx4 v1, s[4:7], s44 offen offset:1024 sc1 lds
v_mfma_f32_16x16x32_bf16 v[212:215], a[104:107], a[44:47], v[212:215]
ds_read_b128 a[144:147], v5 offset:47104
v_mfma_f32_16x16x32_bf16 v[216:219], a[108:111], a[44:47], v[216:219]
ds_write_b128 v234, a[84:87] offset:1024
v_mfma_f32_16x16x32_bf16 v[192:195], a[108:111], a[40:43], v[192:195]
ds_read_b128 a[148:151], v5 offset:48128
v_mfma_f32_16x16x32_bf16 v[168:171], a[108:111], a[36:39], v[168:171]
ds_write_b128 v234, a[88:91] offset:2048
v_mfma_f32_16x16x32_bf16 v[144:147], a[108:111], a[32:35], v[144:147]
buffer_load_dwordx4 v1, s[4:7], s44 offen offset:2048 sc1 lds
v_mfma_f32_16x16x32_bf16 v[148:151], a[112:115], a[32:35], v[148:151]
ds_write_b128 v234, a[92:95] offset:3072
v_mfma_f32_16x16x32_bf16 v[172:175], a[112:115], a[36:39], v[172:175]
v_mfma_f32_16x16x32_bf16 v[196:199], a[112:115], a[40:43], v[196:199]
v_mfma_f32_16x16x32_bf16 v[220:223], a[112:115], a[44:47], v[220:223]
v_mfma_f32_16x16x32_bf16 v[224:227], a[116:119], a[44:47], v[224:227]
buffer_load_dwordx4 v1, s[4:7], s44 offen offset:3072 sc1 lds
s_add_u32 m0, s19, 98304
v_mfma_f32_16x16x32_bf16 v[200:203], a[116:119], a[40:43], v[200:203]
s_add_u32 s44, s84, 0xa10000
v_mfma_f32_16x16x32_bf16 v[176:179], a[116:119], a[36:39], v[176:179]
v_mfma_f32_16x16x32_bf16 v[152:155], a[116:119], a[32:35], v[152:155]
s_waitcnt vmcnt(10) lgkmcnt(0)
s_barrier
v_mfma_f32_16x16x32_bf16 v[132:135], a[128:131], a[48:51], v[132:135]
ds_read_b128 v[92:95], v235 offset:0
v_mfma_f32_16x16x32_bf16 v[156:159], a[128:131], a[52:55], v[156:159]
buffer_load_dwordx4 v1, s[4:7], s44 offen offset:0 sc1 lds
v_mfma_f32_16x16x32_bf16 v[180:183], a[128:131], a[56:59], v[180:183]
ds_read_b128 v[96:99], v235 offset:4096
v_mfma_f32_16x16x32_bf16 v[204:207], a[128:131], a[60:63], v[204:207]
v_mfma_f32_16x16x32_bf16 v[208:211], a[132:135], a[60:63], v[208:211]
ds_read_b128 v[100:103], v235 offset:8192
v_mfma_f32_16x16x32_bf16 v[184:187], a[132:135], a[56:59], v[184:187]
v_mfma_f32_16x16x32_bf16 v[160:163], a[132:135], a[52:55], v[160:163]
ds_read_b128 v[104:107], v235 offset:12288
v_mfma_f32_16x16x32_bf16 v[136:139], a[132:135], a[48:51], v[136:139]
buffer_load_dwordx4 v1, s[4:7], s44 offen offset:1024 sc1 lds
v_mfma_f32_16x16x32_bf16 v[140:143], a[136:139], a[48:51], v[140:143]
v_mfma_f32_16x16x32_bf16 v[164:167], a[136:139], a[52:55], v[164:167]
v_mfma_f32_16x16x32_bf16 v[188:191], a[136:139], a[56:59], v[188:191]
v_mfma_f32_16x16x32_bf16 v[212:215], a[136:139], a[60:63], v[212:215]
v_mfma_f32_16x16x32_bf16 v[216:219], a[140:143], a[60:63], v[216:219]
v_mfma_f32_16x16x32_bf16 v[192:195], a[140:143], a[56:59], v[192:195]
buffer_load_dwordx4 v1, s[4:7], s44 offen offset:2048 sc1 lds
v_mfma_f32_16x16x32_bf16 v[168:171], a[140:143], a[52:55], v[168:171]
v_mfma_f32_16x16x32_bf16 v[144:147], a[140:143], a[48:51], v[144:147]
v_mfma_f32_16x16x32_bf16 v[148:151], a[144:147], a[48:51], v[148:151]
v_mfma_f32_16x16x32_bf16 v[172:175], a[144:147], a[52:55], v[172:175]
v_mfma_f32_16x16x32_bf16 v[196:199], a[144:147], a[56:59], v[196:199]
v_mfma_f32_16x16x32_bf16 v[220:223], a[144:147], a[60:63], v[220:223]
buffer_load_dwordx4 v1, s[4:7], s44 offen offset:3072 sc1 lds
v_mfma_f32_16x16x32_bf16 v[224:227], a[148:151], a[60:63], v[224:227]
v_mfma_f32_16x16x32_bf16 v[200:203], a[148:151], a[56:59], v[200:203]
v_mfma_f32_16x16x32_bf16 v[176:179], a[148:151], a[52:55], v[176:179]
v_mfma_f32_16x16x32_bf16 v[152:155], a[148:151], a[48:51], v[152:155]
.set L_cpf0, .
s_lshl_b32 s36, s28, 12
s_lshl_b32 s37, s28, 10
s_add_u32 m0, s19, 32768
s_add_u32 s44, s84, 0xa00000
buffer_load_dwordx4 v1, s[4:7], s44 offen offset:0 sc1 lds
s_waitcnt lgkmcnt(2)
v_add_f32 v92, v92, v96
s_waitcnt lgkmcnt(0)
v_add_f32 v100, v100, v104
v_add_f32 v93, v93, v97
v_add_f32 v101, v101, v105
v_add_f32 v94, v94, v98
v_add_f32 v102, v102, v106
v_add_f32 v95, v95, v99
v_add_f32 v103, v103, v107
v_add_f32 v228, v92, v100
v_add_f32 v229, v93, v101
v_add_f32 v230, v94, v102
v_add_f32 v231, v95, v103
v_fmac_f32 v228, v72, v90
v_fmac_f32 v229, v73, v90
v_pk_mul_f32 v[212:213], v[212:213], v[88:89] op_sel:[0,1] op_sel_hi:[1,1]
v_pk_mul_f32 v[220:221], v[220:221], v[88:89] op_sel:[0,1] op_sel_hi:[1,1]
v_pk_mul_f32 v[196:197], v[196:197], v[86:87] op_sel:[0,1] op_sel_hi:[1,1]
v_pk_mul_f32 v[172:173], v[172:173], v[84:85] op_sel:[0,1] op_sel_hi:[1,1]
v_pk_mul_f32 v[148:149], v[148:149], v[82:83] op_sel:[0,1] op_sel_hi:[1,1]
v_fmac_f32 v230, v74, v90
v_fmac_f32 v231, v75, v90
v_pk_mul_f32 v[228:229], v[228:229], v[90:91] op_sel:[0,1] op_sel_hi:[1,1]
v_pk_mul_f32 v[214:215], v[214:215], v[88:89] op_sel:[0,1] op_sel_hi:[1,1]
v_pk_mul_f32 v[222:223], v[222:223], v[88:89] op_sel:[0,1] op_sel_hi:[1,1]
v_pk_mul_f32 v[198:199], v[198:199], v[86:87] op_sel:[0,1] op_sel_hi:[1,1]
v_pk_mul_f32 v[174:175], v[174:175], v[84:85] op_sel:[0,1] op_sel_hi:[1,1]
v_pk_mul_f32 v[150:151], v[150:151], v[82:83] op_sel:[0,1] op_sel_hi:[1,1]
buffer_load_dwordx4 v1, s[4:7], s44 offen offset:1024 sc1 lds
v_cvt_pk_bf16_f32 v212, v212, v213
v_cvt_pk_bf16_f32 v220, v220, v221
v_cvt_pk_bf16_f32 v196, v196, v197
v_cvt_pk_bf16_f32 v172, v172, v173
v_cvt_pk_bf16_f32 v148, v148, v149
v_pk_mul_f32 v[230:231], v[230:231], v[90:91] op_sel:[0,1] op_sel_hi:[1,1]
v_pk_mul_f32 v[216:217], v[216:217], v[88:89] op_sel:[0,1] op_sel_hi:[1,1]
v_pk_mul_f32 v[218:219], v[218:219], v[88:89] op_sel:[0,1] op_sel_hi:[1,1]
v_pk_mul_f32 v[224:225], v[224:225], v[88:89] op_sel:[0,1] op_sel_hi:[1,1]
v_pk_mul_f32 v[226:227], v[226:227], v[88:89] op_sel:[0,1] op_sel_hi:[1,1]
v_pk_mul_f32 v[200:201], v[200:201], v[86:87] op_sel:[0,1] op_sel_hi:[1,1]
v_pk_mul_f32 v[202:203], v[202:203], v[86:87] op_sel:[0,1] op_sel_hi:[1,1]
v_pk_mul_f32 v[176:177], v[176:177], v[84:85] op_sel:[0,1] op_sel_hi:[1,1]
v_pk_mul_f32 v[178:179], v[178:179], v[84:85] op_sel:[0,1] op_sel_hi:[1,1]
v_pk_mul_f32 v[152:153], v[152:153], v[82:83] op_sel:[0,1] op_sel_hi:[1,1]
v_pk_mul_f32 v[154:155], v[154:155], v[82:83] op_sel:[0,1] op_sel_hi:[1,1]
v_cvt_pk_bf16_f32 v228, v228, v229
v_cvt_pk_bf16_f32 v213, v214, v215
v_cvt_pk_bf16_f32 v221, v222, v223
v_cvt_pk_bf16_f32 v197, v198, v199
v_cvt_pk_bf16_f32 v173, v174, v175
v_cvt_pk_bf16_f32 v149, v150, v151
v_pk_mul_f32 v[188:189], v[188:189], v[86:87] op_sel:[0,1] op_sel_hi:[1,1]
v_pk_mul_f32 v[164:165], v[164:165], v[84:85] op_sel:[0,1] op_sel_hi:[1,1]
v_pk_mul_f32 v[140:141], v[140:141], v[82:83] op_sel:[0,1] op_sel_hi:[1,1]
v_add_u32 v232, s36, v7
v_add_u32 v233, s37, v1
buffer_load_dwordx4 v1, s[4:7], s44 offen offset:2048 sc1 lds
v_cvt_pk_bf16_f32 v229, v230, v231
v_cvt_pk_bf16_f32 v214, v216, v217
v_cvt_pk_bf16_f32 v215, v218, v219
v_cvt_pk_bf16_f32 v222, v224, v225
v_cvt_pk_bf16_f32 v223, v226, v227
v_cvt_pk_bf16_f32 v198, v200, v201
v_cvt_pk_bf16_f32 v199, v202, v203
v_cvt_pk_bf16_f32 v174, v176, v177
v_cvt_pk_bf16_f32 v175, v178, v179
v_cvt_pk_bf16_f32 v150, v152, v153
v_cvt_pk_bf16_f32 v151, v154, v155
v_pk_mul_f32 v[190:191], v[190:191], v[86:87] op_sel:[0,1] op_sel_hi:[1,1]
v_pk_mul_f32 v[166:167], v[166:167], v[84:85] op_sel:[0,1] op_sel_hi:[1,1]
v_pk_mul_f32 v[142:143], v[142:143], v[82:83] op_sel:[0,1] op_sel_hi:[1,1]
v_cvt_pk_bf16_f32 v188, v188, v189
v_cvt_pk_bf16_f32 v164, v164, v165
v_cvt_pk_bf16_f32 v140, v140, v141
v_cvt_pk_bf16_f32 v132, v132, v133
v_cvt_pk_bf16_f32 v156, v156, v157
v_cvt_pk_bf16_f32 v180, v180, v181
v_cvt_pk_bf16_f32 v204, v204, v205
ds_write_b64 v9, v[228:229]
ds_write_b64 v232, v[220:221] offset:4096
buffer_load_dwordx4 v1, s[4:7], s44 offen offset:3072 sc1 lds
s_add_u32 m0, s19, 114688
s_add_u32 s44, s85, 0xa14000
ds_write_b64 v232, v[222:223] offset:4608
v_pk_mul_f32 v[192:193], v[192:193], v[86:87] op_sel:[0,1] op_sel_hi:[1,1]
v_pk_mul_f32 v[194:195], v[194:195], v[86:87] op_sel:[0,1] op_sel_hi:[1,1]
ds_write_b64 v232, v[196:197] offset:3072
ds_write_b64 v232, v[198:199] offset:3584
v_pk_mul_f32 v[168:169], v[168:169], v[84:85] op_sel:[0,1] op_sel_hi:[1,1]
v_pk_mul_f32 v[170:171], v[170:171], v[84:85] op_sel:[0,1] op_sel_hi:[1,1]
ds_write_b64 v232, v[172:173] offset:2048
v_pk_mul_f32 v[144:145], v[144:145], v[82:83] op_sel:[0,1] op_sel_hi:[1,1]
v_pk_mul_f32 v[146:147], v[146:147], v[82:83] op_sel:[0,1] op_sel_hi:[1,1]
v_cvt_pk_bf16_f32 v189, v190, v191
ds_write_b64 v232, v[174:175] offset:2560
v_cvt_pk_bf16_f32 v165, v166, v167
v_cvt_pk_bf16_f32 v141, v142, v143
v_cvt_pk_bf16_f32 v133, v134, v135
buffer_load_dwordx4 v1, s[4:7], s44 offen offset:0 sc1 lds
v_cvt_pk_bf16_f32 v157, v158, v159
ds_write_b64 v232, v[148:149] offset:1024
ds_write_b64 v232, v[150:151] offset:1536
v_cvt_pk_bf16_f32 v181, v182, v183
v_cvt_pk_bf16_f32 v205, v206, v207
ds_write_b128 v233, v[212:215] offset:21504
v_cvt_pk_bf16_f32 v190, v192, v193
v_cvt_pk_bf16_f32 v191, v194, v195
v_cvt_pk_bf16_f32 v166, v168, v169
v_cvt_pk_bf16_f32 v167, v170, v171
v_cvt_pk_bf16_f32 v142, v144, v145
v_cvt_pk_bf16_f32 v143, v146, v147
v_cvt_pk_bf16_f32 v134, v136, v137
v_cvt_pk_bf16_f32 v135, v138, v139
v_cvt_pk_bf16_f32 v158, v160, v161
v_cvt_pk_bf16_f32 v159, v162, v163
v_cvt_pk_bf16_f32 v182, v184, v185
v_cvt_pk_bf16_f32 v183, v186, v187
v_cvt_pk_bf16_f32 v206, v208, v209
v_cvt_pk_bf16_f32 v207, v210, v211
buffer_load_dwordx4 v1, s[4:7], s44 offen offset:1024 sc1 lds
buffer_load_dwordx4 v1, s[4:7], s44 offen offset:2048 sc1 lds
buffer_load_dwordx4 v1, s[4:7], s44 offen offset:3072 sc1 lds
s_waitcnt lgkmcnt(0)
s_barrier
s_lshl_b32 s35, s30, 12
s_add_u32 s35, s35, 0x1e00000
s_add_u32 m0, s19, 131072
s_add_u32 s44, s86, 0xa18000
buffer_load_dwordx4 v1, s[4:7], s44 offen offset:0 sc1 lds
v_mfma_f32_16x16x32_bf16 v[184:187], v[164:167], v[180:183], v[20:23]
ds_read_b128 a[0:3], v233 offset:20480
v_mfma_f32_16x16x32_bf16 v[200:203], v[188:191], v[180:183], v[24:27]
v_add_u32 v234, s36, v8
ds_read_b64_tr_b16 a[10:11], v234 offset:3072
v_mfma_f32_16x16x32_bf16 v[208:211], v[188:191], v[204:207], v[20:23]
ds_read_b64_tr_b16 a[12:13], v234 offset:4096
v_mfma_f32_16x16x32_bf16 v[224:227], v[212:215], v[204:207], v[24:27]
s_nop 2
v_max_f32 v200, v200, v184
v_max_f32 v201, v201, v185
v_max_f32 v202, v202, v186
v_max_f32 v203, v203, v187
v_max3_f32 v238, v200, v201, v202
v_max_f32 v238, v238, v203
ds_read_b64_tr_b16 a[22:23], v234 offset:3584
v_max_f32 v224, v224, v208
v_max_f32 v225, v225, v209
v_max_f32 v226, v226, v210
v_max_f32 v227, v227, v211
buffer_load_dwordx4 v1, s[4:7], s44 offen offset:1024 sc1 lds
v_max3_f32 v239, v224, v225, v226
v_max_f32 v239, v239, v227
ds_read_b64_tr_b16 a[24:25], v234 offset:4608
s_nop 0
v_permlane32_swap_b32 v239, v238
v_max_f32 v239, v239, v238
v_mov_b32 v242, v239
s_waitcnt lgkmcnt(4)
v_mfma_f32_16x16x32_bf16 v[136:139], a[0:3], v[132:135], v[76:79]
v_permlane16_swap_b32 v239, v242
v_max_f32 v239, v239, v242
v_mov_b32 v242, v239
v_mfma_f32_16x16x32_bf16 v[152:155], v[140:143], v[132:135], v[24:27]
s_nop 0
v_permlane32_swap_b32 v239, v242
v_mfma_f32_16x16x32_bf16 v[160:163], v[140:143], v[156:159], v[20:23]
v_mul_f32 v88, 0x3e8293ee, v89
v_mul_f32_e64 v89, -v239, v88
v_mfma_f32_16x16x32_bf16 v[176:179], v[164:167], v[156:159], v[24:27]
v_fma_f32 v224, v224, v88, v89
v_fma_f32 v225, v225, v88, v89
v_fma_f32 v226, v226, v88, v89
buffer_load_dwordx4 v1, s[4:7], s44 offen offset:2048 sc1 lds
v_fma_f32 v227, v227, v88, v89
v_exp_f32 v224, v224
v_exp_f32 v225, v225
v_exp_f32 v226, v226
v_exp_f32 v227, v227
v_max_f32 v152, v152, v136
v_max_f32 v153, v153, v137
v_max_f32 v154, v154, v138
v_max_f32 v176, v176, v160
v_max_f32 v177, v177, v161
v_max_f32 v178, v178, v162
v_cvt_pk_bf16_f32 v224, v224, v225
ds_read_b64_tr_b16 a[8:9], v234 offset:2048
v_max_f32 v155, v155, v139
v_max3_f32 v236, v152, v153, v154
v_max_f32 v179, v179, v163
v_max3_f32 v237, v176, v177, v178
v_cvt_pk_bf16_f32 v225, v226, v227
ds_read_b64_tr_b16 a[20:21], v234 offset:2560
v_max_f32 v236, v236, v155
v_max_f32 v237, v237, v179
buffer_load_dwordx4 v1, s[4:7], s44 offen offset:3072 sc1 lds
s_add_u32 m0, s19, 147456
s_add_u32 s44, s87, 0xa1c000
v_and_b32 v208, v224, v28
v_and_b32 v209, v225, v29
v_and_b32 v210, v224, v30
v_and_b32 v211, v225, v31
v_permlane32_swap_b32 v237, v236
s_nop 0
v_mfma_f32_16x16x32_bf16 v[216:219], v[16:19], v[208:211], 0
v_mul_f32 v86, 0x3e8293ee, v87
v_max_f32 v237, v237, v236
v_mul_f32_e64 v87, -v242, v86
s_waitcnt lgkmcnt(4)
v_mfma_f32_16x16x32_bf16 v[116:119], a[10:13], v[208:211], 0
v_mov_b32 v243, v237
v_fma_f32 v200, v200, v86, v87
v_fma_f32 v201, v201, v86, v87
v_fma_f32 v202, v202, v86, v87
v_fma_f32 v203, v203, v86, v87
s_waitcnt lgkmcnt(2)
v_mfma_f32_16x16x32_bf16 v[120:123], a[22:25], v[208:211], 0
v_exp_f32 v200, v200
v_exp_f32 v201, v201
v_exp_f32 v202, v202
buffer_load_dwordx4 v1, s[4:7], s44 offen offset:0 sc1 lds
v_exp_f32 v203, v203
v_permlane16_swap_b32 v237, v243
v_rcp_f32 v216, v216
v_cvt_pk_bf16_f32 v200, v200, v201
ds_read_b64_tr_b16 a[6:7], v234 offset:1024
v_max_f32 v237, v237, v243
v_cvt_pk_bf16_f32 v201, v202, v203
ds_read_b64_tr_b16 a[18:19], v234 offset:1536
v_mov_b32 v243, v237
v_and_b32 v184, v200, v28
v_and_b32 v185, v201, v29
v_and_b32 v186, v200, v30
v_and_b32 v187, v201, v31
v_pk_mul_f32 v[116:117], v[116:117], v[216:217] op_sel:[0,0] op_sel_hi:[1,0]
v_pk_mul_f32 v[118:119], v[118:119], v[216:217] op_sel:[0,0] op_sel_hi:[1,0]
v_cvt_pk_bf16_f32 v116, v116, v117
v_pk_mul_f32 v[120:121], v[120:121], v[216:217] op_sel:[0,0] op_sel_hi:[1,0]
v_permlane32_swap_b32 v237, v243
v_pk_mul_f32 v[122:123], v[122:123], v[216:217] op_sel:[0,0] op_sel_hi:[1,0]
v_cvt_pk_bf16_f32 v117, v118, v119
v_mfma_f32_16x16x32_bf16 v[192:195], v[16:19], v[184:187], 0
buffer_load_dwordx4 v1, s[4:7], s44 offen offset:1024 sc1 lds
v_cvt_pk_bf16_f32 v118, v120, v121
v_cvt_pk_bf16_f32 v119, v122, v123
v_mul_f32 v84, 0x3e8293ee, v85
v_mul_f32_e64 v85, -v237, v84
s_waitcnt lgkmcnt(3)
v_mfma_f32_16x16x32_bf16 v[108:111], a[8:11], v[184:187], 0
v_fma_f32 v176, v176, v84, v85
v_fma_f32 v177, v177, v84, v85
v_fma_f32 v178, v178, v84, v85
v_fma_f32 v179, v179, v84, v85
s_waitcnt lgkmcnt(2)
v_mfma_f32_16x16x32_bf16 v[112:115], a[20:23], v[184:187], 0
v_exp_f32 v176, v176
v_exp_f32 v177, v177
v_exp_f32 v178, v178
v_exp_f32 v179, v179
v_rcp_f32 v192, v192
v_cvt_pk_bf16_f32 v176, v176, v177
ds_read_b64_tr_b16 a[4:5], v234 offset:0
v_cvt_pk_bf16_f32 v177, v178, v179
ds_read_b64_tr_b16 a[16:17], v234 offset:512
buffer_load_dwordx4 v1, s[4:7], s44 offen offset:2048 sc1 lds
v_and_b32 v160, v176, v28
v_and_b32 v161, v177, v29
v_and_b32 v162, v176, v30
v_and_b32 v163, v177, v31
v_pk_mul_f32 v[108:109], v[108:109], v[192:193] op_sel:[0,0] op_sel_hi:[1,0]
v_pk_mul_f32 v[110:111], v[110:111], v[192:193] op_sel:[0,0] op_sel_hi:[1,0]
v_cvt_pk_bf16_f32 v108, v108, v109
v_pk_mul_f32 v[112:113], v[112:113], v[192:193] op_sel:[0,0] op_sel_hi:[1,0]
v_cvt_pk_bf16_f32 v109, v110, v111
v_pk_mul_f32 v[114:115], v[114:115], v[192:193] op_sel:[0,0] op_sel_hi:[1,0]
v_cvt_pk_bf16_f32 v110, v112, v113
v_mfma_f32_16x16x32_bf16 v[168:171], v[16:19], v[160:163], 0
v_cvt_pk_bf16_f32 v111, v114, v115
v_mul_f32 v82, 0x3e8293ee, v83
v_mul_f32_e64 v83, -v243, v82
s_waitcnt lgkmcnt(3)
v_mfma_f32_16x16x32_bf16 v[100:103], a[6:9], v[160:163], 0
v_fma_f32 v152, v152, v82, v83
v_fma_f32 v153, v153, v82, v83
v_fma_f32 v154, v154, v82, v83
v_fma_f32 v155, v155, v82, v83
s_waitcnt lgkmcnt(2)
v_mfma_f32_16x16x32_bf16 v[104:107], a[18:21], v[160:163], 0
v_exp_f32 v152, v152
v_exp_f32 v153, v153
buffer_load_dwordx4 v1, s[4:7], s44 offen offset:3072 sc1 lds
v_exp_f32 v154, v154
v_exp_f32 v155, v155
v_rcp_f32 v168, v168
v_cvt_pk_bf16_f32 v152, v152, v153
v_cvt_pk_bf16_f32 v153, v154, v155
v_and_b32 v136, v152, v80
v_and_b32 v137, v153, v81
v_and_b32 v138, v152, v30
v_and_b32 v139, v153, v31
v_pk_mul_f32 v[100:101], v[100:101], v[168:169] op_sel:[0,0] op_sel_hi:[1,0]
v_pk_mul_f32 v[102:103], v[102:103], v[168:169] op_sel:[0,0] op_sel_hi:[1,0]
v_cvt_pk_bf16_f32 v100, v100, v101
v_pk_mul_f32 v[104:105], v[104:105], v[168:169] op_sel:[0,0] op_sel_hi:[1,0]
v_cvt_pk_bf16_f32 v101, v102, v103
v_pk_mul_f32 v[106:107], v[106:107], v[168:169] op_sel:[0,0] op_sel_hi:[1,0]
v_cvt_pk_bf16_f32 v102, v104, v105
v_mfma_f32_16x16x32_bf16 v[144:147], v[16:19], v[136:139], 0
v_cvt_pk_bf16_f32 v103, v106, v107
s_waitcnt lgkmcnt(1)
v_mfma_f32_16x16x32_bf16 v[92:95], a[4:7], v[136:139], 0
buffer_store_dwordx4 v[116:119], v2, s[4:7], s35 offen offset:3072 sc1
s_waitcnt lgkmcnt(0)
v_mfma_f32_16x16x32_bf16 v[96:99], a[16:19], v[136:139], 0
s_nop 1
v_rcp_f32 v144, v144
s_nop 1
v_pk_mul_f32 v[92:93], v[92:93], v[144:145] op_sel:[0,0] op_sel_hi:[1,0]
v_pk_mul_f32 v[94:95], v[94:95], v[144:145] op_sel:[0,0] op_sel_hi:[1,0]
v_cvt_pk_bf16_f32 v92, v92, v93
v_cvt_pk_bf16_f32 v93, v94, v95
v_pk_mul_f32 v[96:97], v[96:97], v[144:145] op_sel:[0,0] op_sel_hi:[1,0]
v_pk_mul_f32 v[98:99], v[98:99], v[144:145] op_sel:[0,0] op_sel_hi:[1,0]
buffer_store_dwordx4 v[108:111], v2, s[4:7], s35 offen offset:2048 sc1
v_cvt_pk_bf16_f32 v94, v96, v97
v_cvt_pk_bf16_f32 v95, v98, v99
buffer_store_dwordx4 v[100:103], v2, s[4:7], s35 offen offset:1024 sc1
buffer_store_dwordx4 v[92:95], v2, s[4:7], s35 offen offset:0 sc1
s_add_u32 s92, s71, 0x0
s_add_u32 s40, s4, 0x1e00000
s_addc_u32 s41, s5, 0
v_add_u32 v5, 32768, v1
v_add_u32 v6, 98304, v1
s_cmp_eq_u32 s3, 0
s_cselect_b32 s35, 8, 0
s_lshl_b32 s35, s35, 12
v_lshlrev_b32 v132, 16, v32
v_and_b32 v133, 0xffff0000, v32
v_lshlrev_b32 v134, 16, v33
v_and_b32 v135, 0xffff0000, v33
v_lshlrev_b32 v136, 16, v34
v_and_b32 v137, 0xffff0000, v34
v_lshlrev_b32 v138, 16, v35
v_and_b32 v139, 0xffff0000, v35
v_lshlrev_b32 v140, 16, v36
v_and_b32 v141, 0xffff0000, v36
v_lshlrev_b32 v142, 16, v37
v_and_b32 v143, 0xffff0000, v37
v_lshlrev_b32 v144, 16, v38
v_and_b32 v145, 0xffff0000, v38
v_lshlrev_b32 v146, 16, v39
v_and_b32 v147, 0xffff0000, v39
v_lshlrev_b32 v148, 16, v40
v_and_b32 v149, 0xffff0000, v40
v_lshlrev_b32 v150, 16, v41
v_and_b32 v151, 0xffff0000, v41
v_lshlrev_b32 v152, 16, v42
v_and_b32 v153, 0xffff0000, v42
v_lshlrev_b32 v154, 16, v43
v_and_b32 v155, 0xffff0000, v43
v_lshlrev_b32 v156, 16, v44
v_and_b32 v157, 0xffff0000, v44
v_lshlrev_b32 v158, 16, v45
v_and_b32 v159, 0xffff0000, v45
v_lshlrev_b32 v160, 16, v46
v_and_b32 v161, 0xffff0000, v46
v_lshlrev_b32 v162, 16, v47
v_and_b32 v163, 0xffff0000, v47
s_waitcnt vmcnt(0)
s_barrier
s_cmp_lg_u32 s28, 1
s_cbranch_scc1 Lsg_4
buffer_atomic_add v12, v10, s[4:7], s92 offen sc1
buffer_atomic_swap v15, v14, s[4:7], s8 offen sc1
buffer_atomic_swap v15, v252, s[4:7], s62 offen offset:64 sc1
Lsg_4:
s_cmp_lg_u32 s28, 1
s_cbranch_scc1 L_wskip1
s_mov_b64 exec, 0
s_branch L_stub3
L_wret1:
s_mov_b64 exec, -1
L_wskip1:
s_cmp_lg_u32 s28, 0
s_cbranch_scc1 Lpe_6
s_add_u32 s36, s66, 0x0
s_mov_b32 s37, 0
Lpoll_5:
v_mov_b32 v11, 0
buffer_atomic_add v11, v251, s[4:7], s36 offen sc0 sc1
s_add_u32 s37, s37, 1
s_waitcnt vmcnt(0)
v_readfirstlane_b32 s38, v11
s_nop 0
s_cmp_ge_u32 s38, 32
s_cbranch_scc1 Lpe_6
s_cmp_lt_u32 s37, 0x100000
s_cbranch_scc1 Lpoll_5
Lpe_6:
s_waitcnt vmcnt(0)
s_barrier
L_k2go0:
buffer_load_dwordx4 a[0:3], v4, s[40:43], s35 offen offset:0 sc1
buffer_load_dwordx4 a[4:7], v4, s[40:43], s35 offen offset:1024 sc1
s_cmp_eq_u32 s3, 1
s_cselect_b32 s35, 9, 1
s_lshl_b32 s35, s35, 12
buffer_load_dwordx4 a[8:11], v4, s[40:43], s35 offen offset:0 sc1
buffer_load_dwordx4 a[12:15], v4, s[40:43], s35 offen offset:1024 sc1
s_cmp_eq_u32 s3, 2
s_cselect_b32 s35, 10, 2
s_lshl_b32 s35, s35, 12
buffer_load_dwordx4 a[16:19], v4, s[40:43], s35 offen offset:0 sc1
buffer_load_dwordx4 a[20:23], v4, s[40:43], s35 offen offset:1024 sc1
s_cmp_eq_u32 s3, 3
s_cselect_b32 s35, 11, 3
s_lshl_b32 s35, s35, 12
buffer_load_dwordx4 a[24:27], v4, s[40:43], s35 offen offset:0 sc1
buffer_load_dwordx4 a[28:31], v4, s[40:43], s35 offen offset:1024 sc1
s_cmp_eq_u32 s3, 4
s_cselect_b32 s35, 12, 4
s_lshl_b32 s35, s35, 12
buffer_load_dwordx4 a[32:35], v4, s[40:43], s35 offen offset:0 sc1
buffer_load_dwordx4 a[36:39], v4, s[40:43], s35 offen offset:1024 sc1
s_cmp_eq_u32 s3, 5
s_cselect_b32 s35, 13, 5
s_lshl_b32 s35, s35, 12
ds_read_b128 a[96:99], v5 offset:0
ds_read_b128 a[100:103], v5 offset:1024
ds_read_b128 a[104:107], v5 offset:2048
ds_read_b128 a[108:111], v5 offset:3072
ds_read_b128 a[112:115], v5 offset:4096
ds_read_b128 a[116:119], v5 offset:5120
ds_read_b128 a[120:123], v5 offset:6144
ds_read_b128 a[124:127], v5 offset:7168
s_waitcnt vmcnt(8) lgkmcnt(4)
v_mfma_f32_16x16x32_bf16 v[132:135], a[96:99], a[0:3], v[132:135]
ds_read_b128 a[128:131], v5 offset:8192
v_mfma_f32_16x16x32_bf16 v[148:151], a[96:99], a[4:7], v[148:151]
ds_read_b128 a[132:135], v5 offset:9216
v_mfma_f32_16x16x32_bf16 v[152:155], a[100:103], a[4:7], v[152:155]
buffer_load_dwordx4 a[40:43], v4, s[40:43], s35 offen offset:0 sc1
v_mfma_f32_16x16x32_bf16 v[136:139], a[100:103], a[0:3], v[136:139]
ds_read_b128 a[136:139], v5 offset:10240
v_mfma_f32_16x16x32_bf16 v[140:143], a[104:107], a[0:3], v[140:143]
ds_read_b128 a[140:143], v5 offset:11264
v_mfma_f32_16x16x32_bf16 v[156:159], a[104:107], a[4:7], v[156:159]
v_mfma_f32_16x16x32_bf16 v[160:163], a[108:111], a[4:7], v[160:163]
buffer_load_dwordx4 a[44:47], v4, s[40:43], s35 offen offset:1024 sc1
v_mfma_f32_16x16x32_bf16 v[144:147], a[108:111], a[0:3], v[144:147]
s_waitcnt vmcnt(8) lgkmcnt(4)
v_mfma_f32_16x16x32_bf16 v[132:135], a[112:115], a[8:11], v[132:135]
s_cmp_eq_u32 s3, 6
s_cselect_b32 s35, 14, 6
s_lshl_b32 s35, s35, 12
v_mfma_f32_16x16x32_bf16 v[148:151], a[112:115], a[12:15], v[148:151]
ds_read_b128 a[96:99], v5 offset:12288
v_mfma_f32_16x16x32_bf16 v[152:155], a[116:119], a[12:15], v[152:155]
buffer_load_dwordx4 a[0:3], v4, s[40:43], s35 offen offset:0 sc1
v_mfma_f32_16x16x32_bf16 v[136:139], a[116:119], a[8:11], v[136:139]
ds_read_b128 a[100:103], v5 offset:13312
v_mfma_f32_16x16x32_bf16 v[140:143], a[120:123], a[8:11], v[140:143]
ds_read_b128 a[104:107], v5 offset:14336
v_mfma_f32_16x16x32_bf16 v[156:159], a[120:123], a[12:15], v[156:159]
ds_read_b128 a[108:111], v5 offset:15360
v_mfma_f32_16x16x32_bf16 v[160:163], a[124:127], a[12:15], v[160:163]
buffer_load_dwordx4 a[4:7], v4, s[40:43], s35 offen offset:1024 sc1
v_mfma_f32_16x16x32_bf16 v[144:147], a[124:127], a[8:11], v[144:147]
s_waitcnt vmcnt(8) lgkmcnt(4)
v_mfma_f32_16x16x32_bf16 v[132:135], a[128:131], a[16:19], v[132:135]
s_cmp_eq_u32 s3, 7
s_cselect_b32 s35, 15, 7
s_lshl_b32 s35, s35, 12
v_mfma_f32_16x16x32_bf16 v[148:151], a[128:131], a[20:23], v[148:151]
ds_read_b128 a[112:115], v5 offset:16384
v_mfma_f32_16x16x32_bf16 v[152:155], a[132:135], a[20:23], v[152:155]
buffer_load_dwordx4 a[8:11], v4, s[40:43], s35 offen offset:0 sc1
v_mfma_f32_16x16x32_bf16 v[136:139], a[132:135], a[16:19], v[136:139]
ds_read_b128 a[116:119], v5 offset:17408
v_mfma_f32_16x16x32_bf16 v[140:143], a[136:139], a[16:19], v[140:143]
ds_read_b128 a[120:123], v5 offset:18432
v_mfma_f32_16x16x32_bf16 v[156:159], a[136:139], a[20:23], v[156:159]
ds_read_b128 a[124:127], v5 offset:19456
v_mfma_f32_16x16x32_bf16 v[160:163], a[140:143], a[20:23], v[160:163]
buffer_load_dwordx4 a[12:15], v4, s[40:43], s35 offen offset:1024 sc1
v_mfma_f32_16x16x32_bf16 v[144:147], a[140:143], a[16:19], v[144:147]
L_stub3:
s_cbranch_execz L_wret1
s_waitcnt vmcnt(8) lgkmcnt(4)
v_mfma_f32_16x16x32_bf16 v[132:135], a[96:99], a[24:27], v[132:135]
s_cmp_eq_u32 s3, 0
s_cselect_b32 s35, 16, 8
s_lshl_b32 s35, s35, 12
v_mfma_f32_16x16x32_bf16 v[148:151], a[96:99], a[28:31], v[148:151]
ds_read_b128 a[128:131], v5 offset:20480
v_mfma_f32_16x16x32_bf16 v[152:155], a[100:103], a[28:31], v[152:155]
buffer_load_dwordx4 a[16:19], v4, s[40:43], s35 offen offset:0 sc1
v_mfma_f32_16x16x32_bf16 v[136:139], a[100:103], a[24:27], v[136:139]
ds_read_b128 a[132:135], v5 offset:21504
v_mfma_f32_16x16x32_bf16 v[140:143], a[104:107], a[24:27], v[140:143]
ds_read_b128 a[136:139], v5 offset:22528
v_mfma_f32_16x16x32_bf16 v[156:159], a[104:107], a[28:31], v[156:159]
ds_read_b128 a[140:143], v5 offset:23552
v_mfma_f32_16x16x32_bf16 v[160:163], a[108:111], a[28:31], v[160:163]
buffer_load_dwordx4 a[20:23], v4, s[40:43], s35 offen offset:1024 sc1
v_mfma_f32_16x16x32_bf16 v[144:147], a[108:111], a[24:27], v[144:147]
s_waitcnt vmcnt(8) lgkmcnt(4)
v_mfma_f32_16x16x32_bf16 v[132:135], a[112:115], a[32:35], v[132:135]
s_cmp_eq_u32 s3, 1
s_cselect_b32 s35, 17, 9
s_lshl_b32 s35, s35, 12
v_mfma_f32_16x16x32_bf16 v[148:151], a[112:115], a[36:39], v[148:151]
ds_read_b128 a[96:99], v5 offset:24576
v_mfma_f32_16x16x32_bf16 v[152:155], a[116:119], a[36:39], v[152:155]
buffer_load_dwordx4 a[24:27], v4, s[40:43], s35 offen offset:0 sc1
v_mfma_f32_16x16x32_bf16 v[136:139], a[116:119], a[32:35], v[136:139]
ds_read_b128 a[100:103], v5 offset:25600
v_mfma_f32_16x16x32_bf16 v[140:143], a[120:123], a[32:35], v[140:143]
ds_read_b128 a[104:107], v5 offset:26624
v_mfma_f32_16x16x32_bf16 v[156:159], a[120:123], a[36:39], v[156:159]
ds_read_b128 a[108:111], v5 offset:27648
v_mfma_f32_16x16x32_bf16 v[160:163], a[124:127], a[36:39], v[160:163]
buffer_load_dwordx4 a[28:31], v4, s[40:43], s35 offen offset:1024 sc1
v_mfma_f32_16x16x32_bf16 v[144:147], a[124:127], a[32:35], v[144:147]
s_waitcnt vmcnt(8) lgkmcnt(4)
v_mfma_f32_16x16x32_bf16 v[132:135], a[128:131], a[40:43], v[132:135]
s_cmp_eq_u32 s3, 2
s_cselect_b32 s35, 18, 10
s_lshl_b32 s35, s35, 12
v_mfma_f32_16x16x32_bf16 v[148:151], a[128:131], a[44:47], v[148:151]
ds_read_b128 a[112:115], v5 offset:28672
v_mfma_f32_16x16x32_bf16 v[152:155], a[132:135], a[44:47], v[152:155]
buffer_load_dwordx4 a[32:35], v4, s[40:43], s35 offen offset:0 sc1
v_mfma_f32_16x16x32_bf16 v[136:139], a[132:135], a[40:43], v[136:139]
ds_read_b128 a[116:119], v5 offset:29696
v_mfma_f32_16x16x32_bf16 v[140:143], a[136:139], a[40:43], v[140:143]
ds_read_b128 a[120:123], v5 offset:30720
v_mfma_f32_16x16x32_bf16 v[156:159], a[136:139], a[44:47], v[156:159]
ds_read_b128 a[124:127], v5 offset:31744
v_mfma_f32_16x16x32_bf16 v[160:163], a[140:143], a[44:47], v[160:163]
buffer_load_dwordx4 a[36:39], v4, s[40:43], s35 offen offset:1024 sc1
v_mfma_f32_16x16x32_bf16 v[144:147], a[140:143], a[40:43], v[144:147]
s_waitcnt vmcnt(8) lgkmcnt(4)
v_mfma_f32_16x16x32_bf16 v[132:135], a[96:99], a[0:3], v[132:135]
s_cmp_eq_u32 s3, 3
s_cselect_b32 s35, 19, 11
s_lshl_b32 s35, s35, 12
v_mfma_f32_16x16x32_bf16 v[148:151], a[96:99], a[4:7], v[148:151]
ds_read_b128 a[128:131], v5 offset:32768
v_mfma_f32_16x16x32_bf16 v[152:155], a[100:103], a[4:7], v[152:155]
buffer_load_dwordx4 a[40:43], v4, s[40:43], s35 offen offset:0 sc1
v_mfma_f32_16x16x32_bf16 v[136:139], a[100:103], a[0:3], v[136:139]
ds_read_b128 a[132:135], v5 offset:33792
v_mfma_f32_16x16x32_bf16 v[140:143], a[104:107], a[0:3], v[140:143]
ds_read_b128 a[136:139], v5 offset:34816
v_mfma_f32_16x16x32_bf16 v[156:159], a[104:107], a[4:7], v[156:159]
ds_read_b128 a[140:143], v5 offset:35840
v_mfma_f32_16x16x32_bf16 v[160:163], a[108:111], a[4:7], v[160:163]
buffer_load_dwordx4 a[44:47], v4, s[40:43], s35 offen offset:1024 sc1
v_mfma_f32_16x16x32_bf16 v[144:147], a[108:111], a[0:3], v[144:147]
s_waitcnt vmcnt(8) lgkmcnt(4)
v_mfma_f32_16x16x32_bf16 v[132:135], a[112:115], a[8:11], v[132:135]
s_cmp_eq_u32 s3, 4
s_cselect_b32 s35, 20, 12
s_lshl_b32 s35, s35, 12
v_mfma_f32_16x16x32_bf16 v[148:151], a[112:115], a[12:15], v[148:151]
ds_read_b128 a[96:99], v5 offset:36864
v_mfma_f32_16x16x32_bf16 v[152:155], a[116:119], a[12:15], v[152:155]
buffer_load_dwordx4 a[0:3], v4, s[40:43], s35 offen offset:0 sc1
v_mfma_f32_16x16x32_bf16 v[136:139], a[116:119], a[8:11], v[136:139]
ds_read_b128 a[100:103], v5 offset:37888
v_mfma_f32_16x16x32_bf16 v[140:143], a[120:123], a[8:11], v[140:143]
ds_read_b128 a[104:107], v5 offset:38912
v_mfma_f32_16x16x32_bf16 v[156:159], a[120:123], a[12:15], v[156:159]
ds_read_b128 a[108:111], v5 offset:39936
v_mfma_f32_16x16x32_bf16 v[160:163], a[124:127], a[12:15], v[160:163]
buffer_load_dwordx4 a[4:7], v4, s[40:43], s35 offen offset:1024 sc1
v_mfma_f32_16x16x32_bf16 v[144:147], a[124:127], a[8:11], v[144:147]
s_waitcnt vmcnt(8) lgkmcnt(4)
v_mfma_f32_16x16x32_bf16 v[132:135], a[128:131], a[16:19], v[132:135]
s_cmp_eq_u32 s3, 5
s_cselect_b32 s35, 21, 13
s_lshl_b32 s35, s35, 12
v_mfma_f32_16x16x32_bf16 v[148:151], a[128:131], a[20:23], v[148:151]
ds_read_b128 a[112:115], v5 offset:40960
v_mfma_f32_16x16x32_bf16 v[152:155], a[132:135], a[20:23], v[152:155]
buffer_load_dwordx4 a[8:11], v4, s[40:43], s35 offen offset:0 sc1
v_mfma_f32_16x16x32_bf16 v[136:139], a[132:135], a[16:19], v[136:139]
ds_read_b128 a[116:119], v5 offset:41984
v_mfma_f32_16x16x32_bf16 v[140:143], a[136:139], a[16:19], v[140:143]
ds_read_b128 a[120:123], v5 offset:43008
v_mfma_f32_16x16x32_bf16 v[156:159], a[136:139], a[20:23], v[156:159]
ds_read_b128 a[124:127], v5 offset:44032
v_mfma_f32_16x16x32_bf16 v[160:163], a[140:143], a[20:23], v[160:163]
buffer_load_dwordx4 a[12:15], v4, s[40:43], s35 offen offset:1024 sc1
v_mfma_f32_16x16x32_bf16 v[144:147], a[140:143], a[16:19], v[144:147]
s_waitcnt vmcnt(8) lgkmcnt(4)
v_mfma_f32_16x16x32_bf16 v[132:135], a[96:99], a[24:27], v[132:135]
s_cmp_eq_u32 s3, 6
s_cselect_b32 s35, 22, 14
s_lshl_b32 s35, s35, 12
v_mfma_f32_16x16x32_bf16 v[148:151], a[96:99], a[28:31], v[148:151]
ds_read_b128 a[128:131], v5 offset:45056
v_mfma_f32_16x16x32_bf16 v[152:155], a[100:103], a[28:31], v[152:155]
buffer_load_dwordx4 a[16:19], v4, s[40:43], s35 offen offset:0 sc1
v_mfma_f32_16x16x32_bf16 v[136:139], a[100:103], a[24:27], v[136:139]
ds_read_b128 a[132:135], v5 offset:46080
v_mfma_f32_16x16x32_bf16 v[140:143], a[104:107], a[24:27], v[140:143]
ds_read_b128 a[136:139], v5 offset:47104
v_mfma_f32_16x16x32_bf16 v[156:159], a[104:107], a[28:31], v[156:159]
ds_read_b128 a[140:143], v5 offset:48128
v_mfma_f32_16x16x32_bf16 v[160:163], a[108:111], a[28:31], v[160:163]
buffer_load_dwordx4 a[20:23], v4, s[40:43], s35 offen offset:1024 sc1
v_mfma_f32_16x16x32_bf16 v[144:147], a[108:111], a[24:27], v[144:147]
s_waitcnt vmcnt(8) lgkmcnt(4)
v_mfma_f32_16x16x32_bf16 v[132:135], a[112:115], a[32:35], v[132:135]
s_cmp_eq_u32 s3, 7
s_cselect_b32 s35, 23, 15
s_lshl_b32 s35, s35, 12
v_mfma_f32_16x16x32_bf16 v[148:151], a[112:115], a[36:39], v[148:151]
ds_read_b128 a[96:99], v5 offset:49152
v_mfma_f32_16x16x32_bf16 v[152:155], a[116:119], a[36:39], v[152:155]
buffer_load_dwordx4 a[24:27], v4, s[40:43], s35 offen offset:0 sc1
v_mfma_f32_16x16x32_bf16 v[136:139], a[116:119], a[32:35], v[136:139]
ds_read_b128 a[100:103], v5 offset:50176
v_mfma_f32_16x16x32_bf16 v[140:143], a[120:123], a[32:35], v[140:143]
ds_read_b128 a[104:107], v5 offset:51200
v_mfma_f32_16x16x32_bf16 v[156:159], a[120:123], a[36:39], v[156:159]
ds_read_b128 a[108:111], v5 offset:52224
v_mfma_f32_16x16x32_bf16 v[160:163], a[124:127], a[36:39], v[160:163]
buffer_load_dwordx4 a[28:31], v4, s[40:43], s35 offen offset:1024 sc1
v_mfma_f32_16x16x32_bf16 v[144:147], a[124:127], a[32:35], v[144:147]
s_waitcnt vmcnt(8) lgkmcnt(4)
v_mfma_f32_16x16x32_bf16 v[132:135], a[128:131], a[40:43], v[132:135]
s_cmp_eq_u32 s3, 0
s_cselect_b32 s35, 24, 16
s_lshl_b32 s35, s35, 12
v_mfma_f32_16x16x32_bf16 v[148:151], a[128:131], a[44:47], v[148:151]
ds_read_b128 a[112:115], v5 offset:53248
v_mfma_f32_16x16x32_bf16 v[152:155], a[132:135], a[44:47], v[152:155]
buffer_load_dwordx4 a[32:35], v4, s[40:43], s35 offen offset:0 sc1
v_mfma_f32_16x16x32_bf16 v[136:139], a[132:135], a[40:43], v[136:139]
ds_read_b128 a[116:119], v5 offset:54272
v_mfma_f32_16x16x32_bf16 v[140:143], a[136:139], a[40:43], v[140:143]
ds_read_b128 a[120:123], v5 offset:55296
v_mfma_f32_16x16x32_bf16 v[156:159], a[136:139], a[44:47], v[156:159]
ds_read_b128 a[124:127], v5 offset:56320
v_mfma_f32_16x16x32_bf16 v[160:163], a[140:143], a[44:47], v[160:163]
buffer_load_dwordx4 a[36:39], v4, s[40:43], s35 offen offset:1024 sc1
v_mfma_f32_16x16x32_bf16 v[144:147], a[140:143], a[40:43], v[144:147]
s_waitcnt vmcnt(8) lgkmcnt(4)
v_mfma_f32_16x16x32_bf16 v[132:135], a[96:99], a[0:3], v[132:135]
s_cmp_eq_u32 s3, 1
s_cselect_b32 s35, 25, 17
s_lshl_b32 s35, s35, 12
v_mfma_f32_16x16x32_bf16 v[148:151], a[96:99], a[4:7], v[148:151]
ds_read_b128 a[128:131], v5 offset:57344
v_mfma_f32_16x16x32_bf16 v[152:155], a[100:103], a[4:7], v[152:155]
buffer_load_dwordx4 a[40:43], v4, s[40:43], s35 offen offset:0 sc1
v_mfma_f32_16x16x32_bf16 v[136:139], a[100:103], a[0:3], v[136:139]
ds_read_b128 a[132:135], v5 offset:58368
v_mfma_f32_16x16x32_bf16 v[140:143], a[104:107], a[0:3], v[140:143]
ds_read_b128 a[136:139], v5 offset:59392
v_mfma_f32_16x16x32_bf16 v[156:159], a[104:107], a[4:7], v[156:159]
ds_read_b128 a[140:143], v5 offset:60416
v_mfma_f32_16x16x32_bf16 v[160:163], a[108:111], a[4:7], v[160:163]
buffer_load_dwordx4 a[44:47], v4, s[40:43], s35 offen offset:1024 sc1
v_mfma_f32_16x16x32_bf16 v[144:147], a[108:111], a[0:3], v[144:147]
s_waitcnt vmcnt(8) lgkmcnt(4)
v_mfma_f32_16x16x32_bf16 v[132:135], a[112:115], a[8:11], v[132:135]
s_cmp_eq_u32 s3, 2
s_cselect_b32 s35, 26, 18
s_lshl_b32 s35, s35, 12
v_mfma_f32_16x16x32_bf16 v[148:151], a[112:115], a[12:15], v[148:151]
ds_read_b128 a[96:99], v5 offset:61440
v_mfma_f32_16x16x32_bf16 v[152:155], a[116:119], a[12:15], v[152:155]
buffer_load_dwordx4 a[0:3], v4, s[40:43], s35 offen offset:0 sc1
v_mfma_f32_16x16x32_bf16 v[136:139], a[116:119], a[8:11], v[136:139]
ds_read_b128 a[100:103], v5 offset:62464
v_mfma_f32_16x16x32_bf16 v[140:143], a[120:123], a[8:11], v[140:143]
ds_read_b128 a[104:107], v5 offset:63488
v_mfma_f32_16x16x32_bf16 v[156:159], a[120:123], a[12:15], v[156:159]
ds_read_b128 a[108:111], v5 offset:64512
v_mfma_f32_16x16x32_bf16 v[160:163], a[124:127], a[12:15], v[160:163]
buffer_load_dwordx4 a[4:7], v4, s[40:43], s35 offen offset:1024 sc1
v_mfma_f32_16x16x32_bf16 v[144:147], a[124:127], a[8:11], v[144:147]
s_waitcnt vmcnt(8) lgkmcnt(4)
v_mfma_f32_16x16x32_bf16 v[132:135], a[128:131], a[16:19], v[132:135]
s_cmp_eq_u32 s3, 3
s_cselect_b32 s35, 27, 19
s_lshl_b32 s35, s35, 12
v_mfma_f32_16x16x32_bf16 v[148:151], a[128:131], a[20:23], v[148:151]
ds_read_b128 a[112:115], v6 offset:0
v_mfma_f32_16x16x32_bf16 v[152:155], a[132:135], a[20:23], v[152:155]
buffer_load_dwordx4 a[8:11], v4, s[40:43], s35 offen offset:0 sc1
v_mfma_f32_16x16x32_bf16 v[136:139], a[132:135], a[16:19], v[136:139]
ds_read_b128 a[116:119], v6 offset:1024
v_mfma_f32_16x16x32_bf16 v[140:143], a[136:139], a[16:19], v[140:143]
ds_read_b128 a[120:123], v6 offset:2048
v_mfma_f32_16x16x32_bf16 v[156:159], a[136:139], a[20:23], v[156:159]
ds_read_b128 a[124:127], v6 offset:3072
v_mfma_f32_16x16x32_bf16 v[160:163], a[140:143], a[20:23], v[160:163]
buffer_load_dwordx4 a[12:15], v4, s[40:43], s35 offen offset:1024 sc1
v_mfma_f32_16x16x32_bf16 v[144:147], a[140:143], a[16:19], v[144:147]
s_waitcnt vmcnt(8) lgkmcnt(4)
v_mfma_f32_16x16x32_bf16 v[132:135], a[96:99], a[24:27], v[132:135]
s_cmp_eq_u32 s3, 4
s_cselect_b32 s35, 28, 20
s_lshl_b32 s35, s35, 12
v_mfma_f32_16x16x32_bf16 v[148:151], a[96:99], a[28:31], v[148:151]
ds_read_b128 a[128:131], v6 offset:4096
v_mfma_f32_16x16x32_bf16 v[152:155], a[100:103], a[28:31], v[152:155]
buffer_load_dwordx4 a[16:19], v4, s[40:43], s35 offen offset:0 sc1
v_mfma_f32_16x16x32_bf16 v[136:139], a[100:103], a[24:27], v[136:139]
ds_read_b128 a[132:135], v6 offset:5120
v_mfma_f32_16x16x32_bf16 v[140:143], a[104:107], a[24:27], v[140:143]
ds_read_b128 a[136:139], v6 offset:6144
v_mfma_f32_16x16x32_bf16 v[156:159], a[104:107], a[28:31], v[156:159]
ds_read_b128 a[140:143], v6 offset:7168
v_mfma_f32_16x16x32_bf16 v[160:163], a[108:111], a[28:31], v[160:163]
buffer_load_dwordx4 a[20:23], v4, s[40:43], s35 offen offset:1024 sc1
v_mfma_f32_16x16x32_bf16 v[144:147], a[108:111], a[24:27], v[144:147]
s_waitcnt vmcnt(8) lgkmcnt(4)
v_mfma_f32_16x16x32_bf16 v[132:135], a[112:115], a[32:35], v[132:135]
s_cmp_eq_u32 s3, 5
s_cselect_b32 s35, 29, 21
s_lshl_b32 s35, s35, 12
v_mfma_f32_16x16x32_bf16 v[148:151], a[112:115], a[36:39], v[148:151]
ds_read_b128 a[96:99], v6 offset:8192
v_mfma_f32_16x16x32_bf16 v[152:155], a[116:119], a[36:39], v[152:155]
buffer_load_dwordx4 a[24:27], v4, s[40:43], s35 offen offset:0 sc1
v_mfma_f32_16x16x32_bf16 v[136:139], a[116:119], a[32:35], v[136:139]
ds_read_b128 a[100:103], v6 offset:9216
v_mfma_f32_16x16x32_bf16 v[140:143], a[120:123], a[32:35], v[140:143]
ds_read_b128 a[104:107], v6 offset:10240
v_mfma_f32_16x16x32_bf16 v[156:159], a[120:123], a[36:39], v[156:159]
ds_read_b128 a[108:111], v6 offset:11264
v_mfma_f32_16x16x32_bf16 v[160:163], a[124:127], a[36:39], v[160:163]
buffer_load_dwordx4 a[28:31], v4, s[40:43], s35 offen offset:1024 sc1
v_mfma_f32_16x16x32_bf16 v[144:147], a[124:127], a[32:35], v[144:147]
s_waitcnt vmcnt(8) lgkmcnt(4)
v_mfma_f32_16x16x32_bf16 v[132:135], a[128:131], a[40:43], v[132:135]
s_cmp_eq_u32 s3, 6
s_cselect_b32 s35, 30, 22
s_lshl_b32 s35, s35, 12
v_mfma_f32_16x16x32_bf16 v[148:151], a[128:131], a[44:47], v[148:151]
ds_read_b128 a[112:115], v6 offset:12288
v_mfma_f32_16x16x32_bf16 v[152:155], a[132:135], a[44:47], v[152:155]
buffer_load_dwordx4 a[32:35], v4, s[40:43], s35 offen offset:0 sc1
v_mfma_f32_16x16x32_bf16 v[136:139], a[132:135], a[40:43], v[136:139]
ds_read_b128 a[116:119], v6 offset:13312
v_mfma_f32_16x16x32_bf16 v[140:143], a[136:139], a[40:43], v[140:143]
ds_read_b128 a[120:123], v6 offset:14336
v_mfma_f32_16x16x32_bf16 v[156:159], a[136:139], a[44:47], v[156:159]
ds_read_b128 a[124:127], v6 offset:15360
v_mfma_f32_16x16x32_bf16 v[160:163], a[140:143], a[44:47], v[160:163]
buffer_load_dwordx4 a[36:39], v4, s[40:43], s35 offen offset:1024 sc1
v_mfma_f32_16x16x32_bf16 v[144:147], a[140:143], a[40:43], v[144:147]
s_waitcnt vmcnt(8) lgkmcnt(4)
v_mfma_f32_16x16x32_bf16 v[132:135], a[96:99], a[0:3], v[132:135]
s_cmp_eq_u32 s3, 7
s_cselect_b32 s35, 31, 23
s_lshl_b32 s35, s35, 12
v_mfma_f32_16x16x32_bf16 v[148:151], a[96:99], a[4:7], v[148:151]
ds_read_b128 a[128:131], v6 offset:16384
v_mfma_f32_16x16x32_bf16 v[152:155], a[100:103], a[4:7], v[152:155]
buffer_load_dwordx4 a[40:43], v4, s[40:43], s35 offen offset:0 sc1
v_mfma_f32_16x16x32_bf16 v[136:139], a[100:103], a[0:3], v[136:139]
ds_read_b128 a[132:135], v6 offset:17408
v_mfma_f32_16x16x32_bf16 v[140:143], a[104:107], a[0:3], v[140:143]
ds_read_b128 a[136:139], v6 offset:18432
v_mfma_f32_16x16x32_bf16 v[156:159], a[104:107], a[4:7], v[156:159]
ds_read_b128 a[140:143], v6 offset:19456
v_mfma_f32_16x16x32_bf16 v[160:163], a[108:111], a[4:7], v[160:163]
buffer_load_dwordx4 a[44:47], v4, s[40:43], s35 offen offset:1024 sc1
v_mfma_f32_16x16x32_bf16 v[144:147], a[108:111], a[0:3], v[144:147]
s_waitcnt vmcnt(8) lgkmcnt(4)
v_mfma_f32_16x16x32_bf16 v[132:135], a[112:115], a[8:11], v[132:135]
s_cmp_eq_u32 s3, 0
s_cselect_b32 s35, 0, 24
s_lshl_b32 s35, s35, 12
v_mfma_f32_16x16x32_bf16 v[148:151], a[112:115], a[12:15], v[148:151]
ds_read_b128 a[96:99], v6 offset:20480
v_mfma_f32_16x16x32_bf16 v[152:155], a[116:119], a[12:15], v[152:155]
buffer_load_dwordx4 a[0:3], v4, s[40:43], s35 offen offset:0 sc1
v_mfma_f32_16x16x32_bf16 v[136:139], a[116:119], a[8:11], v[136:139]
ds_read_b128 a[100:103], v6 offset:21504
v_mfma_f32_16x16x32_bf16 v[140:143], a[120:123], a[8:11], v[140:143]
ds_read_b128 a[104:107], v6 offset:22528
v_mfma_f32_16x16x32_bf16 v[156:159], a[120:123], a[12:15], v[156:159]
ds_read_b128 a[108:111], v6 offset:23552
v_mfma_f32_16x16x32_bf16 v[160:163], a[124:127], a[12:15], v[160:163]
buffer_load_dwordx4 a[4:7], v4, s[40:43], s35 offen offset:1024 sc1
v_mfma_f32_16x16x32_bf16 v[144:147], a[124:127], a[8:11], v[144:147]
s_waitcnt vmcnt(8) lgkmcnt(4)
v_mfma_f32_16x16x32_bf16 v[132:135], a[128:131], a[16:19], v[132:135]
s_cmp_eq_u32 s3, 1
s_cselect_b32 s35, 1, 25
s_lshl_b32 s35, s35, 12
v_mfma_f32_16x16x32_bf16 v[148:151], a[128:131], a[20:23], v[148:151]
ds_read_b128 a[112:115], v6 offset:24576
s_add_u32 s88, s67, 0xe0000
v_mfma_f32_16x16x32_bf16 v[152:155], a[132:135], a[20:23], v[152:155]
buffer_load_dwordx4 a[8:11], v4, s[40:43], s35 offen offset:0 sc1
s_add_u32 s89, s66, 0xd0000
v_mfma_f32_16x16x32_bf16 v[136:139], a[132:135], a[16:19], v[136:139]
ds_read_b128 a[116:119], v6 offset:25600
v_mfma_f32_16x16x32_bf16 v[140:143], a[136:139], a[16:19], v[140:143]
ds_read_b128 a[120:123], v6 offset:26624
v_mfma_f32_16x16x32_bf16 v[156:159], a[136:139], a[20:23], v[156:159]
ds_read_b128 a[124:127], v6 offset:27648
v_mfma_f32_16x16x32_bf16 v[160:163], a[140:143], a[20:23], v[160:163]
buffer_load_dwordx4 a[12:15], v4, s[40:43], s35 offen offset:1024 sc1
v_mfma_f32_16x16x32_bf16 v[144:147], a[140:143], a[16:19], v[144:147]
buffer_load_dword v11, v255, s[4:7], s88 offen sc1
s_waitcnt vmcnt(9) lgkmcnt(4)
v_mfma_f32_16x16x32_bf16 v[132:135], a[96:99], a[24:27], v[132:135]
s_cmp_eq_u32 s3, 2
s_cselect_b32 s35, 2, 26
s_lshl_b32 s35, s35, 12
v_mfma_f32_16x16x32_bf16 v[148:151], a[96:99], a[28:31], v[148:151]
ds_read_b128 a[128:131], v6 offset:28672
v_mfma_f32_16x16x32_bf16 v[152:155], a[100:103], a[28:31], v[152:155]
buffer_load_dwordx4 a[16:19], v4, s[40:43], s35 offen offset:0 sc1
v_mfma_f32_16x16x32_bf16 v[136:139], a[100:103], a[24:27], v[136:139]
ds_read_b128 a[132:135], v6 offset:29696
v_mfma_f32_16x16x32_bf16 v[140:143], a[104:107], a[24:27], v[140:143]
ds_read_b128 a[136:139], v6 offset:30720
v_mfma_f32_16x16x32_bf16 v[156:159], a[104:107], a[28:31], v[156:159]
ds_read_b128 a[140:143], v6 offset:31744
v_mfma_f32_16x16x32_bf16 v[160:163], a[108:111], a[28:31], v[160:163]
buffer_load_dwordx4 a[20:23], v4, s[40:43], s35 offen offset:1024 sc1
v_mfma_f32_16x16x32_bf16 v[144:147], a[108:111], a[24:27], v[144:147]
buffer_load_dword v232, v255, s[4:7], s89 offen offset:64 sc1
s_waitcnt vmcnt(10) lgkmcnt(4)
v_mfma_f32_16x16x32_bf16 v[132:135], a[112:115], a[32:35], v[132:135]
s_cmp_eq_u32 s3, 3
s_cselect_b32 s35, 3, 27
s_lshl_b32 s35, s35, 12
v_mfma_f32_16x16x32_bf16 v[148:151], a[112:115], a[36:39], v[148:151]
ds_read_b128 a[96:99], v6 offset:32768
v_mfma_f32_16x16x32_bf16 v[152:155], a[116:119], a[36:39], v[152:155]
buffer_load_dwordx4 a[24:27], v4, s[40:43], s35 offen offset:0 sc1
v_mfma_f32_16x16x32_bf16 v[136:139], a[116:119], a[32:35], v[136:139]
ds_read_b128 a[100:103], v6 offset:33792
v_mfma_f32_16x16x32_bf16 v[140:143], a[120:123], a[32:35], v[140:143]
ds_read_b128 a[104:107], v6 offset:34816
v_mfma_f32_16x16x32_bf16 v[156:159], a[120:123], a[36:39], v[156:159]
ds_read_b128 a[108:111], v6 offset:35840
v_mfma_f32_16x16x32_bf16 v[160:163], a[124:127], a[36:39], v[160:163]
buffer_load_dwordx4 a[28:31], v4, s[40:43], s35 offen offset:1024 sc1
v_mfma_f32_16x16x32_bf16 v[144:147], a[124:127], a[32:35], v[144:147]
s_waitcnt vmcnt(10) lgkmcnt(4)
v_mfma_f32_16x16x32_bf16 v[132:135], a[128:131], a[40:43], v[132:135]
s_cmp_eq_u32 s3, 4
s_cselect_b32 s35, 4, 28
s_lshl_b32 s35, s35, 12
v_mfma_f32_16x16x32_bf16 v[148:151], a[128:131], a[44:47], v[148:151]
ds_read_b128 a[112:115], v6 offset:36864
v_mfma_f32_16x16x32_bf16 v[152:155], a[132:135], a[44:47], v[152:155]
buffer_load_dwordx4 a[32:35], v4, s[40:43], s35 offen offset:0 sc1
v_mfma_f32_16x16x32_bf16 v[136:139], a[132:135], a[40:43], v[136:139]
ds_read_b128 a[116:119], v6 offset:37888
v_mfma_f32_16x16x32_bf16 v[140:143], a[136:139], a[40:43], v[140:143]
ds_read_b128 a[120:123], v6 offset:38912
v_mfma_f32_16x16x32_bf16 v[156:159], a[136:139], a[44:47], v[156:159]
ds_read_b128 a[124:127], v6 offset:39936
v_mfma_f32_16x16x32_bf16 v[160:163], a[140:143], a[44:47], v[160:163]
buffer_load_dwordx4 a[36:39], v4, s[40:43], s35 offen offset:1024 sc1
v_mfma_f32_16x16x32_bf16 v[144:147], a[140:143], a[40:43], v[144:147]
s_waitcnt vmcnt(10) lgkmcnt(4)
v_mfma_f32_16x16x32_bf16 v[132:135], a[96:99], a[0:3], v[132:135]
s_cmp_eq_u32 s3, 5
s_cselect_b32 s35, 5, 29
s_lshl_b32 s35, s35, 12
v_mfma_f32_16x16x32_bf16 v[148:151], a[96:99], a[4:7], v[148:151]
ds_read_b128 a[128:131], v6 offset:40960
v_mfma_f32_16x16x32_bf16 v[152:155], a[100:103], a[4:7], v[152:155]
buffer_load_dwordx4 a[40:43], v4, s[40:43], s35 offen offset:0 sc1
v_mfma_f32_16x16x32_bf16 v[136:139], a[100:103], a[0:3], v[136:139]
ds_read_b128 a[132:135], v6 offset:41984
v_mfma_f32_16x16x32_bf16 v[140:143], a[104:107], a[0:3], v[140:143]
ds_read_b128 a[136:139], v6 offset:43008
v_mfma_f32_16x16x32_bf16 v[156:159], a[104:107], a[4:7], v[156:159]
ds_read_b128 a[140:143], v6 offset:44032
v_mfma_f32_16x16x32_bf16 v[160:163], a[108:111], a[4:7], v[160:163]
buffer_load_dwordx4 a[44:47], v4, s[40:43], s35 offen offset:1024 sc1
v_mfma_f32_16x16x32_bf16 v[144:147], a[108:111], a[0:3], v[144:147]
s_waitcnt vmcnt(10) lgkmcnt(4)
v_mfma_f32_16x16x32_bf16 v[132:135], a[112:115], a[8:11], v[132:135]
s_cmp_eq_u32 s3, 6
s_cselect_b32 s35, 6, 30
s_lshl_b32 s35, s35, 12
v_mfma_f32_16x16x32_bf16 v[148:151], a[112:115], a[12:15], v[148:151]
ds_read_b128 a[96:99], v6 offset:45056
v_mfma_f32_16x16x32_bf16 v[152:155], a[116:119], a[12:15], v[152:155]
buffer_load_dwordx4 a[0:3], v4, s[40:43], s35 offen offset:0 sc1
v_mfma_f32_16x16x32_bf16 v[136:139], a[116:119], a[8:11], v[136:139]
ds_read_b128 a[100:103], v6 offset:46080
v_mfma_f32_16x16x32_bf16 v[140:143], a[120:123], a[8:11], v[140:143]
ds_read_b128 a[104:107], v6 offset:47104
v_mfma_f32_16x16x32_bf16 v[156:159], a[120:123], a[12:15], v[156:159]
ds_read_b128 a[108:111], v6 offset:48128
v_mfma_f32_16x16x32_bf16 v[160:163], a[124:127], a[12:15], v[160:163]
buffer_load_dwordx4 a[4:7], v4, s[40:43], s35 offen offset:1024 sc1
v_mfma_f32_16x16x32_bf16 v[144:147], a[124:127], a[8:11], v[144:147]
s_waitcnt vmcnt(9) lgkmcnt(4)
v_mfma_f32_16x16x32_bf16 v[132:135], a[128:131], a[16:19], v[132:135]
s_cmp_eq_u32 s3, 7
s_cselect_b32 s35, 7, 31
s_lshl_b32 s35, s35, 12
v_mfma_f32_16x16x32_bf16 v[148:151], a[128:131], a[20:23], v[148:151]
ds_read_b128 a[112:115], v6 offset:49152
v_mfma_f32_16x16x32_bf16 v[152:155], a[132:135], a[20:23], v[152:155]
buffer_load_dwordx4 a[8:11], v4, s[40:43], s35 offen offset:0 sc1
v_mfma_f32_16x16x32_bf16 v[136:139], a[132:135], a[16:19], v[136:139]
ds_read_b128 a[116:119], v6 offset:50176
v_mfma_f32_16x16x32_bf16 v[140:143], a[136:139], a[16:19], v[140:143]
ds_read_b128 a[120:123], v6 offset:51200
v_mfma_f32_16x16x32_bf16 v[156:159], a[136:139], a[20:23], v[156:159]
ds_read_b128 a[124:127], v6 offset:52224
v_mfma_f32_16x16x32_bf16 v[160:163], a[140:143], a[20:23], v[160:163]
buffer_load_dwordx4 a[12:15], v4, s[40:43], s35 offen offset:1024 sc1
v_mfma_f32_16x16x32_bf16 v[144:147], a[140:143], a[16:19], v[144:147]
s_waitcnt vmcnt(8) lgkmcnt(4)
v_mfma_f32_16x16x32_bf16 v[132:135], a[96:99], a[24:27], v[132:135]
ds_read_b128 a[128:131], v6 offset:53248
v_mfma_f32_16x16x32_bf16 v[148:151], a[96:99], a[28:31], v[148:151]
ds_read_b128 a[132:135], v6 offset:54272
v_mfma_f32_16x16x32_bf16 v[152:155], a[100:103], a[28:31], v[152:155]
ds_read_b128 a[136:139], v6 offset:55296
v_mfma_f32_16x16x32_bf16 v[136:139], a[100:103], a[24:27], v[136:139]
ds_read_b128 a[140:143], v6 offset:56320
v_mfma_f32_16x16x32_bf16 v[140:143], a[104:107], a[24:27], v[140:143]
v_mfma_f32_16x16x32_bf16 v[156:159], a[104:107], a[28:31], v[156:159]
v_mfma_f32_16x16x32_bf16 v[160:163], a[108:111], a[28:31], v[160:163]
v_mfma_f32_16x16x32_bf16 v[144:147], a[108:111], a[24:27], v[144:147]
s_waitcnt vmcnt(6) lgkmcnt(4)
v_mfma_f32_16x16x32_bf16 v[132:135], a[112:115], a[32:35], v[132:135]
ds_read_b128 a[96:99], v6 offset:57344
v_mfma_f32_16x16x32_bf16 v[148:151], a[112:115], a[36:39], v[148:151]
ds_read_b128 a[100:103], v6 offset:58368
v_mfma_f32_16x16x32_bf16 v[152:155], a[116:119], a[36:39], v[152:155]
ds_read_b128 a[104:107], v6 offset:59392
v_mfma_f32_16x16x32_bf16 v[136:139], a[116:119], a[32:35], v[136:139]
ds_read_b128 a[108:111], v6 offset:60416
v_mfma_f32_16x16x32_bf16 v[140:143], a[120:123], a[32:35], v[140:143]
v_mfma_f32_16x16x32_bf16 v[156:159], a[120:123], a[36:39], v[156:159]
v_mfma_f32_16x16x32_bf16 v[160:163], a[124:127], a[36:39], v[160:163]
v_mfma_f32_16x16x32_bf16 v[144:147], a[124:127], a[32:35], v[144:147]
s_waitcnt vmcnt(4) lgkmcnt(4)
v_mfma_f32_16x16x32_bf16 v[132:135], a[128:131], a[40:43], v[132:135]
ds_read_b128 a[112:115], v6 offset:61440
v_mfma_f32_16x16x32_bf16 v[148:151], a[128:131], a[44:47], v[148:151]
ds_read_b128 a[116:119], v6 offset:62464
v_mfma_f32_16x16x32_bf16 v[152:155], a[132:135], a[44:47], v[152:155]
ds_read_b128 a[120:123], v6 offset:63488
v_mfma_f32_16x16x32_bf16 v[136:139], a[132:135], a[40:43], v[136:139]
ds_read_b128 a[124:127], v6 offset:64512
v_mfma_f32_16x16x32_bf16 v[140:143], a[136:139], a[40:43], v[140:143]
v_mfma_f32_16x16x32_bf16 v[156:159], a[136:139], a[44:47], v[156:159]
v_mfma_f32_16x16x32_bf16 v[160:163], a[140:143], a[44:47], v[160:163]
v_mfma_f32_16x16x32_bf16 v[144:147], a[140:143], a[40:43], v[144:147]
s_waitcnt vmcnt(2) lgkmcnt(4)
v_mfma_f32_16x16x32_bf16 v[132:135], a[96:99], a[0:3], v[132:135]
v_mfma_f32_16x16x32_bf16 v[148:151], a[96:99], a[4:7], v[148:151]
v_mfma_f32_16x16x32_bf16 v[152:155], a[100:103], a[4:7], v[152:155]
v_mfma_f32_16x16x32_bf16 v[136:139], a[100:103], a[0:3], v[136:139]
v_mfma_f32_16x16x32_bf16 v[140:143], a[104:107], a[0:3], v[140:143]
v_mfma_f32_16x16x32_bf16 v[156:159], a[104:107], a[4:7], v[156:159]
v_mfma_f32_16x16x32_bf16 v[160:163], a[108:111], a[4:7], v[160:163]
v_mfma_f32_16x16x32_bf16 v[144:147], a[108:111], a[0:3], v[144:147]
s_waitcnt vmcnt(0) lgkmcnt(0)
v_mfma_f32_16x16x32_bf16 v[132:135], a[112:115], a[8:11], v[132:135]
v_mfma_f32_16x16x32_bf16 v[148:151], a[112:115], a[12:15], v[148:151]
v_mfma_f32_16x16x32_bf16 v[152:155], a[116:119], a[12:15], v[152:155]
v_mfma_f32_16x16x32_bf16 v[136:139], a[116:119], a[8:11], v[136:139]
v_mfma_f32_16x16x32_bf16 v[140:143], a[120:123], a[8:11], v[140:143]
v_mfma_f32_16x16x32_bf16 v[156:159], a[120:123], a[12:15], v[156:159]
v_mfma_f32_16x16x32_bf16 v[160:163], a[124:127], a[12:15], v[160:163]
v_mfma_f32_16x16x32_bf16 v[144:147], a[124:127], a[8:11], v[144:147]
s_lshl_b32 s36, s32, 13
v_cvt_pk_bf16_f32 v32, v132, v133
v_cvt_pk_bf16_f32 v33, v134, v135
s_nop 0
v_cvt_pk_bf16_f32 v34, v136, v137
v_cvt_pk_bf16_f32 v35, v138, v139
s_add_u32 s36, s36, 0x2200000
buffer_store_dwordx4 v[32:35], v4, s[4:7], s36 offen offset:0 sc1
v_cvt_pk_bf16_f32 v40, v148, v149
v_cvt_pk_bf16_f32 v41, v150, v151
v_cvt_pk_bf16_f32 v42, v152, v153
v_cvt_pk_bf16_f32 v43, v154, v155
v_cvt_pk_bf16_f32 v36, v140, v141
v_cvt_pk_bf16_f32 v37, v142, v143
v_cvt_pk_bf16_f32 v38, v144, v145
v_cvt_pk_bf16_f32 v39, v146, v147
s_add_u32 s37, s36, 4096
v_cvt_pk_bf16_f32 v44, v156, v157
v_cvt_pk_bf16_f32 v45, v158, v159
v_cvt_pk_bf16_f32 v46, v160, v161
buffer_store_dwordx4 v[40:43], v4, s[4:7], s36 offen offset:1024 sc1
v_cvt_pk_bf16_f32 v47, v162, v163
v_mfma_f32_16x16x32_bf16 v[96:99], v[32:35], v[32:35], 0
s_mov_b32 s38, 0x240000
s_add_u32 s92, s78, 0x40000
v_mfma_f32_16x16x32_bf16 v[92:95], v[16:19], v[32:35], 0
s_add_u32 s93, s79, 0x40000
s_add_u32 s40, s4, 0x2200000
v_mfma_f32_16x16x32_bf16 v[96:99], v[36:39], v[36:39], v[96:99]
s_addc_u32 s41, s5, 0
buffer_store_dwordx4 v[36:39], v4, s[4:7], s37 offen offset:0 sc1
v_mfma_f32_16x16x32_bf16 v[92:95], v[16:19], v[36:39], v[92:95]
s_nop 4
v_cndmask_b32 v96, v96, v97, s[46:47]
v_cndmask_b32 v98, v98, v99, s[46:47]
v_mfma_f32_16x16x32_bf16 v[104:107], v[40:43], v[40:43], 0
v_mfma_f32_16x16x32_bf16 v[100:103], v[16:19], v[40:43], 0
v_cndmask_b32 v93, v96, v98, s[48:49]
buffer_store_dwordx4 v[44:47], v4, s[4:7], s37 offen offset:1024 sc1
v_mfma_f32_16x16x32_bf16 v[104:107], v[44:47], v[44:47], v[104:107]
v_mfma_f32_16x16x32_bf16 v[100:103], v[16:19], v[44:47], v[100:103]
s_nop 6
v_cndmask_b32 v104, v104, v105, s[46:47]
v_cndmask_b32 v106, v106, v107, s[46:47]
buffer_store_dwordx2 v[92:93], v253, s[4:7], s38 offen offset:0 sc1
v_cndmask_b32 v101, v104, v106, s[48:49]
buffer_store_dwordx2 v[100:101], v253, s[4:7], s38 offen offset:2048 sc1
v_cmp_ne_u32 vcc, v11, v15
s_cbranch_vccnz Ltr_7
Lte_9:
v_cmp_ne_u32 vcc, v232, v15
s_cbranch_vccnz Ltr_10
Lte_12:
s_barrier
s_add_u32 m0, s18, 0x0
s_add_u32 s44, s50, 0x1400000
buffer_load_dwordx4 v1, s[4:7], s44 offen offset:0 sc1 lds
buffer_load_dwordx4 v1, s[4:7], s44 offen offset:1024 sc1 lds
buffer_load_dwordx4 v1, s[4:7], s44 offen offset:2048 sc1 lds
s_add_u32 m0, s18, 0x3000
s_add_u32 s44, s50, 0x1403000
buffer_load_dwordx4 v1, s[4:7], s44 offen offset:0 sc1 lds
buffer_load_dwordx4 v1, s[4:7], s44 offen offset:1024 sc1 lds
buffer_load_dwordx4 v1, s[4:7], s44 offen offset:2048 sc1 lds
s_waitcnt vmcnt(6)
s_barrier
s_cmp_lg_u32 s28, 1
s_cbranch_scc1 Lsg_13
buffer_atomic_add v12, v10, s[4:7], s92 offen sc1
Lsg_13:
s_cmp_lg_u32 s28, 1
s_cbranch_scc1 L_wskip2
s_mov_b64 exec, 0
s_branch L_stub4
L_wret2:
s_mov_b64 exec, -1
L_wskip2:
s_cmp_lt_u32 s28, 2
s_cbranch_scc1 Lwd_14
s_add_u32 m0, s18, 0x4800
s_add_u32 s44, s50, 0x1404800
buffer_load_dwordx4 v1, s[4:7], s44 offen offset:0 sc1 lds
buffer_load_dwordx4 v1, s[4:7], s44 offen offset:1024 sc1 lds
buffer_load_dwordx4 v1, s[4:7], s44 offen offset:2048 sc1 lds
s_add_u32 m0, s18, 0x6000
L_stub4:
s_cbranch_execz L_stub5
s_add_u32 s44, s50, 0x1406000
buffer_load_dwordx4 v1, s[4:7], s44 offen offset:0 sc1 lds
buffer_load_dwordx4 v1, s[4:7], s44 offen offset:1024 sc1 lds
buffer_load_dwordx4 v1, s[4:7], s44 offen offset:2048 sc1 lds
s_add_u32 m0, s18, 0x7800
s_add_u32 s44, s50, 0x1407800
buffer_load_dwordx4 v1, s[4:7], s44 offen offset:0 sc1 lds
buffer_load_dwordx4 v1, s[4:7], s44 offen offset:1024 sc1 lds
buffer_load_dwordx4 v1, s[4:7], s44 offen offset:2048 sc1 lds
s_add_u32 m0, s18, 0x9000
s_add_u32 s44, s50, 0x1409000
buffer_load_dwordx4 v1, s[4:7], s44 offen offset:0 sc1 lds
buffer_load_dwordx4 v1, s[4:7], s44 offen offset:1024 sc1 lds
buffer_load_dwordx4 v1, s[4:7], s44 offen offset:2048 sc1 lds
s_add_u32 m0, s18, 0xa800
s_add_u32 s44, s50, 0x140a800
buffer_load_dwordx4 v1, s[4:7], s44 offen offset:0 sc1 lds
buffer_load_dwordx4 v1, s[4:7], s44 offen offset:1024 sc1 lds
buffer_load_dwordx4 v1, s[4:7], s44 offen offset:2048 sc1 lds
s_add_u32 m0, s18, 0xc000
s_add_u32 s44, s50, 0x140c000
buffer_load_dwordx4 v1, s[4:7], s44 offen offset:0 sc1 lds
buffer_load_dwordx4 v1, s[4:7], s44 offen offset:1024 sc1 lds
buffer_load_dwordx4 v1, s[4:7], s44 offen offset:2048 sc1 lds
s_add_u32 m0, s18, 0xd800
s_add_u32 s44, s50, 0x140d800
buffer_load_dwordx4 v1, s[4:7], s44 offen offset:0 sc1 lds
buffer_load_dwordx4 v1, s[4:7], s44 offen offset:1024 sc1 lds
buffer_load_dwordx4 v1, s[4:7], s44 offen offset:2048 sc1 lds
s_add_u32 m0, s18, 0xf000
s_add_u32 s44, s50, 0x140f000
buffer_load_dwordx4 v1, s[4:7], s44 offen offset:0 sc1 lds
buffer_load_dwordx4 v1, s[4:7], s44 offen offset:1024 sc1 lds
buffer_load_dwordx4 v1, s[4:7], s44 offen offset:2048 sc1 lds
s_add_u32 m0, s18, 0x10800
s_add_u32 s44, s50, 0x1410800
buffer_load_dwordx4 v1, s[4:7], s44 offen offset:0 sc1 lds
buffer_load_dwordx4 v1, s[4:7], s44 offen offset:1024 sc1 lds
buffer_load_dwordx4 v1, s[4:7], s44 offen offset:2048 sc1 lds
s_add_u32 m0, s18, 0x12000
s_add_u32 s44, s50, 0x1412000
buffer_load_dwordx4 v1, s[4:7], s44 offen offset:0 sc1 lds
buffer_load_dwordx4 v1, s[4:7], s44 offen offset:1024 sc1 lds
buffer_load_dwordx4 v1, s[4:7], s44 offen offset:2048 sc1 lds
s_add_u32 m0, s18, 0x13800
s_add_u32 s44, s50, 0x1413800
buffer_load_dwordx4 v1, s[4:7], s44 offen offset:0 sc1 lds
buffer_load_dwordx4 v1, s[4:7], s44 offen offset:1024 sc1 lds
buffer_load_dwordx4 v1, s[4:7], s44 offen offset:2048 sc1 lds
s_add_u32 m0, s18, 0x15000
s_add_u32 s44, s50, 0x1415000
buffer_load_dwordx4 v1, s[4:7], s44 offen offset:0 sc1 lds
buffer_load_dwordx4 v1, s[4:7], s44 offen offset:1024 sc1 lds
buffer_load_dwordx4 v1, s[4:7], s44 offen offset:2048 sc1 lds
s_add_u32 m0, s18, 0x16800
s_add_u32 s44, s50, 0x1416800
buffer_load_dwordx4 v1, s[4:7], s44 offen offset:0 sc1 lds
buffer_load_dwordx4 v1, s[4:7], s44 offen offset:1024 sc1 lds
buffer_load_dwordx4 v1, s[4:7], s44 offen offset:2048 sc1 lds
s_add_u32 m0, s18, 0x18000
s_add_u32 s44, s50, 0x1418000
buffer_load_dwordx4 v1, s[4:7], s44 offen offset:0 sc1 lds
buffer_load_dwordx4 v1, s[4:7], s44 offen offset:1024 sc1 lds
buffer_load_dwordx4 v1, s[4:7], s44 offen offset:2048 sc1 lds
s_add_u32 m0, s18, 0x19800
s_add_u32 s44, s50, 0x1419800
buffer_load_dwordx4 v1, s[4:7], s44 offen offset:0 sc1 lds
buffer_load_dwordx4 v1, s[4:7], s44 offen offset:1024 sc1 lds
buffer_load_dwordx4 v1, s[4:7], s44 offen offset:2048 sc1 lds
s_add_u32 m0, s18, 0x1b000
s_add_u32 s44, s50, 0x141b000
buffer_load_dwordx4 v1, s[4:7], s44 offen offset:0 sc1 lds
buffer_load_dwordx4 v1, s[4:7], s44 offen offset:1024 sc1 lds
buffer_load_dwordx4 v1, s[4:7], s44 offen offset:2048 sc1 lds
Lwd_14:
s_cmp_lg_u32 s28, 0
s_cbranch_scc1 Lpe_16
s_add_u32 s36, s67, 0x40000
s_mov_b32 s37, 0
Lpoll_15:
v_mov_b32 v11, 0
buffer_atomic_add v11, v251, s[4:7], s36 offen sc0 sc1
s_add_u32 s37, s37, 1
s_waitcnt vmcnt(0)
v_readfirstlane_b32 s38, v11
s_nop 0
s_cmp_ge_u32 s38, 32
s_cbranch_scc1 Lpe_16
s_cmp_lt_u32 s37, 0x100000
s_cbranch_scc1 Lpoll_15
Lpe_16:
s_waitcnt vmcnt(36)
s_cmp_ge_u32 s28, 2
s_cbranch_scc1 Lw_17
s_waitcnt vmcnt(0)
Lw_17:
s_barrier
s_add_u32 s94, s80, 0x80080
s_lshl_b32 s35, s33, 12
buffer_load_dwordx4 a[0:3], v2, s[40:43], s35 offen offset:0 sc1
buffer_load_dwordx4 a[4:7], v2, s[40:43], s35 offen offset:1024 sc1
buffer_load_dwordx4 a[8:11], v2, s[40:43], s35 offen offset:2048 sc1
buffer_load_dwordx4 a[12:15], v2, s[40:43], s35 offen offset:3072 sc1
s_add_u32 s35, s35, 4096
buffer_load_dwordx4 a[16:19], v2, s[40:43], s35 offen offset:0 sc1
buffer_load_dwordx4 a[20:23], v2, s[40:43], s35 offen offset:1024 sc1
buffer_load_dwordx4 a[24:27], v2, s[40:43], s35 offen offset:2048 sc1
buffer_load_dwordx4 a[28:31], v2, s[40:43], s35 offen offset:3072 sc1
s_add_u32 s35, s35, 4096
buffer_load_dwordx4 a[32:35], v2, s[40:43], s35 offen offset:0 sc1
buffer_load_dwordx4 a[36:39], v2, s[40:43], s35 offen offset:1024 sc1
buffer_load_dwordx4 a[40:43], v2, s[40:43], s35 offen offset:2048 sc1
buffer_load_dwordx4 a[44:47], v2, s[40:43], s35 offen offset:3072 sc1
s_add_u32 s35, s35, 4096
v_add_u32 v5, 0, v1
ds_read_b128 a[96:99], v5 offset:0
ds_read_b128 a[100:103], v5 offset:1024
ds_read_b128 a[104:107], v5 offset:2048
ds_read_b128 a[108:111], v5 offset:3072
ds_read_b128 a[112:115], v5 offset:4096
ds_read_b128 a[116:119], v5 offset:5120
s_waitcnt vmcnt(8) lgkmcnt(0)
v_mfma_f32_16x16x32_bf16 v[132:135], a[96:99], a[0:3], 0
v_and_b32 v232, 15, v0
v_lshlrev_b32 v232, 7, v232
v_mfma_f32_16x16x32_bf16 v[156:159], a[96:99], a[4:7], 0
buffer_load_dwordx4 a[48:51], v2, s[40:43], s35 offen offset:0 sc1
v_mfma_f32_16x16x32_bf16 v[180:183], a[96:99], a[8:11], 0
v_lshrrev_b32 v233, 4, v0
v_lshlrev_b32 v233, 4, v233
v_mfma_f32_16x16x32_bf16 v[204:207], a[96:99], a[12:15], 0
v_add_u32 v232, v233, v232
s_mul_i32 s38, s30, 12288
v_mfma_f32_16x16x32_bf16 v[208:211], a[100:103], a[12:15], 0
s_add_u32 s38, s38, 0x380000
s_add_u32 s39, s28, 4
s_min_u32 s39, s39, 5
v_mfma_f32_16x16x32_bf16 v[184:187], a[100:103], a[8:11], 0
buffer_load_dwordx4 a[52:55], v2, s[40:43], s35 offen offset:1024 sc1
s_lshl_b32 s36, s28, 11
v_mfma_f32_16x16x32_bf16 v[160:163], a[100:103], a[4:7], 0
s_add_u32 s36, s36, s38
s_lshl_b32 s37, s39, 11
s_add_u32 s37, s37, s38
v_mfma_f32_16x16x32_bf16 v[136:139], a[100:103], a[0:3], 0
ds_read_b128 a[128:131], v5 offset:6144
v_mfma_f32_16x16x32_bf16 v[140:143], a[104:107], a[0:3], 0
ds_read_b128 a[132:135], v5 offset:7168
v_mfma_f32_16x16x32_bf16 v[164:167], a[104:107], a[4:7], 0
ds_read_b128 a[136:139], v5 offset:8192
v_mfma_f32_16x16x32_bf16 v[188:191], a[104:107], a[8:11], 0
buffer_load_dwordx4 v[48:51], v232, s[4:7], s36 offen sc1
v_mfma_f32_16x16x32_bf16 v[212:215], a[104:107], a[12:15], 0
ds_read_b128 a[140:143], v5 offset:9216
v_mfma_f32_16x16x32_bf16 v[216:219], a[108:111], a[12:15], 0
ds_read_b128 a[144:147], v5 offset:10240
v_mfma_f32_16x16x32_bf16 v[192:195], a[108:111], a[8:11], 0
ds_read_b128 a[148:151], v5 offset:11264
v_mfma_f32_16x16x32_bf16 v[168:171], a[108:111], a[4:7], 0
v_mfma_f32_16x16x32_bf16 v[144:147], a[108:111], a[0:3], 0
buffer_load_dwordx4 a[56:59], v2, s[40:43], s35 offen offset:2048 sc1
v_mfma_f32_16x16x32_bf16 v[148:151], a[112:115], a[0:3], 0
v_mfma_f32_16x16x32_bf16 v[172:175], a[112:115], a[4:7], 0
v_mfma_f32_16x16x32_bf16 v[196:199], a[112:115], a[8:11], 0
v_mfma_f32_16x16x32_bf16 v[220:223], a[112:115], a[12:15], 0
v_mfma_f32_16x16x32_bf16 v[224:227], a[116:119], a[12:15], 0
buffer_load_dwordx4 a[60:63], v2, s[40:43], s35 offen offset:3072 sc1
s_add_u32 s35, s35, 4096
v_mfma_f32_16x16x32_bf16 v[200:203], a[116:119], a[8:11], 0
v_mfma_f32_16x16x32_bf16 v[176:179], a[116:119], a[4:7], 0
v_mfma_f32_16x16x32_bf16 v[152:155], a[116:119], a[0:3], 0
s_waitcnt vmcnt(9) lgkmcnt(0)
v_mfma_f32_16x16x32_bf16 v[132:135], a[128:131], a[16:19], v[132:135]
ds_read_b128 a[96:99], v5 offset:12288
v_mfma_f32_16x16x32_bf16 v[156:159], a[128:131], a[20:23], v[156:159]
buffer_load_dwordx4 a[0:3], v2, s[40:43], s35 offen offset:0 sc1
v_mfma_f32_16x16x32_bf16 v[180:183], a[128:131], a[24:27], v[180:183]
ds_read_b128 a[100:103], v5 offset:13312
v_mfma_f32_16x16x32_bf16 v[204:207], a[128:131], a[28:31], v[204:207]
v_mfma_f32_16x16x32_bf16 v[208:211], a[132:135], a[28:31], v[208:211]
v_mfma_f32_16x16x32_bf16 v[184:187], a[132:135], a[24:27], v[184:187]
buffer_load_dwordx4 a[4:7], v2, s[40:43], s35 offen offset:1024 sc1
v_mfma_f32_16x16x32_bf16 v[160:163], a[132:135], a[20:23], v[160:163]
ds_read_b128 a[104:107], v5 offset:14336
v_mfma_f32_16x16x32_bf16 v[136:139], a[132:135], a[16:19], v[136:139]
v_mfma_f32_16x16x32_bf16 v[140:143], a[136:139], a[16:19], v[140:143]
ds_read_b128 a[108:111], v5 offset:15360
v_mfma_f32_16x16x32_bf16 v[164:167], a[136:139], a[20:23], v[164:167]
v_mfma_f32_16x16x32_bf16 v[188:191], a[136:139], a[24:27], v[188:191]
buffer_load_dwordx4 v[52:55], v232, s[4:7], s37 offen sc1
s_add_u32 m0, s18, 0x1e000
v_mfma_f32_16x16x32_bf16 v[212:215], a[136:139], a[28:31], v[212:215]
s_add_u32 s44, s50, 0x141e000
ds_read_b128 a[112:115], v5 offset:16384
v_mfma_f32_16x16x32_bf16 v[216:219], a[140:143], a[28:31], v[216:219]
v_mfma_f32_16x16x32_bf16 v[192:195], a[140:143], a[24:27], v[192:195]
ds_read_b128 a[116:119], v5 offset:17408
v_mfma_f32_16x16x32_bf16 v[168:171], a[140:143], a[20:23], v[168:171]
v_mfma_f32_16x16x32_bf16 v[144:147], a[140:143], a[16:19], v[144:147]
buffer_load_dwordx4 a[8:11], v2, s[40:43], s35 offen offset:2048 sc1
v_mfma_f32_16x16x32_bf16 v[148:151], a[144:147], a[16:19], v[148:151]
v_mfma_f32_16x16x32_bf16 v[172:175], a[144:147], a[20:23], v[172:175]
v_mfma_f32_16x16x32_bf16 v[196:199], a[144:147], a[24:27], v[196:199]
v_mfma_f32_16x16x32_bf16 v[220:223], a[144:147], a[28:31], v[220:223]
v_mfma_f32_16x16x32_bf16 v[224:227], a[148:151], a[28:31], v[224:227]
buffer_load_dwordx4 a[12:15], v2, s[40:43], s35 offen offset:3072 sc1
s_add_u32 s35, s35, 4096
v_mfma_f32_16x16x32_bf16 v[200:203], a[148:151], a[24:27], v[200:203]
v_mfma_f32_16x16x32_bf16 v[176:179], a[148:151], a[20:23], v[176:179]
v_mfma_f32_16x16x32_bf16 v[152:155], a[148:151], a[16:19], v[152:155]
s_waitcnt vmcnt(10) lgkmcnt(0)
v_mfma_f32_16x16x32_bf16 v[132:135], a[96:99], a[32:35], v[132:135]
ds_read_b128 a[128:131], v5 offset:18432
v_mfma_f32_16x16x32_bf16 v[156:159], a[96:99], a[36:39], v[156:159]
buffer_load_dwordx4 a[16:19], v2, s[40:43], s35 offen offset:0 sc1
v_mfma_f32_16x16x32_bf16 v[180:183], a[96:99], a[40:43], v[180:183]
ds_read_b128 a[132:135], v5 offset:19456
v_mfma_f32_16x16x32_bf16 v[204:207], a[96:99], a[44:47], v[204:207]
v_mfma_f32_16x16x32_bf16 v[208:211], a[100:103], a[44:47], v[208:211]
v_mfma_f32_16x16x32_bf16 v[184:187], a[100:103], a[40:43], v[184:187]
buffer_load_dwordx4 a[20:23], v2, s[40:43], s35 offen offset:1024 sc1
v_mfma_f32_16x16x32_bf16 v[160:163], a[100:103], a[36:39], v[160:163]
ds_read_b128 a[136:139], v5 offset:20480
v_mfma_f32_16x16x32_bf16 v[136:139], a[100:103], a[32:35], v[136:139]
v_mfma_f32_16x16x32_bf16 v[140:143], a[104:107], a[32:35], v[140:143]
ds_read_b128 a[140:143], v5 offset:21504
v_mfma_f32_16x16x32_bf16 v[164:167], a[104:107], a[36:39], v[164:167]
v_mfma_f32_16x16x32_bf16 v[188:191], a[104:107], a[40:43], v[188:191]
buffer_load_dwordx4 v1, s[4:7], s44 offen offset:0 sc1 lds
v_mfma_f32_16x16x32_bf16 v[212:215], a[104:107], a[44:47], v[212:215]
ds_read_b128 a[144:147], v5 offset:22528
v_mfma_f32_16x16x32_bf16 v[216:219], a[108:111], a[44:47], v[216:219]
v_mfma_f32_16x16x32_bf16 v[192:195], a[108:111], a[40:43], v[192:195]
ds_read_b128 a[148:151], v5 offset:23552
v_mfma_f32_16x16x32_bf16 v[168:171], a[108:111], a[36:39], v[168:171]
v_mfma_f32_16x16x32_bf16 v[144:147], a[108:111], a[32:35], v[144:147]
buffer_load_dwordx4 a[24:27], v2, s[40:43], s35 offen offset:2048 sc1
v_mfma_f32_16x16x32_bf16 v[148:151], a[112:115], a[32:35], v[148:151]
v_mfma_f32_16x16x32_bf16 v[172:175], a[112:115], a[36:39], v[172:175]
v_mfma_f32_16x16x32_bf16 v[196:199], a[112:115], a[40:43], v[196:199]
v_mfma_f32_16x16x32_bf16 v[220:223], a[112:115], a[44:47], v[220:223]
v_mfma_f32_16x16x32_bf16 v[224:227], a[116:119], a[44:47], v[224:227]
buffer_load_dwordx4 a[28:31], v2, s[40:43], s35 offen offset:3072 sc1
s_add_u32 s35, s35, 4096
v_mfma_f32_16x16x32_bf16 v[200:203], a[116:119], a[40:43], v[200:203]
v_mfma_f32_16x16x32_bf16 v[176:179], a[116:119], a[36:39], v[176:179]
v_mfma_f32_16x16x32_bf16 v[152:155], a[116:119], a[32:35], v[152:155]
s_waitcnt vmcnt(10) lgkmcnt(0)
v_mfma_f32_16x16x32_bf16 v[132:135], a[128:131], a[48:51], v[132:135]
ds_read_b128 a[96:99], v5 offset:24576
v_mfma_f32_16x16x32_bf16 v[156:159], a[128:131], a[52:55], v[156:159]
buffer_load_dwordx4 a[32:35], v2, s[40:43], s35 offen offset:0 sc1
v_mfma_f32_16x16x32_bf16 v[180:183], a[128:131], a[56:59], v[180:183]
ds_read_b128 a[100:103], v5 offset:25600
v_mfma_f32_16x16x32_bf16 v[204:207], a[128:131], a[60:63], v[204:207]
v_mfma_f32_16x16x32_bf16 v[208:211], a[132:135], a[60:63], v[208:211]
v_mfma_f32_16x16x32_bf16 v[184:187], a[132:135], a[56:59], v[184:187]
buffer_load_dwordx4 a[36:39], v2, s[40:43], s35 offen offset:1024 sc1
v_mfma_f32_16x16x32_bf16 v[160:163], a[132:135], a[52:55], v[160:163]
ds_read_b128 a[104:107], v5 offset:26624
v_mfma_f32_16x16x32_bf16 v[136:139], a[132:135], a[48:51], v[136:139]
v_mfma_f32_16x16x32_bf16 v[140:143], a[136:139], a[48:51], v[140:143]
ds_read_b128 a[108:111], v5 offset:27648
v_mfma_f32_16x16x32_bf16 v[164:167], a[136:139], a[52:55], v[164:167]
v_mfma_f32_16x16x32_bf16 v[188:191], a[136:139], a[56:59], v[188:191]
buffer_load_dwordx4 v1, s[4:7], s44 offen offset:1024 sc1 lds
v_mfma_f32_16x16x32_bf16 v[212:215], a[136:139], a[60:63], v[212:215]
ds_read_b128 a[112:115], v5 offset:28672
v_mfma_f32_16x16x32_bf16 v[216:219], a[140:143], a[60:63], v[216:219]
v_mfma_f32_16x16x32_bf16 v[192:195], a[140:143], a[56:59], v[192:195]
ds_read_b128 a[116:119], v5 offset:29696
v_mfma_f32_16x16x32_bf16 v[168:171], a[140:143], a[52:55], v[168:171]
v_mfma_f32_16x16x32_bf16 v[144:147], a[140:143], a[48:51], v[144:147]
buffer_load_dwordx4 a[40:43], v2, s[40:43], s35 offen offset:2048 sc1
v_mfma_f32_16x16x32_bf16 v[148:151], a[144:147], a[48:51], v[148:151]
v_mfma_f32_16x16x32_bf16 v[172:175], a[144:147], a[52:55], v[172:175]
v_mfma_f32_16x16x32_bf16 v[196:199], a[144:147], a[56:59], v[196:199]
v_mfma_f32_16x16x32_bf16 v[220:223], a[144:147], a[60:63], v[220:223]
v_mfma_f32_16x16x32_bf16 v[224:227], a[148:151], a[60:63], v[224:227]
buffer_load_dwordx4 a[44:47], v2, s[40:43], s35 offen offset:3072 sc1
s_add_u32 s35, s35, 4096
v_mfma_f32_16x16x32_bf16 v[200:203], a[148:151], a[56:59], v[200:203]
v_mfma_f32_16x16x32_bf16 v[176:179], a[148:151], a[52:55], v[176:179]
v_mfma_f32_16x16x32_bf16 v[152:155], a[148:151], a[48:51], v[152:155]
s_waitcnt vmcnt(10) lgkmcnt(0)
v_mfma_f32_16x16x32_bf16 v[132:135], a[96:99], a[0:3], v[132:135]
ds_read_b128 a[128:131], v5 offset:30720
v_mfma_f32_16x16x32_bf16 v[156:159], a[96:99], a[4:7], v[156:159]
buffer_load_dwordx4 a[48:51], v2, s[40:43], s35 offen offset:0 sc1
v_mfma_f32_16x16x32_bf16 v[180:183], a[96:99], a[8:11], v[180:183]
ds_read_b128 a[132:135], v5 offset:31744
v_mfma_f32_16x16x32_bf16 v[204:207], a[96:99], a[12:15], v[204:207]
v_mfma_f32_16x16x32_bf16 v[208:211], a[100:103], a[12:15], v[208:211]
v_mfma_f32_16x16x32_bf16 v[184:187], a[100:103], a[8:11], v[184:187]
buffer_load_dwordx4 a[52:55], v2, s[40:43], s35 offen offset:1024 sc1
v_mfma_f32_16x16x32_bf16 v[160:163], a[100:103], a[4:7], v[160:163]
ds_read_b128 a[136:139], v5 offset:32768
v_mfma_f32_16x16x32_bf16 v[136:139], a[100:103], a[0:3], v[136:139]
v_mfma_f32_16x16x32_bf16 v[140:143], a[104:107], a[0:3], v[140:143]
ds_read_b128 a[140:143], v5 offset:33792
v_mfma_f32_16x16x32_bf16 v[164:167], a[104:107], a[4:7], v[164:167]
v_mfma_f32_16x16x32_bf16 v[188:191], a[104:107], a[8:11], v[188:191]
buffer_load_dwordx4 v1, s[4:7], s44 offen offset:2048 sc1 lds
s_add_u32 m0, s18, 0x21000
v_mfma_f32_16x16x32_bf16 v[212:215], a[104:107], a[12:15], v[212:215]
s_add_u32 s44, s50, 0x1421000
ds_read_b128 a[144:147], v5 offset:34816
v_mfma_f32_16x16x32_bf16 v[216:219], a[108:111], a[12:15], v[216:219]
v_mfma_f32_16x16x32_bf16 v[192:195], a[108:111], a[8:11], v[192:195]
ds_read_b128 a[148:151], v5 offset:35840
v_mfma_f32_16x16x32_bf16 v[168:171], a[108:111], a[4:7], v[168:171]
v_mfma_f32_16x16x32_bf16 v[144:147], a[108:111], a[0:3], v[144:147]
buffer_load_dwordx4 a[56:59], v2, s[40:43], s35 offen offset:2048 sc1
v_mfma_f32_16x16x32_bf16 v[148:151], a[112:115], a[0:3], v[148:151]
v_mfma_f32_16x16x32_bf16 v[172:175], a[112:115], a[4:7], v[172:175]
v_mfma_f32_16x16x32_bf16 v[196:199], a[112:115], a[8:11], v[196:199]
v_mfma_f32_16x16x32_bf16 v[220:223], a[112:115], a[12:15], v[220:223]
v_mfma_f32_16x16x32_bf16 v[224:227], a[116:119], a[12:15], v[224:227]
buffer_load_dwordx4 a[60:63], v2, s[40:43], s35 offen offset:3072 sc1
s_add_u32 s35, s35, 4096
v_mfma_f32_16x16x32_bf16 v[200:203], a[116:119], a[8:11], v[200:203]
v_mfma_f32_16x16x32_bf16 v[176:179], a[116:119], a[4:7], v[176:179]
v_mfma_f32_16x16x32_bf16 v[152:155], a[116:119], a[0:3], v[152:155]
s_waitcnt vmcnt(10) lgkmcnt(0)
v_mfma_f32_16x16x32_bf16 v[132:135], a[128:131], a[16:19], v[132:135]
ds_read_b128 a[96:99], v5 offset:36864
v_mfma_f32_16x16x32_bf16 v[156:159], a[128:131], a[20:23], v[156:159]
buffer_load_dwordx4 a[0:3], v2, s[40:43], s35 offen offset:0 sc1
v_mfma_f32_16x16x32_bf16 v[180:183], a[128:131], a[24:27], v[180:183]
ds_read_b128 a[100:103], v5 offset:37888
v_mfma_f32_16x16x32_bf16 v[204:207], a[128:131], a[28:31], v[204:207]
v_mfma_f32_16x16x32_bf16 v[208:211], a[132:135], a[28:31], v[208:211]
v_mfma_f32_16x16x32_bf16 v[184:187], a[132:135], a[24:27], v[184:187]
buffer_load_dwordx4 v1, s[4:7], s44 offen offset:0 sc1 lds
v_mfma_f32_16x16x32_bf16 v[160:163], a[132:135], a[20:23], v[160:163]
ds_read_b128 a[104:107], v5 offset:38912
v_mfma_f32_16x16x32_bf16 v[136:139], a[132:135], a[16:19], v[136:139]
v_mfma_f32_16x16x32_bf16 v[140:143], a[136:139], a[16:19], v[140:143]
ds_read_b128 a[108:111], v5 offset:39936
v_mfma_f32_16x16x32_bf16 v[164:167], a[136:139], a[20:23], v[164:167]
buffer_load_dwordx4 a[4:7], v2, s[40:43], s35 offen offset:1024 sc1
v_mfma_f32_16x16x32_bf16 v[188:191], a[136:139], a[24:27], v[188:191]
ds_read_b128 a[112:115], v5 offset:40960
v_mfma_f32_16x16x32_bf16 v[212:215], a[136:139], a[28:31], v[212:215]
v_mfma_f32_16x16x32_bf16 v[216:219], a[140:143], a[28:31], v[216:219]
v_mfma_f32_16x16x32_bf16 v[192:195], a[140:143], a[24:27], v[192:195]
buffer_load_dwordx4 a[8:11], v2, s[40:43], s35 offen offset:2048 sc1
v_mfma_f32_16x16x32_bf16 v[168:171], a[140:143], a[20:23], v[168:171]
ds_read_b128 a[116:119], v5 offset:41984
v_mfma_f32_16x16x32_bf16 v[144:147], a[140:143], a[16:19], v[144:147]
v_mfma_f32_16x16x32_bf16 v[148:151], a[144:147], a[16:19], v[148:151]
v_mfma_f32_16x16x32_bf16 v[172:175], a[144:147], a[20:23], v[172:175]
buffer_load_dwordx4 v1, s[4:7], s44 offen offset:1024 sc1 lds
v_mfma_f32_16x16x32_bf16 v[196:199], a[144:147], a[24:27], v[196:199]
v_mfma_f32_16x16x32_bf16 v[220:223], a[144:147], a[28:31], v[220:223]
v_mfma_f32_16x16x32_bf16 v[224:227], a[148:151], a[28:31], v[224:227]
v_mfma_f32_16x16x32_bf16 v[200:203], a[148:151], a[24:27], v[200:203]
buffer_load_dwordx4 a[12:15], v2, s[40:43], s35 offen offset:3072 sc1
s_add_u32 s35, s35, 4096
v_mfma_f32_16x16x32_bf16 v[176:179], a[148:151], a[20:23], v[176:179]
v_mfma_f32_16x16x32_bf16 v[152:155], a[148:151], a[16:19], v[152:155]
s_waitcnt vmcnt(11) lgkmcnt(0)
v_mfma_f32_16x16x32_bf16 v[132:135], a[96:99], a[32:35], v[132:135]
ds_read_b128 a[128:131], v5 offset:43008
v_mfma_f32_16x16x32_bf16 v[156:159], a[96:99], a[36:39], v[156:159]
buffer_load_dwordx4 a[16:19], v2, s[40:43], s35 offen offset:0 sc1
v_mfma_f32_16x16x32_bf16 v[180:183], a[96:99], a[40:43], v[180:183]
ds_read_b128 a[132:135], v5 offset:44032
v_mfma_f32_16x16x32_bf16 v[204:207], a[96:99], a[44:47], v[204:207]
v_mfma_f32_16x16x32_bf16 v[208:211], a[100:103], a[44:47], v[208:211]
v_mfma_f32_16x16x32_bf16 v[184:187], a[100:103], a[40:43], v[184:187]
buffer_load_dwordx4 a[20:23], v2, s[40:43], s35 offen offset:1024 sc1
v_mfma_f32_16x16x32_bf16 v[160:163], a[100:103], a[36:39], v[160:163]
ds_read_b128 a[136:139], v5 offset:45056
v_mfma_f32_16x16x32_bf16 v[136:139], a[100:103], a[32:35], v[136:139]
v_mfma_f32_16x16x32_bf16 v[140:143], a[104:107], a[32:35], v[140:143]
ds_read_b128 a[140:143], v5 offset:46080
v_mfma_f32_16x16x32_bf16 v[164:167], a[104:107], a[36:39], v[164:167]
v_mfma_f32_16x16x32_bf16 v[188:191], a[104:107], a[40:43], v[188:191]
buffer_load_dwordx4 v1, s[4:7], s44 offen offset:2048 sc1 lds
s_add_u32 s88, s82, 0x240000
v_mfma_f32_16x16x32_bf16 v[212:215], a[104:107], a[44:47], v[212:215]
ds_read_b128 a[144:147], v5 offset:47104
v_mfma_f32_16x16x32_bf16 v[216:219], a[108:111], a[44:47], v[216:219]
v_mfma_f32_16x16x32_bf16 v[192:195], a[108:111], a[40:43], v[192:195]
ds_read_b128 a[148:151], v5 offset:48128
v_mfma_f32_16x16x32_bf16 v[168:171], a[108:111], a[36:39], v[168:171]
v_mfma_f32_16x16x32_bf16 v[144:147], a[108:111], a[32:35], v[144:147]
buffer_load_dwordx4 a[24:27], v2, s[40:43], s35 offen offset:2048 sc1
v_mfma_f32_16x16x32_bf16 v[148:151], a[112:115], a[32:35], v[148:151]
v_mfma_f32_16x16x32_bf16 v[172:175], a[112:115], a[36:39], v[172:175]
v_mfma_f32_16x16x32_bf16 v[196:199], a[112:115], a[40:43], v[196:199]
v_mfma_f32_16x16x32_bf16 v[220:223], a[112:115], a[44:47], v[220:223]
v_mfma_f32_16x16x32_bf16 v[224:227], a[116:119], a[44:47], v[224:227]
buffer_load_dwordx4 a[28:31], v2, s[40:43], s35 offen offset:3072 sc1
s_add_u32 s35, s35, 4096
v_mfma_f32_16x16x32_bf16 v[200:203], a[116:119], a[40:43], v[200:203]
v_mfma_f32_16x16x32_bf16 v[176:179], a[116:119], a[36:39], v[176:179]
v_mfma_f32_16x16x32_bf16 v[152:155], a[116:119], a[32:35], v[152:155]
s_waitcnt vmcnt(11) lgkmcnt(0)
s_barrier
v_mfma_f32_16x16x32_bf16 v[132:135], a[128:131], a[48:51], v[132:135]
v_add_u32 v5, 49152, v1
v_mfma_f32_16x16x32_bf16 v[156:159], a[128:131], a[52:55], v[156:159]
buffer_load_dwordx4 a[32:35], v2, s[40:43], s35 offen offset:0 sc1
v_mfma_f32_16x16x32_bf16 v[180:183], a[128:131], a[56:59], v[180:183]
ds_read_b128 a[96:99], v5 offset:0
v_mfma_f32_16x16x32_bf16 v[204:207], a[128:131], a[60:63], v[204:207]
ds_read_b128 a[100:103], v5 offset:1024
v_mfma_f32_16x16x32_bf16 v[208:211], a[132:135], a[60:63], v[208:211]
v_mfma_f32_16x16x32_bf16 v[184:187], a[132:135], a[56:59], v[184:187]
buffer_load_dwordx4 a[36:39], v2, s[40:43], s35 offen offset:1024 sc1
v_mfma_f32_16x16x32_bf16 v[160:163], a[132:135], a[52:55], v[160:163]
ds_read_b128 a[104:107], v5 offset:2048
v_mfma_f32_16x16x32_bf16 v[136:139], a[132:135], a[48:51], v[136:139]
v_mfma_f32_16x16x32_bf16 v[140:143], a[136:139], a[48:51], v[140:143]
ds_read_b128 a[108:111], v5 offset:3072
v_mfma_f32_16x16x32_bf16 v[164:167], a[136:139], a[52:55], v[164:167]
v_mfma_f32_16x16x32_bf16 v[188:191], a[136:139], a[56:59], v[188:191]
buffer_load_dwordx4 v[92:95], v1, s[4:7], s88 offen offset:0 sc1
v_mfma_f32_16x16x32_bf16 v[212:215], a[136:139], a[60:63], v[212:215]
ds_read_b128 a[112:115], v5 offset:4096
v_mfma_f32_16x16x32_bf16 v[216:219], a[140:143], a[60:63], v[216:219]
v_mfma_f32_16x16x32_bf16 v[192:195], a[140:143], a[56:59], v[192:195]
ds_read_b128 a[116:119], v5 offset:5120
v_mfma_f32_16x16x32_bf16 v[168:171], a[140:143], a[52:55], v[168:171]
v_mfma_f32_16x16x32_bf16 v[144:147], a[140:143], a[48:51], v[144:147]
buffer_load_dwordx4 a[40:43], v2, s[40:43], s35 offen offset:2048 sc1
v_mfma_f32_16x16x32_bf16 v[148:151], a[144:147], a[48:51], v[148:151]
v_mfma_f32_16x16x32_bf16 v[172:175], a[144:147], a[52:55], v[172:175]
v_mfma_f32_16x16x32_bf16 v[196:199], a[144:147], a[56:59], v[196:199]
v_mfma_f32_16x16x32_bf16 v[220:223], a[144:147], a[60:63], v[220:223]
v_mfma_f32_16x16x32_bf16 v[224:227], a[148:151], a[60:63], v[224:227]
buffer_load_dwordx4 a[44:47], v2, s[40:43], s35 offen offset:3072 sc1
s_add_u32 s35, s35, 4096
v_mfma_f32_16x16x32_bf16 v[200:203], a[148:151], a[56:59], v[200:203]
v_mfma_f32_16x16x32_bf16 v[176:179], a[148:151], a[52:55], v[176:179]
v_mfma_f32_16x16x32_bf16 v[152:155], a[148:151], a[48:51], v[152:155]
s_waitcnt vmcnt(10) lgkmcnt(0)
v_mfma_f32_16x16x32_bf16 v[132:135], a[96:99], a[0:3], v[132:135]
ds_read_b128 a[128:131], v5 offset:6144
v_mfma_f32_16x16x32_bf16 v[156:159], a[96:99], a[4:7], v[156:159]
buffer_load_dwordx4 a[48:51], v2, s[40:43], s35 offen offset:0 sc1
v_mfma_f32_16x16x32_bf16 v[180:183], a[96:99], a[8:11], v[180:183]
ds_read_b128 a[132:135], v5 offset:7168
v_mfma_f32_16x16x32_bf16 v[204:207], a[96:99], a[12:15], v[204:207]
v_mfma_f32_16x16x32_bf16 v[208:211], a[100:103], a[12:15], v[208:211]
v_mfma_f32_16x16x32_bf16 v[184:187], a[100:103], a[8:11], v[184:187]
buffer_load_dwordx4 a[52:55], v2, s[40:43], s35 offen offset:1024 sc1
v_mfma_f32_16x16x32_bf16 v[160:163], a[100:103], a[4:7], v[160:163]
ds_read_b128 a[136:139], v5 offset:8192
v_mfma_f32_16x16x32_bf16 v[136:139], a[100:103], a[0:3], v[136:139]
v_mfma_f32_16x16x32_bf16 v[140:143], a[104:107], a[0:3], v[140:143]
ds_read_b128 a[140:143], v5 offset:9216
v_mfma_f32_16x16x32_bf16 v[164:167], a[104:107], a[4:7], v[164:167]
v_mfma_f32_16x16x32_bf16 v[188:191], a[104:107], a[8:11], v[188:191]
buffer_load_dwordx4 v[96:99], v1, s[4:7], s88 offen offset:1024 sc1
v_mfma_f32_16x16x32_bf16 v[212:215], a[104:107], a[12:15], v[212:215]
ds_read_b128 a[144:147], v5 offset:10240
v_mfma_f32_16x16x32_bf16 v[216:219], a[108:111], a[12:15], v[216:219]
v_mfma_f32_16x16x32_bf16 v[192:195], a[108:111], a[8:11], v[192:195]
ds_read_b128 a[148:151], v5 offset:11264
v_mfma_f32_16x16x32_bf16 v[168:171], a[108:111], a[4:7], v[168:171]
v_mfma_f32_16x16x32_bf16 v[144:147], a[108:111], a[0:3], v[144:147]
buffer_load_dwordx4 a[56:59], v2, s[40:43], s35 offen offset:2048 sc1
v_mfma_f32_16x16x32_bf16 v[148:151], a[112:115], a[0:3], v[148:151]
v_mfma_f32_16x16x32_bf16 v[172:175], a[112:115], a[4:7], v[172:175]
v_mfma_f32_16x16x32_bf16 v[196:199], a[112:115], a[8:11], v[196:199]
v_mfma_f32_16x16x32_bf16 v[220:223], a[112:115], a[12:15], v[220:223]
v_mfma_f32_16x16x32_bf16 v[224:227], a[116:119], a[12:15], v[224:227]
buffer_load_dwordx4 a[60:63], v2, s[40:43], s35 offen offset:3072 sc1
s_add_u32 s35, s35, 4096
v_mfma_f32_16x16x32_bf16 v[200:203], a[116:119], a[8:11], v[200:203]
v_mfma_f32_16x16x32_bf16 v[176:179], a[116:119], a[4:7], v[176:179]
v_mfma_f32_16x16x32_bf16 v[152:155], a[116:119], a[0:3], v[152:155]
s_waitcnt vmcnt(10) lgkmcnt(0)
v_mfma_f32_16x16x32_bf16 v[132:135], a[128:131], a[16:19], v[132:135]
ds_read_b128 a[96:99], v5 offset:12288
v_mfma_f32_16x16x32_bf16 v[156:159], a[128:131], a[20:23], v[156:159]
buffer_load_dwordx4 a[0:3], v2, s[40:43], s35 offen offset:0 sc1
v_mfma_f32_16x16x32_bf16 v[180:183], a[128:131], a[24:27], v[180:183]
ds_read_b128 a[100:103], v5 offset:13312
v_mfma_f32_16x16x32_bf16 v[204:207], a[128:131], a[28:31], v[204:207]
v_mfma_f32_16x16x32_bf16 v[208:211], a[132:135], a[28:31], v[208:211]
v_mfma_f32_16x16x32_bf16 v[184:187], a[132:135], a[24:27], v[184:187]
buffer_load_dwordx4 a[4:7], v2, s[40:43], s35 offen offset:1024 sc1
v_mfma_f32_16x16x32_bf16 v[160:163], a[132:135], a[20:23], v[160:163]
ds_read_b128 a[104:107], v5 offset:14336
v_mfma_f32_16x16x32_bf16 v[136:139], a[132:135], a[16:19], v[136:139]
v_mfma_f32_16x16x32_bf16 v[140:143], a[136:139], a[16:19], v[140:143]
ds_read_b128 a[108:111], v5 offset:15360
v_mfma_f32_16x16x32_bf16 v[164:167], a[136:139], a[20:23], v[164:167]
v_mfma_f32_16x16x32_bf16 v[188:191], a[136:139], a[24:27], v[188:191]
buffer_load_dwordx4 v[100:103], v1, s[4:7], s88 offen offset:2048 sc1
v_mfma_f32_16x16x32_bf16 v[212:215], a[136:139], a[28:31], v[212:215]
ds_read_b128 a[112:115], v5 offset:16384
v_mfma_f32_16x16x32_bf16 v[216:219], a[140:143], a[28:31], v[216:219]
v_mfma_f32_16x16x32_bf16 v[192:195], a[140:143], a[24:27], v[192:195]
ds_read_b128 a[116:119], v5 offset:17408
v_mfma_f32_16x16x32_bf16 v[168:171], a[140:143], a[20:23], v[168:171]
v_mfma_f32_16x16x32_bf16 v[144:147], a[140:143], a[16:19], v[144:147]
buffer_load_dwordx4 a[8:11], v2, s[40:43], s35 offen offset:2048 sc1
v_mfma_f32_16x16x32_bf16 v[148:151], a[144:147], a[16:19], v[148:151]
v_mfma_f32_16x16x32_bf16 v[172:175], a[144:147], a[20:23], v[172:175]
v_mfma_f32_16x16x32_bf16 v[196:199], a[144:147], a[24:27], v[196:199]
v_mfma_f32_16x16x32_bf16 v[220:223], a[144:147], a[28:31], v[220:223]
v_mfma_f32_16x16x32_bf16 v[224:227], a[148:151], a[28:31], v[224:227]
buffer_load_dwordx4 a[12:15], v2, s[40:43], s35 offen offset:3072 sc1
s_add_u32 s35, s35, 4096
v_mfma_f32_16x16x32_bf16 v[200:203], a[148:151], a[24:27], v[200:203]
v_mfma_f32_16x16x32_bf16 v[176:179], a[148:151], a[20:23], v[176:179]
v_mfma_f32_16x16x32_bf16 v[152:155], a[148:151], a[16:19], v[152:155]
s_waitcnt vmcnt(10) lgkmcnt(0)
v_mfma_f32_16x16x32_bf16 v[132:135], a[96:99], a[32:35], v[132:135]
ds_read_b128 a[128:131], v5 offset:18432
v_mfma_f32_16x16x32_bf16 v[156:159], a[96:99], a[36:39], v[156:159]
buffer_load_dwordx4 a[16:19], v2, s[40:43], s35 offen offset:0 sc1
v_mfma_f32_16x16x32_bf16 v[180:183], a[96:99], a[40:43], v[180:183]
ds_read_b128 a[132:135], v5 offset:19456
v_mfma_f32_16x16x32_bf16 v[204:207], a[96:99], a[44:47], v[204:207]
v_mfma_f32_16x16x32_bf16 v[208:211], a[100:103], a[44:47], v[208:211]
v_mfma_f32_16x16x32_bf16 v[184:187], a[100:103], a[40:43], v[184:187]
buffer_load_dwordx4 a[20:23], v2, s[40:43], s35 offen offset:1024 sc1
v_mfma_f32_16x16x32_bf16 v[160:163], a[100:103], a[36:39], v[160:163]
ds_read_b128 a[136:139], v5 offset:20480
v_mfma_f32_16x16x32_bf16 v[136:139], a[100:103], a[32:35], v[136:139]
v_mfma_f32_16x16x32_bf16 v[140:143], a[104:107], a[32:35], v[140:143]
ds_read_b128 a[140:143], v5 offset:21504
v_mfma_f32_16x16x32_bf16 v[164:167], a[104:107], a[36:39], v[164:167]
v_mfma_f32_16x16x32_bf16 v[188:191], a[104:107], a[40:43], v[188:191]
buffer_load_dwordx4 v[104:107], v1, s[4:7], s88 offen offset:3072 sc1
s_add_u32 s88, s88, 4096
v_mfma_f32_16x16x32_bf16 v[212:215], a[104:107], a[44:47], v[212:215]
ds_read_b128 a[144:147], v5 offset:22528
v_mfma_f32_16x16x32_bf16 v[216:219], a[108:111], a[44:47], v[216:219]
v_mfma_f32_16x16x32_bf16 v[192:195], a[108:111], a[40:43], v[192:195]
L_stub5:
s_cbranch_execz L_stub6
ds_read_b128 a[148:151], v5 offset:23552
v_mfma_f32_16x16x32_bf16 v[168:171], a[108:111], a[36:39], v[168:171]
v_mfma_f32_16x16x32_bf16 v[144:147], a[108:111], a[32:35], v[144:147]
buffer_load_dwordx4 a[24:27], v2, s[40:43], s35 offen offset:2048 sc1
v_mfma_f32_16x16x32_bf16 v[148:151], a[112:115], a[32:35], v[148:151]
v_mfma_f32_16x16x32_bf16 v[172:175], a[112:115], a[36:39], v[172:175]
v_mfma_f32_16x16x32_bf16 v[196:199], a[112:115], a[40:43], v[196:199]
v_mfma_f32_16x16x32_bf16 v[220:223], a[112:115], a[44:47], v[220:223]
v_mfma_f32_16x16x32_bf16 v[224:227], a[116:119], a[44:47], v[224:227]
buffer_load_dwordx4 a[28:31], v2, s[40:43], s35 offen offset:3072 sc1
s_add_u32 s35, s35, 4096
v_mfma_f32_16x16x32_bf16 v[200:203], a[116:119], a[40:43], v[200:203]
v_mfma_f32_16x16x32_bf16 v[176:179], a[116:119], a[36:39], v[176:179]
v_mfma_f32_16x16x32_bf16 v[152:155], a[116:119], a[32:35], v[152:155]
s_waitcnt vmcnt(10) lgkmcnt(0)
v_mfma_f32_16x16x32_bf16 v[132:135], a[128:131], a[48:51], v[132:135]
ds_read_b128 a[96:99], v5 offset:24576
v_mfma_f32_16x16x32_bf16 v[156:159], a[128:131], a[52:55], v[156:159]
buffer_load_dwordx4 a[32:35], v2, s[40:43], s35 offen offset:0 sc1
v_mfma_f32_16x16x32_bf16 v[180:183], a[128:131], a[56:59], v[180:183]
ds_read_b128 a[100:103], v5 offset:25600
v_mfma_f32_16x16x32_bf16 v[204:207], a[128:131], a[60:63], v[204:207]
v_mfma_f32_16x16x32_bf16 v[208:211], a[132:135], a[60:63], v[208:211]
v_mfma_f32_16x16x32_bf16 v[184:187], a[132:135], a[56:59], v[184:187]
buffer_load_dwordx4 a[36:39], v2, s[40:43], s35 offen offset:1024 sc1
v_mfma_f32_16x16x32_bf16 v[160:163], a[132:135], a[52:55], v[160:163]
ds_read_b128 a[104:107], v5 offset:26624
v_mfma_f32_16x16x32_bf16 v[136:139], a[132:135], a[48:51], v[136:139]
v_mfma_f32_16x16x32_bf16 v[140:143], a[136:139], a[48:51], v[140:143]
ds_read_b128 a[108:111], v5 offset:27648
v_mfma_f32_16x16x32_bf16 v[164:167], a[136:139], a[52:55], v[164:167]
v_mfma_f32_16x16x32_bf16 v[188:191], a[136:139], a[56:59], v[188:191]
buffer_load_dwordx4 v[108:111], v1, s[4:7], s88 offen offset:0 sc1
v_mfma_f32_16x16x32_bf16 v[212:215], a[136:139], a[60:63], v[212:215]
ds_read_b128 a[112:115], v5 offset:28672
v_mfma_f32_16x16x32_bf16 v[216:219], a[140:143], a[60:63], v[216:219]
v_mfma_f32_16x16x32_bf16 v[192:195], a[140:143], a[56:59], v[192:195]
ds_read_b128 a[116:119], v5 offset:29696
v_mfma_f32_16x16x32_bf16 v[168:171], a[140:143], a[52:55], v[168:171]
v_mfma_f32_16x16x32_bf16 v[144:147], a[140:143], a[48:51], v[144:147]
buffer_load_dwordx4 a[40:43], v2, s[40:43], s35 offen offset:2048 sc1
v_mfma_f32_16x16x32_bf16 v[148:151], a[144:147], a[48:51], v[148:151]
v_mfma_f32_16x16x32_bf16 v[172:175], a[144:147], a[52:55], v[172:175]
v_mfma_f32_16x16x32_bf16 v[196:199], a[144:147], a[56:59], v[196:199]
v_mfma_f32_16x16x32_bf16 v[220:223], a[144:147], a[60:63], v[220:223]
v_mfma_f32_16x16x32_bf16 v[224:227], a[148:151], a[60:63], v[224:227]
buffer_load_dwordx4 a[44:47], v2, s[40:43], s35 offen offset:3072 sc1
s_add_u32 s35, s35, 4096
v_mfma_f32_16x16x32_bf16 v[200:203], a[148:151], a[56:59], v[200:203]
v_mfma_f32_16x16x32_bf16 v[176:179], a[148:151], a[52:55], v[176:179]
v_mfma_f32_16x16x32_bf16 v[152:155], a[148:151], a[48:51], v[152:155]
s_waitcnt vmcnt(10) lgkmcnt(0)
v_mfma_f32_16x16x32_bf16 v[132:135], a[96:99], a[0:3], v[132:135]
ds_read_b128 a[128:131], v5 offset:30720
v_add_f32_dpp v48, v48, v48 row_ror:8 row_mask:0xf bank_mask:0xf
v_mfma_f32_16x16x32_bf16 v[156:159], a[96:99], a[4:7], v[156:159]
buffer_load_dwordx4 a[48:51], v2, s[40:43], s35 offen offset:0 sc1
v_mfma_f32_16x16x32_bf16 v[180:183], a[96:99], a[8:11], v[180:183]
ds_read_b128 a[132:135], v5 offset:31744
v_add_f32_dpp v49, v49, v49 row_ror:8 row_mask:0xf bank_mask:0xf
v_mfma_f32_16x16x32_bf16 v[204:207], a[96:99], a[12:15], v[204:207]
v_add_f32_dpp v50, v50, v50 row_ror:8 row_mask:0xf bank_mask:0xf
v_add_f32_dpp v51, v51, v51 row_ror:8 row_mask:0xf bank_mask:0xf
v_mfma_f32_16x16x32_bf16 v[208:211], a[100:103], a[12:15], v[208:211]
v_add_f32_dpp v52, v52, v52 row_ror:8 row_mask:0xf bank_mask:0xf
v_add_f32_dpp v53, v53, v53 row_ror:8 row_mask:0xf bank_mask:0xf
v_mfma_f32_16x16x32_bf16 v[184:187], a[100:103], a[8:11], v[184:187]
buffer_load_dwordx4 a[52:55], v2, s[40:43], s35 offen offset:1024 sc1
v_mfma_f32_16x16x32_bf16 v[160:163], a[100:103], a[4:7], v[160:163]
ds_read_b128 a[136:139], v5 offset:32768
v_add_f32_dpp v54, v54, v54 row_ror:8 row_mask:0xf bank_mask:0xf
v_mfma_f32_16x16x32_bf16 v[136:139], a[100:103], a[0:3], v[136:139]
v_add_f32_dpp v55, v55, v55 row_ror:8 row_mask:0xf bank_mask:0xf
v_add_f32_dpp v48, v48, v48 row_ror:4 row_mask:0xf bank_mask:0xf
v_mfma_f32_16x16x32_bf16 v[140:143], a[104:107], a[0:3], v[140:143]
ds_read_b128 a[140:143], v5 offset:33792
v_add_f32_dpp v49, v49, v49 row_ror:4 row_mask:0xf bank_mask:0xf
v_mfma_f32_16x16x32_bf16 v[164:167], a[104:107], a[4:7], v[164:167]
v_add_f32_dpp v50, v50, v50 row_ror:4 row_mask:0xf bank_mask:0xf
v_mfma_f32_16x16x32_bf16 v[188:191], a[104:107], a[8:11], v[188:191]
buffer_load_dwordx4 v[112:115], v1, s[4:7], s88 offen offset:1024 sc1
v_mfma_f32_16x16x32_bf16 v[212:215], a[104:107], a[12:15], v[212:215]
ds_read_b128 a[144:147], v5 offset:34816
v_add_f32_dpp v51, v51, v51 row_ror:4 row_mask:0xf bank_mask:0xf
v_mfma_f32_16x16x32_bf16 v[216:219], a[108:111], a[12:15], v[216:219]
v_add_f32_dpp v52, v52, v52 row_ror:4 row_mask:0xf bank_mask:0xf
v_add_f32_dpp v53, v53, v53 row_ror:4 row_mask:0xf bank_mask:0xf
v_mfma_f32_16x16x32_bf16 v[192:195], a[108:111], a[8:11], v[192:195]
ds_read_b128 a[148:151], v5 offset:35840
v_add_f32_dpp v54, v54, v54 row_ror:4 row_mask:0xf bank_mask:0xf
v_mfma_f32_16x16x32_bf16 v[168:171], a[108:111], a[4:7], v[168:171]
v_add_f32_dpp v55, v55, v55 row_ror:4 row_mask:0xf bank_mask:0xf
v_mfma_f32_16x16x32_bf16 v[144:147], a[108:111], a[0:3], v[144:147]
buffer_load_dwordx4 a[56:59], v2, s[40:43], s35 offen offset:2048 sc1
v_mfma_f32_16x16x32_bf16 v[148:151], a[112:115], a[0:3], v[148:151]
v_add_f32_dpp v48, v48, v48 row_ror:2 row_mask:0xf bank_mask:0xf
v_add_f32_dpp v49, v49, v49 row_ror:2 row_mask:0xf bank_mask:0xf
v_mfma_f32_16x16x32_bf16 v[172:175], a[112:115], a[4:7], v[172:175]
v_add_f32_dpp v50, v50, v50 row_ror:2 row_mask:0xf bank_mask:0xf
v_mfma_f32_16x16x32_bf16 v[196:199], a[112:115], a[8:11], v[196:199]
v_add_f32_dpp v51, v51, v51 row_ror:2 row_mask:0xf bank_mask:0xf
v_mfma_f32_16x16x32_bf16 v[220:223], a[112:115], a[12:15], v[220:223]
v_add_f32_dpp v52, v52, v52 row_ror:2 row_mask:0xf bank_mask:0xf
v_mfma_f32_16x16x32_bf16 v[224:227], a[116:119], a[12:15], v[224:227]
buffer_load_dwordx4 a[60:63], v2, s[40:43], s35 offen offset:3072 sc1
s_add_u32 s35, s35, 4096
v_mfma_f32_16x16x32_bf16 v[200:203], a[116:119], a[8:11], v[200:203]
v_add_f32_dpp v53, v53, v53 row_ror:2 row_mask:0xf bank_mask:0xf
v_add_f32_dpp v54, v54, v54 row_ror:2 row_mask:0xf bank_mask:0xf
v_mfma_f32_16x16x32_bf16 v[176:179], a[116:119], a[4:7], v[176:179]
v_add_f32_dpp v55, v55, v55 row_ror:2 row_mask:0xf bank_mask:0xf
v_mfma_f32_16x16x32_bf16 v[152:155], a[116:119], a[0:3], v[152:155]
v_add_f32_dpp v48, v48, v48 row_ror:1 row_mask:0xf bank_mask:0xf
s_waitcnt vmcnt(10) lgkmcnt(0)
v_mfma_f32_16x16x32_bf16 v[132:135], a[128:131], a[16:19], v[132:135]
ds_read_b128 a[96:99], v5 offset:36864
v_add_f32_dpp v49, v49, v49 row_ror:1 row_mask:0xf bank_mask:0xf
v_mfma_f32_16x16x32_bf16 v[156:159], a[128:131], a[20:23], v[156:159]
buffer_load_dwordx4 a[0:3], v2, s[40:43], s35 offen offset:0 sc1
v_mfma_f32_16x16x32_bf16 v[180:183], a[128:131], a[24:27], v[180:183]
ds_read_b128 a[100:103], v5 offset:37888
v_add_f32_dpp v50, v50, v50 row_ror:1 row_mask:0xf bank_mask:0xf
v_mfma_f32_16x16x32_bf16 v[204:207], a[128:131], a[28:31], v[204:207]
v_add_f32_dpp v51, v51, v51 row_ror:1 row_mask:0xf bank_mask:0xf
v_add_f32_dpp v52, v52, v52 row_ror:1 row_mask:0xf bank_mask:0xf
v_mfma_f32_16x16x32_bf16 v[208:211], a[132:135], a[28:31], v[208:211]
v_add_f32_dpp v53, v53, v53 row_ror:1 row_mask:0xf bank_mask:0xf
v_add_f32_dpp v54, v54, v54 row_ror:1 row_mask:0xf bank_mask:0xf
v_mfma_f32_16x16x32_bf16 v[184:187], a[132:135], a[24:27], v[184:187]
buffer_load_dwordx4 v[116:119], v1, s[4:7], s88 offen offset:2048 sc1
v_mfma_f32_16x16x32_bf16 v[160:163], a[132:135], a[20:23], v[160:163]
ds_read_b128 a[104:107], v5 offset:38912
v_add_f32_dpp v55, v55, v55 row_ror:1 row_mask:0xf bank_mask:0xf
v_mfma_f32_16x16x32_bf16 v[136:139], a[132:135], a[16:19], v[136:139]
v_add_u32 v233, 159744, v233
s_lshl_b32 s36, s28, 6
v_mfma_f32_16x16x32_bf16 v[140:143], a[136:139], a[16:19], v[140:143]
ds_read_b128 a[108:111], v5 offset:39936
s_lshl_b32 s37, s39, 6
v_mfma_f32_16x16x32_bf16 v[164:167], a[136:139], a[20:23], v[164:167]
buffer_load_dwordx4 a[4:7], v2, s[40:43], s35 offen offset:1024 sc1
v_mfma_f32_16x16x32_bf16 v[188:191], a[136:139], a[24:27], v[188:191]
ds_read_b128 a[112:115], v5 offset:40960
v_add_u32 v232, s36, v233
v_mfma_f32_16x16x32_bf16 v[212:215], a[136:139], a[28:31], v[212:215]
v_add_u32 v235, s37, v233
v_mfma_f32_16x16x32_bf16 v[216:219], a[140:143], a[28:31], v[216:219]
v_mfma_f32_16x16x32_bf16 v[192:195], a[140:143], a[24:27], v[192:195]
buffer_load_dwordx4 a[8:11], v2, s[40:43], s35 offen offset:2048 sc1
v_mfma_f32_16x16x32_bf16 v[168:171], a[140:143], a[20:23], v[168:171]
ds_read_b128 a[116:119], v5 offset:41984
v_mfma_f32_16x16x32_bf16 v[144:147], a[140:143], a[16:19], v[144:147]
v_mfma_f32_16x16x32_bf16 v[148:151], a[144:147], a[16:19], v[148:151]
v_mfma_f32_16x16x32_bf16 v[172:175], a[144:147], a[20:23], v[172:175]
buffer_load_dwordx4 v[120:123], v1, s[4:7], s88 offen offset:3072 sc1
s_add_u32 m0, s18, 0x0
v_mfma_f32_16x16x32_bf16 v[196:199], a[144:147], a[24:27], v[196:199]
s_add_u32 s44, s50, 0x1424000
v_mfma_f32_16x16x32_bf16 v[220:223], a[144:147], a[28:31], v[220:223]
v_mfma_f32_16x16x32_bf16 v[224:227], a[148:151], a[28:31], v[224:227]
v_mfma_f32_16x16x32_bf16 v[200:203], a[148:151], a[24:27], v[200:203]
buffer_load_dwordx4 a[12:15], v2, s[40:43], s35 offen offset:3072 sc1
s_add_u32 s35, s35, 4096
v_mfma_f32_16x16x32_bf16 v[176:179], a[148:151], a[20:23], v[176:179]
v_mfma_f32_16x16x32_bf16 v[152:155], a[148:151], a[16:19], v[152:155]
s_waitcnt vmcnt(11) lgkmcnt(0)
v_mfma_f32_16x16x32_bf16 v[132:135], a[96:99], a[32:35], v[132:135]
ds_read_b128 a[128:131], v5 offset:43008
v_mfma_f32_16x16x32_bf16 v[156:159], a[96:99], a[36:39], v[156:159]
buffer_load_dwordx4 a[16:19], v2, s[40:43], s35 offen offset:0 sc1
v_mfma_f32_16x16x32_bf16 v[180:183], a[96:99], a[40:43], v[180:183]
ds_read_b128 a[132:135], v5 offset:44032
v_mfma_f32_16x16x32_bf16 v[204:207], a[96:99], a[44:47], v[204:207]
ds_write_b128 v232, v[48:51]
v_mfma_f32_16x16x32_bf16 v[208:211], a[100:103], a[44:47], v[208:211]
ds_write_b128 v235, v[52:55]
v_mfma_f32_16x16x32_bf16 v[184:187], a[100:103], a[40:43], v[184:187]
buffer_load_dwordx4 a[20:23], v2, s[40:43], s35 offen offset:1024 sc1
v_mfma_f32_16x16x32_bf16 v[160:163], a[100:103], a[36:39], v[160:163]
ds_read_b128 a[136:139], v5 offset:45056
v_mfma_f32_16x16x32_bf16 v[136:139], a[100:103], a[32:35], v[136:139]
v_mfma_f32_16x16x32_bf16 v[140:143], a[104:107], a[32:35], v[140:143]
ds_read_b128 a[140:143], v5 offset:46080
v_mfma_f32_16x16x32_bf16 v[164:167], a[104:107], a[36:39], v[164:167]
v_mfma_f32_16x16x32_bf16 v[188:191], a[104:107], a[40:43], v[188:191]
buffer_load_dwordx4 v1, s[4:7], s44 offen offset:0 sc1 lds
v_mfma_f32_16x16x32_bf16 v[212:215], a[104:107], a[44:47], v[212:215]
ds_read_b128 a[144:147], v5 offset:47104
v_mfma_f32_16x16x32_bf16 v[216:219], a[108:111], a[44:47], v[216:219]
v_mfma_f32_16x16x32_bf16 v[192:195], a[108:111], a[40:43], v[192:195]
ds_read_b128 a[148:151], v5 offset:48128
v_mfma_f32_16x16x32_bf16 v[168:171], a[108:111], a[36:39], v[168:171]
v_mfma_f32_16x16x32_bf16 v[144:147], a[108:111], a[32:35], v[144:147]
buffer_load_dwordx4 a[24:27], v2, s[40:43], s35 offen offset:2048 sc1
v_mfma_f32_16x16x32_bf16 v[148:151], a[112:115], a[32:35], v[148:151]
v_mfma_f32_16x16x32_bf16 v[172:175], a[112:115], a[36:39], v[172:175]
v_mfma_f32_16x16x32_bf16 v[196:199], a[112:115], a[40:43], v[196:199]
v_mfma_f32_16x16x32_bf16 v[220:223], a[112:115], a[44:47], v[220:223]
v_mfma_f32_16x16x32_bf16 v[224:227], a[116:119], a[44:47], v[224:227]
buffer_load_dwordx4 a[28:31], v2, s[40:43], s35 offen offset:3072 sc1
s_add_u32 s35, s35, 4096
v_mfma_f32_16x16x32_bf16 v[200:203], a[116:119], a[40:43], v[200:203]
v_mfma_f32_16x16x32_bf16 v[176:179], a[116:119], a[36:39], v[176:179]
v_mfma_f32_16x16x32_bf16 v[152:155], a[116:119], a[32:35], v[152:155]
s_waitcnt vmcnt(11) lgkmcnt(0)
s_barrier
v_mfma_f32_16x16x32_bf16 v[132:135], a[128:131], a[48:51], v[132:135]
v_add_u32 v5, 98304, v1
v_mfma_f32_16x16x32_bf16 v[156:159], a[128:131], a[52:55], v[156:159]
buffer_load_dwordx4 a[32:35], v2, s[40:43], s35 offen offset:0 sc1
v_mfma_f32_16x16x32_bf16 v[180:183], a[128:131], a[56:59], v[180:183]
ds_read_b128 a[96:99], v5 offset:0
v_mfma_f32_16x16x32_bf16 v[204:207], a[128:131], a[60:63], v[204:207]
ds_read_b128 a[100:103], v5 offset:1024
v_mfma_f32_16x16x32_bf16 v[208:211], a[132:135], a[60:63], v[208:211]
ds_read_b128 v[48:51], v233 offset:0
v_mfma_f32_16x16x32_bf16 v[184:187], a[132:135], a[56:59], v[184:187]
buffer_load_dwordx4 a[36:39], v2, s[40:43], s35 offen offset:1024 sc1
v_mfma_f32_16x16x32_bf16 v[160:163], a[132:135], a[52:55], v[160:163]
ds_read_b128 a[104:107], v5 offset:2048
v_mfma_f32_16x16x32_bf16 v[136:139], a[132:135], a[48:51], v[136:139]
v_mfma_f32_16x16x32_bf16 v[140:143], a[136:139], a[48:51], v[140:143]
ds_read_b128 a[108:111], v5 offset:3072
v_mfma_f32_16x16x32_bf16 v[164:167], a[136:139], a[52:55], v[164:167]
v_mfma_f32_16x16x32_bf16 v[188:191], a[136:139], a[56:59], v[188:191]
buffer_load_dwordx4 v1, s[4:7], s44 offen offset:1024 sc1 lds
v_mfma_f32_16x16x32_bf16 v[212:215], a[136:139], a[60:63], v[212:215]
ds_read_b128 a[112:115], v5 offset:4096
v_mfma_f32_16x16x32_bf16 v[216:219], a[140:143], a[60:63], v[216:219]
ds_read_b128 v[52:55], v233 offset:64
v_mfma_f32_16x16x32_bf16 v[192:195], a[140:143], a[56:59], v[192:195]
ds_read_b128 a[116:119], v5 offset:5120
v_mfma_f32_16x16x32_bf16 v[168:171], a[140:143], a[52:55], v[168:171]
v_mfma_f32_16x16x32_bf16 v[144:147], a[140:143], a[48:51], v[144:147]
buffer_load_dwordx4 a[40:43], v2, s[40:43], s35 offen offset:2048 sc1
v_mfma_f32_16x16x32_bf16 v[148:151], a[144:147], a[48:51], v[148:151]
v_mfma_f32_16x16x32_bf16 v[172:175], a[144:147], a[52:55], v[172:175]
v_mfma_f32_16x16x32_bf16 v[196:199], a[144:147], a[56:59], v[196:199]
v_mfma_f32_16x16x32_bf16 v[220:223], a[144:147], a[60:63], v[220:223]
v_mfma_f32_16x16x32_bf16 v[224:227], a[148:151], a[60:63], v[224:227]
buffer_load_dwordx4 a[44:47], v2, s[40:43], s35 offen offset:3072 sc1
s_add_u32 s35, s35, 4096
v_mfma_f32_16x16x32_bf16 v[200:203], a[148:151], a[56:59], v[200:203]
ds_read_b128 v[56:59], v233 offset:128
v_mfma_f32_16x16x32_bf16 v[176:179], a[148:151], a[52:55], v[176:179]
v_mfma_f32_16x16x32_bf16 v[152:155], a[148:151], a[48:51], v[152:155]
s_waitcnt vmcnt(10) lgkmcnt(1)
v_mfma_f32_16x16x32_bf16 v[132:135], a[96:99], a[0:3], v[132:135]
ds_read_b128 a[128:131], v5 offset:6144
v_mfma_f32_16x16x32_bf16 v[156:159], a[96:99], a[4:7], v[156:159]
buffer_load_dwordx4 a[48:51], v2, s[40:43], s35 offen offset:0 sc1
v_mfma_f32_16x16x32_bf16 v[180:183], a[96:99], a[8:11], v[180:183]
ds_read_b128 a[132:135], v5 offset:7168
v_mfma_f32_16x16x32_bf16 v[204:207], a[96:99], a[12:15], v[204:207]
v_mfma_f32_16x16x32_bf16 v[208:211], a[100:103], a[12:15], v[208:211]
v_mfma_f32_16x16x32_bf16 v[184:187], a[100:103], a[8:11], v[184:187]
buffer_load_dwordx4 a[52:55], v2, s[40:43], s35 offen offset:1024 sc1
v_mfma_f32_16x16x32_bf16 v[160:163], a[100:103], a[4:7], v[160:163]
ds_read_b128 a[136:139], v5 offset:8192
v_mfma_f32_16x16x32_bf16 v[136:139], a[100:103], a[0:3], v[136:139]
v_mfma_f32_16x16x32_bf16 v[140:143], a[104:107], a[0:3], v[140:143]
ds_read_b128 a[140:143], v5 offset:9216
v_mfma_f32_16x16x32_bf16 v[164:167], a[104:107], a[4:7], v[164:167]
ds_read_b128 v[60:63], v233 offset:192
v_mfma_f32_16x16x32_bf16 v[188:191], a[104:107], a[8:11], v[188:191]
buffer_load_dwordx4 v1, s[4:7], s44 offen offset:2048 sc1 lds
s_add_u32 m0, s18, 0x3000
v_mfma_f32_16x16x32_bf16 v[212:215], a[104:107], a[12:15], v[212:215]
s_add_u32 s44, s50, 0x1427000
ds_read_b128 a[144:147], v5 offset:10240
v_mfma_f32_16x16x32_bf16 v[216:219], a[108:111], a[12:15], v[216:219]
v_mfma_f32_16x16x32_bf16 v[192:195], a[108:111], a[8:11], v[192:195]
ds_read_b128 a[148:151], v5 offset:11264
v_mfma_f32_16x16x32_bf16 v[168:171], a[108:111], a[4:7], v[168:171]
v_mfma_f32_16x16x32_bf16 v[144:147], a[108:111], a[0:3], v[144:147]
buffer_load_dwordx4 a[56:59], v2, s[40:43], s35 offen offset:2048 sc1
v_mfma_f32_16x16x32_bf16 v[148:151], a[112:115], a[0:3], v[148:151]
v_mfma_f32_16x16x32_bf16 v[172:175], a[112:115], a[4:7], v[172:175]
v_mfma_f32_16x16x32_bf16 v[196:199], a[112:115], a[8:11], v[196:199]
ds_read_b128 v[64:67], v233 offset:256
v_mfma_f32_16x16x32_bf16 v[220:223], a[112:115], a[12:15], v[220:223]
v_mfma_f32_16x16x32_bf16 v[224:227], a[116:119], a[12:15], v[224:227]
buffer_load_dwordx4 a[60:63], v2, s[40:43], s35 offen offset:3072 sc1
s_add_u32 s35, s35, 4096
v_mfma_f32_16x16x32_bf16 v[200:203], a[116:119], a[8:11], v[200:203]
v_mfma_f32_16x16x32_bf16 v[176:179], a[116:119], a[4:7], v[176:179]
v_mfma_f32_16x16x32_bf16 v[152:155], a[116:119], a[0:3], v[152:155]
s_waitcnt vmcnt(10) lgkmcnt(1)
v_mfma_f32_16x16x32_bf16 v[132:135], a[128:131], a[16:19], v[132:135]
ds_read_b128 a[96:99], v5 offset:12288
v_mfma_f32_16x16x32_bf16 v[156:159], a[128:131], a[20:23], v[156:159]
buffer_load_dwordx4 a[0:3], v2, s[40:43], s35 offen offset:0 sc1
v_mfma_f32_16x16x32_bf16 v[180:183], a[128:131], a[24:27], v[180:183]
ds_read_b128 a[100:103], v5 offset:13312
v_mfma_f32_16x16x32_bf16 v[204:207], a[128:131], a[28:31], v[204:207]
v_mfma_f32_16x16x32_bf16 v[208:211], a[132:135], a[28:31], v[208:211]
v_mfma_f32_16x16x32_bf16 v[184:187], a[132:135], a[24:27], v[184:187]
buffer_load_dwordx4 a[4:7], v2, s[40:43], s35 offen offset:1024 sc1
v_mfma_f32_16x16x32_bf16 v[160:163], a[132:135], a[20:23], v[160:163]
ds_read_b128 a[104:107], v5 offset:14336
v_mfma_f32_16x16x32_bf16 v[136:139], a[132:135], a[16:19], v[136:139]
ds_read_b128 v[68:71], v233 offset:320
v_mfma_f32_16x16x32_bf16 v[140:143], a[136:139], a[16:19], v[140:143]
ds_read_b128 a[108:111], v5 offset:15360
v_mfma_f32_16x16x32_bf16 v[164:167], a[136:139], a[20:23], v[164:167]
v_mfma_f32_16x16x32_bf16 v[188:191], a[136:139], a[24:27], v[188:191]
buffer_load_dwordx4 v1, s[4:7], s44 offen offset:0 sc1 lds
v_mfma_f32_16x16x32_bf16 v[212:215], a[136:139], a[28:31], v[212:215]
ds_read_b128 a[112:115], v5 offset:16384
v_mfma_f32_16x16x32_bf16 v[216:219], a[140:143], a[28:31], v[216:219]
v_mfma_f32_16x16x32_bf16 v[192:195], a[140:143], a[24:27], v[192:195]
ds_read_b128 a[116:119], v5 offset:17408
v_mfma_f32_16x16x32_bf16 v[168:171], a[140:143], a[20:23], v[168:171]
v_mfma_f32_16x16x32_bf16 v[144:147], a[140:143], a[16:19], v[144:147]
buffer_load_dwordx4 a[8:11], v2, s[40:43], s35 offen offset:2048 sc1
v_mfma_f32_16x16x32_bf16 v[148:151], a[144:147], a[16:19], v[148:151]
v_mfma_f32_16x16x32_bf16 v[172:175], a[144:147], a[20:23], v[172:175]
v_mfma_f32_16x16x32_bf16 v[196:199], a[144:147], a[24:27], v[196:199]
v_mfma_f32_16x16x32_bf16 v[220:223], a[144:147], a[28:31], v[220:223]
v_mfma_f32_16x16x32_bf16 v[224:227], a[148:151], a[28:31], v[224:227]
buffer_load_dwordx4 a[12:15], v2, s[40:43], s35 offen offset:3072 sc1
s_add_u32 s35, s35, 4096
v_mfma_f32_16x16x32_bf16 v[200:203], a[148:151], a[24:27], v[200:203]
v_mfma_f32_16x16x32_bf16 v[176:179], a[148:151], a[20:23], v[176:179]
v_mfma_f32_16x16x32_bf16 v[152:155], a[148:151], a[16:19], v[152:155]
s_waitcnt vmcnt(10) lgkmcnt(0)
v_mfma_f32_16x16x32_bf16 v[132:135], a[96:99], a[32:35], v[132:135]
ds_read_b128 a[128:131], v5 offset:18432
v_mfma_f32_16x16x32_bf16 v[156:159], a[96:99], a[36:39], v[156:159]
buffer_load_dwordx4 a[16:19], v2, s[40:43], s35 offen offset:0 sc1
v_mfma_f32_16x16x32_bf16 v[180:183], a[96:99], a[40:43], v[180:183]
ds_read_b128 a[132:135], v5 offset:19456
v_mfma_f32_16x16x32_bf16 v[204:207], a[96:99], a[44:47], v[204:207]
v_mfma_f32_16x16x32_bf16 v[208:211], a[100:103], a[44:47], v[208:211]
v_mfma_f32_16x16x32_bf16 v[184:187], a[100:103], a[40:43], v[184:187]
buffer_load_dwordx4 a[20:23], v2, s[40:43], s35 offen offset:1024 sc1
v_mfma_f32_16x16x32_bf16 v[160:163], a[100:103], a[36:39], v[160:163]
ds_read_b128 a[136:139], v5 offset:20480
v_mfma_f32_16x16x32_bf16 v[136:139], a[100:103], a[32:35], v[136:139]
v_mfma_f32_16x16x32_bf16 v[140:143], a[104:107], a[32:35], v[140:143]
ds_read_b128 a[140:143], v5 offset:21504
v_mfma_f32_16x16x32_bf16 v[164:167], a[104:107], a[36:39], v[164:167]
v_mfma_f32_16x16x32_bf16 v[188:191], a[104:107], a[40:43], v[188:191]
buffer_load_dwordx4 v1, s[4:7], s44 offen offset:1024 sc1 lds
v_mfma_f32_16x16x32_bf16 v[212:215], a[104:107], a[44:47], v[212:215]
ds_read_b128 a[144:147], v5 offset:22528
v_mfma_f32_16x16x32_bf16 v[216:219], a[108:111], a[44:47], v[216:219]
v_mfma_f32_16x16x32_bf16 v[192:195], a[108:111], a[40:43], v[192:195]
ds_read_b128 a[148:151], v5 offset:23552
v_mfma_f32_16x16x32_bf16 v[168:171], a[108:111], a[36:39], v[168:171]
v_mfma_f32_16x16x32_bf16 v[144:147], a[108:111], a[32:35], v[144:147]
buffer_load_dwordx4 a[24:27], v2, s[40:43], s35 offen offset:2048 sc1
v_mfma_f32_16x16x32_bf16 v[148:151], a[112:115], a[32:35], v[148:151]
v_mfma_f32_16x16x32_bf16 v[172:175], a[112:115], a[36:39], v[172:175]
v_mfma_f32_16x16x32_bf16 v[196:199], a[112:115], a[40:43], v[196:199]
v_mfma_f32_16x16x32_bf16 v[220:223], a[112:115], a[44:47], v[220:223]
v_mfma_f32_16x16x32_bf16 v[224:227], a[116:119], a[44:47], v[224:227]
buffer_load_dwordx4 a[28:31], v2, s[40:43], s35 offen offset:3072 sc1
s_add_u32 s35, s35, 4096
v_mfma_f32_16x16x32_bf16 v[200:203], a[116:119], a[40:43], v[200:203]
v_mfma_f32_16x16x32_bf16 v[176:179], a[116:119], a[36:39], v[176:179]
v_mfma_f32_16x16x32_bf16 v[152:155], a[116:119], a[32:35], v[152:155]
s_waitcnt vmcnt(10) lgkmcnt(0)
s_barrier
v_mfma_f32_16x16x32_bf16 v[132:135], a[128:131], a[48:51], v[132:135]
ds_read_b128 a[96:99], v5 offset:24576
v_accvgpr_write_b32 a188, v48
v_mfma_f32_16x16x32_bf16 v[156:159], a[128:131], a[52:55], v[156:159]
buffer_load_dwordx4 a[32:35], v2, s[40:43], s35 offen offset:0 sc1
v_mfma_f32_16x16x32_bf16 v[180:183], a[128:131], a[56:59], v[180:183]
ds_read_b128 a[100:103], v5 offset:25600
v_mfma_f32_16x16x32_bf16 v[204:207], a[128:131], a[60:63], v[204:207]
v_accvgpr_write_b32 a189, v49
v_mfma_f32_16x16x32_bf16 v[208:211], a[132:135], a[60:63], v[208:211]
v_mfma_f32_16x16x32_bf16 v[184:187], a[132:135], a[56:59], v[184:187]
buffer_load_dwordx4 a[36:39], v2, s[40:43], s35 offen offset:1024 sc1
v_mfma_f32_16x16x32_bf16 v[160:163], a[132:135], a[52:55], v[160:163]
ds_read_b128 a[104:107], v5 offset:26624
v_accvgpr_write_b32 a190, v50
v_mfma_f32_16x16x32_bf16 v[136:139], a[132:135], a[48:51], v[136:139]
v_mfma_f32_16x16x32_bf16 v[140:143], a[136:139], a[48:51], v[140:143]
ds_read_b128 a[108:111], v5 offset:27648
v_mfma_f32_16x16x32_bf16 v[164:167], a[136:139], a[52:55], v[164:167]
v_accvgpr_write_b32 a191, v51
v_mfma_f32_16x16x32_bf16 v[188:191], a[136:139], a[56:59], v[188:191]
buffer_load_dwordx4 v1, s[4:7], s44 offen offset:2048 sc1 lds
s_add_u32 m0, s18, 0x6000
v_mfma_f32_16x16x32_bf16 v[212:215], a[136:139], a[60:63], v[212:215]
s_add_u32 s44, s50, 0x142a000
ds_read_b128 a[112:115], v5 offset:28672
v_mfma_f32_16x16x32_bf16 v[216:219], a[140:143], a[60:63], v[216:219]
v_accvgpr_write_b32 a192, v52
v_mfma_f32_16x16x32_bf16 v[192:195], a[140:143], a[56:59], v[192:195]
ds_read_b128 a[116:119], v5 offset:29696
v_mfma_f32_16x16x32_bf16 v[168:171], a[140:143], a[52:55], v[168:171]
v_mfma_f32_16x16x32_bf16 v[144:147], a[140:143], a[48:51], v[144:147]
buffer_load_dwordx4 a[40:43], v2, s[40:43], s35 offen offset:2048 sc1
v_mfma_f32_16x16x32_bf16 v[148:151], a[144:147], a[48:51], v[148:151]
v_accvgpr_write_b32 a193, v53
v_mfma_f32_16x16x32_bf16 v[172:175], a[144:147], a[52:55], v[172:175]
v_mfma_f32_16x16x32_bf16 v[196:199], a[144:147], a[56:59], v[196:199]
v_accvgpr_write_b32 a194, v54
v_mfma_f32_16x16x32_bf16 v[220:223], a[144:147], a[60:63], v[220:223]
v_mfma_f32_16x16x32_bf16 v[224:227], a[148:151], a[60:63], v[224:227]
buffer_load_dwordx4 a[44:47], v2, s[40:43], s35 offen offset:3072 sc1
s_add_u32 s35, s35, 4096
v_mfma_f32_16x16x32_bf16 v[200:203], a[148:151], a[56:59], v[200:203]
v_accvgpr_write_b32 a195, v55
v_mfma_f32_16x16x32_bf16 v[176:179], a[148:151], a[52:55], v[176:179]
v_mfma_f32_16x16x32_bf16 v[152:155], a[148:151], a[48:51], v[152:155]
s_waitcnt vmcnt(10) lgkmcnt(0)
v_mfma_f32_16x16x32_bf16 v[132:135], a[96:99], a[0:3], v[132:135]
ds_read_b128 a[128:131], v5 offset:30720
v_accvgpr_write_b32 a196, v56
v_mfma_f32_16x16x32_bf16 v[156:159], a[96:99], a[4:7], v[156:159]
buffer_load_dwordx4 a[48:51], v2, s[40:43], s35 offen offset:0 sc1
v_mfma_f32_16x16x32_bf16 v[180:183], a[96:99], a[8:11], v[180:183]
ds_read_b128 a[132:135], v5 offset:31744
v_mfma_f32_16x16x32_bf16 v[204:207], a[96:99], a[12:15], v[204:207]
v_accvgpr_write_b32 a197, v57
v_mfma_f32_16x16x32_bf16 v[208:211], a[100:103], a[12:15], v[208:211]
v_mfma_f32_16x16x32_bf16 v[184:187], a[100:103], a[8:11], v[184:187]
buffer_load_dwordx4 a[52:55], v2, s[40:43], s35 offen offset:1024 sc1
v_mfma_f32_16x16x32_bf16 v[160:163], a[100:103], a[4:7], v[160:163]
ds_read_b128 a[136:139], v5 offset:32768
v_accvgpr_write_b32 a198, v58
v_mfma_f32_16x16x32_bf16 v[136:139], a[100:103], a[0:3], v[136:139]
v_mfma_f32_16x16x32_bf16 v[140:143], a[104:107], a[0:3], v[140:143]
ds_read_b128 a[140:143], v5 offset:33792
v_mfma_f32_16x16x32_bf16 v[164:167], a[104:107], a[4:7], v[164:167]
v_accvgpr_write_b32 a199, v59
v_mfma_f32_16x16x32_bf16 v[188:191], a[104:107], a[8:11], v[188:191]
buffer_load_dwordx4 v1, s[4:7], s44 offen offset:0 sc1 lds
v_mfma_f32_16x16x32_bf16 v[212:215], a[104:107], a[12:15], v[212:215]
ds_read_b128 a[144:147], v5 offset:34816
v_mfma_f32_16x16x32_bf16 v[216:219], a[108:111], a[12:15], v[216:219]
v_accvgpr_write_b32 a200, v60
v_mfma_f32_16x16x32_bf16 v[192:195], a[108:111], a[8:11], v[192:195]
ds_read_b128 a[148:151], v5 offset:35840
v_mfma_f32_16x16x32_bf16 v[168:171], a[108:111], a[4:7], v[168:171]
v_mfma_f32_16x16x32_bf16 v[144:147], a[108:111], a[0:3], v[144:147]
buffer_load_dwordx4 a[56:59], v2, s[40:43], s35 offen offset:2048 sc1
v_mfma_f32_16x16x32_bf16 v[148:151], a[112:115], a[0:3], v[148:151]
v_accvgpr_write_b32 a201, v61
v_mfma_f32_16x16x32_bf16 v[172:175], a[112:115], a[4:7], v[172:175]
v_mfma_f32_16x16x32_bf16 v[196:199], a[112:115], a[8:11], v[196:199]
v_accvgpr_write_b32 a202, v62
v_mfma_f32_16x16x32_bf16 v[220:223], a[112:115], a[12:15], v[220:223]
v_mfma_f32_16x16x32_bf16 v[224:227], a[116:119], a[12:15], v[224:227]
buffer_load_dwordx4 a[60:63], v2, s[40:43], s35 offen offset:3072 sc1
s_add_u32 s35, s35, 4096
v_mfma_f32_16x16x32_bf16 v[200:203], a[116:119], a[8:11], v[200:203]
v_accvgpr_write_b32 a203, v63
v_mfma_f32_16x16x32_bf16 v[176:179], a[116:119], a[4:7], v[176:179]
v_mfma_f32_16x16x32_bf16 v[152:155], a[116:119], a[0:3], v[152:155]
s_waitcnt vmcnt(10) lgkmcnt(0)
v_mfma_f32_16x16x32_bf16 v[132:135], a[128:131], a[16:19], v[132:135]
ds_read_b128 a[96:99], v5 offset:36864
v_accvgpr_write_b32 a204, v64
v_mfma_f32_16x16x32_bf16 v[156:159], a[128:131], a[20:23], v[156:159]
buffer_load_dwordx4 a[0:3], v2, s[40:43], s35 offen offset:0 sc1
v_mfma_f32_16x16x32_bf16 v[180:183], a[128:131], a[24:27], v[180:183]
ds_read_b128 a[100:103], v5 offset:37888
v_mfma_f32_16x16x32_bf16 v[204:207], a[128:131], a[28:31], v[204:207]
v_accvgpr_write_b32 a205, v65
v_mfma_f32_16x16x32_bf16 v[208:211], a[132:135], a[28:31], v[208:211]
v_mfma_f32_16x16x32_bf16 v[184:187], a[132:135], a[24:27], v[184:187]
buffer_load_dwordx4 v1, s[4:7], s44 offen offset:1024 sc1 lds
v_mfma_f32_16x16x32_bf16 v[160:163], a[132:135], a[20:23], v[160:163]
ds_read_b128 a[104:107], v5 offset:38912
v_accvgpr_write_b32 a206, v66
v_mfma_f32_16x16x32_bf16 v[136:139], a[132:135], a[16:19], v[136:139]
v_mfma_f32_16x16x32_bf16 v[140:143], a[136:139], a[16:19], v[140:143]
ds_read_b128 a[108:111], v5 offset:39936
v_mfma_f32_16x16x32_bf16 v[164:167], a[136:139], a[20:23], v[164:167]
buffer_load_dwordx4 a[4:7], v2, s[40:43], s35 offen offset:1024 sc1
v_mfma_f32_16x16x32_bf16 v[188:191], a[136:139], a[24:27], v[188:191]
ds_read_b128 a[112:115], v5 offset:40960
v_accvgpr_write_b32 a207, v67
v_mfma_f32_16x16x32_bf16 v[212:215], a[136:139], a[28:31], v[212:215]
v_mfma_f32_16x16x32_bf16 v[216:219], a[140:143], a[28:31], v[216:219]
v_accvgpr_write_b32 a208, v68
v_mfma_f32_16x16x32_bf16 v[192:195], a[140:143], a[24:27], v[192:195]
buffer_load_dwordx4 a[8:11], v2, s[40:43], s35 offen offset:2048 sc1
v_mfma_f32_16x16x32_bf16 v[168:171], a[140:143], a[20:23], v[168:171]
ds_read_b128 a[116:119], v5 offset:41984
v_mfma_f32_16x16x32_bf16 v[144:147], a[140:143], a[16:19], v[144:147]
v_accvgpr_write_b32 a209, v69
v_mfma_f32_16x16x32_bf16 v[148:151], a[144:147], a[16:19], v[148:151]
v_mfma_f32_16x16x32_bf16 v[172:175], a[144:147], a[20:23], v[172:175]
buffer_load_dwordx4 v1, s[4:7], s44 offen offset:2048 sc1 lds
s_add_u32 m0, s18, 0x9000
v_mfma_f32_16x16x32_bf16 v[196:199], a[144:147], a[24:27], v[196:199]
s_add_u32 s44, s50, 0x142d000
v_accvgpr_write_b32 a210, v70
v_mfma_f32_16x16x32_bf16 v[220:223], a[144:147], a[28:31], v[220:223]
v_mfma_f32_16x16x32_bf16 v[224:227], a[148:151], a[28:31], v[224:227]
v_mfma_f32_16x16x32_bf16 v[200:203], a[148:151], a[24:27], v[200:203]
buffer_load_dwordx4 a[12:15], v2, s[40:43], s35 offen offset:3072 sc1
s_add_u32 s35, s35, 4096
v_mfma_f32_16x16x32_bf16 v[176:179], a[148:151], a[20:23], v[176:179]
v_accvgpr_write_b32 a211, v71
v_mfma_f32_16x16x32_bf16 v[152:155], a[148:151], a[16:19], v[152:155]
s_waitcnt vmcnt(11) lgkmcnt(0)
v_mfma_f32_16x16x32_bf16 v[132:135], a[96:99], a[32:35], v[132:135]
ds_read_b128 a[128:131], v5 offset:43008
v_add_f32 v92, v92, v96
v_mfma_f32_16x16x32_bf16 v[156:159], a[96:99], a[36:39], v[156:159]
buffer_load_dwordx4 a[16:19], v2, s[40:43], s35 offen offset:0 sc1
v_mfma_f32_16x16x32_bf16 v[180:183], a[96:99], a[40:43], v[180:183]
ds_read_b128 a[132:135], v5 offset:44032
v_add_f32 v100, v100, v104
v_mfma_f32_16x16x32_bf16 v[204:207], a[96:99], a[44:47], v[204:207]
v_add_f32 v108, v108, v112
v_add_f32 v116, v116, v120
v_mfma_f32_16x16x32_bf16 v[208:211], a[100:103], a[44:47], v[208:211]
v_add_f32 v93, v93, v97
v_add_f32 v101, v101, v105
v_mfma_f32_16x16x32_bf16 v[184:187], a[100:103], a[40:43], v[184:187]
buffer_load_dwordx4 a[20:23], v2, s[40:43], s35 offen offset:1024 sc1
v_mfma_f32_16x16x32_bf16 v[160:163], a[100:103], a[36:39], v[160:163]
ds_read_b128 a[136:139], v5 offset:45056
v_add_f32 v109, v109, v113
v_mfma_f32_16x16x32_bf16 v[136:139], a[100:103], a[32:35], v[136:139]
v_add_f32 v117, v117, v121
L_stub6:
s_cbranch_execz L_stub7
v_add_f32 v94, v94, v98
v_mfma_f32_16x16x32_bf16 v[140:143], a[104:107], a[32:35], v[140:143]
ds_read_b128 a[140:143], v5 offset:46080
v_add_f32 v102, v102, v106
v_mfma_f32_16x16x32_bf16 v[164:167], a[104:107], a[36:39], v[164:167]
v_add_f32 v110, v110, v114
v_mfma_f32_16x16x32_bf16 v[188:191], a[104:107], a[40:43], v[188:191]
buffer_load_dwordx4 v1, s[4:7], s44 offen offset:0 sc1 lds
v_mfma_f32_16x16x32_bf16 v[212:215], a[104:107], a[44:47], v[212:215]
ds_read_b128 a[144:147], v5 offset:47104
v_add_f32 v118, v118, v122
v_mfma_f32_16x16x32_bf16 v[216:219], a[108:111], a[44:47], v[216:219]
v_add_f32 v95, v95, v99
v_add_f32 v103, v103, v107
v_mfma_f32_16x16x32_bf16 v[192:195], a[108:111], a[40:43], v[192:195]
ds_read_b128 a[148:151], v5 offset:48128
v_add_f32 v111, v111, v115
v_mfma_f32_16x16x32_bf16 v[168:171], a[108:111], a[36:39], v[168:171]
v_add_f32 v119, v119, v123
v_mfma_f32_16x16x32_bf16 v[144:147], a[108:111], a[32:35], v[144:147]
buffer_load_dwordx4 a[24:27], v2, s[40:43], s35 offen offset:2048 sc1
v_mfma_f32_16x16x32_bf16 v[148:151], a[112:115], a[32:35], v[148:151]
v_add_f32_dpp v92, v92, v92 row_ror:8 row_mask:0xf bank_mask:0xf
v_add_f32_dpp v100, v100, v100 row_ror:8 row_mask:0xf bank_mask:0xf
v_mfma_f32_16x16x32_bf16 v[172:175], a[112:115], a[36:39], v[172:175]
v_add_f32_dpp v108, v108, v108 row_ror:8 row_mask:0xf bank_mask:0xf
v_mfma_f32_16x16x32_bf16 v[196:199], a[112:115], a[40:43], v[196:199]
v_add_f32_dpp v116, v116, v116 row_ror:8 row_mask:0xf bank_mask:0xf
v_mfma_f32_16x16x32_bf16 v[220:223], a[112:115], a[44:47], v[220:223]
v_add_f32_dpp v93, v93, v93 row_ror:8 row_mask:0xf bank_mask:0xf
v_mfma_f32_16x16x32_bf16 v[224:227], a[116:119], a[44:47], v[224:227]
buffer_load_dwordx4 a[28:31], v2, s[40:43], s35 offen offset:3072 sc1
s_add_u32 s35, s35, 4096
v_mfma_f32_16x16x32_bf16 v[200:203], a[116:119], a[40:43], v[200:203]
v_add_f32_dpp v101, v101, v101 row_ror:8 row_mask:0xf bank_mask:0xf
v_add_f32_dpp v109, v109, v109 row_ror:8 row_mask:0xf bank_mask:0xf
v_mfma_f32_16x16x32_bf16 v[176:179], a[116:119], a[36:39], v[176:179]
v_add_f32_dpp v117, v117, v117 row_ror:8 row_mask:0xf bank_mask:0xf
v_mfma_f32_16x16x32_bf16 v[152:155], a[116:119], a[32:35], v[152:155]
s_waitcnt vmcnt(11) lgkmcnt(0)
s_barrier
v_mfma_f32_16x16x32_bf16 v[132:135], a[128:131], a[48:51], v[132:135]
v_add_u32 v5, 0, v1
v_add_f32_dpp v92, v94, v94 row_ror:8 row_mask:0xf bank_mask:0xc
v_mfma_f32_16x16x32_bf16 v[156:159], a[128:131], a[52:55], v[156:159]
buffer_load_dwordx4 a[32:35], v2, s[40:43], s35 offen offset:0 sc1
v_mfma_f32_16x16x32_bf16 v[180:183], a[128:131], a[56:59], v[180:183]
ds_read_b128 a[96:99], v5 offset:0
v_add_f32_dpp v100, v102, v102 row_ror:8 row_mask:0xf bank_mask:0xc
v_mfma_f32_16x16x32_bf16 v[204:207], a[128:131], a[60:63], v[204:207]
ds_read_b128 a[100:103], v5 offset:1024
v_add_f32_dpp v108, v110, v110 row_ror:8 row_mask:0xf bank_mask:0xc
v_mfma_f32_16x16x32_bf16 v[208:211], a[132:135], a[60:63], v[208:211]
v_add_f32_dpp v116, v118, v118 row_ror:8 row_mask:0xf bank_mask:0xc
v_add_f32_dpp v93, v95, v95 row_ror:8 row_mask:0xf bank_mask:0xc
v_mfma_f32_16x16x32_bf16 v[184:187], a[132:135], a[56:59], v[184:187]
buffer_load_dwordx4 a[36:39], v2, s[40:43], s35 offen offset:1024 sc1
v_mfma_f32_16x16x32_bf16 v[160:163], a[132:135], a[52:55], v[160:163]
ds_read_b128 a[104:107], v5 offset:2048
v_add_f32_dpp v101, v103, v103 row_ror:8 row_mask:0xf bank_mask:0xc
v_mfma_f32_16x16x32_bf16 v[136:139], a[132:135], a[48:51], v[136:139]
v_add_f32_dpp v109, v111, v111 row_ror:8 row_mask:0xf bank_mask:0xc
v_add_f32_dpp v117, v119, v119 row_ror:8 row_mask:0xf bank_mask:0xc
v_mfma_f32_16x16x32_bf16 v[140:143], a[136:139], a[48:51], v[140:143]
ds_read_b128 a[108:111], v5 offset:3072
v_mfma_f32_16x16x32_bf16 v[164:167], a[136:139], a[52:55], v[164:167]
v_permlane32_swap_b32 v92, v93
v_mfma_f32_16x16x32_bf16 v[188:191], a[136:139], a[56:59], v[188:191]
buffer_load_dwordx4 v1, s[4:7], s44 offen offset:1024 sc1 lds
v_mfma_f32_16x16x32_bf16 v[212:215], a[136:139], a[60:63], v[212:215]
ds_read_b128 a[112:115], v5 offset:4096
v_mfma_f32_16x16x32_bf16 v[216:219], a[140:143], a[60:63], v[216:219]
v_permlane32_swap_b32 v100, v101
v_mfma_f32_16x16x32_bf16 v[192:195], a[140:143], a[56:59], v[192:195]
ds_read_b128 a[116:119], v5 offset:5120
v_mfma_f32_16x16x32_bf16 v[168:171], a[140:143], a[52:55], v[168:171]
v_permlane32_swap_b32 v108, v109
v_mfma_f32_16x16x32_bf16 v[144:147], a[140:143], a[48:51], v[144:147]
buffer_load_dwordx4 a[40:43], v2, s[40:43], s35 offen offset:2048 sc1
v_mfma_f32_16x16x32_bf16 v[148:151], a[144:147], a[48:51], v[148:151]
v_permlane32_swap_b32 v116, v117
v_mfma_f32_16x16x32_bf16 v[172:175], a[144:147], a[52:55], v[172:175]
v_add_f32 v92, v92, v93
v_add_f32 v100, v100, v101
v_mfma_f32_16x16x32_bf16 v[196:199], a[144:147], a[56:59], v[196:199]
v_add_f32 v108, v108, v109
v_add_f32 v116, v116, v117
v_mfma_f32_16x16x32_bf16 v[220:223], a[144:147], a[60:63], v[220:223]
v_mov_b32 v94, v92
v_mov_b32 v102, v100
v_mfma_f32_16x16x32_bf16 v[224:227], a[148:151], a[60:63], v[224:227]
buffer_load_dwordx4 a[44:47], v2, s[40:43], s35 offen offset:3072 sc1
s_add_u32 s35, s35, 4096
v_mfma_f32_16x16x32_bf16 v[200:203], a[148:151], a[56:59], v[200:203]
v_mov_b32 v110, v108
v_mov_b32 v118, v116
v_mfma_f32_16x16x32_bf16 v[176:179], a[148:151], a[52:55], v[176:179]
v_permlane16_swap_b32 v92, v94
v_mfma_f32_16x16x32_bf16 v[152:155], a[148:151], a[48:51], v[152:155]
s_waitcnt vmcnt(10) lgkmcnt(0)
v_mfma_f32_16x16x32_bf16 v[132:135], a[96:99], a[0:3], v[132:135]
ds_read_b128 a[128:131], v5 offset:6144
v_mfma_f32_16x16x32_bf16 v[156:159], a[96:99], a[4:7], v[156:159]
buffer_load_dwordx4 a[48:51], v2, s[40:43], s35 offen offset:0 sc1
v_mfma_f32_16x16x32_bf16 v[180:183], a[96:99], a[8:11], v[180:183]
ds_read_b128 a[132:135], v5 offset:7168
v_mfma_f32_16x16x32_bf16 v[204:207], a[96:99], a[12:15], v[204:207]
v_permlane16_swap_b32 v100, v102
v_mfma_f32_16x16x32_bf16 v[208:211], a[100:103], a[12:15], v[208:211]
v_permlane16_swap_b32 v108, v110
v_mfma_f32_16x16x32_bf16 v[184:187], a[100:103], a[8:11], v[184:187]
buffer_load_dwordx4 a[52:55], v2, s[40:43], s35 offen offset:1024 sc1
v_mfma_f32_16x16x32_bf16 v[160:163], a[100:103], a[4:7], v[160:163]
ds_read_b128 a[136:139], v5 offset:8192
v_mfma_f32_16x16x32_bf16 v[136:139], a[100:103], a[0:3], v[136:139]
v_permlane16_swap_b32 v116, v118
v_mfma_f32_16x16x32_bf16 v[140:143], a[104:107], a[0:3], v[140:143]
ds_read_b128 a[140:143], v5 offset:9216
v_add_f32 v92, v92, v94
v_mfma_f32_16x16x32_bf16 v[164:167], a[104:107], a[4:7], v[164:167]
v_add_f32 v100, v100, v102
v_add_f32 v108, v108, v110
v_mfma_f32_16x16x32_bf16 v[188:191], a[104:107], a[8:11], v[188:191]
buffer_load_dwordx4 v1, s[4:7], s44 offen offset:2048 sc1 lds
s_add_u32 m0, s19, 49152
v_mfma_f32_16x16x32_bf16 v[212:215], a[104:107], a[12:15], v[212:215]
s_add_u32 s44, s85, 0xc04000
ds_read_b128 a[144:147], v5 offset:10240
v_mfma_f32_16x16x32_bf16 v[216:219], a[108:111], a[12:15], v[216:219]
v_add_f32 v116, v116, v118
v_mov_b32 v94, v92
v_mfma_f32_16x16x32_bf16 v[192:195], a[108:111], a[8:11], v[192:195]
ds_read_b128 a[148:151], v5 offset:11264
v_mov_b32 v102, v100
v_mfma_f32_16x16x32_bf16 v[168:171], a[108:111], a[4:7], v[168:171]
v_mov_b32 v110, v108
v_mov_b32 v118, v116
v_mfma_f32_16x16x32_bf16 v[144:147], a[108:111], a[0:3], v[144:147]
buffer_load_dwordx4 a[56:59], v2, s[40:43], s35 offen offset:2048 sc1
v_mfma_f32_16x16x32_bf16 v[148:151], a[112:115], a[0:3], v[148:151]
v_permlane32_swap_b32 v92, v94
v_mfma_f32_16x16x32_bf16 v[172:175], a[112:115], a[4:7], v[172:175]
v_permlane32_swap_b32 v100, v102
v_mfma_f32_16x16x32_bf16 v[196:199], a[112:115], a[8:11], v[196:199]
v_permlane32_swap_b32 v108, v110
v_mfma_f32_16x16x32_bf16 v[220:223], a[112:115], a[12:15], v[220:223]
v_permlane32_swap_b32 v116, v118
v_mfma_f32_16x16x32_bf16 v[224:227], a[116:119], a[12:15], v[224:227]
buffer_load_dwordx4 a[60:63], v2, s[40:43], s35 offen offset:3072 sc1
s_add_u32 s35, s35, 4096
v_mfma_f32_16x16x32_bf16 v[200:203], a[116:119], a[8:11], v[200:203]
v_mul_f32 v82, 0xba800000, v92
v_mfma_f32_16x16x32_bf16 v[176:179], a[116:119], a[4:7], v[176:179]
v_mul_f32 v84, 0xba800000, v100
v_mfma_f32_16x16x32_bf16 v[152:155], a[116:119], a[0:3], v[152:155]
v_mul_f32 v86, 0xba800000, v108
s_waitcnt vmcnt(10) lgkmcnt(0)
v_mfma_f32_16x16x32_bf16 v[132:135], a[128:131], a[16:19], v[132:135]
ds_read_b128 a[96:99], v5 offset:12288
v_mul_f32 v88, 0xba800000, v116
v_mfma_f32_16x16x32_bf16 v[156:159], a[128:131], a[20:23], v[156:159]
buffer_load_dwordx4 a[0:3], v2, s[40:43], s35 offen offset:0 sc1
v_mfma_f32_16x16x32_bf16 v[180:183], a[128:131], a[24:27], v[180:183]
ds_read_b128 a[100:103], v5 offset:13312
v_mul_f32 v94, 0x3a800000, v94
v_mfma_f32_16x16x32_bf16 v[204:207], a[128:131], a[28:31], v[204:207]
v_mul_f32 v102, 0x3a800000, v102
v_mul_f32 v110, 0x3a800000, v110
v_mfma_f32_16x16x32_bf16 v[208:211], a[132:135], a[28:31], v[208:211]
v_mul_f32 v118, 0x3a800000, v118
v_fma_f32 v94, -v82, v82, v94
v_mfma_f32_16x16x32_bf16 v[184:187], a[132:135], a[24:27], v[184:187]
buffer_load_dwordx4 a[4:7], v2, s[40:43], s35 offen offset:1024 sc1
v_mfma_f32_16x16x32_bf16 v[160:163], a[132:135], a[20:23], v[160:163]
ds_read_b128 a[104:107], v5 offset:14336
v_fma_f32 v102, -v84, v84, v102
v_mfma_f32_16x16x32_bf16 v[136:139], a[132:135], a[16:19], v[136:139]
v_fma_f32 v110, -v86, v86, v110
v_fma_f32 v118, -v88, v88, v118
v_mfma_f32_16x16x32_bf16 v[140:143], a[136:139], a[16:19], v[140:143]
ds_read_b128 a[108:111], v5 offset:15360
v_max_f32 v94, 0, v94
v_mfma_f32_16x16x32_bf16 v[164:167], a[136:139], a[20:23], v[164:167]
v_max_f32 v102, 0, v102
v_mfma_f32_16x16x32_bf16 v[188:191], a[136:139], a[24:27], v[188:191]
buffer_load_dwordx4 v1, s[4:7], s44 offen offset:0 sc1 lds
v_mfma_f32_16x16x32_bf16 v[212:215], a[136:139], a[28:31], v[212:215]
ds_read_b128 a[112:115], v5 offset:16384
v_max_f32 v110, 0, v110
v_mfma_f32_16x16x32_bf16 v[216:219], a[140:143], a[28:31], v[216:219]
v_max_f32 v118, 0, v118
v_add_f32 v94, 0x3727c5ac, v94
v_mfma_f32_16x16x32_bf16 v[192:195], a[140:143], a[24:27], v[192:195]
ds_read_b128 a[116:119], v5 offset:17408
v_add_f32 v102, 0x3727c5ac, v102
v_mfma_f32_16x16x32_bf16 v[168:171], a[140:143], a[20:23], v[168:171]
v_add_f32 v110, 0x3727c5ac, v110
v_mfma_f32_16x16x32_bf16 v[144:147], a[140:143], a[16:19], v[144:147]
buffer_load_dwordx4 a[8:11], v2, s[40:43], s35 offen offset:2048 sc1
v_mfma_f32_16x16x32_bf16 v[148:151], a[144:147], a[16:19], v[148:151]
v_add_f32 v118, 0x3727c5ac, v118
v_mfma_f32_16x16x32_bf16 v[172:175], a[144:147], a[20:23], v[172:175]
v_rsq_f32 v83, v94
v_mfma_f32_16x16x32_bf16 v[196:199], a[144:147], a[24:27], v[196:199]
v_rsq_f32 v85, v102
v_mfma_f32_16x16x32_bf16 v[220:223], a[144:147], a[28:31], v[220:223]
v_mfma_f32_16x16x32_bf16 v[224:227], a[148:151], a[28:31], v[224:227]
buffer_load_dwordx4 a[12:15], v2, s[40:43], s35 offen offset:3072 sc1
s_add_u32 s35, s35, 4096
v_mfma_f32_16x16x32_bf16 v[200:203], a[148:151], a[24:27], v[200:203]
v_rsq_f32 v87, v110
v_mfma_f32_16x16x32_bf16 v[176:179], a[148:151], a[20:23], v[176:179]
v_rsq_f32 v89, v118
v_mfma_f32_16x16x32_bf16 v[152:155], a[148:151], a[16:19], v[152:155]
s_waitcnt vmcnt(10) lgkmcnt(0)
v_mfma_f32_16x16x32_bf16 v[132:135], a[96:99], a[32:35], v[132:135]
ds_read_b128 a[128:131], v5 offset:18432
v_mfma_f32_16x16x32_bf16 v[156:159], a[96:99], a[36:39], v[156:159]
buffer_load_dwordx4 a[16:19], v2, s[40:43], s35 offen offset:0 sc1
v_mfma_f32_16x16x32_bf16 v[180:183], a[96:99], a[40:43], v[180:183]
ds_read_b128 a[132:135], v5 offset:19456
v_mfma_f32_16x16x32_bf16 v[204:207], a[96:99], a[44:47], v[204:207]
v_mfma_f32_16x16x32_bf16 v[208:211], a[100:103], a[44:47], v[208:211]
v_mfma_f32_16x16x32_bf16 v[184:187], a[100:103], a[40:43], v[184:187]
buffer_load_dwordx4 a[20:23], v2, s[40:43], s35 offen offset:1024 sc1
v_mfma_f32_16x16x32_bf16 v[160:163], a[100:103], a[36:39], v[160:163]
ds_read_b128 a[136:139], v5 offset:20480
v_mfma_f32_16x16x32_bf16 v[136:139], a[100:103], a[32:35], v[136:139]
v_mfma_f32_16x16x32_bf16 v[140:143], a[104:107], a[32:35], v[140:143]
ds_read_b128 a[140:143], v5 offset:21504
v_mfma_f32_16x16x32_bf16 v[164:167], a[104:107], a[36:39], v[164:167]
v_fmac_f32 v132, v48, v82
v_mfma_f32_16x16x32_bf16 v[188:191], a[104:107], a[40:43], v[188:191]
buffer_load_dwordx4 v1, s[4:7], s44 offen offset:1024 sc1 lds
v_mfma_f32_16x16x32_bf16 v[212:215], a[104:107], a[44:47], v[212:215]
ds_read_b128 a[144:147], v5 offset:22528
v_fmac_f32 v156, v48, v84
v_mfma_f32_16x16x32_bf16 v[216:219], a[108:111], a[44:47], v[216:219]
v_fmac_f32 v180, v48, v86
v_fmac_f32 v204, v48, v88
v_mfma_f32_16x16x32_bf16 v[192:195], a[108:111], a[40:43], v[192:195]
ds_read_b128 a[148:151], v5 offset:23552
v_fmac_f32 v208, v52, v88
v_mfma_f32_16x16x32_bf16 v[168:171], a[108:111], a[36:39], v[168:171]
v_fmac_f32 v184, v52, v86
v_mfma_f32_16x16x32_bf16 v[144:147], a[108:111], a[32:35], v[144:147]
buffer_load_dwordx4 a[24:27], v2, s[40:43], s35 offen offset:2048 sc1
v_mfma_f32_16x16x32_bf16 v[148:151], a[112:115], a[32:35], v[148:151]
v_fmac_f32 v160, v52, v84
v_fmac_f32 v136, v52, v82
v_mfma_f32_16x16x32_bf16 v[172:175], a[112:115], a[36:39], v[172:175]
v_fmac_f32 v140, v56, v82
v_mfma_f32_16x16x32_bf16 v[196:199], a[112:115], a[40:43], v[196:199]
v_fmac_f32 v164, v56, v84
v_mfma_f32_16x16x32_bf16 v[220:223], a[112:115], a[44:47], v[220:223]
v_fmac_f32 v188, v56, v86
v_mfma_f32_16x16x32_bf16 v[224:227], a[116:119], a[44:47], v[224:227]
buffer_load_dwordx4 a[28:31], v2, s[40:43], s35 offen offset:3072 sc1
s_add_u32 s35, s35, 4096
v_mfma_f32_16x16x32_bf16 v[200:203], a[116:119], a[40:43], v[200:203]
v_fmac_f32 v212, v56, v88
v_fmac_f32 v216, v60, v88
v_mfma_f32_16x16x32_bf16 v[176:179], a[116:119], a[36:39], v[176:179]
v_fmac_f32 v192, v60, v86
v_mfma_f32_16x16x32_bf16 v[152:155], a[116:119], a[32:35], v[152:155]
s_waitcnt vmcnt(10) lgkmcnt(0)
s_barrier
v_mfma_f32_16x16x32_bf16 v[132:135], a[128:131], a[48:51], v[132:135]
ds_read_b128 a[96:99], v5 offset:24576
v_fmac_f32 v168, v60, v84
v_mfma_f32_16x16x32_bf16 v[156:159], a[128:131], a[52:55], v[156:159]
buffer_load_dwordx4 a[32:35], v2, s[40:43], s35 offen offset:0 sc1
v_mfma_f32_16x16x32_bf16 v[180:183], a[128:131], a[56:59], v[180:183]
ds_read_b128 a[100:103], v5 offset:25600
v_fmac_f32 v144, v60, v82
v_mfma_f32_16x16x32_bf16 v[204:207], a[128:131], a[60:63], v[204:207]
v_fmac_f32 v148, v64, v82
v_fmac_f32 v172, v64, v84
v_mfma_f32_16x16x32_bf16 v[208:211], a[132:135], a[60:63], v[208:211]
v_fmac_f32 v196, v64, v86
v_fmac_f32 v220, v64, v88
v_mfma_f32_16x16x32_bf16 v[184:187], a[132:135], a[56:59], v[184:187]
buffer_load_dwordx4 a[36:39], v2, s[40:43], s35 offen offset:1024 sc1
v_mfma_f32_16x16x32_bf16 v[160:163], a[132:135], a[52:55], v[160:163]
ds_read_b128 a[104:107], v5 offset:26624
v_fmac_f32 v224, v68, v88
v_mfma_f32_16x16x32_bf16 v[136:139], a[132:135], a[48:51], v[136:139]
v_fmac_f32 v200, v68, v86
v_fmac_f32 v176, v68, v84
v_mfma_f32_16x16x32_bf16 v[140:143], a[136:139], a[48:51], v[140:143]
ds_read_b128 a[108:111], v5 offset:27648
v_fmac_f32 v152, v68, v82
v_mfma_f32_16x16x32_bf16 v[164:167], a[136:139], a[52:55], v[164:167]
v_fmac_f32 v133, v49, v82
v_mfma_f32_16x16x32_bf16 v[188:191], a[136:139], a[56:59], v[188:191]
buffer_load_dwordx4 v1, s[4:7], s44 offen offset:2048 sc1 lds
v_mfma_f32_16x16x32_bf16 v[212:215], a[136:139], a[60:63], v[212:215]
ds_read_b128 a[112:115], v5 offset:28672
v_fmac_f32 v157, v49, v84
v_mfma_f32_16x16x32_bf16 v[216:219], a[140:143], a[60:63], v[216:219]
v_fmac_f32 v181, v49, v86
v_fmac_f32 v205, v49, v88
v_mfma_f32_16x16x32_bf16 v[192:195], a[140:143], a[56:59], v[192:195]
ds_read_b128 a[116:119], v5 offset:29696
v_fmac_f32 v209, v53, v88
v_mfma_f32_16x16x32_bf16 v[168:171], a[140:143], a[52:55], v[168:171]
v_fmac_f32 v185, v53, v86
v_mfma_f32_16x16x32_bf16 v[144:147], a[140:143], a[48:51], v[144:147]
buffer_load_dwordx4 a[40:43], v2, s[40:43], s35 offen offset:2048 sc1
v_mfma_f32_16x16x32_bf16 v[148:151], a[144:147], a[48:51], v[148:151]
v_fmac_f32 v161, v53, v84
v_fmac_f32 v137, v53, v82
v_mfma_f32_16x16x32_bf16 v[172:175], a[144:147], a[52:55], v[172:175]
v_fmac_f32 v141, v57, v82
v_mfma_f32_16x16x32_bf16 v[196:199], a[144:147], a[56:59], v[196:199]
v_fmac_f32 v165, v57, v84
v_mfma_f32_16x16x32_bf16 v[220:223], a[144:147], a[60:63], v[220:223]
v_fmac_f32 v189, v57, v86
v_mfma_f32_16x16x32_bf16 v[224:227], a[148:151], a[60:63], v[224:227]
buffer_load_dwordx4 a[44:47], v2, s[40:43], s35 offen offset:3072 sc1
s_add_u32 s35, s35, 4096
v_mfma_f32_16x16x32_bf16 v[200:203], a[148:151], a[56:59], v[200:203]
v_fmac_f32 v213, v57, v88
v_fmac_f32 v217, v61, v88
v_mfma_f32_16x16x32_bf16 v[176:179], a[148:151], a[52:55], v[176:179]
v_fmac_f32 v193, v61, v86
v_mfma_f32_16x16x32_bf16 v[152:155], a[148:151], a[48:51], v[152:155]
v_fmac_f32 v169, v61, v84
s_waitcnt vmcnt(10) lgkmcnt(0)
v_mfma_f32_16x16x32_bf16 v[132:135], a[96:99], a[0:3], v[132:135]
ds_read_b128 a[128:131], v5 offset:30720
v_fmac_f32 v145, v61, v82
v_mfma_f32_16x16x32_bf16 v[156:159], a[96:99], a[4:7], v[156:159]
buffer_load_dwordx4 a[48:51], v2, s[40:43], s35 offen offset:0 sc1
v_mfma_f32_16x16x32_bf16 v[180:183], a[96:99], a[8:11], v[180:183]
ds_read_b128 a[132:135], v5 offset:31744
v_fmac_f32 v149, v65, v82
v_mfma_f32_16x16x32_bf16 v[204:207], a[96:99], a[12:15], v[204:207]
v_fmac_f32 v173, v65, v84
v_fmac_f32 v197, v65, v86
v_mfma_f32_16x16x32_bf16 v[208:211], a[100:103], a[12:15], v[208:211]
v_fmac_f32 v221, v65, v88
v_mfma_f32_16x16x32_bf16 v[184:187], a[100:103], a[8:11], v[184:187]
buffer_load_dwordx4 a[52:55], v2, s[40:43], s35 offen offset:1024 sc1
v_mfma_f32_16x16x32_bf16 v[160:163], a[100:103], a[4:7], v[160:163]
ds_read_b128 a[136:139], v5 offset:32768
v_fmac_f32 v225, v69, v88
v_mfma_f32_16x16x32_bf16 v[136:139], a[100:103], a[0:3], v[136:139]
v_fmac_f32 v201, v69, v86
v_fmac_f32 v177, v69, v84
v_mfma_f32_16x16x32_bf16 v[140:143], a[104:107], a[0:3], v[140:143]
ds_read_b128 a[140:143], v5 offset:33792
v_fmac_f32 v153, v69, v82
v_mfma_f32_16x16x32_bf16 v[164:167], a[104:107], a[4:7], v[164:167]
v_fmac_f32 v134, v50, v82
v_mfma_f32_16x16x32_bf16 v[188:191], a[104:107], a[8:11], v[188:191]
buffer_load_dwordx4 v1, s[4:7], s44 offen offset:3072 sc1 lds
s_add_u32 m0, s19, 65536
v_mfma_f32_16x16x32_bf16 v[212:215], a[104:107], a[12:15], v[212:215]
s_add_u32 s44, s84, 0xc08000
ds_read_b128 a[144:147], v5 offset:34816
v_mfma_f32_16x16x32_bf16 v[216:219], a[108:111], a[12:15], v[216:219]
v_fmac_f32 v158, v50, v84
v_fmac_f32 v182, v50, v86
v_mfma_f32_16x16x32_bf16 v[192:195], a[108:111], a[8:11], v[192:195]
ds_read_b128 a[148:151], v5 offset:35840
v_fmac_f32 v206, v50, v88
v_mfma_f32_16x16x32_bf16 v[168:171], a[108:111], a[4:7], v[168:171]
v_fmac_f32 v210, v54, v88
v_fmac_f32 v186, v54, v86
v_mfma_f32_16x16x32_bf16 v[144:147], a[108:111], a[0:3], v[144:147]
buffer_load_dwordx4 a[56:59], v2, s[40:43], s35 offen offset:2048 sc1
v_mfma_f32_16x16x32_bf16 v[148:151], a[112:115], a[0:3], v[148:151]
v_fmac_f32 v162, v54, v84
v_fmac_f32 v138, v54, v82
v_mfma_f32_16x16x32_bf16 v[172:175], a[112:115], a[4:7], v[172:175]
v_fmac_f32 v142, v58, v82
v_mfma_f32_16x16x32_bf16 v[196:199], a[112:115], a[8:11], v[196:199]
v_fmac_f32 v166, v58, v84
v_mfma_f32_16x16x32_bf16 v[220:223], a[112:115], a[12:15], v[220:223]
v_fmac_f32 v190, v58, v86
v_mfma_f32_16x16x32_bf16 v[224:227], a[116:119], a[12:15], v[224:227]
buffer_load_dwordx4 a[60:63], v2, s[40:43], s35 offen offset:3072 sc1
s_add_u32 s35, s35, 4096
v_mfma_f32_16x16x32_bf16 v[200:203], a[116:119], a[8:11], v[200:203]
v_fmac_f32 v214, v58, v88
v_fmac_f32 v218, v62, v88
v_mfma_f32_16x16x32_bf16 v[176:179], a[116:119], a[4:7], v[176:179]
v_fmac_f32 v194, v62, v86
v_mfma_f32_16x16x32_bf16 v[152:155], a[116:119], a[0:3], v[152:155]
v_fmac_f32 v170, v62, v84
s_waitcnt vmcnt(10) lgkmcnt(0)
v_mfma_f32_16x16x32_bf16 v[132:135], a[128:131], a[16:19], v[132:135]
ds_read_b128 a[96:99], v5 offset:36864
v_fmac_f32 v146, v62, v82
v_mfma_f32_16x16x32_bf16 v[156:159], a[128:131], a[20:23], v[156:159]
buffer_load_dwordx4 v1, s[4:7], s44 offen offset:0 sc1 lds
v_mfma_f32_16x16x32_bf16 v[180:183], a[128:131], a[24:27], v[180:183]
ds_read_b128 a[100:103], v5 offset:37888
v_fmac_f32 v150, v66, v82
v_mfma_f32_16x16x32_bf16 v[204:207], a[128:131], a[28:31], v[204:207]
v_fmac_f32 v174, v66, v84
v_fmac_f32 v198, v66, v86
v_mfma_f32_16x16x32_bf16 v[208:211], a[132:135], a[28:31], v[208:211]
v_fmac_f32 v222, v66, v88
v_mfma_f32_16x16x32_bf16 v[184:187], a[132:135], a[24:27], v[184:187]
buffer_load_dwordx4 v1, s[4:7], s44 offen offset:1024 sc1 lds
v_mfma_f32_16x16x32_bf16 v[160:163], a[132:135], a[20:23], v[160:163]
ds_read_b128 a[104:107], v5 offset:38912
v_fmac_f32 v226, v70, v88
v_mfma_f32_16x16x32_bf16 v[136:139], a[132:135], a[16:19], v[136:139]
v_fmac_f32 v202, v70, v86
v_fmac_f32 v178, v70, v84
v_mfma_f32_16x16x32_bf16 v[140:143], a[136:139], a[16:19], v[140:143]
ds_read_b128 a[108:111], v5 offset:39936
v_fmac_f32 v154, v70, v82
v_mfma_f32_16x16x32_bf16 v[164:167], a[136:139], a[20:23], v[164:167]
v_fmac_f32 v135, v51, v82
v_mfma_f32_16x16x32_bf16 v[188:191], a[136:139], a[24:27], v[188:191]
buffer_load_dwordx4 v1, s[4:7], s44 offen offset:2048 sc1 lds
v_mfma_f32_16x16x32_bf16 v[212:215], a[136:139], a[28:31], v[212:215]
ds_read_b128 a[112:115], v5 offset:40960
v_fmac_f32 v159, v51, v84
v_mfma_f32_16x16x32_bf16 v[216:219], a[140:143], a[28:31], v[216:219]
v_fmac_f32 v183, v51, v86
v_fmac_f32 v207, v51, v88
v_mfma_f32_16x16x32_bf16 v[192:195], a[140:143], a[24:27], v[192:195]
ds_read_b128 a[116:119], v5 offset:41984
v_fmac_f32 v211, v55, v88
v_mfma_f32_16x16x32_bf16 v[168:171], a[140:143], a[20:23], v[168:171]
v_fmac_f32 v187, v55, v86
v_mfma_f32_16x16x32_bf16 v[144:147], a[140:143], a[16:19], v[144:147]
buffer_load_dwordx4 v1, s[4:7], s44 offen offset:3072 sc1 lds
s_add_u32 m0, s19, 81920
v_mfma_f32_16x16x32_bf16 v[148:151], a[144:147], a[16:19], v[148:151]
s_add_u32 s44, s85, 0xc0c000
v_fmac_f32 v163, v55, v84
v_mfma_f32_16x16x32_bf16 v[172:175], a[144:147], a[20:23], v[172:175]
v_fmac_f32 v139, v55, v82
v_fmac_f32 v143, v59, v82
v_mfma_f32_16x16x32_bf16 v[196:199], a[144:147], a[24:27], v[196:199]
v_fmac_f32 v167, v59, v84
v_mfma_f32_16x16x32_bf16 v[220:223], a[144:147], a[28:31], v[220:223]
v_fmac_f32 v191, v59, v86
v_mfma_f32_16x16x32_bf16 v[224:227], a[148:151], a[28:31], v[224:227]
buffer_load_dwordx4 v1, s[4:7], s44 offen offset:0 sc1 lds
v_mfma_f32_16x16x32_bf16 v[200:203], a[148:151], a[24:27], v[200:203]
v_fmac_f32 v215, v59, v88
v_fmac_f32 v219, v63, v88
v_mfma_f32_16x16x32_bf16 v[176:179], a[148:151], a[20:23], v[176:179]
v_fmac_f32 v195, v63, v86
v_mfma_f32_16x16x32_bf16 v[152:155], a[148:151], a[16:19], v[152:155]
v_fmac_f32 v171, v63, v84
s_waitcnt vmcnt(10) lgkmcnt(0)
v_mfma_f32_16x16x32_bf16 v[132:135], a[96:99], a[32:35], v[132:135]
ds_read_b128 a[128:131], v5 offset:43008
v_fmac_f32 v147, v63, v82
v_mfma_f32_16x16x32_bf16 v[156:159], a[96:99], a[36:39], v[156:159]
buffer_load_dwordx4 v1, s[4:7], s44 offen offset:1024 sc1 lds
v_mfma_f32_16x16x32_bf16 v[180:183], a[96:99], a[40:43], v[180:183]
ds_read_b128 a[132:135], v5 offset:44032
v_fmac_f32 v151, v67, v82
v_mfma_f32_16x16x32_bf16 v[204:207], a[96:99], a[44:47], v[204:207]
v_fmac_f32 v175, v67, v84
v_fmac_f32 v199, v67, v86
v_mfma_f32_16x16x32_bf16 v[208:211], a[100:103], a[44:47], v[208:211]
v_fmac_f32 v223, v67, v88
v_mfma_f32_16x16x32_bf16 v[184:187], a[100:103], a[40:43], v[184:187]
buffer_load_dwordx4 v1, s[4:7], s44 offen offset:2048 sc1 lds
v_mfma_f32_16x16x32_bf16 v[160:163], a[100:103], a[36:39], v[160:163]
ds_read_b128 a[136:139], v5 offset:45056
v_fmac_f32 v227, v71, v88
v_mfma_f32_16x16x32_bf16 v[136:139], a[100:103], a[32:35], v[136:139]
v_fmac_f32 v203, v71, v86
v_fmac_f32 v179, v71, v84
v_mfma_f32_16x16x32_bf16 v[140:143], a[104:107], a[32:35], v[140:143]
ds_read_b128 a[140:143], v5 offset:46080
v_fmac_f32 v155, v71, v82
v_mfma_f32_16x16x32_bf16 v[164:167], a[104:107], a[36:39], v[164:167]
v_mfma_f32_16x16x32_bf16 v[188:191], a[104:107], a[40:43], v[188:191]
buffer_load_dwordx4 v1, s[4:7], s44 offen offset:3072 sc1 lds
s_add_u32 m0, s19, 147456
v_mfma_f32_16x16x32_bf16 v[212:215], a[104:107], a[44:47], v[212:215]
s_add_u32 s44, s87, 0xc1c000
ds_read_b128 a[144:147], v5 offset:47104
v_mfma_f32_16x16x32_bf16 v[216:219], a[108:111], a[44:47], v[216:219]
v_mfma_f32_16x16x32_bf16 v[192:195], a[108:111], a[40:43], v[192:195]
ds_read_b128 a[148:151], v5 offset:48128
v_mfma_f32_16x16x32_bf16 v[168:171], a[108:111], a[36:39], v[168:171]
v_mfma_f32_16x16x32_bf16 v[144:147], a[108:111], a[32:35], v[144:147]
buffer_load_dwordx4 v1, s[4:7], s44 offen offset:0 sc1 lds
v_mfma_f32_16x16x32_bf16 v[148:151], a[112:115], a[32:35], v[148:151]
v_mfma_f32_16x16x32_bf16 v[172:175], a[112:115], a[36:39], v[172:175]
v_mfma_f32_16x16x32_bf16 v[196:199], a[112:115], a[40:43], v[196:199]
v_mfma_f32_16x16x32_bf16 v[220:223], a[112:115], a[44:47], v[220:223]
v_mfma_f32_16x16x32_bf16 v[224:227], a[116:119], a[44:47], v[224:227]
buffer_load_dwordx4 v1, s[4:7], s44 offen offset:1024 sc1 lds
v_mfma_f32_16x16x32_bf16 v[200:203], a[116:119], a[40:43], v[200:203]
v_mfma_f32_16x16x32_bf16 v[176:179], a[116:119], a[36:39], v[176:179]
v_mfma_f32_16x16x32_bf16 v[152:155], a[116:119], a[32:35], v[152:155]
s_waitcnt vmcnt(10) lgkmcnt(0)
s_barrier
v_mfma_f32_16x16x32_bf16 v[132:135], a[128:131], a[48:51], v[132:135]
v_mfma_f32_16x16x32_bf16 v[156:159], a[128:131], a[52:55], v[156:159]
buffer_load_dwordx4 v1, s[4:7], s44 offen offset:2048 sc1 lds
v_mfma_f32_16x16x32_bf16 v[180:183], a[128:131], a[56:59], v[180:183]
v_mfma_f32_16x16x32_bf16 v[204:207], a[128:131], a[60:63], v[204:207]
v_mfma_f32_16x16x32_bf16 v[208:211], a[132:135], a[60:63], v[208:211]
v_mfma_f32_16x16x32_bf16 v[184:187], a[132:135], a[56:59], v[184:187]
v_mfma_f32_16x16x32_bf16 v[160:163], a[132:135], a[52:55], v[160:163]
v_mfma_f32_16x16x32_bf16 v[136:139], a[132:135], a[48:51], v[136:139]
v_mfma_f32_16x16x32_bf16 v[140:143], a[136:139], a[48:51], v[140:143]
v_mfma_f32_16x16x32_bf16 v[164:167], a[136:139], a[52:55], v[164:167]
v_mfma_f32_16x16x32_bf16 v[188:191], a[136:139], a[56:59], v[188:191]
v_mfma_f32_16x16x32_bf16 v[212:215], a[136:139], a[60:63], v[212:215]
v_mfma_f32_16x16x32_bf16 v[216:219], a[140:143], a[60:63], v[216:219]
v_mfma_f32_16x16x32_bf16 v[192:195], a[140:143], a[56:59], v[192:195]
buffer_load_dwordx4 v1, s[4:7], s44 offen offset:3072 sc1 lds
v_mfma_f32_16x16x32_bf16 v[168:171], a[140:143], a[52:55], v[168:171]
v_mfma_f32_16x16x32_bf16 v[144:147], a[140:143], a[48:51], v[144:147]
v_mfma_f32_16x16x32_bf16 v[148:151], a[144:147], a[48:51], v[148:151]
v_mfma_f32_16x16x32_bf16 v[172:175], a[144:147], a[52:55], v[172:175]
v_mfma_f32_16x16x32_bf16 v[196:199], a[144:147], a[56:59], v[196:199]
v_mfma_f32_16x16x32_bf16 v[220:223], a[144:147], a[60:63], v[220:223]
v_mfma_f32_16x16x32_bf16 v[224:227], a[148:151], a[60:63], v[224:227]
v_mfma_f32_16x16x32_bf16 v[200:203], a[148:151], a[56:59], v[200:203]
v_mfma_f32_16x16x32_bf16 v[176:179], a[148:151], a[52:55], v[176:179]
v_mfma_f32_16x16x32_bf16 v[152:155], a[148:151], a[48:51], v[152:155]
.set L_cpf1, .
s_lshl_b32 s36, s28, 12
v_add_u32 v232, s36, v7
v_add_u32 v233, s36, v232
s_lshl_b32 s36, s28, 9
s_lshl_b32 s37, s30, 2
s_add_u32 s37, s37, s28
s_lshl_b32 s37, s37, 3
s_add_u32 s38, s37, s29
s_lshl_b32 s39, s38, 7
s_add_u32 s39, s39, 0x800000
s_lshl_b32 s38, s38, 10
s_add_u32 s38, s38, 0x400000
s_lshl_b32 s88, s28, 6
s_add_u32 s94, s80, s88
s_add_u32 s94, s94, 0x80000
s_add_u32 s88, s88, s70
s_add_u32 s89, s88, 0x80000
s_lshl_b32 s91, s30, 2
s_add_u32 s91, s91, s28
s_lshl_b32 s91, s91, 3
s_add_u32 s91, s91, s29
s_lshl_b32 s91, s91, 7
s_add_u32 s91, s91, 0x800000
buffer_store_dwordx4 a[228:231], v254, s[4:7], s91 offen offset:0 sc1
s_sub_u32 s91, s91, 0x800000
s_lshl_b32 s91, s91, 3
s_add_u32 s91, s91, 0x400000
s_add_u32 m0, s19, 98304
s_add_u32 s44, s84, 0xc10000
v_cvt_pk_bf16_f32 v140, v140, v141
v_cvt_pk_bf16_f32 v164, v164, v165
v_cvt_pk_bf16_f32 v141, v142, v143
v_cvt_pk_bf16_f32 v165, v166, v167
v_cvt_pk_bf16_f32 v142, v144, v145
v_cvt_pk_bf16_f32 v143, v146, v147
v_cvt_pk_bf16_f32 v166, v168, v169
v_cvt_pk_bf16_f32 v167, v170, v171
v_mfma_f32_16x16x32_bf16 v[92:95], a[232:235], v[140:143], 0
v_mul_f32 v240, 0x3fb8aa3b, v83
v_mul_f32 v246, 0x3fb8aa3b, v85
v_mfma_f32_16x16x32_bf16 v[108:111], a[232:235], v[164:167], 0
v_cvt_pk_bf16_f32 v188, v188, v189
v_cvt_pk_bf16_f32 v212, v212, v213
v_mfma_f32_16x16x32_bf16 v[96:99], a[236:239], v[140:143], 0
s_nop 1
v_max3_f32 v236, v92, v93, v94
v_max3_f32 v237, -v92, -v93, -v94
v_mfma_f32_16x16x32_bf16 v[112:115], a[236:239], v[164:167], 0
v_max3_f32 v242, v108, v109, v110
v_max3_f32 v243, -v108, -v109, -v110
v_cvt_pk_bf16_f32 v189, v190, v191
v_cvt_pk_bf16_f32 v213, v214, v215
v_max3_f32 v236, v236, v95, v96
v_max3_f32 v237, v237, -v95, -v96
v_max3_f32 v236, v236, v97, v98
buffer_store_dwordx4 a[228:231], v1, s[4:7], s91 offen offset:0 sc1
v_max3_f32 v242, v242, v111, v112
v_max3_f32 v243, v243, -v111, -v112
v_max3_f32 v237, v237, -v97, -v98
v_max3_f32 v242, v242, v113, v114
v_max3_f32 v243, v243, -v113, -v114
v_max_f32 v236, v236, v99
v_max_f32_e64 v237, v237, -v99
v_max_f32 v242, v242, v115
v_max_f32_e64 v243, v243, -v115
v_permlane32_swap_b32 v236, v237
s_nop 0
v_permlane32_swap_b32 v242, v243
v_max_f32 v236, v236, v237
v_max_f32 v242, v242, v243
v_mov_b32 v238, v236
v_mov_b32 v244, v242
v_pk_mul_f32 v[148:149], v[148:149], v[82:83] op_sel:[0,1] op_sel_hi:[1,1]
v_permlane16_swap_b32 v236, v238
v_permlane16_swap_b32 v242, v244
v_max_f32 v236, v236, v238
L_stub7:
s_cbranch_execz L_stub8
v_max_f32 v242, v242, v244
v_mov_b32 v238, v236
v_mov_b32 v244, v242
v_pk_mul_f32 v[172:173], v[172:173], v[84:85] op_sel:[0,1] op_sel_hi:[1,1]
v_permlane32_swap_b32 v236, v238
v_permlane32_swap_b32 v242, v244
v_mul_f32_e64 v236, -v236, v240
v_mul_f32_e64 v237, -v238, v240
v_mul_f32_e64 v242, -v242, v246
buffer_load_dwordx4 v1, s[4:7], s44 offen offset:0 sc1 lds
v_mul_f32_e64 v243, -v244, v246
v_pk_fma_f32 v[100:101], v[92:93], v[240:241], v[236:237] op_sel:[0,0,0] op_sel_hi:[1,0,0]
v_pk_fma_f32 v[102:103], v[94:95], v[240:241], v[236:237] op_sel:[0,0,0] op_sel_hi:[1,0,0]
v_pk_fma_f32 v[104:105], v[96:97], v[240:241], v[236:237] op_sel:[0,0,0] op_sel_hi:[1,0,0]
v_pk_fma_f32 v[106:107], v[98:99], v[240:241], v[236:237] op_sel:[0,0,0] op_sel_hi:[1,0,0]
v_pk_fma_f32 v[116:117], v[108:109], v[246:247], v[242:243] op_sel:[0,0,0] op_sel_hi:[1,0,0]
v_pk_fma_f32 v[118:119], v[110:111], v[246:247], v[242:243] op_sel:[0,0,0] op_sel_hi:[1,0,0]
v_pk_fma_f32 v[120:121], v[112:113], v[246:247], v[242:243] op_sel:[0,0,0] op_sel_hi:[1,0,0]
v_pk_fma_f32 v[122:123], v[114:115], v[246:247], v[242:243] op_sel:[0,0,0] op_sel_hi:[1,0,0]
v_pk_fma_f32 v[92:93], v[92:93], v[240:241], v[236:237] op_sel:[0,0,1] op_sel_hi:[1,0,1] neg_lo:[1,0,0] neg_hi:[1,0,0]
v_pk_fma_f32 v[94:95], v[94:95], v[240:241], v[236:237] op_sel:[0,0,1] op_sel_hi:[1,0,1] neg_lo:[1,0,0] neg_hi:[1,0,0]
v_pk_fma_f32 v[96:97], v[96:97], v[240:241], v[236:237] op_sel:[0,0,1] op_sel_hi:[1,0,1] neg_lo:[1,0,0] neg_hi:[1,0,0]
v_pk_fma_f32 v[98:99], v[98:99], v[240:241], v[236:237] op_sel:[0,0,1] op_sel_hi:[1,0,1] neg_lo:[1,0,0] neg_hi:[1,0,0]
v_pk_fma_f32 v[108:109], v[108:109], v[246:247], v[242:243] op_sel:[0,0,1] op_sel_hi:[1,0,1] neg_lo:[1,0,0] neg_hi:[1,0,0]
v_pk_fma_f32 v[110:111], v[110:111], v[246:247], v[242:243] op_sel:[0,0,1] op_sel_hi:[1,0,1] neg_lo:[1,0,0] neg_hi:[1,0,0]
v_pk_fma_f32 v[112:113], v[112:113], v[246:247], v[242:243] op_sel:[0,0,1] op_sel_hi:[1,0,1] neg_lo:[1,0,0] neg_hi:[1,0,0]
v_pk_fma_f32 v[114:115], v[114:115], v[246:247], v[242:243] op_sel:[0,0,1] op_sel_hi:[1,0,1] neg_lo:[1,0,0] neg_hi:[1,0,0]
v_exp_f32 v92, v92
v_exp_f32 v93, v93
v_exp_f32 v94, v94
v_exp_f32 v95, v95
v_exp_f32 v96, v96
buffer_load_dwordx4 v1, s[4:7], s44 offen offset:1024 sc1 lds
v_exp_f32 v97, v97
v_exp_f32 v98, v98
v_exp_f32 v99, v99
v_exp_f32 v108, v108
v_exp_f32 v109, v109
v_exp_f32 v110, v110
v_exp_f32 v111, v111
v_exp_f32 v112, v112
v_exp_f32 v113, v113
v_exp_f32 v114, v114
v_exp_f32 v115, v115
v_pk_mul_f32 v[150:151], v[150:151], v[82:83] op_sel:[0,1] op_sel_hi:[1,1]
v_pk_mul_f32 v[174:175], v[174:175], v[84:85] op_sel:[0,1] op_sel_hi:[1,1]
v_cvt_pk_bf16_f32 v144, v92, v93
v_cvt_pk_bf16_f32 v145, v94, v95
v_cvt_pk_bf16_f32 v146, v96, v97
buffer_load_dwordx4 v1, s[4:7], s44 offen offset:2048 sc1 lds
v_cvt_pk_bf16_f32 v147, v98, v99
v_cvt_pk_bf16_f32 v168, v108, v109
v_cvt_pk_bf16_f32 v169, v110, v111
v_cvt_pk_bf16_f32 v170, v112, v113
v_cvt_pk_bf16_f32 v171, v114, v115
v_cvt_pk_bf16_f32 v148, v148, v149
v_cvt_pk_bf16_f32 v172, v172, v173
v_pk_mul_f32 v[152:153], v[152:153], v[82:83] op_sel:[0,1] op_sel_hi:[1,1]
v_pk_mul_f32 v[154:155], v[154:155], v[82:83] op_sel:[0,1] op_sel_hi:[1,1]
v_pk_mul_f32 v[176:177], v[176:177], v[84:85] op_sel:[0,1] op_sel_hi:[1,1]
v_pk_mul_f32 v[178:179], v[178:179], v[84:85] op_sel:[0,1] op_sel_hi:[1,1]
v_cvt_pk_bf16_f32 v149, v150, v151
v_cvt_pk_bf16_f32 v173, v174, v175
v_cvt_pk_bf16_f32 v150, v152, v153
v_cvt_pk_bf16_f32 v151, v154, v155
v_cvt_pk_bf16_f32 v174, v176, v177
v_cvt_pk_bf16_f32 v175, v178, v179
v_mfma_f32_16x16x32_bf16 v[152:155], v[16:19], v[144:147], 0
v_cvt_pk_bf16_f32 v190, v192, v193
v_cvt_pk_bf16_f32 v191, v194, v195
v_mfma_f32_16x16x32_bf16 v[176:179], v[16:19], v[168:171], 0
v_cvt_pk_bf16_f32 v214, v216, v217
v_cvt_pk_bf16_f32 v215, v218, v219
v_exp_f32 v100, v100
buffer_load_dwordx4 v1, s[4:7], s44 offen offset:3072 sc1 lds
s_add_u32 m0, s19, 114688
s_add_u32 s44, s85, 0xc14000
s_lshl_b32 s91, s30, 12
s_add_u32 s91, s91, 0x2600000
v_rcp_f32 v152, v152
v_rcp_f32 v176, v176
v_pk_mul_f32 v[92:93], v[92:93], v[152:153] op_sel:[0,0] op_sel_hi:[1,0]
v_pk_mul_f32 v[94:95], v[94:95], v[152:153] op_sel:[0,0] op_sel_hi:[1,0]
v_pk_mul_f32 v[108:109], v[108:109], v[176:177] op_sel:[0,0] op_sel_hi:[1,0]
v_pk_mul_f32 v[110:111], v[110:111], v[176:177] op_sel:[0,0] op_sel_hi:[1,0]
v_pk_mul_f32 v[96:97], v[96:97], v[152:153] op_sel:[0,0] op_sel_hi:[1,0]
v_pk_mul_f32 v[98:99], v[98:99], v[152:153] op_sel:[0,0] op_sel_hi:[1,0]
v_cvt_pk_bf16_f32 v144, v92, v93
v_cvt_pk_bf16_f32 v145, v94, v95
v_pk_mul_f32 v[112:113], v[112:113], v[176:177] op_sel:[0,0] op_sel_hi:[1,0]
v_cvt_pk_bf16_f32 v168, v108, v109
v_pk_mul_f32 v[114:115], v[114:115], v[176:177] op_sel:[0,0] op_sel_hi:[1,0]
v_cvt_pk_bf16_f32 v169, v110, v111
v_mfma_f32_16x16x32_bf16 v[92:95], a[232:235], v[188:191], 0
v_cvt_pk_bf16_f32 v146, v96, v97
v_cvt_pk_bf16_f32 v147, v98, v99
v_mfma_f32_16x16x32_bf16 v[108:111], a[232:235], v[212:215], 0
v_cvt_pk_bf16_f32 v170, v112, v113
buffer_load_dwordx4 v1, s[4:7], s44 offen offset:0 sc1 lds
v_cvt_pk_bf16_f32 v171, v114, v115
v_mfma_f32_16x16x32_bf16 v[96:99], a[236:239], v[188:191], 0
s_nop 0
v_max3_f32 v236, v92, v93, v94
v_max3_f32 v237, -v92, -v93, -v94
v_mfma_f32_16x16x32_bf16 v[112:115], a[236:239], v[212:215], 0
v_max3_f32 v242, v108, v109, v110
v_max3_f32 v243, -v108, -v109, -v110
v_exp_f32 v101, v101
s_nop 0
v_max3_f32 v236, v236, v95, v96
v_max3_f32 v237, v237, -v95, -v96
v_max3_f32 v236, v236, v97, v98
v_max3_f32 v237, v237, -v97, -v98
v_max3_f32 v242, v242, v111, v112
v_max3_f32 v243, v243, -v111, -v112
v_max3_f32 v242, v242, v113, v114
v_max3_f32 v243, v243, -v113, -v114
v_max_f32 v236, v236, v99
v_max_f32_e64 v237, v237, -v99
v_max_f32 v242, v242, v115
v_max_f32_e64 v243, v243, -v115
v_exp_f32 v102, v102
v_exp_f32 v103, v103
buffer_load_dwordx4 v1, s[4:7], s44 offen offset:1024 sc1 lds
v_exp_f32 v104, v104
v_exp_f32 v105, v105
v_exp_f32 v106, v106
v_exp_f32 v107, v107
v_exp_f32 v116, v116
v_exp_f32 v117, v117
v_exp_f32 v118, v118
v_exp_f32 v119, v119
v_exp_f32 v120, v120
v_exp_f32 v121, v121
v_exp_f32 v122, v122
v_exp_f32 v123, v123
v_permlane32_swap_b32 v236, v237
v_permlane32_swap_b32 v242, v243
buffer_load_dwordx4 v1, s[4:7], s44 offen offset:2048 sc1 lds
v_cvt_pk_bf16_f32 v140, v100, v101
v_cvt_pk_bf16_f32 v141, v102, v103
v_cvt_pk_bf16_f32 v142, v104, v105
v_cvt_pk_bf16_f32 v143, v106, v107
v_cvt_pk_bf16_f32 v164, v116, v117
v_cvt_pk_bf16_f32 v165, v118, v119
v_cvt_pk_bf16_f32 v166, v120, v121
v_cvt_pk_bf16_f32 v167, v122, v123
ds_write_b64 v232, v[148:149] offset:0
ds_write_b64 v232, v[150:151] offset:512
ds_write_b64 v232, v[172:173] offset:1024
v_max_f32 v236, v236, v237
v_max_f32 v242, v242, v243
v_mfma_f32_16x16x32_bf16 v[148:151], v[16:19], v[140:143], 0
ds_write_b64 v232, v[174:175] offset:1536
v_mfma_f32_16x16x32_bf16 v[172:175], v[16:19], v[164:167], 0
v_mov_b32 v238, v236
buffer_load_dwordx4 v1, s[4:7], s44 offen offset:3072 sc1 lds
v_mov_b32 v244, v242
v_permlane16_swap_b32 v236, v238
s_nop 0
v_permlane16_swap_b32 v242, v244
v_max_f32 v236, v236, v238
v_max_f32 v242, v242, v244
v_mov_b32 v238, v236
v_mov_b32 v244, v242
v_rcp_f32 v148, v148
v_rcp_f32 v172, v172
v_permlane32_swap_b32 v236, v238
v_permlane32_swap_b32 v242, v244
v_mul_f32 v240, 0x3fb8aa3b, v87
v_mul_f32 v246, 0x3fb8aa3b, v89
v_pk_mul_f32 v[100:101], v[100:101], v[148:149] op_sel:[0,0] op_sel_hi:[1,0]
v_pk_mul_f32 v[102:103], v[102:103], v[148:149] op_sel:[0,0] op_sel_hi:[1,0]
v_pk_mul_f32 v[104:105], v[104:105], v[148:149] op_sel:[0,0] op_sel_hi:[1,0]
v_pk_mul_f32 v[106:107], v[106:107], v[148:149] op_sel:[0,0] op_sel_hi:[1,0]
v_pk_mul_f32 v[116:117], v[116:117], v[172:173] op_sel:[0,0] op_sel_hi:[1,0]
v_pk_mul_f32 v[118:119], v[118:119], v[172:173] op_sel:[0,0] op_sel_hi:[1,0]
v_pk_mul_f32 v[120:121], v[120:121], v[172:173] op_sel:[0,0] op_sel_hi:[1,0]
v_pk_mul_f32 v[122:123], v[122:123], v[172:173] op_sel:[0,0] op_sel_hi:[1,0]
buffer_store_dwordx4 a[228:231], v2, s[4:7], s91 offen offset:0 sc1
v_mul_f32_e64 v236, -v236, v240
v_mul_f32_e64 v237, -v238, v240
v_mul_f32_e64 v242, -v242, v246
v_mul_f32_e64 v243, -v244, v246
v_cvt_pk_bf16_f32 v140, v100, v101
v_cvt_pk_bf16_f32 v141, v102, v103
v_cvt_pk_bf16_f32 v142, v104, v105
v_cvt_pk_bf16_f32 v143, v106, v107
v_cvt_pk_bf16_f32 v164, v116, v117
v_cvt_pk_bf16_f32 v165, v118, v119
v_cvt_pk_bf16_f32 v166, v120, v121
v_cvt_pk_bf16_f32 v167, v122, v123
v_pk_fma_f32 v[100:101], v[92:93], v[240:241], v[236:237] op_sel:[0,0,0] op_sel_hi:[1,0,0]
v_pk_fma_f32 v[102:103], v[94:95], v[240:241], v[236:237] op_sel:[0,0,0] op_sel_hi:[1,0,0]
v_pk_fma_f32 v[104:105], v[96:97], v[240:241], v[236:237] op_sel:[0,0,0] op_sel_hi:[1,0,0]
v_pk_fma_f32 v[106:107], v[98:99], v[240:241], v[236:237] op_sel:[0,0,0] op_sel_hi:[1,0,0]
v_pk_fma_f32 v[116:117], v[108:109], v[246:247], v[242:243] op_sel:[0,0,0] op_sel_hi:[1,0,0]
v_pk_fma_f32 v[118:119], v[110:111], v[246:247], v[242:243] op_sel:[0,0,0] op_sel_hi:[1,0,0]
v_pk_fma_f32 v[120:121], v[112:113], v[246:247], v[242:243] op_sel:[0,0,0] op_sel_hi:[1,0,0]
v_pk_fma_f32 v[122:123], v[114:115], v[246:247], v[242:243] op_sel:[0,0,0] op_sel_hi:[1,0,0]
v_pk_fma_f32 v[92:93], v[92:93], v[240:241], v[236:237] op_sel:[0,0,1] op_sel_hi:[1,0,1] neg_lo:[1,0,0] neg_hi:[1,0,0]
v_pk_fma_f32 v[94:95], v[94:95], v[240:241], v[236:237] op_sel:[0,0,1] op_sel_hi:[1,0,1] neg_lo:[1,0,0] neg_hi:[1,0,0]
v_pk_fma_f32 v[96:97], v[96:97], v[240:241], v[236:237] op_sel:[0,0,1] op_sel_hi:[1,0,1] neg_lo:[1,0,0] neg_hi:[1,0,0]
v_pk_fma_f32 v[98:99], v[98:99], v[240:241], v[236:237] op_sel:[0,0,1] op_sel_hi:[1,0,1] neg_lo:[1,0,0] neg_hi:[1,0,0]
v_pk_fma_f32 v[108:109], v[108:109], v[246:247], v[242:243] op_sel:[0,0,1] op_sel_hi:[1,0,1] neg_lo:[1,0,0] neg_hi:[1,0,0]
v_pk_fma_f32 v[110:111], v[110:111], v[246:247], v[242:243] op_sel:[0,0,1] op_sel_hi:[1,0,1] neg_lo:[1,0,0] neg_hi:[1,0,0]
v_pk_fma_f32 v[112:113], v[112:113], v[246:247], v[242:243] op_sel:[0,0,1] op_sel_hi:[1,0,1] neg_lo:[1,0,0] neg_hi:[1,0,0]
v_pk_fma_f32 v[114:115], v[114:115], v[246:247], v[242:243] op_sel:[0,0,1] op_sel_hi:[1,0,1] neg_lo:[1,0,0] neg_hi:[1,0,0]
v_pk_mul_f32 v[196:197], v[196:197], v[86:87] op_sel:[0,1] op_sel_hi:[1,1]
v_pk_mul_f32 v[220:221], v[220:221], v[88:89] op_sel:[0,1] op_sel_hi:[1,1]
v_exp_f32 v100, v100
v_exp_f32 v92, v92
buffer_store_dwordx4 a[228:231], v2, s[4:7], s91 offen offset:1024 sc1
v_exp_f32 v101, v101
v_exp_f32 v93, v93
v_exp_f32 v102, v102
v_exp_f32 v94, v94
v_exp_f32 v103, v103
v_exp_f32 v95, v95
v_exp_f32 v104, v104
v_exp_f32 v96, v96
v_exp_f32 v105, v105
v_exp_f32 v97, v97
v_exp_f32 v106, v106
v_exp_f32 v98, v98
v_exp_f32 v107, v107
v_exp_f32 v99, v99
v_exp_f32 v116, v116
v_exp_f32 v108, v108
v_exp_f32 v117, v117
buffer_store_dwordx4 a[228:231], v2, s[4:7], s91 offen offset:2048 sc1
v_exp_f32 v109, v109
v_exp_f32 v118, v118
v_exp_f32 v110, v110
v_exp_f32 v119, v119
v_exp_f32 v111, v111
v_exp_f32 v120, v120
v_exp_f32 v112, v112
v_exp_f32 v121, v121
v_exp_f32 v113, v113
v_exp_f32 v122, v122
v_exp_f32 v114, v114
v_exp_f32 v123, v123
v_exp_f32 v115, v115
v_pk_mul_f32 v[198:199], v[198:199], v[86:87] op_sel:[0,1] op_sel_hi:[1,1]
v_pk_mul_f32 v[222:223], v[222:223], v[88:89] op_sel:[0,1] op_sel_hi:[1,1]
v_cvt_pk_bf16_f32 v196, v196, v197
v_cvt_pk_bf16_f32 v220, v220, v221
v_pk_mul_f32 v[200:201], v[200:201], v[86:87] op_sel:[0,1] op_sel_hi:[1,1]
v_pk_mul_f32 v[202:203], v[202:203], v[86:87] op_sel:[0,1] op_sel_hi:[1,1]
v_pk_mul_f32 v[224:225], v[224:225], v[88:89] op_sel:[0,1] op_sel_hi:[1,1]
v_pk_mul_f32 v[226:227], v[226:227], v[88:89] op_sel:[0,1] op_sel_hi:[1,1]
v_cvt_pk_bf16_f32 v197, v198, v199
v_cvt_pk_bf16_f32 v221, v222, v223
v_cvt_pk_bf16_f32 v198, v200, v201
v_cvt_pk_bf16_f32 v199, v202, v203
v_cvt_pk_bf16_f32 v222, v224, v225
v_cvt_pk_bf16_f32 v223, v226, v227
v_cvt_pk_bf16_f32 v188, v100, v101
v_cvt_pk_bf16_f32 v189, v102, v103
v_cvt_pk_bf16_f32 v190, v104, v105
v_cvt_pk_bf16_f32 v191, v106, v107
v_cvt_pk_bf16_f32 v192, v92, v93
v_cvt_pk_bf16_f32 v193, v94, v95
v_cvt_pk_bf16_f32 v194, v96, v97
v_cvt_pk_bf16_f32 v195, v98, v99
v_cvt_pk_bf16_f32 v212, v116, v117
v_cvt_pk_bf16_f32 v213, v118, v119
v_cvt_pk_bf16_f32 v214, v120, v121
v_cvt_pk_bf16_f32 v215, v122, v123
v_cvt_pk_bf16_f32 v216, v108, v109
v_cvt_pk_bf16_f32 v217, v110, v111
v_cvt_pk_bf16_f32 v218, v112, v113
v_cvt_pk_bf16_f32 v219, v114, v115
ds_write_b64 v232, v[196:197] offset:2048
ds_write_b64 v232, v[198:199] offset:2560
ds_write_b64 v232, v[220:221] offset:3072
v_mfma_f32_16x16x32_bf16 v[196:199], v[16:19], v[188:191], 0
buffer_store_dwordx4 a[228:231], v2, s[4:7], s91 offen offset:3072 sc1
ds_write_b64 v232, v[222:223] offset:3584
v_mfma_f32_16x16x32_bf16 v[200:203], v[16:19], v[192:195], 0
s_nop 4
v_rcp_f32 v196, v196
v_mfma_f32_16x16x32_bf16 v[220:223], v[16:19], v[212:215], 0
ds_write_b64 v233, v[140:141] offset:16384
v_mfma_f32_16x16x32_bf16 v[224:227], v[16:19], v[216:219], 0
v_rcp_f32 v200, v200
ds_write_b64 v233, v[142:143] offset:16896
s_nop 3
v_rcp_f32 v220, v220
v_pk_mul_f32 v[100:101], v[100:101], v[196:197] op_sel:[0,0] op_sel_hi:[1,0]
v_rcp_f32 v224, v224
v_pk_mul_f32 v[102:103], v[102:103], v[196:197] op_sel:[0,0] op_sel_hi:[1,0]
v_pk_mul_f32 v[104:105], v[104:105], v[196:197] op_sel:[0,0] op_sel_hi:[1,0]
v_pk_mul_f32 v[106:107], v[106:107], v[196:197] op_sel:[0,0] op_sel_hi:[1,0]
v_pk_mul_f32 v[92:93], v[92:93], v[200:201] op_sel:[0,0] op_sel_hi:[1,0]
v_pk_mul_f32 v[94:95], v[94:95], v[200:201] op_sel:[0,0] op_sel_hi:[1,0]
v_pk_mul_f32 v[96:97], v[96:97], v[200:201] op_sel:[0,0] op_sel_hi:[1,0]
v_pk_mul_f32 v[98:99], v[98:99], v[200:201] op_sel:[0,0] op_sel_hi:[1,0]
v_pk_mul_f32 v[116:117], v[116:117], v[220:221] op_sel:[0,0] op_sel_hi:[1,0]
v_pk_mul_f32 v[118:119], v[118:119], v[220:221] op_sel:[0,0] op_sel_hi:[1,0]
v_pk_mul_f32 v[120:121], v[120:121], v[220:221] op_sel:[0,0] op_sel_hi:[1,0]
v_pk_mul_f32 v[122:123], v[122:123], v[220:221] op_sel:[0,0] op_sel_hi:[1,0]
v_pk_mul_f32 v[108:109], v[108:109], v[224:225] op_sel:[0,0] op_sel_hi:[1,0]
v_pk_mul_f32 v[110:111], v[110:111], v[224:225] op_sel:[0,0] op_sel_hi:[1,0]
v_pk_mul_f32 v[112:113], v[112:113], v[224:225] op_sel:[0,0] op_sel_hi:[1,0]
v_pk_mul_f32 v[114:115], v[114:115], v[224:225] op_sel:[0,0] op_sel_hi:[1,0]
v_cvt_pk_bf16_f32 v188, v100, v101
v_cvt_pk_bf16_f32 v189, v102, v103
v_cvt_pk_bf16_f32 v190, v104, v105
v_cvt_pk_bf16_f32 v191, v106, v107
v_cvt_pk_bf16_f32 v192, v92, v93
v_cvt_pk_bf16_f32 v193, v94, v95
v_cvt_pk_bf16_f32 v194, v96, v97
v_cvt_pk_bf16_f32 v195, v98, v99
v_cvt_pk_bf16_f32 v212, v116, v117
v_cvt_pk_bf16_f32 v213, v118, v119
v_cvt_pk_bf16_f32 v214, v120, v121
v_cvt_pk_bf16_f32 v215, v122, v123
v_cvt_pk_bf16_f32 v216, v108, v109
v_cvt_pk_bf16_f32 v217, v110, v111
v_cvt_pk_bf16_f32 v218, v112, v113
v_cvt_pk_bf16_f32 v219, v114, v115
ds_write_b64 v233, v[144:145] offset:17408
ds_write_b64 v233, v[146:147] offset:17920
ds_write_b64 v233, v[164:165] offset:18432
v_lshlrev_b32 v235, 8, v0
v_add_u32 v234, s36, v8
v_cndmask_b32 v235, 2.0, v235, s[64:65]
ds_write_b64 v233, v[166:167] offset:18944
ds_write_b64 v233, v[168:169] offset:19456
ds_write_b64 v233, v[170:171] offset:19968
ds_write_b64 v233, v[188:189] offset:20480
ds_write_b64 v233, v[190:191] offset:20992
ds_write_b64 v233, v[192:193] offset:21504
ds_write_b64 v233, v[194:195] offset:22016
ds_write_b64 v233, v[212:213] offset:22528
ds_write_b64 v233, v[214:215] offset:23040
ds_write_b64 v233, v[216:217] offset:23552
ds_write_b64 v233, v[218:219] offset:24064
s_waitcnt vmcnt(12)
s_waitcnt lgkmcnt(0)
s_barrier
ds_read_b64_tr_b16 a[0:1], v234 offset:16384
ds_read_b64_tr_b16 a[2:3], v234 offset:18432
ds_read_b64_tr_b16 a[12:13], v234 offset:20480
ds_read_b64_tr_b16 a[14:15], v234 offset:22528
ds_read_b64_tr_b16 a[24:25], v234 offset:24576
ds_read_b64_tr_b16 a[26:27], v234 offset:26624
ds_read_b64_tr_b16 a[4:5], v8 offset:0
ds_read_b64_tr_b16 a[6:7], v8 offset:1024
ds_read_b64_tr_b16 a[8:9], v8 offset:512
ds_read_b64_tr_b16 a[10:11], v8 offset:1536
ds_read_b64_tr_b16 a[36:37], v234 offset:28672
ds_read_b64_tr_b16 a[38:39], v234 offset:30720
ds_read_b64_tr_b16 a[16:17], v8 offset:2048
ds_read_b64_tr_b16 a[18:19], v8 offset:3072
ds_read_b64_tr_b16 a[20:21], v8 offset:2560
ds_read_b64_tr_b16 a[22:23], v8 offset:3584
ds_read_b64_tr_b16 a[48:49], v234 offset:32768
ds_read_b64_tr_b16 a[50:51], v234 offset:34816
ds_read_b64_tr_b16 a[28:29], v8 offset:4096
ds_read_b64_tr_b16 a[30:31], v8 offset:5120
ds_read_b64_tr_b16 a[32:33], v8 offset:4608
ds_read_b64_tr_b16 a[34:35], v8 offset:5632
ds_read_b64_tr_b16 a[60:61], v234 offset:36864
ds_read_b64_tr_b16 a[62:63], v234 offset:38912
s_waitcnt lgkmcnt(14)
v_mfma_f32_16x16x32_bf16 v[100:103], a[0:3], v[16:19], 0
ds_read_b64_tr_b16 a[40:41], v8 offset:6144
ds_read_b64_tr_b16 a[42:43], v8 offset:7168
ds_read_b64_tr_b16 a[44:45], v8 offset:6656
ds_read_b64_tr_b16 a[46:47], v8 offset:7680
ds_read_b64_tr_b16 a[72:73], v234 offset:40960
ds_read_b64_tr_b16 a[74:75], v234 offset:43008
v_mfma_f32_16x16x32_bf16 v[100:103], a[12:15], v[16:19], v[100:103]
buffer_atomic_add v12, v235, s[4:7], s94 offen sc1
ds_read_b64_tr_b16 a[52:53], v8 offset:8192
ds_read_b64_tr_b16 a[54:55], v8 offset:9216
ds_read_b64_tr_b16 a[56:57], v8 offset:8704
ds_read_b64_tr_b16 a[58:59], v8 offset:9728
ds_read_b64_tr_b16 a[84:85], v234 offset:45056
ds_read_b64_tr_b16 a[86:87], v234 offset:47104
v_mfma_f32_16x16x32_bf16 v[100:103], a[24:27], v[16:19], v[100:103]
ds_read_b64_tr_b16 a[64:65], v8 offset:10240
ds_read_b64_tr_b16 a[66:67], v8 offset:11264
v_mfma_f32_16x16x32_bf16 v[92:95], a[0:3], a[4:7], 0
ds_read_b64_tr_b16 a[68:69], v8 offset:10752
ds_read_b64_tr_b16 a[70:71], v8 offset:11776
v_mfma_f32_16x16x32_bf16 v[96:99], a[0:3], a[8:11], 0
ds_read_b64_tr_b16 a[76:77], v8 offset:12288
s_waitcnt lgkmcnt(14)
v_mfma_f32_16x16x32_bf16 v[100:103], a[36:39], v[16:19], v[100:103]
ds_read_b64_tr_b16 a[78:79], v8 offset:13312
v_mfma_f32_16x16x32_bf16 v[92:95], a[12:15], a[16:19], v[92:95]
ds_read_b64_tr_b16 a[80:81], v8 offset:12800
ds_read_b64_tr_b16 a[82:83], v8 offset:13824
v_mfma_f32_16x16x32_bf16 v[96:99], a[12:15], a[20:23], v[96:99]
ds_read_b64_tr_b16 a[88:89], v8 offset:14336
v_mfma_f32_16x16x32_bf16 v[100:103], a[48:51], v[16:19], v[100:103]
ds_read_b64_tr_b16 a[90:91], v8 offset:15360
v_mfma_f32_16x16x32_bf16 v[92:95], a[24:27], a[28:31], v[92:95]
ds_read_b64_tr_b16 a[92:93], v8 offset:14848
ds_read_b64_tr_b16 a[94:95], v8 offset:15872
v_mfma_f32_16x16x32_bf16 v[96:99], a[24:27], a[32:35], v[96:99]
v_cvt_pk_bf16_f32 v132, v132, v133
v_cvt_pk_bf16_f32 v156, v156, v157
v_mfma_f32_16x16x32_bf16 v[100:103], a[60:63], v[16:19], v[100:103]
v_cvt_pk_bf16_f32 v180, v180, v181
v_cvt_pk_bf16_f32 v204, v204, v205
v_mfma_f32_16x16x32_bf16 v[92:95], a[36:39], a[40:43], v[92:95]
v_cvt_pk_bf16_f32 v133, v134, v135
v_cvt_pk_bf16_f32 v157, v158, v159
s_waitcnt lgkmcnt(14)
v_mfma_f32_16x16x32_bf16 v[96:99], a[36:39], a[44:47], v[96:99]
v_cvt_pk_bf16_f32 v181, v182, v183
v_cvt_pk_bf16_f32 v205, v206, v207
v_mfma_f32_16x16x32_bf16 v[100:103], a[72:75], v[16:19], v[100:103]
v_cvt_pk_bf16_f32 v134, v136, v137
v_cvt_pk_bf16_f32 v135, v138, v139
v_mfma_f32_16x16x32_bf16 v[92:95], a[48:51], a[52:55], v[92:95]
v_cvt_pk_bf16_f32 v158, v160, v161
v_cvt_pk_bf16_f32 v159, v162, v163
v_mfma_f32_16x16x32_bf16 v[96:99], a[48:51], a[56:59], v[96:99]
v_cvt_pk_bf16_f32 v182, v184, v185
v_cvt_pk_bf16_f32 v183, v186, v187
s_waitcnt lgkmcnt(12)
v_mfma_f32_16x16x32_bf16 v[100:103], a[84:87], v[16:19], v[100:103]
v_cvt_pk_bf16_f32 v206, v208, v209
v_cvt_pk_bf16_f32 v207, v210, v211
s_waitcnt lgkmcnt(10)
v_mfma_f32_16x16x32_bf16 v[92:95], a[60:63], a[64:67], v[92:95]
s_waitcnt lgkmcnt(8)
v_mfma_f32_16x16x32_bf16 v[96:99], a[60:63], a[68:71], v[96:99]
s_nop 1
v_min_u32 v100, -2, v100
v_min_u32 v101, -2, v101
s_waitcnt lgkmcnt(6)
v_mfma_f32_16x16x32_bf16 v[92:95], a[72:75], a[76:79], v[92:95]
v_min_u32 v102, -2, v102
v_min_u32 v103, -2, v103
s_waitcnt lgkmcnt(4)
v_mfma_f32_16x16x32_bf16 v[96:99], a[72:75], a[80:83], v[96:99]
buffer_store_dwordx4 v[100:103], v254, s[4:7], s39 offen sc1
s_waitcnt lgkmcnt(2)
v_mfma_f32_16x16x32_bf16 v[92:95], a[84:87], a[88:91], v[92:95]
s_waitcnt lgkmcnt(0)
v_mfma_f32_16x16x32_bf16 v[96:99], a[84:87], a[92:95], v[96:99]
s_nop 5
v_cvt_pk_bf16_f32 v92, v92, v93
v_cvt_pk_bf16_f32 v93, v94, v95
v_min_u32 v92, -2, v92
v_min_u32 v93, -2, v93
v_cvt_pk_bf16_f32 v94, v96, v97
v_cvt_pk_bf16_f32 v95, v98, v99
v_min_u32 v94, -2, v94
v_min_u32 v95, -2, v95
buffer_store_dwordx4 v[92:95], v1, s[4:7], s38 offen sc1
s_barrier
s_add_u32 m0, s19, 32768
s_add_u32 s44, s84, 0xc00000
buffer_load_dwordx4 v1, s[4:7], s44 offen offset:0 sc1 lds
v_mfma_f32_16x16x32_bf16 v[108:111], a[232:235], v[132:135], 0
v_mul_f32 v240, 0x3fb8aa3b, v83
v_mul_f32 v246, 0x3fb8aa3b, v85
v_mfma_f32_16x16x32_bf16 v[172:175], a[232:235], v[156:159], 0
v_mfma_f32_16x16x32_bf16 v[112:115], a[236:239], v[132:135], 0
s_nop 3
v_max3_f32 v236, v108, v109, v110
v_max3_f32 v237, -v108, -v109, -v110
v_mfma_f32_16x16x32_bf16 v[176:179], a[236:239], v[156:159], 0
v_max3_f32 v242, v172, v173, v174
v_max3_f32 v243, -v172, -v173, -v174
v_max3_f32 v236, v236, v111, v112
v_max3_f32 v237, v237, -v111, -v112
v_max3_f32 v236, v236, v113, v114
v_max3_f32 v237, v237, -v113, -v114
s_nop 1
v_max3_f32 v242, v242, v175, v176
v_max3_f32 v243, v243, -v175, -v176
v_max3_f32 v242, v242, v177, v178
v_max3_f32 v243, v243, -v177, -v178
v_max_f32 v236, v236, v115
buffer_load_dwordx4 v1, s[4:7], s44 offen offset:1024 sc1 lds
v_max_f32_e64 v237, v237, -v115
v_max_f32 v242, v242, v179
v_max_f32_e64 v243, v243, -v179
v_permlane32_swap_b32 v236, v237
s_nop 0
v_permlane32_swap_b32 v242, v243
v_mov_b32 v11, 0
buffer_atomic_add v11, v251, s[4:7], s89 offen sc0 sc1
v_max_f32 v236, v236, v237
v_max_f32 v242, v242, v243
v_mov_b32 v238, v236
v_mov_b32 v244, v242
s_nop 0
v_permlane16_swap_b32 v236, v238
v_permlane16_swap_b32 v242, v244
v_max_f32 v236, v236, v238
v_max_f32 v242, v242, v244
v_mov_b32 v238, v236
v_mov_b32 v244, v242
s_nop 0
v_permlane32_swap_b32 v236, v238
v_permlane32_swap_b32 v242, v244
v_mul_f32_e64 v236, -v236, v240
v_mul_f32_e64 v237, -v238, v240
buffer_load_dwordx4 v1, s[4:7], s44 offen offset:2048 sc1 lds
v_mul_f32_e64 v242, -v242, v246
v_mul_f32_e64 v243, -v244, v246
v_pk_fma_f32 v[116:117], v[108:109], v[240:241], v[236:237] op_sel:[0,0,0] op_sel_hi:[1,0,0]
v_pk_fma_f32 v[118:119], v[110:111], v[240:241], v[236:237] op_sel:[0,0,0] op_sel_hi:[1,0,0]
v_pk_fma_f32 v[120:121], v[112:113], v[240:241], v[236:237] op_sel:[0,0,0] op_sel_hi:[1,0,0]
v_pk_fma_f32 v[122:123], v[114:115], v[240:241], v[236:237] op_sel:[0,0,0] op_sel_hi:[1,0,0]
v_pk_fma_f32 v[148:149], v[172:173], v[246:247], v[242:243] op_sel:[0,0,0] op_sel_hi:[1,0,0]
v_pk_fma_f32 v[150:151], v[174:175], v[246:247], v[242:243] op_sel:[0,0,0] op_sel_hi:[1,0,0]
v_pk_fma_f32 v[152:153], v[176:177], v[246:247], v[242:243] op_sel:[0,0,0] op_sel_hi:[1,0,0]
v_pk_fma_f32 v[154:155], v[178:179], v[246:247], v[242:243] op_sel:[0,0,0] op_sel_hi:[1,0,0]
v_pk_fma_f32 v[108:109], v[108:109], v[240:241], v[236:237] op_sel:[0,0,1] op_sel_hi:[1,0,1] neg_lo:[1,0,0] neg_hi:[1,0,0]
v_pk_fma_f32 v[110:111], v[110:111], v[240:241], v[236:237] op_sel:[0,0,1] op_sel_hi:[1,0,1] neg_lo:[1,0,0] neg_hi:[1,0,0]
v_pk_fma_f32 v[112:113], v[112:113], v[240:241], v[236:237] op_sel:[0,0,1] op_sel_hi:[1,0,1] neg_lo:[1,0,0] neg_hi:[1,0,0]
v_pk_fma_f32 v[114:115], v[114:115], v[240:241], v[236:237] op_sel:[0,0,1] op_sel_hi:[1,0,1] neg_lo:[1,0,0] neg_hi:[1,0,0]
v_pk_fma_f32 v[172:173], v[172:173], v[246:247], v[242:243] op_sel:[0,0,1] op_sel_hi:[1,0,1] neg_lo:[1,0,0] neg_hi:[1,0,0]
v_pk_fma_f32 v[174:175], v[174:175], v[246:247], v[242:243] op_sel:[0,0,1] op_sel_hi:[1,0,1] neg_lo:[1,0,0] neg_hi:[1,0,0]
v_pk_fma_f32 v[176:177], v[176:177], v[246:247], v[242:243] op_sel:[0,0,1] op_sel_hi:[1,0,1] neg_lo:[1,0,0] neg_hi:[1,0,0]
v_pk_fma_f32 v[178:179], v[178:179], v[246:247], v[242:243] op_sel:[0,0,1] op_sel_hi:[1,0,1] neg_lo:[1,0,0] neg_hi:[1,0,0]
v_exp_f32 v116, v116
v_exp_f32 v108, v108
v_exp_f32 v117, v117
v_exp_f32 v109, v109
v_exp_f32 v118, v118
v_exp_f32 v110, v110
v_exp_f32 v119, v119
v_exp_f32 v111, v111
v_exp_f32 v120, v120
v_exp_f32 v112, v112
v_exp_f32 v121, v121
v_exp_f32 v113, v113
v_exp_f32 v122, v122
v_exp_f32 v114, v114
v_exp_f32 v123, v123
v_exp_f32 v115, v115
v_exp_f32 v148, v148
v_exp_f32 v172, v172
v_exp_f32 v149, v149
v_exp_f32 v173, v173
v_exp_f32 v150, v150
v_exp_f32 v174, v174
v_exp_f32 v151, v151
v_exp_f32 v175, v175
v_exp_f32 v152, v152
v_exp_f32 v176, v176
v_exp_f32 v153, v153
v_exp_f32 v177, v177
v_exp_f32 v154, v154
v_exp_f32 v178, v178
v_exp_f32 v155, v155
v_exp_f32 v179, v179
buffer_load_dwordx4 v1, s[4:7], s44 offen offset:3072 sc1 lds
v_cvt_pk_bf16_f32 v140, v116, v117
v_cvt_pk_bf16_f32 v141, v118, v119
v_cvt_pk_bf16_f32 v142, v120, v121
v_cvt_pk_bf16_f32 v143, v122, v123
v_cvt_pk_bf16_f32 v144, v108, v109
v_cvt_pk_bf16_f32 v145, v110, v111
v_cvt_pk_bf16_f32 v146, v112, v113
v_cvt_pk_bf16_f32 v147, v114, v115
v_cvt_pk_bf16_f32 v164, v148, v149
v_cvt_pk_bf16_f32 v165, v150, v151
v_cvt_pk_bf16_f32 v166, v152, v153
v_cvt_pk_bf16_f32 v167, v154, v155
v_cvt_pk_bf16_f32 v168, v172, v173
v_cvt_pk_bf16_f32 v169, v174, v175
v_cvt_pk_bf16_f32 v170, v176, v177
v_cvt_pk_bf16_f32 v171, v178, v179
s_waitcnt vmcnt(2)
v_readfirstlane_b32 s38, v11
s_nop 0
s_cmp_ge_u32 s38, 8
s_cbranch_scc1 Lpe_19
s_add_u32 s36, s88, 0x80000
s_mov_b32 s37, 0
Lpoll_18:
v_mov_b32 v11, 0
buffer_atomic_add v11, v251, s[4:7], s36 offen sc0 sc1
s_add_u32 s37, s37, 1
s_waitcnt vmcnt(0)
v_readfirstlane_b32 s38, v11
s_nop 0
s_cmp_ge_u32 s38, 8
s_cbranch_scc1 Lpe_19
s_cmp_lt_u32 s37, 0x100000
s_cbranch_scc1 Lpoll_18
Lpe_19:
s_lshl_b32 s37, s30, 2
s_add_u32 s37, s37, s28
s_lshl_b32 s38, s37, 13
s_add_u32 s38, s38, 0x400000
buffer_load_dwordx4 v[48:51], v1, s[4:7], s38 offen offset:0 sc1
v_and_b32 v248, 7, v0
s_add_u32 s36, s38, 4096
s_lshl_b32 s39, s37, 10
v_lshlrev_b32 v248, 7, v248
v_lshrrev_b32 v249, 4, v0
s_add_u32 s39, s39, 0x800000
v_lshl_add_u32 v248, v249, 4, v248
s_lshl_b32 s91, s30, 12
s_add_u32 s91, s91, 0x1e00000
s_add_u32 m0, s19, 131072
s_add_u32 s44, s86, 0xc18000
v_mfma_f32_16x16x32_bf16 v[108:111], a[232:235], v[180:183], 0
buffer_load_dwordx4 v[124:127], v248, s[4:7], s39 offen sc1
v_mfma_f32_16x16x32_bf16 v[220:223], a[232:235], v[204:207], 0
L_stub8:
s_cbranch_execz L_wret2
v_mov_b32 v249, 0x3f80
v_mov_b32 v250, 1.0
v_mfma_f32_16x16x32_bf16 v[112:115], a[236:239], v[180:183], 0
s_nop 2
v_max3_f32 v236, v108, v109, v110
v_max3_f32 v237, -v108, -v109, -v110
v_mfma_f32_16x16x32_bf16 v[224:227], a[236:239], v[204:207], 0
v_max3_f32 v242, v220, v221, v222
v_max3_f32 v243, -v220, -v221, -v222
v_mul_f32 v240, 0x3fb8aa3b, v87
buffer_load_dwordx4 v[52:55], v1, s[4:7], s38 offen offset:1024 sc1
v_max3_f32 v236, v236, v111, v112
v_max3_f32 v237, v237, -v111, -v112
s_nop 1
v_max3_f32 v242, v242, v223, v224
v_max3_f32 v243, v243, -v223, -v224
v_max3_f32 v236, v236, v113, v114
v_max3_f32 v237, v237, -v113, -v114
v_max3_f32 v242, v242, v225, v226
v_max3_f32 v243, v243, -v225, -v226
v_max_f32 v236, v236, v115
v_max_f32_e64 v237, v237, -v115
v_max_f32 v242, v242, v227
v_max_f32_e64 v243, v243, -v227
v_permlane32_swap_b32 v236, v237
buffer_load_dwordx4 v[56:59], v1, s[4:7], s38 offen offset:2048 sc1
v_permlane32_swap_b32 v242, v243
v_max_f32 v236, v236, v237
v_max_f32 v242, v242, v243
v_mov_b32 v238, v236
v_mov_b32 v244, v242
v_mul_f32 v246, 0x3fb8aa3b, v89
v_permlane16_swap_b32 v236, v238
v_permlane16_swap_b32 v242, v244
v_max_f32 v236, v236, v238
v_max_f32 v242, v242, v244
buffer_load_dwordx4 v[60:63], v1, s[4:7], s38 offen offset:3072 sc1
v_mov_b32 v238, v236
v_mov_b32 v244, v242
s_nop 0
v_permlane32_swap_b32 v236, v238
v_permlane32_swap_b32 v242, v244
v_mul_f32_e64 v236, -v236, v240
v_mul_f32_e64 v237, -v238, v240
v_mul_f32_e64 v242, -v242, v246
v_mul_f32_e64 v243, -v244, v246
v_pk_fma_f32 v[116:117], v[108:109], v[240:241], v[236:237] op_sel:[0,0,0] op_sel_hi:[1,0,0]
v_pk_fma_f32 v[118:119], v[110:111], v[240:241], v[236:237] op_sel:[0,0,0] op_sel_hi:[1,0,0]
buffer_load_dwordx4 v[64:67], v1, s[4:7], s36 offen offset:0 sc1
v_pk_fma_f32 v[120:121], v[112:113], v[240:241], v[236:237] op_sel:[0,0,0] op_sel_hi:[1,0,0]
v_pk_fma_f32 v[122:123], v[114:115], v[240:241], v[236:237] op_sel:[0,0,0] op_sel_hi:[1,0,0]
v_pk_fma_f32 v[196:197], v[220:221], v[246:247], v[242:243] op_sel:[0,0,0] op_sel_hi:[1,0,0]
v_pk_fma_f32 v[198:199], v[222:223], v[246:247], v[242:243] op_sel:[0,0,0] op_sel_hi:[1,0,0]
v_pk_fma_f32 v[200:201], v[224:225], v[246:247], v[242:243] op_sel:[0,0,0] op_sel_hi:[1,0,0]
v_pk_fma_f32 v[202:203], v[226:227], v[246:247], v[242:243] op_sel:[0,0,0] op_sel_hi:[1,0,0]
v_pk_fma_f32 v[108:109], v[108:109], v[240:241], v[236:237] op_sel:[0,0,1] op_sel_hi:[1,0,1] neg_lo:[1,0,0] neg_hi:[1,0,0]
v_pk_fma_f32 v[110:111], v[110:111], v[240:241], v[236:237] op_sel:[0,0,1] op_sel_hi:[1,0,1] neg_lo:[1,0,0] neg_hi:[1,0,0]
v_pk_fma_f32 v[112:113], v[112:113], v[240:241], v[236:237] op_sel:[0,0,1] op_sel_hi:[1,0,1] neg_lo:[1,0,0] neg_hi:[1,0,0]
v_pk_fma_f32 v[114:115], v[114:115], v[240:241], v[236:237] op_sel:[0,0,1] op_sel_hi:[1,0,1] neg_lo:[1,0,0] neg_hi:[1,0,0]
v_pk_fma_f32 v[220:221], v[220:221], v[246:247], v[242:243] op_sel:[0,0,1] op_sel_hi:[1,0,1] neg_lo:[1,0,0] neg_hi:[1,0,0]
v_pk_fma_f32 v[222:223], v[222:223], v[246:247], v[242:243] op_sel:[0,0,1] op_sel_hi:[1,0,1] neg_lo:[1,0,0] neg_hi:[1,0,0]
v_pk_fma_f32 v[224:225], v[224:225], v[246:247], v[242:243] op_sel:[0,0,1] op_sel_hi:[1,0,1] neg_lo:[1,0,0] neg_hi:[1,0,0]
buffer_load_dwordx4 v[68:71], v1, s[4:7], s36 offen offset:1024 sc1
v_pk_fma_f32 v[226:227], v[226:227], v[246:247], v[242:243] op_sel:[0,0,1] op_sel_hi:[1,0,1] neg_lo:[1,0,0] neg_hi:[1,0,0]
v_exp_f32 v116, v116
v_exp_f32 v108, v108
v_exp_f32 v117, v117
v_exp_f32 v109, v109
v_exp_f32 v118, v118
v_exp_f32 v110, v110
buffer_load_dwordx4 v[100:103], v1, s[4:7], s36 offen offset:2048 sc1
v_exp_f32 v119, v119
v_exp_f32 v111, v111
v_exp_f32 v120, v120
v_exp_f32 v112, v112
v_exp_f32 v121, v121
v_exp_f32 v113, v113
v_exp_f32 v122, v122
buffer_load_dwordx4 v[104:107], v1, s[4:7], s36 offen offset:3072 sc1
v_exp_f32 v114, v114
v_exp_f32 v123, v123
v_exp_f32 v115, v115
v_exp_f32 v196, v196
v_exp_f32 v220, v220
v_exp_f32 v197, v197
v_exp_f32 v221, v221
buffer_store_dwordx4 a[228:231], v2, s[4:7], s91 offen offset:0 sc1
v_exp_f32 v198, v198
v_exp_f32 v222, v222
v_exp_f32 v199, v199
v_exp_f32 v223, v223
v_exp_f32 v200, v200
v_exp_f32 v224, v224
v_exp_f32 v201, v201
v_exp_f32 v225, v225
v_exp_f32 v202, v202
v_exp_f32 v226, v226
v_exp_f32 v203, v203
v_exp_f32 v227, v227
v_cvt_pk_bf16_f32 v188, v116, v117
v_cvt_pk_bf16_f32 v189, v118, v119
v_cvt_pk_bf16_f32 v190, v120, v121
v_cvt_pk_bf16_f32 v191, v122, v123
v_cvt_pk_bf16_f32 v192, v108, v109
v_cvt_pk_bf16_f32 v193, v110, v111
v_cvt_pk_bf16_f32 v194, v112, v113
v_cvt_pk_bf16_f32 v195, v114, v115
v_cvt_pk_bf16_f32 v212, v196, v197
v_cvt_pk_bf16_f32 v213, v198, v199
buffer_store_dwordx4 a[228:231], v2, s[4:7], s91 offen offset:1024 sc1
v_cvt_pk_bf16_f32 v214, v200, v201
v_cvt_pk_bf16_f32 v215, v202, v203
v_cvt_pk_bf16_f32 v216, v220, v221
v_cvt_pk_bf16_f32 v217, v222, v223
v_cvt_pk_bf16_f32 v218, v224, v225
v_cvt_pk_bf16_f32 v219, v226, v227
s_waitcnt vmcnt(10)
v_lshlrev_b32 v92, 16, v48
v_and_b32 v93, 0xffff0000, v48
v_lshlrev_b32 v94, 16, v49
v_and_b32 v95, 0xffff0000, v49
v_lshlrev_b32 v96, 16, v50
v_and_b32 v97, 0xffff0000, v50
v_lshlrev_b32 v98, 16, v51
v_and_b32 v99, 0xffff0000, v51
s_waitcnt vmcnt(9)
v_add_f32_dpp v128, v124, v124 row_ror:4 row_mask:0xf bank_mask:0xf
v_add_f32_dpp v129, v125, v125 row_ror:4 row_mask:0xf bank_mask:0xf
v_add_f32_dpp v130, v126, v126 row_ror:4 row_mask:0xf bank_mask:0xf
v_add_f32_dpp v131, v127, v127 row_ror:4 row_mask:0xf bank_mask:0xf
v_add_f32_dpp v128, v128, v128 row_ror:2 row_mask:0xf bank_mask:0xf
v_add_f32_dpp v129, v129, v129 row_ror:2 row_mask:0xf bank_mask:0xf
v_add_f32_dpp v130, v130, v130 row_ror:2 row_mask:0xf bank_mask:0xf
buffer_store_dwordx4 a[228:231], v2, s[4:7], s91 offen offset:2048 sc1
v_add_f32_dpp v131, v131, v131 row_ror:2 row_mask:0xf bank_mask:0xf
v_add_f32_dpp v128, v128, v128 row_ror:1 row_mask:0xf bank_mask:0xf
v_add_f32_dpp v129, v129, v129 row_ror:1 row_mask:0xf bank_mask:0xf
v_add_f32_dpp v130, v130, v130 row_ror:1 row_mask:0xf bank_mask:0xf
v_add_f32_dpp v131, v131, v131 row_ror:1 row_mask:0xf bank_mask:0xf
s_waitcnt vmcnt(9)
v_dot2c_f32_bf16 v92, v52, v249
v_dot2c_f32_bf16 v93, v52, v250
v_dot2c_f32_bf16 v94, v53, v249
v_dot2c_f32_bf16 v95, v53, v250
v_dot2c_f32_bf16 v96, v54, v249
v_dot2c_f32_bf16 v97, v54, v250
v_dot2c_f32_bf16 v98, v55, v249
v_dot2c_f32_bf16 v99, v55, v250
v_fma_f32 v135, v129, v130, v131
s_waitcnt vmcnt(8)
v_dot2c_f32_bf16 v92, v56, v249
v_dot2c_f32_bf16 v93, v56, v250
v_dot2c_f32_bf16 v94, v57, v249
v_dot2c_f32_bf16 v95, v57, v250
v_dot2c_f32_bf16 v96, v58, v249
v_dot2c_f32_bf16 v97, v58, v250
v_dot2c_f32_bf16 v98, v59, v249
v_dot2c_f32_bf16 v99, v59, v250
buffer_store_dwordx4 a[228:231], v2, s[4:7], s91 offen offset:3072 sc1
s_waitcnt vmcnt(8)
v_dot2c_f32_bf16 v92, v60, v249
v_dot2c_f32_bf16 v93, v60, v250
v_dot2c_f32_bf16 v94, v61, v249
v_dot2c_f32_bf16 v95, v61, v250
v_dot2c_f32_bf16 v96, v62, v249
v_dot2c_f32_bf16 v97, v62, v250
v_dot2c_f32_bf16 v98, v63, v249
v_dot2c_f32_bf16 v99, v63, v250
s_waitcnt vmcnt(7)
v_dot2c_f32_bf16 v92, v64, v249
v_dot2c_f32_bf16 v93, v64, v250
v_dot2c_f32_bf16 v94, v65, v249
v_dot2c_f32_bf16 v95, v65, v250
v_dot2c_f32_bf16 v96, v66, v249
v_dot2c_f32_bf16 v97, v66, v250
v_dot2c_f32_bf16 v98, v67, v249
v_dot2c_f32_bf16 v99, v67, v250
s_waitcnt vmcnt(6)
v_dot2c_f32_bf16 v92, v68, v249
buffer_load_dwordx4 v1, s[4:7], s44 offen offset:0 sc1 lds
v_dot2c_f32_bf16 v93, v68, v250
v_dot2c_f32_bf16 v94, v69, v249
v_dot2c_f32_bf16 v95, v69, v250
v_dot2c_f32_bf16 v96, v70, v249
v_dot2c_f32_bf16 v97, v70, v250
v_dot2c_f32_bf16 v98, v71, v249
v_dot2c_f32_bf16 v99, v71, v250
s_waitcnt vmcnt(6)
v_dot2c_f32_bf16 v92, v100, v249
buffer_load_dwordx4 v1, s[4:7], s44 offen offset:1024 sc1 lds
v_dot2c_f32_bf16 v93, v100, v250
v_dot2c_f32_bf16 v94, v101, v249
v_dot2c_f32_bf16 v95, v101, v250
v_dot2c_f32_bf16 v96, v102, v249
v_dot2c_f32_bf16 v97, v102, v250
v_dot2c_f32_bf16 v98, v103, v249
v_dot2c_f32_bf16 v99, v103, v250
buffer_load_dwordx4 v1, s[4:7], s44 offen offset:2048 sc1 lds
s_waitcnt vmcnt(7)
v_dot2c_f32_bf16 v92, v104, v249
v_dot2c_f32_bf16 v93, v104, v250
v_dot2c_f32_bf16 v94, v105, v249
v_dot2c_f32_bf16 v95, v105, v250
v_dot2c_f32_bf16 v96, v106, v249
v_dot2c_f32_bf16 v97, v106, v250
v_dot2c_f32_bf16 v98, v107, v249
v_dot2c_f32_bf16 v99, v107, v250
v_fma_f32 v132, v92, v93, v94
v_fma_f32 v133, v95, v96, v97
s_nop 0
v_fma_f32 v134, v98, v99, v128
v_fma_f32 v132, v132, v133, v134
v_cmp_u_f32 vcc, v132, v135
buffer_load_dwordx4 v1, s[4:7], s44 offen offset:3072 sc1 lds
s_cbranch_vccnz L_kvredo1
L_kvback1:
s_lshr_b32 s36, s28, 1
s_and_b32 s37, s28, 1
v_cvt_pk_bf16_f32 v128, v128, v129
v_cvt_pk_bf16_f32 v129, v130, v131
s_mul_i32 s36, s36, 3072
s_lshl_b32 s37, s37, 3
v_cvt_pk_bf16_f32 v92, v92, v93
v_cndmask_b32 v128, 0, v128, s[56:57]
v_cndmask_b32 v129, 0, v129, s[56:57]
s_add_u32 s36, s36, s37
v_cvt_pk_bf16_f32 v93, v94, v95
v_cvt_pk_bf16_f32 v94, v96, v97
v_cvt_pk_bf16_f32 v95, v98, v99
v_cndmask_b32 v128, v128, v16, s[58:59]
v_cndmask_b32 v129, v129, v16, s[58:59]
v_add_u32 v236, s36, v1
s_lshl_b32 s35, s30, 12
ds_write_b64 v236, v[92:93] offset:0
ds_write_b64 v236, v[94:95] offset:1024
ds_write_b64 v236, v[128:129] offset:2048
s_add_u32 s35, s35, 0x2600000
s_add_u32 s94, s71, 0x10080
s_waitcnt lgkmcnt(0)
s_barrier
ds_read_b128 a[8:11], v1 offset:2048
ds_read_b128 a[20:23], v1 offset:5120
ds_read_b128 a[0:3], v1 offset:0
ds_read_b128 a[12:15], v1 offset:3072
ds_read_b128 a[4:7], v1 offset:1024
ds_read_b128 a[16:19], v1 offset:4096
s_waitcnt lgkmcnt(5)
v_mfma_f32_16x16x32_bf16 v[92:95], a[8:11], v[140:143], 0
s_waitcnt lgkmcnt(4)
v_mfma_f32_16x16x32_bf16 v[96:99], a[20:23], v[144:147], 0
s_waitcnt lgkmcnt(3)
v_mfma_f32_16x16x32_bf16 v[132:135], a[0:3], v[140:143], 0
s_nop 3
v_rcp_f32 v94, v93
s_waitcnt lgkmcnt(2)
v_mfma_f32_16x16x32_bf16 v[148:151], a[12:15], v[144:147], 0
v_rcp_f32 v95, v97
v_mul_f32 v92, v92, v94
v_fmac_f32 v92, v96, v95
v_mfma_f32_16x16x32_bf16 v[100:103], a[8:11], v[164:167], 0
v_add_f32 v92, 0x358637bd, v92
v_rcp_f32 v92, v92
s_waitcnt lgkmcnt(1)
v_mfma_f32_16x16x32_bf16 v[136:139], a[4:7], v[140:143], 0
v_mul_f32 v94, v94, v92
v_mul_f32 v95, v95, v92
v_mfma_f32_16x16x32_bf16 v[104:107], a[20:23], v[168:171], 0
v_mul_f32 v132, v132, v94
v_mul_f32 v133, v133, v94
s_waitcnt lgkmcnt(0)
v_mfma_f32_16x16x32_bf16 v[152:155], a[16:19], v[144:147], 0
v_mul_f32 v134, v134, v94
v_mul_f32 v135, v135, v94
v_fmac_f32 v132, v148, v95
v_fmac_f32 v133, v149, v95
v_rcp_f32 v102, v101
v_mul_f32 v136, v136, v94
v_mul_f32 v137, v137, v94
v_mul_f32 v138, v138, v94
v_mul_f32 v139, v139, v94
v_fmac_f32 v134, v150, v95
v_fmac_f32 v135, v151, v95
v_cvt_pk_bf16_f32 v132, v132, v133
v_rcp_f32 v103, v105
v_fmac_f32 v136, v152, v95
v_fmac_f32 v137, v153, v95
v_fmac_f32 v138, v154, v95
v_fmac_f32 v139, v155, v95
v_cvt_pk_bf16_f32 v133, v134, v135
v_cvt_pk_bf16_f32 v134, v136, v137
v_cvt_pk_bf16_f32 v135, v138, v139
v_mul_f32 v100, v100, v102
v_mfma_f32_16x16x32_bf16 v[156:159], a[0:3], v[164:167], 0
buffer_store_dwordx4 v[132:135], v2, s[4:7], s35 offen offset:0 sc1
v_fmac_f32 v100, v104, v103
v_mfma_f32_16x16x32_bf16 v[172:175], a[12:15], v[168:171], 0
v_add_f32 v100, 0x358637bd, v100
v_rcp_f32 v100, v100
v_mfma_f32_16x16x32_bf16 v[108:111], a[8:11], v[188:191], 0
v_mul_f32 v102, v102, v100
v_mul_f32 v103, v103, v100
v_mfma_f32_16x16x32_bf16 v[160:163], a[4:7], v[164:167], 0
v_mul_f32 v156, v156, v102
v_mul_f32 v157, v157, v102
v_mfma_f32_16x16x32_bf16 v[112:115], a[20:23], v[192:195], 0
v_mul_f32 v158, v158, v102
v_mul_f32 v159, v159, v102
v_mfma_f32_16x16x32_bf16 v[176:179], a[16:19], v[168:171], 0
v_fmac_f32 v156, v172, v103
v_fmac_f32 v157, v173, v103
v_rcp_f32 v110, v109
v_mul_f32 v160, v160, v102
v_mul_f32 v161, v161, v102
v_mul_f32 v162, v162, v102
v_mul_f32 v163, v163, v102
v_fmac_f32 v158, v174, v103
v_fmac_f32 v159, v175, v103
v_cvt_pk_bf16_f32 v156, v156, v157
v_rcp_f32 v111, v113
v_fmac_f32 v160, v176, v103
v_fmac_f32 v161, v177, v103
v_fmac_f32 v162, v178, v103
v_fmac_f32 v163, v179, v103
v_cvt_pk_bf16_f32 v157, v158, v159
v_cvt_pk_bf16_f32 v158, v160, v161
v_cvt_pk_bf16_f32 v159, v162, v163
v_mul_f32 v108, v108, v110
v_mfma_f32_16x16x32_bf16 v[180:183], a[0:3], v[188:191], 0
buffer_store_dwordx4 v[156:159], v2, s[4:7], s35 offen offset:1024 sc1
v_fmac_f32 v108, v112, v111
v_mfma_f32_16x16x32_bf16 v[196:199], a[12:15], v[192:195], 0
v_add_f32 v108, 0x358637bd, v108
v_rcp_f32 v108, v108
v_mfma_f32_16x16x32_bf16 v[116:119], a[8:11], v[212:215], 0
v_mul_f32 v110, v110, v108
v_mul_f32 v111, v111, v108
v_mfma_f32_16x16x32_bf16 v[184:187], a[4:7], v[188:191], 0
v_mul_f32 v180, v180, v110
v_mul_f32 v181, v181, v110
v_mfma_f32_16x16x32_bf16 v[120:123], a[20:23], v[216:219], 0
v_mul_f32 v182, v182, v110
v_mul_f32 v183, v183, v110
v_mfma_f32_16x16x32_bf16 v[200:203], a[16:19], v[192:195], 0
v_fmac_f32 v180, v196, v111
v_fmac_f32 v181, v197, v111
v_rcp_f32 v118, v117
v_mul_f32 v184, v184, v110
v_mul_f32 v185, v185, v110
v_mul_f32 v186, v186, v110
v_mul_f32 v187, v187, v110
v_fmac_f32 v182, v198, v111
v_fmac_f32 v183, v199, v111
v_cvt_pk_bf16_f32 v180, v180, v181
v_rcp_f32 v119, v121
buffer_atomic_add v12, v10, s[4:7], s94 offen sc1
v_fmac_f32 v184, v200, v111
v_fmac_f32 v185, v201, v111
v_fmac_f32 v186, v202, v111
v_fmac_f32 v187, v203, v111
v_cvt_pk_bf16_f32 v181, v182, v183
v_cvt_pk_bf16_f32 v182, v184, v185
v_cvt_pk_bf16_f32 v183, v186, v187
v_mul_f32 v116, v116, v118
v_mfma_f32_16x16x32_bf16 v[204:207], a[0:3], v[212:215], 0
buffer_store_dwordx4 v[180:183], v2, s[4:7], s35 offen offset:2048 sc1
v_fmac_f32 v116, v120, v119
v_mfma_f32_16x16x32_bf16 v[220:223], a[12:15], v[216:219], 0
v_add_f32 v116, 0x358637bd, v116
v_rcp_f32 v116, v116
v_mfma_f32_16x16x32_bf16 v[208:211], a[4:7], v[212:215], 0
v_mul_f32 v118, v118, v116
v_mul_f32 v119, v119, v116
v_mfma_f32_16x16x32_bf16 v[224:227], a[16:19], v[216:219], 0
v_mul_f32 v204, v204, v118
v_mul_f32 v205, v205, v118
v_mul_f32 v206, v206, v118
v_mul_f32 v207, v207, v118
v_fmac_f32 v204, v220, v119
v_fmac_f32 v205, v221, v119
v_mul_f32 v208, v208, v118
v_mul_f32 v209, v209, v118
v_mul_f32 v210, v210, v118
v_mul_f32 v211, v211, v118
v_fmac_f32 v206, v222, v119
v_fmac_f32 v207, v223, v119
v_cvt_pk_bf16_f32 v204, v204, v205
v_fmac_f32 v208, v224, v119
v_fmac_f32 v209, v225, v119
v_fmac_f32 v210, v226, v119
v_fmac_f32 v211, v227, v119
v_cvt_pk_bf16_f32 v205, v206, v207
v_cvt_pk_bf16_f32 v206, v208, v209
v_cvt_pk_bf16_f32 v207, v210, v211
buffer_store_dwordx4 v[204:207], v2, s[4:7], s35 offen offset:3072 sc1
s_add_u32 s92, s71, 0x10000
s_add_u32 s36, s66, 0x10080
s_add_u32 s40, s4, 0x2600000
s_addc_u32 s41, s5, 0
v_add_u32 v5, 32768, v1
v_add_u32 v6, 98304, v1
s_cmp_eq_u32 s3, 0
s_cselect_b32 s35, 8, 0
s_lshl_b32 s35, s35, 12
v_lshlrev_b32 v132, 16, v32
v_and_b32 v133, 0xffff0000, v32
v_lshlrev_b32 v134, 16, v33
v_and_b32 v135, 0xffff0000, v33
v_lshlrev_b32 v136, 16, v34
v_and_b32 v137, 0xffff0000, v34
v_lshlrev_b32 v138, 16, v35
v_and_b32 v139, 0xffff0000, v35
v_lshlrev_b32 v140, 16, v36
v_and_b32 v141, 0xffff0000, v36
v_lshlrev_b32 v142, 16, v37
v_and_b32 v143, 0xffff0000, v37
v_lshlrev_b32 v144, 16, v38
v_and_b32 v145, 0xffff0000, v38
v_lshlrev_b32 v146, 16, v39
v_and_b32 v147, 0xffff0000, v39
v_lshlrev_b32 v148, 16, v40
v_and_b32 v149, 0xffff0000, v40
v_lshlrev_b32 v150, 16, v41
v_and_b32 v151, 0xffff0000, v41
v_lshlrev_b32 v152, 16, v42
v_and_b32 v153, 0xffff0000, v42
v_lshlrev_b32 v154, 16, v43
v_and_b32 v155, 0xffff0000, v43
v_lshlrev_b32 v156, 16, v44
v_and_b32 v157, 0xffff0000, v44
v_lshlrev_b32 v158, 16, v45
v_and_b32 v159, 0xffff0000, v45
v_lshlrev_b32 v160, 16, v46
v_and_b32 v161, 0xffff0000, v46
v_lshlrev_b32 v162, 16, v47
v_and_b32 v163, 0xffff0000, v47
s_mov_b32 s95, -1
s_cmp_lg_u32 s28, 3
s_cbranch_scc1 L_wskip3
s_mov_b64 exec, 0
s_branch L_stub9
L_wret3:
s_mov_b64 exec, -1
L_wskip3:
s_cmp_lg_u32 s28, 0
s_cbranch_scc1 Lpe_21
s_add_u32 s36, s66, 0x10080
s_mov_b32 s37, 0
Lpoll_20:
v_mov_b32 v11, 0
buffer_atomic_add v11, v251, s[4:7], s36 offen sc0 sc1
s_add_u32 s37, s37, 1
s_waitcnt vmcnt(0)
v_readfirstlane_b32 s38, v11
s_nop 0
s_cmp_ge_u32 s38, 32
s_cbranch_scc1 Lpe_21
s_cmp_lt_u32 s37, 0x100000
s_cbranch_scc1 Lpoll_20
Lpe_21:
s_waitcnt vmcnt(0)
s_barrier
L_k2go1:
buffer_load_dwordx4 a[0:3], v4, s[40:43], s35 offen offset:0 sc1
buffer_load_dwordx4 a[4:7], v4, s[40:43], s35 offen offset:1024 sc1
s_cmp_eq_u32 s3, 1
s_cselect_b32 s35, 9, 1
s_lshl_b32 s35, s35, 12
buffer_load_dwordx4 a[8:11], v4, s[40:43], s35 offen offset:0 sc1
buffer_load_dwordx4 a[12:15], v4, s[40:43], s35 offen offset:1024 sc1
s_cmp_eq_u32 s3, 2
s_cselect_b32 s35, 10, 2
s_lshl_b32 s35, s35, 12
buffer_load_dwordx4 a[16:19], v4, s[40:43], s35 offen offset:0 sc1
buffer_load_dwordx4 a[20:23], v4, s[40:43], s35 offen offset:1024 sc1
s_cmp_eq_u32 s3, 3
s_cselect_b32 s35, 11, 3
s_lshl_b32 s35, s35, 12
buffer_load_dwordx4 a[24:27], v4, s[40:43], s35 offen offset:0 sc1
buffer_load_dwordx4 a[28:31], v4, s[40:43], s35 offen offset:1024 sc1
s_cmp_eq_u32 s3, 4
s_cselect_b32 s35, 12, 4
s_lshl_b32 s35, s35, 12
buffer_load_dwordx4 a[32:35], v4, s[40:43], s35 offen offset:0 sc1
buffer_load_dwordx4 a[36:39], v4, s[40:43], s35 offen offset:1024 sc1
s_cmp_eq_u32 s3, 5
s_cselect_b32 s35, 13, 5
s_lshl_b32 s35, s35, 12
ds_read_b128 a[96:99], v5 offset:0
ds_read_b128 a[100:103], v5 offset:1024
ds_read_b128 a[104:107], v5 offset:2048
ds_read_b128 a[108:111], v5 offset:3072
ds_read_b128 a[112:115], v5 offset:4096
ds_read_b128 a[116:119], v5 offset:5120
ds_read_b128 a[120:123], v5 offset:6144
ds_read_b128 a[124:127], v5 offset:7168
s_waitcnt vmcnt(8) lgkmcnt(4)
v_mfma_f32_16x16x32_bf16 v[132:135], a[96:99], a[0:3], v[132:135]
ds_read_b128 a[128:131], v5 offset:8192
v_mfma_f32_16x16x32_bf16 v[148:151], a[96:99], a[4:7], v[148:151]
ds_read_b128 a[132:135], v5 offset:9216
v_mfma_f32_16x16x32_bf16 v[152:155], a[100:103], a[4:7], v[152:155]
buffer_load_dwordx4 a[40:43], v4, s[40:43], s35 offen offset:0 sc1
v_mfma_f32_16x16x32_bf16 v[136:139], a[100:103], a[0:3], v[136:139]
ds_read_b128 a[136:139], v5 offset:10240
v_mfma_f32_16x16x32_bf16 v[140:143], a[104:107], a[0:3], v[140:143]
ds_read_b128 a[140:143], v5 offset:11264
v_mfma_f32_16x16x32_bf16 v[156:159], a[104:107], a[4:7], v[156:159]
v_mfma_f32_16x16x32_bf16 v[160:163], a[108:111], a[4:7], v[160:163]
buffer_load_dwordx4 a[44:47], v4, s[40:43], s35 offen offset:1024 sc1
v_mfma_f32_16x16x32_bf16 v[144:147], a[108:111], a[0:3], v[144:147]
s_waitcnt vmcnt(8) lgkmcnt(4)
v_mfma_f32_16x16x32_bf16 v[132:135], a[112:115], a[8:11], v[132:135]
s_cmp_eq_u32 s3, 6
s_cselect_b32 s35, 14, 6
s_lshl_b32 s35, s35, 12
v_mfma_f32_16x16x32_bf16 v[148:151], a[112:115], a[12:15], v[148:151]
ds_read_b128 a[96:99], v5 offset:12288
v_mfma_f32_16x16x32_bf16 v[152:155], a[116:119], a[12:15], v[152:155]
buffer_load_dwordx4 a[0:3], v4, s[40:43], s35 offen offset:0 sc1
v_mfma_f32_16x16x32_bf16 v[136:139], a[116:119], a[8:11], v[136:139]
ds_read_b128 a[100:103], v5 offset:13312
v_mfma_f32_16x16x32_bf16 v[140:143], a[120:123], a[8:11], v[140:143]
ds_read_b128 a[104:107], v5 offset:14336
v_mfma_f32_16x16x32_bf16 v[156:159], a[120:123], a[12:15], v[156:159]
ds_read_b128 a[108:111], v5 offset:15360
v_mfma_f32_16x16x32_bf16 v[160:163], a[124:127], a[12:15], v[160:163]
buffer_load_dwordx4 a[4:7], v4, s[40:43], s35 offen offset:1024 sc1
v_mfma_f32_16x16x32_bf16 v[144:147], a[124:127], a[8:11], v[144:147]
s_waitcnt vmcnt(8) lgkmcnt(4)
v_mfma_f32_16x16x32_bf16 v[132:135], a[128:131], a[16:19], v[132:135]
s_cmp_eq_u32 s3, 7
s_cselect_b32 s35, 15, 7
s_lshl_b32 s35, s35, 12
v_mfma_f32_16x16x32_bf16 v[148:151], a[128:131], a[20:23], v[148:151]
ds_read_b128 a[112:115], v5 offset:16384
v_mfma_f32_16x16x32_bf16 v[152:155], a[132:135], a[20:23], v[152:155]
buffer_load_dwordx4 a[8:11], v4, s[40:43], s35 offen offset:0 sc1
v_mfma_f32_16x16x32_bf16 v[136:139], a[132:135], a[16:19], v[136:139]
ds_read_b128 a[116:119], v5 offset:17408
v_mfma_f32_16x16x32_bf16 v[140:143], a[136:139], a[16:19], v[140:143]
ds_read_b128 a[120:123], v5 offset:18432
v_mfma_f32_16x16x32_bf16 v[156:159], a[136:139], a[20:23], v[156:159]
ds_read_b128 a[124:127], v5 offset:19456
v_mfma_f32_16x16x32_bf16 v[160:163], a[140:143], a[20:23], v[160:163]
buffer_load_dwordx4 a[12:15], v4, s[40:43], s35 offen offset:1024 sc1
v_mfma_f32_16x16x32_bf16 v[144:147], a[140:143], a[16:19], v[144:147]
s_waitcnt vmcnt(8) lgkmcnt(4)
v_mfma_f32_16x16x32_bf16 v[132:135], a[96:99], a[24:27], v[132:135]
s_cmp_eq_u32 s3, 0
s_cselect_b32 s35, 16, 8
s_lshl_b32 s35, s35, 12
v_mfma_f32_16x16x32_bf16 v[148:151], a[96:99], a[28:31], v[148:151]
ds_read_b128 a[128:131], v5 offset:20480
v_mfma_f32_16x16x32_bf16 v[152:155], a[100:103], a[28:31], v[152:155]
buffer_load_dwordx4 a[16:19], v4, s[40:43], s35 offen offset:0 sc1
v_mfma_f32_16x16x32_bf16 v[136:139], a[100:103], a[24:27], v[136:139]
ds_read_b128 a[132:135], v5 offset:21504
v_mfma_f32_16x16x32_bf16 v[140:143], a[104:107], a[24:27], v[140:143]
ds_read_b128 a[136:139], v5 offset:22528
v_mfma_f32_16x16x32_bf16 v[156:159], a[104:107], a[28:31], v[156:159]
ds_read_b128 a[140:143], v5 offset:23552
v_mfma_f32_16x16x32_bf16 v[160:163], a[108:111], a[28:31], v[160:163]
buffer_load_dwordx4 a[20:23], v4, s[40:43], s35 offen offset:1024 sc1
v_mfma_f32_16x16x32_bf16 v[144:147], a[108:111], a[24:27], v[144:147]
s_waitcnt vmcnt(8) lgkmcnt(4)
v_mfma_f32_16x16x32_bf16 v[132:135], a[112:115], a[32:35], v[132:135]
s_cmp_eq_u32 s3, 1
s_cselect_b32 s35, 17, 9
s_lshl_b32 s35, s35, 12
v_mfma_f32_16x16x32_bf16 v[148:151], a[112:115], a[36:39], v[148:151]
ds_read_b128 a[96:99], v5 offset:24576
v_mfma_f32_16x16x32_bf16 v[152:155], a[116:119], a[36:39], v[152:155]
buffer_load_dwordx4 a[24:27], v4, s[40:43], s35 offen offset:0 sc1
v_mfma_f32_16x16x32_bf16 v[136:139], a[116:119], a[32:35], v[136:139]
ds_read_b128 a[100:103], v5 offset:25600
v_mfma_f32_16x16x32_bf16 v[140:143], a[120:123], a[32:35], v[140:143]
ds_read_b128 a[104:107], v5 offset:26624
v_mfma_f32_16x16x32_bf16 v[156:159], a[120:123], a[36:39], v[156:159]
ds_read_b128 a[108:111], v5 offset:27648
v_mfma_f32_16x16x32_bf16 v[160:163], a[124:127], a[36:39], v[160:163]
buffer_load_dwordx4 a[28:31], v4, s[40:43], s35 offen offset:1024 sc1
v_mfma_f32_16x16x32_bf16 v[144:147], a[124:127], a[32:35], v[144:147]
s_waitcnt vmcnt(8) lgkmcnt(4)
v_mfma_f32_16x16x32_bf16 v[132:135], a[128:131], a[40:43], v[132:135]
s_cmp_eq_u32 s3, 2
s_cselect_b32 s35, 18, 10
s_lshl_b32 s35, s35, 12
v_mfma_f32_16x16x32_bf16 v[148:151], a[128:131], a[44:47], v[148:151]
ds_read_b128 a[112:115], v5 offset:28672
v_mfma_f32_16x16x32_bf16 v[152:155], a[132:135], a[44:47], v[152:155]
buffer_load_dwordx4 a[32:35], v4, s[40:43], s35 offen offset:0 sc1
v_mfma_f32_16x16x32_bf16 v[136:139], a[132:135], a[40:43], v[136:139]
ds_read_b128 a[116:119], v5 offset:29696
v_mfma_f32_16x16x32_bf16 v[140:143], a[136:139], a[40:43], v[140:143]
ds_read_b128 a[120:123], v5 offset:30720
v_mfma_f32_16x16x32_bf16 v[156:159], a[136:139], a[44:47], v[156:159]
ds_read_b128 a[124:127], v5 offset:31744
v_mfma_f32_16x16x32_bf16 v[160:163], a[140:143], a[44:47], v[160:163]
buffer_load_dwordx4 a[36:39], v4, s[40:43], s35 offen offset:1024 sc1
v_mfma_f32_16x16x32_bf16 v[144:147], a[140:143], a[40:43], v[144:147]
s_waitcnt vmcnt(8) lgkmcnt(4)
v_mfma_f32_16x16x32_bf16 v[132:135], a[96:99], a[0:3], v[132:135]
s_cmp_eq_u32 s3, 3
s_cselect_b32 s35, 19, 11
s_lshl_b32 s35, s35, 12
v_mfma_f32_16x16x32_bf16 v[148:151], a[96:99], a[4:7], v[148:151]
ds_read_b128 a[128:131], v5 offset:32768
v_mfma_f32_16x16x32_bf16 v[152:155], a[100:103], a[4:7], v[152:155]
buffer_load_dwordx4 a[40:43], v4, s[40:43], s35 offen offset:0 sc1
v_mfma_f32_16x16x32_bf16 v[136:139], a[100:103], a[0:3], v[136:139]
ds_read_b128 a[132:135], v5 offset:33792
v_mfma_f32_16x16x32_bf16 v[140:143], a[104:107], a[0:3], v[140:143]
ds_read_b128 a[136:139], v5 offset:34816
v_mfma_f32_16x16x32_bf16 v[156:159], a[104:107], a[4:7], v[156:159]
ds_read_b128 a[140:143], v5 offset:35840
v_mfma_f32_16x16x32_bf16 v[160:163], a[108:111], a[4:7], v[160:163]
buffer_load_dwordx4 a[44:47], v4, s[40:43], s35 offen offset:1024 sc1
v_mfma_f32_16x16x32_bf16 v[144:147], a[108:111], a[0:3], v[144:147]
s_waitcnt vmcnt(8) lgkmcnt(4)
v_mfma_f32_16x16x32_bf16 v[132:135], a[112:115], a[8:11], v[132:135]
s_cmp_eq_u32 s3, 4
s_cselect_b32 s35, 20, 12
s_lshl_b32 s35, s35, 12
v_mfma_f32_16x16x32_bf16 v[148:151], a[112:115], a[12:15], v[148:151]
ds_read_b128 a[96:99], v5 offset:36864
v_mfma_f32_16x16x32_bf16 v[152:155], a[116:119], a[12:15], v[152:155]
buffer_load_dwordx4 a[0:3], v4, s[40:43], s35 offen offset:0 sc1
v_mfma_f32_16x16x32_bf16 v[136:139], a[116:119], a[8:11], v[136:139]
ds_read_b128 a[100:103], v5 offset:37888
v_mfma_f32_16x16x32_bf16 v[140:143], a[120:123], a[8:11], v[140:143]
ds_read_b128 a[104:107], v5 offset:38912
v_mfma_f32_16x16x32_bf16 v[156:159], a[120:123], a[12:15], v[156:159]
ds_read_b128 a[108:111], v5 offset:39936
v_mfma_f32_16x16x32_bf16 v[160:163], a[124:127], a[12:15], v[160:163]
buffer_load_dwordx4 a[4:7], v4, s[40:43], s35 offen offset:1024 sc1
v_mfma_f32_16x16x32_bf16 v[144:147], a[124:127], a[8:11], v[144:147]
s_waitcnt vmcnt(8) lgkmcnt(4)
v_mfma_f32_16x16x32_bf16 v[132:135], a[128:131], a[16:19], v[132:135]
s_cmp_eq_u32 s3, 5
s_cselect_b32 s35, 21, 13
s_lshl_b32 s35, s35, 12
v_mfma_f32_16x16x32_bf16 v[148:151], a[128:131], a[20:23], v[148:151]
ds_read_b128 a[112:115], v5 offset:40960
v_mfma_f32_16x16x32_bf16 v[152:155], a[132:135], a[20:23], v[152:155]
buffer_load_dwordx4 a[8:11], v4, s[40:43], s35 offen offset:0 sc1
v_mfma_f32_16x16x32_bf16 v[136:139], a[132:135], a[16:19], v[136:139]
ds_read_b128 a[116:119], v5 offset:41984
v_mfma_f32_16x16x32_bf16 v[140:143], a[136:139], a[16:19], v[140:143]
ds_read_b128 a[120:123], v5 offset:43008
v_mfma_f32_16x16x32_bf16 v[156:159], a[136:139], a[20:23], v[156:159]
ds_read_b128 a[124:127], v5 offset:44032
v_mfma_f32_16x16x32_bf16 v[160:163], a[140:143], a[20:23], v[160:163]
buffer_load_dwordx4 a[12:15], v4, s[40:43], s35 offen offset:1024 sc1
v_mfma_f32_16x16x32_bf16 v[144:147], a[140:143], a[16:19], v[144:147]
s_waitcnt vmcnt(8) lgkmcnt(4)
v_mfma_f32_16x16x32_bf16 v[132:135], a[96:99], a[24:27], v[132:135]
s_cmp_eq_u32 s3, 6
s_cselect_b32 s35, 22, 14
s_lshl_b32 s35, s35, 12
v_mfma_f32_16x16x32_bf16 v[148:151], a[96:99], a[28:31], v[148:151]
ds_read_b128 a[128:131], v5 offset:45056
v_mfma_f32_16x16x32_bf16 v[152:155], a[100:103], a[28:31], v[152:155]
buffer_load_dwordx4 a[16:19], v4, s[40:43], s35 offen offset:0 sc1
v_mfma_f32_16x16x32_bf16 v[136:139], a[100:103], a[24:27], v[136:139]
ds_read_b128 a[132:135], v5 offset:46080
v_mfma_f32_16x16x32_bf16 v[140:143], a[104:107], a[24:27], v[140:143]
ds_read_b128 a[136:139], v5 offset:47104
v_mfma_f32_16x16x32_bf16 v[156:159], a[104:107], a[28:31], v[156:159]
ds_read_b128 a[140:143], v5 offset:48128
v_mfma_f32_16x16x32_bf16 v[160:163], a[108:111], a[28:31], v[160:163]
buffer_load_dwordx4 a[20:23], v4, s[40:43], s35 offen offset:1024 sc1
v_mfma_f32_16x16x32_bf16 v[144:147], a[108:111], a[24:27], v[144:147]
s_waitcnt vmcnt(8) lgkmcnt(4)
v_mfma_f32_16x16x32_bf16 v[132:135], a[112:115], a[32:35], v[132:135]
s_cmp_eq_u32 s3, 7
s_cselect_b32 s35, 23, 15
s_lshl_b32 s35, s35, 12
v_mfma_f32_16x16x32_bf16 v[148:151], a[112:115], a[36:39], v[148:151]
ds_read_b128 a[96:99], v5 offset:49152
v_mfma_f32_16x16x32_bf16 v[152:155], a[116:119], a[36:39], v[152:155]
buffer_load_dwordx4 a[24:27], v4, s[40:43], s35 offen offset:0 sc1
L_stub9:
s_cbranch_execz L_wret3
v_mfma_f32_16x16x32_bf16 v[136:139], a[116:119], a[32:35], v[136:139]
ds_read_b128 a[100:103], v5 offset:50176
v_mfma_f32_16x16x32_bf16 v[140:143], a[120:123], a[32:35], v[140:143]
ds_read_b128 a[104:107], v5 offset:51200
v_mfma_f32_16x16x32_bf16 v[156:159], a[120:123], a[36:39], v[156:159]
ds_read_b128 a[108:111], v5 offset:52224
v_mfma_f32_16x16x32_bf16 v[160:163], a[124:127], a[36:39], v[160:163]
buffer_load_dwordx4 a[28:31], v4, s[40:43], s35 offen offset:1024 sc1
v_mfma_f32_16x16x32_bf16 v[144:147], a[124:127], a[32:35], v[144:147]
s_waitcnt vmcnt(8) lgkmcnt(4)
v_mfma_f32_16x16x32_bf16 v[132:135], a[128:131], a[40:43], v[132:135]
s_cmp_eq_u32 s3, 0
s_cselect_b32 s35, 24, 16
s_lshl_b32 s35, s35, 12
v_mfma_f32_16x16x32_bf16 v[148:151], a[128:131], a[44:47], v[148:151]
ds_read_b128 a[112:115], v5 offset:53248
v_mfma_f32_16x16x32_bf16 v[152:155], a[132:135], a[44:47], v[152:155]
buffer_load_dwordx4 a[32:35], v4, s[40:43], s35 offen offset:0 sc1
v_mfma_f32_16x16x32_bf16 v[136:139], a[132:135], a[40:43], v[136:139]
ds_read_b128 a[116:119], v5 offset:54272
v_mfma_f32_16x16x32_bf16 v[140:143], a[136:139], a[40:43], v[140:143]
ds_read_b128 a[120:123], v5 offset:55296
v_mfma_f32_16x16x32_bf16 v[156:159], a[136:139], a[44:47], v[156:159]
ds_read_b128 a[124:127], v5 offset:56320
v_mfma_f32_16x16x32_bf16 v[160:163], a[140:143], a[44:47], v[160:163]
buffer_load_dwordx4 a[36:39], v4, s[40:43], s35 offen offset:1024 sc1
v_mfma_f32_16x16x32_bf16 v[144:147], a[140:143], a[40:43], v[144:147]
s_waitcnt vmcnt(8) lgkmcnt(4)
v_mfma_f32_16x16x32_bf16 v[132:135], a[96:99], a[0:3], v[132:135]
s_cmp_eq_u32 s3, 1
s_cselect_b32 s35, 25, 17
s_lshl_b32 s35, s35, 12
v_mfma_f32_16x16x32_bf16 v[148:151], a[96:99], a[4:7], v[148:151]
ds_read_b128 a[128:131], v5 offset:57344
v_mfma_f32_16x16x32_bf16 v[152:155], a[100:103], a[4:7], v[152:155]
buffer_load_dwordx4 a[40:43], v4, s[40:43], s35 offen offset:0 sc1
v_mfma_f32_16x16x32_bf16 v[136:139], a[100:103], a[0:3], v[136:139]
ds_read_b128 a[132:135], v5 offset:58368
v_mfma_f32_16x16x32_bf16 v[140:143], a[104:107], a[0:3], v[140:143]
ds_read_b128 a[136:139], v5 offset:59392
v_mfma_f32_16x16x32_bf16 v[156:159], a[104:107], a[4:7], v[156:159]
ds_read_b128 a[140:143], v5 offset:60416
v_mfma_f32_16x16x32_bf16 v[160:163], a[108:111], a[4:7], v[160:163]
buffer_load_dwordx4 a[44:47], v4, s[40:43], s35 offen offset:1024 sc1
v_mfma_f32_16x16x32_bf16 v[144:147], a[108:111], a[0:3], v[144:147]
s_waitcnt vmcnt(8) lgkmcnt(4)
v_mfma_f32_16x16x32_bf16 v[132:135], a[112:115], a[8:11], v[132:135]
s_cmp_eq_u32 s3, 2
s_cselect_b32 s35, 26, 18
s_lshl_b32 s35, s35, 12
v_mfma_f32_16x16x32_bf16 v[148:151], a[112:115], a[12:15], v[148:151]
ds_read_b128 a[96:99], v5 offset:61440
v_mfma_f32_16x16x32_bf16 v[152:155], a[116:119], a[12:15], v[152:155]
buffer_load_dwordx4 a[0:3], v4, s[40:43], s35 offen offset:0 sc1
v_mfma_f32_16x16x32_bf16 v[136:139], a[116:119], a[8:11], v[136:139]
ds_read_b128 a[100:103], v5 offset:62464
v_mfma_f32_16x16x32_bf16 v[140:143], a[120:123], a[8:11], v[140:143]
ds_read_b128 a[104:107], v5 offset:63488
v_mfma_f32_16x16x32_bf16 v[156:159], a[120:123], a[12:15], v[156:159]
ds_read_b128 a[108:111], v5 offset:64512
v_mfma_f32_16x16x32_bf16 v[160:163], a[124:127], a[12:15], v[160:163]
buffer_load_dwordx4 a[4:7], v4, s[40:43], s35 offen offset:1024 sc1
v_mfma_f32_16x16x32_bf16 v[144:147], a[124:127], a[8:11], v[144:147]
s_waitcnt vmcnt(8) lgkmcnt(4)
v_mfma_f32_16x16x32_bf16 v[132:135], a[128:131], a[16:19], v[132:135]
s_cmp_eq_u32 s3, 3
s_cselect_b32 s35, 27, 19
s_lshl_b32 s35, s35, 12
v_mfma_f32_16x16x32_bf16 v[148:151], a[128:131], a[20:23], v[148:151]
ds_read_b128 a[112:115], v6 offset:0
v_mfma_f32_16x16x32_bf16 v[152:155], a[132:135], a[20:23], v[152:155]
buffer_load_dwordx4 a[8:11], v4, s[40:43], s35 offen offset:0 sc1
v_mfma_f32_16x16x32_bf16 v[136:139], a[132:135], a[16:19], v[136:139]
ds_read_b128 a[116:119], v6 offset:1024
v_mfma_f32_16x16x32_bf16 v[140:143], a[136:139], a[16:19], v[140:143]
ds_read_b128 a[120:123], v6 offset:2048
v_mfma_f32_16x16x32_bf16 v[156:159], a[136:139], a[20:23], v[156:159]
ds_read_b128 a[124:127], v6 offset:3072
v_mfma_f32_16x16x32_bf16 v[160:163], a[140:143], a[20:23], v[160:163]
buffer_load_dwordx4 a[12:15], v4, s[40:43], s35 offen offset:1024 sc1
v_mfma_f32_16x16x32_bf16 v[144:147], a[140:143], a[16:19], v[144:147]
s_waitcnt vmcnt(8) lgkmcnt(4)
v_mfma_f32_16x16x32_bf16 v[132:135], a[96:99], a[24:27], v[132:135]
s_cmp_eq_u32 s3, 4
s_cselect_b32 s35, 28, 20
s_lshl_b32 s35, s35, 12
v_mfma_f32_16x16x32_bf16 v[148:151], a[96:99], a[28:31], v[148:151]
ds_read_b128 a[128:131], v6 offset:4096
v_mfma_f32_16x16x32_bf16 v[152:155], a[100:103], a[28:31], v[152:155]
buffer_load_dwordx4 a[16:19], v4, s[40:43], s35 offen offset:0 sc1
v_mfma_f32_16x16x32_bf16 v[136:139], a[100:103], a[24:27], v[136:139]
ds_read_b128 a[132:135], v6 offset:5120
v_mfma_f32_16x16x32_bf16 v[140:143], a[104:107], a[24:27], v[140:143]
ds_read_b128 a[136:139], v6 offset:6144
v_mfma_f32_16x16x32_bf16 v[156:159], a[104:107], a[28:31], v[156:159]
ds_read_b128 a[140:143], v6 offset:7168
v_mfma_f32_16x16x32_bf16 v[160:163], a[108:111], a[28:31], v[160:163]
buffer_load_dwordx4 a[20:23], v4, s[40:43], s35 offen offset:1024 sc1
v_mfma_f32_16x16x32_bf16 v[144:147], a[108:111], a[24:27], v[144:147]
s_waitcnt vmcnt(8) lgkmcnt(4)
v_mfma_f32_16x16x32_bf16 v[132:135], a[112:115], a[32:35], v[132:135]
s_cmp_eq_u32 s3, 5
s_cselect_b32 s35, 29, 21
s_lshl_b32 s35, s35, 12
v_mfma_f32_16x16x32_bf16 v[148:151], a[112:115], a[36:39], v[148:151]
ds_read_b128 a[96:99], v6 offset:8192
v_mfma_f32_16x16x32_bf16 v[152:155], a[116:119], a[36:39], v[152:155]
buffer_load_dwordx4 a[24:27], v4, s[40:43], s35 offen offset:0 sc1
v_mfma_f32_16x16x32_bf16 v[136:139], a[116:119], a[32:35], v[136:139]
ds_read_b128 a[100:103], v6 offset:9216
v_mfma_f32_16x16x32_bf16 v[140:143], a[120:123], a[32:35], v[140:143]
ds_read_b128 a[104:107], v6 offset:10240
v_mfma_f32_16x16x32_bf16 v[156:159], a[120:123], a[36:39], v[156:159]
ds_read_b128 a[108:111], v6 offset:11264
v_mfma_f32_16x16x32_bf16 v[160:163], a[124:127], a[36:39], v[160:163]
buffer_load_dwordx4 a[28:31], v4, s[40:43], s35 offen offset:1024 sc1
v_mfma_f32_16x16x32_bf16 v[144:147], a[124:127], a[32:35], v[144:147]
s_waitcnt vmcnt(8) lgkmcnt(4)
v_mfma_f32_16x16x32_bf16 v[132:135], a[128:131], a[40:43], v[132:135]
s_cmp_eq_u32 s3, 6
s_cselect_b32 s35, 30, 22
s_lshl_b32 s35, s35, 12
v_mfma_f32_16x16x32_bf16 v[148:151], a[128:131], a[44:47], v[148:151]
ds_read_b128 a[112:115], v6 offset:12288
v_mfma_f32_16x16x32_bf16 v[152:155], a[132:135], a[44:47], v[152:155]
buffer_load_dwordx4 a[32:35], v4, s[40:43], s35 offen offset:0 sc1
v_mfma_f32_16x16x32_bf16 v[136:139], a[132:135], a[40:43], v[136:139]
ds_read_b128 a[116:119], v6 offset:13312
v_mfma_f32_16x16x32_bf16 v[140:143], a[136:139], a[40:43], v[140:143]
ds_read_b128 a[120:123], v6 offset:14336
v_mfma_f32_16x16x32_bf16 v[156:159], a[136:139], a[44:47], v[156:159]
ds_read_b128 a[124:127], v6 offset:15360
v_mfma_f32_16x16x32_bf16 v[160:163], a[140:143], a[44:47], v[160:163]
buffer_load_dwordx4 a[36:39], v4, s[40:43], s35 offen offset:1024 sc1
v_mfma_f32_16x16x32_bf16 v[144:147], a[140:143], a[40:43], v[144:147]
s_waitcnt vmcnt(8) lgkmcnt(4)
v_mfma_f32_16x16x32_bf16 v[132:135], a[96:99], a[0:3], v[132:135]
s_cmp_eq_u32 s3, 7
s_cselect_b32 s35, 31, 23
s_lshl_b32 s35, s35, 12
v_mfma_f32_16x16x32_bf16 v[148:151], a[96:99], a[4:7], v[148:151]
ds_read_b128 a[128:131], v6 offset:16384
v_mfma_f32_16x16x32_bf16 v[152:155], a[100:103], a[4:7], v[152:155]
buffer_load_dwordx4 a[40:43], v4, s[40:43], s35 offen offset:0 sc1
v_mfma_f32_16x16x32_bf16 v[136:139], a[100:103], a[0:3], v[136:139]
ds_read_b128 a[132:135], v6 offset:17408
v_mfma_f32_16x16x32_bf16 v[140:143], a[104:107], a[0:3], v[140:143]
ds_read_b128 a[136:139], v6 offset:18432
v_mfma_f32_16x16x32_bf16 v[156:159], a[104:107], a[4:7], v[156:159]
ds_read_b128 a[140:143], v6 offset:19456
v_mfma_f32_16x16x32_bf16 v[160:163], a[108:111], a[4:7], v[160:163]
buffer_load_dwordx4 a[44:47], v4, s[40:43], s35 offen offset:1024 sc1
v_mfma_f32_16x16x32_bf16 v[144:147], a[108:111], a[0:3], v[144:147]
s_waitcnt vmcnt(8) lgkmcnt(4)
v_mfma_f32_16x16x32_bf16 v[132:135], a[112:115], a[8:11], v[132:135]
s_cmp_eq_u32 s3, 0
s_cselect_b32 s35, 0, 24
s_lshl_b32 s35, s35, 12
v_mfma_f32_16x16x32_bf16 v[148:151], a[112:115], a[12:15], v[148:151]
ds_read_b128 a[96:99], v6 offset:20480
v_mfma_f32_16x16x32_bf16 v[152:155], a[116:119], a[12:15], v[152:155]
buffer_load_dwordx4 a[0:3], v4, s[40:43], s35 offen offset:0 sc1
v_mfma_f32_16x16x32_bf16 v[136:139], a[116:119], a[8:11], v[136:139]
ds_read_b128 a[100:103], v6 offset:21504
v_mfma_f32_16x16x32_bf16 v[140:143], a[120:123], a[8:11], v[140:143]
ds_read_b128 a[104:107], v6 offset:22528
v_mfma_f32_16x16x32_bf16 v[156:159], a[120:123], a[12:15], v[156:159]
ds_read_b128 a[108:111], v6 offset:23552
v_mfma_f32_16x16x32_bf16 v[160:163], a[124:127], a[12:15], v[160:163]
buffer_load_dwordx4 a[4:7], v4, s[40:43], s35 offen offset:1024 sc1
v_mfma_f32_16x16x32_bf16 v[144:147], a[124:127], a[8:11], v[144:147]
s_waitcnt vmcnt(8) lgkmcnt(4)
v_mfma_f32_16x16x32_bf16 v[132:135], a[128:131], a[16:19], v[132:135]
s_cmp_eq_u32 s3, 1
s_cselect_b32 s35, 1, 25
s_lshl_b32 s35, s35, 12
v_mfma_f32_16x16x32_bf16 v[148:151], a[128:131], a[20:23], v[148:151]
ds_read_b128 a[112:115], v6 offset:24576
v_mfma_f32_16x16x32_bf16 v[152:155], a[132:135], a[20:23], v[152:155]
buffer_load_dwordx4 a[8:11], v4, s[40:43], s35 offen offset:0 sc1
v_mfma_f32_16x16x32_bf16 v[136:139], a[132:135], a[16:19], v[136:139]
ds_read_b128 a[116:119], v6 offset:25600
v_mfma_f32_16x16x32_bf16 v[140:143], a[136:139], a[16:19], v[140:143]
ds_read_b128 a[120:123], v6 offset:26624
v_mfma_f32_16x16x32_bf16 v[156:159], a[136:139], a[20:23], v[156:159]
ds_read_b128 a[124:127], v6 offset:27648
v_mfma_f32_16x16x32_bf16 v[160:163], a[140:143], a[20:23], v[160:163]
buffer_load_dwordx4 a[12:15], v4, s[40:43], s35 offen offset:1024 sc1
v_mfma_f32_16x16x32_bf16 v[144:147], a[140:143], a[16:19], v[144:147]
s_waitcnt vmcnt(8) lgkmcnt(4)
v_mfma_f32_16x16x32_bf16 v[132:135], a[96:99], a[24:27], v[132:135]
s_cmp_eq_u32 s3, 2
s_cselect_b32 s35, 2, 26
s_lshl_b32 s35, s35, 12
v_mfma_f32_16x16x32_bf16 v[148:151], a[96:99], a[28:31], v[148:151]
ds_read_b128 a[128:131], v6 offset:28672
v_mfma_f32_16x16x32_bf16 v[152:155], a[100:103], a[28:31], v[152:155]
buffer_load_dwordx4 a[16:19], v4, s[40:43], s35 offen offset:0 sc1
v_mfma_f32_16x16x32_bf16 v[136:139], a[100:103], a[24:27], v[136:139]
ds_read_b128 a[132:135], v6 offset:29696
v_mfma_f32_16x16x32_bf16 v[140:143], a[104:107], a[24:27], v[140:143]
ds_read_b128 a[136:139], v6 offset:30720
v_mfma_f32_16x16x32_bf16 v[156:159], a[104:107], a[28:31], v[156:159]
ds_read_b128 a[140:143], v6 offset:31744
v_mfma_f32_16x16x32_bf16 v[160:163], a[108:111], a[28:31], v[160:163]
buffer_load_dwordx4 a[20:23], v4, s[40:43], s35 offen offset:1024 sc1
v_mfma_f32_16x16x32_bf16 v[144:147], a[108:111], a[24:27], v[144:147]
s_waitcnt vmcnt(8) lgkmcnt(4)
v_mfma_f32_16x16x32_bf16 v[132:135], a[112:115], a[32:35], v[132:135]
s_cmp_eq_u32 s3, 3
s_cselect_b32 s35, 3, 27
s_lshl_b32 s35, s35, 12
v_mfma_f32_16x16x32_bf16 v[148:151], a[112:115], a[36:39], v[148:151]
ds_read_b128 a[96:99], v6 offset:32768
v_mfma_f32_16x16x32_bf16 v[152:155], a[116:119], a[36:39], v[152:155]
buffer_load_dwordx4 a[24:27], v4, s[40:43], s35 offen offset:0 sc1
v_mfma_f32_16x16x32_bf16 v[136:139], a[116:119], a[32:35], v[136:139]
ds_read_b128 a[100:103], v6 offset:33792
v_mfma_f32_16x16x32_bf16 v[140:143], a[120:123], a[32:35], v[140:143]
ds_read_b128 a[104:107], v6 offset:34816
v_mfma_f32_16x16x32_bf16 v[156:159], a[120:123], a[36:39], v[156:159]
ds_read_b128 a[108:111], v6 offset:35840
v_mfma_f32_16x16x32_bf16 v[160:163], a[124:127], a[36:39], v[160:163]
buffer_load_dwordx4 a[28:31], v4, s[40:43], s35 offen offset:1024 sc1
v_mfma_f32_16x16x32_bf16 v[144:147], a[124:127], a[32:35], v[144:147]
s_waitcnt vmcnt(8) lgkmcnt(4)
v_mfma_f32_16x16x32_bf16 v[132:135], a[128:131], a[40:43], v[132:135]
s_cmp_eq_u32 s3, 4
s_cselect_b32 s35, 4, 28
s_lshl_b32 s35, s35, 12
v_mfma_f32_16x16x32_bf16 v[148:151], a[128:131], a[44:47], v[148:151]
ds_read_b128 a[112:115], v6 offset:36864
v_mfma_f32_16x16x32_bf16 v[152:155], a[132:135], a[44:47], v[152:155]
buffer_load_dwordx4 a[32:35], v4, s[40:43], s35 offen offset:0 sc1
v_mfma_f32_16x16x32_bf16 v[136:139], a[132:135], a[40:43], v[136:139]
ds_read_b128 a[116:119], v6 offset:37888
v_mfma_f32_16x16x32_bf16 v[140:143], a[136:139], a[40:43], v[140:143]
ds_read_b128 a[120:123], v6 offset:38912
v_mfma_f32_16x16x32_bf16 v[156:159], a[136:139], a[44:47], v[156:159]
ds_read_b128 a[124:127], v6 offset:39936
v_mfma_f32_16x16x32_bf16 v[160:163], a[140:143], a[44:47], v[160:163]
buffer_load_dwordx4 a[36:39], v4, s[40:43], s35 offen offset:1024 sc1
v_mfma_f32_16x16x32_bf16 v[144:147], a[140:143], a[40:43], v[144:147]
s_waitcnt vmcnt(8) lgkmcnt(4)
v_mfma_f32_16x16x32_bf16 v[132:135], a[96:99], a[0:3], v[132:135]
s_cmp_eq_u32 s3, 5
s_cselect_b32 s35, 5, 29
s_lshl_b32 s35, s35, 12
v_mfma_f32_16x16x32_bf16 v[148:151], a[96:99], a[4:7], v[148:151]
ds_read_b128 a[128:131], v6 offset:40960
v_mfma_f32_16x16x32_bf16 v[152:155], a[100:103], a[4:7], v[152:155]
buffer_load_dwordx4 a[40:43], v4, s[40:43], s35 offen offset:0 sc1
v_mfma_f32_16x16x32_bf16 v[136:139], a[100:103], a[0:3], v[136:139]
ds_read_b128 a[132:135], v6 offset:41984
v_mfma_f32_16x16x32_bf16 v[140:143], a[104:107], a[0:3], v[140:143]
ds_read_b128 a[136:139], v6 offset:43008
v_mfma_f32_16x16x32_bf16 v[156:159], a[104:107], a[4:7], v[156:159]
ds_read_b128 a[140:143], v6 offset:44032
v_mfma_f32_16x16x32_bf16 v[160:163], a[108:111], a[4:7], v[160:163]
buffer_load_dwordx4 a[44:47], v4, s[40:43], s35 offen offset:1024 sc1
v_mfma_f32_16x16x32_bf16 v[144:147], a[108:111], a[0:3], v[144:147]
s_waitcnt vmcnt(8) lgkmcnt(4)
v_mfma_f32_16x16x32_bf16 v[132:135], a[112:115], a[8:11], v[132:135]
s_cmp_eq_u32 s3, 6
s_cselect_b32 s35, 6, 30
s_lshl_b32 s35, s35, 12
v_mfma_f32_16x16x32_bf16 v[148:151], a[112:115], a[12:15], v[148:151]
ds_read_b128 a[96:99], v6 offset:45056
v_mfma_f32_16x16x32_bf16 v[152:155], a[116:119], a[12:15], v[152:155]
buffer_load_dwordx4 a[0:3], v4, s[40:43], s35 offen offset:0 sc1
v_mfma_f32_16x16x32_bf16 v[136:139], a[116:119], a[8:11], v[136:139]
ds_read_b128 a[100:103], v6 offset:46080
v_mfma_f32_16x16x32_bf16 v[140:143], a[120:123], a[8:11], v[140:143]
ds_read_b128 a[104:107], v6 offset:47104
v_mfma_f32_16x16x32_bf16 v[156:159], a[120:123], a[12:15], v[156:159]
ds_read_b128 a[108:111], v6 offset:48128
v_mfma_f32_16x16x32_bf16 v[160:163], a[124:127], a[12:15], v[160:163]
buffer_load_dwordx4 a[4:7], v4, s[40:43], s35 offen offset:1024 sc1
v_mfma_f32_16x16x32_bf16 v[144:147], a[124:127], a[8:11], v[144:147]
s_waitcnt vmcnt(8) lgkmcnt(4)
v_mfma_f32_16x16x32_bf16 v[132:135], a[128:131], a[16:19], v[132:135]
s_cmp_eq_u32 s3, 7
s_cselect_b32 s35, 7, 31
s_lshl_b32 s35, s35, 12
v_mfma_f32_16x16x32_bf16 v[148:151], a[128:131], a[20:23], v[148:151]
ds_read_b128 a[112:115], v6 offset:49152
v_mfma_f32_16x16x32_bf16 v[152:155], a[132:135], a[20:23], v[152:155]
buffer_load_dwordx4 a[8:11], v4, s[40:43], s35 offen offset:0 sc1
v_mfma_f32_16x16x32_bf16 v[136:139], a[132:135], a[16:19], v[136:139]
ds_read_b128 a[116:119], v6 offset:50176
v_mfma_f32_16x16x32_bf16 v[140:143], a[136:139], a[16:19], v[140:143]
ds_read_b128 a[120:123], v6 offset:51200
v_mfma_f32_16x16x32_bf16 v[156:159], a[136:139], a[20:23], v[156:159]
ds_read_b128 a[124:127], v6 offset:52224
v_mfma_f32_16x16x32_bf16 v[160:163], a[140:143], a[20:23], v[160:163]
buffer_load_dwordx4 a[12:15], v4, s[40:43], s35 offen offset:1024 sc1
v_mfma_f32_16x16x32_bf16 v[144:147], a[140:143], a[16:19], v[144:147]
s_waitcnt vmcnt(8) lgkmcnt(4)
v_mfma_f32_16x16x32_bf16 v[132:135], a[96:99], a[24:27], v[132:135]
ds_read_b128 a[128:131], v6 offset:53248
v_mfma_f32_16x16x32_bf16 v[148:151], a[96:99], a[28:31], v[148:151]
ds_read_b128 a[132:135], v6 offset:54272
v_mfma_f32_16x16x32_bf16 v[152:155], a[100:103], a[28:31], v[152:155]
ds_read_b128 a[136:139], v6 offset:55296
v_mfma_f32_16x16x32_bf16 v[136:139], a[100:103], a[24:27], v[136:139]
ds_read_b128 a[140:143], v6 offset:56320
v_mfma_f32_16x16x32_bf16 v[140:143], a[104:107], a[24:27], v[140:143]
v_mfma_f32_16x16x32_bf16 v[156:159], a[104:107], a[28:31], v[156:159]
buffer_atomic_add v12, v10, s[4:7], s92 offen sc1
v_mfma_f32_16x16x32_bf16 v[160:163], a[108:111], a[28:31], v[160:163]
v_mfma_f32_16x16x32_bf16 v[144:147], a[108:111], a[24:27], v[144:147]
s_waitcnt vmcnt(7) lgkmcnt(4)
v_mfma_f32_16x16x32_bf16 v[132:135], a[112:115], a[32:35], v[132:135]
ds_read_b128 a[96:99], v6 offset:57344
v_mfma_f32_16x16x32_bf16 v[148:151], a[112:115], a[36:39], v[148:151]
ds_read_b128 a[100:103], v6 offset:58368
v_mfma_f32_16x16x32_bf16 v[152:155], a[116:119], a[36:39], v[152:155]
ds_read_b128 a[104:107], v6 offset:59392
v_mfma_f32_16x16x32_bf16 v[136:139], a[116:119], a[32:35], v[136:139]
ds_read_b128 a[108:111], v6 offset:60416
v_mfma_f32_16x16x32_bf16 v[140:143], a[120:123], a[32:35], v[140:143]
v_mfma_f32_16x16x32_bf16 v[156:159], a[120:123], a[36:39], v[156:159]
v_mfma_f32_16x16x32_bf16 v[160:163], a[124:127], a[36:39], v[160:163]
v_mfma_f32_16x16x32_bf16 v[144:147], a[124:127], a[32:35], v[144:147]
s_waitcnt vmcnt(5) lgkmcnt(4)
v_mfma_f32_16x16x32_bf16 v[132:135], a[128:131], a[40:43], v[132:135]
ds_read_b128 a[112:115], v6 offset:61440
v_mfma_f32_16x16x32_bf16 v[148:151], a[128:131], a[44:47], v[148:151]
ds_read_b128 a[116:119], v6 offset:62464
v_mfma_f32_16x16x32_bf16 v[152:155], a[132:135], a[44:47], v[152:155]
ds_read_b128 a[120:123], v6 offset:63488
v_mfma_f32_16x16x32_bf16 v[136:139], a[132:135], a[40:43], v[136:139]
ds_read_b128 a[124:127], v6 offset:64512
v_mfma_f32_16x16x32_bf16 v[140:143], a[136:139], a[40:43], v[140:143]
v_mfma_f32_16x16x32_bf16 v[156:159], a[136:139], a[44:47], v[156:159]
v_mfma_f32_16x16x32_bf16 v[160:163], a[140:143], a[44:47], v[160:163]
v_mfma_f32_16x16x32_bf16 v[144:147], a[140:143], a[40:43], v[144:147]
s_waitcnt vmcnt(3) lgkmcnt(4)
v_mfma_f32_16x16x32_bf16 v[132:135], a[96:99], a[0:3], v[132:135]
v_mfma_f32_16x16x32_bf16 v[148:151], a[96:99], a[4:7], v[148:151]
v_mfma_f32_16x16x32_bf16 v[152:155], a[100:103], a[4:7], v[152:155]
v_mfma_f32_16x16x32_bf16 v[136:139], a[100:103], a[0:3], v[136:139]
v_mfma_f32_16x16x32_bf16 v[140:143], a[104:107], a[0:3], v[140:143]
v_mfma_f32_16x16x32_bf16 v[156:159], a[104:107], a[4:7], v[156:159]
v_mfma_f32_16x16x32_bf16 v[160:163], a[108:111], a[4:7], v[160:163]
v_mfma_f32_16x16x32_bf16 v[144:147], a[108:111], a[0:3], v[144:147]
s_waitcnt vmcnt(1) lgkmcnt(0)
v_mfma_f32_16x16x32_bf16 v[132:135], a[112:115], a[8:11], v[132:135]
v_mfma_f32_16x16x32_bf16 v[148:151], a[112:115], a[12:15], v[148:151]
v_mfma_f32_16x16x32_bf16 v[152:155], a[116:119], a[12:15], v[152:155]
v_mfma_f32_16x16x32_bf16 v[136:139], a[116:119], a[8:11], v[136:139]
v_mfma_f32_16x16x32_bf16 v[140:143], a[120:123], a[8:11], v[140:143]
v_mfma_f32_16x16x32_bf16 v[156:159], a[120:123], a[12:15], v[156:159]
v_mfma_f32_16x16x32_bf16 v[160:163], a[124:127], a[12:15], v[160:163]
v_mfma_f32_16x16x32_bf16 v[144:147], a[124:127], a[8:11], v[144:147]
s_nop 1
v_cmp_u_f32 vcc, v132, v148
s_nop 0
s_and_b32 vcc_lo, vcc_lo, s95
s_cbranch_scc1 L_k2redo1
s_lshl_b32 s36, s32, 13
v_cvt_pk_bf16_f32 v32, v132, v133
v_cvt_pk_bf16_f32 v33, v134, v135
v_cvt_pk_bf16_f32 v34, v136, v137
v_cvt_pk_bf16_f32 v35, v138, v139
s_add_u32 s36, s36, 0x0
buffer_store_dwordx4 v[32:35], v4, s[12:15], s36 offen offset:0 sc1
v_cvt_pk_bf16_f32 v40, v148, v149
v_cvt_pk_bf16_f32 v41, v150, v151
v_cvt_pk_bf16_f32 v42, v152, v153
v_cvt_pk_bf16_f32 v43, v154, v155
v_cvt_pk_bf16_f32 v36, v140, v141
v_cvt_pk_bf16_f32 v37, v142, v143
v_cvt_pk_bf16_f32 v38, v144, v145
v_cvt_pk_bf16_f32 v39, v146, v147
s_add_u32 s37, s36, 4096
v_cvt_pk_bf16_f32 v44, v156, v157
v_cvt_pk_bf16_f32 v45, v158, v159
v_cvt_pk_bf16_f32 v46, v160, v161
buffer_store_dwordx4 v[40:43], v4, s[12:15], s36 offen offset:1024 sc1
v_cvt_pk_bf16_f32 v47, v162, v163
v_mfma_f32_16x16x32_bf16 v[96:99], v[32:35], v[32:35], 0
s_mov_b32 s38, 0x280000
s_add_u32 s92, s78, 0x50000
v_mfma_f32_16x16x32_bf16 v[92:95], v[16:19], v[32:35], 0
s_add_u32 s93, s79, 0x50000
s_mov_b64 s[40:41], s[12:13]
v_mfma_f32_16x16x32_bf16 v[96:99], v[36:39], v[36:39], v[96:99]
buffer_store_dwordx4 v[36:39], v4, s[12:15], s37 offen offset:0 sc1
v_mfma_f32_16x16x32_bf16 v[92:95], v[16:19], v[36:39], v[92:95]
s_nop 5
v_cndmask_b32 v96, v96, v97, s[46:47]
v_cndmask_b32 v98, v98, v99, s[46:47]
v_mfma_f32_16x16x32_bf16 v[104:107], v[40:43], v[40:43], 0
v_mfma_f32_16x16x32_bf16 v[100:103], v[16:19], v[40:43], 0
v_cndmask_b32 v93, v96, v98, s[48:49]
buffer_store_dwordx4 v[44:47], v4, s[12:15], s37 offen offset:1024 sc1
v_mfma_f32_16x16x32_bf16 v[104:107], v[44:47], v[44:47], v[104:107]
v_mfma_f32_16x16x32_bf16 v[100:103], v[16:19], v[44:47], v[100:103]
s_nop 6
v_cndmask_b32 v104, v104, v105, s[46:47]
v_cndmask_b32 v106, v106, v107, s[46:47]
buffer_store_dwordx2 v[92:93], v253, s[4:7], s38 offen offset:0 sc1
v_cndmask_b32 v101, v104, v106, s[48:49]
buffer_store_dwordx2 v[100:101], v253, s[4:7], s38 offen offset:2048 sc1
s_barrier
s_add_u32 m0, s18, 0x0
s_add_u32 s44, s50, 0xe00000
buffer_load_dwordx4 v1, s[4:7], s44 offen offset:0 sc1 lds
buffer_load_dwordx4 v1, s[4:7], s44 offen offset:1024 sc1 lds
buffer_load_dwordx4 v1, s[4:7], s44 offen offset:2048 sc1 lds
s_add_u32 m0, s18, 0x3000
s_add_u32 s44, s50, 0xe03000
buffer_load_dwordx4 v1, s[4:7], s44 offen offset:0 sc1 lds
buffer_load_dwordx4 v1, s[4:7], s44 offen offset:1024 sc1 lds
buffer_load_dwordx4 v1, s[4:7], s44 offen offset:2048 sc1 lds
s_waitcnt vmcnt(6)
s_barrier
s_cmp_lg_u32 s28, 1
s_cbranch_scc1 Lsg_22
buffer_atomic_add v12, v10, s[4:7], s92 offen sc1
buffer_atomic_add v12, v10, s[4:7], s93 offen sc1
Lsg_22:
s_cmp_lg_u32 s28, 1
s_cbranch_scc1 L_wskip4
s_mov_b64 exec, 0
s_branch L_stub10
L_wret4:
s_mov_b64 exec, -1
L_wskip4:
s_cmp_lt_u32 s28, 2
s_cbranch_scc1 Lwd_23
s_add_u32 m0, s18, 0x4800
s_add_u32 s44, s50, 0xe04800
buffer_load_dwordx4 v1, s[4:7], s44 offen offset:0 sc1 lds
buffer_load_dwordx4 v1, s[4:7], s44 offen offset:1024 sc1 lds
buffer_load_dwordx4 v1, s[4:7], s44 offen offset:2048 sc1 lds
s_add_u32 m0, s18, 0x6000
s_add_u32 s44, s50, 0xe06000
buffer_load_dwordx4 v1, s[4:7], s44 offen offset:0 sc1 lds
buffer_load_dwordx4 v1, s[4:7], s44 offen offset:1024 sc1 lds
buffer_load_dwordx4 v1, s[4:7], s44 offen offset:2048 sc1 lds
s_add_u32 m0, s18, 0x7800
s_add_u32 s44, s50, 0xe07800
buffer_load_dwordx4 v1, s[4:7], s44 offen offset:0 sc1 lds
buffer_load_dwordx4 v1, s[4:7], s44 offen offset:1024 sc1 lds
buffer_load_dwordx4 v1, s[4:7], s44 offen offset:2048 sc1 lds
s_add_u32 m0, s18, 0x9000
s_add_u32 s44, s50, 0xe09000
buffer_load_dwordx4 v1, s[4:7], s44 offen offset:0 sc1 lds
buffer_load_dwordx4 v1, s[4:7], s44 offen offset:1024 sc1 lds
buffer_load_dwordx4 v1, s[4:7], s44 offen offset:2048 sc1 lds
s_add_u32 m0, s18, 0xa800
s_add_u32 s44, s50, 0xe0a800
buffer_load_dwordx4 v1, s[4:7], s44 offen offset:0 sc1 lds
buffer_load_dwordx4 v1, s[4:7], s44 offen offset:1024 sc1 lds
buffer_load_dwordx4 v1, s[4:7], s44 offen offset:2048 sc1 lds
s_add_u32 m0, s18, 0xc000
s_add_u32 s44, s50, 0xe0c000
buffer_load_dwordx4 v1, s[4:7], s44 offen offset:0 sc1 lds
buffer_load_dwordx4 v1, s[4:7], s44 offen offset:1024 sc1 lds
buffer_load_dwordx4 v1, s[4:7], s44 offen offset:2048 sc1 lds
s_add_u32 m0, s18, 0xd800
s_add_u32 s44, s50, 0xe0d800
buffer_load_dwordx4 v1, s[4:7], s44 offen offset:0 sc1 lds
buffer_load_dwordx4 v1, s[4:7], s44 offen offset:1024 sc1 lds
buffer_load_dwordx4 v1, s[4:7], s44 offen offset:2048 sc1 lds
s_add_u32 m0, s18, 0xf000
s_add_u32 s44, s50, 0xe0f000
buffer_load_dwordx4 v1, s[4:7], s44 offen offset:0 sc1 lds
buffer_load_dwordx4 v1, s[4:7], s44 offen offset:1024 sc1 lds
buffer_load_dwordx4 v1, s[4:7], s44 offen offset:2048 sc1 lds
s_add_u32 m0, s18, 0x10800
s_add_u32 s44, s50, 0xe10800
buffer_load_dwordx4 v1, s[4:7], s44 offen offset:0 sc1 lds
buffer_load_dwordx4 v1, s[4:7], s44 offen offset:1024 sc1 lds
buffer_load_dwordx4 v1, s[4:7], s44 offen offset:2048 sc1 lds
s_add_u32 m0, s18, 0x12000
s_add_u32 s44, s50, 0xe12000
buffer_load_dwordx4 v1, s[4:7], s44 offen offset:0 sc1 lds
buffer_load_dwordx4 v1, s[4:7], s44 offen offset:1024 sc1 lds
buffer_load_dwordx4 v1, s[4:7], s44 offen offset:2048 sc1 lds
s_add_u32 m0, s18, 0x13800
s_add_u32 s44, s50, 0xe13800
buffer_load_dwordx4 v1, s[4:7], s44 offen offset:0 sc1 lds
buffer_load_dwordx4 v1, s[4:7], s44 offen offset:1024 sc1 lds
buffer_load_dwordx4 v1, s[4:7], s44 offen offset:2048 sc1 lds
s_add_u32 m0, s18, 0x15000
s_add_u32 s44, s50, 0xe15000
buffer_load_dwordx4 v1, s[4:7], s44 offen offset:0 sc1 lds
buffer_load_dwordx4 v1, s[4:7], s44 offen offset:1024 sc1 lds
buffer_load_dwordx4 v1, s[4:7], s44 offen offset:2048 sc1 lds
s_add_u32 m0, s18, 0x16800
s_add_u32 s44, s50, 0xe16800
buffer_load_dwordx4 v1, s[4:7], s44 offen offset:0 sc1 lds
buffer_load_dwordx4 v1, s[4:7], s44 offen offset:1024 sc1 lds
buffer_load_dwordx4 v1, s[4:7], s44 offen offset:2048 sc1 lds
s_add_u32 m0, s18, 0x18000
s_add_u32 s44, s50, 0xe18000
buffer_load_dwordx4 v1, s[4:7], s44 offen offset:0 sc1 lds
buffer_load_dwordx4 v1, s[4:7], s44 offen offset:1024 sc1 lds
buffer_load_dwordx4 v1, s[4:7], s44 offen offset:2048 sc1 lds
s_add_u32 m0, s18, 0x19800
s_add_u32 s44, s50, 0xe19800
buffer_load_dwordx4 v1, s[4:7], s44 offen offset:0 sc1 lds
buffer_load_dwordx4 v1, s[4:7], s44 offen offset:1024 sc1 lds
buffer_load_dwordx4 v1, s[4:7], s44 offen offset:2048 sc1 lds
s_add_u32 m0, s18, 0x1b000
s_add_u32 s44, s50, 0xe1b000
buffer_load_dwordx4 v1, s[4:7], s44 offen offset:0 sc1 lds
buffer_load_dwordx4 v1, s[4:7], s44 offen offset:1024 sc1 lds
buffer_load_dwordx4 v1, s[4:7], s44 offen offset:2048 sc1 lds
Lwd_23:
s_cmp_lg_u32 s28, 0
s_cbranch_scc1 Lpe_25
s_add_u32 s36, s67, 0x50000
s_mov_b32 s37, 0
Lpoll_24:
v_mov_b32 v11, 0
buffer_atomic_add v11, v251, s[4:7], s36 offen sc0 sc1
s_add_u32 s37, s37, 1
s_waitcnt vmcnt(0)
v_readfirstlane_b32 s38, v11
s_nop 0
s_cmp_ge_u32 s38, s54
s_cbranch_scc1 Lpe_25
s_cmp_lt_u32 s37, 0x100000
s_cbranch_scc1 Lpoll_24
Lpe_25:
s_waitcnt vmcnt(36)
s_cmp_ge_u32 s28, 2
s_cbranch_scc1 Lw_26
s_waitcnt vmcnt(0)
Lw_26:
s_barrier
s_add_u32 s94, s71, 0x20080
s_lshl_b32 s35, s33, 12
buffer_load_dwordx4 a[0:3], v2, s[40:43], s35 offen offset:0 sc1
buffer_load_dwordx4 a[4:7], v2, s[40:43], s35 offen offset:1024 sc1
buffer_load_dwordx4 a[8:11], v2, s[40:43], s35 offen offset:2048 sc1
buffer_load_dwordx4 a[12:15], v2, s[40:43], s35 offen offset:3072 sc1
s_add_u32 s35, s35, 4096
s_add_u32 s63, s28, 0
s_lshl_b32 s63, s63, 12
buffer_load_dwordx4 a[64:67], v3, s[40:43], s63 offen sc1
buffer_load_dwordx4 a[16:19], v2, s[40:43], s35 offen offset:0 sc1
buffer_load_dwordx4 a[20:23], v2, s[40:43], s35 offen offset:1024 sc1
buffer_load_dwordx4 a[24:27], v2, s[40:43], s35 offen offset:2048 sc1
buffer_load_dwordx4 a[28:31], v2, s[40:43], s35 offen offset:3072 sc1
s_add_u32 s35, s35, 4096
buffer_load_dwordx4 a[32:35], v2, s[40:43], s35 offen offset:0 sc1
buffer_load_dwordx4 a[36:39], v2, s[40:43], s35 offen offset:1024 sc1
buffer_load_dwordx4 a[40:43], v2, s[40:43], s35 offen offset:2048 sc1
buffer_load_dwordx4 a[44:47], v2, s[40:43], s35 offen offset:3072 sc1
s_add_u32 s35, s35, 4096
v_add_u32 v5, 0, v1
v_add_u32 v6, s55, v5
ds_read_b128 a[96:99], v5 offset:0
ds_read_b128 a[100:103], v5 offset:1024
ds_read_b128 a[104:107], v5 offset:2048
ds_read_b128 a[108:111], v5 offset:3072
ds_read_b128 a[112:115], v5 offset:4096
ds_read_b128 a[116:119], v5 offset:5120
ds_read_b128 a[120:123], v6 offset:2048
s_waitcnt vmcnt(8) lgkmcnt(0)
v_mfma_f32_16x16x32_bf16 v[132:135], a[96:99], a[0:3], 0
s_add_u32 s63, s28, 4
s_lshl_b32 s63, s63, 12
v_mfma_f32_16x16x32_bf16 v[156:159], a[96:99], a[4:7], 0
buffer_load_dwordx4 a[48:51], v2, s[40:43], s35 offen offset:0 sc1
v_mfma_f32_16x16x32_bf16 v[180:183], a[96:99], a[8:11], 0
ds_read_b128 a[128:131], v5 offset:6144
v_mfma_f32_16x16x32_bf16 v[204:207], a[96:99], a[12:15], 0
ds_read_b128 a[132:135], v5 offset:7168
v_mfma_f32_16x16x32_bf16 v[208:211], a[100:103], a[12:15], 0
ds_read_b128 a[136:139], v5 offset:8192
L_stub10:
s_cbranch_execz L_stub11
v_mfma_f32_16x16x32_bf16 v[184:187], a[100:103], a[8:11], 0
v_mfma_f32_16x16x32_bf16 v[160:163], a[100:103], a[4:7], 0
buffer_load_dwordx4 a[52:55], v2, s[40:43], s35 offen offset:1024 sc1
v_mfma_f32_16x16x32_bf16 v[136:139], a[100:103], a[0:3], 0
ds_read_b128 a[140:143], v5 offset:9216
v_mfma_f32_16x16x32_bf16 v[140:143], a[104:107], a[0:3], 0
v_mfma_f32_16x16x32_bf16 v[164:167], a[104:107], a[4:7], 0
ds_read_b128 a[144:147], v5 offset:10240
v_mfma_f32_16x16x32_bf16 v[188:191], a[104:107], a[8:11], 0
v_mfma_f32_16x16x32_bf16 v[212:215], a[104:107], a[12:15], 0
buffer_load_dwordx4 a[68:71], v3, s[40:43], s63 offen sc1
s_add_u32 m0, s18, 0x1e000
v_mfma_f32_16x16x32_bf16 v[216:219], a[108:111], a[12:15], 0
s_add_u32 s44, s50, 0xe1e000
ds_read_b128 a[148:151], v5 offset:11264
v_mfma_f32_16x16x32_bf16 v[192:195], a[108:111], a[8:11], 0
ds_read_b128 a[152:155], v6 offset:3072
v_mfma_f32_16x16x32_bf16 v[168:171], a[108:111], a[4:7], 0
v_mfma_f32_16x16x32_bf16 v[144:147], a[108:111], a[0:3], 0
v_mfma_f32_16x16x32_bf16 v[148:151], a[112:115], a[0:3], 0
buffer_load_dwordx4 a[56:59], v2, s[40:43], s35 offen offset:2048 sc1
v_mfma_f32_16x16x32_bf16 v[172:175], a[112:115], a[4:7], 0
v_mfma_f32_16x16x32_bf16 v[196:199], a[112:115], a[8:11], 0
v_mfma_f32_16x16x32_bf16 v[220:223], a[112:115], a[12:15], 0
v_mfma_f32_16x16x32_bf16 v[224:227], a[116:119], a[12:15], 0
v_mfma_f32_16x16x32_bf16 v[200:203], a[116:119], a[8:11], 0
buffer_load_dwordx4 a[60:63], v2, s[40:43], s35 offen offset:3072 sc1
s_add_u32 s35, s35, 4096
v_mfma_f32_16x16x32_bf16 v[176:179], a[116:119], a[4:7], 0
v_mfma_f32_16x16x32_bf16 v[152:155], a[116:119], a[0:3], 0
v_mfma_f32_16x16x32_bf16 a[80:83], a[120:123], a[64:67], 0
s_waitcnt vmcnt(9) lgkmcnt(0)
v_mfma_f32_16x16x32_bf16 v[132:135], a[128:131], a[16:19], v[132:135]
ds_read_b128 a[96:99], v5 offset:12288
v_mfma_f32_16x16x32_bf16 v[156:159], a[128:131], a[20:23], v[156:159]
buffer_load_dwordx4 a[0:3], v2, s[40:43], s35 offen offset:0 sc1
v_mfma_f32_16x16x32_bf16 v[180:183], a[128:131], a[24:27], v[180:183]
ds_read_b128 a[100:103], v5 offset:13312
v_mfma_f32_16x16x32_bf16 v[204:207], a[128:131], a[28:31], v[204:207]
v_mfma_f32_16x16x32_bf16 v[208:211], a[132:135], a[28:31], v[208:211]
ds_read_b128 a[104:107], v5 offset:14336
v_mfma_f32_16x16x32_bf16 v[184:187], a[132:135], a[24:27], v[184:187]
buffer_load_dwordx4 v1, s[4:7], s44 offen offset:0 sc1 lds
v_mfma_f32_16x16x32_bf16 v[160:163], a[132:135], a[20:23], v[160:163]
ds_read_b128 a[108:111], v5 offset:15360
v_mfma_f32_16x16x32_bf16 v[136:139], a[132:135], a[16:19], v[136:139]
v_mfma_f32_16x16x32_bf16 v[140:143], a[136:139], a[16:19], v[140:143]
v_mfma_f32_16x16x32_bf16 v[164:167], a[136:139], a[20:23], v[164:167]
buffer_load_dwordx4 a[4:7], v2, s[40:43], s35 offen offset:1024 sc1
v_mfma_f32_16x16x32_bf16 v[188:191], a[136:139], a[24:27], v[188:191]
ds_read_b128 a[112:115], v5 offset:16384
v_mfma_f32_16x16x32_bf16 v[212:215], a[136:139], a[28:31], v[212:215]
ds_read_b128 a[116:119], v5 offset:17408
v_mfma_f32_16x16x32_bf16 v[216:219], a[140:143], a[28:31], v[216:219]
v_mfma_f32_16x16x32_bf16 v[192:195], a[140:143], a[24:27], v[192:195]
buffer_load_dwordx4 a[8:11], v2, s[40:43], s35 offen offset:2048 sc1
v_mfma_f32_16x16x32_bf16 v[168:171], a[140:143], a[20:23], v[168:171]
ds_read_b128 a[120:123], v6 offset:4096
v_mfma_f32_16x16x32_bf16 v[144:147], a[140:143], a[16:19], v[144:147]
v_mfma_f32_16x16x32_bf16 v[148:151], a[144:147], a[16:19], v[148:151]
v_mfma_f32_16x16x32_bf16 v[172:175], a[144:147], a[20:23], v[172:175]
buffer_load_dwordx4 v1, s[4:7], s44 offen offset:1024 sc1 lds
v_mfma_f32_16x16x32_bf16 v[196:199], a[144:147], a[24:27], v[196:199]
v_mfma_f32_16x16x32_bf16 v[220:223], a[144:147], a[28:31], v[220:223]
v_mfma_f32_16x16x32_bf16 v[224:227], a[148:151], a[28:31], v[224:227]
v_mfma_f32_16x16x32_bf16 v[200:203], a[148:151], a[24:27], v[200:203]
buffer_load_dwordx4 a[12:15], v2, s[40:43], s35 offen offset:3072 sc1
s_add_u32 s35, s35, 4096
v_mfma_f32_16x16x32_bf16 v[176:179], a[148:151], a[20:23], v[176:179]
v_mfma_f32_16x16x32_bf16 v[152:155], a[148:151], a[16:19], v[152:155]
v_mfma_f32_16x16x32_bf16 a[84:87], a[152:155], a[64:67], 0
s_waitcnt vmcnt(11) lgkmcnt(0)
v_mfma_f32_16x16x32_bf16 v[132:135], a[96:99], a[32:35], v[132:135]
ds_read_b128 a[128:131], v5 offset:18432
v_mfma_f32_16x16x32_bf16 v[156:159], a[96:99], a[36:39], v[156:159]
buffer_load_dwordx4 a[16:19], v2, s[40:43], s35 offen offset:0 sc1
v_mfma_f32_16x16x32_bf16 v[180:183], a[96:99], a[40:43], v[180:183]
ds_read_b128 a[132:135], v5 offset:19456
v_mfma_f32_16x16x32_bf16 v[204:207], a[96:99], a[44:47], v[204:207]
v_mfma_f32_16x16x32_bf16 v[208:211], a[100:103], a[44:47], v[208:211]
ds_read_b128 a[136:139], v5 offset:20480
v_mfma_f32_16x16x32_bf16 v[184:187], a[100:103], a[40:43], v[184:187]
buffer_load_dwordx4 v1, s[4:7], s44 offen offset:2048 sc1 lds
s_add_u32 m0, s18, 0x21000
v_mfma_f32_16x16x32_bf16 v[160:163], a[100:103], a[36:39], v[160:163]
s_add_u32 s44, s50, 0xe21000
ds_read_b128 a[140:143], v5 offset:21504
v_mfma_f32_16x16x32_bf16 v[136:139], a[100:103], a[32:35], v[136:139]
v_mfma_f32_16x16x32_bf16 v[140:143], a[104:107], a[32:35], v[140:143]
v_mfma_f32_16x16x32_bf16 v[164:167], a[104:107], a[36:39], v[164:167]
buffer_load_dwordx4 a[20:23], v2, s[40:43], s35 offen offset:1024 sc1
v_mfma_f32_16x16x32_bf16 v[188:191], a[104:107], a[40:43], v[188:191]
ds_read_b128 a[144:147], v5 offset:22528
v_mfma_f32_16x16x32_bf16 v[212:215], a[104:107], a[44:47], v[212:215]
ds_read_b128 a[148:151], v5 offset:23552
v_mfma_f32_16x16x32_bf16 v[216:219], a[108:111], a[44:47], v[216:219]
v_mfma_f32_16x16x32_bf16 v[192:195], a[108:111], a[40:43], v[192:195]
buffer_load_dwordx4 a[24:27], v2, s[40:43], s35 offen offset:2048 sc1
v_mfma_f32_16x16x32_bf16 v[168:171], a[108:111], a[36:39], v[168:171]
ds_read_b128 a[152:155], v6 offset:5120
v_mfma_f32_16x16x32_bf16 v[144:147], a[108:111], a[32:35], v[144:147]
v_mfma_f32_16x16x32_bf16 v[148:151], a[112:115], a[32:35], v[148:151]
v_mfma_f32_16x16x32_bf16 v[172:175], a[112:115], a[36:39], v[172:175]
buffer_load_dwordx4 v1, s[4:7], s44 offen offset:0 sc1 lds
v_mfma_f32_16x16x32_bf16 v[196:199], a[112:115], a[40:43], v[196:199]
v_mfma_f32_16x16x32_bf16 v[220:223], a[112:115], a[44:47], v[220:223]
v_mfma_f32_16x16x32_bf16 v[224:227], a[116:119], a[44:47], v[224:227]
v_mfma_f32_16x16x32_bf16 v[200:203], a[116:119], a[40:43], v[200:203]
buffer_load_dwordx4 a[28:31], v2, s[40:43], s35 offen offset:3072 sc1
s_add_u32 s35, s35, 4096
v_mfma_f32_16x16x32_bf16 v[176:179], a[116:119], a[36:39], v[176:179]
v_mfma_f32_16x16x32_bf16 v[152:155], a[116:119], a[32:35], v[152:155]
v_mfma_f32_16x16x32_bf16 a[88:91], a[120:123], a[64:67], 0
s_waitcnt vmcnt(12) lgkmcnt(0)
v_mfma_f32_16x16x32_bf16 v[132:135], a[128:131], a[48:51], v[132:135]
ds_read_b128 a[96:99], v5 offset:24576
v_mfma_f32_16x16x32_bf16 v[156:159], a[128:131], a[52:55], v[156:159]
buffer_load_dwordx4 a[32:35], v2, s[40:43], s35 offen offset:0 sc1
v_mfma_f32_16x16x32_bf16 v[180:183], a[128:131], a[56:59], v[180:183]
ds_read_b128 a[100:103], v5 offset:25600
v_mfma_f32_16x16x32_bf16 v[204:207], a[128:131], a[60:63], v[204:207]
v_mfma_f32_16x16x32_bf16 v[208:211], a[132:135], a[60:63], v[208:211]
ds_read_b128 a[104:107], v5 offset:26624
v_mfma_f32_16x16x32_bf16 v[184:187], a[132:135], a[56:59], v[184:187]
v_mfma_f32_16x16x32_bf16 v[160:163], a[132:135], a[52:55], v[160:163]
buffer_load_dwordx4 a[36:39], v2, s[40:43], s35 offen offset:1024 sc1
v_mfma_f32_16x16x32_bf16 v[136:139], a[132:135], a[48:51], v[136:139]
ds_read_b128 a[108:111], v5 offset:27648
v_mfma_f32_16x16x32_bf16 v[140:143], a[136:139], a[48:51], v[140:143]
v_mfma_f32_16x16x32_bf16 v[164:167], a[136:139], a[52:55], v[164:167]
ds_read_b128 a[112:115], v5 offset:28672
v_mfma_f32_16x16x32_bf16 v[188:191], a[136:139], a[56:59], v[188:191]
v_mfma_f32_16x16x32_bf16 v[212:215], a[136:139], a[60:63], v[212:215]
buffer_load_dwordx4 v1, s[4:7], s44 offen offset:1024 sc1 lds
v_mfma_f32_16x16x32_bf16 v[216:219], a[140:143], a[60:63], v[216:219]
ds_read_b128 a[116:119], v5 offset:29696
v_mfma_f32_16x16x32_bf16 v[192:195], a[140:143], a[56:59], v[192:195]
ds_read_b128 a[120:123], v6 offset:26624
v_mfma_f32_16x16x32_bf16 v[168:171], a[140:143], a[52:55], v[168:171]
v_mfma_f32_16x16x32_bf16 v[144:147], a[140:143], a[48:51], v[144:147]
v_mfma_f32_16x16x32_bf16 v[148:151], a[144:147], a[48:51], v[148:151]
buffer_load_dwordx4 a[40:43], v2, s[40:43], s35 offen offset:2048 sc1
v_mfma_f32_16x16x32_bf16 v[172:175], a[144:147], a[52:55], v[172:175]
v_mfma_f32_16x16x32_bf16 v[196:199], a[144:147], a[56:59], v[196:199]
v_mfma_f32_16x16x32_bf16 v[220:223], a[144:147], a[60:63], v[220:223]
v_mfma_f32_16x16x32_bf16 v[224:227], a[148:151], a[60:63], v[224:227]
v_mfma_f32_16x16x32_bf16 v[200:203], a[148:151], a[56:59], v[200:203]
buffer_load_dwordx4 a[44:47], v2, s[40:43], s35 offen offset:3072 sc1
s_add_u32 s35, s35, 4096
v_mfma_f32_16x16x32_bf16 v[176:179], a[148:151], a[52:55], v[176:179]
v_mfma_f32_16x16x32_bf16 v[152:155], a[148:151], a[48:51], v[152:155]
v_mfma_f32_16x16x32_bf16 a[92:95], a[152:155], a[64:67], 0
s_waitcnt vmcnt(11) lgkmcnt(0)
v_mfma_f32_16x16x32_bf16 v[132:135], a[96:99], a[0:3], v[132:135]
ds_read_b128 a[128:131], v5 offset:30720
v_accvgpr_read_b32 v48, a160
v_mfma_f32_16x16x32_bf16 v[156:159], a[96:99], a[4:7], v[156:159]
buffer_load_dwordx4 a[48:51], v2, s[40:43], s35 offen offset:0 sc1
v_mfma_f32_16x16x32_bf16 v[180:183], a[96:99], a[8:11], v[180:183]
ds_read_b128 a[132:135], v5 offset:31744
v_mfma_f32_16x16x32_bf16 v[204:207], a[96:99], a[12:15], v[204:207]
v_mfma_f32_16x16x32_bf16 v[208:211], a[100:103], a[12:15], v[208:211]
ds_read_b128 a[136:139], v5 offset:32768
v_mfma_f32_16x16x32_bf16 v[184:187], a[100:103], a[8:11], v[184:187]
buffer_load_dwordx4 v1, s[4:7], s44 offen offset:2048 sc1 lds
s_add_u32 s63, s28, 8
v_mfma_f32_16x16x32_bf16 v[160:163], a[100:103], a[4:7], v[160:163]
s_lshl_b32 s63, s63, 12
ds_read_b128 a[140:143], v5 offset:33792
v_mfma_f32_16x16x32_bf16 v[136:139], a[100:103], a[0:3], v[136:139]
v_accvgpr_read_b32 v49, a161
v_mfma_f32_16x16x32_bf16 v[140:143], a[104:107], a[0:3], v[140:143]
v_mfma_f32_16x16x32_bf16 v[164:167], a[104:107], a[4:7], v[164:167]
buffer_load_dwordx4 a[52:55], v2, s[40:43], s35 offen offset:1024 sc1
v_mfma_f32_16x16x32_bf16 v[188:191], a[104:107], a[8:11], v[188:191]
ds_read_b128 a[144:147], v5 offset:34816
v_mfma_f32_16x16x32_bf16 v[212:215], a[104:107], a[12:15], v[212:215]
ds_read_b128 a[148:151], v5 offset:35840
v_mfma_f32_16x16x32_bf16 v[216:219], a[108:111], a[12:15], v[216:219]
v_accvgpr_read_b32 v50, a162
v_mfma_f32_16x16x32_bf16 v[192:195], a[108:111], a[8:11], v[192:195]
buffer_load_dwordx4 a[56:59], v2, s[40:43], s35 offen offset:2048 sc1
v_mfma_f32_16x16x32_bf16 v[168:171], a[108:111], a[4:7], v[168:171]
ds_read_b128 a[152:155], v6 offset:27648
v_mfma_f32_16x16x32_bf16 v[144:147], a[108:111], a[0:3], v[144:147]
v_mfma_f32_16x16x32_bf16 v[148:151], a[112:115], a[0:3], v[148:151]
v_mfma_f32_16x16x32_bf16 v[172:175], a[112:115], a[4:7], v[172:175]
buffer_load_dwordx4 a[72:75], v3, s[40:43], s63 offen sc1
s_add_u32 s88, s82, 0x280000
v_mfma_f32_16x16x32_bf16 v[196:199], a[112:115], a[8:11], v[196:199]
v_accvgpr_read_b32 v51, a163
v_mfma_f32_16x16x32_bf16 v[220:223], a[112:115], a[12:15], v[220:223]
v_mfma_f32_16x16x32_bf16 v[224:227], a[116:119], a[12:15], v[224:227]
v_mfma_f32_16x16x32_bf16 v[200:203], a[116:119], a[8:11], v[200:203]
buffer_load_dwordx4 a[60:63], v2, s[40:43], s35 offen offset:3072 sc1
s_add_u32 s35, s35, 4096
v_mfma_f32_16x16x32_bf16 v[176:179], a[116:119], a[4:7], v[176:179]
v_mfma_f32_16x16x32_bf16 v[152:155], a[116:119], a[0:3], v[152:155]
v_mfma_f32_16x16x32_bf16 a[80:83], a[120:123], a[68:71], a[80:83]
s_waitcnt vmcnt(11) lgkmcnt(0)
v_mfma_f32_16x16x32_bf16 v[132:135], a[128:131], a[16:19], v[132:135]
ds_read_b128 a[96:99], v5 offset:36864
v_accvgpr_read_b32 v52, a164
v_mfma_f32_16x16x32_bf16 v[156:159], a[128:131], a[20:23], v[156:159]
buffer_load_dwordx4 a[0:3], v2, s[40:43], s35 offen offset:0 sc1
v_mfma_f32_16x16x32_bf16 v[180:183], a[128:131], a[24:27], v[180:183]
ds_read_b128 a[100:103], v5 offset:37888
v_mfma_f32_16x16x32_bf16 v[204:207], a[128:131], a[28:31], v[204:207]
v_mfma_f32_16x16x32_bf16 v[208:211], a[132:135], a[28:31], v[208:211]
ds_read_b128 a[104:107], v5 offset:38912
v_mfma_f32_16x16x32_bf16 v[184:187], a[132:135], a[24:27], v[184:187]
v_mfma_f32_16x16x32_bf16 v[160:163], a[132:135], a[20:23], v[160:163]
buffer_load_dwordx4 a[4:7], v2, s[40:43], s35 offen offset:1024 sc1
v_mfma_f32_16x16x32_bf16 v[136:139], a[132:135], a[16:19], v[136:139]
ds_read_b128 a[108:111], v5 offset:39936
v_accvgpr_read_b32 v53, a165
v_mfma_f32_16x16x32_bf16 v[140:143], a[136:139], a[16:19], v[140:143]
v_mfma_f32_16x16x32_bf16 v[164:167], a[136:139], a[20:23], v[164:167]
ds_read_b128 a[112:115], v5 offset:40960
v_mfma_f32_16x16x32_bf16 v[188:191], a[136:139], a[24:27], v[188:191]
v_mfma_f32_16x16x32_bf16 v[212:215], a[136:139], a[28:31], v[212:215]
buffer_load_dwordx4 v[92:95], v1, s[4:7], s88 offen offset:0 sc1
v_mfma_f32_16x16x32_bf16 v[216:219], a[140:143], a[28:31], v[216:219]
ds_read_b128 a[116:119], v5 offset:41984
v_accvgpr_read_b32 v54, a166
v_mfma_f32_16x16x32_bf16 v[192:195], a[140:143], a[24:27], v[192:195]
ds_read_b128 a[120:123], v6 offset:28672
v_mfma_f32_16x16x32_bf16 v[168:171], a[140:143], a[20:23], v[168:171]
v_mfma_f32_16x16x32_bf16 v[144:147], a[140:143], a[16:19], v[144:147]
v_mfma_f32_16x16x32_bf16 v[148:151], a[144:147], a[16:19], v[148:151]
buffer_load_dwordx4 a[8:11], v2, s[40:43], s35 offen offset:2048 sc1
v_mfma_f32_16x16x32_bf16 v[172:175], a[144:147], a[20:23], v[172:175]
v_mfma_f32_16x16x32_bf16 v[196:199], a[144:147], a[24:27], v[196:199]
v_accvgpr_read_b32 v55, a167
v_mfma_f32_16x16x32_bf16 v[220:223], a[144:147], a[28:31], v[220:223]
v_mfma_f32_16x16x32_bf16 v[224:227], a[148:151], a[28:31], v[224:227]
v_mfma_f32_16x16x32_bf16 v[200:203], a[148:151], a[24:27], v[200:203]
buffer_load_dwordx4 a[12:15], v2, s[40:43], s35 offen offset:3072 sc1
s_add_u32 s35, s35, 4096
v_mfma_f32_16x16x32_bf16 v[176:179], a[148:151], a[20:23], v[176:179]
v_mfma_f32_16x16x32_bf16 v[152:155], a[148:151], a[16:19], v[152:155]
v_mfma_f32_16x16x32_bf16 a[84:87], a[152:155], a[68:71], a[84:87]
s_waitcnt vmcnt(11) lgkmcnt(0)
v_mfma_f32_16x16x32_bf16 v[132:135], a[96:99], a[32:35], v[132:135]
ds_read_b128 a[128:131], v5 offset:43008
v_accvgpr_read_b32 v56, a168
v_mfma_f32_16x16x32_bf16 v[156:159], a[96:99], a[36:39], v[156:159]
buffer_load_dwordx4 a[16:19], v2, s[40:43], s35 offen offset:0 sc1
v_mfma_f32_16x16x32_bf16 v[180:183], a[96:99], a[40:43], v[180:183]
ds_read_b128 a[132:135], v5 offset:44032
v_mfma_f32_16x16x32_bf16 v[204:207], a[96:99], a[44:47], v[204:207]
v_mfma_f32_16x16x32_bf16 v[208:211], a[100:103], a[44:47], v[208:211]
ds_read_b128 a[136:139], v5 offset:45056
v_mfma_f32_16x16x32_bf16 v[184:187], a[100:103], a[40:43], v[184:187]
buffer_load_dwordx4 v[96:99], v1, s[4:7], s88 offen offset:1024 sc1
v_mfma_f32_16x16x32_bf16 v[160:163], a[100:103], a[36:39], v[160:163]
ds_read_b128 a[140:143], v5 offset:46080
v_accvgpr_read_b32 v57, a169
v_mfma_f32_16x16x32_bf16 v[136:139], a[100:103], a[32:35], v[136:139]
v_mfma_f32_16x16x32_bf16 v[140:143], a[104:107], a[32:35], v[140:143]
v_mfma_f32_16x16x32_bf16 v[164:167], a[104:107], a[36:39], v[164:167]
buffer_load_dwordx4 a[20:23], v2, s[40:43], s35 offen offset:1024 sc1
v_mfma_f32_16x16x32_bf16 v[188:191], a[104:107], a[40:43], v[188:191]
ds_read_b128 a[144:147], v5 offset:47104
v_mfma_f32_16x16x32_bf16 v[212:215], a[104:107], a[44:47], v[212:215]
ds_read_b128 a[148:151], v5 offset:48128
v_mfma_f32_16x16x32_bf16 v[216:219], a[108:111], a[44:47], v[216:219]
v_accvgpr_read_b32 v58, a170
v_mfma_f32_16x16x32_bf16 v[192:195], a[108:111], a[40:43], v[192:195]
buffer_load_dwordx4 a[24:27], v2, s[40:43], s35 offen offset:2048 sc1
v_mfma_f32_16x16x32_bf16 v[168:171], a[108:111], a[36:39], v[168:171]
ds_read_b128 a[152:155], v6 offset:29696
v_mfma_f32_16x16x32_bf16 v[144:147], a[108:111], a[32:35], v[144:147]
v_mfma_f32_16x16x32_bf16 v[148:151], a[112:115], a[32:35], v[148:151]
v_mfma_f32_16x16x32_bf16 v[172:175], a[112:115], a[36:39], v[172:175]
buffer_load_dwordx4 v[100:103], v1, s[4:7], s88 offen offset:2048 sc1
v_mfma_f32_16x16x32_bf16 v[196:199], a[112:115], a[40:43], v[196:199]
v_accvgpr_read_b32 v59, a171
v_mfma_f32_16x16x32_bf16 v[220:223], a[112:115], a[44:47], v[220:223]
v_mfma_f32_16x16x32_bf16 v[224:227], a[116:119], a[44:47], v[224:227]
v_mfma_f32_16x16x32_bf16 v[200:203], a[116:119], a[40:43], v[200:203]
buffer_load_dwordx4 a[28:31], v2, s[40:43], s35 offen offset:3072 sc1
s_add_u32 s35, s35, 4096
v_mfma_f32_16x16x32_bf16 v[176:179], a[116:119], a[36:39], v[176:179]
v_mfma_f32_16x16x32_bf16 v[152:155], a[116:119], a[32:35], v[152:155]
v_mfma_f32_16x16x32_bf16 a[88:91], a[120:123], a[68:71], a[88:91]
s_waitcnt vmcnt(11) lgkmcnt(0)
s_barrier
v_mfma_f32_16x16x32_bf16 v[132:135], a[128:131], a[48:51], v[132:135]
v_add_u32 v5, 49152, v1
v_add_u32 v6, s55, v5
v_mfma_f32_16x16x32_bf16 v[156:159], a[128:131], a[52:55], v[156:159]
buffer_load_dwordx4 a[32:35], v2, s[40:43], s35 offen offset:0 sc1
v_mfma_f32_16x16x32_bf16 v[180:183], a[128:131], a[56:59], v[180:183]
ds_read_b128 a[96:99], v5 offset:0
v_accvgpr_read_b32 v60, a172
v_mfma_f32_16x16x32_bf16 v[204:207], a[128:131], a[60:63], v[204:207]
ds_read_b128 a[100:103], v5 offset:1024
v_mfma_f32_16x16x32_bf16 v[208:211], a[132:135], a[60:63], v[208:211]
ds_read_b128 a[104:107], v5 offset:2048
v_mfma_f32_16x16x32_bf16 v[184:187], a[132:135], a[56:59], v[184:187]
buffer_load_dwordx4 v[104:107], v1, s[4:7], s88 offen offset:3072 sc1
s_add_u32 s88, s88, 4096
v_mfma_f32_16x16x32_bf16 v[160:163], a[132:135], a[52:55], v[160:163]
ds_read_b128 a[108:111], v5 offset:3072
v_accvgpr_read_b32 v61, a173
v_mfma_f32_16x16x32_bf16 v[136:139], a[132:135], a[48:51], v[136:139]
v_mfma_f32_16x16x32_bf16 v[140:143], a[136:139], a[48:51], v[140:143]
v_mfma_f32_16x16x32_bf16 v[164:167], a[136:139], a[52:55], v[164:167]
buffer_load_dwordx4 a[36:39], v2, s[40:43], s35 offen offset:1024 sc1
v_mfma_f32_16x16x32_bf16 v[188:191], a[136:139], a[56:59], v[188:191]
ds_read_b128 a[112:115], v5 offset:4096
v_mfma_f32_16x16x32_bf16 v[212:215], a[136:139], a[60:63], v[212:215]
ds_read_b128 a[116:119], v5 offset:5120
v_mfma_f32_16x16x32_bf16 v[216:219], a[140:143], a[60:63], v[216:219]
v_accvgpr_read_b32 v62, a174
v_mfma_f32_16x16x32_bf16 v[192:195], a[140:143], a[56:59], v[192:195]
buffer_load_dwordx4 a[40:43], v2, s[40:43], s35 offen offset:2048 sc1
v_mfma_f32_16x16x32_bf16 v[168:171], a[140:143], a[52:55], v[168:171]
ds_read_b128 a[120:123], v6 offset:2048
v_mfma_f32_16x16x32_bf16 v[144:147], a[140:143], a[48:51], v[144:147]
v_mfma_f32_16x16x32_bf16 v[148:151], a[144:147], a[48:51], v[148:151]
v_mfma_f32_16x16x32_bf16 v[172:175], a[144:147], a[52:55], v[172:175]
buffer_load_dwordx4 v[108:111], v1, s[4:7], s88 offen offset:0 sc1
s_add_u32 s63, s28, 12
v_mfma_f32_16x16x32_bf16 v[196:199], a[144:147], a[56:59], v[196:199]
s_lshl_b32 s63, s63, 12
v_accvgpr_read_b32 v63, a175
v_mfma_f32_16x16x32_bf16 v[220:223], a[144:147], a[60:63], v[220:223]
v_mfma_f32_16x16x32_bf16 v[224:227], a[148:151], a[60:63], v[224:227]
v_mfma_f32_16x16x32_bf16 v[200:203], a[148:151], a[56:59], v[200:203]
buffer_load_dwordx4 a[44:47], v2, s[40:43], s35 offen offset:3072 sc1
s_add_u32 s35, s35, 4096
v_mfma_f32_16x16x32_bf16 v[176:179], a[148:151], a[52:55], v[176:179]
v_mfma_f32_16x16x32_bf16 v[152:155], a[148:151], a[48:51], v[152:155]
v_mfma_f32_16x16x32_bf16 a[92:95], a[152:155], a[68:71], a[92:95]
s_waitcnt vmcnt(12) lgkmcnt(0)
v_mfma_f32_16x16x32_bf16 v[132:135], a[96:99], a[0:3], v[132:135]
ds_read_b128 a[128:131], v5 offset:6144
v_accvgpr_read_b32 v64, a176
v_mfma_f32_16x16x32_bf16 v[156:159], a[96:99], a[4:7], v[156:159]
buffer_load_dwordx4 a[48:51], v2, s[40:43], s35 offen offset:0 sc1
v_mfma_f32_16x16x32_bf16 v[180:183], a[96:99], a[8:11], v[180:183]
ds_read_b128 a[132:135], v5 offset:7168
v_mfma_f32_16x16x32_bf16 v[204:207], a[96:99], a[12:15], v[204:207]
v_mfma_f32_16x16x32_bf16 v[208:211], a[100:103], a[12:15], v[208:211]
ds_read_b128 a[136:139], v5 offset:8192
v_mfma_f32_16x16x32_bf16 v[184:187], a[100:103], a[8:11], v[184:187]
v_mfma_f32_16x16x32_bf16 v[160:163], a[100:103], a[4:7], v[160:163]
buffer_load_dwordx4 a[52:55], v2, s[40:43], s35 offen offset:1024 sc1
v_mfma_f32_16x16x32_bf16 v[136:139], a[100:103], a[0:3], v[136:139]
ds_read_b128 a[140:143], v5 offset:9216
v_accvgpr_read_b32 v65, a177
v_mfma_f32_16x16x32_bf16 v[140:143], a[104:107], a[0:3], v[140:143]
v_mfma_f32_16x16x32_bf16 v[164:167], a[104:107], a[4:7], v[164:167]
ds_read_b128 a[144:147], v5 offset:10240
v_mfma_f32_16x16x32_bf16 v[188:191], a[104:107], a[8:11], v[188:191]
v_mfma_f32_16x16x32_bf16 v[212:215], a[104:107], a[12:15], v[212:215]
buffer_load_dwordx4 a[64:67], v3, s[40:43], s63 offen sc1
v_mfma_f32_16x16x32_bf16 v[216:219], a[108:111], a[12:15], v[216:219]
ds_read_b128 a[148:151], v5 offset:11264
v_accvgpr_read_b32 v66, a178
v_mfma_f32_16x16x32_bf16 v[192:195], a[108:111], a[8:11], v[192:195]
ds_read_b128 a[152:155], v6 offset:3072
v_mfma_f32_16x16x32_bf16 v[168:171], a[108:111], a[4:7], v[168:171]
v_mfma_f32_16x16x32_bf16 v[144:147], a[108:111], a[0:3], v[144:147]
v_mfma_f32_16x16x32_bf16 v[148:151], a[112:115], a[0:3], v[148:151]
buffer_load_dwordx4 a[56:59], v2, s[40:43], s35 offen offset:2048 sc1
v_mfma_f32_16x16x32_bf16 v[172:175], a[112:115], a[4:7], v[172:175]
v_mfma_f32_16x16x32_bf16 v[196:199], a[112:115], a[8:11], v[196:199]
v_accvgpr_read_b32 v67, a179
v_mfma_f32_16x16x32_bf16 v[220:223], a[112:115], a[12:15], v[220:223]
v_mfma_f32_16x16x32_bf16 v[224:227], a[116:119], a[12:15], v[224:227]
v_mfma_f32_16x16x32_bf16 v[200:203], a[116:119], a[8:11], v[200:203]
buffer_load_dwordx4 a[60:63], v2, s[40:43], s35 offen offset:3072 sc1
s_add_u32 s35, s35, 4096
v_mfma_f32_16x16x32_bf16 v[176:179], a[116:119], a[4:7], v[176:179]
v_mfma_f32_16x16x32_bf16 v[152:155], a[116:119], a[0:3], v[152:155]
v_mfma_f32_16x16x32_bf16 a[80:83], a[120:123], a[72:75], a[80:83]
s_waitcnt vmcnt(11) lgkmcnt(0)
v_mfma_f32_16x16x32_bf16 v[132:135], a[128:131], a[16:19], v[132:135]
ds_read_b128 a[96:99], v5 offset:12288
v_accvgpr_read_b32 v68, a180
v_mfma_f32_16x16x32_bf16 v[156:159], a[128:131], a[20:23], v[156:159]
buffer_load_dwordx4 a[0:3], v2, s[40:43], s35 offen offset:0 sc1
v_mfma_f32_16x16x32_bf16 v[180:183], a[128:131], a[24:27], v[180:183]
ds_read_b128 a[100:103], v5 offset:13312
v_mfma_f32_16x16x32_bf16 v[204:207], a[128:131], a[28:31], v[204:207]
v_mfma_f32_16x16x32_bf16 v[208:211], a[132:135], a[28:31], v[208:211]
ds_read_b128 a[104:107], v5 offset:14336
v_mfma_f32_16x16x32_bf16 v[184:187], a[132:135], a[24:27], v[184:187]
buffer_load_dwordx4 v[112:115], v1, s[4:7], s88 offen offset:1024 sc1
v_mfma_f32_16x16x32_bf16 v[160:163], a[132:135], a[20:23], v[160:163]
ds_read_b128 a[108:111], v5 offset:15360
v_accvgpr_read_b32 v69, a181
v_mfma_f32_16x16x32_bf16 v[136:139], a[132:135], a[16:19], v[136:139]
v_mfma_f32_16x16x32_bf16 v[140:143], a[136:139], a[16:19], v[140:143]
v_mfma_f32_16x16x32_bf16 v[164:167], a[136:139], a[20:23], v[164:167]
buffer_load_dwordx4 a[4:7], v2, s[40:43], s35 offen offset:1024 sc1
v_mfma_f32_16x16x32_bf16 v[188:191], a[136:139], a[24:27], v[188:191]
ds_read_b128 a[112:115], v5 offset:16384
v_mfma_f32_16x16x32_bf16 v[212:215], a[136:139], a[28:31], v[212:215]
ds_read_b128 a[116:119], v5 offset:17408
v_mfma_f32_16x16x32_bf16 v[216:219], a[140:143], a[28:31], v[216:219]
v_accvgpr_read_b32 v70, a182
v_mfma_f32_16x16x32_bf16 v[192:195], a[140:143], a[24:27], v[192:195]
buffer_load_dwordx4 a[8:11], v2, s[40:43], s35 offen offset:2048 sc1
v_mfma_f32_16x16x32_bf16 v[168:171], a[140:143], a[20:23], v[168:171]
ds_read_b128 a[120:123], v6 offset:4096
v_mfma_f32_16x16x32_bf16 v[144:147], a[140:143], a[16:19], v[144:147]
v_mfma_f32_16x16x32_bf16 v[148:151], a[144:147], a[16:19], v[148:151]
v_mfma_f32_16x16x32_bf16 v[172:175], a[144:147], a[20:23], v[172:175]
buffer_load_dwordx4 v[116:119], v1, s[4:7], s88 offen offset:2048 sc1
v_mfma_f32_16x16x32_bf16 v[196:199], a[144:147], a[24:27], v[196:199]
v_accvgpr_read_b32 v71, a183
v_mfma_f32_16x16x32_bf16 v[220:223], a[144:147], a[28:31], v[220:223]
v_mfma_f32_16x16x32_bf16 v[224:227], a[148:151], a[28:31], v[224:227]
v_mfma_f32_16x16x32_bf16 v[200:203], a[148:151], a[24:27], v[200:203]
buffer_load_dwordx4 a[12:15], v2, s[40:43], s35 offen offset:3072 sc1
s_add_u32 s35, s35, 4096
v_mfma_f32_16x16x32_bf16 v[176:179], a[148:151], a[20:23], v[176:179]
v_mfma_f32_16x16x32_bf16 v[152:155], a[148:151], a[16:19], v[152:155]
v_mfma_f32_16x16x32_bf16 a[84:87], a[152:155], a[72:75], a[84:87]
s_waitcnt vmcnt(11) lgkmcnt(0)
v_mfma_f32_16x16x32_bf16 v[132:135], a[96:99], a[32:35], v[132:135]
ds_read_b128 a[128:131], v5 offset:18432
v_accvgpr_read_b32 v72, a184
v_mfma_f32_16x16x32_bf16 v[156:159], a[96:99], a[36:39], v[156:159]
buffer_load_dwordx4 a[16:19], v2, s[40:43], s35 offen offset:0 sc1
v_mfma_f32_16x16x32_bf16 v[180:183], a[96:99], a[40:43], v[180:183]
ds_read_b128 a[132:135], v5 offset:19456
v_mfma_f32_16x16x32_bf16 v[204:207], a[96:99], a[44:47], v[204:207]
v_mfma_f32_16x16x32_bf16 v[208:211], a[100:103], a[44:47], v[208:211]
ds_read_b128 a[136:139], v5 offset:20480
v_mfma_f32_16x16x32_bf16 v[184:187], a[100:103], a[40:43], v[184:187]
v_mfma_f32_16x16x32_bf16 v[160:163], a[100:103], a[36:39], v[160:163]
buffer_load_dwordx4 a[20:23], v2, s[40:43], s35 offen offset:1024 sc1
v_mfma_f32_16x16x32_bf16 v[136:139], a[100:103], a[32:35], v[136:139]
ds_read_b128 a[140:143], v5 offset:21504
v_accvgpr_read_b32 v73, a185
v_mfma_f32_16x16x32_bf16 v[140:143], a[104:107], a[32:35], v[140:143]
v_mfma_f32_16x16x32_bf16 v[164:167], a[104:107], a[36:39], v[164:167]
ds_read_b128 a[144:147], v5 offset:22528
v_mfma_f32_16x16x32_bf16 v[188:191], a[104:107], a[40:43], v[188:191]
v_mfma_f32_16x16x32_bf16 v[212:215], a[104:107], a[44:47], v[212:215]
buffer_load_dwordx4 v[120:123], v1, s[4:7], s88 offen offset:3072 sc1
s_add_u32 s88, s83, 0x280000
v_mfma_f32_16x16x32_bf16 v[216:219], a[108:111], a[44:47], v[216:219]
ds_read_b128 a[148:151], v5 offset:23552
v_accvgpr_read_b32 v74, a186
v_mfma_f32_16x16x32_bf16 v[192:195], a[108:111], a[40:43], v[192:195]
ds_read_b128 a[152:155], v6 offset:5120
v_mfma_f32_16x16x32_bf16 v[168:171], a[108:111], a[36:39], v[168:171]
v_mfma_f32_16x16x32_bf16 v[144:147], a[108:111], a[32:35], v[144:147]
v_mfma_f32_16x16x32_bf16 v[148:151], a[112:115], a[32:35], v[148:151]
buffer_load_dwordx4 a[24:27], v2, s[40:43], s35 offen offset:2048 sc1
v_mfma_f32_16x16x32_bf16 v[172:175], a[112:115], a[36:39], v[172:175]
v_mfma_f32_16x16x32_bf16 v[196:199], a[112:115], a[40:43], v[196:199]
v_accvgpr_read_b32 v75, a187
v_mfma_f32_16x16x32_bf16 v[220:223], a[112:115], a[44:47], v[220:223]
v_mfma_f32_16x16x32_bf16 v[224:227], a[116:119], a[44:47], v[224:227]
v_mfma_f32_16x16x32_bf16 v[200:203], a[116:119], a[40:43], v[200:203]
buffer_load_dwordx4 a[28:31], v2, s[40:43], s35 offen offset:3072 sc1
s_add_u32 s35, s35, 4096
v_mfma_f32_16x16x32_bf16 v[176:179], a[116:119], a[36:39], v[176:179]
v_mfma_f32_16x16x32_bf16 v[152:155], a[116:119], a[32:35], v[152:155]
v_mfma_f32_16x16x32_bf16 a[88:91], a[120:123], a[72:75], a[88:91]
s_waitcnt vmcnt(11) lgkmcnt(0)
v_mfma_f32_16x16x32_bf16 v[132:135], a[128:131], a[48:51], v[132:135]
ds_read_b128 a[96:99], v5 offset:24576
v_mfma_f32_16x16x32_bf16 v[156:159], a[128:131], a[52:55], v[156:159]
buffer_load_dwordx4 a[32:35], v2, s[40:43], s35 offen offset:0 sc1
v_mfma_f32_16x16x32_bf16 v[180:183], a[128:131], a[56:59], v[180:183]
ds_read_b128 a[100:103], v5 offset:25600
v_mfma_f32_16x16x32_bf16 v[204:207], a[128:131], a[60:63], v[204:207]
v_mfma_f32_16x16x32_bf16 v[208:211], a[132:135], a[60:63], v[208:211]
ds_read_b128 a[104:107], v5 offset:26624
v_mfma_f32_16x16x32_bf16 v[184:187], a[132:135], a[56:59], v[184:187]
buffer_load_dwordx4 v[124:127], v1, s[4:7], s88 offen offset:0 sc1
v_mfma_f32_16x16x32_bf16 v[160:163], a[132:135], a[52:55], v[160:163]
ds_read_b128 a[108:111], v5 offset:27648
v_mfma_f32_16x16x32_bf16 v[136:139], a[132:135], a[48:51], v[136:139]
v_mfma_f32_16x16x32_bf16 v[140:143], a[136:139], a[48:51], v[140:143]
v_mfma_f32_16x16x32_bf16 v[164:167], a[136:139], a[52:55], v[164:167]
buffer_load_dwordx4 a[36:39], v2, s[40:43], s35 offen offset:1024 sc1
v_mfma_f32_16x16x32_bf16 v[188:191], a[136:139], a[56:59], v[188:191]
ds_read_b128 a[112:115], v5 offset:28672
v_mfma_f32_16x16x32_bf16 v[212:215], a[136:139], a[60:63], v[212:215]
ds_read_b128 a[116:119], v5 offset:29696
v_mfma_f32_16x16x32_bf16 v[216:219], a[140:143], a[60:63], v[216:219]
v_mfma_f32_16x16x32_bf16 v[192:195], a[140:143], a[56:59], v[192:195]
buffer_load_dwordx4 a[40:43], v2, s[40:43], s35 offen offset:2048 sc1
v_mfma_f32_16x16x32_bf16 v[168:171], a[140:143], a[52:55], v[168:171]
ds_read_b128 a[120:123], v6 offset:26624
v_mfma_f32_16x16x32_bf16 v[144:147], a[140:143], a[48:51], v[144:147]
v_mfma_f32_16x16x32_bf16 v[148:151], a[144:147], a[48:51], v[148:151]
v_mfma_f32_16x16x32_bf16 v[172:175], a[144:147], a[52:55], v[172:175]
buffer_load_dwordx4 v[128:131], v1, s[4:7], s88 offen offset:1024 sc1
s_add_u32 m0, s18, 0x0
v_mfma_f32_16x16x32_bf16 v[196:199], a[144:147], a[56:59], v[196:199]
s_add_u32 s44, s50, 0xe24000
v_mfma_f32_16x16x32_bf16 v[220:223], a[144:147], a[60:63], v[220:223]
v_mfma_f32_16x16x32_bf16 v[224:227], a[148:151], a[60:63], v[224:227]
v_mfma_f32_16x16x32_bf16 v[200:203], a[148:151], a[56:59], v[200:203]
buffer_load_dwordx4 a[44:47], v2, s[40:43], s35 offen offset:3072 sc1
s_add_u32 s35, s35, 4096
v_mfma_f32_16x16x32_bf16 v[176:179], a[148:151], a[52:55], v[176:179]
v_mfma_f32_16x16x32_bf16 v[152:155], a[148:151], a[48:51], v[152:155]
v_mfma_f32_16x16x32_bf16 a[92:95], a[152:155], a[72:75], a[92:95]
s_waitcnt vmcnt(11) lgkmcnt(0)
v_mfma_f32_16x16x32_bf16 v[132:135], a[96:99], a[0:3], v[132:135]
ds_read_b128 a[128:131], v5 offset:30720
v_mfma_f32_16x16x32_bf16 v[156:159], a[96:99], a[4:7], v[156:159]
buffer_load_dwordx4 a[48:51], v2, s[40:43], s35 offen offset:0 sc1
v_mfma_f32_16x16x32_bf16 v[180:183], a[96:99], a[8:11], v[180:183]
ds_read_b128 a[132:135], v5 offset:31744
v_mfma_f32_16x16x32_bf16 v[204:207], a[96:99], a[12:15], v[204:207]
v_mfma_f32_16x16x32_bf16 v[208:211], a[100:103], a[12:15], v[208:211]
ds_read_b128 a[136:139], v5 offset:32768
v_mfma_f32_16x16x32_bf16 v[184:187], a[100:103], a[8:11], v[184:187]
buffer_load_dwordx4 v1, s[4:7], s44 offen offset:0 sc1 lds
L_stub11:
s_cbranch_execz L_stub12
s_add_u32 s63, s28, 16
v_mfma_f32_16x16x32_bf16 v[160:163], a[100:103], a[4:7], v[160:163]
s_lshl_b32 s63, s63, 12
ds_read_b128 a[140:143], v5 offset:33792
v_mfma_f32_16x16x32_bf16 v[136:139], a[100:103], a[0:3], v[136:139]
v_mfma_f32_16x16x32_bf16 v[140:143], a[104:107], a[0:3], v[140:143]
v_mfma_f32_16x16x32_bf16 v[164:167], a[104:107], a[4:7], v[164:167]
buffer_load_dwordx4 a[52:55], v2, s[40:43], s35 offen offset:1024 sc1
v_mfma_f32_16x16x32_bf16 v[188:191], a[104:107], a[8:11], v[188:191]
ds_read_b128 a[144:147], v5 offset:34816
v_mfma_f32_16x16x32_bf16 v[212:215], a[104:107], a[12:15], v[212:215]
ds_read_b128 a[148:151], v5 offset:35840
v_mfma_f32_16x16x32_bf16 v[216:219], a[108:111], a[12:15], v[216:219]
v_mfma_f32_16x16x32_bf16 v[192:195], a[108:111], a[8:11], v[192:195]
buffer_load_dwordx4 a[56:59], v2, s[40:43], s35 offen offset:2048 sc1
v_mfma_f32_16x16x32_bf16 v[168:171], a[108:111], a[4:7], v[168:171]
ds_read_b128 a[152:155], v6 offset:27648
v_mfma_f32_16x16x32_bf16 v[144:147], a[108:111], a[0:3], v[144:147]
v_mfma_f32_16x16x32_bf16 v[148:151], a[112:115], a[0:3], v[148:151]
v_mfma_f32_16x16x32_bf16 v[172:175], a[112:115], a[4:7], v[172:175]
buffer_load_dwordx4 a[68:71], v3, s[40:43], s63 offen sc1
v_mfma_f32_16x16x32_bf16 v[196:199], a[112:115], a[8:11], v[196:199]
v_mfma_f32_16x16x32_bf16 v[220:223], a[112:115], a[12:15], v[220:223]
v_mfma_f32_16x16x32_bf16 v[224:227], a[116:119], a[12:15], v[224:227]
v_mfma_f32_16x16x32_bf16 v[200:203], a[116:119], a[8:11], v[200:203]
buffer_load_dwordx4 a[60:63], v2, s[40:43], s35 offen offset:3072 sc1
s_add_u32 s35, s35, 4096
v_mfma_f32_16x16x32_bf16 v[176:179], a[116:119], a[4:7], v[176:179]
v_mfma_f32_16x16x32_bf16 v[152:155], a[116:119], a[0:3], v[152:155]
v_mfma_f32_16x16x32_bf16 a[80:83], a[120:123], a[64:67], a[80:83]
s_waitcnt vmcnt(12) lgkmcnt(0)
v_mfma_f32_16x16x32_bf16 v[132:135], a[128:131], a[16:19], v[132:135]
ds_read_b128 a[96:99], v5 offset:36864
v_mfma_f32_16x16x32_bf16 v[156:159], a[128:131], a[20:23], v[156:159]
buffer_load_dwordx4 a[0:3], v2, s[40:43], s35 offen offset:0 sc1
v_mfma_f32_16x16x32_bf16 v[180:183], a[128:131], a[24:27], v[180:183]
ds_read_b128 a[100:103], v5 offset:37888
v_mfma_f32_16x16x32_bf16 v[204:207], a[128:131], a[28:31], v[204:207]
v_mfma_f32_16x16x32_bf16 v[208:211], a[132:135], a[28:31], v[208:211]
ds_read_b128 a[104:107], v5 offset:38912
v_mfma_f32_16x16x32_bf16 v[184:187], a[132:135], a[24:27], v[184:187]
v_mfma_f32_16x16x32_bf16 v[160:163], a[132:135], a[20:23], v[160:163]
buffer_load_dwordx4 a[4:7], v2, s[40:43], s35 offen offset:1024 sc1
v_mfma_f32_16x16x32_bf16 v[136:139], a[132:135], a[16:19], v[136:139]
ds_read_b128 a[108:111], v5 offset:39936
v_mfma_f32_16x16x32_bf16 v[140:143], a[136:139], a[16:19], v[140:143]
v_mfma_f32_16x16x32_bf16 v[164:167], a[136:139], a[20:23], v[164:167]
ds_read_b128 a[112:115], v5 offset:40960
v_mfma_f32_16x16x32_bf16 v[188:191], a[136:139], a[24:27], v[188:191]
v_mfma_f32_16x16x32_bf16 v[212:215], a[136:139], a[28:31], v[212:215]
buffer_load_dwordx4 v1, s[4:7], s44 offen offset:1024 sc1 lds
v_mfma_f32_16x16x32_bf16 v[216:219], a[140:143], a[28:31], v[216:219]
ds_read_b128 a[116:119], v5 offset:41984
v_mfma_f32_16x16x32_bf16 v[192:195], a[140:143], a[24:27], v[192:195]
ds_read_b128 a[120:123], v6 offset:28672
v_mfma_f32_16x16x32_bf16 v[168:171], a[140:143], a[20:23], v[168:171]
v_mfma_f32_16x16x32_bf16 v[144:147], a[140:143], a[16:19], v[144:147]
v_mfma_f32_16x16x32_bf16 v[148:151], a[144:147], a[16:19], v[148:151]
buffer_load_dwordx4 a[8:11], v2, s[40:43], s35 offen offset:2048 sc1
v_mfma_f32_16x16x32_bf16 v[172:175], a[144:147], a[20:23], v[172:175]
v_mfma_f32_16x16x32_bf16 v[196:199], a[144:147], a[24:27], v[196:199]
v_mfma_f32_16x16x32_bf16 v[220:223], a[144:147], a[28:31], v[220:223]
v_mfma_f32_16x16x32_bf16 v[224:227], a[148:151], a[28:31], v[224:227]
v_mfma_f32_16x16x32_bf16 v[200:203], a[148:151], a[24:27], v[200:203]
buffer_load_dwordx4 a[12:15], v2, s[40:43], s35 offen offset:3072 sc1
s_add_u32 s35, s35, 4096
v_mfma_f32_16x16x32_bf16 v[176:179], a[148:151], a[20:23], v[176:179]
v_mfma_f32_16x16x32_bf16 v[152:155], a[148:151], a[16:19], v[152:155]
v_mfma_f32_16x16x32_bf16 a[84:87], a[152:155], a[64:67], a[84:87]
s_waitcnt vmcnt(11) lgkmcnt(0)
v_mfma_f32_16x16x32_bf16 v[132:135], a[96:99], a[32:35], v[132:135]
ds_read_b128 a[128:131], v5 offset:43008
v_mfma_f32_16x16x32_bf16 v[156:159], a[96:99], a[36:39], v[156:159]
buffer_load_dwordx4 a[16:19], v2, s[40:43], s35 offen offset:0 sc1
v_mfma_f32_16x16x32_bf16 v[180:183], a[96:99], a[40:43], v[180:183]
ds_read_b128 a[132:135], v5 offset:44032
v_mfma_f32_16x16x32_bf16 v[204:207], a[96:99], a[44:47], v[204:207]
v_mfma_f32_16x16x32_bf16 v[208:211], a[100:103], a[44:47], v[208:211]
ds_read_b128 a[136:139], v5 offset:45056
v_mfma_f32_16x16x32_bf16 v[184:187], a[100:103], a[40:43], v[184:187]
buffer_load_dwordx4 v1, s[4:7], s44 offen offset:2048 sc1 lds
s_add_u32 m0, s18, 0x3000
v_mfma_f32_16x16x32_bf16 v[160:163], a[100:103], a[36:39], v[160:163]
s_add_u32 s44, s50, 0xe27000
ds_read_b128 a[140:143], v5 offset:46080
v_mfma_f32_16x16x32_bf16 v[136:139], a[100:103], a[32:35], v[136:139]
v_mfma_f32_16x16x32_bf16 v[140:143], a[104:107], a[32:35], v[140:143]
v_mfma_f32_16x16x32_bf16 v[164:167], a[104:107], a[36:39], v[164:167]
buffer_load_dwordx4 a[20:23], v2, s[40:43], s35 offen offset:1024 sc1
v_mfma_f32_16x16x32_bf16 v[188:191], a[104:107], a[40:43], v[188:191]
ds_read_b128 a[144:147], v5 offset:47104
v_mfma_f32_16x16x32_bf16 v[212:215], a[104:107], a[44:47], v[212:215]
ds_read_b128 a[148:151], v5 offset:48128
v_mfma_f32_16x16x32_bf16 v[216:219], a[108:111], a[44:47], v[216:219]
v_mfma_f32_16x16x32_bf16 v[192:195], a[108:111], a[40:43], v[192:195]
buffer_load_dwordx4 a[24:27], v2, s[40:43], s35 offen offset:2048 sc1
v_mfma_f32_16x16x32_bf16 v[168:171], a[108:111], a[36:39], v[168:171]
ds_read_b128 a[152:155], v6 offset:29696
v_mfma_f32_16x16x32_bf16 v[144:147], a[108:111], a[32:35], v[144:147]
v_mfma_f32_16x16x32_bf16 v[148:151], a[112:115], a[32:35], v[148:151]
v_mfma_f32_16x16x32_bf16 v[172:175], a[112:115], a[36:39], v[172:175]
buffer_load_dwordx4 v1, s[4:7], s44 offen offset:0 sc1 lds
v_mfma_f32_16x16x32_bf16 v[196:199], a[112:115], a[40:43], v[196:199]
v_mfma_f32_16x16x32_bf16 v[220:223], a[112:115], a[44:47], v[220:223]
v_mfma_f32_16x16x32_bf16 v[224:227], a[116:119], a[44:47], v[224:227]
v_mfma_f32_16x16x32_bf16 v[200:203], a[116:119], a[40:43], v[200:203]
buffer_load_dwordx4 a[28:31], v2, s[40:43], s35 offen offset:3072 sc1
s_add_u32 s35, s35, 4096
v_mfma_f32_16x16x32_bf16 v[176:179], a[116:119], a[36:39], v[176:179]
v_mfma_f32_16x16x32_bf16 v[152:155], a[116:119], a[32:35], v[152:155]
v_mfma_f32_16x16x32_bf16 a[88:91], a[120:123], a[64:67], a[88:91]
s_waitcnt vmcnt(11) lgkmcnt(0)
s_barrier
v_mfma_f32_16x16x32_bf16 v[132:135], a[128:131], a[48:51], v[132:135]
v_add_u32 v5, 98304, v1
v_add_u32 v6, s55, v5
v_mfma_f32_16x16x32_bf16 v[156:159], a[128:131], a[52:55], v[156:159]
buffer_load_dwordx4 a[32:35], v2, s[40:43], s35 offen offset:0 sc1
v_mfma_f32_16x16x32_bf16 v[180:183], a[128:131], a[56:59], v[180:183]
ds_read_b128 a[96:99], v5 offset:0
v_mfma_f32_16x16x32_bf16 v[204:207], a[128:131], a[60:63], v[204:207]
ds_read_b128 a[100:103], v5 offset:1024
v_mfma_f32_16x16x32_bf16 v[208:211], a[132:135], a[60:63], v[208:211]
ds_read_b128 a[104:107], v5 offset:2048
v_mfma_f32_16x16x32_bf16 v[184:187], a[132:135], a[56:59], v[184:187]
v_mfma_f32_16x16x32_bf16 v[160:163], a[132:135], a[52:55], v[160:163]
buffer_load_dwordx4 a[36:39], v2, s[40:43], s35 offen offset:1024 sc1
v_mfma_f32_16x16x32_bf16 v[136:139], a[132:135], a[48:51], v[136:139]
ds_read_b128 a[108:111], v5 offset:3072
v_mfma_f32_16x16x32_bf16 v[140:143], a[136:139], a[48:51], v[140:143]
v_mfma_f32_16x16x32_bf16 v[164:167], a[136:139], a[52:55], v[164:167]
ds_read_b128 a[112:115], v5 offset:4096
v_mfma_f32_16x16x32_bf16 v[188:191], a[136:139], a[56:59], v[188:191]
v_mfma_f32_16x16x32_bf16 v[212:215], a[136:139], a[60:63], v[212:215]
buffer_load_dwordx4 v1, s[4:7], s44 offen offset:1024 sc1 lds
v_mfma_f32_16x16x32_bf16 v[216:219], a[140:143], a[60:63], v[216:219]
ds_read_b128 a[116:119], v5 offset:5120
v_mfma_f32_16x16x32_bf16 v[192:195], a[140:143], a[56:59], v[192:195]
ds_read_b128 a[120:123], v6 offset:2048
v_mfma_f32_16x16x32_bf16 v[168:171], a[140:143], a[52:55], v[168:171]
v_mfma_f32_16x16x32_bf16 v[144:147], a[140:143], a[48:51], v[144:147]
v_mfma_f32_16x16x32_bf16 v[148:151], a[144:147], a[48:51], v[148:151]
buffer_load_dwordx4 a[40:43], v2, s[40:43], s35 offen offset:2048 sc1
v_mfma_f32_16x16x32_bf16 v[172:175], a[144:147], a[52:55], v[172:175]
v_mfma_f32_16x16x32_bf16 v[196:199], a[144:147], a[56:59], v[196:199]
v_mfma_f32_16x16x32_bf16 v[220:223], a[144:147], a[60:63], v[220:223]
v_mfma_f32_16x16x32_bf16 v[224:227], a[148:151], a[60:63], v[224:227]
v_mfma_f32_16x16x32_bf16 v[200:203], a[148:151], a[56:59], v[200:203]
buffer_load_dwordx4 a[44:47], v2, s[40:43], s35 offen offset:3072 sc1
s_add_u32 s35, s35, 4096
v_mfma_f32_16x16x32_bf16 v[176:179], a[148:151], a[52:55], v[176:179]
v_mfma_f32_16x16x32_bf16 v[152:155], a[148:151], a[48:51], v[152:155]
v_mfma_f32_16x16x32_bf16 a[92:95], a[152:155], a[64:67], a[92:95]
s_waitcnt vmcnt(11) lgkmcnt(0)
v_mfma_f32_16x16x32_bf16 v[132:135], a[96:99], a[0:3], v[132:135]
ds_read_b128 a[128:131], v5 offset:6144
v_mfma_f32_16x16x32_bf16 v[156:159], a[96:99], a[4:7], v[156:159]
buffer_load_dwordx4 a[48:51], v2, s[40:43], s35 offen offset:0 sc1
v_mfma_f32_16x16x32_bf16 v[180:183], a[96:99], a[8:11], v[180:183]
ds_read_b128 a[132:135], v5 offset:7168
v_mfma_f32_16x16x32_bf16 v[204:207], a[96:99], a[12:15], v[204:207]
v_mfma_f32_16x16x32_bf16 v[208:211], a[100:103], a[12:15], v[208:211]
ds_read_b128 a[136:139], v5 offset:8192
v_mfma_f32_16x16x32_bf16 v[184:187], a[100:103], a[8:11], v[184:187]
buffer_load_dwordx4 v1, s[4:7], s44 offen offset:2048 sc1 lds
s_add_u32 s63, s28, 20
v_mfma_f32_16x16x32_bf16 v[160:163], a[100:103], a[4:7], v[160:163]
s_lshl_b32 s63, s63, 12
ds_read_b128 a[140:143], v5 offset:9216
v_mfma_f32_16x16x32_bf16 v[136:139], a[100:103], a[0:3], v[136:139]
v_mfma_f32_16x16x32_bf16 v[140:143], a[104:107], a[0:3], v[140:143]
v_mfma_f32_16x16x32_bf16 v[164:167], a[104:107], a[4:7], v[164:167]
buffer_load_dwordx4 a[52:55], v2, s[40:43], s35 offen offset:1024 sc1
v_mfma_f32_16x16x32_bf16 v[188:191], a[104:107], a[8:11], v[188:191]
ds_read_b128 a[144:147], v5 offset:10240
v_mfma_f32_16x16x32_bf16 v[212:215], a[104:107], a[12:15], v[212:215]
ds_read_b128 a[148:151], v5 offset:11264
v_mfma_f32_16x16x32_bf16 v[216:219], a[108:111], a[12:15], v[216:219]
v_mfma_f32_16x16x32_bf16 v[192:195], a[108:111], a[8:11], v[192:195]
buffer_load_dwordx4 a[56:59], v2, s[40:43], s35 offen offset:2048 sc1
v_mfma_f32_16x16x32_bf16 v[168:171], a[108:111], a[4:7], v[168:171]
ds_read_b128 a[152:155], v6 offset:3072
v_mfma_f32_16x16x32_bf16 v[144:147], a[108:111], a[0:3], v[144:147]
v_mfma_f32_16x16x32_bf16 v[148:151], a[112:115], a[0:3], v[148:151]
v_mfma_f32_16x16x32_bf16 v[172:175], a[112:115], a[4:7], v[172:175]
buffer_load_dwordx4 a[72:75], v3, s[40:43], s63 offen sc1
s_add_u32 m0, s18, 0x6000
v_mfma_f32_16x16x32_bf16 v[196:199], a[112:115], a[8:11], v[196:199]
s_add_u32 s44, s50, 0xe2a000
v_mfma_f32_16x16x32_bf16 v[220:223], a[112:115], a[12:15], v[220:223]
v_mfma_f32_16x16x32_bf16 v[224:227], a[116:119], a[12:15], v[224:227]
v_mfma_f32_16x16x32_bf16 v[200:203], a[116:119], a[8:11], v[200:203]
buffer_load_dwordx4 a[60:63], v2, s[40:43], s35 offen offset:3072 sc1
s_add_u32 s35, s35, 4096
v_mfma_f32_16x16x32_bf16 v[176:179], a[116:119], a[4:7], v[176:179]
v_mfma_f32_16x16x32_bf16 v[152:155], a[116:119], a[0:3], v[152:155]
v_mfma_f32_16x16x32_bf16 a[80:83], a[120:123], a[68:71], a[80:83]
s_waitcnt vmcnt(11) lgkmcnt(0)
v_mfma_f32_16x16x32_bf16 v[132:135], a[128:131], a[16:19], v[132:135]
ds_read_b128 a[96:99], v5 offset:12288
v_mfma_f32_16x16x32_bf16 v[156:159], a[128:131], a[20:23], v[156:159]
buffer_load_dwordx4 a[0:3], v2, s[40:43], s35 offen offset:0 sc1
v_mfma_f32_16x16x32_bf16 v[180:183], a[128:131], a[24:27], v[180:183]
ds_read_b128 a[100:103], v5 offset:13312
v_mfma_f32_16x16x32_bf16 v[204:207], a[128:131], a[28:31], v[204:207]
v_mfma_f32_16x16x32_bf16 v[208:211], a[132:135], a[28:31], v[208:211]
ds_read_b128 a[104:107], v5 offset:14336
v_mfma_f32_16x16x32_bf16 v[184:187], a[132:135], a[24:27], v[184:187]
buffer_load_dwordx4 v1, s[4:7], s44 offen offset:0 sc1 lds
v_mfma_f32_16x16x32_bf16 v[160:163], a[132:135], a[20:23], v[160:163]
ds_read_b128 a[108:111], v5 offset:15360
v_mfma_f32_16x16x32_bf16 v[136:139], a[132:135], a[16:19], v[136:139]
v_mfma_f32_16x16x32_bf16 v[140:143], a[136:139], a[16:19], v[140:143]
v_mfma_f32_16x16x32_bf16 v[164:167], a[136:139], a[20:23], v[164:167]
buffer_load_dwordx4 a[4:7], v2, s[40:43], s35 offen offset:1024 sc1
v_mfma_f32_16x16x32_bf16 v[188:191], a[136:139], a[24:27], v[188:191]
ds_read_b128 a[112:115], v5 offset:16384
v_mfma_f32_16x16x32_bf16 v[212:215], a[136:139], a[28:31], v[212:215]
ds_read_b128 a[116:119], v5 offset:17408
v_mfma_f32_16x16x32_bf16 v[216:219], a[140:143], a[28:31], v[216:219]
v_mfma_f32_16x16x32_bf16 v[192:195], a[140:143], a[24:27], v[192:195]
buffer_load_dwordx4 a[8:11], v2, s[40:43], s35 offen offset:2048 sc1
v_mfma_f32_16x16x32_bf16 v[168:171], a[140:143], a[20:23], v[168:171]
ds_read_b128 a[120:123], v6 offset:4096
v_mfma_f32_16x16x32_bf16 v[144:147], a[140:143], a[16:19], v[144:147]
v_mfma_f32_16x16x32_bf16 v[148:151], a[144:147], a[16:19], v[148:151]
v_mfma_f32_16x16x32_bf16 v[172:175], a[144:147], a[20:23], v[172:175]
buffer_load_dwordx4 v1, s[4:7], s44 offen offset:1024 sc1 lds
v_mfma_f32_16x16x32_bf16 v[196:199], a[144:147], a[24:27], v[196:199]
v_mfma_f32_16x16x32_bf16 v[220:223], a[144:147], a[28:31], v[220:223]
v_mfma_f32_16x16x32_bf16 v[224:227], a[148:151], a[28:31], v[224:227]
v_mfma_f32_16x16x32_bf16 v[200:203], a[148:151], a[24:27], v[200:203]
buffer_load_dwordx4 a[12:15], v2, s[40:43], s35 offen offset:3072 sc1
s_add_u32 s35, s35, 4096
v_mfma_f32_16x16x32_bf16 v[176:179], a[148:151], a[20:23], v[176:179]
v_mfma_f32_16x16x32_bf16 v[152:155], a[148:151], a[16:19], v[152:155]
v_mfma_f32_16x16x32_bf16 a[84:87], a[152:155], a[68:71], a[84:87]
s_waitcnt vmcnt(12) lgkmcnt(0)
v_mfma_f32_16x16x32_bf16 v[132:135], a[96:99], a[32:35], v[132:135]
ds_read_b128 a[128:131], v5 offset:18432
v_mfma_f32_16x16x32_bf16 v[156:159], a[96:99], a[36:39], v[156:159]
buffer_load_dwordx4 a[16:19], v2, s[40:43], s35 offen offset:0 sc1
v_mfma_f32_16x16x32_bf16 v[180:183], a[96:99], a[40:43], v[180:183]
ds_read_b128 a[132:135], v5 offset:19456
v_mfma_f32_16x16x32_bf16 v[204:207], a[96:99], a[44:47], v[204:207]
v_mfma_f32_16x16x32_bf16 v[208:211], a[100:103], a[44:47], v[208:211]
ds_read_b128 a[136:139], v5 offset:20480
v_mfma_f32_16x16x32_bf16 v[184:187], a[100:103], a[40:43], v[184:187]
v_mfma_f32_16x16x32_bf16 v[160:163], a[100:103], a[36:39], v[160:163]
buffer_load_dwordx4 a[20:23], v2, s[40:43], s35 offen offset:1024 sc1
v_mfma_f32_16x16x32_bf16 v[136:139], a[100:103], a[32:35], v[136:139]
ds_read_b128 a[140:143], v5 offset:21504
v_mfma_f32_16x16x32_bf16 v[140:143], a[104:107], a[32:35], v[140:143]
v_mfma_f32_16x16x32_bf16 v[164:167], a[104:107], a[36:39], v[164:167]
ds_read_b128 a[144:147], v5 offset:22528
v_mfma_f32_16x16x32_bf16 v[188:191], a[104:107], a[40:43], v[188:191]
v_mfma_f32_16x16x32_bf16 v[212:215], a[104:107], a[44:47], v[212:215]
buffer_load_dwordx4 v1, s[4:7], s44 offen offset:2048 sc1 lds
s_add_u32 m0, s18, 0x9000
v_mfma_f32_16x16x32_bf16 v[216:219], a[108:111], a[44:47], v[216:219]
s_add_u32 s44, s50, 0xe2d000
ds_read_b128 a[148:151], v5 offset:23552
v_mfma_f32_16x16x32_bf16 v[192:195], a[108:111], a[40:43], v[192:195]
ds_read_b128 a[152:155], v6 offset:5120
v_mfma_f32_16x16x32_bf16 v[168:171], a[108:111], a[36:39], v[168:171]
v_mfma_f32_16x16x32_bf16 v[144:147], a[108:111], a[32:35], v[144:147]
v_mfma_f32_16x16x32_bf16 v[148:151], a[112:115], a[32:35], v[148:151]
buffer_load_dwordx4 a[24:27], v2, s[40:43], s35 offen offset:2048 sc1
v_mfma_f32_16x16x32_bf16 v[172:175], a[112:115], a[36:39], v[172:175]
v_mfma_f32_16x16x32_bf16 v[196:199], a[112:115], a[40:43], v[196:199]
v_mfma_f32_16x16x32_bf16 v[220:223], a[112:115], a[44:47], v[220:223]
v_mfma_f32_16x16x32_bf16 v[224:227], a[116:119], a[44:47], v[224:227]
v_mfma_f32_16x16x32_bf16 v[200:203], a[116:119], a[40:43], v[200:203]
buffer_load_dwordx4 a[28:31], v2, s[40:43], s35 offen offset:3072 sc1
s_add_u32 s35, s35, 4096
v_mfma_f32_16x16x32_bf16 v[176:179], a[116:119], a[36:39], v[176:179]
v_mfma_f32_16x16x32_bf16 v[152:155], a[116:119], a[32:35], v[152:155]
v_mfma_f32_16x16x32_bf16 a[88:91], a[120:123], a[68:71], a[88:91]
s_waitcnt vmcnt(11) lgkmcnt(0)
s_barrier
v_mfma_f32_16x16x32_bf16 v[132:135], a[128:131], a[48:51], v[132:135]
ds_read_b128 a[96:99], v5 offset:24576
v_mfma_f32_16x16x32_bf16 v[156:159], a[128:131], a[52:55], v[156:159]
buffer_load_dwordx4 a[32:35], v2, s[40:43], s35 offen offset:0 sc1
v_mfma_f32_16x16x32_bf16 v[180:183], a[128:131], a[56:59], v[180:183]
ds_read_b128 a[100:103], v5 offset:25600
v_mfma_f32_16x16x32_bf16 v[204:207], a[128:131], a[60:63], v[204:207]
v_mfma_f32_16x16x32_bf16 v[208:211], a[132:135], a[60:63], v[208:211]
ds_read_b128 a[104:107], v5 offset:26624
v_mfma_f32_16x16x32_bf16 v[184:187], a[132:135], a[56:59], v[184:187]
buffer_load_dwordx4 v1, s[4:7], s44 offen offset:0 sc1 lds
v_mfma_f32_16x16x32_bf16 v[160:163], a[132:135], a[52:55], v[160:163]
ds_read_b128 a[108:111], v5 offset:27648
v_mfma_f32_16x16x32_bf16 v[136:139], a[132:135], a[48:51], v[136:139]
v_mfma_f32_16x16x32_bf16 v[140:143], a[136:139], a[48:51], v[140:143]
v_mfma_f32_16x16x32_bf16 v[164:167], a[136:139], a[52:55], v[164:167]
buffer_load_dwordx4 a[36:39], v2, s[40:43], s35 offen offset:1024 sc1
v_mfma_f32_16x16x32_bf16 v[188:191], a[136:139], a[56:59], v[188:191]
ds_read_b128 a[112:115], v5 offset:28672
v_mfma_f32_16x16x32_bf16 v[212:215], a[136:139], a[60:63], v[212:215]
ds_read_b128 a[116:119], v5 offset:29696
v_mfma_f32_16x16x32_bf16 v[216:219], a[140:143], a[60:63], v[216:219]
v_mfma_f32_16x16x32_bf16 v[192:195], a[140:143], a[56:59], v[192:195]
buffer_load_dwordx4 a[40:43], v2, s[40:43], s35 offen offset:2048 sc1
v_mfma_f32_16x16x32_bf16 v[168:171], a[140:143], a[52:55], v[168:171]
ds_read_b128 a[120:123], v6 offset:26624
v_mfma_f32_16x16x32_bf16 v[144:147], a[140:143], a[48:51], v[144:147]
v_mfma_f32_16x16x32_bf16 v[148:151], a[144:147], a[48:51], v[148:151]
v_mfma_f32_16x16x32_bf16 v[172:175], a[144:147], a[52:55], v[172:175]
buffer_load_dwordx4 v1, s[4:7], s44 offen offset:1024 sc1 lds
s_add_u32 s63, s28, 24
v_mfma_f32_16x16x32_bf16 v[196:199], a[144:147], a[56:59], v[196:199]
s_lshl_b32 s63, s63, 12
v_mfma_f32_16x16x32_bf16 v[220:223], a[144:147], a[60:63], v[220:223]
v_mfma_f32_16x16x32_bf16 v[224:227], a[148:151], a[60:63], v[224:227]
v_mfma_f32_16x16x32_bf16 v[200:203], a[148:151], a[56:59], v[200:203]
buffer_load_dwordx4 a[44:47], v2, s[40:43], s35 offen offset:3072 sc1
s_add_u32 s35, s35, 4096
v_mfma_f32_16x16x32_bf16 v[176:179], a[148:151], a[52:55], v[176:179]
v_mfma_f32_16x16x32_bf16 v[152:155], a[148:151], a[48:51], v[152:155]
v_mfma_f32_16x16x32_bf16 a[92:95], a[152:155], a[68:71], a[92:95]
s_waitcnt vmcnt(11) lgkmcnt(0)
v_mfma_f32_16x16x32_bf16 v[132:135], a[96:99], a[0:3], v[132:135]
ds_read_b128 a[128:131], v5 offset:30720
v_mfma_f32_16x16x32_bf16 v[156:159], a[96:99], a[4:7], v[156:159]
buffer_load_dwordx4 a[48:51], v2, s[40:43], s35 offen offset:0 sc1
v_mfma_f32_16x16x32_bf16 v[180:183], a[96:99], a[8:11], v[180:183]
ds_read_b128 a[132:135], v5 offset:31744
v_mfma_f32_16x16x32_bf16 v[204:207], a[96:99], a[12:15], v[204:207]
v_mfma_f32_16x16x32_bf16 v[208:211], a[100:103], a[12:15], v[208:211]
ds_read_b128 a[136:139], v5 offset:32768
v_mfma_f32_16x16x32_bf16 v[184:187], a[100:103], a[8:11], v[184:187]
v_mfma_f32_16x16x32_bf16 v[160:163], a[100:103], a[4:7], v[160:163]
buffer_load_dwordx4 a[52:55], v2, s[40:43], s35 offen offset:1024 sc1
v_mfma_f32_16x16x32_bf16 v[136:139], a[100:103], a[0:3], v[136:139]
ds_read_b128 a[140:143], v5 offset:33792
v_mfma_f32_16x16x32_bf16 v[140:143], a[104:107], a[0:3], v[140:143]
v_mfma_f32_16x16x32_bf16 v[164:167], a[104:107], a[4:7], v[164:167]
ds_read_b128 a[144:147], v5 offset:34816
v_mfma_f32_16x16x32_bf16 v[188:191], a[104:107], a[8:11], v[188:191]
v_mfma_f32_16x16x32_bf16 v[212:215], a[104:107], a[12:15], v[212:215]
buffer_load_dwordx4 a[64:67], v3, s[40:43], s63 offen sc1
v_mfma_f32_16x16x32_bf16 v[216:219], a[108:111], a[12:15], v[216:219]
ds_read_b128 a[148:151], v5 offset:35840
v_mfma_f32_16x16x32_bf16 v[192:195], a[108:111], a[8:11], v[192:195]
ds_read_b128 a[152:155], v6 offset:27648
v_mfma_f32_16x16x32_bf16 v[168:171], a[108:111], a[4:7], v[168:171]
v_mfma_f32_16x16x32_bf16 v[144:147], a[108:111], a[0:3], v[144:147]
v_mfma_f32_16x16x32_bf16 v[148:151], a[112:115], a[0:3], v[148:151]
buffer_load_dwordx4 a[56:59], v2, s[40:43], s35 offen offset:2048 sc1
v_mfma_f32_16x16x32_bf16 v[172:175], a[112:115], a[4:7], v[172:175]
v_mfma_f32_16x16x32_bf16 v[196:199], a[112:115], a[8:11], v[196:199]
v_mfma_f32_16x16x32_bf16 v[220:223], a[112:115], a[12:15], v[220:223]
v_mfma_f32_16x16x32_bf16 v[224:227], a[116:119], a[12:15], v[224:227]
v_mfma_f32_16x16x32_bf16 v[200:203], a[116:119], a[8:11], v[200:203]
buffer_load_dwordx4 a[60:63], v2, s[40:43], s35 offen offset:3072 sc1
s_add_u32 s35, s35, 4096
v_mfma_f32_16x16x32_bf16 v[176:179], a[116:119], a[4:7], v[176:179]
v_mfma_f32_16x16x32_bf16 v[152:155], a[116:119], a[0:3], v[152:155]
v_mfma_f32_16x16x32_bf16 a[80:83], a[120:123], a[72:75], a[80:83]
s_waitcnt vmcnt(11) lgkmcnt(0)
v_mfma_f32_16x16x32_bf16 v[132:135], a[128:131], a[16:19], v[132:135]
ds_read_b128 a[96:99], v5 offset:36864
v_mfma_f32_16x16x32_bf16 v[156:159], a[128:131], a[20:23], v[156:159]
buffer_load_dwordx4 a[0:3], v2, s[40:43], s35 offen offset:0 sc1
v_mfma_f32_16x16x32_bf16 v[180:183], a[128:131], a[24:27], v[180:183]
ds_read_b128 a[100:103], v5 offset:37888
v_mfma_f32_16x16x32_bf16 v[204:207], a[128:131], a[28:31], v[204:207]
v_mfma_f32_16x16x32_bf16 v[208:211], a[132:135], a[28:31], v[208:211]
ds_read_b128 a[104:107], v5 offset:38912
v_mfma_f32_16x16x32_bf16 v[184:187], a[132:135], a[24:27], v[184:187]
buffer_load_dwordx4 v1, s[4:7], s44 offen offset:2048 sc1 lds
s_add_u32 s63, s28, 28
v_mfma_f32_16x16x32_bf16 v[160:163], a[132:135], a[20:23], v[160:163]
s_lshl_b32 s63, s63, 12
ds_read_b128 a[108:111], v5 offset:39936
v_mfma_f32_16x16x32_bf16 v[136:139], a[132:135], a[16:19], v[136:139]
v_mfma_f32_16x16x32_bf16 v[140:143], a[136:139], a[16:19], v[140:143]
v_mfma_f32_16x16x32_bf16 v[164:167], a[136:139], a[20:23], v[164:167]
buffer_load_dwordx4 a[4:7], v2, s[40:43], s35 offen offset:1024 sc1
v_mfma_f32_16x16x32_bf16 v[188:191], a[136:139], a[24:27], v[188:191]
ds_read_b128 a[112:115], v5 offset:40960
v_mfma_f32_16x16x32_bf16 v[212:215], a[136:139], a[28:31], v[212:215]
ds_read_b128 a[116:119], v5 offset:41984
v_mfma_f32_16x16x32_bf16 v[216:219], a[140:143], a[28:31], v[216:219]
v_mfma_f32_16x16x32_bf16 v[192:195], a[140:143], a[24:27], v[192:195]
buffer_load_dwordx4 a[8:11], v2, s[40:43], s35 offen offset:2048 sc1
v_mfma_f32_16x16x32_bf16 v[168:171], a[140:143], a[20:23], v[168:171]
ds_read_b128 a[120:123], v6 offset:28672
v_mfma_f32_16x16x32_bf16 v[144:147], a[140:143], a[16:19], v[144:147]
v_mfma_f32_16x16x32_bf16 v[148:151], a[144:147], a[16:19], v[148:151]
v_mfma_f32_16x16x32_bf16 v[172:175], a[144:147], a[20:23], v[172:175]
buffer_load_dwordx4 a[68:71], v3, s[40:43], s63 offen sc1
s_add_u32 m0, s19, 49152
v_mfma_f32_16x16x32_bf16 v[196:199], a[144:147], a[24:27], v[196:199]
s_add_u32 s44, s85, 0xa04000
v_mfma_f32_16x16x32_bf16 v[220:223], a[144:147], a[28:31], v[220:223]
v_mfma_f32_16x16x32_bf16 v[224:227], a[148:151], a[28:31], v[224:227]
v_mfma_f32_16x16x32_bf16 v[200:203], a[148:151], a[24:27], v[200:203]
buffer_load_dwordx4 a[12:15], v2, s[40:43], s35 offen offset:3072 sc1
s_add_u32 s35, s35, 4096
v_mfma_f32_16x16x32_bf16 v[176:179], a[148:151], a[20:23], v[176:179]
v_mfma_f32_16x16x32_bf16 v[152:155], a[148:151], a[16:19], v[152:155]
v_mfma_f32_16x16x32_bf16 a[84:87], a[152:155], a[72:75], a[84:87]
s_waitcnt vmcnt(11) lgkmcnt(0)
v_mfma_f32_16x16x32_bf16 v[132:135], a[96:99], a[32:35], v[132:135]
ds_read_b128 a[128:131], v5 offset:43008
v_add_f32 v92, v92, v96
v_mfma_f32_16x16x32_bf16 v[156:159], a[96:99], a[36:39], v[156:159]
buffer_load_dwordx4 a[16:19], v2, s[40:43], s35 offen offset:0 sc1
v_mfma_f32_16x16x32_bf16 v[180:183], a[96:99], a[40:43], v[180:183]
ds_read_b128 a[132:135], v5 offset:44032
v_add_f32 v100, v100, v104
v_mfma_f32_16x16x32_bf16 v[204:207], a[96:99], a[44:47], v[204:207]
v_add_f32 v108, v108, v112
v_add_f32 v116, v116, v120
v_mfma_f32_16x16x32_bf16 v[208:211], a[100:103], a[44:47], v[208:211]
ds_read_b128 a[136:139], v5 offset:45056
v_add_f32 v124, v124, v128
v_mfma_f32_16x16x32_bf16 v[184:187], a[100:103], a[40:43], v[184:187]
v_add_f32 v93, v93, v97
v_add_f32 v101, v101, v105
v_mfma_f32_16x16x32_bf16 v[160:163], a[100:103], a[36:39], v[160:163]
buffer_load_dwordx4 a[20:23], v2, s[40:43], s35 offen offset:1024 sc1
v_mfma_f32_16x16x32_bf16 v[136:139], a[100:103], a[32:35], v[136:139]
ds_read_b128 a[140:143], v5 offset:46080
v_add_f32 v109, v109, v113
v_mfma_f32_16x16x32_bf16 v[140:143], a[104:107], a[32:35], v[140:143]
v_add_f32 v117, v117, v121
v_add_f32 v125, v125, v129
v_mfma_f32_16x16x32_bf16 v[164:167], a[104:107], a[36:39], v[164:167]
ds_read_b128 a[144:147], v5 offset:47104
v_add_f32 v94, v94, v98
v_mfma_f32_16x16x32_bf16 v[188:191], a[104:107], a[40:43], v[188:191]
v_add_f32 v102, v102, v106
v_add_f32 v110, v110, v114
v_mfma_f32_16x16x32_bf16 v[212:215], a[104:107], a[44:47], v[212:215]
buffer_load_dwordx4 v1, s[4:7], s44 offen offset:0 sc1 lds
v_mfma_f32_16x16x32_bf16 v[216:219], a[108:111], a[44:47], v[216:219]
ds_read_b128 a[148:151], v5 offset:48128
v_add_f32 v118, v118, v122
v_mfma_f32_16x16x32_bf16 v[192:195], a[108:111], a[40:43], v[192:195]
ds_read_b128 a[152:155], v6 offset:29696
v_add_f32 v126, v126, v130
v_mfma_f32_16x16x32_bf16 v[168:171], a[108:111], a[36:39], v[168:171]
v_add_f32 v95, v95, v99
v_add_f32 v103, v103, v107
v_mfma_f32_16x16x32_bf16 v[144:147], a[108:111], a[32:35], v[144:147]
v_add_f32 v111, v111, v115
v_add_f32 v119, v119, v123
v_mfma_f32_16x16x32_bf16 v[148:151], a[112:115], a[32:35], v[148:151]
buffer_load_dwordx4 a[24:27], v2, s[40:43], s35 offen offset:2048 sc1
v_mfma_f32_16x16x32_bf16 v[172:175], a[112:115], a[36:39], v[172:175]
v_add_f32 v127, v127, v131
v_add_f32_dpp v92, v92, v92 row_ror:8 row_mask:0xf bank_mask:0xf
v_mfma_f32_16x16x32_bf16 v[196:199], a[112:115], a[40:43], v[196:199]
v_add_f32_dpp v100, v100, v100 row_ror:8 row_mask:0xf bank_mask:0xf
v_add_f32_dpp v108, v108, v108 row_ror:8 row_mask:0xf bank_mask:0xf
v_mfma_f32_16x16x32_bf16 v[220:223], a[112:115], a[44:47], v[220:223]
v_add_f32_dpp v116, v116, v116 row_ror:8 row_mask:0xf bank_mask:0xf
v_add_f32_dpp v124, v124, v124 row_ror:8 row_mask:0xf bank_mask:0xf
v_mfma_f32_16x16x32_bf16 v[224:227], a[116:119], a[44:47], v[224:227]
v_add_f32_dpp v93, v93, v93 row_ror:8 row_mask:0xf bank_mask:0xf
v_mfma_f32_16x16x32_bf16 v[200:203], a[116:119], a[40:43], v[200:203]
buffer_load_dwordx4 a[28:31], v2, s[40:43], s35 offen offset:3072 sc1
s_add_u32 s35, s35, 4096
v_mfma_f32_16x16x32_bf16 v[176:179], a[116:119], a[36:39], v[176:179]
v_add_f32_dpp v101, v101, v101 row_ror:8 row_mask:0xf bank_mask:0xf
v_add_f32_dpp v109, v109, v109 row_ror:8 row_mask:0xf bank_mask:0xf
v_mfma_f32_16x16x32_bf16 v[152:155], a[116:119], a[32:35], v[152:155]
v_add_f32_dpp v117, v117, v117 row_ror:8 row_mask:0xf bank_mask:0xf
v_add_f32_dpp v125, v125, v125 row_ror:8 row_mask:0xf bank_mask:0xf
v_mfma_f32_16x16x32_bf16 a[88:91], a[120:123], a[72:75], a[88:91]
s_waitcnt vmcnt(9) lgkmcnt(0)
s_barrier
v_mfma_f32_16x16x32_bf16 v[132:135], a[128:131], a[48:51], v[132:135]
v_add_u32 v5, 0, v1
v_add_u32 v6, s55, v5
v_mfma_f32_16x16x32_bf16 v[156:159], a[128:131], a[52:55], v[156:159]
buffer_load_dwordx4 a[32:35], v2, s[40:43], s35 offen offset:0 sc1
v_mfma_f32_16x16x32_bf16 v[180:183], a[128:131], a[56:59], v[180:183]
ds_read_b128 a[96:99], v5 offset:0
v_add_f32_dpp v92, v94, v94 row_ror:8 row_mask:0xf bank_mask:0xc
v_mfma_f32_16x16x32_bf16 v[204:207], a[128:131], a[60:63], v[204:207]
ds_read_b128 a[100:103], v5 offset:1024
v_add_f32_dpp v100, v102, v102 row_ror:8 row_mask:0xf bank_mask:0xc
v_mfma_f32_16x16x32_bf16 v[208:211], a[132:135], a[60:63], v[208:211]
ds_read_b128 a[104:107], v5 offset:2048
v_add_f32_dpp v108, v110, v110 row_ror:8 row_mask:0xf bank_mask:0xc
v_mfma_f32_16x16x32_bf16 v[184:187], a[132:135], a[56:59], v[184:187]
v_add_f32_dpp v116, v118, v118 row_ror:8 row_mask:0xf bank_mask:0xc
v_add_f32_dpp v124, v126, v126 row_ror:8 row_mask:0xf bank_mask:0xc
v_mfma_f32_16x16x32_bf16 v[160:163], a[132:135], a[52:55], v[160:163]
buffer_load_dwordx4 a[36:39], v2, s[40:43], s35 offen offset:1024 sc1
v_mfma_f32_16x16x32_bf16 v[136:139], a[132:135], a[48:51], v[136:139]
ds_read_b128 a[108:111], v5 offset:3072
v_add_f32_dpp v93, v95, v95 row_ror:8 row_mask:0xf bank_mask:0xc
v_mfma_f32_16x16x32_bf16 v[140:143], a[136:139], a[48:51], v[140:143]
ds_read_b128 a[112:115], v5 offset:4096
v_add_f32_dpp v101, v103, v103 row_ror:8 row_mask:0xf bank_mask:0xc
v_mfma_f32_16x16x32_bf16 v[164:167], a[136:139], a[52:55], v[164:167]
v_add_f32_dpp v109, v111, v111 row_ror:8 row_mask:0xf bank_mask:0xc
v_add_f32_dpp v117, v119, v119 row_ror:8 row_mask:0xf bank_mask:0xc
v_mfma_f32_16x16x32_bf16 v[188:191], a[136:139], a[56:59], v[188:191]
ds_read_b128 a[116:119], v5 offset:5120
v_add_f32_dpp v125, v127, v127 row_ror:8 row_mask:0xf bank_mask:0xc
v_mfma_f32_16x16x32_bf16 v[212:215], a[136:139], a[60:63], v[212:215]
buffer_load_dwordx4 v1, s[4:7], s44 offen offset:1024 sc1 lds
v_mfma_f32_16x16x32_bf16 v[216:219], a[140:143], a[60:63], v[216:219]
ds_read_b128 a[120:123], v6 offset:2048
v_mfma_f32_16x16x32_bf16 v[192:195], a[140:143], a[56:59], v[192:195]
v_permlane32_swap_b32 v92, v93
v_mfma_f32_16x16x32_bf16 v[168:171], a[140:143], a[52:55], v[168:171]
ds_read_b128 a[124:127], v6 offset:26624
v_mfma_f32_16x16x32_bf16 v[144:147], a[140:143], a[48:51], v[144:147]
v_permlane32_swap_b32 v100, v101
v_mfma_f32_16x16x32_bf16 v[148:151], a[144:147], a[48:51], v[148:151]
buffer_load_dwordx4 a[40:43], v2, s[40:43], s35 offen offset:2048 sc1
v_mfma_f32_16x16x32_bf16 v[172:175], a[144:147], a[52:55], v[172:175]
v_permlane32_swap_b32 v108, v109
v_mfma_f32_16x16x32_bf16 v[196:199], a[144:147], a[56:59], v[196:199]
v_permlane32_swap_b32 v116, v117
v_mfma_f32_16x16x32_bf16 v[220:223], a[144:147], a[60:63], v[220:223]
v_permlane32_swap_b32 v124, v125
v_mfma_f32_16x16x32_bf16 v[224:227], a[148:151], a[60:63], v[224:227]
v_add_f32 v92, v92, v93
v_add_f32 v100, v100, v101
v_mfma_f32_16x16x32_bf16 v[200:203], a[148:151], a[56:59], v[200:203]
buffer_load_dwordx4 a[44:47], v2, s[40:43], s35 offen offset:3072 sc1
s_add_u32 s35, s35, 4096
v_mfma_f32_16x16x32_bf16 v[176:179], a[148:151], a[52:55], v[176:179]
v_add_f32 v108, v108, v109
v_add_f32 v116, v116, v117
v_mfma_f32_16x16x32_bf16 v[152:155], a[148:151], a[48:51], v[152:155]
v_add_f32 v124, v124, v125
v_mov_b32 v94, v92
v_mfma_f32_16x16x32_bf16 a[92:95], a[152:155], a[72:75], a[92:95]
v_mov_b32 v102, v100
s_waitcnt vmcnt(10) lgkmcnt(0)
v_mfma_f32_16x16x32_bf16 v[132:135], a[96:99], a[0:3], v[132:135]
ds_read_b128 a[128:131], v5 offset:6144
L_stub12:
s_cbranch_execz L_stub13
v_mov_b32 v110, v108
v_mfma_f32_16x16x32_bf16 v[156:159], a[96:99], a[4:7], v[156:159]
buffer_load_dwordx4 a[48:51], v2, s[40:43], s35 offen offset:0 sc1
v_mfma_f32_16x16x32_bf16 v[180:183], a[96:99], a[8:11], v[180:183]
ds_read_b128 a[132:135], v5 offset:7168
v_mov_b32 v118, v116
v_mfma_f32_16x16x32_bf16 v[204:207], a[96:99], a[12:15], v[204:207]
v_mov_b32 v126, v124
v_mfma_f32_16x16x32_bf16 v[208:211], a[100:103], a[12:15], v[208:211]
ds_read_b128 a[136:139], v5 offset:8192
v_mfma_f32_16x16x32_bf16 v[184:187], a[100:103], a[8:11], v[184:187]
buffer_load_dwordx4 v1, s[4:7], s44 offen offset:2048 sc1 lds
v_mfma_f32_16x16x32_bf16 v[160:163], a[100:103], a[4:7], v[160:163]
ds_read_b128 a[140:143], v5 offset:9216
v_mfma_f32_16x16x32_bf16 v[136:139], a[100:103], a[0:3], v[136:139]
v_permlane16_swap_b32 v92, v94
v_mfma_f32_16x16x32_bf16 v[140:143], a[104:107], a[0:3], v[140:143]
ds_read_b128 a[144:147], v5 offset:10240
v_mfma_f32_16x16x32_bf16 v[164:167], a[104:107], a[4:7], v[164:167]
buffer_load_dwordx4 a[52:55], v2, s[40:43], s35 offen offset:1024 sc1
v_mfma_f32_16x16x32_bf16 v[188:191], a[104:107], a[8:11], v[188:191]
ds_read_b128 a[148:151], v5 offset:11264
v_mfma_f32_16x16x32_bf16 v[212:215], a[104:107], a[12:15], v[212:215]
v_permlane16_swap_b32 v100, v102
v_mfma_f32_16x16x32_bf16 v[216:219], a[108:111], a[12:15], v[216:219]
ds_read_b128 a[152:155], v6 offset:3072
v_mfma_f32_16x16x32_bf16 v[192:195], a[108:111], a[8:11], v[192:195]
v_permlane16_swap_b32 v108, v110
v_mfma_f32_16x16x32_bf16 v[168:171], a[108:111], a[4:7], v[168:171]
buffer_load_dwordx4 a[56:59], v2, s[40:43], s35 offen offset:2048 sc1
v_mfma_f32_16x16x32_bf16 v[144:147], a[108:111], a[0:3], v[144:147]
ds_read_b128 a[156:159], v6 offset:27648
v_mfma_f32_16x16x32_bf16 v[148:151], a[112:115], a[0:3], v[148:151]
v_permlane16_swap_b32 v116, v118
v_mfma_f32_16x16x32_bf16 v[172:175], a[112:115], a[4:7], v[172:175]
v_permlane16_swap_b32 v124, v126
v_mfma_f32_16x16x32_bf16 v[196:199], a[112:115], a[8:11], v[196:199]
buffer_load_dwordx4 v1, s[4:7], s44 offen offset:3072 sc1 lds
s_add_u32 m0, s19, 65536
v_mfma_f32_16x16x32_bf16 v[220:223], a[112:115], a[12:15], v[220:223]
s_add_u32 s44, s84, 0xa08000
v_add_f32 v92, v92, v94
v_mfma_f32_16x16x32_bf16 v[224:227], a[116:119], a[12:15], v[224:227]
v_add_f32 v100, v100, v102
v_add_f32 v108, v108, v110
v_mfma_f32_16x16x32_bf16 v[200:203], a[116:119], a[8:11], v[200:203]
v_add_f32 v116, v116, v118
v_add_f32 v124, v124, v126
v_mfma_f32_16x16x32_bf16 v[176:179], a[116:119], a[4:7], v[176:179]
buffer_load_dwordx4 a[60:63], v2, s[40:43], s35 offen offset:3072 sc1
s_add_u32 s35, s35, 4096
v_mfma_f32_16x16x32_bf16 v[152:155], a[116:119], a[0:3], v[152:155]
v_mov_b32 v94, v92
v_mov_b32 v102, v100
v_mfma_f32_16x16x32_bf16 a[80:83], a[120:123], a[64:67], a[80:83]
v_mov_b32 v110, v108
v_mov_b32 v118, v116
v_mfma_f32_16x16x32_bf16 a[80:83], a[124:127], a[68:71], a[80:83]
v_mov_b32 v126, v124
s_waitcnt vmcnt(11) lgkmcnt(0)
v_mfma_f32_16x16x32_bf16 v[132:135], a[128:131], a[16:19], v[132:135]
ds_read_b128 a[96:99], v5 offset:12288
v_mfma_f32_16x16x32_bf16 v[156:159], a[128:131], a[20:23], v[156:159]
buffer_load_dwordx4 a[0:3], v2, s[40:43], s35 offen offset:0 sc1
v_mfma_f32_16x16x32_bf16 v[180:183], a[128:131], a[24:27], v[180:183]
ds_read_b128 a[100:103], v5 offset:13312
v_mfma_f32_16x16x32_bf16 v[204:207], a[128:131], a[28:31], v[204:207]
v_permlane32_swap_b32 v92, v94
v_mfma_f32_16x16x32_bf16 v[208:211], a[132:135], a[28:31], v[208:211]
ds_read_b128 a[104:107], v5 offset:14336
v_mfma_f32_16x16x32_bf16 v[184:187], a[132:135], a[24:27], v[184:187]
v_permlane32_swap_b32 v100, v102
v_mfma_f32_16x16x32_bf16 v[160:163], a[132:135], a[20:23], v[160:163]
buffer_load_dwordx4 a[4:7], v2, s[40:43], s35 offen offset:1024 sc1
v_mfma_f32_16x16x32_bf16 v[136:139], a[132:135], a[16:19], v[136:139]
ds_read_b128 a[108:111], v5 offset:15360
v_mfma_f32_16x16x32_bf16 v[140:143], a[136:139], a[16:19], v[140:143]
ds_read_b128 a[112:115], v5 offset:16384
v_mfma_f32_16x16x32_bf16 v[164:167], a[136:139], a[20:23], v[164:167]
v_permlane32_swap_b32 v108, v110
v_mfma_f32_16x16x32_bf16 v[188:191], a[136:139], a[24:27], v[188:191]
ds_read_b128 a[116:119], v5 offset:17408
v_mfma_f32_16x16x32_bf16 v[212:215], a[136:139], a[28:31], v[212:215]
buffer_load_dwordx4 v1, s[4:7], s44 offen offset:0 sc1 lds
v_mfma_f32_16x16x32_bf16 v[216:219], a[140:143], a[28:31], v[216:219]
ds_read_b128 a[120:123], v6 offset:4096
v_mfma_f32_16x16x32_bf16 v[192:195], a[140:143], a[24:27], v[192:195]
v_permlane32_swap_b32 v116, v118
v_mfma_f32_16x16x32_bf16 v[168:171], a[140:143], a[20:23], v[168:171]
ds_read_b128 a[124:127], v6 offset:28672
v_mfma_f32_16x16x32_bf16 v[144:147], a[140:143], a[16:19], v[144:147]
v_permlane32_swap_b32 v124, v126
v_mfma_f32_16x16x32_bf16 v[148:151], a[144:147], a[16:19], v[148:151]
buffer_load_dwordx4 a[8:11], v2, s[40:43], s35 offen offset:2048 sc1
v_mfma_f32_16x16x32_bf16 v[172:175], a[144:147], a[20:23], v[172:175]
v_mul_f32 v82, 0xba800000, v92
v_mul_f32 v84, 0xba800000, v100
v_mfma_f32_16x16x32_bf16 v[196:199], a[144:147], a[24:27], v[196:199]
v_mul_f32 v86, 0xba800000, v108
v_mul_f32 v88, 0xba800000, v116
v_mfma_f32_16x16x32_bf16 v[220:223], a[144:147], a[28:31], v[220:223]
v_mul_f32 v90, 0xba800000, v124
v_mul_f32 v94, 0x3a800000, v94
v_mfma_f32_16x16x32_bf16 v[224:227], a[148:151], a[28:31], v[224:227]
v_mul_f32 v102, 0x3a800000, v102
v_mul_f32 v110, 0x3a800000, v110
v_mfma_f32_16x16x32_bf16 v[200:203], a[148:151], a[24:27], v[200:203]
buffer_load_dwordx4 a[12:15], v2, s[40:43], s35 offen offset:3072 sc1
s_add_u32 s35, s35, 4096
v_mfma_f32_16x16x32_bf16 v[176:179], a[148:151], a[20:23], v[176:179]
v_mul_f32 v118, 0x3a800000, v118
v_mul_f32 v126, 0x3a800000, v126
v_mfma_f32_16x16x32_bf16 v[152:155], a[148:151], a[16:19], v[152:155]
v_fma_f32 v94, -v82, v82, v94
v_fma_f32 v102, -v84, v84, v102
v_mfma_f32_16x16x32_bf16 a[84:87], a[152:155], a[64:67], a[84:87]
v_fma_f32 v110, -v86, v86, v110
v_fma_f32 v118, -v88, v88, v118
v_mfma_f32_16x16x32_bf16 a[84:87], a[156:159], a[68:71], a[84:87]
v_fma_f32 v126, -v90, v90, v126
s_waitcnt vmcnt(11) lgkmcnt(0)
v_mfma_f32_16x16x32_bf16 v[132:135], a[96:99], a[32:35], v[132:135]
ds_read_b128 a[128:131], v5 offset:18432
v_max_f32 v94, 0, v94
v_mfma_f32_16x16x32_bf16 v[156:159], a[96:99], a[36:39], v[156:159]
buffer_load_dwordx4 a[16:19], v2, s[40:43], s35 offen offset:0 sc1
v_mfma_f32_16x16x32_bf16 v[180:183], a[96:99], a[40:43], v[180:183]
ds_read_b128 a[132:135], v5 offset:19456
v_max_f32 v102, 0, v102
v_mfma_f32_16x16x32_bf16 v[204:207], a[96:99], a[44:47], v[204:207]
v_max_f32 v110, 0, v110
v_max_f32 v118, 0, v118
v_mfma_f32_16x16x32_bf16 v[208:211], a[100:103], a[44:47], v[208:211]
ds_read_b128 a[136:139], v5 offset:20480
v_max_f32 v126, 0, v126
v_mfma_f32_16x16x32_bf16 v[184:187], a[100:103], a[40:43], v[184:187]
buffer_load_dwordx4 v1, s[4:7], s44 offen offset:1024 sc1 lds
v_mfma_f32_16x16x32_bf16 v[160:163], a[100:103], a[36:39], v[160:163]
ds_read_b128 a[140:143], v5 offset:21504
v_add_f32 v94, 0x3727c5ac, v94
v_mfma_f32_16x16x32_bf16 v[136:139], a[100:103], a[32:35], v[136:139]
v_add_f32 v102, 0x3727c5ac, v102
v_add_f32 v110, 0x3727c5ac, v110
v_add_f32 v118, 0x3727c5ac, v118
v_add_f32 v126, 0x3727c5ac, v126
v_rsq_f32 v83, v94
v_rsq_f32 v85, v102
v_rsq_f32 v87, v110
v_rsq_f32 v89, v118
v_rsq_f32 v91, v126
v_mfma_f32_16x16x32_bf16 v[140:143], a[104:107], a[32:35], v[140:143]
ds_read_b128 a[144:147], v5 offset:22528
v_mfma_f32_16x16x32_bf16 v[164:167], a[104:107], a[36:39], v[164:167]
buffer_load_dwordx4 a[20:23], v2, s[40:43], s35 offen offset:1024 sc1
v_mfma_f32_16x16x32_bf16 v[188:191], a[104:107], a[40:43], v[188:191]
ds_read_b128 a[148:151], v5 offset:23552
v_fmac_f32 v132, v48, v82
v_mfma_f32_16x16x32_bf16 v[212:215], a[104:107], a[44:47], v[212:215]
v_fmac_f32 v156, v48, v84
v_fmac_f32 v180, v48, v86
v_mfma_f32_16x16x32_bf16 v[216:219], a[108:111], a[44:47], v[216:219]
ds_read_b128 a[152:155], v6 offset:5120
v_fmac_f32 v204, v48, v88
v_mfma_f32_16x16x32_bf16 v[192:195], a[108:111], a[40:43], v[192:195]
v_fmac_f32 v208, v52, v88
v_mfma_f32_16x16x32_bf16 v[168:171], a[108:111], a[36:39], v[168:171]
buffer_load_dwordx4 a[24:27], v2, s[40:43], s35 offen offset:2048 sc1
v_mfma_f32_16x16x32_bf16 v[144:147], a[108:111], a[32:35], v[144:147]
ds_read_b128 a[156:159], v6 offset:29696
v_fmac_f32 v184, v52, v86
v_mfma_f32_16x16x32_bf16 v[148:151], a[112:115], a[32:35], v[148:151]
v_fmac_f32 v160, v52, v84
v_fmac_f32 v136, v52, v82
v_mfma_f32_16x16x32_bf16 v[172:175], a[112:115], a[36:39], v[172:175]
v_fmac_f32 v140, v56, v82
v_mfma_f32_16x16x32_bf16 v[196:199], a[112:115], a[40:43], v[196:199]
buffer_load_dwordx4 v1, s[4:7], s44 offen offset:2048 sc1 lds
v_mfma_f32_16x16x32_bf16 v[220:223], a[112:115], a[44:47], v[220:223]
v_fmac_f32 v164, v56, v84
v_fmac_f32 v188, v56, v86
v_mfma_f32_16x16x32_bf16 v[224:227], a[116:119], a[44:47], v[224:227]
v_fmac_f32 v212, v56, v88
v_mfma_f32_16x16x32_bf16 v[200:203], a[116:119], a[40:43], v[200:203]
v_fmac_f32 v216, v60, v88
v_mfma_f32_16x16x32_bf16 v[176:179], a[116:119], a[36:39], v[176:179]
buffer_load_dwordx4 a[28:31], v2, s[40:43], s35 offen offset:3072 sc1
s_add_u32 s35, s35, 4096
v_mfma_f32_16x16x32_bf16 v[152:155], a[116:119], a[32:35], v[152:155]
v_fmac_f32 v192, v60, v86
v_fmac_f32 v168, v60, v84
v_mfma_f32_16x16x32_bf16 a[88:91], a[120:123], a[64:67], a[88:91]
v_fmac_f32 v144, v60, v82
v_mfma_f32_16x16x32_bf16 a[88:91], a[124:127], a[68:71], a[88:91]
v_fmac_f32 v148, v64, v82
s_waitcnt vmcnt(11) lgkmcnt(0)
v_mfma_f32_16x16x32_bf16 v[132:135], a[128:131], a[48:51], v[132:135]
ds_read_b128 a[96:99], v5 offset:24576
v_fmac_f32 v172, v64, v84
v_mfma_f32_16x16x32_bf16 v[156:159], a[128:131], a[52:55], v[156:159]
buffer_load_dwordx4 a[32:35], v2, s[40:43], s35 offen offset:0 sc1
s_lshl_b32 s90, s28, 12
v_mfma_f32_16x16x32_bf16 v[180:183], a[128:131], a[56:59], v[180:183]
ds_read_b128 a[100:103], v5 offset:25600
v_fmac_f32 v196, v64, v86
v_mfma_f32_16x16x32_bf16 v[204:207], a[128:131], a[60:63], v[204:207]
v_fmac_f32 v220, v64, v88
v_fmac_f32 v224, v68, v88
v_mfma_f32_16x16x32_bf16 v[208:211], a[132:135], a[60:63], v[208:211]
v_fmac_f32 v200, v68, v86
s_add_u32 s90, s90, 147456
v_mfma_f32_16x16x32_bf16 v[184:187], a[132:135], a[56:59], v[184:187]
ds_read_b128 a[104:107], v5 offset:26624
v_fmac_f32 v176, v68, v84
v_mfma_f32_16x16x32_bf16 v[160:163], a[132:135], a[52:55], v[160:163]
buffer_load_dwordx4 a[36:39], v2, s[40:43], s35 offen offset:1024 sc1
v_mfma_f32_16x16x32_bf16 v[136:139], a[132:135], a[48:51], v[136:139]
v_fmac_f32 v152, v68, v82
v_add_u32 v234, s90, v1
v_mfma_f32_16x16x32_bf16 v[140:143], a[136:139], a[48:51], v[140:143]
ds_read_b128 a[108:111], v5 offset:27648
s_lshl_b32 s90, s28, 10
v_mfma_f32_16x16x32_bf16 v[164:167], a[136:139], a[52:55], v[164:167]
v_fmac_f32 v133, v49, v82
s_add_u32 s90, s90, 147456
v_mfma_f32_16x16x32_bf16 v[188:191], a[136:139], a[56:59], v[188:191]
ds_read_b128 a[112:115], v5 offset:28672
v_fmac_f32 v157, v49, v84
v_mfma_f32_16x16x32_bf16 v[212:215], a[136:139], a[60:63], v[212:215]
buffer_load_dwordx4 v1, s[4:7], s44 offen offset:3072 sc1 lds
s_add_u32 m0, s19, 81920
v_mfma_f32_16x16x32_bf16 v[216:219], a[140:143], a[60:63], v[216:219]
s_add_u32 s44, s85, 0xa0c000
v_fmac_f32 v181, v49, v86
v_mfma_f32_16x16x32_bf16 v[192:195], a[140:143], a[56:59], v[192:195]
ds_read_b128 a[116:119], v5 offset:29696
v_fmac_f32 v205, v49, v88
v_mfma_f32_16x16x32_bf16 v[168:171], a[140:143], a[52:55], v[168:171]
v_fmac_f32 v209, v53, v88
v_fmac_f32 v185, v53, v86
v_mfma_f32_16x16x32_bf16 v[144:147], a[140:143], a[48:51], v[144:147]
v_fmac_f32 v161, v53, v84
v_add_u32 v235, s90, v1
v_mfma_f32_16x16x32_bf16 v[148:151], a[144:147], a[48:51], v[148:151]
buffer_load_dwordx4 a[40:43], v2, s[40:43], s35 offen offset:2048 sc1
v_mfma_f32_16x16x32_bf16 v[172:175], a[144:147], a[52:55], v[172:175]
v_fmac_f32 v137, v53, v82
v_fmac_f32 v141, v57, v82
v_mfma_f32_16x16x32_bf16 v[196:199], a[144:147], a[56:59], v[196:199]
v_fmac_f32 v165, v57, v84
v_mfma_f32_16x16x32_bf16 v[220:223], a[144:147], a[60:63], v[220:223]
v_fmac_f32 v189, v57, v86
v_mfma_f32_16x16x32_bf16 v[224:227], a[148:151], a[60:63], v[224:227]
v_fmac_f32 v213, v57, v88
v_mfma_f32_16x16x32_bf16 v[200:203], a[148:151], a[56:59], v[200:203]
buffer_load_dwordx4 a[44:47], v2, s[40:43], s35 offen offset:3072 sc1
s_add_u32 s35, s35, 4096
v_mfma_f32_16x16x32_bf16 v[176:179], a[148:151], a[52:55], v[176:179]
v_fmac_f32 v217, v61, v88
v_fmac_f32 v193, v61, v86
v_mfma_f32_16x16x32_bf16 v[152:155], a[148:151], a[48:51], v[152:155]
v_fmac_f32 v169, v61, v84
v_mfma_f32_16x16x32_bf16 a[92:95], a[152:155], a[64:67], a[92:95]
v_fmac_f32 v145, v61, v82
v_mfma_f32_16x16x32_bf16 a[92:95], a[156:159], a[68:71], a[92:95]
v_fmac_f32 v149, v65, v82
s_waitcnt vmcnt(11) lgkmcnt(0)
v_mfma_f32_16x16x32_bf16 v[132:135], a[96:99], a[0:3], v[132:135]
ds_read_b128 a[128:131], v5 offset:30720
v_fmac_f32 v173, v65, v84
v_mfma_f32_16x16x32_bf16 v[156:159], a[96:99], a[4:7], v[156:159]
buffer_load_dwordx4 a[48:51], v2, s[40:43], s35 offen offset:0 sc1
v_mfma_f32_16x16x32_bf16 v[180:183], a[96:99], a[8:11], v[180:183]
ds_read_b128 a[132:135], v5 offset:31744
v_fmac_f32 v197, v65, v86
v_mfma_f32_16x16x32_bf16 v[204:207], a[96:99], a[12:15], v[204:207]
v_fmac_f32 v221, v65, v88
v_fmac_f32 v225, v69, v88
v_mfma_f32_16x16x32_bf16 v[208:211], a[100:103], a[12:15], v[208:211]
v_fmac_f32 v201, v69, v86
v_mfma_f32_16x16x32_bf16 v[184:187], a[100:103], a[8:11], v[184:187]
buffer_load_dwordx4 a[52:55], v2, s[40:43], s35 offen offset:1024 sc1
v_mfma_f32_16x16x32_bf16 v[160:163], a[100:103], a[4:7], v[160:163]
ds_read_b128 a[136:139], v5 offset:32768
v_fmac_f32 v177, v69, v84
v_mfma_f32_16x16x32_bf16 v[136:139], a[100:103], a[0:3], v[136:139]
v_fmac_f32 v153, v69, v82
v_mfma_f32_16x16x32_bf16 v[140:143], a[104:107], a[0:3], v[140:143]
ds_read_b128 a[140:143], v5 offset:33792
v_mfma_f32_16x16x32_bf16 v[164:167], a[104:107], a[4:7], v[164:167]
v_fmac_f32 v134, v50, v82
v_mfma_f32_16x16x32_bf16 v[188:191], a[104:107], a[8:11], v[188:191]
buffer_load_dwordx4 v1, s[4:7], s44 offen offset:0 sc1 lds
v_mfma_f32_16x16x32_bf16 v[212:215], a[104:107], a[12:15], v[212:215]
ds_read_b128 a[144:147], v5 offset:34816
v_fmac_f32 v158, v50, v84
v_mfma_f32_16x16x32_bf16 v[216:219], a[108:111], a[12:15], v[216:219]
v_fmac_f32 v182, v50, v86
v_fmac_f32 v206, v50, v88
v_mfma_f32_16x16x32_bf16 v[192:195], a[108:111], a[8:11], v[192:195]
ds_read_b128 a[148:151], v5 offset:35840
v_fmac_f32 v210, v54, v88
v_mfma_f32_16x16x32_bf16 v[168:171], a[108:111], a[4:7], v[168:171]
v_fmac_f32 v186, v54, v86
v_mfma_f32_16x16x32_bf16 v[144:147], a[108:111], a[0:3], v[144:147]
buffer_load_dwordx4 a[56:59], v2, s[40:43], s35 offen offset:2048 sc1
v_mfma_f32_16x16x32_bf16 v[148:151], a[112:115], a[0:3], v[148:151]
v_fmac_f32 v162, v54, v84
v_fmac_f32 v138, v54, v82
v_mfma_f32_16x16x32_bf16 v[172:175], a[112:115], a[4:7], v[172:175]
v_fmac_f32 v142, v58, v82
v_mfma_f32_16x16x32_bf16 v[196:199], a[112:115], a[8:11], v[196:199]
v_fmac_f32 v166, v58, v84
v_mfma_f32_16x16x32_bf16 v[220:223], a[112:115], a[12:15], v[220:223]
v_fmac_f32 v190, v58, v86
v_mfma_f32_16x16x32_bf16 v[224:227], a[116:119], a[12:15], v[224:227]
buffer_load_dwordx4 a[60:63], v2, s[40:43], s35 offen offset:3072 sc1
s_add_u32 s35, s35, 4096
v_mfma_f32_16x16x32_bf16 v[200:203], a[116:119], a[8:11], v[200:203]
v_fmac_f32 v214, v58, v88
v_fmac_f32 v218, v62, v88
v_mfma_f32_16x16x32_bf16 v[176:179], a[116:119], a[4:7], v[176:179]
v_fmac_f32 v194, v62, v86
v_mfma_f32_16x16x32_bf16 v[152:155], a[116:119], a[0:3], v[152:155]
v_fmac_f32 v170, v62, v84
s_waitcnt vmcnt(10) lgkmcnt(0)
v_mfma_f32_16x16x32_bf16 v[132:135], a[128:131], a[16:19], v[132:135]
ds_read_b128 a[96:99], v5 offset:36864
v_fmac_f32 v146, v62, v82
v_mfma_f32_16x16x32_bf16 v[156:159], a[128:131], a[20:23], v[156:159]
buffer_load_dwordx4 v1, s[4:7], s44 offen offset:1024 sc1 lds
v_mfma_f32_16x16x32_bf16 v[180:183], a[128:131], a[24:27], v[180:183]
ds_read_b128 a[100:103], v5 offset:37888
v_fmac_f32 v150, v66, v82
v_mfma_f32_16x16x32_bf16 v[204:207], a[128:131], a[28:31], v[204:207]
v_fmac_f32 v174, v66, v84
v_fmac_f32 v198, v66, v86
v_mfma_f32_16x16x32_bf16 v[208:211], a[132:135], a[28:31], v[208:211]
v_fmac_f32 v222, v66, v88
v_mfma_f32_16x16x32_bf16 v[184:187], a[132:135], a[24:27], v[184:187]
buffer_load_dwordx4 v1, s[4:7], s44 offen offset:2048 sc1 lds
v_mfma_f32_16x16x32_bf16 v[160:163], a[132:135], a[20:23], v[160:163]
ds_read_b128 a[104:107], v5 offset:38912
v_fmac_f32 v226, v70, v88
v_mfma_f32_16x16x32_bf16 v[136:139], a[132:135], a[16:19], v[136:139]
v_fmac_f32 v202, v70, v86
v_fmac_f32 v178, v70, v84
v_mfma_f32_16x16x32_bf16 v[140:143], a[136:139], a[16:19], v[140:143]
ds_read_b128 a[108:111], v5 offset:39936
v_fmac_f32 v154, v70, v82
v_mfma_f32_16x16x32_bf16 v[164:167], a[136:139], a[20:23], v[164:167]
v_fmac_f32 v135, v51, v82
v_mfma_f32_16x16x32_bf16 v[188:191], a[136:139], a[24:27], v[188:191]
buffer_load_dwordx4 v1, s[4:7], s44 offen offset:3072 sc1 lds
s_add_u32 m0, s19, 98304
v_mfma_f32_16x16x32_bf16 v[212:215], a[136:139], a[28:31], v[212:215]
s_add_u32 s44, s84, 0xa10000
ds_read_b128 a[112:115], v5 offset:40960
v_mfma_f32_16x16x32_bf16 v[216:219], a[140:143], a[28:31], v[216:219]
v_fmac_f32 v159, v51, v84
v_fmac_f32 v183, v51, v86
v_mfma_f32_16x16x32_bf16 v[192:195], a[140:143], a[24:27], v[192:195]
ds_read_b128 a[116:119], v5 offset:41984
v_fmac_f32 v207, v51, v88
v_mfma_f32_16x16x32_bf16 v[168:171], a[140:143], a[20:23], v[168:171]
v_fmac_f32 v211, v55, v88
v_fmac_f32 v187, v55, v86
v_mfma_f32_16x16x32_bf16 v[144:147], a[140:143], a[16:19], v[144:147]
buffer_load_dwordx4 v1, s[4:7], s44 offen offset:0 sc1 lds
v_mfma_f32_16x16x32_bf16 v[148:151], a[144:147], a[16:19], v[148:151]
v_fmac_f32 v163, v55, v84
v_fmac_f32 v139, v55, v82
v_mfma_f32_16x16x32_bf16 v[172:175], a[144:147], a[20:23], v[172:175]
v_fmac_f32 v143, v59, v82
v_mfma_f32_16x16x32_bf16 v[196:199], a[144:147], a[24:27], v[196:199]
v_fmac_f32 v167, v59, v84
v_mfma_f32_16x16x32_bf16 v[220:223], a[144:147], a[28:31], v[220:223]
v_fmac_f32 v191, v59, v86
v_mfma_f32_16x16x32_bf16 v[224:227], a[148:151], a[28:31], v[224:227]
buffer_load_dwordx4 v1, s[4:7], s44 offen offset:1024 sc1 lds
v_mfma_f32_16x16x32_bf16 v[200:203], a[148:151], a[24:27], v[200:203]
v_fmac_f32 v215, v59, v88
v_fmac_f32 v219, v63, v88
v_mfma_f32_16x16x32_bf16 v[176:179], a[148:151], a[20:23], v[176:179]
v_fmac_f32 v195, v63, v86
v_mfma_f32_16x16x32_bf16 v[152:155], a[148:151], a[16:19], v[152:155]
v_fmac_f32 v171, v63, v84
s_waitcnt vmcnt(10) lgkmcnt(0)
v_mfma_f32_16x16x32_bf16 v[132:135], a[96:99], a[32:35], v[132:135]
ds_read_b128 a[128:131], v5 offset:43008
v_fmac_f32 v147, v63, v82
v_mfma_f32_16x16x32_bf16 v[156:159], a[96:99], a[36:39], v[156:159]
buffer_load_dwordx4 v1, s[4:7], s44 offen offset:2048 sc1 lds
v_mfma_f32_16x16x32_bf16 v[180:183], a[96:99], a[40:43], v[180:183]
ds_read_b128 a[132:135], v5 offset:44032
v_fmac_f32 v151, v67, v82
v_mfma_f32_16x16x32_bf16 v[204:207], a[96:99], a[44:47], v[204:207]
v_fmac_f32 v175, v67, v84
v_fmac_f32 v199, v67, v86
v_mfma_f32_16x16x32_bf16 v[208:211], a[100:103], a[44:47], v[208:211]
v_fmac_f32 v223, v67, v88
v_mfma_f32_16x16x32_bf16 v[184:187], a[100:103], a[40:43], v[184:187]
buffer_load_dwordx4 v1, s[4:7], s44 offen offset:3072 sc1 lds
s_add_u32 m0, s19, 114688
v_mfma_f32_16x16x32_bf16 v[160:163], a[100:103], a[36:39], v[160:163]
s_add_u32 s44, s85, 0xa14000
ds_read_b128 a[136:139], v5 offset:45056
v_mfma_f32_16x16x32_bf16 v[136:139], a[100:103], a[32:35], v[136:139]
v_fmac_f32 v227, v71, v88
v_fmac_f32 v203, v71, v86
v_mfma_f32_16x16x32_bf16 v[140:143], a[104:107], a[32:35], v[140:143]
ds_read_b128 a[140:143], v5 offset:46080
v_fmac_f32 v179, v71, v84
v_mfma_f32_16x16x32_bf16 v[164:167], a[104:107], a[36:39], v[164:167]
v_fmac_f32 v155, v71, v82
v_mfma_f32_16x16x32_bf16 v[188:191], a[104:107], a[40:43], v[188:191]
buffer_load_dwordx4 v1, s[4:7], s44 offen offset:0 sc1 lds
v_mfma_f32_16x16x32_bf16 v[212:215], a[104:107], a[44:47], v[212:215]
ds_read_b128 a[144:147], v5 offset:47104
v_mfma_f32_16x16x32_bf16 v[216:219], a[108:111], a[44:47], v[216:219]
ds_write_b128 v234, a[80:83] offset:0
v_mfma_f32_16x16x32_bf16 v[192:195], a[108:111], a[40:43], v[192:195]
ds_read_b128 a[148:151], v5 offset:48128
v_mfma_f32_16x16x32_bf16 v[168:171], a[108:111], a[36:39], v[168:171]
ds_write_b128 v234, a[84:87] offset:1024
v_mfma_f32_16x16x32_bf16 v[144:147], a[108:111], a[32:35], v[144:147]
buffer_load_dwordx4 v1, s[4:7], s44 offen offset:1024 sc1 lds
v_mfma_f32_16x16x32_bf16 v[148:151], a[112:115], a[32:35], v[148:151]
ds_write_b128 v234, a[88:91] offset:2048
v_mfma_f32_16x16x32_bf16 v[172:175], a[112:115], a[36:39], v[172:175]
ds_write_b128 v234, a[92:95] offset:3072
v_mfma_f32_16x16x32_bf16 v[196:199], a[112:115], a[40:43], v[196:199]
v_mfma_f32_16x16x32_bf16 v[220:223], a[112:115], a[44:47], v[220:223]
v_mfma_f32_16x16x32_bf16 v[224:227], a[116:119], a[44:47], v[224:227]
buffer_load_dwordx4 v1, s[4:7], s44 offen offset:2048 sc1 lds
v_mfma_f32_16x16x32_bf16 v[200:203], a[116:119], a[40:43], v[200:203]
v_mfma_f32_16x16x32_bf16 v[176:179], a[116:119], a[36:39], v[176:179]
v_mfma_f32_16x16x32_bf16 v[152:155], a[116:119], a[32:35], v[152:155]
s_waitcnt vmcnt(10) lgkmcnt(0)
s_barrier
v_mfma_f32_16x16x32_bf16 v[132:135], a[128:131], a[48:51], v[132:135]
ds_read_b128 v[92:95], v235 offset:0
v_mfma_f32_16x16x32_bf16 v[156:159], a[128:131], a[52:55], v[156:159]
buffer_load_dwordx4 v1, s[4:7], s44 offen offset:3072 sc1 lds
s_add_u32 m0, s19, 131072
v_mfma_f32_16x16x32_bf16 v[180:183], a[128:131], a[56:59], v[180:183]
s_add_u32 s44, s86, 0xa18000
ds_read_b128 v[96:99], v235 offset:4096
v_mfma_f32_16x16x32_bf16 v[204:207], a[128:131], a[60:63], v[204:207]
v_mfma_f32_16x16x32_bf16 v[208:211], a[132:135], a[60:63], v[208:211]
ds_read_b128 v[100:103], v235 offset:8192
v_mfma_f32_16x16x32_bf16 v[184:187], a[132:135], a[56:59], v[184:187]
buffer_load_dwordx4 v1, s[4:7], s44 offen offset:0 sc1 lds
v_mfma_f32_16x16x32_bf16 v[160:163], a[132:135], a[52:55], v[160:163]
ds_read_b128 v[104:107], v235 offset:12288
v_mfma_f32_16x16x32_bf16 v[136:139], a[132:135], a[48:51], v[136:139]
v_mfma_f32_16x16x32_bf16 v[140:143], a[136:139], a[48:51], v[140:143]
v_mfma_f32_16x16x32_bf16 v[164:167], a[136:139], a[52:55], v[164:167]
v_mfma_f32_16x16x32_bf16 v[188:191], a[136:139], a[56:59], v[188:191]
buffer_load_dwordx4 v1, s[4:7], s44 offen offset:1024 sc1 lds
v_mfma_f32_16x16x32_bf16 v[212:215], a[136:139], a[60:63], v[212:215]
v_mfma_f32_16x16x32_bf16 v[216:219], a[140:143], a[60:63], v[216:219]
v_mfma_f32_16x16x32_bf16 v[192:195], a[140:143], a[56:59], v[192:195]
v_mfma_f32_16x16x32_bf16 v[168:171], a[140:143], a[52:55], v[168:171]
v_mfma_f32_16x16x32_bf16 v[144:147], a[140:143], a[48:51], v[144:147]
buffer_load_dwordx4 v1, s[4:7], s44 offen offset:2048 sc1 lds
v_mfma_f32_16x16x32_bf16 v[148:151], a[144:147], a[48:51], v[148:151]
v_mfma_f32_16x16x32_bf16 v[172:175], a[144:147], a[52:55], v[172:175]
v_mfma_f32_16x16x32_bf16 v[196:199], a[144:147], a[56:59], v[196:199]
v_mfma_f32_16x16x32_bf16 v[220:223], a[144:147], a[60:63], v[220:223]
v_mfma_f32_16x16x32_bf16 v[224:227], a[148:151], a[60:63], v[224:227]
buffer_load_dwordx4 v1, s[4:7], s44 offen offset:3072 sc1 lds
v_mfma_f32_16x16x32_bf16 v[200:203], a[148:151], a[56:59], v[200:203]
v_mfma_f32_16x16x32_bf16 v[176:179], a[148:151], a[52:55], v[176:179]
v_mfma_f32_16x16x32_bf16 v[152:155], a[148:151], a[48:51], v[152:155]
.set L_cpf2, .
s_lshl_b32 s36, s28, 12
s_lshl_b32 s37, s28, 10
s_add_u32 m0, s19, 32768
s_add_u32 s44, s84, 0xa00000
buffer_load_dwordx4 v1, s[4:7], s44 offen offset:0 sc1 lds
s_waitcnt lgkmcnt(2)
v_add_f32 v92, v92, v96
s_waitcnt lgkmcnt(0)
v_add_f32 v100, v100, v104
v_add_f32 v93, v93, v97
v_add_f32 v101, v101, v105
v_add_f32 v94, v94, v98
v_add_f32 v102, v102, v106
v_add_f32 v95, v95, v99
v_add_f32 v103, v103, v107
v_add_f32 v228, v92, v100
v_add_f32 v229, v93, v101
v_add_f32 v230, v94, v102
v_add_f32 v231, v95, v103
v_fmac_f32 v228, v72, v90
v_fmac_f32 v229, v73, v90
v_pk_mul_f32 v[212:213], v[212:213], v[88:89] op_sel:[0,1] op_sel_hi:[1,1]
v_pk_mul_f32 v[220:221], v[220:221], v[88:89] op_sel:[0,1] op_sel_hi:[1,1]
v_pk_mul_f32 v[196:197], v[196:197], v[86:87] op_sel:[0,1] op_sel_hi:[1,1]
v_pk_mul_f32 v[172:173], v[172:173], v[84:85] op_sel:[0,1] op_sel_hi:[1,1]
v_pk_mul_f32 v[148:149], v[148:149], v[82:83] op_sel:[0,1] op_sel_hi:[1,1]
v_fmac_f32 v230, v74, v90
v_fmac_f32 v231, v75, v90
v_pk_mul_f32 v[228:229], v[228:229], v[90:91] op_sel:[0,1] op_sel_hi:[1,1]
v_pk_mul_f32 v[214:215], v[214:215], v[88:89] op_sel:[0,1] op_sel_hi:[1,1]
v_pk_mul_f32 v[222:223], v[222:223], v[88:89] op_sel:[0,1] op_sel_hi:[1,1]
v_pk_mul_f32 v[198:199], v[198:199], v[86:87] op_sel:[0,1] op_sel_hi:[1,1]
v_pk_mul_f32 v[174:175], v[174:175], v[84:85] op_sel:[0,1] op_sel_hi:[1,1]
v_pk_mul_f32 v[150:151], v[150:151], v[82:83] op_sel:[0,1] op_sel_hi:[1,1]
buffer_load_dwordx4 v1, s[4:7], s44 offen offset:1024 sc1 lds
v_cvt_pk_bf16_f32 v212, v212, v213
v_cvt_pk_bf16_f32 v220, v220, v221
v_cvt_pk_bf16_f32 v196, v196, v197
v_cvt_pk_bf16_f32 v172, v172, v173
v_cvt_pk_bf16_f32 v148, v148, v149
v_pk_mul_f32 v[230:231], v[230:231], v[90:91] op_sel:[0,1] op_sel_hi:[1,1]
v_pk_mul_f32 v[216:217], v[216:217], v[88:89] op_sel:[0,1] op_sel_hi:[1,1]
v_pk_mul_f32 v[218:219], v[218:219], v[88:89] op_sel:[0,1] op_sel_hi:[1,1]
v_pk_mul_f32 v[224:225], v[224:225], v[88:89] op_sel:[0,1] op_sel_hi:[1,1]
v_pk_mul_f32 v[226:227], v[226:227], v[88:89] op_sel:[0,1] op_sel_hi:[1,1]
v_pk_mul_f32 v[200:201], v[200:201], v[86:87] op_sel:[0,1] op_sel_hi:[1,1]
v_pk_mul_f32 v[202:203], v[202:203], v[86:87] op_sel:[0,1] op_sel_hi:[1,1]
v_pk_mul_f32 v[176:177], v[176:177], v[84:85] op_sel:[0,1] op_sel_hi:[1,1]
v_pk_mul_f32 v[178:179], v[178:179], v[84:85] op_sel:[0,1] op_sel_hi:[1,1]
v_pk_mul_f32 v[152:153], v[152:153], v[82:83] op_sel:[0,1] op_sel_hi:[1,1]
v_pk_mul_f32 v[154:155], v[154:155], v[82:83] op_sel:[0,1] op_sel_hi:[1,1]
v_cvt_pk_bf16_f32 v228, v228, v229
v_cvt_pk_bf16_f32 v213, v214, v215
v_cvt_pk_bf16_f32 v221, v222, v223
v_cvt_pk_bf16_f32 v197, v198, v199
v_cvt_pk_bf16_f32 v173, v174, v175
v_cvt_pk_bf16_f32 v149, v150, v151
v_pk_mul_f32 v[188:189], v[188:189], v[86:87] op_sel:[0,1] op_sel_hi:[1,1]
v_pk_mul_f32 v[164:165], v[164:165], v[84:85] op_sel:[0,1] op_sel_hi:[1,1]
v_pk_mul_f32 v[140:141], v[140:141], v[82:83] op_sel:[0,1] op_sel_hi:[1,1]
v_add_u32 v232, s36, v7
v_add_u32 v233, s37, v1
buffer_load_dwordx4 v1, s[4:7], s44 offen offset:2048 sc1 lds
v_cvt_pk_bf16_f32 v229, v230, v231
v_cvt_pk_bf16_f32 v214, v216, v217
v_cvt_pk_bf16_f32 v215, v218, v219
v_cvt_pk_bf16_f32 v222, v224, v225
v_cvt_pk_bf16_f32 v223, v226, v227
v_cvt_pk_bf16_f32 v198, v200, v201
v_cvt_pk_bf16_f32 v199, v202, v203
v_cvt_pk_bf16_f32 v174, v176, v177
v_cvt_pk_bf16_f32 v175, v178, v179
v_cvt_pk_bf16_f32 v150, v152, v153
v_cvt_pk_bf16_f32 v151, v154, v155
v_pk_mul_f32 v[190:191], v[190:191], v[86:87] op_sel:[0,1] op_sel_hi:[1,1]
v_pk_mul_f32 v[166:167], v[166:167], v[84:85] op_sel:[0,1] op_sel_hi:[1,1]
v_pk_mul_f32 v[142:143], v[142:143], v[82:83] op_sel:[0,1] op_sel_hi:[1,1]
v_cvt_pk_bf16_f32 v188, v188, v189
v_cvt_pk_bf16_f32 v164, v164, v165
v_cvt_pk_bf16_f32 v140, v140, v141
v_cvt_pk_bf16_f32 v132, v132, v133
v_cvt_pk_bf16_f32 v156, v156, v157
v_cvt_pk_bf16_f32 v180, v180, v181
v_cvt_pk_bf16_f32 v204, v204, v205
ds_write_b64 v9, v[228:229]
ds_write_b64 v232, v[220:221] offset:4096
ds_write_b64 v232, v[222:223] offset:4608
v_pk_mul_f32 v[192:193], v[192:193], v[86:87] op_sel:[0,1] op_sel_hi:[1,1]
v_pk_mul_f32 v[194:195], v[194:195], v[86:87] op_sel:[0,1] op_sel_hi:[1,1]
v_pk_mul_f32 v[168:169], v[168:169], v[84:85] op_sel:[0,1] op_sel_hi:[1,1]
ds_write_b64 v232, v[196:197] offset:3072
v_pk_mul_f32 v[170:171], v[170:171], v[84:85] op_sel:[0,1] op_sel_hi:[1,1]
v_pk_mul_f32 v[144:145], v[144:145], v[82:83] op_sel:[0,1] op_sel_hi:[1,1]
v_pk_mul_f32 v[146:147], v[146:147], v[82:83] op_sel:[0,1] op_sel_hi:[1,1]
ds_write_b64 v232, v[198:199] offset:3584
buffer_load_dwordx4 v1, s[4:7], s44 offen offset:3072 sc1 lds
v_cvt_pk_bf16_f32 v189, v190, v191
ds_write_b64 v232, v[172:173] offset:2048
v_cvt_pk_bf16_f32 v165, v166, v167
v_cvt_pk_bf16_f32 v141, v142, v143
ds_write_b64 v232, v[174:175] offset:2560
v_cvt_pk_bf16_f32 v133, v134, v135
v_cvt_pk_bf16_f32 v157, v158, v159
v_cvt_pk_bf16_f32 v181, v182, v183
ds_write_b64 v232, v[148:149] offset:1024
v_cvt_pk_bf16_f32 v205, v206, v207
v_cvt_pk_bf16_f32 v190, v192, v193
v_cvt_pk_bf16_f32 v191, v194, v195
ds_write_b64 v232, v[150:151] offset:1536
v_cvt_pk_bf16_f32 v166, v168, v169
v_cvt_pk_bf16_f32 v167, v170, v171
v_cvt_pk_bf16_f32 v142, v144, v145
ds_write_b128 v233, v[212:215] offset:21504
v_cvt_pk_bf16_f32 v143, v146, v147
v_cvt_pk_bf16_f32 v134, v136, v137
v_cvt_pk_bf16_f32 v135, v138, v139
v_cvt_pk_bf16_f32 v158, v160, v161
v_cvt_pk_bf16_f32 v159, v162, v163
v_cvt_pk_bf16_f32 v182, v184, v185
L_stub13:
s_cbranch_execz L_wret4
v_cvt_pk_bf16_f32 v183, v186, v187
v_cvt_pk_bf16_f32 v206, v208, v209
v_cvt_pk_bf16_f32 v207, v210, v211
s_waitcnt lgkmcnt(0)
s_barrier
s_lshl_b32 s35, s30, 12
s_add_u32 s35, s35, 0x1e00000
s_add_u32 m0, s19, 147456
s_add_u32 s44, s87, 0xa1c000
buffer_load_dwordx4 v1, s[4:7], s44 offen offset:0 sc1 lds
v_mfma_f32_16x16x32_bf16 v[184:187], v[164:167], v[180:183], v[20:23]
ds_read_b128 a[0:3], v233 offset:20480
v_mfma_f32_16x16x32_bf16 v[200:203], v[188:191], v[180:183], v[24:27]
v_add_u32 v234, s36, v8
ds_read_b64_tr_b16 a[10:11], v234 offset:3072
v_mfma_f32_16x16x32_bf16 v[208:211], v[188:191], v[204:207], v[20:23]
ds_read_b64_tr_b16 a[12:13], v234 offset:4096
v_mfma_f32_16x16x32_bf16 v[224:227], v[212:215], v[204:207], v[24:27]
s_nop 2
v_max_f32 v200, v200, v184
v_max_f32 v201, v201, v185
v_max_f32 v202, v202, v186
v_max_f32 v203, v203, v187
v_max3_f32 v238, v200, v201, v202
v_max_f32 v238, v238, v203
ds_read_b64_tr_b16 a[22:23], v234 offset:3584
v_max_f32 v224, v224, v208
v_max_f32 v225, v225, v209
v_max_f32 v226, v226, v210
v_max_f32 v227, v227, v211
buffer_load_dwordx4 v1, s[4:7], s44 offen offset:1024 sc1 lds
v_max3_f32 v239, v224, v225, v226
v_max_f32 v239, v239, v227
ds_read_b64_tr_b16 a[24:25], v234 offset:4608
s_nop 0
v_permlane32_swap_b32 v239, v238
v_max_f32 v239, v239, v238
v_mov_b32 v242, v239
s_waitcnt lgkmcnt(4)
v_mfma_f32_16x16x32_bf16 v[136:139], a[0:3], v[132:135], v[76:79]
v_permlane16_swap_b32 v239, v242
v_max_f32 v239, v239, v242
v_mov_b32 v242, v239
v_mfma_f32_16x16x32_bf16 v[152:155], v[140:143], v[132:135], v[24:27]
s_nop 0
v_permlane32_swap_b32 v239, v242
v_mfma_f32_16x16x32_bf16 v[160:163], v[140:143], v[156:159], v[20:23]
v_mul_f32 v88, 0x3e8293ee, v89
v_mul_f32_e64 v89, -v239, v88
v_mfma_f32_16x16x32_bf16 v[176:179], v[164:167], v[156:159], v[24:27]
v_fma_f32 v224, v224, v88, v89
v_fma_f32 v225, v225, v88, v89
v_fma_f32 v226, v226, v88, v89
buffer_load_dwordx4 v1, s[4:7], s44 offen offset:2048 sc1 lds
v_fma_f32 v227, v227, v88, v89
v_exp_f32 v224, v224
v_exp_f32 v225, v225
v_exp_f32 v226, v226
v_exp_f32 v227, v227
v_max_f32 v152, v152, v136
v_max_f32 v153, v153, v137
v_max_f32 v154, v154, v138
v_max_f32 v176, v176, v160
v_max_f32 v177, v177, v161
v_max_f32 v178, v178, v162
v_cvt_pk_bf16_f32 v224, v224, v225
ds_read_b64_tr_b16 a[8:9], v234 offset:2048
v_max_f32 v155, v155, v139
v_max3_f32 v236, v152, v153, v154
v_max_f32 v179, v179, v163
v_max3_f32 v237, v176, v177, v178
v_cvt_pk_bf16_f32 v225, v226, v227
ds_read_b64_tr_b16 a[20:21], v234 offset:2560
v_max_f32 v236, v236, v155
v_max_f32 v237, v237, v179
buffer_load_dwordx4 v1, s[4:7], s44 offen offset:3072 sc1 lds
v_and_b32 v208, v224, v28
v_and_b32 v209, v225, v29
v_and_b32 v210, v224, v30
v_and_b32 v211, v225, v31
v_permlane32_swap_b32 v237, v236
s_nop 0
v_mfma_f32_16x16x32_bf16 v[216:219], v[16:19], v[208:211], 0
v_mul_f32 v86, 0x3e8293ee, v87
v_max_f32 v237, v237, v236
v_mul_f32_e64 v87, -v242, v86
s_waitcnt lgkmcnt(4)
v_mfma_f32_16x16x32_bf16 v[116:119], a[10:13], v[208:211], 0
v_mov_b32 v243, v237
v_fma_f32 v200, v200, v86, v87
v_fma_f32 v201, v201, v86, v87
v_fma_f32 v202, v202, v86, v87
v_fma_f32 v203, v203, v86, v87
s_waitcnt lgkmcnt(2)
v_mfma_f32_16x16x32_bf16 v[120:123], a[22:25], v[208:211], 0
v_exp_f32 v200, v200
v_exp_f32 v201, v201
v_exp_f32 v202, v202
v_exp_f32 v203, v203
v_permlane16_swap_b32 v237, v243
v_rcp_f32 v216, v216
v_cvt_pk_bf16_f32 v200, v200, v201
ds_read_b64_tr_b16 a[6:7], v234 offset:1024
v_max_f32 v237, v237, v243
v_cvt_pk_bf16_f32 v201, v202, v203
ds_read_b64_tr_b16 a[18:19], v234 offset:1536
v_mov_b32 v243, v237
v_and_b32 v184, v200, v28
v_and_b32 v185, v201, v29
v_and_b32 v186, v200, v30
v_and_b32 v187, v201, v31
v_pk_mul_f32 v[116:117], v[116:117], v[216:217] op_sel:[0,0] op_sel_hi:[1,0]
v_pk_mul_f32 v[118:119], v[118:119], v[216:217] op_sel:[0,0] op_sel_hi:[1,0]
v_cvt_pk_bf16_f32 v116, v116, v117
v_pk_mul_f32 v[120:121], v[120:121], v[216:217] op_sel:[0,0] op_sel_hi:[1,0]
v_permlane32_swap_b32 v237, v243
v_pk_mul_f32 v[122:123], v[122:123], v[216:217] op_sel:[0,0] op_sel_hi:[1,0]
v_cvt_pk_bf16_f32 v117, v118, v119
v_mfma_f32_16x16x32_bf16 v[192:195], v[16:19], v[184:187], 0
v_cvt_pk_bf16_f32 v118, v120, v121
v_cvt_pk_bf16_f32 v119, v122, v123
v_mul_f32 v84, 0x3e8293ee, v85
buffer_store_dwordx4 v[116:119], v2, s[4:7], s35 offen offset:3072 sc1
v_mul_f32_e64 v85, -v237, v84
s_waitcnt lgkmcnt(3)
v_mfma_f32_16x16x32_bf16 v[108:111], a[8:11], v[184:187], 0
v_fma_f32 v176, v176, v84, v85
v_fma_f32 v177, v177, v84, v85
v_fma_f32 v178, v178, v84, v85
v_fma_f32 v179, v179, v84, v85
s_waitcnt lgkmcnt(2)
v_mfma_f32_16x16x32_bf16 v[112:115], a[20:23], v[184:187], 0
v_exp_f32 v176, v176
v_exp_f32 v177, v177
v_exp_f32 v178, v178
v_exp_f32 v179, v179
v_rcp_f32 v192, v192
v_cvt_pk_bf16_f32 v176, v176, v177
ds_read_b64_tr_b16 a[4:5], v234 offset:0
v_cvt_pk_bf16_f32 v177, v178, v179
ds_read_b64_tr_b16 a[16:17], v234 offset:512
v_and_b32 v160, v176, v28
v_and_b32 v161, v177, v29
v_and_b32 v162, v176, v30
v_and_b32 v163, v177, v31
v_pk_mul_f32 v[108:109], v[108:109], v[192:193] op_sel:[0,0] op_sel_hi:[1,0]
v_pk_mul_f32 v[110:111], v[110:111], v[192:193] op_sel:[0,0] op_sel_hi:[1,0]
v_cvt_pk_bf16_f32 v108, v108, v109
v_pk_mul_f32 v[112:113], v[112:113], v[192:193] op_sel:[0,0] op_sel_hi:[1,0]
v_cvt_pk_bf16_f32 v109, v110, v111
v_pk_mul_f32 v[114:115], v[114:115], v[192:193] op_sel:[0,0] op_sel_hi:[1,0]
v_cvt_pk_bf16_f32 v110, v112, v113
v_mfma_f32_16x16x32_bf16 v[168:171], v[16:19], v[160:163], 0
v_cvt_pk_bf16_f32 v111, v114, v115
v_mul_f32 v82, 0x3e8293ee, v83
buffer_store_dwordx4 v[108:111], v2, s[4:7], s35 offen offset:2048 sc1
v_mul_f32_e64 v83, -v243, v82
s_waitcnt lgkmcnt(3)
v_mfma_f32_16x16x32_bf16 v[100:103], a[6:9], v[160:163], 0
v_fma_f32 v152, v152, v82, v83
v_fma_f32 v153, v153, v82, v83
v_fma_f32 v154, v154, v82, v83
v_fma_f32 v155, v155, v82, v83
s_waitcnt lgkmcnt(2)
v_mfma_f32_16x16x32_bf16 v[104:107], a[18:21], v[160:163], 0
v_exp_f32 v152, v152
v_exp_f32 v153, v153
buffer_atomic_add v12, v10, s[4:7], s94 offen sc1
v_exp_f32 v154, v154
v_exp_f32 v155, v155
v_rcp_f32 v168, v168
v_cvt_pk_bf16_f32 v152, v152, v153
v_cvt_pk_bf16_f32 v153, v154, v155
v_and_b32 v136, v152, v80
v_and_b32 v137, v153, v81
v_and_b32 v138, v152, v30
v_and_b32 v139, v153, v31
v_pk_mul_f32 v[100:101], v[100:101], v[168:169] op_sel:[0,0] op_sel_hi:[1,0]
v_pk_mul_f32 v[102:103], v[102:103], v[168:169] op_sel:[0,0] op_sel_hi:[1,0]
v_cvt_pk_bf16_f32 v100, v100, v101
v_pk_mul_f32 v[104:105], v[104:105], v[168:169] op_sel:[0,0] op_sel_hi:[1,0]
v_cvt_pk_bf16_f32 v101, v102, v103
v_pk_mul_f32 v[106:107], v[106:107], v[168:169] op_sel:[0,0] op_sel_hi:[1,0]
v_cvt_pk_bf16_f32 v102, v104, v105
v_mfma_f32_16x16x32_bf16 v[144:147], v[16:19], v[136:139], 0
v_cvt_pk_bf16_f32 v103, v106, v107
buffer_store_dwordx4 v[100:103], v2, s[4:7], s35 offen offset:1024 sc1
s_waitcnt lgkmcnt(1)
v_mfma_f32_16x16x32_bf16 v[92:95], a[4:7], v[136:139], 0
s_nop 3
v_rcp_f32 v144, v144
s_waitcnt lgkmcnt(0)
v_mfma_f32_16x16x32_bf16 v[96:99], a[16:19], v[136:139], 0
s_nop 0
v_pk_mul_f32 v[92:93], v[92:93], v[144:145] op_sel:[0,0] op_sel_hi:[1,0]
v_pk_mul_f32 v[94:95], v[94:95], v[144:145] op_sel:[0,0] op_sel_hi:[1,0]
v_cvt_pk_bf16_f32 v92, v92, v93
v_cvt_pk_bf16_f32 v93, v94, v95
s_nop 2
v_pk_mul_f32 v[96:97], v[96:97], v[144:145] op_sel:[0,0] op_sel_hi:[1,0]
v_pk_mul_f32 v[98:99], v[98:99], v[144:145] op_sel:[0,0] op_sel_hi:[1,0]
v_cvt_pk_bf16_f32 v94, v96, v97
v_cvt_pk_bf16_f32 v95, v98, v99
buffer_store_dwordx4 v[92:95], v2, s[4:7], s35 offen offset:0 sc1
s_add_u32 s92, s71, 0x20000
s_add_u32 s36, s66, 0x20080
s_add_u32 s40, s4, 0x1e00000
s_addc_u32 s41, s5, 0
v_add_u32 v5, 32768, v1
v_add_u32 v6, 98304, v1
s_cmp_eq_u32 s3, 0
s_cselect_b32 s35, 8, 0
s_lshl_b32 s35, s35, 12
v_lshlrev_b32 v132, 16, v32
v_and_b32 v133, 0xffff0000, v32
v_lshlrev_b32 v134, 16, v33
v_and_b32 v135, 0xffff0000, v33
v_lshlrev_b32 v136, 16, v34
v_and_b32 v137, 0xffff0000, v34
v_lshlrev_b32 v138, 16, v35
v_and_b32 v139, 0xffff0000, v35
v_lshlrev_b32 v140, 16, v36
v_and_b32 v141, 0xffff0000, v36
v_lshlrev_b32 v142, 16, v37
v_and_b32 v143, 0xffff0000, v37
v_lshlrev_b32 v144, 16, v38
v_and_b32 v145, 0xffff0000, v38
v_lshlrev_b32 v146, 16, v39
v_and_b32 v147, 0xffff0000, v39
v_lshlrev_b32 v148, 16, v40
v_and_b32 v149, 0xffff0000, v40
v_lshlrev_b32 v150, 16, v41
v_and_b32 v151, 0xffff0000, v41
v_lshlrev_b32 v152, 16, v42
v_and_b32 v153, 0xffff0000, v42
v_lshlrev_b32 v154, 16, v43
v_and_b32 v155, 0xffff0000, v43
v_lshlrev_b32 v156, 16, v44
v_and_b32 v157, 0xffff0000, v44
v_lshlrev_b32 v158, 16, v45
v_and_b32 v159, 0xffff0000, v45
v_lshlrev_b32 v160, 16, v46
v_and_b32 v161, 0xffff0000, v46
v_lshlrev_b32 v162, 16, v47
v_and_b32 v163, 0xffff0000, v47
s_mov_b32 s95, -1
s_cmp_lg_u32 s28, 3
s_cbranch_scc1 L_wskip5
s_mov_b64 exec, 0
s_branch L_stub14
L_wret5:
s_mov_b64 exec, -1
L_wskip5:
s_cmp_lg_u32 s28, 0
s_cbranch_scc1 Lpe_28
s_add_u32 s36, s66, 0x20080
s_mov_b32 s37, 0
Lpoll_27:
v_mov_b32 v11, 0
buffer_atomic_add v11, v251, s[4:7], s36 offen sc0 sc1
s_add_u32 s37, s37, 1
s_waitcnt vmcnt(0)
v_readfirstlane_b32 s38, v11
s_nop 0
s_cmp_ge_u32 s38, 32
s_cbranch_scc1 Lpe_28
s_cmp_lt_u32 s37, 0x100000
s_cbranch_scc1 Lpoll_27
Lpe_28:
s_waitcnt vmcnt(0)
s_barrier
L_k2go2:
buffer_load_dwordx4 a[0:3], v4, s[40:43], s35 offen offset:0 sc1
buffer_load_dwordx4 a[4:7], v4, s[40:43], s35 offen offset:1024 sc1
s_cmp_eq_u32 s3, 1
s_cselect_b32 s35, 9, 1
s_lshl_b32 s35, s35, 12
buffer_load_dwordx4 a[8:11], v4, s[40:43], s35 offen offset:0 sc1
buffer_load_dwordx4 a[12:15], v4, s[40:43], s35 offen offset:1024 sc1
s_cmp_eq_u32 s3, 2
s_cselect_b32 s35, 10, 2
s_lshl_b32 s35, s35, 12
buffer_load_dwordx4 a[16:19], v4, s[40:43], s35 offen offset:0 sc1
buffer_load_dwordx4 a[20:23], v4, s[40:43], s35 offen offset:1024 sc1
s_cmp_eq_u32 s3, 3
s_cselect_b32 s35, 11, 3
s_lshl_b32 s35, s35, 12
buffer_load_dwordx4 a[24:27], v4, s[40:43], s35 offen offset:0 sc1
buffer_load_dwordx4 a[28:31], v4, s[40:43], s35 offen offset:1024 sc1
s_cmp_eq_u32 s3, 4
s_cselect_b32 s35, 12, 4
s_lshl_b32 s35, s35, 12
buffer_load_dwordx4 a[32:35], v4, s[40:43], s35 offen offset:0 sc1
buffer_load_dwordx4 a[36:39], v4, s[40:43], s35 offen offset:1024 sc1
s_cmp_eq_u32 s3, 5
s_cselect_b32 s35, 13, 5
s_lshl_b32 s35, s35, 12
ds_read_b128 a[96:99], v5 offset:0
ds_read_b128 a[100:103], v5 offset:1024
ds_read_b128 a[104:107], v5 offset:2048
ds_read_b128 a[108:111], v5 offset:3072
ds_read_b128 a[112:115], v5 offset:4096
ds_read_b128 a[116:119], v5 offset:5120
ds_read_b128 a[120:123], v5 offset:6144
ds_read_b128 a[124:127], v5 offset:7168
s_waitcnt vmcnt(8) lgkmcnt(4)
v_mfma_f32_16x16x32_bf16 v[132:135], a[96:99], a[0:3], v[132:135]
ds_read_b128 a[128:131], v5 offset:8192
v_mfma_f32_16x16x32_bf16 v[148:151], a[96:99], a[4:7], v[148:151]
ds_read_b128 a[132:135], v5 offset:9216
v_mfma_f32_16x16x32_bf16 v[152:155], a[100:103], a[4:7], v[152:155]
buffer_load_dwordx4 a[40:43], v4, s[40:43], s35 offen offset:0 sc1
v_mfma_f32_16x16x32_bf16 v[136:139], a[100:103], a[0:3], v[136:139]
ds_read_b128 a[136:139], v5 offset:10240
v_mfma_f32_16x16x32_bf16 v[140:143], a[104:107], a[0:3], v[140:143]
ds_read_b128 a[140:143], v5 offset:11264
v_mfma_f32_16x16x32_bf16 v[156:159], a[104:107], a[4:7], v[156:159]
v_mfma_f32_16x16x32_bf16 v[160:163], a[108:111], a[4:7], v[160:163]
buffer_load_dwordx4 a[44:47], v4, s[40:43], s35 offen offset:1024 sc1
v_mfma_f32_16x16x32_bf16 v[144:147], a[108:111], a[0:3], v[144:147]
s_waitcnt vmcnt(8) lgkmcnt(4)
v_mfma_f32_16x16x32_bf16 v[132:135], a[112:115], a[8:11], v[132:135]
s_cmp_eq_u32 s3, 6
s_cselect_b32 s35, 14, 6
s_lshl_b32 s35, s35, 12
v_mfma_f32_16x16x32_bf16 v[148:151], a[112:115], a[12:15], v[148:151]
ds_read_b128 a[96:99], v5 offset:12288
v_mfma_f32_16x16x32_bf16 v[152:155], a[116:119], a[12:15], v[152:155]
buffer_load_dwordx4 a[0:3], v4, s[40:43], s35 offen offset:0 sc1
v_mfma_f32_16x16x32_bf16 v[136:139], a[116:119], a[8:11], v[136:139]
ds_read_b128 a[100:103], v5 offset:13312
v_mfma_f32_16x16x32_bf16 v[140:143], a[120:123], a[8:11], v[140:143]
ds_read_b128 a[104:107], v5 offset:14336
v_mfma_f32_16x16x32_bf16 v[156:159], a[120:123], a[12:15], v[156:159]
ds_read_b128 a[108:111], v5 offset:15360
v_mfma_f32_16x16x32_bf16 v[160:163], a[124:127], a[12:15], v[160:163]
buffer_load_dwordx4 a[4:7], v4, s[40:43], s35 offen offset:1024 sc1
v_mfma_f32_16x16x32_bf16 v[144:147], a[124:127], a[8:11], v[144:147]
s_waitcnt vmcnt(8) lgkmcnt(4)
v_mfma_f32_16x16x32_bf16 v[132:135], a[128:131], a[16:19], v[132:135]
s_cmp_eq_u32 s3, 7
s_cselect_b32 s35, 15, 7
s_lshl_b32 s35, s35, 12
v_mfma_f32_16x16x32_bf16 v[148:151], a[128:131], a[20:23], v[148:151]
ds_read_b128 a[112:115], v5 offset:16384
v_mfma_f32_16x16x32_bf16 v[152:155], a[132:135], a[20:23], v[152:155]
buffer_load_dwordx4 a[8:11], v4, s[40:43], s35 offen offset:0 sc1
v_mfma_f32_16x16x32_bf16 v[136:139], a[132:135], a[16:19], v[136:139]
ds_read_b128 a[116:119], v5 offset:17408
v_mfma_f32_16x16x32_bf16 v[140:143], a[136:139], a[16:19], v[140:143]
ds_read_b128 a[120:123], v5 offset:18432
v_mfma_f32_16x16x32_bf16 v[156:159], a[136:139], a[20:23], v[156:159]
ds_read_b128 a[124:127], v5 offset:19456
v_mfma_f32_16x16x32_bf16 v[160:163], a[140:143], a[20:23], v[160:163]
buffer_load_dwordx4 a[12:15], v4, s[40:43], s35 offen offset:1024 sc1
v_mfma_f32_16x16x32_bf16 v[144:147], a[140:143], a[16:19], v[144:147]
s_waitcnt vmcnt(8) lgkmcnt(4)
v_mfma_f32_16x16x32_bf16 v[132:135], a[96:99], a[24:27], v[132:135]
s_cmp_eq_u32 s3, 0
s_cselect_b32 s35, 16, 8
s_lshl_b32 s35, s35, 12
v_mfma_f32_16x16x32_bf16 v[148:151], a[96:99], a[28:31], v[148:151]
ds_read_b128 a[128:131], v5 offset:20480
v_mfma_f32_16x16x32_bf16 v[152:155], a[100:103], a[28:31], v[152:155]
buffer_load_dwordx4 a[16:19], v4, s[40:43], s35 offen offset:0 sc1
v_mfma_f32_16x16x32_bf16 v[136:139], a[100:103], a[24:27], v[136:139]
ds_read_b128 a[132:135], v5 offset:21504
v_mfma_f32_16x16x32_bf16 v[140:143], a[104:107], a[24:27], v[140:143]
ds_read_b128 a[136:139], v5 offset:22528
v_mfma_f32_16x16x32_bf16 v[156:159], a[104:107], a[28:31], v[156:159]
ds_read_b128 a[140:143], v5 offset:23552
v_mfma_f32_16x16x32_bf16 v[160:163], a[108:111], a[28:31], v[160:163]
buffer_load_dwordx4 a[20:23], v4, s[40:43], s35 offen offset:1024 sc1
v_mfma_f32_16x16x32_bf16 v[144:147], a[108:111], a[24:27], v[144:147]
s_waitcnt vmcnt(8) lgkmcnt(4)
v_mfma_f32_16x16x32_bf16 v[132:135], a[112:115], a[32:35], v[132:135]
s_cmp_eq_u32 s3, 1
s_cselect_b32 s35, 17, 9
s_lshl_b32 s35, s35, 12
v_mfma_f32_16x16x32_bf16 v[148:151], a[112:115], a[36:39], v[148:151]
ds_read_b128 a[96:99], v5 offset:24576
v_mfma_f32_16x16x32_bf16 v[152:155], a[116:119], a[36:39], v[152:155]
buffer_load_dwordx4 a[24:27], v4, s[40:43], s35 offen offset:0 sc1
v_mfma_f32_16x16x32_bf16 v[136:139], a[116:119], a[32:35], v[136:139]
ds_read_b128 a[100:103], v5 offset:25600
v_mfma_f32_16x16x32_bf16 v[140:143], a[120:123], a[32:35], v[140:143]
ds_read_b128 a[104:107], v5 offset:26624
v_mfma_f32_16x16x32_bf16 v[156:159], a[120:123], a[36:39], v[156:159]
ds_read_b128 a[108:111], v5 offset:27648
v_mfma_f32_16x16x32_bf16 v[160:163], a[124:127], a[36:39], v[160:163]
buffer_load_dwordx4 a[28:31], v4, s[40:43], s35 offen offset:1024 sc1
v_mfma_f32_16x16x32_bf16 v[144:147], a[124:127], a[32:35], v[144:147]
s_waitcnt vmcnt(8) lgkmcnt(4)
v_mfma_f32_16x16x32_bf16 v[132:135], a[128:131], a[40:43], v[132:135]
s_cmp_eq_u32 s3, 2
s_cselect_b32 s35, 18, 10
s_lshl_b32 s35, s35, 12
v_mfma_f32_16x16x32_bf16 v[148:151], a[128:131], a[44:47], v[148:151]
ds_read_b128 a[112:115], v5 offset:28672
v_mfma_f32_16x16x32_bf16 v[152:155], a[132:135], a[44:47], v[152:155]
buffer_load_dwordx4 a[32:35], v4, s[40:43], s35 offen offset:0 sc1
v_mfma_f32_16x16x32_bf16 v[136:139], a[132:135], a[40:43], v[136:139]
ds_read_b128 a[116:119], v5 offset:29696
v_mfma_f32_16x16x32_bf16 v[140:143], a[136:139], a[40:43], v[140:143]
ds_read_b128 a[120:123], v5 offset:30720
v_mfma_f32_16x16x32_bf16 v[156:159], a[136:139], a[44:47], v[156:159]
ds_read_b128 a[124:127], v5 offset:31744
v_mfma_f32_16x16x32_bf16 v[160:163], a[140:143], a[44:47], v[160:163]
buffer_load_dwordx4 a[36:39], v4, s[40:43], s35 offen offset:1024 sc1
v_mfma_f32_16x16x32_bf16 v[144:147], a[140:143], a[40:43], v[144:147]
s_waitcnt vmcnt(8) lgkmcnt(4)
v_mfma_f32_16x16x32_bf16 v[132:135], a[96:99], a[0:3], v[132:135]
s_cmp_eq_u32 s3, 3
s_cselect_b32 s35, 19, 11
s_lshl_b32 s35, s35, 12
v_mfma_f32_16x16x32_bf16 v[148:151], a[96:99], a[4:7], v[148:151]
ds_read_b128 a[128:131], v5 offset:32768
v_mfma_f32_16x16x32_bf16 v[152:155], a[100:103], a[4:7], v[152:155]
buffer_load_dwordx4 a[40:43], v4, s[40:43], s35 offen offset:0 sc1
v_mfma_f32_16x16x32_bf16 v[136:139], a[100:103], a[0:3], v[136:139]
ds_read_b128 a[132:135], v5 offset:33792
v_mfma_f32_16x16x32_bf16 v[140:143], a[104:107], a[0:3], v[140:143]
ds_read_b128 a[136:139], v5 offset:34816
v_mfma_f32_16x16x32_bf16 v[156:159], a[104:107], a[4:7], v[156:159]
ds_read_b128 a[140:143], v5 offset:35840
v_mfma_f32_16x16x32_bf16 v[160:163], a[108:111], a[4:7], v[160:163]
buffer_load_dwordx4 a[44:47], v4, s[40:43], s35 offen offset:1024 sc1
v_mfma_f32_16x16x32_bf16 v[144:147], a[108:111], a[0:3], v[144:147]
s_waitcnt vmcnt(8) lgkmcnt(4)
v_mfma_f32_16x16x32_bf16 v[132:135], a[112:115], a[8:11], v[132:135]
s_cmp_eq_u32 s3, 4
s_cselect_b32 s35, 20, 12
s_lshl_b32 s35, s35, 12
v_mfma_f32_16x16x32_bf16 v[148:151], a[112:115], a[12:15], v[148:151]
ds_read_b128 a[96:99], v5 offset:36864
v_mfma_f32_16x16x32_bf16 v[152:155], a[116:119], a[12:15], v[152:155]
buffer_load_dwordx4 a[0:3], v4, s[40:43], s35 offen offset:0 sc1
v_mfma_f32_16x16x32_bf16 v[136:139], a[116:119], a[8:11], v[136:139]
ds_read_b128 a[100:103], v5 offset:37888
v_mfma_f32_16x16x32_bf16 v[140:143], a[120:123], a[8:11], v[140:143]
ds_read_b128 a[104:107], v5 offset:38912
v_mfma_f32_16x16x32_bf16 v[156:159], a[120:123], a[12:15], v[156:159]
ds_read_b128 a[108:111], v5 offset:39936
v_mfma_f32_16x16x32_bf16 v[160:163], a[124:127], a[12:15], v[160:163]
buffer_load_dwordx4 a[4:7], v4, s[40:43], s35 offen offset:1024 sc1
v_mfma_f32_16x16x32_bf16 v[144:147], a[124:127], a[8:11], v[144:147]
s_waitcnt vmcnt(8) lgkmcnt(4)
v_mfma_f32_16x16x32_bf16 v[132:135], a[128:131], a[16:19], v[132:135]
s_cmp_eq_u32 s3, 5
s_cselect_b32 s35, 21, 13
s_lshl_b32 s35, s35, 12
v_mfma_f32_16x16x32_bf16 v[148:151], a[128:131], a[20:23], v[148:151]
ds_read_b128 a[112:115], v5 offset:40960
v_mfma_f32_16x16x32_bf16 v[152:155], a[132:135], a[20:23], v[152:155]
buffer_load_dwordx4 a[8:11], v4, s[40:43], s35 offen offset:0 sc1
v_mfma_f32_16x16x32_bf16 v[136:139], a[132:135], a[16:19], v[136:139]
ds_read_b128 a[116:119], v5 offset:41984
v_mfma_f32_16x16x32_bf16 v[140:143], a[136:139], a[16:19], v[140:143]
ds_read_b128 a[120:123], v5 offset:43008
v_mfma_f32_16x16x32_bf16 v[156:159], a[136:139], a[20:23], v[156:159]
ds_read_b128 a[124:127], v5 offset:44032
v_mfma_f32_16x16x32_bf16 v[160:163], a[140:143], a[20:23], v[160:163]
buffer_load_dwordx4 a[12:15], v4, s[40:43], s35 offen offset:1024 sc1
v_mfma_f32_16x16x32_bf16 v[144:147], a[140:143], a[16:19], v[144:147]
s_waitcnt vmcnt(8) lgkmcnt(4)
v_mfma_f32_16x16x32_bf16 v[132:135], a[96:99], a[24:27], v[132:135]
s_cmp_eq_u32 s3, 6
s_cselect_b32 s35, 22, 14
s_lshl_b32 s35, s35, 12
v_mfma_f32_16x16x32_bf16 v[148:151], a[96:99], a[28:31], v[148:151]
ds_read_b128 a[128:131], v5 offset:45056
v_mfma_f32_16x16x32_bf16 v[152:155], a[100:103], a[28:31], v[152:155]
buffer_load_dwordx4 a[16:19], v4, s[40:43], s35 offen offset:0 sc1
v_mfma_f32_16x16x32_bf16 v[136:139], a[100:103], a[24:27], v[136:139]
ds_read_b128 a[132:135], v5 offset:46080
v_mfma_f32_16x16x32_bf16 v[140:143], a[104:107], a[24:27], v[140:143]
ds_read_b128 a[136:139], v5 offset:47104
v_mfma_f32_16x16x32_bf16 v[156:159], a[104:107], a[28:31], v[156:159]
ds_read_b128 a[140:143], v5 offset:48128
v_mfma_f32_16x16x32_bf16 v[160:163], a[108:111], a[28:31], v[160:163]
buffer_load_dwordx4 a[20:23], v4, s[40:43], s35 offen offset:1024 sc1
v_mfma_f32_16x16x32_bf16 v[144:147], a[108:111], a[24:27], v[144:147]
s_waitcnt vmcnt(8) lgkmcnt(4)
v_mfma_f32_16x16x32_bf16 v[132:135], a[112:115], a[32:35], v[132:135]
s_cmp_eq_u32 s3, 7
s_cselect_b32 s35, 23, 15
s_lshl_b32 s35, s35, 12
v_mfma_f32_16x16x32_bf16 v[148:151], a[112:115], a[36:39], v[148:151]
ds_read_b128 a[96:99], v5 offset:49152
v_mfma_f32_16x16x32_bf16 v[152:155], a[116:119], a[36:39], v[152:155]
buffer_load_dwordx4 a[24:27], v4, s[40:43], s35 offen offset:0 sc1
v_mfma_f32_16x16x32_bf16 v[136:139], a[116:119], a[32:35], v[136:139]
ds_read_b128 a[100:103], v5 offset:50176
v_mfma_f32_16x16x32_bf16 v[140:143], a[120:123], a[32:35], v[140:143]
ds_read_b128 a[104:107], v5 offset:51200
v_mfma_f32_16x16x32_bf16 v[156:159], a[120:123], a[36:39], v[156:159]
ds_read_b128 a[108:111], v5 offset:52224
v_mfma_f32_16x16x32_bf16 v[160:163], a[124:127], a[36:39], v[160:163]
buffer_load_dwordx4 a[28:31], v4, s[40:43], s35 offen offset:1024 sc1
v_mfma_f32_16x16x32_bf16 v[144:147], a[124:127], a[32:35], v[144:147]
s_waitcnt vmcnt(8) lgkmcnt(4)
v_mfma_f32_16x16x32_bf16 v[132:135], a[128:131], a[40:43], v[132:135]
s_cmp_eq_u32 s3, 0
s_cselect_b32 s35, 24, 16
s_lshl_b32 s35, s35, 12
v_mfma_f32_16x16x32_bf16 v[148:151], a[128:131], a[44:47], v[148:151]
ds_read_b128 a[112:115], v5 offset:53248
v_mfma_f32_16x16x32_bf16 v[152:155], a[132:135], a[44:47], v[152:155]
buffer_load_dwordx4 a[32:35], v4, s[40:43], s35 offen offset:0 sc1
v_mfma_f32_16x16x32_bf16 v[136:139], a[132:135], a[40:43], v[136:139]
ds_read_b128 a[116:119], v5 offset:54272
v_mfma_f32_16x16x32_bf16 v[140:143], a[136:139], a[40:43], v[140:143]
ds_read_b128 a[120:123], v5 offset:55296
v_mfma_f32_16x16x32_bf16 v[156:159], a[136:139], a[44:47], v[156:159]
ds_read_b128 a[124:127], v5 offset:56320
v_mfma_f32_16x16x32_bf16 v[160:163], a[140:143], a[44:47], v[160:163]
buffer_load_dwordx4 a[36:39], v4, s[40:43], s35 offen offset:1024 sc1
v_mfma_f32_16x16x32_bf16 v[144:147], a[140:143], a[40:43], v[144:147]
s_waitcnt vmcnt(8) lgkmcnt(4)
v_mfma_f32_16x16x32_bf16 v[132:135], a[96:99], a[0:3], v[132:135]
s_cmp_eq_u32 s3, 1
s_cselect_b32 s35, 25, 17
s_lshl_b32 s35, s35, 12
v_mfma_f32_16x16x32_bf16 v[148:151], a[96:99], a[4:7], v[148:151]
ds_read_b128 a[128:131], v5 offset:57344
v_mfma_f32_16x16x32_bf16 v[152:155], a[100:103], a[4:7], v[152:155]
buffer_load_dwordx4 a[40:43], v4, s[40:43], s35 offen offset:0 sc1
v_mfma_f32_16x16x32_bf16 v[136:139], a[100:103], a[0:3], v[136:139]
ds_read_b128 a[132:135], v5 offset:58368
v_mfma_f32_16x16x32_bf16 v[140:143], a[104:107], a[0:3], v[140:143]
ds_read_b128 a[136:139], v5 offset:59392
v_mfma_f32_16x16x32_bf16 v[156:159], a[104:107], a[4:7], v[156:159]
ds_read_b128 a[140:143], v5 offset:60416
v_mfma_f32_16x16x32_bf16 v[160:163], a[108:111], a[4:7], v[160:163]
buffer_load_dwordx4 a[44:47], v4, s[40:43], s35 offen offset:1024 sc1
v_mfma_f32_16x16x32_bf16 v[144:147], a[108:111], a[0:3], v[144:147]
s_waitcnt vmcnt(8) lgkmcnt(4)
v_mfma_f32_16x16x32_bf16 v[132:135], a[112:115], a[8:11], v[132:135]
s_cmp_eq_u32 s3, 2
s_cselect_b32 s35, 26, 18
s_lshl_b32 s35, s35, 12
v_mfma_f32_16x16x32_bf16 v[148:151], a[112:115], a[12:15], v[148:151]
ds_read_b128 a[96:99], v5 offset:61440
v_mfma_f32_16x16x32_bf16 v[152:155], a[116:119], a[12:15], v[152:155]
buffer_load_dwordx4 a[0:3], v4, s[40:43], s35 offen offset:0 sc1
v_mfma_f32_16x16x32_bf16 v[136:139], a[116:119], a[8:11], v[136:139]
ds_read_b128 a[100:103], v5 offset:62464
v_mfma_f32_16x16x32_bf16 v[140:143], a[120:123], a[8:11], v[140:143]
ds_read_b128 a[104:107], v5 offset:63488
v_mfma_f32_16x16x32_bf16 v[156:159], a[120:123], a[12:15], v[156:159]
ds_read_b128 a[108:111], v5 offset:64512
v_mfma_f32_16x16x32_bf16 v[160:163], a[124:127], a[12:15], v[160:163]
buffer_load_dwordx4 a[4:7], v4, s[40:43], s35 offen offset:1024 sc1
v_mfma_f32_16x16x32_bf16 v[144:147], a[124:127], a[8:11], v[144:147]
s_waitcnt vmcnt(8) lgkmcnt(4)
v_mfma_f32_16x16x32_bf16 v[132:135], a[128:131], a[16:19], v[132:135]
s_cmp_eq_u32 s3, 3
s_cselect_b32 s35, 27, 19
s_lshl_b32 s35, s35, 12
v_mfma_f32_16x16x32_bf16 v[148:151], a[128:131], a[20:23], v[148:151]
ds_read_b128 a[112:115], v6 offset:0
v_mfma_f32_16x16x32_bf16 v[152:155], a[132:135], a[20:23], v[152:155]
buffer_load_dwordx4 a[8:11], v4, s[40:43], s35 offen offset:0 sc1
v_mfma_f32_16x16x32_bf16 v[136:139], a[132:135], a[16:19], v[136:139]
ds_read_b128 a[116:119], v6 offset:1024
v_mfma_f32_16x16x32_bf16 v[140:143], a[136:139], a[16:19], v[140:143]
ds_read_b128 a[120:123], v6 offset:2048
v_mfma_f32_16x16x32_bf16 v[156:159], a[136:139], a[20:23], v[156:159]
ds_read_b128 a[124:127], v6 offset:3072
v_mfma_f32_16x16x32_bf16 v[160:163], a[140:143], a[20:23], v[160:163]
buffer_load_dwordx4 a[12:15], v4, s[40:43], s35 offen offset:1024 sc1
v_mfma_f32_16x16x32_bf16 v[144:147], a[140:143], a[16:19], v[144:147]
s_waitcnt vmcnt(8) lgkmcnt(4)
v_mfma_f32_16x16x32_bf16 v[132:135], a[96:99], a[24:27], v[132:135]
s_cmp_eq_u32 s3, 4
s_cselect_b32 s35, 28, 20
s_lshl_b32 s35, s35, 12
v_mfma_f32_16x16x32_bf16 v[148:151], a[96:99], a[28:31], v[148:151]
ds_read_b128 a[128:131], v6 offset:4096
v_mfma_f32_16x16x32_bf16 v[152:155], a[100:103], a[28:31], v[152:155]
buffer_load_dwordx4 a[16:19], v4, s[40:43], s35 offen offset:0 sc1
v_mfma_f32_16x16x32_bf16 v[136:139], a[100:103], a[24:27], v[136:139]
ds_read_b128 a[132:135], v6 offset:5120
v_mfma_f32_16x16x32_bf16 v[140:143], a[104:107], a[24:27], v[140:143]
ds_read_b128 a[136:139], v6 offset:6144
v_mfma_f32_16x16x32_bf16 v[156:159], a[104:107], a[28:31], v[156:159]
ds_read_b128 a[140:143], v6 offset:7168
v_mfma_f32_16x16x32_bf16 v[160:163], a[108:111], a[28:31], v[160:163]
buffer_load_dwordx4 a[20:23], v4, s[40:43], s35 offen offset:1024 sc1
v_mfma_f32_16x16x32_bf16 v[144:147], a[108:111], a[24:27], v[144:147]
s_waitcnt vmcnt(8) lgkmcnt(4)
v_mfma_f32_16x16x32_bf16 v[132:135], a[112:115], a[32:35], v[132:135]
s_cmp_eq_u32 s3, 5
s_cselect_b32 s35, 29, 21
s_lshl_b32 s35, s35, 12
v_mfma_f32_16x16x32_bf16 v[148:151], a[112:115], a[36:39], v[148:151]
ds_read_b128 a[96:99], v6 offset:8192
v_mfma_f32_16x16x32_bf16 v[152:155], a[116:119], a[36:39], v[152:155]
buffer_load_dwordx4 a[24:27], v4, s[40:43], s35 offen offset:0 sc1
v_mfma_f32_16x16x32_bf16 v[136:139], a[116:119], a[32:35], v[136:139]
ds_read_b128 a[100:103], v6 offset:9216
v_mfma_f32_16x16x32_bf16 v[140:143], a[120:123], a[32:35], v[140:143]
ds_read_b128 a[104:107], v6 offset:10240
v_mfma_f32_16x16x32_bf16 v[156:159], a[120:123], a[36:39], v[156:159]
ds_read_b128 a[108:111], v6 offset:11264
v_mfma_f32_16x16x32_bf16 v[160:163], a[124:127], a[36:39], v[160:163]
buffer_load_dwordx4 a[28:31], v4, s[40:43], s35 offen offset:1024 sc1
v_mfma_f32_16x16x32_bf16 v[144:147], a[124:127], a[32:35], v[144:147]
s_waitcnt vmcnt(8) lgkmcnt(4)
v_mfma_f32_16x16x32_bf16 v[132:135], a[128:131], a[40:43], v[132:135]
s_cmp_eq_u32 s3, 6
s_cselect_b32 s35, 30, 22
s_lshl_b32 s35, s35, 12
v_mfma_f32_16x16x32_bf16 v[148:151], a[128:131], a[44:47], v[148:151]
ds_read_b128 a[112:115], v6 offset:12288
v_mfma_f32_16x16x32_bf16 v[152:155], a[132:135], a[44:47], v[152:155]
buffer_load_dwordx4 a[32:35], v4, s[40:43], s35 offen offset:0 sc1
v_mfma_f32_16x16x32_bf16 v[136:139], a[132:135], a[40:43], v[136:139]
ds_read_b128 a[116:119], v6 offset:13312
v_mfma_f32_16x16x32_bf16 v[140:143], a[136:139], a[40:43], v[140:143]
ds_read_b128 a[120:123], v6 offset:14336
v_mfma_f32_16x16x32_bf16 v[156:159], a[136:139], a[44:47], v[156:159]
ds_read_b128 a[124:127], v6 offset:15360
L_stub14:
s_cbranch_execz L_wret5
v_mfma_f32_16x16x32_bf16 v[160:163], a[140:143], a[44:47], v[160:163]
buffer_load_dwordx4 a[36:39], v4, s[40:43], s35 offen offset:1024 sc1
v_mfma_f32_16x16x32_bf16 v[144:147], a[140:143], a[40:43], v[144:147]
s_waitcnt vmcnt(8) lgkmcnt(4)
v_mfma_f32_16x16x32_bf16 v[132:135], a[96:99], a[0:3], v[132:135]
s_cmp_eq_u32 s3, 7
s_cselect_b32 s35, 31, 23
s_lshl_b32 s35, s35, 12
v_mfma_f32_16x16x32_bf16 v[148:151], a[96:99], a[4:7], v[148:151]
ds_read_b128 a[128:131], v6 offset:16384
v_mfma_f32_16x16x32_bf16 v[152:155], a[100:103], a[4:7], v[152:155]
buffer_load_dwordx4 a[40:43], v4, s[40:43], s35 offen offset:0 sc1
v_mfma_f32_16x16x32_bf16 v[136:139], a[100:103], a[0:3], v[136:139]
ds_read_b128 a[132:135], v6 offset:17408
v_mfma_f32_16x16x32_bf16 v[140:143], a[104:107], a[0:3], v[140:143]
ds_read_b128 a[136:139], v6 offset:18432
v_mfma_f32_16x16x32_bf16 v[156:159], a[104:107], a[4:7], v[156:159]
ds_read_b128 a[140:143], v6 offset:19456
v_mfma_f32_16x16x32_bf16 v[160:163], a[108:111], a[4:7], v[160:163]
buffer_load_dwordx4 a[44:47], v4, s[40:43], s35 offen offset:1024 sc1
v_mfma_f32_16x16x32_bf16 v[144:147], a[108:111], a[0:3], v[144:147]
s_waitcnt vmcnt(8) lgkmcnt(4)
v_mfma_f32_16x16x32_bf16 v[132:135], a[112:115], a[8:11], v[132:135]
s_cmp_eq_u32 s3, 0
s_cselect_b32 s35, 0, 24
s_lshl_b32 s35, s35, 12
v_mfma_f32_16x16x32_bf16 v[148:151], a[112:115], a[12:15], v[148:151]
ds_read_b128 a[96:99], v6 offset:20480
v_mfma_f32_16x16x32_bf16 v[152:155], a[116:119], a[12:15], v[152:155]
buffer_load_dwordx4 a[0:3], v4, s[40:43], s35 offen offset:0 sc1
v_mfma_f32_16x16x32_bf16 v[136:139], a[116:119], a[8:11], v[136:139]
ds_read_b128 a[100:103], v6 offset:21504
v_mfma_f32_16x16x32_bf16 v[140:143], a[120:123], a[8:11], v[140:143]
ds_read_b128 a[104:107], v6 offset:22528
v_mfma_f32_16x16x32_bf16 v[156:159], a[120:123], a[12:15], v[156:159]
ds_read_b128 a[108:111], v6 offset:23552
v_mfma_f32_16x16x32_bf16 v[160:163], a[124:127], a[12:15], v[160:163]
buffer_load_dwordx4 a[4:7], v4, s[40:43], s35 offen offset:1024 sc1
v_mfma_f32_16x16x32_bf16 v[144:147], a[124:127], a[8:11], v[144:147]
s_waitcnt vmcnt(8) lgkmcnt(4)
v_mfma_f32_16x16x32_bf16 v[132:135], a[128:131], a[16:19], v[132:135]
s_cmp_eq_u32 s3, 1
s_cselect_b32 s35, 1, 25
s_lshl_b32 s35, s35, 12
v_mfma_f32_16x16x32_bf16 v[148:151], a[128:131], a[20:23], v[148:151]
ds_read_b128 a[112:115], v6 offset:24576
v_mfma_f32_16x16x32_bf16 v[152:155], a[132:135], a[20:23], v[152:155]
buffer_load_dwordx4 a[8:11], v4, s[40:43], s35 offen offset:0 sc1
v_mfma_f32_16x16x32_bf16 v[136:139], a[132:135], a[16:19], v[136:139]
ds_read_b128 a[116:119], v6 offset:25600
v_mfma_f32_16x16x32_bf16 v[140:143], a[136:139], a[16:19], v[140:143]
ds_read_b128 a[120:123], v6 offset:26624
v_mfma_f32_16x16x32_bf16 v[156:159], a[136:139], a[20:23], v[156:159]
ds_read_b128 a[124:127], v6 offset:27648
v_mfma_f32_16x16x32_bf16 v[160:163], a[140:143], a[20:23], v[160:163]
buffer_load_dwordx4 a[12:15], v4, s[40:43], s35 offen offset:1024 sc1
v_mfma_f32_16x16x32_bf16 v[144:147], a[140:143], a[16:19], v[144:147]
s_waitcnt vmcnt(8) lgkmcnt(4)
v_mfma_f32_16x16x32_bf16 v[132:135], a[96:99], a[24:27], v[132:135]
s_cmp_eq_u32 s3, 2
s_cselect_b32 s35, 2, 26
s_lshl_b32 s35, s35, 12
v_mfma_f32_16x16x32_bf16 v[148:151], a[96:99], a[28:31], v[148:151]
ds_read_b128 a[128:131], v6 offset:28672
v_mfma_f32_16x16x32_bf16 v[152:155], a[100:103], a[28:31], v[152:155]
buffer_load_dwordx4 a[16:19], v4, s[40:43], s35 offen offset:0 sc1
v_mfma_f32_16x16x32_bf16 v[136:139], a[100:103], a[24:27], v[136:139]
ds_read_b128 a[132:135], v6 offset:29696
v_mfma_f32_16x16x32_bf16 v[140:143], a[104:107], a[24:27], v[140:143]
ds_read_b128 a[136:139], v6 offset:30720
v_mfma_f32_16x16x32_bf16 v[156:159], a[104:107], a[28:31], v[156:159]
ds_read_b128 a[140:143], v6 offset:31744
v_mfma_f32_16x16x32_bf16 v[160:163], a[108:111], a[28:31], v[160:163]
buffer_load_dwordx4 a[20:23], v4, s[40:43], s35 offen offset:1024 sc1
v_mfma_f32_16x16x32_bf16 v[144:147], a[108:111], a[24:27], v[144:147]
s_waitcnt vmcnt(8) lgkmcnt(4)
v_mfma_f32_16x16x32_bf16 v[132:135], a[112:115], a[32:35], v[132:135]
s_cmp_eq_u32 s3, 3
s_cselect_b32 s35, 3, 27
s_lshl_b32 s35, s35, 12
v_mfma_f32_16x16x32_bf16 v[148:151], a[112:115], a[36:39], v[148:151]
ds_read_b128 a[96:99], v6 offset:32768
v_mfma_f32_16x16x32_bf16 v[152:155], a[116:119], a[36:39], v[152:155]
buffer_load_dwordx4 a[24:27], v4, s[40:43], s35 offen offset:0 sc1
v_mfma_f32_16x16x32_bf16 v[136:139], a[116:119], a[32:35], v[136:139]
ds_read_b128 a[100:103], v6 offset:33792
v_mfma_f32_16x16x32_bf16 v[140:143], a[120:123], a[32:35], v[140:143]
ds_read_b128 a[104:107], v6 offset:34816
v_mfma_f32_16x16x32_bf16 v[156:159], a[120:123], a[36:39], v[156:159]
ds_read_b128 a[108:111], v6 offset:35840
v_mfma_f32_16x16x32_bf16 v[160:163], a[124:127], a[36:39], v[160:163]
buffer_load_dwordx4 a[28:31], v4, s[40:43], s35 offen offset:1024 sc1
v_mfma_f32_16x16x32_bf16 v[144:147], a[124:127], a[32:35], v[144:147]
s_waitcnt vmcnt(8) lgkmcnt(4)
v_mfma_f32_16x16x32_bf16 v[132:135], a[128:131], a[40:43], v[132:135]
s_cmp_eq_u32 s3, 4
s_cselect_b32 s35, 4, 28
s_lshl_b32 s35, s35, 12
v_mfma_f32_16x16x32_bf16 v[148:151], a[128:131], a[44:47], v[148:151]
ds_read_b128 a[112:115], v6 offset:36864
v_mfma_f32_16x16x32_bf16 v[152:155], a[132:135], a[44:47], v[152:155]
buffer_load_dwordx4 a[32:35], v4, s[40:43], s35 offen offset:0 sc1
v_mfma_f32_16x16x32_bf16 v[136:139], a[132:135], a[40:43], v[136:139]
ds_read_b128 a[116:119], v6 offset:37888
v_mfma_f32_16x16x32_bf16 v[140:143], a[136:139], a[40:43], v[140:143]
ds_read_b128 a[120:123], v6 offset:38912
v_mfma_f32_16x16x32_bf16 v[156:159], a[136:139], a[44:47], v[156:159]
ds_read_b128 a[124:127], v6 offset:39936
v_mfma_f32_16x16x32_bf16 v[160:163], a[140:143], a[44:47], v[160:163]
buffer_load_dwordx4 a[36:39], v4, s[40:43], s35 offen offset:1024 sc1
v_mfma_f32_16x16x32_bf16 v[144:147], a[140:143], a[40:43], v[144:147]
s_waitcnt vmcnt(8) lgkmcnt(4)
v_mfma_f32_16x16x32_bf16 v[132:135], a[96:99], a[0:3], v[132:135]
s_cmp_eq_u32 s3, 5
s_cselect_b32 s35, 5, 29
s_lshl_b32 s35, s35, 12
v_mfma_f32_16x16x32_bf16 v[148:151], a[96:99], a[4:7], v[148:151]
ds_read_b128 a[128:131], v6 offset:40960
v_mfma_f32_16x16x32_bf16 v[152:155], a[100:103], a[4:7], v[152:155]
buffer_load_dwordx4 a[40:43], v4, s[40:43], s35 offen offset:0 sc1
v_mfma_f32_16x16x32_bf16 v[136:139], a[100:103], a[0:3], v[136:139]
ds_read_b128 a[132:135], v6 offset:41984
v_mfma_f32_16x16x32_bf16 v[140:143], a[104:107], a[0:3], v[140:143]
ds_read_b128 a[136:139], v6 offset:43008
v_mfma_f32_16x16x32_bf16 v[156:159], a[104:107], a[4:7], v[156:159]
ds_read_b128 a[140:143], v6 offset:44032
v_mfma_f32_16x16x32_bf16 v[160:163], a[108:111], a[4:7], v[160:163]
buffer_load_dwordx4 a[44:47], v4, s[40:43], s35 offen offset:1024 sc1
v_mfma_f32_16x16x32_bf16 v[144:147], a[108:111], a[0:3], v[144:147]
s_waitcnt vmcnt(8) lgkmcnt(4)
v_mfma_f32_16x16x32_bf16 v[132:135], a[112:115], a[8:11], v[132:135]
s_cmp_eq_u32 s3, 6
s_cselect_b32 s35, 6, 30
s_lshl_b32 s35, s35, 12
v_mfma_f32_16x16x32_bf16 v[148:151], a[112:115], a[12:15], v[148:151]
ds_read_b128 a[96:99], v6 offset:45056
v_mfma_f32_16x16x32_bf16 v[152:155], a[116:119], a[12:15], v[152:155]
buffer_load_dwordx4 a[0:3], v4, s[40:43], s35 offen offset:0 sc1
v_mfma_f32_16x16x32_bf16 v[136:139], a[116:119], a[8:11], v[136:139]
ds_read_b128 a[100:103], v6 offset:46080
v_mfma_f32_16x16x32_bf16 v[140:143], a[120:123], a[8:11], v[140:143]
ds_read_b128 a[104:107], v6 offset:47104
v_mfma_f32_16x16x32_bf16 v[156:159], a[120:123], a[12:15], v[156:159]
ds_read_b128 a[108:111], v6 offset:48128
v_mfma_f32_16x16x32_bf16 v[160:163], a[124:127], a[12:15], v[160:163]
buffer_load_dwordx4 a[4:7], v4, s[40:43], s35 offen offset:1024 sc1
v_mfma_f32_16x16x32_bf16 v[144:147], a[124:127], a[8:11], v[144:147]
s_waitcnt vmcnt(8) lgkmcnt(4)
v_mfma_f32_16x16x32_bf16 v[132:135], a[128:131], a[16:19], v[132:135]
s_cmp_eq_u32 s3, 7
s_cselect_b32 s35, 7, 31
s_lshl_b32 s35, s35, 12
v_mfma_f32_16x16x32_bf16 v[148:151], a[128:131], a[20:23], v[148:151]
ds_read_b128 a[112:115], v6 offset:49152
v_mfma_f32_16x16x32_bf16 v[152:155], a[132:135], a[20:23], v[152:155]
buffer_load_dwordx4 a[8:11], v4, s[40:43], s35 offen offset:0 sc1
v_mfma_f32_16x16x32_bf16 v[136:139], a[132:135], a[16:19], v[136:139]
ds_read_b128 a[116:119], v6 offset:50176
v_mfma_f32_16x16x32_bf16 v[140:143], a[136:139], a[16:19], v[140:143]
ds_read_b128 a[120:123], v6 offset:51200
v_mfma_f32_16x16x32_bf16 v[156:159], a[136:139], a[20:23], v[156:159]
ds_read_b128 a[124:127], v6 offset:52224
v_mfma_f32_16x16x32_bf16 v[160:163], a[140:143], a[20:23], v[160:163]
buffer_load_dwordx4 a[12:15], v4, s[40:43], s35 offen offset:1024 sc1
v_mfma_f32_16x16x32_bf16 v[144:147], a[140:143], a[16:19], v[144:147]
s_waitcnt vmcnt(8) lgkmcnt(4)
v_mfma_f32_16x16x32_bf16 v[132:135], a[96:99], a[24:27], v[132:135]
ds_read_b128 a[128:131], v6 offset:53248
v_mfma_f32_16x16x32_bf16 v[148:151], a[96:99], a[28:31], v[148:151]
ds_read_b128 a[132:135], v6 offset:54272
v_mfma_f32_16x16x32_bf16 v[152:155], a[100:103], a[28:31], v[152:155]
ds_read_b128 a[136:139], v6 offset:55296
v_mfma_f32_16x16x32_bf16 v[136:139], a[100:103], a[24:27], v[136:139]
ds_read_b128 a[140:143], v6 offset:56320
v_mfma_f32_16x16x32_bf16 v[140:143], a[104:107], a[24:27], v[140:143]
v_mfma_f32_16x16x32_bf16 v[156:159], a[104:107], a[28:31], v[156:159]
buffer_atomic_add v12, v10, s[4:7], s92 offen sc1
v_mfma_f32_16x16x32_bf16 v[160:163], a[108:111], a[28:31], v[160:163]
v_mfma_f32_16x16x32_bf16 v[144:147], a[108:111], a[24:27], v[144:147]
s_waitcnt vmcnt(7) lgkmcnt(4)
v_mfma_f32_16x16x32_bf16 v[132:135], a[112:115], a[32:35], v[132:135]
ds_read_b128 a[96:99], v6 offset:57344
v_mfma_f32_16x16x32_bf16 v[148:151], a[112:115], a[36:39], v[148:151]
ds_read_b128 a[100:103], v6 offset:58368
v_mfma_f32_16x16x32_bf16 v[152:155], a[116:119], a[36:39], v[152:155]
ds_read_b128 a[104:107], v6 offset:59392
v_mfma_f32_16x16x32_bf16 v[136:139], a[116:119], a[32:35], v[136:139]
ds_read_b128 a[108:111], v6 offset:60416
v_mfma_f32_16x16x32_bf16 v[140:143], a[120:123], a[32:35], v[140:143]
v_mfma_f32_16x16x32_bf16 v[156:159], a[120:123], a[36:39], v[156:159]
v_mfma_f32_16x16x32_bf16 v[160:163], a[124:127], a[36:39], v[160:163]
v_mfma_f32_16x16x32_bf16 v[144:147], a[124:127], a[32:35], v[144:147]
s_waitcnt vmcnt(5) lgkmcnt(4)
v_mfma_f32_16x16x32_bf16 v[132:135], a[128:131], a[40:43], v[132:135]
ds_read_b128 a[112:115], v6 offset:61440
v_mfma_f32_16x16x32_bf16 v[148:151], a[128:131], a[44:47], v[148:151]
ds_read_b128 a[116:119], v6 offset:62464
v_mfma_f32_16x16x32_bf16 v[152:155], a[132:135], a[44:47], v[152:155]
ds_read_b128 a[120:123], v6 offset:63488
v_mfma_f32_16x16x32_bf16 v[136:139], a[132:135], a[40:43], v[136:139]
ds_read_b128 a[124:127], v6 offset:64512
v_mfma_f32_16x16x32_bf16 v[140:143], a[136:139], a[40:43], v[140:143]
v_mfma_f32_16x16x32_bf16 v[156:159], a[136:139], a[44:47], v[156:159]
v_mfma_f32_16x16x32_bf16 v[160:163], a[140:143], a[44:47], v[160:163]
v_mfma_f32_16x16x32_bf16 v[144:147], a[140:143], a[40:43], v[144:147]
s_waitcnt vmcnt(3) lgkmcnt(4)
v_mfma_f32_16x16x32_bf16 v[132:135], a[96:99], a[0:3], v[132:135]
v_mfma_f32_16x16x32_bf16 v[148:151], a[96:99], a[4:7], v[148:151]
v_mfma_f32_16x16x32_bf16 v[152:155], a[100:103], a[4:7], v[152:155]
v_mfma_f32_16x16x32_bf16 v[136:139], a[100:103], a[0:3], v[136:139]
v_mfma_f32_16x16x32_bf16 v[140:143], a[104:107], a[0:3], v[140:143]
v_mfma_f32_16x16x32_bf16 v[156:159], a[104:107], a[4:7], v[156:159]
v_mfma_f32_16x16x32_bf16 v[160:163], a[108:111], a[4:7], v[160:163]
v_mfma_f32_16x16x32_bf16 v[144:147], a[108:111], a[0:3], v[144:147]
s_waitcnt vmcnt(1) lgkmcnt(0)
v_mfma_f32_16x16x32_bf16 v[132:135], a[112:115], a[8:11], v[132:135]
v_mfma_f32_16x16x32_bf16 v[148:151], a[112:115], a[12:15], v[148:151]
v_mfma_f32_16x16x32_bf16 v[152:155], a[116:119], a[12:15], v[152:155]
v_mfma_f32_16x16x32_bf16 v[136:139], a[116:119], a[8:11], v[136:139]
v_mfma_f32_16x16x32_bf16 v[140:143], a[120:123], a[8:11], v[140:143]
v_mfma_f32_16x16x32_bf16 v[156:159], a[120:123], a[12:15], v[156:159]
v_mfma_f32_16x16x32_bf16 v[160:163], a[124:127], a[12:15], v[160:163]
v_mfma_f32_16x16x32_bf16 v[144:147], a[124:127], a[8:11], v[144:147]
s_nop 1
v_cmp_u_f32 vcc, v132, v148
s_nop 0
s_and_b32 vcc_lo, vcc_lo, s95
s_cbranch_scc1 L_k2redo2
s_lshl_b32 s36, s32, 13
v_cvt_pk_bf16_f32 v32, v132, v133
v_cvt_pk_bf16_f32 v33, v134, v135
v_cvt_pk_bf16_f32 v34, v136, v137
v_cvt_pk_bf16_f32 v35, v138, v139
s_add_u32 s36, s36, 0x2200000
buffer_store_dwordx4 v[32:35], v4, s[4:7], s36 offen offset:0 sc1
v_cvt_pk_bf16_f32 v40, v148, v149
v_cvt_pk_bf16_f32 v41, v150, v151
v_cvt_pk_bf16_f32 v42, v152, v153
v_cvt_pk_bf16_f32 v43, v154, v155
v_cvt_pk_bf16_f32 v36, v140, v141
v_cvt_pk_bf16_f32 v37, v142, v143
v_cvt_pk_bf16_f32 v38, v144, v145
v_cvt_pk_bf16_f32 v39, v146, v147
s_add_u32 s37, s36, 4096
v_cvt_pk_bf16_f32 v44, v156, v157
v_cvt_pk_bf16_f32 v45, v158, v159
v_cvt_pk_bf16_f32 v46, v160, v161
buffer_store_dwordx4 v[40:43], v4, s[4:7], s36 offen offset:1024 sc1
v_cvt_pk_bf16_f32 v47, v162, v163
v_mfma_f32_16x16x32_bf16 v[96:99], v[32:35], v[32:35], 0
s_mov_b32 s38, 0x2c0000
s_add_u32 s92, s78, 0x60000
v_mfma_f32_16x16x32_bf16 v[92:95], v[16:19], v[32:35], 0
s_add_u32 s93, s79, 0x60000
s_add_u32 s40, s4, 0x2200000
v_mfma_f32_16x16x32_bf16 v[96:99], v[36:39], v[36:39], v[96:99]
s_addc_u32 s41, s5, 0
buffer_store_dwordx4 v[36:39], v4, s[4:7], s37 offen offset:0 sc1
v_mfma_f32_16x16x32_bf16 v[92:95], v[16:19], v[36:39], v[92:95]
s_nop 4
v_cndmask_b32 v96, v96, v97, s[46:47]
v_cndmask_b32 v98, v98, v99, s[46:47]
v_mfma_f32_16x16x32_bf16 v[104:107], v[40:43], v[40:43], 0
v_mfma_f32_16x16x32_bf16 v[100:103], v[16:19], v[40:43], 0
v_cndmask_b32 v93, v96, v98, s[48:49]
buffer_store_dwordx4 v[44:47], v4, s[4:7], s37 offen offset:1024 sc1
v_mfma_f32_16x16x32_bf16 v[104:107], v[44:47], v[44:47], v[104:107]
v_mfma_f32_16x16x32_bf16 v[100:103], v[16:19], v[44:47], v[100:103]
s_nop 6
v_cndmask_b32 v104, v104, v105, s[46:47]
v_cndmask_b32 v106, v106, v107, s[46:47]
buffer_store_dwordx2 v[92:93], v253, s[4:7], s38 offen offset:0 sc1
v_cndmask_b32 v101, v104, v106, s[48:49]
buffer_store_dwordx2 v[100:101], v253, s[4:7], s38 offen offset:2048 sc1
s_barrier
s_add_u32 m0, s18, 0x0
s_add_u32 s44, s50, 0x1400000
buffer_load_dwordx4 v1, s[4:7], s44 offen offset:0 sc1 lds
buffer_load_dwordx4 v1, s[4:7], s44 offen offset:1024 sc1 lds
buffer_load_dwordx4 v1, s[4:7], s44 offen offset:2048 sc1 lds
s_add_u32 m0, s18, 0x3000
s_add_u32 s44, s50, 0x1403000
buffer_load_dwordx4 v1, s[4:7], s44 offen offset:0 sc1 lds
buffer_load_dwordx4 v1, s[4:7], s44 offen offset:1024 sc1 lds
buffer_load_dwordx4 v1, s[4:7], s44 offen offset:2048 sc1 lds
s_waitcnt vmcnt(6)
s_barrier
s_cmp_lg_u32 s28, 1
s_cbranch_scc1 Lsg_29
buffer_atomic_add v12, v10, s[4:7], s92 offen sc1
Lsg_29:
s_cmp_lg_u32 s28, 1
s_cbranch_scc1 L_wskip6
s_mov_b64 exec, 0
s_branch L_stub15
L_wret6:
s_mov_b64 exec, -1
L_wskip6:
s_cmp_lt_u32 s28, 2
s_cbranch_scc1 Lwd_30
s_add_u32 m0, s18, 0x4800
s_add_u32 s44, s50, 0x1404800
buffer_load_dwordx4 v1, s[4:7], s44 offen offset:0 sc1 lds
buffer_load_dwordx4 v1, s[4:7], s44 offen offset:1024 sc1 lds
buffer_load_dwordx4 v1, s[4:7], s44 offen offset:2048 sc1 lds
s_add_u32 m0, s18, 0x6000
s_add_u32 s44, s50, 0x1406000
buffer_load_dwordx4 v1, s[4:7], s44 offen offset:0 sc1 lds
buffer_load_dwordx4 v1, s[4:7], s44 offen offset:1024 sc1 lds
buffer_load_dwordx4 v1, s[4:7], s44 offen offset:2048 sc1 lds
s_add_u32 m0, s18, 0x7800
s_add_u32 s44, s50, 0x1407800
buffer_load_dwordx4 v1, s[4:7], s44 offen offset:0 sc1 lds
buffer_load_dwordx4 v1, s[4:7], s44 offen offset:1024 sc1 lds
buffer_load_dwordx4 v1, s[4:7], s44 offen offset:2048 sc1 lds
s_add_u32 m0, s18, 0x9000
s_add_u32 s44, s50, 0x1409000
buffer_load_dwordx4 v1, s[4:7], s44 offen offset:0 sc1 lds
buffer_load_dwordx4 v1, s[4:7], s44 offen offset:1024 sc1 lds
buffer_load_dwordx4 v1, s[4:7], s44 offen offset:2048 sc1 lds
s_add_u32 m0, s18, 0xa800
s_add_u32 s44, s50, 0x140a800
buffer_load_dwordx4 v1, s[4:7], s44 offen offset:0 sc1 lds
buffer_load_dwordx4 v1, s[4:7], s44 offen offset:1024 sc1 lds
buffer_load_dwordx4 v1, s[4:7], s44 offen offset:2048 sc1 lds
s_add_u32 m0, s18, 0xc000
s_add_u32 s44, s50, 0x140c000
buffer_load_dwordx4 v1, s[4:7], s44 offen offset:0 sc1 lds
buffer_load_dwordx4 v1, s[4:7], s44 offen offset:1024 sc1 lds
buffer_load_dwordx4 v1, s[4:7], s44 offen offset:2048 sc1 lds
s_add_u32 m0, s18, 0xd800
s_add_u32 s44, s50, 0x140d800
buffer_load_dwordx4 v1, s[4:7], s44 offen offset:0 sc1 lds
buffer_load_dwordx4 v1, s[4:7], s44 offen offset:1024 sc1 lds
buffer_load_dwordx4 v1, s[4:7], s44 offen offset:2048 sc1 lds
s_add_u32 m0, s18, 0xf000
s_add_u32 s44, s50, 0x140f000
buffer_load_dwordx4 v1, s[4:7], s44 offen offset:0 sc1 lds
buffer_load_dwordx4 v1, s[4:7], s44 offen offset:1024 sc1 lds
buffer_load_dwordx4 v1, s[4:7], s44 offen offset:2048 sc1 lds
s_add_u32 m0, s18, 0x10800
s_add_u32 s44, s50, 0x1410800
buffer_load_dwordx4 v1, s[4:7], s44 offen offset:0 sc1 lds
buffer_load_dwordx4 v1, s[4:7], s44 offen offset:1024 sc1 lds
buffer_load_dwordx4 v1, s[4:7], s44 offen offset:2048 sc1 lds
s_add_u32 m0, s18, 0x12000
s_add_u32 s44, s50, 0x1412000
buffer_load_dwordx4 v1, s[4:7], s44 offen offset:0 sc1 lds
buffer_load_dwordx4 v1, s[4:7], s44 offen offset:1024 sc1 lds
buffer_load_dwordx4 v1, s[4:7], s44 offen offset:2048 sc1 lds
s_add_u32 m0, s18, 0x13800
s_add_u32 s44, s50, 0x1413800
buffer_load_dwordx4 v1, s[4:7], s44 offen offset:0 sc1 lds
buffer_load_dwordx4 v1, s[4:7], s44 offen offset:1024 sc1 lds
buffer_load_dwordx4 v1, s[4:7], s44 offen offset:2048 sc1 lds
s_add_u32 m0, s18, 0x15000
s_add_u32 s44, s50, 0x1415000
buffer_load_dwordx4 v1, s[4:7], s44 offen offset:0 sc1 lds
buffer_load_dwordx4 v1, s[4:7], s44 offen offset:1024 sc1 lds
buffer_load_dwordx4 v1, s[4:7], s44 offen offset:2048 sc1 lds
s_add_u32 m0, s18, 0x16800
s_add_u32 s44, s50, 0x1416800
buffer_load_dwordx4 v1, s[4:7], s44 offen offset:0 sc1 lds
buffer_load_dwordx4 v1, s[4:7], s44 offen offset:1024 sc1 lds
buffer_load_dwordx4 v1, s[4:7], s44 offen offset:2048 sc1 lds
s_add_u32 m0, s18, 0x18000
s_add_u32 s44, s50, 0x1418000
buffer_load_dwordx4 v1, s[4:7], s44 offen offset:0 sc1 lds
buffer_load_dwordx4 v1, s[4:7], s44 offen offset:1024 sc1 lds
buffer_load_dwordx4 v1, s[4:7], s44 offen offset:2048 sc1 lds
s_add_u32 m0, s18, 0x19800
s_add_u32 s44, s50, 0x1419800
buffer_load_dwordx4 v1, s[4:7], s44 offen offset:0 sc1 lds
buffer_load_dwordx4 v1, s[4:7], s44 offen offset:1024 sc1 lds
buffer_load_dwordx4 v1, s[4:7], s44 offen offset:2048 sc1 lds
s_add_u32 m0, s18, 0x1b000
s_add_u32 s44, s50, 0x141b000
buffer_load_dwordx4 v1, s[4:7], s44 offen offset:0 sc1 lds
buffer_load_dwordx4 v1, s[4:7], s44 offen offset:1024 sc1 lds
buffer_load_dwordx4 v1, s[4:7], s44 offen offset:2048 sc1 lds
Lwd_30:
s_cmp_lg_u32 s28, 0
s_cbranch_scc1 Lpe_32
s_add_u32 s36, s67, 0x60000
s_mov_b32 s37, 0
Lpoll_31:
v_mov_b32 v11, 0
buffer_atomic_add v11, v251, s[4:7], s36 offen sc0 sc1
s_add_u32 s37, s37, 1
s_waitcnt vmcnt(0)
v_readfirstlane_b32 s38, v11
s_nop 0
s_cmp_ge_u32 s38, 32
s_cbranch_scc1 Lpe_32
s_cmp_lt_u32 s37, 0x100000
s_cbranch_scc1 Lpoll_31
Lpe_32:
s_waitcnt vmcnt(36)
s_cmp_ge_u32 s28, 2
s_cbranch_scc1 Lw_33
s_waitcnt vmcnt(0)
Lw_33:
s_barrier
s_add_u32 s94, s80, 0x90080
s_lshl_b32 s35, s33, 12
buffer_load_dwordx4 a[0:3], v2, s[40:43], s35 offen offset:0 sc1
buffer_load_dwordx4 a[4:7], v2, s[40:43], s35 offen offset:1024 sc1
buffer_load_dwordx4 a[8:11], v2, s[40:43], s35 offen offset:2048 sc1
buffer_load_dwordx4 a[12:15], v2, s[40:43], s35 offen offset:3072 sc1
s_add_u32 s35, s35, 4096
buffer_load_dwordx4 a[16:19], v2, s[40:43], s35 offen offset:0 sc1
buffer_load_dwordx4 a[20:23], v2, s[40:43], s35 offen offset:1024 sc1
buffer_load_dwordx4 a[24:27], v2, s[40:43], s35 offen offset:2048 sc1
buffer_load_dwordx4 a[28:31], v2, s[40:43], s35 offen offset:3072 sc1
s_add_u32 s35, s35, 4096
buffer_load_dwordx4 a[32:35], v2, s[40:43], s35 offen offset:0 sc1
buffer_load_dwordx4 a[36:39], v2, s[40:43], s35 offen offset:1024 sc1
buffer_load_dwordx4 a[40:43], v2, s[40:43], s35 offen offset:2048 sc1
buffer_load_dwordx4 a[44:47], v2, s[40:43], s35 offen offset:3072 sc1
s_add_u32 s35, s35, 4096
v_add_u32 v5, 0, v1
ds_read_b128 a[96:99], v5 offset:0
ds_read_b128 a[100:103], v5 offset:1024
ds_read_b128 a[104:107], v5 offset:2048
ds_read_b128 a[108:111], v5 offset:3072
ds_read_b128 a[112:115], v5 offset:4096
ds_read_b128 a[116:119], v5 offset:5120
s_waitcnt vmcnt(8) lgkmcnt(0)
v_mfma_f32_16x16x32_bf16 v[132:135], a[96:99], a[0:3], 0
s_add_u32 m0, s18, 0x1e000
s_add_u32 s44, s50, 0x141e000
v_mfma_f32_16x16x32_bf16 v[156:159], a[96:99], a[4:7], 0
buffer_load_dwordx4 a[48:51], v2, s[40:43], s35 offen offset:0 sc1
v_mfma_f32_16x16x32_bf16 v[180:183], a[96:99], a[8:11], 0
ds_read_b128 a[128:131], v5 offset:6144
v_mfma_f32_16x16x32_bf16 v[204:207], a[96:99], a[12:15], 0
ds_read_b128 a[132:135], v5 offset:7168
v_mfma_f32_16x16x32_bf16 v[208:211], a[100:103], a[12:15], 0
v_mfma_f32_16x16x32_bf16 v[184:187], a[100:103], a[8:11], 0
buffer_load_dwordx4 a[52:55], v2, s[40:43], s35 offen offset:1024 sc1
v_mfma_f32_16x16x32_bf16 v[160:163], a[100:103], a[4:7], 0
ds_read_b128 a[136:139], v5 offset:8192
v_mfma_f32_16x16x32_bf16 v[136:139], a[100:103], a[0:3], 0
v_mfma_f32_16x16x32_bf16 v[140:143], a[104:107], a[0:3], 0
ds_read_b128 a[140:143], v5 offset:9216
v_mfma_f32_16x16x32_bf16 v[164:167], a[104:107], a[4:7], 0
v_mfma_f32_16x16x32_bf16 v[188:191], a[104:107], a[8:11], 0
buffer_load_dwordx4 v1, s[4:7], s44 offen offset:0 sc1 lds
v_mfma_f32_16x16x32_bf16 v[212:215], a[104:107], a[12:15], 0
ds_read_b128 a[144:147], v5 offset:10240
v_mfma_f32_16x16x32_bf16 v[216:219], a[108:111], a[12:15], 0
v_mfma_f32_16x16x32_bf16 v[192:195], a[108:111], a[8:11], 0
ds_read_b128 a[148:151], v5 offset:11264
v_mfma_f32_16x16x32_bf16 v[168:171], a[108:111], a[4:7], 0
v_mfma_f32_16x16x32_bf16 v[144:147], a[108:111], a[0:3], 0
buffer_load_dwordx4 a[56:59], v2, s[40:43], s35 offen offset:2048 sc1
v_mfma_f32_16x16x32_bf16 v[148:151], a[112:115], a[0:3], 0
v_mfma_f32_16x16x32_bf16 v[172:175], a[112:115], a[4:7], 0
v_mfma_f32_16x16x32_bf16 v[196:199], a[112:115], a[8:11], 0
v_mfma_f32_16x16x32_bf16 v[220:223], a[112:115], a[12:15], 0
v_mfma_f32_16x16x32_bf16 v[224:227], a[116:119], a[12:15], 0
buffer_load_dwordx4 a[60:63], v2, s[40:43], s35 offen offset:3072 sc1
s_add_u32 s35, s35, 4096
v_mfma_f32_16x16x32_bf16 v[200:203], a[116:119], a[8:11], 0
v_mfma_f32_16x16x32_bf16 v[176:179], a[116:119], a[4:7], 0
v_mfma_f32_16x16x32_bf16 v[152:155], a[116:119], a[0:3], 0
s_waitcnt vmcnt(9) lgkmcnt(0)
v_mfma_f32_16x16x32_bf16 v[132:135], a[128:131], a[16:19], v[132:135]
ds_read_b128 a[96:99], v5 offset:12288
v_mfma_f32_16x16x32_bf16 v[156:159], a[128:131], a[20:23], v[156:159]
buffer_load_dwordx4 a[0:3], v2, s[40:43], s35 offen offset:0 sc1
v_mfma_f32_16x16x32_bf16 v[180:183], a[128:131], a[24:27], v[180:183]
ds_read_b128 a[100:103], v5 offset:13312
v_mfma_f32_16x16x32_bf16 v[204:207], a[128:131], a[28:31], v[204:207]
v_mfma_f32_16x16x32_bf16 v[208:211], a[132:135], a[28:31], v[208:211]
v_mfma_f32_16x16x32_bf16 v[184:187], a[132:135], a[24:27], v[184:187]
buffer_load_dwordx4 a[4:7], v2, s[40:43], s35 offen offset:1024 sc1
v_mfma_f32_16x16x32_bf16 v[160:163], a[132:135], a[20:23], v[160:163]
ds_read_b128 a[104:107], v5 offset:14336
v_mfma_f32_16x16x32_bf16 v[136:139], a[132:135], a[16:19], v[136:139]
v_mfma_f32_16x16x32_bf16 v[140:143], a[136:139], a[16:19], v[140:143]
ds_read_b128 a[108:111], v5 offset:15360
v_mfma_f32_16x16x32_bf16 v[164:167], a[136:139], a[20:23], v[164:167]
v_mfma_f32_16x16x32_bf16 v[188:191], a[136:139], a[24:27], v[188:191]
buffer_load_dwordx4 v1, s[4:7], s44 offen offset:1024 sc1 lds
v_mfma_f32_16x16x32_bf16 v[212:215], a[136:139], a[28:31], v[212:215]
ds_read_b128 a[112:115], v5 offset:16384
v_mfma_f32_16x16x32_bf16 v[216:219], a[140:143], a[28:31], v[216:219]
v_mfma_f32_16x16x32_bf16 v[192:195], a[140:143], a[24:27], v[192:195]
ds_read_b128 a[116:119], v5 offset:17408
v_mfma_f32_16x16x32_bf16 v[168:171], a[140:143], a[20:23], v[168:171]
v_mfma_f32_16x16x32_bf16 v[144:147], a[140:143], a[16:19], v[144:147]
buffer_load_dwordx4 a[8:11], v2, s[40:43], s35 offen offset:2048 sc1
v_mfma_f32_16x16x32_bf16 v[148:151], a[144:147], a[16:19], v[148:151]
v_mfma_f32_16x16x32_bf16 v[172:175], a[144:147], a[20:23], v[172:175]
v_mfma_f32_16x16x32_bf16 v[196:199], a[144:147], a[24:27], v[196:199]
v_mfma_f32_16x16x32_bf16 v[220:223], a[144:147], a[28:31], v[220:223]
v_mfma_f32_16x16x32_bf16 v[224:227], a[148:151], a[28:31], v[224:227]
buffer_load_dwordx4 a[12:15], v2, s[40:43], s35 offen offset:3072 sc1
s_add_u32 s35, s35, 4096
v_mfma_f32_16x16x32_bf16 v[200:203], a[148:151], a[24:27], v[200:203]
v_mfma_f32_16x16x32_bf16 v[176:179], a[148:151], a[20:23], v[176:179]
v_mfma_f32_16x16x32_bf16 v[152:155], a[148:151], a[16:19], v[152:155]
s_waitcnt vmcnt(10) lgkmcnt(0)
v_mfma_f32_16x16x32_bf16 v[132:135], a[96:99], a[32:35], v[132:135]
ds_read_b128 a[128:131], v5 offset:18432
v_mfma_f32_16x16x32_bf16 v[156:159], a[96:99], a[36:39], v[156:159]
buffer_load_dwordx4 a[16:19], v2, s[40:43], s35 offen offset:0 sc1
v_mfma_f32_16x16x32_bf16 v[180:183], a[96:99], a[40:43], v[180:183]
ds_read_b128 a[132:135], v5 offset:19456
v_mfma_f32_16x16x32_bf16 v[204:207], a[96:99], a[44:47], v[204:207]
v_mfma_f32_16x16x32_bf16 v[208:211], a[100:103], a[44:47], v[208:211]
v_mfma_f32_16x16x32_bf16 v[184:187], a[100:103], a[40:43], v[184:187]
buffer_load_dwordx4 a[20:23], v2, s[40:43], s35 offen offset:1024 sc1
v_mfma_f32_16x16x32_bf16 v[160:163], a[100:103], a[36:39], v[160:163]
ds_read_b128 a[136:139], v5 offset:20480
v_mfma_f32_16x16x32_bf16 v[136:139], a[100:103], a[32:35], v[136:139]
v_mfma_f32_16x16x32_bf16 v[140:143], a[104:107], a[32:35], v[140:143]
ds_read_b128 a[140:143], v5 offset:21504
v_mfma_f32_16x16x32_bf16 v[164:167], a[104:107], a[36:39], v[164:167]
v_mfma_f32_16x16x32_bf16 v[188:191], a[104:107], a[40:43], v[188:191]
buffer_load_dwordx4 v1, s[4:7], s44 offen offset:2048 sc1 lds
s_add_u32 m0, s18, 0x21000
v_mfma_f32_16x16x32_bf16 v[212:215], a[104:107], a[44:47], v[212:215]
s_add_u32 s44, s50, 0x1421000
ds_read_b128 a[144:147], v5 offset:22528
v_mfma_f32_16x16x32_bf16 v[216:219], a[108:111], a[44:47], v[216:219]
v_mfma_f32_16x16x32_bf16 v[192:195], a[108:111], a[40:43], v[192:195]
ds_read_b128 a[148:151], v5 offset:23552
v_mfma_f32_16x16x32_bf16 v[168:171], a[108:111], a[36:39], v[168:171]
v_mfma_f32_16x16x32_bf16 v[144:147], a[108:111], a[32:35], v[144:147]
buffer_load_dwordx4 a[24:27], v2, s[40:43], s35 offen offset:2048 sc1
v_mfma_f32_16x16x32_bf16 v[148:151], a[112:115], a[32:35], v[148:151]
v_mfma_f32_16x16x32_bf16 v[172:175], a[112:115], a[36:39], v[172:175]
v_mfma_f32_16x16x32_bf16 v[196:199], a[112:115], a[40:43], v[196:199]
v_mfma_f32_16x16x32_bf16 v[220:223], a[112:115], a[44:47], v[220:223]
v_mfma_f32_16x16x32_bf16 v[224:227], a[116:119], a[44:47], v[224:227]
buffer_load_dwordx4 a[28:31], v2, s[40:43], s35 offen offset:3072 sc1
s_add_u32 s35, s35, 4096
v_mfma_f32_16x16x32_bf16 v[200:203], a[116:119], a[40:43], v[200:203]
v_mfma_f32_16x16x32_bf16 v[176:179], a[116:119], a[36:39], v[176:179]
v_mfma_f32_16x16x32_bf16 v[152:155], a[116:119], a[32:35], v[152:155]
s_waitcnt vmcnt(10) lgkmcnt(0)
v_mfma_f32_16x16x32_bf16 v[132:135], a[128:131], a[48:51], v[132:135]
ds_read_b128 a[96:99], v5 offset:24576
v_mfma_f32_16x16x32_bf16 v[156:159], a[128:131], a[52:55], v[156:159]
buffer_load_dwordx4 a[32:35], v2, s[40:43], s35 offen offset:0 sc1
v_mfma_f32_16x16x32_bf16 v[180:183], a[128:131], a[56:59], v[180:183]
ds_read_b128 a[100:103], v5 offset:25600
v_mfma_f32_16x16x32_bf16 v[204:207], a[128:131], a[60:63], v[204:207]
v_mfma_f32_16x16x32_bf16 v[208:211], a[132:135], a[60:63], v[208:211]
v_mfma_f32_16x16x32_bf16 v[184:187], a[132:135], a[56:59], v[184:187]
buffer_load_dwordx4 a[36:39], v2, s[40:43], s35 offen offset:1024 sc1
v_mfma_f32_16x16x32_bf16 v[160:163], a[132:135], a[52:55], v[160:163]
ds_read_b128 a[104:107], v5 offset:26624
v_mfma_f32_16x16x32_bf16 v[136:139], a[132:135], a[48:51], v[136:139]
v_mfma_f32_16x16x32_bf16 v[140:143], a[136:139], a[48:51], v[140:143]
ds_read_b128 a[108:111], v5 offset:27648
v_mfma_f32_16x16x32_bf16 v[164:167], a[136:139], a[52:55], v[164:167]
v_mfma_f32_16x16x32_bf16 v[188:191], a[136:139], a[56:59], v[188:191]
buffer_load_dwordx4 v1, s[4:7], s44 offen offset:0 sc1 lds
L_stub15:
s_cbranch_execz L_stub16
v_mfma_f32_16x16x32_bf16 v[212:215], a[136:139], a[60:63], v[212:215]
ds_read_b128 a[112:115], v5 offset:28672
v_mfma_f32_16x16x32_bf16 v[216:219], a[140:143], a[60:63], v[216:219]
v_mfma_f32_16x16x32_bf16 v[192:195], a[140:143], a[56:59], v[192:195]
ds_read_b128 a[116:119], v5 offset:29696
v_mfma_f32_16x16x32_bf16 v[168:171], a[140:143], a[52:55], v[168:171]
v_mfma_f32_16x16x32_bf16 v[144:147], a[140:143], a[48:51], v[144:147]
buffer_load_dwordx4 a[40:43], v2, s[40:43], s35 offen offset:2048 sc1
v_mfma_f32_16x16x32_bf16 v[148:151], a[144:147], a[48:51], v[148:151]
v_mfma_f32_16x16x32_bf16 v[172:175], a[144:147], a[52:55], v[172:175]
v_mfma_f32_16x16x32_bf16 v[196:199], a[144:147], a[56:59], v[196:199]
v_mfma_f32_16x16x32_bf16 v[220:223], a[144:147], a[60:63], v[220:223]
v_mfma_f32_16x16x32_bf16 v[224:227], a[148:151], a[60:63], v[224:227]
buffer_load_dwordx4 a[44:47], v2, s[40:43], s35 offen offset:3072 sc1
s_add_u32 s35, s35, 4096
v_mfma_f32_16x16x32_bf16 v[200:203], a[148:151], a[56:59], v[200:203]
v_mfma_f32_16x16x32_bf16 v[176:179], a[148:151], a[52:55], v[176:179]
v_mfma_f32_16x16x32_bf16 v[152:155], a[148:151], a[48:51], v[152:155]
s_waitcnt vmcnt(10) lgkmcnt(0)
v_mfma_f32_16x16x32_bf16 v[132:135], a[96:99], a[0:3], v[132:135]
ds_read_b128 a[128:131], v5 offset:30720
v_accvgpr_read_b32 v48, a188
v_mfma_f32_16x16x32_bf16 v[156:159], a[96:99], a[4:7], v[156:159]
buffer_load_dwordx4 a[48:51], v2, s[40:43], s35 offen offset:0 sc1
v_mfma_f32_16x16x32_bf16 v[180:183], a[96:99], a[8:11], v[180:183]
ds_read_b128 a[132:135], v5 offset:31744
v_mfma_f32_16x16x32_bf16 v[204:207], a[96:99], a[12:15], v[204:207]
v_mfma_f32_16x16x32_bf16 v[208:211], a[100:103], a[12:15], v[208:211]
v_mfma_f32_16x16x32_bf16 v[184:187], a[100:103], a[8:11], v[184:187]
buffer_load_dwordx4 a[52:55], v2, s[40:43], s35 offen offset:1024 sc1
v_mfma_f32_16x16x32_bf16 v[160:163], a[100:103], a[4:7], v[160:163]
ds_read_b128 a[136:139], v5 offset:32768
v_mfma_f32_16x16x32_bf16 v[136:139], a[100:103], a[0:3], v[136:139]
v_accvgpr_read_b32 v49, a189
v_mfma_f32_16x16x32_bf16 v[140:143], a[104:107], a[0:3], v[140:143]
ds_read_b128 a[140:143], v5 offset:33792
v_mfma_f32_16x16x32_bf16 v[164:167], a[104:107], a[4:7], v[164:167]
v_mfma_f32_16x16x32_bf16 v[188:191], a[104:107], a[8:11], v[188:191]
buffer_load_dwordx4 v1, s[4:7], s44 offen offset:1024 sc1 lds
v_mfma_f32_16x16x32_bf16 v[212:215], a[104:107], a[12:15], v[212:215]
ds_read_b128 a[144:147], v5 offset:34816
v_mfma_f32_16x16x32_bf16 v[216:219], a[108:111], a[12:15], v[216:219]
v_mfma_f32_16x16x32_bf16 v[192:195], a[108:111], a[8:11], v[192:195]
ds_read_b128 a[148:151], v5 offset:35840
v_mfma_f32_16x16x32_bf16 v[168:171], a[108:111], a[4:7], v[168:171]
v_accvgpr_read_b32 v50, a190
v_mfma_f32_16x16x32_bf16 v[144:147], a[108:111], a[0:3], v[144:147]
buffer_load_dwordx4 a[56:59], v2, s[40:43], s35 offen offset:2048 sc1
v_mfma_f32_16x16x32_bf16 v[148:151], a[112:115], a[0:3], v[148:151]
v_mfma_f32_16x16x32_bf16 v[172:175], a[112:115], a[4:7], v[172:175]
v_mfma_f32_16x16x32_bf16 v[196:199], a[112:115], a[8:11], v[196:199]
v_mfma_f32_16x16x32_bf16 v[220:223], a[112:115], a[12:15], v[220:223]
v_mfma_f32_16x16x32_bf16 v[224:227], a[116:119], a[12:15], v[224:227]
buffer_load_dwordx4 a[60:63], v2, s[40:43], s35 offen offset:3072 sc1
s_add_u32 s35, s35, 4096
v_mfma_f32_16x16x32_bf16 v[200:203], a[116:119], a[8:11], v[200:203]
v_accvgpr_read_b32 v51, a191
v_mfma_f32_16x16x32_bf16 v[176:179], a[116:119], a[4:7], v[176:179]
v_mfma_f32_16x16x32_bf16 v[152:155], a[116:119], a[0:3], v[152:155]
s_waitcnt vmcnt(10) lgkmcnt(0)
v_mfma_f32_16x16x32_bf16 v[132:135], a[128:131], a[16:19], v[132:135]
ds_read_b128 a[96:99], v5 offset:36864
v_mfma_f32_16x16x32_bf16 v[156:159], a[128:131], a[20:23], v[156:159]
buffer_load_dwordx4 a[0:3], v2, s[40:43], s35 offen offset:0 sc1
v_mfma_f32_16x16x32_bf16 v[180:183], a[128:131], a[24:27], v[180:183]
ds_read_b128 a[100:103], v5 offset:37888
v_mfma_f32_16x16x32_bf16 v[204:207], a[128:131], a[28:31], v[204:207]
v_mfma_f32_16x16x32_bf16 v[208:211], a[132:135], a[28:31], v[208:211]
v_accvgpr_read_b32 v52, a192
v_mfma_f32_16x16x32_bf16 v[184:187], a[132:135], a[24:27], v[184:187]
buffer_load_dwordx4 a[4:7], v2, s[40:43], s35 offen offset:1024 sc1
v_mfma_f32_16x16x32_bf16 v[160:163], a[132:135], a[20:23], v[160:163]
ds_read_b128 a[104:107], v5 offset:38912
v_mfma_f32_16x16x32_bf16 v[136:139], a[132:135], a[16:19], v[136:139]
v_mfma_f32_16x16x32_bf16 v[140:143], a[136:139], a[16:19], v[140:143]
ds_read_b128 a[108:111], v5 offset:39936
v_mfma_f32_16x16x32_bf16 v[164:167], a[136:139], a[20:23], v[164:167]
v_mfma_f32_16x16x32_bf16 v[188:191], a[136:139], a[24:27], v[188:191]
buffer_load_dwordx4 v1, s[4:7], s44 offen offset:2048 sc1 lds
s_add_u32 s88, s82, 0x2c0000
v_mfma_f32_16x16x32_bf16 v[212:215], a[136:139], a[28:31], v[212:215]
ds_read_b128 a[112:115], v5 offset:40960
v_accvgpr_read_b32 v53, a193
v_mfma_f32_16x16x32_bf16 v[216:219], a[140:143], a[28:31], v[216:219]
v_mfma_f32_16x16x32_bf16 v[192:195], a[140:143], a[24:27], v[192:195]
ds_read_b128 a[116:119], v5 offset:41984
v_mfma_f32_16x16x32_bf16 v[168:171], a[140:143], a[20:23], v[168:171]
v_mfma_f32_16x16x32_bf16 v[144:147], a[140:143], a[16:19], v[144:147]
buffer_load_dwordx4 a[8:11], v2, s[40:43], s35 offen offset:2048 sc1
v_mfma_f32_16x16x32_bf16 v[148:151], a[144:147], a[16:19], v[148:151]
v_mfma_f32_16x16x32_bf16 v[172:175], a[144:147], a[20:23], v[172:175]
v_mfma_f32_16x16x32_bf16 v[196:199], a[144:147], a[24:27], v[196:199]
v_accvgpr_read_b32 v54, a194
v_mfma_f32_16x16x32_bf16 v[220:223], a[144:147], a[28:31], v[220:223]
v_mfma_f32_16x16x32_bf16 v[224:227], a[148:151], a[28:31], v[224:227]
buffer_load_dwordx4 a[12:15], v2, s[40:43], s35 offen offset:3072 sc1
s_add_u32 s35, s35, 4096
v_mfma_f32_16x16x32_bf16 v[200:203], a[148:151], a[24:27], v[200:203]
v_mfma_f32_16x16x32_bf16 v[176:179], a[148:151], a[20:23], v[176:179]
v_mfma_f32_16x16x32_bf16 v[152:155], a[148:151], a[16:19], v[152:155]
s_waitcnt vmcnt(10) lgkmcnt(0)
v_mfma_f32_16x16x32_bf16 v[132:135], a[96:99], a[32:35], v[132:135]
ds_read_b128 a[128:131], v5 offset:43008
v_mfma_f32_16x16x32_bf16 v[156:159], a[96:99], a[36:39], v[156:159]
buffer_load_dwordx4 a[16:19], v2, s[40:43], s35 offen offset:0 sc1
v_mfma_f32_16x16x32_bf16 v[180:183], a[96:99], a[40:43], v[180:183]
ds_read_b128 a[132:135], v5 offset:44032
v_accvgpr_read_b32 v55, a195
v_mfma_f32_16x16x32_bf16 v[204:207], a[96:99], a[44:47], v[204:207]
v_mfma_f32_16x16x32_bf16 v[208:211], a[100:103], a[44:47], v[208:211]
v_mfma_f32_16x16x32_bf16 v[184:187], a[100:103], a[40:43], v[184:187]
buffer_load_dwordx4 a[20:23], v2, s[40:43], s35 offen offset:1024 sc1
v_mfma_f32_16x16x32_bf16 v[160:163], a[100:103], a[36:39], v[160:163]
ds_read_b128 a[136:139], v5 offset:45056
v_mfma_f32_16x16x32_bf16 v[136:139], a[100:103], a[32:35], v[136:139]
v_mfma_f32_16x16x32_bf16 v[140:143], a[104:107], a[32:35], v[140:143]
ds_read_b128 a[140:143], v5 offset:46080
v_accvgpr_read_b32 v56, a196
v_mfma_f32_16x16x32_bf16 v[164:167], a[104:107], a[36:39], v[164:167]
v_mfma_f32_16x16x32_bf16 v[188:191], a[104:107], a[40:43], v[188:191]
buffer_load_dwordx4 v[92:95], v1, s[4:7], s88 offen offset:0 sc1
v_mfma_f32_16x16x32_bf16 v[212:215], a[104:107], a[44:47], v[212:215]
ds_read_b128 a[144:147], v5 offset:47104
v_mfma_f32_16x16x32_bf16 v[216:219], a[108:111], a[44:47], v[216:219]
v_mfma_f32_16x16x32_bf16 v[192:195], a[108:111], a[40:43], v[192:195]
ds_read_b128 a[148:151], v5 offset:48128
v_mfma_f32_16x16x32_bf16 v[168:171], a[108:111], a[36:39], v[168:171]
v_mfma_f32_16x16x32_bf16 v[144:147], a[108:111], a[32:35], v[144:147]
buffer_load_dwordx4 a[24:27], v2, s[40:43], s35 offen offset:2048 sc1
v_mfma_f32_16x16x32_bf16 v[148:151], a[112:115], a[32:35], v[148:151]
v_accvgpr_read_b32 v57, a197
v_mfma_f32_16x16x32_bf16 v[172:175], a[112:115], a[36:39], v[172:175]
v_mfma_f32_16x16x32_bf16 v[196:199], a[112:115], a[40:43], v[196:199]
v_mfma_f32_16x16x32_bf16 v[220:223], a[112:115], a[44:47], v[220:223]
v_mfma_f32_16x16x32_bf16 v[224:227], a[116:119], a[44:47], v[224:227]
buffer_load_dwordx4 a[28:31], v2, s[40:43], s35 offen offset:3072 sc1
s_add_u32 s35, s35, 4096
v_mfma_f32_16x16x32_bf16 v[200:203], a[116:119], a[40:43], v[200:203]
v_mfma_f32_16x16x32_bf16 v[176:179], a[116:119], a[36:39], v[176:179]
v_accvgpr_read_b32 v58, a198
v_mfma_f32_16x16x32_bf16 v[152:155], a[116:119], a[32:35], v[152:155]
s_waitcnt vmcnt(10) lgkmcnt(0)
s_barrier
v_mfma_f32_16x16x32_bf16 v[132:135], a[128:131], a[48:51], v[132:135]
v_add_u32 v5, 49152, v1
v_mfma_f32_16x16x32_bf16 v[156:159], a[128:131], a[52:55], v[156:159]
buffer_load_dwordx4 a[32:35], v2, s[40:43], s35 offen offset:0 sc1
v_mfma_f32_16x16x32_bf16 v[180:183], a[128:131], a[56:59], v[180:183]
ds_read_b128 a[96:99], v5 offset:0
v_mfma_f32_16x16x32_bf16 v[204:207], a[128:131], a[60:63], v[204:207]
ds_read_b128 a[100:103], v5 offset:1024
v_mfma_f32_16x16x32_bf16 v[208:211], a[132:135], a[60:63], v[208:211]
v_mfma_f32_16x16x32_bf16 v[184:187], a[132:135], a[56:59], v[184:187]
buffer_load_dwordx4 a[36:39], v2, s[40:43], s35 offen offset:1024 sc1
v_mfma_f32_16x16x32_bf16 v[160:163], a[132:135], a[52:55], v[160:163]
ds_read_b128 a[104:107], v5 offset:2048
v_accvgpr_read_b32 v59, a199
v_mfma_f32_16x16x32_bf16 v[136:139], a[132:135], a[48:51], v[136:139]
v_mfma_f32_16x16x32_bf16 v[140:143], a[136:139], a[48:51], v[140:143]
ds_read_b128 a[108:111], v5 offset:3072
v_mfma_f32_16x16x32_bf16 v[164:167], a[136:139], a[52:55], v[164:167]
v_mfma_f32_16x16x32_bf16 v[188:191], a[136:139], a[56:59], v[188:191]
buffer_load_dwordx4 v[96:99], v1, s[4:7], s88 offen offset:1024 sc1
v_mfma_f32_16x16x32_bf16 v[212:215], a[136:139], a[60:63], v[212:215]
ds_read_b128 a[112:115], v5 offset:4096
v_mfma_f32_16x16x32_bf16 v[216:219], a[140:143], a[60:63], v[216:219]
v_accvgpr_read_b32 v60, a200
v_mfma_f32_16x16x32_bf16 v[192:195], a[140:143], a[56:59], v[192:195]
ds_read_b128 a[116:119], v5 offset:5120
v_mfma_f32_16x16x32_bf16 v[168:171], a[140:143], a[52:55], v[168:171]
v_mfma_f32_16x16x32_bf16 v[144:147], a[140:143], a[48:51], v[144:147]
buffer_load_dwordx4 a[40:43], v2, s[40:43], s35 offen offset:2048 sc1
v_mfma_f32_16x16x32_bf16 v[148:151], a[144:147], a[48:51], v[148:151]
v_mfma_f32_16x16x32_bf16 v[172:175], a[144:147], a[52:55], v[172:175]
v_mfma_f32_16x16x32_bf16 v[196:199], a[144:147], a[56:59], v[196:199]
v_mfma_f32_16x16x32_bf16 v[220:223], a[144:147], a[60:63], v[220:223]
v_accvgpr_read_b32 v61, a201
v_mfma_f32_16x16x32_bf16 v[224:227], a[148:151], a[60:63], v[224:227]
buffer_load_dwordx4 a[44:47], v2, s[40:43], s35 offen offset:3072 sc1
s_add_u32 s35, s35, 4096
v_mfma_f32_16x16x32_bf16 v[200:203], a[148:151], a[56:59], v[200:203]
v_mfma_f32_16x16x32_bf16 v[176:179], a[148:151], a[52:55], v[176:179]
v_mfma_f32_16x16x32_bf16 v[152:155], a[148:151], a[48:51], v[152:155]
s_waitcnt vmcnt(10) lgkmcnt(0)
v_mfma_f32_16x16x32_bf16 v[132:135], a[96:99], a[0:3], v[132:135]
ds_read_b128 a[128:131], v5 offset:6144
v_mfma_f32_16x16x32_bf16 v[156:159], a[96:99], a[4:7], v[156:159]
buffer_load_dwordx4 a[48:51], v2, s[40:43], s35 offen offset:0 sc1
v_mfma_f32_16x16x32_bf16 v[180:183], a[96:99], a[8:11], v[180:183]
ds_read_b128 a[132:135], v5 offset:7168
v_accvgpr_read_b32 v62, a202
v_mfma_f32_16x16x32_bf16 v[204:207], a[96:99], a[12:15], v[204:207]
v_mfma_f32_16x16x32_bf16 v[208:211], a[100:103], a[12:15], v[208:211]
v_mfma_f32_16x16x32_bf16 v[184:187], a[100:103], a[8:11], v[184:187]
buffer_load_dwordx4 a[52:55], v2, s[40:43], s35 offen offset:1024 sc1
v_mfma_f32_16x16x32_bf16 v[160:163], a[100:103], a[4:7], v[160:163]
ds_read_b128 a[136:139], v5 offset:8192
v_mfma_f32_16x16x32_bf16 v[136:139], a[100:103], a[0:3], v[136:139]
v_mfma_f32_16x16x32_bf16 v[140:143], a[104:107], a[0:3], v[140:143]
ds_read_b128 a[140:143], v5 offset:9216
v_mfma_f32_16x16x32_bf16 v[164:167], a[104:107], a[4:7], v[164:167]
v_accvgpr_read_b32 v63, a203
v_mfma_f32_16x16x32_bf16 v[188:191], a[104:107], a[8:11], v[188:191]
buffer_load_dwordx4 v[100:103], v1, s[4:7], s88 offen offset:2048 sc1
v_mfma_f32_16x16x32_bf16 v[212:215], a[104:107], a[12:15], v[212:215]
ds_read_b128 a[144:147], v5 offset:10240
v_mfma_f32_16x16x32_bf16 v[216:219], a[108:111], a[12:15], v[216:219]
v_mfma_f32_16x16x32_bf16 v[192:195], a[108:111], a[8:11], v[192:195]
ds_read_b128 a[148:151], v5 offset:11264
v_mfma_f32_16x16x32_bf16 v[168:171], a[108:111], a[4:7], v[168:171]
v_mfma_f32_16x16x32_bf16 v[144:147], a[108:111], a[0:3], v[144:147]
buffer_load_dwordx4 a[56:59], v2, s[40:43], s35 offen offset:2048 sc1
v_mfma_f32_16x16x32_bf16 v[148:151], a[112:115], a[0:3], v[148:151]
v_accvgpr_read_b32 v64, a204
v_mfma_f32_16x16x32_bf16 v[172:175], a[112:115], a[4:7], v[172:175]
v_mfma_f32_16x16x32_bf16 v[196:199], a[112:115], a[8:11], v[196:199]
v_mfma_f32_16x16x32_bf16 v[220:223], a[112:115], a[12:15], v[220:223]
v_mfma_f32_16x16x32_bf16 v[224:227], a[116:119], a[12:15], v[224:227]
buffer_load_dwordx4 a[60:63], v2, s[40:43], s35 offen offset:3072 sc1
s_add_u32 s35, s35, 4096
v_mfma_f32_16x16x32_bf16 v[200:203], a[116:119], a[8:11], v[200:203]
v_mfma_f32_16x16x32_bf16 v[176:179], a[116:119], a[4:7], v[176:179]
v_mfma_f32_16x16x32_bf16 v[152:155], a[116:119], a[0:3], v[152:155]
v_accvgpr_read_b32 v65, a205
s_waitcnt vmcnt(10) lgkmcnt(0)
v_mfma_f32_16x16x32_bf16 v[132:135], a[128:131], a[16:19], v[132:135]
ds_read_b128 a[96:99], v5 offset:12288
v_mfma_f32_16x16x32_bf16 v[156:159], a[128:131], a[20:23], v[156:159]
buffer_load_dwordx4 a[0:3], v2, s[40:43], s35 offen offset:0 sc1
v_mfma_f32_16x16x32_bf16 v[180:183], a[128:131], a[24:27], v[180:183]
ds_read_b128 a[100:103], v5 offset:13312
v_mfma_f32_16x16x32_bf16 v[204:207], a[128:131], a[28:31], v[204:207]
v_mfma_f32_16x16x32_bf16 v[208:211], a[132:135], a[28:31], v[208:211]
v_mfma_f32_16x16x32_bf16 v[184:187], a[132:135], a[24:27], v[184:187]
buffer_load_dwordx4 a[4:7], v2, s[40:43], s35 offen offset:1024 sc1
v_mfma_f32_16x16x32_bf16 v[160:163], a[132:135], a[20:23], v[160:163]
ds_read_b128 a[104:107], v5 offset:14336
v_accvgpr_read_b32 v66, a206
v_mfma_f32_16x16x32_bf16 v[136:139], a[132:135], a[16:19], v[136:139]
v_mfma_f32_16x16x32_bf16 v[140:143], a[136:139], a[16:19], v[140:143]
ds_read_b128 a[108:111], v5 offset:15360
v_mfma_f32_16x16x32_bf16 v[164:167], a[136:139], a[20:23], v[164:167]
v_mfma_f32_16x16x32_bf16 v[188:191], a[136:139], a[24:27], v[188:191]
buffer_load_dwordx4 v[104:107], v1, s[4:7], s88 offen offset:3072 sc1
s_add_u32 s88, s88, 4096
v_mfma_f32_16x16x32_bf16 v[212:215], a[136:139], a[28:31], v[212:215]
ds_read_b128 a[112:115], v5 offset:16384
v_mfma_f32_16x16x32_bf16 v[216:219], a[140:143], a[28:31], v[216:219]
v_mfma_f32_16x16x32_bf16 v[192:195], a[140:143], a[24:27], v[192:195]
ds_read_b128 a[116:119], v5 offset:17408
v_accvgpr_read_b32 v67, a207
v_mfma_f32_16x16x32_bf16 v[168:171], a[140:143], a[20:23], v[168:171]
v_mfma_f32_16x16x32_bf16 v[144:147], a[140:143], a[16:19], v[144:147]
buffer_load_dwordx4 a[8:11], v2, s[40:43], s35 offen offset:2048 sc1
v_mfma_f32_16x16x32_bf16 v[148:151], a[144:147], a[16:19], v[148:151]
v_mfma_f32_16x16x32_bf16 v[172:175], a[144:147], a[20:23], v[172:175]
v_mfma_f32_16x16x32_bf16 v[196:199], a[144:147], a[24:27], v[196:199]
v_mfma_f32_16x16x32_bf16 v[220:223], a[144:147], a[28:31], v[220:223]
v_mfma_f32_16x16x32_bf16 v[224:227], a[148:151], a[28:31], v[224:227]
buffer_load_dwordx4 a[12:15], v2, s[40:43], s35 offen offset:3072 sc1
s_add_u32 s35, s35, 4096
v_mfma_f32_16x16x32_bf16 v[200:203], a[148:151], a[24:27], v[200:203]
v_accvgpr_read_b32 v68, a208
v_mfma_f32_16x16x32_bf16 v[176:179], a[148:151], a[20:23], v[176:179]
v_mfma_f32_16x16x32_bf16 v[152:155], a[148:151], a[16:19], v[152:155]
s_waitcnt vmcnt(10) lgkmcnt(0)
v_mfma_f32_16x16x32_bf16 v[132:135], a[96:99], a[32:35], v[132:135]
ds_read_b128 a[128:131], v5 offset:18432
v_mfma_f32_16x16x32_bf16 v[156:159], a[96:99], a[36:39], v[156:159]
buffer_load_dwordx4 a[16:19], v2, s[40:43], s35 offen offset:0 sc1
v_mfma_f32_16x16x32_bf16 v[180:183], a[96:99], a[40:43], v[180:183]
ds_read_b128 a[132:135], v5 offset:19456
v_mfma_f32_16x16x32_bf16 v[204:207], a[96:99], a[44:47], v[204:207]
v_accvgpr_read_b32 v69, a209
v_mfma_f32_16x16x32_bf16 v[208:211], a[100:103], a[44:47], v[208:211]
v_mfma_f32_16x16x32_bf16 v[184:187], a[100:103], a[40:43], v[184:187]
buffer_load_dwordx4 a[20:23], v2, s[40:43], s35 offen offset:1024 sc1
v_mfma_f32_16x16x32_bf16 v[160:163], a[100:103], a[36:39], v[160:163]
ds_read_b128 a[136:139], v5 offset:20480
v_mfma_f32_16x16x32_bf16 v[136:139], a[100:103], a[32:35], v[136:139]
v_mfma_f32_16x16x32_bf16 v[140:143], a[104:107], a[32:35], v[140:143]
ds_read_b128 a[140:143], v5 offset:21504
v_mfma_f32_16x16x32_bf16 v[164:167], a[104:107], a[36:39], v[164:167]
v_mfma_f32_16x16x32_bf16 v[188:191], a[104:107], a[40:43], v[188:191]
buffer_load_dwordx4 v[108:111], v1, s[4:7], s88 offen offset:0 sc1
v_mfma_f32_16x16x32_bf16 v[212:215], a[104:107], a[44:47], v[212:215]
ds_read_b128 a[144:147], v5 offset:22528
v_accvgpr_read_b32 v70, a210
v_mfma_f32_16x16x32_bf16 v[216:219], a[108:111], a[44:47], v[216:219]
v_mfma_f32_16x16x32_bf16 v[192:195], a[108:111], a[40:43], v[192:195]
ds_read_b128 a[148:151], v5 offset:23552
v_mfma_f32_16x16x32_bf16 v[168:171], a[108:111], a[36:39], v[168:171]
v_mfma_f32_16x16x32_bf16 v[144:147], a[108:111], a[32:35], v[144:147]
buffer_load_dwordx4 a[24:27], v2, s[40:43], s35 offen offset:2048 sc1
v_mfma_f32_16x16x32_bf16 v[148:151], a[112:115], a[32:35], v[148:151]
v_mfma_f32_16x16x32_bf16 v[172:175], a[112:115], a[36:39], v[172:175]
v_accvgpr_read_b32 v71, a211
v_mfma_f32_16x16x32_bf16 v[196:199], a[112:115], a[40:43], v[196:199]
v_mfma_f32_16x16x32_bf16 v[220:223], a[112:115], a[44:47], v[220:223]
v_mfma_f32_16x16x32_bf16 v[224:227], a[116:119], a[44:47], v[224:227]
buffer_load_dwordx4 a[28:31], v2, s[40:43], s35 offen offset:3072 sc1
s_add_u32 s35, s35, 4096
v_mfma_f32_16x16x32_bf16 v[200:203], a[116:119], a[40:43], v[200:203]
v_mfma_f32_16x16x32_bf16 v[176:179], a[116:119], a[36:39], v[176:179]
v_mfma_f32_16x16x32_bf16 v[152:155], a[116:119], a[32:35], v[152:155]
s_waitcnt vmcnt(10) lgkmcnt(0)
v_mfma_f32_16x16x32_bf16 v[132:135], a[128:131], a[48:51], v[132:135]
ds_read_b128 a[96:99], v5 offset:24576
v_mfma_f32_16x16x32_bf16 v[156:159], a[128:131], a[52:55], v[156:159]
buffer_load_dwordx4 a[32:35], v2, s[40:43], s35 offen offset:0 sc1
v_mfma_f32_16x16x32_bf16 v[180:183], a[128:131], a[56:59], v[180:183]
ds_read_b128 a[100:103], v5 offset:25600
v_mfma_f32_16x16x32_bf16 v[204:207], a[128:131], a[60:63], v[204:207]
v_mfma_f32_16x16x32_bf16 v[208:211], a[132:135], a[60:63], v[208:211]
v_mfma_f32_16x16x32_bf16 v[184:187], a[132:135], a[56:59], v[184:187]
buffer_load_dwordx4 a[36:39], v2, s[40:43], s35 offen offset:1024 sc1
v_mfma_f32_16x16x32_bf16 v[160:163], a[132:135], a[52:55], v[160:163]
ds_read_b128 a[104:107], v5 offset:26624
v_mfma_f32_16x16x32_bf16 v[136:139], a[132:135], a[48:51], v[136:139]
v_mfma_f32_16x16x32_bf16 v[140:143], a[136:139], a[48:51], v[140:143]
ds_read_b128 a[108:111], v5 offset:27648
v_mfma_f32_16x16x32_bf16 v[164:167], a[136:139], a[52:55], v[164:167]
v_mfma_f32_16x16x32_bf16 v[188:191], a[136:139], a[56:59], v[188:191]
buffer_load_dwordx4 v[112:115], v1, s[4:7], s88 offen offset:1024 sc1
v_mfma_f32_16x16x32_bf16 v[212:215], a[136:139], a[60:63], v[212:215]
ds_read_b128 a[112:115], v5 offset:28672
v_mfma_f32_16x16x32_bf16 v[216:219], a[140:143], a[60:63], v[216:219]
v_mfma_f32_16x16x32_bf16 v[192:195], a[140:143], a[56:59], v[192:195]
ds_read_b128 a[116:119], v5 offset:29696
v_mfma_f32_16x16x32_bf16 v[168:171], a[140:143], a[52:55], v[168:171]
v_mfma_f32_16x16x32_bf16 v[144:147], a[140:143], a[48:51], v[144:147]
buffer_load_dwordx4 a[40:43], v2, s[40:43], s35 offen offset:2048 sc1
v_mfma_f32_16x16x32_bf16 v[148:151], a[144:147], a[48:51], v[148:151]
v_mfma_f32_16x16x32_bf16 v[172:175], a[144:147], a[52:55], v[172:175]
v_mfma_f32_16x16x32_bf16 v[196:199], a[144:147], a[56:59], v[196:199]
v_mfma_f32_16x16x32_bf16 v[220:223], a[144:147], a[60:63], v[220:223]
v_mfma_f32_16x16x32_bf16 v[224:227], a[148:151], a[60:63], v[224:227]
buffer_load_dwordx4 a[44:47], v2, s[40:43], s35 offen offset:3072 sc1
s_add_u32 s35, s35, 4096
v_mfma_f32_16x16x32_bf16 v[200:203], a[148:151], a[56:59], v[200:203]
v_mfma_f32_16x16x32_bf16 v[176:179], a[148:151], a[52:55], v[176:179]
v_mfma_f32_16x16x32_bf16 v[152:155], a[148:151], a[48:51], v[152:155]
s_waitcnt vmcnt(10) lgkmcnt(0)
v_mfma_f32_16x16x32_bf16 v[132:135], a[96:99], a[0:3], v[132:135]
ds_read_b128 a[128:131], v5 offset:30720
v_mfma_f32_16x16x32_bf16 v[156:159], a[96:99], a[4:7], v[156:159]
buffer_load_dwordx4 a[48:51], v2, s[40:43], s35 offen offset:0 sc1
v_mfma_f32_16x16x32_bf16 v[180:183], a[96:99], a[8:11], v[180:183]
ds_read_b128 a[132:135], v5 offset:31744
v_mfma_f32_16x16x32_bf16 v[204:207], a[96:99], a[12:15], v[204:207]
v_mfma_f32_16x16x32_bf16 v[208:211], a[100:103], a[12:15], v[208:211]
v_mfma_f32_16x16x32_bf16 v[184:187], a[100:103], a[8:11], v[184:187]
buffer_load_dwordx4 a[52:55], v2, s[40:43], s35 offen offset:1024 sc1
v_mfma_f32_16x16x32_bf16 v[160:163], a[100:103], a[4:7], v[160:163]
ds_read_b128 a[136:139], v5 offset:32768
v_mfma_f32_16x16x32_bf16 v[136:139], a[100:103], a[0:3], v[136:139]
v_mfma_f32_16x16x32_bf16 v[140:143], a[104:107], a[0:3], v[140:143]
ds_read_b128 a[140:143], v5 offset:33792
v_mfma_f32_16x16x32_bf16 v[164:167], a[104:107], a[4:7], v[164:167]
v_mfma_f32_16x16x32_bf16 v[188:191], a[104:107], a[8:11], v[188:191]
buffer_load_dwordx4 v[116:119], v1, s[4:7], s88 offen offset:2048 sc1
v_mfma_f32_16x16x32_bf16 v[212:215], a[104:107], a[12:15], v[212:215]
ds_read_b128 a[144:147], v5 offset:34816
v_mfma_f32_16x16x32_bf16 v[216:219], a[108:111], a[12:15], v[216:219]
v_mfma_f32_16x16x32_bf16 v[192:195], a[108:111], a[8:11], v[192:195]
ds_read_b128 a[148:151], v5 offset:35840
v_mfma_f32_16x16x32_bf16 v[168:171], a[108:111], a[4:7], v[168:171]
v_mfma_f32_16x16x32_bf16 v[144:147], a[108:111], a[0:3], v[144:147]
buffer_load_dwordx4 a[56:59], v2, s[40:43], s35 offen offset:2048 sc1
v_mfma_f32_16x16x32_bf16 v[148:151], a[112:115], a[0:3], v[148:151]
v_mfma_f32_16x16x32_bf16 v[172:175], a[112:115], a[4:7], v[172:175]
v_mfma_f32_16x16x32_bf16 v[196:199], a[112:115], a[8:11], v[196:199]
v_mfma_f32_16x16x32_bf16 v[220:223], a[112:115], a[12:15], v[220:223]
v_mfma_f32_16x16x32_bf16 v[224:227], a[116:119], a[12:15], v[224:227]
buffer_load_dwordx4 a[60:63], v2, s[40:43], s35 offen offset:3072 sc1
s_add_u32 s35, s35, 4096
v_mfma_f32_16x16x32_bf16 v[200:203], a[116:119], a[8:11], v[200:203]
v_mfma_f32_16x16x32_bf16 v[176:179], a[116:119], a[4:7], v[176:179]
v_mfma_f32_16x16x32_bf16 v[152:155], a[116:119], a[0:3], v[152:155]
s_waitcnt vmcnt(10) lgkmcnt(0)
v_mfma_f32_16x16x32_bf16 v[132:135], a[128:131], a[16:19], v[132:135]
ds_read_b128 a[96:99], v5 offset:36864
v_mfma_f32_16x16x32_bf16 v[156:159], a[128:131], a[20:23], v[156:159]
buffer_load_dwordx4 a[0:3], v2, s[40:43], s35 offen offset:0 sc1
v_mfma_f32_16x16x32_bf16 v[180:183], a[128:131], a[24:27], v[180:183]
ds_read_b128 a[100:103], v5 offset:37888
v_mfma_f32_16x16x32_bf16 v[204:207], a[128:131], a[28:31], v[204:207]
v_mfma_f32_16x16x32_bf16 v[208:211], a[132:135], a[28:31], v[208:211]
v_mfma_f32_16x16x32_bf16 v[184:187], a[132:135], a[24:27], v[184:187]
buffer_load_dwordx4 a[4:7], v2, s[40:43], s35 offen offset:1024 sc1
v_mfma_f32_16x16x32_bf16 v[160:163], a[132:135], a[20:23], v[160:163]
ds_read_b128 a[104:107], v5 offset:38912
v_mfma_f32_16x16x32_bf16 v[136:139], a[132:135], a[16:19], v[136:139]
v_mfma_f32_16x16x32_bf16 v[140:143], a[136:139], a[16:19], v[140:143]
ds_read_b128 a[108:111], v5 offset:39936
v_mfma_f32_16x16x32_bf16 v[164:167], a[136:139], a[20:23], v[164:167]
v_mfma_f32_16x16x32_bf16 v[188:191], a[136:139], a[24:27], v[188:191]
buffer_load_dwordx4 v[120:123], v1, s[4:7], s88 offen offset:3072 sc1
s_add_u32 m0, s18, 0x0
v_mfma_f32_16x16x32_bf16 v[212:215], a[136:139], a[28:31], v[212:215]
s_add_u32 s44, s50, 0x1424000
ds_read_b128 a[112:115], v5 offset:40960
v_mfma_f32_16x16x32_bf16 v[216:219], a[140:143], a[28:31], v[216:219]
v_mfma_f32_16x16x32_bf16 v[192:195], a[140:143], a[24:27], v[192:195]
ds_read_b128 a[116:119], v5 offset:41984
v_mfma_f32_16x16x32_bf16 v[168:171], a[140:143], a[20:23], v[168:171]
v_mfma_f32_16x16x32_bf16 v[144:147], a[140:143], a[16:19], v[144:147]
buffer_load_dwordx4 a[8:11], v2, s[40:43], s35 offen offset:2048 sc1
v_mfma_f32_16x16x32_bf16 v[148:151], a[144:147], a[16:19], v[148:151]
v_mfma_f32_16x16x32_bf16 v[172:175], a[144:147], a[20:23], v[172:175]
v_mfma_f32_16x16x32_bf16 v[196:199], a[144:147], a[24:27], v[196:199]
v_mfma_f32_16x16x32_bf16 v[220:223], a[144:147], a[28:31], v[220:223]
v_mfma_f32_16x16x32_bf16 v[224:227], a[148:151], a[28:31], v[224:227]
buffer_load_dwordx4 a[12:15], v2, s[40:43], s35 offen offset:3072 sc1
s_add_u32 s35, s35, 4096
v_mfma_f32_16x16x32_bf16 v[200:203], a[148:151], a[24:27], v[200:203]
v_mfma_f32_16x16x32_bf16 v[176:179], a[148:151], a[20:23], v[176:179]
v_mfma_f32_16x16x32_bf16 v[152:155], a[148:151], a[16:19], v[152:155]
s_waitcnt vmcnt(10) lgkmcnt(0)
v_mfma_f32_16x16x32_bf16 v[132:135], a[96:99], a[32:35], v[132:135]
ds_read_b128 a[128:131], v5 offset:43008
v_mfma_f32_16x16x32_bf16 v[156:159], a[96:99], a[36:39], v[156:159]
buffer_load_dwordx4 a[16:19], v2, s[40:43], s35 offen offset:0 sc1
v_mfma_f32_16x16x32_bf16 v[180:183], a[96:99], a[40:43], v[180:183]
ds_read_b128 a[132:135], v5 offset:44032
v_mfma_f32_16x16x32_bf16 v[204:207], a[96:99], a[44:47], v[204:207]
v_mfma_f32_16x16x32_bf16 v[208:211], a[100:103], a[44:47], v[208:211]
v_mfma_f32_16x16x32_bf16 v[184:187], a[100:103], a[40:43], v[184:187]
buffer_load_dwordx4 a[20:23], v2, s[40:43], s35 offen offset:1024 sc1
v_mfma_f32_16x16x32_bf16 v[160:163], a[100:103], a[36:39], v[160:163]
ds_read_b128 a[136:139], v5 offset:45056
v_mfma_f32_16x16x32_bf16 v[136:139], a[100:103], a[32:35], v[136:139]
v_mfma_f32_16x16x32_bf16 v[140:143], a[104:107], a[32:35], v[140:143]
ds_read_b128 a[140:143], v5 offset:46080
v_mfma_f32_16x16x32_bf16 v[164:167], a[104:107], a[36:39], v[164:167]
v_mfma_f32_16x16x32_bf16 v[188:191], a[104:107], a[40:43], v[188:191]
buffer_load_dwordx4 v1, s[4:7], s44 offen offset:0 sc1 lds
v_mfma_f32_16x16x32_bf16 v[212:215], a[104:107], a[44:47], v[212:215]
ds_read_b128 a[144:147], v5 offset:47104
v_mfma_f32_16x16x32_bf16 v[216:219], a[108:111], a[44:47], v[216:219]
v_mfma_f32_16x16x32_bf16 v[192:195], a[108:111], a[40:43], v[192:195]
ds_read_b128 a[148:151], v5 offset:48128
v_mfma_f32_16x16x32_bf16 v[168:171], a[108:111], a[36:39], v[168:171]
v_mfma_f32_16x16x32_bf16 v[144:147], a[108:111], a[32:35], v[144:147]
buffer_load_dwordx4 a[24:27], v2, s[40:43], s35 offen offset:2048 sc1
v_mfma_f32_16x16x32_bf16 v[148:151], a[112:115], a[32:35], v[148:151]
v_mfma_f32_16x16x32_bf16 v[172:175], a[112:115], a[36:39], v[172:175]
v_mfma_f32_16x16x32_bf16 v[196:199], a[112:115], a[40:43], v[196:199]
v_mfma_f32_16x16x32_bf16 v[220:223], a[112:115], a[44:47], v[220:223]
v_mfma_f32_16x16x32_bf16 v[224:227], a[116:119], a[44:47], v[224:227]
buffer_load_dwordx4 a[28:31], v2, s[40:43], s35 offen offset:3072 sc1
s_add_u32 s35, s35, 4096
v_mfma_f32_16x16x32_bf16 v[200:203], a[116:119], a[40:43], v[200:203]
v_mfma_f32_16x16x32_bf16 v[176:179], a[116:119], a[36:39], v[176:179]
v_mfma_f32_16x16x32_bf16 v[152:155], a[116:119], a[32:35], v[152:155]
s_waitcnt vmcnt(10) lgkmcnt(0)
s_barrier
v_mfma_f32_16x16x32_bf16 v[132:135], a[128:131], a[48:51], v[132:135]
v_add_u32 v5, 98304, v1
v_mfma_f32_16x16x32_bf16 v[156:159], a[128:131], a[52:55], v[156:159]
buffer_load_dwordx4 a[32:35], v2, s[40:43], s35 offen offset:0 sc1
v_mfma_f32_16x16x32_bf16 v[180:183], a[128:131], a[56:59], v[180:183]
ds_read_b128 a[96:99], v5 offset:0
v_mfma_f32_16x16x32_bf16 v[204:207], a[128:131], a[60:63], v[204:207]
ds_read_b128 a[100:103], v5 offset:1024
v_mfma_f32_16x16x32_bf16 v[208:211], a[132:135], a[60:63], v[208:211]
v_mfma_f32_16x16x32_bf16 v[184:187], a[132:135], a[56:59], v[184:187]
buffer_load_dwordx4 a[36:39], v2, s[40:43], s35 offen offset:1024 sc1
v_mfma_f32_16x16x32_bf16 v[160:163], a[132:135], a[52:55], v[160:163]
ds_read_b128 a[104:107], v5 offset:2048
v_mfma_f32_16x16x32_bf16 v[136:139], a[132:135], a[48:51], v[136:139]
v_mfma_f32_16x16x32_bf16 v[140:143], a[136:139], a[48:51], v[140:143]
ds_read_b128 a[108:111], v5 offset:3072
v_mfma_f32_16x16x32_bf16 v[164:167], a[136:139], a[52:55], v[164:167]
v_mfma_f32_16x16x32_bf16 v[188:191], a[136:139], a[56:59], v[188:191]
buffer_load_dwordx4 v1, s[4:7], s44 offen offset:1024 sc1 lds
v_mfma_f32_16x16x32_bf16 v[212:215], a[136:139], a[60:63], v[212:215]
ds_read_b128 a[112:115], v5 offset:4096
v_mfma_f32_16x16x32_bf16 v[216:219], a[140:143], a[60:63], v[216:219]
v_mfma_f32_16x16x32_bf16 v[192:195], a[140:143], a[56:59], v[192:195]
ds_read_b128 a[116:119], v5 offset:5120
v_mfma_f32_16x16x32_bf16 v[168:171], a[140:143], a[52:55], v[168:171]
v_mfma_f32_16x16x32_bf16 v[144:147], a[140:143], a[48:51], v[144:147]
buffer_load_dwordx4 a[40:43], v2, s[40:43], s35 offen offset:2048 sc1
v_mfma_f32_16x16x32_bf16 v[148:151], a[144:147], a[48:51], v[148:151]
v_mfma_f32_16x16x32_bf16 v[172:175], a[144:147], a[52:55], v[172:175]
v_mfma_f32_16x16x32_bf16 v[196:199], a[144:147], a[56:59], v[196:199]
v_mfma_f32_16x16x32_bf16 v[220:223], a[144:147], a[60:63], v[220:223]
v_mfma_f32_16x16x32_bf16 v[224:227], a[148:151], a[60:63], v[224:227]
buffer_load_dwordx4 a[44:47], v2, s[40:43], s35 offen offset:3072 sc1
s_add_u32 s35, s35, 4096
v_mfma_f32_16x16x32_bf16 v[200:203], a[148:151], a[56:59], v[200:203]
v_mfma_f32_16x16x32_bf16 v[176:179], a[148:151], a[52:55], v[176:179]
v_mfma_f32_16x16x32_bf16 v[152:155], a[148:151], a[48:51], v[152:155]
s_waitcnt vmcnt(10) lgkmcnt(0)
v_mfma_f32_16x16x32_bf16 v[132:135], a[96:99], a[0:3], v[132:135]
ds_read_b128 a[128:131], v5 offset:6144
v_mfma_f32_16x16x32_bf16 v[156:159], a[96:99], a[4:7], v[156:159]
buffer_load_dwordx4 a[48:51], v2, s[40:43], s35 offen offset:0 sc1
v_mfma_f32_16x16x32_bf16 v[180:183], a[96:99], a[8:11], v[180:183]
ds_read_b128 a[132:135], v5 offset:7168
v_mfma_f32_16x16x32_bf16 v[204:207], a[96:99], a[12:15], v[204:207]
v_mfma_f32_16x16x32_bf16 v[208:211], a[100:103], a[12:15], v[208:211]
v_mfma_f32_16x16x32_bf16 v[184:187], a[100:103], a[8:11], v[184:187]
buffer_load_dwordx4 a[52:55], v2, s[40:43], s35 offen offset:1024 sc1
v_mfma_f32_16x16x32_bf16 v[160:163], a[100:103], a[4:7], v[160:163]
ds_read_b128 a[136:139], v5 offset:8192
v_mfma_f32_16x16x32_bf16 v[136:139], a[100:103], a[0:3], v[136:139]
v_mfma_f32_16x16x32_bf16 v[140:143], a[104:107], a[0:3], v[140:143]
ds_read_b128 a[140:143], v5 offset:9216
v_mfma_f32_16x16x32_bf16 v[164:167], a[104:107], a[4:7], v[164:167]
v_mfma_f32_16x16x32_bf16 v[188:191], a[104:107], a[8:11], v[188:191]
buffer_load_dwordx4 v1, s[4:7], s44 offen offset:2048 sc1 lds
s_add_u32 m0, s18, 0x3000
v_mfma_f32_16x16x32_bf16 v[212:215], a[104:107], a[12:15], v[212:215]
s_add_u32 s44, s50, 0x1427000
ds_read_b128 a[144:147], v5 offset:10240
v_mfma_f32_16x16x32_bf16 v[216:219], a[108:111], a[12:15], v[216:219]
v_mfma_f32_16x16x32_bf16 v[192:195], a[108:111], a[8:11], v[192:195]
L_stub16:
s_cbranch_execz L_stub17
ds_read_b128 a[148:151], v5 offset:11264
v_mfma_f32_16x16x32_bf16 v[168:171], a[108:111], a[4:7], v[168:171]
v_mfma_f32_16x16x32_bf16 v[144:147], a[108:111], a[0:3], v[144:147]
buffer_load_dwordx4 a[56:59], v2, s[40:43], s35 offen offset:2048 sc1
v_mfma_f32_16x16x32_bf16 v[148:151], a[112:115], a[0:3], v[148:151]
v_mfma_f32_16x16x32_bf16 v[172:175], a[112:115], a[4:7], v[172:175]
v_mfma_f32_16x16x32_bf16 v[196:199], a[112:115], a[8:11], v[196:199]
v_mfma_f32_16x16x32_bf16 v[220:223], a[112:115], a[12:15], v[220:223]
v_mfma_f32_16x16x32_bf16 v[224:227], a[116:119], a[12:15], v[224:227]
buffer_load_dwordx4 a[60:63], v2, s[40:43], s35 offen offset:3072 sc1
s_add_u32 s35, s35, 4096
v_mfma_f32_16x16x32_bf16 v[200:203], a[116:119], a[8:11], v[200:203]
v_mfma_f32_16x16x32_bf16 v[176:179], a[116:119], a[4:7], v[176:179]
v_mfma_f32_16x16x32_bf16 v[152:155], a[116:119], a[0:3], v[152:155]
s_waitcnt vmcnt(10) lgkmcnt(0)
v_mfma_f32_16x16x32_bf16 v[132:135], a[128:131], a[16:19], v[132:135]
ds_read_b128 a[96:99], v5 offset:12288
v_mfma_f32_16x16x32_bf16 v[156:159], a[128:131], a[20:23], v[156:159]
buffer_load_dwordx4 a[0:3], v2, s[40:43], s35 offen offset:0 sc1
v_mfma_f32_16x16x32_bf16 v[180:183], a[128:131], a[24:27], v[180:183]
ds_read_b128 a[100:103], v5 offset:13312
v_mfma_f32_16x16x32_bf16 v[204:207], a[128:131], a[28:31], v[204:207]
v_mfma_f32_16x16x32_bf16 v[208:211], a[132:135], a[28:31], v[208:211]
v_mfma_f32_16x16x32_bf16 v[184:187], a[132:135], a[24:27], v[184:187]
buffer_load_dwordx4 a[4:7], v2, s[40:43], s35 offen offset:1024 sc1
v_mfma_f32_16x16x32_bf16 v[160:163], a[132:135], a[20:23], v[160:163]
ds_read_b128 a[104:107], v5 offset:14336
v_mfma_f32_16x16x32_bf16 v[136:139], a[132:135], a[16:19], v[136:139]
v_mfma_f32_16x16x32_bf16 v[140:143], a[136:139], a[16:19], v[140:143]
ds_read_b128 a[108:111], v5 offset:15360
v_mfma_f32_16x16x32_bf16 v[164:167], a[136:139], a[20:23], v[164:167]
v_mfma_f32_16x16x32_bf16 v[188:191], a[136:139], a[24:27], v[188:191]
buffer_load_dwordx4 v1, s[4:7], s44 offen offset:0 sc1 lds
v_mfma_f32_16x16x32_bf16 v[212:215], a[136:139], a[28:31], v[212:215]
ds_read_b128 a[112:115], v5 offset:16384
v_mfma_f32_16x16x32_bf16 v[216:219], a[140:143], a[28:31], v[216:219]
v_mfma_f32_16x16x32_bf16 v[192:195], a[140:143], a[24:27], v[192:195]
ds_read_b128 a[116:119], v5 offset:17408
v_mfma_f32_16x16x32_bf16 v[168:171], a[140:143], a[20:23], v[168:171]
v_mfma_f32_16x16x32_bf16 v[144:147], a[140:143], a[16:19], v[144:147]
buffer_load_dwordx4 a[8:11], v2, s[40:43], s35 offen offset:2048 sc1
v_mfma_f32_16x16x32_bf16 v[148:151], a[144:147], a[16:19], v[148:151]
v_mfma_f32_16x16x32_bf16 v[172:175], a[144:147], a[20:23], v[172:175]
v_mfma_f32_16x16x32_bf16 v[196:199], a[144:147], a[24:27], v[196:199]
v_mfma_f32_16x16x32_bf16 v[220:223], a[144:147], a[28:31], v[220:223]
v_mfma_f32_16x16x32_bf16 v[224:227], a[148:151], a[28:31], v[224:227]
buffer_load_dwordx4 a[12:15], v2, s[40:43], s35 offen offset:3072 sc1
s_add_u32 s35, s35, 4096
v_mfma_f32_16x16x32_bf16 v[200:203], a[148:151], a[24:27], v[200:203]
v_mfma_f32_16x16x32_bf16 v[176:179], a[148:151], a[20:23], v[176:179]
v_mfma_f32_16x16x32_bf16 v[152:155], a[148:151], a[16:19], v[152:155]
s_waitcnt vmcnt(10) lgkmcnt(0)
v_mfma_f32_16x16x32_bf16 v[132:135], a[96:99], a[32:35], v[132:135]
ds_read_b128 a[128:131], v5 offset:18432
v_mfma_f32_16x16x32_bf16 v[156:159], a[96:99], a[36:39], v[156:159]
buffer_load_dwordx4 a[16:19], v2, s[40:43], s35 offen offset:0 sc1
v_mfma_f32_16x16x32_bf16 v[180:183], a[96:99], a[40:43], v[180:183]
ds_read_b128 a[132:135], v5 offset:19456
v_mfma_f32_16x16x32_bf16 v[204:207], a[96:99], a[44:47], v[204:207]
v_mfma_f32_16x16x32_bf16 v[208:211], a[100:103], a[44:47], v[208:211]
v_mfma_f32_16x16x32_bf16 v[184:187], a[100:103], a[40:43], v[184:187]
buffer_load_dwordx4 a[20:23], v2, s[40:43], s35 offen offset:1024 sc1
v_mfma_f32_16x16x32_bf16 v[160:163], a[100:103], a[36:39], v[160:163]
ds_read_b128 a[136:139], v5 offset:20480
v_mfma_f32_16x16x32_bf16 v[136:139], a[100:103], a[32:35], v[136:139]
v_mfma_f32_16x16x32_bf16 v[140:143], a[104:107], a[32:35], v[140:143]
ds_read_b128 a[140:143], v5 offset:21504
v_mfma_f32_16x16x32_bf16 v[164:167], a[104:107], a[36:39], v[164:167]
v_mfma_f32_16x16x32_bf16 v[188:191], a[104:107], a[40:43], v[188:191]
buffer_load_dwordx4 v1, s[4:7], s44 offen offset:1024 sc1 lds
v_mfma_f32_16x16x32_bf16 v[212:215], a[104:107], a[44:47], v[212:215]
ds_read_b128 a[144:147], v5 offset:22528
v_mfma_f32_16x16x32_bf16 v[216:219], a[108:111], a[44:47], v[216:219]
v_mfma_f32_16x16x32_bf16 v[192:195], a[108:111], a[40:43], v[192:195]
ds_read_b128 a[148:151], v5 offset:23552
v_mfma_f32_16x16x32_bf16 v[168:171], a[108:111], a[36:39], v[168:171]
v_mfma_f32_16x16x32_bf16 v[144:147], a[108:111], a[32:35], v[144:147]
buffer_load_dwordx4 a[24:27], v2, s[40:43], s35 offen offset:2048 sc1
v_mfma_f32_16x16x32_bf16 v[148:151], a[112:115], a[32:35], v[148:151]
v_mfma_f32_16x16x32_bf16 v[172:175], a[112:115], a[36:39], v[172:175]
v_mfma_f32_16x16x32_bf16 v[196:199], a[112:115], a[40:43], v[196:199]
v_mfma_f32_16x16x32_bf16 v[220:223], a[112:115], a[44:47], v[220:223]
v_mfma_f32_16x16x32_bf16 v[224:227], a[116:119], a[44:47], v[224:227]
buffer_load_dwordx4 a[28:31], v2, s[40:43], s35 offen offset:3072 sc1
s_add_u32 s35, s35, 4096
v_mfma_f32_16x16x32_bf16 v[200:203], a[116:119], a[40:43], v[200:203]
v_mfma_f32_16x16x32_bf16 v[176:179], a[116:119], a[36:39], v[176:179]
v_mfma_f32_16x16x32_bf16 v[152:155], a[116:119], a[32:35], v[152:155]
s_waitcnt vmcnt(10) lgkmcnt(0)
s_barrier
v_mfma_f32_16x16x32_bf16 v[132:135], a[128:131], a[48:51], v[132:135]
ds_read_b128 a[96:99], v5 offset:24576
v_mfma_f32_16x16x32_bf16 v[156:159], a[128:131], a[52:55], v[156:159]
buffer_load_dwordx4 a[32:35], v2, s[40:43], s35 offen offset:0 sc1
v_mfma_f32_16x16x32_bf16 v[180:183], a[128:131], a[56:59], v[180:183]
ds_read_b128 a[100:103], v5 offset:25600
v_mfma_f32_16x16x32_bf16 v[204:207], a[128:131], a[60:63], v[204:207]
v_mfma_f32_16x16x32_bf16 v[208:211], a[132:135], a[60:63], v[208:211]
v_mfma_f32_16x16x32_bf16 v[184:187], a[132:135], a[56:59], v[184:187]
buffer_load_dwordx4 a[36:39], v2, s[40:43], s35 offen offset:1024 sc1
v_mfma_f32_16x16x32_bf16 v[160:163], a[132:135], a[52:55], v[160:163]
ds_read_b128 a[104:107], v5 offset:26624
v_mfma_f32_16x16x32_bf16 v[136:139], a[132:135], a[48:51], v[136:139]
v_mfma_f32_16x16x32_bf16 v[140:143], a[136:139], a[48:51], v[140:143]
ds_read_b128 a[108:111], v5 offset:27648
v_mfma_f32_16x16x32_bf16 v[164:167], a[136:139], a[52:55], v[164:167]
v_mfma_f32_16x16x32_bf16 v[188:191], a[136:139], a[56:59], v[188:191]
buffer_load_dwordx4 v1, s[4:7], s44 offen offset:2048 sc1 lds
s_add_u32 m0, s18, 0x6000
v_mfma_f32_16x16x32_bf16 v[212:215], a[136:139], a[60:63], v[212:215]
s_add_u32 s44, s50, 0x142a000
ds_read_b128 a[112:115], v5 offset:28672
v_mfma_f32_16x16x32_bf16 v[216:219], a[140:143], a[60:63], v[216:219]
v_mfma_f32_16x16x32_bf16 v[192:195], a[140:143], a[56:59], v[192:195]
ds_read_b128 a[116:119], v5 offset:29696
v_mfma_f32_16x16x32_bf16 v[168:171], a[140:143], a[52:55], v[168:171]
v_mfma_f32_16x16x32_bf16 v[144:147], a[140:143], a[48:51], v[144:147]
buffer_load_dwordx4 a[40:43], v2, s[40:43], s35 offen offset:2048 sc1
v_mfma_f32_16x16x32_bf16 v[148:151], a[144:147], a[48:51], v[148:151]
v_mfma_f32_16x16x32_bf16 v[172:175], a[144:147], a[52:55], v[172:175]
v_mfma_f32_16x16x32_bf16 v[196:199], a[144:147], a[56:59], v[196:199]
v_mfma_f32_16x16x32_bf16 v[220:223], a[144:147], a[60:63], v[220:223]
v_mfma_f32_16x16x32_bf16 v[224:227], a[148:151], a[60:63], v[224:227]
buffer_load_dwordx4 a[44:47], v2, s[40:43], s35 offen offset:3072 sc1
s_add_u32 s35, s35, 4096
v_mfma_f32_16x16x32_bf16 v[200:203], a[148:151], a[56:59], v[200:203]
v_mfma_f32_16x16x32_bf16 v[176:179], a[148:151], a[52:55], v[176:179]
v_mfma_f32_16x16x32_bf16 v[152:155], a[148:151], a[48:51], v[152:155]
s_waitcnt vmcnt(10) lgkmcnt(0)
v_mfma_f32_16x16x32_bf16 v[132:135], a[96:99], a[0:3], v[132:135]
ds_read_b128 a[128:131], v5 offset:30720
v_mfma_f32_16x16x32_bf16 v[156:159], a[96:99], a[4:7], v[156:159]
buffer_load_dwordx4 a[48:51], v2, s[40:43], s35 offen offset:0 sc1
v_mfma_f32_16x16x32_bf16 v[180:183], a[96:99], a[8:11], v[180:183]
ds_read_b128 a[132:135], v5 offset:31744
v_mfma_f32_16x16x32_bf16 v[204:207], a[96:99], a[12:15], v[204:207]
v_mfma_f32_16x16x32_bf16 v[208:211], a[100:103], a[12:15], v[208:211]
v_mfma_f32_16x16x32_bf16 v[184:187], a[100:103], a[8:11], v[184:187]
buffer_load_dwordx4 a[52:55], v2, s[40:43], s35 offen offset:1024 sc1
v_mfma_f32_16x16x32_bf16 v[160:163], a[100:103], a[4:7], v[160:163]
ds_read_b128 a[136:139], v5 offset:32768
v_mfma_f32_16x16x32_bf16 v[136:139], a[100:103], a[0:3], v[136:139]
v_mfma_f32_16x16x32_bf16 v[140:143], a[104:107], a[0:3], v[140:143]
ds_read_b128 a[140:143], v5 offset:33792
v_mfma_f32_16x16x32_bf16 v[164:167], a[104:107], a[4:7], v[164:167]
v_mfma_f32_16x16x32_bf16 v[188:191], a[104:107], a[8:11], v[188:191]
buffer_load_dwordx4 v1, s[4:7], s44 offen offset:0 sc1 lds
v_mfma_f32_16x16x32_bf16 v[212:215], a[104:107], a[12:15], v[212:215]
ds_read_b128 a[144:147], v5 offset:34816
v_mfma_f32_16x16x32_bf16 v[216:219], a[108:111], a[12:15], v[216:219]
v_mfma_f32_16x16x32_bf16 v[192:195], a[108:111], a[8:11], v[192:195]
ds_read_b128 a[148:151], v5 offset:35840
v_mfma_f32_16x16x32_bf16 v[168:171], a[108:111], a[4:7], v[168:171]
v_mfma_f32_16x16x32_bf16 v[144:147], a[108:111], a[0:3], v[144:147]
buffer_load_dwordx4 a[56:59], v2, s[40:43], s35 offen offset:2048 sc1
v_mfma_f32_16x16x32_bf16 v[148:151], a[112:115], a[0:3], v[148:151]
v_mfma_f32_16x16x32_bf16 v[172:175], a[112:115], a[4:7], v[172:175]
v_mfma_f32_16x16x32_bf16 v[196:199], a[112:115], a[8:11], v[196:199]
v_mfma_f32_16x16x32_bf16 v[220:223], a[112:115], a[12:15], v[220:223]
v_mfma_f32_16x16x32_bf16 v[224:227], a[116:119], a[12:15], v[224:227]
buffer_load_dwordx4 a[60:63], v2, s[40:43], s35 offen offset:3072 sc1
s_add_u32 s35, s35, 4096
v_mfma_f32_16x16x32_bf16 v[200:203], a[116:119], a[8:11], v[200:203]
v_mfma_f32_16x16x32_bf16 v[176:179], a[116:119], a[4:7], v[176:179]
v_mfma_f32_16x16x32_bf16 v[152:155], a[116:119], a[0:3], v[152:155]
s_waitcnt vmcnt(10) lgkmcnt(0)
v_mfma_f32_16x16x32_bf16 v[132:135], a[128:131], a[16:19], v[132:135]
ds_read_b128 a[96:99], v5 offset:36864
v_mfma_f32_16x16x32_bf16 v[156:159], a[128:131], a[20:23], v[156:159]
buffer_load_dwordx4 a[0:3], v2, s[40:43], s35 offen offset:0 sc1
v_mfma_f32_16x16x32_bf16 v[180:183], a[128:131], a[24:27], v[180:183]
ds_read_b128 a[100:103], v5 offset:37888
v_mfma_f32_16x16x32_bf16 v[204:207], a[128:131], a[28:31], v[204:207]
v_mfma_f32_16x16x32_bf16 v[208:211], a[132:135], a[28:31], v[208:211]
v_mfma_f32_16x16x32_bf16 v[184:187], a[132:135], a[24:27], v[184:187]
buffer_load_dwordx4 a[4:7], v2, s[40:43], s35 offen offset:1024 sc1
v_mfma_f32_16x16x32_bf16 v[160:163], a[132:135], a[20:23], v[160:163]
ds_read_b128 a[104:107], v5 offset:38912
v_mfma_f32_16x16x32_bf16 v[136:139], a[132:135], a[16:19], v[136:139]
v_mfma_f32_16x16x32_bf16 v[140:143], a[136:139], a[16:19], v[140:143]
ds_read_b128 a[108:111], v5 offset:39936
v_mfma_f32_16x16x32_bf16 v[164:167], a[136:139], a[20:23], v[164:167]
v_mfma_f32_16x16x32_bf16 v[188:191], a[136:139], a[24:27], v[188:191]
buffer_load_dwordx4 v1, s[4:7], s44 offen offset:1024 sc1 lds
v_mfma_f32_16x16x32_bf16 v[212:215], a[136:139], a[28:31], v[212:215]
ds_read_b128 a[112:115], v5 offset:40960
v_mfma_f32_16x16x32_bf16 v[216:219], a[140:143], a[28:31], v[216:219]
v_mfma_f32_16x16x32_bf16 v[192:195], a[140:143], a[24:27], v[192:195]
ds_read_b128 a[116:119], v5 offset:41984
v_mfma_f32_16x16x32_bf16 v[168:171], a[140:143], a[20:23], v[168:171]
v_mfma_f32_16x16x32_bf16 v[144:147], a[140:143], a[16:19], v[144:147]
buffer_load_dwordx4 a[8:11], v2, s[40:43], s35 offen offset:2048 sc1
v_mfma_f32_16x16x32_bf16 v[148:151], a[144:147], a[16:19], v[148:151]
v_mfma_f32_16x16x32_bf16 v[172:175], a[144:147], a[20:23], v[172:175]
v_mfma_f32_16x16x32_bf16 v[196:199], a[144:147], a[24:27], v[196:199]
v_mfma_f32_16x16x32_bf16 v[220:223], a[144:147], a[28:31], v[220:223]
v_mfma_f32_16x16x32_bf16 v[224:227], a[148:151], a[28:31], v[224:227]
buffer_load_dwordx4 a[12:15], v2, s[40:43], s35 offen offset:3072 sc1
s_add_u32 s35, s35, 4096
v_mfma_f32_16x16x32_bf16 v[200:203], a[148:151], a[24:27], v[200:203]
v_mfma_f32_16x16x32_bf16 v[176:179], a[148:151], a[20:23], v[176:179]
v_mfma_f32_16x16x32_bf16 v[152:155], a[148:151], a[16:19], v[152:155]
s_waitcnt vmcnt(10) lgkmcnt(0)
v_mfma_f32_16x16x32_bf16 v[132:135], a[96:99], a[32:35], v[132:135]
ds_read_b128 a[128:131], v5 offset:43008
v_add_f32 v92, v92, v96
v_mfma_f32_16x16x32_bf16 v[156:159], a[96:99], a[36:39], v[156:159]
buffer_load_dwordx4 a[16:19], v2, s[40:43], s35 offen offset:0 sc1
v_mfma_f32_16x16x32_bf16 v[180:183], a[96:99], a[40:43], v[180:183]
ds_read_b128 a[132:135], v5 offset:44032
v_add_f32 v100, v100, v104
v_mfma_f32_16x16x32_bf16 v[204:207], a[96:99], a[44:47], v[204:207]
v_add_f32 v108, v108, v112
v_add_f32 v116, v116, v120
v_mfma_f32_16x16x32_bf16 v[208:211], a[100:103], a[44:47], v[208:211]
v_add_f32 v93, v93, v97
v_add_f32 v101, v101, v105
v_mfma_f32_16x16x32_bf16 v[184:187], a[100:103], a[40:43], v[184:187]
buffer_load_dwordx4 a[20:23], v2, s[40:43], s35 offen offset:1024 sc1
v_mfma_f32_16x16x32_bf16 v[160:163], a[100:103], a[36:39], v[160:163]
ds_read_b128 a[136:139], v5 offset:45056
v_add_f32 v109, v109, v113
v_mfma_f32_16x16x32_bf16 v[136:139], a[100:103], a[32:35], v[136:139]
v_add_f32 v117, v117, v121
v_add_f32 v94, v94, v98
v_mfma_f32_16x16x32_bf16 v[140:143], a[104:107], a[32:35], v[140:143]
ds_read_b128 a[140:143], v5 offset:46080
v_add_f32 v102, v102, v106
v_mfma_f32_16x16x32_bf16 v[164:167], a[104:107], a[36:39], v[164:167]
v_add_f32 v110, v110, v114
v_mfma_f32_16x16x32_bf16 v[188:191], a[104:107], a[40:43], v[188:191]
buffer_load_dwordx4 v1, s[4:7], s44 offen offset:2048 sc1 lds
s_add_u32 m0, s18, 0x9000
v_mfma_f32_16x16x32_bf16 v[212:215], a[104:107], a[44:47], v[212:215]
s_add_u32 s44, s50, 0x142d000
ds_read_b128 a[144:147], v5 offset:47104
v_mfma_f32_16x16x32_bf16 v[216:219], a[108:111], a[44:47], v[216:219]
v_add_f32 v118, v118, v122
v_add_f32 v95, v95, v99
v_mfma_f32_16x16x32_bf16 v[192:195], a[108:111], a[40:43], v[192:195]
ds_read_b128 a[148:151], v5 offset:48128
v_add_f32 v103, v103, v107
v_mfma_f32_16x16x32_bf16 v[168:171], a[108:111], a[36:39], v[168:171]
v_add_f32 v111, v111, v115
v_add_f32 v119, v119, v123
v_mfma_f32_16x16x32_bf16 v[144:147], a[108:111], a[32:35], v[144:147]
buffer_load_dwordx4 a[24:27], v2, s[40:43], s35 offen offset:2048 sc1
v_mfma_f32_16x16x32_bf16 v[148:151], a[112:115], a[32:35], v[148:151]
v_add_f32_dpp v92, v92, v92 row_ror:8 row_mask:0xf bank_mask:0xf
v_add_f32_dpp v100, v100, v100 row_ror:8 row_mask:0xf bank_mask:0xf
v_mfma_f32_16x16x32_bf16 v[172:175], a[112:115], a[36:39], v[172:175]
v_add_f32_dpp v108, v108, v108 row_ror:8 row_mask:0xf bank_mask:0xf
v_mfma_f32_16x16x32_bf16 v[196:199], a[112:115], a[40:43], v[196:199]
v_add_f32_dpp v116, v116, v116 row_ror:8 row_mask:0xf bank_mask:0xf
v_mfma_f32_16x16x32_bf16 v[220:223], a[112:115], a[44:47], v[220:223]
v_add_f32_dpp v93, v93, v93 row_ror:8 row_mask:0xf bank_mask:0xf
v_mfma_f32_16x16x32_bf16 v[224:227], a[116:119], a[44:47], v[224:227]
buffer_load_dwordx4 a[28:31], v2, s[40:43], s35 offen offset:3072 sc1
s_add_u32 s35, s35, 4096
v_mfma_f32_16x16x32_bf16 v[200:203], a[116:119], a[40:43], v[200:203]
v_add_f32_dpp v101, v101, v101 row_ror:8 row_mask:0xf bank_mask:0xf
v_add_f32_dpp v109, v109, v109 row_ror:8 row_mask:0xf bank_mask:0xf
v_mfma_f32_16x16x32_bf16 v[176:179], a[116:119], a[36:39], v[176:179]
v_add_f32_dpp v117, v117, v117 row_ror:8 row_mask:0xf bank_mask:0xf
v_mfma_f32_16x16x32_bf16 v[152:155], a[116:119], a[32:35], v[152:155]
s_waitcnt vmcnt(10) lgkmcnt(0)
s_barrier
v_mfma_f32_16x16x32_bf16 v[132:135], a[128:131], a[48:51], v[132:135]
v_add_u32 v5, 0, v1
v_add_f32_dpp v92, v94, v94 row_ror:8 row_mask:0xf bank_mask:0xc
v_mfma_f32_16x16x32_bf16 v[156:159], a[128:131], a[52:55], v[156:159]
buffer_load_dwordx4 a[32:35], v2, s[40:43], s35 offen offset:0 sc1
v_mfma_f32_16x16x32_bf16 v[180:183], a[128:131], a[56:59], v[180:183]
ds_read_b128 a[96:99], v5 offset:0
v_add_f32_dpp v100, v102, v102 row_ror:8 row_mask:0xf bank_mask:0xc
v_mfma_f32_16x16x32_bf16 v[204:207], a[128:131], a[60:63], v[204:207]
ds_read_b128 a[100:103], v5 offset:1024
v_add_f32_dpp v108, v110, v110 row_ror:8 row_mask:0xf bank_mask:0xc
v_mfma_f32_16x16x32_bf16 v[208:211], a[132:135], a[60:63], v[208:211]
v_add_f32_dpp v116, v118, v118 row_ror:8 row_mask:0xf bank_mask:0xc
v_add_f32_dpp v93, v95, v95 row_ror:8 row_mask:0xf bank_mask:0xc
v_mfma_f32_16x16x32_bf16 v[184:187], a[132:135], a[56:59], v[184:187]
buffer_load_dwordx4 a[36:39], v2, s[40:43], s35 offen offset:1024 sc1
v_mfma_f32_16x16x32_bf16 v[160:163], a[132:135], a[52:55], v[160:163]
ds_read_b128 a[104:107], v5 offset:2048
v_add_f32_dpp v101, v103, v103 row_ror:8 row_mask:0xf bank_mask:0xc
v_mfma_f32_16x16x32_bf16 v[136:139], a[132:135], a[48:51], v[136:139]
v_add_f32_dpp v109, v111, v111 row_ror:8 row_mask:0xf bank_mask:0xc
v_add_f32_dpp v117, v119, v119 row_ror:8 row_mask:0xf bank_mask:0xc
v_mfma_f32_16x16x32_bf16 v[140:143], a[136:139], a[48:51], v[140:143]
ds_read_b128 a[108:111], v5 offset:3072
v_mfma_f32_16x16x32_bf16 v[164:167], a[136:139], a[52:55], v[164:167]
v_permlane32_swap_b32 v92, v93
v_mfma_f32_16x16x32_bf16 v[188:191], a[136:139], a[56:59], v[188:191]
buffer_load_dwordx4 v1, s[4:7], s44 offen offset:0 sc1 lds
v_mfma_f32_16x16x32_bf16 v[212:215], a[136:139], a[60:63], v[212:215]
ds_read_b128 a[112:115], v5 offset:4096
v_mfma_f32_16x16x32_bf16 v[216:219], a[140:143], a[60:63], v[216:219]
v_permlane32_swap_b32 v100, v101
v_mfma_f32_16x16x32_bf16 v[192:195], a[140:143], a[56:59], v[192:195]
ds_read_b128 a[116:119], v5 offset:5120
v_mfma_f32_16x16x32_bf16 v[168:171], a[140:143], a[52:55], v[168:171]
v_permlane32_swap_b32 v108, v109
v_mfma_f32_16x16x32_bf16 v[144:147], a[140:143], a[48:51], v[144:147]
buffer_load_dwordx4 a[40:43], v2, s[40:43], s35 offen offset:2048 sc1
v_mfma_f32_16x16x32_bf16 v[148:151], a[144:147], a[48:51], v[148:151]
v_permlane32_swap_b32 v116, v117
v_mfma_f32_16x16x32_bf16 v[172:175], a[144:147], a[52:55], v[172:175]
v_add_f32 v92, v92, v93
v_add_f32 v100, v100, v101
v_mfma_f32_16x16x32_bf16 v[196:199], a[144:147], a[56:59], v[196:199]
v_add_f32 v108, v108, v109
v_add_f32 v116, v116, v117
v_mfma_f32_16x16x32_bf16 v[220:223], a[144:147], a[60:63], v[220:223]
v_mov_b32 v94, v92
v_mov_b32 v102, v100
v_mfma_f32_16x16x32_bf16 v[224:227], a[148:151], a[60:63], v[224:227]
buffer_load_dwordx4 a[44:47], v2, s[40:43], s35 offen offset:3072 sc1
s_add_u32 s35, s35, 4096
v_mfma_f32_16x16x32_bf16 v[200:203], a[148:151], a[56:59], v[200:203]
v_mov_b32 v110, v108
v_mov_b32 v118, v116
v_mfma_f32_16x16x32_bf16 v[176:179], a[148:151], a[52:55], v[176:179]
v_permlane16_swap_b32 v92, v94
v_mfma_f32_16x16x32_bf16 v[152:155], a[148:151], a[48:51], v[152:155]
s_waitcnt vmcnt(10) lgkmcnt(0)
v_mfma_f32_16x16x32_bf16 v[132:135], a[96:99], a[0:3], v[132:135]
ds_read_b128 a[128:131], v5 offset:6144
v_mfma_f32_16x16x32_bf16 v[156:159], a[96:99], a[4:7], v[156:159]
buffer_load_dwordx4 a[48:51], v2, s[40:43], s35 offen offset:0 sc1
v_mfma_f32_16x16x32_bf16 v[180:183], a[96:99], a[8:11], v[180:183]
ds_read_b128 a[132:135], v5 offset:7168
v_mfma_f32_16x16x32_bf16 v[204:207], a[96:99], a[12:15], v[204:207]
v_permlane16_swap_b32 v100, v102
v_mfma_f32_16x16x32_bf16 v[208:211], a[100:103], a[12:15], v[208:211]
v_permlane16_swap_b32 v108, v110
v_mfma_f32_16x16x32_bf16 v[184:187], a[100:103], a[8:11], v[184:187]
buffer_load_dwordx4 a[52:55], v2, s[40:43], s35 offen offset:1024 sc1
v_mfma_f32_16x16x32_bf16 v[160:163], a[100:103], a[4:7], v[160:163]
ds_read_b128 a[136:139], v5 offset:8192
v_mfma_f32_16x16x32_bf16 v[136:139], a[100:103], a[0:3], v[136:139]
v_permlane16_swap_b32 v116, v118
v_mfma_f32_16x16x32_bf16 v[140:143], a[104:107], a[0:3], v[140:143]
ds_read_b128 a[140:143], v5 offset:9216
v_add_f32 v92, v92, v94
v_mfma_f32_16x16x32_bf16 v[164:167], a[104:107], a[4:7], v[164:167]
v_add_f32 v100, v100, v102
v_add_f32 v108, v108, v110
v_mfma_f32_16x16x32_bf16 v[188:191], a[104:107], a[8:11], v[188:191]
buffer_load_dwordx4 v1, s[4:7], s44 offen offset:1024 sc1 lds
v_mfma_f32_16x16x32_bf16 v[212:215], a[104:107], a[12:15], v[212:215]
ds_read_b128 a[144:147], v5 offset:10240
v_add_f32 v116, v116, v118
v_mfma_f32_16x16x32_bf16 v[216:219], a[108:111], a[12:15], v[216:219]
v_mov_b32 v94, v92
v_mov_b32 v102, v100
v_mfma_f32_16x16x32_bf16 v[192:195], a[108:111], a[8:11], v[192:195]
ds_read_b128 a[148:151], v5 offset:11264
v_mov_b32 v110, v108
v_mfma_f32_16x16x32_bf16 v[168:171], a[108:111], a[4:7], v[168:171]
v_mov_b32 v118, v116
v_mfma_f32_16x16x32_bf16 v[144:147], a[108:111], a[0:3], v[144:147]
buffer_load_dwordx4 a[56:59], v2, s[40:43], s35 offen offset:2048 sc1
v_mfma_f32_16x16x32_bf16 v[148:151], a[112:115], a[0:3], v[148:151]
v_permlane32_swap_b32 v92, v94
v_mfma_f32_16x16x32_bf16 v[172:175], a[112:115], a[4:7], v[172:175]
v_permlane32_swap_b32 v100, v102
v_mfma_f32_16x16x32_bf16 v[196:199], a[112:115], a[8:11], v[196:199]
v_permlane32_swap_b32 v108, v110
v_mfma_f32_16x16x32_bf16 v[220:223], a[112:115], a[12:15], v[220:223]
v_permlane32_swap_b32 v116, v118
v_mfma_f32_16x16x32_bf16 v[224:227], a[116:119], a[12:15], v[224:227]
buffer_load_dwordx4 a[60:63], v2, s[40:43], s35 offen offset:3072 sc1
s_add_u32 s35, s35, 4096
v_mfma_f32_16x16x32_bf16 v[200:203], a[116:119], a[8:11], v[200:203]
v_mul_f32 v82, 0xba800000, v92
v_mfma_f32_16x16x32_bf16 v[176:179], a[116:119], a[4:7], v[176:179]
v_mul_f32 v84, 0xba800000, v100
v_mfma_f32_16x16x32_bf16 v[152:155], a[116:119], a[0:3], v[152:155]
v_mul_f32 v86, 0xba800000, v108
s_waitcnt vmcnt(10) lgkmcnt(0)
v_mfma_f32_16x16x32_bf16 v[132:135], a[128:131], a[16:19], v[132:135]
ds_read_b128 a[96:99], v5 offset:12288
v_mul_f32 v88, 0xba800000, v116
v_mfma_f32_16x16x32_bf16 v[156:159], a[128:131], a[20:23], v[156:159]
buffer_load_dwordx4 a[0:3], v2, s[40:43], s35 offen offset:0 sc1
v_mfma_f32_16x16x32_bf16 v[180:183], a[128:131], a[24:27], v[180:183]
ds_read_b128 a[100:103], v5 offset:13312
v_mul_f32 v94, 0x3a800000, v94
v_mfma_f32_16x16x32_bf16 v[204:207], a[128:131], a[28:31], v[204:207]
v_mul_f32 v102, 0x3a800000, v102
v_mul_f32 v110, 0x3a800000, v110
v_mfma_f32_16x16x32_bf16 v[208:211], a[132:135], a[28:31], v[208:211]
v_mul_f32 v118, 0x3a800000, v118
v_fma_f32 v94, -v82, v82, v94
v_mfma_f32_16x16x32_bf16 v[184:187], a[132:135], a[24:27], v[184:187]
buffer_load_dwordx4 a[4:7], v2, s[40:43], s35 offen offset:1024 sc1
v_mfma_f32_16x16x32_bf16 v[160:163], a[132:135], a[20:23], v[160:163]
ds_read_b128 a[104:107], v5 offset:14336
v_fma_f32 v102, -v84, v84, v102
v_mfma_f32_16x16x32_bf16 v[136:139], a[132:135], a[16:19], v[136:139]
v_fma_f32 v110, -v86, v86, v110
v_fma_f32 v118, -v88, v88, v118
v_mfma_f32_16x16x32_bf16 v[140:143], a[136:139], a[16:19], v[140:143]
ds_read_b128 a[108:111], v5 offset:15360
v_max_f32 v94, 0, v94
v_mfma_f32_16x16x32_bf16 v[164:167], a[136:139], a[20:23], v[164:167]
v_max_f32 v102, 0, v102
v_mfma_f32_16x16x32_bf16 v[188:191], a[136:139], a[24:27], v[188:191]
buffer_load_dwordx4 v1, s[4:7], s44 offen offset:2048 sc1 lds
s_add_u32 m0, s19, 49152
v_mfma_f32_16x16x32_bf16 v[212:215], a[136:139], a[28:31], v[212:215]
s_add_u32 s44, s85, 0xc04000
ds_read_b128 a[112:115], v5 offset:16384
v_mfma_f32_16x16x32_bf16 v[216:219], a[140:143], a[28:31], v[216:219]
v_max_f32 v110, 0, v110
v_max_f32 v118, 0, v118
v_mfma_f32_16x16x32_bf16 v[192:195], a[140:143], a[24:27], v[192:195]
ds_read_b128 a[116:119], v5 offset:17408
v_add_f32 v94, 0x3727c5ac, v94
v_mfma_f32_16x16x32_bf16 v[168:171], a[140:143], a[20:23], v[168:171]
v_add_f32 v102, 0x3727c5ac, v102
v_add_f32 v110, 0x3727c5ac, v110
v_mfma_f32_16x16x32_bf16 v[144:147], a[140:143], a[16:19], v[144:147]
buffer_load_dwordx4 a[8:11], v2, s[40:43], s35 offen offset:2048 sc1
v_mfma_f32_16x16x32_bf16 v[148:151], a[144:147], a[16:19], v[148:151]
v_add_f32 v118, 0x3727c5ac, v118
v_mfma_f32_16x16x32_bf16 v[172:175], a[144:147], a[20:23], v[172:175]
v_rsq_f32 v83, v94
v_mfma_f32_16x16x32_bf16 v[196:199], a[144:147], a[24:27], v[196:199]
v_rsq_f32 v85, v102
v_mfma_f32_16x16x32_bf16 v[220:223], a[144:147], a[28:31], v[220:223]
v_mfma_f32_16x16x32_bf16 v[224:227], a[148:151], a[28:31], v[224:227]
buffer_load_dwordx4 a[12:15], v2, s[40:43], s35 offen offset:3072 sc1
s_add_u32 s35, s35, 4096
v_mfma_f32_16x16x32_bf16 v[200:203], a[148:151], a[24:27], v[200:203]
v_rsq_f32 v87, v110
v_mfma_f32_16x16x32_bf16 v[176:179], a[148:151], a[20:23], v[176:179]
v_rsq_f32 v89, v118
v_mfma_f32_16x16x32_bf16 v[152:155], a[148:151], a[16:19], v[152:155]
s_waitcnt vmcnt(10) lgkmcnt(0)
v_mfma_f32_16x16x32_bf16 v[132:135], a[96:99], a[32:35], v[132:135]
ds_read_b128 a[128:131], v5 offset:18432
v_mfma_f32_16x16x32_bf16 v[156:159], a[96:99], a[36:39], v[156:159]
buffer_load_dwordx4 a[16:19], v2, s[40:43], s35 offen offset:0 sc1
v_mfma_f32_16x16x32_bf16 v[180:183], a[96:99], a[40:43], v[180:183]
ds_read_b128 a[132:135], v5 offset:19456
v_mfma_f32_16x16x32_bf16 v[204:207], a[96:99], a[44:47], v[204:207]
v_mfma_f32_16x16x32_bf16 v[208:211], a[100:103], a[44:47], v[208:211]
v_mfma_f32_16x16x32_bf16 v[184:187], a[100:103], a[40:43], v[184:187]
buffer_load_dwordx4 a[20:23], v2, s[40:43], s35 offen offset:1024 sc1
v_mfma_f32_16x16x32_bf16 v[160:163], a[100:103], a[36:39], v[160:163]
ds_read_b128 a[136:139], v5 offset:20480
v_mfma_f32_16x16x32_bf16 v[136:139], a[100:103], a[32:35], v[136:139]
v_mfma_f32_16x16x32_bf16 v[140:143], a[104:107], a[32:35], v[140:143]
ds_read_b128 a[140:143], v5 offset:21504
v_mfma_f32_16x16x32_bf16 v[164:167], a[104:107], a[36:39], v[164:167]
v_fmac_f32 v132, v48, v82
v_mfma_f32_16x16x32_bf16 v[188:191], a[104:107], a[40:43], v[188:191]
buffer_load_dwordx4 v1, s[4:7], s44 offen offset:0 sc1 lds
v_mfma_f32_16x16x32_bf16 v[212:215], a[104:107], a[44:47], v[212:215]
ds_read_b128 a[144:147], v5 offset:22528
v_fmac_f32 v156, v48, v84
v_mfma_f32_16x16x32_bf16 v[216:219], a[108:111], a[44:47], v[216:219]
v_fmac_f32 v180, v48, v86
v_fmac_f32 v204, v48, v88
v_mfma_f32_16x16x32_bf16 v[192:195], a[108:111], a[40:43], v[192:195]
ds_read_b128 a[148:151], v5 offset:23552
v_fmac_f32 v208, v52, v88
v_mfma_f32_16x16x32_bf16 v[168:171], a[108:111], a[36:39], v[168:171]
v_fmac_f32 v184, v52, v86
v_mfma_f32_16x16x32_bf16 v[144:147], a[108:111], a[32:35], v[144:147]
buffer_load_dwordx4 a[24:27], v2, s[40:43], s35 offen offset:2048 sc1
v_mfma_f32_16x16x32_bf16 v[148:151], a[112:115], a[32:35], v[148:151]
v_fmac_f32 v160, v52, v84
v_fmac_f32 v136, v52, v82
v_mfma_f32_16x16x32_bf16 v[172:175], a[112:115], a[36:39], v[172:175]
v_fmac_f32 v140, v56, v82
v_mfma_f32_16x16x32_bf16 v[196:199], a[112:115], a[40:43], v[196:199]
v_fmac_f32 v164, v56, v84
v_mfma_f32_16x16x32_bf16 v[220:223], a[112:115], a[44:47], v[220:223]
v_fmac_f32 v188, v56, v86
v_mfma_f32_16x16x32_bf16 v[224:227], a[116:119], a[44:47], v[224:227]
buffer_load_dwordx4 a[28:31], v2, s[40:43], s35 offen offset:3072 sc1
s_add_u32 s35, s35, 4096
v_mfma_f32_16x16x32_bf16 v[200:203], a[116:119], a[40:43], v[200:203]
v_fmac_f32 v212, v56, v88
v_fmac_f32 v216, v60, v88
v_mfma_f32_16x16x32_bf16 v[176:179], a[116:119], a[36:39], v[176:179]
v_fmac_f32 v192, v60, v86
v_mfma_f32_16x16x32_bf16 v[152:155], a[116:119], a[32:35], v[152:155]
s_waitcnt vmcnt(7) lgkmcnt(0)
s_barrier
v_mfma_f32_16x16x32_bf16 v[132:135], a[128:131], a[48:51], v[132:135]
ds_read_b128 a[96:99], v5 offset:24576
v_fmac_f32 v168, v60, v84
v_mfma_f32_16x16x32_bf16 v[156:159], a[128:131], a[52:55], v[156:159]
buffer_load_dwordx4 a[32:35], v2, s[40:43], s35 offen offset:0 sc1
v_mfma_f32_16x16x32_bf16 v[180:183], a[128:131], a[56:59], v[180:183]
ds_read_b128 a[100:103], v5 offset:25600
v_fmac_f32 v144, v60, v82
v_mfma_f32_16x16x32_bf16 v[204:207], a[128:131], a[60:63], v[204:207]
v_fmac_f32 v148, v64, v82
v_fmac_f32 v172, v64, v84
v_mfma_f32_16x16x32_bf16 v[208:211], a[132:135], a[60:63], v[208:211]
v_fmac_f32 v196, v64, v86
v_fmac_f32 v220, v64, v88
v_mfma_f32_16x16x32_bf16 v[184:187], a[132:135], a[56:59], v[184:187]
buffer_load_dwordx4 a[36:39], v2, s[40:43], s35 offen offset:1024 sc1
v_mfma_f32_16x16x32_bf16 v[160:163], a[132:135], a[52:55], v[160:163]
ds_read_b128 a[104:107], v5 offset:26624
v_fmac_f32 v224, v68, v88
v_mfma_f32_16x16x32_bf16 v[136:139], a[132:135], a[48:51], v[136:139]
v_fmac_f32 v200, v68, v86
v_fmac_f32 v176, v68, v84
v_mfma_f32_16x16x32_bf16 v[140:143], a[136:139], a[48:51], v[140:143]
ds_read_b128 a[108:111], v5 offset:27648
v_fmac_f32 v152, v68, v82
v_mfma_f32_16x16x32_bf16 v[164:167], a[136:139], a[52:55], v[164:167]
v_fmac_f32 v133, v49, v82
v_mfma_f32_16x16x32_bf16 v[188:191], a[136:139], a[56:59], v[188:191]
buffer_load_dwordx4 v1, s[4:7], s44 offen offset:1024 sc1 lds
v_mfma_f32_16x16x32_bf16 v[212:215], a[136:139], a[60:63], v[212:215]
ds_read_b128 a[112:115], v5 offset:28672
v_fmac_f32 v157, v49, v84
v_mfma_f32_16x16x32_bf16 v[216:219], a[140:143], a[60:63], v[216:219]
v_fmac_f32 v181, v49, v86
v_fmac_f32 v205, v49, v88
v_mfma_f32_16x16x32_bf16 v[192:195], a[140:143], a[56:59], v[192:195]
ds_read_b128 a[116:119], v5 offset:29696
v_fmac_f32 v209, v53, v88
v_mfma_f32_16x16x32_bf16 v[168:171], a[140:143], a[52:55], v[168:171]
v_fmac_f32 v185, v53, v86
v_mfma_f32_16x16x32_bf16 v[144:147], a[140:143], a[48:51], v[144:147]
buffer_load_dwordx4 a[40:43], v2, s[40:43], s35 offen offset:2048 sc1
v_mfma_f32_16x16x32_bf16 v[148:151], a[144:147], a[48:51], v[148:151]
v_fmac_f32 v161, v53, v84
v_fmac_f32 v137, v53, v82
v_mfma_f32_16x16x32_bf16 v[172:175], a[144:147], a[52:55], v[172:175]
v_fmac_f32 v141, v57, v82
v_mfma_f32_16x16x32_bf16 v[196:199], a[144:147], a[56:59], v[196:199]
v_fmac_f32 v165, v57, v84
v_mfma_f32_16x16x32_bf16 v[220:223], a[144:147], a[60:63], v[220:223]
v_fmac_f32 v189, v57, v86
v_mfma_f32_16x16x32_bf16 v[224:227], a[148:151], a[60:63], v[224:227]
buffer_load_dwordx4 a[44:47], v2, s[40:43], s35 offen offset:3072 sc1
s_add_u32 s35, s35, 4096
v_mfma_f32_16x16x32_bf16 v[200:203], a[148:151], a[56:59], v[200:203]
v_fmac_f32 v213, v57, v88
v_fmac_f32 v217, v61, v88
v_mfma_f32_16x16x32_bf16 v[176:179], a[148:151], a[52:55], v[176:179]
v_fmac_f32 v193, v61, v86
v_mfma_f32_16x16x32_bf16 v[152:155], a[148:151], a[48:51], v[152:155]
v_fmac_f32 v169, v61, v84
s_waitcnt vmcnt(10) lgkmcnt(0)
v_mfma_f32_16x16x32_bf16 v[132:135], a[96:99], a[0:3], v[132:135]
ds_read_b128 a[128:131], v5 offset:30720
v_fmac_f32 v145, v61, v82
v_mfma_f32_16x16x32_bf16 v[156:159], a[96:99], a[4:7], v[156:159]
buffer_load_dwordx4 a[48:51], v2, s[40:43], s35 offen offset:0 sc1
v_mfma_f32_16x16x32_bf16 v[180:183], a[96:99], a[8:11], v[180:183]
ds_read_b128 a[132:135], v5 offset:31744
v_fmac_f32 v149, v65, v82
v_mfma_f32_16x16x32_bf16 v[204:207], a[96:99], a[12:15], v[204:207]
v_fmac_f32 v173, v65, v84
v_fmac_f32 v197, v65, v86
v_mfma_f32_16x16x32_bf16 v[208:211], a[100:103], a[12:15], v[208:211]
L_stub17:
s_cbranch_execz L_stub18
v_fmac_f32 v221, v65, v88
v_mfma_f32_16x16x32_bf16 v[184:187], a[100:103], a[8:11], v[184:187]
buffer_load_dwordx4 a[52:55], v2, s[40:43], s35 offen offset:1024 sc1
v_mfma_f32_16x16x32_bf16 v[160:163], a[100:103], a[4:7], v[160:163]
ds_read_b128 a[136:139], v5 offset:32768
v_fmac_f32 v225, v69, v88
v_mfma_f32_16x16x32_bf16 v[136:139], a[100:103], a[0:3], v[136:139]
v_fmac_f32 v201, v69, v86
v_fmac_f32 v177, v69, v84
v_mfma_f32_16x16x32_bf16 v[140:143], a[104:107], a[0:3], v[140:143]
ds_read_b128 a[140:143], v5 offset:33792
v_fmac_f32 v153, v69, v82
v_mfma_f32_16x16x32_bf16 v[164:167], a[104:107], a[4:7], v[164:167]
v_fmac_f32 v134, v50, v82
v_mfma_f32_16x16x32_bf16 v[188:191], a[104:107], a[8:11], v[188:191]
buffer_load_dwordx4 v1, s[4:7], s44 offen offset:2048 sc1 lds
v_mfma_f32_16x16x32_bf16 v[212:215], a[104:107], a[12:15], v[212:215]
ds_read_b128 a[144:147], v5 offset:34816
v_fmac_f32 v158, v50, v84
v_mfma_f32_16x16x32_bf16 v[216:219], a[108:111], a[12:15], v[216:219]
v_fmac_f32 v182, v50, v86
v_fmac_f32 v206, v50, v88
v_mfma_f32_16x16x32_bf16 v[192:195], a[108:111], a[8:11], v[192:195]
ds_read_b128 a[148:151], v5 offset:35840
v_fmac_f32 v210, v54, v88
v_mfma_f32_16x16x32_bf16 v[168:171], a[108:111], a[4:7], v[168:171]
v_fmac_f32 v186, v54, v86
v_mfma_f32_16x16x32_bf16 v[144:147], a[108:111], a[0:3], v[144:147]
buffer_load_dwordx4 a[56:59], v2, s[40:43], s35 offen offset:2048 sc1
v_mfma_f32_16x16x32_bf16 v[148:151], a[112:115], a[0:3], v[148:151]
v_fmac_f32 v162, v54, v84
v_fmac_f32 v138, v54, v82
v_mfma_f32_16x16x32_bf16 v[172:175], a[112:115], a[4:7], v[172:175]
v_fmac_f32 v142, v58, v82
v_mfma_f32_16x16x32_bf16 v[196:199], a[112:115], a[8:11], v[196:199]
v_fmac_f32 v166, v58, v84
v_mfma_f32_16x16x32_bf16 v[220:223], a[112:115], a[12:15], v[220:223]
v_fmac_f32 v190, v58, v86
v_mfma_f32_16x16x32_bf16 v[224:227], a[116:119], a[12:15], v[224:227]
buffer_load_dwordx4 a[60:63], v2, s[40:43], s35 offen offset:3072 sc1
s_add_u32 s35, s35, 4096
v_mfma_f32_16x16x32_bf16 v[200:203], a[116:119], a[8:11], v[200:203]
v_fmac_f32 v214, v58, v88
v_fmac_f32 v218, v62, v88
v_mfma_f32_16x16x32_bf16 v[176:179], a[116:119], a[4:7], v[176:179]
v_fmac_f32 v194, v62, v86
v_mfma_f32_16x16x32_bf16 v[152:155], a[116:119], a[0:3], v[152:155]
v_fmac_f32 v170, v62, v84
s_waitcnt vmcnt(10) lgkmcnt(0)
v_mfma_f32_16x16x32_bf16 v[132:135], a[128:131], a[16:19], v[132:135]
ds_read_b128 a[96:99], v5 offset:36864
v_fmac_f32 v146, v62, v82
v_mfma_f32_16x16x32_bf16 v[156:159], a[128:131], a[20:23], v[156:159]
buffer_load_dwordx4 v1, s[4:7], s44 offen offset:3072 sc1 lds
s_add_u32 m0, s19, 65536
v_mfma_f32_16x16x32_bf16 v[180:183], a[128:131], a[24:27], v[180:183]
s_add_u32 s44, s84, 0xc08000
ds_read_b128 a[100:103], v5 offset:37888
v_mfma_f32_16x16x32_bf16 v[204:207], a[128:131], a[28:31], v[204:207]
v_fmac_f32 v150, v66, v82
v_fmac_f32 v174, v66, v84
v_mfma_f32_16x16x32_bf16 v[208:211], a[132:135], a[28:31], v[208:211]
v_fmac_f32 v198, v66, v86
v_fmac_f32 v222, v66, v88
v_mfma_f32_16x16x32_bf16 v[184:187], a[132:135], a[24:27], v[184:187]
buffer_load_dwordx4 v1, s[4:7], s44 offen offset:0 sc1 lds
v_mfma_f32_16x16x32_bf16 v[160:163], a[132:135], a[20:23], v[160:163]
ds_read_b128 a[104:107], v5 offset:38912
v_fmac_f32 v226, v70, v88
v_mfma_f32_16x16x32_bf16 v[136:139], a[132:135], a[16:19], v[136:139]
v_fmac_f32 v202, v70, v86
v_fmac_f32 v178, v70, v84
v_mfma_f32_16x16x32_bf16 v[140:143], a[136:139], a[16:19], v[140:143]
ds_read_b128 a[108:111], v5 offset:39936
v_fmac_f32 v154, v70, v82
v_mfma_f32_16x16x32_bf16 v[164:167], a[136:139], a[20:23], v[164:167]
v_fmac_f32 v135, v51, v82
v_mfma_f32_16x16x32_bf16 v[188:191], a[136:139], a[24:27], v[188:191]
buffer_load_dwordx4 v1, s[4:7], s44 offen offset:1024 sc1 lds
v_mfma_f32_16x16x32_bf16 v[212:215], a[136:139], a[28:31], v[212:215]
ds_read_b128 a[112:115], v5 offset:40960
v_fmac_f32 v159, v51, v84
v_mfma_f32_16x16x32_bf16 v[216:219], a[140:143], a[28:31], v[216:219]
v_fmac_f32 v183, v51, v86
v_fmac_f32 v207, v51, v88
v_mfma_f32_16x16x32_bf16 v[192:195], a[140:143], a[24:27], v[192:195]
ds_read_b128 a[116:119], v5 offset:41984
v_fmac_f32 v211, v55, v88
v_mfma_f32_16x16x32_bf16 v[168:171], a[140:143], a[20:23], v[168:171]
v_fmac_f32 v187, v55, v86
v_mfma_f32_16x16x32_bf16 v[144:147], a[140:143], a[16:19], v[144:147]
buffer_load_dwordx4 v1, s[4:7], s44 offen offset:2048 sc1 lds
v_mfma_f32_16x16x32_bf16 v[148:151], a[144:147], a[16:19], v[148:151]
v_fmac_f32 v163, v55, v84
v_fmac_f32 v139, v55, v82
v_mfma_f32_16x16x32_bf16 v[172:175], a[144:147], a[20:23], v[172:175]
v_fmac_f32 v143, v59, v82
v_mfma_f32_16x16x32_bf16 v[196:199], a[144:147], a[24:27], v[196:199]
v_fmac_f32 v167, v59, v84
v_mfma_f32_16x16x32_bf16 v[220:223], a[144:147], a[28:31], v[220:223]
v_fmac_f32 v191, v59, v86
v_mfma_f32_16x16x32_bf16 v[224:227], a[148:151], a[28:31], v[224:227]
buffer_load_dwordx4 v1, s[4:7], s44 offen offset:3072 sc1 lds
s_add_u32 m0, s19, 81920
v_mfma_f32_16x16x32_bf16 v[200:203], a[148:151], a[24:27], v[200:203]
s_add_u32 s44, s85, 0xc0c000
v_fmac_f32 v215, v59, v88
v_mfma_f32_16x16x32_bf16 v[176:179], a[148:151], a[20:23], v[176:179]
v_fmac_f32 v219, v63, v88
v_fmac_f32 v195, v63, v86
v_mfma_f32_16x16x32_bf16 v[152:155], a[148:151], a[16:19], v[152:155]
v_fmac_f32 v171, v63, v84
s_waitcnt vmcnt(10) lgkmcnt(0)
v_mfma_f32_16x16x32_bf16 v[132:135], a[96:99], a[32:35], v[132:135]
ds_read_b128 a[128:131], v5 offset:43008
v_fmac_f32 v147, v63, v82
v_mfma_f32_16x16x32_bf16 v[156:159], a[96:99], a[36:39], v[156:159]
buffer_load_dwordx4 v1, s[4:7], s44 offen offset:0 sc1 lds
v_mfma_f32_16x16x32_bf16 v[180:183], a[96:99], a[40:43], v[180:183]
ds_read_b128 a[132:135], v5 offset:44032
v_fmac_f32 v151, v67, v82
v_mfma_f32_16x16x32_bf16 v[204:207], a[96:99], a[44:47], v[204:207]
v_fmac_f32 v175, v67, v84
v_fmac_f32 v199, v67, v86
v_mfma_f32_16x16x32_bf16 v[208:211], a[100:103], a[44:47], v[208:211]
v_fmac_f32 v223, v67, v88
v_mfma_f32_16x16x32_bf16 v[184:187], a[100:103], a[40:43], v[184:187]
buffer_load_dwordx4 v1, s[4:7], s44 offen offset:1024 sc1 lds
v_mfma_f32_16x16x32_bf16 v[160:163], a[100:103], a[36:39], v[160:163]
ds_read_b128 a[136:139], v5 offset:45056
v_fmac_f32 v227, v71, v88
v_mfma_f32_16x16x32_bf16 v[136:139], a[100:103], a[32:35], v[136:139]
v_fmac_f32 v203, v71, v86
v_fmac_f32 v179, v71, v84
v_mfma_f32_16x16x32_bf16 v[140:143], a[104:107], a[32:35], v[140:143]
ds_read_b128 a[140:143], v5 offset:46080
v_fmac_f32 v155, v71, v82
v_mfma_f32_16x16x32_bf16 v[164:167], a[104:107], a[36:39], v[164:167]
v_mfma_f32_16x16x32_bf16 v[188:191], a[104:107], a[40:43], v[188:191]
buffer_load_dwordx4 v1, s[4:7], s44 offen offset:2048 sc1 lds
v_mfma_f32_16x16x32_bf16 v[212:215], a[104:107], a[44:47], v[212:215]
ds_read_b128 a[144:147], v5 offset:47104
v_mfma_f32_16x16x32_bf16 v[216:219], a[108:111], a[44:47], v[216:219]
v_mfma_f32_16x16x32_bf16 v[192:195], a[108:111], a[40:43], v[192:195]
ds_read_b128 a[148:151], v5 offset:48128
v_mfma_f32_16x16x32_bf16 v[168:171], a[108:111], a[36:39], v[168:171]
v_mfma_f32_16x16x32_bf16 v[144:147], a[108:111], a[32:35], v[144:147]
buffer_load_dwordx4 v1, s[4:7], s44 offen offset:3072 sc1 lds
s_add_u32 m0, s19, 147456
v_mfma_f32_16x16x32_bf16 v[148:151], a[112:115], a[32:35], v[148:151]
s_add_u32 s44, s87, 0xc1c000
v_mfma_f32_16x16x32_bf16 v[172:175], a[112:115], a[36:39], v[172:175]
v_mfma_f32_16x16x32_bf16 v[196:199], a[112:115], a[40:43], v[196:199]
v_mfma_f32_16x16x32_bf16 v[220:223], a[112:115], a[44:47], v[220:223]
v_mfma_f32_16x16x32_bf16 v[224:227], a[116:119], a[44:47], v[224:227]
buffer_load_dwordx4 v1, s[4:7], s44 offen offset:0 sc1 lds
v_mfma_f32_16x16x32_bf16 v[200:203], a[116:119], a[40:43], v[200:203]
v_mfma_f32_16x16x32_bf16 v[176:179], a[116:119], a[36:39], v[176:179]
v_mfma_f32_16x16x32_bf16 v[152:155], a[116:119], a[32:35], v[152:155]
s_waitcnt vmcnt(10) lgkmcnt(0)
s_barrier
v_mfma_f32_16x16x32_bf16 v[132:135], a[128:131], a[48:51], v[132:135]
v_mfma_f32_16x16x32_bf16 v[156:159], a[128:131], a[52:55], v[156:159]
buffer_load_dwordx4 v1, s[4:7], s44 offen offset:1024 sc1 lds
v_mfma_f32_16x16x32_bf16 v[180:183], a[128:131], a[56:59], v[180:183]
v_mfma_f32_16x16x32_bf16 v[204:207], a[128:131], a[60:63], v[204:207]
v_mfma_f32_16x16x32_bf16 v[208:211], a[132:135], a[60:63], v[208:211]
v_mfma_f32_16x16x32_bf16 v[184:187], a[132:135], a[56:59], v[184:187]
v_mfma_f32_16x16x32_bf16 v[160:163], a[132:135], a[52:55], v[160:163]
v_mfma_f32_16x16x32_bf16 v[136:139], a[132:135], a[48:51], v[136:139]
v_mfma_f32_16x16x32_bf16 v[140:143], a[136:139], a[48:51], v[140:143]
v_mfma_f32_16x16x32_bf16 v[164:167], a[136:139], a[52:55], v[164:167]
buffer_load_dwordx4 v1, s[4:7], s44 offen offset:2048 sc1 lds
v_mfma_f32_16x16x32_bf16 v[188:191], a[136:139], a[56:59], v[188:191]
v_mfma_f32_16x16x32_bf16 v[212:215], a[136:139], a[60:63], v[212:215]
v_mfma_f32_16x16x32_bf16 v[216:219], a[140:143], a[60:63], v[216:219]
v_mfma_f32_16x16x32_bf16 v[192:195], a[140:143], a[56:59], v[192:195]
v_mfma_f32_16x16x32_bf16 v[168:171], a[140:143], a[52:55], v[168:171]
v_mfma_f32_16x16x32_bf16 v[144:147], a[140:143], a[48:51], v[144:147]
v_mfma_f32_16x16x32_bf16 v[148:151], a[144:147], a[48:51], v[148:151]
v_mfma_f32_16x16x32_bf16 v[172:175], a[144:147], a[52:55], v[172:175]
buffer_load_dwordx4 v1, s[4:7], s44 offen offset:3072 sc1 lds
v_mfma_f32_16x16x32_bf16 v[196:199], a[144:147], a[56:59], v[196:199]
v_mfma_f32_16x16x32_bf16 v[220:223], a[144:147], a[60:63], v[220:223]
v_mfma_f32_16x16x32_bf16 v[224:227], a[148:151], a[60:63], v[224:227]
v_mfma_f32_16x16x32_bf16 v[200:203], a[148:151], a[56:59], v[200:203]
v_mfma_f32_16x16x32_bf16 v[176:179], a[148:151], a[52:55], v[176:179]
v_mfma_f32_16x16x32_bf16 v[152:155], a[148:151], a[48:51], v[152:155]
.set L_cpf3, .
s_lshl_b32 s36, s28, 12
v_add_u32 v232, s36, v7
v_add_u32 v233, s36, v232
s_lshl_b32 s36, s28, 9
s_lshl_b32 s37, s30, 2
s_add_u32 s37, s37, s28
s_lshl_b32 s37, s37, 3
s_add_u32 s38, s37, s29
s_lshl_b32 s39, s38, 7
s_add_u32 s39, s39, 0x820000
s_lshl_b32 s38, s38, 10
s_add_u32 s38, s38, 0x400000
s_lshl_b32 s88, s28, 6
s_add_u32 s94, s80, s88
s_add_u32 s94, s94, 0x90000
s_add_u32 s88, s88, s70
s_add_u32 s89, s88, 0x90000
s_lshl_b32 s91, s30, 2
s_add_u32 s91, s91, s28
s_lshl_b32 s91, s91, 3
s_add_u32 s91, s91, s29
s_lshl_b32 s91, s91, 7
s_add_u32 s91, s91, 0x820000
buffer_store_dwordx4 a[228:231], v254, s[4:7], s91 offen offset:0 sc1
s_sub_u32 s91, s91, 0x820000
s_lshl_b32 s91, s91, 3
s_add_u32 s91, s91, 0x400000
s_add_u32 m0, s19, 98304
s_add_u32 s44, s84, 0xc10000
v_cvt_pk_bf16_f32 v140, v140, v141
v_cvt_pk_bf16_f32 v164, v164, v165
v_cvt_pk_bf16_f32 v141, v142, v143
v_cvt_pk_bf16_f32 v165, v166, v167
v_cvt_pk_bf16_f32 v142, v144, v145
v_cvt_pk_bf16_f32 v143, v146, v147
v_cvt_pk_bf16_f32 v166, v168, v169
v_cvt_pk_bf16_f32 v167, v170, v171
v_mfma_f32_16x16x32_bf16 v[92:95], a[232:235], v[140:143], 0
v_mul_f32 v240, 0x3fb8aa3b, v83
v_mul_f32 v246, 0x3fb8aa3b, v85
v_mfma_f32_16x16x32_bf16 v[108:111], a[232:235], v[164:167], 0
v_cvt_pk_bf16_f32 v188, v188, v189
v_cvt_pk_bf16_f32 v212, v212, v213
v_mfma_f32_16x16x32_bf16 v[96:99], a[236:239], v[140:143], 0
s_nop 1
v_max3_f32 v236, v92, v93, v94
v_max3_f32 v237, -v92, -v93, -v94
v_mfma_f32_16x16x32_bf16 v[112:115], a[236:239], v[164:167], 0
v_max3_f32 v242, v108, v109, v110
v_max3_f32 v243, -v108, -v109, -v110
v_cvt_pk_bf16_f32 v189, v190, v191
v_cvt_pk_bf16_f32 v213, v214, v215
v_max3_f32 v236, v236, v95, v96
v_max3_f32 v237, v237, -v95, -v96
v_max3_f32 v236, v236, v97, v98
buffer_store_dwordx4 a[228:231], v1, s[4:7], s91 offen offset:0 sc1
v_max3_f32 v242, v242, v111, v112
v_max3_f32 v243, v243, -v111, -v112
v_max3_f32 v237, v237, -v97, -v98
v_max3_f32 v242, v242, v113, v114
v_max3_f32 v243, v243, -v113, -v114
v_max_f32 v236, v236, v99
v_max_f32_e64 v237, v237, -v99
v_max_f32 v242, v242, v115
v_max_f32_e64 v243, v243, -v115
v_permlane32_swap_b32 v236, v237
s_nop 0
v_permlane32_swap_b32 v242, v243
v_max_f32 v236, v236, v237
v_max_f32 v242, v242, v243
v_mov_b32 v238, v236
v_mov_b32 v244, v242
v_pk_mul_f32 v[148:149], v[148:149], v[82:83] op_sel:[0,1] op_sel_hi:[1,1]
v_permlane16_swap_b32 v236, v238
v_permlane16_swap_b32 v242, v244
v_max_f32 v236, v236, v238
v_max_f32 v242, v242, v244
v_mov_b32 v238, v236
v_mov_b32 v244, v242
v_pk_mul_f32 v[172:173], v[172:173], v[84:85] op_sel:[0,1] op_sel_hi:[1,1]
v_permlane32_swap_b32 v236, v238
v_permlane32_swap_b32 v242, v244
v_mul_f32_e64 v236, -v236, v240
v_mul_f32_e64 v237, -v238, v240
v_mul_f32_e64 v242, -v242, v246
buffer_load_dwordx4 v1, s[4:7], s44 offen offset:0 sc1 lds
v_mul_f32_e64 v243, -v244, v246
v_pk_fma_f32 v[100:101], v[92:93], v[240:241], v[236:237] op_sel:[0,0,0] op_sel_hi:[1,0,0]
v_pk_fma_f32 v[102:103], v[94:95], v[240:241], v[236:237] op_sel:[0,0,0] op_sel_hi:[1,0,0]
v_pk_fma_f32 v[104:105], v[96:97], v[240:241], v[236:237] op_sel:[0,0,0] op_sel_hi:[1,0,0]
v_pk_fma_f32 v[106:107], v[98:99], v[240:241], v[236:237] op_sel:[0,0,0] op_sel_hi:[1,0,0]
v_pk_fma_f32 v[116:117], v[108:109], v[246:247], v[242:243] op_sel:[0,0,0] op_sel_hi:[1,0,0]
v_pk_fma_f32 v[118:119], v[110:111], v[246:247], v[242:243] op_sel:[0,0,0] op_sel_hi:[1,0,0]
v_pk_fma_f32 v[120:121], v[112:113], v[246:247], v[242:243] op_sel:[0,0,0] op_sel_hi:[1,0,0]
v_pk_fma_f32 v[122:123], v[114:115], v[246:247], v[242:243] op_sel:[0,0,0] op_sel_hi:[1,0,0]
v_pk_fma_f32 v[92:93], v[92:93], v[240:241], v[236:237] op_sel:[0,0,1] op_sel_hi:[1,0,1] neg_lo:[1,0,0] neg_hi:[1,0,0]
v_pk_fma_f32 v[94:95], v[94:95], v[240:241], v[236:237] op_sel:[0,0,1] op_sel_hi:[1,0,1] neg_lo:[1,0,0] neg_hi:[1,0,0]
v_pk_fma_f32 v[96:97], v[96:97], v[240:241], v[236:237] op_sel:[0,0,1] op_sel_hi:[1,0,1] neg_lo:[1,0,0] neg_hi:[1,0,0]
v_pk_fma_f32 v[98:99], v[98:99], v[240:241], v[236:237] op_sel:[0,0,1] op_sel_hi:[1,0,1] neg_lo:[1,0,0] neg_hi:[1,0,0]
v_pk_fma_f32 v[108:109], v[108:109], v[246:247], v[242:243] op_sel:[0,0,1] op_sel_hi:[1,0,1] neg_lo:[1,0,0] neg_hi:[1,0,0]
v_pk_fma_f32 v[110:111], v[110:111], v[246:247], v[242:243] op_sel:[0,0,1] op_sel_hi:[1,0,1] neg_lo:[1,0,0] neg_hi:[1,0,0]
v_pk_fma_f32 v[112:113], v[112:113], v[246:247], v[242:243] op_sel:[0,0,1] op_sel_hi:[1,0,1] neg_lo:[1,0,0] neg_hi:[1,0,0]
v_pk_fma_f32 v[114:115], v[114:115], v[246:247], v[242:243] op_sel:[0,0,1] op_sel_hi:[1,0,1] neg_lo:[1,0,0] neg_hi:[1,0,0]
v_exp_f32 v92, v92
v_exp_f32 v93, v93
v_exp_f32 v94, v94
v_exp_f32 v95, v95
v_exp_f32 v96, v96
buffer_load_dwordx4 v1, s[4:7], s44 offen offset:1024 sc1 lds
v_exp_f32 v97, v97
v_exp_f32 v98, v98
v_exp_f32 v99, v99
v_exp_f32 v108, v108
v_exp_f32 v109, v109
v_exp_f32 v110, v110
v_exp_f32 v111, v111
v_exp_f32 v112, v112
v_exp_f32 v113, v113
v_exp_f32 v114, v114
v_exp_f32 v115, v115
v_pk_mul_f32 v[150:151], v[150:151], v[82:83] op_sel:[0,1] op_sel_hi:[1,1]
v_pk_mul_f32 v[174:175], v[174:175], v[84:85] op_sel:[0,1] op_sel_hi:[1,1]
v_cvt_pk_bf16_f32 v144, v92, v93
v_cvt_pk_bf16_f32 v145, v94, v95
v_cvt_pk_bf16_f32 v146, v96, v97
buffer_load_dwordx4 v1, s[4:7], s44 offen offset:2048 sc1 lds
v_cvt_pk_bf16_f32 v147, v98, v99
v_cvt_pk_bf16_f32 v168, v108, v109
v_cvt_pk_bf16_f32 v169, v110, v111
v_cvt_pk_bf16_f32 v170, v112, v113
v_cvt_pk_bf16_f32 v171, v114, v115
v_cvt_pk_bf16_f32 v148, v148, v149
v_cvt_pk_bf16_f32 v172, v172, v173
v_pk_mul_f32 v[152:153], v[152:153], v[82:83] op_sel:[0,1] op_sel_hi:[1,1]
v_pk_mul_f32 v[154:155], v[154:155], v[82:83] op_sel:[0,1] op_sel_hi:[1,1]
v_pk_mul_f32 v[176:177], v[176:177], v[84:85] op_sel:[0,1] op_sel_hi:[1,1]
v_pk_mul_f32 v[178:179], v[178:179], v[84:85] op_sel:[0,1] op_sel_hi:[1,1]
v_cvt_pk_bf16_f32 v149, v150, v151
v_cvt_pk_bf16_f32 v173, v174, v175
v_cvt_pk_bf16_f32 v150, v152, v153
v_cvt_pk_bf16_f32 v151, v154, v155
v_cvt_pk_bf16_f32 v174, v176, v177
v_cvt_pk_bf16_f32 v175, v178, v179
v_mfma_f32_16x16x32_bf16 v[152:155], v[16:19], v[144:147], 0
v_cvt_pk_bf16_f32 v190, v192, v193
v_cvt_pk_bf16_f32 v191, v194, v195
v_mfma_f32_16x16x32_bf16 v[176:179], v[16:19], v[168:171], 0
v_cvt_pk_bf16_f32 v214, v216, v217
v_cvt_pk_bf16_f32 v215, v218, v219
v_exp_f32 v100, v100
buffer_load_dwordx4 v1, s[4:7], s44 offen offset:3072 sc1 lds
s_add_u32 m0, s19, 114688
s_add_u32 s44, s85, 0xc14000
s_lshl_b32 s91, s30, 12
s_add_u32 s91, s91, 0x2600000
v_rcp_f32 v152, v152
v_rcp_f32 v176, v176
v_pk_mul_f32 v[92:93], v[92:93], v[152:153] op_sel:[0,0] op_sel_hi:[1,0]
v_pk_mul_f32 v[94:95], v[94:95], v[152:153] op_sel:[0,0] op_sel_hi:[1,0]
v_pk_mul_f32 v[108:109], v[108:109], v[176:177] op_sel:[0,0] op_sel_hi:[1,0]
v_pk_mul_f32 v[110:111], v[110:111], v[176:177] op_sel:[0,0] op_sel_hi:[1,0]
v_pk_mul_f32 v[96:97], v[96:97], v[152:153] op_sel:[0,0] op_sel_hi:[1,0]
v_pk_mul_f32 v[98:99], v[98:99], v[152:153] op_sel:[0,0] op_sel_hi:[1,0]
v_cvt_pk_bf16_f32 v144, v92, v93
v_cvt_pk_bf16_f32 v145, v94, v95
v_pk_mul_f32 v[112:113], v[112:113], v[176:177] op_sel:[0,0] op_sel_hi:[1,0]
v_cvt_pk_bf16_f32 v168, v108, v109
v_pk_mul_f32 v[114:115], v[114:115], v[176:177] op_sel:[0,0] op_sel_hi:[1,0]
v_cvt_pk_bf16_f32 v169, v110, v111
v_mfma_f32_16x16x32_bf16 v[92:95], a[232:235], v[188:191], 0
v_cvt_pk_bf16_f32 v146, v96, v97
v_cvt_pk_bf16_f32 v147, v98, v99
v_mfma_f32_16x16x32_bf16 v[108:111], a[232:235], v[212:215], 0
v_cvt_pk_bf16_f32 v170, v112, v113
buffer_load_dwordx4 v1, s[4:7], s44 offen offset:0 sc1 lds
v_cvt_pk_bf16_f32 v171, v114, v115
v_mfma_f32_16x16x32_bf16 v[96:99], a[236:239], v[188:191], 0
s_nop 0
v_max3_f32 v236, v92, v93, v94
v_max3_f32 v237, -v92, -v93, -v94
v_mfma_f32_16x16x32_bf16 v[112:115], a[236:239], v[212:215], 0
v_max3_f32 v242, v108, v109, v110
v_max3_f32 v243, -v108, -v109, -v110
v_exp_f32 v101, v101
s_nop 0
v_max3_f32 v236, v236, v95, v96
v_max3_f32 v237, v237, -v95, -v96
v_max3_f32 v236, v236, v97, v98
v_max3_f32 v237, v237, -v97, -v98
v_max3_f32 v242, v242, v111, v112
v_max3_f32 v243, v243, -v111, -v112
v_max3_f32 v242, v242, v113, v114
v_max3_f32 v243, v243, -v113, -v114
v_max_f32 v236, v236, v99
v_max_f32_e64 v237, v237, -v99
v_max_f32 v242, v242, v115
v_max_f32_e64 v243, v243, -v115
v_exp_f32 v102, v102
v_exp_f32 v103, v103
buffer_load_dwordx4 v1, s[4:7], s44 offen offset:1024 sc1 lds
v_exp_f32 v104, v104
v_exp_f32 v105, v105
v_exp_f32 v106, v106
v_exp_f32 v107, v107
v_exp_f32 v116, v116
v_exp_f32 v117, v117
v_exp_f32 v118, v118
v_exp_f32 v119, v119
v_exp_f32 v120, v120
v_exp_f32 v121, v121
v_exp_f32 v122, v122
v_exp_f32 v123, v123
v_permlane32_swap_b32 v236, v237
v_permlane32_swap_b32 v242, v243
buffer_load_dwordx4 v1, s[4:7], s44 offen offset:2048 sc1 lds
v_cvt_pk_bf16_f32 v140, v100, v101
v_cvt_pk_bf16_f32 v141, v102, v103
v_cvt_pk_bf16_f32 v142, v104, v105
v_cvt_pk_bf16_f32 v143, v106, v107
v_cvt_pk_bf16_f32 v164, v116, v117
v_cvt_pk_bf16_f32 v165, v118, v119
v_cvt_pk_bf16_f32 v166, v120, v121
v_cvt_pk_bf16_f32 v167, v122, v123
ds_write_b64 v232, v[148:149] offset:0
ds_write_b64 v232, v[150:151] offset:512
ds_write_b64 v232, v[172:173] offset:1024
v_max_f32 v236, v236, v237
v_max_f32 v242, v242, v243
v_mfma_f32_16x16x32_bf16 v[148:151], v[16:19], v[140:143], 0
ds_write_b64 v232, v[174:175] offset:1536
v_mfma_f32_16x16x32_bf16 v[172:175], v[16:19], v[164:167], 0
v_mov_b32 v238, v236
buffer_load_dwordx4 v1, s[4:7], s44 offen offset:3072 sc1 lds
v_mov_b32 v244, v242
v_permlane16_swap_b32 v236, v238
s_nop 0
v_permlane16_swap_b32 v242, v244
v_max_f32 v236, v236, v238
v_max_f32 v242, v242, v244
v_mov_b32 v238, v236
v_mov_b32 v244, v242
v_rcp_f32 v148, v148
v_rcp_f32 v172, v172
v_permlane32_swap_b32 v236, v238
v_permlane32_swap_b32 v242, v244
v_mul_f32 v240, 0x3fb8aa3b, v87
v_mul_f32 v246, 0x3fb8aa3b, v89
v_pk_mul_f32 v[100:101], v[100:101], v[148:149] op_sel:[0,0] op_sel_hi:[1,0]
v_pk_mul_f32 v[102:103], v[102:103], v[148:149] op_sel:[0,0] op_sel_hi:[1,0]
v_pk_mul_f32 v[104:105], v[104:105], v[148:149] op_sel:[0,0] op_sel_hi:[1,0]
v_pk_mul_f32 v[106:107], v[106:107], v[148:149] op_sel:[0,0] op_sel_hi:[1,0]
v_pk_mul_f32 v[116:117], v[116:117], v[172:173] op_sel:[0,0] op_sel_hi:[1,0]
v_pk_mul_f32 v[118:119], v[118:119], v[172:173] op_sel:[0,0] op_sel_hi:[1,0]
v_pk_mul_f32 v[120:121], v[120:121], v[172:173] op_sel:[0,0] op_sel_hi:[1,0]
v_pk_mul_f32 v[122:123], v[122:123], v[172:173] op_sel:[0,0] op_sel_hi:[1,0]
buffer_store_dwordx4 a[228:231], v2, s[4:7], s91 offen offset:0 sc1
v_mul_f32_e64 v236, -v236, v240
v_mul_f32_e64 v237, -v238, v240
v_mul_f32_e64 v242, -v242, v246
v_mul_f32_e64 v243, -v244, v246
v_cvt_pk_bf16_f32 v140, v100, v101
v_cvt_pk_bf16_f32 v141, v102, v103
v_cvt_pk_bf16_f32 v142, v104, v105
v_cvt_pk_bf16_f32 v143, v106, v107
v_cvt_pk_bf16_f32 v164, v116, v117
v_cvt_pk_bf16_f32 v165, v118, v119
v_cvt_pk_bf16_f32 v166, v120, v121
v_cvt_pk_bf16_f32 v167, v122, v123
v_pk_fma_f32 v[100:101], v[92:93], v[240:241], v[236:237] op_sel:[0,0,0] op_sel_hi:[1,0,0]
v_pk_fma_f32 v[102:103], v[94:95], v[240:241], v[236:237] op_sel:[0,0,0] op_sel_hi:[1,0,0]
v_pk_fma_f32 v[104:105], v[96:97], v[240:241], v[236:237] op_sel:[0,0,0] op_sel_hi:[1,0,0]
v_pk_fma_f32 v[106:107], v[98:99], v[240:241], v[236:237] op_sel:[0,0,0] op_sel_hi:[1,0,0]
v_pk_fma_f32 v[116:117], v[108:109], v[246:247], v[242:243] op_sel:[0,0,0] op_sel_hi:[1,0,0]
v_pk_fma_f32 v[118:119], v[110:111], v[246:247], v[242:243] op_sel:[0,0,0] op_sel_hi:[1,0,0]
v_pk_fma_f32 v[120:121], v[112:113], v[246:247], v[242:243] op_sel:[0,0,0] op_sel_hi:[1,0,0]
v_pk_fma_f32 v[122:123], v[114:115], v[246:247], v[242:243] op_sel:[0,0,0] op_sel_hi:[1,0,0]
v_pk_fma_f32 v[92:93], v[92:93], v[240:241], v[236:237] op_sel:[0,0,1] op_sel_hi:[1,0,1] neg_lo:[1,0,0] neg_hi:[1,0,0]
v_pk_fma_f32 v[94:95], v[94:95], v[240:241], v[236:237] op_sel:[0,0,1] op_sel_hi:[1,0,1] neg_lo:[1,0,0] neg_hi:[1,0,0]
v_pk_fma_f32 v[96:97], v[96:97], v[240:241], v[236:237] op_sel:[0,0,1] op_sel_hi:[1,0,1] neg_lo:[1,0,0] neg_hi:[1,0,0]
v_pk_fma_f32 v[98:99], v[98:99], v[240:241], v[236:237] op_sel:[0,0,1] op_sel_hi:[1,0,1] neg_lo:[1,0,0] neg_hi:[1,0,0]
v_pk_fma_f32 v[108:109], v[108:109], v[246:247], v[242:243] op_sel:[0,0,1] op_sel_hi:[1,0,1] neg_lo:[1,0,0] neg_hi:[1,0,0]
v_pk_fma_f32 v[110:111], v[110:111], v[246:247], v[242:243] op_sel:[0,0,1] op_sel_hi:[1,0,1] neg_lo:[1,0,0] neg_hi:[1,0,0]
v_pk_fma_f32 v[112:113], v[112:113], v[246:247], v[242:243] op_sel:[0,0,1] op_sel_hi:[1,0,1] neg_lo:[1,0,0] neg_hi:[1,0,0]
v_pk_fma_f32 v[114:115], v[114:115], v[246:247], v[242:243] op_sel:[0,0,1] op_sel_hi:[1,0,1] neg_lo:[1,0,0] neg_hi:[1,0,0]
v_pk_mul_f32 v[196:197], v[196:197], v[86:87] op_sel:[0,1] op_sel_hi:[1,1]
v_pk_mul_f32 v[220:221], v[220:221], v[88:89] op_sel:[0,1] op_sel_hi:[1,1]
v_exp_f32 v100, v100
v_exp_f32 v92, v92
buffer_store_dwordx4 a[228:231], v2, s[4:7], s91 offen offset:1024 sc1
v_exp_f32 v101, v101
v_exp_f32 v93, v93
v_exp_f32 v102, v102
v_exp_f32 v94, v94
v_exp_f32 v103, v103
v_exp_f32 v95, v95
v_exp_f32 v104, v104
v_exp_f32 v96, v96
v_exp_f32 v105, v105
v_exp_f32 v97, v97
v_exp_f32 v106, v106
v_exp_f32 v98, v98
v_exp_f32 v107, v107
v_exp_f32 v99, v99
v_exp_f32 v116, v116
v_exp_f32 v108, v108
v_exp_f32 v117, v117
buffer_store_dwordx4 a[228:231], v2, s[4:7], s91 offen offset:2048 sc1
v_exp_f32 v109, v109
v_exp_f32 v118, v118
v_exp_f32 v110, v110
v_exp_f32 v119, v119
v_exp_f32 v111, v111
v_exp_f32 v120, v120
v_exp_f32 v112, v112
v_exp_f32 v121, v121
v_exp_f32 v113, v113
v_exp_f32 v122, v122
v_exp_f32 v114, v114
v_exp_f32 v123, v123
v_exp_f32 v115, v115
v_pk_mul_f32 v[198:199], v[198:199], v[86:87] op_sel:[0,1] op_sel_hi:[1,1]
v_pk_mul_f32 v[222:223], v[222:223], v[88:89] op_sel:[0,1] op_sel_hi:[1,1]
v_cvt_pk_bf16_f32 v196, v196, v197
v_cvt_pk_bf16_f32 v220, v220, v221
v_pk_mul_f32 v[200:201], v[200:201], v[86:87] op_sel:[0,1] op_sel_hi:[1,1]
v_pk_mul_f32 v[202:203], v[202:203], v[86:87] op_sel:[0,1] op_sel_hi:[1,1]
v_pk_mul_f32 v[224:225], v[224:225], v[88:89] op_sel:[0,1] op_sel_hi:[1,1]
v_pk_mul_f32 v[226:227], v[226:227], v[88:89] op_sel:[0,1] op_sel_hi:[1,1]
v_cvt_pk_bf16_f32 v197, v198, v199
v_cvt_pk_bf16_f32 v221, v222, v223
v_cvt_pk_bf16_f32 v198, v200, v201
v_cvt_pk_bf16_f32 v199, v202, v203
v_cvt_pk_bf16_f32 v222, v224, v225
v_cvt_pk_bf16_f32 v223, v226, v227
v_cvt_pk_bf16_f32 v188, v100, v101
v_cvt_pk_bf16_f32 v189, v102, v103
v_cvt_pk_bf16_f32 v190, v104, v105
v_cvt_pk_bf16_f32 v191, v106, v107
v_cvt_pk_bf16_f32 v192, v92, v93
v_cvt_pk_bf16_f32 v193, v94, v95
v_cvt_pk_bf16_f32 v194, v96, v97
v_cvt_pk_bf16_f32 v195, v98, v99
v_cvt_pk_bf16_f32 v212, v116, v117
v_cvt_pk_bf16_f32 v213, v118, v119
v_cvt_pk_bf16_f32 v214, v120, v121
v_cvt_pk_bf16_f32 v215, v122, v123
v_cvt_pk_bf16_f32 v216, v108, v109
v_cvt_pk_bf16_f32 v217, v110, v111
v_cvt_pk_bf16_f32 v218, v112, v113
v_cvt_pk_bf16_f32 v219, v114, v115
ds_write_b64 v232, v[196:197] offset:2048
ds_write_b64 v232, v[198:199] offset:2560
ds_write_b64 v232, v[220:221] offset:3072
v_mfma_f32_16x16x32_bf16 v[196:199], v[16:19], v[188:191], 0
buffer_store_dwordx4 a[228:231], v2, s[4:7], s91 offen offset:3072 sc1
ds_write_b64 v232, v[222:223] offset:3584
v_mfma_f32_16x16x32_bf16 v[200:203], v[16:19], v[192:195], 0
s_nop 4
v_rcp_f32 v196, v196
v_mfma_f32_16x16x32_bf16 v[220:223], v[16:19], v[212:215], 0
ds_write_b64 v233, v[140:141] offset:16384
v_mfma_f32_16x16x32_bf16 v[224:227], v[16:19], v[216:219], 0
v_rcp_f32 v200, v200
ds_write_b64 v233, v[142:143] offset:16896
s_nop 3
v_rcp_f32 v220, v220
v_pk_mul_f32 v[100:101], v[100:101], v[196:197] op_sel:[0,0] op_sel_hi:[1,0]
v_rcp_f32 v224, v224
v_pk_mul_f32 v[102:103], v[102:103], v[196:197] op_sel:[0,0] op_sel_hi:[1,0]
v_pk_mul_f32 v[104:105], v[104:105], v[196:197] op_sel:[0,0] op_sel_hi:[1,0]
v_pk_mul_f32 v[106:107], v[106:107], v[196:197] op_sel:[0,0] op_sel_hi:[1,0]
v_pk_mul_f32 v[92:93], v[92:93], v[200:201] op_sel:[0,0] op_sel_hi:[1,0]
v_pk_mul_f32 v[94:95], v[94:95], v[200:201] op_sel:[0,0] op_sel_hi:[1,0]
v_pk_mul_f32 v[96:97], v[96:97], v[200:201] op_sel:[0,0] op_sel_hi:[1,0]
v_pk_mul_f32 v[98:99], v[98:99], v[200:201] op_sel:[0,0] op_sel_hi:[1,0]
v_pk_mul_f32 v[116:117], v[116:117], v[220:221] op_sel:[0,0] op_sel_hi:[1,0]
v_pk_mul_f32 v[118:119], v[118:119], v[220:221] op_sel:[0,0] op_sel_hi:[1,0]
v_pk_mul_f32 v[120:121], v[120:121], v[220:221] op_sel:[0,0] op_sel_hi:[1,0]
v_pk_mul_f32 v[122:123], v[122:123], v[220:221] op_sel:[0,0] op_sel_hi:[1,0]
v_pk_mul_f32 v[108:109], v[108:109], v[224:225] op_sel:[0,0] op_sel_hi:[1,0]
v_pk_mul_f32 v[110:111], v[110:111], v[224:225] op_sel:[0,0] op_sel_hi:[1,0]
v_pk_mul_f32 v[112:113], v[112:113], v[224:225] op_sel:[0,0] op_sel_hi:[1,0]
v_pk_mul_f32 v[114:115], v[114:115], v[224:225] op_sel:[0,0] op_sel_hi:[1,0]
v_cvt_pk_bf16_f32 v188, v100, v101
v_cvt_pk_bf16_f32 v189, v102, v103
v_cvt_pk_bf16_f32 v190, v104, v105
v_cvt_pk_bf16_f32 v191, v106, v107
v_cvt_pk_bf16_f32 v192, v92, v93
v_cvt_pk_bf16_f32 v193, v94, v95
v_cvt_pk_bf16_f32 v194, v96, v97
v_cvt_pk_bf16_f32 v195, v98, v99
v_cvt_pk_bf16_f32 v212, v116, v117
v_cvt_pk_bf16_f32 v213, v118, v119
v_cvt_pk_bf16_f32 v214, v120, v121
v_cvt_pk_bf16_f32 v215, v122, v123
v_cvt_pk_bf16_f32 v216, v108, v109
v_cvt_pk_bf16_f32 v217, v110, v111
v_cvt_pk_bf16_f32 v218, v112, v113
v_cvt_pk_bf16_f32 v219, v114, v115
ds_write_b64 v233, v[144:145] offset:17408
ds_write_b64 v233, v[146:147] offset:17920
ds_write_b64 v233, v[164:165] offset:18432
v_lshlrev_b32 v235, 8, v0
v_add_u32 v234, s36, v8
v_cndmask_b32 v235, 2.0, v235, s[64:65]
ds_write_b64 v233, v[166:167] offset:18944
ds_write_b64 v233, v[168:169] offset:19456
ds_write_b64 v233, v[170:171] offset:19968
ds_write_b64 v233, v[188:189] offset:20480
ds_write_b64 v233, v[190:191] offset:20992
ds_write_b64 v233, v[192:193] offset:21504
ds_write_b64 v233, v[194:195] offset:22016
ds_write_b64 v233, v[212:213] offset:22528
ds_write_b64 v233, v[214:215] offset:23040
ds_write_b64 v233, v[216:217] offset:23552
ds_write_b64 v233, v[218:219] offset:24064
s_waitcnt vmcnt(12)
s_waitcnt lgkmcnt(0)
s_barrier
ds_read_b64_tr_b16 a[0:1], v234 offset:16384
L_stub18:
s_cbranch_execz L_stub19
ds_read_b64_tr_b16 a[2:3], v234 offset:18432
ds_read_b64_tr_b16 a[12:13], v234 offset:20480
ds_read_b64_tr_b16 a[14:15], v234 offset:22528
ds_read_b64_tr_b16 a[24:25], v234 offset:24576
ds_read_b64_tr_b16 a[26:27], v234 offset:26624
ds_read_b64_tr_b16 a[4:5], v8 offset:0
ds_read_b64_tr_b16 a[6:7], v8 offset:1024
ds_read_b64_tr_b16 a[8:9], v8 offset:512
ds_read_b64_tr_b16 a[10:11], v8 offset:1536
ds_read_b64_tr_b16 a[36:37], v234 offset:28672
ds_read_b64_tr_b16 a[38:39], v234 offset:30720
ds_read_b64_tr_b16 a[16:17], v8 offset:2048
ds_read_b64_tr_b16 a[18:19], v8 offset:3072
ds_read_b64_tr_b16 a[20:21], v8 offset:2560
ds_read_b64_tr_b16 a[22:23], v8 offset:3584
ds_read_b64_tr_b16 a[48:49], v234 offset:32768
ds_read_b64_tr_b16 a[50:51], v234 offset:34816
ds_read_b64_tr_b16 a[28:29], v8 offset:4096
ds_read_b64_tr_b16 a[30:31], v8 offset:5120
ds_read_b64_tr_b16 a[32:33], v8 offset:4608
ds_read_b64_tr_b16 a[34:35], v8 offset:5632
ds_read_b64_tr_b16 a[60:61], v234 offset:36864
ds_read_b64_tr_b16 a[62:63], v234 offset:38912
s_waitcnt lgkmcnt(14)
v_mfma_f32_16x16x32_bf16 v[100:103], a[0:3], v[16:19], 0
ds_read_b64_tr_b16 a[40:41], v8 offset:6144
ds_read_b64_tr_b16 a[42:43], v8 offset:7168
ds_read_b64_tr_b16 a[44:45], v8 offset:6656
ds_read_b64_tr_b16 a[46:47], v8 offset:7680
ds_read_b64_tr_b16 a[72:73], v234 offset:40960
ds_read_b64_tr_b16 a[74:75], v234 offset:43008
v_mfma_f32_16x16x32_bf16 v[100:103], a[12:15], v[16:19], v[100:103]
buffer_atomic_add v12, v235, s[4:7], s94 offen sc1
ds_read_b64_tr_b16 a[52:53], v8 offset:8192
ds_read_b64_tr_b16 a[54:55], v8 offset:9216
ds_read_b64_tr_b16 a[56:57], v8 offset:8704
ds_read_b64_tr_b16 a[58:59], v8 offset:9728
ds_read_b64_tr_b16 a[84:85], v234 offset:45056
ds_read_b64_tr_b16 a[86:87], v234 offset:47104
v_mfma_f32_16x16x32_bf16 v[100:103], a[24:27], v[16:19], v[100:103]
ds_read_b64_tr_b16 a[64:65], v8 offset:10240
ds_read_b64_tr_b16 a[66:67], v8 offset:11264
v_mfma_f32_16x16x32_bf16 v[92:95], a[0:3], a[4:7], 0
ds_read_b64_tr_b16 a[68:69], v8 offset:10752
ds_read_b64_tr_b16 a[70:71], v8 offset:11776
v_mfma_f32_16x16x32_bf16 v[96:99], a[0:3], a[8:11], 0
ds_read_b64_tr_b16 a[76:77], v8 offset:12288
s_waitcnt lgkmcnt(14)
v_mfma_f32_16x16x32_bf16 v[100:103], a[36:39], v[16:19], v[100:103]
ds_read_b64_tr_b16 a[78:79], v8 offset:13312
v_mfma_f32_16x16x32_bf16 v[92:95], a[12:15], a[16:19], v[92:95]
ds_read_b64_tr_b16 a[80:81], v8 offset:12800
ds_read_b64_tr_b16 a[82:83], v8 offset:13824
v_mfma_f32_16x16x32_bf16 v[96:99], a[12:15], a[20:23], v[96:99]
ds_read_b64_tr_b16 a[88:89], v8 offset:14336
v_mfma_f32_16x16x32_bf16 v[100:103], a[48:51], v[16:19], v[100:103]
ds_read_b64_tr_b16 a[90:91], v8 offset:15360
v_mfma_f32_16x16x32_bf16 v[92:95], a[24:27], a[28:31], v[92:95]
ds_read_b64_tr_b16 a[92:93], v8 offset:14848
ds_read_b64_tr_b16 a[94:95], v8 offset:15872
v_mfma_f32_16x16x32_bf16 v[96:99], a[24:27], a[32:35], v[96:99]
v_cvt_pk_bf16_f32 v132, v132, v133
v_cvt_pk_bf16_f32 v156, v156, v157
v_mfma_f32_16x16x32_bf16 v[100:103], a[60:63], v[16:19], v[100:103]
v_cvt_pk_bf16_f32 v180, v180, v181
v_cvt_pk_bf16_f32 v204, v204, v205
v_mfma_f32_16x16x32_bf16 v[92:95], a[36:39], a[40:43], v[92:95]
v_cvt_pk_bf16_f32 v133, v134, v135
v_cvt_pk_bf16_f32 v157, v158, v159
s_waitcnt lgkmcnt(14)
v_mfma_f32_16x16x32_bf16 v[96:99], a[36:39], a[44:47], v[96:99]
v_cvt_pk_bf16_f32 v181, v182, v183
v_cvt_pk_bf16_f32 v205, v206, v207
v_mfma_f32_16x16x32_bf16 v[100:103], a[72:75], v[16:19], v[100:103]
v_cvt_pk_bf16_f32 v134, v136, v137
v_cvt_pk_bf16_f32 v135, v138, v139
v_mfma_f32_16x16x32_bf16 v[92:95], a[48:51], a[52:55], v[92:95]
v_cvt_pk_bf16_f32 v158, v160, v161
v_cvt_pk_bf16_f32 v159, v162, v163
v_mfma_f32_16x16x32_bf16 v[96:99], a[48:51], a[56:59], v[96:99]
v_cvt_pk_bf16_f32 v182, v184, v185
v_cvt_pk_bf16_f32 v183, v186, v187
s_waitcnt lgkmcnt(12)
v_mfma_f32_16x16x32_bf16 v[100:103], a[84:87], v[16:19], v[100:103]
v_cvt_pk_bf16_f32 v206, v208, v209
v_cvt_pk_bf16_f32 v207, v210, v211
s_waitcnt lgkmcnt(10)
v_mfma_f32_16x16x32_bf16 v[92:95], a[60:63], a[64:67], v[92:95]
s_waitcnt lgkmcnt(8)
v_mfma_f32_16x16x32_bf16 v[96:99], a[60:63], a[68:71], v[96:99]
s_nop 1
v_min_u32 v100, -2, v100
v_min_u32 v101, -2, v101
s_waitcnt lgkmcnt(6)
v_mfma_f32_16x16x32_bf16 v[92:95], a[72:75], a[76:79], v[92:95]
v_min_u32 v102, -2, v102
v_min_u32 v103, -2, v103
s_waitcnt lgkmcnt(4)
v_mfma_f32_16x16x32_bf16 v[96:99], a[72:75], a[80:83], v[96:99]
buffer_store_dwordx4 v[100:103], v254, s[4:7], s39 offen sc1
s_waitcnt lgkmcnt(2)
v_mfma_f32_16x16x32_bf16 v[92:95], a[84:87], a[88:91], v[92:95]
s_waitcnt lgkmcnt(0)
v_mfma_f32_16x16x32_bf16 v[96:99], a[84:87], a[92:95], v[96:99]
s_nop 5
v_cvt_pk_bf16_f32 v92, v92, v93
v_cvt_pk_bf16_f32 v93, v94, v95
v_min_u32 v92, -2, v92
v_min_u32 v93, -2, v93
v_cvt_pk_bf16_f32 v94, v96, v97
v_cvt_pk_bf16_f32 v95, v98, v99
v_min_u32 v94, -2, v94
v_min_u32 v95, -2, v95
buffer_store_dwordx4 v[92:95], v1, s[4:7], s38 offen sc1
s_barrier
s_add_u32 m0, s19, 32768
s_add_u32 s44, s84, 0xc00000
buffer_load_dwordx4 v1, s[4:7], s44 offen offset:0 sc1 lds
v_mfma_f32_16x16x32_bf16 v[108:111], a[232:235], v[132:135], 0
v_mul_f32 v240, 0x3fb8aa3b, v83
v_mul_f32 v246, 0x3fb8aa3b, v85
v_mfma_f32_16x16x32_bf16 v[172:175], a[232:235], v[156:159], 0
v_mfma_f32_16x16x32_bf16 v[112:115], a[236:239], v[132:135], 0
s_nop 3
v_max3_f32 v236, v108, v109, v110
v_max3_f32 v237, -v108, -v109, -v110
v_mfma_f32_16x16x32_bf16 v[176:179], a[236:239], v[156:159], 0
v_max3_f32 v242, v172, v173, v174
v_max3_f32 v243, -v172, -v173, -v174
v_max3_f32 v236, v236, v111, v112
v_max3_f32 v237, v237, -v111, -v112
v_max3_f32 v236, v236, v113, v114
v_max3_f32 v237, v237, -v113, -v114
s_nop 1
v_max3_f32 v242, v242, v175, v176
v_max3_f32 v243, v243, -v175, -v176
v_max3_f32 v242, v242, v177, v178
v_max3_f32 v243, v243, -v177, -v178
v_max_f32 v236, v236, v115
buffer_load_dwordx4 v1, s[4:7], s44 offen offset:1024 sc1 lds
v_max_f32_e64 v237, v237, -v115
v_max_f32 v242, v242, v179
v_max_f32_e64 v243, v243, -v179
v_permlane32_swap_b32 v236, v237
s_nop 0
v_permlane32_swap_b32 v242, v243
v_mov_b32 v11, 0
buffer_atomic_add v11, v251, s[4:7], s89 offen sc0 sc1
v_max_f32 v236, v236, v237
v_max_f32 v242, v242, v243
v_mov_b32 v238, v236
v_mov_b32 v244, v242
s_nop 0
v_permlane16_swap_b32 v236, v238
v_permlane16_swap_b32 v242, v244
v_max_f32 v236, v236, v238
v_max_f32 v242, v242, v244
v_mov_b32 v238, v236
v_mov_b32 v244, v242
s_nop 0
v_permlane32_swap_b32 v236, v238
v_permlane32_swap_b32 v242, v244
v_mul_f32_e64 v236, -v236, v240
v_mul_f32_e64 v237, -v238, v240
buffer_load_dwordx4 v1, s[4:7], s44 offen offset:2048 sc1 lds
v_mul_f32_e64 v242, -v242, v246
v_mul_f32_e64 v243, -v244, v246
v_pk_fma_f32 v[116:117], v[108:109], v[240:241], v[236:237] op_sel:[0,0,0] op_sel_hi:[1,0,0]
v_pk_fma_f32 v[118:119], v[110:111], v[240:241], v[236:237] op_sel:[0,0,0] op_sel_hi:[1,0,0]
v_pk_fma_f32 v[120:121], v[112:113], v[240:241], v[236:237] op_sel:[0,0,0] op_sel_hi:[1,0,0]
v_pk_fma_f32 v[122:123], v[114:115], v[240:241], v[236:237] op_sel:[0,0,0] op_sel_hi:[1,0,0]
v_pk_fma_f32 v[148:149], v[172:173], v[246:247], v[242:243] op_sel:[0,0,0] op_sel_hi:[1,0,0]
v_pk_fma_f32 v[150:151], v[174:175], v[246:247], v[242:243] op_sel:[0,0,0] op_sel_hi:[1,0,0]
v_pk_fma_f32 v[152:153], v[176:177], v[246:247], v[242:243] op_sel:[0,0,0] op_sel_hi:[1,0,0]
v_pk_fma_f32 v[154:155], v[178:179], v[246:247], v[242:243] op_sel:[0,0,0] op_sel_hi:[1,0,0]
v_pk_fma_f32 v[108:109], v[108:109], v[240:241], v[236:237] op_sel:[0,0,1] op_sel_hi:[1,0,1] neg_lo:[1,0,0] neg_hi:[1,0,0]
v_pk_fma_f32 v[110:111], v[110:111], v[240:241], v[236:237] op_sel:[0,0,1] op_sel_hi:[1,0,1] neg_lo:[1,0,0] neg_hi:[1,0,0]
v_pk_fma_f32 v[112:113], v[112:113], v[240:241], v[236:237] op_sel:[0,0,1] op_sel_hi:[1,0,1] neg_lo:[1,0,0] neg_hi:[1,0,0]
v_pk_fma_f32 v[114:115], v[114:115], v[240:241], v[236:237] op_sel:[0,0,1] op_sel_hi:[1,0,1] neg_lo:[1,0,0] neg_hi:[1,0,0]
v_pk_fma_f32 v[172:173], v[172:173], v[246:247], v[242:243] op_sel:[0,0,1] op_sel_hi:[1,0,1] neg_lo:[1,0,0] neg_hi:[1,0,0]
v_pk_fma_f32 v[174:175], v[174:175], v[246:247], v[242:243] op_sel:[0,0,1] op_sel_hi:[1,0,1] neg_lo:[1,0,0] neg_hi:[1,0,0]
v_pk_fma_f32 v[176:177], v[176:177], v[246:247], v[242:243] op_sel:[0,0,1] op_sel_hi:[1,0,1] neg_lo:[1,0,0] neg_hi:[1,0,0]
v_pk_fma_f32 v[178:179], v[178:179], v[246:247], v[242:243] op_sel:[0,0,1] op_sel_hi:[1,0,1] neg_lo:[1,0,0] neg_hi:[1,0,0]
v_exp_f32 v116, v116
v_exp_f32 v108, v108
v_exp_f32 v117, v117
v_exp_f32 v109, v109
v_exp_f32 v118, v118
v_exp_f32 v110, v110
v_exp_f32 v119, v119
v_exp_f32 v111, v111
v_exp_f32 v120, v120
v_exp_f32 v112, v112
v_exp_f32 v121, v121
v_exp_f32 v113, v113
v_exp_f32 v122, v122
v_exp_f32 v114, v114
v_exp_f32 v123, v123
v_exp_f32 v115, v115
v_exp_f32 v148, v148
v_exp_f32 v172, v172
v_exp_f32 v149, v149
v_exp_f32 v173, v173
v_exp_f32 v150, v150
v_exp_f32 v174, v174
v_exp_f32 v151, v151
v_exp_f32 v175, v175
v_exp_f32 v152, v152
v_exp_f32 v176, v176
v_exp_f32 v153, v153
v_exp_f32 v177, v177
v_exp_f32 v154, v154
v_exp_f32 v178, v178
v_exp_f32 v155, v155
v_exp_f32 v179, v179
buffer_load_dwordx4 v1, s[4:7], s44 offen offset:3072 sc1 lds
v_cvt_pk_bf16_f32 v140, v116, v117
v_cvt_pk_bf16_f32 v141, v118, v119
v_cvt_pk_bf16_f32 v142, v120, v121
v_cvt_pk_bf16_f32 v143, v122, v123
v_cvt_pk_bf16_f32 v144, v108, v109
v_cvt_pk_bf16_f32 v145, v110, v111
v_cvt_pk_bf16_f32 v146, v112, v113
v_cvt_pk_bf16_f32 v147, v114, v115
v_cvt_pk_bf16_f32 v164, v148, v149
v_cvt_pk_bf16_f32 v165, v150, v151
v_cvt_pk_bf16_f32 v166, v152, v153
v_cvt_pk_bf16_f32 v167, v154, v155
v_cvt_pk_bf16_f32 v168, v172, v173
v_cvt_pk_bf16_f32 v169, v174, v175
v_cvt_pk_bf16_f32 v170, v176, v177
v_cvt_pk_bf16_f32 v171, v178, v179
s_waitcnt vmcnt(2)
v_readfirstlane_b32 s38, v11
s_nop 0
s_cmp_ge_u32 s38, 8
s_cbranch_scc1 Lpe_35
s_add_u32 s36, s88, 0x90000
s_mov_b32 s37, 0
Lpoll_34:
v_mov_b32 v11, 0
buffer_atomic_add v11, v251, s[4:7], s36 offen sc0 sc1
s_add_u32 s37, s37, 1
s_waitcnt vmcnt(0)
v_readfirstlane_b32 s38, v11
s_nop 0
s_cmp_ge_u32 s38, 8
s_cbranch_scc1 Lpe_35
s_cmp_lt_u32 s37, 0x100000
s_cbranch_scc1 Lpoll_34
Lpe_35:
s_lshl_b32 s37, s30, 2
s_add_u32 s37, s37, s28
s_lshl_b32 s38, s37, 13
s_add_u32 s38, s38, 0x400000
buffer_load_dwordx4 v[48:51], v1, s[4:7], s38 offen offset:0 sc1
v_and_b32 v248, 7, v0
s_add_u32 s36, s38, 4096
s_lshl_b32 s39, s37, 10
v_lshlrev_b32 v248, 7, v248
v_lshrrev_b32 v249, 4, v0
s_add_u32 s39, s39, 0x820000
v_lshl_add_u32 v248, v249, 4, v248
s_add_u32 m0, s19, 131072
s_add_u32 s44, s86, 0xc18000
v_mfma_f32_16x16x32_bf16 v[108:111], a[232:235], v[180:183], 0
v_mov_b32 v249, 0x3f80
v_mov_b32 v250, 1.0
buffer_load_dwordx4 v[124:127], v248, s[4:7], s39 offen sc1
v_mfma_f32_16x16x32_bf16 v[220:223], a[232:235], v[204:207], 0
v_mul_f32 v240, 0x3fb8aa3b, v87
s_nop 2
v_max3_f32 v236, v108, v109, v110
v_mfma_f32_16x16x32_bf16 v[112:115], a[236:239], v[180:183], 0
v_max3_f32 v237, -v108, -v109, -v110
v_mul_f32 v246, 0x3fb8aa3b, v89
v_mfma_f32_16x16x32_bf16 v[224:227], a[236:239], v[204:207], 0
v_max3_f32 v242, v220, v221, v222
v_max3_f32 v243, -v220, -v221, -v222
buffer_load_dwordx4 v[52:55], v1, s[4:7], s38 offen offset:1024 sc1
s_nop 1
v_max3_f32 v236, v236, v111, v112
v_max3_f32 v237, v237, -v111, -v112
s_nop 0
v_max3_f32 v242, v242, v223, v224
v_max3_f32 v243, v243, -v223, -v224
v_max3_f32 v236, v236, v113, v114
v_max3_f32 v237, v237, -v113, -v114
v_max3_f32 v242, v242, v225, v226
v_max3_f32 v243, v243, -v225, -v226
v_max_f32 v236, v236, v115
v_max_f32_e64 v237, v237, -v115
v_max_f32 v242, v242, v227
v_max_f32_e64 v243, v243, -v227
v_permlane32_swap_b32 v236, v237
buffer_load_dwordx4 v[56:59], v1, s[4:7], s38 offen offset:2048 sc1
v_permlane32_swap_b32 v242, v243
v_max_f32 v236, v236, v237
v_max_f32 v242, v242, v243
v_mov_b32 v238, v236
v_mov_b32 v244, v242
s_nop 0
v_permlane16_swap_b32 v236, v238
v_permlane16_swap_b32 v242, v244
v_max_f32 v236, v236, v238
v_max_f32 v242, v242, v244
buffer_load_dwordx4 v[60:63], v1, s[4:7], s38 offen offset:3072 sc1
v_mov_b32 v238, v236
v_mov_b32 v244, v242
s_nop 0
v_permlane32_swap_b32 v236, v238
v_permlane32_swap_b32 v242, v244
v_mul_f32_e64 v236, -v236, v240
v_mul_f32_e64 v237, -v238, v240
v_mul_f32_e64 v242, -v242, v246
v_mul_f32_e64 v243, -v244, v246
v_pk_fma_f32 v[116:117], v[108:109], v[240:241], v[236:237] op_sel:[0,0,0] op_sel_hi:[1,0,0]
v_pk_fma_f32 v[118:119], v[110:111], v[240:241], v[236:237] op_sel:[0,0,0] op_sel_hi:[1,0,0]
buffer_load_dwordx4 v[64:67], v1, s[4:7], s36 offen offset:0 sc1
v_pk_fma_f32 v[120:121], v[112:113], v[240:241], v[236:237] op_sel:[0,0,0] op_sel_hi:[1,0,0]
v_pk_fma_f32 v[122:123], v[114:115], v[240:241], v[236:237] op_sel:[0,0,0] op_sel_hi:[1,0,0]
v_pk_fma_f32 v[196:197], v[220:221], v[246:247], v[242:243] op_sel:[0,0,0] op_sel_hi:[1,0,0]
v_pk_fma_f32 v[198:199], v[222:223], v[246:247], v[242:243] op_sel:[0,0,0] op_sel_hi:[1,0,0]
v_pk_fma_f32 v[200:201], v[224:225], v[246:247], v[242:243] op_sel:[0,0,0] op_sel_hi:[1,0,0]
v_pk_fma_f32 v[202:203], v[226:227], v[246:247], v[242:243] op_sel:[0,0,0] op_sel_hi:[1,0,0]
v_pk_fma_f32 v[108:109], v[108:109], v[240:241], v[236:237] op_sel:[0,0,1] op_sel_hi:[1,0,1] neg_lo:[1,0,0] neg_hi:[1,0,0]
v_pk_fma_f32 v[110:111], v[110:111], v[240:241], v[236:237] op_sel:[0,0,1] op_sel_hi:[1,0,1] neg_lo:[1,0,0] neg_hi:[1,0,0]
v_pk_fma_f32 v[112:113], v[112:113], v[240:241], v[236:237] op_sel:[0,0,1] op_sel_hi:[1,0,1] neg_lo:[1,0,0] neg_hi:[1,0,0]
v_pk_fma_f32 v[114:115], v[114:115], v[240:241], v[236:237] op_sel:[0,0,1] op_sel_hi:[1,0,1] neg_lo:[1,0,0] neg_hi:[1,0,0]
v_pk_fma_f32 v[220:221], v[220:221], v[246:247], v[242:243] op_sel:[0,0,1] op_sel_hi:[1,0,1] neg_lo:[1,0,0] neg_hi:[1,0,0]
v_pk_fma_f32 v[222:223], v[222:223], v[246:247], v[242:243] op_sel:[0,0,1] op_sel_hi:[1,0,1] neg_lo:[1,0,0] neg_hi:[1,0,0]
v_pk_fma_f32 v[224:225], v[224:225], v[246:247], v[242:243] op_sel:[0,0,1] op_sel_hi:[1,0,1] neg_lo:[1,0,0] neg_hi:[1,0,0]
buffer_load_dwordx4 v[68:71], v1, s[4:7], s36 offen offset:1024 sc1
v_pk_fma_f32 v[226:227], v[226:227], v[246:247], v[242:243] op_sel:[0,0,1] op_sel_hi:[1,0,1] neg_lo:[1,0,0] neg_hi:[1,0,0]
v_exp_f32 v116, v116
v_exp_f32 v108, v108
v_exp_f32 v117, v117
v_exp_f32 v109, v109
v_exp_f32 v118, v118
v_exp_f32 v110, v110
buffer_load_dwordx4 v[100:103], v1, s[4:7], s36 offen offset:2048 sc1
v_exp_f32 v119, v119
v_exp_f32 v111, v111
v_exp_f32 v120, v120
v_exp_f32 v112, v112
v_exp_f32 v121, v121
v_exp_f32 v113, v113
v_exp_f32 v122, v122
buffer_load_dwordx4 v[104:107], v1, s[4:7], s36 offen offset:3072 sc1
v_exp_f32 v114, v114
v_exp_f32 v123, v123
v_exp_f32 v115, v115
v_exp_f32 v196, v196
v_exp_f32 v220, v220
v_exp_f32 v197, v197
v_exp_f32 v221, v221
buffer_load_dwordx4 v1, s[4:7], s44 offen offset:0 sc1 lds
v_exp_f32 v198, v198
v_exp_f32 v222, v222
v_exp_f32 v199, v199
v_exp_f32 v223, v223
v_exp_f32 v200, v200
v_exp_f32 v224, v224
v_exp_f32 v201, v201
buffer_load_dwordx4 v1, s[4:7], s44 offen offset:1024 sc1 lds
v_exp_f32 v225, v225
v_exp_f32 v202, v202
v_exp_f32 v226, v226
v_exp_f32 v203, v203
v_exp_f32 v227, v227
v_cvt_pk_bf16_f32 v188, v116, v117
v_cvt_pk_bf16_f32 v189, v118, v119
v_cvt_pk_bf16_f32 v190, v120, v121
buffer_load_dwordx4 v1, s[4:7], s44 offen offset:2048 sc1 lds
v_cvt_pk_bf16_f32 v191, v122, v123
v_cvt_pk_bf16_f32 v192, v108, v109
v_cvt_pk_bf16_f32 v193, v110, v111
v_cvt_pk_bf16_f32 v194, v112, v113
v_cvt_pk_bf16_f32 v195, v114, v115
v_cvt_pk_bf16_f32 v212, v196, v197
v_cvt_pk_bf16_f32 v213, v198, v199
v_cvt_pk_bf16_f32 v214, v200, v201
v_cvt_pk_bf16_f32 v215, v202, v203
v_cvt_pk_bf16_f32 v216, v220, v221
v_cvt_pk_bf16_f32 v217, v222, v223
v_cvt_pk_bf16_f32 v218, v224, v225
v_cvt_pk_bf16_f32 v219, v226, v227
buffer_load_dwordx4 v1, s[4:7], s44 offen offset:3072 sc1 lds
s_waitcnt vmcnt(12)
v_lshlrev_b32 v92, 16, v48
v_and_b32 v93, 0xffff0000, v48
v_lshlrev_b32 v94, 16, v49
v_and_b32 v95, 0xffff0000, v49
v_lshlrev_b32 v96, 16, v50
v_and_b32 v97, 0xffff0000, v50
v_lshlrev_b32 v98, 16, v51
v_and_b32 v99, 0xffff0000, v51
s_waitcnt vmcnt(11)
v_add_f32_dpp v128, v124, v124 row_ror:4 row_mask:0xf bank_mask:0xf
v_add_f32_dpp v129, v125, v125 row_ror:4 row_mask:0xf bank_mask:0xf
v_add_f32_dpp v130, v126, v126 row_ror:4 row_mask:0xf bank_mask:0xf
v_add_f32_dpp v131, v127, v127 row_ror:4 row_mask:0xf bank_mask:0xf
v_add_f32_dpp v128, v128, v128 row_ror:2 row_mask:0xf bank_mask:0xf
v_add_f32_dpp v129, v129, v129 row_ror:2 row_mask:0xf bank_mask:0xf
v_add_f32_dpp v130, v130, v130 row_ror:2 row_mask:0xf bank_mask:0xf
v_add_f32_dpp v131, v131, v131 row_ror:2 row_mask:0xf bank_mask:0xf
v_add_f32_dpp v128, v128, v128 row_ror:1 row_mask:0xf bank_mask:0xf
v_add_f32_dpp v129, v129, v129 row_ror:1 row_mask:0xf bank_mask:0xf
v_add_f32_dpp v130, v130, v130 row_ror:1 row_mask:0xf bank_mask:0xf
v_add_f32_dpp v131, v131, v131 row_ror:1 row_mask:0xf bank_mask:0xf
v_fma_f32 v135, v129, v130, v131
s_waitcnt vmcnt(10)
v_dot2c_f32_bf16 v92, v52, v249
v_dot2c_f32_bf16 v93, v52, v250
v_dot2c_f32_bf16 v94, v53, v249
v_dot2c_f32_bf16 v95, v53, v250
v_dot2c_f32_bf16 v96, v54, v249
v_dot2c_f32_bf16 v97, v54, v250
v_dot2c_f32_bf16 v98, v55, v249
v_dot2c_f32_bf16 v99, v55, v250
s_waitcnt vmcnt(9)
v_dot2c_f32_bf16 v92, v56, v249
v_dot2c_f32_bf16 v93, v56, v250
v_dot2c_f32_bf16 v94, v57, v249
v_dot2c_f32_bf16 v95, v57, v250
v_dot2c_f32_bf16 v96, v58, v249
v_dot2c_f32_bf16 v97, v58, v250
v_dot2c_f32_bf16 v98, v59, v249
v_dot2c_f32_bf16 v99, v59, v250
s_waitcnt vmcnt(8)
v_dot2c_f32_bf16 v92, v60, v249
v_dot2c_f32_bf16 v93, v60, v250
v_dot2c_f32_bf16 v94, v61, v249
v_dot2c_f32_bf16 v95, v61, v250
v_dot2c_f32_bf16 v96, v62, v249
v_dot2c_f32_bf16 v97, v62, v250
v_dot2c_f32_bf16 v98, v63, v249
v_dot2c_f32_bf16 v99, v63, v250
s_waitcnt vmcnt(7)
v_dot2c_f32_bf16 v92, v64, v249
v_dot2c_f32_bf16 v93, v64, v250
v_dot2c_f32_bf16 v94, v65, v249
v_dot2c_f32_bf16 v95, v65, v250
v_dot2c_f32_bf16 v96, v66, v249
v_dot2c_f32_bf16 v97, v66, v250
v_dot2c_f32_bf16 v98, v67, v249
v_dot2c_f32_bf16 v99, v67, v250
s_waitcnt vmcnt(6)
v_dot2c_f32_bf16 v92, v68, v249
v_dot2c_f32_bf16 v93, v68, v250
v_dot2c_f32_bf16 v94, v69, v249
v_dot2c_f32_bf16 v95, v69, v250
v_dot2c_f32_bf16 v96, v70, v249
v_dot2c_f32_bf16 v97, v70, v250
v_dot2c_f32_bf16 v98, v71, v249
v_dot2c_f32_bf16 v99, v71, v250
s_waitcnt vmcnt(5)
v_dot2c_f32_bf16 v92, v100, v249
v_dot2c_f32_bf16 v93, v100, v250
v_dot2c_f32_bf16 v94, v101, v249
v_dot2c_f32_bf16 v95, v101, v250
v_dot2c_f32_bf16 v96, v102, v249
v_dot2c_f32_bf16 v97, v102, v250
v_dot2c_f32_bf16 v98, v103, v249
v_dot2c_f32_bf16 v99, v103, v250
s_waitcnt vmcnt(4)
v_dot2c_f32_bf16 v92, v104, v249
v_dot2c_f32_bf16 v93, v104, v250
v_dot2c_f32_bf16 v94, v105, v249
v_dot2c_f32_bf16 v95, v105, v250
v_dot2c_f32_bf16 v96, v106, v249
v_dot2c_f32_bf16 v97, v106, v250
v_dot2c_f32_bf16 v98, v107, v249
v_dot2c_f32_bf16 v99, v107, v250
v_fma_f32 v132, v92, v93, v94
v_fma_f32 v133, v95, v96, v97
s_nop 0
v_fma_f32 v134, v98, v99, v128
v_fma_f32 v132, v132, v133, v134
v_cmp_u_f32 vcc, v132, v135
s_cbranch_vccnz L_kvredo3
L_kvback3:
s_lshr_b32 s36, s28, 1
s_and_b32 s37, s28, 1
v_cvt_pk_bf16_f32 v128, v128, v129
v_cvt_pk_bf16_f32 v129, v130, v131
s_mul_i32 s36, s36, 3072
s_lshl_b32 s37, s37, 3
v_cvt_pk_bf16_f32 v92, v92, v93
v_cndmask_b32 v128, 0, v128, s[56:57]
v_cndmask_b32 v129, 0, v129, s[56:57]
s_add_u32 s36, s36, s37
v_cvt_pk_bf16_f32 v93, v94, v95
v_cvt_pk_bf16_f32 v94, v96, v97
v_cvt_pk_bf16_f32 v95, v98, v99
v_cndmask_b32 v128, v128, v16, s[58:59]
v_cndmask_b32 v129, v129, v16, s[58:59]
v_add_u32 v236, s36, v1
s_lshl_b32 s35, s30, 12
ds_write_b64 v236, v[92:93] offset:0
ds_write_b64 v236, v[94:95] offset:1024
ds_write_b64 v236, v[128:129] offset:2048
s_add_u32 s35, s35, 0x2600000
s_add_u32 s94, s71, 0x30080
s_waitcnt lgkmcnt(0)
s_barrier
ds_read_b128 a[8:11], v1 offset:2048
ds_read_b128 a[20:23], v1 offset:5120
ds_read_b128 a[0:3], v1 offset:0
ds_read_b128 a[12:15], v1 offset:3072
ds_read_b128 a[4:7], v1 offset:1024
ds_read_b128 a[16:19], v1 offset:4096
s_waitcnt lgkmcnt(5)
v_mfma_f32_16x16x32_bf16 v[92:95], a[8:11], v[140:143], 0
s_waitcnt lgkmcnt(4)
v_mfma_f32_16x16x32_bf16 v[96:99], a[20:23], v[144:147], 0
s_waitcnt lgkmcnt(3)
v_mfma_f32_16x16x32_bf16 v[132:135], a[0:3], v[140:143], 0
s_nop 3
v_rcp_f32 v94, v93
s_waitcnt lgkmcnt(2)
v_mfma_f32_16x16x32_bf16 v[148:151], a[12:15], v[144:147], 0
v_rcp_f32 v95, v97
v_mul_f32 v92, v92, v94
v_fmac_f32 v92, v96, v95
v_mfma_f32_16x16x32_bf16 v[100:103], a[8:11], v[164:167], 0
v_add_f32 v92, 0x358637bd, v92
v_rcp_f32 v92, v92
s_waitcnt lgkmcnt(1)
v_mfma_f32_16x16x32_bf16 v[136:139], a[4:7], v[140:143], 0
v_mul_f32 v94, v94, v92
v_mul_f32 v95, v95, v92
v_mfma_f32_16x16x32_bf16 v[104:107], a[20:23], v[168:171], 0
v_mul_f32 v132, v132, v94
v_mul_f32 v133, v133, v94
s_waitcnt lgkmcnt(0)
v_mfma_f32_16x16x32_bf16 v[152:155], a[16:19], v[144:147], 0
v_mul_f32 v134, v134, v94
v_mul_f32 v135, v135, v94
v_fmac_f32 v132, v148, v95
v_fmac_f32 v133, v149, v95
v_rcp_f32 v102, v101
v_mul_f32 v136, v136, v94
v_mul_f32 v137, v137, v94
v_mul_f32 v138, v138, v94
v_mul_f32 v139, v139, v94
v_fmac_f32 v134, v150, v95
v_fmac_f32 v135, v151, v95
v_cvt_pk_bf16_f32 v132, v132, v133
v_rcp_f32 v103, v105
v_fmac_f32 v136, v152, v95
v_fmac_f32 v137, v153, v95
v_fmac_f32 v138, v154, v95
v_fmac_f32 v139, v155, v95
v_cvt_pk_bf16_f32 v133, v134, v135
v_cvt_pk_bf16_f32 v134, v136, v137
v_cvt_pk_bf16_f32 v135, v138, v139
v_mul_f32 v100, v100, v102
v_mfma_f32_16x16x32_bf16 v[156:159], a[0:3], v[164:167], 0
buffer_store_dwordx4 v[132:135], v2, s[4:7], s35 offen offset:0 sc1
v_fmac_f32 v100, v104, v103
v_mfma_f32_16x16x32_bf16 v[172:175], a[12:15], v[168:171], 0
v_add_f32 v100, 0x358637bd, v100
v_rcp_f32 v100, v100
v_mfma_f32_16x16x32_bf16 v[108:111], a[8:11], v[188:191], 0
v_mul_f32 v102, v102, v100
v_mul_f32 v103, v103, v100
v_mfma_f32_16x16x32_bf16 v[160:163], a[4:7], v[164:167], 0
v_mul_f32 v156, v156, v102
v_mul_f32 v157, v157, v102
v_mfma_f32_16x16x32_bf16 v[112:115], a[20:23], v[192:195], 0
v_mul_f32 v158, v158, v102
v_mul_f32 v159, v159, v102
v_mfma_f32_16x16x32_bf16 v[176:179], a[16:19], v[168:171], 0
v_fmac_f32 v156, v172, v103
v_fmac_f32 v157, v173, v103
v_rcp_f32 v110, v109
v_mul_f32 v160, v160, v102
v_mul_f32 v161, v161, v102
v_mul_f32 v162, v162, v102
v_mul_f32 v163, v163, v102
v_fmac_f32 v158, v174, v103
v_fmac_f32 v159, v175, v103
v_cvt_pk_bf16_f32 v156, v156, v157
v_rcp_f32 v111, v113
v_fmac_f32 v160, v176, v103
v_fmac_f32 v161, v177, v103
v_fmac_f32 v162, v178, v103
v_fmac_f32 v163, v179, v103
v_cvt_pk_bf16_f32 v157, v158, v159
v_cvt_pk_bf16_f32 v158, v160, v161
v_cvt_pk_bf16_f32 v159, v162, v163
v_mul_f32 v108, v108, v110
v_mfma_f32_16x16x32_bf16 v[180:183], a[0:3], v[188:191], 0
buffer_store_dwordx4 v[156:159], v2, s[4:7], s35 offen offset:1024 sc1
v_fmac_f32 v108, v112, v111
v_mfma_f32_16x16x32_bf16 v[196:199], a[12:15], v[192:195], 0
v_add_f32 v108, 0x358637bd, v108
v_rcp_f32 v108, v108
v_mfma_f32_16x16x32_bf16 v[116:119], a[8:11], v[212:215], 0
v_mul_f32 v110, v110, v108
v_mul_f32 v111, v111, v108
v_mfma_f32_16x16x32_bf16 v[184:187], a[4:7], v[188:191], 0
v_mul_f32 v180, v180, v110
v_mul_f32 v181, v181, v110
v_mfma_f32_16x16x32_bf16 v[120:123], a[20:23], v[216:219], 0
v_mul_f32 v182, v182, v110
v_mul_f32 v183, v183, v110
v_mfma_f32_16x16x32_bf16 v[200:203], a[16:19], v[192:195], 0
v_fmac_f32 v180, v196, v111
v_fmac_f32 v181, v197, v111
v_rcp_f32 v118, v117
v_mul_f32 v184, v184, v110
v_mul_f32 v185, v185, v110
v_mul_f32 v186, v186, v110
v_mul_f32 v187, v187, v110
v_fmac_f32 v182, v198, v111
v_fmac_f32 v183, v199, v111
v_cvt_pk_bf16_f32 v180, v180, v181
v_rcp_f32 v119, v121
buffer_atomic_add v12, v10, s[4:7], s94 offen sc1
v_fmac_f32 v184, v200, v111
v_fmac_f32 v185, v201, v111
v_fmac_f32 v186, v202, v111
v_fmac_f32 v187, v203, v111
v_cvt_pk_bf16_f32 v181, v182, v183
v_cvt_pk_bf16_f32 v182, v184, v185
v_cvt_pk_bf16_f32 v183, v186, v187
v_mul_f32 v116, v116, v118
v_mfma_f32_16x16x32_bf16 v[204:207], a[0:3], v[212:215], 0
buffer_store_dwordx4 v[180:183], v2, s[4:7], s35 offen offset:2048 sc1
v_fmac_f32 v116, v120, v119
v_mfma_f32_16x16x32_bf16 v[220:223], a[12:15], v[216:219], 0
v_add_f32 v116, 0x358637bd, v116
v_rcp_f32 v116, v116
v_mfma_f32_16x16x32_bf16 v[208:211], a[4:7], v[212:215], 0
v_mul_f32 v118, v118, v116
v_mul_f32 v119, v119, v116
v_mfma_f32_16x16x32_bf16 v[224:227], a[16:19], v[216:219], 0
v_mul_f32 v204, v204, v118
v_mul_f32 v205, v205, v118
v_mul_f32 v206, v206, v118
v_mul_f32 v207, v207, v118
v_fmac_f32 v204, v220, v119
v_fmac_f32 v205, v221, v119
v_mul_f32 v208, v208, v118
v_mul_f32 v209, v209, v118
v_mul_f32 v210, v210, v118
v_mul_f32 v211, v211, v118
v_fmac_f32 v206, v222, v119
v_fmac_f32 v207, v223, v119
v_cvt_pk_bf16_f32 v204, v204, v205
v_fmac_f32 v208, v224, v119
v_fmac_f32 v209, v225, v119
v_fmac_f32 v210, v226, v119
v_fmac_f32 v211, v227, v119
v_cvt_pk_bf16_f32 v205, v206, v207
v_cvt_pk_bf16_f32 v206, v208, v209
v_cvt_pk_bf16_f32 v207, v210, v211
buffer_store_dwordx4 v[204:207], v2, s[4:7], s35 offen offset:3072 sc1
s_add_u32 s92, s71, 0x30000
s_add_u32 s36, s66, 0x30080
s_add_u32 s40, s4, 0x2600000
s_addc_u32 s41, s5, 0
v_add_u32 v5, 32768, v1
v_add_u32 v6, 98304, v1
s_cmp_eq_u32 s3, 0
s_cselect_b32 s35, 8, 0
s_lshl_b32 s35, s35, 12
v_lshlrev_b32 v132, 16, v32
v_and_b32 v133, 0xffff0000, v32
v_lshlrev_b32 v134, 16, v33
v_and_b32 v135, 0xffff0000, v33
v_lshlrev_b32 v136, 16, v34
v_and_b32 v137, 0xffff0000, v34
v_lshlrev_b32 v138, 16, v35
v_and_b32 v139, 0xffff0000, v35
v_lshlrev_b32 v140, 16, v36
v_and_b32 v141, 0xffff0000, v36
v_lshlrev_b32 v142, 16, v37
v_and_b32 v143, 0xffff0000, v37
v_lshlrev_b32 v144, 16, v38
v_and_b32 v145, 0xffff0000, v38
v_lshlrev_b32 v146, 16, v39
v_and_b32 v147, 0xffff0000, v39
L_stub19:
s_cbranch_execz L_wret6
v_lshlrev_b32 v148, 16, v40
v_and_b32 v149, 0xffff0000, v40
v_lshlrev_b32 v150, 16, v41
v_and_b32 v151, 0xffff0000, v41
v_lshlrev_b32 v152, 16, v42
v_and_b32 v153, 0xffff0000, v42
v_lshlrev_b32 v154, 16, v43
v_and_b32 v155, 0xffff0000, v43
v_lshlrev_b32 v156, 16, v44
v_and_b32 v157, 0xffff0000, v44
v_lshlrev_b32 v158, 16, v45
v_and_b32 v159, 0xffff0000, v45
v_lshlrev_b32 v160, 16, v46
v_and_b32 v161, 0xffff0000, v46
v_lshlrev_b32 v162, 16, v47
v_and_b32 v163, 0xffff0000, v47
s_mov_b32 s95, -1
s_cmp_lg_u32 s28, 3
s_cbranch_scc1 L_wskip7
s_mov_b64 exec, 0
s_branch L_stub20
L_wret7:
s_mov_b64 exec, -1
L_wskip7:
s_cmp_lg_u32 s28, 0
s_cbranch_scc1 Lpe_37
s_add_u32 s36, s66, 0x30080
s_mov_b32 s37, 0
Lpoll_36:
v_mov_b32 v11, 0
buffer_atomic_add v11, v251, s[4:7], s36 offen sc0 sc1
s_add_u32 s37, s37, 1
s_waitcnt vmcnt(0)
v_readfirstlane_b32 s38, v11
s_nop 0
s_cmp_ge_u32 s38, 32
s_cbranch_scc1 Lpe_37
s_cmp_lt_u32 s37, 0x100000
s_cbranch_scc1 Lpoll_36
Lpe_37:
s_waitcnt vmcnt(0)
s_barrier
L_k2go3:
buffer_load_dwordx4 a[0:3], v4, s[40:43], s35 offen offset:0 sc1
buffer_load_dwordx4 a[4:7], v4, s[40:43], s35 offen offset:1024 sc1
s_cmp_eq_u32 s3, 1
s_cselect_b32 s35, 9, 1
s_lshl_b32 s35, s35, 12
buffer_load_dwordx4 a[8:11], v4, s[40:43], s35 offen offset:0 sc1
buffer_load_dwordx4 a[12:15], v4, s[40:43], s35 offen offset:1024 sc1
s_cmp_eq_u32 s3, 2
s_cselect_b32 s35, 10, 2
s_lshl_b32 s35, s35, 12
buffer_load_dwordx4 a[16:19], v4, s[40:43], s35 offen offset:0 sc1
buffer_load_dwordx4 a[20:23], v4, s[40:43], s35 offen offset:1024 sc1
s_cmp_eq_u32 s3, 3
s_cselect_b32 s35, 11, 3
s_lshl_b32 s35, s35, 12
buffer_load_dwordx4 a[24:27], v4, s[40:43], s35 offen offset:0 sc1
buffer_load_dwordx4 a[28:31], v4, s[40:43], s35 offen offset:1024 sc1
s_cmp_eq_u32 s3, 4
s_cselect_b32 s35, 12, 4
s_lshl_b32 s35, s35, 12
buffer_load_dwordx4 a[32:35], v4, s[40:43], s35 offen offset:0 sc1
buffer_load_dwordx4 a[36:39], v4, s[40:43], s35 offen offset:1024 sc1
s_cmp_eq_u32 s3, 5
s_cselect_b32 s35, 13, 5
s_lshl_b32 s35, s35, 12
ds_read_b128 a[96:99], v5 offset:0
ds_read_b128 a[100:103], v5 offset:1024
ds_read_b128 a[104:107], v5 offset:2048
ds_read_b128 a[108:111], v5 offset:3072
ds_read_b128 a[112:115], v5 offset:4096
ds_read_b128 a[116:119], v5 offset:5120
ds_read_b128 a[120:123], v5 offset:6144
ds_read_b128 a[124:127], v5 offset:7168
s_waitcnt vmcnt(8) lgkmcnt(4)
v_mfma_f32_16x16x32_bf16 v[132:135], a[96:99], a[0:3], v[132:135]
ds_read_b128 a[128:131], v5 offset:8192
v_mfma_f32_16x16x32_bf16 v[148:151], a[96:99], a[4:7], v[148:151]
ds_read_b128 a[132:135], v5 offset:9216
v_mfma_f32_16x16x32_bf16 v[152:155], a[100:103], a[4:7], v[152:155]
buffer_load_dwordx4 a[40:43], v4, s[40:43], s35 offen offset:0 sc1
v_mfma_f32_16x16x32_bf16 v[136:139], a[100:103], a[0:3], v[136:139]
ds_read_b128 a[136:139], v5 offset:10240
v_mfma_f32_16x16x32_bf16 v[140:143], a[104:107], a[0:3], v[140:143]
ds_read_b128 a[140:143], v5 offset:11264
v_mfma_f32_16x16x32_bf16 v[156:159], a[104:107], a[4:7], v[156:159]
v_mfma_f32_16x16x32_bf16 v[160:163], a[108:111], a[4:7], v[160:163]
buffer_load_dwordx4 a[44:47], v4, s[40:43], s35 offen offset:1024 sc1
v_mfma_f32_16x16x32_bf16 v[144:147], a[108:111], a[0:3], v[144:147]
s_waitcnt vmcnt(8) lgkmcnt(4)
v_mfma_f32_16x16x32_bf16 v[132:135], a[112:115], a[8:11], v[132:135]
s_cmp_eq_u32 s3, 6
s_cselect_b32 s35, 14, 6
s_lshl_b32 s35, s35, 12
v_mfma_f32_16x16x32_bf16 v[148:151], a[112:115], a[12:15], v[148:151]
ds_read_b128 a[96:99], v5 offset:12288
v_mfma_f32_16x16x32_bf16 v[152:155], a[116:119], a[12:15], v[152:155]
buffer_load_dwordx4 a[0:3], v4, s[40:43], s35 offen offset:0 sc1
v_mfma_f32_16x16x32_bf16 v[136:139], a[116:119], a[8:11], v[136:139]
ds_read_b128 a[100:103], v5 offset:13312
v_mfma_f32_16x16x32_bf16 v[140:143], a[120:123], a[8:11], v[140:143]
ds_read_b128 a[104:107], v5 offset:14336
v_mfma_f32_16x16x32_bf16 v[156:159], a[120:123], a[12:15], v[156:159]
ds_read_b128 a[108:111], v5 offset:15360
v_mfma_f32_16x16x32_bf16 v[160:163], a[124:127], a[12:15], v[160:163]
buffer_load_dwordx4 a[4:7], v4, s[40:43], s35 offen offset:1024 sc1
v_mfma_f32_16x16x32_bf16 v[144:147], a[124:127], a[8:11], v[144:147]
s_waitcnt vmcnt(8) lgkmcnt(4)
v_mfma_f32_16x16x32_bf16 v[132:135], a[128:131], a[16:19], v[132:135]
s_cmp_eq_u32 s3, 7
s_cselect_b32 s35, 15, 7
s_lshl_b32 s35, s35, 12
v_mfma_f32_16x16x32_bf16 v[148:151], a[128:131], a[20:23], v[148:151]
ds_read_b128 a[112:115], v5 offset:16384
v_mfma_f32_16x16x32_bf16 v[152:155], a[132:135], a[20:23], v[152:155]
buffer_load_dwordx4 a[8:11], v4, s[40:43], s35 offen offset:0 sc1
v_mfma_f32_16x16x32_bf16 v[136:139], a[132:135], a[16:19], v[136:139]
ds_read_b128 a[116:119], v5 offset:17408
v_mfma_f32_16x16x32_bf16 v[140:143], a[136:139], a[16:19], v[140:143]
ds_read_b128 a[120:123], v5 offset:18432
v_mfma_f32_16x16x32_bf16 v[156:159], a[136:139], a[20:23], v[156:159]
ds_read_b128 a[124:127], v5 offset:19456
v_mfma_f32_16x16x32_bf16 v[160:163], a[140:143], a[20:23], v[160:163]
buffer_load_dwordx4 a[12:15], v4, s[40:43], s35 offen offset:1024 sc1
v_mfma_f32_16x16x32_bf16 v[144:147], a[140:143], a[16:19], v[144:147]
s_waitcnt vmcnt(8) lgkmcnt(4)
v_mfma_f32_16x16x32_bf16 v[132:135], a[96:99], a[24:27], v[132:135]
s_cmp_eq_u32 s3, 0
s_cselect_b32 s35, 16, 8
s_lshl_b32 s35, s35, 12
v_mfma_f32_16x16x32_bf16 v[148:151], a[96:99], a[28:31], v[148:151]
ds_read_b128 a[128:131], v5 offset:20480
v_mfma_f32_16x16x32_bf16 v[152:155], a[100:103], a[28:31], v[152:155]
buffer_load_dwordx4 a[16:19], v4, s[40:43], s35 offen offset:0 sc1
v_mfma_f32_16x16x32_bf16 v[136:139], a[100:103], a[24:27], v[136:139]
ds_read_b128 a[132:135], v5 offset:21504
v_mfma_f32_16x16x32_bf16 v[140:143], a[104:107], a[24:27], v[140:143]
ds_read_b128 a[136:139], v5 offset:22528
v_mfma_f32_16x16x32_bf16 v[156:159], a[104:107], a[28:31], v[156:159]
ds_read_b128 a[140:143], v5 offset:23552
v_mfma_f32_16x16x32_bf16 v[160:163], a[108:111], a[28:31], v[160:163]
buffer_load_dwordx4 a[20:23], v4, s[40:43], s35 offen offset:1024 sc1
v_mfma_f32_16x16x32_bf16 v[144:147], a[108:111], a[24:27], v[144:147]
s_waitcnt vmcnt(8) lgkmcnt(4)
v_mfma_f32_16x16x32_bf16 v[132:135], a[112:115], a[32:35], v[132:135]
s_cmp_eq_u32 s3, 1
s_cselect_b32 s35, 17, 9
s_lshl_b32 s35, s35, 12
v_mfma_f32_16x16x32_bf16 v[148:151], a[112:115], a[36:39], v[148:151]
ds_read_b128 a[96:99], v5 offset:24576
v_mfma_f32_16x16x32_bf16 v[152:155], a[116:119], a[36:39], v[152:155]
buffer_load_dwordx4 a[24:27], v4, s[40:43], s35 offen offset:0 sc1
v_mfma_f32_16x16x32_bf16 v[136:139], a[116:119], a[32:35], v[136:139]
ds_read_b128 a[100:103], v5 offset:25600
v_mfma_f32_16x16x32_bf16 v[140:143], a[120:123], a[32:35], v[140:143]
ds_read_b128 a[104:107], v5 offset:26624
v_mfma_f32_16x16x32_bf16 v[156:159], a[120:123], a[36:39], v[156:159]
ds_read_b128 a[108:111], v5 offset:27648
v_mfma_f32_16x16x32_bf16 v[160:163], a[124:127], a[36:39], v[160:163]
buffer_load_dwordx4 a[28:31], v4, s[40:43], s35 offen offset:1024 sc1
v_mfma_f32_16x16x32_bf16 v[144:147], a[124:127], a[32:35], v[144:147]
s_waitcnt vmcnt(8) lgkmcnt(4)
v_mfma_f32_16x16x32_bf16 v[132:135], a[128:131], a[40:43], v[132:135]
s_cmp_eq_u32 s3, 2
s_cselect_b32 s35, 18, 10
s_lshl_b32 s35, s35, 12
v_mfma_f32_16x16x32_bf16 v[148:151], a[128:131], a[44:47], v[148:151]
ds_read_b128 a[112:115], v5 offset:28672
v_mfma_f32_16x16x32_bf16 v[152:155], a[132:135], a[44:47], v[152:155]
buffer_load_dwordx4 a[32:35], v4, s[40:43], s35 offen offset:0 sc1
v_mfma_f32_16x16x32_bf16 v[136:139], a[132:135], a[40:43], v[136:139]
ds_read_b128 a[116:119], v5 offset:29696
v_mfma_f32_16x16x32_bf16 v[140:143], a[136:139], a[40:43], v[140:143]
ds_read_b128 a[120:123], v5 offset:30720
v_mfma_f32_16x16x32_bf16 v[156:159], a[136:139], a[44:47], v[156:159]
ds_read_b128 a[124:127], v5 offset:31744
v_mfma_f32_16x16x32_bf16 v[160:163], a[140:143], a[44:47], v[160:163]
buffer_load_dwordx4 a[36:39], v4, s[40:43], s35 offen offset:1024 sc1
v_mfma_f32_16x16x32_bf16 v[144:147], a[140:143], a[40:43], v[144:147]
s_waitcnt vmcnt(8) lgkmcnt(4)
v_mfma_f32_16x16x32_bf16 v[132:135], a[96:99], a[0:3], v[132:135]
s_cmp_eq_u32 s3, 3
s_cselect_b32 s35, 19, 11
s_lshl_b32 s35, s35, 12
v_mfma_f32_16x16x32_bf16 v[148:151], a[96:99], a[4:7], v[148:151]
ds_read_b128 a[128:131], v5 offset:32768
v_mfma_f32_16x16x32_bf16 v[152:155], a[100:103], a[4:7], v[152:155]
buffer_load_dwordx4 a[40:43], v4, s[40:43], s35 offen offset:0 sc1
v_mfma_f32_16x16x32_bf16 v[136:139], a[100:103], a[0:3], v[136:139]
ds_read_b128 a[132:135], v5 offset:33792
v_mfma_f32_16x16x32_bf16 v[140:143], a[104:107], a[0:3], v[140:143]
ds_read_b128 a[136:139], v5 offset:34816
v_mfma_f32_16x16x32_bf16 v[156:159], a[104:107], a[4:7], v[156:159]
ds_read_b128 a[140:143], v5 offset:35840
v_mfma_f32_16x16x32_bf16 v[160:163], a[108:111], a[4:7], v[160:163]
buffer_load_dwordx4 a[44:47], v4, s[40:43], s35 offen offset:1024 sc1
v_mfma_f32_16x16x32_bf16 v[144:147], a[108:111], a[0:3], v[144:147]
s_waitcnt vmcnt(8) lgkmcnt(4)
v_mfma_f32_16x16x32_bf16 v[132:135], a[112:115], a[8:11], v[132:135]
s_cmp_eq_u32 s3, 4
s_cselect_b32 s35, 20, 12
s_lshl_b32 s35, s35, 12
v_mfma_f32_16x16x32_bf16 v[148:151], a[112:115], a[12:15], v[148:151]
ds_read_b128 a[96:99], v5 offset:36864
v_mfma_f32_16x16x32_bf16 v[152:155], a[116:119], a[12:15], v[152:155]
buffer_load_dwordx4 a[0:3], v4, s[40:43], s35 offen offset:0 sc1
v_mfma_f32_16x16x32_bf16 v[136:139], a[116:119], a[8:11], v[136:139]
ds_read_b128 a[100:103], v5 offset:37888
v_mfma_f32_16x16x32_bf16 v[140:143], a[120:123], a[8:11], v[140:143]
ds_read_b128 a[104:107], v5 offset:38912
v_mfma_f32_16x16x32_bf16 v[156:159], a[120:123], a[12:15], v[156:159]
ds_read_b128 a[108:111], v5 offset:39936
v_mfma_f32_16x16x32_bf16 v[160:163], a[124:127], a[12:15], v[160:163]
buffer_load_dwordx4 a[4:7], v4, s[40:43], s35 offen offset:1024 sc1
v_mfma_f32_16x16x32_bf16 v[144:147], a[124:127], a[8:11], v[144:147]
s_waitcnt vmcnt(8) lgkmcnt(4)
v_mfma_f32_16x16x32_bf16 v[132:135], a[128:131], a[16:19], v[132:135]
s_cmp_eq_u32 s3, 5
s_cselect_b32 s35, 21, 13
s_lshl_b32 s35, s35, 12
v_mfma_f32_16x16x32_bf16 v[148:151], a[128:131], a[20:23], v[148:151]
ds_read_b128 a[112:115], v5 offset:40960
v_mfma_f32_16x16x32_bf16 v[152:155], a[132:135], a[20:23], v[152:155]
buffer_load_dwordx4 a[8:11], v4, s[40:43], s35 offen offset:0 sc1
v_mfma_f32_16x16x32_bf16 v[136:139], a[132:135], a[16:19], v[136:139]
ds_read_b128 a[116:119], v5 offset:41984
v_mfma_f32_16x16x32_bf16 v[140:143], a[136:139], a[16:19], v[140:143]
ds_read_b128 a[120:123], v5 offset:43008
v_mfma_f32_16x16x32_bf16 v[156:159], a[136:139], a[20:23], v[156:159]
ds_read_b128 a[124:127], v5 offset:44032
v_mfma_f32_16x16x32_bf16 v[160:163], a[140:143], a[20:23], v[160:163]
buffer_load_dwordx4 a[12:15], v4, s[40:43], s35 offen offset:1024 sc1
v_mfma_f32_16x16x32_bf16 v[144:147], a[140:143], a[16:19], v[144:147]
s_waitcnt vmcnt(8) lgkmcnt(4)
v_mfma_f32_16x16x32_bf16 v[132:135], a[96:99], a[24:27], v[132:135]
s_cmp_eq_u32 s3, 6
s_cselect_b32 s35, 22, 14
s_lshl_b32 s35, s35, 12
v_mfma_f32_16x16x32_bf16 v[148:151], a[96:99], a[28:31], v[148:151]
ds_read_b128 a[128:131], v5 offset:45056
v_mfma_f32_16x16x32_bf16 v[152:155], a[100:103], a[28:31], v[152:155]
buffer_load_dwordx4 a[16:19], v4, s[40:43], s35 offen offset:0 sc1
v_mfma_f32_16x16x32_bf16 v[136:139], a[100:103], a[24:27], v[136:139]
ds_read_b128 a[132:135], v5 offset:46080
v_mfma_f32_16x16x32_bf16 v[140:143], a[104:107], a[24:27], v[140:143]
ds_read_b128 a[136:139], v5 offset:47104
v_mfma_f32_16x16x32_bf16 v[156:159], a[104:107], a[28:31], v[156:159]
ds_read_b128 a[140:143], v5 offset:48128
v_mfma_f32_16x16x32_bf16 v[160:163], a[108:111], a[28:31], v[160:163]
buffer_load_dwordx4 a[20:23], v4, s[40:43], s35 offen offset:1024 sc1
v_mfma_f32_16x16x32_bf16 v[144:147], a[108:111], a[24:27], v[144:147]
s_waitcnt vmcnt(8) lgkmcnt(4)
v_mfma_f32_16x16x32_bf16 v[132:135], a[112:115], a[32:35], v[132:135]
s_cmp_eq_u32 s3, 7
s_cselect_b32 s35, 23, 15
s_lshl_b32 s35, s35, 12
v_mfma_f32_16x16x32_bf16 v[148:151], a[112:115], a[36:39], v[148:151]
ds_read_b128 a[96:99], v5 offset:49152
v_mfma_f32_16x16x32_bf16 v[152:155], a[116:119], a[36:39], v[152:155]
buffer_load_dwordx4 a[24:27], v4, s[40:43], s35 offen offset:0 sc1
v_mfma_f32_16x16x32_bf16 v[136:139], a[116:119], a[32:35], v[136:139]
ds_read_b128 a[100:103], v5 offset:50176
v_mfma_f32_16x16x32_bf16 v[140:143], a[120:123], a[32:35], v[140:143]
ds_read_b128 a[104:107], v5 offset:51200
v_mfma_f32_16x16x32_bf16 v[156:159], a[120:123], a[36:39], v[156:159]
ds_read_b128 a[108:111], v5 offset:52224
v_mfma_f32_16x16x32_bf16 v[160:163], a[124:127], a[36:39], v[160:163]
buffer_load_dwordx4 a[28:31], v4, s[40:43], s35 offen offset:1024 sc1
v_mfma_f32_16x16x32_bf16 v[144:147], a[124:127], a[32:35], v[144:147]
s_waitcnt vmcnt(8) lgkmcnt(4)
v_mfma_f32_16x16x32_bf16 v[132:135], a[128:131], a[40:43], v[132:135]
s_cmp_eq_u32 s3, 0
s_cselect_b32 s35, 24, 16
s_lshl_b32 s35, s35, 12
v_mfma_f32_16x16x32_bf16 v[148:151], a[128:131], a[44:47], v[148:151]
ds_read_b128 a[112:115], v5 offset:53248
v_mfma_f32_16x16x32_bf16 v[152:155], a[132:135], a[44:47], v[152:155]
buffer_load_dwordx4 a[32:35], v4, s[40:43], s35 offen offset:0 sc1
v_mfma_f32_16x16x32_bf16 v[136:139], a[132:135], a[40:43], v[136:139]
ds_read_b128 a[116:119], v5 offset:54272
v_mfma_f32_16x16x32_bf16 v[140:143], a[136:139], a[40:43], v[140:143]
ds_read_b128 a[120:123], v5 offset:55296
v_mfma_f32_16x16x32_bf16 v[156:159], a[136:139], a[44:47], v[156:159]
ds_read_b128 a[124:127], v5 offset:56320
v_mfma_f32_16x16x32_bf16 v[160:163], a[140:143], a[44:47], v[160:163]
buffer_load_dwordx4 a[36:39], v4, s[40:43], s35 offen offset:1024 sc1
v_mfma_f32_16x16x32_bf16 v[144:147], a[140:143], a[40:43], v[144:147]
s_waitcnt vmcnt(8) lgkmcnt(4)
v_mfma_f32_16x16x32_bf16 v[132:135], a[96:99], a[0:3], v[132:135]
s_cmp_eq_u32 s3, 1
s_cselect_b32 s35, 25, 17
s_lshl_b32 s35, s35, 12
v_mfma_f32_16x16x32_bf16 v[148:151], a[96:99], a[4:7], v[148:151]
ds_read_b128 a[128:131], v5 offset:57344
v_mfma_f32_16x16x32_bf16 v[152:155], a[100:103], a[4:7], v[152:155]
buffer_load_dwordx4 a[40:43], v4, s[40:43], s35 offen offset:0 sc1
v_mfma_f32_16x16x32_bf16 v[136:139], a[100:103], a[0:3], v[136:139]
ds_read_b128 a[132:135], v5 offset:58368
v_mfma_f32_16x16x32_bf16 v[140:143], a[104:107], a[0:3], v[140:143]
ds_read_b128 a[136:139], v5 offset:59392
v_mfma_f32_16x16x32_bf16 v[156:159], a[104:107], a[4:7], v[156:159]
ds_read_b128 a[140:143], v5 offset:60416
v_mfma_f32_16x16x32_bf16 v[160:163], a[108:111], a[4:7], v[160:163]
buffer_load_dwordx4 a[44:47], v4, s[40:43], s35 offen offset:1024 sc1
v_mfma_f32_16x16x32_bf16 v[144:147], a[108:111], a[0:3], v[144:147]
s_waitcnt vmcnt(8) lgkmcnt(4)
v_mfma_f32_16x16x32_bf16 v[132:135], a[112:115], a[8:11], v[132:135]
s_cmp_eq_u32 s3, 2
s_cselect_b32 s35, 26, 18
s_lshl_b32 s35, s35, 12
v_mfma_f32_16x16x32_bf16 v[148:151], a[112:115], a[12:15], v[148:151]
ds_read_b128 a[96:99], v5 offset:61440
v_mfma_f32_16x16x32_bf16 v[152:155], a[116:119], a[12:15], v[152:155]
buffer_load_dwordx4 a[0:3], v4, s[40:43], s35 offen offset:0 sc1
v_mfma_f32_16x16x32_bf16 v[136:139], a[116:119], a[8:11], v[136:139]
ds_read_b128 a[100:103], v5 offset:62464
v_mfma_f32_16x16x32_bf16 v[140:143], a[120:123], a[8:11], v[140:143]
ds_read_b128 a[104:107], v5 offset:63488
v_mfma_f32_16x16x32_bf16 v[156:159], a[120:123], a[12:15], v[156:159]
ds_read_b128 a[108:111], v5 offset:64512
v_mfma_f32_16x16x32_bf16 v[160:163], a[124:127], a[12:15], v[160:163]
buffer_load_dwordx4 a[4:7], v4, s[40:43], s35 offen offset:1024 sc1
v_mfma_f32_16x16x32_bf16 v[144:147], a[124:127], a[8:11], v[144:147]
s_waitcnt vmcnt(8) lgkmcnt(4)
v_mfma_f32_16x16x32_bf16 v[132:135], a[128:131], a[16:19], v[132:135]
s_cmp_eq_u32 s3, 3
s_cselect_b32 s35, 27, 19
s_lshl_b32 s35, s35, 12
v_mfma_f32_16x16x32_bf16 v[148:151], a[128:131], a[20:23], v[148:151]
ds_read_b128 a[112:115], v6 offset:0
v_mfma_f32_16x16x32_bf16 v[152:155], a[132:135], a[20:23], v[152:155]
buffer_load_dwordx4 a[8:11], v4, s[40:43], s35 offen offset:0 sc1
v_mfma_f32_16x16x32_bf16 v[136:139], a[132:135], a[16:19], v[136:139]
ds_read_b128 a[116:119], v6 offset:1024
v_mfma_f32_16x16x32_bf16 v[140:143], a[136:139], a[16:19], v[140:143]
ds_read_b128 a[120:123], v6 offset:2048
v_mfma_f32_16x16x32_bf16 v[156:159], a[136:139], a[20:23], v[156:159]
ds_read_b128 a[124:127], v6 offset:3072
v_mfma_f32_16x16x32_bf16 v[160:163], a[140:143], a[20:23], v[160:163]
buffer_load_dwordx4 a[12:15], v4, s[40:43], s35 offen offset:1024 sc1
v_mfma_f32_16x16x32_bf16 v[144:147], a[140:143], a[16:19], v[144:147]
s_waitcnt vmcnt(8) lgkmcnt(4)
v_mfma_f32_16x16x32_bf16 v[132:135], a[96:99], a[24:27], v[132:135]
s_cmp_eq_u32 s3, 4
s_cselect_b32 s35, 28, 20
s_lshl_b32 s35, s35, 12
v_mfma_f32_16x16x32_bf16 v[148:151], a[96:99], a[28:31], v[148:151]
ds_read_b128 a[128:131], v6 offset:4096
v_mfma_f32_16x16x32_bf16 v[152:155], a[100:103], a[28:31], v[152:155]
buffer_load_dwordx4 a[16:19], v4, s[40:43], s35 offen offset:0 sc1
v_mfma_f32_16x16x32_bf16 v[136:139], a[100:103], a[24:27], v[136:139]
ds_read_b128 a[132:135], v6 offset:5120
v_mfma_f32_16x16x32_bf16 v[140:143], a[104:107], a[24:27], v[140:143]
ds_read_b128 a[136:139], v6 offset:6144
v_mfma_f32_16x16x32_bf16 v[156:159], a[104:107], a[28:31], v[156:159]
ds_read_b128 a[140:143], v6 offset:7168
v_mfma_f32_16x16x32_bf16 v[160:163], a[108:111], a[28:31], v[160:163]
buffer_load_dwordx4 a[20:23], v4, s[40:43], s35 offen offset:1024 sc1
v_mfma_f32_16x16x32_bf16 v[144:147], a[108:111], a[24:27], v[144:147]
s_waitcnt vmcnt(8) lgkmcnt(4)
v_mfma_f32_16x16x32_bf16 v[132:135], a[112:115], a[32:35], v[132:135]
s_cmp_eq_u32 s3, 5
s_cselect_b32 s35, 29, 21
s_lshl_b32 s35, s35, 12
v_mfma_f32_16x16x32_bf16 v[148:151], a[112:115], a[36:39], v[148:151]
ds_read_b128 a[96:99], v6 offset:8192
v_mfma_f32_16x16x32_bf16 v[152:155], a[116:119], a[36:39], v[152:155]
buffer_load_dwordx4 a[24:27], v4, s[40:43], s35 offen offset:0 sc1
v_mfma_f32_16x16x32_bf16 v[136:139], a[116:119], a[32:35], v[136:139]
ds_read_b128 a[100:103], v6 offset:9216
v_mfma_f32_16x16x32_bf16 v[140:143], a[120:123], a[32:35], v[140:143]
ds_read_b128 a[104:107], v6 offset:10240
v_mfma_f32_16x16x32_bf16 v[156:159], a[120:123], a[36:39], v[156:159]
ds_read_b128 a[108:111], v6 offset:11264
v_mfma_f32_16x16x32_bf16 v[160:163], a[124:127], a[36:39], v[160:163]
buffer_load_dwordx4 a[28:31], v4, s[40:43], s35 offen offset:1024 sc1
v_mfma_f32_16x16x32_bf16 v[144:147], a[124:127], a[32:35], v[144:147]
s_waitcnt vmcnt(8) lgkmcnt(4)
v_mfma_f32_16x16x32_bf16 v[132:135], a[128:131], a[40:43], v[132:135]
s_cmp_eq_u32 s3, 6
s_cselect_b32 s35, 30, 22
s_lshl_b32 s35, s35, 12
v_mfma_f32_16x16x32_bf16 v[148:151], a[128:131], a[44:47], v[148:151]
ds_read_b128 a[112:115], v6 offset:12288
v_mfma_f32_16x16x32_bf16 v[152:155], a[132:135], a[44:47], v[152:155]
buffer_load_dwordx4 a[32:35], v4, s[40:43], s35 offen offset:0 sc1
v_mfma_f32_16x16x32_bf16 v[136:139], a[132:135], a[40:43], v[136:139]
ds_read_b128 a[116:119], v6 offset:13312
v_mfma_f32_16x16x32_bf16 v[140:143], a[136:139], a[40:43], v[140:143]
ds_read_b128 a[120:123], v6 offset:14336
v_mfma_f32_16x16x32_bf16 v[156:159], a[136:139], a[44:47], v[156:159]
ds_read_b128 a[124:127], v6 offset:15360
v_mfma_f32_16x16x32_bf16 v[160:163], a[140:143], a[44:47], v[160:163]
buffer_load_dwordx4 a[36:39], v4, s[40:43], s35 offen offset:1024 sc1
v_mfma_f32_16x16x32_bf16 v[144:147], a[140:143], a[40:43], v[144:147]
s_waitcnt vmcnt(8) lgkmcnt(4)
v_mfma_f32_16x16x32_bf16 v[132:135], a[96:99], a[0:3], v[132:135]
s_cmp_eq_u32 s3, 7
s_cselect_b32 s35, 31, 23
s_lshl_b32 s35, s35, 12
v_mfma_f32_16x16x32_bf16 v[148:151], a[96:99], a[4:7], v[148:151]
ds_read_b128 a[128:131], v6 offset:16384
v_mfma_f32_16x16x32_bf16 v[152:155], a[100:103], a[4:7], v[152:155]
buffer_load_dwordx4 a[40:43], v4, s[40:43], s35 offen offset:0 sc1
v_mfma_f32_16x16x32_bf16 v[136:139], a[100:103], a[0:3], v[136:139]
ds_read_b128 a[132:135], v6 offset:17408
v_mfma_f32_16x16x32_bf16 v[140:143], a[104:107], a[0:3], v[140:143]
ds_read_b128 a[136:139], v6 offset:18432
v_mfma_f32_16x16x32_bf16 v[156:159], a[104:107], a[4:7], v[156:159]
ds_read_b128 a[140:143], v6 offset:19456
v_mfma_f32_16x16x32_bf16 v[160:163], a[108:111], a[4:7], v[160:163]
buffer_load_dwordx4 a[44:47], v4, s[40:43], s35 offen offset:1024 sc1
v_mfma_f32_16x16x32_bf16 v[144:147], a[108:111], a[0:3], v[144:147]
s_waitcnt vmcnt(8) lgkmcnt(4)
v_mfma_f32_16x16x32_bf16 v[132:135], a[112:115], a[8:11], v[132:135]
s_cmp_eq_u32 s3, 0
s_cselect_b32 s35, 0, 24
s_lshl_b32 s35, s35, 12
v_mfma_f32_16x16x32_bf16 v[148:151], a[112:115], a[12:15], v[148:151]
ds_read_b128 a[96:99], v6 offset:20480
v_mfma_f32_16x16x32_bf16 v[152:155], a[116:119], a[12:15], v[152:155]
buffer_load_dwordx4 a[0:3], v4, s[40:43], s35 offen offset:0 sc1
v_mfma_f32_16x16x32_bf16 v[136:139], a[116:119], a[8:11], v[136:139]
ds_read_b128 a[100:103], v6 offset:21504
v_mfma_f32_16x16x32_bf16 v[140:143], a[120:123], a[8:11], v[140:143]
ds_read_b128 a[104:107], v6 offset:22528
v_mfma_f32_16x16x32_bf16 v[156:159], a[120:123], a[12:15], v[156:159]
ds_read_b128 a[108:111], v6 offset:23552
v_mfma_f32_16x16x32_bf16 v[160:163], a[124:127], a[12:15], v[160:163]
buffer_load_dwordx4 a[4:7], v4, s[40:43], s35 offen offset:1024 sc1
v_mfma_f32_16x16x32_bf16 v[144:147], a[124:127], a[8:11], v[144:147]
s_waitcnt vmcnt(8) lgkmcnt(4)
v_mfma_f32_16x16x32_bf16 v[132:135], a[128:131], a[16:19], v[132:135]
s_cmp_eq_u32 s3, 1
s_cselect_b32 s35, 1, 25
s_lshl_b32 s35, s35, 12
v_mfma_f32_16x16x32_bf16 v[148:151], a[128:131], a[20:23], v[148:151]
ds_read_b128 a[112:115], v6 offset:24576
v_mfma_f32_16x16x32_bf16 v[152:155], a[132:135], a[20:23], v[152:155]
buffer_load_dwordx4 a[8:11], v4, s[40:43], s35 offen offset:0 sc1
v_mfma_f32_16x16x32_bf16 v[136:139], a[132:135], a[16:19], v[136:139]
ds_read_b128 a[116:119], v6 offset:25600
v_mfma_f32_16x16x32_bf16 v[140:143], a[136:139], a[16:19], v[140:143]
ds_read_b128 a[120:123], v6 offset:26624
v_mfma_f32_16x16x32_bf16 v[156:159], a[136:139], a[20:23], v[156:159]
ds_read_b128 a[124:127], v6 offset:27648
v_mfma_f32_16x16x32_bf16 v[160:163], a[140:143], a[20:23], v[160:163]
buffer_load_dwordx4 a[12:15], v4, s[40:43], s35 offen offset:1024 sc1
v_mfma_f32_16x16x32_bf16 v[144:147], a[140:143], a[16:19], v[144:147]
s_waitcnt vmcnt(8) lgkmcnt(4)
v_mfma_f32_16x16x32_bf16 v[132:135], a[96:99], a[24:27], v[132:135]
s_cmp_eq_u32 s3, 2
s_cselect_b32 s35, 2, 26
s_lshl_b32 s35, s35, 12
v_mfma_f32_16x16x32_bf16 v[148:151], a[96:99], a[28:31], v[148:151]
ds_read_b128 a[128:131], v6 offset:28672
v_mfma_f32_16x16x32_bf16 v[152:155], a[100:103], a[28:31], v[152:155]
buffer_load_dwordx4 a[16:19], v4, s[40:43], s35 offen offset:0 sc1
v_mfma_f32_16x16x32_bf16 v[136:139], a[100:103], a[24:27], v[136:139]
ds_read_b128 a[132:135], v6 offset:29696
v_mfma_f32_16x16x32_bf16 v[140:143], a[104:107], a[24:27], v[140:143]
ds_read_b128 a[136:139], v6 offset:30720
v_mfma_f32_16x16x32_bf16 v[156:159], a[104:107], a[28:31], v[156:159]
ds_read_b128 a[140:143], v6 offset:31744
v_mfma_f32_16x16x32_bf16 v[160:163], a[108:111], a[28:31], v[160:163]
buffer_load_dwordx4 a[20:23], v4, s[40:43], s35 offen offset:1024 sc1
v_mfma_f32_16x16x32_bf16 v[144:147], a[108:111], a[24:27], v[144:147]
s_waitcnt vmcnt(8) lgkmcnt(4)
v_mfma_f32_16x16x32_bf16 v[132:135], a[112:115], a[32:35], v[132:135]
s_cmp_eq_u32 s3, 3
s_cselect_b32 s35, 3, 27
s_lshl_b32 s35, s35, 12
v_mfma_f32_16x16x32_bf16 v[148:151], a[112:115], a[36:39], v[148:151]
ds_read_b128 a[96:99], v6 offset:32768
v_mfma_f32_16x16x32_bf16 v[152:155], a[116:119], a[36:39], v[152:155]
buffer_load_dwordx4 a[24:27], v4, s[40:43], s35 offen offset:0 sc1
v_mfma_f32_16x16x32_bf16 v[136:139], a[116:119], a[32:35], v[136:139]
ds_read_b128 a[100:103], v6 offset:33792
v_mfma_f32_16x16x32_bf16 v[140:143], a[120:123], a[32:35], v[140:143]
ds_read_b128 a[104:107], v6 offset:34816
v_mfma_f32_16x16x32_bf16 v[156:159], a[120:123], a[36:39], v[156:159]
ds_read_b128 a[108:111], v6 offset:35840
v_mfma_f32_16x16x32_bf16 v[160:163], a[124:127], a[36:39], v[160:163]
buffer_load_dwordx4 a[28:31], v4, s[40:43], s35 offen offset:1024 sc1
v_mfma_f32_16x16x32_bf16 v[144:147], a[124:127], a[32:35], v[144:147]
s_waitcnt vmcnt(8) lgkmcnt(4)
v_mfma_f32_16x16x32_bf16 v[132:135], a[128:131], a[40:43], v[132:135]
s_cmp_eq_u32 s3, 4
s_cselect_b32 s35, 4, 28
s_lshl_b32 s35, s35, 12
v_mfma_f32_16x16x32_bf16 v[148:151], a[128:131], a[44:47], v[148:151]
ds_read_b128 a[112:115], v6 offset:36864
v_mfma_f32_16x16x32_bf16 v[152:155], a[132:135], a[44:47], v[152:155]
buffer_load_dwordx4 a[32:35], v4, s[40:43], s35 offen offset:0 sc1
v_mfma_f32_16x16x32_bf16 v[136:139], a[132:135], a[40:43], v[136:139]
ds_read_b128 a[116:119], v6 offset:37888
v_mfma_f32_16x16x32_bf16 v[140:143], a[136:139], a[40:43], v[140:143]
ds_read_b128 a[120:123], v6 offset:38912
v_mfma_f32_16x16x32_bf16 v[156:159], a[136:139], a[44:47], v[156:159]
ds_read_b128 a[124:127], v6 offset:39936
v_mfma_f32_16x16x32_bf16 v[160:163], a[140:143], a[44:47], v[160:163]
buffer_load_dwordx4 a[36:39], v4, s[40:43], s35 offen offset:1024 sc1
v_mfma_f32_16x16x32_bf16 v[144:147], a[140:143], a[40:43], v[144:147]
s_waitcnt vmcnt(8) lgkmcnt(4)
v_mfma_f32_16x16x32_bf16 v[132:135], a[96:99], a[0:3], v[132:135]
s_cmp_eq_u32 s3, 5
s_cselect_b32 s35, 5, 29
s_lshl_b32 s35, s35, 12
v_mfma_f32_16x16x32_bf16 v[148:151], a[96:99], a[4:7], v[148:151]
ds_read_b128 a[128:131], v6 offset:40960
v_mfma_f32_16x16x32_bf16 v[152:155], a[100:103], a[4:7], v[152:155]
buffer_load_dwordx4 a[40:43], v4, s[40:43], s35 offen offset:0 sc1
v_mfma_f32_16x16x32_bf16 v[136:139], a[100:103], a[0:3], v[136:139]
ds_read_b128 a[132:135], v6 offset:41984
v_mfma_f32_16x16x32_bf16 v[140:143], a[104:107], a[0:3], v[140:143]
ds_read_b128 a[136:139], v6 offset:43008
v_mfma_f32_16x16x32_bf16 v[156:159], a[104:107], a[4:7], v[156:159]
ds_read_b128 a[140:143], v6 offset:44032
v_mfma_f32_16x16x32_bf16 v[160:163], a[108:111], a[4:7], v[160:163]
buffer_load_dwordx4 a[44:47], v4, s[40:43], s35 offen offset:1024 sc1
v_mfma_f32_16x16x32_bf16 v[144:147], a[108:111], a[0:3], v[144:147]
s_waitcnt vmcnt(8) lgkmcnt(4)
v_mfma_f32_16x16x32_bf16 v[132:135], a[112:115], a[8:11], v[132:135]
s_cmp_eq_u32 s3, 6
s_cselect_b32 s35, 6, 30
s_lshl_b32 s35, s35, 12
v_mfma_f32_16x16x32_bf16 v[148:151], a[112:115], a[12:15], v[148:151]
ds_read_b128 a[96:99], v6 offset:45056
v_mfma_f32_16x16x32_bf16 v[152:155], a[116:119], a[12:15], v[152:155]
buffer_load_dwordx4 a[0:3], v4, s[40:43], s35 offen offset:0 sc1
v_mfma_f32_16x16x32_bf16 v[136:139], a[116:119], a[8:11], v[136:139]
ds_read_b128 a[100:103], v6 offset:46080
v_mfma_f32_16x16x32_bf16 v[140:143], a[120:123], a[8:11], v[140:143]
ds_read_b128 a[104:107], v6 offset:47104
v_mfma_f32_16x16x32_bf16 v[156:159], a[120:123], a[12:15], v[156:159]
ds_read_b128 a[108:111], v6 offset:48128
v_mfma_f32_16x16x32_bf16 v[160:163], a[124:127], a[12:15], v[160:163]
buffer_load_dwordx4 a[4:7], v4, s[40:43], s35 offen offset:1024 sc1
v_mfma_f32_16x16x32_bf16 v[144:147], a[124:127], a[8:11], v[144:147]
s_waitcnt vmcnt(8) lgkmcnt(4)
v_mfma_f32_16x16x32_bf16 v[132:135], a[128:131], a[16:19], v[132:135]
s_cmp_eq_u32 s3, 7
s_cselect_b32 s35, 7, 31
s_lshl_b32 s35, s35, 12
v_mfma_f32_16x16x32_bf16 v[148:151], a[128:131], a[20:23], v[148:151]
ds_read_b128 a[112:115], v6 offset:49152
v_mfma_f32_16x16x32_bf16 v[152:155], a[132:135], a[20:23], v[152:155]
buffer_load_dwordx4 a[8:11], v4, s[40:43], s35 offen offset:0 sc1
v_mfma_f32_16x16x32_bf16 v[136:139], a[132:135], a[16:19], v[136:139]
ds_read_b128 a[116:119], v6 offset:50176
v_mfma_f32_16x16x32_bf16 v[140:143], a[136:139], a[16:19], v[140:143]
ds_read_b128 a[120:123], v6 offset:51200
v_mfma_f32_16x16x32_bf16 v[156:159], a[136:139], a[20:23], v[156:159]
ds_read_b128 a[124:127], v6 offset:52224
v_mfma_f32_16x16x32_bf16 v[160:163], a[140:143], a[20:23], v[160:163]
buffer_load_dwordx4 a[12:15], v4, s[40:43], s35 offen offset:1024 sc1
v_mfma_f32_16x16x32_bf16 v[144:147], a[140:143], a[16:19], v[144:147]
s_waitcnt vmcnt(8) lgkmcnt(4)
v_mfma_f32_16x16x32_bf16 v[132:135], a[96:99], a[24:27], v[132:135]
ds_read_b128 a[128:131], v6 offset:53248
v_mfma_f32_16x16x32_bf16 v[148:151], a[96:99], a[28:31], v[148:151]
ds_read_b128 a[132:135], v6 offset:54272
v_mfma_f32_16x16x32_bf16 v[152:155], a[100:103], a[28:31], v[152:155]
ds_read_b128 a[136:139], v6 offset:55296
v_mfma_f32_16x16x32_bf16 v[136:139], a[100:103], a[24:27], v[136:139]
ds_read_b128 a[140:143], v6 offset:56320
v_mfma_f32_16x16x32_bf16 v[140:143], a[104:107], a[24:27], v[140:143]
v_mfma_f32_16x16x32_bf16 v[156:159], a[104:107], a[28:31], v[156:159]
buffer_atomic_add v12, v10, s[4:7], s92 offen sc1
v_mfma_f32_16x16x32_bf16 v[160:163], a[108:111], a[28:31], v[160:163]
v_mfma_f32_16x16x32_bf16 v[144:147], a[108:111], a[24:27], v[144:147]
s_waitcnt vmcnt(7) lgkmcnt(4)
v_mfma_f32_16x16x32_bf16 v[132:135], a[112:115], a[32:35], v[132:135]
ds_read_b128 a[96:99], v6 offset:57344
v_mfma_f32_16x16x32_bf16 v[148:151], a[112:115], a[36:39], v[148:151]
ds_read_b128 a[100:103], v6 offset:58368
v_mfma_f32_16x16x32_bf16 v[152:155], a[116:119], a[36:39], v[152:155]
ds_read_b128 a[104:107], v6 offset:59392
v_mfma_f32_16x16x32_bf16 v[136:139], a[116:119], a[32:35], v[136:139]
ds_read_b128 a[108:111], v6 offset:60416
v_mfma_f32_16x16x32_bf16 v[140:143], a[120:123], a[32:35], v[140:143]
v_mfma_f32_16x16x32_bf16 v[156:159], a[120:123], a[36:39], v[156:159]
v_mfma_f32_16x16x32_bf16 v[160:163], a[124:127], a[36:39], v[160:163]
v_mfma_f32_16x16x32_bf16 v[144:147], a[124:127], a[32:35], v[144:147]
s_waitcnt vmcnt(5) lgkmcnt(4)
v_mfma_f32_16x16x32_bf16 v[132:135], a[128:131], a[40:43], v[132:135]
ds_read_b128 a[112:115], v6 offset:61440
v_mfma_f32_16x16x32_bf16 v[148:151], a[128:131], a[44:47], v[148:151]
ds_read_b128 a[116:119], v6 offset:62464
v_mfma_f32_16x16x32_bf16 v[152:155], a[132:135], a[44:47], v[152:155]
L_stub20:
s_cbranch_execz L_wret7
ds_read_b128 a[120:123], v6 offset:63488
v_mfma_f32_16x16x32_bf16 v[136:139], a[132:135], a[40:43], v[136:139]
ds_read_b128 a[124:127], v6 offset:64512
v_mfma_f32_16x16x32_bf16 v[140:143], a[136:139], a[40:43], v[140:143]
v_mfma_f32_16x16x32_bf16 v[156:159], a[136:139], a[44:47], v[156:159]
v_mfma_f32_16x16x32_bf16 v[160:163], a[140:143], a[44:47], v[160:163]
v_mfma_f32_16x16x32_bf16 v[144:147], a[140:143], a[40:43], v[144:147]
s_waitcnt vmcnt(3) lgkmcnt(4)
v_mfma_f32_16x16x32_bf16 v[132:135], a[96:99], a[0:3], v[132:135]
v_mfma_f32_16x16x32_bf16 v[148:151], a[96:99], a[4:7], v[148:151]
v_mfma_f32_16x16x32_bf16 v[152:155], a[100:103], a[4:7], v[152:155]
v_mfma_f32_16x16x32_bf16 v[136:139], a[100:103], a[0:3], v[136:139]
v_mfma_f32_16x16x32_bf16 v[140:143], a[104:107], a[0:3], v[140:143]
v_mfma_f32_16x16x32_bf16 v[156:159], a[104:107], a[4:7], v[156:159]
v_mfma_f32_16x16x32_bf16 v[160:163], a[108:111], a[4:7], v[160:163]
v_mfma_f32_16x16x32_bf16 v[144:147], a[108:111], a[0:3], v[144:147]
s_waitcnt vmcnt(1) lgkmcnt(0)
v_mfma_f32_16x16x32_bf16 v[132:135], a[112:115], a[8:11], v[132:135]
v_mfma_f32_16x16x32_bf16 v[148:151], a[112:115], a[12:15], v[148:151]
v_mfma_f32_16x16x32_bf16 v[152:155], a[116:119], a[12:15], v[152:155]
v_mfma_f32_16x16x32_bf16 v[136:139], a[116:119], a[8:11], v[136:139]
v_mfma_f32_16x16x32_bf16 v[140:143], a[120:123], a[8:11], v[140:143]
v_mfma_f32_16x16x32_bf16 v[156:159], a[120:123], a[12:15], v[156:159]
v_mfma_f32_16x16x32_bf16 v[160:163], a[124:127], a[12:15], v[160:163]
v_mfma_f32_16x16x32_bf16 v[144:147], a[124:127], a[8:11], v[144:147]
s_nop 1
v_cmp_u_f32 vcc, v132, v148
s_nop 0
s_and_b32 vcc_lo, vcc_lo, s95
s_cbranch_scc1 L_k2redo3
s_and_b32 s36, s31, 7
s_lshl_b32 s36, s36, 7
s_lshl_b32 s37, s28, 5
s_add_u32 s36, s36, s37
s_lshl_b32 s36, s36, 1
s_lshr_b32 s37, s31, 3
s_add_u32 s36, s36, s37
s_lshl_b32 s36, s36, 11
s_lshl_b32 s37, s32, 7
v_and_b32 v234, 15, v0
s_add_u32 s36, s36, s37
v_lshrrev_b32 v233, 4, v0
v_lshl_add_u32 v232, v234, 12, s36
v_cvt_pk_bf16_f32 v32, v132, v133
v_cvt_pk_bf16_f32 v33, v134, v135
v_cvt_pk_bf16_f32 v34, v136, v137
v_cvt_pk_bf16_f32 v35, v138, v139
v_lshl_add_u32 v232, v233, 4, v232
buffer_store_dwordx4 v[32:35], v232, s[12:15], 0 offen offset:0
v_cvt_pk_bf16_f32 v36, v140, v141
v_cvt_pk_bf16_f32 v37, v142, v143
v_cvt_pk_bf16_f32 v38, v144, v145
v_cvt_pk_bf16_f32 v39, v146, v147
v_cvt_pk_bf16_f32 v40, v148, v149
v_cvt_pk_bf16_f32 v41, v150, v151
v_cvt_pk_bf16_f32 v42, v152, v153
v_cvt_pk_bf16_f32 v43, v154, v155
s_mov_b32 s36, 0x10000
v_cvt_pk_bf16_f32 v44, v156, v157
v_cvt_pk_bf16_f32 v45, v158, v159
v_cvt_pk_bf16_f32 v46, v160, v161
buffer_store_dwordx4 v[36:39], v232, s[12:15], 0 offen offset:64
v_cvt_pk_bf16_f32 v47, v162, v163
buffer_store_dwordx4 v[40:43], v232, s[12:15], s36 offen offset:0
buffer_store_dwordx4 v[44:47], v232, s[12:15], s36 offen offset:64
s_or_b32 s36, s2, s28
s_cbranch_scc1 Lep_38
s_mov_b32 s36, 0xf0000
buffer_store_dword v15, off, s[4:7], s36 sc1
Lep_38:
L_end:
s_endpgm
Ltr_7:
s_add_u32 s52, s67, 0xe0000
s_mov_b32 s53, 0
Ltp_8:
s_sleep 4
buffer_load_dword v11, v255, s[4:7], s52 offen sc1
s_add_u32 s53, s53, 1
s_waitcnt vmcnt(0)
v_cmp_ne_u32 vcc, v11, v15
s_cbranch_vccz Lte_9
s_cmp_lt_u32 s53, 0x100000
s_cbranch_scc1 Ltp_8
s_branch Lte_9
Ltr_10:
s_add_u32 s52, s66, 0xd0040
s_mov_b32 s53, 0
Ltp_11:
s_sleep 4
buffer_load_dword v232, v255, s[4:7], s52 offen sc1
s_add_u32 s53, s53, 1
s_waitcnt vmcnt(0)
v_cmp_ne_u32 vcc, v232, v15
s_cbranch_vccz Lte_12
s_cmp_lt_u32 s53, 0x100000
s_cbranch_scc1 Ltp_11
s_branch Lte_12
L_kvredo1:
s_mov_b32 s88, 0
L_kvredo1b:
v_max_u32 v132, v48, v49
v_max3_u32 v132, v132, v50, v51
v_max3_u32 v132, v132, v52, v53
v_max3_u32 v132, v132, v54, v55
v_max3_u32 v132, v132, v56, v57
v_max3_u32 v132, v132, v58, v59
v_max3_u32 v132, v132, v60, v61
v_max3_u32 v132, v132, v62, v63
v_max3_u32 v132, v132, v64, v65
v_max3_u32 v132, v132, v66, v67
v_max3_u32 v132, v132, v68, v69
v_max3_u32 v132, v132, v70, v71
v_max3_u32 v132, v132, v100, v101
v_max3_u32 v132, v132, v102, v103
v_max3_u32 v132, v132, v104, v105
v_max3_u32 v132, v132, v106, v107
v_max3_u32 v132, v132, v124, v125
v_max3_u32 v132, v132, v126, v127
v_cmp_eq_u32 vcc, -1, v132
s_cbranch_vccz L_kvback1
s_add_u32 s88, s88, 1
s_cmp_gt_u32 s88, 0x80000
s_cbranch_scc1 L_kvback1
s_sleep 4
s_lshl_b32 s37, s30, 2
s_add_u32 s37, s37, s28
s_lshl_b32 s38, s37, 13
s_add_u32 s38, s38, 0x400000
s_add_u32 s36, s38, 4096
s_lshl_b32 s39, s37, 10
s_add_u32 s39, s39, 0x800000
v_and_b32 v248, 7, v0
v_lshlrev_b32 v248, 7, v248
v_lshrrev_b32 v249, 4, v0
v_lshl_add_u32 v248, v249, 4, v248
buffer_load_dwordx4 v[48:51], v1, s[4:7], s38 offen offset:0 sc1
buffer_load_dwordx4 v[124:127], v248, s[4:7], s39 offen sc1
buffer_load_dwordx4 v[52:55], v1, s[4:7], s38 offen offset:1024 sc1
buffer_load_dwordx4 v[56:59], v1, s[4:7], s38 offen offset:2048 sc1
buffer_load_dwordx4 v[60:63], v1, s[4:7], s38 offen offset:3072 sc1
buffer_load_dwordx4 v[64:67], v1, s[4:7], s36 offen offset:0 sc1
buffer_load_dwordx4 v[68:71], v1, s[4:7], s36 offen offset:1024 sc1
buffer_load_dwordx4 v[100:103], v1, s[4:7], s36 offen offset:2048 sc1
buffer_load_dwordx4 v[104:107], v1, s[4:7], s36 offen offset:3072 sc1
v_mov_b32 v249, 0x3f80
v_mov_b32 v250, 1.0
s_waitcnt vmcnt(8)
v_lshlrev_b32 v92, 16, v48
v_and_b32 v93, 0xffff0000, v48
v_lshlrev_b32 v94, 16, v49
v_and_b32 v95, 0xffff0000, v49
v_lshlrev_b32 v96, 16, v50
v_and_b32 v97, 0xffff0000, v50
v_lshlrev_b32 v98, 16, v51
v_and_b32 v99, 0xffff0000, v51
s_waitcnt vmcnt(7)
v_add_f32_dpp v128, v124, v124 row_ror:4 row_mask:0xf bank_mask:0xf
v_add_f32_dpp v129, v125, v125 row_ror:4 row_mask:0xf bank_mask:0xf
v_add_f32_dpp v130, v126, v126 row_ror:4 row_mask:0xf bank_mask:0xf
v_add_f32_dpp v131, v127, v127 row_ror:4 row_mask:0xf bank_mask:0xf
v_add_f32_dpp v128, v128, v128 row_ror:2 row_mask:0xf bank_mask:0xf
v_add_f32_dpp v129, v129, v129 row_ror:2 row_mask:0xf bank_mask:0xf
v_add_f32_dpp v130, v130, v130 row_ror:2 row_mask:0xf bank_mask:0xf
v_add_f32_dpp v131, v131, v131 row_ror:2 row_mask:0xf bank_mask:0xf
v_add_f32_dpp v128, v128, v128 row_ror:1 row_mask:0xf bank_mask:0xf
v_add_f32_dpp v129, v129, v129 row_ror:1 row_mask:0xf bank_mask:0xf
v_add_f32_dpp v130, v130, v130 row_ror:1 row_mask:0xf bank_mask:0xf
v_add_f32_dpp v131, v131, v131 row_ror:1 row_mask:0xf bank_mask:0xf
s_waitcnt vmcnt(6)
v_dot2c_f32_bf16 v92, v52, v249
v_dot2c_f32_bf16 v93, v52, v250
v_dot2c_f32_bf16 v94, v53, v249
v_dot2c_f32_bf16 v95, v53, v250
v_dot2c_f32_bf16 v96, v54, v249
v_dot2c_f32_bf16 v97, v54, v250
v_dot2c_f32_bf16 v98, v55, v249
v_dot2c_f32_bf16 v99, v55, v250
s_waitcnt vmcnt(5)
v_dot2c_f32_bf16 v92, v56, v249
v_dot2c_f32_bf16 v93, v56, v250
v_dot2c_f32_bf16 v94, v57, v249
v_dot2c_f32_bf16 v95, v57, v250
v_dot2c_f32_bf16 v96, v58, v249
v_dot2c_f32_bf16 v97, v58, v250
v_dot2c_f32_bf16 v98, v59, v249
v_dot2c_f32_bf16 v99, v59, v250
s_waitcnt vmcnt(4)
v_dot2c_f32_bf16 v92, v60, v249
v_dot2c_f32_bf16 v93, v60, v250
v_dot2c_f32_bf16 v94, v61, v249
v_dot2c_f32_bf16 v95, v61, v250
v_dot2c_f32_bf16 v96, v62, v249
v_dot2c_f32_bf16 v97, v62, v250
v_dot2c_f32_bf16 v98, v63, v249
v_dot2c_f32_bf16 v99, v63, v250
s_waitcnt vmcnt(3)
v_dot2c_f32_bf16 v92, v64, v249
v_dot2c_f32_bf16 v93, v64, v250
v_dot2c_f32_bf16 v94, v65, v249
v_dot2c_f32_bf16 v95, v65, v250
v_dot2c_f32_bf16 v96, v66, v249
v_dot2c_f32_bf16 v97, v66, v250
v_dot2c_f32_bf16 v98, v67, v249
v_dot2c_f32_bf16 v99, v67, v250
s_waitcnt vmcnt(2)
v_dot2c_f32_bf16 v92, v68, v249
v_dot2c_f32_bf16 v93, v68, v250
v_dot2c_f32_bf16 v94, v69, v249
v_dot2c_f32_bf16 v95, v69, v250
v_dot2c_f32_bf16 v96, v70, v249
v_dot2c_f32_bf16 v97, v70, v250
v_dot2c_f32_bf16 v98, v71, v249
v_dot2c_f32_bf16 v99, v71, v250
s_waitcnt vmcnt(1)
v_dot2c_f32_bf16 v92, v100, v249
v_dot2c_f32_bf16 v93, v100, v250
v_dot2c_f32_bf16 v94, v101, v249
v_dot2c_f32_bf16 v95, v101, v250
v_dot2c_f32_bf16 v96, v102, v249
v_dot2c_f32_bf16 v97, v102, v250
v_dot2c_f32_bf16 v98, v103, v249
v_dot2c_f32_bf16 v99, v103, v250
s_waitcnt vmcnt(0)
v_dot2c_f32_bf16 v92, v104, v249
v_dot2c_f32_bf16 v93, v104, v250
v_dot2c_f32_bf16 v94, v105, v249
v_dot2c_f32_bf16 v95, v105, v250
v_dot2c_f32_bf16 v96, v106, v249
v_dot2c_f32_bf16 v97, v106, v250
v_dot2c_f32_bf16 v98, v107, v249
v_dot2c_f32_bf16 v99, v107, v250
s_nop 2
s_branch L_kvredo1b
L_k2redo1:
s_mov_b32 s95, 0
s_mov_b32 s92, 0x40000000
s_mov_b32 s93, 0x40000000
s_mov_b32 s94, 0x40000000
s_add_u32 s36, s66, 0x10000
s_mov_b32 s37, 0
Lpoll_39:
v_mov_b32 v11, 0
buffer_atomic_add v11, v251, s[4:7], s36 offen sc0 sc1
s_add_u32 s37, s37, 1
s_waitcnt vmcnt(0)
v_readfirstlane_b32 s38, v11
s_nop 0
s_cmp_ge_u32 s38, 32
s_cbranch_scc1 Lpe_40
s_cmp_lt_u32 s37, 0x100000
s_cbranch_scc1 Lpoll_39
Lpe_40:
s_nop 7
s_cmp_eq_u32 s3, 0
s_cselect_b32 s35, 8, 0
s_lshl_b32 s35, s35, 12
v_lshlrev_b32 v132, 16, v32
v_and_b32 v133, 0xffff0000, v32
v_lshlrev_b32 v134, 16, v33
v_and_b32 v135, 0xffff0000, v33
v_lshlrev_b32 v136, 16, v34
v_and_b32 v137, 0xffff0000, v34
v_lshlrev_b32 v138, 16, v35
v_and_b32 v139, 0xffff0000, v35
v_lshlrev_b32 v140, 16, v36
v_and_b32 v141, 0xffff0000, v36
v_lshlrev_b32 v142, 16, v37
v_and_b32 v143, 0xffff0000, v37
v_lshlrev_b32 v144, 16, v38
v_and_b32 v145, 0xffff0000, v38
v_lshlrev_b32 v146, 16, v39
v_and_b32 v147, 0xffff0000, v39
v_lshlrev_b32 v148, 16, v40
v_and_b32 v149, 0xffff0000, v40
v_lshlrev_b32 v150, 16, v41
v_and_b32 v151, 0xffff0000, v41
v_lshlrev_b32 v152, 16, v42
v_and_b32 v153, 0xffff0000, v42
v_lshlrev_b32 v154, 16, v43
v_and_b32 v155, 0xffff0000, v43
v_lshlrev_b32 v156, 16, v44
v_and_b32 v157, 0xffff0000, v44
v_lshlrev_b32 v158, 16, v45
v_and_b32 v159, 0xffff0000, v45
v_lshlrev_b32 v160, 16, v46
v_and_b32 v161, 0xffff0000, v46
v_lshlrev_b32 v162, 16, v47
v_and_b32 v163, 0xffff0000, v47
s_branch L_k2go1
L_k2redo2:
s_mov_b32 s95, 0
s_mov_b32 s92, 0x40000000
s_mov_b32 s93, 0x40000000
s_mov_b32 s94, 0x40000000
s_add_u32 s36, s66, 0x20000
s_mov_b32 s37, 0
Lpoll_41:
v_mov_b32 v11, 0
buffer_atomic_add v11, v251, s[4:7], s36 offen sc0 sc1
s_add_u32 s37, s37, 1
s_waitcnt vmcnt(0)
v_readfirstlane_b32 s38, v11
s_nop 0
s_cmp_ge_u32 s38, 32
s_cbranch_scc1 Lpe_42
s_cmp_lt_u32 s37, 0x100000
s_cbranch_scc1 Lpoll_41
Lpe_42:
s_nop 7
s_cmp_eq_u32 s3, 0
s_cselect_b32 s35, 8, 0
s_lshl_b32 s35, s35, 12
v_lshlrev_b32 v132, 16, v32
v_and_b32 v133, 0xffff0000, v32
v_lshlrev_b32 v134, 16, v33
v_and_b32 v135, 0xffff0000, v33
v_lshlrev_b32 v136, 16, v34
v_and_b32 v137, 0xffff0000, v34
v_lshlrev_b32 v138, 16, v35
v_and_b32 v139, 0xffff0000, v35
v_lshlrev_b32 v140, 16, v36
v_and_b32 v141, 0xffff0000, v36
v_lshlrev_b32 v142, 16, v37
v_and_b32 v143, 0xffff0000, v37
v_lshlrev_b32 v144, 16, v38
v_and_b32 v145, 0xffff0000, v38
v_lshlrev_b32 v146, 16, v39
v_and_b32 v147, 0xffff0000, v39
v_lshlrev_b32 v148, 16, v40
v_and_b32 v149, 0xffff0000, v40
v_lshlrev_b32 v150, 16, v41
v_and_b32 v151, 0xffff0000, v41
v_lshlrev_b32 v152, 16, v42
v_and_b32 v153, 0xffff0000, v42
v_lshlrev_b32 v154, 16, v43
v_and_b32 v155, 0xffff0000, v43
v_lshlrev_b32 v156, 16, v44
v_and_b32 v157, 0xffff0000, v44
v_lshlrev_b32 v158, 16, v45
v_and_b32 v159, 0xffff0000, v45
v_lshlrev_b32 v160, 16, v46
v_and_b32 v161, 0xffff0000, v46
v_lshlrev_b32 v162, 16, v47
v_and_b32 v163, 0xffff0000, v47
s_branch L_k2go2
L_kvredo3:
s_mov_b32 s88, 0
L_kvredo3b:
v_max_u32 v132, v48, v49
v_max3_u32 v132, v132, v50, v51
v_max3_u32 v132, v132, v52, v53
v_max3_u32 v132, v132, v54, v55
v_max3_u32 v132, v132, v56, v57
v_max3_u32 v132, v132, v58, v59
v_max3_u32 v132, v132, v60, v61
v_max3_u32 v132, v132, v62, v63
v_max3_u32 v132, v132, v64, v65
v_max3_u32 v132, v132, v66, v67
v_max3_u32 v132, v132, v68, v69
v_max3_u32 v132, v132, v70, v71
v_max3_u32 v132, v132, v100, v101
v_max3_u32 v132, v132, v102, v103
v_max3_u32 v132, v132, v104, v105
v_max3_u32 v132, v132, v106, v107
v_max3_u32 v132, v132, v124, v125
v_max3_u32 v132, v132, v126, v127
v_cmp_eq_u32 vcc, -1, v132
s_cbranch_vccz L_kvback3
s_add_u32 s88, s88, 1
s_cmp_gt_u32 s88, 0x80000
s_cbranch_scc1 L_kvback3
s_sleep 4
s_lshl_b32 s37, s30, 2
s_add_u32 s37, s37, s28
s_lshl_b32 s38, s37, 13
s_add_u32 s38, s38, 0x400000
s_add_u32 s36, s38, 4096
s_lshl_b32 s39, s37, 10
s_add_u32 s39, s39, 0x820000
v_and_b32 v248, 7, v0
v_lshlrev_b32 v248, 7, v248
v_lshrrev_b32 v249, 4, v0
v_lshl_add_u32 v248, v249, 4, v248
buffer_load_dwordx4 v[48:51], v1, s[4:7], s38 offen offset:0 sc1
buffer_load_dwordx4 v[124:127], v248, s[4:7], s39 offen sc1
buffer_load_dwordx4 v[52:55], v1, s[4:7], s38 offen offset:1024 sc1
buffer_load_dwordx4 v[56:59], v1, s[4:7], s38 offen offset:2048 sc1
buffer_load_dwordx4 v[60:63], v1, s[4:7], s38 offen offset:3072 sc1
buffer_load_dwordx4 v[64:67], v1, s[4:7], s36 offen offset:0 sc1
buffer_load_dwordx4 v[68:71], v1, s[4:7], s36 offen offset:1024 sc1
buffer_load_dwordx4 v[100:103], v1, s[4:7], s36 offen offset:2048 sc1
buffer_load_dwordx4 v[104:107], v1, s[4:7], s36 offen offset:3072 sc1
v_mov_b32 v249, 0x3f80
v_mov_b32 v250, 1.0
s_waitcnt vmcnt(8)
v_lshlrev_b32 v92, 16, v48
v_and_b32 v93, 0xffff0000, v48
v_lshlrev_b32 v94, 16, v49
v_and_b32 v95, 0xffff0000, v49
v_lshlrev_b32 v96, 16, v50
v_and_b32 v97, 0xffff0000, v50
v_lshlrev_b32 v98, 16, v51
v_and_b32 v99, 0xffff0000, v51
s_waitcnt vmcnt(7)
v_add_f32_dpp v128, v124, v124 row_ror:4 row_mask:0xf bank_mask:0xf
v_add_f32_dpp v129, v125, v125 row_ror:4 row_mask:0xf bank_mask:0xf
v_add_f32_dpp v130, v126, v126 row_ror:4 row_mask:0xf bank_mask:0xf
v_add_f32_dpp v131, v127, v127 row_ror:4 row_mask:0xf bank_mask:0xf
v_add_f32_dpp v128, v128, v128 row_ror:2 row_mask:0xf bank_mask:0xf
v_add_f32_dpp v129, v129, v129 row_ror:2 row_mask:0xf bank_mask:0xf
v_add_f32_dpp v130, v130, v130 row_ror:2 row_mask:0xf bank_mask:0xf
v_add_f32_dpp v131, v131, v131 row_ror:2 row_mask:0xf bank_mask:0xf
v_add_f32_dpp v128, v128, v128 row_ror:1 row_mask:0xf bank_mask:0xf
v_add_f32_dpp v129, v129, v129 row_ror:1 row_mask:0xf bank_mask:0xf
v_add_f32_dpp v130, v130, v130 row_ror:1 row_mask:0xf bank_mask:0xf
v_add_f32_dpp v131, v131, v131 row_ror:1 row_mask:0xf bank_mask:0xf
s_waitcnt vmcnt(6)
v_dot2c_f32_bf16 v92, v52, v249
v_dot2c_f32_bf16 v93, v52, v250
v_dot2c_f32_bf16 v94, v53, v249
v_dot2c_f32_bf16 v95, v53, v250
v_dot2c_f32_bf16 v96, v54, v249
v_dot2c_f32_bf16 v97, v54, v250
v_dot2c_f32_bf16 v98, v55, v249
v_dot2c_f32_bf16 v99, v55, v250
s_waitcnt vmcnt(5)
v_dot2c_f32_bf16 v92, v56, v249
v_dot2c_f32_bf16 v93, v56, v250
v_dot2c_f32_bf16 v94, v57, v249
v_dot2c_f32_bf16 v95, v57, v250
v_dot2c_f32_bf16 v96, v58, v249
v_dot2c_f32_bf16 v97, v58, v250
v_dot2c_f32_bf16 v98, v59, v249
v_dot2c_f32_bf16 v99, v59, v250
s_waitcnt vmcnt(4)
v_dot2c_f32_bf16 v92, v60, v249
v_dot2c_f32_bf16 v93, v60, v250
v_dot2c_f32_bf16 v94, v61, v249
v_dot2c_f32_bf16 v95, v61, v250
v_dot2c_f32_bf16 v96, v62, v249
v_dot2c_f32_bf16 v97, v62, v250
v_dot2c_f32_bf16 v98, v63, v249
v_dot2c_f32_bf16 v99, v63, v250
s_waitcnt vmcnt(3)
v_dot2c_f32_bf16 v92, v64, v249
v_dot2c_f32_bf16 v93, v64, v250
v_dot2c_f32_bf16 v94, v65, v249
v_dot2c_f32_bf16 v95, v65, v250
v_dot2c_f32_bf16 v96, v66, v249
v_dot2c_f32_bf16 v97, v66, v250
v_dot2c_f32_bf16 v98, v67, v249
v_dot2c_f32_bf16 v99, v67, v250
s_waitcnt vmcnt(2)
v_dot2c_f32_bf16 v92, v68, v249
v_dot2c_f32_bf16 v93, v68, v250
v_dot2c_f32_bf16 v94, v69, v249
v_dot2c_f32_bf16 v95, v69, v250
v_dot2c_f32_bf16 v96, v70, v249
v_dot2c_f32_bf16 v97, v70, v250
v_dot2c_f32_bf16 v98, v71, v249
v_dot2c_f32_bf16 v99, v71, v250
s_waitcnt vmcnt(1)
v_dot2c_f32_bf16 v92, v100, v249
v_dot2c_f32_bf16 v93, v100, v250
v_dot2c_f32_bf16 v94, v101, v249
v_dot2c_f32_bf16 v95, v101, v250
v_dot2c_f32_bf16 v96, v102, v249
v_dot2c_f32_bf16 v97, v102, v250
v_dot2c_f32_bf16 v98, v103, v249
v_dot2c_f32_bf16 v99, v103, v250
s_waitcnt vmcnt(0)
v_dot2c_f32_bf16 v92, v104, v249
v_dot2c_f32_bf16 v93, v104, v250
v_dot2c_f32_bf16 v94, v105, v249
v_dot2c_f32_bf16 v95, v105, v250
v_dot2c_f32_bf16 v96, v106, v249
v_dot2c_f32_bf16 v97, v106, v250
v_dot2c_f32_bf16 v98, v107, v249
v_dot2c_f32_bf16 v99, v107, v250
s_nop 2
s_branch L_kvredo3b
L_k2redo3:
s_mov_b32 s95, 0
s_mov_b32 s92, 0x40000000
s_mov_b32 s93, 0x40000000
s_mov_b32 s94, 0x40000000
s_add_u32 s36, s66, 0x30000
s_mov_b32 s37, 0
Lpoll_43:
v_mov_b32 v11, 0
buffer_atomic_add v11, v251, s[4:7], s36 offen sc0 sc1
s_add_u32 s37, s37, 1
s_waitcnt vmcnt(0)
v_readfirstlane_b32 s38, v11
s_nop 0
s_cmp_ge_u32 s38, 32
s_cbranch_scc1 Lpe_44
s_cmp_lt_u32 s37, 0x100000
s_cbranch_scc1 Lpoll_43
Lpe_44:
s_nop 7
s_cmp_eq_u32 s3, 0
s_cselect_b32 s35, 8, 0
s_lshl_b32 s35, s35, 12
v_lshlrev_b32 v132, 16, v32
v_and_b32 v133, 0xffff0000, v32
v_lshlrev_b32 v134, 16, v33
v_and_b32 v135, 0xffff0000, v33
v_lshlrev_b32 v136, 16, v34
v_and_b32 v137, 0xffff0000, v34
v_lshlrev_b32 v138, 16, v35
v_and_b32 v139, 0xffff0000, v35
v_lshlrev_b32 v140, 16, v36
v_and_b32 v141, 0xffff0000, v36
v_lshlrev_b32 v142, 16, v37
v_and_b32 v143, 0xffff0000, v37
v_lshlrev_b32 v144, 16, v38
v_and_b32 v145, 0xffff0000, v38
v_lshlrev_b32 v146, 16, v39
v_and_b32 v147, 0xffff0000, v39
v_lshlrev_b32 v148, 16, v40
v_and_b32 v149, 0xffff0000, v40
v_lshlrev_b32 v150, 16, v41
v_and_b32 v151, 0xffff0000, v41
v_lshlrev_b32 v152, 16, v42
v_and_b32 v153, 0xffff0000, v42
v_lshlrev_b32 v154, 16, v43
v_and_b32 v155, 0xffff0000, v43
v_lshlrev_b32 v156, 16, v44
v_and_b32 v157, 0xffff0000, v44
v_lshlrev_b32 v158, 16, v45
v_and_b32 v159, 0xffff0000, v45
v_lshlrev_b32 v160, 16, v46
v_and_b32 v161, 0xffff0000, v46
v_lshlrev_b32 v162, 16, v47
v_and_b32 v163, 0xffff0000, v47
s_branch L_k2go3
L_code_end:
.section .rodata,"a"
.p2align 6
.amdhsa_kernel interleave_layers__sliding_local_dilated__linear_kernel_hedgehog__prompt_kernel
  .amdhsa_next_free_vgpr 512
  .amdhsa_next_free_sgpr 102
  .amdhsa_accum_offset 256
  .amdhsa_group_segment_fixed_size 0
  .amdhsa_kernarg_size 80
  .amdhsa_user_sgpr_count 2
  .amdhsa_user_sgpr_kernarg_segment_ptr 1
  .amdhsa_system_sgpr_workgroup_id_x 1
.end_amdhsa_kernel
```

```asm
; @launch grid=(256,1,1) block=(256,1,1) lds=163840
.amdgcn_target "amdgcn-amd-amdhsa--gfx950"
.text
.globl interleave_layers__sliding_local_dilated__linear_kernel_hedgehog__prompt_kernel
.p2align 8
.type interleave_layers__sliding_local_dilated__linear_kernel_hedgehog__prompt_kernel,@function
interleave_layers__sliding_local_dilated__linear_kernel_hedgehog__prompt_kernel:
s_cmp_ge_u32 s2, 256
s_cbranch_scc1 L_end
s_load_dwordx16 s[64:79], s[0:1], 0
s_load_dwordx4 s[80:83], s[0:1], 64
s_getpc_b64 s[24:25]
s_mov_b32 s26, (L_end - interleave_layers__sliding_local_dilated__linear_kernel_hedgehog__prompt_kernel - 64)
s_mov_b32 s27, 0x20000
v_lshlrev_b32 v1, 5, v0
buffer_load_dword v238, v1, s[24:27], 0 offen
v_lshrrev_b32 v1, 6, v0
v_and_b32 v0, 63, v0
v_readfirstlane_b32 s28, v1
s_and_b32 s36, s2, 7
s_lshr_b32 s37, s2, 3
s_and_b32 s38, s37, 3
s_lshr_b32 s39, s37, 2
s_and_b32 s29, s36, 1
s_lshl_b32 s32, s29, 3
s_lshl_b32 s29, s29, 2
s_add_u32 s29, s29, s38
s_add_u32 s32, s32, s39
s_lshr_b32 s36, s36, 1
s_lshl_b32 s30, s36, 3
s_add_u32 s30, s30, s39
s_lshl_b32 s31, s36, 2
s_add_u32 s31, s31, s38
s_and_b32 s32, s36, 1
s_lshl_b32 s32, s32, 3
s_add_u32 s32, s32, s39
s_and_b32 s31, s2, 1
s_lshl_b32 s31, s31, 3
s_add_u32 s31, s31, s38
s_and_b32 s3, s2, 4
s_add_u32 s31, s31, s3
s_mov_b32 s3, s39
s_and_b32 s35, s2, 7
s_lshl_b32 s35, s35, 5
s_add_u32 s35, s35, s37
s_mul_i32 s33, s39, 0
s_and_b32 s33, s33, 31
s_mul_i32 s34, s39, 0
s_and_b32 s34, s34, 31
v_lshlrev_b32 v1, 4, v0
v_lshrrev_b32 v233, 4, v0
v_and_b32 v234, 15, v0
s_and_b32 s88, s31, 7
s_lshl_b32 s88, s88, 7
s_lshl_b32 s37, s28, 5
s_add_u32 s88, s88, s37
s_lshl_b32 s88, s88, 1
s_lshr_b32 s37, s31, 3
s_add_u32 s88, s88, s37
s_lshl_b32 s88, s88, 11
s_lshl_b32 s37, s32, 7
s_add_u32 s88, s88, s37
v_lshrrev_b32 v235, 3, v0
v_and_b32 v236, 7, v0
v_xor_b32 v232, v236, v233
v_lshlrev_b32 v232, 4, v232
v_lshl_add_u32 v232, v235, 12, v232
v_xor_b32 v246, 64, v232
v_lshlrev_b32 v236, 4, v236
v_lshl_add_u32 v237, v235, 11, v236
v_mul_u32_u24 v235, 6144, v235
v_add_u32 v235, v235, v236
s_lshr_b32 s36, s35, 4
s_lshl_b32 s36, s36, 2
s_add_u32 s36, s36, s28
s_mul_i32 s36, s36, 98304
s_and_b32 s37, s35, 15
s_lshl_b32 s37, s37, 7
s_add_u32 s36, s36, s37
s_lshl_b32 s37, s28, 11
s_mov_b32 s39, 0x10000
s_mov_b32 s10, 0x400000
s_mov_b32 s11, 0x20000
s_mov_b32 s22, 0x600000
s_mov_b32 s23, 0x20000
s_mov_b32 s6, 0x10000000
s_mov_b32 s7, 0x20000
s_mov_b32 s44, 0xf0000
s_waitcnt lgkmcnt(0)
s_mov_b64 s[8:9], s[64:65]
s_mov_b64 s[20:21], s[66:67]
s_lshl_b32 s39, s37, 1
s_add_u32 m0, s37, 0
s_add_u32 s38, s36, 0
buffer_load_dwordx4 v235, s[20:23], s38 offen nt lds
s_add_u32 m0, s37, 1024
s_add_u32 s38, s36, 49152
buffer_load_dwordx4 v235, s[20:23], s38 offen nt lds
s_add_u32 m0, s37, 8192
s_add_u32 s38, s36, 2048
buffer_load_dwordx4 v235, s[20:23], s38 offen nt lds
s_add_u32 m0, s37, 9216
s_add_u32 s38, s36, 51200
buffer_load_dwordx4 v235, s[20:23], s38 offen nt lds
s_add_u32 m0, s37, 16384
s_add_u32 s38, s36, 4096
buffer_load_dwordx4 v235, s[20:23], s38 offen nt lds
s_add_u32 m0, s37, 17408
s_add_u32 s38, s36, 53248
buffer_load_dwordx4 v235, s[20:23], s38 offen nt lds
s_add_u32 m0, s39, 24576
s_add_u32 s38, s88, 0
buffer_load_dwordx4 v232, s[8:11], s38 offen nt lds
s_add_u32 m0, s39, 25600
s_add_u32 s38, s88, 32768
buffer_load_dwordx4 v246, s[8:11], s38 offen nt lds
s_add_u32 m0, s39, 26624
s_add_u32 s38, s88, 65536
buffer_load_dwordx4 v232, s[8:11], s38 offen nt lds
s_add_u32 m0, s39, 27648
s_add_u32 s38, s88, 98304
buffer_load_dwordx4 v246, s[8:11], s38 offen nt lds
s_mov_b32 s37, s39
v_lshrrev_b32 v232, 1, v234
v_xor_b32 v232, v232, v233
v_lshlrev_b32 v232, 4, v232
v_lshl_add_u32 v232, v234, 7, v232
v_add_u32 v232, s37, v232
s_add_u32 s4, s82, 0x0
s_addc_u32 s5, s83, 0
s_mov_b32 s12, s78
s_mov_b32 s13, s79
s_mov_b32 s14, 0x400000
s_mov_b32 s15, 0x20000
s_mov_b32 s42, 0x400000
s_mov_b32 s43, 0x20000
v_mov_b32 v12, 1
s_mov_b64 s[40:41], s[12:13]
s_mov_b32 s64, 0xff
s_mov_b32 s65, 0
s_and_b32 s81, s29, 3
s_lshl_b32 s66, s31, 4
s_add_u32 s66, s66, s32
s_lshl_b32 s66, s66, 8
s_lshl_b32 s67, s29, 5
s_add_u32 s67, s67, s30
s_lshl_b32 s67, s67, 8
s_lshl_b32 s80, s30, 11
s_lshl_b32 s70, s29, 8
s_add_u32 s70, s70, s80
s_lshl_b32 s71, s29, 13
s_lshr_b32 s78, s31, 1
s_lshl_b32 s78, s78, 13
s_add_u32 s79, s78, 8192
s_bitcmp1_b32 s31, 0
s_cselect_b32 s79, s79, 0x40000000
s_and_b32 s36, s31, 7
s_cmp_eq_u32 s36, 7
s_cselect_b32 s79, 0x40000000, s79
v_mov_b32 v240, 0
v_mov_b32 v241, 0
v_mov_b32 v242, 0
v_mov_b32 v243, 0
v_mov_b32 v228, v235
v_mov_b32 v229, v237
s_lshr_b32 s36, s35, 4
s_lshl_b32 s36, s36, 2
s_add_u32 s36, s36, s28
s_and_b32 s37, s35, 15
s_lshl_b32 s37, s37, 7
s_lshl_b32 s16, s36, 15
s_add_u32 s16, s16, s37
s_mul_i32 s17, s36, 98304
s_add_u32 s17, s17, s37
v_mov_b32 v16, 0x3f803f80
v_mov_b32 v17, 0x3f803f80
v_mov_b32 v18, 0x3f803f80
v_mov_b32 v19, 0x3f803f80
s_mov_b32 s46, 0xaaaaaaaa
s_mov_b32 s47, 0xaaaaaaaa
s_mov_b32 s48, 0xcccccccc
s_mov_b32 s49, 0xcccccccc
s_lshl_b32 s36, s31, 1
s_lshr_b32 s37, s28, 1
s_add_u32 s36, s36, s37
s_lshl_b32 s36, s36, 17
s_and_b32 s37, s28, 1
s_lshl_b32 s37, s37, 11
s_add_u32 s36, s36, s37
v_add_u32 v4, s36, v1
s_lshl_b32 s38, s31, 2
s_add_u32 s38, s38, s28
s_lshl_b32 s38, s38, 12
s_lshl_b32 s39, s32, 7
s_add_u32 s38, s38, s39
v_lshrrev_b32 v244, 2, v234
v_cmp_eq_u32 vcc, v244, v233
v_and_b32 v244, 7, v234
v_lshl_add_u32 v244, v244, 4, s38
v_and_b32 v245, 8, v234
v_add_u32 v244, v244, v245
v_cndmask_b32 v253, 2.0, v244, vcc
v_lshlrev_b32 v244, 4, v233
v_lshl_add_u32 v244, v234, 6, v244
v_cmp_gt_u32 vcc, 2, v234
s_nop 1
v_cndmask_b32 v254, 2.0, v244, vcc
v_lshrrev_b32 v248, 4, v0
v_lshlrev_b32 v248, 10, v248
v_bfe_u32 v249, v0, 2, 2
v_lshl_add_u32 v248, v249, 7, v248
v_and_b32 v251, 3, v0
v_lshl_add_u32 v248, v251, 3, v248
s_lshr_b32 s36, s28, 1
s_lshl_b32 s36, s36, 6
s_and_b32 s37, s28, 1
s_mul_i32 s38, s37, 8224
s_add_u32 s38, s38, s36
s_mul_i32 s39, s37, 16352
s_add_u32 s39, s39, s36
v_add_u32 v249, s39, v248
v_add_u32 v248, s38, v248
s_and_b32 s38, s35, 15
s_lshl_b32 s38, s38, 1
s_lshr_b32 s36, s28, 1
s_add_u32 s38, s38, s36
s_lshr_b32 s36, s35, 4
s_mul_i32 s96, s38, 196608
s_mul_i32 s44, s36, 12288
s_add_u32 s96, s96, s44
s_mul_i32 s44, s37, 3072
s_add_u32 s96, s96, s44
s_add_u32 s96, s96, 0xe00000
s_add_u32 s97, s96, 6144
s_mul_i32 s38, s38, 6
s_mul_i32 s37, s37, 3
s_add_u32 s38, s38, s37
s_lshl_b32 s38, s38, 11
s_lshl_b32 s36, s36, 7
s_add_u32 s38, s38, s36
s_add_u32 s98, s38, 0x300000
s_add_u32 s99, s98, 4096
v_lshrrev_b32 v247, 2, v0
v_lshlrev_b32 v250, 7, v247
v_lshl_add_u32 v250, v251, 4, v250
s_lshr_b32 s36, s28, 1
s_lshl_b32 s36, s36, 12
s_and_b32 s37, s28, 1
s_lshl_b32 s37, s37, 6
s_add_u32 s36, s36, s37
s_add_u32 s36, s36, 147456
v_add_u32 v250, s36, v250
v_subrev_u32 v230, 122880, v250
s_and_b32 s36, s35, 15
s_lshl_b32 s36, s36, 17
s_lshr_b32 s37, s35, 4
s_lshl_b32 s37, s37, 13
s_add_u32 s36, s36, s37
s_lshl_b32 s37, s28, 11
s_add_u32 s36, s36, s37
s_add_u32 s100, s36, 0xa00000
s_add_u32 s101, s36, 0xc00000
v_lshlrev_b32 v247, 6, v247
v_lshl_add_u32 v251, v251, 3, v247
v_add_u32 v251, 155648, v251
v_xor_b32 v236, 64, v232
s_mov_b64 s[20:21], s[68:69]
s_mov_b32 s22, 0x200000
s_lshl_b32 s37, s28, 11
s_add_u32 m0, s37, 147456
s_add_u32 s36, s16, 0
buffer_load_dwordx4 v229, s[20:23], s36 offen nt lds
s_add_u32 m0, s37, 148480
s_add_u32 s36, s16, 16384
buffer_load_dwordx4 v229, s[20:23], s36 offen nt lds
s_add_u32 s36, s67, 0xc0000
s_add_u32 s37, s66, 0xd0000
s_cmp_eq_u32 s28, 2
s_cselect_b32 s36, s37, s36
s_cmp_eq_u32 s28, 1
s_cselect_b32 s37, 128, 0
s_add_u32 s36, s36, s37
s_cmp_eq_u32 s28, 3
s_cselect_b32 s37, 0x20000, 0
s_add_u32 s36, s36, s37
s_mov_b64 exec, 1
buffer_atomic_add v240, off, s[4:7], s36 sc1
s_mov_b64 exec, -1
s_mov_b32 s36, 0xf0000
buffer_load_dword v11, off, s[4:7], s36 sc1
s_lshr_b32 s36, s2, 3
s_lshl_b32 s36, s36, 2
s_add_u32 s36, s36, s28
s_lshl_b32 s36, s36, 10
buffer_load_dwordx4 a[0:3], v1, s[24:27], s36 offen
s_mov_b64 s[20:21], s[74:75]
s_mov_b32 s22, 0x10000
s_and_b32 s36, s28, 1
s_lshl_b32 s36, s36, 10
s_add_u32 m0, s36, 155648
s_lshl_b32 s37, s30, 11
s_add_u32 s36, s36, s37
buffer_load_dwordx4 v1, s[20:23], s36 offen lds
s_waitcnt vmcnt(6)
ds_read_b128 v[32:35], v232 offset:24576
ds_read_b128 v[36:39], v236 offset:24576
ds_read_b128 v[40:43], v232 offset:26624
ds_read_b128 v[44:47], v236 offset:26624
s_barrier
ds_read_b64_tr_b16 a[188:189], v248 offset:0
ds_read_b64_tr_b16 a[190:191], v248 offset:512
ds_read_b64_tr_b16 a[192:193], v248 offset:4096
ds_read_b64_tr_b16 a[194:195], v248 offset:4608
ds_read_b64_tr_b16 a[196:197], v249 offset:32
ds_read_b64_tr_b16 a[198:199], v249 offset:544
ds_read_b64_tr_b16 a[200:201], v249 offset:4128
ds_read_b64_tr_b16 a[202:203], v249 offset:4640
ds_read_b64_tr_b16 a[204:205], v248 offset:8192
ds_read_b64_tr_b16 a[206:207], v248 offset:8704
ds_read_b64_tr_b16 a[208:209], v248 offset:12288
ds_read_b64_tr_b16 a[210:211], v248 offset:12800
s_lshl_b32 s36, s32, 13
s_add_u32 s36, s36, 0x0
s_add_u32 s37, s36, 4096
s_mov_b32 s38, 0x200000
s_waitcnt lgkmcnt(14)
v_mfma_f32_16x16x32_bf16 v[96:99], v[32:35], v[32:35], 0
v_mfma_f32_16x16x32_bf16 v[92:95], v[16:19], v[32:35], 0
buffer_store_dwordx4 v[32:35], v4, s[12:15], s36 offen offset:0 sc1
s_waitcnt lgkmcnt(13)
v_mfma_f32_16x16x32_bf16 v[104:107], v[40:43], v[40:43], 0
v_mfma_f32_16x16x32_bf16 v[100:103], v[16:19], v[40:43], 0
buffer_store_dwordx4 v[40:43], v4, s[12:15], s36 offen offset:1024 sc1
v_mfma_f32_16x16x32_bf16 v[96:99], v[36:39], v[36:39], v[96:99]
v_mfma_f32_16x16x32_bf16 v[92:95], v[16:19], v[36:39], v[92:95]
buffer_store_dwordx4 v[36:39], v4, s[12:15], s37 offen offset:0 sc1
s_waitcnt lgkmcnt(12)
v_mfma_f32_16x16x32_bf16 v[104:107], v[44:47], v[44:47], v[104:107]
v_mfma_f32_16x16x32_bf16 v[100:103], v[16:19], v[44:47], v[100:103]
buffer_store_dwordx4 v[44:47], v4, s[12:15], s37 offen offset:1024 sc1
s_nop 1
v_cndmask_b32 v96, v96, v97, s[46:47]
v_cndmask_b32 v98, v98, v99, s[46:47]
v_cndmask_b32 v93, v96, v98, s[48:49]
buffer_store_dwordx2 v[92:93], v253, s[4:7], s38 offen offset:0 sc1
v_cndmask_b32 v104, v104, v105, s[46:47]
v_cndmask_b32 v106, v106, v107, s[46:47]
v_cndmask_b32 v101, v104, v106, s[48:49]
buffer_store_dwordx2 v[100:101], v253, s[4:7], s38 offen offset:2048 sc1
s_waitcnt lgkmcnt(10)
v_mfma_f32_16x16x32_bf16 v[108:111], a[188:191], v[16:19], 0
s_waitcnt lgkmcnt(6)
v_mfma_f32_16x16x32_bf16 v[112:115], a[196:199], v[16:19], 0
s_waitcnt lgkmcnt(2)
v_mfma_f32_16x16x32_bf16 v[116:119], a[204:207], v[16:19], 0
v_mfma_f32_16x16x32_bf16 v[108:111], a[192:195], v[16:19], v[108:111]
v_mfma_f32_16x16x32_bf16 v[112:115], a[200:203], v[16:19], v[112:115]
s_waitcnt lgkmcnt(0)
v_mfma_f32_16x16x32_bf16 v[116:119], a[208:211], v[16:19], v[116:119]
buffer_store_dwordx4 a[188:191], v1, s[4:7], s96 offen offset:0 sc1
buffer_store_dwordx4 a[192:195], v1, s[4:7], s97 offen offset:0 sc1
buffer_store_dwordx4 a[196:199], v1, s[4:7], s96 offen offset:1024 sc1
buffer_store_dwordx4 a[200:203], v1, s[4:7], s97 offen offset:1024 sc1
buffer_store_dwordx4 a[204:207], v1, s[4:7], s96 offen offset:2048 sc1
buffer_store_dwordx4 a[208:211], v1, s[4:7], s97 offen offset:2048 sc1
buffer_store_dwordx4 v[108:111], v254, s[4:7], s98 offen offset:0 sc1
buffer_store_dwordx4 v[112:115], v254, s[4:7], s98 offen offset:2048 sc1
buffer_store_dwordx4 v[116:119], v254, s[4:7], s99 offen offset:0 sc1
v_lshlrev_b32 v239, 16, v233
v_lshl_add_u32 v239, v234, 4, v239
s_cmp_eq_u32 s28, 0
s_cselect_b32 s36, s66, s67
s_cmp_eq_u32 s28, 2
s_cselect_b32 s36, s70, s36
s_lshl_b32 s37, s28, 18
s_add_u32 s36, s36, s37
s_cmp_eq_u32 s28, 3
s_cselect_b32 s36, 0x40000000, s36
buffer_store_dwordx4 v[240:243], v239, s[4:7], s36 offen sc1
s_waitcnt vmcnt(20)
s_barrier
ds_read_b64_tr_b16 a[212:213], v250 offset:0
ds_read_b64_tr_b16 a[214:215], v250 offset:2048
ds_read_b64_tr_b16 a[216:217], v250 offset:8
ds_read_b64_tr_b16 a[218:219], v250 offset:2056
s_waitcnt lgkmcnt(2)
buffer_store_dwordx4 a[212:215], v1, s[4:7], s100 offen offset:0 sc1
s_waitcnt lgkmcnt(0)
buffer_store_dwordx4 a[216:219], v1, s[4:7], s100 offen offset:1024 sc1
s_mov_b32 s56, 0x11111111
s_mov_b32 s57, 0x11111111
s_mov_b32 s58, 0x22222222
s_mov_b32 s59, 0x22222222
s_mul_i32 s18, s28, 3072
s_lshl_b32 s19, s28, 12
s_mul_i32 s50, s30, 196608
s_add_u32 s50, s50, s18
s_lshl_b32 s36, s32, 17
s_add_u32 s36, s36, s19
s_add_u32 s37, s28, 0
s_cmp_eq_u32 s37, s3
s_cselect_b32 s37, 32768, 0
s_add_u32 s84, s36, s37
s_mul_i32 s37, s37, 3
s_sub_u32 s86, s36, s37
s_add_u32 s37, s28, 4
s_cmp_eq_u32 s37, s3
s_cselect_b32 s37, 32768, 0
s_add_u32 s85, s36, s37
s_mul_i32 s37, s37, 3
s_sub_u32 s87, s36, s37
s_mul_i32 s55, s28, 6144
v_accvgpr_write_b32 a248, -1
v_accvgpr_write_b32 a249, -1
v_accvgpr_write_b32 a250, -1
v_accvgpr_write_b32 a251, -1
s_lshl_b32 s36, s29, 2
s_add_u32 s36, s36, s28
s_lshl_b32 s37, s36, 17
v_add_u32 v2, s37, v1
s_lshl_b32 s82, s36, 13
s_and_b32 s38, s29, 3
s_cmp_eq_u32 s38, 0
s_cselect_b32 s38, 0, 0x1f400
s_cselect_b32 s39, 0, 2048
s_cselect_b32 s54, 32, 48
s_lshl_b32 s37, s29, 19
s_sub_u32 s37, s37, s38
v_add_u32 v3, s37, v1
v_cmp_le_u32 vcc, 8, v234
s_nop 1
v_cndmask_b32 v3, 2.0, v3, vcc
s_lshl_b32 s37, s29, 15
s_sub_u32 s83, s37, s39
s_cmp_eq_u32 s28, 1
s_cselect_b32 vcc_lo, -1, 0
s_mov_b32 vcc_hi, 0
v_lshlrev_b32 v244, 8, v0
v_cndmask_b32 v10, 2.0, v244, vcc
v_and_b32 v244, 1, v233
v_lshl_add_u32 v244, v244, 3, v234
v_and_b32 v244, 15, v244
v_lshrrev_b32 v245, 1, v233
v_lshl_add_u32 v244, v245, 4, v244
v_lshrrev_b32 v245, 3, v234
v_lshl_add_u32 v244, v245, 5, v244
v_lshlrev_b32 v7, 3, v244
v_lshrrev_b32 v246, 2, v0
v_and_b32 v247, 3, v0
v_and_b32 v244, 1, v247
v_lshl_add_u32 v244, v244, 3, v246
v_and_b32 v244, 15, v244
v_lshrrev_b32 v245, 1, v247
v_lshl_add_u32 v244, v245, 4, v244
v_lshrrev_b32 v245, 3, v246
v_lshl_add_u32 v244, v245, 5, v244
v_lshlrev_b32 v8, 3, v244
s_and_b32 s36, s28, 1
s_lshl_b32 s37, s36, 3
s_add_u32 s37, s37, 20480
s_lshl_b32 s36, s36, 9
v_add_u32 v244, s37, v1
v_add_u32 v245, s36, v7
s_cmp_lt_u32 s28, 2
s_cselect_b64 vcc, -1, 0
v_cndmask_b32 v9, v245, v244, vcc
v_lshlrev_b32 v239, 2, v233
v_sub_u32 v239, v239, v234
v_mov_b32 v247, 0xf149f2ca
v_add_u32 v246, 7, v239
v_cmp_gt_u32 vcc, 8, v246
v_mov_b32 v244, 0xffff
s_nop 0
v_cndmask_b32 v24, v247, 0, vcc
v_cndmask_b32 v244, 0, v244, vcc
v_mov_b32 v30, v244
v_add_u32 v246, 0, v239
v_cmp_le_i32 vcc, 9, v246
v_mov_b32 v244, 0xffff
s_nop 0
v_cndmask_b32 v20, v247, 0, vcc
v_cndmask_b32 v244, 0, v244, vcc
v_mov_b32 v28, v244
v_add_u32 v246, 8, v239
v_cmp_gt_u32 vcc, 8, v246
v_mov_b32 v244, 0xffff0000
s_nop 0
v_cndmask_b32 v25, v247, 0, vcc
v_cndmask_b32 v244, 0, v244, vcc
v_or_b32 v30, v30, v244
v_add_u32 v246, 1, v239
v_cmp_le_i32 vcc, 9, v246
v_mov_b32 v244, 0xffff0000
s_nop 0
v_cndmask_b32 v21, v247, 0, vcc
v_cndmask_b32 v244, 0, v244, vcc
v_or_b32 v28, v28, v244
v_add_u32 v246, 9, v239
v_cmp_gt_u32 vcc, 8, v246
v_mov_b32 v244, 0xffff
s_nop 0
v_cndmask_b32 v26, v247, 0, vcc
v_cndmask_b32 v244, 0, v244, vcc
v_mov_b32 v31, v244
v_add_u32 v246, 2, v239
v_cmp_le_i32 vcc, 9, v246
v_mov_b32 v244, 0xffff
s_nop 0
v_cndmask_b32 v22, v247, 0, vcc
v_cndmask_b32 v244, 0, v244, vcc
v_mov_b32 v29, v244
v_add_u32 v246, 10, v239
v_cmp_gt_u32 vcc, 8, v246
v_mov_b32 v244, 0xffff0000
s_nop 0
v_cndmask_b32 v27, v247, 0, vcc
v_cndmask_b32 v244, 0, v244, vcc
v_or_b32 v31, v31, v244
v_add_u32 v246, 3, v239
v_cmp_le_i32 vcc, 9, v246
v_mov_b32 v244, 0xffff0000
s_nop 0
v_cndmask_b32 v23, v247, 0, vcc
v_cndmask_b32 v244, 0, v244, vcc
v_or_b32 v29, v29, v244
s_and_b32 s36, s29, 3
s_or_b32 s36, s36, s28
s_cmp_eq_u32 s36, 0
s_cselect_b64 vcc, -1, 0
v_cndmask_b32 v76, v20, v247, vcc
v_cndmask_b32 v77, v21, v247, vcc
v_cndmask_b32 v78, v22, v247, vcc
v_cndmask_b32 v79, v23, v247, vcc
v_cndmask_b32 v80, v28, 0, vcc
v_cndmask_b32 v81, v29, 0, vcc
s_mov_b32 s36, 0x9e3779b1
s_waitcnt vmcnt(20)
v_mul_lo_u32 v15, v11, s36
v_add_u32 v15, 0x7f4a7c15, v15
s_and_b32 s36, s31, 1
s_lshl_b32 s36, s36, 4
s_add_u32 s36, s36, s32
s_lshl_b32 s36, s36, 2
s_add_u32 s92, s78, s36
s_add_u32 s92, s92, 0xc0000
s_lshl_b32 s36, s32, 2
s_add_u32 s93, s79, s36
s_add_u32 s93, s93, 0xc0080
s_and_b32 s94, s35, 15
s_lshl_b32 s94, s94, 9
s_lshr_b32 s36, s35, 4
s_lshl_b32 s36, s36, 2
s_add_u32 s94, s94, s36
s_add_u32 s94, s94, 0xc00c0
v_lshrrev_b32 v240, 1, v0
v_lshlrev_b32 v240, 13, v240
v_and_b32 v241, 1, v0
v_lshl_add_u32 v240, v241, 8, v240
s_mov_b32 vcc_lo, 0xffff
s_mov_b32 vcc_hi, 0
v_cndmask_b32 v240, 2.0, v240, vcc
v_lshlrev_b32 v241, 2, v0
v_add_u32 v248, 0, v248
v_add_u32 v249, 0, v249
s_add_u32 s96, s96, 0x600000
s_add_u32 s98, s98, 0x80000
s_add_u32 s97, s97, 0x600000
s_add_u32 s99, s99, 0x80000
s_cmp_eq_u32 s28, 1
s_cselect_b32 vcc_lo, 0xffff, 0
v_lshlrev_b32 v252, 12, v0
v_cndmask_b32 v252, 2.0, v252, vcc
v_cndmask_b32 v14, 2.0, v240, vcc
s_and_b32 s62, s35, 15
s_lshl_b32 s62, s62, 8
s_lshr_b32 s36, s35, 4
s_lshl_b32 s36, s36, 2
s_add_u32 s62, s62, s36
s_add_u32 s62, s62, 0xd0000
s_add_u32 s8, s94, 0x1ff40
v_and_b32 v255, 15, v0
v_lshlrev_b32 v255, 2, v255
s_waitcnt vmcnt(0)
s_barrier
s_cmp_lg_u32 s28, 1
s_cbranch_scc1 Lg1s_1
buffer_atomic_swap v15, v10, s[4:7], s92 offen sc1
buffer_atomic_swap v15, v10, s[4:7], s93 offen sc1
buffer_atomic_swap v15, v240, s[4:7], s94 offen sc1
buffer_atomic_swap v15, v252, s[4:7], s62 offen sc1
Lg1s_1:
s_branch L_aligned
.p2align 12
L_aligned:
s_mov_b64 s[20:21], s[76:77]
s_mov_b32 s22, 0x200000
s_add_u32 s89, s16, 0
buffer_load_dwordx4 a[220:223], v229, s[20:23], s89 offen nt
s_mov_b64 s[20:21], s[76:77]
s_mov_b32 s22, 0x200000
s_add_u32 s89, s16, 16384
buffer_load_dwordx4 a[224:227], v229, s[20:23], s89 offen nt
s_mov_b64 s[20:21], s[72:73]
s_mov_b32 s22, 0x600000
s_add_u32 s89, s17, 0
buffer_load_dwordx4 a[188:191], v228, s[20:23], s89 offen nt
s_mov_b64 s[20:21], s[72:73]
s_mov_b32 s22, 0x600000
s_add_u32 s89, s17, 49152
buffer_load_dwordx4 a[192:195], v228, s[20:23], s89 offen nt
s_mov_b64 s[20:21], s[72:73]
s_mov_b32 s22, 0x600000
s_add_u32 s89, s17, 2048
buffer_load_dwordx4 a[196:199], v228, s[20:23], s89 offen nt
s_mov_b64 s[20:21], s[72:73]
s_mov_b32 s22, 0x600000
s_add_u32 s89, s17, 51200
buffer_load_dwordx4 a[200:203], v228, s[20:23], s89 offen nt
s_mov_b64 s[20:21], s[72:73]
s_mov_b32 s22, 0x600000
s_add_u32 s89, s17, 4096
buffer_load_dwordx4 a[204:207], v228, s[20:23], s89 offen nt
s_mov_b64 s[20:21], s[72:73]
s_mov_b32 s22, 0x600000
s_add_u32 s89, s17, 53248
buffer_load_dwordx4 a[208:211], v228, s[20:23], s89 offen nt
s_add_u32 s89, s66, 0xd0000
ds_read_b64_tr_b16 a[240:241], v251 offset:0
ds_read_b64_tr_b16 a[242:243], v251 offset:1024
ds_read_b64_tr_b16 a[244:245], v251 offset:32
ds_read_b64_tr_b16 a[246:247], v251 offset:1056
s_lshl_b32 s36, s28, 11
v_add_u32 v231, s36, v1
s_waitcnt lgkmcnt(0)
v_add_u32 v231, 0, v231
v_cmp_eq_u32 vcc, 0, v0
s_nop 1
v_cndmask_b32 v251, 2.0, v0, vcc
s_mov_b64 exec, 0
s_cmp_eq_u32 s28, 3
s_cbranch_scc1 L_stub0
s_cmp_eq_u32 s28, 2
s_cbranch_scc1 L_stub1
s_cmp_eq_u32 s28, 1
s_cbranch_scc1 L_stub2
L_wret0:
s_mov_b64 exec, -1
s_cmp_lg_u32 s28, 0
s_cbranch_scc1 Lg1e_3
s_cmp_eq_u32 s54, 32
s_cselect_b32 s39, 0xffff0000, -1
s_mov_b32 s38, -1
s_add_u32 s36, s67, 0xc0000
s_mov_b32 s37, 0
Lg1p_2:
v_mov_b32 v11, 0
buffer_atomic_add v11, v241, s[4:7], s36 offen sc0 sc1
s_add_u32 s37, s37, 1
v_mov_b32 v242, v15
s_mov_b64 exec, 0xffff
v_mov_b32 v242, 0
buffer_atomic_add v242, v241, s[4:7], s89 offen sc0 sc1
s_mov_b64 exec, -1
s_waitcnt vmcnt(0)
v_cmp_ne_u32 vcc, v11, v15
v_cmp_ne_u32 s[52:53], v242, v15
s_and_b64 vcc, vcc, s[38:39]
s_or_b64 vcc, vcc, s[52:53]
s_cbranch_scc0 Lg1e_3
s_cmp_lt_u32 s37, 0x100000
s_cbranch_scc1 Lg1p_2
Lg1e_3:
s_barrier
s_add_u32 s94, s71, 0x80
s_add_u32 m0, s18, 0x0
s_add_u32 s44, s50, 0xe00000
buffer_load_dwordx4 v1, s[4:7], s44 offen offset:0 sc1 lds
buffer_load_dwordx4 v1, s[4:7], s44 offen offset:1024 sc1 lds
buffer_load_dwordx4 v1, s[4:7], s44 offen offset:2048 sc1 lds
s_add_u32 m0, s18, 0x3000
s_add_u32 s44, s50, 0xe03000
buffer_load_dwordx4 v1, s[4:7], s44 offen offset:0 sc1 lds
buffer_load_dwordx4 v1, s[4:7], s44 offen offset:1024 sc1 lds
buffer_load_dwordx4 v1, s[4:7], s44 offen offset:2048 sc1 lds
s_add_u32 m0, s18, 0x6000
s_add_u32 s44, s50, 0xe06000
buffer_load_dwordx4 v1, s[4:7], s44 offen offset:0 sc1 lds
buffer_load_dwordx4 v1, s[4:7], s44 offen offset:1024 sc1 lds
buffer_load_dwordx4 v1, s[4:7], s44 offen offset:2048 sc1 lds
s_add_u32 m0, s18, 0x9000
s_add_u32 s44, s50, 0xe09000
buffer_load_dwordx4 v1, s[4:7], s44 offen offset:0 sc1 lds
buffer_load_dwordx4 v1, s[4:7], s44 offen offset:1024 sc1 lds
buffer_load_dwordx4 v1, s[4:7], s44 offen offset:2048 sc1 lds
s_mov_b32 s35, 0
s_mov_b32 s33, 0x1000
buffer_load_dwordx4 a[0:3], v2, s[40:43], s35 offen offset:0 sc1
buffer_load_dwordx4 a[4:7], v2, s[40:43], s33 offen offset:0 sc1
buffer_load_dwordx4 a[8:11], v2, s[40:43], s35 offen offset:1024 sc1
buffer_load_dwordx4 a[12:15], v2, s[40:43], s33 offen offset:1024 sc1
buffer_load_dwordx4 a[16:19], v2, s[40:43], s35 offen offset:2048 sc1
buffer_load_dwordx4 a[20:23], v2, s[40:43], s33 offen offset:2048 sc1
buffer_load_dwordx4 a[24:27], v2, s[40:43], s35 offen offset:3072 sc1
buffer_load_dwordx4 a[28:31], v2, s[40:43], s33 offen offset:3072 sc1
s_add_u32 s35, s35, 8192
s_add_u32 s33, s33, 8192
s_add_u32 s63, s28, 0
s_lshl_b32 s63, s63, 12
buffer_load_dwordx4 a[160:163], v3, s[40:43], s63 offen sc1
buffer_load_dwordx4 a[32:35], v2, s[40:43], s35 offen offset:0 sc1
buffer_load_dwordx4 a[36:39], v2, s[40:43], s33 offen offset:0 sc1
buffer_load_dwordx4 a[40:43], v2, s[40:43], s35 offen offset:1024 sc1
buffer_load_dwordx4 a[44:47], v2, s[40:43], s33 offen offset:1024 sc1
buffer_load_dwordx4 a[48:51], v2, s[40:43], s35 offen offset:2048 sc1
buffer_load_dwordx4 a[52:55], v2, s[40:43], s33 offen offset:2048 sc1
buffer_load_dwordx4 a[56:59], v2, s[40:43], s35 offen offset:3072 sc1
buffer_load_dwordx4 a[60:63], v2, s[40:43], s33 offen offset:3072 sc1
s_add_u32 s35, s35, 8192
s_add_u32 s33, s33, 8192
s_waitcnt vmcnt(17)
s_barrier
v_add_u32 v5, 0, v1
v_add_u32 v6, s55, v5
ds_read_b128 a[96:99], v5 offset:2048
ds_read_b128 a[100:103], v5 offset:8192
ds_read_b128 a[104:107], v5 offset:3072
ds_read_b128 a[108:111], v5 offset:9216
ds_read_b128 a[112:115], v5 offset:4096
ds_read_b128 a[116:119], v5 offset:10240
ds_read_b128 a[120:123], v6 offset:2048
s_waitcnt vmcnt(15) lgkmcnt(5)
v_mfma_f32_16x16x32_bf16 v[140:143], a[96:99], a[0:3], 0
s_add_u32 m0, s18, 0xc000
s_add_u32 s44, s50, 0xe0c000
v_mfma_f32_16x16x32_bf16 v[140:143], a[100:103], a[4:7], v[140:143]
buffer_load_dwordx4 a[64:67], v2, s[40:43], s35 offen offset:0 sc1
s_waitcnt vmcnt(14)
v_mfma_f32_16x16x32_bf16 v[164:167], a[100:103], a[12:15], 0
ds_read_b128 a[128:131], v5 offset:5120
v_mfma_f32_16x16x32_bf16 v[164:167], a[96:99], a[8:11], v[164:167]
ds_read_b128 a[132:135], v5 offset:11264
s_waitcnt vmcnt(13)
v_mfma_f32_16x16x32_bf16 v[188:191], a[96:99], a[16:19], 0
ds_read_b128 a[136:139], v5 offset:0
s_waitcnt vmcnt(12)
v_mfma_f32_16x16x32_bf16 v[188:191], a[100:103], a[20:23], v[188:191]
buffer_load_dwordx4 v1, s[4:7], s44 offen offset:0 sc1 lds
s_add_u32 s63, s28, 4
s_waitcnt vmcnt(11)
v_mfma_f32_16x16x32_bf16 v[212:215], a[100:103], a[28:31], 0
s_lshl_b32 s63, s63, 12
ds_read_b128 a[140:143], v5 offset:6144
v_mfma_f32_16x16x32_bf16 v[212:215], a[96:99], a[24:27], v[212:215]
s_waitcnt lgkmcnt(8)
v_mfma_f32_16x16x32_bf16 v[216:219], a[104:107], a[24:27], 0
s_waitcnt lgkmcnt(7)
v_mfma_f32_16x16x32_bf16 v[216:219], a[108:111], a[28:31], v[216:219]
buffer_load_dwordx4 a[68:71], v2, s[40:43], s33 offen offset:0 sc1
v_mfma_f32_16x16x32_bf16 v[192:195], a[108:111], a[20:23], 0
ds_read_b128 a[144:147], v5 offset:1024
v_mfma_f32_16x16x32_bf16 v[192:195], a[104:107], a[16:19], v[192:195]
ds_read_b128 a[148:151], v5 offset:7168
v_mfma_f32_16x16x32_bf16 v[168:171], a[104:107], a[8:11], 0
v_mfma_f32_16x16x32_bf16 v[168:171], a[108:111], a[12:15], v[168:171]
buffer_load_dwordx4 a[72:75], v2, s[40:43], s35 offen offset:1024 sc1
v_mfma_f32_16x16x32_bf16 v[144:147], a[108:111], a[4:7], 0
ds_read_b128 a[152:155], v6 offset:3072
v_mfma_f32_16x16x32_bf16 v[144:147], a[104:107], a[0:3], v[144:147]
s_waitcnt lgkmcnt(9)
v_mfma_f32_16x16x32_bf16 v[148:151], a[112:115], a[0:3], 0
s_waitcnt lgkmcnt(8)
v_mfma_f32_16x16x32_bf16 v[148:151], a[116:119], a[4:7], v[148:151]
buffer_load_dwordx4 a[164:167], v3, s[40:43], s63 offen sc1
v_mfma_f32_16x16x32_bf16 v[172:175], a[116:119], a[12:15], 0
v_mfma_f32_16x16x32_bf16 v[172:175], a[112:115], a[8:11], v[172:175]
v_mfma_f32_16x16x32_bf16 v[196:199], a[112:115], a[16:19], 0
v_mfma_f32_16x16x32_bf16 v[196:199], a[116:119], a[20:23], v[196:199]
buffer_load_dwordx4 a[76:79], v2, s[40:43], s33 offen offset:1024 sc1
v_mfma_f32_16x16x32_bf16 v[220:223], a[116:119], a[28:31], 0
v_mfma_f32_16x16x32_bf16 v[220:223], a[112:115], a[24:27], v[220:223]
s_waitcnt vmcnt(14) lgkmcnt(7)
v_mfma_f32_16x16x32_bf16 a[172:175], a[120:123], a[160:163], 0
s_waitcnt lgkmcnt(0)
v_mfma_f32_16x16x32_bf16 v[224:227], a[128:131], a[24:27], 0
ds_read_b128 a[96:99], v5 offset:14336
v_mfma_f32_16x16x32_bf16 v[224:227], a[132:135], a[28:31], v[224:227]
buffer_load_dwordx4 a[80:83], v2, s[40:43], s35 offen offset:2048 sc1
v_mfma_f32_16x16x32_bf16 v[200:203], a[132:135], a[20:23], 0
ds_read_b128 a[100:103], v5 offset:20480
v_mfma_f32_16x16x32_bf16 v[200:203], a[128:131], a[16:19], v[200:203]
v_mfma_f32_16x16x32_bf16 v[176:179], a[128:131], a[8:11], 0
buffer_load_dwordx4 v1, s[4:7], s44 offen offset:1024 sc1 lds
v_mfma_f32_16x16x32_bf16 v[176:179], a[132:135], a[12:15], v[176:179]
ds_read_b128 a[104:107], v5 offset:15360
v_mfma_f32_16x16x32_bf16 v[152:155], a[132:135], a[4:7], 0
ds_read_b128 a[108:111], v5 offset:21504
v_mfma_f32_16x16x32_bf16 v[152:155], a[128:131], a[0:3], v[152:155]
v_mfma_f32_16x16x32_bf16 v[132:135], a[136:139], a[0:3], 0
buffer_load_dwordx4 a[84:87], v2, s[40:43], s33 offen offset:2048 sc1
v_mfma_f32_16x16x32_bf16 v[132:135], a[140:143], a[4:7], v[132:135]
ds_read_b128 a[112:115], v5 offset:16384
v_mfma_f32_16x16x32_bf16 v[156:159], a[140:143], a[12:15], 0
v_mfma_f32_16x16x32_bf16 v[156:159], a[136:139], a[8:11], v[156:159]
buffer_load_dwordx4 v1, s[4:7], s44 offen offset:2048 sc1 lds
s_add_u32 m0, s18, 0xf000
v_mfma_f32_16x16x32_bf16 v[180:183], a[136:139], a[16:19], 0
s_add_u32 s44, s50, 0xe0f000
ds_read_b128 a[116:119], v5 offset:22528
v_mfma_f32_16x16x32_bf16 v[180:183], a[140:143], a[20:23], v[180:183]
ds_read_b128 a[120:123], v6 offset:4096
v_mfma_f32_16x16x32_bf16 v[204:207], a[140:143], a[28:31], 0
v_mfma_f32_16x16x32_bf16 v[204:207], a[136:139], a[24:27], v[204:207]
buffer_load_dwordx4 a[88:91], v2, s[40:43], s35 offen offset:3072 sc1
v_mfma_f32_16x16x32_bf16 v[208:211], a[144:147], a[24:27], 0
v_mfma_f32_16x16x32_bf16 v[208:211], a[148:151], a[28:31], v[208:211]
v_mfma_f32_16x16x32_bf16 v[184:187], a[148:151], a[20:23], 0
buffer_load_dwordx4 v1, s[4:7], s44 offen offset:0 sc1 lds
v_mfma_f32_16x16x32_bf16 v[184:187], a[144:147], a[16:19], v[184:187]
v_mfma_f32_16x16x32_bf16 v[160:163], a[144:147], a[8:11], 0
v_mfma_f32_16x16x32_bf16 v[160:163], a[148:151], a[12:15], v[160:163]
v_mfma_f32_16x16x32_bf16 v[136:139], a[148:151], a[4:7], 0
buffer_load_dwordx4 a[92:95], v2, s[40:43], s33 offen offset:3072 sc1
s_add_u32 s35, s35, 8192
v_mfma_f32_16x16x32_bf16 v[136:139], a[144:147], a[0:3], v[136:139]
s_add_u32 s33, s33, 8192
v_mfma_f32_16x16x32_bf16 a[176:179], a[152:155], a[160:163], 0
s_waitcnt vmcnt(13) lgkmcnt(0)
v_mfma_f32_16x16x32_bf16 v[140:143], a[96:99], a[32:35], v[140:143]
ds_read_b128 a[128:131], v5 offset:17408
v_mfma_f32_16x16x32_bf16 v[140:143], a[100:103], a[36:39], v[140:143]
buffer_load_dwordx4 a[0:3], v2, s[40:43], s35 offen offset:0 sc1
v_mfma_f32_16x16x32_bf16 v[164:167], a[100:103], a[44:47], v[164:167]
ds_read_b128 a[132:135], v5 offset:23552
v_mfma_f32_16x16x32_bf16 v[164:167], a[96:99], a[40:43], v[164:167]
v_mfma_f32_16x16x32_bf16 v[188:191], a[96:99], a[48:51], v[188:191]
ds_read_b128 a[136:139], v5 offset:12288
v_mfma_f32_16x16x32_bf16 v[188:191], a[100:103], a[52:55], v[188:191]
buffer_load_dwordx4 v1, s[4:7], s44 offen offset:1024 sc1 lds
v_mfma_f32_16x16x32_bf16 v[212:215], a[100:103], a[60:63], v[212:215]
ds_read_b128 a[140:143], v5 offset:18432
v_mfma_f32_16x16x32_bf16 v[212:215], a[96:99], a[56:59], v[212:215]
v_mfma_f32_16x16x32_bf16 v[216:219], a[104:107], a[56:59], v[216:219]
v_mfma_f32_16x16x32_bf16 v[216:219], a[108:111], a[60:63], v[216:219]
buffer_load_dwordx4 a[4:7], v2, s[40:43], s33 offen offset:0 sc1
v_mfma_f32_16x16x32_bf16 v[192:195], a[108:111], a[52:55], v[192:195]
ds_read_b128 a[144:147], v5 offset:13312
v_mfma_f32_16x16x32_bf16 v[192:195], a[104:107], a[48:51], v[192:195]
ds_read_b128 a[148:151], v5 offset:19456
v_mfma_f32_16x16x32_bf16 v[168:171], a[104:107], a[40:43], v[168:171]
v_mfma_f32_16x16x32_bf16 v[168:171], a[108:111], a[44:47], v[168:171]
buffer_load_dwordx4 a[8:11], v2, s[40:43], s35 offen offset:1024 sc1
v_mfma_f32_16x16x32_bf16 v[144:147], a[108:111], a[36:39], v[144:147]
ds_read_b128 a[152:155], v6 offset:5120
v_mfma_f32_16x16x32_bf16 v[144:147], a[104:107], a[32:35], v[144:147]
v_mfma_f32_16x16x32_bf16 v[148:151], a[112:115], a[32:35], v[148:151]
v_mfma_f32_16x16x32_bf16 v[148:151], a[116:119], a[36:39], v[148:151]
buffer_load_dwordx4 v1, s[4:7], s44 offen offset:2048 sc1 lds
s_add_u32 m0, s18, 0x12000
v_mfma_f32_16x16x32_bf16 v[172:175], a[116:119], a[44:47], v[172:175]
s_add_u32 s44, s50, 0xe12000
v_mfma_f32_16x16x32_bf16 v[172:175], a[112:115], a[40:43], v[172:175]
v_mfma_f32_16x16x32_bf16 v[196:199], a[112:115], a[48:51], v[196:199]
v_mfma_f32_16x16x32_bf16 v[196:199], a[116:119], a[52:55], v[196:199]
buffer_load_dwordx4 a[12:15], v2, s[40:43], s33 offen offset:1024 sc1
v_mfma_f32_16x16x32_bf16 v[220:223], a[116:119], a[60:63], v[220:223]
v_mfma_f32_16x16x32_bf16 v[220:223], a[112:115], a[56:59], v[220:223]
v_mfma_f32_16x16x32_bf16 a[180:183], a[120:123], a[160:163], 0
s_waitcnt lgkmcnt(0)
v_mfma_f32_16x16x32_bf16 v[224:227], a[128:131], a[56:59], v[224:227]
ds_read_b128 a[96:99], v5 offset:26624
v_mfma_f32_16x16x32_bf16 v[224:227], a[132:135], a[60:63], v[224:227]
buffer_load_dwordx4 a[16:19], v2, s[40:43], s35 offen offset:2048 sc1
v_mfma_f32_16x16x32_bf16 v[200:203], a[132:135], a[52:55], v[200:203]
ds_read_b128 a[100:103], v5 offset:32768
v_mfma_f32_16x16x32_bf16 v[200:203], a[128:131], a[48:51], v[200:203]
v_mfma_f32_16x16x32_bf16 v[176:179], a[128:131], a[40:43], v[176:179]
buffer_load_dwordx4 v1, s[4:7], s44 offen offset:0 sc1 lds
v_mfma_f32_16x16x32_bf16 v[176:179], a[132:135], a[44:47], v[176:179]
ds_read_b128 a[104:107], v5 offset:27648
v_mfma_f32_16x16x32_bf16 v[152:155], a[132:135], a[36:39], v[152:155]
ds_read_b128 a[108:111], v5 offset:33792
v_mfma_f32_16x16x32_bf16 v[152:155], a[128:131], a[32:35], v[152:155]
v_mfma_f32_16x16x32_bf16 v[132:135], a[136:139], a[32:35], v[132:135]
buffer_load_dwordx4 a[20:23], v2, s[40:43], s33 offen offset:2048 sc1
v_mfma_f32_16x16x32_bf16 v[132:135], a[140:143], a[36:39], v[132:135]
ds_read_b128 a[112:115], v5 offset:28672
v_mfma_f32_16x16x32_bf16 v[156:159], a[140:143], a[44:47], v[156:159]
v_mfma_f32_16x16x32_bf16 v[156:159], a[136:139], a[40:43], v[156:159]
buffer_load_dwordx4 v1, s[4:7], s44 offen offset:1024 sc1 lds
v_mfma_f32_16x16x32_bf16 v[180:183], a[136:139], a[48:51], v[180:183]
ds_read_b128 a[116:119], v5 offset:34816
v_mfma_f32_16x16x32_bf16 v[180:183], a[140:143], a[52:55], v[180:183]
ds_read_b128 a[120:123], v6 offset:26624
v_mfma_f32_16x16x32_bf16 v[204:207], a[140:143], a[60:63], v[204:207]
v_mfma_f32_16x16x32_bf16 v[204:207], a[136:139], a[56:59], v[204:207]
buffer_load_dwordx4 a[24:27], v2, s[40:43], s35 offen offset:3072 sc1
v_mfma_f32_16x16x32_bf16 v[208:211], a[144:147], a[56:59], v[208:211]
v_mfma_f32_16x16x32_bf16 v[208:211], a[148:151], a[60:63], v[208:211]
v_mfma_f32_16x16x32_bf16 v[184:187], a[148:151], a[52:55], v[184:187]
buffer_load_dwordx4 v1, s[4:7], s44 offen offset:2048 sc1 lds
s_add_u32 m0, s18, 0x15000
v_mfma_f32_16x16x32_bf16 v[184:187], a[144:147], a[48:51], v[184:187]
s_add_u32 s44, s50, 0xe15000
v_mfma_f32_16x16x32_bf16 v[160:163], a[144:147], a[40:43], v[160:163]
v_mfma_f32_16x16x32_bf16 v[160:163], a[148:151], a[44:47], v[160:163]
v_mfma_f32_16x16x32_bf16 v[136:139], a[148:151], a[36:39], v[136:139]
buffer_load_dwordx4 a[28:31], v2, s[40:43], s33 offen offset:3072 sc1
s_add_u32 s35, s35, 8192
v_mfma_f32_16x16x32_bf16 v[136:139], a[144:147], a[32:35], v[136:139]
s_add_u32 s33, s33, 8192
v_mfma_f32_16x16x32_bf16 a[184:187], a[152:155], a[160:163], 0
s_waitcnt vmcnt(13) lgkmcnt(0)
v_mfma_f32_16x16x32_bf16 v[140:143], a[96:99], a[64:67], v[140:143]
ds_read_b128 a[128:131], v5 offset:29696
v_mfma_f32_16x16x32_bf16 v[140:143], a[100:103], a[68:71], v[140:143]
buffer_load_dwordx4 a[32:35], v2, s[40:43], s35 offen offset:0 sc1
v_mfma_f32_16x16x32_bf16 v[164:167], a[100:103], a[76:79], v[164:167]
ds_read_b128 a[132:135], v5 offset:35840
v_mfma_f32_16x16x32_bf16 v[164:167], a[96:99], a[72:75], v[164:167]
v_mfma_f32_16x16x32_bf16 v[188:191], a[96:99], a[80:83], v[188:191]
ds_read_b128 a[136:139], v5 offset:24576
v_mfma_f32_16x16x32_bf16 v[188:191], a[100:103], a[84:87], v[188:191]
buffer_load_dwordx4 v1, s[4:7], s44 offen offset:0 sc1 lds
s_add_u32 s63, s28, 8
v_mfma_f32_16x16x32_bf16 v[212:215], a[100:103], a[92:95], v[212:215]
s_lshl_b32 s63, s63, 12
ds_read_b128 a[140:143], v5 offset:30720
v_mfma_f32_16x16x32_bf16 v[212:215], a[96:99], a[88:91], v[212:215]
v_mfma_f32_16x16x32_bf16 v[216:219], a[104:107], a[88:91], v[216:219]
v_mfma_f32_16x16x32_bf16 v[216:219], a[108:111], a[92:95], v[216:219]
buffer_load_dwordx4 a[36:39], v2, s[40:43], s33 offen offset:0 sc1
v_mfma_f32_16x16x32_bf16 v[192:195], a[108:111], a[84:87], v[192:195]
ds_read_b128 a[144:147], v5 offset:25600
v_mfma_f32_16x16x32_bf16 v[192:195], a[104:107], a[80:83], v[192:195]
ds_read_b128 a[148:151], v5 offset:31744
v_mfma_f32_16x16x32_bf16 v[168:171], a[104:107], a[72:75], v[168:171]
v_mfma_f32_16x16x32_bf16 v[168:171], a[108:111], a[76:79], v[168:171]
buffer_load_dwordx4 a[40:43], v2, s[40:43], s35 offen offset:1024 sc1
v_mfma_f32_16x16x32_bf16 v[144:147], a[108:111], a[68:71], v[144:147]
ds_read_b128 a[152:155], v6 offset:27648
v_mfma_f32_16x16x32_bf16 v[144:147], a[104:107], a[64:67], v[144:147]
v_mfma_f32_16x16x32_bf16 v[148:151], a[112:115], a[64:67], v[148:151]
v_mfma_f32_16x16x32_bf16 v[148:151], a[116:119], a[68:71], v[148:151]
buffer_load_dwordx4 a[168:171], v3, s[40:43], s63 offen sc1
v_mfma_f32_16x16x32_bf16 v[172:175], a[116:119], a[76:79], v[172:175]
v_mfma_f32_16x16x32_bf16 v[172:175], a[112:115], a[72:75], v[172:175]
v_mfma_f32_16x16x32_bf16 v[196:199], a[112:115], a[80:83], v[196:199]
v_mfma_f32_16x16x32_bf16 v[196:199], a[116:119], a[84:87], v[196:199]
buffer_load_dwordx4 a[44:47], v2, s[40:43], s33 offen offset:1024 sc1
v_mfma_f32_16x16x32_bf16 v[220:223], a[116:119], a[92:95], v[220:223]
v_mfma_f32_16x16x32_bf16 v[220:223], a[112:115], a[88:91], v[220:223]
v_mfma_f32_16x16x32_bf16 a[172:175], a[120:123], a[164:167], a[172:175]
s_waitcnt lgkmcnt(0)
v_mfma_f32_16x16x32_bf16 v[224:227], a[128:131], a[88:91], v[224:227]
ds_read_b128 a[96:99], v5 offset:38912
v_mfma_f32_16x16x32_bf16 v[224:227], a[132:135], a[92:95], v[224:227]
buffer_load_dwordx4 a[48:51], v2, s[40:43], s35 offen offset:2048 sc1
v_mfma_f32_16x16x32_bf16 v[200:203], a[132:135], a[84:87], v[200:203]
ds_read_b128 a[100:103], v5 offset:45056
v_mfma_f32_16x16x32_bf16 v[200:203], a[128:131], a[80:83], v[200:203]
v_mfma_f32_16x16x32_bf16 v[176:179], a[128:131], a[72:75], v[176:179]
buffer_load_dwordx4 v1, s[4:7], s44 offen offset:1024 sc1 lds
v_mfma_f32_16x16x32_bf16 v[176:179], a[132:135], a[76:79], v[176:179]
ds_read_b128 a[104:107], v5 offset:39936
v_mfma_f32_16x16x32_bf16 v[152:155], a[132:135], a[68:71], v[152:155]
ds_read_b128 a[108:111], v5 offset:46080
v_mfma_f32_16x16x32_bf16 v[152:155], a[128:131], a[64:67], v[152:155]
v_mfma_f32_16x16x32_bf16 v[132:135], a[136:139], a[64:67], v[132:135]
buffer_load_dwordx4 a[52:55], v2, s[40:43], s33 offen offset:2048 sc1
v_mfma_f32_16x16x32_bf16 v[132:135], a[140:143], a[68:71], v[132:135]
ds_read_b128 a[112:115], v5 offset:40960
v_mfma_f32_16x16x32_bf16 v[156:159], a[140:143], a[76:79], v[156:159]
v_mfma_f32_16x16x32_bf16 v[156:159], a[136:139], a[72:75], v[156:159]
buffer_load_dwordx4 v1, s[4:7], s44 offen offset:2048 sc1 lds
v_mfma_f32_16x16x32_bf16 v[180:183], a[136:139], a[80:83], v[180:183]
v_and_b32 v232, 15, v0
v_lshlrev_b32 v232, 7, v232
v_mfma_f32_16x16x32_bf16 v[180:183], a[140:143], a[84:87], v[180:183]
v_lshrrev_b32 v233, 4, v0
v_lshlrev_b32 v233, 4, v233
v_mfma_f32_16x16x32_bf16 v[204:207], a[140:143], a[92:95], v[204:207]
v_add_u32 v232, v233, v232
s_mul_i32 s38, s30, 12288
v_mfma_f32_16x16x32_bf16 v[204:207], a[136:139], a[88:91], v[204:207]
buffer_load_dwordx4 a[56:59], v2, s[40:43], s35 offen offset:3072 sc1
s_add_u32 s38, s38, 0x300000
v_mfma_f32_16x16x32_bf16 v[208:211], a[144:147], a[88:91], v[208:211]
s_add_u32 s39, s28, 4
s_min_u32 s39, s39, 5
s_lshl_b32 s36, s28, 11
v_mfma_f32_16x16x32_bf16 v[208:211], a[148:151], a[92:95], v[208:211]
s_add_u32 s36, s36, s38
s_lshl_b32 s37, s39, 11
s_add_u32 s37, s37, s38
v_mfma_f32_16x16x32_bf16 v[184:187], a[148:151], a[84:87], v[184:187]
buffer_load_dwordx4 v[48:51], v232, s[4:7], s36 offen sc1
v_mfma_f32_16x16x32_bf16 v[184:187], a[144:147], a[80:83], v[184:187]
ds_read_b128 a[116:119], v5 offset:47104
v_mfma_f32_16x16x32_bf16 v[160:163], a[144:147], a[72:75], v[160:163]
ds_read_b128 a[120:123], v6 offset:28672
v_mfma_f32_16x16x32_bf16 v[160:163], a[148:151], a[76:79], v[160:163]
v_mfma_f32_16x16x32_bf16 v[136:139], a[148:151], a[68:71], v[136:139]
buffer_load_dwordx4 a[60:63], v2, s[40:43], s33 offen offset:3072 sc1
s_add_u32 s35, s35, 8192
v_mfma_f32_16x16x32_bf16 v[136:139], a[144:147], a[64:67], v[136:139]
s_add_u32 s33, s33, 8192
v_mfma_f32_16x16x32_bf16 a[176:179], a[152:155], a[164:167], a[176:179]
s_waitcnt vmcnt(13) lgkmcnt(0)
v_mfma_f32_16x16x32_bf16 v[140:143], a[96:99], a[0:3], v[140:143]
ds_read_b128 a[128:131], v5 offset:41984
v_mfma_f32_16x16x32_bf16 v[140:143], a[100:103], a[4:7], v[140:143]
buffer_load_dwordx4 a[64:67], v2, s[40:43], s35 offen offset:0 sc1
v_mfma_f32_16x16x32_bf16 v[164:167], a[100:103], a[12:15], v[164:167]
ds_read_b128 a[132:135], v5 offset:48128
v_mfma_f32_16x16x32_bf16 v[164:167], a[96:99], a[8:11], v[164:167]
v_mfma_f32_16x16x32_bf16 v[188:191], a[96:99], a[16:19], v[188:191]
ds_read_b128 a[136:139], v5 offset:36864
v_mfma_f32_16x16x32_bf16 v[188:191], a[100:103], a[20:23], v[188:191]
buffer_load_dwordx4 v[52:55], v232, s[4:7], s37 offen sc1
s_add_u32 m0, s18, 0x18000
v_mfma_f32_16x16x32_bf16 v[212:215], a[100:103], a[28:31], v[212:215]
s_add_u32 s44, s50, 0xe18000
ds_read_b128 a[140:143], v5 offset:43008
v_mfma_f32_16x16x32_bf16 v[212:215], a[96:99], a[24:27], v[212:215]
v_mfma_f32_16x16x32_bf16 v[216:219], a[104:107], a[24:27], v[216:219]
v_mfma_f32_16x16x32_bf16 v[216:219], a[108:111], a[28:31], v[216:219]
buffer_load_dwordx4 a[68:71], v2, s[40:43], s33 offen offset:0 sc1
v_mfma_f32_16x16x32_bf16 v[192:195], a[108:111], a[20:23], v[192:195]
ds_read_b128 a[144:147], v5 offset:37888
v_mfma_f32_16x16x32_bf16 v[192:195], a[104:107], a[16:19], v[192:195]
ds_read_b128 a[148:151], v5 offset:44032
v_mfma_f32_16x16x32_bf16 v[168:171], a[104:107], a[8:11], v[168:171]
v_mfma_f32_16x16x32_bf16 v[168:171], a[108:111], a[12:15], v[168:171]
buffer_load_dwordx4 a[72:75], v2, s[40:43], s35 offen offset:1024 sc1
v_mfma_f32_16x16x32_bf16 v[144:147], a[108:111], a[4:7], v[144:147]
ds_read_b128 a[152:155], v6 offset:29696
v_mfma_f32_16x16x32_bf16 v[144:147], a[104:107], a[0:3], v[144:147]
v_mfma_f32_16x16x32_bf16 v[148:151], a[112:115], a[0:3], v[148:151]
v_mfma_f32_16x16x32_bf16 v[148:151], a[116:119], a[4:7], v[148:151]
buffer_load_dwordx4 v1, s[4:7], s44 offen offset:0 sc1 lds
v_mfma_f32_16x16x32_bf16 v[172:175], a[116:119], a[12:15], v[172:175]
v_mfma_f32_16x16x32_bf16 v[172:175], a[112:115], a[8:11], v[172:175]
v_mfma_f32_16x16x32_bf16 v[196:199], a[112:115], a[16:19], v[196:199]
v_mfma_f32_16x16x32_bf16 v[196:199], a[116:119], a[20:23], v[196:199]
buffer_load_dwordx4 a[76:79], v2, s[40:43], s33 offen offset:1024 sc1
v_mfma_f32_16x16x32_bf16 v[220:223], a[116:119], a[28:31], v[220:223]
v_mfma_f32_16x16x32_bf16 v[220:223], a[112:115], a[24:27], v[220:223]
v_mfma_f32_16x16x32_bf16 a[180:183], a[120:123], a[164:167], a[180:183]
s_waitcnt lgkmcnt(0)
s_barrier
v_mfma_f32_16x16x32_bf16 v[224:227], a[128:131], a[24:27], v[224:227]
v_add_u32 v5, 49152, v1
v_add_u32 v6, s55, v5
v_mfma_f32_16x16x32_bf16 v[224:227], a[132:135], a[28:31], v[224:227]
buffer_load_dwordx4 a[80:83], v2, s[40:43], s35 offen offset:2048 sc1
v_mfma_f32_16x16x32_bf16 v[200:203], a[132:135], a[20:23], v[200:203]
ds_read_b128 a[96:99], v5 offset:2048
v_mfma_f32_16x16x32_bf16 v[200:203], a[128:131], a[16:19], v[200:203]
ds_read_b128 a[100:103], v5 offset:8192
v_mfma_f32_16x16x32_bf16 v[176:179], a[128:131], a[8:11], v[176:179]
buffer_load_dwordx4 v1, s[4:7], s44 offen offset:1024 sc1 lds
v_mfma_f32_16x16x32_bf16 v[176:179], a[132:135], a[12:15], v[176:179]
ds_read_b128 a[104:107], v5 offset:3072
v_mfma_f32_16x16x32_bf16 v[152:155], a[132:135], a[4:7], v[152:155]
ds_read_b128 a[108:111], v5 offset:9216
v_mfma_f32_16x16x32_bf16 v[152:155], a[128:131], a[0:3], v[152:155]
ds_write_b128 v231, a[220:223] offset:24576
v_mfma_f32_16x16x32_bf16 v[132:135], a[136:139], a[0:3], v[132:135]
buffer_load_dwordx4 a[84:87], v2, s[40:43], s33 offen offset:2048 sc1
v_mfma_f32_16x16x32_bf16 v[132:135], a[140:143], a[4:7], v[132:135]
ds_read_b128 a[112:115], v5 offset:4096
v_mfma_f32_16x16x32_bf16 v[156:159], a[140:143], a[12:15], v[156:159]
v_mfma_f32_16x16x32_bf16 v[156:159], a[136:139], a[8:11], v[156:159]
buffer_load_dwordx4 v1, s[4:7], s44 offen offset:2048 sc1 lds
s_add_u32 m0, s18, 0x1b000
v_mfma_f32_16x16x32_bf16 v[180:183], a[136:139], a[16:19], v[180:183]
s_add_u32 s44, s50, 0xe1b000
ds_read_b128 a[116:119], v5 offset:10240
v_mfma_f32_16x16x32_bf16 v[180:183], a[140:143], a[20:23], v[180:183]
ds_read_b128 a[120:123], v6 offset:2048
v_mfma_f32_16x16x32_bf16 v[204:207], a[140:143], a[28:31], v[204:207]
ds_write_b128 v231, a[224:227] offset:25600
v_mfma_f32_16x16x32_bf16 v[204:207], a[136:139], a[24:27], v[204:207]
buffer_load_dwordx4 a[88:91], v2, s[40:43], s35 offen offset:3072 sc1
v_mfma_f32_16x16x32_bf16 v[208:211], a[144:147], a[24:27], v[208:211]
v_mfma_f32_16x16x32_bf16 v[208:211], a[148:151], a[28:31], v[208:211]
v_mfma_f32_16x16x32_bf16 v[184:187], a[148:151], a[20:23], v[184:187]
buffer_load_dwordx4 v1, s[4:7], s44 offen offset:0 sc1 lds
v_mfma_f32_16x16x32_bf16 v[184:187], a[144:147], a[16:19], v[184:187]
v_mfma_f32_16x16x32_bf16 v[160:163], a[144:147], a[8:11], v[160:163]
v_mfma_f32_16x16x32_bf16 v[160:163], a[148:151], a[12:15], v[160:163]
v_mfma_f32_16x16x32_bf16 v[136:139], a[148:151], a[4:7], v[136:139]
buffer_load_dwordx4 a[92:95], v2, s[40:43], s33 offen offset:3072 sc1
s_add_u32 s35, s35, 8192
v_mfma_f32_16x16x32_bf16 v[136:139], a[144:147], a[0:3], v[136:139]
s_add_u32 s33, s33, 8192
ds_write_b128 v231, a[188:191] offset:0
v_mfma_f32_16x16x32_bf16 a[184:187], a[152:155], a[164:167], a[184:187]
s_waitcnt vmcnt(13) lgkmcnt(2)
v_mfma_f32_16x16x32_bf16 v[140:143], a[96:99], a[32:35], v[140:143]
ds_read_b128 a[128:131], v5 offset:5120
v_mfma_f32_16x16x32_bf16 v[140:143], a[100:103], a[36:39], v[140:143]
buffer_load_dwordx4 a[0:3], v2, s[40:43], s35 offen offset:0 sc1
v_mfma_f32_16x16x32_bf16 v[164:167], a[100:103], a[44:47], v[164:167]
ds_read_b128 a[132:135], v5 offset:11264
v_mfma_f32_16x16x32_bf16 v[164:167], a[96:99], a[40:43], v[164:167]
v_mfma_f32_16x16x32_bf16 v[188:191], a[96:99], a[48:51], v[188:191]
ds_read_b128 a[136:139], v5 offset:0
v_mfma_f32_16x16x32_bf16 v[188:191], a[100:103], a[52:55], v[188:191]
buffer_load_dwordx4 v1, s[4:7], s44 offen offset:1024 sc1 lds
s_add_u32 s63, s28, 12
v_mfma_f32_16x16x32_bf16 v[212:215], a[100:103], a[60:63], v[212:215]
s_lshl_b32 s63, s63, 12
ds_read_b128 a[140:143], v5 offset:6144
v_mfma_f32_16x16x32_bf16 v[212:215], a[96:99], a[56:59], v[212:215]
v_mfma_f32_16x16x32_bf16 v[216:219], a[104:107], a[56:59], v[216:219]
ds_write_b128 v231, a[192:195] offset:1024
v_mfma_f32_16x16x32_bf16 v[216:219], a[108:111], a[60:63], v[216:219]
buffer_load_dwordx4 a[4:7], v2, s[40:43], s33 offen offset:0 sc1
v_mfma_f32_16x16x32_bf16 v[192:195], a[108:111], a[52:55], v[192:195]
ds_read_b128 a[144:147], v5 offset:1024
v_mfma_f32_16x16x32_bf16 v[192:195], a[104:107], a[48:51], v[192:195]
ds_read_b128 a[148:151], v5 offset:7168
v_mfma_f32_16x16x32_bf16 v[168:171], a[104:107], a[40:43], v[168:171]
v_mfma_f32_16x16x32_bf16 v[168:171], a[108:111], a[44:47], v[168:171]
buffer_load_dwordx4 a[8:11], v2, s[40:43], s35 offen offset:1024 sc1
v_mfma_f32_16x16x32_bf16 v[144:147], a[108:111], a[36:39], v[144:147]
ds_read_b128 a[152:155], v6 offset:3072
v_mfma_f32_16x16x32_bf16 v[144:147], a[104:107], a[32:35], v[144:147]
v_mfma_f32_16x16x32_bf16 v[148:151], a[112:115], a[32:35], v[148:151]
v_mfma_f32_16x16x32_bf16 v[148:151], a[116:119], a[36:39], v[148:151]
buffer_load_dwordx4 a[160:163], v3, s[40:43], s63 offen sc1
v_mfma_f32_16x16x32_bf16 v[172:175], a[116:119], a[44:47], v[172:175]
v_mfma_f32_16x16x32_bf16 v[172:175], a[112:115], a[40:43], v[172:175]
ds_write_b128 v231, a[196:199] offset:8192
v_mfma_f32_16x16x32_bf16 v[196:199], a[112:115], a[48:51], v[196:199]
v_mfma_f32_16x16x32_bf16 v[196:199], a[116:119], a[52:55], v[196:199]
buffer_load_dwordx4 a[12:15], v2, s[40:43], s33 offen offset:1024 sc1
v_mfma_f32_16x16x32_bf16 v[220:223], a[116:119], a[60:63], v[220:223]
v_mfma_f32_16x16x32_bf16 v[220:223], a[112:115], a[56:59], v[220:223]
v_mfma_f32_16x16x32_bf16 a[172:175], a[120:123], a[168:171], a[172:175]
s_waitcnt lgkmcnt(1)
v_mfma_f32_16x16x32_bf16 v[224:227], a[128:131], a[56:59], v[224:227]
ds_read_b128 a[96:99], v5 offset:14336
v_mfma_f32_16x16x32_bf16 v[224:227], a[132:135], a[60:63], v[224:227]
buffer_load_dwordx4 a[16:19], v2, s[40:43], s35 offen offset:2048 sc1
v_mfma_f32_16x16x32_bf16 v[200:203], a[132:135], a[52:55], v[200:203]
ds_read_b128 a[100:103], v5 offset:20480
v_mfma_f32_16x16x32_bf16 v[200:203], a[128:131], a[48:51], v[200:203]
v_mfma_f32_16x16x32_bf16 v[176:179], a[128:131], a[40:43], v[176:179]
buffer_load_dwordx4 v1, s[4:7], s44 offen offset:2048 sc1 lds
s_add_u32 m0, s18, 0x1e000
v_mfma_f32_16x16x32_bf16 v[176:179], a[132:135], a[44:47], v[176:179]
L_stub0:
s_cbranch_execz L_wret0
s_add_u32 s44, s50, 0xe1e000
ds_read_b128 a[104:107], v5 offset:15360
v_mfma_f32_16x16x32_bf16 v[152:155], a[132:135], a[36:39], v[152:155]
ds_read_b128 a[108:111], v5 offset:21504
v_mfma_f32_16x16x32_bf16 v[152:155], a[128:131], a[32:35], v[152:155]
ds_write_b128 v231, a[200:203] offset:9216
v_mfma_f32_16x16x32_bf16 v[132:135], a[136:139], a[32:35], v[132:135]
buffer_load_dwordx4 a[20:23], v2, s[40:43], s33 offen offset:2048 sc1
v_mfma_f32_16x16x32_bf16 v[132:135], a[140:143], a[36:39], v[132:135]
ds_read_b128 a[112:115], v5 offset:16384
v_mfma_f32_16x16x32_bf16 v[156:159], a[140:143], a[44:47], v[156:159]
v_mfma_f32_16x16x32_bf16 v[156:159], a[136:139], a[40:43], v[156:159]
buffer_load_dwordx4 v1, s[4:7], s44 offen offset:0 sc1 lds
v_mfma_f32_16x16x32_bf16 v[180:183], a[136:139], a[48:51], v[180:183]
ds_read_b128 a[116:119], v5 offset:22528
v_mfma_f32_16x16x32_bf16 v[180:183], a[140:143], a[52:55], v[180:183]
ds_read_b128 a[120:123], v6 offset:4096
v_mfma_f32_16x16x32_bf16 v[204:207], a[140:143], a[60:63], v[204:207]
v_mfma_f32_16x16x32_bf16 v[204:207], a[136:139], a[56:59], v[204:207]
buffer_load_dwordx4 a[24:27], v2, s[40:43], s35 offen offset:3072 sc1
v_mfma_f32_16x16x32_bf16 v[208:211], a[144:147], a[56:59], v[208:211]
ds_write_b128 v231, a[204:207] offset:16384
v_mfma_f32_16x16x32_bf16 v[208:211], a[148:151], a[60:63], v[208:211]
v_mfma_f32_16x16x32_bf16 v[184:187], a[148:151], a[52:55], v[184:187]
buffer_load_dwordx4 v1, s[4:7], s44 offen offset:1024 sc1 lds
v_mfma_f32_16x16x32_bf16 v[184:187], a[144:147], a[48:51], v[184:187]
v_mfma_f32_16x16x32_bf16 v[160:163], a[144:147], a[40:43], v[160:163]
v_mfma_f32_16x16x32_bf16 v[160:163], a[148:151], a[44:47], v[160:163]
v_mfma_f32_16x16x32_bf16 v[136:139], a[148:151], a[36:39], v[136:139]
buffer_load_dwordx4 a[28:31], v2, s[40:43], s33 offen offset:3072 sc1
s_add_u32 s35, s35, 8192
v_mfma_f32_16x16x32_bf16 v[136:139], a[144:147], a[32:35], v[136:139]
s_add_u32 s33, s33, 8192
v_mfma_f32_16x16x32_bf16 a[176:179], a[152:155], a[168:171], a[176:179]
s_waitcnt vmcnt(13) lgkmcnt(1)
v_mfma_f32_16x16x32_bf16 v[140:143], a[96:99], a[64:67], v[140:143]
ds_read_b128 a[128:131], v5 offset:17408
v_mfma_f32_16x16x32_bf16 v[140:143], a[100:103], a[68:71], v[140:143]
buffer_load_dwordx4 a[32:35], v2, s[40:43], s35 offen offset:0 sc1
v_mfma_f32_16x16x32_bf16 v[164:167], a[100:103], a[76:79], v[164:167]
ds_read_b128 a[132:135], v5 offset:23552
v_mfma_f32_16x16x32_bf16 v[164:167], a[96:99], a[72:75], v[164:167]
ds_write_b128 v231, a[208:211] offset:17408
v_mfma_f32_16x16x32_bf16 v[188:191], a[96:99], a[80:83], v[188:191]
ds_read_b128 a[136:139], v5 offset:12288
v_mfma_f32_16x16x32_bf16 v[188:191], a[100:103], a[84:87], v[188:191]
buffer_load_dwordx4 v1, s[4:7], s44 offen offset:2048 sc1 lds
s_add_u32 m0, s18, 0x21000
v_mfma_f32_16x16x32_bf16 v[212:215], a[100:103], a[92:95], v[212:215]
s_add_u32 s44, s50, 0xe21000
ds_read_b128 a[140:143], v5 offset:18432
v_mfma_f32_16x16x32_bf16 v[212:215], a[96:99], a[88:91], v[212:215]
v_mfma_f32_16x16x32_bf16 v[216:219], a[104:107], a[88:91], v[216:219]
v_mfma_f32_16x16x32_bf16 v[216:219], a[108:111], a[92:95], v[216:219]
buffer_load_dwordx4 a[36:39], v2, s[40:43], s33 offen offset:0 sc1
v_mfma_f32_16x16x32_bf16 v[192:195], a[108:111], a[84:87], v[192:195]
ds_read_b128 a[144:147], v5 offset:13312
v_mfma_f32_16x16x32_bf16 v[192:195], a[104:107], a[80:83], v[192:195]
ds_read_b128 a[148:151], v5 offset:19456
v_mfma_f32_16x16x32_bf16 v[168:171], a[104:107], a[72:75], v[168:171]
v_mfma_f32_16x16x32_bf16 v[168:171], a[108:111], a[76:79], v[168:171]
buffer_load_dwordx4 a[40:43], v2, s[40:43], s35 offen offset:1024 sc1
v_mfma_f32_16x16x32_bf16 v[144:147], a[108:111], a[68:71], v[144:147]
ds_read_b128 a[152:155], v6 offset:5120
v_mfma_f32_16x16x32_bf16 v[144:147], a[104:107], a[64:67], v[144:147]
v_mfma_f32_16x16x32_bf16 v[148:151], a[112:115], a[64:67], v[148:151]
v_mfma_f32_16x16x32_bf16 v[148:151], a[116:119], a[68:71], v[148:151]
buffer_load_dwordx4 v1, s[4:7], s44 offen offset:0 sc1 lds
v_mfma_f32_16x16x32_bf16 v[172:175], a[116:119], a[76:79], v[172:175]
v_mfma_f32_16x16x32_bf16 v[172:175], a[112:115], a[72:75], v[172:175]
v_mfma_f32_16x16x32_bf16 v[196:199], a[112:115], a[80:83], v[196:199]
v_mfma_f32_16x16x32_bf16 v[196:199], a[116:119], a[84:87], v[196:199]
buffer_load_dwordx4 a[44:47], v2, s[40:43], s33 offen offset:1024 sc1
v_mfma_f32_16x16x32_bf16 v[220:223], a[116:119], a[92:95], v[220:223]
v_mfma_f32_16x16x32_bf16 v[220:223], a[112:115], a[88:91], v[220:223]
v_mfma_f32_16x16x32_bf16 a[180:183], a[120:123], a[168:171], a[180:183]
s_waitcnt lgkmcnt(0)
s_barrier
v_mfma_f32_16x16x32_bf16 v[224:227], a[128:131], a[88:91], v[224:227]
ds_read_b128 a[96:99], v5 offset:26624
v_mfma_f32_16x16x32_bf16 v[224:227], a[132:135], a[92:95], v[224:227]
buffer_load_dwordx4 a[48:51], v2, s[40:43], s35 offen offset:2048 sc1
v_mfma_f32_16x16x32_bf16 v[200:203], a[132:135], a[84:87], v[200:203]
ds_read_b128 a[100:103], v5 offset:32768
v_mfma_f32_16x16x32_bf16 v[200:203], a[128:131], a[80:83], v[200:203]
ds_read_b64_tr_b16 a[220:221], v230 offset:0
v_mfma_f32_16x16x32_bf16 v[176:179], a[128:131], a[72:75], v[176:179]
buffer_load_dwordx4 v1, s[4:7], s44 offen offset:1024 sc1 lds
v_mfma_f32_16x16x32_bf16 v[176:179], a[132:135], a[76:79], v[176:179]
ds_read_b128 a[104:107], v5 offset:27648
v_mfma_f32_16x16x32_bf16 v[152:155], a[132:135], a[68:71], v[152:155]
ds_read_b128 a[108:111], v5 offset:33792
v_mfma_f32_16x16x32_bf16 v[152:155], a[128:131], a[64:67], v[152:155]
ds_read_b64_tr_b16 a[222:223], v230 offset:2048
v_mfma_f32_16x16x32_bf16 v[132:135], a[136:139], a[64:67], v[132:135]
buffer_load_dwordx4 a[52:55], v2, s[40:43], s33 offen offset:2048 sc1
v_mfma_f32_16x16x32_bf16 v[132:135], a[140:143], a[68:71], v[132:135]
ds_read_b128 a[112:115], v5 offset:28672
v_mfma_f32_16x16x32_bf16 v[156:159], a[140:143], a[76:79], v[156:159]
v_mfma_f32_16x16x32_bf16 v[156:159], a[136:139], a[72:75], v[156:159]
buffer_load_dwordx4 v1, s[4:7], s44 offen offset:2048 sc1 lds
s_add_u32 s88, s82, 0x200000
v_mfma_f32_16x16x32_bf16 v[180:183], a[136:139], a[80:83], v[180:183]
ds_read_b128 a[116:119], v5 offset:34816
v_mfma_f32_16x16x32_bf16 v[180:183], a[140:143], a[84:87], v[180:183]
ds_read_b128 a[120:123], v6 offset:26624
v_mfma_f32_16x16x32_bf16 v[204:207], a[140:143], a[92:95], v[204:207]
ds_read_b64_tr_b16 a[224:225], v230 offset:8
v_mfma_f32_16x16x32_bf16 v[204:207], a[136:139], a[88:91], v[204:207]
buffer_load_dwordx4 a[56:59], v2, s[40:43], s35 offen offset:3072 sc1
v_mfma_f32_16x16x32_bf16 v[208:211], a[144:147], a[88:91], v[208:211]
v_mfma_f32_16x16x32_bf16 v[208:211], a[148:151], a[92:95], v[208:211]
ds_read_b64_tr_b16 a[226:227], v230 offset:2056
v_mfma_f32_16x16x32_bf16 v[184:187], a[148:151], a[84:87], v[184:187]
buffer_load_dwordx4 v[92:95], v1, s[4:7], s88 offen offset:0 sc1
v_mfma_f32_16x16x32_bf16 v[184:187], a[144:147], a[80:83], v[184:187]
v_mfma_f32_16x16x32_bf16 v[160:163], a[144:147], a[72:75], v[160:163]
v_mfma_f32_16x16x32_bf16 v[160:163], a[148:151], a[76:79], v[160:163]
v_mfma_f32_16x16x32_bf16 v[136:139], a[148:151], a[68:71], v[136:139]
buffer_load_dwordx4 a[60:63], v2, s[40:43], s33 offen offset:3072 sc1
s_add_u32 s35, s35, 8192
v_mfma_f32_16x16x32_bf16 v[136:139], a[144:147], a[64:67], v[136:139]
s_add_u32 s33, s33, 8192
ds_read_b64_tr_b16 a[188:189], v248 offset:0
v_mfma_f32_16x16x32_bf16 a[184:187], a[152:155], a[168:171], a[184:187]
s_waitcnt vmcnt(13) lgkmcnt(3)
v_mfma_f32_16x16x32_bf16 v[140:143], a[96:99], a[0:3], v[140:143]
ds_read_b128 a[128:131], v5 offset:29696
v_add_f32_dpp v48, v48, v48 row_ror:8 row_mask:0xf bank_mask:0xf
v_mfma_f32_16x16x32_bf16 v[140:143], a[100:103], a[4:7], v[140:143]
buffer_load_dwordx4 a[64:67], v2, s[40:43], s35 offen offset:0 sc1
v_mfma_f32_16x16x32_bf16 v[164:167], a[100:103], a[12:15], v[164:167]
ds_read_b128 a[132:135], v5 offset:35840
v_add_f32_dpp v49, v49, v49 row_ror:8 row_mask:0xf bank_mask:0xf
v_mfma_f32_16x16x32_bf16 v[164:167], a[96:99], a[8:11], v[164:167]
ds_read_b64_tr_b16 a[190:191], v248 offset:512
v_add_f32_dpp v50, v50, v50 row_ror:8 row_mask:0xf bank_mask:0xf
v_mfma_f32_16x16x32_bf16 v[188:191], a[96:99], a[16:19], v[188:191]
ds_read_b128 a[136:139], v5 offset:24576
v_add_f32_dpp v51, v51, v51 row_ror:8 row_mask:0xf bank_mask:0xf
v_mfma_f32_16x16x32_bf16 v[188:191], a[100:103], a[20:23], v[188:191]
buffer_load_dwordx4 v[96:99], v1, s[4:7], s88 offen offset:1024 sc1
s_add_u32 s63, s28, 16
v_mfma_f32_16x16x32_bf16 v[212:215], a[100:103], a[28:31], v[212:215]
s_lshl_b32 s63, s63, 12
ds_read_b128 a[140:143], v5 offset:30720
v_mfma_f32_16x16x32_bf16 v[212:215], a[96:99], a[24:27], v[212:215]
v_add_f32_dpp v52, v52, v52 row_ror:8 row_mask:0xf bank_mask:0xf
v_add_f32_dpp v53, v53, v53 row_ror:8 row_mask:0xf bank_mask:0xf
v_mfma_f32_16x16x32_bf16 v[216:219], a[104:107], a[24:27], v[216:219]
v_add_f32_dpp v54, v54, v54 row_ror:8 row_mask:0xf bank_mask:0xf
v_add_f32_dpp v55, v55, v55 row_ror:8 row_mask:0xf bank_mask:0xf
v_mfma_f32_16x16x32_bf16 v[216:219], a[108:111], a[28:31], v[216:219]
buffer_load_dwordx4 a[68:71], v2, s[40:43], s33 offen offset:0 sc1
v_mfma_f32_16x16x32_bf16 v[192:195], a[108:111], a[20:23], v[192:195]
ds_read_b128 a[144:147], v5 offset:25600
v_add_f32_dpp v48, v48, v48 row_ror:4 row_mask:0xf bank_mask:0xf
v_mfma_f32_16x16x32_bf16 v[192:195], a[104:107], a[16:19], v[192:195]
ds_read_b128 a[148:151], v5 offset:31744
v_add_f32_dpp v49, v49, v49 row_ror:4 row_mask:0xf bank_mask:0xf
v_mfma_f32_16x16x32_bf16 v[168:171], a[104:107], a[8:11], v[168:171]
ds_read_b64_tr_b16 a[192:193], v248 offset:4096
v_add_f32_dpp v50, v50, v50 row_ror:4 row_mask:0xf bank_mask:0xf
v_mfma_f32_16x16x32_bf16 v[168:171], a[108:111], a[12:15], v[168:171]
buffer_load_dwordx4 a[72:75], v2, s[40:43], s35 offen offset:1024 sc1
v_mfma_f32_16x16x32_bf16 v[144:147], a[108:111], a[4:7], v[144:147]
ds_read_b128 a[152:155], v6 offset:27648
v_add_f32_dpp v51, v51, v51 row_ror:4 row_mask:0xf bank_mask:0xf
v_mfma_f32_16x16x32_bf16 v[144:147], a[104:107], a[0:3], v[144:147]
ds_read_b64_tr_b16 a[194:195], v248 offset:4608
v_add_f32_dpp v52, v52, v52 row_ror:4 row_mask:0xf bank_mask:0xf
v_mfma_f32_16x16x32_bf16 v[148:151], a[112:115], a[0:3], v[148:151]
v_add_f32_dpp v53, v53, v53 row_ror:4 row_mask:0xf bank_mask:0xf
v_add_f32_dpp v54, v54, v54 row_ror:4 row_mask:0xf bank_mask:0xf
v_mfma_f32_16x16x32_bf16 v[148:151], a[116:119], a[4:7], v[148:151]
buffer_load_dwordx4 a[164:167], v3, s[40:43], s63 offen sc1
v_mfma_f32_16x16x32_bf16 v[172:175], a[116:119], a[12:15], v[172:175]
v_add_f32_dpp v55, v55, v55 row_ror:4 row_mask:0xf bank_mask:0xf
v_add_f32_dpp v48, v48, v48 row_ror:2 row_mask:0xf bank_mask:0xf
v_mfma_f32_16x16x32_bf16 v[172:175], a[112:115], a[8:11], v[172:175]
v_add_f32_dpp v49, v49, v49 row_ror:2 row_mask:0xf bank_mask:0xf
v_add_f32_dpp v50, v50, v50 row_ror:2 row_mask:0xf bank_mask:0xf
v_mfma_f32_16x16x32_bf16 v[196:199], a[112:115], a[16:19], v[196:199]
v_add_f32_dpp v51, v51, v51 row_ror:2 row_mask:0xf bank_mask:0xf
v_add_f32_dpp v52, v52, v52 row_ror:2 row_mask:0xf bank_mask:0xf
v_mfma_f32_16x16x32_bf16 v[196:199], a[116:119], a[20:23], v[196:199]
buffer_load_dwordx4 a[76:79], v2, s[40:43], s33 offen offset:1024 sc1
v_mfma_f32_16x16x32_bf16 v[220:223], a[116:119], a[28:31], v[220:223]
ds_read_b64_tr_b16 a[196:197], v249 offset:32
v_add_f32_dpp v53, v53, v53 row_ror:2 row_mask:0xf bank_mask:0xf
v_mfma_f32_16x16x32_bf16 v[220:223], a[112:115], a[24:27], v[220:223]
v_add_f32_dpp v54, v54, v54 row_ror:2 row_mask:0xf bank_mask:0xf
v_add_f32_dpp v55, v55, v55 row_ror:2 row_mask:0xf bank_mask:0xf
v_mfma_f32_16x16x32_bf16 a[172:175], a[120:123], a[160:163], a[172:175]
v_add_f32_dpp v48, v48, v48 row_ror:1 row_mask:0xf bank_mask:0xf
s_waitcnt lgkmcnt(2)
v_mfma_f32_16x16x32_bf16 v[224:227], a[128:131], a[24:27], v[224:227]
ds_read_b128 a[96:99], v5 offset:38912
v_add_f32_dpp v49, v49, v49 row_ror:1 row_mask:0xf bank_mask:0xf
v_mfma_f32_16x16x32_bf16 v[224:227], a[132:135], a[28:31], v[224:227]
buffer_load_dwordx4 a[80:83], v2, s[40:43], s35 offen offset:2048 sc1
v_mfma_f32_16x16x32_bf16 v[200:203], a[132:135], a[20:23], v[200:203]
ds_read_b128 a[100:103], v5 offset:45056
v_add_f32_dpp v50, v50, v50 row_ror:1 row_mask:0xf bank_mask:0xf
v_mfma_f32_16x16x32_bf16 v[200:203], a[128:131], a[16:19], v[200:203]
ds_read_b64_tr_b16 a[198:199], v249 offset:544
v_add_f32_dpp v51, v51, v51 row_ror:1 row_mask:0xf bank_mask:0xf
v_mfma_f32_16x16x32_bf16 v[176:179], a[128:131], a[8:11], v[176:179]
buffer_load_dwordx4 v[100:103], v1, s[4:7], s88 offen offset:2048 sc1
v_mfma_f32_16x16x32_bf16 v[176:179], a[132:135], a[12:15], v[176:179]
ds_read_b128 a[104:107], v5 offset:39936
v_add_f32_dpp v52, v52, v52 row_ror:1 row_mask:0xf bank_mask:0xf
v_mfma_f32_16x16x32_bf16 v[152:155], a[132:135], a[4:7], v[152:155]
ds_read_b128 a[108:111], v5 offset:46080
v_add_f32_dpp v53, v53, v53 row_ror:1 row_mask:0xf bank_mask:0xf
v_mfma_f32_16x16x32_bf16 v[152:155], a[128:131], a[0:3], v[152:155]
ds_read_b64_tr_b16 a[200:201], v249 offset:4128
v_add_f32_dpp v54, v54, v54 row_ror:1 row_mask:0xf bank_mask:0xf
v_mfma_f32_16x16x32_bf16 v[132:135], a[136:139], a[0:3], v[132:135]
buffer_load_dwordx4 a[84:87], v2, s[40:43], s33 offen offset:2048 sc1
v_mfma_f32_16x16x32_bf16 v[132:135], a[140:143], a[4:7], v[132:135]
ds_read_b128 a[112:115], v5 offset:40960
v_add_f32_dpp v55, v55, v55 row_ror:1 row_mask:0xf bank_mask:0xf
v_mfma_f32_16x16x32_bf16 v[156:159], a[140:143], a[12:15], v[156:159]
v_add_u32 v233, 159744, v233
s_lshl_b32 s36, s28, 6
v_mfma_f32_16x16x32_bf16 v[156:159], a[136:139], a[8:11], v[156:159]
buffer_load_dwordx4 v[104:107], v1, s[4:7], s88 offen offset:3072 sc1
s_add_u32 s88, s88, 4096
v_mfma_f32_16x16x32_bf16 v[180:183], a[136:139], a[16:19], v[180:183]
ds_read_b128 a[116:119], v5 offset:47104
s_lshl_b32 s37, s39, 6
v_mfma_f32_16x16x32_bf16 v[180:183], a[140:143], a[20:23], v[180:183]
ds_read_b128 a[120:123], v6 offset:28672
v_add_u32 v232, s36, v233
v_mfma_f32_16x16x32_bf16 v[204:207], a[140:143], a[28:31], v[204:207]
ds_read_b64_tr_b16 a[202:203], v249 offset:4640
v_add_u32 v235, s37, v233
v_mfma_f32_16x16x32_bf16 v[204:207], a[136:139], a[24:27], v[204:207]
buffer_load_dwordx4 a[88:91], v2, s[40:43], s35 offen offset:3072 sc1
v_mfma_f32_16x16x32_bf16 v[208:211], a[144:147], a[24:27], v[208:211]
v_mfma_f32_16x16x32_bf16 v[208:211], a[148:151], a[28:31], v[208:211]
v_mfma_f32_16x16x32_bf16 v[184:187], a[148:151], a[20:23], v[184:187]
buffer_load_dwordx4 v[108:111], v1, s[4:7], s88 offen offset:0 sc1
v_mfma_f32_16x16x32_bf16 v[184:187], a[144:147], a[16:19], v[184:187]
ds_read_b64_tr_b16 a[204:205], v248 offset:8192
v_mfma_f32_16x16x32_bf16 v[160:163], a[144:147], a[8:11], v[160:163]
v_mfma_f32_16x16x32_bf16 v[160:163], a[148:151], a[12:15], v[160:163]
v_mfma_f32_16x16x32_bf16 v[136:139], a[148:151], a[4:7], v[136:139]
buffer_load_dwordx4 a[92:95], v2, s[40:43], s33 offen offset:3072 sc1
s_add_u32 s35, s35, 8192
v_mfma_f32_16x16x32_bf16 v[136:139], a[144:147], a[0:3], v[136:139]
s_add_u32 s33, s33, 8192
v_mfma_f32_16x16x32_bf16 a[176:179], a[152:155], a[160:163], a[176:179]
ds_read_b64_tr_b16 a[206:207], v248 offset:8704
s_waitcnt vmcnt(13) lgkmcnt(3)
v_mfma_f32_16x16x32_bf16 v[140:143], a[96:99], a[32:35], v[140:143]
ds_read_b128 a[128:131], v5 offset:41984
v_mfma_f32_16x16x32_bf16 v[140:143], a[100:103], a[36:39], v[140:143]
buffer_load_dwordx4 a[0:3], v2, s[40:43], s35 offen offset:0 sc1
v_mfma_f32_16x16x32_bf16 v[164:167], a[100:103], a[44:47], v[164:167]
ds_read_b128 a[132:135], v5 offset:48128
v_mfma_f32_16x16x32_bf16 v[164:167], a[96:99], a[40:43], v[164:167]
ds_write_b128 v232, v[48:51]
v_mfma_f32_16x16x32_bf16 v[188:191], a[96:99], a[48:51], v[188:191]
ds_read_b128 a[136:139], v5 offset:36864
v_mfma_f32_16x16x32_bf16 v[188:191], a[100:103], a[52:55], v[188:191]
buffer_load_dwordx4 v[112:115], v1, s[4:7], s88 offen offset:1024 sc1
v_mfma_f32_16x16x32_bf16 v[212:215], a[100:103], a[60:63], v[212:215]
ds_read_b128 a[140:143], v5 offset:43008
v_mfma_f32_16x16x32_bf16 v[212:215], a[96:99], a[56:59], v[212:215]
ds_read_b64_tr_b16 a[208:209], v248 offset:12288
v_mfma_f32_16x16x32_bf16 v[216:219], a[104:107], a[56:59], v[216:219]
ds_write_b128 v235, v[52:55]
v_mfma_f32_16x16x32_bf16 v[216:219], a[108:111], a[60:63], v[216:219]
buffer_load_dwordx4 a[4:7], v2, s[40:43], s33 offen offset:0 sc1
v_mfma_f32_16x16x32_bf16 v[192:195], a[108:111], a[52:55], v[192:195]
ds_read_b128 a[144:147], v5 offset:37888
v_mfma_f32_16x16x32_bf16 v[192:195], a[104:107], a[48:51], v[192:195]
ds_read_b128 a[148:151], v5 offset:44032
v_mfma_f32_16x16x32_bf16 v[168:171], a[104:107], a[40:43], v[168:171]
ds_read_b64_tr_b16 a[210:211], v248 offset:12800
v_mfma_f32_16x16x32_bf16 v[168:171], a[108:111], a[44:47], v[168:171]
buffer_load_dwordx4 a[8:11], v2, s[40:43], s35 offen offset:1024 sc1
v_mfma_f32_16x16x32_bf16 v[144:147], a[108:111], a[36:39], v[144:147]
ds_read_b128 a[152:155], v6 offset:29696
v_mfma_f32_16x16x32_bf16 v[144:147], a[104:107], a[32:35], v[144:147]
v_mfma_f32_16x16x32_bf16 v[148:151], a[112:115], a[32:35], v[148:151]
v_mfma_f32_16x16x32_bf16 v[148:151], a[116:119], a[36:39], v[148:151]
buffer_load_dwordx4 v[116:119], v1, s[4:7], s88 offen offset:2048 sc1
v_mfma_f32_16x16x32_bf16 v[172:175], a[116:119], a[44:47], v[172:175]
v_mfma_f32_16x16x32_bf16 v[172:175], a[112:115], a[40:43], v[172:175]
v_mfma_f32_16x16x32_bf16 v[196:199], a[112:115], a[48:51], v[196:199]
v_mfma_f32_16x16x32_bf16 v[196:199], a[116:119], a[52:55], v[196:199]
buffer_load_dwordx4 a[12:15], v2, s[40:43], s33 offen offset:1024 sc1
v_mfma_f32_16x16x32_bf16 v[220:223], a[116:119], a[60:63], v[220:223]
v_mfma_f32_16x16x32_bf16 v[220:223], a[112:115], a[56:59], v[220:223]
v_mfma_f32_16x16x32_bf16 a[180:183], a[120:123], a[160:163], a[180:183]
s_waitcnt lgkmcnt(0)
s_barrier
v_mfma_f32_16x16x32_bf16 v[224:227], a[128:131], a[56:59], v[224:227]
v_add_u32 v5, 98304, v1
v_add_u32 v6, s55, v5
v_mfma_f32_16x16x32_bf16 v[224:227], a[132:135], a[60:63], v[224:227]
buffer_load_dwordx4 a[16:19], v2, s[40:43], s35 offen offset:2048 sc1
v_mfma_f32_16x16x32_bf16 v[200:203], a[132:135], a[52:55], v[200:203]
ds_read_b128 a[96:99], v5 offset:2048
v_mfma_f32_16x16x32_bf16 v[200:203], a[128:131], a[48:51], v[200:203]
ds_read_b128 a[100:103], v5 offset:8192
v_mfma_f32_16x16x32_bf16 v[176:179], a[128:131], a[40:43], v[176:179]
buffer_load_dwordx4 v[120:123], v1, s[4:7], s88 offen offset:3072 sc1
s_add_u32 s88, s83, 0x200000
v_mfma_f32_16x16x32_bf16 v[176:179], a[132:135], a[44:47], v[176:179]
ds_read_b128 a[104:107], v5 offset:3072
v_mfma_f32_16x16x32_bf16 v[152:155], a[132:135], a[36:39], v[152:155]
ds_read_b128 a[108:111], v5 offset:9216
v_mfma_f32_16x16x32_bf16 v[152:155], a[128:131], a[32:35], v[152:155]
ds_read_b128 v[48:51], v233 offset:0
v_mfma_f32_16x16x32_bf16 v[132:135], a[136:139], a[32:35], v[132:135]
buffer_load_dwordx4 a[20:23], v2, s[40:43], s33 offen offset:2048 sc1
v_mfma_f32_16x16x32_bf16 v[132:135], a[140:143], a[36:39], v[132:135]
ds_read_b128 a[112:115], v5 offset:4096
v_mfma_f32_16x16x32_bf16 v[156:159], a[140:143], a[44:47], v[156:159]
ds_read_b128 v[52:55], v233 offset:64
v_mfma_f32_16x16x32_bf16 v[156:159], a[136:139], a[40:43], v[156:159]
buffer_load_dwordx4 v[124:127], v1, s[4:7], s88 offen offset:0 sc1
v_mfma_f32_16x16x32_bf16 v[180:183], a[136:139], a[48:51], v[180:183]
ds_read_b128 a[116:119], v5 offset:10240
v_mfma_f32_16x16x32_bf16 v[180:183], a[140:143], a[52:55], v[180:183]
ds_read_b128 a[120:123], v6 offset:2048
v_mfma_f32_16x16x32_bf16 v[204:207], a[140:143], a[60:63], v[204:207]
v_mfma_f32_16x16x32_bf16 v[204:207], a[136:139], a[56:59], v[204:207]
buffer_load_dwordx4 a[24:27], v2, s[40:43], s35 offen offset:3072 sc1
v_mfma_f32_16x16x32_bf16 v[208:211], a[144:147], a[56:59], v[208:211]
v_mfma_f32_16x16x32_bf16 v[208:211], a[148:151], a[60:63], v[208:211]
v_mfma_f32_16x16x32_bf16 v[184:187], a[148:151], a[52:55], v[184:187]
buffer_load_dwordx4 v[128:131], v1, s[4:7], s88 offen offset:1024 sc1
s_add_u32 m0, s18, 0x0
v_mfma_f32_16x16x32_bf16 v[184:187], a[144:147], a[48:51], v[184:187]
s_add_u32 s44, s50, 0xe24000
ds_read_b128 v[56:59], v233 offset:128
v_mfma_f32_16x16x32_bf16 v[160:163], a[144:147], a[40:43], v[160:163]
v_mfma_f32_16x16x32_bf16 v[160:163], a[148:151], a[44:47], v[160:163]
v_mfma_f32_16x16x32_bf16 v[136:139], a[148:151], a[36:39], v[136:139]
buffer_load_dwordx4 a[28:31], v2, s[40:43], s33 offen offset:3072 sc1
s_add_u32 s35, s35, 8192
v_mfma_f32_16x16x32_bf16 v[136:139], a[144:147], a[32:35], v[136:139]
s_add_u32 s33, s33, 8192
v_mfma_f32_16x16x32_bf16 a[184:187], a[152:155], a[160:163], a[184:187]
s_waitcnt vmcnt(13) lgkmcnt(1)
v_mfma_f32_16x16x32_bf16 v[140:143], a[96:99], a[64:67], v[140:143]
ds_read_b128 a[128:131], v5 offset:5120
v_mfma_f32_16x16x32_bf16 v[140:143], a[100:103], a[68:71], v[140:143]
buffer_load_dwordx4 a[32:35], v2, s[40:43], s35 offen offset:0 sc1
v_mfma_f32_16x16x32_bf16 v[164:167], a[100:103], a[76:79], v[164:167]
ds_read_b128 a[132:135], v5 offset:11264
v_mfma_f32_16x16x32_bf16 v[164:167], a[96:99], a[72:75], v[164:167]
v_mfma_f32_16x16x32_bf16 v[236:239], a[188:191], v[16:19], 0
v_mfma_f32_16x16x32_bf16 v[188:191], a[96:99], a[80:83], v[188:191]
ds_read_b128 a[136:139], v5 offset:0
v_mfma_f32_16x16x32_bf16 v[188:191], a[100:103], a[84:87], v[188:191]
buffer_load_dwordx4 v1, s[4:7], s44 offen offset:0 sc1 lds
s_add_u32 s63, s28, 20
v_mfma_f32_16x16x32_bf16 v[212:215], a[100:103], a[92:95], v[212:215]
s_lshl_b32 s63, s63, 12
ds_read_b128 a[140:143], v5 offset:6144
v_mfma_f32_16x16x32_bf16 v[212:215], a[96:99], a[88:91], v[212:215]
v_mfma_f32_16x16x32_bf16 v[240:243], a[196:199], v[16:19], 0
v_mfma_f32_16x16x32_bf16 v[216:219], a[104:107], a[88:91], v[216:219]
v_mfma_f32_16x16x32_bf16 v[244:247], a[204:207], v[16:19], 0
v_mfma_f32_16x16x32_bf16 v[216:219], a[108:111], a[92:95], v[216:219]
buffer_load_dwordx4 a[36:39], v2, s[40:43], s33 offen offset:0 sc1
v_mfma_f32_16x16x32_bf16 v[192:195], a[108:111], a[84:87], v[192:195]
ds_read_b128 a[144:147], v5 offset:1024
v_mfma_f32_16x16x32_bf16 v[192:195], a[104:107], a[80:83], v[192:195]
ds_read_b128 a[148:151], v5 offset:7168
v_mfma_f32_16x16x32_bf16 v[168:171], a[104:107], a[72:75], v[168:171]
v_mfma_f32_16x16x32_bf16 v[236:239], a[192:195], v[16:19], v[236:239]
v_mfma_f32_16x16x32_bf16 v[168:171], a[108:111], a[76:79], v[168:171]
buffer_load_dwordx4 a[40:43], v2, s[40:43], s35 offen offset:1024 sc1
v_mfma_f32_16x16x32_bf16 v[144:147], a[108:111], a[68:71], v[144:147]
ds_read_b128 a[152:155], v6 offset:3072
v_mfma_f32_16x16x32_bf16 v[144:147], a[104:107], a[64:67], v[144:147]
ds_read_b128 v[60:63], v233 offset:192
v_mfma_f32_16x16x32_bf16 v[148:151], a[112:115], a[64:67], v[148:151]
v_mfma_f32_16x16x32_bf16 v[240:243], a[200:203], v[16:19], v[240:243]
v_mfma_f32_16x16x32_bf16 v[148:151], a[116:119], a[68:71], v[148:151]
buffer_load_dwordx4 a[168:171], v3, s[40:43], s63 offen sc1
v_mfma_f32_16x16x32_bf16 v[172:175], a[116:119], a[76:79], v[172:175]
ds_read_b128 v[64:67], v233 offset:256
v_mfma_f32_16x16x32_bf16 v[172:175], a[112:115], a[72:75], v[172:175]
v_mfma_f32_16x16x32_bf16 v[196:199], a[112:115], a[80:83], v[196:199]
v_mfma_f32_16x16x32_bf16 v[244:247], a[208:211], v[16:19], v[244:247]
v_mfma_f32_16x16x32_bf16 v[196:199], a[116:119], a[84:87], v[196:199]
buffer_load_dwordx4 a[44:47], v2, s[40:43], s33 offen offset:1024 sc1
v_mfma_f32_16x16x32_bf16 v[220:223], a[116:119], a[92:95], v[220:223]
ds_read_b128 v[68:71], v233 offset:320
v_mfma_f32_16x16x32_bf16 v[220:223], a[112:115], a[88:91], v[220:223]
v_mfma_f32_16x16x32_bf16 a[172:175], a[120:123], a[164:167], a[172:175]
s_waitcnt lgkmcnt(3)
v_mfma_f32_16x16x32_bf16 v[224:227], a[128:131], a[88:91], v[224:227]
ds_read_b128 a[96:99], v5 offset:14336
v_mfma_f32_16x16x32_bf16 v[224:227], a[132:135], a[92:95], v[224:227]
buffer_load_dwordx4 a[48:51], v2, s[40:43], s35 offen offset:2048 sc1
v_mfma_f32_16x16x32_bf16 v[200:203], a[132:135], a[84:87], v[200:203]
ds_read_b128 a[100:103], v5 offset:20480
v_mfma_f32_16x16x32_bf16 v[200:203], a[128:131], a[80:83], v[200:203]
v_mfma_f32_16x16x32_bf16 v[176:179], a[128:131], a[72:75], v[176:179]
buffer_load_dwordx4 v1, s[4:7], s44 offen offset:1024 sc1 lds
v_mfma_f32_16x16x32_bf16 v[176:179], a[132:135], a[76:79], v[176:179]
ds_read_b128 a[104:107], v5 offset:15360
v_mfma_f32_16x16x32_bf16 v[152:155], a[132:135], a[68:71], v[152:155]
ds_read_b128 a[108:111], v5 offset:21504
v_mfma_f32_16x16x32_bf16 v[152:155], a[128:131], a[64:67], v[152:155]
ds_read_b128 v[72:75], v232 offset:128
v_mfma_f32_16x16x32_bf16 v[132:135], a[136:139], a[64:67], v[132:135]
buffer_load_dwordx4 a[52:55], v2, s[40:43], s33 offen offset:2048 sc1
v_mfma_f32_16x16x32_bf16 v[132:135], a[140:143], a[68:71], v[132:135]
ds_read_b128 a[112:115], v5 offset:16384
v_mfma_f32_16x16x32_bf16 v[156:159], a[140:143], a[76:79], v[156:159]
v_mfma_f32_16x16x32_bf16 v[156:159], a[136:139], a[72:75], v[156:159]
buffer_load_dwordx4 v1, s[4:7], s44 offen offset:2048 sc1 lds
s_add_u32 m0, s18, 0x3000
v_mfma_f32_16x16x32_bf16 v[180:183], a[136:139], a[80:83], v[180:183]
s_add_u32 s44, s50, 0xe27000
ds_read_b128 a[116:119], v5 offset:22528
v_mfma_f32_16x16x32_bf16 v[180:183], a[140:143], a[84:87], v[180:183]
ds_read_b128 a[120:123], v6 offset:4096
v_mfma_f32_16x16x32_bf16 v[204:207], a[140:143], a[92:95], v[204:207]
v_mfma_f32_16x16x32_bf16 v[204:207], a[136:139], a[88:91], v[204:207]
buffer_load_dwordx4 a[56:59], v2, s[40:43], s35 offen offset:3072 sc1
v_mfma_f32_16x16x32_bf16 v[208:211], a[144:147], a[88:91], v[208:211]
v_mfma_f32_16x16x32_bf16 v[208:211], a[148:151], a[92:95], v[208:211]
v_mfma_f32_16x16x32_bf16 v[184:187], a[148:151], a[84:87], v[184:187]
buffer_load_dwordx4 v1, s[4:7], s44 offen offset:0 sc1 lds
v_mfma_f32_16x16x32_bf16 v[184:187], a[144:147], a[80:83], v[184:187]
v_mfma_f32_16x16x32_bf16 v[160:163], a[144:147], a[72:75], v[160:163]
v_mfma_f32_16x16x32_bf16 v[160:163], a[148:151], a[76:79], v[160:163]
v_mfma_f32_16x16x32_bf16 v[136:139], a[148:151], a[68:71], v[136:139]
buffer_load_dwordx4 a[60:63], v2, s[40:43], s33 offen offset:3072 sc1
s_add_u32 s35, s35, 8192
v_mfma_f32_16x16x32_bf16 v[136:139], a[144:147], a[64:67], v[136:139]
s_add_u32 s33, s33, 8192
v_mfma_f32_16x16x32_bf16 a[176:179], a[152:155], a[164:167], a[176:179]
s_waitcnt vmcnt(13) lgkmcnt(0)
v_mfma_f32_16x16x32_bf16 v[140:143], a[96:99], a[0:3], v[140:143]
ds_read_b128 a[128:131], v5 offset:17408
v_mfma_f32_16x16x32_bf16 v[140:143], a[100:103], a[4:7], v[140:143]
buffer_load_dwordx4 a[64:67], v2, s[40:43], s35 offen offset:0 sc1
v_mfma_f32_16x16x32_bf16 v[164:167], a[100:103], a[12:15], v[164:167]
ds_read_b128 a[132:135], v5 offset:23552
v_mfma_f32_16x16x32_bf16 v[164:167], a[96:99], a[8:11], v[164:167]
v_mfma_f32_16x16x32_bf16 v[188:191], a[96:99], a[16:19], v[188:191]
ds_read_b128 a[136:139], v5 offset:12288
v_mfma_f32_16x16x32_bf16 v[188:191], a[100:103], a[20:23], v[188:191]
buffer_load_dwordx4 v1, s[4:7], s44 offen offset:1024 sc1 lds
v_mfma_f32_16x16x32_bf16 v[212:215], a[100:103], a[28:31], v[212:215]
ds_read_b128 a[140:143], v5 offset:18432
v_mfma_f32_16x16x32_bf16 v[212:215], a[96:99], a[24:27], v[212:215]
v_mfma_f32_16x16x32_bf16 v[216:219], a[104:107], a[24:27], v[216:219]
v_mfma_f32_16x16x32_bf16 v[216:219], a[108:111], a[28:31], v[216:219]
buffer_load_dwordx4 a[68:71], v2, s[40:43], s33 offen offset:0 sc1
v_mfma_f32_16x16x32_bf16 v[192:195], a[108:111], a[20:23], v[192:195]
ds_read_b128 a[144:147], v5 offset:13312
v_mfma_f32_16x16x32_bf16 v[192:195], a[104:107], a[16:19], v[192:195]
ds_read_b128 a[148:151], v5 offset:19456
v_mfma_f32_16x16x32_bf16 v[168:171], a[104:107], a[8:11], v[168:171]
v_mfma_f32_16x16x32_bf16 v[168:171], a[108:111], a[12:15], v[168:171]
buffer_load_dwordx4 a[72:75], v2, s[40:43], s35 offen offset:1024 sc1
v_mfma_f32_16x16x32_bf16 v[144:147], a[108:111], a[4:7], v[144:147]
ds_read_b128 a[152:155], v6 offset:5120
v_mfma_f32_16x16x32_bf16 v[144:147], a[104:107], a[0:3], v[144:147]
v_mfma_f32_16x16x32_bf16 v[148:151], a[112:115], a[0:3], v[148:151]
v_mfma_f32_16x16x32_bf16 v[148:151], a[116:119], a[4:7], v[148:151]
buffer_load_dwordx4 v1, s[4:7], s44 offen offset:2048 sc1 lds
s_add_u32 m0, s18, 0x6000
v_mfma_f32_16x16x32_bf16 v[172:175], a[116:119], a[12:15], v[172:175]
s_add_u32 s44, s50, 0xe2a000
v_mfma_f32_16x16x32_bf16 v[172:175], a[112:115], a[8:11], v[172:175]
v_mfma_f32_16x16x32_bf16 v[196:199], a[112:115], a[16:19], v[196:199]
v_mfma_f32_16x16x32_bf16 v[196:199], a[116:119], a[20:23], v[196:199]
buffer_load_dwordx4 a[76:79], v2, s[40:43], s33 offen offset:1024 sc1
v_mfma_f32_16x16x32_bf16 v[220:223], a[116:119], a[28:31], v[220:223]
v_mfma_f32_16x16x32_bf16 v[220:223], a[112:115], a[24:27], v[220:223]
v_mfma_f32_16x16x32_bf16 a[180:183], a[120:123], a[164:167], a[180:183]
s_waitcnt lgkmcnt(0)
s_barrier
v_mfma_f32_16x16x32_bf16 v[224:227], a[128:131], a[24:27], v[224:227]
ds_read_b128 a[96:99], v5 offset:26624
v_mfma_f32_16x16x32_bf16 v[224:227], a[132:135], a[28:31], v[224:227]
buffer_load_dwordx4 a[80:83], v2, s[40:43], s35 offen offset:2048 sc1
v_mfma_f32_16x16x32_bf16 v[200:203], a[132:135], a[20:23], v[200:203]
ds_read_b128 a[100:103], v5 offset:32768
v_mfma_f32_16x16x32_bf16 v[200:203], a[128:131], a[16:19], v[200:203]
v_mfma_f32_16x16x32_bf16 v[176:179], a[128:131], a[8:11], v[176:179]
buffer_load_dwordx4 v1, s[4:7], s44 offen offset:0 sc1 lds
v_mfma_f32_16x16x32_bf16 v[176:179], a[132:135], a[12:15], v[176:179]
ds_read_b128 a[104:107], v5 offset:27648
v_mfma_f32_16x16x32_bf16 v[152:155], a[132:135], a[4:7], v[152:155]
ds_read_b128 a[108:111], v5 offset:33792
v_mfma_f32_16x16x32_bf16 v[152:155], a[128:131], a[0:3], v[152:155]
v_mfma_f32_16x16x32_bf16 v[132:135], a[136:139], a[0:3], v[132:135]
buffer_load_dwordx4 a[84:87], v2, s[40:43], s33 offen offset:2048 sc1
v_mfma_f32_16x16x32_bf16 v[132:135], a[140:143], a[4:7], v[132:135]
ds_read_b128 a[112:115], v5 offset:28672
v_mfma_f32_16x16x32_bf16 v[156:159], a[140:143], a[12:15], v[156:159]
v_mfma_f32_16x16x32_bf16 v[156:159], a[136:139], a[8:11], v[156:159]
buffer_load_dwordx4 v1, s[4:7], s44 offen offset:1024 sc1 lds
v_mfma_f32_16x16x32_bf16 v[180:183], a[136:139], a[16:19], v[180:183]
ds_read_b128 a[116:119], v5 offset:34816
v_mfma_f32_16x16x32_bf16 v[180:183], a[140:143], a[20:23], v[180:183]
ds_read_b128 a[120:123], v6 offset:26624
v_mfma_f32_16x16x32_bf16 v[204:207], a[140:143], a[28:31], v[204:207]
v_mfma_f32_16x16x32_bf16 v[204:207], a[136:139], a[24:27], v[204:207]
buffer_load_dwordx4 a[88:91], v2, s[40:43], s35 offen offset:3072 sc1
v_mfma_f32_16x16x32_bf16 v[208:211], a[144:147], a[24:27], v[208:211]
v_mfma_f32_16x16x32_bf16 v[208:211], a[148:151], a[28:31], v[208:211]
v_mfma_f32_16x16x32_bf16 v[184:187], a[148:151], a[20:23], v[184:187]
buffer_load_dwordx4 v1, s[4:7], s44 offen offset:2048 sc1 lds
s_add_u32 m0, s18, 0x9000
v_mfma_f32_16x16x32_bf16 v[184:187], a[144:147], a[16:19], v[184:187]
s_add_u32 s44, s50, 0xe2d000
v_mfma_f32_16x16x32_bf16 v[160:163], a[144:147], a[8:11], v[160:163]
L_stub1:
s_cbranch_execz L_wret0
v_mfma_f32_16x16x32_bf16 v[160:163], a[148:151], a[12:15], v[160:163]
v_mfma_f32_16x16x32_bf16 v[136:139], a[148:151], a[4:7], v[136:139]
buffer_load_dwordx4 a[92:95], v2, s[40:43], s33 offen offset:3072 sc1
s_add_u32 s35, s35, 8192
v_mfma_f32_16x16x32_bf16 v[136:139], a[144:147], a[0:3], v[136:139]
s_add_u32 s33, s33, 8192
v_mfma_f32_16x16x32_bf16 a[184:187], a[152:155], a[164:167], a[184:187]
s_waitcnt vmcnt(13) lgkmcnt(0)
v_mfma_f32_16x16x32_bf16 v[140:143], a[96:99], a[32:35], v[140:143]
ds_read_b128 a[128:131], v5 offset:29696
v_mfma_f32_16x16x32_bf16 v[140:143], a[100:103], a[36:39], v[140:143]
buffer_load_dwordx4 a[0:3], v2, s[40:43], s35 offen offset:0 sc1
v_mfma_f32_16x16x32_bf16 v[164:167], a[100:103], a[44:47], v[164:167]
ds_read_b128 a[132:135], v5 offset:35840
v_mfma_f32_16x16x32_bf16 v[164:167], a[96:99], a[40:43], v[164:167]
v_mfma_f32_16x16x32_bf16 v[188:191], a[96:99], a[48:51], v[188:191]
ds_read_b128 a[136:139], v5 offset:24576
v_mfma_f32_16x16x32_bf16 v[188:191], a[100:103], a[52:55], v[188:191]
buffer_load_dwordx4 v1, s[4:7], s44 offen offset:0 sc1 lds
s_add_u32 s63, s28, 24
v_mfma_f32_16x16x32_bf16 v[212:215], a[100:103], a[60:63], v[212:215]
s_lshl_b32 s63, s63, 12
ds_read_b128 a[140:143], v5 offset:30720
v_mfma_f32_16x16x32_bf16 v[212:215], a[96:99], a[56:59], v[212:215]
v_mfma_f32_16x16x32_bf16 v[216:219], a[104:107], a[56:59], v[216:219]
v_mfma_f32_16x16x32_bf16 v[216:219], a[108:111], a[60:63], v[216:219]
buffer_load_dwordx4 a[4:7], v2, s[40:43], s33 offen offset:0 sc1
v_mfma_f32_16x16x32_bf16 v[192:195], a[108:111], a[52:55], v[192:195]
ds_read_b128 a[144:147], v5 offset:25600
v_mfma_f32_16x16x32_bf16 v[192:195], a[104:107], a[48:51], v[192:195]
ds_read_b128 a[148:151], v5 offset:31744
v_mfma_f32_16x16x32_bf16 v[168:171], a[104:107], a[40:43], v[168:171]
v_mfma_f32_16x16x32_bf16 v[168:171], a[108:111], a[44:47], v[168:171]
buffer_load_dwordx4 a[8:11], v2, s[40:43], s35 offen offset:1024 sc1
v_mfma_f32_16x16x32_bf16 v[144:147], a[108:111], a[36:39], v[144:147]
ds_read_b128 a[152:155], v6 offset:27648
v_mfma_f32_16x16x32_bf16 v[144:147], a[104:107], a[32:35], v[144:147]
v_mfma_f32_16x16x32_bf16 v[148:151], a[112:115], a[32:35], v[148:151]
v_mfma_f32_16x16x32_bf16 v[148:151], a[116:119], a[36:39], v[148:151]
buffer_load_dwordx4 a[160:163], v3, s[40:43], s63 offen sc1
v_mfma_f32_16x16x32_bf16 v[172:175], a[116:119], a[44:47], v[172:175]
v_mfma_f32_16x16x32_bf16 v[172:175], a[112:115], a[40:43], v[172:175]
v_mfma_f32_16x16x32_bf16 v[196:199], a[112:115], a[48:51], v[196:199]
v_mfma_f32_16x16x32_bf16 v[196:199], a[116:119], a[52:55], v[196:199]
buffer_load_dwordx4 a[12:15], v2, s[40:43], s33 offen offset:1024 sc1
v_mfma_f32_16x16x32_bf16 v[220:223], a[116:119], a[60:63], v[220:223]
v_mfma_f32_16x16x32_bf16 v[220:223], a[112:115], a[56:59], v[220:223]
v_mfma_f32_16x16x32_bf16 a[172:175], a[120:123], a[168:171], a[172:175]
s_waitcnt lgkmcnt(0)
v_mfma_f32_16x16x32_bf16 v[224:227], a[128:131], a[56:59], v[224:227]
ds_read_b128 a[96:99], v5 offset:38912
v_mfma_f32_16x16x32_bf16 v[224:227], a[132:135], a[60:63], v[224:227]
buffer_load_dwordx4 a[16:19], v2, s[40:43], s35 offen offset:2048 sc1
v_mfma_f32_16x16x32_bf16 v[200:203], a[132:135], a[52:55], v[200:203]
ds_read_b128 a[100:103], v5 offset:45056
v_mfma_f32_16x16x32_bf16 v[200:203], a[128:131], a[48:51], v[200:203]
v_mfma_f32_16x16x32_bf16 v[176:179], a[128:131], a[40:43], v[176:179]
buffer_load_dwordx4 v1, s[4:7], s44 offen offset:1024 sc1 lds
v_mfma_f32_16x16x32_bf16 v[176:179], a[132:135], a[44:47], v[176:179]
ds_read_b128 a[104:107], v5 offset:39936
v_mfma_f32_16x16x32_bf16 v[152:155], a[132:135], a[36:39], v[152:155]
ds_read_b128 a[108:111], v5 offset:46080
v_mfma_f32_16x16x32_bf16 v[152:155], a[128:131], a[32:35], v[152:155]
v_mfma_f32_16x16x32_bf16 v[132:135], a[136:139], a[32:35], v[132:135]
buffer_load_dwordx4 a[20:23], v2, s[40:43], s33 offen offset:2048 sc1
v_mfma_f32_16x16x32_bf16 v[132:135], a[140:143], a[36:39], v[132:135]
ds_read_b128 a[112:115], v5 offset:40960
v_mfma_f32_16x16x32_bf16 v[156:159], a[140:143], a[44:47], v[156:159]
v_mfma_f32_16x16x32_bf16 v[156:159], a[136:139], a[40:43], v[156:159]
buffer_load_dwordx4 v1, s[4:7], s44 offen offset:2048 sc1 lds
s_add_u32 s63, s28, 28
v_mfma_f32_16x16x32_bf16 v[180:183], a[136:139], a[48:51], v[180:183]
s_lshl_b32 s63, s63, 12
ds_read_b128 a[116:119], v5 offset:47104
v_mfma_f32_16x16x32_bf16 v[180:183], a[140:143], a[52:55], v[180:183]
ds_read_b128 a[120:123], v6 offset:28672
v_mfma_f32_16x16x32_bf16 v[204:207], a[140:143], a[60:63], v[204:207]
v_mfma_f32_16x16x32_bf16 v[204:207], a[136:139], a[56:59], v[204:207]
buffer_load_dwordx4 a[24:27], v2, s[40:43], s35 offen offset:3072 sc1
v_mfma_f32_16x16x32_bf16 v[208:211], a[144:147], a[56:59], v[208:211]
v_mfma_f32_16x16x32_bf16 v[208:211], a[148:151], a[60:63], v[208:211]
v_mfma_f32_16x16x32_bf16 v[184:187], a[148:151], a[52:55], v[184:187]
buffer_load_dwordx4 a[164:167], v3, s[40:43], s63 offen sc1
s_add_u32 m0, s19, 49152
v_mfma_f32_16x16x32_bf16 v[184:187], a[144:147], a[48:51], v[184:187]
s_add_u32 s44, s85, 0xa04000
v_mfma_f32_16x16x32_bf16 v[160:163], a[144:147], a[40:43], v[160:163]
v_mfma_f32_16x16x32_bf16 v[160:163], a[148:151], a[44:47], v[160:163]
v_mfma_f32_16x16x32_bf16 v[136:139], a[148:151], a[36:39], v[136:139]
buffer_load_dwordx4 a[28:31], v2, s[40:43], s33 offen offset:3072 sc1
s_add_u32 s35, s35, 8192
v_mfma_f32_16x16x32_bf16 v[136:139], a[144:147], a[32:35], v[136:139]
s_add_u32 s33, s33, 8192
v_mfma_f32_16x16x32_bf16 a[176:179], a[152:155], a[168:171], a[176:179]
s_waitcnt vmcnt(13) lgkmcnt(0)
v_mfma_f32_16x16x32_bf16 v[140:143], a[96:99], a[64:67], v[140:143]
ds_read_b128 a[128:131], v5 offset:41984
v_add_f32 v92, v92, v96
v_mfma_f32_16x16x32_bf16 v[140:143], a[100:103], a[68:71], v[140:143]
buffer_load_dwordx4 a[32:35], v2, s[40:43], s35 offen offset:0 sc1
v_mfma_f32_16x16x32_bf16 v[164:167], a[100:103], a[76:79], v[164:167]
ds_read_b128 a[132:135], v5 offset:48128
v_add_f32 v100, v100, v104
v_mfma_f32_16x16x32_bf16 v[164:167], a[96:99], a[72:75], v[164:167]
v_add_f32 v108, v108, v112
v_add_f32 v116, v116, v120
v_mfma_f32_16x16x32_bf16 v[188:191], a[96:99], a[80:83], v[188:191]
ds_read_b128 a[136:139], v5 offset:36864
v_add_f32 v124, v124, v128
v_mfma_f32_16x16x32_bf16 v[188:191], a[100:103], a[84:87], v[188:191]
buffer_load_dwordx4 v1, s[4:7], s44 offen offset:0 sc1 lds
v_mfma_f32_16x16x32_bf16 v[212:215], a[100:103], a[92:95], v[212:215]
ds_read_b128 a[140:143], v5 offset:43008
v_add_f32 v93, v93, v97
v_mfma_f32_16x16x32_bf16 v[212:215], a[96:99], a[88:91], v[212:215]
v_add_f32 v101, v101, v105
v_add_f32 v109, v109, v113
v_mfma_f32_16x16x32_bf16 v[216:219], a[104:107], a[88:91], v[216:219]
v_add_f32 v117, v117, v121
v_add_f32 v125, v125, v129
v_mfma_f32_16x16x32_bf16 v[216:219], a[108:111], a[92:95], v[216:219]
buffer_load_dwordx4 a[36:39], v2, s[40:43], s33 offen offset:0 sc1
v_mfma_f32_16x16x32_bf16 v[192:195], a[108:111], a[84:87], v[192:195]
ds_read_b128 a[144:147], v5 offset:37888
v_add_f32 v94, v94, v98
v_mfma_f32_16x16x32_bf16 v[192:195], a[104:107], a[80:83], v[192:195]
ds_read_b128 a[148:151], v5 offset:44032
v_add_f32 v102, v102, v106
v_mfma_f32_16x16x32_bf16 v[168:171], a[104:107], a[72:75], v[168:171]
v_add_f32 v110, v110, v114
v_add_f32 v118, v118, v122
v_mfma_f32_16x16x32_bf16 v[168:171], a[108:111], a[76:79], v[168:171]
buffer_load_dwordx4 a[40:43], v2, s[40:43], s35 offen offset:1024 sc1
v_mfma_f32_16x16x32_bf16 v[144:147], a[108:111], a[68:71], v[144:147]
ds_read_b128 a[152:155], v6 offset:29696
v_add_f32 v126, v126, v130
v_mfma_f32_16x16x32_bf16 v[144:147], a[104:107], a[64:67], v[144:147]
v_add_f32 v95, v95, v99
v_add_f32 v103, v103, v107
v_mfma_f32_16x16x32_bf16 v[148:151], a[112:115], a[64:67], v[148:151]
v_add_f32 v111, v111, v115
v_add_f32 v119, v119, v123
v_mfma_f32_16x16x32_bf16 v[148:151], a[116:119], a[68:71], v[148:151]
buffer_load_dwordx4 v1, s[4:7], s44 offen offset:1024 sc1 lds
v_mfma_f32_16x16x32_bf16 v[172:175], a[116:119], a[76:79], v[172:175]
v_add_f32 v127, v127, v131
v_add_f32_dpp v92, v92, v92 row_ror:8 row_mask:0xf bank_mask:0xf
v_mfma_f32_16x16x32_bf16 v[172:175], a[112:115], a[72:75], v[172:175]
v_add_f32_dpp v100, v100, v100 row_ror:8 row_mask:0xf bank_mask:0xf
v_add_f32_dpp v108, v108, v108 row_ror:8 row_mask:0xf bank_mask:0xf
v_mfma_f32_16x16x32_bf16 v[196:199], a[112:115], a[80:83], v[196:199]
v_add_f32_dpp v116, v116, v116 row_ror:8 row_mask:0xf bank_mask:0xf
v_add_f32_dpp v124, v124, v124 row_ror:8 row_mask:0xf bank_mask:0xf
v_mfma_f32_16x16x32_bf16 v[196:199], a[116:119], a[84:87], v[196:199]
buffer_load_dwordx4 a[44:47], v2, s[40:43], s33 offen offset:1024 sc1
v_mfma_f32_16x16x32_bf16 v[220:223], a[116:119], a[92:95], v[220:223]
v_add_f32_dpp v93, v93, v93 row_ror:8 row_mask:0xf bank_mask:0xf
v_add_f32_dpp v101, v101, v101 row_ror:8 row_mask:0xf bank_mask:0xf
v_mfma_f32_16x16x32_bf16 v[220:223], a[112:115], a[88:91], v[220:223]
v_add_f32_dpp v109, v109, v109 row_ror:8 row_mask:0xf bank_mask:0xf
v_add_f32_dpp v117, v117, v117 row_ror:8 row_mask:0xf bank_mask:0xf
v_mfma_f32_16x16x32_bf16 a[180:183], a[120:123], a[168:171], a[180:183]
s_waitcnt vmcnt(9) lgkmcnt(0)
s_barrier
v_mfma_f32_16x16x32_bf16 v[224:227], a[128:131], a[88:91], v[224:227]
v_add_u32 v5, 0, v1
v_add_u32 v6, s55, v5
v_mfma_f32_16x16x32_bf16 v[224:227], a[132:135], a[92:95], v[224:227]
buffer_load_dwordx4 a[48:51], v2, s[40:43], s35 offen offset:2048 sc1
v_mfma_f32_16x16x32_bf16 v[200:203], a[132:135], a[84:87], v[200:203]
ds_read_b128 a[96:99], v5 offset:2048
v_add_f32_dpp v125, v125, v125 row_ror:8 row_mask:0xf bank_mask:0xf
v_mfma_f32_16x16x32_bf16 v[200:203], a[128:131], a[80:83], v[200:203]
ds_read_b128 a[100:103], v5 offset:8192
v_add_f32_dpp v92, v94, v94 row_ror:8 row_mask:0xf bank_mask:0xc
v_mfma_f32_16x16x32_bf16 v[176:179], a[128:131], a[72:75], v[176:179]
buffer_load_dwordx4 v1, s[4:7], s44 offen offset:2048 sc1 lds
v_mfma_f32_16x16x32_bf16 v[176:179], a[132:135], a[76:79], v[176:179]
ds_read_b128 a[104:107], v5 offset:3072
v_add_f32_dpp v100, v102, v102 row_ror:8 row_mask:0xf bank_mask:0xc
v_mfma_f32_16x16x32_bf16 v[152:155], a[132:135], a[68:71], v[152:155]
ds_read_b128 a[108:111], v5 offset:9216
v_add_f32_dpp v108, v110, v110 row_ror:8 row_mask:0xf bank_mask:0xc
v_mfma_f32_16x16x32_bf16 v[152:155], a[128:131], a[64:67], v[152:155]
v_add_f32_dpp v116, v118, v118 row_ror:8 row_mask:0xf bank_mask:0xc
v_add_f32_dpp v124, v126, v126 row_ror:8 row_mask:0xf bank_mask:0xc
v_mfma_f32_16x16x32_bf16 v[132:135], a[136:139], a[64:67], v[132:135]
buffer_load_dwordx4 a[52:55], v2, s[40:43], s33 offen offset:2048 sc1
v_mfma_f32_16x16x32_bf16 v[132:135], a[140:143], a[68:71], v[132:135]
ds_read_b128 a[112:115], v5 offset:4096
v_add_f32_dpp v93, v95, v95 row_ror:8 row_mask:0xf bank_mask:0xc
v_mfma_f32_16x16x32_bf16 v[156:159], a[140:143], a[76:79], v[156:159]
ds_read_b128 a[116:119], v5 offset:10240
v_add_f32_dpp v101, v103, v103 row_ror:8 row_mask:0xf bank_mask:0xc
v_mfma_f32_16x16x32_bf16 v[156:159], a[136:139], a[72:75], v[156:159]
buffer_load_dwordx4 v1, s[4:7], s44 offen offset:3072 sc1 lds
s_add_u32 m0, s19, 65536
v_mfma_f32_16x16x32_bf16 v[180:183], a[136:139], a[80:83], v[180:183]
s_add_u32 s44, s84, 0xa08000
ds_read_b128 a[120:123], v6 offset:2048
v_mfma_f32_16x16x32_bf16 v[180:183], a[140:143], a[84:87], v[180:183]
v_add_f32_dpp v109, v111, v111 row_ror:8 row_mask:0xf bank_mask:0xc
v_add_f32_dpp v117, v119, v119 row_ror:8 row_mask:0xf bank_mask:0xc
v_mfma_f32_16x16x32_bf16 v[204:207], a[140:143], a[92:95], v[204:207]
ds_read_b128 a[124:127], v6 offset:26624
v_add_f32_dpp v125, v127, v127 row_ror:8 row_mask:0xf bank_mask:0xc
v_mfma_f32_16x16x32_bf16 v[204:207], a[136:139], a[88:91], v[204:207]
buffer_load_dwordx4 a[56:59], v2, s[40:43], s35 offen offset:3072 sc1
v_mfma_f32_16x16x32_bf16 v[208:211], a[144:147], a[88:91], v[208:211]
v_permlane32_swap_b32 v92, v93
v_mfma_f32_16x16x32_bf16 v[208:211], a[148:151], a[92:95], v[208:211]
v_permlane32_swap_b32 v100, v101
v_mfma_f32_16x16x32_bf16 v[184:187], a[148:151], a[84:87], v[184:187]
buffer_load_dwordx4 v1, s[4:7], s44 offen offset:0 sc1 lds
v_mfma_f32_16x16x32_bf16 v[184:187], a[144:147], a[80:83], v[184:187]
v_permlane32_swap_b32 v108, v109
v_mfma_f32_16x16x32_bf16 v[160:163], a[144:147], a[72:75], v[160:163]
v_permlane32_swap_b32 v116, v117
v_mfma_f32_16x16x32_bf16 v[160:163], a[148:151], a[76:79], v[160:163]
v_permlane32_swap_b32 v124, v125
v_mfma_f32_16x16x32_bf16 v[136:139], a[148:151], a[68:71], v[136:139]
buffer_load_dwordx4 a[60:63], v2, s[40:43], s33 offen offset:3072 sc1
s_add_u32 s35, s35, 8192
v_mfma_f32_16x16x32_bf16 v[136:139], a[144:147], a[64:67], v[136:139]
s_add_u32 s33, s33, 8192
v_add_f32 v92, v92, v93
v_mfma_f32_16x16x32_bf16 a[184:187], a[152:155], a[168:171], a[184:187]
v_add_f32 v100, v100, v101
s_waitcnt vmcnt(13) lgkmcnt(0)
v_mfma_f32_16x16x32_bf16 v[140:143], a[96:99], a[0:3], v[140:143]
ds_read_b128 a[128:131], v5 offset:5120
v_add_f32 v108, v108, v109
v_mfma_f32_16x16x32_bf16 v[140:143], a[100:103], a[4:7], v[140:143]
buffer_load_dwordx4 a[64:67], v2, s[40:43], s35 offen offset:0 sc1
v_mfma_f32_16x16x32_bf16 v[164:167], a[100:103], a[12:15], v[164:167]
ds_read_b128 a[132:135], v5 offset:11264
v_add_f32 v116, v116, v117
v_mfma_f32_16x16x32_bf16 v[164:167], a[96:99], a[8:11], v[164:167]
v_add_f32 v124, v124, v125
v_mov_b32 v94, v92
v_mfma_f32_16x16x32_bf16 v[188:191], a[96:99], a[16:19], v[188:191]
buffer_load_dwordx4 v1, s[4:7], s44 offen offset:1024 sc1 lds
v_mfma_f32_16x16x32_bf16 v[188:191], a[100:103], a[20:23], v[188:191]
ds_read_b128 a[136:139], v5 offset:0
v_mov_b32 v102, v100
v_mfma_f32_16x16x32_bf16 v[212:215], a[100:103], a[28:31], v[212:215]
ds_read_b128 a[140:143], v5 offset:6144
v_mov_b32 v110, v108
v_mfma_f32_16x16x32_bf16 v[212:215], a[96:99], a[24:27], v[212:215]
v_mov_b32 v118, v116
v_mov_b32 v126, v124
v_mfma_f32_16x16x32_bf16 v[216:219], a[104:107], a[24:27], v[216:219]
buffer_load_dwordx4 a[68:71], v2, s[40:43], s33 offen offset:0 sc1
v_mfma_f32_16x16x32_bf16 v[216:219], a[108:111], a[28:31], v[216:219]
ds_read_b128 a[144:147], v5 offset:1024
v_mfma_f32_16x16x32_bf16 v[192:195], a[108:111], a[20:23], v[192:195]
ds_read_b128 a[148:151], v5 offset:7168
v_mfma_f32_16x16x32_bf16 v[192:195], a[104:107], a[16:19], v[192:195]
v_permlane16_swap_b32 v92, v94
v_mfma_f32_16x16x32_bf16 v[168:171], a[104:107], a[8:11], v[168:171]
buffer_load_dwordx4 v1, s[4:7], s44 offen offset:2048 sc1 lds
v_mfma_f32_16x16x32_bf16 v[168:171], a[108:111], a[12:15], v[168:171]
ds_read_b128 a[152:155], v6 offset:3072
v_mfma_f32_16x16x32_bf16 v[144:147], a[108:111], a[4:7], v[144:147]
ds_read_b128 a[156:159], v6 offset:27648
v_mfma_f32_16x16x32_bf16 v[144:147], a[104:107], a[0:3], v[144:147]
buffer_load_dwordx4 a[72:75], v2, s[40:43], s35 offen offset:1024 sc1
v_mfma_f32_16x16x32_bf16 v[148:151], a[112:115], a[0:3], v[148:151]
v_permlane16_swap_b32 v100, v102
v_mfma_f32_16x16x32_bf16 v[148:151], a[116:119], a[4:7], v[148:151]
v_permlane16_swap_b32 v108, v110
v_mfma_f32_16x16x32_bf16 v[172:175], a[116:119], a[12:15], v[172:175]
v_permlane16_swap_b32 v116, v118
v_mfma_f32_16x16x32_bf16 v[172:175], a[112:115], a[8:11], v[172:175]
buffer_load_dwordx4 v1, s[4:7], s44 offen offset:3072 sc1 lds
s_add_u32 m0, s19, 81920
v_mfma_f32_16x16x32_bf16 v[196:199], a[112:115], a[16:19], v[196:199]
s_add_u32 s44, s85, 0xa0c000
v_mfma_f32_16x16x32_bf16 v[196:199], a[116:119], a[20:23], v[196:199]
v_permlane16_swap_b32 v124, v126
v_mfma_f32_16x16x32_bf16 v[220:223], a[116:119], a[28:31], v[220:223]
v_add_f32 v92, v92, v94
v_add_f32 v100, v100, v102
v_mfma_f32_16x16x32_bf16 v[220:223], a[112:115], a[24:27], v[220:223]
buffer_load_dwordx4 a[76:79], v2, s[40:43], s33 offen offset:1024 sc1
v_mfma_f32_16x16x32_bf16 a[172:175], a[120:123], a[160:163], a[172:175]
v_add_f32 v108, v108, v110
v_add_f32 v116, v116, v118
v_mfma_f32_16x16x32_bf16 a[172:175], a[124:127], a[164:167], a[172:175]
v_add_f32 v124, v124, v126
s_waitcnt lgkmcnt(0)
v_mfma_f32_16x16x32_bf16 v[224:227], a[128:131], a[24:27], v[224:227]
ds_read_b128 a[96:99], v5 offset:14336
v_mov_b32 v94, v92
v_mfma_f32_16x16x32_bf16 v[224:227], a[132:135], a[28:31], v[224:227]
buffer_load_dwordx4 a[80:83], v2, s[40:43], s35 offen offset:2048 sc1
v_mfma_f32_16x16x32_bf16 v[200:203], a[132:135], a[20:23], v[200:203]
ds_read_b128 a[100:103], v5 offset:20480
v_mov_b32 v102, v100
v_mfma_f32_16x16x32_bf16 v[200:203], a[128:131], a[16:19], v[200:203]
v_mov_b32 v110, v108
v_mov_b32 v118, v116
v_mfma_f32_16x16x32_bf16 v[176:179], a[128:131], a[8:11], v[176:179]
buffer_load_dwordx4 v1, s[4:7], s44 offen offset:0 sc1 lds
v_mfma_f32_16x16x32_bf16 v[176:179], a[132:135], a[12:15], v[176:179]
ds_read_b128 a[104:107], v5 offset:15360
v_mov_b32 v126, v124
v_mfma_f32_16x16x32_bf16 v[152:155], a[132:135], a[4:7], v[152:155]
ds_read_b128 a[108:111], v5 offset:21504
v_mfma_f32_16x16x32_bf16 v[152:155], a[128:131], a[0:3], v[152:155]
v_permlane32_swap_b32 v92, v94
v_mfma_f32_16x16x32_bf16 v[132:135], a[136:139], a[0:3], v[132:135]
buffer_load_dwordx4 a[84:87], v2, s[40:43], s33 offen offset:2048 sc1
v_mfma_f32_16x16x32_bf16 v[132:135], a[140:143], a[4:7], v[132:135]
ds_read_b128 a[112:115], v5 offset:16384
v_mfma_f32_16x16x32_bf16 v[156:159], a[140:143], a[12:15], v[156:159]
ds_read_b128 a[116:119], v5 offset:22528
v_mfma_f32_16x16x32_bf16 v[156:159], a[136:139], a[8:11], v[156:159]
v_permlane32_swap_b32 v100, v102
v_mfma_f32_16x16x32_bf16 v[180:183], a[136:139], a[16:19], v[180:183]
buffer_load_dwordx4 v1, s[4:7], s44 offen offset:1024 sc1 lds
v_mfma_f32_16x16x32_bf16 v[180:183], a[140:143], a[20:23], v[180:183]
ds_read_b128 a[120:123], v6 offset:4096
v_mfma_f32_16x16x32_bf16 v[204:207], a[140:143], a[28:31], v[204:207]
ds_read_b128 a[124:127], v6 offset:28672
v_mfma_f32_16x16x32_bf16 v[204:207], a[136:139], a[24:27], v[204:207]
buffer_load_dwordx4 a[88:91], v2, s[40:43], s35 offen offset:3072 sc1
v_mfma_f32_16x16x32_bf16 v[208:211], a[144:147], a[24:27], v[208:211]
v_permlane32_swap_b32 v108, v110
v_mfma_f32_16x16x32_bf16 v[208:211], a[148:151], a[28:31], v[208:211]
v_permlane32_swap_b32 v116, v118
v_mfma_f32_16x16x32_bf16 v[184:187], a[148:151], a[20:23], v[184:187]
v_permlane32_swap_b32 v124, v126
v_mfma_f32_16x16x32_bf16 v[184:187], a[144:147], a[16:19], v[184:187]
buffer_load_dwordx4 v1, s[4:7], s44 offen offset:2048 sc1 lds
v_mfma_f32_16x16x32_bf16 v[160:163], a[144:147], a[8:11], v[160:163]
v_mul_f32 v82, 0xba800000, v92
v_mul_f32 v84, 0xba800000, v100
v_mfma_f32_16x16x32_bf16 v[160:163], a[148:151], a[12:15], v[160:163]
v_mul_f32 v86, 0xba800000, v108
v_mul_f32 v88, 0xba800000, v116
v_mfma_f32_16x16x32_bf16 v[136:139], a[148:151], a[4:7], v[136:139]
v_mul_f32 v90, 0xba800000, v124
v_mul_f32 v94, 0x3a800000, v94
v_mfma_f32_16x16x32_bf16 v[136:139], a[144:147], a[0:3], v[136:139]
buffer_load_dwordx4 a[92:95], v2, s[40:43], s33 offen offset:3072 sc1
s_add_u32 s35, s35, 8192
v_mfma_f32_16x16x32_bf16 a[176:179], a[152:155], a[160:163], a[176:179]
s_add_u32 s33, s33, 8192
v_mul_f32 v102, 0x3a800000, v102
v_mfma_f32_16x16x32_bf16 a[176:179], a[156:159], a[164:167], a[176:179]
v_mul_f32 v110, 0x3a800000, v110
s_waitcnt vmcnt(14) lgkmcnt(0)
v_mfma_f32_16x16x32_bf16 v[140:143], a[96:99], a[32:35], v[140:143]
ds_read_b128 a[128:131], v5 offset:17408
v_mul_f32 v118, 0x3a800000, v118
v_mfma_f32_16x16x32_bf16 v[140:143], a[100:103], a[36:39], v[140:143]
buffer_load_dwordx4 a[0:3], v2, s[40:43], s35 offen offset:0 sc1
v_mfma_f32_16x16x32_bf16 v[164:167], a[100:103], a[44:47], v[164:167]
ds_read_b128 a[132:135], v5 offset:23552
v_mul_f32 v126, 0x3a800000, v126
v_mfma_f32_16x16x32_bf16 v[164:167], a[96:99], a[40:43], v[164:167]
v_fma_f32 v94, -v82, v82, v94
v_fma_f32 v102, -v84, v84, v102
v_mfma_f32_16x16x32_bf16 v[188:191], a[96:99], a[48:51], v[188:191]
ds_read_b128 a[136:139], v5 offset:12288
v_fma_f32 v110, -v86, v86, v110
v_mfma_f32_16x16x32_bf16 v[188:191], a[100:103], a[52:55], v[188:191]
v_fma_f32 v118, -v88, v88, v118
v_fma_f32 v126, -v90, v90, v126
v_mfma_f32_16x16x32_bf16 v[212:215], a[100:103], a[60:63], v[212:215]
buffer_load_dwordx4 a[4:7], v2, s[40:43], s33 offen offset:0 sc1
v_mfma_f32_16x16x32_bf16 v[212:215], a[96:99], a[56:59], v[212:215]
ds_read_b128 a[140:143], v5 offset:18432
v_max_f32 v94, 0, v94
v_max_f32 v102, 0, v102
v_max_f32 v110, 0, v110
v_max_f32 v118, 0, v118
v_max_f32 v126, 0, v126
v_add_f32 v94, 0x3727c5ac, v94
v_add_f32 v102, 0x3727c5ac, v102
v_add_f32 v110, 0x3727c5ac, v110
v_add_f32 v118, 0x3727c5ac, v118
v_add_f32 v126, 0x3727c5ac, v126
v_rsq_f32 v83, v94
v_rsq_f32 v85, v102
v_rsq_f32 v87, v110
v_rsq_f32 v89, v118
v_rsq_f32 v91, v126
v_mfma_f32_16x16x32_bf16 v[216:219], a[104:107], a[56:59], v[216:219]
ds_read_b128 a[144:147], v5 offset:13312
v_mfma_f32_16x16x32_bf16 v[216:219], a[108:111], a[60:63], v[216:219]
v_mfma_f32_16x16x32_bf16 v[192:195], a[108:111], a[52:55], v[192:195]
ds_read_b128 a[148:151], v5 offset:19456
v_fmac_f32 v140, v56, v82
v_mfma_f32_16x16x32_bf16 v[192:195], a[104:107], a[48:51], v[192:195]
buffer_load_dwordx4 v1, s[4:7], s44 offen offset:3072 sc1 lds
v_mfma_f32_16x16x32_bf16 v[168:171], a[104:107], a[40:43], v[168:171]
ds_read_b128 a[152:155], v6 offset:5120
v_fmac_f32 v164, v56, v84
v_mfma_f32_16x16x32_bf16 v[168:171], a[108:111], a[44:47], v[168:171]
v_mfma_f32_16x16x32_bf16 v[144:147], a[108:111], a[36:39], v[144:147]
ds_read_b128 a[156:159], v6 offset:29696
v_fmac_f32 v188, v56, v86
v_mfma_f32_16x16x32_bf16 v[144:147], a[104:107], a[32:35], v[144:147]
v_mfma_f32_16x16x32_bf16 v[148:151], a[112:115], a[32:35], v[148:151]
buffer_load_dwordx4 a[8:11], v2, s[40:43], s35 offen offset:1024 sc1
v_mfma_f32_16x16x32_bf16 v[148:151], a[116:119], a[36:39], v[148:151]
v_fmac_f32 v212, v56, v88
v_mfma_f32_16x16x32_bf16 v[172:175], a[116:119], a[44:47], v[172:175]
v_fmac_f32 v216, v60, v88
v_mfma_f32_16x16x32_bf16 v[172:175], a[112:115], a[40:43], v[172:175]
v_mfma_f32_16x16x32_bf16 v[196:199], a[112:115], a[48:51], v[196:199]
v_fmac_f32 v192, v60, v86
v_mfma_f32_16x16x32_bf16 v[196:199], a[116:119], a[52:55], v[196:199]
buffer_load_dwordx4 a[12:15], v2, s[40:43], s33 offen offset:1024 sc1
v_mfma_f32_16x16x32_bf16 v[220:223], a[116:119], a[60:63], v[220:223]
v_fmac_f32 v168, v60, v84
v_fmac_f32 v141, v57, v82
v_mfma_f32_16x16x32_bf16 v[220:223], a[112:115], a[56:59], v[220:223]
v_mfma_f32_16x16x32_bf16 a[180:183], a[120:123], a[160:163], a[180:183]
v_fmac_f32 v144, v60, v82
v_fmac_f32 v165, v57, v84
v_mfma_f32_16x16x32_bf16 a[180:183], a[124:127], a[164:167], a[180:183]
s_waitcnt lgkmcnt(0)
v_mfma_f32_16x16x32_bf16 v[224:227], a[128:131], a[56:59], v[224:227]
ds_read_b128 a[96:99], v5 offset:26624
v_fmac_f32 v148, v64, v82
v_mfma_f32_16x16x32_bf16 v[224:227], a[132:135], a[60:63], v[224:227]
buffer_load_dwordx4 a[16:19], v2, s[40:43], s35 offen offset:2048 sc1
s_lshl_b32 s90, s28, 12
v_mfma_f32_16x16x32_bf16 v[200:203], a[132:135], a[52:55], v[200:203]
ds_read_b128 a[100:103], v5 offset:32768
v_fmac_f32 v172, v64, v84
v_mfma_f32_16x16x32_bf16 v[200:203], a[128:131], a[48:51], v[200:203]
v_fmac_f32 v189, v57, v86
v_fmac_f32 v213, v57, v88
v_mfma_f32_16x16x32_bf16 v[176:179], a[128:131], a[40:43], v[176:179]
v_fmac_f32 v196, v64, v86
v_fmac_f32 v217, v61, v88
v_mfma_f32_16x16x32_bf16 v[176:179], a[132:135], a[44:47], v[176:179]
ds_read_b128 a[104:107], v5 offset:27648
s_add_u32 s90, s90, 147456
v_mfma_f32_16x16x32_bf16 v[152:155], a[132:135], a[36:39], v[152:155]
v_fmac_f32 v220, v64, v88
v_fmac_f32 v193, v61, v86
v_mfma_f32_16x16x32_bf16 v[152:155], a[128:131], a[32:35], v[152:155]
buffer_load_dwordx4 a[20:23], v2, s[40:43], s33 offen offset:2048 sc1
v_mfma_f32_16x16x32_bf16 v[132:135], a[136:139], a[32:35], v[132:135]
ds_read_b128 a[108:111], v5 offset:33792
v_fmac_f32 v169, v61, v84
v_mfma_f32_16x16x32_bf16 v[132:135], a[140:143], a[36:39], v[132:135]
v_add_u32 v234, s90, v1
s_lshl_b32 s90, s28, 10
v_mfma_f32_16x16x32_bf16 v[156:159], a[140:143], a[44:47], v[156:159]
ds_read_b128 a[112:115], v5 offset:28672
v_fmac_f32 v224, v68, v88
v_mfma_f32_16x16x32_bf16 v[156:159], a[136:139], a[40:43], v[156:159]
v_fmac_f32 v145, v61, v82
s_add_u32 s90, s90, 147456
v_mfma_f32_16x16x32_bf16 v[180:183], a[136:139], a[48:51], v[180:183]
v_fmac_f32 v200, v68, v86
v_fmac_f32 v149, v65, v82
v_mfma_f32_16x16x32_bf16 v[180:183], a[140:143], a[52:55], v[180:183]
ds_read_b128 a[116:119], v5 offset:34816
v_add_u32 v235, s90, v1
v_mfma_f32_16x16x32_bf16 v[204:207], a[140:143], a[60:63], v[204:207]
buffer_load_dwordx4 a[24:27], v2, s[40:43], s35 offen offset:3072 sc1
v_mfma_f32_16x16x32_bf16 v[204:207], a[136:139], a[56:59], v[204:207]
v_fmac_f32 v176, v68, v84
v_fmac_f32 v173, v65, v84
v_mfma_f32_16x16x32_bf16 v[208:211], a[144:147], a[56:59], v[208:211]
v_fmac_f32 v152, v68, v82
v_fmac_f32 v197, v65, v86
v_mfma_f32_16x16x32_bf16 v[208:211], a[148:151], a[60:63], v[208:211]
v_mfma_f32_16x16x32_bf16 v[184:187], a[148:151], a[52:55], v[184:187]
v_fmac_f32 v132, v48, v82
v_fmac_f32 v221, v65, v88
v_mfma_f32_16x16x32_bf16 v[184:187], a[144:147], a[48:51], v[184:187]
v_mfma_f32_16x16x32_bf16 v[160:163], a[144:147], a[40:43], v[160:163]
buffer_load_dwordx4 a[28:31], v2, s[40:43], s33 offen offset:3072 sc1
s_add_u32 s35, s35, 8192
v_mfma_f32_16x16x32_bf16 v[160:163], a[148:151], a[44:47], v[160:163]
s_add_u32 s33, s33, 8192
v_fmac_f32 v156, v48, v84
v_mfma_f32_16x16x32_bf16 v[136:139], a[148:151], a[36:39], v[136:139]
v_fmac_f32 v180, v48, v86
v_fmac_f32 v225, v69, v88
v_mfma_f32_16x16x32_bf16 v[136:139], a[144:147], a[32:35], v[136:139]
v_mfma_f32_16x16x32_bf16 a[184:187], a[152:155], a[160:163], a[184:187]
v_fmac_f32 v204, v48, v88
v_fmac_f32 v201, v69, v86
v_mfma_f32_16x16x32_bf16 a[184:187], a[156:159], a[164:167], a[184:187]
s_waitcnt vmcnt(9) lgkmcnt(0)
v_mfma_f32_16x16x32_bf16 v[140:143], a[96:99], a[64:67], v[140:143]
ds_read_b128 a[128:131], v5 offset:29696
v_fmac_f32 v208, v52, v88
v_mfma_f32_16x16x32_bf16 v[140:143], a[100:103], a[68:71], v[140:143]
buffer_store_dwordx4 a[220:223], v1, s[4:7], s101 offen offset:0 sc1
v_mfma_f32_16x16x32_bf16 v[164:167], a[100:103], a[76:79], v[164:167]
ds_read_b128 a[132:135], v5 offset:35840
v_fmac_f32 v184, v52, v86
v_mfma_f32_16x16x32_bf16 v[164:167], a[96:99], a[72:75], v[164:167]
v_fmac_f32 v177, v69, v84
v_fmac_f32 v153, v69, v82
v_mfma_f32_16x16x32_bf16 v[188:191], a[96:99], a[80:83], v[188:191]
v_fmac_f32 v160, v52, v84
v_fmac_f32 v133, v49, v82
v_mfma_f32_16x16x32_bf16 v[188:191], a[100:103], a[84:87], v[188:191]
ds_read_b128 a[136:139], v5 offset:24576
v_mfma_f32_16x16x32_bf16 v[212:215], a[100:103], a[92:95], v[212:215]
v_fmac_f32 v136, v52, v82
v_fmac_f32 v157, v49, v84
v_mfma_f32_16x16x32_bf16 v[212:215], a[96:99], a[88:91], v[212:215]
v_mfma_f32_16x16x32_bf16 v[216:219], a[104:107], a[88:91], v[216:219]
ds_read_b128 a[140:143], v5 offset:30720
v_fmac_f32 v181, v49, v86
v_mfma_f32_16x16x32_bf16 v[216:219], a[108:111], a[92:95], v[216:219]
buffer_store_dwordx4 a[224:227], v1, s[4:7], s101 offen offset:1024 sc1
v_mfma_f32_16x16x32_bf16 v[192:195], a[108:111], a[84:87], v[192:195]
ds_read_b128 a[144:147], v5 offset:25600
v_fmac_f32 v205, v49, v88
v_mfma_f32_16x16x32_bf16 v[192:195], a[104:107], a[80:83], v[192:195]
v_fmac_f32 v142, v58, v82
v_mfma_f32_16x16x32_bf16 v[168:171], a[104:107], a[72:75], v[168:171]
v_fmac_f32 v209, v53, v88
v_fmac_f32 v166, v58, v84
v_mfma_f32_16x16x32_bf16 v[168:171], a[108:111], a[76:79], v[168:171]
ds_read_b128 a[148:151], v5 offset:31744
v_mfma_f32_16x16x32_bf16 v[144:147], a[108:111], a[68:71], v[144:147]
v_fmac_f32 v185, v53, v86
v_fmac_f32 v190, v58, v86
v_mfma_f32_16x16x32_bf16 v[144:147], a[104:107], a[64:67], v[144:147]
ds_write_b128 v234, a[172:175] offset:0
v_mfma_f32_16x16x32_bf16 v[148:151], a[112:115], a[64:67], v[148:151]
v_fmac_f32 v161, v53, v84
v_fmac_f32 v214, v58, v88
v_mfma_f32_16x16x32_bf16 v[148:151], a[116:119], a[68:71], v[148:151]
buffer_store_dwordx4 a[188:191], v1, s[4:7], s96 offen offset:0 sc1
v_mfma_f32_16x16x32_bf16 v[172:175], a[116:119], a[76:79], v[172:175]
v_fmac_f32 v137, v53, v82
v_fmac_f32 v218, v62, v88
v_mfma_f32_16x16x32_bf16 v[172:175], a[112:115], a[72:75], v[172:175]
v_mfma_f32_16x16x32_bf16 v[196:199], a[112:115], a[80:83], v[196:199]
v_fmac_f32 v194, v62, v86
v_mfma_f32_16x16x32_bf16 v[196:199], a[116:119], a[84:87], v[196:199]
v_mfma_f32_16x16x32_bf16 v[220:223], a[116:119], a[92:95], v[220:223]
v_fmac_f32 v170, v62, v84
v_fmac_f32 v143, v59, v82
v_mfma_f32_16x16x32_bf16 v[220:223], a[112:115], a[88:91], v[220:223]
ds_write_b128 v234, a[176:179] offset:1024
s_waitcnt lgkmcnt(2)
v_mfma_f32_16x16x32_bf16 v[224:227], a[128:131], a[88:91], v[224:227]
ds_read_b128 a[96:99], v5 offset:38912
v_fmac_f32 v146, v62, v82
v_mfma_f32_16x16x32_bf16 v[224:227], a[132:135], a[92:95], v[224:227]
buffer_store_dwordx4 a[192:195], v1, s[4:7], s97 offen offset:0 sc1
v_mfma_f32_16x16x32_bf16 v[200:203], a[132:135], a[84:87], v[200:203]
ds_read_b128 a[100:103], v5 offset:45056
v_fmac_f32 v150, v66, v82
v_mfma_f32_16x16x32_bf16 v[200:203], a[128:131], a[80:83], v[200:203]
v_fmac_f32 v167, v59, v84
v_fmac_f32 v191, v59, v86
v_mfma_f32_16x16x32_bf16 v[176:179], a[128:131], a[72:75], v[176:179]
v_fmac_f32 v174, v66, v84
v_fmac_f32 v215, v59, v88
v_mfma_f32_16x16x32_bf16 v[176:179], a[132:135], a[76:79], v[176:179]
ds_read_b128 a[104:107], v5 offset:39936
v_mfma_f32_16x16x32_bf16 v[152:155], a[132:135], a[68:71], v[152:155]
v_fmac_f32 v198, v66, v86
v_fmac_f32 v219, v63, v88
v_mfma_f32_16x16x32_bf16 v[152:155], a[128:131], a[64:67], v[152:155]
v_mfma_f32_16x16x32_bf16 v[132:135], a[136:139], a[64:67], v[132:135]
ds_read_b128 a[108:111], v5 offset:46080
v_fmac_f32 v222, v66, v88
v_mfma_f32_16x16x32_bf16 v[132:135], a[140:143], a[68:71], v[132:135]
buffer_store_dwordx4 a[196:199], v1, s[4:7], s96 offen offset:1024 sc1
v_mfma_f32_16x16x32_bf16 v[156:159], a[140:143], a[76:79], v[156:159]
ds_read_b128 a[112:115], v5 offset:40960
v_fmac_f32 v226, v70, v88
v_mfma_f32_16x16x32_bf16 v[156:159], a[136:139], a[72:75], v[156:159]
v_fmac_f32 v195, v63, v86
v_fmac_f32 v171, v63, v84
v_mfma_f32_16x16x32_bf16 v[180:183], a[136:139], a[80:83], v[180:183]
v_fmac_f32 v202, v70, v86
v_fmac_f32 v147, v63, v82
v_mfma_f32_16x16x32_bf16 v[180:183], a[140:143], a[84:87], v[180:183]
ds_read_b128 a[116:119], v5 offset:47104
v_mfma_f32_16x16x32_bf16 v[204:207], a[140:143], a[92:95], v[204:207]
v_fmac_f32 v178, v70, v84
L_stub2:
s_cbranch_execz L_wret0
v_fmac_f32 v151, v67, v82
v_mfma_f32_16x16x32_bf16 v[204:207], a[136:139], a[88:91], v[204:207]
ds_write_b128 v234, a[180:183] offset:2048
v_mfma_f32_16x16x32_bf16 v[208:211], a[144:147], a[88:91], v[208:211]
v_fmac_f32 v154, v70, v82
v_fmac_f32 v175, v67, v84
v_mfma_f32_16x16x32_bf16 v[208:211], a[148:151], a[92:95], v[208:211]
buffer_store_dwordx4 a[200:203], v1, s[4:7], s97 offen offset:1024 sc1
v_mfma_f32_16x16x32_bf16 v[184:187], a[148:151], a[84:87], v[184:187]
v_fmac_f32 v134, v50, v82
v_fmac_f32 v199, v67, v86
v_mfma_f32_16x16x32_bf16 v[184:187], a[144:147], a[80:83], v[184:187]
v_mfma_f32_16x16x32_bf16 v[160:163], a[144:147], a[72:75], v[160:163]
v_fmac_f32 v158, v50, v84
v_fmac_f32 v223, v67, v88
v_mfma_f32_16x16x32_bf16 v[160:163], a[148:151], a[76:79], v[160:163]
v_mfma_f32_16x16x32_bf16 v[136:139], a[148:151], a[68:71], v[136:139]
v_fmac_f32 v182, v50, v86
v_fmac_f32 v227, v71, v88
v_mfma_f32_16x16x32_bf16 v[136:139], a[144:147], a[64:67], v[136:139]
ds_write_b128 v234, a[184:187] offset:3072
s_waitcnt vmcnt(6) lgkmcnt(2)
v_mfma_f32_16x16x32_bf16 v[140:143], a[96:99], a[0:3], v[140:143]
ds_read_b128 a[128:131], v5 offset:41984
v_fmac_f32 v206, v50, v88
v_mfma_f32_16x16x32_bf16 v[140:143], a[100:103], a[4:7], v[140:143]
buffer_store_dwordx4 a[204:207], v1, s[4:7], s96 offen offset:2048 sc1
v_mfma_f32_16x16x32_bf16 v[164:167], a[100:103], a[12:15], v[164:167]
ds_read_b128 a[132:135], v5 offset:48128
v_fmac_f32 v210, v54, v88
v_mfma_f32_16x16x32_bf16 v[164:167], a[96:99], a[8:11], v[164:167]
v_fmac_f32 v203, v71, v86
v_fmac_f32 v179, v71, v84
v_mfma_f32_16x16x32_bf16 v[188:191], a[96:99], a[16:19], v[188:191]
v_fmac_f32 v186, v54, v86
v_fmac_f32 v155, v71, v82
v_mfma_f32_16x16x32_bf16 v[188:191], a[100:103], a[20:23], v[188:191]
ds_read_b128 a[136:139], v5 offset:36864
v_mfma_f32_16x16x32_bf16 v[212:215], a[100:103], a[28:31], v[212:215]
v_fmac_f32 v162, v54, v84
v_fmac_f32 v135, v51, v82
v_mfma_f32_16x16x32_bf16 v[212:215], a[96:99], a[24:27], v[212:215]
v_mfma_f32_16x16x32_bf16 v[216:219], a[104:107], a[24:27], v[216:219]
ds_read_b128 a[140:143], v5 offset:43008
v_fmac_f32 v138, v54, v82
v_mfma_f32_16x16x32_bf16 v[216:219], a[108:111], a[28:31], v[216:219]
buffer_store_dwordx4 a[208:211], v1, s[4:7], s97 offen offset:2048 sc1
v_mfma_f32_16x16x32_bf16 v[192:195], a[108:111], a[20:23], v[192:195]
ds_read_b128 a[144:147], v5 offset:37888
v_fmac_f32 v159, v51, v84
v_mfma_f32_16x16x32_bf16 v[192:195], a[104:107], a[16:19], v[192:195]
v_fmac_f32 v183, v51, v86
v_mfma_f32_16x16x32_bf16 v[168:171], a[104:107], a[8:11], v[168:171]
v_fmac_f32 v207, v51, v88
v_mfma_f32_16x16x32_bf16 v[168:171], a[108:111], a[12:15], v[168:171]
ds_read_b128 a[148:151], v5 offset:44032
v_mfma_f32_16x16x32_bf16 v[144:147], a[108:111], a[4:7], v[144:147]
v_fmac_f32 v211, v55, v88
v_mfma_f32_16x16x32_bf16 v[144:147], a[104:107], a[0:3], v[144:147]
v_mfma_f32_16x16x32_bf16 v[148:151], a[112:115], a[0:3], v[148:151]
v_fmac_f32 v187, v55, v86
v_mfma_f32_16x16x32_bf16 v[148:151], a[116:119], a[4:7], v[148:151]
buffer_store_dwordx4 v[236:239], v254, s[4:7], s98 offen offset:0 sc1
v_mfma_f32_16x16x32_bf16 v[172:175], a[116:119], a[12:15], v[172:175]
v_fmac_f32 v163, v55, v84
v_mfma_f32_16x16x32_bf16 v[172:175], a[112:115], a[8:11], v[172:175]
v_mfma_f32_16x16x32_bf16 v[196:199], a[112:115], a[16:19], v[196:199]
v_fmac_f32 v139, v55, v82
v_mfma_f32_16x16x32_bf16 v[196:199], a[116:119], a[20:23], v[196:199]
v_mfma_f32_16x16x32_bf16 v[220:223], a[116:119], a[28:31], v[220:223]
v_mfma_f32_16x16x32_bf16 v[220:223], a[112:115], a[24:27], v[220:223]
s_waitcnt lgkmcnt(0)
s_barrier
v_mfma_f32_16x16x32_bf16 v[224:227], a[128:131], a[24:27], v[224:227]
ds_read_b128 v[92:95], v235 offset:0
v_mfma_f32_16x16x32_bf16 v[224:227], a[132:135], a[28:31], v[224:227]
buffer_store_dwordx4 v[240:243], v254, s[4:7], s98 offen offset:2048 sc1
v_mfma_f32_16x16x32_bf16 v[200:203], a[132:135], a[20:23], v[200:203]
ds_read_b128 v[96:99], v235 offset:4096
v_mfma_f32_16x16x32_bf16 v[200:203], a[128:131], a[16:19], v[200:203]
v_mfma_f32_16x16x32_bf16 v[176:179], a[128:131], a[8:11], v[176:179]
ds_read_b128 v[100:103], v235 offset:8192
v_mfma_f32_16x16x32_bf16 v[176:179], a[132:135], a[12:15], v[176:179]
v_mfma_f32_16x16x32_bf16 v[152:155], a[132:135], a[4:7], v[152:155]
ds_read_b128 v[104:107], v235 offset:12288
v_mfma_f32_16x16x32_bf16 v[152:155], a[128:131], a[0:3], v[152:155]
v_mfma_f32_16x16x32_bf16 v[132:135], a[136:139], a[0:3], v[132:135]
v_mfma_f32_16x16x32_bf16 v[132:135], a[140:143], a[4:7], v[132:135]
v_mfma_f32_16x16x32_bf16 v[156:159], a[140:143], a[12:15], v[156:159]
v_mfma_f32_16x16x32_bf16 v[156:159], a[136:139], a[8:11], v[156:159]
v_mfma_f32_16x16x32_bf16 v[180:183], a[136:139], a[16:19], v[180:183]
v_mfma_f32_16x16x32_bf16 v[180:183], a[140:143], a[20:23], v[180:183]
buffer_store_dwordx4 v[244:247], v254, s[4:7], s99 offen offset:0 sc1
v_mfma_f32_16x16x32_bf16 v[204:207], a[140:143], a[28:31], v[204:207]
v_mfma_f32_16x16x32_bf16 v[204:207], a[136:139], a[24:27], v[204:207]
v_mfma_f32_16x16x32_bf16 v[208:211], a[144:147], a[24:27], v[208:211]
v_mfma_f32_16x16x32_bf16 v[208:211], a[148:151], a[28:31], v[208:211]
v_mfma_f32_16x16x32_bf16 v[184:187], a[148:151], a[20:23], v[184:187]
v_mfma_f32_16x16x32_bf16 v[184:187], a[144:147], a[16:19], v[184:187]
v_mfma_f32_16x16x32_bf16 v[160:163], a[144:147], a[8:11], v[160:163]
v_mfma_f32_16x16x32_bf16 v[160:163], a[148:151], a[12:15], v[160:163]
v_mfma_f32_16x16x32_bf16 v[136:139], a[148:151], a[4:7], v[136:139]
v_mfma_f32_16x16x32_bf16 v[136:139], a[144:147], a[0:3], v[136:139]
.set L_cpf0, .
s_lshl_b32 s36, s28, 12
s_lshl_b32 s37, s28, 10
s_add_u32 m0, s19, 32768
s_add_u32 s44, s84, 0xa00000
buffer_load_dwordx4 v1, s[4:7], s44 offen offset:0 sc1 lds
s_waitcnt lgkmcnt(2)
v_add_f32 v92, v92, v96
s_waitcnt lgkmcnt(0)
v_add_f32 v100, v100, v104
v_add_f32 v93, v93, v97
v_add_f32 v101, v101, v105
v_add_f32 v94, v94, v98
v_add_f32 v102, v102, v106
v_add_f32 v95, v95, v99
v_add_f32 v103, v103, v107
v_add_f32 v228, v92, v100
v_add_f32 v229, v93, v101
v_add_f32 v230, v94, v102
v_add_f32 v231, v95, v103
v_fmac_f32 v228, v72, v90
v_fmac_f32 v229, v73, v90
v_pk_mul_f32 v[212:213], v[212:213], v[88:89] op_sel:[0,1] op_sel_hi:[1,1]
v_pk_mul_f32 v[220:221], v[220:221], v[88:89] op_sel:[0,1] op_sel_hi:[1,1]
v_pk_mul_f32 v[196:197], v[196:197], v[86:87] op_sel:[0,1] op_sel_hi:[1,1]
v_pk_mul_f32 v[172:173], v[172:173], v[84:85] op_sel:[0,1] op_sel_hi:[1,1]
v_pk_mul_f32 v[148:149], v[148:149], v[82:83] op_sel:[0,1] op_sel_hi:[1,1]
v_fmac_f32 v230, v74, v90
v_fmac_f32 v231, v75, v90
v_pk_mul_f32 v[228:229], v[228:229], v[90:91] op_sel:[0,1] op_sel_hi:[1,1]
v_pk_mul_f32 v[214:215], v[214:215], v[88:89] op_sel:[0,1] op_sel_hi:[1,1]
v_pk_mul_f32 v[222:223], v[222:223], v[88:89] op_sel:[0,1] op_sel_hi:[1,1]
v_pk_mul_f32 v[198:199], v[198:199], v[86:87] op_sel:[0,1] op_sel_hi:[1,1]
v_pk_mul_f32 v[174:175], v[174:175], v[84:85] op_sel:[0,1] op_sel_hi:[1,1]
v_pk_mul_f32 v[150:151], v[150:151], v[82:83] op_sel:[0,1] op_sel_hi:[1,1]
buffer_load_dwordx4 v1, s[4:7], s44 offen offset:1024 sc1 lds
v_cvt_pk_bf16_f32 v212, v212, v213
v_cvt_pk_bf16_f32 v220, v220, v221
v_cvt_pk_bf16_f32 v196, v196, v197
v_cvt_pk_bf16_f32 v172, v172, v173
v_cvt_pk_bf16_f32 v148, v148, v149
v_pk_mul_f32 v[230:231], v[230:231], v[90:91] op_sel:[0,1] op_sel_hi:[1,1]
v_pk_mul_f32 v[216:217], v[216:217], v[88:89] op_sel:[0,1] op_sel_hi:[1,1]
v_pk_mul_f32 v[218:219], v[218:219], v[88:89] op_sel:[0,1] op_sel_hi:[1,1]
v_pk_mul_f32 v[224:225], v[224:225], v[88:89] op_sel:[0,1] op_sel_hi:[1,1]
v_pk_mul_f32 v[226:227], v[226:227], v[88:89] op_sel:[0,1] op_sel_hi:[1,1]
v_pk_mul_f32 v[200:201], v[200:201], v[86:87] op_sel:[0,1] op_sel_hi:[1,1]
v_pk_mul_f32 v[202:203], v[202:203], v[86:87] op_sel:[0,1] op_sel_hi:[1,1]
v_pk_mul_f32 v[176:177], v[176:177], v[84:85] op_sel:[0,1] op_sel_hi:[1,1]
v_pk_mul_f32 v[178:179], v[178:179], v[84:85] op_sel:[0,1] op_sel_hi:[1,1]
v_pk_mul_f32 v[152:153], v[152:153], v[82:83] op_sel:[0,1] op_sel_hi:[1,1]
v_pk_mul_f32 v[154:155], v[154:155], v[82:83] op_sel:[0,1] op_sel_hi:[1,1]
v_cvt_pk_bf16_f32 v228, v228, v229
v_cvt_pk_bf16_f32 v213, v214, v215
v_cvt_pk_bf16_f32 v221, v222, v223
v_cvt_pk_bf16_f32 v197, v198, v199
v_cvt_pk_bf16_f32 v173, v174, v175
v_cvt_pk_bf16_f32 v149, v150, v151
v_pk_mul_f32 v[188:189], v[188:189], v[86:87] op_sel:[0,1] op_sel_hi:[1,1]
v_pk_mul_f32 v[164:165], v[164:165], v[84:85] op_sel:[0,1] op_sel_hi:[1,1]
v_pk_mul_f32 v[140:141], v[140:141], v[82:83] op_sel:[0,1] op_sel_hi:[1,1]
v_add_u32 v232, s36, v7
v_add_u32 v233, s37, v1
buffer_load_dwordx4 v1, s[4:7], s44 offen offset:2048 sc1 lds
v_cvt_pk_bf16_f32 v229, v230, v231
v_cvt_pk_bf16_f32 v214, v216, v217
v_cvt_pk_bf16_f32 v215, v218, v219
v_cvt_pk_bf16_f32 v222, v224, v225
v_cvt_pk_bf16_f32 v223, v226, v227
v_cvt_pk_bf16_f32 v198, v200, v201
v_cvt_pk_bf16_f32 v199, v202, v203
v_cvt_pk_bf16_f32 v174, v176, v177
v_cvt_pk_bf16_f32 v175, v178, v179
v_cvt_pk_bf16_f32 v150, v152, v153
v_cvt_pk_bf16_f32 v151, v154, v155
v_pk_mul_f32 v[190:191], v[190:191], v[86:87] op_sel:[0,1] op_sel_hi:[1,1]
v_pk_mul_f32 v[166:167], v[166:167], v[84:85] op_sel:[0,1] op_sel_hi:[1,1]
v_pk_mul_f32 v[142:143], v[142:143], v[82:83] op_sel:[0,1] op_sel_hi:[1,1]
v_cvt_pk_bf16_f32 v188, v188, v189
v_cvt_pk_bf16_f32 v164, v164, v165
v_cvt_pk_bf16_f32 v140, v140, v141
v_cvt_pk_bf16_f32 v132, v132, v133
v_cvt_pk_bf16_f32 v156, v156, v157
v_cvt_pk_bf16_f32 v180, v180, v181
v_cvt_pk_bf16_f32 v204, v204, v205
ds_write_b64 v9, v[228:229]
ds_write_b64 v232, v[220:221] offset:4096
buffer_load_dwordx4 v1, s[4:7], s44 offen offset:3072 sc1 lds
s_add_u32 m0, s19, 98304
s_add_u32 s44, s84, 0xa10000
ds_write_b64 v232, v[222:223] offset:4608
v_pk_mul_f32 v[192:193], v[192:193], v[86:87] op_sel:[0,1] op_sel_hi:[1,1]
v_pk_mul_f32 v[194:195], v[194:195], v[86:87] op_sel:[0,1] op_sel_hi:[1,1]
ds_write_b64 v232, v[196:197] offset:3072
ds_write_b64 v232, v[198:199] offset:3584
v_pk_mul_f32 v[168:169], v[168:169], v[84:85] op_sel:[0,1] op_sel_hi:[1,1]
v_pk_mul_f32 v[170:171], v[170:171], v[84:85] op_sel:[0,1] op_sel_hi:[1,1]
ds_write_b64 v232, v[172:173] offset:2048
v_pk_mul_f32 v[144:145], v[144:145], v[82:83] op_sel:[0,1] op_sel_hi:[1,1]
v_pk_mul_f32 v[146:147], v[146:147], v[82:83] op_sel:[0,1] op_sel_hi:[1,1]
v_cvt_pk_bf16_f32 v189, v190, v191
ds_write_b64 v232, v[174:175] offset:2560
v_cvt_pk_bf16_f32 v165, v166, v167
v_cvt_pk_bf16_f32 v141, v142, v143
v_cvt_pk_bf16_f32 v133, v134, v135
buffer_load_dwordx4 v1, s[4:7], s44 offen offset:0 sc1 lds
v_cvt_pk_bf16_f32 v157, v158, v159
ds_write_b64 v232, v[148:149] offset:1024
ds_write_b64 v232, v[150:151] offset:1536
v_cvt_pk_bf16_f32 v181, v182, v183
v_cvt_pk_bf16_f32 v205, v206, v207
ds_write_b128 v233, v[212:215] offset:21504
v_cvt_pk_bf16_f32 v190, v192, v193
v_cvt_pk_bf16_f32 v191, v194, v195
v_cvt_pk_bf16_f32 v166, v168, v169
v_cvt_pk_bf16_f32 v167, v170, v171
v_cvt_pk_bf16_f32 v142, v144, v145
v_cvt_pk_bf16_f32 v143, v146, v147
v_cvt_pk_bf16_f32 v134, v136, v137
v_cvt_pk_bf16_f32 v135, v138, v139
v_cvt_pk_bf16_f32 v158, v160, v161
v_cvt_pk_bf16_f32 v159, v162, v163
v_cvt_pk_bf16_f32 v182, v184, v185
v_cvt_pk_bf16_f32 v183, v186, v187
v_cvt_pk_bf16_f32 v206, v208, v209
v_cvt_pk_bf16_f32 v207, v210, v211
buffer_load_dwordx4 v1, s[4:7], s44 offen offset:1024 sc1 lds
buffer_load_dwordx4 v1, s[4:7], s44 offen offset:2048 sc1 lds
buffer_load_dwordx4 v1, s[4:7], s44 offen offset:3072 sc1 lds
s_waitcnt lgkmcnt(0)
s_barrier
s_lshl_b32 s35, s30, 12
s_add_u32 s35, s35, 0x1e00000
s_add_u32 m0, s19, 114688
s_add_u32 s44, s85, 0xa14000
buffer_load_dwordx4 v1, s[4:7], s44 offen offset:0 sc1 lds
v_mfma_f32_16x16x32_bf16 v[184:187], v[164:167], v[180:183], v[20:23]
ds_read_b128 a[0:3], v233 offset:20480
v_mfma_f32_16x16x32_bf16 v[200:203], v[188:191], v[180:183], v[24:27]
v_add_u32 v234, s36, v8
ds_read_b64_tr_b16 a[10:11], v234 offset:3072
v_mfma_f32_16x16x32_bf16 v[208:211], v[188:191], v[204:207], v[20:23]
ds_read_b64_tr_b16 a[12:13], v234 offset:4096
v_mfma_f32_16x16x32_bf16 v[224:227], v[212:215], v[204:207], v[24:27]
s_nop 2
v_max_f32 v200, v200, v184
v_max_f32 v201, v201, v185
v_max_f32 v202, v202, v186
v_max_f32 v203, v203, v187
v_max3_f32 v238, v200, v201, v202
v_max_f32 v238, v238, v203
ds_read_b64_tr_b16 a[22:23], v234 offset:3584
v_max_f32 v224, v224, v208
v_max_f32 v225, v225, v209
v_max_f32 v226, v226, v210
v_max_f32 v227, v227, v211
buffer_load_dwordx4 v1, s[4:7], s44 offen offset:1024 sc1 lds
v_max3_f32 v239, v224, v225, v226
v_max_f32 v239, v239, v227
ds_read_b64_tr_b16 a[24:25], v234 offset:4608
s_nop 0
v_permlane32_swap_b32 v239, v238
v_max_f32 v239, v239, v238
v_mov_b32 v242, v239
s_waitcnt lgkmcnt(4)
v_mfma_f32_16x16x32_bf16 v[136:139], a[0:3], v[132:135], v[76:79]
v_permlane16_swap_b32 v239, v242
v_max_f32 v239, v239, v242
v_mov_b32 v242, v239
v_mfma_f32_16x16x32_bf16 v[152:155], v[140:143], v[132:135], v[24:27]
s_nop 0
v_permlane32_swap_b32 v239, v242
v_mfma_f32_16x16x32_bf16 v[160:163], v[140:143], v[156:159], v[20:23]
v_mul_f32 v88, 0x3e8293ee, v89
v_mul_f32_e64 v89, -v239, v88
v_mfma_f32_16x16x32_bf16 v[176:179], v[164:167], v[156:159], v[24:27]
v_fma_f32 v224, v224, v88, v89
v_fma_f32 v225, v225, v88, v89
v_fma_f32 v226, v226, v88, v89
buffer_load_dwordx4 v1, s[4:7], s44 offen offset:2048 sc1 lds
v_fma_f32 v227, v227, v88, v89
v_exp_f32 v224, v224
v_exp_f32 v225, v225
v_exp_f32 v226, v226
v_exp_f32 v227, v227
v_max_f32 v152, v152, v136
v_max_f32 v153, v153, v137
v_max_f32 v154, v154, v138
v_max_f32 v176, v176, v160
v_max_f32 v177, v177, v161
v_max_f32 v178, v178, v162
v_cvt_pk_bf16_f32 v224, v224, v225
ds_read_b64_tr_b16 a[8:9], v234 offset:2048
v_max_f32 v155, v155, v139
v_max3_f32 v236, v152, v153, v154
v_max_f32 v179, v179, v163
v_max3_f32 v237, v176, v177, v178
v_cvt_pk_bf16_f32 v225, v226, v227
ds_read_b64_tr_b16 a[20:21], v234 offset:2560
v_max_f32 v236, v236, v155
v_max_f32 v237, v237, v179
buffer_load_dwordx4 v1, s[4:7], s44 offen offset:3072 sc1 lds
s_add_u32 m0, s19, 131072
s_add_u32 s44, s86, 0xa18000
v_and_b32 v208, v224, v28
v_and_b32 v209, v225, v29
v_and_b32 v210, v224, v30
v_and_b32 v211, v225, v31
v_permlane32_swap_b32 v237, v236
s_nop 0
v_mfma_f32_16x16x32_bf16 v[216:219], v[16:19], v[208:211], 0
v_mul_f32 v86, 0x3e8293ee, v87
v_max_f32 v237, v237, v236
v_mul_f32_e64 v87, -v242, v86
s_waitcnt lgkmcnt(4)
v_mfma_f32_16x16x32_bf16 v[116:119], a[10:13], v[208:211], 0
v_mov_b32 v243, v237
v_fma_f32 v200, v200, v86, v87
v_fma_f32 v201, v201, v86, v87
v_fma_f32 v202, v202, v86, v87
v_fma_f32 v203, v203, v86, v87
s_waitcnt lgkmcnt(2)
v_mfma_f32_16x16x32_bf16 v[120:123], a[22:25], v[208:211], 0
v_exp_f32 v200, v200
v_exp_f32 v201, v201
v_exp_f32 v202, v202
buffer_load_dwordx4 v1, s[4:7], s44 offen offset:0 sc1 lds
v_exp_f32 v203, v203
v_permlane16_swap_b32 v237, v243
v_rcp_f32 v216, v216
v_cvt_pk_bf16_f32 v200, v200, v201
ds_read_b64_tr_b16 a[6:7], v234 offset:1024
v_max_f32 v237, v237, v243
v_cvt_pk_bf16_f32 v201, v202, v203
ds_read_b64_tr_b16 a[18:19], v234 offset:1536
v_mov_b32 v243, v237
v_and_b32 v184, v200, v28
v_and_b32 v185, v201, v29
v_and_b32 v186, v200, v30
v_and_b32 v187, v201, v31
v_pk_mul_f32 v[116:117], v[116:117], v[216:217] op_sel:[0,0] op_sel_hi:[1,0]
v_pk_mul_f32 v[118:119], v[118:119], v[216:217] op_sel:[0,0] op_sel_hi:[1,0]
v_cvt_pk_bf16_f32 v116, v116, v117
v_pk_mul_f32 v[120:121], v[120:121], v[216:217] op_sel:[0,0] op_sel_hi:[1,0]
v_permlane32_swap_b32 v237, v243
v_pk_mul_f32 v[122:123], v[122:123], v[216:217] op_sel:[0,0] op_sel_hi:[1,0]
v_cvt_pk_bf16_f32 v117, v118, v119
v_mfma_f32_16x16x32_bf16 v[192:195], v[16:19], v[184:187], 0
buffer_load_dwordx4 v1, s[4:7], s44 offen offset:1024 sc1 lds
v_cvt_pk_bf16_f32 v118, v120, v121
v_cvt_pk_bf16_f32 v119, v122, v123
v_mul_f32 v84, 0x3e8293ee, v85
v_mul_f32_e64 v85, -v237, v84
s_waitcnt lgkmcnt(3)
v_mfma_f32_16x16x32_bf16 v[108:111], a[8:11], v[184:187], 0
v_fma_f32 v176, v176, v84, v85
v_fma_f32 v177, v177, v84, v85
v_fma_f32 v178, v178, v84, v85
v_fma_f32 v179, v179, v84, v85
s_waitcnt lgkmcnt(2)
v_mfma_f32_16x16x32_bf16 v[112:115], a[20:23], v[184:187], 0
v_exp_f32 v176, v176
v_exp_f32 v177, v177
v_exp_f32 v178, v178
v_exp_f32 v179, v179
v_rcp_f32 v192, v192
v_cvt_pk_bf16_f32 v176, v176, v177
ds_read_b64_tr_b16 a[4:5], v234 offset:0
v_cvt_pk_bf16_f32 v177, v178, v179
ds_read_b64_tr_b16 a[16:17], v234 offset:512
buffer_load_dwordx4 v1, s[4:7], s44 offen offset:2048 sc1 lds
v_and_b32 v160, v176, v28
v_and_b32 v161, v177, v29
v_and_b32 v162, v176, v30
v_and_b32 v163, v177, v31
v_pk_mul_f32 v[108:109], v[108:109], v[192:193] op_sel:[0,0] op_sel_hi:[1,0]
v_pk_mul_f32 v[110:111], v[110:111], v[192:193] op_sel:[0,0] op_sel_hi:[1,0]
v_cvt_pk_bf16_f32 v108, v108, v109
v_pk_mul_f32 v[112:113], v[112:113], v[192:193] op_sel:[0,0] op_sel_hi:[1,0]
v_cvt_pk_bf16_f32 v109, v110, v111
v_pk_mul_f32 v[114:115], v[114:115], v[192:193] op_sel:[0,0] op_sel_hi:[1,0]
v_cvt_pk_bf16_f32 v110, v112, v113
v_mfma_f32_16x16x32_bf16 v[168:171], v[16:19], v[160:163], 0
v_cvt_pk_bf16_f32 v111, v114, v115
v_mul_f32 v82, 0x3e8293ee, v83
v_mul_f32_e64 v83, -v243, v82
s_waitcnt lgkmcnt(3)
v_mfma_f32_16x16x32_bf16 v[100:103], a[6:9], v[160:163], 0
v_fma_f32 v152, v152, v82, v83
v_fma_f32 v153, v153, v82, v83
v_fma_f32 v154, v154, v82, v83
v_fma_f32 v155, v155, v82, v83
s_waitcnt lgkmcnt(2)
v_mfma_f32_16x16x32_bf16 v[104:107], a[18:21], v[160:163], 0
v_exp_f32 v152, v152
v_exp_f32 v153, v153
buffer_load_dwordx4 v1, s[4:7], s44 offen offset:3072 sc1 lds
v_exp_f32 v154, v154
v_exp_f32 v155, v155
v_rcp_f32 v168, v168
v_cvt_pk_bf16_f32 v152, v152, v153
v_cvt_pk_bf16_f32 v153, v154, v155
v_and_b32 v136, v152, v80
v_and_b32 v137, v153, v81
v_and_b32 v138, v152, v30
v_and_b32 v139, v153, v31
v_pk_mul_f32 v[100:101], v[100:101], v[168:169] op_sel:[0,0] op_sel_hi:[1,0]
v_pk_mul_f32 v[102:103], v[102:103], v[168:169] op_sel:[0,0] op_sel_hi:[1,0]
v_cvt_pk_bf16_f32 v100, v100, v101
v_pk_mul_f32 v[104:105], v[104:105], v[168:169] op_sel:[0,0] op_sel_hi:[1,0]
v_cvt_pk_bf16_f32 v101, v102, v103
v_pk_mul_f32 v[106:107], v[106:107], v[168:169] op_sel:[0,0] op_sel_hi:[1,0]
v_cvt_pk_bf16_f32 v102, v104, v105
v_mfma_f32_16x16x32_bf16 v[144:147], v[16:19], v[136:139], 0
v_cvt_pk_bf16_f32 v103, v106, v107
s_waitcnt lgkmcnt(1)
v_mfma_f32_16x16x32_bf16 v[92:95], a[4:7], v[136:139], 0
buffer_store_dwordx4 v[116:119], v2, s[4:7], s35 offen offset:3072 sc1
s_waitcnt lgkmcnt(0)
v_mfma_f32_16x16x32_bf16 v[96:99], a[16:19], v[136:139], 0
s_nop 1
v_rcp_f32 v144, v144
s_nop 1
v_pk_mul_f32 v[92:93], v[92:93], v[144:145] op_sel:[0,0] op_sel_hi:[1,0]
v_pk_mul_f32 v[94:95], v[94:95], v[144:145] op_sel:[0,0] op_sel_hi:[1,0]
v_cvt_pk_bf16_f32 v92, v92, v93
v_cvt_pk_bf16_f32 v93, v94, v95
v_pk_mul_f32 v[96:97], v[96:97], v[144:145] op_sel:[0,0] op_sel_hi:[1,0]
v_pk_mul_f32 v[98:99], v[98:99], v[144:145] op_sel:[0,0] op_sel_hi:[1,0]
buffer_store_dwordx4 v[108:111], v2, s[4:7], s35 offen offset:2048 sc1
v_cvt_pk_bf16_f32 v94, v96, v97
v_cvt_pk_bf16_f32 v95, v98, v99
buffer_store_dwordx4 v[100:103], v2, s[4:7], s35 offen offset:1024 sc1
buffer_store_dwordx4 v[92:95], v2, s[4:7], s35 offen offset:0 sc1
s_add_u32 s92, s71, 0x0
v_accvgpr_write_b32 a188, v48
v_accvgpr_write_b32 a189, v49
v_accvgpr_write_b32 a190, v50
v_accvgpr_write_b32 a191, v51
v_accvgpr_write_b32 a192, v52
v_accvgpr_write_b32 a193, v53
v_accvgpr_write_b32 a194, v54
v_accvgpr_write_b32 a195, v55
v_accvgpr_write_b32 a196, v56
v_accvgpr_write_b32 a197, v57
v_accvgpr_write_b32 a198, v58
v_accvgpr_write_b32 a199, v59
v_accvgpr_write_b32 a200, v60
v_accvgpr_write_b32 a201, v61
v_accvgpr_write_b32 a202, v62
v_accvgpr_write_b32 a203, v63
v_accvgpr_write_b32 a204, v64
v_accvgpr_write_b32 a205, v65
v_accvgpr_write_b32 a206, v66
v_accvgpr_write_b32 a207, v67
v_accvgpr_write_b32 a208, v68
v_accvgpr_write_b32 a209, v69
v_accvgpr_write_b32 a210, v70
v_accvgpr_write_b32 a211, v71
v_accvgpr_write_b32 a212, v72
v_accvgpr_write_b32 a213, v73
v_accvgpr_write_b32 a214, v74
v_accvgpr_write_b32 a215, v75
s_add_u32 s40, s4, 0x1e00000
s_addc_u32 s41, s5, 0
v_add_u32 v5, 32768, v1
v_add_u32 v6, 98304, v1
s_cmp_eq_u32 s3, 0
s_cselect_b32 s35, 8, 0
s_lshl_b32 s35, s35, 12
v_lshlrev_b32 v132, 16, v32
v_and_b32 v133, 0xffff0000, v32
v_lshlrev_b32 v134, 16, v33
v_and_b32 v135, 0xffff0000, v33
v_lshlrev_b32 v136, 16, v34
v_and_b32 v137, 0xffff0000, v34
v_lshlrev_b32 v138, 16, v35
v_and_b32 v139, 0xffff0000, v35
v_lshlrev_b32 v140, 16, v36
v_and_b32 v141, 0xffff0000, v36
v_lshlrev_b32 v142, 16, v37
v_and_b32 v143, 0xffff0000, v37
v_lshlrev_b32 v144, 16, v38
v_and_b32 v145, 0xffff0000, v38
v_lshlrev_b32 v146, 16, v39
v_and_b32 v147, 0xffff0000, v39
v_lshlrev_b32 v148, 16, v40
v_and_b32 v149, 0xffff0000, v40
v_lshlrev_b32 v150, 16, v41
v_and_b32 v151, 0xffff0000, v41
v_lshlrev_b32 v152, 16, v42
v_and_b32 v153, 0xffff0000, v42
v_lshlrev_b32 v154, 16, v43
v_and_b32 v155, 0xffff0000, v43
v_lshlrev_b32 v156, 16, v44
v_and_b32 v157, 0xffff0000, v44
v_lshlrev_b32 v158, 16, v45
v_and_b32 v159, 0xffff0000, v45
v_lshlrev_b32 v160, 16, v46
v_and_b32 v161, 0xffff0000, v46
v_lshlrev_b32 v162, 16, v47
v_and_b32 v163, 0xffff0000, v47
s_waitcnt vmcnt(0)
s_barrier
s_cmp_lg_u32 s28, 1
s_cbranch_scc1 Lsg_4
buffer_atomic_add v12, v10, s[4:7], s92 offen sc1
buffer_atomic_swap v15, v14, s[4:7], s8 offen sc1
buffer_atomic_swap v15, v252, s[4:7], s62 offen offset:64 sc1
Lsg_4:
s_mov_b64 exec, 0
s_cmp_eq_u32 s28, 1
s_cbranch_scc1 L_stub3
L_wret1:
s_mov_b64 exec, -1
s_add_u32 m0, s19, 147456
s_add_u32 s44, s87, 0xa1c000
buffer_load_dwordx4 v1, s[4:7], s44 offen offset:0 sc1 lds
buffer_load_dwordx4 v1, s[4:7], s44 offen offset:1024 sc1 lds
buffer_load_dwordx4 v1, s[4:7], s44 offen offset:2048 sc1 lds
buffer_load_dwordx4 v1, s[4:7], s44 offen offset:3072 sc1 lds
s_cmp_lg_u32 s28, 0
s_cbranch_scc1 Lpe_6
s_add_u32 s36, s66, 0x0
s_mov_b32 s37, 0
Lpoll_5:
v_mov_b32 v11, 0
buffer_atomic_add v11, v251, s[4:7], s36 offen sc0 sc1
s_add_u32 s37, s37, 1
s_waitcnt vmcnt(0)
v_readfirstlane_b32 s38, v11
s_nop 0
s_cmp_ge_u32 s38, 32
s_cbranch_scc1 Lpe_6
s_cmp_lt_u32 s37, 0x100000
s_cbranch_scc1 Lpoll_5
Lpe_6:
s_waitcnt vmcnt(0)
s_barrier
L_k2go0:
buffer_load_dwordx4 a[0:3], v4, s[40:43], s35 offen offset:0 sc1
buffer_load_dwordx4 a[4:7], v4, s[40:43], s35 offen offset:1024 sc1
s_cmp_eq_u32 s3, 1
s_cselect_b32 s35, 9, 1
s_lshl_b32 s35, s35, 12
buffer_load_dwordx4 a[8:11], v4, s[40:43], s35 offen offset:0 sc1
buffer_load_dwordx4 a[12:15], v4, s[40:43], s35 offen offset:1024 sc1
s_cmp_eq_u32 s3, 2
s_cselect_b32 s35, 10, 2
s_lshl_b32 s35, s35, 12
buffer_load_dwordx4 a[16:19], v4, s[40:43], s35 offen offset:0 sc1
buffer_load_dwordx4 a[20:23], v4, s[40:43], s35 offen offset:1024 sc1
s_cmp_eq_u32 s3, 3
s_cselect_b32 s35, 11, 3
s_lshl_b32 s35, s35, 12
buffer_load_dwordx4 a[24:27], v4, s[40:43], s35 offen offset:0 sc1
buffer_load_dwordx4 a[28:31], v4, s[40:43], s35 offen offset:1024 sc1
s_cmp_eq_u32 s3, 4
s_cselect_b32 s35, 12, 4
s_lshl_b32 s35, s35, 12
buffer_load_dwordx4 a[32:35], v4, s[40:43], s35 offen offset:0 sc1
buffer_load_dwordx4 a[36:39], v4, s[40:43], s35 offen offset:1024 sc1
s_cmp_eq_u32 s3, 5
s_cselect_b32 s35, 13, 5
s_lshl_b32 s35, s35, 12
ds_read_b128 a[96:99], v5 offset:0
ds_read_b128 a[100:103], v5 offset:1024
ds_read_b128 a[104:107], v5 offset:2048
ds_read_b128 a[108:111], v5 offset:3072
ds_read_b128 a[112:115], v5 offset:4096
ds_read_b128 a[116:119], v5 offset:5120
ds_read_b128 a[120:123], v5 offset:6144
ds_read_b128 a[124:127], v5 offset:7168
s_waitcnt vmcnt(8) lgkmcnt(4)
v_mfma_f32_16x16x32_bf16 v[132:135], a[96:99], a[0:3], v[132:135]
ds_read_b128 a[128:131], v5 offset:8192
v_mfma_f32_16x16x32_bf16 v[148:151], a[96:99], a[4:7], v[148:151]
ds_read_b128 a[132:135], v5 offset:9216
v_mfma_f32_16x16x32_bf16 v[152:155], a[100:103], a[4:7], v[152:155]
buffer_load_dwordx4 a[40:43], v4, s[40:43], s35 offen offset:0 sc1
v_mfma_f32_16x16x32_bf16 v[136:139], a[100:103], a[0:3], v[136:139]
ds_read_b128 a[136:139], v5 offset:10240
v_mfma_f32_16x16x32_bf16 v[140:143], a[104:107], a[0:3], v[140:143]
ds_read_b128 a[140:143], v5 offset:11264
v_mfma_f32_16x16x32_bf16 v[156:159], a[104:107], a[4:7], v[156:159]
v_mfma_f32_16x16x32_bf16 v[160:163], a[108:111], a[4:7], v[160:163]
buffer_load_dwordx4 a[44:47], v4, s[40:43], s35 offen offset:1024 sc1
v_mfma_f32_16x16x32_bf16 v[144:147], a[108:111], a[0:3], v[144:147]
s_waitcnt vmcnt(8) lgkmcnt(4)
v_mfma_f32_16x16x32_bf16 v[132:135], a[112:115], a[8:11], v[132:135]
s_cmp_eq_u32 s3, 6
s_cselect_b32 s35, 14, 6
s_lshl_b32 s35, s35, 12
v_mfma_f32_16x16x32_bf16 v[148:151], a[112:115], a[12:15], v[148:151]
ds_read_b128 a[96:99], v5 offset:12288
v_mfma_f32_16x16x32_bf16 v[152:155], a[116:119], a[12:15], v[152:155]
buffer_load_dwordx4 a[0:3], v4, s[40:43], s35 offen offset:0 sc1
v_mfma_f32_16x16x32_bf16 v[136:139], a[116:119], a[8:11], v[136:139]
ds_read_b128 a[100:103], v5 offset:13312
v_mfma_f32_16x16x32_bf16 v[140:143], a[120:123], a[8:11], v[140:143]
ds_read_b128 a[104:107], v5 offset:14336
v_mfma_f32_16x16x32_bf16 v[156:159], a[120:123], a[12:15], v[156:159]
ds_read_b128 a[108:111], v5 offset:15360
v_mfma_f32_16x16x32_bf16 v[160:163], a[124:127], a[12:15], v[160:163]
buffer_load_dwordx4 a[4:7], v4, s[40:43], s35 offen offset:1024 sc1
v_mfma_f32_16x16x32_bf16 v[144:147], a[124:127], a[8:11], v[144:147]
s_waitcnt vmcnt(8) lgkmcnt(4)
v_mfma_f32_16x16x32_bf16 v[132:135], a[128:131], a[16:19], v[132:135]
s_cmp_eq_u32 s3, 7
s_cselect_b32 s35, 15, 7
s_lshl_b32 s35, s35, 12
v_mfma_f32_16x16x32_bf16 v[148:151], a[128:131], a[20:23], v[148:151]
ds_read_b128 a[112:115], v5 offset:16384
v_mfma_f32_16x16x32_bf16 v[152:155], a[132:135], a[20:23], v[152:155]
buffer_load_dwordx4 a[8:11], v4, s[40:43], s35 offen offset:0 sc1
v_mfma_f32_16x16x32_bf16 v[136:139], a[132:135], a[16:19], v[136:139]
ds_read_b128 a[116:119], v5 offset:17408
v_mfma_f32_16x16x32_bf16 v[140:143], a[136:139], a[16:19], v[140:143]
L_stub3:
s_cbranch_execz L_wret1
ds_read_b128 a[120:123], v5 offset:18432
v_mfma_f32_16x16x32_bf16 v[156:159], a[136:139], a[20:23], v[156:159]
ds_read_b128 a[124:127], v5 offset:19456
v_mfma_f32_16x16x32_bf16 v[160:163], a[140:143], a[20:23], v[160:163]
buffer_load_dwordx4 a[12:15], v4, s[40:43], s35 offen offset:1024 sc1
v_mfma_f32_16x16x32_bf16 v[144:147], a[140:143], a[16:19], v[144:147]
s_waitcnt vmcnt(8) lgkmcnt(4)
v_mfma_f32_16x16x32_bf16 v[132:135], a[96:99], a[24:27], v[132:135]
s_cmp_eq_u32 s3, 0
s_cselect_b32 s35, 16, 8
s_lshl_b32 s35, s35, 12
v_mfma_f32_16x16x32_bf16 v[148:151], a[96:99], a[28:31], v[148:151]
ds_read_b128 a[128:131], v5 offset:20480
v_mfma_f32_16x16x32_bf16 v[152:155], a[100:103], a[28:31], v[152:155]
buffer_load_dwordx4 a[16:19], v4, s[40:43], s35 offen offset:0 sc1
v_mfma_f32_16x16x32_bf16 v[136:139], a[100:103], a[24:27], v[136:139]
ds_read_b128 a[132:135], v5 offset:21504
v_mfma_f32_16x16x32_bf16 v[140:143], a[104:107], a[24:27], v[140:143]
ds_read_b128 a[136:139], v5 offset:22528
v_mfma_f32_16x16x32_bf16 v[156:159], a[104:107], a[28:31], v[156:159]
ds_read_b128 a[140:143], v5 offset:23552
v_mfma_f32_16x16x32_bf16 v[160:163], a[108:111], a[28:31], v[160:163]
buffer_load_dwordx4 a[20:23], v4, s[40:43], s35 offen offset:1024 sc1
v_mfma_f32_16x16x32_bf16 v[144:147], a[108:111], a[24:27], v[144:147]
s_waitcnt vmcnt(8) lgkmcnt(4)
v_mfma_f32_16x16x32_bf16 v[132:135], a[112:115], a[32:35], v[132:135]
s_cmp_eq_u32 s3, 1
s_cselect_b32 s35, 17, 9
s_lshl_b32 s35, s35, 12
v_mfma_f32_16x16x32_bf16 v[148:151], a[112:115], a[36:39], v[148:151]
ds_read_b128 a[96:99], v5 offset:24576
v_mfma_f32_16x16x32_bf16 v[152:155], a[116:119], a[36:39], v[152:155]
buffer_load_dwordx4 a[24:27], v4, s[40:43], s35 offen offset:0 sc1
v_mfma_f32_16x16x32_bf16 v[136:139], a[116:119], a[32:35], v[136:139]
ds_read_b128 a[100:103], v5 offset:25600
v_mfma_f32_16x16x32_bf16 v[140:143], a[120:123], a[32:35], v[140:143]
ds_read_b128 a[104:107], v5 offset:26624
v_mfma_f32_16x16x32_bf16 v[156:159], a[120:123], a[36:39], v[156:159]
ds_read_b128 a[108:111], v5 offset:27648
v_mfma_f32_16x16x32_bf16 v[160:163], a[124:127], a[36:39], v[160:163]
buffer_load_dwordx4 a[28:31], v4, s[40:43], s35 offen offset:1024 sc1
v_mfma_f32_16x16x32_bf16 v[144:147], a[124:127], a[32:35], v[144:147]
s_waitcnt vmcnt(8) lgkmcnt(4)
v_mfma_f32_16x16x32_bf16 v[132:135], a[128:131], a[40:43], v[132:135]
s_cmp_eq_u32 s3, 2
s_cselect_b32 s35, 18, 10
s_lshl_b32 s35, s35, 12
v_mfma_f32_16x16x32_bf16 v[148:151], a[128:131], a[44:47], v[148:151]
ds_read_b128 a[112:115], v5 offset:28672
v_mfma_f32_16x16x32_bf16 v[152:155], a[132:135], a[44:47], v[152:155]
buffer_load_dwordx4 a[32:35], v4, s[40:43], s35 offen offset:0 sc1
v_mfma_f32_16x16x32_bf16 v[136:139], a[132:135], a[40:43], v[136:139]
ds_read_b128 a[116:119], v5 offset:29696
v_mfma_f32_16x16x32_bf16 v[140:143], a[136:139], a[40:43], v[140:143]
ds_read_b128 a[120:123], v5 offset:30720
v_mfma_f32_16x16x32_bf16 v[156:159], a[136:139], a[44:47], v[156:159]
ds_read_b128 a[124:127], v5 offset:31744
v_mfma_f32_16x16x32_bf16 v[160:163], a[140:143], a[44:47], v[160:163]
buffer_load_dwordx4 a[36:39], v4, s[40:43], s35 offen offset:1024 sc1
v_mfma_f32_16x16x32_bf16 v[144:147], a[140:143], a[40:43], v[144:147]
s_waitcnt vmcnt(8) lgkmcnt(4)
v_mfma_f32_16x16x32_bf16 v[132:135], a[96:99], a[0:3], v[132:135]
s_cmp_eq_u32 s3, 3
s_cselect_b32 s35, 19, 11
s_lshl_b32 s35, s35, 12
v_mfma_f32_16x16x32_bf16 v[148:151], a[96:99], a[4:7], v[148:151]
ds_read_b128 a[128:131], v5 offset:32768
v_mfma_f32_16x16x32_bf16 v[152:155], a[100:103], a[4:7], v[152:155]
buffer_load_dwordx4 a[40:43], v4, s[40:43], s35 offen offset:0 sc1
v_mfma_f32_16x16x32_bf16 v[136:139], a[100:103], a[0:3], v[136:139]
ds_read_b128 a[132:135], v5 offset:33792
v_mfma_f32_16x16x32_bf16 v[140:143], a[104:107], a[0:3], v[140:143]
ds_read_b128 a[136:139], v5 offset:34816
v_mfma_f32_16x16x32_bf16 v[156:159], a[104:107], a[4:7], v[156:159]
ds_read_b128 a[140:143], v5 offset:35840
v_mfma_f32_16x16x32_bf16 v[160:163], a[108:111], a[4:7], v[160:163]
buffer_load_dwordx4 a[44:47], v4, s[40:43], s35 offen offset:1024 sc1
v_mfma_f32_16x16x32_bf16 v[144:147], a[108:111], a[0:3], v[144:147]
s_waitcnt vmcnt(8) lgkmcnt(4)
v_mfma_f32_16x16x32_bf16 v[132:135], a[112:115], a[8:11], v[132:135]
s_cmp_eq_u32 s3, 4
s_cselect_b32 s35, 20, 12
s_lshl_b32 s35, s35, 12
v_mfma_f32_16x16x32_bf16 v[148:151], a[112:115], a[12:15], v[148:151]
ds_read_b128 a[96:99], v5 offset:36864
v_mfma_f32_16x16x32_bf16 v[152:155], a[116:119], a[12:15], v[152:155]
buffer_load_dwordx4 a[0:3], v4, s[40:43], s35 offen offset:0 sc1
v_mfma_f32_16x16x32_bf16 v[136:139], a[116:119], a[8:11], v[136:139]
ds_read_b128 a[100:103], v5 offset:37888
v_mfma_f32_16x16x32_bf16 v[140:143], a[120:123], a[8:11], v[140:143]
ds_read_b128 a[104:107], v5 offset:38912
v_mfma_f32_16x16x32_bf16 v[156:159], a[120:123], a[12:15], v[156:159]
ds_read_b128 a[108:111], v5 offset:39936
v_mfma_f32_16x16x32_bf16 v[160:163], a[124:127], a[12:15], v[160:163]
buffer_load_dwordx4 a[4:7], v4, s[40:43], s35 offen offset:1024 sc1
v_mfma_f32_16x16x32_bf16 v[144:147], a[124:127], a[8:11], v[144:147]
s_waitcnt vmcnt(8) lgkmcnt(4)
v_mfma_f32_16x16x32_bf16 v[132:135], a[128:131], a[16:19], v[132:135]
s_cmp_eq_u32 s3, 5
s_cselect_b32 s35, 21, 13
s_lshl_b32 s35, s35, 12
v_mfma_f32_16x16x32_bf16 v[148:151], a[128:131], a[20:23], v[148:151]
ds_read_b128 a[112:115], v5 offset:40960
v_mfma_f32_16x16x32_bf16 v[152:155], a[132:135], a[20:23], v[152:155]
buffer_load_dwordx4 a[8:11], v4, s[40:43], s35 offen offset:0 sc1
v_mfma_f32_16x16x32_bf16 v[136:139], a[132:135], a[16:19], v[136:139]
ds_read_b128 a[116:119], v5 offset:41984
v_mfma_f32_16x16x32_bf16 v[140:143], a[136:139], a[16:19], v[140:143]
ds_read_b128 a[120:123], v5 offset:43008
v_mfma_f32_16x16x32_bf16 v[156:159], a[136:139], a[20:23], v[156:159]
ds_read_b128 a[124:127], v5 offset:44032
v_mfma_f32_16x16x32_bf16 v[160:163], a[140:143], a[20:23], v[160:163]
buffer_load_dwordx4 a[12:15], v4, s[40:43], s35 offen offset:1024 sc1
v_mfma_f32_16x16x32_bf16 v[144:147], a[140:143], a[16:19], v[144:147]
s_waitcnt vmcnt(8) lgkmcnt(4)
v_mfma_f32_16x16x32_bf16 v[132:135], a[96:99], a[24:27], v[132:135]
s_cmp_eq_u32 s3, 6
s_cselect_b32 s35, 22, 14
s_lshl_b32 s35, s35, 12
v_mfma_f32_16x16x32_bf16 v[148:151], a[96:99], a[28:31], v[148:151]
ds_read_b128 a[128:131], v5 offset:45056
v_mfma_f32_16x16x32_bf16 v[152:155], a[100:103], a[28:31], v[152:155]
buffer_load_dwordx4 a[16:19], v4, s[40:43], s35 offen offset:0 sc1
v_mfma_f32_16x16x32_bf16 v[136:139], a[100:103], a[24:27], v[136:139]
ds_read_b128 a[132:135], v5 offset:46080
v_mfma_f32_16x16x32_bf16 v[140:143], a[104:107], a[24:27], v[140:143]
ds_read_b128 a[136:139], v5 offset:47104
v_mfma_f32_16x16x32_bf16 v[156:159], a[104:107], a[28:31], v[156:159]
ds_read_b128 a[140:143], v5 offset:48128
v_mfma_f32_16x16x32_bf16 v[160:163], a[108:111], a[28:31], v[160:163]
buffer_load_dwordx4 a[20:23], v4, s[40:43], s35 offen offset:1024 sc1
v_mfma_f32_16x16x32_bf16 v[144:147], a[108:111], a[24:27], v[144:147]
s_waitcnt vmcnt(8) lgkmcnt(4)
v_mfma_f32_16x16x32_bf16 v[132:135], a[112:115], a[32:35], v[132:135]
s_cmp_eq_u32 s3, 7
s_cselect_b32 s35, 23, 15
s_lshl_b32 s35, s35, 12
v_mfma_f32_16x16x32_bf16 v[148:151], a[112:115], a[36:39], v[148:151]
ds_read_b128 a[96:99], v5 offset:49152
v_mfma_f32_16x16x32_bf16 v[152:155], a[116:119], a[36:39], v[152:155]
buffer_load_dwordx4 a[24:27], v4, s[40:43], s35 offen offset:0 sc1
v_mfma_f32_16x16x32_bf16 v[136:139], a[116:119], a[32:35], v[136:139]
ds_read_b128 a[100:103], v5 offset:50176
v_mfma_f32_16x16x32_bf16 v[140:143], a[120:123], a[32:35], v[140:143]
ds_read_b128 a[104:107], v5 offset:51200
v_mfma_f32_16x16x32_bf16 v[156:159], a[120:123], a[36:39], v[156:159]
ds_read_b128 a[108:111], v5 offset:52224
v_mfma_f32_16x16x32_bf16 v[160:163], a[124:127], a[36:39], v[160:163]
buffer_load_dwordx4 a[28:31], v4, s[40:43], s35 offen offset:1024 sc1
v_mfma_f32_16x16x32_bf16 v[144:147], a[124:127], a[32:35], v[144:147]
s_waitcnt vmcnt(8) lgkmcnt(4)
v_mfma_f32_16x16x32_bf16 v[132:135], a[128:131], a[40:43], v[132:135]
s_cmp_eq_u32 s3, 0
s_cselect_b32 s35, 24, 16
s_lshl_b32 s35, s35, 12
v_mfma_f32_16x16x32_bf16 v[148:151], a[128:131], a[44:47], v[148:151]
ds_read_b128 a[112:115], v5 offset:53248
v_mfma_f32_16x16x32_bf16 v[152:155], a[132:135], a[44:47], v[152:155]
buffer_load_dwordx4 a[32:35], v4, s[40:43], s35 offen offset:0 sc1
v_mfma_f32_16x16x32_bf16 v[136:139], a[132:135], a[40:43], v[136:139]
ds_read_b128 a[116:119], v5 offset:54272
v_mfma_f32_16x16x32_bf16 v[140:143], a[136:139], a[40:43], v[140:143]
ds_read_b128 a[120:123], v5 offset:55296
v_mfma_f32_16x16x32_bf16 v[156:159], a[136:139], a[44:47], v[156:159]
ds_read_b128 a[124:127], v5 offset:56320
v_mfma_f32_16x16x32_bf16 v[160:163], a[140:143], a[44:47], v[160:163]
buffer_load_dwordx4 a[36:39], v4, s[40:43], s35 offen offset:1024 sc1
v_mfma_f32_16x16x32_bf16 v[144:147], a[140:143], a[40:43], v[144:147]
s_waitcnt vmcnt(8) lgkmcnt(4)
v_mfma_f32_16x16x32_bf16 v[132:135], a[96:99], a[0:3], v[132:135]
s_cmp_eq_u32 s3, 1
s_cselect_b32 s35, 25, 17
s_lshl_b32 s35, s35, 12
v_mfma_f32_16x16x32_bf16 v[148:151], a[96:99], a[4:7], v[148:151]
ds_read_b128 a[128:131], v5 offset:57344
v_mfma_f32_16x16x32_bf16 v[152:155], a[100:103], a[4:7], v[152:155]
buffer_load_dwordx4 a[40:43], v4, s[40:43], s35 offen offset:0 sc1
v_mfma_f32_16x16x32_bf16 v[136:139], a[100:103], a[0:3], v[136:139]
ds_read_b128 a[132:135], v5 offset:58368
v_mfma_f32_16x16x32_bf16 v[140:143], a[104:107], a[0:3], v[140:143]
ds_read_b128 a[136:139], v5 offset:59392
v_mfma_f32_16x16x32_bf16 v[156:159], a[104:107], a[4:7], v[156:159]
ds_read_b128 a[140:143], v5 offset:60416
v_mfma_f32_16x16x32_bf16 v[160:163], a[108:111], a[4:7], v[160:163]
buffer_load_dwordx4 a[44:47], v4, s[40:43], s35 offen offset:1024 sc1
v_mfma_f32_16x16x32_bf16 v[144:147], a[108:111], a[0:3], v[144:147]
s_waitcnt vmcnt(8) lgkmcnt(4)
v_mfma_f32_16x16x32_bf16 v[132:135], a[112:115], a[8:11], v[132:135]
s_cmp_eq_u32 s3, 2
s_cselect_b32 s35, 26, 18
s_lshl_b32 s35, s35, 12
v_mfma_f32_16x16x32_bf16 v[148:151], a[112:115], a[12:15], v[148:151]
ds_read_b128 a[96:99], v5 offset:61440
v_mfma_f32_16x16x32_bf16 v[152:155], a[116:119], a[12:15], v[152:155]
buffer_load_dwordx4 a[0:3], v4, s[40:43], s35 offen offset:0 sc1
v_mfma_f32_16x16x32_bf16 v[136:139], a[116:119], a[8:11], v[136:139]
ds_read_b128 a[100:103], v5 offset:62464
v_mfma_f32_16x16x32_bf16 v[140:143], a[120:123], a[8:11], v[140:143]
ds_read_b128 a[104:107], v5 offset:63488
v_mfma_f32_16x16x32_bf16 v[156:159], a[120:123], a[12:15], v[156:159]
ds_read_b128 a[108:111], v5 offset:64512
v_mfma_f32_16x16x32_bf16 v[160:163], a[124:127], a[12:15], v[160:163]
buffer_load_dwordx4 a[4:7], v4, s[40:43], s35 offen offset:1024 sc1
v_mfma_f32_16x16x32_bf16 v[144:147], a[124:127], a[8:11], v[144:147]
s_waitcnt vmcnt(8) lgkmcnt(4)
v_mfma_f32_16x16x32_bf16 v[132:135], a[128:131], a[16:19], v[132:135]
s_cmp_eq_u32 s3, 3
s_cselect_b32 s35, 27, 19
s_lshl_b32 s35, s35, 12
v_mfma_f32_16x16x32_bf16 v[148:151], a[128:131], a[20:23], v[148:151]
ds_read_b128 a[112:115], v6 offset:0
v_mfma_f32_16x16x32_bf16 v[152:155], a[132:135], a[20:23], v[152:155]
buffer_load_dwordx4 a[8:11], v4, s[40:43], s35 offen offset:0 sc1
v_mfma_f32_16x16x32_bf16 v[136:139], a[132:135], a[16:19], v[136:139]
ds_read_b128 a[116:119], v6 offset:1024
v_mfma_f32_16x16x32_bf16 v[140:143], a[136:139], a[16:19], v[140:143]
ds_read_b128 a[120:123], v6 offset:2048
v_mfma_f32_16x16x32_bf16 v[156:159], a[136:139], a[20:23], v[156:159]
ds_read_b128 a[124:127], v6 offset:3072
v_mfma_f32_16x16x32_bf16 v[160:163], a[140:143], a[20:23], v[160:163]
buffer_load_dwordx4 a[12:15], v4, s[40:43], s35 offen offset:1024 sc1
v_mfma_f32_16x16x32_bf16 v[144:147], a[140:143], a[16:19], v[144:147]
s_waitcnt vmcnt(8) lgkmcnt(4)
v_mfma_f32_16x16x32_bf16 v[132:135], a[96:99], a[24:27], v[132:135]
s_cmp_eq_u32 s3, 4
s_cselect_b32 s35, 28, 20
s_lshl_b32 s35, s35, 12
v_mfma_f32_16x16x32_bf16 v[148:151], a[96:99], a[28:31], v[148:151]
ds_read_b128 a[128:131], v6 offset:4096
v_mfma_f32_16x16x32_bf16 v[152:155], a[100:103], a[28:31], v[152:155]
buffer_load_dwordx4 a[16:19], v4, s[40:43], s35 offen offset:0 sc1
v_mfma_f32_16x16x32_bf16 v[136:139], a[100:103], a[24:27], v[136:139]
ds_read_b128 a[132:135], v6 offset:5120
v_mfma_f32_16x16x32_bf16 v[140:143], a[104:107], a[24:27], v[140:143]
ds_read_b128 a[136:139], v6 offset:6144
v_mfma_f32_16x16x32_bf16 v[156:159], a[104:107], a[28:31], v[156:159]
ds_read_b128 a[140:143], v6 offset:7168
v_mfma_f32_16x16x32_bf16 v[160:163], a[108:111], a[28:31], v[160:163]
buffer_load_dwordx4 a[20:23], v4, s[40:43], s35 offen offset:1024 sc1
v_mfma_f32_16x16x32_bf16 v[144:147], a[108:111], a[24:27], v[144:147]
s_waitcnt vmcnt(8) lgkmcnt(4)
v_mfma_f32_16x16x32_bf16 v[132:135], a[112:115], a[32:35], v[132:135]
s_cmp_eq_u32 s3, 5
s_cselect_b32 s35, 29, 21
s_lshl_b32 s35, s35, 12
v_mfma_f32_16x16x32_bf16 v[148:151], a[112:115], a[36:39], v[148:151]
ds_read_b128 a[96:99], v6 offset:8192
v_mfma_f32_16x16x32_bf16 v[152:155], a[116:119], a[36:39], v[152:155]
buffer_load_dwordx4 a[24:27], v4, s[40:43], s35 offen offset:0 sc1
v_mfma_f32_16x16x32_bf16 v[136:139], a[116:119], a[32:35], v[136:139]
ds_read_b128 a[100:103], v6 offset:9216
v_mfma_f32_16x16x32_bf16 v[140:143], a[120:123], a[32:35], v[140:143]
ds_read_b128 a[104:107], v6 offset:10240
v_mfma_f32_16x16x32_bf16 v[156:159], a[120:123], a[36:39], v[156:159]
ds_read_b128 a[108:111], v6 offset:11264
v_mfma_f32_16x16x32_bf16 v[160:163], a[124:127], a[36:39], v[160:163]
buffer_load_dwordx4 a[28:31], v4, s[40:43], s35 offen offset:1024 sc1
v_mfma_f32_16x16x32_bf16 v[144:147], a[124:127], a[32:35], v[144:147]
s_waitcnt vmcnt(8) lgkmcnt(4)
v_mfma_f32_16x16x32_bf16 v[132:135], a[128:131], a[40:43], v[132:135]
s_cmp_eq_u32 s3, 6
s_cselect_b32 s35, 30, 22
s_lshl_b32 s35, s35, 12
v_mfma_f32_16x16x32_bf16 v[148:151], a[128:131], a[44:47], v[148:151]
ds_read_b128 a[112:115], v6 offset:12288
v_mfma_f32_16x16x32_bf16 v[152:155], a[132:135], a[44:47], v[152:155]
buffer_load_dwordx4 a[32:35], v4, s[40:43], s35 offen offset:0 sc1
v_mfma_f32_16x16x32_bf16 v[136:139], a[132:135], a[40:43], v[136:139]
ds_read_b128 a[116:119], v6 offset:13312
v_mfma_f32_16x16x32_bf16 v[140:143], a[136:139], a[40:43], v[140:143]
ds_read_b128 a[120:123], v6 offset:14336
v_mfma_f32_16x16x32_bf16 v[156:159], a[136:139], a[44:47], v[156:159]
ds_read_b128 a[124:127], v6 offset:15360
v_mfma_f32_16x16x32_bf16 v[160:163], a[140:143], a[44:47], v[160:163]
buffer_load_dwordx4 a[36:39], v4, s[40:43], s35 offen offset:1024 sc1
v_mfma_f32_16x16x32_bf16 v[144:147], a[140:143], a[40:43], v[144:147]
s_waitcnt vmcnt(8) lgkmcnt(4)
v_mfma_f32_16x16x32_bf16 v[132:135], a[96:99], a[0:3], v[132:135]
s_cmp_eq_u32 s3, 7
s_cselect_b32 s35, 31, 23
s_lshl_b32 s35, s35, 12
v_mfma_f32_16x16x32_bf16 v[148:151], a[96:99], a[4:7], v[148:151]
ds_read_b128 a[128:131], v6 offset:16384
v_mfma_f32_16x16x32_bf16 v[152:155], a[100:103], a[4:7], v[152:155]
buffer_load_dwordx4 a[40:43], v4, s[40:43], s35 offen offset:0 sc1
v_mfma_f32_16x16x32_bf16 v[136:139], a[100:103], a[0:3], v[136:139]
ds_read_b128 a[132:135], v6 offset:17408
v_mfma_f32_16x16x32_bf16 v[140:143], a[104:107], a[0:3], v[140:143]
ds_read_b128 a[136:139], v6 offset:18432
v_mfma_f32_16x16x32_bf16 v[156:159], a[104:107], a[4:7], v[156:159]
ds_read_b128 a[140:143], v6 offset:19456
v_mfma_f32_16x16x32_bf16 v[160:163], a[108:111], a[4:7], v[160:163]
buffer_load_dwordx4 a[44:47], v4, s[40:43], s35 offen offset:1024 sc1
v_mfma_f32_16x16x32_bf16 v[144:147], a[108:111], a[0:3], v[144:147]
s_waitcnt vmcnt(8) lgkmcnt(4)
v_mfma_f32_16x16x32_bf16 v[132:135], a[112:115], a[8:11], v[132:135]
s_cmp_eq_u32 s3, 0
s_cselect_b32 s35, 0, 24
s_lshl_b32 s35, s35, 12
v_mfma_f32_16x16x32_bf16 v[148:151], a[112:115], a[12:15], v[148:151]
ds_read_b128 a[96:99], v6 offset:20480
v_mfma_f32_16x16x32_bf16 v[152:155], a[116:119], a[12:15], v[152:155]
buffer_load_dwordx4 a[0:3], v4, s[40:43], s35 offen offset:0 sc1
v_mfma_f32_16x16x32_bf16 v[136:139], a[116:119], a[8:11], v[136:139]
ds_read_b128 a[100:103], v6 offset:21504
v_mfma_f32_16x16x32_bf16 v[140:143], a[120:123], a[8:11], v[140:143]
ds_read_b128 a[104:107], v6 offset:22528
v_mfma_f32_16x16x32_bf16 v[156:159], a[120:123], a[12:15], v[156:159]
ds_read_b128 a[108:111], v6 offset:23552
v_mfma_f32_16x16x32_bf16 v[160:163], a[124:127], a[12:15], v[160:163]
buffer_load_dwordx4 a[4:7], v4, s[40:43], s35 offen offset:1024 sc1
v_mfma_f32_16x16x32_bf16 v[144:147], a[124:127], a[8:11], v[144:147]
s_waitcnt vmcnt(8) lgkmcnt(4)
v_mfma_f32_16x16x32_bf16 v[132:135], a[128:131], a[16:19], v[132:135]
s_cmp_eq_u32 s3, 1
s_cselect_b32 s35, 1, 25
s_lshl_b32 s35, s35, 12
v_mfma_f32_16x16x32_bf16 v[148:151], a[128:131], a[20:23], v[148:151]
ds_read_b128 a[112:115], v6 offset:24576
s_add_u32 s88, s67, 0xe0000
v_mfma_f32_16x16x32_bf16 v[152:155], a[132:135], a[20:23], v[152:155]
buffer_load_dwordx4 a[8:11], v4, s[40:43], s35 offen offset:0 sc1
s_add_u32 s89, s66, 0xd0000
v_mfma_f32_16x16x32_bf16 v[136:139], a[132:135], a[16:19], v[136:139]
ds_read_b128 a[116:119], v6 offset:25600
v_mfma_f32_16x16x32_bf16 v[140:143], a[136:139], a[16:19], v[140:143]
ds_read_b128 a[120:123], v6 offset:26624
v_mfma_f32_16x16x32_bf16 v[156:159], a[136:139], a[20:23], v[156:159]
ds_read_b128 a[124:127], v6 offset:27648
v_mfma_f32_16x16x32_bf16 v[160:163], a[140:143], a[20:23], v[160:163]
buffer_load_dwordx4 a[12:15], v4, s[40:43], s35 offen offset:1024 sc1
v_mfma_f32_16x16x32_bf16 v[144:147], a[140:143], a[16:19], v[144:147]
buffer_load_dword v11, v255, s[4:7], s88 offen sc1
s_waitcnt vmcnt(9) lgkmcnt(4)
v_mfma_f32_16x16x32_bf16 v[132:135], a[96:99], a[24:27], v[132:135]
s_cmp_eq_u32 s3, 2
s_cselect_b32 s35, 2, 26
s_lshl_b32 s35, s35, 12
v_mfma_f32_16x16x32_bf16 v[148:151], a[96:99], a[28:31], v[148:151]
ds_read_b128 a[128:131], v6 offset:28672
v_mfma_f32_16x16x32_bf16 v[152:155], a[100:103], a[28:31], v[152:155]
buffer_load_dwordx4 a[16:19], v4, s[40:43], s35 offen offset:0 sc1
v_mfma_f32_16x16x32_bf16 v[136:139], a[100:103], a[24:27], v[136:139]
ds_read_b128 a[132:135], v6 offset:29696
v_mfma_f32_16x16x32_bf16 v[140:143], a[104:107], a[24:27], v[140:143]
ds_read_b128 a[136:139], v6 offset:30720
v_mfma_f32_16x16x32_bf16 v[156:159], a[104:107], a[28:31], v[156:159]
ds_read_b128 a[140:143], v6 offset:31744
v_mfma_f32_16x16x32_bf16 v[160:163], a[108:111], a[28:31], v[160:163]
buffer_load_dwordx4 a[20:23], v4, s[40:43], s35 offen offset:1024 sc1
v_mfma_f32_16x16x32_bf16 v[144:147], a[108:111], a[24:27], v[144:147]
buffer_load_dword v232, v255, s[4:7], s89 offen offset:64 sc1
s_waitcnt vmcnt(10) lgkmcnt(4)
v_mfma_f32_16x16x32_bf16 v[132:135], a[112:115], a[32:35], v[132:135]
s_cmp_eq_u32 s3, 3
s_cselect_b32 s35, 3, 27
s_lshl_b32 s35, s35, 12
v_mfma_f32_16x16x32_bf16 v[148:151], a[112:115], a[36:39], v[148:151]
ds_read_b128 a[96:99], v6 offset:32768
v_mfma_f32_16x16x32_bf16 v[152:155], a[116:119], a[36:39], v[152:155]
buffer_load_dwordx4 a[24:27], v4, s[40:43], s35 offen offset:0 sc1
v_mfma_f32_16x16x32_bf16 v[136:139], a[116:119], a[32:35], v[136:139]
ds_read_b128 a[100:103], v6 offset:33792
v_mfma_f32_16x16x32_bf16 v[140:143], a[120:123], a[32:35], v[140:143]
ds_read_b128 a[104:107], v6 offset:34816
v_mfma_f32_16x16x32_bf16 v[156:159], a[120:123], a[36:39], v[156:159]
ds_read_b128 a[108:111], v6 offset:35840
v_mfma_f32_16x16x32_bf16 v[160:163], a[124:127], a[36:39], v[160:163]
buffer_load_dwordx4 a[28:31], v4, s[40:43], s35 offen offset:1024 sc1
v_mfma_f32_16x16x32_bf16 v[144:147], a[124:127], a[32:35], v[144:147]
s_waitcnt vmcnt(10) lgkmcnt(4)
v_mfma_f32_16x16x32_bf16 v[132:135], a[128:131], a[40:43], v[132:135]
s_cmp_eq_u32 s3, 4
s_cselect_b32 s35, 4, 28
s_lshl_b32 s35, s35, 12
v_mfma_f32_16x16x32_bf16 v[148:151], a[128:131], a[44:47], v[148:151]
ds_read_b128 a[112:115], v6 offset:36864
v_mfma_f32_16x16x32_bf16 v[152:155], a[132:135], a[44:47], v[152:155]
buffer_load_dwordx4 a[32:35], v4, s[40:43], s35 offen offset:0 sc1
v_mfma_f32_16x16x32_bf16 v[136:139], a[132:135], a[40:43], v[136:139]
ds_read_b128 a[116:119], v6 offset:37888
v_mfma_f32_16x16x32_bf16 v[140:143], a[136:139], a[40:43], v[140:143]
ds_read_b128 a[120:123], v6 offset:38912
v_mfma_f32_16x16x32_bf16 v[156:159], a[136:139], a[44:47], v[156:159]
ds_read_b128 a[124:127], v6 offset:39936
v_mfma_f32_16x16x32_bf16 v[160:163], a[140:143], a[44:47], v[160:163]
buffer_load_dwordx4 a[36:39], v4, s[40:43], s35 offen offset:1024 sc1
v_mfma_f32_16x16x32_bf16 v[144:147], a[140:143], a[40:43], v[144:147]
s_waitcnt vmcnt(10) lgkmcnt(4)
v_mfma_f32_16x16x32_bf16 v[132:135], a[96:99], a[0:3], v[132:135]
s_cmp_eq_u32 s3, 5
s_cselect_b32 s35, 5, 29
s_lshl_b32 s35, s35, 12
v_mfma_f32_16x16x32_bf16 v[148:151], a[96:99], a[4:7], v[148:151]
ds_read_b128 a[128:131], v6 offset:40960
v_mfma_f32_16x16x32_bf16 v[152:155], a[100:103], a[4:7], v[152:155]
buffer_load_dwordx4 a[40:43], v4, s[40:43], s35 offen offset:0 sc1
v_mfma_f32_16x16x32_bf16 v[136:139], a[100:103], a[0:3], v[136:139]
ds_read_b128 a[132:135], v6 offset:41984
v_mfma_f32_16x16x32_bf16 v[140:143], a[104:107], a[0:3], v[140:143]
ds_read_b128 a[136:139], v6 offset:43008
v_mfma_f32_16x16x32_bf16 v[156:159], a[104:107], a[4:7], v[156:159]
ds_read_b128 a[140:143], v6 offset:44032
v_mfma_f32_16x16x32_bf16 v[160:163], a[108:111], a[4:7], v[160:163]
buffer_load_dwordx4 a[44:47], v4, s[40:43], s35 offen offset:1024 sc1
v_mfma_f32_16x16x32_bf16 v[144:147], a[108:111], a[0:3], v[144:147]
s_waitcnt vmcnt(10) lgkmcnt(4)
v_mfma_f32_16x16x32_bf16 v[132:135], a[112:115], a[8:11], v[132:135]
s_cmp_eq_u32 s3, 6
s_cselect_b32 s35, 6, 30
s_lshl_b32 s35, s35, 12
v_mfma_f32_16x16x32_bf16 v[148:151], a[112:115], a[12:15], v[148:151]
ds_read_b128 a[96:99], v6 offset:45056
v_mfma_f32_16x16x32_bf16 v[152:155], a[116:119], a[12:15], v[152:155]
buffer_load_dwordx4 a[0:3], v4, s[40:43], s35 offen offset:0 sc1
v_mfma_f32_16x16x32_bf16 v[136:139], a[116:119], a[8:11], v[136:139]
ds_read_b128 a[100:103], v6 offset:46080
v_mfma_f32_16x16x32_bf16 v[140:143], a[120:123], a[8:11], v[140:143]
ds_read_b128 a[104:107], v6 offset:47104
v_mfma_f32_16x16x32_bf16 v[156:159], a[120:123], a[12:15], v[156:159]
ds_read_b128 a[108:111], v6 offset:48128
v_mfma_f32_16x16x32_bf16 v[160:163], a[124:127], a[12:15], v[160:163]
buffer_load_dwordx4 a[4:7], v4, s[40:43], s35 offen offset:1024 sc1
v_mfma_f32_16x16x32_bf16 v[144:147], a[124:127], a[8:11], v[144:147]
s_waitcnt vmcnt(9) lgkmcnt(4)
v_mfma_f32_16x16x32_bf16 v[132:135], a[128:131], a[16:19], v[132:135]
s_cmp_eq_u32 s3, 7
s_cselect_b32 s35, 7, 31
s_lshl_b32 s35, s35, 12
v_mfma_f32_16x16x32_bf16 v[148:151], a[128:131], a[20:23], v[148:151]
ds_read_b128 a[112:115], v6 offset:49152
v_mfma_f32_16x16x32_bf16 v[152:155], a[132:135], a[20:23], v[152:155]
buffer_load_dwordx4 a[8:11], v4, s[40:43], s35 offen offset:0 sc1
v_mfma_f32_16x16x32_bf16 v[136:139], a[132:135], a[16:19], v[136:139]
ds_read_b128 a[116:119], v6 offset:50176
v_mfma_f32_16x16x32_bf16 v[140:143], a[136:139], a[16:19], v[140:143]
ds_read_b128 a[120:123], v6 offset:51200
v_mfma_f32_16x16x32_bf16 v[156:159], a[136:139], a[20:23], v[156:159]
ds_read_b128 a[124:127], v6 offset:52224
v_mfma_f32_16x16x32_bf16 v[160:163], a[140:143], a[20:23], v[160:163]
buffer_load_dwordx4 a[12:15], v4, s[40:43], s35 offen offset:1024 sc1
v_mfma_f32_16x16x32_bf16 v[144:147], a[140:143], a[16:19], v[144:147]
s_waitcnt vmcnt(8) lgkmcnt(4)
v_mfma_f32_16x16x32_bf16 v[132:135], a[96:99], a[24:27], v[132:135]
ds_read_b128 a[128:131], v6 offset:53248
v_mfma_f32_16x16x32_bf16 v[148:151], a[96:99], a[28:31], v[148:151]
ds_read_b128 a[132:135], v6 offset:54272
v_mfma_f32_16x16x32_bf16 v[152:155], a[100:103], a[28:31], v[152:155]
ds_read_b128 a[136:139], v6 offset:55296
v_mfma_f32_16x16x32_bf16 v[136:139], a[100:103], a[24:27], v[136:139]
ds_read_b128 a[140:143], v6 offset:56320
v_mfma_f32_16x16x32_bf16 v[140:143], a[104:107], a[24:27], v[140:143]
v_mfma_f32_16x16x32_bf16 v[156:159], a[104:107], a[28:31], v[156:159]
v_mfma_f32_16x16x32_bf16 v[160:163], a[108:111], a[28:31], v[160:163]
v_mfma_f32_16x16x32_bf16 v[144:147], a[108:111], a[24:27], v[144:147]
s_waitcnt vmcnt(6) lgkmcnt(4)
v_mfma_f32_16x16x32_bf16 v[132:135], a[112:115], a[32:35], v[132:135]
ds_read_b128 a[96:99], v6 offset:57344
v_mfma_f32_16x16x32_bf16 v[148:151], a[112:115], a[36:39], v[148:151]
ds_read_b128 a[100:103], v6 offset:58368
v_mfma_f32_16x16x32_bf16 v[152:155], a[116:119], a[36:39], v[152:155]
ds_read_b128 a[104:107], v6 offset:59392
v_mfma_f32_16x16x32_bf16 v[136:139], a[116:119], a[32:35], v[136:139]
ds_read_b128 a[108:111], v6 offset:60416
v_mfma_f32_16x16x32_bf16 v[140:143], a[120:123], a[32:35], v[140:143]
v_mfma_f32_16x16x32_bf16 v[156:159], a[120:123], a[36:39], v[156:159]
v_mfma_f32_16x16x32_bf16 v[160:163], a[124:127], a[36:39], v[160:163]
v_mfma_f32_16x16x32_bf16 v[144:147], a[124:127], a[32:35], v[144:147]
s_waitcnt vmcnt(4) lgkmcnt(4)
v_mfma_f32_16x16x32_bf16 v[132:135], a[128:131], a[40:43], v[132:135]
ds_read_b128 a[112:115], v6 offset:61440
v_mfma_f32_16x16x32_bf16 v[148:151], a[128:131], a[44:47], v[148:151]
ds_read_b128 a[116:119], v6 offset:62464
v_mfma_f32_16x16x32_bf16 v[152:155], a[132:135], a[44:47], v[152:155]
ds_read_b128 a[120:123], v6 offset:63488
v_mfma_f32_16x16x32_bf16 v[136:139], a[132:135], a[40:43], v[136:139]
ds_read_b128 a[124:127], v6 offset:64512
v_mfma_f32_16x16x32_bf16 v[140:143], a[136:139], a[40:43], v[140:143]
v_mfma_f32_16x16x32_bf16 v[156:159], a[136:139], a[44:47], v[156:159]
v_mfma_f32_16x16x32_bf16 v[160:163], a[140:143], a[44:47], v[160:163]
v_mfma_f32_16x16x32_bf16 v[144:147], a[140:143], a[40:43], v[144:147]
s_waitcnt vmcnt(2) lgkmcnt(4)
v_mfma_f32_16x16x32_bf16 v[132:135], a[96:99], a[0:3], v[132:135]
v_mfma_f32_16x16x32_bf16 v[148:151], a[96:99], a[4:7], v[148:151]
v_mfma_f32_16x16x32_bf16 v[152:155], a[100:103], a[4:7], v[152:155]
v_mfma_f32_16x16x32_bf16 v[136:139], a[100:103], a[0:3], v[136:139]
v_mfma_f32_16x16x32_bf16 v[140:143], a[104:107], a[0:3], v[140:143]
v_mfma_f32_16x16x32_bf16 v[156:159], a[104:107], a[4:7], v[156:159]
v_mfma_f32_16x16x32_bf16 v[160:163], a[108:111], a[4:7], v[160:163]
v_mfma_f32_16x16x32_bf16 v[144:147], a[108:111], a[0:3], v[144:147]
s_waitcnt vmcnt(0) lgkmcnt(0)
v_mfma_f32_16x16x32_bf16 v[132:135], a[112:115], a[8:11], v[132:135]
v_mfma_f32_16x16x32_bf16 v[148:151], a[112:115], a[12:15], v[148:151]
v_mfma_f32_16x16x32_bf16 v[152:155], a[116:119], a[12:15], v[152:155]
v_mfma_f32_16x16x32_bf16 v[136:139], a[116:119], a[8:11], v[136:139]
v_mfma_f32_16x16x32_bf16 v[140:143], a[120:123], a[8:11], v[140:143]
v_mfma_f32_16x16x32_bf16 v[156:159], a[120:123], a[12:15], v[156:159]
v_mfma_f32_16x16x32_bf16 v[160:163], a[124:127], a[12:15], v[160:163]
v_mfma_f32_16x16x32_bf16 v[144:147], a[124:127], a[8:11], v[144:147]
s_lshl_b32 s36, s32, 13
v_cvt_pk_bf16_f32 v32, v132, v133
v_cvt_pk_bf16_f32 v33, v134, v135
s_nop 0
v_cvt_pk_bf16_f32 v34, v136, v137
v_cvt_pk_bf16_f32 v35, v138, v139
s_add_u32 s36, s36, 0x2200000
buffer_store_dwordx4 v[32:35], v4, s[4:7], s36 offen offset:0 sc1
v_cvt_pk_bf16_f32 v40, v148, v149
v_cvt_pk_bf16_f32 v41, v150, v151
v_cvt_pk_bf16_f32 v42, v152, v153
v_cvt_pk_bf16_f32 v43, v154, v155
v_cvt_pk_bf16_f32 v36, v140, v141
v_cvt_pk_bf16_f32 v37, v142, v143
v_cvt_pk_bf16_f32 v38, v144, v145
v_cvt_pk_bf16_f32 v39, v146, v147
s_add_u32 s37, s36, 4096
v_cvt_pk_bf16_f32 v44, v156, v157
v_cvt_pk_bf16_f32 v45, v158, v159
v_cvt_pk_bf16_f32 v46, v160, v161
buffer_store_dwordx4 v[40:43], v4, s[4:7], s36 offen offset:1024 sc1
v_cvt_pk_bf16_f32 v47, v162, v163
v_mfma_f32_16x16x32_bf16 v[96:99], v[32:35], v[32:35], 0
s_mov_b32 s38, 0x240000
s_add_u32 s92, s78, 0x40000
v_mfma_f32_16x16x32_bf16 v[92:95], v[16:19], v[32:35], 0
s_add_u32 s93, s79, 0x40000
s_add_u32 s40, s4, 0x2200000
v_mfma_f32_16x16x32_bf16 v[96:99], v[36:39], v[36:39], v[96:99]
s_addc_u32 s41, s5, 0
buffer_store_dwordx4 v[36:39], v4, s[4:7], s37 offen offset:0 sc1
v_mfma_f32_16x16x32_bf16 v[92:95], v[16:19], v[36:39], v[92:95]
s_nop 4
v_cndmask_b32 v96, v96, v97, s[46:47]
v_cndmask_b32 v98, v98, v99, s[46:47]
v_mfma_f32_16x16x32_bf16 v[104:107], v[40:43], v[40:43], 0
v_mfma_f32_16x16x32_bf16 v[100:103], v[16:19], v[40:43], 0
v_cndmask_b32 v93, v96, v98, s[48:49]
buffer_store_dwordx4 v[44:47], v4, s[4:7], s37 offen offset:1024 sc1
v_mfma_f32_16x16x32_bf16 v[104:107], v[44:47], v[44:47], v[104:107]
v_mfma_f32_16x16x32_bf16 v[100:103], v[16:19], v[44:47], v[100:103]
s_nop 6
v_cndmask_b32 v104, v104, v105, s[46:47]
v_cndmask_b32 v106, v106, v107, s[46:47]
buffer_store_dwordx2 v[92:93], v253, s[4:7], s38 offen offset:0 sc1
v_cndmask_b32 v101, v104, v106, s[48:49]
buffer_store_dwordx2 v[100:101], v253, s[4:7], s38 offen offset:2048 sc1
v_cmp_ne_u32 vcc, v11, v15
s_cbranch_vccnz Ltr_7
Lte_9:
v_cmp_ne_u32 vcc, v232, v15
s_cbranch_vccnz Ltr_10
Lte_12:
s_barrier
s_add_u32 m0, s18, 0x0
s_add_u32 s44, s50, 0x1400000
buffer_load_dwordx4 v1, s[4:7], s44 offen offset:0 sc1 lds
buffer_load_dwordx4 v1, s[4:7], s44 offen offset:1024 sc1 lds
buffer_load_dwordx4 v1, s[4:7], s44 offen offset:2048 sc1 lds
s_add_u32 m0, s18, 0x3000
s_add_u32 s44, s50, 0x1403000
buffer_load_dwordx4 v1, s[4:7], s44 offen offset:0 sc1 lds
buffer_load_dwordx4 v1, s[4:7], s44 offen offset:1024 sc1 lds
buffer_load_dwordx4 v1, s[4:7], s44 offen offset:2048 sc1 lds
s_waitcnt vmcnt(6)
s_barrier
s_cmp_lg_u32 s28, 1
s_cbranch_scc1 Lsg_13
buffer_atomic_add v12, v10, s[4:7], s92 offen sc1
Lsg_13:
s_mov_b64 exec, 0
s_cmp_eq_u32 s28, 1
s_cbranch_scc1 L_stub4
L_wret2:
s_mov_b64 exec, -1
s_cmp_lt_u32 s28, 2
s_cbranch_scc1 Lwd_14
L_stub4:
s_cbranch_execz L_stub5
s_add_u32 m0, s18, 0x4800
s_add_u32 s44, s50, 0x1404800
buffer_load_dwordx4 v1, s[4:7], s44 offen offset:0 sc1 lds
buffer_load_dwordx4 v1, s[4:7], s44 offen offset:1024 sc1 lds
buffer_load_dwordx4 v1, s[4:7], s44 offen offset:2048 sc1 lds
s_add_u32 m0, s18, 0x6000
s_add_u32 s44, s50, 0x1406000
buffer_load_dwordx4 v1, s[4:7], s44 offen offset:0 sc1 lds
buffer_load_dwordx4 v1, s[4:7], s44 offen offset:1024 sc1 lds
buffer_load_dwordx4 v1, s[4:7], s44 offen offset:2048 sc1 lds
s_add_u32 m0, s18, 0x7800
s_add_u32 s44, s50, 0x1407800
buffer_load_dwordx4 v1, s[4:7], s44 offen offset:0 sc1 lds
buffer_load_dwordx4 v1, s[4:7], s44 offen offset:1024 sc1 lds
buffer_load_dwordx4 v1, s[4:7], s44 offen offset:2048 sc1 lds
s_add_u32 m0, s18, 0x9000
s_add_u32 s44, s50, 0x1409000
buffer_load_dwordx4 v1, s[4:7], s44 offen offset:0 sc1 lds
buffer_load_dwordx4 v1, s[4:7], s44 offen offset:1024 sc1 lds
buffer_load_dwordx4 v1, s[4:7], s44 offen offset:2048 sc1 lds
s_add_u32 m0, s18, 0xa800
s_add_u32 s44, s50, 0x140a800
buffer_load_dwordx4 v1, s[4:7], s44 offen offset:0 sc1 lds
buffer_load_dwordx4 v1, s[4:7], s44 offen offset:1024 sc1 lds
buffer_load_dwordx4 v1, s[4:7], s44 offen offset:2048 sc1 lds
s_add_u32 m0, s18, 0xc000
s_add_u32 s44, s50, 0x140c000
buffer_load_dwordx4 v1, s[4:7], s44 offen offset:0 sc1 lds
buffer_load_dwordx4 v1, s[4:7], s44 offen offset:1024 sc1 lds
buffer_load_dwordx4 v1, s[4:7], s44 offen offset:2048 sc1 lds
s_add_u32 m0, s18, 0xd800
s_add_u32 s44, s50, 0x140d800
buffer_load_dwordx4 v1, s[4:7], s44 offen offset:0 sc1 lds
buffer_load_dwordx4 v1, s[4:7], s44 offen offset:1024 sc1 lds
buffer_load_dwordx4 v1, s[4:7], s44 offen offset:2048 sc1 lds
s_add_u32 m0, s18, 0xf000
s_add_u32 s44, s50, 0x140f000
buffer_load_dwordx4 v1, s[4:7], s44 offen offset:0 sc1 lds
buffer_load_dwordx4 v1, s[4:7], s44 offen offset:1024 sc1 lds
buffer_load_dwordx4 v1, s[4:7], s44 offen offset:2048 sc1 lds
s_add_u32 m0, s18, 0x10800
s_add_u32 s44, s50, 0x1410800
buffer_load_dwordx4 v1, s[4:7], s44 offen offset:0 sc1 lds
buffer_load_dwordx4 v1, s[4:7], s44 offen offset:1024 sc1 lds
buffer_load_dwordx4 v1, s[4:7], s44 offen offset:2048 sc1 lds
s_add_u32 m0, s18, 0x12000
s_add_u32 s44, s50, 0x1412000
buffer_load_dwordx4 v1, s[4:7], s44 offen offset:0 sc1 lds
buffer_load_dwordx4 v1, s[4:7], s44 offen offset:1024 sc1 lds
buffer_load_dwordx4 v1, s[4:7], s44 offen offset:2048 sc1 lds
s_add_u32 m0, s18, 0x13800
s_add_u32 s44, s50, 0x1413800
buffer_load_dwordx4 v1, s[4:7], s44 offen offset:0 sc1 lds
buffer_load_dwordx4 v1, s[4:7], s44 offen offset:1024 sc1 lds
buffer_load_dwordx4 v1, s[4:7], s44 offen offset:2048 sc1 lds
s_add_u32 m0, s18, 0x15000
s_add_u32 s44, s50, 0x1415000
buffer_load_dwordx4 v1, s[4:7], s44 offen offset:0 sc1 lds
buffer_load_dwordx4 v1, s[4:7], s44 offen offset:1024 sc1 lds
buffer_load_dwordx4 v1, s[4:7], s44 offen offset:2048 sc1 lds
s_add_u32 m0, s18, 0x16800
s_add_u32 s44, s50, 0x1416800
buffer_load_dwordx4 v1, s[4:7], s44 offen offset:0 sc1 lds
buffer_load_dwordx4 v1, s[4:7], s44 offen offset:1024 sc1 lds
buffer_load_dwordx4 v1, s[4:7], s44 offen offset:2048 sc1 lds
s_add_u32 m0, s18, 0x18000
s_add_u32 s44, s50, 0x1418000
buffer_load_dwordx4 v1, s[4:7], s44 offen offset:0 sc1 lds
buffer_load_dwordx4 v1, s[4:7], s44 offen offset:1024 sc1 lds
buffer_load_dwordx4 v1, s[4:7], s44 offen offset:2048 sc1 lds
s_add_u32 m0, s18, 0x19800
s_add_u32 s44, s50, 0x1419800
buffer_load_dwordx4 v1, s[4:7], s44 offen offset:0 sc1 lds
buffer_load_dwordx4 v1, s[4:7], s44 offen offset:1024 sc1 lds
buffer_load_dwordx4 v1, s[4:7], s44 offen offset:2048 sc1 lds
s_add_u32 m0, s18, 0x1b000
s_add_u32 s44, s50, 0x141b000
buffer_load_dwordx4 v1, s[4:7], s44 offen offset:0 sc1 lds
buffer_load_dwordx4 v1, s[4:7], s44 offen offset:1024 sc1 lds
buffer_load_dwordx4 v1, s[4:7], s44 offen offset:2048 sc1 lds
Lwd_14:
s_cmp_lg_u32 s28, 0
s_cbranch_scc1 Lpe_16
s_add_u32 s36, s67, 0x40000
s_mov_b32 s37, 0
Lpoll_15:
v_mov_b32 v11, 0
buffer_atomic_add v11, v251, s[4:7], s36 offen sc0 sc1
s_add_u32 s37, s37, 1
s_waitcnt vmcnt(0)
v_readfirstlane_b32 s38, v11
s_nop 0
s_cmp_ge_u32 s38, 32
s_cbranch_scc1 Lpe_16
s_cmp_lt_u32 s37, 0x100000
s_cbranch_scc1 Lpoll_15
Lpe_16:
s_waitcnt vmcnt(36) lgkmcnt(0)
s_cmp_ge_u32 s28, 2
s_cbranch_scc1 Lw_17
s_waitcnt vmcnt(0)
Lw_17:
s_barrier
s_add_u32 s94, s80, 0x80080
s_mov_b32 s35, 0
s_mov_b32 s33, 0x1000
buffer_load_dwordx4 a[0:3], v2, s[40:43], s35 offen offset:0 sc1
buffer_load_dwordx4 a[4:7], v2, s[40:43], s33 offen offset:0 sc1
buffer_load_dwordx4 a[8:11], v2, s[40:43], s35 offen offset:1024 sc1
buffer_load_dwordx4 a[12:15], v2, s[40:43], s33 offen offset:1024 sc1
buffer_load_dwordx4 a[16:19], v2, s[40:43], s35 offen offset:2048 sc1
buffer_load_dwordx4 a[20:23], v2, s[40:43], s33 offen offset:2048 sc1
buffer_load_dwordx4 a[24:27], v2, s[40:43], s35 offen offset:3072 sc1
buffer_load_dwordx4 a[28:31], v2, s[40:43], s33 offen offset:3072 sc1
s_add_u32 s35, s35, 8192
s_add_u32 s33, s33, 8192
buffer_load_dwordx4 a[32:35], v2, s[40:43], s35 offen offset:0 sc1
buffer_load_dwordx4 a[36:39], v2, s[40:43], s33 offen offset:0 sc1
buffer_load_dwordx4 a[40:43], v2, s[40:43], s35 offen offset:1024 sc1
buffer_load_dwordx4 a[44:47], v2, s[40:43], s33 offen offset:1024 sc1
buffer_load_dwordx4 a[48:51], v2, s[40:43], s35 offen offset:2048 sc1
buffer_load_dwordx4 a[52:55], v2, s[40:43], s33 offen offset:2048 sc1
buffer_load_dwordx4 a[56:59], v2, s[40:43], s35 offen offset:3072 sc1
buffer_load_dwordx4 a[60:63], v2, s[40:43], s33 offen offset:3072 sc1
s_add_u32 s35, s35, 8192
s_add_u32 s33, s33, 8192
v_add_u32 v5, 0, v1
ds_read_b128 a[96:99], v5 offset:2048
ds_read_b128 a[100:103], v5 offset:8192
ds_read_b128 a[104:107], v5 offset:3072
ds_read_b128 a[108:111], v5 offset:9216
ds_read_b128 a[112:115], v5 offset:4096
ds_read_b128 a[116:119], v5 offset:10240
s_waitcnt vmcnt(14) lgkmcnt(4)
v_mfma_f32_16x16x32_bf16 v[140:143], a[96:99], a[0:3], 0
v_and_b32 v232, 15, v0
v_lshlrev_b32 v232, 7, v232
v_mfma_f32_16x16x32_bf16 v[140:143], a[100:103], a[4:7], v[140:143]
buffer_load_dwordx4 a[64:67], v2, s[40:43], s35 offen offset:0 sc1
s_waitcnt vmcnt(13)
v_mfma_f32_16x16x32_bf16 v[164:167], a[100:103], a[12:15], 0
v_lshrrev_b32 v233, 4, v0
v_lshlrev_b32 v233, 4, v233
v_mfma_f32_16x16x32_bf16 v[164:167], a[96:99], a[8:11], v[164:167]
v_add_u32 v232, v233, v232
s_mul_i32 s38, s30, 12288
s_waitcnt vmcnt(12)
v_mfma_f32_16x16x32_bf16 v[188:191], a[96:99], a[16:19], 0
s_add_u32 s38, s38, 0x380000
s_add_u32 s39, s28, 4
s_min_u32 s39, s39, 5
s_waitcnt vmcnt(11)
v_mfma_f32_16x16x32_bf16 v[188:191], a[100:103], a[20:23], v[188:191]
buffer_load_dwordx4 a[68:71], v2, s[40:43], s33 offen offset:0 sc1
s_lshl_b32 s36, s28, 11
s_waitcnt vmcnt(10)
v_mfma_f32_16x16x32_bf16 v[212:215], a[100:103], a[28:31], 0
s_add_u32 s36, s36, s38
s_lshl_b32 s37, s39, 11
s_add_u32 s37, s37, s38
v_mfma_f32_16x16x32_bf16 v[212:215], a[96:99], a[24:27], v[212:215]
ds_read_b128 a[128:131], v5 offset:5120
s_waitcnt lgkmcnt(4)
v_mfma_f32_16x16x32_bf16 v[216:219], a[104:107], a[24:27], 0
ds_read_b128 a[132:135], v5 offset:11264
s_waitcnt lgkmcnt(4)
v_mfma_f32_16x16x32_bf16 v[216:219], a[108:111], a[28:31], v[216:219]
ds_read_b128 a[136:139], v5 offset:0
v_mfma_f32_16x16x32_bf16 v[192:195], a[108:111], a[20:23], 0
buffer_load_dwordx4 v[48:51], v232, s[4:7], s36 offen sc1
v_mfma_f32_16x16x32_bf16 v[192:195], a[104:107], a[16:19], v[192:195]
ds_read_b128 a[140:143], v5 offset:6144
v_mfma_f32_16x16x32_bf16 v[168:171], a[104:107], a[8:11], 0
ds_read_b128 a[144:147], v5 offset:1024
v_mfma_f32_16x16x32_bf16 v[168:171], a[108:111], a[12:15], v[168:171]
ds_read_b128 a[148:151], v5 offset:7168
v_mfma_f32_16x16x32_bf16 v[144:147], a[108:111], a[4:7], 0
v_mfma_f32_16x16x32_bf16 v[144:147], a[104:107], a[0:3], v[144:147]
buffer_load_dwordx4 a[72:75], v2, s[40:43], s35 offen offset:1024 sc1
s_waitcnt lgkmcnt(7)
v_mfma_f32_16x16x32_bf16 v[148:151], a[112:115], a[0:3], 0
s_waitcnt lgkmcnt(6)
v_mfma_f32_16x16x32_bf16 v[148:151], a[116:119], a[4:7], v[148:151]
v_mfma_f32_16x16x32_bf16 v[172:175], a[116:119], a[12:15], 0
v_mfma_f32_16x16x32_bf16 v[172:175], a[112:115], a[8:11], v[172:175]
v_mfma_f32_16x16x32_bf16 v[196:199], a[112:115], a[16:19], 0
buffer_load_dwordx4 a[76:79], v2, s[40:43], s33 offen offset:1024 sc1
v_mfma_f32_16x16x32_bf16 v[196:199], a[116:119], a[20:23], v[196:199]
v_mfma_f32_16x16x32_bf16 v[220:223], a[116:119], a[28:31], 0
v_mfma_f32_16x16x32_bf16 v[220:223], a[112:115], a[24:27], v[220:223]
s_waitcnt lgkmcnt(0)
v_mfma_f32_16x16x32_bf16 v[224:227], a[128:131], a[24:27], 0
ds_read_b128 a[96:99], v5 offset:14336
v_mfma_f32_16x16x32_bf16 v[224:227], a[132:135], a[28:31], v[224:227]
buffer_load_dwordx4 a[80:83], v2, s[40:43], s35 offen offset:2048 sc1
v_mfma_f32_16x16x32_bf16 v[200:203], a[132:135], a[20:23], 0
ds_read_b128 a[100:103], v5 offset:20480
v_mfma_f32_16x16x32_bf16 v[200:203], a[128:131], a[16:19], v[200:203]
v_mfma_f32_16x16x32_bf16 v[176:179], a[128:131], a[8:11], 0
v_mfma_f32_16x16x32_bf16 v[176:179], a[132:135], a[12:15], v[176:179]
buffer_load_dwordx4 a[84:87], v2, s[40:43], s33 offen offset:2048 sc1
v_mfma_f32_16x16x32_bf16 v[152:155], a[132:135], a[4:7], 0
ds_read_b128 a[104:107], v5 offset:15360
v_mfma_f32_16x16x32_bf16 v[152:155], a[128:131], a[0:3], v[152:155]
v_mfma_f32_16x16x32_bf16 v[132:135], a[136:139], a[0:3], 0
ds_read_b128 a[108:111], v5 offset:21504
v_mfma_f32_16x16x32_bf16 v[132:135], a[140:143], a[4:7], v[132:135]
v_mfma_f32_16x16x32_bf16 v[156:159], a[140:143], a[12:15], 0
buffer_load_dwordx4 v[52:55], v232, s[4:7], s37 offen sc1
s_add_u32 m0, s18, 0x1e000
v_mfma_f32_16x16x32_bf16 v[156:159], a[136:139], a[8:11], v[156:159]
s_add_u32 s44, s50, 0x141e000
ds_read_b128 a[112:115], v5 offset:16384
v_mfma_f32_16x16x32_bf16 v[180:183], a[136:139], a[16:19], 0
v_mfma_f32_16x16x32_bf16 v[180:183], a[140:143], a[20:23], v[180:183]
ds_read_b128 a[116:119], v5 offset:22528
v_mfma_f32_16x16x32_bf16 v[204:207], a[140:143], a[28:31], 0
v_mfma_f32_16x16x32_bf16 v[204:207], a[136:139], a[24:27], v[204:207]
buffer_load_dwordx4 a[88:91], v2, s[40:43], s35 offen offset:3072 sc1
v_mfma_f32_16x16x32_bf16 v[208:211], a[144:147], a[24:27], 0
v_mfma_f32_16x16x32_bf16 v[208:211], a[148:151], a[28:31], v[208:211]
v_mfma_f32_16x16x32_bf16 v[184:187], a[148:151], a[20:23], 0
v_mfma_f32_16x16x32_bf16 v[184:187], a[144:147], a[16:19], v[184:187]
v_mfma_f32_16x16x32_bf16 v[160:163], a[144:147], a[8:11], 0
buffer_load_dwordx4 a[92:95], v2, s[40:43], s33 offen offset:3072 sc1
s_add_u32 s35, s35, 8192
v_mfma_f32_16x16x32_bf16 v[160:163], a[148:151], a[12:15], v[160:163]
s_add_u32 s33, s33, 8192
v_mfma_f32_16x16x32_bf16 v[136:139], a[148:151], a[4:7], 0
v_mfma_f32_16x16x32_bf16 v[136:139], a[144:147], a[0:3], v[136:139]
s_waitcnt vmcnt(10) lgkmcnt(0)
v_mfma_f32_16x16x32_bf16 v[140:143], a[96:99], a[32:35], v[140:143]
ds_read_b128 a[128:131], v5 offset:17408
v_mfma_f32_16x16x32_bf16 v[140:143], a[100:103], a[36:39], v[140:143]
buffer_load_dwordx4 a[0:3], v2, s[40:43], s35 offen offset:0 sc1
v_mfma_f32_16x16x32_bf16 v[164:167], a[100:103], a[44:47], v[164:167]
ds_read_b128 a[132:135], v5 offset:23552
v_mfma_f32_16x16x32_bf16 v[164:167], a[96:99], a[40:43], v[164:167]
v_mfma_f32_16x16x32_bf16 v[188:191], a[96:99], a[48:51], v[188:191]
v_mfma_f32_16x16x32_bf16 v[188:191], a[100:103], a[52:55], v[188:191]
buffer_load_dwordx4 a[4:7], v2, s[40:43], s33 offen offset:0 sc1
v_mfma_f32_16x16x32_bf16 v[212:215], a[100:103], a[60:63], v[212:215]
ds_read_b128 a[136:139], v5 offset:12288
v_mfma_f32_16x16x32_bf16 v[212:215], a[96:99], a[56:59], v[212:215]
v_mfma_f32_16x16x32_bf16 v[216:219], a[104:107], a[56:59], v[216:219]
ds_read_b128 a[140:143], v5 offset:18432
v_mfma_f32_16x16x32_bf16 v[216:219], a[108:111], a[60:63], v[216:219]
v_mfma_f32_16x16x32_bf16 v[192:195], a[108:111], a[52:55], v[192:195]
buffer_load_dwordx4 v1, s[4:7], s44 offen offset:0 sc1 lds
v_mfma_f32_16x16x32_bf16 v[192:195], a[104:107], a[48:51], v[192:195]
ds_read_b128 a[144:147], v5 offset:13312
v_mfma_f32_16x16x32_bf16 v[168:171], a[104:107], a[40:43], v[168:171]
v_mfma_f32_16x16x32_bf16 v[168:171], a[108:111], a[44:47], v[168:171]
ds_read_b128 a[148:151], v5 offset:19456
v_mfma_f32_16x16x32_bf16 v[144:147], a[108:111], a[36:39], v[144:147]
v_mfma_f32_16x16x32_bf16 v[144:147], a[104:107], a[32:35], v[144:147]
buffer_load_dwordx4 a[8:11], v2, s[40:43], s35 offen offset:1024 sc1
v_mfma_f32_16x16x32_bf16 v[148:151], a[112:115], a[32:35], v[148:151]
v_mfma_f32_16x16x32_bf16 v[148:151], a[116:119], a[36:39], v[148:151]
v_mfma_f32_16x16x32_bf16 v[172:175], a[116:119], a[44:47], v[172:175]
v_mfma_f32_16x16x32_bf16 v[172:175], a[112:115], a[40:43], v[172:175]
v_mfma_f32_16x16x32_bf16 v[196:199], a[112:115], a[48:51], v[196:199]
buffer_load_dwordx4 a[12:15], v2, s[40:43], s33 offen offset:1024 sc1
v_mfma_f32_16x16x32_bf16 v[196:199], a[116:119], a[52:55], v[196:199]
v_mfma_f32_16x16x32_bf16 v[220:223], a[116:119], a[60:63], v[220:223]
v_mfma_f32_16x16x32_bf16 v[220:223], a[112:115], a[56:59], v[220:223]
s_waitcnt lgkmcnt(0)
v_mfma_f32_16x16x32_bf16 v[224:227], a[128:131], a[56:59], v[224:227]
ds_read_b128 a[96:99], v5 offset:26624
v_mfma_f32_16x16x32_bf16 v[224:227], a[132:135], a[60:63], v[224:227]
buffer_load_dwordx4 a[16:19], v2, s[40:43], s35 offen offset:2048 sc1
v_mfma_f32_16x16x32_bf16 v[200:203], a[132:135], a[52:55], v[200:203]
ds_read_b128 a[100:103], v5 offset:32768
v_mfma_f32_16x16x32_bf16 v[200:203], a[128:131], a[48:51], v[200:203]
v_mfma_f32_16x16x32_bf16 v[176:179], a[128:131], a[40:43], v[176:179]
v_mfma_f32_16x16x32_bf16 v[176:179], a[132:135], a[44:47], v[176:179]
buffer_load_dwordx4 a[20:23], v2, s[40:43], s33 offen offset:2048 sc1
v_mfma_f32_16x16x32_bf16 v[152:155], a[132:135], a[36:39], v[152:155]
ds_read_b128 a[104:107], v5 offset:27648
v_mfma_f32_16x16x32_bf16 v[152:155], a[128:131], a[32:35], v[152:155]
v_mfma_f32_16x16x32_bf16 v[132:135], a[136:139], a[32:35], v[132:135]
ds_read_b128 a[108:111], v5 offset:33792
v_mfma_f32_16x16x32_bf16 v[132:135], a[140:143], a[36:39], v[132:135]
v_mfma_f32_16x16x32_bf16 v[156:159], a[140:143], a[44:47], v[156:159]
buffer_load_dwordx4 v1, s[4:7], s44 offen offset:1024 sc1 lds
v_mfma_f32_16x16x32_bf16 v[156:159], a[136:139], a[40:43], v[156:159]
ds_read_b128 a[112:115], v5 offset:28672
v_mfma_f32_16x16x32_bf16 v[180:183], a[136:139], a[48:51], v[180:183]
v_mfma_f32_16x16x32_bf16 v[180:183], a[140:143], a[52:55], v[180:183]
ds_read_b128 a[116:119], v5 offset:34816
v_mfma_f32_16x16x32_bf16 v[204:207], a[140:143], a[60:63], v[204:207]
v_mfma_f32_16x16x32_bf16 v[204:207], a[136:139], a[56:59], v[204:207]
buffer_load_dwordx4 a[24:27], v2, s[40:43], s35 offen offset:3072 sc1
v_mfma_f32_16x16x32_bf16 v[208:211], a[144:147], a[56:59], v[208:211]
v_mfma_f32_16x16x32_bf16 v[208:211], a[148:151], a[60:63], v[208:211]
v_mfma_f32_16x16x32_bf16 v[184:187], a[148:151], a[52:55], v[184:187]
v_mfma_f32_16x16x32_bf16 v[184:187], a[144:147], a[48:51], v[184:187]
v_mfma_f32_16x16x32_bf16 v[160:163], a[144:147], a[40:43], v[160:163]
buffer_load_dwordx4 a[28:31], v2, s[40:43], s33 offen offset:3072 sc1
s_add_u32 s35, s35, 8192
v_mfma_f32_16x16x32_bf16 v[160:163], a[148:151], a[44:47], v[160:163]
s_add_u32 s33, s33, 8192
v_mfma_f32_16x16x32_bf16 v[136:139], a[148:151], a[36:39], v[136:139]
v_mfma_f32_16x16x32_bf16 v[136:139], a[144:147], a[32:35], v[136:139]
s_waitcnt vmcnt(10) lgkmcnt(0)
v_mfma_f32_16x16x32_bf16 v[140:143], a[96:99], a[64:67], v[140:143]
ds_read_b128 a[128:131], v5 offset:29696
v_mfma_f32_16x16x32_bf16 v[140:143], a[100:103], a[68:71], v[140:143]
buffer_load_dwordx4 a[32:35], v2, s[40:43], s35 offen offset:0 sc1
v_mfma_f32_16x16x32_bf16 v[164:167], a[100:103], a[76:79], v[164:167]
ds_read_b128 a[132:135], v5 offset:35840
v_mfma_f32_16x16x32_bf16 v[164:167], a[96:99], a[72:75], v[164:167]
v_mfma_f32_16x16x32_bf16 v[188:191], a[96:99], a[80:83], v[188:191]
v_mfma_f32_16x16x32_bf16 v[188:191], a[100:103], a[84:87], v[188:191]
buffer_load_dwordx4 a[36:39], v2, s[40:43], s33 offen offset:0 sc1
v_mfma_f32_16x16x32_bf16 v[212:215], a[100:103], a[92:95], v[212:215]
ds_read_b128 a[136:139], v5 offset:24576
v_mfma_f32_16x16x32_bf16 v[212:215], a[96:99], a[88:91], v[212:215]
v_mfma_f32_16x16x32_bf16 v[216:219], a[104:107], a[88:91], v[216:219]
ds_read_b128 a[140:143], v5 offset:30720
v_mfma_f32_16x16x32_bf16 v[216:219], a[108:111], a[92:95], v[216:219]
v_mfma_f32_16x16x32_bf16 v[192:195], a[108:111], a[84:87], v[192:195]
buffer_load_dwordx4 v1, s[4:7], s44 offen offset:2048 sc1 lds
s_add_u32 m0, s18, 0x21000
v_mfma_f32_16x16x32_bf16 v[192:195], a[104:107], a[80:83], v[192:195]
s_add_u32 s44, s50, 0x1421000
ds_read_b128 a[144:147], v5 offset:25600
v_mfma_f32_16x16x32_bf16 v[168:171], a[104:107], a[72:75], v[168:171]
v_mfma_f32_16x16x32_bf16 v[168:171], a[108:111], a[76:79], v[168:171]
ds_read_b128 a[148:151], v5 offset:31744
v_mfma_f32_16x16x32_bf16 v[144:147], a[108:111], a[68:71], v[144:147]
v_mfma_f32_16x16x32_bf16 v[144:147], a[104:107], a[64:67], v[144:147]
buffer_load_dwordx4 a[40:43], v2, s[40:43], s35 offen offset:1024 sc1
v_mfma_f32_16x16x32_bf16 v[148:151], a[112:115], a[64:67], v[148:151]
v_mfma_f32_16x16x32_bf16 v[148:151], a[116:119], a[68:71], v[148:151]
v_mfma_f32_16x16x32_bf16 v[172:175], a[116:119], a[76:79], v[172:175]
v_mfma_f32_16x16x32_bf16 v[172:175], a[112:115], a[72:75], v[172:175]
v_mfma_f32_16x16x32_bf16 v[196:199], a[112:115], a[80:83], v[196:199]
buffer_load_dwordx4 a[44:47], v2, s[40:43], s33 offen offset:1024 sc1
v_mfma_f32_16x16x32_bf16 v[196:199], a[116:119], a[84:87], v[196:199]
v_mfma_f32_16x16x32_bf16 v[220:223], a[116:119], a[92:95], v[220:223]
v_mfma_f32_16x16x32_bf16 v[220:223], a[112:115], a[88:91], v[220:223]
s_waitcnt lgkmcnt(0)
v_mfma_f32_16x16x32_bf16 v[224:227], a[128:131], a[88:91], v[224:227]
ds_read_b128 a[96:99], v5 offset:38912
v_mfma_f32_16x16x32_bf16 v[224:227], a[132:135], a[92:95], v[224:227]
buffer_load_dwordx4 a[48:51], v2, s[40:43], s35 offen offset:2048 sc1
v_mfma_f32_16x16x32_bf16 v[200:203], a[132:135], a[84:87], v[200:203]
ds_read_b128 a[100:103], v5 offset:45056
v_mfma_f32_16x16x32_bf16 v[200:203], a[128:131], a[80:83], v[200:203]
v_mfma_f32_16x16x32_bf16 v[176:179], a[128:131], a[72:75], v[176:179]
v_mfma_f32_16x16x32_bf16 v[176:179], a[132:135], a[76:79], v[176:179]
buffer_load_dwordx4 v1, s[4:7], s44 offen offset:0 sc1 lds
v_mfma_f32_16x16x32_bf16 v[152:155], a[132:135], a[68:71], v[152:155]
ds_read_b128 a[104:107], v5 offset:39936
v_mfma_f32_16x16x32_bf16 v[152:155], a[128:131], a[64:67], v[152:155]
v_mfma_f32_16x16x32_bf16 v[132:135], a[136:139], a[64:67], v[132:135]
ds_read_b128 a[108:111], v5 offset:46080
v_mfma_f32_16x16x32_bf16 v[132:135], a[140:143], a[68:71], v[132:135]
buffer_load_dwordx4 a[52:55], v2, s[40:43], s33 offen offset:2048 sc1
v_mfma_f32_16x16x32_bf16 v[156:159], a[140:143], a[76:79], v[156:159]
ds_read_b128 a[112:115], v5 offset:40960
v_mfma_f32_16x16x32_bf16 v[156:159], a[136:139], a[72:75], v[156:159]
v_mfma_f32_16x16x32_bf16 v[180:183], a[136:139], a[80:83], v[180:183]
v_mfma_f32_16x16x32_bf16 v[180:183], a[140:143], a[84:87], v[180:183]
buffer_load_dwordx4 a[56:59], v2, s[40:43], s35 offen offset:3072 sc1
v_mfma_f32_16x16x32_bf16 v[204:207], a[140:143], a[92:95], v[204:207]
ds_read_b128 a[116:119], v5 offset:47104
v_mfma_f32_16x16x32_bf16 v[204:207], a[136:139], a[88:91], v[204:207]
v_mfma_f32_16x16x32_bf16 v[208:211], a[144:147], a[88:91], v[208:211]
v_mfma_f32_16x16x32_bf16 v[208:211], a[148:151], a[92:95], v[208:211]
buffer_load_dwordx4 v1, s[4:7], s44 offen offset:1024 sc1 lds
v_mfma_f32_16x16x32_bf16 v[184:187], a[148:151], a[84:87], v[184:187]
v_mfma_f32_16x16x32_bf16 v[184:187], a[144:147], a[80:83], v[184:187]
v_mfma_f32_16x16x32_bf16 v[160:163], a[144:147], a[72:75], v[160:163]
v_mfma_f32_16x16x32_bf16 v[160:163], a[148:151], a[76:79], v[160:163]
buffer_load_dwordx4 a[60:63], v2, s[40:43], s33 offen offset:3072 sc1
s_add_u32 s35, s35, 8192
v_mfma_f32_16x16x32_bf16 v[136:139], a[148:151], a[68:71], v[136:139]
s_add_u32 s33, s33, 8192
v_mfma_f32_16x16x32_bf16 v[136:139], a[144:147], a[64:67], v[136:139]
s_waitcnt vmcnt(11) lgkmcnt(0)
v_mfma_f32_16x16x32_bf16 v[140:143], a[96:99], a[0:3], v[140:143]
ds_read_b128 a[128:131], v5 offset:41984
v_mfma_f32_16x16x32_bf16 v[140:143], a[100:103], a[4:7], v[140:143]
buffer_load_dwordx4 a[64:67], v2, s[40:43], s35 offen offset:0 sc1
v_mfma_f32_16x16x32_bf16 v[164:167], a[100:103], a[12:15], v[164:167]
ds_read_b128 a[132:135], v5 offset:48128
v_mfma_f32_16x16x32_bf16 v[164:167], a[96:99], a[8:11], v[164:167]
v_mfma_f32_16x16x32_bf16 v[188:191], a[96:99], a[16:19], v[188:191]
v_mfma_f32_16x16x32_bf16 v[188:191], a[100:103], a[20:23], v[188:191]
buffer_load_dwordx4 a[68:71], v2, s[40:43], s33 offen offset:0 sc1
v_mfma_f32_16x16x32_bf16 v[212:215], a[100:103], a[28:31], v[212:215]
ds_read_b128 a[136:139], v5 offset:36864
v_mfma_f32_16x16x32_bf16 v[212:215], a[96:99], a[24:27], v[212:215]
v_mfma_f32_16x16x32_bf16 v[216:219], a[104:107], a[24:27], v[216:219]
ds_read_b128 a[140:143], v5 offset:43008
v_mfma_f32_16x16x32_bf16 v[216:219], a[108:111], a[28:31], v[216:219]
v_mfma_f32_16x16x32_bf16 v[192:195], a[108:111], a[20:23], v[192:195]
buffer_load_dwordx4 v1, s[4:7], s44 offen offset:2048 sc1 lds
s_add_u32 s88, s82, 0x240000
v_mfma_f32_16x16x32_bf16 v[192:195], a[104:107], a[16:19], v[192:195]
ds_read_b128 a[144:147], v5 offset:37888
v_mfma_f32_16x16x32_bf16 v[168:171], a[104:107], a[8:11], v[168:171]
v_mfma_f32_16x16x32_bf16 v[168:171], a[108:111], a[12:15], v[168:171]
ds_read_b128 a[148:151], v5 offset:44032
v_mfma_f32_16x16x32_bf16 v[144:147], a[108:111], a[4:7], v[144:147]
v_mfma_f32_16x16x32_bf16 v[144:147], a[104:107], a[0:3], v[144:147]
buffer_load_dwordx4 a[72:75], v2, s[40:43], s35 offen offset:1024 sc1
v_mfma_f32_16x16x32_bf16 v[148:151], a[112:115], a[0:3], v[148:151]
v_mfma_f32_16x16x32_bf16 v[148:151], a[116:119], a[4:7], v[148:151]
v_mfma_f32_16x16x32_bf16 v[172:175], a[116:119], a[12:15], v[172:175]
v_mfma_f32_16x16x32_bf16 v[172:175], a[112:115], a[8:11], v[172:175]
v_mfma_f32_16x16x32_bf16 v[196:199], a[112:115], a[16:19], v[196:199]
buffer_load_dwordx4 a[76:79], v2, s[40:43], s33 offen offset:1024 sc1
v_mfma_f32_16x16x32_bf16 v[196:199], a[116:119], a[20:23], v[196:199]
v_mfma_f32_16x16x32_bf16 v[220:223], a[116:119], a[28:31], v[220:223]
v_mfma_f32_16x16x32_bf16 v[220:223], a[112:115], a[24:27], v[220:223]
s_waitcnt lgkmcnt(0)
s_barrier
v_mfma_f32_16x16x32_bf16 v[224:227], a[128:131], a[24:27], v[224:227]
v_add_u32 v5, 49152, v1
v_mfma_f32_16x16x32_bf16 v[224:227], a[132:135], a[28:31], v[224:227]
buffer_load_dwordx4 a[80:83], v2, s[40:43], s35 offen offset:2048 sc1
v_mfma_f32_16x16x32_bf16 v[200:203], a[132:135], a[20:23], v[200:203]
ds_read_b128 a[96:99], v5 offset:2048
v_mfma_f32_16x16x32_bf16 v[200:203], a[128:131], a[16:19], v[200:203]
ds_read_b128 a[100:103], v5 offset:8192
v_mfma_f32_16x16x32_bf16 v[176:179], a[128:131], a[8:11], v[176:179]
v_mfma_f32_16x16x32_bf16 v[176:179], a[132:135], a[12:15], v[176:179]
buffer_load_dwordx4 a[84:87], v2, s[40:43], s33 offen offset:2048 sc1
v_mfma_f32_16x16x32_bf16 v[152:155], a[132:135], a[4:7], v[152:155]
ds_read_b128 a[104:107], v5 offset:3072
v_mfma_f32_16x16x32_bf16 v[152:155], a[128:131], a[0:3], v[152:155]
v_mfma_f32_16x16x32_bf16 v[132:135], a[136:139], a[0:3], v[132:135]
ds_read_b128 a[108:111], v5 offset:9216
v_mfma_f32_16x16x32_bf16 v[132:135], a[140:143], a[4:7], v[132:135]
v_mfma_f32_16x16x32_bf16 v[156:159], a[140:143], a[12:15], v[156:159]
buffer_load_dwordx4 v[92:95], v1, s[4:7], s88 offen offset:0 sc1
v_mfma_f32_16x16x32_bf16 v[156:159], a[136:139], a[8:11], v[156:159]
ds_read_b128 a[112:115], v5 offset:4096
v_mfma_f32_16x16x32_bf16 v[180:183], a[136:139], a[16:19], v[180:183]
v_mfma_f32_16x16x32_bf16 v[180:183], a[140:143], a[20:23], v[180:183]
ds_read_b128 a[116:119], v5 offset:10240
v_mfma_f32_16x16x32_bf16 v[204:207], a[140:143], a[28:31], v[204:207]
v_mfma_f32_16x16x32_bf16 v[204:207], a[136:139], a[24:27], v[204:207]
buffer_load_dwordx4 a[88:91], v2, s[40:43], s35 offen offset:3072 sc1
v_mfma_f32_16x16x32_bf16 v[208:211], a[144:147], a[24:27], v[208:211]
v_mfma_f32_16x16x32_bf16 v[208:211], a[148:151], a[28:31], v[208:211]
v_mfma_f32_16x16x32_bf16 v[184:187], a[148:151], a[20:23], v[184:187]
v_mfma_f32_16x16x32_bf16 v[184:187], a[144:147], a[16:19], v[184:187]
v_mfma_f32_16x16x32_bf16 v[160:163], a[144:147], a[8:11], v[160:163]
buffer_load_dwordx4 a[92:95], v2, s[40:43], s33 offen offset:3072 sc1
s_add_u32 s35, s35, 8192
v_mfma_f32_16x16x32_bf16 v[160:163], a[148:151], a[12:15], v[160:163]
s_add_u32 s33, s33, 8192
v_mfma_f32_16x16x32_bf16 v[136:139], a[148:151], a[4:7], v[136:139]
v_mfma_f32_16x16x32_bf16 v[136:139], a[144:147], a[0:3], v[136:139]
s_waitcnt vmcnt(10) lgkmcnt(0)
v_mfma_f32_16x16x32_bf16 v[140:143], a[96:99], a[32:35], v[140:143]
ds_read_b128 a[128:131], v5 offset:5120
v_mfma_f32_16x16x32_bf16 v[140:143], a[100:103], a[36:39], v[140:143]
buffer_load_dwordx4 a[0:3], v2, s[40:43], s35 offen offset:0 sc1
v_mfma_f32_16x16x32_bf16 v[164:167], a[100:103], a[44:47], v[164:167]
ds_read_b128 a[132:135], v5 offset:11264
v_mfma_f32_16x16x32_bf16 v[164:167], a[96:99], a[40:43], v[164:167]
v_mfma_f32_16x16x32_bf16 v[188:191], a[96:99], a[48:51], v[188:191]
v_mfma_f32_16x16x32_bf16 v[188:191], a[100:103], a[52:55], v[188:191]
buffer_load_dwordx4 a[4:7], v2, s[40:43], s33 offen offset:0 sc1
v_mfma_f32_16x16x32_bf16 v[212:215], a[100:103], a[60:63], v[212:215]
ds_read_b128 a[136:139], v5 offset:0
v_mfma_f32_16x16x32_bf16 v[212:215], a[96:99], a[56:59], v[212:215]
v_mfma_f32_16x16x32_bf16 v[216:219], a[104:107], a[56:59], v[216:219]
ds_read_b128 a[140:143], v5 offset:6144
v_mfma_f32_16x16x32_bf16 v[216:219], a[108:111], a[60:63], v[216:219]
v_mfma_f32_16x16x32_bf16 v[192:195], a[108:111], a[52:55], v[192:195]
buffer_load_dwordx4 v[96:99], v1, s[4:7], s88 offen offset:1024 sc1
v_mfma_f32_16x16x32_bf16 v[192:195], a[104:107], a[48:51], v[192:195]
ds_read_b128 a[144:147], v5 offset:1024
v_mfma_f32_16x16x32_bf16 v[168:171], a[104:107], a[40:43], v[168:171]
v_mfma_f32_16x16x32_bf16 v[168:171], a[108:111], a[44:47], v[168:171]
ds_read_b128 a[148:151], v5 offset:7168
v_mfma_f32_16x16x32_bf16 v[144:147], a[108:111], a[36:39], v[144:147]
v_mfma_f32_16x16x32_bf16 v[144:147], a[104:107], a[32:35], v[144:147]
buffer_load_dwordx4 a[8:11], v2, s[40:43], s35 offen offset:1024 sc1
v_mfma_f32_16x16x32_bf16 v[148:151], a[112:115], a[32:35], v[148:151]
v_mfma_f32_16x16x32_bf16 v[148:151], a[116:119], a[36:39], v[148:151]
v_mfma_f32_16x16x32_bf16 v[172:175], a[116:119], a[44:47], v[172:175]
v_mfma_f32_16x16x32_bf16 v[172:175], a[112:115], a[40:43], v[172:175]
v_mfma_f32_16x16x32_bf16 v[196:199], a[112:115], a[48:51], v[196:199]
buffer_load_dwordx4 a[12:15], v2, s[40:43], s33 offen offset:1024 sc1
v_mfma_f32_16x16x32_bf16 v[196:199], a[116:119], a[52:55], v[196:199]
v_mfma_f32_16x16x32_bf16 v[220:223], a[116:119], a[60:63], v[220:223]
v_mfma_f32_16x16x32_bf16 v[220:223], a[112:115], a[56:59], v[220:223]
s_waitcnt lgkmcnt(0)
v_mfma_f32_16x16x32_bf16 v[224:227], a[128:131], a[56:59], v[224:227]
ds_read_b128 a[96:99], v5 offset:14336
v_mfma_f32_16x16x32_bf16 v[224:227], a[132:135], a[60:63], v[224:227]
buffer_load_dwordx4 a[16:19], v2, s[40:43], s35 offen offset:2048 sc1
v_mfma_f32_16x16x32_bf16 v[200:203], a[132:135], a[52:55], v[200:203]
ds_read_b128 a[100:103], v5 offset:20480
v_mfma_f32_16x16x32_bf16 v[200:203], a[128:131], a[48:51], v[200:203]
v_mfma_f32_16x16x32_bf16 v[176:179], a[128:131], a[40:43], v[176:179]
v_mfma_f32_16x16x32_bf16 v[176:179], a[132:135], a[44:47], v[176:179]
buffer_load_dwordx4 a[20:23], v2, s[40:43], s33 offen offset:2048 sc1
v_mfma_f32_16x16x32_bf16 v[152:155], a[132:135], a[36:39], v[152:155]
ds_read_b128 a[104:107], v5 offset:15360
v_mfma_f32_16x16x32_bf16 v[152:155], a[128:131], a[32:35], v[152:155]
v_mfma_f32_16x16x32_bf16 v[132:135], a[136:139], a[32:35], v[132:135]
ds_read_b128 a[108:111], v5 offset:21504
v_mfma_f32_16x16x32_bf16 v[132:135], a[140:143], a[36:39], v[132:135]
v_mfma_f32_16x16x32_bf16 v[156:159], a[140:143], a[44:47], v[156:159]
buffer_load_dwordx4 v[100:103], v1, s[4:7], s88 offen offset:2048 sc1
v_mfma_f32_16x16x32_bf16 v[156:159], a[136:139], a[40:43], v[156:159]
ds_read_b128 a[112:115], v5 offset:16384
v_mfma_f32_16x16x32_bf16 v[180:183], a[136:139], a[48:51], v[180:183]
v_mfma_f32_16x16x32_bf16 v[180:183], a[140:143], a[52:55], v[180:183]
ds_read_b128 a[116:119], v5 offset:22528
v_mfma_f32_16x16x32_bf16 v[204:207], a[140:143], a[60:63], v[204:207]
v_mfma_f32_16x16x32_bf16 v[204:207], a[136:139], a[56:59], v[204:207]
buffer_load_dwordx4 a[24:27], v2, s[40:43], s35 offen offset:3072 sc1
v_mfma_f32_16x16x32_bf16 v[208:211], a[144:147], a[56:59], v[208:211]
v_mfma_f32_16x16x32_bf16 v[208:211], a[148:151], a[60:63], v[208:211]
v_mfma_f32_16x16x32_bf16 v[184:187], a[148:151], a[52:55], v[184:187]
v_mfma_f32_16x16x32_bf16 v[184:187], a[144:147], a[48:51], v[184:187]
v_mfma_f32_16x16x32_bf16 v[160:163], a[144:147], a[40:43], v[160:163]
buffer_load_dwordx4 a[28:31], v2, s[40:43], s33 offen offset:3072 sc1
s_add_u32 s35, s35, 8192
v_mfma_f32_16x16x32_bf16 v[160:163], a[148:151], a[44:47], v[160:163]
s_add_u32 s33, s33, 8192
v_mfma_f32_16x16x32_bf16 v[136:139], a[148:151], a[36:39], v[136:139]
v_mfma_f32_16x16x32_bf16 v[136:139], a[144:147], a[32:35], v[136:139]
s_waitcnt vmcnt(10) lgkmcnt(0)
v_mfma_f32_16x16x32_bf16 v[140:143], a[96:99], a[64:67], v[140:143]
ds_read_b128 a[128:131], v5 offset:17408
v_mfma_f32_16x16x32_bf16 v[140:143], a[100:103], a[68:71], v[140:143]
buffer_load_dwordx4 a[32:35], v2, s[40:43], s35 offen offset:0 sc1
v_mfma_f32_16x16x32_bf16 v[164:167], a[100:103], a[76:79], v[164:167]
ds_read_b128 a[132:135], v5 offset:23552
v_mfma_f32_16x16x32_bf16 v[164:167], a[96:99], a[72:75], v[164:167]
L_stub5:
s_cbranch_execz L_stub6
v_mfma_f32_16x16x32_bf16 v[188:191], a[96:99], a[80:83], v[188:191]
v_mfma_f32_16x16x32_bf16 v[188:191], a[100:103], a[84:87], v[188:191]
buffer_load_dwordx4 a[36:39], v2, s[40:43], s33 offen offset:0 sc1
v_mfma_f32_16x16x32_bf16 v[212:215], a[100:103], a[92:95], v[212:215]
ds_read_b128 a[136:139], v5 offset:12288
v_mfma_f32_16x16x32_bf16 v[212:215], a[96:99], a[88:91], v[212:215]
v_mfma_f32_16x16x32_bf16 v[216:219], a[104:107], a[88:91], v[216:219]
ds_read_b128 a[140:143], v5 offset:18432
v_mfma_f32_16x16x32_bf16 v[216:219], a[108:111], a[92:95], v[216:219]
v_mfma_f32_16x16x32_bf16 v[192:195], a[108:111], a[84:87], v[192:195]
buffer_load_dwordx4 v[104:107], v1, s[4:7], s88 offen offset:3072 sc1
s_add_u32 s88, s88, 4096
v_mfma_f32_16x16x32_bf16 v[192:195], a[104:107], a[80:83], v[192:195]
ds_read_b128 a[144:147], v5 offset:13312
v_mfma_f32_16x16x32_bf16 v[168:171], a[104:107], a[72:75], v[168:171]
v_mfma_f32_16x16x32_bf16 v[168:171], a[108:111], a[76:79], v[168:171]
ds_read_b128 a[148:151], v5 offset:19456
v_mfma_f32_16x16x32_bf16 v[144:147], a[108:111], a[68:71], v[144:147]
v_mfma_f32_16x16x32_bf16 v[144:147], a[104:107], a[64:67], v[144:147]
buffer_load_dwordx4 a[40:43], v2, s[40:43], s35 offen offset:1024 sc1
v_mfma_f32_16x16x32_bf16 v[148:151], a[112:115], a[64:67], v[148:151]
v_mfma_f32_16x16x32_bf16 v[148:151], a[116:119], a[68:71], v[148:151]
v_mfma_f32_16x16x32_bf16 v[172:175], a[116:119], a[76:79], v[172:175]
v_mfma_f32_16x16x32_bf16 v[172:175], a[112:115], a[72:75], v[172:175]
v_mfma_f32_16x16x32_bf16 v[196:199], a[112:115], a[80:83], v[196:199]
buffer_load_dwordx4 a[44:47], v2, s[40:43], s33 offen offset:1024 sc1
v_mfma_f32_16x16x32_bf16 v[196:199], a[116:119], a[84:87], v[196:199]
v_mfma_f32_16x16x32_bf16 v[220:223], a[116:119], a[92:95], v[220:223]
v_mfma_f32_16x16x32_bf16 v[220:223], a[112:115], a[88:91], v[220:223]
s_waitcnt lgkmcnt(0)
v_mfma_f32_16x16x32_bf16 v[224:227], a[128:131], a[88:91], v[224:227]
ds_read_b128 a[96:99], v5 offset:26624
v_mfma_f32_16x16x32_bf16 v[224:227], a[132:135], a[92:95], v[224:227]
buffer_load_dwordx4 a[48:51], v2, s[40:43], s35 offen offset:2048 sc1
v_mfma_f32_16x16x32_bf16 v[200:203], a[132:135], a[84:87], v[200:203]
ds_read_b128 a[100:103], v5 offset:32768
v_mfma_f32_16x16x32_bf16 v[200:203], a[128:131], a[80:83], v[200:203]
v_mfma_f32_16x16x32_bf16 v[176:179], a[128:131], a[72:75], v[176:179]
v_mfma_f32_16x16x32_bf16 v[176:179], a[132:135], a[76:79], v[176:179]
buffer_load_dwordx4 a[52:55], v2, s[40:43], s33 offen offset:2048 sc1
v_mfma_f32_16x16x32_bf16 v[152:155], a[132:135], a[68:71], v[152:155]
ds_read_b128 a[104:107], v5 offset:27648
v_mfma_f32_16x16x32_bf16 v[152:155], a[128:131], a[64:67], v[152:155]
v_mfma_f32_16x16x32_bf16 v[132:135], a[136:139], a[64:67], v[132:135]
ds_read_b128 a[108:111], v5 offset:33792
v_mfma_f32_16x16x32_bf16 v[132:135], a[140:143], a[68:71], v[132:135]
v_mfma_f32_16x16x32_bf16 v[156:159], a[140:143], a[76:79], v[156:159]
buffer_load_dwordx4 v[108:111], v1, s[4:7], s88 offen offset:0 sc1
v_mfma_f32_16x16x32_bf16 v[156:159], a[136:139], a[72:75], v[156:159]
ds_read_b128 a[112:115], v5 offset:28672
v_mfma_f32_16x16x32_bf16 v[180:183], a[136:139], a[80:83], v[180:183]
v_mfma_f32_16x16x32_bf16 v[180:183], a[140:143], a[84:87], v[180:183]
ds_read_b128 a[116:119], v5 offset:34816
v_mfma_f32_16x16x32_bf16 v[204:207], a[140:143], a[92:95], v[204:207]
v_mfma_f32_16x16x32_bf16 v[204:207], a[136:139], a[88:91], v[204:207]
buffer_load_dwordx4 a[56:59], v2, s[40:43], s35 offen offset:3072 sc1
v_mfma_f32_16x16x32_bf16 v[208:211], a[144:147], a[88:91], v[208:211]
v_mfma_f32_16x16x32_bf16 v[208:211], a[148:151], a[92:95], v[208:211]
v_mfma_f32_16x16x32_bf16 v[184:187], a[148:151], a[84:87], v[184:187]
v_mfma_f32_16x16x32_bf16 v[184:187], a[144:147], a[80:83], v[184:187]
v_mfma_f32_16x16x32_bf16 v[160:163], a[144:147], a[72:75], v[160:163]
buffer_load_dwordx4 a[60:63], v2, s[40:43], s33 offen offset:3072 sc1
s_add_u32 s35, s35, 8192
v_mfma_f32_16x16x32_bf16 v[160:163], a[148:151], a[76:79], v[160:163]
s_add_u32 s33, s33, 8192
v_mfma_f32_16x16x32_bf16 v[136:139], a[148:151], a[68:71], v[136:139]
v_mfma_f32_16x16x32_bf16 v[136:139], a[144:147], a[64:67], v[136:139]
s_waitcnt vmcnt(10) lgkmcnt(0)
v_mfma_f32_16x16x32_bf16 v[140:143], a[96:99], a[0:3], v[140:143]
ds_read_b128 a[128:131], v5 offset:29696
v_add_f32_dpp v48, v48, v48 row_ror:8 row_mask:0xf bank_mask:0xf
v_mfma_f32_16x16x32_bf16 v[140:143], a[100:103], a[4:7], v[140:143]
buffer_load_dwordx4 a[64:67], v2, s[40:43], s35 offen offset:0 sc1
v_mfma_f32_16x16x32_bf16 v[164:167], a[100:103], a[12:15], v[164:167]
ds_read_b128 a[132:135], v5 offset:35840
v_add_f32_dpp v49, v49, v49 row_ror:8 row_mask:0xf bank_mask:0xf
v_mfma_f32_16x16x32_bf16 v[164:167], a[96:99], a[8:11], v[164:167]
v_add_f32_dpp v50, v50, v50 row_ror:8 row_mask:0xf bank_mask:0xf
v_add_f32_dpp v51, v51, v51 row_ror:8 row_mask:0xf bank_mask:0xf
v_mfma_f32_16x16x32_bf16 v[188:191], a[96:99], a[16:19], v[188:191]
v_add_f32_dpp v52, v52, v52 row_ror:8 row_mask:0xf bank_mask:0xf
v_add_f32_dpp v53, v53, v53 row_ror:8 row_mask:0xf bank_mask:0xf
v_mfma_f32_16x16x32_bf16 v[188:191], a[100:103], a[20:23], v[188:191]
buffer_load_dwordx4 a[68:71], v2, s[40:43], s33 offen offset:0 sc1
v_mfma_f32_16x16x32_bf16 v[212:215], a[100:103], a[28:31], v[212:215]
ds_read_b128 a[136:139], v5 offset:24576
v_add_f32_dpp v54, v54, v54 row_ror:8 row_mask:0xf bank_mask:0xf
v_mfma_f32_16x16x32_bf16 v[212:215], a[96:99], a[24:27], v[212:215]
v_add_f32_dpp v55, v55, v55 row_ror:8 row_mask:0xf bank_mask:0xf
v_add_f32_dpp v48, v48, v48 row_ror:4 row_mask:0xf bank_mask:0xf
v_mfma_f32_16x16x32_bf16 v[216:219], a[104:107], a[24:27], v[216:219]
ds_read_b128 a[140:143], v5 offset:30720
v_add_f32_dpp v49, v49, v49 row_ror:4 row_mask:0xf bank_mask:0xf
v_mfma_f32_16x16x32_bf16 v[216:219], a[108:111], a[28:31], v[216:219]
v_add_f32_dpp v50, v50, v50 row_ror:4 row_mask:0xf bank_mask:0xf
v_mfma_f32_16x16x32_bf16 v[192:195], a[108:111], a[20:23], v[192:195]
buffer_load_dwordx4 v[112:115], v1, s[4:7], s88 offen offset:1024 sc1
v_mfma_f32_16x16x32_bf16 v[192:195], a[104:107], a[16:19], v[192:195]
ds_read_b128 a[144:147], v5 offset:25600
v_add_f32_dpp v51, v51, v51 row_ror:4 row_mask:0xf bank_mask:0xf
v_mfma_f32_16x16x32_bf16 v[168:171], a[104:107], a[8:11], v[168:171]
v_add_f32_dpp v52, v52, v52 row_ror:4 row_mask:0xf bank_mask:0xf
v_add_f32_dpp v53, v53, v53 row_ror:4 row_mask:0xf bank_mask:0xf
v_mfma_f32_16x16x32_bf16 v[168:171], a[108:111], a[12:15], v[168:171]
ds_read_b128 a[148:151], v5 offset:31744
v_add_f32_dpp v54, v54, v54 row_ror:4 row_mask:0xf bank_mask:0xf
v_mfma_f32_16x16x32_bf16 v[144:147], a[108:111], a[4:7], v[144:147]
v_add_f32_dpp v55, v55, v55 row_ror:4 row_mask:0xf bank_mask:0xf
v_mfma_f32_16x16x32_bf16 v[144:147], a[104:107], a[0:3], v[144:147]
buffer_load_dwordx4 a[72:75], v2, s[40:43], s35 offen offset:1024 sc1
v_mfma_f32_16x16x32_bf16 v[148:151], a[112:115], a[0:3], v[148:151]
v_add_f32_dpp v48, v48, v48 row_ror:2 row_mask:0xf bank_mask:0xf
v_add_f32_dpp v49, v49, v49 row_ror:2 row_mask:0xf bank_mask:0xf
v_mfma_f32_16x16x32_bf16 v[148:151], a[116:119], a[4:7], v[148:151]
v_add_f32_dpp v50, v50, v50 row_ror:2 row_mask:0xf bank_mask:0xf
v_mfma_f32_16x16x32_bf16 v[172:175], a[116:119], a[12:15], v[172:175]
v_add_f32_dpp v51, v51, v51 row_ror:2 row_mask:0xf bank_mask:0xf
v_mfma_f32_16x16x32_bf16 v[172:175], a[112:115], a[8:11], v[172:175]
v_add_f32_dpp v52, v52, v52 row_ror:2 row_mask:0xf bank_mask:0xf
v_mfma_f32_16x16x32_bf16 v[196:199], a[112:115], a[16:19], v[196:199]
buffer_load_dwordx4 a[76:79], v2, s[40:43], s33 offen offset:1024 sc1
v_mfma_f32_16x16x32_bf16 v[196:199], a[116:119], a[20:23], v[196:199]
v_add_f32_dpp v53, v53, v53 row_ror:2 row_mask:0xf bank_mask:0xf
v_add_f32_dpp v54, v54, v54 row_ror:2 row_mask:0xf bank_mask:0xf
v_mfma_f32_16x16x32_bf16 v[220:223], a[116:119], a[28:31], v[220:223]
v_add_f32_dpp v55, v55, v55 row_ror:2 row_mask:0xf bank_mask:0xf
v_mfma_f32_16x16x32_bf16 v[220:223], a[112:115], a[24:27], v[220:223]
v_add_f32_dpp v48, v48, v48 row_ror:1 row_mask:0xf bank_mask:0xf
s_waitcnt lgkmcnt(0)
v_mfma_f32_16x16x32_bf16 v[224:227], a[128:131], a[24:27], v[224:227]
ds_read_b128 a[96:99], v5 offset:38912
v_add_f32_dpp v49, v49, v49 row_ror:1 row_mask:0xf bank_mask:0xf
v_mfma_f32_16x16x32_bf16 v[224:227], a[132:135], a[28:31], v[224:227]
buffer_load_dwordx4 a[80:83], v2, s[40:43], s35 offen offset:2048 sc1
v_mfma_f32_16x16x32_bf16 v[200:203], a[132:135], a[20:23], v[200:203]
ds_read_b128 a[100:103], v5 offset:45056
v_add_f32_dpp v50, v50, v50 row_ror:1 row_mask:0xf bank_mask:0xf
v_mfma_f32_16x16x32_bf16 v[200:203], a[128:131], a[16:19], v[200:203]
v_add_f32_dpp v51, v51, v51 row_ror:1 row_mask:0xf bank_mask:0xf
v_add_f32_dpp v52, v52, v52 row_ror:1 row_mask:0xf bank_mask:0xf
v_mfma_f32_16x16x32_bf16 v[176:179], a[128:131], a[8:11], v[176:179]
v_add_f32_dpp v53, v53, v53 row_ror:1 row_mask:0xf bank_mask:0xf
v_add_f32_dpp v54, v54, v54 row_ror:1 row_mask:0xf bank_mask:0xf
v_mfma_f32_16x16x32_bf16 v[176:179], a[132:135], a[12:15], v[176:179]
buffer_load_dwordx4 v[116:119], v1, s[4:7], s88 offen offset:2048 sc1
v_mfma_f32_16x16x32_bf16 v[152:155], a[132:135], a[4:7], v[152:155]
ds_read_b128 a[104:107], v5 offset:39936
v_add_f32_dpp v55, v55, v55 row_ror:1 row_mask:0xf bank_mask:0xf
v_mfma_f32_16x16x32_bf16 v[152:155], a[128:131], a[0:3], v[152:155]
v_add_u32 v233, 159744, v233
s_lshl_b32 s36, s28, 6
v_mfma_f32_16x16x32_bf16 v[132:135], a[136:139], a[0:3], v[132:135]
ds_read_b128 a[108:111], v5 offset:46080
s_lshl_b32 s37, s39, 6
v_mfma_f32_16x16x32_bf16 v[132:135], a[140:143], a[4:7], v[132:135]
buffer_load_dwordx4 a[84:87], v2, s[40:43], s33 offen offset:2048 sc1
v_mfma_f32_16x16x32_bf16 v[156:159], a[140:143], a[12:15], v[156:159]
ds_read_b128 a[112:115], v5 offset:40960
v_add_u32 v232, s36, v233
v_mfma_f32_16x16x32_bf16 v[156:159], a[136:139], a[8:11], v[156:159]
v_add_u32 v235, s37, v233
v_mfma_f32_16x16x32_bf16 v[180:183], a[136:139], a[16:19], v[180:183]
v_mfma_f32_16x16x32_bf16 v[180:183], a[140:143], a[20:23], v[180:183]
buffer_load_dwordx4 a[88:91], v2, s[40:43], s35 offen offset:3072 sc1
v_mfma_f32_16x16x32_bf16 v[204:207], a[140:143], a[28:31], v[204:207]
ds_read_b128 a[116:119], v5 offset:47104
v_mfma_f32_16x16x32_bf16 v[204:207], a[136:139], a[24:27], v[204:207]
v_mfma_f32_16x16x32_bf16 v[208:211], a[144:147], a[24:27], v[208:211]
v_mfma_f32_16x16x32_bf16 v[208:211], a[148:151], a[28:31], v[208:211]
buffer_load_dwordx4 v[120:123], v1, s[4:7], s88 offen offset:3072 sc1
s_add_u32 m0, s18, 0x0
v_mfma_f32_16x16x32_bf16 v[184:187], a[148:151], a[20:23], v[184:187]
s_add_u32 s44, s50, 0x1424000
v_mfma_f32_16x16x32_bf16 v[184:187], a[144:147], a[16:19], v[184:187]
v_mfma_f32_16x16x32_bf16 v[160:163], a[144:147], a[8:11], v[160:163]
v_mfma_f32_16x16x32_bf16 v[160:163], a[148:151], a[12:15], v[160:163]
buffer_load_dwordx4 a[92:95], v2, s[40:43], s33 offen offset:3072 sc1
s_add_u32 s35, s35, 8192
v_mfma_f32_16x16x32_bf16 v[136:139], a[148:151], a[4:7], v[136:139]
s_add_u32 s33, s33, 8192
v_mfma_f32_16x16x32_bf16 v[136:139], a[144:147], a[0:3], v[136:139]
s_waitcnt vmcnt(11) lgkmcnt(0)
v_mfma_f32_16x16x32_bf16 v[140:143], a[96:99], a[32:35], v[140:143]
ds_read_b128 a[128:131], v5 offset:41984
v_mfma_f32_16x16x32_bf16 v[140:143], a[100:103], a[36:39], v[140:143]
buffer_load_dwordx4 a[0:3], v2, s[40:43], s35 offen offset:0 sc1
v_mfma_f32_16x16x32_bf16 v[164:167], a[100:103], a[44:47], v[164:167]
ds_read_b128 a[132:135], v5 offset:48128
v_mfma_f32_16x16x32_bf16 v[164:167], a[96:99], a[40:43], v[164:167]
ds_write_b128 v232, v[48:51]
v_mfma_f32_16x16x32_bf16 v[188:191], a[96:99], a[48:51], v[188:191]
ds_write_b128 v235, v[52:55]
v_mfma_f32_16x16x32_bf16 v[188:191], a[100:103], a[52:55], v[188:191]
buffer_load_dwordx4 a[4:7], v2, s[40:43], s33 offen offset:0 sc1
v_mfma_f32_16x16x32_bf16 v[212:215], a[100:103], a[60:63], v[212:215]
ds_read_b128 a[136:139], v5 offset:36864
v_mfma_f32_16x16x32_bf16 v[212:215], a[96:99], a[56:59], v[212:215]
v_mfma_f32_16x16x32_bf16 v[216:219], a[104:107], a[56:59], v[216:219]
ds_read_b128 a[140:143], v5 offset:43008
v_mfma_f32_16x16x32_bf16 v[216:219], a[108:111], a[60:63], v[216:219]
v_mfma_f32_16x16x32_bf16 v[192:195], a[108:111], a[52:55], v[192:195]
buffer_load_dwordx4 v1, s[4:7], s44 offen offset:0 sc1 lds
v_mfma_f32_16x16x32_bf16 v[192:195], a[104:107], a[48:51], v[192:195]
ds_read_b128 a[144:147], v5 offset:37888
v_mfma_f32_16x16x32_bf16 v[168:171], a[104:107], a[40:43], v[168:171]
v_mfma_f32_16x16x32_bf16 v[168:171], a[108:111], a[44:47], v[168:171]
ds_read_b128 a[148:151], v5 offset:44032
v_mfma_f32_16x16x32_bf16 v[144:147], a[108:111], a[36:39], v[144:147]
v_mfma_f32_16x16x32_bf16 v[144:147], a[104:107], a[32:35], v[144:147]
buffer_load_dwordx4 a[8:11], v2, s[40:43], s35 offen offset:1024 sc1
v_mfma_f32_16x16x32_bf16 v[148:151], a[112:115], a[32:35], v[148:151]
v_mfma_f32_16x16x32_bf16 v[148:151], a[116:119], a[36:39], v[148:151]
v_mfma_f32_16x16x32_bf16 v[172:175], a[116:119], a[44:47], v[172:175]
v_mfma_f32_16x16x32_bf16 v[172:175], a[112:115], a[40:43], v[172:175]
v_mfma_f32_16x16x32_bf16 v[196:199], a[112:115], a[48:51], v[196:199]
buffer_load_dwordx4 a[12:15], v2, s[40:43], s33 offen offset:1024 sc1
v_mfma_f32_16x16x32_bf16 v[196:199], a[116:119], a[52:55], v[196:199]
v_mfma_f32_16x16x32_bf16 v[220:223], a[116:119], a[60:63], v[220:223]
v_mfma_f32_16x16x32_bf16 v[220:223], a[112:115], a[56:59], v[220:223]
s_waitcnt lgkmcnt(0)
s_barrier
v_mfma_f32_16x16x32_bf16 v[224:227], a[128:131], a[56:59], v[224:227]
v_add_u32 v5, 98304, v1
v_mfma_f32_16x16x32_bf16 v[224:227], a[132:135], a[60:63], v[224:227]
buffer_load_dwordx4 a[16:19], v2, s[40:43], s35 offen offset:2048 sc1
v_mfma_f32_16x16x32_bf16 v[200:203], a[132:135], a[52:55], v[200:203]
ds_read_b128 a[96:99], v5 offset:2048
v_mfma_f32_16x16x32_bf16 v[200:203], a[128:131], a[48:51], v[200:203]
ds_read_b128 a[100:103], v5 offset:8192
v_mfma_f32_16x16x32_bf16 v[176:179], a[128:131], a[40:43], v[176:179]
ds_read_b128 v[48:51], v233 offset:0
v_mfma_f32_16x16x32_bf16 v[176:179], a[132:135], a[44:47], v[176:179]
buffer_load_dwordx4 a[20:23], v2, s[40:43], s33 offen offset:2048 sc1
v_mfma_f32_16x16x32_bf16 v[152:155], a[132:135], a[36:39], v[152:155]
ds_read_b128 a[104:107], v5 offset:3072
v_mfma_f32_16x16x32_bf16 v[152:155], a[128:131], a[32:35], v[152:155]
v_mfma_f32_16x16x32_bf16 v[132:135], a[136:139], a[32:35], v[132:135]
ds_read_b128 a[108:111], v5 offset:9216
v_mfma_f32_16x16x32_bf16 v[132:135], a[140:143], a[36:39], v[132:135]
v_mfma_f32_16x16x32_bf16 v[156:159], a[140:143], a[44:47], v[156:159]
buffer_load_dwordx4 v1, s[4:7], s44 offen offset:1024 sc1 lds
v_mfma_f32_16x16x32_bf16 v[156:159], a[136:139], a[40:43], v[156:159]
ds_read_b128 a[112:115], v5 offset:4096
v_mfma_f32_16x16x32_bf16 v[180:183], a[136:139], a[48:51], v[180:183]
ds_read_b128 v[52:55], v233 offset:64
v_mfma_f32_16x16x32_bf16 v[180:183], a[140:143], a[52:55], v[180:183]
ds_read_b128 a[116:119], v5 offset:10240
v_mfma_f32_16x16x32_bf16 v[204:207], a[140:143], a[60:63], v[204:207]
v_mfma_f32_16x16x32_bf16 v[204:207], a[136:139], a[56:59], v[204:207]
buffer_load_dwordx4 a[24:27], v2, s[40:43], s35 offen offset:3072 sc1
v_mfma_f32_16x16x32_bf16 v[208:211], a[144:147], a[56:59], v[208:211]
v_mfma_f32_16x16x32_bf16 v[208:211], a[148:151], a[60:63], v[208:211]
v_mfma_f32_16x16x32_bf16 v[184:187], a[148:151], a[52:55], v[184:187]
v_mfma_f32_16x16x32_bf16 v[184:187], a[144:147], a[48:51], v[184:187]
v_mfma_f32_16x16x32_bf16 v[160:163], a[144:147], a[40:43], v[160:163]
buffer_load_dwordx4 a[28:31], v2, s[40:43], s33 offen offset:3072 sc1
s_add_u32 s35, s35, 8192
v_mfma_f32_16x16x32_bf16 v[160:163], a[148:151], a[44:47], v[160:163]
s_add_u32 s33, s33, 8192
ds_read_b128 v[56:59], v233 offset:128
v_mfma_f32_16x16x32_bf16 v[136:139], a[148:151], a[36:39], v[136:139]
v_mfma_f32_16x16x32_bf16 v[136:139], a[144:147], a[32:35], v[136:139]
s_waitcnt vmcnt(10) lgkmcnt(1)
v_mfma_f32_16x16x32_bf16 v[140:143], a[96:99], a[64:67], v[140:143]
ds_read_b128 a[128:131], v5 offset:5120
v_mfma_f32_16x16x32_bf16 v[140:143], a[100:103], a[68:71], v[140:143]
buffer_load_dwordx4 a[32:35], v2, s[40:43], s35 offen offset:0 sc1
v_mfma_f32_16x16x32_bf16 v[164:167], a[100:103], a[76:79], v[164:167]
ds_read_b128 a[132:135], v5 offset:11264
v_mfma_f32_16x16x32_bf16 v[164:167], a[96:99], a[72:75], v[164:167]
v_mfma_f32_16x16x32_bf16 v[188:191], a[96:99], a[80:83], v[188:191]
v_mfma_f32_16x16x32_bf16 v[188:191], a[100:103], a[84:87], v[188:191]
buffer_load_dwordx4 a[36:39], v2, s[40:43], s33 offen offset:0 sc1
v_mfma_f32_16x16x32_bf16 v[212:215], a[100:103], a[92:95], v[212:215]
ds_read_b128 a[136:139], v5 offset:0
v_mfma_f32_16x16x32_bf16 v[212:215], a[96:99], a[88:91], v[212:215]
v_mfma_f32_16x16x32_bf16 v[216:219], a[104:107], a[88:91], v[216:219]
ds_read_b128 a[140:143], v5 offset:6144
v_mfma_f32_16x16x32_bf16 v[216:219], a[108:111], a[92:95], v[216:219]
ds_read_b128 v[60:63], v233 offset:192
v_mfma_f32_16x16x32_bf16 v[192:195], a[108:111], a[84:87], v[192:195]
buffer_load_dwordx4 v1, s[4:7], s44 offen offset:2048 sc1 lds
s_add_u32 m0, s18, 0x3000
v_mfma_f32_16x16x32_bf16 v[192:195], a[104:107], a[80:83], v[192:195]
s_add_u32 s44, s50, 0x1427000
ds_read_b128 a[144:147], v5 offset:1024
v_mfma_f32_16x16x32_bf16 v[168:171], a[104:107], a[72:75], v[168:171]
v_mfma_f32_16x16x32_bf16 v[168:171], a[108:111], a[76:79], v[168:171]
ds_read_b128 a[148:151], v5 offset:7168
v_mfma_f32_16x16x32_bf16 v[144:147], a[108:111], a[68:71], v[144:147]
v_mfma_f32_16x16x32_bf16 v[144:147], a[104:107], a[64:67], v[144:147]
buffer_load_dwordx4 a[40:43], v2, s[40:43], s35 offen offset:1024 sc1
v_mfma_f32_16x16x32_bf16 v[148:151], a[112:115], a[64:67], v[148:151]
v_mfma_f32_16x16x32_bf16 v[148:151], a[116:119], a[68:71], v[148:151]
v_mfma_f32_16x16x32_bf16 v[172:175], a[116:119], a[76:79], v[172:175]
ds_read_b128 v[64:67], v233 offset:256
v_mfma_f32_16x16x32_bf16 v[172:175], a[112:115], a[72:75], v[172:175]
v_mfma_f32_16x16x32_bf16 v[196:199], a[112:115], a[80:83], v[196:199]
buffer_load_dwordx4 a[44:47], v2, s[40:43], s33 offen offset:1024 sc1
v_mfma_f32_16x16x32_bf16 v[196:199], a[116:119], a[84:87], v[196:199]
v_mfma_f32_16x16x32_bf16 v[220:223], a[116:119], a[92:95], v[220:223]
v_mfma_f32_16x16x32_bf16 v[220:223], a[112:115], a[88:91], v[220:223]
s_waitcnt lgkmcnt(1)
v_mfma_f32_16x16x32_bf16 v[224:227], a[128:131], a[88:91], v[224:227]
ds_read_b128 a[96:99], v5 offset:14336
v_mfma_f32_16x16x32_bf16 v[224:227], a[132:135], a[92:95], v[224:227]
buffer_load_dwordx4 a[48:51], v2, s[40:43], s35 offen offset:2048 sc1
v_mfma_f32_16x16x32_bf16 v[200:203], a[132:135], a[84:87], v[200:203]
ds_read_b128 a[100:103], v5 offset:20480
v_mfma_f32_16x16x32_bf16 v[200:203], a[128:131], a[80:83], v[200:203]
v_mfma_f32_16x16x32_bf16 v[176:179], a[128:131], a[72:75], v[176:179]
v_mfma_f32_16x16x32_bf16 v[176:179], a[132:135], a[76:79], v[176:179]
buffer_load_dwordx4 a[52:55], v2, s[40:43], s33 offen offset:2048 sc1
v_mfma_f32_16x16x32_bf16 v[152:155], a[132:135], a[68:71], v[152:155]
ds_read_b128 a[104:107], v5 offset:15360
v_mfma_f32_16x16x32_bf16 v[152:155], a[128:131], a[64:67], v[152:155]
ds_read_b128 v[68:71], v233 offset:320
v_mfma_f32_16x16x32_bf16 v[132:135], a[136:139], a[64:67], v[132:135]
ds_read_b128 a[108:111], v5 offset:21504
v_mfma_f32_16x16x32_bf16 v[132:135], a[140:143], a[68:71], v[132:135]
v_mfma_f32_16x16x32_bf16 v[156:159], a[140:143], a[76:79], v[156:159]
buffer_load_dwordx4 v1, s[4:7], s44 offen offset:0 sc1 lds
v_mfma_f32_16x16x32_bf16 v[156:159], a[136:139], a[72:75], v[156:159]
ds_read_b128 a[112:115], v5 offset:16384
v_mfma_f32_16x16x32_bf16 v[180:183], a[136:139], a[80:83], v[180:183]
v_mfma_f32_16x16x32_bf16 v[180:183], a[140:143], a[84:87], v[180:183]
ds_read_b128 a[116:119], v5 offset:22528
v_mfma_f32_16x16x32_bf16 v[204:207], a[140:143], a[92:95], v[204:207]
v_mfma_f32_16x16x32_bf16 v[204:207], a[136:139], a[88:91], v[204:207]
buffer_load_dwordx4 a[56:59], v2, s[40:43], s35 offen offset:3072 sc1
v_mfma_f32_16x16x32_bf16 v[208:211], a[144:147], a[88:91], v[208:211]
v_mfma_f32_16x16x32_bf16 v[208:211], a[148:151], a[92:95], v[208:211]
v_mfma_f32_16x16x32_bf16 v[184:187], a[148:151], a[84:87], v[184:187]
v_mfma_f32_16x16x32_bf16 v[184:187], a[144:147], a[80:83], v[184:187]
v_mfma_f32_16x16x32_bf16 v[160:163], a[144:147], a[72:75], v[160:163]
buffer_load_dwordx4 a[60:63], v2, s[40:43], s33 offen offset:3072 sc1
s_add_u32 s35, s35, 8192
v_mfma_f32_16x16x32_bf16 v[160:163], a[148:151], a[76:79], v[160:163]
s_add_u32 s33, s33, 8192
v_mfma_f32_16x16x32_bf16 v[136:139], a[148:151], a[68:71], v[136:139]
v_mfma_f32_16x16x32_bf16 v[136:139], a[144:147], a[64:67], v[136:139]
s_waitcnt vmcnt(10) lgkmcnt(0)
v_mfma_f32_16x16x32_bf16 v[140:143], a[96:99], a[0:3], v[140:143]
ds_read_b128 a[128:131], v5 offset:17408
v_mfma_f32_16x16x32_bf16 v[140:143], a[100:103], a[4:7], v[140:143]
buffer_load_dwordx4 a[64:67], v2, s[40:43], s35 offen offset:0 sc1
v_mfma_f32_16x16x32_bf16 v[164:167], a[100:103], a[12:15], v[164:167]
ds_read_b128 a[132:135], v5 offset:23552
v_mfma_f32_16x16x32_bf16 v[164:167], a[96:99], a[8:11], v[164:167]
v_mfma_f32_16x16x32_bf16 v[188:191], a[96:99], a[16:19], v[188:191]
v_mfma_f32_16x16x32_bf16 v[188:191], a[100:103], a[20:23], v[188:191]
buffer_load_dwordx4 a[68:71], v2, s[40:43], s33 offen offset:0 sc1
v_mfma_f32_16x16x32_bf16 v[212:215], a[100:103], a[28:31], v[212:215]
ds_read_b128 a[136:139], v5 offset:12288
v_mfma_f32_16x16x32_bf16 v[212:215], a[96:99], a[24:27], v[212:215]
v_mfma_f32_16x16x32_bf16 v[216:219], a[104:107], a[24:27], v[216:219]
ds_read_b128 a[140:143], v5 offset:18432
v_mfma_f32_16x16x32_bf16 v[216:219], a[108:111], a[28:31], v[216:219]
v_mfma_f32_16x16x32_bf16 v[192:195], a[108:111], a[20:23], v[192:195]
buffer_load_dwordx4 v1, s[4:7], s44 offen offset:1024 sc1 lds
v_mfma_f32_16x16x32_bf16 v[192:195], a[104:107], a[16:19], v[192:195]
ds_read_b128 a[144:147], v5 offset:13312
v_mfma_f32_16x16x32_bf16 v[168:171], a[104:107], a[8:11], v[168:171]
v_mfma_f32_16x16x32_bf16 v[168:171], a[108:111], a[12:15], v[168:171]
ds_read_b128 a[148:151], v5 offset:19456
v_mfma_f32_16x16x32_bf16 v[144:147], a[108:111], a[4:7], v[144:147]
v_mfma_f32_16x16x32_bf16 v[144:147], a[104:107], a[0:3], v[144:147]
buffer_load_dwordx4 a[72:75], v2, s[40:43], s35 offen offset:1024 sc1
v_mfma_f32_16x16x32_bf16 v[148:151], a[112:115], a[0:3], v[148:151]
v_mfma_f32_16x16x32_bf16 v[148:151], a[116:119], a[4:7], v[148:151]
v_mfma_f32_16x16x32_bf16 v[172:175], a[116:119], a[12:15], v[172:175]
v_mfma_f32_16x16x32_bf16 v[172:175], a[112:115], a[8:11], v[172:175]
v_mfma_f32_16x16x32_bf16 v[196:199], a[112:115], a[16:19], v[196:199]
buffer_load_dwordx4 a[76:79], v2, s[40:43], s33 offen offset:1024 sc1
v_mfma_f32_16x16x32_bf16 v[196:199], a[116:119], a[20:23], v[196:199]
v_mfma_f32_16x16x32_bf16 v[220:223], a[116:119], a[28:31], v[220:223]
v_mfma_f32_16x16x32_bf16 v[220:223], a[112:115], a[24:27], v[220:223]
s_waitcnt lgkmcnt(0)
s_barrier
v_mfma_f32_16x16x32_bf16 v[224:227], a[128:131], a[24:27], v[224:227]
ds_read_b128 a[96:99], v5 offset:26624
v_accvgpr_write_b32 a216, v48
v_mfma_f32_16x16x32_bf16 v[224:227], a[132:135], a[28:31], v[224:227]
buffer_load_dwordx4 a[80:83], v2, s[40:43], s35 offen offset:2048 sc1
v_mfma_f32_16x16x32_bf16 v[200:203], a[132:135], a[20:23], v[200:203]
ds_read_b128 a[100:103], v5 offset:32768
v_mfma_f32_16x16x32_bf16 v[200:203], a[128:131], a[16:19], v[200:203]
v_accvgpr_write_b32 a217, v49
v_mfma_f32_16x16x32_bf16 v[176:179], a[128:131], a[8:11], v[176:179]
v_mfma_f32_16x16x32_bf16 v[176:179], a[132:135], a[12:15], v[176:179]
buffer_load_dwordx4 a[84:87], v2, s[40:43], s33 offen offset:2048 sc1
v_mfma_f32_16x16x32_bf16 v[152:155], a[132:135], a[4:7], v[152:155]
ds_read_b128 a[104:107], v5 offset:27648
v_accvgpr_write_b32 a218, v50
v_mfma_f32_16x16x32_bf16 v[152:155], a[128:131], a[0:3], v[152:155]
v_mfma_f32_16x16x32_bf16 v[132:135], a[136:139], a[0:3], v[132:135]
ds_read_b128 a[108:111], v5 offset:33792
v_mfma_f32_16x16x32_bf16 v[132:135], a[140:143], a[4:7], v[132:135]
v_accvgpr_write_b32 a219, v51
v_mfma_f32_16x16x32_bf16 v[156:159], a[140:143], a[12:15], v[156:159]
buffer_load_dwordx4 v1, s[4:7], s44 offen offset:2048 sc1 lds
s_add_u32 m0, s18, 0x6000
v_mfma_f32_16x16x32_bf16 v[156:159], a[136:139], a[8:11], v[156:159]
s_add_u32 s44, s50, 0x142a000
ds_read_b128 a[112:115], v5 offset:28672
v_mfma_f32_16x16x32_bf16 v[180:183], a[136:139], a[16:19], v[180:183]
v_accvgpr_write_b32 a220, v52
v_mfma_f32_16x16x32_bf16 v[180:183], a[140:143], a[20:23], v[180:183]
ds_read_b128 a[116:119], v5 offset:34816
v_mfma_f32_16x16x32_bf16 v[204:207], a[140:143], a[28:31], v[204:207]
v_mfma_f32_16x16x32_bf16 v[204:207], a[136:139], a[24:27], v[204:207]
buffer_load_dwordx4 a[88:91], v2, s[40:43], s35 offen offset:3072 sc1
v_mfma_f32_16x16x32_bf16 v[208:211], a[144:147], a[24:27], v[208:211]
v_accvgpr_write_b32 a221, v53
v_mfma_f32_16x16x32_bf16 v[208:211], a[148:151], a[28:31], v[208:211]
v_mfma_f32_16x16x32_bf16 v[184:187], a[148:151], a[20:23], v[184:187]
v_accvgpr_write_b32 a222, v54
v_mfma_f32_16x16x32_bf16 v[184:187], a[144:147], a[16:19], v[184:187]
v_mfma_f32_16x16x32_bf16 v[160:163], a[144:147], a[8:11], v[160:163]
buffer_load_dwordx4 a[92:95], v2, s[40:43], s33 offen offset:3072 sc1
s_add_u32 s35, s35, 8192
v_mfma_f32_16x16x32_bf16 v[160:163], a[148:151], a[12:15], v[160:163]
s_add_u32 s33, s33, 8192
v_accvgpr_write_b32 a223, v55
v_mfma_f32_16x16x32_bf16 v[136:139], a[148:151], a[4:7], v[136:139]
v_mfma_f32_16x16x32_bf16 v[136:139], a[144:147], a[0:3], v[136:139]
s_waitcnt vmcnt(10) lgkmcnt(0)
v_mfma_f32_16x16x32_bf16 v[140:143], a[96:99], a[32:35], v[140:143]
ds_read_b128 a[128:131], v5 offset:29696
v_accvgpr_write_b32 a224, v56
v_mfma_f32_16x16x32_bf16 v[140:143], a[100:103], a[36:39], v[140:143]
buffer_load_dwordx4 a[0:3], v2, s[40:43], s35 offen offset:0 sc1
v_mfma_f32_16x16x32_bf16 v[164:167], a[100:103], a[44:47], v[164:167]
ds_read_b128 a[132:135], v5 offset:35840
v_mfma_f32_16x16x32_bf16 v[164:167], a[96:99], a[40:43], v[164:167]
v_accvgpr_write_b32 a225, v57
v_mfma_f32_16x16x32_bf16 v[188:191], a[96:99], a[48:51], v[188:191]
v_mfma_f32_16x16x32_bf16 v[188:191], a[100:103], a[52:55], v[188:191]
buffer_load_dwordx4 a[4:7], v2, s[40:43], s33 offen offset:0 sc1
v_mfma_f32_16x16x32_bf16 v[212:215], a[100:103], a[60:63], v[212:215]
ds_read_b128 a[136:139], v5 offset:24576
v_accvgpr_write_b32 a226, v58
v_mfma_f32_16x16x32_bf16 v[212:215], a[96:99], a[56:59], v[212:215]
v_mfma_f32_16x16x32_bf16 v[216:219], a[104:107], a[56:59], v[216:219]
ds_read_b128 a[140:143], v5 offset:30720
v_mfma_f32_16x16x32_bf16 v[216:219], a[108:111], a[60:63], v[216:219]
v_accvgpr_write_b32 a227, v59
v_mfma_f32_16x16x32_bf16 v[192:195], a[108:111], a[52:55], v[192:195]
buffer_load_dwordx4 v1, s[4:7], s44 offen offset:0 sc1 lds
v_mfma_f32_16x16x32_bf16 v[192:195], a[104:107], a[48:51], v[192:195]
ds_read_b128 a[144:147], v5 offset:25600
v_mfma_f32_16x16x32_bf16 v[168:171], a[104:107], a[40:43], v[168:171]
v_accvgpr_write_b32 a228, v60
v_mfma_f32_16x16x32_bf16 v[168:171], a[108:111], a[44:47], v[168:171]
ds_read_b128 a[148:151], v5 offset:31744
v_mfma_f32_16x16x32_bf16 v[144:147], a[108:111], a[36:39], v[144:147]
v_mfma_f32_16x16x32_bf16 v[144:147], a[104:107], a[32:35], v[144:147]
buffer_load_dwordx4 a[8:11], v2, s[40:43], s35 offen offset:1024 sc1
v_mfma_f32_16x16x32_bf16 v[148:151], a[112:115], a[32:35], v[148:151]
v_accvgpr_write_b32 a229, v61
v_mfma_f32_16x16x32_bf16 v[148:151], a[116:119], a[36:39], v[148:151]
v_mfma_f32_16x16x32_bf16 v[172:175], a[116:119], a[44:47], v[172:175]
v_accvgpr_write_b32 a230, v62
v_mfma_f32_16x16x32_bf16 v[172:175], a[112:115], a[40:43], v[172:175]
v_mfma_f32_16x16x32_bf16 v[196:199], a[112:115], a[48:51], v[196:199]
buffer_load_dwordx4 a[12:15], v2, s[40:43], s33 offen offset:1024 sc1
v_mfma_f32_16x16x32_bf16 v[196:199], a[116:119], a[52:55], v[196:199]
v_accvgpr_write_b32 a231, v63
v_mfma_f32_16x16x32_bf16 v[220:223], a[116:119], a[60:63], v[220:223]
v_mfma_f32_16x16x32_bf16 v[220:223], a[112:115], a[56:59], v[220:223]
s_waitcnt lgkmcnt(0)
v_mfma_f32_16x16x32_bf16 v[224:227], a[128:131], a[56:59], v[224:227]
ds_read_b128 a[96:99], v5 offset:38912
v_accvgpr_write_b32 a232, v64
v_mfma_f32_16x16x32_bf16 v[224:227], a[132:135], a[60:63], v[224:227]
buffer_load_dwordx4 a[16:19], v2, s[40:43], s35 offen offset:2048 sc1
v_mfma_f32_16x16x32_bf16 v[200:203], a[132:135], a[52:55], v[200:203]
ds_read_b128 a[100:103], v5 offset:45056
v_mfma_f32_16x16x32_bf16 v[200:203], a[128:131], a[48:51], v[200:203]
v_accvgpr_write_b32 a233, v65
v_mfma_f32_16x16x32_bf16 v[176:179], a[128:131], a[40:43], v[176:179]
v_mfma_f32_16x16x32_bf16 v[176:179], a[132:135], a[44:47], v[176:179]
buffer_load_dwordx4 v1, s[4:7], s44 offen offset:1024 sc1 lds
v_mfma_f32_16x16x32_bf16 v[152:155], a[132:135], a[36:39], v[152:155]
ds_read_b128 a[104:107], v5 offset:39936
v_accvgpr_write_b32 a234, v66
v_mfma_f32_16x16x32_bf16 v[152:155], a[128:131], a[32:35], v[152:155]
v_mfma_f32_16x16x32_bf16 v[132:135], a[136:139], a[32:35], v[132:135]
ds_read_b128 a[108:111], v5 offset:46080
v_mfma_f32_16x16x32_bf16 v[132:135], a[140:143], a[36:39], v[132:135]
buffer_load_dwordx4 a[20:23], v2, s[40:43], s33 offen offset:2048 sc1
v_mfma_f32_16x16x32_bf16 v[156:159], a[140:143], a[44:47], v[156:159]
ds_read_b128 a[112:115], v5 offset:40960
v_accvgpr_write_b32 a235, v67
v_mfma_f32_16x16x32_bf16 v[156:159], a[136:139], a[40:43], v[156:159]
v_mfma_f32_16x16x32_bf16 v[180:183], a[136:139], a[48:51], v[180:183]
v_accvgpr_write_b32 a236, v68
v_mfma_f32_16x16x32_bf16 v[180:183], a[140:143], a[52:55], v[180:183]
buffer_load_dwordx4 a[24:27], v2, s[40:43], s35 offen offset:3072 sc1
v_mfma_f32_16x16x32_bf16 v[204:207], a[140:143], a[60:63], v[204:207]
ds_read_b128 a[116:119], v5 offset:47104
v_mfma_f32_16x16x32_bf16 v[204:207], a[136:139], a[56:59], v[204:207]
v_accvgpr_write_b32 a237, v69
v_mfma_f32_16x16x32_bf16 v[208:211], a[144:147], a[56:59], v[208:211]
v_mfma_f32_16x16x32_bf16 v[208:211], a[148:151], a[60:63], v[208:211]
buffer_load_dwordx4 v1, s[4:7], s44 offen offset:2048 sc1 lds
s_add_u32 m0, s18, 0x9000
v_mfma_f32_16x16x32_bf16 v[184:187], a[148:151], a[52:55], v[184:187]
s_add_u32 s44, s50, 0x142d000
v_accvgpr_write_b32 a238, v70
v_mfma_f32_16x16x32_bf16 v[184:187], a[144:147], a[48:51], v[184:187]
v_mfma_f32_16x16x32_bf16 v[160:163], a[144:147], a[40:43], v[160:163]
v_mfma_f32_16x16x32_bf16 v[160:163], a[148:151], a[44:47], v[160:163]
buffer_load_dwordx4 a[28:31], v2, s[40:43], s33 offen offset:3072 sc1
s_add_u32 s35, s35, 8192
v_mfma_f32_16x16x32_bf16 v[136:139], a[148:151], a[36:39], v[136:139]
s_add_u32 s33, s33, 8192
v_accvgpr_write_b32 a239, v71
v_mfma_f32_16x16x32_bf16 v[136:139], a[144:147], a[32:35], v[136:139]
s_waitcnt vmcnt(11) lgkmcnt(0)
v_mfma_f32_16x16x32_bf16 v[140:143], a[96:99], a[64:67], v[140:143]
L_stub6:
s_cbranch_execz L_stub7
ds_read_b128 a[128:131], v5 offset:41984
v_add_f32 v92, v92, v96
v_mfma_f32_16x16x32_bf16 v[140:143], a[100:103], a[68:71], v[140:143]
buffer_load_dwordx4 a[32:35], v2, s[40:43], s35 offen offset:0 sc1
v_mfma_f32_16x16x32_bf16 v[164:167], a[100:103], a[76:79], v[164:167]
ds_read_b128 a[132:135], v5 offset:48128
v_add_f32 v100, v100, v104
v_mfma_f32_16x16x32_bf16 v[164:167], a[96:99], a[72:75], v[164:167]
v_add_f32 v108, v108, v112
v_add_f32 v116, v116, v120
v_mfma_f32_16x16x32_bf16 v[188:191], a[96:99], a[80:83], v[188:191]
v_add_f32 v93, v93, v97
v_add_f32 v101, v101, v105
v_mfma_f32_16x16x32_bf16 v[188:191], a[100:103], a[84:87], v[188:191]
buffer_load_dwordx4 a[36:39], v2, s[40:43], s33 offen offset:0 sc1
v_mfma_f32_16x16x32_bf16 v[212:215], a[100:103], a[92:95], v[212:215]
ds_read_b128 a[136:139], v5 offset:36864
v_add_f32 v109, v109, v113
v_mfma_f32_16x16x32_bf16 v[212:215], a[96:99], a[88:91], v[212:215]
v_add_f32 v117, v117, v121
v_add_f32 v94, v94, v98
v_mfma_f32_16x16x32_bf16 v[216:219], a[104:107], a[88:91], v[216:219]
ds_read_b128 a[140:143], v5 offset:43008
v_add_f32 v102, v102, v106
v_mfma_f32_16x16x32_bf16 v[216:219], a[108:111], a[92:95], v[216:219]
v_add_f32 v110, v110, v114
v_mfma_f32_16x16x32_bf16 v[192:195], a[108:111], a[84:87], v[192:195]
buffer_load_dwordx4 v1, s[4:7], s44 offen offset:0 sc1 lds
v_mfma_f32_16x16x32_bf16 v[192:195], a[104:107], a[80:83], v[192:195]
ds_read_b128 a[144:147], v5 offset:37888
v_add_f32 v118, v118, v122
v_mfma_f32_16x16x32_bf16 v[168:171], a[104:107], a[72:75], v[168:171]
v_add_f32 v95, v95, v99
v_add_f32 v103, v103, v107
v_mfma_f32_16x16x32_bf16 v[168:171], a[108:111], a[76:79], v[168:171]
ds_read_b128 a[148:151], v5 offset:44032
v_add_f32 v111, v111, v115
v_mfma_f32_16x16x32_bf16 v[144:147], a[108:111], a[68:71], v[144:147]
v_add_f32 v119, v119, v123
v_mfma_f32_16x16x32_bf16 v[144:147], a[104:107], a[64:67], v[144:147]
buffer_load_dwordx4 a[40:43], v2, s[40:43], s35 offen offset:1024 sc1
v_mfma_f32_16x16x32_bf16 v[148:151], a[112:115], a[64:67], v[148:151]
v_add_f32_dpp v92, v92, v92 row_ror:8 row_mask:0xf bank_mask:0xf
v_add_f32_dpp v100, v100, v100 row_ror:8 row_mask:0xf bank_mask:0xf
v_mfma_f32_16x16x32_bf16 v[148:151], a[116:119], a[68:71], v[148:151]
v_add_f32_dpp v108, v108, v108 row_ror:8 row_mask:0xf bank_mask:0xf
v_mfma_f32_16x16x32_bf16 v[172:175], a[116:119], a[76:79], v[172:175]
v_add_f32_dpp v116, v116, v116 row_ror:8 row_mask:0xf bank_mask:0xf
v_mfma_f32_16x16x32_bf16 v[172:175], a[112:115], a[72:75], v[172:175]
v_add_f32_dpp v93, v93, v93 row_ror:8 row_mask:0xf bank_mask:0xf
v_mfma_f32_16x16x32_bf16 v[196:199], a[112:115], a[80:83], v[196:199]
buffer_load_dwordx4 a[44:47], v2, s[40:43], s33 offen offset:1024 sc1
v_mfma_f32_16x16x32_bf16 v[196:199], a[116:119], a[84:87], v[196:199]
v_add_f32_dpp v101, v101, v101 row_ror:8 row_mask:0xf bank_mask:0xf
v_add_f32_dpp v109, v109, v109 row_ror:8 row_mask:0xf bank_mask:0xf
v_mfma_f32_16x16x32_bf16 v[220:223], a[116:119], a[92:95], v[220:223]
v_add_f32_dpp v117, v117, v117 row_ror:8 row_mask:0xf bank_mask:0xf
v_mfma_f32_16x16x32_bf16 v[220:223], a[112:115], a[88:91], v[220:223]
s_waitcnt lgkmcnt(0)
s_barrier
v_mfma_f32_16x16x32_bf16 v[224:227], a[128:131], a[88:91], v[224:227]
v_add_u32 v5, 0, v1
v_add_f32_dpp v92, v94, v94 row_ror:8 row_mask:0xf bank_mask:0xc
v_mfma_f32_16x16x32_bf16 v[224:227], a[132:135], a[92:95], v[224:227]
buffer_load_dwordx4 a[48:51], v2, s[40:43], s35 offen offset:2048 sc1
v_mfma_f32_16x16x32_bf16 v[200:203], a[132:135], a[84:87], v[200:203]
ds_read_b128 a[96:99], v5 offset:2048
v_add_f32_dpp v100, v102, v102 row_ror:8 row_mask:0xf bank_mask:0xc
v_mfma_f32_16x16x32_bf16 v[200:203], a[128:131], a[80:83], v[200:203]
ds_read_b128 a[100:103], v5 offset:8192
v_add_f32_dpp v108, v110, v110 row_ror:8 row_mask:0xf bank_mask:0xc
v_mfma_f32_16x16x32_bf16 v[176:179], a[128:131], a[72:75], v[176:179]
v_add_f32_dpp v116, v118, v118 row_ror:8 row_mask:0xf bank_mask:0xc
v_add_f32_dpp v93, v95, v95 row_ror:8 row_mask:0xf bank_mask:0xc
v_mfma_f32_16x16x32_bf16 v[176:179], a[132:135], a[76:79], v[176:179]
buffer_load_dwordx4 a[52:55], v2, s[40:43], s33 offen offset:2048 sc1
v_mfma_f32_16x16x32_bf16 v[152:155], a[132:135], a[68:71], v[152:155]
ds_read_b128 a[104:107], v5 offset:3072
v_add_f32_dpp v101, v103, v103 row_ror:8 row_mask:0xf bank_mask:0xc
v_mfma_f32_16x16x32_bf16 v[152:155], a[128:131], a[64:67], v[152:155]
v_add_f32_dpp v109, v111, v111 row_ror:8 row_mask:0xf bank_mask:0xc
v_add_f32_dpp v117, v119, v119 row_ror:8 row_mask:0xf bank_mask:0xc
v_mfma_f32_16x16x32_bf16 v[132:135], a[136:139], a[64:67], v[132:135]
ds_read_b128 a[108:111], v5 offset:9216
v_mfma_f32_16x16x32_bf16 v[132:135], a[140:143], a[68:71], v[132:135]
v_permlane32_swap_b32 v92, v93
v_mfma_f32_16x16x32_bf16 v[156:159], a[140:143], a[76:79], v[156:159]
buffer_load_dwordx4 v1, s[4:7], s44 offen offset:1024 sc1 lds
v_mfma_f32_16x16x32_bf16 v[156:159], a[136:139], a[72:75], v[156:159]
ds_read_b128 a[112:115], v5 offset:4096
v_mfma_f32_16x16x32_bf16 v[180:183], a[136:139], a[80:83], v[180:183]
v_permlane32_swap_b32 v100, v101
v_mfma_f32_16x16x32_bf16 v[180:183], a[140:143], a[84:87], v[180:183]
ds_read_b128 a[116:119], v5 offset:10240
v_mfma_f32_16x16x32_bf16 v[204:207], a[140:143], a[92:95], v[204:207]
v_permlane32_swap_b32 v108, v109
v_mfma_f32_16x16x32_bf16 v[204:207], a[136:139], a[88:91], v[204:207]
buffer_load_dwordx4 a[56:59], v2, s[40:43], s35 offen offset:3072 sc1
v_mfma_f32_16x16x32_bf16 v[208:211], a[144:147], a[88:91], v[208:211]
v_permlane32_swap_b32 v116, v117
v_mfma_f32_16x16x32_bf16 v[208:211], a[148:151], a[92:95], v[208:211]
v_add_f32 v92, v92, v93
v_add_f32 v100, v100, v101
v_mfma_f32_16x16x32_bf16 v[184:187], a[148:151], a[84:87], v[184:187]
v_add_f32 v108, v108, v109
v_add_f32 v116, v116, v117
v_mfma_f32_16x16x32_bf16 v[184:187], a[144:147], a[80:83], v[184:187]
v_mov_b32 v94, v92
v_mov_b32 v102, v100
v_mfma_f32_16x16x32_bf16 v[160:163], a[144:147], a[72:75], v[160:163]
buffer_load_dwordx4 a[60:63], v2, s[40:43], s33 offen offset:3072 sc1
s_add_u32 s35, s35, 8192
v_mfma_f32_16x16x32_bf16 v[160:163], a[148:151], a[76:79], v[160:163]
s_add_u32 s33, s33, 8192
v_mov_b32 v110, v108
v_mfma_f32_16x16x32_bf16 v[136:139], a[148:151], a[68:71], v[136:139]
v_mov_b32 v118, v116
v_mfma_f32_16x16x32_bf16 v[136:139], a[144:147], a[64:67], v[136:139]
s_waitcnt vmcnt(10) lgkmcnt(0)
v_mfma_f32_16x16x32_bf16 v[140:143], a[96:99], a[0:3], v[140:143]
ds_read_b128 a[128:131], v5 offset:5120
v_mfma_f32_16x16x32_bf16 v[140:143], a[100:103], a[4:7], v[140:143]
buffer_load_dwordx4 a[64:67], v2, s[40:43], s35 offen offset:0 sc1
v_mfma_f32_16x16x32_bf16 v[164:167], a[100:103], a[12:15], v[164:167]
ds_read_b128 a[132:135], v5 offset:11264
v_mfma_f32_16x16x32_bf16 v[164:167], a[96:99], a[8:11], v[164:167]
v_permlane16_swap_b32 v92, v94
v_mfma_f32_16x16x32_bf16 v[188:191], a[96:99], a[16:19], v[188:191]
v_permlane16_swap_b32 v100, v102
v_mfma_f32_16x16x32_bf16 v[188:191], a[100:103], a[20:23], v[188:191]
buffer_load_dwordx4 a[68:71], v2, s[40:43], s33 offen offset:0 sc1
v_mfma_f32_16x16x32_bf16 v[212:215], a[100:103], a[28:31], v[212:215]
ds_read_b128 a[136:139], v5 offset:0
v_mfma_f32_16x16x32_bf16 v[212:215], a[96:99], a[24:27], v[212:215]
v_permlane16_swap_b32 v108, v110
v_mfma_f32_16x16x32_bf16 v[216:219], a[104:107], a[24:27], v[216:219]
ds_read_b128 a[140:143], v5 offset:6144
v_mfma_f32_16x16x32_bf16 v[216:219], a[108:111], a[28:31], v[216:219]
v_permlane16_swap_b32 v116, v118
v_mfma_f32_16x16x32_bf16 v[192:195], a[108:111], a[20:23], v[192:195]
buffer_load_dwordx4 v1, s[4:7], s44 offen offset:2048 sc1 lds
s_add_u32 m0, s19, 49152
v_mfma_f32_16x16x32_bf16 v[192:195], a[104:107], a[16:19], v[192:195]
s_add_u32 s44, s85, 0xc04000
ds_read_b128 a[144:147], v5 offset:1024
v_mfma_f32_16x16x32_bf16 v[168:171], a[104:107], a[8:11], v[168:171]
v_add_f32 v92, v92, v94
v_add_f32 v100, v100, v102
v_mfma_f32_16x16x32_bf16 v[168:171], a[108:111], a[12:15], v[168:171]
ds_read_b128 a[148:151], v5 offset:7168
v_add_f32 v108, v108, v110
v_mfma_f32_16x16x32_bf16 v[144:147], a[108:111], a[4:7], v[144:147]
v_add_f32 v116, v116, v118
v_mov_b32 v94, v92
v_mfma_f32_16x16x32_bf16 v[144:147], a[104:107], a[0:3], v[144:147]
buffer_load_dwordx4 a[72:75], v2, s[40:43], s35 offen offset:1024 sc1
v_mfma_f32_16x16x32_bf16 v[148:151], a[112:115], a[0:3], v[148:151]
v_mov_b32 v102, v100
v_mov_b32 v110, v108
v_mfma_f32_16x16x32_bf16 v[148:151], a[116:119], a[4:7], v[148:151]
v_mov_b32 v118, v116
v_mfma_f32_16x16x32_bf16 v[172:175], a[116:119], a[12:15], v[172:175]
v_permlane32_swap_b32 v92, v94
v_mfma_f32_16x16x32_bf16 v[172:175], a[112:115], a[8:11], v[172:175]
v_permlane32_swap_b32 v100, v102
v_mfma_f32_16x16x32_bf16 v[196:199], a[112:115], a[16:19], v[196:199]
buffer_load_dwordx4 a[76:79], v2, s[40:43], s33 offen offset:1024 sc1
v_mfma_f32_16x16x32_bf16 v[196:199], a[116:119], a[20:23], v[196:199]
v_permlane32_swap_b32 v108, v110
v_mfma_f32_16x16x32_bf16 v[220:223], a[116:119], a[28:31], v[220:223]
v_permlane32_swap_b32 v116, v118
v_mfma_f32_16x16x32_bf16 v[220:223], a[112:115], a[24:27], v[220:223]
v_mul_f32 v82, 0xba800000, v92
s_waitcnt lgkmcnt(0)
v_mfma_f32_16x16x32_bf16 v[224:227], a[128:131], a[24:27], v[224:227]
ds_read_b128 a[96:99], v5 offset:14336
v_mul_f32 v84, 0xba800000, v100
v_mfma_f32_16x16x32_bf16 v[224:227], a[132:135], a[28:31], v[224:227]
buffer_load_dwordx4 a[80:83], v2, s[40:43], s35 offen offset:2048 sc1
v_mfma_f32_16x16x32_bf16 v[200:203], a[132:135], a[20:23], v[200:203]
ds_read_b128 a[100:103], v5 offset:20480
v_mul_f32 v86, 0xba800000, v108
v_mfma_f32_16x16x32_bf16 v[200:203], a[128:131], a[16:19], v[200:203]
v_mul_f32 v88, 0xba800000, v116
v_mul_f32 v94, 0x3a800000, v94
v_mfma_f32_16x16x32_bf16 v[176:179], a[128:131], a[8:11], v[176:179]
v_mul_f32 v102, 0x3a800000, v102
v_mul_f32 v110, 0x3a800000, v110
v_mfma_f32_16x16x32_bf16 v[176:179], a[132:135], a[12:15], v[176:179]
buffer_load_dwordx4 a[84:87], v2, s[40:43], s33 offen offset:2048 sc1
v_mfma_f32_16x16x32_bf16 v[152:155], a[132:135], a[4:7], v[152:155]
ds_read_b128 a[104:107], v5 offset:15360
v_mul_f32 v118, 0x3a800000, v118
v_mfma_f32_16x16x32_bf16 v[152:155], a[128:131], a[0:3], v[152:155]
v_fma_f32 v94, -v82, v82, v94
v_fma_f32 v102, -v84, v84, v102
v_mfma_f32_16x16x32_bf16 v[132:135], a[136:139], a[0:3], v[132:135]
ds_read_b128 a[108:111], v5 offset:21504
v_fma_f32 v110, -v86, v86, v110
v_mfma_f32_16x16x32_bf16 v[132:135], a[140:143], a[4:7], v[132:135]
v_fma_f32 v118, -v88, v88, v118
v_max_f32 v94, 0, v94
v_mfma_f32_16x16x32_bf16 v[156:159], a[140:143], a[12:15], v[156:159]
buffer_load_dwordx4 v1, s[4:7], s44 offen offset:0 sc1 lds
v_mfma_f32_16x16x32_bf16 v[156:159], a[136:139], a[8:11], v[156:159]
ds_read_b128 a[112:115], v5 offset:16384
v_max_f32 v102, 0, v102
v_mfma_f32_16x16x32_bf16 v[180:183], a[136:139], a[16:19], v[180:183]
v_max_f32 v110, 0, v110
v_max_f32 v118, 0, v118
v_mfma_f32_16x16x32_bf16 v[180:183], a[140:143], a[20:23], v[180:183]
ds_read_b128 a[116:119], v5 offset:22528
v_add_f32 v94, 0x3727c5ac, v94
v_mfma_f32_16x16x32_bf16 v[204:207], a[140:143], a[28:31], v[204:207]
v_add_f32 v102, 0x3727c5ac, v102
v_add_f32 v110, 0x3727c5ac, v110
v_mfma_f32_16x16x32_bf16 v[204:207], a[136:139], a[24:27], v[204:207]
buffer_load_dwordx4 a[88:91], v2, s[40:43], s35 offen offset:3072 sc1
v_mfma_f32_16x16x32_bf16 v[208:211], a[144:147], a[24:27], v[208:211]
v_add_f32 v118, 0x3727c5ac, v118
v_mfma_f32_16x16x32_bf16 v[208:211], a[148:151], a[28:31], v[208:211]
v_rsq_f32 v83, v94
v_mfma_f32_16x16x32_bf16 v[184:187], a[148:151], a[20:23], v[184:187]
v_rsq_f32 v85, v102
v_mfma_f32_16x16x32_bf16 v[184:187], a[144:147], a[16:19], v[184:187]
v_mfma_f32_16x16x32_bf16 v[160:163], a[144:147], a[8:11], v[160:163]
buffer_load_dwordx4 a[92:95], v2, s[40:43], s33 offen offset:3072 sc1
s_add_u32 s35, s35, 8192
v_mfma_f32_16x16x32_bf16 v[160:163], a[148:151], a[12:15], v[160:163]
s_add_u32 s33, s33, 8192
v_mfma_f32_16x16x32_bf16 v[136:139], a[148:151], a[4:7], v[136:139]
v_rsq_f32 v87, v110
v_mfma_f32_16x16x32_bf16 v[136:139], a[144:147], a[0:3], v[136:139]
s_waitcnt vmcnt(10) lgkmcnt(0)
v_mfma_f32_16x16x32_bf16 v[140:143], a[96:99], a[32:35], v[140:143]
ds_read_b128 a[128:131], v5 offset:17408
v_mfma_f32_16x16x32_bf16 v[140:143], a[100:103], a[36:39], v[140:143]
buffer_load_dwordx4 a[0:3], v2, s[40:43], s35 offen offset:0 sc1
v_mfma_f32_16x16x32_bf16 v[164:167], a[100:103], a[44:47], v[164:167]
ds_read_b128 a[132:135], v5 offset:23552
v_mfma_f32_16x16x32_bf16 v[164:167], a[96:99], a[40:43], v[164:167]
v_rsq_f32 v89, v118
v_mfma_f32_16x16x32_bf16 v[188:191], a[96:99], a[48:51], v[188:191]
v_mfma_f32_16x16x32_bf16 v[188:191], a[100:103], a[52:55], v[188:191]
buffer_load_dwordx4 a[4:7], v2, s[40:43], s33 offen offset:0 sc1
v_mfma_f32_16x16x32_bf16 v[212:215], a[100:103], a[60:63], v[212:215]
ds_read_b128 a[136:139], v5 offset:12288
v_mfma_f32_16x16x32_bf16 v[212:215], a[96:99], a[56:59], v[212:215]
v_mfma_f32_16x16x32_bf16 v[216:219], a[104:107], a[56:59], v[216:219]
ds_read_b128 a[140:143], v5 offset:18432
v_mfma_f32_16x16x32_bf16 v[216:219], a[108:111], a[60:63], v[216:219]
v_mfma_f32_16x16x32_bf16 v[192:195], a[108:111], a[52:55], v[192:195]
buffer_load_dwordx4 v1, s[4:7], s44 offen offset:1024 sc1 lds
v_mfma_f32_16x16x32_bf16 v[192:195], a[104:107], a[48:51], v[192:195]
ds_read_b128 a[144:147], v5 offset:13312
v_fmac_f32 v140, v56, v82
v_mfma_f32_16x16x32_bf16 v[168:171], a[104:107], a[40:43], v[168:171]
v_fmac_f32 v164, v56, v84
v_mfma_f32_16x16x32_bf16 v[168:171], a[108:111], a[44:47], v[168:171]
ds_read_b128 a[148:151], v5 offset:19456
v_mfma_f32_16x16x32_bf16 v[144:147], a[108:111], a[36:39], v[144:147]
v_fmac_f32 v188, v56, v86
v_mfma_f32_16x16x32_bf16 v[144:147], a[104:107], a[32:35], v[144:147]
buffer_load_dwordx4 a[8:11], v2, s[40:43], s35 offen offset:1024 sc1
v_mfma_f32_16x16x32_bf16 v[148:151], a[112:115], a[32:35], v[148:151]
v_fmac_f32 v212, v56, v88
v_mfma_f32_16x16x32_bf16 v[148:151], a[116:119], a[36:39], v[148:151]
v_mfma_f32_16x16x32_bf16 v[172:175], a[116:119], a[44:47], v[172:175]
v_fmac_f32 v216, v60, v88
v_mfma_f32_16x16x32_bf16 v[172:175], a[112:115], a[40:43], v[172:175]
v_mfma_f32_16x16x32_bf16 v[196:199], a[112:115], a[48:51], v[196:199]
buffer_load_dwordx4 a[12:15], v2, s[40:43], s33 offen offset:1024 sc1
v_mfma_f32_16x16x32_bf16 v[196:199], a[116:119], a[52:55], v[196:199]
v_fmac_f32 v192, v60, v86
v_mfma_f32_16x16x32_bf16 v[220:223], a[116:119], a[60:63], v[220:223]
v_fmac_f32 v168, v60, v84
v_fmac_f32 v141, v57, v82
v_mfma_f32_16x16x32_bf16 v[220:223], a[112:115], a[56:59], v[220:223]
s_waitcnt vmcnt(12) lgkmcnt(0)
s_barrier
v_mfma_f32_16x16x32_bf16 v[224:227], a[128:131], a[56:59], v[224:227]
ds_read_b128 a[96:99], v5 offset:26624
v_fmac_f32 v144, v60, v82
v_mfma_f32_16x16x32_bf16 v[224:227], a[132:135], a[60:63], v[224:227]
buffer_load_dwordx4 a[16:19], v2, s[40:43], s35 offen offset:2048 sc1
v_mfma_f32_16x16x32_bf16 v[200:203], a[132:135], a[52:55], v[200:203]
ds_read_b128 a[100:103], v5 offset:32768
v_fmac_f32 v148, v64, v82
v_mfma_f32_16x16x32_bf16 v[200:203], a[128:131], a[48:51], v[200:203]
v_fmac_f32 v165, v57, v84
v_fmac_f32 v189, v57, v86
v_mfma_f32_16x16x32_bf16 v[176:179], a[128:131], a[40:43], v[176:179]
v_fmac_f32 v172, v64, v84
v_fmac_f32 v213, v57, v88
v_mfma_f32_16x16x32_bf16 v[176:179], a[132:135], a[44:47], v[176:179]
buffer_load_dwordx4 a[20:23], v2, s[40:43], s33 offen offset:2048 sc1
v_mfma_f32_16x16x32_bf16 v[152:155], a[132:135], a[36:39], v[152:155]
ds_read_b128 a[104:107], v5 offset:27648
v_fmac_f32 v196, v64, v86
v_mfma_f32_16x16x32_bf16 v[152:155], a[128:131], a[32:35], v[152:155]
v_fmac_f32 v217, v61, v88
v_mfma_f32_16x16x32_bf16 v[132:135], a[136:139], a[32:35], v[132:135]
ds_read_b128 a[108:111], v5 offset:33792
v_fmac_f32 v220, v64, v88
v_mfma_f32_16x16x32_bf16 v[132:135], a[140:143], a[36:39], v[132:135]
v_fmac_f32 v193, v61, v86
v_mfma_f32_16x16x32_bf16 v[156:159], a[140:143], a[44:47], v[156:159]
buffer_load_dwordx4 v1, s[4:7], s44 offen offset:2048 sc1 lds
v_mfma_f32_16x16x32_bf16 v[156:159], a[136:139], a[40:43], v[156:159]
ds_read_b128 a[112:115], v5 offset:28672
v_fmac_f32 v224, v68, v88
v_mfma_f32_16x16x32_bf16 v[180:183], a[136:139], a[48:51], v[180:183]
v_fmac_f32 v200, v68, v86
v_fmac_f32 v169, v61, v84
v_mfma_f32_16x16x32_bf16 v[180:183], a[140:143], a[52:55], v[180:183]
ds_read_b128 a[116:119], v5 offset:34816
v_fmac_f32 v145, v61, v82
v_mfma_f32_16x16x32_bf16 v[204:207], a[140:143], a[60:63], v[204:207]
v_fmac_f32 v176, v68, v84
v_fmac_f32 v149, v65, v82
v_mfma_f32_16x16x32_bf16 v[204:207], a[136:139], a[56:59], v[204:207]
buffer_load_dwordx4 a[24:27], v2, s[40:43], s35 offen offset:3072 sc1
v_mfma_f32_16x16x32_bf16 v[208:211], a[144:147], a[56:59], v[208:211]
v_fmac_f32 v152, v68, v82
v_fmac_f32 v173, v65, v84
v_mfma_f32_16x16x32_bf16 v[208:211], a[148:151], a[60:63], v[208:211]
v_mfma_f32_16x16x32_bf16 v[184:187], a[148:151], a[52:55], v[184:187]
v_fmac_f32 v132, v48, v82
v_fmac_f32 v197, v65, v86
v_mfma_f32_16x16x32_bf16 v[184:187], a[144:147], a[48:51], v[184:187]
v_mfma_f32_16x16x32_bf16 v[160:163], a[144:147], a[40:43], v[160:163]
buffer_load_dwordx4 a[28:31], v2, s[40:43], s33 offen offset:3072 sc1
s_add_u32 s35, s35, 8192
v_mfma_f32_16x16x32_bf16 v[160:163], a[148:151], a[44:47], v[160:163]
s_add_u32 s33, s33, 8192
v_fmac_f32 v156, v48, v84
v_mfma_f32_16x16x32_bf16 v[136:139], a[148:151], a[36:39], v[136:139]
v_fmac_f32 v180, v48, v86
v_fmac_f32 v221, v65, v88
v_mfma_f32_16x16x32_bf16 v[136:139], a[144:147], a[32:35], v[136:139]
v_fmac_f32 v225, v69, v88
s_waitcnt vmcnt(10) lgkmcnt(0)
v_mfma_f32_16x16x32_bf16 v[140:143], a[96:99], a[64:67], v[140:143]
ds_read_b128 a[128:131], v5 offset:29696
v_fmac_f32 v204, v48, v88
v_mfma_f32_16x16x32_bf16 v[140:143], a[100:103], a[68:71], v[140:143]
buffer_load_dwordx4 v1, s[4:7], s44 offen offset:3072 sc1 lds
s_add_u32 m0, s19, 65536
v_mfma_f32_16x16x32_bf16 v[164:167], a[100:103], a[76:79], v[164:167]
s_add_u32 s44, s84, 0xc08000
ds_read_b128 a[132:135], v5 offset:35840
v_mfma_f32_16x16x32_bf16 v[164:167], a[96:99], a[72:75], v[164:167]
v_fmac_f32 v208, v52, v88
v_fmac_f32 v201, v69, v86
v_mfma_f32_16x16x32_bf16 v[188:191], a[96:99], a[80:83], v[188:191]
v_fmac_f32 v184, v52, v86
v_fmac_f32 v177, v69, v84
v_mfma_f32_16x16x32_bf16 v[188:191], a[100:103], a[84:87], v[188:191]
buffer_load_dwordx4 v1, s[4:7], s44 offen offset:0 sc1 lds
v_mfma_f32_16x16x32_bf16 v[212:215], a[100:103], a[92:95], v[212:215]
ds_read_b128 a[136:139], v5 offset:24576
v_fmac_f32 v160, v52, v84
v_mfma_f32_16x16x32_bf16 v[212:215], a[96:99], a[88:91], v[212:215]
v_fmac_f32 v153, v69, v82
v_fmac_f32 v133, v49, v82
v_mfma_f32_16x16x32_bf16 v[216:219], a[104:107], a[88:91], v[216:219]
ds_read_b128 a[140:143], v5 offset:30720
v_fmac_f32 v136, v52, v82
v_mfma_f32_16x16x32_bf16 v[216:219], a[108:111], a[92:95], v[216:219]
v_fmac_f32 v157, v49, v84
v_mfma_f32_16x16x32_bf16 v[192:195], a[108:111], a[84:87], v[192:195]
buffer_load_dwordx4 v1, s[4:7], s44 offen offset:1024 sc1 lds
v_mfma_f32_16x16x32_bf16 v[192:195], a[104:107], a[80:83], v[192:195]
ds_read_b128 a[144:147], v5 offset:25600
v_fmac_f32 v181, v49, v86
v_mfma_f32_16x16x32_bf16 v[168:171], a[104:107], a[72:75], v[168:171]
v_fmac_f32 v205, v49, v88
v_fmac_f32 v142, v58, v82
v_mfma_f32_16x16x32_bf16 v[168:171], a[108:111], a[76:79], v[168:171]
ds_read_b128 a[148:151], v5 offset:31744
v_fmac_f32 v166, v58, v84
v_mfma_f32_16x16x32_bf16 v[144:147], a[108:111], a[68:71], v[144:147]
v_fmac_f32 v209, v53, v88
v_fmac_f32 v190, v58, v86
v_mfma_f32_16x16x32_bf16 v[144:147], a[104:107], a[64:67], v[144:147]
buffer_load_dwordx4 v1, s[4:7], s44 offen offset:2048 sc1 lds
v_mfma_f32_16x16x32_bf16 v[148:151], a[112:115], a[64:67], v[148:151]
v_fmac_f32 v185, v53, v86
v_fmac_f32 v214, v58, v88
v_mfma_f32_16x16x32_bf16 v[148:151], a[116:119], a[68:71], v[148:151]
v_mfma_f32_16x16x32_bf16 v[172:175], a[116:119], a[76:79], v[172:175]
v_fmac_f32 v161, v53, v84
v_fmac_f32 v218, v62, v88
v_mfma_f32_16x16x32_bf16 v[172:175], a[112:115], a[72:75], v[172:175]
v_mfma_f32_16x16x32_bf16 v[196:199], a[112:115], a[80:83], v[196:199]
buffer_load_dwordx4 v1, s[4:7], s44 offen offset:3072 sc1 lds
s_add_u32 m0, s19, 81920
v_mfma_f32_16x16x32_bf16 v[196:199], a[116:119], a[84:87], v[196:199]
s_add_u32 s44, s85, 0xc0c000
v_fmac_f32 v137, v53, v82
v_mfma_f32_16x16x32_bf16 v[220:223], a[116:119], a[92:95], v[220:223]
v_fmac_f32 v194, v62, v86
v_fmac_f32 v170, v62, v84
v_mfma_f32_16x16x32_bf16 v[220:223], a[112:115], a[88:91], v[220:223]
v_fmac_f32 v143, v59, v82
s_waitcnt lgkmcnt(0)
v_mfma_f32_16x16x32_bf16 v[224:227], a[128:131], a[88:91], v[224:227]
ds_read_b128 a[96:99], v5 offset:38912
v_fmac_f32 v146, v62, v82
v_mfma_f32_16x16x32_bf16 v[224:227], a[132:135], a[92:95], v[224:227]
buffer_load_dwordx4 v1, s[4:7], s44 offen offset:0 sc1 lds
v_mfma_f32_16x16x32_bf16 v[200:203], a[132:135], a[84:87], v[200:203]
ds_read_b128 a[100:103], v5 offset:45056
v_fmac_f32 v150, v66, v82
v_mfma_f32_16x16x32_bf16 v[200:203], a[128:131], a[80:83], v[200:203]
v_fmac_f32 v167, v59, v84
v_fmac_f32 v191, v59, v86
v_mfma_f32_16x16x32_bf16 v[176:179], a[128:131], a[72:75], v[176:179]
v_fmac_f32 v174, v66, v84
v_fmac_f32 v215, v59, v88
v_mfma_f32_16x16x32_bf16 v[176:179], a[132:135], a[76:79], v[176:179]
buffer_load_dwordx4 v1, s[4:7], s44 offen offset:1024 sc1 lds
v_mfma_f32_16x16x32_bf16 v[152:155], a[132:135], a[68:71], v[152:155]
ds_read_b128 a[104:107], v5 offset:39936
v_fmac_f32 v198, v66, v86
v_mfma_f32_16x16x32_bf16 v[152:155], a[128:131], a[64:67], v[152:155]
v_fmac_f32 v219, v63, v88
v_mfma_f32_16x16x32_bf16 v[132:135], a[136:139], a[64:67], v[132:135]
ds_read_b128 a[108:111], v5 offset:46080
v_fmac_f32 v222, v66, v88
v_mfma_f32_16x16x32_bf16 v[132:135], a[140:143], a[68:71], v[132:135]
v_fmac_f32 v195, v63, v86
v_mfma_f32_16x16x32_bf16 v[156:159], a[140:143], a[76:79], v[156:159]
buffer_load_dwordx4 v1, s[4:7], s44 offen offset:2048 sc1 lds
v_mfma_f32_16x16x32_bf16 v[156:159], a[136:139], a[72:75], v[156:159]
ds_read_b128 a[112:115], v5 offset:40960
v_fmac_f32 v226, v70, v88
v_mfma_f32_16x16x32_bf16 v[180:183], a[136:139], a[80:83], v[180:183]
v_fmac_f32 v202, v70, v86
v_fmac_f32 v171, v63, v84
v_mfma_f32_16x16x32_bf16 v[180:183], a[140:143], a[84:87], v[180:183]
ds_read_b128 a[116:119], v5 offset:47104
v_fmac_f32 v147, v63, v82
v_mfma_f32_16x16x32_bf16 v[204:207], a[140:143], a[92:95], v[204:207]
v_fmac_f32 v178, v70, v84
v_fmac_f32 v151, v67, v82
v_mfma_f32_16x16x32_bf16 v[204:207], a[136:139], a[88:91], v[204:207]
buffer_load_dwordx4 v1, s[4:7], s44 offen offset:3072 sc1 lds
s_add_u32 m0, s19, 147456
v_mfma_f32_16x16x32_bf16 v[208:211], a[144:147], a[88:91], v[208:211]
s_add_u32 s44, s87, 0xc1c000
v_fmac_f32 v154, v70, v82
v_mfma_f32_16x16x32_bf16 v[208:211], a[148:151], a[92:95], v[208:211]
v_fmac_f32 v175, v67, v84
v_mfma_f32_16x16x32_bf16 v[184:187], a[148:151], a[84:87], v[184:187]
v_fmac_f32 v134, v50, v82
v_fmac_f32 v199, v67, v86
v_mfma_f32_16x16x32_bf16 v[184:187], a[144:147], a[80:83], v[184:187]
v_mfma_f32_16x16x32_bf16 v[160:163], a[144:147], a[72:75], v[160:163]
buffer_load_dwordx4 v1, s[4:7], s44 offen offset:0 sc1 lds
v_mfma_f32_16x16x32_bf16 v[160:163], a[148:151], a[76:79], v[160:163]
v_fmac_f32 v158, v50, v84
v_fmac_f32 v223, v67, v88
v_mfma_f32_16x16x32_bf16 v[136:139], a[148:151], a[68:71], v[136:139]
v_fmac_f32 v182, v50, v86
v_fmac_f32 v227, v71, v88
v_mfma_f32_16x16x32_bf16 v[136:139], a[144:147], a[64:67], v[136:139]
s_waitcnt vmcnt(10) lgkmcnt(0)
v_mfma_f32_16x16x32_bf16 v[140:143], a[96:99], a[0:3], v[140:143]
ds_read_b128 a[128:131], v5 offset:41984
v_fmac_f32 v206, v50, v88
v_mfma_f32_16x16x32_bf16 v[140:143], a[100:103], a[4:7], v[140:143]
buffer_load_dwordx4 v1, s[4:7], s44 offen offset:1024 sc1 lds
v_mfma_f32_16x16x32_bf16 v[164:167], a[100:103], a[12:15], v[164:167]
ds_read_b128 a[132:135], v5 offset:48128
v_fmac_f32 v210, v54, v88
v_mfma_f32_16x16x32_bf16 v[164:167], a[96:99], a[8:11], v[164:167]
v_fmac_f32 v203, v71, v86
v_fmac_f32 v179, v71, v84
v_mfma_f32_16x16x32_bf16 v[188:191], a[96:99], a[16:19], v[188:191]
v_fmac_f32 v186, v54, v86
v_fmac_f32 v155, v71, v82
v_mfma_f32_16x16x32_bf16 v[188:191], a[100:103], a[20:23], v[188:191]
buffer_load_dwordx4 v1, s[4:7], s44 offen offset:2048 sc1 lds
v_mfma_f32_16x16x32_bf16 v[212:215], a[100:103], a[28:31], v[212:215]
ds_read_b128 a[136:139], v5 offset:36864
v_fmac_f32 v162, v54, v84
v_mfma_f32_16x16x32_bf16 v[212:215], a[96:99], a[24:27], v[212:215]
v_fmac_f32 v135, v51, v82
v_mfma_f32_16x16x32_bf16 v[216:219], a[104:107], a[24:27], v[216:219]
ds_read_b128 a[140:143], v5 offset:43008
v_fmac_f32 v138, v54, v82
v_mfma_f32_16x16x32_bf16 v[216:219], a[108:111], a[28:31], v[216:219]
v_fmac_f32 v159, v51, v84
v_mfma_f32_16x16x32_bf16 v[192:195], a[108:111], a[20:23], v[192:195]
buffer_load_dwordx4 v1, s[4:7], s44 offen offset:3072 sc1 lds
s_add_u32 m0, s19, 98304
v_mfma_f32_16x16x32_bf16 v[192:195], a[104:107], a[16:19], v[192:195]
s_add_u32 s44, s84, 0xc10000
ds_read_b128 a[144:147], v5 offset:37888
v_mfma_f32_16x16x32_bf16 v[168:171], a[104:107], a[8:11], v[168:171]
v_fmac_f32 v183, v51, v86
v_fmac_f32 v207, v51, v88
v_mfma_f32_16x16x32_bf16 v[168:171], a[108:111], a[12:15], v[168:171]
ds_read_b128 a[148:151], v5 offset:44032
v_mfma_f32_16x16x32_bf16 v[144:147], a[108:111], a[4:7], v[144:147]
v_fmac_f32 v211, v55, v88
v_mfma_f32_16x16x32_bf16 v[144:147], a[104:107], a[0:3], v[144:147]
buffer_load_dwordx4 v1, s[4:7], s44 offen offset:0 sc1 lds
v_mfma_f32_16x16x32_bf16 v[148:151], a[112:115], a[0:3], v[148:151]
v_fmac_f32 v187, v55, v86
v_mfma_f32_16x16x32_bf16 v[148:151], a[116:119], a[4:7], v[148:151]
v_mfma_f32_16x16x32_bf16 v[172:175], a[116:119], a[12:15], v[172:175]
v_fmac_f32 v163, v55, v84
v_mfma_f32_16x16x32_bf16 v[172:175], a[112:115], a[8:11], v[172:175]
v_mfma_f32_16x16x32_bf16 v[196:199], a[112:115], a[16:19], v[196:199]
buffer_load_dwordx4 v1, s[4:7], s44 offen offset:1024 sc1 lds
v_mfma_f32_16x16x32_bf16 v[196:199], a[116:119], a[20:23], v[196:199]
v_fmac_f32 v139, v55, v82
v_mfma_f32_16x16x32_bf16 v[220:223], a[116:119], a[28:31], v[220:223]
v_mfma_f32_16x16x32_bf16 v[220:223], a[112:115], a[24:27], v[220:223]
s_waitcnt lgkmcnt(0)
s_barrier
v_mfma_f32_16x16x32_bf16 v[224:227], a[128:131], a[24:27], v[224:227]
v_mfma_f32_16x16x32_bf16 v[224:227], a[132:135], a[28:31], v[224:227]
buffer_load_dwordx4 v1, s[4:7], s44 offen offset:2048 sc1 lds
v_mfma_f32_16x16x32_bf16 v[200:203], a[132:135], a[20:23], v[200:203]
v_mfma_f32_16x16x32_bf16 v[200:203], a[128:131], a[16:19], v[200:203]
v_mfma_f32_16x16x32_bf16 v[176:179], a[128:131], a[8:11], v[176:179]
v_mfma_f32_16x16x32_bf16 v[176:179], a[132:135], a[12:15], v[176:179]
v_mfma_f32_16x16x32_bf16 v[152:155], a[132:135], a[4:7], v[152:155]
v_mfma_f32_16x16x32_bf16 v[152:155], a[128:131], a[0:3], v[152:155]
v_mfma_f32_16x16x32_bf16 v[132:135], a[136:139], a[0:3], v[132:135]
v_mfma_f32_16x16x32_bf16 v[132:135], a[140:143], a[4:7], v[132:135]
v_mfma_f32_16x16x32_bf16 v[156:159], a[140:143], a[12:15], v[156:159]
v_mfma_f32_16x16x32_bf16 v[156:159], a[136:139], a[8:11], v[156:159]
v_mfma_f32_16x16x32_bf16 v[180:183], a[136:139], a[16:19], v[180:183]
v_mfma_f32_16x16x32_bf16 v[180:183], a[140:143], a[20:23], v[180:183]
buffer_load_dwordx4 v1, s[4:7], s44 offen offset:3072 sc1 lds
v_mfma_f32_16x16x32_bf16 v[204:207], a[140:143], a[28:31], v[204:207]
v_mfma_f32_16x16x32_bf16 v[204:207], a[136:139], a[24:27], v[204:207]
v_mfma_f32_16x16x32_bf16 v[208:211], a[144:147], a[24:27], v[208:211]
v_mfma_f32_16x16x32_bf16 v[208:211], a[148:151], a[28:31], v[208:211]
v_mfma_f32_16x16x32_bf16 v[184:187], a[148:151], a[20:23], v[184:187]
v_mfma_f32_16x16x32_bf16 v[184:187], a[144:147], a[16:19], v[184:187]
v_mfma_f32_16x16x32_bf16 v[160:163], a[144:147], a[8:11], v[160:163]
v_mfma_f32_16x16x32_bf16 v[160:163], a[148:151], a[12:15], v[160:163]
v_mfma_f32_16x16x32_bf16 v[136:139], a[148:151], a[4:7], v[136:139]
v_mfma_f32_16x16x32_bf16 v[136:139], a[144:147], a[0:3], v[136:139]
.set L_cpf1, .
s_lshl_b32 s36, s28, 12
v_add_u32 v232, s36, v7
v_add_u32 v233, s36, v232
s_lshl_b32 s36, s28, 9
s_lshl_b32 s37, s30, 2
s_add_u32 s37, s37, s28
s_lshl_b32 s37, s37, 3
s_add_u32 s38, s37, s29
s_lshl_b32 s39, s38, 7
s_add_u32 s39, s39, 0x800000
s_lshl_b32 s38, s38, 10
s_add_u32 s38, s38, 0x400000
s_lshl_b32 s88, s28, 6
s_add_u32 s94, s80, s88
s_add_u32 s94, s94, 0x80000
s_add_u32 s88, s88, s70
s_add_u32 s89, s88, 0x80000
s_lshl_b32 s91, s30, 2
s_add_u32 s91, s91, s28
s_lshl_b32 s91, s91, 3
s_add_u32 s91, s91, s29
s_lshl_b32 s91, s91, 7
s_add_u32 s91, s91, 0x800000
buffer_store_dwordx4 a[248:251], v254, s[4:7], s91 offen offset:0 sc1
s_sub_u32 s91, s91, 0x800000
s_lshl_b32 s91, s91, 3
s_add_u32 s91, s91, 0x400000
s_add_u32 m0, s19, 114688
s_add_u32 s44, s85, 0xc14000
v_cvt_pk_bf16_f32 v140, v140, v141
v_cvt_pk_bf16_f32 v164, v164, v165
v_cvt_pk_bf16_f32 v141, v142, v143
v_cvt_pk_bf16_f32 v165, v166, v167
v_cvt_pk_bf16_f32 v142, v144, v145
v_cvt_pk_bf16_f32 v143, v146, v147
v_cvt_pk_bf16_f32 v166, v168, v169
v_cvt_pk_bf16_f32 v167, v170, v171
v_mfma_f32_16x16x32_bf16 v[92:95], a[240:243], v[140:143], 0
v_mul_f32 v240, 0x3fb8aa3b, v83
v_mul_f32 v246, 0x3fb8aa3b, v85
v_mfma_f32_16x16x32_bf16 v[108:111], a[240:243], v[164:167], 0
v_cvt_pk_bf16_f32 v188, v188, v189
v_cvt_pk_bf16_f32 v212, v212, v213
v_mfma_f32_16x16x32_bf16 v[96:99], a[244:247], v[140:143], 0
s_nop 1
v_max3_f32 v236, v92, v93, v94
v_max3_f32 v237, -v92, -v93, -v94
v_mfma_f32_16x16x32_bf16 v[112:115], a[244:247], v[164:167], 0
v_max3_f32 v242, v108, v109, v110
v_max3_f32 v243, -v108, -v109, -v110
v_cvt_pk_bf16_f32 v189, v190, v191
v_cvt_pk_bf16_f32 v213, v214, v215
v_max3_f32 v236, v236, v95, v96
L_stub7:
s_cbranch_execz L_stub8
v_max3_f32 v237, v237, -v95, -v96
v_max3_f32 v236, v236, v97, v98
buffer_store_dwordx4 a[248:251], v1, s[4:7], s91 offen offset:0 sc1
v_max3_f32 v242, v242, v111, v112
v_max3_f32 v243, v243, -v111, -v112
v_max3_f32 v237, v237, -v97, -v98
v_max3_f32 v242, v242, v113, v114
v_max3_f32 v243, v243, -v113, -v114
v_max_f32 v236, v236, v99
v_max_f32_e64 v237, v237, -v99
v_max_f32 v242, v242, v115
v_max_f32_e64 v243, v243, -v115
v_permlane32_swap_b32 v236, v237
s_nop 0
v_permlane32_swap_b32 v242, v243
v_max_f32 v236, v236, v237
v_max_f32 v242, v242, v243
v_mov_b32 v238, v236
v_mov_b32 v244, v242
v_pk_mul_f32 v[148:149], v[148:149], v[82:83] op_sel:[0,1] op_sel_hi:[1,1]
v_permlane16_swap_b32 v236, v238
v_permlane16_swap_b32 v242, v244
v_max_f32 v236, v236, v238
v_max_f32 v242, v242, v244
v_mov_b32 v238, v236
v_mov_b32 v244, v242
v_pk_mul_f32 v[172:173], v[172:173], v[84:85] op_sel:[0,1] op_sel_hi:[1,1]
v_permlane32_swap_b32 v236, v238
v_permlane32_swap_b32 v242, v244
v_mul_f32_e64 v236, -v236, v240
v_mul_f32_e64 v237, -v238, v240
v_mul_f32_e64 v242, -v242, v246
buffer_load_dwordx4 v1, s[4:7], s44 offen offset:0 sc1 lds
v_mul_f32_e64 v243, -v244, v246
v_pk_fma_f32 v[100:101], v[92:93], v[240:241], v[236:237] op_sel:[0,0,0] op_sel_hi:[1,0,0]
v_pk_fma_f32 v[102:103], v[94:95], v[240:241], v[236:237] op_sel:[0,0,0] op_sel_hi:[1,0,0]
v_pk_fma_f32 v[104:105], v[96:97], v[240:241], v[236:237] op_sel:[0,0,0] op_sel_hi:[1,0,0]
v_pk_fma_f32 v[106:107], v[98:99], v[240:241], v[236:237] op_sel:[0,0,0] op_sel_hi:[1,0,0]
v_pk_fma_f32 v[116:117], v[108:109], v[246:247], v[242:243] op_sel:[0,0,0] op_sel_hi:[1,0,0]
v_pk_fma_f32 v[118:119], v[110:111], v[246:247], v[242:243] op_sel:[0,0,0] op_sel_hi:[1,0,0]
v_pk_fma_f32 v[120:121], v[112:113], v[246:247], v[242:243] op_sel:[0,0,0] op_sel_hi:[1,0,0]
v_pk_fma_f32 v[122:123], v[114:115], v[246:247], v[242:243] op_sel:[0,0,0] op_sel_hi:[1,0,0]
v_pk_fma_f32 v[92:93], v[92:93], v[240:241], v[236:237] op_sel:[0,0,1] op_sel_hi:[1,0,1] neg_lo:[1,0,0] neg_hi:[1,0,0]
v_pk_fma_f32 v[94:95], v[94:95], v[240:241], v[236:237] op_sel:[0,0,1] op_sel_hi:[1,0,1] neg_lo:[1,0,0] neg_hi:[1,0,0]
v_pk_fma_f32 v[96:97], v[96:97], v[240:241], v[236:237] op_sel:[0,0,1] op_sel_hi:[1,0,1] neg_lo:[1,0,0] neg_hi:[1,0,0]
v_pk_fma_f32 v[98:99], v[98:99], v[240:241], v[236:237] op_sel:[0,0,1] op_sel_hi:[1,0,1] neg_lo:[1,0,0] neg_hi:[1,0,0]
v_pk_fma_f32 v[108:109], v[108:109], v[246:247], v[242:243] op_sel:[0,0,1] op_sel_hi:[1,0,1] neg_lo:[1,0,0] neg_hi:[1,0,0]
v_pk_fma_f32 v[110:111], v[110:111], v[246:247], v[242:243] op_sel:[0,0,1] op_sel_hi:[1,0,1] neg_lo:[1,0,0] neg_hi:[1,0,0]
v_pk_fma_f32 v[112:113], v[112:113], v[246:247], v[242:243] op_sel:[0,0,1] op_sel_hi:[1,0,1] neg_lo:[1,0,0] neg_hi:[1,0,0]
v_pk_fma_f32 v[114:115], v[114:115], v[246:247], v[242:243] op_sel:[0,0,1] op_sel_hi:[1,0,1] neg_lo:[1,0,0] neg_hi:[1,0,0]
v_exp_f32 v92, v92
v_exp_f32 v93, v93
v_exp_f32 v94, v94
v_exp_f32 v95, v95
v_exp_f32 v96, v96
buffer_load_dwordx4 v1, s[4:7], s44 offen offset:1024 sc1 lds
v_exp_f32 v97, v97
v_exp_f32 v98, v98
v_exp_f32 v99, v99
v_exp_f32 v108, v108
v_exp_f32 v109, v109
v_exp_f32 v110, v110
v_exp_f32 v111, v111
v_exp_f32 v112, v112
v_exp_f32 v113, v113
v_exp_f32 v114, v114
v_exp_f32 v115, v115
v_pk_mul_f32 v[150:151], v[150:151], v[82:83] op_sel:[0,1] op_sel_hi:[1,1]
v_pk_mul_f32 v[174:175], v[174:175], v[84:85] op_sel:[0,1] op_sel_hi:[1,1]
v_cvt_pk_bf16_f32 v144, v92, v93
v_cvt_pk_bf16_f32 v145, v94, v95
v_cvt_pk_bf16_f32 v146, v96, v97
buffer_load_dwordx4 v1, s[4:7], s44 offen offset:2048 sc1 lds
v_cvt_pk_bf16_f32 v147, v98, v99
v_cvt_pk_bf16_f32 v168, v108, v109
v_cvt_pk_bf16_f32 v169, v110, v111
v_cvt_pk_bf16_f32 v170, v112, v113
v_cvt_pk_bf16_f32 v171, v114, v115
v_cvt_pk_bf16_f32 v148, v148, v149
v_cvt_pk_bf16_f32 v172, v172, v173
v_pk_mul_f32 v[152:153], v[152:153], v[82:83] op_sel:[0,1] op_sel_hi:[1,1]
v_pk_mul_f32 v[154:155], v[154:155], v[82:83] op_sel:[0,1] op_sel_hi:[1,1]
v_pk_mul_f32 v[176:177], v[176:177], v[84:85] op_sel:[0,1] op_sel_hi:[1,1]
v_pk_mul_f32 v[178:179], v[178:179], v[84:85] op_sel:[0,1] op_sel_hi:[1,1]
v_cvt_pk_bf16_f32 v149, v150, v151
v_cvt_pk_bf16_f32 v173, v174, v175
v_cvt_pk_bf16_f32 v150, v152, v153
v_cvt_pk_bf16_f32 v151, v154, v155
v_cvt_pk_bf16_f32 v174, v176, v177
v_cvt_pk_bf16_f32 v175, v178, v179
v_mfma_f32_16x16x32_bf16 v[152:155], v[16:19], v[144:147], 0
v_cvt_pk_bf16_f32 v190, v192, v193
v_cvt_pk_bf16_f32 v191, v194, v195
v_mfma_f32_16x16x32_bf16 v[176:179], v[16:19], v[168:171], 0
v_cvt_pk_bf16_f32 v214, v216, v217
v_cvt_pk_bf16_f32 v215, v218, v219
v_exp_f32 v100, v100
buffer_load_dwordx4 v1, s[4:7], s44 offen offset:3072 sc1 lds
s_add_u32 m0, s19, 131072
s_add_u32 s44, s86, 0xc18000
s_lshl_b32 s91, s30, 12
s_add_u32 s91, s91, 0x2600000
v_rcp_f32 v152, v152
v_rcp_f32 v176, v176
v_pk_mul_f32 v[92:93], v[92:93], v[152:153] op_sel:[0,0] op_sel_hi:[1,0]
v_pk_mul_f32 v[94:95], v[94:95], v[152:153] op_sel:[0,0] op_sel_hi:[1,0]
v_pk_mul_f32 v[108:109], v[108:109], v[176:177] op_sel:[0,0] op_sel_hi:[1,0]
v_pk_mul_f32 v[110:111], v[110:111], v[176:177] op_sel:[0,0] op_sel_hi:[1,0]
v_pk_mul_f32 v[96:97], v[96:97], v[152:153] op_sel:[0,0] op_sel_hi:[1,0]
v_pk_mul_f32 v[98:99], v[98:99], v[152:153] op_sel:[0,0] op_sel_hi:[1,0]
v_cvt_pk_bf16_f32 v144, v92, v93
v_cvt_pk_bf16_f32 v145, v94, v95
v_pk_mul_f32 v[112:113], v[112:113], v[176:177] op_sel:[0,0] op_sel_hi:[1,0]
v_cvt_pk_bf16_f32 v168, v108, v109
v_pk_mul_f32 v[114:115], v[114:115], v[176:177] op_sel:[0,0] op_sel_hi:[1,0]
v_cvt_pk_bf16_f32 v169, v110, v111
v_mfma_f32_16x16x32_bf16 v[92:95], a[240:243], v[188:191], 0
v_cvt_pk_bf16_f32 v146, v96, v97
v_cvt_pk_bf16_f32 v147, v98, v99
v_mfma_f32_16x16x32_bf16 v[108:111], a[240:243], v[212:215], 0
v_cvt_pk_bf16_f32 v170, v112, v113
buffer_load_dwordx4 v1, s[4:7], s44 offen offset:0 sc1 lds
v_cvt_pk_bf16_f32 v171, v114, v115
v_mfma_f32_16x16x32_bf16 v[96:99], a[244:247], v[188:191], 0
s_nop 0
v_max3_f32 v236, v92, v93, v94
v_max3_f32 v237, -v92, -v93, -v94
v_mfma_f32_16x16x32_bf16 v[112:115], a[244:247], v[212:215], 0
v_max3_f32 v242, v108, v109, v110
v_max3_f32 v243, -v108, -v109, -v110
v_exp_f32 v101, v101
s_nop 0
v_max3_f32 v236, v236, v95, v96
v_max3_f32 v237, v237, -v95, -v96
v_max3_f32 v236, v236, v97, v98
v_max3_f32 v237, v237, -v97, -v98
v_max3_f32 v242, v242, v111, v112
v_max3_f32 v243, v243, -v111, -v112
v_max3_f32 v242, v242, v113, v114
v_max3_f32 v243, v243, -v113, -v114
v_max_f32 v236, v236, v99
v_max_f32_e64 v237, v237, -v99
v_max_f32 v242, v242, v115
v_max_f32_e64 v243, v243, -v115
v_exp_f32 v102, v102
v_exp_f32 v103, v103
buffer_load_dwordx4 v1, s[4:7], s44 offen offset:1024 sc1 lds
v_exp_f32 v104, v104
v_exp_f32 v105, v105
v_exp_f32 v106, v106
v_exp_f32 v107, v107
v_exp_f32 v116, v116
v_exp_f32 v117, v117
v_exp_f32 v118, v118
v_exp_f32 v119, v119
v_exp_f32 v120, v120
v_exp_f32 v121, v121
v_exp_f32 v122, v122
v_exp_f32 v123, v123
v_permlane32_swap_b32 v236, v237
v_permlane32_swap_b32 v242, v243
buffer_load_dwordx4 v1, s[4:7], s44 offen offset:2048 sc1 lds
v_cvt_pk_bf16_f32 v140, v100, v101
v_cvt_pk_bf16_f32 v141, v102, v103
v_cvt_pk_bf16_f32 v142, v104, v105
v_cvt_pk_bf16_f32 v143, v106, v107
v_cvt_pk_bf16_f32 v164, v116, v117
v_cvt_pk_bf16_f32 v165, v118, v119
v_cvt_pk_bf16_f32 v166, v120, v121
v_cvt_pk_bf16_f32 v167, v122, v123
ds_write_b64 v232, v[148:149] offset:0
ds_write_b64 v232, v[150:151] offset:512
ds_write_b64 v232, v[172:173] offset:1024
v_max_f32 v236, v236, v237
v_max_f32 v242, v242, v243
v_mfma_f32_16x16x32_bf16 v[148:151], v[16:19], v[140:143], 0
ds_write_b64 v232, v[174:175] offset:1536
v_mfma_f32_16x16x32_bf16 v[172:175], v[16:19], v[164:167], 0
v_mov_b32 v238, v236
buffer_load_dwordx4 v1, s[4:7], s44 offen offset:3072 sc1 lds
v_mov_b32 v244, v242
v_permlane16_swap_b32 v236, v238
s_nop 0
v_permlane16_swap_b32 v242, v244
v_max_f32 v236, v236, v238
v_max_f32 v242, v242, v244
v_mov_b32 v238, v236
v_mov_b32 v244, v242
v_rcp_f32 v148, v148
v_rcp_f32 v172, v172
v_permlane32_swap_b32 v236, v238
v_permlane32_swap_b32 v242, v244
v_mul_f32 v240, 0x3fb8aa3b, v87
v_mul_f32 v246, 0x3fb8aa3b, v89
v_pk_mul_f32 v[100:101], v[100:101], v[148:149] op_sel:[0,0] op_sel_hi:[1,0]
v_pk_mul_f32 v[102:103], v[102:103], v[148:149] op_sel:[0,0] op_sel_hi:[1,0]
v_pk_mul_f32 v[104:105], v[104:105], v[148:149] op_sel:[0,0] op_sel_hi:[1,0]
v_pk_mul_f32 v[106:107], v[106:107], v[148:149] op_sel:[0,0] op_sel_hi:[1,0]
v_pk_mul_f32 v[116:117], v[116:117], v[172:173] op_sel:[0,0] op_sel_hi:[1,0]
v_pk_mul_f32 v[118:119], v[118:119], v[172:173] op_sel:[0,0] op_sel_hi:[1,0]
v_pk_mul_f32 v[120:121], v[120:121], v[172:173] op_sel:[0,0] op_sel_hi:[1,0]
v_pk_mul_f32 v[122:123], v[122:123], v[172:173] op_sel:[0,0] op_sel_hi:[1,0]
buffer_store_dwordx4 a[248:251], v2, s[4:7], s91 offen offset:0 sc1
v_mul_f32_e64 v236, -v236, v240
v_mul_f32_e64 v237, -v238, v240
v_mul_f32_e64 v242, -v242, v246
v_mul_f32_e64 v243, -v244, v246
v_cvt_pk_bf16_f32 v140, v100, v101
v_cvt_pk_bf16_f32 v141, v102, v103
v_cvt_pk_bf16_f32 v142, v104, v105
v_cvt_pk_bf16_f32 v143, v106, v107
v_cvt_pk_bf16_f32 v164, v116, v117
v_cvt_pk_bf16_f32 v165, v118, v119
v_cvt_pk_bf16_f32 v166, v120, v121
v_cvt_pk_bf16_f32 v167, v122, v123
v_pk_fma_f32 v[100:101], v[92:93], v[240:241], v[236:237] op_sel:[0,0,0] op_sel_hi:[1,0,0]
v_pk_fma_f32 v[102:103], v[94:95], v[240:241], v[236:237] op_sel:[0,0,0] op_sel_hi:[1,0,0]
v_pk_fma_f32 v[104:105], v[96:97], v[240:241], v[236:237] op_sel:[0,0,0] op_sel_hi:[1,0,0]
v_pk_fma_f32 v[106:107], v[98:99], v[240:241], v[236:237] op_sel:[0,0,0] op_sel_hi:[1,0,0]
v_pk_fma_f32 v[116:117], v[108:109], v[246:247], v[242:243] op_sel:[0,0,0] op_sel_hi:[1,0,0]
v_pk_fma_f32 v[118:119], v[110:111], v[246:247], v[242:243] op_sel:[0,0,0] op_sel_hi:[1,0,0]
v_pk_fma_f32 v[120:121], v[112:113], v[246:247], v[242:243] op_sel:[0,0,0] op_sel_hi:[1,0,0]
v_pk_fma_f32 v[122:123], v[114:115], v[246:247], v[242:243] op_sel:[0,0,0] op_sel_hi:[1,0,0]
v_pk_fma_f32 v[92:93], v[92:93], v[240:241], v[236:237] op_sel:[0,0,1] op_sel_hi:[1,0,1] neg_lo:[1,0,0] neg_hi:[1,0,0]
v_pk_fma_f32 v[94:95], v[94:95], v[240:241], v[236:237] op_sel:[0,0,1] op_sel_hi:[1,0,1] neg_lo:[1,0,0] neg_hi:[1,0,0]
v_pk_fma_f32 v[96:97], v[96:97], v[240:241], v[236:237] op_sel:[0,0,1] op_sel_hi:[1,0,1] neg_lo:[1,0,0] neg_hi:[1,0,0]
v_pk_fma_f32 v[98:99], v[98:99], v[240:241], v[236:237] op_sel:[0,0,1] op_sel_hi:[1,0,1] neg_lo:[1,0,0] neg_hi:[1,0,0]
v_pk_fma_f32 v[108:109], v[108:109], v[246:247], v[242:243] op_sel:[0,0,1] op_sel_hi:[1,0,1] neg_lo:[1,0,0] neg_hi:[1,0,0]
v_pk_fma_f32 v[110:111], v[110:111], v[246:247], v[242:243] op_sel:[0,0,1] op_sel_hi:[1,0,1] neg_lo:[1,0,0] neg_hi:[1,0,0]
v_pk_fma_f32 v[112:113], v[112:113], v[246:247], v[242:243] op_sel:[0,0,1] op_sel_hi:[1,0,1] neg_lo:[1,0,0] neg_hi:[1,0,0]
v_pk_fma_f32 v[114:115], v[114:115], v[246:247], v[242:243] op_sel:[0,0,1] op_sel_hi:[1,0,1] neg_lo:[1,0,0] neg_hi:[1,0,0]
v_pk_mul_f32 v[196:197], v[196:197], v[86:87] op_sel:[0,1] op_sel_hi:[1,1]
v_pk_mul_f32 v[220:221], v[220:221], v[88:89] op_sel:[0,1] op_sel_hi:[1,1]
v_exp_f32 v100, v100
v_exp_f32 v92, v92
buffer_store_dwordx4 a[248:251], v2, s[4:7], s91 offen offset:1024 sc1
v_exp_f32 v101, v101
v_exp_f32 v93, v93
v_exp_f32 v102, v102
v_exp_f32 v94, v94
v_exp_f32 v103, v103
v_exp_f32 v95, v95
v_exp_f32 v104, v104
v_exp_f32 v96, v96
v_exp_f32 v105, v105
v_exp_f32 v97, v97
v_exp_f32 v106, v106
v_exp_f32 v98, v98
v_exp_f32 v107, v107
v_exp_f32 v99, v99
v_exp_f32 v116, v116
v_exp_f32 v108, v108
v_exp_f32 v117, v117
buffer_store_dwordx4 a[248:251], v2, s[4:7], s91 offen offset:2048 sc1
v_exp_f32 v109, v109
v_exp_f32 v118, v118
v_exp_f32 v110, v110
v_exp_f32 v119, v119
v_exp_f32 v111, v111
v_exp_f32 v120, v120
v_exp_f32 v112, v112
v_exp_f32 v121, v121
v_exp_f32 v113, v113
v_exp_f32 v122, v122
v_exp_f32 v114, v114
v_exp_f32 v123, v123
v_exp_f32 v115, v115
v_pk_mul_f32 v[198:199], v[198:199], v[86:87] op_sel:[0,1] op_sel_hi:[1,1]
v_pk_mul_f32 v[222:223], v[222:223], v[88:89] op_sel:[0,1] op_sel_hi:[1,1]
v_cvt_pk_bf16_f32 v196, v196, v197
v_cvt_pk_bf16_f32 v220, v220, v221
v_pk_mul_f32 v[200:201], v[200:201], v[86:87] op_sel:[0,1] op_sel_hi:[1,1]
v_pk_mul_f32 v[202:203], v[202:203], v[86:87] op_sel:[0,1] op_sel_hi:[1,1]
v_pk_mul_f32 v[224:225], v[224:225], v[88:89] op_sel:[0,1] op_sel_hi:[1,1]
v_pk_mul_f32 v[226:227], v[226:227], v[88:89] op_sel:[0,1] op_sel_hi:[1,1]
v_cvt_pk_bf16_f32 v197, v198, v199
v_cvt_pk_bf16_f32 v221, v222, v223
v_cvt_pk_bf16_f32 v198, v200, v201
v_cvt_pk_bf16_f32 v199, v202, v203
v_cvt_pk_bf16_f32 v222, v224, v225
v_cvt_pk_bf16_f32 v223, v226, v227
v_cvt_pk_bf16_f32 v188, v100, v101
v_cvt_pk_bf16_f32 v189, v102, v103
v_cvt_pk_bf16_f32 v190, v104, v105
v_cvt_pk_bf16_f32 v191, v106, v107
v_cvt_pk_bf16_f32 v192, v92, v93
v_cvt_pk_bf16_f32 v193, v94, v95
v_cvt_pk_bf16_f32 v194, v96, v97
v_cvt_pk_bf16_f32 v195, v98, v99
v_cvt_pk_bf16_f32 v212, v116, v117
v_cvt_pk_bf16_f32 v213, v118, v119
v_cvt_pk_bf16_f32 v214, v120, v121
v_cvt_pk_bf16_f32 v215, v122, v123
v_cvt_pk_bf16_f32 v216, v108, v109
v_cvt_pk_bf16_f32 v217, v110, v111
v_cvt_pk_bf16_f32 v218, v112, v113
v_cvt_pk_bf16_f32 v219, v114, v115
ds_write_b64 v232, v[196:197] offset:2048
ds_write_b64 v232, v[198:199] offset:2560
ds_write_b64 v232, v[220:221] offset:3072
v_mfma_f32_16x16x32_bf16 v[196:199], v[16:19], v[188:191], 0
buffer_store_dwordx4 a[248:251], v2, s[4:7], s91 offen offset:3072 sc1
ds_write_b64 v232, v[222:223] offset:3584
v_mfma_f32_16x16x32_bf16 v[200:203], v[16:19], v[192:195], 0
s_nop 4
v_rcp_f32 v196, v196
v_mfma_f32_16x16x32_bf16 v[220:223], v[16:19], v[212:215], 0
ds_write_b64 v233, v[140:141] offset:16384
v_mfma_f32_16x16x32_bf16 v[224:227], v[16:19], v[216:219], 0
v_rcp_f32 v200, v200
ds_write_b64 v233, v[142:143] offset:16896
s_nop 3
v_rcp_f32 v220, v220
v_pk_mul_f32 v[100:101], v[100:101], v[196:197] op_sel:[0,0] op_sel_hi:[1,0]
v_rcp_f32 v224, v224
v_pk_mul_f32 v[102:103], v[102:103], v[196:197] op_sel:[0,0] op_sel_hi:[1,0]
v_pk_mul_f32 v[104:105], v[104:105], v[196:197] op_sel:[0,0] op_sel_hi:[1,0]
v_pk_mul_f32 v[106:107], v[106:107], v[196:197] op_sel:[0,0] op_sel_hi:[1,0]
v_pk_mul_f32 v[92:93], v[92:93], v[200:201] op_sel:[0,0] op_sel_hi:[1,0]
v_pk_mul_f32 v[94:95], v[94:95], v[200:201] op_sel:[0,0] op_sel_hi:[1,0]
v_pk_mul_f32 v[96:97], v[96:97], v[200:201] op_sel:[0,0] op_sel_hi:[1,0]
v_pk_mul_f32 v[98:99], v[98:99], v[200:201] op_sel:[0,0] op_sel_hi:[1,0]
v_pk_mul_f32 v[116:117], v[116:117], v[220:221] op_sel:[0,0] op_sel_hi:[1,0]
v_pk_mul_f32 v[118:119], v[118:119], v[220:221] op_sel:[0,0] op_sel_hi:[1,0]
v_pk_mul_f32 v[120:121], v[120:121], v[220:221] op_sel:[0,0] op_sel_hi:[1,0]
v_pk_mul_f32 v[122:123], v[122:123], v[220:221] op_sel:[0,0] op_sel_hi:[1,0]
v_pk_mul_f32 v[108:109], v[108:109], v[224:225] op_sel:[0,0] op_sel_hi:[1,0]
v_pk_mul_f32 v[110:111], v[110:111], v[224:225] op_sel:[0,0] op_sel_hi:[1,0]
v_pk_mul_f32 v[112:113], v[112:113], v[224:225] op_sel:[0,0] op_sel_hi:[1,0]
v_pk_mul_f32 v[114:115], v[114:115], v[224:225] op_sel:[0,0] op_sel_hi:[1,0]
v_cvt_pk_bf16_f32 v188, v100, v101
v_cvt_pk_bf16_f32 v189, v102, v103
v_cvt_pk_bf16_f32 v190, v104, v105
v_cvt_pk_bf16_f32 v191, v106, v107
v_cvt_pk_bf16_f32 v192, v92, v93
v_cvt_pk_bf16_f32 v193, v94, v95
v_cvt_pk_bf16_f32 v194, v96, v97
v_cvt_pk_bf16_f32 v195, v98, v99
v_cvt_pk_bf16_f32 v212, v116, v117
v_cvt_pk_bf16_f32 v213, v118, v119
v_cvt_pk_bf16_f32 v214, v120, v121
v_cvt_pk_bf16_f32 v215, v122, v123
v_cvt_pk_bf16_f32 v216, v108, v109
v_cvt_pk_bf16_f32 v217, v110, v111
v_cvt_pk_bf16_f32 v218, v112, v113
v_cvt_pk_bf16_f32 v219, v114, v115
ds_write_b64 v233, v[144:145] offset:17408
ds_write_b64 v233, v[146:147] offset:17920
ds_write_b64 v233, v[164:165] offset:18432
v_lshlrev_b32 v235, 8, v0
v_add_u32 v234, s36, v8
v_cndmask_b32 v235, 2.0, v235, s[64:65]
ds_write_b64 v233, v[166:167] offset:18944
ds_write_b64 v233, v[168:169] offset:19456
ds_write_b64 v233, v[170:171] offset:19968
ds_write_b64 v233, v[188:189] offset:20480
ds_write_b64 v233, v[190:191] offset:20992
ds_write_b64 v233, v[192:193] offset:21504
ds_write_b64 v233, v[194:195] offset:22016
ds_write_b64 v233, v[212:213] offset:22528
ds_write_b64 v233, v[214:215] offset:23040
ds_write_b64 v233, v[216:217] offset:23552
ds_write_b64 v233, v[218:219] offset:24064
s_waitcnt vmcnt(12)
s_waitcnt lgkmcnt(0)
s_barrier
ds_read_b64_tr_b16 a[0:1], v234 offset:16384
ds_read_b64_tr_b16 a[2:3], v234 offset:18432
ds_read_b64_tr_b16 a[12:13], v234 offset:20480
ds_read_b64_tr_b16 a[14:15], v234 offset:22528
ds_read_b64_tr_b16 a[24:25], v234 offset:24576
ds_read_b64_tr_b16 a[26:27], v234 offset:26624
ds_read_b64_tr_b16 a[4:5], v8 offset:0
ds_read_b64_tr_b16 a[6:7], v8 offset:1024
ds_read_b64_tr_b16 a[8:9], v8 offset:512
ds_read_b64_tr_b16 a[10:11], v8 offset:1536
ds_read_b64_tr_b16 a[36:37], v234 offset:28672
ds_read_b64_tr_b16 a[38:39], v234 offset:30720
ds_read_b64_tr_b16 a[16:17], v8 offset:2048
ds_read_b64_tr_b16 a[18:19], v8 offset:3072
ds_read_b64_tr_b16 a[20:21], v8 offset:2560
ds_read_b64_tr_b16 a[22:23], v8 offset:3584
ds_read_b64_tr_b16 a[48:49], v234 offset:32768
ds_read_b64_tr_b16 a[50:51], v234 offset:34816
ds_read_b64_tr_b16 a[28:29], v8 offset:4096
ds_read_b64_tr_b16 a[30:31], v8 offset:5120
ds_read_b64_tr_b16 a[32:33], v8 offset:4608
ds_read_b64_tr_b16 a[34:35], v8 offset:5632
ds_read_b64_tr_b16 a[60:61], v234 offset:36864
ds_read_b64_tr_b16 a[62:63], v234 offset:38912
s_waitcnt lgkmcnt(14)
v_mfma_f32_16x16x32_bf16 v[100:103], a[0:3], v[16:19], 0
ds_read_b64_tr_b16 a[40:41], v8 offset:6144
ds_read_b64_tr_b16 a[42:43], v8 offset:7168
ds_read_b64_tr_b16 a[44:45], v8 offset:6656
ds_read_b64_tr_b16 a[46:47], v8 offset:7680
ds_read_b64_tr_b16 a[72:73], v234 offset:40960
ds_read_b64_tr_b16 a[74:75], v234 offset:43008
v_mfma_f32_16x16x32_bf16 v[100:103], a[12:15], v[16:19], v[100:103]
buffer_atomic_add v12, v235, s[4:7], s94 offen sc1
ds_read_b64_tr_b16 a[52:53], v8 offset:8192
ds_read_b64_tr_b16 a[54:55], v8 offset:9216
ds_read_b64_tr_b16 a[56:57], v8 offset:8704
ds_read_b64_tr_b16 a[58:59], v8 offset:9728
ds_read_b64_tr_b16 a[84:85], v234 offset:45056
ds_read_b64_tr_b16 a[86:87], v234 offset:47104
v_mfma_f32_16x16x32_bf16 v[100:103], a[24:27], v[16:19], v[100:103]
ds_read_b64_tr_b16 a[64:65], v8 offset:10240
ds_read_b64_tr_b16 a[66:67], v8 offset:11264
v_mfma_f32_16x16x32_bf16 v[92:95], a[0:3], a[4:7], 0
ds_read_b64_tr_b16 a[68:69], v8 offset:10752
ds_read_b64_tr_b16 a[70:71], v8 offset:11776
v_mfma_f32_16x16x32_bf16 v[96:99], a[0:3], a[8:11], 0
ds_read_b64_tr_b16 a[76:77], v8 offset:12288
s_waitcnt lgkmcnt(14)
v_mfma_f32_16x16x32_bf16 v[100:103], a[36:39], v[16:19], v[100:103]
ds_read_b64_tr_b16 a[78:79], v8 offset:13312
v_mfma_f32_16x16x32_bf16 v[92:95], a[12:15], a[16:19], v[92:95]
ds_read_b64_tr_b16 a[80:81], v8 offset:12800
ds_read_b64_tr_b16 a[82:83], v8 offset:13824
v_mfma_f32_16x16x32_bf16 v[96:99], a[12:15], a[20:23], v[96:99]
ds_read_b64_tr_b16 a[88:89], v8 offset:14336
v_mfma_f32_16x16x32_bf16 v[100:103], a[48:51], v[16:19], v[100:103]
ds_read_b64_tr_b16 a[90:91], v8 offset:15360
v_mfma_f32_16x16x32_bf16 v[92:95], a[24:27], a[28:31], v[92:95]
ds_read_b64_tr_b16 a[92:93], v8 offset:14848
ds_read_b64_tr_b16 a[94:95], v8 offset:15872
v_mfma_f32_16x16x32_bf16 v[96:99], a[24:27], a[32:35], v[96:99]
v_cvt_pk_bf16_f32 v132, v132, v133
v_cvt_pk_bf16_f32 v156, v156, v157
v_mfma_f32_16x16x32_bf16 v[100:103], a[60:63], v[16:19], v[100:103]
v_cvt_pk_bf16_f32 v180, v180, v181
v_cvt_pk_bf16_f32 v204, v204, v205
v_mfma_f32_16x16x32_bf16 v[92:95], a[36:39], a[40:43], v[92:95]
v_cvt_pk_bf16_f32 v133, v134, v135
v_cvt_pk_bf16_f32 v157, v158, v159
s_waitcnt lgkmcnt(14)
v_mfma_f32_16x16x32_bf16 v[96:99], a[36:39], a[44:47], v[96:99]
v_cvt_pk_bf16_f32 v181, v182, v183
v_cvt_pk_bf16_f32 v205, v206, v207
v_mfma_f32_16x16x32_bf16 v[100:103], a[72:75], v[16:19], v[100:103]
v_cvt_pk_bf16_f32 v134, v136, v137
v_cvt_pk_bf16_f32 v135, v138, v139
v_mfma_f32_16x16x32_bf16 v[92:95], a[48:51], a[52:55], v[92:95]
v_cvt_pk_bf16_f32 v158, v160, v161
v_cvt_pk_bf16_f32 v159, v162, v163
v_mfma_f32_16x16x32_bf16 v[96:99], a[48:51], a[56:59], v[96:99]
v_cvt_pk_bf16_f32 v182, v184, v185
v_cvt_pk_bf16_f32 v183, v186, v187
s_waitcnt lgkmcnt(12)
v_mfma_f32_16x16x32_bf16 v[100:103], a[84:87], v[16:19], v[100:103]
v_cvt_pk_bf16_f32 v206, v208, v209
v_cvt_pk_bf16_f32 v207, v210, v211
s_waitcnt lgkmcnt(10)
v_mfma_f32_16x16x32_bf16 v[92:95], a[60:63], a[64:67], v[92:95]
s_waitcnt lgkmcnt(8)
v_mfma_f32_16x16x32_bf16 v[96:99], a[60:63], a[68:71], v[96:99]
s_nop 1
v_min_u32 v100, -2, v100
v_min_u32 v101, -2, v101
s_waitcnt lgkmcnt(6)
v_mfma_f32_16x16x32_bf16 v[92:95], a[72:75], a[76:79], v[92:95]
v_min_u32 v102, -2, v102
v_min_u32 v103, -2, v103
s_waitcnt lgkmcnt(4)
v_mfma_f32_16x16x32_bf16 v[96:99], a[72:75], a[80:83], v[96:99]
buffer_store_dwordx4 v[100:103], v254, s[4:7], s39 offen sc1
s_waitcnt lgkmcnt(2)
v_mfma_f32_16x16x32_bf16 v[92:95], a[84:87], a[88:91], v[92:95]
s_waitcnt lgkmcnt(0)
v_mfma_f32_16x16x32_bf16 v[96:99], a[84:87], a[92:95], v[96:99]
s_nop 5
v_cvt_pk_bf16_f32 v92, v92, v93
v_cvt_pk_bf16_f32 v93, v94, v95
v_min_u32 v92, -2, v92
v_min_u32 v93, -2, v93
v_cvt_pk_bf16_f32 v94, v96, v97
v_cvt_pk_bf16_f32 v95, v98, v99
v_min_u32 v94, -2, v94
v_min_u32 v95, -2, v95
buffer_store_dwordx4 v[92:95], v1, s[4:7], s38 offen sc1
s_barrier
s_add_u32 m0, s19, 32768
s_add_u32 s44, s84, 0xc00000
buffer_load_dwordx4 v1, s[4:7], s44 offen offset:0 sc1 lds
v_mfma_f32_16x16x32_bf16 v[108:111], a[240:243], v[132:135], 0
v_mul_f32 v240, 0x3fb8aa3b, v83
v_mul_f32 v246, 0x3fb8aa3b, v85
v_mfma_f32_16x16x32_bf16 v[172:175], a[240:243], v[156:159], 0
v_mfma_f32_16x16x32_bf16 v[112:115], a[244:247], v[132:135], 0
s_nop 3
v_max3_f32 v236, v108, v109, v110
v_max3_f32 v237, -v108, -v109, -v110
v_mfma_f32_16x16x32_bf16 v[176:179], a[244:247], v[156:159], 0
v_max3_f32 v242, v172, v173, v174
v_max3_f32 v243, -v172, -v173, -v174
v_max3_f32 v236, v236, v111, v112
v_max3_f32 v237, v237, -v111, -v112
v_max3_f32 v236, v236, v113, v114
v_max3_f32 v237, v237, -v113, -v114
s_nop 1
v_max3_f32 v242, v242, v175, v176
v_max3_f32 v243, v243, -v175, -v176
v_max3_f32 v242, v242, v177, v178
v_max3_f32 v243, v243, -v177, -v178
v_max_f32 v236, v236, v115
buffer_load_dwordx4 v1, s[4:7], s44 offen offset:1024 sc1 lds
v_max_f32_e64 v237, v237, -v115
v_max_f32 v242, v242, v179
v_max_f32_e64 v243, v243, -v179
v_permlane32_swap_b32 v236, v237
s_nop 0
v_permlane32_swap_b32 v242, v243
v_mov_b32 v11, 0
buffer_atomic_add v11, v251, s[4:7], s89 offen sc0 sc1
v_max_f32 v236, v236, v237
v_max_f32 v242, v242, v243
v_mov_b32 v238, v236
v_mov_b32 v244, v242
s_nop 0
v_permlane16_swap_b32 v236, v238
v_permlane16_swap_b32 v242, v244
v_max_f32 v236, v236, v238
v_max_f32 v242, v242, v244
v_mov_b32 v238, v236
v_mov_b32 v244, v242
s_nop 0
v_permlane32_swap_b32 v236, v238
v_permlane32_swap_b32 v242, v244
v_mul_f32_e64 v236, -v236, v240
v_mul_f32_e64 v237, -v238, v240
buffer_load_dwordx4 v1, s[4:7], s44 offen offset:2048 sc1 lds
v_mul_f32_e64 v242, -v242, v246
v_mul_f32_e64 v243, -v244, v246
v_pk_fma_f32 v[116:117], v[108:109], v[240:241], v[236:237] op_sel:[0,0,0] op_sel_hi:[1,0,0]
v_pk_fma_f32 v[118:119], v[110:111], v[240:241], v[236:237] op_sel:[0,0,0] op_sel_hi:[1,0,0]
v_pk_fma_f32 v[120:121], v[112:113], v[240:241], v[236:237] op_sel:[0,0,0] op_sel_hi:[1,0,0]
v_pk_fma_f32 v[122:123], v[114:115], v[240:241], v[236:237] op_sel:[0,0,0] op_sel_hi:[1,0,0]
v_pk_fma_f32 v[148:149], v[172:173], v[246:247], v[242:243] op_sel:[0,0,0] op_sel_hi:[1,0,0]
v_pk_fma_f32 v[150:151], v[174:175], v[246:247], v[242:243] op_sel:[0,0,0] op_sel_hi:[1,0,0]
v_pk_fma_f32 v[152:153], v[176:177], v[246:247], v[242:243] op_sel:[0,0,0] op_sel_hi:[1,0,0]
v_pk_fma_f32 v[154:155], v[178:179], v[246:247], v[242:243] op_sel:[0,0,0] op_sel_hi:[1,0,0]
v_pk_fma_f32 v[108:109], v[108:109], v[240:241], v[236:237] op_sel:[0,0,1] op_sel_hi:[1,0,1] neg_lo:[1,0,0] neg_hi:[1,0,0]
v_pk_fma_f32 v[110:111], v[110:111], v[240:241], v[236:237] op_sel:[0,0,1] op_sel_hi:[1,0,1] neg_lo:[1,0,0] neg_hi:[1,0,0]
v_pk_fma_f32 v[112:113], v[112:113], v[240:241], v[236:237] op_sel:[0,0,1] op_sel_hi:[1,0,1] neg_lo:[1,0,0] neg_hi:[1,0,0]
v_pk_fma_f32 v[114:115], v[114:115], v[240:241], v[236:237] op_sel:[0,0,1] op_sel_hi:[1,0,1] neg_lo:[1,0,0] neg_hi:[1,0,0]
v_pk_fma_f32 v[172:173], v[172:173], v[246:247], v[242:243] op_sel:[0,0,1] op_sel_hi:[1,0,1] neg_lo:[1,0,0] neg_hi:[1,0,0]
v_pk_fma_f32 v[174:175], v[174:175], v[246:247], v[242:243] op_sel:[0,0,1] op_sel_hi:[1,0,1] neg_lo:[1,0,0] neg_hi:[1,0,0]
v_pk_fma_f32 v[176:177], v[176:177], v[246:247], v[242:243] op_sel:[0,0,1] op_sel_hi:[1,0,1] neg_lo:[1,0,0] neg_hi:[1,0,0]
v_pk_fma_f32 v[178:179], v[178:179], v[246:247], v[242:243] op_sel:[0,0,1] op_sel_hi:[1,0,1] neg_lo:[1,0,0] neg_hi:[1,0,0]
v_exp_f32 v116, v116
v_exp_f32 v108, v108
v_exp_f32 v117, v117
v_exp_f32 v109, v109
v_exp_f32 v118, v118
v_exp_f32 v110, v110
v_exp_f32 v119, v119
v_exp_f32 v111, v111
v_exp_f32 v120, v120
v_exp_f32 v112, v112
v_exp_f32 v121, v121
v_exp_f32 v113, v113
v_exp_f32 v122, v122
v_exp_f32 v114, v114
v_exp_f32 v123, v123
v_exp_f32 v115, v115
v_exp_f32 v148, v148
v_exp_f32 v172, v172
v_exp_f32 v149, v149
v_exp_f32 v173, v173
v_exp_f32 v150, v150
v_exp_f32 v174, v174
v_exp_f32 v151, v151
v_exp_f32 v175, v175
v_exp_f32 v152, v152
v_exp_f32 v176, v176
v_exp_f32 v153, v153
v_exp_f32 v177, v177
v_exp_f32 v154, v154
v_exp_f32 v178, v178
v_exp_f32 v155, v155
v_exp_f32 v179, v179
buffer_load_dwordx4 v1, s[4:7], s44 offen offset:3072 sc1 lds
v_cvt_pk_bf16_f32 v140, v116, v117
v_cvt_pk_bf16_f32 v141, v118, v119
v_cvt_pk_bf16_f32 v142, v120, v121
v_cvt_pk_bf16_f32 v143, v122, v123
v_cvt_pk_bf16_f32 v144, v108, v109
v_cvt_pk_bf16_f32 v145, v110, v111
v_cvt_pk_bf16_f32 v146, v112, v113
v_cvt_pk_bf16_f32 v147, v114, v115
v_cvt_pk_bf16_f32 v164, v148, v149
v_cvt_pk_bf16_f32 v165, v150, v151
v_cvt_pk_bf16_f32 v166, v152, v153
v_cvt_pk_bf16_f32 v167, v154, v155
v_cvt_pk_bf16_f32 v168, v172, v173
v_cvt_pk_bf16_f32 v169, v174, v175
v_cvt_pk_bf16_f32 v170, v176, v177
v_cvt_pk_bf16_f32 v171, v178, v179
s_waitcnt vmcnt(2)
v_readfirstlane_b32 s38, v11
s_nop 0
s_cmp_ge_u32 s38, 8
s_cbranch_scc1 Lpe_19
s_add_u32 s36, s88, 0x80000
s_mov_b32 s37, 0
Lpoll_18:
v_mov_b32 v11, 0
buffer_atomic_add v11, v251, s[4:7], s36 offen sc0 sc1
s_add_u32 s37, s37, 1
s_waitcnt vmcnt(0)
v_readfirstlane_b32 s38, v11
s_nop 0
s_cmp_ge_u32 s38, 8
L_stub8:
s_cbranch_execz L_wret2
s_cbranch_scc1 Lpe_19
s_cmp_lt_u32 s37, 0x100000
s_cbranch_scc1 Lpoll_18
Lpe_19:
s_lshl_b32 s37, s30, 2
s_add_u32 s37, s37, s28
s_lshl_b32 s38, s37, 13
s_add_u32 s38, s38, 0x400000
buffer_load_dwordx4 v[48:51], v1, s[4:7], s38 offen offset:0 sc1
v_and_b32 v248, 7, v0
s_add_u32 s36, s38, 4096
s_lshl_b32 s39, s37, 10
v_lshlrev_b32 v248, 7, v248
v_lshrrev_b32 v249, 4, v0
s_add_u32 s39, s39, 0x800000
v_lshl_add_u32 v248, v249, 4, v248
s_lshl_b32 s91, s30, 12
s_add_u32 s91, s91, 0x1e00000
v_mfma_f32_16x16x32_bf16 v[108:111], a[240:243], v[180:183], 0
v_mov_b32 v249, 0x3f80
v_mov_b32 v250, 1.0
buffer_load_dwordx4 v[124:127], v248, s[4:7], s39 offen sc1
v_mfma_f32_16x16x32_bf16 v[220:223], a[240:243], v[204:207], 0
v_mul_f32 v240, 0x3fb8aa3b, v87
s_nop 2
v_max3_f32 v236, v108, v109, v110
v_mfma_f32_16x16x32_bf16 v[112:115], a[244:247], v[180:183], 0
v_max3_f32 v237, -v108, -v109, -v110
v_mul_f32 v246, 0x3fb8aa3b, v89
v_mfma_f32_16x16x32_bf16 v[224:227], a[244:247], v[204:207], 0
v_max3_f32 v242, v220, v221, v222
v_max3_f32 v243, -v220, -v221, -v222
buffer_load_dwordx4 v[52:55], v1, s[4:7], s38 offen offset:1024 sc1
s_nop 1
v_max3_f32 v236, v236, v111, v112
v_max3_f32 v237, v237, -v111, -v112
s_nop 0
v_max3_f32 v242, v242, v223, v224
v_max3_f32 v243, v243, -v223, -v224
v_max3_f32 v236, v236, v113, v114
v_max3_f32 v237, v237, -v113, -v114
v_max3_f32 v242, v242, v225, v226
v_max3_f32 v243, v243, -v225, -v226
v_max_f32 v236, v236, v115
v_max_f32_e64 v237, v237, -v115
v_max_f32 v242, v242, v227
v_max_f32_e64 v243, v243, -v227
v_permlane32_swap_b32 v236, v237
buffer_load_dwordx4 v[56:59], v1, s[4:7], s38 offen offset:2048 sc1
v_permlane32_swap_b32 v242, v243
v_max_f32 v236, v236, v237
v_max_f32 v242, v242, v243
v_mov_b32 v238, v236
v_mov_b32 v244, v242
s_nop 0
v_permlane16_swap_b32 v236, v238
v_permlane16_swap_b32 v242, v244
v_max_f32 v236, v236, v238
v_max_f32 v242, v242, v244
buffer_load_dwordx4 v[60:63], v1, s[4:7], s38 offen offset:3072 sc1
v_mov_b32 v238, v236
v_mov_b32 v244, v242
s_nop 0
v_permlane32_swap_b32 v236, v238
v_permlane32_swap_b32 v242, v244
v_mul_f32_e64 v236, -v236, v240
v_mul_f32_e64 v237, -v238, v240
v_mul_f32_e64 v242, -v242, v246
v_mul_f32_e64 v243, -v244, v246
v_pk_fma_f32 v[116:117], v[108:109], v[240:241], v[236:237] op_sel:[0,0,0] op_sel_hi:[1,0,0]
v_pk_fma_f32 v[118:119], v[110:111], v[240:241], v[236:237] op_sel:[0,0,0] op_sel_hi:[1,0,0]
buffer_load_dwordx4 v[64:67], v1, s[4:7], s36 offen offset:0 sc1
v_pk_fma_f32 v[120:121], v[112:113], v[240:241], v[236:237] op_sel:[0,0,0] op_sel_hi:[1,0,0]
v_pk_fma_f32 v[122:123], v[114:115], v[240:241], v[236:237] op_sel:[0,0,0] op_sel_hi:[1,0,0]
v_pk_fma_f32 v[196:197], v[220:221], v[246:247], v[242:243] op_sel:[0,0,0] op_sel_hi:[1,0,0]
v_pk_fma_f32 v[198:199], v[222:223], v[246:247], v[242:243] op_sel:[0,0,0] op_sel_hi:[1,0,0]
v_pk_fma_f32 v[200:201], v[224:225], v[246:247], v[242:243] op_sel:[0,0,0] op_sel_hi:[1,0,0]
v_pk_fma_f32 v[202:203], v[226:227], v[246:247], v[242:243] op_sel:[0,0,0] op_sel_hi:[1,0,0]
v_pk_fma_f32 v[108:109], v[108:109], v[240:241], v[236:237] op_sel:[0,0,1] op_sel_hi:[1,0,1] neg_lo:[1,0,0] neg_hi:[1,0,0]
v_pk_fma_f32 v[110:111], v[110:111], v[240:241], v[236:237] op_sel:[0,0,1] op_sel_hi:[1,0,1] neg_lo:[1,0,0] neg_hi:[1,0,0]
v_pk_fma_f32 v[112:113], v[112:113], v[240:241], v[236:237] op_sel:[0,0,1] op_sel_hi:[1,0,1] neg_lo:[1,0,0] neg_hi:[1,0,0]
v_pk_fma_f32 v[114:115], v[114:115], v[240:241], v[236:237] op_sel:[0,0,1] op_sel_hi:[1,0,1] neg_lo:[1,0,0] neg_hi:[1,0,0]
v_pk_fma_f32 v[220:221], v[220:221], v[246:247], v[242:243] op_sel:[0,0,1] op_sel_hi:[1,0,1] neg_lo:[1,0,0] neg_hi:[1,0,0]
v_pk_fma_f32 v[222:223], v[222:223], v[246:247], v[242:243] op_sel:[0,0,1] op_sel_hi:[1,0,1] neg_lo:[1,0,0] neg_hi:[1,0,0]
v_pk_fma_f32 v[224:225], v[224:225], v[246:247], v[242:243] op_sel:[0,0,1] op_sel_hi:[1,0,1] neg_lo:[1,0,0] neg_hi:[1,0,0]
buffer_load_dwordx4 v[68:71], v1, s[4:7], s36 offen offset:1024 sc1
v_pk_fma_f32 v[226:227], v[226:227], v[246:247], v[242:243] op_sel:[0,0,1] op_sel_hi:[1,0,1] neg_lo:[1,0,0] neg_hi:[1,0,0]
v_exp_f32 v116, v116
v_exp_f32 v108, v108
v_exp_f32 v117, v117
v_exp_f32 v109, v109
v_exp_f32 v118, v118
v_exp_f32 v110, v110
buffer_load_dwordx4 v[100:103], v1, s[4:7], s36 offen offset:2048 sc1
v_exp_f32 v119, v119
v_exp_f32 v111, v111
v_exp_f32 v120, v120
v_exp_f32 v112, v112
v_exp_f32 v121, v121
v_exp_f32 v113, v113
v_exp_f32 v122, v122
buffer_load_dwordx4 v[104:107], v1, s[4:7], s36 offen offset:3072 sc1
v_exp_f32 v114, v114
v_exp_f32 v123, v123
v_exp_f32 v115, v115
v_exp_f32 v196, v196
v_exp_f32 v220, v220
v_exp_f32 v197, v197
v_exp_f32 v221, v221
buffer_store_dwordx4 a[248:251], v2, s[4:7], s91 offen offset:0 sc1
v_exp_f32 v198, v198
v_exp_f32 v222, v222
v_exp_f32 v199, v199
v_exp_f32 v223, v223
v_exp_f32 v200, v200
v_exp_f32 v224, v224
v_exp_f32 v201, v201
v_exp_f32 v225, v225
v_exp_f32 v202, v202
v_exp_f32 v226, v226
v_exp_f32 v203, v203
v_exp_f32 v227, v227
v_cvt_pk_bf16_f32 v188, v116, v117
v_cvt_pk_bf16_f32 v189, v118, v119
v_cvt_pk_bf16_f32 v190, v120, v121
v_cvt_pk_bf16_f32 v191, v122, v123
v_cvt_pk_bf16_f32 v192, v108, v109
v_cvt_pk_bf16_f32 v193, v110, v111
v_cvt_pk_bf16_f32 v194, v112, v113
v_cvt_pk_bf16_f32 v195, v114, v115
v_cvt_pk_bf16_f32 v212, v196, v197
v_cvt_pk_bf16_f32 v213, v198, v199
buffer_store_dwordx4 a[248:251], v2, s[4:7], s91 offen offset:1024 sc1
v_cvt_pk_bf16_f32 v214, v200, v201
v_cvt_pk_bf16_f32 v215, v202, v203
v_cvt_pk_bf16_f32 v216, v220, v221
v_cvt_pk_bf16_f32 v217, v222, v223
v_cvt_pk_bf16_f32 v218, v224, v225
v_cvt_pk_bf16_f32 v219, v226, v227
s_waitcnt vmcnt(10)
v_lshlrev_b32 v92, 16, v48
v_and_b32 v93, 0xffff0000, v48
v_lshlrev_b32 v94, 16, v49
v_and_b32 v95, 0xffff0000, v49
v_lshlrev_b32 v96, 16, v50
v_and_b32 v97, 0xffff0000, v50
v_lshlrev_b32 v98, 16, v51
v_and_b32 v99, 0xffff0000, v51
s_waitcnt vmcnt(9)
v_add_f32_dpp v128, v124, v124 row_ror:4 row_mask:0xf bank_mask:0xf
v_add_f32_dpp v129, v125, v125 row_ror:4 row_mask:0xf bank_mask:0xf
v_add_f32_dpp v130, v126, v126 row_ror:4 row_mask:0xf bank_mask:0xf
v_add_f32_dpp v131, v127, v127 row_ror:4 row_mask:0xf bank_mask:0xf
v_add_f32_dpp v128, v128, v128 row_ror:2 row_mask:0xf bank_mask:0xf
v_add_f32_dpp v129, v129, v129 row_ror:2 row_mask:0xf bank_mask:0xf
v_add_f32_dpp v130, v130, v130 row_ror:2 row_mask:0xf bank_mask:0xf
buffer_store_dwordx4 a[248:251], v2, s[4:7], s91 offen offset:2048 sc1
v_add_f32_dpp v131, v131, v131 row_ror:2 row_mask:0xf bank_mask:0xf
v_add_f32_dpp v128, v128, v128 row_ror:1 row_mask:0xf bank_mask:0xf
v_add_f32_dpp v129, v129, v129 row_ror:1 row_mask:0xf bank_mask:0xf
v_add_f32_dpp v130, v130, v130 row_ror:1 row_mask:0xf bank_mask:0xf
v_add_f32_dpp v131, v131, v131 row_ror:1 row_mask:0xf bank_mask:0xf
s_waitcnt vmcnt(9)
v_dot2c_f32_bf16 v92, v52, v249
v_dot2c_f32_bf16 v93, v52, v250
v_dot2c_f32_bf16 v94, v53, v249
v_dot2c_f32_bf16 v95, v53, v250
v_dot2c_f32_bf16 v96, v54, v249
v_dot2c_f32_bf16 v97, v54, v250
v_dot2c_f32_bf16 v98, v55, v249
v_dot2c_f32_bf16 v99, v55, v250
v_fma_f32 v135, v129, v130, v131
s_waitcnt vmcnt(8)
v_dot2c_f32_bf16 v92, v56, v249
v_dot2c_f32_bf16 v93, v56, v250
v_dot2c_f32_bf16 v94, v57, v249
v_dot2c_f32_bf16 v95, v57, v250
v_dot2c_f32_bf16 v96, v58, v249
v_dot2c_f32_bf16 v97, v58, v250
v_dot2c_f32_bf16 v98, v59, v249
v_dot2c_f32_bf16 v99, v59, v250
buffer_store_dwordx4 a[248:251], v2, s[4:7], s91 offen offset:3072 sc1
s_waitcnt vmcnt(8)
v_dot2c_f32_bf16 v92, v60, v249
v_dot2c_f32_bf16 v93, v60, v250
v_dot2c_f32_bf16 v94, v61, v249
v_dot2c_f32_bf16 v95, v61, v250
v_dot2c_f32_bf16 v96, v62, v249
v_dot2c_f32_bf16 v97, v62, v250
v_dot2c_f32_bf16 v98, v63, v249
v_dot2c_f32_bf16 v99, v63, v250
s_waitcnt vmcnt(7)
v_dot2c_f32_bf16 v92, v64, v249
v_dot2c_f32_bf16 v93, v64, v250
v_dot2c_f32_bf16 v94, v65, v249
v_dot2c_f32_bf16 v95, v65, v250
v_dot2c_f32_bf16 v96, v66, v249
v_dot2c_f32_bf16 v97, v66, v250
v_dot2c_f32_bf16 v98, v67, v249
v_dot2c_f32_bf16 v99, v67, v250
s_waitcnt vmcnt(6)
v_dot2c_f32_bf16 v92, v68, v249
v_dot2c_f32_bf16 v93, v68, v250
v_dot2c_f32_bf16 v94, v69, v249
v_dot2c_f32_bf16 v95, v69, v250
v_dot2c_f32_bf16 v96, v70, v249
v_dot2c_f32_bf16 v97, v70, v250
v_dot2c_f32_bf16 v98, v71, v249
v_dot2c_f32_bf16 v99, v71, v250
s_waitcnt vmcnt(5)
v_dot2c_f32_bf16 v92, v100, v249
v_dot2c_f32_bf16 v93, v100, v250
v_dot2c_f32_bf16 v94, v101, v249
v_dot2c_f32_bf16 v95, v101, v250
v_dot2c_f32_bf16 v96, v102, v249
v_dot2c_f32_bf16 v97, v102, v250
v_dot2c_f32_bf16 v98, v103, v249
v_dot2c_f32_bf16 v99, v103, v250
s_waitcnt vmcnt(4)
v_dot2c_f32_bf16 v92, v104, v249
v_dot2c_f32_bf16 v93, v104, v250
v_dot2c_f32_bf16 v94, v105, v249
v_dot2c_f32_bf16 v95, v105, v250
v_dot2c_f32_bf16 v96, v106, v249
v_dot2c_f32_bf16 v97, v106, v250
v_dot2c_f32_bf16 v98, v107, v249
v_dot2c_f32_bf16 v99, v107, v250
v_fma_f32 v132, v92, v93, v94
v_fma_f32 v133, v95, v96, v97
s_nop 0
v_fma_f32 v134, v98, v99, v128
v_fma_f32 v132, v132, v133, v134
v_cmp_u_f32 vcc, v132, v135
s_cbranch_vccnz L_kvredo1
L_kvback1:
s_lshr_b32 s36, s28, 1
s_and_b32 s37, s28, 1
v_cvt_pk_bf16_f32 v128, v128, v129
v_cvt_pk_bf16_f32 v129, v130, v131
s_mul_i32 s36, s36, 3072
s_lshl_b32 s37, s37, 3
v_cvt_pk_bf16_f32 v92, v92, v93
v_cndmask_b32 v128, 0, v128, s[56:57]
v_cndmask_b32 v129, 0, v129, s[56:57]
s_add_u32 s36, s36, s37
v_cvt_pk_bf16_f32 v93, v94, v95
v_cvt_pk_bf16_f32 v94, v96, v97
v_cvt_pk_bf16_f32 v95, v98, v99
v_cndmask_b32 v128, v128, v16, s[58:59]
v_cndmask_b32 v129, v129, v16, s[58:59]
v_add_u32 v236, s36, v1
s_lshl_b32 s35, s30, 12
ds_write_b64 v236, v[92:93] offset:0
ds_write_b64 v236, v[94:95] offset:1024
ds_write_b64 v236, v[128:129] offset:2048
s_add_u32 s35, s35, 0x2600000
s_add_u32 s94, s71, 0x10080
s_waitcnt lgkmcnt(0)
s_barrier
ds_read_b128 a[8:11], v1 offset:2048
ds_read_b128 a[20:23], v1 offset:5120
ds_read_b128 a[0:3], v1 offset:0
ds_read_b128 a[12:15], v1 offset:3072
ds_read_b128 a[4:7], v1 offset:1024
ds_read_b128 a[16:19], v1 offset:4096
s_waitcnt lgkmcnt(5)
v_mfma_f32_16x16x32_bf16 v[92:95], a[8:11], v[140:143], 0
s_waitcnt lgkmcnt(4)
v_mfma_f32_16x16x32_bf16 v[96:99], a[20:23], v[144:147], 0
s_waitcnt lgkmcnt(3)
v_mfma_f32_16x16x32_bf16 v[132:135], a[0:3], v[140:143], 0
s_nop 3
v_rcp_f32 v94, v93
s_waitcnt lgkmcnt(2)
v_mfma_f32_16x16x32_bf16 v[148:151], a[12:15], v[144:147], 0
v_rcp_f32 v95, v97
v_mul_f32 v92, v92, v94
v_fmac_f32 v92, v96, v95
v_mfma_f32_16x16x32_bf16 v[100:103], a[8:11], v[164:167], 0
v_add_f32 v92, 0x358637bd, v92
v_rcp_f32 v92, v92
s_waitcnt lgkmcnt(1)
v_mfma_f32_16x16x32_bf16 v[136:139], a[4:7], v[140:143], 0
v_mul_f32 v94, v94, v92
v_mul_f32 v95, v95, v92
v_mfma_f32_16x16x32_bf16 v[104:107], a[20:23], v[168:171], 0
v_mul_f32 v132, v132, v94
v_mul_f32 v133, v133, v94
s_waitcnt lgkmcnt(0)
v_mfma_f32_16x16x32_bf16 v[152:155], a[16:19], v[144:147], 0
v_mul_f32 v134, v134, v94
v_mul_f32 v135, v135, v94
v_fmac_f32 v132, v148, v95
v_fmac_f32 v133, v149, v95
v_rcp_f32 v102, v101
v_mul_f32 v136, v136, v94
v_mul_f32 v137, v137, v94
v_mul_f32 v138, v138, v94
v_mul_f32 v139, v139, v94
v_fmac_f32 v134, v150, v95
v_fmac_f32 v135, v151, v95
v_cvt_pk_bf16_f32 v132, v132, v133
v_rcp_f32 v103, v105
v_fmac_f32 v136, v152, v95
v_fmac_f32 v137, v153, v95
v_fmac_f32 v138, v154, v95
v_fmac_f32 v139, v155, v95
v_cvt_pk_bf16_f32 v133, v134, v135
v_cvt_pk_bf16_f32 v134, v136, v137
v_cvt_pk_bf16_f32 v135, v138, v139
v_mul_f32 v100, v100, v102
v_mfma_f32_16x16x32_bf16 v[156:159], a[0:3], v[164:167], 0
buffer_store_dwordx4 v[132:135], v2, s[4:7], s35 offen offset:0 sc1
v_fmac_f32 v100, v104, v103
v_mfma_f32_16x16x32_bf16 v[172:175], a[12:15], v[168:171], 0
v_add_f32 v100, 0x358637bd, v100
v_rcp_f32 v100, v100
v_mfma_f32_16x16x32_bf16 v[108:111], a[8:11], v[188:191], 0
v_mul_f32 v102, v102, v100
v_mul_f32 v103, v103, v100
v_mfma_f32_16x16x32_bf16 v[160:163], a[4:7], v[164:167], 0
v_mul_f32 v156, v156, v102
v_mul_f32 v157, v157, v102
v_mfma_f32_16x16x32_bf16 v[112:115], a[20:23], v[192:195], 0
v_mul_f32 v158, v158, v102
v_mul_f32 v159, v159, v102
v_mfma_f32_16x16x32_bf16 v[176:179], a[16:19], v[168:171], 0
v_fmac_f32 v156, v172, v103
v_fmac_f32 v157, v173, v103
v_rcp_f32 v110, v109
v_mul_f32 v160, v160, v102
v_mul_f32 v161, v161, v102
v_mul_f32 v162, v162, v102
v_mul_f32 v163, v163, v102
v_fmac_f32 v158, v174, v103
v_fmac_f32 v159, v175, v103
v_cvt_pk_bf16_f32 v156, v156, v157
v_rcp_f32 v111, v113
v_fmac_f32 v160, v176, v103
v_fmac_f32 v161, v177, v103
v_fmac_f32 v162, v178, v103
v_fmac_f32 v163, v179, v103
v_cvt_pk_bf16_f32 v157, v158, v159
v_cvt_pk_bf16_f32 v158, v160, v161
v_cvt_pk_bf16_f32 v159, v162, v163
v_mul_f32 v108, v108, v110
v_mfma_f32_16x16x32_bf16 v[180:183], a[0:3], v[188:191], 0
buffer_store_dwordx4 v[156:159], v2, s[4:7], s35 offen offset:1024 sc1
v_fmac_f32 v108, v112, v111
v_mfma_f32_16x16x32_bf16 v[196:199], a[12:15], v[192:195], 0
v_add_f32 v108, 0x358637bd, v108
v_rcp_f32 v108, v108
v_mfma_f32_16x16x32_bf16 v[116:119], a[8:11], v[212:215], 0
v_mul_f32 v110, v110, v108
v_mul_f32 v111, v111, v108
v_mfma_f32_16x16x32_bf16 v[184:187], a[4:7], v[188:191], 0
v_mul_f32 v180, v180, v110
v_mul_f32 v181, v181, v110
v_mfma_f32_16x16x32_bf16 v[120:123], a[20:23], v[216:219], 0
v_mul_f32 v182, v182, v110
v_mul_f32 v183, v183, v110
v_mfma_f32_16x16x32_bf16 v[200:203], a[16:19], v[192:195], 0
v_fmac_f32 v180, v196, v111
v_fmac_f32 v181, v197, v111
v_rcp_f32 v118, v117
v_mul_f32 v184, v184, v110
v_mul_f32 v185, v185, v110
v_mul_f32 v186, v186, v110
v_mul_f32 v187, v187, v110
v_fmac_f32 v182, v198, v111
v_fmac_f32 v183, v199, v111
v_cvt_pk_bf16_f32 v180, v180, v181
v_rcp_f32 v119, v121
buffer_atomic_add v12, v10, s[4:7], s94 offen sc1
v_fmac_f32 v184, v200, v111
v_fmac_f32 v185, v201, v111
v_fmac_f32 v186, v202, v111
v_fmac_f32 v187, v203, v111
v_cvt_pk_bf16_f32 v181, v182, v183
v_cvt_pk_bf16_f32 v182, v184, v185
v_cvt_pk_bf16_f32 v183, v186, v187
v_mul_f32 v116, v116, v118
v_mfma_f32_16x16x32_bf16 v[204:207], a[0:3], v[212:215], 0
buffer_store_dwordx4 v[180:183], v2, s[4:7], s35 offen offset:2048 sc1
v_fmac_f32 v116, v120, v119
v_mfma_f32_16x16x32_bf16 v[220:223], a[12:15], v[216:219], 0
v_add_f32 v116, 0x358637bd, v116
v_rcp_f32 v116, v116
v_mfma_f32_16x16x32_bf16 v[208:211], a[4:7], v[212:215], 0
v_mul_f32 v118, v118, v116
v_mul_f32 v119, v119, v116
v_mfma_f32_16x16x32_bf16 v[224:227], a[16:19], v[216:219], 0
v_mul_f32 v204, v204, v118
v_mul_f32 v205, v205, v118
v_mul_f32 v206, v206, v118
v_mul_f32 v207, v207, v118
v_fmac_f32 v204, v220, v119
v_fmac_f32 v205, v221, v119
v_mul_f32 v208, v208, v118
v_mul_f32 v209, v209, v118
v_mul_f32 v210, v210, v118
v_mul_f32 v211, v211, v118
v_fmac_f32 v206, v222, v119
v_fmac_f32 v207, v223, v119
v_cvt_pk_bf16_f32 v204, v204, v205
v_fmac_f32 v208, v224, v119
v_fmac_f32 v209, v225, v119
v_fmac_f32 v210, v226, v119
v_fmac_f32 v211, v227, v119
v_cvt_pk_bf16_f32 v205, v206, v207
v_cvt_pk_bf16_f32 v206, v208, v209
v_cvt_pk_bf16_f32 v207, v210, v211
buffer_store_dwordx4 v[204:207], v2, s[4:7], s35 offen offset:3072 sc1
s_add_u32 s92, s71, 0x10000
s_add_u32 s36, s66, 0x10080
s_add_u32 s40, s4, 0x2600000
s_addc_u32 s41, s5, 0
v_add_u32 v5, 32768, v1
v_add_u32 v6, 98304, v1
s_cmp_eq_u32 s3, 0
s_cselect_b32 s35, 8, 0
s_lshl_b32 s35, s35, 12
v_lshlrev_b32 v132, 16, v32
v_and_b32 v133, 0xffff0000, v32
v_lshlrev_b32 v134, 16, v33
v_and_b32 v135, 0xffff0000, v33
v_lshlrev_b32 v136, 16, v34
v_and_b32 v137, 0xffff0000, v34
v_lshlrev_b32 v138, 16, v35
v_and_b32 v139, 0xffff0000, v35
v_lshlrev_b32 v140, 16, v36
v_and_b32 v141, 0xffff0000, v36
v_lshlrev_b32 v142, 16, v37
v_and_b32 v143, 0xffff0000, v37
v_lshlrev_b32 v144, 16, v38
v_and_b32 v145, 0xffff0000, v38
v_lshlrev_b32 v146, 16, v39
v_and_b32 v147, 0xffff0000, v39
v_lshlrev_b32 v148, 16, v40
v_and_b32 v149, 0xffff0000, v40
v_lshlrev_b32 v150, 16, v41
v_and_b32 v151, 0xffff0000, v41
v_lshlrev_b32 v152, 16, v42
v_and_b32 v153, 0xffff0000, v42
v_lshlrev_b32 v154, 16, v43
v_and_b32 v155, 0xffff0000, v43
v_lshlrev_b32 v156, 16, v44
v_and_b32 v157, 0xffff0000, v44
v_lshlrev_b32 v158, 16, v45
v_and_b32 v159, 0xffff0000, v45
v_lshlrev_b32 v160, 16, v46
v_and_b32 v161, 0xffff0000, v46
v_lshlrev_b32 v162, 16, v47
v_and_b32 v163, 0xffff0000, v47
s_mov_b32 s95, -1
s_mov_b64 exec, 0
s_cmp_eq_u32 s28, 3
s_cbranch_scc1 L_stub9
s_cmp_eq_u32 s28, 2
s_cbranch_scc1 L_wret3
L_wret3:
s_mov_b64 exec, -1
s_cmp_lg_u32 s28, 0
s_cbranch_scc1 Lpe_21
s_add_u32 s36, s66, 0x10080
s_mov_b32 s37, 0
Lpoll_20:
v_mov_b32 v11, 0
buffer_atomic_add v11, v251, s[4:7], s36 offen sc0 sc1
s_add_u32 s37, s37, 1
s_waitcnt vmcnt(0)
v_readfirstlane_b32 s38, v11
s_nop 0
s_cmp_ge_u32 s38, 32
s_cbranch_scc1 Lpe_21
s_cmp_lt_u32 s37, 0x100000
s_cbranch_scc1 Lpoll_20
Lpe_21:
s_waitcnt vmcnt(0)
s_barrier
L_k2go1:
buffer_load_dwordx4 a[0:3], v4, s[40:43], s35 offen offset:0 sc1
buffer_load_dwordx4 a[4:7], v4, s[40:43], s35 offen offset:1024 sc1
s_cmp_eq_u32 s3, 1
s_cselect_b32 s35, 9, 1
s_lshl_b32 s35, s35, 12
buffer_load_dwordx4 a[8:11], v4, s[40:43], s35 offen offset:0 sc1
buffer_load_dwordx4 a[12:15], v4, s[40:43], s35 offen offset:1024 sc1
s_cmp_eq_u32 s3, 2
s_cselect_b32 s35, 10, 2
s_lshl_b32 s35, s35, 12
buffer_load_dwordx4 a[16:19], v4, s[40:43], s35 offen offset:0 sc1
buffer_load_dwordx4 a[20:23], v4, s[40:43], s35 offen offset:1024 sc1
s_cmp_eq_u32 s3, 3
s_cselect_b32 s35, 11, 3
s_lshl_b32 s35, s35, 12
buffer_load_dwordx4 a[24:27], v4, s[40:43], s35 offen offset:0 sc1
buffer_load_dwordx4 a[28:31], v4, s[40:43], s35 offen offset:1024 sc1
s_cmp_eq_u32 s3, 4
s_cselect_b32 s35, 12, 4
s_lshl_b32 s35, s35, 12
buffer_load_dwordx4 a[32:35], v4, s[40:43], s35 offen offset:0 sc1
buffer_load_dwordx4 a[36:39], v4, s[40:43], s35 offen offset:1024 sc1
s_cmp_eq_u32 s3, 5
s_cselect_b32 s35, 13, 5
s_lshl_b32 s35, s35, 12
ds_read_b128 a[96:99], v5 offset:0
ds_read_b128 a[100:103], v5 offset:1024
ds_read_b128 a[104:107], v5 offset:2048
ds_read_b128 a[108:111], v5 offset:3072
ds_read_b128 a[112:115], v5 offset:4096
ds_read_b128 a[116:119], v5 offset:5120
ds_read_b128 a[120:123], v5 offset:6144
ds_read_b128 a[124:127], v5 offset:7168
s_waitcnt vmcnt(8) lgkmcnt(4)
v_mfma_f32_16x16x32_bf16 v[132:135], a[96:99], a[0:3], v[132:135]
ds_read_b128 a[128:131], v5 offset:8192
v_mfma_f32_16x16x32_bf16 v[148:151], a[96:99], a[4:7], v[148:151]
ds_read_b128 a[132:135], v5 offset:9216
v_mfma_f32_16x16x32_bf16 v[152:155], a[100:103], a[4:7], v[152:155]
buffer_load_dwordx4 a[40:43], v4, s[40:43], s35 offen offset:0 sc1
v_mfma_f32_16x16x32_bf16 v[136:139], a[100:103], a[0:3], v[136:139]
ds_read_b128 a[136:139], v5 offset:10240
v_mfma_f32_16x16x32_bf16 v[140:143], a[104:107], a[0:3], v[140:143]
ds_read_b128 a[140:143], v5 offset:11264
v_mfma_f32_16x16x32_bf16 v[156:159], a[104:107], a[4:7], v[156:159]
v_mfma_f32_16x16x32_bf16 v[160:163], a[108:111], a[4:7], v[160:163]
buffer_load_dwordx4 a[44:47], v4, s[40:43], s35 offen offset:1024 sc1
v_mfma_f32_16x16x32_bf16 v[144:147], a[108:111], a[0:3], v[144:147]
s_waitcnt vmcnt(8) lgkmcnt(4)
v_mfma_f32_16x16x32_bf16 v[132:135], a[112:115], a[8:11], v[132:135]
s_cmp_eq_u32 s3, 6
s_cselect_b32 s35, 14, 6
s_lshl_b32 s35, s35, 12
v_mfma_f32_16x16x32_bf16 v[148:151], a[112:115], a[12:15], v[148:151]
ds_read_b128 a[96:99], v5 offset:12288
v_mfma_f32_16x16x32_bf16 v[152:155], a[116:119], a[12:15], v[152:155]
buffer_load_dwordx4 a[0:3], v4, s[40:43], s35 offen offset:0 sc1
v_mfma_f32_16x16x32_bf16 v[136:139], a[116:119], a[8:11], v[136:139]
ds_read_b128 a[100:103], v5 offset:13312
v_mfma_f32_16x16x32_bf16 v[140:143], a[120:123], a[8:11], v[140:143]
ds_read_b128 a[104:107], v5 offset:14336
v_mfma_f32_16x16x32_bf16 v[156:159], a[120:123], a[12:15], v[156:159]
ds_read_b128 a[108:111], v5 offset:15360
v_mfma_f32_16x16x32_bf16 v[160:163], a[124:127], a[12:15], v[160:163]
buffer_load_dwordx4 a[4:7], v4, s[40:43], s35 offen offset:1024 sc1
v_mfma_f32_16x16x32_bf16 v[144:147], a[124:127], a[8:11], v[144:147]
s_waitcnt vmcnt(8) lgkmcnt(4)
v_mfma_f32_16x16x32_bf16 v[132:135], a[128:131], a[16:19], v[132:135]
s_cmp_eq_u32 s3, 7
s_cselect_b32 s35, 15, 7
s_lshl_b32 s35, s35, 12
v_mfma_f32_16x16x32_bf16 v[148:151], a[128:131], a[20:23], v[148:151]
ds_read_b128 a[112:115], v5 offset:16384
v_mfma_f32_16x16x32_bf16 v[152:155], a[132:135], a[20:23], v[152:155]
buffer_load_dwordx4 a[8:11], v4, s[40:43], s35 offen offset:0 sc1
v_mfma_f32_16x16x32_bf16 v[136:139], a[132:135], a[16:19], v[136:139]
ds_read_b128 a[116:119], v5 offset:17408
v_mfma_f32_16x16x32_bf16 v[140:143], a[136:139], a[16:19], v[140:143]
ds_read_b128 a[120:123], v5 offset:18432
v_mfma_f32_16x16x32_bf16 v[156:159], a[136:139], a[20:23], v[156:159]
ds_read_b128 a[124:127], v5 offset:19456
v_mfma_f32_16x16x32_bf16 v[160:163], a[140:143], a[20:23], v[160:163]
buffer_load_dwordx4 a[12:15], v4, s[40:43], s35 offen offset:1024 sc1
v_mfma_f32_16x16x32_bf16 v[144:147], a[140:143], a[16:19], v[144:147]
s_waitcnt vmcnt(8) lgkmcnt(4)
v_mfma_f32_16x16x32_bf16 v[132:135], a[96:99], a[24:27], v[132:135]
s_cmp_eq_u32 s3, 0
s_cselect_b32 s35, 16, 8
s_lshl_b32 s35, s35, 12
v_mfma_f32_16x16x32_bf16 v[148:151], a[96:99], a[28:31], v[148:151]
ds_read_b128 a[128:131], v5 offset:20480
v_mfma_f32_16x16x32_bf16 v[152:155], a[100:103], a[28:31], v[152:155]
buffer_load_dwordx4 a[16:19], v4, s[40:43], s35 offen offset:0 sc1
v_mfma_f32_16x16x32_bf16 v[136:139], a[100:103], a[24:27], v[136:139]
ds_read_b128 a[132:135], v5 offset:21504
v_mfma_f32_16x16x32_bf16 v[140:143], a[104:107], a[24:27], v[140:143]
ds_read_b128 a[136:139], v5 offset:22528
v_mfma_f32_16x16x32_bf16 v[156:159], a[104:107], a[28:31], v[156:159]
ds_read_b128 a[140:143], v5 offset:23552
v_mfma_f32_16x16x32_bf16 v[160:163], a[108:111], a[28:31], v[160:163]
buffer_load_dwordx4 a[20:23], v4, s[40:43], s35 offen offset:1024 sc1
v_mfma_f32_16x16x32_bf16 v[144:147], a[108:111], a[24:27], v[144:147]
s_waitcnt vmcnt(8) lgkmcnt(4)
v_mfma_f32_16x16x32_bf16 v[132:135], a[112:115], a[32:35], v[132:135]
s_cmp_eq_u32 s3, 1
s_cselect_b32 s35, 17, 9
s_lshl_b32 s35, s35, 12
v_mfma_f32_16x16x32_bf16 v[148:151], a[112:115], a[36:39], v[148:151]
ds_read_b128 a[96:99], v5 offset:24576
v_mfma_f32_16x16x32_bf16 v[152:155], a[116:119], a[36:39], v[152:155]
buffer_load_dwordx4 a[24:27], v4, s[40:43], s35 offen offset:0 sc1
v_mfma_f32_16x16x32_bf16 v[136:139], a[116:119], a[32:35], v[136:139]
ds_read_b128 a[100:103], v5 offset:25600
v_mfma_f32_16x16x32_bf16 v[140:143], a[120:123], a[32:35], v[140:143]
ds_read_b128 a[104:107], v5 offset:26624
v_mfma_f32_16x16x32_bf16 v[156:159], a[120:123], a[36:39], v[156:159]
ds_read_b128 a[108:111], v5 offset:27648
v_mfma_f32_16x16x32_bf16 v[160:163], a[124:127], a[36:39], v[160:163]
buffer_load_dwordx4 a[28:31], v4, s[40:43], s35 offen offset:1024 sc1
v_mfma_f32_16x16x32_bf16 v[144:147], a[124:127], a[32:35], v[144:147]
s_waitcnt vmcnt(8) lgkmcnt(4)
v_mfma_f32_16x16x32_bf16 v[132:135], a[128:131], a[40:43], v[132:135]
s_cmp_eq_u32 s3, 2
s_cselect_b32 s35, 18, 10
s_lshl_b32 s35, s35, 12
v_mfma_f32_16x16x32_bf16 v[148:151], a[128:131], a[44:47], v[148:151]
ds_read_b128 a[112:115], v5 offset:28672
v_mfma_f32_16x16x32_bf16 v[152:155], a[132:135], a[44:47], v[152:155]
buffer_load_dwordx4 a[32:35], v4, s[40:43], s35 offen offset:0 sc1
v_mfma_f32_16x16x32_bf16 v[136:139], a[132:135], a[40:43], v[136:139]
ds_read_b128 a[116:119], v5 offset:29696
v_mfma_f32_16x16x32_bf16 v[140:143], a[136:139], a[40:43], v[140:143]
ds_read_b128 a[120:123], v5 offset:30720
v_mfma_f32_16x16x32_bf16 v[156:159], a[136:139], a[44:47], v[156:159]
ds_read_b128 a[124:127], v5 offset:31744
v_mfma_f32_16x16x32_bf16 v[160:163], a[140:143], a[44:47], v[160:163]
buffer_load_dwordx4 a[36:39], v4, s[40:43], s35 offen offset:1024 sc1
v_mfma_f32_16x16x32_bf16 v[144:147], a[140:143], a[40:43], v[144:147]
s_waitcnt vmcnt(8) lgkmcnt(4)
v_mfma_f32_16x16x32_bf16 v[132:135], a[96:99], a[0:3], v[132:135]
s_cmp_eq_u32 s3, 3
s_cselect_b32 s35, 19, 11
s_lshl_b32 s35, s35, 12
v_mfma_f32_16x16x32_bf16 v[148:151], a[96:99], a[4:7], v[148:151]
ds_read_b128 a[128:131], v5 offset:32768
v_mfma_f32_16x16x32_bf16 v[152:155], a[100:103], a[4:7], v[152:155]
buffer_load_dwordx4 a[40:43], v4, s[40:43], s35 offen offset:0 sc1
v_mfma_f32_16x16x32_bf16 v[136:139], a[100:103], a[0:3], v[136:139]
ds_read_b128 a[132:135], v5 offset:33792
v_mfma_f32_16x16x32_bf16 v[140:143], a[104:107], a[0:3], v[140:143]
ds_read_b128 a[136:139], v5 offset:34816
v_mfma_f32_16x16x32_bf16 v[156:159], a[104:107], a[4:7], v[156:159]
ds_read_b128 a[140:143], v5 offset:35840
v_mfma_f32_16x16x32_bf16 v[160:163], a[108:111], a[4:7], v[160:163]
buffer_load_dwordx4 a[44:47], v4, s[40:43], s35 offen offset:1024 sc1
v_mfma_f32_16x16x32_bf16 v[144:147], a[108:111], a[0:3], v[144:147]
s_waitcnt vmcnt(8) lgkmcnt(4)
v_mfma_f32_16x16x32_bf16 v[132:135], a[112:115], a[8:11], v[132:135]
s_cmp_eq_u32 s3, 4
s_cselect_b32 s35, 20, 12
s_lshl_b32 s35, s35, 12
v_mfma_f32_16x16x32_bf16 v[148:151], a[112:115], a[12:15], v[148:151]
ds_read_b128 a[96:99], v5 offset:36864
v_mfma_f32_16x16x32_bf16 v[152:155], a[116:119], a[12:15], v[152:155]
buffer_load_dwordx4 a[0:3], v4, s[40:43], s35 offen offset:0 sc1
v_mfma_f32_16x16x32_bf16 v[136:139], a[116:119], a[8:11], v[136:139]
ds_read_b128 a[100:103], v5 offset:37888
v_mfma_f32_16x16x32_bf16 v[140:143], a[120:123], a[8:11], v[140:143]
ds_read_b128 a[104:107], v5 offset:38912
v_mfma_f32_16x16x32_bf16 v[156:159], a[120:123], a[12:15], v[156:159]
ds_read_b128 a[108:111], v5 offset:39936
v_mfma_f32_16x16x32_bf16 v[160:163], a[124:127], a[12:15], v[160:163]
buffer_load_dwordx4 a[4:7], v4, s[40:43], s35 offen offset:1024 sc1
v_mfma_f32_16x16x32_bf16 v[144:147], a[124:127], a[8:11], v[144:147]
s_waitcnt vmcnt(8) lgkmcnt(4)
v_mfma_f32_16x16x32_bf16 v[132:135], a[128:131], a[16:19], v[132:135]
s_cmp_eq_u32 s3, 5
s_cselect_b32 s35, 21, 13
s_lshl_b32 s35, s35, 12
v_mfma_f32_16x16x32_bf16 v[148:151], a[128:131], a[20:23], v[148:151]
ds_read_b128 a[112:115], v5 offset:40960
v_mfma_f32_16x16x32_bf16 v[152:155], a[132:135], a[20:23], v[152:155]
buffer_load_dwordx4 a[8:11], v4, s[40:43], s35 offen offset:0 sc1
v_mfma_f32_16x16x32_bf16 v[136:139], a[132:135], a[16:19], v[136:139]
ds_read_b128 a[116:119], v5 offset:41984
v_mfma_f32_16x16x32_bf16 v[140:143], a[136:139], a[16:19], v[140:143]
ds_read_b128 a[120:123], v5 offset:43008
v_mfma_f32_16x16x32_bf16 v[156:159], a[136:139], a[20:23], v[156:159]
ds_read_b128 a[124:127], v5 offset:44032
v_mfma_f32_16x16x32_bf16 v[160:163], a[140:143], a[20:23], v[160:163]
buffer_load_dwordx4 a[12:15], v4, s[40:43], s35 offen offset:1024 sc1
v_mfma_f32_16x16x32_bf16 v[144:147], a[140:143], a[16:19], v[144:147]
s_waitcnt vmcnt(8) lgkmcnt(4)
v_mfma_f32_16x16x32_bf16 v[132:135], a[96:99], a[24:27], v[132:135]
s_cmp_eq_u32 s3, 6
s_cselect_b32 s35, 22, 14
s_lshl_b32 s35, s35, 12
v_mfma_f32_16x16x32_bf16 v[148:151], a[96:99], a[28:31], v[148:151]
ds_read_b128 a[128:131], v5 offset:45056
v_mfma_f32_16x16x32_bf16 v[152:155], a[100:103], a[28:31], v[152:155]
buffer_load_dwordx4 a[16:19], v4, s[40:43], s35 offen offset:0 sc1
v_mfma_f32_16x16x32_bf16 v[136:139], a[100:103], a[24:27], v[136:139]
ds_read_b128 a[132:135], v5 offset:46080
v_mfma_f32_16x16x32_bf16 v[140:143], a[104:107], a[24:27], v[140:143]
L_stub9:
s_cbranch_execz L_wret3
ds_read_b128 a[136:139], v5 offset:47104
v_mfma_f32_16x16x32_bf16 v[156:159], a[104:107], a[28:31], v[156:159]
ds_read_b128 a[140:143], v5 offset:48128
v_mfma_f32_16x16x32_bf16 v[160:163], a[108:111], a[28:31], v[160:163]
buffer_load_dwordx4 a[20:23], v4, s[40:43], s35 offen offset:1024 sc1
v_mfma_f32_16x16x32_bf16 v[144:147], a[108:111], a[24:27], v[144:147]
s_waitcnt vmcnt(8) lgkmcnt(4)
v_mfma_f32_16x16x32_bf16 v[132:135], a[112:115], a[32:35], v[132:135]
s_cmp_eq_u32 s3, 7
s_cselect_b32 s35, 23, 15
s_lshl_b32 s35, s35, 12
v_mfma_f32_16x16x32_bf16 v[148:151], a[112:115], a[36:39], v[148:151]
ds_read_b128 a[96:99], v5 offset:49152
v_mfma_f32_16x16x32_bf16 v[152:155], a[116:119], a[36:39], v[152:155]
buffer_load_dwordx4 a[24:27], v4, s[40:43], s35 offen offset:0 sc1
v_mfma_f32_16x16x32_bf16 v[136:139], a[116:119], a[32:35], v[136:139]
ds_read_b128 a[100:103], v5 offset:50176
v_mfma_f32_16x16x32_bf16 v[140:143], a[120:123], a[32:35], v[140:143]
ds_read_b128 a[104:107], v5 offset:51200
v_mfma_f32_16x16x32_bf16 v[156:159], a[120:123], a[36:39], v[156:159]
ds_read_b128 a[108:111], v5 offset:52224
v_mfma_f32_16x16x32_bf16 v[160:163], a[124:127], a[36:39], v[160:163]
buffer_load_dwordx4 a[28:31], v4, s[40:43], s35 offen offset:1024 sc1
v_mfma_f32_16x16x32_bf16 v[144:147], a[124:127], a[32:35], v[144:147]
s_waitcnt vmcnt(8) lgkmcnt(4)
v_mfma_f32_16x16x32_bf16 v[132:135], a[128:131], a[40:43], v[132:135]
s_cmp_eq_u32 s3, 0
s_cselect_b32 s35, 24, 16
s_lshl_b32 s35, s35, 12
v_mfma_f32_16x16x32_bf16 v[148:151], a[128:131], a[44:47], v[148:151]
ds_read_b128 a[112:115], v5 offset:53248
v_mfma_f32_16x16x32_bf16 v[152:155], a[132:135], a[44:47], v[152:155]
buffer_load_dwordx4 a[32:35], v4, s[40:43], s35 offen offset:0 sc1
v_mfma_f32_16x16x32_bf16 v[136:139], a[132:135], a[40:43], v[136:139]
ds_read_b128 a[116:119], v5 offset:54272
v_mfma_f32_16x16x32_bf16 v[140:143], a[136:139], a[40:43], v[140:143]
ds_read_b128 a[120:123], v5 offset:55296
v_mfma_f32_16x16x32_bf16 v[156:159], a[136:139], a[44:47], v[156:159]
ds_read_b128 a[124:127], v5 offset:56320
v_mfma_f32_16x16x32_bf16 v[160:163], a[140:143], a[44:47], v[160:163]
buffer_load_dwordx4 a[36:39], v4, s[40:43], s35 offen offset:1024 sc1
v_mfma_f32_16x16x32_bf16 v[144:147], a[140:143], a[40:43], v[144:147]
s_waitcnt vmcnt(8) lgkmcnt(4)
v_mfma_f32_16x16x32_bf16 v[132:135], a[96:99], a[0:3], v[132:135]
s_cmp_eq_u32 s3, 1
s_cselect_b32 s35, 25, 17
s_lshl_b32 s35, s35, 12
v_mfma_f32_16x16x32_bf16 v[148:151], a[96:99], a[4:7], v[148:151]
ds_read_b128 a[128:131], v5 offset:57344
v_mfma_f32_16x16x32_bf16 v[152:155], a[100:103], a[4:7], v[152:155]
buffer_load_dwordx4 a[40:43], v4, s[40:43], s35 offen offset:0 sc1
v_mfma_f32_16x16x32_bf16 v[136:139], a[100:103], a[0:3], v[136:139]
ds_read_b128 a[132:135], v5 offset:58368
v_mfma_f32_16x16x32_bf16 v[140:143], a[104:107], a[0:3], v[140:143]
ds_read_b128 a[136:139], v5 offset:59392
v_mfma_f32_16x16x32_bf16 v[156:159], a[104:107], a[4:7], v[156:159]
ds_read_b128 a[140:143], v5 offset:60416
v_mfma_f32_16x16x32_bf16 v[160:163], a[108:111], a[4:7], v[160:163]
buffer_load_dwordx4 a[44:47], v4, s[40:43], s35 offen offset:1024 sc1
v_mfma_f32_16x16x32_bf16 v[144:147], a[108:111], a[0:3], v[144:147]
s_waitcnt vmcnt(8) lgkmcnt(4)
v_mfma_f32_16x16x32_bf16 v[132:135], a[112:115], a[8:11], v[132:135]
s_cmp_eq_u32 s3, 2
s_cselect_b32 s35, 26, 18
s_lshl_b32 s35, s35, 12
v_mfma_f32_16x16x32_bf16 v[148:151], a[112:115], a[12:15], v[148:151]
ds_read_b128 a[96:99], v5 offset:61440
v_mfma_f32_16x16x32_bf16 v[152:155], a[116:119], a[12:15], v[152:155]
buffer_load_dwordx4 a[0:3], v4, s[40:43], s35 offen offset:0 sc1
v_mfma_f32_16x16x32_bf16 v[136:139], a[116:119], a[8:11], v[136:139]
ds_read_b128 a[100:103], v5 offset:62464
v_mfma_f32_16x16x32_bf16 v[140:143], a[120:123], a[8:11], v[140:143]
ds_read_b128 a[104:107], v5 offset:63488
v_mfma_f32_16x16x32_bf16 v[156:159], a[120:123], a[12:15], v[156:159]
ds_read_b128 a[108:111], v5 offset:64512
v_mfma_f32_16x16x32_bf16 v[160:163], a[124:127], a[12:15], v[160:163]
buffer_load_dwordx4 a[4:7], v4, s[40:43], s35 offen offset:1024 sc1
v_mfma_f32_16x16x32_bf16 v[144:147], a[124:127], a[8:11], v[144:147]
s_waitcnt vmcnt(8) lgkmcnt(4)
v_mfma_f32_16x16x32_bf16 v[132:135], a[128:131], a[16:19], v[132:135]
s_cmp_eq_u32 s3, 3
s_cselect_b32 s35, 27, 19
s_lshl_b32 s35, s35, 12
v_mfma_f32_16x16x32_bf16 v[148:151], a[128:131], a[20:23], v[148:151]
ds_read_b128 a[112:115], v6 offset:0
v_mfma_f32_16x16x32_bf16 v[152:155], a[132:135], a[20:23], v[152:155]
buffer_load_dwordx4 a[8:11], v4, s[40:43], s35 offen offset:0 sc1
v_mfma_f32_16x16x32_bf16 v[136:139], a[132:135], a[16:19], v[136:139]
ds_read_b128 a[116:119], v6 offset:1024
v_mfma_f32_16x16x32_bf16 v[140:143], a[136:139], a[16:19], v[140:143]
ds_read_b128 a[120:123], v6 offset:2048
v_mfma_f32_16x16x32_bf16 v[156:159], a[136:139], a[20:23], v[156:159]
ds_read_b128 a[124:127], v6 offset:3072
v_mfma_f32_16x16x32_bf16 v[160:163], a[140:143], a[20:23], v[160:163]
buffer_load_dwordx4 a[12:15], v4, s[40:43], s35 offen offset:1024 sc1
v_mfma_f32_16x16x32_bf16 v[144:147], a[140:143], a[16:19], v[144:147]
s_waitcnt vmcnt(8) lgkmcnt(4)
v_mfma_f32_16x16x32_bf16 v[132:135], a[96:99], a[24:27], v[132:135]
s_cmp_eq_u32 s3, 4
s_cselect_b32 s35, 28, 20
s_lshl_b32 s35, s35, 12
v_mfma_f32_16x16x32_bf16 v[148:151], a[96:99], a[28:31], v[148:151]
ds_read_b128 a[128:131], v6 offset:4096
v_mfma_f32_16x16x32_bf16 v[152:155], a[100:103], a[28:31], v[152:155]
buffer_load_dwordx4 a[16:19], v4, s[40:43], s35 offen offset:0 sc1
v_mfma_f32_16x16x32_bf16 v[136:139], a[100:103], a[24:27], v[136:139]
ds_read_b128 a[132:135], v6 offset:5120
v_mfma_f32_16x16x32_bf16 v[140:143], a[104:107], a[24:27], v[140:143]
ds_read_b128 a[136:139], v6 offset:6144
v_mfma_f32_16x16x32_bf16 v[156:159], a[104:107], a[28:31], v[156:159]
ds_read_b128 a[140:143], v6 offset:7168
v_mfma_f32_16x16x32_bf16 v[160:163], a[108:111], a[28:31], v[160:163]
buffer_load_dwordx4 a[20:23], v4, s[40:43], s35 offen offset:1024 sc1
v_mfma_f32_16x16x32_bf16 v[144:147], a[108:111], a[24:27], v[144:147]
s_waitcnt vmcnt(8) lgkmcnt(4)
v_mfma_f32_16x16x32_bf16 v[132:135], a[112:115], a[32:35], v[132:135]
s_cmp_eq_u32 s3, 5
s_cselect_b32 s35, 29, 21
s_lshl_b32 s35, s35, 12
v_mfma_f32_16x16x32_bf16 v[148:151], a[112:115], a[36:39], v[148:151]
ds_read_b128 a[96:99], v6 offset:8192
v_mfma_f32_16x16x32_bf16 v[152:155], a[116:119], a[36:39], v[152:155]
buffer_load_dwordx4 a[24:27], v4, s[40:43], s35 offen offset:0 sc1
v_mfma_f32_16x16x32_bf16 v[136:139], a[116:119], a[32:35], v[136:139]
ds_read_b128 a[100:103], v6 offset:9216
v_mfma_f32_16x16x32_bf16 v[140:143], a[120:123], a[32:35], v[140:143]
ds_read_b128 a[104:107], v6 offset:10240
v_mfma_f32_16x16x32_bf16 v[156:159], a[120:123], a[36:39], v[156:159]
ds_read_b128 a[108:111], v6 offset:11264
v_mfma_f32_16x16x32_bf16 v[160:163], a[124:127], a[36:39], v[160:163]
buffer_load_dwordx4 a[28:31], v4, s[40:43], s35 offen offset:1024 sc1
v_mfma_f32_16x16x32_bf16 v[144:147], a[124:127], a[32:35], v[144:147]
s_waitcnt vmcnt(8) lgkmcnt(4)
v_mfma_f32_16x16x32_bf16 v[132:135], a[128:131], a[40:43], v[132:135]
s_cmp_eq_u32 s3, 6
s_cselect_b32 s35, 30, 22
s_lshl_b32 s35, s35, 12
v_mfma_f32_16x16x32_bf16 v[148:151], a[128:131], a[44:47], v[148:151]
ds_read_b128 a[112:115], v6 offset:12288
v_mfma_f32_16x16x32_bf16 v[152:155], a[132:135], a[44:47], v[152:155]
buffer_load_dwordx4 a[32:35], v4, s[40:43], s35 offen offset:0 sc1
v_mfma_f32_16x16x32_bf16 v[136:139], a[132:135], a[40:43], v[136:139]
ds_read_b128 a[116:119], v6 offset:13312
v_mfma_f32_16x16x32_bf16 v[140:143], a[136:139], a[40:43], v[140:143]
ds_read_b128 a[120:123], v6 offset:14336
v_mfma_f32_16x16x32_bf16 v[156:159], a[136:139], a[44:47], v[156:159]
ds_read_b128 a[124:127], v6 offset:15360
v_mfma_f32_16x16x32_bf16 v[160:163], a[140:143], a[44:47], v[160:163]
buffer_load_dwordx4 a[36:39], v4, s[40:43], s35 offen offset:1024 sc1
v_mfma_f32_16x16x32_bf16 v[144:147], a[140:143], a[40:43], v[144:147]
s_waitcnt vmcnt(8) lgkmcnt(4)
v_mfma_f32_16x16x32_bf16 v[132:135], a[96:99], a[0:3], v[132:135]
s_cmp_eq_u32 s3, 7
s_cselect_b32 s35, 31, 23
s_lshl_b32 s35, s35, 12
v_mfma_f32_16x16x32_bf16 v[148:151], a[96:99], a[4:7], v[148:151]
ds_read_b128 a[128:131], v6 offset:16384
v_mfma_f32_16x16x32_bf16 v[152:155], a[100:103], a[4:7], v[152:155]
buffer_load_dwordx4 a[40:43], v4, s[40:43], s35 offen offset:0 sc1
v_mfma_f32_16x16x32_bf16 v[136:139], a[100:103], a[0:3], v[136:139]
ds_read_b128 a[132:135], v6 offset:17408
v_mfma_f32_16x16x32_bf16 v[140:143], a[104:107], a[0:3], v[140:143]
ds_read_b128 a[136:139], v6 offset:18432
v_mfma_f32_16x16x32_bf16 v[156:159], a[104:107], a[4:7], v[156:159]
ds_read_b128 a[140:143], v6 offset:19456
v_mfma_f32_16x16x32_bf16 v[160:163], a[108:111], a[4:7], v[160:163]
buffer_load_dwordx4 a[44:47], v4, s[40:43], s35 offen offset:1024 sc1
v_mfma_f32_16x16x32_bf16 v[144:147], a[108:111], a[0:3], v[144:147]
s_waitcnt vmcnt(8) lgkmcnt(4)
v_mfma_f32_16x16x32_bf16 v[132:135], a[112:115], a[8:11], v[132:135]
s_cmp_eq_u32 s3, 0
s_cselect_b32 s35, 0, 24
s_lshl_b32 s35, s35, 12
v_mfma_f32_16x16x32_bf16 v[148:151], a[112:115], a[12:15], v[148:151]
ds_read_b128 a[96:99], v6 offset:20480
v_mfma_f32_16x16x32_bf16 v[152:155], a[116:119], a[12:15], v[152:155]
buffer_load_dwordx4 a[0:3], v4, s[40:43], s35 offen offset:0 sc1
v_mfma_f32_16x16x32_bf16 v[136:139], a[116:119], a[8:11], v[136:139]
ds_read_b128 a[100:103], v6 offset:21504
v_mfma_f32_16x16x32_bf16 v[140:143], a[120:123], a[8:11], v[140:143]
ds_read_b128 a[104:107], v6 offset:22528
v_mfma_f32_16x16x32_bf16 v[156:159], a[120:123], a[12:15], v[156:159]
ds_read_b128 a[108:111], v6 offset:23552
v_mfma_f32_16x16x32_bf16 v[160:163], a[124:127], a[12:15], v[160:163]
buffer_load_dwordx4 a[4:7], v4, s[40:43], s35 offen offset:1024 sc1
v_mfma_f32_16x16x32_bf16 v[144:147], a[124:127], a[8:11], v[144:147]
s_waitcnt vmcnt(8) lgkmcnt(4)
v_mfma_f32_16x16x32_bf16 v[132:135], a[128:131], a[16:19], v[132:135]
s_cmp_eq_u32 s3, 1
s_cselect_b32 s35, 1, 25
s_lshl_b32 s35, s35, 12
v_mfma_f32_16x16x32_bf16 v[148:151], a[128:131], a[20:23], v[148:151]
ds_read_b128 a[112:115], v6 offset:24576
v_mfma_f32_16x16x32_bf16 v[152:155], a[132:135], a[20:23], v[152:155]
buffer_load_dwordx4 a[8:11], v4, s[40:43], s35 offen offset:0 sc1
v_mfma_f32_16x16x32_bf16 v[136:139], a[132:135], a[16:19], v[136:139]
ds_read_b128 a[116:119], v6 offset:25600
v_mfma_f32_16x16x32_bf16 v[140:143], a[136:139], a[16:19], v[140:143]
ds_read_b128 a[120:123], v6 offset:26624
v_mfma_f32_16x16x32_bf16 v[156:159], a[136:139], a[20:23], v[156:159]
ds_read_b128 a[124:127], v6 offset:27648
v_mfma_f32_16x16x32_bf16 v[160:163], a[140:143], a[20:23], v[160:163]
buffer_load_dwordx4 a[12:15], v4, s[40:43], s35 offen offset:1024 sc1
v_mfma_f32_16x16x32_bf16 v[144:147], a[140:143], a[16:19], v[144:147]
s_waitcnt vmcnt(8) lgkmcnt(4)
v_mfma_f32_16x16x32_bf16 v[132:135], a[96:99], a[24:27], v[132:135]
s_cmp_eq_u32 s3, 2
s_cselect_b32 s35, 2, 26
s_lshl_b32 s35, s35, 12
v_mfma_f32_16x16x32_bf16 v[148:151], a[96:99], a[28:31], v[148:151]
ds_read_b128 a[128:131], v6 offset:28672
v_mfma_f32_16x16x32_bf16 v[152:155], a[100:103], a[28:31], v[152:155]
buffer_load_dwordx4 a[16:19], v4, s[40:43], s35 offen offset:0 sc1
v_mfma_f32_16x16x32_bf16 v[136:139], a[100:103], a[24:27], v[136:139]
ds_read_b128 a[132:135], v6 offset:29696
v_mfma_f32_16x16x32_bf16 v[140:143], a[104:107], a[24:27], v[140:143]
ds_read_b128 a[136:139], v6 offset:30720
v_mfma_f32_16x16x32_bf16 v[156:159], a[104:107], a[28:31], v[156:159]
ds_read_b128 a[140:143], v6 offset:31744
v_mfma_f32_16x16x32_bf16 v[160:163], a[108:111], a[28:31], v[160:163]
buffer_load_dwordx4 a[20:23], v4, s[40:43], s35 offen offset:1024 sc1
v_mfma_f32_16x16x32_bf16 v[144:147], a[108:111], a[24:27], v[144:147]
s_waitcnt vmcnt(8) lgkmcnt(4)
v_mfma_f32_16x16x32_bf16 v[132:135], a[112:115], a[32:35], v[132:135]
s_cmp_eq_u32 s3, 3
s_cselect_b32 s35, 3, 27
s_lshl_b32 s35, s35, 12
v_mfma_f32_16x16x32_bf16 v[148:151], a[112:115], a[36:39], v[148:151]
ds_read_b128 a[96:99], v6 offset:32768
v_mfma_f32_16x16x32_bf16 v[152:155], a[116:119], a[36:39], v[152:155]
buffer_load_dwordx4 a[24:27], v4, s[40:43], s35 offen offset:0 sc1
v_mfma_f32_16x16x32_bf16 v[136:139], a[116:119], a[32:35], v[136:139]
ds_read_b128 a[100:103], v6 offset:33792
v_mfma_f32_16x16x32_bf16 v[140:143], a[120:123], a[32:35], v[140:143]
ds_read_b128 a[104:107], v6 offset:34816
v_mfma_f32_16x16x32_bf16 v[156:159], a[120:123], a[36:39], v[156:159]
ds_read_b128 a[108:111], v6 offset:35840
v_mfma_f32_16x16x32_bf16 v[160:163], a[124:127], a[36:39], v[160:163]
buffer_load_dwordx4 a[28:31], v4, s[40:43], s35 offen offset:1024 sc1
v_mfma_f32_16x16x32_bf16 v[144:147], a[124:127], a[32:35], v[144:147]
s_waitcnt vmcnt(8) lgkmcnt(4)
v_mfma_f32_16x16x32_bf16 v[132:135], a[128:131], a[40:43], v[132:135]
s_cmp_eq_u32 s3, 4
s_cselect_b32 s35, 4, 28
s_lshl_b32 s35, s35, 12
v_mfma_f32_16x16x32_bf16 v[148:151], a[128:131], a[44:47], v[148:151]
ds_read_b128 a[112:115], v6 offset:36864
v_mfma_f32_16x16x32_bf16 v[152:155], a[132:135], a[44:47], v[152:155]
buffer_load_dwordx4 a[32:35], v4, s[40:43], s35 offen offset:0 sc1
v_mfma_f32_16x16x32_bf16 v[136:139], a[132:135], a[40:43], v[136:139]
ds_read_b128 a[116:119], v6 offset:37888
v_mfma_f32_16x16x32_bf16 v[140:143], a[136:139], a[40:43], v[140:143]
ds_read_b128 a[120:123], v6 offset:38912
v_mfma_f32_16x16x32_bf16 v[156:159], a[136:139], a[44:47], v[156:159]
ds_read_b128 a[124:127], v6 offset:39936
v_mfma_f32_16x16x32_bf16 v[160:163], a[140:143], a[44:47], v[160:163]
buffer_load_dwordx4 a[36:39], v4, s[40:43], s35 offen offset:1024 sc1
v_mfma_f32_16x16x32_bf16 v[144:147], a[140:143], a[40:43], v[144:147]
s_waitcnt vmcnt(8) lgkmcnt(4)
v_mfma_f32_16x16x32_bf16 v[132:135], a[96:99], a[0:3], v[132:135]
s_cmp_eq_u32 s3, 5
s_cselect_b32 s35, 5, 29
s_lshl_b32 s35, s35, 12
v_mfma_f32_16x16x32_bf16 v[148:151], a[96:99], a[4:7], v[148:151]
ds_read_b128 a[128:131], v6 offset:40960
v_mfma_f32_16x16x32_bf16 v[152:155], a[100:103], a[4:7], v[152:155]
buffer_load_dwordx4 a[40:43], v4, s[40:43], s35 offen offset:0 sc1
v_mfma_f32_16x16x32_bf16 v[136:139], a[100:103], a[0:3], v[136:139]
ds_read_b128 a[132:135], v6 offset:41984
v_mfma_f32_16x16x32_bf16 v[140:143], a[104:107], a[0:3], v[140:143]
ds_read_b128 a[136:139], v6 offset:43008
v_mfma_f32_16x16x32_bf16 v[156:159], a[104:107], a[4:7], v[156:159]
ds_read_b128 a[140:143], v6 offset:44032
v_mfma_f32_16x16x32_bf16 v[160:163], a[108:111], a[4:7], v[160:163]
buffer_load_dwordx4 a[44:47], v4, s[40:43], s35 offen offset:1024 sc1
v_mfma_f32_16x16x32_bf16 v[144:147], a[108:111], a[0:3], v[144:147]
s_waitcnt vmcnt(8) lgkmcnt(4)
v_mfma_f32_16x16x32_bf16 v[132:135], a[112:115], a[8:11], v[132:135]
s_cmp_eq_u32 s3, 6
s_cselect_b32 s35, 6, 30
s_lshl_b32 s35, s35, 12
v_mfma_f32_16x16x32_bf16 v[148:151], a[112:115], a[12:15], v[148:151]
ds_read_b128 a[96:99], v6 offset:45056
v_mfma_f32_16x16x32_bf16 v[152:155], a[116:119], a[12:15], v[152:155]
buffer_load_dwordx4 a[0:3], v4, s[40:43], s35 offen offset:0 sc1
v_mfma_f32_16x16x32_bf16 v[136:139], a[116:119], a[8:11], v[136:139]
ds_read_b128 a[100:103], v6 offset:46080
v_mfma_f32_16x16x32_bf16 v[140:143], a[120:123], a[8:11], v[140:143]
ds_read_b128 a[104:107], v6 offset:47104
v_mfma_f32_16x16x32_bf16 v[156:159], a[120:123], a[12:15], v[156:159]
ds_read_b128 a[108:111], v6 offset:48128
v_mfma_f32_16x16x32_bf16 v[160:163], a[124:127], a[12:15], v[160:163]
buffer_load_dwordx4 a[4:7], v4, s[40:43], s35 offen offset:1024 sc1
v_mfma_f32_16x16x32_bf16 v[144:147], a[124:127], a[8:11], v[144:147]
s_waitcnt vmcnt(8) lgkmcnt(4)
v_mfma_f32_16x16x32_bf16 v[132:135], a[128:131], a[16:19], v[132:135]
s_cmp_eq_u32 s3, 7
s_cselect_b32 s35, 7, 31
s_lshl_b32 s35, s35, 12
v_mfma_f32_16x16x32_bf16 v[148:151], a[128:131], a[20:23], v[148:151]
ds_read_b128 a[112:115], v6 offset:49152
v_mfma_f32_16x16x32_bf16 v[152:155], a[132:135], a[20:23], v[152:155]
buffer_load_dwordx4 a[8:11], v4, s[40:43], s35 offen offset:0 sc1
v_mfma_f32_16x16x32_bf16 v[136:139], a[132:135], a[16:19], v[136:139]
ds_read_b128 a[116:119], v6 offset:50176
v_mfma_f32_16x16x32_bf16 v[140:143], a[136:139], a[16:19], v[140:143]
ds_read_b128 a[120:123], v6 offset:51200
v_mfma_f32_16x16x32_bf16 v[156:159], a[136:139], a[20:23], v[156:159]
ds_read_b128 a[124:127], v6 offset:52224
v_mfma_f32_16x16x32_bf16 v[160:163], a[140:143], a[20:23], v[160:163]
buffer_load_dwordx4 a[12:15], v4, s[40:43], s35 offen offset:1024 sc1
v_mfma_f32_16x16x32_bf16 v[144:147], a[140:143], a[16:19], v[144:147]
s_waitcnt vmcnt(8) lgkmcnt(4)
v_mfma_f32_16x16x32_bf16 v[132:135], a[96:99], a[24:27], v[132:135]
ds_read_b128 a[128:131], v6 offset:53248
v_mfma_f32_16x16x32_bf16 v[148:151], a[96:99], a[28:31], v[148:151]
ds_read_b128 a[132:135], v6 offset:54272
v_mfma_f32_16x16x32_bf16 v[152:155], a[100:103], a[28:31], v[152:155]
ds_read_b128 a[136:139], v6 offset:55296
v_mfma_f32_16x16x32_bf16 v[136:139], a[100:103], a[24:27], v[136:139]
ds_read_b128 a[140:143], v6 offset:56320
v_mfma_f32_16x16x32_bf16 v[140:143], a[104:107], a[24:27], v[140:143]
v_mfma_f32_16x16x32_bf16 v[156:159], a[104:107], a[28:31], v[156:159]
buffer_atomic_add v12, v10, s[4:7], s92 offen sc1
v_mfma_f32_16x16x32_bf16 v[160:163], a[108:111], a[28:31], v[160:163]
v_mfma_f32_16x16x32_bf16 v[144:147], a[108:111], a[24:27], v[144:147]
s_waitcnt vmcnt(7) lgkmcnt(4)
v_mfma_f32_16x16x32_bf16 v[132:135], a[112:115], a[32:35], v[132:135]
ds_read_b128 a[96:99], v6 offset:57344
v_mfma_f32_16x16x32_bf16 v[148:151], a[112:115], a[36:39], v[148:151]
ds_read_b128 a[100:103], v6 offset:58368
v_mfma_f32_16x16x32_bf16 v[152:155], a[116:119], a[36:39], v[152:155]
ds_read_b128 a[104:107], v6 offset:59392
v_mfma_f32_16x16x32_bf16 v[136:139], a[116:119], a[32:35], v[136:139]
ds_read_b128 a[108:111], v6 offset:60416
v_mfma_f32_16x16x32_bf16 v[140:143], a[120:123], a[32:35], v[140:143]
v_mfma_f32_16x16x32_bf16 v[156:159], a[120:123], a[36:39], v[156:159]
v_mfma_f32_16x16x32_bf16 v[160:163], a[124:127], a[36:39], v[160:163]
v_mfma_f32_16x16x32_bf16 v[144:147], a[124:127], a[32:35], v[144:147]
s_waitcnt vmcnt(5) lgkmcnt(4)
v_mfma_f32_16x16x32_bf16 v[132:135], a[128:131], a[40:43], v[132:135]
ds_read_b128 a[112:115], v6 offset:61440
v_mfma_f32_16x16x32_bf16 v[148:151], a[128:131], a[44:47], v[148:151]
ds_read_b128 a[116:119], v6 offset:62464
v_mfma_f32_16x16x32_bf16 v[152:155], a[132:135], a[44:47], v[152:155]
ds_read_b128 a[120:123], v6 offset:63488
v_mfma_f32_16x16x32_bf16 v[136:139], a[132:135], a[40:43], v[136:139]
ds_read_b128 a[124:127], v6 offset:64512
v_mfma_f32_16x16x32_bf16 v[140:143], a[136:139], a[40:43], v[140:143]
v_mfma_f32_16x16x32_bf16 v[156:159], a[136:139], a[44:47], v[156:159]
v_mfma_f32_16x16x32_bf16 v[160:163], a[140:143], a[44:47], v[160:163]
v_mfma_f32_16x16x32_bf16 v[144:147], a[140:143], a[40:43], v[144:147]
s_waitcnt vmcnt(3) lgkmcnt(4)
v_mfma_f32_16x16x32_bf16 v[132:135], a[96:99], a[0:3], v[132:135]
v_mfma_f32_16x16x32_bf16 v[148:151], a[96:99], a[4:7], v[148:151]
v_mfma_f32_16x16x32_bf16 v[152:155], a[100:103], a[4:7], v[152:155]
v_mfma_f32_16x16x32_bf16 v[136:139], a[100:103], a[0:3], v[136:139]
v_mfma_f32_16x16x32_bf16 v[140:143], a[104:107], a[0:3], v[140:143]
v_mfma_f32_16x16x32_bf16 v[156:159], a[104:107], a[4:7], v[156:159]
v_mfma_f32_16x16x32_bf16 v[160:163], a[108:111], a[4:7], v[160:163]
v_mfma_f32_16x16x32_bf16 v[144:147], a[108:111], a[0:3], v[144:147]
s_waitcnt vmcnt(1) lgkmcnt(0)
v_mfma_f32_16x16x32_bf16 v[132:135], a[112:115], a[8:11], v[132:135]
v_mfma_f32_16x16x32_bf16 v[148:151], a[112:115], a[12:15], v[148:151]
v_mfma_f32_16x16x32_bf16 v[152:155], a[116:119], a[12:15], v[152:155]
v_mfma_f32_16x16x32_bf16 v[136:139], a[116:119], a[8:11], v[136:139]
v_mfma_f32_16x16x32_bf16 v[140:143], a[120:123], a[8:11], v[140:143]
v_mfma_f32_16x16x32_bf16 v[156:159], a[120:123], a[12:15], v[156:159]
v_mfma_f32_16x16x32_bf16 v[160:163], a[124:127], a[12:15], v[160:163]
v_mfma_f32_16x16x32_bf16 v[144:147], a[124:127], a[8:11], v[144:147]
s_nop 1
v_cmp_u_f32 vcc, v132, v148
s_nop 0
s_and_b32 vcc_lo, vcc_lo, s95
s_cbranch_scc1 L_k2redo1
s_lshl_b32 s36, s32, 13
v_cvt_pk_bf16_f32 v32, v132, v133
v_cvt_pk_bf16_f32 v33, v134, v135
v_cvt_pk_bf16_f32 v34, v136, v137
v_cvt_pk_bf16_f32 v35, v138, v139
s_add_u32 s36, s36, 0x0
buffer_store_dwordx4 v[32:35], v4, s[12:15], s36 offen offset:0 sc1
v_cvt_pk_bf16_f32 v40, v148, v149
v_cvt_pk_bf16_f32 v41, v150, v151
v_cvt_pk_bf16_f32 v42, v152, v153
v_cvt_pk_bf16_f32 v43, v154, v155
v_cvt_pk_bf16_f32 v36, v140, v141
v_cvt_pk_bf16_f32 v37, v142, v143
v_cvt_pk_bf16_f32 v38, v144, v145
v_cvt_pk_bf16_f32 v39, v146, v147
s_add_u32 s37, s36, 4096
v_cvt_pk_bf16_f32 v44, v156, v157
v_cvt_pk_bf16_f32 v45, v158, v159
v_cvt_pk_bf16_f32 v46, v160, v161
buffer_store_dwordx4 v[40:43], v4, s[12:15], s36 offen offset:1024 sc1
v_cvt_pk_bf16_f32 v47, v162, v163
v_mfma_f32_16x16x32_bf16 v[96:99], v[32:35], v[32:35], 0
s_mov_b32 s38, 0x280000
s_add_u32 s92, s78, 0x50000
v_mfma_f32_16x16x32_bf16 v[92:95], v[16:19], v[32:35], 0
s_add_u32 s93, s79, 0x50000
s_mov_b64 s[40:41], s[12:13]
v_mfma_f32_16x16x32_bf16 v[96:99], v[36:39], v[36:39], v[96:99]
buffer_store_dwordx4 v[36:39], v4, s[12:15], s37 offen offset:0 sc1
v_mfma_f32_16x16x32_bf16 v[92:95], v[16:19], v[36:39], v[92:95]
s_nop 5
v_cndmask_b32 v96, v96, v97, s[46:47]
v_cndmask_b32 v98, v98, v99, s[46:47]
v_mfma_f32_16x16x32_bf16 v[104:107], v[40:43], v[40:43], 0
v_mfma_f32_16x16x32_bf16 v[100:103], v[16:19], v[40:43], 0
v_cndmask_b32 v93, v96, v98, s[48:49]
buffer_store_dwordx4 v[44:47], v4, s[12:15], s37 offen offset:1024 sc1
v_mfma_f32_16x16x32_bf16 v[104:107], v[44:47], v[44:47], v[104:107]
v_mfma_f32_16x16x32_bf16 v[100:103], v[16:19], v[44:47], v[100:103]
s_nop 6
v_cndmask_b32 v104, v104, v105, s[46:47]
v_cndmask_b32 v106, v106, v107, s[46:47]
buffer_store_dwordx2 v[92:93], v253, s[4:7], s38 offen offset:0 sc1
v_cndmask_b32 v101, v104, v106, s[48:49]
buffer_store_dwordx2 v[100:101], v253, s[4:7], s38 offen offset:2048 sc1
s_barrier
s_add_u32 m0, s18, 0x0
s_add_u32 s44, s50, 0xe00000
buffer_load_dwordx4 v1, s[4:7], s44 offen offset:0 sc1 lds
buffer_load_dwordx4 v1, s[4:7], s44 offen offset:1024 sc1 lds
buffer_load_dwordx4 v1, s[4:7], s44 offen offset:2048 sc1 lds
s_add_u32 m0, s18, 0x3000
s_add_u32 s44, s50, 0xe03000
buffer_load_dwordx4 v1, s[4:7], s44 offen offset:0 sc1 lds
buffer_load_dwordx4 v1, s[4:7], s44 offen offset:1024 sc1 lds
buffer_load_dwordx4 v1, s[4:7], s44 offen offset:2048 sc1 lds
v_accvgpr_read_b32 v48, a188
v_accvgpr_read_b32 v49, a189
v_accvgpr_read_b32 v50, a190
v_accvgpr_read_b32 v51, a191
v_accvgpr_read_b32 v52, a192
v_accvgpr_read_b32 v53, a193
v_accvgpr_read_b32 v54, a194
v_accvgpr_read_b32 v55, a195
v_accvgpr_read_b32 v56, a196
v_accvgpr_read_b32 v57, a197
v_accvgpr_read_b32 v58, a198
v_accvgpr_read_b32 v59, a199
v_accvgpr_read_b32 v60, a200
v_accvgpr_read_b32 v61, a201
v_accvgpr_read_b32 v62, a202
v_accvgpr_read_b32 v63, a203
v_accvgpr_read_b32 v64, a204
v_accvgpr_read_b32 v65, a205
v_accvgpr_read_b32 v66, a206
v_accvgpr_read_b32 v67, a207
v_accvgpr_read_b32 v68, a208
v_accvgpr_read_b32 v69, a209
v_accvgpr_read_b32 v70, a210
v_accvgpr_read_b32 v71, a211
v_accvgpr_read_b32 v72, a212
v_accvgpr_read_b32 v73, a213
v_accvgpr_read_b32 v74, a214
v_accvgpr_read_b32 v75, a215
s_waitcnt vmcnt(6)
s_barrier
s_cmp_lg_u32 s28, 1
s_cbranch_scc1 Lsg_22
buffer_atomic_add v12, v10, s[4:7], s92 offen sc1
buffer_atomic_add v12, v10, s[4:7], s93 offen sc1
Lsg_22:
s_mov_b64 exec, 0
s_cmp_eq_u32 s28, 1
s_cbranch_scc1 L_stub10
L_wret4:
s_mov_b64 exec, -1
s_cmp_lt_u32 s28, 2
s_cbranch_scc1 Lwd_23
s_add_u32 m0, s18, 0x4800
s_add_u32 s44, s50, 0xe04800
buffer_load_dwordx4 v1, s[4:7], s44 offen offset:0 sc1 lds
buffer_load_dwordx4 v1, s[4:7], s44 offen offset:1024 sc1 lds
buffer_load_dwordx4 v1, s[4:7], s44 offen offset:2048 sc1 lds
s_add_u32 m0, s18, 0x6000
s_add_u32 s44, s50, 0xe06000
buffer_load_dwordx4 v1, s[4:7], s44 offen offset:0 sc1 lds
buffer_load_dwordx4 v1, s[4:7], s44 offen offset:1024 sc1 lds
buffer_load_dwordx4 v1, s[4:7], s44 offen offset:2048 sc1 lds
s_add_u32 m0, s18, 0x7800
s_add_u32 s44, s50, 0xe07800
buffer_load_dwordx4 v1, s[4:7], s44 offen offset:0 sc1 lds
buffer_load_dwordx4 v1, s[4:7], s44 offen offset:1024 sc1 lds
buffer_load_dwordx4 v1, s[4:7], s44 offen offset:2048 sc1 lds
s_add_u32 m0, s18, 0x9000
s_add_u32 s44, s50, 0xe09000
buffer_load_dwordx4 v1, s[4:7], s44 offen offset:0 sc1 lds
buffer_load_dwordx4 v1, s[4:7], s44 offen offset:1024 sc1 lds
buffer_load_dwordx4 v1, s[4:7], s44 offen offset:2048 sc1 lds
s_add_u32 m0, s18, 0xa800
s_add_u32 s44, s50, 0xe0a800
buffer_load_dwordx4 v1, s[4:7], s44 offen offset:0 sc1 lds
buffer_load_dwordx4 v1, s[4:7], s44 offen offset:1024 sc1 lds
buffer_load_dwordx4 v1, s[4:7], s44 offen offset:2048 sc1 lds
s_add_u32 m0, s18, 0xc000
s_add_u32 s44, s50, 0xe0c000
buffer_load_dwordx4 v1, s[4:7], s44 offen offset:0 sc1 lds
buffer_load_dwordx4 v1, s[4:7], s44 offen offset:1024 sc1 lds
buffer_load_dwordx4 v1, s[4:7], s44 offen offset:2048 sc1 lds
s_add_u32 m0, s18, 0xd800
s_add_u32 s44, s50, 0xe0d800
buffer_load_dwordx4 v1, s[4:7], s44 offen offset:0 sc1 lds
buffer_load_dwordx4 v1, s[4:7], s44 offen offset:1024 sc1 lds
buffer_load_dwordx4 v1, s[4:7], s44 offen offset:2048 sc1 lds
s_add_u32 m0, s18, 0xf000
s_add_u32 s44, s50, 0xe0f000
buffer_load_dwordx4 v1, s[4:7], s44 offen offset:0 sc1 lds
buffer_load_dwordx4 v1, s[4:7], s44 offen offset:1024 sc1 lds
buffer_load_dwordx4 v1, s[4:7], s44 offen offset:2048 sc1 lds
s_add_u32 m0, s18, 0x10800
s_add_u32 s44, s50, 0xe10800
buffer_load_dwordx4 v1, s[4:7], s44 offen offset:0 sc1 lds
buffer_load_dwordx4 v1, s[4:7], s44 offen offset:1024 sc1 lds
buffer_load_dwordx4 v1, s[4:7], s44 offen offset:2048 sc1 lds
s_add_u32 m0, s18, 0x12000
s_add_u32 s44, s50, 0xe12000
buffer_load_dwordx4 v1, s[4:7], s44 offen offset:0 sc1 lds
buffer_load_dwordx4 v1, s[4:7], s44 offen offset:1024 sc1 lds
buffer_load_dwordx4 v1, s[4:7], s44 offen offset:2048 sc1 lds
s_add_u32 m0, s18, 0x13800
s_add_u32 s44, s50, 0xe13800
buffer_load_dwordx4 v1, s[4:7], s44 offen offset:0 sc1 lds
buffer_load_dwordx4 v1, s[4:7], s44 offen offset:1024 sc1 lds
buffer_load_dwordx4 v1, s[4:7], s44 offen offset:2048 sc1 lds
s_add_u32 m0, s18, 0x15000
s_add_u32 s44, s50, 0xe15000
buffer_load_dwordx4 v1, s[4:7], s44 offen offset:0 sc1 lds
buffer_load_dwordx4 v1, s[4:7], s44 offen offset:1024 sc1 lds
buffer_load_dwordx4 v1, s[4:7], s44 offen offset:2048 sc1 lds
s_add_u32 m0, s18, 0x16800
s_add_u32 s44, s50, 0xe16800
buffer_load_dwordx4 v1, s[4:7], s44 offen offset:0 sc1 lds
buffer_load_dwordx4 v1, s[4:7], s44 offen offset:1024 sc1 lds
buffer_load_dwordx4 v1, s[4:7], s44 offen offset:2048 sc1 lds
s_add_u32 m0, s18, 0x18000
s_add_u32 s44, s50, 0xe18000
buffer_load_dwordx4 v1, s[4:7], s44 offen offset:0 sc1 lds
buffer_load_dwordx4 v1, s[4:7], s44 offen offset:1024 sc1 lds
buffer_load_dwordx4 v1, s[4:7], s44 offen offset:2048 sc1 lds
s_add_u32 m0, s18, 0x19800
s_add_u32 s44, s50, 0xe19800
buffer_load_dwordx4 v1, s[4:7], s44 offen offset:0 sc1 lds
buffer_load_dwordx4 v1, s[4:7], s44 offen offset:1024 sc1 lds
buffer_load_dwordx4 v1, s[4:7], s44 offen offset:2048 sc1 lds
s_add_u32 m0, s18, 0x1b000
s_add_u32 s44, s50, 0xe1b000
buffer_load_dwordx4 v1, s[4:7], s44 offen offset:0 sc1 lds
buffer_load_dwordx4 v1, s[4:7], s44 offen offset:1024 sc1 lds
buffer_load_dwordx4 v1, s[4:7], s44 offen offset:2048 sc1 lds
Lwd_23:
s_cmp_lg_u32 s28, 0
s_cbranch_scc1 Lpe_25
s_add_u32 s36, s67, 0x50000
s_mov_b32 s37, 0
Lpoll_24:
v_mov_b32 v11, 0
buffer_atomic_add v11, v251, s[4:7], s36 offen sc0 sc1
s_add_u32 s37, s37, 1
s_waitcnt vmcnt(0)
v_readfirstlane_b32 s38, v11
s_nop 0
s_cmp_ge_u32 s38, s54
s_cbranch_scc1 Lpe_25
s_cmp_lt_u32 s37, 0x100000
L_stub10:
s_cbranch_execz L_stub11
s_cbranch_scc1 Lpoll_24
Lpe_25:
s_waitcnt vmcnt(36) lgkmcnt(0)
s_cmp_ge_u32 s28, 2
s_cbranch_scc1 Lw_26
s_waitcnt vmcnt(0)
Lw_26:
s_barrier
s_add_u32 s94, s71, 0x20080
s_mov_b32 s35, 0
s_mov_b32 s33, 0x1000
buffer_load_dwordx4 a[0:3], v2, s[40:43], s35 offen offset:0 sc1
buffer_load_dwordx4 a[4:7], v2, s[40:43], s33 offen offset:0 sc1
buffer_load_dwordx4 a[8:11], v2, s[40:43], s35 offen offset:1024 sc1
buffer_load_dwordx4 a[12:15], v2, s[40:43], s33 offen offset:1024 sc1
buffer_load_dwordx4 a[16:19], v2, s[40:43], s35 offen offset:2048 sc1
buffer_load_dwordx4 a[20:23], v2, s[40:43], s33 offen offset:2048 sc1
buffer_load_dwordx4 a[24:27], v2, s[40:43], s35 offen offset:3072 sc1
buffer_load_dwordx4 a[28:31], v2, s[40:43], s33 offen offset:3072 sc1
s_add_u32 s35, s35, 8192
s_add_u32 s33, s33, 8192
s_add_u32 s63, s28, 0
s_lshl_b32 s63, s63, 12
buffer_load_dwordx4 a[160:163], v3, s[40:43], s63 offen sc1
buffer_load_dwordx4 a[32:35], v2, s[40:43], s35 offen offset:0 sc1
buffer_load_dwordx4 a[36:39], v2, s[40:43], s33 offen offset:0 sc1
buffer_load_dwordx4 a[40:43], v2, s[40:43], s35 offen offset:1024 sc1
buffer_load_dwordx4 a[44:47], v2, s[40:43], s33 offen offset:1024 sc1
buffer_load_dwordx4 a[48:51], v2, s[40:43], s35 offen offset:2048 sc1
buffer_load_dwordx4 a[52:55], v2, s[40:43], s33 offen offset:2048 sc1
buffer_load_dwordx4 a[56:59], v2, s[40:43], s35 offen offset:3072 sc1
buffer_load_dwordx4 a[60:63], v2, s[40:43], s33 offen offset:3072 sc1
s_add_u32 s35, s35, 8192
s_add_u32 s33, s33, 8192
v_add_u32 v5, 0, v1
v_add_u32 v6, s55, v5
ds_read_b128 a[96:99], v5 offset:2048
ds_read_b128 a[100:103], v5 offset:8192
ds_read_b128 a[104:107], v5 offset:3072
ds_read_b128 a[108:111], v5 offset:9216
ds_read_b128 a[112:115], v5 offset:4096
ds_read_b128 a[116:119], v5 offset:10240
ds_read_b128 a[120:123], v6 offset:2048
s_waitcnt vmcnt(15) lgkmcnt(5)
v_mfma_f32_16x16x32_bf16 v[140:143], a[96:99], a[0:3], 0
s_add_u32 s63, s28, 4
s_lshl_b32 s63, s63, 12
v_mfma_f32_16x16x32_bf16 v[140:143], a[100:103], a[4:7], v[140:143]
buffer_load_dwordx4 a[64:67], v2, s[40:43], s35 offen offset:0 sc1
s_waitcnt vmcnt(14)
v_mfma_f32_16x16x32_bf16 v[164:167], a[100:103], a[12:15], 0
ds_read_b128 a[128:131], v5 offset:5120
v_mfma_f32_16x16x32_bf16 v[164:167], a[96:99], a[8:11], v[164:167]
ds_read_b128 a[132:135], v5 offset:11264
s_waitcnt vmcnt(13)
v_mfma_f32_16x16x32_bf16 v[188:191], a[96:99], a[16:19], 0
ds_read_b128 a[136:139], v5 offset:0
s_waitcnt vmcnt(12)
v_mfma_f32_16x16x32_bf16 v[188:191], a[100:103], a[20:23], v[188:191]
s_waitcnt vmcnt(10)
v_mfma_f32_16x16x32_bf16 v[212:215], a[100:103], a[28:31], 0
buffer_load_dwordx4 a[68:71], v2, s[40:43], s33 offen offset:0 sc1
v_mfma_f32_16x16x32_bf16 v[212:215], a[96:99], a[24:27], v[212:215]
ds_read_b128 a[140:143], v5 offset:6144
s_waitcnt lgkmcnt(8)
v_mfma_f32_16x16x32_bf16 v[216:219], a[104:107], a[24:27], 0
s_waitcnt lgkmcnt(7)
v_mfma_f32_16x16x32_bf16 v[216:219], a[108:111], a[28:31], v[216:219]
ds_read_b128 a[144:147], v5 offset:1024
v_mfma_f32_16x16x32_bf16 v[192:195], a[108:111], a[20:23], 0
v_mfma_f32_16x16x32_bf16 v[192:195], a[104:107], a[16:19], v[192:195]
buffer_load_dwordx4 a[164:167], v3, s[40:43], s63 offen sc1
s_add_u32 m0, s18, 0x1e000
v_mfma_f32_16x16x32_bf16 v[168:171], a[104:107], a[8:11], 0
s_add_u32 s44, s50, 0xe1e000
ds_read_b128 a[148:151], v5 offset:7168
v_mfma_f32_16x16x32_bf16 v[168:171], a[108:111], a[12:15], v[168:171]
ds_read_b128 a[152:155], v6 offset:3072
v_mfma_f32_16x16x32_bf16 v[144:147], a[108:111], a[4:7], 0
v_mfma_f32_16x16x32_bf16 v[144:147], a[104:107], a[0:3], v[144:147]
s_waitcnt lgkmcnt(9)
v_mfma_f32_16x16x32_bf16 v[148:151], a[112:115], a[0:3], 0
buffer_load_dwordx4 a[72:75], v2, s[40:43], s35 offen offset:1024 sc1
s_waitcnt lgkmcnt(8)
v_mfma_f32_16x16x32_bf16 v[148:151], a[116:119], a[4:7], v[148:151]
v_mfma_f32_16x16x32_bf16 v[172:175], a[116:119], a[12:15], 0
v_mfma_f32_16x16x32_bf16 v[172:175], a[112:115], a[8:11], v[172:175]
v_mfma_f32_16x16x32_bf16 v[196:199], a[112:115], a[16:19], 0
v_mfma_f32_16x16x32_bf16 v[196:199], a[116:119], a[20:23], v[196:199]
buffer_load_dwordx4 a[76:79], v2, s[40:43], s33 offen offset:1024 sc1
v_mfma_f32_16x16x32_bf16 v[220:223], a[116:119], a[28:31], 0
v_mfma_f32_16x16x32_bf16 v[220:223], a[112:115], a[24:27], v[220:223]
s_waitcnt vmcnt(13) lgkmcnt(7)
v_mfma_f32_16x16x32_bf16 a[172:175], a[120:123], a[160:163], 0
s_waitcnt lgkmcnt(0)
v_mfma_f32_16x16x32_bf16 v[224:227], a[128:131], a[24:27], 0
ds_read_b128 a[96:99], v5 offset:14336
v_mfma_f32_16x16x32_bf16 v[224:227], a[132:135], a[28:31], v[224:227]
buffer_load_dwordx4 a[80:83], v2, s[40:43], s35 offen offset:2048 sc1
v_mfma_f32_16x16x32_bf16 v[200:203], a[132:135], a[20:23], 0
ds_read_b128 a[100:103], v5 offset:20480
v_mfma_f32_16x16x32_bf16 v[200:203], a[128:131], a[16:19], v[200:203]
v_mfma_f32_16x16x32_bf16 v[176:179], a[128:131], a[8:11], 0
ds_read_b128 a[104:107], v5 offset:15360
v_mfma_f32_16x16x32_bf16 v[176:179], a[132:135], a[12:15], v[176:179]
buffer_load_dwordx4 v1, s[4:7], s44 offen offset:0 sc1 lds
v_mfma_f32_16x16x32_bf16 v[152:155], a[132:135], a[4:7], 0
ds_read_b128 a[108:111], v5 offset:21504
v_mfma_f32_16x16x32_bf16 v[152:155], a[128:131], a[0:3], v[152:155]
v_mfma_f32_16x16x32_bf16 v[132:135], a[136:139], a[0:3], 0
v_mfma_f32_16x16x32_bf16 v[132:135], a[140:143], a[4:7], v[132:135]
buffer_load_dwordx4 a[84:87], v2, s[40:43], s33 offen offset:2048 sc1
v_mfma_f32_16x16x32_bf16 v[156:159], a[140:143], a[12:15], 0
ds_read_b128 a[112:115], v5 offset:16384
v_mfma_f32_16x16x32_bf16 v[156:159], a[136:139], a[8:11], v[156:159]
ds_read_b128 a[116:119], v5 offset:22528
v_mfma_f32_16x16x32_bf16 v[180:183], a[136:139], a[16:19], 0
v_mfma_f32_16x16x32_bf16 v[180:183], a[140:143], a[20:23], v[180:183]
buffer_load_dwordx4 a[88:91], v2, s[40:43], s35 offen offset:3072 sc1
v_mfma_f32_16x16x32_bf16 v[204:207], a[140:143], a[28:31], 0
ds_read_b128 a[120:123], v6 offset:4096
v_mfma_f32_16x16x32_bf16 v[204:207], a[136:139], a[24:27], v[204:207]
v_mfma_f32_16x16x32_bf16 v[208:211], a[144:147], a[24:27], 0
v_mfma_f32_16x16x32_bf16 v[208:211], a[148:151], a[28:31], v[208:211]
buffer_load_dwordx4 v1, s[4:7], s44 offen offset:1024 sc1 lds
v_mfma_f32_16x16x32_bf16 v[184:187], a[148:151], a[20:23], 0
v_mfma_f32_16x16x32_bf16 v[184:187], a[144:147], a[16:19], v[184:187]
v_mfma_f32_16x16x32_bf16 v[160:163], a[144:147], a[8:11], 0
v_mfma_f32_16x16x32_bf16 v[160:163], a[148:151], a[12:15], v[160:163]
buffer_load_dwordx4 a[92:95], v2, s[40:43], s33 offen offset:3072 sc1
s_add_u32 s35, s35, 8192
v_mfma_f32_16x16x32_bf16 v[136:139], a[148:151], a[4:7], 0
s_add_u32 s33, s33, 8192
v_mfma_f32_16x16x32_bf16 v[136:139], a[144:147], a[0:3], v[136:139]
v_mfma_f32_16x16x32_bf16 a[176:179], a[152:155], a[160:163], 0
s_waitcnt vmcnt(11) lgkmcnt(0)
v_mfma_f32_16x16x32_bf16 v[140:143], a[96:99], a[32:35], v[140:143]
ds_read_b128 a[128:131], v5 offset:17408
v_mfma_f32_16x16x32_bf16 v[140:143], a[100:103], a[36:39], v[140:143]
buffer_load_dwordx4 a[0:3], v2, s[40:43], s35 offen offset:0 sc1
v_mfma_f32_16x16x32_bf16 v[164:167], a[100:103], a[44:47], v[164:167]
ds_read_b128 a[132:135], v5 offset:23552
v_mfma_f32_16x16x32_bf16 v[164:167], a[96:99], a[40:43], v[164:167]
v_mfma_f32_16x16x32_bf16 v[188:191], a[96:99], a[48:51], v[188:191]
ds_read_b128 a[136:139], v5 offset:12288
v_mfma_f32_16x16x32_bf16 v[188:191], a[100:103], a[52:55], v[188:191]
buffer_load_dwordx4 v1, s[4:7], s44 offen offset:2048 sc1 lds
s_add_u32 m0, s18, 0x21000
v_mfma_f32_16x16x32_bf16 v[212:215], a[100:103], a[60:63], v[212:215]
s_add_u32 s44, s50, 0xe21000
ds_read_b128 a[140:143], v5 offset:18432
v_mfma_f32_16x16x32_bf16 v[212:215], a[96:99], a[56:59], v[212:215]
v_mfma_f32_16x16x32_bf16 v[216:219], a[104:107], a[56:59], v[216:219]
v_mfma_f32_16x16x32_bf16 v[216:219], a[108:111], a[60:63], v[216:219]
buffer_load_dwordx4 a[4:7], v2, s[40:43], s33 offen offset:0 sc1
v_mfma_f32_16x16x32_bf16 v[192:195], a[108:111], a[52:55], v[192:195]
ds_read_b128 a[144:147], v5 offset:13312
v_mfma_f32_16x16x32_bf16 v[192:195], a[104:107], a[48:51], v[192:195]
ds_read_b128 a[148:151], v5 offset:19456
v_mfma_f32_16x16x32_bf16 v[168:171], a[104:107], a[40:43], v[168:171]
v_mfma_f32_16x16x32_bf16 v[168:171], a[108:111], a[44:47], v[168:171]
buffer_load_dwordx4 a[8:11], v2, s[40:43], s35 offen offset:1024 sc1
v_mfma_f32_16x16x32_bf16 v[144:147], a[108:111], a[36:39], v[144:147]
ds_read_b128 a[152:155], v6 offset:5120
v_mfma_f32_16x16x32_bf16 v[144:147], a[104:107], a[32:35], v[144:147]
v_mfma_f32_16x16x32_bf16 v[148:151], a[112:115], a[32:35], v[148:151]
v_mfma_f32_16x16x32_bf16 v[148:151], a[116:119], a[36:39], v[148:151]
buffer_load_dwordx4 v1, s[4:7], s44 offen offset:0 sc1 lds
v_mfma_f32_16x16x32_bf16 v[172:175], a[116:119], a[44:47], v[172:175]
v_mfma_f32_16x16x32_bf16 v[172:175], a[112:115], a[40:43], v[172:175]
v_mfma_f32_16x16x32_bf16 v[196:199], a[112:115], a[48:51], v[196:199]
v_mfma_f32_16x16x32_bf16 v[196:199], a[116:119], a[52:55], v[196:199]
buffer_load_dwordx4 a[12:15], v2, s[40:43], s33 offen offset:1024 sc1
v_mfma_f32_16x16x32_bf16 v[220:223], a[116:119], a[60:63], v[220:223]
v_mfma_f32_16x16x32_bf16 v[220:223], a[112:115], a[56:59], v[220:223]
v_mfma_f32_16x16x32_bf16 a[180:183], a[120:123], a[160:163], 0
s_waitcnt lgkmcnt(0)
v_mfma_f32_16x16x32_bf16 v[224:227], a[128:131], a[56:59], v[224:227]
ds_read_b128 a[96:99], v5 offset:26624
v_mfma_f32_16x16x32_bf16 v[224:227], a[132:135], a[60:63], v[224:227]
buffer_load_dwordx4 a[16:19], v2, s[40:43], s35 offen offset:2048 sc1
v_mfma_f32_16x16x32_bf16 v[200:203], a[132:135], a[52:55], v[200:203]
ds_read_b128 a[100:103], v5 offset:32768
v_mfma_f32_16x16x32_bf16 v[200:203], a[128:131], a[48:51], v[200:203]
v_mfma_f32_16x16x32_bf16 v[176:179], a[128:131], a[40:43], v[176:179]
ds_read_b128 a[104:107], v5 offset:27648
v_mfma_f32_16x16x32_bf16 v[176:179], a[132:135], a[44:47], v[176:179]
v_mfma_f32_16x16x32_bf16 v[152:155], a[132:135], a[36:39], v[152:155]
buffer_load_dwordx4 a[20:23], v2, s[40:43], s33 offen offset:2048 sc1
v_mfma_f32_16x16x32_bf16 v[152:155], a[128:131], a[32:35], v[152:155]
ds_read_b128 a[108:111], v5 offset:33792
v_mfma_f32_16x16x32_bf16 v[132:135], a[136:139], a[32:35], v[132:135]
v_mfma_f32_16x16x32_bf16 v[132:135], a[140:143], a[36:39], v[132:135]
ds_read_b128 a[112:115], v5 offset:28672
v_mfma_f32_16x16x32_bf16 v[156:159], a[140:143], a[44:47], v[156:159]
v_mfma_f32_16x16x32_bf16 v[156:159], a[136:139], a[40:43], v[156:159]
buffer_load_dwordx4 v1, s[4:7], s44 offen offset:1024 sc1 lds
v_mfma_f32_16x16x32_bf16 v[180:183], a[136:139], a[48:51], v[180:183]
ds_read_b128 a[116:119], v5 offset:34816
v_mfma_f32_16x16x32_bf16 v[180:183], a[140:143], a[52:55], v[180:183]
ds_read_b128 a[120:123], v6 offset:26624
v_mfma_f32_16x16x32_bf16 v[204:207], a[140:143], a[60:63], v[204:207]
v_mfma_f32_16x16x32_bf16 v[204:207], a[136:139], a[56:59], v[204:207]
v_mfma_f32_16x16x32_bf16 v[208:211], a[144:147], a[56:59], v[208:211]
buffer_load_dwordx4 a[24:27], v2, s[40:43], s35 offen offset:3072 sc1
v_mfma_f32_16x16x32_bf16 v[208:211], a[148:151], a[60:63], v[208:211]
v_mfma_f32_16x16x32_bf16 v[184:187], a[148:151], a[52:55], v[184:187]
v_mfma_f32_16x16x32_bf16 v[184:187], a[144:147], a[48:51], v[184:187]
v_mfma_f32_16x16x32_bf16 v[160:163], a[144:147], a[40:43], v[160:163]
v_mfma_f32_16x16x32_bf16 v[160:163], a[148:151], a[44:47], v[160:163]
buffer_load_dwordx4 a[28:31], v2, s[40:43], s33 offen offset:3072 sc1
s_add_u32 s35, s35, 8192
v_mfma_f32_16x16x32_bf16 v[136:139], a[148:151], a[36:39], v[136:139]
s_add_u32 s33, s33, 8192
v_mfma_f32_16x16x32_bf16 v[136:139], a[144:147], a[32:35], v[136:139]
v_mfma_f32_16x16x32_bf16 a[184:187], a[152:155], a[160:163], 0
s_waitcnt vmcnt(11) lgkmcnt(0)
v_mfma_f32_16x16x32_bf16 v[140:143], a[96:99], a[64:67], v[140:143]
ds_read_b128 a[128:131], v5 offset:29696
v_mfma_f32_16x16x32_bf16 v[140:143], a[100:103], a[68:71], v[140:143]
buffer_load_dwordx4 a[32:35], v2, s[40:43], s35 offen offset:0 sc1
v_mfma_f32_16x16x32_bf16 v[164:167], a[100:103], a[76:79], v[164:167]
ds_read_b128 a[132:135], v5 offset:35840
v_mfma_f32_16x16x32_bf16 v[164:167], a[96:99], a[72:75], v[164:167]
v_mfma_f32_16x16x32_bf16 v[188:191], a[96:99], a[80:83], v[188:191]
ds_read_b128 a[136:139], v5 offset:24576
v_mfma_f32_16x16x32_bf16 v[188:191], a[100:103], a[84:87], v[188:191]
buffer_load_dwordx4 v1, s[4:7], s44 offen offset:2048 sc1 lds
s_add_u32 s63, s28, 8
v_mfma_f32_16x16x32_bf16 v[212:215], a[100:103], a[92:95], v[212:215]
s_lshl_b32 s63, s63, 12
ds_read_b128 a[140:143], v5 offset:30720
v_mfma_f32_16x16x32_bf16 v[212:215], a[96:99], a[88:91], v[212:215]
v_mfma_f32_16x16x32_bf16 v[216:219], a[104:107], a[88:91], v[216:219]
v_mfma_f32_16x16x32_bf16 v[216:219], a[108:111], a[92:95], v[216:219]
buffer_load_dwordx4 a[36:39], v2, s[40:43], s33 offen offset:0 sc1
v_mfma_f32_16x16x32_bf16 v[192:195], a[108:111], a[84:87], v[192:195]
ds_read_b128 a[144:147], v5 offset:25600
v_mfma_f32_16x16x32_bf16 v[192:195], a[104:107], a[80:83], v[192:195]
ds_read_b128 a[148:151], v5 offset:31744
v_mfma_f32_16x16x32_bf16 v[168:171], a[104:107], a[72:75], v[168:171]
v_mfma_f32_16x16x32_bf16 v[168:171], a[108:111], a[76:79], v[168:171]
buffer_load_dwordx4 a[40:43], v2, s[40:43], s35 offen offset:1024 sc1
v_mfma_f32_16x16x32_bf16 v[144:147], a[108:111], a[68:71], v[144:147]
ds_read_b128 a[152:155], v6 offset:27648
v_mfma_f32_16x16x32_bf16 v[144:147], a[104:107], a[64:67], v[144:147]
v_mfma_f32_16x16x32_bf16 v[148:151], a[112:115], a[64:67], v[148:151]
v_mfma_f32_16x16x32_bf16 v[148:151], a[116:119], a[68:71], v[148:151]
buffer_load_dwordx4 a[168:171], v3, s[40:43], s63 offen sc1
s_add_u32 s88, s82, 0x280000
v_mfma_f32_16x16x32_bf16 v[172:175], a[116:119], a[76:79], v[172:175]
v_mfma_f32_16x16x32_bf16 v[172:175], a[112:115], a[72:75], v[172:175]
v_mfma_f32_16x16x32_bf16 v[196:199], a[112:115], a[80:83], v[196:199]
v_mfma_f32_16x16x32_bf16 v[196:199], a[116:119], a[84:87], v[196:199]
buffer_load_dwordx4 a[44:47], v2, s[40:43], s33 offen offset:1024 sc1
v_mfma_f32_16x16x32_bf16 v[220:223], a[116:119], a[92:95], v[220:223]
v_mfma_f32_16x16x32_bf16 v[220:223], a[112:115], a[88:91], v[220:223]
v_mfma_f32_16x16x32_bf16 a[172:175], a[120:123], a[164:167], a[172:175]
s_waitcnt lgkmcnt(0)
v_mfma_f32_16x16x32_bf16 v[224:227], a[128:131], a[88:91], v[224:227]
ds_read_b128 a[96:99], v5 offset:38912
v_mfma_f32_16x16x32_bf16 v[224:227], a[132:135], a[92:95], v[224:227]
buffer_load_dwordx4 a[48:51], v2, s[40:43], s35 offen offset:2048 sc1
v_mfma_f32_16x16x32_bf16 v[200:203], a[132:135], a[84:87], v[200:203]
ds_read_b128 a[100:103], v5 offset:45056
v_mfma_f32_16x16x32_bf16 v[200:203], a[128:131], a[80:83], v[200:203]
v_mfma_f32_16x16x32_bf16 v[176:179], a[128:131], a[72:75], v[176:179]
ds_read_b128 a[104:107], v5 offset:39936
v_mfma_f32_16x16x32_bf16 v[176:179], a[132:135], a[76:79], v[176:179]
v_mfma_f32_16x16x32_bf16 v[152:155], a[132:135], a[68:71], v[152:155]
buffer_load_dwordx4 a[52:55], v2, s[40:43], s33 offen offset:2048 sc1
v_mfma_f32_16x16x32_bf16 v[152:155], a[128:131], a[64:67], v[152:155]
ds_read_b128 a[108:111], v5 offset:46080
v_mfma_f32_16x16x32_bf16 v[132:135], a[136:139], a[64:67], v[132:135]
v_mfma_f32_16x16x32_bf16 v[132:135], a[140:143], a[68:71], v[132:135]
ds_read_b128 a[112:115], v5 offset:40960
v_mfma_f32_16x16x32_bf16 v[156:159], a[140:143], a[76:79], v[156:159]
v_mfma_f32_16x16x32_bf16 v[156:159], a[136:139], a[72:75], v[156:159]
buffer_load_dwordx4 v[92:95], v1, s[4:7], s88 offen offset:0 sc1
v_mfma_f32_16x16x32_bf16 v[180:183], a[136:139], a[80:83], v[180:183]
ds_read_b128 a[116:119], v5 offset:47104
v_mfma_f32_16x16x32_bf16 v[180:183], a[140:143], a[84:87], v[180:183]
ds_read_b128 a[120:123], v6 offset:28672
v_mfma_f32_16x16x32_bf16 v[204:207], a[140:143], a[92:95], v[204:207]
v_mfma_f32_16x16x32_bf16 v[204:207], a[136:139], a[88:91], v[204:207]
v_mfma_f32_16x16x32_bf16 v[208:211], a[144:147], a[88:91], v[208:211]
buffer_load_dwordx4 a[56:59], v2, s[40:43], s35 offen offset:3072 sc1
v_mfma_f32_16x16x32_bf16 v[208:211], a[148:151], a[92:95], v[208:211]
v_mfma_f32_16x16x32_bf16 v[184:187], a[148:151], a[84:87], v[184:187]
v_mfma_f32_16x16x32_bf16 v[184:187], a[144:147], a[80:83], v[184:187]
v_mfma_f32_16x16x32_bf16 v[160:163], a[144:147], a[72:75], v[160:163]
v_mfma_f32_16x16x32_bf16 v[160:163], a[148:151], a[76:79], v[160:163]
buffer_load_dwordx4 a[60:63], v2, s[40:43], s33 offen offset:3072 sc1
s_add_u32 s35, s35, 8192
v_mfma_f32_16x16x32_bf16 v[136:139], a[148:151], a[68:71], v[136:139]
s_add_u32 s33, s33, 8192
v_mfma_f32_16x16x32_bf16 v[136:139], a[144:147], a[64:67], v[136:139]
v_mfma_f32_16x16x32_bf16 a[176:179], a[152:155], a[164:167], a[176:179]
s_waitcnt vmcnt(11) lgkmcnt(0)
v_mfma_f32_16x16x32_bf16 v[140:143], a[96:99], a[0:3], v[140:143]
ds_read_b128 a[128:131], v5 offset:41984
v_mfma_f32_16x16x32_bf16 v[140:143], a[100:103], a[4:7], v[140:143]
buffer_load_dwordx4 a[64:67], v2, s[40:43], s35 offen offset:0 sc1
v_mfma_f32_16x16x32_bf16 v[164:167], a[100:103], a[12:15], v[164:167]
ds_read_b128 a[132:135], v5 offset:48128
v_mfma_f32_16x16x32_bf16 v[164:167], a[96:99], a[8:11], v[164:167]
v_mfma_f32_16x16x32_bf16 v[188:191], a[96:99], a[16:19], v[188:191]
ds_read_b128 a[136:139], v5 offset:36864
v_mfma_f32_16x16x32_bf16 v[188:191], a[100:103], a[20:23], v[188:191]
buffer_load_dwordx4 v[96:99], v1, s[4:7], s88 offen offset:1024 sc1
v_mfma_f32_16x16x32_bf16 v[212:215], a[100:103], a[28:31], v[212:215]
ds_read_b128 a[140:143], v5 offset:43008
v_mfma_f32_16x16x32_bf16 v[212:215], a[96:99], a[24:27], v[212:215]
v_mfma_f32_16x16x32_bf16 v[216:219], a[104:107], a[24:27], v[216:219]
v_mfma_f32_16x16x32_bf16 v[216:219], a[108:111], a[28:31], v[216:219]
buffer_load_dwordx4 a[68:71], v2, s[40:43], s33 offen offset:0 sc1
v_mfma_f32_16x16x32_bf16 v[192:195], a[108:111], a[20:23], v[192:195]
ds_read_b128 a[144:147], v5 offset:37888
v_mfma_f32_16x16x32_bf16 v[192:195], a[104:107], a[16:19], v[192:195]
ds_read_b128 a[148:151], v5 offset:44032
v_mfma_f32_16x16x32_bf16 v[168:171], a[104:107], a[8:11], v[168:171]
v_mfma_f32_16x16x32_bf16 v[168:171], a[108:111], a[12:15], v[168:171]
buffer_load_dwordx4 a[72:75], v2, s[40:43], s35 offen offset:1024 sc1
v_mfma_f32_16x16x32_bf16 v[144:147], a[108:111], a[4:7], v[144:147]
ds_read_b128 a[152:155], v6 offset:29696
v_mfma_f32_16x16x32_bf16 v[144:147], a[104:107], a[0:3], v[144:147]
v_mfma_f32_16x16x32_bf16 v[148:151], a[112:115], a[0:3], v[148:151]
v_mfma_f32_16x16x32_bf16 v[148:151], a[116:119], a[4:7], v[148:151]
buffer_load_dwordx4 v[100:103], v1, s[4:7], s88 offen offset:2048 sc1
v_mfma_f32_16x16x32_bf16 v[172:175], a[116:119], a[12:15], v[172:175]
v_mfma_f32_16x16x32_bf16 v[172:175], a[112:115], a[8:11], v[172:175]
v_mfma_f32_16x16x32_bf16 v[196:199], a[112:115], a[16:19], v[196:199]
v_mfma_f32_16x16x32_bf16 v[196:199], a[116:119], a[20:23], v[196:199]
buffer_load_dwordx4 a[76:79], v2, s[40:43], s33 offen offset:1024 sc1
v_mfma_f32_16x16x32_bf16 v[220:223], a[116:119], a[28:31], v[220:223]
v_mfma_f32_16x16x32_bf16 v[220:223], a[112:115], a[24:27], v[220:223]
v_mfma_f32_16x16x32_bf16 a[180:183], a[120:123], a[164:167], a[180:183]
s_waitcnt lgkmcnt(0)
s_barrier
v_mfma_f32_16x16x32_bf16 v[224:227], a[128:131], a[24:27], v[224:227]
v_add_u32 v5, 49152, v1
v_add_u32 v6, s55, v5
v_mfma_f32_16x16x32_bf16 v[224:227], a[132:135], a[28:31], v[224:227]
buffer_load_dwordx4 a[80:83], v2, s[40:43], s35 offen offset:2048 sc1
v_mfma_f32_16x16x32_bf16 v[200:203], a[132:135], a[20:23], v[200:203]
ds_read_b128 a[96:99], v5 offset:2048
v_mfma_f32_16x16x32_bf16 v[200:203], a[128:131], a[16:19], v[200:203]
ds_read_b128 a[100:103], v5 offset:8192
v_mfma_f32_16x16x32_bf16 v[176:179], a[128:131], a[8:11], v[176:179]
ds_read_b128 a[104:107], v5 offset:3072
v_mfma_f32_16x16x32_bf16 v[176:179], a[132:135], a[12:15], v[176:179]
buffer_load_dwordx4 v[104:107], v1, s[4:7], s88 offen offset:3072 sc1
s_add_u32 s88, s88, 4096
v_mfma_f32_16x16x32_bf16 v[152:155], a[132:135], a[4:7], v[152:155]
ds_read_b128 a[108:111], v5 offset:9216
v_mfma_f32_16x16x32_bf16 v[152:155], a[128:131], a[0:3], v[152:155]
v_mfma_f32_16x16x32_bf16 v[132:135], a[136:139], a[0:3], v[132:135]
v_mfma_f32_16x16x32_bf16 v[132:135], a[140:143], a[4:7], v[132:135]
buffer_load_dwordx4 a[84:87], v2, s[40:43], s33 offen offset:2048 sc1
v_mfma_f32_16x16x32_bf16 v[156:159], a[140:143], a[12:15], v[156:159]
ds_read_b128 a[112:115], v5 offset:4096
v_mfma_f32_16x16x32_bf16 v[156:159], a[136:139], a[8:11], v[156:159]
ds_read_b128 a[116:119], v5 offset:10240
v_mfma_f32_16x16x32_bf16 v[180:183], a[136:139], a[16:19], v[180:183]
v_mfma_f32_16x16x32_bf16 v[180:183], a[140:143], a[20:23], v[180:183]
buffer_load_dwordx4 a[88:91], v2, s[40:43], s35 offen offset:3072 sc1
v_mfma_f32_16x16x32_bf16 v[204:207], a[140:143], a[28:31], v[204:207]
ds_read_b128 a[120:123], v6 offset:2048
v_mfma_f32_16x16x32_bf16 v[204:207], a[136:139], a[24:27], v[204:207]
v_mfma_f32_16x16x32_bf16 v[208:211], a[144:147], a[24:27], v[208:211]
v_mfma_f32_16x16x32_bf16 v[208:211], a[148:151], a[28:31], v[208:211]
buffer_load_dwordx4 v[108:111], v1, s[4:7], s88 offen offset:0 sc1
s_add_u32 s63, s28, 12
v_mfma_f32_16x16x32_bf16 v[184:187], a[148:151], a[20:23], v[184:187]
s_lshl_b32 s63, s63, 12
v_mfma_f32_16x16x32_bf16 v[184:187], a[144:147], a[16:19], v[184:187]
v_mfma_f32_16x16x32_bf16 v[160:163], a[144:147], a[8:11], v[160:163]
v_mfma_f32_16x16x32_bf16 v[160:163], a[148:151], a[12:15], v[160:163]
buffer_load_dwordx4 a[92:95], v2, s[40:43], s33 offen offset:3072 sc1
s_add_u32 s35, s35, 8192
v_mfma_f32_16x16x32_bf16 v[136:139], a[148:151], a[4:7], v[136:139]
s_add_u32 s33, s33, 8192
v_mfma_f32_16x16x32_bf16 v[136:139], a[144:147], a[0:3], v[136:139]
v_mfma_f32_16x16x32_bf16 a[184:187], a[152:155], a[164:167], a[184:187]
s_waitcnt vmcnt(12) lgkmcnt(0)
v_mfma_f32_16x16x32_bf16 v[140:143], a[96:99], a[32:35], v[140:143]
ds_read_b128 a[128:131], v5 offset:5120
v_mfma_f32_16x16x32_bf16 v[140:143], a[100:103], a[36:39], v[140:143]
buffer_load_dwordx4 a[0:3], v2, s[40:43], s35 offen offset:0 sc1
v_mfma_f32_16x16x32_bf16 v[164:167], a[100:103], a[44:47], v[164:167]
ds_read_b128 a[132:135], v5 offset:11264
v_mfma_f32_16x16x32_bf16 v[164:167], a[96:99], a[40:43], v[164:167]
v_mfma_f32_16x16x32_bf16 v[188:191], a[96:99], a[48:51], v[188:191]
ds_read_b128 a[136:139], v5 offset:0
v_mfma_f32_16x16x32_bf16 v[188:191], a[100:103], a[52:55], v[188:191]
v_mfma_f32_16x16x32_bf16 v[212:215], a[100:103], a[60:63], v[212:215]
buffer_load_dwordx4 a[4:7], v2, s[40:43], s33 offen offset:0 sc1
v_mfma_f32_16x16x32_bf16 v[212:215], a[96:99], a[56:59], v[212:215]
ds_read_b128 a[140:143], v5 offset:6144
v_mfma_f32_16x16x32_bf16 v[216:219], a[104:107], a[56:59], v[216:219]
v_mfma_f32_16x16x32_bf16 v[216:219], a[108:111], a[60:63], v[216:219]
ds_read_b128 a[144:147], v5 offset:1024
v_mfma_f32_16x16x32_bf16 v[192:195], a[108:111], a[52:55], v[192:195]
v_mfma_f32_16x16x32_bf16 v[192:195], a[104:107], a[48:51], v[192:195]
buffer_load_dwordx4 a[160:163], v3, s[40:43], s63 offen sc1
v_mfma_f32_16x16x32_bf16 v[168:171], a[104:107], a[40:43], v[168:171]
ds_read_b128 a[148:151], v5 offset:7168
v_mfma_f32_16x16x32_bf16 v[168:171], a[108:111], a[44:47], v[168:171]
ds_read_b128 a[152:155], v6 offset:3072
v_mfma_f32_16x16x32_bf16 v[144:147], a[108:111], a[36:39], v[144:147]
v_mfma_f32_16x16x32_bf16 v[144:147], a[104:107], a[32:35], v[144:147]
v_mfma_f32_16x16x32_bf16 v[148:151], a[112:115], a[32:35], v[148:151]
buffer_load_dwordx4 a[8:11], v2, s[40:43], s35 offen offset:1024 sc1
v_mfma_f32_16x16x32_bf16 v[148:151], a[116:119], a[36:39], v[148:151]
v_mfma_f32_16x16x32_bf16 v[172:175], a[116:119], a[44:47], v[172:175]
v_mfma_f32_16x16x32_bf16 v[172:175], a[112:115], a[40:43], v[172:175]
v_mfma_f32_16x16x32_bf16 v[196:199], a[112:115], a[48:51], v[196:199]
v_mfma_f32_16x16x32_bf16 v[196:199], a[116:119], a[52:55], v[196:199]
buffer_load_dwordx4 a[12:15], v2, s[40:43], s33 offen offset:1024 sc1
v_mfma_f32_16x16x32_bf16 v[220:223], a[116:119], a[60:63], v[220:223]
v_mfma_f32_16x16x32_bf16 v[220:223], a[112:115], a[56:59], v[220:223]
v_mfma_f32_16x16x32_bf16 a[172:175], a[120:123], a[168:171], a[172:175]
s_waitcnt lgkmcnt(0)
v_mfma_f32_16x16x32_bf16 v[224:227], a[128:131], a[56:59], v[224:227]
ds_read_b128 a[96:99], v5 offset:14336
v_mfma_f32_16x16x32_bf16 v[224:227], a[132:135], a[60:63], v[224:227]
buffer_load_dwordx4 a[16:19], v2, s[40:43], s35 offen offset:2048 sc1
v_mfma_f32_16x16x32_bf16 v[200:203], a[132:135], a[52:55], v[200:203]
ds_read_b128 a[100:103], v5 offset:20480
v_mfma_f32_16x16x32_bf16 v[200:203], a[128:131], a[48:51], v[200:203]
v_mfma_f32_16x16x32_bf16 v[176:179], a[128:131], a[40:43], v[176:179]
ds_read_b128 a[104:107], v5 offset:15360
v_mfma_f32_16x16x32_bf16 v[176:179], a[132:135], a[44:47], v[176:179]
buffer_load_dwordx4 v[112:115], v1, s[4:7], s88 offen offset:1024 sc1
v_mfma_f32_16x16x32_bf16 v[152:155], a[132:135], a[36:39], v[152:155]
ds_read_b128 a[108:111], v5 offset:21504
v_mfma_f32_16x16x32_bf16 v[152:155], a[128:131], a[32:35], v[152:155]
v_mfma_f32_16x16x32_bf16 v[132:135], a[136:139], a[32:35], v[132:135]
v_mfma_f32_16x16x32_bf16 v[132:135], a[140:143], a[36:39], v[132:135]
buffer_load_dwordx4 a[20:23], v2, s[40:43], s33 offen offset:2048 sc1
v_mfma_f32_16x16x32_bf16 v[156:159], a[140:143], a[44:47], v[156:159]
ds_read_b128 a[112:115], v5 offset:16384
v_mfma_f32_16x16x32_bf16 v[156:159], a[136:139], a[40:43], v[156:159]
ds_read_b128 a[116:119], v5 offset:22528
v_mfma_f32_16x16x32_bf16 v[180:183], a[136:139], a[48:51], v[180:183]
v_mfma_f32_16x16x32_bf16 v[180:183], a[140:143], a[52:55], v[180:183]
buffer_load_dwordx4 a[24:27], v2, s[40:43], s35 offen offset:3072 sc1
v_mfma_f32_16x16x32_bf16 v[204:207], a[140:143], a[60:63], v[204:207]
ds_read_b128 a[120:123], v6 offset:4096
v_mfma_f32_16x16x32_bf16 v[204:207], a[136:139], a[56:59], v[204:207]
v_mfma_f32_16x16x32_bf16 v[208:211], a[144:147], a[56:59], v[208:211]
v_mfma_f32_16x16x32_bf16 v[208:211], a[148:151], a[60:63], v[208:211]
buffer_load_dwordx4 v[116:119], v1, s[4:7], s88 offen offset:2048 sc1
v_mfma_f32_16x16x32_bf16 v[184:187], a[148:151], a[52:55], v[184:187]
v_mfma_f32_16x16x32_bf16 v[184:187], a[144:147], a[48:51], v[184:187]
v_mfma_f32_16x16x32_bf16 v[160:163], a[144:147], a[40:43], v[160:163]
v_mfma_f32_16x16x32_bf16 v[160:163], a[148:151], a[44:47], v[160:163]
buffer_load_dwordx4 a[28:31], v2, s[40:43], s33 offen offset:3072 sc1
s_add_u32 s35, s35, 8192
v_mfma_f32_16x16x32_bf16 v[136:139], a[148:151], a[36:39], v[136:139]
s_add_u32 s33, s33, 8192
v_mfma_f32_16x16x32_bf16 v[136:139], a[144:147], a[32:35], v[136:139]
v_mfma_f32_16x16x32_bf16 a[176:179], a[152:155], a[168:171], a[176:179]
s_waitcnt vmcnt(11) lgkmcnt(0)
v_mfma_f32_16x16x32_bf16 v[140:143], a[96:99], a[64:67], v[140:143]
ds_read_b128 a[128:131], v5 offset:17408
v_mfma_f32_16x16x32_bf16 v[140:143], a[100:103], a[68:71], v[140:143]
buffer_load_dwordx4 a[32:35], v2, s[40:43], s35 offen offset:0 sc1
v_mfma_f32_16x16x32_bf16 v[164:167], a[100:103], a[76:79], v[164:167]
ds_read_b128 a[132:135], v5 offset:23552
v_mfma_f32_16x16x32_bf16 v[164:167], a[96:99], a[72:75], v[164:167]
v_mfma_f32_16x16x32_bf16 v[188:191], a[96:99], a[80:83], v[188:191]
ds_read_b128 a[136:139], v5 offset:12288
v_mfma_f32_16x16x32_bf16 v[188:191], a[100:103], a[84:87], v[188:191]
v_mfma_f32_16x16x32_bf16 v[212:215], a[100:103], a[92:95], v[212:215]
buffer_load_dwordx4 a[36:39], v2, s[40:43], s33 offen offset:0 sc1
v_mfma_f32_16x16x32_bf16 v[212:215], a[96:99], a[88:91], v[212:215]
ds_read_b128 a[140:143], v5 offset:18432
v_mfma_f32_16x16x32_bf16 v[216:219], a[104:107], a[88:91], v[216:219]
v_mfma_f32_16x16x32_bf16 v[216:219], a[108:111], a[92:95], v[216:219]
ds_read_b128 a[144:147], v5 offset:13312
v_mfma_f32_16x16x32_bf16 v[192:195], a[108:111], a[84:87], v[192:195]
v_mfma_f32_16x16x32_bf16 v[192:195], a[104:107], a[80:83], v[192:195]
buffer_load_dwordx4 v[120:123], v1, s[4:7], s88 offen offset:3072 sc1
s_add_u32 s88, s83, 0x280000
v_mfma_f32_16x16x32_bf16 v[168:171], a[104:107], a[72:75], v[168:171]
ds_read_b128 a[148:151], v5 offset:19456
v_mfma_f32_16x16x32_bf16 v[168:171], a[108:111], a[76:79], v[168:171]
ds_read_b128 a[152:155], v6 offset:5120
v_mfma_f32_16x16x32_bf16 v[144:147], a[108:111], a[68:71], v[144:147]
v_mfma_f32_16x16x32_bf16 v[144:147], a[104:107], a[64:67], v[144:147]
v_mfma_f32_16x16x32_bf16 v[148:151], a[112:115], a[64:67], v[148:151]
buffer_load_dwordx4 a[40:43], v2, s[40:43], s35 offen offset:1024 sc1
v_mfma_f32_16x16x32_bf16 v[148:151], a[116:119], a[68:71], v[148:151]
v_mfma_f32_16x16x32_bf16 v[172:175], a[116:119], a[76:79], v[172:175]
v_mfma_f32_16x16x32_bf16 v[172:175], a[112:115], a[72:75], v[172:175]
v_mfma_f32_16x16x32_bf16 v[196:199], a[112:115], a[80:83], v[196:199]
v_mfma_f32_16x16x32_bf16 v[196:199], a[116:119], a[84:87], v[196:199]
buffer_load_dwordx4 a[44:47], v2, s[40:43], s33 offen offset:1024 sc1
v_mfma_f32_16x16x32_bf16 v[220:223], a[116:119], a[92:95], v[220:223]
v_mfma_f32_16x16x32_bf16 v[220:223], a[112:115], a[88:91], v[220:223]
v_mfma_f32_16x16x32_bf16 a[180:183], a[120:123], a[168:171], a[180:183]
s_waitcnt lgkmcnt(0)
v_mfma_f32_16x16x32_bf16 v[224:227], a[128:131], a[88:91], v[224:227]
ds_read_b128 a[96:99], v5 offset:26624
v_mfma_f32_16x16x32_bf16 v[224:227], a[132:135], a[92:95], v[224:227]
buffer_load_dwordx4 a[48:51], v2, s[40:43], s35 offen offset:2048 sc1
v_mfma_f32_16x16x32_bf16 v[200:203], a[132:135], a[84:87], v[200:203]
ds_read_b128 a[100:103], v5 offset:32768
v_mfma_f32_16x16x32_bf16 v[200:203], a[128:131], a[80:83], v[200:203]
v_mfma_f32_16x16x32_bf16 v[176:179], a[128:131], a[72:75], v[176:179]
ds_read_b128 a[104:107], v5 offset:27648
v_mfma_f32_16x16x32_bf16 v[176:179], a[132:135], a[76:79], v[176:179]
buffer_load_dwordx4 v[124:127], v1, s[4:7], s88 offen offset:0 sc1
v_mfma_f32_16x16x32_bf16 v[152:155], a[132:135], a[68:71], v[152:155]
ds_read_b128 a[108:111], v5 offset:33792
v_mfma_f32_16x16x32_bf16 v[152:155], a[128:131], a[64:67], v[152:155]
v_mfma_f32_16x16x32_bf16 v[132:135], a[136:139], a[64:67], v[132:135]
v_mfma_f32_16x16x32_bf16 v[132:135], a[140:143], a[68:71], v[132:135]
buffer_load_dwordx4 a[52:55], v2, s[40:43], s33 offen offset:2048 sc1
v_mfma_f32_16x16x32_bf16 v[156:159], a[140:143], a[76:79], v[156:159]
ds_read_b128 a[112:115], v5 offset:28672
v_mfma_f32_16x16x32_bf16 v[156:159], a[136:139], a[72:75], v[156:159]
ds_read_b128 a[116:119], v5 offset:34816
v_mfma_f32_16x16x32_bf16 v[180:183], a[136:139], a[80:83], v[180:183]
v_mfma_f32_16x16x32_bf16 v[180:183], a[140:143], a[84:87], v[180:183]
buffer_load_dwordx4 a[56:59], v2, s[40:43], s35 offen offset:3072 sc1
v_mfma_f32_16x16x32_bf16 v[204:207], a[140:143], a[92:95], v[204:207]
ds_read_b128 a[120:123], v6 offset:26624
v_mfma_f32_16x16x32_bf16 v[204:207], a[136:139], a[88:91], v[204:207]
v_mfma_f32_16x16x32_bf16 v[208:211], a[144:147], a[88:91], v[208:211]
v_mfma_f32_16x16x32_bf16 v[208:211], a[148:151], a[92:95], v[208:211]
buffer_load_dwordx4 v[128:131], v1, s[4:7], s88 offen offset:1024 sc1
s_add_u32 m0, s18, 0x0
L_stub11:
s_cbranch_execz L_stub12
v_mfma_f32_16x16x32_bf16 v[184:187], a[148:151], a[84:87], v[184:187]
s_add_u32 s44, s50, 0xe24000
v_mfma_f32_16x16x32_bf16 v[184:187], a[144:147], a[80:83], v[184:187]
v_mfma_f32_16x16x32_bf16 v[160:163], a[144:147], a[72:75], v[160:163]
v_mfma_f32_16x16x32_bf16 v[160:163], a[148:151], a[76:79], v[160:163]
buffer_load_dwordx4 a[60:63], v2, s[40:43], s33 offen offset:3072 sc1
s_add_u32 s35, s35, 8192
v_mfma_f32_16x16x32_bf16 v[136:139], a[148:151], a[68:71], v[136:139]
s_add_u32 s33, s33, 8192
v_mfma_f32_16x16x32_bf16 v[136:139], a[144:147], a[64:67], v[136:139]
v_mfma_f32_16x16x32_bf16 a[184:187], a[152:155], a[168:171], a[184:187]
s_waitcnt vmcnt(11) lgkmcnt(0)
v_mfma_f32_16x16x32_bf16 v[140:143], a[96:99], a[0:3], v[140:143]
ds_read_b128 a[128:131], v5 offset:29696
v_mfma_f32_16x16x32_bf16 v[140:143], a[100:103], a[4:7], v[140:143]
buffer_load_dwordx4 a[64:67], v2, s[40:43], s35 offen offset:0 sc1
v_mfma_f32_16x16x32_bf16 v[164:167], a[100:103], a[12:15], v[164:167]
ds_read_b128 a[132:135], v5 offset:35840
v_mfma_f32_16x16x32_bf16 v[164:167], a[96:99], a[8:11], v[164:167]
v_mfma_f32_16x16x32_bf16 v[188:191], a[96:99], a[16:19], v[188:191]
ds_read_b128 a[136:139], v5 offset:24576
v_mfma_f32_16x16x32_bf16 v[188:191], a[100:103], a[20:23], v[188:191]
buffer_load_dwordx4 v1, s[4:7], s44 offen offset:0 sc1 lds
s_add_u32 s63, s28, 16
v_mfma_f32_16x16x32_bf16 v[212:215], a[100:103], a[28:31], v[212:215]
s_lshl_b32 s63, s63, 12
ds_read_b128 a[140:143], v5 offset:30720
v_mfma_f32_16x16x32_bf16 v[212:215], a[96:99], a[24:27], v[212:215]
v_mfma_f32_16x16x32_bf16 v[216:219], a[104:107], a[24:27], v[216:219]
v_mfma_f32_16x16x32_bf16 v[216:219], a[108:111], a[28:31], v[216:219]
buffer_load_dwordx4 a[68:71], v2, s[40:43], s33 offen offset:0 sc1
v_mfma_f32_16x16x32_bf16 v[192:195], a[108:111], a[20:23], v[192:195]
ds_read_b128 a[144:147], v5 offset:25600
v_mfma_f32_16x16x32_bf16 v[192:195], a[104:107], a[16:19], v[192:195]
ds_read_b128 a[148:151], v5 offset:31744
v_mfma_f32_16x16x32_bf16 v[168:171], a[104:107], a[8:11], v[168:171]
v_mfma_f32_16x16x32_bf16 v[168:171], a[108:111], a[12:15], v[168:171]
buffer_load_dwordx4 a[72:75], v2, s[40:43], s35 offen offset:1024 sc1
v_mfma_f32_16x16x32_bf16 v[144:147], a[108:111], a[4:7], v[144:147]
ds_read_b128 a[152:155], v6 offset:27648
v_mfma_f32_16x16x32_bf16 v[144:147], a[104:107], a[0:3], v[144:147]
v_mfma_f32_16x16x32_bf16 v[148:151], a[112:115], a[0:3], v[148:151]
v_mfma_f32_16x16x32_bf16 v[148:151], a[116:119], a[4:7], v[148:151]
buffer_load_dwordx4 a[164:167], v3, s[40:43], s63 offen sc1
v_mfma_f32_16x16x32_bf16 v[172:175], a[116:119], a[12:15], v[172:175]
v_mfma_f32_16x16x32_bf16 v[172:175], a[112:115], a[8:11], v[172:175]
v_mfma_f32_16x16x32_bf16 v[196:199], a[112:115], a[16:19], v[196:199]
v_mfma_f32_16x16x32_bf16 v[196:199], a[116:119], a[20:23], v[196:199]
buffer_load_dwordx4 a[76:79], v2, s[40:43], s33 offen offset:1024 sc1
v_mfma_f32_16x16x32_bf16 v[220:223], a[116:119], a[28:31], v[220:223]
v_mfma_f32_16x16x32_bf16 v[220:223], a[112:115], a[24:27], v[220:223]
v_mfma_f32_16x16x32_bf16 a[172:175], a[120:123], a[160:163], a[172:175]
s_waitcnt lgkmcnt(0)
v_mfma_f32_16x16x32_bf16 v[224:227], a[128:131], a[24:27], v[224:227]
ds_read_b128 a[96:99], v5 offset:38912
v_mfma_f32_16x16x32_bf16 v[224:227], a[132:135], a[28:31], v[224:227]
buffer_load_dwordx4 a[80:83], v2, s[40:43], s35 offen offset:2048 sc1
v_mfma_f32_16x16x32_bf16 v[200:203], a[132:135], a[20:23], v[200:203]
ds_read_b128 a[100:103], v5 offset:45056
v_mfma_f32_16x16x32_bf16 v[200:203], a[128:131], a[16:19], v[200:203]
v_mfma_f32_16x16x32_bf16 v[176:179], a[128:131], a[8:11], v[176:179]
ds_read_b128 a[104:107], v5 offset:39936
v_mfma_f32_16x16x32_bf16 v[176:179], a[132:135], a[12:15], v[176:179]
v_mfma_f32_16x16x32_bf16 v[152:155], a[132:135], a[4:7], v[152:155]
buffer_load_dwordx4 a[84:87], v2, s[40:43], s33 offen offset:2048 sc1
v_mfma_f32_16x16x32_bf16 v[152:155], a[128:131], a[0:3], v[152:155]
ds_read_b128 a[108:111], v5 offset:46080
v_mfma_f32_16x16x32_bf16 v[132:135], a[136:139], a[0:3], v[132:135]
v_mfma_f32_16x16x32_bf16 v[132:135], a[140:143], a[4:7], v[132:135]
ds_read_b128 a[112:115], v5 offset:40960
v_mfma_f32_16x16x32_bf16 v[156:159], a[140:143], a[12:15], v[156:159]
v_mfma_f32_16x16x32_bf16 v[156:159], a[136:139], a[8:11], v[156:159]
buffer_load_dwordx4 v1, s[4:7], s44 offen offset:1024 sc1 lds
v_mfma_f32_16x16x32_bf16 v[180:183], a[136:139], a[16:19], v[180:183]
ds_read_b128 a[116:119], v5 offset:47104
v_mfma_f32_16x16x32_bf16 v[180:183], a[140:143], a[20:23], v[180:183]
ds_read_b128 a[120:123], v6 offset:28672
v_mfma_f32_16x16x32_bf16 v[204:207], a[140:143], a[28:31], v[204:207]
v_mfma_f32_16x16x32_bf16 v[204:207], a[136:139], a[24:27], v[204:207]
v_mfma_f32_16x16x32_bf16 v[208:211], a[144:147], a[24:27], v[208:211]
buffer_load_dwordx4 a[88:91], v2, s[40:43], s35 offen offset:3072 sc1
v_mfma_f32_16x16x32_bf16 v[208:211], a[148:151], a[28:31], v[208:211]
v_mfma_f32_16x16x32_bf16 v[184:187], a[148:151], a[20:23], v[184:187]
v_mfma_f32_16x16x32_bf16 v[184:187], a[144:147], a[16:19], v[184:187]
v_mfma_f32_16x16x32_bf16 v[160:163], a[144:147], a[8:11], v[160:163]
v_mfma_f32_16x16x32_bf16 v[160:163], a[148:151], a[12:15], v[160:163]
buffer_load_dwordx4 a[92:95], v2, s[40:43], s33 offen offset:3072 sc1
s_add_u32 s35, s35, 8192
v_mfma_f32_16x16x32_bf16 v[136:139], a[148:151], a[4:7], v[136:139]
s_add_u32 s33, s33, 8192
v_mfma_f32_16x16x32_bf16 v[136:139], a[144:147], a[0:3], v[136:139]
v_mfma_f32_16x16x32_bf16 a[176:179], a[152:155], a[160:163], a[176:179]
s_waitcnt vmcnt(11) lgkmcnt(0)
v_mfma_f32_16x16x32_bf16 v[140:143], a[96:99], a[32:35], v[140:143]
ds_read_b128 a[128:131], v5 offset:41984
v_mfma_f32_16x16x32_bf16 v[140:143], a[100:103], a[36:39], v[140:143]
buffer_load_dwordx4 a[0:3], v2, s[40:43], s35 offen offset:0 sc1
v_mfma_f32_16x16x32_bf16 v[164:167], a[100:103], a[44:47], v[164:167]
ds_read_b128 a[132:135], v5 offset:48128
v_mfma_f32_16x16x32_bf16 v[164:167], a[96:99], a[40:43], v[164:167]
v_mfma_f32_16x16x32_bf16 v[188:191], a[96:99], a[48:51], v[188:191]
ds_read_b128 a[136:139], v5 offset:36864
v_mfma_f32_16x16x32_bf16 v[188:191], a[100:103], a[52:55], v[188:191]
buffer_load_dwordx4 v1, s[4:7], s44 offen offset:2048 sc1 lds
s_add_u32 m0, s18, 0x3000
v_mfma_f32_16x16x32_bf16 v[212:215], a[100:103], a[60:63], v[212:215]
s_add_u32 s44, s50, 0xe27000
ds_read_b128 a[140:143], v5 offset:43008
v_mfma_f32_16x16x32_bf16 v[212:215], a[96:99], a[56:59], v[212:215]
v_mfma_f32_16x16x32_bf16 v[216:219], a[104:107], a[56:59], v[216:219]
v_mfma_f32_16x16x32_bf16 v[216:219], a[108:111], a[60:63], v[216:219]
buffer_load_dwordx4 a[4:7], v2, s[40:43], s33 offen offset:0 sc1
v_mfma_f32_16x16x32_bf16 v[192:195], a[108:111], a[52:55], v[192:195]
ds_read_b128 a[144:147], v5 offset:37888
v_mfma_f32_16x16x32_bf16 v[192:195], a[104:107], a[48:51], v[192:195]
ds_read_b128 a[148:151], v5 offset:44032
v_mfma_f32_16x16x32_bf16 v[168:171], a[104:107], a[40:43], v[168:171]
v_mfma_f32_16x16x32_bf16 v[168:171], a[108:111], a[44:47], v[168:171]
buffer_load_dwordx4 a[8:11], v2, s[40:43], s35 offen offset:1024 sc1
v_mfma_f32_16x16x32_bf16 v[144:147], a[108:111], a[36:39], v[144:147]
ds_read_b128 a[152:155], v6 offset:29696
v_mfma_f32_16x16x32_bf16 v[144:147], a[104:107], a[32:35], v[144:147]
v_mfma_f32_16x16x32_bf16 v[148:151], a[112:115], a[32:35], v[148:151]
v_mfma_f32_16x16x32_bf16 v[148:151], a[116:119], a[36:39], v[148:151]
buffer_load_dwordx4 v1, s[4:7], s44 offen offset:0 sc1 lds
v_mfma_f32_16x16x32_bf16 v[172:175], a[116:119], a[44:47], v[172:175]
v_mfma_f32_16x16x32_bf16 v[172:175], a[112:115], a[40:43], v[172:175]
v_mfma_f32_16x16x32_bf16 v[196:199], a[112:115], a[48:51], v[196:199]
v_mfma_f32_16x16x32_bf16 v[196:199], a[116:119], a[52:55], v[196:199]
buffer_load_dwordx4 a[12:15], v2, s[40:43], s33 offen offset:1024 sc1
v_mfma_f32_16x16x32_bf16 v[220:223], a[116:119], a[60:63], v[220:223]
v_mfma_f32_16x16x32_bf16 v[220:223], a[112:115], a[56:59], v[220:223]
v_mfma_f32_16x16x32_bf16 a[180:183], a[120:123], a[160:163], a[180:183]
s_waitcnt lgkmcnt(0)
s_barrier
v_mfma_f32_16x16x32_bf16 v[224:227], a[128:131], a[56:59], v[224:227]
v_add_u32 v5, 98304, v1
v_add_u32 v6, s55, v5
v_mfma_f32_16x16x32_bf16 v[224:227], a[132:135], a[60:63], v[224:227]
buffer_load_dwordx4 a[16:19], v2, s[40:43], s35 offen offset:2048 sc1
v_mfma_f32_16x16x32_bf16 v[200:203], a[132:135], a[52:55], v[200:203]
ds_read_b128 a[96:99], v5 offset:2048
v_mfma_f32_16x16x32_bf16 v[200:203], a[128:131], a[48:51], v[200:203]
ds_read_b128 a[100:103], v5 offset:8192
v_mfma_f32_16x16x32_bf16 v[176:179], a[128:131], a[40:43], v[176:179]
ds_read_b128 a[104:107], v5 offset:3072
v_mfma_f32_16x16x32_bf16 v[176:179], a[132:135], a[44:47], v[176:179]
v_mfma_f32_16x16x32_bf16 v[152:155], a[132:135], a[36:39], v[152:155]
buffer_load_dwordx4 a[20:23], v2, s[40:43], s33 offen offset:2048 sc1
v_mfma_f32_16x16x32_bf16 v[152:155], a[128:131], a[32:35], v[152:155]
ds_read_b128 a[108:111], v5 offset:9216
v_mfma_f32_16x16x32_bf16 v[132:135], a[136:139], a[32:35], v[132:135]
v_mfma_f32_16x16x32_bf16 v[132:135], a[140:143], a[36:39], v[132:135]
ds_read_b128 a[112:115], v5 offset:4096
v_mfma_f32_16x16x32_bf16 v[156:159], a[140:143], a[44:47], v[156:159]
v_mfma_f32_16x16x32_bf16 v[156:159], a[136:139], a[40:43], v[156:159]
buffer_load_dwordx4 v1, s[4:7], s44 offen offset:1024 sc1 lds
v_mfma_f32_16x16x32_bf16 v[180:183], a[136:139], a[48:51], v[180:183]
ds_read_b128 a[116:119], v5 offset:10240
v_mfma_f32_16x16x32_bf16 v[180:183], a[140:143], a[52:55], v[180:183]
ds_read_b128 a[120:123], v6 offset:2048
v_mfma_f32_16x16x32_bf16 v[204:207], a[140:143], a[60:63], v[204:207]
v_mfma_f32_16x16x32_bf16 v[204:207], a[136:139], a[56:59], v[204:207]
v_mfma_f32_16x16x32_bf16 v[208:211], a[144:147], a[56:59], v[208:211]
buffer_load_dwordx4 a[24:27], v2, s[40:43], s35 offen offset:3072 sc1
v_mfma_f32_16x16x32_bf16 v[208:211], a[148:151], a[60:63], v[208:211]
v_mfma_f32_16x16x32_bf16 v[184:187], a[148:151], a[52:55], v[184:187]
v_mfma_f32_16x16x32_bf16 v[184:187], a[144:147], a[48:51], v[184:187]
v_mfma_f32_16x16x32_bf16 v[160:163], a[144:147], a[40:43], v[160:163]
v_mfma_f32_16x16x32_bf16 v[160:163], a[148:151], a[44:47], v[160:163]
buffer_load_dwordx4 a[28:31], v2, s[40:43], s33 offen offset:3072 sc1
s_add_u32 s35, s35, 8192
v_mfma_f32_16x16x32_bf16 v[136:139], a[148:151], a[36:39], v[136:139]
s_add_u32 s33, s33, 8192
v_mfma_f32_16x16x32_bf16 v[136:139], a[144:147], a[32:35], v[136:139]
v_mfma_f32_16x16x32_bf16 a[184:187], a[152:155], a[160:163], a[184:187]
s_waitcnt vmcnt(11) lgkmcnt(0)
v_mfma_f32_16x16x32_bf16 v[140:143], a[96:99], a[64:67], v[140:143]
ds_read_b128 a[128:131], v5 offset:5120
v_mfma_f32_16x16x32_bf16 v[140:143], a[100:103], a[68:71], v[140:143]
buffer_load_dwordx4 a[32:35], v2, s[40:43], s35 offen offset:0 sc1
v_mfma_f32_16x16x32_bf16 v[164:167], a[100:103], a[76:79], v[164:167]
ds_read_b128 a[132:135], v5 offset:11264
v_mfma_f32_16x16x32_bf16 v[164:167], a[96:99], a[72:75], v[164:167]
v_mfma_f32_16x16x32_bf16 v[188:191], a[96:99], a[80:83], v[188:191]
ds_read_b128 a[136:139], v5 offset:0
v_mfma_f32_16x16x32_bf16 v[188:191], a[100:103], a[84:87], v[188:191]
buffer_load_dwordx4 v1, s[4:7], s44 offen offset:2048 sc1 lds
s_add_u32 s63, s28, 20
v_mfma_f32_16x16x32_bf16 v[212:215], a[100:103], a[92:95], v[212:215]
s_lshl_b32 s63, s63, 12
ds_read_b128 a[140:143], v5 offset:6144
v_mfma_f32_16x16x32_bf16 v[212:215], a[96:99], a[88:91], v[212:215]
v_mfma_f32_16x16x32_bf16 v[216:219], a[104:107], a[88:91], v[216:219]
v_mfma_f32_16x16x32_bf16 v[216:219], a[108:111], a[92:95], v[216:219]
buffer_load_dwordx4 a[36:39], v2, s[40:43], s33 offen offset:0 sc1
v_mfma_f32_16x16x32_bf16 v[192:195], a[108:111], a[84:87], v[192:195]
ds_read_b128 a[144:147], v5 offset:1024
v_mfma_f32_16x16x32_bf16 v[192:195], a[104:107], a[80:83], v[192:195]
ds_read_b128 a[148:151], v5 offset:7168
v_mfma_f32_16x16x32_bf16 v[168:171], a[104:107], a[72:75], v[168:171]
v_mfma_f32_16x16x32_bf16 v[168:171], a[108:111], a[76:79], v[168:171]
buffer_load_dwordx4 a[40:43], v2, s[40:43], s35 offen offset:1024 sc1
v_mfma_f32_16x16x32_bf16 v[144:147], a[108:111], a[68:71], v[144:147]
ds_read_b128 a[152:155], v6 offset:3072
v_mfma_f32_16x16x32_bf16 v[144:147], a[104:107], a[64:67], v[144:147]
v_mfma_f32_16x16x32_bf16 v[148:151], a[112:115], a[64:67], v[148:151]
v_mfma_f32_16x16x32_bf16 v[148:151], a[116:119], a[68:71], v[148:151]
buffer_load_dwordx4 a[168:171], v3, s[40:43], s63 offen sc1
s_add_u32 m0, s18, 0x6000
v_mfma_f32_16x16x32_bf16 v[172:175], a[116:119], a[76:79], v[172:175]
s_add_u32 s44, s50, 0xe2a000
v_mfma_f32_16x16x32_bf16 v[172:175], a[112:115], a[72:75], v[172:175]
v_mfma_f32_16x16x32_bf16 v[196:199], a[112:115], a[80:83], v[196:199]
v_mfma_f32_16x16x32_bf16 v[196:199], a[116:119], a[84:87], v[196:199]
buffer_load_dwordx4 a[44:47], v2, s[40:43], s33 offen offset:1024 sc1
v_mfma_f32_16x16x32_bf16 v[220:223], a[116:119], a[92:95], v[220:223]
v_mfma_f32_16x16x32_bf16 v[220:223], a[112:115], a[88:91], v[220:223]
v_mfma_f32_16x16x32_bf16 a[172:175], a[120:123], a[164:167], a[172:175]
s_waitcnt lgkmcnt(0)
v_mfma_f32_16x16x32_bf16 v[224:227], a[128:131], a[88:91], v[224:227]
ds_read_b128 a[96:99], v5 offset:14336
v_mfma_f32_16x16x32_bf16 v[224:227], a[132:135], a[92:95], v[224:227]
buffer_load_dwordx4 a[48:51], v2, s[40:43], s35 offen offset:2048 sc1
v_mfma_f32_16x16x32_bf16 v[200:203], a[132:135], a[84:87], v[200:203]
ds_read_b128 a[100:103], v5 offset:20480
v_mfma_f32_16x16x32_bf16 v[200:203], a[128:131], a[80:83], v[200:203]
v_mfma_f32_16x16x32_bf16 v[176:179], a[128:131], a[72:75], v[176:179]
ds_read_b128 a[104:107], v5 offset:15360
v_mfma_f32_16x16x32_bf16 v[176:179], a[132:135], a[76:79], v[176:179]
buffer_load_dwordx4 v1, s[4:7], s44 offen offset:0 sc1 lds
v_mfma_f32_16x16x32_bf16 v[152:155], a[132:135], a[68:71], v[152:155]
ds_read_b128 a[108:111], v5 offset:21504
v_mfma_f32_16x16x32_bf16 v[152:155], a[128:131], a[64:67], v[152:155]
v_mfma_f32_16x16x32_bf16 v[132:135], a[136:139], a[64:67], v[132:135]
v_mfma_f32_16x16x32_bf16 v[132:135], a[140:143], a[68:71], v[132:135]
buffer_load_dwordx4 a[52:55], v2, s[40:43], s33 offen offset:2048 sc1
v_mfma_f32_16x16x32_bf16 v[156:159], a[140:143], a[76:79], v[156:159]
ds_read_b128 a[112:115], v5 offset:16384
v_mfma_f32_16x16x32_bf16 v[156:159], a[136:139], a[72:75], v[156:159]
ds_read_b128 a[116:119], v5 offset:22528
v_mfma_f32_16x16x32_bf16 v[180:183], a[136:139], a[80:83], v[180:183]
v_mfma_f32_16x16x32_bf16 v[180:183], a[140:143], a[84:87], v[180:183]
buffer_load_dwordx4 a[56:59], v2, s[40:43], s35 offen offset:3072 sc1
v_mfma_f32_16x16x32_bf16 v[204:207], a[140:143], a[92:95], v[204:207]
ds_read_b128 a[120:123], v6 offset:4096
v_mfma_f32_16x16x32_bf16 v[204:207], a[136:139], a[88:91], v[204:207]
v_mfma_f32_16x16x32_bf16 v[208:211], a[144:147], a[88:91], v[208:211]
v_mfma_f32_16x16x32_bf16 v[208:211], a[148:151], a[92:95], v[208:211]
buffer_load_dwordx4 v1, s[4:7], s44 offen offset:1024 sc1 lds
v_mfma_f32_16x16x32_bf16 v[184:187], a[148:151], a[84:87], v[184:187]
v_mfma_f32_16x16x32_bf16 v[184:187], a[144:147], a[80:83], v[184:187]
v_mfma_f32_16x16x32_bf16 v[160:163], a[144:147], a[72:75], v[160:163]
v_mfma_f32_16x16x32_bf16 v[160:163], a[148:151], a[76:79], v[160:163]
buffer_load_dwordx4 a[60:63], v2, s[40:43], s33 offen offset:3072 sc1
s_add_u32 s35, s35, 8192
v_mfma_f32_16x16x32_bf16 v[136:139], a[148:151], a[68:71], v[136:139]
s_add_u32 s33, s33, 8192
v_mfma_f32_16x16x32_bf16 v[136:139], a[144:147], a[64:67], v[136:139]
v_mfma_f32_16x16x32_bf16 a[176:179], a[152:155], a[164:167], a[176:179]
s_waitcnt vmcnt(12) lgkmcnt(0)
v_mfma_f32_16x16x32_bf16 v[140:143], a[96:99], a[0:3], v[140:143]
ds_read_b128 a[128:131], v5 offset:17408
v_mfma_f32_16x16x32_bf16 v[140:143], a[100:103], a[4:7], v[140:143]
buffer_load_dwordx4 a[64:67], v2, s[40:43], s35 offen offset:0 sc1
v_mfma_f32_16x16x32_bf16 v[164:167], a[100:103], a[12:15], v[164:167]
ds_read_b128 a[132:135], v5 offset:23552
v_mfma_f32_16x16x32_bf16 v[164:167], a[96:99], a[8:11], v[164:167]
v_mfma_f32_16x16x32_bf16 v[188:191], a[96:99], a[16:19], v[188:191]
ds_read_b128 a[136:139], v5 offset:12288
v_mfma_f32_16x16x32_bf16 v[188:191], a[100:103], a[20:23], v[188:191]
v_mfma_f32_16x16x32_bf16 v[212:215], a[100:103], a[28:31], v[212:215]
buffer_load_dwordx4 a[68:71], v2, s[40:43], s33 offen offset:0 sc1
v_mfma_f32_16x16x32_bf16 v[212:215], a[96:99], a[24:27], v[212:215]
ds_read_b128 a[140:143], v5 offset:18432
v_mfma_f32_16x16x32_bf16 v[216:219], a[104:107], a[24:27], v[216:219]
v_mfma_f32_16x16x32_bf16 v[216:219], a[108:111], a[28:31], v[216:219]
ds_read_b128 a[144:147], v5 offset:13312
v_mfma_f32_16x16x32_bf16 v[192:195], a[108:111], a[20:23], v[192:195]
v_mfma_f32_16x16x32_bf16 v[192:195], a[104:107], a[16:19], v[192:195]
buffer_load_dwordx4 v1, s[4:7], s44 offen offset:2048 sc1 lds
s_add_u32 m0, s18, 0x9000
v_mfma_f32_16x16x32_bf16 v[168:171], a[104:107], a[8:11], v[168:171]
s_add_u32 s44, s50, 0xe2d000
ds_read_b128 a[148:151], v5 offset:19456
v_mfma_f32_16x16x32_bf16 v[168:171], a[108:111], a[12:15], v[168:171]
ds_read_b128 a[152:155], v6 offset:5120
v_mfma_f32_16x16x32_bf16 v[144:147], a[108:111], a[4:7], v[144:147]
v_mfma_f32_16x16x32_bf16 v[144:147], a[104:107], a[0:3], v[144:147]
v_mfma_f32_16x16x32_bf16 v[148:151], a[112:115], a[0:3], v[148:151]
buffer_load_dwordx4 a[72:75], v2, s[40:43], s35 offen offset:1024 sc1
v_mfma_f32_16x16x32_bf16 v[148:151], a[116:119], a[4:7], v[148:151]
v_mfma_f32_16x16x32_bf16 v[172:175], a[116:119], a[12:15], v[172:175]
v_mfma_f32_16x16x32_bf16 v[172:175], a[112:115], a[8:11], v[172:175]
v_mfma_f32_16x16x32_bf16 v[196:199], a[112:115], a[16:19], v[196:199]
v_mfma_f32_16x16x32_bf16 v[196:199], a[116:119], a[20:23], v[196:199]
buffer_load_dwordx4 a[76:79], v2, s[40:43], s33 offen offset:1024 sc1
v_mfma_f32_16x16x32_bf16 v[220:223], a[116:119], a[28:31], v[220:223]
v_mfma_f32_16x16x32_bf16 v[220:223], a[112:115], a[24:27], v[220:223]
v_mfma_f32_16x16x32_bf16 a[180:183], a[120:123], a[164:167], a[180:183]
s_waitcnt lgkmcnt(0)
s_barrier
v_mfma_f32_16x16x32_bf16 v[224:227], a[128:131], a[24:27], v[224:227]
ds_read_b128 a[96:99], v5 offset:26624
v_mfma_f32_16x16x32_bf16 v[224:227], a[132:135], a[28:31], v[224:227]
buffer_load_dwordx4 a[80:83], v2, s[40:43], s35 offen offset:2048 sc1
v_mfma_f32_16x16x32_bf16 v[200:203], a[132:135], a[20:23], v[200:203]
ds_read_b128 a[100:103], v5 offset:32768
v_mfma_f32_16x16x32_bf16 v[200:203], a[128:131], a[16:19], v[200:203]
v_mfma_f32_16x16x32_bf16 v[176:179], a[128:131], a[8:11], v[176:179]
ds_read_b128 a[104:107], v5 offset:27648
v_mfma_f32_16x16x32_bf16 v[176:179], a[132:135], a[12:15], v[176:179]
buffer_load_dwordx4 v1, s[4:7], s44 offen offset:0 sc1 lds
v_mfma_f32_16x16x32_bf16 v[152:155], a[132:135], a[4:7], v[152:155]
ds_read_b128 a[108:111], v5 offset:33792
v_mfma_f32_16x16x32_bf16 v[152:155], a[128:131], a[0:3], v[152:155]
v_mfma_f32_16x16x32_bf16 v[132:135], a[136:139], a[0:3], v[132:135]
v_mfma_f32_16x16x32_bf16 v[132:135], a[140:143], a[4:7], v[132:135]
buffer_load_dwordx4 a[84:87], v2, s[40:43], s33 offen offset:2048 sc1
v_mfma_f32_16x16x32_bf16 v[156:159], a[140:143], a[12:15], v[156:159]
ds_read_b128 a[112:115], v5 offset:28672
v_mfma_f32_16x16x32_bf16 v[156:159], a[136:139], a[8:11], v[156:159]
ds_read_b128 a[116:119], v5 offset:34816
v_mfma_f32_16x16x32_bf16 v[180:183], a[136:139], a[16:19], v[180:183]
v_mfma_f32_16x16x32_bf16 v[180:183], a[140:143], a[20:23], v[180:183]
buffer_load_dwordx4 a[88:91], v2, s[40:43], s35 offen offset:3072 sc1
v_mfma_f32_16x16x32_bf16 v[204:207], a[140:143], a[28:31], v[204:207]
ds_read_b128 a[120:123], v6 offset:26624
v_mfma_f32_16x16x32_bf16 v[204:207], a[136:139], a[24:27], v[204:207]
v_mfma_f32_16x16x32_bf16 v[208:211], a[144:147], a[24:27], v[208:211]
v_mfma_f32_16x16x32_bf16 v[208:211], a[148:151], a[28:31], v[208:211]
buffer_load_dwordx4 v1, s[4:7], s44 offen offset:1024 sc1 lds
s_add_u32 s63, s28, 24
v_mfma_f32_16x16x32_bf16 v[184:187], a[148:151], a[20:23], v[184:187]
s_lshl_b32 s63, s63, 12
v_mfma_f32_16x16x32_bf16 v[184:187], a[144:147], a[16:19], v[184:187]
v_mfma_f32_16x16x32_bf16 v[160:163], a[144:147], a[8:11], v[160:163]
v_mfma_f32_16x16x32_bf16 v[160:163], a[148:151], a[12:15], v[160:163]
buffer_load_dwordx4 a[92:95], v2, s[40:43], s33 offen offset:3072 sc1
s_add_u32 s35, s35, 8192
v_mfma_f32_16x16x32_bf16 v[136:139], a[148:151], a[4:7], v[136:139]
s_add_u32 s33, s33, 8192
v_mfma_f32_16x16x32_bf16 v[136:139], a[144:147], a[0:3], v[136:139]
v_mfma_f32_16x16x32_bf16 a[184:187], a[152:155], a[164:167], a[184:187]
s_waitcnt vmcnt(11) lgkmcnt(0)
v_mfma_f32_16x16x32_bf16 v[140:143], a[96:99], a[32:35], v[140:143]
ds_read_b128 a[128:131], v5 offset:29696
v_mfma_f32_16x16x32_bf16 v[140:143], a[100:103], a[36:39], v[140:143]
buffer_load_dwordx4 a[0:3], v2, s[40:43], s35 offen offset:0 sc1
v_mfma_f32_16x16x32_bf16 v[164:167], a[100:103], a[44:47], v[164:167]
ds_read_b128 a[132:135], v5 offset:35840
v_mfma_f32_16x16x32_bf16 v[164:167], a[96:99], a[40:43], v[164:167]
v_mfma_f32_16x16x32_bf16 v[188:191], a[96:99], a[48:51], v[188:191]
ds_read_b128 a[136:139], v5 offset:24576
v_mfma_f32_16x16x32_bf16 v[188:191], a[100:103], a[52:55], v[188:191]
v_mfma_f32_16x16x32_bf16 v[212:215], a[100:103], a[60:63], v[212:215]
buffer_load_dwordx4 a[4:7], v2, s[40:43], s33 offen offset:0 sc1
v_mfma_f32_16x16x32_bf16 v[212:215], a[96:99], a[56:59], v[212:215]
ds_read_b128 a[140:143], v5 offset:30720
v_mfma_f32_16x16x32_bf16 v[216:219], a[104:107], a[56:59], v[216:219]
v_mfma_f32_16x16x32_bf16 v[216:219], a[108:111], a[60:63], v[216:219]
ds_read_b128 a[144:147], v5 offset:25600
v_mfma_f32_16x16x32_bf16 v[192:195], a[108:111], a[52:55], v[192:195]
v_mfma_f32_16x16x32_bf16 v[192:195], a[104:107], a[48:51], v[192:195]
buffer_load_dwordx4 a[160:163], v3, s[40:43], s63 offen sc1
v_mfma_f32_16x16x32_bf16 v[168:171], a[104:107], a[40:43], v[168:171]
ds_read_b128 a[148:151], v5 offset:31744
v_mfma_f32_16x16x32_bf16 v[168:171], a[108:111], a[44:47], v[168:171]
ds_read_b128 a[152:155], v6 offset:27648
v_mfma_f32_16x16x32_bf16 v[144:147], a[108:111], a[36:39], v[144:147]
v_mfma_f32_16x16x32_bf16 v[144:147], a[104:107], a[32:35], v[144:147]
v_mfma_f32_16x16x32_bf16 v[148:151], a[112:115], a[32:35], v[148:151]
buffer_load_dwordx4 a[8:11], v2, s[40:43], s35 offen offset:1024 sc1
v_mfma_f32_16x16x32_bf16 v[148:151], a[116:119], a[36:39], v[148:151]
v_mfma_f32_16x16x32_bf16 v[172:175], a[116:119], a[44:47], v[172:175]
v_mfma_f32_16x16x32_bf16 v[172:175], a[112:115], a[40:43], v[172:175]
v_mfma_f32_16x16x32_bf16 v[196:199], a[112:115], a[48:51], v[196:199]
v_mfma_f32_16x16x32_bf16 v[196:199], a[116:119], a[52:55], v[196:199]
buffer_load_dwordx4 a[12:15], v2, s[40:43], s33 offen offset:1024 sc1
v_mfma_f32_16x16x32_bf16 v[220:223], a[116:119], a[60:63], v[220:223]
v_mfma_f32_16x16x32_bf16 v[220:223], a[112:115], a[56:59], v[220:223]
v_mfma_f32_16x16x32_bf16 a[172:175], a[120:123], a[168:171], a[172:175]
s_waitcnt lgkmcnt(0)
v_mfma_f32_16x16x32_bf16 v[224:227], a[128:131], a[56:59], v[224:227]
ds_read_b128 a[96:99], v5 offset:38912
v_mfma_f32_16x16x32_bf16 v[224:227], a[132:135], a[60:63], v[224:227]
buffer_load_dwordx4 a[16:19], v2, s[40:43], s35 offen offset:2048 sc1
v_mfma_f32_16x16x32_bf16 v[200:203], a[132:135], a[52:55], v[200:203]
ds_read_b128 a[100:103], v5 offset:45056
v_mfma_f32_16x16x32_bf16 v[200:203], a[128:131], a[48:51], v[200:203]
v_mfma_f32_16x16x32_bf16 v[176:179], a[128:131], a[40:43], v[176:179]
ds_read_b128 a[104:107], v5 offset:39936
v_mfma_f32_16x16x32_bf16 v[176:179], a[132:135], a[44:47], v[176:179]
buffer_load_dwordx4 v1, s[4:7], s44 offen offset:2048 sc1 lds
s_add_u32 s63, s28, 28
v_mfma_f32_16x16x32_bf16 v[152:155], a[132:135], a[36:39], v[152:155]
s_lshl_b32 s63, s63, 12
ds_read_b128 a[108:111], v5 offset:46080
v_mfma_f32_16x16x32_bf16 v[152:155], a[128:131], a[32:35], v[152:155]
v_mfma_f32_16x16x32_bf16 v[132:135], a[136:139], a[32:35], v[132:135]
v_mfma_f32_16x16x32_bf16 v[132:135], a[140:143], a[36:39], v[132:135]
buffer_load_dwordx4 a[20:23], v2, s[40:43], s33 offen offset:2048 sc1
v_mfma_f32_16x16x32_bf16 v[156:159], a[140:143], a[44:47], v[156:159]
ds_read_b128 a[112:115], v5 offset:40960
v_mfma_f32_16x16x32_bf16 v[156:159], a[136:139], a[40:43], v[156:159]
ds_read_b128 a[116:119], v5 offset:47104
v_mfma_f32_16x16x32_bf16 v[180:183], a[136:139], a[48:51], v[180:183]
v_mfma_f32_16x16x32_bf16 v[180:183], a[140:143], a[52:55], v[180:183]
buffer_load_dwordx4 a[24:27], v2, s[40:43], s35 offen offset:3072 sc1
v_mfma_f32_16x16x32_bf16 v[204:207], a[140:143], a[60:63], v[204:207]
ds_read_b128 a[120:123], v6 offset:28672
v_mfma_f32_16x16x32_bf16 v[204:207], a[136:139], a[56:59], v[204:207]
v_mfma_f32_16x16x32_bf16 v[208:211], a[144:147], a[56:59], v[208:211]
v_mfma_f32_16x16x32_bf16 v[208:211], a[148:151], a[60:63], v[208:211]
buffer_load_dwordx4 a[164:167], v3, s[40:43], s63 offen sc1
s_add_u32 m0, s19, 49152
v_mfma_f32_16x16x32_bf16 v[184:187], a[148:151], a[52:55], v[184:187]
s_add_u32 s44, s85, 0xa04000
v_mfma_f32_16x16x32_bf16 v[184:187], a[144:147], a[48:51], v[184:187]
v_mfma_f32_16x16x32_bf16 v[160:163], a[144:147], a[40:43], v[160:163]
v_mfma_f32_16x16x32_bf16 v[160:163], a[148:151], a[44:47], v[160:163]
buffer_load_dwordx4 a[28:31], v2, s[40:43], s33 offen offset:3072 sc1
s_add_u32 s35, s35, 8192
v_mfma_f32_16x16x32_bf16 v[136:139], a[148:151], a[36:39], v[136:139]
s_add_u32 s33, s33, 8192
v_mfma_f32_16x16x32_bf16 v[136:139], a[144:147], a[32:35], v[136:139]
v_mfma_f32_16x16x32_bf16 a[176:179], a[152:155], a[168:171], a[176:179]
s_waitcnt vmcnt(11) lgkmcnt(0)
v_mfma_f32_16x16x32_bf16 v[140:143], a[96:99], a[64:67], v[140:143]
ds_read_b128 a[128:131], v5 offset:41984
v_add_f32 v92, v92, v96
v_mfma_f32_16x16x32_bf16 v[140:143], a[100:103], a[68:71], v[140:143]
buffer_load_dwordx4 a[32:35], v2, s[40:43], s35 offen offset:0 sc1
v_mfma_f32_16x16x32_bf16 v[164:167], a[100:103], a[76:79], v[164:167]
ds_read_b128 a[132:135], v5 offset:48128
v_add_f32 v100, v100, v104
v_mfma_f32_16x16x32_bf16 v[164:167], a[96:99], a[72:75], v[164:167]
v_add_f32 v108, v108, v112
v_add_f32 v116, v116, v120
v_mfma_f32_16x16x32_bf16 v[188:191], a[96:99], a[80:83], v[188:191]
ds_read_b128 a[136:139], v5 offset:36864
v_add_f32 v124, v124, v128
v_mfma_f32_16x16x32_bf16 v[188:191], a[100:103], a[84:87], v[188:191]
v_add_f32 v93, v93, v97
v_add_f32 v101, v101, v105
v_mfma_f32_16x16x32_bf16 v[212:215], a[100:103], a[92:95], v[212:215]
buffer_load_dwordx4 a[36:39], v2, s[40:43], s33 offen offset:0 sc1
v_mfma_f32_16x16x32_bf16 v[212:215], a[96:99], a[88:91], v[212:215]
ds_read_b128 a[140:143], v5 offset:43008
v_add_f32 v109, v109, v113
v_mfma_f32_16x16x32_bf16 v[216:219], a[104:107], a[88:91], v[216:219]
v_add_f32 v117, v117, v121
v_add_f32 v125, v125, v129
v_mfma_f32_16x16x32_bf16 v[216:219], a[108:111], a[92:95], v[216:219]
ds_read_b128 a[144:147], v5 offset:37888
v_add_f32 v94, v94, v98
v_mfma_f32_16x16x32_bf16 v[192:195], a[108:111], a[84:87], v[192:195]
v_add_f32 v102, v102, v106
v_add_f32 v110, v110, v114
v_mfma_f32_16x16x32_bf16 v[192:195], a[104:107], a[80:83], v[192:195]
buffer_load_dwordx4 v1, s[4:7], s44 offen offset:0 sc1 lds
v_mfma_f32_16x16x32_bf16 v[168:171], a[104:107], a[72:75], v[168:171]
ds_read_b128 a[148:151], v5 offset:44032
v_add_f32 v118, v118, v122
v_mfma_f32_16x16x32_bf16 v[168:171], a[108:111], a[76:79], v[168:171]
ds_read_b128 a[152:155], v6 offset:29696
v_add_f32 v126, v126, v130
v_mfma_f32_16x16x32_bf16 v[144:147], a[108:111], a[68:71], v[144:147]
v_add_f32 v95, v95, v99
v_add_f32 v103, v103, v107
v_mfma_f32_16x16x32_bf16 v[144:147], a[104:107], a[64:67], v[144:147]
v_add_f32 v111, v111, v115
v_add_f32 v119, v119, v123
v_mfma_f32_16x16x32_bf16 v[148:151], a[112:115], a[64:67], v[148:151]
buffer_load_dwordx4 a[40:43], v2, s[40:43], s35 offen offset:1024 sc1
v_mfma_f32_16x16x32_bf16 v[148:151], a[116:119], a[68:71], v[148:151]
v_add_f32 v127, v127, v131
v_add_f32_dpp v92, v92, v92 row_ror:8 row_mask:0xf bank_mask:0xf
v_mfma_f32_16x16x32_bf16 v[172:175], a[116:119], a[76:79], v[172:175]
v_add_f32_dpp v100, v100, v100 row_ror:8 row_mask:0xf bank_mask:0xf
v_add_f32_dpp v108, v108, v108 row_ror:8 row_mask:0xf bank_mask:0xf
v_mfma_f32_16x16x32_bf16 v[172:175], a[112:115], a[72:75], v[172:175]
v_add_f32_dpp v116, v116, v116 row_ror:8 row_mask:0xf bank_mask:0xf
v_add_f32_dpp v124, v124, v124 row_ror:8 row_mask:0xf bank_mask:0xf
v_mfma_f32_16x16x32_bf16 v[196:199], a[112:115], a[80:83], v[196:199]
v_add_f32_dpp v93, v93, v93 row_ror:8 row_mask:0xf bank_mask:0xf
v_mfma_f32_16x16x32_bf16 v[196:199], a[116:119], a[84:87], v[196:199]
buffer_load_dwordx4 a[44:47], v2, s[40:43], s33 offen offset:1024 sc1
v_mfma_f32_16x16x32_bf16 v[220:223], a[116:119], a[92:95], v[220:223]
v_add_f32_dpp v101, v101, v101 row_ror:8 row_mask:0xf bank_mask:0xf
v_add_f32_dpp v109, v109, v109 row_ror:8 row_mask:0xf bank_mask:0xf
v_mfma_f32_16x16x32_bf16 v[220:223], a[112:115], a[88:91], v[220:223]
v_add_f32_dpp v117, v117, v117 row_ror:8 row_mask:0xf bank_mask:0xf
v_add_f32_dpp v125, v125, v125 row_ror:8 row_mask:0xf bank_mask:0xf
v_mfma_f32_16x16x32_bf16 a[180:183], a[120:123], a[168:171], a[180:183]
s_waitcnt vmcnt(9) lgkmcnt(0)
s_barrier
v_mfma_f32_16x16x32_bf16 v[224:227], a[128:131], a[88:91], v[224:227]
v_add_u32 v5, 0, v1
v_add_u32 v6, s55, v5
v_mfma_f32_16x16x32_bf16 v[224:227], a[132:135], a[92:95], v[224:227]
buffer_load_dwordx4 a[48:51], v2, s[40:43], s35 offen offset:2048 sc1
v_mfma_f32_16x16x32_bf16 v[200:203], a[132:135], a[84:87], v[200:203]
ds_read_b128 a[96:99], v5 offset:2048
v_add_f32_dpp v92, v94, v94 row_ror:8 row_mask:0xf bank_mask:0xc
v_mfma_f32_16x16x32_bf16 v[200:203], a[128:131], a[80:83], v[200:203]
ds_read_b128 a[100:103], v5 offset:8192
v_add_f32_dpp v100, v102, v102 row_ror:8 row_mask:0xf bank_mask:0xc
v_mfma_f32_16x16x32_bf16 v[176:179], a[128:131], a[72:75], v[176:179]
ds_read_b128 a[104:107], v5 offset:3072
v_add_f32_dpp v108, v110, v110 row_ror:8 row_mask:0xf bank_mask:0xc
v_mfma_f32_16x16x32_bf16 v[176:179], a[132:135], a[76:79], v[176:179]
v_add_f32_dpp v116, v118, v118 row_ror:8 row_mask:0xf bank_mask:0xc
v_add_f32_dpp v124, v126, v126 row_ror:8 row_mask:0xf bank_mask:0xc
v_mfma_f32_16x16x32_bf16 v[152:155], a[132:135], a[68:71], v[152:155]
buffer_load_dwordx4 a[52:55], v2, s[40:43], s33 offen offset:2048 sc1
v_mfma_f32_16x16x32_bf16 v[152:155], a[128:131], a[64:67], v[152:155]
ds_read_b128 a[108:111], v5 offset:9216
v_add_f32_dpp v93, v95, v95 row_ror:8 row_mask:0xf bank_mask:0xc
v_mfma_f32_16x16x32_bf16 v[132:135], a[136:139], a[64:67], v[132:135]
ds_read_b128 a[112:115], v5 offset:4096
v_add_f32_dpp v101, v103, v103 row_ror:8 row_mask:0xf bank_mask:0xc
v_mfma_f32_16x16x32_bf16 v[132:135], a[140:143], a[68:71], v[132:135]
v_add_f32_dpp v109, v111, v111 row_ror:8 row_mask:0xf bank_mask:0xc
v_add_f32_dpp v117, v119, v119 row_ror:8 row_mask:0xf bank_mask:0xc
v_mfma_f32_16x16x32_bf16 v[156:159], a[140:143], a[76:79], v[156:159]
ds_read_b128 a[116:119], v5 offset:10240
v_add_f32_dpp v125, v127, v127 row_ror:8 row_mask:0xf bank_mask:0xc
v_mfma_f32_16x16x32_bf16 v[156:159], a[136:139], a[72:75], v[156:159]
buffer_load_dwordx4 v1, s[4:7], s44 offen offset:1024 sc1 lds
v_mfma_f32_16x16x32_bf16 v[180:183], a[136:139], a[80:83], v[180:183]
ds_read_b128 a[120:123], v6 offset:2048
v_mfma_f32_16x16x32_bf16 v[180:183], a[140:143], a[84:87], v[180:183]
v_permlane32_swap_b32 v92, v93
v_mfma_f32_16x16x32_bf16 v[204:207], a[140:143], a[92:95], v[204:207]
L_stub12:
s_cbranch_execz L_stub13
ds_read_b128 a[124:127], v6 offset:26624
v_mfma_f32_16x16x32_bf16 v[204:207], a[136:139], a[88:91], v[204:207]
v_permlane32_swap_b32 v100, v101
v_mfma_f32_16x16x32_bf16 v[208:211], a[144:147], a[88:91], v[208:211]
buffer_load_dwordx4 a[56:59], v2, s[40:43], s35 offen offset:3072 sc1
v_mfma_f32_16x16x32_bf16 v[208:211], a[148:151], a[92:95], v[208:211]
v_permlane32_swap_b32 v108, v109
v_mfma_f32_16x16x32_bf16 v[184:187], a[148:151], a[84:87], v[184:187]
v_permlane32_swap_b32 v116, v117
v_mfma_f32_16x16x32_bf16 v[184:187], a[144:147], a[80:83], v[184:187]
v_permlane32_swap_b32 v124, v125
v_mfma_f32_16x16x32_bf16 v[160:163], a[144:147], a[72:75], v[160:163]
v_add_f32 v92, v92, v93
v_add_f32 v100, v100, v101
v_mfma_f32_16x16x32_bf16 v[160:163], a[148:151], a[76:79], v[160:163]
buffer_load_dwordx4 a[60:63], v2, s[40:43], s33 offen offset:3072 sc1
s_add_u32 s35, s35, 8192
v_mfma_f32_16x16x32_bf16 v[136:139], a[148:151], a[68:71], v[136:139]
s_add_u32 s33, s33, 8192
v_add_f32 v108, v108, v109
v_mfma_f32_16x16x32_bf16 v[136:139], a[144:147], a[64:67], v[136:139]
v_add_f32 v116, v116, v117
v_add_f32 v124, v124, v125
v_mfma_f32_16x16x32_bf16 a[184:187], a[152:155], a[168:171], a[184:187]
v_mov_b32 v94, v92
s_waitcnt vmcnt(10) lgkmcnt(0)
v_mfma_f32_16x16x32_bf16 v[140:143], a[96:99], a[0:3], v[140:143]
ds_read_b128 a[128:131], v5 offset:5120
v_mov_b32 v102, v100
v_mfma_f32_16x16x32_bf16 v[140:143], a[100:103], a[4:7], v[140:143]
buffer_load_dwordx4 a[64:67], v2, s[40:43], s35 offen offset:0 sc1
v_mfma_f32_16x16x32_bf16 v[164:167], a[100:103], a[12:15], v[164:167]
ds_read_b128 a[132:135], v5 offset:11264
v_mov_b32 v110, v108
v_mfma_f32_16x16x32_bf16 v[164:167], a[96:99], a[8:11], v[164:167]
v_mov_b32 v118, v116
v_mov_b32 v126, v124
v_mfma_f32_16x16x32_bf16 v[188:191], a[96:99], a[16:19], v[188:191]
ds_read_b128 a[136:139], v5 offset:0
v_mfma_f32_16x16x32_bf16 v[188:191], a[100:103], a[20:23], v[188:191]
buffer_load_dwordx4 v1, s[4:7], s44 offen offset:2048 sc1 lds
v_mfma_f32_16x16x32_bf16 v[212:215], a[100:103], a[28:31], v[212:215]
ds_read_b128 a[140:143], v5 offset:6144
v_mfma_f32_16x16x32_bf16 v[212:215], a[96:99], a[24:27], v[212:215]
v_permlane16_swap_b32 v92, v94
v_mfma_f32_16x16x32_bf16 v[216:219], a[104:107], a[24:27], v[216:219]
ds_read_b128 a[144:147], v5 offset:1024
v_mfma_f32_16x16x32_bf16 v[216:219], a[108:111], a[28:31], v[216:219]
buffer_load_dwordx4 a[68:71], v2, s[40:43], s33 offen offset:0 sc1
v_mfma_f32_16x16x32_bf16 v[192:195], a[108:111], a[20:23], v[192:195]
ds_read_b128 a[148:151], v5 offset:7168
v_mfma_f32_16x16x32_bf16 v[192:195], a[104:107], a[16:19], v[192:195]
v_permlane16_swap_b32 v100, v102
v_mfma_f32_16x16x32_bf16 v[168:171], a[104:107], a[8:11], v[168:171]
ds_read_b128 a[152:155], v6 offset:3072
v_mfma_f32_16x16x32_bf16 v[168:171], a[108:111], a[12:15], v[168:171]
v_permlane16_swap_b32 v108, v110
v_mfma_f32_16x16x32_bf16 v[144:147], a[108:111], a[4:7], v[144:147]
buffer_load_dwordx4 a[72:75], v2, s[40:43], s35 offen offset:1024 sc1
v_mfma_f32_16x16x32_bf16 v[144:147], a[104:107], a[0:3], v[144:147]
ds_read_b128 a[156:159], v6 offset:27648
v_mfma_f32_16x16x32_bf16 v[148:151], a[112:115], a[0:3], v[148:151]
v_permlane16_swap_b32 v116, v118
v_mfma_f32_16x16x32_bf16 v[148:151], a[116:119], a[4:7], v[148:151]
v_permlane16_swap_b32 v124, v126
v_mfma_f32_16x16x32_bf16 v[172:175], a[116:119], a[12:15], v[172:175]
buffer_load_dwordx4 v1, s[4:7], s44 offen offset:3072 sc1 lds
s_add_u32 m0, s19, 65536
v_mfma_f32_16x16x32_bf16 v[172:175], a[112:115], a[8:11], v[172:175]
s_add_u32 s44, s84, 0xa08000
v_add_f32 v92, v92, v94
v_mfma_f32_16x16x32_bf16 v[196:199], a[112:115], a[16:19], v[196:199]
v_add_f32 v100, v100, v102
v_add_f32 v108, v108, v110
v_mfma_f32_16x16x32_bf16 v[196:199], a[116:119], a[20:23], v[196:199]
v_add_f32 v116, v116, v118
v_add_f32 v124, v124, v126
v_mfma_f32_16x16x32_bf16 v[220:223], a[116:119], a[28:31], v[220:223]
buffer_load_dwordx4 a[76:79], v2, s[40:43], s33 offen offset:1024 sc1
v_mfma_f32_16x16x32_bf16 v[220:223], a[112:115], a[24:27], v[220:223]
v_mov_b32 v94, v92
v_mov_b32 v102, v100
v_mfma_f32_16x16x32_bf16 a[172:175], a[120:123], a[160:163], a[172:175]
v_mov_b32 v110, v108
v_mov_b32 v118, v116
v_mfma_f32_16x16x32_bf16 a[172:175], a[124:127], a[164:167], a[172:175]
v_mov_b32 v126, v124
s_waitcnt lgkmcnt(0)
v_mfma_f32_16x16x32_bf16 v[224:227], a[128:131], a[24:27], v[224:227]
ds_read_b128 a[96:99], v5 offset:14336
v_mfma_f32_16x16x32_bf16 v[224:227], a[132:135], a[28:31], v[224:227]
buffer_load_dwordx4 a[80:83], v2, s[40:43], s35 offen offset:2048 sc1
v_mfma_f32_16x16x32_bf16 v[200:203], a[132:135], a[20:23], v[200:203]
ds_read_b128 a[100:103], v5 offset:20480
v_mfma_f32_16x16x32_bf16 v[200:203], a[128:131], a[16:19], v[200:203]
v_permlane32_swap_b32 v92, v94
v_mfma_f32_16x16x32_bf16 v[176:179], a[128:131], a[8:11], v[176:179]
ds_read_b128 a[104:107], v5 offset:15360
v_mfma_f32_16x16x32_bf16 v[176:179], a[132:135], a[12:15], v[176:179]
v_permlane32_swap_b32 v100, v102
v_mfma_f32_16x16x32_bf16 v[152:155], a[132:135], a[4:7], v[152:155]
buffer_load_dwordx4 a[84:87], v2, s[40:43], s33 offen offset:2048 sc1
v_mfma_f32_16x16x32_bf16 v[152:155], a[128:131], a[0:3], v[152:155]
ds_read_b128 a[108:111], v5 offset:21504
v_mfma_f32_16x16x32_bf16 v[132:135], a[136:139], a[0:3], v[132:135]
ds_read_b128 a[112:115], v5 offset:16384
v_mfma_f32_16x16x32_bf16 v[132:135], a[140:143], a[4:7], v[132:135]
v_permlane32_swap_b32 v108, v110
v_mfma_f32_16x16x32_bf16 v[156:159], a[140:143], a[12:15], v[156:159]
ds_read_b128 a[116:119], v5 offset:22528
v_mfma_f32_16x16x32_bf16 v[156:159], a[136:139], a[8:11], v[156:159]
buffer_load_dwordx4 v1, s[4:7], s44 offen offset:0 sc1 lds
v_mfma_f32_16x16x32_bf16 v[180:183], a[136:139], a[16:19], v[180:183]
ds_read_b128 a[120:123], v6 offset:4096
v_mfma_f32_16x16x32_bf16 v[180:183], a[140:143], a[20:23], v[180:183]
v_permlane32_swap_b32 v116, v118
v_mfma_f32_16x16x32_bf16 v[204:207], a[140:143], a[28:31], v[204:207]
ds_read_b128 a[124:127], v6 offset:28672
v_mfma_f32_16x16x32_bf16 v[204:207], a[136:139], a[24:27], v[204:207]
v_permlane32_swap_b32 v124, v126
v_mfma_f32_16x16x32_bf16 v[208:211], a[144:147], a[24:27], v[208:211]
buffer_load_dwordx4 a[88:91], v2, s[40:43], s35 offen offset:3072 sc1
v_mfma_f32_16x16x32_bf16 v[208:211], a[148:151], a[28:31], v[208:211]
v_mul_f32 v82, 0xba800000, v92
v_mul_f32 v84, 0xba800000, v100
v_mfma_f32_16x16x32_bf16 v[184:187], a[148:151], a[20:23], v[184:187]
v_mul_f32 v86, 0xba800000, v108
v_mul_f32 v88, 0xba800000, v116
v_mfma_f32_16x16x32_bf16 v[184:187], a[144:147], a[16:19], v[184:187]
v_mul_f32 v90, 0xba800000, v124
v_mul_f32 v94, 0x3a800000, v94
v_mfma_f32_16x16x32_bf16 v[160:163], a[144:147], a[8:11], v[160:163]
v_mul_f32 v102, 0x3a800000, v102
v_mul_f32 v110, 0x3a800000, v110
v_mfma_f32_16x16x32_bf16 v[160:163], a[148:151], a[12:15], v[160:163]
buffer_load_dwordx4 a[92:95], v2, s[40:43], s33 offen offset:3072 sc1
s_add_u32 s35, s35, 8192
v_mfma_f32_16x16x32_bf16 v[136:139], a[148:151], a[4:7], v[136:139]
s_add_u32 s33, s33, 8192
v_mul_f32 v118, 0x3a800000, v118
v_mfma_f32_16x16x32_bf16 v[136:139], a[144:147], a[0:3], v[136:139]
v_mul_f32 v126, 0x3a800000, v126
v_fma_f32 v94, -v82, v82, v94
v_mfma_f32_16x16x32_bf16 a[176:179], a[152:155], a[160:163], a[176:179]
v_fma_f32 v102, -v84, v84, v102
v_fma_f32 v110, -v86, v86, v110
v_mfma_f32_16x16x32_bf16 a[176:179], a[156:159], a[164:167], a[176:179]
v_fma_f32 v118, -v88, v88, v118
s_waitcnt vmcnt(11) lgkmcnt(0)
v_mfma_f32_16x16x32_bf16 v[140:143], a[96:99], a[32:35], v[140:143]
ds_read_b128 a[128:131], v5 offset:17408
v_fma_f32 v126, -v90, v90, v126
v_mfma_f32_16x16x32_bf16 v[140:143], a[100:103], a[36:39], v[140:143]
buffer_load_dwordx4 a[0:3], v2, s[40:43], s35 offen offset:0 sc1
v_mfma_f32_16x16x32_bf16 v[164:167], a[100:103], a[44:47], v[164:167]
ds_read_b128 a[132:135], v5 offset:23552
v_max_f32 v94, 0, v94
v_mfma_f32_16x16x32_bf16 v[164:167], a[96:99], a[40:43], v[164:167]
v_max_f32 v102, 0, v102
v_max_f32 v110, 0, v110
v_mfma_f32_16x16x32_bf16 v[188:191], a[96:99], a[48:51], v[188:191]
ds_read_b128 a[136:139], v5 offset:12288
v_max_f32 v118, 0, v118
v_mfma_f32_16x16x32_bf16 v[188:191], a[100:103], a[52:55], v[188:191]
buffer_load_dwordx4 v1, s[4:7], s44 offen offset:1024 sc1 lds
v_mfma_f32_16x16x32_bf16 v[212:215], a[100:103], a[60:63], v[212:215]
ds_read_b128 a[140:143], v5 offset:18432
v_max_f32 v126, 0, v126
v_mfma_f32_16x16x32_bf16 v[212:215], a[96:99], a[56:59], v[212:215]
v_add_f32 v94, 0x3727c5ac, v94
v_add_f32 v102, 0x3727c5ac, v102
v_add_f32 v110, 0x3727c5ac, v110
v_add_f32 v118, 0x3727c5ac, v118
v_add_f32 v126, 0x3727c5ac, v126
v_rsq_f32 v83, v94
v_rsq_f32 v85, v102
v_rsq_f32 v87, v110
v_rsq_f32 v89, v118
v_rsq_f32 v91, v126
v_mfma_f32_16x16x32_bf16 v[216:219], a[104:107], a[56:59], v[216:219]
ds_read_b128 a[144:147], v5 offset:13312
v_mfma_f32_16x16x32_bf16 v[216:219], a[108:111], a[60:63], v[216:219]
buffer_load_dwordx4 a[4:7], v2, s[40:43], s33 offen offset:0 sc1
v_mfma_f32_16x16x32_bf16 v[192:195], a[108:111], a[52:55], v[192:195]
ds_read_b128 a[148:151], v5 offset:19456
v_fmac_f32 v140, v56, v82
v_mfma_f32_16x16x32_bf16 v[192:195], a[104:107], a[48:51], v[192:195]
v_mfma_f32_16x16x32_bf16 v[168:171], a[104:107], a[40:43], v[168:171]
ds_read_b128 a[152:155], v6 offset:5120
v_fmac_f32 v164, v56, v84
v_mfma_f32_16x16x32_bf16 v[168:171], a[108:111], a[44:47], v[168:171]
v_mfma_f32_16x16x32_bf16 v[144:147], a[108:111], a[36:39], v[144:147]
buffer_load_dwordx4 a[8:11], v2, s[40:43], s35 offen offset:1024 sc1
v_mfma_f32_16x16x32_bf16 v[144:147], a[104:107], a[32:35], v[144:147]
ds_read_b128 a[156:159], v6 offset:29696
v_fmac_f32 v188, v56, v86
v_mfma_f32_16x16x32_bf16 v[148:151], a[112:115], a[32:35], v[148:151]
v_fmac_f32 v212, v56, v88
v_mfma_f32_16x16x32_bf16 v[148:151], a[116:119], a[36:39], v[148:151]
v_mfma_f32_16x16x32_bf16 v[172:175], a[116:119], a[44:47], v[172:175]
buffer_load_dwordx4 v1, s[4:7], s44 offen offset:2048 sc1 lds
v_mfma_f32_16x16x32_bf16 v[172:175], a[112:115], a[40:43], v[172:175]
v_fmac_f32 v216, v60, v88
v_mfma_f32_16x16x32_bf16 v[196:199], a[112:115], a[48:51], v[196:199]
v_fmac_f32 v192, v60, v86
v_mfma_f32_16x16x32_bf16 v[196:199], a[116:119], a[52:55], v[196:199]
v_mfma_f32_16x16x32_bf16 v[220:223], a[116:119], a[60:63], v[220:223]
buffer_load_dwordx4 a[12:15], v2, s[40:43], s33 offen offset:1024 sc1
v_mfma_f32_16x16x32_bf16 v[220:223], a[112:115], a[56:59], v[220:223]
v_fmac_f32 v168, v60, v84
v_fmac_f32 v141, v57, v82
v_mfma_f32_16x16x32_bf16 a[180:183], a[120:123], a[160:163], a[180:183]
v_fmac_f32 v144, v60, v82
v_fmac_f32 v165, v57, v84
v_mfma_f32_16x16x32_bf16 a[180:183], a[124:127], a[164:167], a[180:183]
s_waitcnt lgkmcnt(0)
v_mfma_f32_16x16x32_bf16 v[224:227], a[128:131], a[56:59], v[224:227]
ds_read_b128 a[96:99], v5 offset:26624
v_fmac_f32 v148, v64, v82
v_mfma_f32_16x16x32_bf16 v[224:227], a[132:135], a[60:63], v[224:227]
buffer_load_dwordx4 a[16:19], v2, s[40:43], s35 offen offset:2048 sc1
s_lshl_b32 s90, s28, 12
v_mfma_f32_16x16x32_bf16 v[200:203], a[132:135], a[52:55], v[200:203]
ds_read_b128 a[100:103], v5 offset:32768
v_fmac_f32 v172, v64, v84
v_mfma_f32_16x16x32_bf16 v[200:203], a[128:131], a[48:51], v[200:203]
v_fmac_f32 v189, v57, v86
v_fmac_f32 v213, v57, v88
v_mfma_f32_16x16x32_bf16 v[176:179], a[128:131], a[40:43], v[176:179]
v_fmac_f32 v196, v64, v86
v_fmac_f32 v217, v61, v88
v_mfma_f32_16x16x32_bf16 v[176:179], a[132:135], a[44:47], v[176:179]
ds_read_b128 a[104:107], v5 offset:27648
s_add_u32 s90, s90, 147456
v_mfma_f32_16x16x32_bf16 v[152:155], a[132:135], a[36:39], v[152:155]
buffer_load_dwordx4 a[20:23], v2, s[40:43], s33 offen offset:2048 sc1
v_mfma_f32_16x16x32_bf16 v[152:155], a[128:131], a[32:35], v[152:155]
v_fmac_f32 v220, v64, v88
v_fmac_f32 v193, v61, v86
v_mfma_f32_16x16x32_bf16 v[132:135], a[136:139], a[32:35], v[132:135]
ds_read_b128 a[108:111], v5 offset:33792
v_fmac_f32 v169, v61, v84
v_mfma_f32_16x16x32_bf16 v[132:135], a[140:143], a[36:39], v[132:135]
v_add_u32 v234, s90, v1
s_lshl_b32 s90, s28, 10
v_mfma_f32_16x16x32_bf16 v[156:159], a[140:143], a[44:47], v[156:159]
ds_read_b128 a[112:115], v5 offset:28672
v_fmac_f32 v224, v68, v88
v_mfma_f32_16x16x32_bf16 v[156:159], a[136:139], a[40:43], v[156:159]
buffer_load_dwordx4 v1, s[4:7], s44 offen offset:3072 sc1 lds
s_add_u32 m0, s19, 81920
v_mfma_f32_16x16x32_bf16 v[180:183], a[136:139], a[48:51], v[180:183]
s_add_u32 s44, s85, 0xa0c000
v_fmac_f32 v200, v68, v86
v_mfma_f32_16x16x32_bf16 v[180:183], a[140:143], a[52:55], v[180:183]
ds_read_b128 a[116:119], v5 offset:34816
v_fmac_f32 v145, v61, v82
v_mfma_f32_16x16x32_bf16 v[204:207], a[140:143], a[60:63], v[204:207]
v_fmac_f32 v176, v68, v84
v_fmac_f32 v149, v65, v82
v_mfma_f32_16x16x32_bf16 v[204:207], a[136:139], a[56:59], v[204:207]
v_fmac_f32 v173, v65, v84
s_add_u32 s90, s90, 147456
v_mfma_f32_16x16x32_bf16 v[208:211], a[144:147], a[56:59], v[208:211]
buffer_load_dwordx4 a[24:27], v2, s[40:43], s35 offen offset:3072 sc1
v_mfma_f32_16x16x32_bf16 v[208:211], a[148:151], a[60:63], v[208:211]
v_fmac_f32 v152, v68, v82
v_fmac_f32 v197, v65, v86
v_mfma_f32_16x16x32_bf16 v[184:187], a[148:151], a[52:55], v[184:187]
v_fmac_f32 v132, v48, v82
v_fmac_f32 v221, v65, v88
v_mfma_f32_16x16x32_bf16 v[184:187], a[144:147], a[48:51], v[184:187]
v_add_u32 v235, s90, v1
v_mfma_f32_16x16x32_bf16 v[160:163], a[144:147], a[40:43], v[160:163]
v_fmac_f32 v156, v48, v84
v_mfma_f32_16x16x32_bf16 v[160:163], a[148:151], a[44:47], v[160:163]
buffer_load_dwordx4 a[28:31], v2, s[40:43], s33 offen offset:3072 sc1
s_add_u32 s35, s35, 8192
v_mfma_f32_16x16x32_bf16 v[136:139], a[148:151], a[36:39], v[136:139]
s_add_u32 s33, s33, 8192
v_fmac_f32 v180, v48, v86
v_mfma_f32_16x16x32_bf16 v[136:139], a[144:147], a[32:35], v[136:139]
v_fmac_f32 v225, v69, v88
v_mfma_f32_16x16x32_bf16 a[184:187], a[152:155], a[160:163], a[184:187]
v_fmac_f32 v204, v48, v88
v_fmac_f32 v201, v69, v86
v_mfma_f32_16x16x32_bf16 a[184:187], a[156:159], a[164:167], a[184:187]
s_waitcnt vmcnt(11) lgkmcnt(0)
v_mfma_f32_16x16x32_bf16 v[140:143], a[96:99], a[64:67], v[140:143]
ds_read_b128 a[128:131], v5 offset:29696
v_fmac_f32 v208, v52, v88
v_mfma_f32_16x16x32_bf16 v[140:143], a[100:103], a[68:71], v[140:143]
buffer_load_dwordx4 v1, s[4:7], s44 offen offset:0 sc1 lds
v_mfma_f32_16x16x32_bf16 v[164:167], a[100:103], a[76:79], v[164:167]
ds_read_b128 a[132:135], v5 offset:35840
v_fmac_f32 v184, v52, v86
v_mfma_f32_16x16x32_bf16 v[164:167], a[96:99], a[72:75], v[164:167]
v_fmac_f32 v177, v69, v84
v_fmac_f32 v153, v69, v82
v_mfma_f32_16x16x32_bf16 v[188:191], a[96:99], a[80:83], v[188:191]
v_fmac_f32 v160, v52, v84
v_fmac_f32 v133, v49, v82
v_mfma_f32_16x16x32_bf16 v[188:191], a[100:103], a[84:87], v[188:191]
buffer_load_dwordx4 v1, s[4:7], s44 offen offset:1024 sc1 lds
v_mfma_f32_16x16x32_bf16 v[212:215], a[100:103], a[92:95], v[212:215]
ds_read_b128 a[136:139], v5 offset:24576
v_fmac_f32 v136, v52, v82
v_mfma_f32_16x16x32_bf16 v[212:215], a[96:99], a[88:91], v[212:215]
v_fmac_f32 v157, v49, v84
v_mfma_f32_16x16x32_bf16 v[216:219], a[104:107], a[88:91], v[216:219]
ds_read_b128 a[140:143], v5 offset:30720
v_fmac_f32 v181, v49, v86
v_mfma_f32_16x16x32_bf16 v[216:219], a[108:111], a[92:95], v[216:219]
v_mfma_f32_16x16x32_bf16 v[192:195], a[108:111], a[84:87], v[192:195]
buffer_load_dwordx4 v1, s[4:7], s44 offen offset:2048 sc1 lds
v_mfma_f32_16x16x32_bf16 v[192:195], a[104:107], a[80:83], v[192:195]
ds_read_b128 a[144:147], v5 offset:25600
v_fmac_f32 v205, v49, v88
v_mfma_f32_16x16x32_bf16 v[168:171], a[104:107], a[72:75], v[168:171]
v_fmac_f32 v209, v53, v88
v_fmac_f32 v142, v58, v82
v_mfma_f32_16x16x32_bf16 v[168:171], a[108:111], a[76:79], v[168:171]
ds_read_b128 a[148:151], v5 offset:31744
v_fmac_f32 v166, v58, v84
v_mfma_f32_16x16x32_bf16 v[144:147], a[108:111], a[68:71], v[144:147]
v_fmac_f32 v185, v53, v86
v_fmac_f32 v190, v58, v86
v_mfma_f32_16x16x32_bf16 v[144:147], a[104:107], a[64:67], v[144:147]
buffer_load_dwordx4 v1, s[4:7], s44 offen offset:3072 sc1 lds
s_add_u32 m0, s19, 98304
v_mfma_f32_16x16x32_bf16 v[148:151], a[112:115], a[64:67], v[148:151]
s_add_u32 s44, s84, 0xa10000
v_fmac_f32 v161, v53, v84
v_mfma_f32_16x16x32_bf16 v[148:151], a[116:119], a[68:71], v[148:151]
v_fmac_f32 v214, v58, v88
v_mfma_f32_16x16x32_bf16 v[172:175], a[116:119], a[76:79], v[172:175]
v_fmac_f32 v137, v53, v82
v_fmac_f32 v218, v62, v88
v_mfma_f32_16x16x32_bf16 v[172:175], a[112:115], a[72:75], v[172:175]
ds_write_b128 v234, a[172:175] offset:0
v_mfma_f32_16x16x32_bf16 v[196:199], a[112:115], a[80:83], v[196:199]
buffer_load_dwordx4 v1, s[4:7], s44 offen offset:0 sc1 lds
v_mfma_f32_16x16x32_bf16 v[196:199], a[116:119], a[84:87], v[196:199]
v_fmac_f32 v194, v62, v86
v_mfma_f32_16x16x32_bf16 v[220:223], a[116:119], a[92:95], v[220:223]
v_fmac_f32 v170, v62, v84
v_fmac_f32 v143, v59, v82
v_mfma_f32_16x16x32_bf16 v[220:223], a[112:115], a[88:91], v[220:223]
ds_write_b128 v234, a[176:179] offset:1024
s_waitcnt lgkmcnt(2)
v_mfma_f32_16x16x32_bf16 v[224:227], a[128:131], a[88:91], v[224:227]
ds_read_b128 a[96:99], v5 offset:38912
v_fmac_f32 v146, v62, v82
v_mfma_f32_16x16x32_bf16 v[224:227], a[132:135], a[92:95], v[224:227]
buffer_load_dwordx4 v1, s[4:7], s44 offen offset:1024 sc1 lds
v_mfma_f32_16x16x32_bf16 v[200:203], a[132:135], a[84:87], v[200:203]
ds_read_b128 a[100:103], v5 offset:45056
v_fmac_f32 v150, v66, v82
v_mfma_f32_16x16x32_bf16 v[200:203], a[128:131], a[80:83], v[200:203]
v_fmac_f32 v167, v59, v84
v_fmac_f32 v191, v59, v86
v_mfma_f32_16x16x32_bf16 v[176:179], a[128:131], a[72:75], v[176:179]
v_fmac_f32 v174, v66, v84
v_fmac_f32 v215, v59, v88
v_mfma_f32_16x16x32_bf16 v[176:179], a[132:135], a[76:79], v[176:179]
buffer_load_dwordx4 v1, s[4:7], s44 offen offset:2048 sc1 lds
v_mfma_f32_16x16x32_bf16 v[152:155], a[132:135], a[68:71], v[152:155]
ds_read_b128 a[104:107], v5 offset:39936
v_fmac_f32 v198, v66, v86
v_mfma_f32_16x16x32_bf16 v[152:155], a[128:131], a[64:67], v[152:155]
v_fmac_f32 v219, v63, v88
v_mfma_f32_16x16x32_bf16 v[132:135], a[136:139], a[64:67], v[132:135]
ds_read_b128 a[108:111], v5 offset:46080
v_fmac_f32 v222, v66, v88
v_mfma_f32_16x16x32_bf16 v[132:135], a[140:143], a[68:71], v[132:135]
v_fmac_f32 v195, v63, v86
v_mfma_f32_16x16x32_bf16 v[156:159], a[140:143], a[76:79], v[156:159]
buffer_load_dwordx4 v1, s[4:7], s44 offen offset:3072 sc1 lds
s_add_u32 m0, s19, 114688
v_mfma_f32_16x16x32_bf16 v[156:159], a[136:139], a[72:75], v[156:159]
s_add_u32 s44, s85, 0xa14000
ds_read_b128 a[112:115], v5 offset:40960
v_mfma_f32_16x16x32_bf16 v[180:183], a[136:139], a[80:83], v[180:183]
v_fmac_f32 v226, v70, v88
v_fmac_f32 v202, v70, v86
v_mfma_f32_16x16x32_bf16 v[180:183], a[140:143], a[84:87], v[180:183]
ds_read_b128 a[116:119], v5 offset:47104
v_fmac_f32 v171, v63, v84
v_mfma_f32_16x16x32_bf16 v[204:207], a[140:143], a[92:95], v[204:207]
v_fmac_f32 v178, v70, v84
v_fmac_f32 v147, v63, v82
v_mfma_f32_16x16x32_bf16 v[204:207], a[136:139], a[88:91], v[204:207]
buffer_load_dwordx4 v1, s[4:7], s44 offen offset:0 sc1 lds
v_mfma_f32_16x16x32_bf16 v[208:211], a[144:147], a[88:91], v[208:211]
v_fmac_f32 v154, v70, v82
v_fmac_f32 v151, v67, v82
v_mfma_f32_16x16x32_bf16 v[208:211], a[148:151], a[92:95], v[208:211]
v_fmac_f32 v175, v67, v84
v_mfma_f32_16x16x32_bf16 v[184:187], a[148:151], a[84:87], v[184:187]
v_fmac_f32 v134, v50, v82
v_fmac_f32 v199, v67, v86
v_mfma_f32_16x16x32_bf16 v[184:187], a[144:147], a[80:83], v[184:187]
ds_write_b128 v234, a[180:183] offset:2048
v_mfma_f32_16x16x32_bf16 v[160:163], a[144:147], a[72:75], v[160:163]
buffer_load_dwordx4 v1, s[4:7], s44 offen offset:1024 sc1 lds
v_mfma_f32_16x16x32_bf16 v[160:163], a[148:151], a[76:79], v[160:163]
v_fmac_f32 v158, v50, v84
v_fmac_f32 v223, v67, v88
v_mfma_f32_16x16x32_bf16 v[136:139], a[148:151], a[68:71], v[136:139]
v_fmac_f32 v182, v50, v86
v_fmac_f32 v227, v71, v88
v_mfma_f32_16x16x32_bf16 v[136:139], a[144:147], a[64:67], v[136:139]
ds_write_b128 v234, a[184:187] offset:3072
s_waitcnt vmcnt(10) lgkmcnt(2)
v_mfma_f32_16x16x32_bf16 v[140:143], a[96:99], a[0:3], v[140:143]
ds_read_b128 a[128:131], v5 offset:41984
v_fmac_f32 v206, v50, v88
v_mfma_f32_16x16x32_bf16 v[140:143], a[100:103], a[4:7], v[140:143]
buffer_load_dwordx4 v1, s[4:7], s44 offen offset:2048 sc1 lds
v_mfma_f32_16x16x32_bf16 v[164:167], a[100:103], a[12:15], v[164:167]
ds_read_b128 a[132:135], v5 offset:48128
v_fmac_f32 v210, v54, v88
v_mfma_f32_16x16x32_bf16 v[164:167], a[96:99], a[8:11], v[164:167]
v_fmac_f32 v203, v71, v86
v_fmac_f32 v179, v71, v84
v_mfma_f32_16x16x32_bf16 v[188:191], a[96:99], a[16:19], v[188:191]
v_fmac_f32 v186, v54, v86
v_fmac_f32 v155, v71, v82
v_mfma_f32_16x16x32_bf16 v[188:191], a[100:103], a[20:23], v[188:191]
buffer_load_dwordx4 v1, s[4:7], s44 offen offset:3072 sc1 lds
s_add_u32 m0, s19, 131072
v_mfma_f32_16x16x32_bf16 v[212:215], a[100:103], a[28:31], v[212:215]
s_add_u32 s44, s86, 0xa18000
ds_read_b128 a[136:139], v5 offset:36864
v_mfma_f32_16x16x32_bf16 v[212:215], a[96:99], a[24:27], v[212:215]
v_fmac_f32 v162, v54, v84
v_fmac_f32 v135, v51, v82
v_mfma_f32_16x16x32_bf16 v[216:219], a[104:107], a[24:27], v[216:219]
ds_read_b128 a[140:143], v5 offset:43008
v_fmac_f32 v138, v54, v82
v_mfma_f32_16x16x32_bf16 v[216:219], a[108:111], a[28:31], v[216:219]
v_fmac_f32 v159, v51, v84
v_mfma_f32_16x16x32_bf16 v[192:195], a[108:111], a[20:23], v[192:195]
buffer_load_dwordx4 v1, s[4:7], s44 offen offset:0 sc1 lds
v_mfma_f32_16x16x32_bf16 v[192:195], a[104:107], a[16:19], v[192:195]
ds_read_b128 a[144:147], v5 offset:37888
v_fmac_f32 v183, v51, v86
v_mfma_f32_16x16x32_bf16 v[168:171], a[104:107], a[8:11], v[168:171]
v_fmac_f32 v207, v51, v88
v_mfma_f32_16x16x32_bf16 v[168:171], a[108:111], a[12:15], v[168:171]
ds_read_b128 a[148:151], v5 offset:44032
v_mfma_f32_16x16x32_bf16 v[144:147], a[108:111], a[4:7], v[144:147]
v_fmac_f32 v211, v55, v88
v_mfma_f32_16x16x32_bf16 v[144:147], a[104:107], a[0:3], v[144:147]
buffer_load_dwordx4 v1, s[4:7], s44 offen offset:1024 sc1 lds
v_mfma_f32_16x16x32_bf16 v[148:151], a[112:115], a[0:3], v[148:151]
v_fmac_f32 v187, v55, v86
v_mfma_f32_16x16x32_bf16 v[148:151], a[116:119], a[4:7], v[148:151]
v_mfma_f32_16x16x32_bf16 v[172:175], a[116:119], a[12:15], v[172:175]
v_fmac_f32 v163, v55, v84
v_mfma_f32_16x16x32_bf16 v[172:175], a[112:115], a[8:11], v[172:175]
v_mfma_f32_16x16x32_bf16 v[196:199], a[112:115], a[16:19], v[196:199]
buffer_load_dwordx4 v1, s[4:7], s44 offen offset:2048 sc1 lds
v_mfma_f32_16x16x32_bf16 v[196:199], a[116:119], a[20:23], v[196:199]
v_fmac_f32 v139, v55, v82
v_mfma_f32_16x16x32_bf16 v[220:223], a[116:119], a[28:31], v[220:223]
v_mfma_f32_16x16x32_bf16 v[220:223], a[112:115], a[24:27], v[220:223]
s_waitcnt lgkmcnt(0)
s_barrier
v_mfma_f32_16x16x32_bf16 v[224:227], a[128:131], a[24:27], v[224:227]
ds_read_b128 v[92:95], v235 offset:0
v_mfma_f32_16x16x32_bf16 v[224:227], a[132:135], a[28:31], v[224:227]
buffer_load_dwordx4 v1, s[4:7], s44 offen offset:3072 sc1 lds
v_mfma_f32_16x16x32_bf16 v[200:203], a[132:135], a[20:23], v[200:203]
ds_read_b128 v[96:99], v235 offset:4096
v_mfma_f32_16x16x32_bf16 v[200:203], a[128:131], a[16:19], v[200:203]
v_mfma_f32_16x16x32_bf16 v[176:179], a[128:131], a[8:11], v[176:179]
ds_read_b128 v[100:103], v235 offset:8192
v_mfma_f32_16x16x32_bf16 v[176:179], a[132:135], a[12:15], v[176:179]
v_mfma_f32_16x16x32_bf16 v[152:155], a[132:135], a[4:7], v[152:155]
ds_read_b128 v[104:107], v235 offset:12288
v_mfma_f32_16x16x32_bf16 v[152:155], a[128:131], a[0:3], v[152:155]
v_mfma_f32_16x16x32_bf16 v[132:135], a[136:139], a[0:3], v[132:135]
v_mfma_f32_16x16x32_bf16 v[132:135], a[140:143], a[4:7], v[132:135]
v_mfma_f32_16x16x32_bf16 v[156:159], a[140:143], a[12:15], v[156:159]
v_mfma_f32_16x16x32_bf16 v[156:159], a[136:139], a[8:11], v[156:159]
v_mfma_f32_16x16x32_bf16 v[180:183], a[136:139], a[16:19], v[180:183]
v_mfma_f32_16x16x32_bf16 v[180:183], a[140:143], a[20:23], v[180:183]
v_mfma_f32_16x16x32_bf16 v[204:207], a[140:143], a[28:31], v[204:207]
v_mfma_f32_16x16x32_bf16 v[204:207], a[136:139], a[24:27], v[204:207]
v_mfma_f32_16x16x32_bf16 v[208:211], a[144:147], a[24:27], v[208:211]
v_mfma_f32_16x16x32_bf16 v[208:211], a[148:151], a[28:31], v[208:211]
v_mfma_f32_16x16x32_bf16 v[184:187], a[148:151], a[20:23], v[184:187]
v_mfma_f32_16x16x32_bf16 v[184:187], a[144:147], a[16:19], v[184:187]
v_mfma_f32_16x16x32_bf16 v[160:163], a[144:147], a[8:11], v[160:163]
v_mfma_f32_16x16x32_bf16 v[160:163], a[148:151], a[12:15], v[160:163]
v_mfma_f32_16x16x32_bf16 v[136:139], a[148:151], a[4:7], v[136:139]
v_mfma_f32_16x16x32_bf16 v[136:139], a[144:147], a[0:3], v[136:139]
.set L_cpf2, .
s_lshl_b32 s36, s28, 12
s_lshl_b32 s37, s28, 10
s_add_u32 m0, s19, 32768
s_add_u32 s44, s84, 0xa00000
buffer_load_dwordx4 v1, s[4:7], s44 offen offset:0 sc1 lds
s_waitcnt lgkmcnt(2)
v_add_f32 v92, v92, v96
s_waitcnt lgkmcnt(0)
v_add_f32 v100, v100, v104
v_add_f32 v93, v93, v97
v_add_f32 v101, v101, v105
v_add_f32 v94, v94, v98
v_add_f32 v102, v102, v106
v_add_f32 v95, v95, v99
v_add_f32 v103, v103, v107
v_add_f32 v228, v92, v100
v_add_f32 v229, v93, v101
v_add_f32 v230, v94, v102
v_add_f32 v231, v95, v103
v_fmac_f32 v228, v72, v90
v_fmac_f32 v229, v73, v90
v_pk_mul_f32 v[212:213], v[212:213], v[88:89] op_sel:[0,1] op_sel_hi:[1,1]
v_pk_mul_f32 v[220:221], v[220:221], v[88:89] op_sel:[0,1] op_sel_hi:[1,1]
v_pk_mul_f32 v[196:197], v[196:197], v[86:87] op_sel:[0,1] op_sel_hi:[1,1]
v_pk_mul_f32 v[172:173], v[172:173], v[84:85] op_sel:[0,1] op_sel_hi:[1,1]
v_pk_mul_f32 v[148:149], v[148:149], v[82:83] op_sel:[0,1] op_sel_hi:[1,1]
v_fmac_f32 v230, v74, v90
v_fmac_f32 v231, v75, v90
v_pk_mul_f32 v[228:229], v[228:229], v[90:91] op_sel:[0,1] op_sel_hi:[1,1]
v_pk_mul_f32 v[214:215], v[214:215], v[88:89] op_sel:[0,1] op_sel_hi:[1,1]
v_pk_mul_f32 v[222:223], v[222:223], v[88:89] op_sel:[0,1] op_sel_hi:[1,1]
v_pk_mul_f32 v[198:199], v[198:199], v[86:87] op_sel:[0,1] op_sel_hi:[1,1]
v_pk_mul_f32 v[174:175], v[174:175], v[84:85] op_sel:[0,1] op_sel_hi:[1,1]
v_pk_mul_f32 v[150:151], v[150:151], v[82:83] op_sel:[0,1] op_sel_hi:[1,1]
buffer_load_dwordx4 v1, s[4:7], s44 offen offset:1024 sc1 lds
v_cvt_pk_bf16_f32 v212, v212, v213
v_cvt_pk_bf16_f32 v220, v220, v221
v_cvt_pk_bf16_f32 v196, v196, v197
v_cvt_pk_bf16_f32 v172, v172, v173
v_cvt_pk_bf16_f32 v148, v148, v149
v_pk_mul_f32 v[230:231], v[230:231], v[90:91] op_sel:[0,1] op_sel_hi:[1,1]
v_pk_mul_f32 v[216:217], v[216:217], v[88:89] op_sel:[0,1] op_sel_hi:[1,1]
v_pk_mul_f32 v[218:219], v[218:219], v[88:89] op_sel:[0,1] op_sel_hi:[1,1]
v_pk_mul_f32 v[224:225], v[224:225], v[88:89] op_sel:[0,1] op_sel_hi:[1,1]
v_pk_mul_f32 v[226:227], v[226:227], v[88:89] op_sel:[0,1] op_sel_hi:[1,1]
v_pk_mul_f32 v[200:201], v[200:201], v[86:87] op_sel:[0,1] op_sel_hi:[1,1]
v_pk_mul_f32 v[202:203], v[202:203], v[86:87] op_sel:[0,1] op_sel_hi:[1,1]
v_pk_mul_f32 v[176:177], v[176:177], v[84:85] op_sel:[0,1] op_sel_hi:[1,1]
v_pk_mul_f32 v[178:179], v[178:179], v[84:85] op_sel:[0,1] op_sel_hi:[1,1]
v_pk_mul_f32 v[152:153], v[152:153], v[82:83] op_sel:[0,1] op_sel_hi:[1,1]
v_pk_mul_f32 v[154:155], v[154:155], v[82:83] op_sel:[0,1] op_sel_hi:[1,1]
v_cvt_pk_bf16_f32 v228, v228, v229
v_cvt_pk_bf16_f32 v213, v214, v215
v_cvt_pk_bf16_f32 v221, v222, v223
v_cvt_pk_bf16_f32 v197, v198, v199
v_cvt_pk_bf16_f32 v173, v174, v175
v_cvt_pk_bf16_f32 v149, v150, v151
v_pk_mul_f32 v[188:189], v[188:189], v[86:87] op_sel:[0,1] op_sel_hi:[1,1]
v_pk_mul_f32 v[164:165], v[164:165], v[84:85] op_sel:[0,1] op_sel_hi:[1,1]
v_pk_mul_f32 v[140:141], v[140:141], v[82:83] op_sel:[0,1] op_sel_hi:[1,1]
v_add_u32 v232, s36, v7
v_add_u32 v233, s37, v1
buffer_load_dwordx4 v1, s[4:7], s44 offen offset:2048 sc1 lds
v_cvt_pk_bf16_f32 v229, v230, v231
v_cvt_pk_bf16_f32 v214, v216, v217
v_cvt_pk_bf16_f32 v215, v218, v219
v_cvt_pk_bf16_f32 v222, v224, v225
v_cvt_pk_bf16_f32 v223, v226, v227
v_cvt_pk_bf16_f32 v198, v200, v201
v_cvt_pk_bf16_f32 v199, v202, v203
v_cvt_pk_bf16_f32 v174, v176, v177
v_cvt_pk_bf16_f32 v175, v178, v179
v_cvt_pk_bf16_f32 v150, v152, v153
v_cvt_pk_bf16_f32 v151, v154, v155
v_pk_mul_f32 v[190:191], v[190:191], v[86:87] op_sel:[0,1] op_sel_hi:[1,1]
v_pk_mul_f32 v[166:167], v[166:167], v[84:85] op_sel:[0,1] op_sel_hi:[1,1]
v_pk_mul_f32 v[142:143], v[142:143], v[82:83] op_sel:[0,1] op_sel_hi:[1,1]
v_cvt_pk_bf16_f32 v188, v188, v189
v_cvt_pk_bf16_f32 v164, v164, v165
v_cvt_pk_bf16_f32 v140, v140, v141
v_cvt_pk_bf16_f32 v132, v132, v133
v_cvt_pk_bf16_f32 v156, v156, v157
v_cvt_pk_bf16_f32 v180, v180, v181
v_cvt_pk_bf16_f32 v204, v204, v205
ds_write_b64 v9, v[228:229]
ds_write_b64 v232, v[220:221] offset:4096
ds_write_b64 v232, v[222:223] offset:4608
v_pk_mul_f32 v[192:193], v[192:193], v[86:87] op_sel:[0,1] op_sel_hi:[1,1]
v_pk_mul_f32 v[194:195], v[194:195], v[86:87] op_sel:[0,1] op_sel_hi:[1,1]
v_pk_mul_f32 v[168:169], v[168:169], v[84:85] op_sel:[0,1] op_sel_hi:[1,1]
ds_write_b64 v232, v[196:197] offset:3072
v_pk_mul_f32 v[170:171], v[170:171], v[84:85] op_sel:[0,1] op_sel_hi:[1,1]
v_pk_mul_f32 v[144:145], v[144:145], v[82:83] op_sel:[0,1] op_sel_hi:[1,1]
v_pk_mul_f32 v[146:147], v[146:147], v[82:83] op_sel:[0,1] op_sel_hi:[1,1]
ds_write_b64 v232, v[198:199] offset:3584
buffer_load_dwordx4 v1, s[4:7], s44 offen offset:3072 sc1 lds
v_cvt_pk_bf16_f32 v189, v190, v191
ds_write_b64 v232, v[172:173] offset:2048
v_cvt_pk_bf16_f32 v165, v166, v167
v_cvt_pk_bf16_f32 v141, v142, v143
ds_write_b64 v232, v[174:175] offset:2560
L_stub13:
s_cbranch_execz L_wret4
v_cvt_pk_bf16_f32 v133, v134, v135
v_cvt_pk_bf16_f32 v157, v158, v159
v_cvt_pk_bf16_f32 v181, v182, v183
ds_write_b64 v232, v[148:149] offset:1024
v_cvt_pk_bf16_f32 v205, v206, v207
v_cvt_pk_bf16_f32 v190, v192, v193
v_cvt_pk_bf16_f32 v191, v194, v195
ds_write_b64 v232, v[150:151] offset:1536
v_cvt_pk_bf16_f32 v166, v168, v169
v_cvt_pk_bf16_f32 v167, v170, v171
v_cvt_pk_bf16_f32 v142, v144, v145
ds_write_b128 v233, v[212:215] offset:21504
v_cvt_pk_bf16_f32 v143, v146, v147
v_cvt_pk_bf16_f32 v134, v136, v137
v_cvt_pk_bf16_f32 v135, v138, v139
v_cvt_pk_bf16_f32 v158, v160, v161
v_cvt_pk_bf16_f32 v159, v162, v163
v_cvt_pk_bf16_f32 v182, v184, v185
v_cvt_pk_bf16_f32 v183, v186, v187
v_cvt_pk_bf16_f32 v206, v208, v209
v_cvt_pk_bf16_f32 v207, v210, v211
s_waitcnt lgkmcnt(0)
s_barrier
s_lshl_b32 s35, s30, 12
s_add_u32 s35, s35, 0x1e00000
s_add_u32 m0, s19, 147456
s_add_u32 s44, s87, 0xa1c000
buffer_load_dwordx4 v1, s[4:7], s44 offen offset:0 sc1 lds
v_mfma_f32_16x16x32_bf16 v[184:187], v[164:167], v[180:183], v[20:23]
ds_read_b128 a[0:3], v233 offset:20480
v_mfma_f32_16x16x32_bf16 v[200:203], v[188:191], v[180:183], v[24:27]
v_add_u32 v234, s36, v8
ds_read_b64_tr_b16 a[10:11], v234 offset:3072
v_mfma_f32_16x16x32_bf16 v[208:211], v[188:191], v[204:207], v[20:23]
ds_read_b64_tr_b16 a[12:13], v234 offset:4096
v_mfma_f32_16x16x32_bf16 v[224:227], v[212:215], v[204:207], v[24:27]
s_nop 2
v_max_f32 v200, v200, v184
v_max_f32 v201, v201, v185
v_max_f32 v202, v202, v186
v_max_f32 v203, v203, v187
v_max3_f32 v238, v200, v201, v202
v_max_f32 v238, v238, v203
ds_read_b64_tr_b16 a[22:23], v234 offset:3584
v_max_f32 v224, v224, v208
v_max_f32 v225, v225, v209
v_max_f32 v226, v226, v210
v_max_f32 v227, v227, v211
buffer_load_dwordx4 v1, s[4:7], s44 offen offset:1024 sc1 lds
v_max3_f32 v239, v224, v225, v226
v_max_f32 v239, v239, v227
ds_read_b64_tr_b16 a[24:25], v234 offset:4608
s_nop 0
v_permlane32_swap_b32 v239, v238
v_max_f32 v239, v239, v238
v_mov_b32 v242, v239
s_waitcnt lgkmcnt(4)
v_mfma_f32_16x16x32_bf16 v[136:139], a[0:3], v[132:135], v[76:79]
v_permlane16_swap_b32 v239, v242
v_max_f32 v239, v239, v242
v_mov_b32 v242, v239
v_mfma_f32_16x16x32_bf16 v[152:155], v[140:143], v[132:135], v[24:27]
s_nop 0
v_permlane32_swap_b32 v239, v242
v_mfma_f32_16x16x32_bf16 v[160:163], v[140:143], v[156:159], v[20:23]
v_mul_f32 v88, 0x3e8293ee, v89
v_mul_f32_e64 v89, -v239, v88
v_mfma_f32_16x16x32_bf16 v[176:179], v[164:167], v[156:159], v[24:27]
v_fma_f32 v224, v224, v88, v89
v_fma_f32 v225, v225, v88, v89
v_fma_f32 v226, v226, v88, v89
buffer_load_dwordx4 v1, s[4:7], s44 offen offset:2048 sc1 lds
v_fma_f32 v227, v227, v88, v89
v_exp_f32 v224, v224
v_exp_f32 v225, v225
v_exp_f32 v226, v226
v_exp_f32 v227, v227
v_max_f32 v152, v152, v136
v_max_f32 v153, v153, v137
v_max_f32 v154, v154, v138
v_max_f32 v176, v176, v160
v_max_f32 v177, v177, v161
v_max_f32 v178, v178, v162
v_cvt_pk_bf16_f32 v224, v224, v225
ds_read_b64_tr_b16 a[8:9], v234 offset:2048
v_max_f32 v155, v155, v139
v_max3_f32 v236, v152, v153, v154
v_max_f32 v179, v179, v163
v_max3_f32 v237, v176, v177, v178
v_cvt_pk_bf16_f32 v225, v226, v227
ds_read_b64_tr_b16 a[20:21], v234 offset:2560
v_max_f32 v236, v236, v155
v_max_f32 v237, v237, v179
buffer_load_dwordx4 v1, s[4:7], s44 offen offset:3072 sc1 lds
v_and_b32 v208, v224, v28
v_and_b32 v209, v225, v29
v_and_b32 v210, v224, v30
v_and_b32 v211, v225, v31
v_permlane32_swap_b32 v237, v236
s_nop 0
v_mfma_f32_16x16x32_bf16 v[216:219], v[16:19], v[208:211], 0
v_mul_f32 v86, 0x3e8293ee, v87
v_max_f32 v237, v237, v236
v_mul_f32_e64 v87, -v242, v86
s_waitcnt lgkmcnt(4)
v_mfma_f32_16x16x32_bf16 v[116:119], a[10:13], v[208:211], 0
v_mov_b32 v243, v237
v_fma_f32 v200, v200, v86, v87
v_fma_f32 v201, v201, v86, v87
v_fma_f32 v202, v202, v86, v87
v_fma_f32 v203, v203, v86, v87
s_waitcnt lgkmcnt(2)
v_mfma_f32_16x16x32_bf16 v[120:123], a[22:25], v[208:211], 0
v_exp_f32 v200, v200
v_exp_f32 v201, v201
v_exp_f32 v202, v202
v_exp_f32 v203, v203
v_permlane16_swap_b32 v237, v243
v_rcp_f32 v216, v216
v_cvt_pk_bf16_f32 v200, v200, v201
ds_read_b64_tr_b16 a[6:7], v234 offset:1024
v_max_f32 v237, v237, v243
v_cvt_pk_bf16_f32 v201, v202, v203
ds_read_b64_tr_b16 a[18:19], v234 offset:1536
v_mov_b32 v243, v237
v_and_b32 v184, v200, v28
v_and_b32 v185, v201, v29
v_and_b32 v186, v200, v30
v_and_b32 v187, v201, v31
v_pk_mul_f32 v[116:117], v[116:117], v[216:217] op_sel:[0,0] op_sel_hi:[1,0]
v_pk_mul_f32 v[118:119], v[118:119], v[216:217] op_sel:[0,0] op_sel_hi:[1,0]
v_cvt_pk_bf16_f32 v116, v116, v117
v_pk_mul_f32 v[120:121], v[120:121], v[216:217] op_sel:[0,0] op_sel_hi:[1,0]
v_permlane32_swap_b32 v237, v243
v_pk_mul_f32 v[122:123], v[122:123], v[216:217] op_sel:[0,0] op_sel_hi:[1,0]
v_cvt_pk_bf16_f32 v117, v118, v119
v_mfma_f32_16x16x32_bf16 v[192:195], v[16:19], v[184:187], 0
v_cvt_pk_bf16_f32 v118, v120, v121
v_cvt_pk_bf16_f32 v119, v122, v123
v_mul_f32 v84, 0x3e8293ee, v85
buffer_store_dwordx4 v[116:119], v2, s[4:7], s35 offen offset:3072 sc1
v_mul_f32_e64 v85, -v237, v84
s_waitcnt lgkmcnt(3)
v_mfma_f32_16x16x32_bf16 v[108:111], a[8:11], v[184:187], 0
v_fma_f32 v176, v176, v84, v85
v_fma_f32 v177, v177, v84, v85
v_fma_f32 v178, v178, v84, v85
v_fma_f32 v179, v179, v84, v85
s_waitcnt lgkmcnt(2)
v_mfma_f32_16x16x32_bf16 v[112:115], a[20:23], v[184:187], 0
v_exp_f32 v176, v176
v_exp_f32 v177, v177
v_exp_f32 v178, v178
v_exp_f32 v179, v179
v_rcp_f32 v192, v192
v_cvt_pk_bf16_f32 v176, v176, v177
ds_read_b64_tr_b16 a[4:5], v234 offset:0
v_cvt_pk_bf16_f32 v177, v178, v179
ds_read_b64_tr_b16 a[16:17], v234 offset:512
v_and_b32 v160, v176, v28
v_and_b32 v161, v177, v29
v_and_b32 v162, v176, v30
v_and_b32 v163, v177, v31
v_pk_mul_f32 v[108:109], v[108:109], v[192:193] op_sel:[0,0] op_sel_hi:[1,0]
v_pk_mul_f32 v[110:111], v[110:111], v[192:193] op_sel:[0,0] op_sel_hi:[1,0]
v_cvt_pk_bf16_f32 v108, v108, v109
v_pk_mul_f32 v[112:113], v[112:113], v[192:193] op_sel:[0,0] op_sel_hi:[1,0]
v_cvt_pk_bf16_f32 v109, v110, v111
v_pk_mul_f32 v[114:115], v[114:115], v[192:193] op_sel:[0,0] op_sel_hi:[1,0]
v_cvt_pk_bf16_f32 v110, v112, v113
v_mfma_f32_16x16x32_bf16 v[168:171], v[16:19], v[160:163], 0
v_cvt_pk_bf16_f32 v111, v114, v115
v_mul_f32 v82, 0x3e8293ee, v83
buffer_store_dwordx4 v[108:111], v2, s[4:7], s35 offen offset:2048 sc1
v_mul_f32_e64 v83, -v243, v82
s_waitcnt lgkmcnt(3)
v_mfma_f32_16x16x32_bf16 v[100:103], a[6:9], v[160:163], 0
v_fma_f32 v152, v152, v82, v83
v_fma_f32 v153, v153, v82, v83
v_fma_f32 v154, v154, v82, v83
v_fma_f32 v155, v155, v82, v83
s_waitcnt lgkmcnt(2)
v_mfma_f32_16x16x32_bf16 v[104:107], a[18:21], v[160:163], 0
v_exp_f32 v152, v152
v_exp_f32 v153, v153
buffer_atomic_add v12, v10, s[4:7], s94 offen sc1
v_exp_f32 v154, v154
v_exp_f32 v155, v155
v_rcp_f32 v168, v168
v_cvt_pk_bf16_f32 v152, v152, v153
v_cvt_pk_bf16_f32 v153, v154, v155
v_and_b32 v136, v152, v80
v_and_b32 v137, v153, v81
v_and_b32 v138, v152, v30
v_and_b32 v139, v153, v31
v_pk_mul_f32 v[100:101], v[100:101], v[168:169] op_sel:[0,0] op_sel_hi:[1,0]
v_pk_mul_f32 v[102:103], v[102:103], v[168:169] op_sel:[0,0] op_sel_hi:[1,0]
v_cvt_pk_bf16_f32 v100, v100, v101
v_pk_mul_f32 v[104:105], v[104:105], v[168:169] op_sel:[0,0] op_sel_hi:[1,0]
v_cvt_pk_bf16_f32 v101, v102, v103
v_pk_mul_f32 v[106:107], v[106:107], v[168:169] op_sel:[0,0] op_sel_hi:[1,0]
v_cvt_pk_bf16_f32 v102, v104, v105
v_mfma_f32_16x16x32_bf16 v[144:147], v[16:19], v[136:139], 0
v_cvt_pk_bf16_f32 v103, v106, v107
buffer_store_dwordx4 v[100:103], v2, s[4:7], s35 offen offset:1024 sc1
s_waitcnt lgkmcnt(1)
v_mfma_f32_16x16x32_bf16 v[92:95], a[4:7], v[136:139], 0
s_nop 3
v_rcp_f32 v144, v144
s_waitcnt lgkmcnt(0)
v_mfma_f32_16x16x32_bf16 v[96:99], a[16:19], v[136:139], 0
s_nop 0
v_pk_mul_f32 v[92:93], v[92:93], v[144:145] op_sel:[0,0] op_sel_hi:[1,0]
v_pk_mul_f32 v[94:95], v[94:95], v[144:145] op_sel:[0,0] op_sel_hi:[1,0]
v_cvt_pk_bf16_f32 v92, v92, v93
v_cvt_pk_bf16_f32 v93, v94, v95
s_nop 2
v_pk_mul_f32 v[96:97], v[96:97], v[144:145] op_sel:[0,0] op_sel_hi:[1,0]
v_pk_mul_f32 v[98:99], v[98:99], v[144:145] op_sel:[0,0] op_sel_hi:[1,0]
v_cvt_pk_bf16_f32 v94, v96, v97
v_cvt_pk_bf16_f32 v95, v98, v99
buffer_store_dwordx4 v[92:95], v2, s[4:7], s35 offen offset:0 sc1
s_add_u32 s92, s71, 0x20000
s_add_u32 s36, s66, 0x20080
s_add_u32 s40, s4, 0x1e00000
s_addc_u32 s41, s5, 0
v_add_u32 v5, 32768, v1
v_add_u32 v6, 98304, v1
s_cmp_eq_u32 s3, 0
s_cselect_b32 s35, 8, 0
s_lshl_b32 s35, s35, 12
v_lshlrev_b32 v132, 16, v32
v_and_b32 v133, 0xffff0000, v32
v_lshlrev_b32 v134, 16, v33
v_and_b32 v135, 0xffff0000, v33
v_lshlrev_b32 v136, 16, v34
v_and_b32 v137, 0xffff0000, v34
v_lshlrev_b32 v138, 16, v35
v_and_b32 v139, 0xffff0000, v35
v_lshlrev_b32 v140, 16, v36
v_and_b32 v141, 0xffff0000, v36
v_lshlrev_b32 v142, 16, v37
v_and_b32 v143, 0xffff0000, v37
v_lshlrev_b32 v144, 16, v38
v_and_b32 v145, 0xffff0000, v38
v_lshlrev_b32 v146, 16, v39
v_and_b32 v147, 0xffff0000, v39
v_lshlrev_b32 v148, 16, v40
v_and_b32 v149, 0xffff0000, v40
v_lshlrev_b32 v150, 16, v41
v_and_b32 v151, 0xffff0000, v41
v_lshlrev_b32 v152, 16, v42
v_and_b32 v153, 0xffff0000, v42
v_lshlrev_b32 v154, 16, v43
v_and_b32 v155, 0xffff0000, v43
v_lshlrev_b32 v156, 16, v44
v_and_b32 v157, 0xffff0000, v44
v_lshlrev_b32 v158, 16, v45
v_and_b32 v159, 0xffff0000, v45
v_lshlrev_b32 v160, 16, v46
v_and_b32 v161, 0xffff0000, v46
v_lshlrev_b32 v162, 16, v47
v_and_b32 v163, 0xffff0000, v47
s_mov_b32 s95, -1
s_mov_b64 exec, 0
s_cmp_eq_u32 s28, 3
s_cbranch_scc1 L_stub14
s_cmp_eq_u32 s28, 2
s_cbranch_scc1 L_wret5
L_wret5:
s_mov_b64 exec, -1
s_cmp_lg_u32 s28, 0
s_cbranch_scc1 Lpe_28
s_add_u32 s36, s66, 0x20080
s_mov_b32 s37, 0
Lpoll_27:
v_mov_b32 v11, 0
buffer_atomic_add v11, v251, s[4:7], s36 offen sc0 sc1
s_add_u32 s37, s37, 1
s_waitcnt vmcnt(0)
v_readfirstlane_b32 s38, v11
s_nop 0
s_cmp_ge_u32 s38, 32
s_cbranch_scc1 Lpe_28
s_cmp_lt_u32 s37, 0x100000
s_cbranch_scc1 Lpoll_27
Lpe_28:
s_waitcnt vmcnt(0)
s_barrier
L_k2go2:
buffer_load_dwordx4 a[0:3], v4, s[40:43], s35 offen offset:0 sc1
buffer_load_dwordx4 a[4:7], v4, s[40:43], s35 offen offset:1024 sc1
s_cmp_eq_u32 s3, 1
s_cselect_b32 s35, 9, 1
s_lshl_b32 s35, s35, 12
buffer_load_dwordx4 a[8:11], v4, s[40:43], s35 offen offset:0 sc1
buffer_load_dwordx4 a[12:15], v4, s[40:43], s35 offen offset:1024 sc1
s_cmp_eq_u32 s3, 2
s_cselect_b32 s35, 10, 2
s_lshl_b32 s35, s35, 12
buffer_load_dwordx4 a[16:19], v4, s[40:43], s35 offen offset:0 sc1
buffer_load_dwordx4 a[20:23], v4, s[40:43], s35 offen offset:1024 sc1
s_cmp_eq_u32 s3, 3
s_cselect_b32 s35, 11, 3
s_lshl_b32 s35, s35, 12
buffer_load_dwordx4 a[24:27], v4, s[40:43], s35 offen offset:0 sc1
buffer_load_dwordx4 a[28:31], v4, s[40:43], s35 offen offset:1024 sc1
s_cmp_eq_u32 s3, 4
s_cselect_b32 s35, 12, 4
s_lshl_b32 s35, s35, 12
buffer_load_dwordx4 a[32:35], v4, s[40:43], s35 offen offset:0 sc1
buffer_load_dwordx4 a[36:39], v4, s[40:43], s35 offen offset:1024 sc1
s_cmp_eq_u32 s3, 5
s_cselect_b32 s35, 13, 5
s_lshl_b32 s35, s35, 12
ds_read_b128 a[96:99], v5 offset:0
ds_read_b128 a[100:103], v5 offset:1024
ds_read_b128 a[104:107], v5 offset:2048
ds_read_b128 a[108:111], v5 offset:3072
ds_read_b128 a[112:115], v5 offset:4096
ds_read_b128 a[116:119], v5 offset:5120
ds_read_b128 a[120:123], v5 offset:6144
ds_read_b128 a[124:127], v5 offset:7168
s_waitcnt vmcnt(8) lgkmcnt(4)
v_mfma_f32_16x16x32_bf16 v[132:135], a[96:99], a[0:3], v[132:135]
ds_read_b128 a[128:131], v5 offset:8192
v_mfma_f32_16x16x32_bf16 v[148:151], a[96:99], a[4:7], v[148:151]
ds_read_b128 a[132:135], v5 offset:9216
v_mfma_f32_16x16x32_bf16 v[152:155], a[100:103], a[4:7], v[152:155]
buffer_load_dwordx4 a[40:43], v4, s[40:43], s35 offen offset:0 sc1
v_mfma_f32_16x16x32_bf16 v[136:139], a[100:103], a[0:3], v[136:139]
ds_read_b128 a[136:139], v5 offset:10240
v_mfma_f32_16x16x32_bf16 v[140:143], a[104:107], a[0:3], v[140:143]
ds_read_b128 a[140:143], v5 offset:11264
v_mfma_f32_16x16x32_bf16 v[156:159], a[104:107], a[4:7], v[156:159]
v_mfma_f32_16x16x32_bf16 v[160:163], a[108:111], a[4:7], v[160:163]
buffer_load_dwordx4 a[44:47], v4, s[40:43], s35 offen offset:1024 sc1
v_mfma_f32_16x16x32_bf16 v[144:147], a[108:111], a[0:3], v[144:147]
s_waitcnt vmcnt(8) lgkmcnt(4)
v_mfma_f32_16x16x32_bf16 v[132:135], a[112:115], a[8:11], v[132:135]
s_cmp_eq_u32 s3, 6
s_cselect_b32 s35, 14, 6
s_lshl_b32 s35, s35, 12
v_mfma_f32_16x16x32_bf16 v[148:151], a[112:115], a[12:15], v[148:151]
ds_read_b128 a[96:99], v5 offset:12288
v_mfma_f32_16x16x32_bf16 v[152:155], a[116:119], a[12:15], v[152:155]
buffer_load_dwordx4 a[0:3], v4, s[40:43], s35 offen offset:0 sc1
v_mfma_f32_16x16x32_bf16 v[136:139], a[116:119], a[8:11], v[136:139]
ds_read_b128 a[100:103], v5 offset:13312
v_mfma_f32_16x16x32_bf16 v[140:143], a[120:123], a[8:11], v[140:143]
ds_read_b128 a[104:107], v5 offset:14336
v_mfma_f32_16x16x32_bf16 v[156:159], a[120:123], a[12:15], v[156:159]
ds_read_b128 a[108:111], v5 offset:15360
v_mfma_f32_16x16x32_bf16 v[160:163], a[124:127], a[12:15], v[160:163]
buffer_load_dwordx4 a[4:7], v4, s[40:43], s35 offen offset:1024 sc1
v_mfma_f32_16x16x32_bf16 v[144:147], a[124:127], a[8:11], v[144:147]
s_waitcnt vmcnt(8) lgkmcnt(4)
v_mfma_f32_16x16x32_bf16 v[132:135], a[128:131], a[16:19], v[132:135]
s_cmp_eq_u32 s3, 7
s_cselect_b32 s35, 15, 7
s_lshl_b32 s35, s35, 12
v_mfma_f32_16x16x32_bf16 v[148:151], a[128:131], a[20:23], v[148:151]
ds_read_b128 a[112:115], v5 offset:16384
v_mfma_f32_16x16x32_bf16 v[152:155], a[132:135], a[20:23], v[152:155]
buffer_load_dwordx4 a[8:11], v4, s[40:43], s35 offen offset:0 sc1
v_mfma_f32_16x16x32_bf16 v[136:139], a[132:135], a[16:19], v[136:139]
ds_read_b128 a[116:119], v5 offset:17408
v_mfma_f32_16x16x32_bf16 v[140:143], a[136:139], a[16:19], v[140:143]
ds_read_b128 a[120:123], v5 offset:18432
v_mfma_f32_16x16x32_bf16 v[156:159], a[136:139], a[20:23], v[156:159]
ds_read_b128 a[124:127], v5 offset:19456
v_mfma_f32_16x16x32_bf16 v[160:163], a[140:143], a[20:23], v[160:163]
buffer_load_dwordx4 a[12:15], v4, s[40:43], s35 offen offset:1024 sc1
v_mfma_f32_16x16x32_bf16 v[144:147], a[140:143], a[16:19], v[144:147]
s_waitcnt vmcnt(8) lgkmcnt(4)
v_mfma_f32_16x16x32_bf16 v[132:135], a[96:99], a[24:27], v[132:135]
s_cmp_eq_u32 s3, 0
s_cselect_b32 s35, 16, 8
s_lshl_b32 s35, s35, 12
v_mfma_f32_16x16x32_bf16 v[148:151], a[96:99], a[28:31], v[148:151]
ds_read_b128 a[128:131], v5 offset:20480
v_mfma_f32_16x16x32_bf16 v[152:155], a[100:103], a[28:31], v[152:155]
buffer_load_dwordx4 a[16:19], v4, s[40:43], s35 offen offset:0 sc1
v_mfma_f32_16x16x32_bf16 v[136:139], a[100:103], a[24:27], v[136:139]
ds_read_b128 a[132:135], v5 offset:21504
v_mfma_f32_16x16x32_bf16 v[140:143], a[104:107], a[24:27], v[140:143]
ds_read_b128 a[136:139], v5 offset:22528
v_mfma_f32_16x16x32_bf16 v[156:159], a[104:107], a[28:31], v[156:159]
ds_read_b128 a[140:143], v5 offset:23552
v_mfma_f32_16x16x32_bf16 v[160:163], a[108:111], a[28:31], v[160:163]
buffer_load_dwordx4 a[20:23], v4, s[40:43], s35 offen offset:1024 sc1
v_mfma_f32_16x16x32_bf16 v[144:147], a[108:111], a[24:27], v[144:147]
s_waitcnt vmcnt(8) lgkmcnt(4)
v_mfma_f32_16x16x32_bf16 v[132:135], a[112:115], a[32:35], v[132:135]
s_cmp_eq_u32 s3, 1
s_cselect_b32 s35, 17, 9
s_lshl_b32 s35, s35, 12
v_mfma_f32_16x16x32_bf16 v[148:151], a[112:115], a[36:39], v[148:151]
ds_read_b128 a[96:99], v5 offset:24576
v_mfma_f32_16x16x32_bf16 v[152:155], a[116:119], a[36:39], v[152:155]
buffer_load_dwordx4 a[24:27], v4, s[40:43], s35 offen offset:0 sc1
v_mfma_f32_16x16x32_bf16 v[136:139], a[116:119], a[32:35], v[136:139]
ds_read_b128 a[100:103], v5 offset:25600
v_mfma_f32_16x16x32_bf16 v[140:143], a[120:123], a[32:35], v[140:143]
ds_read_b128 a[104:107], v5 offset:26624
v_mfma_f32_16x16x32_bf16 v[156:159], a[120:123], a[36:39], v[156:159]
ds_read_b128 a[108:111], v5 offset:27648
v_mfma_f32_16x16x32_bf16 v[160:163], a[124:127], a[36:39], v[160:163]
buffer_load_dwordx4 a[28:31], v4, s[40:43], s35 offen offset:1024 sc1
v_mfma_f32_16x16x32_bf16 v[144:147], a[124:127], a[32:35], v[144:147]
s_waitcnt vmcnt(8) lgkmcnt(4)
v_mfma_f32_16x16x32_bf16 v[132:135], a[128:131], a[40:43], v[132:135]
s_cmp_eq_u32 s3, 2
s_cselect_b32 s35, 18, 10
s_lshl_b32 s35, s35, 12
v_mfma_f32_16x16x32_bf16 v[148:151], a[128:131], a[44:47], v[148:151]
ds_read_b128 a[112:115], v5 offset:28672
v_mfma_f32_16x16x32_bf16 v[152:155], a[132:135], a[44:47], v[152:155]
buffer_load_dwordx4 a[32:35], v4, s[40:43], s35 offen offset:0 sc1
v_mfma_f32_16x16x32_bf16 v[136:139], a[132:135], a[40:43], v[136:139]
ds_read_b128 a[116:119], v5 offset:29696
v_mfma_f32_16x16x32_bf16 v[140:143], a[136:139], a[40:43], v[140:143]
ds_read_b128 a[120:123], v5 offset:30720
v_mfma_f32_16x16x32_bf16 v[156:159], a[136:139], a[44:47], v[156:159]
ds_read_b128 a[124:127], v5 offset:31744
v_mfma_f32_16x16x32_bf16 v[160:163], a[140:143], a[44:47], v[160:163]
buffer_load_dwordx4 a[36:39], v4, s[40:43], s35 offen offset:1024 sc1
v_mfma_f32_16x16x32_bf16 v[144:147], a[140:143], a[40:43], v[144:147]
s_waitcnt vmcnt(8) lgkmcnt(4)
v_mfma_f32_16x16x32_bf16 v[132:135], a[96:99], a[0:3], v[132:135]
s_cmp_eq_u32 s3, 3
s_cselect_b32 s35, 19, 11
s_lshl_b32 s35, s35, 12
v_mfma_f32_16x16x32_bf16 v[148:151], a[96:99], a[4:7], v[148:151]
ds_read_b128 a[128:131], v5 offset:32768
v_mfma_f32_16x16x32_bf16 v[152:155], a[100:103], a[4:7], v[152:155]
buffer_load_dwordx4 a[40:43], v4, s[40:43], s35 offen offset:0 sc1
v_mfma_f32_16x16x32_bf16 v[136:139], a[100:103], a[0:3], v[136:139]
ds_read_b128 a[132:135], v5 offset:33792
v_mfma_f32_16x16x32_bf16 v[140:143], a[104:107], a[0:3], v[140:143]
ds_read_b128 a[136:139], v5 offset:34816
v_mfma_f32_16x16x32_bf16 v[156:159], a[104:107], a[4:7], v[156:159]
ds_read_b128 a[140:143], v5 offset:35840
v_mfma_f32_16x16x32_bf16 v[160:163], a[108:111], a[4:7], v[160:163]
buffer_load_dwordx4 a[44:47], v4, s[40:43], s35 offen offset:1024 sc1
v_mfma_f32_16x16x32_bf16 v[144:147], a[108:111], a[0:3], v[144:147]
s_waitcnt vmcnt(8) lgkmcnt(4)
v_mfma_f32_16x16x32_bf16 v[132:135], a[112:115], a[8:11], v[132:135]
s_cmp_eq_u32 s3, 4
s_cselect_b32 s35, 20, 12
s_lshl_b32 s35, s35, 12
v_mfma_f32_16x16x32_bf16 v[148:151], a[112:115], a[12:15], v[148:151]
ds_read_b128 a[96:99], v5 offset:36864
v_mfma_f32_16x16x32_bf16 v[152:155], a[116:119], a[12:15], v[152:155]
buffer_load_dwordx4 a[0:3], v4, s[40:43], s35 offen offset:0 sc1
v_mfma_f32_16x16x32_bf16 v[136:139], a[116:119], a[8:11], v[136:139]
ds_read_b128 a[100:103], v5 offset:37888
v_mfma_f32_16x16x32_bf16 v[140:143], a[120:123], a[8:11], v[140:143]
ds_read_b128 a[104:107], v5 offset:38912
v_mfma_f32_16x16x32_bf16 v[156:159], a[120:123], a[12:15], v[156:159]
ds_read_b128 a[108:111], v5 offset:39936
v_mfma_f32_16x16x32_bf16 v[160:163], a[124:127], a[12:15], v[160:163]
buffer_load_dwordx4 a[4:7], v4, s[40:43], s35 offen offset:1024 sc1
v_mfma_f32_16x16x32_bf16 v[144:147], a[124:127], a[8:11], v[144:147]
s_waitcnt vmcnt(8) lgkmcnt(4)
v_mfma_f32_16x16x32_bf16 v[132:135], a[128:131], a[16:19], v[132:135]
s_cmp_eq_u32 s3, 5
s_cselect_b32 s35, 21, 13
s_lshl_b32 s35, s35, 12
v_mfma_f32_16x16x32_bf16 v[148:151], a[128:131], a[20:23], v[148:151]
ds_read_b128 a[112:115], v5 offset:40960
v_mfma_f32_16x16x32_bf16 v[152:155], a[132:135], a[20:23], v[152:155]
buffer_load_dwordx4 a[8:11], v4, s[40:43], s35 offen offset:0 sc1
v_mfma_f32_16x16x32_bf16 v[136:139], a[132:135], a[16:19], v[136:139]
ds_read_b128 a[116:119], v5 offset:41984
v_mfma_f32_16x16x32_bf16 v[140:143], a[136:139], a[16:19], v[140:143]
ds_read_b128 a[120:123], v5 offset:43008
v_mfma_f32_16x16x32_bf16 v[156:159], a[136:139], a[20:23], v[156:159]
ds_read_b128 a[124:127], v5 offset:44032
v_mfma_f32_16x16x32_bf16 v[160:163], a[140:143], a[20:23], v[160:163]
buffer_load_dwordx4 a[12:15], v4, s[40:43], s35 offen offset:1024 sc1
v_mfma_f32_16x16x32_bf16 v[144:147], a[140:143], a[16:19], v[144:147]
s_waitcnt vmcnt(8) lgkmcnt(4)
v_mfma_f32_16x16x32_bf16 v[132:135], a[96:99], a[24:27], v[132:135]
s_cmp_eq_u32 s3, 6
s_cselect_b32 s35, 22, 14
s_lshl_b32 s35, s35, 12
v_mfma_f32_16x16x32_bf16 v[148:151], a[96:99], a[28:31], v[148:151]
ds_read_b128 a[128:131], v5 offset:45056
v_mfma_f32_16x16x32_bf16 v[152:155], a[100:103], a[28:31], v[152:155]
buffer_load_dwordx4 a[16:19], v4, s[40:43], s35 offen offset:0 sc1
v_mfma_f32_16x16x32_bf16 v[136:139], a[100:103], a[24:27], v[136:139]
ds_read_b128 a[132:135], v5 offset:46080
v_mfma_f32_16x16x32_bf16 v[140:143], a[104:107], a[24:27], v[140:143]
ds_read_b128 a[136:139], v5 offset:47104
v_mfma_f32_16x16x32_bf16 v[156:159], a[104:107], a[28:31], v[156:159]
ds_read_b128 a[140:143], v5 offset:48128
v_mfma_f32_16x16x32_bf16 v[160:163], a[108:111], a[28:31], v[160:163]
buffer_load_dwordx4 a[20:23], v4, s[40:43], s35 offen offset:1024 sc1
v_mfma_f32_16x16x32_bf16 v[144:147], a[108:111], a[24:27], v[144:147]
s_waitcnt vmcnt(8) lgkmcnt(4)
v_mfma_f32_16x16x32_bf16 v[132:135], a[112:115], a[32:35], v[132:135]
s_cmp_eq_u32 s3, 7
s_cselect_b32 s35, 23, 15
s_lshl_b32 s35, s35, 12
v_mfma_f32_16x16x32_bf16 v[148:151], a[112:115], a[36:39], v[148:151]
ds_read_b128 a[96:99], v5 offset:49152
v_mfma_f32_16x16x32_bf16 v[152:155], a[116:119], a[36:39], v[152:155]
buffer_load_dwordx4 a[24:27], v4, s[40:43], s35 offen offset:0 sc1
v_mfma_f32_16x16x32_bf16 v[136:139], a[116:119], a[32:35], v[136:139]
ds_read_b128 a[100:103], v5 offset:50176
v_mfma_f32_16x16x32_bf16 v[140:143], a[120:123], a[32:35], v[140:143]
ds_read_b128 a[104:107], v5 offset:51200
v_mfma_f32_16x16x32_bf16 v[156:159], a[120:123], a[36:39], v[156:159]
ds_read_b128 a[108:111], v5 offset:52224
v_mfma_f32_16x16x32_bf16 v[160:163], a[124:127], a[36:39], v[160:163]
buffer_load_dwordx4 a[28:31], v4, s[40:43], s35 offen offset:1024 sc1
v_mfma_f32_16x16x32_bf16 v[144:147], a[124:127], a[32:35], v[144:147]
s_waitcnt vmcnt(8) lgkmcnt(4)
v_mfma_f32_16x16x32_bf16 v[132:135], a[128:131], a[40:43], v[132:135]
s_cmp_eq_u32 s3, 0
s_cselect_b32 s35, 24, 16
s_lshl_b32 s35, s35, 12
v_mfma_f32_16x16x32_bf16 v[148:151], a[128:131], a[44:47], v[148:151]
ds_read_b128 a[112:115], v5 offset:53248
v_mfma_f32_16x16x32_bf16 v[152:155], a[132:135], a[44:47], v[152:155]
buffer_load_dwordx4 a[32:35], v4, s[40:43], s35 offen offset:0 sc1
v_mfma_f32_16x16x32_bf16 v[136:139], a[132:135], a[40:43], v[136:139]
ds_read_b128 a[116:119], v5 offset:54272
v_mfma_f32_16x16x32_bf16 v[140:143], a[136:139], a[40:43], v[140:143]
ds_read_b128 a[120:123], v5 offset:55296
v_mfma_f32_16x16x32_bf16 v[156:159], a[136:139], a[44:47], v[156:159]
ds_read_b128 a[124:127], v5 offset:56320
v_mfma_f32_16x16x32_bf16 v[160:163], a[140:143], a[44:47], v[160:163]
buffer_load_dwordx4 a[36:39], v4, s[40:43], s35 offen offset:1024 sc1
v_mfma_f32_16x16x32_bf16 v[144:147], a[140:143], a[40:43], v[144:147]
s_waitcnt vmcnt(8) lgkmcnt(4)
v_mfma_f32_16x16x32_bf16 v[132:135], a[96:99], a[0:3], v[132:135]
s_cmp_eq_u32 s3, 1
s_cselect_b32 s35, 25, 17
s_lshl_b32 s35, s35, 12
v_mfma_f32_16x16x32_bf16 v[148:151], a[96:99], a[4:7], v[148:151]
ds_read_b128 a[128:131], v5 offset:57344
v_mfma_f32_16x16x32_bf16 v[152:155], a[100:103], a[4:7], v[152:155]
buffer_load_dwordx4 a[40:43], v4, s[40:43], s35 offen offset:0 sc1
v_mfma_f32_16x16x32_bf16 v[136:139], a[100:103], a[0:3], v[136:139]
ds_read_b128 a[132:135], v5 offset:58368
v_mfma_f32_16x16x32_bf16 v[140:143], a[104:107], a[0:3], v[140:143]
ds_read_b128 a[136:139], v5 offset:59392
v_mfma_f32_16x16x32_bf16 v[156:159], a[104:107], a[4:7], v[156:159]
ds_read_b128 a[140:143], v5 offset:60416
v_mfma_f32_16x16x32_bf16 v[160:163], a[108:111], a[4:7], v[160:163]
buffer_load_dwordx4 a[44:47], v4, s[40:43], s35 offen offset:1024 sc1
v_mfma_f32_16x16x32_bf16 v[144:147], a[108:111], a[0:3], v[144:147]
s_waitcnt vmcnt(8) lgkmcnt(4)
v_mfma_f32_16x16x32_bf16 v[132:135], a[112:115], a[8:11], v[132:135]
s_cmp_eq_u32 s3, 2
s_cselect_b32 s35, 26, 18
s_lshl_b32 s35, s35, 12
v_mfma_f32_16x16x32_bf16 v[148:151], a[112:115], a[12:15], v[148:151]
ds_read_b128 a[96:99], v5 offset:61440
v_mfma_f32_16x16x32_bf16 v[152:155], a[116:119], a[12:15], v[152:155]
buffer_load_dwordx4 a[0:3], v4, s[40:43], s35 offen offset:0 sc1
v_mfma_f32_16x16x32_bf16 v[136:139], a[116:119], a[8:11], v[136:139]
ds_read_b128 a[100:103], v5 offset:62464
v_mfma_f32_16x16x32_bf16 v[140:143], a[120:123], a[8:11], v[140:143]
ds_read_b128 a[104:107], v5 offset:63488
v_mfma_f32_16x16x32_bf16 v[156:159], a[120:123], a[12:15], v[156:159]
ds_read_b128 a[108:111], v5 offset:64512
v_mfma_f32_16x16x32_bf16 v[160:163], a[124:127], a[12:15], v[160:163]
buffer_load_dwordx4 a[4:7], v4, s[40:43], s35 offen offset:1024 sc1
v_mfma_f32_16x16x32_bf16 v[144:147], a[124:127], a[8:11], v[144:147]
s_waitcnt vmcnt(8) lgkmcnt(4)
v_mfma_f32_16x16x32_bf16 v[132:135], a[128:131], a[16:19], v[132:135]
s_cmp_eq_u32 s3, 3
s_cselect_b32 s35, 27, 19
s_lshl_b32 s35, s35, 12
v_mfma_f32_16x16x32_bf16 v[148:151], a[128:131], a[20:23], v[148:151]
ds_read_b128 a[112:115], v6 offset:0
v_mfma_f32_16x16x32_bf16 v[152:155], a[132:135], a[20:23], v[152:155]
buffer_load_dwordx4 a[8:11], v4, s[40:43], s35 offen offset:0 sc1
v_mfma_f32_16x16x32_bf16 v[136:139], a[132:135], a[16:19], v[136:139]
ds_read_b128 a[116:119], v6 offset:1024
v_mfma_f32_16x16x32_bf16 v[140:143], a[136:139], a[16:19], v[140:143]
ds_read_b128 a[120:123], v6 offset:2048
v_mfma_f32_16x16x32_bf16 v[156:159], a[136:139], a[20:23], v[156:159]
ds_read_b128 a[124:127], v6 offset:3072
v_mfma_f32_16x16x32_bf16 v[160:163], a[140:143], a[20:23], v[160:163]
buffer_load_dwordx4 a[12:15], v4, s[40:43], s35 offen offset:1024 sc1
v_mfma_f32_16x16x32_bf16 v[144:147], a[140:143], a[16:19], v[144:147]
s_waitcnt vmcnt(8) lgkmcnt(4)
v_mfma_f32_16x16x32_bf16 v[132:135], a[96:99], a[24:27], v[132:135]
s_cmp_eq_u32 s3, 4
s_cselect_b32 s35, 28, 20
s_lshl_b32 s35, s35, 12
v_mfma_f32_16x16x32_bf16 v[148:151], a[96:99], a[28:31], v[148:151]
ds_read_b128 a[128:131], v6 offset:4096
v_mfma_f32_16x16x32_bf16 v[152:155], a[100:103], a[28:31], v[152:155]
buffer_load_dwordx4 a[16:19], v4, s[40:43], s35 offen offset:0 sc1
v_mfma_f32_16x16x32_bf16 v[136:139], a[100:103], a[24:27], v[136:139]
ds_read_b128 a[132:135], v6 offset:5120
v_mfma_f32_16x16x32_bf16 v[140:143], a[104:107], a[24:27], v[140:143]
ds_read_b128 a[136:139], v6 offset:6144
v_mfma_f32_16x16x32_bf16 v[156:159], a[104:107], a[28:31], v[156:159]
ds_read_b128 a[140:143], v6 offset:7168
v_mfma_f32_16x16x32_bf16 v[160:163], a[108:111], a[28:31], v[160:163]
buffer_load_dwordx4 a[20:23], v4, s[40:43], s35 offen offset:1024 sc1
v_mfma_f32_16x16x32_bf16 v[144:147], a[108:111], a[24:27], v[144:147]
s_waitcnt vmcnt(8) lgkmcnt(4)
v_mfma_f32_16x16x32_bf16 v[132:135], a[112:115], a[32:35], v[132:135]
s_cmp_eq_u32 s3, 5
s_cselect_b32 s35, 29, 21
s_lshl_b32 s35, s35, 12
v_mfma_f32_16x16x32_bf16 v[148:151], a[112:115], a[36:39], v[148:151]
ds_read_b128 a[96:99], v6 offset:8192
v_mfma_f32_16x16x32_bf16 v[152:155], a[116:119], a[36:39], v[152:155]
buffer_load_dwordx4 a[24:27], v4, s[40:43], s35 offen offset:0 sc1
v_mfma_f32_16x16x32_bf16 v[136:139], a[116:119], a[32:35], v[136:139]
ds_read_b128 a[100:103], v6 offset:9216
v_mfma_f32_16x16x32_bf16 v[140:143], a[120:123], a[32:35], v[140:143]
ds_read_b128 a[104:107], v6 offset:10240
L_stub14:
s_cbranch_execz L_wret5
v_mfma_f32_16x16x32_bf16 v[156:159], a[120:123], a[36:39], v[156:159]
ds_read_b128 a[108:111], v6 offset:11264
v_mfma_f32_16x16x32_bf16 v[160:163], a[124:127], a[36:39], v[160:163]
buffer_load_dwordx4 a[28:31], v4, s[40:43], s35 offen offset:1024 sc1
v_mfma_f32_16x16x32_bf16 v[144:147], a[124:127], a[32:35], v[144:147]
s_waitcnt vmcnt(8) lgkmcnt(4)
v_mfma_f32_16x16x32_bf16 v[132:135], a[128:131], a[40:43], v[132:135]
s_cmp_eq_u32 s3, 6
s_cselect_b32 s35, 30, 22
s_lshl_b32 s35, s35, 12
v_mfma_f32_16x16x32_bf16 v[148:151], a[128:131], a[44:47], v[148:151]
ds_read_b128 a[112:115], v6 offset:12288
v_mfma_f32_16x16x32_bf16 v[152:155], a[132:135], a[44:47], v[152:155]
buffer_load_dwordx4 a[32:35], v4, s[40:43], s35 offen offset:0 sc1
v_mfma_f32_16x16x32_bf16 v[136:139], a[132:135], a[40:43], v[136:139]
ds_read_b128 a[116:119], v6 offset:13312
v_mfma_f32_16x16x32_bf16 v[140:143], a[136:139], a[40:43], v[140:143]
ds_read_b128 a[120:123], v6 offset:14336
v_mfma_f32_16x16x32_bf16 v[156:159], a[136:139], a[44:47], v[156:159]
ds_read_b128 a[124:127], v6 offset:15360
v_mfma_f32_16x16x32_bf16 v[160:163], a[140:143], a[44:47], v[160:163]
buffer_load_dwordx4 a[36:39], v4, s[40:43], s35 offen offset:1024 sc1
v_mfma_f32_16x16x32_bf16 v[144:147], a[140:143], a[40:43], v[144:147]
s_waitcnt vmcnt(8) lgkmcnt(4)
v_mfma_f32_16x16x32_bf16 v[132:135], a[96:99], a[0:3], v[132:135]
s_cmp_eq_u32 s3, 7
s_cselect_b32 s35, 31, 23
s_lshl_b32 s35, s35, 12
v_mfma_f32_16x16x32_bf16 v[148:151], a[96:99], a[4:7], v[148:151]
ds_read_b128 a[128:131], v6 offset:16384
v_mfma_f32_16x16x32_bf16 v[152:155], a[100:103], a[4:7], v[152:155]
buffer_load_dwordx4 a[40:43], v4, s[40:43], s35 offen offset:0 sc1
v_mfma_f32_16x16x32_bf16 v[136:139], a[100:103], a[0:3], v[136:139]
ds_read_b128 a[132:135], v6 offset:17408
v_mfma_f32_16x16x32_bf16 v[140:143], a[104:107], a[0:3], v[140:143]
ds_read_b128 a[136:139], v6 offset:18432
v_mfma_f32_16x16x32_bf16 v[156:159], a[104:107], a[4:7], v[156:159]
ds_read_b128 a[140:143], v6 offset:19456
v_mfma_f32_16x16x32_bf16 v[160:163], a[108:111], a[4:7], v[160:163]
buffer_load_dwordx4 a[44:47], v4, s[40:43], s35 offen offset:1024 sc1
v_mfma_f32_16x16x32_bf16 v[144:147], a[108:111], a[0:3], v[144:147]
s_waitcnt vmcnt(8) lgkmcnt(4)
v_mfma_f32_16x16x32_bf16 v[132:135], a[112:115], a[8:11], v[132:135]
s_cmp_eq_u32 s3, 0
s_cselect_b32 s35, 0, 24
s_lshl_b32 s35, s35, 12
v_mfma_f32_16x16x32_bf16 v[148:151], a[112:115], a[12:15], v[148:151]
ds_read_b128 a[96:99], v6 offset:20480
v_mfma_f32_16x16x32_bf16 v[152:155], a[116:119], a[12:15], v[152:155]
buffer_load_dwordx4 a[0:3], v4, s[40:43], s35 offen offset:0 sc1
v_mfma_f32_16x16x32_bf16 v[136:139], a[116:119], a[8:11], v[136:139]
ds_read_b128 a[100:103], v6 offset:21504
v_mfma_f32_16x16x32_bf16 v[140:143], a[120:123], a[8:11], v[140:143]
ds_read_b128 a[104:107], v6 offset:22528
v_mfma_f32_16x16x32_bf16 v[156:159], a[120:123], a[12:15], v[156:159]
ds_read_b128 a[108:111], v6 offset:23552
v_mfma_f32_16x16x32_bf16 v[160:163], a[124:127], a[12:15], v[160:163]
buffer_load_dwordx4 a[4:7], v4, s[40:43], s35 offen offset:1024 sc1
v_mfma_f32_16x16x32_bf16 v[144:147], a[124:127], a[8:11], v[144:147]
s_waitcnt vmcnt(8) lgkmcnt(4)
v_mfma_f32_16x16x32_bf16 v[132:135], a[128:131], a[16:19], v[132:135]
s_cmp_eq_u32 s3, 1
s_cselect_b32 s35, 1, 25
s_lshl_b32 s35, s35, 12
v_mfma_f32_16x16x32_bf16 v[148:151], a[128:131], a[20:23], v[148:151]
ds_read_b128 a[112:115], v6 offset:24576
v_mfma_f32_16x16x32_bf16 v[152:155], a[132:135], a[20:23], v[152:155]
buffer_load_dwordx4 a[8:11], v4, s[40:43], s35 offen offset:0 sc1
v_mfma_f32_16x16x32_bf16 v[136:139], a[132:135], a[16:19], v[136:139]
ds_read_b128 a[116:119], v6 offset:25600
v_mfma_f32_16x16x32_bf16 v[140:143], a[136:139], a[16:19], v[140:143]
ds_read_b128 a[120:123], v6 offset:26624
v_mfma_f32_16x16x32_bf16 v[156:159], a[136:139], a[20:23], v[156:159]
ds_read_b128 a[124:127], v6 offset:27648
v_mfma_f32_16x16x32_bf16 v[160:163], a[140:143], a[20:23], v[160:163]
buffer_load_dwordx4 a[12:15], v4, s[40:43], s35 offen offset:1024 sc1
v_mfma_f32_16x16x32_bf16 v[144:147], a[140:143], a[16:19], v[144:147]
s_waitcnt vmcnt(8) lgkmcnt(4)
v_mfma_f32_16x16x32_bf16 v[132:135], a[96:99], a[24:27], v[132:135]
s_cmp_eq_u32 s3, 2
s_cselect_b32 s35, 2, 26
s_lshl_b32 s35, s35, 12
v_mfma_f32_16x16x32_bf16 v[148:151], a[96:99], a[28:31], v[148:151]
ds_read_b128 a[128:131], v6 offset:28672
v_mfma_f32_16x16x32_bf16 v[152:155], a[100:103], a[28:31], v[152:155]
buffer_load_dwordx4 a[16:19], v4, s[40:43], s35 offen offset:0 sc1
v_mfma_f32_16x16x32_bf16 v[136:139], a[100:103], a[24:27], v[136:139]
ds_read_b128 a[132:135], v6 offset:29696
v_mfma_f32_16x16x32_bf16 v[140:143], a[104:107], a[24:27], v[140:143]
ds_read_b128 a[136:139], v6 offset:30720
v_mfma_f32_16x16x32_bf16 v[156:159], a[104:107], a[28:31], v[156:159]
ds_read_b128 a[140:143], v6 offset:31744
v_mfma_f32_16x16x32_bf16 v[160:163], a[108:111], a[28:31], v[160:163]
buffer_load_dwordx4 a[20:23], v4, s[40:43], s35 offen offset:1024 sc1
v_mfma_f32_16x16x32_bf16 v[144:147], a[108:111], a[24:27], v[144:147]
s_waitcnt vmcnt(8) lgkmcnt(4)
v_mfma_f32_16x16x32_bf16 v[132:135], a[112:115], a[32:35], v[132:135]
s_cmp_eq_u32 s3, 3
s_cselect_b32 s35, 3, 27
s_lshl_b32 s35, s35, 12
v_mfma_f32_16x16x32_bf16 v[148:151], a[112:115], a[36:39], v[148:151]
ds_read_b128 a[96:99], v6 offset:32768
v_mfma_f32_16x16x32_bf16 v[152:155], a[116:119], a[36:39], v[152:155]
buffer_load_dwordx4 a[24:27], v4, s[40:43], s35 offen offset:0 sc1
v_mfma_f32_16x16x32_bf16 v[136:139], a[116:119], a[32:35], v[136:139]
ds_read_b128 a[100:103], v6 offset:33792
v_mfma_f32_16x16x32_bf16 v[140:143], a[120:123], a[32:35], v[140:143]
ds_read_b128 a[104:107], v6 offset:34816
v_mfma_f32_16x16x32_bf16 v[156:159], a[120:123], a[36:39], v[156:159]
ds_read_b128 a[108:111], v6 offset:35840
v_mfma_f32_16x16x32_bf16 v[160:163], a[124:127], a[36:39], v[160:163]
buffer_load_dwordx4 a[28:31], v4, s[40:43], s35 offen offset:1024 sc1
v_mfma_f32_16x16x32_bf16 v[144:147], a[124:127], a[32:35], v[144:147]
s_waitcnt vmcnt(8) lgkmcnt(4)
v_mfma_f32_16x16x32_bf16 v[132:135], a[128:131], a[40:43], v[132:135]
s_cmp_eq_u32 s3, 4
s_cselect_b32 s35, 4, 28
s_lshl_b32 s35, s35, 12
v_mfma_f32_16x16x32_bf16 v[148:151], a[128:131], a[44:47], v[148:151]
ds_read_b128 a[112:115], v6 offset:36864
v_mfma_f32_16x16x32_bf16 v[152:155], a[132:135], a[44:47], v[152:155]
buffer_load_dwordx4 a[32:35], v4, s[40:43], s35 offen offset:0 sc1
v_mfma_f32_16x16x32_bf16 v[136:139], a[132:135], a[40:43], v[136:139]
ds_read_b128 a[116:119], v6 offset:37888
v_mfma_f32_16x16x32_bf16 v[140:143], a[136:139], a[40:43], v[140:143]
ds_read_b128 a[120:123], v6 offset:38912
v_mfma_f32_16x16x32_bf16 v[156:159], a[136:139], a[44:47], v[156:159]
ds_read_b128 a[124:127], v6 offset:39936
v_mfma_f32_16x16x32_bf16 v[160:163], a[140:143], a[44:47], v[160:163]
buffer_load_dwordx4 a[36:39], v4, s[40:43], s35 offen offset:1024 sc1
v_mfma_f32_16x16x32_bf16 v[144:147], a[140:143], a[40:43], v[144:147]
s_waitcnt vmcnt(8) lgkmcnt(4)
v_mfma_f32_16x16x32_bf16 v[132:135], a[96:99], a[0:3], v[132:135]
s_cmp_eq_u32 s3, 5
s_cselect_b32 s35, 5, 29
s_lshl_b32 s35, s35, 12
v_mfma_f32_16x16x32_bf16 v[148:151], a[96:99], a[4:7], v[148:151]
ds_read_b128 a[128:131], v6 offset:40960
v_mfma_f32_16x16x32_bf16 v[152:155], a[100:103], a[4:7], v[152:155]
buffer_load_dwordx4 a[40:43], v4, s[40:43], s35 offen offset:0 sc1
v_mfma_f32_16x16x32_bf16 v[136:139], a[100:103], a[0:3], v[136:139]
ds_read_b128 a[132:135], v6 offset:41984
v_mfma_f32_16x16x32_bf16 v[140:143], a[104:107], a[0:3], v[140:143]
ds_read_b128 a[136:139], v6 offset:43008
v_mfma_f32_16x16x32_bf16 v[156:159], a[104:107], a[4:7], v[156:159]
ds_read_b128 a[140:143], v6 offset:44032
v_mfma_f32_16x16x32_bf16 v[160:163], a[108:111], a[4:7], v[160:163]
buffer_load_dwordx4 a[44:47], v4, s[40:43], s35 offen offset:1024 sc1
v_mfma_f32_16x16x32_bf16 v[144:147], a[108:111], a[0:3], v[144:147]
s_waitcnt vmcnt(8) lgkmcnt(4)
v_mfma_f32_16x16x32_bf16 v[132:135], a[112:115], a[8:11], v[132:135]
s_cmp_eq_u32 s3, 6
s_cselect_b32 s35, 6, 30
s_lshl_b32 s35, s35, 12
v_mfma_f32_16x16x32_bf16 v[148:151], a[112:115], a[12:15], v[148:151]
ds_read_b128 a[96:99], v6 offset:45056
v_mfma_f32_16x16x32_bf16 v[152:155], a[116:119], a[12:15], v[152:155]
buffer_load_dwordx4 a[0:3], v4, s[40:43], s35 offen offset:0 sc1
v_mfma_f32_16x16x32_bf16 v[136:139], a[116:119], a[8:11], v[136:139]
ds_read_b128 a[100:103], v6 offset:46080
v_mfma_f32_16x16x32_bf16 v[140:143], a[120:123], a[8:11], v[140:143]
ds_read_b128 a[104:107], v6 offset:47104
v_mfma_f32_16x16x32_bf16 v[156:159], a[120:123], a[12:15], v[156:159]
ds_read_b128 a[108:111], v6 offset:48128
v_mfma_f32_16x16x32_bf16 v[160:163], a[124:127], a[12:15], v[160:163]
buffer_load_dwordx4 a[4:7], v4, s[40:43], s35 offen offset:1024 sc1
v_mfma_f32_16x16x32_bf16 v[144:147], a[124:127], a[8:11], v[144:147]
s_waitcnt vmcnt(8) lgkmcnt(4)
v_mfma_f32_16x16x32_bf16 v[132:135], a[128:131], a[16:19], v[132:135]
s_cmp_eq_u32 s3, 7
s_cselect_b32 s35, 7, 31
s_lshl_b32 s35, s35, 12
v_mfma_f32_16x16x32_bf16 v[148:151], a[128:131], a[20:23], v[148:151]
ds_read_b128 a[112:115], v6 offset:49152
v_mfma_f32_16x16x32_bf16 v[152:155], a[132:135], a[20:23], v[152:155]
buffer_load_dwordx4 a[8:11], v4, s[40:43], s35 offen offset:0 sc1
v_mfma_f32_16x16x32_bf16 v[136:139], a[132:135], a[16:19], v[136:139]
ds_read_b128 a[116:119], v6 offset:50176
v_mfma_f32_16x16x32_bf16 v[140:143], a[136:139], a[16:19], v[140:143]
ds_read_b128 a[120:123], v6 offset:51200
v_mfma_f32_16x16x32_bf16 v[156:159], a[136:139], a[20:23], v[156:159]
ds_read_b128 a[124:127], v6 offset:52224
v_mfma_f32_16x16x32_bf16 v[160:163], a[140:143], a[20:23], v[160:163]
buffer_load_dwordx4 a[12:15], v4, s[40:43], s35 offen offset:1024 sc1
v_mfma_f32_16x16x32_bf16 v[144:147], a[140:143], a[16:19], v[144:147]
s_waitcnt vmcnt(8) lgkmcnt(4)
v_mfma_f32_16x16x32_bf16 v[132:135], a[96:99], a[24:27], v[132:135]
ds_read_b128 a[128:131], v6 offset:53248
v_mfma_f32_16x16x32_bf16 v[148:151], a[96:99], a[28:31], v[148:151]
ds_read_b128 a[132:135], v6 offset:54272
v_mfma_f32_16x16x32_bf16 v[152:155], a[100:103], a[28:31], v[152:155]
ds_read_b128 a[136:139], v6 offset:55296
v_mfma_f32_16x16x32_bf16 v[136:139], a[100:103], a[24:27], v[136:139]
ds_read_b128 a[140:143], v6 offset:56320
v_mfma_f32_16x16x32_bf16 v[140:143], a[104:107], a[24:27], v[140:143]
v_mfma_f32_16x16x32_bf16 v[156:159], a[104:107], a[28:31], v[156:159]
buffer_atomic_add v12, v10, s[4:7], s92 offen sc1
v_mfma_f32_16x16x32_bf16 v[160:163], a[108:111], a[28:31], v[160:163]
v_mfma_f32_16x16x32_bf16 v[144:147], a[108:111], a[24:27], v[144:147]
s_waitcnt vmcnt(7) lgkmcnt(4)
v_mfma_f32_16x16x32_bf16 v[132:135], a[112:115], a[32:35], v[132:135]
ds_read_b128 a[96:99], v6 offset:57344
v_mfma_f32_16x16x32_bf16 v[148:151], a[112:115], a[36:39], v[148:151]
ds_read_b128 a[100:103], v6 offset:58368
v_mfma_f32_16x16x32_bf16 v[152:155], a[116:119], a[36:39], v[152:155]
ds_read_b128 a[104:107], v6 offset:59392
v_mfma_f32_16x16x32_bf16 v[136:139], a[116:119], a[32:35], v[136:139]
ds_read_b128 a[108:111], v6 offset:60416
v_mfma_f32_16x16x32_bf16 v[140:143], a[120:123], a[32:35], v[140:143]
v_mfma_f32_16x16x32_bf16 v[156:159], a[120:123], a[36:39], v[156:159]
v_mfma_f32_16x16x32_bf16 v[160:163], a[124:127], a[36:39], v[160:163]
v_mfma_f32_16x16x32_bf16 v[144:147], a[124:127], a[32:35], v[144:147]
s_waitcnt vmcnt(5) lgkmcnt(4)
v_mfma_f32_16x16x32_bf16 v[132:135], a[128:131], a[40:43], v[132:135]
ds_read_b128 a[112:115], v6 offset:61440
v_mfma_f32_16x16x32_bf16 v[148:151], a[128:131], a[44:47], v[148:151]
ds_read_b128 a[116:119], v6 offset:62464
v_mfma_f32_16x16x32_bf16 v[152:155], a[132:135], a[44:47], v[152:155]
ds_read_b128 a[120:123], v6 offset:63488
v_mfma_f32_16x16x32_bf16 v[136:139], a[132:135], a[40:43], v[136:139]
ds_read_b128 a[124:127], v6 offset:64512
v_mfma_f32_16x16x32_bf16 v[140:143], a[136:139], a[40:43], v[140:143]
v_mfma_f32_16x16x32_bf16 v[156:159], a[136:139], a[44:47], v[156:159]
v_mfma_f32_16x16x32_bf16 v[160:163], a[140:143], a[44:47], v[160:163]
v_mfma_f32_16x16x32_bf16 v[144:147], a[140:143], a[40:43], v[144:147]
s_waitcnt vmcnt(3) lgkmcnt(4)
v_mfma_f32_16x16x32_bf16 v[132:135], a[96:99], a[0:3], v[132:135]
v_mfma_f32_16x16x32_bf16 v[148:151], a[96:99], a[4:7], v[148:151]
v_mfma_f32_16x16x32_bf16 v[152:155], a[100:103], a[4:7], v[152:155]
v_mfma_f32_16x16x32_bf16 v[136:139], a[100:103], a[0:3], v[136:139]
v_mfma_f32_16x16x32_bf16 v[140:143], a[104:107], a[0:3], v[140:143]
v_mfma_f32_16x16x32_bf16 v[156:159], a[104:107], a[4:7], v[156:159]
v_mfma_f32_16x16x32_bf16 v[160:163], a[108:111], a[4:7], v[160:163]
v_mfma_f32_16x16x32_bf16 v[144:147], a[108:111], a[0:3], v[144:147]
s_waitcnt vmcnt(1) lgkmcnt(0)
v_mfma_f32_16x16x32_bf16 v[132:135], a[112:115], a[8:11], v[132:135]
v_mfma_f32_16x16x32_bf16 v[148:151], a[112:115], a[12:15], v[148:151]
v_mfma_f32_16x16x32_bf16 v[152:155], a[116:119], a[12:15], v[152:155]
v_mfma_f32_16x16x32_bf16 v[136:139], a[116:119], a[8:11], v[136:139]
v_mfma_f32_16x16x32_bf16 v[140:143], a[120:123], a[8:11], v[140:143]
v_mfma_f32_16x16x32_bf16 v[156:159], a[120:123], a[12:15], v[156:159]
v_mfma_f32_16x16x32_bf16 v[160:163], a[124:127], a[12:15], v[160:163]
v_mfma_f32_16x16x32_bf16 v[144:147], a[124:127], a[8:11], v[144:147]
s_nop 1
v_cmp_u_f32 vcc, v132, v148
s_nop 0
s_and_b32 vcc_lo, vcc_lo, s95
s_cbranch_scc1 L_k2redo2
s_lshl_b32 s36, s32, 13
v_cvt_pk_bf16_f32 v32, v132, v133
v_cvt_pk_bf16_f32 v33, v134, v135
v_cvt_pk_bf16_f32 v34, v136, v137
v_cvt_pk_bf16_f32 v35, v138, v139
s_add_u32 s36, s36, 0x2200000
buffer_store_dwordx4 v[32:35], v4, s[4:7], s36 offen offset:0 sc1
v_cvt_pk_bf16_f32 v40, v148, v149
v_cvt_pk_bf16_f32 v41, v150, v151
v_cvt_pk_bf16_f32 v42, v152, v153
v_cvt_pk_bf16_f32 v43, v154, v155
v_cvt_pk_bf16_f32 v36, v140, v141
v_cvt_pk_bf16_f32 v37, v142, v143
v_cvt_pk_bf16_f32 v38, v144, v145
v_cvt_pk_bf16_f32 v39, v146, v147
s_add_u32 s37, s36, 4096
v_cvt_pk_bf16_f32 v44, v156, v157
v_cvt_pk_bf16_f32 v45, v158, v159
v_cvt_pk_bf16_f32 v46, v160, v161
buffer_store_dwordx4 v[40:43], v4, s[4:7], s36 offen offset:1024 sc1
v_cvt_pk_bf16_f32 v47, v162, v163
v_mfma_f32_16x16x32_bf16 v[96:99], v[32:35], v[32:35], 0
s_mov_b32 s38, 0x2c0000
s_add_u32 s92, s78, 0x60000
v_mfma_f32_16x16x32_bf16 v[92:95], v[16:19], v[32:35], 0
s_add_u32 s93, s79, 0x60000
s_add_u32 s40, s4, 0x2200000
v_mfma_f32_16x16x32_bf16 v[96:99], v[36:39], v[36:39], v[96:99]
s_addc_u32 s41, s5, 0
buffer_store_dwordx4 v[36:39], v4, s[4:7], s37 offen offset:0 sc1
v_mfma_f32_16x16x32_bf16 v[92:95], v[16:19], v[36:39], v[92:95]
s_nop 4
v_cndmask_b32 v96, v96, v97, s[46:47]
v_cndmask_b32 v98, v98, v99, s[46:47]
v_mfma_f32_16x16x32_bf16 v[104:107], v[40:43], v[40:43], 0
v_mfma_f32_16x16x32_bf16 v[100:103], v[16:19], v[40:43], 0
v_cndmask_b32 v93, v96, v98, s[48:49]
buffer_store_dwordx4 v[44:47], v4, s[4:7], s37 offen offset:1024 sc1
v_mfma_f32_16x16x32_bf16 v[104:107], v[44:47], v[44:47], v[104:107]
v_mfma_f32_16x16x32_bf16 v[100:103], v[16:19], v[44:47], v[100:103]
s_nop 6
v_cndmask_b32 v104, v104, v105, s[46:47]
v_cndmask_b32 v106, v106, v107, s[46:47]
buffer_store_dwordx2 v[92:93], v253, s[4:7], s38 offen offset:0 sc1
v_cndmask_b32 v101, v104, v106, s[48:49]
buffer_store_dwordx2 v[100:101], v253, s[4:7], s38 offen offset:2048 sc1
s_barrier
s_add_u32 m0, s18, 0x0
s_add_u32 s44, s50, 0x1400000
buffer_load_dwordx4 v1, s[4:7], s44 offen offset:0 sc1 lds
buffer_load_dwordx4 v1, s[4:7], s44 offen offset:1024 sc1 lds
buffer_load_dwordx4 v1, s[4:7], s44 offen offset:2048 sc1 lds
s_add_u32 m0, s18, 0x3000
s_add_u32 s44, s50, 0x1403000
buffer_load_dwordx4 v1, s[4:7], s44 offen offset:0 sc1 lds
buffer_load_dwordx4 v1, s[4:7], s44 offen offset:1024 sc1 lds
buffer_load_dwordx4 v1, s[4:7], s44 offen offset:2048 sc1 lds
v_accvgpr_read_b32 v48, a216
v_accvgpr_read_b32 v49, a217
v_accvgpr_read_b32 v50, a218
v_accvgpr_read_b32 v51, a219
v_accvgpr_read_b32 v52, a220
v_accvgpr_read_b32 v53, a221
v_accvgpr_read_b32 v54, a222
v_accvgpr_read_b32 v55, a223
v_accvgpr_read_b32 v56, a224
v_accvgpr_read_b32 v57, a225
v_accvgpr_read_b32 v58, a226
v_accvgpr_read_b32 v59, a227
v_accvgpr_read_b32 v60, a228
v_accvgpr_read_b32 v61, a229
v_accvgpr_read_b32 v62, a230
v_accvgpr_read_b32 v63, a231
v_accvgpr_read_b32 v64, a232
v_accvgpr_read_b32 v65, a233
v_accvgpr_read_b32 v66, a234
v_accvgpr_read_b32 v67, a235
v_accvgpr_read_b32 v68, a236
v_accvgpr_read_b32 v69, a237
v_accvgpr_read_b32 v70, a238
v_accvgpr_read_b32 v71, a239
s_waitcnt vmcnt(6)
s_barrier
s_cmp_lg_u32 s28, 1
s_cbranch_scc1 Lsg_29
buffer_atomic_add v12, v10, s[4:7], s92 offen sc1
Lsg_29:
s_mov_b64 exec, 0
s_cmp_eq_u32 s28, 1
s_cbranch_scc1 L_stub15
L_wret6:
s_mov_b64 exec, -1
s_cmp_lt_u32 s28, 2
s_cbranch_scc1 Lwd_30
s_add_u32 m0, s18, 0x4800
s_add_u32 s44, s50, 0x1404800
buffer_load_dwordx4 v1, s[4:7], s44 offen offset:0 sc1 lds
buffer_load_dwordx4 v1, s[4:7], s44 offen offset:1024 sc1 lds
buffer_load_dwordx4 v1, s[4:7], s44 offen offset:2048 sc1 lds
s_add_u32 m0, s18, 0x6000
s_add_u32 s44, s50, 0x1406000
buffer_load_dwordx4 v1, s[4:7], s44 offen offset:0 sc1 lds
buffer_load_dwordx4 v1, s[4:7], s44 offen offset:1024 sc1 lds
buffer_load_dwordx4 v1, s[4:7], s44 offen offset:2048 sc1 lds
s_add_u32 m0, s18, 0x7800
s_add_u32 s44, s50, 0x1407800
buffer_load_dwordx4 v1, s[4:7], s44 offen offset:0 sc1 lds
buffer_load_dwordx4 v1, s[4:7], s44 offen offset:1024 sc1 lds
buffer_load_dwordx4 v1, s[4:7], s44 offen offset:2048 sc1 lds
s_add_u32 m0, s18, 0x9000
s_add_u32 s44, s50, 0x1409000
buffer_load_dwordx4 v1, s[4:7], s44 offen offset:0 sc1 lds
buffer_load_dwordx4 v1, s[4:7], s44 offen offset:1024 sc1 lds
buffer_load_dwordx4 v1, s[4:7], s44 offen offset:2048 sc1 lds
s_add_u32 m0, s18, 0xa800
s_add_u32 s44, s50, 0x140a800
buffer_load_dwordx4 v1, s[4:7], s44 offen offset:0 sc1 lds
buffer_load_dwordx4 v1, s[4:7], s44 offen offset:1024 sc1 lds
buffer_load_dwordx4 v1, s[4:7], s44 offen offset:2048 sc1 lds
s_add_u32 m0, s18, 0xc000
s_add_u32 s44, s50, 0x140c000
buffer_load_dwordx4 v1, s[4:7], s44 offen offset:0 sc1 lds
buffer_load_dwordx4 v1, s[4:7], s44 offen offset:1024 sc1 lds
buffer_load_dwordx4 v1, s[4:7], s44 offen offset:2048 sc1 lds
s_add_u32 m0, s18, 0xd800
s_add_u32 s44, s50, 0x140d800
buffer_load_dwordx4 v1, s[4:7], s44 offen offset:0 sc1 lds
buffer_load_dwordx4 v1, s[4:7], s44 offen offset:1024 sc1 lds
buffer_load_dwordx4 v1, s[4:7], s44 offen offset:2048 sc1 lds
s_add_u32 m0, s18, 0xf000
s_add_u32 s44, s50, 0x140f000
buffer_load_dwordx4 v1, s[4:7], s44 offen offset:0 sc1 lds
buffer_load_dwordx4 v1, s[4:7], s44 offen offset:1024 sc1 lds
buffer_load_dwordx4 v1, s[4:7], s44 offen offset:2048 sc1 lds
s_add_u32 m0, s18, 0x10800
s_add_u32 s44, s50, 0x1410800
buffer_load_dwordx4 v1, s[4:7], s44 offen offset:0 sc1 lds
buffer_load_dwordx4 v1, s[4:7], s44 offen offset:1024 sc1 lds
buffer_load_dwordx4 v1, s[4:7], s44 offen offset:2048 sc1 lds
s_add_u32 m0, s18, 0x12000
s_add_u32 s44, s50, 0x1412000
buffer_load_dwordx4 v1, s[4:7], s44 offen offset:0 sc1 lds
buffer_load_dwordx4 v1, s[4:7], s44 offen offset:1024 sc1 lds
buffer_load_dwordx4 v1, s[4:7], s44 offen offset:2048 sc1 lds
s_add_u32 m0, s18, 0x13800
s_add_u32 s44, s50, 0x1413800
buffer_load_dwordx4 v1, s[4:7], s44 offen offset:0 sc1 lds
buffer_load_dwordx4 v1, s[4:7], s44 offen offset:1024 sc1 lds
buffer_load_dwordx4 v1, s[4:7], s44 offen offset:2048 sc1 lds
s_add_u32 m0, s18, 0x15000
s_add_u32 s44, s50, 0x1415000
buffer_load_dwordx4 v1, s[4:7], s44 offen offset:0 sc1 lds
buffer_load_dwordx4 v1, s[4:7], s44 offen offset:1024 sc1 lds
buffer_load_dwordx4 v1, s[4:7], s44 offen offset:2048 sc1 lds
s_add_u32 m0, s18, 0x16800
s_add_u32 s44, s50, 0x1416800
buffer_load_dwordx4 v1, s[4:7], s44 offen offset:0 sc1 lds
buffer_load_dwordx4 v1, s[4:7], s44 offen offset:1024 sc1 lds
buffer_load_dwordx4 v1, s[4:7], s44 offen offset:2048 sc1 lds
s_add_u32 m0, s18, 0x18000
s_add_u32 s44, s50, 0x1418000
buffer_load_dwordx4 v1, s[4:7], s44 offen offset:0 sc1 lds
buffer_load_dwordx4 v1, s[4:7], s44 offen offset:1024 sc1 lds
buffer_load_dwordx4 v1, s[4:7], s44 offen offset:2048 sc1 lds
s_add_u32 m0, s18, 0x19800
s_add_u32 s44, s50, 0x1419800
buffer_load_dwordx4 v1, s[4:7], s44 offen offset:0 sc1 lds
buffer_load_dwordx4 v1, s[4:7], s44 offen offset:1024 sc1 lds
buffer_load_dwordx4 v1, s[4:7], s44 offen offset:2048 sc1 lds
s_add_u32 m0, s18, 0x1b000
s_add_u32 s44, s50, 0x141b000
buffer_load_dwordx4 v1, s[4:7], s44 offen offset:0 sc1 lds
buffer_load_dwordx4 v1, s[4:7], s44 offen offset:1024 sc1 lds
buffer_load_dwordx4 v1, s[4:7], s44 offen offset:2048 sc1 lds
Lwd_30:
s_cmp_lg_u32 s28, 0
s_cbranch_scc1 Lpe_32
s_add_u32 s36, s67, 0x60000
s_mov_b32 s37, 0
Lpoll_31:
v_mov_b32 v11, 0
buffer_atomic_add v11, v251, s[4:7], s36 offen sc0 sc1
s_add_u32 s37, s37, 1
s_waitcnt vmcnt(0)
v_readfirstlane_b32 s38, v11
s_nop 0
s_cmp_ge_u32 s38, 32
s_cbranch_scc1 Lpe_32
s_cmp_lt_u32 s37, 0x100000
s_cbranch_scc1 Lpoll_31
Lpe_32:
s_waitcnt vmcnt(36) lgkmcnt(0)
s_cmp_ge_u32 s28, 2
s_cbranch_scc1 Lw_33
s_waitcnt vmcnt(0)
Lw_33:
s_barrier
s_add_u32 s94, s80, 0x90080
s_mov_b32 s35, 0
s_mov_b32 s33, 0x1000
buffer_load_dwordx4 a[0:3], v2, s[40:43], s35 offen offset:0 sc1
buffer_load_dwordx4 a[4:7], v2, s[40:43], s33 offen offset:0 sc1
buffer_load_dwordx4 a[8:11], v2, s[40:43], s35 offen offset:1024 sc1
buffer_load_dwordx4 a[12:15], v2, s[40:43], s33 offen offset:1024 sc1
buffer_load_dwordx4 a[16:19], v2, s[40:43], s35 offen offset:2048 sc1
buffer_load_dwordx4 a[20:23], v2, s[40:43], s33 offen offset:2048 sc1
buffer_load_dwordx4 a[24:27], v2, s[40:43], s35 offen offset:3072 sc1
buffer_load_dwordx4 a[28:31], v2, s[40:43], s33 offen offset:3072 sc1
s_add_u32 s35, s35, 8192
s_add_u32 s33, s33, 8192
buffer_load_dwordx4 a[32:35], v2, s[40:43], s35 offen offset:0 sc1
buffer_load_dwordx4 a[36:39], v2, s[40:43], s33 offen offset:0 sc1
buffer_load_dwordx4 a[40:43], v2, s[40:43], s35 offen offset:1024 sc1
buffer_load_dwordx4 a[44:47], v2, s[40:43], s33 offen offset:1024 sc1
buffer_load_dwordx4 a[48:51], v2, s[40:43], s35 offen offset:2048 sc1
buffer_load_dwordx4 a[52:55], v2, s[40:43], s33 offen offset:2048 sc1
buffer_load_dwordx4 a[56:59], v2, s[40:43], s35 offen offset:3072 sc1
buffer_load_dwordx4 a[60:63], v2, s[40:43], s33 offen offset:3072 sc1
s_add_u32 s35, s35, 8192
s_add_u32 s33, s33, 8192
v_add_u32 v5, 0, v1
ds_read_b128 a[96:99], v5 offset:2048
ds_read_b128 a[100:103], v5 offset:8192
ds_read_b128 a[104:107], v5 offset:3072
ds_read_b128 a[108:111], v5 offset:9216
ds_read_b128 a[112:115], v5 offset:4096
ds_read_b128 a[116:119], v5 offset:10240
s_waitcnt vmcnt(14) lgkmcnt(4)
v_mfma_f32_16x16x32_bf16 v[140:143], a[96:99], a[0:3], 0
s_add_u32 m0, s18, 0x1e000
s_add_u32 s44, s50, 0x141e000
v_mfma_f32_16x16x32_bf16 v[140:143], a[100:103], a[4:7], v[140:143]
buffer_load_dwordx4 a[64:67], v2, s[40:43], s35 offen offset:0 sc1
s_waitcnt vmcnt(13)
v_mfma_f32_16x16x32_bf16 v[164:167], a[100:103], a[12:15], 0
ds_read_b128 a[128:131], v5 offset:5120
v_mfma_f32_16x16x32_bf16 v[164:167], a[96:99], a[8:11], v[164:167]
ds_read_b128 a[132:135], v5 offset:11264
s_waitcnt vmcnt(12)
v_mfma_f32_16x16x32_bf16 v[188:191], a[96:99], a[16:19], 0
s_waitcnt vmcnt(11)
v_mfma_f32_16x16x32_bf16 v[188:191], a[100:103], a[20:23], v[188:191]
buffer_load_dwordx4 a[68:71], v2, s[40:43], s33 offen offset:0 sc1
s_waitcnt vmcnt(10)
v_mfma_f32_16x16x32_bf16 v[212:215], a[100:103], a[28:31], 0
ds_read_b128 a[136:139], v5 offset:0
v_mfma_f32_16x16x32_bf16 v[212:215], a[96:99], a[24:27], v[212:215]
s_waitcnt lgkmcnt(6)
v_mfma_f32_16x16x32_bf16 v[216:219], a[104:107], a[24:27], 0
ds_read_b128 a[140:143], v5 offset:6144
s_waitcnt lgkmcnt(6)
v_mfma_f32_16x16x32_bf16 v[216:219], a[108:111], a[28:31], v[216:219]
v_mfma_f32_16x16x32_bf16 v[192:195], a[108:111], a[20:23], 0
buffer_load_dwordx4 v1, s[4:7], s44 offen offset:0 sc1 lds
v_mfma_f32_16x16x32_bf16 v[192:195], a[104:107], a[16:19], v[192:195]
ds_read_b128 a[144:147], v5 offset:1024
v_mfma_f32_16x16x32_bf16 v[168:171], a[104:107], a[8:11], 0
v_mfma_f32_16x16x32_bf16 v[168:171], a[108:111], a[12:15], v[168:171]
ds_read_b128 a[148:151], v5 offset:7168
v_mfma_f32_16x16x32_bf16 v[144:147], a[108:111], a[4:7], 0
v_mfma_f32_16x16x32_bf16 v[144:147], a[104:107], a[0:3], v[144:147]
buffer_load_dwordx4 a[72:75], v2, s[40:43], s35 offen offset:1024 sc1
s_waitcnt lgkmcnt(7)
v_mfma_f32_16x16x32_bf16 v[148:151], a[112:115], a[0:3], 0
s_waitcnt lgkmcnt(6)
v_mfma_f32_16x16x32_bf16 v[148:151], a[116:119], a[4:7], v[148:151]
v_mfma_f32_16x16x32_bf16 v[172:175], a[116:119], a[12:15], 0
v_mfma_f32_16x16x32_bf16 v[172:175], a[112:115], a[8:11], v[172:175]
v_mfma_f32_16x16x32_bf16 v[196:199], a[112:115], a[16:19], 0
buffer_load_dwordx4 a[76:79], v2, s[40:43], s33 offen offset:1024 sc1
v_mfma_f32_16x16x32_bf16 v[196:199], a[116:119], a[20:23], v[196:199]
v_mfma_f32_16x16x32_bf16 v[220:223], a[116:119], a[28:31], 0
v_mfma_f32_16x16x32_bf16 v[220:223], a[112:115], a[24:27], v[220:223]
s_waitcnt lgkmcnt(0)
v_mfma_f32_16x16x32_bf16 v[224:227], a[128:131], a[24:27], 0
ds_read_b128 a[96:99], v5 offset:14336
v_mfma_f32_16x16x32_bf16 v[224:227], a[132:135], a[28:31], v[224:227]
buffer_load_dwordx4 a[80:83], v2, s[40:43], s35 offen offset:2048 sc1
v_mfma_f32_16x16x32_bf16 v[200:203], a[132:135], a[20:23], 0
ds_read_b128 a[100:103], v5 offset:20480
v_mfma_f32_16x16x32_bf16 v[200:203], a[128:131], a[16:19], v[200:203]
v_mfma_f32_16x16x32_bf16 v[176:179], a[128:131], a[8:11], 0
v_mfma_f32_16x16x32_bf16 v[176:179], a[132:135], a[12:15], v[176:179]
buffer_load_dwordx4 a[84:87], v2, s[40:43], s33 offen offset:2048 sc1
v_mfma_f32_16x16x32_bf16 v[152:155], a[132:135], a[4:7], 0
ds_read_b128 a[104:107], v5 offset:15360
v_mfma_f32_16x16x32_bf16 v[152:155], a[128:131], a[0:3], v[152:155]
v_mfma_f32_16x16x32_bf16 v[132:135], a[136:139], a[0:3], 0
ds_read_b128 a[108:111], v5 offset:21504
v_mfma_f32_16x16x32_bf16 v[132:135], a[140:143], a[4:7], v[132:135]
v_mfma_f32_16x16x32_bf16 v[156:159], a[140:143], a[12:15], 0
buffer_load_dwordx4 v1, s[4:7], s44 offen offset:1024 sc1 lds
v_mfma_f32_16x16x32_bf16 v[156:159], a[136:139], a[8:11], v[156:159]
ds_read_b128 a[112:115], v5 offset:16384
v_mfma_f32_16x16x32_bf16 v[180:183], a[136:139], a[16:19], 0
v_mfma_f32_16x16x32_bf16 v[180:183], a[140:143], a[20:23], v[180:183]
ds_read_b128 a[116:119], v5 offset:22528
v_mfma_f32_16x16x32_bf16 v[204:207], a[140:143], a[28:31], 0
v_mfma_f32_16x16x32_bf16 v[204:207], a[136:139], a[24:27], v[204:207]
buffer_load_dwordx4 a[88:91], v2, s[40:43], s35 offen offset:3072 sc1
v_mfma_f32_16x16x32_bf16 v[208:211], a[144:147], a[24:27], 0
v_mfma_f32_16x16x32_bf16 v[208:211], a[148:151], a[28:31], v[208:211]
v_mfma_f32_16x16x32_bf16 v[184:187], a[148:151], a[20:23], 0
v_mfma_f32_16x16x32_bf16 v[184:187], a[144:147], a[16:19], v[184:187]
v_mfma_f32_16x16x32_bf16 v[160:163], a[144:147], a[8:11], 0
buffer_load_dwordx4 a[92:95], v2, s[40:43], s33 offen offset:3072 sc1
s_add_u32 s35, s35, 8192
v_mfma_f32_16x16x32_bf16 v[160:163], a[148:151], a[12:15], v[160:163]
s_add_u32 s33, s33, 8192
v_mfma_f32_16x16x32_bf16 v[136:139], a[148:151], a[4:7], 0
v_mfma_f32_16x16x32_bf16 v[136:139], a[144:147], a[0:3], v[136:139]
s_waitcnt vmcnt(10) lgkmcnt(0)
v_mfma_f32_16x16x32_bf16 v[140:143], a[96:99], a[32:35], v[140:143]
ds_read_b128 a[128:131], v5 offset:17408
v_mfma_f32_16x16x32_bf16 v[140:143], a[100:103], a[36:39], v[140:143]
buffer_load_dwordx4 a[0:3], v2, s[40:43], s35 offen offset:0 sc1
v_mfma_f32_16x16x32_bf16 v[164:167], a[100:103], a[44:47], v[164:167]
L_stub15:
s_cbranch_execz L_stub16
ds_read_b128 a[132:135], v5 offset:23552
v_mfma_f32_16x16x32_bf16 v[164:167], a[96:99], a[40:43], v[164:167]
v_mfma_f32_16x16x32_bf16 v[188:191], a[96:99], a[48:51], v[188:191]
v_mfma_f32_16x16x32_bf16 v[188:191], a[100:103], a[52:55], v[188:191]
buffer_load_dwordx4 a[4:7], v2, s[40:43], s33 offen offset:0 sc1
v_mfma_f32_16x16x32_bf16 v[212:215], a[100:103], a[60:63], v[212:215]
ds_read_b128 a[136:139], v5 offset:12288
v_mfma_f32_16x16x32_bf16 v[212:215], a[96:99], a[56:59], v[212:215]
v_mfma_f32_16x16x32_bf16 v[216:219], a[104:107], a[56:59], v[216:219]
ds_read_b128 a[140:143], v5 offset:18432
v_mfma_f32_16x16x32_bf16 v[216:219], a[108:111], a[60:63], v[216:219]
v_mfma_f32_16x16x32_bf16 v[192:195], a[108:111], a[52:55], v[192:195]
buffer_load_dwordx4 v1, s[4:7], s44 offen offset:2048 sc1 lds
s_add_u32 m0, s18, 0x21000
v_mfma_f32_16x16x32_bf16 v[192:195], a[104:107], a[48:51], v[192:195]
s_add_u32 s44, s50, 0x1421000
ds_read_b128 a[144:147], v5 offset:13312
v_mfma_f32_16x16x32_bf16 v[168:171], a[104:107], a[40:43], v[168:171]
v_mfma_f32_16x16x32_bf16 v[168:171], a[108:111], a[44:47], v[168:171]
ds_read_b128 a[148:151], v5 offset:19456
v_mfma_f32_16x16x32_bf16 v[144:147], a[108:111], a[36:39], v[144:147]
v_mfma_f32_16x16x32_bf16 v[144:147], a[104:107], a[32:35], v[144:147]
buffer_load_dwordx4 a[8:11], v2, s[40:43], s35 offen offset:1024 sc1
v_mfma_f32_16x16x32_bf16 v[148:151], a[112:115], a[32:35], v[148:151]
v_mfma_f32_16x16x32_bf16 v[148:151], a[116:119], a[36:39], v[148:151]
v_mfma_f32_16x16x32_bf16 v[172:175], a[116:119], a[44:47], v[172:175]
v_mfma_f32_16x16x32_bf16 v[172:175], a[112:115], a[40:43], v[172:175]
v_mfma_f32_16x16x32_bf16 v[196:199], a[112:115], a[48:51], v[196:199]
buffer_load_dwordx4 a[12:15], v2, s[40:43], s33 offen offset:1024 sc1
v_mfma_f32_16x16x32_bf16 v[196:199], a[116:119], a[52:55], v[196:199]
v_mfma_f32_16x16x32_bf16 v[220:223], a[116:119], a[60:63], v[220:223]
v_mfma_f32_16x16x32_bf16 v[220:223], a[112:115], a[56:59], v[220:223]
s_waitcnt lgkmcnt(0)
v_mfma_f32_16x16x32_bf16 v[224:227], a[128:131], a[56:59], v[224:227]
ds_read_b128 a[96:99], v5 offset:26624
v_mfma_f32_16x16x32_bf16 v[224:227], a[132:135], a[60:63], v[224:227]
buffer_load_dwordx4 a[16:19], v2, s[40:43], s35 offen offset:2048 sc1
v_mfma_f32_16x16x32_bf16 v[200:203], a[132:135], a[52:55], v[200:203]
ds_read_b128 a[100:103], v5 offset:32768
v_mfma_f32_16x16x32_bf16 v[200:203], a[128:131], a[48:51], v[200:203]
v_mfma_f32_16x16x32_bf16 v[176:179], a[128:131], a[40:43], v[176:179]
v_mfma_f32_16x16x32_bf16 v[176:179], a[132:135], a[44:47], v[176:179]
buffer_load_dwordx4 a[20:23], v2, s[40:43], s33 offen offset:2048 sc1
v_mfma_f32_16x16x32_bf16 v[152:155], a[132:135], a[36:39], v[152:155]
ds_read_b128 a[104:107], v5 offset:27648
v_mfma_f32_16x16x32_bf16 v[152:155], a[128:131], a[32:35], v[152:155]
v_mfma_f32_16x16x32_bf16 v[132:135], a[136:139], a[32:35], v[132:135]
ds_read_b128 a[108:111], v5 offset:33792
v_mfma_f32_16x16x32_bf16 v[132:135], a[140:143], a[36:39], v[132:135]
v_mfma_f32_16x16x32_bf16 v[156:159], a[140:143], a[44:47], v[156:159]
buffer_load_dwordx4 v1, s[4:7], s44 offen offset:0 sc1 lds
v_mfma_f32_16x16x32_bf16 v[156:159], a[136:139], a[40:43], v[156:159]
ds_read_b128 a[112:115], v5 offset:28672
v_mfma_f32_16x16x32_bf16 v[180:183], a[136:139], a[48:51], v[180:183]
v_mfma_f32_16x16x32_bf16 v[180:183], a[140:143], a[52:55], v[180:183]
ds_read_b128 a[116:119], v5 offset:34816
v_mfma_f32_16x16x32_bf16 v[204:207], a[140:143], a[60:63], v[204:207]
v_mfma_f32_16x16x32_bf16 v[204:207], a[136:139], a[56:59], v[204:207]
buffer_load_dwordx4 a[24:27], v2, s[40:43], s35 offen offset:3072 sc1
v_mfma_f32_16x16x32_bf16 v[208:211], a[144:147], a[56:59], v[208:211]
v_mfma_f32_16x16x32_bf16 v[208:211], a[148:151], a[60:63], v[208:211]
v_mfma_f32_16x16x32_bf16 v[184:187], a[148:151], a[52:55], v[184:187]
v_mfma_f32_16x16x32_bf16 v[184:187], a[144:147], a[48:51], v[184:187]
v_mfma_f32_16x16x32_bf16 v[160:163], a[144:147], a[40:43], v[160:163]
buffer_load_dwordx4 a[28:31], v2, s[40:43], s33 offen offset:3072 sc1
s_add_u32 s35, s35, 8192
v_mfma_f32_16x16x32_bf16 v[160:163], a[148:151], a[44:47], v[160:163]
s_add_u32 s33, s33, 8192
v_mfma_f32_16x16x32_bf16 v[136:139], a[148:151], a[36:39], v[136:139]
v_mfma_f32_16x16x32_bf16 v[136:139], a[144:147], a[32:35], v[136:139]
s_waitcnt vmcnt(10) lgkmcnt(0)
v_mfma_f32_16x16x32_bf16 v[140:143], a[96:99], a[64:67], v[140:143]
ds_read_b128 a[128:131], v5 offset:29696
v_mfma_f32_16x16x32_bf16 v[140:143], a[100:103], a[68:71], v[140:143]
buffer_load_dwordx4 a[32:35], v2, s[40:43], s35 offen offset:0 sc1
v_mfma_f32_16x16x32_bf16 v[164:167], a[100:103], a[76:79], v[164:167]
ds_read_b128 a[132:135], v5 offset:35840
v_mfma_f32_16x16x32_bf16 v[164:167], a[96:99], a[72:75], v[164:167]
v_mfma_f32_16x16x32_bf16 v[188:191], a[96:99], a[80:83], v[188:191]
v_mfma_f32_16x16x32_bf16 v[188:191], a[100:103], a[84:87], v[188:191]
buffer_load_dwordx4 a[36:39], v2, s[40:43], s33 offen offset:0 sc1
v_mfma_f32_16x16x32_bf16 v[212:215], a[100:103], a[92:95], v[212:215]
ds_read_b128 a[136:139], v5 offset:24576
v_mfma_f32_16x16x32_bf16 v[212:215], a[96:99], a[88:91], v[212:215]
v_mfma_f32_16x16x32_bf16 v[216:219], a[104:107], a[88:91], v[216:219]
ds_read_b128 a[140:143], v5 offset:30720
v_mfma_f32_16x16x32_bf16 v[216:219], a[108:111], a[92:95], v[216:219]
v_mfma_f32_16x16x32_bf16 v[192:195], a[108:111], a[84:87], v[192:195]
buffer_load_dwordx4 v1, s[4:7], s44 offen offset:1024 sc1 lds
v_mfma_f32_16x16x32_bf16 v[192:195], a[104:107], a[80:83], v[192:195]
ds_read_b128 a[144:147], v5 offset:25600
v_mfma_f32_16x16x32_bf16 v[168:171], a[104:107], a[72:75], v[168:171]
v_mfma_f32_16x16x32_bf16 v[168:171], a[108:111], a[76:79], v[168:171]
ds_read_b128 a[148:151], v5 offset:31744
v_mfma_f32_16x16x32_bf16 v[144:147], a[108:111], a[68:71], v[144:147]
v_mfma_f32_16x16x32_bf16 v[144:147], a[104:107], a[64:67], v[144:147]
buffer_load_dwordx4 a[40:43], v2, s[40:43], s35 offen offset:1024 sc1
v_mfma_f32_16x16x32_bf16 v[148:151], a[112:115], a[64:67], v[148:151]
v_mfma_f32_16x16x32_bf16 v[148:151], a[116:119], a[68:71], v[148:151]
v_mfma_f32_16x16x32_bf16 v[172:175], a[116:119], a[76:79], v[172:175]
v_mfma_f32_16x16x32_bf16 v[172:175], a[112:115], a[72:75], v[172:175]
v_mfma_f32_16x16x32_bf16 v[196:199], a[112:115], a[80:83], v[196:199]
buffer_load_dwordx4 a[44:47], v2, s[40:43], s33 offen offset:1024 sc1
v_mfma_f32_16x16x32_bf16 v[196:199], a[116:119], a[84:87], v[196:199]
v_mfma_f32_16x16x32_bf16 v[220:223], a[116:119], a[92:95], v[220:223]
v_mfma_f32_16x16x32_bf16 v[220:223], a[112:115], a[88:91], v[220:223]
s_waitcnt lgkmcnt(0)
v_mfma_f32_16x16x32_bf16 v[224:227], a[128:131], a[88:91], v[224:227]
ds_read_b128 a[96:99], v5 offset:38912
v_mfma_f32_16x16x32_bf16 v[224:227], a[132:135], a[92:95], v[224:227]
buffer_load_dwordx4 a[48:51], v2, s[40:43], s35 offen offset:2048 sc1
v_mfma_f32_16x16x32_bf16 v[200:203], a[132:135], a[84:87], v[200:203]
ds_read_b128 a[100:103], v5 offset:45056
v_mfma_f32_16x16x32_bf16 v[200:203], a[128:131], a[80:83], v[200:203]
v_mfma_f32_16x16x32_bf16 v[176:179], a[128:131], a[72:75], v[176:179]
v_mfma_f32_16x16x32_bf16 v[176:179], a[132:135], a[76:79], v[176:179]
buffer_load_dwordx4 a[52:55], v2, s[40:43], s33 offen offset:2048 sc1
v_mfma_f32_16x16x32_bf16 v[152:155], a[132:135], a[68:71], v[152:155]
ds_read_b128 a[104:107], v5 offset:39936
v_mfma_f32_16x16x32_bf16 v[152:155], a[128:131], a[64:67], v[152:155]
v_mfma_f32_16x16x32_bf16 v[132:135], a[136:139], a[64:67], v[132:135]
ds_read_b128 a[108:111], v5 offset:46080
v_mfma_f32_16x16x32_bf16 v[132:135], a[140:143], a[68:71], v[132:135]
v_mfma_f32_16x16x32_bf16 v[156:159], a[140:143], a[76:79], v[156:159]
buffer_load_dwordx4 v1, s[4:7], s44 offen offset:2048 sc1 lds
s_add_u32 s88, s82, 0x2c0000
v_mfma_f32_16x16x32_bf16 v[156:159], a[136:139], a[72:75], v[156:159]
ds_read_b128 a[112:115], v5 offset:40960
v_mfma_f32_16x16x32_bf16 v[180:183], a[136:139], a[80:83], v[180:183]
v_mfma_f32_16x16x32_bf16 v[180:183], a[140:143], a[84:87], v[180:183]
ds_read_b128 a[116:119], v5 offset:47104
v_mfma_f32_16x16x32_bf16 v[204:207], a[140:143], a[92:95], v[204:207]
v_mfma_f32_16x16x32_bf16 v[204:207], a[136:139], a[88:91], v[204:207]
buffer_load_dwordx4 a[56:59], v2, s[40:43], s35 offen offset:3072 sc1
v_mfma_f32_16x16x32_bf16 v[208:211], a[144:147], a[88:91], v[208:211]
v_mfma_f32_16x16x32_bf16 v[208:211], a[148:151], a[92:95], v[208:211]
v_mfma_f32_16x16x32_bf16 v[184:187], a[148:151], a[84:87], v[184:187]
v_mfma_f32_16x16x32_bf16 v[184:187], a[144:147], a[80:83], v[184:187]
v_mfma_f32_16x16x32_bf16 v[160:163], a[144:147], a[72:75], v[160:163]
buffer_load_dwordx4 a[60:63], v2, s[40:43], s33 offen offset:3072 sc1
s_add_u32 s35, s35, 8192
v_mfma_f32_16x16x32_bf16 v[160:163], a[148:151], a[76:79], v[160:163]
s_add_u32 s33, s33, 8192
v_mfma_f32_16x16x32_bf16 v[136:139], a[148:151], a[68:71], v[136:139]
v_mfma_f32_16x16x32_bf16 v[136:139], a[144:147], a[64:67], v[136:139]
s_waitcnt vmcnt(10) lgkmcnt(0)
v_mfma_f32_16x16x32_bf16 v[140:143], a[96:99], a[0:3], v[140:143]
ds_read_b128 a[128:131], v5 offset:41984
v_mfma_f32_16x16x32_bf16 v[140:143], a[100:103], a[4:7], v[140:143]
buffer_load_dwordx4 a[64:67], v2, s[40:43], s35 offen offset:0 sc1
v_mfma_f32_16x16x32_bf16 v[164:167], a[100:103], a[12:15], v[164:167]
ds_read_b128 a[132:135], v5 offset:48128
v_mfma_f32_16x16x32_bf16 v[164:167], a[96:99], a[8:11], v[164:167]
v_mfma_f32_16x16x32_bf16 v[188:191], a[96:99], a[16:19], v[188:191]
v_mfma_f32_16x16x32_bf16 v[188:191], a[100:103], a[20:23], v[188:191]
buffer_load_dwordx4 a[68:71], v2, s[40:43], s33 offen offset:0 sc1
v_mfma_f32_16x16x32_bf16 v[212:215], a[100:103], a[28:31], v[212:215]
ds_read_b128 a[136:139], v5 offset:36864
v_mfma_f32_16x16x32_bf16 v[212:215], a[96:99], a[24:27], v[212:215]
v_mfma_f32_16x16x32_bf16 v[216:219], a[104:107], a[24:27], v[216:219]
ds_read_b128 a[140:143], v5 offset:43008
v_mfma_f32_16x16x32_bf16 v[216:219], a[108:111], a[28:31], v[216:219]
v_mfma_f32_16x16x32_bf16 v[192:195], a[108:111], a[20:23], v[192:195]
buffer_load_dwordx4 v[92:95], v1, s[4:7], s88 offen offset:0 sc1
v_mfma_f32_16x16x32_bf16 v[192:195], a[104:107], a[16:19], v[192:195]
ds_read_b128 a[144:147], v5 offset:37888
v_mfma_f32_16x16x32_bf16 v[168:171], a[104:107], a[8:11], v[168:171]
v_mfma_f32_16x16x32_bf16 v[168:171], a[108:111], a[12:15], v[168:171]
ds_read_b128 a[148:151], v5 offset:44032
v_mfma_f32_16x16x32_bf16 v[144:147], a[108:111], a[4:7], v[144:147]
v_mfma_f32_16x16x32_bf16 v[144:147], a[104:107], a[0:3], v[144:147]
buffer_load_dwordx4 a[72:75], v2, s[40:43], s35 offen offset:1024 sc1
v_mfma_f32_16x16x32_bf16 v[148:151], a[112:115], a[0:3], v[148:151]
v_mfma_f32_16x16x32_bf16 v[148:151], a[116:119], a[4:7], v[148:151]
v_mfma_f32_16x16x32_bf16 v[172:175], a[116:119], a[12:15], v[172:175]
v_mfma_f32_16x16x32_bf16 v[172:175], a[112:115], a[8:11], v[172:175]
v_mfma_f32_16x16x32_bf16 v[196:199], a[112:115], a[16:19], v[196:199]
buffer_load_dwordx4 a[76:79], v2, s[40:43], s33 offen offset:1024 sc1
v_mfma_f32_16x16x32_bf16 v[196:199], a[116:119], a[20:23], v[196:199]
v_mfma_f32_16x16x32_bf16 v[220:223], a[116:119], a[28:31], v[220:223]
v_mfma_f32_16x16x32_bf16 v[220:223], a[112:115], a[24:27], v[220:223]
s_waitcnt lgkmcnt(0)
s_barrier
v_mfma_f32_16x16x32_bf16 v[224:227], a[128:131], a[24:27], v[224:227]
v_add_u32 v5, 49152, v1
v_mfma_f32_16x16x32_bf16 v[224:227], a[132:135], a[28:31], v[224:227]
buffer_load_dwordx4 a[80:83], v2, s[40:43], s35 offen offset:2048 sc1
v_mfma_f32_16x16x32_bf16 v[200:203], a[132:135], a[20:23], v[200:203]
ds_read_b128 a[96:99], v5 offset:2048
v_mfma_f32_16x16x32_bf16 v[200:203], a[128:131], a[16:19], v[200:203]
ds_read_b128 a[100:103], v5 offset:8192
v_mfma_f32_16x16x32_bf16 v[176:179], a[128:131], a[8:11], v[176:179]
v_mfma_f32_16x16x32_bf16 v[176:179], a[132:135], a[12:15], v[176:179]
buffer_load_dwordx4 a[84:87], v2, s[40:43], s33 offen offset:2048 sc1
v_mfma_f32_16x16x32_bf16 v[152:155], a[132:135], a[4:7], v[152:155]
ds_read_b128 a[104:107], v5 offset:3072
v_mfma_f32_16x16x32_bf16 v[152:155], a[128:131], a[0:3], v[152:155]
v_mfma_f32_16x16x32_bf16 v[132:135], a[136:139], a[0:3], v[132:135]
ds_read_b128 a[108:111], v5 offset:9216
v_mfma_f32_16x16x32_bf16 v[132:135], a[140:143], a[4:7], v[132:135]
v_mfma_f32_16x16x32_bf16 v[156:159], a[140:143], a[12:15], v[156:159]
buffer_load_dwordx4 v[96:99], v1, s[4:7], s88 offen offset:1024 sc1
v_mfma_f32_16x16x32_bf16 v[156:159], a[136:139], a[8:11], v[156:159]
ds_read_b128 a[112:115], v5 offset:4096
v_mfma_f32_16x16x32_bf16 v[180:183], a[136:139], a[16:19], v[180:183]
v_mfma_f32_16x16x32_bf16 v[180:183], a[140:143], a[20:23], v[180:183]
ds_read_b128 a[116:119], v5 offset:10240
v_mfma_f32_16x16x32_bf16 v[204:207], a[140:143], a[28:31], v[204:207]
v_mfma_f32_16x16x32_bf16 v[204:207], a[136:139], a[24:27], v[204:207]
buffer_load_dwordx4 a[88:91], v2, s[40:43], s35 offen offset:3072 sc1
v_mfma_f32_16x16x32_bf16 v[208:211], a[144:147], a[24:27], v[208:211]
v_mfma_f32_16x16x32_bf16 v[208:211], a[148:151], a[28:31], v[208:211]
v_mfma_f32_16x16x32_bf16 v[184:187], a[148:151], a[20:23], v[184:187]
v_mfma_f32_16x16x32_bf16 v[184:187], a[144:147], a[16:19], v[184:187]
v_mfma_f32_16x16x32_bf16 v[160:163], a[144:147], a[8:11], v[160:163]
buffer_load_dwordx4 a[92:95], v2, s[40:43], s33 offen offset:3072 sc1
s_add_u32 s35, s35, 8192
v_mfma_f32_16x16x32_bf16 v[160:163], a[148:151], a[12:15], v[160:163]
s_add_u32 s33, s33, 8192
v_mfma_f32_16x16x32_bf16 v[136:139], a[148:151], a[4:7], v[136:139]
v_mfma_f32_16x16x32_bf16 v[136:139], a[144:147], a[0:3], v[136:139]
s_waitcnt vmcnt(10) lgkmcnt(0)
v_mfma_f32_16x16x32_bf16 v[140:143], a[96:99], a[32:35], v[140:143]
ds_read_b128 a[128:131], v5 offset:5120
v_mfma_f32_16x16x32_bf16 v[140:143], a[100:103], a[36:39], v[140:143]
buffer_load_dwordx4 a[0:3], v2, s[40:43], s35 offen offset:0 sc1
v_mfma_f32_16x16x32_bf16 v[164:167], a[100:103], a[44:47], v[164:167]
ds_read_b128 a[132:135], v5 offset:11264
v_mfma_f32_16x16x32_bf16 v[164:167], a[96:99], a[40:43], v[164:167]
v_mfma_f32_16x16x32_bf16 v[188:191], a[96:99], a[48:51], v[188:191]
v_mfma_f32_16x16x32_bf16 v[188:191], a[100:103], a[52:55], v[188:191]
buffer_load_dwordx4 a[4:7], v2, s[40:43], s33 offen offset:0 sc1
v_mfma_f32_16x16x32_bf16 v[212:215], a[100:103], a[60:63], v[212:215]
ds_read_b128 a[136:139], v5 offset:0
v_mfma_f32_16x16x32_bf16 v[212:215], a[96:99], a[56:59], v[212:215]
v_mfma_f32_16x16x32_bf16 v[216:219], a[104:107], a[56:59], v[216:219]
ds_read_b128 a[140:143], v5 offset:6144
v_mfma_f32_16x16x32_bf16 v[216:219], a[108:111], a[60:63], v[216:219]
v_mfma_f32_16x16x32_bf16 v[192:195], a[108:111], a[52:55], v[192:195]
buffer_load_dwordx4 v[100:103], v1, s[4:7], s88 offen offset:2048 sc1
v_mfma_f32_16x16x32_bf16 v[192:195], a[104:107], a[48:51], v[192:195]
ds_read_b128 a[144:147], v5 offset:1024
v_mfma_f32_16x16x32_bf16 v[168:171], a[104:107], a[40:43], v[168:171]
v_mfma_f32_16x16x32_bf16 v[168:171], a[108:111], a[44:47], v[168:171]
ds_read_b128 a[148:151], v5 offset:7168
v_mfma_f32_16x16x32_bf16 v[144:147], a[108:111], a[36:39], v[144:147]
v_mfma_f32_16x16x32_bf16 v[144:147], a[104:107], a[32:35], v[144:147]
buffer_load_dwordx4 a[8:11], v2, s[40:43], s35 offen offset:1024 sc1
v_mfma_f32_16x16x32_bf16 v[148:151], a[112:115], a[32:35], v[148:151]
v_mfma_f32_16x16x32_bf16 v[148:151], a[116:119], a[36:39], v[148:151]
v_mfma_f32_16x16x32_bf16 v[172:175], a[116:119], a[44:47], v[172:175]
v_mfma_f32_16x16x32_bf16 v[172:175], a[112:115], a[40:43], v[172:175]
v_mfma_f32_16x16x32_bf16 v[196:199], a[112:115], a[48:51], v[196:199]
buffer_load_dwordx4 a[12:15], v2, s[40:43], s33 offen offset:1024 sc1
v_mfma_f32_16x16x32_bf16 v[196:199], a[116:119], a[52:55], v[196:199]
v_mfma_f32_16x16x32_bf16 v[220:223], a[116:119], a[60:63], v[220:223]
v_mfma_f32_16x16x32_bf16 v[220:223], a[112:115], a[56:59], v[220:223]
s_waitcnt lgkmcnt(0)
v_mfma_f32_16x16x32_bf16 v[224:227], a[128:131], a[56:59], v[224:227]
ds_read_b128 a[96:99], v5 offset:14336
v_mfma_f32_16x16x32_bf16 v[224:227], a[132:135], a[60:63], v[224:227]
buffer_load_dwordx4 a[16:19], v2, s[40:43], s35 offen offset:2048 sc1
v_mfma_f32_16x16x32_bf16 v[200:203], a[132:135], a[52:55], v[200:203]
ds_read_b128 a[100:103], v5 offset:20480
v_mfma_f32_16x16x32_bf16 v[200:203], a[128:131], a[48:51], v[200:203]
v_mfma_f32_16x16x32_bf16 v[176:179], a[128:131], a[40:43], v[176:179]
v_mfma_f32_16x16x32_bf16 v[176:179], a[132:135], a[44:47], v[176:179]
buffer_load_dwordx4 a[20:23], v2, s[40:43], s33 offen offset:2048 sc1
v_mfma_f32_16x16x32_bf16 v[152:155], a[132:135], a[36:39], v[152:155]
ds_read_b128 a[104:107], v5 offset:15360
v_mfma_f32_16x16x32_bf16 v[152:155], a[128:131], a[32:35], v[152:155]
v_mfma_f32_16x16x32_bf16 v[132:135], a[136:139], a[32:35], v[132:135]
ds_read_b128 a[108:111], v5 offset:21504
v_mfma_f32_16x16x32_bf16 v[132:135], a[140:143], a[36:39], v[132:135]
v_mfma_f32_16x16x32_bf16 v[156:159], a[140:143], a[44:47], v[156:159]
buffer_load_dwordx4 v[104:107], v1, s[4:7], s88 offen offset:3072 sc1
s_add_u32 s88, s88, 4096
v_mfma_f32_16x16x32_bf16 v[156:159], a[136:139], a[40:43], v[156:159]
ds_read_b128 a[112:115], v5 offset:16384
v_mfma_f32_16x16x32_bf16 v[180:183], a[136:139], a[48:51], v[180:183]
v_mfma_f32_16x16x32_bf16 v[180:183], a[140:143], a[52:55], v[180:183]
ds_read_b128 a[116:119], v5 offset:22528
v_mfma_f32_16x16x32_bf16 v[204:207], a[140:143], a[60:63], v[204:207]
v_mfma_f32_16x16x32_bf16 v[204:207], a[136:139], a[56:59], v[204:207]
buffer_load_dwordx4 a[24:27], v2, s[40:43], s35 offen offset:3072 sc1
v_mfma_f32_16x16x32_bf16 v[208:211], a[144:147], a[56:59], v[208:211]
v_mfma_f32_16x16x32_bf16 v[208:211], a[148:151], a[60:63], v[208:211]
v_mfma_f32_16x16x32_bf16 v[184:187], a[148:151], a[52:55], v[184:187]
v_mfma_f32_16x16x32_bf16 v[184:187], a[144:147], a[48:51], v[184:187]
v_mfma_f32_16x16x32_bf16 v[160:163], a[144:147], a[40:43], v[160:163]
buffer_load_dwordx4 a[28:31], v2, s[40:43], s33 offen offset:3072 sc1
s_add_u32 s35, s35, 8192
v_mfma_f32_16x16x32_bf16 v[160:163], a[148:151], a[44:47], v[160:163]
s_add_u32 s33, s33, 8192
v_mfma_f32_16x16x32_bf16 v[136:139], a[148:151], a[36:39], v[136:139]
v_mfma_f32_16x16x32_bf16 v[136:139], a[144:147], a[32:35], v[136:139]
s_waitcnt vmcnt(10) lgkmcnt(0)
v_mfma_f32_16x16x32_bf16 v[140:143], a[96:99], a[64:67], v[140:143]
ds_read_b128 a[128:131], v5 offset:17408
v_mfma_f32_16x16x32_bf16 v[140:143], a[100:103], a[68:71], v[140:143]
buffer_load_dwordx4 a[32:35], v2, s[40:43], s35 offen offset:0 sc1
v_mfma_f32_16x16x32_bf16 v[164:167], a[100:103], a[76:79], v[164:167]
ds_read_b128 a[132:135], v5 offset:23552
v_mfma_f32_16x16x32_bf16 v[164:167], a[96:99], a[72:75], v[164:167]
v_mfma_f32_16x16x32_bf16 v[188:191], a[96:99], a[80:83], v[188:191]
v_mfma_f32_16x16x32_bf16 v[188:191], a[100:103], a[84:87], v[188:191]
buffer_load_dwordx4 a[36:39], v2, s[40:43], s33 offen offset:0 sc1
v_mfma_f32_16x16x32_bf16 v[212:215], a[100:103], a[92:95], v[212:215]
ds_read_b128 a[136:139], v5 offset:12288
v_mfma_f32_16x16x32_bf16 v[212:215], a[96:99], a[88:91], v[212:215]
v_mfma_f32_16x16x32_bf16 v[216:219], a[104:107], a[88:91], v[216:219]
ds_read_b128 a[140:143], v5 offset:18432
v_mfma_f32_16x16x32_bf16 v[216:219], a[108:111], a[92:95], v[216:219]
v_mfma_f32_16x16x32_bf16 v[192:195], a[108:111], a[84:87], v[192:195]
buffer_load_dwordx4 v[108:111], v1, s[4:7], s88 offen offset:0 sc1
v_mfma_f32_16x16x32_bf16 v[192:195], a[104:107], a[80:83], v[192:195]
ds_read_b128 a[144:147], v5 offset:13312
v_mfma_f32_16x16x32_bf16 v[168:171], a[104:107], a[72:75], v[168:171]
v_mfma_f32_16x16x32_bf16 v[168:171], a[108:111], a[76:79], v[168:171]
ds_read_b128 a[148:151], v5 offset:19456
v_mfma_f32_16x16x32_bf16 v[144:147], a[108:111], a[68:71], v[144:147]
v_mfma_f32_16x16x32_bf16 v[144:147], a[104:107], a[64:67], v[144:147]
buffer_load_dwordx4 a[40:43], v2, s[40:43], s35 offen offset:1024 sc1
v_mfma_f32_16x16x32_bf16 v[148:151], a[112:115], a[64:67], v[148:151]
v_mfma_f32_16x16x32_bf16 v[148:151], a[116:119], a[68:71], v[148:151]
v_mfma_f32_16x16x32_bf16 v[172:175], a[116:119], a[76:79], v[172:175]
v_mfma_f32_16x16x32_bf16 v[172:175], a[112:115], a[72:75], v[172:175]
v_mfma_f32_16x16x32_bf16 v[196:199], a[112:115], a[80:83], v[196:199]
buffer_load_dwordx4 a[44:47], v2, s[40:43], s33 offen offset:1024 sc1
v_mfma_f32_16x16x32_bf16 v[196:199], a[116:119], a[84:87], v[196:199]
v_mfma_f32_16x16x32_bf16 v[220:223], a[116:119], a[92:95], v[220:223]
v_mfma_f32_16x16x32_bf16 v[220:223], a[112:115], a[88:91], v[220:223]
s_waitcnt lgkmcnt(0)
v_mfma_f32_16x16x32_bf16 v[224:227], a[128:131], a[88:91], v[224:227]
ds_read_b128 a[96:99], v5 offset:26624
v_mfma_f32_16x16x32_bf16 v[224:227], a[132:135], a[92:95], v[224:227]
buffer_load_dwordx4 a[48:51], v2, s[40:43], s35 offen offset:2048 sc1
v_mfma_f32_16x16x32_bf16 v[200:203], a[132:135], a[84:87], v[200:203]
ds_read_b128 a[100:103], v5 offset:32768
v_mfma_f32_16x16x32_bf16 v[200:203], a[128:131], a[80:83], v[200:203]
v_mfma_f32_16x16x32_bf16 v[176:179], a[128:131], a[72:75], v[176:179]
v_mfma_f32_16x16x32_bf16 v[176:179], a[132:135], a[76:79], v[176:179]
buffer_load_dwordx4 a[52:55], v2, s[40:43], s33 offen offset:2048 sc1
v_mfma_f32_16x16x32_bf16 v[152:155], a[132:135], a[68:71], v[152:155]
ds_read_b128 a[104:107], v5 offset:27648
v_mfma_f32_16x16x32_bf16 v[152:155], a[128:131], a[64:67], v[152:155]
v_mfma_f32_16x16x32_bf16 v[132:135], a[136:139], a[64:67], v[132:135]
ds_read_b128 a[108:111], v5 offset:33792
v_mfma_f32_16x16x32_bf16 v[132:135], a[140:143], a[68:71], v[132:135]
v_mfma_f32_16x16x32_bf16 v[156:159], a[140:143], a[76:79], v[156:159]
buffer_load_dwordx4 v[112:115], v1, s[4:7], s88 offen offset:1024 sc1
v_mfma_f32_16x16x32_bf16 v[156:159], a[136:139], a[72:75], v[156:159]
ds_read_b128 a[112:115], v5 offset:28672
v_mfma_f32_16x16x32_bf16 v[180:183], a[136:139], a[80:83], v[180:183]
v_mfma_f32_16x16x32_bf16 v[180:183], a[140:143], a[84:87], v[180:183]
ds_read_b128 a[116:119], v5 offset:34816
v_mfma_f32_16x16x32_bf16 v[204:207], a[140:143], a[92:95], v[204:207]
v_mfma_f32_16x16x32_bf16 v[204:207], a[136:139], a[88:91], v[204:207]
buffer_load_dwordx4 a[56:59], v2, s[40:43], s35 offen offset:3072 sc1
v_mfma_f32_16x16x32_bf16 v[208:211], a[144:147], a[88:91], v[208:211]
v_mfma_f32_16x16x32_bf16 v[208:211], a[148:151], a[92:95], v[208:211]
v_mfma_f32_16x16x32_bf16 v[184:187], a[148:151], a[84:87], v[184:187]
v_mfma_f32_16x16x32_bf16 v[184:187], a[144:147], a[80:83], v[184:187]
v_mfma_f32_16x16x32_bf16 v[160:163], a[144:147], a[72:75], v[160:163]
buffer_load_dwordx4 a[60:63], v2, s[40:43], s33 offen offset:3072 sc1
s_add_u32 s35, s35, 8192
v_mfma_f32_16x16x32_bf16 v[160:163], a[148:151], a[76:79], v[160:163]
s_add_u32 s33, s33, 8192
v_mfma_f32_16x16x32_bf16 v[136:139], a[148:151], a[68:71], v[136:139]
v_mfma_f32_16x16x32_bf16 v[136:139], a[144:147], a[64:67], v[136:139]
s_waitcnt vmcnt(10) lgkmcnt(0)
v_mfma_f32_16x16x32_bf16 v[140:143], a[96:99], a[0:3], v[140:143]
ds_read_b128 a[128:131], v5 offset:29696
v_mfma_f32_16x16x32_bf16 v[140:143], a[100:103], a[4:7], v[140:143]
buffer_load_dwordx4 a[64:67], v2, s[40:43], s35 offen offset:0 sc1
v_mfma_f32_16x16x32_bf16 v[164:167], a[100:103], a[12:15], v[164:167]
ds_read_b128 a[132:135], v5 offset:35840
v_mfma_f32_16x16x32_bf16 v[164:167], a[96:99], a[8:11], v[164:167]
v_mfma_f32_16x16x32_bf16 v[188:191], a[96:99], a[16:19], v[188:191]
v_mfma_f32_16x16x32_bf16 v[188:191], a[100:103], a[20:23], v[188:191]
buffer_load_dwordx4 a[68:71], v2, s[40:43], s33 offen offset:0 sc1
v_mfma_f32_16x16x32_bf16 v[212:215], a[100:103], a[28:31], v[212:215]
ds_read_b128 a[136:139], v5 offset:24576
v_mfma_f32_16x16x32_bf16 v[212:215], a[96:99], a[24:27], v[212:215]
v_mfma_f32_16x16x32_bf16 v[216:219], a[104:107], a[24:27], v[216:219]
ds_read_b128 a[140:143], v5 offset:30720
v_mfma_f32_16x16x32_bf16 v[216:219], a[108:111], a[28:31], v[216:219]
v_mfma_f32_16x16x32_bf16 v[192:195], a[108:111], a[20:23], v[192:195]
buffer_load_dwordx4 v[116:119], v1, s[4:7], s88 offen offset:2048 sc1
v_mfma_f32_16x16x32_bf16 v[192:195], a[104:107], a[16:19], v[192:195]
ds_read_b128 a[144:147], v5 offset:25600
v_mfma_f32_16x16x32_bf16 v[168:171], a[104:107], a[8:11], v[168:171]
v_mfma_f32_16x16x32_bf16 v[168:171], a[108:111], a[12:15], v[168:171]
ds_read_b128 a[148:151], v5 offset:31744
v_mfma_f32_16x16x32_bf16 v[144:147], a[108:111], a[4:7], v[144:147]
v_mfma_f32_16x16x32_bf16 v[144:147], a[104:107], a[0:3], v[144:147]
buffer_load_dwordx4 a[72:75], v2, s[40:43], s35 offen offset:1024 sc1
v_mfma_f32_16x16x32_bf16 v[148:151], a[112:115], a[0:3], v[148:151]
v_mfma_f32_16x16x32_bf16 v[148:151], a[116:119], a[4:7], v[148:151]
v_mfma_f32_16x16x32_bf16 v[172:175], a[116:119], a[12:15], v[172:175]
v_mfma_f32_16x16x32_bf16 v[172:175], a[112:115], a[8:11], v[172:175]
v_mfma_f32_16x16x32_bf16 v[196:199], a[112:115], a[16:19], v[196:199]
buffer_load_dwordx4 a[76:79], v2, s[40:43], s33 offen offset:1024 sc1
v_mfma_f32_16x16x32_bf16 v[196:199], a[116:119], a[20:23], v[196:199]
v_mfma_f32_16x16x32_bf16 v[220:223], a[116:119], a[28:31], v[220:223]
v_mfma_f32_16x16x32_bf16 v[220:223], a[112:115], a[24:27], v[220:223]
s_waitcnt lgkmcnt(0)
v_mfma_f32_16x16x32_bf16 v[224:227], a[128:131], a[24:27], v[224:227]
ds_read_b128 a[96:99], v5 offset:38912
v_mfma_f32_16x16x32_bf16 v[224:227], a[132:135], a[28:31], v[224:227]
buffer_load_dwordx4 a[80:83], v2, s[40:43], s35 offen offset:2048 sc1
v_mfma_f32_16x16x32_bf16 v[200:203], a[132:135], a[20:23], v[200:203]
ds_read_b128 a[100:103], v5 offset:45056
v_mfma_f32_16x16x32_bf16 v[200:203], a[128:131], a[16:19], v[200:203]
v_mfma_f32_16x16x32_bf16 v[176:179], a[128:131], a[8:11], v[176:179]
v_mfma_f32_16x16x32_bf16 v[176:179], a[132:135], a[12:15], v[176:179]
buffer_load_dwordx4 a[84:87], v2, s[40:43], s33 offen offset:2048 sc1
v_mfma_f32_16x16x32_bf16 v[152:155], a[132:135], a[4:7], v[152:155]
ds_read_b128 a[104:107], v5 offset:39936
v_mfma_f32_16x16x32_bf16 v[152:155], a[128:131], a[0:3], v[152:155]
v_mfma_f32_16x16x32_bf16 v[132:135], a[136:139], a[0:3], v[132:135]
ds_read_b128 a[108:111], v5 offset:46080
v_mfma_f32_16x16x32_bf16 v[132:135], a[140:143], a[4:7], v[132:135]
v_mfma_f32_16x16x32_bf16 v[156:159], a[140:143], a[12:15], v[156:159]
buffer_load_dwordx4 v[120:123], v1, s[4:7], s88 offen offset:3072 sc1
s_add_u32 m0, s18, 0x0
v_mfma_f32_16x16x32_bf16 v[156:159], a[136:139], a[8:11], v[156:159]
s_add_u32 s44, s50, 0x1424000
ds_read_b128 a[112:115], v5 offset:40960
v_mfma_f32_16x16x32_bf16 v[180:183], a[136:139], a[16:19], v[180:183]
v_mfma_f32_16x16x32_bf16 v[180:183], a[140:143], a[20:23], v[180:183]
ds_read_b128 a[116:119], v5 offset:47104
v_mfma_f32_16x16x32_bf16 v[204:207], a[140:143], a[28:31], v[204:207]
v_mfma_f32_16x16x32_bf16 v[204:207], a[136:139], a[24:27], v[204:207]
buffer_load_dwordx4 a[88:91], v2, s[40:43], s35 offen offset:3072 sc1
v_mfma_f32_16x16x32_bf16 v[208:211], a[144:147], a[24:27], v[208:211]
v_mfma_f32_16x16x32_bf16 v[208:211], a[148:151], a[28:31], v[208:211]
v_mfma_f32_16x16x32_bf16 v[184:187], a[148:151], a[20:23], v[184:187]
v_mfma_f32_16x16x32_bf16 v[184:187], a[144:147], a[16:19], v[184:187]
v_mfma_f32_16x16x32_bf16 v[160:163], a[144:147], a[8:11], v[160:163]
buffer_load_dwordx4 a[92:95], v2, s[40:43], s33 offen offset:3072 sc1
s_add_u32 s35, s35, 8192
v_mfma_f32_16x16x32_bf16 v[160:163], a[148:151], a[12:15], v[160:163]
s_add_u32 s33, s33, 8192
v_mfma_f32_16x16x32_bf16 v[136:139], a[148:151], a[4:7], v[136:139]
v_mfma_f32_16x16x32_bf16 v[136:139], a[144:147], a[0:3], v[136:139]
s_waitcnt vmcnt(10) lgkmcnt(0)
v_mfma_f32_16x16x32_bf16 v[140:143], a[96:99], a[32:35], v[140:143]
ds_read_b128 a[128:131], v5 offset:41984
v_mfma_f32_16x16x32_bf16 v[140:143], a[100:103], a[36:39], v[140:143]
buffer_load_dwordx4 a[0:3], v2, s[40:43], s35 offen offset:0 sc1
v_mfma_f32_16x16x32_bf16 v[164:167], a[100:103], a[44:47], v[164:167]
ds_read_b128 a[132:135], v5 offset:48128
v_mfma_f32_16x16x32_bf16 v[164:167], a[96:99], a[40:43], v[164:167]
v_mfma_f32_16x16x32_bf16 v[188:191], a[96:99], a[48:51], v[188:191]
v_mfma_f32_16x16x32_bf16 v[188:191], a[100:103], a[52:55], v[188:191]
buffer_load_dwordx4 a[4:7], v2, s[40:43], s33 offen offset:0 sc1
v_mfma_f32_16x16x32_bf16 v[212:215], a[100:103], a[60:63], v[212:215]
ds_read_b128 a[136:139], v5 offset:36864
v_mfma_f32_16x16x32_bf16 v[212:215], a[96:99], a[56:59], v[212:215]
v_mfma_f32_16x16x32_bf16 v[216:219], a[104:107], a[56:59], v[216:219]
ds_read_b128 a[140:143], v5 offset:43008
v_mfma_f32_16x16x32_bf16 v[216:219], a[108:111], a[60:63], v[216:219]
v_mfma_f32_16x16x32_bf16 v[192:195], a[108:111], a[52:55], v[192:195]
buffer_load_dwordx4 v1, s[4:7], s44 offen offset:0 sc1 lds
v_mfma_f32_16x16x32_bf16 v[192:195], a[104:107], a[48:51], v[192:195]
ds_read_b128 a[144:147], v5 offset:37888
v_mfma_f32_16x16x32_bf16 v[168:171], a[104:107], a[40:43], v[168:171]
v_mfma_f32_16x16x32_bf16 v[168:171], a[108:111], a[44:47], v[168:171]
ds_read_b128 a[148:151], v5 offset:44032
v_mfma_f32_16x16x32_bf16 v[144:147], a[108:111], a[36:39], v[144:147]
v_mfma_f32_16x16x32_bf16 v[144:147], a[104:107], a[32:35], v[144:147]
buffer_load_dwordx4 a[8:11], v2, s[40:43], s35 offen offset:1024 sc1
v_mfma_f32_16x16x32_bf16 v[148:151], a[112:115], a[32:35], v[148:151]
v_mfma_f32_16x16x32_bf16 v[148:151], a[116:119], a[36:39], v[148:151]
v_mfma_f32_16x16x32_bf16 v[172:175], a[116:119], a[44:47], v[172:175]
v_mfma_f32_16x16x32_bf16 v[172:175], a[112:115], a[40:43], v[172:175]
v_mfma_f32_16x16x32_bf16 v[196:199], a[112:115], a[48:51], v[196:199]
buffer_load_dwordx4 a[12:15], v2, s[40:43], s33 offen offset:1024 sc1
v_mfma_f32_16x16x32_bf16 v[196:199], a[116:119], a[52:55], v[196:199]
v_mfma_f32_16x16x32_bf16 v[220:223], a[116:119], a[60:63], v[220:223]
v_mfma_f32_16x16x32_bf16 v[220:223], a[112:115], a[56:59], v[220:223]
s_waitcnt lgkmcnt(0)
s_barrier
v_mfma_f32_16x16x32_bf16 v[224:227], a[128:131], a[56:59], v[224:227]
v_add_u32 v5, 98304, v1
v_mfma_f32_16x16x32_bf16 v[224:227], a[132:135], a[60:63], v[224:227]
buffer_load_dwordx4 a[16:19], v2, s[40:43], s35 offen offset:2048 sc1
v_mfma_f32_16x16x32_bf16 v[200:203], a[132:135], a[52:55], v[200:203]
ds_read_b128 a[96:99], v5 offset:2048
v_mfma_f32_16x16x32_bf16 v[200:203], a[128:131], a[48:51], v[200:203]
ds_read_b128 a[100:103], v5 offset:8192
v_mfma_f32_16x16x32_bf16 v[176:179], a[128:131], a[40:43], v[176:179]
v_mfma_f32_16x16x32_bf16 v[176:179], a[132:135], a[44:47], v[176:179]
buffer_load_dwordx4 a[20:23], v2, s[40:43], s33 offen offset:2048 sc1
v_mfma_f32_16x16x32_bf16 v[152:155], a[132:135], a[36:39], v[152:155]
ds_read_b128 a[104:107], v5 offset:3072
v_mfma_f32_16x16x32_bf16 v[152:155], a[128:131], a[32:35], v[152:155]
v_mfma_f32_16x16x32_bf16 v[132:135], a[136:139], a[32:35], v[132:135]
ds_read_b128 a[108:111], v5 offset:9216
v_mfma_f32_16x16x32_bf16 v[132:135], a[140:143], a[36:39], v[132:135]
v_mfma_f32_16x16x32_bf16 v[156:159], a[140:143], a[44:47], v[156:159]
buffer_load_dwordx4 v1, s[4:7], s44 offen offset:1024 sc1 lds
v_mfma_f32_16x16x32_bf16 v[156:159], a[136:139], a[40:43], v[156:159]
ds_read_b128 a[112:115], v5 offset:4096
v_mfma_f32_16x16x32_bf16 v[180:183], a[136:139], a[48:51], v[180:183]
v_mfma_f32_16x16x32_bf16 v[180:183], a[140:143], a[52:55], v[180:183]
ds_read_b128 a[116:119], v5 offset:10240
v_mfma_f32_16x16x32_bf16 v[204:207], a[140:143], a[60:63], v[204:207]
v_mfma_f32_16x16x32_bf16 v[204:207], a[136:139], a[56:59], v[204:207]
buffer_load_dwordx4 a[24:27], v2, s[40:43], s35 offen offset:3072 sc1
v_mfma_f32_16x16x32_bf16 v[208:211], a[144:147], a[56:59], v[208:211]
v_mfma_f32_16x16x32_bf16 v[208:211], a[148:151], a[60:63], v[208:211]
v_mfma_f32_16x16x32_bf16 v[184:187], a[148:151], a[52:55], v[184:187]
v_mfma_f32_16x16x32_bf16 v[184:187], a[144:147], a[48:51], v[184:187]
v_mfma_f32_16x16x32_bf16 v[160:163], a[144:147], a[40:43], v[160:163]
buffer_load_dwordx4 a[28:31], v2, s[40:43], s33 offen offset:3072 sc1
s_add_u32 s35, s35, 8192
v_mfma_f32_16x16x32_bf16 v[160:163], a[148:151], a[44:47], v[160:163]
L_stub16:
s_cbranch_execz L_stub17
s_add_u32 s33, s33, 8192
v_mfma_f32_16x16x32_bf16 v[136:139], a[148:151], a[36:39], v[136:139]
v_mfma_f32_16x16x32_bf16 v[136:139], a[144:147], a[32:35], v[136:139]
s_waitcnt vmcnt(10) lgkmcnt(0)
v_mfma_f32_16x16x32_bf16 v[140:143], a[96:99], a[64:67], v[140:143]
ds_read_b128 a[128:131], v5 offset:5120
v_mfma_f32_16x16x32_bf16 v[140:143], a[100:103], a[68:71], v[140:143]
buffer_load_dwordx4 a[32:35], v2, s[40:43], s35 offen offset:0 sc1
v_mfma_f32_16x16x32_bf16 v[164:167], a[100:103], a[76:79], v[164:167]
ds_read_b128 a[132:135], v5 offset:11264
v_mfma_f32_16x16x32_bf16 v[164:167], a[96:99], a[72:75], v[164:167]
v_mfma_f32_16x16x32_bf16 v[188:191], a[96:99], a[80:83], v[188:191]
v_mfma_f32_16x16x32_bf16 v[188:191], a[100:103], a[84:87], v[188:191]
buffer_load_dwordx4 a[36:39], v2, s[40:43], s33 offen offset:0 sc1
v_mfma_f32_16x16x32_bf16 v[212:215], a[100:103], a[92:95], v[212:215]
ds_read_b128 a[136:139], v5 offset:0
v_mfma_f32_16x16x32_bf16 v[212:215], a[96:99], a[88:91], v[212:215]
v_mfma_f32_16x16x32_bf16 v[216:219], a[104:107], a[88:91], v[216:219]
ds_read_b128 a[140:143], v5 offset:6144
v_mfma_f32_16x16x32_bf16 v[216:219], a[108:111], a[92:95], v[216:219]
v_mfma_f32_16x16x32_bf16 v[192:195], a[108:111], a[84:87], v[192:195]
buffer_load_dwordx4 v1, s[4:7], s44 offen offset:2048 sc1 lds
s_add_u32 m0, s18, 0x3000
v_mfma_f32_16x16x32_bf16 v[192:195], a[104:107], a[80:83], v[192:195]
s_add_u32 s44, s50, 0x1427000
ds_read_b128 a[144:147], v5 offset:1024
v_mfma_f32_16x16x32_bf16 v[168:171], a[104:107], a[72:75], v[168:171]
v_mfma_f32_16x16x32_bf16 v[168:171], a[108:111], a[76:79], v[168:171]
ds_read_b128 a[148:151], v5 offset:7168
v_mfma_f32_16x16x32_bf16 v[144:147], a[108:111], a[68:71], v[144:147]
v_mfma_f32_16x16x32_bf16 v[144:147], a[104:107], a[64:67], v[144:147]
buffer_load_dwordx4 a[40:43], v2, s[40:43], s35 offen offset:1024 sc1
v_mfma_f32_16x16x32_bf16 v[148:151], a[112:115], a[64:67], v[148:151]
v_mfma_f32_16x16x32_bf16 v[148:151], a[116:119], a[68:71], v[148:151]
v_mfma_f32_16x16x32_bf16 v[172:175], a[116:119], a[76:79], v[172:175]
v_mfma_f32_16x16x32_bf16 v[172:175], a[112:115], a[72:75], v[172:175]
v_mfma_f32_16x16x32_bf16 v[196:199], a[112:115], a[80:83], v[196:199]
buffer_load_dwordx4 a[44:47], v2, s[40:43], s33 offen offset:1024 sc1
v_mfma_f32_16x16x32_bf16 v[196:199], a[116:119], a[84:87], v[196:199]
v_mfma_f32_16x16x32_bf16 v[220:223], a[116:119], a[92:95], v[220:223]
v_mfma_f32_16x16x32_bf16 v[220:223], a[112:115], a[88:91], v[220:223]
s_waitcnt lgkmcnt(0)
v_mfma_f32_16x16x32_bf16 v[224:227], a[128:131], a[88:91], v[224:227]
ds_read_b128 a[96:99], v5 offset:14336
v_mfma_f32_16x16x32_bf16 v[224:227], a[132:135], a[92:95], v[224:227]
buffer_load_dwordx4 a[48:51], v2, s[40:43], s35 offen offset:2048 sc1
v_mfma_f32_16x16x32_bf16 v[200:203], a[132:135], a[84:87], v[200:203]
ds_read_b128 a[100:103], v5 offset:20480
v_mfma_f32_16x16x32_bf16 v[200:203], a[128:131], a[80:83], v[200:203]
v_mfma_f32_16x16x32_bf16 v[176:179], a[128:131], a[72:75], v[176:179]
v_mfma_f32_16x16x32_bf16 v[176:179], a[132:135], a[76:79], v[176:179]
buffer_load_dwordx4 a[52:55], v2, s[40:43], s33 offen offset:2048 sc1
v_mfma_f32_16x16x32_bf16 v[152:155], a[132:135], a[68:71], v[152:155]
ds_read_b128 a[104:107], v5 offset:15360
v_mfma_f32_16x16x32_bf16 v[152:155], a[128:131], a[64:67], v[152:155]
v_mfma_f32_16x16x32_bf16 v[132:135], a[136:139], a[64:67], v[132:135]
ds_read_b128 a[108:111], v5 offset:21504
v_mfma_f32_16x16x32_bf16 v[132:135], a[140:143], a[68:71], v[132:135]
v_mfma_f32_16x16x32_bf16 v[156:159], a[140:143], a[76:79], v[156:159]
buffer_load_dwordx4 v1, s[4:7], s44 offen offset:0 sc1 lds
v_mfma_f32_16x16x32_bf16 v[156:159], a[136:139], a[72:75], v[156:159]
ds_read_b128 a[112:115], v5 offset:16384
v_mfma_f32_16x16x32_bf16 v[180:183], a[136:139], a[80:83], v[180:183]
v_mfma_f32_16x16x32_bf16 v[180:183], a[140:143], a[84:87], v[180:183]
ds_read_b128 a[116:119], v5 offset:22528
v_mfma_f32_16x16x32_bf16 v[204:207], a[140:143], a[92:95], v[204:207]
v_mfma_f32_16x16x32_bf16 v[204:207], a[136:139], a[88:91], v[204:207]
buffer_load_dwordx4 a[56:59], v2, s[40:43], s35 offen offset:3072 sc1
v_mfma_f32_16x16x32_bf16 v[208:211], a[144:147], a[88:91], v[208:211]
v_mfma_f32_16x16x32_bf16 v[208:211], a[148:151], a[92:95], v[208:211]
v_mfma_f32_16x16x32_bf16 v[184:187], a[148:151], a[84:87], v[184:187]
v_mfma_f32_16x16x32_bf16 v[184:187], a[144:147], a[80:83], v[184:187]
v_mfma_f32_16x16x32_bf16 v[160:163], a[144:147], a[72:75], v[160:163]
buffer_load_dwordx4 a[60:63], v2, s[40:43], s33 offen offset:3072 sc1
s_add_u32 s35, s35, 8192
v_mfma_f32_16x16x32_bf16 v[160:163], a[148:151], a[76:79], v[160:163]
s_add_u32 s33, s33, 8192
v_mfma_f32_16x16x32_bf16 v[136:139], a[148:151], a[68:71], v[136:139]
v_mfma_f32_16x16x32_bf16 v[136:139], a[144:147], a[64:67], v[136:139]
s_waitcnt vmcnt(10) lgkmcnt(0)
v_mfma_f32_16x16x32_bf16 v[140:143], a[96:99], a[0:3], v[140:143]
ds_read_b128 a[128:131], v5 offset:17408
v_mfma_f32_16x16x32_bf16 v[140:143], a[100:103], a[4:7], v[140:143]
buffer_load_dwordx4 a[64:67], v2, s[40:43], s35 offen offset:0 sc1
v_mfma_f32_16x16x32_bf16 v[164:167], a[100:103], a[12:15], v[164:167]
ds_read_b128 a[132:135], v5 offset:23552
v_mfma_f32_16x16x32_bf16 v[164:167], a[96:99], a[8:11], v[164:167]
v_mfma_f32_16x16x32_bf16 v[188:191], a[96:99], a[16:19], v[188:191]
v_mfma_f32_16x16x32_bf16 v[188:191], a[100:103], a[20:23], v[188:191]
buffer_load_dwordx4 a[68:71], v2, s[40:43], s33 offen offset:0 sc1
v_mfma_f32_16x16x32_bf16 v[212:215], a[100:103], a[28:31], v[212:215]
ds_read_b128 a[136:139], v5 offset:12288
v_mfma_f32_16x16x32_bf16 v[212:215], a[96:99], a[24:27], v[212:215]
v_mfma_f32_16x16x32_bf16 v[216:219], a[104:107], a[24:27], v[216:219]
ds_read_b128 a[140:143], v5 offset:18432
v_mfma_f32_16x16x32_bf16 v[216:219], a[108:111], a[28:31], v[216:219]
v_mfma_f32_16x16x32_bf16 v[192:195], a[108:111], a[20:23], v[192:195]
buffer_load_dwordx4 v1, s[4:7], s44 offen offset:1024 sc1 lds
v_mfma_f32_16x16x32_bf16 v[192:195], a[104:107], a[16:19], v[192:195]
ds_read_b128 a[144:147], v5 offset:13312
v_mfma_f32_16x16x32_bf16 v[168:171], a[104:107], a[8:11], v[168:171]
v_mfma_f32_16x16x32_bf16 v[168:171], a[108:111], a[12:15], v[168:171]
ds_read_b128 a[148:151], v5 offset:19456
v_mfma_f32_16x16x32_bf16 v[144:147], a[108:111], a[4:7], v[144:147]
v_mfma_f32_16x16x32_bf16 v[144:147], a[104:107], a[0:3], v[144:147]
buffer_load_dwordx4 a[72:75], v2, s[40:43], s35 offen offset:1024 sc1
v_mfma_f32_16x16x32_bf16 v[148:151], a[112:115], a[0:3], v[148:151]
v_mfma_f32_16x16x32_bf16 v[148:151], a[116:119], a[4:7], v[148:151]
v_mfma_f32_16x16x32_bf16 v[172:175], a[116:119], a[12:15], v[172:175]
v_mfma_f32_16x16x32_bf16 v[172:175], a[112:115], a[8:11], v[172:175]
v_mfma_f32_16x16x32_bf16 v[196:199], a[112:115], a[16:19], v[196:199]
buffer_load_dwordx4 a[76:79], v2, s[40:43], s33 offen offset:1024 sc1
v_mfma_f32_16x16x32_bf16 v[196:199], a[116:119], a[20:23], v[196:199]
v_mfma_f32_16x16x32_bf16 v[220:223], a[116:119], a[28:31], v[220:223]
v_mfma_f32_16x16x32_bf16 v[220:223], a[112:115], a[24:27], v[220:223]
s_waitcnt lgkmcnt(0)
s_barrier
v_mfma_f32_16x16x32_bf16 v[224:227], a[128:131], a[24:27], v[224:227]
ds_read_b128 a[96:99], v5 offset:26624
v_mfma_f32_16x16x32_bf16 v[224:227], a[132:135], a[28:31], v[224:227]
buffer_load_dwordx4 a[80:83], v2, s[40:43], s35 offen offset:2048 sc1
v_mfma_f32_16x16x32_bf16 v[200:203], a[132:135], a[20:23], v[200:203]
ds_read_b128 a[100:103], v5 offset:32768
v_mfma_f32_16x16x32_bf16 v[200:203], a[128:131], a[16:19], v[200:203]
v_mfma_f32_16x16x32_bf16 v[176:179], a[128:131], a[8:11], v[176:179]
v_mfma_f32_16x16x32_bf16 v[176:179], a[132:135], a[12:15], v[176:179]
buffer_load_dwordx4 a[84:87], v2, s[40:43], s33 offen offset:2048 sc1
v_mfma_f32_16x16x32_bf16 v[152:155], a[132:135], a[4:7], v[152:155]
ds_read_b128 a[104:107], v5 offset:27648
v_mfma_f32_16x16x32_bf16 v[152:155], a[128:131], a[0:3], v[152:155]
v_mfma_f32_16x16x32_bf16 v[132:135], a[136:139], a[0:3], v[132:135]
ds_read_b128 a[108:111], v5 offset:33792
v_mfma_f32_16x16x32_bf16 v[132:135], a[140:143], a[4:7], v[132:135]
v_mfma_f32_16x16x32_bf16 v[156:159], a[140:143], a[12:15], v[156:159]
buffer_load_dwordx4 v1, s[4:7], s44 offen offset:2048 sc1 lds
s_add_u32 m0, s18, 0x6000
v_mfma_f32_16x16x32_bf16 v[156:159], a[136:139], a[8:11], v[156:159]
s_add_u32 s44, s50, 0x142a000
ds_read_b128 a[112:115], v5 offset:28672
v_mfma_f32_16x16x32_bf16 v[180:183], a[136:139], a[16:19], v[180:183]
v_mfma_f32_16x16x32_bf16 v[180:183], a[140:143], a[20:23], v[180:183]
ds_read_b128 a[116:119], v5 offset:34816
v_mfma_f32_16x16x32_bf16 v[204:207], a[140:143], a[28:31], v[204:207]
v_mfma_f32_16x16x32_bf16 v[204:207], a[136:139], a[24:27], v[204:207]
buffer_load_dwordx4 a[88:91], v2, s[40:43], s35 offen offset:3072 sc1
v_mfma_f32_16x16x32_bf16 v[208:211], a[144:147], a[24:27], v[208:211]
v_mfma_f32_16x16x32_bf16 v[208:211], a[148:151], a[28:31], v[208:211]
v_mfma_f32_16x16x32_bf16 v[184:187], a[148:151], a[20:23], v[184:187]
v_mfma_f32_16x16x32_bf16 v[184:187], a[144:147], a[16:19], v[184:187]
v_mfma_f32_16x16x32_bf16 v[160:163], a[144:147], a[8:11], v[160:163]
buffer_load_dwordx4 a[92:95], v2, s[40:43], s33 offen offset:3072 sc1
s_add_u32 s35, s35, 8192
v_mfma_f32_16x16x32_bf16 v[160:163], a[148:151], a[12:15], v[160:163]
s_add_u32 s33, s33, 8192
v_mfma_f32_16x16x32_bf16 v[136:139], a[148:151], a[4:7], v[136:139]
v_mfma_f32_16x16x32_bf16 v[136:139], a[144:147], a[0:3], v[136:139]
s_waitcnt vmcnt(10) lgkmcnt(0)
v_mfma_f32_16x16x32_bf16 v[140:143], a[96:99], a[32:35], v[140:143]
ds_read_b128 a[128:131], v5 offset:29696
v_mfma_f32_16x16x32_bf16 v[140:143], a[100:103], a[36:39], v[140:143]
buffer_load_dwordx4 a[0:3], v2, s[40:43], s35 offen offset:0 sc1
v_mfma_f32_16x16x32_bf16 v[164:167], a[100:103], a[44:47], v[164:167]
ds_read_b128 a[132:135], v5 offset:35840
v_mfma_f32_16x16x32_bf16 v[164:167], a[96:99], a[40:43], v[164:167]
v_mfma_f32_16x16x32_bf16 v[188:191], a[96:99], a[48:51], v[188:191]
v_mfma_f32_16x16x32_bf16 v[188:191], a[100:103], a[52:55], v[188:191]
buffer_load_dwordx4 a[4:7], v2, s[40:43], s33 offen offset:0 sc1
v_mfma_f32_16x16x32_bf16 v[212:215], a[100:103], a[60:63], v[212:215]
ds_read_b128 a[136:139], v5 offset:24576
v_mfma_f32_16x16x32_bf16 v[212:215], a[96:99], a[56:59], v[212:215]
v_mfma_f32_16x16x32_bf16 v[216:219], a[104:107], a[56:59], v[216:219]
ds_read_b128 a[140:143], v5 offset:30720
v_mfma_f32_16x16x32_bf16 v[216:219], a[108:111], a[60:63], v[216:219]
v_mfma_f32_16x16x32_bf16 v[192:195], a[108:111], a[52:55], v[192:195]
buffer_load_dwordx4 v1, s[4:7], s44 offen offset:0 sc1 lds
v_mfma_f32_16x16x32_bf16 v[192:195], a[104:107], a[48:51], v[192:195]
ds_read_b128 a[144:147], v5 offset:25600
v_mfma_f32_16x16x32_bf16 v[168:171], a[104:107], a[40:43], v[168:171]
v_mfma_f32_16x16x32_bf16 v[168:171], a[108:111], a[44:47], v[168:171]
ds_read_b128 a[148:151], v5 offset:31744
v_mfma_f32_16x16x32_bf16 v[144:147], a[108:111], a[36:39], v[144:147]
v_mfma_f32_16x16x32_bf16 v[144:147], a[104:107], a[32:35], v[144:147]
buffer_load_dwordx4 a[8:11], v2, s[40:43], s35 offen offset:1024 sc1
v_mfma_f32_16x16x32_bf16 v[148:151], a[112:115], a[32:35], v[148:151]
v_mfma_f32_16x16x32_bf16 v[148:151], a[116:119], a[36:39], v[148:151]
v_mfma_f32_16x16x32_bf16 v[172:175], a[116:119], a[44:47], v[172:175]
v_mfma_f32_16x16x32_bf16 v[172:175], a[112:115], a[40:43], v[172:175]
v_mfma_f32_16x16x32_bf16 v[196:199], a[112:115], a[48:51], v[196:199]
buffer_load_dwordx4 a[12:15], v2, s[40:43], s33 offen offset:1024 sc1
v_mfma_f32_16x16x32_bf16 v[196:199], a[116:119], a[52:55], v[196:199]
v_mfma_f32_16x16x32_bf16 v[220:223], a[116:119], a[60:63], v[220:223]
v_mfma_f32_16x16x32_bf16 v[220:223], a[112:115], a[56:59], v[220:223]
s_waitcnt lgkmcnt(0)
v_mfma_f32_16x16x32_bf16 v[224:227], a[128:131], a[56:59], v[224:227]
ds_read_b128 a[96:99], v5 offset:38912
v_mfma_f32_16x16x32_bf16 v[224:227], a[132:135], a[60:63], v[224:227]
buffer_load_dwordx4 a[16:19], v2, s[40:43], s35 offen offset:2048 sc1
v_mfma_f32_16x16x32_bf16 v[200:203], a[132:135], a[52:55], v[200:203]
ds_read_b128 a[100:103], v5 offset:45056
v_mfma_f32_16x16x32_bf16 v[200:203], a[128:131], a[48:51], v[200:203]
v_mfma_f32_16x16x32_bf16 v[176:179], a[128:131], a[40:43], v[176:179]
v_mfma_f32_16x16x32_bf16 v[176:179], a[132:135], a[44:47], v[176:179]
buffer_load_dwordx4 a[20:23], v2, s[40:43], s33 offen offset:2048 sc1
v_mfma_f32_16x16x32_bf16 v[152:155], a[132:135], a[36:39], v[152:155]
ds_read_b128 a[104:107], v5 offset:39936
v_mfma_f32_16x16x32_bf16 v[152:155], a[128:131], a[32:35], v[152:155]
v_mfma_f32_16x16x32_bf16 v[132:135], a[136:139], a[32:35], v[132:135]
ds_read_b128 a[108:111], v5 offset:46080
v_mfma_f32_16x16x32_bf16 v[132:135], a[140:143], a[36:39], v[132:135]
v_mfma_f32_16x16x32_bf16 v[156:159], a[140:143], a[44:47], v[156:159]
buffer_load_dwordx4 v1, s[4:7], s44 offen offset:1024 sc1 lds
v_mfma_f32_16x16x32_bf16 v[156:159], a[136:139], a[40:43], v[156:159]
ds_read_b128 a[112:115], v5 offset:40960
v_mfma_f32_16x16x32_bf16 v[180:183], a[136:139], a[48:51], v[180:183]
v_mfma_f32_16x16x32_bf16 v[180:183], a[140:143], a[52:55], v[180:183]
ds_read_b128 a[116:119], v5 offset:47104
v_mfma_f32_16x16x32_bf16 v[204:207], a[140:143], a[60:63], v[204:207]
v_mfma_f32_16x16x32_bf16 v[204:207], a[136:139], a[56:59], v[204:207]
buffer_load_dwordx4 a[24:27], v2, s[40:43], s35 offen offset:3072 sc1
v_mfma_f32_16x16x32_bf16 v[208:211], a[144:147], a[56:59], v[208:211]
v_mfma_f32_16x16x32_bf16 v[208:211], a[148:151], a[60:63], v[208:211]
v_mfma_f32_16x16x32_bf16 v[184:187], a[148:151], a[52:55], v[184:187]
v_mfma_f32_16x16x32_bf16 v[184:187], a[144:147], a[48:51], v[184:187]
v_mfma_f32_16x16x32_bf16 v[160:163], a[144:147], a[40:43], v[160:163]
buffer_load_dwordx4 a[28:31], v2, s[40:43], s33 offen offset:3072 sc1
s_add_u32 s35, s35, 8192
v_mfma_f32_16x16x32_bf16 v[160:163], a[148:151], a[44:47], v[160:163]
s_add_u32 s33, s33, 8192
v_mfma_f32_16x16x32_bf16 v[136:139], a[148:151], a[36:39], v[136:139]
v_mfma_f32_16x16x32_bf16 v[136:139], a[144:147], a[32:35], v[136:139]
s_waitcnt vmcnt(10) lgkmcnt(0)
v_mfma_f32_16x16x32_bf16 v[140:143], a[96:99], a[64:67], v[140:143]
ds_read_b128 a[128:131], v5 offset:41984
v_add_f32 v92, v92, v96
v_mfma_f32_16x16x32_bf16 v[140:143], a[100:103], a[68:71], v[140:143]
buffer_load_dwordx4 a[32:35], v2, s[40:43], s35 offen offset:0 sc1
v_mfma_f32_16x16x32_bf16 v[164:167], a[100:103], a[76:79], v[164:167]
ds_read_b128 a[132:135], v5 offset:48128
v_add_f32 v100, v100, v104
v_mfma_f32_16x16x32_bf16 v[164:167], a[96:99], a[72:75], v[164:167]
v_add_f32 v108, v108, v112
v_add_f32 v116, v116, v120
v_mfma_f32_16x16x32_bf16 v[188:191], a[96:99], a[80:83], v[188:191]
v_add_f32 v93, v93, v97
v_add_f32 v101, v101, v105
v_mfma_f32_16x16x32_bf16 v[188:191], a[100:103], a[84:87], v[188:191]
buffer_load_dwordx4 a[36:39], v2, s[40:43], s33 offen offset:0 sc1
v_mfma_f32_16x16x32_bf16 v[212:215], a[100:103], a[92:95], v[212:215]
ds_read_b128 a[136:139], v5 offset:36864
v_add_f32 v109, v109, v113
v_mfma_f32_16x16x32_bf16 v[212:215], a[96:99], a[88:91], v[212:215]
v_add_f32 v117, v117, v121
v_add_f32 v94, v94, v98
v_mfma_f32_16x16x32_bf16 v[216:219], a[104:107], a[88:91], v[216:219]
ds_read_b128 a[140:143], v5 offset:43008
v_add_f32 v102, v102, v106
v_mfma_f32_16x16x32_bf16 v[216:219], a[108:111], a[92:95], v[216:219]
v_add_f32 v110, v110, v114
v_mfma_f32_16x16x32_bf16 v[192:195], a[108:111], a[84:87], v[192:195]
buffer_load_dwordx4 v1, s[4:7], s44 offen offset:2048 sc1 lds
s_add_u32 m0, s18, 0x9000
v_mfma_f32_16x16x32_bf16 v[192:195], a[104:107], a[80:83], v[192:195]
s_add_u32 s44, s50, 0x142d000
ds_read_b128 a[144:147], v5 offset:37888
v_mfma_f32_16x16x32_bf16 v[168:171], a[104:107], a[72:75], v[168:171]
v_add_f32 v118, v118, v122
v_add_f32 v95, v95, v99
v_mfma_f32_16x16x32_bf16 v[168:171], a[108:111], a[76:79], v[168:171]
ds_read_b128 a[148:151], v5 offset:44032
v_add_f32 v103, v103, v107
v_mfma_f32_16x16x32_bf16 v[144:147], a[108:111], a[68:71], v[144:147]
v_add_f32 v111, v111, v115
v_add_f32 v119, v119, v123
v_mfma_f32_16x16x32_bf16 v[144:147], a[104:107], a[64:67], v[144:147]
buffer_load_dwordx4 a[40:43], v2, s[40:43], s35 offen offset:1024 sc1
v_mfma_f32_16x16x32_bf16 v[148:151], a[112:115], a[64:67], v[148:151]
v_add_f32_dpp v92, v92, v92 row_ror:8 row_mask:0xf bank_mask:0xf
v_add_f32_dpp v100, v100, v100 row_ror:8 row_mask:0xf bank_mask:0xf
v_mfma_f32_16x16x32_bf16 v[148:151], a[116:119], a[68:71], v[148:151]
v_add_f32_dpp v108, v108, v108 row_ror:8 row_mask:0xf bank_mask:0xf
v_mfma_f32_16x16x32_bf16 v[172:175], a[116:119], a[76:79], v[172:175]
v_add_f32_dpp v116, v116, v116 row_ror:8 row_mask:0xf bank_mask:0xf
v_mfma_f32_16x16x32_bf16 v[172:175], a[112:115], a[72:75], v[172:175]
v_add_f32_dpp v93, v93, v93 row_ror:8 row_mask:0xf bank_mask:0xf
v_mfma_f32_16x16x32_bf16 v[196:199], a[112:115], a[80:83], v[196:199]
buffer_load_dwordx4 a[44:47], v2, s[40:43], s33 offen offset:1024 sc1
v_mfma_f32_16x16x32_bf16 v[196:199], a[116:119], a[84:87], v[196:199]
v_add_f32_dpp v101, v101, v101 row_ror:8 row_mask:0xf bank_mask:0xf
v_add_f32_dpp v109, v109, v109 row_ror:8 row_mask:0xf bank_mask:0xf
v_mfma_f32_16x16x32_bf16 v[220:223], a[116:119], a[92:95], v[220:223]
v_add_f32_dpp v117, v117, v117 row_ror:8 row_mask:0xf bank_mask:0xf
v_mfma_f32_16x16x32_bf16 v[220:223], a[112:115], a[88:91], v[220:223]
s_waitcnt lgkmcnt(0)
s_barrier
v_mfma_f32_16x16x32_bf16 v[224:227], a[128:131], a[88:91], v[224:227]
v_add_u32 v5, 0, v1
v_add_f32_dpp v92, v94, v94 row_ror:8 row_mask:0xf bank_mask:0xc
v_mfma_f32_16x16x32_bf16 v[224:227], a[132:135], a[92:95], v[224:227]
buffer_load_dwordx4 a[48:51], v2, s[40:43], s35 offen offset:2048 sc1
v_mfma_f32_16x16x32_bf16 v[200:203], a[132:135], a[84:87], v[200:203]
ds_read_b128 a[96:99], v5 offset:2048
v_add_f32_dpp v100, v102, v102 row_ror:8 row_mask:0xf bank_mask:0xc
v_mfma_f32_16x16x32_bf16 v[200:203], a[128:131], a[80:83], v[200:203]
ds_read_b128 a[100:103], v5 offset:8192
v_add_f32_dpp v108, v110, v110 row_ror:8 row_mask:0xf bank_mask:0xc
v_mfma_f32_16x16x32_bf16 v[176:179], a[128:131], a[72:75], v[176:179]
v_add_f32_dpp v116, v118, v118 row_ror:8 row_mask:0xf bank_mask:0xc
v_add_f32_dpp v93, v95, v95 row_ror:8 row_mask:0xf bank_mask:0xc
v_mfma_f32_16x16x32_bf16 v[176:179], a[132:135], a[76:79], v[176:179]
buffer_load_dwordx4 a[52:55], v2, s[40:43], s33 offen offset:2048 sc1
v_mfma_f32_16x16x32_bf16 v[152:155], a[132:135], a[68:71], v[152:155]
ds_read_b128 a[104:107], v5 offset:3072
v_add_f32_dpp v101, v103, v103 row_ror:8 row_mask:0xf bank_mask:0xc
v_mfma_f32_16x16x32_bf16 v[152:155], a[128:131], a[64:67], v[152:155]
v_add_f32_dpp v109, v111, v111 row_ror:8 row_mask:0xf bank_mask:0xc
v_add_f32_dpp v117, v119, v119 row_ror:8 row_mask:0xf bank_mask:0xc
v_mfma_f32_16x16x32_bf16 v[132:135], a[136:139], a[64:67], v[132:135]
ds_read_b128 a[108:111], v5 offset:9216
v_mfma_f32_16x16x32_bf16 v[132:135], a[140:143], a[68:71], v[132:135]
v_permlane32_swap_b32 v92, v93
v_mfma_f32_16x16x32_bf16 v[156:159], a[140:143], a[76:79], v[156:159]
buffer_load_dwordx4 v1, s[4:7], s44 offen offset:0 sc1 lds
v_mfma_f32_16x16x32_bf16 v[156:159], a[136:139], a[72:75], v[156:159]
ds_read_b128 a[112:115], v5 offset:4096
v_mfma_f32_16x16x32_bf16 v[180:183], a[136:139], a[80:83], v[180:183]
v_permlane32_swap_b32 v100, v101
v_mfma_f32_16x16x32_bf16 v[180:183], a[140:143], a[84:87], v[180:183]
ds_read_b128 a[116:119], v5 offset:10240
v_mfma_f32_16x16x32_bf16 v[204:207], a[140:143], a[92:95], v[204:207]
v_permlane32_swap_b32 v108, v109
v_mfma_f32_16x16x32_bf16 v[204:207], a[136:139], a[88:91], v[204:207]
buffer_load_dwordx4 a[56:59], v2, s[40:43], s35 offen offset:3072 sc1
v_mfma_f32_16x16x32_bf16 v[208:211], a[144:147], a[88:91], v[208:211]
v_permlane32_swap_b32 v116, v117
v_mfma_f32_16x16x32_bf16 v[208:211], a[148:151], a[92:95], v[208:211]
v_add_f32 v92, v92, v93
v_add_f32 v100, v100, v101
v_mfma_f32_16x16x32_bf16 v[184:187], a[148:151], a[84:87], v[184:187]
v_add_f32 v108, v108, v109
v_add_f32 v116, v116, v117
v_mfma_f32_16x16x32_bf16 v[184:187], a[144:147], a[80:83], v[184:187]
v_mov_b32 v94, v92
v_mov_b32 v102, v100
v_mfma_f32_16x16x32_bf16 v[160:163], a[144:147], a[72:75], v[160:163]
buffer_load_dwordx4 a[60:63], v2, s[40:43], s33 offen offset:3072 sc1
s_add_u32 s35, s35, 8192
v_mfma_f32_16x16x32_bf16 v[160:163], a[148:151], a[76:79], v[160:163]
s_add_u32 s33, s33, 8192
v_mov_b32 v110, v108
v_mfma_f32_16x16x32_bf16 v[136:139], a[148:151], a[68:71], v[136:139]
v_mov_b32 v118, v116
v_mfma_f32_16x16x32_bf16 v[136:139], a[144:147], a[64:67], v[136:139]
s_waitcnt vmcnt(10) lgkmcnt(0)
v_mfma_f32_16x16x32_bf16 v[140:143], a[96:99], a[0:3], v[140:143]
ds_read_b128 a[128:131], v5 offset:5120
v_mfma_f32_16x16x32_bf16 v[140:143], a[100:103], a[4:7], v[140:143]
buffer_load_dwordx4 a[64:67], v2, s[40:43], s35 offen offset:0 sc1
v_mfma_f32_16x16x32_bf16 v[164:167], a[100:103], a[12:15], v[164:167]
ds_read_b128 a[132:135], v5 offset:11264
v_mfma_f32_16x16x32_bf16 v[164:167], a[96:99], a[8:11], v[164:167]
v_permlane16_swap_b32 v92, v94
v_mfma_f32_16x16x32_bf16 v[188:191], a[96:99], a[16:19], v[188:191]
v_permlane16_swap_b32 v100, v102
v_mfma_f32_16x16x32_bf16 v[188:191], a[100:103], a[20:23], v[188:191]
buffer_load_dwordx4 a[68:71], v2, s[40:43], s33 offen offset:0 sc1
v_mfma_f32_16x16x32_bf16 v[212:215], a[100:103], a[28:31], v[212:215]
ds_read_b128 a[136:139], v5 offset:0
v_mfma_f32_16x16x32_bf16 v[212:215], a[96:99], a[24:27], v[212:215]
v_permlane16_swap_b32 v108, v110
v_mfma_f32_16x16x32_bf16 v[216:219], a[104:107], a[24:27], v[216:219]
ds_read_b128 a[140:143], v5 offset:6144
v_mfma_f32_16x16x32_bf16 v[216:219], a[108:111], a[28:31], v[216:219]
v_permlane16_swap_b32 v116, v118
v_mfma_f32_16x16x32_bf16 v[192:195], a[108:111], a[20:23], v[192:195]
buffer_load_dwordx4 v1, s[4:7], s44 offen offset:1024 sc1 lds
v_mfma_f32_16x16x32_bf16 v[192:195], a[104:107], a[16:19], v[192:195]
ds_read_b128 a[144:147], v5 offset:1024
v_add_f32 v92, v92, v94
v_mfma_f32_16x16x32_bf16 v[168:171], a[104:107], a[8:11], v[168:171]
v_add_f32 v100, v100, v102
v_add_f32 v108, v108, v110
v_mfma_f32_16x16x32_bf16 v[168:171], a[108:111], a[12:15], v[168:171]
ds_read_b128 a[148:151], v5 offset:7168
v_add_f32 v116, v116, v118
v_mfma_f32_16x16x32_bf16 v[144:147], a[108:111], a[4:7], v[144:147]
v_mov_b32 v94, v92
v_mov_b32 v102, v100
v_mfma_f32_16x16x32_bf16 v[144:147], a[104:107], a[0:3], v[144:147]
buffer_load_dwordx4 a[72:75], v2, s[40:43], s35 offen offset:1024 sc1
v_mfma_f32_16x16x32_bf16 v[148:151], a[112:115], a[0:3], v[148:151]
v_mov_b32 v110, v108
v_mov_b32 v118, v116
v_mfma_f32_16x16x32_bf16 v[148:151], a[116:119], a[4:7], v[148:151]
v_permlane32_swap_b32 v92, v94
v_mfma_f32_16x16x32_bf16 v[172:175], a[116:119], a[12:15], v[172:175]
v_permlane32_swap_b32 v100, v102
v_mfma_f32_16x16x32_bf16 v[172:175], a[112:115], a[8:11], v[172:175]
v_permlane32_swap_b32 v108, v110
v_mfma_f32_16x16x32_bf16 v[196:199], a[112:115], a[16:19], v[196:199]
buffer_load_dwordx4 a[76:79], v2, s[40:43], s33 offen offset:1024 sc1
v_mfma_f32_16x16x32_bf16 v[196:199], a[116:119], a[20:23], v[196:199]
v_permlane32_swap_b32 v116, v118
v_mfma_f32_16x16x32_bf16 v[220:223], a[116:119], a[28:31], v[220:223]
v_mul_f32 v82, 0xba800000, v92
v_mul_f32 v84, 0xba800000, v100
v_mfma_f32_16x16x32_bf16 v[220:223], a[112:115], a[24:27], v[220:223]
v_mul_f32 v86, 0xba800000, v108
s_waitcnt lgkmcnt(0)
v_mfma_f32_16x16x32_bf16 v[224:227], a[128:131], a[24:27], v[224:227]
ds_read_b128 a[96:99], v5 offset:14336
v_mul_f32 v88, 0xba800000, v116
v_mfma_f32_16x16x32_bf16 v[224:227], a[132:135], a[28:31], v[224:227]
buffer_load_dwordx4 a[80:83], v2, s[40:43], s35 offen offset:2048 sc1
v_mfma_f32_16x16x32_bf16 v[200:203], a[132:135], a[20:23], v[200:203]
ds_read_b128 a[100:103], v5 offset:20480
v_mul_f32 v94, 0x3a800000, v94
v_mfma_f32_16x16x32_bf16 v[200:203], a[128:131], a[16:19], v[200:203]
v_mul_f32 v102, 0x3a800000, v102
v_mul_f32 v110, 0x3a800000, v110
v_mfma_f32_16x16x32_bf16 v[176:179], a[128:131], a[8:11], v[176:179]
v_mul_f32 v118, 0x3a800000, v118
v_fma_f32 v94, -v82, v82, v94
v_mfma_f32_16x16x32_bf16 v[176:179], a[132:135], a[12:15], v[176:179]
buffer_load_dwordx4 a[84:87], v2, s[40:43], s33 offen offset:2048 sc1
v_mfma_f32_16x16x32_bf16 v[152:155], a[132:135], a[4:7], v[152:155]
ds_read_b128 a[104:107], v5 offset:15360
v_fma_f32 v102, -v84, v84, v102
v_mfma_f32_16x16x32_bf16 v[152:155], a[128:131], a[0:3], v[152:155]
v_fma_f32 v110, -v86, v86, v110
v_fma_f32 v118, -v88, v88, v118
v_mfma_f32_16x16x32_bf16 v[132:135], a[136:139], a[0:3], v[132:135]
ds_read_b128 a[108:111], v5 offset:21504
v_max_f32 v94, 0, v94
v_mfma_f32_16x16x32_bf16 v[132:135], a[140:143], a[4:7], v[132:135]
v_max_f32 v102, 0, v102
v_mfma_f32_16x16x32_bf16 v[156:159], a[140:143], a[12:15], v[156:159]
buffer_load_dwordx4 v1, s[4:7], s44 offen offset:2048 sc1 lds
s_add_u32 m0, s19, 49152
v_mfma_f32_16x16x32_bf16 v[156:159], a[136:139], a[8:11], v[156:159]
s_add_u32 s44, s85, 0xc04000
ds_read_b128 a[112:115], v5 offset:16384
v_mfma_f32_16x16x32_bf16 v[180:183], a[136:139], a[16:19], v[180:183]
v_max_f32 v110, 0, v110
v_max_f32 v118, 0, v118
v_mfma_f32_16x16x32_bf16 v[180:183], a[140:143], a[20:23], v[180:183]
ds_read_b128 a[116:119], v5 offset:22528
v_add_f32 v94, 0x3727c5ac, v94
v_mfma_f32_16x16x32_bf16 v[204:207], a[140:143], a[28:31], v[204:207]
v_add_f32 v102, 0x3727c5ac, v102
v_add_f32 v110, 0x3727c5ac, v110
v_mfma_f32_16x16x32_bf16 v[204:207], a[136:139], a[24:27], v[204:207]
buffer_load_dwordx4 a[88:91], v2, s[40:43], s35 offen offset:3072 sc1
v_mfma_f32_16x16x32_bf16 v[208:211], a[144:147], a[24:27], v[208:211]
v_add_f32 v118, 0x3727c5ac, v118
v_mfma_f32_16x16x32_bf16 v[208:211], a[148:151], a[28:31], v[208:211]
v_rsq_f32 v83, v94
v_mfma_f32_16x16x32_bf16 v[184:187], a[148:151], a[20:23], v[184:187]
v_rsq_f32 v85, v102
v_mfma_f32_16x16x32_bf16 v[184:187], a[144:147], a[16:19], v[184:187]
v_mfma_f32_16x16x32_bf16 v[160:163], a[144:147], a[8:11], v[160:163]
buffer_load_dwordx4 a[92:95], v2, s[40:43], s33 offen offset:3072 sc1
s_add_u32 s35, s35, 8192
v_mfma_f32_16x16x32_bf16 v[160:163], a[148:151], a[12:15], v[160:163]
s_add_u32 s33, s33, 8192
v_mfma_f32_16x16x32_bf16 v[136:139], a[148:151], a[4:7], v[136:139]
v_rsq_f32 v87, v110
v_mfma_f32_16x16x32_bf16 v[136:139], a[144:147], a[0:3], v[136:139]
s_waitcnt vmcnt(10) lgkmcnt(0)
v_mfma_f32_16x16x32_bf16 v[140:143], a[96:99], a[32:35], v[140:143]
ds_read_b128 a[128:131], v5 offset:17408
v_mfma_f32_16x16x32_bf16 v[140:143], a[100:103], a[36:39], v[140:143]
buffer_load_dwordx4 a[0:3], v2, s[40:43], s35 offen offset:0 sc1
v_mfma_f32_16x16x32_bf16 v[164:167], a[100:103], a[44:47], v[164:167]
ds_read_b128 a[132:135], v5 offset:23552
v_mfma_f32_16x16x32_bf16 v[164:167], a[96:99], a[40:43], v[164:167]
v_rsq_f32 v89, v118
v_mfma_f32_16x16x32_bf16 v[188:191], a[96:99], a[48:51], v[188:191]
v_mfma_f32_16x16x32_bf16 v[188:191], a[100:103], a[52:55], v[188:191]
buffer_load_dwordx4 a[4:7], v2, s[40:43], s33 offen offset:0 sc1
v_mfma_f32_16x16x32_bf16 v[212:215], a[100:103], a[60:63], v[212:215]
ds_read_b128 a[136:139], v5 offset:12288
v_mfma_f32_16x16x32_bf16 v[212:215], a[96:99], a[56:59], v[212:215]
v_mfma_f32_16x16x32_bf16 v[216:219], a[104:107], a[56:59], v[216:219]
ds_read_b128 a[140:143], v5 offset:18432
v_mfma_f32_16x16x32_bf16 v[216:219], a[108:111], a[60:63], v[216:219]
v_mfma_f32_16x16x32_bf16 v[192:195], a[108:111], a[52:55], v[192:195]
buffer_load_dwordx4 v1, s[4:7], s44 offen offset:0 sc1 lds
v_mfma_f32_16x16x32_bf16 v[192:195], a[104:107], a[48:51], v[192:195]
ds_read_b128 a[144:147], v5 offset:13312
v_fmac_f32 v140, v56, v82
v_mfma_f32_16x16x32_bf16 v[168:171], a[104:107], a[40:43], v[168:171]
v_fmac_f32 v164, v56, v84
v_mfma_f32_16x16x32_bf16 v[168:171], a[108:111], a[44:47], v[168:171]
ds_read_b128 a[148:151], v5 offset:19456
v_mfma_f32_16x16x32_bf16 v[144:147], a[108:111], a[36:39], v[144:147]
v_fmac_f32 v188, v56, v86
v_mfma_f32_16x16x32_bf16 v[144:147], a[104:107], a[32:35], v[144:147]
buffer_load_dwordx4 a[8:11], v2, s[40:43], s35 offen offset:1024 sc1
v_mfma_f32_16x16x32_bf16 v[148:151], a[112:115], a[32:35], v[148:151]
v_fmac_f32 v212, v56, v88
v_mfma_f32_16x16x32_bf16 v[148:151], a[116:119], a[36:39], v[148:151]
v_mfma_f32_16x16x32_bf16 v[172:175], a[116:119], a[44:47], v[172:175]
v_fmac_f32 v216, v60, v88
v_mfma_f32_16x16x32_bf16 v[172:175], a[112:115], a[40:43], v[172:175]
v_mfma_f32_16x16x32_bf16 v[196:199], a[112:115], a[48:51], v[196:199]
buffer_load_dwordx4 a[12:15], v2, s[40:43], s33 offen offset:1024 sc1
v_mfma_f32_16x16x32_bf16 v[196:199], a[116:119], a[52:55], v[196:199]
v_fmac_f32 v192, v60, v86
v_mfma_f32_16x16x32_bf16 v[220:223], a[116:119], a[60:63], v[220:223]
v_fmac_f32 v168, v60, v84
v_fmac_f32 v141, v57, v82
v_mfma_f32_16x16x32_bf16 v[220:223], a[112:115], a[56:59], v[220:223]
s_waitcnt vmcnt(7) lgkmcnt(0)
s_barrier
v_mfma_f32_16x16x32_bf16 v[224:227], a[128:131], a[56:59], v[224:227]
ds_read_b128 a[96:99], v5 offset:26624
v_fmac_f32 v144, v60, v82
v_mfma_f32_16x16x32_bf16 v[224:227], a[132:135], a[60:63], v[224:227]
buffer_load_dwordx4 a[16:19], v2, s[40:43], s35 offen offset:2048 sc1
v_mfma_f32_16x16x32_bf16 v[200:203], a[132:135], a[52:55], v[200:203]
ds_read_b128 a[100:103], v5 offset:32768
v_fmac_f32 v148, v64, v82
v_mfma_f32_16x16x32_bf16 v[200:203], a[128:131], a[48:51], v[200:203]
v_fmac_f32 v165, v57, v84
v_fmac_f32 v189, v57, v86
v_mfma_f32_16x16x32_bf16 v[176:179], a[128:131], a[40:43], v[176:179]
v_fmac_f32 v172, v64, v84
v_fmac_f32 v213, v57, v88
v_mfma_f32_16x16x32_bf16 v[176:179], a[132:135], a[44:47], v[176:179]
buffer_load_dwordx4 a[20:23], v2, s[40:43], s33 offen offset:2048 sc1
v_mfma_f32_16x16x32_bf16 v[152:155], a[132:135], a[36:39], v[152:155]
ds_read_b128 a[104:107], v5 offset:27648
v_fmac_f32 v196, v64, v86
v_mfma_f32_16x16x32_bf16 v[152:155], a[128:131], a[32:35], v[152:155]
v_fmac_f32 v217, v61, v88
v_mfma_f32_16x16x32_bf16 v[132:135], a[136:139], a[32:35], v[132:135]
ds_read_b128 a[108:111], v5 offset:33792
v_fmac_f32 v220, v64, v88
v_mfma_f32_16x16x32_bf16 v[132:135], a[140:143], a[36:39], v[132:135]
v_fmac_f32 v193, v61, v86
v_mfma_f32_16x16x32_bf16 v[156:159], a[140:143], a[44:47], v[156:159]
buffer_load_dwordx4 v1, s[4:7], s44 offen offset:1024 sc1 lds
v_mfma_f32_16x16x32_bf16 v[156:159], a[136:139], a[40:43], v[156:159]
ds_read_b128 a[112:115], v5 offset:28672
v_fmac_f32 v224, v68, v88
v_mfma_f32_16x16x32_bf16 v[180:183], a[136:139], a[48:51], v[180:183]
v_fmac_f32 v200, v68, v86
v_fmac_f32 v169, v61, v84
v_mfma_f32_16x16x32_bf16 v[180:183], a[140:143], a[52:55], v[180:183]
ds_read_b128 a[116:119], v5 offset:34816
v_fmac_f32 v145, v61, v82
v_mfma_f32_16x16x32_bf16 v[204:207], a[140:143], a[60:63], v[204:207]
v_fmac_f32 v176, v68, v84
v_fmac_f32 v149, v65, v82
v_mfma_f32_16x16x32_bf16 v[204:207], a[136:139], a[56:59], v[204:207]
buffer_load_dwordx4 a[24:27], v2, s[40:43], s35 offen offset:3072 sc1
v_mfma_f32_16x16x32_bf16 v[208:211], a[144:147], a[56:59], v[208:211]
v_fmac_f32 v152, v68, v82
L_stub17:
s_cbranch_execz L_stub18
v_fmac_f32 v173, v65, v84
v_mfma_f32_16x16x32_bf16 v[208:211], a[148:151], a[60:63], v[208:211]
v_mfma_f32_16x16x32_bf16 v[184:187], a[148:151], a[52:55], v[184:187]
v_fmac_f32 v132, v48, v82
v_fmac_f32 v197, v65, v86
v_mfma_f32_16x16x32_bf16 v[184:187], a[144:147], a[48:51], v[184:187]
v_mfma_f32_16x16x32_bf16 v[160:163], a[144:147], a[40:43], v[160:163]
buffer_load_dwordx4 a[28:31], v2, s[40:43], s33 offen offset:3072 sc1
s_add_u32 s35, s35, 8192
v_mfma_f32_16x16x32_bf16 v[160:163], a[148:151], a[44:47], v[160:163]
s_add_u32 s33, s33, 8192
v_fmac_f32 v156, v48, v84
v_mfma_f32_16x16x32_bf16 v[136:139], a[148:151], a[36:39], v[136:139]
v_fmac_f32 v180, v48, v86
v_fmac_f32 v221, v65, v88
v_mfma_f32_16x16x32_bf16 v[136:139], a[144:147], a[32:35], v[136:139]
v_fmac_f32 v225, v69, v88
s_waitcnt vmcnt(10) lgkmcnt(0)
v_mfma_f32_16x16x32_bf16 v[140:143], a[96:99], a[64:67], v[140:143]
ds_read_b128 a[128:131], v5 offset:29696
v_fmac_f32 v204, v48, v88
v_mfma_f32_16x16x32_bf16 v[140:143], a[100:103], a[68:71], v[140:143]
buffer_load_dwordx4 v1, s[4:7], s44 offen offset:2048 sc1 lds
v_mfma_f32_16x16x32_bf16 v[164:167], a[100:103], a[76:79], v[164:167]
ds_read_b128 a[132:135], v5 offset:35840
v_fmac_f32 v208, v52, v88
v_mfma_f32_16x16x32_bf16 v[164:167], a[96:99], a[72:75], v[164:167]
v_fmac_f32 v201, v69, v86
v_fmac_f32 v177, v69, v84
v_mfma_f32_16x16x32_bf16 v[188:191], a[96:99], a[80:83], v[188:191]
v_fmac_f32 v184, v52, v86
v_fmac_f32 v153, v69, v82
v_mfma_f32_16x16x32_bf16 v[188:191], a[100:103], a[84:87], v[188:191]
buffer_load_dwordx4 v1, s[4:7], s44 offen offset:3072 sc1 lds
s_add_u32 m0, s19, 65536
v_mfma_f32_16x16x32_bf16 v[212:215], a[100:103], a[92:95], v[212:215]
s_add_u32 s44, s84, 0xc08000
ds_read_b128 a[136:139], v5 offset:24576
v_mfma_f32_16x16x32_bf16 v[212:215], a[96:99], a[88:91], v[212:215]
v_fmac_f32 v160, v52, v84
v_fmac_f32 v133, v49, v82
v_mfma_f32_16x16x32_bf16 v[216:219], a[104:107], a[88:91], v[216:219]
ds_read_b128 a[140:143], v5 offset:30720
v_fmac_f32 v136, v52, v82
v_mfma_f32_16x16x32_bf16 v[216:219], a[108:111], a[92:95], v[216:219]
v_fmac_f32 v157, v49, v84
v_mfma_f32_16x16x32_bf16 v[192:195], a[108:111], a[84:87], v[192:195]
buffer_load_dwordx4 v1, s[4:7], s44 offen offset:0 sc1 lds
v_mfma_f32_16x16x32_bf16 v[192:195], a[104:107], a[80:83], v[192:195]
ds_read_b128 a[144:147], v5 offset:25600
v_fmac_f32 v181, v49, v86
v_mfma_f32_16x16x32_bf16 v[168:171], a[104:107], a[72:75], v[168:171]
v_fmac_f32 v205, v49, v88
v_fmac_f32 v142, v58, v82
v_mfma_f32_16x16x32_bf16 v[168:171], a[108:111], a[76:79], v[168:171]
ds_read_b128 a[148:151], v5 offset:31744
v_fmac_f32 v166, v58, v84
v_mfma_f32_16x16x32_bf16 v[144:147], a[108:111], a[68:71], v[144:147]
v_fmac_f32 v209, v53, v88
v_fmac_f32 v190, v58, v86
v_mfma_f32_16x16x32_bf16 v[144:147], a[104:107], a[64:67], v[144:147]
buffer_load_dwordx4 v1, s[4:7], s44 offen offset:1024 sc1 lds
v_mfma_f32_16x16x32_bf16 v[148:151], a[112:115], a[64:67], v[148:151]
v_fmac_f32 v185, v53, v86
v_fmac_f32 v214, v58, v88
v_mfma_f32_16x16x32_bf16 v[148:151], a[116:119], a[68:71], v[148:151]
v_mfma_f32_16x16x32_bf16 v[172:175], a[116:119], a[76:79], v[172:175]
v_fmac_f32 v161, v53, v84
v_fmac_f32 v218, v62, v88
v_mfma_f32_16x16x32_bf16 v[172:175], a[112:115], a[72:75], v[172:175]
v_mfma_f32_16x16x32_bf16 v[196:199], a[112:115], a[80:83], v[196:199]
buffer_load_dwordx4 v1, s[4:7], s44 offen offset:2048 sc1 lds
v_mfma_f32_16x16x32_bf16 v[196:199], a[116:119], a[84:87], v[196:199]
v_fmac_f32 v137, v53, v82
v_fmac_f32 v194, v62, v86
v_mfma_f32_16x16x32_bf16 v[220:223], a[116:119], a[92:95], v[220:223]
v_fmac_f32 v170, v62, v84
v_fmac_f32 v143, v59, v82
v_mfma_f32_16x16x32_bf16 v[220:223], a[112:115], a[88:91], v[220:223]
s_waitcnt lgkmcnt(0)
v_mfma_f32_16x16x32_bf16 v[224:227], a[128:131], a[88:91], v[224:227]
ds_read_b128 a[96:99], v5 offset:38912
v_fmac_f32 v146, v62, v82
v_mfma_f32_16x16x32_bf16 v[224:227], a[132:135], a[92:95], v[224:227]
buffer_load_dwordx4 v1, s[4:7], s44 offen offset:3072 sc1 lds
s_add_u32 m0, s19, 81920
v_mfma_f32_16x16x32_bf16 v[200:203], a[132:135], a[84:87], v[200:203]
s_add_u32 s44, s85, 0xc0c000
ds_read_b128 a[100:103], v5 offset:45056
v_mfma_f32_16x16x32_bf16 v[200:203], a[128:131], a[80:83], v[200:203]
v_fmac_f32 v150, v66, v82
v_fmac_f32 v167, v59, v84
v_mfma_f32_16x16x32_bf16 v[176:179], a[128:131], a[72:75], v[176:179]
v_fmac_f32 v174, v66, v84
v_fmac_f32 v191, v59, v86
v_mfma_f32_16x16x32_bf16 v[176:179], a[132:135], a[76:79], v[176:179]
buffer_load_dwordx4 v1, s[4:7], s44 offen offset:0 sc1 lds
v_mfma_f32_16x16x32_bf16 v[152:155], a[132:135], a[68:71], v[152:155]
ds_read_b128 a[104:107], v5 offset:39936
v_fmac_f32 v198, v66, v86
v_mfma_f32_16x16x32_bf16 v[152:155], a[128:131], a[64:67], v[152:155]
v_fmac_f32 v215, v59, v88
v_fmac_f32 v219, v63, v88
v_mfma_f32_16x16x32_bf16 v[132:135], a[136:139], a[64:67], v[132:135]
ds_read_b128 a[108:111], v5 offset:46080
v_fmac_f32 v222, v66, v88
v_mfma_f32_16x16x32_bf16 v[132:135], a[140:143], a[68:71], v[132:135]
v_fmac_f32 v195, v63, v86
v_mfma_f32_16x16x32_bf16 v[156:159], a[140:143], a[76:79], v[156:159]
buffer_load_dwordx4 v1, s[4:7], s44 offen offset:1024 sc1 lds
v_mfma_f32_16x16x32_bf16 v[156:159], a[136:139], a[72:75], v[156:159]
ds_read_b128 a[112:115], v5 offset:40960
v_fmac_f32 v226, v70, v88
v_mfma_f32_16x16x32_bf16 v[180:183], a[136:139], a[80:83], v[180:183]
v_fmac_f32 v202, v70, v86
v_fmac_f32 v171, v63, v84
v_mfma_f32_16x16x32_bf16 v[180:183], a[140:143], a[84:87], v[180:183]
ds_read_b128 a[116:119], v5 offset:47104
v_fmac_f32 v147, v63, v82
v_mfma_f32_16x16x32_bf16 v[204:207], a[140:143], a[92:95], v[204:207]
v_fmac_f32 v178, v70, v84
v_fmac_f32 v151, v67, v82
v_mfma_f32_16x16x32_bf16 v[204:207], a[136:139], a[88:91], v[204:207]
buffer_load_dwordx4 v1, s[4:7], s44 offen offset:2048 sc1 lds
v_mfma_f32_16x16x32_bf16 v[208:211], a[144:147], a[88:91], v[208:211]
v_fmac_f32 v154, v70, v82
v_fmac_f32 v175, v67, v84
v_mfma_f32_16x16x32_bf16 v[208:211], a[148:151], a[92:95], v[208:211]
v_mfma_f32_16x16x32_bf16 v[184:187], a[148:151], a[84:87], v[184:187]
v_fmac_f32 v134, v50, v82
v_fmac_f32 v199, v67, v86
v_mfma_f32_16x16x32_bf16 v[184:187], a[144:147], a[80:83], v[184:187]
v_mfma_f32_16x16x32_bf16 v[160:163], a[144:147], a[72:75], v[160:163]
buffer_load_dwordx4 v1, s[4:7], s44 offen offset:3072 sc1 lds
s_add_u32 m0, s19, 147456
v_mfma_f32_16x16x32_bf16 v[160:163], a[148:151], a[76:79], v[160:163]
s_add_u32 s44, s87, 0xc1c000
v_fmac_f32 v158, v50, v84
v_mfma_f32_16x16x32_bf16 v[136:139], a[148:151], a[68:71], v[136:139]
v_fmac_f32 v182, v50, v86
v_fmac_f32 v223, v67, v88
v_mfma_f32_16x16x32_bf16 v[136:139], a[144:147], a[64:67], v[136:139]
v_fmac_f32 v227, v71, v88
s_waitcnt vmcnt(10) lgkmcnt(0)
v_mfma_f32_16x16x32_bf16 v[140:143], a[96:99], a[0:3], v[140:143]
ds_read_b128 a[128:131], v5 offset:41984
v_fmac_f32 v206, v50, v88
v_mfma_f32_16x16x32_bf16 v[140:143], a[100:103], a[4:7], v[140:143]
buffer_load_dwordx4 v1, s[4:7], s44 offen offset:0 sc1 lds
v_mfma_f32_16x16x32_bf16 v[164:167], a[100:103], a[12:15], v[164:167]
ds_read_b128 a[132:135], v5 offset:48128
v_fmac_f32 v210, v54, v88
v_mfma_f32_16x16x32_bf16 v[164:167], a[96:99], a[8:11], v[164:167]
v_fmac_f32 v203, v71, v86
v_fmac_f32 v179, v71, v84
v_mfma_f32_16x16x32_bf16 v[188:191], a[96:99], a[16:19], v[188:191]
v_fmac_f32 v186, v54, v86
v_fmac_f32 v155, v71, v82
v_mfma_f32_16x16x32_bf16 v[188:191], a[100:103], a[20:23], v[188:191]
buffer_load_dwordx4 v1, s[4:7], s44 offen offset:1024 sc1 lds
v_mfma_f32_16x16x32_bf16 v[212:215], a[100:103], a[28:31], v[212:215]
ds_read_b128 a[136:139], v5 offset:36864
v_fmac_f32 v162, v54, v84
v_mfma_f32_16x16x32_bf16 v[212:215], a[96:99], a[24:27], v[212:215]
v_fmac_f32 v135, v51, v82
v_mfma_f32_16x16x32_bf16 v[216:219], a[104:107], a[24:27], v[216:219]
ds_read_b128 a[140:143], v5 offset:43008
v_fmac_f32 v138, v54, v82
v_mfma_f32_16x16x32_bf16 v[216:219], a[108:111], a[28:31], v[216:219]
v_fmac_f32 v159, v51, v84
v_mfma_f32_16x16x32_bf16 v[192:195], a[108:111], a[20:23], v[192:195]
buffer_load_dwordx4 v1, s[4:7], s44 offen offset:2048 sc1 lds
v_mfma_f32_16x16x32_bf16 v[192:195], a[104:107], a[16:19], v[192:195]
ds_read_b128 a[144:147], v5 offset:37888
v_fmac_f32 v183, v51, v86
v_mfma_f32_16x16x32_bf16 v[168:171], a[104:107], a[8:11], v[168:171]
v_fmac_f32 v207, v51, v88
v_mfma_f32_16x16x32_bf16 v[168:171], a[108:111], a[12:15], v[168:171]
ds_read_b128 a[148:151], v5 offset:44032
v_mfma_f32_16x16x32_bf16 v[144:147], a[108:111], a[4:7], v[144:147]
v_fmac_f32 v211, v55, v88
v_mfma_f32_16x16x32_bf16 v[144:147], a[104:107], a[0:3], v[144:147]
buffer_load_dwordx4 v1, s[4:7], s44 offen offset:3072 sc1 lds
s_add_u32 m0, s19, 98304
v_mfma_f32_16x16x32_bf16 v[148:151], a[112:115], a[0:3], v[148:151]
s_add_u32 s44, s84, 0xc10000
v_fmac_f32 v187, v55, v86
v_mfma_f32_16x16x32_bf16 v[148:151], a[116:119], a[4:7], v[148:151]
v_mfma_f32_16x16x32_bf16 v[172:175], a[116:119], a[12:15], v[172:175]
v_fmac_f32 v163, v55, v84
v_mfma_f32_16x16x32_bf16 v[172:175], a[112:115], a[8:11], v[172:175]
v_mfma_f32_16x16x32_bf16 v[196:199], a[112:115], a[16:19], v[196:199]
buffer_load_dwordx4 v1, s[4:7], s44 offen offset:0 sc1 lds
v_mfma_f32_16x16x32_bf16 v[196:199], a[116:119], a[20:23], v[196:199]
v_fmac_f32 v139, v55, v82
v_mfma_f32_16x16x32_bf16 v[220:223], a[116:119], a[28:31], v[220:223]
v_mfma_f32_16x16x32_bf16 v[220:223], a[112:115], a[24:27], v[220:223]
s_waitcnt lgkmcnt(0)
s_barrier
v_mfma_f32_16x16x32_bf16 v[224:227], a[128:131], a[24:27], v[224:227]
v_mfma_f32_16x16x32_bf16 v[224:227], a[132:135], a[28:31], v[224:227]
buffer_load_dwordx4 v1, s[4:7], s44 offen offset:1024 sc1 lds
v_mfma_f32_16x16x32_bf16 v[200:203], a[132:135], a[20:23], v[200:203]
v_mfma_f32_16x16x32_bf16 v[200:203], a[128:131], a[16:19], v[200:203]
v_mfma_f32_16x16x32_bf16 v[176:179], a[128:131], a[8:11], v[176:179]
v_mfma_f32_16x16x32_bf16 v[176:179], a[132:135], a[12:15], v[176:179]
v_mfma_f32_16x16x32_bf16 v[152:155], a[132:135], a[4:7], v[152:155]
v_mfma_f32_16x16x32_bf16 v[152:155], a[128:131], a[0:3], v[152:155]
v_mfma_f32_16x16x32_bf16 v[132:135], a[136:139], a[0:3], v[132:135]
v_mfma_f32_16x16x32_bf16 v[132:135], a[140:143], a[4:7], v[132:135]
buffer_load_dwordx4 v1, s[4:7], s44 offen offset:2048 sc1 lds
v_mfma_f32_16x16x32_bf16 v[156:159], a[140:143], a[12:15], v[156:159]
v_mfma_f32_16x16x32_bf16 v[156:159], a[136:139], a[8:11], v[156:159]
v_mfma_f32_16x16x32_bf16 v[180:183], a[136:139], a[16:19], v[180:183]
v_mfma_f32_16x16x32_bf16 v[180:183], a[140:143], a[20:23], v[180:183]
v_mfma_f32_16x16x32_bf16 v[204:207], a[140:143], a[28:31], v[204:207]
v_mfma_f32_16x16x32_bf16 v[204:207], a[136:139], a[24:27], v[204:207]
v_mfma_f32_16x16x32_bf16 v[208:211], a[144:147], a[24:27], v[208:211]
v_mfma_f32_16x16x32_bf16 v[208:211], a[148:151], a[28:31], v[208:211]
buffer_load_dwordx4 v1, s[4:7], s44 offen offset:3072 sc1 lds
v_mfma_f32_16x16x32_bf16 v[184:187], a[148:151], a[20:23], v[184:187]
v_mfma_f32_16x16x32_bf16 v[184:187], a[144:147], a[16:19], v[184:187]
v_mfma_f32_16x16x32_bf16 v[160:163], a[144:147], a[8:11], v[160:163]
v_mfma_f32_16x16x32_bf16 v[160:163], a[148:151], a[12:15], v[160:163]
v_mfma_f32_16x16x32_bf16 v[136:139], a[148:151], a[4:7], v[136:139]
v_mfma_f32_16x16x32_bf16 v[136:139], a[144:147], a[0:3], v[136:139]
.set L_cpf3, .
s_lshl_b32 s36, s28, 12
v_add_u32 v232, s36, v7
v_add_u32 v233, s36, v232
s_lshl_b32 s36, s28, 9
s_lshl_b32 s37, s30, 2
s_add_u32 s37, s37, s28
s_lshl_b32 s37, s37, 3
s_add_u32 s38, s37, s29
s_lshl_b32 s39, s38, 7
s_add_u32 s39, s39, 0x820000
s_lshl_b32 s38, s38, 10
s_add_u32 s38, s38, 0x400000
s_lshl_b32 s88, s28, 6
s_add_u32 s94, s80, s88
s_add_u32 s94, s94, 0x90000
s_add_u32 s88, s88, s70
s_add_u32 s89, s88, 0x90000
s_lshl_b32 s91, s30, 2
s_add_u32 s91, s91, s28
s_lshl_b32 s91, s91, 3
s_add_u32 s91, s91, s29
s_lshl_b32 s91, s91, 7
s_add_u32 s91, s91, 0x820000
buffer_store_dwordx4 a[248:251], v254, s[4:7], s91 offen offset:0 sc1
s_sub_u32 s91, s91, 0x820000
s_lshl_b32 s91, s91, 3
s_add_u32 s91, s91, 0x400000
s_add_u32 m0, s19, 114688
s_add_u32 s44, s85, 0xc14000
v_cvt_pk_bf16_f32 v140, v140, v141
v_cvt_pk_bf16_f32 v164, v164, v165
v_cvt_pk_bf16_f32 v141, v142, v143
v_cvt_pk_bf16_f32 v165, v166, v167
v_cvt_pk_bf16_f32 v142, v144, v145
v_cvt_pk_bf16_f32 v143, v146, v147
v_cvt_pk_bf16_f32 v166, v168, v169
v_cvt_pk_bf16_f32 v167, v170, v171
v_mfma_f32_16x16x32_bf16 v[92:95], a[240:243], v[140:143], 0
v_mul_f32 v240, 0x3fb8aa3b, v83
v_mul_f32 v246, 0x3fb8aa3b, v85
v_mfma_f32_16x16x32_bf16 v[108:111], a[240:243], v[164:167], 0
v_cvt_pk_bf16_f32 v188, v188, v189
v_cvt_pk_bf16_f32 v212, v212, v213
v_mfma_f32_16x16x32_bf16 v[96:99], a[244:247], v[140:143], 0
s_nop 1
v_max3_f32 v236, v92, v93, v94
v_max3_f32 v237, -v92, -v93, -v94
v_mfma_f32_16x16x32_bf16 v[112:115], a[244:247], v[164:167], 0
v_max3_f32 v242, v108, v109, v110
v_max3_f32 v243, -v108, -v109, -v110
v_cvt_pk_bf16_f32 v189, v190, v191
v_cvt_pk_bf16_f32 v213, v214, v215
v_max3_f32 v236, v236, v95, v96
v_max3_f32 v237, v237, -v95, -v96
v_max3_f32 v236, v236, v97, v98
buffer_store_dwordx4 a[248:251], v1, s[4:7], s91 offen offset:0 sc1
v_max3_f32 v242, v242, v111, v112
v_max3_f32 v243, v243, -v111, -v112
v_max3_f32 v237, v237, -v97, -v98
v_max3_f32 v242, v242, v113, v114
v_max3_f32 v243, v243, -v113, -v114
v_max_f32 v236, v236, v99
v_max_f32_e64 v237, v237, -v99
v_max_f32 v242, v242, v115
v_max_f32_e64 v243, v243, -v115
v_permlane32_swap_b32 v236, v237
s_nop 0
v_permlane32_swap_b32 v242, v243
v_max_f32 v236, v236, v237
v_max_f32 v242, v242, v243
v_mov_b32 v238, v236
v_mov_b32 v244, v242
v_pk_mul_f32 v[148:149], v[148:149], v[82:83] op_sel:[0,1] op_sel_hi:[1,1]
v_permlane16_swap_b32 v236, v238
v_permlane16_swap_b32 v242, v244
v_max_f32 v236, v236, v238
v_max_f32 v242, v242, v244
v_mov_b32 v238, v236
v_mov_b32 v244, v242
v_pk_mul_f32 v[172:173], v[172:173], v[84:85] op_sel:[0,1] op_sel_hi:[1,1]
v_permlane32_swap_b32 v236, v238
v_permlane32_swap_b32 v242, v244
v_mul_f32_e64 v236, -v236, v240
v_mul_f32_e64 v237, -v238, v240
v_mul_f32_e64 v242, -v242, v246
buffer_load_dwordx4 v1, s[4:7], s44 offen offset:0 sc1 lds
v_mul_f32_e64 v243, -v244, v246
v_pk_fma_f32 v[100:101], v[92:93], v[240:241], v[236:237] op_sel:[0,0,0] op_sel_hi:[1,0,0]
v_pk_fma_f32 v[102:103], v[94:95], v[240:241], v[236:237] op_sel:[0,0,0] op_sel_hi:[1,0,0]
v_pk_fma_f32 v[104:105], v[96:97], v[240:241], v[236:237] op_sel:[0,0,0] op_sel_hi:[1,0,0]
v_pk_fma_f32 v[106:107], v[98:99], v[240:241], v[236:237] op_sel:[0,0,0] op_sel_hi:[1,0,0]
v_pk_fma_f32 v[116:117], v[108:109], v[246:247], v[242:243] op_sel:[0,0,0] op_sel_hi:[1,0,0]
v_pk_fma_f32 v[118:119], v[110:111], v[246:247], v[242:243] op_sel:[0,0,0] op_sel_hi:[1,0,0]
v_pk_fma_f32 v[120:121], v[112:113], v[246:247], v[242:243] op_sel:[0,0,0] op_sel_hi:[1,0,0]
v_pk_fma_f32 v[122:123], v[114:115], v[246:247], v[242:243] op_sel:[0,0,0] op_sel_hi:[1,0,0]
v_pk_fma_f32 v[92:93], v[92:93], v[240:241], v[236:237] op_sel:[0,0,1] op_sel_hi:[1,0,1] neg_lo:[1,0,0] neg_hi:[1,0,0]
v_pk_fma_f32 v[94:95], v[94:95], v[240:241], v[236:237] op_sel:[0,0,1] op_sel_hi:[1,0,1] neg_lo:[1,0,0] neg_hi:[1,0,0]
v_pk_fma_f32 v[96:97], v[96:97], v[240:241], v[236:237] op_sel:[0,0,1] op_sel_hi:[1,0,1] neg_lo:[1,0,0] neg_hi:[1,0,0]
v_pk_fma_f32 v[98:99], v[98:99], v[240:241], v[236:237] op_sel:[0,0,1] op_sel_hi:[1,0,1] neg_lo:[1,0,0] neg_hi:[1,0,0]
v_pk_fma_f32 v[108:109], v[108:109], v[246:247], v[242:243] op_sel:[0,0,1] op_sel_hi:[1,0,1] neg_lo:[1,0,0] neg_hi:[1,0,0]
v_pk_fma_f32 v[110:111], v[110:111], v[246:247], v[242:243] op_sel:[0,0,1] op_sel_hi:[1,0,1] neg_lo:[1,0,0] neg_hi:[1,0,0]
v_pk_fma_f32 v[112:113], v[112:113], v[246:247], v[242:243] op_sel:[0,0,1] op_sel_hi:[1,0,1] neg_lo:[1,0,0] neg_hi:[1,0,0]
v_pk_fma_f32 v[114:115], v[114:115], v[246:247], v[242:243] op_sel:[0,0,1] op_sel_hi:[1,0,1] neg_lo:[1,0,0] neg_hi:[1,0,0]
v_exp_f32 v92, v92
v_exp_f32 v93, v93
v_exp_f32 v94, v94
v_exp_f32 v95, v95
v_exp_f32 v96, v96
buffer_load_dwordx4 v1, s[4:7], s44 offen offset:1024 sc1 lds
v_exp_f32 v97, v97
v_exp_f32 v98, v98
v_exp_f32 v99, v99
v_exp_f32 v108, v108
v_exp_f32 v109, v109
v_exp_f32 v110, v110
v_exp_f32 v111, v111
v_exp_f32 v112, v112
v_exp_f32 v113, v113
v_exp_f32 v114, v114
v_exp_f32 v115, v115
v_pk_mul_f32 v[150:151], v[150:151], v[82:83] op_sel:[0,1] op_sel_hi:[1,1]
v_pk_mul_f32 v[174:175], v[174:175], v[84:85] op_sel:[0,1] op_sel_hi:[1,1]
v_cvt_pk_bf16_f32 v144, v92, v93
v_cvt_pk_bf16_f32 v145, v94, v95
v_cvt_pk_bf16_f32 v146, v96, v97
buffer_load_dwordx4 v1, s[4:7], s44 offen offset:2048 sc1 lds
v_cvt_pk_bf16_f32 v147, v98, v99
v_cvt_pk_bf16_f32 v168, v108, v109
v_cvt_pk_bf16_f32 v169, v110, v111
v_cvt_pk_bf16_f32 v170, v112, v113
v_cvt_pk_bf16_f32 v171, v114, v115
v_cvt_pk_bf16_f32 v148, v148, v149
v_cvt_pk_bf16_f32 v172, v172, v173
v_pk_mul_f32 v[152:153], v[152:153], v[82:83] op_sel:[0,1] op_sel_hi:[1,1]
v_pk_mul_f32 v[154:155], v[154:155], v[82:83] op_sel:[0,1] op_sel_hi:[1,1]
v_pk_mul_f32 v[176:177], v[176:177], v[84:85] op_sel:[0,1] op_sel_hi:[1,1]
v_pk_mul_f32 v[178:179], v[178:179], v[84:85] op_sel:[0,1] op_sel_hi:[1,1]
v_cvt_pk_bf16_f32 v149, v150, v151
v_cvt_pk_bf16_f32 v173, v174, v175
v_cvt_pk_bf16_f32 v150, v152, v153
v_cvt_pk_bf16_f32 v151, v154, v155
v_cvt_pk_bf16_f32 v174, v176, v177
v_cvt_pk_bf16_f32 v175, v178, v179
v_mfma_f32_16x16x32_bf16 v[152:155], v[16:19], v[144:147], 0
v_cvt_pk_bf16_f32 v190, v192, v193
v_cvt_pk_bf16_f32 v191, v194, v195
v_mfma_f32_16x16x32_bf16 v[176:179], v[16:19], v[168:171], 0
v_cvt_pk_bf16_f32 v214, v216, v217
v_cvt_pk_bf16_f32 v215, v218, v219
v_exp_f32 v100, v100
buffer_load_dwordx4 v1, s[4:7], s44 offen offset:3072 sc1 lds
s_add_u32 m0, s19, 131072
s_add_u32 s44, s86, 0xc18000
s_lshl_b32 s91, s30, 12
s_add_u32 s91, s91, 0x2600000
v_rcp_f32 v152, v152
v_rcp_f32 v176, v176
v_pk_mul_f32 v[92:93], v[92:93], v[152:153] op_sel:[0,0] op_sel_hi:[1,0]
v_pk_mul_f32 v[94:95], v[94:95], v[152:153] op_sel:[0,0] op_sel_hi:[1,0]
v_pk_mul_f32 v[108:109], v[108:109], v[176:177] op_sel:[0,0] op_sel_hi:[1,0]
v_pk_mul_f32 v[110:111], v[110:111], v[176:177] op_sel:[0,0] op_sel_hi:[1,0]
v_pk_mul_f32 v[96:97], v[96:97], v[152:153] op_sel:[0,0] op_sel_hi:[1,0]
v_pk_mul_f32 v[98:99], v[98:99], v[152:153] op_sel:[0,0] op_sel_hi:[1,0]
v_cvt_pk_bf16_f32 v144, v92, v93
v_cvt_pk_bf16_f32 v145, v94, v95
v_pk_mul_f32 v[112:113], v[112:113], v[176:177] op_sel:[0,0] op_sel_hi:[1,0]
v_cvt_pk_bf16_f32 v168, v108, v109
v_pk_mul_f32 v[114:115], v[114:115], v[176:177] op_sel:[0,0] op_sel_hi:[1,0]
v_cvt_pk_bf16_f32 v169, v110, v111
v_mfma_f32_16x16x32_bf16 v[92:95], a[240:243], v[188:191], 0
v_cvt_pk_bf16_f32 v146, v96, v97
v_cvt_pk_bf16_f32 v147, v98, v99
v_mfma_f32_16x16x32_bf16 v[108:111], a[240:243], v[212:215], 0
v_cvt_pk_bf16_f32 v170, v112, v113
buffer_load_dwordx4 v1, s[4:7], s44 offen offset:0 sc1 lds
v_cvt_pk_bf16_f32 v171, v114, v115
v_mfma_f32_16x16x32_bf16 v[96:99], a[244:247], v[188:191], 0
s_nop 0
v_max3_f32 v236, v92, v93, v94
v_max3_f32 v237, -v92, -v93, -v94
v_mfma_f32_16x16x32_bf16 v[112:115], a[244:247], v[212:215], 0
v_max3_f32 v242, v108, v109, v110
v_max3_f32 v243, -v108, -v109, -v110
v_exp_f32 v101, v101
s_nop 0
v_max3_f32 v236, v236, v95, v96
v_max3_f32 v237, v237, -v95, -v96
v_max3_f32 v236, v236, v97, v98
v_max3_f32 v237, v237, -v97, -v98
v_max3_f32 v242, v242, v111, v112
v_max3_f32 v243, v243, -v111, -v112
v_max3_f32 v242, v242, v113, v114
v_max3_f32 v243, v243, -v113, -v114
v_max_f32 v236, v236, v99
v_max_f32_e64 v237, v237, -v99
v_max_f32 v242, v242, v115
v_max_f32_e64 v243, v243, -v115
v_exp_f32 v102, v102
v_exp_f32 v103, v103
buffer_load_dwordx4 v1, s[4:7], s44 offen offset:1024 sc1 lds
v_exp_f32 v104, v104
v_exp_f32 v105, v105
v_exp_f32 v106, v106
v_exp_f32 v107, v107
v_exp_f32 v116, v116
v_exp_f32 v117, v117
v_exp_f32 v118, v118
v_exp_f32 v119, v119
v_exp_f32 v120, v120
v_exp_f32 v121, v121
v_exp_f32 v122, v122
v_exp_f32 v123, v123
v_permlane32_swap_b32 v236, v237
v_permlane32_swap_b32 v242, v243
buffer_load_dwordx4 v1, s[4:7], s44 offen offset:2048 sc1 lds
v_cvt_pk_bf16_f32 v140, v100, v101
v_cvt_pk_bf16_f32 v141, v102, v103
v_cvt_pk_bf16_f32 v142, v104, v105
v_cvt_pk_bf16_f32 v143, v106, v107
v_cvt_pk_bf16_f32 v164, v116, v117
v_cvt_pk_bf16_f32 v165, v118, v119
v_cvt_pk_bf16_f32 v166, v120, v121
v_cvt_pk_bf16_f32 v167, v122, v123
ds_write_b64 v232, v[148:149] offset:0
ds_write_b64 v232, v[150:151] offset:512
ds_write_b64 v232, v[172:173] offset:1024
v_max_f32 v236, v236, v237
v_max_f32 v242, v242, v243
v_mfma_f32_16x16x32_bf16 v[148:151], v[16:19], v[140:143], 0
ds_write_b64 v232, v[174:175] offset:1536
v_mfma_f32_16x16x32_bf16 v[172:175], v[16:19], v[164:167], 0
v_mov_b32 v238, v236
buffer_load_dwordx4 v1, s[4:7], s44 offen offset:3072 sc1 lds
v_mov_b32 v244, v242
v_permlane16_swap_b32 v236, v238
s_nop 0
v_permlane16_swap_b32 v242, v244
v_max_f32 v236, v236, v238
v_max_f32 v242, v242, v244
v_mov_b32 v238, v236
v_mov_b32 v244, v242
v_rcp_f32 v148, v148
v_rcp_f32 v172, v172
v_permlane32_swap_b32 v236, v238
v_permlane32_swap_b32 v242, v244
v_mul_f32 v240, 0x3fb8aa3b, v87
v_mul_f32 v246, 0x3fb8aa3b, v89
v_pk_mul_f32 v[100:101], v[100:101], v[148:149] op_sel:[0,0] op_sel_hi:[1,0]
v_pk_mul_f32 v[102:103], v[102:103], v[148:149] op_sel:[0,0] op_sel_hi:[1,0]
v_pk_mul_f32 v[104:105], v[104:105], v[148:149] op_sel:[0,0] op_sel_hi:[1,0]
v_pk_mul_f32 v[106:107], v[106:107], v[148:149] op_sel:[0,0] op_sel_hi:[1,0]
v_pk_mul_f32 v[116:117], v[116:117], v[172:173] op_sel:[0,0] op_sel_hi:[1,0]
v_pk_mul_f32 v[118:119], v[118:119], v[172:173] op_sel:[0,0] op_sel_hi:[1,0]
v_pk_mul_f32 v[120:121], v[120:121], v[172:173] op_sel:[0,0] op_sel_hi:[1,0]
v_pk_mul_f32 v[122:123], v[122:123], v[172:173] op_sel:[0,0] op_sel_hi:[1,0]
buffer_store_dwordx4 a[248:251], v2, s[4:7], s91 offen offset:0 sc1
v_mul_f32_e64 v236, -v236, v240
v_mul_f32_e64 v237, -v238, v240
v_mul_f32_e64 v242, -v242, v246
v_mul_f32_e64 v243, -v244, v246
v_cvt_pk_bf16_f32 v140, v100, v101
v_cvt_pk_bf16_f32 v141, v102, v103
v_cvt_pk_bf16_f32 v142, v104, v105
v_cvt_pk_bf16_f32 v143, v106, v107
v_cvt_pk_bf16_f32 v164, v116, v117
v_cvt_pk_bf16_f32 v165, v118, v119
v_cvt_pk_bf16_f32 v166, v120, v121
v_cvt_pk_bf16_f32 v167, v122, v123
v_pk_fma_f32 v[100:101], v[92:93], v[240:241], v[236:237] op_sel:[0,0,0] op_sel_hi:[1,0,0]
v_pk_fma_f32 v[102:103], v[94:95], v[240:241], v[236:237] op_sel:[0,0,0] op_sel_hi:[1,0,0]
v_pk_fma_f32 v[104:105], v[96:97], v[240:241], v[236:237] op_sel:[0,0,0] op_sel_hi:[1,0,0]
v_pk_fma_f32 v[106:107], v[98:99], v[240:241], v[236:237] op_sel:[0,0,0] op_sel_hi:[1,0,0]
v_pk_fma_f32 v[116:117], v[108:109], v[246:247], v[242:243] op_sel:[0,0,0] op_sel_hi:[1,0,0]
v_pk_fma_f32 v[118:119], v[110:111], v[246:247], v[242:243] op_sel:[0,0,0] op_sel_hi:[1,0,0]
v_pk_fma_f32 v[120:121], v[112:113], v[246:247], v[242:243] op_sel:[0,0,0] op_sel_hi:[1,0,0]
v_pk_fma_f32 v[122:123], v[114:115], v[246:247], v[242:243] op_sel:[0,0,0] op_sel_hi:[1,0,0]
v_pk_fma_f32 v[92:93], v[92:93], v[240:241], v[236:237] op_sel:[0,0,1] op_sel_hi:[1,0,1] neg_lo:[1,0,0] neg_hi:[1,0,0]
v_pk_fma_f32 v[94:95], v[94:95], v[240:241], v[236:237] op_sel:[0,0,1] op_sel_hi:[1,0,1] neg_lo:[1,0,0] neg_hi:[1,0,0]
v_pk_fma_f32 v[96:97], v[96:97], v[240:241], v[236:237] op_sel:[0,0,1] op_sel_hi:[1,0,1] neg_lo:[1,0,0] neg_hi:[1,0,0]
v_pk_fma_f32 v[98:99], v[98:99], v[240:241], v[236:237] op_sel:[0,0,1] op_sel_hi:[1,0,1] neg_lo:[1,0,0] neg_hi:[1,0,0]
v_pk_fma_f32 v[108:109], v[108:109], v[246:247], v[242:243] op_sel:[0,0,1] op_sel_hi:[1,0,1] neg_lo:[1,0,0] neg_hi:[1,0,0]
v_pk_fma_f32 v[110:111], v[110:111], v[246:247], v[242:243] op_sel:[0,0,1] op_sel_hi:[1,0,1] neg_lo:[1,0,0] neg_hi:[1,0,0]
v_pk_fma_f32 v[112:113], v[112:113], v[246:247], v[242:243] op_sel:[0,0,1] op_sel_hi:[1,0,1] neg_lo:[1,0,0] neg_hi:[1,0,0]
v_pk_fma_f32 v[114:115], v[114:115], v[246:247], v[242:243] op_sel:[0,0,1] op_sel_hi:[1,0,1] neg_lo:[1,0,0] neg_hi:[1,0,0]
v_pk_mul_f32 v[196:197], v[196:197], v[86:87] op_sel:[0,1] op_sel_hi:[1,1]
v_pk_mul_f32 v[220:221], v[220:221], v[88:89] op_sel:[0,1] op_sel_hi:[1,1]
v_exp_f32 v100, v100
v_exp_f32 v92, v92
buffer_store_dwordx4 a[248:251], v2, s[4:7], s91 offen offset:1024 sc1
v_exp_f32 v101, v101
v_exp_f32 v93, v93
v_exp_f32 v102, v102
v_exp_f32 v94, v94
v_exp_f32 v103, v103
v_exp_f32 v95, v95
v_exp_f32 v104, v104
v_exp_f32 v96, v96
v_exp_f32 v105, v105
v_exp_f32 v97, v97
v_exp_f32 v106, v106
v_exp_f32 v98, v98
v_exp_f32 v107, v107
v_exp_f32 v99, v99
v_exp_f32 v116, v116
v_exp_f32 v108, v108
v_exp_f32 v117, v117
buffer_store_dwordx4 a[248:251], v2, s[4:7], s91 offen offset:2048 sc1
v_exp_f32 v109, v109
v_exp_f32 v118, v118
v_exp_f32 v110, v110
v_exp_f32 v119, v119
v_exp_f32 v111, v111
v_exp_f32 v120, v120
v_exp_f32 v112, v112
v_exp_f32 v121, v121
v_exp_f32 v113, v113
v_exp_f32 v122, v122
v_exp_f32 v114, v114
v_exp_f32 v123, v123
v_exp_f32 v115, v115
v_pk_mul_f32 v[198:199], v[198:199], v[86:87] op_sel:[0,1] op_sel_hi:[1,1]
v_pk_mul_f32 v[222:223], v[222:223], v[88:89] op_sel:[0,1] op_sel_hi:[1,1]
v_cvt_pk_bf16_f32 v196, v196, v197
v_cvt_pk_bf16_f32 v220, v220, v221
v_pk_mul_f32 v[200:201], v[200:201], v[86:87] op_sel:[0,1] op_sel_hi:[1,1]
v_pk_mul_f32 v[202:203], v[202:203], v[86:87] op_sel:[0,1] op_sel_hi:[1,1]
v_pk_mul_f32 v[224:225], v[224:225], v[88:89] op_sel:[0,1] op_sel_hi:[1,1]
v_pk_mul_f32 v[226:227], v[226:227], v[88:89] op_sel:[0,1] op_sel_hi:[1,1]
v_cvt_pk_bf16_f32 v197, v198, v199
v_cvt_pk_bf16_f32 v221, v222, v223
v_cvt_pk_bf16_f32 v198, v200, v201
v_cvt_pk_bf16_f32 v199, v202, v203
v_cvt_pk_bf16_f32 v222, v224, v225
v_cvt_pk_bf16_f32 v223, v226, v227
v_cvt_pk_bf16_f32 v188, v100, v101
v_cvt_pk_bf16_f32 v189, v102, v103
v_cvt_pk_bf16_f32 v190, v104, v105
v_cvt_pk_bf16_f32 v191, v106, v107
v_cvt_pk_bf16_f32 v192, v92, v93
v_cvt_pk_bf16_f32 v193, v94, v95
v_cvt_pk_bf16_f32 v194, v96, v97
v_cvt_pk_bf16_f32 v195, v98, v99
v_cvt_pk_bf16_f32 v212, v116, v117
v_cvt_pk_bf16_f32 v213, v118, v119
v_cvt_pk_bf16_f32 v214, v120, v121
v_cvt_pk_bf16_f32 v215, v122, v123
v_cvt_pk_bf16_f32 v216, v108, v109
v_cvt_pk_bf16_f32 v217, v110, v111
v_cvt_pk_bf16_f32 v218, v112, v113
v_cvt_pk_bf16_f32 v219, v114, v115
ds_write_b64 v232, v[196:197] offset:2048
ds_write_b64 v232, v[198:199] offset:2560
ds_write_b64 v232, v[220:221] offset:3072
v_mfma_f32_16x16x32_bf16 v[196:199], v[16:19], v[188:191], 0
buffer_store_dwordx4 a[248:251], v2, s[4:7], s91 offen offset:3072 sc1
ds_write_b64 v232, v[222:223] offset:3584
v_mfma_f32_16x16x32_bf16 v[200:203], v[16:19], v[192:195], 0
s_nop 4
v_rcp_f32 v196, v196
v_mfma_f32_16x16x32_bf16 v[220:223], v[16:19], v[212:215], 0
ds_write_b64 v233, v[140:141] offset:16384
v_mfma_f32_16x16x32_bf16 v[224:227], v[16:19], v[216:219], 0
v_rcp_f32 v200, v200
ds_write_b64 v233, v[142:143] offset:16896
s_nop 3
v_rcp_f32 v220, v220
v_pk_mul_f32 v[100:101], v[100:101], v[196:197] op_sel:[0,0] op_sel_hi:[1,0]
v_rcp_f32 v224, v224
v_pk_mul_f32 v[102:103], v[102:103], v[196:197] op_sel:[0,0] op_sel_hi:[1,0]
v_pk_mul_f32 v[104:105], v[104:105], v[196:197] op_sel:[0,0] op_sel_hi:[1,0]
v_pk_mul_f32 v[106:107], v[106:107], v[196:197] op_sel:[0,0] op_sel_hi:[1,0]
v_pk_mul_f32 v[92:93], v[92:93], v[200:201] op_sel:[0,0] op_sel_hi:[1,0]
v_pk_mul_f32 v[94:95], v[94:95], v[200:201] op_sel:[0,0] op_sel_hi:[1,0]
v_pk_mul_f32 v[96:97], v[96:97], v[200:201] op_sel:[0,0] op_sel_hi:[1,0]
v_pk_mul_f32 v[98:99], v[98:99], v[200:201] op_sel:[0,0] op_sel_hi:[1,0]
v_pk_mul_f32 v[116:117], v[116:117], v[220:221] op_sel:[0,0] op_sel_hi:[1,0]
v_pk_mul_f32 v[118:119], v[118:119], v[220:221] op_sel:[0,0] op_sel_hi:[1,0]
v_pk_mul_f32 v[120:121], v[120:121], v[220:221] op_sel:[0,0] op_sel_hi:[1,0]
v_pk_mul_f32 v[122:123], v[122:123], v[220:221] op_sel:[0,0] op_sel_hi:[1,0]
v_pk_mul_f32 v[108:109], v[108:109], v[224:225] op_sel:[0,0] op_sel_hi:[1,0]
v_pk_mul_f32 v[110:111], v[110:111], v[224:225] op_sel:[0,0] op_sel_hi:[1,0]
v_pk_mul_f32 v[112:113], v[112:113], v[224:225] op_sel:[0,0] op_sel_hi:[1,0]
v_pk_mul_f32 v[114:115], v[114:115], v[224:225] op_sel:[0,0] op_sel_hi:[1,0]
v_cvt_pk_bf16_f32 v188, v100, v101
v_cvt_pk_bf16_f32 v189, v102, v103
v_cvt_pk_bf16_f32 v190, v104, v105
v_cvt_pk_bf16_f32 v191, v106, v107
v_cvt_pk_bf16_f32 v192, v92, v93
v_cvt_pk_bf16_f32 v193, v94, v95
L_stub18:
s_cbranch_execz L_stub19
v_cvt_pk_bf16_f32 v194, v96, v97
v_cvt_pk_bf16_f32 v195, v98, v99
v_cvt_pk_bf16_f32 v212, v116, v117
v_cvt_pk_bf16_f32 v213, v118, v119
v_cvt_pk_bf16_f32 v214, v120, v121
v_cvt_pk_bf16_f32 v215, v122, v123
v_cvt_pk_bf16_f32 v216, v108, v109
v_cvt_pk_bf16_f32 v217, v110, v111
v_cvt_pk_bf16_f32 v218, v112, v113
v_cvt_pk_bf16_f32 v219, v114, v115
ds_write_b64 v233, v[144:145] offset:17408
ds_write_b64 v233, v[146:147] offset:17920
ds_write_b64 v233, v[164:165] offset:18432
v_lshlrev_b32 v235, 8, v0
v_add_u32 v234, s36, v8
v_cndmask_b32 v235, 2.0, v235, s[64:65]
ds_write_b64 v233, v[166:167] offset:18944
ds_write_b64 v233, v[168:169] offset:19456
ds_write_b64 v233, v[170:171] offset:19968
ds_write_b64 v233, v[188:189] offset:20480
ds_write_b64 v233, v[190:191] offset:20992
ds_write_b64 v233, v[192:193] offset:21504
ds_write_b64 v233, v[194:195] offset:22016
ds_write_b64 v233, v[212:213] offset:22528
ds_write_b64 v233, v[214:215] offset:23040
ds_write_b64 v233, v[216:217] offset:23552
ds_write_b64 v233, v[218:219] offset:24064
s_waitcnt vmcnt(12)
s_waitcnt lgkmcnt(0)
s_barrier
ds_read_b64_tr_b16 a[0:1], v234 offset:16384
ds_read_b64_tr_b16 a[2:3], v234 offset:18432
ds_read_b64_tr_b16 a[12:13], v234 offset:20480
ds_read_b64_tr_b16 a[14:15], v234 offset:22528
ds_read_b64_tr_b16 a[24:25], v234 offset:24576
ds_read_b64_tr_b16 a[26:27], v234 offset:26624
ds_read_b64_tr_b16 a[4:5], v8 offset:0
ds_read_b64_tr_b16 a[6:7], v8 offset:1024
ds_read_b64_tr_b16 a[8:9], v8 offset:512
ds_read_b64_tr_b16 a[10:11], v8 offset:1536
ds_read_b64_tr_b16 a[36:37], v234 offset:28672
ds_read_b64_tr_b16 a[38:39], v234 offset:30720
ds_read_b64_tr_b16 a[16:17], v8 offset:2048
ds_read_b64_tr_b16 a[18:19], v8 offset:3072
ds_read_b64_tr_b16 a[20:21], v8 offset:2560
ds_read_b64_tr_b16 a[22:23], v8 offset:3584
ds_read_b64_tr_b16 a[48:49], v234 offset:32768
ds_read_b64_tr_b16 a[50:51], v234 offset:34816
ds_read_b64_tr_b16 a[28:29], v8 offset:4096
ds_read_b64_tr_b16 a[30:31], v8 offset:5120
ds_read_b64_tr_b16 a[32:33], v8 offset:4608
ds_read_b64_tr_b16 a[34:35], v8 offset:5632
ds_read_b64_tr_b16 a[60:61], v234 offset:36864
ds_read_b64_tr_b16 a[62:63], v234 offset:38912
s_waitcnt lgkmcnt(14)
v_mfma_f32_16x16x32_bf16 v[100:103], a[0:3], v[16:19], 0
ds_read_b64_tr_b16 a[40:41], v8 offset:6144
ds_read_b64_tr_b16 a[42:43], v8 offset:7168
ds_read_b64_tr_b16 a[44:45], v8 offset:6656
ds_read_b64_tr_b16 a[46:47], v8 offset:7680
ds_read_b64_tr_b16 a[72:73], v234 offset:40960
ds_read_b64_tr_b16 a[74:75], v234 offset:43008
v_mfma_f32_16x16x32_bf16 v[100:103], a[12:15], v[16:19], v[100:103]
buffer_atomic_add v12, v235, s[4:7], s94 offen sc1
ds_read_b64_tr_b16 a[52:53], v8 offset:8192
ds_read_b64_tr_b16 a[54:55], v8 offset:9216
ds_read_b64_tr_b16 a[56:57], v8 offset:8704
ds_read_b64_tr_b16 a[58:59], v8 offset:9728
ds_read_b64_tr_b16 a[84:85], v234 offset:45056
ds_read_b64_tr_b16 a[86:87], v234 offset:47104
v_mfma_f32_16x16x32_bf16 v[100:103], a[24:27], v[16:19], v[100:103]
ds_read_b64_tr_b16 a[64:65], v8 offset:10240
ds_read_b64_tr_b16 a[66:67], v8 offset:11264
v_mfma_f32_16x16x32_bf16 v[92:95], a[0:3], a[4:7], 0
ds_read_b64_tr_b16 a[68:69], v8 offset:10752
ds_read_b64_tr_b16 a[70:71], v8 offset:11776
v_mfma_f32_16x16x32_bf16 v[96:99], a[0:3], a[8:11], 0
ds_read_b64_tr_b16 a[76:77], v8 offset:12288
s_waitcnt lgkmcnt(14)
v_mfma_f32_16x16x32_bf16 v[100:103], a[36:39], v[16:19], v[100:103]
ds_read_b64_tr_b16 a[78:79], v8 offset:13312
v_mfma_f32_16x16x32_bf16 v[92:95], a[12:15], a[16:19], v[92:95]
ds_read_b64_tr_b16 a[80:81], v8 offset:12800
ds_read_b64_tr_b16 a[82:83], v8 offset:13824
v_mfma_f32_16x16x32_bf16 v[96:99], a[12:15], a[20:23], v[96:99]
ds_read_b64_tr_b16 a[88:89], v8 offset:14336
v_mfma_f32_16x16x32_bf16 v[100:103], a[48:51], v[16:19], v[100:103]
ds_read_b64_tr_b16 a[90:91], v8 offset:15360
v_mfma_f32_16x16x32_bf16 v[92:95], a[24:27], a[28:31], v[92:95]
ds_read_b64_tr_b16 a[92:93], v8 offset:14848
ds_read_b64_tr_b16 a[94:95], v8 offset:15872
v_mfma_f32_16x16x32_bf16 v[96:99], a[24:27], a[32:35], v[96:99]
v_cvt_pk_bf16_f32 v132, v132, v133
v_cvt_pk_bf16_f32 v156, v156, v157
v_mfma_f32_16x16x32_bf16 v[100:103], a[60:63], v[16:19], v[100:103]
v_cvt_pk_bf16_f32 v180, v180, v181
v_cvt_pk_bf16_f32 v204, v204, v205
v_mfma_f32_16x16x32_bf16 v[92:95], a[36:39], a[40:43], v[92:95]
v_cvt_pk_bf16_f32 v133, v134, v135
v_cvt_pk_bf16_f32 v157, v158, v159
s_waitcnt lgkmcnt(14)
v_mfma_f32_16x16x32_bf16 v[96:99], a[36:39], a[44:47], v[96:99]
v_cvt_pk_bf16_f32 v181, v182, v183
v_cvt_pk_bf16_f32 v205, v206, v207
v_mfma_f32_16x16x32_bf16 v[100:103], a[72:75], v[16:19], v[100:103]
v_cvt_pk_bf16_f32 v134, v136, v137
v_cvt_pk_bf16_f32 v135, v138, v139
v_mfma_f32_16x16x32_bf16 v[92:95], a[48:51], a[52:55], v[92:95]
v_cvt_pk_bf16_f32 v158, v160, v161
v_cvt_pk_bf16_f32 v159, v162, v163
v_mfma_f32_16x16x32_bf16 v[96:99], a[48:51], a[56:59], v[96:99]
v_cvt_pk_bf16_f32 v182, v184, v185
v_cvt_pk_bf16_f32 v183, v186, v187
s_waitcnt lgkmcnt(12)
v_mfma_f32_16x16x32_bf16 v[100:103], a[84:87], v[16:19], v[100:103]
v_cvt_pk_bf16_f32 v206, v208, v209
v_cvt_pk_bf16_f32 v207, v210, v211
s_waitcnt lgkmcnt(10)
v_mfma_f32_16x16x32_bf16 v[92:95], a[60:63], a[64:67], v[92:95]
s_waitcnt lgkmcnt(8)
v_mfma_f32_16x16x32_bf16 v[96:99], a[60:63], a[68:71], v[96:99]
s_nop 1
v_min_u32 v100, -2, v100
v_min_u32 v101, -2, v101
s_waitcnt lgkmcnt(6)
v_mfma_f32_16x16x32_bf16 v[92:95], a[72:75], a[76:79], v[92:95]
v_min_u32 v102, -2, v102
v_min_u32 v103, -2, v103
s_waitcnt lgkmcnt(4)
v_mfma_f32_16x16x32_bf16 v[96:99], a[72:75], a[80:83], v[96:99]
buffer_store_dwordx4 v[100:103], v254, s[4:7], s39 offen sc1
s_waitcnt lgkmcnt(2)
v_mfma_f32_16x16x32_bf16 v[92:95], a[84:87], a[88:91], v[92:95]
s_waitcnt lgkmcnt(0)
v_mfma_f32_16x16x32_bf16 v[96:99], a[84:87], a[92:95], v[96:99]
s_nop 5
v_cvt_pk_bf16_f32 v92, v92, v93
v_cvt_pk_bf16_f32 v93, v94, v95
v_min_u32 v92, -2, v92
v_min_u32 v93, -2, v93
v_cvt_pk_bf16_f32 v94, v96, v97
v_cvt_pk_bf16_f32 v95, v98, v99
v_min_u32 v94, -2, v94
v_min_u32 v95, -2, v95
buffer_store_dwordx4 v[92:95], v1, s[4:7], s38 offen sc1
s_barrier
s_add_u32 m0, s19, 32768
s_add_u32 s44, s84, 0xc00000
buffer_load_dwordx4 v1, s[4:7], s44 offen offset:0 sc1 lds
v_mfma_f32_16x16x32_bf16 v[108:111], a[240:243], v[132:135], 0
v_mul_f32 v240, 0x3fb8aa3b, v83
v_mul_f32 v246, 0x3fb8aa3b, v85
v_mfma_f32_16x16x32_bf16 v[172:175], a[240:243], v[156:159], 0
v_mfma_f32_16x16x32_bf16 v[112:115], a[244:247], v[132:135], 0
s_nop 3
v_max3_f32 v236, v108, v109, v110
v_max3_f32 v237, -v108, -v109, -v110
v_mfma_f32_16x16x32_bf16 v[176:179], a[244:247], v[156:159], 0
v_max3_f32 v242, v172, v173, v174
v_max3_f32 v243, -v172, -v173, -v174
v_max3_f32 v236, v236, v111, v112
v_max3_f32 v237, v237, -v111, -v112
v_max3_f32 v236, v236, v113, v114
v_max3_f32 v237, v237, -v113, -v114
s_nop 1
v_max3_f32 v242, v242, v175, v176
v_max3_f32 v243, v243, -v175, -v176
v_max3_f32 v242, v242, v177, v178
v_max3_f32 v243, v243, -v177, -v178
v_max_f32 v236, v236, v115
buffer_load_dwordx4 v1, s[4:7], s44 offen offset:1024 sc1 lds
v_max_f32_e64 v237, v237, -v115
v_max_f32 v242, v242, v179
v_max_f32_e64 v243, v243, -v179
v_permlane32_swap_b32 v236, v237
s_nop 0
v_permlane32_swap_b32 v242, v243
v_mov_b32 v11, 0
buffer_atomic_add v11, v251, s[4:7], s89 offen sc0 sc1
v_max_f32 v236, v236, v237
v_max_f32 v242, v242, v243
v_mov_b32 v238, v236
v_mov_b32 v244, v242
s_nop 0
v_permlane16_swap_b32 v236, v238
v_permlane16_swap_b32 v242, v244
v_max_f32 v236, v236, v238
v_max_f32 v242, v242, v244
v_mov_b32 v238, v236
v_mov_b32 v244, v242
s_nop 0
v_permlane32_swap_b32 v236, v238
v_permlane32_swap_b32 v242, v244
v_mul_f32_e64 v236, -v236, v240
v_mul_f32_e64 v237, -v238, v240
buffer_load_dwordx4 v1, s[4:7], s44 offen offset:2048 sc1 lds
v_mul_f32_e64 v242, -v242, v246
v_mul_f32_e64 v243, -v244, v246
v_pk_fma_f32 v[116:117], v[108:109], v[240:241], v[236:237] op_sel:[0,0,0] op_sel_hi:[1,0,0]
v_pk_fma_f32 v[118:119], v[110:111], v[240:241], v[236:237] op_sel:[0,0,0] op_sel_hi:[1,0,0]
v_pk_fma_f32 v[120:121], v[112:113], v[240:241], v[236:237] op_sel:[0,0,0] op_sel_hi:[1,0,0]
v_pk_fma_f32 v[122:123], v[114:115], v[240:241], v[236:237] op_sel:[0,0,0] op_sel_hi:[1,0,0]
v_pk_fma_f32 v[148:149], v[172:173], v[246:247], v[242:243] op_sel:[0,0,0] op_sel_hi:[1,0,0]
v_pk_fma_f32 v[150:151], v[174:175], v[246:247], v[242:243] op_sel:[0,0,0] op_sel_hi:[1,0,0]
v_pk_fma_f32 v[152:153], v[176:177], v[246:247], v[242:243] op_sel:[0,0,0] op_sel_hi:[1,0,0]
v_pk_fma_f32 v[154:155], v[178:179], v[246:247], v[242:243] op_sel:[0,0,0] op_sel_hi:[1,0,0]
v_pk_fma_f32 v[108:109], v[108:109], v[240:241], v[236:237] op_sel:[0,0,1] op_sel_hi:[1,0,1] neg_lo:[1,0,0] neg_hi:[1,0,0]
v_pk_fma_f32 v[110:111], v[110:111], v[240:241], v[236:237] op_sel:[0,0,1] op_sel_hi:[1,0,1] neg_lo:[1,0,0] neg_hi:[1,0,0]
v_pk_fma_f32 v[112:113], v[112:113], v[240:241], v[236:237] op_sel:[0,0,1] op_sel_hi:[1,0,1] neg_lo:[1,0,0] neg_hi:[1,0,0]
v_pk_fma_f32 v[114:115], v[114:115], v[240:241], v[236:237] op_sel:[0,0,1] op_sel_hi:[1,0,1] neg_lo:[1,0,0] neg_hi:[1,0,0]
v_pk_fma_f32 v[172:173], v[172:173], v[246:247], v[242:243] op_sel:[0,0,1] op_sel_hi:[1,0,1] neg_lo:[1,0,0] neg_hi:[1,0,0]
v_pk_fma_f32 v[174:175], v[174:175], v[246:247], v[242:243] op_sel:[0,0,1] op_sel_hi:[1,0,1] neg_lo:[1,0,0] neg_hi:[1,0,0]
v_pk_fma_f32 v[176:177], v[176:177], v[246:247], v[242:243] op_sel:[0,0,1] op_sel_hi:[1,0,1] neg_lo:[1,0,0] neg_hi:[1,0,0]
v_pk_fma_f32 v[178:179], v[178:179], v[246:247], v[242:243] op_sel:[0,0,1] op_sel_hi:[1,0,1] neg_lo:[1,0,0] neg_hi:[1,0,0]
v_exp_f32 v116, v116
v_exp_f32 v108, v108
v_exp_f32 v117, v117
v_exp_f32 v109, v109
v_exp_f32 v118, v118
v_exp_f32 v110, v110
v_exp_f32 v119, v119
v_exp_f32 v111, v111
v_exp_f32 v120, v120
v_exp_f32 v112, v112
v_exp_f32 v121, v121
v_exp_f32 v113, v113
v_exp_f32 v122, v122
v_exp_f32 v114, v114
v_exp_f32 v123, v123
v_exp_f32 v115, v115
v_exp_f32 v148, v148
v_exp_f32 v172, v172
v_exp_f32 v149, v149
v_exp_f32 v173, v173
v_exp_f32 v150, v150
v_exp_f32 v174, v174
v_exp_f32 v151, v151
v_exp_f32 v175, v175
v_exp_f32 v152, v152
v_exp_f32 v176, v176
v_exp_f32 v153, v153
v_exp_f32 v177, v177
v_exp_f32 v154, v154
v_exp_f32 v178, v178
v_exp_f32 v155, v155
v_exp_f32 v179, v179
buffer_load_dwordx4 v1, s[4:7], s44 offen offset:3072 sc1 lds
v_cvt_pk_bf16_f32 v140, v116, v117
v_cvt_pk_bf16_f32 v141, v118, v119
v_cvt_pk_bf16_f32 v142, v120, v121
v_cvt_pk_bf16_f32 v143, v122, v123
v_cvt_pk_bf16_f32 v144, v108, v109
v_cvt_pk_bf16_f32 v145, v110, v111
v_cvt_pk_bf16_f32 v146, v112, v113
v_cvt_pk_bf16_f32 v147, v114, v115
v_cvt_pk_bf16_f32 v164, v148, v149
v_cvt_pk_bf16_f32 v165, v150, v151
v_cvt_pk_bf16_f32 v166, v152, v153
v_cvt_pk_bf16_f32 v167, v154, v155
v_cvt_pk_bf16_f32 v168, v172, v173
v_cvt_pk_bf16_f32 v169, v174, v175
v_cvt_pk_bf16_f32 v170, v176, v177
v_cvt_pk_bf16_f32 v171, v178, v179
s_waitcnt vmcnt(2)
v_readfirstlane_b32 s38, v11
s_nop 0
s_cmp_ge_u32 s38, 8
s_cbranch_scc1 Lpe_35
s_add_u32 s36, s88, 0x90000
s_mov_b32 s37, 0
Lpoll_34:
v_mov_b32 v11, 0
buffer_atomic_add v11, v251, s[4:7], s36 offen sc0 sc1
s_add_u32 s37, s37, 1
s_waitcnt vmcnt(0)
v_readfirstlane_b32 s38, v11
s_nop 0
s_cmp_ge_u32 s38, 8
s_cbranch_scc1 Lpe_35
s_cmp_lt_u32 s37, 0x100000
s_cbranch_scc1 Lpoll_34
Lpe_35:
s_lshl_b32 s37, s30, 2
s_add_u32 s37, s37, s28
s_lshl_b32 s38, s37, 13
s_add_u32 s38, s38, 0x400000
buffer_load_dwordx4 v[48:51], v1, s[4:7], s38 offen offset:0 sc1
v_and_b32 v248, 7, v0
s_add_u32 s36, s38, 4096
s_lshl_b32 s39, s37, 10
v_lshlrev_b32 v248, 7, v248
v_lshrrev_b32 v249, 4, v0
s_add_u32 s39, s39, 0x820000
v_lshl_add_u32 v248, v249, 4, v248
v_mfma_f32_16x16x32_bf16 v[108:111], a[240:243], v[180:183], 0
v_mov_b32 v249, 0x3f80
v_mov_b32 v250, 1.0
v_mfma_f32_16x16x32_bf16 v[220:223], a[240:243], v[204:207], 0
buffer_load_dwordx4 v[124:127], v248, s[4:7], s39 offen sc1
v_mfma_f32_16x16x32_bf16 v[112:115], a[244:247], v[180:183], 0
s_nop 2
v_max3_f32 v236, v108, v109, v110
v_max3_f32 v237, -v108, -v109, -v110
v_mfma_f32_16x16x32_bf16 v[224:227], a[244:247], v[204:207], 0
v_max3_f32 v242, v220, v221, v222
v_max3_f32 v243, -v220, -v221, -v222
v_mul_f32 v240, 0x3fb8aa3b, v87
v_mul_f32 v246, 0x3fb8aa3b, v89
v_max3_f32 v236, v236, v111, v112
v_max3_f32 v237, v237, -v111, -v112
v_max3_f32 v236, v236, v113, v114
buffer_load_dwordx4 v[52:55], v1, s[4:7], s38 offen offset:1024 sc1
v_max3_f32 v242, v242, v223, v224
v_max3_f32 v243, v243, -v223, -v224
v_max3_f32 v237, v237, -v113, -v114
v_max3_f32 v242, v242, v225, v226
v_max3_f32 v243, v243, -v225, -v226
v_max_f32 v236, v236, v115
v_max_f32_e64 v237, v237, -v115
v_max_f32 v242, v242, v227
v_max_f32_e64 v243, v243, -v227
v_permlane32_swap_b32 v236, v237
s_nop 0
v_permlane32_swap_b32 v242, v243
buffer_load_dwordx4 v[56:59], v1, s[4:7], s38 offen offset:2048 sc1
v_max_f32 v236, v236, v237
v_max_f32 v242, v242, v243
v_mov_b32 v238, v236
v_mov_b32 v244, v242
s_nop 0
v_permlane16_swap_b32 v236, v238
v_permlane16_swap_b32 v242, v244
v_max_f32 v236, v236, v238
v_max_f32 v242, v242, v244
v_mov_b32 v238, v236
v_mov_b32 v244, v242
buffer_load_dwordx4 v[60:63], v1, s[4:7], s38 offen offset:3072 sc1
v_permlane32_swap_b32 v236, v238
v_permlane32_swap_b32 v242, v244
v_mul_f32_e64 v236, -v236, v240
v_mul_f32_e64 v237, -v238, v240
v_mul_f32_e64 v242, -v242, v246
v_mul_f32_e64 v243, -v244, v246
v_pk_fma_f32 v[116:117], v[108:109], v[240:241], v[236:237] op_sel:[0,0,0] op_sel_hi:[1,0,0]
v_pk_fma_f32 v[118:119], v[110:111], v[240:241], v[236:237] op_sel:[0,0,0] op_sel_hi:[1,0,0]
v_pk_fma_f32 v[120:121], v[112:113], v[240:241], v[236:237] op_sel:[0,0,0] op_sel_hi:[1,0,0]
v_pk_fma_f32 v[122:123], v[114:115], v[240:241], v[236:237] op_sel:[0,0,0] op_sel_hi:[1,0,0]
v_pk_fma_f32 v[196:197], v[220:221], v[246:247], v[242:243] op_sel:[0,0,0] op_sel_hi:[1,0,0]
buffer_load_dwordx4 v[64:67], v1, s[4:7], s36 offen offset:0 sc1
v_pk_fma_f32 v[198:199], v[222:223], v[246:247], v[242:243] op_sel:[0,0,0] op_sel_hi:[1,0,0]
v_pk_fma_f32 v[200:201], v[224:225], v[246:247], v[242:243] op_sel:[0,0,0] op_sel_hi:[1,0,0]
v_pk_fma_f32 v[202:203], v[226:227], v[246:247], v[242:243] op_sel:[0,0,0] op_sel_hi:[1,0,0]
v_pk_fma_f32 v[108:109], v[108:109], v[240:241], v[236:237] op_sel:[0,0,1] op_sel_hi:[1,0,1] neg_lo:[1,0,0] neg_hi:[1,0,0]
v_pk_fma_f32 v[110:111], v[110:111], v[240:241], v[236:237] op_sel:[0,0,1] op_sel_hi:[1,0,1] neg_lo:[1,0,0] neg_hi:[1,0,0]
v_pk_fma_f32 v[112:113], v[112:113], v[240:241], v[236:237] op_sel:[0,0,1] op_sel_hi:[1,0,1] neg_lo:[1,0,0] neg_hi:[1,0,0]
v_pk_fma_f32 v[114:115], v[114:115], v[240:241], v[236:237] op_sel:[0,0,1] op_sel_hi:[1,0,1] neg_lo:[1,0,0] neg_hi:[1,0,0]
v_pk_fma_f32 v[220:221], v[220:221], v[246:247], v[242:243] op_sel:[0,0,1] op_sel_hi:[1,0,1] neg_lo:[1,0,0] neg_hi:[1,0,0]
v_pk_fma_f32 v[222:223], v[222:223], v[246:247], v[242:243] op_sel:[0,0,1] op_sel_hi:[1,0,1] neg_lo:[1,0,0] neg_hi:[1,0,0]
v_pk_fma_f32 v[224:225], v[224:225], v[246:247], v[242:243] op_sel:[0,0,1] op_sel_hi:[1,0,1] neg_lo:[1,0,0] neg_hi:[1,0,0]
v_pk_fma_f32 v[226:227], v[226:227], v[246:247], v[242:243] op_sel:[0,0,1] op_sel_hi:[1,0,1] neg_lo:[1,0,0] neg_hi:[1,0,0]
v_exp_f32 v116, v116
buffer_load_dwordx4 v[68:71], v1, s[4:7], s36 offen offset:1024 sc1
v_exp_f32 v108, v108
v_exp_f32 v117, v117
v_exp_f32 v109, v109
v_exp_f32 v118, v118
v_exp_f32 v110, v110
v_exp_f32 v119, v119
v_exp_f32 v111, v111
buffer_load_dwordx4 v[100:103], v1, s[4:7], s36 offen offset:2048 sc1
v_exp_f32 v120, v120
v_exp_f32 v112, v112
v_exp_f32 v121, v121
v_exp_f32 v113, v113
v_exp_f32 v122, v122
v_exp_f32 v114, v114
v_exp_f32 v123, v123
buffer_load_dwordx4 v[104:107], v1, s[4:7], s36 offen offset:3072 sc1
v_exp_f32 v115, v115
v_exp_f32 v196, v196
v_exp_f32 v220, v220
v_exp_f32 v197, v197
v_exp_f32 v221, v221
v_exp_f32 v198, v198
v_exp_f32 v222, v222
v_exp_f32 v199, v199
v_exp_f32 v223, v223
v_exp_f32 v200, v200
v_exp_f32 v224, v224
v_exp_f32 v201, v201
v_exp_f32 v225, v225
v_exp_f32 v202, v202
v_exp_f32 v226, v226
v_exp_f32 v203, v203
v_exp_f32 v227, v227
v_cvt_pk_bf16_f32 v188, v116, v117
v_cvt_pk_bf16_f32 v189, v118, v119
v_cvt_pk_bf16_f32 v190, v120, v121
v_cvt_pk_bf16_f32 v191, v122, v123
v_cvt_pk_bf16_f32 v192, v108, v109
v_cvt_pk_bf16_f32 v193, v110, v111
v_cvt_pk_bf16_f32 v194, v112, v113
v_cvt_pk_bf16_f32 v195, v114, v115
v_cvt_pk_bf16_f32 v212, v196, v197
v_cvt_pk_bf16_f32 v213, v198, v199
v_cvt_pk_bf16_f32 v214, v200, v201
v_cvt_pk_bf16_f32 v215, v202, v203
v_cvt_pk_bf16_f32 v216, v220, v221
v_cvt_pk_bf16_f32 v217, v222, v223
v_cvt_pk_bf16_f32 v218, v224, v225
v_cvt_pk_bf16_f32 v219, v226, v227
s_waitcnt vmcnt(8)
v_lshlrev_b32 v92, 16, v48
v_and_b32 v93, 0xffff0000, v48
v_lshlrev_b32 v94, 16, v49
v_and_b32 v95, 0xffff0000, v49
v_lshlrev_b32 v96, 16, v50
v_and_b32 v97, 0xffff0000, v50
v_lshlrev_b32 v98, 16, v51
v_and_b32 v99, 0xffff0000, v51
s_waitcnt vmcnt(7)
v_add_f32_dpp v128, v124, v124 row_ror:4 row_mask:0xf bank_mask:0xf
v_add_f32_dpp v129, v125, v125 row_ror:4 row_mask:0xf bank_mask:0xf
v_add_f32_dpp v130, v126, v126 row_ror:4 row_mask:0xf bank_mask:0xf
v_add_f32_dpp v131, v127, v127 row_ror:4 row_mask:0xf bank_mask:0xf
v_add_f32_dpp v128, v128, v128 row_ror:2 row_mask:0xf bank_mask:0xf
v_add_f32_dpp v129, v129, v129 row_ror:2 row_mask:0xf bank_mask:0xf
v_add_f32_dpp v130, v130, v130 row_ror:2 row_mask:0xf bank_mask:0xf
v_add_f32_dpp v131, v131, v131 row_ror:2 row_mask:0xf bank_mask:0xf
v_add_f32_dpp v128, v128, v128 row_ror:1 row_mask:0xf bank_mask:0xf
v_add_f32_dpp v129, v129, v129 row_ror:1 row_mask:0xf bank_mask:0xf
v_add_f32_dpp v130, v130, v130 row_ror:1 row_mask:0xf bank_mask:0xf
v_add_f32_dpp v131, v131, v131 row_ror:1 row_mask:0xf bank_mask:0xf
v_fma_f32 v135, v129, v130, v131
s_waitcnt vmcnt(6)
v_dot2c_f32_bf16 v92, v52, v249
v_dot2c_f32_bf16 v93, v52, v250
v_dot2c_f32_bf16 v94, v53, v249
v_dot2c_f32_bf16 v95, v53, v250
v_dot2c_f32_bf16 v96, v54, v249
v_dot2c_f32_bf16 v97, v54, v250
v_dot2c_f32_bf16 v98, v55, v249
v_dot2c_f32_bf16 v99, v55, v250
s_waitcnt vmcnt(5)
v_dot2c_f32_bf16 v92, v56, v249
v_dot2c_f32_bf16 v93, v56, v250
v_dot2c_f32_bf16 v94, v57, v249
v_dot2c_f32_bf16 v95, v57, v250
v_dot2c_f32_bf16 v96, v58, v249
v_dot2c_f32_bf16 v97, v58, v250
v_dot2c_f32_bf16 v98, v59, v249
v_dot2c_f32_bf16 v99, v59, v250
s_waitcnt vmcnt(4)
v_dot2c_f32_bf16 v92, v60, v249
v_dot2c_f32_bf16 v93, v60, v250
v_dot2c_f32_bf16 v94, v61, v249
v_dot2c_f32_bf16 v95, v61, v250
v_dot2c_f32_bf16 v96, v62, v249
v_dot2c_f32_bf16 v97, v62, v250
v_dot2c_f32_bf16 v98, v63, v249
v_dot2c_f32_bf16 v99, v63, v250
s_waitcnt vmcnt(3)
v_dot2c_f32_bf16 v92, v64, v249
v_dot2c_f32_bf16 v93, v64, v250
v_dot2c_f32_bf16 v94, v65, v249
v_dot2c_f32_bf16 v95, v65, v250
v_dot2c_f32_bf16 v96, v66, v249
v_dot2c_f32_bf16 v97, v66, v250
v_dot2c_f32_bf16 v98, v67, v249
v_dot2c_f32_bf16 v99, v67, v250
s_waitcnt vmcnt(2)
v_dot2c_f32_bf16 v92, v68, v249
v_dot2c_f32_bf16 v93, v68, v250
v_dot2c_f32_bf16 v94, v69, v249
v_dot2c_f32_bf16 v95, v69, v250
v_dot2c_f32_bf16 v96, v70, v249
v_dot2c_f32_bf16 v97, v70, v250
v_dot2c_f32_bf16 v98, v71, v249
v_dot2c_f32_bf16 v99, v71, v250
s_waitcnt vmcnt(1)
v_dot2c_f32_bf16 v92, v100, v249
v_dot2c_f32_bf16 v93, v100, v250
v_dot2c_f32_bf16 v94, v101, v249
v_dot2c_f32_bf16 v95, v101, v250
v_dot2c_f32_bf16 v96, v102, v249
v_dot2c_f32_bf16 v97, v102, v250
v_dot2c_f32_bf16 v98, v103, v249
v_dot2c_f32_bf16 v99, v103, v250
s_waitcnt vmcnt(0)
v_dot2c_f32_bf16 v92, v104, v249
v_dot2c_f32_bf16 v93, v104, v250
v_dot2c_f32_bf16 v94, v105, v249
v_dot2c_f32_bf16 v95, v105, v250
v_dot2c_f32_bf16 v96, v106, v249
v_dot2c_f32_bf16 v97, v106, v250
v_dot2c_f32_bf16 v98, v107, v249
v_dot2c_f32_bf16 v99, v107, v250
v_fma_f32 v132, v92, v93, v94
v_fma_f32 v133, v95, v96, v97
s_nop 0
v_fma_f32 v134, v98, v99, v128
v_fma_f32 v132, v132, v133, v134
v_cmp_u_f32 vcc, v132, v135
s_cbranch_vccnz L_kvredo3
L_kvback3:
s_lshr_b32 s36, s28, 1
s_and_b32 s37, s28, 1
v_cvt_pk_bf16_f32 v128, v128, v129
v_cvt_pk_bf16_f32 v129, v130, v131
s_mul_i32 s36, s36, 3072
s_lshl_b32 s37, s37, 3
v_cvt_pk_bf16_f32 v92, v92, v93
v_cndmask_b32 v128, 0, v128, s[56:57]
v_cndmask_b32 v129, 0, v129, s[56:57]
s_add_u32 s36, s36, s37
v_cvt_pk_bf16_f32 v93, v94, v95
v_cvt_pk_bf16_f32 v94, v96, v97
v_cvt_pk_bf16_f32 v95, v98, v99
v_cndmask_b32 v128, v128, v16, s[58:59]
v_cndmask_b32 v129, v129, v16, s[58:59]
v_add_u32 v236, s36, v1
s_lshl_b32 s35, s30, 12
ds_write_b64 v236, v[92:93] offset:0
ds_write_b64 v236, v[94:95] offset:1024
ds_write_b64 v236, v[128:129] offset:2048
s_add_u32 s35, s35, 0x2600000
s_add_u32 s94, s71, 0x30080
s_waitcnt lgkmcnt(0)
s_barrier
ds_read_b128 a[8:11], v1 offset:2048
ds_read_b128 a[20:23], v1 offset:5120
ds_read_b128 a[0:3], v1 offset:0
ds_read_b128 a[12:15], v1 offset:3072
ds_read_b128 a[4:7], v1 offset:1024
ds_read_b128 a[16:19], v1 offset:4096
s_waitcnt lgkmcnt(5)
v_mfma_f32_16x16x32_bf16 v[92:95], a[8:11], v[140:143], 0
s_waitcnt lgkmcnt(4)
v_mfma_f32_16x16x32_bf16 v[96:99], a[20:23], v[144:147], 0
s_waitcnt lgkmcnt(3)
v_mfma_f32_16x16x32_bf16 v[132:135], a[0:3], v[140:143], 0
s_nop 3
v_rcp_f32 v94, v93
s_waitcnt lgkmcnt(2)
v_mfma_f32_16x16x32_bf16 v[148:151], a[12:15], v[144:147], 0
v_rcp_f32 v95, v97
v_mul_f32 v92, v92, v94
v_fmac_f32 v92, v96, v95
v_mfma_f32_16x16x32_bf16 v[100:103], a[8:11], v[164:167], 0
v_add_f32 v92, 0x358637bd, v92
v_rcp_f32 v92, v92
s_waitcnt lgkmcnt(1)
v_mfma_f32_16x16x32_bf16 v[136:139], a[4:7], v[140:143], 0
v_mul_f32 v94, v94, v92
v_mul_f32 v95, v95, v92
v_mfma_f32_16x16x32_bf16 v[104:107], a[20:23], v[168:171], 0
v_mul_f32 v132, v132, v94
v_mul_f32 v133, v133, v94
s_waitcnt lgkmcnt(0)
v_mfma_f32_16x16x32_bf16 v[152:155], a[16:19], v[144:147], 0
v_mul_f32 v134, v134, v94
v_mul_f32 v135, v135, v94
v_fmac_f32 v132, v148, v95
v_fmac_f32 v133, v149, v95
v_rcp_f32 v102, v101
v_mul_f32 v136, v136, v94
v_mul_f32 v137, v137, v94
v_mul_f32 v138, v138, v94
v_mul_f32 v139, v139, v94
v_fmac_f32 v134, v150, v95
v_fmac_f32 v135, v151, v95
v_cvt_pk_bf16_f32 v132, v132, v133
v_rcp_f32 v103, v105
v_fmac_f32 v136, v152, v95
v_fmac_f32 v137, v153, v95
v_fmac_f32 v138, v154, v95
v_fmac_f32 v139, v155, v95
v_cvt_pk_bf16_f32 v133, v134, v135
v_cvt_pk_bf16_f32 v134, v136, v137
v_cvt_pk_bf16_f32 v135, v138, v139
v_mul_f32 v100, v100, v102
v_mfma_f32_16x16x32_bf16 v[156:159], a[0:3], v[164:167], 0
buffer_store_dwordx4 v[132:135], v2, s[4:7], s35 offen offset:0 sc1
v_fmac_f32 v100, v104, v103
v_mfma_f32_16x16x32_bf16 v[172:175], a[12:15], v[168:171], 0
v_add_f32 v100, 0x358637bd, v100
v_rcp_f32 v100, v100
v_mfma_f32_16x16x32_bf16 v[108:111], a[8:11], v[188:191], 0
v_mul_f32 v102, v102, v100
v_mul_f32 v103, v103, v100
v_mfma_f32_16x16x32_bf16 v[160:163], a[4:7], v[164:167], 0
v_mul_f32 v156, v156, v102
v_mul_f32 v157, v157, v102
v_mfma_f32_16x16x32_bf16 v[112:115], a[20:23], v[192:195], 0
v_mul_f32 v158, v158, v102
v_mul_f32 v159, v159, v102
v_mfma_f32_16x16x32_bf16 v[176:179], a[16:19], v[168:171], 0
v_fmac_f32 v156, v172, v103
v_fmac_f32 v157, v173, v103
v_rcp_f32 v110, v109
v_mul_f32 v160, v160, v102
v_mul_f32 v161, v161, v102
v_mul_f32 v162, v162, v102
v_mul_f32 v163, v163, v102
v_fmac_f32 v158, v174, v103
v_fmac_f32 v159, v175, v103
v_cvt_pk_bf16_f32 v156, v156, v157
v_rcp_f32 v111, v113
v_fmac_f32 v160, v176, v103
v_fmac_f32 v161, v177, v103
v_fmac_f32 v162, v178, v103
v_fmac_f32 v163, v179, v103
v_cvt_pk_bf16_f32 v157, v158, v159
v_cvt_pk_bf16_f32 v158, v160, v161
v_cvt_pk_bf16_f32 v159, v162, v163
v_mul_f32 v108, v108, v110
v_mfma_f32_16x16x32_bf16 v[180:183], a[0:3], v[188:191], 0
buffer_store_dwordx4 v[156:159], v2, s[4:7], s35 offen offset:1024 sc1
v_fmac_f32 v108, v112, v111
v_mfma_f32_16x16x32_bf16 v[196:199], a[12:15], v[192:195], 0
v_add_f32 v108, 0x358637bd, v108
v_rcp_f32 v108, v108
v_mfma_f32_16x16x32_bf16 v[116:119], a[8:11], v[212:215], 0
v_mul_f32 v110, v110, v108
v_mul_f32 v111, v111, v108
v_mfma_f32_16x16x32_bf16 v[184:187], a[4:7], v[188:191], 0
v_mul_f32 v180, v180, v110
v_mul_f32 v181, v181, v110
v_mfma_f32_16x16x32_bf16 v[120:123], a[20:23], v[216:219], 0
v_mul_f32 v182, v182, v110
v_mul_f32 v183, v183, v110
v_mfma_f32_16x16x32_bf16 v[200:203], a[16:19], v[192:195], 0
v_fmac_f32 v180, v196, v111
v_fmac_f32 v181, v197, v111
v_rcp_f32 v118, v117
v_mul_f32 v184, v184, v110
v_mul_f32 v185, v185, v110
v_mul_f32 v186, v186, v110
v_mul_f32 v187, v187, v110
v_fmac_f32 v182, v198, v111
v_fmac_f32 v183, v199, v111
v_cvt_pk_bf16_f32 v180, v180, v181
v_rcp_f32 v119, v121
buffer_atomic_add v12, v10, s[4:7], s94 offen sc1
v_fmac_f32 v184, v200, v111
v_fmac_f32 v185, v201, v111
v_fmac_f32 v186, v202, v111
v_fmac_f32 v187, v203, v111
v_cvt_pk_bf16_f32 v181, v182, v183
v_cvt_pk_bf16_f32 v182, v184, v185
v_cvt_pk_bf16_f32 v183, v186, v187
v_mul_f32 v116, v116, v118
v_mfma_f32_16x16x32_bf16 v[204:207], a[0:3], v[212:215], 0
buffer_store_dwordx4 v[180:183], v2, s[4:7], s35 offen offset:2048 sc1
v_fmac_f32 v116, v120, v119
v_mfma_f32_16x16x32_bf16 v[220:223], a[12:15], v[216:219], 0
v_add_f32 v116, 0x358637bd, v116
v_rcp_f32 v116, v116
v_mfma_f32_16x16x32_bf16 v[208:211], a[4:7], v[212:215], 0
v_mul_f32 v118, v118, v116
v_mul_f32 v119, v119, v116
v_mfma_f32_16x16x32_bf16 v[224:227], a[16:19], v[216:219], 0
v_mul_f32 v204, v204, v118
v_mul_f32 v205, v205, v118
v_mul_f32 v206, v206, v118
v_mul_f32 v207, v207, v118
v_fmac_f32 v204, v220, v119
v_fmac_f32 v205, v221, v119
v_mul_f32 v208, v208, v118
v_mul_f32 v209, v209, v118
v_mul_f32 v210, v210, v118
v_mul_f32 v211, v211, v118
v_fmac_f32 v206, v222, v119
v_fmac_f32 v207, v223, v119
v_cvt_pk_bf16_f32 v204, v204, v205
v_fmac_f32 v208, v224, v119
v_fmac_f32 v209, v225, v119
v_fmac_f32 v210, v226, v119
v_fmac_f32 v211, v227, v119
v_cvt_pk_bf16_f32 v205, v206, v207
v_cvt_pk_bf16_f32 v206, v208, v209
L_stub19:
s_cbranch_execz L_wret6
v_cvt_pk_bf16_f32 v207, v210, v211
buffer_store_dwordx4 v[204:207], v2, s[4:7], s35 offen offset:3072 sc1
s_add_u32 s92, s71, 0x30000
s_add_u32 s36, s66, 0x30080
s_add_u32 s40, s4, 0x2600000
s_addc_u32 s41, s5, 0
v_add_u32 v5, 32768, v1
v_add_u32 v6, 98304, v1
s_cmp_eq_u32 s3, 0
s_cselect_b32 s35, 8, 0
s_lshl_b32 s35, s35, 12
v_lshlrev_b32 v132, 16, v32
v_and_b32 v133, 0xffff0000, v32
v_lshlrev_b32 v134, 16, v33
v_and_b32 v135, 0xffff0000, v33
v_lshlrev_b32 v136, 16, v34
v_and_b32 v137, 0xffff0000, v34
v_lshlrev_b32 v138, 16, v35
v_and_b32 v139, 0xffff0000, v35
v_lshlrev_b32 v140, 16, v36
v_and_b32 v141, 0xffff0000, v36
v_lshlrev_b32 v142, 16, v37
v_and_b32 v143, 0xffff0000, v37
v_lshlrev_b32 v144, 16, v38
v_and_b32 v145, 0xffff0000, v38
v_lshlrev_b32 v146, 16, v39
v_and_b32 v147, 0xffff0000, v39
v_lshlrev_b32 v148, 16, v40
v_and_b32 v149, 0xffff0000, v40
v_lshlrev_b32 v150, 16, v41
v_and_b32 v151, 0xffff0000, v41
v_lshlrev_b32 v152, 16, v42
v_and_b32 v153, 0xffff0000, v42
v_lshlrev_b32 v154, 16, v43
v_and_b32 v155, 0xffff0000, v43
v_lshlrev_b32 v156, 16, v44
v_and_b32 v157, 0xffff0000, v44
v_lshlrev_b32 v158, 16, v45
v_and_b32 v159, 0xffff0000, v45
v_lshlrev_b32 v160, 16, v46
v_and_b32 v161, 0xffff0000, v46
v_lshlrev_b32 v162, 16, v47
v_and_b32 v163, 0xffff0000, v47
s_mov_b32 s95, -1
s_mov_b64 exec, 0
s_cmp_eq_u32 s28, 3
s_cbranch_scc1 L_stub20
s_cmp_eq_u32 s28, 2
s_cbranch_scc1 L_wret7
L_wret7:
s_mov_b64 exec, -1
s_cmp_lg_u32 s28, 0
s_cbranch_scc1 Lpe_37
s_add_u32 s36, s66, 0x30080
s_mov_b32 s37, 0
Lpoll_36:
v_mov_b32 v11, 0
buffer_atomic_add v11, v251, s[4:7], s36 offen sc0 sc1
s_add_u32 s37, s37, 1
s_waitcnt vmcnt(0)
v_readfirstlane_b32 s38, v11
s_nop 0
s_cmp_ge_u32 s38, 32
s_cbranch_scc1 Lpe_37
s_cmp_lt_u32 s37, 0x100000
s_cbranch_scc1 Lpoll_36
Lpe_37:
s_waitcnt vmcnt(0)
s_barrier
L_k2go3:
buffer_load_dwordx4 a[0:3], v4, s[40:43], s35 offen offset:0 sc1
buffer_load_dwordx4 a[4:7], v4, s[40:43], s35 offen offset:1024 sc1
s_cmp_eq_u32 s3, 1
s_cselect_b32 s35, 9, 1
s_lshl_b32 s35, s35, 12
buffer_load_dwordx4 a[8:11], v4, s[40:43], s35 offen offset:0 sc1
buffer_load_dwordx4 a[12:15], v4, s[40:43], s35 offen offset:1024 sc1
s_cmp_eq_u32 s3, 2
s_cselect_b32 s35, 10, 2
s_lshl_b32 s35, s35, 12
buffer_load_dwordx4 a[16:19], v4, s[40:43], s35 offen offset:0 sc1
buffer_load_dwordx4 a[20:23], v4, s[40:43], s35 offen offset:1024 sc1
s_cmp_eq_u32 s3, 3
s_cselect_b32 s35, 11, 3
s_lshl_b32 s35, s35, 12
buffer_load_dwordx4 a[24:27], v4, s[40:43], s35 offen offset:0 sc1
buffer_load_dwordx4 a[28:31], v4, s[40:43], s35 offen offset:1024 sc1
s_cmp_eq_u32 s3, 4
s_cselect_b32 s35, 12, 4
s_lshl_b32 s35, s35, 12
buffer_load_dwordx4 a[32:35], v4, s[40:43], s35 offen offset:0 sc1
buffer_load_dwordx4 a[36:39], v4, s[40:43], s35 offen offset:1024 sc1
s_cmp_eq_u32 s3, 5
s_cselect_b32 s35, 13, 5
s_lshl_b32 s35, s35, 12
ds_read_b128 a[96:99], v5 offset:0
ds_read_b128 a[100:103], v5 offset:1024
ds_read_b128 a[104:107], v5 offset:2048
ds_read_b128 a[108:111], v5 offset:3072
ds_read_b128 a[112:115], v5 offset:4096
ds_read_b128 a[116:119], v5 offset:5120
ds_read_b128 a[120:123], v5 offset:6144
ds_read_b128 a[124:127], v5 offset:7168
s_waitcnt vmcnt(8) lgkmcnt(4)
v_mfma_f32_16x16x32_bf16 v[132:135], a[96:99], a[0:3], v[132:135]
ds_read_b128 a[128:131], v5 offset:8192
v_mfma_f32_16x16x32_bf16 v[148:151], a[96:99], a[4:7], v[148:151]
ds_read_b128 a[132:135], v5 offset:9216
v_mfma_f32_16x16x32_bf16 v[152:155], a[100:103], a[4:7], v[152:155]
buffer_load_dwordx4 a[40:43], v4, s[40:43], s35 offen offset:0 sc1
v_mfma_f32_16x16x32_bf16 v[136:139], a[100:103], a[0:3], v[136:139]
ds_read_b128 a[136:139], v5 offset:10240
v_mfma_f32_16x16x32_bf16 v[140:143], a[104:107], a[0:3], v[140:143]
ds_read_b128 a[140:143], v5 offset:11264
v_mfma_f32_16x16x32_bf16 v[156:159], a[104:107], a[4:7], v[156:159]
v_mfma_f32_16x16x32_bf16 v[160:163], a[108:111], a[4:7], v[160:163]
buffer_load_dwordx4 a[44:47], v4, s[40:43], s35 offen offset:1024 sc1
v_mfma_f32_16x16x32_bf16 v[144:147], a[108:111], a[0:3], v[144:147]
s_waitcnt vmcnt(8) lgkmcnt(4)
v_mfma_f32_16x16x32_bf16 v[132:135], a[112:115], a[8:11], v[132:135]
s_cmp_eq_u32 s3, 6
s_cselect_b32 s35, 14, 6
s_lshl_b32 s35, s35, 12
v_mfma_f32_16x16x32_bf16 v[148:151], a[112:115], a[12:15], v[148:151]
ds_read_b128 a[96:99], v5 offset:12288
v_mfma_f32_16x16x32_bf16 v[152:155], a[116:119], a[12:15], v[152:155]
buffer_load_dwordx4 a[0:3], v4, s[40:43], s35 offen offset:0 sc1
v_mfma_f32_16x16x32_bf16 v[136:139], a[116:119], a[8:11], v[136:139]
ds_read_b128 a[100:103], v5 offset:13312
v_mfma_f32_16x16x32_bf16 v[140:143], a[120:123], a[8:11], v[140:143]
ds_read_b128 a[104:107], v5 offset:14336
v_mfma_f32_16x16x32_bf16 v[156:159], a[120:123], a[12:15], v[156:159]
ds_read_b128 a[108:111], v5 offset:15360
v_mfma_f32_16x16x32_bf16 v[160:163], a[124:127], a[12:15], v[160:163]
buffer_load_dwordx4 a[4:7], v4, s[40:43], s35 offen offset:1024 sc1
v_mfma_f32_16x16x32_bf16 v[144:147], a[124:127], a[8:11], v[144:147]
s_waitcnt vmcnt(8) lgkmcnt(4)
v_mfma_f32_16x16x32_bf16 v[132:135], a[128:131], a[16:19], v[132:135]
s_cmp_eq_u32 s3, 7
s_cselect_b32 s35, 15, 7
s_lshl_b32 s35, s35, 12
v_mfma_f32_16x16x32_bf16 v[148:151], a[128:131], a[20:23], v[148:151]
ds_read_b128 a[112:115], v5 offset:16384
v_mfma_f32_16x16x32_bf16 v[152:155], a[132:135], a[20:23], v[152:155]
buffer_load_dwordx4 a[8:11], v4, s[40:43], s35 offen offset:0 sc1
v_mfma_f32_16x16x32_bf16 v[136:139], a[132:135], a[16:19], v[136:139]
ds_read_b128 a[116:119], v5 offset:17408
v_mfma_f32_16x16x32_bf16 v[140:143], a[136:139], a[16:19], v[140:143]
ds_read_b128 a[120:123], v5 offset:18432
v_mfma_f32_16x16x32_bf16 v[156:159], a[136:139], a[20:23], v[156:159]
ds_read_b128 a[124:127], v5 offset:19456
v_mfma_f32_16x16x32_bf16 v[160:163], a[140:143], a[20:23], v[160:163]
buffer_load_dwordx4 a[12:15], v4, s[40:43], s35 offen offset:1024 sc1
v_mfma_f32_16x16x32_bf16 v[144:147], a[140:143], a[16:19], v[144:147]
s_waitcnt vmcnt(8) lgkmcnt(4)
v_mfma_f32_16x16x32_bf16 v[132:135], a[96:99], a[24:27], v[132:135]
s_cmp_eq_u32 s3, 0
s_cselect_b32 s35, 16, 8
s_lshl_b32 s35, s35, 12
v_mfma_f32_16x16x32_bf16 v[148:151], a[96:99], a[28:31], v[148:151]
ds_read_b128 a[128:131], v5 offset:20480
v_mfma_f32_16x16x32_bf16 v[152:155], a[100:103], a[28:31], v[152:155]
buffer_load_dwordx4 a[16:19], v4, s[40:43], s35 offen offset:0 sc1
v_mfma_f32_16x16x32_bf16 v[136:139], a[100:103], a[24:27], v[136:139]
ds_read_b128 a[132:135], v5 offset:21504
v_mfma_f32_16x16x32_bf16 v[140:143], a[104:107], a[24:27], v[140:143]
ds_read_b128 a[136:139], v5 offset:22528
v_mfma_f32_16x16x32_bf16 v[156:159], a[104:107], a[28:31], v[156:159]
ds_read_b128 a[140:143], v5 offset:23552
v_mfma_f32_16x16x32_bf16 v[160:163], a[108:111], a[28:31], v[160:163]
buffer_load_dwordx4 a[20:23], v4, s[40:43], s35 offen offset:1024 sc1
v_mfma_f32_16x16x32_bf16 v[144:147], a[108:111], a[24:27], v[144:147]
s_waitcnt vmcnt(8) lgkmcnt(4)
v_mfma_f32_16x16x32_bf16 v[132:135], a[112:115], a[32:35], v[132:135]
s_cmp_eq_u32 s3, 1
s_cselect_b32 s35, 17, 9
s_lshl_b32 s35, s35, 12
v_mfma_f32_16x16x32_bf16 v[148:151], a[112:115], a[36:39], v[148:151]
ds_read_b128 a[96:99], v5 offset:24576
v_mfma_f32_16x16x32_bf16 v[152:155], a[116:119], a[36:39], v[152:155]
buffer_load_dwordx4 a[24:27], v4, s[40:43], s35 offen offset:0 sc1
v_mfma_f32_16x16x32_bf16 v[136:139], a[116:119], a[32:35], v[136:139]
ds_read_b128 a[100:103], v5 offset:25600
v_mfma_f32_16x16x32_bf16 v[140:143], a[120:123], a[32:35], v[140:143]
ds_read_b128 a[104:107], v5 offset:26624
v_mfma_f32_16x16x32_bf16 v[156:159], a[120:123], a[36:39], v[156:159]
ds_read_b128 a[108:111], v5 offset:27648
v_mfma_f32_16x16x32_bf16 v[160:163], a[124:127], a[36:39], v[160:163]
buffer_load_dwordx4 a[28:31], v4, s[40:43], s35 offen offset:1024 sc1
v_mfma_f32_16x16x32_bf16 v[144:147], a[124:127], a[32:35], v[144:147]
s_waitcnt vmcnt(8) lgkmcnt(4)
v_mfma_f32_16x16x32_bf16 v[132:135], a[128:131], a[40:43], v[132:135]
s_cmp_eq_u32 s3, 2
s_cselect_b32 s35, 18, 10
s_lshl_b32 s35, s35, 12
v_mfma_f32_16x16x32_bf16 v[148:151], a[128:131], a[44:47], v[148:151]
ds_read_b128 a[112:115], v5 offset:28672
v_mfma_f32_16x16x32_bf16 v[152:155], a[132:135], a[44:47], v[152:155]
buffer_load_dwordx4 a[32:35], v4, s[40:43], s35 offen offset:0 sc1
v_mfma_f32_16x16x32_bf16 v[136:139], a[132:135], a[40:43], v[136:139]
ds_read_b128 a[116:119], v5 offset:29696
v_mfma_f32_16x16x32_bf16 v[140:143], a[136:139], a[40:43], v[140:143]
ds_read_b128 a[120:123], v5 offset:30720
v_mfma_f32_16x16x32_bf16 v[156:159], a[136:139], a[44:47], v[156:159]
ds_read_b128 a[124:127], v5 offset:31744
v_mfma_f32_16x16x32_bf16 v[160:163], a[140:143], a[44:47], v[160:163]
buffer_load_dwordx4 a[36:39], v4, s[40:43], s35 offen offset:1024 sc1
v_mfma_f32_16x16x32_bf16 v[144:147], a[140:143], a[40:43], v[144:147]
s_waitcnt vmcnt(8) lgkmcnt(4)
v_mfma_f32_16x16x32_bf16 v[132:135], a[96:99], a[0:3], v[132:135]
s_cmp_eq_u32 s3, 3
s_cselect_b32 s35, 19, 11
s_lshl_b32 s35, s35, 12
v_mfma_f32_16x16x32_bf16 v[148:151], a[96:99], a[4:7], v[148:151]
ds_read_b128 a[128:131], v5 offset:32768
v_mfma_f32_16x16x32_bf16 v[152:155], a[100:103], a[4:7], v[152:155]
buffer_load_dwordx4 a[40:43], v4, s[40:43], s35 offen offset:0 sc1
v_mfma_f32_16x16x32_bf16 v[136:139], a[100:103], a[0:3], v[136:139]
ds_read_b128 a[132:135], v5 offset:33792
v_mfma_f32_16x16x32_bf16 v[140:143], a[104:107], a[0:3], v[140:143]
ds_read_b128 a[136:139], v5 offset:34816
v_mfma_f32_16x16x32_bf16 v[156:159], a[104:107], a[4:7], v[156:159]
ds_read_b128 a[140:143], v5 offset:35840
v_mfma_f32_16x16x32_bf16 v[160:163], a[108:111], a[4:7], v[160:163]
buffer_load_dwordx4 a[44:47], v4, s[40:43], s35 offen offset:1024 sc1
v_mfma_f32_16x16x32_bf16 v[144:147], a[108:111], a[0:3], v[144:147]
s_waitcnt vmcnt(8) lgkmcnt(4)
v_mfma_f32_16x16x32_bf16 v[132:135], a[112:115], a[8:11], v[132:135]
s_cmp_eq_u32 s3, 4
s_cselect_b32 s35, 20, 12
s_lshl_b32 s35, s35, 12
v_mfma_f32_16x16x32_bf16 v[148:151], a[112:115], a[12:15], v[148:151]
ds_read_b128 a[96:99], v5 offset:36864
v_mfma_f32_16x16x32_bf16 v[152:155], a[116:119], a[12:15], v[152:155]
buffer_load_dwordx4 a[0:3], v4, s[40:43], s35 offen offset:0 sc1
v_mfma_f32_16x16x32_bf16 v[136:139], a[116:119], a[8:11], v[136:139]
ds_read_b128 a[100:103], v5 offset:37888
v_mfma_f32_16x16x32_bf16 v[140:143], a[120:123], a[8:11], v[140:143]
ds_read_b128 a[104:107], v5 offset:38912
v_mfma_f32_16x16x32_bf16 v[156:159], a[120:123], a[12:15], v[156:159]
ds_read_b128 a[108:111], v5 offset:39936
v_mfma_f32_16x16x32_bf16 v[160:163], a[124:127], a[12:15], v[160:163]
buffer_load_dwordx4 a[4:7], v4, s[40:43], s35 offen offset:1024 sc1
v_mfma_f32_16x16x32_bf16 v[144:147], a[124:127], a[8:11], v[144:147]
s_waitcnt vmcnt(8) lgkmcnt(4)
v_mfma_f32_16x16x32_bf16 v[132:135], a[128:131], a[16:19], v[132:135]
s_cmp_eq_u32 s3, 5
s_cselect_b32 s35, 21, 13
s_lshl_b32 s35, s35, 12
v_mfma_f32_16x16x32_bf16 v[148:151], a[128:131], a[20:23], v[148:151]
ds_read_b128 a[112:115], v5 offset:40960
v_mfma_f32_16x16x32_bf16 v[152:155], a[132:135], a[20:23], v[152:155]
buffer_load_dwordx4 a[8:11], v4, s[40:43], s35 offen offset:0 sc1
v_mfma_f32_16x16x32_bf16 v[136:139], a[132:135], a[16:19], v[136:139]
ds_read_b128 a[116:119], v5 offset:41984
v_mfma_f32_16x16x32_bf16 v[140:143], a[136:139], a[16:19], v[140:143]
ds_read_b128 a[120:123], v5 offset:43008
v_mfma_f32_16x16x32_bf16 v[156:159], a[136:139], a[20:23], v[156:159]
ds_read_b128 a[124:127], v5 offset:44032
v_mfma_f32_16x16x32_bf16 v[160:163], a[140:143], a[20:23], v[160:163]
buffer_load_dwordx4 a[12:15], v4, s[40:43], s35 offen offset:1024 sc1
v_mfma_f32_16x16x32_bf16 v[144:147], a[140:143], a[16:19], v[144:147]
s_waitcnt vmcnt(8) lgkmcnt(4)
v_mfma_f32_16x16x32_bf16 v[132:135], a[96:99], a[24:27], v[132:135]
s_cmp_eq_u32 s3, 6
s_cselect_b32 s35, 22, 14
s_lshl_b32 s35, s35, 12
v_mfma_f32_16x16x32_bf16 v[148:151], a[96:99], a[28:31], v[148:151]
ds_read_b128 a[128:131], v5 offset:45056
v_mfma_f32_16x16x32_bf16 v[152:155], a[100:103], a[28:31], v[152:155]
buffer_load_dwordx4 a[16:19], v4, s[40:43], s35 offen offset:0 sc1
v_mfma_f32_16x16x32_bf16 v[136:139], a[100:103], a[24:27], v[136:139]
ds_read_b128 a[132:135], v5 offset:46080
v_mfma_f32_16x16x32_bf16 v[140:143], a[104:107], a[24:27], v[140:143]
ds_read_b128 a[136:139], v5 offset:47104
v_mfma_f32_16x16x32_bf16 v[156:159], a[104:107], a[28:31], v[156:159]
ds_read_b128 a[140:143], v5 offset:48128
v_mfma_f32_16x16x32_bf16 v[160:163], a[108:111], a[28:31], v[160:163]
buffer_load_dwordx4 a[20:23], v4, s[40:43], s35 offen offset:1024 sc1
v_mfma_f32_16x16x32_bf16 v[144:147], a[108:111], a[24:27], v[144:147]
s_waitcnt vmcnt(8) lgkmcnt(4)
v_mfma_f32_16x16x32_bf16 v[132:135], a[112:115], a[32:35], v[132:135]
s_cmp_eq_u32 s3, 7
s_cselect_b32 s35, 23, 15
s_lshl_b32 s35, s35, 12
v_mfma_f32_16x16x32_bf16 v[148:151], a[112:115], a[36:39], v[148:151]
ds_read_b128 a[96:99], v5 offset:49152
v_mfma_f32_16x16x32_bf16 v[152:155], a[116:119], a[36:39], v[152:155]
buffer_load_dwordx4 a[24:27], v4, s[40:43], s35 offen offset:0 sc1
v_mfma_f32_16x16x32_bf16 v[136:139], a[116:119], a[32:35], v[136:139]
ds_read_b128 a[100:103], v5 offset:50176
v_mfma_f32_16x16x32_bf16 v[140:143], a[120:123], a[32:35], v[140:143]
ds_read_b128 a[104:107], v5 offset:51200
v_mfma_f32_16x16x32_bf16 v[156:159], a[120:123], a[36:39], v[156:159]
ds_read_b128 a[108:111], v5 offset:52224
v_mfma_f32_16x16x32_bf16 v[160:163], a[124:127], a[36:39], v[160:163]
buffer_load_dwordx4 a[28:31], v4, s[40:43], s35 offen offset:1024 sc1
v_mfma_f32_16x16x32_bf16 v[144:147], a[124:127], a[32:35], v[144:147]
s_waitcnt vmcnt(8) lgkmcnt(4)
v_mfma_f32_16x16x32_bf16 v[132:135], a[128:131], a[40:43], v[132:135]
s_cmp_eq_u32 s3, 0
s_cselect_b32 s35, 24, 16
s_lshl_b32 s35, s35, 12
v_mfma_f32_16x16x32_bf16 v[148:151], a[128:131], a[44:47], v[148:151]
ds_read_b128 a[112:115], v5 offset:53248
v_mfma_f32_16x16x32_bf16 v[152:155], a[132:135], a[44:47], v[152:155]
buffer_load_dwordx4 a[32:35], v4, s[40:43], s35 offen offset:0 sc1
v_mfma_f32_16x16x32_bf16 v[136:139], a[132:135], a[40:43], v[136:139]
ds_read_b128 a[116:119], v5 offset:54272
v_mfma_f32_16x16x32_bf16 v[140:143], a[136:139], a[40:43], v[140:143]
ds_read_b128 a[120:123], v5 offset:55296
v_mfma_f32_16x16x32_bf16 v[156:159], a[136:139], a[44:47], v[156:159]
ds_read_b128 a[124:127], v5 offset:56320
v_mfma_f32_16x16x32_bf16 v[160:163], a[140:143], a[44:47], v[160:163]
buffer_load_dwordx4 a[36:39], v4, s[40:43], s35 offen offset:1024 sc1
v_mfma_f32_16x16x32_bf16 v[144:147], a[140:143], a[40:43], v[144:147]
s_waitcnt vmcnt(8) lgkmcnt(4)
v_mfma_f32_16x16x32_bf16 v[132:135], a[96:99], a[0:3], v[132:135]
s_cmp_eq_u32 s3, 1
s_cselect_b32 s35, 25, 17
s_lshl_b32 s35, s35, 12
v_mfma_f32_16x16x32_bf16 v[148:151], a[96:99], a[4:7], v[148:151]
ds_read_b128 a[128:131], v5 offset:57344
v_mfma_f32_16x16x32_bf16 v[152:155], a[100:103], a[4:7], v[152:155]
buffer_load_dwordx4 a[40:43], v4, s[40:43], s35 offen offset:0 sc1
v_mfma_f32_16x16x32_bf16 v[136:139], a[100:103], a[0:3], v[136:139]
ds_read_b128 a[132:135], v5 offset:58368
v_mfma_f32_16x16x32_bf16 v[140:143], a[104:107], a[0:3], v[140:143]
ds_read_b128 a[136:139], v5 offset:59392
v_mfma_f32_16x16x32_bf16 v[156:159], a[104:107], a[4:7], v[156:159]
ds_read_b128 a[140:143], v5 offset:60416
v_mfma_f32_16x16x32_bf16 v[160:163], a[108:111], a[4:7], v[160:163]
buffer_load_dwordx4 a[44:47], v4, s[40:43], s35 offen offset:1024 sc1
v_mfma_f32_16x16x32_bf16 v[144:147], a[108:111], a[0:3], v[144:147]
s_waitcnt vmcnt(8) lgkmcnt(4)
v_mfma_f32_16x16x32_bf16 v[132:135], a[112:115], a[8:11], v[132:135]
s_cmp_eq_u32 s3, 2
s_cselect_b32 s35, 26, 18
s_lshl_b32 s35, s35, 12
v_mfma_f32_16x16x32_bf16 v[148:151], a[112:115], a[12:15], v[148:151]
ds_read_b128 a[96:99], v5 offset:61440
v_mfma_f32_16x16x32_bf16 v[152:155], a[116:119], a[12:15], v[152:155]
buffer_load_dwordx4 a[0:3], v4, s[40:43], s35 offen offset:0 sc1
v_mfma_f32_16x16x32_bf16 v[136:139], a[116:119], a[8:11], v[136:139]
ds_read_b128 a[100:103], v5 offset:62464
v_mfma_f32_16x16x32_bf16 v[140:143], a[120:123], a[8:11], v[140:143]
ds_read_b128 a[104:107], v5 offset:63488
v_mfma_f32_16x16x32_bf16 v[156:159], a[120:123], a[12:15], v[156:159]
ds_read_b128 a[108:111], v5 offset:64512
v_mfma_f32_16x16x32_bf16 v[160:163], a[124:127], a[12:15], v[160:163]
buffer_load_dwordx4 a[4:7], v4, s[40:43], s35 offen offset:1024 sc1
v_mfma_f32_16x16x32_bf16 v[144:147], a[124:127], a[8:11], v[144:147]
s_waitcnt vmcnt(8) lgkmcnt(4)
v_mfma_f32_16x16x32_bf16 v[132:135], a[128:131], a[16:19], v[132:135]
s_cmp_eq_u32 s3, 3
s_cselect_b32 s35, 27, 19
s_lshl_b32 s35, s35, 12
v_mfma_f32_16x16x32_bf16 v[148:151], a[128:131], a[20:23], v[148:151]
ds_read_b128 a[112:115], v6 offset:0
v_mfma_f32_16x16x32_bf16 v[152:155], a[132:135], a[20:23], v[152:155]
buffer_load_dwordx4 a[8:11], v4, s[40:43], s35 offen offset:0 sc1
v_mfma_f32_16x16x32_bf16 v[136:139], a[132:135], a[16:19], v[136:139]
ds_read_b128 a[116:119], v6 offset:1024
v_mfma_f32_16x16x32_bf16 v[140:143], a[136:139], a[16:19], v[140:143]
ds_read_b128 a[120:123], v6 offset:2048
v_mfma_f32_16x16x32_bf16 v[156:159], a[136:139], a[20:23], v[156:159]
ds_read_b128 a[124:127], v6 offset:3072
v_mfma_f32_16x16x32_bf16 v[160:163], a[140:143], a[20:23], v[160:163]
buffer_load_dwordx4 a[12:15], v4, s[40:43], s35 offen offset:1024 sc1
v_mfma_f32_16x16x32_bf16 v[144:147], a[140:143], a[16:19], v[144:147]
s_waitcnt vmcnt(8) lgkmcnt(4)
v_mfma_f32_16x16x32_bf16 v[132:135], a[96:99], a[24:27], v[132:135]
s_cmp_eq_u32 s3, 4
s_cselect_b32 s35, 28, 20
s_lshl_b32 s35, s35, 12
v_mfma_f32_16x16x32_bf16 v[148:151], a[96:99], a[28:31], v[148:151]
ds_read_b128 a[128:131], v6 offset:4096
v_mfma_f32_16x16x32_bf16 v[152:155], a[100:103], a[28:31], v[152:155]
buffer_load_dwordx4 a[16:19], v4, s[40:43], s35 offen offset:0 sc1
v_mfma_f32_16x16x32_bf16 v[136:139], a[100:103], a[24:27], v[136:139]
ds_read_b128 a[132:135], v6 offset:5120
v_mfma_f32_16x16x32_bf16 v[140:143], a[104:107], a[24:27], v[140:143]
ds_read_b128 a[136:139], v6 offset:6144
v_mfma_f32_16x16x32_bf16 v[156:159], a[104:107], a[28:31], v[156:159]
ds_read_b128 a[140:143], v6 offset:7168
v_mfma_f32_16x16x32_bf16 v[160:163], a[108:111], a[28:31], v[160:163]
buffer_load_dwordx4 a[20:23], v4, s[40:43], s35 offen offset:1024 sc1
v_mfma_f32_16x16x32_bf16 v[144:147], a[108:111], a[24:27], v[144:147]
s_waitcnt vmcnt(8) lgkmcnt(4)
v_mfma_f32_16x16x32_bf16 v[132:135], a[112:115], a[32:35], v[132:135]
s_cmp_eq_u32 s3, 5
s_cselect_b32 s35, 29, 21
s_lshl_b32 s35, s35, 12
v_mfma_f32_16x16x32_bf16 v[148:151], a[112:115], a[36:39], v[148:151]
ds_read_b128 a[96:99], v6 offset:8192
v_mfma_f32_16x16x32_bf16 v[152:155], a[116:119], a[36:39], v[152:155]
buffer_load_dwordx4 a[24:27], v4, s[40:43], s35 offen offset:0 sc1
v_mfma_f32_16x16x32_bf16 v[136:139], a[116:119], a[32:35], v[136:139]
ds_read_b128 a[100:103], v6 offset:9216
v_mfma_f32_16x16x32_bf16 v[140:143], a[120:123], a[32:35], v[140:143]
ds_read_b128 a[104:107], v6 offset:10240
v_mfma_f32_16x16x32_bf16 v[156:159], a[120:123], a[36:39], v[156:159]
ds_read_b128 a[108:111], v6 offset:11264
v_mfma_f32_16x16x32_bf16 v[160:163], a[124:127], a[36:39], v[160:163]
buffer_load_dwordx4 a[28:31], v4, s[40:43], s35 offen offset:1024 sc1
v_mfma_f32_16x16x32_bf16 v[144:147], a[124:127], a[32:35], v[144:147]
s_waitcnt vmcnt(8) lgkmcnt(4)
v_mfma_f32_16x16x32_bf16 v[132:135], a[128:131], a[40:43], v[132:135]
s_cmp_eq_u32 s3, 6
s_cselect_b32 s35, 30, 22
s_lshl_b32 s35, s35, 12
v_mfma_f32_16x16x32_bf16 v[148:151], a[128:131], a[44:47], v[148:151]
ds_read_b128 a[112:115], v6 offset:12288
v_mfma_f32_16x16x32_bf16 v[152:155], a[132:135], a[44:47], v[152:155]
buffer_load_dwordx4 a[32:35], v4, s[40:43], s35 offen offset:0 sc1
v_mfma_f32_16x16x32_bf16 v[136:139], a[132:135], a[40:43], v[136:139]
ds_read_b128 a[116:119], v6 offset:13312
v_mfma_f32_16x16x32_bf16 v[140:143], a[136:139], a[40:43], v[140:143]
ds_read_b128 a[120:123], v6 offset:14336
v_mfma_f32_16x16x32_bf16 v[156:159], a[136:139], a[44:47], v[156:159]
ds_read_b128 a[124:127], v6 offset:15360
v_mfma_f32_16x16x32_bf16 v[160:163], a[140:143], a[44:47], v[160:163]
buffer_load_dwordx4 a[36:39], v4, s[40:43], s35 offen offset:1024 sc1
v_mfma_f32_16x16x32_bf16 v[144:147], a[140:143], a[40:43], v[144:147]
s_waitcnt vmcnt(8) lgkmcnt(4)
v_mfma_f32_16x16x32_bf16 v[132:135], a[96:99], a[0:3], v[132:135]
s_cmp_eq_u32 s3, 7
s_cselect_b32 s35, 31, 23
s_lshl_b32 s35, s35, 12
v_mfma_f32_16x16x32_bf16 v[148:151], a[96:99], a[4:7], v[148:151]
ds_read_b128 a[128:131], v6 offset:16384
v_mfma_f32_16x16x32_bf16 v[152:155], a[100:103], a[4:7], v[152:155]
buffer_load_dwordx4 a[40:43], v4, s[40:43], s35 offen offset:0 sc1
v_mfma_f32_16x16x32_bf16 v[136:139], a[100:103], a[0:3], v[136:139]
ds_read_b128 a[132:135], v6 offset:17408
v_mfma_f32_16x16x32_bf16 v[140:143], a[104:107], a[0:3], v[140:143]
ds_read_b128 a[136:139], v6 offset:18432
v_mfma_f32_16x16x32_bf16 v[156:159], a[104:107], a[4:7], v[156:159]
ds_read_b128 a[140:143], v6 offset:19456
v_mfma_f32_16x16x32_bf16 v[160:163], a[108:111], a[4:7], v[160:163]
buffer_load_dwordx4 a[44:47], v4, s[40:43], s35 offen offset:1024 sc1
v_mfma_f32_16x16x32_bf16 v[144:147], a[108:111], a[0:3], v[144:147]
s_waitcnt vmcnt(8) lgkmcnt(4)
v_mfma_f32_16x16x32_bf16 v[132:135], a[112:115], a[8:11], v[132:135]
s_cmp_eq_u32 s3, 0
s_cselect_b32 s35, 0, 24
s_lshl_b32 s35, s35, 12
v_mfma_f32_16x16x32_bf16 v[148:151], a[112:115], a[12:15], v[148:151]
ds_read_b128 a[96:99], v6 offset:20480
v_mfma_f32_16x16x32_bf16 v[152:155], a[116:119], a[12:15], v[152:155]
buffer_load_dwordx4 a[0:3], v4, s[40:43], s35 offen offset:0 sc1
v_mfma_f32_16x16x32_bf16 v[136:139], a[116:119], a[8:11], v[136:139]
ds_read_b128 a[100:103], v6 offset:21504
v_mfma_f32_16x16x32_bf16 v[140:143], a[120:123], a[8:11], v[140:143]
ds_read_b128 a[104:107], v6 offset:22528
v_mfma_f32_16x16x32_bf16 v[156:159], a[120:123], a[12:15], v[156:159]
ds_read_b128 a[108:111], v6 offset:23552
v_mfma_f32_16x16x32_bf16 v[160:163], a[124:127], a[12:15], v[160:163]
buffer_load_dwordx4 a[4:7], v4, s[40:43], s35 offen offset:1024 sc1
v_mfma_f32_16x16x32_bf16 v[144:147], a[124:127], a[8:11], v[144:147]
s_waitcnt vmcnt(8) lgkmcnt(4)
v_mfma_f32_16x16x32_bf16 v[132:135], a[128:131], a[16:19], v[132:135]
s_cmp_eq_u32 s3, 1
s_cselect_b32 s35, 1, 25
s_lshl_b32 s35, s35, 12
v_mfma_f32_16x16x32_bf16 v[148:151], a[128:131], a[20:23], v[148:151]
ds_read_b128 a[112:115], v6 offset:24576
v_mfma_f32_16x16x32_bf16 v[152:155], a[132:135], a[20:23], v[152:155]
buffer_load_dwordx4 a[8:11], v4, s[40:43], s35 offen offset:0 sc1
v_mfma_f32_16x16x32_bf16 v[136:139], a[132:135], a[16:19], v[136:139]
ds_read_b128 a[116:119], v6 offset:25600
v_mfma_f32_16x16x32_bf16 v[140:143], a[136:139], a[16:19], v[140:143]
ds_read_b128 a[120:123], v6 offset:26624
v_mfma_f32_16x16x32_bf16 v[156:159], a[136:139], a[20:23], v[156:159]
ds_read_b128 a[124:127], v6 offset:27648
v_mfma_f32_16x16x32_bf16 v[160:163], a[140:143], a[20:23], v[160:163]
buffer_load_dwordx4 a[12:15], v4, s[40:43], s35 offen offset:1024 sc1
v_mfma_f32_16x16x32_bf16 v[144:147], a[140:143], a[16:19], v[144:147]
s_waitcnt vmcnt(8) lgkmcnt(4)
v_mfma_f32_16x16x32_bf16 v[132:135], a[96:99], a[24:27], v[132:135]
s_cmp_eq_u32 s3, 2
s_cselect_b32 s35, 2, 26
s_lshl_b32 s35, s35, 12
v_mfma_f32_16x16x32_bf16 v[148:151], a[96:99], a[28:31], v[148:151]
ds_read_b128 a[128:131], v6 offset:28672
v_mfma_f32_16x16x32_bf16 v[152:155], a[100:103], a[28:31], v[152:155]
buffer_load_dwordx4 a[16:19], v4, s[40:43], s35 offen offset:0 sc1
v_mfma_f32_16x16x32_bf16 v[136:139], a[100:103], a[24:27], v[136:139]
ds_read_b128 a[132:135], v6 offset:29696
v_mfma_f32_16x16x32_bf16 v[140:143], a[104:107], a[24:27], v[140:143]
ds_read_b128 a[136:139], v6 offset:30720
v_mfma_f32_16x16x32_bf16 v[156:159], a[104:107], a[28:31], v[156:159]
ds_read_b128 a[140:143], v6 offset:31744
v_mfma_f32_16x16x32_bf16 v[160:163], a[108:111], a[28:31], v[160:163]
buffer_load_dwordx4 a[20:23], v4, s[40:43], s35 offen offset:1024 sc1
v_mfma_f32_16x16x32_bf16 v[144:147], a[108:111], a[24:27], v[144:147]
s_waitcnt vmcnt(8) lgkmcnt(4)
v_mfma_f32_16x16x32_bf16 v[132:135], a[112:115], a[32:35], v[132:135]
s_cmp_eq_u32 s3, 3
s_cselect_b32 s35, 3, 27
s_lshl_b32 s35, s35, 12
v_mfma_f32_16x16x32_bf16 v[148:151], a[112:115], a[36:39], v[148:151]
ds_read_b128 a[96:99], v6 offset:32768
v_mfma_f32_16x16x32_bf16 v[152:155], a[116:119], a[36:39], v[152:155]
buffer_load_dwordx4 a[24:27], v4, s[40:43], s35 offen offset:0 sc1
v_mfma_f32_16x16x32_bf16 v[136:139], a[116:119], a[32:35], v[136:139]
ds_read_b128 a[100:103], v6 offset:33792
v_mfma_f32_16x16x32_bf16 v[140:143], a[120:123], a[32:35], v[140:143]
ds_read_b128 a[104:107], v6 offset:34816
v_mfma_f32_16x16x32_bf16 v[156:159], a[120:123], a[36:39], v[156:159]
ds_read_b128 a[108:111], v6 offset:35840
v_mfma_f32_16x16x32_bf16 v[160:163], a[124:127], a[36:39], v[160:163]
buffer_load_dwordx4 a[28:31], v4, s[40:43], s35 offen offset:1024 sc1
v_mfma_f32_16x16x32_bf16 v[144:147], a[124:127], a[32:35], v[144:147]
s_waitcnt vmcnt(8) lgkmcnt(4)
v_mfma_f32_16x16x32_bf16 v[132:135], a[128:131], a[40:43], v[132:135]
s_cmp_eq_u32 s3, 4
s_cselect_b32 s35, 4, 28
s_lshl_b32 s35, s35, 12
v_mfma_f32_16x16x32_bf16 v[148:151], a[128:131], a[44:47], v[148:151]
ds_read_b128 a[112:115], v6 offset:36864
v_mfma_f32_16x16x32_bf16 v[152:155], a[132:135], a[44:47], v[152:155]
buffer_load_dwordx4 a[32:35], v4, s[40:43], s35 offen offset:0 sc1
v_mfma_f32_16x16x32_bf16 v[136:139], a[132:135], a[40:43], v[136:139]
ds_read_b128 a[116:119], v6 offset:37888
v_mfma_f32_16x16x32_bf16 v[140:143], a[136:139], a[40:43], v[140:143]
ds_read_b128 a[120:123], v6 offset:38912
v_mfma_f32_16x16x32_bf16 v[156:159], a[136:139], a[44:47], v[156:159]
ds_read_b128 a[124:127], v6 offset:39936
v_mfma_f32_16x16x32_bf16 v[160:163], a[140:143], a[44:47], v[160:163]
buffer_load_dwordx4 a[36:39], v4, s[40:43], s35 offen offset:1024 sc1
v_mfma_f32_16x16x32_bf16 v[144:147], a[140:143], a[40:43], v[144:147]
s_waitcnt vmcnt(8) lgkmcnt(4)
v_mfma_f32_16x16x32_bf16 v[132:135], a[96:99], a[0:3], v[132:135]
s_cmp_eq_u32 s3, 5
s_cselect_b32 s35, 5, 29
s_lshl_b32 s35, s35, 12
v_mfma_f32_16x16x32_bf16 v[148:151], a[96:99], a[4:7], v[148:151]
ds_read_b128 a[128:131], v6 offset:40960
v_mfma_f32_16x16x32_bf16 v[152:155], a[100:103], a[4:7], v[152:155]
buffer_load_dwordx4 a[40:43], v4, s[40:43], s35 offen offset:0 sc1
v_mfma_f32_16x16x32_bf16 v[136:139], a[100:103], a[0:3], v[136:139]
ds_read_b128 a[132:135], v6 offset:41984
v_mfma_f32_16x16x32_bf16 v[140:143], a[104:107], a[0:3], v[140:143]
ds_read_b128 a[136:139], v6 offset:43008
v_mfma_f32_16x16x32_bf16 v[156:159], a[104:107], a[4:7], v[156:159]
ds_read_b128 a[140:143], v6 offset:44032
v_mfma_f32_16x16x32_bf16 v[160:163], a[108:111], a[4:7], v[160:163]
buffer_load_dwordx4 a[44:47], v4, s[40:43], s35 offen offset:1024 sc1
v_mfma_f32_16x16x32_bf16 v[144:147], a[108:111], a[0:3], v[144:147]
s_waitcnt vmcnt(8) lgkmcnt(4)
v_mfma_f32_16x16x32_bf16 v[132:135], a[112:115], a[8:11], v[132:135]
s_cmp_eq_u32 s3, 6
s_cselect_b32 s35, 6, 30
s_lshl_b32 s35, s35, 12
v_mfma_f32_16x16x32_bf16 v[148:151], a[112:115], a[12:15], v[148:151]
ds_read_b128 a[96:99], v6 offset:45056
v_mfma_f32_16x16x32_bf16 v[152:155], a[116:119], a[12:15], v[152:155]
buffer_load_dwordx4 a[0:3], v4, s[40:43], s35 offen offset:0 sc1
v_mfma_f32_16x16x32_bf16 v[136:139], a[116:119], a[8:11], v[136:139]
ds_read_b128 a[100:103], v6 offset:46080
v_mfma_f32_16x16x32_bf16 v[140:143], a[120:123], a[8:11], v[140:143]
ds_read_b128 a[104:107], v6 offset:47104
v_mfma_f32_16x16x32_bf16 v[156:159], a[120:123], a[12:15], v[156:159]
ds_read_b128 a[108:111], v6 offset:48128
v_mfma_f32_16x16x32_bf16 v[160:163], a[124:127], a[12:15], v[160:163]
buffer_load_dwordx4 a[4:7], v4, s[40:43], s35 offen offset:1024 sc1
v_mfma_f32_16x16x32_bf16 v[144:147], a[124:127], a[8:11], v[144:147]
s_waitcnt vmcnt(8) lgkmcnt(4)
v_mfma_f32_16x16x32_bf16 v[132:135], a[128:131], a[16:19], v[132:135]
s_cmp_eq_u32 s3, 7
s_cselect_b32 s35, 7, 31
s_lshl_b32 s35, s35, 12
v_mfma_f32_16x16x32_bf16 v[148:151], a[128:131], a[20:23], v[148:151]
ds_read_b128 a[112:115], v6 offset:49152
v_mfma_f32_16x16x32_bf16 v[152:155], a[132:135], a[20:23], v[152:155]
buffer_load_dwordx4 a[8:11], v4, s[40:43], s35 offen offset:0 sc1
v_mfma_f32_16x16x32_bf16 v[136:139], a[132:135], a[16:19], v[136:139]
ds_read_b128 a[116:119], v6 offset:50176
v_mfma_f32_16x16x32_bf16 v[140:143], a[136:139], a[16:19], v[140:143]
ds_read_b128 a[120:123], v6 offset:51200
v_mfma_f32_16x16x32_bf16 v[156:159], a[136:139], a[20:23], v[156:159]
ds_read_b128 a[124:127], v6 offset:52224
v_mfma_f32_16x16x32_bf16 v[160:163], a[140:143], a[20:23], v[160:163]
buffer_load_dwordx4 a[12:15], v4, s[40:43], s35 offen offset:1024 sc1
v_mfma_f32_16x16x32_bf16 v[144:147], a[140:143], a[16:19], v[144:147]
s_waitcnt vmcnt(8) lgkmcnt(4)
v_mfma_f32_16x16x32_bf16 v[132:135], a[96:99], a[24:27], v[132:135]
ds_read_b128 a[128:131], v6 offset:53248
v_mfma_f32_16x16x32_bf16 v[148:151], a[96:99], a[28:31], v[148:151]
ds_read_b128 a[132:135], v6 offset:54272
v_mfma_f32_16x16x32_bf16 v[152:155], a[100:103], a[28:31], v[152:155]
ds_read_b128 a[136:139], v6 offset:55296
v_mfma_f32_16x16x32_bf16 v[136:139], a[100:103], a[24:27], v[136:139]
ds_read_b128 a[140:143], v6 offset:56320
v_mfma_f32_16x16x32_bf16 v[140:143], a[104:107], a[24:27], v[140:143]
L_stub20:
s_cbranch_execz L_wret7
v_mfma_f32_16x16x32_bf16 v[156:159], a[104:107], a[28:31], v[156:159]
buffer_atomic_add v12, v10, s[4:7], s92 offen sc1
v_mfma_f32_16x16x32_bf16 v[160:163], a[108:111], a[28:31], v[160:163]
v_mfma_f32_16x16x32_bf16 v[144:147], a[108:111], a[24:27], v[144:147]
s_waitcnt vmcnt(7) lgkmcnt(4)
v_mfma_f32_16x16x32_bf16 v[132:135], a[112:115], a[32:35], v[132:135]
ds_read_b128 a[96:99], v6 offset:57344
v_mfma_f32_16x16x32_bf16 v[148:151], a[112:115], a[36:39], v[148:151]
ds_read_b128 a[100:103], v6 offset:58368
v_mfma_f32_16x16x32_bf16 v[152:155], a[116:119], a[36:39], v[152:155]
ds_read_b128 a[104:107], v6 offset:59392
v_mfma_f32_16x16x32_bf16 v[136:139], a[116:119], a[32:35], v[136:139]
ds_read_b128 a[108:111], v6 offset:60416
v_mfma_f32_16x16x32_bf16 v[140:143], a[120:123], a[32:35], v[140:143]
v_mfma_f32_16x16x32_bf16 v[156:159], a[120:123], a[36:39], v[156:159]
v_mfma_f32_16x16x32_bf16 v[160:163], a[124:127], a[36:39], v[160:163]
v_mfma_f32_16x16x32_bf16 v[144:147], a[124:127], a[32:35], v[144:147]
s_waitcnt vmcnt(5) lgkmcnt(4)
v_mfma_f32_16x16x32_bf16 v[132:135], a[128:131], a[40:43], v[132:135]
ds_read_b128 a[112:115], v6 offset:61440
v_mfma_f32_16x16x32_bf16 v[148:151], a[128:131], a[44:47], v[148:151]
ds_read_b128 a[116:119], v6 offset:62464
v_mfma_f32_16x16x32_bf16 v[152:155], a[132:135], a[44:47], v[152:155]
ds_read_b128 a[120:123], v6 offset:63488
v_mfma_f32_16x16x32_bf16 v[136:139], a[132:135], a[40:43], v[136:139]
ds_read_b128 a[124:127], v6 offset:64512
v_mfma_f32_16x16x32_bf16 v[140:143], a[136:139], a[40:43], v[140:143]
v_mfma_f32_16x16x32_bf16 v[156:159], a[136:139], a[44:47], v[156:159]
v_mfma_f32_16x16x32_bf16 v[160:163], a[140:143], a[44:47], v[160:163]
v_mfma_f32_16x16x32_bf16 v[144:147], a[140:143], a[40:43], v[144:147]
s_waitcnt vmcnt(3) lgkmcnt(4)
v_mfma_f32_16x16x32_bf16 v[132:135], a[96:99], a[0:3], v[132:135]
v_mfma_f32_16x16x32_bf16 v[148:151], a[96:99], a[4:7], v[148:151]
v_mfma_f32_16x16x32_bf16 v[152:155], a[100:103], a[4:7], v[152:155]
v_mfma_f32_16x16x32_bf16 v[136:139], a[100:103], a[0:3], v[136:139]
v_mfma_f32_16x16x32_bf16 v[140:143], a[104:107], a[0:3], v[140:143]
v_mfma_f32_16x16x32_bf16 v[156:159], a[104:107], a[4:7], v[156:159]
v_mfma_f32_16x16x32_bf16 v[160:163], a[108:111], a[4:7], v[160:163]
v_mfma_f32_16x16x32_bf16 v[144:147], a[108:111], a[0:3], v[144:147]
s_waitcnt vmcnt(1) lgkmcnt(0)
v_mfma_f32_16x16x32_bf16 v[132:135], a[112:115], a[8:11], v[132:135]
v_mfma_f32_16x16x32_bf16 v[148:151], a[112:115], a[12:15], v[148:151]
v_mfma_f32_16x16x32_bf16 v[152:155], a[116:119], a[12:15], v[152:155]
v_mfma_f32_16x16x32_bf16 v[136:139], a[116:119], a[8:11], v[136:139]
v_mfma_f32_16x16x32_bf16 v[140:143], a[120:123], a[8:11], v[140:143]
v_mfma_f32_16x16x32_bf16 v[156:159], a[120:123], a[12:15], v[156:159]
v_mfma_f32_16x16x32_bf16 v[160:163], a[124:127], a[12:15], v[160:163]
v_mfma_f32_16x16x32_bf16 v[144:147], a[124:127], a[8:11], v[144:147]
s_nop 1
v_cmp_u_f32 vcc, v132, v148
s_nop 0
s_and_b32 vcc_lo, vcc_lo, s95
s_cbranch_scc1 L_k2redo3
s_and_b32 s36, s31, 7
s_lshl_b32 s36, s36, 7
s_lshl_b32 s37, s28, 5
s_add_u32 s36, s36, s37
s_lshl_b32 s36, s36, 1
s_lshr_b32 s37, s31, 3
s_add_u32 s36, s36, s37
s_lshl_b32 s36, s36, 11
s_lshl_b32 s37, s32, 7
v_and_b32 v234, 15, v0
s_add_u32 s36, s36, s37
v_lshrrev_b32 v233, 4, v0
v_lshl_add_u32 v232, v234, 12, s36
v_cvt_pk_bf16_f32 v32, v132, v133
v_cvt_pk_bf16_f32 v33, v134, v135
v_cvt_pk_bf16_f32 v34, v136, v137
v_cvt_pk_bf16_f32 v35, v138, v139
v_lshl_add_u32 v232, v233, 4, v232
buffer_store_dwordx4 v[32:35], v232, s[12:15], 0 offen offset:0
v_cvt_pk_bf16_f32 v36, v140, v141
v_cvt_pk_bf16_f32 v37, v142, v143
v_cvt_pk_bf16_f32 v38, v144, v145
v_cvt_pk_bf16_f32 v39, v146, v147
v_cvt_pk_bf16_f32 v40, v148, v149
v_cvt_pk_bf16_f32 v41, v150, v151
v_cvt_pk_bf16_f32 v42, v152, v153
v_cvt_pk_bf16_f32 v43, v154, v155
s_mov_b32 s36, 0x10000
v_cvt_pk_bf16_f32 v44, v156, v157
v_cvt_pk_bf16_f32 v45, v158, v159
v_cvt_pk_bf16_f32 v46, v160, v161
buffer_store_dwordx4 v[36:39], v232, s[12:15], 0 offen offset:64
v_cvt_pk_bf16_f32 v47, v162, v163
buffer_store_dwordx4 v[40:43], v232, s[12:15], s36 offen offset:0
buffer_store_dwordx4 v[44:47], v232, s[12:15], s36 offen offset:64
s_or_b32 s36, s2, s28
s_cbranch_scc1 Lep_38
s_mov_b32 s36, 0xf0000
buffer_store_dword v15, off, s[4:7], s36 sc1
Lep_38:
L_end:
s_endpgm
Ltr_7:
s_add_u32 s52, s67, 0xe0000
s_mov_b32 s53, 0
Ltp_8:
s_sleep 4
buffer_load_dword v11, v255, s[4:7], s52 offen sc1
s_add_u32 s53, s53, 1
s_waitcnt vmcnt(0)
v_cmp_ne_u32 vcc, v11, v15
s_cbranch_vccz Lte_9
s_cmp_lt_u32 s53, 0x100000
s_cbranch_scc1 Ltp_8
s_branch Lte_9
Ltr_10:
s_add_u32 s52, s66, 0xd0040
s_mov_b32 s53, 0
Ltp_11:
s_sleep 4
buffer_load_dword v232, v255, s[4:7], s52 offen sc1
s_add_u32 s53, s53, 1
s_waitcnt vmcnt(0)
v_cmp_ne_u32 vcc, v232, v15
s_cbranch_vccz Lte_12
s_cmp_lt_u32 s53, 0x100000
s_cbranch_scc1 Ltp_11
s_branch Lte_12
L_kvredo1:
s_mov_b32 s88, 0
L_kvredo1b:
v_max_u32 v132, v48, v49
v_max3_u32 v132, v132, v50, v51
v_max3_u32 v132, v132, v52, v53
v_max3_u32 v132, v132, v54, v55
v_max3_u32 v132, v132, v56, v57
v_max3_u32 v132, v132, v58, v59
v_max3_u32 v132, v132, v60, v61
v_max3_u32 v132, v132, v62, v63
v_max3_u32 v132, v132, v64, v65
v_max3_u32 v132, v132, v66, v67
v_max3_u32 v132, v132, v68, v69
v_max3_u32 v132, v132, v70, v71
v_max3_u32 v132, v132, v100, v101
v_max3_u32 v132, v132, v102, v103
v_max3_u32 v132, v132, v104, v105
v_max3_u32 v132, v132, v106, v107
v_max3_u32 v132, v132, v124, v125
v_max3_u32 v132, v132, v126, v127
v_cmp_eq_u32 vcc, -1, v132
s_cbranch_vccz L_kvback1
s_add_u32 s88, s88, 1
s_cmp_gt_u32 s88, 0x80000
s_cbranch_scc1 L_kvback1
s_sleep 4
s_lshl_b32 s37, s30, 2
s_add_u32 s37, s37, s28
s_lshl_b32 s38, s37, 13
s_add_u32 s38, s38, 0x400000
s_add_u32 s36, s38, 4096
s_lshl_b32 s39, s37, 10
s_add_u32 s39, s39, 0x800000
v_and_b32 v248, 7, v0
v_lshlrev_b32 v248, 7, v248
v_lshrrev_b32 v249, 4, v0
v_lshl_add_u32 v248, v249, 4, v248
buffer_load_dwordx4 v[48:51], v1, s[4:7], s38 offen offset:0 sc1
buffer_load_dwordx4 v[124:127], v248, s[4:7], s39 offen sc1
buffer_load_dwordx4 v[52:55], v1, s[4:7], s38 offen offset:1024 sc1
buffer_load_dwordx4 v[56:59], v1, s[4:7], s38 offen offset:2048 sc1
buffer_load_dwordx4 v[60:63], v1, s[4:7], s38 offen offset:3072 sc1
buffer_load_dwordx4 v[64:67], v1, s[4:7], s36 offen offset:0 sc1
buffer_load_dwordx4 v[68:71], v1, s[4:7], s36 offen offset:1024 sc1
buffer_load_dwordx4 v[100:103], v1, s[4:7], s36 offen offset:2048 sc1
buffer_load_dwordx4 v[104:107], v1, s[4:7], s36 offen offset:3072 sc1
v_mov_b32 v249, 0x3f80
v_mov_b32 v250, 1.0
s_waitcnt vmcnt(8)
v_lshlrev_b32 v92, 16, v48
v_and_b32 v93, 0xffff0000, v48
v_lshlrev_b32 v94, 16, v49
v_and_b32 v95, 0xffff0000, v49
v_lshlrev_b32 v96, 16, v50
v_and_b32 v97, 0xffff0000, v50
v_lshlrev_b32 v98, 16, v51
v_and_b32 v99, 0xffff0000, v51
s_waitcnt vmcnt(7)
v_add_f32_dpp v128, v124, v124 row_ror:4 row_mask:0xf bank_mask:0xf
v_add_f32_dpp v129, v125, v125 row_ror:4 row_mask:0xf bank_mask:0xf
v_add_f32_dpp v130, v126, v126 row_ror:4 row_mask:0xf bank_mask:0xf
v_add_f32_dpp v131, v127, v127 row_ror:4 row_mask:0xf bank_mask:0xf
v_add_f32_dpp v128, v128, v128 row_ror:2 row_mask:0xf bank_mask:0xf
v_add_f32_dpp v129, v129, v129 row_ror:2 row_mask:0xf bank_mask:0xf
v_add_f32_dpp v130, v130, v130 row_ror:2 row_mask:0xf bank_mask:0xf
v_add_f32_dpp v131, v131, v131 row_ror:2 row_mask:0xf bank_mask:0xf
v_add_f32_dpp v128, v128, v128 row_ror:1 row_mask:0xf bank_mask:0xf
v_add_f32_dpp v129, v129, v129 row_ror:1 row_mask:0xf bank_mask:0xf
v_add_f32_dpp v130, v130, v130 row_ror:1 row_mask:0xf bank_mask:0xf
v_add_f32_dpp v131, v131, v131 row_ror:1 row_mask:0xf bank_mask:0xf
s_waitcnt vmcnt(6)
v_dot2c_f32_bf16 v92, v52, v249
v_dot2c_f32_bf16 v93, v52, v250
v_dot2c_f32_bf16 v94, v53, v249
v_dot2c_f32_bf16 v95, v53, v250
v_dot2c_f32_bf16 v96, v54, v249
v_dot2c_f32_bf16 v97, v54, v250
v_dot2c_f32_bf16 v98, v55, v249
v_dot2c_f32_bf16 v99, v55, v250
s_waitcnt vmcnt(5)
v_dot2c_f32_bf16 v92, v56, v249
v_dot2c_f32_bf16 v93, v56, v250
v_dot2c_f32_bf16 v94, v57, v249
v_dot2c_f32_bf16 v95, v57, v250
v_dot2c_f32_bf16 v96, v58, v249
v_dot2c_f32_bf16 v97, v58, v250
v_dot2c_f32_bf16 v98, v59, v249
v_dot2c_f32_bf16 v99, v59, v250
s_waitcnt vmcnt(4)
v_dot2c_f32_bf16 v92, v60, v249
v_dot2c_f32_bf16 v93, v60, v250
v_dot2c_f32_bf16 v94, v61, v249
v_dot2c_f32_bf16 v95, v61, v250
v_dot2c_f32_bf16 v96, v62, v249
v_dot2c_f32_bf16 v97, v62, v250
v_dot2c_f32_bf16 v98, v63, v249
v_dot2c_f32_bf16 v99, v63, v250
s_waitcnt vmcnt(3)
v_dot2c_f32_bf16 v92, v64, v249
v_dot2c_f32_bf16 v93, v64, v250
v_dot2c_f32_bf16 v94, v65, v249
v_dot2c_f32_bf16 v95, v65, v250
v_dot2c_f32_bf16 v96, v66, v249
v_dot2c_f32_bf16 v97, v66, v250
v_dot2c_f32_bf16 v98, v67, v249
v_dot2c_f32_bf16 v99, v67, v250
s_waitcnt vmcnt(2)
v_dot2c_f32_bf16 v92, v68, v249
v_dot2c_f32_bf16 v93, v68, v250
v_dot2c_f32_bf16 v94, v69, v249
v_dot2c_f32_bf16 v95, v69, v250
v_dot2c_f32_bf16 v96, v70, v249
v_dot2c_f32_bf16 v97, v70, v250
v_dot2c_f32_bf16 v98, v71, v249
v_dot2c_f32_bf16 v99, v71, v250
s_waitcnt vmcnt(1)
v_dot2c_f32_bf16 v92, v100, v249
v_dot2c_f32_bf16 v93, v100, v250
v_dot2c_f32_bf16 v94, v101, v249
v_dot2c_f32_bf16 v95, v101, v250
v_dot2c_f32_bf16 v96, v102, v249
v_dot2c_f32_bf16 v97, v102, v250
v_dot2c_f32_bf16 v98, v103, v249
v_dot2c_f32_bf16 v99, v103, v250
s_waitcnt vmcnt(0)
v_dot2c_f32_bf16 v92, v104, v249
v_dot2c_f32_bf16 v93, v104, v250
v_dot2c_f32_bf16 v94, v105, v249
v_dot2c_f32_bf16 v95, v105, v250
v_dot2c_f32_bf16 v96, v106, v249
v_dot2c_f32_bf16 v97, v106, v250
v_dot2c_f32_bf16 v98, v107, v249
v_dot2c_f32_bf16 v99, v107, v250
s_nop 2
s_branch L_kvredo1b
L_k2redo1:
s_mov_b32 s95, 0
s_mov_b32 s92, 0x40000000
s_mov_b32 s93, 0x40000000
s_mov_b32 s94, 0x40000000
s_add_u32 s36, s66, 0x10000
s_mov_b32 s37, 0
Lpoll_39:
v_mov_b32 v11, 0
buffer_atomic_add v11, v251, s[4:7], s36 offen sc0 sc1
s_add_u32 s37, s37, 1
s_waitcnt vmcnt(0)
v_readfirstlane_b32 s38, v11
s_nop 0
s_cmp_ge_u32 s38, 32
s_cbranch_scc1 Lpe_40
s_cmp_lt_u32 s37, 0x100000
s_cbranch_scc1 Lpoll_39
Lpe_40:
s_nop 7
s_cmp_eq_u32 s3, 0
s_cselect_b32 s35, 8, 0
s_lshl_b32 s35, s35, 12
v_lshlrev_b32 v132, 16, v32
v_and_b32 v133, 0xffff0000, v32
v_lshlrev_b32 v134, 16, v33
v_and_b32 v135, 0xffff0000, v33
v_lshlrev_b32 v136, 16, v34
v_and_b32 v137, 0xffff0000, v34
v_lshlrev_b32 v138, 16, v35
v_and_b32 v139, 0xffff0000, v35
v_lshlrev_b32 v140, 16, v36
v_and_b32 v141, 0xffff0000, v36
v_lshlrev_b32 v142, 16, v37
v_and_b32 v143, 0xffff0000, v37
v_lshlrev_b32 v144, 16, v38
v_and_b32 v145, 0xffff0000, v38
v_lshlrev_b32 v146, 16, v39
v_and_b32 v147, 0xffff0000, v39
v_lshlrev_b32 v148, 16, v40
v_and_b32 v149, 0xffff0000, v40
v_lshlrev_b32 v150, 16, v41
v_and_b32 v151, 0xffff0000, v41
v_lshlrev_b32 v152, 16, v42
v_and_b32 v153, 0xffff0000, v42
v_lshlrev_b32 v154, 16, v43
v_and_b32 v155, 0xffff0000, v43
v_lshlrev_b32 v156, 16, v44
v_and_b32 v157, 0xffff0000, v44
v_lshlrev_b32 v158, 16, v45
v_and_b32 v159, 0xffff0000, v45
v_lshlrev_b32 v160, 16, v46
v_and_b32 v161, 0xffff0000, v46
v_lshlrev_b32 v162, 16, v47
v_and_b32 v163, 0xffff0000, v47
s_branch L_k2go1
L_k2redo2:
s_mov_b32 s95, 0
s_mov_b32 s92, 0x40000000
s_mov_b32 s93, 0x40000000
s_mov_b32 s94, 0x40000000
s_add_u32 s36, s66, 0x20000
s_mov_b32 s37, 0
Lpoll_41:
v_mov_b32 v11, 0
buffer_atomic_add v11, v251, s[4:7], s36 offen sc0 sc1
s_add_u32 s37, s37, 1
s_waitcnt vmcnt(0)
v_readfirstlane_b32 s38, v11
s_nop 0
s_cmp_ge_u32 s38, 32
s_cbranch_scc1 Lpe_42
s_cmp_lt_u32 s37, 0x100000
s_cbranch_scc1 Lpoll_41
Lpe_42:
s_nop 7
s_cmp_eq_u32 s3, 0
s_cselect_b32 s35, 8, 0
s_lshl_b32 s35, s35, 12
v_lshlrev_b32 v132, 16, v32
v_and_b32 v133, 0xffff0000, v32
v_lshlrev_b32 v134, 16, v33
v_and_b32 v135, 0xffff0000, v33
v_lshlrev_b32 v136, 16, v34
v_and_b32 v137, 0xffff0000, v34
v_lshlrev_b32 v138, 16, v35
v_and_b32 v139, 0xffff0000, v35
v_lshlrev_b32 v140, 16, v36
v_and_b32 v141, 0xffff0000, v36
v_lshlrev_b32 v142, 16, v37
v_and_b32 v143, 0xffff0000, v37
v_lshlrev_b32 v144, 16, v38
v_and_b32 v145, 0xffff0000, v38
v_lshlrev_b32 v146, 16, v39
v_and_b32 v147, 0xffff0000, v39
v_lshlrev_b32 v148, 16, v40
v_and_b32 v149, 0xffff0000, v40
v_lshlrev_b32 v150, 16, v41
v_and_b32 v151, 0xffff0000, v41
v_lshlrev_b32 v152, 16, v42
v_and_b32 v153, 0xffff0000, v42
v_lshlrev_b32 v154, 16, v43
v_and_b32 v155, 0xffff0000, v43
v_lshlrev_b32 v156, 16, v44
v_and_b32 v157, 0xffff0000, v44
v_lshlrev_b32 v158, 16, v45
v_and_b32 v159, 0xffff0000, v45
v_lshlrev_b32 v160, 16, v46
v_and_b32 v161, 0xffff0000, v46
v_lshlrev_b32 v162, 16, v47
v_and_b32 v163, 0xffff0000, v47
s_branch L_k2go2
L_kvredo3:
s_mov_b32 s88, 0
L_kvredo3b:
v_max_u32 v132, v48, v49
v_max3_u32 v132, v132, v50, v51
v_max3_u32 v132, v132, v52, v53
v_max3_u32 v132, v132, v54, v55
v_max3_u32 v132, v132, v56, v57
v_max3_u32 v132, v132, v58, v59
v_max3_u32 v132, v132, v60, v61
v_max3_u32 v132, v132, v62, v63
v_max3_u32 v132, v132, v64, v65
v_max3_u32 v132, v132, v66, v67
v_max3_u32 v132, v132, v68, v69
v_max3_u32 v132, v132, v70, v71
v_max3_u32 v132, v132, v100, v101
v_max3_u32 v132, v132, v102, v103
v_max3_u32 v132, v132, v104, v105
v_max3_u32 v132, v132, v106, v107
v_max3_u32 v132, v132, v124, v125
v_max3_u32 v132, v132, v126, v127
v_cmp_eq_u32 vcc, -1, v132
s_cbranch_vccz L_kvback3
s_add_u32 s88, s88, 1
s_cmp_gt_u32 s88, 0x80000
s_cbranch_scc1 L_kvback3
s_sleep 4
s_lshl_b32 s37, s30, 2
s_add_u32 s37, s37, s28
s_lshl_b32 s38, s37, 13
s_add_u32 s38, s38, 0x400000
s_add_u32 s36, s38, 4096
s_lshl_b32 s39, s37, 10
s_add_u32 s39, s39, 0x820000
v_and_b32 v248, 7, v0
v_lshlrev_b32 v248, 7, v248
v_lshrrev_b32 v249, 4, v0
v_lshl_add_u32 v248, v249, 4, v248
buffer_load_dwordx4 v[48:51], v1, s[4:7], s38 offen offset:0 sc1
buffer_load_dwordx4 v[124:127], v248, s[4:7], s39 offen sc1
buffer_load_dwordx4 v[52:55], v1, s[4:7], s38 offen offset:1024 sc1
buffer_load_dwordx4 v[56:59], v1, s[4:7], s38 offen offset:2048 sc1
buffer_load_dwordx4 v[60:63], v1, s[4:7], s38 offen offset:3072 sc1
buffer_load_dwordx4 v[64:67], v1, s[4:7], s36 offen offset:0 sc1
buffer_load_dwordx4 v[68:71], v1, s[4:7], s36 offen offset:1024 sc1
buffer_load_dwordx4 v[100:103], v1, s[4:7], s36 offen offset:2048 sc1
buffer_load_dwordx4 v[104:107], v1, s[4:7], s36 offen offset:3072 sc1
v_mov_b32 v249, 0x3f80
v_mov_b32 v250, 1.0
s_waitcnt vmcnt(8)
v_lshlrev_b32 v92, 16, v48
v_and_b32 v93, 0xffff0000, v48
v_lshlrev_b32 v94, 16, v49
v_and_b32 v95, 0xffff0000, v49
v_lshlrev_b32 v96, 16, v50
v_and_b32 v97, 0xffff0000, v50
v_lshlrev_b32 v98, 16, v51
v_and_b32 v99, 0xffff0000, v51
s_waitcnt vmcnt(7)
v_add_f32_dpp v128, v124, v124 row_ror:4 row_mask:0xf bank_mask:0xf
v_add_f32_dpp v129, v125, v125 row_ror:4 row_mask:0xf bank_mask:0xf
v_add_f32_dpp v130, v126, v126 row_ror:4 row_mask:0xf bank_mask:0xf
v_add_f32_dpp v131, v127, v127 row_ror:4 row_mask:0xf bank_mask:0xf
v_add_f32_dpp v128, v128, v128 row_ror:2 row_mask:0xf bank_mask:0xf
v_add_f32_dpp v129, v129, v129 row_ror:2 row_mask:0xf bank_mask:0xf
v_add_f32_dpp v130, v130, v130 row_ror:2 row_mask:0xf bank_mask:0xf
v_add_f32_dpp v131, v131, v131 row_ror:2 row_mask:0xf bank_mask:0xf
v_add_f32_dpp v128, v128, v128 row_ror:1 row_mask:0xf bank_mask:0xf
v_add_f32_dpp v129, v129, v129 row_ror:1 row_mask:0xf bank_mask:0xf
v_add_f32_dpp v130, v130, v130 row_ror:1 row_mask:0xf bank_mask:0xf
v_add_f32_dpp v131, v131, v131 row_ror:1 row_mask:0xf bank_mask:0xf
s_waitcnt vmcnt(6)
v_dot2c_f32_bf16 v92, v52, v249
v_dot2c_f32_bf16 v93, v52, v250
v_dot2c_f32_bf16 v94, v53, v249
v_dot2c_f32_bf16 v95, v53, v250
v_dot2c_f32_bf16 v96, v54, v249
v_dot2c_f32_bf16 v97, v54, v250
v_dot2c_f32_bf16 v98, v55, v249
v_dot2c_f32_bf16 v99, v55, v250
s_waitcnt vmcnt(5)
v_dot2c_f32_bf16 v92, v56, v249
v_dot2c_f32_bf16 v93, v56, v250
v_dot2c_f32_bf16 v94, v57, v249
v_dot2c_f32_bf16 v95, v57, v250
v_dot2c_f32_bf16 v96, v58, v249
v_dot2c_f32_bf16 v97, v58, v250
v_dot2c_f32_bf16 v98, v59, v249
v_dot2c_f32_bf16 v99, v59, v250
s_waitcnt vmcnt(4)
v_dot2c_f32_bf16 v92, v60, v249
v_dot2c_f32_bf16 v93, v60, v250
v_dot2c_f32_bf16 v94, v61, v249
v_dot2c_f32_bf16 v95, v61, v250
v_dot2c_f32_bf16 v96, v62, v249
v_dot2c_f32_bf16 v97, v62, v250
v_dot2c_f32_bf16 v98, v63, v249
v_dot2c_f32_bf16 v99, v63, v250
s_waitcnt vmcnt(3)
v_dot2c_f32_bf16 v92, v64, v249
v_dot2c_f32_bf16 v93, v64, v250
v_dot2c_f32_bf16 v94, v65, v249
v_dot2c_f32_bf16 v95, v65, v250
v_dot2c_f32_bf16 v96, v66, v249
v_dot2c_f32_bf16 v97, v66, v250
v_dot2c_f32_bf16 v98, v67, v249
v_dot2c_f32_bf16 v99, v67, v250
s_waitcnt vmcnt(2)
v_dot2c_f32_bf16 v92, v68, v249
v_dot2c_f32_bf16 v93, v68, v250
v_dot2c_f32_bf16 v94, v69, v249
v_dot2c_f32_bf16 v95, v69, v250
v_dot2c_f32_bf16 v96, v70, v249
v_dot2c_f32_bf16 v97, v70, v250
v_dot2c_f32_bf16 v98, v71, v249
v_dot2c_f32_bf16 v99, v71, v250
s_waitcnt vmcnt(1)
v_dot2c_f32_bf16 v92, v100, v249
v_dot2c_f32_bf16 v93, v100, v250
v_dot2c_f32_bf16 v94, v101, v249
v_dot2c_f32_bf16 v95, v101, v250
v_dot2c_f32_bf16 v96, v102, v249
v_dot2c_f32_bf16 v97, v102, v250
v_dot2c_f32_bf16 v98, v103, v249
v_dot2c_f32_bf16 v99, v103, v250
s_waitcnt vmcnt(0)
v_dot2c_f32_bf16 v92, v104, v249
v_dot2c_f32_bf16 v93, v104, v250
v_dot2c_f32_bf16 v94, v105, v249
v_dot2c_f32_bf16 v95, v105, v250
v_dot2c_f32_bf16 v96, v106, v249
v_dot2c_f32_bf16 v97, v106, v250
v_dot2c_f32_bf16 v98, v107, v249
v_dot2c_f32_bf16 v99, v107, v250
s_nop 2
s_branch L_kvredo3b
L_k2redo3:
s_mov_b32 s95, 0
s_mov_b32 s92, 0x40000000
s_mov_b32 s93, 0x40000000
s_mov_b32 s94, 0x40000000
s_add_u32 s36, s66, 0x30000
s_mov_b32 s37, 0
Lpoll_43:
v_mov_b32 v11, 0
buffer_atomic_add v11, v251, s[4:7], s36 offen sc0 sc1
s_add_u32 s37, s37, 1
s_waitcnt vmcnt(0)
v_readfirstlane_b32 s38, v11
s_nop 0
s_cmp_ge_u32 s38, 32
s_cbranch_scc1 Lpe_44
s_cmp_lt_u32 s37, 0x100000
s_cbranch_scc1 Lpoll_43
Lpe_44:
s_nop 7
s_cmp_eq_u32 s3, 0
s_cselect_b32 s35, 8, 0
s_lshl_b32 s35, s35, 12
v_lshlrev_b32 v132, 16, v32
v_and_b32 v133, 0xffff0000, v32
v_lshlrev_b32 v134, 16, v33
v_and_b32 v135, 0xffff0000, v33
v_lshlrev_b32 v136, 16, v34
v_and_b32 v137, 0xffff0000, v34
v_lshlrev_b32 v138, 16, v35
v_and_b32 v139, 0xffff0000, v35
v_lshlrev_b32 v140, 16, v36
v_and_b32 v141, 0xffff0000, v36
v_lshlrev_b32 v142, 16, v37
v_and_b32 v143, 0xffff0000, v37
v_lshlrev_b32 v144, 16, v38
v_and_b32 v145, 0xffff0000, v38
v_lshlrev_b32 v146, 16, v39
v_and_b32 v147, 0xffff0000, v39
v_lshlrev_b32 v148, 16, v40
v_and_b32 v149, 0xffff0000, v40
v_lshlrev_b32 v150, 16, v41
v_and_b32 v151, 0xffff0000, v41
v_lshlrev_b32 v152, 16, v42
v_and_b32 v153, 0xffff0000, v42
v_lshlrev_b32 v154, 16, v43
v_and_b32 v155, 0xffff0000, v43
v_lshlrev_b32 v156, 16, v44
v_and_b32 v157, 0xffff0000, v44
v_lshlrev_b32 v158, 16, v45
v_and_b32 v159, 0xffff0000, v45
v_lshlrev_b32 v160, 16, v46
v_and_b32 v161, 0xffff0000, v46
v_lshlrev_b32 v162, 16, v47
v_and_b32 v163, 0xffff0000, v47
s_branch L_k2go3
L_code_end:
.section .rodata,"a"
.p2align 6
.amdhsa_kernel interleave_layers__sliding_local_dilated__linear_kernel_hedgehog__prompt_kernel
  .amdhsa_next_free_vgpr 512
  .amdhsa_next_free_sgpr 102
  .amdhsa_accum_offset 256
  .amdhsa_group_segment_fixed_size 0
  .amdhsa_kernarg_size 80
  .amdhsa_user_sgpr_count 2
  .amdhsa_user_sgpr_kernarg_segment_ptr 1
  .amdhsa_system_sgpr_workgroup_id_x 1
.end_amdhsa_kernel
```

```asm
; @launch grid=(256,1,1) block=(256,1,1) lds=163840
.amdgcn_target "amdgcn-amd-amdhsa--gfx950"
.text
.globl interleave_layers__sliding_local_dilated__linear_kernel_hedgehog__prompt_kernel
.p2align 8
.type interleave_layers__sliding_local_dilated__linear_kernel_hedgehog__prompt_kernel,@function
interleave_layers__sliding_local_dilated__linear_kernel_hedgehog__prompt_kernel:
s_cmp_ge_u32 s2, 256
s_cbranch_scc1 L_end
s_load_dwordx16 s[64:79], s[0:1], 0
s_load_dwordx4 s[80:83], s[0:1], 64
s_getpc_b64 s[24:25]
s_mov_b32 s26, (L_end - interleave_layers__sliding_local_dilated__linear_kernel_hedgehog__prompt_kernel - 64)
s_mov_b32 s27, 0x20000
v_lshlrev_b32 v1, 5, v0
buffer_load_dword v238, v1, s[24:27], 0 offen
v_lshrrev_b32 v1, 6, v0
v_and_b32 v0, 63, v0
v_readfirstlane_b32 s28, v1
s_and_b32 s36, s2, 7
s_lshr_b32 s37, s2, 3
s_and_b32 s38, s37, 3
s_lshr_b32 s39, s37, 2
s_and_b32 s29, s36, 1
s_lshl_b32 s32, s29, 3
s_lshl_b32 s29, s29, 2
s_add_u32 s29, s29, s38
s_add_u32 s32, s32, s39
s_lshr_b32 s36, s36, 1
s_lshl_b32 s30, s36, 3
s_add_u32 s30, s30, s39
s_lshl_b32 s31, s36, 2
s_add_u32 s31, s31, s38
s_and_b32 s32, s36, 1
s_lshl_b32 s32, s32, 3
s_add_u32 s32, s32, s39
s_and_b32 s31, s2, 1
s_lshl_b32 s31, s31, 3
s_add_u32 s31, s31, s38
s_and_b32 s3, s2, 4
s_add_u32 s31, s31, s3
s_mov_b32 s3, s39
s_and_b32 s35, s2, 7
s_lshl_b32 s35, s35, 5
s_add_u32 s35, s35, s37
s_mul_i32 s33, s39, 0
s_and_b32 s33, s33, 31
s_mul_i32 s34, s39, 0
s_and_b32 s34, s34, 31
v_lshlrev_b32 v1, 4, v0
v_lshrrev_b32 v233, 4, v0
v_and_b32 v234, 15, v0
s_and_b32 s88, s31, 7
s_lshl_b32 s88, s88, 7
s_lshl_b32 s37, s28, 5
s_add_u32 s88, s88, s37
s_lshl_b32 s88, s88, 1
s_lshr_b32 s37, s31, 3
s_add_u32 s88, s88, s37
s_lshl_b32 s88, s88, 11
s_lshl_b32 s37, s32, 7
s_add_u32 s88, s88, s37
v_lshrrev_b32 v235, 3, v0
v_and_b32 v236, 7, v0
v_xor_b32 v232, v236, v233
v_lshlrev_b32 v232, 4, v232
v_lshl_add_u32 v232, v235, 12, v232
v_xor_b32 v246, 64, v232
v_lshlrev_b32 v236, 4, v236
v_lshl_add_u32 v237, v235, 11, v236
v_mul_u32_u24 v235, 6144, v235
v_add_u32 v235, v235, v236
s_lshr_b32 s36, s35, 4
s_lshl_b32 s36, s36, 2
s_add_u32 s36, s36, s28
s_mul_i32 s36, s36, 98304
s_and_b32 s37, s35, 15
s_lshl_b32 s37, s37, 7
s_add_u32 s36, s36, s37
s_lshl_b32 s37, s28, 11
s_mov_b32 s39, 0x10000
s_mov_b32 s10, 0x400000
s_mov_b32 s11, 0x20000
s_mov_b32 s22, 0x600000
s_mov_b32 s23, 0x20000
s_mov_b32 s6, 0x10000000
s_mov_b32 s7, 0x20000
s_mov_b32 s44, 0xf0000
s_waitcnt lgkmcnt(0)
s_mov_b64 s[8:9], s[64:65]
s_mov_b64 s[20:21], s[66:67]
s_lshl_b32 s39, s37, 1
s_add_u32 m0, s37, 0
s_add_u32 s38, s36, 0
buffer_load_dwordx4 v235, s[20:23], s38 offen nt lds
s_add_u32 m0, s37, 1024
s_add_u32 s38, s36, 49152
buffer_load_dwordx4 v235, s[20:23], s38 offen nt lds
s_add_u32 m0, s37, 8192
s_add_u32 s38, s36, 2048
buffer_load_dwordx4 v235, s[20:23], s38 offen nt lds
s_add_u32 m0, s37, 9216
s_add_u32 s38, s36, 51200
buffer_load_dwordx4 v235, s[20:23], s38 offen nt lds
s_add_u32 m0, s37, 16384
s_add_u32 s38, s36, 4096
buffer_load_dwordx4 v235, s[20:23], s38 offen nt lds
s_add_u32 m0, s37, 17408
s_add_u32 s38, s36, 53248
buffer_load_dwordx4 v235, s[20:23], s38 offen nt lds
s_add_u32 m0, s39, 24576
s_add_u32 s38, s88, 0
buffer_load_dwordx4 v232, s[8:11], s38 offen nt lds
s_add_u32 m0, s39, 25600
s_add_u32 s38, s88, 32768
buffer_load_dwordx4 v246, s[8:11], s38 offen nt lds
s_add_u32 m0, s39, 26624
s_add_u32 s38, s88, 65536
buffer_load_dwordx4 v232, s[8:11], s38 offen nt lds
s_add_u32 m0, s39, 27648
s_add_u32 s38, s88, 98304
buffer_load_dwordx4 v246, s[8:11], s38 offen nt lds
s_mov_b32 s37, s39
v_lshrrev_b32 v232, 1, v234
v_xor_b32 v232, v232, v233
v_lshlrev_b32 v232, 4, v232
v_lshl_add_u32 v232, v234, 7, v232
v_add_u32 v232, s37, v232
s_add_u32 s4, s82, 0x0
s_addc_u32 s5, s83, 0
s_mov_b32 s12, s78
s_mov_b32 s13, s79
s_mov_b32 s14, 0x400000
s_mov_b32 s15, 0x20000
s_mov_b32 s42, 0x400000
s_mov_b32 s43, 0x20000
v_mov_b32 v12, 1
s_mov_b64 s[40:41], s[12:13]
s_mov_b32 s64, 0xff
s_mov_b32 s65, 0
s_and_b32 s81, s29, 3
s_lshl_b32 s66, s31, 4
s_add_u32 s66, s66, s32
s_lshl_b32 s66, s66, 8
s_lshl_b32 s67, s29, 5
s_add_u32 s67, s67, s30
s_lshl_b32 s67, s67, 8
s_lshl_b32 s80, s30, 11
s_lshl_b32 s70, s29, 8
s_add_u32 s70, s70, s80
s_lshl_b32 s71, s29, 13
s_lshr_b32 s78, s31, 1
s_lshl_b32 s78, s78, 13
s_add_u32 s79, s78, 8192
s_bitcmp1_b32 s31, 0
s_cselect_b32 s79, s79, 0x40000000
s_and_b32 s36, s31, 7
s_cmp_eq_u32 s36, 7
s_cselect_b32 s79, 0x40000000, s79
v_mov_b32 v240, 0
v_mov_b32 v241, 0
v_mov_b32 v242, 0
v_mov_b32 v243, 0
v_mov_b32 v228, v235
v_mov_b32 v229, v237
s_lshr_b32 s36, s35, 4
s_lshl_b32 s36, s36, 2
s_add_u32 s36, s36, s28
s_and_b32 s37, s35, 15
s_lshl_b32 s37, s37, 7
s_lshl_b32 s16, s36, 15
s_add_u32 s16, s16, s37
s_mul_i32 s17, s36, 98304
s_add_u32 s17, s17, s37
v_mov_b32 v16, 0x3f803f80
v_mov_b32 v17, 0x3f803f80
v_mov_b32 v18, 0x3f803f80
v_mov_b32 v19, 0x3f803f80
s_mov_b32 s46, 0xaaaaaaaa
s_mov_b32 s47, 0xaaaaaaaa
s_mov_b32 s48, 0xcccccccc
s_mov_b32 s49, 0xcccccccc
s_lshl_b32 s36, s31, 1
s_lshr_b32 s37, s28, 1
s_add_u32 s36, s36, s37
s_lshl_b32 s36, s36, 17
s_and_b32 s37, s28, 1
s_lshl_b32 s37, s37, 11
s_add_u32 s36, s36, s37
v_add_u32 v4, s36, v1
s_lshl_b32 s38, s31, 2
s_add_u32 s38, s38, s28
s_lshl_b32 s38, s38, 12
s_lshl_b32 s39, s32, 7
s_add_u32 s38, s38, s39
v_lshrrev_b32 v244, 2, v234
v_cmp_eq_u32 vcc, v244, v233
v_and_b32 v244, 7, v234
v_lshl_add_u32 v244, v244, 4, s38
v_and_b32 v245, 8, v234
v_add_u32 v244, v244, v245
v_cndmask_b32 v253, 2.0, v244, vcc
v_lshlrev_b32 v244, 4, v233
v_lshl_add_u32 v244, v234, 6, v244
v_cmp_gt_u32 vcc, 2, v234
s_nop 1
v_cndmask_b32 v254, 2.0, v244, vcc
v_lshrrev_b32 v248, 4, v0
v_lshlrev_b32 v248, 10, v248
v_bfe_u32 v249, v0, 2, 2
v_lshl_add_u32 v248, v249, 7, v248
v_and_b32 v251, 3, v0
v_lshl_add_u32 v248, v251, 3, v248
s_lshr_b32 s36, s28, 1
s_lshl_b32 s36, s36, 6
s_and_b32 s37, s28, 1
s_mul_i32 s38, s37, 8224
s_add_u32 s38, s38, s36
s_mul_i32 s39, s37, 16352
s_add_u32 s39, s39, s36
v_add_u32 v249, s39, v248
v_add_u32 v248, s38, v248
s_and_b32 s38, s35, 15
s_lshl_b32 s38, s38, 1
s_lshr_b32 s36, s28, 1
s_add_u32 s38, s38, s36
s_lshr_b32 s36, s35, 4
s_mul_i32 s96, s38, 196608
s_mul_i32 s44, s36, 12288
s_add_u32 s96, s96, s44
s_mul_i32 s44, s37, 3072
s_add_u32 s96, s96, s44
s_add_u32 s96, s96, 0xe00000
s_add_u32 s97, s96, 6144
s_mul_i32 s38, s38, 6
s_mul_i32 s37, s37, 3
s_add_u32 s38, s38, s37
s_lshl_b32 s38, s38, 11
s_lshl_b32 s36, s36, 7
s_add_u32 s38, s38, s36
s_add_u32 s98, s38, 0x300000
s_add_u32 s99, s98, 4096
v_lshrrev_b32 v247, 2, v0
v_lshlrev_b32 v250, 7, v247
v_lshl_add_u32 v250, v251, 4, v250
s_lshr_b32 s36, s28, 1
s_lshl_b32 s36, s36, 12
s_and_b32 s37, s28, 1
s_lshl_b32 s37, s37, 6
s_add_u32 s36, s36, s37
s_add_u32 s36, s36, 147456
v_add_u32 v250, s36, v250
v_subrev_u32 v230, 122880, v250
s_and_b32 s36, s35, 15
s_lshl_b32 s36, s36, 17
s_lshr_b32 s37, s35, 4
s_lshl_b32 s37, s37, 13
s_add_u32 s36, s36, s37
s_lshl_b32 s37, s28, 11
s_add_u32 s36, s36, s37
s_add_u32 s100, s36, 0xa00000
s_add_u32 s101, s36, 0xc00000
v_lshlrev_b32 v247, 6, v247
v_lshl_add_u32 v251, v251, 3, v247
v_add_u32 v251, 155648, v251
v_xor_b32 v236, 64, v232
s_mov_b64 s[20:21], s[68:69]
s_mov_b32 s22, 0x200000
s_lshl_b32 s37, s28, 11
s_add_u32 m0, s37, 147456
s_add_u32 s36, s16, 0
buffer_load_dwordx4 v229, s[20:23], s36 offen nt lds
s_add_u32 m0, s37, 148480
s_add_u32 s36, s16, 16384
buffer_load_dwordx4 v229, s[20:23], s36 offen nt lds
s_add_u32 s36, s67, 0xc0000
s_add_u32 s37, s66, 0xd0000
s_cmp_eq_u32 s28, 2
s_cselect_b32 s36, s37, s36
s_cmp_eq_u32 s28, 1
s_cselect_b32 s37, 128, 0
s_add_u32 s36, s36, s37
s_cmp_eq_u32 s28, 3
s_cselect_b32 s37, 0x20000, 0
s_add_u32 s36, s36, s37
s_mov_b64 exec, 1
buffer_atomic_add v240, off, s[4:7], s36 sc1
s_mov_b64 exec, -1
s_mov_b32 s36, 0xf0000
buffer_load_dword v11, off, s[4:7], s36 sc1
s_lshr_b32 s36, s2, 3
s_lshl_b32 s36, s36, 2
s_add_u32 s36, s36, s28
s_lshl_b32 s36, s36, 10
buffer_load_dwordx4 a[0:3], v1, s[24:27], s36 offen
s_mov_b64 s[20:21], s[74:75]
s_mov_b32 s22, 0x10000
s_and_b32 s36, s28, 1
s_lshl_b32 s36, s36, 10
s_add_u32 m0, s36, 155648
s_lshl_b32 s37, s30, 11
s_add_u32 s36, s36, s37
buffer_load_dwordx4 v1, s[20:23], s36 offen lds
s_waitcnt vmcnt(6)
ds_read_b128 v[32:35], v232 offset:24576
ds_read_b128 v[36:39], v236 offset:24576
ds_read_b128 v[40:43], v232 offset:26624
ds_read_b128 v[44:47], v236 offset:26624
s_barrier
ds_read_b64_tr_b16 a[188:189], v248 offset:0
ds_read_b64_tr_b16 a[190:191], v248 offset:512
ds_read_b64_tr_b16 a[192:193], v248 offset:4096
ds_read_b64_tr_b16 a[194:195], v248 offset:4608
ds_read_b64_tr_b16 a[196:197], v249 offset:32
ds_read_b64_tr_b16 a[198:199], v249 offset:544
ds_read_b64_tr_b16 a[200:201], v249 offset:4128
ds_read_b64_tr_b16 a[202:203], v249 offset:4640
ds_read_b64_tr_b16 a[204:205], v248 offset:8192
ds_read_b64_tr_b16 a[206:207], v248 offset:8704
ds_read_b64_tr_b16 a[208:209], v248 offset:12288
ds_read_b64_tr_b16 a[210:211], v248 offset:12800
s_lshl_b32 s36, s32, 13
s_add_u32 s36, s36, 0x0
s_add_u32 s37, s36, 4096
s_mov_b32 s38, 0x200000
s_waitcnt lgkmcnt(14)
v_mfma_f32_16x16x32_bf16 v[96:99], v[32:35], v[32:35], 0
v_mfma_f32_16x16x32_bf16 v[92:95], v[16:19], v[32:35], 0
buffer_store_dwordx4 v[32:35], v4, s[12:15], s36 offen offset:0 sc1
s_waitcnt lgkmcnt(13)
v_mfma_f32_16x16x32_bf16 v[104:107], v[40:43], v[40:43], 0
v_mfma_f32_16x16x32_bf16 v[100:103], v[16:19], v[40:43], 0
buffer_store_dwordx4 v[40:43], v4, s[12:15], s36 offen offset:1024 sc1
v_mfma_f32_16x16x32_bf16 v[96:99], v[36:39], v[36:39], v[96:99]
v_mfma_f32_16x16x32_bf16 v[92:95], v[16:19], v[36:39], v[92:95]
buffer_store_dwordx4 v[36:39], v4, s[12:15], s37 offen offset:0 sc1
s_waitcnt lgkmcnt(12)
v_mfma_f32_16x16x32_bf16 v[104:107], v[44:47], v[44:47], v[104:107]
v_mfma_f32_16x16x32_bf16 v[100:103], v[16:19], v[44:47], v[100:103]
buffer_store_dwordx4 v[44:47], v4, s[12:15], s37 offen offset:1024 sc1
s_nop 1
v_cndmask_b32 v96, v96, v97, s[46:47]
v_cndmask_b32 v98, v98, v99, s[46:47]
v_cndmask_b32 v93, v96, v98, s[48:49]
buffer_store_dwordx2 v[92:93], v253, s[4:7], s38 offen offset:0 sc1
v_cndmask_b32 v104, v104, v105, s[46:47]
v_cndmask_b32 v106, v106, v107, s[46:47]
v_cndmask_b32 v101, v104, v106, s[48:49]
buffer_store_dwordx2 v[100:101], v253, s[4:7], s38 offen offset:2048 sc1
s_waitcnt lgkmcnt(10)
v_mfma_f32_16x16x32_bf16 v[108:111], a[188:191], v[16:19], 0
s_waitcnt lgkmcnt(6)
v_mfma_f32_16x16x32_bf16 v[112:115], a[196:199], v[16:19], 0
s_waitcnt lgkmcnt(2)
v_mfma_f32_16x16x32_bf16 v[116:119], a[204:207], v[16:19], 0
v_mfma_f32_16x16x32_bf16 v[108:111], a[192:195], v[16:19], v[108:111]
v_mfma_f32_16x16x32_bf16 v[112:115], a[200:203], v[16:19], v[112:115]
s_waitcnt lgkmcnt(0)
v_mfma_f32_16x16x32_bf16 v[116:119], a[208:211], v[16:19], v[116:119]
buffer_store_dwordx4 a[188:191], v1, s[4:7], s96 offen offset:0 sc1
buffer_store_dwordx4 a[192:195], v1, s[4:7], s97 offen offset:0 sc1
buffer_store_dwordx4 a[196:199], v1, s[4:7], s96 offen offset:1024 sc1
buffer_store_dwordx4 a[200:203], v1, s[4:7], s97 offen offset:1024 sc1
buffer_store_dwordx4 a[204:207], v1, s[4:7], s96 offen offset:2048 sc1
buffer_store_dwordx4 a[208:211], v1, s[4:7], s97 offen offset:2048 sc1
buffer_store_dwordx4 v[108:111], v254, s[4:7], s98 offen offset:0 sc1
buffer_store_dwordx4 v[112:115], v254, s[4:7], s98 offen offset:2048 sc1
buffer_store_dwordx4 v[116:119], v254, s[4:7], s99 offen offset:0 sc1
v_lshlrev_b32 v239, 16, v233
v_lshl_add_u32 v239, v234, 4, v239
s_cmp_eq_u32 s28, 0
s_cselect_b32 s36, s66, s67
s_cmp_eq_u32 s28, 2
s_cselect_b32 s36, s70, s36
s_lshl_b32 s37, s28, 18
s_add_u32 s36, s36, s37
s_cmp_eq_u32 s28, 3
s_cselect_b32 s36, 0x40000000, s36
buffer_store_dwordx4 v[240:243], v239, s[4:7], s36 offen sc1
s_waitcnt vmcnt(20)
s_barrier
ds_read_b64_tr_b16 a[212:213], v250 offset:0
ds_read_b64_tr_b16 a[214:215], v250 offset:2048
ds_read_b64_tr_b16 a[216:217], v250 offset:8
ds_read_b64_tr_b16 a[218:219], v250 offset:2056
s_waitcnt lgkmcnt(2)
buffer_store_dwordx4 a[212:215], v1, s[4:7], s100 offen offset:0 sc1
s_waitcnt lgkmcnt(0)
buffer_store_dwordx4 a[216:219], v1, s[4:7], s100 offen offset:1024 sc1
s_mov_b32 s56, 0x11111111
s_mov_b32 s57, 0x11111111
s_mov_b32 s58, 0x22222222
s_mov_b32 s59, 0x22222222
s_mul_i32 s18, s28, 3072
s_lshl_b32 s19, s28, 12
s_mul_i32 s50, s30, 196608
s_add_u32 s50, s50, s18
s_lshl_b32 s36, s32, 17
s_add_u32 s36, s36, s19
s_add_u32 s37, s28, 0
s_cmp_eq_u32 s37, s3
s_cselect_b32 s37, 32768, 0
s_add_u32 s84, s36, s37
s_mul_i32 s37, s37, 3
s_sub_u32 s86, s36, s37
s_add_u32 s37, s28, 4
s_cmp_eq_u32 s37, s3
s_cselect_b32 s37, 32768, 0
s_add_u32 s85, s36, s37
s_mul_i32 s37, s37, 3
s_sub_u32 s87, s36, s37
s_mul_i32 s55, s28, 6144
v_accvgpr_write_b32 a248, -1
v_accvgpr_write_b32 a249, -1
v_accvgpr_write_b32 a250, -1
v_accvgpr_write_b32 a251, -1
s_lshl_b32 s36, s29, 2
s_add_u32 s36, s36, s28
s_lshl_b32 s37, s36, 17
v_add_u32 v2, s37, v1
s_lshl_b32 s82, s36, 13
s_and_b32 s38, s29, 3
s_cmp_eq_u32 s38, 0
s_cselect_b32 s38, 0, 0x1f400
s_cselect_b32 s39, 0, 2048
s_cselect_b32 s54, 32, 48
s_lshl_b32 s37, s29, 19
s_sub_u32 s37, s37, s38
v_add_u32 v3, s37, v1
v_cmp_le_u32 vcc, 8, v234
s_nop 1
v_cndmask_b32 v3, 2.0, v3, vcc
s_lshl_b32 s37, s29, 15
s_sub_u32 s83, s37, s39
s_cmp_eq_u32 s28, 1
s_cselect_b32 vcc_lo, -1, 0
s_mov_b32 vcc_hi, 0
v_lshlrev_b32 v244, 8, v0
v_cndmask_b32 v10, 2.0, v244, vcc
v_and_b32 v244, 1, v233
v_lshl_add_u32 v244, v244, 3, v234
v_and_b32 v244, 15, v244
v_lshrrev_b32 v245, 1, v233
v_lshl_add_u32 v244, v245, 4, v244
v_lshrrev_b32 v245, 3, v234
v_lshl_add_u32 v244, v245, 5, v244
v_lshlrev_b32 v7, 3, v244
v_lshrrev_b32 v246, 2, v0
v_and_b32 v247, 3, v0
v_and_b32 v244, 1, v247
v_lshl_add_u32 v244, v244, 3, v246
v_and_b32 v244, 15, v244
v_lshrrev_b32 v245, 1, v247
v_lshl_add_u32 v244, v245, 4, v244
v_lshrrev_b32 v245, 3, v246
v_lshl_add_u32 v244, v245, 5, v244
v_lshlrev_b32 v8, 3, v244
s_and_b32 s36, s28, 1
s_lshl_b32 s37, s36, 3
s_add_u32 s37, s37, 20480
s_lshl_b32 s36, s36, 9
v_add_u32 v244, s37, v1
v_add_u32 v245, s36, v7
s_cmp_lt_u32 s28, 2
s_cselect_b64 vcc, -1, 0
v_cndmask_b32 v9, v245, v244, vcc
v_lshlrev_b32 v239, 2, v233
v_sub_u32 v239, v239, v234
v_mov_b32 v247, 0xf149f2ca
v_add_u32 v246, 7, v239
v_cmp_gt_u32 vcc, 8, v246
v_mov_b32 v244, 0xffff
s_nop 0
v_cndmask_b32 v24, v247, 0, vcc
v_cndmask_b32 v244, 0, v244, vcc
v_mov_b32 v30, v244
v_add_u32 v246, 0, v239
v_cmp_le_i32 vcc, 9, v246
v_mov_b32 v244, 0xffff
s_nop 0
v_cndmask_b32 v20, v247, 0, vcc
v_cndmask_b32 v244, 0, v244, vcc
v_mov_b32 v28, v244
v_add_u32 v246, 8, v239
v_cmp_gt_u32 vcc, 8, v246
v_mov_b32 v244, 0xffff0000
s_nop 0
v_cndmask_b32 v25, v247, 0, vcc
v_cndmask_b32 v244, 0, v244, vcc
v_or_b32 v30, v30, v244
v_add_u32 v246, 1, v239
v_cmp_le_i32 vcc, 9, v246
v_mov_b32 v244, 0xffff0000
s_nop 0
v_cndmask_b32 v21, v247, 0, vcc
v_cndmask_b32 v244, 0, v244, vcc
v_or_b32 v28, v28, v244
v_add_u32 v246, 9, v239
v_cmp_gt_u32 vcc, 8, v246
v_mov_b32 v244, 0xffff
s_nop 0
v_cndmask_b32 v26, v247, 0, vcc
v_cndmask_b32 v244, 0, v244, vcc
v_mov_b32 v31, v244
v_add_u32 v246, 2, v239
v_cmp_le_i32 vcc, 9, v246
v_mov_b32 v244, 0xffff
s_nop 0
v_cndmask_b32 v22, v247, 0, vcc
v_cndmask_b32 v244, 0, v244, vcc
v_mov_b32 v29, v244
v_add_u32 v246, 10, v239
v_cmp_gt_u32 vcc, 8, v246
v_mov_b32 v244, 0xffff0000
s_nop 0
v_cndmask_b32 v27, v247, 0, vcc
v_cndmask_b32 v244, 0, v244, vcc
v_or_b32 v31, v31, v244
v_add_u32 v246, 3, v239
v_cmp_le_i32 vcc, 9, v246
v_mov_b32 v244, 0xffff0000
s_nop 0
v_cndmask_b32 v23, v247, 0, vcc
v_cndmask_b32 v244, 0, v244, vcc
v_or_b32 v29, v29, v244
s_and_b32 s36, s29, 3
s_or_b32 s36, s36, s28
s_cmp_eq_u32 s36, 0
s_cselect_b64 vcc, -1, 0
v_cndmask_b32 v76, v20, v247, vcc
v_cndmask_b32 v77, v21, v247, vcc
v_cndmask_b32 v78, v22, v247, vcc
v_cndmask_b32 v79, v23, v247, vcc
v_cndmask_b32 v80, v28, 0, vcc
v_cndmask_b32 v81, v29, 0, vcc
s_mov_b32 s36, 0x9e3779b1
s_waitcnt vmcnt(20)
v_mul_lo_u32 v15, v11, s36
v_add_u32 v15, 0x7f4a7c15, v15
s_and_b32 s36, s31, 1
s_lshl_b32 s36, s36, 4
s_add_u32 s36, s36, s32
s_lshl_b32 s36, s36, 2
s_add_u32 s92, s78, s36
s_add_u32 s92, s92, 0xc0000
s_lshl_b32 s36, s32, 2
s_add_u32 s93, s79, s36
s_add_u32 s93, s93, 0xc0080
s_and_b32 s94, s35, 15
s_lshl_b32 s94, s94, 9
s_lshr_b32 s36, s35, 4
s_lshl_b32 s36, s36, 2
s_add_u32 s94, s94, s36
s_add_u32 s94, s94, 0xc00c0
v_lshrrev_b32 v240, 1, v0
v_lshlrev_b32 v240, 13, v240
v_and_b32 v241, 1, v0
v_lshl_add_u32 v240, v241, 8, v240
s_mov_b32 vcc_lo, 0xffff
s_mov_b32 vcc_hi, 0
v_cndmask_b32 v240, 2.0, v240, vcc
v_lshlrev_b32 v241, 2, v0
v_add_u32 v248, 0, v248
v_add_u32 v249, 0, v249
s_add_u32 s96, s96, 0x600000
s_add_u32 s98, s98, 0x80000
s_add_u32 s97, s97, 0x600000
s_add_u32 s99, s99, 0x80000
s_cmp_eq_u32 s28, 1
s_cselect_b32 vcc_lo, 0xffff, 0
v_lshlrev_b32 v252, 12, v0
v_cndmask_b32 v252, 2.0, v252, vcc
v_cndmask_b32 v14, 2.0, v240, vcc
s_and_b32 s62, s35, 15
s_lshl_b32 s62, s62, 8
s_lshr_b32 s36, s35, 4
s_lshl_b32 s36, s36, 2
s_add_u32 s62, s62, s36
s_add_u32 s62, s62, 0xd0000
s_add_u32 s8, s94, 0x1ff40
v_and_b32 v255, 15, v0
v_lshlrev_b32 v255, 2, v255
s_waitcnt vmcnt(0)
s_barrier
s_cmp_lg_u32 s28, 1
s_cbranch_scc1 Lg1s_1
buffer_atomic_swap v15, v10, s[4:7], s92 offen sc1
buffer_atomic_swap v15, v10, s[4:7], s93 offen sc1
buffer_atomic_swap v15, v240, s[4:7], s94 offen sc1
buffer_atomic_swap v15, v252, s[4:7], s62 offen sc1
Lg1s_1:
s_branch L_aligned
.p2align 12
L_aligned:
s_mov_b64 s[20:21], s[76:77]
s_mov_b32 s22, 0x200000
s_add_u32 s89, s16, 0
buffer_load_dwordx4 a[220:223], v229, s[20:23], s89 offen nt
s_mov_b64 s[20:21], s[76:77]
s_mov_b32 s22, 0x200000
s_add_u32 s89, s16, 16384
buffer_load_dwordx4 a[224:227], v229, s[20:23], s89 offen nt
s_mov_b64 s[20:21], s[72:73]
s_mov_b32 s22, 0x600000
s_add_u32 s89, s17, 0
buffer_load_dwordx4 a[188:191], v228, s[20:23], s89 offen nt
s_mov_b64 s[20:21], s[72:73]
s_mov_b32 s22, 0x600000
s_add_u32 s89, s17, 49152
buffer_load_dwordx4 a[192:195], v228, s[20:23], s89 offen nt
s_mov_b64 s[20:21], s[72:73]
s_mov_b32 s22, 0x600000
s_add_u32 s89, s17, 2048
buffer_load_dwordx4 a[196:199], v228, s[20:23], s89 offen nt
s_mov_b64 s[20:21], s[72:73]
s_mov_b32 s22, 0x600000
s_add_u32 s89, s17, 51200
buffer_load_dwordx4 a[200:203], v228, s[20:23], s89 offen nt
s_mov_b64 s[20:21], s[72:73]
s_mov_b32 s22, 0x600000
s_add_u32 s89, s17, 4096
buffer_load_dwordx4 a[204:207], v228, s[20:23], s89 offen nt
s_mov_b64 s[20:21], s[72:73]
s_mov_b32 s22, 0x600000
s_add_u32 s89, s17, 53248
buffer_load_dwordx4 a[208:211], v228, s[20:23], s89 offen nt
s_add_u32 s89, s66, 0xd0000
ds_read_b64_tr_b16 a[240:241], v251 offset:0
ds_read_b64_tr_b16 a[242:243], v251 offset:1024
ds_read_b64_tr_b16 a[244:245], v251 offset:32
ds_read_b64_tr_b16 a[246:247], v251 offset:1056
s_lshl_b32 s36, s28, 11
v_add_u32 v231, s36, v1
s_waitcnt lgkmcnt(0)
v_add_u32 v231, 0, v231
v_cmp_eq_u32 vcc, 0, v0
s_nop 1
v_cndmask_b32 v251, 2.0, v0, vcc
s_mov_b64 exec, 0
s_cmp_eq_u32 s28, 3
s_cbranch_scc1 L_stub0
s_cmp_eq_u32 s28, 2
s_cbranch_scc1 L_stub1
s_cmp_eq_u32 s28, 1
s_cbranch_scc1 L_stub2
L_wret0:
s_mov_b64 exec, -1
s_cmp_lg_u32 s28, 0
s_cbranch_scc1 Lg1e_3
s_cmp_eq_u32 s54, 32
s_cselect_b32 s39, 0xffff0000, -1
s_mov_b32 s38, -1
s_add_u32 s36, s67, 0xc0000
s_mov_b32 s37, 0
Lg1p_2:
v_mov_b32 v11, 0
buffer_atomic_add v11, v241, s[4:7], s36 offen sc0 sc1
s_add_u32 s37, s37, 1
v_mov_b32 v242, v15
s_mov_b64 exec, 0xffff
v_mov_b32 v242, 0
buffer_atomic_add v242, v241, s[4:7], s89 offen sc0 sc1
s_mov_b64 exec, -1
s_waitcnt vmcnt(0)
v_cmp_ne_u32 vcc, v11, v15
v_cmp_ne_u32 s[52:53], v242, v15
s_and_b64 vcc, vcc, s[38:39]
s_or_b64 vcc, vcc, s[52:53]
s_cbranch_scc0 Lg1e_3
s_cmp_lt_u32 s37, 0x100000
s_cbranch_scc1 Lg1p_2
Lg1e_3:
s_barrier
s_add_u32 s94, s71, 0x80
s_add_u32 m0, s18, 0x0
s_add_u32 s44, s50, 0xe00000
buffer_load_dwordx4 v1, s[4:7], s44 offen offset:0 sc1 lds
buffer_load_dwordx4 v1, s[4:7], s44 offen offset:1024 sc1 lds
buffer_load_dwordx4 v1, s[4:7], s44 offen offset:2048 sc1 lds
s_add_u32 m0, s18, 0x3000
s_add_u32 s44, s50, 0xe03000
buffer_load_dwordx4 v1, s[4:7], s44 offen offset:0 sc1 lds
buffer_load_dwordx4 v1, s[4:7], s44 offen offset:1024 sc1 lds
buffer_load_dwordx4 v1, s[4:7], s44 offen offset:2048 sc1 lds
s_add_u32 m0, s18, 0x6000
s_add_u32 s44, s50, 0xe06000
buffer_load_dwordx4 v1, s[4:7], s44 offen offset:0 sc1 lds
buffer_load_dwordx4 v1, s[4:7], s44 offen offset:1024 sc1 lds
buffer_load_dwordx4 v1, s[4:7], s44 offen offset:2048 sc1 lds
s_add_u32 m0, s18, 0x9000
s_add_u32 s44, s50, 0xe09000
buffer_load_dwordx4 v1, s[4:7], s44 offen offset:0 sc1 lds
buffer_load_dwordx4 v1, s[4:7], s44 offen offset:1024 sc1 lds
buffer_load_dwordx4 v1, s[4:7], s44 offen offset:2048 sc1 lds
s_mov_b32 s35, 0
s_mov_b32 s33, 0x1000
buffer_load_dwordx4 a[0:3], v2, s[40:43], s35 offen offset:0 sc1
buffer_load_dwordx4 a[4:7], v2, s[40:43], s33 offen offset:0 sc1
buffer_load_dwordx4 a[8:11], v2, s[40:43], s35 offen offset:1024 sc1
buffer_load_dwordx4 a[12:15], v2, s[40:43], s33 offen offset:1024 sc1
buffer_load_dwordx4 a[16:19], v2, s[40:43], s35 offen offset:2048 sc1
buffer_load_dwordx4 a[20:23], v2, s[40:43], s33 offen offset:2048 sc1
buffer_load_dwordx4 a[24:27], v2, s[40:43], s35 offen offset:3072 sc1
buffer_load_dwordx4 a[28:31], v2, s[40:43], s33 offen offset:3072 sc1
s_add_u32 s35, s35, 8192
s_add_u32 s33, s33, 8192
s_add_u32 s63, s28, 0
s_lshl_b32 s63, s63, 12
buffer_load_dwordx4 a[160:163], v3, s[40:43], s63 offen sc1
buffer_load_dwordx4 a[32:35], v2, s[40:43], s35 offen offset:0 sc1
buffer_load_dwordx4 a[36:39], v2, s[40:43], s33 offen offset:0 sc1
buffer_load_dwordx4 a[40:43], v2, s[40:43], s35 offen offset:1024 sc1
buffer_load_dwordx4 a[44:47], v2, s[40:43], s33 offen offset:1024 sc1
buffer_load_dwordx4 a[48:51], v2, s[40:43], s35 offen offset:2048 sc1
buffer_load_dwordx4 a[52:55], v2, s[40:43], s33 offen offset:2048 sc1
buffer_load_dwordx4 a[56:59], v2, s[40:43], s35 offen offset:3072 sc1
buffer_load_dwordx4 a[60:63], v2, s[40:43], s33 offen offset:3072 sc1
s_add_u32 s35, s35, 8192
s_add_u32 s33, s33, 8192
s_waitcnt vmcnt(17)
s_barrier
v_add_u32 v5, 0, v1
v_add_u32 v6, s55, v5
ds_read_b128 a[96:99], v5 offset:2048
ds_read_b128 a[100:103], v5 offset:8192
ds_read_b128 a[104:107], v5 offset:3072
ds_read_b128 a[108:111], v5 offset:9216
ds_read_b128 a[112:115], v5 offset:4096
ds_read_b128 a[116:119], v5 offset:10240
ds_read_b128 a[120:123], v6 offset:2048
s_waitcnt vmcnt(15) lgkmcnt(5)
v_mfma_f32_16x16x32_bf16 v[140:143], a[96:99], a[0:3], 0
s_add_u32 m0, s18, 0xc000
s_add_u32 s44, s50, 0xe0c000
v_mfma_f32_16x16x32_bf16 v[140:143], a[100:103], a[4:7], v[140:143]
buffer_load_dwordx4 a[64:67], v2, s[40:43], s35 offen offset:0 sc1
s_waitcnt vmcnt(14)
v_mfma_f32_16x16x32_bf16 v[164:167], a[100:103], a[12:15], 0
ds_read_b128 a[128:131], v5 offset:5120
v_mfma_f32_16x16x32_bf16 v[164:167], a[96:99], a[8:11], v[164:167]
ds_read_b128 a[132:135], v5 offset:11264
s_waitcnt vmcnt(13)
v_mfma_f32_16x16x32_bf16 v[188:191], a[96:99], a[16:19], 0
ds_read_b128 a[136:139], v5 offset:0
s_waitcnt vmcnt(12)
v_mfma_f32_16x16x32_bf16 v[188:191], a[100:103], a[20:23], v[188:191]
buffer_load_dwordx4 v1, s[4:7], s44 offen offset:0 sc1 lds
s_add_u32 s63, s28, 4
s_waitcnt vmcnt(11)
v_mfma_f32_16x16x32_bf16 v[212:215], a[100:103], a[28:31], 0
s_lshl_b32 s63, s63, 12
ds_read_b128 a[140:143], v5 offset:6144
v_mfma_f32_16x16x32_bf16 v[212:215], a[96:99], a[24:27], v[212:215]
s_waitcnt lgkmcnt(8)
v_mfma_f32_16x16x32_bf16 v[216:219], a[104:107], a[24:27], 0
s_waitcnt lgkmcnt(7)
v_mfma_f32_16x16x32_bf16 v[216:219], a[108:111], a[28:31], v[216:219]
buffer_load_dwordx4 a[68:71], v2, s[40:43], s33 offen offset:0 sc1
v_mfma_f32_16x16x32_bf16 v[192:195], a[108:111], a[20:23], 0
ds_read_b128 a[144:147], v5 offset:1024
v_mfma_f32_16x16x32_bf16 v[192:195], a[104:107], a[16:19], v[192:195]
ds_read_b128 a[148:151], v5 offset:7168
v_mfma_f32_16x16x32_bf16 v[168:171], a[104:107], a[8:11], 0
v_mfma_f32_16x16x32_bf16 v[168:171], a[108:111], a[12:15], v[168:171]
buffer_load_dwordx4 a[72:75], v2, s[40:43], s35 offen offset:1024 sc1
v_mfma_f32_16x16x32_bf16 v[144:147], a[108:111], a[4:7], 0
ds_read_b128 a[152:155], v6 offset:3072
v_mfma_f32_16x16x32_bf16 v[144:147], a[104:107], a[0:3], v[144:147]
s_waitcnt lgkmcnt(9)
v_mfma_f32_16x16x32_bf16 v[148:151], a[112:115], a[0:3], 0
s_waitcnt lgkmcnt(8)
v_mfma_f32_16x16x32_bf16 v[148:151], a[116:119], a[4:7], v[148:151]
buffer_load_dwordx4 a[164:167], v3, s[40:43], s63 offen sc1
v_mfma_f32_16x16x32_bf16 v[172:175], a[116:119], a[12:15], 0
v_mfma_f32_16x16x32_bf16 v[172:175], a[112:115], a[8:11], v[172:175]
v_mfma_f32_16x16x32_bf16 v[196:199], a[112:115], a[16:19], 0
v_mfma_f32_16x16x32_bf16 v[196:199], a[116:119], a[20:23], v[196:199]
buffer_load_dwordx4 a[76:79], v2, s[40:43], s33 offen offset:1024 sc1
v_mfma_f32_16x16x32_bf16 v[220:223], a[116:119], a[28:31], 0
v_mfma_f32_16x16x32_bf16 v[220:223], a[112:115], a[24:27], v[220:223]
s_waitcnt vmcnt(14) lgkmcnt(7)
v_mfma_f32_16x16x32_bf16 a[172:175], a[120:123], a[160:163], 0
s_waitcnt lgkmcnt(0)
v_mfma_f32_16x16x32_bf16 v[224:227], a[128:131], a[24:27], 0
ds_read_b128 a[96:99], v5 offset:14336
v_mfma_f32_16x16x32_bf16 v[224:227], a[132:135], a[28:31], v[224:227]
buffer_load_dwordx4 a[80:83], v2, s[40:43], s35 offen offset:2048 sc1
v_mfma_f32_16x16x32_bf16 v[200:203], a[132:135], a[20:23], 0
ds_read_b128 a[100:103], v5 offset:20480
v_mfma_f32_16x16x32_bf16 v[200:203], a[128:131], a[16:19], v[200:203]
v_mfma_f32_16x16x32_bf16 v[176:179], a[128:131], a[8:11], 0
buffer_load_dwordx4 v1, s[4:7], s44 offen offset:1024 sc1 lds
v_mfma_f32_16x16x32_bf16 v[176:179], a[132:135], a[12:15], v[176:179]
ds_read_b128 a[104:107], v5 offset:15360
v_mfma_f32_16x16x32_bf16 v[152:155], a[132:135], a[4:7], 0
ds_read_b128 a[108:111], v5 offset:21504
v_mfma_f32_16x16x32_bf16 v[152:155], a[128:131], a[0:3], v[152:155]
v_mfma_f32_16x16x32_bf16 v[132:135], a[136:139], a[0:3], 0
buffer_load_dwordx4 a[84:87], v2, s[40:43], s33 offen offset:2048 sc1
v_mfma_f32_16x16x32_bf16 v[132:135], a[140:143], a[4:7], v[132:135]
ds_read_b128 a[112:115], v5 offset:16384
v_mfma_f32_16x16x32_bf16 v[156:159], a[140:143], a[12:15], 0
v_mfma_f32_16x16x32_bf16 v[156:159], a[136:139], a[8:11], v[156:159]
buffer_load_dwordx4 v1, s[4:7], s44 offen offset:2048 sc1 lds
s_add_u32 m0, s18, 0xf000
v_mfma_f32_16x16x32_bf16 v[180:183], a[136:139], a[16:19], 0
s_add_u32 s44, s50, 0xe0f000
ds_read_b128 a[116:119], v5 offset:22528
v_mfma_f32_16x16x32_bf16 v[180:183], a[140:143], a[20:23], v[180:183]
ds_read_b128 a[120:123], v6 offset:4096
v_mfma_f32_16x16x32_bf16 v[204:207], a[140:143], a[28:31], 0
v_mfma_f32_16x16x32_bf16 v[204:207], a[136:139], a[24:27], v[204:207]
buffer_load_dwordx4 a[88:91], v2, s[40:43], s35 offen offset:3072 sc1
v_mfma_f32_16x16x32_bf16 v[208:211], a[144:147], a[24:27], 0
v_mfma_f32_16x16x32_bf16 v[208:211], a[148:151], a[28:31], v[208:211]
v_mfma_f32_16x16x32_bf16 v[184:187], a[148:151], a[20:23], 0
buffer_load_dwordx4 v1, s[4:7], s44 offen offset:0 sc1 lds
v_mfma_f32_16x16x32_bf16 v[184:187], a[144:147], a[16:19], v[184:187]
v_mfma_f32_16x16x32_bf16 v[160:163], a[144:147], a[8:11], 0
v_mfma_f32_16x16x32_bf16 v[160:163], a[148:151], a[12:15], v[160:163]
v_mfma_f32_16x16x32_bf16 v[136:139], a[148:151], a[4:7], 0
buffer_load_dwordx4 a[92:95], v2, s[40:43], s33 offen offset:3072 sc1
s_add_u32 s35, s35, 8192
v_mfma_f32_16x16x32_bf16 v[136:139], a[144:147], a[0:3], v[136:139]
s_add_u32 s33, s33, 8192
v_mfma_f32_16x16x32_bf16 a[176:179], a[152:155], a[160:163], 0
s_waitcnt vmcnt(13) lgkmcnt(0)
v_mfma_f32_16x16x32_bf16 v[140:143], a[96:99], a[32:35], v[140:143]
ds_read_b128 a[128:131], v5 offset:17408
v_mfma_f32_16x16x32_bf16 v[140:143], a[100:103], a[36:39], v[140:143]
buffer_load_dwordx4 a[0:3], v2, s[40:43], s35 offen offset:0 sc1
v_mfma_f32_16x16x32_bf16 v[164:167], a[100:103], a[44:47], v[164:167]
ds_read_b128 a[132:135], v5 offset:23552
v_mfma_f32_16x16x32_bf16 v[164:167], a[96:99], a[40:43], v[164:167]
v_mfma_f32_16x16x32_bf16 v[188:191], a[96:99], a[48:51], v[188:191]
ds_read_b128 a[136:139], v5 offset:12288
v_mfma_f32_16x16x32_bf16 v[188:191], a[100:103], a[52:55], v[188:191]
buffer_load_dwordx4 v1, s[4:7], s44 offen offset:1024 sc1 lds
v_mfma_f32_16x16x32_bf16 v[212:215], a[100:103], a[60:63], v[212:215]
ds_read_b128 a[140:143], v5 offset:18432
v_mfma_f32_16x16x32_bf16 v[212:215], a[96:99], a[56:59], v[212:215]
v_mfma_f32_16x16x32_bf16 v[216:219], a[104:107], a[56:59], v[216:219]
v_mfma_f32_16x16x32_bf16 v[216:219], a[108:111], a[60:63], v[216:219]
buffer_load_dwordx4 a[4:7], v2, s[40:43], s33 offen offset:0 sc1
v_mfma_f32_16x16x32_bf16 v[192:195], a[108:111], a[52:55], v[192:195]
ds_read_b128 a[144:147], v5 offset:13312
v_mfma_f32_16x16x32_bf16 v[192:195], a[104:107], a[48:51], v[192:195]
ds_read_b128 a[148:151], v5 offset:19456
v_mfma_f32_16x16x32_bf16 v[168:171], a[104:107], a[40:43], v[168:171]
v_mfma_f32_16x16x32_bf16 v[168:171], a[108:111], a[44:47], v[168:171]
buffer_load_dwordx4 a[8:11], v2, s[40:43], s35 offen offset:1024 sc1
v_mfma_f32_16x16x32_bf16 v[144:147], a[108:111], a[36:39], v[144:147]
ds_read_b128 a[152:155], v6 offset:5120
v_mfma_f32_16x16x32_bf16 v[144:147], a[104:107], a[32:35], v[144:147]
v_mfma_f32_16x16x32_bf16 v[148:151], a[112:115], a[32:35], v[148:151]
v_mfma_f32_16x16x32_bf16 v[148:151], a[116:119], a[36:39], v[148:151]
buffer_load_dwordx4 v1, s[4:7], s44 offen offset:2048 sc1 lds
s_add_u32 m0, s18, 0x12000
v_mfma_f32_16x16x32_bf16 v[172:175], a[116:119], a[44:47], v[172:175]
s_add_u32 s44, s50, 0xe12000
v_mfma_f32_16x16x32_bf16 v[172:175], a[112:115], a[40:43], v[172:175]
v_mfma_f32_16x16x32_bf16 v[196:199], a[112:115], a[48:51], v[196:199]
v_mfma_f32_16x16x32_bf16 v[196:199], a[116:119], a[52:55], v[196:199]
buffer_load_dwordx4 a[12:15], v2, s[40:43], s33 offen offset:1024 sc1
v_mfma_f32_16x16x32_bf16 v[220:223], a[116:119], a[60:63], v[220:223]
v_mfma_f32_16x16x32_bf16 v[220:223], a[112:115], a[56:59], v[220:223]
v_mfma_f32_16x16x32_bf16 a[180:183], a[120:123], a[160:163], 0
s_waitcnt lgkmcnt(0)
v_mfma_f32_16x16x32_bf16 v[224:227], a[128:131], a[56:59], v[224:227]
ds_read_b128 a[96:99], v5 offset:26624
v_mfma_f32_16x16x32_bf16 v[224:227], a[132:135], a[60:63], v[224:227]
buffer_load_dwordx4 a[16:19], v2, s[40:43], s35 offen offset:2048 sc1
v_mfma_f32_16x16x32_bf16 v[200:203], a[132:135], a[52:55], v[200:203]
ds_read_b128 a[100:103], v5 offset:32768
v_mfma_f32_16x16x32_bf16 v[200:203], a[128:131], a[48:51], v[200:203]
v_mfma_f32_16x16x32_bf16 v[176:179], a[128:131], a[40:43], v[176:179]
buffer_load_dwordx4 v1, s[4:7], s44 offen offset:0 sc1 lds
v_mfma_f32_16x16x32_bf16 v[176:179], a[132:135], a[44:47], v[176:179]
ds_read_b128 a[104:107], v5 offset:27648
v_mfma_f32_16x16x32_bf16 v[152:155], a[132:135], a[36:39], v[152:155]
ds_read_b128 a[108:111], v5 offset:33792
v_mfma_f32_16x16x32_bf16 v[152:155], a[128:131], a[32:35], v[152:155]
v_mfma_f32_16x16x32_bf16 v[132:135], a[136:139], a[32:35], v[132:135]
buffer_load_dwordx4 a[20:23], v2, s[40:43], s33 offen offset:2048 sc1
v_mfma_f32_16x16x32_bf16 v[132:135], a[140:143], a[36:39], v[132:135]
ds_read_b128 a[112:115], v5 offset:28672
v_mfma_f32_16x16x32_bf16 v[156:159], a[140:143], a[44:47], v[156:159]
v_mfma_f32_16x16x32_bf16 v[156:159], a[136:139], a[40:43], v[156:159]
buffer_load_dwordx4 v1, s[4:7], s44 offen offset:1024 sc1 lds
v_mfma_f32_16x16x32_bf16 v[180:183], a[136:139], a[48:51], v[180:183]
ds_read_b128 a[116:119], v5 offset:34816
v_mfma_f32_16x16x32_bf16 v[180:183], a[140:143], a[52:55], v[180:183]
ds_read_b128 a[120:123], v6 offset:26624
v_mfma_f32_16x16x32_bf16 v[204:207], a[140:143], a[60:63], v[204:207]
v_mfma_f32_16x16x32_bf16 v[204:207], a[136:139], a[56:59], v[204:207]
buffer_load_dwordx4 a[24:27], v2, s[40:43], s35 offen offset:3072 sc1
v_mfma_f32_16x16x32_bf16 v[208:211], a[144:147], a[56:59], v[208:211]
v_mfma_f32_16x16x32_bf16 v[208:211], a[148:151], a[60:63], v[208:211]
v_mfma_f32_16x16x32_bf16 v[184:187], a[148:151], a[52:55], v[184:187]
buffer_load_dwordx4 v1, s[4:7], s44 offen offset:2048 sc1 lds
s_add_u32 m0, s18, 0x15000
v_mfma_f32_16x16x32_bf16 v[184:187], a[144:147], a[48:51], v[184:187]
s_add_u32 s44, s50, 0xe15000
v_mfma_f32_16x16x32_bf16 v[160:163], a[144:147], a[40:43], v[160:163]
v_mfma_f32_16x16x32_bf16 v[160:163], a[148:151], a[44:47], v[160:163]
v_mfma_f32_16x16x32_bf16 v[136:139], a[148:151], a[36:39], v[136:139]
buffer_load_dwordx4 a[28:31], v2, s[40:43], s33 offen offset:3072 sc1
s_add_u32 s35, s35, 8192
v_mfma_f32_16x16x32_bf16 v[136:139], a[144:147], a[32:35], v[136:139]
s_add_u32 s33, s33, 8192
v_mfma_f32_16x16x32_bf16 a[184:187], a[152:155], a[160:163], 0
s_waitcnt vmcnt(13) lgkmcnt(0)
v_mfma_f32_16x16x32_bf16 v[140:143], a[96:99], a[64:67], v[140:143]
ds_read_b128 a[128:131], v5 offset:29696
v_mfma_f32_16x16x32_bf16 v[140:143], a[100:103], a[68:71], v[140:143]
buffer_load_dwordx4 a[32:35], v2, s[40:43], s35 offen offset:0 sc1
v_mfma_f32_16x16x32_bf16 v[164:167], a[100:103], a[76:79], v[164:167]
ds_read_b128 a[132:135], v5 offset:35840
v_mfma_f32_16x16x32_bf16 v[164:167], a[96:99], a[72:75], v[164:167]
v_mfma_f32_16x16x32_bf16 v[188:191], a[96:99], a[80:83], v[188:191]
ds_read_b128 a[136:139], v5 offset:24576
v_mfma_f32_16x16x32_bf16 v[188:191], a[100:103], a[84:87], v[188:191]
buffer_load_dwordx4 v1, s[4:7], s44 offen offset:0 sc1 lds
s_add_u32 s63, s28, 8
v_mfma_f32_16x16x32_bf16 v[212:215], a[100:103], a[92:95], v[212:215]
s_lshl_b32 s63, s63, 12
ds_read_b128 a[140:143], v5 offset:30720
v_mfma_f32_16x16x32_bf16 v[212:215], a[96:99], a[88:91], v[212:215]
v_mfma_f32_16x16x32_bf16 v[216:219], a[104:107], a[88:91], v[216:219]
v_mfma_f32_16x16x32_bf16 v[216:219], a[108:111], a[92:95], v[216:219]
buffer_load_dwordx4 a[36:39], v2, s[40:43], s33 offen offset:0 sc1
v_mfma_f32_16x16x32_bf16 v[192:195], a[108:111], a[84:87], v[192:195]
ds_read_b128 a[144:147], v5 offset:25600
v_mfma_f32_16x16x32_bf16 v[192:195], a[104:107], a[80:83], v[192:195]
ds_read_b128 a[148:151], v5 offset:31744
v_mfma_f32_16x16x32_bf16 v[168:171], a[104:107], a[72:75], v[168:171]
v_mfma_f32_16x16x32_bf16 v[168:171], a[108:111], a[76:79], v[168:171]
buffer_load_dwordx4 a[40:43], v2, s[40:43], s35 offen offset:1024 sc1
v_mfma_f32_16x16x32_bf16 v[144:147], a[108:111], a[68:71], v[144:147]
ds_read_b128 a[152:155], v6 offset:27648
v_mfma_f32_16x16x32_bf16 v[144:147], a[104:107], a[64:67], v[144:147]
v_mfma_f32_16x16x32_bf16 v[148:151], a[112:115], a[64:67], v[148:151]
v_mfma_f32_16x16x32_bf16 v[148:151], a[116:119], a[68:71], v[148:151]
buffer_load_dwordx4 a[168:171], v3, s[40:43], s63 offen sc1
v_mfma_f32_16x16x32_bf16 v[172:175], a[116:119], a[76:79], v[172:175]
v_mfma_f32_16x16x32_bf16 v[172:175], a[112:115], a[72:75], v[172:175]
v_mfma_f32_16x16x32_bf16 v[196:199], a[112:115], a[80:83], v[196:199]
v_mfma_f32_16x16x32_bf16 v[196:199], a[116:119], a[84:87], v[196:199]
buffer_load_dwordx4 a[44:47], v2, s[40:43], s33 offen offset:1024 sc1
v_mfma_f32_16x16x32_bf16 v[220:223], a[116:119], a[92:95], v[220:223]
v_mfma_f32_16x16x32_bf16 v[220:223], a[112:115], a[88:91], v[220:223]
v_mfma_f32_16x16x32_bf16 a[172:175], a[120:123], a[164:167], a[172:175]
s_waitcnt lgkmcnt(0)
v_mfma_f32_16x16x32_bf16 v[224:227], a[128:131], a[88:91], v[224:227]
ds_read_b128 a[96:99], v5 offset:38912
v_mfma_f32_16x16x32_bf16 v[224:227], a[132:135], a[92:95], v[224:227]
buffer_load_dwordx4 a[48:51], v2, s[40:43], s35 offen offset:2048 sc1
v_mfma_f32_16x16x32_bf16 v[200:203], a[132:135], a[84:87], v[200:203]
ds_read_b128 a[100:103], v5 offset:45056
v_mfma_f32_16x16x32_bf16 v[200:203], a[128:131], a[80:83], v[200:203]
v_mfma_f32_16x16x32_bf16 v[176:179], a[128:131], a[72:75], v[176:179]
buffer_load_dwordx4 v1, s[4:7], s44 offen offset:1024 sc1 lds
v_mfma_f32_16x16x32_bf16 v[176:179], a[132:135], a[76:79], v[176:179]
ds_read_b128 a[104:107], v5 offset:39936
v_mfma_f32_16x16x32_bf16 v[152:155], a[132:135], a[68:71], v[152:155]
ds_read_b128 a[108:111], v5 offset:46080
v_mfma_f32_16x16x32_bf16 v[152:155], a[128:131], a[64:67], v[152:155]
v_mfma_f32_16x16x32_bf16 v[132:135], a[136:139], a[64:67], v[132:135]
buffer_load_dwordx4 a[52:55], v2, s[40:43], s33 offen offset:2048 sc1
v_mfma_f32_16x16x32_bf16 v[132:135], a[140:143], a[68:71], v[132:135]
ds_read_b128 a[112:115], v5 offset:40960
v_mfma_f32_16x16x32_bf16 v[156:159], a[140:143], a[76:79], v[156:159]
v_mfma_f32_16x16x32_bf16 v[156:159], a[136:139], a[72:75], v[156:159]
buffer_load_dwordx4 v1, s[4:7], s44 offen offset:2048 sc1 lds
v_mfma_f32_16x16x32_bf16 v[180:183], a[136:139], a[80:83], v[180:183]
v_and_b32 v232, 15, v0
v_lshlrev_b32 v232, 7, v232
v_mfma_f32_16x16x32_bf16 v[180:183], a[140:143], a[84:87], v[180:183]
v_lshrrev_b32 v233, 4, v0
v_lshlrev_b32 v233, 4, v233
v_mfma_f32_16x16x32_bf16 v[204:207], a[140:143], a[92:95], v[204:207]
v_add_u32 v232, v233, v232
s_mul_i32 s38, s30, 12288
v_mfma_f32_16x16x32_bf16 v[204:207], a[136:139], a[88:91], v[204:207]
buffer_load_dwordx4 a[56:59], v2, s[40:43], s35 offen offset:3072 sc1
s_add_u32 s38, s38, 0x300000
v_mfma_f32_16x16x32_bf16 v[208:211], a[144:147], a[88:91], v[208:211]
s_add_u32 s39, s28, 4
s_min_u32 s39, s39, 5
s_lshl_b32 s36, s28, 11
v_mfma_f32_16x16x32_bf16 v[208:211], a[148:151], a[92:95], v[208:211]
s_add_u32 s36, s36, s38
s_lshl_b32 s37, s39, 11
s_add_u32 s37, s37, s38
v_mfma_f32_16x16x32_bf16 v[184:187], a[148:151], a[84:87], v[184:187]
buffer_load_dwordx4 v[48:51], v232, s[4:7], s36 offen sc1
v_mfma_f32_16x16x32_bf16 v[184:187], a[144:147], a[80:83], v[184:187]
ds_read_b128 a[116:119], v5 offset:47104
v_mfma_f32_16x16x32_bf16 v[160:163], a[144:147], a[72:75], v[160:163]
ds_read_b128 a[120:123], v6 offset:28672
v_mfma_f32_16x16x32_bf16 v[160:163], a[148:151], a[76:79], v[160:163]
v_mfma_f32_16x16x32_bf16 v[136:139], a[148:151], a[68:71], v[136:139]
buffer_load_dwordx4 a[60:63], v2, s[40:43], s33 offen offset:3072 sc1
s_add_u32 s35, s35, 8192
v_mfma_f32_16x16x32_bf16 v[136:139], a[144:147], a[64:67], v[136:139]
s_add_u32 s33, s33, 8192
v_mfma_f32_16x16x32_bf16 a[176:179], a[152:155], a[164:167], a[176:179]
s_waitcnt vmcnt(13) lgkmcnt(0)
v_mfma_f32_16x16x32_bf16 v[140:143], a[96:99], a[0:3], v[140:143]
ds_read_b128 a[128:131], v5 offset:41984
v_mfma_f32_16x16x32_bf16 v[140:143], a[100:103], a[4:7], v[140:143]
buffer_load_dwordx4 a[64:67], v2, s[40:43], s35 offen offset:0 sc1
v_mfma_f32_16x16x32_bf16 v[164:167], a[100:103], a[12:15], v[164:167]
ds_read_b128 a[132:135], v5 offset:48128
v_mfma_f32_16x16x32_bf16 v[164:167], a[96:99], a[8:11], v[164:167]
v_mfma_f32_16x16x32_bf16 v[188:191], a[96:99], a[16:19], v[188:191]
ds_read_b128 a[136:139], v5 offset:36864
v_mfma_f32_16x16x32_bf16 v[188:191], a[100:103], a[20:23], v[188:191]
buffer_load_dwordx4 v[52:55], v232, s[4:7], s37 offen sc1
s_add_u32 m0, s18, 0x18000
v_mfma_f32_16x16x32_bf16 v[212:215], a[100:103], a[28:31], v[212:215]
s_add_u32 s44, s50, 0xe18000
ds_read_b128 a[140:143], v5 offset:43008
v_mfma_f32_16x16x32_bf16 v[212:215], a[96:99], a[24:27], v[212:215]
v_mfma_f32_16x16x32_bf16 v[216:219], a[104:107], a[24:27], v[216:219]
v_mfma_f32_16x16x32_bf16 v[216:219], a[108:111], a[28:31], v[216:219]
buffer_load_dwordx4 a[68:71], v2, s[40:43], s33 offen offset:0 sc1
v_mfma_f32_16x16x32_bf16 v[192:195], a[108:111], a[20:23], v[192:195]
ds_read_b128 a[144:147], v5 offset:37888
v_mfma_f32_16x16x32_bf16 v[192:195], a[104:107], a[16:19], v[192:195]
ds_read_b128 a[148:151], v5 offset:44032
v_mfma_f32_16x16x32_bf16 v[168:171], a[104:107], a[8:11], v[168:171]
v_mfma_f32_16x16x32_bf16 v[168:171], a[108:111], a[12:15], v[168:171]
buffer_load_dwordx4 a[72:75], v2, s[40:43], s35 offen offset:1024 sc1
v_mfma_f32_16x16x32_bf16 v[144:147], a[108:111], a[4:7], v[144:147]
ds_read_b128 a[152:155], v6 offset:29696
v_mfma_f32_16x16x32_bf16 v[144:147], a[104:107], a[0:3], v[144:147]
v_mfma_f32_16x16x32_bf16 v[148:151], a[112:115], a[0:3], v[148:151]
v_mfma_f32_16x16x32_bf16 v[148:151], a[116:119], a[4:7], v[148:151]
buffer_load_dwordx4 v1, s[4:7], s44 offen offset:0 sc1 lds
v_mfma_f32_16x16x32_bf16 v[172:175], a[116:119], a[12:15], v[172:175]
v_mfma_f32_16x16x32_bf16 v[172:175], a[112:115], a[8:11], v[172:175]
v_mfma_f32_16x16x32_bf16 v[196:199], a[112:115], a[16:19], v[196:199]
v_mfma_f32_16x16x32_bf16 v[196:199], a[116:119], a[20:23], v[196:199]
buffer_load_dwordx4 a[76:79], v2, s[40:43], s33 offen offset:1024 sc1
v_mfma_f32_16x16x32_bf16 v[220:223], a[116:119], a[28:31], v[220:223]
v_mfma_f32_16x16x32_bf16 v[220:223], a[112:115], a[24:27], v[220:223]
v_mfma_f32_16x16x32_bf16 a[180:183], a[120:123], a[164:167], a[180:183]
s_waitcnt lgkmcnt(0)
s_barrier
v_mfma_f32_16x16x32_bf16 v[224:227], a[128:131], a[24:27], v[224:227]
v_add_u32 v5, 49152, v1
v_add_u32 v6, s55, v5
v_mfma_f32_16x16x32_bf16 v[224:227], a[132:135], a[28:31], v[224:227]
buffer_load_dwordx4 a[80:83], v2, s[40:43], s35 offen offset:2048 sc1
v_mfma_f32_16x16x32_bf16 v[200:203], a[132:135], a[20:23], v[200:203]
ds_read_b128 a[96:99], v5 offset:2048
v_mfma_f32_16x16x32_bf16 v[200:203], a[128:131], a[16:19], v[200:203]
ds_read_b128 a[100:103], v5 offset:8192
v_mfma_f32_16x16x32_bf16 v[176:179], a[128:131], a[8:11], v[176:179]
buffer_load_dwordx4 v1, s[4:7], s44 offen offset:1024 sc1 lds
v_mfma_f32_16x16x32_bf16 v[176:179], a[132:135], a[12:15], v[176:179]
ds_read_b128 a[104:107], v5 offset:3072
v_mfma_f32_16x16x32_bf16 v[152:155], a[132:135], a[4:7], v[152:155]
ds_read_b128 a[108:111], v5 offset:9216
v_mfma_f32_16x16x32_bf16 v[152:155], a[128:131], a[0:3], v[152:155]
ds_write_b128 v231, a[220:223] offset:24576
v_mfma_f32_16x16x32_bf16 v[132:135], a[136:139], a[0:3], v[132:135]
buffer_load_dwordx4 a[84:87], v2, s[40:43], s33 offen offset:2048 sc1
v_mfma_f32_16x16x32_bf16 v[132:135], a[140:143], a[4:7], v[132:135]
ds_read_b128 a[112:115], v5 offset:4096
v_mfma_f32_16x16x32_bf16 v[156:159], a[140:143], a[12:15], v[156:159]
v_mfma_f32_16x16x32_bf16 v[156:159], a[136:139], a[8:11], v[156:159]
buffer_load_dwordx4 v1, s[4:7], s44 offen offset:2048 sc1 lds
s_add_u32 m0, s18, 0x1b000
v_mfma_f32_16x16x32_bf16 v[180:183], a[136:139], a[16:19], v[180:183]
s_add_u32 s44, s50, 0xe1b000
ds_read_b128 a[116:119], v5 offset:10240
v_mfma_f32_16x16x32_bf16 v[180:183], a[140:143], a[20:23], v[180:183]
ds_read_b128 a[120:123], v6 offset:2048
v_mfma_f32_16x16x32_bf16 v[204:207], a[140:143], a[28:31], v[204:207]
ds_write_b128 v231, a[224:227] offset:25600
v_mfma_f32_16x16x32_bf16 v[204:207], a[136:139], a[24:27], v[204:207]
buffer_load_dwordx4 a[88:91], v2, s[40:43], s35 offen offset:3072 sc1
v_mfma_f32_16x16x32_bf16 v[208:211], a[144:147], a[24:27], v[208:211]
v_mfma_f32_16x16x32_bf16 v[208:211], a[148:151], a[28:31], v[208:211]
v_mfma_f32_16x16x32_bf16 v[184:187], a[148:151], a[20:23], v[184:187]
buffer_load_dwordx4 v1, s[4:7], s44 offen offset:0 sc1 lds
v_mfma_f32_16x16x32_bf16 v[184:187], a[144:147], a[16:19], v[184:187]
v_mfma_f32_16x16x32_bf16 v[160:163], a[144:147], a[8:11], v[160:163]
v_mfma_f32_16x16x32_bf16 v[160:163], a[148:151], a[12:15], v[160:163]
v_mfma_f32_16x16x32_bf16 v[136:139], a[148:151], a[4:7], v[136:139]
buffer_load_dwordx4 a[92:95], v2, s[40:43], s33 offen offset:3072 sc1
s_add_u32 s35, s35, 8192
v_mfma_f32_16x16x32_bf16 v[136:139], a[144:147], a[0:3], v[136:139]
s_add_u32 s33, s33, 8192
ds_write_b128 v231, a[188:191] offset:0
v_mfma_f32_16x16x32_bf16 a[184:187], a[152:155], a[164:167], a[184:187]
s_waitcnt vmcnt(13) lgkmcnt(2)
v_mfma_f32_16x16x32_bf16 v[140:143], a[96:99], a[32:35], v[140:143]
ds_read_b128 a[128:131], v5 offset:5120
v_mfma_f32_16x16x32_bf16 v[140:143], a[100:103], a[36:39], v[140:143]
buffer_load_dwordx4 a[0:3], v2, s[40:43], s35 offen offset:0 sc1
v_mfma_f32_16x16x32_bf16 v[164:167], a[100:103], a[44:47], v[164:167]
ds_read_b128 a[132:135], v5 offset:11264
v_mfma_f32_16x16x32_bf16 v[164:167], a[96:99], a[40:43], v[164:167]
v_mfma_f32_16x16x32_bf16 v[188:191], a[96:99], a[48:51], v[188:191]
ds_read_b128 a[136:139], v5 offset:0
v_mfma_f32_16x16x32_bf16 v[188:191], a[100:103], a[52:55], v[188:191]
buffer_load_dwordx4 v1, s[4:7], s44 offen offset:1024 sc1 lds
s_add_u32 s63, s28, 12
v_mfma_f32_16x16x32_bf16 v[212:215], a[100:103], a[60:63], v[212:215]
s_lshl_b32 s63, s63, 12
ds_read_b128 a[140:143], v5 offset:6144
v_mfma_f32_16x16x32_bf16 v[212:215], a[96:99], a[56:59], v[212:215]
v_mfma_f32_16x16x32_bf16 v[216:219], a[104:107], a[56:59], v[216:219]
ds_write_b128 v231, a[192:195] offset:1024
v_mfma_f32_16x16x32_bf16 v[216:219], a[108:111], a[60:63], v[216:219]
buffer_load_dwordx4 a[4:7], v2, s[40:43], s33 offen offset:0 sc1
v_mfma_f32_16x16x32_bf16 v[192:195], a[108:111], a[52:55], v[192:195]
ds_read_b128 a[144:147], v5 offset:1024
v_mfma_f32_16x16x32_bf16 v[192:195], a[104:107], a[48:51], v[192:195]
ds_read_b128 a[148:151], v5 offset:7168
v_mfma_f32_16x16x32_bf16 v[168:171], a[104:107], a[40:43], v[168:171]
v_mfma_f32_16x16x32_bf16 v[168:171], a[108:111], a[44:47], v[168:171]
buffer_load_dwordx4 a[8:11], v2, s[40:43], s35 offen offset:1024 sc1
v_mfma_f32_16x16x32_bf16 v[144:147], a[108:111], a[36:39], v[144:147]
ds_read_b128 a[152:155], v6 offset:3072
v_mfma_f32_16x16x32_bf16 v[144:147], a[104:107], a[32:35], v[144:147]
v_mfma_f32_16x16x32_bf16 v[148:151], a[112:115], a[32:35], v[148:151]
v_mfma_f32_16x16x32_bf16 v[148:151], a[116:119], a[36:39], v[148:151]
buffer_load_dwordx4 a[160:163], v3, s[40:43], s63 offen sc1
v_mfma_f32_16x16x32_bf16 v[172:175], a[116:119], a[44:47], v[172:175]
v_mfma_f32_16x16x32_bf16 v[172:175], a[112:115], a[40:43], v[172:175]
ds_write_b128 v231, a[196:199] offset:8192
v_mfma_f32_16x16x32_bf16 v[196:199], a[112:115], a[48:51], v[196:199]
v_mfma_f32_16x16x32_bf16 v[196:199], a[116:119], a[52:55], v[196:199]
buffer_load_dwordx4 a[12:15], v2, s[40:43], s33 offen offset:1024 sc1
v_mfma_f32_16x16x32_bf16 v[220:223], a[116:119], a[60:63], v[220:223]
v_mfma_f32_16x16x32_bf16 v[220:223], a[112:115], a[56:59], v[220:223]
v_mfma_f32_16x16x32_bf16 a[172:175], a[120:123], a[168:171], a[172:175]
s_waitcnt lgkmcnt(1)
v_mfma_f32_16x16x32_bf16 v[224:227], a[128:131], a[56:59], v[224:227]
ds_read_b128 a[96:99], v5 offset:14336
v_mfma_f32_16x16x32_bf16 v[224:227], a[132:135], a[60:63], v[224:227]
buffer_load_dwordx4 a[16:19], v2, s[40:43], s35 offen offset:2048 sc1
v_mfma_f32_16x16x32_bf16 v[200:203], a[132:135], a[52:55], v[200:203]
ds_read_b128 a[100:103], v5 offset:20480
v_mfma_f32_16x16x32_bf16 v[200:203], a[128:131], a[48:51], v[200:203]
v_mfma_f32_16x16x32_bf16 v[176:179], a[128:131], a[40:43], v[176:179]
buffer_load_dwordx4 v1, s[4:7], s44 offen offset:2048 sc1 lds
s_add_u32 s88, s82, 0x200000
v_mfma_f32_16x16x32_bf16 v[176:179], a[132:135], a[44:47], v[176:179]
L_stub0:
s_cbranch_execz L_wret0
ds_read_b128 a[104:107], v5 offset:15360
v_mfma_f32_16x16x32_bf16 v[152:155], a[132:135], a[36:39], v[152:155]
ds_read_b128 a[108:111], v5 offset:21504
v_mfma_f32_16x16x32_bf16 v[152:155], a[128:131], a[32:35], v[152:155]
ds_write_b128 v231, a[200:203] offset:9216
v_mfma_f32_16x16x32_bf16 v[132:135], a[136:139], a[32:35], v[132:135]
buffer_load_dwordx4 a[20:23], v2, s[40:43], s33 offen offset:2048 sc1
v_mfma_f32_16x16x32_bf16 v[132:135], a[140:143], a[36:39], v[132:135]
ds_read_b128 a[112:115], v5 offset:16384
v_mfma_f32_16x16x32_bf16 v[156:159], a[140:143], a[44:47], v[156:159]
v_mfma_f32_16x16x32_bf16 v[156:159], a[136:139], a[40:43], v[156:159]
buffer_load_dwordx4 v[92:95], v1, s[4:7], s88 offen offset:0 sc1
v_mfma_f32_16x16x32_bf16 v[180:183], a[136:139], a[48:51], v[180:183]
ds_read_b128 a[116:119], v5 offset:22528
v_mfma_f32_16x16x32_bf16 v[180:183], a[140:143], a[52:55], v[180:183]
ds_read_b128 a[120:123], v6 offset:4096
v_mfma_f32_16x16x32_bf16 v[204:207], a[140:143], a[60:63], v[204:207]
v_mfma_f32_16x16x32_bf16 v[204:207], a[136:139], a[56:59], v[204:207]
buffer_load_dwordx4 a[24:27], v2, s[40:43], s35 offen offset:3072 sc1
v_mfma_f32_16x16x32_bf16 v[208:211], a[144:147], a[56:59], v[208:211]
ds_write_b128 v231, a[204:207] offset:16384
v_mfma_f32_16x16x32_bf16 v[208:211], a[148:151], a[60:63], v[208:211]
v_mfma_f32_16x16x32_bf16 v[184:187], a[148:151], a[52:55], v[184:187]
buffer_load_dwordx4 v[96:99], v1, s[4:7], s88 offen offset:1024 sc1
v_mfma_f32_16x16x32_bf16 v[184:187], a[144:147], a[48:51], v[184:187]
v_mfma_f32_16x16x32_bf16 v[160:163], a[144:147], a[40:43], v[160:163]
v_mfma_f32_16x16x32_bf16 v[160:163], a[148:151], a[44:47], v[160:163]
v_mfma_f32_16x16x32_bf16 v[136:139], a[148:151], a[36:39], v[136:139]
buffer_load_dwordx4 a[28:31], v2, s[40:43], s33 offen offset:3072 sc1
s_add_u32 s35, s35, 8192
v_mfma_f32_16x16x32_bf16 v[136:139], a[144:147], a[32:35], v[136:139]
s_add_u32 s33, s33, 8192
v_mfma_f32_16x16x32_bf16 a[176:179], a[152:155], a[168:171], a[176:179]
s_waitcnt vmcnt(13) lgkmcnt(1)
v_mfma_f32_16x16x32_bf16 v[140:143], a[96:99], a[64:67], v[140:143]
ds_read_b128 a[128:131], v5 offset:17408
v_mfma_f32_16x16x32_bf16 v[140:143], a[100:103], a[68:71], v[140:143]
buffer_load_dwordx4 a[32:35], v2, s[40:43], s35 offen offset:0 sc1
v_mfma_f32_16x16x32_bf16 v[164:167], a[100:103], a[76:79], v[164:167]
ds_read_b128 a[132:135], v5 offset:23552
v_mfma_f32_16x16x32_bf16 v[164:167], a[96:99], a[72:75], v[164:167]
ds_write_b128 v231, a[208:211] offset:17408
v_mfma_f32_16x16x32_bf16 v[188:191], a[96:99], a[80:83], v[188:191]
ds_read_b128 a[136:139], v5 offset:12288
v_mfma_f32_16x16x32_bf16 v[188:191], a[100:103], a[84:87], v[188:191]
buffer_load_dwordx4 v[100:103], v1, s[4:7], s88 offen offset:2048 sc1
v_mfma_f32_16x16x32_bf16 v[212:215], a[100:103], a[92:95], v[212:215]
ds_read_b128 a[140:143], v5 offset:18432
v_mfma_f32_16x16x32_bf16 v[212:215], a[96:99], a[88:91], v[212:215]
v_mfma_f32_16x16x32_bf16 v[216:219], a[104:107], a[88:91], v[216:219]
v_mfma_f32_16x16x32_bf16 v[216:219], a[108:111], a[92:95], v[216:219]
buffer_load_dwordx4 a[36:39], v2, s[40:43], s33 offen offset:0 sc1
v_mfma_f32_16x16x32_bf16 v[192:195], a[108:111], a[84:87], v[192:195]
ds_read_b128 a[144:147], v5 offset:13312
v_mfma_f32_16x16x32_bf16 v[192:195], a[104:107], a[80:83], v[192:195]
ds_read_b128 a[148:151], v5 offset:19456
v_mfma_f32_16x16x32_bf16 v[168:171], a[104:107], a[72:75], v[168:171]
v_mfma_f32_16x16x32_bf16 v[168:171], a[108:111], a[76:79], v[168:171]
buffer_load_dwordx4 a[40:43], v2, s[40:43], s35 offen offset:1024 sc1
v_mfma_f32_16x16x32_bf16 v[144:147], a[108:111], a[68:71], v[144:147]
ds_read_b128 a[152:155], v6 offset:5120
v_mfma_f32_16x16x32_bf16 v[144:147], a[104:107], a[64:67], v[144:147]
v_mfma_f32_16x16x32_bf16 v[148:151], a[112:115], a[64:67], v[148:151]
v_mfma_f32_16x16x32_bf16 v[148:151], a[116:119], a[68:71], v[148:151]
buffer_load_dwordx4 v[104:107], v1, s[4:7], s88 offen offset:3072 sc1
s_add_u32 s88, s88, 4096
v_mfma_f32_16x16x32_bf16 v[172:175], a[116:119], a[76:79], v[172:175]
v_mfma_f32_16x16x32_bf16 v[172:175], a[112:115], a[72:75], v[172:175]
v_mfma_f32_16x16x32_bf16 v[196:199], a[112:115], a[80:83], v[196:199]
v_mfma_f32_16x16x32_bf16 v[196:199], a[116:119], a[84:87], v[196:199]
buffer_load_dwordx4 a[44:47], v2, s[40:43], s33 offen offset:1024 sc1
v_mfma_f32_16x16x32_bf16 v[220:223], a[116:119], a[92:95], v[220:223]
v_mfma_f32_16x16x32_bf16 v[220:223], a[112:115], a[88:91], v[220:223]
v_mfma_f32_16x16x32_bf16 a[180:183], a[120:123], a[168:171], a[180:183]
s_waitcnt lgkmcnt(0)
s_barrier
v_mfma_f32_16x16x32_bf16 v[224:227], a[128:131], a[88:91], v[224:227]
ds_read_b128 a[96:99], v5 offset:26624
v_mfma_f32_16x16x32_bf16 v[224:227], a[132:135], a[92:95], v[224:227]
buffer_load_dwordx4 a[48:51], v2, s[40:43], s35 offen offset:2048 sc1
v_mfma_f32_16x16x32_bf16 v[200:203], a[132:135], a[84:87], v[200:203]
ds_read_b128 a[100:103], v5 offset:32768
v_mfma_f32_16x16x32_bf16 v[200:203], a[128:131], a[80:83], v[200:203]
ds_read_b64_tr_b16 a[220:221], v230 offset:0
v_mfma_f32_16x16x32_bf16 v[176:179], a[128:131], a[72:75], v[176:179]
buffer_load_dwordx4 v[108:111], v1, s[4:7], s88 offen offset:0 sc1
v_mfma_f32_16x16x32_bf16 v[176:179], a[132:135], a[76:79], v[176:179]
ds_read_b128 a[104:107], v5 offset:27648
v_mfma_f32_16x16x32_bf16 v[152:155], a[132:135], a[68:71], v[152:155]
ds_read_b128 a[108:111], v5 offset:33792
v_mfma_f32_16x16x32_bf16 v[152:155], a[128:131], a[64:67], v[152:155]
ds_read_b64_tr_b16 a[222:223], v230 offset:2048
v_mfma_f32_16x16x32_bf16 v[132:135], a[136:139], a[64:67], v[132:135]
buffer_load_dwordx4 a[52:55], v2, s[40:43], s33 offen offset:2048 sc1
v_mfma_f32_16x16x32_bf16 v[132:135], a[140:143], a[68:71], v[132:135]
ds_read_b128 a[112:115], v5 offset:28672
v_mfma_f32_16x16x32_bf16 v[156:159], a[140:143], a[76:79], v[156:159]
v_mfma_f32_16x16x32_bf16 v[156:159], a[136:139], a[72:75], v[156:159]
buffer_load_dwordx4 v[112:115], v1, s[4:7], s88 offen offset:1024 sc1
v_mfma_f32_16x16x32_bf16 v[180:183], a[136:139], a[80:83], v[180:183]
ds_read_b128 a[116:119], v5 offset:34816
v_mfma_f32_16x16x32_bf16 v[180:183], a[140:143], a[84:87], v[180:183]
ds_read_b128 a[120:123], v6 offset:26624
v_mfma_f32_16x16x32_bf16 v[204:207], a[140:143], a[92:95], v[204:207]
ds_read_b64_tr_b16 a[224:225], v230 offset:8
v_mfma_f32_16x16x32_bf16 v[204:207], a[136:139], a[88:91], v[204:207]
buffer_load_dwordx4 a[56:59], v2, s[40:43], s35 offen offset:3072 sc1
v_mfma_f32_16x16x32_bf16 v[208:211], a[144:147], a[88:91], v[208:211]
v_mfma_f32_16x16x32_bf16 v[208:211], a[148:151], a[92:95], v[208:211]
ds_read_b64_tr_b16 a[226:227], v230 offset:2056
v_mfma_f32_16x16x32_bf16 v[184:187], a[148:151], a[84:87], v[184:187]
buffer_load_dwordx4 v[116:119], v1, s[4:7], s88 offen offset:2048 sc1
v_mfma_f32_16x16x32_bf16 v[184:187], a[144:147], a[80:83], v[184:187]
v_mfma_f32_16x16x32_bf16 v[160:163], a[144:147], a[72:75], v[160:163]
v_mfma_f32_16x16x32_bf16 v[160:163], a[148:151], a[76:79], v[160:163]
v_mfma_f32_16x16x32_bf16 v[136:139], a[148:151], a[68:71], v[136:139]
buffer_load_dwordx4 a[60:63], v2, s[40:43], s33 offen offset:3072 sc1
s_add_u32 s35, s35, 8192
v_mfma_f32_16x16x32_bf16 v[136:139], a[144:147], a[64:67], v[136:139]
s_add_u32 s33, s33, 8192
ds_read_b64_tr_b16 a[188:189], v248 offset:0
v_mfma_f32_16x16x32_bf16 a[184:187], a[152:155], a[168:171], a[184:187]
s_waitcnt vmcnt(13) lgkmcnt(3)
v_mfma_f32_16x16x32_bf16 v[140:143], a[96:99], a[0:3], v[140:143]
ds_read_b128 a[128:131], v5 offset:29696
v_add_f32_dpp v48, v48, v48 row_ror:8 row_mask:0xf bank_mask:0xf
v_mfma_f32_16x16x32_bf16 v[140:143], a[100:103], a[4:7], v[140:143]
buffer_load_dwordx4 a[64:67], v2, s[40:43], s35 offen offset:0 sc1
v_mfma_f32_16x16x32_bf16 v[164:167], a[100:103], a[12:15], v[164:167]
ds_read_b128 a[132:135], v5 offset:35840
v_add_f32_dpp v49, v49, v49 row_ror:8 row_mask:0xf bank_mask:0xf
v_mfma_f32_16x16x32_bf16 v[164:167], a[96:99], a[8:11], v[164:167]
ds_read_b64_tr_b16 a[190:191], v248 offset:512
v_add_f32_dpp v50, v50, v50 row_ror:8 row_mask:0xf bank_mask:0xf
v_mfma_f32_16x16x32_bf16 v[188:191], a[96:99], a[16:19], v[188:191]
ds_read_b128 a[136:139], v5 offset:24576
v_add_f32_dpp v51, v51, v51 row_ror:8 row_mask:0xf bank_mask:0xf
v_mfma_f32_16x16x32_bf16 v[188:191], a[100:103], a[20:23], v[188:191]
buffer_load_dwordx4 v[120:123], v1, s[4:7], s88 offen offset:3072 sc1
s_add_u32 s63, s28, 16
v_mfma_f32_16x16x32_bf16 v[212:215], a[100:103], a[28:31], v[212:215]
s_lshl_b32 s63, s63, 12
ds_read_b128 a[140:143], v5 offset:30720
v_mfma_f32_16x16x32_bf16 v[212:215], a[96:99], a[24:27], v[212:215]
v_add_f32_dpp v52, v52, v52 row_ror:8 row_mask:0xf bank_mask:0xf
v_add_f32_dpp v53, v53, v53 row_ror:8 row_mask:0xf bank_mask:0xf
v_mfma_f32_16x16x32_bf16 v[216:219], a[104:107], a[24:27], v[216:219]
v_add_f32_dpp v54, v54, v54 row_ror:8 row_mask:0xf bank_mask:0xf
v_add_f32_dpp v55, v55, v55 row_ror:8 row_mask:0xf bank_mask:0xf
v_mfma_f32_16x16x32_bf16 v[216:219], a[108:111], a[28:31], v[216:219]
buffer_load_dwordx4 a[68:71], v2, s[40:43], s33 offen offset:0 sc1
v_mfma_f32_16x16x32_bf16 v[192:195], a[108:111], a[20:23], v[192:195]
ds_read_b128 a[144:147], v5 offset:25600
v_add_f32_dpp v48, v48, v48 row_ror:4 row_mask:0xf bank_mask:0xf
v_mfma_f32_16x16x32_bf16 v[192:195], a[104:107], a[16:19], v[192:195]
ds_read_b128 a[148:151], v5 offset:31744
v_add_f32_dpp v49, v49, v49 row_ror:4 row_mask:0xf bank_mask:0xf
v_mfma_f32_16x16x32_bf16 v[168:171], a[104:107], a[8:11], v[168:171]
ds_read_b64_tr_b16 a[192:193], v248 offset:4096
v_add_f32_dpp v50, v50, v50 row_ror:4 row_mask:0xf bank_mask:0xf
v_mfma_f32_16x16x32_bf16 v[168:171], a[108:111], a[12:15], v[168:171]
buffer_load_dwordx4 a[72:75], v2, s[40:43], s35 offen offset:1024 sc1
v_mfma_f32_16x16x32_bf16 v[144:147], a[108:111], a[4:7], v[144:147]
ds_read_b128 a[152:155], v6 offset:27648
v_add_f32_dpp v51, v51, v51 row_ror:4 row_mask:0xf bank_mask:0xf
v_mfma_f32_16x16x32_bf16 v[144:147], a[104:107], a[0:3], v[144:147]
ds_read_b64_tr_b16 a[194:195], v248 offset:4608
v_add_f32_dpp v52, v52, v52 row_ror:4 row_mask:0xf bank_mask:0xf
v_mfma_f32_16x16x32_bf16 v[148:151], a[112:115], a[0:3], v[148:151]
v_add_f32_dpp v53, v53, v53 row_ror:4 row_mask:0xf bank_mask:0xf
v_add_f32_dpp v54, v54, v54 row_ror:4 row_mask:0xf bank_mask:0xf
v_mfma_f32_16x16x32_bf16 v[148:151], a[116:119], a[4:7], v[148:151]
buffer_load_dwordx4 a[164:167], v3, s[40:43], s63 offen sc1
s_add_u32 s88, s83, 0x200000
v_mfma_f32_16x16x32_bf16 v[172:175], a[116:119], a[12:15], v[172:175]
v_add_f32_dpp v55, v55, v55 row_ror:4 row_mask:0xf bank_mask:0xf
v_add_f32_dpp v48, v48, v48 row_ror:2 row_mask:0xf bank_mask:0xf
v_mfma_f32_16x16x32_bf16 v[172:175], a[112:115], a[8:11], v[172:175]
v_add_f32_dpp v49, v49, v49 row_ror:2 row_mask:0xf bank_mask:0xf
v_add_f32_dpp v50, v50, v50 row_ror:2 row_mask:0xf bank_mask:0xf
v_mfma_f32_16x16x32_bf16 v[196:199], a[112:115], a[16:19], v[196:199]
v_add_f32_dpp v51, v51, v51 row_ror:2 row_mask:0xf bank_mask:0xf
v_add_f32_dpp v52, v52, v52 row_ror:2 row_mask:0xf bank_mask:0xf
v_mfma_f32_16x16x32_bf16 v[196:199], a[116:119], a[20:23], v[196:199]
buffer_load_dwordx4 a[76:79], v2, s[40:43], s33 offen offset:1024 sc1
v_mfma_f32_16x16x32_bf16 v[220:223], a[116:119], a[28:31], v[220:223]
ds_read_b64_tr_b16 a[196:197], v249 offset:32
v_add_f32_dpp v53, v53, v53 row_ror:2 row_mask:0xf bank_mask:0xf
v_mfma_f32_16x16x32_bf16 v[220:223], a[112:115], a[24:27], v[220:223]
v_add_f32_dpp v54, v54, v54 row_ror:2 row_mask:0xf bank_mask:0xf
v_add_f32_dpp v55, v55, v55 row_ror:2 row_mask:0xf bank_mask:0xf
v_mfma_f32_16x16x32_bf16 a[172:175], a[120:123], a[160:163], a[172:175]
v_add_f32_dpp v48, v48, v48 row_ror:1 row_mask:0xf bank_mask:0xf
s_waitcnt lgkmcnt(2)
v_mfma_f32_16x16x32_bf16 v[224:227], a[128:131], a[24:27], v[224:227]
ds_read_b128 a[96:99], v5 offset:38912
v_add_f32_dpp v49, v49, v49 row_ror:1 row_mask:0xf bank_mask:0xf
v_mfma_f32_16x16x32_bf16 v[224:227], a[132:135], a[28:31], v[224:227]
buffer_load_dwordx4 a[80:83], v2, s[40:43], s35 offen offset:2048 sc1
v_mfma_f32_16x16x32_bf16 v[200:203], a[132:135], a[20:23], v[200:203]
ds_read_b128 a[100:103], v5 offset:45056
v_add_f32_dpp v50, v50, v50 row_ror:1 row_mask:0xf bank_mask:0xf
v_mfma_f32_16x16x32_bf16 v[200:203], a[128:131], a[16:19], v[200:203]
ds_read_b64_tr_b16 a[198:199], v249 offset:544
v_add_f32_dpp v51, v51, v51 row_ror:1 row_mask:0xf bank_mask:0xf
v_mfma_f32_16x16x32_bf16 v[176:179], a[128:131], a[8:11], v[176:179]
buffer_load_dwordx4 v[124:127], v1, s[4:7], s88 offen offset:0 sc1
v_mfma_f32_16x16x32_bf16 v[176:179], a[132:135], a[12:15], v[176:179]
ds_read_b128 a[104:107], v5 offset:39936
v_add_f32_dpp v52, v52, v52 row_ror:1 row_mask:0xf bank_mask:0xf
v_mfma_f32_16x16x32_bf16 v[152:155], a[132:135], a[4:7], v[152:155]
ds_read_b128 a[108:111], v5 offset:46080
v_add_f32_dpp v53, v53, v53 row_ror:1 row_mask:0xf bank_mask:0xf
v_mfma_f32_16x16x32_bf16 v[152:155], a[128:131], a[0:3], v[152:155]
ds_read_b64_tr_b16 a[200:201], v249 offset:4128
v_add_f32_dpp v54, v54, v54 row_ror:1 row_mask:0xf bank_mask:0xf
v_mfma_f32_16x16x32_bf16 v[132:135], a[136:139], a[0:3], v[132:135]
buffer_load_dwordx4 a[84:87], v2, s[40:43], s33 offen offset:2048 sc1
v_mfma_f32_16x16x32_bf16 v[132:135], a[140:143], a[4:7], v[132:135]
ds_read_b128 a[112:115], v5 offset:40960
v_add_f32_dpp v55, v55, v55 row_ror:1 row_mask:0xf bank_mask:0xf
v_mfma_f32_16x16x32_bf16 v[156:159], a[140:143], a[12:15], v[156:159]
v_add_u32 v233, 159744, v233
s_lshl_b32 s36, s28, 6
v_mfma_f32_16x16x32_bf16 v[156:159], a[136:139], a[8:11], v[156:159]
buffer_load_dwordx4 v[128:131], v1, s[4:7], s88 offen offset:1024 sc1
s_add_u32 m0, s18, 0x1e000
v_mfma_f32_16x16x32_bf16 v[180:183], a[136:139], a[16:19], v[180:183]
s_add_u32 s44, s50, 0xe1e000
ds_read_b128 a[116:119], v5 offset:47104
v_mfma_f32_16x16x32_bf16 v[180:183], a[140:143], a[20:23], v[180:183]
ds_read_b128 a[120:123], v6 offset:28672
s_lshl_b32 s37, s39, 6
v_mfma_f32_16x16x32_bf16 v[204:207], a[140:143], a[28:31], v[204:207]
ds_read_b64_tr_b16 a[202:203], v249 offset:4640
v_add_u32 v232, s36, v233
v_mfma_f32_16x16x32_bf16 v[204:207], a[136:139], a[24:27], v[204:207]
buffer_load_dwordx4 a[88:91], v2, s[40:43], s35 offen offset:3072 sc1
v_mfma_f32_16x16x32_bf16 v[208:211], a[144:147], a[24:27], v[208:211]
v_add_u32 v235, s37, v233
v_mfma_f32_16x16x32_bf16 v[208:211], a[148:151], a[28:31], v[208:211]
v_mfma_f32_16x16x32_bf16 v[184:187], a[148:151], a[20:23], v[184:187]
buffer_load_dwordx4 v1, s[4:7], s44 offen offset:0 sc1 lds
v_mfma_f32_16x16x32_bf16 v[184:187], a[144:147], a[16:19], v[184:187]
ds_read_b64_tr_b16 a[204:205], v248 offset:8192
v_mfma_f32_16x16x32_bf16 v[160:163], a[144:147], a[8:11], v[160:163]
v_mfma_f32_16x16x32_bf16 v[160:163], a[148:151], a[12:15], v[160:163]
v_mfma_f32_16x16x32_bf16 v[136:139], a[148:151], a[4:7], v[136:139]
buffer_load_dwordx4 a[92:95], v2, s[40:43], s33 offen offset:3072 sc1
s_add_u32 s35, s35, 8192
v_mfma_f32_16x16x32_bf16 v[136:139], a[144:147], a[0:3], v[136:139]
s_add_u32 s33, s33, 8192
v_mfma_f32_16x16x32_bf16 a[176:179], a[152:155], a[160:163], a[176:179]
ds_read_b64_tr_b16 a[206:207], v248 offset:8704
s_waitcnt vmcnt(13) lgkmcnt(3)
v_mfma_f32_16x16x32_bf16 v[140:143], a[96:99], a[32:35], v[140:143]
ds_read_b128 a[128:131], v5 offset:41984
v_mfma_f32_16x16x32_bf16 v[140:143], a[100:103], a[36:39], v[140:143]
buffer_load_dwordx4 a[0:3], v2, s[40:43], s35 offen offset:0 sc1
v_mfma_f32_16x16x32_bf16 v[164:167], a[100:103], a[44:47], v[164:167]
ds_read_b128 a[132:135], v5 offset:48128
v_mfma_f32_16x16x32_bf16 v[164:167], a[96:99], a[40:43], v[164:167]
ds_write_b128 v232, v[48:51]
v_mfma_f32_16x16x32_bf16 v[188:191], a[96:99], a[48:51], v[188:191]
ds_read_b128 a[136:139], v5 offset:36864
v_mfma_f32_16x16x32_bf16 v[188:191], a[100:103], a[52:55], v[188:191]
buffer_load_dwordx4 v1, s[4:7], s44 offen offset:1024 sc1 lds
v_mfma_f32_16x16x32_bf16 v[212:215], a[100:103], a[60:63], v[212:215]
ds_read_b128 a[140:143], v5 offset:43008
v_mfma_f32_16x16x32_bf16 v[212:215], a[96:99], a[56:59], v[212:215]
ds_read_b64_tr_b16 a[208:209], v248 offset:12288
v_mfma_f32_16x16x32_bf16 v[216:219], a[104:107], a[56:59], v[216:219]
ds_write_b128 v235, v[52:55]
v_mfma_f32_16x16x32_bf16 v[216:219], a[108:111], a[60:63], v[216:219]
buffer_load_dwordx4 a[4:7], v2, s[40:43], s33 offen offset:0 sc1
v_mfma_f32_16x16x32_bf16 v[192:195], a[108:111], a[52:55], v[192:195]
ds_read_b128 a[144:147], v5 offset:37888
v_mfma_f32_16x16x32_bf16 v[192:195], a[104:107], a[48:51], v[192:195]
ds_read_b128 a[148:151], v5 offset:44032
v_mfma_f32_16x16x32_bf16 v[168:171], a[104:107], a[40:43], v[168:171]
ds_read_b64_tr_b16 a[210:211], v248 offset:12800
v_mfma_f32_16x16x32_bf16 v[168:171], a[108:111], a[44:47], v[168:171]
buffer_load_dwordx4 a[8:11], v2, s[40:43], s35 offen offset:1024 sc1
v_mfma_f32_16x16x32_bf16 v[144:147], a[108:111], a[36:39], v[144:147]
ds_read_b128 a[152:155], v6 offset:29696
v_mfma_f32_16x16x32_bf16 v[144:147], a[104:107], a[32:35], v[144:147]
v_mfma_f32_16x16x32_bf16 v[148:151], a[112:115], a[32:35], v[148:151]
v_mfma_f32_16x16x32_bf16 v[148:151], a[116:119], a[36:39], v[148:151]
buffer_load_dwordx4 v1, s[4:7], s44 offen offset:2048 sc1 lds
s_add_u32 m0, s18, 0x21000
v_mfma_f32_16x16x32_bf16 v[172:175], a[116:119], a[44:47], v[172:175]
s_add_u32 s44, s50, 0xe21000
v_mfma_f32_16x16x32_bf16 v[172:175], a[112:115], a[40:43], v[172:175]
v_mfma_f32_16x16x32_bf16 v[196:199], a[112:115], a[48:51], v[196:199]
v_mfma_f32_16x16x32_bf16 v[196:199], a[116:119], a[52:55], v[196:199]
buffer_load_dwordx4 a[12:15], v2, s[40:43], s33 offen offset:1024 sc1
v_mfma_f32_16x16x32_bf16 v[220:223], a[116:119], a[60:63], v[220:223]
v_mfma_f32_16x16x32_bf16 v[220:223], a[112:115], a[56:59], v[220:223]
v_mfma_f32_16x16x32_bf16 a[180:183], a[120:123], a[160:163], a[180:183]
s_waitcnt lgkmcnt(0)
s_barrier
v_mfma_f32_16x16x32_bf16 v[224:227], a[128:131], a[56:59], v[224:227]
v_add_u32 v5, 98304, v1
v_add_u32 v6, s55, v5
v_mfma_f32_16x16x32_bf16 v[224:227], a[132:135], a[60:63], v[224:227]
buffer_load_dwordx4 a[16:19], v2, s[40:43], s35 offen offset:2048 sc1
v_mfma_f32_16x16x32_bf16 v[200:203], a[132:135], a[52:55], v[200:203]
ds_read_b128 a[96:99], v5 offset:2048
v_mfma_f32_16x16x32_bf16 v[200:203], a[128:131], a[48:51], v[200:203]
ds_read_b128 a[100:103], v5 offset:8192
v_mfma_f32_16x16x32_bf16 v[176:179], a[128:131], a[40:43], v[176:179]
buffer_load_dwordx4 v1, s[4:7], s44 offen offset:0 sc1 lds
v_mfma_f32_16x16x32_bf16 v[176:179], a[132:135], a[44:47], v[176:179]
ds_read_b128 a[104:107], v5 offset:3072
v_mfma_f32_16x16x32_bf16 v[152:155], a[132:135], a[36:39], v[152:155]
ds_read_b128 a[108:111], v5 offset:9216
v_mfma_f32_16x16x32_bf16 v[152:155], a[128:131], a[32:35], v[152:155]
ds_read_b128 v[48:51], v233 offset:0
v_mfma_f32_16x16x32_bf16 v[132:135], a[136:139], a[32:35], v[132:135]
buffer_load_dwordx4 a[20:23], v2, s[40:43], s33 offen offset:2048 sc1
v_mfma_f32_16x16x32_bf16 v[132:135], a[140:143], a[36:39], v[132:135]
ds_read_b128 a[112:115], v5 offset:4096
v_mfma_f32_16x16x32_bf16 v[156:159], a[140:143], a[44:47], v[156:159]
ds_read_b128 v[52:55], v233 offset:64
v_mfma_f32_16x16x32_bf16 v[156:159], a[136:139], a[40:43], v[156:159]
buffer_load_dwordx4 v1, s[4:7], s44 offen offset:1024 sc1 lds
v_mfma_f32_16x16x32_bf16 v[180:183], a[136:139], a[48:51], v[180:183]
ds_read_b128 a[116:119], v5 offset:10240
v_mfma_f32_16x16x32_bf16 v[180:183], a[140:143], a[52:55], v[180:183]
ds_read_b128 a[120:123], v6 offset:2048
v_mfma_f32_16x16x32_bf16 v[204:207], a[140:143], a[60:63], v[204:207]
v_mfma_f32_16x16x32_bf16 v[204:207], a[136:139], a[56:59], v[204:207]
buffer_load_dwordx4 a[24:27], v2, s[40:43], s35 offen offset:3072 sc1
v_mfma_f32_16x16x32_bf16 v[208:211], a[144:147], a[56:59], v[208:211]
v_mfma_f32_16x16x32_bf16 v[208:211], a[148:151], a[60:63], v[208:211]
v_mfma_f32_16x16x32_bf16 v[184:187], a[148:151], a[52:55], v[184:187]
buffer_load_dwordx4 v1, s[4:7], s44 offen offset:2048 sc1 lds
s_add_u32 m0, s18, 0x0
v_mfma_f32_16x16x32_bf16 v[184:187], a[144:147], a[48:51], v[184:187]
s_add_u32 s44, s50, 0xe24000
ds_read_b128 v[56:59], v233 offset:128
v_mfma_f32_16x16x32_bf16 v[160:163], a[144:147], a[40:43], v[160:163]
v_mfma_f32_16x16x32_bf16 v[160:163], a[148:151], a[44:47], v[160:163]
v_mfma_f32_16x16x32_bf16 v[136:139], a[148:151], a[36:39], v[136:139]
buffer_load_dwordx4 a[28:31], v2, s[40:43], s33 offen offset:3072 sc1
s_add_u32 s35, s35, 8192
v_mfma_f32_16x16x32_bf16 v[136:139], a[144:147], a[32:35], v[136:139]
s_add_u32 s33, s33, 8192
v_mfma_f32_16x16x32_bf16 a[184:187], a[152:155], a[160:163], a[184:187]
s_waitcnt vmcnt(13) lgkmcnt(1)
v_mfma_f32_16x16x32_bf16 v[140:143], a[96:99], a[64:67], v[140:143]
ds_read_b128 a[128:131], v5 offset:5120
v_mfma_f32_16x16x32_bf16 v[140:143], a[100:103], a[68:71], v[140:143]
buffer_load_dwordx4 a[32:35], v2, s[40:43], s35 offen offset:0 sc1
v_mfma_f32_16x16x32_bf16 v[164:167], a[100:103], a[76:79], v[164:167]
ds_read_b128 a[132:135], v5 offset:11264
v_mfma_f32_16x16x32_bf16 v[164:167], a[96:99], a[72:75], v[164:167]
v_mfma_f32_16x16x32_bf16 v[236:239], a[188:191], v[16:19], 0
v_mfma_f32_16x16x32_bf16 v[188:191], a[96:99], a[80:83], v[188:191]
ds_read_b128 a[136:139], v5 offset:0
v_mfma_f32_16x16x32_bf16 v[188:191], a[100:103], a[84:87], v[188:191]
buffer_load_dwordx4 v1, s[4:7], s44 offen offset:0 sc1 lds
s_add_u32 s63, s28, 20
v_mfma_f32_16x16x32_bf16 v[212:215], a[100:103], a[92:95], v[212:215]
s_lshl_b32 s63, s63, 12
ds_read_b128 a[140:143], v5 offset:6144
v_mfma_f32_16x16x32_bf16 v[212:215], a[96:99], a[88:91], v[212:215]
v_mfma_f32_16x16x32_bf16 v[240:243], a[196:199], v[16:19], 0
v_mfma_f32_16x16x32_bf16 v[216:219], a[104:107], a[88:91], v[216:219]
v_mfma_f32_16x16x32_bf16 v[244:247], a[204:207], v[16:19], 0
v_mfma_f32_16x16x32_bf16 v[216:219], a[108:111], a[92:95], v[216:219]
buffer_load_dwordx4 a[36:39], v2, s[40:43], s33 offen offset:0 sc1
v_mfma_f32_16x16x32_bf16 v[192:195], a[108:111], a[84:87], v[192:195]
ds_read_b128 a[144:147], v5 offset:1024
v_mfma_f32_16x16x32_bf16 v[192:195], a[104:107], a[80:83], v[192:195]
ds_read_b128 a[148:151], v5 offset:7168
v_mfma_f32_16x16x32_bf16 v[168:171], a[104:107], a[72:75], v[168:171]
v_mfma_f32_16x16x32_bf16 v[236:239], a[192:195], v[16:19], v[236:239]
v_mfma_f32_16x16x32_bf16 v[168:171], a[108:111], a[76:79], v[168:171]
buffer_load_dwordx4 a[40:43], v2, s[40:43], s35 offen offset:1024 sc1
v_mfma_f32_16x16x32_bf16 v[144:147], a[108:111], a[68:71], v[144:147]
ds_read_b128 a[152:155], v6 offset:3072
v_mfma_f32_16x16x32_bf16 v[144:147], a[104:107], a[64:67], v[144:147]
ds_read_b128 v[60:63], v233 offset:192
v_mfma_f32_16x16x32_bf16 v[148:151], a[112:115], a[64:67], v[148:151]
v_mfma_f32_16x16x32_bf16 v[240:243], a[200:203], v[16:19], v[240:243]
v_mfma_f32_16x16x32_bf16 v[148:151], a[116:119], a[68:71], v[148:151]
buffer_load_dwordx4 a[168:171], v3, s[40:43], s63 offen sc1
v_mfma_f32_16x16x32_bf16 v[172:175], a[116:119], a[76:79], v[172:175]
ds_read_b128 v[64:67], v233 offset:256
v_mfma_f32_16x16x32_bf16 v[172:175], a[112:115], a[72:75], v[172:175]
v_mfma_f32_16x16x32_bf16 v[196:199], a[112:115], a[80:83], v[196:199]
v_mfma_f32_16x16x32_bf16 v[244:247], a[208:211], v[16:19], v[244:247]
v_mfma_f32_16x16x32_bf16 v[196:199], a[116:119], a[84:87], v[196:199]
buffer_load_dwordx4 a[44:47], v2, s[40:43], s33 offen offset:1024 sc1
v_mfma_f32_16x16x32_bf16 v[220:223], a[116:119], a[92:95], v[220:223]
ds_read_b128 v[68:71], v233 offset:320
v_mfma_f32_16x16x32_bf16 v[220:223], a[112:115], a[88:91], v[220:223]
v_mfma_f32_16x16x32_bf16 a[172:175], a[120:123], a[164:167], a[172:175]
s_waitcnt lgkmcnt(3)
v_mfma_f32_16x16x32_bf16 v[224:227], a[128:131], a[88:91], v[224:227]
ds_read_b128 a[96:99], v5 offset:14336
v_mfma_f32_16x16x32_bf16 v[224:227], a[132:135], a[92:95], v[224:227]
buffer_load_dwordx4 a[48:51], v2, s[40:43], s35 offen offset:2048 sc1
v_mfma_f32_16x16x32_bf16 v[200:203], a[132:135], a[84:87], v[200:203]
ds_read_b128 a[100:103], v5 offset:20480
v_mfma_f32_16x16x32_bf16 v[200:203], a[128:131], a[80:83], v[200:203]
v_mfma_f32_16x16x32_bf16 v[176:179], a[128:131], a[72:75], v[176:179]
buffer_load_dwordx4 v1, s[4:7], s44 offen offset:1024 sc1 lds
v_mfma_f32_16x16x32_bf16 v[176:179], a[132:135], a[76:79], v[176:179]
ds_read_b128 a[104:107], v5 offset:15360
v_mfma_f32_16x16x32_bf16 v[152:155], a[132:135], a[68:71], v[152:155]
ds_read_b128 a[108:111], v5 offset:21504
v_mfma_f32_16x16x32_bf16 v[152:155], a[128:131], a[64:67], v[152:155]
ds_read_b128 v[72:75], v232 offset:128
v_mfma_f32_16x16x32_bf16 v[132:135], a[136:139], a[64:67], v[132:135]
buffer_load_dwordx4 a[52:55], v2, s[40:43], s33 offen offset:2048 sc1
v_mfma_f32_16x16x32_bf16 v[132:135], a[140:143], a[68:71], v[132:135]
ds_read_b128 a[112:115], v5 offset:16384
v_mfma_f32_16x16x32_bf16 v[156:159], a[140:143], a[76:79], v[156:159]
v_mfma_f32_16x16x32_bf16 v[156:159], a[136:139], a[72:75], v[156:159]
buffer_load_dwordx4 v1, s[4:7], s44 offen offset:2048 sc1 lds
s_add_u32 m0, s18, 0x3000
v_mfma_f32_16x16x32_bf16 v[180:183], a[136:139], a[80:83], v[180:183]
s_add_u32 s44, s50, 0xe27000
ds_read_b128 a[116:119], v5 offset:22528
v_mfma_f32_16x16x32_bf16 v[180:183], a[140:143], a[84:87], v[180:183]
ds_read_b128 a[120:123], v6 offset:4096
v_mfma_f32_16x16x32_bf16 v[204:207], a[140:143], a[92:95], v[204:207]
v_mfma_f32_16x16x32_bf16 v[204:207], a[136:139], a[88:91], v[204:207]
buffer_load_dwordx4 a[56:59], v2, s[40:43], s35 offen offset:3072 sc1
v_mfma_f32_16x16x32_bf16 v[208:211], a[144:147], a[88:91], v[208:211]
v_mfma_f32_16x16x32_bf16 v[208:211], a[148:151], a[92:95], v[208:211]
v_mfma_f32_16x16x32_bf16 v[184:187], a[148:151], a[84:87], v[184:187]
buffer_load_dwordx4 v1, s[4:7], s44 offen offset:0 sc1 lds
v_mfma_f32_16x16x32_bf16 v[184:187], a[144:147], a[80:83], v[184:187]
v_mfma_f32_16x16x32_bf16 v[160:163], a[144:147], a[72:75], v[160:163]
v_mfma_f32_16x16x32_bf16 v[160:163], a[148:151], a[76:79], v[160:163]
v_mfma_f32_16x16x32_bf16 v[136:139], a[148:151], a[68:71], v[136:139]
buffer_load_dwordx4 a[60:63], v2, s[40:43], s33 offen offset:3072 sc1
s_add_u32 s35, s35, 8192
v_mfma_f32_16x16x32_bf16 v[136:139], a[144:147], a[64:67], v[136:139]
s_add_u32 s33, s33, 8192
v_mfma_f32_16x16x32_bf16 a[176:179], a[152:155], a[164:167], a[176:179]
s_waitcnt vmcnt(13) lgkmcnt(0)
v_mfma_f32_16x16x32_bf16 v[140:143], a[96:99], a[0:3], v[140:143]
ds_read_b128 a[128:131], v5 offset:17408
v_add_f32 v92, v92, v96
v_mfma_f32_16x16x32_bf16 v[140:143], a[100:103], a[4:7], v[140:143]
buffer_load_dwordx4 a[64:67], v2, s[40:43], s35 offen offset:0 sc1
v_mfma_f32_16x16x32_bf16 v[164:167], a[100:103], a[12:15], v[164:167]
ds_read_b128 a[132:135], v5 offset:23552
v_add_f32 v100, v100, v104
v_mfma_f32_16x16x32_bf16 v[164:167], a[96:99], a[8:11], v[164:167]
v_add_f32 v108, v108, v112
v_add_f32 v116, v116, v120
v_mfma_f32_16x16x32_bf16 v[188:191], a[96:99], a[16:19], v[188:191]
ds_read_b128 a[136:139], v5 offset:12288
v_add_f32 v124, v124, v128
v_mfma_f32_16x16x32_bf16 v[188:191], a[100:103], a[20:23], v[188:191]
buffer_load_dwordx4 v1, s[4:7], s44 offen offset:1024 sc1 lds
v_mfma_f32_16x16x32_bf16 v[212:215], a[100:103], a[28:31], v[212:215]
ds_read_b128 a[140:143], v5 offset:18432
v_add_f32 v93, v93, v97
v_mfma_f32_16x16x32_bf16 v[212:215], a[96:99], a[24:27], v[212:215]
v_add_f32 v101, v101, v105
v_add_f32 v109, v109, v113
v_mfma_f32_16x16x32_bf16 v[216:219], a[104:107], a[24:27], v[216:219]
v_add_f32 v117, v117, v121
v_add_f32 v125, v125, v129
v_mfma_f32_16x16x32_bf16 v[216:219], a[108:111], a[28:31], v[216:219]
buffer_load_dwordx4 a[68:71], v2, s[40:43], s33 offen offset:0 sc1
v_mfma_f32_16x16x32_bf16 v[192:195], a[108:111], a[20:23], v[192:195]
ds_read_b128 a[144:147], v5 offset:13312
v_add_f32 v94, v94, v98
v_mfma_f32_16x16x32_bf16 v[192:195], a[104:107], a[16:19], v[192:195]
ds_read_b128 a[148:151], v5 offset:19456
v_add_f32 v102, v102, v106
v_mfma_f32_16x16x32_bf16 v[168:171], a[104:107], a[8:11], v[168:171]
v_add_f32 v110, v110, v114
v_add_f32 v118, v118, v122
v_mfma_f32_16x16x32_bf16 v[168:171], a[108:111], a[12:15], v[168:171]
buffer_load_dwordx4 a[72:75], v2, s[40:43], s35 offen offset:1024 sc1
v_mfma_f32_16x16x32_bf16 v[144:147], a[108:111], a[4:7], v[144:147]
ds_read_b128 a[152:155], v6 offset:5120
v_add_f32 v126, v126, v130
v_mfma_f32_16x16x32_bf16 v[144:147], a[104:107], a[0:3], v[144:147]
v_add_f32 v95, v95, v99
v_add_f32 v103, v103, v107
v_mfma_f32_16x16x32_bf16 v[148:151], a[112:115], a[0:3], v[148:151]
v_add_f32 v111, v111, v115
v_add_f32 v119, v119, v123
v_mfma_f32_16x16x32_bf16 v[148:151], a[116:119], a[4:7], v[148:151]
buffer_load_dwordx4 v1, s[4:7], s44 offen offset:2048 sc1 lds
s_add_u32 m0, s18, 0x6000
v_mfma_f32_16x16x32_bf16 v[172:175], a[116:119], a[12:15], v[172:175]
s_add_u32 s44, s50, 0xe2a000
v_add_f32 v127, v127, v131
v_mfma_f32_16x16x32_bf16 v[172:175], a[112:115], a[8:11], v[172:175]
v_add_f32_dpp v92, v92, v92 row_ror:8 row_mask:0xf bank_mask:0xf
v_add_f32_dpp v100, v100, v100 row_ror:8 row_mask:0xf bank_mask:0xf
v_mfma_f32_16x16x32_bf16 v[196:199], a[112:115], a[16:19], v[196:199]
v_add_f32_dpp v108, v108, v108 row_ror:8 row_mask:0xf bank_mask:0xf
v_add_f32_dpp v116, v116, v116 row_ror:8 row_mask:0xf bank_mask:0xf
v_mfma_f32_16x16x32_bf16 v[196:199], a[116:119], a[20:23], v[196:199]
buffer_load_dwordx4 a[76:79], v2, s[40:43], s33 offen offset:1024 sc1
v_mfma_f32_16x16x32_bf16 v[220:223], a[116:119], a[28:31], v[220:223]
v_add_f32_dpp v124, v124, v124 row_ror:8 row_mask:0xf bank_mask:0xf
v_add_f32_dpp v93, v93, v93 row_ror:8 row_mask:0xf bank_mask:0xf
v_mfma_f32_16x16x32_bf16 v[220:223], a[112:115], a[24:27], v[220:223]
v_add_f32_dpp v101, v101, v101 row_ror:8 row_mask:0xf bank_mask:0xf
v_add_f32_dpp v109, v109, v109 row_ror:8 row_mask:0xf bank_mask:0xf
v_mfma_f32_16x16x32_bf16 a[180:183], a[120:123], a[164:167], a[180:183]
s_waitcnt lgkmcnt(0)
s_barrier
v_mfma_f32_16x16x32_bf16 v[224:227], a[128:131], a[24:27], v[224:227]
ds_read_b128 a[96:99], v5 offset:26624
v_add_f32_dpp v117, v117, v117 row_ror:8 row_mask:0xf bank_mask:0xf
v_mfma_f32_16x16x32_bf16 v[224:227], a[132:135], a[28:31], v[224:227]
buffer_load_dwordx4 a[80:83], v2, s[40:43], s35 offen offset:2048 sc1
v_mfma_f32_16x16x32_bf16 v[200:203], a[132:135], a[20:23], v[200:203]
ds_read_b128 a[100:103], v5 offset:32768
v_add_f32_dpp v125, v125, v125 row_ror:8 row_mask:0xf bank_mask:0xf
v_mfma_f32_16x16x32_bf16 v[200:203], a[128:131], a[16:19], v[200:203]
v_add_f32_dpp v92, v94, v94 row_ror:8 row_mask:0xf bank_mask:0xc
v_add_f32_dpp v100, v102, v102 row_ror:8 row_mask:0xf bank_mask:0xc
v_mfma_f32_16x16x32_bf16 v[176:179], a[128:131], a[8:11], v[176:179]
buffer_load_dwordx4 v1, s[4:7], s44 offen offset:0 sc1 lds
v_mfma_f32_16x16x32_bf16 v[176:179], a[132:135], a[12:15], v[176:179]
ds_read_b128 a[104:107], v5 offset:27648
v_add_f32_dpp v108, v110, v110 row_ror:8 row_mask:0xf bank_mask:0xc
v_mfma_f32_16x16x32_bf16 v[152:155], a[132:135], a[4:7], v[152:155]
ds_read_b128 a[108:111], v5 offset:33792
L_stub1:
s_cbranch_execz L_wret0
v_add_f32_dpp v116, v118, v118 row_ror:8 row_mask:0xf bank_mask:0xc
v_mfma_f32_16x16x32_bf16 v[152:155], a[128:131], a[0:3], v[152:155]
v_add_f32_dpp v124, v126, v126 row_ror:8 row_mask:0xf bank_mask:0xc
v_add_f32_dpp v93, v95, v95 row_ror:8 row_mask:0xf bank_mask:0xc
v_mfma_f32_16x16x32_bf16 v[132:135], a[136:139], a[0:3], v[132:135]
buffer_load_dwordx4 a[84:87], v2, s[40:43], s33 offen offset:2048 sc1
v_mfma_f32_16x16x32_bf16 v[132:135], a[140:143], a[4:7], v[132:135]
ds_read_b128 a[112:115], v5 offset:28672
v_add_f32_dpp v101, v103, v103 row_ror:8 row_mask:0xf bank_mask:0xc
v_mfma_f32_16x16x32_bf16 v[156:159], a[140:143], a[12:15], v[156:159]
v_add_f32_dpp v109, v111, v111 row_ror:8 row_mask:0xf bank_mask:0xc
v_add_f32_dpp v117, v119, v119 row_ror:8 row_mask:0xf bank_mask:0xc
v_mfma_f32_16x16x32_bf16 v[156:159], a[136:139], a[8:11], v[156:159]
buffer_load_dwordx4 v1, s[4:7], s44 offen offset:1024 sc1 lds
v_mfma_f32_16x16x32_bf16 v[180:183], a[136:139], a[16:19], v[180:183]
ds_read_b128 a[116:119], v5 offset:34816
v_add_f32_dpp v125, v127, v127 row_ror:8 row_mask:0xf bank_mask:0xc
v_mfma_f32_16x16x32_bf16 v[180:183], a[140:143], a[20:23], v[180:183]
ds_read_b128 a[120:123], v6 offset:26624
v_mfma_f32_16x16x32_bf16 v[204:207], a[140:143], a[28:31], v[204:207]
v_permlane32_swap_b32 v92, v93
v_mfma_f32_16x16x32_bf16 v[204:207], a[136:139], a[24:27], v[204:207]
buffer_load_dwordx4 a[88:91], v2, s[40:43], s35 offen offset:3072 sc1
v_mfma_f32_16x16x32_bf16 v[208:211], a[144:147], a[24:27], v[208:211]
v_permlane32_swap_b32 v100, v101
v_mfma_f32_16x16x32_bf16 v[208:211], a[148:151], a[28:31], v[208:211]
v_permlane32_swap_b32 v108, v109
v_mfma_f32_16x16x32_bf16 v[184:187], a[148:151], a[20:23], v[184:187]
buffer_load_dwordx4 v1, s[4:7], s44 offen offset:2048 sc1 lds
s_add_u32 m0, s18, 0x9000
v_mfma_f32_16x16x32_bf16 v[184:187], a[144:147], a[16:19], v[184:187]
s_add_u32 s44, s50, 0xe2d000
v_mfma_f32_16x16x32_bf16 v[160:163], a[144:147], a[8:11], v[160:163]
v_permlane32_swap_b32 v116, v117
v_mfma_f32_16x16x32_bf16 v[160:163], a[148:151], a[12:15], v[160:163]
v_permlane32_swap_b32 v124, v125
v_mfma_f32_16x16x32_bf16 v[136:139], a[148:151], a[4:7], v[136:139]
buffer_load_dwordx4 a[92:95], v2, s[40:43], s33 offen offset:3072 sc1
s_add_u32 s35, s35, 8192
v_mfma_f32_16x16x32_bf16 v[136:139], a[144:147], a[0:3], v[136:139]
s_add_u32 s33, s33, 8192
v_add_f32 v92, v92, v93
v_mfma_f32_16x16x32_bf16 a[184:187], a[152:155], a[164:167], a[184:187]
v_add_f32 v100, v100, v101
s_waitcnt vmcnt(13) lgkmcnt(0)
v_mfma_f32_16x16x32_bf16 v[140:143], a[96:99], a[32:35], v[140:143]
ds_read_b128 a[128:131], v5 offset:29696
v_add_f32 v108, v108, v109
v_mfma_f32_16x16x32_bf16 v[140:143], a[100:103], a[36:39], v[140:143]
buffer_load_dwordx4 a[0:3], v2, s[40:43], s35 offen offset:0 sc1
v_mfma_f32_16x16x32_bf16 v[164:167], a[100:103], a[44:47], v[164:167]
ds_read_b128 a[132:135], v5 offset:35840
v_add_f32 v116, v116, v117
v_mfma_f32_16x16x32_bf16 v[164:167], a[96:99], a[40:43], v[164:167]
v_add_f32 v124, v124, v125
v_mov_b32 v94, v92
v_mfma_f32_16x16x32_bf16 v[188:191], a[96:99], a[48:51], v[188:191]
ds_read_b128 a[136:139], v5 offset:24576
v_mov_b32 v102, v100
v_mfma_f32_16x16x32_bf16 v[188:191], a[100:103], a[52:55], v[188:191]
buffer_load_dwordx4 v1, s[4:7], s44 offen offset:0 sc1 lds
s_add_u32 s63, s28, 24
v_mfma_f32_16x16x32_bf16 v[212:215], a[100:103], a[60:63], v[212:215]
s_lshl_b32 s63, s63, 12
ds_read_b128 a[140:143], v5 offset:30720
v_mfma_f32_16x16x32_bf16 v[212:215], a[96:99], a[56:59], v[212:215]
v_mov_b32 v110, v108
v_mov_b32 v118, v116
v_mfma_f32_16x16x32_bf16 v[216:219], a[104:107], a[56:59], v[216:219]
v_mov_b32 v126, v124
v_mfma_f32_16x16x32_bf16 v[216:219], a[108:111], a[60:63], v[216:219]
buffer_load_dwordx4 a[4:7], v2, s[40:43], s33 offen offset:0 sc1
v_mfma_f32_16x16x32_bf16 v[192:195], a[108:111], a[52:55], v[192:195]
ds_read_b128 a[144:147], v5 offset:25600
v_mfma_f32_16x16x32_bf16 v[192:195], a[104:107], a[48:51], v[192:195]
ds_read_b128 a[148:151], v5 offset:31744
v_mfma_f32_16x16x32_bf16 v[168:171], a[104:107], a[40:43], v[168:171]
v_permlane16_swap_b32 v92, v94
v_mfma_f32_16x16x32_bf16 v[168:171], a[108:111], a[44:47], v[168:171]
buffer_load_dwordx4 a[8:11], v2, s[40:43], s35 offen offset:1024 sc1
v_mfma_f32_16x16x32_bf16 v[144:147], a[108:111], a[36:39], v[144:147]
ds_read_b128 a[152:155], v6 offset:27648
v_mfma_f32_16x16x32_bf16 v[144:147], a[104:107], a[32:35], v[144:147]
v_permlane16_swap_b32 v100, v102
v_mfma_f32_16x16x32_bf16 v[148:151], a[112:115], a[32:35], v[148:151]
v_permlane16_swap_b32 v108, v110
v_mfma_f32_16x16x32_bf16 v[148:151], a[116:119], a[36:39], v[148:151]
buffer_load_dwordx4 a[160:163], v3, s[40:43], s63 offen sc1
v_mfma_f32_16x16x32_bf16 v[172:175], a[116:119], a[44:47], v[172:175]
v_permlane16_swap_b32 v116, v118
v_mfma_f32_16x16x32_bf16 v[172:175], a[112:115], a[40:43], v[172:175]
v_permlane16_swap_b32 v124, v126
v_mfma_f32_16x16x32_bf16 v[196:199], a[112:115], a[48:51], v[196:199]
v_add_f32 v92, v92, v94
v_add_f32 v100, v100, v102
v_mfma_f32_16x16x32_bf16 v[196:199], a[116:119], a[52:55], v[196:199]
buffer_load_dwordx4 a[12:15], v2, s[40:43], s33 offen offset:1024 sc1
v_mfma_f32_16x16x32_bf16 v[220:223], a[116:119], a[60:63], v[220:223]
v_add_f32 v108, v108, v110
v_add_f32 v116, v116, v118
v_mfma_f32_16x16x32_bf16 v[220:223], a[112:115], a[56:59], v[220:223]
v_add_f32 v124, v124, v126
v_mov_b32 v94, v92
v_mfma_f32_16x16x32_bf16 a[172:175], a[120:123], a[168:171], a[172:175]
v_mov_b32 v102, v100
s_waitcnt lgkmcnt(0)
v_mfma_f32_16x16x32_bf16 v[224:227], a[128:131], a[56:59], v[224:227]
ds_read_b128 a[96:99], v5 offset:38912
v_mov_b32 v110, v108
v_mfma_f32_16x16x32_bf16 v[224:227], a[132:135], a[60:63], v[224:227]
buffer_load_dwordx4 a[16:19], v2, s[40:43], s35 offen offset:2048 sc1
v_mfma_f32_16x16x32_bf16 v[200:203], a[132:135], a[52:55], v[200:203]
ds_read_b128 a[100:103], v5 offset:45056
v_mov_b32 v118, v116
v_mfma_f32_16x16x32_bf16 v[200:203], a[128:131], a[48:51], v[200:203]
v_mov_b32 v126, v124
v_mfma_f32_16x16x32_bf16 v[176:179], a[128:131], a[40:43], v[176:179]
buffer_load_dwordx4 v1, s[4:7], s44 offen offset:1024 sc1 lds
v_mfma_f32_16x16x32_bf16 v[176:179], a[132:135], a[44:47], v[176:179]
ds_read_b128 a[104:107], v5 offset:39936
v_mfma_f32_16x16x32_bf16 v[152:155], a[132:135], a[36:39], v[152:155]
ds_read_b128 a[108:111], v5 offset:46080
v_mfma_f32_16x16x32_bf16 v[152:155], a[128:131], a[32:35], v[152:155]
v_permlane32_swap_b32 v92, v94
v_mfma_f32_16x16x32_bf16 v[132:135], a[136:139], a[32:35], v[132:135]
buffer_load_dwordx4 a[20:23], v2, s[40:43], s33 offen offset:2048 sc1
v_mfma_f32_16x16x32_bf16 v[132:135], a[140:143], a[36:39], v[132:135]
ds_read_b128 a[112:115], v5 offset:40960
v_mfma_f32_16x16x32_bf16 v[156:159], a[140:143], a[44:47], v[156:159]
v_permlane32_swap_b32 v100, v102
v_mfma_f32_16x16x32_bf16 v[156:159], a[136:139], a[40:43], v[156:159]
buffer_load_dwordx4 v1, s[4:7], s44 offen offset:2048 sc1 lds
s_add_u32 s63, s28, 28
v_mfma_f32_16x16x32_bf16 v[180:183], a[136:139], a[48:51], v[180:183]
s_lshl_b32 s63, s63, 12
ds_read_b128 a[116:119], v5 offset:47104
v_mfma_f32_16x16x32_bf16 v[180:183], a[140:143], a[52:55], v[180:183]
ds_read_b128 a[120:123], v6 offset:28672
v_mfma_f32_16x16x32_bf16 v[204:207], a[140:143], a[60:63], v[204:207]
v_permlane32_swap_b32 v108, v110
v_mfma_f32_16x16x32_bf16 v[204:207], a[136:139], a[56:59], v[204:207]
buffer_load_dwordx4 a[24:27], v2, s[40:43], s35 offen offset:3072 sc1
v_mfma_f32_16x16x32_bf16 v[208:211], a[144:147], a[56:59], v[208:211]
v_permlane32_swap_b32 v116, v118
v_mfma_f32_16x16x32_bf16 v[208:211], a[148:151], a[60:63], v[208:211]
v_permlane32_swap_b32 v124, v126
v_mfma_f32_16x16x32_bf16 v[184:187], a[148:151], a[52:55], v[184:187]
buffer_load_dwordx4 a[164:167], v3, s[40:43], s63 offen sc1
s_add_u32 m0, s19, 49152
v_mfma_f32_16x16x32_bf16 v[184:187], a[144:147], a[48:51], v[184:187]
s_add_u32 s44, s85, 0xa04000
v_mul_f32 v82, 0xba800000, v92
v_mfma_f32_16x16x32_bf16 v[160:163], a[144:147], a[40:43], v[160:163]
v_mul_f32 v84, 0xba800000, v100
v_mul_f32 v86, 0xba800000, v108
v_mfma_f32_16x16x32_bf16 v[160:163], a[148:151], a[44:47], v[160:163]
v_mul_f32 v88, 0xba800000, v116
v_mul_f32 v90, 0xba800000, v124
v_mfma_f32_16x16x32_bf16 v[136:139], a[148:151], a[36:39], v[136:139]
buffer_load_dwordx4 a[28:31], v2, s[40:43], s33 offen offset:3072 sc1
s_add_u32 s35, s35, 8192
v_mfma_f32_16x16x32_bf16 v[136:139], a[144:147], a[32:35], v[136:139]
s_add_u32 s33, s33, 8192
v_mul_f32 v94, 0x3a800000, v94
v_mfma_f32_16x16x32_bf16 a[176:179], a[152:155], a[168:171], a[176:179]
v_mul_f32 v102, 0x3a800000, v102
s_waitcnt vmcnt(13) lgkmcnt(0)
v_mfma_f32_16x16x32_bf16 v[140:143], a[96:99], a[64:67], v[140:143]
ds_read_b128 a[128:131], v5 offset:41984
v_mul_f32 v110, 0x3a800000, v110
v_mfma_f32_16x16x32_bf16 v[140:143], a[100:103], a[68:71], v[140:143]
buffer_load_dwordx4 a[32:35], v2, s[40:43], s35 offen offset:0 sc1
v_mfma_f32_16x16x32_bf16 v[164:167], a[100:103], a[76:79], v[164:167]
ds_read_b128 a[132:135], v5 offset:48128
v_mul_f32 v118, 0x3a800000, v118
v_mfma_f32_16x16x32_bf16 v[164:167], a[96:99], a[72:75], v[164:167]
v_mul_f32 v126, 0x3a800000, v126
v_fma_f32 v94, -v82, v82, v94
v_mfma_f32_16x16x32_bf16 v[188:191], a[96:99], a[80:83], v[188:191]
ds_read_b128 a[136:139], v5 offset:36864
v_fma_f32 v102, -v84, v84, v102
v_mfma_f32_16x16x32_bf16 v[188:191], a[100:103], a[84:87], v[188:191]
buffer_load_dwordx4 v1, s[4:7], s44 offen offset:0 sc1 lds
v_mfma_f32_16x16x32_bf16 v[212:215], a[100:103], a[92:95], v[212:215]
ds_read_b128 a[140:143], v5 offset:43008
v_fma_f32 v110, -v86, v86, v110
v_mfma_f32_16x16x32_bf16 v[212:215], a[96:99], a[88:91], v[212:215]
v_fma_f32 v118, -v88, v88, v118
v_fma_f32 v126, -v90, v90, v126
v_max_f32 v94, 0, v94
v_max_f32 v102, 0, v102
v_max_f32 v110, 0, v110
v_max_f32 v118, 0, v118
v_max_f32 v126, 0, v126
v_add_f32 v94, 0x3727c5ac, v94
v_add_f32 v102, 0x3727c5ac, v102
v_add_f32 v110, 0x3727c5ac, v110
v_add_f32 v118, 0x3727c5ac, v118
v_add_f32 v126, 0x3727c5ac, v126
v_rsq_f32 v83, v94
v_rsq_f32 v85, v102
v_rsq_f32 v87, v110
v_rsq_f32 v89, v118
v_rsq_f32 v91, v126
v_mfma_f32_16x16x32_bf16 v[216:219], a[104:107], a[88:91], v[216:219]
v_mfma_f32_16x16x32_bf16 v[216:219], a[108:111], a[92:95], v[216:219]
buffer_load_dwordx4 a[36:39], v2, s[40:43], s33 offen offset:0 sc1
v_mfma_f32_16x16x32_bf16 v[192:195], a[108:111], a[84:87], v[192:195]
ds_read_b128 a[144:147], v5 offset:37888
v_fmac_f32 v140, v56, v82
v_mfma_f32_16x16x32_bf16 v[192:195], a[104:107], a[80:83], v[192:195]
ds_read_b128 a[148:151], v5 offset:44032
v_mfma_f32_16x16x32_bf16 v[168:171], a[104:107], a[72:75], v[168:171]
v_fmac_f32 v164, v56, v84
v_mfma_f32_16x16x32_bf16 v[168:171], a[108:111], a[76:79], v[168:171]
buffer_load_dwordx4 a[40:43], v2, s[40:43], s35 offen offset:1024 sc1
v_mfma_f32_16x16x32_bf16 v[144:147], a[108:111], a[68:71], v[144:147]
ds_read_b128 a[152:155], v6 offset:29696
v_fmac_f32 v188, v56, v86
v_mfma_f32_16x16x32_bf16 v[144:147], a[104:107], a[64:67], v[144:147]
v_mfma_f32_16x16x32_bf16 v[148:151], a[112:115], a[64:67], v[148:151]
v_fmac_f32 v212, v56, v88
v_mfma_f32_16x16x32_bf16 v[148:151], a[116:119], a[68:71], v[148:151]
buffer_load_dwordx4 v1, s[4:7], s44 offen offset:1024 sc1 lds
v_mfma_f32_16x16x32_bf16 v[172:175], a[116:119], a[76:79], v[172:175]
v_fmac_f32 v216, v60, v88
v_mfma_f32_16x16x32_bf16 v[172:175], a[112:115], a[72:75], v[172:175]
v_mfma_f32_16x16x32_bf16 v[196:199], a[112:115], a[80:83], v[196:199]
v_fmac_f32 v192, v60, v86
v_mfma_f32_16x16x32_bf16 v[196:199], a[116:119], a[84:87], v[196:199]
buffer_load_dwordx4 a[44:47], v2, s[40:43], s33 offen offset:1024 sc1
v_mfma_f32_16x16x32_bf16 v[220:223], a[116:119], a[92:95], v[220:223]
v_fmac_f32 v168, v60, v84
v_fmac_f32 v141, v57, v82
v_mfma_f32_16x16x32_bf16 v[220:223], a[112:115], a[88:91], v[220:223]
v_mfma_f32_16x16x32_bf16 a[180:183], a[120:123], a[168:171], a[180:183]
s_waitcnt vmcnt(9) lgkmcnt(0)
s_barrier
v_mfma_f32_16x16x32_bf16 v[224:227], a[128:131], a[88:91], v[224:227]
v_add_u32 v5, 0, v1
v_add_u32 v6, s55, v5
v_mfma_f32_16x16x32_bf16 v[224:227], a[132:135], a[92:95], v[224:227]
buffer_load_dwordx4 a[48:51], v2, s[40:43], s35 offen offset:2048 sc1
v_mfma_f32_16x16x32_bf16 v[200:203], a[132:135], a[84:87], v[200:203]
ds_read_b128 a[96:99], v5 offset:2048
v_fmac_f32 v144, v60, v82
v_mfma_f32_16x16x32_bf16 v[200:203], a[128:131], a[80:83], v[200:203]
ds_read_b128 a[100:103], v5 offset:8192
v_fmac_f32 v148, v64, v82
v_mfma_f32_16x16x32_bf16 v[176:179], a[128:131], a[72:75], v[176:179]
buffer_load_dwordx4 v1, s[4:7], s44 offen offset:2048 sc1 lds
v_mfma_f32_16x16x32_bf16 v[176:179], a[132:135], a[76:79], v[176:179]
ds_read_b128 a[104:107], v5 offset:3072
v_fmac_f32 v172, v64, v84
v_mfma_f32_16x16x32_bf16 v[152:155], a[132:135], a[68:71], v[152:155]
ds_read_b128 a[108:111], v5 offset:9216
v_fmac_f32 v196, v64, v86
v_mfma_f32_16x16x32_bf16 v[152:155], a[128:131], a[64:67], v[152:155]
v_fmac_f32 v220, v64, v88
v_fmac_f32 v165, v57, v84
v_mfma_f32_16x16x32_bf16 v[132:135], a[136:139], a[64:67], v[132:135]
buffer_load_dwordx4 a[52:55], v2, s[40:43], s33 offen offset:2048 sc1
v_mfma_f32_16x16x32_bf16 v[132:135], a[140:143], a[68:71], v[132:135]
ds_read_b128 a[112:115], v5 offset:4096
v_fmac_f32 v189, v57, v86
v_mfma_f32_16x16x32_bf16 v[156:159], a[140:143], a[76:79], v[156:159]
ds_read_b128 a[116:119], v5 offset:10240
v_fmac_f32 v224, v68, v88
v_mfma_f32_16x16x32_bf16 v[156:159], a[136:139], a[72:75], v[156:159]
buffer_load_dwordx4 v1, s[4:7], s44 offen offset:3072 sc1 lds
s_add_u32 m0, s19, 65536
v_mfma_f32_16x16x32_bf16 v[180:183], a[136:139], a[80:83], v[180:183]
s_add_u32 s44, s84, 0xa08000
ds_read_b128 a[120:123], v6 offset:2048
v_mfma_f32_16x16x32_bf16 v[180:183], a[140:143], a[84:87], v[180:183]
v_fmac_f32 v200, v68, v86
v_fmac_f32 v213, v57, v88
v_mfma_f32_16x16x32_bf16 v[204:207], a[140:143], a[92:95], v[204:207]
ds_read_b128 a[124:127], v6 offset:26624
v_fmac_f32 v176, v68, v84
v_mfma_f32_16x16x32_bf16 v[204:207], a[136:139], a[88:91], v[204:207]
buffer_load_dwordx4 a[56:59], v2, s[40:43], s35 offen offset:3072 sc1
v_mfma_f32_16x16x32_bf16 v[208:211], a[144:147], a[88:91], v[208:211]
v_fmac_f32 v152, v68, v82
v_fmac_f32 v217, v61, v88
v_mfma_f32_16x16x32_bf16 v[208:211], a[148:151], a[92:95], v[208:211]
v_fmac_f32 v193, v61, v86
v_fmac_f32 v169, v61, v84
v_mfma_f32_16x16x32_bf16 v[184:187], a[148:151], a[84:87], v[184:187]
buffer_load_dwordx4 v1, s[4:7], s44 offen offset:0 sc1 lds
v_mfma_f32_16x16x32_bf16 v[184:187], a[144:147], a[80:83], v[184:187]
v_fmac_f32 v132, v48, v82
v_fmac_f32 v145, v61, v82
v_mfma_f32_16x16x32_bf16 v[160:163], a[144:147], a[72:75], v[160:163]
v_fmac_f32 v156, v48, v84
v_fmac_f32 v149, v65, v82
v_mfma_f32_16x16x32_bf16 v[160:163], a[148:151], a[76:79], v[160:163]
v_fmac_f32 v173, v65, v84
v_fmac_f32 v197, v65, v86
v_mfma_f32_16x16x32_bf16 v[136:139], a[148:151], a[68:71], v[136:139]
buffer_load_dwordx4 a[60:63], v2, s[40:43], s33 offen offset:3072 sc1
s_add_u32 s35, s35, 8192
v_mfma_f32_16x16x32_bf16 v[136:139], a[144:147], a[64:67], v[136:139]
s_add_u32 s33, s33, 8192
v_fmac_f32 v180, v48, v86
v_mfma_f32_16x16x32_bf16 a[184:187], a[152:155], a[168:171], a[184:187]
v_fmac_f32 v204, v48, v88
s_waitcnt vmcnt(13) lgkmcnt(0)
v_mfma_f32_16x16x32_bf16 v[140:143], a[96:99], a[0:3], v[140:143]
ds_read_b128 a[128:131], v5 offset:5120
v_fmac_f32 v221, v65, v88
v_mfma_f32_16x16x32_bf16 v[140:143], a[100:103], a[4:7], v[140:143]
buffer_load_dwordx4 a[64:67], v2, s[40:43], s35 offen offset:0 sc1
s_lshl_b32 s37, s28, 10
v_mfma_f32_16x16x32_bf16 v[164:167], a[100:103], a[12:15], v[164:167]
ds_read_b128 a[132:135], v5 offset:11264
v_fmac_f32 v208, v52, v88
v_mfma_f32_16x16x32_bf16 v[164:167], a[96:99], a[8:11], v[164:167]
v_fmac_f32 v184, v52, v86
v_fmac_f32 v225, v69, v88
v_mfma_f32_16x16x32_bf16 v[188:191], a[96:99], a[16:19], v[188:191]
buffer_load_dwordx4 a[68:71], v2, s[40:43], s33 offen offset:0 sc1
s_lshl_b32 s72, s30, 12
v_mfma_f32_16x16x32_bf16 v[188:191], a[100:103], a[20:23], v[188:191]
ds_read_b128 a[136:139], v5 offset:0
v_fmac_f32 v160, v52, v84
v_mfma_f32_16x16x32_bf16 v[212:215], a[100:103], a[28:31], v[212:215]
ds_read_b128 a[140:143], v5 offset:6144
v_fmac_f32 v201, v69, v86
v_mfma_f32_16x16x32_bf16 v[212:215], a[96:99], a[24:27], v[212:215]
v_fmac_f32 v136, v52, v82
v_fmac_f32 v177, v69, v84
v_mfma_f32_16x16x32_bf16 v[216:219], a[104:107], a[24:27], v[216:219]
buffer_load_dwordx4 v1, s[4:7], s44 offen offset:1024 sc1 lds
s_add_u32 s72, s72, 0x1e00000
v_mfma_f32_16x16x32_bf16 v[216:219], a[108:111], a[28:31], v[216:219]
ds_read_b128 a[144:147], v5 offset:1024
v_fmac_f32 v153, v69, v82
v_mfma_f32_16x16x32_bf16 v[192:195], a[108:111], a[20:23], v[192:195]
ds_read_b128 a[148:151], v5 offset:7168
v_fmac_f32 v133, v49, v82
v_mfma_f32_16x16x32_bf16 v[192:195], a[104:107], a[16:19], v[192:195]
v_fmac_f32 v157, v49, v84
v_fmac_f32 v181, v49, v86
v_mfma_f32_16x16x32_bf16 v[168:171], a[104:107], a[8:11], v[168:171]
buffer_load_dwordx4 a[72:75], v2, s[40:43], s35 offen offset:1024 sc1
v_mfma_f32_16x16x32_bf16 v[168:171], a[108:111], a[12:15], v[168:171]
ds_read_b128 a[152:155], v6 offset:3072
v_fmac_f32 v205, v49, v88
v_mfma_f32_16x16x32_bf16 v[144:147], a[108:111], a[4:7], v[144:147]
ds_read_b128 a[156:159], v6 offset:27648
v_fmac_f32 v209, v53, v88
v_mfma_f32_16x16x32_bf16 v[144:147], a[104:107], a[0:3], v[144:147]
buffer_load_dwordx4 a[76:79], v2, s[40:43], s33 offen offset:1024 sc1
v_mfma_f32_16x16x32_bf16 v[148:151], a[112:115], a[0:3], v[148:151]
v_fmac_f32 v185, v53, v86
v_fmac_f32 v142, v58, v82
v_mfma_f32_16x16x32_bf16 v[148:151], a[116:119], a[4:7], v[148:151]
v_fmac_f32 v161, v53, v84
v_fmac_f32 v166, v58, v84
v_mfma_f32_16x16x32_bf16 v[172:175], a[116:119], a[12:15], v[172:175]
v_fmac_f32 v190, v58, v86
v_fmac_f32 v214, v58, v88
v_mfma_f32_16x16x32_bf16 v[172:175], a[112:115], a[8:11], v[172:175]
buffer_load_dwordx4 a[80:83], v2, s[40:43], s35 offen offset:2048 sc1
v_mfma_f32_16x16x32_bf16 v[196:199], a[112:115], a[16:19], v[196:199]
v_fmac_f32 v137, v53, v82
v_fmac_f32 v218, v62, v88
v_mfma_f32_16x16x32_bf16 v[196:199], a[116:119], a[20:23], v[196:199]
v_fmac_f32 v194, v62, v86
v_add_u32 v233, s37, v1
v_mfma_f32_16x16x32_bf16 v[220:223], a[116:119], a[28:31], v[220:223]
v_fmac_f32 v170, v62, v84
v_fmac_f32 v143, v59, v82
v_mfma_f32_16x16x32_bf16 v[220:223], a[112:115], a[24:27], v[220:223]
buffer_load_dwordx4 a[84:87], v2, s[40:43], s33 offen offset:2048 sc1
v_mfma_f32_16x16x32_bf16 a[172:175], a[120:123], a[160:163], a[172:175]
v_fmac_f32 v146, v62, v82
v_fmac_f32 v167, v59, v84
v_mfma_f32_16x16x32_bf16 a[172:175], a[124:127], a[164:167], a[172:175]
v_add_u32 v232, s19, v7
s_waitcnt lgkmcnt(0)
v_mfma_f32_16x16x32_bf16 v[224:227], a[128:131], a[24:27], v[224:227]
ds_read_b128 a[96:99], v5 offset:14336
v_fmac_f32 v150, v66, v82
v_mfma_f32_16x16x32_bf16 v[224:227], a[132:135], a[28:31], v[224:227]
buffer_load_dwordx4 a[88:91], v2, s[40:43], s35 offen offset:3072 sc1
v_mfma_f32_16x16x32_bf16 v[200:203], a[132:135], a[20:23], v[200:203]
ds_read_b128 a[100:103], v5 offset:20480
v_fmac_f32 v174, v66, v84
v_mfma_f32_16x16x32_bf16 v[200:203], a[128:131], a[16:19], v[200:203]
v_fmac_f32 v191, v59, v86
v_fmac_f32 v215, v59, v88
v_mfma_f32_16x16x32_bf16 v[176:179], a[128:131], a[8:11], v[176:179]
buffer_load_dwordx4 v1, s[4:7], s44 offen offset:2048 sc1 lds
v_mfma_f32_16x16x32_bf16 v[176:179], a[132:135], a[12:15], v[176:179]
ds_read_b128 a[104:107], v5 offset:15360
v_fmac_f32 v198, v66, v86
v_mfma_f32_16x16x32_bf16 v[152:155], a[132:135], a[4:7], v[152:155]
ds_read_b128 a[108:111], v5 offset:21504
v_fmac_f32 v222, v66, v88
v_mfma_f32_16x16x32_bf16 v[152:155], a[128:131], a[0:3], v[152:155]
v_fmac_f32 v219, v63, v88
v_fmac_f32 v195, v63, v86
v_mfma_f32_16x16x32_bf16 v[132:135], a[136:139], a[0:3], v[132:135]
buffer_load_dwordx4 v1, s[4:7], s44 offen offset:3072 sc1 lds
s_add_u32 m0, s19, 81920
v_mfma_f32_16x16x32_bf16 v[132:135], a[140:143], a[4:7], v[132:135]
s_add_u32 s44, s85, 0xa0c000
ds_read_b128 a[112:115], v5 offset:16384
v_mfma_f32_16x16x32_bf16 v[156:159], a[140:143], a[12:15], v[156:159]
ds_read_b128 a[116:119], v5 offset:22528
v_fmac_f32 v226, v70, v88
v_mfma_f32_16x16x32_bf16 v[156:159], a[136:139], a[8:11], v[156:159]
v_fmac_f32 v171, v63, v84
v_fmac_f32 v147, v63, v82
v_mfma_f32_16x16x32_bf16 v[180:183], a[136:139], a[16:19], v[180:183]
buffer_load_dwordx4 v1, s[4:7], s44 offen offset:0 sc1 lds
v_mfma_f32_16x16x32_bf16 v[180:183], a[140:143], a[20:23], v[180:183]
ds_read_b128 a[120:123], v6 offset:4096
v_fmac_f32 v202, v70, v86
v_mfma_f32_16x16x32_bf16 v[204:207], a[140:143], a[28:31], v[204:207]
ds_read_b128 a[124:127], v6 offset:28672
v_fmac_f32 v178, v70, v84
v_mfma_f32_16x16x32_bf16 v[204:207], a[136:139], a[24:27], v[204:207]
buffer_load_dwordx4 a[92:95], v2, s[40:43], s33 offen offset:3072 sc1
s_add_u32 s35, s35, 8192
v_mfma_f32_16x16x32_bf16 v[208:211], a[144:147], a[24:27], v[208:211]
s_add_u32 s33, s33, 8192
v_fmac_f32 v154, v70, v82
v_mfma_f32_16x16x32_bf16 v[208:211], a[148:151], a[28:31], v[208:211]
v_fmac_f32 v151, v67, v82
v_fmac_f32 v175, v67, v84
v_mfma_f32_16x16x32_bf16 v[184:187], a[148:151], a[20:23], v[184:187]
v_fmac_f32 v134, v50, v82
v_fmac_f32 v199, v67, v86
v_mfma_f32_16x16x32_bf16 v[184:187], a[144:147], a[16:19], v[184:187]
buffer_load_dwordx4 v1, s[4:7], s44 offen offset:1024 sc1 lds
v_mfma_f32_16x16x32_bf16 v[160:163], a[144:147], a[8:11], v[160:163]
v_fmac_f32 v158, v50, v84
v_fmac_f32 v223, v67, v88
v_mfma_f32_16x16x32_bf16 v[160:163], a[148:151], a[12:15], v[160:163]
v_add_u32 v248, s19, v8
v_mfma_f32_16x16x32_bf16 v[136:139], a[148:151], a[4:7], v[136:139]
v_fmac_f32 v182, v50, v86
v_fmac_f32 v227, v71, v88
v_mfma_f32_16x16x32_bf16 v[136:139], a[144:147], a[0:3], v[136:139]
buffer_load_dwordx4 v1, s[4:7], s44 offen offset:2048 sc1 lds
v_mfma_f32_16x16x32_bf16 a[176:179], a[152:155], a[160:163], a[176:179]
v_fmac_f32 v206, v50, v88
v_fmac_f32 v203, v71, v86
v_mfma_f32_16x16x32_bf16 a[176:179], a[156:159], a[164:167], a[176:179]
s_waitcnt vmcnt(14) lgkmcnt(0)
v_mfma_f32_16x16x32_bf16 v[140:143], a[96:99], a[32:35], v[140:143]
ds_read_b128 a[128:131], v5 offset:17408
v_fmac_f32 v210, v54, v88
v_mfma_f32_16x16x32_bf16 v[140:143], a[100:103], a[36:39], v[140:143]
buffer_load_dwordx4 a[0:3], v2, s[40:43], s35 offen offset:0 sc1
v_mfma_f32_16x16x32_bf16 v[164:167], a[100:103], a[44:47], v[164:167]
ds_read_b128 a[132:135], v5 offset:23552
v_fmac_f32 v186, v54, v86
v_mfma_f32_16x16x32_bf16 v[164:167], a[96:99], a[40:43], v[164:167]
v_fmac_f32 v179, v71, v84
v_fmac_f32 v155, v71, v82
v_mfma_f32_16x16x32_bf16 v[188:191], a[96:99], a[48:51], v[188:191]
buffer_load_dwordx4 a[4:7], v2, s[40:43], s33 offen offset:0 sc1
v_mfma_f32_16x16x32_bf16 v[188:191], a[100:103], a[52:55], v[188:191]
ds_read_b128 a[136:139], v5 offset:26624
v_fmac_f32 v162, v54, v84
v_mfma_f32_16x16x32_bf16 v[212:215], a[100:103], a[60:63], v[212:215]
ds_read_b128 a[140:143], v5 offset:32768
v_fmac_f32 v138, v54, v82
v_mfma_f32_16x16x32_bf16 v[212:215], a[96:99], a[56:59], v[212:215]
buffer_load_dwordx4 a[8:11], v2, s[40:43], s35 offen offset:1024 sc1
v_mfma_f32_16x16x32_bf16 v[216:219], a[104:107], a[56:59], v[216:219]
ds_read_b128 a[144:147], v5 offset:27648
v_fmac_f32 v135, v51, v82
v_mfma_f32_16x16x32_bf16 v[216:219], a[108:111], a[60:63], v[216:219]
v_fmac_f32 v159, v51, v84
v_fmac_f32 v183, v51, v86
v_mfma_f32_16x16x32_bf16 v[192:195], a[108:111], a[52:55], v[192:195]
buffer_load_dwordx4 a[12:15], v2, s[40:43], s33 offen offset:1024 sc1
v_mfma_f32_16x16x32_bf16 v[192:195], a[104:107], a[48:51], v[192:195]
ds_read_b128 a[148:151], v5 offset:33792
v_fmac_f32 v207, v51, v88
v_mfma_f32_16x16x32_bf16 v[168:171], a[104:107], a[40:43], v[168:171]
ds_read_b128 a[152:155], v6 offset:5120
v_fmac_f32 v211, v55, v88
v_mfma_f32_16x16x32_bf16 v[168:171], a[108:111], a[44:47], v[168:171]
v_mul_f32 v88, 0x3e8293ee, v89
v_mfma_f32_16x16x32_bf16 v[144:147], a[108:111], a[36:39], v[144:147]
buffer_load_dwordx4 a[16:19], v2, s[40:43], s35 offen offset:2048 sc1
v_mfma_f32_16x16x32_bf16 v[144:147], a[104:107], a[32:35], v[144:147]
ds_read_b128 a[156:159], v6 offset:29696
v_fmac_f32 v187, v55, v86
v_mfma_f32_16x16x32_bf16 v[148:151], a[112:115], a[32:35], v[148:151]
v_fmac_f32 v163, v55, v84
v_mul_f32 v86, 0x3e8293ee, v87
v_mfma_f32_16x16x32_bf16 v[148:151], a[116:119], a[36:39], v[148:151]
buffer_load_dwordx4 a[20:23], v2, s[40:43], s33 offen offset:2048 sc1
v_mfma_f32_16x16x32_bf16 v[172:175], a[116:119], a[44:47], v[172:175]
v_fmac_f32 v139, v55, v82
v_mul_f32 v84, 0x3e8293ee, v85
v_mfma_f32_16x16x32_bf16 v[172:175], a[112:115], a[40:43], v[172:175]
v_mul_f32 v82, 0x3e8293ee, v83
v_mfma_f32_16x16x32_bf16 v[196:199], a[112:115], a[48:51], v[196:199]
buffer_load_dwordx4 a[24:27], v2, s[40:43], s35 offen offset:3072 sc1
v_mfma_f32_16x16x32_bf16 v[196:199], a[116:119], a[52:55], v[196:199]
v_mfma_f32_16x16x32_bf16 v[220:223], a[116:119], a[60:63], v[220:223]
v_mfma_f32_16x16x32_bf16 v[220:223], a[112:115], a[56:59], v[220:223]
buffer_load_dwordx4 a[28:31], v2, s[40:43], s33 offen offset:3072 sc1
s_add_u32 s35, s35, 8192
v_mfma_f32_16x16x32_bf16 a[180:183], a[120:123], a[160:163], a[180:183]
s_add_u32 s33, s33, 8192
v_mfma_f32_16x16x32_bf16 a[180:183], a[124:127], a[164:167], a[180:183]
s_waitcnt lgkmcnt(0)
v_mfma_f32_16x16x32_bf16 v[224:227], a[128:131], a[56:59], v[224:227]
ds_read_b128 a[96:99], v5 offset:28672
s_lshl_b32 s90, s28, 12
v_mfma_f32_16x16x32_bf16 v[224:227], a[132:135], a[60:63], v[224:227]
buffer_load_dwordx4 v1, s[4:7], s44 offen offset:3072 sc1 lds
s_add_u32 s90, s90, 147456
v_mfma_f32_16x16x32_bf16 v[200:203], a[132:135], a[52:55], v[200:203]
ds_read_b128 a[100:103], v5 offset:34816
v_add_u32 v234, s90, v1
v_mfma_f32_16x16x32_bf16 v[200:203], a[128:131], a[48:51], v[200:203]
s_lshl_b32 s90, s28, 10
s_add_u32 s90, s90, 147456
v_mfma_f32_16x16x32_bf16 v[176:179], a[128:131], a[40:43], v[176:179]
v_add_u32 v235, s90, v1
v_mfma_f32_16x16x32_bf16 v[176:179], a[132:135], a[44:47], v[176:179]
ds_read_b128 a[104:107], v5 offset:29696
v_mfma_f32_16x16x32_bf16 v[152:155], a[132:135], a[36:39], v[152:155]
v_mfma_f32_16x16x32_bf16 v[152:155], a[128:131], a[32:35], v[152:155]
s_waitcnt vmcnt(22)
v_mfma_f32_16x16x32_bf16 v[140:143], a[136:139], a[64:67], v[140:143]
ds_read_b128 a[108:111], v5 offset:35840
s_waitcnt vmcnt(21)
v_mfma_f32_16x16x32_bf16 v[140:143], a[140:143], a[68:71], v[140:143]
s_waitcnt vmcnt(18)
v_mfma_f32_16x16x32_bf16 v[164:167], a[140:143], a[76:79], v[164:167]
ds_read_b128 a[112:115], v5 offset:38912
v_mfma_f32_16x16x32_bf16 v[164:167], a[136:139], a[72:75], v[164:167]
s_waitcnt vmcnt(17)
v_mfma_f32_16x16x32_bf16 v[188:191], a[136:139], a[80:83], v[188:191]
s_waitcnt vmcnt(16)
v_mfma_f32_16x16x32_bf16 v[188:191], a[140:143], a[84:87], v[188:191]
ds_read_b128 a[116:119], v5 offset:45056
s_waitcnt vmcnt(11)
v_mfma_f32_16x16x32_bf16 v[212:215], a[140:143], a[92:95], v[212:215]
v_mfma_f32_16x16x32_bf16 v[212:215], a[136:139], a[88:91], v[212:215]
v_mfma_f32_16x16x32_bf16 v[216:219], a[144:147], a[88:91], v[216:219]
v_mfma_f32_16x16x32_bf16 v[216:219], a[148:151], a[92:95], v[216:219]
v_mfma_f32_16x16x32_bf16 v[192:195], a[148:151], a[84:87], v[192:195]
v_mfma_f32_16x16x32_bf16 v[192:195], a[144:147], a[80:83], v[192:195]
v_mfma_f32_16x16x32_bf16 v[168:171], a[144:147], a[72:75], v[168:171]
v_mfma_f32_16x16x32_bf16 v[168:171], a[148:151], a[76:79], v[168:171]
v_mfma_f32_16x16x32_bf16 v[144:147], a[148:151], a[68:71], v[144:147]
v_mfma_f32_16x16x32_bf16 v[144:147], a[144:147], a[64:67], v[144:147]
v_mfma_f32_16x16x32_bf16 a[184:187], a[152:155], a[160:163], a[184:187]
v_mfma_f32_16x16x32_bf16 a[184:187], a[156:159], a[164:167], a[184:187]
s_waitcnt lgkmcnt(0)
v_mfma_f32_16x16x32_bf16 v[148:151], a[96:99], a[64:67], v[148:151]
ds_read_b128 a[128:131], v5 offset:39936
v_mfma_f32_16x16x32_bf16 v[148:151], a[100:103], a[68:71], v[148:151]
buffer_store_dwordx4 a[220:223], v1, s[4:7], s101 offen offset:0 sc1
v_mfma_f32_16x16x32_bf16 v[172:175], a[100:103], a[76:79], v[172:175]
ds_read_b128 a[132:135], v5 offset:46080
v_mfma_f32_16x16x32_bf16 v[172:175], a[96:99], a[72:75], v[172:175]
v_mfma_f32_16x16x32_bf16 v[196:199], a[96:99], a[80:83], v[196:199]
v_mfma_f32_16x16x32_bf16 v[196:199], a[100:103], a[84:87], v[196:199]
ds_read_b128 a[136:139], v5 offset:40960
v_mfma_f32_16x16x32_bf16 v[220:223], a[100:103], a[92:95], v[220:223]
v_mfma_f32_16x16x32_bf16 v[220:223], a[96:99], a[88:91], v[220:223]
v_mfma_f32_16x16x32_bf16 v[224:227], a[104:107], a[88:91], v[224:227]
ds_read_b128 a[140:143], v5 offset:47104
v_mfma_f32_16x16x32_bf16 v[224:227], a[108:111], a[92:95], v[224:227]
buffer_store_dwordx4 a[224:227], v1, s[4:7], s101 offen offset:1024 sc1
v_mfma_f32_16x16x32_bf16 v[200:203], a[108:111], a[84:87], v[200:203]
ds_read_b128 a[144:147], v5 offset:41984
v_mfma_f32_16x16x32_bf16 v[200:203], a[104:107], a[80:83], v[200:203]
ds_write_b128 v234, a[172:175] offset:0
v_mfma_f32_16x16x32_bf16 v[176:179], a[104:107], a[72:75], v[176:179]
v_mfma_f32_16x16x32_bf16 v[176:179], a[108:111], a[76:79], v[176:179]
ds_read_b128 a[148:151], v5 offset:48128
v_mfma_f32_16x16x32_bf16 v[152:155], a[108:111], a[68:71], v[152:155]
v_mfma_f32_16x16x32_bf16 v[152:155], a[104:107], a[64:67], v[152:155]
s_waitcnt vmcnt(10)
v_mfma_f32_16x16x32_bf16 v[140:143], a[112:115], a[0:3], v[140:143]
s_waitcnt vmcnt(9)
v_mfma_f32_16x16x32_bf16 v[140:143], a[116:119], a[4:7], v[140:143]
buffer_store_dwordx4 a[188:191], v1, s[4:7], s96 offen offset:0 sc1
s_waitcnt vmcnt(8)
v_mfma_f32_16x16x32_bf16 v[164:167], a[116:119], a[12:15], v[164:167]
v_mfma_f32_16x16x32_bf16 v[164:167], a[112:115], a[8:11], v[164:167]
s_waitcnt vmcnt(7)
v_mfma_f32_16x16x32_bf16 v[188:191], a[112:115], a[16:19], v[188:191]
s_waitcnt vmcnt(6)
v_mfma_f32_16x16x32_bf16 v[188:191], a[116:119], a[20:23], v[188:191]
s_waitcnt vmcnt(4)
v_mfma_f32_16x16x32_bf16 v[212:215], a[116:119], a[28:31], v[212:215]
L_stub2:
s_cbranch_execz L_wret0
ds_write_b128 v234, a[176:179] offset:1024
v_mfma_f32_16x16x32_bf16 v[212:215], a[112:115], a[24:27], v[212:215]
s_waitcnt lgkmcnt(1)
v_mfma_f32_16x16x32_bf16 v[216:219], a[128:131], a[24:27], v[216:219]
ds_read_b128 a[96:99], v5 offset:12288
v_mul_f32 v140, v140, v83
v_mfma_f32_16x16x32_bf16 v[216:219], a[132:135], a[28:31], v[216:219]
buffer_store_dwordx4 a[192:195], v1, s[4:7], s97 offen offset:0 sc1
v_mfma_f32_16x16x32_bf16 v[192:195], a[132:135], a[20:23], v[192:195]
ds_read_b128 a[100:103], v5 offset:18432
v_mul_f32 v141, v141, v83
v_mfma_f32_16x16x32_bf16 v[192:195], a[128:131], a[16:19], v[192:195]
v_cvt_pk_bf16_f32 v140, v140, v141
v_mul_f32 v164, v164, v85
v_mfma_f32_16x16x32_bf16 v[168:171], a[128:131], a[8:11], v[168:171]
v_mul_f32 v165, v165, v85
v_cvt_pk_bf16_f32 v164, v164, v165
v_mfma_f32_16x16x32_bf16 v[168:171], a[132:135], a[12:15], v[168:171]
ds_read_b128 a[104:107], v5 offset:24576
v_mul_f32 v188, v188, v87
v_mfma_f32_16x16x32_bf16 v[144:147], a[132:135], a[4:7], v[144:147]
v_mul_f32 v189, v189, v87
v_cvt_pk_bf16_f32 v188, v188, v189
v_mfma_f32_16x16x32_bf16 v[144:147], a[128:131], a[0:3], v[144:147]
v_mul_f32 v212, v212, v89
v_mul_f32 v213, v213, v89
v_mfma_f32_16x16x32_bf16 v[148:151], a[136:139], a[0:3], v[148:151]
ds_read_b128 a[108:111], v5 offset:30720
v_cvt_pk_bf16_f32 v212, v212, v213
v_mfma_f32_16x16x32_bf16 v[148:151], a[140:143], a[4:7], v[148:151]
buffer_store_dwordx4 a[196:199], v1, s[4:7], s96 offen offset:1024 sc1
v_mfma_f32_16x16x32_bf16 v[172:175], a[140:143], a[12:15], v[172:175]
ds_read_b128 a[112:115], v5 offset:36864
v_mul_f32 v214, v214, v89
v_mfma_f32_16x16x32_bf16 v[172:175], a[136:139], a[8:11], v[172:175]
ds_write_b128 v234, a[180:183] offset:2048
v_mul_f32 v215, v215, v89
v_mfma_f32_16x16x32_bf16 v[196:199], a[136:139], a[16:19], v[196:199]
v_cvt_pk_bf16_f32 v213, v214, v215
v_mul_f32 v216, v216, v89
v_mfma_f32_16x16x32_bf16 v[196:199], a[140:143], a[20:23], v[196:199]
ds_read_b128 a[116:119], v5 offset:43008
v_mul_f32 v217, v217, v89
v_mfma_f32_16x16x32_bf16 v[220:223], a[140:143], a[28:31], v[220:223]
v_cvt_pk_bf16_f32 v214, v216, v217
v_mul_f32 v218, v218, v89
v_mfma_f32_16x16x32_bf16 v[220:223], a[136:139], a[24:27], v[220:223]
v_mul_f32 v219, v219, v89
v_cvt_pk_bf16_f32 v215, v218, v219
v_mfma_f32_16x16x32_bf16 v[224:227], a[144:147], a[24:27], v[224:227]
v_mul_f32 v148, v148, v83
v_mul_f32 v149, v149, v83
v_mfma_f32_16x16x32_bf16 v[224:227], a[148:151], a[28:31], v[224:227]
buffer_store_dwordx4 a[200:203], v1, s[4:7], s97 offen offset:1024 sc1
v_mfma_f32_16x16x32_bf16 v[200:203], a[148:151], a[20:23], v[200:203]
v_cvt_pk_bf16_f32 v148, v148, v149
v_mul_f32 v172, v172, v85
v_mfma_f32_16x16x32_bf16 v[200:203], a[144:147], a[16:19], v[200:203]
v_mul_f32 v173, v173, v85
v_cvt_pk_bf16_f32 v172, v172, v173
v_mfma_f32_16x16x32_bf16 v[176:179], a[144:147], a[8:11], v[176:179]
v_mul_f32 v196, v196, v87
v_mul_f32 v197, v197, v87
v_mfma_f32_16x16x32_bf16 v[176:179], a[148:151], a[12:15], v[176:179]
v_cvt_pk_bf16_f32 v196, v196, v197
v_mul_f32 v198, v198, v87
v_mfma_f32_16x16x32_bf16 v[152:155], a[148:151], a[4:7], v[152:155]
ds_write_b128 v234, a[184:187] offset:3072
v_mul_f32 v199, v199, v87
v_mfma_f32_16x16x32_bf16 v[152:155], a[144:147], a[0:3], v[152:155]
v_cvt_pk_bf16_f32 v197, v198, v199
s_waitcnt lgkmcnt(1)
v_mfma_f32_16x16x32_bf16 v[132:135], a[96:99], a[32:35], v[132:135]
ds_read_b128 a[128:131], v5 offset:13312
v_mul_f32 v220, v220, v89
v_mfma_f32_16x16x32_bf16 v[132:135], a[100:103], a[36:39], v[132:135]
buffer_store_dwordx4 a[204:207], v1, s[4:7], s96 offen offset:2048 sc1
v_mfma_f32_16x16x32_bf16 v[156:159], a[100:103], a[44:47], v[156:159]
ds_read_b128 a[132:135], v5 offset:19456
v_mul_f32 v221, v221, v89
v_mfma_f32_16x16x32_bf16 v[156:159], a[96:99], a[40:43], v[156:159]
v_cvt_pk_bf16_f32 v220, v220, v221
v_mul_f32 v222, v222, v89
v_mfma_f32_16x16x32_bf16 v[180:183], a[96:99], a[48:51], v[180:183]
v_mul_f32 v223, v223, v89
v_cvt_pk_bf16_f32 v221, v222, v223
v_mfma_f32_16x16x32_bf16 v[180:183], a[100:103], a[52:55], v[180:183]
ds_read_b128 a[136:139], v5 offset:25600
v_mul_f32 v224, v224, v89
v_mfma_f32_16x16x32_bf16 v[204:207], a[100:103], a[60:63], v[204:207]
v_mul_f32 v225, v225, v89
v_cvt_pk_bf16_f32 v222, v224, v225
v_mfma_f32_16x16x32_bf16 v[204:207], a[96:99], a[56:59], v[204:207]
v_mul_f32 v226, v226, v89
v_mul_f32 v227, v227, v89
v_mfma_f32_16x16x32_bf16 v[204:207], a[104:107], a[88:91], v[204:207]
ds_read_b128 a[140:143], v5 offset:31744
v_cvt_pk_bf16_f32 v223, v226, v227
v_mfma_f32_16x16x32_bf16 v[204:207], a[108:111], a[92:95], v[204:207]
buffer_store_dwordx4 a[208:211], v1, s[4:7], s97 offen offset:2048 sc1
v_mfma_f32_16x16x32_bf16 v[180:183], a[108:111], a[84:87], v[180:183]
ds_read_b128 a[144:147], v5 offset:37888
v_mul_f32 v200, v200, v87
v_mfma_f32_16x16x32_bf16 v[180:183], a[104:107], a[80:83], v[180:183]
v_mul_f32 v201, v201, v87
v_cvt_pk_bf16_f32 v198, v200, v201
v_mfma_f32_16x16x32_bf16 v[156:159], a[104:107], a[72:75], v[156:159]
v_mul_f32 v202, v202, v87
v_mul_f32 v203, v203, v87
v_mfma_f32_16x16x32_bf16 v[156:159], a[108:111], a[76:79], v[156:159]
ds_read_b128 a[148:151], v5 offset:44032
v_cvt_pk_bf16_f32 v199, v202, v203
v_mfma_f32_16x16x32_bf16 v[132:135], a[108:111], a[68:71], v[132:135]
v_mul_f32 v174, v174, v85
v_mul_f32 v175, v175, v85
v_mfma_f32_16x16x32_bf16 v[132:135], a[104:107], a[64:67], v[132:135]
v_cvt_pk_bf16_f32 v173, v174, v175
v_mul_f32 v176, v176, v85
v_mfma_f32_16x16x32_bf16 v[132:135], a[112:115], a[0:3], v[132:135]
v_mul_f32 v177, v177, v85
v_cvt_pk_bf16_f32 v174, v176, v177
v_mfma_f32_16x16x32_bf16 v[132:135], a[116:119], a[4:7], v[132:135]
buffer_store_dwordx4 v[236:239], v254, s[4:7], s98 offen offset:0 sc1
v_mfma_f32_16x16x32_bf16 v[156:159], a[116:119], a[12:15], v[156:159]
v_mul_f32 v178, v178, v85
v_mul_f32 v179, v179, v85
v_mfma_f32_16x16x32_bf16 v[156:159], a[112:115], a[8:11], v[156:159]
v_cvt_pk_bf16_f32 v175, v178, v179
v_mul_f32 v150, v150, v83
v_mfma_f32_16x16x32_bf16 v[180:183], a[112:115], a[16:19], v[180:183]
v_mul_f32 v151, v151, v83
v_cvt_pk_bf16_f32 v149, v150, v151
v_mfma_f32_16x16x32_bf16 v[180:183], a[116:119], a[20:23], v[180:183]
v_mul_f32 v152, v152, v83
v_mul_f32 v153, v153, v83
v_mfma_f32_16x16x32_bf16 v[204:207], a[116:119], a[28:31], v[204:207]
v_cvt_pk_bf16_f32 v150, v152, v153
v_mul_f32 v154, v154, v83
v_mfma_f32_16x16x32_bf16 v[204:207], a[112:115], a[24:27], v[204:207]
s_waitcnt lgkmcnt(0)
s_barrier
v_mfma_f32_16x16x32_bf16 v[208:211], a[128:131], a[56:59], v[208:211]
ds_read_b128 v[92:95], v235 offset:0
v_mul_f32 v155, v155, v83
v_mfma_f32_16x16x32_bf16 v[208:211], a[132:135], a[60:63], v[208:211]
buffer_store_dwordx4 v[240:243], v254, s[4:7], s98 offen offset:2048 sc1
v_mfma_f32_16x16x32_bf16 v[184:187], a[132:135], a[52:55], v[184:187]
ds_read_b128 v[96:99], v235 offset:4096
v_cvt_pk_bf16_f32 v151, v154, v155
v_mfma_f32_16x16x32_bf16 v[184:187], a[128:131], a[48:51], v[184:187]
ds_write_b128 v233, v[212:215] offset:21504
v_cvt_pk_bf16_f32 v132, v132, v133
v_mfma_f32_16x16x32_bf16 v[160:163], a[128:131], a[40:43], v[160:163]
ds_read_b128 v[100:103], v235 offset:8192
v_cvt_pk_bf16_f32 v156, v156, v157
v_mfma_f32_16x16x32_bf16 v[160:163], a[132:135], a[44:47], v[160:163]
ds_write_b64 v232, v[220:221] offset:4096
v_cvt_pk_bf16_f32 v180, v180, v181
v_mfma_f32_16x16x32_bf16 v[136:139], a[132:135], a[36:39], v[136:139]
ds_read_b128 v[104:107], v235 offset:12288
v_cvt_pk_bf16_f32 v204, v204, v205
v_mfma_f32_16x16x32_bf16 v[136:139], a[128:131], a[32:35], v[136:139]
ds_write_b64 v232, v[222:223] offset:4608
v_cvt_pk_bf16_f32 v133, v134, v135
v_mfma_f32_16x16x32_bf16 v[136:139], a[136:139], a[64:67], v[136:139]
ds_write_b64 v232, v[196:197] offset:3072
v_cvt_pk_bf16_f32 v157, v158, v159
v_mfma_f32_16x16x32_bf16 v[136:139], a[140:143], a[68:71], v[136:139]
ds_write_b64 v232, v[198:199] offset:3584
v_cvt_pk_bf16_f32 v181, v182, v183
v_mfma_f32_16x16x32_bf16 v[160:163], a[140:143], a[76:79], v[160:163]
ds_write_b64 v232, v[172:173] offset:2048
s_waitcnt lgkmcnt(8)
v_add_f32 v92, v92, v96
v_mfma_f32_16x16x32_bf16 v[160:163], a[136:139], a[72:75], v[160:163]
ds_write_b64 v232, v[174:175] offset:2560
v_add_f32 v93, v93, v97
v_mfma_f32_16x16x32_bf16 v[184:187], a[136:139], a[80:83], v[184:187]
ds_write_b64 v232, v[148:149] offset:1024
v_add_f32 v94, v94, v98
v_mfma_f32_16x16x32_bf16 v[184:187], a[140:143], a[84:87], v[184:187]
buffer_store_dwordx4 v[244:247], v254, s[4:7], s99 offen offset:0 sc1
v_mfma_f32_16x16x32_bf16 v[208:211], a[140:143], a[92:95], v[208:211]
s_waitcnt lgkmcnt(6)
v_add_f32 v100, v100, v104
v_add_f32 v101, v101, v105
v_mfma_f32_16x16x32_bf16 v[208:211], a[136:139], a[88:91], v[208:211]
v_add_f32 v102, v102, v106
v_add_f32 v95, v95, v99
v_mfma_f32_16x16x32_bf16 v[208:211], a[144:147], a[24:27], v[208:211]
v_add_f32 v103, v103, v107
v_add_f32 v228, v92, v100
v_mfma_f32_16x16x32_bf16 v[208:211], a[148:151], a[28:31], v[208:211]
v_add_f32 v229, v93, v101
v_add_f32 v230, v94, v102
v_mfma_f32_16x16x32_bf16 v[184:187], a[148:151], a[20:23], v[184:187]
ds_write_b64 v232, v[150:151] offset:1536
v_add_f32 v231, v95, v103
v_mfma_f32_16x16x32_bf16 v[184:187], a[144:147], a[16:19], v[184:187]
v_fmac_f32 v228, v72, v90
v_fmac_f32 v229, v73, v90
v_mfma_f32_16x16x32_bf16 v[160:163], a[144:147], a[8:11], v[160:163]
v_fmac_f32 v230, v74, v90
v_fmac_f32 v231, v75, v90
v_mfma_f32_16x16x32_bf16 v[160:163], a[148:151], a[12:15], v[160:163]
v_cvt_pk_bf16_f32 v205, v206, v207
v_mul_f32 v228, v228, v91
v_mfma_f32_16x16x32_bf16 v[136:139], a[148:151], a[4:7], v[136:139]
v_mul_f32 v229, v229, v91
v_cvt_pk_bf16_f32 v228, v228, v229
v_mfma_f32_16x16x32_bf16 v[136:139], a[144:147], a[0:3], v[136:139]
v_mul_f32 v230, v230, v91
v_mul_f32 v231, v231, v91
s_add_u32 m0, s19, 32768
s_add_u32 s44, s84, 0xa00000
buffer_load_dwordx4 v1, s[4:7], s44 offen offset:0 sc1 lds
v_cvt_pk_bf16_f32 v229, v230, v231
v_pk_mul_f32 v[190:191], v[190:191], v[86:87] op_sel:[0,1] op_sel_hi:[1,1]
v_pk_mul_f32 v[166:167], v[166:167], v[84:85] op_sel:[0,1] op_sel_hi:[1,1]
v_pk_mul_f32 v[142:143], v[142:143], v[82:83] op_sel:[0,1] op_sel_hi:[1,1]
v_pk_mul_f32 v[192:193], v[192:193], v[86:87] op_sel:[0,1] op_sel_hi:[1,1]
v_pk_mul_f32 v[194:195], v[194:195], v[86:87] op_sel:[0,1] op_sel_hi:[1,1]
v_pk_mul_f32 v[168:169], v[168:169], v[84:85] op_sel:[0,1] op_sel_hi:[1,1]
v_pk_mul_f32 v[170:171], v[170:171], v[84:85] op_sel:[0,1] op_sel_hi:[1,1]
v_pk_mul_f32 v[144:145], v[144:145], v[82:83] op_sel:[0,1] op_sel_hi:[1,1]
v_pk_mul_f32 v[146:147], v[146:147], v[82:83] op_sel:[0,1] op_sel_hi:[1,1]
ds_write_b64 v9, v[228:229]
v_cvt_pk_bf16_f32 v189, v190, v191
v_cvt_pk_bf16_f32 v165, v166, v167
v_cvt_pk_bf16_f32 v141, v142, v143
v_cvt_pk_bf16_f32 v190, v192, v193
v_cvt_pk_bf16_f32 v191, v194, v195
v_cvt_pk_bf16_f32 v166, v168, v169
v_cvt_pk_bf16_f32 v167, v170, v171
v_cvt_pk_bf16_f32 v142, v144, v145
v_cvt_pk_bf16_f32 v143, v146, v147
v_cvt_pk_bf16_f32 v134, v136, v137
v_cvt_pk_bf16_f32 v135, v138, v139
v_cvt_pk_bf16_f32 v158, v160, v161
v_cvt_pk_bf16_f32 v159, v162, v163
v_cvt_pk_bf16_f32 v182, v184, v185
buffer_load_dwordx4 v1, s[4:7], s44 offen offset:1024 sc1 lds
v_cvt_pk_bf16_f32 v183, v186, v187
v_cvt_pk_bf16_f32 v206, v208, v209
v_cvt_pk_bf16_f32 v207, v210, v211
buffer_load_dwordx4 v1, s[4:7], s44 offen offset:2048 sc1 lds
buffer_load_dwordx4 v1, s[4:7], s44 offen offset:3072 sc1 lds
s_add_u32 m0, s19, 98304
s_add_u32 s44, s84, 0xa10000
buffer_load_dwordx4 v1, s[4:7], s44 offen offset:0 sc1 lds
buffer_load_dwordx4 v1, s[4:7], s44 offen offset:1024 sc1 lds
buffer_load_dwordx4 v1, s[4:7], s44 offen offset:2048 sc1 lds
buffer_load_dwordx4 v1, s[4:7], s44 offen offset:3072 sc1 lds
s_waitcnt lgkmcnt(0)
s_barrier
s_add_u32 m0, s19, 114688
s_add_u32 s44, s85, 0xa14000
buffer_load_dwordx4 v1, s[4:7], s44 offen offset:0 sc1 lds
v_mfma_f32_16x16x32_bf16 v[184:187], v[164:167], v[180:183], v[20:23]
ds_read_b128 a[0:3], v233 offset:20480
v_mfma_f32_16x16x32_bf16 v[200:203], v[188:191], v[180:183], v[24:27]
ds_read_b64_tr_b16 a[10:11], v248 offset:3072
v_mfma_f32_16x16x32_bf16 v[208:211], v[188:191], v[204:207], v[20:23]
ds_read_b64_tr_b16 a[12:13], v248 offset:4096
v_mfma_f32_16x16x32_bf16 v[224:227], v[212:215], v[204:207], v[24:27]
s_nop 3
v_max_f32 v200, v200, v184
v_max_f32 v201, v201, v185
v_max_f32 v202, v202, v186
v_max_f32 v203, v203, v187
v_max3_f32 v238, v200, v201, v202
v_max_f32 v238, v238, v203
ds_read_b64_tr_b16 a[22:23], v248 offset:3584
v_max_f32 v224, v224, v208
v_max_f32 v225, v225, v209
v_max_f32 v226, v226, v210
v_max_f32 v227, v227, v211
v_max3_f32 v239, v224, v225, v226
buffer_load_dwordx4 v1, s[4:7], s44 offen offset:1024 sc1 lds
v_max_f32 v239, v239, v227
ds_read_b64_tr_b16 a[24:25], v248 offset:4608
s_nop 0
v_permlane32_swap_b32 v239, v238
v_max_f32 v239, v239, v238
v_mov_b32 v242, v239
s_waitcnt lgkmcnt(4)
v_mfma_f32_16x16x32_bf16 v[136:139], a[0:3], v[132:135], v[76:79]
v_permlane16_swap_b32 v239, v242
v_max_f32 v239, v239, v242
v_mov_b32 v242, v239
v_mfma_f32_16x16x32_bf16 v[152:155], v[140:143], v[132:135], v[24:27]
s_nop 0
v_permlane32_swap_b32 v239, v242
v_mfma_f32_16x16x32_bf16 v[160:163], v[140:143], v[156:159], v[20:23]
v_mul_f32_e64 v89, -v239, v88
v_fma_f32 v224, v224, v88, v89
v_mfma_f32_16x16x32_bf16 v[176:179], v[164:167], v[156:159], v[24:27]
v_fma_f32 v225, v225, v88, v89
v_fma_f32 v226, v226, v88, v89
v_fma_f32 v227, v227, v88, v89
v_exp_f32 v224, v224
buffer_load_dwordx4 v1, s[4:7], s44 offen offset:2048 sc1 lds
v_exp_f32 v225, v225
v_exp_f32 v226, v226
v_exp_f32 v227, v227
v_max_f32 v152, v152, v136
v_max_f32 v153, v153, v137
v_max_f32 v154, v154, v138
v_max_f32 v176, v176, v160
v_max_f32 v177, v177, v161
v_max_f32 v178, v178, v162
v_cvt_pk_bf16_f32 v224, v224, v225
ds_read_b64_tr_b16 a[8:9], v248 offset:2048
v_max_f32 v155, v155, v139
v_max3_f32 v236, v152, v153, v154
v_max_f32 v179, v179, v163
v_max3_f32 v237, v176, v177, v178
v_cvt_pk_bf16_f32 v225, v226, v227
ds_read_b64_tr_b16 a[20:21], v248 offset:2560
v_max_f32 v236, v236, v155
v_max_f32 v237, v237, v179
v_and_b32 v208, v224, v28
v_and_b32 v209, v225, v29
v_and_b32 v210, v224, v30
buffer_load_dwordx4 v1, s[4:7], s44 offen offset:3072 sc1 lds
s_add_u32 m0, s19, 131072
s_add_u32 s44, s86, 0xa18000
v_and_b32 v211, v225, v31
v_permlane32_swap_b32 v237, v236
s_nop 0
v_mfma_f32_16x16x32_bf16 v[216:219], v[16:19], v[208:211], 0
v_max_f32 v237, v237, v236
v_mul_f32_e64 v87, -v242, v86
s_waitcnt lgkmcnt(4)
v_mfma_f32_16x16x32_bf16 v[116:119], a[10:13], v[208:211], 0
v_mov_b32 v243, v237
v_fma_f32 v200, v200, v86, v87
v_fma_f32 v201, v201, v86, v87
v_fma_f32 v202, v202, v86, v87
v_fma_f32 v203, v203, v86, v87
s_waitcnt lgkmcnt(2)
v_mfma_f32_16x16x32_bf16 v[120:123], a[22:25], v[208:211], 0
v_exp_f32 v200, v200
v_exp_f32 v201, v201
v_exp_f32 v202, v202
v_exp_f32 v203, v203
v_permlane16_swap_b32 v237, v243
buffer_load_dwordx4 v1, s[4:7], s44 offen offset:0 sc1 lds
v_rcp_f32 v216, v216
v_cvt_pk_bf16_f32 v200, v200, v201
ds_read_b64_tr_b16 a[6:7], v248 offset:1024
v_max_f32 v237, v237, v243
v_cvt_pk_bf16_f32 v201, v202, v203
ds_read_b64_tr_b16 a[18:19], v248 offset:1536
v_mov_b32 v243, v237
v_and_b32 v184, v200, v28
v_and_b32 v185, v201, v29
v_and_b32 v186, v200, v30
v_and_b32 v187, v201, v31
v_pk_mul_f32 v[116:117], v[116:117], v[216:217] op_sel:[0,0] op_sel_hi:[1,0]
v_pk_mul_f32 v[118:119], v[118:119], v[216:217] op_sel:[0,0] op_sel_hi:[1,0]
v_cvt_pk_bf16_f32 v116, v116, v117
v_pk_mul_f32 v[120:121], v[120:121], v[216:217] op_sel:[0,0] op_sel_hi:[1,0]
v_permlane32_swap_b32 v237, v243
v_pk_mul_f32 v[122:123], v[122:123], v[216:217] op_sel:[0,0] op_sel_hi:[1,0]
v_cvt_pk_bf16_f32 v117, v118, v119
v_mfma_f32_16x16x32_bf16 v[192:195], v[16:19], v[184:187], 0
v_cvt_pk_bf16_f32 v118, v120, v121
v_cvt_pk_bf16_f32 v119, v122, v123
v_mul_f32_e64 v85, -v237, v84
buffer_load_dwordx4 v1, s[4:7], s44 offen offset:1024 sc1 lds
s_waitcnt lgkmcnt(3)
v_mfma_f32_16x16x32_bf16 v[108:111], a[8:11], v[184:187], 0
v_fma_f32 v176, v176, v84, v85
v_fma_f32 v177, v177, v84, v85
v_fma_f32 v178, v178, v84, v85
v_fma_f32 v179, v179, v84, v85
s_waitcnt lgkmcnt(2)
v_mfma_f32_16x16x32_bf16 v[112:115], a[20:23], v[184:187], 0
v_exp_f32 v176, v176
v_exp_f32 v177, v177
v_exp_f32 v178, v178
v_exp_f32 v179, v179
v_rcp_f32 v192, v192
v_cvt_pk_bf16_f32 v176, v176, v177
ds_read_b64_tr_b16 a[4:5], v248 offset:0
v_cvt_pk_bf16_f32 v177, v178, v179
ds_read_b64_tr_b16 a[16:17], v248 offset:512
v_and_b32 v160, v176, v28
v_and_b32 v161, v177, v29
v_and_b32 v162, v176, v30
buffer_load_dwordx4 v1, s[4:7], s44 offen offset:2048 sc1 lds
v_and_b32 v163, v177, v31
v_pk_mul_f32 v[108:109], v[108:109], v[192:193] op_sel:[0,0] op_sel_hi:[1,0]
v_pk_mul_f32 v[110:111], v[110:111], v[192:193] op_sel:[0,0] op_sel_hi:[1,0]
v_cvt_pk_bf16_f32 v108, v108, v109
v_pk_mul_f32 v[112:113], v[112:113], v[192:193] op_sel:[0,0] op_sel_hi:[1,0]
v_cvt_pk_bf16_f32 v109, v110, v111
v_pk_mul_f32 v[114:115], v[114:115], v[192:193] op_sel:[0,0] op_sel_hi:[1,0]
v_cvt_pk_bf16_f32 v110, v112, v113
v_mfma_f32_16x16x32_bf16 v[168:171], v[16:19], v[160:163], 0
v_cvt_pk_bf16_f32 v111, v114, v115
v_mul_f32_e64 v83, -v243, v82
s_waitcnt lgkmcnt(3)
v_mfma_f32_16x16x32_bf16 v[100:103], a[6:9], v[160:163], 0
v_fma_f32 v152, v152, v82, v83
v_fma_f32 v153, v153, v82, v83
v_fma_f32 v154, v154, v82, v83
v_fma_f32 v155, v155, v82, v83
s_waitcnt lgkmcnt(2)
v_mfma_f32_16x16x32_bf16 v[104:107], a[18:21], v[160:163], 0
v_exp_f32 v152, v152
v_exp_f32 v153, v153
v_exp_f32 v154, v154
v_exp_f32 v155, v155
buffer_load_dwordx4 v1, s[4:7], s44 offen offset:3072 sc1 lds
v_rcp_f32 v168, v168
v_cvt_pk_bf16_f32 v152, v152, v153
v_cvt_pk_bf16_f32 v153, v154, v155
v_and_b32 v136, v152, v80
v_and_b32 v137, v153, v81
v_and_b32 v138, v152, v30
v_and_b32 v139, v153, v31
v_pk_mul_f32 v[100:101], v[100:101], v[168:169] op_sel:[0,0] op_sel_hi:[1,0]
v_pk_mul_f32 v[102:103], v[102:103], v[168:169] op_sel:[0,0] op_sel_hi:[1,0]
v_cvt_pk_bf16_f32 v100, v100, v101
v_pk_mul_f32 v[104:105], v[104:105], v[168:169] op_sel:[0,0] op_sel_hi:[1,0]
v_cvt_pk_bf16_f32 v101, v102, v103
v_pk_mul_f32 v[106:107], v[106:107], v[168:169] op_sel:[0,0] op_sel_hi:[1,0]
v_cvt_pk_bf16_f32 v102, v104, v105
v_mfma_f32_16x16x32_bf16 v[144:147], v[16:19], v[136:139], 0
v_cvt_pk_bf16_f32 v103, v106, v107
s_waitcnt lgkmcnt(1)
v_mfma_f32_16x16x32_bf16 v[92:95], a[4:7], v[136:139], 0
s_waitcnt lgkmcnt(0)
v_mfma_f32_16x16x32_bf16 v[96:99], a[16:19], v[136:139], 0
s_nop 2
v_rcp_f32 v144, v144
buffer_store_dwordx4 v[116:119], v2, s[4:7], s72 offen offset:3072 sc1
s_nop 0
v_pk_mul_f32 v[92:93], v[92:93], v[144:145] op_sel:[0,0] op_sel_hi:[1,0]
v_pk_mul_f32 v[94:95], v[94:95], v[144:145] op_sel:[0,0] op_sel_hi:[1,0]
v_cvt_pk_bf16_f32 v92, v92, v93
v_pk_mul_f32 v[96:97], v[96:97], v[144:145] op_sel:[0,0] op_sel_hi:[1,0]
v_pk_mul_f32 v[98:99], v[98:99], v[144:145] op_sel:[0,0] op_sel_hi:[1,0]
v_cvt_pk_bf16_f32 v93, v94, v95
v_cvt_pk_bf16_f32 v94, v96, v97
v_cvt_pk_bf16_f32 v95, v98, v99
buffer_store_dwordx4 v[108:111], v2, s[4:7], s72 offen offset:2048 sc1
buffer_store_dwordx4 v[100:103], v2, s[4:7], s72 offen offset:1024 sc1
buffer_store_dwordx4 v[92:95], v2, s[4:7], s72 offen offset:0 sc1
s_add_u32 s92, s71, 0x0
v_accvgpr_write_b32 a188, v48
v_accvgpr_write_b32 a189, v49
v_accvgpr_write_b32 a190, v50
v_accvgpr_write_b32 a191, v51
v_accvgpr_write_b32 a192, v52
v_accvgpr_write_b32 a193, v53
v_accvgpr_write_b32 a194, v54
v_accvgpr_write_b32 a195, v55
v_accvgpr_write_b32 a196, v56
v_accvgpr_write_b32 a197, v57
v_accvgpr_write_b32 a198, v58
v_accvgpr_write_b32 a199, v59
v_accvgpr_write_b32 a200, v60
v_accvgpr_write_b32 a201, v61
v_accvgpr_write_b32 a202, v62
v_accvgpr_write_b32 a203, v63
v_accvgpr_write_b32 a204, v64
v_accvgpr_write_b32 a205, v65
v_accvgpr_write_b32 a206, v66
v_accvgpr_write_b32 a207, v67
v_accvgpr_write_b32 a208, v68
v_accvgpr_write_b32 a209, v69
v_accvgpr_write_b32 a210, v70
v_accvgpr_write_b32 a211, v71
v_accvgpr_write_b32 a212, v72
v_accvgpr_write_b32 a213, v73
v_accvgpr_write_b32 a214, v74
v_accvgpr_write_b32 a215, v75
s_add_u32 s40, s4, 0x1e00000
s_addc_u32 s41, s5, 0
v_add_u32 v5, 32768, v1
v_add_u32 v6, 98304, v1
s_cmp_eq_u32 s3, 0
s_cselect_b32 s35, 8, 0
s_lshl_b32 s35, s35, 12
v_lshlrev_b32 v132, 16, v32
v_and_b32 v133, 0xffff0000, v32
v_lshlrev_b32 v134, 16, v33
v_and_b32 v135, 0xffff0000, v33
v_lshlrev_b32 v136, 16, v34
v_and_b32 v137, 0xffff0000, v34
v_lshlrev_b32 v138, 16, v35
v_and_b32 v139, 0xffff0000, v35
v_lshlrev_b32 v140, 16, v36
v_and_b32 v141, 0xffff0000, v36
v_lshlrev_b32 v142, 16, v37
v_and_b32 v143, 0xffff0000, v37
v_lshlrev_b32 v144, 16, v38
v_and_b32 v145, 0xffff0000, v38
v_lshlrev_b32 v146, 16, v39
v_and_b32 v147, 0xffff0000, v39
v_lshlrev_b32 v148, 16, v40
v_and_b32 v149, 0xffff0000, v40
v_lshlrev_b32 v150, 16, v41
v_and_b32 v151, 0xffff0000, v41
v_lshlrev_b32 v152, 16, v42
v_and_b32 v153, 0xffff0000, v42
v_lshlrev_b32 v154, 16, v43
v_and_b32 v155, 0xffff0000, v43
v_lshlrev_b32 v156, 16, v44
v_and_b32 v157, 0xffff0000, v44
v_lshlrev_b32 v158, 16, v45
v_and_b32 v159, 0xffff0000, v45
v_lshlrev_b32 v160, 16, v46
v_and_b32 v161, 0xffff0000, v46
v_lshlrev_b32 v162, 16, v47
v_and_b32 v163, 0xffff0000, v47
s_waitcnt vmcnt(0)
s_barrier
s_cmp_lg_u32 s28, 1
s_cbranch_scc1 Lsg_4
buffer_atomic_add v12, v10, s[4:7], s92 offen sc1
buffer_atomic_swap v15, v14, s[4:7], s8 offen sc1
buffer_atomic_swap v15, v252, s[4:7], s62 offen offset:64 sc1
Lsg_4:
s_mov_b64 exec, 0
s_cmp_eq_u32 s28, 1
s_cbranch_scc1 L_stub3
L_wret1:
s_mov_b64 exec, -1
s_add_u32 m0, s19, 147456
s_add_u32 s44, s87, 0xa1c000
buffer_load_dwordx4 v1, s[4:7], s44 offen offset:0 sc1 lds
buffer_load_dwordx4 v1, s[4:7], s44 offen offset:1024 sc1 lds
buffer_load_dwordx4 v1, s[4:7], s44 offen offset:2048 sc1 lds
buffer_load_dwordx4 v1, s[4:7], s44 offen offset:3072 sc1 lds
s_cmp_lg_u32 s28, 0
s_cbranch_scc1 Lpe_6
s_add_u32 s36, s66, 0x0
s_mov_b32 s37, 0
Lpoll_5:
v_mov_b32 v11, 0
buffer_atomic_add v11, v251, s[4:7], s36 offen sc0 sc1
s_add_u32 s37, s37, 1
s_waitcnt vmcnt(0)
v_readfirstlane_b32 s38, v11
s_nop 0
s_cmp_ge_u32 s38, 32
s_cbranch_scc1 Lpe_6
s_cmp_lt_u32 s37, 0x100000
s_cbranch_scc1 Lpoll_5
Lpe_6:
s_waitcnt vmcnt(0)
s_barrier
L_k2go0:
buffer_load_dwordx4 a[0:3], v4, s[40:43], s35 offen offset:0 sc1
buffer_load_dwordx4 a[4:7], v4, s[40:43], s35 offen offset:1024 sc1
s_cmp_eq_u32 s3, 1
s_cselect_b32 s35, 9, 1
s_lshl_b32 s35, s35, 12
buffer_load_dwordx4 a[8:11], v4, s[40:43], s35 offen offset:0 sc1
buffer_load_dwordx4 a[12:15], v4, s[40:43], s35 offen offset:1024 sc1
s_cmp_eq_u32 s3, 2
s_cselect_b32 s35, 10, 2
s_lshl_b32 s35, s35, 12
buffer_load_dwordx4 a[16:19], v4, s[40:43], s35 offen offset:0 sc1
buffer_load_dwordx4 a[20:23], v4, s[40:43], s35 offen offset:1024 sc1
s_cmp_eq_u32 s3, 3
s_cselect_b32 s35, 11, 3
s_lshl_b32 s35, s35, 12
buffer_load_dwordx4 a[24:27], v4, s[40:43], s35 offen offset:0 sc1
buffer_load_dwordx4 a[28:31], v4, s[40:43], s35 offen offset:1024 sc1
s_cmp_eq_u32 s3, 4
s_cselect_b32 s35, 12, 4
s_lshl_b32 s35, s35, 12
buffer_load_dwordx4 a[32:35], v4, s[40:43], s35 offen offset:0 sc1
buffer_load_dwordx4 a[36:39], v4, s[40:43], s35 offen offset:1024 sc1
s_cmp_eq_u32 s3, 5
s_cselect_b32 s35, 13, 5
s_lshl_b32 s35, s35, 12
ds_read_b128 a[96:99], v5 offset:0
ds_read_b128 a[100:103], v5 offset:1024
ds_read_b128 a[104:107], v5 offset:2048
ds_read_b128 a[108:111], v5 offset:3072
ds_read_b128 a[112:115], v5 offset:4096
ds_read_b128 a[116:119], v5 offset:5120
ds_read_b128 a[120:123], v5 offset:6144
ds_read_b128 a[124:127], v5 offset:7168
s_waitcnt vmcnt(8) lgkmcnt(4)
v_mfma_f32_16x16x32_bf16 v[132:135], a[96:99], a[0:3], v[132:135]
ds_read_b128 a[128:131], v5 offset:8192
v_mfma_f32_16x16x32_bf16 v[148:151], a[96:99], a[4:7], v[148:151]
ds_read_b128 a[132:135], v5 offset:9216
v_mfma_f32_16x16x32_bf16 v[152:155], a[100:103], a[4:7], v[152:155]
buffer_load_dwordx4 a[40:43], v4, s[40:43], s35 offen offset:0 sc1
v_mfma_f32_16x16x32_bf16 v[136:139], a[100:103], a[0:3], v[136:139]
ds_read_b128 a[136:139], v5 offset:10240
v_mfma_f32_16x16x32_bf16 v[140:143], a[104:107], a[0:3], v[140:143]
ds_read_b128 a[140:143], v5 offset:11264
v_mfma_f32_16x16x32_bf16 v[156:159], a[104:107], a[4:7], v[156:159]
v_mfma_f32_16x16x32_bf16 v[160:163], a[108:111], a[4:7], v[160:163]
buffer_load_dwordx4 a[44:47], v4, s[40:43], s35 offen offset:1024 sc1
v_mfma_f32_16x16x32_bf16 v[144:147], a[108:111], a[0:3], v[144:147]
s_waitcnt vmcnt(8) lgkmcnt(4)
v_mfma_f32_16x16x32_bf16 v[132:135], a[112:115], a[8:11], v[132:135]
s_cmp_eq_u32 s3, 6
s_cselect_b32 s35, 14, 6
s_lshl_b32 s35, s35, 12
v_mfma_f32_16x16x32_bf16 v[148:151], a[112:115], a[12:15], v[148:151]
ds_read_b128 a[96:99], v5 offset:12288
v_mfma_f32_16x16x32_bf16 v[152:155], a[116:119], a[12:15], v[152:155]
buffer_load_dwordx4 a[0:3], v4, s[40:43], s35 offen offset:0 sc1
v_mfma_f32_16x16x32_bf16 v[136:139], a[116:119], a[8:11], v[136:139]
ds_read_b128 a[100:103], v5 offset:13312
v_mfma_f32_16x16x32_bf16 v[140:143], a[120:123], a[8:11], v[140:143]
ds_read_b128 a[104:107], v5 offset:14336
v_mfma_f32_16x16x32_bf16 v[156:159], a[120:123], a[12:15], v[156:159]
ds_read_b128 a[108:111], v5 offset:15360
v_mfma_f32_16x16x32_bf16 v[160:163], a[124:127], a[12:15], v[160:163]
buffer_load_dwordx4 a[4:7], v4, s[40:43], s35 offen offset:1024 sc1
v_mfma_f32_16x16x32_bf16 v[144:147], a[124:127], a[8:11], v[144:147]
s_waitcnt vmcnt(8) lgkmcnt(4)
v_mfma_f32_16x16x32_bf16 v[132:135], a[128:131], a[16:19], v[132:135]
s_cmp_eq_u32 s3, 7
s_cselect_b32 s35, 15, 7
s_lshl_b32 s35, s35, 12
v_mfma_f32_16x16x32_bf16 v[148:151], a[128:131], a[20:23], v[148:151]
L_stub3:
s_cbranch_execz L_stub4
ds_read_b128 a[112:115], v5 offset:16384
v_mfma_f32_16x16x32_bf16 v[152:155], a[132:135], a[20:23], v[152:155]
buffer_load_dwordx4 a[8:11], v4, s[40:43], s35 offen offset:0 sc1
v_mfma_f32_16x16x32_bf16 v[136:139], a[132:135], a[16:19], v[136:139]
ds_read_b128 a[116:119], v5 offset:17408
v_mfma_f32_16x16x32_bf16 v[140:143], a[136:139], a[16:19], v[140:143]
ds_read_b128 a[120:123], v5 offset:18432
v_mfma_f32_16x16x32_bf16 v[156:159], a[136:139], a[20:23], v[156:159]
ds_read_b128 a[124:127], v5 offset:19456
v_mfma_f32_16x16x32_bf16 v[160:163], a[140:143], a[20:23], v[160:163]
buffer_load_dwordx4 a[12:15], v4, s[40:43], s35 offen offset:1024 sc1
v_mfma_f32_16x16x32_bf16 v[144:147], a[140:143], a[16:19], v[144:147]
s_waitcnt vmcnt(8) lgkmcnt(4)
v_mfma_f32_16x16x32_bf16 v[132:135], a[96:99], a[24:27], v[132:135]
s_cmp_eq_u32 s3, 0
s_cselect_b32 s35, 16, 8
s_lshl_b32 s35, s35, 12
v_mfma_f32_16x16x32_bf16 v[148:151], a[96:99], a[28:31], v[148:151]
ds_read_b128 a[128:131], v5 offset:20480
v_mfma_f32_16x16x32_bf16 v[152:155], a[100:103], a[28:31], v[152:155]
buffer_load_dwordx4 a[16:19], v4, s[40:43], s35 offen offset:0 sc1
v_mfma_f32_16x16x32_bf16 v[136:139], a[100:103], a[24:27], v[136:139]
ds_read_b128 a[132:135], v5 offset:21504
v_mfma_f32_16x16x32_bf16 v[140:143], a[104:107], a[24:27], v[140:143]
ds_read_b128 a[136:139], v5 offset:22528
v_mfma_f32_16x16x32_bf16 v[156:159], a[104:107], a[28:31], v[156:159]
ds_read_b128 a[140:143], v5 offset:23552
v_mfma_f32_16x16x32_bf16 v[160:163], a[108:111], a[28:31], v[160:163]
buffer_load_dwordx4 a[20:23], v4, s[40:43], s35 offen offset:1024 sc1
v_mfma_f32_16x16x32_bf16 v[144:147], a[108:111], a[24:27], v[144:147]
s_waitcnt vmcnt(8) lgkmcnt(4)
v_mfma_f32_16x16x32_bf16 v[132:135], a[112:115], a[32:35], v[132:135]
s_cmp_eq_u32 s3, 1
s_cselect_b32 s35, 17, 9
s_lshl_b32 s35, s35, 12
v_mfma_f32_16x16x32_bf16 v[148:151], a[112:115], a[36:39], v[148:151]
ds_read_b128 a[96:99], v5 offset:24576
v_mfma_f32_16x16x32_bf16 v[152:155], a[116:119], a[36:39], v[152:155]
buffer_load_dwordx4 a[24:27], v4, s[40:43], s35 offen offset:0 sc1
v_mfma_f32_16x16x32_bf16 v[136:139], a[116:119], a[32:35], v[136:139]
ds_read_b128 a[100:103], v5 offset:25600
v_mfma_f32_16x16x32_bf16 v[140:143], a[120:123], a[32:35], v[140:143]
ds_read_b128 a[104:107], v5 offset:26624
v_mfma_f32_16x16x32_bf16 v[156:159], a[120:123], a[36:39], v[156:159]
ds_read_b128 a[108:111], v5 offset:27648
v_mfma_f32_16x16x32_bf16 v[160:163], a[124:127], a[36:39], v[160:163]
buffer_load_dwordx4 a[28:31], v4, s[40:43], s35 offen offset:1024 sc1
v_mfma_f32_16x16x32_bf16 v[144:147], a[124:127], a[32:35], v[144:147]
s_waitcnt vmcnt(8) lgkmcnt(4)
v_mfma_f32_16x16x32_bf16 v[132:135], a[128:131], a[40:43], v[132:135]
s_cmp_eq_u32 s3, 2
s_cselect_b32 s35, 18, 10
s_lshl_b32 s35, s35, 12
v_mfma_f32_16x16x32_bf16 v[148:151], a[128:131], a[44:47], v[148:151]
ds_read_b128 a[112:115], v5 offset:28672
v_mfma_f32_16x16x32_bf16 v[152:155], a[132:135], a[44:47], v[152:155]
buffer_load_dwordx4 a[32:35], v4, s[40:43], s35 offen offset:0 sc1
v_mfma_f32_16x16x32_bf16 v[136:139], a[132:135], a[40:43], v[136:139]
ds_read_b128 a[116:119], v5 offset:29696
v_mfma_f32_16x16x32_bf16 v[140:143], a[136:139], a[40:43], v[140:143]
ds_read_b128 a[120:123], v5 offset:30720
v_mfma_f32_16x16x32_bf16 v[156:159], a[136:139], a[44:47], v[156:159]
ds_read_b128 a[124:127], v5 offset:31744
v_mfma_f32_16x16x32_bf16 v[160:163], a[140:143], a[44:47], v[160:163]
buffer_load_dwordx4 a[36:39], v4, s[40:43], s35 offen offset:1024 sc1
v_mfma_f32_16x16x32_bf16 v[144:147], a[140:143], a[40:43], v[144:147]
s_waitcnt vmcnt(8) lgkmcnt(4)
v_mfma_f32_16x16x32_bf16 v[132:135], a[96:99], a[0:3], v[132:135]
s_cmp_eq_u32 s3, 3
s_cselect_b32 s35, 19, 11
s_lshl_b32 s35, s35, 12
v_mfma_f32_16x16x32_bf16 v[148:151], a[96:99], a[4:7], v[148:151]
ds_read_b128 a[128:131], v5 offset:32768
v_mfma_f32_16x16x32_bf16 v[152:155], a[100:103], a[4:7], v[152:155]
buffer_load_dwordx4 a[40:43], v4, s[40:43], s35 offen offset:0 sc1
v_mfma_f32_16x16x32_bf16 v[136:139], a[100:103], a[0:3], v[136:139]
ds_read_b128 a[132:135], v5 offset:33792
v_mfma_f32_16x16x32_bf16 v[140:143], a[104:107], a[0:3], v[140:143]
ds_read_b128 a[136:139], v5 offset:34816
v_mfma_f32_16x16x32_bf16 v[156:159], a[104:107], a[4:7], v[156:159]
ds_read_b128 a[140:143], v5 offset:35840
v_mfma_f32_16x16x32_bf16 v[160:163], a[108:111], a[4:7], v[160:163]
buffer_load_dwordx4 a[44:47], v4, s[40:43], s35 offen offset:1024 sc1
v_mfma_f32_16x16x32_bf16 v[144:147], a[108:111], a[0:3], v[144:147]
s_waitcnt vmcnt(8) lgkmcnt(4)
v_mfma_f32_16x16x32_bf16 v[132:135], a[112:115], a[8:11], v[132:135]
s_cmp_eq_u32 s3, 4
s_cselect_b32 s35, 20, 12
s_lshl_b32 s35, s35, 12
v_mfma_f32_16x16x32_bf16 v[148:151], a[112:115], a[12:15], v[148:151]
ds_read_b128 a[96:99], v5 offset:36864
v_mfma_f32_16x16x32_bf16 v[152:155], a[116:119], a[12:15], v[152:155]
buffer_load_dwordx4 a[0:3], v4, s[40:43], s35 offen offset:0 sc1
v_mfma_f32_16x16x32_bf16 v[136:139], a[116:119], a[8:11], v[136:139]
ds_read_b128 a[100:103], v5 offset:37888
v_mfma_f32_16x16x32_bf16 v[140:143], a[120:123], a[8:11], v[140:143]
ds_read_b128 a[104:107], v5 offset:38912
v_mfma_f32_16x16x32_bf16 v[156:159], a[120:123], a[12:15], v[156:159]
ds_read_b128 a[108:111], v5 offset:39936
v_mfma_f32_16x16x32_bf16 v[160:163], a[124:127], a[12:15], v[160:163]
buffer_load_dwordx4 a[4:7], v4, s[40:43], s35 offen offset:1024 sc1
v_mfma_f32_16x16x32_bf16 v[144:147], a[124:127], a[8:11], v[144:147]
s_waitcnt vmcnt(8) lgkmcnt(4)
v_mfma_f32_16x16x32_bf16 v[132:135], a[128:131], a[16:19], v[132:135]
s_cmp_eq_u32 s3, 5
s_cselect_b32 s35, 21, 13
s_lshl_b32 s35, s35, 12
v_mfma_f32_16x16x32_bf16 v[148:151], a[128:131], a[20:23], v[148:151]
ds_read_b128 a[112:115], v5 offset:40960
v_mfma_f32_16x16x32_bf16 v[152:155], a[132:135], a[20:23], v[152:155]
buffer_load_dwordx4 a[8:11], v4, s[40:43], s35 offen offset:0 sc1
v_mfma_f32_16x16x32_bf16 v[136:139], a[132:135], a[16:19], v[136:139]
ds_read_b128 a[116:119], v5 offset:41984
v_mfma_f32_16x16x32_bf16 v[140:143], a[136:139], a[16:19], v[140:143]
ds_read_b128 a[120:123], v5 offset:43008
v_mfma_f32_16x16x32_bf16 v[156:159], a[136:139], a[20:23], v[156:159]
ds_read_b128 a[124:127], v5 offset:44032
v_mfma_f32_16x16x32_bf16 v[160:163], a[140:143], a[20:23], v[160:163]
buffer_load_dwordx4 a[12:15], v4, s[40:43], s35 offen offset:1024 sc1
v_mfma_f32_16x16x32_bf16 v[144:147], a[140:143], a[16:19], v[144:147]
s_waitcnt vmcnt(8) lgkmcnt(4)
v_mfma_f32_16x16x32_bf16 v[132:135], a[96:99], a[24:27], v[132:135]
s_cmp_eq_u32 s3, 6
s_cselect_b32 s35, 22, 14
s_lshl_b32 s35, s35, 12
v_mfma_f32_16x16x32_bf16 v[148:151], a[96:99], a[28:31], v[148:151]
ds_read_b128 a[128:131], v5 offset:45056
v_mfma_f32_16x16x32_bf16 v[152:155], a[100:103], a[28:31], v[152:155]
buffer_load_dwordx4 a[16:19], v4, s[40:43], s35 offen offset:0 sc1
v_mfma_f32_16x16x32_bf16 v[136:139], a[100:103], a[24:27], v[136:139]
ds_read_b128 a[132:135], v5 offset:46080
v_mfma_f32_16x16x32_bf16 v[140:143], a[104:107], a[24:27], v[140:143]
ds_read_b128 a[136:139], v5 offset:47104
v_mfma_f32_16x16x32_bf16 v[156:159], a[104:107], a[28:31], v[156:159]
ds_read_b128 a[140:143], v5 offset:48128
v_mfma_f32_16x16x32_bf16 v[160:163], a[108:111], a[28:31], v[160:163]
buffer_load_dwordx4 a[20:23], v4, s[40:43], s35 offen offset:1024 sc1
v_mfma_f32_16x16x32_bf16 v[144:147], a[108:111], a[24:27], v[144:147]
s_waitcnt vmcnt(8) lgkmcnt(4)
v_mfma_f32_16x16x32_bf16 v[132:135], a[112:115], a[32:35], v[132:135]
s_cmp_eq_u32 s3, 7
s_cselect_b32 s35, 23, 15
s_lshl_b32 s35, s35, 12
v_mfma_f32_16x16x32_bf16 v[148:151], a[112:115], a[36:39], v[148:151]
ds_read_b128 a[96:99], v5 offset:49152
v_mfma_f32_16x16x32_bf16 v[152:155], a[116:119], a[36:39], v[152:155]
buffer_load_dwordx4 a[24:27], v4, s[40:43], s35 offen offset:0 sc1
v_mfma_f32_16x16x32_bf16 v[136:139], a[116:119], a[32:35], v[136:139]
ds_read_b128 a[100:103], v5 offset:50176
v_mfma_f32_16x16x32_bf16 v[140:143], a[120:123], a[32:35], v[140:143]
ds_read_b128 a[104:107], v5 offset:51200
v_mfma_f32_16x16x32_bf16 v[156:159], a[120:123], a[36:39], v[156:159]
ds_read_b128 a[108:111], v5 offset:52224
v_mfma_f32_16x16x32_bf16 v[160:163], a[124:127], a[36:39], v[160:163]
buffer_load_dwordx4 a[28:31], v4, s[40:43], s35 offen offset:1024 sc1
v_mfma_f32_16x16x32_bf16 v[144:147], a[124:127], a[32:35], v[144:147]
s_waitcnt vmcnt(8) lgkmcnt(4)
v_mfma_f32_16x16x32_bf16 v[132:135], a[128:131], a[40:43], v[132:135]
s_cmp_eq_u32 s3, 0
s_cselect_b32 s35, 24, 16
s_lshl_b32 s35, s35, 12
v_mfma_f32_16x16x32_bf16 v[148:151], a[128:131], a[44:47], v[148:151]
ds_read_b128 a[112:115], v5 offset:53248
v_mfma_f32_16x16x32_bf16 v[152:155], a[132:135], a[44:47], v[152:155]
buffer_load_dwordx4 a[32:35], v4, s[40:43], s35 offen offset:0 sc1
v_mfma_f32_16x16x32_bf16 v[136:139], a[132:135], a[40:43], v[136:139]
ds_read_b128 a[116:119], v5 offset:54272
v_mfma_f32_16x16x32_bf16 v[140:143], a[136:139], a[40:43], v[140:143]
ds_read_b128 a[120:123], v5 offset:55296
v_mfma_f32_16x16x32_bf16 v[156:159], a[136:139], a[44:47], v[156:159]
ds_read_b128 a[124:127], v5 offset:56320
v_mfma_f32_16x16x32_bf16 v[160:163], a[140:143], a[44:47], v[160:163]
buffer_load_dwordx4 a[36:39], v4, s[40:43], s35 offen offset:1024 sc1
v_mfma_f32_16x16x32_bf16 v[144:147], a[140:143], a[40:43], v[144:147]
s_waitcnt vmcnt(8) lgkmcnt(4)
v_mfma_f32_16x16x32_bf16 v[132:135], a[96:99], a[0:3], v[132:135]
s_cmp_eq_u32 s3, 1
s_cselect_b32 s35, 25, 17
s_lshl_b32 s35, s35, 12
v_mfma_f32_16x16x32_bf16 v[148:151], a[96:99], a[4:7], v[148:151]
ds_read_b128 a[128:131], v5 offset:57344
v_mfma_f32_16x16x32_bf16 v[152:155], a[100:103], a[4:7], v[152:155]
buffer_load_dwordx4 a[40:43], v4, s[40:43], s35 offen offset:0 sc1
v_mfma_f32_16x16x32_bf16 v[136:139], a[100:103], a[0:3], v[136:139]
ds_read_b128 a[132:135], v5 offset:58368
v_mfma_f32_16x16x32_bf16 v[140:143], a[104:107], a[0:3], v[140:143]
ds_read_b128 a[136:139], v5 offset:59392
v_mfma_f32_16x16x32_bf16 v[156:159], a[104:107], a[4:7], v[156:159]
ds_read_b128 a[140:143], v5 offset:60416
v_mfma_f32_16x16x32_bf16 v[160:163], a[108:111], a[4:7], v[160:163]
buffer_load_dwordx4 a[44:47], v4, s[40:43], s35 offen offset:1024 sc1
v_mfma_f32_16x16x32_bf16 v[144:147], a[108:111], a[0:3], v[144:147]
s_waitcnt vmcnt(8) lgkmcnt(4)
v_mfma_f32_16x16x32_bf16 v[132:135], a[112:115], a[8:11], v[132:135]
s_cmp_eq_u32 s3, 2
s_cselect_b32 s35, 26, 18
s_lshl_b32 s35, s35, 12
v_mfma_f32_16x16x32_bf16 v[148:151], a[112:115], a[12:15], v[148:151]
ds_read_b128 a[96:99], v5 offset:61440
v_mfma_f32_16x16x32_bf16 v[152:155], a[116:119], a[12:15], v[152:155]
buffer_load_dwordx4 a[0:3], v4, s[40:43], s35 offen offset:0 sc1
v_mfma_f32_16x16x32_bf16 v[136:139], a[116:119], a[8:11], v[136:139]
ds_read_b128 a[100:103], v5 offset:62464
v_mfma_f32_16x16x32_bf16 v[140:143], a[120:123], a[8:11], v[140:143]
ds_read_b128 a[104:107], v5 offset:63488
v_mfma_f32_16x16x32_bf16 v[156:159], a[120:123], a[12:15], v[156:159]
ds_read_b128 a[108:111], v5 offset:64512
v_mfma_f32_16x16x32_bf16 v[160:163], a[124:127], a[12:15], v[160:163]
buffer_load_dwordx4 a[4:7], v4, s[40:43], s35 offen offset:1024 sc1
v_mfma_f32_16x16x32_bf16 v[144:147], a[124:127], a[8:11], v[144:147]
s_waitcnt vmcnt(8) lgkmcnt(4)
v_mfma_f32_16x16x32_bf16 v[132:135], a[128:131], a[16:19], v[132:135]
s_cmp_eq_u32 s3, 3
s_cselect_b32 s35, 27, 19
s_lshl_b32 s35, s35, 12
v_mfma_f32_16x16x32_bf16 v[148:151], a[128:131], a[20:23], v[148:151]
ds_read_b128 a[112:115], v6 offset:0
v_mfma_f32_16x16x32_bf16 v[152:155], a[132:135], a[20:23], v[152:155]
buffer_load_dwordx4 a[8:11], v4, s[40:43], s35 offen offset:0 sc1
v_mfma_f32_16x16x32_bf16 v[136:139], a[132:135], a[16:19], v[136:139]
ds_read_b128 a[116:119], v6 offset:1024
v_mfma_f32_16x16x32_bf16 v[140:143], a[136:139], a[16:19], v[140:143]
ds_read_b128 a[120:123], v6 offset:2048
v_mfma_f32_16x16x32_bf16 v[156:159], a[136:139], a[20:23], v[156:159]
ds_read_b128 a[124:127], v6 offset:3072
v_mfma_f32_16x16x32_bf16 v[160:163], a[140:143], a[20:23], v[160:163]
buffer_load_dwordx4 a[12:15], v4, s[40:43], s35 offen offset:1024 sc1
v_mfma_f32_16x16x32_bf16 v[144:147], a[140:143], a[16:19], v[144:147]
s_waitcnt vmcnt(8) lgkmcnt(4)
v_mfma_f32_16x16x32_bf16 v[132:135], a[96:99], a[24:27], v[132:135]
s_cmp_eq_u32 s3, 4
s_cselect_b32 s35, 28, 20
s_lshl_b32 s35, s35, 12
v_mfma_f32_16x16x32_bf16 v[148:151], a[96:99], a[28:31], v[148:151]
ds_read_b128 a[128:131], v6 offset:4096
v_mfma_f32_16x16x32_bf16 v[152:155], a[100:103], a[28:31], v[152:155]
buffer_load_dwordx4 a[16:19], v4, s[40:43], s35 offen offset:0 sc1
v_mfma_f32_16x16x32_bf16 v[136:139], a[100:103], a[24:27], v[136:139]
ds_read_b128 a[132:135], v6 offset:5120
v_mfma_f32_16x16x32_bf16 v[140:143], a[104:107], a[24:27], v[140:143]
ds_read_b128 a[136:139], v6 offset:6144
v_mfma_f32_16x16x32_bf16 v[156:159], a[104:107], a[28:31], v[156:159]
ds_read_b128 a[140:143], v6 offset:7168
v_mfma_f32_16x16x32_bf16 v[160:163], a[108:111], a[28:31], v[160:163]
buffer_load_dwordx4 a[20:23], v4, s[40:43], s35 offen offset:1024 sc1
v_mfma_f32_16x16x32_bf16 v[144:147], a[108:111], a[24:27], v[144:147]
s_waitcnt vmcnt(8) lgkmcnt(4)
v_mfma_f32_16x16x32_bf16 v[132:135], a[112:115], a[32:35], v[132:135]
s_cmp_eq_u32 s3, 5
s_cselect_b32 s35, 29, 21
s_lshl_b32 s35, s35, 12
v_mfma_f32_16x16x32_bf16 v[148:151], a[112:115], a[36:39], v[148:151]
ds_read_b128 a[96:99], v6 offset:8192
v_mfma_f32_16x16x32_bf16 v[152:155], a[116:119], a[36:39], v[152:155]
buffer_load_dwordx4 a[24:27], v4, s[40:43], s35 offen offset:0 sc1
v_mfma_f32_16x16x32_bf16 v[136:139], a[116:119], a[32:35], v[136:139]
ds_read_b128 a[100:103], v6 offset:9216
v_mfma_f32_16x16x32_bf16 v[140:143], a[120:123], a[32:35], v[140:143]
ds_read_b128 a[104:107], v6 offset:10240
v_mfma_f32_16x16x32_bf16 v[156:159], a[120:123], a[36:39], v[156:159]
ds_read_b128 a[108:111], v6 offset:11264
v_mfma_f32_16x16x32_bf16 v[160:163], a[124:127], a[36:39], v[160:163]
buffer_load_dwordx4 a[28:31], v4, s[40:43], s35 offen offset:1024 sc1
v_mfma_f32_16x16x32_bf16 v[144:147], a[124:127], a[32:35], v[144:147]
s_waitcnt vmcnt(8) lgkmcnt(4)
v_mfma_f32_16x16x32_bf16 v[132:135], a[128:131], a[40:43], v[132:135]
s_cmp_eq_u32 s3, 6
s_cselect_b32 s35, 30, 22
s_lshl_b32 s35, s35, 12
v_mfma_f32_16x16x32_bf16 v[148:151], a[128:131], a[44:47], v[148:151]
ds_read_b128 a[112:115], v6 offset:12288
v_mfma_f32_16x16x32_bf16 v[152:155], a[132:135], a[44:47], v[152:155]
buffer_load_dwordx4 a[32:35], v4, s[40:43], s35 offen offset:0 sc1
v_mfma_f32_16x16x32_bf16 v[136:139], a[132:135], a[40:43], v[136:139]
ds_read_b128 a[116:119], v6 offset:13312
v_mfma_f32_16x16x32_bf16 v[140:143], a[136:139], a[40:43], v[140:143]
ds_read_b128 a[120:123], v6 offset:14336
v_mfma_f32_16x16x32_bf16 v[156:159], a[136:139], a[44:47], v[156:159]
ds_read_b128 a[124:127], v6 offset:15360
v_mfma_f32_16x16x32_bf16 v[160:163], a[140:143], a[44:47], v[160:163]
buffer_load_dwordx4 a[36:39], v4, s[40:43], s35 offen offset:1024 sc1
v_mfma_f32_16x16x32_bf16 v[144:147], a[140:143], a[40:43], v[144:147]
s_waitcnt vmcnt(8) lgkmcnt(4)
v_mfma_f32_16x16x32_bf16 v[132:135], a[96:99], a[0:3], v[132:135]
s_cmp_eq_u32 s3, 7
s_cselect_b32 s35, 31, 23
s_lshl_b32 s35, s35, 12
v_mfma_f32_16x16x32_bf16 v[148:151], a[96:99], a[4:7], v[148:151]
ds_read_b128 a[128:131], v6 offset:16384
v_mfma_f32_16x16x32_bf16 v[152:155], a[100:103], a[4:7], v[152:155]
buffer_load_dwordx4 a[40:43], v4, s[40:43], s35 offen offset:0 sc1
v_mfma_f32_16x16x32_bf16 v[136:139], a[100:103], a[0:3], v[136:139]
ds_read_b128 a[132:135], v6 offset:17408
v_mfma_f32_16x16x32_bf16 v[140:143], a[104:107], a[0:3], v[140:143]
ds_read_b128 a[136:139], v6 offset:18432
v_mfma_f32_16x16x32_bf16 v[156:159], a[104:107], a[4:7], v[156:159]
ds_read_b128 a[140:143], v6 offset:19456
v_mfma_f32_16x16x32_bf16 v[160:163], a[108:111], a[4:7], v[160:163]
buffer_load_dwordx4 a[44:47], v4, s[40:43], s35 offen offset:1024 sc1
v_mfma_f32_16x16x32_bf16 v[144:147], a[108:111], a[0:3], v[144:147]
s_waitcnt vmcnt(8) lgkmcnt(4)
v_mfma_f32_16x16x32_bf16 v[132:135], a[112:115], a[8:11], v[132:135]
s_cmp_eq_u32 s3, 0
s_cselect_b32 s35, 0, 24
s_lshl_b32 s35, s35, 12
v_mfma_f32_16x16x32_bf16 v[148:151], a[112:115], a[12:15], v[148:151]
ds_read_b128 a[96:99], v6 offset:20480
v_mfma_f32_16x16x32_bf16 v[152:155], a[116:119], a[12:15], v[152:155]
buffer_load_dwordx4 a[0:3], v4, s[40:43], s35 offen offset:0 sc1
v_mfma_f32_16x16x32_bf16 v[136:139], a[116:119], a[8:11], v[136:139]
ds_read_b128 a[100:103], v6 offset:21504
v_mfma_f32_16x16x32_bf16 v[140:143], a[120:123], a[8:11], v[140:143]
ds_read_b128 a[104:107], v6 offset:22528
v_mfma_f32_16x16x32_bf16 v[156:159], a[120:123], a[12:15], v[156:159]
ds_read_b128 a[108:111], v6 offset:23552
v_mfma_f32_16x16x32_bf16 v[160:163], a[124:127], a[12:15], v[160:163]
buffer_load_dwordx4 a[4:7], v4, s[40:43], s35 offen offset:1024 sc1
v_mfma_f32_16x16x32_bf16 v[144:147], a[124:127], a[8:11], v[144:147]
s_waitcnt vmcnt(8) lgkmcnt(4)
v_mfma_f32_16x16x32_bf16 v[132:135], a[128:131], a[16:19], v[132:135]
s_cmp_eq_u32 s3, 1
s_cselect_b32 s35, 1, 25
s_lshl_b32 s35, s35, 12
v_mfma_f32_16x16x32_bf16 v[148:151], a[128:131], a[20:23], v[148:151]
ds_read_b128 a[112:115], v6 offset:24576
s_add_u32 s88, s67, 0xe0000
v_mfma_f32_16x16x32_bf16 v[152:155], a[132:135], a[20:23], v[152:155]
buffer_load_dwordx4 a[8:11], v4, s[40:43], s35 offen offset:0 sc1
s_add_u32 s89, s66, 0xd0000
v_mfma_f32_16x16x32_bf16 v[136:139], a[132:135], a[16:19], v[136:139]
ds_read_b128 a[116:119], v6 offset:25600
v_mfma_f32_16x16x32_bf16 v[140:143], a[136:139], a[16:19], v[140:143]
ds_read_b128 a[120:123], v6 offset:26624
v_mfma_f32_16x16x32_bf16 v[156:159], a[136:139], a[20:23], v[156:159]
ds_read_b128 a[124:127], v6 offset:27648
v_mfma_f32_16x16x32_bf16 v[160:163], a[140:143], a[20:23], v[160:163]
buffer_load_dwordx4 a[12:15], v4, s[40:43], s35 offen offset:1024 sc1
v_mfma_f32_16x16x32_bf16 v[144:147], a[140:143], a[16:19], v[144:147]
buffer_load_dword v11, v255, s[4:7], s88 offen sc1
s_waitcnt vmcnt(9) lgkmcnt(4)
v_mfma_f32_16x16x32_bf16 v[132:135], a[96:99], a[24:27], v[132:135]
s_cmp_eq_u32 s3, 2
s_cselect_b32 s35, 2, 26
s_lshl_b32 s35, s35, 12
v_mfma_f32_16x16x32_bf16 v[148:151], a[96:99], a[28:31], v[148:151]
ds_read_b128 a[128:131], v6 offset:28672
v_mfma_f32_16x16x32_bf16 v[152:155], a[100:103], a[28:31], v[152:155]
buffer_load_dwordx4 a[16:19], v4, s[40:43], s35 offen offset:0 sc1
v_mfma_f32_16x16x32_bf16 v[136:139], a[100:103], a[24:27], v[136:139]
ds_read_b128 a[132:135], v6 offset:29696
v_mfma_f32_16x16x32_bf16 v[140:143], a[104:107], a[24:27], v[140:143]
ds_read_b128 a[136:139], v6 offset:30720
v_mfma_f32_16x16x32_bf16 v[156:159], a[104:107], a[28:31], v[156:159]
ds_read_b128 a[140:143], v6 offset:31744
v_mfma_f32_16x16x32_bf16 v[160:163], a[108:111], a[28:31], v[160:163]
buffer_load_dwordx4 a[20:23], v4, s[40:43], s35 offen offset:1024 sc1
v_mfma_f32_16x16x32_bf16 v[144:147], a[108:111], a[24:27], v[144:147]
buffer_load_dword v232, v255, s[4:7], s89 offen offset:64 sc1
s_waitcnt vmcnt(10) lgkmcnt(4)
v_mfma_f32_16x16x32_bf16 v[132:135], a[112:115], a[32:35], v[132:135]
s_cmp_eq_u32 s3, 3
s_cselect_b32 s35, 3, 27
s_lshl_b32 s35, s35, 12
v_mfma_f32_16x16x32_bf16 v[148:151], a[112:115], a[36:39], v[148:151]
ds_read_b128 a[96:99], v6 offset:32768
v_mfma_f32_16x16x32_bf16 v[152:155], a[116:119], a[36:39], v[152:155]
buffer_load_dwordx4 a[24:27], v4, s[40:43], s35 offen offset:0 sc1
v_mfma_f32_16x16x32_bf16 v[136:139], a[116:119], a[32:35], v[136:139]
ds_read_b128 a[100:103], v6 offset:33792
v_mfma_f32_16x16x32_bf16 v[140:143], a[120:123], a[32:35], v[140:143]
ds_read_b128 a[104:107], v6 offset:34816
v_mfma_f32_16x16x32_bf16 v[156:159], a[120:123], a[36:39], v[156:159]
ds_read_b128 a[108:111], v6 offset:35840
v_mfma_f32_16x16x32_bf16 v[160:163], a[124:127], a[36:39], v[160:163]
buffer_load_dwordx4 a[28:31], v4, s[40:43], s35 offen offset:1024 sc1
v_mfma_f32_16x16x32_bf16 v[144:147], a[124:127], a[32:35], v[144:147]
s_waitcnt vmcnt(10) lgkmcnt(4)
v_mfma_f32_16x16x32_bf16 v[132:135], a[128:131], a[40:43], v[132:135]
s_cmp_eq_u32 s3, 4
s_cselect_b32 s35, 4, 28
s_lshl_b32 s35, s35, 12
v_mfma_f32_16x16x32_bf16 v[148:151], a[128:131], a[44:47], v[148:151]
ds_read_b128 a[112:115], v6 offset:36864
v_mfma_f32_16x16x32_bf16 v[152:155], a[132:135], a[44:47], v[152:155]
buffer_load_dwordx4 a[32:35], v4, s[40:43], s35 offen offset:0 sc1
v_mfma_f32_16x16x32_bf16 v[136:139], a[132:135], a[40:43], v[136:139]
ds_read_b128 a[116:119], v6 offset:37888
v_mfma_f32_16x16x32_bf16 v[140:143], a[136:139], a[40:43], v[140:143]
ds_read_b128 a[120:123], v6 offset:38912
v_mfma_f32_16x16x32_bf16 v[156:159], a[136:139], a[44:47], v[156:159]
ds_read_b128 a[124:127], v6 offset:39936
v_mfma_f32_16x16x32_bf16 v[160:163], a[140:143], a[44:47], v[160:163]
buffer_load_dwordx4 a[36:39], v4, s[40:43], s35 offen offset:1024 sc1
v_mfma_f32_16x16x32_bf16 v[144:147], a[140:143], a[40:43], v[144:147]
s_waitcnt vmcnt(10) lgkmcnt(4)
v_mfma_f32_16x16x32_bf16 v[132:135], a[96:99], a[0:3], v[132:135]
s_cmp_eq_u32 s3, 5
s_cselect_b32 s35, 5, 29
s_lshl_b32 s35, s35, 12
v_mfma_f32_16x16x32_bf16 v[148:151], a[96:99], a[4:7], v[148:151]
ds_read_b128 a[128:131], v6 offset:40960
v_mfma_f32_16x16x32_bf16 v[152:155], a[100:103], a[4:7], v[152:155]
buffer_load_dwordx4 a[40:43], v4, s[40:43], s35 offen offset:0 sc1
v_mfma_f32_16x16x32_bf16 v[136:139], a[100:103], a[0:3], v[136:139]
ds_read_b128 a[132:135], v6 offset:41984
v_mfma_f32_16x16x32_bf16 v[140:143], a[104:107], a[0:3], v[140:143]
ds_read_b128 a[136:139], v6 offset:43008
v_mfma_f32_16x16x32_bf16 v[156:159], a[104:107], a[4:7], v[156:159]
ds_read_b128 a[140:143], v6 offset:44032
v_mfma_f32_16x16x32_bf16 v[160:163], a[108:111], a[4:7], v[160:163]
buffer_load_dwordx4 a[44:47], v4, s[40:43], s35 offen offset:1024 sc1
v_mfma_f32_16x16x32_bf16 v[144:147], a[108:111], a[0:3], v[144:147]
s_waitcnt vmcnt(10) lgkmcnt(4)
v_mfma_f32_16x16x32_bf16 v[132:135], a[112:115], a[8:11], v[132:135]
s_cmp_eq_u32 s3, 6
s_cselect_b32 s35, 6, 30
s_lshl_b32 s35, s35, 12
v_mfma_f32_16x16x32_bf16 v[148:151], a[112:115], a[12:15], v[148:151]
ds_read_b128 a[96:99], v6 offset:45056
v_mfma_f32_16x16x32_bf16 v[152:155], a[116:119], a[12:15], v[152:155]
buffer_load_dwordx4 a[0:3], v4, s[40:43], s35 offen offset:0 sc1
v_mfma_f32_16x16x32_bf16 v[136:139], a[116:119], a[8:11], v[136:139]
ds_read_b128 a[100:103], v6 offset:46080
v_mfma_f32_16x16x32_bf16 v[140:143], a[120:123], a[8:11], v[140:143]
ds_read_b128 a[104:107], v6 offset:47104
v_mfma_f32_16x16x32_bf16 v[156:159], a[120:123], a[12:15], v[156:159]
ds_read_b128 a[108:111], v6 offset:48128
v_mfma_f32_16x16x32_bf16 v[160:163], a[124:127], a[12:15], v[160:163]
buffer_load_dwordx4 a[4:7], v4, s[40:43], s35 offen offset:1024 sc1
v_mfma_f32_16x16x32_bf16 v[144:147], a[124:127], a[8:11], v[144:147]
s_waitcnt vmcnt(9) lgkmcnt(4)
v_mfma_f32_16x16x32_bf16 v[132:135], a[128:131], a[16:19], v[132:135]
s_cmp_eq_u32 s3, 7
s_cselect_b32 s35, 7, 31
s_lshl_b32 s35, s35, 12
v_mfma_f32_16x16x32_bf16 v[148:151], a[128:131], a[20:23], v[148:151]
ds_read_b128 a[112:115], v6 offset:49152
v_mfma_f32_16x16x32_bf16 v[152:155], a[132:135], a[20:23], v[152:155]
buffer_load_dwordx4 a[8:11], v4, s[40:43], s35 offen offset:0 sc1
v_mfma_f32_16x16x32_bf16 v[136:139], a[132:135], a[16:19], v[136:139]
ds_read_b128 a[116:119], v6 offset:50176
v_mfma_f32_16x16x32_bf16 v[140:143], a[136:139], a[16:19], v[140:143]
ds_read_b128 a[120:123], v6 offset:51200
v_mfma_f32_16x16x32_bf16 v[156:159], a[136:139], a[20:23], v[156:159]
ds_read_b128 a[124:127], v6 offset:52224
v_mfma_f32_16x16x32_bf16 v[160:163], a[140:143], a[20:23], v[160:163]
buffer_load_dwordx4 a[12:15], v4, s[40:43], s35 offen offset:1024 sc1
v_mfma_f32_16x16x32_bf16 v[144:147], a[140:143], a[16:19], v[144:147]
s_waitcnt vmcnt(8) lgkmcnt(4)
v_mfma_f32_16x16x32_bf16 v[132:135], a[96:99], a[24:27], v[132:135]
ds_read_b128 a[128:131], v6 offset:53248
v_mfma_f32_16x16x32_bf16 v[148:151], a[96:99], a[28:31], v[148:151]
ds_read_b128 a[132:135], v6 offset:54272
v_mfma_f32_16x16x32_bf16 v[152:155], a[100:103], a[28:31], v[152:155]
ds_read_b128 a[136:139], v6 offset:55296
v_mfma_f32_16x16x32_bf16 v[136:139], a[100:103], a[24:27], v[136:139]
ds_read_b128 a[140:143], v6 offset:56320
v_mfma_f32_16x16x32_bf16 v[140:143], a[104:107], a[24:27], v[140:143]
v_mfma_f32_16x16x32_bf16 v[156:159], a[104:107], a[28:31], v[156:159]
v_mfma_f32_16x16x32_bf16 v[160:163], a[108:111], a[28:31], v[160:163]
v_mfma_f32_16x16x32_bf16 v[144:147], a[108:111], a[24:27], v[144:147]
s_waitcnt vmcnt(6) lgkmcnt(4)
v_mfma_f32_16x16x32_bf16 v[132:135], a[112:115], a[32:35], v[132:135]
ds_read_b128 a[96:99], v6 offset:57344
v_mfma_f32_16x16x32_bf16 v[148:151], a[112:115], a[36:39], v[148:151]
ds_read_b128 a[100:103], v6 offset:58368
v_mfma_f32_16x16x32_bf16 v[152:155], a[116:119], a[36:39], v[152:155]
ds_read_b128 a[104:107], v6 offset:59392
v_mfma_f32_16x16x32_bf16 v[136:139], a[116:119], a[32:35], v[136:139]
ds_read_b128 a[108:111], v6 offset:60416
v_mfma_f32_16x16x32_bf16 v[140:143], a[120:123], a[32:35], v[140:143]
v_mfma_f32_16x16x32_bf16 v[156:159], a[120:123], a[36:39], v[156:159]
v_mfma_f32_16x16x32_bf16 v[160:163], a[124:127], a[36:39], v[160:163]
v_mfma_f32_16x16x32_bf16 v[144:147], a[124:127], a[32:35], v[144:147]
s_waitcnt vmcnt(4) lgkmcnt(4)
v_mfma_f32_16x16x32_bf16 v[132:135], a[128:131], a[40:43], v[132:135]
ds_read_b128 a[112:115], v6 offset:61440
v_mfma_f32_16x16x32_bf16 v[148:151], a[128:131], a[44:47], v[148:151]
ds_read_b128 a[116:119], v6 offset:62464
v_mfma_f32_16x16x32_bf16 v[152:155], a[132:135], a[44:47], v[152:155]
ds_read_b128 a[120:123], v6 offset:63488
v_mfma_f32_16x16x32_bf16 v[136:139], a[132:135], a[40:43], v[136:139]
ds_read_b128 a[124:127], v6 offset:64512
v_mfma_f32_16x16x32_bf16 v[140:143], a[136:139], a[40:43], v[140:143]
v_mfma_f32_16x16x32_bf16 v[156:159], a[136:139], a[44:47], v[156:159]
v_mfma_f32_16x16x32_bf16 v[160:163], a[140:143], a[44:47], v[160:163]
v_mfma_f32_16x16x32_bf16 v[144:147], a[140:143], a[40:43], v[144:147]
s_waitcnt vmcnt(2) lgkmcnt(4)
v_mfma_f32_16x16x32_bf16 v[132:135], a[96:99], a[0:3], v[132:135]
v_mfma_f32_16x16x32_bf16 v[148:151], a[96:99], a[4:7], v[148:151]
v_mfma_f32_16x16x32_bf16 v[152:155], a[100:103], a[4:7], v[152:155]
v_mfma_f32_16x16x32_bf16 v[136:139], a[100:103], a[0:3], v[136:139]
v_mfma_f32_16x16x32_bf16 v[140:143], a[104:107], a[0:3], v[140:143]
v_mfma_f32_16x16x32_bf16 v[156:159], a[104:107], a[4:7], v[156:159]
v_mfma_f32_16x16x32_bf16 v[160:163], a[108:111], a[4:7], v[160:163]
v_mfma_f32_16x16x32_bf16 v[144:147], a[108:111], a[0:3], v[144:147]
s_waitcnt vmcnt(0) lgkmcnt(0)
v_mfma_f32_16x16x32_bf16 v[132:135], a[112:115], a[8:11], v[132:135]
v_mfma_f32_16x16x32_bf16 v[148:151], a[112:115], a[12:15], v[148:151]
v_mfma_f32_16x16x32_bf16 v[152:155], a[116:119], a[12:15], v[152:155]
v_mfma_f32_16x16x32_bf16 v[136:139], a[116:119], a[8:11], v[136:139]
v_mfma_f32_16x16x32_bf16 v[140:143], a[120:123], a[8:11], v[140:143]
v_mfma_f32_16x16x32_bf16 v[156:159], a[120:123], a[12:15], v[156:159]
v_mfma_f32_16x16x32_bf16 v[160:163], a[124:127], a[12:15], v[160:163]
v_mfma_f32_16x16x32_bf16 v[144:147], a[124:127], a[8:11], v[144:147]
s_lshl_b32 s36, s32, 13
v_cvt_pk_bf16_f32 v32, v132, v133
v_cvt_pk_bf16_f32 v33, v134, v135
s_nop 0
v_cvt_pk_bf16_f32 v34, v136, v137
v_cvt_pk_bf16_f32 v35, v138, v139
s_add_u32 s36, s36, 0x2200000
buffer_store_dwordx4 v[32:35], v4, s[4:7], s36 offen offset:0 sc1
v_cvt_pk_bf16_f32 v40, v148, v149
v_cvt_pk_bf16_f32 v41, v150, v151
v_cvt_pk_bf16_f32 v42, v152, v153
v_cvt_pk_bf16_f32 v43, v154, v155
v_cvt_pk_bf16_f32 v36, v140, v141
v_cvt_pk_bf16_f32 v37, v142, v143
v_cvt_pk_bf16_f32 v38, v144, v145
v_cvt_pk_bf16_f32 v39, v146, v147
s_add_u32 s37, s36, 4096
v_cvt_pk_bf16_f32 v44, v156, v157
v_cvt_pk_bf16_f32 v45, v158, v159
v_cvt_pk_bf16_f32 v46, v160, v161
buffer_store_dwordx4 v[40:43], v4, s[4:7], s36 offen offset:1024 sc1
v_cvt_pk_bf16_f32 v47, v162, v163
v_mfma_f32_16x16x32_bf16 v[96:99], v[32:35], v[32:35], 0
s_mov_b32 s38, 0x240000
s_add_u32 s92, s78, 0x40000
v_mfma_f32_16x16x32_bf16 v[92:95], v[16:19], v[32:35], 0
s_add_u32 s93, s79, 0x40000
s_add_u32 s40, s4, 0x2200000
v_mfma_f32_16x16x32_bf16 v[96:99], v[36:39], v[36:39], v[96:99]
s_addc_u32 s41, s5, 0
buffer_store_dwordx4 v[36:39], v4, s[4:7], s37 offen offset:0 sc1
v_mfma_f32_16x16x32_bf16 v[92:95], v[16:19], v[36:39], v[92:95]
s_nop 4
v_cndmask_b32 v96, v96, v97, s[46:47]
v_cndmask_b32 v98, v98, v99, s[46:47]
v_mfma_f32_16x16x32_bf16 v[104:107], v[40:43], v[40:43], 0
v_mfma_f32_16x16x32_bf16 v[100:103], v[16:19], v[40:43], 0
v_cndmask_b32 v93, v96, v98, s[48:49]
buffer_store_dwordx4 v[44:47], v4, s[4:7], s37 offen offset:1024 sc1
v_mfma_f32_16x16x32_bf16 v[104:107], v[44:47], v[44:47], v[104:107]
v_mfma_f32_16x16x32_bf16 v[100:103], v[16:19], v[44:47], v[100:103]
s_nop 6
v_cndmask_b32 v104, v104, v105, s[46:47]
v_cndmask_b32 v106, v106, v107, s[46:47]
buffer_store_dwordx2 v[92:93], v253, s[4:7], s38 offen offset:0 sc1
v_cndmask_b32 v101, v104, v106, s[48:49]
buffer_store_dwordx2 v[100:101], v253, s[4:7], s38 offen offset:2048 sc1
v_cmp_ne_u32 vcc, v11, v15
s_cbranch_vccnz Ltr_7
Lte_9:
v_cmp_ne_u32 vcc, v232, v15
s_cbranch_vccnz Ltr_10
Lte_12:
s_barrier
s_add_u32 m0, s18, 0x0
s_add_u32 s44, s50, 0x1400000
buffer_load_dwordx4 v1, s[4:7], s44 offen offset:0 sc1 lds
buffer_load_dwordx4 v1, s[4:7], s44 offen offset:1024 sc1 lds
buffer_load_dwordx4 v1, s[4:7], s44 offen offset:2048 sc1 lds
s_add_u32 m0, s18, 0x3000
s_add_u32 s44, s50, 0x1403000
buffer_load_dwordx4 v1, s[4:7], s44 offen offset:0 sc1 lds
buffer_load_dwordx4 v1, s[4:7], s44 offen offset:1024 sc1 lds
buffer_load_dwordx4 v1, s[4:7], s44 offen offset:2048 sc1 lds
s_waitcnt vmcnt(6)
L_stub4:
s_cbranch_execz L_wret1
s_barrier
s_cmp_lg_u32 s28, 1
s_cbranch_scc1 Lsg_13
buffer_atomic_add v12, v10, s[4:7], s92 offen sc1
Lsg_13:
s_mov_b64 exec, 0
s_cmp_eq_u32 s28, 1
s_cbranch_scc1 L_stub5
L_wret2:
s_mov_b64 exec, -1
s_cmp_lt_u32 s28, 2
s_cbranch_scc1 Lwd_14
s_add_u32 m0, s18, 0x4800
s_add_u32 s44, s50, 0x1404800
buffer_load_dwordx4 v1, s[4:7], s44 offen offset:0 sc1 lds
buffer_load_dwordx4 v1, s[4:7], s44 offen offset:1024 sc1 lds
buffer_load_dwordx4 v1, s[4:7], s44 offen offset:2048 sc1 lds
s_add_u32 m0, s18, 0x6000
s_add_u32 s44, s50, 0x1406000
buffer_load_dwordx4 v1, s[4:7], s44 offen offset:0 sc1 lds
buffer_load_dwordx4 v1, s[4:7], s44 offen offset:1024 sc1 lds
buffer_load_dwordx4 v1, s[4:7], s44 offen offset:2048 sc1 lds
s_add_u32 m0, s18, 0x7800
s_add_u32 s44, s50, 0x1407800
buffer_load_dwordx4 v1, s[4:7], s44 offen offset:0 sc1 lds
buffer_load_dwordx4 v1, s[4:7], s44 offen offset:1024 sc1 lds
buffer_load_dwordx4 v1, s[4:7], s44 offen offset:2048 sc1 lds
s_add_u32 m0, s18, 0x9000
s_add_u32 s44, s50, 0x1409000
buffer_load_dwordx4 v1, s[4:7], s44 offen offset:0 sc1 lds
buffer_load_dwordx4 v1, s[4:7], s44 offen offset:1024 sc1 lds
buffer_load_dwordx4 v1, s[4:7], s44 offen offset:2048 sc1 lds
s_add_u32 m0, s18, 0xa800
s_add_u32 s44, s50, 0x140a800
buffer_load_dwordx4 v1, s[4:7], s44 offen offset:0 sc1 lds
buffer_load_dwordx4 v1, s[4:7], s44 offen offset:1024 sc1 lds
buffer_load_dwordx4 v1, s[4:7], s44 offen offset:2048 sc1 lds
s_add_u32 m0, s18, 0xc000
s_add_u32 s44, s50, 0x140c000
buffer_load_dwordx4 v1, s[4:7], s44 offen offset:0 sc1 lds
buffer_load_dwordx4 v1, s[4:7], s44 offen offset:1024 sc1 lds
buffer_load_dwordx4 v1, s[4:7], s44 offen offset:2048 sc1 lds
s_add_u32 m0, s18, 0xd800
s_add_u32 s44, s50, 0x140d800
buffer_load_dwordx4 v1, s[4:7], s44 offen offset:0 sc1 lds
buffer_load_dwordx4 v1, s[4:7], s44 offen offset:1024 sc1 lds
buffer_load_dwordx4 v1, s[4:7], s44 offen offset:2048 sc1 lds
s_add_u32 m0, s18, 0xf000
s_add_u32 s44, s50, 0x140f000
buffer_load_dwordx4 v1, s[4:7], s44 offen offset:0 sc1 lds
buffer_load_dwordx4 v1, s[4:7], s44 offen offset:1024 sc1 lds
buffer_load_dwordx4 v1, s[4:7], s44 offen offset:2048 sc1 lds
s_add_u32 m0, s18, 0x10800
s_add_u32 s44, s50, 0x1410800
buffer_load_dwordx4 v1, s[4:7], s44 offen offset:0 sc1 lds
buffer_load_dwordx4 v1, s[4:7], s44 offen offset:1024 sc1 lds
buffer_load_dwordx4 v1, s[4:7], s44 offen offset:2048 sc1 lds
s_add_u32 m0, s18, 0x12000
s_add_u32 s44, s50, 0x1412000
buffer_load_dwordx4 v1, s[4:7], s44 offen offset:0 sc1 lds
buffer_load_dwordx4 v1, s[4:7], s44 offen offset:1024 sc1 lds
buffer_load_dwordx4 v1, s[4:7], s44 offen offset:2048 sc1 lds
s_add_u32 m0, s18, 0x13800
s_add_u32 s44, s50, 0x1413800
buffer_load_dwordx4 v1, s[4:7], s44 offen offset:0 sc1 lds
buffer_load_dwordx4 v1, s[4:7], s44 offen offset:1024 sc1 lds
buffer_load_dwordx4 v1, s[4:7], s44 offen offset:2048 sc1 lds
s_add_u32 m0, s18, 0x15000
s_add_u32 s44, s50, 0x1415000
buffer_load_dwordx4 v1, s[4:7], s44 offen offset:0 sc1 lds
buffer_load_dwordx4 v1, s[4:7], s44 offen offset:1024 sc1 lds
buffer_load_dwordx4 v1, s[4:7], s44 offen offset:2048 sc1 lds
s_add_u32 m0, s18, 0x16800
s_add_u32 s44, s50, 0x1416800
buffer_load_dwordx4 v1, s[4:7], s44 offen offset:0 sc1 lds
buffer_load_dwordx4 v1, s[4:7], s44 offen offset:1024 sc1 lds
buffer_load_dwordx4 v1, s[4:7], s44 offen offset:2048 sc1 lds
s_add_u32 m0, s18, 0x18000
s_add_u32 s44, s50, 0x1418000
buffer_load_dwordx4 v1, s[4:7], s44 offen offset:0 sc1 lds
buffer_load_dwordx4 v1, s[4:7], s44 offen offset:1024 sc1 lds
buffer_load_dwordx4 v1, s[4:7], s44 offen offset:2048 sc1 lds
s_add_u32 m0, s18, 0x19800
s_add_u32 s44, s50, 0x1419800
buffer_load_dwordx4 v1, s[4:7], s44 offen offset:0 sc1 lds
buffer_load_dwordx4 v1, s[4:7], s44 offen offset:1024 sc1 lds
buffer_load_dwordx4 v1, s[4:7], s44 offen offset:2048 sc1 lds
s_add_u32 m0, s18, 0x1b000
s_add_u32 s44, s50, 0x141b000
buffer_load_dwordx4 v1, s[4:7], s44 offen offset:0 sc1 lds
buffer_load_dwordx4 v1, s[4:7], s44 offen offset:1024 sc1 lds
buffer_load_dwordx4 v1, s[4:7], s44 offen offset:2048 sc1 lds
Lwd_14:
s_cmp_lg_u32 s28, 0
s_cbranch_scc1 Lpe_16
s_add_u32 s36, s67, 0x40000
s_mov_b32 s37, 0
Lpoll_15:
v_mov_b32 v11, 0
buffer_atomic_add v11, v251, s[4:7], s36 offen sc0 sc1
s_add_u32 s37, s37, 1
s_waitcnt vmcnt(0)
v_readfirstlane_b32 s38, v11
s_nop 0
s_cmp_ge_u32 s38, 32
s_cbranch_scc1 Lpe_16
s_cmp_lt_u32 s37, 0x100000
s_cbranch_scc1 Lpoll_15
Lpe_16:
s_waitcnt vmcnt(36) lgkmcnt(0)
s_cmp_ge_u32 s28, 2
s_cbranch_scc1 Lw_17
s_waitcnt vmcnt(0)
Lw_17:
s_barrier
s_mov_b32 s35, 0
s_mov_b32 s33, 0x1000
buffer_load_dwordx4 a[0:3], v2, s[40:43], s35 offen offset:0 sc1
buffer_load_dwordx4 a[4:7], v2, s[40:43], s33 offen offset:0 sc1
buffer_load_dwordx4 a[8:11], v2, s[40:43], s35 offen offset:1024 sc1
buffer_load_dwordx4 a[12:15], v2, s[40:43], s33 offen offset:1024 sc1
buffer_load_dwordx4 a[16:19], v2, s[40:43], s35 offen offset:2048 sc1
buffer_load_dwordx4 a[20:23], v2, s[40:43], s33 offen offset:2048 sc1
buffer_load_dwordx4 a[24:27], v2, s[40:43], s35 offen offset:3072 sc1
buffer_load_dwordx4 a[28:31], v2, s[40:43], s33 offen offset:3072 sc1
s_add_u32 s35, s35, 8192
s_add_u32 s33, s33, 8192
buffer_load_dwordx4 a[32:35], v2, s[40:43], s35 offen offset:0 sc1
buffer_load_dwordx4 a[36:39], v2, s[40:43], s33 offen offset:0 sc1
buffer_load_dwordx4 a[40:43], v2, s[40:43], s35 offen offset:1024 sc1
buffer_load_dwordx4 a[44:47], v2, s[40:43], s33 offen offset:1024 sc1
buffer_load_dwordx4 a[48:51], v2, s[40:43], s35 offen offset:2048 sc1
buffer_load_dwordx4 a[52:55], v2, s[40:43], s33 offen offset:2048 sc1
buffer_load_dwordx4 a[56:59], v2, s[40:43], s35 offen offset:3072 sc1
buffer_load_dwordx4 a[60:63], v2, s[40:43], s33 offen offset:3072 sc1
s_add_u32 s35, s35, 8192
s_add_u32 s33, s33, 8192
v_add_u32 v5, 0, v1
ds_read_b128 a[96:99], v5 offset:2048
ds_read_b128 a[100:103], v5 offset:8192
ds_read_b128 a[104:107], v5 offset:3072
ds_read_b128 a[108:111], v5 offset:9216
ds_read_b128 a[112:115], v5 offset:4096
ds_read_b128 a[116:119], v5 offset:10240
s_waitcnt vmcnt(14) lgkmcnt(4)
v_mfma_f32_16x16x32_bf16 v[140:143], a[96:99], a[0:3], 0
v_and_b32 v232, 15, v0
v_lshlrev_b32 v232, 7, v232
v_mfma_f32_16x16x32_bf16 v[140:143], a[100:103], a[4:7], v[140:143]
buffer_load_dwordx4 a[64:67], v2, s[40:43], s35 offen offset:0 sc1
s_waitcnt vmcnt(13)
v_mfma_f32_16x16x32_bf16 v[164:167], a[100:103], a[12:15], 0
v_lshrrev_b32 v233, 4, v0
v_lshlrev_b32 v233, 4, v233
v_mfma_f32_16x16x32_bf16 v[164:167], a[96:99], a[8:11], v[164:167]
v_add_u32 v232, v233, v232
s_mul_i32 s38, s30, 12288
s_waitcnt vmcnt(12)
v_mfma_f32_16x16x32_bf16 v[188:191], a[96:99], a[16:19], 0
s_add_u32 s38, s38, 0x380000
s_add_u32 s39, s28, 4
s_min_u32 s39, s39, 5
s_waitcnt vmcnt(11)
v_mfma_f32_16x16x32_bf16 v[188:191], a[100:103], a[20:23], v[188:191]
buffer_load_dwordx4 a[68:71], v2, s[40:43], s33 offen offset:0 sc1
s_lshl_b32 s36, s28, 11
s_waitcnt vmcnt(10)
v_mfma_f32_16x16x32_bf16 v[212:215], a[100:103], a[28:31], 0
s_add_u32 s36, s36, s38
s_lshl_b32 s37, s39, 11
s_add_u32 s37, s37, s38
v_mfma_f32_16x16x32_bf16 v[212:215], a[96:99], a[24:27], v[212:215]
ds_read_b128 a[128:131], v5 offset:5120
s_waitcnt lgkmcnt(4)
v_mfma_f32_16x16x32_bf16 v[216:219], a[104:107], a[24:27], 0
ds_read_b128 a[132:135], v5 offset:11264
s_waitcnt lgkmcnt(4)
v_mfma_f32_16x16x32_bf16 v[216:219], a[108:111], a[28:31], v[216:219]
ds_read_b128 a[136:139], v5 offset:0
v_mfma_f32_16x16x32_bf16 v[192:195], a[108:111], a[20:23], 0
buffer_load_dwordx4 v[48:51], v232, s[4:7], s36 offen sc1
v_mfma_f32_16x16x32_bf16 v[192:195], a[104:107], a[16:19], v[192:195]
ds_read_b128 a[140:143], v5 offset:6144
v_mfma_f32_16x16x32_bf16 v[168:171], a[104:107], a[8:11], 0
ds_read_b128 a[144:147], v5 offset:1024
v_mfma_f32_16x16x32_bf16 v[168:171], a[108:111], a[12:15], v[168:171]
ds_read_b128 a[148:151], v5 offset:7168
v_mfma_f32_16x16x32_bf16 v[144:147], a[108:111], a[4:7], 0
v_mfma_f32_16x16x32_bf16 v[144:147], a[104:107], a[0:3], v[144:147]
buffer_load_dwordx4 a[72:75], v2, s[40:43], s35 offen offset:1024 sc1
s_waitcnt lgkmcnt(7)
v_mfma_f32_16x16x32_bf16 v[148:151], a[112:115], a[0:3], 0
s_waitcnt lgkmcnt(6)
v_mfma_f32_16x16x32_bf16 v[148:151], a[116:119], a[4:7], v[148:151]
v_mfma_f32_16x16x32_bf16 v[172:175], a[116:119], a[12:15], 0
v_mfma_f32_16x16x32_bf16 v[172:175], a[112:115], a[8:11], v[172:175]
v_mfma_f32_16x16x32_bf16 v[196:199], a[112:115], a[16:19], 0
buffer_load_dwordx4 a[76:79], v2, s[40:43], s33 offen offset:1024 sc1
v_mfma_f32_16x16x32_bf16 v[196:199], a[116:119], a[20:23], v[196:199]
v_mfma_f32_16x16x32_bf16 v[220:223], a[116:119], a[28:31], 0
v_mfma_f32_16x16x32_bf16 v[220:223], a[112:115], a[24:27], v[220:223]
s_waitcnt lgkmcnt(0)
v_mfma_f32_16x16x32_bf16 v[224:227], a[128:131], a[24:27], 0
ds_read_b128 a[96:99], v5 offset:14336
v_mfma_f32_16x16x32_bf16 v[224:227], a[132:135], a[28:31], v[224:227]
buffer_load_dwordx4 a[80:83], v2, s[40:43], s35 offen offset:2048 sc1
v_mfma_f32_16x16x32_bf16 v[200:203], a[132:135], a[20:23], 0
ds_read_b128 a[100:103], v5 offset:20480
v_mfma_f32_16x16x32_bf16 v[200:203], a[128:131], a[16:19], v[200:203]
v_mfma_f32_16x16x32_bf16 v[176:179], a[128:131], a[8:11], 0
v_mfma_f32_16x16x32_bf16 v[176:179], a[132:135], a[12:15], v[176:179]
buffer_load_dwordx4 a[84:87], v2, s[40:43], s33 offen offset:2048 sc1
v_mfma_f32_16x16x32_bf16 v[152:155], a[132:135], a[4:7], 0
ds_read_b128 a[104:107], v5 offset:15360
v_mfma_f32_16x16x32_bf16 v[152:155], a[128:131], a[0:3], v[152:155]
v_mfma_f32_16x16x32_bf16 v[132:135], a[136:139], a[0:3], 0
ds_read_b128 a[108:111], v5 offset:21504
v_mfma_f32_16x16x32_bf16 v[132:135], a[140:143], a[4:7], v[132:135]
v_mfma_f32_16x16x32_bf16 v[156:159], a[140:143], a[12:15], 0
buffer_load_dwordx4 v[52:55], v232, s[4:7], s37 offen sc1
s_add_u32 s88, s82, 0x240000
v_mfma_f32_16x16x32_bf16 v[156:159], a[136:139], a[8:11], v[156:159]
ds_read_b128 a[112:115], v5 offset:16384
v_mfma_f32_16x16x32_bf16 v[180:183], a[136:139], a[16:19], 0
v_mfma_f32_16x16x32_bf16 v[180:183], a[140:143], a[20:23], v[180:183]
ds_read_b128 a[116:119], v5 offset:22528
v_mfma_f32_16x16x32_bf16 v[204:207], a[140:143], a[28:31], 0
v_mfma_f32_16x16x32_bf16 v[204:207], a[136:139], a[24:27], v[204:207]
buffer_load_dwordx4 a[88:91], v2, s[40:43], s35 offen offset:3072 sc1
v_mfma_f32_16x16x32_bf16 v[208:211], a[144:147], a[24:27], 0
v_mfma_f32_16x16x32_bf16 v[208:211], a[148:151], a[28:31], v[208:211]
v_mfma_f32_16x16x32_bf16 v[184:187], a[148:151], a[20:23], 0
v_mfma_f32_16x16x32_bf16 v[184:187], a[144:147], a[16:19], v[184:187]
v_mfma_f32_16x16x32_bf16 v[160:163], a[144:147], a[8:11], 0
buffer_load_dwordx4 a[92:95], v2, s[40:43], s33 offen offset:3072 sc1
s_add_u32 s35, s35, 8192
v_mfma_f32_16x16x32_bf16 v[160:163], a[148:151], a[12:15], v[160:163]
s_add_u32 s33, s33, 8192
v_mfma_f32_16x16x32_bf16 v[136:139], a[148:151], a[4:7], 0
v_mfma_f32_16x16x32_bf16 v[136:139], a[144:147], a[0:3], v[136:139]
s_waitcnt vmcnt(10) lgkmcnt(0)
v_mfma_f32_16x16x32_bf16 v[140:143], a[96:99], a[32:35], v[140:143]
ds_read_b128 a[128:131], v5 offset:17408
v_mfma_f32_16x16x32_bf16 v[140:143], a[100:103], a[36:39], v[140:143]
buffer_load_dwordx4 a[0:3], v2, s[40:43], s35 offen offset:0 sc1
v_mfma_f32_16x16x32_bf16 v[164:167], a[100:103], a[44:47], v[164:167]
ds_read_b128 a[132:135], v5 offset:23552
v_mfma_f32_16x16x32_bf16 v[164:167], a[96:99], a[40:43], v[164:167]
v_mfma_f32_16x16x32_bf16 v[188:191], a[96:99], a[48:51], v[188:191]
v_mfma_f32_16x16x32_bf16 v[188:191], a[100:103], a[52:55], v[188:191]
buffer_load_dwordx4 a[4:7], v2, s[40:43], s33 offen offset:0 sc1
v_mfma_f32_16x16x32_bf16 v[212:215], a[100:103], a[60:63], v[212:215]
ds_read_b128 a[136:139], v5 offset:12288
v_mfma_f32_16x16x32_bf16 v[212:215], a[96:99], a[56:59], v[212:215]
v_mfma_f32_16x16x32_bf16 v[216:219], a[104:107], a[56:59], v[216:219]
ds_read_b128 a[140:143], v5 offset:18432
v_mfma_f32_16x16x32_bf16 v[216:219], a[108:111], a[60:63], v[216:219]
v_mfma_f32_16x16x32_bf16 v[192:195], a[108:111], a[52:55], v[192:195]
buffer_load_dwordx4 v[92:95], v1, s[4:7], s88 offen offset:0 sc1
v_mfma_f32_16x16x32_bf16 v[192:195], a[104:107], a[48:51], v[192:195]
ds_read_b128 a[144:147], v5 offset:13312
v_mfma_f32_16x16x32_bf16 v[168:171], a[104:107], a[40:43], v[168:171]
v_mfma_f32_16x16x32_bf16 v[168:171], a[108:111], a[44:47], v[168:171]
ds_read_b128 a[148:151], v5 offset:19456
v_mfma_f32_16x16x32_bf16 v[144:147], a[108:111], a[36:39], v[144:147]
v_mfma_f32_16x16x32_bf16 v[144:147], a[104:107], a[32:35], v[144:147]
buffer_load_dwordx4 a[8:11], v2, s[40:43], s35 offen offset:1024 sc1
v_mfma_f32_16x16x32_bf16 v[148:151], a[112:115], a[32:35], v[148:151]
v_mfma_f32_16x16x32_bf16 v[148:151], a[116:119], a[36:39], v[148:151]
v_mfma_f32_16x16x32_bf16 v[172:175], a[116:119], a[44:47], v[172:175]
v_mfma_f32_16x16x32_bf16 v[172:175], a[112:115], a[40:43], v[172:175]
v_mfma_f32_16x16x32_bf16 v[196:199], a[112:115], a[48:51], v[196:199]
buffer_load_dwordx4 a[12:15], v2, s[40:43], s33 offen offset:1024 sc1
v_mfma_f32_16x16x32_bf16 v[196:199], a[116:119], a[52:55], v[196:199]
v_mfma_f32_16x16x32_bf16 v[220:223], a[116:119], a[60:63], v[220:223]
v_mfma_f32_16x16x32_bf16 v[220:223], a[112:115], a[56:59], v[220:223]
s_waitcnt lgkmcnt(0)
v_mfma_f32_16x16x32_bf16 v[224:227], a[128:131], a[56:59], v[224:227]
ds_read_b128 a[96:99], v5 offset:26624
v_mfma_f32_16x16x32_bf16 v[224:227], a[132:135], a[60:63], v[224:227]
buffer_load_dwordx4 a[16:19], v2, s[40:43], s35 offen offset:2048 sc1
v_mfma_f32_16x16x32_bf16 v[200:203], a[132:135], a[52:55], v[200:203]
ds_read_b128 a[100:103], v5 offset:32768
v_mfma_f32_16x16x32_bf16 v[200:203], a[128:131], a[48:51], v[200:203]
v_mfma_f32_16x16x32_bf16 v[176:179], a[128:131], a[40:43], v[176:179]
v_mfma_f32_16x16x32_bf16 v[176:179], a[132:135], a[44:47], v[176:179]
buffer_load_dwordx4 v[96:99], v1, s[4:7], s88 offen offset:1024 sc1
v_mfma_f32_16x16x32_bf16 v[152:155], a[132:135], a[36:39], v[152:155]
ds_read_b128 a[104:107], v5 offset:27648
v_mfma_f32_16x16x32_bf16 v[152:155], a[128:131], a[32:35], v[152:155]
v_mfma_f32_16x16x32_bf16 v[132:135], a[136:139], a[32:35], v[132:135]
ds_read_b128 a[108:111], v5 offset:33792
v_mfma_f32_16x16x32_bf16 v[132:135], a[140:143], a[36:39], v[132:135]
buffer_load_dwordx4 a[20:23], v2, s[40:43], s33 offen offset:2048 sc1
v_mfma_f32_16x16x32_bf16 v[156:159], a[140:143], a[44:47], v[156:159]
ds_read_b128 a[112:115], v5 offset:28672
v_mfma_f32_16x16x32_bf16 v[156:159], a[136:139], a[40:43], v[156:159]
v_mfma_f32_16x16x32_bf16 v[180:183], a[136:139], a[48:51], v[180:183]
v_mfma_f32_16x16x32_bf16 v[180:183], a[140:143], a[52:55], v[180:183]
buffer_load_dwordx4 a[24:27], v2, s[40:43], s35 offen offset:3072 sc1
v_mfma_f32_16x16x32_bf16 v[204:207], a[140:143], a[60:63], v[204:207]
ds_read_b128 a[116:119], v5 offset:34816
v_mfma_f32_16x16x32_bf16 v[204:207], a[136:139], a[56:59], v[204:207]
v_mfma_f32_16x16x32_bf16 v[208:211], a[144:147], a[56:59], v[208:211]
v_mfma_f32_16x16x32_bf16 v[208:211], a[148:151], a[60:63], v[208:211]
buffer_load_dwordx4 v[100:103], v1, s[4:7], s88 offen offset:2048 sc1
v_mfma_f32_16x16x32_bf16 v[184:187], a[148:151], a[52:55], v[184:187]
v_mfma_f32_16x16x32_bf16 v[184:187], a[144:147], a[48:51], v[184:187]
v_mfma_f32_16x16x32_bf16 v[160:163], a[144:147], a[40:43], v[160:163]
v_mfma_f32_16x16x32_bf16 v[160:163], a[148:151], a[44:47], v[160:163]
buffer_load_dwordx4 a[28:31], v2, s[40:43], s33 offen offset:3072 sc1
s_add_u32 s35, s35, 8192
v_mfma_f32_16x16x32_bf16 v[136:139], a[148:151], a[36:39], v[136:139]
s_add_u32 s33, s33, 8192
v_mfma_f32_16x16x32_bf16 v[136:139], a[144:147], a[32:35], v[136:139]
s_waitcnt vmcnt(11) lgkmcnt(0)
v_mfma_f32_16x16x32_bf16 v[140:143], a[96:99], a[64:67], v[140:143]
ds_read_b128 a[128:131], v5 offset:29696
v_mfma_f32_16x16x32_bf16 v[140:143], a[100:103], a[68:71], v[140:143]
buffer_load_dwordx4 a[32:35], v2, s[40:43], s35 offen offset:0 sc1
v_mfma_f32_16x16x32_bf16 v[164:167], a[100:103], a[76:79], v[164:167]
ds_read_b128 a[132:135], v5 offset:35840
v_mfma_f32_16x16x32_bf16 v[164:167], a[96:99], a[72:75], v[164:167]
v_mfma_f32_16x16x32_bf16 v[188:191], a[96:99], a[80:83], v[188:191]
v_mfma_f32_16x16x32_bf16 v[188:191], a[100:103], a[84:87], v[188:191]
buffer_load_dwordx4 a[36:39], v2, s[40:43], s33 offen offset:0 sc1
v_mfma_f32_16x16x32_bf16 v[212:215], a[100:103], a[92:95], v[212:215]
ds_read_b128 a[136:139], v5 offset:24576
v_mfma_f32_16x16x32_bf16 v[212:215], a[96:99], a[88:91], v[212:215]
v_mfma_f32_16x16x32_bf16 v[216:219], a[104:107], a[88:91], v[216:219]
ds_read_b128 a[140:143], v5 offset:30720
v_mfma_f32_16x16x32_bf16 v[216:219], a[108:111], a[92:95], v[216:219]
v_mfma_f32_16x16x32_bf16 v[192:195], a[108:111], a[84:87], v[192:195]
buffer_load_dwordx4 v[104:107], v1, s[4:7], s88 offen offset:3072 sc1
s_add_u32 s88, s88, 4096
v_mfma_f32_16x16x32_bf16 v[192:195], a[104:107], a[80:83], v[192:195]
ds_read_b128 a[144:147], v5 offset:25600
v_mfma_f32_16x16x32_bf16 v[168:171], a[104:107], a[72:75], v[168:171]
v_mfma_f32_16x16x32_bf16 v[168:171], a[108:111], a[76:79], v[168:171]
ds_read_b128 a[148:151], v5 offset:31744
v_mfma_f32_16x16x32_bf16 v[144:147], a[108:111], a[68:71], v[144:147]
v_mfma_f32_16x16x32_bf16 v[144:147], a[104:107], a[64:67], v[144:147]
buffer_load_dwordx4 a[40:43], v2, s[40:43], s35 offen offset:1024 sc1
v_mfma_f32_16x16x32_bf16 v[148:151], a[112:115], a[64:67], v[148:151]
v_mfma_f32_16x16x32_bf16 v[148:151], a[116:119], a[68:71], v[148:151]
v_mfma_f32_16x16x32_bf16 v[172:175], a[116:119], a[76:79], v[172:175]
v_mfma_f32_16x16x32_bf16 v[172:175], a[112:115], a[72:75], v[172:175]
v_mfma_f32_16x16x32_bf16 v[196:199], a[112:115], a[80:83], v[196:199]
buffer_load_dwordx4 a[44:47], v2, s[40:43], s33 offen offset:1024 sc1
v_mfma_f32_16x16x32_bf16 v[196:199], a[116:119], a[84:87], v[196:199]
v_mfma_f32_16x16x32_bf16 v[220:223], a[116:119], a[92:95], v[220:223]
v_mfma_f32_16x16x32_bf16 v[220:223], a[112:115], a[88:91], v[220:223]
s_waitcnt lgkmcnt(0)
v_mfma_f32_16x16x32_bf16 v[224:227], a[128:131], a[88:91], v[224:227]
ds_read_b128 a[96:99], v5 offset:38912
v_mfma_f32_16x16x32_bf16 v[224:227], a[132:135], a[92:95], v[224:227]
buffer_load_dwordx4 a[48:51], v2, s[40:43], s35 offen offset:2048 sc1
v_mfma_f32_16x16x32_bf16 v[200:203], a[132:135], a[84:87], v[200:203]
ds_read_b128 a[100:103], v5 offset:45056
v_mfma_f32_16x16x32_bf16 v[200:203], a[128:131], a[80:83], v[200:203]
v_mfma_f32_16x16x32_bf16 v[176:179], a[128:131], a[72:75], v[176:179]
v_mfma_f32_16x16x32_bf16 v[176:179], a[132:135], a[76:79], v[176:179]
buffer_load_dwordx4 a[52:55], v2, s[40:43], s33 offen offset:2048 sc1
v_mfma_f32_16x16x32_bf16 v[152:155], a[132:135], a[68:71], v[152:155]
ds_read_b128 a[104:107], v5 offset:39936
v_mfma_f32_16x16x32_bf16 v[152:155], a[128:131], a[64:67], v[152:155]
v_mfma_f32_16x16x32_bf16 v[132:135], a[136:139], a[64:67], v[132:135]
ds_read_b128 a[108:111], v5 offset:46080
v_mfma_f32_16x16x32_bf16 v[132:135], a[140:143], a[68:71], v[132:135]
v_mfma_f32_16x16x32_bf16 v[156:159], a[140:143], a[76:79], v[156:159]
buffer_load_dwordx4 v[108:111], v1, s[4:7], s88 offen offset:0 sc1
v_mfma_f32_16x16x32_bf16 v[156:159], a[136:139], a[72:75], v[156:159]
ds_read_b128 a[112:115], v5 offset:40960
v_mfma_f32_16x16x32_bf16 v[180:183], a[136:139], a[80:83], v[180:183]
v_mfma_f32_16x16x32_bf16 v[180:183], a[140:143], a[84:87], v[180:183]
ds_read_b128 a[116:119], v5 offset:47104
v_mfma_f32_16x16x32_bf16 v[204:207], a[140:143], a[92:95], v[204:207]
v_mfma_f32_16x16x32_bf16 v[204:207], a[136:139], a[88:91], v[204:207]
buffer_load_dwordx4 a[56:59], v2, s[40:43], s35 offen offset:3072 sc1
v_mfma_f32_16x16x32_bf16 v[208:211], a[144:147], a[88:91], v[208:211]
v_mfma_f32_16x16x32_bf16 v[208:211], a[148:151], a[92:95], v[208:211]
v_mfma_f32_16x16x32_bf16 v[184:187], a[148:151], a[84:87], v[184:187]
v_mfma_f32_16x16x32_bf16 v[184:187], a[144:147], a[80:83], v[184:187]
v_mfma_f32_16x16x32_bf16 v[160:163], a[144:147], a[72:75], v[160:163]
buffer_load_dwordx4 a[60:63], v2, s[40:43], s33 offen offset:3072 sc1
s_add_u32 s35, s35, 8192
v_mfma_f32_16x16x32_bf16 v[160:163], a[148:151], a[76:79], v[160:163]
s_add_u32 s33, s33, 8192
v_mfma_f32_16x16x32_bf16 v[136:139], a[148:151], a[68:71], v[136:139]
v_mfma_f32_16x16x32_bf16 v[136:139], a[144:147], a[64:67], v[136:139]
s_waitcnt vmcnt(10) lgkmcnt(0)
v_mfma_f32_16x16x32_bf16 v[140:143], a[96:99], a[0:3], v[140:143]
ds_read_b128 a[128:131], v5 offset:41984
v_mfma_f32_16x16x32_bf16 v[140:143], a[100:103], a[4:7], v[140:143]
buffer_load_dwordx4 a[64:67], v2, s[40:43], s35 offen offset:0 sc1
v_mfma_f32_16x16x32_bf16 v[164:167], a[100:103], a[12:15], v[164:167]
ds_read_b128 a[132:135], v5 offset:48128
v_mfma_f32_16x16x32_bf16 v[164:167], a[96:99], a[8:11], v[164:167]
v_mfma_f32_16x16x32_bf16 v[188:191], a[96:99], a[16:19], v[188:191]
v_mfma_f32_16x16x32_bf16 v[188:191], a[100:103], a[20:23], v[188:191]
buffer_load_dwordx4 a[68:71], v2, s[40:43], s33 offen offset:0 sc1
v_mfma_f32_16x16x32_bf16 v[212:215], a[100:103], a[28:31], v[212:215]
ds_read_b128 a[136:139], v5 offset:36864
v_mfma_f32_16x16x32_bf16 v[212:215], a[96:99], a[24:27], v[212:215]
v_mfma_f32_16x16x32_bf16 v[216:219], a[104:107], a[24:27], v[216:219]
ds_read_b128 a[140:143], v5 offset:43008
v_mfma_f32_16x16x32_bf16 v[216:219], a[108:111], a[28:31], v[216:219]
v_mfma_f32_16x16x32_bf16 v[192:195], a[108:111], a[20:23], v[192:195]
buffer_load_dwordx4 v[112:115], v1, s[4:7], s88 offen offset:1024 sc1
v_mfma_f32_16x16x32_bf16 v[192:195], a[104:107], a[16:19], v[192:195]
ds_read_b128 a[144:147], v5 offset:37888
v_mfma_f32_16x16x32_bf16 v[168:171], a[104:107], a[8:11], v[168:171]
v_mfma_f32_16x16x32_bf16 v[168:171], a[108:111], a[12:15], v[168:171]
ds_read_b128 a[148:151], v5 offset:44032
v_mfma_f32_16x16x32_bf16 v[144:147], a[108:111], a[4:7], v[144:147]
v_mfma_f32_16x16x32_bf16 v[144:147], a[104:107], a[0:3], v[144:147]
buffer_load_dwordx4 a[72:75], v2, s[40:43], s35 offen offset:1024 sc1
v_mfma_f32_16x16x32_bf16 v[148:151], a[112:115], a[0:3], v[148:151]
v_mfma_f32_16x16x32_bf16 v[148:151], a[116:119], a[4:7], v[148:151]
v_mfma_f32_16x16x32_bf16 v[172:175], a[116:119], a[12:15], v[172:175]
v_mfma_f32_16x16x32_bf16 v[172:175], a[112:115], a[8:11], v[172:175]
v_mfma_f32_16x16x32_bf16 v[196:199], a[112:115], a[16:19], v[196:199]
buffer_load_dwordx4 a[76:79], v2, s[40:43], s33 offen offset:1024 sc1
v_mfma_f32_16x16x32_bf16 v[196:199], a[116:119], a[20:23], v[196:199]
v_mfma_f32_16x16x32_bf16 v[220:223], a[116:119], a[28:31], v[220:223]
v_mfma_f32_16x16x32_bf16 v[220:223], a[112:115], a[24:27], v[220:223]
s_waitcnt lgkmcnt(0)
s_barrier
v_mfma_f32_16x16x32_bf16 v[224:227], a[128:131], a[24:27], v[224:227]
v_add_u32 v5, 49152, v1
v_mfma_f32_16x16x32_bf16 v[224:227], a[132:135], a[28:31], v[224:227]
buffer_load_dwordx4 a[80:83], v2, s[40:43], s35 offen offset:2048 sc1
v_mfma_f32_16x16x32_bf16 v[200:203], a[132:135], a[20:23], v[200:203]
ds_read_b128 a[96:99], v5 offset:2048
v_mfma_f32_16x16x32_bf16 v[200:203], a[128:131], a[16:19], v[200:203]
ds_read_b128 a[100:103], v5 offset:8192
v_mfma_f32_16x16x32_bf16 v[176:179], a[128:131], a[8:11], v[176:179]
v_mfma_f32_16x16x32_bf16 v[176:179], a[132:135], a[12:15], v[176:179]
buffer_load_dwordx4 a[84:87], v2, s[40:43], s33 offen offset:2048 sc1
v_mfma_f32_16x16x32_bf16 v[152:155], a[132:135], a[4:7], v[152:155]
ds_read_b128 a[104:107], v5 offset:3072
v_mfma_f32_16x16x32_bf16 v[152:155], a[128:131], a[0:3], v[152:155]
v_mfma_f32_16x16x32_bf16 v[132:135], a[136:139], a[0:3], v[132:135]
ds_read_b128 a[108:111], v5 offset:9216
v_mfma_f32_16x16x32_bf16 v[132:135], a[140:143], a[4:7], v[132:135]
v_mfma_f32_16x16x32_bf16 v[156:159], a[140:143], a[12:15], v[156:159]
buffer_load_dwordx4 v[116:119], v1, s[4:7], s88 offen offset:2048 sc1
v_mfma_f32_16x16x32_bf16 v[156:159], a[136:139], a[8:11], v[156:159]
ds_read_b128 a[112:115], v5 offset:4096
v_mfma_f32_16x16x32_bf16 v[180:183], a[136:139], a[16:19], v[180:183]
v_mfma_f32_16x16x32_bf16 v[180:183], a[140:143], a[20:23], v[180:183]
ds_read_b128 a[116:119], v5 offset:10240
v_mfma_f32_16x16x32_bf16 v[204:207], a[140:143], a[28:31], v[204:207]
v_mfma_f32_16x16x32_bf16 v[204:207], a[136:139], a[24:27], v[204:207]
buffer_load_dwordx4 a[88:91], v2, s[40:43], s35 offen offset:3072 sc1
v_mfma_f32_16x16x32_bf16 v[208:211], a[144:147], a[24:27], v[208:211]
v_mfma_f32_16x16x32_bf16 v[208:211], a[148:151], a[28:31], v[208:211]
v_mfma_f32_16x16x32_bf16 v[184:187], a[148:151], a[20:23], v[184:187]
v_mfma_f32_16x16x32_bf16 v[184:187], a[144:147], a[16:19], v[184:187]
v_mfma_f32_16x16x32_bf16 v[160:163], a[144:147], a[8:11], v[160:163]
buffer_load_dwordx4 a[92:95], v2, s[40:43], s33 offen offset:3072 sc1
s_add_u32 s35, s35, 8192
v_mfma_f32_16x16x32_bf16 v[160:163], a[148:151], a[12:15], v[160:163]
s_add_u32 s33, s33, 8192
v_mfma_f32_16x16x32_bf16 v[136:139], a[148:151], a[4:7], v[136:139]
v_mfma_f32_16x16x32_bf16 v[136:139], a[144:147], a[0:3], v[136:139]
s_waitcnt vmcnt(10) lgkmcnt(0)
v_mfma_f32_16x16x32_bf16 v[140:143], a[96:99], a[32:35], v[140:143]
ds_read_b128 a[128:131], v5 offset:5120
v_mfma_f32_16x16x32_bf16 v[140:143], a[100:103], a[36:39], v[140:143]
buffer_load_dwordx4 a[0:3], v2, s[40:43], s35 offen offset:0 sc1
v_mfma_f32_16x16x32_bf16 v[164:167], a[100:103], a[44:47], v[164:167]
ds_read_b128 a[132:135], v5 offset:11264
v_mfma_f32_16x16x32_bf16 v[164:167], a[96:99], a[40:43], v[164:167]
v_mfma_f32_16x16x32_bf16 v[188:191], a[96:99], a[48:51], v[188:191]
v_mfma_f32_16x16x32_bf16 v[188:191], a[100:103], a[52:55], v[188:191]
buffer_load_dwordx4 a[4:7], v2, s[40:43], s33 offen offset:0 sc1
v_mfma_f32_16x16x32_bf16 v[212:215], a[100:103], a[60:63], v[212:215]
ds_read_b128 a[136:139], v5 offset:0
v_mfma_f32_16x16x32_bf16 v[212:215], a[96:99], a[56:59], v[212:215]
v_mfma_f32_16x16x32_bf16 v[216:219], a[104:107], a[56:59], v[216:219]
ds_read_b128 a[140:143], v5 offset:6144
v_mfma_f32_16x16x32_bf16 v[216:219], a[108:111], a[60:63], v[216:219]
v_mfma_f32_16x16x32_bf16 v[192:195], a[108:111], a[52:55], v[192:195]
buffer_load_dwordx4 v[120:123], v1, s[4:7], s88 offen offset:3072 sc1
s_add_u32 m0, s18, 0x1e000
v_mfma_f32_16x16x32_bf16 v[192:195], a[104:107], a[48:51], v[192:195]
s_add_u32 s44, s50, 0x141e000
ds_read_b128 a[144:147], v5 offset:1024
v_mfma_f32_16x16x32_bf16 v[168:171], a[104:107], a[40:43], v[168:171]
v_mfma_f32_16x16x32_bf16 v[168:171], a[108:111], a[44:47], v[168:171]
ds_read_b128 a[148:151], v5 offset:7168
v_mfma_f32_16x16x32_bf16 v[144:147], a[108:111], a[36:39], v[144:147]
v_mfma_f32_16x16x32_bf16 v[144:147], a[104:107], a[32:35], v[144:147]
buffer_load_dwordx4 a[8:11], v2, s[40:43], s35 offen offset:1024 sc1
v_mfma_f32_16x16x32_bf16 v[148:151], a[112:115], a[32:35], v[148:151]
v_mfma_f32_16x16x32_bf16 v[148:151], a[116:119], a[36:39], v[148:151]
v_mfma_f32_16x16x32_bf16 v[172:175], a[116:119], a[44:47], v[172:175]
v_mfma_f32_16x16x32_bf16 v[172:175], a[112:115], a[40:43], v[172:175]
v_mfma_f32_16x16x32_bf16 v[196:199], a[112:115], a[48:51], v[196:199]
buffer_load_dwordx4 a[12:15], v2, s[40:43], s33 offen offset:1024 sc1
v_mfma_f32_16x16x32_bf16 v[196:199], a[116:119], a[52:55], v[196:199]
v_mfma_f32_16x16x32_bf16 v[220:223], a[116:119], a[60:63], v[220:223]
v_mfma_f32_16x16x32_bf16 v[220:223], a[112:115], a[56:59], v[220:223]
s_waitcnt lgkmcnt(0)
v_mfma_f32_16x16x32_bf16 v[224:227], a[128:131], a[56:59], v[224:227]
ds_read_b128 a[96:99], v5 offset:14336
v_mfma_f32_16x16x32_bf16 v[224:227], a[132:135], a[60:63], v[224:227]
buffer_load_dwordx4 a[16:19], v2, s[40:43], s35 offen offset:2048 sc1
v_mfma_f32_16x16x32_bf16 v[200:203], a[132:135], a[52:55], v[200:203]
ds_read_b128 a[100:103], v5 offset:20480
v_mfma_f32_16x16x32_bf16 v[200:203], a[128:131], a[48:51], v[200:203]
v_mfma_f32_16x16x32_bf16 v[176:179], a[128:131], a[40:43], v[176:179]
v_mfma_f32_16x16x32_bf16 v[176:179], a[132:135], a[44:47], v[176:179]
buffer_load_dwordx4 v1, s[4:7], s44 offen offset:0 sc1 lds
v_mfma_f32_16x16x32_bf16 v[152:155], a[132:135], a[36:39], v[152:155]
ds_read_b128 a[104:107], v5 offset:15360
v_mfma_f32_16x16x32_bf16 v[152:155], a[128:131], a[32:35], v[152:155]
v_mfma_f32_16x16x32_bf16 v[132:135], a[136:139], a[32:35], v[132:135]
ds_read_b128 a[108:111], v5 offset:21504
v_mfma_f32_16x16x32_bf16 v[132:135], a[140:143], a[36:39], v[132:135]
buffer_load_dwordx4 a[20:23], v2, s[40:43], s33 offen offset:2048 sc1
v_mfma_f32_16x16x32_bf16 v[156:159], a[140:143], a[44:47], v[156:159]
ds_read_b128 a[112:115], v5 offset:16384
v_mfma_f32_16x16x32_bf16 v[156:159], a[136:139], a[40:43], v[156:159]
v_mfma_f32_16x16x32_bf16 v[180:183], a[136:139], a[48:51], v[180:183]
v_mfma_f32_16x16x32_bf16 v[180:183], a[140:143], a[52:55], v[180:183]
buffer_load_dwordx4 a[24:27], v2, s[40:43], s35 offen offset:3072 sc1
v_mfma_f32_16x16x32_bf16 v[204:207], a[140:143], a[60:63], v[204:207]
ds_read_b128 a[116:119], v5 offset:22528
v_mfma_f32_16x16x32_bf16 v[204:207], a[136:139], a[56:59], v[204:207]
v_mfma_f32_16x16x32_bf16 v[208:211], a[144:147], a[56:59], v[208:211]
v_mfma_f32_16x16x32_bf16 v[208:211], a[148:151], a[60:63], v[208:211]
buffer_load_dwordx4 v1, s[4:7], s44 offen offset:1024 sc1 lds
v_mfma_f32_16x16x32_bf16 v[184:187], a[148:151], a[52:55], v[184:187]
v_mfma_f32_16x16x32_bf16 v[184:187], a[144:147], a[48:51], v[184:187]
v_mfma_f32_16x16x32_bf16 v[160:163], a[144:147], a[40:43], v[160:163]
v_mfma_f32_16x16x32_bf16 v[160:163], a[148:151], a[44:47], v[160:163]
buffer_load_dwordx4 a[28:31], v2, s[40:43], s33 offen offset:3072 sc1
s_add_u32 s35, s35, 8192
v_mfma_f32_16x16x32_bf16 v[136:139], a[148:151], a[36:39], v[136:139]
s_add_u32 s33, s33, 8192
v_mfma_f32_16x16x32_bf16 v[136:139], a[144:147], a[32:35], v[136:139]
s_waitcnt vmcnt(11) lgkmcnt(0)
v_mfma_f32_16x16x32_bf16 v[140:143], a[96:99], a[64:67], v[140:143]
ds_read_b128 a[128:131], v5 offset:17408
v_mfma_f32_16x16x32_bf16 v[140:143], a[100:103], a[68:71], v[140:143]
L_stub5:
s_cbranch_execz L_stub6
buffer_load_dwordx4 a[32:35], v2, s[40:43], s35 offen offset:0 sc1
v_mfma_f32_16x16x32_bf16 v[164:167], a[100:103], a[76:79], v[164:167]
ds_read_b128 a[132:135], v5 offset:23552
v_mfma_f32_16x16x32_bf16 v[164:167], a[96:99], a[72:75], v[164:167]
v_mfma_f32_16x16x32_bf16 v[188:191], a[96:99], a[80:83], v[188:191]
v_mfma_f32_16x16x32_bf16 v[188:191], a[100:103], a[84:87], v[188:191]
buffer_load_dwordx4 a[36:39], v2, s[40:43], s33 offen offset:0 sc1
v_mfma_f32_16x16x32_bf16 v[212:215], a[100:103], a[92:95], v[212:215]
ds_read_b128 a[136:139], v5 offset:12288
v_mfma_f32_16x16x32_bf16 v[212:215], a[96:99], a[88:91], v[212:215]
v_mfma_f32_16x16x32_bf16 v[216:219], a[104:107], a[88:91], v[216:219]
ds_read_b128 a[140:143], v5 offset:18432
v_mfma_f32_16x16x32_bf16 v[216:219], a[108:111], a[92:95], v[216:219]
v_mfma_f32_16x16x32_bf16 v[192:195], a[108:111], a[84:87], v[192:195]
buffer_load_dwordx4 v1, s[4:7], s44 offen offset:2048 sc1 lds
s_add_u32 m0, s18, 0x21000
v_mfma_f32_16x16x32_bf16 v[192:195], a[104:107], a[80:83], v[192:195]
s_add_u32 s44, s50, 0x1421000
ds_read_b128 a[144:147], v5 offset:13312
v_mfma_f32_16x16x32_bf16 v[168:171], a[104:107], a[72:75], v[168:171]
v_mfma_f32_16x16x32_bf16 v[168:171], a[108:111], a[76:79], v[168:171]
ds_read_b128 a[148:151], v5 offset:19456
v_mfma_f32_16x16x32_bf16 v[144:147], a[108:111], a[68:71], v[144:147]
v_mfma_f32_16x16x32_bf16 v[144:147], a[104:107], a[64:67], v[144:147]
buffer_load_dwordx4 a[40:43], v2, s[40:43], s35 offen offset:1024 sc1
v_mfma_f32_16x16x32_bf16 v[148:151], a[112:115], a[64:67], v[148:151]
v_mfma_f32_16x16x32_bf16 v[148:151], a[116:119], a[68:71], v[148:151]
v_mfma_f32_16x16x32_bf16 v[172:175], a[116:119], a[76:79], v[172:175]
v_mfma_f32_16x16x32_bf16 v[172:175], a[112:115], a[72:75], v[172:175]
v_mfma_f32_16x16x32_bf16 v[196:199], a[112:115], a[80:83], v[196:199]
buffer_load_dwordx4 a[44:47], v2, s[40:43], s33 offen offset:1024 sc1
v_mfma_f32_16x16x32_bf16 v[196:199], a[116:119], a[84:87], v[196:199]
v_mfma_f32_16x16x32_bf16 v[220:223], a[116:119], a[92:95], v[220:223]
v_mfma_f32_16x16x32_bf16 v[220:223], a[112:115], a[88:91], v[220:223]
s_waitcnt lgkmcnt(0)
v_mfma_f32_16x16x32_bf16 v[224:227], a[128:131], a[88:91], v[224:227]
ds_read_b128 a[96:99], v5 offset:26624
v_mfma_f32_16x16x32_bf16 v[224:227], a[132:135], a[92:95], v[224:227]
buffer_load_dwordx4 a[48:51], v2, s[40:43], s35 offen offset:2048 sc1
v_mfma_f32_16x16x32_bf16 v[200:203], a[132:135], a[84:87], v[200:203]
ds_read_b128 a[100:103], v5 offset:32768
v_mfma_f32_16x16x32_bf16 v[200:203], a[128:131], a[80:83], v[200:203]
v_mfma_f32_16x16x32_bf16 v[176:179], a[128:131], a[72:75], v[176:179]
v_mfma_f32_16x16x32_bf16 v[176:179], a[132:135], a[76:79], v[176:179]
buffer_load_dwordx4 a[52:55], v2, s[40:43], s33 offen offset:2048 sc1
v_mfma_f32_16x16x32_bf16 v[152:155], a[132:135], a[68:71], v[152:155]
ds_read_b128 a[104:107], v5 offset:27648
v_mfma_f32_16x16x32_bf16 v[152:155], a[128:131], a[64:67], v[152:155]
v_mfma_f32_16x16x32_bf16 v[132:135], a[136:139], a[64:67], v[132:135]
ds_read_b128 a[108:111], v5 offset:33792
v_mfma_f32_16x16x32_bf16 v[132:135], a[140:143], a[68:71], v[132:135]
v_mfma_f32_16x16x32_bf16 v[156:159], a[140:143], a[76:79], v[156:159]
buffer_load_dwordx4 v1, s[4:7], s44 offen offset:0 sc1 lds
v_mfma_f32_16x16x32_bf16 v[156:159], a[136:139], a[72:75], v[156:159]
ds_read_b128 a[112:115], v5 offset:28672
v_mfma_f32_16x16x32_bf16 v[180:183], a[136:139], a[80:83], v[180:183]
v_mfma_f32_16x16x32_bf16 v[180:183], a[140:143], a[84:87], v[180:183]
ds_read_b128 a[116:119], v5 offset:34816
v_mfma_f32_16x16x32_bf16 v[204:207], a[140:143], a[92:95], v[204:207]
v_mfma_f32_16x16x32_bf16 v[204:207], a[136:139], a[88:91], v[204:207]
buffer_load_dwordx4 a[56:59], v2, s[40:43], s35 offen offset:3072 sc1
v_mfma_f32_16x16x32_bf16 v[208:211], a[144:147], a[88:91], v[208:211]
v_mfma_f32_16x16x32_bf16 v[208:211], a[148:151], a[92:95], v[208:211]
v_mfma_f32_16x16x32_bf16 v[184:187], a[148:151], a[84:87], v[184:187]
v_mfma_f32_16x16x32_bf16 v[184:187], a[144:147], a[80:83], v[184:187]
v_mfma_f32_16x16x32_bf16 v[160:163], a[144:147], a[72:75], v[160:163]
buffer_load_dwordx4 a[60:63], v2, s[40:43], s33 offen offset:3072 sc1
s_add_u32 s35, s35, 8192
v_mfma_f32_16x16x32_bf16 v[160:163], a[148:151], a[76:79], v[160:163]
s_add_u32 s33, s33, 8192
v_mfma_f32_16x16x32_bf16 v[136:139], a[148:151], a[68:71], v[136:139]
v_mfma_f32_16x16x32_bf16 v[136:139], a[144:147], a[64:67], v[136:139]
s_waitcnt vmcnt(10) lgkmcnt(0)
v_mfma_f32_16x16x32_bf16 v[140:143], a[96:99], a[0:3], v[140:143]
ds_read_b128 a[128:131], v5 offset:29696
v_add_f32_dpp v48, v48, v48 row_ror:8 row_mask:0xf bank_mask:0xf
v_mfma_f32_16x16x32_bf16 v[140:143], a[100:103], a[4:7], v[140:143]
buffer_load_dwordx4 a[64:67], v2, s[40:43], s35 offen offset:0 sc1
v_mfma_f32_16x16x32_bf16 v[164:167], a[100:103], a[12:15], v[164:167]
ds_read_b128 a[132:135], v5 offset:35840
v_add_f32_dpp v49, v49, v49 row_ror:8 row_mask:0xf bank_mask:0xf
v_mfma_f32_16x16x32_bf16 v[164:167], a[96:99], a[8:11], v[164:167]
v_add_f32_dpp v50, v50, v50 row_ror:8 row_mask:0xf bank_mask:0xf
v_add_f32_dpp v51, v51, v51 row_ror:8 row_mask:0xf bank_mask:0xf
v_mfma_f32_16x16x32_bf16 v[188:191], a[96:99], a[16:19], v[188:191]
v_add_f32_dpp v52, v52, v52 row_ror:8 row_mask:0xf bank_mask:0xf
v_add_f32_dpp v53, v53, v53 row_ror:8 row_mask:0xf bank_mask:0xf
v_mfma_f32_16x16x32_bf16 v[188:191], a[100:103], a[20:23], v[188:191]
buffer_load_dwordx4 a[68:71], v2, s[40:43], s33 offen offset:0 sc1
v_mfma_f32_16x16x32_bf16 v[212:215], a[100:103], a[28:31], v[212:215]
ds_read_b128 a[136:139], v5 offset:24576
v_add_f32_dpp v54, v54, v54 row_ror:8 row_mask:0xf bank_mask:0xf
v_mfma_f32_16x16x32_bf16 v[212:215], a[96:99], a[24:27], v[212:215]
v_add_f32_dpp v55, v55, v55 row_ror:8 row_mask:0xf bank_mask:0xf
v_add_f32_dpp v48, v48, v48 row_ror:4 row_mask:0xf bank_mask:0xf
v_mfma_f32_16x16x32_bf16 v[216:219], a[104:107], a[24:27], v[216:219]
ds_read_b128 a[140:143], v5 offset:30720
v_add_f32_dpp v49, v49, v49 row_ror:4 row_mask:0xf bank_mask:0xf
v_mfma_f32_16x16x32_bf16 v[216:219], a[108:111], a[28:31], v[216:219]
v_add_f32_dpp v50, v50, v50 row_ror:4 row_mask:0xf bank_mask:0xf
v_mfma_f32_16x16x32_bf16 v[192:195], a[108:111], a[20:23], v[192:195]
buffer_load_dwordx4 v1, s[4:7], s44 offen offset:1024 sc1 lds
v_mfma_f32_16x16x32_bf16 v[192:195], a[104:107], a[16:19], v[192:195]
ds_read_b128 a[144:147], v5 offset:25600
v_add_f32_dpp v51, v51, v51 row_ror:4 row_mask:0xf bank_mask:0xf
v_mfma_f32_16x16x32_bf16 v[168:171], a[104:107], a[8:11], v[168:171]
v_add_f32_dpp v52, v52, v52 row_ror:4 row_mask:0xf bank_mask:0xf
v_add_f32_dpp v53, v53, v53 row_ror:4 row_mask:0xf bank_mask:0xf
v_mfma_f32_16x16x32_bf16 v[168:171], a[108:111], a[12:15], v[168:171]
ds_read_b128 a[148:151], v5 offset:31744
v_add_f32_dpp v54, v54, v54 row_ror:4 row_mask:0xf bank_mask:0xf
v_mfma_f32_16x16x32_bf16 v[144:147], a[108:111], a[4:7], v[144:147]
v_add_f32_dpp v55, v55, v55 row_ror:4 row_mask:0xf bank_mask:0xf
v_mfma_f32_16x16x32_bf16 v[144:147], a[104:107], a[0:3], v[144:147]
buffer_load_dwordx4 a[72:75], v2, s[40:43], s35 offen offset:1024 sc1
v_mfma_f32_16x16x32_bf16 v[148:151], a[112:115], a[0:3], v[148:151]
v_add_f32_dpp v48, v48, v48 row_ror:2 row_mask:0xf bank_mask:0xf
v_add_f32_dpp v49, v49, v49 row_ror:2 row_mask:0xf bank_mask:0xf
v_mfma_f32_16x16x32_bf16 v[148:151], a[116:119], a[4:7], v[148:151]
v_add_f32_dpp v50, v50, v50 row_ror:2 row_mask:0xf bank_mask:0xf
v_mfma_f32_16x16x32_bf16 v[172:175], a[116:119], a[12:15], v[172:175]
v_add_f32_dpp v51, v51, v51 row_ror:2 row_mask:0xf bank_mask:0xf
v_mfma_f32_16x16x32_bf16 v[172:175], a[112:115], a[8:11], v[172:175]
v_add_f32_dpp v52, v52, v52 row_ror:2 row_mask:0xf bank_mask:0xf
v_mfma_f32_16x16x32_bf16 v[196:199], a[112:115], a[16:19], v[196:199]
buffer_load_dwordx4 a[76:79], v2, s[40:43], s33 offen offset:1024 sc1
v_mfma_f32_16x16x32_bf16 v[196:199], a[116:119], a[20:23], v[196:199]
v_add_f32_dpp v53, v53, v53 row_ror:2 row_mask:0xf bank_mask:0xf
v_add_f32_dpp v54, v54, v54 row_ror:2 row_mask:0xf bank_mask:0xf
v_mfma_f32_16x16x32_bf16 v[220:223], a[116:119], a[28:31], v[220:223]
v_add_f32_dpp v55, v55, v55 row_ror:2 row_mask:0xf bank_mask:0xf
v_mfma_f32_16x16x32_bf16 v[220:223], a[112:115], a[24:27], v[220:223]
v_add_f32_dpp v48, v48, v48 row_ror:1 row_mask:0xf bank_mask:0xf
s_waitcnt lgkmcnt(0)
v_mfma_f32_16x16x32_bf16 v[224:227], a[128:131], a[24:27], v[224:227]
ds_read_b128 a[96:99], v5 offset:38912
v_add_f32_dpp v49, v49, v49 row_ror:1 row_mask:0xf bank_mask:0xf
v_mfma_f32_16x16x32_bf16 v[224:227], a[132:135], a[28:31], v[224:227]
buffer_load_dwordx4 a[80:83], v2, s[40:43], s35 offen offset:2048 sc1
v_mfma_f32_16x16x32_bf16 v[200:203], a[132:135], a[20:23], v[200:203]
ds_read_b128 a[100:103], v5 offset:45056
v_add_f32_dpp v50, v50, v50 row_ror:1 row_mask:0xf bank_mask:0xf
v_mfma_f32_16x16x32_bf16 v[200:203], a[128:131], a[16:19], v[200:203]
v_add_f32_dpp v51, v51, v51 row_ror:1 row_mask:0xf bank_mask:0xf
v_add_f32_dpp v52, v52, v52 row_ror:1 row_mask:0xf bank_mask:0xf
v_mfma_f32_16x16x32_bf16 v[176:179], a[128:131], a[8:11], v[176:179]
v_add_f32_dpp v53, v53, v53 row_ror:1 row_mask:0xf bank_mask:0xf
v_add_f32_dpp v54, v54, v54 row_ror:1 row_mask:0xf bank_mask:0xf
v_mfma_f32_16x16x32_bf16 v[176:179], a[132:135], a[12:15], v[176:179]
buffer_load_dwordx4 a[84:87], v2, s[40:43], s33 offen offset:2048 sc1
v_mfma_f32_16x16x32_bf16 v[152:155], a[132:135], a[4:7], v[152:155]
ds_read_b128 a[104:107], v5 offset:39936
v_add_f32_dpp v55, v55, v55 row_ror:1 row_mask:0xf bank_mask:0xf
v_mfma_f32_16x16x32_bf16 v[152:155], a[128:131], a[0:3], v[152:155]
v_add_u32 v233, 159744, v233
s_lshl_b32 s36, s28, 6
v_mfma_f32_16x16x32_bf16 v[132:135], a[136:139], a[0:3], v[132:135]
ds_read_b128 a[108:111], v5 offset:46080
s_lshl_b32 s37, s39, 6
v_mfma_f32_16x16x32_bf16 v[132:135], a[140:143], a[4:7], v[132:135]
v_add_u32 v232, s36, v233
v_mfma_f32_16x16x32_bf16 v[156:159], a[140:143], a[12:15], v[156:159]
buffer_load_dwordx4 v1, s[4:7], s44 offen offset:2048 sc1 lds
s_add_u32 m0, s18, 0x0
v_mfma_f32_16x16x32_bf16 v[156:159], a[136:139], a[8:11], v[156:159]
s_add_u32 s44, s50, 0x1424000
ds_read_b128 a[112:115], v5 offset:40960
v_mfma_f32_16x16x32_bf16 v[180:183], a[136:139], a[16:19], v[180:183]
v_add_u32 v235, s37, v233
v_mfma_f32_16x16x32_bf16 v[180:183], a[140:143], a[20:23], v[180:183]
ds_read_b128 a[116:119], v5 offset:47104
v_mfma_f32_16x16x32_bf16 v[204:207], a[140:143], a[28:31], v[204:207]
v_mfma_f32_16x16x32_bf16 v[204:207], a[136:139], a[24:27], v[204:207]
buffer_load_dwordx4 a[88:91], v2, s[40:43], s35 offen offset:3072 sc1
v_mfma_f32_16x16x32_bf16 v[208:211], a[144:147], a[24:27], v[208:211]
v_mfma_f32_16x16x32_bf16 v[208:211], a[148:151], a[28:31], v[208:211]
v_mfma_f32_16x16x32_bf16 v[184:187], a[148:151], a[20:23], v[184:187]
v_mfma_f32_16x16x32_bf16 v[184:187], a[144:147], a[16:19], v[184:187]
v_mfma_f32_16x16x32_bf16 v[160:163], a[144:147], a[8:11], v[160:163]
buffer_load_dwordx4 a[92:95], v2, s[40:43], s33 offen offset:3072 sc1
s_add_u32 s35, s35, 8192
v_mfma_f32_16x16x32_bf16 v[160:163], a[148:151], a[12:15], v[160:163]
s_add_u32 s33, s33, 8192
v_mfma_f32_16x16x32_bf16 v[136:139], a[148:151], a[4:7], v[136:139]
v_mfma_f32_16x16x32_bf16 v[136:139], a[144:147], a[0:3], v[136:139]
s_waitcnt vmcnt(10) lgkmcnt(0)
v_mfma_f32_16x16x32_bf16 v[140:143], a[96:99], a[32:35], v[140:143]
ds_read_b128 a[128:131], v5 offset:41984
v_mfma_f32_16x16x32_bf16 v[140:143], a[100:103], a[36:39], v[140:143]
buffer_load_dwordx4 a[0:3], v2, s[40:43], s35 offen offset:0 sc1
v_mfma_f32_16x16x32_bf16 v[164:167], a[100:103], a[44:47], v[164:167]
ds_read_b128 a[132:135], v5 offset:48128
v_mfma_f32_16x16x32_bf16 v[164:167], a[96:99], a[40:43], v[164:167]
ds_write_b128 v232, v[48:51]
v_mfma_f32_16x16x32_bf16 v[188:191], a[96:99], a[48:51], v[188:191]
ds_write_b128 v235, v[52:55]
v_mfma_f32_16x16x32_bf16 v[188:191], a[100:103], a[52:55], v[188:191]
buffer_load_dwordx4 v1, s[4:7], s44 offen offset:0 sc1 lds
v_mfma_f32_16x16x32_bf16 v[212:215], a[100:103], a[60:63], v[212:215]
ds_read_b128 a[136:139], v5 offset:36864
v_mfma_f32_16x16x32_bf16 v[212:215], a[96:99], a[56:59], v[212:215]
v_mfma_f32_16x16x32_bf16 v[216:219], a[104:107], a[56:59], v[216:219]
ds_read_b128 a[140:143], v5 offset:43008
v_mfma_f32_16x16x32_bf16 v[216:219], a[108:111], a[60:63], v[216:219]
buffer_load_dwordx4 a[4:7], v2, s[40:43], s33 offen offset:0 sc1
v_mfma_f32_16x16x32_bf16 v[192:195], a[108:111], a[52:55], v[192:195]
ds_read_b128 a[144:147], v5 offset:37888
v_mfma_f32_16x16x32_bf16 v[192:195], a[104:107], a[48:51], v[192:195]
v_mfma_f32_16x16x32_bf16 v[168:171], a[104:107], a[40:43], v[168:171]
v_mfma_f32_16x16x32_bf16 v[168:171], a[108:111], a[44:47], v[168:171]
buffer_load_dwordx4 a[8:11], v2, s[40:43], s35 offen offset:1024 sc1
v_mfma_f32_16x16x32_bf16 v[144:147], a[108:111], a[36:39], v[144:147]
ds_read_b128 a[148:151], v5 offset:44032
v_mfma_f32_16x16x32_bf16 v[144:147], a[104:107], a[32:35], v[144:147]
v_mfma_f32_16x16x32_bf16 v[148:151], a[112:115], a[32:35], v[148:151]
v_mfma_f32_16x16x32_bf16 v[148:151], a[116:119], a[36:39], v[148:151]
buffer_load_dwordx4 v1, s[4:7], s44 offen offset:1024 sc1 lds
v_mfma_f32_16x16x32_bf16 v[172:175], a[116:119], a[44:47], v[172:175]
v_mfma_f32_16x16x32_bf16 v[172:175], a[112:115], a[40:43], v[172:175]
v_mfma_f32_16x16x32_bf16 v[196:199], a[112:115], a[48:51], v[196:199]
v_mfma_f32_16x16x32_bf16 v[196:199], a[116:119], a[52:55], v[196:199]
buffer_load_dwordx4 a[12:15], v2, s[40:43], s33 offen offset:1024 sc1
v_mfma_f32_16x16x32_bf16 v[220:223], a[116:119], a[60:63], v[220:223]
v_mfma_f32_16x16x32_bf16 v[220:223], a[112:115], a[56:59], v[220:223]
s_waitcnt lgkmcnt(0)
s_barrier
v_mfma_f32_16x16x32_bf16 v[224:227], a[128:131], a[56:59], v[224:227]
v_add_u32 v5, 98304, v1
v_mfma_f32_16x16x32_bf16 v[224:227], a[132:135], a[60:63], v[224:227]
buffer_load_dwordx4 a[16:19], v2, s[40:43], s35 offen offset:2048 sc1
v_mfma_f32_16x16x32_bf16 v[200:203], a[132:135], a[52:55], v[200:203]
ds_read_b128 a[96:99], v5 offset:2048
v_mfma_f32_16x16x32_bf16 v[200:203], a[128:131], a[48:51], v[200:203]
ds_read_b128 a[100:103], v5 offset:8192
v_mfma_f32_16x16x32_bf16 v[176:179], a[128:131], a[40:43], v[176:179]
ds_read_b128 v[48:51], v233 offset:0
v_mfma_f32_16x16x32_bf16 v[176:179], a[132:135], a[44:47], v[176:179]
buffer_load_dwordx4 a[20:23], v2, s[40:43], s33 offen offset:2048 sc1
v_mfma_f32_16x16x32_bf16 v[152:155], a[132:135], a[36:39], v[152:155]
ds_read_b128 a[104:107], v5 offset:3072
v_mfma_f32_16x16x32_bf16 v[152:155], a[128:131], a[32:35], v[152:155]
v_mfma_f32_16x16x32_bf16 v[132:135], a[136:139], a[32:35], v[132:135]
ds_read_b128 a[108:111], v5 offset:9216
v_mfma_f32_16x16x32_bf16 v[132:135], a[140:143], a[36:39], v[132:135]
v_mfma_f32_16x16x32_bf16 v[156:159], a[140:143], a[44:47], v[156:159]
buffer_load_dwordx4 v1, s[4:7], s44 offen offset:2048 sc1 lds
s_add_u32 m0, s18, 0x3000
v_mfma_f32_16x16x32_bf16 v[156:159], a[136:139], a[40:43], v[156:159]
s_add_u32 s44, s50, 0x1427000
ds_read_b128 a[112:115], v5 offset:4096
v_mfma_f32_16x16x32_bf16 v[180:183], a[136:139], a[48:51], v[180:183]
ds_read_b128 v[52:55], v233 offset:64
v_mfma_f32_16x16x32_bf16 v[180:183], a[140:143], a[52:55], v[180:183]
ds_read_b128 a[116:119], v5 offset:10240
v_mfma_f32_16x16x32_bf16 v[204:207], a[140:143], a[60:63], v[204:207]
v_mfma_f32_16x16x32_bf16 v[204:207], a[136:139], a[56:59], v[204:207]
buffer_load_dwordx4 a[24:27], v2, s[40:43], s35 offen offset:3072 sc1
v_mfma_f32_16x16x32_bf16 v[208:211], a[144:147], a[56:59], v[208:211]
v_mfma_f32_16x16x32_bf16 v[208:211], a[148:151], a[60:63], v[208:211]
v_mfma_f32_16x16x32_bf16 v[184:187], a[148:151], a[52:55], v[184:187]
v_mfma_f32_16x16x32_bf16 v[184:187], a[144:147], a[48:51], v[184:187]
v_mfma_f32_16x16x32_bf16 v[160:163], a[144:147], a[40:43], v[160:163]
buffer_load_dwordx4 a[28:31], v2, s[40:43], s33 offen offset:3072 sc1
s_add_u32 s35, s35, 8192
v_mfma_f32_16x16x32_bf16 v[160:163], a[148:151], a[44:47], v[160:163]
s_add_u32 s33, s33, 8192
ds_read_b128 v[56:59], v233 offset:128
v_mfma_f32_16x16x32_bf16 v[136:139], a[148:151], a[36:39], v[136:139]
v_mfma_f32_16x16x32_bf16 v[136:139], a[144:147], a[32:35], v[136:139]
s_waitcnt vmcnt(11) lgkmcnt(1)
v_mfma_f32_16x16x32_bf16 v[140:143], a[96:99], a[64:67], v[140:143]
ds_read_b128 a[128:131], v5 offset:5120
v_mfma_f32_16x16x32_bf16 v[140:143], a[100:103], a[68:71], v[140:143]
buffer_load_dwordx4 a[32:35], v2, s[40:43], s35 offen offset:0 sc1
v_mfma_f32_16x16x32_bf16 v[164:167], a[100:103], a[76:79], v[164:167]
ds_read_b128 a[132:135], v5 offset:11264
v_mfma_f32_16x16x32_bf16 v[164:167], a[96:99], a[72:75], v[164:167]
v_mfma_f32_16x16x32_bf16 v[188:191], a[96:99], a[80:83], v[188:191]
v_mfma_f32_16x16x32_bf16 v[188:191], a[100:103], a[84:87], v[188:191]
buffer_load_dwordx4 a[36:39], v2, s[40:43], s33 offen offset:0 sc1
v_mfma_f32_16x16x32_bf16 v[212:215], a[100:103], a[92:95], v[212:215]
ds_read_b128 a[136:139], v5 offset:0
v_mfma_f32_16x16x32_bf16 v[212:215], a[96:99], a[88:91], v[212:215]
v_mfma_f32_16x16x32_bf16 v[216:219], a[104:107], a[88:91], v[216:219]
ds_read_b128 a[140:143], v5 offset:6144
v_mfma_f32_16x16x32_bf16 v[216:219], a[108:111], a[92:95], v[216:219]
ds_read_b128 v[60:63], v233 offset:192
v_mfma_f32_16x16x32_bf16 v[192:195], a[108:111], a[84:87], v[192:195]
buffer_load_dwordx4 v1, s[4:7], s44 offen offset:0 sc1 lds
v_mfma_f32_16x16x32_bf16 v[192:195], a[104:107], a[80:83], v[192:195]
ds_read_b128 a[144:147], v5 offset:1024
v_mfma_f32_16x16x32_bf16 v[168:171], a[104:107], a[72:75], v[168:171]
v_mfma_f32_16x16x32_bf16 v[168:171], a[108:111], a[76:79], v[168:171]
ds_read_b128 a[148:151], v5 offset:7168
v_mfma_f32_16x16x32_bf16 v[144:147], a[108:111], a[68:71], v[144:147]
v_mfma_f32_16x16x32_bf16 v[144:147], a[104:107], a[64:67], v[144:147]
buffer_load_dwordx4 a[40:43], v2, s[40:43], s35 offen offset:1024 sc1
v_mfma_f32_16x16x32_bf16 v[148:151], a[112:115], a[64:67], v[148:151]
v_mfma_f32_16x16x32_bf16 v[148:151], a[116:119], a[68:71], v[148:151]
v_mfma_f32_16x16x32_bf16 v[172:175], a[116:119], a[76:79], v[172:175]
ds_read_b128 v[64:67], v233 offset:256
v_mfma_f32_16x16x32_bf16 v[172:175], a[112:115], a[72:75], v[172:175]
v_mfma_f32_16x16x32_bf16 v[196:199], a[112:115], a[80:83], v[196:199]
buffer_load_dwordx4 a[44:47], v2, s[40:43], s33 offen offset:1024 sc1
v_mfma_f32_16x16x32_bf16 v[196:199], a[116:119], a[84:87], v[196:199]
v_mfma_f32_16x16x32_bf16 v[220:223], a[116:119], a[92:95], v[220:223]
v_mfma_f32_16x16x32_bf16 v[220:223], a[112:115], a[88:91], v[220:223]
s_waitcnt lgkmcnt(1)
v_mfma_f32_16x16x32_bf16 v[224:227], a[128:131], a[88:91], v[224:227]
ds_read_b128 a[96:99], v5 offset:14336
v_mfma_f32_16x16x32_bf16 v[224:227], a[132:135], a[92:95], v[224:227]
buffer_load_dwordx4 a[48:51], v2, s[40:43], s35 offen offset:2048 sc1
v_mfma_f32_16x16x32_bf16 v[200:203], a[132:135], a[84:87], v[200:203]
ds_read_b128 a[100:103], v5 offset:20480
v_mfma_f32_16x16x32_bf16 v[200:203], a[128:131], a[80:83], v[200:203]
v_mfma_f32_16x16x32_bf16 v[176:179], a[128:131], a[72:75], v[176:179]
v_mfma_f32_16x16x32_bf16 v[176:179], a[132:135], a[76:79], v[176:179]
buffer_load_dwordx4 a[52:55], v2, s[40:43], s33 offen offset:2048 sc1
v_mfma_f32_16x16x32_bf16 v[152:155], a[132:135], a[68:71], v[152:155]
ds_read_b128 a[104:107], v5 offset:15360
v_mfma_f32_16x16x32_bf16 v[152:155], a[128:131], a[64:67], v[152:155]
ds_read_b128 v[68:71], v233 offset:320
v_mfma_f32_16x16x32_bf16 v[132:135], a[136:139], a[64:67], v[132:135]
ds_read_b128 a[108:111], v5 offset:21504
v_mfma_f32_16x16x32_bf16 v[132:135], a[140:143], a[68:71], v[132:135]
v_mfma_f32_16x16x32_bf16 v[156:159], a[140:143], a[76:79], v[156:159]
buffer_load_dwordx4 v1, s[4:7], s44 offen offset:1024 sc1 lds
v_mfma_f32_16x16x32_bf16 v[156:159], a[136:139], a[72:75], v[156:159]
ds_read_b128 a[112:115], v5 offset:16384
v_mfma_f32_16x16x32_bf16 v[180:183], a[136:139], a[80:83], v[180:183]
v_mfma_f32_16x16x32_bf16 v[180:183], a[140:143], a[84:87], v[180:183]
ds_read_b128 a[116:119], v5 offset:22528
v_mfma_f32_16x16x32_bf16 v[204:207], a[140:143], a[92:95], v[204:207]
v_mfma_f32_16x16x32_bf16 v[204:207], a[136:139], a[88:91], v[204:207]
buffer_load_dwordx4 a[56:59], v2, s[40:43], s35 offen offset:3072 sc1
v_mfma_f32_16x16x32_bf16 v[208:211], a[144:147], a[88:91], v[208:211]
v_mfma_f32_16x16x32_bf16 v[208:211], a[148:151], a[92:95], v[208:211]
v_mfma_f32_16x16x32_bf16 v[184:187], a[148:151], a[84:87], v[184:187]
v_mfma_f32_16x16x32_bf16 v[184:187], a[144:147], a[80:83], v[184:187]
v_mfma_f32_16x16x32_bf16 v[160:163], a[144:147], a[72:75], v[160:163]
buffer_load_dwordx4 a[60:63], v2, s[40:43], s33 offen offset:3072 sc1
s_add_u32 s35, s35, 8192
v_mfma_f32_16x16x32_bf16 v[160:163], a[148:151], a[76:79], v[160:163]
s_add_u32 s33, s33, 8192
v_mfma_f32_16x16x32_bf16 v[136:139], a[148:151], a[68:71], v[136:139]
v_mfma_f32_16x16x32_bf16 v[136:139], a[144:147], a[64:67], v[136:139]
s_waitcnt vmcnt(10) lgkmcnt(0)
v_mfma_f32_16x16x32_bf16 v[140:143], a[96:99], a[0:3], v[140:143]
ds_read_b128 a[128:131], v5 offset:17408
v_add_f32 v92, v92, v96
v_mfma_f32_16x16x32_bf16 v[140:143], a[100:103], a[4:7], v[140:143]
buffer_load_dwordx4 a[64:67], v2, s[40:43], s35 offen offset:0 sc1
v_mfma_f32_16x16x32_bf16 v[164:167], a[100:103], a[12:15], v[164:167]
ds_read_b128 a[132:135], v5 offset:23552
v_add_f32 v100, v100, v104
v_mfma_f32_16x16x32_bf16 v[164:167], a[96:99], a[8:11], v[164:167]
v_add_f32 v108, v108, v112
v_add_f32 v116, v116, v120
v_mfma_f32_16x16x32_bf16 v[188:191], a[96:99], a[16:19], v[188:191]
v_add_f32 v93, v93, v97
v_add_f32 v101, v101, v105
v_mfma_f32_16x16x32_bf16 v[188:191], a[100:103], a[20:23], v[188:191]
buffer_load_dwordx4 a[68:71], v2, s[40:43], s33 offen offset:0 sc1
v_mfma_f32_16x16x32_bf16 v[212:215], a[100:103], a[28:31], v[212:215]
ds_read_b128 a[136:139], v5 offset:12288
v_add_f32 v109, v109, v113
v_mfma_f32_16x16x32_bf16 v[212:215], a[96:99], a[24:27], v[212:215]
v_add_f32 v117, v117, v121
v_add_f32 v94, v94, v98
v_mfma_f32_16x16x32_bf16 v[216:219], a[104:107], a[24:27], v[216:219]
ds_read_b128 a[140:143], v5 offset:18432
v_add_f32 v102, v102, v106
v_mfma_f32_16x16x32_bf16 v[216:219], a[108:111], a[28:31], v[216:219]
v_add_f32 v110, v110, v114
v_mfma_f32_16x16x32_bf16 v[192:195], a[108:111], a[20:23], v[192:195]
buffer_load_dwordx4 v1, s[4:7], s44 offen offset:2048 sc1 lds
s_add_u32 m0, s18, 0x6000
v_mfma_f32_16x16x32_bf16 v[192:195], a[104:107], a[16:19], v[192:195]
s_add_u32 s44, s50, 0x142a000
ds_read_b128 a[144:147], v5 offset:13312
v_mfma_f32_16x16x32_bf16 v[168:171], a[104:107], a[8:11], v[168:171]
v_add_f32 v118, v118, v122
v_add_f32 v95, v95, v99
v_mfma_f32_16x16x32_bf16 v[168:171], a[108:111], a[12:15], v[168:171]
ds_read_b128 a[148:151], v5 offset:19456
v_add_f32 v103, v103, v107
v_mfma_f32_16x16x32_bf16 v[144:147], a[108:111], a[4:7], v[144:147]
v_add_f32 v111, v111, v115
v_add_f32 v119, v119, v123
v_mfma_f32_16x16x32_bf16 v[144:147], a[104:107], a[0:3], v[144:147]
buffer_load_dwordx4 a[72:75], v2, s[40:43], s35 offen offset:1024 sc1
v_mfma_f32_16x16x32_bf16 v[148:151], a[112:115], a[0:3], v[148:151]
v_add_f32_dpp v92, v92, v92 row_ror:8 row_mask:0xf bank_mask:0xf
v_add_f32_dpp v100, v100, v100 row_ror:8 row_mask:0xf bank_mask:0xf
v_mfma_f32_16x16x32_bf16 v[148:151], a[116:119], a[4:7], v[148:151]
v_add_f32_dpp v108, v108, v108 row_ror:8 row_mask:0xf bank_mask:0xf
v_mfma_f32_16x16x32_bf16 v[172:175], a[116:119], a[12:15], v[172:175]
v_add_f32_dpp v116, v116, v116 row_ror:8 row_mask:0xf bank_mask:0xf
v_mfma_f32_16x16x32_bf16 v[172:175], a[112:115], a[8:11], v[172:175]
v_add_f32_dpp v93, v93, v93 row_ror:8 row_mask:0xf bank_mask:0xf
v_mfma_f32_16x16x32_bf16 v[196:199], a[112:115], a[16:19], v[196:199]
buffer_load_dwordx4 a[76:79], v2, s[40:43], s33 offen offset:1024 sc1
v_mfma_f32_16x16x32_bf16 v[196:199], a[116:119], a[20:23], v[196:199]
v_add_f32_dpp v101, v101, v101 row_ror:8 row_mask:0xf bank_mask:0xf
v_add_f32_dpp v109, v109, v109 row_ror:8 row_mask:0xf bank_mask:0xf
v_mfma_f32_16x16x32_bf16 v[220:223], a[116:119], a[28:31], v[220:223]
v_add_f32_dpp v117, v117, v117 row_ror:8 row_mask:0xf bank_mask:0xf
v_mfma_f32_16x16x32_bf16 v[220:223], a[112:115], a[24:27], v[220:223]
s_waitcnt lgkmcnt(0)
s_barrier
v_mfma_f32_16x16x32_bf16 v[224:227], a[128:131], a[24:27], v[224:227]
ds_read_b128 a[96:99], v5 offset:26624
v_accvgpr_write_b32 a216, v48
v_mfma_f32_16x16x32_bf16 v[224:227], a[132:135], a[28:31], v[224:227]
buffer_load_dwordx4 a[80:83], v2, s[40:43], s35 offen offset:2048 sc1
v_mfma_f32_16x16x32_bf16 v[200:203], a[132:135], a[20:23], v[200:203]
ds_read_b128 a[100:103], v5 offset:32768
v_add_f32_dpp v92, v94, v94 row_ror:8 row_mask:0xf bank_mask:0xc
v_mfma_f32_16x16x32_bf16 v[200:203], a[128:131], a[16:19], v[200:203]
v_accvgpr_write_b32 a217, v49
v_add_f32_dpp v100, v102, v102 row_ror:8 row_mask:0xf bank_mask:0xc
v_mfma_f32_16x16x32_bf16 v[176:179], a[128:131], a[8:11], v[176:179]
v_add_f32_dpp v108, v110, v110 row_ror:8 row_mask:0xf bank_mask:0xc
v_add_f32_dpp v116, v118, v118 row_ror:8 row_mask:0xf bank_mask:0xc
v_mfma_f32_16x16x32_bf16 v[176:179], a[132:135], a[12:15], v[176:179]
buffer_load_dwordx4 v1, s[4:7], s44 offen offset:0 sc1 lds
v_mfma_f32_16x16x32_bf16 v[152:155], a[132:135], a[4:7], v[152:155]
ds_read_b128 a[104:107], v5 offset:27648
v_accvgpr_write_b32 a218, v50
v_mfma_f32_16x16x32_bf16 v[152:155], a[128:131], a[0:3], v[152:155]
v_add_f32_dpp v93, v95, v95 row_ror:8 row_mask:0xf bank_mask:0xc
v_add_f32_dpp v101, v103, v103 row_ror:8 row_mask:0xf bank_mask:0xc
v_mfma_f32_16x16x32_bf16 v[132:135], a[136:139], a[0:3], v[132:135]
ds_read_b128 a[108:111], v5 offset:33792
v_add_f32_dpp v109, v111, v111 row_ror:8 row_mask:0xf bank_mask:0xc
v_mfma_f32_16x16x32_bf16 v[132:135], a[140:143], a[4:7], v[132:135]
buffer_load_dwordx4 a[84:87], v2, s[40:43], s33 offen offset:2048 sc1
v_mfma_f32_16x16x32_bf16 v[156:159], a[140:143], a[12:15], v[156:159]
ds_read_b128 a[112:115], v5 offset:28672
v_accvgpr_write_b32 a219, v51
v_mfma_f32_16x16x32_bf16 v[156:159], a[136:139], a[8:11], v[156:159]
v_add_f32_dpp v117, v119, v119 row_ror:8 row_mask:0xf bank_mask:0xc
v_mfma_f32_16x16x32_bf16 v[180:183], a[136:139], a[16:19], v[180:183]
v_accvgpr_write_b32 a220, v52
v_mfma_f32_16x16x32_bf16 v[180:183], a[140:143], a[20:23], v[180:183]
buffer_load_dwordx4 a[88:91], v2, s[40:43], s35 offen offset:3072 sc1
v_mfma_f32_16x16x32_bf16 v[204:207], a[140:143], a[28:31], v[204:207]
ds_read_b128 a[116:119], v5 offset:34816
v_mfma_f32_16x16x32_bf16 v[204:207], a[136:139], a[24:27], v[204:207]
v_accvgpr_write_b32 a221, v53
v_mfma_f32_16x16x32_bf16 v[208:211], a[144:147], a[24:27], v[208:211]
v_permlane32_swap_b32 v92, v93
v_mfma_f32_16x16x32_bf16 v[208:211], a[148:151], a[28:31], v[208:211]
buffer_load_dwordx4 v1, s[4:7], s44 offen offset:1024 sc1 lds
v_mfma_f32_16x16x32_bf16 v[184:187], a[148:151], a[20:23], v[184:187]
v_accvgpr_write_b32 a222, v54
v_mfma_f32_16x16x32_bf16 v[184:187], a[144:147], a[16:19], v[184:187]
v_permlane32_swap_b32 v100, v101
v_mfma_f32_16x16x32_bf16 v[160:163], a[144:147], a[8:11], v[160:163]
v_permlane32_swap_b32 v108, v109
v_mfma_f32_16x16x32_bf16 v[160:163], a[148:151], a[12:15], v[160:163]
buffer_load_dwordx4 a[92:95], v2, s[40:43], s33 offen offset:3072 sc1
s_add_u32 s35, s35, 8192
v_mfma_f32_16x16x32_bf16 v[136:139], a[148:151], a[4:7], v[136:139]
s_add_u32 s33, s33, 8192
v_accvgpr_write_b32 a223, v55
v_mfma_f32_16x16x32_bf16 v[136:139], a[144:147], a[0:3], v[136:139]
s_waitcnt vmcnt(11) lgkmcnt(0)
v_mfma_f32_16x16x32_bf16 v[140:143], a[96:99], a[32:35], v[140:143]
ds_read_b128 a[128:131], v5 offset:29696
v_accvgpr_write_b32 a224, v56
v_mfma_f32_16x16x32_bf16 v[140:143], a[100:103], a[36:39], v[140:143]
buffer_load_dwordx4 a[0:3], v2, s[40:43], s35 offen offset:0 sc1
v_mfma_f32_16x16x32_bf16 v[164:167], a[100:103], a[44:47], v[164:167]
ds_read_b128 a[132:135], v5 offset:35840
v_mfma_f32_16x16x32_bf16 v[164:167], a[96:99], a[40:43], v[164:167]
v_accvgpr_write_b32 a225, v57
v_mfma_f32_16x16x32_bf16 v[188:191], a[96:99], a[48:51], v[188:191]
v_permlane32_swap_b32 v116, v117
v_mfma_f32_16x16x32_bf16 v[188:191], a[100:103], a[52:55], v[188:191]
buffer_load_dwordx4 a[4:7], v2, s[40:43], s33 offen offset:0 sc1
v_mfma_f32_16x16x32_bf16 v[212:215], a[100:103], a[60:63], v[212:215]
ds_read_b128 a[136:139], v5 offset:24576
v_accvgpr_write_b32 a226, v58
v_mfma_f32_16x16x32_bf16 v[212:215], a[96:99], a[56:59], v[212:215]
v_add_f32 v92, v92, v93
v_add_f32 v100, v100, v101
v_mfma_f32_16x16x32_bf16 v[216:219], a[104:107], a[56:59], v[216:219]
ds_read_b128 a[140:143], v5 offset:30720
v_add_f32 v108, v108, v109
v_mfma_f32_16x16x32_bf16 v[216:219], a[108:111], a[60:63], v[216:219]
v_accvgpr_write_b32 a227, v59
v_add_f32 v116, v116, v117
v_mfma_f32_16x16x32_bf16 v[192:195], a[108:111], a[52:55], v[192:195]
buffer_load_dwordx4 v1, s[4:7], s44 offen offset:2048 sc1 lds
s_add_u32 m0, s18, 0x9000
v_mfma_f32_16x16x32_bf16 v[192:195], a[104:107], a[48:51], v[192:195]
s_add_u32 s44, s50, 0x142d000
ds_read_b128 a[144:147], v5 offset:25600
v_mfma_f32_16x16x32_bf16 v[168:171], a[104:107], a[40:43], v[168:171]
v_accvgpr_write_b32 a228, v60
v_mov_b32 v94, v92
v_mfma_f32_16x16x32_bf16 v[168:171], a[108:111], a[44:47], v[168:171]
ds_read_b128 a[148:151], v5 offset:31744
v_mov_b32 v102, v100
v_mfma_f32_16x16x32_bf16 v[144:147], a[108:111], a[36:39], v[144:147]
v_mov_b32 v110, v108
v_mov_b32 v118, v116
v_mfma_f32_16x16x32_bf16 v[144:147], a[104:107], a[32:35], v[144:147]
buffer_load_dwordx4 a[8:11], v2, s[40:43], s35 offen offset:1024 sc1
v_mfma_f32_16x16x32_bf16 v[148:151], a[112:115], a[32:35], v[148:151]
v_accvgpr_write_b32 a229, v61
v_mfma_f32_16x16x32_bf16 v[148:151], a[116:119], a[36:39], v[148:151]
v_permlane16_swap_b32 v92, v94
v_mfma_f32_16x16x32_bf16 v[172:175], a[116:119], a[44:47], v[172:175]
v_accvgpr_write_b32 a230, v62
v_mfma_f32_16x16x32_bf16 v[172:175], a[112:115], a[40:43], v[172:175]
v_permlane16_swap_b32 v100, v102
v_mfma_f32_16x16x32_bf16 v[196:199], a[112:115], a[48:51], v[196:199]
buffer_load_dwordx4 a[12:15], v2, s[40:43], s33 offen offset:1024 sc1
v_mfma_f32_16x16x32_bf16 v[196:199], a[116:119], a[52:55], v[196:199]
v_accvgpr_write_b32 a231, v63
v_mfma_f32_16x16x32_bf16 v[220:223], a[116:119], a[60:63], v[220:223]
v_permlane16_swap_b32 v108, v110
v_mfma_f32_16x16x32_bf16 v[220:223], a[112:115], a[56:59], v[220:223]
s_waitcnt lgkmcnt(0)
v_mfma_f32_16x16x32_bf16 v[224:227], a[128:131], a[56:59], v[224:227]
ds_read_b128 a[96:99], v5 offset:38912
v_accvgpr_write_b32 a232, v64
v_mfma_f32_16x16x32_bf16 v[224:227], a[132:135], a[60:63], v[224:227]
buffer_load_dwordx4 a[16:19], v2, s[40:43], s35 offen offset:2048 sc1
v_mfma_f32_16x16x32_bf16 v[200:203], a[132:135], a[52:55], v[200:203]
ds_read_b128 a[100:103], v5 offset:45056
v_mfma_f32_16x16x32_bf16 v[200:203], a[128:131], a[48:51], v[200:203]
v_accvgpr_write_b32 a233, v65
v_mfma_f32_16x16x32_bf16 v[176:179], a[128:131], a[40:43], v[176:179]
L_stub6:
s_cbranch_execz L_stub7
v_permlane16_swap_b32 v116, v118
v_mfma_f32_16x16x32_bf16 v[176:179], a[132:135], a[44:47], v[176:179]
buffer_load_dwordx4 a[20:23], v2, s[40:43], s33 offen offset:2048 sc1
v_mfma_f32_16x16x32_bf16 v[152:155], a[132:135], a[36:39], v[152:155]
ds_read_b128 a[104:107], v5 offset:39936
v_accvgpr_write_b32 a234, v66
v_mfma_f32_16x16x32_bf16 v[152:155], a[128:131], a[32:35], v[152:155]
v_add_f32 v92, v92, v94
v_add_f32 v100, v100, v102
v_mfma_f32_16x16x32_bf16 v[132:135], a[136:139], a[32:35], v[132:135]
ds_read_b128 a[108:111], v5 offset:46080
v_add_f32 v108, v108, v110
v_mfma_f32_16x16x32_bf16 v[132:135], a[140:143], a[36:39], v[132:135]
v_accvgpr_write_b32 a235, v67
v_add_f32 v116, v116, v118
v_mfma_f32_16x16x32_bf16 v[156:159], a[140:143], a[44:47], v[156:159]
buffer_load_dwordx4 v1, s[4:7], s44 offen offset:0 sc1 lds
v_mfma_f32_16x16x32_bf16 v[156:159], a[136:139], a[40:43], v[156:159]
ds_read_b128 a[112:115], v5 offset:40960
v_mov_b32 v94, v92
v_mfma_f32_16x16x32_bf16 v[180:183], a[136:139], a[48:51], v[180:183]
v_accvgpr_write_b32 a236, v68
v_mov_b32 v102, v100
v_mfma_f32_16x16x32_bf16 v[180:183], a[140:143], a[52:55], v[180:183]
ds_read_b128 a[116:119], v5 offset:47104
v_mov_b32 v110, v108
v_mfma_f32_16x16x32_bf16 v[204:207], a[140:143], a[60:63], v[204:207]
v_mov_b32 v118, v116
v_mfma_f32_16x16x32_bf16 v[204:207], a[136:139], a[56:59], v[204:207]
buffer_load_dwordx4 a[24:27], v2, s[40:43], s35 offen offset:3072 sc1
v_mfma_f32_16x16x32_bf16 v[208:211], a[144:147], a[56:59], v[208:211]
v_accvgpr_write_b32 a237, v69
v_mfma_f32_16x16x32_bf16 v[208:211], a[148:151], a[60:63], v[208:211]
v_permlane32_swap_b32 v92, v94
v_mfma_f32_16x16x32_bf16 v[184:187], a[148:151], a[52:55], v[184:187]
v_accvgpr_write_b32 a238, v70
v_mfma_f32_16x16x32_bf16 v[184:187], a[144:147], a[48:51], v[184:187]
v_permlane32_swap_b32 v100, v102
v_mfma_f32_16x16x32_bf16 v[160:163], a[144:147], a[40:43], v[160:163]
buffer_load_dwordx4 a[28:31], v2, s[40:43], s33 offen offset:3072 sc1
s_add_u32 s35, s35, 8192
v_mfma_f32_16x16x32_bf16 v[160:163], a[148:151], a[44:47], v[160:163]
s_add_u32 s33, s33, 8192
v_accvgpr_write_b32 a239, v71
v_mfma_f32_16x16x32_bf16 v[136:139], a[148:151], a[36:39], v[136:139]
v_permlane32_swap_b32 v108, v110
v_mfma_f32_16x16x32_bf16 v[136:139], a[144:147], a[32:35], v[136:139]
s_waitcnt vmcnt(10) lgkmcnt(0)
v_mfma_f32_16x16x32_bf16 v[140:143], a[96:99], a[64:67], v[140:143]
ds_read_b128 a[128:131], v5 offset:41984
v_mfma_f32_16x16x32_bf16 v[140:143], a[100:103], a[68:71], v[140:143]
buffer_load_dwordx4 a[32:35], v2, s[40:43], s35 offen offset:0 sc1
v_mfma_f32_16x16x32_bf16 v[164:167], a[100:103], a[76:79], v[164:167]
ds_read_b128 a[132:135], v5 offset:48128
v_mfma_f32_16x16x32_bf16 v[164:167], a[96:99], a[72:75], v[164:167]
v_permlane32_swap_b32 v116, v118
v_mfma_f32_16x16x32_bf16 v[188:191], a[96:99], a[80:83], v[188:191]
v_mul_f32 v82, 0xba800000, v92
v_mul_f32 v84, 0xba800000, v100
v_mfma_f32_16x16x32_bf16 v[188:191], a[100:103], a[84:87], v[188:191]
buffer_load_dwordx4 a[36:39], v2, s[40:43], s33 offen offset:0 sc1
v_mfma_f32_16x16x32_bf16 v[212:215], a[100:103], a[92:95], v[212:215]
ds_read_b128 a[136:139], v5 offset:36864
v_mul_f32 v86, 0xba800000, v108
v_mfma_f32_16x16x32_bf16 v[212:215], a[96:99], a[88:91], v[212:215]
v_mul_f32 v88, 0xba800000, v116
v_mul_f32 v94, 0x3a800000, v94
v_mul_f32 v102, 0x3a800000, v102
v_mul_f32 v110, 0x3a800000, v110
v_mul_f32 v118, 0x3a800000, v118
v_fma_f32 v94, -v82, v82, v94
v_fma_f32 v102, -v84, v84, v102
v_fma_f32 v110, -v86, v86, v110
v_fma_f32 v118, -v88, v88, v118
v_max_f32 v94, 0, v94
v_max_f32 v102, 0, v102
v_max_f32 v110, 0, v110
v_max_f32 v118, 0, v118
v_add_f32 v94, 0x3727c5ac, v94
v_add_f32 v102, 0x3727c5ac, v102
v_add_f32 v110, 0x3727c5ac, v110
v_add_f32 v118, 0x3727c5ac, v118
v_rsq_f32 v83, v94
v_rsq_f32 v85, v102
v_rsq_f32 v87, v110
v_rsq_f32 v89, v118
v_mfma_f32_16x16x32_bf16 v[216:219], a[104:107], a[88:91], v[216:219]
ds_read_b128 a[140:143], v5 offset:43008
v_mfma_f32_16x16x32_bf16 v[216:219], a[108:111], a[92:95], v[216:219]
v_mfma_f32_16x16x32_bf16 v[192:195], a[108:111], a[84:87], v[192:195]
buffer_load_dwordx4 v1, s[4:7], s44 offen offset:1024 sc1 lds
v_mfma_f32_16x16x32_bf16 v[192:195], a[104:107], a[80:83], v[192:195]
ds_read_b128 a[144:147], v5 offset:37888
v_fmac_f32 v140, v56, v82
v_mfma_f32_16x16x32_bf16 v[168:171], a[104:107], a[72:75], v[168:171]
v_fmac_f32 v164, v56, v84
v_mfma_f32_16x16x32_bf16 v[168:171], a[108:111], a[76:79], v[168:171]
ds_read_b128 a[148:151], v5 offset:44032
v_mfma_f32_16x16x32_bf16 v[144:147], a[108:111], a[68:71], v[144:147]
v_fmac_f32 v188, v56, v86
v_mfma_f32_16x16x32_bf16 v[144:147], a[104:107], a[64:67], v[144:147]
buffer_load_dwordx4 a[40:43], v2, s[40:43], s35 offen offset:1024 sc1
v_mfma_f32_16x16x32_bf16 v[148:151], a[112:115], a[64:67], v[148:151]
v_fmac_f32 v212, v56, v88
v_mfma_f32_16x16x32_bf16 v[148:151], a[116:119], a[68:71], v[148:151]
v_mfma_f32_16x16x32_bf16 v[172:175], a[116:119], a[76:79], v[172:175]
v_fmac_f32 v216, v60, v88
v_mfma_f32_16x16x32_bf16 v[172:175], a[112:115], a[72:75], v[172:175]
v_mfma_f32_16x16x32_bf16 v[196:199], a[112:115], a[80:83], v[196:199]
buffer_load_dwordx4 a[44:47], v2, s[40:43], s33 offen offset:1024 sc1
v_mfma_f32_16x16x32_bf16 v[196:199], a[116:119], a[84:87], v[196:199]
v_fmac_f32 v192, v60, v86
v_mfma_f32_16x16x32_bf16 v[220:223], a[116:119], a[92:95], v[220:223]
v_fmac_f32 v168, v60, v84
v_fmac_f32 v141, v57, v82
v_mfma_f32_16x16x32_bf16 v[220:223], a[112:115], a[88:91], v[220:223]
s_waitcnt lgkmcnt(0)
s_barrier
v_mfma_f32_16x16x32_bf16 v[224:227], a[128:131], a[88:91], v[224:227]
v_add_u32 v5, 0, v1
v_fmac_f32 v144, v60, v82
v_mfma_f32_16x16x32_bf16 v[224:227], a[132:135], a[92:95], v[224:227]
buffer_load_dwordx4 a[48:51], v2, s[40:43], s35 offen offset:2048 sc1
v_mfma_f32_16x16x32_bf16 v[200:203], a[132:135], a[84:87], v[200:203]
ds_read_b128 a[96:99], v5 offset:2048
v_fmac_f32 v148, v64, v82
v_mfma_f32_16x16x32_bf16 v[200:203], a[128:131], a[80:83], v[200:203]
ds_read_b128 a[100:103], v5 offset:8192
v_fmac_f32 v165, v57, v84
v_mfma_f32_16x16x32_bf16 v[176:179], a[128:131], a[72:75], v[176:179]
v_fmac_f32 v172, v64, v84
v_fmac_f32 v189, v57, v86
v_mfma_f32_16x16x32_bf16 v[176:179], a[132:135], a[76:79], v[176:179]
buffer_load_dwordx4 a[52:55], v2, s[40:43], s33 offen offset:2048 sc1
v_mfma_f32_16x16x32_bf16 v[152:155], a[132:135], a[68:71], v[152:155]
ds_read_b128 a[104:107], v5 offset:3072
v_fmac_f32 v196, v64, v86
v_mfma_f32_16x16x32_bf16 v[152:155], a[128:131], a[64:67], v[152:155]
v_fmac_f32 v213, v57, v88
v_fmac_f32 v217, v61, v88
v_mfma_f32_16x16x32_bf16 v[132:135], a[136:139], a[64:67], v[132:135]
ds_read_b128 a[108:111], v5 offset:9216
v_fmac_f32 v220, v64, v88
v_mfma_f32_16x16x32_bf16 v[132:135], a[140:143], a[68:71], v[132:135]
v_fmac_f32 v193, v61, v86
v_mfma_f32_16x16x32_bf16 v[156:159], a[140:143], a[76:79], v[156:159]
buffer_load_dwordx4 v1, s[4:7], s44 offen offset:2048 sc1 lds
s_add_u32 m0, s19, 49152
v_mfma_f32_16x16x32_bf16 v[156:159], a[136:139], a[72:75], v[156:159]
s_add_u32 s44, s85, 0xc04000
ds_read_b128 a[112:115], v5 offset:4096
v_mfma_f32_16x16x32_bf16 v[180:183], a[136:139], a[80:83], v[180:183]
v_fmac_f32 v224, v68, v88
v_fmac_f32 v200, v68, v86
v_mfma_f32_16x16x32_bf16 v[180:183], a[140:143], a[84:87], v[180:183]
ds_read_b128 a[116:119], v5 offset:10240
v_fmac_f32 v169, v61, v84
v_mfma_f32_16x16x32_bf16 v[204:207], a[140:143], a[92:95], v[204:207]
v_fmac_f32 v176, v68, v84
v_fmac_f32 v145, v61, v82
v_mfma_f32_16x16x32_bf16 v[204:207], a[136:139], a[88:91], v[204:207]
buffer_load_dwordx4 a[56:59], v2, s[40:43], s35 offen offset:3072 sc1
v_mfma_f32_16x16x32_bf16 v[208:211], a[144:147], a[88:91], v[208:211]
v_fmac_f32 v152, v68, v82
v_fmac_f32 v149, v65, v82
v_mfma_f32_16x16x32_bf16 v[208:211], a[148:151], a[92:95], v[208:211]
v_fmac_f32 v173, v65, v84
v_mfma_f32_16x16x32_bf16 v[184:187], a[148:151], a[84:87], v[184:187]
v_fmac_f32 v132, v48, v82
v_fmac_f32 v197, v65, v86
v_mfma_f32_16x16x32_bf16 v[184:187], a[144:147], a[80:83], v[184:187]
v_mfma_f32_16x16x32_bf16 v[160:163], a[144:147], a[72:75], v[160:163]
buffer_load_dwordx4 a[60:63], v2, s[40:43], s33 offen offset:3072 sc1
s_add_u32 s35, s35, 8192
v_mfma_f32_16x16x32_bf16 v[160:163], a[148:151], a[76:79], v[160:163]
s_add_u32 s33, s33, 8192
v_fmac_f32 v156, v48, v84
v_mfma_f32_16x16x32_bf16 v[136:139], a[148:151], a[68:71], v[136:139]
v_fmac_f32 v180, v48, v86
v_fmac_f32 v221, v65, v88
v_mfma_f32_16x16x32_bf16 v[136:139], a[144:147], a[64:67], v[136:139]
v_fmac_f32 v225, v69, v88
s_waitcnt vmcnt(10) lgkmcnt(0)
v_mfma_f32_16x16x32_bf16 v[140:143], a[96:99], a[0:3], v[140:143]
ds_read_b128 a[128:131], v5 offset:5120
v_fmac_f32 v204, v48, v88
v_mfma_f32_16x16x32_bf16 v[140:143], a[100:103], a[4:7], v[140:143]
buffer_load_dwordx4 a[64:67], v2, s[40:43], s35 offen offset:0 sc1
s_lshl_b32 s36, s28, 9
v_mfma_f32_16x16x32_bf16 v[164:167], a[100:103], a[12:15], v[164:167]
ds_read_b128 a[132:135], v5 offset:11264
v_fmac_f32 v208, v52, v88
v_mfma_f32_16x16x32_bf16 v[164:167], a[96:99], a[8:11], v[164:167]
v_fmac_f32 v201, v69, v86
v_fmac_f32 v177, v69, v84
v_mfma_f32_16x16x32_bf16 v[188:191], a[96:99], a[16:19], v[188:191]
v_fmac_f32 v184, v52, v86
v_fmac_f32 v153, v69, v82
v_mfma_f32_16x16x32_bf16 v[188:191], a[100:103], a[20:23], v[188:191]
buffer_load_dwordx4 a[68:71], v2, s[40:43], s33 offen offset:0 sc1
s_lshl_b32 s37, s30, 2
v_mfma_f32_16x16x32_bf16 v[212:215], a[100:103], a[28:31], v[212:215]
ds_read_b128 a[136:139], v5 offset:0
v_fmac_f32 v160, v52, v84
v_mfma_f32_16x16x32_bf16 v[212:215], a[96:99], a[24:27], v[212:215]
v_fmac_f32 v133, v49, v82
v_add_u32 v232, s19, v7
v_mfma_f32_16x16x32_bf16 v[216:219], a[104:107], a[24:27], v[216:219]
ds_read_b128 a[140:143], v5 offset:6144
v_fmac_f32 v136, v52, v82
v_mfma_f32_16x16x32_bf16 v[216:219], a[108:111], a[28:31], v[216:219]
buffer_load_dwordx4 a[72:75], v2, s[40:43], s35 offen offset:1024 sc1
s_add_u32 s37, s37, s28
v_mfma_f32_16x16x32_bf16 v[192:195], a[108:111], a[20:23], v[192:195]
ds_read_b128 a[144:147], v5 offset:1024
v_fmac_f32 v157, v49, v84
v_mfma_f32_16x16x32_bf16 v[192:195], a[104:107], a[16:19], v[192:195]
v_fmac_f32 v181, v49, v86
v_fmac_f32 v142, v58, v82
v_mfma_f32_16x16x32_bf16 v[168:171], a[104:107], a[8:11], v[168:171]
v_fmac_f32 v205, v49, v88
v_fmac_f32 v166, v58, v84
v_mfma_f32_16x16x32_bf16 v[168:171], a[108:111], a[12:15], v[168:171]
buffer_load_dwordx4 a[76:79], v2, s[40:43], s33 offen offset:1024 sc1
s_lshl_b32 s98, s37, 13
v_mfma_f32_16x16x32_bf16 v[144:147], a[108:111], a[4:7], v[144:147]
ds_read_b128 a[148:151], v5 offset:7168
v_fmac_f32 v209, v53, v88
v_mfma_f32_16x16x32_bf16 v[144:147], a[104:107], a[0:3], v[144:147]
v_fmac_f32 v190, v58, v86
s_add_u32 s98, s98, 0x400000
v_mfma_f32_16x16x32_bf16 v[148:151], a[112:115], a[0:3], v[148:151]
v_fmac_f32 v185, v53, v86
v_fmac_f32 v214, v58, v88
v_mfma_f32_16x16x32_bf16 v[148:151], a[116:119], a[4:7], v[148:151]
buffer_load_dwordx4 a[80:83], v2, s[40:43], s35 offen offset:2048 sc1
s_add_u32 s99, s98, 4096
v_mfma_f32_16x16x32_bf16 v[172:175], a[116:119], a[12:15], v[172:175]
v_fmac_f32 v161, v53, v84
v_fmac_f32 v218, v62, v88
v_mfma_f32_16x16x32_bf16 v[172:175], a[112:115], a[8:11], v[172:175]
s_lshl_b32 s100, s37, 10
s_add_u32 s100, s100, 0x800000
s_lshl_b32 s96, s29, 10
v_mfma_f32_16x16x32_bf16 v[196:199], a[112:115], a[16:19], v[196:199]
v_fmac_f32 v137, v53, v82
v_fmac_f32 v194, v62, v86
v_mfma_f32_16x16x32_bf16 v[196:199], a[116:119], a[20:23], v[196:199]
buffer_load_dwordx4 a[84:87], v2, s[40:43], s33 offen offset:2048 sc1
s_add_u32 s96, s96, s98
v_mfma_f32_16x16x32_bf16 v[220:223], a[116:119], a[28:31], v[220:223]
v_fmac_f32 v170, v62, v84
v_fmac_f32 v143, v59, v82
v_mfma_f32_16x16x32_bf16 v[220:223], a[112:115], a[24:27], v[220:223]
s_lshl_b32 s97, s29, 7
s_waitcnt lgkmcnt(0)
v_mfma_f32_16x16x32_bf16 v[224:227], a[128:131], a[24:27], v[224:227]
ds_read_b128 a[96:99], v5 offset:14336
v_fmac_f32 v146, v62, v82
v_mfma_f32_16x16x32_bf16 v[224:227], a[132:135], a[28:31], v[224:227]
buffer_load_dwordx4 a[88:91], v2, s[40:43], s35 offen offset:3072 sc1
s_add_u32 s97, s97, s100
v_mfma_f32_16x16x32_bf16 v[200:203], a[132:135], a[20:23], v[200:203]
ds_read_b128 a[100:103], v5 offset:20480
v_fmac_f32 v150, v66, v82
v_mfma_f32_16x16x32_bf16 v[200:203], a[128:131], a[16:19], v[200:203]
v_fmac_f32 v167, v59, v84
v_fmac_f32 v191, v59, v86
v_mfma_f32_16x16x32_bf16 v[176:179], a[128:131], a[8:11], v[176:179]
v_fmac_f32 v174, v66, v84
v_fmac_f32 v215, v59, v88
v_mfma_f32_16x16x32_bf16 v[176:179], a[132:135], a[12:15], v[176:179]
ds_read_b128 a[104:107], v5 offset:15360
s_lshl_b32 s88, s28, 6
v_mfma_f32_16x16x32_bf16 v[152:155], a[132:135], a[4:7], v[152:155]
v_fmac_f32 v198, v66, v86
v_fmac_f32 v219, v63, v88
v_mfma_f32_16x16x32_bf16 v[152:155], a[128:131], a[0:3], v[152:155]
buffer_load_dwordx4 v1, s[4:7], s44 offen offset:0 sc1 lds
s_add_u32 s94, s80, s88
v_mfma_f32_16x16x32_bf16 v[132:135], a[136:139], a[0:3], v[132:135]
ds_read_b128 a[108:111], v5 offset:21504
v_fmac_f32 v222, v66, v88
v_mfma_f32_16x16x32_bf16 v[132:135], a[140:143], a[4:7], v[132:135]
v_fmac_f32 v195, v63, v86
s_add_u32 s94, s94, 0x80000
v_mfma_f32_16x16x32_bf16 v[156:159], a[140:143], a[12:15], v[156:159]
ds_read_b128 a[112:115], v5 offset:16384
v_fmac_f32 v226, v70, v88
v_mfma_f32_16x16x32_bf16 v[156:159], a[136:139], a[8:11], v[156:159]
v_fmac_f32 v171, v63, v84
s_add_u32 s88, s88, s70
v_mfma_f32_16x16x32_bf16 v[180:183], a[136:139], a[16:19], v[180:183]
v_fmac_f32 v202, v70, v86
v_fmac_f32 v147, v63, v82
v_mfma_f32_16x16x32_bf16 v[180:183], a[140:143], a[20:23], v[180:183]
buffer_load_dwordx4 a[92:95], v2, s[40:43], s33 offen offset:3072 sc1
s_add_u32 s35, s35, 8192
v_mfma_f32_16x16x32_bf16 v[204:207], a[140:143], a[28:31], v[204:207]
s_add_u32 s33, s33, 8192
ds_read_b128 a[116:119], v5 offset:22528
v_mfma_f32_16x16x32_bf16 v[204:207], a[136:139], a[24:27], v[204:207]
v_fmac_f32 v178, v70, v84
v_fmac_f32 v151, v67, v82
v_mfma_f32_16x16x32_bf16 v[208:211], a[144:147], a[24:27], v[208:211]
v_fmac_f32 v154, v70, v82
v_fmac_f32 v175, v67, v84
v_mfma_f32_16x16x32_bf16 v[208:211], a[148:151], a[28:31], v[208:211]
s_add_u32 s89, s88, 0x80000
s_add_u32 s74, s71, 0x10080
s_lshl_b32 s73, s30, 12
v_mfma_f32_16x16x32_bf16 v[184:187], a[148:151], a[20:23], v[184:187]
v_fmac_f32 v134, v50, v82
v_fmac_f32 v199, v67, v86
v_mfma_f32_16x16x32_bf16 v[184:187], a[144:147], a[16:19], v[184:187]
buffer_load_dwordx4 v1, s[4:7], s44 offen offset:1024 sc1 lds
s_add_u32 s72, s73, 0x2600000
v_mfma_f32_16x16x32_bf16 v[160:163], a[144:147], a[8:11], v[160:163]
v_fmac_f32 v158, v50, v84
v_fmac_f32 v223, v67, v88
v_mfma_f32_16x16x32_bf16 v[160:163], a[148:151], a[12:15], v[160:163]
v_add_u32 v233, s19, v232
s_add_u32 s73, s73, 0x1e00000
v_mfma_f32_16x16x32_bf16 v[136:139], a[148:151], a[4:7], v[136:139]
v_fmac_f32 v182, v50, v86
v_fmac_f32 v227, v71, v88
v_mfma_f32_16x16x32_bf16 v[136:139], a[144:147], a[0:3], v[136:139]
s_waitcnt vmcnt(10) lgkmcnt(0)
s_barrier
v_mfma_f32_16x16x32_bf16 v[140:143], a[96:99], a[32:35], v[140:143]
ds_read_b128 a[128:131], v5 offset:17408
v_fmac_f32 v206, v50, v88
v_mfma_f32_16x16x32_bf16 v[140:143], a[100:103], a[36:39], v[140:143]
buffer_load_dwordx4 a[0:3], v2, s[40:43], s35 offen offset:0 sc1
s_lshr_b32 s38, s28, 1
v_mfma_f32_16x16x32_bf16 v[164:167], a[100:103], a[44:47], v[164:167]
ds_read_b128 a[132:135], v5 offset:23552
v_fmac_f32 v210, v54, v88
v_mfma_f32_16x16x32_bf16 v[164:167], a[96:99], a[40:43], v[164:167]
v_fmac_f32 v203, v71, v86
v_fmac_f32 v179, v71, v84
v_mfma_f32_16x16x32_bf16 v[188:191], a[96:99], a[48:51], v[188:191]
buffer_load_dwordx4 a[4:7], v2, s[40:43], s33 offen offset:0 sc1
s_and_b32 s39, s28, 1
v_mfma_f32_16x16x32_bf16 v[188:191], a[100:103], a[52:55], v[188:191]
ds_read_b128 a[136:139], v5 offset:26624
v_fmac_f32 v186, v54, v86
v_mfma_f32_16x16x32_bf16 v[212:215], a[100:103], a[60:63], v[212:215]
v_fmac_f32 v162, v54, v84
v_fmac_f32 v155, v71, v82
v_mfma_f32_16x16x32_bf16 v[212:215], a[96:99], a[56:59], v[212:215]
buffer_load_dwordx4 a[8:11], v2, s[40:43], s35 offen offset:1024 sc1
s_mul_i32 s38, s38, 3072
v_mfma_f32_16x16x32_bf16 v[216:219], a[104:107], a[56:59], v[216:219]
ds_read_b128 a[140:143], v5 offset:32768
v_fmac_f32 v138, v54, v82
v_mfma_f32_16x16x32_bf16 v[216:219], a[108:111], a[60:63], v[216:219]
v_fmac_f32 v135, v51, v82
v_fmac_f32 v159, v51, v84
v_mfma_f32_16x16x32_bf16 v[192:195], a[108:111], a[52:55], v[192:195]
buffer_load_dwordx4 a[12:15], v2, s[40:43], s33 offen offset:1024 sc1
s_lshl_b32 s39, s39, 3
v_mfma_f32_16x16x32_bf16 v[192:195], a[104:107], a[48:51], v[192:195]
ds_read_b128 a[144:147], v5 offset:27648
v_fmac_f32 v183, v51, v86
v_mfma_f32_16x16x32_bf16 v[168:171], a[104:107], a[40:43], v[168:171]
v_fmac_f32 v207, v51, v88
s_add_u32 s38, s38, s39
v_mfma_f32_16x16x32_bf16 v[168:171], a[108:111], a[44:47], v[168:171]
buffer_load_dwordx4 a[16:19], v2, s[40:43], s35 offen offset:2048 sc1
v_mfma_f32_16x16x32_bf16 v[144:147], a[108:111], a[36:39], v[144:147]
ds_read_b128 a[148:151], v5 offset:33792
v_fmac_f32 v211, v55, v88
v_mfma_f32_16x16x32_bf16 v[144:147], a[104:107], a[32:35], v[144:147]
v_mul_f32 v88, 0x3fb8aa3b, v89
v_and_b32 v248, 7, v0
v_mfma_f32_16x16x32_bf16 v[148:151], a[112:115], a[32:35], v[148:151]
buffer_load_dwordx4 a[20:23], v2, s[40:43], s33 offen offset:2048 sc1
v_mfma_f32_16x16x32_bf16 v[148:151], a[116:119], a[36:39], v[148:151]
v_fmac_f32 v187, v55, v86
v_lshlrev_b32 v248, 7, v248
v_mfma_f32_16x16x32_bf16 v[172:175], a[116:119], a[44:47], v[172:175]
v_fmac_f32 v163, v55, v84
v_mul_f32 v86, 0x3fb8aa3b, v87
v_mfma_f32_16x16x32_bf16 v[172:175], a[112:115], a[40:43], v[172:175]
buffer_load_dwordx4 a[24:27], v2, s[40:43], s35 offen offset:3072 sc1
v_mfma_f32_16x16x32_bf16 v[196:199], a[112:115], a[48:51], v[196:199]
v_fmac_f32 v139, v55, v82
v_mul_f32 v84, 0x3fb8aa3b, v85
v_mfma_f32_16x16x32_bf16 v[196:199], a[116:119], a[52:55], v[196:199]
v_mul_f32 v82, 0x3fb8aa3b, v83
v_lshrrev_b32 v249, 4, v0
v_mfma_f32_16x16x32_bf16 v[220:223], a[116:119], a[60:63], v[220:223]
buffer_load_dwordx4 a[28:31], v2, s[40:43], s33 offen offset:3072 sc1
s_add_u32 s35, s35, 8192
v_mfma_f32_16x16x32_bf16 v[220:223], a[112:115], a[56:59], v[220:223]
s_add_u32 s33, s33, 8192
s_waitcnt lgkmcnt(0)
v_mfma_f32_16x16x32_bf16 v[224:227], a[128:131], a[56:59], v[224:227]
ds_read_b128 a[96:99], v5 offset:28672
v_lshlrev_b32 v235, 8, v0
v_mfma_f32_16x16x32_bf16 v[224:227], a[132:135], a[60:63], v[224:227]
buffer_load_dwordx4 v1, s[4:7], s44 offen offset:2048 sc1 lds
v_mfma_f32_16x16x32_bf16 v[200:203], a[132:135], a[52:55], v[200:203]
ds_read_b128 a[100:103], v5 offset:34816
v_lshl_add_u32 v248, v249, 4, v248
v_mfma_f32_16x16x32_bf16 v[200:203], a[128:131], a[48:51], v[200:203]
v_add_u32 v234, s36, v8
v_cndmask_b32 v235, 2.0, v235, s[64:65]
v_mfma_f32_16x16x32_bf16 v[176:179], a[128:131], a[40:43], v[176:179]
v_mov_b32 v249, 0x3f80
v_mov_b32 v250, 1.0
v_mfma_f32_16x16x32_bf16 v[176:179], a[132:135], a[44:47], v[176:179]
ds_read_b128 a[104:107], v5 offset:29696
v_add_u32 v252, s38, v1
v_mfma_f32_16x16x32_bf16 v[152:155], a[132:135], a[36:39], v[152:155]
v_mfma_f32_16x16x32_bf16 v[152:155], a[128:131], a[32:35], v[152:155]
s_waitcnt vmcnt(18)
v_mfma_f32_16x16x32_bf16 v[140:143], a[136:139], a[64:67], v[140:143]
ds_read_b128 a[108:111], v5 offset:35840
s_waitcnt vmcnt(17)
v_mfma_f32_16x16x32_bf16 v[140:143], a[140:143], a[68:71], v[140:143]
s_waitcnt vmcnt(15)
v_mfma_f32_16x16x32_bf16 v[164:167], a[140:143], a[76:79], v[164:167]
ds_read_b128 a[112:115], v5 offset:38912
v_mfma_f32_16x16x32_bf16 v[164:167], a[136:139], a[72:75], v[164:167]
s_waitcnt vmcnt(14)
v_mfma_f32_16x16x32_bf16 v[188:191], a[136:139], a[80:83], v[188:191]
s_waitcnt vmcnt(13)
v_mfma_f32_16x16x32_bf16 v[188:191], a[140:143], a[84:87], v[188:191]
buffer_load_dwordx4 v1, s[4:7], s44 offen offset:3072 sc1 lds
s_add_u32 m0, s19, 65536
s_waitcnt vmcnt(11)
v_mfma_f32_16x16x32_bf16 v[212:215], a[140:143], a[92:95], v[212:215]
s_add_u32 s44, s84, 0xc08000
ds_read_b128 a[116:119], v5 offset:45056
v_mfma_f32_16x16x32_bf16 v[212:215], a[136:139], a[88:91], v[212:215]
v_mfma_f32_16x16x32_bf16 v[216:219], a[144:147], a[88:91], v[216:219]
v_mfma_f32_16x16x32_bf16 v[216:219], a[148:151], a[92:95], v[216:219]
v_mfma_f32_16x16x32_bf16 v[192:195], a[148:151], a[84:87], v[192:195]
v_mfma_f32_16x16x32_bf16 v[192:195], a[144:147], a[80:83], v[192:195]
v_mfma_f32_16x16x32_bf16 v[168:171], a[144:147], a[72:75], v[168:171]
v_mfma_f32_16x16x32_bf16 v[168:171], a[148:151], a[76:79], v[168:171]
v_mfma_f32_16x16x32_bf16 v[144:147], a[148:151], a[68:71], v[144:147]
v_mfma_f32_16x16x32_bf16 v[144:147], a[144:147], a[64:67], v[144:147]
s_waitcnt lgkmcnt(0)
v_mfma_f32_16x16x32_bf16 v[148:151], a[96:99], a[64:67], v[148:151]
ds_read_b128 a[128:131], v5 offset:39936
v_mfma_f32_16x16x32_bf16 v[148:151], a[100:103], a[68:71], v[148:151]
buffer_load_dwordx4 v1, s[4:7], s44 offen offset:0 sc1 lds
v_mfma_f32_16x16x32_bf16 v[172:175], a[100:103], a[76:79], v[172:175]
ds_read_b128 a[132:135], v5 offset:46080
v_mfma_f32_16x16x32_bf16 v[172:175], a[96:99], a[72:75], v[172:175]
v_mfma_f32_16x16x32_bf16 v[196:199], a[96:99], a[80:83], v[196:199]
v_mfma_f32_16x16x32_bf16 v[196:199], a[100:103], a[84:87], v[196:199]
buffer_load_dwordx4 v1, s[4:7], s44 offen offset:1024 sc1 lds
v_mfma_f32_16x16x32_bf16 v[220:223], a[100:103], a[92:95], v[220:223]
ds_read_b128 a[136:139], v5 offset:40960
v_mfma_f32_16x16x32_bf16 v[220:223], a[96:99], a[88:91], v[220:223]
v_mfma_f32_16x16x32_bf16 v[224:227], a[104:107], a[88:91], v[224:227]
ds_read_b128 a[140:143], v5 offset:47104
v_mfma_f32_16x16x32_bf16 v[224:227], a[108:111], a[92:95], v[224:227]
v_mfma_f32_16x16x32_bf16 v[200:203], a[108:111], a[84:87], v[200:203]
buffer_load_dwordx4 v1, s[4:7], s44 offen offset:2048 sc1 lds
v_mfma_f32_16x16x32_bf16 v[200:203], a[104:107], a[80:83], v[200:203]
ds_read_b128 a[144:147], v5 offset:41984
v_mfma_f32_16x16x32_bf16 v[176:179], a[104:107], a[72:75], v[176:179]
v_mfma_f32_16x16x32_bf16 v[176:179], a[108:111], a[76:79], v[176:179]
ds_read_b128 a[148:151], v5 offset:48128
v_mfma_f32_16x16x32_bf16 v[152:155], a[108:111], a[68:71], v[152:155]
v_mfma_f32_16x16x32_bf16 v[152:155], a[104:107], a[64:67], v[152:155]
buffer_load_dwordx4 v1, s[4:7], s44 offen offset:3072 sc1 lds
s_add_u32 m0, s19, 81920
s_waitcnt vmcnt(13)
v_mfma_f32_16x16x32_bf16 v[140:143], a[112:115], a[0:3], v[140:143]
s_add_u32 s44, s85, 0xc0c000
s_waitcnt vmcnt(12)
v_mfma_f32_16x16x32_bf16 v[140:143], a[116:119], a[4:7], v[140:143]
s_waitcnt vmcnt(10)
v_mfma_f32_16x16x32_bf16 v[164:167], a[116:119], a[12:15], v[164:167]
v_mfma_f32_16x16x32_bf16 v[164:167], a[112:115], a[8:11], v[164:167]
s_waitcnt vmcnt(9)
v_mfma_f32_16x16x32_bf16 v[188:191], a[112:115], a[16:19], v[188:191]
buffer_load_dwordx4 v1, s[4:7], s44 offen offset:0 sc1 lds
s_waitcnt vmcnt(9)
v_mfma_f32_16x16x32_bf16 v[188:191], a[116:119], a[20:23], v[188:191]
s_waitcnt vmcnt(7)
v_mfma_f32_16x16x32_bf16 v[212:215], a[116:119], a[28:31], v[212:215]
v_mfma_f32_16x16x32_bf16 v[212:215], a[112:115], a[24:27], v[212:215]
s_waitcnt lgkmcnt(0)
v_mfma_f32_16x16x32_bf16 v[216:219], a[128:131], a[24:27], v[216:219]
ds_read_b128 a[96:99], v5 offset:12288
v_cvt_pk_bf16_f32 v140, v140, v141
v_mfma_f32_16x16x32_bf16 v[216:219], a[132:135], a[28:31], v[216:219]
buffer_load_dwordx4 v1, s[4:7], s44 offen offset:1024 sc1 lds
v_mfma_f32_16x16x32_bf16 v[192:195], a[132:135], a[20:23], v[192:195]
ds_read_b128 a[100:103], v5 offset:18432
v_cvt_pk_bf16_f32 v141, v142, v143
v_mfma_f32_16x16x32_bf16 v[192:195], a[128:131], a[16:19], v[192:195]
v_cvt_pk_bf16_f32 v164, v164, v165
v_cvt_pk_bf16_f32 v165, v166, v167
v_mfma_f32_16x16x32_bf16 v[168:171], a[128:131], a[8:11], v[168:171]
v_cvt_pk_bf16_f32 v188, v188, v189
v_cvt_pk_bf16_f32 v189, v190, v191
v_mfma_f32_16x16x32_bf16 v[168:171], a[132:135], a[12:15], v[168:171]
buffer_load_dwordx4 v1, s[4:7], s44 offen offset:2048 sc1 lds
v_mfma_f32_16x16x32_bf16 v[144:147], a[132:135], a[4:7], v[144:147]
ds_read_b128 a[104:107], v5 offset:24576
v_cvt_pk_bf16_f32 v212, v212, v213
v_mfma_f32_16x16x32_bf16 v[144:147], a[128:131], a[0:3], v[144:147]
v_cvt_pk_bf16_f32 v213, v214, v215
v_mfma_f32_16x16x32_bf16 v[148:151], a[136:139], a[0:3], v[148:151]
ds_read_b128 a[108:111], v5 offset:30720
v_cvt_pk_bf16_f32 v214, v216, v217
v_mfma_f32_16x16x32_bf16 v[148:151], a[140:143], a[4:7], v[148:151]
v_cvt_pk_bf16_f32 v215, v218, v219
v_mfma_f32_16x16x32_bf16 v[172:175], a[140:143], a[12:15], v[172:175]
buffer_load_dwordx4 v1, s[4:7], s44 offen offset:3072 sc1 lds
s_add_u32 m0, s19, 147456
v_mfma_f32_16x16x32_bf16 v[172:175], a[136:139], a[8:11], v[172:175]
s_add_u32 s44, s87, 0xc1c000
ds_read_b128 a[112:115], v5 offset:36864
v_mfma_f32_16x16x32_bf16 v[196:199], a[136:139], a[16:19], v[196:199]
v_cvt_pk_bf16_f32 v166, v168, v169
v_cvt_pk_bf16_f32 v167, v170, v171
v_mfma_f32_16x16x32_bf16 v[196:199], a[140:143], a[20:23], v[196:199]
ds_read_b128 a[116:119], v5 offset:43008
v_cvt_pk_bf16_f32 v190, v192, v193
v_mfma_f32_16x16x32_bf16 v[220:223], a[140:143], a[28:31], v[220:223]
v_cvt_pk_bf16_f32 v142, v144, v145
v_cvt_pk_bf16_f32 v143, v146, v147
v_mfma_f32_16x16x32_bf16 v[220:223], a[136:139], a[24:27], v[220:223]
buffer_load_dwordx4 v1, s[4:7], s44 offen offset:0 sc1 lds
v_mfma_f32_16x16x32_bf16 v[224:227], a[144:147], a[24:27], v[224:227]
v_mfma_f32_16x16x32_bf16 v[92:95], a[240:243], v[140:143], 0
v_mfma_f32_16x16x32_bf16 v[224:227], a[148:151], a[28:31], v[224:227]
v_mfma_f32_16x16x32_bf16 v[96:99], a[244:247], v[140:143], 0
v_mfma_f32_16x16x32_bf16 v[200:203], a[148:151], a[20:23], v[200:203]
v_mfma_f32_16x16x32_bf16 v[100:103], a[240:243], v[164:167], 0
v_mfma_f32_16x16x32_bf16 v[200:203], a[144:147], a[16:19], v[200:203]
v_mfma_f32_16x16x32_bf16 v[104:107], a[244:247], v[164:167], 0
v_mfma_f32_16x16x32_bf16 v[176:179], a[144:147], a[8:11], v[176:179]
buffer_load_dwordx4 v1, s[4:7], s44 offen offset:1024 sc1 lds
v_mfma_f32_16x16x32_bf16 v[176:179], a[148:151], a[12:15], v[176:179]
v_max3_f32 v236, v92, v93, v94
v_max3_f32 v237, -v92, -v93, -v94
v_mfma_f32_16x16x32_bf16 v[152:155], a[148:151], a[4:7], v[152:155]
v_max3_f32 v236, v236, v95, v96
v_max3_f32 v237, v237, -v95, -v96
v_mfma_f32_16x16x32_bf16 v[152:155], a[144:147], a[0:3], v[152:155]
v_max3_f32 v236, v236, v97, v98
s_waitcnt lgkmcnt(0)
v_mfma_f32_16x16x32_bf16 v[132:135], a[96:99], a[32:35], v[132:135]
ds_read_b128 a[128:131], v5 offset:13312
v_max3_f32 v237, v237, -v97, -v98
v_mfma_f32_16x16x32_bf16 v[132:135], a[100:103], a[36:39], v[132:135]
buffer_load_dwordx4 v1, s[4:7], s44 offen offset:2048 sc1 lds
v_mfma_f32_16x16x32_bf16 v[156:159], a[100:103], a[44:47], v[156:159]
ds_read_b128 a[132:135], v5 offset:19456
v_max_f32 v236, v236, v99
v_mfma_f32_16x16x32_bf16 v[156:159], a[96:99], a[40:43], v[156:159]
v_max_f32_e64 v237, v237, -v99
v_max3_f32 v238, v100, v101, v102
v_mfma_f32_16x16x32_bf16 v[180:183], a[96:99], a[48:51], v[180:183]
v_permlane32_swap_b32 v236, v237
v_mfma_f32_16x16x32_bf16 v[180:183], a[100:103], a[52:55], v[180:183]
buffer_load_dwordx4 v1, s[4:7], s44 offen offset:3072 sc1 lds
s_add_u32 m0, s19, 98304
v_mfma_f32_16x16x32_bf16 v[204:207], a[100:103], a[60:63], v[204:207]
s_add_u32 s44, s84, 0xc10000
ds_read_b128 a[136:139], v5 offset:25600
v_mfma_f32_16x16x32_bf16 v[204:207], a[96:99], a[56:59], v[204:207]
v_max_f32 v236, v236, v237
v_mov_b32 v244, v236
v_mfma_f32_16x16x32_bf16 v[204:207], a[104:107], a[88:91], v[204:207]
ds_read_b128 a[140:143], v5 offset:31744
v_max3_f32 v239, -v100, -v101, -v102
v_mfma_f32_16x16x32_bf16 v[204:207], a[108:111], a[92:95], v[204:207]
v_permlane16_swap_b32 v236, v244
v_mfma_f32_16x16x32_bf16 v[180:183], a[108:111], a[84:87], v[180:183]
buffer_load_dwordx4 v1, s[4:7], s44 offen offset:0 sc1 lds
v_mfma_f32_16x16x32_bf16 v[180:183], a[104:107], a[80:83], v[180:183]
ds_read_b128 a[144:147], v5 offset:37888
v_max_f32 v236, v236, v244
v_mfma_f32_16x16x32_bf16 v[156:159], a[104:107], a[72:75], v[156:159]
v_mov_b32 v244, v236
v_max3_f32 v238, v238, v103, v104
v_mfma_f32_16x16x32_bf16 v[156:159], a[108:111], a[76:79], v[156:159]
ds_read_b128 a[148:151], v5 offset:44032
v_max3_f32 v239, v239, -v103, -v104
v_mfma_f32_16x16x32_bf16 v[132:135], a[108:111], a[68:71], v[132:135]
v_permlane32_swap_b32 v236, v244
v_mfma_f32_16x16x32_bf16 v[132:135], a[104:107], a[64:67], v[132:135]
buffer_load_dwordx4 v1, s[4:7], s44 offen offset:1024 sc1 lds
v_mfma_f32_16x16x32_bf16 v[132:135], a[112:115], a[0:3], v[132:135]
v_mul_f32_e64 v236, -v236, v82
v_mul_f32_e64 v237, -v244, v82
v_mfma_f32_16x16x32_bf16 v[132:135], a[116:119], a[4:7], v[132:135]
v_max3_f32 v238, v238, v105, v106
L_stub7:
s_cbranch_execz L_stub8
v_max3_f32 v239, v239, -v105, -v106
v_mfma_f32_16x16x32_bf16 v[156:159], a[116:119], a[12:15], v[156:159]
v_max_f32 v238, v238, v107
v_max_f32_e64 v239, v239, -v107
v_mfma_f32_16x16x32_bf16 v[156:159], a[112:115], a[8:11], v[156:159]
s_nop 0
v_permlane32_swap_b32 v238, v239
v_mfma_f32_16x16x32_bf16 v[180:183], a[112:115], a[16:19], v[180:183]
buffer_load_dwordx4 v1, s[4:7], s44 offen offset:2048 sc1 lds
v_mfma_f32_16x16x32_bf16 v[180:183], a[116:119], a[20:23], v[180:183]
v_max_f32 v238, v238, v239
v_mov_b32 v245, v238
v_mfma_f32_16x16x32_bf16 v[204:207], a[116:119], a[28:31], v[204:207]
s_nop 0
v_permlane16_swap_b32 v238, v245
v_mfma_f32_16x16x32_bf16 v[204:207], a[112:115], a[24:27], v[204:207]
s_waitcnt lgkmcnt(0)
s_barrier
v_mfma_f32_16x16x32_bf16 v[208:211], a[128:131], a[56:59], v[208:211]
v_max_f32 v238, v238, v245
v_mov_b32 v245, v238
v_mfma_f32_16x16x32_bf16 v[208:211], a[132:135], a[60:63], v[208:211]
buffer_load_dwordx4 v1, s[4:7], s44 offen offset:3072 sc1 lds
s_add_u32 m0, s19, 114688
v_mfma_f32_16x16x32_bf16 v[184:187], a[132:135], a[52:55], v[184:187]
s_add_u32 s44, s85, 0xc14000
v_cvt_pk_bf16_f32 v191, v194, v195
v_mfma_f32_16x16x32_bf16 v[184:187], a[128:131], a[48:51], v[184:187]
v_permlane32_swap_b32 v238, v245
v_mfma_f32_16x16x32_bf16 v[160:163], a[128:131], a[40:43], v[160:163]
v_mul_f32_e64 v238, -v238, v84
v_mul_f32_e64 v239, -v245, v84
v_mfma_f32_16x16x32_bf16 v[160:163], a[132:135], a[44:47], v[160:163]
buffer_load_dwordx4 v1, s[4:7], s44 offen offset:0 sc1 lds
v_mfma_f32_16x16x32_bf16 v[136:139], a[132:135], a[36:39], v[136:139]
v_mfma_f32_16x16x32_bf16 v[108:111], a[240:243], v[188:191], 0
v_mfma_f32_16x16x32_bf16 v[136:139], a[128:131], a[32:35], v[136:139]
v_mfma_f32_16x16x32_bf16 v[112:115], a[244:247], v[188:191], 0
v_mfma_f32_16x16x32_bf16 v[136:139], a[136:139], a[64:67], v[136:139]
v_mfma_f32_16x16x32_bf16 v[116:119], a[240:243], v[212:215], 0
v_mfma_f32_16x16x32_bf16 v[136:139], a[140:143], a[68:71], v[136:139]
v_mfma_f32_16x16x32_bf16 v[120:123], a[244:247], v[212:215], 0
v_mfma_f32_16x16x32_bf16 v[160:163], a[140:143], a[76:79], v[160:163]
buffer_load_dwordx4 v1, s[4:7], s44 offen offset:1024 sc1 lds
v_mfma_f32_16x16x32_bf16 v[160:163], a[136:139], a[72:75], v[160:163]
v_max3_f32 v240, v108, v109, v110
v_max3_f32 v241, -v108, -v109, -v110
v_mfma_f32_16x16x32_bf16 v[184:187], a[136:139], a[80:83], v[184:187]
v_max3_f32 v240, v240, v111, v112
v_max3_f32 v241, v241, -v111, -v112
v_mfma_f32_16x16x32_bf16 v[184:187], a[140:143], a[84:87], v[184:187]
v_max3_f32 v240, v240, v113, v114
v_max3_f32 v241, v241, -v113, -v114
v_mfma_f32_16x16x32_bf16 v[208:211], a[140:143], a[92:95], v[208:211]
v_max_f32 v240, v240, v115
v_max_f32_e64 v241, v241, -v115
v_mfma_f32_16x16x32_bf16 v[208:211], a[136:139], a[88:91], v[208:211]
buffer_load_dwordx4 v1, s[4:7], s44 offen offset:2048 sc1 lds
v_mfma_f32_16x16x32_bf16 v[208:211], a[144:147], a[24:27], v[208:211]
v_permlane32_swap_b32 v240, v241
v_mfma_f32_16x16x32_bf16 v[208:211], a[148:151], a[28:31], v[208:211]
v_max_f32 v240, v240, v241
v_mov_b32 v246, v240
v_mfma_f32_16x16x32_bf16 v[184:187], a[148:151], a[20:23], v[184:187]
s_nop 0
v_permlane16_swap_b32 v240, v246
v_mfma_f32_16x16x32_bf16 v[184:187], a[144:147], a[16:19], v[184:187]
v_max_f32 v240, v240, v246
v_mov_b32 v246, v240
v_mfma_f32_16x16x32_bf16 v[160:163], a[144:147], a[8:11], v[160:163]
buffer_load_dwordx4 v1, s[4:7], s44 offen offset:3072 sc1 lds
v_mfma_f32_16x16x32_bf16 v[160:163], a[148:151], a[12:15], v[160:163]
v_permlane32_swap_b32 v240, v246
v_mfma_f32_16x16x32_bf16 v[136:139], a[148:151], a[4:7], v[136:139]
v_mul_f32_e64 v240, -v240, v86
v_mul_f32_e64 v241, -v246, v86
v_mfma_f32_16x16x32_bf16 v[136:139], a[144:147], a[0:3], v[136:139]
v_max3_f32 v242, v116, v117, v118
v_max3_f32 v243, -v116, -v117, -v118
v_pk_mul_f32 v[148:149], v[148:149], v[82:83] op_sel:[0,1] op_sel_hi:[1,1]
v_pk_mul_f32 v[150:151], v[150:151], v[82:83] op_sel:[0,1] op_sel_hi:[1,1]
v_cvt_pk_bf16_f32 v148, v148, v149
v_cvt_pk_bf16_f32 v149, v150, v151
ds_write_b64 v232, v[148:149] offset:0
v_pk_mul_f32 v[152:153], v[152:153], v[82:83] op_sel:[0,1] op_sel_hi:[1,1]
v_pk_mul_f32 v[154:155], v[154:155], v[82:83] op_sel:[0,1] op_sel_hi:[1,1]
v_cvt_pk_bf16_f32 v150, v152, v153
v_cvt_pk_bf16_f32 v151, v154, v155
v_pk_mul_f32 v[172:173], v[172:173], v[84:85] op_sel:[0,1] op_sel_hi:[1,1]
v_pk_mul_f32 v[174:175], v[174:175], v[84:85] op_sel:[0,1] op_sel_hi:[1,1]
v_cvt_pk_bf16_f32 v172, v172, v173
v_cvt_pk_bf16_f32 v173, v174, v175
v_pk_mul_f32 v[176:177], v[176:177], v[84:85] op_sel:[0,1] op_sel_hi:[1,1]
v_pk_mul_f32 v[178:179], v[178:179], v[84:85] op_sel:[0,1] op_sel_hi:[1,1]
v_cvt_pk_bf16_f32 v174, v176, v177
v_cvt_pk_bf16_f32 v175, v178, v179
ds_write_b64 v232, v[150:151] offset:512
v_pk_mul_f32 v[196:197], v[196:197], v[86:87] op_sel:[0,1] op_sel_hi:[1,1]
v_pk_mul_f32 v[198:199], v[198:199], v[86:87] op_sel:[0,1] op_sel_hi:[1,1]
v_cvt_pk_bf16_f32 v196, v196, v197
v_cvt_pk_bf16_f32 v197, v198, v199
buffer_store_dwordx4 a[248:251], v254, s[4:7], s97 offen offset:0 sc1
v_pk_mul_f32 v[200:201], v[200:201], v[86:87] op_sel:[0,1] op_sel_hi:[1,1]
v_pk_mul_f32 v[202:203], v[202:203], v[86:87] op_sel:[0,1] op_sel_hi:[1,1]
v_cvt_pk_bf16_f32 v198, v200, v201
v_cvt_pk_bf16_f32 v199, v202, v203
ds_write_b64 v232, v[172:173] offset:1024
v_pk_mul_f32 v[220:221], v[220:221], v[88:89] op_sel:[0,1] op_sel_hi:[1,1]
v_pk_mul_f32 v[222:223], v[222:223], v[88:89] op_sel:[0,1] op_sel_hi:[1,1]
v_cvt_pk_bf16_f32 v220, v220, v221
v_cvt_pk_bf16_f32 v221, v222, v223
v_pk_fma_f32 v[48:49], v[92:93], v[82:83], v[236:237] op_sel:[0,0,0] op_sel_hi:[1,0,0]
v_pk_fma_f32 v[50:51], v[94:95], v[82:83], v[236:237] op_sel:[0,0,0] op_sel_hi:[1,0,0]
v_pk_fma_f32 v[52:53], v[96:97], v[82:83], v[236:237] op_sel:[0,0,0] op_sel_hi:[1,0,0]
v_pk_fma_f32 v[54:55], v[98:99], v[82:83], v[236:237] op_sel:[0,0,0] op_sel_hi:[1,0,0]
v_exp_f32 v48, v48
v_exp_f32 v49, v49
ds_write_b64 v232, v[174:175] offset:1536
v_exp_f32 v50, v50
v_exp_f32 v51, v51
v_exp_f32 v52, v52
v_exp_f32 v53, v53
v_exp_f32 v54, v54
v_exp_f32 v55, v55
ds_write_b64 v232, v[196:197] offset:2048
buffer_store_dwordx4 a[248:251], v1, s[4:7], s96 offen offset:0 sc1
v_cvt_pk_bf16_f32 v140, v48, v49
v_cvt_pk_bf16_f32 v141, v50, v51
v_cvt_pk_bf16_f32 v142, v52, v53
v_cvt_pk_bf16_f32 v143, v54, v55
v_pk_mul_f32 v[224:225], v[224:225], v[88:89] op_sel:[0,1] op_sel_hi:[1,1]
v_pk_mul_f32 v[226:227], v[226:227], v[88:89] op_sel:[0,1] op_sel_hi:[1,1]
v_cvt_pk_bf16_f32 v222, v224, v225
v_mfma_f32_16x16x32_bf16 v[148:151], v[16:19], v[140:143], 0
ds_write_b64 v232, v[198:199] offset:2560
v_cvt_pk_bf16_f32 v223, v226, v227
s_add_u32 m0, s19, 131072
v_pk_fma_f32 v[92:93], v[92:93], v[82:83], v[236:237] op_sel:[0,0,1] op_sel_hi:[1,0,1] neg_lo:[1,0,0] neg_hi:[1,0,0]
v_pk_fma_f32 v[94:95], v[94:95], v[82:83], v[236:237] op_sel:[0,0,1] op_sel_hi:[1,0,1] neg_lo:[1,0,0] neg_hi:[1,0,0]
v_pk_fma_f32 v[96:97], v[96:97], v[82:83], v[236:237] op_sel:[0,0,1] op_sel_hi:[1,0,1] neg_lo:[1,0,0] neg_hi:[1,0,0]
s_nop 1
v_rcp_f32 v148, v148
v_pk_fma_f32 v[98:99], v[98:99], v[82:83], v[236:237] op_sel:[0,0,1] op_sel_hi:[1,0,1] neg_lo:[1,0,0] neg_hi:[1,0,0]
v_pk_mul_f32 v[48:49], v[48:49], v[148:149] op_sel:[0,0] op_sel_hi:[1,0]
v_pk_mul_f32 v[50:51], v[50:51], v[148:149] op_sel:[0,0] op_sel_hi:[1,0]
v_cvt_pk_bf16_f32 v140, v48, v49
v_cvt_pk_bf16_f32 v141, v50, v51
ds_write_b64 v232, v[220:221] offset:3072
v_exp_f32 v92, v92
v_exp_f32 v93, v93
v_exp_f32 v94, v94
v_exp_f32 v95, v95
v_exp_f32 v96, v96
v_exp_f32 v97, v97
ds_write_b64 v232, v[222:223] offset:3584
v_exp_f32 v98, v98
v_exp_f32 v99, v99
s_add_u32 s44, s86, 0xc18000
v_cvt_pk_bf16_f32 v144, v92, v93
v_cvt_pk_bf16_f32 v145, v94, v95
v_cvt_pk_bf16_f32 v146, v96, v97
v_cvt_pk_bf16_f32 v147, v98, v99
buffer_load_dwordx4 v1, s[4:7], s44 offen offset:0 sc1 lds
v_pk_mul_f32 v[52:53], v[52:53], v[148:149] op_sel:[0,0] op_sel_hi:[1,0]
ds_write_b64 v233, v[140:141] offset:16384
v_pk_mul_f32 v[54:55], v[54:55], v[148:149] op_sel:[0,0] op_sel_hi:[1,0]
v_cvt_pk_bf16_f32 v142, v52, v53
v_mfma_f32_16x16x32_bf16 v[152:155], v[16:19], v[144:147], 0
v_cvt_pk_bf16_f32 v143, v54, v55
v_max3_f32 v242, v242, v119, v120
v_max3_f32 v243, v243, -v119, -v120
v_max3_f32 v242, v242, v121, v122
v_max3_f32 v243, v243, -v121, -v122
v_pk_fma_f32 v[56:57], v[100:101], v[84:85], v[238:239] op_sel:[0,0,0] op_sel_hi:[1,0,0]
v_pk_fma_f32 v[58:59], v[102:103], v[84:85], v[238:239] op_sel:[0,0,0] op_sel_hi:[1,0,0]
v_pk_fma_f32 v[60:61], v[104:105], v[84:85], v[238:239] op_sel:[0,0,0] op_sel_hi:[1,0,0]
ds_write_b64 v233, v[142:143] offset:16896
v_rcp_f32 v152, v152
v_pk_fma_f32 v[62:63], v[106:107], v[84:85], v[238:239] op_sel:[0,0,0] op_sel_hi:[1,0,0]
v_pk_mul_f32 v[92:93], v[92:93], v[152:153] op_sel:[0,0] op_sel_hi:[1,0]
v_pk_mul_f32 v[94:95], v[94:95], v[152:153] op_sel:[0,0] op_sel_hi:[1,0]
v_cvt_pk_bf16_f32 v144, v92, v93
v_cvt_pk_bf16_f32 v145, v94, v95
v_exp_f32 v56, v56
v_exp_f32 v57, v57
v_exp_f32 v58, v58
ds_write_b64 v233, v[144:145] offset:17408
v_exp_f32 v59, v59
v_exp_f32 v60, v60
v_exp_f32 v61, v61
v_exp_f32 v62, v62
v_exp_f32 v63, v63
buffer_load_dwordx4 v1, s[4:7], s44 offen offset:1024 sc1 lds
v_cvt_pk_bf16_f32 v164, v56, v57
v_cvt_pk_bf16_f32 v165, v58, v59
v_cvt_pk_bf16_f32 v166, v60, v61
v_cvt_pk_bf16_f32 v167, v62, v63
v_pk_mul_f32 v[96:97], v[96:97], v[152:153] op_sel:[0,0] op_sel_hi:[1,0]
v_pk_mul_f32 v[98:99], v[98:99], v[152:153] op_sel:[0,0] op_sel_hi:[1,0]
v_cvt_pk_bf16_f32 v146, v96, v97
v_mfma_f32_16x16x32_bf16 v[172:175], v[16:19], v[164:167], 0
v_cvt_pk_bf16_f32 v147, v98, v99
ds_write_b64 v233, v[146:147] offset:17920
v_max_f32 v242, v242, v123
v_pk_fma_f32 v[100:101], v[100:101], v[84:85], v[238:239] op_sel:[0,0,1] op_sel_hi:[1,0,1] neg_lo:[1,0,0] neg_hi:[1,0,0]
v_pk_fma_f32 v[102:103], v[102:103], v[84:85], v[238:239] op_sel:[0,0,1] op_sel_hi:[1,0,1] neg_lo:[1,0,0] neg_hi:[1,0,0]
v_pk_fma_f32 v[104:105], v[104:105], v[84:85], v[238:239] op_sel:[0,0,1] op_sel_hi:[1,0,1] neg_lo:[1,0,0] neg_hi:[1,0,0]
s_nop 1
v_rcp_f32 v172, v172
v_pk_fma_f32 v[106:107], v[106:107], v[84:85], v[238:239] op_sel:[0,0,1] op_sel_hi:[1,0,1] neg_lo:[1,0,0] neg_hi:[1,0,0]
v_pk_mul_f32 v[56:57], v[56:57], v[172:173] op_sel:[0,0] op_sel_hi:[1,0]
v_pk_mul_f32 v[58:59], v[58:59], v[172:173] op_sel:[0,0] op_sel_hi:[1,0]
v_cvt_pk_bf16_f32 v164, v56, v57
v_cvt_pk_bf16_f32 v165, v58, v59
v_exp_f32 v100, v100
ds_write_b64 v233, v[164:165] offset:18432
v_exp_f32 v101, v101
v_exp_f32 v102, v102
v_exp_f32 v103, v103
v_exp_f32 v104, v104
v_exp_f32 v105, v105
v_exp_f32 v106, v106
v_exp_f32 v107, v107
buffer_load_dwordx4 v1, s[4:7], s44 offen offset:2048 sc1 lds
v_cvt_pk_bf16_f32 v168, v100, v101
v_cvt_pk_bf16_f32 v169, v102, v103
v_cvt_pk_bf16_f32 v170, v104, v105
v_cvt_pk_bf16_f32 v171, v106, v107
v_pk_mul_f32 v[60:61], v[60:61], v[172:173] op_sel:[0,0] op_sel_hi:[1,0]
v_pk_mul_f32 v[62:63], v[62:63], v[172:173] op_sel:[0,0] op_sel_hi:[1,0]
v_cvt_pk_bf16_f32 v166, v60, v61
v_mfma_f32_16x16x32_bf16 v[176:179], v[16:19], v[168:171], 0
v_cvt_pk_bf16_f32 v167, v62, v63
ds_write_b64 v233, v[166:167] offset:18944
v_max_f32_e64 v243, v243, -v123
v_pk_fma_f32 v[64:65], v[108:109], v[86:87], v[240:241] op_sel:[0,0,0] op_sel_hi:[1,0,0]
v_pk_fma_f32 v[66:67], v[110:111], v[86:87], v[240:241] op_sel:[0,0,0] op_sel_hi:[1,0,0]
v_pk_fma_f32 v[68:69], v[112:113], v[86:87], v[240:241] op_sel:[0,0,0] op_sel_hi:[1,0,0]
s_nop 1
v_rcp_f32 v176, v176
v_pk_fma_f32 v[70:71], v[114:115], v[86:87], v[240:241] op_sel:[0,0,0] op_sel_hi:[1,0,0]
v_pk_mul_f32 v[100:101], v[100:101], v[176:177] op_sel:[0,0] op_sel_hi:[1,0]
v_pk_mul_f32 v[102:103], v[102:103], v[176:177] op_sel:[0,0] op_sel_hi:[1,0]
v_cvt_pk_bf16_f32 v168, v100, v101
v_cvt_pk_bf16_f32 v169, v102, v103
v_exp_f32 v64, v64
ds_write_b64 v233, v[168:169] offset:19456
buffer_load_dwordx4 v1, s[4:7], s44 offen offset:3072 sc1 lds
v_exp_f32 v65, v65
v_exp_f32 v66, v66
v_exp_f32 v67, v67
v_exp_f32 v68, v68
v_exp_f32 v69, v69
v_exp_f32 v70, v70
v_exp_f32 v71, v71
v_cvt_pk_bf16_f32 v188, v64, v65
v_cvt_pk_bf16_f32 v189, v66, v67
v_cvt_pk_bf16_f32 v190, v68, v69
v_cvt_pk_bf16_f32 v191, v70, v71
v_pk_mul_f32 v[104:105], v[104:105], v[176:177] op_sel:[0,0] op_sel_hi:[1,0]
v_pk_mul_f32 v[106:107], v[106:107], v[176:177] op_sel:[0,0] op_sel_hi:[1,0]
v_cvt_pk_bf16_f32 v170, v104, v105
v_mfma_f32_16x16x32_bf16 v[196:199], v[16:19], v[188:191], 0
v_cvt_pk_bf16_f32 v171, v106, v107
ds_write_b64 v233, v[170:171] offset:19968
buffer_store_dwordx4 a[248:251], v2, s[4:7], s72 offen offset:0 sc1
s_nop 4
v_rcp_f32 v196, v196
v_pk_fma_f32 v[108:109], v[108:109], v[86:87], v[240:241] op_sel:[0,0,1] op_sel_hi:[1,0,1] neg_lo:[1,0,0] neg_hi:[1,0,0]
v_pk_mul_f32 v[64:65], v[64:65], v[196:197] op_sel:[0,0] op_sel_hi:[1,0]
v_pk_mul_f32 v[66:67], v[66:67], v[196:197] op_sel:[0,0] op_sel_hi:[1,0]
v_cvt_pk_bf16_f32 v188, v64, v65
v_cvt_pk_bf16_f32 v189, v66, v67
v_pk_fma_f32 v[110:111], v[110:111], v[86:87], v[240:241] op_sel:[0,0,1] op_sel_hi:[1,0,1] neg_lo:[1,0,0] neg_hi:[1,0,0]
ds_write_b64 v233, v[188:189] offset:20480
v_pk_fma_f32 v[112:113], v[112:113], v[86:87], v[240:241] op_sel:[0,0,1] op_sel_hi:[1,0,1] neg_lo:[1,0,0] neg_hi:[1,0,0]
v_pk_fma_f32 v[114:115], v[114:115], v[86:87], v[240:241] op_sel:[0,0,1] op_sel_hi:[1,0,1] neg_lo:[1,0,0] neg_hi:[1,0,0]
v_exp_f32 v108, v108
v_exp_f32 v109, v109
v_exp_f32 v110, v110
v_exp_f32 v111, v111
v_exp_f32 v112, v112
v_exp_f32 v113, v113
v_exp_f32 v114, v114
v_exp_f32 v115, v115
v_cvt_pk_bf16_f32 v192, v108, v109
v_cvt_pk_bf16_f32 v193, v110, v111
v_cvt_pk_bf16_f32 v194, v112, v113
v_cvt_pk_bf16_f32 v195, v114, v115
v_pk_mul_f32 v[68:69], v[68:69], v[196:197] op_sel:[0,0] op_sel_hi:[1,0]
v_pk_mul_f32 v[70:71], v[70:71], v[196:197] op_sel:[0,0] op_sel_hi:[1,0]
v_permlane32_swap_b32 v242, v243
v_mfma_f32_16x16x32_bf16 v[200:203], v[16:19], v[192:195], 0
v_cvt_pk_bf16_f32 v190, v68, v69
v_cvt_pk_bf16_f32 v191, v70, v71
ds_write_b64 v233, v[190:191] offset:20992
v_max_f32 v242, v242, v243
v_mov_b32 v247, v242
buffer_store_dwordx4 a[248:251], v2, s[4:7], s72 offen offset:1024 sc1
s_nop 0
v_permlane16_swap_b32 v242, v247
v_rcp_f32 v200, v200
v_max_f32 v242, v242, v247
v_mov_b32 v247, v242
v_pk_mul_f32 v[108:109], v[108:109], v[200:201] op_sel:[0,0] op_sel_hi:[1,0]
v_pk_mul_f32 v[110:111], v[110:111], v[200:201] op_sel:[0,0] op_sel_hi:[1,0]
v_cvt_pk_bf16_f32 v192, v108, v109
v_cvt_pk_bf16_f32 v193, v110, v111
v_permlane32_swap_b32 v242, v247
ds_write_b64 v233, v[192:193] offset:21504
v_mul_f32_e64 v242, -v242, v88
v_mul_f32_e64 v243, -v247, v88
v_pk_fma_f32 v[124:125], v[116:117], v[88:89], v[242:243] op_sel:[0,0,0] op_sel_hi:[1,0,0]
v_pk_fma_f32 v[126:127], v[118:119], v[88:89], v[242:243] op_sel:[0,0,0] op_sel_hi:[1,0,0]
v_pk_fma_f32 v[128:129], v[120:121], v[88:89], v[242:243] op_sel:[0,0,0] op_sel_hi:[1,0,0]
v_pk_fma_f32 v[130:131], v[122:123], v[88:89], v[242:243] op_sel:[0,0,0] op_sel_hi:[1,0,0]
v_exp_f32 v124, v124
v_exp_f32 v125, v125
v_exp_f32 v126, v126
v_exp_f32 v127, v127
v_exp_f32 v128, v128
v_exp_f32 v129, v129
v_exp_f32 v130, v130
v_exp_f32 v131, v131
v_cvt_pk_bf16_f32 v212, v124, v125
v_cvt_pk_bf16_f32 v213, v126, v127
v_cvt_pk_bf16_f32 v214, v128, v129
v_cvt_pk_bf16_f32 v215, v130, v131
v_pk_mul_f32 v[112:113], v[112:113], v[200:201] op_sel:[0,0] op_sel_hi:[1,0]
v_pk_mul_f32 v[114:115], v[114:115], v[200:201] op_sel:[0,0] op_sel_hi:[1,0]
v_cvt_pk_bf16_f32 v194, v112, v113
v_mfma_f32_16x16x32_bf16 v[220:223], v[16:19], v[212:215], 0
v_cvt_pk_bf16_f32 v195, v114, v115
ds_write_b64 v233, v[194:195] offset:22016
buffer_store_dwordx4 a[248:251], v2, s[4:7], s72 offen offset:2048 sc1
s_nop 4
v_rcp_f32 v220, v220
v_pk_fma_f32 v[116:117], v[116:117], v[88:89], v[242:243] op_sel:[0,0,1] op_sel_hi:[1,0,1] neg_lo:[1,0,0] neg_hi:[1,0,0]
v_pk_mul_f32 v[124:125], v[124:125], v[220:221] op_sel:[0,0] op_sel_hi:[1,0]
v_pk_mul_f32 v[126:127], v[126:127], v[220:221] op_sel:[0,0] op_sel_hi:[1,0]
v_cvt_pk_bf16_f32 v212, v124, v125
v_cvt_pk_bf16_f32 v213, v126, v127
v_pk_fma_f32 v[118:119], v[118:119], v[88:89], v[242:243] op_sel:[0,0,1] op_sel_hi:[1,0,1] neg_lo:[1,0,0] neg_hi:[1,0,0]
ds_write_b64 v233, v[212:213] offset:22528
v_pk_fma_f32 v[120:121], v[120:121], v[88:89], v[242:243] op_sel:[0,0,1] op_sel_hi:[1,0,1] neg_lo:[1,0,0] neg_hi:[1,0,0]
v_pk_fma_f32 v[122:123], v[122:123], v[88:89], v[242:243] op_sel:[0,0,1] op_sel_hi:[1,0,1] neg_lo:[1,0,0] neg_hi:[1,0,0]
v_exp_f32 v116, v116
v_exp_f32 v117, v117
v_exp_f32 v118, v118
v_exp_f32 v119, v119
v_exp_f32 v120, v120
v_exp_f32 v121, v121
v_exp_f32 v122, v122
v_exp_f32 v123, v123
v_cvt_pk_bf16_f32 v216, v116, v117
v_cvt_pk_bf16_f32 v217, v118, v119
v_cvt_pk_bf16_f32 v218, v120, v121
v_cvt_pk_bf16_f32 v219, v122, v123
v_pk_mul_f32 v[128:129], v[128:129], v[220:221] op_sel:[0,0] op_sel_hi:[1,0]
v_pk_mul_f32 v[130:131], v[130:131], v[220:221] op_sel:[0,0] op_sel_hi:[1,0]
v_cvt_pk_bf16_f32 v214, v128, v129
v_mfma_f32_16x16x32_bf16 v[224:227], v[16:19], v[216:219], 0
v_cvt_pk_bf16_f32 v215, v130, v131
ds_write_b64 v233, v[214:215] offset:23040
buffer_store_dwordx4 a[248:251], v2, s[4:7], s72 offen offset:3072 sc1
s_nop 4
v_rcp_f32 v224, v224
s_nop 0
v_pk_mul_f32 v[116:117], v[116:117], v[224:225] op_sel:[0,0] op_sel_hi:[1,0]
v_pk_mul_f32 v[118:119], v[118:119], v[224:225] op_sel:[0,0] op_sel_hi:[1,0]
v_cvt_pk_bf16_f32 v216, v116, v117
v_cvt_pk_bf16_f32 v217, v118, v119
v_pk_mul_f32 v[120:121], v[120:121], v[224:225] op_sel:[0,0] op_sel_hi:[1,0]
ds_write_b64 v233, v[216:217] offset:23552
v_pk_mul_f32 v[122:123], v[122:123], v[224:225] op_sel:[0,0] op_sel_hi:[1,0]
v_cvt_pk_bf16_f32 v218, v120, v121
v_cvt_pk_bf16_f32 v219, v122, v123
ds_write_b64 v233, v[218:219] offset:24064
s_waitcnt vmcnt(8)
s_waitcnt lgkmcnt(0)
s_barrier
ds_read_b64_tr_b16 a[0:1], v234 offset:16384
ds_read_b64_tr_b16 a[2:3], v234 offset:18432
ds_read_b64_tr_b16 a[12:13], v234 offset:20480
ds_read_b64_tr_b16 a[14:15], v234 offset:22528
ds_read_b64_tr_b16 a[24:25], v234 offset:24576
ds_read_b64_tr_b16 a[26:27], v234 offset:26624
ds_read_b64_tr_b16 a[4:5], v8 offset:0
ds_read_b64_tr_b16 a[6:7], v8 offset:1024
ds_read_b64_tr_b16 a[8:9], v8 offset:512
ds_read_b64_tr_b16 a[10:11], v8 offset:1536
ds_read_b64_tr_b16 a[36:37], v234 offset:28672
ds_read_b64_tr_b16 a[38:39], v234 offset:30720
ds_read_b64_tr_b16 a[16:17], v8 offset:2048
ds_read_b64_tr_b16 a[18:19], v8 offset:3072
ds_read_b64_tr_b16 a[20:21], v8 offset:2560
ds_read_b64_tr_b16 a[22:23], v8 offset:3584
ds_read_b64_tr_b16 a[48:49], v234 offset:32768
ds_read_b64_tr_b16 a[50:51], v234 offset:34816
ds_read_b64_tr_b16 a[28:29], v8 offset:4096
ds_read_b64_tr_b16 a[30:31], v8 offset:5120
ds_read_b64_tr_b16 a[32:33], v8 offset:4608
ds_read_b64_tr_b16 a[34:35], v8 offset:5632
ds_read_b64_tr_b16 a[60:61], v234 offset:36864
ds_read_b64_tr_b16 a[62:63], v234 offset:38912
s_waitcnt lgkmcnt(14)
v_mfma_f32_16x16x32_bf16 v[100:103], a[0:3], v[16:19], 0
ds_read_b64_tr_b16 a[40:41], v8 offset:6144
ds_read_b64_tr_b16 a[42:43], v8 offset:7168
ds_read_b64_tr_b16 a[44:45], v8 offset:6656
ds_read_b64_tr_b16 a[46:47], v8 offset:7680
ds_read_b64_tr_b16 a[72:73], v234 offset:40960
ds_read_b64_tr_b16 a[74:75], v234 offset:43008
v_mfma_f32_16x16x32_bf16 v[100:103], a[12:15], v[16:19], v[100:103]
buffer_atomic_add v12, v235, s[4:7], s94 offen sc1
ds_read_b64_tr_b16 a[52:53], v8 offset:8192
ds_read_b64_tr_b16 a[54:55], v8 offset:9216
ds_read_b64_tr_b16 a[56:57], v8 offset:8704
ds_read_b64_tr_b16 a[58:59], v8 offset:9728
ds_read_b64_tr_b16 a[84:85], v234 offset:45056
ds_read_b64_tr_b16 a[86:87], v234 offset:47104
v_mfma_f32_16x16x32_bf16 v[100:103], a[24:27], v[16:19], v[100:103]
ds_read_b64_tr_b16 a[64:65], v8 offset:10240
ds_read_b64_tr_b16 a[66:67], v8 offset:11264
v_mfma_f32_16x16x32_bf16 v[92:95], a[0:3], a[4:7], 0
ds_read_b64_tr_b16 a[68:69], v8 offset:10752
ds_read_b64_tr_b16 a[70:71], v8 offset:11776
v_mfma_f32_16x16x32_bf16 v[96:99], a[0:3], a[8:11], 0
ds_read_b64_tr_b16 a[76:77], v8 offset:12288
s_waitcnt lgkmcnt(14)
v_mfma_f32_16x16x32_bf16 v[100:103], a[36:39], v[16:19], v[100:103]
ds_read_b64_tr_b16 a[78:79], v8 offset:13312
v_mfma_f32_16x16x32_bf16 v[92:95], a[12:15], a[16:19], v[92:95]
ds_read_b64_tr_b16 a[80:81], v8 offset:12800
ds_read_b64_tr_b16 a[82:83], v8 offset:13824
v_mfma_f32_16x16x32_bf16 v[96:99], a[12:15], a[20:23], v[96:99]
ds_read_b64_tr_b16 a[88:89], v8 offset:14336
v_mfma_f32_16x16x32_bf16 v[100:103], a[48:51], v[16:19], v[100:103]
ds_read_b64_tr_b16 a[90:91], v8 offset:15360
v_mfma_f32_16x16x32_bf16 v[92:95], a[24:27], a[28:31], v[92:95]
ds_read_b64_tr_b16 a[92:93], v8 offset:14848
ds_read_b64_tr_b16 a[94:95], v8 offset:15872
v_mfma_f32_16x16x32_bf16 v[96:99], a[24:27], a[32:35], v[96:99]
v_cvt_pk_bf16_f32 v132, v132, v133
v_cvt_pk_bf16_f32 v156, v156, v157
v_mfma_f32_16x16x32_bf16 v[100:103], a[60:63], v[16:19], v[100:103]
v_cvt_pk_bf16_f32 v180, v180, v181
v_cvt_pk_bf16_f32 v204, v204, v205
v_mfma_f32_16x16x32_bf16 v[92:95], a[36:39], a[40:43], v[92:95]
v_cvt_pk_bf16_f32 v133, v134, v135
v_cvt_pk_bf16_f32 v157, v158, v159
s_waitcnt lgkmcnt(14)
v_mfma_f32_16x16x32_bf16 v[96:99], a[36:39], a[44:47], v[96:99]
v_cvt_pk_bf16_f32 v181, v182, v183
v_cvt_pk_bf16_f32 v205, v206, v207
v_mfma_f32_16x16x32_bf16 v[100:103], a[72:75], v[16:19], v[100:103]
v_cvt_pk_bf16_f32 v134, v136, v137
v_cvt_pk_bf16_f32 v135, v138, v139
v_mfma_f32_16x16x32_bf16 v[92:95], a[48:51], a[52:55], v[92:95]
v_cvt_pk_bf16_f32 v158, v160, v161
v_cvt_pk_bf16_f32 v159, v162, v163
v_mfma_f32_16x16x32_bf16 v[96:99], a[48:51], a[56:59], v[96:99]
v_cvt_pk_bf16_f32 v182, v184, v185
v_cvt_pk_bf16_f32 v183, v186, v187
s_waitcnt lgkmcnt(12)
v_mfma_f32_16x16x32_bf16 v[100:103], a[84:87], v[16:19], v[100:103]
v_cvt_pk_bf16_f32 v206, v208, v209
v_cvt_pk_bf16_f32 v207, v210, v211
s_waitcnt lgkmcnt(10)
v_mfma_f32_16x16x32_bf16 v[92:95], a[60:63], a[64:67], v[92:95]
s_waitcnt lgkmcnt(8)
v_mfma_f32_16x16x32_bf16 v[96:99], a[60:63], a[68:71], v[96:99]
s_nop 1
v_min_u32 v100, -2, v100
v_min_u32 v101, -2, v101
s_waitcnt lgkmcnt(6)
v_mfma_f32_16x16x32_bf16 v[92:95], a[72:75], a[76:79], v[92:95]
v_min_u32 v102, -2, v102
v_min_u32 v103, -2, v103
s_waitcnt lgkmcnt(4)
v_mfma_f32_16x16x32_bf16 v[96:99], a[72:75], a[80:83], v[96:99]
buffer_store_dwordx4 v[100:103], v254, s[4:7], s97 offen sc1
s_waitcnt lgkmcnt(2)
v_mfma_f32_16x16x32_bf16 v[92:95], a[84:87], a[88:91], v[92:95]
s_waitcnt lgkmcnt(0)
v_mfma_f32_16x16x32_bf16 v[96:99], a[84:87], a[92:95], v[96:99]
s_nop 5
v_cvt_pk_bf16_f32 v92, v92, v93
v_cvt_pk_bf16_f32 v93, v94, v95
v_min_u32 v92, -2, v92
v_min_u32 v93, -2, v93
v_cvt_pk_bf16_f32 v94, v96, v97
v_cvt_pk_bf16_f32 v95, v98, v99
v_min_u32 v94, -2, v94
v_min_u32 v95, -2, v95
buffer_store_dwordx4 v[92:95], v1, s[4:7], s96 offen sc1
s_barrier
s_add_u32 m0, s19, 32768
s_add_u32 s44, s84, 0xc00000
buffer_load_dwordx4 v1, s[4:7], s44 offen offset:0 sc1 lds
v_mfma_f32_16x16x32_bf16 v[108:111], a[240:243], v[132:135], 0
v_mfma_f32_16x16x32_bf16 v[172:175], a[240:243], v[156:159], 0
v_mfma_f32_16x16x32_bf16 v[112:115], a[244:247], v[132:135], 0
s_nop 5
v_max3_f32 v236, v108, v109, v110
v_max3_f32 v237, -v108, -v109, -v110
v_mfma_f32_16x16x32_bf16 v[176:179], a[244:247], v[156:159], 0
v_max3_f32 v238, v172, v173, v174
v_max3_f32 v239, -v172, -v173, -v174
v_max3_f32 v236, v236, v111, v112
v_max3_f32 v237, v237, -v111, -v112
v_max3_f32 v236, v236, v113, v114
v_max3_f32 v237, v237, -v113, -v114
s_nop 1
v_max3_f32 v238, v238, v175, v176
v_max3_f32 v239, v239, -v175, -v176
v_max3_f32 v238, v238, v177, v178
v_max3_f32 v239, v239, -v177, -v178
v_max_f32 v236, v236, v115
buffer_load_dwordx4 v1, s[4:7], s44 offen offset:1024 sc1 lds
v_max_f32_e64 v237, v237, -v115
v_max_f32 v238, v238, v179
v_max_f32_e64 v239, v239, -v179
v_permlane32_swap_b32 v236, v237
s_nop 0
v_permlane32_swap_b32 v238, v239
v_mov_b32 v11, 0
buffer_atomic_add v11, v251, s[4:7], s89 offen sc0 sc1
v_max_f32 v236, v236, v237
v_max_f32 v238, v238, v239
v_mov_b32 v244, v236
v_mov_b32 v245, v238
s_nop 0
v_permlane16_swap_b32 v236, v244
v_permlane16_swap_b32 v238, v245
v_max_f32 v236, v236, v244
v_max_f32 v238, v238, v245
v_mov_b32 v244, v236
v_mov_b32 v245, v238
s_nop 0
v_permlane32_swap_b32 v236, v244
v_permlane32_swap_b32 v238, v245
v_mul_f32_e64 v236, -v236, v82
v_mul_f32_e64 v237, -v244, v82
buffer_load_dwordx4 v1, s[4:7], s44 offen offset:2048 sc1 lds
v_mul_f32_e64 v238, -v238, v84
v_mul_f32_e64 v239, -v245, v84
v_pk_fma_f32 v[116:117], v[108:109], v[82:83], v[236:237] op_sel:[0,0,0] op_sel_hi:[1,0,0]
v_pk_fma_f32 v[118:119], v[110:111], v[82:83], v[236:237] op_sel:[0,0,0] op_sel_hi:[1,0,0]
v_pk_fma_f32 v[120:121], v[112:113], v[82:83], v[236:237] op_sel:[0,0,0] op_sel_hi:[1,0,0]
v_pk_fma_f32 v[122:123], v[114:115], v[82:83], v[236:237] op_sel:[0,0,0] op_sel_hi:[1,0,0]
v_pk_fma_f32 v[148:149], v[172:173], v[84:85], v[238:239] op_sel:[0,0,0] op_sel_hi:[1,0,0]
v_pk_fma_f32 v[150:151], v[174:175], v[84:85], v[238:239] op_sel:[0,0,0] op_sel_hi:[1,0,0]
v_pk_fma_f32 v[152:153], v[176:177], v[84:85], v[238:239] op_sel:[0,0,0] op_sel_hi:[1,0,0]
v_pk_fma_f32 v[154:155], v[178:179], v[84:85], v[238:239] op_sel:[0,0,0] op_sel_hi:[1,0,0]
v_pk_fma_f32 v[108:109], v[108:109], v[82:83], v[236:237] op_sel:[0,0,1] op_sel_hi:[1,0,1] neg_lo:[1,0,0] neg_hi:[1,0,0]
v_pk_fma_f32 v[110:111], v[110:111], v[82:83], v[236:237] op_sel:[0,0,1] op_sel_hi:[1,0,1] neg_lo:[1,0,0] neg_hi:[1,0,0]
v_pk_fma_f32 v[112:113], v[112:113], v[82:83], v[236:237] op_sel:[0,0,1] op_sel_hi:[1,0,1] neg_lo:[1,0,0] neg_hi:[1,0,0]
v_pk_fma_f32 v[114:115], v[114:115], v[82:83], v[236:237] op_sel:[0,0,1] op_sel_hi:[1,0,1] neg_lo:[1,0,0] neg_hi:[1,0,0]
v_pk_fma_f32 v[172:173], v[172:173], v[84:85], v[238:239] op_sel:[0,0,1] op_sel_hi:[1,0,1] neg_lo:[1,0,0] neg_hi:[1,0,0]
v_pk_fma_f32 v[174:175], v[174:175], v[84:85], v[238:239] op_sel:[0,0,1] op_sel_hi:[1,0,1] neg_lo:[1,0,0] neg_hi:[1,0,0]
v_pk_fma_f32 v[176:177], v[176:177], v[84:85], v[238:239] op_sel:[0,0,1] op_sel_hi:[1,0,1] neg_lo:[1,0,0] neg_hi:[1,0,0]
v_pk_fma_f32 v[178:179], v[178:179], v[84:85], v[238:239] op_sel:[0,0,1] op_sel_hi:[1,0,1] neg_lo:[1,0,0] neg_hi:[1,0,0]
v_exp_f32 v116, v116
v_exp_f32 v108, v108
v_exp_f32 v117, v117
v_exp_f32 v109, v109
v_exp_f32 v118, v118
v_exp_f32 v110, v110
v_exp_f32 v119, v119
v_exp_f32 v111, v111
v_exp_f32 v120, v120
v_exp_f32 v112, v112
v_exp_f32 v121, v121
v_exp_f32 v113, v113
v_exp_f32 v122, v122
v_exp_f32 v114, v114
v_exp_f32 v123, v123
v_exp_f32 v115, v115
v_exp_f32 v148, v148
v_exp_f32 v172, v172
v_exp_f32 v149, v149
v_exp_f32 v173, v173
v_exp_f32 v150, v150
v_exp_f32 v174, v174
v_exp_f32 v151, v151
v_exp_f32 v175, v175
v_exp_f32 v152, v152
v_exp_f32 v176, v176
v_exp_f32 v153, v153
v_exp_f32 v177, v177
v_exp_f32 v154, v154
v_exp_f32 v178, v178
v_exp_f32 v155, v155
v_exp_f32 v179, v179
buffer_load_dwordx4 v1, s[4:7], s44 offen offset:3072 sc1 lds
v_cvt_pk_bf16_f32 v140, v116, v117
v_cvt_pk_bf16_f32 v141, v118, v119
v_cvt_pk_bf16_f32 v142, v120, v121
v_cvt_pk_bf16_f32 v143, v122, v123
v_cvt_pk_bf16_f32 v144, v108, v109
v_cvt_pk_bf16_f32 v145, v110, v111
v_cvt_pk_bf16_f32 v146, v112, v113
v_cvt_pk_bf16_f32 v147, v114, v115
v_cvt_pk_bf16_f32 v164, v148, v149
L_stub8:
s_cbranch_execz L_wret2
v_cvt_pk_bf16_f32 v165, v150, v151
v_cvt_pk_bf16_f32 v166, v152, v153
v_cvt_pk_bf16_f32 v167, v154, v155
v_cvt_pk_bf16_f32 v168, v172, v173
v_cvt_pk_bf16_f32 v169, v174, v175
v_cvt_pk_bf16_f32 v170, v176, v177
v_cvt_pk_bf16_f32 v171, v178, v179
s_waitcnt vmcnt(2)
v_readfirstlane_b32 s38, v11
s_nop 0
s_cmp_ge_u32 s38, 8
s_cbranch_scc1 Lpe_19
s_add_u32 s36, s88, 0x80000
s_mov_b32 s37, 0
Lpoll_18:
v_mov_b32 v11, 0
buffer_atomic_add v11, v251, s[4:7], s36 offen sc0 sc1
s_add_u32 s37, s37, 1
s_waitcnt vmcnt(0)
v_readfirstlane_b32 s38, v11
s_nop 0
s_cmp_ge_u32 s38, 8
s_cbranch_scc1 Lpe_19
s_cmp_lt_u32 s37, 0x100000
s_cbranch_scc1 Lpoll_18
Lpe_19:
buffer_load_dwordx4 v[48:51], v1, s[4:7], s98 offen offset:0 sc1
v_mfma_f32_16x16x32_bf16 v[108:111], a[240:243], v[180:183], 0
v_mfma_f32_16x16x32_bf16 v[220:223], a[240:243], v[204:207], 0
v_mfma_f32_16x16x32_bf16 v[112:115], a[244:247], v[180:183], 0
s_nop 5
v_max3_f32 v240, v108, v109, v110
v_max3_f32 v241, -v108, -v109, -v110
v_mfma_f32_16x16x32_bf16 v[224:227], a[244:247], v[204:207], 0
buffer_load_dwordx4 v[124:127], v248, s[4:7], s100 offen sc1
v_max3_f32 v242, v220, v221, v222
v_max3_f32 v243, -v220, -v221, -v222
v_max3_f32 v240, v240, v111, v112
v_max3_f32 v241, v241, -v111, -v112
v_max3_f32 v240, v240, v113, v114
s_nop 1
v_max3_f32 v242, v242, v223, v224
v_max3_f32 v243, v243, -v223, -v224
v_max3_f32 v241, v241, -v113, -v114
v_max3_f32 v242, v242, v225, v226
v_max3_f32 v243, v243, -v225, -v226
v_max_f32 v240, v240, v115
v_max_f32_e64 v241, v241, -v115
v_max_f32 v242, v242, v227
buffer_load_dwordx4 v[52:55], v1, s[4:7], s98 offen offset:1024 sc1
v_max_f32_e64 v243, v243, -v227
v_permlane32_swap_b32 v240, v241
s_nop 0
v_permlane32_swap_b32 v242, v243
v_max_f32 v240, v240, v241
v_max_f32 v242, v242, v243
v_mov_b32 v246, v240
v_mov_b32 v247, v242
s_nop 0
v_permlane16_swap_b32 v240, v246
v_permlane16_swap_b32 v242, v247
buffer_load_dwordx4 v[56:59], v1, s[4:7], s98 offen offset:2048 sc1
v_max_f32 v240, v240, v246
v_max_f32 v242, v242, v247
v_mov_b32 v246, v240
v_mov_b32 v247, v242
s_nop 0
v_permlane32_swap_b32 v240, v246
v_permlane32_swap_b32 v242, v247
v_mul_f32_e64 v240, -v240, v86
v_mul_f32_e64 v241, -v246, v86
v_mul_f32_e64 v242, -v242, v88
v_mul_f32_e64 v243, -v247, v88
buffer_load_dwordx4 v[60:63], v1, s[4:7], s98 offen offset:3072 sc1
v_pk_fma_f32 v[116:117], v[108:109], v[86:87], v[240:241] op_sel:[0,0,0] op_sel_hi:[1,0,0]
v_pk_fma_f32 v[118:119], v[110:111], v[86:87], v[240:241] op_sel:[0,0,0] op_sel_hi:[1,0,0]
v_pk_fma_f32 v[120:121], v[112:113], v[86:87], v[240:241] op_sel:[0,0,0] op_sel_hi:[1,0,0]
v_pk_fma_f32 v[122:123], v[114:115], v[86:87], v[240:241] op_sel:[0,0,0] op_sel_hi:[1,0,0]
v_pk_fma_f32 v[196:197], v[220:221], v[88:89], v[242:243] op_sel:[0,0,0] op_sel_hi:[1,0,0]
v_pk_fma_f32 v[198:199], v[222:223], v[88:89], v[242:243] op_sel:[0,0,0] op_sel_hi:[1,0,0]
v_pk_fma_f32 v[200:201], v[224:225], v[88:89], v[242:243] op_sel:[0,0,0] op_sel_hi:[1,0,0]
v_pk_fma_f32 v[202:203], v[226:227], v[88:89], v[242:243] op_sel:[0,0,0] op_sel_hi:[1,0,0]
v_pk_fma_f32 v[108:109], v[108:109], v[86:87], v[240:241] op_sel:[0,0,1] op_sel_hi:[1,0,1] neg_lo:[1,0,0] neg_hi:[1,0,0]
v_pk_fma_f32 v[110:111], v[110:111], v[86:87], v[240:241] op_sel:[0,0,1] op_sel_hi:[1,0,1] neg_lo:[1,0,0] neg_hi:[1,0,0]
v_pk_fma_f32 v[112:113], v[112:113], v[86:87], v[240:241] op_sel:[0,0,1] op_sel_hi:[1,0,1] neg_lo:[1,0,0] neg_hi:[1,0,0]
v_pk_fma_f32 v[114:115], v[114:115], v[86:87], v[240:241] op_sel:[0,0,1] op_sel_hi:[1,0,1] neg_lo:[1,0,0] neg_hi:[1,0,0]
v_pk_fma_f32 v[220:221], v[220:221], v[88:89], v[242:243] op_sel:[0,0,1] op_sel_hi:[1,0,1] neg_lo:[1,0,0] neg_hi:[1,0,0]
buffer_load_dwordx4 v[64:67], v1, s[4:7], s99 offen offset:0 sc1
v_pk_fma_f32 v[222:223], v[222:223], v[88:89], v[242:243] op_sel:[0,0,1] op_sel_hi:[1,0,1] neg_lo:[1,0,0] neg_hi:[1,0,0]
v_pk_fma_f32 v[224:225], v[224:225], v[88:89], v[242:243] op_sel:[0,0,1] op_sel_hi:[1,0,1] neg_lo:[1,0,0] neg_hi:[1,0,0]
v_pk_fma_f32 v[226:227], v[226:227], v[88:89], v[242:243] op_sel:[0,0,1] op_sel_hi:[1,0,1] neg_lo:[1,0,0] neg_hi:[1,0,0]
v_exp_f32 v116, v116
v_exp_f32 v108, v108
v_exp_f32 v117, v117
v_exp_f32 v109, v109
v_exp_f32 v118, v118
buffer_load_dwordx4 v[68:71], v1, s[4:7], s99 offen offset:1024 sc1
v_exp_f32 v110, v110
v_exp_f32 v119, v119
v_exp_f32 v111, v111
v_exp_f32 v120, v120
v_exp_f32 v112, v112
v_exp_f32 v121, v121
v_exp_f32 v113, v113
buffer_load_dwordx4 v[100:103], v1, s[4:7], s99 offen offset:2048 sc1
v_exp_f32 v122, v122
v_exp_f32 v114, v114
v_exp_f32 v123, v123
v_exp_f32 v115, v115
v_exp_f32 v196, v196
v_exp_f32 v220, v220
v_exp_f32 v197, v197
buffer_load_dwordx4 v[104:107], v1, s[4:7], s99 offen offset:3072 sc1
v_exp_f32 v221, v221
v_exp_f32 v198, v198
v_exp_f32 v222, v222
v_exp_f32 v199, v199
v_exp_f32 v223, v223
v_exp_f32 v200, v200
v_exp_f32 v224, v224
buffer_store_dwordx4 a[248:251], v2, s[4:7], s73 offen offset:0 sc1
v_exp_f32 v201, v201
v_exp_f32 v225, v225
v_exp_f32 v202, v202
v_exp_f32 v226, v226
v_exp_f32 v203, v203
v_exp_f32 v227, v227
v_cvt_pk_bf16_f32 v188, v116, v117
v_cvt_pk_bf16_f32 v189, v118, v119
v_cvt_pk_bf16_f32 v190, v120, v121
v_cvt_pk_bf16_f32 v191, v122, v123
v_cvt_pk_bf16_f32 v192, v108, v109
v_cvt_pk_bf16_f32 v193, v110, v111
v_cvt_pk_bf16_f32 v194, v112, v113
v_cvt_pk_bf16_f32 v195, v114, v115
v_cvt_pk_bf16_f32 v212, v196, v197
v_cvt_pk_bf16_f32 v213, v198, v199
v_cvt_pk_bf16_f32 v214, v200, v201
v_cvt_pk_bf16_f32 v215, v202, v203
v_cvt_pk_bf16_f32 v216, v220, v221
v_cvt_pk_bf16_f32 v217, v222, v223
v_cvt_pk_bf16_f32 v218, v224, v225
v_cvt_pk_bf16_f32 v219, v226, v227
buffer_store_dwordx4 a[248:251], v2, s[4:7], s73 offen offset:1024 sc1
s_waitcnt vmcnt(10)
v_lshlrev_b32 v92, 16, v48
v_and_b32 v93, 0xffff0000, v48
v_lshlrev_b32 v94, 16, v49
v_and_b32 v95, 0xffff0000, v49
v_lshlrev_b32 v96, 16, v50
v_and_b32 v97, 0xffff0000, v50
v_lshlrev_b32 v98, 16, v51
v_and_b32 v99, 0xffff0000, v51
s_waitcnt vmcnt(9)
v_add_f32_dpp v128, v124, v124 row_ror:4 row_mask:0xf bank_mask:0xf
v_add_f32_dpp v129, v125, v125 row_ror:4 row_mask:0xf bank_mask:0xf
v_add_f32_dpp v130, v126, v126 row_ror:4 row_mask:0xf bank_mask:0xf
v_add_f32_dpp v131, v127, v127 row_ror:4 row_mask:0xf bank_mask:0xf
v_add_f32_dpp v128, v128, v128 row_ror:2 row_mask:0xf bank_mask:0xf
v_add_f32_dpp v129, v129, v129 row_ror:2 row_mask:0xf bank_mask:0xf
v_add_f32_dpp v130, v130, v130 row_ror:2 row_mask:0xf bank_mask:0xf
buffer_store_dwordx4 a[248:251], v2, s[4:7], s73 offen offset:2048 sc1
v_add_f32_dpp v131, v131, v131 row_ror:2 row_mask:0xf bank_mask:0xf
v_add_f32_dpp v128, v128, v128 row_ror:1 row_mask:0xf bank_mask:0xf
v_add_f32_dpp v129, v129, v129 row_ror:1 row_mask:0xf bank_mask:0xf
v_add_f32_dpp v130, v130, v130 row_ror:1 row_mask:0xf bank_mask:0xf
v_add_f32_dpp v131, v131, v131 row_ror:1 row_mask:0xf bank_mask:0xf
s_waitcnt vmcnt(9)
v_dot2c_f32_bf16 v92, v52, v249
v_dot2c_f32_bf16 v93, v52, v250
v_dot2c_f32_bf16 v94, v53, v249
v_dot2c_f32_bf16 v95, v53, v250
v_dot2c_f32_bf16 v96, v54, v249
v_dot2c_f32_bf16 v97, v54, v250
v_dot2c_f32_bf16 v98, v55, v249
v_dot2c_f32_bf16 v99, v55, v250
v_fma_f32 v135, v129, v130, v131
s_waitcnt vmcnt(8)
v_dot2c_f32_bf16 v92, v56, v249
v_dot2c_f32_bf16 v93, v56, v250
v_dot2c_f32_bf16 v94, v57, v249
v_dot2c_f32_bf16 v95, v57, v250
v_dot2c_f32_bf16 v96, v58, v249
v_dot2c_f32_bf16 v97, v58, v250
v_dot2c_f32_bf16 v98, v59, v249
v_dot2c_f32_bf16 v99, v59, v250
buffer_store_dwordx4 a[248:251], v2, s[4:7], s73 offen offset:3072 sc1
s_waitcnt vmcnt(8)
v_dot2c_f32_bf16 v92, v60, v249
v_dot2c_f32_bf16 v93, v60, v250
v_dot2c_f32_bf16 v94, v61, v249
v_dot2c_f32_bf16 v95, v61, v250
v_dot2c_f32_bf16 v96, v62, v249
v_dot2c_f32_bf16 v97, v62, v250
v_dot2c_f32_bf16 v98, v63, v249
v_dot2c_f32_bf16 v99, v63, v250
s_waitcnt vmcnt(7)
v_dot2c_f32_bf16 v92, v64, v249
v_dot2c_f32_bf16 v93, v64, v250
v_dot2c_f32_bf16 v94, v65, v249
v_dot2c_f32_bf16 v95, v65, v250
v_dot2c_f32_bf16 v96, v66, v249
v_dot2c_f32_bf16 v97, v66, v250
v_dot2c_f32_bf16 v98, v67, v249
v_dot2c_f32_bf16 v99, v67, v250
s_waitcnt vmcnt(6)
v_dot2c_f32_bf16 v92, v68, v249
v_dot2c_f32_bf16 v93, v68, v250
v_dot2c_f32_bf16 v94, v69, v249
v_dot2c_f32_bf16 v95, v69, v250
v_dot2c_f32_bf16 v96, v70, v249
v_dot2c_f32_bf16 v97, v70, v250
v_dot2c_f32_bf16 v98, v71, v249
v_dot2c_f32_bf16 v99, v71, v250
s_waitcnt vmcnt(5)
v_dot2c_f32_bf16 v92, v100, v249
v_dot2c_f32_bf16 v93, v100, v250
v_dot2c_f32_bf16 v94, v101, v249
v_dot2c_f32_bf16 v95, v101, v250
v_dot2c_f32_bf16 v96, v102, v249
v_dot2c_f32_bf16 v97, v102, v250
v_dot2c_f32_bf16 v98, v103, v249
v_dot2c_f32_bf16 v99, v103, v250
s_waitcnt vmcnt(4)
v_dot2c_f32_bf16 v92, v104, v249
v_dot2c_f32_bf16 v93, v104, v250
v_dot2c_f32_bf16 v94, v105, v249
v_dot2c_f32_bf16 v95, v105, v250
v_dot2c_f32_bf16 v96, v106, v249
v_dot2c_f32_bf16 v97, v106, v250
v_dot2c_f32_bf16 v98, v107, v249
v_dot2c_f32_bf16 v99, v107, v250
v_fma_f32 v132, v92, v93, v94
v_fma_f32 v133, v95, v96, v97
s_nop 0
v_fma_f32 v134, v98, v99, v128
v_fma_f32 v132, v132, v133, v134
v_cmp_u_f32 vcc, v132, v135
s_cbranch_vccnz L_kvredo1
L_kvback1:
v_cvt_pk_bf16_f32 v128, v128, v129
v_cvt_pk_bf16_f32 v129, v130, v131
v_cvt_pk_bf16_f32 v92, v92, v93
v_cndmask_b32 v128, 0, v128, s[56:57]
v_cndmask_b32 v129, 0, v129, s[56:57]
v_cvt_pk_bf16_f32 v93, v94, v95
v_cvt_pk_bf16_f32 v94, v96, v97
v_cvt_pk_bf16_f32 v95, v98, v99
v_cndmask_b32 v128, v128, v16, s[58:59]
v_cndmask_b32 v129, v129, v16, s[58:59]
ds_write_b64 v252, v[92:93] offset:0
ds_write_b64 v252, v[94:95] offset:1024
ds_write_b64 v252, v[128:129] offset:2048
s_waitcnt lgkmcnt(0)
s_barrier
ds_read_b128 a[8:11], v1 offset:2048
ds_read_b128 a[20:23], v1 offset:5120
ds_read_b128 a[0:3], v1 offset:0
ds_read_b128 a[12:15], v1 offset:3072
ds_read_b128 a[4:7], v1 offset:1024
ds_read_b128 a[16:19], v1 offset:4096
s_waitcnt lgkmcnt(5)
v_mfma_f32_16x16x32_bf16 v[92:95], a[8:11], v[140:143], 0
s_waitcnt lgkmcnt(4)
v_mfma_f32_16x16x32_bf16 v[96:99], a[20:23], v[144:147], 0
s_waitcnt lgkmcnt(3)
v_mfma_f32_16x16x32_bf16 v[132:135], a[0:3], v[140:143], 0
s_nop 3
v_rcp_f32 v94, v93
s_waitcnt lgkmcnt(2)
v_mfma_f32_16x16x32_bf16 v[148:151], a[12:15], v[144:147], 0
v_rcp_f32 v95, v97
v_mul_f32 v92, v92, v94
v_fmac_f32 v92, v96, v95
v_mfma_f32_16x16x32_bf16 v[100:103], a[8:11], v[164:167], 0
v_add_f32 v92, 0x358637bd, v92
v_rcp_f32 v92, v92
s_waitcnt lgkmcnt(1)
v_mfma_f32_16x16x32_bf16 v[136:139], a[4:7], v[140:143], 0
v_mul_f32 v94, v94, v92
v_mul_f32 v95, v95, v92
v_mfma_f32_16x16x32_bf16 v[104:107], a[20:23], v[168:171], 0
v_mul_f32 v132, v132, v94
v_mul_f32 v133, v133, v94
s_waitcnt lgkmcnt(0)
v_mfma_f32_16x16x32_bf16 v[152:155], a[16:19], v[144:147], 0
v_mul_f32 v134, v134, v94
v_mul_f32 v135, v135, v94
v_fmac_f32 v132, v148, v95
v_fmac_f32 v133, v149, v95
v_rcp_f32 v102, v101
v_mul_f32 v136, v136, v94
v_mul_f32 v137, v137, v94
v_mul_f32 v138, v138, v94
v_mul_f32 v139, v139, v94
v_fmac_f32 v134, v150, v95
v_fmac_f32 v135, v151, v95
v_cvt_pk_bf16_f32 v132, v132, v133
v_rcp_f32 v103, v105
v_fmac_f32 v136, v152, v95
v_fmac_f32 v137, v153, v95
v_fmac_f32 v138, v154, v95
v_fmac_f32 v139, v155, v95
v_cvt_pk_bf16_f32 v133, v134, v135
v_cvt_pk_bf16_f32 v134, v136, v137
v_cvt_pk_bf16_f32 v135, v138, v139
v_mul_f32 v100, v100, v102
v_mfma_f32_16x16x32_bf16 v[156:159], a[0:3], v[164:167], 0
buffer_store_dwordx4 v[132:135], v2, s[4:7], s72 offen offset:0 sc1
v_fmac_f32 v100, v104, v103
v_mfma_f32_16x16x32_bf16 v[172:175], a[12:15], v[168:171], 0
v_add_f32 v100, 0x358637bd, v100
v_rcp_f32 v100, v100
v_mfma_f32_16x16x32_bf16 v[108:111], a[8:11], v[188:191], 0
v_mul_f32 v102, v102, v100
v_mul_f32 v103, v103, v100
v_mfma_f32_16x16x32_bf16 v[160:163], a[4:7], v[164:167], 0
v_mul_f32 v156, v156, v102
v_mul_f32 v157, v157, v102
v_mfma_f32_16x16x32_bf16 v[112:115], a[20:23], v[192:195], 0
v_mul_f32 v158, v158, v102
v_mul_f32 v159, v159, v102
v_mfma_f32_16x16x32_bf16 v[176:179], a[16:19], v[168:171], 0
v_fmac_f32 v156, v172, v103
v_fmac_f32 v157, v173, v103
v_rcp_f32 v110, v109
v_mul_f32 v160, v160, v102
v_mul_f32 v161, v161, v102
v_mul_f32 v162, v162, v102
v_mul_f32 v163, v163, v102
v_fmac_f32 v158, v174, v103
v_fmac_f32 v159, v175, v103
v_cvt_pk_bf16_f32 v156, v156, v157
v_rcp_f32 v111, v113
v_fmac_f32 v160, v176, v103
v_fmac_f32 v161, v177, v103
v_fmac_f32 v162, v178, v103
v_fmac_f32 v163, v179, v103
v_cvt_pk_bf16_f32 v157, v158, v159
v_cvt_pk_bf16_f32 v158, v160, v161
v_cvt_pk_bf16_f32 v159, v162, v163
v_mul_f32 v108, v108, v110
v_mfma_f32_16x16x32_bf16 v[180:183], a[0:3], v[188:191], 0
buffer_store_dwordx4 v[156:159], v2, s[4:7], s72 offen offset:1024 sc1
v_fmac_f32 v108, v112, v111
v_mfma_f32_16x16x32_bf16 v[196:199], a[12:15], v[192:195], 0
v_add_f32 v108, 0x358637bd, v108
v_rcp_f32 v108, v108
v_mfma_f32_16x16x32_bf16 v[116:119], a[8:11], v[212:215], 0
v_mul_f32 v110, v110, v108
v_mul_f32 v111, v111, v108
v_mfma_f32_16x16x32_bf16 v[184:187], a[4:7], v[188:191], 0
v_mul_f32 v180, v180, v110
v_mul_f32 v181, v181, v110
v_mfma_f32_16x16x32_bf16 v[120:123], a[20:23], v[216:219], 0
v_mul_f32 v182, v182, v110
v_mul_f32 v183, v183, v110
v_mfma_f32_16x16x32_bf16 v[200:203], a[16:19], v[192:195], 0
v_fmac_f32 v180, v196, v111
v_fmac_f32 v181, v197, v111
v_rcp_f32 v118, v117
v_mul_f32 v184, v184, v110
v_mul_f32 v185, v185, v110
v_mul_f32 v186, v186, v110
v_mul_f32 v187, v187, v110
v_fmac_f32 v182, v198, v111
v_fmac_f32 v183, v199, v111
v_cvt_pk_bf16_f32 v180, v180, v181
v_rcp_f32 v119, v121
buffer_atomic_add v12, v10, s[4:7], s74 offen sc1
v_fmac_f32 v184, v200, v111
v_fmac_f32 v185, v201, v111
v_fmac_f32 v186, v202, v111
v_fmac_f32 v187, v203, v111
v_cvt_pk_bf16_f32 v181, v182, v183
v_cvt_pk_bf16_f32 v182, v184, v185
v_cvt_pk_bf16_f32 v183, v186, v187
v_mul_f32 v116, v116, v118
v_mfma_f32_16x16x32_bf16 v[204:207], a[0:3], v[212:215], 0
buffer_store_dwordx4 v[180:183], v2, s[4:7], s72 offen offset:2048 sc1
v_fmac_f32 v116, v120, v119
v_mfma_f32_16x16x32_bf16 v[220:223], a[12:15], v[216:219], 0
v_add_f32 v116, 0x358637bd, v116
v_rcp_f32 v116, v116
v_mfma_f32_16x16x32_bf16 v[208:211], a[4:7], v[212:215], 0
v_mul_f32 v118, v118, v116
v_mul_f32 v119, v119, v116
v_mfma_f32_16x16x32_bf16 v[224:227], a[16:19], v[216:219], 0
v_mul_f32 v204, v204, v118
v_mul_f32 v205, v205, v118
v_mul_f32 v206, v206, v118
v_mul_f32 v207, v207, v118
v_fmac_f32 v204, v220, v119
v_fmac_f32 v205, v221, v119
v_mul_f32 v208, v208, v118
v_mul_f32 v209, v209, v118
v_mul_f32 v210, v210, v118
v_mul_f32 v211, v211, v118
v_fmac_f32 v206, v222, v119
v_fmac_f32 v207, v223, v119
v_cvt_pk_bf16_f32 v204, v204, v205
v_fmac_f32 v208, v224, v119
v_fmac_f32 v209, v225, v119
v_fmac_f32 v210, v226, v119
v_fmac_f32 v211, v227, v119
v_cvt_pk_bf16_f32 v205, v206, v207
v_cvt_pk_bf16_f32 v206, v208, v209
v_cvt_pk_bf16_f32 v207, v210, v211
buffer_store_dwordx4 v[204:207], v2, s[4:7], s72 offen offset:3072 sc1
s_add_u32 s92, s71, 0x10000
s_add_u32 s36, s66, 0x10080
s_add_u32 s40, s4, 0x2600000
s_addc_u32 s41, s5, 0
v_add_u32 v5, 32768, v1
v_add_u32 v6, 98304, v1
s_cmp_eq_u32 s3, 0
s_cselect_b32 s35, 8, 0
s_lshl_b32 s35, s35, 12
v_lshlrev_b32 v132, 16, v32
v_and_b32 v133, 0xffff0000, v32
v_lshlrev_b32 v134, 16, v33
v_and_b32 v135, 0xffff0000, v33
v_lshlrev_b32 v136, 16, v34
v_and_b32 v137, 0xffff0000, v34
v_lshlrev_b32 v138, 16, v35
v_and_b32 v139, 0xffff0000, v35
v_lshlrev_b32 v140, 16, v36
v_and_b32 v141, 0xffff0000, v36
v_lshlrev_b32 v142, 16, v37
v_and_b32 v143, 0xffff0000, v37
v_lshlrev_b32 v144, 16, v38
v_and_b32 v145, 0xffff0000, v38
v_lshlrev_b32 v146, 16, v39
v_and_b32 v147, 0xffff0000, v39
v_lshlrev_b32 v148, 16, v40
v_and_b32 v149, 0xffff0000, v40
v_lshlrev_b32 v150, 16, v41
v_and_b32 v151, 0xffff0000, v41
v_lshlrev_b32 v152, 16, v42
v_and_b32 v153, 0xffff0000, v42
v_lshlrev_b32 v154, 16, v43
v_and_b32 v155, 0xffff0000, v43
v_lshlrev_b32 v156, 16, v44
v_and_b32 v157, 0xffff0000, v44
v_lshlrev_b32 v158, 16, v45
v_and_b32 v159, 0xffff0000, v45
v_lshlrev_b32 v160, 16, v46
v_and_b32 v161, 0xffff0000, v46
v_lshlrev_b32 v162, 16, v47
v_and_b32 v163, 0xffff0000, v47
s_mov_b32 s95, -1
s_mov_b64 exec, 0
s_cmp_eq_u32 s28, 3
s_cbranch_scc1 L_stub9
s_cmp_eq_u32 s28, 2
s_cbranch_scc1 L_wret3
L_wret3:
s_mov_b64 exec, -1
s_cmp_lg_u32 s28, 0
s_cbranch_scc1 Lpe_21
s_add_u32 s36, s66, 0x10080
s_mov_b32 s37, 0
Lpoll_20:
v_mov_b32 v11, 0
buffer_atomic_add v11, v251, s[4:7], s36 offen sc0 sc1
s_add_u32 s37, s37, 1
s_waitcnt vmcnt(0)
v_readfirstlane_b32 s38, v11
s_nop 0
s_cmp_ge_u32 s38, 32
s_cbranch_scc1 Lpe_21
s_cmp_lt_u32 s37, 0x100000
s_cbranch_scc1 Lpoll_20
Lpe_21:
s_waitcnt vmcnt(0)
s_barrier
L_k2go1:
buffer_load_dwordx4 a[0:3], v4, s[40:43], s35 offen offset:0 sc1
buffer_load_dwordx4 a[4:7], v4, s[40:43], s35 offen offset:1024 sc1
s_cmp_eq_u32 s3, 1
s_cselect_b32 s35, 9, 1
s_lshl_b32 s35, s35, 12
buffer_load_dwordx4 a[8:11], v4, s[40:43], s35 offen offset:0 sc1
buffer_load_dwordx4 a[12:15], v4, s[40:43], s35 offen offset:1024 sc1
s_cmp_eq_u32 s3, 2
s_cselect_b32 s35, 10, 2
s_lshl_b32 s35, s35, 12
buffer_load_dwordx4 a[16:19], v4, s[40:43], s35 offen offset:0 sc1
buffer_load_dwordx4 a[20:23], v4, s[40:43], s35 offen offset:1024 sc1
s_cmp_eq_u32 s3, 3
s_cselect_b32 s35, 11, 3
s_lshl_b32 s35, s35, 12
buffer_load_dwordx4 a[24:27], v4, s[40:43], s35 offen offset:0 sc1
buffer_load_dwordx4 a[28:31], v4, s[40:43], s35 offen offset:1024 sc1
s_cmp_eq_u32 s3, 4
s_cselect_b32 s35, 12, 4
s_lshl_b32 s35, s35, 12
buffer_load_dwordx4 a[32:35], v4, s[40:43], s35 offen offset:0 sc1
buffer_load_dwordx4 a[36:39], v4, s[40:43], s35 offen offset:1024 sc1
s_cmp_eq_u32 s3, 5
s_cselect_b32 s35, 13, 5
s_lshl_b32 s35, s35, 12
ds_read_b128 a[96:99], v5 offset:0
ds_read_b128 a[100:103], v5 offset:1024
ds_read_b128 a[104:107], v5 offset:2048
ds_read_b128 a[108:111], v5 offset:3072
ds_read_b128 a[112:115], v5 offset:4096
ds_read_b128 a[116:119], v5 offset:5120
ds_read_b128 a[120:123], v5 offset:6144
ds_read_b128 a[124:127], v5 offset:7168
s_waitcnt vmcnt(8) lgkmcnt(4)
v_mfma_f32_16x16x32_bf16 v[132:135], a[96:99], a[0:3], v[132:135]
ds_read_b128 a[128:131], v5 offset:8192
v_mfma_f32_16x16x32_bf16 v[148:151], a[96:99], a[4:7], v[148:151]
ds_read_b128 a[132:135], v5 offset:9216
v_mfma_f32_16x16x32_bf16 v[152:155], a[100:103], a[4:7], v[152:155]
buffer_load_dwordx4 a[40:43], v4, s[40:43], s35 offen offset:0 sc1
v_mfma_f32_16x16x32_bf16 v[136:139], a[100:103], a[0:3], v[136:139]
ds_read_b128 a[136:139], v5 offset:10240
v_mfma_f32_16x16x32_bf16 v[140:143], a[104:107], a[0:3], v[140:143]
ds_read_b128 a[140:143], v5 offset:11264
v_mfma_f32_16x16x32_bf16 v[156:159], a[104:107], a[4:7], v[156:159]
v_mfma_f32_16x16x32_bf16 v[160:163], a[108:111], a[4:7], v[160:163]
buffer_load_dwordx4 a[44:47], v4, s[40:43], s35 offen offset:1024 sc1
v_mfma_f32_16x16x32_bf16 v[144:147], a[108:111], a[0:3], v[144:147]
s_waitcnt vmcnt(8) lgkmcnt(4)
v_mfma_f32_16x16x32_bf16 v[132:135], a[112:115], a[8:11], v[132:135]
s_cmp_eq_u32 s3, 6
s_cselect_b32 s35, 14, 6
s_lshl_b32 s35, s35, 12
v_mfma_f32_16x16x32_bf16 v[148:151], a[112:115], a[12:15], v[148:151]
ds_read_b128 a[96:99], v5 offset:12288
v_mfma_f32_16x16x32_bf16 v[152:155], a[116:119], a[12:15], v[152:155]
buffer_load_dwordx4 a[0:3], v4, s[40:43], s35 offen offset:0 sc1
v_mfma_f32_16x16x32_bf16 v[136:139], a[116:119], a[8:11], v[136:139]
ds_read_b128 a[100:103], v5 offset:13312
v_mfma_f32_16x16x32_bf16 v[140:143], a[120:123], a[8:11], v[140:143]
ds_read_b128 a[104:107], v5 offset:14336
v_mfma_f32_16x16x32_bf16 v[156:159], a[120:123], a[12:15], v[156:159]
ds_read_b128 a[108:111], v5 offset:15360
v_mfma_f32_16x16x32_bf16 v[160:163], a[124:127], a[12:15], v[160:163]
buffer_load_dwordx4 a[4:7], v4, s[40:43], s35 offen offset:1024 sc1
v_mfma_f32_16x16x32_bf16 v[144:147], a[124:127], a[8:11], v[144:147]
s_waitcnt vmcnt(8) lgkmcnt(4)
v_mfma_f32_16x16x32_bf16 v[132:135], a[128:131], a[16:19], v[132:135]
s_cmp_eq_u32 s3, 7
s_cselect_b32 s35, 15, 7
s_lshl_b32 s35, s35, 12
v_mfma_f32_16x16x32_bf16 v[148:151], a[128:131], a[20:23], v[148:151]
ds_read_b128 a[112:115], v5 offset:16384
v_mfma_f32_16x16x32_bf16 v[152:155], a[132:135], a[20:23], v[152:155]
buffer_load_dwordx4 a[8:11], v4, s[40:43], s35 offen offset:0 sc1
v_mfma_f32_16x16x32_bf16 v[136:139], a[132:135], a[16:19], v[136:139]
ds_read_b128 a[116:119], v5 offset:17408
v_mfma_f32_16x16x32_bf16 v[140:143], a[136:139], a[16:19], v[140:143]
ds_read_b128 a[120:123], v5 offset:18432
v_mfma_f32_16x16x32_bf16 v[156:159], a[136:139], a[20:23], v[156:159]
ds_read_b128 a[124:127], v5 offset:19456
v_mfma_f32_16x16x32_bf16 v[160:163], a[140:143], a[20:23], v[160:163]
buffer_load_dwordx4 a[12:15], v4, s[40:43], s35 offen offset:1024 sc1
v_mfma_f32_16x16x32_bf16 v[144:147], a[140:143], a[16:19], v[144:147]
s_waitcnt vmcnt(8) lgkmcnt(4)
v_mfma_f32_16x16x32_bf16 v[132:135], a[96:99], a[24:27], v[132:135]
s_cmp_eq_u32 s3, 0
s_cselect_b32 s35, 16, 8
s_lshl_b32 s35, s35, 12
v_mfma_f32_16x16x32_bf16 v[148:151], a[96:99], a[28:31], v[148:151]
ds_read_b128 a[128:131], v5 offset:20480
v_mfma_f32_16x16x32_bf16 v[152:155], a[100:103], a[28:31], v[152:155]
buffer_load_dwordx4 a[16:19], v4, s[40:43], s35 offen offset:0 sc1
v_mfma_f32_16x16x32_bf16 v[136:139], a[100:103], a[24:27], v[136:139]
ds_read_b128 a[132:135], v5 offset:21504
v_mfma_f32_16x16x32_bf16 v[140:143], a[104:107], a[24:27], v[140:143]
ds_read_b128 a[136:139], v5 offset:22528
v_mfma_f32_16x16x32_bf16 v[156:159], a[104:107], a[28:31], v[156:159]
ds_read_b128 a[140:143], v5 offset:23552
v_mfma_f32_16x16x32_bf16 v[160:163], a[108:111], a[28:31], v[160:163]
buffer_load_dwordx4 a[20:23], v4, s[40:43], s35 offen offset:1024 sc1
v_mfma_f32_16x16x32_bf16 v[144:147], a[108:111], a[24:27], v[144:147]
s_waitcnt vmcnt(8) lgkmcnt(4)
v_mfma_f32_16x16x32_bf16 v[132:135], a[112:115], a[32:35], v[132:135]
s_cmp_eq_u32 s3, 1
s_cselect_b32 s35, 17, 9
s_lshl_b32 s35, s35, 12
v_mfma_f32_16x16x32_bf16 v[148:151], a[112:115], a[36:39], v[148:151]
ds_read_b128 a[96:99], v5 offset:24576
v_mfma_f32_16x16x32_bf16 v[152:155], a[116:119], a[36:39], v[152:155]
buffer_load_dwordx4 a[24:27], v4, s[40:43], s35 offen offset:0 sc1
v_mfma_f32_16x16x32_bf16 v[136:139], a[116:119], a[32:35], v[136:139]
ds_read_b128 a[100:103], v5 offset:25600
v_mfma_f32_16x16x32_bf16 v[140:143], a[120:123], a[32:35], v[140:143]
ds_read_b128 a[104:107], v5 offset:26624
v_mfma_f32_16x16x32_bf16 v[156:159], a[120:123], a[36:39], v[156:159]
ds_read_b128 a[108:111], v5 offset:27648
v_mfma_f32_16x16x32_bf16 v[160:163], a[124:127], a[36:39], v[160:163]
buffer_load_dwordx4 a[28:31], v4, s[40:43], s35 offen offset:1024 sc1
v_mfma_f32_16x16x32_bf16 v[144:147], a[124:127], a[32:35], v[144:147]
s_waitcnt vmcnt(8) lgkmcnt(4)
v_mfma_f32_16x16x32_bf16 v[132:135], a[128:131], a[40:43], v[132:135]
s_cmp_eq_u32 s3, 2
s_cselect_b32 s35, 18, 10
s_lshl_b32 s35, s35, 12
v_mfma_f32_16x16x32_bf16 v[148:151], a[128:131], a[44:47], v[148:151]
ds_read_b128 a[112:115], v5 offset:28672
v_mfma_f32_16x16x32_bf16 v[152:155], a[132:135], a[44:47], v[152:155]
buffer_load_dwordx4 a[32:35], v4, s[40:43], s35 offen offset:0 sc1
v_mfma_f32_16x16x32_bf16 v[136:139], a[132:135], a[40:43], v[136:139]
ds_read_b128 a[116:119], v5 offset:29696
v_mfma_f32_16x16x32_bf16 v[140:143], a[136:139], a[40:43], v[140:143]
ds_read_b128 a[120:123], v5 offset:30720
v_mfma_f32_16x16x32_bf16 v[156:159], a[136:139], a[44:47], v[156:159]
ds_read_b128 a[124:127], v5 offset:31744
v_mfma_f32_16x16x32_bf16 v[160:163], a[140:143], a[44:47], v[160:163]
buffer_load_dwordx4 a[36:39], v4, s[40:43], s35 offen offset:1024 sc1
v_mfma_f32_16x16x32_bf16 v[144:147], a[140:143], a[40:43], v[144:147]
s_waitcnt vmcnt(8) lgkmcnt(4)
v_mfma_f32_16x16x32_bf16 v[132:135], a[96:99], a[0:3], v[132:135]
s_cmp_eq_u32 s3, 3
s_cselect_b32 s35, 19, 11
s_lshl_b32 s35, s35, 12
v_mfma_f32_16x16x32_bf16 v[148:151], a[96:99], a[4:7], v[148:151]
ds_read_b128 a[128:131], v5 offset:32768
v_mfma_f32_16x16x32_bf16 v[152:155], a[100:103], a[4:7], v[152:155]
buffer_load_dwordx4 a[40:43], v4, s[40:43], s35 offen offset:0 sc1
v_mfma_f32_16x16x32_bf16 v[136:139], a[100:103], a[0:3], v[136:139]
ds_read_b128 a[132:135], v5 offset:33792
v_mfma_f32_16x16x32_bf16 v[140:143], a[104:107], a[0:3], v[140:143]
ds_read_b128 a[136:139], v5 offset:34816
v_mfma_f32_16x16x32_bf16 v[156:159], a[104:107], a[4:7], v[156:159]
ds_read_b128 a[140:143], v5 offset:35840
v_mfma_f32_16x16x32_bf16 v[160:163], a[108:111], a[4:7], v[160:163]
buffer_load_dwordx4 a[44:47], v4, s[40:43], s35 offen offset:1024 sc1
v_mfma_f32_16x16x32_bf16 v[144:147], a[108:111], a[0:3], v[144:147]
s_waitcnt vmcnt(8) lgkmcnt(4)
v_mfma_f32_16x16x32_bf16 v[132:135], a[112:115], a[8:11], v[132:135]
s_cmp_eq_u32 s3, 4
s_cselect_b32 s35, 20, 12
s_lshl_b32 s35, s35, 12
v_mfma_f32_16x16x32_bf16 v[148:151], a[112:115], a[12:15], v[148:151]
ds_read_b128 a[96:99], v5 offset:36864
v_mfma_f32_16x16x32_bf16 v[152:155], a[116:119], a[12:15], v[152:155]
buffer_load_dwordx4 a[0:3], v4, s[40:43], s35 offen offset:0 sc1
v_mfma_f32_16x16x32_bf16 v[136:139], a[116:119], a[8:11], v[136:139]
ds_read_b128 a[100:103], v5 offset:37888
v_mfma_f32_16x16x32_bf16 v[140:143], a[120:123], a[8:11], v[140:143]
ds_read_b128 a[104:107], v5 offset:38912
v_mfma_f32_16x16x32_bf16 v[156:159], a[120:123], a[12:15], v[156:159]
ds_read_b128 a[108:111], v5 offset:39936
v_mfma_f32_16x16x32_bf16 v[160:163], a[124:127], a[12:15], v[160:163]
buffer_load_dwordx4 a[4:7], v4, s[40:43], s35 offen offset:1024 sc1
v_mfma_f32_16x16x32_bf16 v[144:147], a[124:127], a[8:11], v[144:147]
s_waitcnt vmcnt(8) lgkmcnt(4)
v_mfma_f32_16x16x32_bf16 v[132:135], a[128:131], a[16:19], v[132:135]
s_cmp_eq_u32 s3, 5
s_cselect_b32 s35, 21, 13
s_lshl_b32 s35, s35, 12
v_mfma_f32_16x16x32_bf16 v[148:151], a[128:131], a[20:23], v[148:151]
ds_read_b128 a[112:115], v5 offset:40960
v_mfma_f32_16x16x32_bf16 v[152:155], a[132:135], a[20:23], v[152:155]
buffer_load_dwordx4 a[8:11], v4, s[40:43], s35 offen offset:0 sc1
v_mfma_f32_16x16x32_bf16 v[136:139], a[132:135], a[16:19], v[136:139]
ds_read_b128 a[116:119], v5 offset:41984
v_mfma_f32_16x16x32_bf16 v[140:143], a[136:139], a[16:19], v[140:143]
ds_read_b128 a[120:123], v5 offset:43008
v_mfma_f32_16x16x32_bf16 v[156:159], a[136:139], a[20:23], v[156:159]
ds_read_b128 a[124:127], v5 offset:44032
v_mfma_f32_16x16x32_bf16 v[160:163], a[140:143], a[20:23], v[160:163]
buffer_load_dwordx4 a[12:15], v4, s[40:43], s35 offen offset:1024 sc1
v_mfma_f32_16x16x32_bf16 v[144:147], a[140:143], a[16:19], v[144:147]
s_waitcnt vmcnt(8) lgkmcnt(4)
v_mfma_f32_16x16x32_bf16 v[132:135], a[96:99], a[24:27], v[132:135]
s_cmp_eq_u32 s3, 6
s_cselect_b32 s35, 22, 14
s_lshl_b32 s35, s35, 12
v_mfma_f32_16x16x32_bf16 v[148:151], a[96:99], a[28:31], v[148:151]
ds_read_b128 a[128:131], v5 offset:45056
v_mfma_f32_16x16x32_bf16 v[152:155], a[100:103], a[28:31], v[152:155]
buffer_load_dwordx4 a[16:19], v4, s[40:43], s35 offen offset:0 sc1
v_mfma_f32_16x16x32_bf16 v[136:139], a[100:103], a[24:27], v[136:139]
ds_read_b128 a[132:135], v5 offset:46080
v_mfma_f32_16x16x32_bf16 v[140:143], a[104:107], a[24:27], v[140:143]
ds_read_b128 a[136:139], v5 offset:47104
v_mfma_f32_16x16x32_bf16 v[156:159], a[104:107], a[28:31], v[156:159]
ds_read_b128 a[140:143], v5 offset:48128
L_stub9:
s_cbranch_execz L_wret3
v_mfma_f32_16x16x32_bf16 v[160:163], a[108:111], a[28:31], v[160:163]
buffer_load_dwordx4 a[20:23], v4, s[40:43], s35 offen offset:1024 sc1
v_mfma_f32_16x16x32_bf16 v[144:147], a[108:111], a[24:27], v[144:147]
s_waitcnt vmcnt(8) lgkmcnt(4)
v_mfma_f32_16x16x32_bf16 v[132:135], a[112:115], a[32:35], v[132:135]
s_cmp_eq_u32 s3, 7
s_cselect_b32 s35, 23, 15
s_lshl_b32 s35, s35, 12
v_mfma_f32_16x16x32_bf16 v[148:151], a[112:115], a[36:39], v[148:151]
ds_read_b128 a[96:99], v5 offset:49152
v_mfma_f32_16x16x32_bf16 v[152:155], a[116:119], a[36:39], v[152:155]
buffer_load_dwordx4 a[24:27], v4, s[40:43], s35 offen offset:0 sc1
v_mfma_f32_16x16x32_bf16 v[136:139], a[116:119], a[32:35], v[136:139]
ds_read_b128 a[100:103], v5 offset:50176
v_mfma_f32_16x16x32_bf16 v[140:143], a[120:123], a[32:35], v[140:143]
ds_read_b128 a[104:107], v5 offset:51200
v_mfma_f32_16x16x32_bf16 v[156:159], a[120:123], a[36:39], v[156:159]
ds_read_b128 a[108:111], v5 offset:52224
v_mfma_f32_16x16x32_bf16 v[160:163], a[124:127], a[36:39], v[160:163]
buffer_load_dwordx4 a[28:31], v4, s[40:43], s35 offen offset:1024 sc1
v_mfma_f32_16x16x32_bf16 v[144:147], a[124:127], a[32:35], v[144:147]
s_waitcnt vmcnt(8) lgkmcnt(4)
v_mfma_f32_16x16x32_bf16 v[132:135], a[128:131], a[40:43], v[132:135]
s_cmp_eq_u32 s3, 0
s_cselect_b32 s35, 24, 16
s_lshl_b32 s35, s35, 12
v_mfma_f32_16x16x32_bf16 v[148:151], a[128:131], a[44:47], v[148:151]
ds_read_b128 a[112:115], v5 offset:53248
v_mfma_f32_16x16x32_bf16 v[152:155], a[132:135], a[44:47], v[152:155]
buffer_load_dwordx4 a[32:35], v4, s[40:43], s35 offen offset:0 sc1
v_mfma_f32_16x16x32_bf16 v[136:139], a[132:135], a[40:43], v[136:139]
ds_read_b128 a[116:119], v5 offset:54272
v_mfma_f32_16x16x32_bf16 v[140:143], a[136:139], a[40:43], v[140:143]
ds_read_b128 a[120:123], v5 offset:55296
v_mfma_f32_16x16x32_bf16 v[156:159], a[136:139], a[44:47], v[156:159]
ds_read_b128 a[124:127], v5 offset:56320
v_mfma_f32_16x16x32_bf16 v[160:163], a[140:143], a[44:47], v[160:163]
buffer_load_dwordx4 a[36:39], v4, s[40:43], s35 offen offset:1024 sc1
v_mfma_f32_16x16x32_bf16 v[144:147], a[140:143], a[40:43], v[144:147]
s_waitcnt vmcnt(8) lgkmcnt(4)
v_mfma_f32_16x16x32_bf16 v[132:135], a[96:99], a[0:3], v[132:135]
s_cmp_eq_u32 s3, 1
s_cselect_b32 s35, 25, 17
s_lshl_b32 s35, s35, 12
v_mfma_f32_16x16x32_bf16 v[148:151], a[96:99], a[4:7], v[148:151]
ds_read_b128 a[128:131], v5 offset:57344
v_mfma_f32_16x16x32_bf16 v[152:155], a[100:103], a[4:7], v[152:155]
buffer_load_dwordx4 a[40:43], v4, s[40:43], s35 offen offset:0 sc1
v_mfma_f32_16x16x32_bf16 v[136:139], a[100:103], a[0:3], v[136:139]
ds_read_b128 a[132:135], v5 offset:58368
v_mfma_f32_16x16x32_bf16 v[140:143], a[104:107], a[0:3], v[140:143]
ds_read_b128 a[136:139], v5 offset:59392
v_mfma_f32_16x16x32_bf16 v[156:159], a[104:107], a[4:7], v[156:159]
ds_read_b128 a[140:143], v5 offset:60416
v_mfma_f32_16x16x32_bf16 v[160:163], a[108:111], a[4:7], v[160:163]
buffer_load_dwordx4 a[44:47], v4, s[40:43], s35 offen offset:1024 sc1
v_mfma_f32_16x16x32_bf16 v[144:147], a[108:111], a[0:3], v[144:147]
s_waitcnt vmcnt(8) lgkmcnt(4)
v_mfma_f32_16x16x32_bf16 v[132:135], a[112:115], a[8:11], v[132:135]
s_cmp_eq_u32 s3, 2
s_cselect_b32 s35, 26, 18
s_lshl_b32 s35, s35, 12
v_mfma_f32_16x16x32_bf16 v[148:151], a[112:115], a[12:15], v[148:151]
ds_read_b128 a[96:99], v5 offset:61440
v_mfma_f32_16x16x32_bf16 v[152:155], a[116:119], a[12:15], v[152:155]
buffer_load_dwordx4 a[0:3], v4, s[40:43], s35 offen offset:0 sc1
v_mfma_f32_16x16x32_bf16 v[136:139], a[116:119], a[8:11], v[136:139]
ds_read_b128 a[100:103], v5 offset:62464
v_mfma_f32_16x16x32_bf16 v[140:143], a[120:123], a[8:11], v[140:143]
ds_read_b128 a[104:107], v5 offset:63488
v_mfma_f32_16x16x32_bf16 v[156:159], a[120:123], a[12:15], v[156:159]
ds_read_b128 a[108:111], v5 offset:64512
v_mfma_f32_16x16x32_bf16 v[160:163], a[124:127], a[12:15], v[160:163]
buffer_load_dwordx4 a[4:7], v4, s[40:43], s35 offen offset:1024 sc1
v_mfma_f32_16x16x32_bf16 v[144:147], a[124:127], a[8:11], v[144:147]
s_waitcnt vmcnt(8) lgkmcnt(4)
v_mfma_f32_16x16x32_bf16 v[132:135], a[128:131], a[16:19], v[132:135]
s_cmp_eq_u32 s3, 3
s_cselect_b32 s35, 27, 19
s_lshl_b32 s35, s35, 12
v_mfma_f32_16x16x32_bf16 v[148:151], a[128:131], a[20:23], v[148:151]
ds_read_b128 a[112:115], v6 offset:0
v_mfma_f32_16x16x32_bf16 v[152:155], a[132:135], a[20:23], v[152:155]
buffer_load_dwordx4 a[8:11], v4, s[40:43], s35 offen offset:0 sc1
v_mfma_f32_16x16x32_bf16 v[136:139], a[132:135], a[16:19], v[136:139]
ds_read_b128 a[116:119], v6 offset:1024
v_mfma_f32_16x16x32_bf16 v[140:143], a[136:139], a[16:19], v[140:143]
ds_read_b128 a[120:123], v6 offset:2048
v_mfma_f32_16x16x32_bf16 v[156:159], a[136:139], a[20:23], v[156:159]
ds_read_b128 a[124:127], v6 offset:3072
v_mfma_f32_16x16x32_bf16 v[160:163], a[140:143], a[20:23], v[160:163]
buffer_load_dwordx4 a[12:15], v4, s[40:43], s35 offen offset:1024 sc1
v_mfma_f32_16x16x32_bf16 v[144:147], a[140:143], a[16:19], v[144:147]
s_waitcnt vmcnt(8) lgkmcnt(4)
v_mfma_f32_16x16x32_bf16 v[132:135], a[96:99], a[24:27], v[132:135]
s_cmp_eq_u32 s3, 4
s_cselect_b32 s35, 28, 20
s_lshl_b32 s35, s35, 12
v_mfma_f32_16x16x32_bf16 v[148:151], a[96:99], a[28:31], v[148:151]
ds_read_b128 a[128:131], v6 offset:4096
v_mfma_f32_16x16x32_bf16 v[152:155], a[100:103], a[28:31], v[152:155]
buffer_load_dwordx4 a[16:19], v4, s[40:43], s35 offen offset:0 sc1
v_mfma_f32_16x16x32_bf16 v[136:139], a[100:103], a[24:27], v[136:139]
ds_read_b128 a[132:135], v6 offset:5120
v_mfma_f32_16x16x32_bf16 v[140:143], a[104:107], a[24:27], v[140:143]
ds_read_b128 a[136:139], v6 offset:6144
v_mfma_f32_16x16x32_bf16 v[156:159], a[104:107], a[28:31], v[156:159]
ds_read_b128 a[140:143], v6 offset:7168
v_mfma_f32_16x16x32_bf16 v[160:163], a[108:111], a[28:31], v[160:163]
buffer_load_dwordx4 a[20:23], v4, s[40:43], s35 offen offset:1024 sc1
v_mfma_f32_16x16x32_bf16 v[144:147], a[108:111], a[24:27], v[144:147]
s_waitcnt vmcnt(8) lgkmcnt(4)
v_mfma_f32_16x16x32_bf16 v[132:135], a[112:115], a[32:35], v[132:135]
s_cmp_eq_u32 s3, 5
s_cselect_b32 s35, 29, 21
s_lshl_b32 s35, s35, 12
v_mfma_f32_16x16x32_bf16 v[148:151], a[112:115], a[36:39], v[148:151]
ds_read_b128 a[96:99], v6 offset:8192
v_mfma_f32_16x16x32_bf16 v[152:155], a[116:119], a[36:39], v[152:155]
buffer_load_dwordx4 a[24:27], v4, s[40:43], s35 offen offset:0 sc1
v_mfma_f32_16x16x32_bf16 v[136:139], a[116:119], a[32:35], v[136:139]
ds_read_b128 a[100:103], v6 offset:9216
v_mfma_f32_16x16x32_bf16 v[140:143], a[120:123], a[32:35], v[140:143]
ds_read_b128 a[104:107], v6 offset:10240
v_mfma_f32_16x16x32_bf16 v[156:159], a[120:123], a[36:39], v[156:159]
ds_read_b128 a[108:111], v6 offset:11264
v_mfma_f32_16x16x32_bf16 v[160:163], a[124:127], a[36:39], v[160:163]
buffer_load_dwordx4 a[28:31], v4, s[40:43], s35 offen offset:1024 sc1
v_mfma_f32_16x16x32_bf16 v[144:147], a[124:127], a[32:35], v[144:147]
s_waitcnt vmcnt(8) lgkmcnt(4)
v_mfma_f32_16x16x32_bf16 v[132:135], a[128:131], a[40:43], v[132:135]
s_cmp_eq_u32 s3, 6
s_cselect_b32 s35, 30, 22
s_lshl_b32 s35, s35, 12
v_mfma_f32_16x16x32_bf16 v[148:151], a[128:131], a[44:47], v[148:151]
ds_read_b128 a[112:115], v6 offset:12288
v_mfma_f32_16x16x32_bf16 v[152:155], a[132:135], a[44:47], v[152:155]
buffer_load_dwordx4 a[32:35], v4, s[40:43], s35 offen offset:0 sc1
v_mfma_f32_16x16x32_bf16 v[136:139], a[132:135], a[40:43], v[136:139]
ds_read_b128 a[116:119], v6 offset:13312
v_mfma_f32_16x16x32_bf16 v[140:143], a[136:139], a[40:43], v[140:143]
ds_read_b128 a[120:123], v6 offset:14336
v_mfma_f32_16x16x32_bf16 v[156:159], a[136:139], a[44:47], v[156:159]
ds_read_b128 a[124:127], v6 offset:15360
v_mfma_f32_16x16x32_bf16 v[160:163], a[140:143], a[44:47], v[160:163]
buffer_load_dwordx4 a[36:39], v4, s[40:43], s35 offen offset:1024 sc1
v_mfma_f32_16x16x32_bf16 v[144:147], a[140:143], a[40:43], v[144:147]
s_waitcnt vmcnt(8) lgkmcnt(4)
v_mfma_f32_16x16x32_bf16 v[132:135], a[96:99], a[0:3], v[132:135]
s_cmp_eq_u32 s3, 7
s_cselect_b32 s35, 31, 23
s_lshl_b32 s35, s35, 12
v_mfma_f32_16x16x32_bf16 v[148:151], a[96:99], a[4:7], v[148:151]
ds_read_b128 a[128:131], v6 offset:16384
v_mfma_f32_16x16x32_bf16 v[152:155], a[100:103], a[4:7], v[152:155]
buffer_load_dwordx4 a[40:43], v4, s[40:43], s35 offen offset:0 sc1
v_mfma_f32_16x16x32_bf16 v[136:139], a[100:103], a[0:3], v[136:139]
ds_read_b128 a[132:135], v6 offset:17408
v_mfma_f32_16x16x32_bf16 v[140:143], a[104:107], a[0:3], v[140:143]
ds_read_b128 a[136:139], v6 offset:18432
v_mfma_f32_16x16x32_bf16 v[156:159], a[104:107], a[4:7], v[156:159]
ds_read_b128 a[140:143], v6 offset:19456
v_mfma_f32_16x16x32_bf16 v[160:163], a[108:111], a[4:7], v[160:163]
buffer_load_dwordx4 a[44:47], v4, s[40:43], s35 offen offset:1024 sc1
v_mfma_f32_16x16x32_bf16 v[144:147], a[108:111], a[0:3], v[144:147]
s_waitcnt vmcnt(8) lgkmcnt(4)
v_mfma_f32_16x16x32_bf16 v[132:135], a[112:115], a[8:11], v[132:135]
s_cmp_eq_u32 s3, 0
s_cselect_b32 s35, 0, 24
s_lshl_b32 s35, s35, 12
v_mfma_f32_16x16x32_bf16 v[148:151], a[112:115], a[12:15], v[148:151]
ds_read_b128 a[96:99], v6 offset:20480
v_mfma_f32_16x16x32_bf16 v[152:155], a[116:119], a[12:15], v[152:155]
buffer_load_dwordx4 a[0:3], v4, s[40:43], s35 offen offset:0 sc1
v_mfma_f32_16x16x32_bf16 v[136:139], a[116:119], a[8:11], v[136:139]
ds_read_b128 a[100:103], v6 offset:21504
v_mfma_f32_16x16x32_bf16 v[140:143], a[120:123], a[8:11], v[140:143]
ds_read_b128 a[104:107], v6 offset:22528
v_mfma_f32_16x16x32_bf16 v[156:159], a[120:123], a[12:15], v[156:159]
ds_read_b128 a[108:111], v6 offset:23552
v_mfma_f32_16x16x32_bf16 v[160:163], a[124:127], a[12:15], v[160:163]
buffer_load_dwordx4 a[4:7], v4, s[40:43], s35 offen offset:1024 sc1
v_mfma_f32_16x16x32_bf16 v[144:147], a[124:127], a[8:11], v[144:147]
s_waitcnt vmcnt(8) lgkmcnt(4)
v_mfma_f32_16x16x32_bf16 v[132:135], a[128:131], a[16:19], v[132:135]
s_cmp_eq_u32 s3, 1
s_cselect_b32 s35, 1, 25
s_lshl_b32 s35, s35, 12
v_mfma_f32_16x16x32_bf16 v[148:151], a[128:131], a[20:23], v[148:151]
ds_read_b128 a[112:115], v6 offset:24576
v_mfma_f32_16x16x32_bf16 v[152:155], a[132:135], a[20:23], v[152:155]
buffer_load_dwordx4 a[8:11], v4, s[40:43], s35 offen offset:0 sc1
v_mfma_f32_16x16x32_bf16 v[136:139], a[132:135], a[16:19], v[136:139]
ds_read_b128 a[116:119], v6 offset:25600
v_mfma_f32_16x16x32_bf16 v[140:143], a[136:139], a[16:19], v[140:143]
ds_read_b128 a[120:123], v6 offset:26624
v_mfma_f32_16x16x32_bf16 v[156:159], a[136:139], a[20:23], v[156:159]
ds_read_b128 a[124:127], v6 offset:27648
v_mfma_f32_16x16x32_bf16 v[160:163], a[140:143], a[20:23], v[160:163]
buffer_load_dwordx4 a[12:15], v4, s[40:43], s35 offen offset:1024 sc1
v_mfma_f32_16x16x32_bf16 v[144:147], a[140:143], a[16:19], v[144:147]
s_waitcnt vmcnt(8) lgkmcnt(4)
v_mfma_f32_16x16x32_bf16 v[132:135], a[96:99], a[24:27], v[132:135]
s_cmp_eq_u32 s3, 2
s_cselect_b32 s35, 2, 26
s_lshl_b32 s35, s35, 12
v_mfma_f32_16x16x32_bf16 v[148:151], a[96:99], a[28:31], v[148:151]
ds_read_b128 a[128:131], v6 offset:28672
v_mfma_f32_16x16x32_bf16 v[152:155], a[100:103], a[28:31], v[152:155]
buffer_load_dwordx4 a[16:19], v4, s[40:43], s35 offen offset:0 sc1
v_mfma_f32_16x16x32_bf16 v[136:139], a[100:103], a[24:27], v[136:139]
ds_read_b128 a[132:135], v6 offset:29696
v_mfma_f32_16x16x32_bf16 v[140:143], a[104:107], a[24:27], v[140:143]
ds_read_b128 a[136:139], v6 offset:30720
v_mfma_f32_16x16x32_bf16 v[156:159], a[104:107], a[28:31], v[156:159]
ds_read_b128 a[140:143], v6 offset:31744
v_mfma_f32_16x16x32_bf16 v[160:163], a[108:111], a[28:31], v[160:163]
buffer_load_dwordx4 a[20:23], v4, s[40:43], s35 offen offset:1024 sc1
v_mfma_f32_16x16x32_bf16 v[144:147], a[108:111], a[24:27], v[144:147]
s_waitcnt vmcnt(8) lgkmcnt(4)
v_mfma_f32_16x16x32_bf16 v[132:135], a[112:115], a[32:35], v[132:135]
s_cmp_eq_u32 s3, 3
s_cselect_b32 s35, 3, 27
s_lshl_b32 s35, s35, 12
v_mfma_f32_16x16x32_bf16 v[148:151], a[112:115], a[36:39], v[148:151]
ds_read_b128 a[96:99], v6 offset:32768
v_mfma_f32_16x16x32_bf16 v[152:155], a[116:119], a[36:39], v[152:155]
buffer_load_dwordx4 a[24:27], v4, s[40:43], s35 offen offset:0 sc1
v_mfma_f32_16x16x32_bf16 v[136:139], a[116:119], a[32:35], v[136:139]
ds_read_b128 a[100:103], v6 offset:33792
v_mfma_f32_16x16x32_bf16 v[140:143], a[120:123], a[32:35], v[140:143]
ds_read_b128 a[104:107], v6 offset:34816
v_mfma_f32_16x16x32_bf16 v[156:159], a[120:123], a[36:39], v[156:159]
ds_read_b128 a[108:111], v6 offset:35840
v_mfma_f32_16x16x32_bf16 v[160:163], a[124:127], a[36:39], v[160:163]
buffer_load_dwordx4 a[28:31], v4, s[40:43], s35 offen offset:1024 sc1
v_mfma_f32_16x16x32_bf16 v[144:147], a[124:127], a[32:35], v[144:147]
s_waitcnt vmcnt(8) lgkmcnt(4)
v_mfma_f32_16x16x32_bf16 v[132:135], a[128:131], a[40:43], v[132:135]
s_cmp_eq_u32 s3, 4
s_cselect_b32 s35, 4, 28
s_lshl_b32 s35, s35, 12
v_mfma_f32_16x16x32_bf16 v[148:151], a[128:131], a[44:47], v[148:151]
ds_read_b128 a[112:115], v6 offset:36864
v_mfma_f32_16x16x32_bf16 v[152:155], a[132:135], a[44:47], v[152:155]
buffer_load_dwordx4 a[32:35], v4, s[40:43], s35 offen offset:0 sc1
v_mfma_f32_16x16x32_bf16 v[136:139], a[132:135], a[40:43], v[136:139]
ds_read_b128 a[116:119], v6 offset:37888
v_mfma_f32_16x16x32_bf16 v[140:143], a[136:139], a[40:43], v[140:143]
ds_read_b128 a[120:123], v6 offset:38912
v_mfma_f32_16x16x32_bf16 v[156:159], a[136:139], a[44:47], v[156:159]
ds_read_b128 a[124:127], v6 offset:39936
v_mfma_f32_16x16x32_bf16 v[160:163], a[140:143], a[44:47], v[160:163]
buffer_load_dwordx4 a[36:39], v4, s[40:43], s35 offen offset:1024 sc1
v_mfma_f32_16x16x32_bf16 v[144:147], a[140:143], a[40:43], v[144:147]
s_waitcnt vmcnt(8) lgkmcnt(4)
v_mfma_f32_16x16x32_bf16 v[132:135], a[96:99], a[0:3], v[132:135]
s_cmp_eq_u32 s3, 5
s_cselect_b32 s35, 5, 29
s_lshl_b32 s35, s35, 12
v_mfma_f32_16x16x32_bf16 v[148:151], a[96:99], a[4:7], v[148:151]
ds_read_b128 a[128:131], v6 offset:40960
v_mfma_f32_16x16x32_bf16 v[152:155], a[100:103], a[4:7], v[152:155]
buffer_load_dwordx4 a[40:43], v4, s[40:43], s35 offen offset:0 sc1
v_mfma_f32_16x16x32_bf16 v[136:139], a[100:103], a[0:3], v[136:139]
ds_read_b128 a[132:135], v6 offset:41984
v_mfma_f32_16x16x32_bf16 v[140:143], a[104:107], a[0:3], v[140:143]
ds_read_b128 a[136:139], v6 offset:43008
v_mfma_f32_16x16x32_bf16 v[156:159], a[104:107], a[4:7], v[156:159]
ds_read_b128 a[140:143], v6 offset:44032
v_mfma_f32_16x16x32_bf16 v[160:163], a[108:111], a[4:7], v[160:163]
buffer_load_dwordx4 a[44:47], v4, s[40:43], s35 offen offset:1024 sc1
v_mfma_f32_16x16x32_bf16 v[144:147], a[108:111], a[0:3], v[144:147]
s_waitcnt vmcnt(8) lgkmcnt(4)
v_mfma_f32_16x16x32_bf16 v[132:135], a[112:115], a[8:11], v[132:135]
s_cmp_eq_u32 s3, 6
s_cselect_b32 s35, 6, 30
s_lshl_b32 s35, s35, 12
v_mfma_f32_16x16x32_bf16 v[148:151], a[112:115], a[12:15], v[148:151]
ds_read_b128 a[96:99], v6 offset:45056
v_mfma_f32_16x16x32_bf16 v[152:155], a[116:119], a[12:15], v[152:155]
buffer_load_dwordx4 a[0:3], v4, s[40:43], s35 offen offset:0 sc1
v_mfma_f32_16x16x32_bf16 v[136:139], a[116:119], a[8:11], v[136:139]
ds_read_b128 a[100:103], v6 offset:46080
v_mfma_f32_16x16x32_bf16 v[140:143], a[120:123], a[8:11], v[140:143]
ds_read_b128 a[104:107], v6 offset:47104
v_mfma_f32_16x16x32_bf16 v[156:159], a[120:123], a[12:15], v[156:159]
ds_read_b128 a[108:111], v6 offset:48128
v_mfma_f32_16x16x32_bf16 v[160:163], a[124:127], a[12:15], v[160:163]
buffer_load_dwordx4 a[4:7], v4, s[40:43], s35 offen offset:1024 sc1
v_mfma_f32_16x16x32_bf16 v[144:147], a[124:127], a[8:11], v[144:147]
s_waitcnt vmcnt(8) lgkmcnt(4)
v_mfma_f32_16x16x32_bf16 v[132:135], a[128:131], a[16:19], v[132:135]
s_cmp_eq_u32 s3, 7
s_cselect_b32 s35, 7, 31
s_lshl_b32 s35, s35, 12
v_mfma_f32_16x16x32_bf16 v[148:151], a[128:131], a[20:23], v[148:151]
ds_read_b128 a[112:115], v6 offset:49152
v_mfma_f32_16x16x32_bf16 v[152:155], a[132:135], a[20:23], v[152:155]
buffer_load_dwordx4 a[8:11], v4, s[40:43], s35 offen offset:0 sc1
v_mfma_f32_16x16x32_bf16 v[136:139], a[132:135], a[16:19], v[136:139]
ds_read_b128 a[116:119], v6 offset:50176
v_mfma_f32_16x16x32_bf16 v[140:143], a[136:139], a[16:19], v[140:143]
ds_read_b128 a[120:123], v6 offset:51200
v_mfma_f32_16x16x32_bf16 v[156:159], a[136:139], a[20:23], v[156:159]
ds_read_b128 a[124:127], v6 offset:52224
v_mfma_f32_16x16x32_bf16 v[160:163], a[140:143], a[20:23], v[160:163]
buffer_load_dwordx4 a[12:15], v4, s[40:43], s35 offen offset:1024 sc1
v_mfma_f32_16x16x32_bf16 v[144:147], a[140:143], a[16:19], v[144:147]
s_waitcnt vmcnt(8) lgkmcnt(4)
v_mfma_f32_16x16x32_bf16 v[132:135], a[96:99], a[24:27], v[132:135]
ds_read_b128 a[128:131], v6 offset:53248
v_mfma_f32_16x16x32_bf16 v[148:151], a[96:99], a[28:31], v[148:151]
ds_read_b128 a[132:135], v6 offset:54272
v_mfma_f32_16x16x32_bf16 v[152:155], a[100:103], a[28:31], v[152:155]
ds_read_b128 a[136:139], v6 offset:55296
v_mfma_f32_16x16x32_bf16 v[136:139], a[100:103], a[24:27], v[136:139]
ds_read_b128 a[140:143], v6 offset:56320
v_mfma_f32_16x16x32_bf16 v[140:143], a[104:107], a[24:27], v[140:143]
v_mfma_f32_16x16x32_bf16 v[156:159], a[104:107], a[28:31], v[156:159]
buffer_atomic_add v12, v10, s[4:7], s92 offen sc1
v_mfma_f32_16x16x32_bf16 v[160:163], a[108:111], a[28:31], v[160:163]
v_mfma_f32_16x16x32_bf16 v[144:147], a[108:111], a[24:27], v[144:147]
s_waitcnt vmcnt(7) lgkmcnt(4)
v_mfma_f32_16x16x32_bf16 v[132:135], a[112:115], a[32:35], v[132:135]
ds_read_b128 a[96:99], v6 offset:57344
v_mfma_f32_16x16x32_bf16 v[148:151], a[112:115], a[36:39], v[148:151]
ds_read_b128 a[100:103], v6 offset:58368
v_mfma_f32_16x16x32_bf16 v[152:155], a[116:119], a[36:39], v[152:155]
ds_read_b128 a[104:107], v6 offset:59392
v_mfma_f32_16x16x32_bf16 v[136:139], a[116:119], a[32:35], v[136:139]
ds_read_b128 a[108:111], v6 offset:60416
v_mfma_f32_16x16x32_bf16 v[140:143], a[120:123], a[32:35], v[140:143]
v_mfma_f32_16x16x32_bf16 v[156:159], a[120:123], a[36:39], v[156:159]
v_mfma_f32_16x16x32_bf16 v[160:163], a[124:127], a[36:39], v[160:163]
v_mfma_f32_16x16x32_bf16 v[144:147], a[124:127], a[32:35], v[144:147]
s_waitcnt vmcnt(5) lgkmcnt(4)
v_mfma_f32_16x16x32_bf16 v[132:135], a[128:131], a[40:43], v[132:135]
ds_read_b128 a[112:115], v6 offset:61440
v_mfma_f32_16x16x32_bf16 v[148:151], a[128:131], a[44:47], v[148:151]
ds_read_b128 a[116:119], v6 offset:62464
v_mfma_f32_16x16x32_bf16 v[152:155], a[132:135], a[44:47], v[152:155]
ds_read_b128 a[120:123], v6 offset:63488
v_mfma_f32_16x16x32_bf16 v[136:139], a[132:135], a[40:43], v[136:139]
ds_read_b128 a[124:127], v6 offset:64512
v_mfma_f32_16x16x32_bf16 v[140:143], a[136:139], a[40:43], v[140:143]
v_mfma_f32_16x16x32_bf16 v[156:159], a[136:139], a[44:47], v[156:159]
v_mfma_f32_16x16x32_bf16 v[160:163], a[140:143], a[44:47], v[160:163]
v_mfma_f32_16x16x32_bf16 v[144:147], a[140:143], a[40:43], v[144:147]
s_waitcnt vmcnt(3) lgkmcnt(4)
v_mfma_f32_16x16x32_bf16 v[132:135], a[96:99], a[0:3], v[132:135]
v_mfma_f32_16x16x32_bf16 v[148:151], a[96:99], a[4:7], v[148:151]
v_mfma_f32_16x16x32_bf16 v[152:155], a[100:103], a[4:7], v[152:155]
v_mfma_f32_16x16x32_bf16 v[136:139], a[100:103], a[0:3], v[136:139]
v_mfma_f32_16x16x32_bf16 v[140:143], a[104:107], a[0:3], v[140:143]
v_mfma_f32_16x16x32_bf16 v[156:159], a[104:107], a[4:7], v[156:159]
v_mfma_f32_16x16x32_bf16 v[160:163], a[108:111], a[4:7], v[160:163]
v_mfma_f32_16x16x32_bf16 v[144:147], a[108:111], a[0:3], v[144:147]
s_waitcnt vmcnt(1) lgkmcnt(0)
v_mfma_f32_16x16x32_bf16 v[132:135], a[112:115], a[8:11], v[132:135]
v_mfma_f32_16x16x32_bf16 v[148:151], a[112:115], a[12:15], v[148:151]
v_mfma_f32_16x16x32_bf16 v[152:155], a[116:119], a[12:15], v[152:155]
v_mfma_f32_16x16x32_bf16 v[136:139], a[116:119], a[8:11], v[136:139]
v_mfma_f32_16x16x32_bf16 v[140:143], a[120:123], a[8:11], v[140:143]
v_mfma_f32_16x16x32_bf16 v[156:159], a[120:123], a[12:15], v[156:159]
v_mfma_f32_16x16x32_bf16 v[160:163], a[124:127], a[12:15], v[160:163]
v_mfma_f32_16x16x32_bf16 v[144:147], a[124:127], a[8:11], v[144:147]
s_nop 1
v_cmp_u_f32 vcc, v132, v148
s_nop 0
s_and_b32 vcc_lo, vcc_lo, s95
s_cbranch_scc1 L_k2redo1
s_lshl_b32 s36, s32, 13
v_cvt_pk_bf16_f32 v32, v132, v133
v_cvt_pk_bf16_f32 v33, v134, v135
v_cvt_pk_bf16_f32 v34, v136, v137
v_cvt_pk_bf16_f32 v35, v138, v139
s_add_u32 s36, s36, 0x0
buffer_store_dwordx4 v[32:35], v4, s[12:15], s36 offen offset:0 sc1
v_cvt_pk_bf16_f32 v40, v148, v149
v_cvt_pk_bf16_f32 v41, v150, v151
v_cvt_pk_bf16_f32 v42, v152, v153
v_cvt_pk_bf16_f32 v43, v154, v155
v_cvt_pk_bf16_f32 v36, v140, v141
v_cvt_pk_bf16_f32 v37, v142, v143
v_cvt_pk_bf16_f32 v38, v144, v145
v_cvt_pk_bf16_f32 v39, v146, v147
s_add_u32 s37, s36, 4096
v_cvt_pk_bf16_f32 v44, v156, v157
v_cvt_pk_bf16_f32 v45, v158, v159
v_cvt_pk_bf16_f32 v46, v160, v161
buffer_store_dwordx4 v[40:43], v4, s[12:15], s36 offen offset:1024 sc1
v_cvt_pk_bf16_f32 v47, v162, v163
v_mfma_f32_16x16x32_bf16 v[96:99], v[32:35], v[32:35], 0
s_mov_b32 s38, 0x280000
s_add_u32 s92, s78, 0x50000
v_mfma_f32_16x16x32_bf16 v[92:95], v[16:19], v[32:35], 0
s_add_u32 s93, s79, 0x50000
s_mov_b64 s[40:41], s[12:13]
v_mfma_f32_16x16x32_bf16 v[96:99], v[36:39], v[36:39], v[96:99]
buffer_store_dwordx4 v[36:39], v4, s[12:15], s37 offen offset:0 sc1
v_mfma_f32_16x16x32_bf16 v[92:95], v[16:19], v[36:39], v[92:95]
s_nop 5
v_cndmask_b32 v96, v96, v97, s[46:47]
v_cndmask_b32 v98, v98, v99, s[46:47]
v_mfma_f32_16x16x32_bf16 v[104:107], v[40:43], v[40:43], 0
v_mfma_f32_16x16x32_bf16 v[100:103], v[16:19], v[40:43], 0
v_cndmask_b32 v93, v96, v98, s[48:49]
buffer_store_dwordx4 v[44:47], v4, s[12:15], s37 offen offset:1024 sc1
v_mfma_f32_16x16x32_bf16 v[104:107], v[44:47], v[44:47], v[104:107]
v_mfma_f32_16x16x32_bf16 v[100:103], v[16:19], v[44:47], v[100:103]
s_nop 6
v_cndmask_b32 v104, v104, v105, s[46:47]
v_cndmask_b32 v106, v106, v107, s[46:47]
buffer_store_dwordx2 v[92:93], v253, s[4:7], s38 offen offset:0 sc1
v_cndmask_b32 v101, v104, v106, s[48:49]
buffer_store_dwordx2 v[100:101], v253, s[4:7], s38 offen offset:2048 sc1
s_barrier
s_add_u32 m0, s18, 0x0
s_add_u32 s44, s50, 0xe00000
buffer_load_dwordx4 v1, s[4:7], s44 offen offset:0 sc1 lds
buffer_load_dwordx4 v1, s[4:7], s44 offen offset:1024 sc1 lds
buffer_load_dwordx4 v1, s[4:7], s44 offen offset:2048 sc1 lds
s_add_u32 m0, s18, 0x3000
s_add_u32 s44, s50, 0xe03000
buffer_load_dwordx4 v1, s[4:7], s44 offen offset:0 sc1 lds
buffer_load_dwordx4 v1, s[4:7], s44 offen offset:1024 sc1 lds
buffer_load_dwordx4 v1, s[4:7], s44 offen offset:2048 sc1 lds
v_accvgpr_read_b32 v48, a188
v_accvgpr_read_b32 v49, a189
v_accvgpr_read_b32 v50, a190
v_accvgpr_read_b32 v51, a191
v_accvgpr_read_b32 v52, a192
v_accvgpr_read_b32 v53, a193
v_accvgpr_read_b32 v54, a194
v_accvgpr_read_b32 v55, a195
v_accvgpr_read_b32 v56, a196
v_accvgpr_read_b32 v57, a197
v_accvgpr_read_b32 v58, a198
v_accvgpr_read_b32 v59, a199
v_accvgpr_read_b32 v60, a200
v_accvgpr_read_b32 v61, a201
v_accvgpr_read_b32 v62, a202
v_accvgpr_read_b32 v63, a203
v_accvgpr_read_b32 v64, a204
v_accvgpr_read_b32 v65, a205
v_accvgpr_read_b32 v66, a206
v_accvgpr_read_b32 v67, a207
v_accvgpr_read_b32 v68, a208
v_accvgpr_read_b32 v69, a209
v_accvgpr_read_b32 v70, a210
v_accvgpr_read_b32 v71, a211
v_accvgpr_read_b32 v72, a212
v_accvgpr_read_b32 v73, a213
v_accvgpr_read_b32 v74, a214
v_accvgpr_read_b32 v75, a215
s_waitcnt vmcnt(6)
s_barrier
s_cmp_lg_u32 s28, 1
s_cbranch_scc1 Lsg_22
buffer_atomic_add v12, v10, s[4:7], s92 offen sc1
buffer_atomic_add v12, v10, s[4:7], s93 offen sc1
Lsg_22:
s_mov_b64 exec, 0
s_cmp_eq_u32 s28, 1
s_cbranch_scc1 L_stub10
L_wret4:
s_mov_b64 exec, -1
s_cmp_lt_u32 s28, 2
s_cbranch_scc1 Lwd_23
s_add_u32 m0, s18, 0x4800
s_add_u32 s44, s50, 0xe04800
buffer_load_dwordx4 v1, s[4:7], s44 offen offset:0 sc1 lds
buffer_load_dwordx4 v1, s[4:7], s44 offen offset:1024 sc1 lds
buffer_load_dwordx4 v1, s[4:7], s44 offen offset:2048 sc1 lds
s_add_u32 m0, s18, 0x6000
s_add_u32 s44, s50, 0xe06000
buffer_load_dwordx4 v1, s[4:7], s44 offen offset:0 sc1 lds
buffer_load_dwordx4 v1, s[4:7], s44 offen offset:1024 sc1 lds
buffer_load_dwordx4 v1, s[4:7], s44 offen offset:2048 sc1 lds
s_add_u32 m0, s18, 0x7800
s_add_u32 s44, s50, 0xe07800
buffer_load_dwordx4 v1, s[4:7], s44 offen offset:0 sc1 lds
buffer_load_dwordx4 v1, s[4:7], s44 offen offset:1024 sc1 lds
buffer_load_dwordx4 v1, s[4:7], s44 offen offset:2048 sc1 lds
s_add_u32 m0, s18, 0x9000
s_add_u32 s44, s50, 0xe09000
buffer_load_dwordx4 v1, s[4:7], s44 offen offset:0 sc1 lds
buffer_load_dwordx4 v1, s[4:7], s44 offen offset:1024 sc1 lds
buffer_load_dwordx4 v1, s[4:7], s44 offen offset:2048 sc1 lds
s_add_u32 m0, s18, 0xa800
s_add_u32 s44, s50, 0xe0a800
buffer_load_dwordx4 v1, s[4:7], s44 offen offset:0 sc1 lds
buffer_load_dwordx4 v1, s[4:7], s44 offen offset:1024 sc1 lds
buffer_load_dwordx4 v1, s[4:7], s44 offen offset:2048 sc1 lds
s_add_u32 m0, s18, 0xc000
s_add_u32 s44, s50, 0xe0c000
buffer_load_dwordx4 v1, s[4:7], s44 offen offset:0 sc1 lds
buffer_load_dwordx4 v1, s[4:7], s44 offen offset:1024 sc1 lds
buffer_load_dwordx4 v1, s[4:7], s44 offen offset:2048 sc1 lds
s_add_u32 m0, s18, 0xd800
s_add_u32 s44, s50, 0xe0d800
buffer_load_dwordx4 v1, s[4:7], s44 offen offset:0 sc1 lds
buffer_load_dwordx4 v1, s[4:7], s44 offen offset:1024 sc1 lds
buffer_load_dwordx4 v1, s[4:7], s44 offen offset:2048 sc1 lds
s_add_u32 m0, s18, 0xf000
s_add_u32 s44, s50, 0xe0f000
buffer_load_dwordx4 v1, s[4:7], s44 offen offset:0 sc1 lds
buffer_load_dwordx4 v1, s[4:7], s44 offen offset:1024 sc1 lds
buffer_load_dwordx4 v1, s[4:7], s44 offen offset:2048 sc1 lds
s_add_u32 m0, s18, 0x10800
s_add_u32 s44, s50, 0xe10800
buffer_load_dwordx4 v1, s[4:7], s44 offen offset:0 sc1 lds
buffer_load_dwordx4 v1, s[4:7], s44 offen offset:1024 sc1 lds
buffer_load_dwordx4 v1, s[4:7], s44 offen offset:2048 sc1 lds
s_add_u32 m0, s18, 0x12000
s_add_u32 s44, s50, 0xe12000
buffer_load_dwordx4 v1, s[4:7], s44 offen offset:0 sc1 lds
buffer_load_dwordx4 v1, s[4:7], s44 offen offset:1024 sc1 lds
buffer_load_dwordx4 v1, s[4:7], s44 offen offset:2048 sc1 lds
s_add_u32 m0, s18, 0x13800
s_add_u32 s44, s50, 0xe13800
buffer_load_dwordx4 v1, s[4:7], s44 offen offset:0 sc1 lds
buffer_load_dwordx4 v1, s[4:7], s44 offen offset:1024 sc1 lds
buffer_load_dwordx4 v1, s[4:7], s44 offen offset:2048 sc1 lds
s_add_u32 m0, s18, 0x15000
s_add_u32 s44, s50, 0xe15000
buffer_load_dwordx4 v1, s[4:7], s44 offen offset:0 sc1 lds
buffer_load_dwordx4 v1, s[4:7], s44 offen offset:1024 sc1 lds
buffer_load_dwordx4 v1, s[4:7], s44 offen offset:2048 sc1 lds
s_add_u32 m0, s18, 0x16800
s_add_u32 s44, s50, 0xe16800
buffer_load_dwordx4 v1, s[4:7], s44 offen offset:0 sc1 lds
buffer_load_dwordx4 v1, s[4:7], s44 offen offset:1024 sc1 lds
buffer_load_dwordx4 v1, s[4:7], s44 offen offset:2048 sc1 lds
s_add_u32 m0, s18, 0x18000
s_add_u32 s44, s50, 0xe18000
buffer_load_dwordx4 v1, s[4:7], s44 offen offset:0 sc1 lds
buffer_load_dwordx4 v1, s[4:7], s44 offen offset:1024 sc1 lds
buffer_load_dwordx4 v1, s[4:7], s44 offen offset:2048 sc1 lds
s_add_u32 m0, s18, 0x19800
s_add_u32 s44, s50, 0xe19800
buffer_load_dwordx4 v1, s[4:7], s44 offen offset:0 sc1 lds
buffer_load_dwordx4 v1, s[4:7], s44 offen offset:1024 sc1 lds
buffer_load_dwordx4 v1, s[4:7], s44 offen offset:2048 sc1 lds
s_add_u32 m0, s18, 0x1b000
s_add_u32 s44, s50, 0xe1b000
buffer_load_dwordx4 v1, s[4:7], s44 offen offset:0 sc1 lds
buffer_load_dwordx4 v1, s[4:7], s44 offen offset:1024 sc1 lds
buffer_load_dwordx4 v1, s[4:7], s44 offen offset:2048 sc1 lds
Lwd_23:
s_cmp_lg_u32 s28, 0
s_cbranch_scc1 Lpe_25
s_add_u32 s36, s67, 0x50000
s_mov_b32 s37, 0
Lpoll_24:
v_mov_b32 v11, 0
buffer_atomic_add v11, v251, s[4:7], s36 offen sc0 sc1
s_add_u32 s37, s37, 1
s_waitcnt vmcnt(0)
v_readfirstlane_b32 s38, v11
s_nop 0
s_cmp_ge_u32 s38, s54
s_cbranch_scc1 Lpe_25
s_cmp_lt_u32 s37, 0x100000
s_cbranch_scc1 Lpoll_24
Lpe_25:
s_waitcnt vmcnt(36) lgkmcnt(0)
s_cmp_ge_u32 s28, 2
s_cbranch_scc1 Lw_26
s_waitcnt vmcnt(0)
Lw_26:
s_barrier
L_stub10:
s_cbranch_execz L_stub11
s_add_u32 s94, s71, 0x20080
s_mov_b32 s35, 0
s_mov_b32 s33, 0x1000
buffer_load_dwordx4 a[0:3], v2, s[40:43], s35 offen offset:0 sc1
buffer_load_dwordx4 a[4:7], v2, s[40:43], s33 offen offset:0 sc1
buffer_load_dwordx4 a[8:11], v2, s[40:43], s35 offen offset:1024 sc1
buffer_load_dwordx4 a[12:15], v2, s[40:43], s33 offen offset:1024 sc1
buffer_load_dwordx4 a[16:19], v2, s[40:43], s35 offen offset:2048 sc1
buffer_load_dwordx4 a[20:23], v2, s[40:43], s33 offen offset:2048 sc1
buffer_load_dwordx4 a[24:27], v2, s[40:43], s35 offen offset:3072 sc1
buffer_load_dwordx4 a[28:31], v2, s[40:43], s33 offen offset:3072 sc1
s_add_u32 s35, s35, 8192
s_add_u32 s33, s33, 8192
s_add_u32 s63, s28, 0
s_lshl_b32 s63, s63, 12
buffer_load_dwordx4 a[160:163], v3, s[40:43], s63 offen sc1
buffer_load_dwordx4 a[32:35], v2, s[40:43], s35 offen offset:0 sc1
buffer_load_dwordx4 a[36:39], v2, s[40:43], s33 offen offset:0 sc1
buffer_load_dwordx4 a[40:43], v2, s[40:43], s35 offen offset:1024 sc1
buffer_load_dwordx4 a[44:47], v2, s[40:43], s33 offen offset:1024 sc1
buffer_load_dwordx4 a[48:51], v2, s[40:43], s35 offen offset:2048 sc1
buffer_load_dwordx4 a[52:55], v2, s[40:43], s33 offen offset:2048 sc1
buffer_load_dwordx4 a[56:59], v2, s[40:43], s35 offen offset:3072 sc1
buffer_load_dwordx4 a[60:63], v2, s[40:43], s33 offen offset:3072 sc1
s_add_u32 s35, s35, 8192
s_add_u32 s33, s33, 8192
v_add_u32 v5, 0, v1
v_add_u32 v6, s55, v5
ds_read_b128 a[96:99], v5 offset:2048
ds_read_b128 a[100:103], v5 offset:8192
ds_read_b128 a[104:107], v5 offset:3072
ds_read_b128 a[108:111], v5 offset:9216
ds_read_b128 a[112:115], v5 offset:4096
ds_read_b128 a[116:119], v5 offset:10240
ds_read_b128 a[120:123], v6 offset:2048
s_waitcnt vmcnt(15) lgkmcnt(5)
v_mfma_f32_16x16x32_bf16 v[140:143], a[96:99], a[0:3], 0
s_add_u32 s63, s28, 4
s_lshl_b32 s63, s63, 12
v_mfma_f32_16x16x32_bf16 v[140:143], a[100:103], a[4:7], v[140:143]
buffer_load_dwordx4 a[64:67], v2, s[40:43], s35 offen offset:0 sc1
s_waitcnt vmcnt(14)
v_mfma_f32_16x16x32_bf16 v[164:167], a[100:103], a[12:15], 0
ds_read_b128 a[128:131], v5 offset:5120
v_mfma_f32_16x16x32_bf16 v[164:167], a[96:99], a[8:11], v[164:167]
ds_read_b128 a[132:135], v5 offset:11264
s_waitcnt vmcnt(13)
v_mfma_f32_16x16x32_bf16 v[188:191], a[96:99], a[16:19], 0
ds_read_b128 a[136:139], v5 offset:0
s_waitcnt vmcnt(12)
v_mfma_f32_16x16x32_bf16 v[188:191], a[100:103], a[20:23], v[188:191]
s_waitcnt vmcnt(10)
v_mfma_f32_16x16x32_bf16 v[212:215], a[100:103], a[28:31], 0
buffer_load_dwordx4 a[68:71], v2, s[40:43], s33 offen offset:0 sc1
v_mfma_f32_16x16x32_bf16 v[212:215], a[96:99], a[24:27], v[212:215]
ds_read_b128 a[140:143], v5 offset:6144
s_waitcnt lgkmcnt(8)
v_mfma_f32_16x16x32_bf16 v[216:219], a[104:107], a[24:27], 0
s_waitcnt lgkmcnt(7)
v_mfma_f32_16x16x32_bf16 v[216:219], a[108:111], a[28:31], v[216:219]
ds_read_b128 a[144:147], v5 offset:1024
v_mfma_f32_16x16x32_bf16 v[192:195], a[108:111], a[20:23], 0
v_mfma_f32_16x16x32_bf16 v[192:195], a[104:107], a[16:19], v[192:195]
buffer_load_dwordx4 a[164:167], v3, s[40:43], s63 offen sc1
s_add_u32 s88, s82, 0x280000
v_mfma_f32_16x16x32_bf16 v[168:171], a[104:107], a[8:11], 0
ds_read_b128 a[148:151], v5 offset:7168
v_mfma_f32_16x16x32_bf16 v[168:171], a[108:111], a[12:15], v[168:171]
ds_read_b128 a[152:155], v6 offset:3072
v_mfma_f32_16x16x32_bf16 v[144:147], a[108:111], a[4:7], 0
v_mfma_f32_16x16x32_bf16 v[144:147], a[104:107], a[0:3], v[144:147]
s_waitcnt lgkmcnt(9)
v_mfma_f32_16x16x32_bf16 v[148:151], a[112:115], a[0:3], 0
buffer_load_dwordx4 a[72:75], v2, s[40:43], s35 offen offset:1024 sc1
s_waitcnt lgkmcnt(8)
v_mfma_f32_16x16x32_bf16 v[148:151], a[116:119], a[4:7], v[148:151]
v_mfma_f32_16x16x32_bf16 v[172:175], a[116:119], a[12:15], 0
v_mfma_f32_16x16x32_bf16 v[172:175], a[112:115], a[8:11], v[172:175]
v_mfma_f32_16x16x32_bf16 v[196:199], a[112:115], a[16:19], 0
v_mfma_f32_16x16x32_bf16 v[196:199], a[116:119], a[20:23], v[196:199]
buffer_load_dwordx4 a[76:79], v2, s[40:43], s33 offen offset:1024 sc1
v_mfma_f32_16x16x32_bf16 v[220:223], a[116:119], a[28:31], 0
v_mfma_f32_16x16x32_bf16 v[220:223], a[112:115], a[24:27], v[220:223]
s_waitcnt vmcnt(13) lgkmcnt(7)
v_mfma_f32_16x16x32_bf16 a[172:175], a[120:123], a[160:163], 0
s_waitcnt lgkmcnt(0)
v_mfma_f32_16x16x32_bf16 v[224:227], a[128:131], a[24:27], 0
ds_read_b128 a[96:99], v5 offset:14336
v_mfma_f32_16x16x32_bf16 v[224:227], a[132:135], a[28:31], v[224:227]
buffer_load_dwordx4 a[80:83], v2, s[40:43], s35 offen offset:2048 sc1
v_mfma_f32_16x16x32_bf16 v[200:203], a[132:135], a[20:23], 0
ds_read_b128 a[100:103], v5 offset:20480
v_mfma_f32_16x16x32_bf16 v[200:203], a[128:131], a[16:19], v[200:203]
v_mfma_f32_16x16x32_bf16 v[176:179], a[128:131], a[8:11], 0
ds_read_b128 a[104:107], v5 offset:15360
v_mfma_f32_16x16x32_bf16 v[176:179], a[132:135], a[12:15], v[176:179]
buffer_load_dwordx4 v[92:95], v1, s[4:7], s88 offen offset:0 sc1
v_mfma_f32_16x16x32_bf16 v[152:155], a[132:135], a[4:7], 0
ds_read_b128 a[108:111], v5 offset:21504
v_mfma_f32_16x16x32_bf16 v[152:155], a[128:131], a[0:3], v[152:155]
v_mfma_f32_16x16x32_bf16 v[132:135], a[136:139], a[0:3], 0
v_mfma_f32_16x16x32_bf16 v[132:135], a[140:143], a[4:7], v[132:135]
buffer_load_dwordx4 a[84:87], v2, s[40:43], s33 offen offset:2048 sc1
v_mfma_f32_16x16x32_bf16 v[156:159], a[140:143], a[12:15], 0
ds_read_b128 a[112:115], v5 offset:16384
v_mfma_f32_16x16x32_bf16 v[156:159], a[136:139], a[8:11], v[156:159]
ds_read_b128 a[116:119], v5 offset:22528
v_mfma_f32_16x16x32_bf16 v[180:183], a[136:139], a[16:19], 0
v_mfma_f32_16x16x32_bf16 v[180:183], a[140:143], a[20:23], v[180:183]
buffer_load_dwordx4 a[88:91], v2, s[40:43], s35 offen offset:3072 sc1
v_mfma_f32_16x16x32_bf16 v[204:207], a[140:143], a[28:31], 0
ds_read_b128 a[120:123], v6 offset:4096
v_mfma_f32_16x16x32_bf16 v[204:207], a[136:139], a[24:27], v[204:207]
v_mfma_f32_16x16x32_bf16 v[208:211], a[144:147], a[24:27], 0
v_mfma_f32_16x16x32_bf16 v[208:211], a[148:151], a[28:31], v[208:211]
buffer_load_dwordx4 v[96:99], v1, s[4:7], s88 offen offset:1024 sc1
v_mfma_f32_16x16x32_bf16 v[184:187], a[148:151], a[20:23], 0
v_mfma_f32_16x16x32_bf16 v[184:187], a[144:147], a[16:19], v[184:187]
v_mfma_f32_16x16x32_bf16 v[160:163], a[144:147], a[8:11], 0
v_mfma_f32_16x16x32_bf16 v[160:163], a[148:151], a[12:15], v[160:163]
buffer_load_dwordx4 a[92:95], v2, s[40:43], s33 offen offset:3072 sc1
s_add_u32 s35, s35, 8192
v_mfma_f32_16x16x32_bf16 v[136:139], a[148:151], a[4:7], 0
s_add_u32 s33, s33, 8192
v_mfma_f32_16x16x32_bf16 v[136:139], a[144:147], a[0:3], v[136:139]
v_mfma_f32_16x16x32_bf16 a[176:179], a[152:155], a[160:163], 0
s_waitcnt vmcnt(11) lgkmcnt(0)
v_mfma_f32_16x16x32_bf16 v[140:143], a[96:99], a[32:35], v[140:143]
ds_read_b128 a[128:131], v5 offset:17408
v_mfma_f32_16x16x32_bf16 v[140:143], a[100:103], a[36:39], v[140:143]
buffer_load_dwordx4 a[0:3], v2, s[40:43], s35 offen offset:0 sc1
v_mfma_f32_16x16x32_bf16 v[164:167], a[100:103], a[44:47], v[164:167]
ds_read_b128 a[132:135], v5 offset:23552
v_mfma_f32_16x16x32_bf16 v[164:167], a[96:99], a[40:43], v[164:167]
v_mfma_f32_16x16x32_bf16 v[188:191], a[96:99], a[48:51], v[188:191]
ds_read_b128 a[136:139], v5 offset:12288
v_mfma_f32_16x16x32_bf16 v[188:191], a[100:103], a[52:55], v[188:191]
buffer_load_dwordx4 v[100:103], v1, s[4:7], s88 offen offset:2048 sc1
v_mfma_f32_16x16x32_bf16 v[212:215], a[100:103], a[60:63], v[212:215]
ds_read_b128 a[140:143], v5 offset:18432
v_mfma_f32_16x16x32_bf16 v[212:215], a[96:99], a[56:59], v[212:215]
v_mfma_f32_16x16x32_bf16 v[216:219], a[104:107], a[56:59], v[216:219]
v_mfma_f32_16x16x32_bf16 v[216:219], a[108:111], a[60:63], v[216:219]
buffer_load_dwordx4 a[4:7], v2, s[40:43], s33 offen offset:0 sc1
v_mfma_f32_16x16x32_bf16 v[192:195], a[108:111], a[52:55], v[192:195]
ds_read_b128 a[144:147], v5 offset:13312
v_mfma_f32_16x16x32_bf16 v[192:195], a[104:107], a[48:51], v[192:195]
ds_read_b128 a[148:151], v5 offset:19456
v_mfma_f32_16x16x32_bf16 v[168:171], a[104:107], a[40:43], v[168:171]
v_mfma_f32_16x16x32_bf16 v[168:171], a[108:111], a[44:47], v[168:171]
buffer_load_dwordx4 a[8:11], v2, s[40:43], s35 offen offset:1024 sc1
v_mfma_f32_16x16x32_bf16 v[144:147], a[108:111], a[36:39], v[144:147]
ds_read_b128 a[152:155], v6 offset:5120
v_mfma_f32_16x16x32_bf16 v[144:147], a[104:107], a[32:35], v[144:147]
v_mfma_f32_16x16x32_bf16 v[148:151], a[112:115], a[32:35], v[148:151]
v_mfma_f32_16x16x32_bf16 v[148:151], a[116:119], a[36:39], v[148:151]
buffer_load_dwordx4 v[104:107], v1, s[4:7], s88 offen offset:3072 sc1
s_add_u32 s88, s88, 4096
v_mfma_f32_16x16x32_bf16 v[172:175], a[116:119], a[44:47], v[172:175]
v_mfma_f32_16x16x32_bf16 v[172:175], a[112:115], a[40:43], v[172:175]
v_mfma_f32_16x16x32_bf16 v[196:199], a[112:115], a[48:51], v[196:199]
v_mfma_f32_16x16x32_bf16 v[196:199], a[116:119], a[52:55], v[196:199]
buffer_load_dwordx4 a[12:15], v2, s[40:43], s33 offen offset:1024 sc1
v_mfma_f32_16x16x32_bf16 v[220:223], a[116:119], a[60:63], v[220:223]
v_mfma_f32_16x16x32_bf16 v[220:223], a[112:115], a[56:59], v[220:223]
v_mfma_f32_16x16x32_bf16 a[180:183], a[120:123], a[160:163], 0
s_waitcnt lgkmcnt(0)
v_mfma_f32_16x16x32_bf16 v[224:227], a[128:131], a[56:59], v[224:227]
ds_read_b128 a[96:99], v5 offset:26624
v_mfma_f32_16x16x32_bf16 v[224:227], a[132:135], a[60:63], v[224:227]
buffer_load_dwordx4 a[16:19], v2, s[40:43], s35 offen offset:2048 sc1
v_mfma_f32_16x16x32_bf16 v[200:203], a[132:135], a[52:55], v[200:203]
ds_read_b128 a[100:103], v5 offset:32768
v_mfma_f32_16x16x32_bf16 v[200:203], a[128:131], a[48:51], v[200:203]
v_mfma_f32_16x16x32_bf16 v[176:179], a[128:131], a[40:43], v[176:179]
ds_read_b128 a[104:107], v5 offset:27648
v_mfma_f32_16x16x32_bf16 v[176:179], a[132:135], a[44:47], v[176:179]
v_mfma_f32_16x16x32_bf16 v[152:155], a[132:135], a[36:39], v[152:155]
buffer_load_dwordx4 a[20:23], v2, s[40:43], s33 offen offset:2048 sc1
v_mfma_f32_16x16x32_bf16 v[152:155], a[128:131], a[32:35], v[152:155]
ds_read_b128 a[108:111], v5 offset:33792
v_mfma_f32_16x16x32_bf16 v[132:135], a[136:139], a[32:35], v[132:135]
v_mfma_f32_16x16x32_bf16 v[132:135], a[140:143], a[36:39], v[132:135]
ds_read_b128 a[112:115], v5 offset:28672
v_mfma_f32_16x16x32_bf16 v[156:159], a[140:143], a[44:47], v[156:159]
v_mfma_f32_16x16x32_bf16 v[156:159], a[136:139], a[40:43], v[156:159]
buffer_load_dwordx4 v[108:111], v1, s[4:7], s88 offen offset:0 sc1
v_mfma_f32_16x16x32_bf16 v[180:183], a[136:139], a[48:51], v[180:183]
ds_read_b128 a[116:119], v5 offset:34816
v_mfma_f32_16x16x32_bf16 v[180:183], a[140:143], a[52:55], v[180:183]
ds_read_b128 a[120:123], v6 offset:26624
v_mfma_f32_16x16x32_bf16 v[204:207], a[140:143], a[60:63], v[204:207]
v_mfma_f32_16x16x32_bf16 v[204:207], a[136:139], a[56:59], v[204:207]
v_mfma_f32_16x16x32_bf16 v[208:211], a[144:147], a[56:59], v[208:211]
buffer_load_dwordx4 a[24:27], v2, s[40:43], s35 offen offset:3072 sc1
v_mfma_f32_16x16x32_bf16 v[208:211], a[148:151], a[60:63], v[208:211]
v_mfma_f32_16x16x32_bf16 v[184:187], a[148:151], a[52:55], v[184:187]
v_mfma_f32_16x16x32_bf16 v[184:187], a[144:147], a[48:51], v[184:187]
v_mfma_f32_16x16x32_bf16 v[160:163], a[144:147], a[40:43], v[160:163]
v_mfma_f32_16x16x32_bf16 v[160:163], a[148:151], a[44:47], v[160:163]
buffer_load_dwordx4 a[28:31], v2, s[40:43], s33 offen offset:3072 sc1
s_add_u32 s35, s35, 8192
v_mfma_f32_16x16x32_bf16 v[136:139], a[148:151], a[36:39], v[136:139]
s_add_u32 s33, s33, 8192
v_mfma_f32_16x16x32_bf16 v[136:139], a[144:147], a[32:35], v[136:139]
v_mfma_f32_16x16x32_bf16 a[184:187], a[152:155], a[160:163], 0
s_waitcnt vmcnt(11) lgkmcnt(0)
v_mfma_f32_16x16x32_bf16 v[140:143], a[96:99], a[64:67], v[140:143]
ds_read_b128 a[128:131], v5 offset:29696
v_mfma_f32_16x16x32_bf16 v[140:143], a[100:103], a[68:71], v[140:143]
buffer_load_dwordx4 a[32:35], v2, s[40:43], s35 offen offset:0 sc1
v_mfma_f32_16x16x32_bf16 v[164:167], a[100:103], a[76:79], v[164:167]
ds_read_b128 a[132:135], v5 offset:35840
v_mfma_f32_16x16x32_bf16 v[164:167], a[96:99], a[72:75], v[164:167]
v_mfma_f32_16x16x32_bf16 v[188:191], a[96:99], a[80:83], v[188:191]
ds_read_b128 a[136:139], v5 offset:24576
v_mfma_f32_16x16x32_bf16 v[188:191], a[100:103], a[84:87], v[188:191]
buffer_load_dwordx4 v[112:115], v1, s[4:7], s88 offen offset:1024 sc1
s_add_u32 s63, s28, 8
v_mfma_f32_16x16x32_bf16 v[212:215], a[100:103], a[92:95], v[212:215]
s_lshl_b32 s63, s63, 12
ds_read_b128 a[140:143], v5 offset:30720
v_mfma_f32_16x16x32_bf16 v[212:215], a[96:99], a[88:91], v[212:215]
v_mfma_f32_16x16x32_bf16 v[216:219], a[104:107], a[88:91], v[216:219]
v_mfma_f32_16x16x32_bf16 v[216:219], a[108:111], a[92:95], v[216:219]
buffer_load_dwordx4 a[36:39], v2, s[40:43], s33 offen offset:0 sc1
v_mfma_f32_16x16x32_bf16 v[192:195], a[108:111], a[84:87], v[192:195]
ds_read_b128 a[144:147], v5 offset:25600
v_mfma_f32_16x16x32_bf16 v[192:195], a[104:107], a[80:83], v[192:195]
ds_read_b128 a[148:151], v5 offset:31744
v_mfma_f32_16x16x32_bf16 v[168:171], a[104:107], a[72:75], v[168:171]
v_mfma_f32_16x16x32_bf16 v[168:171], a[108:111], a[76:79], v[168:171]
buffer_load_dwordx4 a[40:43], v2, s[40:43], s35 offen offset:1024 sc1
v_mfma_f32_16x16x32_bf16 v[144:147], a[108:111], a[68:71], v[144:147]
ds_read_b128 a[152:155], v6 offset:27648
v_mfma_f32_16x16x32_bf16 v[144:147], a[104:107], a[64:67], v[144:147]
v_mfma_f32_16x16x32_bf16 v[148:151], a[112:115], a[64:67], v[148:151]
v_mfma_f32_16x16x32_bf16 v[148:151], a[116:119], a[68:71], v[148:151]
buffer_load_dwordx4 a[168:171], v3, s[40:43], s63 offen sc1
v_mfma_f32_16x16x32_bf16 v[172:175], a[116:119], a[76:79], v[172:175]
v_mfma_f32_16x16x32_bf16 v[172:175], a[112:115], a[72:75], v[172:175]
v_mfma_f32_16x16x32_bf16 v[196:199], a[112:115], a[80:83], v[196:199]
v_mfma_f32_16x16x32_bf16 v[196:199], a[116:119], a[84:87], v[196:199]
buffer_load_dwordx4 a[44:47], v2, s[40:43], s33 offen offset:1024 sc1
v_mfma_f32_16x16x32_bf16 v[220:223], a[116:119], a[92:95], v[220:223]
v_mfma_f32_16x16x32_bf16 v[220:223], a[112:115], a[88:91], v[220:223]
v_mfma_f32_16x16x32_bf16 a[172:175], a[120:123], a[164:167], a[172:175]
s_waitcnt lgkmcnt(0)
v_mfma_f32_16x16x32_bf16 v[224:227], a[128:131], a[88:91], v[224:227]
ds_read_b128 a[96:99], v5 offset:38912
v_mfma_f32_16x16x32_bf16 v[224:227], a[132:135], a[92:95], v[224:227]
buffer_load_dwordx4 a[48:51], v2, s[40:43], s35 offen offset:2048 sc1
v_mfma_f32_16x16x32_bf16 v[200:203], a[132:135], a[84:87], v[200:203]
ds_read_b128 a[100:103], v5 offset:45056
v_mfma_f32_16x16x32_bf16 v[200:203], a[128:131], a[80:83], v[200:203]
v_mfma_f32_16x16x32_bf16 v[176:179], a[128:131], a[72:75], v[176:179]
ds_read_b128 a[104:107], v5 offset:39936
v_mfma_f32_16x16x32_bf16 v[176:179], a[132:135], a[76:79], v[176:179]
v_mfma_f32_16x16x32_bf16 v[152:155], a[132:135], a[68:71], v[152:155]
buffer_load_dwordx4 a[52:55], v2, s[40:43], s33 offen offset:2048 sc1
v_mfma_f32_16x16x32_bf16 v[152:155], a[128:131], a[64:67], v[152:155]
ds_read_b128 a[108:111], v5 offset:46080
v_mfma_f32_16x16x32_bf16 v[132:135], a[136:139], a[64:67], v[132:135]
v_mfma_f32_16x16x32_bf16 v[132:135], a[140:143], a[68:71], v[132:135]
ds_read_b128 a[112:115], v5 offset:40960
v_mfma_f32_16x16x32_bf16 v[156:159], a[140:143], a[76:79], v[156:159]
v_mfma_f32_16x16x32_bf16 v[156:159], a[136:139], a[72:75], v[156:159]
buffer_load_dwordx4 v[116:119], v1, s[4:7], s88 offen offset:2048 sc1
v_mfma_f32_16x16x32_bf16 v[180:183], a[136:139], a[80:83], v[180:183]
ds_read_b128 a[116:119], v5 offset:47104
v_mfma_f32_16x16x32_bf16 v[180:183], a[140:143], a[84:87], v[180:183]
ds_read_b128 a[120:123], v6 offset:28672
v_mfma_f32_16x16x32_bf16 v[204:207], a[140:143], a[92:95], v[204:207]
v_mfma_f32_16x16x32_bf16 v[204:207], a[136:139], a[88:91], v[204:207]
v_mfma_f32_16x16x32_bf16 v[208:211], a[144:147], a[88:91], v[208:211]
buffer_load_dwordx4 a[56:59], v2, s[40:43], s35 offen offset:3072 sc1
v_mfma_f32_16x16x32_bf16 v[208:211], a[148:151], a[92:95], v[208:211]
v_mfma_f32_16x16x32_bf16 v[184:187], a[148:151], a[84:87], v[184:187]
v_mfma_f32_16x16x32_bf16 v[184:187], a[144:147], a[80:83], v[184:187]
v_mfma_f32_16x16x32_bf16 v[160:163], a[144:147], a[72:75], v[160:163]
v_mfma_f32_16x16x32_bf16 v[160:163], a[148:151], a[76:79], v[160:163]
buffer_load_dwordx4 a[60:63], v2, s[40:43], s33 offen offset:3072 sc1
s_add_u32 s35, s35, 8192
v_mfma_f32_16x16x32_bf16 v[136:139], a[148:151], a[68:71], v[136:139]
s_add_u32 s33, s33, 8192
v_mfma_f32_16x16x32_bf16 v[136:139], a[144:147], a[64:67], v[136:139]
v_mfma_f32_16x16x32_bf16 a[176:179], a[152:155], a[164:167], a[176:179]
s_waitcnt vmcnt(11) lgkmcnt(0)
v_mfma_f32_16x16x32_bf16 v[140:143], a[96:99], a[0:3], v[140:143]
ds_read_b128 a[128:131], v5 offset:41984
v_mfma_f32_16x16x32_bf16 v[140:143], a[100:103], a[4:7], v[140:143]
buffer_load_dwordx4 a[64:67], v2, s[40:43], s35 offen offset:0 sc1
v_mfma_f32_16x16x32_bf16 v[164:167], a[100:103], a[12:15], v[164:167]
ds_read_b128 a[132:135], v5 offset:48128
v_mfma_f32_16x16x32_bf16 v[164:167], a[96:99], a[8:11], v[164:167]
v_mfma_f32_16x16x32_bf16 v[188:191], a[96:99], a[16:19], v[188:191]
ds_read_b128 a[136:139], v5 offset:36864
v_mfma_f32_16x16x32_bf16 v[188:191], a[100:103], a[20:23], v[188:191]
buffer_load_dwordx4 v[120:123], v1, s[4:7], s88 offen offset:3072 sc1
s_add_u32 s88, s83, 0x280000
v_mfma_f32_16x16x32_bf16 v[212:215], a[100:103], a[28:31], v[212:215]
ds_read_b128 a[140:143], v5 offset:43008
v_mfma_f32_16x16x32_bf16 v[212:215], a[96:99], a[24:27], v[212:215]
v_mfma_f32_16x16x32_bf16 v[216:219], a[104:107], a[24:27], v[216:219]
v_mfma_f32_16x16x32_bf16 v[216:219], a[108:111], a[28:31], v[216:219]
buffer_load_dwordx4 a[68:71], v2, s[40:43], s33 offen offset:0 sc1
v_mfma_f32_16x16x32_bf16 v[192:195], a[108:111], a[20:23], v[192:195]
ds_read_b128 a[144:147], v5 offset:37888
v_mfma_f32_16x16x32_bf16 v[192:195], a[104:107], a[16:19], v[192:195]
ds_read_b128 a[148:151], v5 offset:44032
v_mfma_f32_16x16x32_bf16 v[168:171], a[104:107], a[8:11], v[168:171]
v_mfma_f32_16x16x32_bf16 v[168:171], a[108:111], a[12:15], v[168:171]
buffer_load_dwordx4 a[72:75], v2, s[40:43], s35 offen offset:1024 sc1
v_mfma_f32_16x16x32_bf16 v[144:147], a[108:111], a[4:7], v[144:147]
ds_read_b128 a[152:155], v6 offset:29696
v_mfma_f32_16x16x32_bf16 v[144:147], a[104:107], a[0:3], v[144:147]
v_mfma_f32_16x16x32_bf16 v[148:151], a[112:115], a[0:3], v[148:151]
v_mfma_f32_16x16x32_bf16 v[148:151], a[116:119], a[4:7], v[148:151]
buffer_load_dwordx4 v[124:127], v1, s[4:7], s88 offen offset:0 sc1
v_mfma_f32_16x16x32_bf16 v[172:175], a[116:119], a[12:15], v[172:175]
v_mfma_f32_16x16x32_bf16 v[172:175], a[112:115], a[8:11], v[172:175]
v_mfma_f32_16x16x32_bf16 v[196:199], a[112:115], a[16:19], v[196:199]
v_mfma_f32_16x16x32_bf16 v[196:199], a[116:119], a[20:23], v[196:199]
buffer_load_dwordx4 a[76:79], v2, s[40:43], s33 offen offset:1024 sc1
v_mfma_f32_16x16x32_bf16 v[220:223], a[116:119], a[28:31], v[220:223]
v_mfma_f32_16x16x32_bf16 v[220:223], a[112:115], a[24:27], v[220:223]
v_mfma_f32_16x16x32_bf16 a[180:183], a[120:123], a[164:167], a[180:183]
s_waitcnt lgkmcnt(0)
s_barrier
v_mfma_f32_16x16x32_bf16 v[224:227], a[128:131], a[24:27], v[224:227]
v_add_u32 v5, 49152, v1
v_add_u32 v6, s55, v5
v_mfma_f32_16x16x32_bf16 v[224:227], a[132:135], a[28:31], v[224:227]
buffer_load_dwordx4 a[80:83], v2, s[40:43], s35 offen offset:2048 sc1
v_mfma_f32_16x16x32_bf16 v[200:203], a[132:135], a[20:23], v[200:203]
ds_read_b128 a[96:99], v5 offset:2048
v_mfma_f32_16x16x32_bf16 v[200:203], a[128:131], a[16:19], v[200:203]
ds_read_b128 a[100:103], v5 offset:8192
v_mfma_f32_16x16x32_bf16 v[176:179], a[128:131], a[8:11], v[176:179]
ds_read_b128 a[104:107], v5 offset:3072
v_mfma_f32_16x16x32_bf16 v[176:179], a[132:135], a[12:15], v[176:179]
buffer_load_dwordx4 v[128:131], v1, s[4:7], s88 offen offset:1024 sc1
s_add_u32 m0, s18, 0x1e000
v_mfma_f32_16x16x32_bf16 v[152:155], a[132:135], a[4:7], v[152:155]
s_add_u32 s44, s50, 0xe1e000
ds_read_b128 a[108:111], v5 offset:9216
v_mfma_f32_16x16x32_bf16 v[152:155], a[128:131], a[0:3], v[152:155]
v_mfma_f32_16x16x32_bf16 v[132:135], a[136:139], a[0:3], v[132:135]
v_mfma_f32_16x16x32_bf16 v[132:135], a[140:143], a[4:7], v[132:135]
buffer_load_dwordx4 a[84:87], v2, s[40:43], s33 offen offset:2048 sc1
v_mfma_f32_16x16x32_bf16 v[156:159], a[140:143], a[12:15], v[156:159]
ds_read_b128 a[112:115], v5 offset:4096
v_mfma_f32_16x16x32_bf16 v[156:159], a[136:139], a[8:11], v[156:159]
ds_read_b128 a[116:119], v5 offset:10240
v_mfma_f32_16x16x32_bf16 v[180:183], a[136:139], a[16:19], v[180:183]
v_mfma_f32_16x16x32_bf16 v[180:183], a[140:143], a[20:23], v[180:183]
buffer_load_dwordx4 a[88:91], v2, s[40:43], s35 offen offset:3072 sc1
v_mfma_f32_16x16x32_bf16 v[204:207], a[140:143], a[28:31], v[204:207]
ds_read_b128 a[120:123], v6 offset:2048
v_mfma_f32_16x16x32_bf16 v[204:207], a[136:139], a[24:27], v[204:207]
v_mfma_f32_16x16x32_bf16 v[208:211], a[144:147], a[24:27], v[208:211]
v_mfma_f32_16x16x32_bf16 v[208:211], a[148:151], a[28:31], v[208:211]
buffer_load_dwordx4 v1, s[4:7], s44 offen offset:0 sc1 lds
s_add_u32 s63, s28, 12
v_mfma_f32_16x16x32_bf16 v[184:187], a[148:151], a[20:23], v[184:187]
s_lshl_b32 s63, s63, 12
v_mfma_f32_16x16x32_bf16 v[184:187], a[144:147], a[16:19], v[184:187]
v_mfma_f32_16x16x32_bf16 v[160:163], a[144:147], a[8:11], v[160:163]
v_mfma_f32_16x16x32_bf16 v[160:163], a[148:151], a[12:15], v[160:163]
buffer_load_dwordx4 a[92:95], v2, s[40:43], s33 offen offset:3072 sc1
s_add_u32 s35, s35, 8192
v_mfma_f32_16x16x32_bf16 v[136:139], a[148:151], a[4:7], v[136:139]
s_add_u32 s33, s33, 8192
v_mfma_f32_16x16x32_bf16 v[136:139], a[144:147], a[0:3], v[136:139]
v_mfma_f32_16x16x32_bf16 a[184:187], a[152:155], a[164:167], a[184:187]
s_waitcnt vmcnt(12) lgkmcnt(0)
v_mfma_f32_16x16x32_bf16 v[140:143], a[96:99], a[32:35], v[140:143]
ds_read_b128 a[128:131], v5 offset:5120
v_mfma_f32_16x16x32_bf16 v[140:143], a[100:103], a[36:39], v[140:143]
buffer_load_dwordx4 a[0:3], v2, s[40:43], s35 offen offset:0 sc1
v_mfma_f32_16x16x32_bf16 v[164:167], a[100:103], a[44:47], v[164:167]
ds_read_b128 a[132:135], v5 offset:11264
v_mfma_f32_16x16x32_bf16 v[164:167], a[96:99], a[40:43], v[164:167]
v_mfma_f32_16x16x32_bf16 v[188:191], a[96:99], a[48:51], v[188:191]
ds_read_b128 a[136:139], v5 offset:0
v_mfma_f32_16x16x32_bf16 v[188:191], a[100:103], a[52:55], v[188:191]
v_mfma_f32_16x16x32_bf16 v[212:215], a[100:103], a[60:63], v[212:215]
buffer_load_dwordx4 a[4:7], v2, s[40:43], s33 offen offset:0 sc1
v_mfma_f32_16x16x32_bf16 v[212:215], a[96:99], a[56:59], v[212:215]
ds_read_b128 a[140:143], v5 offset:6144
v_mfma_f32_16x16x32_bf16 v[216:219], a[104:107], a[56:59], v[216:219]
v_mfma_f32_16x16x32_bf16 v[216:219], a[108:111], a[60:63], v[216:219]
ds_read_b128 a[144:147], v5 offset:1024
v_mfma_f32_16x16x32_bf16 v[192:195], a[108:111], a[52:55], v[192:195]
v_mfma_f32_16x16x32_bf16 v[192:195], a[104:107], a[48:51], v[192:195]
buffer_load_dwordx4 a[160:163], v3, s[40:43], s63 offen sc1
v_mfma_f32_16x16x32_bf16 v[168:171], a[104:107], a[40:43], v[168:171]
ds_read_b128 a[148:151], v5 offset:7168
v_mfma_f32_16x16x32_bf16 v[168:171], a[108:111], a[44:47], v[168:171]
ds_read_b128 a[152:155], v6 offset:3072
v_mfma_f32_16x16x32_bf16 v[144:147], a[108:111], a[36:39], v[144:147]
v_mfma_f32_16x16x32_bf16 v[144:147], a[104:107], a[32:35], v[144:147]
v_mfma_f32_16x16x32_bf16 v[148:151], a[112:115], a[32:35], v[148:151]
buffer_load_dwordx4 a[8:11], v2, s[40:43], s35 offen offset:1024 sc1
v_mfma_f32_16x16x32_bf16 v[148:151], a[116:119], a[36:39], v[148:151]
v_mfma_f32_16x16x32_bf16 v[172:175], a[116:119], a[44:47], v[172:175]
v_mfma_f32_16x16x32_bf16 v[172:175], a[112:115], a[40:43], v[172:175]
v_mfma_f32_16x16x32_bf16 v[196:199], a[112:115], a[48:51], v[196:199]
v_mfma_f32_16x16x32_bf16 v[196:199], a[116:119], a[52:55], v[196:199]
buffer_load_dwordx4 a[12:15], v2, s[40:43], s33 offen offset:1024 sc1
v_mfma_f32_16x16x32_bf16 v[220:223], a[116:119], a[60:63], v[220:223]
v_mfma_f32_16x16x32_bf16 v[220:223], a[112:115], a[56:59], v[220:223]
v_mfma_f32_16x16x32_bf16 a[172:175], a[120:123], a[168:171], a[172:175]
s_waitcnt lgkmcnt(0)
v_mfma_f32_16x16x32_bf16 v[224:227], a[128:131], a[56:59], v[224:227]
ds_read_b128 a[96:99], v5 offset:14336
v_mfma_f32_16x16x32_bf16 v[224:227], a[132:135], a[60:63], v[224:227]
buffer_load_dwordx4 a[16:19], v2, s[40:43], s35 offen offset:2048 sc1
v_mfma_f32_16x16x32_bf16 v[200:203], a[132:135], a[52:55], v[200:203]
ds_read_b128 a[100:103], v5 offset:20480
v_mfma_f32_16x16x32_bf16 v[200:203], a[128:131], a[48:51], v[200:203]
v_mfma_f32_16x16x32_bf16 v[176:179], a[128:131], a[40:43], v[176:179]
ds_read_b128 a[104:107], v5 offset:15360
v_mfma_f32_16x16x32_bf16 v[176:179], a[132:135], a[44:47], v[176:179]
buffer_load_dwordx4 v1, s[4:7], s44 offen offset:1024 sc1 lds
v_mfma_f32_16x16x32_bf16 v[152:155], a[132:135], a[36:39], v[152:155]
ds_read_b128 a[108:111], v5 offset:21504
v_mfma_f32_16x16x32_bf16 v[152:155], a[128:131], a[32:35], v[152:155]
v_mfma_f32_16x16x32_bf16 v[132:135], a[136:139], a[32:35], v[132:135]
v_mfma_f32_16x16x32_bf16 v[132:135], a[140:143], a[36:39], v[132:135]
buffer_load_dwordx4 a[20:23], v2, s[40:43], s33 offen offset:2048 sc1
v_mfma_f32_16x16x32_bf16 v[156:159], a[140:143], a[44:47], v[156:159]
ds_read_b128 a[112:115], v5 offset:16384
v_mfma_f32_16x16x32_bf16 v[156:159], a[136:139], a[40:43], v[156:159]
ds_read_b128 a[116:119], v5 offset:22528
v_mfma_f32_16x16x32_bf16 v[180:183], a[136:139], a[48:51], v[180:183]
v_mfma_f32_16x16x32_bf16 v[180:183], a[140:143], a[52:55], v[180:183]
buffer_load_dwordx4 a[24:27], v2, s[40:43], s35 offen offset:3072 sc1
v_mfma_f32_16x16x32_bf16 v[204:207], a[140:143], a[60:63], v[204:207]
ds_read_b128 a[120:123], v6 offset:4096
v_mfma_f32_16x16x32_bf16 v[204:207], a[136:139], a[56:59], v[204:207]
v_mfma_f32_16x16x32_bf16 v[208:211], a[144:147], a[56:59], v[208:211]
v_mfma_f32_16x16x32_bf16 v[208:211], a[148:151], a[60:63], v[208:211]
buffer_load_dwordx4 v1, s[4:7], s44 offen offset:2048 sc1 lds
s_add_u32 m0, s18, 0x21000
v_mfma_f32_16x16x32_bf16 v[184:187], a[148:151], a[52:55], v[184:187]
s_add_u32 s44, s50, 0xe21000
v_mfma_f32_16x16x32_bf16 v[184:187], a[144:147], a[48:51], v[184:187]
v_mfma_f32_16x16x32_bf16 v[160:163], a[144:147], a[40:43], v[160:163]
v_mfma_f32_16x16x32_bf16 v[160:163], a[148:151], a[44:47], v[160:163]
buffer_load_dwordx4 a[28:31], v2, s[40:43], s33 offen offset:3072 sc1
s_add_u32 s35, s35, 8192
v_mfma_f32_16x16x32_bf16 v[136:139], a[148:151], a[36:39], v[136:139]
s_add_u32 s33, s33, 8192
v_mfma_f32_16x16x32_bf16 v[136:139], a[144:147], a[32:35], v[136:139]
v_mfma_f32_16x16x32_bf16 a[176:179], a[152:155], a[168:171], a[176:179]
s_waitcnt vmcnt(11) lgkmcnt(0)
v_mfma_f32_16x16x32_bf16 v[140:143], a[96:99], a[64:67], v[140:143]
ds_read_b128 a[128:131], v5 offset:17408
v_mfma_f32_16x16x32_bf16 v[140:143], a[100:103], a[68:71], v[140:143]
buffer_load_dwordx4 a[32:35], v2, s[40:43], s35 offen offset:0 sc1
v_mfma_f32_16x16x32_bf16 v[164:167], a[100:103], a[76:79], v[164:167]
ds_read_b128 a[132:135], v5 offset:23552
v_mfma_f32_16x16x32_bf16 v[164:167], a[96:99], a[72:75], v[164:167]
v_mfma_f32_16x16x32_bf16 v[188:191], a[96:99], a[80:83], v[188:191]
ds_read_b128 a[136:139], v5 offset:12288
v_mfma_f32_16x16x32_bf16 v[188:191], a[100:103], a[84:87], v[188:191]
v_mfma_f32_16x16x32_bf16 v[212:215], a[100:103], a[92:95], v[212:215]
buffer_load_dwordx4 a[36:39], v2, s[40:43], s33 offen offset:0 sc1
v_mfma_f32_16x16x32_bf16 v[212:215], a[96:99], a[88:91], v[212:215]
ds_read_b128 a[140:143], v5 offset:18432
v_mfma_f32_16x16x32_bf16 v[216:219], a[104:107], a[88:91], v[216:219]
v_mfma_f32_16x16x32_bf16 v[216:219], a[108:111], a[92:95], v[216:219]
ds_read_b128 a[144:147], v5 offset:13312
v_mfma_f32_16x16x32_bf16 v[192:195], a[108:111], a[84:87], v[192:195]
v_mfma_f32_16x16x32_bf16 v[192:195], a[104:107], a[80:83], v[192:195]
buffer_load_dwordx4 v1, s[4:7], s44 offen offset:0 sc1 lds
v_mfma_f32_16x16x32_bf16 v[168:171], a[104:107], a[72:75], v[168:171]
ds_read_b128 a[148:151], v5 offset:19456
v_mfma_f32_16x16x32_bf16 v[168:171], a[108:111], a[76:79], v[168:171]
ds_read_b128 a[152:155], v6 offset:5120
v_mfma_f32_16x16x32_bf16 v[144:147], a[108:111], a[68:71], v[144:147]
v_mfma_f32_16x16x32_bf16 v[144:147], a[104:107], a[64:67], v[144:147]
v_mfma_f32_16x16x32_bf16 v[148:151], a[112:115], a[64:67], v[148:151]
buffer_load_dwordx4 a[40:43], v2, s[40:43], s35 offen offset:1024 sc1
v_mfma_f32_16x16x32_bf16 v[148:151], a[116:119], a[68:71], v[148:151]
v_mfma_f32_16x16x32_bf16 v[172:175], a[116:119], a[76:79], v[172:175]
v_mfma_f32_16x16x32_bf16 v[172:175], a[112:115], a[72:75], v[172:175]
v_mfma_f32_16x16x32_bf16 v[196:199], a[112:115], a[80:83], v[196:199]
v_mfma_f32_16x16x32_bf16 v[196:199], a[116:119], a[84:87], v[196:199]
buffer_load_dwordx4 a[44:47], v2, s[40:43], s33 offen offset:1024 sc1
v_mfma_f32_16x16x32_bf16 v[220:223], a[116:119], a[92:95], v[220:223]
v_mfma_f32_16x16x32_bf16 v[220:223], a[112:115], a[88:91], v[220:223]
v_mfma_f32_16x16x32_bf16 a[180:183], a[120:123], a[168:171], a[180:183]
s_waitcnt lgkmcnt(0)
v_mfma_f32_16x16x32_bf16 v[224:227], a[128:131], a[88:91], v[224:227]
ds_read_b128 a[96:99], v5 offset:26624
v_mfma_f32_16x16x32_bf16 v[224:227], a[132:135], a[92:95], v[224:227]
buffer_load_dwordx4 a[48:51], v2, s[40:43], s35 offen offset:2048 sc1
v_mfma_f32_16x16x32_bf16 v[200:203], a[132:135], a[84:87], v[200:203]
ds_read_b128 a[100:103], v5 offset:32768
v_mfma_f32_16x16x32_bf16 v[200:203], a[128:131], a[80:83], v[200:203]
v_mfma_f32_16x16x32_bf16 v[176:179], a[128:131], a[72:75], v[176:179]
ds_read_b128 a[104:107], v5 offset:27648
v_mfma_f32_16x16x32_bf16 v[176:179], a[132:135], a[76:79], v[176:179]
buffer_load_dwordx4 v1, s[4:7], s44 offen offset:1024 sc1 lds
v_mfma_f32_16x16x32_bf16 v[152:155], a[132:135], a[68:71], v[152:155]
ds_read_b128 a[108:111], v5 offset:33792
v_mfma_f32_16x16x32_bf16 v[152:155], a[128:131], a[64:67], v[152:155]
v_mfma_f32_16x16x32_bf16 v[132:135], a[136:139], a[64:67], v[132:135]
v_mfma_f32_16x16x32_bf16 v[132:135], a[140:143], a[68:71], v[132:135]
buffer_load_dwordx4 a[52:55], v2, s[40:43], s33 offen offset:2048 sc1
v_mfma_f32_16x16x32_bf16 v[156:159], a[140:143], a[76:79], v[156:159]
ds_read_b128 a[112:115], v5 offset:28672
v_mfma_f32_16x16x32_bf16 v[156:159], a[136:139], a[72:75], v[156:159]
ds_read_b128 a[116:119], v5 offset:34816
v_mfma_f32_16x16x32_bf16 v[180:183], a[136:139], a[80:83], v[180:183]
v_mfma_f32_16x16x32_bf16 v[180:183], a[140:143], a[84:87], v[180:183]
buffer_load_dwordx4 a[56:59], v2, s[40:43], s35 offen offset:3072 sc1
v_mfma_f32_16x16x32_bf16 v[204:207], a[140:143], a[92:95], v[204:207]
ds_read_b128 a[120:123], v6 offset:26624
v_mfma_f32_16x16x32_bf16 v[204:207], a[136:139], a[88:91], v[204:207]
v_mfma_f32_16x16x32_bf16 v[208:211], a[144:147], a[88:91], v[208:211]
v_mfma_f32_16x16x32_bf16 v[208:211], a[148:151], a[92:95], v[208:211]
buffer_load_dwordx4 v1, s[4:7], s44 offen offset:2048 sc1 lds
s_add_u32 m0, s18, 0x0
v_mfma_f32_16x16x32_bf16 v[184:187], a[148:151], a[84:87], v[184:187]
s_add_u32 s44, s50, 0xe24000
v_mfma_f32_16x16x32_bf16 v[184:187], a[144:147], a[80:83], v[184:187]
L_stub11:
s_cbranch_execz L_stub12
v_mfma_f32_16x16x32_bf16 v[160:163], a[144:147], a[72:75], v[160:163]
v_mfma_f32_16x16x32_bf16 v[160:163], a[148:151], a[76:79], v[160:163]
buffer_load_dwordx4 a[60:63], v2, s[40:43], s33 offen offset:3072 sc1
s_add_u32 s35, s35, 8192
v_mfma_f32_16x16x32_bf16 v[136:139], a[148:151], a[68:71], v[136:139]
s_add_u32 s33, s33, 8192
v_mfma_f32_16x16x32_bf16 v[136:139], a[144:147], a[64:67], v[136:139]
v_mfma_f32_16x16x32_bf16 a[184:187], a[152:155], a[168:171], a[184:187]
s_waitcnt vmcnt(11) lgkmcnt(0)
v_mfma_f32_16x16x32_bf16 v[140:143], a[96:99], a[0:3], v[140:143]
ds_read_b128 a[128:131], v5 offset:29696
v_mfma_f32_16x16x32_bf16 v[140:143], a[100:103], a[4:7], v[140:143]
buffer_load_dwordx4 a[64:67], v2, s[40:43], s35 offen offset:0 sc1
v_mfma_f32_16x16x32_bf16 v[164:167], a[100:103], a[12:15], v[164:167]
ds_read_b128 a[132:135], v5 offset:35840
v_mfma_f32_16x16x32_bf16 v[164:167], a[96:99], a[8:11], v[164:167]
v_mfma_f32_16x16x32_bf16 v[188:191], a[96:99], a[16:19], v[188:191]
ds_read_b128 a[136:139], v5 offset:24576
v_mfma_f32_16x16x32_bf16 v[188:191], a[100:103], a[20:23], v[188:191]
buffer_load_dwordx4 v1, s[4:7], s44 offen offset:0 sc1 lds
s_add_u32 s63, s28, 16
v_mfma_f32_16x16x32_bf16 v[212:215], a[100:103], a[28:31], v[212:215]
s_lshl_b32 s63, s63, 12
ds_read_b128 a[140:143], v5 offset:30720
v_mfma_f32_16x16x32_bf16 v[212:215], a[96:99], a[24:27], v[212:215]
v_mfma_f32_16x16x32_bf16 v[216:219], a[104:107], a[24:27], v[216:219]
v_mfma_f32_16x16x32_bf16 v[216:219], a[108:111], a[28:31], v[216:219]
buffer_load_dwordx4 a[68:71], v2, s[40:43], s33 offen offset:0 sc1
v_mfma_f32_16x16x32_bf16 v[192:195], a[108:111], a[20:23], v[192:195]
ds_read_b128 a[144:147], v5 offset:25600
v_mfma_f32_16x16x32_bf16 v[192:195], a[104:107], a[16:19], v[192:195]
ds_read_b128 a[148:151], v5 offset:31744
v_mfma_f32_16x16x32_bf16 v[168:171], a[104:107], a[8:11], v[168:171]
v_mfma_f32_16x16x32_bf16 v[168:171], a[108:111], a[12:15], v[168:171]
buffer_load_dwordx4 a[72:75], v2, s[40:43], s35 offen offset:1024 sc1
v_mfma_f32_16x16x32_bf16 v[144:147], a[108:111], a[4:7], v[144:147]
ds_read_b128 a[152:155], v6 offset:27648
v_mfma_f32_16x16x32_bf16 v[144:147], a[104:107], a[0:3], v[144:147]
v_mfma_f32_16x16x32_bf16 v[148:151], a[112:115], a[0:3], v[148:151]
v_mfma_f32_16x16x32_bf16 v[148:151], a[116:119], a[4:7], v[148:151]
buffer_load_dwordx4 a[164:167], v3, s[40:43], s63 offen sc1
v_mfma_f32_16x16x32_bf16 v[172:175], a[116:119], a[12:15], v[172:175]
v_mfma_f32_16x16x32_bf16 v[172:175], a[112:115], a[8:11], v[172:175]
v_mfma_f32_16x16x32_bf16 v[196:199], a[112:115], a[16:19], v[196:199]
v_mfma_f32_16x16x32_bf16 v[196:199], a[116:119], a[20:23], v[196:199]
buffer_load_dwordx4 a[76:79], v2, s[40:43], s33 offen offset:1024 sc1
v_mfma_f32_16x16x32_bf16 v[220:223], a[116:119], a[28:31], v[220:223]
v_mfma_f32_16x16x32_bf16 v[220:223], a[112:115], a[24:27], v[220:223]
v_mfma_f32_16x16x32_bf16 a[172:175], a[120:123], a[160:163], a[172:175]
s_waitcnt lgkmcnt(0)
v_mfma_f32_16x16x32_bf16 v[224:227], a[128:131], a[24:27], v[224:227]
ds_read_b128 a[96:99], v5 offset:38912
v_mfma_f32_16x16x32_bf16 v[224:227], a[132:135], a[28:31], v[224:227]
buffer_load_dwordx4 a[80:83], v2, s[40:43], s35 offen offset:2048 sc1
v_mfma_f32_16x16x32_bf16 v[200:203], a[132:135], a[20:23], v[200:203]
ds_read_b128 a[100:103], v5 offset:45056
v_mfma_f32_16x16x32_bf16 v[200:203], a[128:131], a[16:19], v[200:203]
v_mfma_f32_16x16x32_bf16 v[176:179], a[128:131], a[8:11], v[176:179]
ds_read_b128 a[104:107], v5 offset:39936
v_mfma_f32_16x16x32_bf16 v[176:179], a[132:135], a[12:15], v[176:179]
v_mfma_f32_16x16x32_bf16 v[152:155], a[132:135], a[4:7], v[152:155]
buffer_load_dwordx4 a[84:87], v2, s[40:43], s33 offen offset:2048 sc1
v_mfma_f32_16x16x32_bf16 v[152:155], a[128:131], a[0:3], v[152:155]
ds_read_b128 a[108:111], v5 offset:46080
v_mfma_f32_16x16x32_bf16 v[132:135], a[136:139], a[0:3], v[132:135]
v_mfma_f32_16x16x32_bf16 v[132:135], a[140:143], a[4:7], v[132:135]
ds_read_b128 a[112:115], v5 offset:40960
v_mfma_f32_16x16x32_bf16 v[156:159], a[140:143], a[12:15], v[156:159]
v_mfma_f32_16x16x32_bf16 v[156:159], a[136:139], a[8:11], v[156:159]
buffer_load_dwordx4 v1, s[4:7], s44 offen offset:1024 sc1 lds
v_mfma_f32_16x16x32_bf16 v[180:183], a[136:139], a[16:19], v[180:183]
ds_read_b128 a[116:119], v5 offset:47104
v_mfma_f32_16x16x32_bf16 v[180:183], a[140:143], a[20:23], v[180:183]
ds_read_b128 a[120:123], v6 offset:28672
v_mfma_f32_16x16x32_bf16 v[204:207], a[140:143], a[28:31], v[204:207]
v_mfma_f32_16x16x32_bf16 v[204:207], a[136:139], a[24:27], v[204:207]
v_mfma_f32_16x16x32_bf16 v[208:211], a[144:147], a[24:27], v[208:211]
buffer_load_dwordx4 a[88:91], v2, s[40:43], s35 offen offset:3072 sc1
v_mfma_f32_16x16x32_bf16 v[208:211], a[148:151], a[28:31], v[208:211]
v_mfma_f32_16x16x32_bf16 v[184:187], a[148:151], a[20:23], v[184:187]
v_mfma_f32_16x16x32_bf16 v[184:187], a[144:147], a[16:19], v[184:187]
v_mfma_f32_16x16x32_bf16 v[160:163], a[144:147], a[8:11], v[160:163]
v_mfma_f32_16x16x32_bf16 v[160:163], a[148:151], a[12:15], v[160:163]
buffer_load_dwordx4 a[92:95], v2, s[40:43], s33 offen offset:3072 sc1
s_add_u32 s35, s35, 8192
v_mfma_f32_16x16x32_bf16 v[136:139], a[148:151], a[4:7], v[136:139]
s_add_u32 s33, s33, 8192
v_mfma_f32_16x16x32_bf16 v[136:139], a[144:147], a[0:3], v[136:139]
v_mfma_f32_16x16x32_bf16 a[176:179], a[152:155], a[160:163], a[176:179]
s_waitcnt vmcnt(11) lgkmcnt(0)
v_mfma_f32_16x16x32_bf16 v[140:143], a[96:99], a[32:35], v[140:143]
ds_read_b128 a[128:131], v5 offset:41984
v_mfma_f32_16x16x32_bf16 v[140:143], a[100:103], a[36:39], v[140:143]
buffer_load_dwordx4 a[0:3], v2, s[40:43], s35 offen offset:0 sc1
v_mfma_f32_16x16x32_bf16 v[164:167], a[100:103], a[44:47], v[164:167]
ds_read_b128 a[132:135], v5 offset:48128
v_mfma_f32_16x16x32_bf16 v[164:167], a[96:99], a[40:43], v[164:167]
v_mfma_f32_16x16x32_bf16 v[188:191], a[96:99], a[48:51], v[188:191]
ds_read_b128 a[136:139], v5 offset:36864
v_mfma_f32_16x16x32_bf16 v[188:191], a[100:103], a[52:55], v[188:191]
buffer_load_dwordx4 v1, s[4:7], s44 offen offset:2048 sc1 lds
s_add_u32 m0, s18, 0x3000
v_mfma_f32_16x16x32_bf16 v[212:215], a[100:103], a[60:63], v[212:215]
s_add_u32 s44, s50, 0xe27000
ds_read_b128 a[140:143], v5 offset:43008
v_mfma_f32_16x16x32_bf16 v[212:215], a[96:99], a[56:59], v[212:215]
v_mfma_f32_16x16x32_bf16 v[216:219], a[104:107], a[56:59], v[216:219]
v_mfma_f32_16x16x32_bf16 v[216:219], a[108:111], a[60:63], v[216:219]
buffer_load_dwordx4 a[4:7], v2, s[40:43], s33 offen offset:0 sc1
v_mfma_f32_16x16x32_bf16 v[192:195], a[108:111], a[52:55], v[192:195]
ds_read_b128 a[144:147], v5 offset:37888
v_mfma_f32_16x16x32_bf16 v[192:195], a[104:107], a[48:51], v[192:195]
ds_read_b128 a[148:151], v5 offset:44032
v_mfma_f32_16x16x32_bf16 v[168:171], a[104:107], a[40:43], v[168:171]
v_mfma_f32_16x16x32_bf16 v[168:171], a[108:111], a[44:47], v[168:171]
buffer_load_dwordx4 a[8:11], v2, s[40:43], s35 offen offset:1024 sc1
v_mfma_f32_16x16x32_bf16 v[144:147], a[108:111], a[36:39], v[144:147]
ds_read_b128 a[152:155], v6 offset:29696
v_mfma_f32_16x16x32_bf16 v[144:147], a[104:107], a[32:35], v[144:147]
v_mfma_f32_16x16x32_bf16 v[148:151], a[112:115], a[32:35], v[148:151]
v_mfma_f32_16x16x32_bf16 v[148:151], a[116:119], a[36:39], v[148:151]
buffer_load_dwordx4 v1, s[4:7], s44 offen offset:0 sc1 lds
v_mfma_f32_16x16x32_bf16 v[172:175], a[116:119], a[44:47], v[172:175]
v_mfma_f32_16x16x32_bf16 v[172:175], a[112:115], a[40:43], v[172:175]
v_mfma_f32_16x16x32_bf16 v[196:199], a[112:115], a[48:51], v[196:199]
v_mfma_f32_16x16x32_bf16 v[196:199], a[116:119], a[52:55], v[196:199]
buffer_load_dwordx4 a[12:15], v2, s[40:43], s33 offen offset:1024 sc1
v_mfma_f32_16x16x32_bf16 v[220:223], a[116:119], a[60:63], v[220:223]
v_mfma_f32_16x16x32_bf16 v[220:223], a[112:115], a[56:59], v[220:223]
v_mfma_f32_16x16x32_bf16 a[180:183], a[120:123], a[160:163], a[180:183]
s_waitcnt lgkmcnt(0)
s_barrier
v_mfma_f32_16x16x32_bf16 v[224:227], a[128:131], a[56:59], v[224:227]
v_add_u32 v5, 98304, v1
v_add_u32 v6, s55, v5
v_mfma_f32_16x16x32_bf16 v[224:227], a[132:135], a[60:63], v[224:227]
buffer_load_dwordx4 a[16:19], v2, s[40:43], s35 offen offset:2048 sc1
v_mfma_f32_16x16x32_bf16 v[200:203], a[132:135], a[52:55], v[200:203]
ds_read_b128 a[96:99], v5 offset:2048
v_mfma_f32_16x16x32_bf16 v[200:203], a[128:131], a[48:51], v[200:203]
ds_read_b128 a[100:103], v5 offset:8192
v_mfma_f32_16x16x32_bf16 v[176:179], a[128:131], a[40:43], v[176:179]
ds_read_b128 a[104:107], v5 offset:3072
v_mfma_f32_16x16x32_bf16 v[176:179], a[132:135], a[44:47], v[176:179]
v_mfma_f32_16x16x32_bf16 v[152:155], a[132:135], a[36:39], v[152:155]
buffer_load_dwordx4 a[20:23], v2, s[40:43], s33 offen offset:2048 sc1
v_mfma_f32_16x16x32_bf16 v[152:155], a[128:131], a[32:35], v[152:155]
ds_read_b128 a[108:111], v5 offset:9216
v_mfma_f32_16x16x32_bf16 v[132:135], a[136:139], a[32:35], v[132:135]
v_mfma_f32_16x16x32_bf16 v[132:135], a[140:143], a[36:39], v[132:135]
ds_read_b128 a[112:115], v5 offset:4096
v_mfma_f32_16x16x32_bf16 v[156:159], a[140:143], a[44:47], v[156:159]
v_mfma_f32_16x16x32_bf16 v[156:159], a[136:139], a[40:43], v[156:159]
buffer_load_dwordx4 v1, s[4:7], s44 offen offset:1024 sc1 lds
v_mfma_f32_16x16x32_bf16 v[180:183], a[136:139], a[48:51], v[180:183]
ds_read_b128 a[116:119], v5 offset:10240
v_mfma_f32_16x16x32_bf16 v[180:183], a[140:143], a[52:55], v[180:183]
ds_read_b128 a[120:123], v6 offset:2048
v_mfma_f32_16x16x32_bf16 v[204:207], a[140:143], a[60:63], v[204:207]
v_mfma_f32_16x16x32_bf16 v[204:207], a[136:139], a[56:59], v[204:207]
v_mfma_f32_16x16x32_bf16 v[208:211], a[144:147], a[56:59], v[208:211]
buffer_load_dwordx4 a[24:27], v2, s[40:43], s35 offen offset:3072 sc1
v_mfma_f32_16x16x32_bf16 v[208:211], a[148:151], a[60:63], v[208:211]
v_mfma_f32_16x16x32_bf16 v[184:187], a[148:151], a[52:55], v[184:187]
v_mfma_f32_16x16x32_bf16 v[184:187], a[144:147], a[48:51], v[184:187]
v_mfma_f32_16x16x32_bf16 v[160:163], a[144:147], a[40:43], v[160:163]
v_mfma_f32_16x16x32_bf16 v[160:163], a[148:151], a[44:47], v[160:163]
buffer_load_dwordx4 a[28:31], v2, s[40:43], s33 offen offset:3072 sc1
s_add_u32 s35, s35, 8192
v_mfma_f32_16x16x32_bf16 v[136:139], a[148:151], a[36:39], v[136:139]
s_add_u32 s33, s33, 8192
v_mfma_f32_16x16x32_bf16 v[136:139], a[144:147], a[32:35], v[136:139]
v_mfma_f32_16x16x32_bf16 a[184:187], a[152:155], a[160:163], a[184:187]
s_waitcnt vmcnt(11) lgkmcnt(0)
v_mfma_f32_16x16x32_bf16 v[140:143], a[96:99], a[64:67], v[140:143]
ds_read_b128 a[128:131], v5 offset:5120
v_mfma_f32_16x16x32_bf16 v[140:143], a[100:103], a[68:71], v[140:143]
buffer_load_dwordx4 a[32:35], v2, s[40:43], s35 offen offset:0 sc1
v_mfma_f32_16x16x32_bf16 v[164:167], a[100:103], a[76:79], v[164:167]
ds_read_b128 a[132:135], v5 offset:11264
v_mfma_f32_16x16x32_bf16 v[164:167], a[96:99], a[72:75], v[164:167]
v_mfma_f32_16x16x32_bf16 v[188:191], a[96:99], a[80:83], v[188:191]
ds_read_b128 a[136:139], v5 offset:0
v_mfma_f32_16x16x32_bf16 v[188:191], a[100:103], a[84:87], v[188:191]
buffer_load_dwordx4 v1, s[4:7], s44 offen offset:2048 sc1 lds
s_add_u32 s63, s28, 20
v_mfma_f32_16x16x32_bf16 v[212:215], a[100:103], a[92:95], v[212:215]
s_lshl_b32 s63, s63, 12
ds_read_b128 a[140:143], v5 offset:6144
v_mfma_f32_16x16x32_bf16 v[212:215], a[96:99], a[88:91], v[212:215]
v_mfma_f32_16x16x32_bf16 v[216:219], a[104:107], a[88:91], v[216:219]
v_mfma_f32_16x16x32_bf16 v[216:219], a[108:111], a[92:95], v[216:219]
buffer_load_dwordx4 a[36:39], v2, s[40:43], s33 offen offset:0 sc1
v_mfma_f32_16x16x32_bf16 v[192:195], a[108:111], a[84:87], v[192:195]
ds_read_b128 a[144:147], v5 offset:1024
v_mfma_f32_16x16x32_bf16 v[192:195], a[104:107], a[80:83], v[192:195]
ds_read_b128 a[148:151], v5 offset:7168
v_mfma_f32_16x16x32_bf16 v[168:171], a[104:107], a[72:75], v[168:171]
v_mfma_f32_16x16x32_bf16 v[168:171], a[108:111], a[76:79], v[168:171]
buffer_load_dwordx4 a[40:43], v2, s[40:43], s35 offen offset:1024 sc1
v_mfma_f32_16x16x32_bf16 v[144:147], a[108:111], a[68:71], v[144:147]
ds_read_b128 a[152:155], v6 offset:3072
v_mfma_f32_16x16x32_bf16 v[144:147], a[104:107], a[64:67], v[144:147]
v_mfma_f32_16x16x32_bf16 v[148:151], a[112:115], a[64:67], v[148:151]
v_mfma_f32_16x16x32_bf16 v[148:151], a[116:119], a[68:71], v[148:151]
buffer_load_dwordx4 a[168:171], v3, s[40:43], s63 offen sc1
s_add_u32 m0, s18, 0x6000
v_mfma_f32_16x16x32_bf16 v[172:175], a[116:119], a[76:79], v[172:175]
s_add_u32 s44, s50, 0xe2a000
v_mfma_f32_16x16x32_bf16 v[172:175], a[112:115], a[72:75], v[172:175]
v_mfma_f32_16x16x32_bf16 v[196:199], a[112:115], a[80:83], v[196:199]
v_mfma_f32_16x16x32_bf16 v[196:199], a[116:119], a[84:87], v[196:199]
buffer_load_dwordx4 a[44:47], v2, s[40:43], s33 offen offset:1024 sc1
v_mfma_f32_16x16x32_bf16 v[220:223], a[116:119], a[92:95], v[220:223]
v_mfma_f32_16x16x32_bf16 v[220:223], a[112:115], a[88:91], v[220:223]
v_mfma_f32_16x16x32_bf16 a[172:175], a[120:123], a[164:167], a[172:175]
s_waitcnt lgkmcnt(0)
v_mfma_f32_16x16x32_bf16 v[224:227], a[128:131], a[88:91], v[224:227]
ds_read_b128 a[96:99], v5 offset:14336
v_mfma_f32_16x16x32_bf16 v[224:227], a[132:135], a[92:95], v[224:227]
buffer_load_dwordx4 a[48:51], v2, s[40:43], s35 offen offset:2048 sc1
v_mfma_f32_16x16x32_bf16 v[200:203], a[132:135], a[84:87], v[200:203]
ds_read_b128 a[100:103], v5 offset:20480
v_mfma_f32_16x16x32_bf16 v[200:203], a[128:131], a[80:83], v[200:203]
v_mfma_f32_16x16x32_bf16 v[176:179], a[128:131], a[72:75], v[176:179]
ds_read_b128 a[104:107], v5 offset:15360
v_mfma_f32_16x16x32_bf16 v[176:179], a[132:135], a[76:79], v[176:179]
buffer_load_dwordx4 v1, s[4:7], s44 offen offset:0 sc1 lds
v_mfma_f32_16x16x32_bf16 v[152:155], a[132:135], a[68:71], v[152:155]
ds_read_b128 a[108:111], v5 offset:21504
v_mfma_f32_16x16x32_bf16 v[152:155], a[128:131], a[64:67], v[152:155]
v_mfma_f32_16x16x32_bf16 v[132:135], a[136:139], a[64:67], v[132:135]
v_mfma_f32_16x16x32_bf16 v[132:135], a[140:143], a[68:71], v[132:135]
buffer_load_dwordx4 a[52:55], v2, s[40:43], s33 offen offset:2048 sc1
v_mfma_f32_16x16x32_bf16 v[156:159], a[140:143], a[76:79], v[156:159]
ds_read_b128 a[112:115], v5 offset:16384
v_mfma_f32_16x16x32_bf16 v[156:159], a[136:139], a[72:75], v[156:159]
ds_read_b128 a[116:119], v5 offset:22528
v_mfma_f32_16x16x32_bf16 v[180:183], a[136:139], a[80:83], v[180:183]
v_mfma_f32_16x16x32_bf16 v[180:183], a[140:143], a[84:87], v[180:183]
buffer_load_dwordx4 a[56:59], v2, s[40:43], s35 offen offset:3072 sc1
v_mfma_f32_16x16x32_bf16 v[204:207], a[140:143], a[92:95], v[204:207]
ds_read_b128 a[120:123], v6 offset:4096
v_mfma_f32_16x16x32_bf16 v[204:207], a[136:139], a[88:91], v[204:207]
v_mfma_f32_16x16x32_bf16 v[208:211], a[144:147], a[88:91], v[208:211]
v_mfma_f32_16x16x32_bf16 v[208:211], a[148:151], a[92:95], v[208:211]
buffer_load_dwordx4 v1, s[4:7], s44 offen offset:1024 sc1 lds
v_mfma_f32_16x16x32_bf16 v[184:187], a[148:151], a[84:87], v[184:187]
v_mfma_f32_16x16x32_bf16 v[184:187], a[144:147], a[80:83], v[184:187]
v_mfma_f32_16x16x32_bf16 v[160:163], a[144:147], a[72:75], v[160:163]
v_mfma_f32_16x16x32_bf16 v[160:163], a[148:151], a[76:79], v[160:163]
buffer_load_dwordx4 a[60:63], v2, s[40:43], s33 offen offset:3072 sc1
s_add_u32 s35, s35, 8192
v_mfma_f32_16x16x32_bf16 v[136:139], a[148:151], a[68:71], v[136:139]
s_add_u32 s33, s33, 8192
v_mfma_f32_16x16x32_bf16 v[136:139], a[144:147], a[64:67], v[136:139]
v_mfma_f32_16x16x32_bf16 a[176:179], a[152:155], a[164:167], a[176:179]
s_waitcnt vmcnt(12) lgkmcnt(0)
v_mfma_f32_16x16x32_bf16 v[140:143], a[96:99], a[0:3], v[140:143]
ds_read_b128 a[128:131], v5 offset:17408
v_add_f32 v92, v92, v96
v_mfma_f32_16x16x32_bf16 v[140:143], a[100:103], a[4:7], v[140:143]
buffer_load_dwordx4 a[64:67], v2, s[40:43], s35 offen offset:0 sc1
v_mfma_f32_16x16x32_bf16 v[164:167], a[100:103], a[12:15], v[164:167]
ds_read_b128 a[132:135], v5 offset:23552
v_add_f32 v100, v100, v104
v_mfma_f32_16x16x32_bf16 v[164:167], a[96:99], a[8:11], v[164:167]
v_add_f32 v108, v108, v112
v_add_f32 v116, v116, v120
v_mfma_f32_16x16x32_bf16 v[188:191], a[96:99], a[16:19], v[188:191]
ds_read_b128 a[136:139], v5 offset:12288
v_add_f32 v124, v124, v128
v_mfma_f32_16x16x32_bf16 v[188:191], a[100:103], a[20:23], v[188:191]
v_add_f32 v93, v93, v97
v_add_f32 v101, v101, v105
v_mfma_f32_16x16x32_bf16 v[212:215], a[100:103], a[28:31], v[212:215]
buffer_load_dwordx4 a[68:71], v2, s[40:43], s33 offen offset:0 sc1
v_mfma_f32_16x16x32_bf16 v[212:215], a[96:99], a[24:27], v[212:215]
ds_read_b128 a[140:143], v5 offset:18432
v_add_f32 v109, v109, v113
v_mfma_f32_16x16x32_bf16 v[216:219], a[104:107], a[24:27], v[216:219]
v_add_f32 v117, v117, v121
v_add_f32 v125, v125, v129
v_mfma_f32_16x16x32_bf16 v[216:219], a[108:111], a[28:31], v[216:219]
ds_read_b128 a[144:147], v5 offset:13312
v_add_f32 v94, v94, v98
v_mfma_f32_16x16x32_bf16 v[192:195], a[108:111], a[20:23], v[192:195]
v_add_f32 v102, v102, v106
v_add_f32 v110, v110, v114
v_mfma_f32_16x16x32_bf16 v[192:195], a[104:107], a[16:19], v[192:195]
buffer_load_dwordx4 v1, s[4:7], s44 offen offset:2048 sc1 lds
s_add_u32 m0, s18, 0x9000
v_mfma_f32_16x16x32_bf16 v[168:171], a[104:107], a[8:11], v[168:171]
s_add_u32 s44, s50, 0xe2d000
ds_read_b128 a[148:151], v5 offset:19456
v_mfma_f32_16x16x32_bf16 v[168:171], a[108:111], a[12:15], v[168:171]
ds_read_b128 a[152:155], v6 offset:5120
v_add_f32 v118, v118, v122
v_mfma_f32_16x16x32_bf16 v[144:147], a[108:111], a[4:7], v[144:147]
v_add_f32 v126, v126, v130
v_add_f32 v95, v95, v99
v_mfma_f32_16x16x32_bf16 v[144:147], a[104:107], a[0:3], v[144:147]
v_add_f32 v103, v103, v107
v_add_f32 v111, v111, v115
v_mfma_f32_16x16x32_bf16 v[148:151], a[112:115], a[0:3], v[148:151]
buffer_load_dwordx4 a[72:75], v2, s[40:43], s35 offen offset:1024 sc1
v_mfma_f32_16x16x32_bf16 v[148:151], a[116:119], a[4:7], v[148:151]
v_add_f32 v119, v119, v123
v_add_f32 v127, v127, v131
v_mfma_f32_16x16x32_bf16 v[172:175], a[116:119], a[12:15], v[172:175]
v_add_f32_dpp v92, v92, v92 row_ror:8 row_mask:0xf bank_mask:0xf
v_add_f32_dpp v100, v100, v100 row_ror:8 row_mask:0xf bank_mask:0xf
v_mfma_f32_16x16x32_bf16 v[172:175], a[112:115], a[8:11], v[172:175]
v_add_f32_dpp v108, v108, v108 row_ror:8 row_mask:0xf bank_mask:0xf
v_add_f32_dpp v116, v116, v116 row_ror:8 row_mask:0xf bank_mask:0xf
v_mfma_f32_16x16x32_bf16 v[196:199], a[112:115], a[16:19], v[196:199]
v_add_f32_dpp v124, v124, v124 row_ror:8 row_mask:0xf bank_mask:0xf
v_add_f32_dpp v93, v93, v93 row_ror:8 row_mask:0xf bank_mask:0xf
v_mfma_f32_16x16x32_bf16 v[196:199], a[116:119], a[20:23], v[196:199]
buffer_load_dwordx4 a[76:79], v2, s[40:43], s33 offen offset:1024 sc1
v_mfma_f32_16x16x32_bf16 v[220:223], a[116:119], a[28:31], v[220:223]
v_add_f32_dpp v101, v101, v101 row_ror:8 row_mask:0xf bank_mask:0xf
v_add_f32_dpp v109, v109, v109 row_ror:8 row_mask:0xf bank_mask:0xf
v_mfma_f32_16x16x32_bf16 v[220:223], a[112:115], a[24:27], v[220:223]
v_add_f32_dpp v117, v117, v117 row_ror:8 row_mask:0xf bank_mask:0xf
v_add_f32_dpp v125, v125, v125 row_ror:8 row_mask:0xf bank_mask:0xf
v_mfma_f32_16x16x32_bf16 a[180:183], a[120:123], a[164:167], a[180:183]
s_waitcnt lgkmcnt(0)
s_barrier
v_mfma_f32_16x16x32_bf16 v[224:227], a[128:131], a[24:27], v[224:227]
ds_read_b128 a[96:99], v5 offset:26624
v_add_f32_dpp v92, v94, v94 row_ror:8 row_mask:0xf bank_mask:0xc
v_mfma_f32_16x16x32_bf16 v[224:227], a[132:135], a[28:31], v[224:227]
buffer_load_dwordx4 a[80:83], v2, s[40:43], s35 offen offset:2048 sc1
v_mfma_f32_16x16x32_bf16 v[200:203], a[132:135], a[20:23], v[200:203]
ds_read_b128 a[100:103], v5 offset:32768
v_add_f32_dpp v100, v102, v102 row_ror:8 row_mask:0xf bank_mask:0xc
v_mfma_f32_16x16x32_bf16 v[200:203], a[128:131], a[16:19], v[200:203]
v_add_f32_dpp v108, v110, v110 row_ror:8 row_mask:0xf bank_mask:0xc
v_add_f32_dpp v116, v118, v118 row_ror:8 row_mask:0xf bank_mask:0xc
v_mfma_f32_16x16x32_bf16 v[176:179], a[128:131], a[8:11], v[176:179]
ds_read_b128 a[104:107], v5 offset:27648
v_add_f32_dpp v124, v126, v126 row_ror:8 row_mask:0xf bank_mask:0xc
v_mfma_f32_16x16x32_bf16 v[176:179], a[132:135], a[12:15], v[176:179]
buffer_load_dwordx4 v1, s[4:7], s44 offen offset:0 sc1 lds
v_mfma_f32_16x16x32_bf16 v[152:155], a[132:135], a[4:7], v[152:155]
ds_read_b128 a[108:111], v5 offset:33792
v_add_f32_dpp v93, v95, v95 row_ror:8 row_mask:0xf bank_mask:0xc
v_mfma_f32_16x16x32_bf16 v[152:155], a[128:131], a[0:3], v[152:155]
v_add_f32_dpp v101, v103, v103 row_ror:8 row_mask:0xf bank_mask:0xc
v_add_f32_dpp v109, v111, v111 row_ror:8 row_mask:0xf bank_mask:0xc
v_mfma_f32_16x16x32_bf16 v[132:135], a[136:139], a[0:3], v[132:135]
v_add_f32_dpp v117, v119, v119 row_ror:8 row_mask:0xf bank_mask:0xc
v_add_f32_dpp v125, v127, v127 row_ror:8 row_mask:0xf bank_mask:0xc
v_mfma_f32_16x16x32_bf16 v[132:135], a[140:143], a[4:7], v[132:135]
buffer_load_dwordx4 a[84:87], v2, s[40:43], s33 offen offset:2048 sc1
v_mfma_f32_16x16x32_bf16 v[156:159], a[140:143], a[12:15], v[156:159]
ds_read_b128 a[112:115], v5 offset:28672
v_mfma_f32_16x16x32_bf16 v[156:159], a[136:139], a[8:11], v[156:159]
ds_read_b128 a[116:119], v5 offset:34816
v_mfma_f32_16x16x32_bf16 v[180:183], a[136:139], a[16:19], v[180:183]
v_permlane32_swap_b32 v92, v93
v_mfma_f32_16x16x32_bf16 v[180:183], a[140:143], a[20:23], v[180:183]
buffer_load_dwordx4 a[88:91], v2, s[40:43], s35 offen offset:3072 sc1
v_mfma_f32_16x16x32_bf16 v[204:207], a[140:143], a[28:31], v[204:207]
ds_read_b128 a[120:123], v6 offset:26624
v_mfma_f32_16x16x32_bf16 v[204:207], a[136:139], a[24:27], v[204:207]
v_permlane32_swap_b32 v100, v101
v_mfma_f32_16x16x32_bf16 v[208:211], a[144:147], a[24:27], v[208:211]
v_permlane32_swap_b32 v108, v109
v_mfma_f32_16x16x32_bf16 v[208:211], a[148:151], a[28:31], v[208:211]
buffer_load_dwordx4 v1, s[4:7], s44 offen offset:1024 sc1 lds
s_add_u32 s63, s28, 24
v_mfma_f32_16x16x32_bf16 v[184:187], a[148:151], a[20:23], v[184:187]
s_lshl_b32 s63, s63, 12
v_mfma_f32_16x16x32_bf16 v[184:187], a[144:147], a[16:19], v[184:187]
v_permlane32_swap_b32 v116, v117
v_mfma_f32_16x16x32_bf16 v[160:163], a[144:147], a[8:11], v[160:163]
v_permlane32_swap_b32 v124, v125
v_mfma_f32_16x16x32_bf16 v[160:163], a[148:151], a[12:15], v[160:163]
buffer_load_dwordx4 a[92:95], v2, s[40:43], s33 offen offset:3072 sc1
s_add_u32 s35, s35, 8192
v_mfma_f32_16x16x32_bf16 v[136:139], a[148:151], a[4:7], v[136:139]
s_add_u32 s33, s33, 8192
v_add_f32 v92, v92, v93
v_mfma_f32_16x16x32_bf16 v[136:139], a[144:147], a[0:3], v[136:139]
v_add_f32 v100, v100, v101
v_add_f32 v108, v108, v109
v_mfma_f32_16x16x32_bf16 a[184:187], a[152:155], a[164:167], a[184:187]
v_add_f32 v116, v116, v117
s_waitcnt vmcnt(11) lgkmcnt(0)
v_mfma_f32_16x16x32_bf16 v[140:143], a[96:99], a[32:35], v[140:143]
ds_read_b128 a[128:131], v5 offset:29696
v_add_f32 v124, v124, v125
v_mfma_f32_16x16x32_bf16 v[140:143], a[100:103], a[36:39], v[140:143]
buffer_load_dwordx4 a[0:3], v2, s[40:43], s35 offen offset:0 sc1
v_mfma_f32_16x16x32_bf16 v[164:167], a[100:103], a[44:47], v[164:167]
ds_read_b128 a[132:135], v5 offset:35840
v_mov_b32 v94, v92
v_mfma_f32_16x16x32_bf16 v[164:167], a[96:99], a[40:43], v[164:167]
v_mov_b32 v102, v100
v_mov_b32 v110, v108
v_mfma_f32_16x16x32_bf16 v[188:191], a[96:99], a[48:51], v[188:191]
ds_read_b128 a[136:139], v5 offset:24576
v_mov_b32 v118, v116
v_mfma_f32_16x16x32_bf16 v[188:191], a[100:103], a[52:55], v[188:191]
v_mov_b32 v126, v124
v_mfma_f32_16x16x32_bf16 v[212:215], a[100:103], a[60:63], v[212:215]
buffer_load_dwordx4 a[4:7], v2, s[40:43], s33 offen offset:0 sc1
v_mfma_f32_16x16x32_bf16 v[212:215], a[96:99], a[56:59], v[212:215]
ds_read_b128 a[140:143], v5 offset:30720
v_mfma_f32_16x16x32_bf16 v[216:219], a[104:107], a[56:59], v[216:219]
v_permlane16_swap_b32 v92, v94
v_mfma_f32_16x16x32_bf16 v[216:219], a[108:111], a[60:63], v[216:219]
ds_read_b128 a[144:147], v5 offset:25600
v_mfma_f32_16x16x32_bf16 v[192:195], a[108:111], a[52:55], v[192:195]
v_permlane16_swap_b32 v100, v102
v_mfma_f32_16x16x32_bf16 v[192:195], a[104:107], a[48:51], v[192:195]
buffer_load_dwordx4 a[160:163], v3, s[40:43], s63 offen sc1
v_mfma_f32_16x16x32_bf16 v[168:171], a[104:107], a[40:43], v[168:171]
ds_read_b128 a[148:151], v5 offset:31744
v_mfma_f32_16x16x32_bf16 v[168:171], a[108:111], a[44:47], v[168:171]
ds_read_b128 a[152:155], v6 offset:27648
v_mfma_f32_16x16x32_bf16 v[144:147], a[108:111], a[36:39], v[144:147]
v_permlane16_swap_b32 v108, v110
v_mfma_f32_16x16x32_bf16 v[144:147], a[104:107], a[32:35], v[144:147]
v_permlane16_swap_b32 v116, v118
v_mfma_f32_16x16x32_bf16 v[148:151], a[112:115], a[32:35], v[148:151]
buffer_load_dwordx4 a[8:11], v2, s[40:43], s35 offen offset:1024 sc1
v_mfma_f32_16x16x32_bf16 v[148:151], a[116:119], a[36:39], v[148:151]
v_permlane16_swap_b32 v124, v126
v_mfma_f32_16x16x32_bf16 v[172:175], a[116:119], a[44:47], v[172:175]
v_add_f32 v92, v92, v94
v_add_f32 v100, v100, v102
v_mfma_f32_16x16x32_bf16 v[172:175], a[112:115], a[40:43], v[172:175]
v_add_f32 v108, v108, v110
v_add_f32 v116, v116, v118
v_mfma_f32_16x16x32_bf16 v[196:199], a[112:115], a[48:51], v[196:199]
v_add_f32 v124, v124, v126
v_mov_b32 v94, v92
v_mfma_f32_16x16x32_bf16 v[196:199], a[116:119], a[52:55], v[196:199]
buffer_load_dwordx4 a[12:15], v2, s[40:43], s33 offen offset:1024 sc1
v_mfma_f32_16x16x32_bf16 v[220:223], a[116:119], a[60:63], v[220:223]
v_mov_b32 v102, v100
v_mov_b32 v110, v108
v_mfma_f32_16x16x32_bf16 v[220:223], a[112:115], a[56:59], v[220:223]
v_mov_b32 v118, v116
v_mov_b32 v126, v124
v_mfma_f32_16x16x32_bf16 a[172:175], a[120:123], a[168:171], a[172:175]
s_waitcnt lgkmcnt(0)
v_mfma_f32_16x16x32_bf16 v[224:227], a[128:131], a[56:59], v[224:227]
ds_read_b128 a[96:99], v5 offset:38912
v_mfma_f32_16x16x32_bf16 v[224:227], a[132:135], a[60:63], v[224:227]
buffer_load_dwordx4 a[16:19], v2, s[40:43], s35 offen offset:2048 sc1
v_mfma_f32_16x16x32_bf16 v[200:203], a[132:135], a[52:55], v[200:203]
ds_read_b128 a[100:103], v5 offset:45056
v_mfma_f32_16x16x32_bf16 v[200:203], a[128:131], a[48:51], v[200:203]
v_permlane32_swap_b32 v92, v94
v_mfma_f32_16x16x32_bf16 v[176:179], a[128:131], a[40:43], v[176:179]
ds_read_b128 a[104:107], v5 offset:39936
v_mfma_f32_16x16x32_bf16 v[176:179], a[132:135], a[44:47], v[176:179]
buffer_load_dwordx4 v1, s[4:7], s44 offen offset:2048 sc1 lds
s_add_u32 s63, s28, 28
v_mfma_f32_16x16x32_bf16 v[152:155], a[132:135], a[36:39], v[152:155]
s_lshl_b32 s63, s63, 12
ds_read_b128 a[108:111], v5 offset:46080
v_mfma_f32_16x16x32_bf16 v[152:155], a[128:131], a[32:35], v[152:155]
v_permlane32_swap_b32 v100, v102
v_mfma_f32_16x16x32_bf16 v[132:135], a[136:139], a[32:35], v[132:135]
v_permlane32_swap_b32 v108, v110
v_mfma_f32_16x16x32_bf16 v[132:135], a[140:143], a[36:39], v[132:135]
buffer_load_dwordx4 a[20:23], v2, s[40:43], s33 offen offset:2048 sc1
v_mfma_f32_16x16x32_bf16 v[156:159], a[140:143], a[44:47], v[156:159]
ds_read_b128 a[112:115], v5 offset:40960
v_mfma_f32_16x16x32_bf16 v[156:159], a[136:139], a[40:43], v[156:159]
ds_read_b128 a[116:119], v5 offset:47104
v_mfma_f32_16x16x32_bf16 v[180:183], a[136:139], a[48:51], v[180:183]
v_permlane32_swap_b32 v116, v118
v_mfma_f32_16x16x32_bf16 v[180:183], a[140:143], a[52:55], v[180:183]
buffer_load_dwordx4 a[24:27], v2, s[40:43], s35 offen offset:3072 sc1
v_mfma_f32_16x16x32_bf16 v[204:207], a[140:143], a[60:63], v[204:207]
ds_read_b128 a[120:123], v6 offset:28672
v_mfma_f32_16x16x32_bf16 v[204:207], a[136:139], a[56:59], v[204:207]
v_permlane32_swap_b32 v124, v126
v_mfma_f32_16x16x32_bf16 v[208:211], a[144:147], a[56:59], v[208:211]
v_mul_f32 v82, 0xba800000, v92
v_mul_f32 v84, 0xba800000, v100
v_mfma_f32_16x16x32_bf16 v[208:211], a[148:151], a[60:63], v[208:211]
buffer_load_dwordx4 a[164:167], v3, s[40:43], s63 offen sc1
s_add_u32 m0, s19, 49152
v_mfma_f32_16x16x32_bf16 v[184:187], a[148:151], a[52:55], v[184:187]
s_add_u32 s44, s85, 0xa04000
v_mul_f32 v86, 0xba800000, v108
v_mfma_f32_16x16x32_bf16 v[184:187], a[144:147], a[48:51], v[184:187]
v_mul_f32 v88, 0xba800000, v116
v_mul_f32 v90, 0xba800000, v124
v_mfma_f32_16x16x32_bf16 v[160:163], a[144:147], a[40:43], v[160:163]
v_mul_f32 v94, 0x3a800000, v94
v_mul_f32 v102, 0x3a800000, v102
v_mfma_f32_16x16x32_bf16 v[160:163], a[148:151], a[44:47], v[160:163]
buffer_load_dwordx4 a[28:31], v2, s[40:43], s33 offen offset:3072 sc1
s_add_u32 s35, s35, 8192
v_mfma_f32_16x16x32_bf16 v[136:139], a[148:151], a[36:39], v[136:139]
s_add_u32 s33, s33, 8192
v_mul_f32 v110, 0x3a800000, v110
v_mfma_f32_16x16x32_bf16 v[136:139], a[144:147], a[32:35], v[136:139]
v_mul_f32 v118, 0x3a800000, v118
v_mul_f32 v126, 0x3a800000, v126
v_mfma_f32_16x16x32_bf16 a[176:179], a[152:155], a[168:171], a[176:179]
v_fma_f32 v94, -v82, v82, v94
s_waitcnt vmcnt(11) lgkmcnt(0)
v_mfma_f32_16x16x32_bf16 v[140:143], a[96:99], a[64:67], v[140:143]
ds_read_b128 a[128:131], v5 offset:41984
v_fma_f32 v102, -v84, v84, v102
v_mfma_f32_16x16x32_bf16 v[140:143], a[100:103], a[68:71], v[140:143]
buffer_load_dwordx4 a[32:35], v2, s[40:43], s35 offen offset:0 sc1
v_mfma_f32_16x16x32_bf16 v[164:167], a[100:103], a[76:79], v[164:167]
ds_read_b128 a[132:135], v5 offset:48128
v_fma_f32 v110, -v86, v86, v110
v_mfma_f32_16x16x32_bf16 v[164:167], a[96:99], a[72:75], v[164:167]
v_fma_f32 v118, -v88, v88, v118
v_fma_f32 v126, -v90, v90, v126
v_mfma_f32_16x16x32_bf16 v[188:191], a[96:99], a[80:83], v[188:191]
ds_read_b128 a[136:139], v5 offset:36864
v_max_f32 v94, 0, v94
v_mfma_f32_16x16x32_bf16 v[188:191], a[100:103], a[84:87], v[188:191]
v_max_f32 v102, 0, v102
v_max_f32 v110, 0, v110
v_mfma_f32_16x16x32_bf16 v[212:215], a[100:103], a[92:95], v[212:215]
buffer_load_dwordx4 a[36:39], v2, s[40:43], s33 offen offset:0 sc1
v_mfma_f32_16x16x32_bf16 v[212:215], a[96:99], a[88:91], v[212:215]
ds_read_b128 a[140:143], v5 offset:43008
v_max_f32 v118, 0, v118
v_max_f32 v126, 0, v126
v_add_f32 v94, 0x3727c5ac, v94
v_add_f32 v102, 0x3727c5ac, v102
v_add_f32 v110, 0x3727c5ac, v110
v_add_f32 v118, 0x3727c5ac, v118
v_add_f32 v126, 0x3727c5ac, v126
v_rsq_f32 v83, v94
v_rsq_f32 v85, v102
v_rsq_f32 v87, v110
v_rsq_f32 v89, v118
v_rsq_f32 v91, v126
v_mfma_f32_16x16x32_bf16 v[216:219], a[104:107], a[88:91], v[216:219]
v_mfma_f32_16x16x32_bf16 v[216:219], a[108:111], a[92:95], v[216:219]
ds_read_b128 a[144:147], v5 offset:37888
v_mfma_f32_16x16x32_bf16 v[192:195], a[108:111], a[84:87], v[192:195]
v_fmac_f32 v140, v56, v82
v_mfma_f32_16x16x32_bf16 v[192:195], a[104:107], a[80:83], v[192:195]
buffer_load_dwordx4 v1, s[4:7], s44 offen offset:0 sc1 lds
v_mfma_f32_16x16x32_bf16 v[168:171], a[104:107], a[72:75], v[168:171]
ds_read_b128 a[148:151], v5 offset:44032
v_fmac_f32 v164, v56, v84
v_mfma_f32_16x16x32_bf16 v[168:171], a[108:111], a[76:79], v[168:171]
ds_read_b128 a[152:155], v6 offset:29696
L_stub12:
s_cbranch_execz L_stub13
v_mfma_f32_16x16x32_bf16 v[144:147], a[108:111], a[68:71], v[144:147]
v_fmac_f32 v188, v56, v86
v_mfma_f32_16x16x32_bf16 v[144:147], a[104:107], a[64:67], v[144:147]
v_mfma_f32_16x16x32_bf16 v[148:151], a[112:115], a[64:67], v[148:151]
buffer_load_dwordx4 a[40:43], v2, s[40:43], s35 offen offset:1024 sc1
v_mfma_f32_16x16x32_bf16 v[148:151], a[116:119], a[68:71], v[148:151]
v_fmac_f32 v212, v56, v88
v_mfma_f32_16x16x32_bf16 v[172:175], a[116:119], a[76:79], v[172:175]
v_fmac_f32 v216, v60, v88
v_mfma_f32_16x16x32_bf16 v[172:175], a[112:115], a[72:75], v[172:175]
v_mfma_f32_16x16x32_bf16 v[196:199], a[112:115], a[80:83], v[196:199]
v_fmac_f32 v192, v60, v86
v_mfma_f32_16x16x32_bf16 v[196:199], a[116:119], a[84:87], v[196:199]
buffer_load_dwordx4 a[44:47], v2, s[40:43], s33 offen offset:1024 sc1
v_mfma_f32_16x16x32_bf16 v[220:223], a[116:119], a[92:95], v[220:223]
v_fmac_f32 v168, v60, v84
v_fmac_f32 v141, v57, v82
v_mfma_f32_16x16x32_bf16 v[220:223], a[112:115], a[88:91], v[220:223]
v_mfma_f32_16x16x32_bf16 a[180:183], a[120:123], a[168:171], a[180:183]
s_waitcnt vmcnt(9) lgkmcnt(0)
s_barrier
v_mfma_f32_16x16x32_bf16 v[224:227], a[128:131], a[88:91], v[224:227]
v_add_u32 v5, 0, v1
v_add_u32 v6, s55, v5
v_mfma_f32_16x16x32_bf16 v[224:227], a[132:135], a[92:95], v[224:227]
buffer_load_dwordx4 a[48:51], v2, s[40:43], s35 offen offset:2048 sc1
v_mfma_f32_16x16x32_bf16 v[200:203], a[132:135], a[84:87], v[200:203]
ds_read_b128 a[96:99], v5 offset:2048
v_fmac_f32 v144, v60, v82
v_mfma_f32_16x16x32_bf16 v[200:203], a[128:131], a[80:83], v[200:203]
ds_read_b128 a[100:103], v5 offset:8192
v_fmac_f32 v148, v64, v82
v_mfma_f32_16x16x32_bf16 v[176:179], a[128:131], a[72:75], v[176:179]
ds_read_b128 a[104:107], v5 offset:3072
v_fmac_f32 v172, v64, v84
v_mfma_f32_16x16x32_bf16 v[176:179], a[132:135], a[76:79], v[176:179]
v_fmac_f32 v196, v64, v86
v_fmac_f32 v165, v57, v84
v_mfma_f32_16x16x32_bf16 v[152:155], a[132:135], a[68:71], v[152:155]
buffer_load_dwordx4 a[52:55], v2, s[40:43], s33 offen offset:2048 sc1
v_mfma_f32_16x16x32_bf16 v[152:155], a[128:131], a[64:67], v[152:155]
ds_read_b128 a[108:111], v5 offset:9216
v_fmac_f32 v220, v64, v88
v_mfma_f32_16x16x32_bf16 v[132:135], a[136:139], a[64:67], v[132:135]
ds_read_b128 a[112:115], v5 offset:4096
v_fmac_f32 v189, v57, v86
v_mfma_f32_16x16x32_bf16 v[132:135], a[140:143], a[68:71], v[132:135]
v_fmac_f32 v213, v57, v88
v_fmac_f32 v217, v61, v88
v_mfma_f32_16x16x32_bf16 v[156:159], a[140:143], a[76:79], v[156:159]
ds_read_b128 a[116:119], v5 offset:10240
v_fmac_f32 v224, v68, v88
v_mfma_f32_16x16x32_bf16 v[156:159], a[136:139], a[72:75], v[156:159]
buffer_load_dwordx4 v1, s[4:7], s44 offen offset:1024 sc1 lds
v_mfma_f32_16x16x32_bf16 v[180:183], a[136:139], a[80:83], v[180:183]
ds_read_b128 a[120:123], v6 offset:2048
v_fmac_f32 v200, v68, v86
v_mfma_f32_16x16x32_bf16 v[180:183], a[140:143], a[84:87], v[180:183]
v_fmac_f32 v193, v61, v86
v_fmac_f32 v169, v61, v84
v_mfma_f32_16x16x32_bf16 v[204:207], a[140:143], a[92:95], v[204:207]
ds_read_b128 a[124:127], v6 offset:26624
v_fmac_f32 v176, v68, v84
v_mfma_f32_16x16x32_bf16 v[204:207], a[136:139], a[88:91], v[204:207]
v_fmac_f32 v145, v61, v82
v_fmac_f32 v149, v65, v82
v_mfma_f32_16x16x32_bf16 v[208:211], a[144:147], a[88:91], v[208:211]
buffer_load_dwordx4 a[56:59], v2, s[40:43], s35 offen offset:3072 sc1
v_mfma_f32_16x16x32_bf16 v[208:211], a[148:151], a[92:95], v[208:211]
v_fmac_f32 v152, v68, v82
v_fmac_f32 v173, v65, v84
v_mfma_f32_16x16x32_bf16 v[184:187], a[148:151], a[84:87], v[184:187]
v_fmac_f32 v132, v48, v82
v_fmac_f32 v197, v65, v86
v_mfma_f32_16x16x32_bf16 v[184:187], a[144:147], a[80:83], v[184:187]
v_fmac_f32 v221, v65, v88
v_mfma_f32_16x16x32_bf16 v[160:163], a[144:147], a[72:75], v[160:163]
v_fmac_f32 v156, v48, v84
v_mfma_f32_16x16x32_bf16 v[160:163], a[148:151], a[76:79], v[160:163]
buffer_load_dwordx4 a[60:63], v2, s[40:43], s33 offen offset:3072 sc1
s_add_u32 s35, s35, 8192
v_mfma_f32_16x16x32_bf16 v[136:139], a[148:151], a[68:71], v[136:139]
s_add_u32 s33, s33, 8192
v_fmac_f32 v180, v48, v86
v_mfma_f32_16x16x32_bf16 v[136:139], a[144:147], a[64:67], v[136:139]
v_fmac_f32 v225, v69, v88
v_mfma_f32_16x16x32_bf16 a[184:187], a[152:155], a[168:171], a[184:187]
v_fmac_f32 v204, v48, v88
s_waitcnt vmcnt(10) lgkmcnt(0)
v_mfma_f32_16x16x32_bf16 v[140:143], a[96:99], a[0:3], v[140:143]
ds_read_b128 a[128:131], v5 offset:5120
v_fmac_f32 v201, v69, v86
v_mfma_f32_16x16x32_bf16 v[140:143], a[100:103], a[4:7], v[140:143]
buffer_load_dwordx4 a[64:67], v2, s[40:43], s35 offen offset:0 sc1
s_lshl_b32 s37, s28, 10
v_mfma_f32_16x16x32_bf16 v[164:167], a[100:103], a[12:15], v[164:167]
ds_read_b128 a[132:135], v5 offset:11264
v_fmac_f32 v208, v52, v88
v_mfma_f32_16x16x32_bf16 v[164:167], a[96:99], a[8:11], v[164:167]
v_fmac_f32 v184, v52, v86
v_fmac_f32 v177, v69, v84
v_mfma_f32_16x16x32_bf16 v[188:191], a[96:99], a[16:19], v[188:191]
ds_read_b128 a[136:139], v5 offset:0
v_fmac_f32 v153, v69, v82
v_mfma_f32_16x16x32_bf16 v[188:191], a[100:103], a[20:23], v[188:191]
buffer_load_dwordx4 a[68:71], v2, s[40:43], s33 offen offset:0 sc1
s_lshl_b32 s72, s30, 12
v_mfma_f32_16x16x32_bf16 v[212:215], a[100:103], a[28:31], v[212:215]
ds_read_b128 a[140:143], v5 offset:6144
v_fmac_f32 v160, v52, v84
v_mfma_f32_16x16x32_bf16 v[212:215], a[96:99], a[24:27], v[212:215]
v_fmac_f32 v136, v52, v82
v_fmac_f32 v133, v49, v82
v_mfma_f32_16x16x32_bf16 v[216:219], a[104:107], a[24:27], v[216:219]
ds_read_b128 a[144:147], v5 offset:1024
v_fmac_f32 v157, v49, v84
v_mfma_f32_16x16x32_bf16 v[216:219], a[108:111], a[28:31], v[216:219]
buffer_load_dwordx4 a[72:75], v2, s[40:43], s35 offen offset:1024 sc1
s_add_u32 s72, s72, 0x1e00000
v_mfma_f32_16x16x32_bf16 v[192:195], a[108:111], a[20:23], v[192:195]
ds_read_b128 a[148:151], v5 offset:7168
v_fmac_f32 v181, v49, v86
v_mfma_f32_16x16x32_bf16 v[192:195], a[104:107], a[16:19], v[192:195]
v_fmac_f32 v205, v49, v88
v_fmac_f32 v142, v58, v82
v_mfma_f32_16x16x32_bf16 v[168:171], a[104:107], a[8:11], v[168:171]
ds_read_b128 a[152:155], v6 offset:3072
v_fmac_f32 v166, v58, v84
v_mfma_f32_16x16x32_bf16 v[168:171], a[108:111], a[12:15], v[168:171]
v_fmac_f32 v209, v53, v88
v_add_u32 v233, s37, v1
v_mfma_f32_16x16x32_bf16 v[144:147], a[108:111], a[4:7], v[144:147]
buffer_load_dwordx4 a[76:79], v2, s[40:43], s33 offen offset:1024 sc1
v_mfma_f32_16x16x32_bf16 v[144:147], a[104:107], a[0:3], v[144:147]
ds_read_b128 a[156:159], v6 offset:27648
v_fmac_f32 v185, v53, v86
v_mfma_f32_16x16x32_bf16 v[148:151], a[112:115], a[0:3], v[148:151]
v_fmac_f32 v190, v58, v86
v_fmac_f32 v214, v58, v88
v_mfma_f32_16x16x32_bf16 v[148:151], a[116:119], a[4:7], v[148:151]
v_fmac_f32 v161, v53, v84
v_add_u32 v232, s19, v7
v_mfma_f32_16x16x32_bf16 v[172:175], a[116:119], a[12:15], v[172:175]
buffer_load_dwordx4 a[80:83], v2, s[40:43], s35 offen offset:2048 sc1
v_mfma_f32_16x16x32_bf16 v[172:175], a[112:115], a[8:11], v[172:175]
v_fmac_f32 v137, v53, v82
v_fmac_f32 v218, v62, v88
v_mfma_f32_16x16x32_bf16 v[196:199], a[112:115], a[16:19], v[196:199]
v_fmac_f32 v194, v62, v86
v_add_u32 v248, s19, v8
v_mfma_f32_16x16x32_bf16 v[196:199], a[116:119], a[20:23], v[196:199]
v_mfma_f32_16x16x32_bf16 v[220:223], a[116:119], a[28:31], v[220:223]
buffer_load_dwordx4 a[84:87], v2, s[40:43], s33 offen offset:2048 sc1
v_mfma_f32_16x16x32_bf16 v[220:223], a[112:115], a[24:27], v[220:223]
v_fmac_f32 v170, v62, v84
v_fmac_f32 v143, v59, v82
v_mfma_f32_16x16x32_bf16 a[172:175], a[120:123], a[160:163], a[172:175]
v_fmac_f32 v146, v62, v82
v_fmac_f32 v167, v59, v84
v_mfma_f32_16x16x32_bf16 a[172:175], a[124:127], a[164:167], a[172:175]
s_waitcnt lgkmcnt(0)
v_mfma_f32_16x16x32_bf16 v[224:227], a[128:131], a[24:27], v[224:227]
ds_read_b128 a[96:99], v5 offset:14336
v_fmac_f32 v150, v66, v82
v_mfma_f32_16x16x32_bf16 v[224:227], a[132:135], a[28:31], v[224:227]
buffer_load_dwordx4 a[88:91], v2, s[40:43], s35 offen offset:3072 sc1
v_mfma_f32_16x16x32_bf16 v[200:203], a[132:135], a[20:23], v[200:203]
ds_read_b128 a[100:103], v5 offset:20480
v_fmac_f32 v174, v66, v84
v_mfma_f32_16x16x32_bf16 v[200:203], a[128:131], a[16:19], v[200:203]
v_fmac_f32 v191, v59, v86
v_fmac_f32 v215, v59, v88
v_mfma_f32_16x16x32_bf16 v[176:179], a[128:131], a[8:11], v[176:179]
ds_read_b128 a[104:107], v5 offset:15360
v_fmac_f32 v198, v66, v86
v_mfma_f32_16x16x32_bf16 v[176:179], a[132:135], a[12:15], v[176:179]
v_fmac_f32 v219, v63, v88
v_mfma_f32_16x16x32_bf16 v[152:155], a[132:135], a[4:7], v[152:155]
buffer_load_dwordx4 v1, s[4:7], s44 offen offset:2048 sc1 lds
v_mfma_f32_16x16x32_bf16 v[152:155], a[128:131], a[0:3], v[152:155]
ds_read_b128 a[108:111], v5 offset:21504
v_fmac_f32 v222, v66, v88
v_mfma_f32_16x16x32_bf16 v[132:135], a[136:139], a[0:3], v[132:135]
ds_read_b128 a[112:115], v5 offset:16384
v_fmac_f32 v195, v63, v86
v_mfma_f32_16x16x32_bf16 v[132:135], a[140:143], a[4:7], v[132:135]
v_fmac_f32 v171, v63, v84
v_mfma_f32_16x16x32_bf16 v[156:159], a[140:143], a[12:15], v[156:159]
ds_read_b128 a[116:119], v5 offset:22528
v_fmac_f32 v226, v70, v88
v_mfma_f32_16x16x32_bf16 v[156:159], a[136:139], a[8:11], v[156:159]
buffer_load_dwordx4 v1, s[4:7], s44 offen offset:3072 sc1 lds
s_add_u32 m0, s19, 65536
v_mfma_f32_16x16x32_bf16 v[180:183], a[136:139], a[16:19], v[180:183]
s_add_u32 s44, s84, 0xa08000
ds_read_b128 a[120:123], v6 offset:4096
v_mfma_f32_16x16x32_bf16 v[180:183], a[140:143], a[20:23], v[180:183]
v_fmac_f32 v202, v70, v86
v_fmac_f32 v147, v63, v82
v_mfma_f32_16x16x32_bf16 v[204:207], a[140:143], a[28:31], v[204:207]
ds_read_b128 a[124:127], v6 offset:28672
v_fmac_f32 v178, v70, v84
v_mfma_f32_16x16x32_bf16 v[204:207], a[136:139], a[24:27], v[204:207]
v_fmac_f32 v151, v67, v82
v_fmac_f32 v175, v67, v84
v_mfma_f32_16x16x32_bf16 v[208:211], a[144:147], a[24:27], v[208:211]
buffer_load_dwordx4 a[92:95], v2, s[40:43], s33 offen offset:3072 sc1
s_add_u32 s35, s35, 8192
v_mfma_f32_16x16x32_bf16 v[208:211], a[148:151], a[28:31], v[208:211]
s_add_u32 s33, s33, 8192
v_fmac_f32 v154, v70, v82
v_mfma_f32_16x16x32_bf16 v[184:187], a[148:151], a[20:23], v[184:187]
v_fmac_f32 v134, v50, v82
v_fmac_f32 v199, v67, v86
v_mfma_f32_16x16x32_bf16 v[184:187], a[144:147], a[16:19], v[184:187]
v_fmac_f32 v223, v67, v88
v_mfma_f32_16x16x32_bf16 v[160:163], a[144:147], a[8:11], v[160:163]
v_fmac_f32 v158, v50, v84
v_mfma_f32_16x16x32_bf16 v[160:163], a[148:151], a[12:15], v[160:163]
buffer_load_dwordx4 v1, s[4:7], s44 offen offset:0 sc1 lds
v_mfma_f32_16x16x32_bf16 v[136:139], a[148:151], a[4:7], v[136:139]
v_fmac_f32 v182, v50, v86
v_fmac_f32 v227, v71, v88
v_mfma_f32_16x16x32_bf16 v[136:139], a[144:147], a[0:3], v[136:139]
v_mfma_f32_16x16x32_bf16 a[176:179], a[152:155], a[160:163], a[176:179]
v_fmac_f32 v206, v50, v88
v_fmac_f32 v203, v71, v86
v_mfma_f32_16x16x32_bf16 a[176:179], a[156:159], a[164:167], a[176:179]
s_waitcnt vmcnt(11) lgkmcnt(0)
v_mfma_f32_16x16x32_bf16 v[140:143], a[96:99], a[32:35], v[140:143]
ds_read_b128 a[128:131], v5 offset:17408
v_fmac_f32 v210, v54, v88
v_mfma_f32_16x16x32_bf16 v[140:143], a[100:103], a[36:39], v[140:143]
buffer_load_dwordx4 a[0:3], v2, s[40:43], s35 offen offset:0 sc1
v_mfma_f32_16x16x32_bf16 v[164:167], a[100:103], a[44:47], v[164:167]
ds_read_b128 a[132:135], v5 offset:23552
v_fmac_f32 v186, v54, v86
v_mfma_f32_16x16x32_bf16 v[164:167], a[96:99], a[40:43], v[164:167]
v_fmac_f32 v179, v71, v84
v_fmac_f32 v155, v71, v82
v_mfma_f32_16x16x32_bf16 v[188:191], a[96:99], a[48:51], v[188:191]
buffer_load_dwordx4 a[4:7], v2, s[40:43], s33 offen offset:0 sc1
v_mfma_f32_16x16x32_bf16 v[188:191], a[100:103], a[52:55], v[188:191]
ds_read_b128 a[136:139], v5 offset:26624
v_fmac_f32 v162, v54, v84
v_mfma_f32_16x16x32_bf16 v[212:215], a[100:103], a[60:63], v[212:215]
ds_read_b128 a[140:143], v5 offset:32768
v_fmac_f32 v138, v54, v82
v_mfma_f32_16x16x32_bf16 v[212:215], a[96:99], a[56:59], v[212:215]
buffer_load_dwordx4 a[8:11], v2, s[40:43], s35 offen offset:1024 sc1
v_mfma_f32_16x16x32_bf16 v[216:219], a[104:107], a[56:59], v[216:219]
ds_read_b128 a[144:147], v5 offset:27648
v_fmac_f32 v135, v51, v82
v_mfma_f32_16x16x32_bf16 v[216:219], a[108:111], a[60:63], v[216:219]
v_fmac_f32 v159, v51, v84
v_fmac_f32 v183, v51, v86
v_mfma_f32_16x16x32_bf16 v[192:195], a[108:111], a[52:55], v[192:195]
buffer_load_dwordx4 a[12:15], v2, s[40:43], s33 offen offset:1024 sc1
v_mfma_f32_16x16x32_bf16 v[192:195], a[104:107], a[48:51], v[192:195]
ds_read_b128 a[148:151], v5 offset:33792
v_fmac_f32 v207, v51, v88
v_mfma_f32_16x16x32_bf16 v[168:171], a[104:107], a[40:43], v[168:171]
ds_read_b128 a[152:155], v6 offset:5120
v_fmac_f32 v211, v55, v88
v_mfma_f32_16x16x32_bf16 v[168:171], a[108:111], a[44:47], v[168:171]
v_mul_f32 v88, 0x3e8293ee, v89
v_mfma_f32_16x16x32_bf16 v[144:147], a[108:111], a[36:39], v[144:147]
buffer_load_dwordx4 a[16:19], v2, s[40:43], s35 offen offset:2048 sc1
v_mfma_f32_16x16x32_bf16 v[144:147], a[104:107], a[32:35], v[144:147]
ds_read_b128 a[156:159], v6 offset:29696
v_fmac_f32 v187, v55, v86
v_mfma_f32_16x16x32_bf16 v[148:151], a[112:115], a[32:35], v[148:151]
v_fmac_f32 v163, v55, v84
v_mul_f32 v86, 0x3e8293ee, v87
v_mfma_f32_16x16x32_bf16 v[148:151], a[116:119], a[36:39], v[148:151]
buffer_load_dwordx4 a[20:23], v2, s[40:43], s33 offen offset:2048 sc1
v_mfma_f32_16x16x32_bf16 v[172:175], a[116:119], a[44:47], v[172:175]
v_fmac_f32 v139, v55, v82
v_mul_f32 v84, 0x3e8293ee, v85
v_mfma_f32_16x16x32_bf16 v[172:175], a[112:115], a[40:43], v[172:175]
v_mul_f32 v82, 0x3e8293ee, v83
v_mfma_f32_16x16x32_bf16 v[196:199], a[112:115], a[48:51], v[196:199]
buffer_load_dwordx4 a[24:27], v2, s[40:43], s35 offen offset:3072 sc1
v_mfma_f32_16x16x32_bf16 v[196:199], a[116:119], a[52:55], v[196:199]
v_mfma_f32_16x16x32_bf16 v[220:223], a[116:119], a[60:63], v[220:223]
v_mfma_f32_16x16x32_bf16 v[220:223], a[112:115], a[56:59], v[220:223]
buffer_load_dwordx4 a[28:31], v2, s[40:43], s33 offen offset:3072 sc1
s_add_u32 s35, s35, 8192
v_mfma_f32_16x16x32_bf16 a[180:183], a[120:123], a[160:163], a[180:183]
s_add_u32 s33, s33, 8192
v_mfma_f32_16x16x32_bf16 a[180:183], a[124:127], a[164:167], a[180:183]
s_waitcnt lgkmcnt(0)
v_mfma_f32_16x16x32_bf16 v[224:227], a[128:131], a[56:59], v[224:227]
ds_read_b128 a[96:99], v5 offset:28672
s_lshl_b32 s90, s28, 12
v_mfma_f32_16x16x32_bf16 v[224:227], a[132:135], a[60:63], v[224:227]
buffer_load_dwordx4 v1, s[4:7], s44 offen offset:1024 sc1 lds
s_add_u32 s90, s90, 147456
v_mfma_f32_16x16x32_bf16 v[200:203], a[132:135], a[52:55], v[200:203]
ds_read_b128 a[100:103], v5 offset:34816
v_add_u32 v234, s90, v1
v_mfma_f32_16x16x32_bf16 v[200:203], a[128:131], a[48:51], v[200:203]
s_lshl_b32 s90, s28, 10
s_add_u32 s90, s90, 147456
v_mfma_f32_16x16x32_bf16 v[176:179], a[128:131], a[40:43], v[176:179]
v_add_u32 v235, s90, v1
v_mfma_f32_16x16x32_bf16 v[176:179], a[132:135], a[44:47], v[176:179]
ds_read_b128 a[104:107], v5 offset:29696
v_mfma_f32_16x16x32_bf16 v[152:155], a[132:135], a[36:39], v[152:155]
v_mfma_f32_16x16x32_bf16 v[152:155], a[128:131], a[32:35], v[152:155]
s_waitcnt vmcnt(19)
v_mfma_f32_16x16x32_bf16 v[140:143], a[136:139], a[64:67], v[140:143]
ds_read_b128 a[108:111], v5 offset:35840
s_waitcnt vmcnt(18)
v_mfma_f32_16x16x32_bf16 v[140:143], a[140:143], a[68:71], v[140:143]
buffer_load_dwordx4 v1, s[4:7], s44 offen offset:2048 sc1 lds
s_waitcnt vmcnt(17)
v_mfma_f32_16x16x32_bf16 v[164:167], a[140:143], a[76:79], v[164:167]
ds_read_b128 a[112:115], v5 offset:38912
v_mfma_f32_16x16x32_bf16 v[164:167], a[136:139], a[72:75], v[164:167]
s_waitcnt vmcnt(16)
v_mfma_f32_16x16x32_bf16 v[188:191], a[136:139], a[80:83], v[188:191]
s_waitcnt vmcnt(15)
v_mfma_f32_16x16x32_bf16 v[188:191], a[140:143], a[84:87], v[188:191]
ds_read_b128 a[116:119], v5 offset:45056
s_waitcnt vmcnt(11)
v_mfma_f32_16x16x32_bf16 v[212:215], a[140:143], a[92:95], v[212:215]
v_mfma_f32_16x16x32_bf16 v[212:215], a[136:139], a[88:91], v[212:215]
v_mfma_f32_16x16x32_bf16 v[216:219], a[144:147], a[88:91], v[216:219]
v_mfma_f32_16x16x32_bf16 v[216:219], a[148:151], a[92:95], v[216:219]
v_mfma_f32_16x16x32_bf16 v[192:195], a[148:151], a[84:87], v[192:195]
buffer_load_dwordx4 v1, s[4:7], s44 offen offset:3072 sc1 lds
s_add_u32 m0, s19, 81920
v_mfma_f32_16x16x32_bf16 v[192:195], a[144:147], a[80:83], v[192:195]
s_add_u32 s44, s85, 0xa0c000
v_mfma_f32_16x16x32_bf16 v[168:171], a[144:147], a[72:75], v[168:171]
v_mfma_f32_16x16x32_bf16 v[168:171], a[148:151], a[76:79], v[168:171]
v_mfma_f32_16x16x32_bf16 v[144:147], a[148:151], a[68:71], v[144:147]
v_mfma_f32_16x16x32_bf16 v[144:147], a[144:147], a[64:67], v[144:147]
v_mfma_f32_16x16x32_bf16 a[184:187], a[152:155], a[160:163], a[184:187]
v_mfma_f32_16x16x32_bf16 a[184:187], a[156:159], a[164:167], a[184:187]
s_waitcnt lgkmcnt(0)
v_mfma_f32_16x16x32_bf16 v[148:151], a[96:99], a[64:67], v[148:151]
ds_read_b128 a[128:131], v5 offset:39936
v_mfma_f32_16x16x32_bf16 v[148:151], a[100:103], a[68:71], v[148:151]
buffer_load_dwordx4 v1, s[4:7], s44 offen offset:0 sc1 lds
v_mfma_f32_16x16x32_bf16 v[172:175], a[100:103], a[76:79], v[172:175]
ds_read_b128 a[132:135], v5 offset:46080
v_mfma_f32_16x16x32_bf16 v[172:175], a[96:99], a[72:75], v[172:175]
v_mfma_f32_16x16x32_bf16 v[196:199], a[96:99], a[80:83], v[196:199]
v_mfma_f32_16x16x32_bf16 v[196:199], a[100:103], a[84:87], v[196:199]
buffer_load_dwordx4 v1, s[4:7], s44 offen offset:1024 sc1 lds
v_mfma_f32_16x16x32_bf16 v[220:223], a[100:103], a[92:95], v[220:223]
ds_read_b128 a[136:139], v5 offset:40960
v_mfma_f32_16x16x32_bf16 v[220:223], a[96:99], a[88:91], v[220:223]
v_mfma_f32_16x16x32_bf16 v[224:227], a[104:107], a[88:91], v[224:227]
ds_read_b128 a[140:143], v5 offset:47104
v_mfma_f32_16x16x32_bf16 v[224:227], a[108:111], a[92:95], v[224:227]
v_mfma_f32_16x16x32_bf16 v[200:203], a[108:111], a[84:87], v[200:203]
buffer_load_dwordx4 v1, s[4:7], s44 offen offset:2048 sc1 lds
v_mfma_f32_16x16x32_bf16 v[200:203], a[104:107], a[80:83], v[200:203]
ds_read_b128 a[144:147], v5 offset:41984
v_mfma_f32_16x16x32_bf16 v[176:179], a[104:107], a[72:75], v[176:179]
ds_write_b128 v234, a[172:175] offset:0
v_mfma_f32_16x16x32_bf16 v[176:179], a[108:111], a[76:79], v[176:179]
ds_read_b128 a[148:151], v5 offset:48128
v_mfma_f32_16x16x32_bf16 v[152:155], a[108:111], a[68:71], v[152:155]
v_mfma_f32_16x16x32_bf16 v[152:155], a[104:107], a[64:67], v[152:155]
buffer_load_dwordx4 v1, s[4:7], s44 offen offset:3072 sc1 lds
s_add_u32 m0, s19, 98304
s_waitcnt vmcnt(14)
v_mfma_f32_16x16x32_bf16 v[140:143], a[112:115], a[0:3], v[140:143]
s_add_u32 s44, s84, 0xa10000
s_waitcnt vmcnt(13)
v_mfma_f32_16x16x32_bf16 v[140:143], a[116:119], a[4:7], v[140:143]
s_waitcnt vmcnt(11)
v_mfma_f32_16x16x32_bf16 v[164:167], a[116:119], a[12:15], v[164:167]
v_mfma_f32_16x16x32_bf16 v[164:167], a[112:115], a[8:11], v[164:167]
s_waitcnt vmcnt(10)
v_mfma_f32_16x16x32_bf16 v[188:191], a[112:115], a[16:19], v[188:191]
buffer_load_dwordx4 v1, s[4:7], s44 offen offset:0 sc1 lds
s_waitcnt vmcnt(10)
v_mfma_f32_16x16x32_bf16 v[188:191], a[116:119], a[20:23], v[188:191]
s_waitcnt vmcnt(8)
v_mfma_f32_16x16x32_bf16 v[212:215], a[116:119], a[28:31], v[212:215]
ds_write_b128 v234, a[176:179] offset:1024
v_mfma_f32_16x16x32_bf16 v[212:215], a[112:115], a[24:27], v[212:215]
s_waitcnt lgkmcnt(1)
v_mfma_f32_16x16x32_bf16 v[216:219], a[128:131], a[24:27], v[216:219]
ds_read_b128 a[96:99], v5 offset:12288
v_mul_f32 v140, v140, v83
v_mfma_f32_16x16x32_bf16 v[216:219], a[132:135], a[28:31], v[216:219]
buffer_load_dwordx4 v1, s[4:7], s44 offen offset:1024 sc1 lds
v_mfma_f32_16x16x32_bf16 v[192:195], a[132:135], a[20:23], v[192:195]
ds_read_b128 a[100:103], v5 offset:18432
v_mul_f32 v141, v141, v83
v_mfma_f32_16x16x32_bf16 v[192:195], a[128:131], a[16:19], v[192:195]
v_cvt_pk_bf16_f32 v140, v140, v141
v_mul_f32 v164, v164, v85
v_mfma_f32_16x16x32_bf16 v[168:171], a[128:131], a[8:11], v[168:171]
v_mul_f32 v165, v165, v85
v_cvt_pk_bf16_f32 v164, v164, v165
v_mfma_f32_16x16x32_bf16 v[168:171], a[132:135], a[12:15], v[168:171]
buffer_load_dwordx4 v1, s[4:7], s44 offen offset:2048 sc1 lds
v_mfma_f32_16x16x32_bf16 v[144:147], a[132:135], a[4:7], v[144:147]
ds_read_b128 a[104:107], v5 offset:24576
v_mul_f32 v212, v212, v89
v_mfma_f32_16x16x32_bf16 v[144:147], a[128:131], a[0:3], v[144:147]
v_mul_f32 v213, v213, v89
v_cvt_pk_bf16_f32 v212, v212, v213
v_mfma_f32_16x16x32_bf16 v[148:151], a[136:139], a[0:3], v[148:151]
ds_read_b128 a[108:111], v5 offset:30720
v_mul_f32 v214, v214, v89
v_mfma_f32_16x16x32_bf16 v[148:151], a[140:143], a[4:7], v[148:151]
v_mul_f32 v215, v215, v89
v_cvt_pk_bf16_f32 v213, v214, v215
v_mfma_f32_16x16x32_bf16 v[172:175], a[140:143], a[12:15], v[172:175]
buffer_load_dwordx4 v1, s[4:7], s44 offen offset:3072 sc1 lds
s_add_u32 m0, s19, 114688
v_mfma_f32_16x16x32_bf16 v[172:175], a[136:139], a[8:11], v[172:175]
s_add_u32 s44, s85, 0xa14000
ds_read_b128 a[112:115], v5 offset:36864
v_mfma_f32_16x16x32_bf16 v[196:199], a[136:139], a[16:19], v[196:199]
ds_write_b128 v234, a[180:183] offset:2048
v_mul_f32 v216, v216, v89
v_mfma_f32_16x16x32_bf16 v[196:199], a[140:143], a[20:23], v[196:199]
ds_read_b128 a[116:119], v5 offset:43008
v_mul_f32 v217, v217, v89
v_mfma_f32_16x16x32_bf16 v[220:223], a[140:143], a[28:31], v[220:223]
v_cvt_pk_bf16_f32 v214, v216, v217
v_mul_f32 v218, v218, v89
v_mfma_f32_16x16x32_bf16 v[220:223], a[136:139], a[24:27], v[220:223]
buffer_load_dwordx4 v1, s[4:7], s44 offen offset:0 sc1 lds
v_mfma_f32_16x16x32_bf16 v[224:227], a[144:147], a[24:27], v[224:227]
v_mul_f32 v219, v219, v89
v_cvt_pk_bf16_f32 v215, v218, v219
v_mfma_f32_16x16x32_bf16 v[224:227], a[148:151], a[28:31], v[224:227]
v_mul_f32 v148, v148, v83
v_mul_f32 v149, v149, v83
v_mfma_f32_16x16x32_bf16 v[200:203], a[148:151], a[20:23], v[200:203]
v_cvt_pk_bf16_f32 v148, v148, v149
v_mul_f32 v172, v172, v85
v_mfma_f32_16x16x32_bf16 v[200:203], a[144:147], a[16:19], v[200:203]
v_mul_f32 v173, v173, v85
v_cvt_pk_bf16_f32 v172, v172, v173
v_mfma_f32_16x16x32_bf16 v[176:179], a[144:147], a[8:11], v[176:179]
buffer_load_dwordx4 v1, s[4:7], s44 offen offset:1024 sc1 lds
v_mfma_f32_16x16x32_bf16 v[176:179], a[148:151], a[12:15], v[176:179]
v_mul_f32 v196, v196, v87
v_mul_f32 v197, v197, v87
v_mfma_f32_16x16x32_bf16 v[152:155], a[148:151], a[4:7], v[152:155]
ds_write_b128 v234, a[184:187] offset:3072
v_cvt_pk_bf16_f32 v196, v196, v197
v_mfma_f32_16x16x32_bf16 v[152:155], a[144:147], a[0:3], v[152:155]
v_mul_f32 v220, v220, v89
s_waitcnt lgkmcnt(1)
v_mfma_f32_16x16x32_bf16 v[132:135], a[96:99], a[32:35], v[132:135]
ds_read_b128 a[128:131], v5 offset:13312
v_mul_f32 v221, v221, v89
v_mfma_f32_16x16x32_bf16 v[132:135], a[100:103], a[36:39], v[132:135]
buffer_load_dwordx4 v1, s[4:7], s44 offen offset:2048 sc1 lds
v_mfma_f32_16x16x32_bf16 v[156:159], a[100:103], a[44:47], v[156:159]
ds_read_b128 a[132:135], v5 offset:19456
v_cvt_pk_bf16_f32 v220, v220, v221
v_mfma_f32_16x16x32_bf16 v[156:159], a[96:99], a[40:43], v[156:159]
v_mul_f32 v222, v222, v89
v_mul_f32 v223, v223, v89
v_mfma_f32_16x16x32_bf16 v[180:183], a[96:99], a[48:51], v[180:183]
v_cvt_pk_bf16_f32 v221, v222, v223
v_mul_f32 v224, v224, v89
v_mfma_f32_16x16x32_bf16 v[180:183], a[100:103], a[52:55], v[180:183]
buffer_load_dwordx4 v1, s[4:7], s44 offen offset:3072 sc1 lds
s_add_u32 m0, s19, 131072
v_mfma_f32_16x16x32_bf16 v[204:207], a[100:103], a[60:63], v[204:207]
s_add_u32 s44, s86, 0xa18000
ds_read_b128 a[136:139], v5 offset:25600
v_mfma_f32_16x16x32_bf16 v[204:207], a[96:99], a[56:59], v[204:207]
v_mul_f32 v225, v225, v89
v_cvt_pk_bf16_f32 v222, v224, v225
v_mfma_f32_16x16x32_bf16 v[204:207], a[104:107], a[88:91], v[204:207]
ds_read_b128 a[140:143], v5 offset:31744
v_mul_f32 v226, v226, v89
v_mfma_f32_16x16x32_bf16 v[204:207], a[108:111], a[92:95], v[204:207]
v_mul_f32 v227, v227, v89
v_cvt_pk_bf16_f32 v223, v226, v227
v_mfma_f32_16x16x32_bf16 v[180:183], a[108:111], a[84:87], v[180:183]
buffer_load_dwordx4 v1, s[4:7], s44 offen offset:0 sc1 lds
v_mfma_f32_16x16x32_bf16 v[180:183], a[104:107], a[80:83], v[180:183]
ds_read_b128 a[144:147], v5 offset:37888
v_mul_f32 v198, v198, v87
v_mfma_f32_16x16x32_bf16 v[156:159], a[104:107], a[72:75], v[156:159]
v_mul_f32 v199, v199, v87
v_cvt_pk_bf16_f32 v197, v198, v199
v_mfma_f32_16x16x32_bf16 v[156:159], a[108:111], a[76:79], v[156:159]
ds_read_b128 a[148:151], v5 offset:44032
v_mul_f32 v200, v200, v87
v_mfma_f32_16x16x32_bf16 v[132:135], a[108:111], a[68:71], v[132:135]
v_mul_f32 v201, v201, v87
v_cvt_pk_bf16_f32 v198, v200, v201
v_mfma_f32_16x16x32_bf16 v[132:135], a[104:107], a[64:67], v[132:135]
buffer_load_dwordx4 v1, s[4:7], s44 offen offset:1024 sc1 lds
v_mfma_f32_16x16x32_bf16 v[132:135], a[112:115], a[0:3], v[132:135]
v_mul_f32 v202, v202, v87
v_mul_f32 v203, v203, v87
v_mfma_f32_16x16x32_bf16 v[132:135], a[116:119], a[4:7], v[132:135]
v_cvt_pk_bf16_f32 v199, v202, v203
v_mul_f32 v174, v174, v85
v_mfma_f32_16x16x32_bf16 v[156:159], a[116:119], a[12:15], v[156:159]
v_mul_f32 v175, v175, v85
v_cvt_pk_bf16_f32 v173, v174, v175
v_mfma_f32_16x16x32_bf16 v[156:159], a[112:115], a[8:11], v[156:159]
v_mul_f32 v176, v176, v85
v_mul_f32 v177, v177, v85
v_mfma_f32_16x16x32_bf16 v[180:183], a[112:115], a[16:19], v[180:183]
buffer_load_dwordx4 v1, s[4:7], s44 offen offset:2048 sc1 lds
v_mfma_f32_16x16x32_bf16 v[180:183], a[116:119], a[20:23], v[180:183]
v_cvt_pk_bf16_f32 v174, v176, v177
v_mul_f32 v178, v178, v85
v_mfma_f32_16x16x32_bf16 v[204:207], a[116:119], a[28:31], v[204:207]
v_mul_f32 v179, v179, v85
v_cvt_pk_bf16_f32 v175, v178, v179
v_mfma_f32_16x16x32_bf16 v[204:207], a[112:115], a[24:27], v[204:207]
s_waitcnt lgkmcnt(0)
s_barrier
v_mfma_f32_16x16x32_bf16 v[208:211], a[128:131], a[56:59], v[208:211]
ds_read_b128 v[92:95], v235 offset:0
v_cvt_pk_bf16_f32 v132, v132, v133
v_mfma_f32_16x16x32_bf16 v[208:211], a[132:135], a[60:63], v[208:211]
buffer_load_dwordx4 v1, s[4:7], s44 offen offset:3072 sc1 lds
v_mfma_f32_16x16x32_bf16 v[184:187], a[132:135], a[52:55], v[184:187]
ds_read_b128 v[96:99], v235 offset:4096
v_cvt_pk_bf16_f32 v156, v156, v157
v_mfma_f32_16x16x32_bf16 v[184:187], a[128:131], a[48:51], v[184:187]
ds_write_b128 v233, v[212:215] offset:21504
v_cvt_pk_bf16_f32 v133, v134, v135
v_mfma_f32_16x16x32_bf16 v[160:163], a[128:131], a[40:43], v[160:163]
ds_read_b128 v[100:103], v235 offset:8192
v_cvt_pk_bf16_f32 v180, v180, v181
v_mfma_f32_16x16x32_bf16 v[160:163], a[132:135], a[44:47], v[160:163]
ds_write_b64 v232, v[220:221] offset:4096
v_cvt_pk_bf16_f32 v157, v158, v159
v_mfma_f32_16x16x32_bf16 v[136:139], a[132:135], a[36:39], v[136:139]
ds_read_b128 v[104:107], v235 offset:12288
v_cvt_pk_bf16_f32 v204, v204, v205
v_mfma_f32_16x16x32_bf16 v[136:139], a[128:131], a[32:35], v[136:139]
ds_write_b64 v232, v[222:223] offset:4608
v_cvt_pk_bf16_f32 v181, v182, v183
v_mfma_f32_16x16x32_bf16 v[136:139], a[136:139], a[64:67], v[136:139]
ds_write_b64 v232, v[196:197] offset:3072
v_cvt_pk_bf16_f32 v205, v206, v207
v_mfma_f32_16x16x32_bf16 v[136:139], a[140:143], a[68:71], v[136:139]
ds_write_b64 v232, v[198:199] offset:3584
v_mul_f32 v150, v150, v83
v_mfma_f32_16x16x32_bf16 v[160:163], a[140:143], a[76:79], v[160:163]
ds_write_b64 v232, v[172:173] offset:2048
v_mul_f32 v151, v151, v83
v_mfma_f32_16x16x32_bf16 v[160:163], a[136:139], a[72:75], v[160:163]
ds_write_b64 v232, v[174:175] offset:2560
v_cvt_pk_bf16_f32 v149, v150, v151
v_mfma_f32_16x16x32_bf16 v[184:187], a[136:139], a[80:83], v[184:187]
ds_write_b64 v232, v[148:149] offset:1024
s_waitcnt lgkmcnt(10)
v_add_f32 v92, v92, v96
v_mfma_f32_16x16x32_bf16 v[184:187], a[140:143], a[84:87], v[184:187]
v_add_f32 v93, v93, v97
v_add_f32 v94, v94, v98
v_mfma_f32_16x16x32_bf16 v[208:211], a[140:143], a[92:95], v[208:211]
s_waitcnt lgkmcnt(6)
v_add_f32 v100, v100, v104
v_add_f32 v101, v101, v105
v_mfma_f32_16x16x32_bf16 v[208:211], a[136:139], a[88:91], v[208:211]
v_add_f32 v102, v102, v106
v_add_f32 v95, v95, v99
v_mfma_f32_16x16x32_bf16 v[208:211], a[144:147], a[24:27], v[208:211]
v_add_f32 v103, v103, v107
v_add_f32 v228, v92, v100
v_mfma_f32_16x16x32_bf16 v[208:211], a[148:151], a[28:31], v[208:211]
v_add_f32 v229, v93, v101
v_add_f32 v230, v94, v102
v_mfma_f32_16x16x32_bf16 v[184:187], a[148:151], a[20:23], v[184:187]
v_add_f32 v231, v95, v103
v_fmac_f32 v228, v72, v90
v_mfma_f32_16x16x32_bf16 v[184:187], a[144:147], a[16:19], v[184:187]
v_fmac_f32 v229, v73, v90
v_fmac_f32 v230, v74, v90
v_mfma_f32_16x16x32_bf16 v[160:163], a[144:147], a[8:11], v[160:163]
v_fmac_f32 v231, v75, v90
v_mul_f32 v152, v152, v83
v_mfma_f32_16x16x32_bf16 v[160:163], a[148:151], a[12:15], v[160:163]
v_mul_f32 v153, v153, v83
v_cvt_pk_bf16_f32 v150, v152, v153
v_mfma_f32_16x16x32_bf16 v[136:139], a[148:151], a[4:7], v[136:139]
v_mul_f32 v154, v154, v83
v_mul_f32 v155, v155, v83
v_mfma_f32_16x16x32_bf16 v[136:139], a[144:147], a[0:3], v[136:139]
v_cvt_pk_bf16_f32 v151, v154, v155
v_mul_f32 v228, v228, v91
s_add_u32 m0, s19, 32768
s_add_u32 s44, s84, 0xa00000
buffer_load_dwordx4 v1, s[4:7], s44 offen offset:0 sc1 lds
v_mul_f32 v229, v229, v91
ds_write_b64 v232, v[150:151] offset:1536
v_pk_mul_f32 v[230:231], v[230:231], v[90:91] op_sel:[0,1] op_sel_hi:[1,1]
v_cvt_pk_bf16_f32 v228, v228, v229
v_pk_mul_f32 v[188:189], v[188:189], v[86:87] op_sel:[0,1] op_sel_hi:[1,1]
v_cvt_pk_bf16_f32 v229, v230, v231
v_pk_mul_f32 v[190:191], v[190:191], v[86:87] op_sel:[0,1] op_sel_hi:[1,1]
v_pk_mul_f32 v[166:167], v[166:167], v[84:85] op_sel:[0,1] op_sel_hi:[1,1]
L_stub13:
s_cbranch_execz L_wret4
v_pk_mul_f32 v[142:143], v[142:143], v[82:83] op_sel:[0,1] op_sel_hi:[1,1]
v_cvt_pk_bf16_f32 v188, v188, v189
v_pk_mul_f32 v[192:193], v[192:193], v[86:87] op_sel:[0,1] op_sel_hi:[1,1]
v_pk_mul_f32 v[194:195], v[194:195], v[86:87] op_sel:[0,1] op_sel_hi:[1,1]
v_pk_mul_f32 v[168:169], v[168:169], v[84:85] op_sel:[0,1] op_sel_hi:[1,1]
v_pk_mul_f32 v[170:171], v[170:171], v[84:85] op_sel:[0,1] op_sel_hi:[1,1]
v_pk_mul_f32 v[144:145], v[144:145], v[82:83] op_sel:[0,1] op_sel_hi:[1,1]
v_pk_mul_f32 v[146:147], v[146:147], v[82:83] op_sel:[0,1] op_sel_hi:[1,1]
ds_write_b64 v9, v[228:229]
v_cvt_pk_bf16_f32 v189, v190, v191
v_cvt_pk_bf16_f32 v165, v166, v167
v_cvt_pk_bf16_f32 v141, v142, v143
v_cvt_pk_bf16_f32 v190, v192, v193
v_cvt_pk_bf16_f32 v191, v194, v195
v_cvt_pk_bf16_f32 v166, v168, v169
buffer_load_dwordx4 v1, s[4:7], s44 offen offset:1024 sc1 lds
v_cvt_pk_bf16_f32 v167, v170, v171
v_cvt_pk_bf16_f32 v142, v144, v145
v_cvt_pk_bf16_f32 v143, v146, v147
v_cvt_pk_bf16_f32 v134, v136, v137
v_cvt_pk_bf16_f32 v135, v138, v139
v_cvt_pk_bf16_f32 v158, v160, v161
v_cvt_pk_bf16_f32 v159, v162, v163
v_cvt_pk_bf16_f32 v182, v184, v185
v_cvt_pk_bf16_f32 v183, v186, v187
v_cvt_pk_bf16_f32 v206, v208, v209
v_cvt_pk_bf16_f32 v207, v210, v211
buffer_load_dwordx4 v1, s[4:7], s44 offen offset:2048 sc1 lds
buffer_load_dwordx4 v1, s[4:7], s44 offen offset:3072 sc1 lds
s_waitcnt lgkmcnt(0)
s_barrier
s_add_u32 m0, s19, 147456
s_add_u32 s44, s87, 0xa1c000
buffer_load_dwordx4 v1, s[4:7], s44 offen offset:0 sc1 lds
v_mfma_f32_16x16x32_bf16 v[184:187], v[164:167], v[180:183], v[20:23]
ds_read_b128 a[0:3], v233 offset:20480
v_mfma_f32_16x16x32_bf16 v[200:203], v[188:191], v[180:183], v[24:27]
ds_read_b64_tr_b16 a[10:11], v248 offset:3072
v_mfma_f32_16x16x32_bf16 v[208:211], v[188:191], v[204:207], v[20:23]
ds_read_b64_tr_b16 a[12:13], v248 offset:4096
v_mfma_f32_16x16x32_bf16 v[224:227], v[212:215], v[204:207], v[24:27]
s_nop 3
v_max_f32 v200, v200, v184
v_max_f32 v201, v201, v185
v_max_f32 v202, v202, v186
v_max_f32 v203, v203, v187
v_max3_f32 v238, v200, v201, v202
v_max_f32 v238, v238, v203
ds_read_b64_tr_b16 a[22:23], v248 offset:3584
v_max_f32 v224, v224, v208
v_max_f32 v225, v225, v209
v_max_f32 v226, v226, v210
v_max_f32 v227, v227, v211
v_max3_f32 v239, v224, v225, v226
buffer_load_dwordx4 v1, s[4:7], s44 offen offset:1024 sc1 lds
v_max_f32 v239, v239, v227
ds_read_b64_tr_b16 a[24:25], v248 offset:4608
s_nop 0
v_permlane32_swap_b32 v239, v238
v_max_f32 v239, v239, v238
v_mov_b32 v242, v239
s_waitcnt lgkmcnt(4)
v_mfma_f32_16x16x32_bf16 v[136:139], a[0:3], v[132:135], v[76:79]
v_permlane16_swap_b32 v239, v242
v_max_f32 v239, v239, v242
v_mov_b32 v242, v239
v_mfma_f32_16x16x32_bf16 v[152:155], v[140:143], v[132:135], v[24:27]
s_nop 0
v_permlane32_swap_b32 v239, v242
v_mfma_f32_16x16x32_bf16 v[160:163], v[140:143], v[156:159], v[20:23]
v_mul_f32_e64 v89, -v239, v88
v_fma_f32 v224, v224, v88, v89
v_mfma_f32_16x16x32_bf16 v[176:179], v[164:167], v[156:159], v[24:27]
v_fma_f32 v225, v225, v88, v89
v_fma_f32 v226, v226, v88, v89
v_fma_f32 v227, v227, v88, v89
v_exp_f32 v224, v224
buffer_load_dwordx4 v1, s[4:7], s44 offen offset:2048 sc1 lds
v_exp_f32 v225, v225
v_exp_f32 v226, v226
v_exp_f32 v227, v227
v_max_f32 v152, v152, v136
v_max_f32 v153, v153, v137
v_max_f32 v154, v154, v138
v_max_f32 v176, v176, v160
v_max_f32 v177, v177, v161
v_max_f32 v178, v178, v162
v_cvt_pk_bf16_f32 v224, v224, v225
ds_read_b64_tr_b16 a[8:9], v248 offset:2048
v_max_f32 v155, v155, v139
v_max3_f32 v236, v152, v153, v154
v_max_f32 v179, v179, v163
v_max3_f32 v237, v176, v177, v178
v_cvt_pk_bf16_f32 v225, v226, v227
ds_read_b64_tr_b16 a[20:21], v248 offset:2560
v_max_f32 v236, v236, v155
v_max_f32 v237, v237, v179
v_and_b32 v208, v224, v28
v_and_b32 v209, v225, v29
v_and_b32 v210, v224, v30
buffer_load_dwordx4 v1, s[4:7], s44 offen offset:3072 sc1 lds
v_and_b32 v211, v225, v31
v_permlane32_swap_b32 v237, v236
s_nop 0
v_mfma_f32_16x16x32_bf16 v[216:219], v[16:19], v[208:211], 0
v_max_f32 v237, v237, v236
v_mul_f32_e64 v87, -v242, v86
s_waitcnt lgkmcnt(4)
v_mfma_f32_16x16x32_bf16 v[116:119], a[10:13], v[208:211], 0
v_mov_b32 v243, v237
v_fma_f32 v200, v200, v86, v87
v_fma_f32 v201, v201, v86, v87
v_fma_f32 v202, v202, v86, v87
v_fma_f32 v203, v203, v86, v87
s_waitcnt lgkmcnt(2)
v_mfma_f32_16x16x32_bf16 v[120:123], a[22:25], v[208:211], 0
v_exp_f32 v200, v200
v_exp_f32 v201, v201
v_exp_f32 v202, v202
v_exp_f32 v203, v203
v_permlane16_swap_b32 v237, v243
v_rcp_f32 v216, v216
v_cvt_pk_bf16_f32 v200, v200, v201
ds_read_b64_tr_b16 a[6:7], v248 offset:1024
v_max_f32 v237, v237, v243
v_cvt_pk_bf16_f32 v201, v202, v203
ds_read_b64_tr_b16 a[18:19], v248 offset:1536
v_mov_b32 v243, v237
v_and_b32 v184, v200, v28
v_and_b32 v185, v201, v29
v_and_b32 v186, v200, v30
v_and_b32 v187, v201, v31
v_pk_mul_f32 v[116:117], v[116:117], v[216:217] op_sel:[0,0] op_sel_hi:[1,0]
v_pk_mul_f32 v[118:119], v[118:119], v[216:217] op_sel:[0,0] op_sel_hi:[1,0]
v_cvt_pk_bf16_f32 v116, v116, v117
v_pk_mul_f32 v[120:121], v[120:121], v[216:217] op_sel:[0,0] op_sel_hi:[1,0]
v_permlane32_swap_b32 v237, v243
v_pk_mul_f32 v[122:123], v[122:123], v[216:217] op_sel:[0,0] op_sel_hi:[1,0]
v_cvt_pk_bf16_f32 v117, v118, v119
v_mfma_f32_16x16x32_bf16 v[192:195], v[16:19], v[184:187], 0
v_cvt_pk_bf16_f32 v118, v120, v121
v_cvt_pk_bf16_f32 v119, v122, v123
buffer_store_dwordx4 v[116:119], v2, s[4:7], s72 offen offset:3072 sc1
v_mul_f32_e64 v85, -v237, v84
s_waitcnt lgkmcnt(3)
v_mfma_f32_16x16x32_bf16 v[108:111], a[8:11], v[184:187], 0
v_fma_f32 v176, v176, v84, v85
v_fma_f32 v177, v177, v84, v85
v_fma_f32 v178, v178, v84, v85
v_fma_f32 v179, v179, v84, v85
s_waitcnt lgkmcnt(2)
v_mfma_f32_16x16x32_bf16 v[112:115], a[20:23], v[184:187], 0
v_exp_f32 v176, v176
v_exp_f32 v177, v177
v_exp_f32 v178, v178
v_exp_f32 v179, v179
v_rcp_f32 v192, v192
v_cvt_pk_bf16_f32 v176, v176, v177
ds_read_b64_tr_b16 a[4:5], v248 offset:0
v_cvt_pk_bf16_f32 v177, v178, v179
ds_read_b64_tr_b16 a[16:17], v248 offset:512
v_and_b32 v160, v176, v28
v_and_b32 v161, v177, v29
v_and_b32 v162, v176, v30
v_and_b32 v163, v177, v31
v_pk_mul_f32 v[108:109], v[108:109], v[192:193] op_sel:[0,0] op_sel_hi:[1,0]
v_pk_mul_f32 v[110:111], v[110:111], v[192:193] op_sel:[0,0] op_sel_hi:[1,0]
v_cvt_pk_bf16_f32 v108, v108, v109
v_pk_mul_f32 v[112:113], v[112:113], v[192:193] op_sel:[0,0] op_sel_hi:[1,0]
v_cvt_pk_bf16_f32 v109, v110, v111
v_pk_mul_f32 v[114:115], v[114:115], v[192:193] op_sel:[0,0] op_sel_hi:[1,0]
v_cvt_pk_bf16_f32 v110, v112, v113
v_mfma_f32_16x16x32_bf16 v[168:171], v[16:19], v[160:163], 0
v_cvt_pk_bf16_f32 v111, v114, v115
buffer_store_dwordx4 v[108:111], v2, s[4:7], s72 offen offset:2048 sc1
v_mul_f32_e64 v83, -v243, v82
s_waitcnt lgkmcnt(3)
v_mfma_f32_16x16x32_bf16 v[100:103], a[6:9], v[160:163], 0
v_fma_f32 v152, v152, v82, v83
v_fma_f32 v153, v153, v82, v83
v_fma_f32 v154, v154, v82, v83
v_fma_f32 v155, v155, v82, v83
s_waitcnt lgkmcnt(2)
v_mfma_f32_16x16x32_bf16 v[104:107], a[18:21], v[160:163], 0
v_exp_f32 v152, v152
v_exp_f32 v153, v153
buffer_atomic_add v12, v10, s[4:7], s94 offen sc1
v_exp_f32 v154, v154
v_exp_f32 v155, v155
v_rcp_f32 v168, v168
v_cvt_pk_bf16_f32 v152, v152, v153
v_cvt_pk_bf16_f32 v153, v154, v155
v_and_b32 v136, v152, v80
v_and_b32 v137, v153, v81
v_and_b32 v138, v152, v30
v_and_b32 v139, v153, v31
v_pk_mul_f32 v[100:101], v[100:101], v[168:169] op_sel:[0,0] op_sel_hi:[1,0]
v_pk_mul_f32 v[102:103], v[102:103], v[168:169] op_sel:[0,0] op_sel_hi:[1,0]
v_cvt_pk_bf16_f32 v100, v100, v101
v_pk_mul_f32 v[104:105], v[104:105], v[168:169] op_sel:[0,0] op_sel_hi:[1,0]
v_cvt_pk_bf16_f32 v101, v102, v103
v_pk_mul_f32 v[106:107], v[106:107], v[168:169] op_sel:[0,0] op_sel_hi:[1,0]
v_cvt_pk_bf16_f32 v102, v104, v105
v_mfma_f32_16x16x32_bf16 v[144:147], v[16:19], v[136:139], 0
v_cvt_pk_bf16_f32 v103, v106, v107
buffer_store_dwordx4 v[100:103], v2, s[4:7], s72 offen offset:1024 sc1
s_waitcnt lgkmcnt(1)
v_mfma_f32_16x16x32_bf16 v[92:95], a[4:7], v[136:139], 0
s_nop 3
v_rcp_f32 v144, v144
s_waitcnt lgkmcnt(0)
v_mfma_f32_16x16x32_bf16 v[96:99], a[16:19], v[136:139], 0
s_nop 0
v_pk_mul_f32 v[92:93], v[92:93], v[144:145] op_sel:[0,0] op_sel_hi:[1,0]
v_pk_mul_f32 v[94:95], v[94:95], v[144:145] op_sel:[0,0] op_sel_hi:[1,0]
v_cvt_pk_bf16_f32 v92, v92, v93
v_cvt_pk_bf16_f32 v93, v94, v95
s_nop 2
v_pk_mul_f32 v[96:97], v[96:97], v[144:145] op_sel:[0,0] op_sel_hi:[1,0]
v_pk_mul_f32 v[98:99], v[98:99], v[144:145] op_sel:[0,0] op_sel_hi:[1,0]
v_cvt_pk_bf16_f32 v94, v96, v97
v_cvt_pk_bf16_f32 v95, v98, v99
buffer_store_dwordx4 v[92:95], v2, s[4:7], s72 offen offset:0 sc1
s_add_u32 s92, s71, 0x20000
s_add_u32 s36, s66, 0x20080
s_add_u32 s40, s4, 0x1e00000
s_addc_u32 s41, s5, 0
v_add_u32 v5, 32768, v1
v_add_u32 v6, 98304, v1
s_cmp_eq_u32 s3, 0
s_cselect_b32 s35, 8, 0
s_lshl_b32 s35, s35, 12
v_lshlrev_b32 v132, 16, v32
v_and_b32 v133, 0xffff0000, v32
v_lshlrev_b32 v134, 16, v33
v_and_b32 v135, 0xffff0000, v33
v_lshlrev_b32 v136, 16, v34
v_and_b32 v137, 0xffff0000, v34
v_lshlrev_b32 v138, 16, v35
v_and_b32 v139, 0xffff0000, v35
v_lshlrev_b32 v140, 16, v36
v_and_b32 v141, 0xffff0000, v36
v_lshlrev_b32 v142, 16, v37
v_and_b32 v143, 0xffff0000, v37
v_lshlrev_b32 v144, 16, v38
v_and_b32 v145, 0xffff0000, v38
v_lshlrev_b32 v146, 16, v39
v_and_b32 v147, 0xffff0000, v39
v_lshlrev_b32 v148, 16, v40
v_and_b32 v149, 0xffff0000, v40
v_lshlrev_b32 v150, 16, v41
v_and_b32 v151, 0xffff0000, v41
v_lshlrev_b32 v152, 16, v42
v_and_b32 v153, 0xffff0000, v42
v_lshlrev_b32 v154, 16, v43
v_and_b32 v155, 0xffff0000, v43
v_lshlrev_b32 v156, 16, v44
v_and_b32 v157, 0xffff0000, v44
v_lshlrev_b32 v158, 16, v45
v_and_b32 v159, 0xffff0000, v45
v_lshlrev_b32 v160, 16, v46
v_and_b32 v161, 0xffff0000, v46
v_lshlrev_b32 v162, 16, v47
v_and_b32 v163, 0xffff0000, v47
s_mov_b32 s95, -1
s_mov_b64 exec, 0
s_cmp_eq_u32 s28, 3
s_cbranch_scc1 L_stub14
s_cmp_eq_u32 s28, 2
s_cbranch_scc1 L_wret5
L_wret5:
s_mov_b64 exec, -1
s_cmp_lg_u32 s28, 0
s_cbranch_scc1 Lpe_28
s_add_u32 s36, s66, 0x20080
s_mov_b32 s37, 0
Lpoll_27:
v_mov_b32 v11, 0
buffer_atomic_add v11, v251, s[4:7], s36 offen sc0 sc1
s_add_u32 s37, s37, 1
s_waitcnt vmcnt(0)
v_readfirstlane_b32 s38, v11
s_nop 0
s_cmp_ge_u32 s38, 32
s_cbranch_scc1 Lpe_28
s_cmp_lt_u32 s37, 0x100000
s_cbranch_scc1 Lpoll_27
Lpe_28:
s_waitcnt vmcnt(0)
s_barrier
L_k2go2:
buffer_load_dwordx4 a[0:3], v4, s[40:43], s35 offen offset:0 sc1
buffer_load_dwordx4 a[4:7], v4, s[40:43], s35 offen offset:1024 sc1
s_cmp_eq_u32 s3, 1
s_cselect_b32 s35, 9, 1
s_lshl_b32 s35, s35, 12
buffer_load_dwordx4 a[8:11], v4, s[40:43], s35 offen offset:0 sc1
buffer_load_dwordx4 a[12:15], v4, s[40:43], s35 offen offset:1024 sc1
s_cmp_eq_u32 s3, 2
s_cselect_b32 s35, 10, 2
s_lshl_b32 s35, s35, 12
buffer_load_dwordx4 a[16:19], v4, s[40:43], s35 offen offset:0 sc1
buffer_load_dwordx4 a[20:23], v4, s[40:43], s35 offen offset:1024 sc1
s_cmp_eq_u32 s3, 3
s_cselect_b32 s35, 11, 3
s_lshl_b32 s35, s35, 12
buffer_load_dwordx4 a[24:27], v4, s[40:43], s35 offen offset:0 sc1
buffer_load_dwordx4 a[28:31], v4, s[40:43], s35 offen offset:1024 sc1
s_cmp_eq_u32 s3, 4
s_cselect_b32 s35, 12, 4
s_lshl_b32 s35, s35, 12
buffer_load_dwordx4 a[32:35], v4, s[40:43], s35 offen offset:0 sc1
buffer_load_dwordx4 a[36:39], v4, s[40:43], s35 offen offset:1024 sc1
s_cmp_eq_u32 s3, 5
s_cselect_b32 s35, 13, 5
s_lshl_b32 s35, s35, 12
ds_read_b128 a[96:99], v5 offset:0
ds_read_b128 a[100:103], v5 offset:1024
ds_read_b128 a[104:107], v5 offset:2048
ds_read_b128 a[108:111], v5 offset:3072
ds_read_b128 a[112:115], v5 offset:4096
ds_read_b128 a[116:119], v5 offset:5120
ds_read_b128 a[120:123], v5 offset:6144
ds_read_b128 a[124:127], v5 offset:7168
s_waitcnt vmcnt(8) lgkmcnt(4)
v_mfma_f32_16x16x32_bf16 v[132:135], a[96:99], a[0:3], v[132:135]
ds_read_b128 a[128:131], v5 offset:8192
v_mfma_f32_16x16x32_bf16 v[148:151], a[96:99], a[4:7], v[148:151]
ds_read_b128 a[132:135], v5 offset:9216
v_mfma_f32_16x16x32_bf16 v[152:155], a[100:103], a[4:7], v[152:155]
buffer_load_dwordx4 a[40:43], v4, s[40:43], s35 offen offset:0 sc1
v_mfma_f32_16x16x32_bf16 v[136:139], a[100:103], a[0:3], v[136:139]
ds_read_b128 a[136:139], v5 offset:10240
v_mfma_f32_16x16x32_bf16 v[140:143], a[104:107], a[0:3], v[140:143]
ds_read_b128 a[140:143], v5 offset:11264
v_mfma_f32_16x16x32_bf16 v[156:159], a[104:107], a[4:7], v[156:159]
v_mfma_f32_16x16x32_bf16 v[160:163], a[108:111], a[4:7], v[160:163]
buffer_load_dwordx4 a[44:47], v4, s[40:43], s35 offen offset:1024 sc1
v_mfma_f32_16x16x32_bf16 v[144:147], a[108:111], a[0:3], v[144:147]
s_waitcnt vmcnt(8) lgkmcnt(4)
v_mfma_f32_16x16x32_bf16 v[132:135], a[112:115], a[8:11], v[132:135]
s_cmp_eq_u32 s3, 6
s_cselect_b32 s35, 14, 6
s_lshl_b32 s35, s35, 12
v_mfma_f32_16x16x32_bf16 v[148:151], a[112:115], a[12:15], v[148:151]
ds_read_b128 a[96:99], v5 offset:12288
v_mfma_f32_16x16x32_bf16 v[152:155], a[116:119], a[12:15], v[152:155]
buffer_load_dwordx4 a[0:3], v4, s[40:43], s35 offen offset:0 sc1
v_mfma_f32_16x16x32_bf16 v[136:139], a[116:119], a[8:11], v[136:139]
ds_read_b128 a[100:103], v5 offset:13312
v_mfma_f32_16x16x32_bf16 v[140:143], a[120:123], a[8:11], v[140:143]
ds_read_b128 a[104:107], v5 offset:14336
v_mfma_f32_16x16x32_bf16 v[156:159], a[120:123], a[12:15], v[156:159]
ds_read_b128 a[108:111], v5 offset:15360
v_mfma_f32_16x16x32_bf16 v[160:163], a[124:127], a[12:15], v[160:163]
buffer_load_dwordx4 a[4:7], v4, s[40:43], s35 offen offset:1024 sc1
v_mfma_f32_16x16x32_bf16 v[144:147], a[124:127], a[8:11], v[144:147]
s_waitcnt vmcnt(8) lgkmcnt(4)
v_mfma_f32_16x16x32_bf16 v[132:135], a[128:131], a[16:19], v[132:135]
s_cmp_eq_u32 s3, 7
s_cselect_b32 s35, 15, 7
s_lshl_b32 s35, s35, 12
v_mfma_f32_16x16x32_bf16 v[148:151], a[128:131], a[20:23], v[148:151]
ds_read_b128 a[112:115], v5 offset:16384
v_mfma_f32_16x16x32_bf16 v[152:155], a[132:135], a[20:23], v[152:155]
buffer_load_dwordx4 a[8:11], v4, s[40:43], s35 offen offset:0 sc1
v_mfma_f32_16x16x32_bf16 v[136:139], a[132:135], a[16:19], v[136:139]
ds_read_b128 a[116:119], v5 offset:17408
v_mfma_f32_16x16x32_bf16 v[140:143], a[136:139], a[16:19], v[140:143]
ds_read_b128 a[120:123], v5 offset:18432
v_mfma_f32_16x16x32_bf16 v[156:159], a[136:139], a[20:23], v[156:159]
ds_read_b128 a[124:127], v5 offset:19456
v_mfma_f32_16x16x32_bf16 v[160:163], a[140:143], a[20:23], v[160:163]
buffer_load_dwordx4 a[12:15], v4, s[40:43], s35 offen offset:1024 sc1
v_mfma_f32_16x16x32_bf16 v[144:147], a[140:143], a[16:19], v[144:147]
s_waitcnt vmcnt(8) lgkmcnt(4)
v_mfma_f32_16x16x32_bf16 v[132:135], a[96:99], a[24:27], v[132:135]
s_cmp_eq_u32 s3, 0
s_cselect_b32 s35, 16, 8
s_lshl_b32 s35, s35, 12
v_mfma_f32_16x16x32_bf16 v[148:151], a[96:99], a[28:31], v[148:151]
ds_read_b128 a[128:131], v5 offset:20480
v_mfma_f32_16x16x32_bf16 v[152:155], a[100:103], a[28:31], v[152:155]
buffer_load_dwordx4 a[16:19], v4, s[40:43], s35 offen offset:0 sc1
v_mfma_f32_16x16x32_bf16 v[136:139], a[100:103], a[24:27], v[136:139]
ds_read_b128 a[132:135], v5 offset:21504
v_mfma_f32_16x16x32_bf16 v[140:143], a[104:107], a[24:27], v[140:143]
ds_read_b128 a[136:139], v5 offset:22528
v_mfma_f32_16x16x32_bf16 v[156:159], a[104:107], a[28:31], v[156:159]
ds_read_b128 a[140:143], v5 offset:23552
v_mfma_f32_16x16x32_bf16 v[160:163], a[108:111], a[28:31], v[160:163]
buffer_load_dwordx4 a[20:23], v4, s[40:43], s35 offen offset:1024 sc1
v_mfma_f32_16x16x32_bf16 v[144:147], a[108:111], a[24:27], v[144:147]
s_waitcnt vmcnt(8) lgkmcnt(4)
v_mfma_f32_16x16x32_bf16 v[132:135], a[112:115], a[32:35], v[132:135]
s_cmp_eq_u32 s3, 1
s_cselect_b32 s35, 17, 9
s_lshl_b32 s35, s35, 12
v_mfma_f32_16x16x32_bf16 v[148:151], a[112:115], a[36:39], v[148:151]
ds_read_b128 a[96:99], v5 offset:24576
v_mfma_f32_16x16x32_bf16 v[152:155], a[116:119], a[36:39], v[152:155]
buffer_load_dwordx4 a[24:27], v4, s[40:43], s35 offen offset:0 sc1
v_mfma_f32_16x16x32_bf16 v[136:139], a[116:119], a[32:35], v[136:139]
ds_read_b128 a[100:103], v5 offset:25600
v_mfma_f32_16x16x32_bf16 v[140:143], a[120:123], a[32:35], v[140:143]
ds_read_b128 a[104:107], v5 offset:26624
v_mfma_f32_16x16x32_bf16 v[156:159], a[120:123], a[36:39], v[156:159]
ds_read_b128 a[108:111], v5 offset:27648
v_mfma_f32_16x16x32_bf16 v[160:163], a[124:127], a[36:39], v[160:163]
buffer_load_dwordx4 a[28:31], v4, s[40:43], s35 offen offset:1024 sc1
v_mfma_f32_16x16x32_bf16 v[144:147], a[124:127], a[32:35], v[144:147]
s_waitcnt vmcnt(8) lgkmcnt(4)
v_mfma_f32_16x16x32_bf16 v[132:135], a[128:131], a[40:43], v[132:135]
s_cmp_eq_u32 s3, 2
s_cselect_b32 s35, 18, 10
s_lshl_b32 s35, s35, 12
v_mfma_f32_16x16x32_bf16 v[148:151], a[128:131], a[44:47], v[148:151]
ds_read_b128 a[112:115], v5 offset:28672
v_mfma_f32_16x16x32_bf16 v[152:155], a[132:135], a[44:47], v[152:155]
buffer_load_dwordx4 a[32:35], v4, s[40:43], s35 offen offset:0 sc1
v_mfma_f32_16x16x32_bf16 v[136:139], a[132:135], a[40:43], v[136:139]
ds_read_b128 a[116:119], v5 offset:29696
v_mfma_f32_16x16x32_bf16 v[140:143], a[136:139], a[40:43], v[140:143]
ds_read_b128 a[120:123], v5 offset:30720
v_mfma_f32_16x16x32_bf16 v[156:159], a[136:139], a[44:47], v[156:159]
ds_read_b128 a[124:127], v5 offset:31744
v_mfma_f32_16x16x32_bf16 v[160:163], a[140:143], a[44:47], v[160:163]
buffer_load_dwordx4 a[36:39], v4, s[40:43], s35 offen offset:1024 sc1
v_mfma_f32_16x16x32_bf16 v[144:147], a[140:143], a[40:43], v[144:147]
s_waitcnt vmcnt(8) lgkmcnt(4)
v_mfma_f32_16x16x32_bf16 v[132:135], a[96:99], a[0:3], v[132:135]
s_cmp_eq_u32 s3, 3
s_cselect_b32 s35, 19, 11
s_lshl_b32 s35, s35, 12
v_mfma_f32_16x16x32_bf16 v[148:151], a[96:99], a[4:7], v[148:151]
ds_read_b128 a[128:131], v5 offset:32768
v_mfma_f32_16x16x32_bf16 v[152:155], a[100:103], a[4:7], v[152:155]
buffer_load_dwordx4 a[40:43], v4, s[40:43], s35 offen offset:0 sc1
v_mfma_f32_16x16x32_bf16 v[136:139], a[100:103], a[0:3], v[136:139]
ds_read_b128 a[132:135], v5 offset:33792
v_mfma_f32_16x16x32_bf16 v[140:143], a[104:107], a[0:3], v[140:143]
ds_read_b128 a[136:139], v5 offset:34816
v_mfma_f32_16x16x32_bf16 v[156:159], a[104:107], a[4:7], v[156:159]
ds_read_b128 a[140:143], v5 offset:35840
v_mfma_f32_16x16x32_bf16 v[160:163], a[108:111], a[4:7], v[160:163]
buffer_load_dwordx4 a[44:47], v4, s[40:43], s35 offen offset:1024 sc1
v_mfma_f32_16x16x32_bf16 v[144:147], a[108:111], a[0:3], v[144:147]
s_waitcnt vmcnt(8) lgkmcnt(4)
v_mfma_f32_16x16x32_bf16 v[132:135], a[112:115], a[8:11], v[132:135]
s_cmp_eq_u32 s3, 4
s_cselect_b32 s35, 20, 12
s_lshl_b32 s35, s35, 12
v_mfma_f32_16x16x32_bf16 v[148:151], a[112:115], a[12:15], v[148:151]
ds_read_b128 a[96:99], v5 offset:36864
v_mfma_f32_16x16x32_bf16 v[152:155], a[116:119], a[12:15], v[152:155]
buffer_load_dwordx4 a[0:3], v4, s[40:43], s35 offen offset:0 sc1
v_mfma_f32_16x16x32_bf16 v[136:139], a[116:119], a[8:11], v[136:139]
ds_read_b128 a[100:103], v5 offset:37888
v_mfma_f32_16x16x32_bf16 v[140:143], a[120:123], a[8:11], v[140:143]
ds_read_b128 a[104:107], v5 offset:38912
v_mfma_f32_16x16x32_bf16 v[156:159], a[120:123], a[12:15], v[156:159]
ds_read_b128 a[108:111], v5 offset:39936
v_mfma_f32_16x16x32_bf16 v[160:163], a[124:127], a[12:15], v[160:163]
buffer_load_dwordx4 a[4:7], v4, s[40:43], s35 offen offset:1024 sc1
v_mfma_f32_16x16x32_bf16 v[144:147], a[124:127], a[8:11], v[144:147]
s_waitcnt vmcnt(8) lgkmcnt(4)
v_mfma_f32_16x16x32_bf16 v[132:135], a[128:131], a[16:19], v[132:135]
s_cmp_eq_u32 s3, 5
s_cselect_b32 s35, 21, 13
s_lshl_b32 s35, s35, 12
v_mfma_f32_16x16x32_bf16 v[148:151], a[128:131], a[20:23], v[148:151]
ds_read_b128 a[112:115], v5 offset:40960
v_mfma_f32_16x16x32_bf16 v[152:155], a[132:135], a[20:23], v[152:155]
buffer_load_dwordx4 a[8:11], v4, s[40:43], s35 offen offset:0 sc1
v_mfma_f32_16x16x32_bf16 v[136:139], a[132:135], a[16:19], v[136:139]
ds_read_b128 a[116:119], v5 offset:41984
v_mfma_f32_16x16x32_bf16 v[140:143], a[136:139], a[16:19], v[140:143]
ds_read_b128 a[120:123], v5 offset:43008
v_mfma_f32_16x16x32_bf16 v[156:159], a[136:139], a[20:23], v[156:159]
ds_read_b128 a[124:127], v5 offset:44032
v_mfma_f32_16x16x32_bf16 v[160:163], a[140:143], a[20:23], v[160:163]
buffer_load_dwordx4 a[12:15], v4, s[40:43], s35 offen offset:1024 sc1
v_mfma_f32_16x16x32_bf16 v[144:147], a[140:143], a[16:19], v[144:147]
s_waitcnt vmcnt(8) lgkmcnt(4)
v_mfma_f32_16x16x32_bf16 v[132:135], a[96:99], a[24:27], v[132:135]
s_cmp_eq_u32 s3, 6
s_cselect_b32 s35, 22, 14
s_lshl_b32 s35, s35, 12
v_mfma_f32_16x16x32_bf16 v[148:151], a[96:99], a[28:31], v[148:151]
ds_read_b128 a[128:131], v5 offset:45056
v_mfma_f32_16x16x32_bf16 v[152:155], a[100:103], a[28:31], v[152:155]
buffer_load_dwordx4 a[16:19], v4, s[40:43], s35 offen offset:0 sc1
v_mfma_f32_16x16x32_bf16 v[136:139], a[100:103], a[24:27], v[136:139]
ds_read_b128 a[132:135], v5 offset:46080
v_mfma_f32_16x16x32_bf16 v[140:143], a[104:107], a[24:27], v[140:143]
ds_read_b128 a[136:139], v5 offset:47104
v_mfma_f32_16x16x32_bf16 v[156:159], a[104:107], a[28:31], v[156:159]
ds_read_b128 a[140:143], v5 offset:48128
v_mfma_f32_16x16x32_bf16 v[160:163], a[108:111], a[28:31], v[160:163]
buffer_load_dwordx4 a[20:23], v4, s[40:43], s35 offen offset:1024 sc1
v_mfma_f32_16x16x32_bf16 v[144:147], a[108:111], a[24:27], v[144:147]
s_waitcnt vmcnt(8) lgkmcnt(4)
v_mfma_f32_16x16x32_bf16 v[132:135], a[112:115], a[32:35], v[132:135]
s_cmp_eq_u32 s3, 7
s_cselect_b32 s35, 23, 15
s_lshl_b32 s35, s35, 12
v_mfma_f32_16x16x32_bf16 v[148:151], a[112:115], a[36:39], v[148:151]
ds_read_b128 a[96:99], v5 offset:49152
v_mfma_f32_16x16x32_bf16 v[152:155], a[116:119], a[36:39], v[152:155]
buffer_load_dwordx4 a[24:27], v4, s[40:43], s35 offen offset:0 sc1
v_mfma_f32_16x16x32_bf16 v[136:139], a[116:119], a[32:35], v[136:139]
ds_read_b128 a[100:103], v5 offset:50176
v_mfma_f32_16x16x32_bf16 v[140:143], a[120:123], a[32:35], v[140:143]
ds_read_b128 a[104:107], v5 offset:51200
v_mfma_f32_16x16x32_bf16 v[156:159], a[120:123], a[36:39], v[156:159]
ds_read_b128 a[108:111], v5 offset:52224
v_mfma_f32_16x16x32_bf16 v[160:163], a[124:127], a[36:39], v[160:163]
buffer_load_dwordx4 a[28:31], v4, s[40:43], s35 offen offset:1024 sc1
v_mfma_f32_16x16x32_bf16 v[144:147], a[124:127], a[32:35], v[144:147]
s_waitcnt vmcnt(8) lgkmcnt(4)
v_mfma_f32_16x16x32_bf16 v[132:135], a[128:131], a[40:43], v[132:135]
s_cmp_eq_u32 s3, 0
s_cselect_b32 s35, 24, 16
s_lshl_b32 s35, s35, 12
v_mfma_f32_16x16x32_bf16 v[148:151], a[128:131], a[44:47], v[148:151]
ds_read_b128 a[112:115], v5 offset:53248
v_mfma_f32_16x16x32_bf16 v[152:155], a[132:135], a[44:47], v[152:155]
buffer_load_dwordx4 a[32:35], v4, s[40:43], s35 offen offset:0 sc1
v_mfma_f32_16x16x32_bf16 v[136:139], a[132:135], a[40:43], v[136:139]
ds_read_b128 a[116:119], v5 offset:54272
v_mfma_f32_16x16x32_bf16 v[140:143], a[136:139], a[40:43], v[140:143]
ds_read_b128 a[120:123], v5 offset:55296
v_mfma_f32_16x16x32_bf16 v[156:159], a[136:139], a[44:47], v[156:159]
ds_read_b128 a[124:127], v5 offset:56320
v_mfma_f32_16x16x32_bf16 v[160:163], a[140:143], a[44:47], v[160:163]
buffer_load_dwordx4 a[36:39], v4, s[40:43], s35 offen offset:1024 sc1
v_mfma_f32_16x16x32_bf16 v[144:147], a[140:143], a[40:43], v[144:147]
s_waitcnt vmcnt(8) lgkmcnt(4)
v_mfma_f32_16x16x32_bf16 v[132:135], a[96:99], a[0:3], v[132:135]
s_cmp_eq_u32 s3, 1
s_cselect_b32 s35, 25, 17
s_lshl_b32 s35, s35, 12
v_mfma_f32_16x16x32_bf16 v[148:151], a[96:99], a[4:7], v[148:151]
ds_read_b128 a[128:131], v5 offset:57344
v_mfma_f32_16x16x32_bf16 v[152:155], a[100:103], a[4:7], v[152:155]
buffer_load_dwordx4 a[40:43], v4, s[40:43], s35 offen offset:0 sc1
v_mfma_f32_16x16x32_bf16 v[136:139], a[100:103], a[0:3], v[136:139]
ds_read_b128 a[132:135], v5 offset:58368
v_mfma_f32_16x16x32_bf16 v[140:143], a[104:107], a[0:3], v[140:143]
ds_read_b128 a[136:139], v5 offset:59392
v_mfma_f32_16x16x32_bf16 v[156:159], a[104:107], a[4:7], v[156:159]
ds_read_b128 a[140:143], v5 offset:60416
v_mfma_f32_16x16x32_bf16 v[160:163], a[108:111], a[4:7], v[160:163]
buffer_load_dwordx4 a[44:47], v4, s[40:43], s35 offen offset:1024 sc1
v_mfma_f32_16x16x32_bf16 v[144:147], a[108:111], a[0:3], v[144:147]
s_waitcnt vmcnt(8) lgkmcnt(4)
v_mfma_f32_16x16x32_bf16 v[132:135], a[112:115], a[8:11], v[132:135]
s_cmp_eq_u32 s3, 2
s_cselect_b32 s35, 26, 18
s_lshl_b32 s35, s35, 12
v_mfma_f32_16x16x32_bf16 v[148:151], a[112:115], a[12:15], v[148:151]
ds_read_b128 a[96:99], v5 offset:61440
v_mfma_f32_16x16x32_bf16 v[152:155], a[116:119], a[12:15], v[152:155]
buffer_load_dwordx4 a[0:3], v4, s[40:43], s35 offen offset:0 sc1
v_mfma_f32_16x16x32_bf16 v[136:139], a[116:119], a[8:11], v[136:139]
ds_read_b128 a[100:103], v5 offset:62464
v_mfma_f32_16x16x32_bf16 v[140:143], a[120:123], a[8:11], v[140:143]
ds_read_b128 a[104:107], v5 offset:63488
v_mfma_f32_16x16x32_bf16 v[156:159], a[120:123], a[12:15], v[156:159]
ds_read_b128 a[108:111], v5 offset:64512
v_mfma_f32_16x16x32_bf16 v[160:163], a[124:127], a[12:15], v[160:163]
buffer_load_dwordx4 a[4:7], v4, s[40:43], s35 offen offset:1024 sc1
v_mfma_f32_16x16x32_bf16 v[144:147], a[124:127], a[8:11], v[144:147]
s_waitcnt vmcnt(8) lgkmcnt(4)
v_mfma_f32_16x16x32_bf16 v[132:135], a[128:131], a[16:19], v[132:135]
s_cmp_eq_u32 s3, 3
s_cselect_b32 s35, 27, 19
s_lshl_b32 s35, s35, 12
v_mfma_f32_16x16x32_bf16 v[148:151], a[128:131], a[20:23], v[148:151]
ds_read_b128 a[112:115], v6 offset:0
v_mfma_f32_16x16x32_bf16 v[152:155], a[132:135], a[20:23], v[152:155]
buffer_load_dwordx4 a[8:11], v4, s[40:43], s35 offen offset:0 sc1
v_mfma_f32_16x16x32_bf16 v[136:139], a[132:135], a[16:19], v[136:139]
ds_read_b128 a[116:119], v6 offset:1024
v_mfma_f32_16x16x32_bf16 v[140:143], a[136:139], a[16:19], v[140:143]
ds_read_b128 a[120:123], v6 offset:2048
v_mfma_f32_16x16x32_bf16 v[156:159], a[136:139], a[20:23], v[156:159]
ds_read_b128 a[124:127], v6 offset:3072
v_mfma_f32_16x16x32_bf16 v[160:163], a[140:143], a[20:23], v[160:163]
buffer_load_dwordx4 a[12:15], v4, s[40:43], s35 offen offset:1024 sc1
v_mfma_f32_16x16x32_bf16 v[144:147], a[140:143], a[16:19], v[144:147]
s_waitcnt vmcnt(8) lgkmcnt(4)
v_mfma_f32_16x16x32_bf16 v[132:135], a[96:99], a[24:27], v[132:135]
s_cmp_eq_u32 s3, 4
s_cselect_b32 s35, 28, 20
s_lshl_b32 s35, s35, 12
v_mfma_f32_16x16x32_bf16 v[148:151], a[96:99], a[28:31], v[148:151]
ds_read_b128 a[128:131], v6 offset:4096
v_mfma_f32_16x16x32_bf16 v[152:155], a[100:103], a[28:31], v[152:155]
buffer_load_dwordx4 a[16:19], v4, s[40:43], s35 offen offset:0 sc1
v_mfma_f32_16x16x32_bf16 v[136:139], a[100:103], a[24:27], v[136:139]
ds_read_b128 a[132:135], v6 offset:5120
v_mfma_f32_16x16x32_bf16 v[140:143], a[104:107], a[24:27], v[140:143]
ds_read_b128 a[136:139], v6 offset:6144
v_mfma_f32_16x16x32_bf16 v[156:159], a[104:107], a[28:31], v[156:159]
ds_read_b128 a[140:143], v6 offset:7168
v_mfma_f32_16x16x32_bf16 v[160:163], a[108:111], a[28:31], v[160:163]
buffer_load_dwordx4 a[20:23], v4, s[40:43], s35 offen offset:1024 sc1
v_mfma_f32_16x16x32_bf16 v[144:147], a[108:111], a[24:27], v[144:147]
s_waitcnt vmcnt(8) lgkmcnt(4)
v_mfma_f32_16x16x32_bf16 v[132:135], a[112:115], a[32:35], v[132:135]
s_cmp_eq_u32 s3, 5
s_cselect_b32 s35, 29, 21
s_lshl_b32 s35, s35, 12
v_mfma_f32_16x16x32_bf16 v[148:151], a[112:115], a[36:39], v[148:151]
ds_read_b128 a[96:99], v6 offset:8192
v_mfma_f32_16x16x32_bf16 v[152:155], a[116:119], a[36:39], v[152:155]
buffer_load_dwordx4 a[24:27], v4, s[40:43], s35 offen offset:0 sc1
v_mfma_f32_16x16x32_bf16 v[136:139], a[116:119], a[32:35], v[136:139]
L_stub14:
s_cbranch_execz L_wret5
ds_read_b128 a[100:103], v6 offset:9216
v_mfma_f32_16x16x32_bf16 v[140:143], a[120:123], a[32:35], v[140:143]
ds_read_b128 a[104:107], v6 offset:10240
v_mfma_f32_16x16x32_bf16 v[156:159], a[120:123], a[36:39], v[156:159]
ds_read_b128 a[108:111], v6 offset:11264
v_mfma_f32_16x16x32_bf16 v[160:163], a[124:127], a[36:39], v[160:163]
buffer_load_dwordx4 a[28:31], v4, s[40:43], s35 offen offset:1024 sc1
v_mfma_f32_16x16x32_bf16 v[144:147], a[124:127], a[32:35], v[144:147]
s_waitcnt vmcnt(8) lgkmcnt(4)
v_mfma_f32_16x16x32_bf16 v[132:135], a[128:131], a[40:43], v[132:135]
s_cmp_eq_u32 s3, 6
s_cselect_b32 s35, 30, 22
s_lshl_b32 s35, s35, 12
v_mfma_f32_16x16x32_bf16 v[148:151], a[128:131], a[44:47], v[148:151]
ds_read_b128 a[112:115], v6 offset:12288
v_mfma_f32_16x16x32_bf16 v[152:155], a[132:135], a[44:47], v[152:155]
buffer_load_dwordx4 a[32:35], v4, s[40:43], s35 offen offset:0 sc1
v_mfma_f32_16x16x32_bf16 v[136:139], a[132:135], a[40:43], v[136:139]
ds_read_b128 a[116:119], v6 offset:13312
v_mfma_f32_16x16x32_bf16 v[140:143], a[136:139], a[40:43], v[140:143]
ds_read_b128 a[120:123], v6 offset:14336
v_mfma_f32_16x16x32_bf16 v[156:159], a[136:139], a[44:47], v[156:159]
ds_read_b128 a[124:127], v6 offset:15360
v_mfma_f32_16x16x32_bf16 v[160:163], a[140:143], a[44:47], v[160:163]
buffer_load_dwordx4 a[36:39], v4, s[40:43], s35 offen offset:1024 sc1
v_mfma_f32_16x16x32_bf16 v[144:147], a[140:143], a[40:43], v[144:147]
s_waitcnt vmcnt(8) lgkmcnt(4)
v_mfma_f32_16x16x32_bf16 v[132:135], a[96:99], a[0:3], v[132:135]
s_cmp_eq_u32 s3, 7
s_cselect_b32 s35, 31, 23
s_lshl_b32 s35, s35, 12
v_mfma_f32_16x16x32_bf16 v[148:151], a[96:99], a[4:7], v[148:151]
ds_read_b128 a[128:131], v6 offset:16384
v_mfma_f32_16x16x32_bf16 v[152:155], a[100:103], a[4:7], v[152:155]
buffer_load_dwordx4 a[40:43], v4, s[40:43], s35 offen offset:0 sc1
v_mfma_f32_16x16x32_bf16 v[136:139], a[100:103], a[0:3], v[136:139]
ds_read_b128 a[132:135], v6 offset:17408
v_mfma_f32_16x16x32_bf16 v[140:143], a[104:107], a[0:3], v[140:143]
ds_read_b128 a[136:139], v6 offset:18432
v_mfma_f32_16x16x32_bf16 v[156:159], a[104:107], a[4:7], v[156:159]
ds_read_b128 a[140:143], v6 offset:19456
v_mfma_f32_16x16x32_bf16 v[160:163], a[108:111], a[4:7], v[160:163]
buffer_load_dwordx4 a[44:47], v4, s[40:43], s35 offen offset:1024 sc1
v_mfma_f32_16x16x32_bf16 v[144:147], a[108:111], a[0:3], v[144:147]
s_waitcnt vmcnt(8) lgkmcnt(4)
v_mfma_f32_16x16x32_bf16 v[132:135], a[112:115], a[8:11], v[132:135]
s_cmp_eq_u32 s3, 0
s_cselect_b32 s35, 0, 24
s_lshl_b32 s35, s35, 12
v_mfma_f32_16x16x32_bf16 v[148:151], a[112:115], a[12:15], v[148:151]
ds_read_b128 a[96:99], v6 offset:20480
v_mfma_f32_16x16x32_bf16 v[152:155], a[116:119], a[12:15], v[152:155]
buffer_load_dwordx4 a[0:3], v4, s[40:43], s35 offen offset:0 sc1
v_mfma_f32_16x16x32_bf16 v[136:139], a[116:119], a[8:11], v[136:139]
ds_read_b128 a[100:103], v6 offset:21504
v_mfma_f32_16x16x32_bf16 v[140:143], a[120:123], a[8:11], v[140:143]
ds_read_b128 a[104:107], v6 offset:22528
v_mfma_f32_16x16x32_bf16 v[156:159], a[120:123], a[12:15], v[156:159]
ds_read_b128 a[108:111], v6 offset:23552
v_mfma_f32_16x16x32_bf16 v[160:163], a[124:127], a[12:15], v[160:163]
buffer_load_dwordx4 a[4:7], v4, s[40:43], s35 offen offset:1024 sc1
v_mfma_f32_16x16x32_bf16 v[144:147], a[124:127], a[8:11], v[144:147]
s_waitcnt vmcnt(8) lgkmcnt(4)
v_mfma_f32_16x16x32_bf16 v[132:135], a[128:131], a[16:19], v[132:135]
s_cmp_eq_u32 s3, 1
s_cselect_b32 s35, 1, 25
s_lshl_b32 s35, s35, 12
v_mfma_f32_16x16x32_bf16 v[148:151], a[128:131], a[20:23], v[148:151]
ds_read_b128 a[112:115], v6 offset:24576
v_mfma_f32_16x16x32_bf16 v[152:155], a[132:135], a[20:23], v[152:155]
buffer_load_dwordx4 a[8:11], v4, s[40:43], s35 offen offset:0 sc1
v_mfma_f32_16x16x32_bf16 v[136:139], a[132:135], a[16:19], v[136:139]
ds_read_b128 a[116:119], v6 offset:25600
v_mfma_f32_16x16x32_bf16 v[140:143], a[136:139], a[16:19], v[140:143]
ds_read_b128 a[120:123], v6 offset:26624
v_mfma_f32_16x16x32_bf16 v[156:159], a[136:139], a[20:23], v[156:159]
ds_read_b128 a[124:127], v6 offset:27648
v_mfma_f32_16x16x32_bf16 v[160:163], a[140:143], a[20:23], v[160:163]
buffer_load_dwordx4 a[12:15], v4, s[40:43], s35 offen offset:1024 sc1
v_mfma_f32_16x16x32_bf16 v[144:147], a[140:143], a[16:19], v[144:147]
s_waitcnt vmcnt(8) lgkmcnt(4)
v_mfma_f32_16x16x32_bf16 v[132:135], a[96:99], a[24:27], v[132:135]
s_cmp_eq_u32 s3, 2
s_cselect_b32 s35, 2, 26
s_lshl_b32 s35, s35, 12
v_mfma_f32_16x16x32_bf16 v[148:151], a[96:99], a[28:31], v[148:151]
ds_read_b128 a[128:131], v6 offset:28672
v_mfma_f32_16x16x32_bf16 v[152:155], a[100:103], a[28:31], v[152:155]
buffer_load_dwordx4 a[16:19], v4, s[40:43], s35 offen offset:0 sc1
v_mfma_f32_16x16x32_bf16 v[136:139], a[100:103], a[24:27], v[136:139]
ds_read_b128 a[132:135], v6 offset:29696
v_mfma_f32_16x16x32_bf16 v[140:143], a[104:107], a[24:27], v[140:143]
ds_read_b128 a[136:139], v6 offset:30720
v_mfma_f32_16x16x32_bf16 v[156:159], a[104:107], a[28:31], v[156:159]
ds_read_b128 a[140:143], v6 offset:31744
v_mfma_f32_16x16x32_bf16 v[160:163], a[108:111], a[28:31], v[160:163]
buffer_load_dwordx4 a[20:23], v4, s[40:43], s35 offen offset:1024 sc1
v_mfma_f32_16x16x32_bf16 v[144:147], a[108:111], a[24:27], v[144:147]
s_waitcnt vmcnt(8) lgkmcnt(4)
v_mfma_f32_16x16x32_bf16 v[132:135], a[112:115], a[32:35], v[132:135]
s_cmp_eq_u32 s3, 3
s_cselect_b32 s35, 3, 27
s_lshl_b32 s35, s35, 12
v_mfma_f32_16x16x32_bf16 v[148:151], a[112:115], a[36:39], v[148:151]
ds_read_b128 a[96:99], v6 offset:32768
v_mfma_f32_16x16x32_bf16 v[152:155], a[116:119], a[36:39], v[152:155]
buffer_load_dwordx4 a[24:27], v4, s[40:43], s35 offen offset:0 sc1
v_mfma_f32_16x16x32_bf16 v[136:139], a[116:119], a[32:35], v[136:139]
ds_read_b128 a[100:103], v6 offset:33792
v_mfma_f32_16x16x32_bf16 v[140:143], a[120:123], a[32:35], v[140:143]
ds_read_b128 a[104:107], v6 offset:34816
v_mfma_f32_16x16x32_bf16 v[156:159], a[120:123], a[36:39], v[156:159]
ds_read_b128 a[108:111], v6 offset:35840
v_mfma_f32_16x16x32_bf16 v[160:163], a[124:127], a[36:39], v[160:163]
buffer_load_dwordx4 a[28:31], v4, s[40:43], s35 offen offset:1024 sc1
v_mfma_f32_16x16x32_bf16 v[144:147], a[124:127], a[32:35], v[144:147]
s_waitcnt vmcnt(8) lgkmcnt(4)
v_mfma_f32_16x16x32_bf16 v[132:135], a[128:131], a[40:43], v[132:135]
s_cmp_eq_u32 s3, 4
s_cselect_b32 s35, 4, 28
s_lshl_b32 s35, s35, 12
v_mfma_f32_16x16x32_bf16 v[148:151], a[128:131], a[44:47], v[148:151]
ds_read_b128 a[112:115], v6 offset:36864
v_mfma_f32_16x16x32_bf16 v[152:155], a[132:135], a[44:47], v[152:155]
buffer_load_dwordx4 a[32:35], v4, s[40:43], s35 offen offset:0 sc1
v_mfma_f32_16x16x32_bf16 v[136:139], a[132:135], a[40:43], v[136:139]
ds_read_b128 a[116:119], v6 offset:37888
v_mfma_f32_16x16x32_bf16 v[140:143], a[136:139], a[40:43], v[140:143]
ds_read_b128 a[120:123], v6 offset:38912
v_mfma_f32_16x16x32_bf16 v[156:159], a[136:139], a[44:47], v[156:159]
ds_read_b128 a[124:127], v6 offset:39936
v_mfma_f32_16x16x32_bf16 v[160:163], a[140:143], a[44:47], v[160:163]
buffer_load_dwordx4 a[36:39], v4, s[40:43], s35 offen offset:1024 sc1
v_mfma_f32_16x16x32_bf16 v[144:147], a[140:143], a[40:43], v[144:147]
s_waitcnt vmcnt(8) lgkmcnt(4)
v_mfma_f32_16x16x32_bf16 v[132:135], a[96:99], a[0:3], v[132:135]
s_cmp_eq_u32 s3, 5
s_cselect_b32 s35, 5, 29
s_lshl_b32 s35, s35, 12
v_mfma_f32_16x16x32_bf16 v[148:151], a[96:99], a[4:7], v[148:151]
ds_read_b128 a[128:131], v6 offset:40960
v_mfma_f32_16x16x32_bf16 v[152:155], a[100:103], a[4:7], v[152:155]
buffer_load_dwordx4 a[40:43], v4, s[40:43], s35 offen offset:0 sc1
v_mfma_f32_16x16x32_bf16 v[136:139], a[100:103], a[0:3], v[136:139]
ds_read_b128 a[132:135], v6 offset:41984
v_mfma_f32_16x16x32_bf16 v[140:143], a[104:107], a[0:3], v[140:143]
ds_read_b128 a[136:139], v6 offset:43008
v_mfma_f32_16x16x32_bf16 v[156:159], a[104:107], a[4:7], v[156:159]
ds_read_b128 a[140:143], v6 offset:44032
v_mfma_f32_16x16x32_bf16 v[160:163], a[108:111], a[4:7], v[160:163]
buffer_load_dwordx4 a[44:47], v4, s[40:43], s35 offen offset:1024 sc1
v_mfma_f32_16x16x32_bf16 v[144:147], a[108:111], a[0:3], v[144:147]
s_waitcnt vmcnt(8) lgkmcnt(4)
v_mfma_f32_16x16x32_bf16 v[132:135], a[112:115], a[8:11], v[132:135]
s_cmp_eq_u32 s3, 6
s_cselect_b32 s35, 6, 30
s_lshl_b32 s35, s35, 12
v_mfma_f32_16x16x32_bf16 v[148:151], a[112:115], a[12:15], v[148:151]
ds_read_b128 a[96:99], v6 offset:45056
v_mfma_f32_16x16x32_bf16 v[152:155], a[116:119], a[12:15], v[152:155]
buffer_load_dwordx4 a[0:3], v4, s[40:43], s35 offen offset:0 sc1
v_mfma_f32_16x16x32_bf16 v[136:139], a[116:119], a[8:11], v[136:139]
ds_read_b128 a[100:103], v6 offset:46080
v_mfma_f32_16x16x32_bf16 v[140:143], a[120:123], a[8:11], v[140:143]
ds_read_b128 a[104:107], v6 offset:47104
v_mfma_f32_16x16x32_bf16 v[156:159], a[120:123], a[12:15], v[156:159]
ds_read_b128 a[108:111], v6 offset:48128
v_mfma_f32_16x16x32_bf16 v[160:163], a[124:127], a[12:15], v[160:163]
buffer_load_dwordx4 a[4:7], v4, s[40:43], s35 offen offset:1024 sc1
v_mfma_f32_16x16x32_bf16 v[144:147], a[124:127], a[8:11], v[144:147]
s_waitcnt vmcnt(8) lgkmcnt(4)
v_mfma_f32_16x16x32_bf16 v[132:135], a[128:131], a[16:19], v[132:135]
s_cmp_eq_u32 s3, 7
s_cselect_b32 s35, 7, 31
s_lshl_b32 s35, s35, 12
v_mfma_f32_16x16x32_bf16 v[148:151], a[128:131], a[20:23], v[148:151]
ds_read_b128 a[112:115], v6 offset:49152
v_mfma_f32_16x16x32_bf16 v[152:155], a[132:135], a[20:23], v[152:155]
buffer_load_dwordx4 a[8:11], v4, s[40:43], s35 offen offset:0 sc1
v_mfma_f32_16x16x32_bf16 v[136:139], a[132:135], a[16:19], v[136:139]
ds_read_b128 a[116:119], v6 offset:50176
v_mfma_f32_16x16x32_bf16 v[140:143], a[136:139], a[16:19], v[140:143]
ds_read_b128 a[120:123], v6 offset:51200
v_mfma_f32_16x16x32_bf16 v[156:159], a[136:139], a[20:23], v[156:159]
ds_read_b128 a[124:127], v6 offset:52224
v_mfma_f32_16x16x32_bf16 v[160:163], a[140:143], a[20:23], v[160:163]
buffer_load_dwordx4 a[12:15], v4, s[40:43], s35 offen offset:1024 sc1
v_mfma_f32_16x16x32_bf16 v[144:147], a[140:143], a[16:19], v[144:147]
s_waitcnt vmcnt(8) lgkmcnt(4)
v_mfma_f32_16x16x32_bf16 v[132:135], a[96:99], a[24:27], v[132:135]
ds_read_b128 a[128:131], v6 offset:53248
v_mfma_f32_16x16x32_bf16 v[148:151], a[96:99], a[28:31], v[148:151]
ds_read_b128 a[132:135], v6 offset:54272
v_mfma_f32_16x16x32_bf16 v[152:155], a[100:103], a[28:31], v[152:155]
ds_read_b128 a[136:139], v6 offset:55296
v_mfma_f32_16x16x32_bf16 v[136:139], a[100:103], a[24:27], v[136:139]
ds_read_b128 a[140:143], v6 offset:56320
v_mfma_f32_16x16x32_bf16 v[140:143], a[104:107], a[24:27], v[140:143]
v_mfma_f32_16x16x32_bf16 v[156:159], a[104:107], a[28:31], v[156:159]
buffer_atomic_add v12, v10, s[4:7], s92 offen sc1
v_mfma_f32_16x16x32_bf16 v[160:163], a[108:111], a[28:31], v[160:163]
v_mfma_f32_16x16x32_bf16 v[144:147], a[108:111], a[24:27], v[144:147]
s_waitcnt vmcnt(7) lgkmcnt(4)
v_mfma_f32_16x16x32_bf16 v[132:135], a[112:115], a[32:35], v[132:135]
ds_read_b128 a[96:99], v6 offset:57344
v_mfma_f32_16x16x32_bf16 v[148:151], a[112:115], a[36:39], v[148:151]
ds_read_b128 a[100:103], v6 offset:58368
v_mfma_f32_16x16x32_bf16 v[152:155], a[116:119], a[36:39], v[152:155]
ds_read_b128 a[104:107], v6 offset:59392
v_mfma_f32_16x16x32_bf16 v[136:139], a[116:119], a[32:35], v[136:139]
ds_read_b128 a[108:111], v6 offset:60416
v_mfma_f32_16x16x32_bf16 v[140:143], a[120:123], a[32:35], v[140:143]
v_mfma_f32_16x16x32_bf16 v[156:159], a[120:123], a[36:39], v[156:159]
v_mfma_f32_16x16x32_bf16 v[160:163], a[124:127], a[36:39], v[160:163]
v_mfma_f32_16x16x32_bf16 v[144:147], a[124:127], a[32:35], v[144:147]
s_waitcnt vmcnt(5) lgkmcnt(4)
v_mfma_f32_16x16x32_bf16 v[132:135], a[128:131], a[40:43], v[132:135]
ds_read_b128 a[112:115], v6 offset:61440
v_mfma_f32_16x16x32_bf16 v[148:151], a[128:131], a[44:47], v[148:151]
ds_read_b128 a[116:119], v6 offset:62464
v_mfma_f32_16x16x32_bf16 v[152:155], a[132:135], a[44:47], v[152:155]
ds_read_b128 a[120:123], v6 offset:63488
v_mfma_f32_16x16x32_bf16 v[136:139], a[132:135], a[40:43], v[136:139]
ds_read_b128 a[124:127], v6 offset:64512
v_mfma_f32_16x16x32_bf16 v[140:143], a[136:139], a[40:43], v[140:143]
v_mfma_f32_16x16x32_bf16 v[156:159], a[136:139], a[44:47], v[156:159]
v_mfma_f32_16x16x32_bf16 v[160:163], a[140:143], a[44:47], v[160:163]
v_mfma_f32_16x16x32_bf16 v[144:147], a[140:143], a[40:43], v[144:147]
s_waitcnt vmcnt(3) lgkmcnt(4)
v_mfma_f32_16x16x32_bf16 v[132:135], a[96:99], a[0:3], v[132:135]
v_mfma_f32_16x16x32_bf16 v[148:151], a[96:99], a[4:7], v[148:151]
v_mfma_f32_16x16x32_bf16 v[152:155], a[100:103], a[4:7], v[152:155]
v_mfma_f32_16x16x32_bf16 v[136:139], a[100:103], a[0:3], v[136:139]
v_mfma_f32_16x16x32_bf16 v[140:143], a[104:107], a[0:3], v[140:143]
v_mfma_f32_16x16x32_bf16 v[156:159], a[104:107], a[4:7], v[156:159]
v_mfma_f32_16x16x32_bf16 v[160:163], a[108:111], a[4:7], v[160:163]
v_mfma_f32_16x16x32_bf16 v[144:147], a[108:111], a[0:3], v[144:147]
s_waitcnt vmcnt(1) lgkmcnt(0)
v_mfma_f32_16x16x32_bf16 v[132:135], a[112:115], a[8:11], v[132:135]
v_mfma_f32_16x16x32_bf16 v[148:151], a[112:115], a[12:15], v[148:151]
v_mfma_f32_16x16x32_bf16 v[152:155], a[116:119], a[12:15], v[152:155]
v_mfma_f32_16x16x32_bf16 v[136:139], a[116:119], a[8:11], v[136:139]
v_mfma_f32_16x16x32_bf16 v[140:143], a[120:123], a[8:11], v[140:143]
v_mfma_f32_16x16x32_bf16 v[156:159], a[120:123], a[12:15], v[156:159]
v_mfma_f32_16x16x32_bf16 v[160:163], a[124:127], a[12:15], v[160:163]
v_mfma_f32_16x16x32_bf16 v[144:147], a[124:127], a[8:11], v[144:147]
s_nop 1
v_cmp_u_f32 vcc, v132, v148
s_nop 0
s_and_b32 vcc_lo, vcc_lo, s95
s_cbranch_scc1 L_k2redo2
s_lshl_b32 s36, s32, 13
v_cvt_pk_bf16_f32 v32, v132, v133
v_cvt_pk_bf16_f32 v33, v134, v135
v_cvt_pk_bf16_f32 v34, v136, v137
v_cvt_pk_bf16_f32 v35, v138, v139
s_add_u32 s36, s36, 0x2200000
buffer_store_dwordx4 v[32:35], v4, s[4:7], s36 offen offset:0 sc1
v_cvt_pk_bf16_f32 v40, v148, v149
v_cvt_pk_bf16_f32 v41, v150, v151
v_cvt_pk_bf16_f32 v42, v152, v153
v_cvt_pk_bf16_f32 v43, v154, v155
v_cvt_pk_bf16_f32 v36, v140, v141
v_cvt_pk_bf16_f32 v37, v142, v143
v_cvt_pk_bf16_f32 v38, v144, v145
v_cvt_pk_bf16_f32 v39, v146, v147
s_add_u32 s37, s36, 4096
v_cvt_pk_bf16_f32 v44, v156, v157
v_cvt_pk_bf16_f32 v45, v158, v159
v_cvt_pk_bf16_f32 v46, v160, v161
buffer_store_dwordx4 v[40:43], v4, s[4:7], s36 offen offset:1024 sc1
v_cvt_pk_bf16_f32 v47, v162, v163
v_mfma_f32_16x16x32_bf16 v[96:99], v[32:35], v[32:35], 0
s_mov_b32 s38, 0x2c0000
s_add_u32 s92, s78, 0x60000
v_mfma_f32_16x16x32_bf16 v[92:95], v[16:19], v[32:35], 0
s_add_u32 s93, s79, 0x60000
s_add_u32 s40, s4, 0x2200000
v_mfma_f32_16x16x32_bf16 v[96:99], v[36:39], v[36:39], v[96:99]
s_addc_u32 s41, s5, 0
buffer_store_dwordx4 v[36:39], v4, s[4:7], s37 offen offset:0 sc1
v_mfma_f32_16x16x32_bf16 v[92:95], v[16:19], v[36:39], v[92:95]
s_nop 4
v_cndmask_b32 v96, v96, v97, s[46:47]
v_cndmask_b32 v98, v98, v99, s[46:47]
v_mfma_f32_16x16x32_bf16 v[104:107], v[40:43], v[40:43], 0
v_mfma_f32_16x16x32_bf16 v[100:103], v[16:19], v[40:43], 0
v_cndmask_b32 v93, v96, v98, s[48:49]
buffer_store_dwordx4 v[44:47], v4, s[4:7], s37 offen offset:1024 sc1
v_mfma_f32_16x16x32_bf16 v[104:107], v[44:47], v[44:47], v[104:107]
v_mfma_f32_16x16x32_bf16 v[100:103], v[16:19], v[44:47], v[100:103]
s_nop 6
v_cndmask_b32 v104, v104, v105, s[46:47]
v_cndmask_b32 v106, v106, v107, s[46:47]
buffer_store_dwordx2 v[92:93], v253, s[4:7], s38 offen offset:0 sc1
v_cndmask_b32 v101, v104, v106, s[48:49]
buffer_store_dwordx2 v[100:101], v253, s[4:7], s38 offen offset:2048 sc1
s_barrier
s_add_u32 m0, s18, 0x0
s_add_u32 s44, s50, 0x1400000
buffer_load_dwordx4 v1, s[4:7], s44 offen offset:0 sc1 lds
buffer_load_dwordx4 v1, s[4:7], s44 offen offset:1024 sc1 lds
buffer_load_dwordx4 v1, s[4:7], s44 offen offset:2048 sc1 lds
s_add_u32 m0, s18, 0x3000
s_add_u32 s44, s50, 0x1403000
buffer_load_dwordx4 v1, s[4:7], s44 offen offset:0 sc1 lds
buffer_load_dwordx4 v1, s[4:7], s44 offen offset:1024 sc1 lds
buffer_load_dwordx4 v1, s[4:7], s44 offen offset:2048 sc1 lds
v_accvgpr_read_b32 v48, a216
v_accvgpr_read_b32 v49, a217
v_accvgpr_read_b32 v50, a218
v_accvgpr_read_b32 v51, a219
v_accvgpr_read_b32 v52, a220
v_accvgpr_read_b32 v53, a221
v_accvgpr_read_b32 v54, a222
v_accvgpr_read_b32 v55, a223
v_accvgpr_read_b32 v56, a224
v_accvgpr_read_b32 v57, a225
v_accvgpr_read_b32 v58, a226
v_accvgpr_read_b32 v59, a227
v_accvgpr_read_b32 v60, a228
v_accvgpr_read_b32 v61, a229
v_accvgpr_read_b32 v62, a230
v_accvgpr_read_b32 v63, a231
v_accvgpr_read_b32 v64, a232
v_accvgpr_read_b32 v65, a233
v_accvgpr_read_b32 v66, a234
v_accvgpr_read_b32 v67, a235
v_accvgpr_read_b32 v68, a236
v_accvgpr_read_b32 v69, a237
v_accvgpr_read_b32 v70, a238
v_accvgpr_read_b32 v71, a239
s_waitcnt vmcnt(6)
s_barrier
s_cmp_lg_u32 s28, 1
s_cbranch_scc1 Lsg_29
buffer_atomic_add v12, v10, s[4:7], s92 offen sc1
Lsg_29:
s_mov_b64 exec, 0
s_cmp_eq_u32 s28, 1
s_cbranch_scc1 L_stub15
L_wret6:
s_mov_b64 exec, -1
s_cmp_lt_u32 s28, 2
s_cbranch_scc1 Lwd_30
s_add_u32 m0, s18, 0x4800
s_add_u32 s44, s50, 0x1404800
buffer_load_dwordx4 v1, s[4:7], s44 offen offset:0 sc1 lds
buffer_load_dwordx4 v1, s[4:7], s44 offen offset:1024 sc1 lds
buffer_load_dwordx4 v1, s[4:7], s44 offen offset:2048 sc1 lds
s_add_u32 m0, s18, 0x6000
s_add_u32 s44, s50, 0x1406000
buffer_load_dwordx4 v1, s[4:7], s44 offen offset:0 sc1 lds
buffer_load_dwordx4 v1, s[4:7], s44 offen offset:1024 sc1 lds
buffer_load_dwordx4 v1, s[4:7], s44 offen offset:2048 sc1 lds
s_add_u32 m0, s18, 0x7800
s_add_u32 s44, s50, 0x1407800
buffer_load_dwordx4 v1, s[4:7], s44 offen offset:0 sc1 lds
buffer_load_dwordx4 v1, s[4:7], s44 offen offset:1024 sc1 lds
buffer_load_dwordx4 v1, s[4:7], s44 offen offset:2048 sc1 lds
s_add_u32 m0, s18, 0x9000
s_add_u32 s44, s50, 0x1409000
buffer_load_dwordx4 v1, s[4:7], s44 offen offset:0 sc1 lds
buffer_load_dwordx4 v1, s[4:7], s44 offen offset:1024 sc1 lds
buffer_load_dwordx4 v1, s[4:7], s44 offen offset:2048 sc1 lds
s_add_u32 m0, s18, 0xa800
s_add_u32 s44, s50, 0x140a800
buffer_load_dwordx4 v1, s[4:7], s44 offen offset:0 sc1 lds
buffer_load_dwordx4 v1, s[4:7], s44 offen offset:1024 sc1 lds
buffer_load_dwordx4 v1, s[4:7], s44 offen offset:2048 sc1 lds
s_add_u32 m0, s18, 0xc000
s_add_u32 s44, s50, 0x140c000
buffer_load_dwordx4 v1, s[4:7], s44 offen offset:0 sc1 lds
buffer_load_dwordx4 v1, s[4:7], s44 offen offset:1024 sc1 lds
buffer_load_dwordx4 v1, s[4:7], s44 offen offset:2048 sc1 lds
s_add_u32 m0, s18, 0xd800
s_add_u32 s44, s50, 0x140d800
buffer_load_dwordx4 v1, s[4:7], s44 offen offset:0 sc1 lds
buffer_load_dwordx4 v1, s[4:7], s44 offen offset:1024 sc1 lds
buffer_load_dwordx4 v1, s[4:7], s44 offen offset:2048 sc1 lds
s_add_u32 m0, s18, 0xf000
s_add_u32 s44, s50, 0x140f000
buffer_load_dwordx4 v1, s[4:7], s44 offen offset:0 sc1 lds
buffer_load_dwordx4 v1, s[4:7], s44 offen offset:1024 sc1 lds
buffer_load_dwordx4 v1, s[4:7], s44 offen offset:2048 sc1 lds
s_add_u32 m0, s18, 0x10800
s_add_u32 s44, s50, 0x1410800
buffer_load_dwordx4 v1, s[4:7], s44 offen offset:0 sc1 lds
buffer_load_dwordx4 v1, s[4:7], s44 offen offset:1024 sc1 lds
buffer_load_dwordx4 v1, s[4:7], s44 offen offset:2048 sc1 lds
s_add_u32 m0, s18, 0x12000
s_add_u32 s44, s50, 0x1412000
buffer_load_dwordx4 v1, s[4:7], s44 offen offset:0 sc1 lds
buffer_load_dwordx4 v1, s[4:7], s44 offen offset:1024 sc1 lds
buffer_load_dwordx4 v1, s[4:7], s44 offen offset:2048 sc1 lds
s_add_u32 m0, s18, 0x13800
s_add_u32 s44, s50, 0x1413800
buffer_load_dwordx4 v1, s[4:7], s44 offen offset:0 sc1 lds
buffer_load_dwordx4 v1, s[4:7], s44 offen offset:1024 sc1 lds
buffer_load_dwordx4 v1, s[4:7], s44 offen offset:2048 sc1 lds
s_add_u32 m0, s18, 0x15000
s_add_u32 s44, s50, 0x1415000
buffer_load_dwordx4 v1, s[4:7], s44 offen offset:0 sc1 lds
buffer_load_dwordx4 v1, s[4:7], s44 offen offset:1024 sc1 lds
buffer_load_dwordx4 v1, s[4:7], s44 offen offset:2048 sc1 lds
s_add_u32 m0, s18, 0x16800
s_add_u32 s44, s50, 0x1416800
buffer_load_dwordx4 v1, s[4:7], s44 offen offset:0 sc1 lds
buffer_load_dwordx4 v1, s[4:7], s44 offen offset:1024 sc1 lds
buffer_load_dwordx4 v1, s[4:7], s44 offen offset:2048 sc1 lds
s_add_u32 m0, s18, 0x18000
s_add_u32 s44, s50, 0x1418000
buffer_load_dwordx4 v1, s[4:7], s44 offen offset:0 sc1 lds
buffer_load_dwordx4 v1, s[4:7], s44 offen offset:1024 sc1 lds
buffer_load_dwordx4 v1, s[4:7], s44 offen offset:2048 sc1 lds
s_add_u32 m0, s18, 0x19800
s_add_u32 s44, s50, 0x1419800
buffer_load_dwordx4 v1, s[4:7], s44 offen offset:0 sc1 lds
buffer_load_dwordx4 v1, s[4:7], s44 offen offset:1024 sc1 lds
buffer_load_dwordx4 v1, s[4:7], s44 offen offset:2048 sc1 lds
s_add_u32 m0, s18, 0x1b000
s_add_u32 s44, s50, 0x141b000
buffer_load_dwordx4 v1, s[4:7], s44 offen offset:0 sc1 lds
buffer_load_dwordx4 v1, s[4:7], s44 offen offset:1024 sc1 lds
buffer_load_dwordx4 v1, s[4:7], s44 offen offset:2048 sc1 lds
Lwd_30:
s_cmp_lg_u32 s28, 0
s_cbranch_scc1 Lpe_32
s_add_u32 s36, s67, 0x60000
s_mov_b32 s37, 0
Lpoll_31:
v_mov_b32 v11, 0
buffer_atomic_add v11, v251, s[4:7], s36 offen sc0 sc1
s_add_u32 s37, s37, 1
s_waitcnt vmcnt(0)
v_readfirstlane_b32 s38, v11
s_nop 0
s_cmp_ge_u32 s38, 32
s_cbranch_scc1 Lpe_32
s_cmp_lt_u32 s37, 0x100000
s_cbranch_scc1 Lpoll_31
Lpe_32:
s_waitcnt vmcnt(36) lgkmcnt(0)
s_cmp_ge_u32 s28, 2
s_cbranch_scc1 Lw_33
s_waitcnt vmcnt(0)
Lw_33:
s_barrier
s_mov_b32 s35, 0
s_mov_b32 s33, 0x1000
buffer_load_dwordx4 a[0:3], v2, s[40:43], s35 offen offset:0 sc1
buffer_load_dwordx4 a[4:7], v2, s[40:43], s33 offen offset:0 sc1
buffer_load_dwordx4 a[8:11], v2, s[40:43], s35 offen offset:1024 sc1
buffer_load_dwordx4 a[12:15], v2, s[40:43], s33 offen offset:1024 sc1
buffer_load_dwordx4 a[16:19], v2, s[40:43], s35 offen offset:2048 sc1
buffer_load_dwordx4 a[20:23], v2, s[40:43], s33 offen offset:2048 sc1
buffer_load_dwordx4 a[24:27], v2, s[40:43], s35 offen offset:3072 sc1
buffer_load_dwordx4 a[28:31], v2, s[40:43], s33 offen offset:3072 sc1
s_add_u32 s35, s35, 8192
s_add_u32 s33, s33, 8192
buffer_load_dwordx4 a[32:35], v2, s[40:43], s35 offen offset:0 sc1
buffer_load_dwordx4 a[36:39], v2, s[40:43], s33 offen offset:0 sc1
buffer_load_dwordx4 a[40:43], v2, s[40:43], s35 offen offset:1024 sc1
buffer_load_dwordx4 a[44:47], v2, s[40:43], s33 offen offset:1024 sc1
buffer_load_dwordx4 a[48:51], v2, s[40:43], s35 offen offset:2048 sc1
buffer_load_dwordx4 a[52:55], v2, s[40:43], s33 offen offset:2048 sc1
buffer_load_dwordx4 a[56:59], v2, s[40:43], s35 offen offset:3072 sc1
buffer_load_dwordx4 a[60:63], v2, s[40:43], s33 offen offset:3072 sc1
s_add_u32 s35, s35, 8192
s_add_u32 s33, s33, 8192
v_add_u32 v5, 0, v1
ds_read_b128 a[96:99], v5 offset:2048
ds_read_b128 a[100:103], v5 offset:8192
ds_read_b128 a[104:107], v5 offset:3072
ds_read_b128 a[108:111], v5 offset:9216
ds_read_b128 a[112:115], v5 offset:4096
ds_read_b128 a[116:119], v5 offset:10240
s_waitcnt vmcnt(14) lgkmcnt(4)
v_mfma_f32_16x16x32_bf16 v[140:143], a[96:99], a[0:3], 0
s_add_u32 s88, s82, 0x2c0000
ds_read_b128 a[128:131], v5 offset:5120
v_mfma_f32_16x16x32_bf16 v[140:143], a[100:103], a[4:7], v[140:143]
buffer_load_dwordx4 a[64:67], v2, s[40:43], s35 offen offset:0 sc1
s_waitcnt vmcnt(13)
v_mfma_f32_16x16x32_bf16 v[164:167], a[100:103], a[12:15], 0
ds_read_b128 a[132:135], v5 offset:11264
v_mfma_f32_16x16x32_bf16 v[164:167], a[96:99], a[8:11], v[164:167]
s_waitcnt vmcnt(12)
v_mfma_f32_16x16x32_bf16 v[188:191], a[96:99], a[16:19], 0
s_waitcnt vmcnt(11)
v_mfma_f32_16x16x32_bf16 v[188:191], a[100:103], a[20:23], v[188:191]
buffer_load_dwordx4 a[68:71], v2, s[40:43], s33 offen offset:0 sc1
s_waitcnt vmcnt(10)
v_mfma_f32_16x16x32_bf16 v[212:215], a[100:103], a[28:31], 0
ds_read_b128 a[136:139], v5 offset:0
v_mfma_f32_16x16x32_bf16 v[212:215], a[96:99], a[24:27], v[212:215]
s_waitcnt lgkmcnt(6)
v_mfma_f32_16x16x32_bf16 v[216:219], a[104:107], a[24:27], 0
ds_read_b128 a[140:143], v5 offset:6144
s_waitcnt lgkmcnt(6)
v_mfma_f32_16x16x32_bf16 v[216:219], a[108:111], a[28:31], v[216:219]
v_mfma_f32_16x16x32_bf16 v[192:195], a[108:111], a[20:23], 0
buffer_load_dwordx4 v[92:95], v1, s[4:7], s88 offen offset:0 sc1
v_mfma_f32_16x16x32_bf16 v[192:195], a[104:107], a[16:19], v[192:195]
ds_read_b128 a[144:147], v5 offset:1024
v_mfma_f32_16x16x32_bf16 v[168:171], a[104:107], a[8:11], 0
v_mfma_f32_16x16x32_bf16 v[168:171], a[108:111], a[12:15], v[168:171]
ds_read_b128 a[148:151], v5 offset:7168
v_mfma_f32_16x16x32_bf16 v[144:147], a[108:111], a[4:7], 0
v_mfma_f32_16x16x32_bf16 v[144:147], a[104:107], a[0:3], v[144:147]
buffer_load_dwordx4 a[72:75], v2, s[40:43], s35 offen offset:1024 sc1
s_waitcnt lgkmcnt(7)
v_mfma_f32_16x16x32_bf16 v[148:151], a[112:115], a[0:3], 0
s_waitcnt lgkmcnt(6)
v_mfma_f32_16x16x32_bf16 v[148:151], a[116:119], a[4:7], v[148:151]
v_mfma_f32_16x16x32_bf16 v[172:175], a[116:119], a[12:15], 0
v_mfma_f32_16x16x32_bf16 v[172:175], a[112:115], a[8:11], v[172:175]
v_mfma_f32_16x16x32_bf16 v[196:199], a[112:115], a[16:19], 0
buffer_load_dwordx4 a[76:79], v2, s[40:43], s33 offen offset:1024 sc1
v_mfma_f32_16x16x32_bf16 v[196:199], a[116:119], a[20:23], v[196:199]
v_mfma_f32_16x16x32_bf16 v[220:223], a[116:119], a[28:31], 0
v_mfma_f32_16x16x32_bf16 v[220:223], a[112:115], a[24:27], v[220:223]
s_waitcnt lgkmcnt(0)
v_mfma_f32_16x16x32_bf16 v[224:227], a[128:131], a[24:27], 0
ds_read_b128 a[96:99], v5 offset:14336
v_mfma_f32_16x16x32_bf16 v[224:227], a[132:135], a[28:31], v[224:227]
buffer_load_dwordx4 a[80:83], v2, s[40:43], s35 offen offset:2048 sc1
v_mfma_f32_16x16x32_bf16 v[200:203], a[132:135], a[20:23], 0
ds_read_b128 a[100:103], v5 offset:20480
v_mfma_f32_16x16x32_bf16 v[200:203], a[128:131], a[16:19], v[200:203]
v_mfma_f32_16x16x32_bf16 v[176:179], a[128:131], a[8:11], 0
v_mfma_f32_16x16x32_bf16 v[176:179], a[132:135], a[12:15], v[176:179]
buffer_load_dwordx4 a[84:87], v2, s[40:43], s33 offen offset:2048 sc1
v_mfma_f32_16x16x32_bf16 v[152:155], a[132:135], a[4:7], 0
ds_read_b128 a[104:107], v5 offset:15360
v_mfma_f32_16x16x32_bf16 v[152:155], a[128:131], a[0:3], v[152:155]
v_mfma_f32_16x16x32_bf16 v[132:135], a[136:139], a[0:3], 0
ds_read_b128 a[108:111], v5 offset:21504
v_mfma_f32_16x16x32_bf16 v[132:135], a[140:143], a[4:7], v[132:135]
v_mfma_f32_16x16x32_bf16 v[156:159], a[140:143], a[12:15], 0
buffer_load_dwordx4 v[96:99], v1, s[4:7], s88 offen offset:1024 sc1
v_mfma_f32_16x16x32_bf16 v[156:159], a[136:139], a[8:11], v[156:159]
ds_read_b128 a[112:115], v5 offset:16384
v_mfma_f32_16x16x32_bf16 v[180:183], a[136:139], a[16:19], 0
v_mfma_f32_16x16x32_bf16 v[180:183], a[140:143], a[20:23], v[180:183]
ds_read_b128 a[116:119], v5 offset:22528
v_mfma_f32_16x16x32_bf16 v[204:207], a[140:143], a[28:31], 0
v_mfma_f32_16x16x32_bf16 v[204:207], a[136:139], a[24:27], v[204:207]
buffer_load_dwordx4 a[88:91], v2, s[40:43], s35 offen offset:3072 sc1
v_mfma_f32_16x16x32_bf16 v[208:211], a[144:147], a[24:27], 0
v_mfma_f32_16x16x32_bf16 v[208:211], a[148:151], a[28:31], v[208:211]
v_mfma_f32_16x16x32_bf16 v[184:187], a[148:151], a[20:23], 0
v_mfma_f32_16x16x32_bf16 v[184:187], a[144:147], a[16:19], v[184:187]
v_mfma_f32_16x16x32_bf16 v[160:163], a[144:147], a[8:11], 0
buffer_load_dwordx4 a[92:95], v2, s[40:43], s33 offen offset:3072 sc1
s_add_u32 s35, s35, 8192
v_mfma_f32_16x16x32_bf16 v[160:163], a[148:151], a[12:15], v[160:163]
s_add_u32 s33, s33, 8192
v_mfma_f32_16x16x32_bf16 v[136:139], a[148:151], a[4:7], 0
v_mfma_f32_16x16x32_bf16 v[136:139], a[144:147], a[0:3], v[136:139]
s_waitcnt vmcnt(10) lgkmcnt(0)
v_mfma_f32_16x16x32_bf16 v[140:143], a[96:99], a[32:35], v[140:143]
ds_read_b128 a[128:131], v5 offset:17408
v_mfma_f32_16x16x32_bf16 v[140:143], a[100:103], a[36:39], v[140:143]
buffer_load_dwordx4 a[0:3], v2, s[40:43], s35 offen offset:0 sc1
L_stub15:
s_cbranch_execz L_stub16
v_mfma_f32_16x16x32_bf16 v[164:167], a[100:103], a[44:47], v[164:167]
ds_read_b128 a[132:135], v5 offset:23552
v_mfma_f32_16x16x32_bf16 v[164:167], a[96:99], a[40:43], v[164:167]
v_mfma_f32_16x16x32_bf16 v[188:191], a[96:99], a[48:51], v[188:191]
v_mfma_f32_16x16x32_bf16 v[188:191], a[100:103], a[52:55], v[188:191]
buffer_load_dwordx4 a[4:7], v2, s[40:43], s33 offen offset:0 sc1
v_mfma_f32_16x16x32_bf16 v[212:215], a[100:103], a[60:63], v[212:215]
ds_read_b128 a[136:139], v5 offset:12288
v_mfma_f32_16x16x32_bf16 v[212:215], a[96:99], a[56:59], v[212:215]
v_mfma_f32_16x16x32_bf16 v[216:219], a[104:107], a[56:59], v[216:219]
ds_read_b128 a[140:143], v5 offset:18432
v_mfma_f32_16x16x32_bf16 v[216:219], a[108:111], a[60:63], v[216:219]
v_mfma_f32_16x16x32_bf16 v[192:195], a[108:111], a[52:55], v[192:195]
buffer_load_dwordx4 v[100:103], v1, s[4:7], s88 offen offset:2048 sc1
v_mfma_f32_16x16x32_bf16 v[192:195], a[104:107], a[48:51], v[192:195]
ds_read_b128 a[144:147], v5 offset:13312
v_mfma_f32_16x16x32_bf16 v[168:171], a[104:107], a[40:43], v[168:171]
v_mfma_f32_16x16x32_bf16 v[168:171], a[108:111], a[44:47], v[168:171]
ds_read_b128 a[148:151], v5 offset:19456
v_mfma_f32_16x16x32_bf16 v[144:147], a[108:111], a[36:39], v[144:147]
v_mfma_f32_16x16x32_bf16 v[144:147], a[104:107], a[32:35], v[144:147]
buffer_load_dwordx4 a[8:11], v2, s[40:43], s35 offen offset:1024 sc1
v_mfma_f32_16x16x32_bf16 v[148:151], a[112:115], a[32:35], v[148:151]
v_mfma_f32_16x16x32_bf16 v[148:151], a[116:119], a[36:39], v[148:151]
v_mfma_f32_16x16x32_bf16 v[172:175], a[116:119], a[44:47], v[172:175]
v_mfma_f32_16x16x32_bf16 v[172:175], a[112:115], a[40:43], v[172:175]
v_mfma_f32_16x16x32_bf16 v[196:199], a[112:115], a[48:51], v[196:199]
buffer_load_dwordx4 a[12:15], v2, s[40:43], s33 offen offset:1024 sc1
v_mfma_f32_16x16x32_bf16 v[196:199], a[116:119], a[52:55], v[196:199]
v_mfma_f32_16x16x32_bf16 v[220:223], a[116:119], a[60:63], v[220:223]
v_mfma_f32_16x16x32_bf16 v[220:223], a[112:115], a[56:59], v[220:223]
s_waitcnt lgkmcnt(0)
v_mfma_f32_16x16x32_bf16 v[224:227], a[128:131], a[56:59], v[224:227]
ds_read_b128 a[96:99], v5 offset:26624
v_mfma_f32_16x16x32_bf16 v[224:227], a[132:135], a[60:63], v[224:227]
buffer_load_dwordx4 a[16:19], v2, s[40:43], s35 offen offset:2048 sc1
v_mfma_f32_16x16x32_bf16 v[200:203], a[132:135], a[52:55], v[200:203]
ds_read_b128 a[100:103], v5 offset:32768
v_mfma_f32_16x16x32_bf16 v[200:203], a[128:131], a[48:51], v[200:203]
v_mfma_f32_16x16x32_bf16 v[176:179], a[128:131], a[40:43], v[176:179]
v_mfma_f32_16x16x32_bf16 v[176:179], a[132:135], a[44:47], v[176:179]
buffer_load_dwordx4 a[20:23], v2, s[40:43], s33 offen offset:2048 sc1
v_mfma_f32_16x16x32_bf16 v[152:155], a[132:135], a[36:39], v[152:155]
ds_read_b128 a[104:107], v5 offset:27648
v_mfma_f32_16x16x32_bf16 v[152:155], a[128:131], a[32:35], v[152:155]
v_mfma_f32_16x16x32_bf16 v[132:135], a[136:139], a[32:35], v[132:135]
ds_read_b128 a[108:111], v5 offset:33792
v_mfma_f32_16x16x32_bf16 v[132:135], a[140:143], a[36:39], v[132:135]
v_mfma_f32_16x16x32_bf16 v[156:159], a[140:143], a[44:47], v[156:159]
buffer_load_dwordx4 v[104:107], v1, s[4:7], s88 offen offset:3072 sc1
s_add_u32 s88, s88, 4096
v_mfma_f32_16x16x32_bf16 v[156:159], a[136:139], a[40:43], v[156:159]
ds_read_b128 a[112:115], v5 offset:28672
v_mfma_f32_16x16x32_bf16 v[180:183], a[136:139], a[48:51], v[180:183]
v_mfma_f32_16x16x32_bf16 v[180:183], a[140:143], a[52:55], v[180:183]
ds_read_b128 a[116:119], v5 offset:34816
v_mfma_f32_16x16x32_bf16 v[204:207], a[140:143], a[60:63], v[204:207]
v_mfma_f32_16x16x32_bf16 v[204:207], a[136:139], a[56:59], v[204:207]
buffer_load_dwordx4 a[24:27], v2, s[40:43], s35 offen offset:3072 sc1
v_mfma_f32_16x16x32_bf16 v[208:211], a[144:147], a[56:59], v[208:211]
v_mfma_f32_16x16x32_bf16 v[208:211], a[148:151], a[60:63], v[208:211]
v_mfma_f32_16x16x32_bf16 v[184:187], a[148:151], a[52:55], v[184:187]
v_mfma_f32_16x16x32_bf16 v[184:187], a[144:147], a[48:51], v[184:187]
v_mfma_f32_16x16x32_bf16 v[160:163], a[144:147], a[40:43], v[160:163]
buffer_load_dwordx4 a[28:31], v2, s[40:43], s33 offen offset:3072 sc1
s_add_u32 s35, s35, 8192
v_mfma_f32_16x16x32_bf16 v[160:163], a[148:151], a[44:47], v[160:163]
s_add_u32 s33, s33, 8192
v_mfma_f32_16x16x32_bf16 v[136:139], a[148:151], a[36:39], v[136:139]
v_mfma_f32_16x16x32_bf16 v[136:139], a[144:147], a[32:35], v[136:139]
s_waitcnt vmcnt(10) lgkmcnt(0)
v_mfma_f32_16x16x32_bf16 v[140:143], a[96:99], a[64:67], v[140:143]
ds_read_b128 a[128:131], v5 offset:29696
v_mfma_f32_16x16x32_bf16 v[140:143], a[100:103], a[68:71], v[140:143]
buffer_load_dwordx4 a[32:35], v2, s[40:43], s35 offen offset:0 sc1
v_mfma_f32_16x16x32_bf16 v[164:167], a[100:103], a[76:79], v[164:167]
ds_read_b128 a[132:135], v5 offset:35840
v_mfma_f32_16x16x32_bf16 v[164:167], a[96:99], a[72:75], v[164:167]
v_mfma_f32_16x16x32_bf16 v[188:191], a[96:99], a[80:83], v[188:191]
v_mfma_f32_16x16x32_bf16 v[188:191], a[100:103], a[84:87], v[188:191]
buffer_load_dwordx4 a[36:39], v2, s[40:43], s33 offen offset:0 sc1
v_mfma_f32_16x16x32_bf16 v[212:215], a[100:103], a[92:95], v[212:215]
ds_read_b128 a[136:139], v5 offset:24576
v_mfma_f32_16x16x32_bf16 v[212:215], a[96:99], a[88:91], v[212:215]
v_mfma_f32_16x16x32_bf16 v[216:219], a[104:107], a[88:91], v[216:219]
ds_read_b128 a[140:143], v5 offset:30720
v_mfma_f32_16x16x32_bf16 v[216:219], a[108:111], a[92:95], v[216:219]
v_mfma_f32_16x16x32_bf16 v[192:195], a[108:111], a[84:87], v[192:195]
buffer_load_dwordx4 v[108:111], v1, s[4:7], s88 offen offset:0 sc1
v_mfma_f32_16x16x32_bf16 v[192:195], a[104:107], a[80:83], v[192:195]
ds_read_b128 a[144:147], v5 offset:25600
v_mfma_f32_16x16x32_bf16 v[168:171], a[104:107], a[72:75], v[168:171]
v_mfma_f32_16x16x32_bf16 v[168:171], a[108:111], a[76:79], v[168:171]
ds_read_b128 a[148:151], v5 offset:31744
v_mfma_f32_16x16x32_bf16 v[144:147], a[108:111], a[68:71], v[144:147]
v_mfma_f32_16x16x32_bf16 v[144:147], a[104:107], a[64:67], v[144:147]
buffer_load_dwordx4 a[40:43], v2, s[40:43], s35 offen offset:1024 sc1
v_mfma_f32_16x16x32_bf16 v[148:151], a[112:115], a[64:67], v[148:151]
v_mfma_f32_16x16x32_bf16 v[148:151], a[116:119], a[68:71], v[148:151]
v_mfma_f32_16x16x32_bf16 v[172:175], a[116:119], a[76:79], v[172:175]
v_mfma_f32_16x16x32_bf16 v[172:175], a[112:115], a[72:75], v[172:175]
v_mfma_f32_16x16x32_bf16 v[196:199], a[112:115], a[80:83], v[196:199]
buffer_load_dwordx4 a[44:47], v2, s[40:43], s33 offen offset:1024 sc1
v_mfma_f32_16x16x32_bf16 v[196:199], a[116:119], a[84:87], v[196:199]
v_mfma_f32_16x16x32_bf16 v[220:223], a[116:119], a[92:95], v[220:223]
v_mfma_f32_16x16x32_bf16 v[220:223], a[112:115], a[88:91], v[220:223]
s_waitcnt lgkmcnt(0)
v_mfma_f32_16x16x32_bf16 v[224:227], a[128:131], a[88:91], v[224:227]
ds_read_b128 a[96:99], v5 offset:38912
v_mfma_f32_16x16x32_bf16 v[224:227], a[132:135], a[92:95], v[224:227]
buffer_load_dwordx4 a[48:51], v2, s[40:43], s35 offen offset:2048 sc1
v_mfma_f32_16x16x32_bf16 v[200:203], a[132:135], a[84:87], v[200:203]
ds_read_b128 a[100:103], v5 offset:45056
v_mfma_f32_16x16x32_bf16 v[200:203], a[128:131], a[80:83], v[200:203]
v_mfma_f32_16x16x32_bf16 v[176:179], a[128:131], a[72:75], v[176:179]
v_mfma_f32_16x16x32_bf16 v[176:179], a[132:135], a[76:79], v[176:179]
buffer_load_dwordx4 v[112:115], v1, s[4:7], s88 offen offset:1024 sc1
v_mfma_f32_16x16x32_bf16 v[152:155], a[132:135], a[68:71], v[152:155]
ds_read_b128 a[104:107], v5 offset:39936
v_mfma_f32_16x16x32_bf16 v[152:155], a[128:131], a[64:67], v[152:155]
v_mfma_f32_16x16x32_bf16 v[132:135], a[136:139], a[64:67], v[132:135]
ds_read_b128 a[108:111], v5 offset:46080
v_mfma_f32_16x16x32_bf16 v[132:135], a[140:143], a[68:71], v[132:135]
buffer_load_dwordx4 a[52:55], v2, s[40:43], s33 offen offset:2048 sc1
v_mfma_f32_16x16x32_bf16 v[156:159], a[140:143], a[76:79], v[156:159]
ds_read_b128 a[112:115], v5 offset:40960
v_mfma_f32_16x16x32_bf16 v[156:159], a[136:139], a[72:75], v[156:159]
v_mfma_f32_16x16x32_bf16 v[180:183], a[136:139], a[80:83], v[180:183]
v_mfma_f32_16x16x32_bf16 v[180:183], a[140:143], a[84:87], v[180:183]
buffer_load_dwordx4 a[56:59], v2, s[40:43], s35 offen offset:3072 sc1
v_mfma_f32_16x16x32_bf16 v[204:207], a[140:143], a[92:95], v[204:207]
ds_read_b128 a[116:119], v5 offset:47104
v_mfma_f32_16x16x32_bf16 v[204:207], a[136:139], a[88:91], v[204:207]
v_mfma_f32_16x16x32_bf16 v[208:211], a[144:147], a[88:91], v[208:211]
v_mfma_f32_16x16x32_bf16 v[208:211], a[148:151], a[92:95], v[208:211]
buffer_load_dwordx4 v[116:119], v1, s[4:7], s88 offen offset:2048 sc1
v_mfma_f32_16x16x32_bf16 v[184:187], a[148:151], a[84:87], v[184:187]
v_mfma_f32_16x16x32_bf16 v[184:187], a[144:147], a[80:83], v[184:187]
v_mfma_f32_16x16x32_bf16 v[160:163], a[144:147], a[72:75], v[160:163]
v_mfma_f32_16x16x32_bf16 v[160:163], a[148:151], a[76:79], v[160:163]
buffer_load_dwordx4 a[60:63], v2, s[40:43], s33 offen offset:3072 sc1
s_add_u32 s35, s35, 8192
v_mfma_f32_16x16x32_bf16 v[136:139], a[148:151], a[68:71], v[136:139]
s_add_u32 s33, s33, 8192
v_mfma_f32_16x16x32_bf16 v[136:139], a[144:147], a[64:67], v[136:139]
s_waitcnt vmcnt(11) lgkmcnt(0)
v_mfma_f32_16x16x32_bf16 v[140:143], a[96:99], a[0:3], v[140:143]
ds_read_b128 a[128:131], v5 offset:41984
v_mfma_f32_16x16x32_bf16 v[140:143], a[100:103], a[4:7], v[140:143]
buffer_load_dwordx4 a[64:67], v2, s[40:43], s35 offen offset:0 sc1
v_mfma_f32_16x16x32_bf16 v[164:167], a[100:103], a[12:15], v[164:167]
ds_read_b128 a[132:135], v5 offset:48128
v_mfma_f32_16x16x32_bf16 v[164:167], a[96:99], a[8:11], v[164:167]
v_mfma_f32_16x16x32_bf16 v[188:191], a[96:99], a[16:19], v[188:191]
v_mfma_f32_16x16x32_bf16 v[188:191], a[100:103], a[20:23], v[188:191]
buffer_load_dwordx4 a[68:71], v2, s[40:43], s33 offen offset:0 sc1
v_mfma_f32_16x16x32_bf16 v[212:215], a[100:103], a[28:31], v[212:215]
ds_read_b128 a[136:139], v5 offset:36864
v_mfma_f32_16x16x32_bf16 v[212:215], a[96:99], a[24:27], v[212:215]
v_mfma_f32_16x16x32_bf16 v[216:219], a[104:107], a[24:27], v[216:219]
ds_read_b128 a[140:143], v5 offset:43008
v_mfma_f32_16x16x32_bf16 v[216:219], a[108:111], a[28:31], v[216:219]
v_mfma_f32_16x16x32_bf16 v[192:195], a[108:111], a[20:23], v[192:195]
buffer_load_dwordx4 v[120:123], v1, s[4:7], s88 offen offset:3072 sc1
s_add_u32 m0, s18, 0x1e000
v_mfma_f32_16x16x32_bf16 v[192:195], a[104:107], a[16:19], v[192:195]
s_add_u32 s44, s50, 0x141e000
ds_read_b128 a[144:147], v5 offset:37888
v_mfma_f32_16x16x32_bf16 v[168:171], a[104:107], a[8:11], v[168:171]
v_mfma_f32_16x16x32_bf16 v[168:171], a[108:111], a[12:15], v[168:171]
ds_read_b128 a[148:151], v5 offset:44032
v_mfma_f32_16x16x32_bf16 v[144:147], a[108:111], a[4:7], v[144:147]
v_mfma_f32_16x16x32_bf16 v[144:147], a[104:107], a[0:3], v[144:147]
buffer_load_dwordx4 a[72:75], v2, s[40:43], s35 offen offset:1024 sc1
v_mfma_f32_16x16x32_bf16 v[148:151], a[112:115], a[0:3], v[148:151]
v_mfma_f32_16x16x32_bf16 v[148:151], a[116:119], a[4:7], v[148:151]
v_mfma_f32_16x16x32_bf16 v[172:175], a[116:119], a[12:15], v[172:175]
v_mfma_f32_16x16x32_bf16 v[172:175], a[112:115], a[8:11], v[172:175]
v_mfma_f32_16x16x32_bf16 v[196:199], a[112:115], a[16:19], v[196:199]
buffer_load_dwordx4 a[76:79], v2, s[40:43], s33 offen offset:1024 sc1
v_mfma_f32_16x16x32_bf16 v[196:199], a[116:119], a[20:23], v[196:199]
v_mfma_f32_16x16x32_bf16 v[220:223], a[116:119], a[28:31], v[220:223]
v_mfma_f32_16x16x32_bf16 v[220:223], a[112:115], a[24:27], v[220:223]
s_waitcnt lgkmcnt(0)
s_barrier
v_mfma_f32_16x16x32_bf16 v[224:227], a[128:131], a[24:27], v[224:227]
v_add_u32 v5, 49152, v1
v_mfma_f32_16x16x32_bf16 v[224:227], a[132:135], a[28:31], v[224:227]
buffer_load_dwordx4 a[80:83], v2, s[40:43], s35 offen offset:2048 sc1
v_mfma_f32_16x16x32_bf16 v[200:203], a[132:135], a[20:23], v[200:203]
ds_read_b128 a[96:99], v5 offset:2048
v_mfma_f32_16x16x32_bf16 v[200:203], a[128:131], a[16:19], v[200:203]
ds_read_b128 a[100:103], v5 offset:8192
v_mfma_f32_16x16x32_bf16 v[176:179], a[128:131], a[8:11], v[176:179]
v_mfma_f32_16x16x32_bf16 v[176:179], a[132:135], a[12:15], v[176:179]
buffer_load_dwordx4 a[84:87], v2, s[40:43], s33 offen offset:2048 sc1
v_mfma_f32_16x16x32_bf16 v[152:155], a[132:135], a[4:7], v[152:155]
ds_read_b128 a[104:107], v5 offset:3072
v_mfma_f32_16x16x32_bf16 v[152:155], a[128:131], a[0:3], v[152:155]
v_mfma_f32_16x16x32_bf16 v[132:135], a[136:139], a[0:3], v[132:135]
ds_read_b128 a[108:111], v5 offset:9216
v_mfma_f32_16x16x32_bf16 v[132:135], a[140:143], a[4:7], v[132:135]
v_mfma_f32_16x16x32_bf16 v[156:159], a[140:143], a[12:15], v[156:159]
buffer_load_dwordx4 v1, s[4:7], s44 offen offset:0 sc1 lds
v_mfma_f32_16x16x32_bf16 v[156:159], a[136:139], a[8:11], v[156:159]
ds_read_b128 a[112:115], v5 offset:4096
v_mfma_f32_16x16x32_bf16 v[180:183], a[136:139], a[16:19], v[180:183]
v_mfma_f32_16x16x32_bf16 v[180:183], a[140:143], a[20:23], v[180:183]
ds_read_b128 a[116:119], v5 offset:10240
v_mfma_f32_16x16x32_bf16 v[204:207], a[140:143], a[28:31], v[204:207]
v_mfma_f32_16x16x32_bf16 v[204:207], a[136:139], a[24:27], v[204:207]
buffer_load_dwordx4 a[88:91], v2, s[40:43], s35 offen offset:3072 sc1
v_mfma_f32_16x16x32_bf16 v[208:211], a[144:147], a[24:27], v[208:211]
v_mfma_f32_16x16x32_bf16 v[208:211], a[148:151], a[28:31], v[208:211]
v_mfma_f32_16x16x32_bf16 v[184:187], a[148:151], a[20:23], v[184:187]
v_mfma_f32_16x16x32_bf16 v[184:187], a[144:147], a[16:19], v[184:187]
v_mfma_f32_16x16x32_bf16 v[160:163], a[144:147], a[8:11], v[160:163]
buffer_load_dwordx4 a[92:95], v2, s[40:43], s33 offen offset:3072 sc1
s_add_u32 s35, s35, 8192
v_mfma_f32_16x16x32_bf16 v[160:163], a[148:151], a[12:15], v[160:163]
s_add_u32 s33, s33, 8192
v_mfma_f32_16x16x32_bf16 v[136:139], a[148:151], a[4:7], v[136:139]
v_mfma_f32_16x16x32_bf16 v[136:139], a[144:147], a[0:3], v[136:139]
s_waitcnt vmcnt(10) lgkmcnt(0)
v_mfma_f32_16x16x32_bf16 v[140:143], a[96:99], a[32:35], v[140:143]
ds_read_b128 a[128:131], v5 offset:5120
v_mfma_f32_16x16x32_bf16 v[140:143], a[100:103], a[36:39], v[140:143]
buffer_load_dwordx4 a[0:3], v2, s[40:43], s35 offen offset:0 sc1
v_mfma_f32_16x16x32_bf16 v[164:167], a[100:103], a[44:47], v[164:167]
ds_read_b128 a[132:135], v5 offset:11264
v_mfma_f32_16x16x32_bf16 v[164:167], a[96:99], a[40:43], v[164:167]
v_mfma_f32_16x16x32_bf16 v[188:191], a[96:99], a[48:51], v[188:191]
v_mfma_f32_16x16x32_bf16 v[188:191], a[100:103], a[52:55], v[188:191]
buffer_load_dwordx4 a[4:7], v2, s[40:43], s33 offen offset:0 sc1
v_mfma_f32_16x16x32_bf16 v[212:215], a[100:103], a[60:63], v[212:215]
ds_read_b128 a[136:139], v5 offset:0
v_mfma_f32_16x16x32_bf16 v[212:215], a[96:99], a[56:59], v[212:215]
v_mfma_f32_16x16x32_bf16 v[216:219], a[104:107], a[56:59], v[216:219]
ds_read_b128 a[140:143], v5 offset:6144
v_mfma_f32_16x16x32_bf16 v[216:219], a[108:111], a[60:63], v[216:219]
v_mfma_f32_16x16x32_bf16 v[192:195], a[108:111], a[52:55], v[192:195]
buffer_load_dwordx4 v1, s[4:7], s44 offen offset:1024 sc1 lds
v_mfma_f32_16x16x32_bf16 v[192:195], a[104:107], a[48:51], v[192:195]
ds_read_b128 a[144:147], v5 offset:1024
v_mfma_f32_16x16x32_bf16 v[168:171], a[104:107], a[40:43], v[168:171]
v_mfma_f32_16x16x32_bf16 v[168:171], a[108:111], a[44:47], v[168:171]
ds_read_b128 a[148:151], v5 offset:7168
v_mfma_f32_16x16x32_bf16 v[144:147], a[108:111], a[36:39], v[144:147]
v_mfma_f32_16x16x32_bf16 v[144:147], a[104:107], a[32:35], v[144:147]
buffer_load_dwordx4 a[8:11], v2, s[40:43], s35 offen offset:1024 sc1
v_mfma_f32_16x16x32_bf16 v[148:151], a[112:115], a[32:35], v[148:151]
v_mfma_f32_16x16x32_bf16 v[148:151], a[116:119], a[36:39], v[148:151]
v_mfma_f32_16x16x32_bf16 v[172:175], a[116:119], a[44:47], v[172:175]
v_mfma_f32_16x16x32_bf16 v[172:175], a[112:115], a[40:43], v[172:175]
v_mfma_f32_16x16x32_bf16 v[196:199], a[112:115], a[48:51], v[196:199]
buffer_load_dwordx4 a[12:15], v2, s[40:43], s33 offen offset:1024 sc1
v_mfma_f32_16x16x32_bf16 v[196:199], a[116:119], a[52:55], v[196:199]
v_mfma_f32_16x16x32_bf16 v[220:223], a[116:119], a[60:63], v[220:223]
v_mfma_f32_16x16x32_bf16 v[220:223], a[112:115], a[56:59], v[220:223]
s_waitcnt lgkmcnt(0)
v_mfma_f32_16x16x32_bf16 v[224:227], a[128:131], a[56:59], v[224:227]
ds_read_b128 a[96:99], v5 offset:14336
v_mfma_f32_16x16x32_bf16 v[224:227], a[132:135], a[60:63], v[224:227]
buffer_load_dwordx4 a[16:19], v2, s[40:43], s35 offen offset:2048 sc1
v_mfma_f32_16x16x32_bf16 v[200:203], a[132:135], a[52:55], v[200:203]
ds_read_b128 a[100:103], v5 offset:20480
v_mfma_f32_16x16x32_bf16 v[200:203], a[128:131], a[48:51], v[200:203]
v_mfma_f32_16x16x32_bf16 v[176:179], a[128:131], a[40:43], v[176:179]
v_mfma_f32_16x16x32_bf16 v[176:179], a[132:135], a[44:47], v[176:179]
buffer_load_dwordx4 a[20:23], v2, s[40:43], s33 offen offset:2048 sc1
v_mfma_f32_16x16x32_bf16 v[152:155], a[132:135], a[36:39], v[152:155]
ds_read_b128 a[104:107], v5 offset:15360
v_mfma_f32_16x16x32_bf16 v[152:155], a[128:131], a[32:35], v[152:155]
v_mfma_f32_16x16x32_bf16 v[132:135], a[136:139], a[32:35], v[132:135]
ds_read_b128 a[108:111], v5 offset:21504
v_mfma_f32_16x16x32_bf16 v[132:135], a[140:143], a[36:39], v[132:135]
v_mfma_f32_16x16x32_bf16 v[156:159], a[140:143], a[44:47], v[156:159]
buffer_load_dwordx4 v1, s[4:7], s44 offen offset:2048 sc1 lds
s_add_u32 m0, s18, 0x21000
v_mfma_f32_16x16x32_bf16 v[156:159], a[136:139], a[40:43], v[156:159]
s_add_u32 s44, s50, 0x1421000
ds_read_b128 a[112:115], v5 offset:16384
v_mfma_f32_16x16x32_bf16 v[180:183], a[136:139], a[48:51], v[180:183]
v_mfma_f32_16x16x32_bf16 v[180:183], a[140:143], a[52:55], v[180:183]
ds_read_b128 a[116:119], v5 offset:22528
v_mfma_f32_16x16x32_bf16 v[204:207], a[140:143], a[60:63], v[204:207]
v_mfma_f32_16x16x32_bf16 v[204:207], a[136:139], a[56:59], v[204:207]
buffer_load_dwordx4 a[24:27], v2, s[40:43], s35 offen offset:3072 sc1
v_mfma_f32_16x16x32_bf16 v[208:211], a[144:147], a[56:59], v[208:211]
v_mfma_f32_16x16x32_bf16 v[208:211], a[148:151], a[60:63], v[208:211]
v_mfma_f32_16x16x32_bf16 v[184:187], a[148:151], a[52:55], v[184:187]
v_mfma_f32_16x16x32_bf16 v[184:187], a[144:147], a[48:51], v[184:187]
v_mfma_f32_16x16x32_bf16 v[160:163], a[144:147], a[40:43], v[160:163]
buffer_load_dwordx4 a[28:31], v2, s[40:43], s33 offen offset:3072 sc1
s_add_u32 s35, s35, 8192
v_mfma_f32_16x16x32_bf16 v[160:163], a[148:151], a[44:47], v[160:163]
s_add_u32 s33, s33, 8192
v_mfma_f32_16x16x32_bf16 v[136:139], a[148:151], a[36:39], v[136:139]
v_mfma_f32_16x16x32_bf16 v[136:139], a[144:147], a[32:35], v[136:139]
s_waitcnt vmcnt(10) lgkmcnt(0)
v_mfma_f32_16x16x32_bf16 v[140:143], a[96:99], a[64:67], v[140:143]
ds_read_b128 a[128:131], v5 offset:17408
v_mfma_f32_16x16x32_bf16 v[140:143], a[100:103], a[68:71], v[140:143]
buffer_load_dwordx4 a[32:35], v2, s[40:43], s35 offen offset:0 sc1
v_mfma_f32_16x16x32_bf16 v[164:167], a[100:103], a[76:79], v[164:167]
ds_read_b128 a[132:135], v5 offset:23552
v_mfma_f32_16x16x32_bf16 v[164:167], a[96:99], a[72:75], v[164:167]
v_mfma_f32_16x16x32_bf16 v[188:191], a[96:99], a[80:83], v[188:191]
v_mfma_f32_16x16x32_bf16 v[188:191], a[100:103], a[84:87], v[188:191]
buffer_load_dwordx4 a[36:39], v2, s[40:43], s33 offen offset:0 sc1
v_mfma_f32_16x16x32_bf16 v[212:215], a[100:103], a[92:95], v[212:215]
ds_read_b128 a[136:139], v5 offset:12288
v_mfma_f32_16x16x32_bf16 v[212:215], a[96:99], a[88:91], v[212:215]
v_mfma_f32_16x16x32_bf16 v[216:219], a[104:107], a[88:91], v[216:219]
ds_read_b128 a[140:143], v5 offset:18432
v_mfma_f32_16x16x32_bf16 v[216:219], a[108:111], a[92:95], v[216:219]
v_mfma_f32_16x16x32_bf16 v[192:195], a[108:111], a[84:87], v[192:195]
buffer_load_dwordx4 v1, s[4:7], s44 offen offset:0 sc1 lds
v_mfma_f32_16x16x32_bf16 v[192:195], a[104:107], a[80:83], v[192:195]
ds_read_b128 a[144:147], v5 offset:13312
v_mfma_f32_16x16x32_bf16 v[168:171], a[104:107], a[72:75], v[168:171]
v_mfma_f32_16x16x32_bf16 v[168:171], a[108:111], a[76:79], v[168:171]
ds_read_b128 a[148:151], v5 offset:19456
v_mfma_f32_16x16x32_bf16 v[144:147], a[108:111], a[68:71], v[144:147]
v_mfma_f32_16x16x32_bf16 v[144:147], a[104:107], a[64:67], v[144:147]
buffer_load_dwordx4 a[40:43], v2, s[40:43], s35 offen offset:1024 sc1
v_mfma_f32_16x16x32_bf16 v[148:151], a[112:115], a[64:67], v[148:151]
v_mfma_f32_16x16x32_bf16 v[148:151], a[116:119], a[68:71], v[148:151]
v_mfma_f32_16x16x32_bf16 v[172:175], a[116:119], a[76:79], v[172:175]
v_mfma_f32_16x16x32_bf16 v[172:175], a[112:115], a[72:75], v[172:175]
v_mfma_f32_16x16x32_bf16 v[196:199], a[112:115], a[80:83], v[196:199]
buffer_load_dwordx4 a[44:47], v2, s[40:43], s33 offen offset:1024 sc1
v_mfma_f32_16x16x32_bf16 v[196:199], a[116:119], a[84:87], v[196:199]
v_mfma_f32_16x16x32_bf16 v[220:223], a[116:119], a[92:95], v[220:223]
v_mfma_f32_16x16x32_bf16 v[220:223], a[112:115], a[88:91], v[220:223]
s_waitcnt lgkmcnt(0)
v_mfma_f32_16x16x32_bf16 v[224:227], a[128:131], a[88:91], v[224:227]
ds_read_b128 a[96:99], v5 offset:26624
v_mfma_f32_16x16x32_bf16 v[224:227], a[132:135], a[92:95], v[224:227]
buffer_load_dwordx4 a[48:51], v2, s[40:43], s35 offen offset:2048 sc1
v_mfma_f32_16x16x32_bf16 v[200:203], a[132:135], a[84:87], v[200:203]
ds_read_b128 a[100:103], v5 offset:32768
v_mfma_f32_16x16x32_bf16 v[200:203], a[128:131], a[80:83], v[200:203]
v_mfma_f32_16x16x32_bf16 v[176:179], a[128:131], a[72:75], v[176:179]
v_mfma_f32_16x16x32_bf16 v[176:179], a[132:135], a[76:79], v[176:179]
buffer_load_dwordx4 a[52:55], v2, s[40:43], s33 offen offset:2048 sc1
v_mfma_f32_16x16x32_bf16 v[152:155], a[132:135], a[68:71], v[152:155]
ds_read_b128 a[104:107], v5 offset:27648
v_mfma_f32_16x16x32_bf16 v[152:155], a[128:131], a[64:67], v[152:155]
v_mfma_f32_16x16x32_bf16 v[132:135], a[136:139], a[64:67], v[132:135]
ds_read_b128 a[108:111], v5 offset:33792
v_mfma_f32_16x16x32_bf16 v[132:135], a[140:143], a[68:71], v[132:135]
v_mfma_f32_16x16x32_bf16 v[156:159], a[140:143], a[76:79], v[156:159]
buffer_load_dwordx4 v1, s[4:7], s44 offen offset:1024 sc1 lds
v_mfma_f32_16x16x32_bf16 v[156:159], a[136:139], a[72:75], v[156:159]
ds_read_b128 a[112:115], v5 offset:28672
v_mfma_f32_16x16x32_bf16 v[180:183], a[136:139], a[80:83], v[180:183]
v_mfma_f32_16x16x32_bf16 v[180:183], a[140:143], a[84:87], v[180:183]
ds_read_b128 a[116:119], v5 offset:34816
v_mfma_f32_16x16x32_bf16 v[204:207], a[140:143], a[92:95], v[204:207]
v_mfma_f32_16x16x32_bf16 v[204:207], a[136:139], a[88:91], v[204:207]
buffer_load_dwordx4 a[56:59], v2, s[40:43], s35 offen offset:3072 sc1
v_mfma_f32_16x16x32_bf16 v[208:211], a[144:147], a[88:91], v[208:211]
v_mfma_f32_16x16x32_bf16 v[208:211], a[148:151], a[92:95], v[208:211]
v_mfma_f32_16x16x32_bf16 v[184:187], a[148:151], a[84:87], v[184:187]
v_mfma_f32_16x16x32_bf16 v[184:187], a[144:147], a[80:83], v[184:187]
v_mfma_f32_16x16x32_bf16 v[160:163], a[144:147], a[72:75], v[160:163]
buffer_load_dwordx4 a[60:63], v2, s[40:43], s33 offen offset:3072 sc1
s_add_u32 s35, s35, 8192
v_mfma_f32_16x16x32_bf16 v[160:163], a[148:151], a[76:79], v[160:163]
s_add_u32 s33, s33, 8192
v_mfma_f32_16x16x32_bf16 v[136:139], a[148:151], a[68:71], v[136:139]
v_mfma_f32_16x16x32_bf16 v[136:139], a[144:147], a[64:67], v[136:139]
s_waitcnt vmcnt(10) lgkmcnt(0)
v_mfma_f32_16x16x32_bf16 v[140:143], a[96:99], a[0:3], v[140:143]
ds_read_b128 a[128:131], v5 offset:29696
v_mfma_f32_16x16x32_bf16 v[140:143], a[100:103], a[4:7], v[140:143]
buffer_load_dwordx4 a[64:67], v2, s[40:43], s35 offen offset:0 sc1
v_mfma_f32_16x16x32_bf16 v[164:167], a[100:103], a[12:15], v[164:167]
ds_read_b128 a[132:135], v5 offset:35840
v_mfma_f32_16x16x32_bf16 v[164:167], a[96:99], a[8:11], v[164:167]
v_mfma_f32_16x16x32_bf16 v[188:191], a[96:99], a[16:19], v[188:191]
v_mfma_f32_16x16x32_bf16 v[188:191], a[100:103], a[20:23], v[188:191]
buffer_load_dwordx4 a[68:71], v2, s[40:43], s33 offen offset:0 sc1
v_mfma_f32_16x16x32_bf16 v[212:215], a[100:103], a[28:31], v[212:215]
ds_read_b128 a[136:139], v5 offset:24576
v_mfma_f32_16x16x32_bf16 v[212:215], a[96:99], a[24:27], v[212:215]
v_mfma_f32_16x16x32_bf16 v[216:219], a[104:107], a[24:27], v[216:219]
ds_read_b128 a[140:143], v5 offset:30720
v_mfma_f32_16x16x32_bf16 v[216:219], a[108:111], a[28:31], v[216:219]
v_mfma_f32_16x16x32_bf16 v[192:195], a[108:111], a[20:23], v[192:195]
buffer_load_dwordx4 v1, s[4:7], s44 offen offset:2048 sc1 lds
s_add_u32 m0, s18, 0x0
v_mfma_f32_16x16x32_bf16 v[192:195], a[104:107], a[16:19], v[192:195]
s_add_u32 s44, s50, 0x1424000
ds_read_b128 a[144:147], v5 offset:25600
v_mfma_f32_16x16x32_bf16 v[168:171], a[104:107], a[8:11], v[168:171]
v_mfma_f32_16x16x32_bf16 v[168:171], a[108:111], a[12:15], v[168:171]
ds_read_b128 a[148:151], v5 offset:31744
v_mfma_f32_16x16x32_bf16 v[144:147], a[108:111], a[4:7], v[144:147]
v_mfma_f32_16x16x32_bf16 v[144:147], a[104:107], a[0:3], v[144:147]
buffer_load_dwordx4 a[72:75], v2, s[40:43], s35 offen offset:1024 sc1
v_mfma_f32_16x16x32_bf16 v[148:151], a[112:115], a[0:3], v[148:151]
v_mfma_f32_16x16x32_bf16 v[148:151], a[116:119], a[4:7], v[148:151]
v_mfma_f32_16x16x32_bf16 v[172:175], a[116:119], a[12:15], v[172:175]
v_mfma_f32_16x16x32_bf16 v[172:175], a[112:115], a[8:11], v[172:175]
v_mfma_f32_16x16x32_bf16 v[196:199], a[112:115], a[16:19], v[196:199]
buffer_load_dwordx4 a[76:79], v2, s[40:43], s33 offen offset:1024 sc1
v_mfma_f32_16x16x32_bf16 v[196:199], a[116:119], a[20:23], v[196:199]
v_mfma_f32_16x16x32_bf16 v[220:223], a[116:119], a[28:31], v[220:223]
v_mfma_f32_16x16x32_bf16 v[220:223], a[112:115], a[24:27], v[220:223]
s_waitcnt lgkmcnt(0)
v_mfma_f32_16x16x32_bf16 v[224:227], a[128:131], a[24:27], v[224:227]
ds_read_b128 a[96:99], v5 offset:38912
v_mfma_f32_16x16x32_bf16 v[224:227], a[132:135], a[28:31], v[224:227]
buffer_load_dwordx4 a[80:83], v2, s[40:43], s35 offen offset:2048 sc1
v_mfma_f32_16x16x32_bf16 v[200:203], a[132:135], a[20:23], v[200:203]
ds_read_b128 a[100:103], v5 offset:45056
v_mfma_f32_16x16x32_bf16 v[200:203], a[128:131], a[16:19], v[200:203]
v_mfma_f32_16x16x32_bf16 v[176:179], a[128:131], a[8:11], v[176:179]
v_mfma_f32_16x16x32_bf16 v[176:179], a[132:135], a[12:15], v[176:179]
buffer_load_dwordx4 v1, s[4:7], s44 offen offset:0 sc1 lds
v_mfma_f32_16x16x32_bf16 v[152:155], a[132:135], a[4:7], v[152:155]
ds_read_b128 a[104:107], v5 offset:39936
v_mfma_f32_16x16x32_bf16 v[152:155], a[128:131], a[0:3], v[152:155]
v_mfma_f32_16x16x32_bf16 v[132:135], a[136:139], a[0:3], v[132:135]
ds_read_b128 a[108:111], v5 offset:46080
v_mfma_f32_16x16x32_bf16 v[132:135], a[140:143], a[4:7], v[132:135]
buffer_load_dwordx4 a[84:87], v2, s[40:43], s33 offen offset:2048 sc1
v_mfma_f32_16x16x32_bf16 v[156:159], a[140:143], a[12:15], v[156:159]
ds_read_b128 a[112:115], v5 offset:40960
v_mfma_f32_16x16x32_bf16 v[156:159], a[136:139], a[8:11], v[156:159]
v_mfma_f32_16x16x32_bf16 v[180:183], a[136:139], a[16:19], v[180:183]
v_mfma_f32_16x16x32_bf16 v[180:183], a[140:143], a[20:23], v[180:183]
buffer_load_dwordx4 a[88:91], v2, s[40:43], s35 offen offset:3072 sc1
v_mfma_f32_16x16x32_bf16 v[204:207], a[140:143], a[28:31], v[204:207]
ds_read_b128 a[116:119], v5 offset:47104
v_mfma_f32_16x16x32_bf16 v[204:207], a[136:139], a[24:27], v[204:207]
v_mfma_f32_16x16x32_bf16 v[208:211], a[144:147], a[24:27], v[208:211]
v_mfma_f32_16x16x32_bf16 v[208:211], a[148:151], a[28:31], v[208:211]
buffer_load_dwordx4 v1, s[4:7], s44 offen offset:1024 sc1 lds
v_mfma_f32_16x16x32_bf16 v[184:187], a[148:151], a[20:23], v[184:187]
v_mfma_f32_16x16x32_bf16 v[184:187], a[144:147], a[16:19], v[184:187]
v_mfma_f32_16x16x32_bf16 v[160:163], a[144:147], a[8:11], v[160:163]
v_mfma_f32_16x16x32_bf16 v[160:163], a[148:151], a[12:15], v[160:163]
buffer_load_dwordx4 a[92:95], v2, s[40:43], s33 offen offset:3072 sc1
s_add_u32 s35, s35, 8192
v_mfma_f32_16x16x32_bf16 v[136:139], a[148:151], a[4:7], v[136:139]
s_add_u32 s33, s33, 8192
v_mfma_f32_16x16x32_bf16 v[136:139], a[144:147], a[0:3], v[136:139]
s_waitcnt vmcnt(11) lgkmcnt(0)
v_mfma_f32_16x16x32_bf16 v[140:143], a[96:99], a[32:35], v[140:143]
ds_read_b128 a[128:131], v5 offset:41984
v_mfma_f32_16x16x32_bf16 v[140:143], a[100:103], a[36:39], v[140:143]
buffer_load_dwordx4 a[0:3], v2, s[40:43], s35 offen offset:0 sc1
v_mfma_f32_16x16x32_bf16 v[164:167], a[100:103], a[44:47], v[164:167]
ds_read_b128 a[132:135], v5 offset:48128
v_mfma_f32_16x16x32_bf16 v[164:167], a[96:99], a[40:43], v[164:167]
v_mfma_f32_16x16x32_bf16 v[188:191], a[96:99], a[48:51], v[188:191]
v_mfma_f32_16x16x32_bf16 v[188:191], a[100:103], a[52:55], v[188:191]
buffer_load_dwordx4 a[4:7], v2, s[40:43], s33 offen offset:0 sc1
v_mfma_f32_16x16x32_bf16 v[212:215], a[100:103], a[60:63], v[212:215]
ds_read_b128 a[136:139], v5 offset:36864
v_mfma_f32_16x16x32_bf16 v[212:215], a[96:99], a[56:59], v[212:215]
v_mfma_f32_16x16x32_bf16 v[216:219], a[104:107], a[56:59], v[216:219]
ds_read_b128 a[140:143], v5 offset:43008
v_mfma_f32_16x16x32_bf16 v[216:219], a[108:111], a[60:63], v[216:219]
v_mfma_f32_16x16x32_bf16 v[192:195], a[108:111], a[52:55], v[192:195]
buffer_load_dwordx4 v1, s[4:7], s44 offen offset:2048 sc1 lds
s_add_u32 m0, s18, 0x3000
v_mfma_f32_16x16x32_bf16 v[192:195], a[104:107], a[48:51], v[192:195]
s_add_u32 s44, s50, 0x1427000
ds_read_b128 a[144:147], v5 offset:37888
v_mfma_f32_16x16x32_bf16 v[168:171], a[104:107], a[40:43], v[168:171]
v_mfma_f32_16x16x32_bf16 v[168:171], a[108:111], a[44:47], v[168:171]
ds_read_b128 a[148:151], v5 offset:44032
v_mfma_f32_16x16x32_bf16 v[144:147], a[108:111], a[36:39], v[144:147]
v_mfma_f32_16x16x32_bf16 v[144:147], a[104:107], a[32:35], v[144:147]
buffer_load_dwordx4 a[8:11], v2, s[40:43], s35 offen offset:1024 sc1
v_mfma_f32_16x16x32_bf16 v[148:151], a[112:115], a[32:35], v[148:151]
v_mfma_f32_16x16x32_bf16 v[148:151], a[116:119], a[36:39], v[148:151]
v_mfma_f32_16x16x32_bf16 v[172:175], a[116:119], a[44:47], v[172:175]
v_mfma_f32_16x16x32_bf16 v[172:175], a[112:115], a[40:43], v[172:175]
v_mfma_f32_16x16x32_bf16 v[196:199], a[112:115], a[48:51], v[196:199]
buffer_load_dwordx4 a[12:15], v2, s[40:43], s33 offen offset:1024 sc1
v_mfma_f32_16x16x32_bf16 v[196:199], a[116:119], a[52:55], v[196:199]
v_mfma_f32_16x16x32_bf16 v[220:223], a[116:119], a[60:63], v[220:223]
v_mfma_f32_16x16x32_bf16 v[220:223], a[112:115], a[56:59], v[220:223]
s_waitcnt lgkmcnt(0)
s_barrier
v_mfma_f32_16x16x32_bf16 v[224:227], a[128:131], a[56:59], v[224:227]
v_add_u32 v5, 98304, v1
v_mfma_f32_16x16x32_bf16 v[224:227], a[132:135], a[60:63], v[224:227]
buffer_load_dwordx4 a[16:19], v2, s[40:43], s35 offen offset:2048 sc1
v_mfma_f32_16x16x32_bf16 v[200:203], a[132:135], a[52:55], v[200:203]
ds_read_b128 a[96:99], v5 offset:2048
v_mfma_f32_16x16x32_bf16 v[200:203], a[128:131], a[48:51], v[200:203]
ds_read_b128 a[100:103], v5 offset:8192
v_mfma_f32_16x16x32_bf16 v[176:179], a[128:131], a[40:43], v[176:179]
v_mfma_f32_16x16x32_bf16 v[176:179], a[132:135], a[44:47], v[176:179]
buffer_load_dwordx4 a[20:23], v2, s[40:43], s33 offen offset:2048 sc1
v_mfma_f32_16x16x32_bf16 v[152:155], a[132:135], a[36:39], v[152:155]
ds_read_b128 a[104:107], v5 offset:3072
v_mfma_f32_16x16x32_bf16 v[152:155], a[128:131], a[32:35], v[152:155]
v_mfma_f32_16x16x32_bf16 v[132:135], a[136:139], a[32:35], v[132:135]
ds_read_b128 a[108:111], v5 offset:9216
v_mfma_f32_16x16x32_bf16 v[132:135], a[140:143], a[36:39], v[132:135]
v_mfma_f32_16x16x32_bf16 v[156:159], a[140:143], a[44:47], v[156:159]
buffer_load_dwordx4 v1, s[4:7], s44 offen offset:0 sc1 lds
v_mfma_f32_16x16x32_bf16 v[156:159], a[136:139], a[40:43], v[156:159]
ds_read_b128 a[112:115], v5 offset:4096
v_mfma_f32_16x16x32_bf16 v[180:183], a[136:139], a[48:51], v[180:183]
v_mfma_f32_16x16x32_bf16 v[180:183], a[140:143], a[52:55], v[180:183]
ds_read_b128 a[116:119], v5 offset:10240
v_mfma_f32_16x16x32_bf16 v[204:207], a[140:143], a[60:63], v[204:207]
v_mfma_f32_16x16x32_bf16 v[204:207], a[136:139], a[56:59], v[204:207]
buffer_load_dwordx4 a[24:27], v2, s[40:43], s35 offen offset:3072 sc1
v_mfma_f32_16x16x32_bf16 v[208:211], a[144:147], a[56:59], v[208:211]
v_mfma_f32_16x16x32_bf16 v[208:211], a[148:151], a[60:63], v[208:211]
v_mfma_f32_16x16x32_bf16 v[184:187], a[148:151], a[52:55], v[184:187]
L_stub16:
s_cbranch_execz L_stub17
v_mfma_f32_16x16x32_bf16 v[184:187], a[144:147], a[48:51], v[184:187]
v_mfma_f32_16x16x32_bf16 v[160:163], a[144:147], a[40:43], v[160:163]
buffer_load_dwordx4 a[28:31], v2, s[40:43], s33 offen offset:3072 sc1
s_add_u32 s35, s35, 8192
v_mfma_f32_16x16x32_bf16 v[160:163], a[148:151], a[44:47], v[160:163]
s_add_u32 s33, s33, 8192
v_mfma_f32_16x16x32_bf16 v[136:139], a[148:151], a[36:39], v[136:139]
v_mfma_f32_16x16x32_bf16 v[136:139], a[144:147], a[32:35], v[136:139]
s_waitcnt vmcnt(10) lgkmcnt(0)
v_mfma_f32_16x16x32_bf16 v[140:143], a[96:99], a[64:67], v[140:143]
ds_read_b128 a[128:131], v5 offset:5120
v_mfma_f32_16x16x32_bf16 v[140:143], a[100:103], a[68:71], v[140:143]
buffer_load_dwordx4 a[32:35], v2, s[40:43], s35 offen offset:0 sc1
v_mfma_f32_16x16x32_bf16 v[164:167], a[100:103], a[76:79], v[164:167]
ds_read_b128 a[132:135], v5 offset:11264
v_mfma_f32_16x16x32_bf16 v[164:167], a[96:99], a[72:75], v[164:167]
v_mfma_f32_16x16x32_bf16 v[188:191], a[96:99], a[80:83], v[188:191]
v_mfma_f32_16x16x32_bf16 v[188:191], a[100:103], a[84:87], v[188:191]
buffer_load_dwordx4 a[36:39], v2, s[40:43], s33 offen offset:0 sc1
v_mfma_f32_16x16x32_bf16 v[212:215], a[100:103], a[92:95], v[212:215]
ds_read_b128 a[136:139], v5 offset:0
v_mfma_f32_16x16x32_bf16 v[212:215], a[96:99], a[88:91], v[212:215]
v_mfma_f32_16x16x32_bf16 v[216:219], a[104:107], a[88:91], v[216:219]
ds_read_b128 a[140:143], v5 offset:6144
v_mfma_f32_16x16x32_bf16 v[216:219], a[108:111], a[92:95], v[216:219]
v_mfma_f32_16x16x32_bf16 v[192:195], a[108:111], a[84:87], v[192:195]
buffer_load_dwordx4 v1, s[4:7], s44 offen offset:1024 sc1 lds
v_mfma_f32_16x16x32_bf16 v[192:195], a[104:107], a[80:83], v[192:195]
ds_read_b128 a[144:147], v5 offset:1024
v_mfma_f32_16x16x32_bf16 v[168:171], a[104:107], a[72:75], v[168:171]
v_mfma_f32_16x16x32_bf16 v[168:171], a[108:111], a[76:79], v[168:171]
ds_read_b128 a[148:151], v5 offset:7168
v_mfma_f32_16x16x32_bf16 v[144:147], a[108:111], a[68:71], v[144:147]
v_mfma_f32_16x16x32_bf16 v[144:147], a[104:107], a[64:67], v[144:147]
buffer_load_dwordx4 a[40:43], v2, s[40:43], s35 offen offset:1024 sc1
v_mfma_f32_16x16x32_bf16 v[148:151], a[112:115], a[64:67], v[148:151]
v_mfma_f32_16x16x32_bf16 v[148:151], a[116:119], a[68:71], v[148:151]
v_mfma_f32_16x16x32_bf16 v[172:175], a[116:119], a[76:79], v[172:175]
v_mfma_f32_16x16x32_bf16 v[172:175], a[112:115], a[72:75], v[172:175]
v_mfma_f32_16x16x32_bf16 v[196:199], a[112:115], a[80:83], v[196:199]
buffer_load_dwordx4 a[44:47], v2, s[40:43], s33 offen offset:1024 sc1
v_mfma_f32_16x16x32_bf16 v[196:199], a[116:119], a[84:87], v[196:199]
v_mfma_f32_16x16x32_bf16 v[220:223], a[116:119], a[92:95], v[220:223]
v_mfma_f32_16x16x32_bf16 v[220:223], a[112:115], a[88:91], v[220:223]
s_waitcnt lgkmcnt(0)
v_mfma_f32_16x16x32_bf16 v[224:227], a[128:131], a[88:91], v[224:227]
ds_read_b128 a[96:99], v5 offset:14336
v_mfma_f32_16x16x32_bf16 v[224:227], a[132:135], a[92:95], v[224:227]
buffer_load_dwordx4 a[48:51], v2, s[40:43], s35 offen offset:2048 sc1
v_mfma_f32_16x16x32_bf16 v[200:203], a[132:135], a[84:87], v[200:203]
ds_read_b128 a[100:103], v5 offset:20480
v_mfma_f32_16x16x32_bf16 v[200:203], a[128:131], a[80:83], v[200:203]
v_mfma_f32_16x16x32_bf16 v[176:179], a[128:131], a[72:75], v[176:179]
v_mfma_f32_16x16x32_bf16 v[176:179], a[132:135], a[76:79], v[176:179]
buffer_load_dwordx4 a[52:55], v2, s[40:43], s33 offen offset:2048 sc1
v_mfma_f32_16x16x32_bf16 v[152:155], a[132:135], a[68:71], v[152:155]
ds_read_b128 a[104:107], v5 offset:15360
v_mfma_f32_16x16x32_bf16 v[152:155], a[128:131], a[64:67], v[152:155]
v_mfma_f32_16x16x32_bf16 v[132:135], a[136:139], a[64:67], v[132:135]
ds_read_b128 a[108:111], v5 offset:21504
v_mfma_f32_16x16x32_bf16 v[132:135], a[140:143], a[68:71], v[132:135]
v_mfma_f32_16x16x32_bf16 v[156:159], a[140:143], a[76:79], v[156:159]
buffer_load_dwordx4 v1, s[4:7], s44 offen offset:2048 sc1 lds
s_add_u32 m0, s18, 0x6000
v_mfma_f32_16x16x32_bf16 v[156:159], a[136:139], a[72:75], v[156:159]
s_add_u32 s44, s50, 0x142a000
ds_read_b128 a[112:115], v5 offset:16384
v_mfma_f32_16x16x32_bf16 v[180:183], a[136:139], a[80:83], v[180:183]
v_mfma_f32_16x16x32_bf16 v[180:183], a[140:143], a[84:87], v[180:183]
ds_read_b128 a[116:119], v5 offset:22528
v_mfma_f32_16x16x32_bf16 v[204:207], a[140:143], a[92:95], v[204:207]
v_mfma_f32_16x16x32_bf16 v[204:207], a[136:139], a[88:91], v[204:207]
buffer_load_dwordx4 a[56:59], v2, s[40:43], s35 offen offset:3072 sc1
v_mfma_f32_16x16x32_bf16 v[208:211], a[144:147], a[88:91], v[208:211]
v_mfma_f32_16x16x32_bf16 v[208:211], a[148:151], a[92:95], v[208:211]
v_mfma_f32_16x16x32_bf16 v[184:187], a[148:151], a[84:87], v[184:187]
v_mfma_f32_16x16x32_bf16 v[184:187], a[144:147], a[80:83], v[184:187]
v_mfma_f32_16x16x32_bf16 v[160:163], a[144:147], a[72:75], v[160:163]
buffer_load_dwordx4 a[60:63], v2, s[40:43], s33 offen offset:3072 sc1
s_add_u32 s35, s35, 8192
v_mfma_f32_16x16x32_bf16 v[160:163], a[148:151], a[76:79], v[160:163]
s_add_u32 s33, s33, 8192
v_mfma_f32_16x16x32_bf16 v[136:139], a[148:151], a[68:71], v[136:139]
v_mfma_f32_16x16x32_bf16 v[136:139], a[144:147], a[64:67], v[136:139]
s_waitcnt vmcnt(10) lgkmcnt(0)
v_mfma_f32_16x16x32_bf16 v[140:143], a[96:99], a[0:3], v[140:143]
ds_read_b128 a[128:131], v5 offset:17408
v_add_f32 v92, v92, v96
v_mfma_f32_16x16x32_bf16 v[140:143], a[100:103], a[4:7], v[140:143]
buffer_load_dwordx4 a[64:67], v2, s[40:43], s35 offen offset:0 sc1
v_mfma_f32_16x16x32_bf16 v[164:167], a[100:103], a[12:15], v[164:167]
ds_read_b128 a[132:135], v5 offset:23552
v_add_f32 v100, v100, v104
v_mfma_f32_16x16x32_bf16 v[164:167], a[96:99], a[8:11], v[164:167]
v_add_f32 v108, v108, v112
v_add_f32 v116, v116, v120
v_mfma_f32_16x16x32_bf16 v[188:191], a[96:99], a[16:19], v[188:191]
v_add_f32 v93, v93, v97
v_add_f32 v101, v101, v105
v_mfma_f32_16x16x32_bf16 v[188:191], a[100:103], a[20:23], v[188:191]
buffer_load_dwordx4 a[68:71], v2, s[40:43], s33 offen offset:0 sc1
v_mfma_f32_16x16x32_bf16 v[212:215], a[100:103], a[28:31], v[212:215]
ds_read_b128 a[136:139], v5 offset:12288
v_add_f32 v109, v109, v113
v_mfma_f32_16x16x32_bf16 v[212:215], a[96:99], a[24:27], v[212:215]
v_add_f32 v117, v117, v121
v_add_f32 v94, v94, v98
v_mfma_f32_16x16x32_bf16 v[216:219], a[104:107], a[24:27], v[216:219]
ds_read_b128 a[140:143], v5 offset:18432
v_add_f32 v102, v102, v106
v_mfma_f32_16x16x32_bf16 v[216:219], a[108:111], a[28:31], v[216:219]
v_add_f32 v110, v110, v114
v_mfma_f32_16x16x32_bf16 v[192:195], a[108:111], a[20:23], v[192:195]
buffer_load_dwordx4 v1, s[4:7], s44 offen offset:0 sc1 lds
v_mfma_f32_16x16x32_bf16 v[192:195], a[104:107], a[16:19], v[192:195]
ds_read_b128 a[144:147], v5 offset:13312
v_add_f32 v118, v118, v122
v_mfma_f32_16x16x32_bf16 v[168:171], a[104:107], a[8:11], v[168:171]
v_add_f32 v95, v95, v99
v_add_f32 v103, v103, v107
v_mfma_f32_16x16x32_bf16 v[168:171], a[108:111], a[12:15], v[168:171]
ds_read_b128 a[148:151], v5 offset:19456
v_add_f32 v111, v111, v115
v_mfma_f32_16x16x32_bf16 v[144:147], a[108:111], a[4:7], v[144:147]
v_add_f32 v119, v119, v123
v_mfma_f32_16x16x32_bf16 v[144:147], a[104:107], a[0:3], v[144:147]
buffer_load_dwordx4 a[72:75], v2, s[40:43], s35 offen offset:1024 sc1
v_mfma_f32_16x16x32_bf16 v[148:151], a[112:115], a[0:3], v[148:151]
v_add_f32_dpp v92, v92, v92 row_ror:8 row_mask:0xf bank_mask:0xf
v_add_f32_dpp v100, v100, v100 row_ror:8 row_mask:0xf bank_mask:0xf
v_mfma_f32_16x16x32_bf16 v[148:151], a[116:119], a[4:7], v[148:151]
v_add_f32_dpp v108, v108, v108 row_ror:8 row_mask:0xf bank_mask:0xf
v_mfma_f32_16x16x32_bf16 v[172:175], a[116:119], a[12:15], v[172:175]
v_add_f32_dpp v116, v116, v116 row_ror:8 row_mask:0xf bank_mask:0xf
v_mfma_f32_16x16x32_bf16 v[172:175], a[112:115], a[8:11], v[172:175]
v_add_f32_dpp v93, v93, v93 row_ror:8 row_mask:0xf bank_mask:0xf
v_mfma_f32_16x16x32_bf16 v[196:199], a[112:115], a[16:19], v[196:199]
buffer_load_dwordx4 a[76:79], v2, s[40:43], s33 offen offset:1024 sc1
v_mfma_f32_16x16x32_bf16 v[196:199], a[116:119], a[20:23], v[196:199]
v_add_f32_dpp v101, v101, v101 row_ror:8 row_mask:0xf bank_mask:0xf
v_add_f32_dpp v109, v109, v109 row_ror:8 row_mask:0xf bank_mask:0xf
v_mfma_f32_16x16x32_bf16 v[220:223], a[116:119], a[28:31], v[220:223]
v_add_f32_dpp v117, v117, v117 row_ror:8 row_mask:0xf bank_mask:0xf
v_mfma_f32_16x16x32_bf16 v[220:223], a[112:115], a[24:27], v[220:223]
s_waitcnt lgkmcnt(0)
s_barrier
v_mfma_f32_16x16x32_bf16 v[224:227], a[128:131], a[24:27], v[224:227]
ds_read_b128 a[96:99], v5 offset:26624
v_add_f32_dpp v92, v94, v94 row_ror:8 row_mask:0xf bank_mask:0xc
v_mfma_f32_16x16x32_bf16 v[224:227], a[132:135], a[28:31], v[224:227]
buffer_load_dwordx4 a[80:83], v2, s[40:43], s35 offen offset:2048 sc1
v_mfma_f32_16x16x32_bf16 v[200:203], a[132:135], a[20:23], v[200:203]
ds_read_b128 a[100:103], v5 offset:32768
v_add_f32_dpp v100, v102, v102 row_ror:8 row_mask:0xf bank_mask:0xc
v_mfma_f32_16x16x32_bf16 v[200:203], a[128:131], a[16:19], v[200:203]
v_add_f32_dpp v108, v110, v110 row_ror:8 row_mask:0xf bank_mask:0xc
v_add_f32_dpp v116, v118, v118 row_ror:8 row_mask:0xf bank_mask:0xc
v_mfma_f32_16x16x32_bf16 v[176:179], a[128:131], a[8:11], v[176:179]
v_add_f32_dpp v93, v95, v95 row_ror:8 row_mask:0xf bank_mask:0xc
v_add_f32_dpp v101, v103, v103 row_ror:8 row_mask:0xf bank_mask:0xc
v_mfma_f32_16x16x32_bf16 v[176:179], a[132:135], a[12:15], v[176:179]
buffer_load_dwordx4 a[84:87], v2, s[40:43], s33 offen offset:2048 sc1
v_mfma_f32_16x16x32_bf16 v[152:155], a[132:135], a[4:7], v[152:155]
ds_read_b128 a[104:107], v5 offset:27648
v_add_f32_dpp v109, v111, v111 row_ror:8 row_mask:0xf bank_mask:0xc
v_mfma_f32_16x16x32_bf16 v[152:155], a[128:131], a[0:3], v[152:155]
v_add_f32_dpp v117, v119, v119 row_ror:8 row_mask:0xf bank_mask:0xc
v_mfma_f32_16x16x32_bf16 v[132:135], a[136:139], a[0:3], v[132:135]
ds_read_b128 a[108:111], v5 offset:33792
v_mfma_f32_16x16x32_bf16 v[132:135], a[140:143], a[4:7], v[132:135]
v_permlane32_swap_b32 v92, v93
v_mfma_f32_16x16x32_bf16 v[156:159], a[140:143], a[12:15], v[156:159]
buffer_load_dwordx4 v1, s[4:7], s44 offen offset:1024 sc1 lds
v_mfma_f32_16x16x32_bf16 v[156:159], a[136:139], a[8:11], v[156:159]
ds_read_b128 a[112:115], v5 offset:28672
v_mfma_f32_16x16x32_bf16 v[180:183], a[136:139], a[16:19], v[180:183]
v_permlane32_swap_b32 v100, v101
v_mfma_f32_16x16x32_bf16 v[180:183], a[140:143], a[20:23], v[180:183]
ds_read_b128 a[116:119], v5 offset:34816
v_mfma_f32_16x16x32_bf16 v[204:207], a[140:143], a[28:31], v[204:207]
v_permlane32_swap_b32 v108, v109
v_mfma_f32_16x16x32_bf16 v[204:207], a[136:139], a[24:27], v[204:207]
buffer_load_dwordx4 a[88:91], v2, s[40:43], s35 offen offset:3072 sc1
v_mfma_f32_16x16x32_bf16 v[208:211], a[144:147], a[24:27], v[208:211]
v_permlane32_swap_b32 v116, v117
v_mfma_f32_16x16x32_bf16 v[208:211], a[148:151], a[28:31], v[208:211]
v_add_f32 v92, v92, v93
v_add_f32 v100, v100, v101
v_mfma_f32_16x16x32_bf16 v[184:187], a[148:151], a[20:23], v[184:187]
v_add_f32 v108, v108, v109
v_add_f32 v116, v116, v117
v_mfma_f32_16x16x32_bf16 v[184:187], a[144:147], a[16:19], v[184:187]
v_mov_b32 v94, v92
v_mov_b32 v102, v100
v_mfma_f32_16x16x32_bf16 v[160:163], a[144:147], a[8:11], v[160:163]
buffer_load_dwordx4 a[92:95], v2, s[40:43], s33 offen offset:3072 sc1
s_add_u32 s35, s35, 8192
v_mfma_f32_16x16x32_bf16 v[160:163], a[148:151], a[12:15], v[160:163]
s_add_u32 s33, s33, 8192
v_mov_b32 v110, v108
v_mfma_f32_16x16x32_bf16 v[136:139], a[148:151], a[4:7], v[136:139]
v_mov_b32 v118, v116
v_mfma_f32_16x16x32_bf16 v[136:139], a[144:147], a[0:3], v[136:139]
s_waitcnt vmcnt(10) lgkmcnt(0)
v_mfma_f32_16x16x32_bf16 v[140:143], a[96:99], a[32:35], v[140:143]
ds_read_b128 a[128:131], v5 offset:29696
v_mfma_f32_16x16x32_bf16 v[140:143], a[100:103], a[36:39], v[140:143]
buffer_load_dwordx4 a[0:3], v2, s[40:43], s35 offen offset:0 sc1
v_mfma_f32_16x16x32_bf16 v[164:167], a[100:103], a[44:47], v[164:167]
ds_read_b128 a[132:135], v5 offset:35840
v_mfma_f32_16x16x32_bf16 v[164:167], a[96:99], a[40:43], v[164:167]
v_permlane16_swap_b32 v92, v94
v_mfma_f32_16x16x32_bf16 v[188:191], a[96:99], a[48:51], v[188:191]
v_permlane16_swap_b32 v100, v102
v_mfma_f32_16x16x32_bf16 v[188:191], a[100:103], a[52:55], v[188:191]
buffer_load_dwordx4 a[4:7], v2, s[40:43], s33 offen offset:0 sc1
v_mfma_f32_16x16x32_bf16 v[212:215], a[100:103], a[60:63], v[212:215]
ds_read_b128 a[136:139], v5 offset:24576
v_mfma_f32_16x16x32_bf16 v[212:215], a[96:99], a[56:59], v[212:215]
v_permlane16_swap_b32 v108, v110
v_mfma_f32_16x16x32_bf16 v[216:219], a[104:107], a[56:59], v[216:219]
ds_read_b128 a[140:143], v5 offset:30720
v_mfma_f32_16x16x32_bf16 v[216:219], a[108:111], a[60:63], v[216:219]
v_permlane16_swap_b32 v116, v118
v_mfma_f32_16x16x32_bf16 v[192:195], a[108:111], a[52:55], v[192:195]
buffer_load_dwordx4 v1, s[4:7], s44 offen offset:2048 sc1 lds
s_add_u32 m0, s18, 0x9000
v_mfma_f32_16x16x32_bf16 v[192:195], a[104:107], a[48:51], v[192:195]
s_add_u32 s44, s50, 0x142d000
ds_read_b128 a[144:147], v5 offset:25600
v_mfma_f32_16x16x32_bf16 v[168:171], a[104:107], a[40:43], v[168:171]
v_add_f32 v92, v92, v94
v_add_f32 v100, v100, v102
v_mfma_f32_16x16x32_bf16 v[168:171], a[108:111], a[44:47], v[168:171]
ds_read_b128 a[148:151], v5 offset:31744
v_add_f32 v108, v108, v110
v_mfma_f32_16x16x32_bf16 v[144:147], a[108:111], a[36:39], v[144:147]
v_add_f32 v116, v116, v118
v_mov_b32 v94, v92
v_mfma_f32_16x16x32_bf16 v[144:147], a[104:107], a[32:35], v[144:147]
buffer_load_dwordx4 a[8:11], v2, s[40:43], s35 offen offset:1024 sc1
v_mfma_f32_16x16x32_bf16 v[148:151], a[112:115], a[32:35], v[148:151]
v_mov_b32 v102, v100
v_mov_b32 v110, v108
v_mfma_f32_16x16x32_bf16 v[148:151], a[116:119], a[36:39], v[148:151]
v_mov_b32 v118, v116
v_mfma_f32_16x16x32_bf16 v[172:175], a[116:119], a[44:47], v[172:175]
v_permlane32_swap_b32 v92, v94
v_mfma_f32_16x16x32_bf16 v[172:175], a[112:115], a[40:43], v[172:175]
v_permlane32_swap_b32 v100, v102
v_mfma_f32_16x16x32_bf16 v[196:199], a[112:115], a[48:51], v[196:199]
buffer_load_dwordx4 a[12:15], v2, s[40:43], s33 offen offset:1024 sc1
v_mfma_f32_16x16x32_bf16 v[196:199], a[116:119], a[52:55], v[196:199]
v_permlane32_swap_b32 v108, v110
v_mfma_f32_16x16x32_bf16 v[220:223], a[116:119], a[60:63], v[220:223]
v_permlane32_swap_b32 v116, v118
v_mfma_f32_16x16x32_bf16 v[220:223], a[112:115], a[56:59], v[220:223]
v_mul_f32 v82, 0xba800000, v92
s_waitcnt lgkmcnt(0)
v_mfma_f32_16x16x32_bf16 v[224:227], a[128:131], a[56:59], v[224:227]
ds_read_b128 a[96:99], v5 offset:38912
v_mul_f32 v84, 0xba800000, v100
v_mfma_f32_16x16x32_bf16 v[224:227], a[132:135], a[60:63], v[224:227]
buffer_load_dwordx4 a[16:19], v2, s[40:43], s35 offen offset:2048 sc1
v_mfma_f32_16x16x32_bf16 v[200:203], a[132:135], a[52:55], v[200:203]
ds_read_b128 a[100:103], v5 offset:45056
v_mul_f32 v86, 0xba800000, v108
v_mfma_f32_16x16x32_bf16 v[200:203], a[128:131], a[48:51], v[200:203]
v_mul_f32 v88, 0xba800000, v116
v_mul_f32 v94, 0x3a800000, v94
v_mfma_f32_16x16x32_bf16 v[176:179], a[128:131], a[40:43], v[176:179]
v_mul_f32 v102, 0x3a800000, v102
v_mul_f32 v110, 0x3a800000, v110
v_mfma_f32_16x16x32_bf16 v[176:179], a[132:135], a[44:47], v[176:179]
buffer_load_dwordx4 v1, s[4:7], s44 offen offset:0 sc1 lds
v_mfma_f32_16x16x32_bf16 v[152:155], a[132:135], a[36:39], v[152:155]
ds_read_b128 a[104:107], v5 offset:39936
v_mul_f32 v118, 0x3a800000, v118
v_mfma_f32_16x16x32_bf16 v[152:155], a[128:131], a[32:35], v[152:155]
v_fma_f32 v94, -v82, v82, v94
v_fma_f32 v102, -v84, v84, v102
v_mfma_f32_16x16x32_bf16 v[132:135], a[136:139], a[32:35], v[132:135]
ds_read_b128 a[108:111], v5 offset:46080
v_fma_f32 v110, -v86, v86, v110
v_mfma_f32_16x16x32_bf16 v[132:135], a[140:143], a[36:39], v[132:135]
buffer_load_dwordx4 a[20:23], v2, s[40:43], s33 offen offset:2048 sc1
v_mfma_f32_16x16x32_bf16 v[156:159], a[140:143], a[44:47], v[156:159]
ds_read_b128 a[112:115], v5 offset:40960
v_fma_f32 v118, -v88, v88, v118
v_mfma_f32_16x16x32_bf16 v[156:159], a[136:139], a[40:43], v[156:159]
v_max_f32 v94, 0, v94
v_max_f32 v102, 0, v102
v_mfma_f32_16x16x32_bf16 v[180:183], a[136:139], a[48:51], v[180:183]
v_max_f32 v110, 0, v110
v_max_f32 v118, 0, v118
v_mfma_f32_16x16x32_bf16 v[180:183], a[140:143], a[52:55], v[180:183]
buffer_load_dwordx4 a[24:27], v2, s[40:43], s35 offen offset:3072 sc1
v_mfma_f32_16x16x32_bf16 v[204:207], a[140:143], a[60:63], v[204:207]
ds_read_b128 a[116:119], v5 offset:47104
v_add_f32 v94, 0x3727c5ac, v94
v_mfma_f32_16x16x32_bf16 v[204:207], a[136:139], a[56:59], v[204:207]
v_add_f32 v102, 0x3727c5ac, v102
v_add_f32 v110, 0x3727c5ac, v110
v_mfma_f32_16x16x32_bf16 v[208:211], a[144:147], a[56:59], v[208:211]
v_add_f32 v118, 0x3727c5ac, v118
v_mfma_f32_16x16x32_bf16 v[208:211], a[148:151], a[60:63], v[208:211]
buffer_load_dwordx4 v1, s[4:7], s44 offen offset:1024 sc1 lds
v_mfma_f32_16x16x32_bf16 v[184:187], a[148:151], a[52:55], v[184:187]
v_rsq_f32 v83, v94
v_mfma_f32_16x16x32_bf16 v[184:187], a[144:147], a[48:51], v[184:187]
v_rsq_f32 v85, v102
v_mfma_f32_16x16x32_bf16 v[160:163], a[144:147], a[40:43], v[160:163]
v_rsq_f32 v87, v110
v_mfma_f32_16x16x32_bf16 v[160:163], a[148:151], a[44:47], v[160:163]
buffer_load_dwordx4 a[28:31], v2, s[40:43], s33 offen offset:3072 sc1
s_add_u32 s35, s35, 8192
v_mfma_f32_16x16x32_bf16 v[136:139], a[148:151], a[36:39], v[136:139]
s_add_u32 s33, s33, 8192
v_mfma_f32_16x16x32_bf16 v[136:139], a[144:147], a[32:35], v[136:139]
s_waitcnt vmcnt(11) lgkmcnt(0)
v_mfma_f32_16x16x32_bf16 v[140:143], a[96:99], a[64:67], v[140:143]
ds_read_b128 a[128:131], v5 offset:41984
v_mfma_f32_16x16x32_bf16 v[140:143], a[100:103], a[68:71], v[140:143]
buffer_load_dwordx4 a[32:35], v2, s[40:43], s35 offen offset:0 sc1
v_mfma_f32_16x16x32_bf16 v[164:167], a[100:103], a[76:79], v[164:167]
ds_read_b128 a[132:135], v5 offset:48128
v_mfma_f32_16x16x32_bf16 v[164:167], a[96:99], a[72:75], v[164:167]
v_rsq_f32 v89, v118
v_mfma_f32_16x16x32_bf16 v[188:191], a[96:99], a[80:83], v[188:191]
v_mfma_f32_16x16x32_bf16 v[188:191], a[100:103], a[84:87], v[188:191]
buffer_load_dwordx4 a[36:39], v2, s[40:43], s33 offen offset:0 sc1
v_mfma_f32_16x16x32_bf16 v[212:215], a[100:103], a[92:95], v[212:215]
ds_read_b128 a[136:139], v5 offset:36864
v_mfma_f32_16x16x32_bf16 v[212:215], a[96:99], a[88:91], v[212:215]
v_mfma_f32_16x16x32_bf16 v[216:219], a[104:107], a[88:91], v[216:219]
ds_read_b128 a[140:143], v5 offset:43008
v_mfma_f32_16x16x32_bf16 v[216:219], a[108:111], a[92:95], v[216:219]
v_mfma_f32_16x16x32_bf16 v[192:195], a[108:111], a[84:87], v[192:195]
buffer_load_dwordx4 v1, s[4:7], s44 offen offset:2048 sc1 lds
s_add_u32 m0, s19, 49152
v_mfma_f32_16x16x32_bf16 v[192:195], a[104:107], a[80:83], v[192:195]
s_add_u32 s44, s85, 0xc04000
ds_read_b128 a[144:147], v5 offset:37888
v_mfma_f32_16x16x32_bf16 v[168:171], a[104:107], a[72:75], v[168:171]
v_fmac_f32 v140, v56, v82
v_fmac_f32 v164, v56, v84
v_mfma_f32_16x16x32_bf16 v[168:171], a[108:111], a[76:79], v[168:171]
ds_read_b128 a[148:151], v5 offset:44032
v_mfma_f32_16x16x32_bf16 v[144:147], a[108:111], a[68:71], v[144:147]
v_fmac_f32 v188, v56, v86
v_mfma_f32_16x16x32_bf16 v[144:147], a[104:107], a[64:67], v[144:147]
buffer_load_dwordx4 a[40:43], v2, s[40:43], s35 offen offset:1024 sc1
v_mfma_f32_16x16x32_bf16 v[148:151], a[112:115], a[64:67], v[148:151]
v_fmac_f32 v212, v56, v88
v_mfma_f32_16x16x32_bf16 v[148:151], a[116:119], a[68:71], v[148:151]
v_mfma_f32_16x16x32_bf16 v[172:175], a[116:119], a[76:79], v[172:175]
v_fmac_f32 v216, v60, v88
v_mfma_f32_16x16x32_bf16 v[172:175], a[112:115], a[72:75], v[172:175]
v_mfma_f32_16x16x32_bf16 v[196:199], a[112:115], a[80:83], v[196:199]
buffer_load_dwordx4 a[44:47], v2, s[40:43], s33 offen offset:1024 sc1
v_mfma_f32_16x16x32_bf16 v[196:199], a[116:119], a[84:87], v[196:199]
v_fmac_f32 v192, v60, v86
v_mfma_f32_16x16x32_bf16 v[220:223], a[116:119], a[92:95], v[220:223]
v_fmac_f32 v168, v60, v84
v_fmac_f32 v141, v57, v82
v_mfma_f32_16x16x32_bf16 v[220:223], a[112:115], a[88:91], v[220:223]
s_waitcnt lgkmcnt(0)
s_barrier
v_mfma_f32_16x16x32_bf16 v[224:227], a[128:131], a[88:91], v[224:227]
v_add_u32 v5, 0, v1
v_fmac_f32 v144, v60, v82
v_mfma_f32_16x16x32_bf16 v[224:227], a[132:135], a[92:95], v[224:227]
buffer_load_dwordx4 a[48:51], v2, s[40:43], s35 offen offset:2048 sc1
v_mfma_f32_16x16x32_bf16 v[200:203], a[132:135], a[84:87], v[200:203]
ds_read_b128 a[96:99], v5 offset:2048
v_fmac_f32 v148, v64, v82
v_mfma_f32_16x16x32_bf16 v[200:203], a[128:131], a[80:83], v[200:203]
ds_read_b128 a[100:103], v5 offset:8192
v_fmac_f32 v165, v57, v84
v_mfma_f32_16x16x32_bf16 v[176:179], a[128:131], a[72:75], v[176:179]
v_fmac_f32 v172, v64, v84
v_fmac_f32 v189, v57, v86
v_mfma_f32_16x16x32_bf16 v[176:179], a[132:135], a[76:79], v[176:179]
buffer_load_dwordx4 a[52:55], v2, s[40:43], s33 offen offset:2048 sc1
v_mfma_f32_16x16x32_bf16 v[152:155], a[132:135], a[68:71], v[152:155]
ds_read_b128 a[104:107], v5 offset:3072
v_fmac_f32 v196, v64, v86
v_mfma_f32_16x16x32_bf16 v[152:155], a[128:131], a[64:67], v[152:155]
v_fmac_f32 v213, v57, v88
v_fmac_f32 v217, v61, v88
v_mfma_f32_16x16x32_bf16 v[132:135], a[136:139], a[64:67], v[132:135]
ds_read_b128 a[108:111], v5 offset:9216
v_fmac_f32 v220, v64, v88
v_mfma_f32_16x16x32_bf16 v[132:135], a[140:143], a[68:71], v[132:135]
v_fmac_f32 v193, v61, v86
v_mfma_f32_16x16x32_bf16 v[156:159], a[140:143], a[76:79], v[156:159]
buffer_load_dwordx4 v1, s[4:7], s44 offen offset:0 sc1 lds
v_mfma_f32_16x16x32_bf16 v[156:159], a[136:139], a[72:75], v[156:159]
ds_read_b128 a[112:115], v5 offset:4096
v_fmac_f32 v224, v68, v88
v_mfma_f32_16x16x32_bf16 v[180:183], a[136:139], a[80:83], v[180:183]
v_fmac_f32 v200, v68, v86
v_fmac_f32 v169, v61, v84
v_mfma_f32_16x16x32_bf16 v[180:183], a[140:143], a[84:87], v[180:183]
ds_read_b128 a[116:119], v5 offset:10240
v_fmac_f32 v145, v61, v82
v_mfma_f32_16x16x32_bf16 v[204:207], a[140:143], a[92:95], v[204:207]
v_fmac_f32 v176, v68, v84
v_fmac_f32 v149, v65, v82
v_mfma_f32_16x16x32_bf16 v[204:207], a[136:139], a[88:91], v[204:207]
buffer_load_dwordx4 a[56:59], v2, s[40:43], s35 offen offset:3072 sc1
v_mfma_f32_16x16x32_bf16 v[208:211], a[144:147], a[88:91], v[208:211]
v_fmac_f32 v152, v68, v82
v_fmac_f32 v173, v65, v84
v_mfma_f32_16x16x32_bf16 v[208:211], a[148:151], a[92:95], v[208:211]
v_mfma_f32_16x16x32_bf16 v[184:187], a[148:151], a[84:87], v[184:187]
v_fmac_f32 v132, v48, v82
v_fmac_f32 v197, v65, v86
v_mfma_f32_16x16x32_bf16 v[184:187], a[144:147], a[80:83], v[184:187]
v_mfma_f32_16x16x32_bf16 v[160:163], a[144:147], a[72:75], v[160:163]
buffer_load_dwordx4 a[60:63], v2, s[40:43], s33 offen offset:3072 sc1
s_add_u32 s35, s35, 8192
v_mfma_f32_16x16x32_bf16 v[160:163], a[148:151], a[76:79], v[160:163]
s_add_u32 s33, s33, 8192
v_fmac_f32 v156, v48, v84
v_mfma_f32_16x16x32_bf16 v[136:139], a[148:151], a[68:71], v[136:139]
v_fmac_f32 v180, v48, v86
v_fmac_f32 v221, v65, v88
v_mfma_f32_16x16x32_bf16 v[136:139], a[144:147], a[64:67], v[136:139]
v_fmac_f32 v225, v69, v88
s_waitcnt vmcnt(10) lgkmcnt(0)
v_mfma_f32_16x16x32_bf16 v[140:143], a[96:99], a[0:3], v[140:143]
ds_read_b128 a[128:131], v5 offset:5120
v_fmac_f32 v204, v48, v88
v_mfma_f32_16x16x32_bf16 v[140:143], a[100:103], a[4:7], v[140:143]
buffer_load_dwordx4 a[64:67], v2, s[40:43], s35 offen offset:0 sc1
s_lshl_b32 s36, s28, 9
v_mfma_f32_16x16x32_bf16 v[164:167], a[100:103], a[12:15], v[164:167]
ds_read_b128 a[132:135], v5 offset:11264
v_fmac_f32 v208, v52, v88
v_mfma_f32_16x16x32_bf16 v[164:167], a[96:99], a[8:11], v[164:167]
v_fmac_f32 v201, v69, v86
v_fmac_f32 v177, v69, v84
v_mfma_f32_16x16x32_bf16 v[188:191], a[96:99], a[16:19], v[188:191]
v_fmac_f32 v184, v52, v86
v_fmac_f32 v153, v69, v82
v_mfma_f32_16x16x32_bf16 v[188:191], a[100:103], a[20:23], v[188:191]
buffer_load_dwordx4 a[68:71], v2, s[40:43], s33 offen offset:0 sc1
s_lshl_b32 s37, s30, 2
v_mfma_f32_16x16x32_bf16 v[212:215], a[100:103], a[28:31], v[212:215]
ds_read_b128 a[136:139], v5 offset:0
v_fmac_f32 v160, v52, v84
v_mfma_f32_16x16x32_bf16 v[212:215], a[96:99], a[24:27], v[212:215]
v_fmac_f32 v133, v49, v82
v_add_u32 v232, s19, v7
v_mfma_f32_16x16x32_bf16 v[216:219], a[104:107], a[24:27], v[216:219]
ds_read_b128 a[140:143], v5 offset:6144
v_fmac_f32 v136, v52, v82
v_mfma_f32_16x16x32_bf16 v[216:219], a[108:111], a[28:31], v[216:219]
buffer_load_dwordx4 a[72:75], v2, s[40:43], s35 offen offset:1024 sc1
s_add_u32 s37, s37, s28
v_mfma_f32_16x16x32_bf16 v[192:195], a[108:111], a[20:23], v[192:195]
ds_read_b128 a[144:147], v5 offset:1024
v_fmac_f32 v157, v49, v84
v_mfma_f32_16x16x32_bf16 v[192:195], a[104:107], a[16:19], v[192:195]
v_fmac_f32 v181, v49, v86
v_fmac_f32 v142, v58, v82
v_mfma_f32_16x16x32_bf16 v[168:171], a[104:107], a[8:11], v[168:171]
v_fmac_f32 v205, v49, v88
v_fmac_f32 v166, v58, v84
v_mfma_f32_16x16x32_bf16 v[168:171], a[108:111], a[12:15], v[168:171]
buffer_load_dwordx4 a[76:79], v2, s[40:43], s33 offen offset:1024 sc1
s_lshl_b32 s98, s37, 13
v_mfma_f32_16x16x32_bf16 v[144:147], a[108:111], a[4:7], v[144:147]
ds_read_b128 a[148:151], v5 offset:7168
v_fmac_f32 v209, v53, v88
v_mfma_f32_16x16x32_bf16 v[144:147], a[104:107], a[0:3], v[144:147]
v_fmac_f32 v190, v58, v86
s_add_u32 s98, s98, 0x400000
v_mfma_f32_16x16x32_bf16 v[148:151], a[112:115], a[0:3], v[148:151]
v_fmac_f32 v185, v53, v86
v_fmac_f32 v214, v58, v88
v_mfma_f32_16x16x32_bf16 v[148:151], a[116:119], a[4:7], v[148:151]
buffer_load_dwordx4 a[80:83], v2, s[40:43], s35 offen offset:2048 sc1
s_add_u32 s99, s98, 4096
v_mfma_f32_16x16x32_bf16 v[172:175], a[116:119], a[12:15], v[172:175]
v_fmac_f32 v161, v53, v84
v_fmac_f32 v218, v62, v88
v_mfma_f32_16x16x32_bf16 v[172:175], a[112:115], a[8:11], v[172:175]
s_lshl_b32 s100, s37, 10
s_add_u32 s100, s100, 0x820000
s_lshl_b32 s96, s29, 10
v_mfma_f32_16x16x32_bf16 v[196:199], a[112:115], a[16:19], v[196:199]
v_fmac_f32 v137, v53, v82
v_fmac_f32 v194, v62, v86
v_mfma_f32_16x16x32_bf16 v[196:199], a[116:119], a[20:23], v[196:199]
buffer_load_dwordx4 a[84:87], v2, s[40:43], s33 offen offset:2048 sc1
s_add_u32 s96, s96, s98
v_mfma_f32_16x16x32_bf16 v[220:223], a[116:119], a[28:31], v[220:223]
v_fmac_f32 v170, v62, v84
v_fmac_f32 v143, v59, v82
v_mfma_f32_16x16x32_bf16 v[220:223], a[112:115], a[24:27], v[220:223]
s_lshl_b32 s97, s29, 7
s_waitcnt lgkmcnt(0)
v_mfma_f32_16x16x32_bf16 v[224:227], a[128:131], a[24:27], v[224:227]
ds_read_b128 a[96:99], v5 offset:14336
v_fmac_f32 v146, v62, v82
v_mfma_f32_16x16x32_bf16 v[224:227], a[132:135], a[28:31], v[224:227]
buffer_load_dwordx4 a[88:91], v2, s[40:43], s35 offen offset:3072 sc1
s_add_u32 s97, s97, s100
v_mfma_f32_16x16x32_bf16 v[200:203], a[132:135], a[20:23], v[200:203]
ds_read_b128 a[100:103], v5 offset:20480
v_fmac_f32 v150, v66, v82
v_mfma_f32_16x16x32_bf16 v[200:203], a[128:131], a[16:19], v[200:203]
v_fmac_f32 v167, v59, v84
v_fmac_f32 v191, v59, v86
v_mfma_f32_16x16x32_bf16 v[176:179], a[128:131], a[8:11], v[176:179]
v_fmac_f32 v174, v66, v84
v_fmac_f32 v215, v59, v88
v_mfma_f32_16x16x32_bf16 v[176:179], a[132:135], a[12:15], v[176:179]
ds_read_b128 a[104:107], v5 offset:15360
s_lshl_b32 s88, s28, 6
v_mfma_f32_16x16x32_bf16 v[152:155], a[132:135], a[4:7], v[152:155]
v_fmac_f32 v198, v66, v86
v_fmac_f32 v219, v63, v88
v_mfma_f32_16x16x32_bf16 v[152:155], a[128:131], a[0:3], v[152:155]
buffer_load_dwordx4 v1, s[4:7], s44 offen offset:1024 sc1 lds
s_add_u32 s94, s80, s88
v_mfma_f32_16x16x32_bf16 v[132:135], a[136:139], a[0:3], v[132:135]
ds_read_b128 a[108:111], v5 offset:21504
v_fmac_f32 v222, v66, v88
v_mfma_f32_16x16x32_bf16 v[132:135], a[140:143], a[4:7], v[132:135]
v_fmac_f32 v195, v63, v86
s_add_u32 s94, s94, 0x90000
v_mfma_f32_16x16x32_bf16 v[156:159], a[140:143], a[12:15], v[156:159]
ds_read_b128 a[112:115], v5 offset:16384
v_fmac_f32 v226, v70, v88
v_mfma_f32_16x16x32_bf16 v[156:159], a[136:139], a[8:11], v[156:159]
v_fmac_f32 v171, v63, v84
s_add_u32 s88, s88, s70
v_mfma_f32_16x16x32_bf16 v[180:183], a[136:139], a[16:19], v[180:183]
v_fmac_f32 v202, v70, v86
v_fmac_f32 v147, v63, v82
v_mfma_f32_16x16x32_bf16 v[180:183], a[140:143], a[20:23], v[180:183]
buffer_load_dwordx4 a[92:95], v2, s[40:43], s33 offen offset:3072 sc1
s_add_u32 s35, s35, 8192
v_mfma_f32_16x16x32_bf16 v[204:207], a[140:143], a[28:31], v[204:207]
s_add_u32 s33, s33, 8192
ds_read_b128 a[116:119], v5 offset:22528
v_mfma_f32_16x16x32_bf16 v[204:207], a[136:139], a[24:27], v[204:207]
v_fmac_f32 v178, v70, v84
v_fmac_f32 v151, v67, v82
v_mfma_f32_16x16x32_bf16 v[208:211], a[144:147], a[24:27], v[208:211]
v_fmac_f32 v154, v70, v82
v_fmac_f32 v175, v67, v84
v_mfma_f32_16x16x32_bf16 v[208:211], a[148:151], a[28:31], v[208:211]
s_add_u32 s89, s88, 0x90000
s_add_u32 s74, s71, 0x30080
s_lshl_b32 s73, s30, 12
v_mfma_f32_16x16x32_bf16 v[184:187], a[148:151], a[20:23], v[184:187]
v_fmac_f32 v134, v50, v82
v_fmac_f32 v199, v67, v86
v_mfma_f32_16x16x32_bf16 v[184:187], a[144:147], a[16:19], v[184:187]
buffer_load_dwordx4 v1, s[4:7], s44 offen offset:2048 sc1 lds
s_add_u32 s72, s73, 0x2600000
v_mfma_f32_16x16x32_bf16 v[160:163], a[144:147], a[8:11], v[160:163]
v_fmac_f32 v158, v50, v84
v_fmac_f32 v223, v67, v88
v_mfma_f32_16x16x32_bf16 v[160:163], a[148:151], a[12:15], v[160:163]
v_add_u32 v233, s19, v232
s_add_u32 s73, s73, 0x1e00000
v_mfma_f32_16x16x32_bf16 v[136:139], a[148:151], a[4:7], v[136:139]
v_fmac_f32 v182, v50, v86
v_fmac_f32 v227, v71, v88
v_mfma_f32_16x16x32_bf16 v[136:139], a[144:147], a[0:3], v[136:139]
s_waitcnt vmcnt(10) lgkmcnt(0)
s_barrier
v_mfma_f32_16x16x32_bf16 v[140:143], a[96:99], a[32:35], v[140:143]
ds_read_b128 a[128:131], v5 offset:17408
v_fmac_f32 v206, v50, v88
v_mfma_f32_16x16x32_bf16 v[140:143], a[100:103], a[36:39], v[140:143]
buffer_load_dwordx4 a[0:3], v2, s[40:43], s35 offen offset:0 sc1
s_lshr_b32 s38, s28, 1
v_mfma_f32_16x16x32_bf16 v[164:167], a[100:103], a[44:47], v[164:167]
ds_read_b128 a[132:135], v5 offset:23552
v_fmac_f32 v210, v54, v88
v_mfma_f32_16x16x32_bf16 v[164:167], a[96:99], a[40:43], v[164:167]
v_fmac_f32 v203, v71, v86
v_fmac_f32 v179, v71, v84
v_mfma_f32_16x16x32_bf16 v[188:191], a[96:99], a[48:51], v[188:191]
buffer_load_dwordx4 a[4:7], v2, s[40:43], s33 offen offset:0 sc1
s_and_b32 s39, s28, 1
v_mfma_f32_16x16x32_bf16 v[188:191], a[100:103], a[52:55], v[188:191]
ds_read_b128 a[136:139], v5 offset:26624
v_fmac_f32 v186, v54, v86
v_mfma_f32_16x16x32_bf16 v[212:215], a[100:103], a[60:63], v[212:215]
L_stub17:
s_cbranch_execz L_stub18
v_fmac_f32 v162, v54, v84
v_fmac_f32 v155, v71, v82
v_mfma_f32_16x16x32_bf16 v[212:215], a[96:99], a[56:59], v[212:215]
buffer_load_dwordx4 a[8:11], v2, s[40:43], s35 offen offset:1024 sc1
s_mul_i32 s38, s38, 3072
v_mfma_f32_16x16x32_bf16 v[216:219], a[104:107], a[56:59], v[216:219]
ds_read_b128 a[140:143], v5 offset:32768
v_fmac_f32 v138, v54, v82
v_mfma_f32_16x16x32_bf16 v[216:219], a[108:111], a[60:63], v[216:219]
v_fmac_f32 v135, v51, v82
v_fmac_f32 v159, v51, v84
v_mfma_f32_16x16x32_bf16 v[192:195], a[108:111], a[52:55], v[192:195]
buffer_load_dwordx4 a[12:15], v2, s[40:43], s33 offen offset:1024 sc1
s_lshl_b32 s39, s39, 3
v_mfma_f32_16x16x32_bf16 v[192:195], a[104:107], a[48:51], v[192:195]
ds_read_b128 a[144:147], v5 offset:27648
v_fmac_f32 v183, v51, v86
v_mfma_f32_16x16x32_bf16 v[168:171], a[104:107], a[40:43], v[168:171]
v_fmac_f32 v207, v51, v88
s_add_u32 s38, s38, s39
v_mfma_f32_16x16x32_bf16 v[168:171], a[108:111], a[44:47], v[168:171]
buffer_load_dwordx4 a[16:19], v2, s[40:43], s35 offen offset:2048 sc1
v_mfma_f32_16x16x32_bf16 v[144:147], a[108:111], a[36:39], v[144:147]
ds_read_b128 a[148:151], v5 offset:33792
v_fmac_f32 v211, v55, v88
v_mfma_f32_16x16x32_bf16 v[144:147], a[104:107], a[32:35], v[144:147]
v_mul_f32 v88, 0x3fb8aa3b, v89
v_and_b32 v248, 7, v0
v_mfma_f32_16x16x32_bf16 v[148:151], a[112:115], a[32:35], v[148:151]
buffer_load_dwordx4 a[20:23], v2, s[40:43], s33 offen offset:2048 sc1
v_mfma_f32_16x16x32_bf16 v[148:151], a[116:119], a[36:39], v[148:151]
v_fmac_f32 v187, v55, v86
v_lshlrev_b32 v248, 7, v248
v_mfma_f32_16x16x32_bf16 v[172:175], a[116:119], a[44:47], v[172:175]
v_fmac_f32 v163, v55, v84
v_mul_f32 v86, 0x3fb8aa3b, v87
v_mfma_f32_16x16x32_bf16 v[172:175], a[112:115], a[40:43], v[172:175]
buffer_load_dwordx4 a[24:27], v2, s[40:43], s35 offen offset:3072 sc1
v_mfma_f32_16x16x32_bf16 v[196:199], a[112:115], a[48:51], v[196:199]
v_fmac_f32 v139, v55, v82
v_mul_f32 v84, 0x3fb8aa3b, v85
v_mfma_f32_16x16x32_bf16 v[196:199], a[116:119], a[52:55], v[196:199]
v_mul_f32 v82, 0x3fb8aa3b, v83
v_lshrrev_b32 v249, 4, v0
v_mfma_f32_16x16x32_bf16 v[220:223], a[116:119], a[60:63], v[220:223]
buffer_load_dwordx4 a[28:31], v2, s[40:43], s33 offen offset:3072 sc1
s_add_u32 s35, s35, 8192
v_mfma_f32_16x16x32_bf16 v[220:223], a[112:115], a[56:59], v[220:223]
s_add_u32 s33, s33, 8192
s_waitcnt lgkmcnt(0)
v_mfma_f32_16x16x32_bf16 v[224:227], a[128:131], a[56:59], v[224:227]
ds_read_b128 a[96:99], v5 offset:28672
v_lshlrev_b32 v235, 8, v0
v_mfma_f32_16x16x32_bf16 v[224:227], a[132:135], a[60:63], v[224:227]
buffer_load_dwordx4 v1, s[4:7], s44 offen offset:3072 sc1 lds
s_add_u32 m0, s19, 65536
v_mfma_f32_16x16x32_bf16 v[200:203], a[132:135], a[52:55], v[200:203]
s_add_u32 s44, s84, 0xc08000
ds_read_b128 a[100:103], v5 offset:34816
v_mfma_f32_16x16x32_bf16 v[200:203], a[128:131], a[48:51], v[200:203]
v_lshl_add_u32 v248, v249, 4, v248
v_add_u32 v234, s36, v8
v_mfma_f32_16x16x32_bf16 v[176:179], a[128:131], a[40:43], v[176:179]
v_cndmask_b32 v235, 2.0, v235, s[64:65]
v_mov_b32 v249, 0x3f80
v_mfma_f32_16x16x32_bf16 v[176:179], a[132:135], a[44:47], v[176:179]
ds_read_b128 a[104:107], v5 offset:29696
v_mov_b32 v250, 1.0
v_mfma_f32_16x16x32_bf16 v[152:155], a[132:135], a[36:39], v[152:155]
v_add_u32 v252, s38, v1
v_mfma_f32_16x16x32_bf16 v[152:155], a[128:131], a[32:35], v[152:155]
s_waitcnt vmcnt(18)
v_mfma_f32_16x16x32_bf16 v[140:143], a[136:139], a[64:67], v[140:143]
ds_read_b128 a[108:111], v5 offset:35840
s_waitcnt vmcnt(17)
v_mfma_f32_16x16x32_bf16 v[140:143], a[140:143], a[68:71], v[140:143]
s_waitcnt vmcnt(15)
v_mfma_f32_16x16x32_bf16 v[164:167], a[140:143], a[76:79], v[164:167]
ds_read_b128 a[112:115], v5 offset:38912
v_mfma_f32_16x16x32_bf16 v[164:167], a[136:139], a[72:75], v[164:167]
s_waitcnt vmcnt(14)
v_mfma_f32_16x16x32_bf16 v[188:191], a[136:139], a[80:83], v[188:191]
s_waitcnt vmcnt(13)
v_mfma_f32_16x16x32_bf16 v[188:191], a[140:143], a[84:87], v[188:191]
buffer_load_dwordx4 v1, s[4:7], s44 offen offset:0 sc1 lds
s_waitcnt vmcnt(11)
v_mfma_f32_16x16x32_bf16 v[212:215], a[140:143], a[92:95], v[212:215]
ds_read_b128 a[116:119], v5 offset:45056
v_mfma_f32_16x16x32_bf16 v[212:215], a[136:139], a[88:91], v[212:215]
v_mfma_f32_16x16x32_bf16 v[216:219], a[144:147], a[88:91], v[216:219]
v_mfma_f32_16x16x32_bf16 v[216:219], a[148:151], a[92:95], v[216:219]
v_mfma_f32_16x16x32_bf16 v[192:195], a[148:151], a[84:87], v[192:195]
v_mfma_f32_16x16x32_bf16 v[192:195], a[144:147], a[80:83], v[192:195]
v_mfma_f32_16x16x32_bf16 v[168:171], a[144:147], a[72:75], v[168:171]
v_mfma_f32_16x16x32_bf16 v[168:171], a[148:151], a[76:79], v[168:171]
v_mfma_f32_16x16x32_bf16 v[144:147], a[148:151], a[68:71], v[144:147]
v_mfma_f32_16x16x32_bf16 v[144:147], a[144:147], a[64:67], v[144:147]
s_waitcnt lgkmcnt(0)
v_mfma_f32_16x16x32_bf16 v[148:151], a[96:99], a[64:67], v[148:151]
ds_read_b128 a[128:131], v5 offset:39936
v_mfma_f32_16x16x32_bf16 v[148:151], a[100:103], a[68:71], v[148:151]
buffer_load_dwordx4 v1, s[4:7], s44 offen offset:1024 sc1 lds
v_mfma_f32_16x16x32_bf16 v[172:175], a[100:103], a[76:79], v[172:175]
ds_read_b128 a[132:135], v5 offset:46080
v_mfma_f32_16x16x32_bf16 v[172:175], a[96:99], a[72:75], v[172:175]
v_mfma_f32_16x16x32_bf16 v[196:199], a[96:99], a[80:83], v[196:199]
v_mfma_f32_16x16x32_bf16 v[196:199], a[100:103], a[84:87], v[196:199]
buffer_load_dwordx4 v1, s[4:7], s44 offen offset:2048 sc1 lds
v_mfma_f32_16x16x32_bf16 v[220:223], a[100:103], a[92:95], v[220:223]
ds_read_b128 a[136:139], v5 offset:40960
v_mfma_f32_16x16x32_bf16 v[220:223], a[96:99], a[88:91], v[220:223]
v_mfma_f32_16x16x32_bf16 v[224:227], a[104:107], a[88:91], v[224:227]
ds_read_b128 a[140:143], v5 offset:47104
v_mfma_f32_16x16x32_bf16 v[224:227], a[108:111], a[92:95], v[224:227]
v_mfma_f32_16x16x32_bf16 v[200:203], a[108:111], a[84:87], v[200:203]
buffer_load_dwordx4 v1, s[4:7], s44 offen offset:3072 sc1 lds
s_add_u32 m0, s19, 81920
v_mfma_f32_16x16x32_bf16 v[200:203], a[104:107], a[80:83], v[200:203]
s_add_u32 s44, s85, 0xc0c000
ds_read_b128 a[144:147], v5 offset:41984
v_mfma_f32_16x16x32_bf16 v[176:179], a[104:107], a[72:75], v[176:179]
v_mfma_f32_16x16x32_bf16 v[176:179], a[108:111], a[76:79], v[176:179]
ds_read_b128 a[148:151], v5 offset:48128
v_mfma_f32_16x16x32_bf16 v[152:155], a[108:111], a[68:71], v[152:155]
v_mfma_f32_16x16x32_bf16 v[152:155], a[104:107], a[64:67], v[152:155]
buffer_load_dwordx4 v1, s[4:7], s44 offen offset:0 sc1 lds
s_waitcnt vmcnt(13)
v_mfma_f32_16x16x32_bf16 v[140:143], a[112:115], a[0:3], v[140:143]
s_waitcnt vmcnt(12)
v_mfma_f32_16x16x32_bf16 v[140:143], a[116:119], a[4:7], v[140:143]
s_waitcnt vmcnt(10)
v_mfma_f32_16x16x32_bf16 v[164:167], a[116:119], a[12:15], v[164:167]
v_mfma_f32_16x16x32_bf16 v[164:167], a[112:115], a[8:11], v[164:167]
s_waitcnt vmcnt(9)
v_mfma_f32_16x16x32_bf16 v[188:191], a[112:115], a[16:19], v[188:191]
buffer_load_dwordx4 v1, s[4:7], s44 offen offset:1024 sc1 lds
s_waitcnt vmcnt(9)
v_mfma_f32_16x16x32_bf16 v[188:191], a[116:119], a[20:23], v[188:191]
s_waitcnt vmcnt(7)
v_mfma_f32_16x16x32_bf16 v[212:215], a[116:119], a[28:31], v[212:215]
v_mfma_f32_16x16x32_bf16 v[212:215], a[112:115], a[24:27], v[212:215]
s_waitcnt lgkmcnt(0)
v_mfma_f32_16x16x32_bf16 v[216:219], a[128:131], a[24:27], v[216:219]
ds_read_b128 a[96:99], v5 offset:12288
v_cvt_pk_bf16_f32 v140, v140, v141
v_mfma_f32_16x16x32_bf16 v[216:219], a[132:135], a[28:31], v[216:219]
buffer_load_dwordx4 v1, s[4:7], s44 offen offset:2048 sc1 lds
v_mfma_f32_16x16x32_bf16 v[192:195], a[132:135], a[20:23], v[192:195]
ds_read_b128 a[100:103], v5 offset:18432
v_cvt_pk_bf16_f32 v141, v142, v143
v_mfma_f32_16x16x32_bf16 v[192:195], a[128:131], a[16:19], v[192:195]
v_cvt_pk_bf16_f32 v164, v164, v165
v_cvt_pk_bf16_f32 v165, v166, v167
v_mfma_f32_16x16x32_bf16 v[168:171], a[128:131], a[8:11], v[168:171]
v_cvt_pk_bf16_f32 v188, v188, v189
v_cvt_pk_bf16_f32 v189, v190, v191
v_mfma_f32_16x16x32_bf16 v[168:171], a[132:135], a[12:15], v[168:171]
buffer_load_dwordx4 v1, s[4:7], s44 offen offset:3072 sc1 lds
s_add_u32 m0, s19, 147456
v_mfma_f32_16x16x32_bf16 v[144:147], a[132:135], a[4:7], v[144:147]
s_add_u32 s44, s87, 0xc1c000
ds_read_b128 a[104:107], v5 offset:24576
v_mfma_f32_16x16x32_bf16 v[144:147], a[128:131], a[0:3], v[144:147]
v_cvt_pk_bf16_f32 v212, v212, v213
v_cvt_pk_bf16_f32 v213, v214, v215
v_mfma_f32_16x16x32_bf16 v[148:151], a[136:139], a[0:3], v[148:151]
ds_read_b128 a[108:111], v5 offset:30720
v_cvt_pk_bf16_f32 v214, v216, v217
v_mfma_f32_16x16x32_bf16 v[148:151], a[140:143], a[4:7], v[148:151]
v_cvt_pk_bf16_f32 v215, v218, v219
v_mfma_f32_16x16x32_bf16 v[172:175], a[140:143], a[12:15], v[172:175]
buffer_load_dwordx4 v1, s[4:7], s44 offen offset:0 sc1 lds
v_mfma_f32_16x16x32_bf16 v[172:175], a[136:139], a[8:11], v[172:175]
ds_read_b128 a[112:115], v5 offset:36864
v_cvt_pk_bf16_f32 v190, v192, v193
v_mfma_f32_16x16x32_bf16 v[196:199], a[136:139], a[16:19], v[196:199]
v_cvt_pk_bf16_f32 v166, v168, v169
v_cvt_pk_bf16_f32 v167, v170, v171
v_mfma_f32_16x16x32_bf16 v[196:199], a[140:143], a[20:23], v[196:199]
ds_read_b128 a[116:119], v5 offset:43008
v_cvt_pk_bf16_f32 v191, v194, v195
v_mfma_f32_16x16x32_bf16 v[220:223], a[140:143], a[28:31], v[220:223]
v_cvt_pk_bf16_f32 v142, v144, v145
v_cvt_pk_bf16_f32 v143, v146, v147
v_mfma_f32_16x16x32_bf16 v[220:223], a[136:139], a[24:27], v[220:223]
buffer_load_dwordx4 v1, s[4:7], s44 offen offset:1024 sc1 lds
v_mfma_f32_16x16x32_bf16 v[224:227], a[144:147], a[24:27], v[224:227]
v_mfma_f32_16x16x32_bf16 v[92:95], a[240:243], v[140:143], 0
v_mfma_f32_16x16x32_bf16 v[224:227], a[148:151], a[28:31], v[224:227]
v_mfma_f32_16x16x32_bf16 v[96:99], a[244:247], v[140:143], 0
v_mfma_f32_16x16x32_bf16 v[200:203], a[148:151], a[20:23], v[200:203]
v_mfma_f32_16x16x32_bf16 v[100:103], a[240:243], v[164:167], 0
v_mfma_f32_16x16x32_bf16 v[200:203], a[144:147], a[16:19], v[200:203]
v_mfma_f32_16x16x32_bf16 v[104:107], a[244:247], v[164:167], 0
v_mfma_f32_16x16x32_bf16 v[176:179], a[144:147], a[8:11], v[176:179]
buffer_load_dwordx4 v1, s[4:7], s44 offen offset:2048 sc1 lds
v_mfma_f32_16x16x32_bf16 v[176:179], a[148:151], a[12:15], v[176:179]
v_max3_f32 v236, v92, v93, v94
v_max3_f32 v237, -v92, -v93, -v94
v_mfma_f32_16x16x32_bf16 v[152:155], a[148:151], a[4:7], v[152:155]
v_max3_f32 v236, v236, v95, v96
v_max3_f32 v237, v237, -v95, -v96
v_mfma_f32_16x16x32_bf16 v[152:155], a[144:147], a[0:3], v[152:155]
v_max3_f32 v236, v236, v97, v98
s_waitcnt lgkmcnt(0)
v_mfma_f32_16x16x32_bf16 v[132:135], a[96:99], a[32:35], v[132:135]
ds_read_b128 a[128:131], v5 offset:13312
v_max3_f32 v237, v237, -v97, -v98
v_mfma_f32_16x16x32_bf16 v[132:135], a[100:103], a[36:39], v[132:135]
buffer_load_dwordx4 v1, s[4:7], s44 offen offset:3072 sc1 lds
s_add_u32 m0, s19, 98304
v_mfma_f32_16x16x32_bf16 v[156:159], a[100:103], a[44:47], v[156:159]
s_add_u32 s44, s84, 0xc10000
ds_read_b128 a[132:135], v5 offset:19456
v_mfma_f32_16x16x32_bf16 v[156:159], a[96:99], a[40:43], v[156:159]
v_max_f32 v236, v236, v99
v_max_f32_e64 v237, v237, -v99
v_mfma_f32_16x16x32_bf16 v[180:183], a[96:99], a[48:51], v[180:183]
s_nop 0
v_permlane32_swap_b32 v236, v237
v_mfma_f32_16x16x32_bf16 v[180:183], a[100:103], a[52:55], v[180:183]
buffer_load_dwordx4 v1, s[4:7], s44 offen offset:0 sc1 lds
v_mfma_f32_16x16x32_bf16 v[204:207], a[100:103], a[60:63], v[204:207]
ds_read_b128 a[136:139], v5 offset:25600
v_max_f32 v236, v236, v237
v_mfma_f32_16x16x32_bf16 v[204:207], a[96:99], a[56:59], v[204:207]
v_mov_b32 v244, v236
v_max3_f32 v238, v100, v101, v102
v_mfma_f32_16x16x32_bf16 v[204:207], a[104:107], a[88:91], v[204:207]
ds_read_b128 a[140:143], v5 offset:31744
v_max3_f32 v239, -v100, -v101, -v102
v_mfma_f32_16x16x32_bf16 v[204:207], a[108:111], a[92:95], v[204:207]
v_permlane16_swap_b32 v236, v244
v_mfma_f32_16x16x32_bf16 v[180:183], a[108:111], a[84:87], v[180:183]
buffer_load_dwordx4 v1, s[4:7], s44 offen offset:1024 sc1 lds
v_mfma_f32_16x16x32_bf16 v[180:183], a[104:107], a[80:83], v[180:183]
ds_read_b128 a[144:147], v5 offset:37888
v_max_f32 v236, v236, v244
v_mfma_f32_16x16x32_bf16 v[156:159], a[104:107], a[72:75], v[156:159]
v_mov_b32 v244, v236
v_max3_f32 v238, v238, v103, v104
v_mfma_f32_16x16x32_bf16 v[156:159], a[108:111], a[76:79], v[156:159]
ds_read_b128 a[148:151], v5 offset:44032
v_max3_f32 v239, v239, -v103, -v104
v_mfma_f32_16x16x32_bf16 v[132:135], a[108:111], a[68:71], v[132:135]
v_permlane32_swap_b32 v236, v244
v_mfma_f32_16x16x32_bf16 v[132:135], a[104:107], a[64:67], v[132:135]
buffer_load_dwordx4 v1, s[4:7], s44 offen offset:2048 sc1 lds
v_mfma_f32_16x16x32_bf16 v[132:135], a[112:115], a[0:3], v[132:135]
v_mul_f32_e64 v236, -v236, v82
v_mul_f32_e64 v237, -v244, v82
v_mfma_f32_16x16x32_bf16 v[132:135], a[116:119], a[4:7], v[132:135]
v_max3_f32 v238, v238, v105, v106
v_max3_f32 v239, v239, -v105, -v106
v_mfma_f32_16x16x32_bf16 v[156:159], a[116:119], a[12:15], v[156:159]
v_max_f32 v238, v238, v107
v_max_f32_e64 v239, v239, -v107
v_mfma_f32_16x16x32_bf16 v[156:159], a[112:115], a[8:11], v[156:159]
s_nop 0
v_permlane32_swap_b32 v238, v239
v_mfma_f32_16x16x32_bf16 v[180:183], a[112:115], a[16:19], v[180:183]
buffer_load_dwordx4 v1, s[4:7], s44 offen offset:3072 sc1 lds
s_add_u32 m0, s19, 114688
v_mfma_f32_16x16x32_bf16 v[180:183], a[116:119], a[20:23], v[180:183]
s_add_u32 s44, s85, 0xc14000
v_max_f32 v238, v238, v239
v_mfma_f32_16x16x32_bf16 v[204:207], a[116:119], a[28:31], v[204:207]
v_mov_b32 v245, v238
v_mul_f32 v148, v148, v83
v_mfma_f32_16x16x32_bf16 v[204:207], a[112:115], a[24:27], v[204:207]
s_waitcnt lgkmcnt(0)
s_barrier
v_mfma_f32_16x16x32_bf16 v[208:211], a[128:131], a[56:59], v[208:211]
v_mul_f32 v149, v149, v83
v_cvt_pk_bf16_f32 v148, v148, v149
v_mfma_f32_16x16x32_bf16 v[208:211], a[132:135], a[60:63], v[208:211]
buffer_load_dwordx4 v1, s[4:7], s44 offen offset:0 sc1 lds
v_mfma_f32_16x16x32_bf16 v[184:187], a[132:135], a[52:55], v[184:187]
v_permlane16_swap_b32 v238, v245
v_mfma_f32_16x16x32_bf16 v[184:187], a[128:131], a[48:51], v[184:187]
v_max_f32 v238, v238, v245
v_mov_b32 v245, v238
v_mfma_f32_16x16x32_bf16 v[160:163], a[128:131], a[40:43], v[160:163]
s_nop 0
v_permlane32_swap_b32 v238, v245
v_mfma_f32_16x16x32_bf16 v[160:163], a[132:135], a[44:47], v[160:163]
v_mul_f32_e64 v238, -v238, v84
v_mul_f32_e64 v239, -v245, v84
v_mfma_f32_16x16x32_bf16 v[136:139], a[132:135], a[36:39], v[136:139]
v_mfma_f32_16x16x32_bf16 v[108:111], a[240:243], v[188:191], 0
v_mfma_f32_16x16x32_bf16 v[136:139], a[128:131], a[32:35], v[136:139]
buffer_load_dwordx4 v1, s[4:7], s44 offen offset:1024 sc1 lds
v_mfma_f32_16x16x32_bf16 v[136:139], a[136:139], a[64:67], v[136:139]
v_mfma_f32_16x16x32_bf16 v[112:115], a[244:247], v[188:191], 0
v_mfma_f32_16x16x32_bf16 v[136:139], a[140:143], a[68:71], v[136:139]
v_mfma_f32_16x16x32_bf16 v[116:119], a[240:243], v[212:215], 0
v_mfma_f32_16x16x32_bf16 v[160:163], a[140:143], a[76:79], v[160:163]
v_mfma_f32_16x16x32_bf16 v[120:123], a[244:247], v[212:215], 0
v_mfma_f32_16x16x32_bf16 v[160:163], a[136:139], a[72:75], v[160:163]
v_max3_f32 v240, v108, v109, v110
v_max3_f32 v241, -v108, -v109, -v110
v_mfma_f32_16x16x32_bf16 v[184:187], a[136:139], a[80:83], v[184:187]
v_mul_f32 v150, v150, v83
v_mul_f32 v151, v151, v83
v_mfma_f32_16x16x32_bf16 v[184:187], a[140:143], a[84:87], v[184:187]
buffer_load_dwordx4 v1, s[4:7], s44 offen offset:2048 sc1 lds
v_mfma_f32_16x16x32_bf16 v[208:211], a[140:143], a[92:95], v[208:211]
v_cvt_pk_bf16_f32 v149, v150, v151
v_max3_f32 v240, v240, v111, v112
v_mfma_f32_16x16x32_bf16 v[208:211], a[136:139], a[88:91], v[208:211]
ds_write_b64 v232, v[148:149] offset:0
v_max3_f32 v241, v241, -v111, -v112
v_mfma_f32_16x16x32_bf16 v[208:211], a[144:147], a[24:27], v[208:211]
v_max3_f32 v240, v240, v113, v114
v_max3_f32 v241, v241, -v113, -v114
v_mfma_f32_16x16x32_bf16 v[208:211], a[148:151], a[28:31], v[208:211]
v_max_f32 v240, v240, v115
v_max_f32_e64 v241, v241, -v115
v_mfma_f32_16x16x32_bf16 v[184:187], a[148:151], a[20:23], v[184:187]
s_nop 0
v_permlane32_swap_b32 v240, v241
v_mfma_f32_16x16x32_bf16 v[184:187], a[144:147], a[16:19], v[184:187]
buffer_load_dwordx4 v1, s[4:7], s44 offen offset:3072 sc1 lds
v_mfma_f32_16x16x32_bf16 v[160:163], a[144:147], a[8:11], v[160:163]
v_max_f32 v240, v240, v241
v_mov_b32 v246, v240
v_mfma_f32_16x16x32_bf16 v[160:163], a[148:151], a[12:15], v[160:163]
s_nop 0
v_permlane16_swap_b32 v240, v246
v_mfma_f32_16x16x32_bf16 v[136:139], a[148:151], a[4:7], v[136:139]
v_max_f32 v240, v240, v246
v_mov_b32 v246, v240
v_mfma_f32_16x16x32_bf16 v[136:139], a[144:147], a[0:3], v[136:139]
s_nop 0
v_permlane32_swap_b32 v240, v246
v_pk_mul_f32 v[152:153], v[152:153], v[82:83] op_sel:[0,1] op_sel_hi:[1,1]
v_pk_mul_f32 v[154:155], v[154:155], v[82:83] op_sel:[0,1] op_sel_hi:[1,1]
v_cvt_pk_bf16_f32 v150, v152, v153
v_cvt_pk_bf16_f32 v151, v154, v155
ds_write_b64 v232, v[150:151] offset:512
v_pk_mul_f32 v[172:173], v[172:173], v[84:85] op_sel:[0,1] op_sel_hi:[1,1]
v_pk_mul_f32 v[174:175], v[174:175], v[84:85] op_sel:[0,1] op_sel_hi:[1,1]
v_cvt_pk_bf16_f32 v172, v172, v173
v_cvt_pk_bf16_f32 v173, v174, v175
v_pk_mul_f32 v[176:177], v[176:177], v[84:85] op_sel:[0,1] op_sel_hi:[1,1]
v_pk_mul_f32 v[178:179], v[178:179], v[84:85] op_sel:[0,1] op_sel_hi:[1,1]
v_cvt_pk_bf16_f32 v174, v176, v177
v_cvt_pk_bf16_f32 v175, v178, v179
v_pk_mul_f32 v[196:197], v[196:197], v[86:87] op_sel:[0,1] op_sel_hi:[1,1]
v_pk_mul_f32 v[198:199], v[198:199], v[86:87] op_sel:[0,1] op_sel_hi:[1,1]
v_cvt_pk_bf16_f32 v196, v196, v197
v_cvt_pk_bf16_f32 v197, v198, v199
ds_write_b64 v232, v[172:173] offset:1024
buffer_store_dwordx4 a[248:251], v254, s[4:7], s97 offen offset:0 sc1
v_pk_mul_f32 v[200:201], v[200:201], v[86:87] op_sel:[0,1] op_sel_hi:[1,1]
v_pk_mul_f32 v[202:203], v[202:203], v[86:87] op_sel:[0,1] op_sel_hi:[1,1]
v_cvt_pk_bf16_f32 v198, v200, v201
v_cvt_pk_bf16_f32 v199, v202, v203
v_pk_mul_f32 v[220:221], v[220:221], v[88:89] op_sel:[0,1] op_sel_hi:[1,1]
v_pk_mul_f32 v[222:223], v[222:223], v[88:89] op_sel:[0,1] op_sel_hi:[1,1]
v_cvt_pk_bf16_f32 v220, v220, v221
v_cvt_pk_bf16_f32 v221, v222, v223
ds_write_b64 v232, v[174:175] offset:1536
v_pk_fma_f32 v[48:49], v[92:93], v[82:83], v[236:237] op_sel:[0,0,0] op_sel_hi:[1,0,0]
v_pk_fma_f32 v[50:51], v[94:95], v[82:83], v[236:237] op_sel:[0,0,0] op_sel_hi:[1,0,0]
v_pk_fma_f32 v[52:53], v[96:97], v[82:83], v[236:237] op_sel:[0,0,0] op_sel_hi:[1,0,0]
v_pk_fma_f32 v[54:55], v[98:99], v[82:83], v[236:237] op_sel:[0,0,0] op_sel_hi:[1,0,0]
v_exp_f32 v48, v48
v_exp_f32 v49, v49
v_exp_f32 v50, v50
v_exp_f32 v51, v51
ds_write_b64 v232, v[196:197] offset:2048
v_exp_f32 v52, v52
v_exp_f32 v53, v53
v_exp_f32 v54, v54
v_exp_f32 v55, v55
buffer_store_dwordx4 a[248:251], v1, s[4:7], s96 offen offset:0 sc1
ds_write_b64 v232, v[198:199] offset:2560
v_cvt_pk_bf16_f32 v140, v48, v49
v_cvt_pk_bf16_f32 v141, v50, v51
v_cvt_pk_bf16_f32 v142, v52, v53
v_cvt_pk_bf16_f32 v143, v54, v55
v_pk_mul_f32 v[224:225], v[224:225], v[88:89] op_sel:[0,1] op_sel_hi:[1,1]
v_pk_mul_f32 v[226:227], v[226:227], v[88:89] op_sel:[0,1] op_sel_hi:[1,1]
v_cvt_pk_bf16_f32 v222, v224, v225
v_mfma_f32_16x16x32_bf16 v[148:151], v[16:19], v[140:143], 0
v_cvt_pk_bf16_f32 v223, v226, v227
s_add_u32 m0, s19, 131072
s_add_u32 s44, s86, 0xc18000
ds_write_b64 v232, v[220:221] offset:3072
v_pk_fma_f32 v[92:93], v[92:93], v[82:83], v[236:237] op_sel:[0,0,1] op_sel_hi:[1,0,1] neg_lo:[1,0,0] neg_hi:[1,0,0]
v_pk_fma_f32 v[94:95], v[94:95], v[82:83], v[236:237] op_sel:[0,0,1] op_sel_hi:[1,0,1] neg_lo:[1,0,0] neg_hi:[1,0,0]
s_nop 1
v_rcp_f32 v148, v148
v_pk_fma_f32 v[96:97], v[96:97], v[82:83], v[236:237] op_sel:[0,0,1] op_sel_hi:[1,0,1] neg_lo:[1,0,0] neg_hi:[1,0,0]
v_pk_mul_f32 v[48:49], v[48:49], v[148:149] op_sel:[0,0] op_sel_hi:[1,0]
v_pk_mul_f32 v[50:51], v[50:51], v[148:149] op_sel:[0,0] op_sel_hi:[1,0]
v_cvt_pk_bf16_f32 v140, v48, v49
v_cvt_pk_bf16_f32 v141, v50, v51
v_pk_fma_f32 v[98:99], v[98:99], v[82:83], v[236:237] op_sel:[0,0,1] op_sel_hi:[1,0,1] neg_lo:[1,0,0] neg_hi:[1,0,0]
v_exp_f32 v92, v92
ds_write_b64 v232, v[222:223] offset:3584
v_exp_f32 v93, v93
v_exp_f32 v94, v94
v_exp_f32 v95, v95
v_exp_f32 v96, v96
v_exp_f32 v97, v97
v_exp_f32 v98, v98
ds_write_b64 v233, v[140:141] offset:16384
v_exp_f32 v99, v99
v_cvt_pk_bf16_f32 v144, v92, v93
v_cvt_pk_bf16_f32 v145, v94, v95
v_cvt_pk_bf16_f32 v146, v96, v97
v_cvt_pk_bf16_f32 v147, v98, v99
buffer_load_dwordx4 v1, s[4:7], s44 offen offset:0 sc1 lds
v_pk_mul_f32 v[52:53], v[52:53], v[148:149] op_sel:[0,0] op_sel_hi:[1,0]
v_cvt_pk_bf16_f32 v142, v52, v53
v_pk_mul_f32 v[54:55], v[54:55], v[148:149] op_sel:[0,0] op_sel_hi:[1,0]
v_cvt_pk_bf16_f32 v143, v54, v55
v_mfma_f32_16x16x32_bf16 v[152:155], v[16:19], v[144:147], 0
ds_write_b64 v233, v[142:143] offset:16896
v_mul_f32_e64 v240, -v240, v86
v_mul_f32_e64 v241, -v246, v86
v_pk_fma_f32 v[56:57], v[100:101], v[84:85], v[238:239] op_sel:[0,0,0] op_sel_hi:[1,0,0]
v_pk_fma_f32 v[58:59], v[102:103], v[84:85], v[238:239] op_sel:[0,0,0] op_sel_hi:[1,0,0]
v_pk_fma_f32 v[60:61], v[104:105], v[84:85], v[238:239] op_sel:[0,0,0] op_sel_hi:[1,0,0]
s_nop 1
v_rcp_f32 v152, v152
v_pk_fma_f32 v[62:63], v[106:107], v[84:85], v[238:239] op_sel:[0,0,0] op_sel_hi:[1,0,0]
v_pk_mul_f32 v[92:93], v[92:93], v[152:153] op_sel:[0,0] op_sel_hi:[1,0]
v_pk_mul_f32 v[94:95], v[94:95], v[152:153] op_sel:[0,0] op_sel_hi:[1,0]
v_cvt_pk_bf16_f32 v144, v92, v93
v_cvt_pk_bf16_f32 v145, v94, v95
ds_write_b64 v233, v[144:145] offset:17408
v_exp_f32 v56, v56
v_exp_f32 v57, v57
v_exp_f32 v58, v58
v_exp_f32 v59, v59
v_exp_f32 v60, v60
v_exp_f32 v61, v61
v_exp_f32 v62, v62
v_exp_f32 v63, v63
buffer_load_dwordx4 v1, s[4:7], s44 offen offset:1024 sc1 lds
v_cvt_pk_bf16_f32 v164, v56, v57
v_cvt_pk_bf16_f32 v165, v58, v59
v_cvt_pk_bf16_f32 v166, v60, v61
v_cvt_pk_bf16_f32 v167, v62, v63
v_pk_mul_f32 v[96:97], v[96:97], v[152:153] op_sel:[0,0] op_sel_hi:[1,0]
v_pk_mul_f32 v[98:99], v[98:99], v[152:153] op_sel:[0,0] op_sel_hi:[1,0]
v_cvt_pk_bf16_f32 v146, v96, v97
v_mfma_f32_16x16x32_bf16 v[172:175], v[16:19], v[164:167], 0
v_cvt_pk_bf16_f32 v147, v98, v99
ds_write_b64 v233, v[146:147] offset:17920
v_max3_f32 v242, v116, v117, v118
v_pk_fma_f32 v[100:101], v[100:101], v[84:85], v[238:239] op_sel:[0,0,1] op_sel_hi:[1,0,1] neg_lo:[1,0,0] neg_hi:[1,0,0]
v_pk_fma_f32 v[102:103], v[102:103], v[84:85], v[238:239] op_sel:[0,0,1] op_sel_hi:[1,0,1] neg_lo:[1,0,0] neg_hi:[1,0,0]
v_pk_fma_f32 v[104:105], v[104:105], v[84:85], v[238:239] op_sel:[0,0,1] op_sel_hi:[1,0,1] neg_lo:[1,0,0] neg_hi:[1,0,0]
s_nop 1
v_rcp_f32 v172, v172
v_pk_fma_f32 v[106:107], v[106:107], v[84:85], v[238:239] op_sel:[0,0,1] op_sel_hi:[1,0,1] neg_lo:[1,0,0] neg_hi:[1,0,0]
v_pk_mul_f32 v[56:57], v[56:57], v[172:173] op_sel:[0,0] op_sel_hi:[1,0]
v_pk_mul_f32 v[58:59], v[58:59], v[172:173] op_sel:[0,0] op_sel_hi:[1,0]
v_cvt_pk_bf16_f32 v164, v56, v57
v_cvt_pk_bf16_f32 v165, v58, v59
v_exp_f32 v100, v100
ds_write_b64 v233, v[164:165] offset:18432
v_exp_f32 v101, v101
v_exp_f32 v102, v102
v_exp_f32 v103, v103
v_exp_f32 v104, v104
v_exp_f32 v105, v105
v_exp_f32 v106, v106
v_exp_f32 v107, v107
buffer_load_dwordx4 v1, s[4:7], s44 offen offset:2048 sc1 lds
v_cvt_pk_bf16_f32 v168, v100, v101
v_cvt_pk_bf16_f32 v169, v102, v103
v_cvt_pk_bf16_f32 v170, v104, v105
v_cvt_pk_bf16_f32 v171, v106, v107
v_pk_mul_f32 v[60:61], v[60:61], v[172:173] op_sel:[0,0] op_sel_hi:[1,0]
v_pk_mul_f32 v[62:63], v[62:63], v[172:173] op_sel:[0,0] op_sel_hi:[1,0]
v_cvt_pk_bf16_f32 v166, v60, v61
v_mfma_f32_16x16x32_bf16 v[176:179], v[16:19], v[168:171], 0
v_cvt_pk_bf16_f32 v167, v62, v63
ds_write_b64 v233, v[166:167] offset:18944
v_max3_f32 v243, -v116, -v117, -v118
v_pk_fma_f32 v[64:65], v[108:109], v[86:87], v[240:241] op_sel:[0,0,0] op_sel_hi:[1,0,0]
v_pk_fma_f32 v[66:67], v[110:111], v[86:87], v[240:241] op_sel:[0,0,0] op_sel_hi:[1,0,0]
v_pk_fma_f32 v[68:69], v[112:113], v[86:87], v[240:241] op_sel:[0,0,0] op_sel_hi:[1,0,0]
s_nop 1
v_rcp_f32 v176, v176
v_pk_fma_f32 v[70:71], v[114:115], v[86:87], v[240:241] op_sel:[0,0,0] op_sel_hi:[1,0,0]
v_pk_mul_f32 v[100:101], v[100:101], v[176:177] op_sel:[0,0] op_sel_hi:[1,0]
v_pk_mul_f32 v[102:103], v[102:103], v[176:177] op_sel:[0,0] op_sel_hi:[1,0]
v_cvt_pk_bf16_f32 v168, v100, v101
v_cvt_pk_bf16_f32 v169, v102, v103
v_exp_f32 v64, v64
ds_write_b64 v233, v[168:169] offset:19456
buffer_load_dwordx4 v1, s[4:7], s44 offen offset:3072 sc1 lds
v_exp_f32 v65, v65
v_exp_f32 v66, v66
v_exp_f32 v67, v67
v_exp_f32 v68, v68
v_exp_f32 v69, v69
v_exp_f32 v70, v70
v_exp_f32 v71, v71
v_cvt_pk_bf16_f32 v188, v64, v65
v_cvt_pk_bf16_f32 v189, v66, v67
v_cvt_pk_bf16_f32 v190, v68, v69
v_cvt_pk_bf16_f32 v191, v70, v71
v_pk_mul_f32 v[104:105], v[104:105], v[176:177] op_sel:[0,0] op_sel_hi:[1,0]
v_pk_mul_f32 v[106:107], v[106:107], v[176:177] op_sel:[0,0] op_sel_hi:[1,0]
v_cvt_pk_bf16_f32 v170, v104, v105
v_mfma_f32_16x16x32_bf16 v[196:199], v[16:19], v[188:191], 0
v_cvt_pk_bf16_f32 v171, v106, v107
ds_write_b64 v233, v[170:171] offset:19968
buffer_store_dwordx4 a[248:251], v2, s[4:7], s72 offen offset:0 sc1
s_nop 4
v_rcp_f32 v196, v196
v_pk_fma_f32 v[108:109], v[108:109], v[86:87], v[240:241] op_sel:[0,0,1] op_sel_hi:[1,0,1] neg_lo:[1,0,0] neg_hi:[1,0,0]
v_pk_mul_f32 v[64:65], v[64:65], v[196:197] op_sel:[0,0] op_sel_hi:[1,0]
v_pk_mul_f32 v[66:67], v[66:67], v[196:197] op_sel:[0,0] op_sel_hi:[1,0]
v_cvt_pk_bf16_f32 v188, v64, v65
v_cvt_pk_bf16_f32 v189, v66, v67
v_pk_fma_f32 v[110:111], v[110:111], v[86:87], v[240:241] op_sel:[0,0,1] op_sel_hi:[1,0,1] neg_lo:[1,0,0] neg_hi:[1,0,0]
ds_write_b64 v233, v[188:189] offset:20480
v_pk_fma_f32 v[112:113], v[112:113], v[86:87], v[240:241] op_sel:[0,0,1] op_sel_hi:[1,0,1] neg_lo:[1,0,0] neg_hi:[1,0,0]
v_pk_fma_f32 v[114:115], v[114:115], v[86:87], v[240:241] op_sel:[0,0,1] op_sel_hi:[1,0,1] neg_lo:[1,0,0] neg_hi:[1,0,0]
v_exp_f32 v108, v108
v_exp_f32 v109, v109
v_exp_f32 v110, v110
v_exp_f32 v111, v111
v_exp_f32 v112, v112
v_exp_f32 v113, v113
v_exp_f32 v114, v114
v_exp_f32 v115, v115
v_max3_f32 v242, v242, v119, v120
v_max3_f32 v243, v243, -v119, -v120
v_max3_f32 v242, v242, v121, v122
v_max3_f32 v243, v243, -v121, -v122
v_max_f32 v242, v242, v123
v_max_f32_e64 v243, v243, -v123
v_cvt_pk_bf16_f32 v192, v108, v109
v_cvt_pk_bf16_f32 v193, v110, v111
v_cvt_pk_bf16_f32 v194, v112, v113
v_cvt_pk_bf16_f32 v195, v114, v115
v_pk_mul_f32 v[68:69], v[68:69], v[196:197] op_sel:[0,0] op_sel_hi:[1,0]
v_pk_mul_f32 v[70:71], v[70:71], v[196:197] op_sel:[0,0] op_sel_hi:[1,0]
v_permlane32_swap_b32 v242, v243
v_mfma_f32_16x16x32_bf16 v[200:203], v[16:19], v[192:195], 0
v_cvt_pk_bf16_f32 v190, v68, v69
v_cvt_pk_bf16_f32 v191, v70, v71
ds_write_b64 v233, v[190:191] offset:20992
v_max_f32 v242, v242, v243
v_mov_b32 v247, v242
buffer_store_dwordx4 a[248:251], v2, s[4:7], s72 offen offset:1024 sc1
s_nop 0
v_permlane16_swap_b32 v242, v247
v_rcp_f32 v200, v200
v_max_f32 v242, v242, v247
v_mov_b32 v247, v242
v_pk_mul_f32 v[108:109], v[108:109], v[200:201] op_sel:[0,0] op_sel_hi:[1,0]
v_pk_mul_f32 v[110:111], v[110:111], v[200:201] op_sel:[0,0] op_sel_hi:[1,0]
v_cvt_pk_bf16_f32 v192, v108, v109
v_cvt_pk_bf16_f32 v193, v110, v111
v_permlane32_swap_b32 v242, v247
ds_write_b64 v233, v[192:193] offset:21504
v_mul_f32_e64 v242, -v242, v88
v_mul_f32_e64 v243, -v247, v88
v_pk_fma_f32 v[124:125], v[116:117], v[88:89], v[242:243] op_sel:[0,0,0] op_sel_hi:[1,0,0]
v_pk_fma_f32 v[126:127], v[118:119], v[88:89], v[242:243] op_sel:[0,0,0] op_sel_hi:[1,0,0]
v_pk_fma_f32 v[128:129], v[120:121], v[88:89], v[242:243] op_sel:[0,0,0] op_sel_hi:[1,0,0]
v_pk_fma_f32 v[130:131], v[122:123], v[88:89], v[242:243] op_sel:[0,0,0] op_sel_hi:[1,0,0]
v_exp_f32 v124, v124
v_exp_f32 v125, v125
v_exp_f32 v126, v126
v_exp_f32 v127, v127
v_exp_f32 v128, v128
v_exp_f32 v129, v129
v_exp_f32 v130, v130
v_exp_f32 v131, v131
v_cvt_pk_bf16_f32 v212, v124, v125
v_cvt_pk_bf16_f32 v213, v126, v127
v_cvt_pk_bf16_f32 v214, v128, v129
v_cvt_pk_bf16_f32 v215, v130, v131
v_pk_mul_f32 v[112:113], v[112:113], v[200:201] op_sel:[0,0] op_sel_hi:[1,0]
L_stub18:
s_cbranch_execz L_stub19
v_pk_mul_f32 v[114:115], v[114:115], v[200:201] op_sel:[0,0] op_sel_hi:[1,0]
v_cvt_pk_bf16_f32 v194, v112, v113
v_mfma_f32_16x16x32_bf16 v[220:223], v[16:19], v[212:215], 0
v_cvt_pk_bf16_f32 v195, v114, v115
ds_write_b64 v233, v[194:195] offset:22016
buffer_store_dwordx4 a[248:251], v2, s[4:7], s72 offen offset:2048 sc1
s_nop 4
v_rcp_f32 v220, v220
v_pk_fma_f32 v[116:117], v[116:117], v[88:89], v[242:243] op_sel:[0,0,1] op_sel_hi:[1,0,1] neg_lo:[1,0,0] neg_hi:[1,0,0]
v_pk_mul_f32 v[124:125], v[124:125], v[220:221] op_sel:[0,0] op_sel_hi:[1,0]
v_pk_mul_f32 v[126:127], v[126:127], v[220:221] op_sel:[0,0] op_sel_hi:[1,0]
v_cvt_pk_bf16_f32 v212, v124, v125
v_cvt_pk_bf16_f32 v213, v126, v127
v_pk_fma_f32 v[118:119], v[118:119], v[88:89], v[242:243] op_sel:[0,0,1] op_sel_hi:[1,0,1] neg_lo:[1,0,0] neg_hi:[1,0,0]
ds_write_b64 v233, v[212:213] offset:22528
v_pk_fma_f32 v[120:121], v[120:121], v[88:89], v[242:243] op_sel:[0,0,1] op_sel_hi:[1,0,1] neg_lo:[1,0,0] neg_hi:[1,0,0]
v_pk_fma_f32 v[122:123], v[122:123], v[88:89], v[242:243] op_sel:[0,0,1] op_sel_hi:[1,0,1] neg_lo:[1,0,0] neg_hi:[1,0,0]
v_exp_f32 v116, v116
v_exp_f32 v117, v117
v_exp_f32 v118, v118
v_exp_f32 v119, v119
v_exp_f32 v120, v120
v_exp_f32 v121, v121
v_exp_f32 v122, v122
v_exp_f32 v123, v123
v_cvt_pk_bf16_f32 v216, v116, v117
v_cvt_pk_bf16_f32 v217, v118, v119
v_cvt_pk_bf16_f32 v218, v120, v121
v_cvt_pk_bf16_f32 v219, v122, v123
v_pk_mul_f32 v[128:129], v[128:129], v[220:221] op_sel:[0,0] op_sel_hi:[1,0]
v_pk_mul_f32 v[130:131], v[130:131], v[220:221] op_sel:[0,0] op_sel_hi:[1,0]
v_cvt_pk_bf16_f32 v214, v128, v129
v_mfma_f32_16x16x32_bf16 v[224:227], v[16:19], v[216:219], 0
v_cvt_pk_bf16_f32 v215, v130, v131
ds_write_b64 v233, v[214:215] offset:23040
buffer_store_dwordx4 a[248:251], v2, s[4:7], s72 offen offset:3072 sc1
s_nop 4
v_rcp_f32 v224, v224
s_nop 0
v_pk_mul_f32 v[116:117], v[116:117], v[224:225] op_sel:[0,0] op_sel_hi:[1,0]
v_pk_mul_f32 v[118:119], v[118:119], v[224:225] op_sel:[0,0] op_sel_hi:[1,0]
v_cvt_pk_bf16_f32 v216, v116, v117
v_cvt_pk_bf16_f32 v217, v118, v119
v_pk_mul_f32 v[120:121], v[120:121], v[224:225] op_sel:[0,0] op_sel_hi:[1,0]
ds_write_b64 v233, v[216:217] offset:23552
v_pk_mul_f32 v[122:123], v[122:123], v[224:225] op_sel:[0,0] op_sel_hi:[1,0]
v_cvt_pk_bf16_f32 v218, v120, v121
v_cvt_pk_bf16_f32 v219, v122, v123
ds_write_b64 v233, v[218:219] offset:24064
s_waitcnt vmcnt(8)
s_waitcnt lgkmcnt(0)
s_barrier
ds_read_b64_tr_b16 a[0:1], v234 offset:16384
ds_read_b64_tr_b16 a[2:3], v234 offset:18432
ds_read_b64_tr_b16 a[12:13], v234 offset:20480
ds_read_b64_tr_b16 a[14:15], v234 offset:22528
ds_read_b64_tr_b16 a[24:25], v234 offset:24576
ds_read_b64_tr_b16 a[26:27], v234 offset:26624
ds_read_b64_tr_b16 a[4:5], v8 offset:0
ds_read_b64_tr_b16 a[6:7], v8 offset:1024
ds_read_b64_tr_b16 a[8:9], v8 offset:512
ds_read_b64_tr_b16 a[10:11], v8 offset:1536
ds_read_b64_tr_b16 a[36:37], v234 offset:28672
ds_read_b64_tr_b16 a[38:39], v234 offset:30720
ds_read_b64_tr_b16 a[16:17], v8 offset:2048
ds_read_b64_tr_b16 a[18:19], v8 offset:3072
ds_read_b64_tr_b16 a[20:21], v8 offset:2560
ds_read_b64_tr_b16 a[22:23], v8 offset:3584
ds_read_b64_tr_b16 a[48:49], v234 offset:32768
ds_read_b64_tr_b16 a[50:51], v234 offset:34816
ds_read_b64_tr_b16 a[28:29], v8 offset:4096
ds_read_b64_tr_b16 a[30:31], v8 offset:5120
ds_read_b64_tr_b16 a[32:33], v8 offset:4608
ds_read_b64_tr_b16 a[34:35], v8 offset:5632
ds_read_b64_tr_b16 a[60:61], v234 offset:36864
ds_read_b64_tr_b16 a[62:63], v234 offset:38912
s_waitcnt lgkmcnt(14)
v_mfma_f32_16x16x32_bf16 v[100:103], a[0:3], v[16:19], 0
ds_read_b64_tr_b16 a[40:41], v8 offset:6144
ds_read_b64_tr_b16 a[42:43], v8 offset:7168
ds_read_b64_tr_b16 a[44:45], v8 offset:6656
ds_read_b64_tr_b16 a[46:47], v8 offset:7680
ds_read_b64_tr_b16 a[72:73], v234 offset:40960
ds_read_b64_tr_b16 a[74:75], v234 offset:43008
v_mfma_f32_16x16x32_bf16 v[100:103], a[12:15], v[16:19], v[100:103]
buffer_atomic_add v12, v235, s[4:7], s94 offen sc1
ds_read_b64_tr_b16 a[52:53], v8 offset:8192
ds_read_b64_tr_b16 a[54:55], v8 offset:9216
ds_read_b64_tr_b16 a[56:57], v8 offset:8704
ds_read_b64_tr_b16 a[58:59], v8 offset:9728
ds_read_b64_tr_b16 a[84:85], v234 offset:45056
ds_read_b64_tr_b16 a[86:87], v234 offset:47104
v_mfma_f32_16x16x32_bf16 v[100:103], a[24:27], v[16:19], v[100:103]
ds_read_b64_tr_b16 a[64:65], v8 offset:10240
ds_read_b64_tr_b16 a[66:67], v8 offset:11264
v_mfma_f32_16x16x32_bf16 v[92:95], a[0:3], a[4:7], 0
ds_read_b64_tr_b16 a[68:69], v8 offset:10752
ds_read_b64_tr_b16 a[70:71], v8 offset:11776
v_mfma_f32_16x16x32_bf16 v[96:99], a[0:3], a[8:11], 0
ds_read_b64_tr_b16 a[76:77], v8 offset:12288
s_waitcnt lgkmcnt(14)
v_mfma_f32_16x16x32_bf16 v[100:103], a[36:39], v[16:19], v[100:103]
ds_read_b64_tr_b16 a[78:79], v8 offset:13312
v_mfma_f32_16x16x32_bf16 v[92:95], a[12:15], a[16:19], v[92:95]
ds_read_b64_tr_b16 a[80:81], v8 offset:12800
ds_read_b64_tr_b16 a[82:83], v8 offset:13824
v_mfma_f32_16x16x32_bf16 v[96:99], a[12:15], a[20:23], v[96:99]
ds_read_b64_tr_b16 a[88:89], v8 offset:14336
v_mfma_f32_16x16x32_bf16 v[100:103], a[48:51], v[16:19], v[100:103]
ds_read_b64_tr_b16 a[90:91], v8 offset:15360
v_mfma_f32_16x16x32_bf16 v[92:95], a[24:27], a[28:31], v[92:95]
ds_read_b64_tr_b16 a[92:93], v8 offset:14848
ds_read_b64_tr_b16 a[94:95], v8 offset:15872
v_mfma_f32_16x16x32_bf16 v[96:99], a[24:27], a[32:35], v[96:99]
v_cvt_pk_bf16_f32 v132, v132, v133
v_cvt_pk_bf16_f32 v156, v156, v157
v_mfma_f32_16x16x32_bf16 v[100:103], a[60:63], v[16:19], v[100:103]
v_cvt_pk_bf16_f32 v180, v180, v181
v_cvt_pk_bf16_f32 v204, v204, v205
v_mfma_f32_16x16x32_bf16 v[92:95], a[36:39], a[40:43], v[92:95]
v_cvt_pk_bf16_f32 v133, v134, v135
v_cvt_pk_bf16_f32 v157, v158, v159
s_waitcnt lgkmcnt(14)
v_mfma_f32_16x16x32_bf16 v[96:99], a[36:39], a[44:47], v[96:99]
v_cvt_pk_bf16_f32 v181, v182, v183
v_cvt_pk_bf16_f32 v205, v206, v207
v_mfma_f32_16x16x32_bf16 v[100:103], a[72:75], v[16:19], v[100:103]
v_cvt_pk_bf16_f32 v134, v136, v137
v_cvt_pk_bf16_f32 v135, v138, v139
v_mfma_f32_16x16x32_bf16 v[92:95], a[48:51], a[52:55], v[92:95]
v_cvt_pk_bf16_f32 v158, v160, v161
v_cvt_pk_bf16_f32 v159, v162, v163
v_mfma_f32_16x16x32_bf16 v[96:99], a[48:51], a[56:59], v[96:99]
v_cvt_pk_bf16_f32 v182, v184, v185
v_cvt_pk_bf16_f32 v183, v186, v187
s_waitcnt lgkmcnt(12)
v_mfma_f32_16x16x32_bf16 v[100:103], a[84:87], v[16:19], v[100:103]
v_cvt_pk_bf16_f32 v206, v208, v209
v_cvt_pk_bf16_f32 v207, v210, v211
s_waitcnt lgkmcnt(10)
v_mfma_f32_16x16x32_bf16 v[92:95], a[60:63], a[64:67], v[92:95]
s_waitcnt lgkmcnt(8)
v_mfma_f32_16x16x32_bf16 v[96:99], a[60:63], a[68:71], v[96:99]
s_nop 1
v_min_u32 v100, -2, v100
v_min_u32 v101, -2, v101
s_waitcnt lgkmcnt(6)
v_mfma_f32_16x16x32_bf16 v[92:95], a[72:75], a[76:79], v[92:95]
v_min_u32 v102, -2, v102
v_min_u32 v103, -2, v103
s_waitcnt lgkmcnt(4)
v_mfma_f32_16x16x32_bf16 v[96:99], a[72:75], a[80:83], v[96:99]
buffer_store_dwordx4 v[100:103], v254, s[4:7], s97 offen sc1
s_waitcnt lgkmcnt(2)
v_mfma_f32_16x16x32_bf16 v[92:95], a[84:87], a[88:91], v[92:95]
s_waitcnt lgkmcnt(0)
v_mfma_f32_16x16x32_bf16 v[96:99], a[84:87], a[92:95], v[96:99]
s_nop 5
v_cvt_pk_bf16_f32 v92, v92, v93
v_cvt_pk_bf16_f32 v93, v94, v95
v_min_u32 v92, -2, v92
v_min_u32 v93, -2, v93
v_cvt_pk_bf16_f32 v94, v96, v97
v_cvt_pk_bf16_f32 v95, v98, v99
v_min_u32 v94, -2, v94
v_min_u32 v95, -2, v95
buffer_store_dwordx4 v[92:95], v1, s[4:7], s96 offen sc1
s_barrier
s_add_u32 m0, s19, 32768
s_add_u32 s44, s84, 0xc00000
buffer_load_dwordx4 v1, s[4:7], s44 offen offset:0 sc1 lds
v_mfma_f32_16x16x32_bf16 v[108:111], a[240:243], v[132:135], 0
v_mfma_f32_16x16x32_bf16 v[172:175], a[240:243], v[156:159], 0
v_mfma_f32_16x16x32_bf16 v[112:115], a[244:247], v[132:135], 0
s_nop 5
v_max3_f32 v236, v108, v109, v110
v_max3_f32 v237, -v108, -v109, -v110
v_mfma_f32_16x16x32_bf16 v[176:179], a[244:247], v[156:159], 0
v_max3_f32 v238, v172, v173, v174
v_max3_f32 v239, -v172, -v173, -v174
v_max3_f32 v236, v236, v111, v112
v_max3_f32 v237, v237, -v111, -v112
v_max3_f32 v236, v236, v113, v114
v_max3_f32 v237, v237, -v113, -v114
s_nop 1
v_max3_f32 v238, v238, v175, v176
v_max3_f32 v239, v239, -v175, -v176
v_max3_f32 v238, v238, v177, v178
v_max3_f32 v239, v239, -v177, -v178
v_max_f32 v236, v236, v115
buffer_load_dwordx4 v1, s[4:7], s44 offen offset:1024 sc1 lds
v_max_f32_e64 v237, v237, -v115
v_max_f32 v238, v238, v179
v_max_f32_e64 v239, v239, -v179
v_permlane32_swap_b32 v236, v237
s_nop 0
v_permlane32_swap_b32 v238, v239
v_mov_b32 v11, 0
buffer_atomic_add v11, v251, s[4:7], s89 offen sc0 sc1
v_max_f32 v236, v236, v237
v_max_f32 v238, v238, v239
v_mov_b32 v244, v236
v_mov_b32 v245, v238
s_nop 0
v_permlane16_swap_b32 v236, v244
v_permlane16_swap_b32 v238, v245
v_max_f32 v236, v236, v244
v_max_f32 v238, v238, v245
v_mov_b32 v244, v236
v_mov_b32 v245, v238
s_nop 0
v_permlane32_swap_b32 v236, v244
v_permlane32_swap_b32 v238, v245
v_mul_f32_e64 v236, -v236, v82
v_mul_f32_e64 v237, -v244, v82
buffer_load_dwordx4 v1, s[4:7], s44 offen offset:2048 sc1 lds
v_mul_f32_e64 v238, -v238, v84
v_mul_f32_e64 v239, -v245, v84
v_pk_fma_f32 v[116:117], v[108:109], v[82:83], v[236:237] op_sel:[0,0,0] op_sel_hi:[1,0,0]
v_pk_fma_f32 v[118:119], v[110:111], v[82:83], v[236:237] op_sel:[0,0,0] op_sel_hi:[1,0,0]
v_pk_fma_f32 v[120:121], v[112:113], v[82:83], v[236:237] op_sel:[0,0,0] op_sel_hi:[1,0,0]
v_pk_fma_f32 v[122:123], v[114:115], v[82:83], v[236:237] op_sel:[0,0,0] op_sel_hi:[1,0,0]
v_pk_fma_f32 v[148:149], v[172:173], v[84:85], v[238:239] op_sel:[0,0,0] op_sel_hi:[1,0,0]
v_pk_fma_f32 v[150:151], v[174:175], v[84:85], v[238:239] op_sel:[0,0,0] op_sel_hi:[1,0,0]
v_pk_fma_f32 v[152:153], v[176:177], v[84:85], v[238:239] op_sel:[0,0,0] op_sel_hi:[1,0,0]
v_pk_fma_f32 v[154:155], v[178:179], v[84:85], v[238:239] op_sel:[0,0,0] op_sel_hi:[1,0,0]
v_pk_fma_f32 v[108:109], v[108:109], v[82:83], v[236:237] op_sel:[0,0,1] op_sel_hi:[1,0,1] neg_lo:[1,0,0] neg_hi:[1,0,0]
v_pk_fma_f32 v[110:111], v[110:111], v[82:83], v[236:237] op_sel:[0,0,1] op_sel_hi:[1,0,1] neg_lo:[1,0,0] neg_hi:[1,0,0]
v_pk_fma_f32 v[112:113], v[112:113], v[82:83], v[236:237] op_sel:[0,0,1] op_sel_hi:[1,0,1] neg_lo:[1,0,0] neg_hi:[1,0,0]
v_pk_fma_f32 v[114:115], v[114:115], v[82:83], v[236:237] op_sel:[0,0,1] op_sel_hi:[1,0,1] neg_lo:[1,0,0] neg_hi:[1,0,0]
v_pk_fma_f32 v[172:173], v[172:173], v[84:85], v[238:239] op_sel:[0,0,1] op_sel_hi:[1,0,1] neg_lo:[1,0,0] neg_hi:[1,0,0]
v_pk_fma_f32 v[174:175], v[174:175], v[84:85], v[238:239] op_sel:[0,0,1] op_sel_hi:[1,0,1] neg_lo:[1,0,0] neg_hi:[1,0,0]
v_pk_fma_f32 v[176:177], v[176:177], v[84:85], v[238:239] op_sel:[0,0,1] op_sel_hi:[1,0,1] neg_lo:[1,0,0] neg_hi:[1,0,0]
v_pk_fma_f32 v[178:179], v[178:179], v[84:85], v[238:239] op_sel:[0,0,1] op_sel_hi:[1,0,1] neg_lo:[1,0,0] neg_hi:[1,0,0]
v_exp_f32 v116, v116
v_exp_f32 v108, v108
v_exp_f32 v117, v117
v_exp_f32 v109, v109
v_exp_f32 v118, v118
v_exp_f32 v110, v110
v_exp_f32 v119, v119
v_exp_f32 v111, v111
v_exp_f32 v120, v120
v_exp_f32 v112, v112
v_exp_f32 v121, v121
v_exp_f32 v113, v113
v_exp_f32 v122, v122
v_exp_f32 v114, v114
v_exp_f32 v123, v123
v_exp_f32 v115, v115
v_exp_f32 v148, v148
v_exp_f32 v172, v172
v_exp_f32 v149, v149
v_exp_f32 v173, v173
v_exp_f32 v150, v150
v_exp_f32 v174, v174
v_exp_f32 v151, v151
v_exp_f32 v175, v175
v_exp_f32 v152, v152
v_exp_f32 v176, v176
v_exp_f32 v153, v153
v_exp_f32 v177, v177
v_exp_f32 v154, v154
v_exp_f32 v178, v178
v_exp_f32 v155, v155
v_exp_f32 v179, v179
buffer_load_dwordx4 v1, s[4:7], s44 offen offset:3072 sc1 lds
v_cvt_pk_bf16_f32 v140, v116, v117
v_cvt_pk_bf16_f32 v141, v118, v119
v_cvt_pk_bf16_f32 v142, v120, v121
v_cvt_pk_bf16_f32 v143, v122, v123
v_cvt_pk_bf16_f32 v144, v108, v109
v_cvt_pk_bf16_f32 v145, v110, v111
v_cvt_pk_bf16_f32 v146, v112, v113
v_cvt_pk_bf16_f32 v147, v114, v115
v_cvt_pk_bf16_f32 v164, v148, v149
v_cvt_pk_bf16_f32 v165, v150, v151
v_cvt_pk_bf16_f32 v166, v152, v153
v_cvt_pk_bf16_f32 v167, v154, v155
v_cvt_pk_bf16_f32 v168, v172, v173
v_cvt_pk_bf16_f32 v169, v174, v175
v_cvt_pk_bf16_f32 v170, v176, v177
v_cvt_pk_bf16_f32 v171, v178, v179
s_waitcnt vmcnt(2)
v_readfirstlane_b32 s38, v11
s_nop 0
s_cmp_ge_u32 s38, 8
s_cbranch_scc1 Lpe_35
s_add_u32 s36, s88, 0x90000
s_mov_b32 s37, 0
Lpoll_34:
v_mov_b32 v11, 0
buffer_atomic_add v11, v251, s[4:7], s36 offen sc0 sc1
s_add_u32 s37, s37, 1
s_waitcnt vmcnt(0)
v_readfirstlane_b32 s38, v11
s_nop 0
s_cmp_ge_u32 s38, 8
s_cbranch_scc1 Lpe_35
s_cmp_lt_u32 s37, 0x100000
s_cbranch_scc1 Lpoll_34
Lpe_35:
buffer_load_dwordx4 v[48:51], v1, s[4:7], s98 offen offset:0 sc1
v_mfma_f32_16x16x32_bf16 v[108:111], a[240:243], v[180:183], 0
v_mfma_f32_16x16x32_bf16 v[220:223], a[240:243], v[204:207], 0
v_mfma_f32_16x16x32_bf16 v[112:115], a[244:247], v[180:183], 0
s_nop 5
v_max3_f32 v240, v108, v109, v110
v_max3_f32 v241, -v108, -v109, -v110
v_mfma_f32_16x16x32_bf16 v[224:227], a[244:247], v[204:207], 0
buffer_load_dwordx4 v[124:127], v248, s[4:7], s100 offen sc1
v_max3_f32 v242, v220, v221, v222
v_max3_f32 v243, -v220, -v221, -v222
v_max3_f32 v240, v240, v111, v112
v_max3_f32 v241, v241, -v111, -v112
v_max3_f32 v240, v240, v113, v114
s_nop 1
v_max3_f32 v242, v242, v223, v224
v_max3_f32 v243, v243, -v223, -v224
v_max3_f32 v241, v241, -v113, -v114
v_max3_f32 v242, v242, v225, v226
v_max3_f32 v243, v243, -v225, -v226
v_max_f32 v240, v240, v115
v_max_f32_e64 v241, v241, -v115
v_max_f32 v242, v242, v227
buffer_load_dwordx4 v[52:55], v1, s[4:7], s98 offen offset:1024 sc1
v_max_f32_e64 v243, v243, -v227
v_permlane32_swap_b32 v240, v241
s_nop 0
v_permlane32_swap_b32 v242, v243
v_max_f32 v240, v240, v241
v_max_f32 v242, v242, v243
v_mov_b32 v246, v240
v_mov_b32 v247, v242
s_nop 0
v_permlane16_swap_b32 v240, v246
v_permlane16_swap_b32 v242, v247
buffer_load_dwordx4 v[56:59], v1, s[4:7], s98 offen offset:2048 sc1
v_max_f32 v240, v240, v246
v_max_f32 v242, v242, v247
v_mov_b32 v246, v240
v_mov_b32 v247, v242
s_nop 0
v_permlane32_swap_b32 v240, v246
v_permlane32_swap_b32 v242, v247
v_mul_f32_e64 v240, -v240, v86
v_mul_f32_e64 v241, -v246, v86
v_mul_f32_e64 v242, -v242, v88
v_mul_f32_e64 v243, -v247, v88
buffer_load_dwordx4 v[60:63], v1, s[4:7], s98 offen offset:3072 sc1
v_pk_fma_f32 v[116:117], v[108:109], v[86:87], v[240:241] op_sel:[0,0,0] op_sel_hi:[1,0,0]
v_pk_fma_f32 v[118:119], v[110:111], v[86:87], v[240:241] op_sel:[0,0,0] op_sel_hi:[1,0,0]
v_pk_fma_f32 v[120:121], v[112:113], v[86:87], v[240:241] op_sel:[0,0,0] op_sel_hi:[1,0,0]
v_pk_fma_f32 v[122:123], v[114:115], v[86:87], v[240:241] op_sel:[0,0,0] op_sel_hi:[1,0,0]
v_pk_fma_f32 v[196:197], v[220:221], v[88:89], v[242:243] op_sel:[0,0,0] op_sel_hi:[1,0,0]
v_pk_fma_f32 v[198:199], v[222:223], v[88:89], v[242:243] op_sel:[0,0,0] op_sel_hi:[1,0,0]
v_pk_fma_f32 v[200:201], v[224:225], v[88:89], v[242:243] op_sel:[0,0,0] op_sel_hi:[1,0,0]
v_pk_fma_f32 v[202:203], v[226:227], v[88:89], v[242:243] op_sel:[0,0,0] op_sel_hi:[1,0,0]
v_pk_fma_f32 v[108:109], v[108:109], v[86:87], v[240:241] op_sel:[0,0,1] op_sel_hi:[1,0,1] neg_lo:[1,0,0] neg_hi:[1,0,0]
v_pk_fma_f32 v[110:111], v[110:111], v[86:87], v[240:241] op_sel:[0,0,1] op_sel_hi:[1,0,1] neg_lo:[1,0,0] neg_hi:[1,0,0]
v_pk_fma_f32 v[112:113], v[112:113], v[86:87], v[240:241] op_sel:[0,0,1] op_sel_hi:[1,0,1] neg_lo:[1,0,0] neg_hi:[1,0,0]
v_pk_fma_f32 v[114:115], v[114:115], v[86:87], v[240:241] op_sel:[0,0,1] op_sel_hi:[1,0,1] neg_lo:[1,0,0] neg_hi:[1,0,0]
v_pk_fma_f32 v[220:221], v[220:221], v[88:89], v[242:243] op_sel:[0,0,1] op_sel_hi:[1,0,1] neg_lo:[1,0,0] neg_hi:[1,0,0]
buffer_load_dwordx4 v[64:67], v1, s[4:7], s99 offen offset:0 sc1
v_pk_fma_f32 v[222:223], v[222:223], v[88:89], v[242:243] op_sel:[0,0,1] op_sel_hi:[1,0,1] neg_lo:[1,0,0] neg_hi:[1,0,0]
v_pk_fma_f32 v[224:225], v[224:225], v[88:89], v[242:243] op_sel:[0,0,1] op_sel_hi:[1,0,1] neg_lo:[1,0,0] neg_hi:[1,0,0]
v_pk_fma_f32 v[226:227], v[226:227], v[88:89], v[242:243] op_sel:[0,0,1] op_sel_hi:[1,0,1] neg_lo:[1,0,0] neg_hi:[1,0,0]
v_exp_f32 v116, v116
v_exp_f32 v108, v108
v_exp_f32 v117, v117
v_exp_f32 v109, v109
v_exp_f32 v118, v118
buffer_load_dwordx4 v[68:71], v1, s[4:7], s99 offen offset:1024 sc1
v_exp_f32 v110, v110
v_exp_f32 v119, v119
v_exp_f32 v111, v111
v_exp_f32 v120, v120
v_exp_f32 v112, v112
v_exp_f32 v121, v121
v_exp_f32 v113, v113
buffer_load_dwordx4 v[100:103], v1, s[4:7], s99 offen offset:2048 sc1
v_exp_f32 v122, v122
v_exp_f32 v114, v114
v_exp_f32 v123, v123
v_exp_f32 v115, v115
v_exp_f32 v196, v196
v_exp_f32 v220, v220
v_exp_f32 v197, v197
buffer_load_dwordx4 v[104:107], v1, s[4:7], s99 offen offset:3072 sc1
v_exp_f32 v221, v221
v_exp_f32 v198, v198
v_exp_f32 v222, v222
v_exp_f32 v199, v199
v_exp_f32 v223, v223
v_exp_f32 v200, v200
v_exp_f32 v224, v224
v_exp_f32 v201, v201
v_exp_f32 v225, v225
v_exp_f32 v202, v202
v_exp_f32 v226, v226
v_exp_f32 v203, v203
v_exp_f32 v227, v227
v_cvt_pk_bf16_f32 v188, v116, v117
v_cvt_pk_bf16_f32 v189, v118, v119
v_cvt_pk_bf16_f32 v190, v120, v121
v_cvt_pk_bf16_f32 v191, v122, v123
v_cvt_pk_bf16_f32 v192, v108, v109
v_cvt_pk_bf16_f32 v193, v110, v111
v_cvt_pk_bf16_f32 v194, v112, v113
v_cvt_pk_bf16_f32 v195, v114, v115
v_cvt_pk_bf16_f32 v212, v196, v197
v_cvt_pk_bf16_f32 v213, v198, v199
v_cvt_pk_bf16_f32 v214, v200, v201
v_cvt_pk_bf16_f32 v215, v202, v203
v_cvt_pk_bf16_f32 v216, v220, v221
v_cvt_pk_bf16_f32 v217, v222, v223
v_cvt_pk_bf16_f32 v218, v224, v225
v_cvt_pk_bf16_f32 v219, v226, v227
s_waitcnt vmcnt(8)
v_lshlrev_b32 v92, 16, v48
v_and_b32 v93, 0xffff0000, v48
v_lshlrev_b32 v94, 16, v49
v_and_b32 v95, 0xffff0000, v49
v_lshlrev_b32 v96, 16, v50
v_and_b32 v97, 0xffff0000, v50
v_lshlrev_b32 v98, 16, v51
v_and_b32 v99, 0xffff0000, v51
s_waitcnt vmcnt(7)
v_add_f32_dpp v128, v124, v124 row_ror:4 row_mask:0xf bank_mask:0xf
v_add_f32_dpp v129, v125, v125 row_ror:4 row_mask:0xf bank_mask:0xf
v_add_f32_dpp v130, v126, v126 row_ror:4 row_mask:0xf bank_mask:0xf
v_add_f32_dpp v131, v127, v127 row_ror:4 row_mask:0xf bank_mask:0xf
v_add_f32_dpp v128, v128, v128 row_ror:2 row_mask:0xf bank_mask:0xf
v_add_f32_dpp v129, v129, v129 row_ror:2 row_mask:0xf bank_mask:0xf
v_add_f32_dpp v130, v130, v130 row_ror:2 row_mask:0xf bank_mask:0xf
v_add_f32_dpp v131, v131, v131 row_ror:2 row_mask:0xf bank_mask:0xf
v_add_f32_dpp v128, v128, v128 row_ror:1 row_mask:0xf bank_mask:0xf
v_add_f32_dpp v129, v129, v129 row_ror:1 row_mask:0xf bank_mask:0xf
v_add_f32_dpp v130, v130, v130 row_ror:1 row_mask:0xf bank_mask:0xf
v_add_f32_dpp v131, v131, v131 row_ror:1 row_mask:0xf bank_mask:0xf
v_fma_f32 v135, v129, v130, v131
s_waitcnt vmcnt(6)
v_dot2c_f32_bf16 v92, v52, v249
v_dot2c_f32_bf16 v93, v52, v250
v_dot2c_f32_bf16 v94, v53, v249
v_dot2c_f32_bf16 v95, v53, v250
v_dot2c_f32_bf16 v96, v54, v249
v_dot2c_f32_bf16 v97, v54, v250
v_dot2c_f32_bf16 v98, v55, v249
v_dot2c_f32_bf16 v99, v55, v250
s_waitcnt vmcnt(5)
v_dot2c_f32_bf16 v92, v56, v249
v_dot2c_f32_bf16 v93, v56, v250
v_dot2c_f32_bf16 v94, v57, v249
v_dot2c_f32_bf16 v95, v57, v250
v_dot2c_f32_bf16 v96, v58, v249
v_dot2c_f32_bf16 v97, v58, v250
v_dot2c_f32_bf16 v98, v59, v249
v_dot2c_f32_bf16 v99, v59, v250
s_waitcnt vmcnt(4)
v_dot2c_f32_bf16 v92, v60, v249
v_dot2c_f32_bf16 v93, v60, v250
v_dot2c_f32_bf16 v94, v61, v249
v_dot2c_f32_bf16 v95, v61, v250
v_dot2c_f32_bf16 v96, v62, v249
v_dot2c_f32_bf16 v97, v62, v250
v_dot2c_f32_bf16 v98, v63, v249
v_dot2c_f32_bf16 v99, v63, v250
s_waitcnt vmcnt(3)
v_dot2c_f32_bf16 v92, v64, v249
v_dot2c_f32_bf16 v93, v64, v250
v_dot2c_f32_bf16 v94, v65, v249
v_dot2c_f32_bf16 v95, v65, v250
v_dot2c_f32_bf16 v96, v66, v249
v_dot2c_f32_bf16 v97, v66, v250
v_dot2c_f32_bf16 v98, v67, v249
v_dot2c_f32_bf16 v99, v67, v250
s_waitcnt vmcnt(2)
v_dot2c_f32_bf16 v92, v68, v249
v_dot2c_f32_bf16 v93, v68, v250
v_dot2c_f32_bf16 v94, v69, v249
v_dot2c_f32_bf16 v95, v69, v250
v_dot2c_f32_bf16 v96, v70, v249
v_dot2c_f32_bf16 v97, v70, v250
v_dot2c_f32_bf16 v98, v71, v249
v_dot2c_f32_bf16 v99, v71, v250
s_waitcnt vmcnt(1)
v_dot2c_f32_bf16 v92, v100, v249
v_dot2c_f32_bf16 v93, v100, v250
v_dot2c_f32_bf16 v94, v101, v249
v_dot2c_f32_bf16 v95, v101, v250
v_dot2c_f32_bf16 v96, v102, v249
v_dot2c_f32_bf16 v97, v102, v250
v_dot2c_f32_bf16 v98, v103, v249
v_dot2c_f32_bf16 v99, v103, v250
s_waitcnt vmcnt(0)
v_dot2c_f32_bf16 v92, v104, v249
v_dot2c_f32_bf16 v93, v104, v250
v_dot2c_f32_bf16 v94, v105, v249
v_dot2c_f32_bf16 v95, v105, v250
v_dot2c_f32_bf16 v96, v106, v249
v_dot2c_f32_bf16 v97, v106, v250
v_dot2c_f32_bf16 v98, v107, v249
v_dot2c_f32_bf16 v99, v107, v250
v_fma_f32 v132, v92, v93, v94
v_fma_f32 v133, v95, v96, v97
s_nop 0
v_fma_f32 v134, v98, v99, v128
v_fma_f32 v132, v132, v133, v134
v_cmp_u_f32 vcc, v132, v135
s_cbranch_vccnz L_kvredo3
L_kvback3:
v_cvt_pk_bf16_f32 v128, v128, v129
v_cvt_pk_bf16_f32 v129, v130, v131
v_cvt_pk_bf16_f32 v92, v92, v93
v_cndmask_b32 v128, 0, v128, s[56:57]
v_cndmask_b32 v129, 0, v129, s[56:57]
v_cvt_pk_bf16_f32 v93, v94, v95
v_cvt_pk_bf16_f32 v94, v96, v97
v_cvt_pk_bf16_f32 v95, v98, v99
v_cndmask_b32 v128, v128, v16, s[58:59]
v_cndmask_b32 v129, v129, v16, s[58:59]
ds_write_b64 v252, v[92:93] offset:0
ds_write_b64 v252, v[94:95] offset:1024
ds_write_b64 v252, v[128:129] offset:2048
s_waitcnt lgkmcnt(0)
s_barrier
ds_read_b128 a[8:11], v1 offset:2048
ds_read_b128 a[20:23], v1 offset:5120
ds_read_b128 a[0:3], v1 offset:0
ds_read_b128 a[12:15], v1 offset:3072
ds_read_b128 a[4:7], v1 offset:1024
ds_read_b128 a[16:19], v1 offset:4096
s_waitcnt lgkmcnt(5)
v_mfma_f32_16x16x32_bf16 v[92:95], a[8:11], v[140:143], 0
s_waitcnt lgkmcnt(4)
v_mfma_f32_16x16x32_bf16 v[96:99], a[20:23], v[144:147], 0
s_waitcnt lgkmcnt(3)
v_mfma_f32_16x16x32_bf16 v[132:135], a[0:3], v[140:143], 0
s_nop 3
v_rcp_f32 v94, v93
s_waitcnt lgkmcnt(2)
v_mfma_f32_16x16x32_bf16 v[148:151], a[12:15], v[144:147], 0
v_rcp_f32 v95, v97
v_mul_f32 v92, v92, v94
v_fmac_f32 v92, v96, v95
v_mfma_f32_16x16x32_bf16 v[100:103], a[8:11], v[164:167], 0
v_add_f32 v92, 0x358637bd, v92
v_rcp_f32 v92, v92
s_waitcnt lgkmcnt(1)
v_mfma_f32_16x16x32_bf16 v[136:139], a[4:7], v[140:143], 0
v_mul_f32 v94, v94, v92
v_mul_f32 v95, v95, v92
v_mfma_f32_16x16x32_bf16 v[104:107], a[20:23], v[168:171], 0
v_mul_f32 v132, v132, v94
v_mul_f32 v133, v133, v94
s_waitcnt lgkmcnt(0)
v_mfma_f32_16x16x32_bf16 v[152:155], a[16:19], v[144:147], 0
v_mul_f32 v134, v134, v94
v_mul_f32 v135, v135, v94
v_fmac_f32 v132, v148, v95
v_fmac_f32 v133, v149, v95
v_rcp_f32 v102, v101
v_mul_f32 v136, v136, v94
v_mul_f32 v137, v137, v94
v_mul_f32 v138, v138, v94
v_mul_f32 v139, v139, v94
v_fmac_f32 v134, v150, v95
v_fmac_f32 v135, v151, v95
v_cvt_pk_bf16_f32 v132, v132, v133
v_rcp_f32 v103, v105
v_fmac_f32 v136, v152, v95
v_fmac_f32 v137, v153, v95
v_fmac_f32 v138, v154, v95
v_fmac_f32 v139, v155, v95
v_cvt_pk_bf16_f32 v133, v134, v135
v_cvt_pk_bf16_f32 v134, v136, v137
v_cvt_pk_bf16_f32 v135, v138, v139
v_mul_f32 v100, v100, v102
v_mfma_f32_16x16x32_bf16 v[156:159], a[0:3], v[164:167], 0
buffer_store_dwordx4 v[132:135], v2, s[4:7], s72 offen offset:0 sc1
v_fmac_f32 v100, v104, v103
v_mfma_f32_16x16x32_bf16 v[172:175], a[12:15], v[168:171], 0
v_add_f32 v100, 0x358637bd, v100
v_rcp_f32 v100, v100
v_mfma_f32_16x16x32_bf16 v[108:111], a[8:11], v[188:191], 0
v_mul_f32 v102, v102, v100
v_mul_f32 v103, v103, v100
v_mfma_f32_16x16x32_bf16 v[160:163], a[4:7], v[164:167], 0
v_mul_f32 v156, v156, v102
v_mul_f32 v157, v157, v102
v_mfma_f32_16x16x32_bf16 v[112:115], a[20:23], v[192:195], 0
v_mul_f32 v158, v158, v102
v_mul_f32 v159, v159, v102
v_mfma_f32_16x16x32_bf16 v[176:179], a[16:19], v[168:171], 0
v_fmac_f32 v156, v172, v103
v_fmac_f32 v157, v173, v103
v_rcp_f32 v110, v109
v_mul_f32 v160, v160, v102
v_mul_f32 v161, v161, v102
v_mul_f32 v162, v162, v102
v_mul_f32 v163, v163, v102
v_fmac_f32 v158, v174, v103
v_fmac_f32 v159, v175, v103
v_cvt_pk_bf16_f32 v156, v156, v157
v_rcp_f32 v111, v113
v_fmac_f32 v160, v176, v103
v_fmac_f32 v161, v177, v103
v_fmac_f32 v162, v178, v103
v_fmac_f32 v163, v179, v103
v_cvt_pk_bf16_f32 v157, v158, v159
v_cvt_pk_bf16_f32 v158, v160, v161
v_cvt_pk_bf16_f32 v159, v162, v163
v_mul_f32 v108, v108, v110
v_mfma_f32_16x16x32_bf16 v[180:183], a[0:3], v[188:191], 0
buffer_store_dwordx4 v[156:159], v2, s[4:7], s72 offen offset:1024 sc1
v_fmac_f32 v108, v112, v111
v_mfma_f32_16x16x32_bf16 v[196:199], a[12:15], v[192:195], 0
v_add_f32 v108, 0x358637bd, v108
v_rcp_f32 v108, v108
v_mfma_f32_16x16x32_bf16 v[116:119], a[8:11], v[212:215], 0
v_mul_f32 v110, v110, v108
v_mul_f32 v111, v111, v108
v_mfma_f32_16x16x32_bf16 v[184:187], a[4:7], v[188:191], 0
v_mul_f32 v180, v180, v110
v_mul_f32 v181, v181, v110
v_mfma_f32_16x16x32_bf16 v[120:123], a[20:23], v[216:219], 0
v_mul_f32 v182, v182, v110
v_mul_f32 v183, v183, v110
v_mfma_f32_16x16x32_bf16 v[200:203], a[16:19], v[192:195], 0
v_fmac_f32 v180, v196, v111
v_fmac_f32 v181, v197, v111
v_rcp_f32 v118, v117
v_mul_f32 v184, v184, v110
v_mul_f32 v185, v185, v110
v_mul_f32 v186, v186, v110
v_mul_f32 v187, v187, v110
v_fmac_f32 v182, v198, v111
v_fmac_f32 v183, v199, v111
v_cvt_pk_bf16_f32 v180, v180, v181
v_rcp_f32 v119, v121
buffer_atomic_add v12, v10, s[4:7], s74 offen sc1
v_fmac_f32 v184, v200, v111
v_fmac_f32 v185, v201, v111
v_fmac_f32 v186, v202, v111
v_fmac_f32 v187, v203, v111
v_cvt_pk_bf16_f32 v181, v182, v183
v_cvt_pk_bf16_f32 v182, v184, v185
v_cvt_pk_bf16_f32 v183, v186, v187
v_mul_f32 v116, v116, v118
v_mfma_f32_16x16x32_bf16 v[204:207], a[0:3], v[212:215], 0
buffer_store_dwordx4 v[180:183], v2, s[4:7], s72 offen offset:2048 sc1
v_fmac_f32 v116, v120, v119
v_mfma_f32_16x16x32_bf16 v[220:223], a[12:15], v[216:219], 0
v_add_f32 v116, 0x358637bd, v116
v_rcp_f32 v116, v116
v_mfma_f32_16x16x32_bf16 v[208:211], a[4:7], v[212:215], 0
v_mul_f32 v118, v118, v116
v_mul_f32 v119, v119, v116
v_mfma_f32_16x16x32_bf16 v[224:227], a[16:19], v[216:219], 0
v_mul_f32 v204, v204, v118
v_mul_f32 v205, v205, v118
v_mul_f32 v206, v206, v118
v_mul_f32 v207, v207, v118
v_fmac_f32 v204, v220, v119
v_fmac_f32 v205, v221, v119
v_mul_f32 v208, v208, v118
v_mul_f32 v209, v209, v118
v_mul_f32 v210, v210, v118
v_mul_f32 v211, v211, v118
v_fmac_f32 v206, v222, v119
v_fmac_f32 v207, v223, v119
v_cvt_pk_bf16_f32 v204, v204, v205
v_fmac_f32 v208, v224, v119
v_fmac_f32 v209, v225, v119
v_fmac_f32 v210, v226, v119
v_fmac_f32 v211, v227, v119
v_cvt_pk_bf16_f32 v205, v206, v207
v_cvt_pk_bf16_f32 v206, v208, v209
v_cvt_pk_bf16_f32 v207, v210, v211
L_stub19:
s_cbranch_execz L_wret6
buffer_store_dwordx4 v[204:207], v2, s[4:7], s72 offen offset:3072 sc1
s_add_u32 s92, s71, 0x30000
s_add_u32 s36, s66, 0x30080
s_add_u32 s40, s4, 0x2600000
s_addc_u32 s41, s5, 0
v_add_u32 v5, 32768, v1
v_add_u32 v6, 98304, v1
s_cmp_eq_u32 s3, 0
s_cselect_b32 s35, 8, 0
s_lshl_b32 s35, s35, 12
v_lshlrev_b32 v132, 16, v32
v_and_b32 v133, 0xffff0000, v32
v_lshlrev_b32 v134, 16, v33
v_and_b32 v135, 0xffff0000, v33
v_lshlrev_b32 v136, 16, v34
v_and_b32 v137, 0xffff0000, v34
v_lshlrev_b32 v138, 16, v35
v_and_b32 v139, 0xffff0000, v35
v_lshlrev_b32 v140, 16, v36
v_and_b32 v141, 0xffff0000, v36
v_lshlrev_b32 v142, 16, v37
v_and_b32 v143, 0xffff0000, v37
v_lshlrev_b32 v144, 16, v38
v_and_b32 v145, 0xffff0000, v38
v_lshlrev_b32 v146, 16, v39
v_and_b32 v147, 0xffff0000, v39
v_lshlrev_b32 v148, 16, v40
v_and_b32 v149, 0xffff0000, v40
v_lshlrev_b32 v150, 16, v41
v_and_b32 v151, 0xffff0000, v41
v_lshlrev_b32 v152, 16, v42
v_and_b32 v153, 0xffff0000, v42
v_lshlrev_b32 v154, 16, v43
v_and_b32 v155, 0xffff0000, v43
v_lshlrev_b32 v156, 16, v44
v_and_b32 v157, 0xffff0000, v44
v_lshlrev_b32 v158, 16, v45
v_and_b32 v159, 0xffff0000, v45
v_lshlrev_b32 v160, 16, v46
v_and_b32 v161, 0xffff0000, v46
v_lshlrev_b32 v162, 16, v47
v_and_b32 v163, 0xffff0000, v47
s_mov_b32 s95, -1
s_mov_b64 exec, 0
s_cmp_eq_u32 s28, 3
s_cbranch_scc1 L_stub20
s_cmp_eq_u32 s28, 2
s_cbranch_scc1 L_wret7
L_wret7:
s_mov_b64 exec, -1
s_cmp_lg_u32 s28, 0
s_cbranch_scc1 Lpe_37
s_add_u32 s36, s66, 0x30080
s_mov_b32 s37, 0
Lpoll_36:
v_mov_b32 v11, 0
buffer_atomic_add v11, v251, s[4:7], s36 offen sc0 sc1
s_add_u32 s37, s37, 1
s_waitcnt vmcnt(0)
v_readfirstlane_b32 s38, v11
s_nop 0
s_cmp_ge_u32 s38, 32
s_cbranch_scc1 Lpe_37
s_cmp_lt_u32 s37, 0x100000
s_cbranch_scc1 Lpoll_36
Lpe_37:
s_waitcnt vmcnt(0)
s_barrier
L_k2go3:
buffer_load_dwordx4 a[0:3], v4, s[40:43], s35 offen offset:0 sc1
buffer_load_dwordx4 a[4:7], v4, s[40:43], s35 offen offset:1024 sc1
s_cmp_eq_u32 s3, 1
s_cselect_b32 s35, 9, 1
s_lshl_b32 s35, s35, 12
buffer_load_dwordx4 a[8:11], v4, s[40:43], s35 offen offset:0 sc1
buffer_load_dwordx4 a[12:15], v4, s[40:43], s35 offen offset:1024 sc1
s_cmp_eq_u32 s3, 2
s_cselect_b32 s35, 10, 2
s_lshl_b32 s35, s35, 12
buffer_load_dwordx4 a[16:19], v4, s[40:43], s35 offen offset:0 sc1
buffer_load_dwordx4 a[20:23], v4, s[40:43], s35 offen offset:1024 sc1
s_cmp_eq_u32 s3, 3
s_cselect_b32 s35, 11, 3
s_lshl_b32 s35, s35, 12
buffer_load_dwordx4 a[24:27], v4, s[40:43], s35 offen offset:0 sc1
buffer_load_dwordx4 a[28:31], v4, s[40:43], s35 offen offset:1024 sc1
s_cmp_eq_u32 s3, 4
s_cselect_b32 s35, 12, 4
s_lshl_b32 s35, s35, 12
buffer_load_dwordx4 a[32:35], v4, s[40:43], s35 offen offset:0 sc1
buffer_load_dwordx4 a[36:39], v4, s[40:43], s35 offen offset:1024 sc1
s_cmp_eq_u32 s3, 5
s_cselect_b32 s35, 13, 5
s_lshl_b32 s35, s35, 12
ds_read_b128 a[96:99], v5 offset:0
ds_read_b128 a[100:103], v5 offset:1024
ds_read_b128 a[104:107], v5 offset:2048
ds_read_b128 a[108:111], v5 offset:3072
ds_read_b128 a[112:115], v5 offset:4096
ds_read_b128 a[116:119], v5 offset:5120
ds_read_b128 a[120:123], v5 offset:6144
ds_read_b128 a[124:127], v5 offset:7168
s_waitcnt vmcnt(8) lgkmcnt(4)
v_mfma_f32_16x16x32_bf16 v[132:135], a[96:99], a[0:3], v[132:135]
ds_read_b128 a[128:131], v5 offset:8192
v_mfma_f32_16x16x32_bf16 v[148:151], a[96:99], a[4:7], v[148:151]
ds_read_b128 a[132:135], v5 offset:9216
v_mfma_f32_16x16x32_bf16 v[152:155], a[100:103], a[4:7], v[152:155]
buffer_load_dwordx4 a[40:43], v4, s[40:43], s35 offen offset:0 sc1
v_mfma_f32_16x16x32_bf16 v[136:139], a[100:103], a[0:3], v[136:139]
ds_read_b128 a[136:139], v5 offset:10240
v_mfma_f32_16x16x32_bf16 v[140:143], a[104:107], a[0:3], v[140:143]
ds_read_b128 a[140:143], v5 offset:11264
v_mfma_f32_16x16x32_bf16 v[156:159], a[104:107], a[4:7], v[156:159]
v_mfma_f32_16x16x32_bf16 v[160:163], a[108:111], a[4:7], v[160:163]
buffer_load_dwordx4 a[44:47], v4, s[40:43], s35 offen offset:1024 sc1
v_mfma_f32_16x16x32_bf16 v[144:147], a[108:111], a[0:3], v[144:147]
s_waitcnt vmcnt(8) lgkmcnt(4)
v_mfma_f32_16x16x32_bf16 v[132:135], a[112:115], a[8:11], v[132:135]
s_cmp_eq_u32 s3, 6
s_cselect_b32 s35, 14, 6
s_lshl_b32 s35, s35, 12
v_mfma_f32_16x16x32_bf16 v[148:151], a[112:115], a[12:15], v[148:151]
ds_read_b128 a[96:99], v5 offset:12288
v_mfma_f32_16x16x32_bf16 v[152:155], a[116:119], a[12:15], v[152:155]
buffer_load_dwordx4 a[0:3], v4, s[40:43], s35 offen offset:0 sc1
v_mfma_f32_16x16x32_bf16 v[136:139], a[116:119], a[8:11], v[136:139]
ds_read_b128 a[100:103], v5 offset:13312
v_mfma_f32_16x16x32_bf16 v[140:143], a[120:123], a[8:11], v[140:143]
ds_read_b128 a[104:107], v5 offset:14336
v_mfma_f32_16x16x32_bf16 v[156:159], a[120:123], a[12:15], v[156:159]
ds_read_b128 a[108:111], v5 offset:15360
v_mfma_f32_16x16x32_bf16 v[160:163], a[124:127], a[12:15], v[160:163]
buffer_load_dwordx4 a[4:7], v4, s[40:43], s35 offen offset:1024 sc1
v_mfma_f32_16x16x32_bf16 v[144:147], a[124:127], a[8:11], v[144:147]
s_waitcnt vmcnt(8) lgkmcnt(4)
v_mfma_f32_16x16x32_bf16 v[132:135], a[128:131], a[16:19], v[132:135]
s_cmp_eq_u32 s3, 7
s_cselect_b32 s35, 15, 7
s_lshl_b32 s35, s35, 12
v_mfma_f32_16x16x32_bf16 v[148:151], a[128:131], a[20:23], v[148:151]
ds_read_b128 a[112:115], v5 offset:16384
v_mfma_f32_16x16x32_bf16 v[152:155], a[132:135], a[20:23], v[152:155]
buffer_load_dwordx4 a[8:11], v4, s[40:43], s35 offen offset:0 sc1
v_mfma_f32_16x16x32_bf16 v[136:139], a[132:135], a[16:19], v[136:139]
ds_read_b128 a[116:119], v5 offset:17408
v_mfma_f32_16x16x32_bf16 v[140:143], a[136:139], a[16:19], v[140:143]
ds_read_b128 a[120:123], v5 offset:18432
v_mfma_f32_16x16x32_bf16 v[156:159], a[136:139], a[20:23], v[156:159]
ds_read_b128 a[124:127], v5 offset:19456
v_mfma_f32_16x16x32_bf16 v[160:163], a[140:143], a[20:23], v[160:163]
buffer_load_dwordx4 a[12:15], v4, s[40:43], s35 offen offset:1024 sc1
v_mfma_f32_16x16x32_bf16 v[144:147], a[140:143], a[16:19], v[144:147]
s_waitcnt vmcnt(8) lgkmcnt(4)
v_mfma_f32_16x16x32_bf16 v[132:135], a[96:99], a[24:27], v[132:135]
s_cmp_eq_u32 s3, 0
s_cselect_b32 s35, 16, 8
s_lshl_b32 s35, s35, 12
v_mfma_f32_16x16x32_bf16 v[148:151], a[96:99], a[28:31], v[148:151]
ds_read_b128 a[128:131], v5 offset:20480
v_mfma_f32_16x16x32_bf16 v[152:155], a[100:103], a[28:31], v[152:155]
buffer_load_dwordx4 a[16:19], v4, s[40:43], s35 offen offset:0 sc1
v_mfma_f32_16x16x32_bf16 v[136:139], a[100:103], a[24:27], v[136:139]
ds_read_b128 a[132:135], v5 offset:21504
v_mfma_f32_16x16x32_bf16 v[140:143], a[104:107], a[24:27], v[140:143]
ds_read_b128 a[136:139], v5 offset:22528
v_mfma_f32_16x16x32_bf16 v[156:159], a[104:107], a[28:31], v[156:159]
ds_read_b128 a[140:143], v5 offset:23552
v_mfma_f32_16x16x32_bf16 v[160:163], a[108:111], a[28:31], v[160:163]
buffer_load_dwordx4 a[20:23], v4, s[40:43], s35 offen offset:1024 sc1
v_mfma_f32_16x16x32_bf16 v[144:147], a[108:111], a[24:27], v[144:147]
s_waitcnt vmcnt(8) lgkmcnt(4)
v_mfma_f32_16x16x32_bf16 v[132:135], a[112:115], a[32:35], v[132:135]
s_cmp_eq_u32 s3, 1
s_cselect_b32 s35, 17, 9
s_lshl_b32 s35, s35, 12
v_mfma_f32_16x16x32_bf16 v[148:151], a[112:115], a[36:39], v[148:151]
ds_read_b128 a[96:99], v5 offset:24576
v_mfma_f32_16x16x32_bf16 v[152:155], a[116:119], a[36:39], v[152:155]
buffer_load_dwordx4 a[24:27], v4, s[40:43], s35 offen offset:0 sc1
v_mfma_f32_16x16x32_bf16 v[136:139], a[116:119], a[32:35], v[136:139]
ds_read_b128 a[100:103], v5 offset:25600
v_mfma_f32_16x16x32_bf16 v[140:143], a[120:123], a[32:35], v[140:143]
ds_read_b128 a[104:107], v5 offset:26624
v_mfma_f32_16x16x32_bf16 v[156:159], a[120:123], a[36:39], v[156:159]
ds_read_b128 a[108:111], v5 offset:27648
v_mfma_f32_16x16x32_bf16 v[160:163], a[124:127], a[36:39], v[160:163]
buffer_load_dwordx4 a[28:31], v4, s[40:43], s35 offen offset:1024 sc1
v_mfma_f32_16x16x32_bf16 v[144:147], a[124:127], a[32:35], v[144:147]
s_waitcnt vmcnt(8) lgkmcnt(4)
v_mfma_f32_16x16x32_bf16 v[132:135], a[128:131], a[40:43], v[132:135]
s_cmp_eq_u32 s3, 2
s_cselect_b32 s35, 18, 10
s_lshl_b32 s35, s35, 12
v_mfma_f32_16x16x32_bf16 v[148:151], a[128:131], a[44:47], v[148:151]
ds_read_b128 a[112:115], v5 offset:28672
v_mfma_f32_16x16x32_bf16 v[152:155], a[132:135], a[44:47], v[152:155]
buffer_load_dwordx4 a[32:35], v4, s[40:43], s35 offen offset:0 sc1
v_mfma_f32_16x16x32_bf16 v[136:139], a[132:135], a[40:43], v[136:139]
ds_read_b128 a[116:119], v5 offset:29696
v_mfma_f32_16x16x32_bf16 v[140:143], a[136:139], a[40:43], v[140:143]
ds_read_b128 a[120:123], v5 offset:30720
v_mfma_f32_16x16x32_bf16 v[156:159], a[136:139], a[44:47], v[156:159]
ds_read_b128 a[124:127], v5 offset:31744
v_mfma_f32_16x16x32_bf16 v[160:163], a[140:143], a[44:47], v[160:163]
buffer_load_dwordx4 a[36:39], v4, s[40:43], s35 offen offset:1024 sc1
v_mfma_f32_16x16x32_bf16 v[144:147], a[140:143], a[40:43], v[144:147]
s_waitcnt vmcnt(8) lgkmcnt(4)
v_mfma_f32_16x16x32_bf16 v[132:135], a[96:99], a[0:3], v[132:135]
s_cmp_eq_u32 s3, 3
s_cselect_b32 s35, 19, 11
s_lshl_b32 s35, s35, 12
v_mfma_f32_16x16x32_bf16 v[148:151], a[96:99], a[4:7], v[148:151]
ds_read_b128 a[128:131], v5 offset:32768
v_mfma_f32_16x16x32_bf16 v[152:155], a[100:103], a[4:7], v[152:155]
buffer_load_dwordx4 a[40:43], v4, s[40:43], s35 offen offset:0 sc1
v_mfma_f32_16x16x32_bf16 v[136:139], a[100:103], a[0:3], v[136:139]
ds_read_b128 a[132:135], v5 offset:33792
v_mfma_f32_16x16x32_bf16 v[140:143], a[104:107], a[0:3], v[140:143]
ds_read_b128 a[136:139], v5 offset:34816
v_mfma_f32_16x16x32_bf16 v[156:159], a[104:107], a[4:7], v[156:159]
ds_read_b128 a[140:143], v5 offset:35840
v_mfma_f32_16x16x32_bf16 v[160:163], a[108:111], a[4:7], v[160:163]
buffer_load_dwordx4 a[44:47], v4, s[40:43], s35 offen offset:1024 sc1
v_mfma_f32_16x16x32_bf16 v[144:147], a[108:111], a[0:3], v[144:147]
s_waitcnt vmcnt(8) lgkmcnt(4)
v_mfma_f32_16x16x32_bf16 v[132:135], a[112:115], a[8:11], v[132:135]
s_cmp_eq_u32 s3, 4
s_cselect_b32 s35, 20, 12
s_lshl_b32 s35, s35, 12
v_mfma_f32_16x16x32_bf16 v[148:151], a[112:115], a[12:15], v[148:151]
ds_read_b128 a[96:99], v5 offset:36864
v_mfma_f32_16x16x32_bf16 v[152:155], a[116:119], a[12:15], v[152:155]
buffer_load_dwordx4 a[0:3], v4, s[40:43], s35 offen offset:0 sc1
v_mfma_f32_16x16x32_bf16 v[136:139], a[116:119], a[8:11], v[136:139]
ds_read_b128 a[100:103], v5 offset:37888
v_mfma_f32_16x16x32_bf16 v[140:143], a[120:123], a[8:11], v[140:143]
ds_read_b128 a[104:107], v5 offset:38912
v_mfma_f32_16x16x32_bf16 v[156:159], a[120:123], a[12:15], v[156:159]
ds_read_b128 a[108:111], v5 offset:39936
v_mfma_f32_16x16x32_bf16 v[160:163], a[124:127], a[12:15], v[160:163]
buffer_load_dwordx4 a[4:7], v4, s[40:43], s35 offen offset:1024 sc1
v_mfma_f32_16x16x32_bf16 v[144:147], a[124:127], a[8:11], v[144:147]
s_waitcnt vmcnt(8) lgkmcnt(4)
v_mfma_f32_16x16x32_bf16 v[132:135], a[128:131], a[16:19], v[132:135]
s_cmp_eq_u32 s3, 5
s_cselect_b32 s35, 21, 13
s_lshl_b32 s35, s35, 12
v_mfma_f32_16x16x32_bf16 v[148:151], a[128:131], a[20:23], v[148:151]
ds_read_b128 a[112:115], v5 offset:40960
v_mfma_f32_16x16x32_bf16 v[152:155], a[132:135], a[20:23], v[152:155]
buffer_load_dwordx4 a[8:11], v4, s[40:43], s35 offen offset:0 sc1
v_mfma_f32_16x16x32_bf16 v[136:139], a[132:135], a[16:19], v[136:139]
ds_read_b128 a[116:119], v5 offset:41984
v_mfma_f32_16x16x32_bf16 v[140:143], a[136:139], a[16:19], v[140:143]
ds_read_b128 a[120:123], v5 offset:43008
v_mfma_f32_16x16x32_bf16 v[156:159], a[136:139], a[20:23], v[156:159]
ds_read_b128 a[124:127], v5 offset:44032
v_mfma_f32_16x16x32_bf16 v[160:163], a[140:143], a[20:23], v[160:163]
buffer_load_dwordx4 a[12:15], v4, s[40:43], s35 offen offset:1024 sc1
v_mfma_f32_16x16x32_bf16 v[144:147], a[140:143], a[16:19], v[144:147]
s_waitcnt vmcnt(8) lgkmcnt(4)
v_mfma_f32_16x16x32_bf16 v[132:135], a[96:99], a[24:27], v[132:135]
s_cmp_eq_u32 s3, 6
s_cselect_b32 s35, 22, 14
s_lshl_b32 s35, s35, 12
v_mfma_f32_16x16x32_bf16 v[148:151], a[96:99], a[28:31], v[148:151]
ds_read_b128 a[128:131], v5 offset:45056
v_mfma_f32_16x16x32_bf16 v[152:155], a[100:103], a[28:31], v[152:155]
buffer_load_dwordx4 a[16:19], v4, s[40:43], s35 offen offset:0 sc1
v_mfma_f32_16x16x32_bf16 v[136:139], a[100:103], a[24:27], v[136:139]
ds_read_b128 a[132:135], v5 offset:46080
v_mfma_f32_16x16x32_bf16 v[140:143], a[104:107], a[24:27], v[140:143]
ds_read_b128 a[136:139], v5 offset:47104
v_mfma_f32_16x16x32_bf16 v[156:159], a[104:107], a[28:31], v[156:159]
ds_read_b128 a[140:143], v5 offset:48128
v_mfma_f32_16x16x32_bf16 v[160:163], a[108:111], a[28:31], v[160:163]
buffer_load_dwordx4 a[20:23], v4, s[40:43], s35 offen offset:1024 sc1
v_mfma_f32_16x16x32_bf16 v[144:147], a[108:111], a[24:27], v[144:147]
s_waitcnt vmcnt(8) lgkmcnt(4)
v_mfma_f32_16x16x32_bf16 v[132:135], a[112:115], a[32:35], v[132:135]
s_cmp_eq_u32 s3, 7
s_cselect_b32 s35, 23, 15
s_lshl_b32 s35, s35, 12
v_mfma_f32_16x16x32_bf16 v[148:151], a[112:115], a[36:39], v[148:151]
ds_read_b128 a[96:99], v5 offset:49152
v_mfma_f32_16x16x32_bf16 v[152:155], a[116:119], a[36:39], v[152:155]
buffer_load_dwordx4 a[24:27], v4, s[40:43], s35 offen offset:0 sc1
v_mfma_f32_16x16x32_bf16 v[136:139], a[116:119], a[32:35], v[136:139]
ds_read_b128 a[100:103], v5 offset:50176
v_mfma_f32_16x16x32_bf16 v[140:143], a[120:123], a[32:35], v[140:143]
ds_read_b128 a[104:107], v5 offset:51200
v_mfma_f32_16x16x32_bf16 v[156:159], a[120:123], a[36:39], v[156:159]
ds_read_b128 a[108:111], v5 offset:52224
v_mfma_f32_16x16x32_bf16 v[160:163], a[124:127], a[36:39], v[160:163]
buffer_load_dwordx4 a[28:31], v4, s[40:43], s35 offen offset:1024 sc1
v_mfma_f32_16x16x32_bf16 v[144:147], a[124:127], a[32:35], v[144:147]
s_waitcnt vmcnt(8) lgkmcnt(4)
v_mfma_f32_16x16x32_bf16 v[132:135], a[128:131], a[40:43], v[132:135]
s_cmp_eq_u32 s3, 0
s_cselect_b32 s35, 24, 16
s_lshl_b32 s35, s35, 12
v_mfma_f32_16x16x32_bf16 v[148:151], a[128:131], a[44:47], v[148:151]
ds_read_b128 a[112:115], v5 offset:53248
v_mfma_f32_16x16x32_bf16 v[152:155], a[132:135], a[44:47], v[152:155]
buffer_load_dwordx4 a[32:35], v4, s[40:43], s35 offen offset:0 sc1
v_mfma_f32_16x16x32_bf16 v[136:139], a[132:135], a[40:43], v[136:139]
ds_read_b128 a[116:119], v5 offset:54272
v_mfma_f32_16x16x32_bf16 v[140:143], a[136:139], a[40:43], v[140:143]
ds_read_b128 a[120:123], v5 offset:55296
v_mfma_f32_16x16x32_bf16 v[156:159], a[136:139], a[44:47], v[156:159]
ds_read_b128 a[124:127], v5 offset:56320
v_mfma_f32_16x16x32_bf16 v[160:163], a[140:143], a[44:47], v[160:163]
buffer_load_dwordx4 a[36:39], v4, s[40:43], s35 offen offset:1024 sc1
v_mfma_f32_16x16x32_bf16 v[144:147], a[140:143], a[40:43], v[144:147]
s_waitcnt vmcnt(8) lgkmcnt(4)
v_mfma_f32_16x16x32_bf16 v[132:135], a[96:99], a[0:3], v[132:135]
s_cmp_eq_u32 s3, 1
s_cselect_b32 s35, 25, 17
s_lshl_b32 s35, s35, 12
v_mfma_f32_16x16x32_bf16 v[148:151], a[96:99], a[4:7], v[148:151]
ds_read_b128 a[128:131], v5 offset:57344
v_mfma_f32_16x16x32_bf16 v[152:155], a[100:103], a[4:7], v[152:155]
buffer_load_dwordx4 a[40:43], v4, s[40:43], s35 offen offset:0 sc1
v_mfma_f32_16x16x32_bf16 v[136:139], a[100:103], a[0:3], v[136:139]
ds_read_b128 a[132:135], v5 offset:58368
v_mfma_f32_16x16x32_bf16 v[140:143], a[104:107], a[0:3], v[140:143]
ds_read_b128 a[136:139], v5 offset:59392
v_mfma_f32_16x16x32_bf16 v[156:159], a[104:107], a[4:7], v[156:159]
ds_read_b128 a[140:143], v5 offset:60416
v_mfma_f32_16x16x32_bf16 v[160:163], a[108:111], a[4:7], v[160:163]
buffer_load_dwordx4 a[44:47], v4, s[40:43], s35 offen offset:1024 sc1
v_mfma_f32_16x16x32_bf16 v[144:147], a[108:111], a[0:3], v[144:147]
s_waitcnt vmcnt(8) lgkmcnt(4)
v_mfma_f32_16x16x32_bf16 v[132:135], a[112:115], a[8:11], v[132:135]
s_cmp_eq_u32 s3, 2
s_cselect_b32 s35, 26, 18
s_lshl_b32 s35, s35, 12
v_mfma_f32_16x16x32_bf16 v[148:151], a[112:115], a[12:15], v[148:151]
ds_read_b128 a[96:99], v5 offset:61440
v_mfma_f32_16x16x32_bf16 v[152:155], a[116:119], a[12:15], v[152:155]
buffer_load_dwordx4 a[0:3], v4, s[40:43], s35 offen offset:0 sc1
v_mfma_f32_16x16x32_bf16 v[136:139], a[116:119], a[8:11], v[136:139]
ds_read_b128 a[100:103], v5 offset:62464
v_mfma_f32_16x16x32_bf16 v[140:143], a[120:123], a[8:11], v[140:143]
ds_read_b128 a[104:107], v5 offset:63488
v_mfma_f32_16x16x32_bf16 v[156:159], a[120:123], a[12:15], v[156:159]
ds_read_b128 a[108:111], v5 offset:64512
v_mfma_f32_16x16x32_bf16 v[160:163], a[124:127], a[12:15], v[160:163]
buffer_load_dwordx4 a[4:7], v4, s[40:43], s35 offen offset:1024 sc1
v_mfma_f32_16x16x32_bf16 v[144:147], a[124:127], a[8:11], v[144:147]
s_waitcnt vmcnt(8) lgkmcnt(4)
v_mfma_f32_16x16x32_bf16 v[132:135], a[128:131], a[16:19], v[132:135]
s_cmp_eq_u32 s3, 3
s_cselect_b32 s35, 27, 19
s_lshl_b32 s35, s35, 12
v_mfma_f32_16x16x32_bf16 v[148:151], a[128:131], a[20:23], v[148:151]
ds_read_b128 a[112:115], v6 offset:0
v_mfma_f32_16x16x32_bf16 v[152:155], a[132:135], a[20:23], v[152:155]
buffer_load_dwordx4 a[8:11], v4, s[40:43], s35 offen offset:0 sc1
v_mfma_f32_16x16x32_bf16 v[136:139], a[132:135], a[16:19], v[136:139]
ds_read_b128 a[116:119], v6 offset:1024
v_mfma_f32_16x16x32_bf16 v[140:143], a[136:139], a[16:19], v[140:143]
ds_read_b128 a[120:123], v6 offset:2048
v_mfma_f32_16x16x32_bf16 v[156:159], a[136:139], a[20:23], v[156:159]
ds_read_b128 a[124:127], v6 offset:3072
v_mfma_f32_16x16x32_bf16 v[160:163], a[140:143], a[20:23], v[160:163]
buffer_load_dwordx4 a[12:15], v4, s[40:43], s35 offen offset:1024 sc1
v_mfma_f32_16x16x32_bf16 v[144:147], a[140:143], a[16:19], v[144:147]
s_waitcnt vmcnt(8) lgkmcnt(4)
v_mfma_f32_16x16x32_bf16 v[132:135], a[96:99], a[24:27], v[132:135]
s_cmp_eq_u32 s3, 4
s_cselect_b32 s35, 28, 20
s_lshl_b32 s35, s35, 12
v_mfma_f32_16x16x32_bf16 v[148:151], a[96:99], a[28:31], v[148:151]
ds_read_b128 a[128:131], v6 offset:4096
v_mfma_f32_16x16x32_bf16 v[152:155], a[100:103], a[28:31], v[152:155]
buffer_load_dwordx4 a[16:19], v4, s[40:43], s35 offen offset:0 sc1
v_mfma_f32_16x16x32_bf16 v[136:139], a[100:103], a[24:27], v[136:139]
ds_read_b128 a[132:135], v6 offset:5120
v_mfma_f32_16x16x32_bf16 v[140:143], a[104:107], a[24:27], v[140:143]
ds_read_b128 a[136:139], v6 offset:6144
v_mfma_f32_16x16x32_bf16 v[156:159], a[104:107], a[28:31], v[156:159]
ds_read_b128 a[140:143], v6 offset:7168
v_mfma_f32_16x16x32_bf16 v[160:163], a[108:111], a[28:31], v[160:163]
buffer_load_dwordx4 a[20:23], v4, s[40:43], s35 offen offset:1024 sc1
v_mfma_f32_16x16x32_bf16 v[144:147], a[108:111], a[24:27], v[144:147]
s_waitcnt vmcnt(8) lgkmcnt(4)
v_mfma_f32_16x16x32_bf16 v[132:135], a[112:115], a[32:35], v[132:135]
s_cmp_eq_u32 s3, 5
s_cselect_b32 s35, 29, 21
s_lshl_b32 s35, s35, 12
v_mfma_f32_16x16x32_bf16 v[148:151], a[112:115], a[36:39], v[148:151]
ds_read_b128 a[96:99], v6 offset:8192
v_mfma_f32_16x16x32_bf16 v[152:155], a[116:119], a[36:39], v[152:155]
buffer_load_dwordx4 a[24:27], v4, s[40:43], s35 offen offset:0 sc1
v_mfma_f32_16x16x32_bf16 v[136:139], a[116:119], a[32:35], v[136:139]
ds_read_b128 a[100:103], v6 offset:9216
v_mfma_f32_16x16x32_bf16 v[140:143], a[120:123], a[32:35], v[140:143]
ds_read_b128 a[104:107], v6 offset:10240
v_mfma_f32_16x16x32_bf16 v[156:159], a[120:123], a[36:39], v[156:159]
ds_read_b128 a[108:111], v6 offset:11264
v_mfma_f32_16x16x32_bf16 v[160:163], a[124:127], a[36:39], v[160:163]
buffer_load_dwordx4 a[28:31], v4, s[40:43], s35 offen offset:1024 sc1
v_mfma_f32_16x16x32_bf16 v[144:147], a[124:127], a[32:35], v[144:147]
s_waitcnt vmcnt(8) lgkmcnt(4)
v_mfma_f32_16x16x32_bf16 v[132:135], a[128:131], a[40:43], v[132:135]
s_cmp_eq_u32 s3, 6
s_cselect_b32 s35, 30, 22
s_lshl_b32 s35, s35, 12
v_mfma_f32_16x16x32_bf16 v[148:151], a[128:131], a[44:47], v[148:151]
ds_read_b128 a[112:115], v6 offset:12288
v_mfma_f32_16x16x32_bf16 v[152:155], a[132:135], a[44:47], v[152:155]
buffer_load_dwordx4 a[32:35], v4, s[40:43], s35 offen offset:0 sc1
v_mfma_f32_16x16x32_bf16 v[136:139], a[132:135], a[40:43], v[136:139]
ds_read_b128 a[116:119], v6 offset:13312
v_mfma_f32_16x16x32_bf16 v[140:143], a[136:139], a[40:43], v[140:143]
ds_read_b128 a[120:123], v6 offset:14336
v_mfma_f32_16x16x32_bf16 v[156:159], a[136:139], a[44:47], v[156:159]
ds_read_b128 a[124:127], v6 offset:15360
v_mfma_f32_16x16x32_bf16 v[160:163], a[140:143], a[44:47], v[160:163]
buffer_load_dwordx4 a[36:39], v4, s[40:43], s35 offen offset:1024 sc1
v_mfma_f32_16x16x32_bf16 v[144:147], a[140:143], a[40:43], v[144:147]
s_waitcnt vmcnt(8) lgkmcnt(4)
v_mfma_f32_16x16x32_bf16 v[132:135], a[96:99], a[0:3], v[132:135]
s_cmp_eq_u32 s3, 7
s_cselect_b32 s35, 31, 23
s_lshl_b32 s35, s35, 12
v_mfma_f32_16x16x32_bf16 v[148:151], a[96:99], a[4:7], v[148:151]
ds_read_b128 a[128:131], v6 offset:16384
v_mfma_f32_16x16x32_bf16 v[152:155], a[100:103], a[4:7], v[152:155]
buffer_load_dwordx4 a[40:43], v4, s[40:43], s35 offen offset:0 sc1
v_mfma_f32_16x16x32_bf16 v[136:139], a[100:103], a[0:3], v[136:139]
ds_read_b128 a[132:135], v6 offset:17408
v_mfma_f32_16x16x32_bf16 v[140:143], a[104:107], a[0:3], v[140:143]
ds_read_b128 a[136:139], v6 offset:18432
v_mfma_f32_16x16x32_bf16 v[156:159], a[104:107], a[4:7], v[156:159]
ds_read_b128 a[140:143], v6 offset:19456
v_mfma_f32_16x16x32_bf16 v[160:163], a[108:111], a[4:7], v[160:163]
buffer_load_dwordx4 a[44:47], v4, s[40:43], s35 offen offset:1024 sc1
v_mfma_f32_16x16x32_bf16 v[144:147], a[108:111], a[0:3], v[144:147]
s_waitcnt vmcnt(8) lgkmcnt(4)
v_mfma_f32_16x16x32_bf16 v[132:135], a[112:115], a[8:11], v[132:135]
s_cmp_eq_u32 s3, 0
s_cselect_b32 s35, 0, 24
s_lshl_b32 s35, s35, 12
v_mfma_f32_16x16x32_bf16 v[148:151], a[112:115], a[12:15], v[148:151]
ds_read_b128 a[96:99], v6 offset:20480
v_mfma_f32_16x16x32_bf16 v[152:155], a[116:119], a[12:15], v[152:155]
buffer_load_dwordx4 a[0:3], v4, s[40:43], s35 offen offset:0 sc1
v_mfma_f32_16x16x32_bf16 v[136:139], a[116:119], a[8:11], v[136:139]
ds_read_b128 a[100:103], v6 offset:21504
v_mfma_f32_16x16x32_bf16 v[140:143], a[120:123], a[8:11], v[140:143]
ds_read_b128 a[104:107], v6 offset:22528
v_mfma_f32_16x16x32_bf16 v[156:159], a[120:123], a[12:15], v[156:159]
ds_read_b128 a[108:111], v6 offset:23552
v_mfma_f32_16x16x32_bf16 v[160:163], a[124:127], a[12:15], v[160:163]
buffer_load_dwordx4 a[4:7], v4, s[40:43], s35 offen offset:1024 sc1
v_mfma_f32_16x16x32_bf16 v[144:147], a[124:127], a[8:11], v[144:147]
s_waitcnt vmcnt(8) lgkmcnt(4)
v_mfma_f32_16x16x32_bf16 v[132:135], a[128:131], a[16:19], v[132:135]
s_cmp_eq_u32 s3, 1
s_cselect_b32 s35, 1, 25
s_lshl_b32 s35, s35, 12
v_mfma_f32_16x16x32_bf16 v[148:151], a[128:131], a[20:23], v[148:151]
ds_read_b128 a[112:115], v6 offset:24576
v_mfma_f32_16x16x32_bf16 v[152:155], a[132:135], a[20:23], v[152:155]
buffer_load_dwordx4 a[8:11], v4, s[40:43], s35 offen offset:0 sc1
v_mfma_f32_16x16x32_bf16 v[136:139], a[132:135], a[16:19], v[136:139]
ds_read_b128 a[116:119], v6 offset:25600
v_mfma_f32_16x16x32_bf16 v[140:143], a[136:139], a[16:19], v[140:143]
ds_read_b128 a[120:123], v6 offset:26624
v_mfma_f32_16x16x32_bf16 v[156:159], a[136:139], a[20:23], v[156:159]
ds_read_b128 a[124:127], v6 offset:27648
v_mfma_f32_16x16x32_bf16 v[160:163], a[140:143], a[20:23], v[160:163]
buffer_load_dwordx4 a[12:15], v4, s[40:43], s35 offen offset:1024 sc1
v_mfma_f32_16x16x32_bf16 v[144:147], a[140:143], a[16:19], v[144:147]
s_waitcnt vmcnt(8) lgkmcnt(4)
v_mfma_f32_16x16x32_bf16 v[132:135], a[96:99], a[24:27], v[132:135]
s_cmp_eq_u32 s3, 2
s_cselect_b32 s35, 2, 26
s_lshl_b32 s35, s35, 12
v_mfma_f32_16x16x32_bf16 v[148:151], a[96:99], a[28:31], v[148:151]
ds_read_b128 a[128:131], v6 offset:28672
v_mfma_f32_16x16x32_bf16 v[152:155], a[100:103], a[28:31], v[152:155]
buffer_load_dwordx4 a[16:19], v4, s[40:43], s35 offen offset:0 sc1
v_mfma_f32_16x16x32_bf16 v[136:139], a[100:103], a[24:27], v[136:139]
ds_read_b128 a[132:135], v6 offset:29696
v_mfma_f32_16x16x32_bf16 v[140:143], a[104:107], a[24:27], v[140:143]
ds_read_b128 a[136:139], v6 offset:30720
v_mfma_f32_16x16x32_bf16 v[156:159], a[104:107], a[28:31], v[156:159]
ds_read_b128 a[140:143], v6 offset:31744
v_mfma_f32_16x16x32_bf16 v[160:163], a[108:111], a[28:31], v[160:163]
buffer_load_dwordx4 a[20:23], v4, s[40:43], s35 offen offset:1024 sc1
v_mfma_f32_16x16x32_bf16 v[144:147], a[108:111], a[24:27], v[144:147]
s_waitcnt vmcnt(8) lgkmcnt(4)
v_mfma_f32_16x16x32_bf16 v[132:135], a[112:115], a[32:35], v[132:135]
s_cmp_eq_u32 s3, 3
s_cselect_b32 s35, 3, 27
s_lshl_b32 s35, s35, 12
v_mfma_f32_16x16x32_bf16 v[148:151], a[112:115], a[36:39], v[148:151]
ds_read_b128 a[96:99], v6 offset:32768
v_mfma_f32_16x16x32_bf16 v[152:155], a[116:119], a[36:39], v[152:155]
buffer_load_dwordx4 a[24:27], v4, s[40:43], s35 offen offset:0 sc1
v_mfma_f32_16x16x32_bf16 v[136:139], a[116:119], a[32:35], v[136:139]
ds_read_b128 a[100:103], v6 offset:33792
v_mfma_f32_16x16x32_bf16 v[140:143], a[120:123], a[32:35], v[140:143]
ds_read_b128 a[104:107], v6 offset:34816
v_mfma_f32_16x16x32_bf16 v[156:159], a[120:123], a[36:39], v[156:159]
ds_read_b128 a[108:111], v6 offset:35840
v_mfma_f32_16x16x32_bf16 v[160:163], a[124:127], a[36:39], v[160:163]
buffer_load_dwordx4 a[28:31], v4, s[40:43], s35 offen offset:1024 sc1
v_mfma_f32_16x16x32_bf16 v[144:147], a[124:127], a[32:35], v[144:147]
s_waitcnt vmcnt(8) lgkmcnt(4)
v_mfma_f32_16x16x32_bf16 v[132:135], a[128:131], a[40:43], v[132:135]
s_cmp_eq_u32 s3, 4
s_cselect_b32 s35, 4, 28
s_lshl_b32 s35, s35, 12
v_mfma_f32_16x16x32_bf16 v[148:151], a[128:131], a[44:47], v[148:151]
ds_read_b128 a[112:115], v6 offset:36864
v_mfma_f32_16x16x32_bf16 v[152:155], a[132:135], a[44:47], v[152:155]
buffer_load_dwordx4 a[32:35], v4, s[40:43], s35 offen offset:0 sc1
v_mfma_f32_16x16x32_bf16 v[136:139], a[132:135], a[40:43], v[136:139]
ds_read_b128 a[116:119], v6 offset:37888
v_mfma_f32_16x16x32_bf16 v[140:143], a[136:139], a[40:43], v[140:143]
ds_read_b128 a[120:123], v6 offset:38912
v_mfma_f32_16x16x32_bf16 v[156:159], a[136:139], a[44:47], v[156:159]
ds_read_b128 a[124:127], v6 offset:39936
v_mfma_f32_16x16x32_bf16 v[160:163], a[140:143], a[44:47], v[160:163]
buffer_load_dwordx4 a[36:39], v4, s[40:43], s35 offen offset:1024 sc1
v_mfma_f32_16x16x32_bf16 v[144:147], a[140:143], a[40:43], v[144:147]
s_waitcnt vmcnt(8) lgkmcnt(4)
v_mfma_f32_16x16x32_bf16 v[132:135], a[96:99], a[0:3], v[132:135]
s_cmp_eq_u32 s3, 5
s_cselect_b32 s35, 5, 29
s_lshl_b32 s35, s35, 12
v_mfma_f32_16x16x32_bf16 v[148:151], a[96:99], a[4:7], v[148:151]
ds_read_b128 a[128:131], v6 offset:40960
v_mfma_f32_16x16x32_bf16 v[152:155], a[100:103], a[4:7], v[152:155]
buffer_load_dwordx4 a[40:43], v4, s[40:43], s35 offen offset:0 sc1
v_mfma_f32_16x16x32_bf16 v[136:139], a[100:103], a[0:3], v[136:139]
ds_read_b128 a[132:135], v6 offset:41984
v_mfma_f32_16x16x32_bf16 v[140:143], a[104:107], a[0:3], v[140:143]
ds_read_b128 a[136:139], v6 offset:43008
v_mfma_f32_16x16x32_bf16 v[156:159], a[104:107], a[4:7], v[156:159]
ds_read_b128 a[140:143], v6 offset:44032
v_mfma_f32_16x16x32_bf16 v[160:163], a[108:111], a[4:7], v[160:163]
buffer_load_dwordx4 a[44:47], v4, s[40:43], s35 offen offset:1024 sc1
v_mfma_f32_16x16x32_bf16 v[144:147], a[108:111], a[0:3], v[144:147]
s_waitcnt vmcnt(8) lgkmcnt(4)
v_mfma_f32_16x16x32_bf16 v[132:135], a[112:115], a[8:11], v[132:135]
s_cmp_eq_u32 s3, 6
s_cselect_b32 s35, 6, 30
s_lshl_b32 s35, s35, 12
v_mfma_f32_16x16x32_bf16 v[148:151], a[112:115], a[12:15], v[148:151]
ds_read_b128 a[96:99], v6 offset:45056
v_mfma_f32_16x16x32_bf16 v[152:155], a[116:119], a[12:15], v[152:155]
buffer_load_dwordx4 a[0:3], v4, s[40:43], s35 offen offset:0 sc1
v_mfma_f32_16x16x32_bf16 v[136:139], a[116:119], a[8:11], v[136:139]
ds_read_b128 a[100:103], v6 offset:46080
v_mfma_f32_16x16x32_bf16 v[140:143], a[120:123], a[8:11], v[140:143]
ds_read_b128 a[104:107], v6 offset:47104
v_mfma_f32_16x16x32_bf16 v[156:159], a[120:123], a[12:15], v[156:159]
ds_read_b128 a[108:111], v6 offset:48128
v_mfma_f32_16x16x32_bf16 v[160:163], a[124:127], a[12:15], v[160:163]
buffer_load_dwordx4 a[4:7], v4, s[40:43], s35 offen offset:1024 sc1
v_mfma_f32_16x16x32_bf16 v[144:147], a[124:127], a[8:11], v[144:147]
s_waitcnt vmcnt(8) lgkmcnt(4)
v_mfma_f32_16x16x32_bf16 v[132:135], a[128:131], a[16:19], v[132:135]
s_cmp_eq_u32 s3, 7
s_cselect_b32 s35, 7, 31
s_lshl_b32 s35, s35, 12
v_mfma_f32_16x16x32_bf16 v[148:151], a[128:131], a[20:23], v[148:151]
ds_read_b128 a[112:115], v6 offset:49152
v_mfma_f32_16x16x32_bf16 v[152:155], a[132:135], a[20:23], v[152:155]
buffer_load_dwordx4 a[8:11], v4, s[40:43], s35 offen offset:0 sc1
v_mfma_f32_16x16x32_bf16 v[136:139], a[132:135], a[16:19], v[136:139]
ds_read_b128 a[116:119], v6 offset:50176
v_mfma_f32_16x16x32_bf16 v[140:143], a[136:139], a[16:19], v[140:143]
ds_read_b128 a[120:123], v6 offset:51200
v_mfma_f32_16x16x32_bf16 v[156:159], a[136:139], a[20:23], v[156:159]
ds_read_b128 a[124:127], v6 offset:52224
v_mfma_f32_16x16x32_bf16 v[160:163], a[140:143], a[20:23], v[160:163]
buffer_load_dwordx4 a[12:15], v4, s[40:43], s35 offen offset:1024 sc1
v_mfma_f32_16x16x32_bf16 v[144:147], a[140:143], a[16:19], v[144:147]
s_waitcnt vmcnt(8) lgkmcnt(4)
v_mfma_f32_16x16x32_bf16 v[132:135], a[96:99], a[24:27], v[132:135]
ds_read_b128 a[128:131], v6 offset:53248
v_mfma_f32_16x16x32_bf16 v[148:151], a[96:99], a[28:31], v[148:151]
ds_read_b128 a[132:135], v6 offset:54272
v_mfma_f32_16x16x32_bf16 v[152:155], a[100:103], a[28:31], v[152:155]
ds_read_b128 a[136:139], v6 offset:55296
v_mfma_f32_16x16x32_bf16 v[136:139], a[100:103], a[24:27], v[136:139]
ds_read_b128 a[140:143], v6 offset:56320
v_mfma_f32_16x16x32_bf16 v[140:143], a[104:107], a[24:27], v[140:143]
v_mfma_f32_16x16x32_bf16 v[156:159], a[104:107], a[28:31], v[156:159]
L_stub20:
s_cbranch_execz L_wret7
buffer_atomic_add v12, v10, s[4:7], s92 offen sc1
v_mfma_f32_16x16x32_bf16 v[160:163], a[108:111], a[28:31], v[160:163]
v_mfma_f32_16x16x32_bf16 v[144:147], a[108:111], a[24:27], v[144:147]
s_waitcnt vmcnt(7) lgkmcnt(4)
v_mfma_f32_16x16x32_bf16 v[132:135], a[112:115], a[32:35], v[132:135]
ds_read_b128 a[96:99], v6 offset:57344
v_mfma_f32_16x16x32_bf16 v[148:151], a[112:115], a[36:39], v[148:151]
ds_read_b128 a[100:103], v6 offset:58368
v_mfma_f32_16x16x32_bf16 v[152:155], a[116:119], a[36:39], v[152:155]
ds_read_b128 a[104:107], v6 offset:59392
v_mfma_f32_16x16x32_bf16 v[136:139], a[116:119], a[32:35], v[136:139]
ds_read_b128 a[108:111], v6 offset:60416
v_mfma_f32_16x16x32_bf16 v[140:143], a[120:123], a[32:35], v[140:143]
v_mfma_f32_16x16x32_bf16 v[156:159], a[120:123], a[36:39], v[156:159]
v_mfma_f32_16x16x32_bf16 v[160:163], a[124:127], a[36:39], v[160:163]
v_mfma_f32_16x16x32_bf16 v[144:147], a[124:127], a[32:35], v[144:147]
s_waitcnt vmcnt(5) lgkmcnt(4)
v_mfma_f32_16x16x32_bf16 v[132:135], a[128:131], a[40:43], v[132:135]
ds_read_b128 a[112:115], v6 offset:61440
v_mfma_f32_16x16x32_bf16 v[148:151], a[128:131], a[44:47], v[148:151]
ds_read_b128 a[116:119], v6 offset:62464
v_mfma_f32_16x16x32_bf16 v[152:155], a[132:135], a[44:47], v[152:155]
ds_read_b128 a[120:123], v6 offset:63488
v_mfma_f32_16x16x32_bf16 v[136:139], a[132:135], a[40:43], v[136:139]
ds_read_b128 a[124:127], v6 offset:64512
v_mfma_f32_16x16x32_bf16 v[140:143], a[136:139], a[40:43], v[140:143]
v_mfma_f32_16x16x32_bf16 v[156:159], a[136:139], a[44:47], v[156:159]
v_mfma_f32_16x16x32_bf16 v[160:163], a[140:143], a[44:47], v[160:163]
v_mfma_f32_16x16x32_bf16 v[144:147], a[140:143], a[40:43], v[144:147]
s_waitcnt vmcnt(3) lgkmcnt(4)
v_mfma_f32_16x16x32_bf16 v[132:135], a[96:99], a[0:3], v[132:135]
v_mfma_f32_16x16x32_bf16 v[148:151], a[96:99], a[4:7], v[148:151]
v_mfma_f32_16x16x32_bf16 v[152:155], a[100:103], a[4:7], v[152:155]
v_mfma_f32_16x16x32_bf16 v[136:139], a[100:103], a[0:3], v[136:139]
v_mfma_f32_16x16x32_bf16 v[140:143], a[104:107], a[0:3], v[140:143]
v_mfma_f32_16x16x32_bf16 v[156:159], a[104:107], a[4:7], v[156:159]
v_mfma_f32_16x16x32_bf16 v[160:163], a[108:111], a[4:7], v[160:163]
v_mfma_f32_16x16x32_bf16 v[144:147], a[108:111], a[0:3], v[144:147]
s_waitcnt vmcnt(1) lgkmcnt(0)
v_mfma_f32_16x16x32_bf16 v[132:135], a[112:115], a[8:11], v[132:135]
v_mfma_f32_16x16x32_bf16 v[148:151], a[112:115], a[12:15], v[148:151]
v_mfma_f32_16x16x32_bf16 v[152:155], a[116:119], a[12:15], v[152:155]
v_mfma_f32_16x16x32_bf16 v[136:139], a[116:119], a[8:11], v[136:139]
v_mfma_f32_16x16x32_bf16 v[140:143], a[120:123], a[8:11], v[140:143]
v_mfma_f32_16x16x32_bf16 v[156:159], a[120:123], a[12:15], v[156:159]
v_mfma_f32_16x16x32_bf16 v[160:163], a[124:127], a[12:15], v[160:163]
v_mfma_f32_16x16x32_bf16 v[144:147], a[124:127], a[8:11], v[144:147]
s_nop 1
v_cmp_u_f32 vcc, v132, v148
s_nop 0
s_and_b32 vcc_lo, vcc_lo, s95
s_cbranch_scc1 L_k2redo3
s_and_b32 s36, s31, 7
s_lshl_b32 s36, s36, 7
s_lshl_b32 s37, s28, 5
s_add_u32 s36, s36, s37
s_lshl_b32 s36, s36, 1
s_lshr_b32 s37, s31, 3
s_add_u32 s36, s36, s37
s_lshl_b32 s36, s36, 11
s_lshl_b32 s37, s32, 7
v_and_b32 v234, 15, v0
s_add_u32 s36, s36, s37
v_lshrrev_b32 v233, 4, v0
v_lshl_add_u32 v232, v234, 12, s36
v_cvt_pk_bf16_f32 v32, v132, v133
v_cvt_pk_bf16_f32 v33, v134, v135
v_cvt_pk_bf16_f32 v34, v136, v137
v_cvt_pk_bf16_f32 v35, v138, v139
v_lshl_add_u32 v232, v233, 4, v232
buffer_store_dwordx4 v[32:35], v232, s[12:15], 0 offen offset:0
v_cvt_pk_bf16_f32 v36, v140, v141
v_cvt_pk_bf16_f32 v37, v142, v143
v_cvt_pk_bf16_f32 v38, v144, v145
v_cvt_pk_bf16_f32 v39, v146, v147
v_cvt_pk_bf16_f32 v40, v148, v149
v_cvt_pk_bf16_f32 v41, v150, v151
v_cvt_pk_bf16_f32 v42, v152, v153
v_cvt_pk_bf16_f32 v43, v154, v155
s_mov_b32 s36, 0x10000
v_cvt_pk_bf16_f32 v44, v156, v157
v_cvt_pk_bf16_f32 v45, v158, v159
v_cvt_pk_bf16_f32 v46, v160, v161
buffer_store_dwordx4 v[36:39], v232, s[12:15], 0 offen offset:64
v_cvt_pk_bf16_f32 v47, v162, v163
buffer_store_dwordx4 v[40:43], v232, s[12:15], s36 offen offset:0
buffer_store_dwordx4 v[44:47], v232, s[12:15], s36 offen offset:64
s_or_b32 s36, s2, s28
s_cbranch_scc1 Lep_38
s_mov_b32 s36, 0xf0000
buffer_store_dword v15, off, s[4:7], s36 sc1
Lep_38:
L_end:
s_endpgm
Ltr_7:
s_add_u32 s52, s67, 0xe0000
s_mov_b32 s53, 0
Ltp_8:
s_sleep 4
buffer_load_dword v11, v255, s[4:7], s52 offen sc1
s_add_u32 s53, s53, 1
s_waitcnt vmcnt(0)
v_cmp_ne_u32 vcc, v11, v15
s_cbranch_vccz Lte_9
s_cmp_lt_u32 s53, 0x100000
s_cbranch_scc1 Ltp_8
s_branch Lte_9
Ltr_10:
s_add_u32 s52, s66, 0xd0040
s_mov_b32 s53, 0
Ltp_11:
s_sleep 4
buffer_load_dword v232, v255, s[4:7], s52 offen sc1
s_add_u32 s53, s53, 1
s_waitcnt vmcnt(0)
v_cmp_ne_u32 vcc, v232, v15
s_cbranch_vccz Lte_12
s_cmp_lt_u32 s53, 0x100000
s_cbranch_scc1 Ltp_11
s_branch Lte_12
L_kvredo1:
s_mov_b32 s88, 0
L_kvredo1b:
v_max_u32 v132, v48, v49
v_max3_u32 v132, v132, v50, v51
v_max3_u32 v132, v132, v52, v53
v_max3_u32 v132, v132, v54, v55
v_max3_u32 v132, v132, v56, v57
v_max3_u32 v132, v132, v58, v59
v_max3_u32 v132, v132, v60, v61
v_max3_u32 v132, v132, v62, v63
v_max3_u32 v132, v132, v64, v65
v_max3_u32 v132, v132, v66, v67
v_max3_u32 v132, v132, v68, v69
v_max3_u32 v132, v132, v70, v71
v_max3_u32 v132, v132, v100, v101
v_max3_u32 v132, v132, v102, v103
v_max3_u32 v132, v132, v104, v105
v_max3_u32 v132, v132, v106, v107
v_max3_u32 v132, v132, v124, v125
v_max3_u32 v132, v132, v126, v127
v_cmp_eq_u32 vcc, -1, v132
s_cbranch_vccz L_kvback1
s_add_u32 s88, s88, 1
s_cmp_gt_u32 s88, 0x80000
s_cbranch_scc1 L_kvback1
s_sleep 4
buffer_load_dwordx4 v[48:51], v1, s[4:7], s98 offen offset:0 sc1
buffer_load_dwordx4 v[124:127], v248, s[4:7], s100 offen sc1
buffer_load_dwordx4 v[52:55], v1, s[4:7], s98 offen offset:1024 sc1
buffer_load_dwordx4 v[56:59], v1, s[4:7], s98 offen offset:2048 sc1
buffer_load_dwordx4 v[60:63], v1, s[4:7], s98 offen offset:3072 sc1
buffer_load_dwordx4 v[64:67], v1, s[4:7], s99 offen offset:0 sc1
buffer_load_dwordx4 v[68:71], v1, s[4:7], s99 offen offset:1024 sc1
buffer_load_dwordx4 v[100:103], v1, s[4:7], s99 offen offset:2048 sc1
buffer_load_dwordx4 v[104:107], v1, s[4:7], s99 offen offset:3072 sc1
s_waitcnt vmcnt(8)
v_lshlrev_b32 v92, 16, v48
v_and_b32 v93, 0xffff0000, v48
v_lshlrev_b32 v94, 16, v49
v_and_b32 v95, 0xffff0000, v49
v_lshlrev_b32 v96, 16, v50
v_and_b32 v97, 0xffff0000, v50
v_lshlrev_b32 v98, 16, v51
v_and_b32 v99, 0xffff0000, v51
s_waitcnt vmcnt(7)
v_add_f32_dpp v128, v124, v124 row_ror:4 row_mask:0xf bank_mask:0xf
v_add_f32_dpp v129, v125, v125 row_ror:4 row_mask:0xf bank_mask:0xf
v_add_f32_dpp v130, v126, v126 row_ror:4 row_mask:0xf bank_mask:0xf
v_add_f32_dpp v131, v127, v127 row_ror:4 row_mask:0xf bank_mask:0xf
v_add_f32_dpp v128, v128, v128 row_ror:2 row_mask:0xf bank_mask:0xf
v_add_f32_dpp v129, v129, v129 row_ror:2 row_mask:0xf bank_mask:0xf
v_add_f32_dpp v130, v130, v130 row_ror:2 row_mask:0xf bank_mask:0xf
v_add_f32_dpp v131, v131, v131 row_ror:2 row_mask:0xf bank_mask:0xf
v_add_f32_dpp v128, v128, v128 row_ror:1 row_mask:0xf bank_mask:0xf
v_add_f32_dpp v129, v129, v129 row_ror:1 row_mask:0xf bank_mask:0xf
v_add_f32_dpp v130, v130, v130 row_ror:1 row_mask:0xf bank_mask:0xf
v_add_f32_dpp v131, v131, v131 row_ror:1 row_mask:0xf bank_mask:0xf
s_waitcnt vmcnt(6)
v_dot2c_f32_bf16 v92, v52, v249
v_dot2c_f32_bf16 v93, v52, v250
v_dot2c_f32_bf16 v94, v53, v249
v_dot2c_f32_bf16 v95, v53, v250
v_dot2c_f32_bf16 v96, v54, v249
v_dot2c_f32_bf16 v97, v54, v250
v_dot2c_f32_bf16 v98, v55, v249
v_dot2c_f32_bf16 v99, v55, v250
s_waitcnt vmcnt(5)
v_dot2c_f32_bf16 v92, v56, v249
v_dot2c_f32_bf16 v93, v56, v250
v_dot2c_f32_bf16 v94, v57, v249
v_dot2c_f32_bf16 v95, v57, v250
v_dot2c_f32_bf16 v96, v58, v249
v_dot2c_f32_bf16 v97, v58, v250
v_dot2c_f32_bf16 v98, v59, v249
v_dot2c_f32_bf16 v99, v59, v250
s_waitcnt vmcnt(4)
v_dot2c_f32_bf16 v92, v60, v249
v_dot2c_f32_bf16 v93, v60, v250
v_dot2c_f32_bf16 v94, v61, v249
v_dot2c_f32_bf16 v95, v61, v250
v_dot2c_f32_bf16 v96, v62, v249
v_dot2c_f32_bf16 v97, v62, v250
v_dot2c_f32_bf16 v98, v63, v249
v_dot2c_f32_bf16 v99, v63, v250
s_waitcnt vmcnt(3)
v_dot2c_f32_bf16 v92, v64, v249
v_dot2c_f32_bf16 v93, v64, v250
v_dot2c_f32_bf16 v94, v65, v249
v_dot2c_f32_bf16 v95, v65, v250
v_dot2c_f32_bf16 v96, v66, v249
v_dot2c_f32_bf16 v97, v66, v250
v_dot2c_f32_bf16 v98, v67, v249
v_dot2c_f32_bf16 v99, v67, v250
s_waitcnt vmcnt(2)
v_dot2c_f32_bf16 v92, v68, v249
v_dot2c_f32_bf16 v93, v68, v250
v_dot2c_f32_bf16 v94, v69, v249
v_dot2c_f32_bf16 v95, v69, v250
v_dot2c_f32_bf16 v96, v70, v249
v_dot2c_f32_bf16 v97, v70, v250
v_dot2c_f32_bf16 v98, v71, v249
v_dot2c_f32_bf16 v99, v71, v250
s_waitcnt vmcnt(1)
v_dot2c_f32_bf16 v92, v100, v249
v_dot2c_f32_bf16 v93, v100, v250
v_dot2c_f32_bf16 v94, v101, v249
v_dot2c_f32_bf16 v95, v101, v250
v_dot2c_f32_bf16 v96, v102, v249
v_dot2c_f32_bf16 v97, v102, v250
v_dot2c_f32_bf16 v98, v103, v249
v_dot2c_f32_bf16 v99, v103, v250
s_waitcnt vmcnt(0)
v_dot2c_f32_bf16 v92, v104, v249
v_dot2c_f32_bf16 v93, v104, v250
v_dot2c_f32_bf16 v94, v105, v249
v_dot2c_f32_bf16 v95, v105, v250
v_dot2c_f32_bf16 v96, v106, v249
v_dot2c_f32_bf16 v97, v106, v250
v_dot2c_f32_bf16 v98, v107, v249
v_dot2c_f32_bf16 v99, v107, v250
s_nop 2
s_branch L_kvredo1b
L_k2redo1:
s_mov_b32 s95, 0
s_mov_b32 s92, 0x40000000
s_mov_b32 s93, 0x40000000
s_mov_b32 s94, 0x40000000
s_add_u32 s36, s66, 0x10000
s_mov_b32 s37, 0
Lpoll_39:
v_mov_b32 v11, 0
buffer_atomic_add v11, v251, s[4:7], s36 offen sc0 sc1
s_add_u32 s37, s37, 1
s_waitcnt vmcnt(0)
v_readfirstlane_b32 s38, v11
s_nop 0
s_cmp_ge_u32 s38, 32
s_cbranch_scc1 Lpe_40
s_cmp_lt_u32 s37, 0x100000
s_cbranch_scc1 Lpoll_39
Lpe_40:
s_nop 7
s_cmp_eq_u32 s3, 0
s_cselect_b32 s35, 8, 0
s_lshl_b32 s35, s35, 12
v_lshlrev_b32 v132, 16, v32
v_and_b32 v133, 0xffff0000, v32
v_lshlrev_b32 v134, 16, v33
v_and_b32 v135, 0xffff0000, v33
v_lshlrev_b32 v136, 16, v34
v_and_b32 v137, 0xffff0000, v34
v_lshlrev_b32 v138, 16, v35
v_and_b32 v139, 0xffff0000, v35
v_lshlrev_b32 v140, 16, v36
v_and_b32 v141, 0xffff0000, v36
v_lshlrev_b32 v142, 16, v37
v_and_b32 v143, 0xffff0000, v37
v_lshlrev_b32 v144, 16, v38
v_and_b32 v145, 0xffff0000, v38
v_lshlrev_b32 v146, 16, v39
v_and_b32 v147, 0xffff0000, v39
v_lshlrev_b32 v148, 16, v40
v_and_b32 v149, 0xffff0000, v40
v_lshlrev_b32 v150, 16, v41
v_and_b32 v151, 0xffff0000, v41
v_lshlrev_b32 v152, 16, v42
v_and_b32 v153, 0xffff0000, v42
v_lshlrev_b32 v154, 16, v43
v_and_b32 v155, 0xffff0000, v43
v_lshlrev_b32 v156, 16, v44
v_and_b32 v157, 0xffff0000, v44
v_lshlrev_b32 v158, 16, v45
v_and_b32 v159, 0xffff0000, v45
v_lshlrev_b32 v160, 16, v46
v_and_b32 v161, 0xffff0000, v46
v_lshlrev_b32 v162, 16, v47
v_and_b32 v163, 0xffff0000, v47
s_branch L_k2go1
L_k2redo2:
s_mov_b32 s95, 0
s_mov_b32 s92, 0x40000000
s_mov_b32 s93, 0x40000000
s_mov_b32 s94, 0x40000000
s_add_u32 s36, s66, 0x20000
s_mov_b32 s37, 0
Lpoll_41:
v_mov_b32 v11, 0
buffer_atomic_add v11, v251, s[4:7], s36 offen sc0 sc1
s_add_u32 s37, s37, 1
s_waitcnt vmcnt(0)
v_readfirstlane_b32 s38, v11
s_nop 0
s_cmp_ge_u32 s38, 32
s_cbranch_scc1 Lpe_42
s_cmp_lt_u32 s37, 0x100000
s_cbranch_scc1 Lpoll_41
Lpe_42:
s_nop 7
s_cmp_eq_u32 s3, 0
s_cselect_b32 s35, 8, 0
s_lshl_b32 s35, s35, 12
v_lshlrev_b32 v132, 16, v32
v_and_b32 v133, 0xffff0000, v32
v_lshlrev_b32 v134, 16, v33
v_and_b32 v135, 0xffff0000, v33
v_lshlrev_b32 v136, 16, v34
v_and_b32 v137, 0xffff0000, v34
v_lshlrev_b32 v138, 16, v35
v_and_b32 v139, 0xffff0000, v35
v_lshlrev_b32 v140, 16, v36
v_and_b32 v141, 0xffff0000, v36
v_lshlrev_b32 v142, 16, v37
v_and_b32 v143, 0xffff0000, v37
v_lshlrev_b32 v144, 16, v38
v_and_b32 v145, 0xffff0000, v38
v_lshlrev_b32 v146, 16, v39
v_and_b32 v147, 0xffff0000, v39
v_lshlrev_b32 v148, 16, v40
v_and_b32 v149, 0xffff0000, v40
v_lshlrev_b32 v150, 16, v41
v_and_b32 v151, 0xffff0000, v41
v_lshlrev_b32 v152, 16, v42
v_and_b32 v153, 0xffff0000, v42
v_lshlrev_b32 v154, 16, v43
v_and_b32 v155, 0xffff0000, v43
v_lshlrev_b32 v156, 16, v44
v_and_b32 v157, 0xffff0000, v44
v_lshlrev_b32 v158, 16, v45
v_and_b32 v159, 0xffff0000, v45
v_lshlrev_b32 v160, 16, v46
v_and_b32 v161, 0xffff0000, v46
v_lshlrev_b32 v162, 16, v47
v_and_b32 v163, 0xffff0000, v47
s_branch L_k2go2
L_kvredo3:
s_mov_b32 s88, 0
L_kvredo3b:
v_max_u32 v132, v48, v49
v_max3_u32 v132, v132, v50, v51
v_max3_u32 v132, v132, v52, v53
v_max3_u32 v132, v132, v54, v55
v_max3_u32 v132, v132, v56, v57
v_max3_u32 v132, v132, v58, v59
v_max3_u32 v132, v132, v60, v61
v_max3_u32 v132, v132, v62, v63
v_max3_u32 v132, v132, v64, v65
v_max3_u32 v132, v132, v66, v67
v_max3_u32 v132, v132, v68, v69
v_max3_u32 v132, v132, v70, v71
v_max3_u32 v132, v132, v100, v101
v_max3_u32 v132, v132, v102, v103
v_max3_u32 v132, v132, v104, v105
v_max3_u32 v132, v132, v106, v107
v_max3_u32 v132, v132, v124, v125
v_max3_u32 v132, v132, v126, v127
v_cmp_eq_u32 vcc, -1, v132
s_cbranch_vccz L_kvback3
s_add_u32 s88, s88, 1
s_cmp_gt_u32 s88, 0x80000
s_cbranch_scc1 L_kvback3
s_sleep 4
buffer_load_dwordx4 v[48:51], v1, s[4:7], s98 offen offset:0 sc1
buffer_load_dwordx4 v[124:127], v248, s[4:7], s100 offen sc1
buffer_load_dwordx4 v[52:55], v1, s[4:7], s98 offen offset:1024 sc1
buffer_load_dwordx4 v[56:59], v1, s[4:7], s98 offen offset:2048 sc1
buffer_load_dwordx4 v[60:63], v1, s[4:7], s98 offen offset:3072 sc1
buffer_load_dwordx4 v[64:67], v1, s[4:7], s99 offen offset:0 sc1
buffer_load_dwordx4 v[68:71], v1, s[4:7], s99 offen offset:1024 sc1
buffer_load_dwordx4 v[100:103], v1, s[4:7], s99 offen offset:2048 sc1
buffer_load_dwordx4 v[104:107], v1, s[4:7], s99 offen offset:3072 sc1
s_waitcnt vmcnt(8)
v_lshlrev_b32 v92, 16, v48
v_and_b32 v93, 0xffff0000, v48
v_lshlrev_b32 v94, 16, v49
v_and_b32 v95, 0xffff0000, v49
v_lshlrev_b32 v96, 16, v50
v_and_b32 v97, 0xffff0000, v50
v_lshlrev_b32 v98, 16, v51
v_and_b32 v99, 0xffff0000, v51
s_waitcnt vmcnt(7)
v_add_f32_dpp v128, v124, v124 row_ror:4 row_mask:0xf bank_mask:0xf
v_add_f32_dpp v129, v125, v125 row_ror:4 row_mask:0xf bank_mask:0xf
v_add_f32_dpp v130, v126, v126 row_ror:4 row_mask:0xf bank_mask:0xf
v_add_f32_dpp v131, v127, v127 row_ror:4 row_mask:0xf bank_mask:0xf
v_add_f32_dpp v128, v128, v128 row_ror:2 row_mask:0xf bank_mask:0xf
v_add_f32_dpp v129, v129, v129 row_ror:2 row_mask:0xf bank_mask:0xf
v_add_f32_dpp v130, v130, v130 row_ror:2 row_mask:0xf bank_mask:0xf
v_add_f32_dpp v131, v131, v131 row_ror:2 row_mask:0xf bank_mask:0xf
v_add_f32_dpp v128, v128, v128 row_ror:1 row_mask:0xf bank_mask:0xf
v_add_f32_dpp v129, v129, v129 row_ror:1 row_mask:0xf bank_mask:0xf
v_add_f32_dpp v130, v130, v130 row_ror:1 row_mask:0xf bank_mask:0xf
v_add_f32_dpp v131, v131, v131 row_ror:1 row_mask:0xf bank_mask:0xf
s_waitcnt vmcnt(6)
v_dot2c_f32_bf16 v92, v52, v249
v_dot2c_f32_bf16 v93, v52, v250
v_dot2c_f32_bf16 v94, v53, v249
v_dot2c_f32_bf16 v95, v53, v250
v_dot2c_f32_bf16 v96, v54, v249
v_dot2c_f32_bf16 v97, v54, v250
v_dot2c_f32_bf16 v98, v55, v249
v_dot2c_f32_bf16 v99, v55, v250
s_waitcnt vmcnt(5)
v_dot2c_f32_bf16 v92, v56, v249
v_dot2c_f32_bf16 v93, v56, v250
v_dot2c_f32_bf16 v94, v57, v249
v_dot2c_f32_bf16 v95, v57, v250
v_dot2c_f32_bf16 v96, v58, v249
v_dot2c_f32_bf16 v97, v58, v250
v_dot2c_f32_bf16 v98, v59, v249
v_dot2c_f32_bf16 v99, v59, v250
s_waitcnt vmcnt(4)
v_dot2c_f32_bf16 v92, v60, v249
v_dot2c_f32_bf16 v93, v60, v250
v_dot2c_f32_bf16 v94, v61, v249
v_dot2c_f32_bf16 v95, v61, v250
v_dot2c_f32_bf16 v96, v62, v249
v_dot2c_f32_bf16 v97, v62, v250
v_dot2c_f32_bf16 v98, v63, v249
v_dot2c_f32_bf16 v99, v63, v250
s_waitcnt vmcnt(3)
v_dot2c_f32_bf16 v92, v64, v249
v_dot2c_f32_bf16 v93, v64, v250
v_dot2c_f32_bf16 v94, v65, v249
v_dot2c_f32_bf16 v95, v65, v250
v_dot2c_f32_bf16 v96, v66, v249
v_dot2c_f32_bf16 v97, v66, v250
v_dot2c_f32_bf16 v98, v67, v249
v_dot2c_f32_bf16 v99, v67, v250
s_waitcnt vmcnt(2)
v_dot2c_f32_bf16 v92, v68, v249
v_dot2c_f32_bf16 v93, v68, v250
v_dot2c_f32_bf16 v94, v69, v249
v_dot2c_f32_bf16 v95, v69, v250
v_dot2c_f32_bf16 v96, v70, v249
v_dot2c_f32_bf16 v97, v70, v250
v_dot2c_f32_bf16 v98, v71, v249
v_dot2c_f32_bf16 v99, v71, v250
s_waitcnt vmcnt(1)
v_dot2c_f32_bf16 v92, v100, v249
v_dot2c_f32_bf16 v93, v100, v250
v_dot2c_f32_bf16 v94, v101, v249
v_dot2c_f32_bf16 v95, v101, v250
v_dot2c_f32_bf16 v96, v102, v249
v_dot2c_f32_bf16 v97, v102, v250
v_dot2c_f32_bf16 v98, v103, v249
v_dot2c_f32_bf16 v99, v103, v250
s_waitcnt vmcnt(0)
v_dot2c_f32_bf16 v92, v104, v249
v_dot2c_f32_bf16 v93, v104, v250
v_dot2c_f32_bf16 v94, v105, v249
v_dot2c_f32_bf16 v95, v105, v250
v_dot2c_f32_bf16 v96, v106, v249
v_dot2c_f32_bf16 v97, v106, v250
v_dot2c_f32_bf16 v98, v107, v249
v_dot2c_f32_bf16 v99, v107, v250
s_nop 2
s_branch L_kvredo3b
L_k2redo3:
s_mov_b32 s95, 0
s_mov_b32 s92, 0x40000000
s_mov_b32 s93, 0x40000000
s_mov_b32 s94, 0x40000000
s_add_u32 s36, s66, 0x30000
s_mov_b32 s37, 0
Lpoll_43:
v_mov_b32 v11, 0
buffer_atomic_add v11, v251, s[4:7], s36 offen sc0 sc1
s_add_u32 s37, s37, 1
s_waitcnt vmcnt(0)
v_readfirstlane_b32 s38, v11
s_nop 0
s_cmp_ge_u32 s38, 32
s_cbranch_scc1 Lpe_44
s_cmp_lt_u32 s37, 0x100000
s_cbranch_scc1 Lpoll_43
Lpe_44:
s_nop 7
s_cmp_eq_u32 s3, 0
s_cselect_b32 s35, 8, 0
s_lshl_b32 s35, s35, 12
v_lshlrev_b32 v132, 16, v32
v_and_b32 v133, 0xffff0000, v32
v_lshlrev_b32 v134, 16, v33
v_and_b32 v135, 0xffff0000, v33
v_lshlrev_b32 v136, 16, v34
v_and_b32 v137, 0xffff0000, v34
v_lshlrev_b32 v138, 16, v35
v_and_b32 v139, 0xffff0000, v35
v_lshlrev_b32 v140, 16, v36
v_and_b32 v141, 0xffff0000, v36
v_lshlrev_b32 v142, 16, v37
v_and_b32 v143, 0xffff0000, v37
v_lshlrev_b32 v144, 16, v38
v_and_b32 v145, 0xffff0000, v38
v_lshlrev_b32 v146, 16, v39
v_and_b32 v147, 0xffff0000, v39
v_lshlrev_b32 v148, 16, v40
v_and_b32 v149, 0xffff0000, v40
v_lshlrev_b32 v150, 16, v41
v_and_b32 v151, 0xffff0000, v41
v_lshlrev_b32 v152, 16, v42
v_and_b32 v153, 0xffff0000, v42
v_lshlrev_b32 v154, 16, v43
v_and_b32 v155, 0xffff0000, v43
v_lshlrev_b32 v156, 16, v44
v_and_b32 v157, 0xffff0000, v44
v_lshlrev_b32 v158, 16, v45
v_and_b32 v159, 0xffff0000, v45
v_lshlrev_b32 v160, 16, v46
v_and_b32 v161, 0xffff0000, v46
v_lshlrev_b32 v162, 16, v47
v_and_b32 v163, 0xffff0000, v47
s_branch L_k2go3
L_code_end:
.section .rodata,"a"
.p2align 6
.amdhsa_kernel interleave_layers__sliding_local_dilated__linear_kernel_hedgehog__prompt_kernel
  .amdhsa_next_free_vgpr 512
  .amdhsa_next_free_sgpr 102
  .amdhsa_accum_offset 256
  .amdhsa_group_segment_fixed_size 0
  .amdhsa_kernarg_size 80
  .amdhsa_user_sgpr_count 2
  .amdhsa_user_sgpr_kernarg_segment_ptr 1
  .amdhsa_system_sgpr_workgroup_id_x 1
.end_amdhsa_kernel
```

```asm
; @launch grid=(256,1,1) block=(256,1,1) lds=163840
.amdgcn_target "amdgcn-amd-amdhsa--gfx950"
.text
.globl interleave_layers__sliding_local_dilated__linear_kernel_hedgehog__prompt_kernel
.p2align 8
.type interleave_layers__sliding_local_dilated__linear_kernel_hedgehog__prompt_kernel,@function
interleave_layers__sliding_local_dilated__linear_kernel_hedgehog__prompt_kernel:
s_cmp_ge_u32 s2, 256
s_cbranch_scc1 L_end
s_load_dwordx16 s[64:79], s[0:1], 0
s_load_dwordx4 s[80:83], s[0:1], 64
s_getpc_b64 s[24:25]
s_mov_b32 s26, (L_end - interleave_layers__sliding_local_dilated__linear_kernel_hedgehog__prompt_kernel - 64)
s_mov_b32 s27, 0x20000
v_lshlrev_b32 v1, 5, v0
buffer_load_dword v238, v1, s[24:27], 0 offen
v_lshrrev_b32 v1, 6, v0
v_and_b32 v0, 63, v0
v_readfirstlane_b32 s28, v1
s_and_b32 s36, s2, 7
s_lshr_b32 s37, s2, 3
s_and_b32 s38, s37, 3
s_lshr_b32 s39, s37, 2
s_and_b32 s29, s36, 1
s_lshl_b32 s32, s29, 3
s_lshl_b32 s29, s29, 2
s_add_u32 s29, s29, s38
s_add_u32 s32, s32, s39
s_lshr_b32 s36, s36, 1
s_lshl_b32 s30, s36, 3
s_add_u32 s30, s30, s39
s_lshl_b32 s31, s36, 2
s_add_u32 s31, s31, s38
s_and_b32 s32, s36, 1
s_lshl_b32 s32, s32, 3
s_add_u32 s32, s32, s39
s_and_b32 s31, s2, 1
s_lshl_b32 s31, s31, 3
s_add_u32 s31, s31, s38
s_and_b32 s3, s2, 4
s_add_u32 s31, s31, s3
s_mov_b32 s3, s39
s_and_b32 s35, s2, 7
s_lshl_b32 s35, s35, 5
s_add_u32 s35, s35, s37
s_mul_i32 s33, s39, 0
s_and_b32 s33, s33, 31
s_mul_i32 s34, s39, 0
s_and_b32 s34, s34, 31
v_lshlrev_b32 v1, 4, v0
v_lshrrev_b32 v233, 4, v0
v_and_b32 v234, 15, v0
s_and_b32 s88, s31, 7
s_lshl_b32 s88, s88, 7
s_lshl_b32 s37, s28, 5
s_add_u32 s88, s88, s37
s_lshl_b32 s88, s88, 1
s_lshr_b32 s37, s31, 3
s_add_u32 s88, s88, s37
s_lshl_b32 s88, s88, 11
s_lshl_b32 s37, s32, 7
s_add_u32 s88, s88, s37
v_lshrrev_b32 v235, 3, v0
v_and_b32 v236, 7, v0
v_xor_b32 v232, v236, v233
v_lshlrev_b32 v232, 4, v232
v_lshl_add_u32 v232, v235, 12, v232
v_xor_b32 v246, 64, v232
v_lshlrev_b32 v236, 4, v236
v_lshl_add_u32 v237, v235, 11, v236
v_mul_u32_u24 v235, 6144, v235
v_add_u32 v235, v235, v236
s_lshr_b32 s36, s35, 4
s_lshl_b32 s36, s36, 2
s_add_u32 s36, s36, s28
s_mul_i32 s36, s36, 98304
s_and_b32 s37, s35, 15
s_lshl_b32 s37, s37, 7
s_add_u32 s36, s36, s37
s_lshl_b32 s37, s28, 11
s_mov_b32 s39, 0x10000
s_mov_b32 s10, 0x400000
s_mov_b32 s11, 0x20000
s_mov_b32 s22, 0x600000
s_mov_b32 s23, 0x20000
s_mov_b32 s6, 0x10000000
s_mov_b32 s7, 0x20000
s_mov_b32 s44, 0xf0000
s_waitcnt lgkmcnt(0)
s_mov_b64 s[8:9], s[64:65]
s_mov_b64 s[20:21], s[66:67]
s_lshl_b32 s39, s37, 1
s_add_u32 m0, s37, 0
s_add_u32 s38, s36, 0
buffer_load_dwordx4 v235, s[20:23], s38 offen nt lds
s_add_u32 m0, s37, 1024
s_add_u32 s38, s36, 49152
buffer_load_dwordx4 v235, s[20:23], s38 offen nt lds
s_add_u32 m0, s37, 8192
s_add_u32 s38, s36, 2048
buffer_load_dwordx4 v235, s[20:23], s38 offen nt lds
s_add_u32 m0, s37, 9216
s_add_u32 s38, s36, 51200
buffer_load_dwordx4 v235, s[20:23], s38 offen nt lds
s_add_u32 m0, s37, 16384
s_add_u32 s38, s36, 4096
buffer_load_dwordx4 v235, s[20:23], s38 offen nt lds
s_add_u32 m0, s37, 17408
s_add_u32 s38, s36, 53248
buffer_load_dwordx4 v235, s[20:23], s38 offen nt lds
s_add_u32 m0, s39, 24576
s_add_u32 s38, s88, 0
buffer_load_dwordx4 v232, s[8:11], s38 offen nt lds
s_add_u32 m0, s39, 25600
s_add_u32 s38, s88, 32768
buffer_load_dwordx4 v246, s[8:11], s38 offen nt lds
s_add_u32 m0, s39, 26624
s_add_u32 s38, s88, 65536
buffer_load_dwordx4 v232, s[8:11], s38 offen nt lds
s_add_u32 m0, s39, 27648
s_add_u32 s38, s88, 98304
buffer_load_dwordx4 v246, s[8:11], s38 offen nt lds
s_mov_b32 s37, s39
v_lshrrev_b32 v232, 1, v234
v_xor_b32 v232, v232, v233
v_lshlrev_b32 v232, 4, v232
v_lshl_add_u32 v232, v234, 7, v232
v_add_u32 v232, s37, v232
s_add_u32 s4, s82, 0x0
s_addc_u32 s5, s83, 0
s_mov_b32 s12, s78
s_mov_b32 s13, s79
s_mov_b32 s14, 0x400000
s_mov_b32 s15, 0x20000
s_mov_b32 s42, 0x400000
s_mov_b32 s43, 0x20000
v_mov_b32 v12, 1
s_mov_b64 s[40:41], s[12:13]
s_mov_b32 s64, 0xff
s_mov_b32 s65, 0
s_and_b32 s81, s29, 3
s_lshl_b32 s66, s31, 4
s_add_u32 s66, s66, s32
s_lshl_b32 s66, s66, 8
s_lshl_b32 s67, s29, 5
s_add_u32 s67, s67, s30
s_lshl_b32 s67, s67, 8
s_lshl_b32 s80, s30, 11
s_lshl_b32 s70, s29, 8
s_add_u32 s70, s70, s80
s_lshl_b32 s71, s29, 13
s_lshr_b32 s78, s31, 1
s_lshl_b32 s78, s78, 13
s_add_u32 s79, s78, 8192
s_bitcmp1_b32 s31, 0
s_cselect_b32 s79, s79, 0x40000000
s_and_b32 s36, s31, 7
s_cmp_eq_u32 s36, 7
s_cselect_b32 s79, 0x40000000, s79
v_mov_b32 v240, 0
v_mov_b32 v241, 0
v_mov_b32 v242, 0
v_mov_b32 v243, 0
v_mov_b32 v228, v235
v_mov_b32 v229, v237
s_lshr_b32 s36, s35, 4
s_lshl_b32 s36, s36, 2
s_add_u32 s36, s36, s28
s_and_b32 s37, s35, 15
s_lshl_b32 s37, s37, 7
s_lshl_b32 s16, s36, 15
s_add_u32 s16, s16, s37
s_mul_i32 s17, s36, 98304
s_add_u32 s17, s17, s37
v_mov_b32 v16, 0x3f803f80
v_mov_b32 v17, 0x3f803f80
v_mov_b32 v18, 0x3f803f80
v_mov_b32 v19, 0x3f803f80
s_mov_b32 s46, 0xaaaaaaaa
s_mov_b32 s47, 0xaaaaaaaa
s_mov_b32 s48, 0xcccccccc
s_mov_b32 s49, 0xcccccccc
s_lshl_b32 s36, s31, 1
s_lshr_b32 s37, s28, 1
s_add_u32 s36, s36, s37
s_lshl_b32 s36, s36, 17
s_and_b32 s37, s28, 1
s_lshl_b32 s37, s37, 11
s_add_u32 s36, s36, s37
v_add_u32 v4, s36, v1
s_lshl_b32 s38, s31, 2
s_add_u32 s38, s38, s28
s_lshl_b32 s38, s38, 12
s_lshl_b32 s39, s32, 7
s_add_u32 s38, s38, s39
v_lshrrev_b32 v244, 2, v234
v_cmp_eq_u32 vcc, v244, v233
v_and_b32 v244, 7, v234
v_lshl_add_u32 v244, v244, 4, s38
v_and_b32 v245, 8, v234
v_add_u32 v244, v244, v245
v_cndmask_b32 v253, 2.0, v244, vcc
v_lshlrev_b32 v244, 4, v233
v_lshl_add_u32 v244, v234, 6, v244
v_cmp_gt_u32 vcc, 2, v234
s_nop 1
v_cndmask_b32 v254, 2.0, v244, vcc
v_lshrrev_b32 v248, 4, v0
v_lshlrev_b32 v248, 10, v248
v_bfe_u32 v249, v0, 2, 2
v_lshl_add_u32 v248, v249, 7, v248
v_and_b32 v251, 3, v0
v_lshl_add_u32 v248, v251, 3, v248
s_lshr_b32 s36, s28, 1
s_lshl_b32 s36, s36, 6
s_and_b32 s37, s28, 1
s_mul_i32 s38, s37, 8224
s_add_u32 s38, s38, s36
s_mul_i32 s39, s37, 16352
s_add_u32 s39, s39, s36
v_add_u32 v249, s39, v248
v_add_u32 v248, s38, v248
s_and_b32 s38, s35, 15
s_lshl_b32 s38, s38, 1
s_lshr_b32 s36, s28, 1
s_add_u32 s38, s38, s36
s_lshr_b32 s36, s35, 4
s_mul_i32 s96, s38, 196608
s_mul_i32 s44, s36, 12288
s_add_u32 s96, s96, s44
s_mul_i32 s44, s37, 3072
s_add_u32 s96, s96, s44
s_add_u32 s96, s96, 0xe00000
s_add_u32 s97, s96, 6144
s_mul_i32 s38, s38, 6
s_mul_i32 s37, s37, 3
s_add_u32 s38, s38, s37
s_lshl_b32 s38, s38, 11
s_lshl_b32 s36, s36, 7
s_add_u32 s38, s38, s36
s_add_u32 s98, s38, 0x300000
s_add_u32 s99, s98, 4096
v_lshrrev_b32 v247, 2, v0
v_lshlrev_b32 v250, 7, v247
v_lshl_add_u32 v250, v251, 4, v250
s_lshr_b32 s36, s28, 1
s_lshl_b32 s36, s36, 12
s_and_b32 s37, s28, 1
s_lshl_b32 s37, s37, 6
s_add_u32 s36, s36, s37
s_add_u32 s36, s36, 147456
v_add_u32 v250, s36, v250
v_subrev_u32 v230, 122880, v250
s_and_b32 s36, s35, 15
s_lshl_b32 s36, s36, 17
s_lshr_b32 s37, s35, 4
s_lshl_b32 s37, s37, 13
s_add_u32 s36, s36, s37
s_lshl_b32 s37, s28, 11
s_add_u32 s36, s36, s37
s_add_u32 s100, s36, 0xa00000
s_add_u32 s101, s36, 0xc00000
v_lshlrev_b32 v247, 6, v247
v_lshl_add_u32 v251, v251, 3, v247
v_add_u32 v251, 155648, v251
v_xor_b32 v236, 64, v232
s_mov_b64 s[20:21], s[68:69]
s_mov_b32 s22, 0x200000
s_lshl_b32 s37, s28, 11
s_add_u32 m0, s37, 147456
s_add_u32 s36, s16, 0
buffer_load_dwordx4 v229, s[20:23], s36 offen nt lds
s_add_u32 m0, s37, 148480
s_add_u32 s36, s16, 16384
buffer_load_dwordx4 v229, s[20:23], s36 offen nt lds
s_add_u32 s36, s67, 0xc0000
s_add_u32 s37, s66, 0xd0000
s_cmp_eq_u32 s28, 2
s_cselect_b32 s36, s37, s36
s_cmp_eq_u32 s28, 1
s_cselect_b32 s37, 128, 0
s_add_u32 s36, s36, s37
s_cmp_eq_u32 s28, 3
s_cselect_b32 s37, 0x20000, 0
s_add_u32 s36, s36, s37
s_mov_b64 exec, 1
buffer_atomic_add v240, off, s[4:7], s36 sc1
s_mov_b64 exec, -1
s_mov_b32 s36, 0xf0000
buffer_load_dword v11, off, s[4:7], s36 sc1
s_lshr_b32 s36, s2, 3
s_lshl_b32 s36, s36, 2
s_add_u32 s36, s36, s28
s_lshl_b32 s36, s36, 10
buffer_load_dwordx4 a[0:3], v1, s[24:27], s36 offen
s_mov_b64 s[20:21], s[74:75]
s_mov_b32 s22, 0x10000
s_and_b32 s36, s28, 1
s_lshl_b32 s36, s36, 10
s_add_u32 m0, s36, 155648
s_lshl_b32 s37, s30, 11
s_add_u32 s36, s36, s37
buffer_load_dwordx4 v1, s[20:23], s36 offen lds
s_waitcnt vmcnt(6)
ds_read_b128 v[32:35], v232 offset:24576
ds_read_b128 v[36:39], v236 offset:24576
ds_read_b128 v[40:43], v232 offset:26624
ds_read_b128 v[44:47], v236 offset:26624
s_barrier
ds_read_b64_tr_b16 a[188:189], v248 offset:0
ds_read_b64_tr_b16 a[190:191], v248 offset:512
ds_read_b64_tr_b16 a[192:193], v248 offset:4096
ds_read_b64_tr_b16 a[194:195], v248 offset:4608
ds_read_b64_tr_b16 a[196:197], v249 offset:32
ds_read_b64_tr_b16 a[198:199], v249 offset:544
ds_read_b64_tr_b16 a[200:201], v249 offset:4128
ds_read_b64_tr_b16 a[202:203], v249 offset:4640
ds_read_b64_tr_b16 a[204:205], v248 offset:8192
ds_read_b64_tr_b16 a[206:207], v248 offset:8704
ds_read_b64_tr_b16 a[208:209], v248 offset:12288
ds_read_b64_tr_b16 a[210:211], v248 offset:12800
s_lshl_b32 s36, s32, 13
s_add_u32 s36, s36, 0x0
s_add_u32 s37, s36, 4096
s_mov_b32 s38, 0x200000
s_waitcnt lgkmcnt(14)
v_mfma_f32_16x16x32_bf16 v[96:99], v[32:35], v[32:35], 0
v_mfma_f32_16x16x32_bf16 v[92:95], v[16:19], v[32:35], 0
buffer_store_dwordx4 v[32:35], v4, s[12:15], s36 offen offset:0 sc1
s_waitcnt lgkmcnt(13)
v_mfma_f32_16x16x32_bf16 v[104:107], v[40:43], v[40:43], 0
v_mfma_f32_16x16x32_bf16 v[100:103], v[16:19], v[40:43], 0
buffer_store_dwordx4 v[40:43], v4, s[12:15], s36 offen offset:1024 sc1
v_mfma_f32_16x16x32_bf16 v[96:99], v[36:39], v[36:39], v[96:99]
v_mfma_f32_16x16x32_bf16 v[92:95], v[16:19], v[36:39], v[92:95]
buffer_store_dwordx4 v[36:39], v4, s[12:15], s37 offen offset:0 sc1
s_waitcnt lgkmcnt(12)
v_mfma_f32_16x16x32_bf16 v[104:107], v[44:47], v[44:47], v[104:107]
v_mfma_f32_16x16x32_bf16 v[100:103], v[16:19], v[44:47], v[100:103]
buffer_store_dwordx4 v[44:47], v4, s[12:15], s37 offen offset:1024 sc1
s_nop 1
v_cndmask_b32 v96, v96, v97, s[46:47]
v_cndmask_b32 v98, v98, v99, s[46:47]
v_cndmask_b32 v93, v96, v98, s[48:49]
buffer_store_dwordx2 v[92:93], v253, s[4:7], s38 offen offset:0 sc1
v_cndmask_b32 v104, v104, v105, s[46:47]
v_cndmask_b32 v106, v106, v107, s[46:47]
v_cndmask_b32 v101, v104, v106, s[48:49]
buffer_store_dwordx2 v[100:101], v253, s[4:7], s38 offen offset:2048 sc1
s_waitcnt lgkmcnt(10)
v_mfma_f32_16x16x32_bf16 v[108:111], a[188:191], v[16:19], 0
s_waitcnt lgkmcnt(6)
v_mfma_f32_16x16x32_bf16 v[112:115], a[196:199], v[16:19], 0
s_waitcnt lgkmcnt(2)
v_mfma_f32_16x16x32_bf16 v[116:119], a[204:207], v[16:19], 0
v_mfma_f32_16x16x32_bf16 v[108:111], a[192:195], v[16:19], v[108:111]
v_mfma_f32_16x16x32_bf16 v[112:115], a[200:203], v[16:19], v[112:115]
s_waitcnt lgkmcnt(0)
v_mfma_f32_16x16x32_bf16 v[116:119], a[208:211], v[16:19], v[116:119]
buffer_store_dwordx4 a[188:191], v1, s[4:7], s96 offen offset:0 sc1
buffer_store_dwordx4 a[192:195], v1, s[4:7], s97 offen offset:0 sc1
buffer_store_dwordx4 a[196:199], v1, s[4:7], s96 offen offset:1024 sc1
buffer_store_dwordx4 a[200:203], v1, s[4:7], s97 offen offset:1024 sc1
buffer_store_dwordx4 a[204:207], v1, s[4:7], s96 offen offset:2048 sc1
buffer_store_dwordx4 a[208:211], v1, s[4:7], s97 offen offset:2048 sc1
buffer_store_dwordx4 v[108:111], v254, s[4:7], s98 offen offset:0 sc1
buffer_store_dwordx4 v[112:115], v254, s[4:7], s98 offen offset:2048 sc1
buffer_store_dwordx4 v[116:119], v254, s[4:7], s99 offen offset:0 sc1
v_lshlrev_b32 v239, 16, v233
v_lshl_add_u32 v239, v234, 4, v239
s_cmp_eq_u32 s28, 0
s_cselect_b32 s36, s66, s67
s_cmp_eq_u32 s28, 2
s_cselect_b32 s36, s70, s36
s_lshl_b32 s37, s28, 18
s_add_u32 s36, s36, s37
s_cmp_eq_u32 s28, 3
s_cselect_b32 s36, 0x40000000, s36
buffer_store_dwordx4 v[240:243], v239, s[4:7], s36 offen sc1
s_waitcnt vmcnt(20)
s_barrier
ds_read_b64_tr_b16 a[212:213], v250 offset:0
ds_read_b64_tr_b16 a[214:215], v250 offset:2048
ds_read_b64_tr_b16 a[216:217], v250 offset:8
ds_read_b64_tr_b16 a[218:219], v250 offset:2056
s_waitcnt lgkmcnt(2)
buffer_store_dwordx4 a[212:215], v1, s[4:7], s100 offen offset:0 sc1
s_waitcnt lgkmcnt(0)
buffer_store_dwordx4 a[216:219], v1, s[4:7], s100 offen offset:1024 sc1
s_mov_b32 s56, 0x11111111
s_mov_b32 s57, 0x11111111
s_mov_b32 s58, 0x22222222
s_mov_b32 s59, 0x22222222
s_mul_i32 s18, s28, 3072
s_lshl_b32 s19, s28, 12
s_mul_i32 s50, s30, 196608
s_add_u32 s50, s50, s18
s_lshl_b32 s36, s32, 17
s_add_u32 s36, s36, s19
s_add_u32 s37, s28, 0
s_cmp_eq_u32 s37, s3
s_cselect_b32 s37, 32768, 0
s_add_u32 s84, s36, s37
s_mul_i32 s37, s37, 3
s_sub_u32 s86, s36, s37
s_add_u32 s37, s28, 4
s_cmp_eq_u32 s37, s3
s_cselect_b32 s37, 32768, 0
s_add_u32 s85, s36, s37
s_mul_i32 s37, s37, 3
s_sub_u32 s87, s36, s37
s_mul_i32 s55, s28, 6144
v_accvgpr_write_b32 a248, -1
v_accvgpr_write_b32 a249, -1
v_accvgpr_write_b32 a250, -1
v_accvgpr_write_b32 a251, -1
s_lshl_b32 s36, s29, 2
s_add_u32 s36, s36, s28
s_lshl_b32 s37, s36, 17
v_add_u32 v2, s37, v1
s_lshl_b32 s82, s36, 13
s_and_b32 s38, s29, 3
s_cmp_eq_u32 s38, 0
s_cselect_b32 s38, 0, 0x1f400
s_cselect_b32 s39, 0, 2048
s_cselect_b32 s54, 32, 48
s_lshl_b32 s37, s29, 19
s_sub_u32 s37, s37, s38
v_add_u32 v3, s37, v1
v_cmp_le_u32 vcc, 8, v234
s_nop 1
v_cndmask_b32 v3, 2.0, v3, vcc
s_lshl_b32 s37, s29, 15
s_sub_u32 s83, s37, s39
s_cmp_eq_u32 s28, 1
s_cselect_b32 vcc_lo, -1, 0
s_mov_b32 vcc_hi, 0
v_lshlrev_b32 v244, 8, v0
v_cndmask_b32 v10, 2.0, v244, vcc
v_and_b32 v244, 1, v233
v_lshl_add_u32 v244, v244, 3, v234
v_and_b32 v244, 15, v244
v_lshrrev_b32 v245, 1, v233
v_lshl_add_u32 v244, v245, 4, v244
v_lshrrev_b32 v245, 3, v234
v_lshl_add_u32 v244, v245, 5, v244
v_lshlrev_b32 v7, 3, v244
v_lshrrev_b32 v246, 2, v0
v_and_b32 v247, 3, v0
v_and_b32 v244, 1, v247
v_lshl_add_u32 v244, v244, 3, v246
v_and_b32 v244, 15, v244
v_lshrrev_b32 v245, 1, v247
v_lshl_add_u32 v244, v245, 4, v244
v_lshrrev_b32 v245, 3, v246
v_lshl_add_u32 v244, v245, 5, v244
v_lshlrev_b32 v8, 3, v244
s_and_b32 s36, s28, 1
s_lshl_b32 s37, s36, 3
s_add_u32 s37, s37, 20480
s_lshl_b32 s36, s36, 9
v_add_u32 v244, s37, v1
v_add_u32 v245, s36, v7
s_cmp_lt_u32 s28, 2
s_cselect_b64 vcc, -1, 0
v_cndmask_b32 v9, v245, v244, vcc
v_lshlrev_b32 v239, 2, v233
v_sub_u32 v239, v239, v234
v_mov_b32 v247, 0xf149f2ca
v_add_u32 v246, 7, v239
v_cmp_gt_u32 vcc, 8, v246
v_mov_b32 v244, 0xffff
s_nop 0
v_cndmask_b32 v24, v247, 0, vcc
v_cndmask_b32 v244, 0, v244, vcc
v_mov_b32 v30, v244
v_add_u32 v246, 0, v239
v_cmp_le_i32 vcc, 9, v246
v_mov_b32 v244, 0xffff
s_nop 0
v_cndmask_b32 v20, v247, 0, vcc
v_cndmask_b32 v244, 0, v244, vcc
v_mov_b32 v28, v244
v_add_u32 v246, 8, v239
v_cmp_gt_u32 vcc, 8, v246
v_mov_b32 v244, 0xffff0000
s_nop 0
v_cndmask_b32 v25, v247, 0, vcc
v_cndmask_b32 v244, 0, v244, vcc
v_or_b32 v30, v30, v244
v_add_u32 v246, 1, v239
v_cmp_le_i32 vcc, 9, v246
v_mov_b32 v244, 0xffff0000
s_nop 0
v_cndmask_b32 v21, v247, 0, vcc
v_cndmask_b32 v244, 0, v244, vcc
v_or_b32 v28, v28, v244
v_add_u32 v246, 9, v239
v_cmp_gt_u32 vcc, 8, v246
v_mov_b32 v244, 0xffff
s_nop 0
v_cndmask_b32 v26, v247, 0, vcc
v_cndmask_b32 v244, 0, v244, vcc
v_mov_b32 v31, v244
v_add_u32 v246, 2, v239
v_cmp_le_i32 vcc, 9, v246
v_mov_b32 v244, 0xffff
s_nop 0
v_cndmask_b32 v22, v247, 0, vcc
v_cndmask_b32 v244, 0, v244, vcc
v_mov_b32 v29, v244
v_add_u32 v246, 10, v239
v_cmp_gt_u32 vcc, 8, v246
v_mov_b32 v244, 0xffff0000
s_nop 0
v_cndmask_b32 v27, v247, 0, vcc
v_cndmask_b32 v244, 0, v244, vcc
v_or_b32 v31, v31, v244
v_add_u32 v246, 3, v239
v_cmp_le_i32 vcc, 9, v246
v_mov_b32 v244, 0xffff0000
s_nop 0
v_cndmask_b32 v23, v247, 0, vcc
v_cndmask_b32 v244, 0, v244, vcc
v_or_b32 v29, v29, v244
s_and_b32 s36, s29, 3
s_or_b32 s36, s36, s28
s_cmp_eq_u32 s36, 0
s_cselect_b64 vcc, -1, 0
v_cndmask_b32 v76, v20, v247, vcc
v_cndmask_b32 v77, v21, v247, vcc
v_cndmask_b32 v78, v22, v247, vcc
v_cndmask_b32 v79, v23, v247, vcc
v_cndmask_b32 v80, v28, 0, vcc
v_cndmask_b32 v81, v29, 0, vcc
s_mov_b32 s36, 0x9e3779b1
s_waitcnt vmcnt(20)
v_mul_lo_u32 v15, v11, s36
v_add_u32 v15, 0x7f4a7c15, v15
s_and_b32 s36, s31, 1
s_lshl_b32 s36, s36, 4
s_add_u32 s36, s36, s32
s_lshl_b32 s36, s36, 2
s_add_u32 s92, s78, s36
s_add_u32 s92, s92, 0xc0000
s_lshl_b32 s36, s32, 2
s_add_u32 s93, s79, s36
s_add_u32 s93, s93, 0xc0080
s_and_b32 s94, s35, 15
s_lshl_b32 s94, s94, 9
s_lshr_b32 s36, s35, 4
s_lshl_b32 s36, s36, 2
s_add_u32 s94, s94, s36
s_add_u32 s94, s94, 0xc00c0
v_lshrrev_b32 v240, 1, v0
v_lshlrev_b32 v240, 13, v240
v_and_b32 v241, 1, v0
v_lshl_add_u32 v240, v241, 8, v240
s_mov_b32 vcc_lo, 0xffff
s_mov_b32 vcc_hi, 0
v_cndmask_b32 v240, 2.0, v240, vcc
v_lshlrev_b32 v241, 2, v0
v_add_u32 v248, 0, v248
v_add_u32 v249, 0, v249
s_add_u32 s96, s96, 0x600000
s_add_u32 s98, s98, 0x80000
s_add_u32 s97, s97, 0x600000
s_add_u32 s99, s99, 0x80000
s_cmp_eq_u32 s28, 1
s_cselect_b32 vcc_lo, 0xffff, 0
v_lshlrev_b32 v252, 12, v0
v_cndmask_b32 v252, 2.0, v252, vcc
v_cndmask_b32 v14, 2.0, v240, vcc
s_and_b32 s62, s35, 15
s_lshl_b32 s62, s62, 8
s_lshr_b32 s36, s35, 4
s_lshl_b32 s36, s36, 2
s_add_u32 s62, s62, s36
s_add_u32 s62, s62, 0xd0000
s_add_u32 s8, s94, 0x1ff40
v_and_b32 v255, 15, v0
v_lshlrev_b32 v255, 2, v255
s_waitcnt vmcnt(0)
s_barrier
s_cmp_lg_u32 s28, 1
s_cbranch_scc1 Lg1s_1
buffer_atomic_swap v15, v10, s[4:7], s92 offen sc1
buffer_atomic_swap v15, v10, s[4:7], s93 offen sc1
buffer_atomic_swap v15, v240, s[4:7], s94 offen sc1
buffer_atomic_swap v15, v252, s[4:7], s62 offen sc1
Lg1s_1:
s_branch L_aligned
.p2align 12
L_aligned:
s_mov_b64 s[20:21], s[76:77]
s_mov_b32 s22, 0x200000
s_add_u32 s89, s16, 0
buffer_load_dwordx4 a[220:223], v229, s[20:23], s89 offen nt
s_mov_b64 s[20:21], s[76:77]
s_mov_b32 s22, 0x200000
s_add_u32 s89, s16, 16384
buffer_load_dwordx4 a[224:227], v229, s[20:23], s89 offen nt
s_mov_b64 s[20:21], s[72:73]
s_mov_b32 s22, 0x600000
s_add_u32 s89, s17, 0
buffer_load_dwordx4 a[188:191], v228, s[20:23], s89 offen nt
s_mov_b64 s[20:21], s[72:73]
s_mov_b32 s22, 0x600000
s_add_u32 s89, s17, 49152
buffer_load_dwordx4 a[192:195], v228, s[20:23], s89 offen nt
s_mov_b64 s[20:21], s[72:73]
s_mov_b32 s22, 0x600000
s_add_u32 s89, s17, 2048
buffer_load_dwordx4 a[196:199], v228, s[20:23], s89 offen nt
s_mov_b64 s[20:21], s[72:73]
s_mov_b32 s22, 0x600000
s_add_u32 s89, s17, 51200
buffer_load_dwordx4 a[200:203], v228, s[20:23], s89 offen nt
s_mov_b64 s[20:21], s[72:73]
s_mov_b32 s22, 0x600000
s_add_u32 s89, s17, 4096
buffer_load_dwordx4 a[204:207], v228, s[20:23], s89 offen nt
s_mov_b64 s[20:21], s[72:73]
s_mov_b32 s22, 0x600000
s_add_u32 s89, s17, 53248
buffer_load_dwordx4 a[208:211], v228, s[20:23], s89 offen nt
s_add_u32 s89, s66, 0xd0000
ds_read_b64_tr_b16 a[240:241], v251 offset:0
ds_read_b64_tr_b16 a[242:243], v251 offset:1024
ds_read_b64_tr_b16 a[244:245], v251 offset:32
ds_read_b64_tr_b16 a[246:247], v251 offset:1056
s_lshl_b32 s36, s28, 11
v_add_u32 v231, s36, v1
s_waitcnt lgkmcnt(0)
v_add_u32 v231, 0, v231
v_cmp_eq_u32 vcc, 0, v0
s_nop 1
v_cndmask_b32 v251, 2.0, v0, vcc
s_mov_b64 exec, 0
s_cmp_eq_u32 s28, 3
s_cbranch_scc1 L_stub0
s_cmp_eq_u32 s28, 2
s_cbranch_scc1 L_stub1
s_cmp_eq_u32 s28, 1
s_cbranch_scc1 L_stub2
L_wret0:
s_mov_b64 exec, -1
s_cmp_lg_u32 s28, 0
s_cbranch_scc1 Lg1e_3
s_cmp_eq_u32 s54, 32
s_cselect_b32 s39, 0xffff0000, -1
s_mov_b32 s38, -1
s_add_u32 s36, s67, 0xc0000
s_mov_b32 s37, 0
Lg1p_2:
v_mov_b32 v11, 0
buffer_atomic_add v11, v241, s[4:7], s36 offen sc0 sc1
s_add_u32 s37, s37, 1
v_mov_b32 v242, v15
s_mov_b64 exec, 0xffff
v_mov_b32 v242, 0
buffer_atomic_add v242, v241, s[4:7], s89 offen sc0 sc1
s_mov_b64 exec, -1
s_waitcnt vmcnt(0)
v_cmp_ne_u32 vcc, v11, v15
v_cmp_ne_u32 s[52:53], v242, v15
s_and_b64 vcc, vcc, s[38:39]
s_or_b64 vcc, vcc, s[52:53]
s_cbranch_scc0 Lg1e_3
s_cmp_lt_u32 s37, 0x100000
s_cbranch_scc1 Lg1p_2
Lg1e_3:
s_barrier
s_add_u32 s94, s71, 0x80
s_add_u32 s9, s66, 0x80
s_add_u32 m0, s18, 0x0
s_add_u32 s44, s50, 0xe00000
buffer_load_dwordx4 v1, s[4:7], s44 offen offset:0 sc1 lds
buffer_load_dwordx4 v1, s[4:7], s44 offen offset:1024 sc1 lds
buffer_load_dwordx4 v1, s[4:7], s44 offen offset:2048 sc1 lds
s_add_u32 m0, s18, 0x3000
s_add_u32 s44, s50, 0xe03000
buffer_load_dwordx4 v1, s[4:7], s44 offen offset:0 sc1 lds
buffer_load_dwordx4 v1, s[4:7], s44 offen offset:1024 sc1 lds
buffer_load_dwordx4 v1, s[4:7], s44 offen offset:2048 sc1 lds
s_add_u32 m0, s18, 0x6000
s_add_u32 s44, s50, 0xe06000
buffer_load_dwordx4 v1, s[4:7], s44 offen offset:0 sc1 lds
buffer_load_dwordx4 v1, s[4:7], s44 offen offset:1024 sc1 lds
buffer_load_dwordx4 v1, s[4:7], s44 offen offset:2048 sc1 lds
s_add_u32 m0, s18, 0x9000
s_add_u32 s44, s50, 0xe09000
buffer_load_dwordx4 v1, s[4:7], s44 offen offset:0 sc1 lds
buffer_load_dwordx4 v1, s[4:7], s44 offen offset:1024 sc1 lds
buffer_load_dwordx4 v1, s[4:7], s44 offen offset:2048 sc1 lds
s_mov_b32 s35, 0
s_mov_b32 s33, 0x1000
buffer_load_dwordx4 a[0:3], v2, s[40:43], s35 offen offset:0 sc1
buffer_load_dwordx4 a[4:7], v2, s[40:43], s33 offen offset:0 sc1
buffer_load_dwordx4 a[8:11], v2, s[40:43], s35 offen offset:1024 sc1
buffer_load_dwordx4 a[12:15], v2, s[40:43], s33 offen offset:1024 sc1
buffer_load_dwordx4 a[16:19], v2, s[40:43], s35 offen offset:2048 sc1
buffer_load_dwordx4 a[20:23], v2, s[40:43], s33 offen offset:2048 sc1
buffer_load_dwordx4 a[24:27], v2, s[40:43], s35 offen offset:3072 sc1
buffer_load_dwordx4 a[28:31], v2, s[40:43], s33 offen offset:3072 sc1
s_add_u32 s35, s35, 8192
s_add_u32 s33, s33, 8192
s_add_u32 s63, s28, 0
s_lshl_b32 s63, s63, 12
buffer_load_dwordx4 a[160:163], v3, s[40:43], s63 offen sc1
buffer_load_dwordx4 a[32:35], v2, s[40:43], s35 offen offset:0 sc1
buffer_load_dwordx4 a[36:39], v2, s[40:43], s33 offen offset:0 sc1
buffer_load_dwordx4 a[40:43], v2, s[40:43], s35 offen offset:1024 sc1
buffer_load_dwordx4 a[44:47], v2, s[40:43], s33 offen offset:1024 sc1
buffer_load_dwordx4 a[48:51], v2, s[40:43], s35 offen offset:2048 sc1
buffer_load_dwordx4 a[52:55], v2, s[40:43], s33 offen offset:2048 sc1
buffer_load_dwordx4 a[56:59], v2, s[40:43], s35 offen offset:3072 sc1
buffer_load_dwordx4 a[60:63], v2, s[40:43], s33 offen offset:3072 sc1
s_add_u32 s35, s35, 8192
s_add_u32 s33, s33, 8192
s_waitcnt vmcnt(17)
s_barrier
v_add_u32 v5, 0, v1
v_add_u32 v6, s55, v5
ds_read_b128 a[96:99], v5 offset:2048
ds_read_b128 a[100:103], v5 offset:8192
ds_read_b128 a[104:107], v5 offset:3072
ds_read_b128 a[108:111], v5 offset:9216
ds_read_b128 a[112:115], v5 offset:4096
ds_read_b128 a[116:119], v5 offset:10240
ds_read_b128 a[120:123], v6 offset:2048
s_waitcnt vmcnt(15) lgkmcnt(5)
v_mfma_f32_16x16x32_bf16 v[140:143], a[96:99], a[0:3], 0
s_add_u32 m0, s18, 0xc000
s_add_u32 s44, s50, 0xe0c000
v_mfma_f32_16x16x32_bf16 v[140:143], a[100:103], a[4:7], v[140:143]
buffer_load_dwordx4 a[64:67], v2, s[40:43], s35 offen offset:0 sc1
s_waitcnt vmcnt(14)
v_mfma_f32_16x16x32_bf16 v[164:167], a[100:103], a[12:15], 0
ds_read_b128 a[128:131], v5 offset:5120
v_mfma_f32_16x16x32_bf16 v[164:167], a[96:99], a[8:11], v[164:167]
ds_read_b128 a[132:135], v5 offset:11264
s_waitcnt vmcnt(13)
v_mfma_f32_16x16x32_bf16 v[188:191], a[96:99], a[16:19], 0
ds_read_b128 a[136:139], v5 offset:0
s_waitcnt vmcnt(12)
v_mfma_f32_16x16x32_bf16 v[188:191], a[100:103], a[20:23], v[188:191]
buffer_load_dwordx4 v1, s[4:7], s44 offen offset:0 sc1 lds
s_add_u32 s63, s28, 4
s_waitcnt vmcnt(11)
v_mfma_f32_16x16x32_bf16 v[212:215], a[100:103], a[28:31], 0
s_lshl_b32 s63, s63, 12
ds_read_b128 a[140:143], v5 offset:6144
v_mfma_f32_16x16x32_bf16 v[212:215], a[96:99], a[24:27], v[212:215]
s_waitcnt lgkmcnt(8)
v_mfma_f32_16x16x32_bf16 v[216:219], a[104:107], a[24:27], 0
s_waitcnt lgkmcnt(7)
v_mfma_f32_16x16x32_bf16 v[216:219], a[108:111], a[28:31], v[216:219]
buffer_load_dwordx4 a[68:71], v2, s[40:43], s33 offen offset:0 sc1
v_mfma_f32_16x16x32_bf16 v[192:195], a[108:111], a[20:23], 0
ds_read_b128 a[144:147], v5 offset:1024
v_mfma_f32_16x16x32_bf16 v[192:195], a[104:107], a[16:19], v[192:195]
ds_read_b128 a[148:151], v5 offset:7168
v_mfma_f32_16x16x32_bf16 v[168:171], a[104:107], a[8:11], 0
v_mfma_f32_16x16x32_bf16 v[168:171], a[108:111], a[12:15], v[168:171]
buffer_load_dwordx4 a[72:75], v2, s[40:43], s35 offen offset:1024 sc1
v_mfma_f32_16x16x32_bf16 v[144:147], a[108:111], a[4:7], 0
ds_read_b128 a[152:155], v6 offset:3072
v_mfma_f32_16x16x32_bf16 v[144:147], a[104:107], a[0:3], v[144:147]
s_waitcnt lgkmcnt(9)
v_mfma_f32_16x16x32_bf16 v[148:151], a[112:115], a[0:3], 0
s_waitcnt lgkmcnt(8)
v_mfma_f32_16x16x32_bf16 v[148:151], a[116:119], a[4:7], v[148:151]
buffer_load_dwordx4 a[164:167], v3, s[40:43], s63 offen sc1
v_mfma_f32_16x16x32_bf16 v[172:175], a[116:119], a[12:15], 0
v_mfma_f32_16x16x32_bf16 v[172:175], a[112:115], a[8:11], v[172:175]
v_mfma_f32_16x16x32_bf16 v[196:199], a[112:115], a[16:19], 0
v_mfma_f32_16x16x32_bf16 v[196:199], a[116:119], a[20:23], v[196:199]
buffer_load_dwordx4 a[76:79], v2, s[40:43], s33 offen offset:1024 sc1
v_mfma_f32_16x16x32_bf16 v[220:223], a[116:119], a[28:31], 0
v_mfma_f32_16x16x32_bf16 v[220:223], a[112:115], a[24:27], v[220:223]
s_waitcnt vmcnt(14) lgkmcnt(7)
v_mfma_f32_16x16x32_bf16 a[172:175], a[120:123], a[160:163], 0
s_waitcnt lgkmcnt(0)
v_mfma_f32_16x16x32_bf16 v[224:227], a[128:131], a[24:27], 0
ds_read_b128 a[96:99], v5 offset:14336
v_mfma_f32_16x16x32_bf16 v[224:227], a[132:135], a[28:31], v[224:227]
buffer_load_dwordx4 a[80:83], v2, s[40:43], s35 offen offset:2048 sc1
v_mfma_f32_16x16x32_bf16 v[200:203], a[132:135], a[20:23], 0
ds_read_b128 a[100:103], v5 offset:20480
v_mfma_f32_16x16x32_bf16 v[200:203], a[128:131], a[16:19], v[200:203]
v_mfma_f32_16x16x32_bf16 v[176:179], a[128:131], a[8:11], 0
buffer_load_dwordx4 v1, s[4:7], s44 offen offset:1024 sc1 lds
v_mfma_f32_16x16x32_bf16 v[176:179], a[132:135], a[12:15], v[176:179]
ds_read_b128 a[104:107], v5 offset:15360
v_mfma_f32_16x16x32_bf16 v[152:155], a[132:135], a[4:7], 0
ds_read_b128 a[108:111], v5 offset:21504
v_mfma_f32_16x16x32_bf16 v[152:155], a[128:131], a[0:3], v[152:155]
v_mfma_f32_16x16x32_bf16 v[132:135], a[136:139], a[0:3], 0
buffer_load_dwordx4 a[84:87], v2, s[40:43], s33 offen offset:2048 sc1
v_mfma_f32_16x16x32_bf16 v[132:135], a[140:143], a[4:7], v[132:135]
ds_read_b128 a[112:115], v5 offset:16384
v_mfma_f32_16x16x32_bf16 v[156:159], a[140:143], a[12:15], 0
v_mfma_f32_16x16x32_bf16 v[156:159], a[136:139], a[8:11], v[156:159]
buffer_load_dwordx4 v1, s[4:7], s44 offen offset:2048 sc1 lds
s_add_u32 m0, s18, 0xf000
v_mfma_f32_16x16x32_bf16 v[180:183], a[136:139], a[16:19], 0
s_add_u32 s44, s50, 0xe0f000
ds_read_b128 a[116:119], v5 offset:22528
v_mfma_f32_16x16x32_bf16 v[180:183], a[140:143], a[20:23], v[180:183]
ds_read_b128 a[120:123], v6 offset:4096
v_mfma_f32_16x16x32_bf16 v[204:207], a[140:143], a[28:31], 0
v_mfma_f32_16x16x32_bf16 v[204:207], a[136:139], a[24:27], v[204:207]
buffer_load_dwordx4 a[88:91], v2, s[40:43], s35 offen offset:3072 sc1
v_mfma_f32_16x16x32_bf16 v[208:211], a[144:147], a[24:27], 0
v_mfma_f32_16x16x32_bf16 v[208:211], a[148:151], a[28:31], v[208:211]
v_mfma_f32_16x16x32_bf16 v[184:187], a[148:151], a[20:23], 0
buffer_load_dwordx4 v1, s[4:7], s44 offen offset:0 sc1 lds
v_mfma_f32_16x16x32_bf16 v[184:187], a[144:147], a[16:19], v[184:187]
v_mfma_f32_16x16x32_bf16 v[160:163], a[144:147], a[8:11], 0
v_mfma_f32_16x16x32_bf16 v[160:163], a[148:151], a[12:15], v[160:163]
v_mfma_f32_16x16x32_bf16 v[136:139], a[148:151], a[4:7], 0
buffer_load_dwordx4 a[92:95], v2, s[40:43], s33 offen offset:3072 sc1
s_add_u32 s35, s35, 8192
v_mfma_f32_16x16x32_bf16 v[136:139], a[144:147], a[0:3], v[136:139]
s_add_u32 s33, s33, 8192
v_mfma_f32_16x16x32_bf16 a[176:179], a[152:155], a[160:163], 0
s_waitcnt vmcnt(13) lgkmcnt(0)
v_mfma_f32_16x16x32_bf16 v[140:143], a[96:99], a[32:35], v[140:143]
ds_read_b128 a[128:131], v5 offset:17408
v_mfma_f32_16x16x32_bf16 v[140:143], a[100:103], a[36:39], v[140:143]
buffer_load_dwordx4 a[0:3], v2, s[40:43], s35 offen offset:0 sc1
v_mfma_f32_16x16x32_bf16 v[164:167], a[100:103], a[44:47], v[164:167]
ds_read_b128 a[132:135], v5 offset:23552
v_mfma_f32_16x16x32_bf16 v[164:167], a[96:99], a[40:43], v[164:167]
v_mfma_f32_16x16x32_bf16 v[188:191], a[96:99], a[48:51], v[188:191]
ds_read_b128 a[136:139], v5 offset:12288
v_mfma_f32_16x16x32_bf16 v[188:191], a[100:103], a[52:55], v[188:191]
buffer_load_dwordx4 v1, s[4:7], s44 offen offset:1024 sc1 lds
v_mfma_f32_16x16x32_bf16 v[212:215], a[100:103], a[60:63], v[212:215]
ds_read_b128 a[140:143], v5 offset:18432
v_mfma_f32_16x16x32_bf16 v[212:215], a[96:99], a[56:59], v[212:215]
v_mfma_f32_16x16x32_bf16 v[216:219], a[104:107], a[56:59], v[216:219]
v_mfma_f32_16x16x32_bf16 v[216:219], a[108:111], a[60:63], v[216:219]
buffer_load_dwordx4 a[4:7], v2, s[40:43], s33 offen offset:0 sc1
v_mfma_f32_16x16x32_bf16 v[192:195], a[108:111], a[52:55], v[192:195]
ds_read_b128 a[144:147], v5 offset:13312
v_mfma_f32_16x16x32_bf16 v[192:195], a[104:107], a[48:51], v[192:195]
ds_read_b128 a[148:151], v5 offset:19456
v_mfma_f32_16x16x32_bf16 v[168:171], a[104:107], a[40:43], v[168:171]
v_mfma_f32_16x16x32_bf16 v[168:171], a[108:111], a[44:47], v[168:171]
buffer_load_dwordx4 a[8:11], v2, s[40:43], s35 offen offset:1024 sc1
v_mfma_f32_16x16x32_bf16 v[144:147], a[108:111], a[36:39], v[144:147]
ds_read_b128 a[152:155], v6 offset:5120
v_mfma_f32_16x16x32_bf16 v[144:147], a[104:107], a[32:35], v[144:147]
v_mfma_f32_16x16x32_bf16 v[148:151], a[112:115], a[32:35], v[148:151]
v_mfma_f32_16x16x32_bf16 v[148:151], a[116:119], a[36:39], v[148:151]
buffer_load_dwordx4 v1, s[4:7], s44 offen offset:2048 sc1 lds
s_add_u32 m0, s18, 0x12000
v_mfma_f32_16x16x32_bf16 v[172:175], a[116:119], a[44:47], v[172:175]
s_add_u32 s44, s50, 0xe12000
v_mfma_f32_16x16x32_bf16 v[172:175], a[112:115], a[40:43], v[172:175]
v_mfma_f32_16x16x32_bf16 v[196:199], a[112:115], a[48:51], v[196:199]
v_mfma_f32_16x16x32_bf16 v[196:199], a[116:119], a[52:55], v[196:199]
buffer_load_dwordx4 a[12:15], v2, s[40:43], s33 offen offset:1024 sc1
v_mfma_f32_16x16x32_bf16 v[220:223], a[116:119], a[60:63], v[220:223]
v_mfma_f32_16x16x32_bf16 v[220:223], a[112:115], a[56:59], v[220:223]
v_mfma_f32_16x16x32_bf16 a[180:183], a[120:123], a[160:163], 0
s_waitcnt lgkmcnt(0)
v_mfma_f32_16x16x32_bf16 v[224:227], a[128:131], a[56:59], v[224:227]
ds_read_b128 a[96:99], v5 offset:26624
v_mfma_f32_16x16x32_bf16 v[224:227], a[132:135], a[60:63], v[224:227]
buffer_load_dwordx4 a[16:19], v2, s[40:43], s35 offen offset:2048 sc1
v_mfma_f32_16x16x32_bf16 v[200:203], a[132:135], a[52:55], v[200:203]
ds_read_b128 a[100:103], v5 offset:32768
v_mfma_f32_16x16x32_bf16 v[200:203], a[128:131], a[48:51], v[200:203]
v_mfma_f32_16x16x32_bf16 v[176:179], a[128:131], a[40:43], v[176:179]
buffer_load_dwordx4 v1, s[4:7], s44 offen offset:0 sc1 lds
v_mfma_f32_16x16x32_bf16 v[176:179], a[132:135], a[44:47], v[176:179]
ds_read_b128 a[104:107], v5 offset:27648
v_mfma_f32_16x16x32_bf16 v[152:155], a[132:135], a[36:39], v[152:155]
ds_read_b128 a[108:111], v5 offset:33792
v_mfma_f32_16x16x32_bf16 v[152:155], a[128:131], a[32:35], v[152:155]
v_mfma_f32_16x16x32_bf16 v[132:135], a[136:139], a[32:35], v[132:135]
buffer_load_dwordx4 a[20:23], v2, s[40:43], s33 offen offset:2048 sc1
v_mfma_f32_16x16x32_bf16 v[132:135], a[140:143], a[36:39], v[132:135]
ds_read_b128 a[112:115], v5 offset:28672
v_mfma_f32_16x16x32_bf16 v[156:159], a[140:143], a[44:47], v[156:159]
v_mfma_f32_16x16x32_bf16 v[156:159], a[136:139], a[40:43], v[156:159]
buffer_load_dwordx4 v1, s[4:7], s44 offen offset:1024 sc1 lds
v_mfma_f32_16x16x32_bf16 v[180:183], a[136:139], a[48:51], v[180:183]
ds_read_b128 a[116:119], v5 offset:34816
v_mfma_f32_16x16x32_bf16 v[180:183], a[140:143], a[52:55], v[180:183]
ds_read_b128 a[120:123], v6 offset:26624
v_mfma_f32_16x16x32_bf16 v[204:207], a[140:143], a[60:63], v[204:207]
v_mfma_f32_16x16x32_bf16 v[204:207], a[136:139], a[56:59], v[204:207]
buffer_load_dwordx4 a[24:27], v2, s[40:43], s35 offen offset:3072 sc1
v_mfma_f32_16x16x32_bf16 v[208:211], a[144:147], a[56:59], v[208:211]
v_mfma_f32_16x16x32_bf16 v[208:211], a[148:151], a[60:63], v[208:211]
v_mfma_f32_16x16x32_bf16 v[184:187], a[148:151], a[52:55], v[184:187]
buffer_load_dwordx4 v1, s[4:7], s44 offen offset:2048 sc1 lds
s_add_u32 m0, s18, 0x15000
v_mfma_f32_16x16x32_bf16 v[184:187], a[144:147], a[48:51], v[184:187]
s_add_u32 s44, s50, 0xe15000
v_mfma_f32_16x16x32_bf16 v[160:163], a[144:147], a[40:43], v[160:163]
v_mfma_f32_16x16x32_bf16 v[160:163], a[148:151], a[44:47], v[160:163]
v_mfma_f32_16x16x32_bf16 v[136:139], a[148:151], a[36:39], v[136:139]
buffer_load_dwordx4 a[28:31], v2, s[40:43], s33 offen offset:3072 sc1
s_add_u32 s35, s35, 8192
v_mfma_f32_16x16x32_bf16 v[136:139], a[144:147], a[32:35], v[136:139]
s_add_u32 s33, s33, 8192
v_mfma_f32_16x16x32_bf16 a[184:187], a[152:155], a[160:163], 0
s_waitcnt vmcnt(13) lgkmcnt(0)
v_mfma_f32_16x16x32_bf16 v[140:143], a[96:99], a[64:67], v[140:143]
ds_read_b128 a[128:131], v5 offset:29696
v_mfma_f32_16x16x32_bf16 v[140:143], a[100:103], a[68:71], v[140:143]
buffer_load_dwordx4 a[32:35], v2, s[40:43], s35 offen offset:0 sc1
v_mfma_f32_16x16x32_bf16 v[164:167], a[100:103], a[76:79], v[164:167]
ds_read_b128 a[132:135], v5 offset:35840
v_mfma_f32_16x16x32_bf16 v[164:167], a[96:99], a[72:75], v[164:167]
v_mfma_f32_16x16x32_bf16 v[188:191], a[96:99], a[80:83], v[188:191]
ds_read_b128 a[136:139], v5 offset:24576
v_mfma_f32_16x16x32_bf16 v[188:191], a[100:103], a[84:87], v[188:191]
buffer_load_dwordx4 v1, s[4:7], s44 offen offset:0 sc1 lds
s_add_u32 s63, s28, 8
v_mfma_f32_16x16x32_bf16 v[212:215], a[100:103], a[92:95], v[212:215]
s_lshl_b32 s63, s63, 12
ds_read_b128 a[140:143], v5 offset:30720
v_mfma_f32_16x16x32_bf16 v[212:215], a[96:99], a[88:91], v[212:215]
v_mfma_f32_16x16x32_bf16 v[216:219], a[104:107], a[88:91], v[216:219]
v_mfma_f32_16x16x32_bf16 v[216:219], a[108:111], a[92:95], v[216:219]
buffer_load_dwordx4 a[36:39], v2, s[40:43], s33 offen offset:0 sc1
v_mfma_f32_16x16x32_bf16 v[192:195], a[108:111], a[84:87], v[192:195]
ds_read_b128 a[144:147], v5 offset:25600
v_mfma_f32_16x16x32_bf16 v[192:195], a[104:107], a[80:83], v[192:195]
ds_read_b128 a[148:151], v5 offset:31744
v_mfma_f32_16x16x32_bf16 v[168:171], a[104:107], a[72:75], v[168:171]
v_mfma_f32_16x16x32_bf16 v[168:171], a[108:111], a[76:79], v[168:171]
buffer_load_dwordx4 a[40:43], v2, s[40:43], s35 offen offset:1024 sc1
v_mfma_f32_16x16x32_bf16 v[144:147], a[108:111], a[68:71], v[144:147]
ds_read_b128 a[152:155], v6 offset:27648
v_mfma_f32_16x16x32_bf16 v[144:147], a[104:107], a[64:67], v[144:147]
v_mfma_f32_16x16x32_bf16 v[148:151], a[112:115], a[64:67], v[148:151]
v_mfma_f32_16x16x32_bf16 v[148:151], a[116:119], a[68:71], v[148:151]
buffer_load_dwordx4 a[168:171], v3, s[40:43], s63 offen sc1
v_mfma_f32_16x16x32_bf16 v[172:175], a[116:119], a[76:79], v[172:175]
v_mfma_f32_16x16x32_bf16 v[172:175], a[112:115], a[72:75], v[172:175]
v_mfma_f32_16x16x32_bf16 v[196:199], a[112:115], a[80:83], v[196:199]
v_mfma_f32_16x16x32_bf16 v[196:199], a[116:119], a[84:87], v[196:199]
buffer_load_dwordx4 a[44:47], v2, s[40:43], s33 offen offset:1024 sc1
v_mfma_f32_16x16x32_bf16 v[220:223], a[116:119], a[92:95], v[220:223]
v_mfma_f32_16x16x32_bf16 v[220:223], a[112:115], a[88:91], v[220:223]
v_mfma_f32_16x16x32_bf16 a[172:175], a[120:123], a[164:167], a[172:175]
s_waitcnt lgkmcnt(0)
v_mfma_f32_16x16x32_bf16 v[224:227], a[128:131], a[88:91], v[224:227]
ds_read_b128 a[96:99], v5 offset:38912
v_mfma_f32_16x16x32_bf16 v[224:227], a[132:135], a[92:95], v[224:227]
buffer_load_dwordx4 a[48:51], v2, s[40:43], s35 offen offset:2048 sc1
v_mfma_f32_16x16x32_bf16 v[200:203], a[132:135], a[84:87], v[200:203]
ds_read_b128 a[100:103], v5 offset:45056
v_mfma_f32_16x16x32_bf16 v[200:203], a[128:131], a[80:83], v[200:203]
v_mfma_f32_16x16x32_bf16 v[176:179], a[128:131], a[72:75], v[176:179]
buffer_load_dwordx4 v1, s[4:7], s44 offen offset:1024 sc1 lds
v_mfma_f32_16x16x32_bf16 v[176:179], a[132:135], a[76:79], v[176:179]
ds_read_b128 a[104:107], v5 offset:39936
v_mfma_f32_16x16x32_bf16 v[152:155], a[132:135], a[68:71], v[152:155]
ds_read_b128 a[108:111], v5 offset:46080
v_mfma_f32_16x16x32_bf16 v[152:155], a[128:131], a[64:67], v[152:155]
v_mfma_f32_16x16x32_bf16 v[132:135], a[136:139], a[64:67], v[132:135]
buffer_load_dwordx4 a[52:55], v2, s[40:43], s33 offen offset:2048 sc1
v_mfma_f32_16x16x32_bf16 v[132:135], a[140:143], a[68:71], v[132:135]
ds_read_b128 a[112:115], v5 offset:40960
v_mfma_f32_16x16x32_bf16 v[156:159], a[140:143], a[76:79], v[156:159]
v_mfma_f32_16x16x32_bf16 v[156:159], a[136:139], a[72:75], v[156:159]
buffer_load_dwordx4 v1, s[4:7], s44 offen offset:2048 sc1 lds
v_mfma_f32_16x16x32_bf16 v[180:183], a[136:139], a[80:83], v[180:183]
v_and_b32 v232, 15, v0
v_lshlrev_b32 v232, 7, v232
v_mfma_f32_16x16x32_bf16 v[180:183], a[140:143], a[84:87], v[180:183]
v_lshrrev_b32 v233, 4, v0
v_lshlrev_b32 v233, 4, v233
v_mfma_f32_16x16x32_bf16 v[204:207], a[140:143], a[92:95], v[204:207]
v_add_u32 v232, v233, v232
s_mul_i32 s38, s30, 12288
v_mfma_f32_16x16x32_bf16 v[204:207], a[136:139], a[88:91], v[204:207]
buffer_load_dwordx4 a[56:59], v2, s[40:43], s35 offen offset:3072 sc1
s_add_u32 s38, s38, 0x300000
v_mfma_f32_16x16x32_bf16 v[208:211], a[144:147], a[88:91], v[208:211]
s_add_u32 s39, s28, 4
s_min_u32 s39, s39, 5
s_lshl_b32 s36, s28, 11
v_mfma_f32_16x16x32_bf16 v[208:211], a[148:151], a[92:95], v[208:211]
s_add_u32 s36, s36, s38
s_lshl_b32 s37, s39, 11
s_add_u32 s37, s37, s38
v_mfma_f32_16x16x32_bf16 v[184:187], a[148:151], a[84:87], v[184:187]
buffer_load_dwordx4 v[48:51], v232, s[4:7], s36 offen sc1
v_mfma_f32_16x16x32_bf16 v[184:187], a[144:147], a[80:83], v[184:187]
ds_read_b128 a[116:119], v5 offset:47104
v_mfma_f32_16x16x32_bf16 v[160:163], a[144:147], a[72:75], v[160:163]
ds_read_b128 a[120:123], v6 offset:28672
v_mfma_f32_16x16x32_bf16 v[160:163], a[148:151], a[76:79], v[160:163]
v_mfma_f32_16x16x32_bf16 v[136:139], a[148:151], a[68:71], v[136:139]
buffer_load_dwordx4 a[60:63], v2, s[40:43], s33 offen offset:3072 sc1
s_add_u32 s35, s35, 8192
v_mfma_f32_16x16x32_bf16 v[136:139], a[144:147], a[64:67], v[136:139]
s_add_u32 s33, s33, 8192
v_mfma_f32_16x16x32_bf16 a[176:179], a[152:155], a[164:167], a[176:179]
s_waitcnt vmcnt(13) lgkmcnt(0)
v_mfma_f32_16x16x32_bf16 v[140:143], a[96:99], a[0:3], v[140:143]
ds_read_b128 a[128:131], v5 offset:41984
v_mfma_f32_16x16x32_bf16 v[140:143], a[100:103], a[4:7], v[140:143]
buffer_load_dwordx4 a[64:67], v2, s[40:43], s35 offen offset:0 sc1
v_mfma_f32_16x16x32_bf16 v[164:167], a[100:103], a[12:15], v[164:167]
ds_read_b128 a[132:135], v5 offset:48128
v_mfma_f32_16x16x32_bf16 v[164:167], a[96:99], a[8:11], v[164:167]
v_mfma_f32_16x16x32_bf16 v[188:191], a[96:99], a[16:19], v[188:191]
ds_read_b128 a[136:139], v5 offset:36864
v_mfma_f32_16x16x32_bf16 v[188:191], a[100:103], a[20:23], v[188:191]
buffer_load_dwordx4 v[52:55], v232, s[4:7], s37 offen sc1
s_add_u32 m0, s18, 0x18000
v_mfma_f32_16x16x32_bf16 v[212:215], a[100:103], a[28:31], v[212:215]
s_add_u32 s44, s50, 0xe18000
ds_read_b128 a[140:143], v5 offset:43008
v_mfma_f32_16x16x32_bf16 v[212:215], a[96:99], a[24:27], v[212:215]
v_mfma_f32_16x16x32_bf16 v[216:219], a[104:107], a[24:27], v[216:219]
v_mfma_f32_16x16x32_bf16 v[216:219], a[108:111], a[28:31], v[216:219]
buffer_load_dwordx4 a[68:71], v2, s[40:43], s33 offen offset:0 sc1
v_mfma_f32_16x16x32_bf16 v[192:195], a[108:111], a[20:23], v[192:195]
ds_read_b128 a[144:147], v5 offset:37888
v_mfma_f32_16x16x32_bf16 v[192:195], a[104:107], a[16:19], v[192:195]
ds_read_b128 a[148:151], v5 offset:44032
v_mfma_f32_16x16x32_bf16 v[168:171], a[104:107], a[8:11], v[168:171]
v_mfma_f32_16x16x32_bf16 v[168:171], a[108:111], a[12:15], v[168:171]
buffer_load_dwordx4 a[72:75], v2, s[40:43], s35 offen offset:1024 sc1
v_mfma_f32_16x16x32_bf16 v[144:147], a[108:111], a[4:7], v[144:147]
ds_read_b128 a[152:155], v6 offset:29696
v_mfma_f32_16x16x32_bf16 v[144:147], a[104:107], a[0:3], v[144:147]
v_mfma_f32_16x16x32_bf16 v[148:151], a[112:115], a[0:3], v[148:151]
v_mfma_f32_16x16x32_bf16 v[148:151], a[116:119], a[4:7], v[148:151]
buffer_load_dwordx4 v1, s[4:7], s44 offen offset:0 sc1 lds
v_mfma_f32_16x16x32_bf16 v[172:175], a[116:119], a[12:15], v[172:175]
v_mfma_f32_16x16x32_bf16 v[172:175], a[112:115], a[8:11], v[172:175]
v_mfma_f32_16x16x32_bf16 v[196:199], a[112:115], a[16:19], v[196:199]
v_mfma_f32_16x16x32_bf16 v[196:199], a[116:119], a[20:23], v[196:199]
buffer_load_dwordx4 a[76:79], v2, s[40:43], s33 offen offset:1024 sc1
v_mfma_f32_16x16x32_bf16 v[220:223], a[116:119], a[28:31], v[220:223]
v_mfma_f32_16x16x32_bf16 v[220:223], a[112:115], a[24:27], v[220:223]
v_mfma_f32_16x16x32_bf16 a[180:183], a[120:123], a[164:167], a[180:183]
s_waitcnt lgkmcnt(0)
s_barrier
v_mfma_f32_16x16x32_bf16 v[224:227], a[128:131], a[24:27], v[224:227]
v_add_u32 v5, 49152, v1
v_add_u32 v6, s55, v5
v_mfma_f32_16x16x32_bf16 v[224:227], a[132:135], a[28:31], v[224:227]
buffer_load_dwordx4 a[80:83], v2, s[40:43], s35 offen offset:2048 sc1
v_mfma_f32_16x16x32_bf16 v[200:203], a[132:135], a[20:23], v[200:203]
ds_read_b128 a[96:99], v5 offset:2048
v_mfma_f32_16x16x32_bf16 v[200:203], a[128:131], a[16:19], v[200:203]
ds_read_b128 a[100:103], v5 offset:8192
v_mfma_f32_16x16x32_bf16 v[176:179], a[128:131], a[8:11], v[176:179]
buffer_load_dwordx4 v1, s[4:7], s44 offen offset:1024 sc1 lds
v_mfma_f32_16x16x32_bf16 v[176:179], a[132:135], a[12:15], v[176:179]
ds_read_b128 a[104:107], v5 offset:3072
v_mfma_f32_16x16x32_bf16 v[152:155], a[132:135], a[4:7], v[152:155]
ds_read_b128 a[108:111], v5 offset:9216
v_mfma_f32_16x16x32_bf16 v[152:155], a[128:131], a[0:3], v[152:155]
ds_write_b128 v231, a[220:223] offset:24576
v_mfma_f32_16x16x32_bf16 v[132:135], a[136:139], a[0:3], v[132:135]
buffer_load_dwordx4 a[84:87], v2, s[40:43], s33 offen offset:2048 sc1
v_mfma_f32_16x16x32_bf16 v[132:135], a[140:143], a[4:7], v[132:135]
ds_read_b128 a[112:115], v5 offset:4096
v_mfma_f32_16x16x32_bf16 v[156:159], a[140:143], a[12:15], v[156:159]
v_mfma_f32_16x16x32_bf16 v[156:159], a[136:139], a[8:11], v[156:159]
buffer_load_dwordx4 v1, s[4:7], s44 offen offset:2048 sc1 lds
s_add_u32 m0, s18, 0x1b000
v_mfma_f32_16x16x32_bf16 v[180:183], a[136:139], a[16:19], v[180:183]
s_add_u32 s44, s50, 0xe1b000
ds_read_b128 a[116:119], v5 offset:10240
v_mfma_f32_16x16x32_bf16 v[180:183], a[140:143], a[20:23], v[180:183]
ds_read_b128 a[120:123], v6 offset:2048
v_mfma_f32_16x16x32_bf16 v[204:207], a[140:143], a[28:31], v[204:207]
ds_write_b128 v231, a[224:227] offset:25600
v_mfma_f32_16x16x32_bf16 v[204:207], a[136:139], a[24:27], v[204:207]
buffer_load_dwordx4 a[88:91], v2, s[40:43], s35 offen offset:3072 sc1
v_mfma_f32_16x16x32_bf16 v[208:211], a[144:147], a[24:27], v[208:211]
v_mfma_f32_16x16x32_bf16 v[208:211], a[148:151], a[28:31], v[208:211]
v_mfma_f32_16x16x32_bf16 v[184:187], a[148:151], a[20:23], v[184:187]
buffer_load_dwordx4 v1, s[4:7], s44 offen offset:0 sc1 lds
v_mfma_f32_16x16x32_bf16 v[184:187], a[144:147], a[16:19], v[184:187]
v_mfma_f32_16x16x32_bf16 v[160:163], a[144:147], a[8:11], v[160:163]
v_mfma_f32_16x16x32_bf16 v[160:163], a[148:151], a[12:15], v[160:163]
v_mfma_f32_16x16x32_bf16 v[136:139], a[148:151], a[4:7], v[136:139]
buffer_load_dwordx4 a[92:95], v2, s[40:43], s33 offen offset:3072 sc1
s_add_u32 s35, s35, 8192
v_mfma_f32_16x16x32_bf16 v[136:139], a[144:147], a[0:3], v[136:139]
s_add_u32 s33, s33, 8192
ds_write_b128 v231, a[188:191] offset:0
v_mfma_f32_16x16x32_bf16 a[184:187], a[152:155], a[164:167], a[184:187]
s_waitcnt vmcnt(13) lgkmcnt(2)
v_mfma_f32_16x16x32_bf16 v[140:143], a[96:99], a[32:35], v[140:143]
ds_read_b128 a[128:131], v5 offset:5120
v_mfma_f32_16x16x32_bf16 v[140:143], a[100:103], a[36:39], v[140:143]
buffer_load_dwordx4 a[0:3], v2, s[40:43], s35 offen offset:0 sc1
v_mfma_f32_16x16x32_bf16 v[164:167], a[100:103], a[44:47], v[164:167]
ds_read_b128 a[132:135], v5 offset:11264
v_mfma_f32_16x16x32_bf16 v[164:167], a[96:99], a[40:43], v[164:167]
v_mfma_f32_16x16x32_bf16 v[188:191], a[96:99], a[48:51], v[188:191]
ds_read_b128 a[136:139], v5 offset:0
v_mfma_f32_16x16x32_bf16 v[188:191], a[100:103], a[52:55], v[188:191]
buffer_load_dwordx4 v1, s[4:7], s44 offen offset:1024 sc1 lds
s_add_u32 s63, s28, 12
v_mfma_f32_16x16x32_bf16 v[212:215], a[100:103], a[60:63], v[212:215]
s_lshl_b32 s63, s63, 12
ds_read_b128 a[140:143], v5 offset:6144
v_mfma_f32_16x16x32_bf16 v[212:215], a[96:99], a[56:59], v[212:215]
v_mfma_f32_16x16x32_bf16 v[216:219], a[104:107], a[56:59], v[216:219]
ds_write_b128 v231, a[192:195] offset:1024
v_mfma_f32_16x16x32_bf16 v[216:219], a[108:111], a[60:63], v[216:219]
buffer_load_dwordx4 a[4:7], v2, s[40:43], s33 offen offset:0 sc1
v_mfma_f32_16x16x32_bf16 v[192:195], a[108:111], a[52:55], v[192:195]
ds_read_b128 a[144:147], v5 offset:1024
v_mfma_f32_16x16x32_bf16 v[192:195], a[104:107], a[48:51], v[192:195]
ds_read_b128 a[148:151], v5 offset:7168
v_mfma_f32_16x16x32_bf16 v[168:171], a[104:107], a[40:43], v[168:171]
v_mfma_f32_16x16x32_bf16 v[168:171], a[108:111], a[44:47], v[168:171]
buffer_load_dwordx4 a[8:11], v2, s[40:43], s35 offen offset:1024 sc1
v_mfma_f32_16x16x32_bf16 v[144:147], a[108:111], a[36:39], v[144:147]
ds_read_b128 a[152:155], v6 offset:3072
v_mfma_f32_16x16x32_bf16 v[144:147], a[104:107], a[32:35], v[144:147]
v_mfma_f32_16x16x32_bf16 v[148:151], a[112:115], a[32:35], v[148:151]
v_mfma_f32_16x16x32_bf16 v[148:151], a[116:119], a[36:39], v[148:151]
buffer_load_dwordx4 a[160:163], v3, s[40:43], s63 offen sc1
v_mfma_f32_16x16x32_bf16 v[172:175], a[116:119], a[44:47], v[172:175]
v_mfma_f32_16x16x32_bf16 v[172:175], a[112:115], a[40:43], v[172:175]
ds_write_b128 v231, a[196:199] offset:8192
v_mfma_f32_16x16x32_bf16 v[196:199], a[112:115], a[48:51], v[196:199]
v_mfma_f32_16x16x32_bf16 v[196:199], a[116:119], a[52:55], v[196:199]
buffer_load_dwordx4 a[12:15], v2, s[40:43], s33 offen offset:1024 sc1
v_mfma_f32_16x16x32_bf16 v[220:223], a[116:119], a[60:63], v[220:223]
v_mfma_f32_16x16x32_bf16 v[220:223], a[112:115], a[56:59], v[220:223]
v_mfma_f32_16x16x32_bf16 a[172:175], a[120:123], a[168:171], a[172:175]
s_waitcnt lgkmcnt(1)
v_mfma_f32_16x16x32_bf16 v[224:227], a[128:131], a[56:59], v[224:227]
ds_read_b128 a[96:99], v5 offset:14336
v_mfma_f32_16x16x32_bf16 v[224:227], a[132:135], a[60:63], v[224:227]
buffer_load_dwordx4 a[16:19], v2, s[40:43], s35 offen offset:2048 sc1
v_mfma_f32_16x16x32_bf16 v[200:203], a[132:135], a[52:55], v[200:203]
ds_read_b128 a[100:103], v5 offset:20480
v_mfma_f32_16x16x32_bf16 v[200:203], a[128:131], a[48:51], v[200:203]
v_mfma_f32_16x16x32_bf16 v[176:179], a[128:131], a[40:43], v[176:179]
buffer_load_dwordx4 v1, s[4:7], s44 offen offset:2048 sc1 lds
s_add_u32 s88, s82, 0x200000
L_stub0:
s_cbranch_execz L_wret0
v_mfma_f32_16x16x32_bf16 v[176:179], a[132:135], a[44:47], v[176:179]
ds_read_b128 a[104:107], v5 offset:15360
v_mfma_f32_16x16x32_bf16 v[152:155], a[132:135], a[36:39], v[152:155]
ds_read_b128 a[108:111], v5 offset:21504
v_mfma_f32_16x16x32_bf16 v[152:155], a[128:131], a[32:35], v[152:155]
ds_write_b128 v231, a[200:203] offset:9216
v_mfma_f32_16x16x32_bf16 v[132:135], a[136:139], a[32:35], v[132:135]
buffer_load_dwordx4 a[20:23], v2, s[40:43], s33 offen offset:2048 sc1
v_mfma_f32_16x16x32_bf16 v[132:135], a[140:143], a[36:39], v[132:135]
ds_read_b128 a[112:115], v5 offset:16384
v_mfma_f32_16x16x32_bf16 v[156:159], a[140:143], a[44:47], v[156:159]
v_mfma_f32_16x16x32_bf16 v[156:159], a[136:139], a[40:43], v[156:159]
buffer_load_dwordx4 v[92:95], v1, s[4:7], s88 offen offset:0 sc1
v_mfma_f32_16x16x32_bf16 v[180:183], a[136:139], a[48:51], v[180:183]
ds_read_b128 a[116:119], v5 offset:22528
v_mfma_f32_16x16x32_bf16 v[180:183], a[140:143], a[52:55], v[180:183]
ds_read_b128 a[120:123], v6 offset:4096
v_mfma_f32_16x16x32_bf16 v[204:207], a[140:143], a[60:63], v[204:207]
v_mfma_f32_16x16x32_bf16 v[204:207], a[136:139], a[56:59], v[204:207]
buffer_load_dwordx4 a[24:27], v2, s[40:43], s35 offen offset:3072 sc1
v_mfma_f32_16x16x32_bf16 v[208:211], a[144:147], a[56:59], v[208:211]
ds_write_b128 v231, a[204:207] offset:16384
v_mfma_f32_16x16x32_bf16 v[208:211], a[148:151], a[60:63], v[208:211]
v_mfma_f32_16x16x32_bf16 v[184:187], a[148:151], a[52:55], v[184:187]
buffer_load_dwordx4 v[96:99], v1, s[4:7], s88 offen offset:1024 sc1
v_mfma_f32_16x16x32_bf16 v[184:187], a[144:147], a[48:51], v[184:187]
v_mfma_f32_16x16x32_bf16 v[160:163], a[144:147], a[40:43], v[160:163]
v_mfma_f32_16x16x32_bf16 v[160:163], a[148:151], a[44:47], v[160:163]
v_mfma_f32_16x16x32_bf16 v[136:139], a[148:151], a[36:39], v[136:139]
buffer_load_dwordx4 a[28:31], v2, s[40:43], s33 offen offset:3072 sc1
s_add_u32 s35, s35, 8192
v_mfma_f32_16x16x32_bf16 v[136:139], a[144:147], a[32:35], v[136:139]
s_add_u32 s33, s33, 8192
v_mfma_f32_16x16x32_bf16 a[176:179], a[152:155], a[168:171], a[176:179]
s_waitcnt vmcnt(13) lgkmcnt(1)
v_mfma_f32_16x16x32_bf16 v[140:143], a[96:99], a[64:67], v[140:143]
ds_read_b128 a[128:131], v5 offset:17408
v_mfma_f32_16x16x32_bf16 v[140:143], a[100:103], a[68:71], v[140:143]
buffer_load_dwordx4 a[32:35], v2, s[40:43], s35 offen offset:0 sc1
v_mfma_f32_16x16x32_bf16 v[164:167], a[100:103], a[76:79], v[164:167]
ds_read_b128 a[132:135], v5 offset:23552
v_mfma_f32_16x16x32_bf16 v[164:167], a[96:99], a[72:75], v[164:167]
ds_write_b128 v231, a[208:211] offset:17408
v_mfma_f32_16x16x32_bf16 v[188:191], a[96:99], a[80:83], v[188:191]
ds_read_b128 a[136:139], v5 offset:12288
v_mfma_f32_16x16x32_bf16 v[188:191], a[100:103], a[84:87], v[188:191]
buffer_load_dwordx4 v[100:103], v1, s[4:7], s88 offen offset:2048 sc1
v_mfma_f32_16x16x32_bf16 v[212:215], a[100:103], a[92:95], v[212:215]
ds_read_b128 a[140:143], v5 offset:18432
v_mfma_f32_16x16x32_bf16 v[212:215], a[96:99], a[88:91], v[212:215]
v_mfma_f32_16x16x32_bf16 v[216:219], a[104:107], a[88:91], v[216:219]
v_mfma_f32_16x16x32_bf16 v[216:219], a[108:111], a[92:95], v[216:219]
buffer_load_dwordx4 a[36:39], v2, s[40:43], s33 offen offset:0 sc1
v_mfma_f32_16x16x32_bf16 v[192:195], a[108:111], a[84:87], v[192:195]
ds_read_b128 a[144:147], v5 offset:13312
v_mfma_f32_16x16x32_bf16 v[192:195], a[104:107], a[80:83], v[192:195]
ds_read_b128 a[148:151], v5 offset:19456
v_mfma_f32_16x16x32_bf16 v[168:171], a[104:107], a[72:75], v[168:171]
v_mfma_f32_16x16x32_bf16 v[168:171], a[108:111], a[76:79], v[168:171]
buffer_load_dwordx4 a[40:43], v2, s[40:43], s35 offen offset:1024 sc1
v_mfma_f32_16x16x32_bf16 v[144:147], a[108:111], a[68:71], v[144:147]
ds_read_b128 a[152:155], v6 offset:5120
v_mfma_f32_16x16x32_bf16 v[144:147], a[104:107], a[64:67], v[144:147]
v_mfma_f32_16x16x32_bf16 v[148:151], a[112:115], a[64:67], v[148:151]
v_mfma_f32_16x16x32_bf16 v[148:151], a[116:119], a[68:71], v[148:151]
buffer_load_dwordx4 v[104:107], v1, s[4:7], s88 offen offset:3072 sc1
s_add_u32 s88, s88, 4096
v_mfma_f32_16x16x32_bf16 v[172:175], a[116:119], a[76:79], v[172:175]
v_mfma_f32_16x16x32_bf16 v[172:175], a[112:115], a[72:75], v[172:175]
v_mfma_f32_16x16x32_bf16 v[196:199], a[112:115], a[80:83], v[196:199]
v_mfma_f32_16x16x32_bf16 v[196:199], a[116:119], a[84:87], v[196:199]
buffer_load_dwordx4 a[44:47], v2, s[40:43], s33 offen offset:1024 sc1
v_mfma_f32_16x16x32_bf16 v[220:223], a[116:119], a[92:95], v[220:223]
v_mfma_f32_16x16x32_bf16 v[220:223], a[112:115], a[88:91], v[220:223]
v_mfma_f32_16x16x32_bf16 a[180:183], a[120:123], a[168:171], a[180:183]
s_waitcnt lgkmcnt(0)
s_barrier
v_mfma_f32_16x16x32_bf16 v[224:227], a[128:131], a[88:91], v[224:227]
ds_read_b128 a[96:99], v5 offset:26624
v_mfma_f32_16x16x32_bf16 v[224:227], a[132:135], a[92:95], v[224:227]
buffer_load_dwordx4 a[48:51], v2, s[40:43], s35 offen offset:2048 sc1
v_mfma_f32_16x16x32_bf16 v[200:203], a[132:135], a[84:87], v[200:203]
ds_read_b128 a[100:103], v5 offset:32768
v_mfma_f32_16x16x32_bf16 v[200:203], a[128:131], a[80:83], v[200:203]
ds_read_b64_tr_b16 a[220:221], v230 offset:0
v_mfma_f32_16x16x32_bf16 v[176:179], a[128:131], a[72:75], v[176:179]
buffer_load_dwordx4 v[108:111], v1, s[4:7], s88 offen offset:0 sc1
v_mfma_f32_16x16x32_bf16 v[176:179], a[132:135], a[76:79], v[176:179]
ds_read_b128 a[104:107], v5 offset:27648
v_mfma_f32_16x16x32_bf16 v[152:155], a[132:135], a[68:71], v[152:155]
ds_read_b128 a[108:111], v5 offset:33792
v_mfma_f32_16x16x32_bf16 v[152:155], a[128:131], a[64:67], v[152:155]
ds_read_b64_tr_b16 a[222:223], v230 offset:2048
v_mfma_f32_16x16x32_bf16 v[132:135], a[136:139], a[64:67], v[132:135]
buffer_load_dwordx4 a[52:55], v2, s[40:43], s33 offen offset:2048 sc1
v_mfma_f32_16x16x32_bf16 v[132:135], a[140:143], a[68:71], v[132:135]
ds_read_b128 a[112:115], v5 offset:28672
v_mfma_f32_16x16x32_bf16 v[156:159], a[140:143], a[76:79], v[156:159]
v_mfma_f32_16x16x32_bf16 v[156:159], a[136:139], a[72:75], v[156:159]
buffer_load_dwordx4 v[112:115], v1, s[4:7], s88 offen offset:1024 sc1
v_mfma_f32_16x16x32_bf16 v[180:183], a[136:139], a[80:83], v[180:183]
ds_read_b128 a[116:119], v5 offset:34816
v_mfma_f32_16x16x32_bf16 v[180:183], a[140:143], a[84:87], v[180:183]
ds_read_b128 a[120:123], v6 offset:26624
v_mfma_f32_16x16x32_bf16 v[204:207], a[140:143], a[92:95], v[204:207]
ds_read_b64_tr_b16 a[224:225], v230 offset:8
v_mfma_f32_16x16x32_bf16 v[204:207], a[136:139], a[88:91], v[204:207]
buffer_load_dwordx4 a[56:59], v2, s[40:43], s35 offen offset:3072 sc1
v_mfma_f32_16x16x32_bf16 v[208:211], a[144:147], a[88:91], v[208:211]
v_mfma_f32_16x16x32_bf16 v[208:211], a[148:151], a[92:95], v[208:211]
ds_read_b64_tr_b16 a[226:227], v230 offset:2056
v_mfma_f32_16x16x32_bf16 v[184:187], a[148:151], a[84:87], v[184:187]
buffer_load_dwordx4 v[116:119], v1, s[4:7], s88 offen offset:2048 sc1
v_mfma_f32_16x16x32_bf16 v[184:187], a[144:147], a[80:83], v[184:187]
v_mfma_f32_16x16x32_bf16 v[160:163], a[144:147], a[72:75], v[160:163]
v_mfma_f32_16x16x32_bf16 v[160:163], a[148:151], a[76:79], v[160:163]
v_mfma_f32_16x16x32_bf16 v[136:139], a[148:151], a[68:71], v[136:139]
buffer_load_dwordx4 a[60:63], v2, s[40:43], s33 offen offset:3072 sc1
s_add_u32 s35, s35, 8192
v_mfma_f32_16x16x32_bf16 v[136:139], a[144:147], a[64:67], v[136:139]
s_add_u32 s33, s33, 8192
ds_read_b64_tr_b16 a[188:189], v248 offset:0
v_mfma_f32_16x16x32_bf16 a[184:187], a[152:155], a[168:171], a[184:187]
s_waitcnt vmcnt(13) lgkmcnt(3)
v_mfma_f32_16x16x32_bf16 v[140:143], a[96:99], a[0:3], v[140:143]
ds_read_b128 a[128:131], v5 offset:29696
v_add_f32_dpp v48, v48, v48 row_ror:8 row_mask:0xf bank_mask:0xf
v_mfma_f32_16x16x32_bf16 v[140:143], a[100:103], a[4:7], v[140:143]
buffer_load_dwordx4 a[64:67], v2, s[40:43], s35 offen offset:0 sc1
v_mfma_f32_16x16x32_bf16 v[164:167], a[100:103], a[12:15], v[164:167]
ds_read_b128 a[132:135], v5 offset:35840
v_add_f32_dpp v49, v49, v49 row_ror:8 row_mask:0xf bank_mask:0xf
v_mfma_f32_16x16x32_bf16 v[164:167], a[96:99], a[8:11], v[164:167]
ds_read_b64_tr_b16 a[190:191], v248 offset:512
v_add_f32_dpp v50, v50, v50 row_ror:8 row_mask:0xf bank_mask:0xf
v_mfma_f32_16x16x32_bf16 v[188:191], a[96:99], a[16:19], v[188:191]
ds_read_b128 a[136:139], v5 offset:24576
v_add_f32_dpp v51, v51, v51 row_ror:8 row_mask:0xf bank_mask:0xf
v_mfma_f32_16x16x32_bf16 v[188:191], a[100:103], a[20:23], v[188:191]
buffer_load_dwordx4 v[120:123], v1, s[4:7], s88 offen offset:3072 sc1
s_add_u32 s63, s28, 16
v_mfma_f32_16x16x32_bf16 v[212:215], a[100:103], a[28:31], v[212:215]
s_lshl_b32 s63, s63, 12
ds_read_b128 a[140:143], v5 offset:30720
v_mfma_f32_16x16x32_bf16 v[212:215], a[96:99], a[24:27], v[212:215]
v_add_f32_dpp v52, v52, v52 row_ror:8 row_mask:0xf bank_mask:0xf
v_add_f32_dpp v53, v53, v53 row_ror:8 row_mask:0xf bank_mask:0xf
v_mfma_f32_16x16x32_bf16 v[216:219], a[104:107], a[24:27], v[216:219]
v_add_f32_dpp v54, v54, v54 row_ror:8 row_mask:0xf bank_mask:0xf
v_add_f32_dpp v55, v55, v55 row_ror:8 row_mask:0xf bank_mask:0xf
v_mfma_f32_16x16x32_bf16 v[216:219], a[108:111], a[28:31], v[216:219]
buffer_load_dwordx4 a[68:71], v2, s[40:43], s33 offen offset:0 sc1
v_mfma_f32_16x16x32_bf16 v[192:195], a[108:111], a[20:23], v[192:195]
ds_read_b128 a[144:147], v5 offset:25600
v_add_f32_dpp v48, v48, v48 row_ror:4 row_mask:0xf bank_mask:0xf
v_mfma_f32_16x16x32_bf16 v[192:195], a[104:107], a[16:19], v[192:195]
ds_read_b128 a[148:151], v5 offset:31744
v_add_f32_dpp v49, v49, v49 row_ror:4 row_mask:0xf bank_mask:0xf
v_mfma_f32_16x16x32_bf16 v[168:171], a[104:107], a[8:11], v[168:171]
ds_read_b64_tr_b16 a[192:193], v248 offset:4096
v_add_f32_dpp v50, v50, v50 row_ror:4 row_mask:0xf bank_mask:0xf
v_mfma_f32_16x16x32_bf16 v[168:171], a[108:111], a[12:15], v[168:171]
buffer_load_dwordx4 a[72:75], v2, s[40:43], s35 offen offset:1024 sc1
v_mfma_f32_16x16x32_bf16 v[144:147], a[108:111], a[4:7], v[144:147]
ds_read_b128 a[152:155], v6 offset:27648
v_add_f32_dpp v51, v51, v51 row_ror:4 row_mask:0xf bank_mask:0xf
v_mfma_f32_16x16x32_bf16 v[144:147], a[104:107], a[0:3], v[144:147]
ds_read_b64_tr_b16 a[194:195], v248 offset:4608
v_add_f32_dpp v52, v52, v52 row_ror:4 row_mask:0xf bank_mask:0xf
v_mfma_f32_16x16x32_bf16 v[148:151], a[112:115], a[0:3], v[148:151]
v_add_f32_dpp v53, v53, v53 row_ror:4 row_mask:0xf bank_mask:0xf
v_add_f32_dpp v54, v54, v54 row_ror:4 row_mask:0xf bank_mask:0xf
v_mfma_f32_16x16x32_bf16 v[148:151], a[116:119], a[4:7], v[148:151]
buffer_load_dwordx4 a[164:167], v3, s[40:43], s63 offen sc1
s_add_u32 s88, s83, 0x200000
v_mfma_f32_16x16x32_bf16 v[172:175], a[116:119], a[12:15], v[172:175]
v_add_f32_dpp v55, v55, v55 row_ror:4 row_mask:0xf bank_mask:0xf
v_add_f32_dpp v48, v48, v48 row_ror:2 row_mask:0xf bank_mask:0xf
v_mfma_f32_16x16x32_bf16 v[172:175], a[112:115], a[8:11], v[172:175]
v_add_f32_dpp v49, v49, v49 row_ror:2 row_mask:0xf bank_mask:0xf
v_add_f32_dpp v50, v50, v50 row_ror:2 row_mask:0xf bank_mask:0xf
v_mfma_f32_16x16x32_bf16 v[196:199], a[112:115], a[16:19], v[196:199]
v_add_f32_dpp v51, v51, v51 row_ror:2 row_mask:0xf bank_mask:0xf
v_add_f32_dpp v52, v52, v52 row_ror:2 row_mask:0xf bank_mask:0xf
v_mfma_f32_16x16x32_bf16 v[196:199], a[116:119], a[20:23], v[196:199]
buffer_load_dwordx4 a[76:79], v2, s[40:43], s33 offen offset:1024 sc1
v_mfma_f32_16x16x32_bf16 v[220:223], a[116:119], a[28:31], v[220:223]
ds_read_b64_tr_b16 a[196:197], v249 offset:32
v_add_f32_dpp v53, v53, v53 row_ror:2 row_mask:0xf bank_mask:0xf
v_mfma_f32_16x16x32_bf16 v[220:223], a[112:115], a[24:27], v[220:223]
v_add_f32_dpp v54, v54, v54 row_ror:2 row_mask:0xf bank_mask:0xf
v_add_f32_dpp v55, v55, v55 row_ror:2 row_mask:0xf bank_mask:0xf
v_mfma_f32_16x16x32_bf16 a[172:175], a[120:123], a[160:163], a[172:175]
v_add_f32_dpp v48, v48, v48 row_ror:1 row_mask:0xf bank_mask:0xf
s_waitcnt lgkmcnt(2)
v_mfma_f32_16x16x32_bf16 v[224:227], a[128:131], a[24:27], v[224:227]
ds_read_b128 a[96:99], v5 offset:38912
v_add_f32_dpp v49, v49, v49 row_ror:1 row_mask:0xf bank_mask:0xf
v_mfma_f32_16x16x32_bf16 v[224:227], a[132:135], a[28:31], v[224:227]
buffer_load_dwordx4 a[80:83], v2, s[40:43], s35 offen offset:2048 sc1
v_mfma_f32_16x16x32_bf16 v[200:203], a[132:135], a[20:23], v[200:203]
ds_read_b128 a[100:103], v5 offset:45056
v_add_f32_dpp v50, v50, v50 row_ror:1 row_mask:0xf bank_mask:0xf
v_mfma_f32_16x16x32_bf16 v[200:203], a[128:131], a[16:19], v[200:203]
ds_read_b64_tr_b16 a[198:199], v249 offset:544
v_add_f32_dpp v51, v51, v51 row_ror:1 row_mask:0xf bank_mask:0xf
v_mfma_f32_16x16x32_bf16 v[176:179], a[128:131], a[8:11], v[176:179]
buffer_load_dwordx4 v[124:127], v1, s[4:7], s88 offen offset:0 sc1
v_mfma_f32_16x16x32_bf16 v[176:179], a[132:135], a[12:15], v[176:179]
ds_read_b128 a[104:107], v5 offset:39936
v_add_f32_dpp v52, v52, v52 row_ror:1 row_mask:0xf bank_mask:0xf
v_mfma_f32_16x16x32_bf16 v[152:155], a[132:135], a[4:7], v[152:155]
ds_read_b128 a[108:111], v5 offset:46080
v_add_f32_dpp v53, v53, v53 row_ror:1 row_mask:0xf bank_mask:0xf
v_mfma_f32_16x16x32_bf16 v[152:155], a[128:131], a[0:3], v[152:155]
ds_read_b64_tr_b16 a[200:201], v249 offset:4128
v_add_f32_dpp v54, v54, v54 row_ror:1 row_mask:0xf bank_mask:0xf
v_mfma_f32_16x16x32_bf16 v[132:135], a[136:139], a[0:3], v[132:135]
buffer_load_dwordx4 a[84:87], v2, s[40:43], s33 offen offset:2048 sc1
v_mfma_f32_16x16x32_bf16 v[132:135], a[140:143], a[4:7], v[132:135]
ds_read_b128 a[112:115], v5 offset:40960
v_add_f32_dpp v55, v55, v55 row_ror:1 row_mask:0xf bank_mask:0xf
v_mfma_f32_16x16x32_bf16 v[156:159], a[140:143], a[12:15], v[156:159]
v_add_u32 v233, 159744, v233
s_lshl_b32 s36, s28, 6
v_mfma_f32_16x16x32_bf16 v[156:159], a[136:139], a[8:11], v[156:159]
buffer_load_dwordx4 v[128:131], v1, s[4:7], s88 offen offset:1024 sc1
s_add_u32 m0, s18, 0x1e000
v_mfma_f32_16x16x32_bf16 v[180:183], a[136:139], a[16:19], v[180:183]
s_add_u32 s44, s50, 0xe1e000
ds_read_b128 a[116:119], v5 offset:47104
v_mfma_f32_16x16x32_bf16 v[180:183], a[140:143], a[20:23], v[180:183]
ds_read_b128 a[120:123], v6 offset:28672
s_lshl_b32 s37, s39, 6
v_mfma_f32_16x16x32_bf16 v[204:207], a[140:143], a[28:31], v[204:207]
ds_read_b64_tr_b16 a[202:203], v249 offset:4640
v_add_u32 v232, s36, v233
v_mfma_f32_16x16x32_bf16 v[204:207], a[136:139], a[24:27], v[204:207]
buffer_load_dwordx4 a[88:91], v2, s[40:43], s35 offen offset:3072 sc1
v_mfma_f32_16x16x32_bf16 v[208:211], a[144:147], a[24:27], v[208:211]
v_add_u32 v235, s37, v233
v_mfma_f32_16x16x32_bf16 v[208:211], a[148:151], a[28:31], v[208:211]
v_mfma_f32_16x16x32_bf16 v[184:187], a[148:151], a[20:23], v[184:187]
buffer_load_dwordx4 v1, s[4:7], s44 offen offset:0 sc1 lds
v_mfma_f32_16x16x32_bf16 v[184:187], a[144:147], a[16:19], v[184:187]
ds_read_b64_tr_b16 a[204:205], v248 offset:8192
v_mfma_f32_16x16x32_bf16 v[160:163], a[144:147], a[8:11], v[160:163]
v_mfma_f32_16x16x32_bf16 v[160:163], a[148:151], a[12:15], v[160:163]
v_mfma_f32_16x16x32_bf16 v[136:139], a[148:151], a[4:7], v[136:139]
buffer_load_dwordx4 a[92:95], v2, s[40:43], s33 offen offset:3072 sc1
s_add_u32 s35, s35, 8192
v_mfma_f32_16x16x32_bf16 v[136:139], a[144:147], a[0:3], v[136:139]
s_add_u32 s33, s33, 8192
v_mfma_f32_16x16x32_bf16 a[176:179], a[152:155], a[160:163], a[176:179]
ds_read_b64_tr_b16 a[206:207], v248 offset:8704
s_waitcnt vmcnt(13) lgkmcnt(3)
v_mfma_f32_16x16x32_bf16 v[140:143], a[96:99], a[32:35], v[140:143]
ds_read_b128 a[128:131], v5 offset:41984
v_mfma_f32_16x16x32_bf16 v[140:143], a[100:103], a[36:39], v[140:143]
buffer_load_dwordx4 a[0:3], v2, s[40:43], s35 offen offset:0 sc1
v_mfma_f32_16x16x32_bf16 v[164:167], a[100:103], a[44:47], v[164:167]
ds_read_b128 a[132:135], v5 offset:48128
v_mfma_f32_16x16x32_bf16 v[164:167], a[96:99], a[40:43], v[164:167]
ds_write_b128 v232, v[48:51]
v_mfma_f32_16x16x32_bf16 v[188:191], a[96:99], a[48:51], v[188:191]
ds_read_b128 a[136:139], v5 offset:36864
v_mfma_f32_16x16x32_bf16 v[188:191], a[100:103], a[52:55], v[188:191]
buffer_load_dwordx4 v1, s[4:7], s44 offen offset:1024 sc1 lds
v_mfma_f32_16x16x32_bf16 v[212:215], a[100:103], a[60:63], v[212:215]
ds_read_b128 a[140:143], v5 offset:43008
v_mfma_f32_16x16x32_bf16 v[212:215], a[96:99], a[56:59], v[212:215]
ds_read_b64_tr_b16 a[208:209], v248 offset:12288
v_mfma_f32_16x16x32_bf16 v[216:219], a[104:107], a[56:59], v[216:219]
ds_write_b128 v235, v[52:55]
v_mfma_f32_16x16x32_bf16 v[216:219], a[108:111], a[60:63], v[216:219]
buffer_load_dwordx4 a[4:7], v2, s[40:43], s33 offen offset:0 sc1
v_mfma_f32_16x16x32_bf16 v[192:195], a[108:111], a[52:55], v[192:195]
ds_read_b128 a[144:147], v5 offset:37888
v_mfma_f32_16x16x32_bf16 v[192:195], a[104:107], a[48:51], v[192:195]
ds_read_b128 a[148:151], v5 offset:44032
v_mfma_f32_16x16x32_bf16 v[168:171], a[104:107], a[40:43], v[168:171]
ds_read_b64_tr_b16 a[210:211], v248 offset:12800
v_mfma_f32_16x16x32_bf16 v[168:171], a[108:111], a[44:47], v[168:171]
buffer_load_dwordx4 a[8:11], v2, s[40:43], s35 offen offset:1024 sc1
v_mfma_f32_16x16x32_bf16 v[144:147], a[108:111], a[36:39], v[144:147]
ds_read_b128 a[152:155], v6 offset:29696
v_mfma_f32_16x16x32_bf16 v[144:147], a[104:107], a[32:35], v[144:147]
v_mfma_f32_16x16x32_bf16 v[148:151], a[112:115], a[32:35], v[148:151]
v_mfma_f32_16x16x32_bf16 v[148:151], a[116:119], a[36:39], v[148:151]
buffer_load_dwordx4 v1, s[4:7], s44 offen offset:2048 sc1 lds
s_add_u32 m0, s18, 0x21000
v_mfma_f32_16x16x32_bf16 v[172:175], a[116:119], a[44:47], v[172:175]
s_add_u32 s44, s50, 0xe21000
v_mfma_f32_16x16x32_bf16 v[172:175], a[112:115], a[40:43], v[172:175]
v_mfma_f32_16x16x32_bf16 v[196:199], a[112:115], a[48:51], v[196:199]
v_mfma_f32_16x16x32_bf16 v[196:199], a[116:119], a[52:55], v[196:199]
buffer_load_dwordx4 a[12:15], v2, s[40:43], s33 offen offset:1024 sc1
v_mfma_f32_16x16x32_bf16 v[220:223], a[116:119], a[60:63], v[220:223]
v_mfma_f32_16x16x32_bf16 v[220:223], a[112:115], a[56:59], v[220:223]
v_mfma_f32_16x16x32_bf16 a[180:183], a[120:123], a[160:163], a[180:183]
s_waitcnt lgkmcnt(0)
s_barrier
v_mfma_f32_16x16x32_bf16 v[224:227], a[128:131], a[56:59], v[224:227]
v_add_u32 v5, 98304, v1
v_add_u32 v6, s55, v5
v_mfma_f32_16x16x32_bf16 v[224:227], a[132:135], a[60:63], v[224:227]
buffer_load_dwordx4 a[16:19], v2, s[40:43], s35 offen offset:2048 sc1
v_mfma_f32_16x16x32_bf16 v[200:203], a[132:135], a[52:55], v[200:203]
ds_read_b128 a[96:99], v5 offset:2048
v_mfma_f32_16x16x32_bf16 v[200:203], a[128:131], a[48:51], v[200:203]
ds_read_b128 a[100:103], v5 offset:8192
v_mfma_f32_16x16x32_bf16 v[176:179], a[128:131], a[40:43], v[176:179]
buffer_load_dwordx4 v1, s[4:7], s44 offen offset:0 sc1 lds
v_mfma_f32_16x16x32_bf16 v[176:179], a[132:135], a[44:47], v[176:179]
ds_read_b128 a[104:107], v5 offset:3072
v_mfma_f32_16x16x32_bf16 v[152:155], a[132:135], a[36:39], v[152:155]
ds_read_b128 a[108:111], v5 offset:9216
v_mfma_f32_16x16x32_bf16 v[152:155], a[128:131], a[32:35], v[152:155]
ds_read_b128 v[48:51], v233 offset:0
v_mfma_f32_16x16x32_bf16 v[132:135], a[136:139], a[32:35], v[132:135]
buffer_load_dwordx4 a[20:23], v2, s[40:43], s33 offen offset:2048 sc1
v_mfma_f32_16x16x32_bf16 v[132:135], a[140:143], a[36:39], v[132:135]
ds_read_b128 a[112:115], v5 offset:4096
v_mfma_f32_16x16x32_bf16 v[156:159], a[140:143], a[44:47], v[156:159]
ds_read_b128 v[52:55], v233 offset:64
v_mfma_f32_16x16x32_bf16 v[156:159], a[136:139], a[40:43], v[156:159]
buffer_load_dwordx4 v1, s[4:7], s44 offen offset:1024 sc1 lds
v_mfma_f32_16x16x32_bf16 v[180:183], a[136:139], a[48:51], v[180:183]
ds_read_b128 a[116:119], v5 offset:10240
v_mfma_f32_16x16x32_bf16 v[180:183], a[140:143], a[52:55], v[180:183]
ds_read_b128 a[120:123], v6 offset:2048
v_mfma_f32_16x16x32_bf16 v[204:207], a[140:143], a[60:63], v[204:207]
v_mfma_f32_16x16x32_bf16 v[204:207], a[136:139], a[56:59], v[204:207]
buffer_load_dwordx4 a[24:27], v2, s[40:43], s35 offen offset:3072 sc1
v_mfma_f32_16x16x32_bf16 v[208:211], a[144:147], a[56:59], v[208:211]
v_mfma_f32_16x16x32_bf16 v[208:211], a[148:151], a[60:63], v[208:211]
v_mfma_f32_16x16x32_bf16 v[184:187], a[148:151], a[52:55], v[184:187]
buffer_load_dwordx4 v1, s[4:7], s44 offen offset:2048 sc1 lds
s_add_u32 m0, s18, 0x0
v_mfma_f32_16x16x32_bf16 v[184:187], a[144:147], a[48:51], v[184:187]
s_add_u32 s44, s50, 0xe24000
ds_read_b128 v[56:59], v233 offset:128
v_mfma_f32_16x16x32_bf16 v[160:163], a[144:147], a[40:43], v[160:163]
v_mfma_f32_16x16x32_bf16 v[160:163], a[148:151], a[44:47], v[160:163]
v_mfma_f32_16x16x32_bf16 v[136:139], a[148:151], a[36:39], v[136:139]
buffer_load_dwordx4 a[28:31], v2, s[40:43], s33 offen offset:3072 sc1
s_add_u32 s35, s35, 8192
v_mfma_f32_16x16x32_bf16 v[136:139], a[144:147], a[32:35], v[136:139]
s_add_u32 s33, s33, 8192
v_mfma_f32_16x16x32_bf16 a[184:187], a[152:155], a[160:163], a[184:187]
s_waitcnt vmcnt(13) lgkmcnt(1)
v_mfma_f32_16x16x32_bf16 v[140:143], a[96:99], a[64:67], v[140:143]
ds_read_b128 a[128:131], v5 offset:5120
v_mfma_f32_16x16x32_bf16 v[140:143], a[100:103], a[68:71], v[140:143]
buffer_load_dwordx4 a[32:35], v2, s[40:43], s35 offen offset:0 sc1
v_mfma_f32_16x16x32_bf16 v[164:167], a[100:103], a[76:79], v[164:167]
ds_read_b128 a[132:135], v5 offset:11264
v_mfma_f32_16x16x32_bf16 v[164:167], a[96:99], a[72:75], v[164:167]
v_mfma_f32_16x16x32_bf16 v[236:239], a[188:191], v[16:19], 0
v_mfma_f32_16x16x32_bf16 v[188:191], a[96:99], a[80:83], v[188:191]
ds_read_b128 a[136:139], v5 offset:0
v_mfma_f32_16x16x32_bf16 v[188:191], a[100:103], a[84:87], v[188:191]
buffer_load_dwordx4 v1, s[4:7], s44 offen offset:0 sc1 lds
s_add_u32 s63, s28, 20
v_mfma_f32_16x16x32_bf16 v[212:215], a[100:103], a[92:95], v[212:215]
s_lshl_b32 s63, s63, 12
ds_read_b128 a[140:143], v5 offset:6144
v_mfma_f32_16x16x32_bf16 v[212:215], a[96:99], a[88:91], v[212:215]
v_mfma_f32_16x16x32_bf16 v[240:243], a[196:199], v[16:19], 0
v_mfma_f32_16x16x32_bf16 v[216:219], a[104:107], a[88:91], v[216:219]
v_mfma_f32_16x16x32_bf16 v[244:247], a[204:207], v[16:19], 0
v_mfma_f32_16x16x32_bf16 v[216:219], a[108:111], a[92:95], v[216:219]
buffer_load_dwordx4 a[36:39], v2, s[40:43], s33 offen offset:0 sc1
v_mfma_f32_16x16x32_bf16 v[192:195], a[108:111], a[84:87], v[192:195]
ds_read_b128 a[144:147], v5 offset:1024
v_mfma_f32_16x16x32_bf16 v[192:195], a[104:107], a[80:83], v[192:195]
ds_read_b128 a[148:151], v5 offset:7168
v_mfma_f32_16x16x32_bf16 v[168:171], a[104:107], a[72:75], v[168:171]
v_mfma_f32_16x16x32_bf16 v[236:239], a[192:195], v[16:19], v[236:239]
v_mfma_f32_16x16x32_bf16 v[168:171], a[108:111], a[76:79], v[168:171]
buffer_load_dwordx4 a[40:43], v2, s[40:43], s35 offen offset:1024 sc1
v_mfma_f32_16x16x32_bf16 v[144:147], a[108:111], a[68:71], v[144:147]
ds_read_b128 a[152:155], v6 offset:3072
v_mfma_f32_16x16x32_bf16 v[144:147], a[104:107], a[64:67], v[144:147]
ds_read_b128 v[60:63], v233 offset:192
v_mfma_f32_16x16x32_bf16 v[148:151], a[112:115], a[64:67], v[148:151]
v_mfma_f32_16x16x32_bf16 v[240:243], a[200:203], v[16:19], v[240:243]
v_mfma_f32_16x16x32_bf16 v[148:151], a[116:119], a[68:71], v[148:151]
buffer_load_dwordx4 a[168:171], v3, s[40:43], s63 offen sc1
v_mfma_f32_16x16x32_bf16 v[172:175], a[116:119], a[76:79], v[172:175]
ds_read_b128 v[64:67], v233 offset:256
v_mfma_f32_16x16x32_bf16 v[172:175], a[112:115], a[72:75], v[172:175]
v_mfma_f32_16x16x32_bf16 v[196:199], a[112:115], a[80:83], v[196:199]
v_mfma_f32_16x16x32_bf16 v[244:247], a[208:211], v[16:19], v[244:247]
v_mfma_f32_16x16x32_bf16 v[196:199], a[116:119], a[84:87], v[196:199]
buffer_load_dwordx4 a[44:47], v2, s[40:43], s33 offen offset:1024 sc1
v_mfma_f32_16x16x32_bf16 v[220:223], a[116:119], a[92:95], v[220:223]
ds_read_b128 v[68:71], v233 offset:320
v_mfma_f32_16x16x32_bf16 v[220:223], a[112:115], a[88:91], v[220:223]
v_mfma_f32_16x16x32_bf16 a[172:175], a[120:123], a[164:167], a[172:175]
s_waitcnt lgkmcnt(3)
v_mfma_f32_16x16x32_bf16 v[224:227], a[128:131], a[88:91], v[224:227]
ds_read_b128 a[96:99], v5 offset:14336
v_mfma_f32_16x16x32_bf16 v[224:227], a[132:135], a[92:95], v[224:227]
buffer_load_dwordx4 a[48:51], v2, s[40:43], s35 offen offset:2048 sc1
v_mfma_f32_16x16x32_bf16 v[200:203], a[132:135], a[84:87], v[200:203]
ds_read_b128 a[100:103], v5 offset:20480
v_mfma_f32_16x16x32_bf16 v[200:203], a[128:131], a[80:83], v[200:203]
v_mfma_f32_16x16x32_bf16 v[176:179], a[128:131], a[72:75], v[176:179]
buffer_load_dwordx4 v1, s[4:7], s44 offen offset:1024 sc1 lds
v_mfma_f32_16x16x32_bf16 v[176:179], a[132:135], a[76:79], v[176:179]
ds_read_b128 a[104:107], v5 offset:15360
v_mfma_f32_16x16x32_bf16 v[152:155], a[132:135], a[68:71], v[152:155]
ds_read_b128 a[108:111], v5 offset:21504
v_mfma_f32_16x16x32_bf16 v[152:155], a[128:131], a[64:67], v[152:155]
ds_read_b128 v[72:75], v232 offset:128
v_mfma_f32_16x16x32_bf16 v[132:135], a[136:139], a[64:67], v[132:135]
buffer_load_dwordx4 a[52:55], v2, s[40:43], s33 offen offset:2048 sc1
v_mfma_f32_16x16x32_bf16 v[132:135], a[140:143], a[68:71], v[132:135]
ds_read_b128 a[112:115], v5 offset:16384
v_mfma_f32_16x16x32_bf16 v[156:159], a[140:143], a[76:79], v[156:159]
v_mfma_f32_16x16x32_bf16 v[156:159], a[136:139], a[72:75], v[156:159]
buffer_load_dwordx4 v1, s[4:7], s44 offen offset:2048 sc1 lds
s_add_u32 m0, s18, 0x3000
v_mfma_f32_16x16x32_bf16 v[180:183], a[136:139], a[80:83], v[180:183]
s_add_u32 s44, s50, 0xe27000
ds_read_b128 a[116:119], v5 offset:22528
v_mfma_f32_16x16x32_bf16 v[180:183], a[140:143], a[84:87], v[180:183]
ds_read_b128 a[120:123], v6 offset:4096
v_mfma_f32_16x16x32_bf16 v[204:207], a[140:143], a[92:95], v[204:207]
v_mfma_f32_16x16x32_bf16 v[204:207], a[136:139], a[88:91], v[204:207]
buffer_load_dwordx4 a[56:59], v2, s[40:43], s35 offen offset:3072 sc1
v_mfma_f32_16x16x32_bf16 v[208:211], a[144:147], a[88:91], v[208:211]
v_mfma_f32_16x16x32_bf16 v[208:211], a[148:151], a[92:95], v[208:211]
v_mfma_f32_16x16x32_bf16 v[184:187], a[148:151], a[84:87], v[184:187]
buffer_load_dwordx4 v1, s[4:7], s44 offen offset:0 sc1 lds
v_mfma_f32_16x16x32_bf16 v[184:187], a[144:147], a[80:83], v[184:187]
v_mfma_f32_16x16x32_bf16 v[160:163], a[144:147], a[72:75], v[160:163]
v_mfma_f32_16x16x32_bf16 v[160:163], a[148:151], a[76:79], v[160:163]
v_mfma_f32_16x16x32_bf16 v[136:139], a[148:151], a[68:71], v[136:139]
buffer_load_dwordx4 a[60:63], v2, s[40:43], s33 offen offset:3072 sc1
s_add_u32 s35, s35, 8192
v_mfma_f32_16x16x32_bf16 v[136:139], a[144:147], a[64:67], v[136:139]
s_add_u32 s33, s33, 8192
v_mfma_f32_16x16x32_bf16 a[176:179], a[152:155], a[164:167], a[176:179]
s_waitcnt vmcnt(13) lgkmcnt(0)
v_mfma_f32_16x16x32_bf16 v[140:143], a[96:99], a[0:3], v[140:143]
ds_read_b128 a[128:131], v5 offset:17408
v_add_f32 v92, v92, v96
v_mfma_f32_16x16x32_bf16 v[140:143], a[100:103], a[4:7], v[140:143]
buffer_load_dwordx4 a[64:67], v2, s[40:43], s35 offen offset:0 sc1
v_mfma_f32_16x16x32_bf16 v[164:167], a[100:103], a[12:15], v[164:167]
ds_read_b128 a[132:135], v5 offset:23552
v_add_f32 v100, v100, v104
v_mfma_f32_16x16x32_bf16 v[164:167], a[96:99], a[8:11], v[164:167]
v_add_f32 v108, v108, v112
v_add_f32 v116, v116, v120
v_mfma_f32_16x16x32_bf16 v[188:191], a[96:99], a[16:19], v[188:191]
ds_read_b128 a[136:139], v5 offset:12288
v_add_f32 v124, v124, v128
v_mfma_f32_16x16x32_bf16 v[188:191], a[100:103], a[20:23], v[188:191]
buffer_load_dwordx4 v1, s[4:7], s44 offen offset:1024 sc1 lds
v_mfma_f32_16x16x32_bf16 v[212:215], a[100:103], a[28:31], v[212:215]
ds_read_b128 a[140:143], v5 offset:18432
v_add_f32 v93, v93, v97
v_mfma_f32_16x16x32_bf16 v[212:215], a[96:99], a[24:27], v[212:215]
v_add_f32 v101, v101, v105
v_add_f32 v109, v109, v113
v_mfma_f32_16x16x32_bf16 v[216:219], a[104:107], a[24:27], v[216:219]
v_add_f32 v117, v117, v121
v_add_f32 v125, v125, v129
v_mfma_f32_16x16x32_bf16 v[216:219], a[108:111], a[28:31], v[216:219]
buffer_load_dwordx4 a[68:71], v2, s[40:43], s33 offen offset:0 sc1
v_mfma_f32_16x16x32_bf16 v[192:195], a[108:111], a[20:23], v[192:195]
ds_read_b128 a[144:147], v5 offset:13312
v_add_f32 v94, v94, v98
v_mfma_f32_16x16x32_bf16 v[192:195], a[104:107], a[16:19], v[192:195]
ds_read_b128 a[148:151], v5 offset:19456
v_add_f32 v102, v102, v106
v_mfma_f32_16x16x32_bf16 v[168:171], a[104:107], a[8:11], v[168:171]
v_add_f32 v110, v110, v114
v_add_f32 v118, v118, v122
v_mfma_f32_16x16x32_bf16 v[168:171], a[108:111], a[12:15], v[168:171]
buffer_load_dwordx4 a[72:75], v2, s[40:43], s35 offen offset:1024 sc1
v_mfma_f32_16x16x32_bf16 v[144:147], a[108:111], a[4:7], v[144:147]
ds_read_b128 a[152:155], v6 offset:5120
v_add_f32 v126, v126, v130
v_mfma_f32_16x16x32_bf16 v[144:147], a[104:107], a[0:3], v[144:147]
v_add_f32 v95, v95, v99
v_add_f32 v103, v103, v107
v_mfma_f32_16x16x32_bf16 v[148:151], a[112:115], a[0:3], v[148:151]
v_add_f32 v111, v111, v115
v_add_f32 v119, v119, v123
v_mfma_f32_16x16x32_bf16 v[148:151], a[116:119], a[4:7], v[148:151]
buffer_load_dwordx4 v1, s[4:7], s44 offen offset:2048 sc1 lds
s_add_u32 m0, s18, 0x6000
v_mfma_f32_16x16x32_bf16 v[172:175], a[116:119], a[12:15], v[172:175]
s_add_u32 s44, s50, 0xe2a000
v_add_f32 v127, v127, v131
v_mfma_f32_16x16x32_bf16 v[172:175], a[112:115], a[8:11], v[172:175]
v_add_f32_dpp v92, v92, v92 row_ror:8 row_mask:0xf bank_mask:0xf
v_add_f32_dpp v100, v100, v100 row_ror:8 row_mask:0xf bank_mask:0xf
v_mfma_f32_16x16x32_bf16 v[196:199], a[112:115], a[16:19], v[196:199]
v_add_f32_dpp v108, v108, v108 row_ror:8 row_mask:0xf bank_mask:0xf
v_add_f32_dpp v116, v116, v116 row_ror:8 row_mask:0xf bank_mask:0xf
v_mfma_f32_16x16x32_bf16 v[196:199], a[116:119], a[20:23], v[196:199]
buffer_load_dwordx4 a[76:79], v2, s[40:43], s33 offen offset:1024 sc1
v_mfma_f32_16x16x32_bf16 v[220:223], a[116:119], a[28:31], v[220:223]
v_add_f32_dpp v124, v124, v124 row_ror:8 row_mask:0xf bank_mask:0xf
v_add_f32_dpp v93, v93, v93 row_ror:8 row_mask:0xf bank_mask:0xf
v_mfma_f32_16x16x32_bf16 v[220:223], a[112:115], a[24:27], v[220:223]
v_add_f32_dpp v101, v101, v101 row_ror:8 row_mask:0xf bank_mask:0xf
v_add_f32_dpp v109, v109, v109 row_ror:8 row_mask:0xf bank_mask:0xf
v_mfma_f32_16x16x32_bf16 a[180:183], a[120:123], a[164:167], a[180:183]
s_waitcnt lgkmcnt(0)
s_barrier
v_mfma_f32_16x16x32_bf16 v[224:227], a[128:131], a[24:27], v[224:227]
ds_read_b128 a[96:99], v5 offset:26624
v_add_f32_dpp v117, v117, v117 row_ror:8 row_mask:0xf bank_mask:0xf
v_mfma_f32_16x16x32_bf16 v[224:227], a[132:135], a[28:31], v[224:227]
buffer_load_dwordx4 a[80:83], v2, s[40:43], s35 offen offset:2048 sc1
v_mfma_f32_16x16x32_bf16 v[200:203], a[132:135], a[20:23], v[200:203]
ds_read_b128 a[100:103], v5 offset:32768
v_add_f32_dpp v125, v125, v125 row_ror:8 row_mask:0xf bank_mask:0xf
v_mfma_f32_16x16x32_bf16 v[200:203], a[128:131], a[16:19], v[200:203]
v_add_f32_dpp v92, v94, v94 row_ror:8 row_mask:0xf bank_mask:0xc
v_add_f32_dpp v100, v102, v102 row_ror:8 row_mask:0xf bank_mask:0xc
v_mfma_f32_16x16x32_bf16 v[176:179], a[128:131], a[8:11], v[176:179]
buffer_load_dwordx4 v1, s[4:7], s44 offen offset:0 sc1 lds
v_mfma_f32_16x16x32_bf16 v[176:179], a[132:135], a[12:15], v[176:179]
ds_read_b128 a[104:107], v5 offset:27648
v_add_f32_dpp v108, v110, v110 row_ror:8 row_mask:0xf bank_mask:0xc
v_mfma_f32_16x16x32_bf16 v[152:155], a[132:135], a[4:7], v[152:155]
L_stub1:
s_cbranch_execz L_wret0
ds_read_b128 a[108:111], v5 offset:33792
v_add_f32_dpp v116, v118, v118 row_ror:8 row_mask:0xf bank_mask:0xc
v_mfma_f32_16x16x32_bf16 v[152:155], a[128:131], a[0:3], v[152:155]
v_add_f32_dpp v124, v126, v126 row_ror:8 row_mask:0xf bank_mask:0xc
v_add_f32_dpp v93, v95, v95 row_ror:8 row_mask:0xf bank_mask:0xc
v_mfma_f32_16x16x32_bf16 v[132:135], a[136:139], a[0:3], v[132:135]
buffer_load_dwordx4 a[84:87], v2, s[40:43], s33 offen offset:2048 sc1
v_mfma_f32_16x16x32_bf16 v[132:135], a[140:143], a[4:7], v[132:135]
ds_read_b128 a[112:115], v5 offset:28672
v_add_f32_dpp v101, v103, v103 row_ror:8 row_mask:0xf bank_mask:0xc
v_mfma_f32_16x16x32_bf16 v[156:159], a[140:143], a[12:15], v[156:159]
v_add_f32_dpp v109, v111, v111 row_ror:8 row_mask:0xf bank_mask:0xc
v_add_f32_dpp v117, v119, v119 row_ror:8 row_mask:0xf bank_mask:0xc
v_mfma_f32_16x16x32_bf16 v[156:159], a[136:139], a[8:11], v[156:159]
buffer_load_dwordx4 v1, s[4:7], s44 offen offset:1024 sc1 lds
v_mfma_f32_16x16x32_bf16 v[180:183], a[136:139], a[16:19], v[180:183]
ds_read_b128 a[116:119], v5 offset:34816
v_add_f32_dpp v125, v127, v127 row_ror:8 row_mask:0xf bank_mask:0xc
v_mfma_f32_16x16x32_bf16 v[180:183], a[140:143], a[20:23], v[180:183]
ds_read_b128 a[120:123], v6 offset:26624
v_mfma_f32_16x16x32_bf16 v[204:207], a[140:143], a[28:31], v[204:207]
v_permlane32_swap_b32 v92, v93
v_mfma_f32_16x16x32_bf16 v[204:207], a[136:139], a[24:27], v[204:207]
buffer_load_dwordx4 a[88:91], v2, s[40:43], s35 offen offset:3072 sc1
v_mfma_f32_16x16x32_bf16 v[208:211], a[144:147], a[24:27], v[208:211]
v_permlane32_swap_b32 v100, v101
v_mfma_f32_16x16x32_bf16 v[208:211], a[148:151], a[28:31], v[208:211]
v_permlane32_swap_b32 v108, v109
v_mfma_f32_16x16x32_bf16 v[184:187], a[148:151], a[20:23], v[184:187]
buffer_load_dwordx4 v1, s[4:7], s44 offen offset:2048 sc1 lds
s_add_u32 m0, s18, 0x9000
v_mfma_f32_16x16x32_bf16 v[184:187], a[144:147], a[16:19], v[184:187]
s_add_u32 s44, s50, 0xe2d000
v_mfma_f32_16x16x32_bf16 v[160:163], a[144:147], a[8:11], v[160:163]
v_permlane32_swap_b32 v116, v117
v_mfma_f32_16x16x32_bf16 v[160:163], a[148:151], a[12:15], v[160:163]
v_permlane32_swap_b32 v124, v125
v_mfma_f32_16x16x32_bf16 v[136:139], a[148:151], a[4:7], v[136:139]
buffer_load_dwordx4 a[92:95], v2, s[40:43], s33 offen offset:3072 sc1
s_add_u32 s35, s35, 8192
v_mfma_f32_16x16x32_bf16 v[136:139], a[144:147], a[0:3], v[136:139]
s_add_u32 s33, s33, 8192
v_add_f32 v92, v92, v93
v_mfma_f32_16x16x32_bf16 a[184:187], a[152:155], a[164:167], a[184:187]
v_add_f32 v100, v100, v101
s_waitcnt vmcnt(13) lgkmcnt(0)
v_mfma_f32_16x16x32_bf16 v[140:143], a[96:99], a[32:35], v[140:143]
ds_read_b128 a[128:131], v5 offset:29696
v_add_f32 v108, v108, v109
v_mfma_f32_16x16x32_bf16 v[140:143], a[100:103], a[36:39], v[140:143]
buffer_load_dwordx4 a[0:3], v2, s[40:43], s35 offen offset:0 sc1
v_mfma_f32_16x16x32_bf16 v[164:167], a[100:103], a[44:47], v[164:167]
ds_read_b128 a[132:135], v5 offset:35840
v_add_f32 v116, v116, v117
v_mfma_f32_16x16x32_bf16 v[164:167], a[96:99], a[40:43], v[164:167]
v_add_f32 v124, v124, v125
v_mov_b32 v94, v92
v_mfma_f32_16x16x32_bf16 v[188:191], a[96:99], a[48:51], v[188:191]
ds_read_b128 a[136:139], v5 offset:24576
v_mov_b32 v102, v100
v_mfma_f32_16x16x32_bf16 v[188:191], a[100:103], a[52:55], v[188:191]
buffer_load_dwordx4 v1, s[4:7], s44 offen offset:0 sc1 lds
s_add_u32 s63, s28, 24
v_mfma_f32_16x16x32_bf16 v[212:215], a[100:103], a[60:63], v[212:215]
s_lshl_b32 s63, s63, 12
ds_read_b128 a[140:143], v5 offset:30720
v_mfma_f32_16x16x32_bf16 v[212:215], a[96:99], a[56:59], v[212:215]
v_mov_b32 v110, v108
v_mov_b32 v118, v116
v_mfma_f32_16x16x32_bf16 v[216:219], a[104:107], a[56:59], v[216:219]
v_mov_b32 v126, v124
v_mfma_f32_16x16x32_bf16 v[216:219], a[108:111], a[60:63], v[216:219]
buffer_load_dwordx4 a[4:7], v2, s[40:43], s33 offen offset:0 sc1
v_mfma_f32_16x16x32_bf16 v[192:195], a[108:111], a[52:55], v[192:195]
ds_read_b128 a[144:147], v5 offset:25600
v_mfma_f32_16x16x32_bf16 v[192:195], a[104:107], a[48:51], v[192:195]
ds_read_b128 a[148:151], v5 offset:31744
v_mfma_f32_16x16x32_bf16 v[168:171], a[104:107], a[40:43], v[168:171]
v_permlane16_swap_b32 v92, v94
v_mfma_f32_16x16x32_bf16 v[168:171], a[108:111], a[44:47], v[168:171]
buffer_load_dwordx4 a[8:11], v2, s[40:43], s35 offen offset:1024 sc1
v_mfma_f32_16x16x32_bf16 v[144:147], a[108:111], a[36:39], v[144:147]
ds_read_b128 a[152:155], v6 offset:27648
v_mfma_f32_16x16x32_bf16 v[144:147], a[104:107], a[32:35], v[144:147]
v_permlane16_swap_b32 v100, v102
v_mfma_f32_16x16x32_bf16 v[148:151], a[112:115], a[32:35], v[148:151]
v_permlane16_swap_b32 v108, v110
v_mfma_f32_16x16x32_bf16 v[148:151], a[116:119], a[36:39], v[148:151]
buffer_load_dwordx4 a[160:163], v3, s[40:43], s63 offen sc1
v_mfma_f32_16x16x32_bf16 v[172:175], a[116:119], a[44:47], v[172:175]
v_permlane16_swap_b32 v116, v118
v_mfma_f32_16x16x32_bf16 v[172:175], a[112:115], a[40:43], v[172:175]
v_permlane16_swap_b32 v124, v126
v_mfma_f32_16x16x32_bf16 v[196:199], a[112:115], a[48:51], v[196:199]
v_add_f32 v92, v92, v94
v_add_f32 v100, v100, v102
v_mfma_f32_16x16x32_bf16 v[196:199], a[116:119], a[52:55], v[196:199]
buffer_load_dwordx4 a[12:15], v2, s[40:43], s33 offen offset:1024 sc1
v_mfma_f32_16x16x32_bf16 v[220:223], a[116:119], a[60:63], v[220:223]
v_add_f32 v108, v108, v110
v_add_f32 v116, v116, v118
v_mfma_f32_16x16x32_bf16 v[220:223], a[112:115], a[56:59], v[220:223]
v_add_f32 v124, v124, v126
v_mov_b32 v94, v92
v_mfma_f32_16x16x32_bf16 a[172:175], a[120:123], a[168:171], a[172:175]
v_mov_b32 v102, v100
s_waitcnt lgkmcnt(0)
v_mfma_f32_16x16x32_bf16 v[224:227], a[128:131], a[56:59], v[224:227]
ds_read_b128 a[96:99], v5 offset:38912
v_mov_b32 v110, v108
v_mfma_f32_16x16x32_bf16 v[224:227], a[132:135], a[60:63], v[224:227]
buffer_load_dwordx4 a[16:19], v2, s[40:43], s35 offen offset:2048 sc1
v_mfma_f32_16x16x32_bf16 v[200:203], a[132:135], a[52:55], v[200:203]
ds_read_b128 a[100:103], v5 offset:45056
v_mov_b32 v118, v116
v_mfma_f32_16x16x32_bf16 v[200:203], a[128:131], a[48:51], v[200:203]
v_mov_b32 v126, v124
v_mfma_f32_16x16x32_bf16 v[176:179], a[128:131], a[40:43], v[176:179]
buffer_load_dwordx4 v1, s[4:7], s44 offen offset:1024 sc1 lds
v_mfma_f32_16x16x32_bf16 v[176:179], a[132:135], a[44:47], v[176:179]
ds_read_b128 a[104:107], v5 offset:39936
v_mfma_f32_16x16x32_bf16 v[152:155], a[132:135], a[36:39], v[152:155]
ds_read_b128 a[108:111], v5 offset:46080
v_mfma_f32_16x16x32_bf16 v[152:155], a[128:131], a[32:35], v[152:155]
v_permlane32_swap_b32 v92, v94
v_mfma_f32_16x16x32_bf16 v[132:135], a[136:139], a[32:35], v[132:135]
buffer_load_dwordx4 a[20:23], v2, s[40:43], s33 offen offset:2048 sc1
v_mfma_f32_16x16x32_bf16 v[132:135], a[140:143], a[36:39], v[132:135]
ds_read_b128 a[112:115], v5 offset:40960
v_mfma_f32_16x16x32_bf16 v[156:159], a[140:143], a[44:47], v[156:159]
v_permlane32_swap_b32 v100, v102
v_mfma_f32_16x16x32_bf16 v[156:159], a[136:139], a[40:43], v[156:159]
buffer_load_dwordx4 v1, s[4:7], s44 offen offset:2048 sc1 lds
s_add_u32 s63, s28, 28
v_mfma_f32_16x16x32_bf16 v[180:183], a[136:139], a[48:51], v[180:183]
s_lshl_b32 s63, s63, 12
ds_read_b128 a[116:119], v5 offset:47104
v_mfma_f32_16x16x32_bf16 v[180:183], a[140:143], a[52:55], v[180:183]
ds_read_b128 a[120:123], v6 offset:28672
v_mfma_f32_16x16x32_bf16 v[204:207], a[140:143], a[60:63], v[204:207]
v_permlane32_swap_b32 v108, v110
v_mfma_f32_16x16x32_bf16 v[204:207], a[136:139], a[56:59], v[204:207]
buffer_load_dwordx4 a[24:27], v2, s[40:43], s35 offen offset:3072 sc1
v_mfma_f32_16x16x32_bf16 v[208:211], a[144:147], a[56:59], v[208:211]
v_permlane32_swap_b32 v116, v118
v_mfma_f32_16x16x32_bf16 v[208:211], a[148:151], a[60:63], v[208:211]
v_permlane32_swap_b32 v124, v126
v_mfma_f32_16x16x32_bf16 v[184:187], a[148:151], a[52:55], v[184:187]
buffer_load_dwordx4 a[164:167], v3, s[40:43], s63 offen sc1
s_add_u32 m0, s19, 49152
v_mfma_f32_16x16x32_bf16 v[184:187], a[144:147], a[48:51], v[184:187]
s_add_u32 s44, s85, 0xa04000
v_mul_f32 v82, 0xba800000, v92
v_mfma_f32_16x16x32_bf16 v[160:163], a[144:147], a[40:43], v[160:163]
v_mul_f32 v84, 0xba800000, v100
v_mul_f32 v86, 0xba800000, v108
v_mfma_f32_16x16x32_bf16 v[160:163], a[148:151], a[44:47], v[160:163]
v_mul_f32 v88, 0xba800000, v116
v_mul_f32 v90, 0xba800000, v124
v_mfma_f32_16x16x32_bf16 v[136:139], a[148:151], a[36:39], v[136:139]
buffer_load_dwordx4 a[28:31], v2, s[40:43], s33 offen offset:3072 sc1
s_add_u32 s35, s35, 8192
v_mfma_f32_16x16x32_bf16 v[136:139], a[144:147], a[32:35], v[136:139]
s_add_u32 s33, s33, 8192
v_mul_f32 v94, 0x3a800000, v94
v_mfma_f32_16x16x32_bf16 a[176:179], a[152:155], a[168:171], a[176:179]
v_mul_f32 v102, 0x3a800000, v102
s_waitcnt vmcnt(13) lgkmcnt(0)
v_mfma_f32_16x16x32_bf16 v[140:143], a[96:99], a[64:67], v[140:143]
ds_read_b128 a[128:131], v5 offset:41984
v_mul_f32 v110, 0x3a800000, v110
v_mfma_f32_16x16x32_bf16 v[140:143], a[100:103], a[68:71], v[140:143]
buffer_load_dwordx4 a[32:35], v2, s[40:43], s35 offen offset:0 sc1
v_mfma_f32_16x16x32_bf16 v[164:167], a[100:103], a[76:79], v[164:167]
ds_read_b128 a[132:135], v5 offset:48128
v_mul_f32 v118, 0x3a800000, v118
v_mfma_f32_16x16x32_bf16 v[164:167], a[96:99], a[72:75], v[164:167]
v_mul_f32 v126, 0x3a800000, v126
v_fma_f32 v94, -v82, v82, v94
v_mfma_f32_16x16x32_bf16 v[188:191], a[96:99], a[80:83], v[188:191]
ds_read_b128 a[136:139], v5 offset:36864
v_fma_f32 v102, -v84, v84, v102
v_mfma_f32_16x16x32_bf16 v[188:191], a[100:103], a[84:87], v[188:191]
buffer_load_dwordx4 v1, s[4:7], s44 offen offset:0 sc1 lds
v_mfma_f32_16x16x32_bf16 v[212:215], a[100:103], a[92:95], v[212:215]
ds_read_b128 a[140:143], v5 offset:43008
v_fma_f32 v110, -v86, v86, v110
v_mfma_f32_16x16x32_bf16 v[212:215], a[96:99], a[88:91], v[212:215]
v_fma_f32 v118, -v88, v88, v118
v_fma_f32 v126, -v90, v90, v126
v_max_f32 v94, 0, v94
v_max_f32 v102, 0, v102
v_max_f32 v110, 0, v110
v_max_f32 v118, 0, v118
v_max_f32 v126, 0, v126
v_add_f32 v94, 0x3727c5ac, v94
v_add_f32 v102, 0x3727c5ac, v102
v_add_f32 v110, 0x3727c5ac, v110
v_add_f32 v118, 0x3727c5ac, v118
v_add_f32 v126, 0x3727c5ac, v126
v_rsq_f32 v83, v94
v_rsq_f32 v85, v102
v_rsq_f32 v87, v110
v_rsq_f32 v89, v118
v_rsq_f32 v91, v126
v_mfma_f32_16x16x32_bf16 v[216:219], a[104:107], a[88:91], v[216:219]
v_mfma_f32_16x16x32_bf16 v[216:219], a[108:111], a[92:95], v[216:219]
buffer_load_dwordx4 a[36:39], v2, s[40:43], s33 offen offset:0 sc1
v_mfma_f32_16x16x32_bf16 v[192:195], a[108:111], a[84:87], v[192:195]
ds_read_b128 a[144:147], v5 offset:37888
v_fmac_f32 v140, v56, v82
v_mfma_f32_16x16x32_bf16 v[192:195], a[104:107], a[80:83], v[192:195]
ds_read_b128 a[148:151], v5 offset:44032
v_mfma_f32_16x16x32_bf16 v[168:171], a[104:107], a[72:75], v[168:171]
v_fmac_f32 v164, v56, v84
v_mfma_f32_16x16x32_bf16 v[168:171], a[108:111], a[76:79], v[168:171]
buffer_load_dwordx4 a[40:43], v2, s[40:43], s35 offen offset:1024 sc1
v_mfma_f32_16x16x32_bf16 v[144:147], a[108:111], a[68:71], v[144:147]
ds_read_b128 a[152:155], v6 offset:29696
v_fmac_f32 v188, v56, v86
v_mfma_f32_16x16x32_bf16 v[144:147], a[104:107], a[64:67], v[144:147]
v_mfma_f32_16x16x32_bf16 v[148:151], a[112:115], a[64:67], v[148:151]
v_fmac_f32 v212, v56, v88
v_mfma_f32_16x16x32_bf16 v[148:151], a[116:119], a[68:71], v[148:151]
buffer_load_dwordx4 v1, s[4:7], s44 offen offset:1024 sc1 lds
v_mfma_f32_16x16x32_bf16 v[172:175], a[116:119], a[76:79], v[172:175]
v_fmac_f32 v216, v60, v88
v_mfma_f32_16x16x32_bf16 v[172:175], a[112:115], a[72:75], v[172:175]
v_mfma_f32_16x16x32_bf16 v[196:199], a[112:115], a[80:83], v[196:199]
v_fmac_f32 v192, v60, v86
v_mfma_f32_16x16x32_bf16 v[196:199], a[116:119], a[84:87], v[196:199]
buffer_load_dwordx4 a[44:47], v2, s[40:43], s33 offen offset:1024 sc1
v_mfma_f32_16x16x32_bf16 v[220:223], a[116:119], a[92:95], v[220:223]
v_fmac_f32 v168, v60, v84
v_fmac_f32 v141, v57, v82
v_mfma_f32_16x16x32_bf16 v[220:223], a[112:115], a[88:91], v[220:223]
v_mfma_f32_16x16x32_bf16 a[180:183], a[120:123], a[168:171], a[180:183]
s_waitcnt vmcnt(9) lgkmcnt(0)
s_barrier
v_mfma_f32_16x16x32_bf16 v[224:227], a[128:131], a[88:91], v[224:227]
v_add_u32 v5, 0, v1
v_add_u32 v6, s55, v5
v_mfma_f32_16x16x32_bf16 v[224:227], a[132:135], a[92:95], v[224:227]
buffer_load_dwordx4 a[48:51], v2, s[40:43], s35 offen offset:2048 sc1
v_mfma_f32_16x16x32_bf16 v[200:203], a[132:135], a[84:87], v[200:203]
ds_read_b128 a[96:99], v5 offset:2048
v_fmac_f32 v144, v60, v82
v_mfma_f32_16x16x32_bf16 v[200:203], a[128:131], a[80:83], v[200:203]
ds_read_b128 a[100:103], v5 offset:8192
v_fmac_f32 v148, v64, v82
v_mfma_f32_16x16x32_bf16 v[176:179], a[128:131], a[72:75], v[176:179]
buffer_load_dwordx4 v1, s[4:7], s44 offen offset:2048 sc1 lds
v_mfma_f32_16x16x32_bf16 v[176:179], a[132:135], a[76:79], v[176:179]
ds_read_b128 a[104:107], v5 offset:3072
v_fmac_f32 v172, v64, v84
v_mfma_f32_16x16x32_bf16 v[152:155], a[132:135], a[68:71], v[152:155]
ds_read_b128 a[108:111], v5 offset:9216
v_fmac_f32 v196, v64, v86
v_mfma_f32_16x16x32_bf16 v[152:155], a[128:131], a[64:67], v[152:155]
v_fmac_f32 v220, v64, v88
v_fmac_f32 v165, v57, v84
v_mfma_f32_16x16x32_bf16 v[132:135], a[136:139], a[64:67], v[132:135]
buffer_load_dwordx4 a[52:55], v2, s[40:43], s33 offen offset:2048 sc1
v_mfma_f32_16x16x32_bf16 v[132:135], a[140:143], a[68:71], v[132:135]
ds_read_b128 a[112:115], v5 offset:4096
v_fmac_f32 v189, v57, v86
v_mfma_f32_16x16x32_bf16 v[156:159], a[140:143], a[76:79], v[156:159]
ds_read_b128 a[116:119], v5 offset:10240
v_fmac_f32 v224, v68, v88
v_mfma_f32_16x16x32_bf16 v[156:159], a[136:139], a[72:75], v[156:159]
buffer_load_dwordx4 v1, s[4:7], s44 offen offset:3072 sc1 lds
s_add_u32 m0, s19, 65536
v_mfma_f32_16x16x32_bf16 v[180:183], a[136:139], a[80:83], v[180:183]
s_add_u32 s44, s84, 0xa08000
ds_read_b128 a[120:123], v6 offset:2048
v_mfma_f32_16x16x32_bf16 v[180:183], a[140:143], a[84:87], v[180:183]
v_fmac_f32 v200, v68, v86
v_fmac_f32 v213, v57, v88
v_mfma_f32_16x16x32_bf16 v[204:207], a[140:143], a[92:95], v[204:207]
ds_read_b128 a[124:127], v6 offset:26624
v_fmac_f32 v176, v68, v84
v_mfma_f32_16x16x32_bf16 v[204:207], a[136:139], a[88:91], v[204:207]
buffer_load_dwordx4 a[56:59], v2, s[40:43], s35 offen offset:3072 sc1
v_mfma_f32_16x16x32_bf16 v[208:211], a[144:147], a[88:91], v[208:211]
v_fmac_f32 v152, v68, v82
v_fmac_f32 v217, v61, v88
v_mfma_f32_16x16x32_bf16 v[208:211], a[148:151], a[92:95], v[208:211]
v_fmac_f32 v193, v61, v86
v_fmac_f32 v169, v61, v84
v_mfma_f32_16x16x32_bf16 v[184:187], a[148:151], a[84:87], v[184:187]
buffer_load_dwordx4 v1, s[4:7], s44 offen offset:0 sc1 lds
v_mfma_f32_16x16x32_bf16 v[184:187], a[144:147], a[80:83], v[184:187]
v_fmac_f32 v132, v48, v82
v_fmac_f32 v145, v61, v82
v_mfma_f32_16x16x32_bf16 v[160:163], a[144:147], a[72:75], v[160:163]
v_fmac_f32 v156, v48, v84
v_fmac_f32 v149, v65, v82
v_mfma_f32_16x16x32_bf16 v[160:163], a[148:151], a[76:79], v[160:163]
v_fmac_f32 v173, v65, v84
v_fmac_f32 v197, v65, v86
v_mfma_f32_16x16x32_bf16 v[136:139], a[148:151], a[68:71], v[136:139]
buffer_load_dwordx4 a[60:63], v2, s[40:43], s33 offen offset:3072 sc1
s_add_u32 s35, s35, 8192
v_mfma_f32_16x16x32_bf16 v[136:139], a[144:147], a[64:67], v[136:139]
s_add_u32 s33, s33, 8192
v_fmac_f32 v180, v48, v86
v_mfma_f32_16x16x32_bf16 a[184:187], a[152:155], a[168:171], a[184:187]
v_fmac_f32 v204, v48, v88
s_waitcnt vmcnt(13) lgkmcnt(0)
v_mfma_f32_16x16x32_bf16 v[140:143], a[96:99], a[0:3], v[140:143]
ds_read_b128 a[128:131], v5 offset:5120
v_fmac_f32 v221, v65, v88
v_mfma_f32_16x16x32_bf16 v[140:143], a[100:103], a[4:7], v[140:143]
buffer_load_dwordx4 a[64:67], v2, s[40:43], s35 offen offset:0 sc1
s_lshl_b32 s37, s28, 10
v_mfma_f32_16x16x32_bf16 v[164:167], a[100:103], a[12:15], v[164:167]
ds_read_b128 a[132:135], v5 offset:11264
v_fmac_f32 v208, v52, v88
v_mfma_f32_16x16x32_bf16 v[164:167], a[96:99], a[8:11], v[164:167]
v_fmac_f32 v184, v52, v86
v_fmac_f32 v225, v69, v88
v_mfma_f32_16x16x32_bf16 v[188:191], a[96:99], a[16:19], v[188:191]
buffer_load_dwordx4 a[68:71], v2, s[40:43], s33 offen offset:0 sc1
s_lshl_b32 s72, s30, 12
v_mfma_f32_16x16x32_bf16 v[188:191], a[100:103], a[20:23], v[188:191]
ds_read_b128 a[136:139], v5 offset:0
v_fmac_f32 v160, v52, v84
v_mfma_f32_16x16x32_bf16 v[212:215], a[100:103], a[28:31], v[212:215]
ds_read_b128 a[140:143], v5 offset:6144
v_fmac_f32 v201, v69, v86
v_mfma_f32_16x16x32_bf16 v[212:215], a[96:99], a[24:27], v[212:215]
v_fmac_f32 v136, v52, v82
v_fmac_f32 v177, v69, v84
v_mfma_f32_16x16x32_bf16 v[216:219], a[104:107], a[24:27], v[216:219]
buffer_load_dwordx4 v1, s[4:7], s44 offen offset:1024 sc1 lds
s_add_u32 s72, s72, 0x1e00000
v_mfma_f32_16x16x32_bf16 v[216:219], a[108:111], a[28:31], v[216:219]
ds_read_b128 a[144:147], v5 offset:1024
v_fmac_f32 v153, v69, v82
v_mfma_f32_16x16x32_bf16 v[192:195], a[108:111], a[20:23], v[192:195]
ds_read_b128 a[148:151], v5 offset:7168
v_fmac_f32 v133, v49, v82
v_mfma_f32_16x16x32_bf16 v[192:195], a[104:107], a[16:19], v[192:195]
v_fmac_f32 v157, v49, v84
v_fmac_f32 v181, v49, v86
v_mfma_f32_16x16x32_bf16 v[168:171], a[104:107], a[8:11], v[168:171]
buffer_load_dwordx4 a[72:75], v2, s[40:43], s35 offen offset:1024 sc1
v_mfma_f32_16x16x32_bf16 v[168:171], a[108:111], a[12:15], v[168:171]
ds_read_b128 a[152:155], v6 offset:3072
v_fmac_f32 v205, v49, v88
v_mfma_f32_16x16x32_bf16 v[144:147], a[108:111], a[4:7], v[144:147]
ds_read_b128 a[156:159], v6 offset:27648
v_fmac_f32 v209, v53, v88
v_mfma_f32_16x16x32_bf16 v[144:147], a[104:107], a[0:3], v[144:147]
buffer_load_dwordx4 a[76:79], v2, s[40:43], s33 offen offset:1024 sc1
v_mfma_f32_16x16x32_bf16 v[148:151], a[112:115], a[0:3], v[148:151]
v_fmac_f32 v185, v53, v86
v_fmac_f32 v142, v58, v82
v_mfma_f32_16x16x32_bf16 v[148:151], a[116:119], a[4:7], v[148:151]
v_fmac_f32 v161, v53, v84
v_fmac_f32 v166, v58, v84
v_mfma_f32_16x16x32_bf16 v[172:175], a[116:119], a[12:15], v[172:175]
v_fmac_f32 v190, v58, v86
v_fmac_f32 v214, v58, v88
v_mfma_f32_16x16x32_bf16 v[172:175], a[112:115], a[8:11], v[172:175]
buffer_load_dwordx4 a[80:83], v2, s[40:43], s35 offen offset:2048 sc1
v_mfma_f32_16x16x32_bf16 v[196:199], a[112:115], a[16:19], v[196:199]
v_fmac_f32 v137, v53, v82
v_fmac_f32 v218, v62, v88
v_mfma_f32_16x16x32_bf16 v[196:199], a[116:119], a[20:23], v[196:199]
v_fmac_f32 v194, v62, v86
v_add_u32 v233, s37, v1
v_mfma_f32_16x16x32_bf16 v[220:223], a[116:119], a[28:31], v[220:223]
v_fmac_f32 v170, v62, v84
v_fmac_f32 v143, v59, v82
v_mfma_f32_16x16x32_bf16 v[220:223], a[112:115], a[24:27], v[220:223]
buffer_load_dwordx4 a[84:87], v2, s[40:43], s33 offen offset:2048 sc1
v_mfma_f32_16x16x32_bf16 a[172:175], a[120:123], a[160:163], a[172:175]
v_fmac_f32 v146, v62, v82
v_fmac_f32 v167, v59, v84
v_mfma_f32_16x16x32_bf16 a[172:175], a[124:127], a[164:167], a[172:175]
v_add_u32 v232, s19, v7
s_waitcnt lgkmcnt(0)
v_mfma_f32_16x16x32_bf16 v[224:227], a[128:131], a[24:27], v[224:227]
ds_read_b128 a[96:99], v5 offset:14336
v_fmac_f32 v150, v66, v82
v_mfma_f32_16x16x32_bf16 v[224:227], a[132:135], a[28:31], v[224:227]
buffer_load_dwordx4 a[88:91], v2, s[40:43], s35 offen offset:3072 sc1
v_mfma_f32_16x16x32_bf16 v[200:203], a[132:135], a[20:23], v[200:203]
ds_read_b128 a[100:103], v5 offset:20480
v_fmac_f32 v174, v66, v84
v_mfma_f32_16x16x32_bf16 v[200:203], a[128:131], a[16:19], v[200:203]
v_fmac_f32 v191, v59, v86
v_fmac_f32 v215, v59, v88
v_mfma_f32_16x16x32_bf16 v[176:179], a[128:131], a[8:11], v[176:179]
buffer_load_dwordx4 v1, s[4:7], s44 offen offset:2048 sc1 lds
v_mfma_f32_16x16x32_bf16 v[176:179], a[132:135], a[12:15], v[176:179]
ds_read_b128 a[104:107], v5 offset:15360
v_fmac_f32 v198, v66, v86
v_mfma_f32_16x16x32_bf16 v[152:155], a[132:135], a[4:7], v[152:155]
ds_read_b128 a[108:111], v5 offset:21504
v_fmac_f32 v222, v66, v88
v_mfma_f32_16x16x32_bf16 v[152:155], a[128:131], a[0:3], v[152:155]
v_fmac_f32 v219, v63, v88
v_fmac_f32 v195, v63, v86
v_mfma_f32_16x16x32_bf16 v[132:135], a[136:139], a[0:3], v[132:135]
buffer_load_dwordx4 v1, s[4:7], s44 offen offset:3072 sc1 lds
s_add_u32 m0, s19, 81920
v_mfma_f32_16x16x32_bf16 v[132:135], a[140:143], a[4:7], v[132:135]
s_add_u32 s44, s85, 0xa0c000
ds_read_b128 a[112:115], v5 offset:16384
v_mfma_f32_16x16x32_bf16 v[156:159], a[140:143], a[12:15], v[156:159]
ds_read_b128 a[116:119], v5 offset:22528
v_fmac_f32 v226, v70, v88
v_mfma_f32_16x16x32_bf16 v[156:159], a[136:139], a[8:11], v[156:159]
v_fmac_f32 v171, v63, v84
v_fmac_f32 v147, v63, v82
v_mfma_f32_16x16x32_bf16 v[180:183], a[136:139], a[16:19], v[180:183]
buffer_load_dwordx4 v1, s[4:7], s44 offen offset:0 sc1 lds
v_mfma_f32_16x16x32_bf16 v[180:183], a[140:143], a[20:23], v[180:183]
ds_read_b128 a[120:123], v6 offset:4096
v_fmac_f32 v202, v70, v86
v_mfma_f32_16x16x32_bf16 v[204:207], a[140:143], a[28:31], v[204:207]
ds_read_b128 a[124:127], v6 offset:28672
v_fmac_f32 v178, v70, v84
v_mfma_f32_16x16x32_bf16 v[204:207], a[136:139], a[24:27], v[204:207]
buffer_load_dwordx4 a[92:95], v2, s[40:43], s33 offen offset:3072 sc1
s_add_u32 s35, s35, 8192
v_mfma_f32_16x16x32_bf16 v[208:211], a[144:147], a[24:27], v[208:211]
s_add_u32 s33, s33, 8192
v_fmac_f32 v154, v70, v82
v_mfma_f32_16x16x32_bf16 v[208:211], a[148:151], a[28:31], v[208:211]
v_fmac_f32 v151, v67, v82
v_fmac_f32 v175, v67, v84
v_mfma_f32_16x16x32_bf16 v[184:187], a[148:151], a[20:23], v[184:187]
v_fmac_f32 v134, v50, v82
v_fmac_f32 v199, v67, v86
v_mfma_f32_16x16x32_bf16 v[184:187], a[144:147], a[16:19], v[184:187]
buffer_load_dwordx4 v1, s[4:7], s44 offen offset:1024 sc1 lds
v_mfma_f32_16x16x32_bf16 v[160:163], a[144:147], a[8:11], v[160:163]
v_fmac_f32 v158, v50, v84
v_fmac_f32 v223, v67, v88
v_mfma_f32_16x16x32_bf16 v[160:163], a[148:151], a[12:15], v[160:163]
v_add_u32 v248, s19, v8
v_mfma_f32_16x16x32_bf16 v[136:139], a[148:151], a[4:7], v[136:139]
v_fmac_f32 v182, v50, v86
v_fmac_f32 v227, v71, v88
v_mfma_f32_16x16x32_bf16 v[136:139], a[144:147], a[0:3], v[136:139]
buffer_load_dwordx4 v1, s[4:7], s44 offen offset:2048 sc1 lds
v_mfma_f32_16x16x32_bf16 a[176:179], a[152:155], a[160:163], a[176:179]
v_fmac_f32 v206, v50, v88
v_fmac_f32 v203, v71, v86
v_mfma_f32_16x16x32_bf16 a[176:179], a[156:159], a[164:167], a[176:179]
s_waitcnt vmcnt(14) lgkmcnt(0)
v_mfma_f32_16x16x32_bf16 v[140:143], a[96:99], a[32:35], v[140:143]
ds_read_b128 a[128:131], v5 offset:17408
v_fmac_f32 v210, v54, v88
v_mfma_f32_16x16x32_bf16 v[140:143], a[100:103], a[36:39], v[140:143]
buffer_load_dwordx4 a[0:3], v2, s[40:43], s35 offen offset:0 sc1
v_mfma_f32_16x16x32_bf16 v[164:167], a[100:103], a[44:47], v[164:167]
ds_read_b128 a[132:135], v5 offset:23552
v_fmac_f32 v186, v54, v86
v_mfma_f32_16x16x32_bf16 v[164:167], a[96:99], a[40:43], v[164:167]
v_fmac_f32 v179, v71, v84
v_fmac_f32 v155, v71, v82
v_mfma_f32_16x16x32_bf16 v[188:191], a[96:99], a[48:51], v[188:191]
buffer_load_dwordx4 a[4:7], v2, s[40:43], s33 offen offset:0 sc1
v_mfma_f32_16x16x32_bf16 v[188:191], a[100:103], a[52:55], v[188:191]
ds_read_b128 a[136:139], v5 offset:26624
v_fmac_f32 v162, v54, v84
v_mfma_f32_16x16x32_bf16 v[212:215], a[100:103], a[60:63], v[212:215]
ds_read_b128 a[140:143], v5 offset:32768
v_fmac_f32 v138, v54, v82
v_mfma_f32_16x16x32_bf16 v[212:215], a[96:99], a[56:59], v[212:215]
buffer_load_dwordx4 a[8:11], v2, s[40:43], s35 offen offset:1024 sc1
v_mfma_f32_16x16x32_bf16 v[216:219], a[104:107], a[56:59], v[216:219]
ds_read_b128 a[144:147], v5 offset:27648
v_fmac_f32 v135, v51, v82
v_mfma_f32_16x16x32_bf16 v[216:219], a[108:111], a[60:63], v[216:219]
v_fmac_f32 v159, v51, v84
v_fmac_f32 v183, v51, v86
v_mfma_f32_16x16x32_bf16 v[192:195], a[108:111], a[52:55], v[192:195]
buffer_load_dwordx4 a[12:15], v2, s[40:43], s33 offen offset:1024 sc1
v_mfma_f32_16x16x32_bf16 v[192:195], a[104:107], a[48:51], v[192:195]
ds_read_b128 a[148:151], v5 offset:33792
v_fmac_f32 v207, v51, v88
v_mfma_f32_16x16x32_bf16 v[168:171], a[104:107], a[40:43], v[168:171]
ds_read_b128 a[152:155], v6 offset:5120
v_fmac_f32 v211, v55, v88
v_mfma_f32_16x16x32_bf16 v[168:171], a[108:111], a[44:47], v[168:171]
v_mul_f32 v88, 0x3e8293ee, v89
v_mfma_f32_16x16x32_bf16 v[144:147], a[108:111], a[36:39], v[144:147]
buffer_load_dwordx4 a[16:19], v2, s[40:43], s35 offen offset:2048 sc1
v_mfma_f32_16x16x32_bf16 v[144:147], a[104:107], a[32:35], v[144:147]
ds_read_b128 a[156:159], v6 offset:29696
v_fmac_f32 v187, v55, v86
v_mfma_f32_16x16x32_bf16 v[148:151], a[112:115], a[32:35], v[148:151]
v_fmac_f32 v163, v55, v84
v_mul_f32 v86, 0x3e8293ee, v87
v_mfma_f32_16x16x32_bf16 v[148:151], a[116:119], a[36:39], v[148:151]
buffer_load_dwordx4 a[20:23], v2, s[40:43], s33 offen offset:2048 sc1
v_mfma_f32_16x16x32_bf16 v[172:175], a[116:119], a[44:47], v[172:175]
v_fmac_f32 v139, v55, v82
v_mul_f32 v84, 0x3e8293ee, v85
v_mfma_f32_16x16x32_bf16 v[172:175], a[112:115], a[40:43], v[172:175]
v_mul_f32 v82, 0x3e8293ee, v83
v_mfma_f32_16x16x32_bf16 v[196:199], a[112:115], a[48:51], v[196:199]
buffer_load_dwordx4 a[24:27], v2, s[40:43], s35 offen offset:3072 sc1
v_mfma_f32_16x16x32_bf16 v[196:199], a[116:119], a[52:55], v[196:199]
v_mfma_f32_16x16x32_bf16 v[220:223], a[116:119], a[60:63], v[220:223]
v_mfma_f32_16x16x32_bf16 v[220:223], a[112:115], a[56:59], v[220:223]
buffer_load_dwordx4 a[28:31], v2, s[40:43], s33 offen offset:3072 sc1
s_add_u32 s35, s35, 8192
v_mfma_f32_16x16x32_bf16 a[180:183], a[120:123], a[160:163], a[180:183]
s_add_u32 s33, s33, 8192
v_mfma_f32_16x16x32_bf16 a[180:183], a[124:127], a[164:167], a[180:183]
s_waitcnt lgkmcnt(0)
v_mfma_f32_16x16x32_bf16 v[224:227], a[128:131], a[56:59], v[224:227]
ds_read_b128 a[96:99], v5 offset:28672
s_lshl_b32 s90, s28, 12
v_mfma_f32_16x16x32_bf16 v[224:227], a[132:135], a[60:63], v[224:227]
buffer_load_dwordx4 v1, s[4:7], s44 offen offset:3072 sc1 lds
s_add_u32 s90, s90, 147456
v_mfma_f32_16x16x32_bf16 v[200:203], a[132:135], a[52:55], v[200:203]
ds_read_b128 a[100:103], v5 offset:34816
v_add_u32 v234, s90, v1
v_mfma_f32_16x16x32_bf16 v[200:203], a[128:131], a[48:51], v[200:203]
s_lshl_b32 s90, s28, 10
s_add_u32 s90, s90, 147456
v_mfma_f32_16x16x32_bf16 v[176:179], a[128:131], a[40:43], v[176:179]
v_add_u32 v235, s90, v1
v_mfma_f32_16x16x32_bf16 v[176:179], a[132:135], a[44:47], v[176:179]
ds_read_b128 a[104:107], v5 offset:29696
v_mfma_f32_16x16x32_bf16 v[152:155], a[132:135], a[36:39], v[152:155]
v_mfma_f32_16x16x32_bf16 v[152:155], a[128:131], a[32:35], v[152:155]
s_waitcnt vmcnt(22)
v_mfma_f32_16x16x32_bf16 v[140:143], a[136:139], a[64:67], v[140:143]
ds_read_b128 a[108:111], v5 offset:35840
s_waitcnt vmcnt(21)
v_mfma_f32_16x16x32_bf16 v[140:143], a[140:143], a[68:71], v[140:143]
s_waitcnt vmcnt(18)
v_mfma_f32_16x16x32_bf16 v[164:167], a[140:143], a[76:79], v[164:167]
ds_read_b128 a[112:115], v5 offset:38912
v_mfma_f32_16x16x32_bf16 v[164:167], a[136:139], a[72:75], v[164:167]
s_waitcnt vmcnt(17)
v_mfma_f32_16x16x32_bf16 v[188:191], a[136:139], a[80:83], v[188:191]
s_waitcnt vmcnt(16)
v_mfma_f32_16x16x32_bf16 v[188:191], a[140:143], a[84:87], v[188:191]
ds_read_b128 a[116:119], v5 offset:45056
s_waitcnt vmcnt(11)
v_mfma_f32_16x16x32_bf16 v[212:215], a[140:143], a[92:95], v[212:215]
v_mfma_f32_16x16x32_bf16 v[212:215], a[136:139], a[88:91], v[212:215]
v_mfma_f32_16x16x32_bf16 v[216:219], a[144:147], a[88:91], v[216:219]
v_mfma_f32_16x16x32_bf16 v[216:219], a[148:151], a[92:95], v[216:219]
v_mfma_f32_16x16x32_bf16 v[192:195], a[148:151], a[84:87], v[192:195]
v_mfma_f32_16x16x32_bf16 v[192:195], a[144:147], a[80:83], v[192:195]
v_mfma_f32_16x16x32_bf16 v[168:171], a[144:147], a[72:75], v[168:171]
v_mfma_f32_16x16x32_bf16 v[168:171], a[148:151], a[76:79], v[168:171]
v_mfma_f32_16x16x32_bf16 v[144:147], a[148:151], a[68:71], v[144:147]
v_mfma_f32_16x16x32_bf16 v[144:147], a[144:147], a[64:67], v[144:147]
v_mfma_f32_16x16x32_bf16 a[184:187], a[152:155], a[160:163], a[184:187]
v_mfma_f32_16x16x32_bf16 a[184:187], a[156:159], a[164:167], a[184:187]
s_waitcnt lgkmcnt(0)
v_mfma_f32_16x16x32_bf16 v[148:151], a[96:99], a[64:67], v[148:151]
ds_read_b128 a[128:131], v5 offset:39936
v_mfma_f32_16x16x32_bf16 v[148:151], a[100:103], a[68:71], v[148:151]
buffer_store_dwordx4 a[220:223], v1, s[4:7], s101 offen offset:0 sc1
v_mfma_f32_16x16x32_bf16 v[172:175], a[100:103], a[76:79], v[172:175]
ds_read_b128 a[132:135], v5 offset:46080
v_mfma_f32_16x16x32_bf16 v[172:175], a[96:99], a[72:75], v[172:175]
v_mfma_f32_16x16x32_bf16 v[196:199], a[96:99], a[80:83], v[196:199]
v_mfma_f32_16x16x32_bf16 v[196:199], a[100:103], a[84:87], v[196:199]
ds_read_b128 a[136:139], v5 offset:40960
v_mfma_f32_16x16x32_bf16 v[220:223], a[100:103], a[92:95], v[220:223]
v_mfma_f32_16x16x32_bf16 v[220:223], a[96:99], a[88:91], v[220:223]
v_mfma_f32_16x16x32_bf16 v[224:227], a[104:107], a[88:91], v[224:227]
ds_read_b128 a[140:143], v5 offset:47104
v_mfma_f32_16x16x32_bf16 v[224:227], a[108:111], a[92:95], v[224:227]
buffer_store_dwordx4 a[224:227], v1, s[4:7], s101 offen offset:1024 sc1
v_mfma_f32_16x16x32_bf16 v[200:203], a[108:111], a[84:87], v[200:203]
ds_read_b128 a[144:147], v5 offset:41984
v_mfma_f32_16x16x32_bf16 v[200:203], a[104:107], a[80:83], v[200:203]
ds_write_b128 v234, a[172:175] offset:0
v_mfma_f32_16x16x32_bf16 v[176:179], a[104:107], a[72:75], v[176:179]
v_mfma_f32_16x16x32_bf16 v[176:179], a[108:111], a[76:79], v[176:179]
ds_read_b128 a[148:151], v5 offset:48128
v_mfma_f32_16x16x32_bf16 v[152:155], a[108:111], a[68:71], v[152:155]
v_mfma_f32_16x16x32_bf16 v[152:155], a[104:107], a[64:67], v[152:155]
s_waitcnt vmcnt(10)
v_mfma_f32_16x16x32_bf16 v[140:143], a[112:115], a[0:3], v[140:143]
s_waitcnt vmcnt(9)
v_mfma_f32_16x16x32_bf16 v[140:143], a[116:119], a[4:7], v[140:143]
buffer_store_dwordx4 a[188:191], v1, s[4:7], s96 offen offset:0 sc1
s_waitcnt vmcnt(8)
v_mfma_f32_16x16x32_bf16 v[164:167], a[116:119], a[12:15], v[164:167]
v_mfma_f32_16x16x32_bf16 v[164:167], a[112:115], a[8:11], v[164:167]
s_waitcnt vmcnt(7)
v_mfma_f32_16x16x32_bf16 v[188:191], a[112:115], a[16:19], v[188:191]
s_waitcnt vmcnt(6)
v_mfma_f32_16x16x32_bf16 v[188:191], a[116:119], a[20:23], v[188:191]
L_stub2:
s_cbranch_execz L_wret0
s_waitcnt vmcnt(4)
v_mfma_f32_16x16x32_bf16 v[212:215], a[116:119], a[28:31], v[212:215]
ds_write_b128 v234, a[176:179] offset:1024
v_mfma_f32_16x16x32_bf16 v[212:215], a[112:115], a[24:27], v[212:215]
s_waitcnt lgkmcnt(1)
v_mfma_f32_16x16x32_bf16 v[216:219], a[128:131], a[24:27], v[216:219]
ds_read_b128 a[96:99], v5 offset:12288
v_mul_f32 v140, v140, v83
v_mfma_f32_16x16x32_bf16 v[216:219], a[132:135], a[28:31], v[216:219]
buffer_store_dwordx4 a[192:195], v1, s[4:7], s97 offen offset:0 sc1
v_mfma_f32_16x16x32_bf16 v[192:195], a[132:135], a[20:23], v[192:195]
ds_read_b128 a[100:103], v5 offset:18432
v_mul_f32 v141, v141, v83
v_mfma_f32_16x16x32_bf16 v[192:195], a[128:131], a[16:19], v[192:195]
v_cvt_pk_bf16_f32 v140, v140, v141
v_mul_f32 v164, v164, v85
v_mfma_f32_16x16x32_bf16 v[168:171], a[128:131], a[8:11], v[168:171]
v_mul_f32 v165, v165, v85
v_cvt_pk_bf16_f32 v164, v164, v165
v_mfma_f32_16x16x32_bf16 v[168:171], a[132:135], a[12:15], v[168:171]
ds_read_b128 a[104:107], v5 offset:24576
v_mul_f32 v188, v188, v87
v_mfma_f32_16x16x32_bf16 v[144:147], a[132:135], a[4:7], v[144:147]
v_mul_f32 v189, v189, v87
v_cvt_pk_bf16_f32 v188, v188, v189
v_mfma_f32_16x16x32_bf16 v[144:147], a[128:131], a[0:3], v[144:147]
v_mul_f32 v212, v212, v89
v_mul_f32 v213, v213, v89
v_mfma_f32_16x16x32_bf16 v[148:151], a[136:139], a[0:3], v[148:151]
ds_read_b128 a[108:111], v5 offset:30720
v_cvt_pk_bf16_f32 v212, v212, v213
v_mfma_f32_16x16x32_bf16 v[148:151], a[140:143], a[4:7], v[148:151]
buffer_store_dwordx4 a[196:199], v1, s[4:7], s96 offen offset:1024 sc1
v_mfma_f32_16x16x32_bf16 v[172:175], a[140:143], a[12:15], v[172:175]
ds_read_b128 a[112:115], v5 offset:36864
v_mul_f32 v214, v214, v89
v_mfma_f32_16x16x32_bf16 v[172:175], a[136:139], a[8:11], v[172:175]
ds_write_b128 v234, a[180:183] offset:2048
v_mul_f32 v215, v215, v89
v_mfma_f32_16x16x32_bf16 v[196:199], a[136:139], a[16:19], v[196:199]
v_cvt_pk_bf16_f32 v213, v214, v215
v_mul_f32 v216, v216, v89
v_mfma_f32_16x16x32_bf16 v[196:199], a[140:143], a[20:23], v[196:199]
ds_read_b128 a[116:119], v5 offset:43008
v_mul_f32 v217, v217, v89
v_mfma_f32_16x16x32_bf16 v[220:223], a[140:143], a[28:31], v[220:223]
v_cvt_pk_bf16_f32 v214, v216, v217
v_mul_f32 v218, v218, v89
v_mfma_f32_16x16x32_bf16 v[220:223], a[136:139], a[24:27], v[220:223]
v_mul_f32 v219, v219, v89
v_cvt_pk_bf16_f32 v215, v218, v219
v_mfma_f32_16x16x32_bf16 v[224:227], a[144:147], a[24:27], v[224:227]
v_mul_f32 v148, v148, v83
v_mul_f32 v149, v149, v83
v_mfma_f32_16x16x32_bf16 v[224:227], a[148:151], a[28:31], v[224:227]
buffer_store_dwordx4 a[200:203], v1, s[4:7], s97 offen offset:1024 sc1
v_mfma_f32_16x16x32_bf16 v[200:203], a[148:151], a[20:23], v[200:203]
v_cvt_pk_bf16_f32 v148, v148, v149
v_mul_f32 v172, v172, v85
v_mfma_f32_16x16x32_bf16 v[200:203], a[144:147], a[16:19], v[200:203]
v_mul_f32 v173, v173, v85
v_cvt_pk_bf16_f32 v172, v172, v173
v_mfma_f32_16x16x32_bf16 v[176:179], a[144:147], a[8:11], v[176:179]
v_mul_f32 v196, v196, v87
v_mul_f32 v197, v197, v87
v_mfma_f32_16x16x32_bf16 v[176:179], a[148:151], a[12:15], v[176:179]
v_cvt_pk_bf16_f32 v196, v196, v197
v_mul_f32 v198, v198, v87
v_mfma_f32_16x16x32_bf16 v[152:155], a[148:151], a[4:7], v[152:155]
ds_write_b128 v234, a[184:187] offset:3072
v_mul_f32 v199, v199, v87
v_mfma_f32_16x16x32_bf16 v[152:155], a[144:147], a[0:3], v[152:155]
v_cvt_pk_bf16_f32 v197, v198, v199
s_waitcnt lgkmcnt(1)
v_mfma_f32_16x16x32_bf16 v[132:135], a[96:99], a[32:35], v[132:135]
ds_read_b128 a[128:131], v5 offset:13312
v_mul_f32 v220, v220, v89
v_mfma_f32_16x16x32_bf16 v[132:135], a[100:103], a[36:39], v[132:135]
buffer_store_dwordx4 a[204:207], v1, s[4:7], s96 offen offset:2048 sc1
v_mfma_f32_16x16x32_bf16 v[156:159], a[100:103], a[44:47], v[156:159]
ds_read_b128 a[132:135], v5 offset:19456
v_mul_f32 v221, v221, v89
v_mfma_f32_16x16x32_bf16 v[156:159], a[96:99], a[40:43], v[156:159]
v_cvt_pk_bf16_f32 v220, v220, v221
v_mul_f32 v222, v222, v89
v_mfma_f32_16x16x32_bf16 v[180:183], a[96:99], a[48:51], v[180:183]
v_mul_f32 v223, v223, v89
v_cvt_pk_bf16_f32 v221, v222, v223
v_mfma_f32_16x16x32_bf16 v[180:183], a[100:103], a[52:55], v[180:183]
ds_read_b128 a[136:139], v5 offset:25600
v_mul_f32 v224, v224, v89
v_mfma_f32_16x16x32_bf16 v[204:207], a[100:103], a[60:63], v[204:207]
v_mul_f32 v225, v225, v89
v_cvt_pk_bf16_f32 v222, v224, v225
v_mfma_f32_16x16x32_bf16 v[204:207], a[96:99], a[56:59], v[204:207]
v_mul_f32 v226, v226, v89
v_mul_f32 v227, v227, v89
v_mfma_f32_16x16x32_bf16 v[204:207], a[104:107], a[88:91], v[204:207]
ds_read_b128 a[140:143], v5 offset:31744
v_cvt_pk_bf16_f32 v223, v226, v227
v_mfma_f32_16x16x32_bf16 v[204:207], a[108:111], a[92:95], v[204:207]
buffer_store_dwordx4 a[208:211], v1, s[4:7], s97 offen offset:2048 sc1
v_mfma_f32_16x16x32_bf16 v[180:183], a[108:111], a[84:87], v[180:183]
ds_read_b128 a[144:147], v5 offset:37888
v_mul_f32 v200, v200, v87
v_mfma_f32_16x16x32_bf16 v[180:183], a[104:107], a[80:83], v[180:183]
v_mul_f32 v201, v201, v87
v_cvt_pk_bf16_f32 v198, v200, v201
v_mfma_f32_16x16x32_bf16 v[156:159], a[104:107], a[72:75], v[156:159]
v_mul_f32 v202, v202, v87
v_mul_f32 v203, v203, v87
v_mfma_f32_16x16x32_bf16 v[156:159], a[108:111], a[76:79], v[156:159]
ds_read_b128 a[148:151], v5 offset:44032
v_cvt_pk_bf16_f32 v199, v202, v203
v_mfma_f32_16x16x32_bf16 v[132:135], a[108:111], a[68:71], v[132:135]
v_mul_f32 v174, v174, v85
v_mul_f32 v175, v175, v85
v_mfma_f32_16x16x32_bf16 v[132:135], a[104:107], a[64:67], v[132:135]
v_cvt_pk_bf16_f32 v173, v174, v175
v_mul_f32 v176, v176, v85
v_mfma_f32_16x16x32_bf16 v[132:135], a[112:115], a[0:3], v[132:135]
v_mul_f32 v177, v177, v85
v_cvt_pk_bf16_f32 v174, v176, v177
v_mfma_f32_16x16x32_bf16 v[132:135], a[116:119], a[4:7], v[132:135]
buffer_store_dwordx4 v[236:239], v254, s[4:7], s98 offen offset:0 sc1
v_mfma_f32_16x16x32_bf16 v[156:159], a[116:119], a[12:15], v[156:159]
v_mul_f32 v178, v178, v85
v_mul_f32 v179, v179, v85
v_mfma_f32_16x16x32_bf16 v[156:159], a[112:115], a[8:11], v[156:159]
v_cvt_pk_bf16_f32 v175, v178, v179
v_mul_f32 v150, v150, v83
v_mfma_f32_16x16x32_bf16 v[180:183], a[112:115], a[16:19], v[180:183]
v_mul_f32 v151, v151, v83
v_cvt_pk_bf16_f32 v149, v150, v151
v_mfma_f32_16x16x32_bf16 v[180:183], a[116:119], a[20:23], v[180:183]
v_mul_f32 v152, v152, v83
v_mul_f32 v153, v153, v83
v_mfma_f32_16x16x32_bf16 v[204:207], a[116:119], a[28:31], v[204:207]
v_cvt_pk_bf16_f32 v150, v152, v153
v_mul_f32 v154, v154, v83
v_mfma_f32_16x16x32_bf16 v[204:207], a[112:115], a[24:27], v[204:207]
s_waitcnt lgkmcnt(0)
s_barrier
v_mfma_f32_16x16x32_bf16 v[208:211], a[128:131], a[56:59], v[208:211]
ds_read_b128 v[92:95], v235 offset:0
v_mul_f32 v155, v155, v83
v_mfma_f32_16x16x32_bf16 v[208:211], a[132:135], a[60:63], v[208:211]
buffer_store_dwordx4 v[240:243], v254, s[4:7], s98 offen offset:2048 sc1
v_mfma_f32_16x16x32_bf16 v[184:187], a[132:135], a[52:55], v[184:187]
ds_read_b128 v[96:99], v235 offset:4096
v_cvt_pk_bf16_f32 v151, v154, v155
v_mfma_f32_16x16x32_bf16 v[184:187], a[128:131], a[48:51], v[184:187]
ds_write_b128 v233, v[212:215] offset:21504
v_cvt_pk_bf16_f32 v132, v132, v133
v_mfma_f32_16x16x32_bf16 v[160:163], a[128:131], a[40:43], v[160:163]
ds_read_b128 v[100:103], v235 offset:8192
v_cvt_pk_bf16_f32 v156, v156, v157
v_mfma_f32_16x16x32_bf16 v[160:163], a[132:135], a[44:47], v[160:163]
ds_write_b64 v232, v[220:221] offset:4096
v_cvt_pk_bf16_f32 v180, v180, v181
v_mfma_f32_16x16x32_bf16 v[136:139], a[132:135], a[36:39], v[136:139]
ds_read_b128 v[104:107], v235 offset:12288
v_cvt_pk_bf16_f32 v204, v204, v205
v_mfma_f32_16x16x32_bf16 v[136:139], a[128:131], a[32:35], v[136:139]
ds_write_b64 v232, v[222:223] offset:4608
v_cvt_pk_bf16_f32 v133, v134, v135
v_mfma_f32_16x16x32_bf16 v[136:139], a[136:139], a[64:67], v[136:139]
ds_write_b64 v232, v[196:197] offset:3072
v_cvt_pk_bf16_f32 v157, v158, v159
v_mfma_f32_16x16x32_bf16 v[136:139], a[140:143], a[68:71], v[136:139]
ds_write_b64 v232, v[198:199] offset:3584
v_cvt_pk_bf16_f32 v181, v182, v183
v_mfma_f32_16x16x32_bf16 v[160:163], a[140:143], a[76:79], v[160:163]
ds_write_b64 v232, v[172:173] offset:2048
s_waitcnt lgkmcnt(8)
v_add_f32 v92, v92, v96
v_mfma_f32_16x16x32_bf16 v[160:163], a[136:139], a[72:75], v[160:163]
ds_write_b64 v232, v[174:175] offset:2560
v_add_f32 v93, v93, v97
v_mfma_f32_16x16x32_bf16 v[184:187], a[136:139], a[80:83], v[184:187]
ds_write_b64 v232, v[148:149] offset:1024
v_add_f32 v94, v94, v98
v_mfma_f32_16x16x32_bf16 v[184:187], a[140:143], a[84:87], v[184:187]
buffer_store_dwordx4 v[244:247], v254, s[4:7], s99 offen offset:0 sc1
v_mfma_f32_16x16x32_bf16 v[208:211], a[140:143], a[92:95], v[208:211]
s_waitcnt lgkmcnt(6)
v_add_f32 v100, v100, v104
v_add_f32 v101, v101, v105
v_mfma_f32_16x16x32_bf16 v[208:211], a[136:139], a[88:91], v[208:211]
v_add_f32 v102, v102, v106
v_add_f32 v95, v95, v99
v_mfma_f32_16x16x32_bf16 v[208:211], a[144:147], a[24:27], v[208:211]
v_add_f32 v103, v103, v107
v_add_f32 v228, v92, v100
v_mfma_f32_16x16x32_bf16 v[208:211], a[148:151], a[28:31], v[208:211]
v_add_f32 v229, v93, v101
v_add_f32 v230, v94, v102
v_mfma_f32_16x16x32_bf16 v[184:187], a[148:151], a[20:23], v[184:187]
ds_write_b64 v232, v[150:151] offset:1536
v_add_f32 v231, v95, v103
v_mfma_f32_16x16x32_bf16 v[184:187], a[144:147], a[16:19], v[184:187]
v_fmac_f32 v228, v72, v90
v_fmac_f32 v229, v73, v90
v_mfma_f32_16x16x32_bf16 v[160:163], a[144:147], a[8:11], v[160:163]
v_fmac_f32 v230, v74, v90
v_fmac_f32 v231, v75, v90
v_mfma_f32_16x16x32_bf16 v[160:163], a[148:151], a[12:15], v[160:163]
v_cvt_pk_bf16_f32 v205, v206, v207
v_mul_f32 v228, v228, v91
v_mfma_f32_16x16x32_bf16 v[136:139], a[148:151], a[4:7], v[136:139]
v_mul_f32 v229, v229, v91
v_cvt_pk_bf16_f32 v228, v228, v229
v_mfma_f32_16x16x32_bf16 v[136:139], a[144:147], a[0:3], v[136:139]
v_mul_f32 v230, v230, v91
v_mul_f32 v231, v231, v91
s_add_u32 m0, s19, 32768
s_add_u32 s44, s84, 0xa00000
buffer_load_dwordx4 v1, s[4:7], s44 offen offset:0 sc1 lds
v_cvt_pk_bf16_f32 v229, v230, v231
v_pk_mul_f32 v[190:191], v[190:191], v[86:87] op_sel:[0,1] op_sel_hi:[1,1]
v_pk_mul_f32 v[166:167], v[166:167], v[84:85] op_sel:[0,1] op_sel_hi:[1,1]
v_pk_mul_f32 v[142:143], v[142:143], v[82:83] op_sel:[0,1] op_sel_hi:[1,1]
v_pk_mul_f32 v[192:193], v[192:193], v[86:87] op_sel:[0,1] op_sel_hi:[1,1]
v_pk_mul_f32 v[194:195], v[194:195], v[86:87] op_sel:[0,1] op_sel_hi:[1,1]
v_pk_mul_f32 v[168:169], v[168:169], v[84:85] op_sel:[0,1] op_sel_hi:[1,1]
v_pk_mul_f32 v[170:171], v[170:171], v[84:85] op_sel:[0,1] op_sel_hi:[1,1]
v_pk_mul_f32 v[144:145], v[144:145], v[82:83] op_sel:[0,1] op_sel_hi:[1,1]
v_pk_mul_f32 v[146:147], v[146:147], v[82:83] op_sel:[0,1] op_sel_hi:[1,1]
ds_write_b64 v9, v[228:229]
v_cvt_pk_bf16_f32 v189, v190, v191
v_cvt_pk_bf16_f32 v165, v166, v167
v_cvt_pk_bf16_f32 v141, v142, v143
v_cvt_pk_bf16_f32 v190, v192, v193
v_cvt_pk_bf16_f32 v191, v194, v195
v_cvt_pk_bf16_f32 v166, v168, v169
v_cvt_pk_bf16_f32 v167, v170, v171
v_cvt_pk_bf16_f32 v142, v144, v145
v_cvt_pk_bf16_f32 v143, v146, v147
v_cvt_pk_bf16_f32 v134, v136, v137
v_cvt_pk_bf16_f32 v135, v138, v139
v_cvt_pk_bf16_f32 v158, v160, v161
v_cvt_pk_bf16_f32 v159, v162, v163
v_cvt_pk_bf16_f32 v182, v184, v185
buffer_load_dwordx4 v1, s[4:7], s44 offen offset:1024 sc1 lds
v_cvt_pk_bf16_f32 v183, v186, v187
v_cvt_pk_bf16_f32 v206, v208, v209
v_cvt_pk_bf16_f32 v207, v210, v211
buffer_load_dwordx4 v1, s[4:7], s44 offen offset:2048 sc1 lds
buffer_load_dwordx4 v1, s[4:7], s44 offen offset:3072 sc1 lds
s_add_u32 m0, s19, 98304
s_add_u32 s44, s84, 0xa10000
buffer_load_dwordx4 v1, s[4:7], s44 offen offset:0 sc1 lds
buffer_load_dwordx4 v1, s[4:7], s44 offen offset:1024 sc1 lds
buffer_load_dwordx4 v1, s[4:7], s44 offen offset:2048 sc1 lds
buffer_load_dwordx4 v1, s[4:7], s44 offen offset:3072 sc1 lds
s_waitcnt lgkmcnt(0)
s_barrier
s_add_u32 m0, s19, 114688
s_add_u32 s44, s85, 0xa14000
buffer_load_dwordx4 v1, s[4:7], s44 offen offset:0 sc1 lds
v_mfma_f32_16x16x32_bf16 v[160:163], v[140:143], v[156:159], v[20:23]
ds_read_b128 a[0:3], v233 offset:20480
v_mfma_f32_16x16x32_bf16 v[176:179], v[164:167], v[156:159], v[24:27]
ds_read_b64_tr_b16 a[10:11], v248 offset:3072
v_mfma_f32_16x16x32_bf16 v[208:211], v[188:191], v[204:207], v[20:23]
ds_read_b64_tr_b16 a[12:13], v248 offset:4096
v_mfma_f32_16x16x32_bf16 v[224:227], v[212:215], v[204:207], v[24:27]
s_nop 3
v_max_f32 v176, v176, v160
v_max_f32 v177, v177, v161
v_max_f32 v178, v178, v162
v_max_f32 v179, v179, v163
v_max3_f32 v237, v176, v177, v178
v_max_f32 v237, v237, v179
ds_read_b64_tr_b16 a[22:23], v248 offset:3584
v_max_f32 v224, v224, v208
v_max_f32 v225, v225, v209
v_max_f32 v226, v226, v210
v_max_f32 v227, v227, v211
v_max3_f32 v239, v224, v225, v226
buffer_load_dwordx4 v1, s[4:7], s44 offen offset:1024 sc1 lds
v_max_f32 v239, v239, v227
ds_read_b64_tr_b16 a[24:25], v248 offset:4608
s_nop 0
v_permlane32_swap_b32 v239, v237
v_max_f32 v239, v239, v237
v_mov_b32 v242, v239
s_waitcnt lgkmcnt(4)
v_mfma_f32_16x16x32_bf16 v[136:139], a[0:3], v[132:135], v[76:79]
v_permlane16_swap_b32 v239, v242
v_max_f32 v239, v239, v242
v_mov_b32 v242, v239
v_mfma_f32_16x16x32_bf16 v[152:155], v[140:143], v[132:135], v[24:27]
s_nop 0
v_permlane32_swap_b32 v239, v242
v_mfma_f32_16x16x32_bf16 v[184:187], v[164:167], v[180:183], v[20:23]
v_mul_f32_e64 v89, -v239, v88
v_fma_f32 v224, v224, v88, v89
v_mfma_f32_16x16x32_bf16 v[200:203], v[188:191], v[180:183], v[24:27]
v_fma_f32 v225, v225, v88, v89
v_fma_f32 v226, v226, v88, v89
v_fma_f32 v227, v227, v88, v89
v_exp_f32 v224, v224
buffer_load_dwordx4 v1, s[4:7], s44 offen offset:2048 sc1 lds
v_exp_f32 v225, v225
v_exp_f32 v226, v226
v_exp_f32 v227, v227
v_max_f32 v152, v152, v136
v_max_f32 v153, v153, v137
v_max_f32 v154, v154, v138
v_max_f32 v200, v200, v184
v_max_f32 v201, v201, v185
v_max_f32 v202, v202, v186
v_cvt_pk_bf16_f32 v224, v224, v225
ds_read_b64_tr_b16 a[6:7], v248 offset:1024
ds_read_b64_tr_b16 a[8:9], v248 offset:2048
v_max_f32 v155, v155, v139
v_max3_f32 v236, v152, v153, v154
v_max_f32 v203, v203, v187
v_max3_f32 v238, v200, v201, v202
v_cvt_pk_bf16_f32 v225, v226, v227
ds_read_b64_tr_b16 a[18:19], v248 offset:1536
ds_read_b64_tr_b16 a[20:21], v248 offset:2560
v_max_f32 v236, v236, v155
buffer_load_dwordx4 v1, s[4:7], s44 offen offset:3072 sc1 lds
s_add_u32 m0, s19, 131072
s_add_u32 s44, s86, 0xa18000
v_max_f32 v238, v238, v203
v_and_b32 v208, v224, v28
v_and_b32 v209, v225, v29
v_and_b32 v210, v224, v30
v_and_b32 v211, v225, v31
v_permlane32_swap_b32 v238, v236
s_nop 0
v_mfma_f32_16x16x32_bf16 v[216:219], v[16:19], v[208:211], 0
v_max_f32 v238, v238, v236
v_mul_f32_e64 v85, -v242, v84
s_waitcnt lgkmcnt(6)
v_mfma_f32_16x16x32_bf16 v[116:119], a[10:13], v[208:211], 0
v_mov_b32 v243, v238
v_fma_f32 v176, v176, v84, v85
v_fma_f32 v177, v177, v84, v85
v_fma_f32 v178, v178, v84, v85
v_fma_f32 v179, v179, v84, v85
s_waitcnt lgkmcnt(4)
v_mfma_f32_16x16x32_bf16 v[120:123], a[22:25], v[208:211], 0
v_exp_f32 v176, v176
v_exp_f32 v177, v177
v_exp_f32 v178, v178
buffer_load_dwordx4 v1, s[4:7], s44 offen offset:0 sc1 lds
v_exp_f32 v179, v179
v_permlane16_swap_b32 v238, v243
v_rcp_f32 v216, v216
v_cvt_pk_bf16_f32 v176, v176, v177
v_max_f32 v238, v238, v243
v_cvt_pk_bf16_f32 v177, v178, v179
v_mov_b32 v243, v238
v_and_b32 v160, v176, v28
v_and_b32 v161, v177, v29
v_and_b32 v162, v176, v30
v_and_b32 v163, v177, v31
v_pk_mul_f32 v[116:117], v[116:117], v[216:217] op_sel:[0,0] op_sel_hi:[1,0]
v_pk_mul_f32 v[118:119], v[118:119], v[216:217] op_sel:[0,0] op_sel_hi:[1,0]
v_cvt_pk_bf16_f32 v116, v116, v117
v_pk_mul_f32 v[120:121], v[120:121], v[216:217] op_sel:[0,0] op_sel_hi:[1,0]
v_permlane32_swap_b32 v238, v243
v_pk_mul_f32 v[122:123], v[122:123], v[216:217] op_sel:[0,0] op_sel_hi:[1,0]
v_cvt_pk_bf16_f32 v117, v118, v119
v_mfma_f32_16x16x32_bf16 v[168:171], v[16:19], v[160:163], 0
v_cvt_pk_bf16_f32 v118, v120, v121
v_cvt_pk_bf16_f32 v119, v122, v123
v_mul_f32_e64 v87, -v238, v86
buffer_load_dwordx4 v1, s[4:7], s44 offen offset:1024 sc1 lds
s_waitcnt lgkmcnt(2)
v_mfma_f32_16x16x32_bf16 v[100:103], a[6:9], v[160:163], 0
v_fma_f32 v200, v200, v86, v87
v_fma_f32 v201, v201, v86, v87
v_fma_f32 v202, v202, v86, v87
v_fma_f32 v203, v203, v86, v87
s_waitcnt lgkmcnt(0)
v_mfma_f32_16x16x32_bf16 v[104:107], a[18:21], v[160:163], 0
v_exp_f32 v200, v200
v_exp_f32 v201, v201
v_exp_f32 v202, v202
v_exp_f32 v203, v203
v_rcp_f32 v168, v168
v_cvt_pk_bf16_f32 v200, v200, v201
ds_read_b64_tr_b16 a[4:5], v248 offset:0
v_cvt_pk_bf16_f32 v201, v202, v203
ds_read_b64_tr_b16 a[16:17], v248 offset:512
v_and_b32 v184, v200, v28
v_and_b32 v185, v201, v29
v_and_b32 v186, v200, v30
buffer_load_dwordx4 v1, s[4:7], s44 offen offset:2048 sc1 lds
v_and_b32 v187, v201, v31
v_pk_mul_f32 v[100:101], v[100:101], v[168:169] op_sel:[0,0] op_sel_hi:[1,0]
v_pk_mul_f32 v[102:103], v[102:103], v[168:169] op_sel:[0,0] op_sel_hi:[1,0]
v_cvt_pk_bf16_f32 v100, v100, v101
v_pk_mul_f32 v[104:105], v[104:105], v[168:169] op_sel:[0,0] op_sel_hi:[1,0]
v_cvt_pk_bf16_f32 v101, v102, v103
v_pk_mul_f32 v[106:107], v[106:107], v[168:169] op_sel:[0,0] op_sel_hi:[1,0]
v_cvt_pk_bf16_f32 v102, v104, v105
v_mfma_f32_16x16x32_bf16 v[192:195], v[16:19], v[184:187], 0
v_cvt_pk_bf16_f32 v103, v106, v107
v_mul_f32_e64 v83, -v243, v82
v_mfma_f32_16x16x32_bf16 v[108:111], a[8:11], v[184:187], 0
v_fma_f32 v152, v152, v82, v83
v_fma_f32 v153, v153, v82, v83
v_fma_f32 v154, v154, v82, v83
v_fma_f32 v155, v155, v82, v83
v_mfma_f32_16x16x32_bf16 v[112:115], a[20:23], v[184:187], 0
v_exp_f32 v152, v152
v_exp_f32 v153, v153
v_exp_f32 v154, v154
v_exp_f32 v155, v155
buffer_load_dwordx4 v1, s[4:7], s44 offen offset:3072 sc1 lds
v_rcp_f32 v192, v192
v_cvt_pk_bf16_f32 v152, v152, v153
v_cvt_pk_bf16_f32 v153, v154, v155
v_and_b32 v136, v152, v80
v_and_b32 v137, v153, v81
v_and_b32 v138, v152, v30
v_and_b32 v139, v153, v31
v_pk_mul_f32 v[108:109], v[108:109], v[192:193] op_sel:[0,0] op_sel_hi:[1,0]
v_pk_mul_f32 v[110:111], v[110:111], v[192:193] op_sel:[0,0] op_sel_hi:[1,0]
v_cvt_pk_bf16_f32 v108, v108, v109
v_pk_mul_f32 v[112:113], v[112:113], v[192:193] op_sel:[0,0] op_sel_hi:[1,0]
v_cvt_pk_bf16_f32 v109, v110, v111
v_pk_mul_f32 v[114:115], v[114:115], v[192:193] op_sel:[0,0] op_sel_hi:[1,0]
v_cvt_pk_bf16_f32 v110, v112, v113
v_mfma_f32_16x16x32_bf16 v[144:147], v[16:19], v[136:139], 0
v_cvt_pk_bf16_f32 v111, v114, v115
s_waitcnt lgkmcnt(1)
v_mfma_f32_16x16x32_bf16 v[92:95], a[4:7], v[136:139], 0
s_waitcnt lgkmcnt(0)
v_mfma_f32_16x16x32_bf16 v[96:99], a[16:19], v[136:139], 0
s_nop 2
v_rcp_f32 v144, v144
buffer_store_dwordx4 v[116:119], v2, s[4:7], s72 offen offset:3072 sc1
s_nop 0
v_pk_mul_f32 v[92:93], v[92:93], v[144:145] op_sel:[0,0] op_sel_hi:[1,0]
v_pk_mul_f32 v[94:95], v[94:95], v[144:145] op_sel:[0,0] op_sel_hi:[1,0]
v_cvt_pk_bf16_f32 v92, v92, v93
v_pk_mul_f32 v[96:97], v[96:97], v[144:145] op_sel:[0,0] op_sel_hi:[1,0]
v_pk_mul_f32 v[98:99], v[98:99], v[144:145] op_sel:[0,0] op_sel_hi:[1,0]
v_cvt_pk_bf16_f32 v93, v94, v95
v_cvt_pk_bf16_f32 v94, v96, v97
v_cvt_pk_bf16_f32 v95, v98, v99
buffer_store_dwordx4 v[100:103], v2, s[4:7], s72 offen offset:1024 sc1
buffer_store_dwordx4 v[108:111], v2, s[4:7], s72 offen offset:2048 sc1
buffer_store_dwordx4 v[92:95], v2, s[4:7], s72 offen offset:0 sc1
s_add_u32 s92, s71, 0x0
v_accvgpr_write_b32 a188, v48
v_accvgpr_write_b32 a189, v49
v_accvgpr_write_b32 a190, v50
v_accvgpr_write_b32 a191, v51
v_accvgpr_write_b32 a192, v52
v_accvgpr_write_b32 a193, v53
v_accvgpr_write_b32 a194, v54
v_accvgpr_write_b32 a195, v55
v_accvgpr_write_b32 a196, v56
v_accvgpr_write_b32 a197, v57
v_accvgpr_write_b32 a198, v58
v_accvgpr_write_b32 a199, v59
v_accvgpr_write_b32 a200, v60
v_accvgpr_write_b32 a201, v61
v_accvgpr_write_b32 a202, v62
v_accvgpr_write_b32 a203, v63
v_accvgpr_write_b32 a204, v64
v_accvgpr_write_b32 a205, v65
v_accvgpr_write_b32 a206, v66
v_accvgpr_write_b32 a207, v67
v_accvgpr_write_b32 a208, v68
v_accvgpr_write_b32 a209, v69
v_accvgpr_write_b32 a210, v70
v_accvgpr_write_b32 a211, v71
v_accvgpr_write_b32 a212, v72
v_accvgpr_write_b32 a213, v73
v_accvgpr_write_b32 a214, v74
v_accvgpr_write_b32 a215, v75
s_add_u32 s40, s4, 0x1e00000
s_addc_u32 s41, s5, 0
v_add_u32 v5, 32768, v1
v_add_u32 v6, 98304, v1
s_cmp_eq_u32 s3, 0
s_cselect_b32 s35, 8, 0
s_lshl_b32 s35, s35, 12
v_lshlrev_b32 v132, 16, v32
v_and_b32 v133, 0xffff0000, v32
v_lshlrev_b32 v134, 16, v33
v_and_b32 v135, 0xffff0000, v33
v_lshlrev_b32 v136, 16, v34
v_and_b32 v137, 0xffff0000, v34
v_lshlrev_b32 v138, 16, v35
v_and_b32 v139, 0xffff0000, v35
v_lshlrev_b32 v140, 16, v36
v_and_b32 v141, 0xffff0000, v36
v_lshlrev_b32 v142, 16, v37
v_and_b32 v143, 0xffff0000, v37
v_lshlrev_b32 v144, 16, v38
v_and_b32 v145, 0xffff0000, v38
v_lshlrev_b32 v146, 16, v39
v_and_b32 v147, 0xffff0000, v39
v_lshlrev_b32 v148, 16, v40
v_and_b32 v149, 0xffff0000, v40
v_lshlrev_b32 v150, 16, v41
v_and_b32 v151, 0xffff0000, v41
v_lshlrev_b32 v152, 16, v42
v_and_b32 v153, 0xffff0000, v42
v_lshlrev_b32 v154, 16, v43
v_and_b32 v155, 0xffff0000, v43
v_lshlrev_b32 v156, 16, v44
v_and_b32 v157, 0xffff0000, v44
v_lshlrev_b32 v158, 16, v45
v_and_b32 v159, 0xffff0000, v45
v_lshlrev_b32 v160, 16, v46
v_and_b32 v161, 0xffff0000, v46
v_lshlrev_b32 v162, 16, v47
v_and_b32 v163, 0xffff0000, v47
s_waitcnt vmcnt(0)
s_barrier
s_cmp_lg_u32 s28, 1
s_cbranch_scc1 Lsg_4
buffer_atomic_add v12, v10, s[4:7], s92 offen sc1
buffer_atomic_swap v15, v14, s[4:7], s8 offen sc1
buffer_atomic_swap v15, v252, s[4:7], s62 offen offset:64 sc1
Lsg_4:
s_mov_b64 exec, 0
s_cmp_eq_u32 s28, 1
s_cbranch_scc1 L_stub3
L_wret1:
s_mov_b64 exec, -1
s_add_u32 m0, s19, 147456
s_add_u32 s44, s87, 0xa1c000
buffer_load_dwordx4 v1, s[4:7], s44 offen offset:0 sc1 lds
buffer_load_dwordx4 v1, s[4:7], s44 offen offset:1024 sc1 lds
buffer_load_dwordx4 v1, s[4:7], s44 offen offset:2048 sc1 lds
buffer_load_dwordx4 v1, s[4:7], s44 offen offset:3072 sc1 lds
s_cmp_lg_u32 s28, 0
s_cbranch_scc1 Lpo_7
s_add_u32 s36, s66, 0x0
s_mov_b32 s37, 0
v_mov_b32 v11, 0
buffer_atomic_add v11, v251, s[4:7], s36 offen sc0 sc1
s_sleep 4
Lpoll_5:
v_mov_b32 v234, 0
buffer_atomic_add v234, v251, s[4:7], s36 offen sc0 sc1
s_waitcnt vmcnt(1)
v_readfirstlane_b32 s38, v11
s_nop 0
s_cmp_ge_u32 s38, 32
s_cbranch_scc1 Lpe_6
v_mov_b32 v11, 0
buffer_atomic_add v11, v251, s[4:7], s36 offen sc0 sc1
s_waitcnt vmcnt(1)
v_readfirstlane_b32 s38, v234
s_nop 0
s_cmp_ge_u32 s38, 32
s_cbranch_scc1 Lpe_6
s_add_u32 s37, s37, 1
s_cmp_lt_u32 s37, 0x80000
s_cbranch_scc1 Lpoll_5
s_waitcnt vmcnt(0)
Lpo_7:
s_waitcnt vmcnt(0)
Lpe_6:
s_barrier
L_k2go0:
buffer_load_dwordx4 a[0:3], v4, s[40:43], s35 offen offset:0 sc1
buffer_load_dwordx4 a[4:7], v4, s[40:43], s35 offen offset:1024 sc1
s_cmp_eq_u32 s3, 1
s_cselect_b32 s35, 9, 1
s_lshl_b32 s35, s35, 12
buffer_load_dwordx4 a[8:11], v4, s[40:43], s35 offen offset:0 sc1
buffer_load_dwordx4 a[12:15], v4, s[40:43], s35 offen offset:1024 sc1
s_cmp_eq_u32 s3, 2
s_cselect_b32 s35, 10, 2
s_lshl_b32 s35, s35, 12
buffer_load_dwordx4 a[16:19], v4, s[40:43], s35 offen offset:0 sc1
buffer_load_dwordx4 a[20:23], v4, s[40:43], s35 offen offset:1024 sc1
s_cmp_eq_u32 s3, 3
s_cselect_b32 s35, 11, 3
s_lshl_b32 s35, s35, 12
buffer_load_dwordx4 a[24:27], v4, s[40:43], s35 offen offset:0 sc1
buffer_load_dwordx4 a[28:31], v4, s[40:43], s35 offen offset:1024 sc1
s_cmp_eq_u32 s3, 4
s_cselect_b32 s35, 12, 4
s_lshl_b32 s35, s35, 12
buffer_load_dwordx4 a[32:35], v4, s[40:43], s35 offen offset:0 sc1
buffer_load_dwordx4 a[36:39], v4, s[40:43], s35 offen offset:1024 sc1
s_cmp_eq_u32 s3, 5
s_cselect_b32 s35, 13, 5
s_lshl_b32 s35, s35, 12
ds_read_b128 a[96:99], v5 offset:0
ds_read_b128 a[100:103], v5 offset:1024
ds_read_b128 a[104:107], v5 offset:2048
ds_read_b128 a[108:111], v5 offset:3072
ds_read_b128 a[112:115], v5 offset:4096
ds_read_b128 a[116:119], v5 offset:5120
ds_read_b128 a[120:123], v5 offset:6144
ds_read_b128 a[124:127], v5 offset:7168
s_waitcnt vmcnt(8) lgkmcnt(4)
v_mfma_f32_16x16x32_bf16 v[132:135], a[96:99], a[0:3], v[132:135]
ds_read_b128 a[128:131], v5 offset:8192
v_mfma_f32_16x16x32_bf16 v[148:151], a[96:99], a[4:7], v[148:151]
ds_read_b128 a[132:135], v5 offset:9216
v_mfma_f32_16x16x32_bf16 v[152:155], a[100:103], a[4:7], v[152:155]
buffer_load_dwordx4 a[40:43], v4, s[40:43], s35 offen offset:0 sc1
v_mfma_f32_16x16x32_bf16 v[136:139], a[100:103], a[0:3], v[136:139]
ds_read_b128 a[136:139], v5 offset:10240
v_mfma_f32_16x16x32_bf16 v[140:143], a[104:107], a[0:3], v[140:143]
ds_read_b128 a[140:143], v5 offset:11264
v_mfma_f32_16x16x32_bf16 v[156:159], a[104:107], a[4:7], v[156:159]
v_mfma_f32_16x16x32_bf16 v[160:163], a[108:111], a[4:7], v[160:163]
buffer_load_dwordx4 a[44:47], v4, s[40:43], s35 offen offset:1024 sc1
v_mfma_f32_16x16x32_bf16 v[144:147], a[108:111], a[0:3], v[144:147]
s_waitcnt vmcnt(8) lgkmcnt(4)
v_mfma_f32_16x16x32_bf16 v[132:135], a[112:115], a[8:11], v[132:135]
s_cmp_eq_u32 s3, 6
s_cselect_b32 s35, 14, 6
s_lshl_b32 s35, s35, 12
v_mfma_f32_16x16x32_bf16 v[148:151], a[112:115], a[12:15], v[148:151]
ds_read_b128 a[96:99], v5 offset:12288
v_mfma_f32_16x16x32_bf16 v[152:155], a[116:119], a[12:15], v[152:155]
buffer_load_dwordx4 a[0:3], v4, s[40:43], s35 offen offset:0 sc1
v_mfma_f32_16x16x32_bf16 v[136:139], a[116:119], a[8:11], v[136:139]
ds_read_b128 a[100:103], v5 offset:13312
v_mfma_f32_16x16x32_bf16 v[140:143], a[120:123], a[8:11], v[140:143]
ds_read_b128 a[104:107], v5 offset:14336
v_mfma_f32_16x16x32_bf16 v[156:159], a[120:123], a[12:15], v[156:159]
ds_read_b128 a[108:111], v5 offset:15360
v_mfma_f32_16x16x32_bf16 v[160:163], a[124:127], a[12:15], v[160:163]
L_stub3:
s_cbranch_execz L_stub4
buffer_load_dwordx4 a[4:7], v4, s[40:43], s35 offen offset:1024 sc1
v_mfma_f32_16x16x32_bf16 v[144:147], a[124:127], a[8:11], v[144:147]
s_waitcnt vmcnt(8) lgkmcnt(4)
v_mfma_f32_16x16x32_bf16 v[132:135], a[128:131], a[16:19], v[132:135]
s_cmp_eq_u32 s3, 7
s_cselect_b32 s35, 15, 7
s_lshl_b32 s35, s35, 12
v_mfma_f32_16x16x32_bf16 v[148:151], a[128:131], a[20:23], v[148:151]
ds_read_b128 a[112:115], v5 offset:16384
v_mfma_f32_16x16x32_bf16 v[152:155], a[132:135], a[20:23], v[152:155]
buffer_load_dwordx4 a[8:11], v4, s[40:43], s35 offen offset:0 sc1
v_mfma_f32_16x16x32_bf16 v[136:139], a[132:135], a[16:19], v[136:139]
ds_read_b128 a[116:119], v5 offset:17408
v_mfma_f32_16x16x32_bf16 v[140:143], a[136:139], a[16:19], v[140:143]
ds_read_b128 a[120:123], v5 offset:18432
v_mfma_f32_16x16x32_bf16 v[156:159], a[136:139], a[20:23], v[156:159]
ds_read_b128 a[124:127], v5 offset:19456
v_mfma_f32_16x16x32_bf16 v[160:163], a[140:143], a[20:23], v[160:163]
buffer_load_dwordx4 a[12:15], v4, s[40:43], s35 offen offset:1024 sc1
v_mfma_f32_16x16x32_bf16 v[144:147], a[140:143], a[16:19], v[144:147]
s_waitcnt vmcnt(8) lgkmcnt(4)
v_mfma_f32_16x16x32_bf16 v[132:135], a[96:99], a[24:27], v[132:135]
s_cmp_eq_u32 s3, 0
s_cselect_b32 s35, 16, 8
s_lshl_b32 s35, s35, 12
v_mfma_f32_16x16x32_bf16 v[148:151], a[96:99], a[28:31], v[148:151]
ds_read_b128 a[128:131], v5 offset:20480
v_mfma_f32_16x16x32_bf16 v[152:155], a[100:103], a[28:31], v[152:155]
buffer_load_dwordx4 a[16:19], v4, s[40:43], s35 offen offset:0 sc1
v_mfma_f32_16x16x32_bf16 v[136:139], a[100:103], a[24:27], v[136:139]
ds_read_b128 a[132:135], v5 offset:21504
v_mfma_f32_16x16x32_bf16 v[140:143], a[104:107], a[24:27], v[140:143]
ds_read_b128 a[136:139], v5 offset:22528
v_mfma_f32_16x16x32_bf16 v[156:159], a[104:107], a[28:31], v[156:159]
ds_read_b128 a[140:143], v5 offset:23552
v_mfma_f32_16x16x32_bf16 v[160:163], a[108:111], a[28:31], v[160:163]
buffer_load_dwordx4 a[20:23], v4, s[40:43], s35 offen offset:1024 sc1
v_mfma_f32_16x16x32_bf16 v[144:147], a[108:111], a[24:27], v[144:147]
s_waitcnt vmcnt(8) lgkmcnt(4)
v_mfma_f32_16x16x32_bf16 v[132:135], a[112:115], a[32:35], v[132:135]
s_cmp_eq_u32 s3, 1
s_cselect_b32 s35, 17, 9
s_lshl_b32 s35, s35, 12
v_mfma_f32_16x16x32_bf16 v[148:151], a[112:115], a[36:39], v[148:151]
ds_read_b128 a[96:99], v5 offset:24576
v_mfma_f32_16x16x32_bf16 v[152:155], a[116:119], a[36:39], v[152:155]
buffer_load_dwordx4 a[24:27], v4, s[40:43], s35 offen offset:0 sc1
v_mfma_f32_16x16x32_bf16 v[136:139], a[116:119], a[32:35], v[136:139]
ds_read_b128 a[100:103], v5 offset:25600
v_mfma_f32_16x16x32_bf16 v[140:143], a[120:123], a[32:35], v[140:143]
ds_read_b128 a[104:107], v5 offset:26624
v_mfma_f32_16x16x32_bf16 v[156:159], a[120:123], a[36:39], v[156:159]
ds_read_b128 a[108:111], v5 offset:27648
v_mfma_f32_16x16x32_bf16 v[160:163], a[124:127], a[36:39], v[160:163]
buffer_load_dwordx4 a[28:31], v4, s[40:43], s35 offen offset:1024 sc1
v_mfma_f32_16x16x32_bf16 v[144:147], a[124:127], a[32:35], v[144:147]
s_waitcnt vmcnt(8) lgkmcnt(4)
v_mfma_f32_16x16x32_bf16 v[132:135], a[128:131], a[40:43], v[132:135]
s_cmp_eq_u32 s3, 2
s_cselect_b32 s35, 18, 10
s_lshl_b32 s35, s35, 12
v_mfma_f32_16x16x32_bf16 v[148:151], a[128:131], a[44:47], v[148:151]
ds_read_b128 a[112:115], v5 offset:28672
v_mfma_f32_16x16x32_bf16 v[152:155], a[132:135], a[44:47], v[152:155]
buffer_load_dwordx4 a[32:35], v4, s[40:43], s35 offen offset:0 sc1
v_mfma_f32_16x16x32_bf16 v[136:139], a[132:135], a[40:43], v[136:139]
ds_read_b128 a[116:119], v5 offset:29696
v_mfma_f32_16x16x32_bf16 v[140:143], a[136:139], a[40:43], v[140:143]
ds_read_b128 a[120:123], v5 offset:30720
v_mfma_f32_16x16x32_bf16 v[156:159], a[136:139], a[44:47], v[156:159]
ds_read_b128 a[124:127], v5 offset:31744
v_mfma_f32_16x16x32_bf16 v[160:163], a[140:143], a[44:47], v[160:163]
buffer_load_dwordx4 a[36:39], v4, s[40:43], s35 offen offset:1024 sc1
v_mfma_f32_16x16x32_bf16 v[144:147], a[140:143], a[40:43], v[144:147]
s_waitcnt vmcnt(8) lgkmcnt(4)
v_mfma_f32_16x16x32_bf16 v[132:135], a[96:99], a[0:3], v[132:135]
s_cmp_eq_u32 s3, 3
s_cselect_b32 s35, 19, 11
s_lshl_b32 s35, s35, 12
v_mfma_f32_16x16x32_bf16 v[148:151], a[96:99], a[4:7], v[148:151]
ds_read_b128 a[128:131], v5 offset:32768
v_mfma_f32_16x16x32_bf16 v[152:155], a[100:103], a[4:7], v[152:155]
buffer_load_dwordx4 a[40:43], v4, s[40:43], s35 offen offset:0 sc1
v_mfma_f32_16x16x32_bf16 v[136:139], a[100:103], a[0:3], v[136:139]
ds_read_b128 a[132:135], v5 offset:33792
v_mfma_f32_16x16x32_bf16 v[140:143], a[104:107], a[0:3], v[140:143]
ds_read_b128 a[136:139], v5 offset:34816
v_mfma_f32_16x16x32_bf16 v[156:159], a[104:107], a[4:7], v[156:159]
ds_read_b128 a[140:143], v5 offset:35840
v_mfma_f32_16x16x32_bf16 v[160:163], a[108:111], a[4:7], v[160:163]
buffer_load_dwordx4 a[44:47], v4, s[40:43], s35 offen offset:1024 sc1
v_mfma_f32_16x16x32_bf16 v[144:147], a[108:111], a[0:3], v[144:147]
s_waitcnt vmcnt(8) lgkmcnt(4)
v_mfma_f32_16x16x32_bf16 v[132:135], a[112:115], a[8:11], v[132:135]
s_cmp_eq_u32 s3, 4
s_cselect_b32 s35, 20, 12
s_lshl_b32 s35, s35, 12
v_mfma_f32_16x16x32_bf16 v[148:151], a[112:115], a[12:15], v[148:151]
ds_read_b128 a[96:99], v5 offset:36864
v_mfma_f32_16x16x32_bf16 v[152:155], a[116:119], a[12:15], v[152:155]
buffer_load_dwordx4 a[0:3], v4, s[40:43], s35 offen offset:0 sc1
v_mfma_f32_16x16x32_bf16 v[136:139], a[116:119], a[8:11], v[136:139]
ds_read_b128 a[100:103], v5 offset:37888
v_mfma_f32_16x16x32_bf16 v[140:143], a[120:123], a[8:11], v[140:143]
ds_read_b128 a[104:107], v5 offset:38912
v_mfma_f32_16x16x32_bf16 v[156:159], a[120:123], a[12:15], v[156:159]
ds_read_b128 a[108:111], v5 offset:39936
v_mfma_f32_16x16x32_bf16 v[160:163], a[124:127], a[12:15], v[160:163]
buffer_load_dwordx4 a[4:7], v4, s[40:43], s35 offen offset:1024 sc1
v_mfma_f32_16x16x32_bf16 v[144:147], a[124:127], a[8:11], v[144:147]
s_waitcnt vmcnt(8) lgkmcnt(4)
v_mfma_f32_16x16x32_bf16 v[132:135], a[128:131], a[16:19], v[132:135]
s_cmp_eq_u32 s3, 5
s_cselect_b32 s35, 21, 13
s_lshl_b32 s35, s35, 12
v_mfma_f32_16x16x32_bf16 v[148:151], a[128:131], a[20:23], v[148:151]
ds_read_b128 a[112:115], v5 offset:40960
v_mfma_f32_16x16x32_bf16 v[152:155], a[132:135], a[20:23], v[152:155]
buffer_load_dwordx4 a[8:11], v4, s[40:43], s35 offen offset:0 sc1
v_mfma_f32_16x16x32_bf16 v[136:139], a[132:135], a[16:19], v[136:139]
ds_read_b128 a[116:119], v5 offset:41984
v_mfma_f32_16x16x32_bf16 v[140:143], a[136:139], a[16:19], v[140:143]
ds_read_b128 a[120:123], v5 offset:43008
v_mfma_f32_16x16x32_bf16 v[156:159], a[136:139], a[20:23], v[156:159]
ds_read_b128 a[124:127], v5 offset:44032
v_mfma_f32_16x16x32_bf16 v[160:163], a[140:143], a[20:23], v[160:163]
buffer_load_dwordx4 a[12:15], v4, s[40:43], s35 offen offset:1024 sc1
v_mfma_f32_16x16x32_bf16 v[144:147], a[140:143], a[16:19], v[144:147]
s_waitcnt vmcnt(8) lgkmcnt(4)
v_mfma_f32_16x16x32_bf16 v[132:135], a[96:99], a[24:27], v[132:135]
s_cmp_eq_u32 s3, 6
s_cselect_b32 s35, 22, 14
s_lshl_b32 s35, s35, 12
v_mfma_f32_16x16x32_bf16 v[148:151], a[96:99], a[28:31], v[148:151]
ds_read_b128 a[128:131], v5 offset:45056
v_mfma_f32_16x16x32_bf16 v[152:155], a[100:103], a[28:31], v[152:155]
buffer_load_dwordx4 a[16:19], v4, s[40:43], s35 offen offset:0 sc1
v_mfma_f32_16x16x32_bf16 v[136:139], a[100:103], a[24:27], v[136:139]
ds_read_b128 a[132:135], v5 offset:46080
v_mfma_f32_16x16x32_bf16 v[140:143], a[104:107], a[24:27], v[140:143]
ds_read_b128 a[136:139], v5 offset:47104
v_mfma_f32_16x16x32_bf16 v[156:159], a[104:107], a[28:31], v[156:159]
ds_read_b128 a[140:143], v5 offset:48128
v_mfma_f32_16x16x32_bf16 v[160:163], a[108:111], a[28:31], v[160:163]
buffer_load_dwordx4 a[20:23], v4, s[40:43], s35 offen offset:1024 sc1
v_mfma_f32_16x16x32_bf16 v[144:147], a[108:111], a[24:27], v[144:147]
s_waitcnt vmcnt(8) lgkmcnt(4)
v_mfma_f32_16x16x32_bf16 v[132:135], a[112:115], a[32:35], v[132:135]
s_cmp_eq_u32 s3, 7
s_cselect_b32 s35, 23, 15
s_lshl_b32 s35, s35, 12
v_mfma_f32_16x16x32_bf16 v[148:151], a[112:115], a[36:39], v[148:151]
ds_read_b128 a[96:99], v5 offset:49152
v_mfma_f32_16x16x32_bf16 v[152:155], a[116:119], a[36:39], v[152:155]
buffer_load_dwordx4 a[24:27], v4, s[40:43], s35 offen offset:0 sc1
v_mfma_f32_16x16x32_bf16 v[136:139], a[116:119], a[32:35], v[136:139]
ds_read_b128 a[100:103], v5 offset:50176
v_mfma_f32_16x16x32_bf16 v[140:143], a[120:123], a[32:35], v[140:143]
ds_read_b128 a[104:107], v5 offset:51200
v_mfma_f32_16x16x32_bf16 v[156:159], a[120:123], a[36:39], v[156:159]
ds_read_b128 a[108:111], v5 offset:52224
v_mfma_f32_16x16x32_bf16 v[160:163], a[124:127], a[36:39], v[160:163]
buffer_load_dwordx4 a[28:31], v4, s[40:43], s35 offen offset:1024 sc1
v_mfma_f32_16x16x32_bf16 v[144:147], a[124:127], a[32:35], v[144:147]
s_waitcnt vmcnt(8) lgkmcnt(4)
v_mfma_f32_16x16x32_bf16 v[132:135], a[128:131], a[40:43], v[132:135]
s_cmp_eq_u32 s3, 0
s_cselect_b32 s35, 24, 16
s_lshl_b32 s35, s35, 12
v_mfma_f32_16x16x32_bf16 v[148:151], a[128:131], a[44:47], v[148:151]
ds_read_b128 a[112:115], v5 offset:53248
v_mfma_f32_16x16x32_bf16 v[152:155], a[132:135], a[44:47], v[152:155]
buffer_load_dwordx4 a[32:35], v4, s[40:43], s35 offen offset:0 sc1
v_mfma_f32_16x16x32_bf16 v[136:139], a[132:135], a[40:43], v[136:139]
ds_read_b128 a[116:119], v5 offset:54272
v_mfma_f32_16x16x32_bf16 v[140:143], a[136:139], a[40:43], v[140:143]
ds_read_b128 a[120:123], v5 offset:55296
v_mfma_f32_16x16x32_bf16 v[156:159], a[136:139], a[44:47], v[156:159]
ds_read_b128 a[124:127], v5 offset:56320
v_mfma_f32_16x16x32_bf16 v[160:163], a[140:143], a[44:47], v[160:163]
buffer_load_dwordx4 a[36:39], v4, s[40:43], s35 offen offset:1024 sc1
v_mfma_f32_16x16x32_bf16 v[144:147], a[140:143], a[40:43], v[144:147]
s_waitcnt vmcnt(8) lgkmcnt(4)
v_mfma_f32_16x16x32_bf16 v[132:135], a[96:99], a[0:3], v[132:135]
s_cmp_eq_u32 s3, 1
s_cselect_b32 s35, 25, 17
s_lshl_b32 s35, s35, 12
v_mfma_f32_16x16x32_bf16 v[148:151], a[96:99], a[4:7], v[148:151]
ds_read_b128 a[128:131], v5 offset:57344
v_mfma_f32_16x16x32_bf16 v[152:155], a[100:103], a[4:7], v[152:155]
buffer_load_dwordx4 a[40:43], v4, s[40:43], s35 offen offset:0 sc1
v_mfma_f32_16x16x32_bf16 v[136:139], a[100:103], a[0:3], v[136:139]
ds_read_b128 a[132:135], v5 offset:58368
v_mfma_f32_16x16x32_bf16 v[140:143], a[104:107], a[0:3], v[140:143]
ds_read_b128 a[136:139], v5 offset:59392
v_mfma_f32_16x16x32_bf16 v[156:159], a[104:107], a[4:7], v[156:159]
ds_read_b128 a[140:143], v5 offset:60416
v_mfma_f32_16x16x32_bf16 v[160:163], a[108:111], a[4:7], v[160:163]
buffer_load_dwordx4 a[44:47], v4, s[40:43], s35 offen offset:1024 sc1
v_mfma_f32_16x16x32_bf16 v[144:147], a[108:111], a[0:3], v[144:147]
s_waitcnt vmcnt(8) lgkmcnt(4)
v_mfma_f32_16x16x32_bf16 v[132:135], a[112:115], a[8:11], v[132:135]
s_cmp_eq_u32 s3, 2
s_cselect_b32 s35, 26, 18
s_lshl_b32 s35, s35, 12
v_mfma_f32_16x16x32_bf16 v[148:151], a[112:115], a[12:15], v[148:151]
ds_read_b128 a[96:99], v5 offset:61440
v_mfma_f32_16x16x32_bf16 v[152:155], a[116:119], a[12:15], v[152:155]
buffer_load_dwordx4 a[0:3], v4, s[40:43], s35 offen offset:0 sc1
v_mfma_f32_16x16x32_bf16 v[136:139], a[116:119], a[8:11], v[136:139]
ds_read_b128 a[100:103], v5 offset:62464
v_mfma_f32_16x16x32_bf16 v[140:143], a[120:123], a[8:11], v[140:143]
ds_read_b128 a[104:107], v5 offset:63488
v_mfma_f32_16x16x32_bf16 v[156:159], a[120:123], a[12:15], v[156:159]
ds_read_b128 a[108:111], v5 offset:64512
v_mfma_f32_16x16x32_bf16 v[160:163], a[124:127], a[12:15], v[160:163]
buffer_load_dwordx4 a[4:7], v4, s[40:43], s35 offen offset:1024 sc1
v_mfma_f32_16x16x32_bf16 v[144:147], a[124:127], a[8:11], v[144:147]
s_waitcnt vmcnt(8) lgkmcnt(4)
v_mfma_f32_16x16x32_bf16 v[132:135], a[128:131], a[16:19], v[132:135]
s_cmp_eq_u32 s3, 3
s_cselect_b32 s35, 27, 19
s_lshl_b32 s35, s35, 12
v_mfma_f32_16x16x32_bf16 v[148:151], a[128:131], a[20:23], v[148:151]
ds_read_b128 a[112:115], v6 offset:0
v_mfma_f32_16x16x32_bf16 v[152:155], a[132:135], a[20:23], v[152:155]
buffer_load_dwordx4 a[8:11], v4, s[40:43], s35 offen offset:0 sc1
v_mfma_f32_16x16x32_bf16 v[136:139], a[132:135], a[16:19], v[136:139]
ds_read_b128 a[116:119], v6 offset:1024
v_mfma_f32_16x16x32_bf16 v[140:143], a[136:139], a[16:19], v[140:143]
ds_read_b128 a[120:123], v6 offset:2048
v_mfma_f32_16x16x32_bf16 v[156:159], a[136:139], a[20:23], v[156:159]
ds_read_b128 a[124:127], v6 offset:3072
v_mfma_f32_16x16x32_bf16 v[160:163], a[140:143], a[20:23], v[160:163]
buffer_load_dwordx4 a[12:15], v4, s[40:43], s35 offen offset:1024 sc1
v_mfma_f32_16x16x32_bf16 v[144:147], a[140:143], a[16:19], v[144:147]
s_waitcnt vmcnt(8) lgkmcnt(4)
v_mfma_f32_16x16x32_bf16 v[132:135], a[96:99], a[24:27], v[132:135]
s_cmp_eq_u32 s3, 4
s_cselect_b32 s35, 28, 20
s_lshl_b32 s35, s35, 12
v_mfma_f32_16x16x32_bf16 v[148:151], a[96:99], a[28:31], v[148:151]
ds_read_b128 a[128:131], v6 offset:4096
v_mfma_f32_16x16x32_bf16 v[152:155], a[100:103], a[28:31], v[152:155]
buffer_load_dwordx4 a[16:19], v4, s[40:43], s35 offen offset:0 sc1
v_mfma_f32_16x16x32_bf16 v[136:139], a[100:103], a[24:27], v[136:139]
ds_read_b128 a[132:135], v6 offset:5120
v_mfma_f32_16x16x32_bf16 v[140:143], a[104:107], a[24:27], v[140:143]
ds_read_b128 a[136:139], v6 offset:6144
v_mfma_f32_16x16x32_bf16 v[156:159], a[104:107], a[28:31], v[156:159]
ds_read_b128 a[140:143], v6 offset:7168
v_mfma_f32_16x16x32_bf16 v[160:163], a[108:111], a[28:31], v[160:163]
buffer_load_dwordx4 a[20:23], v4, s[40:43], s35 offen offset:1024 sc1
v_mfma_f32_16x16x32_bf16 v[144:147], a[108:111], a[24:27], v[144:147]
s_waitcnt vmcnt(8) lgkmcnt(4)
v_mfma_f32_16x16x32_bf16 v[132:135], a[112:115], a[32:35], v[132:135]
s_cmp_eq_u32 s3, 5
s_cselect_b32 s35, 29, 21
s_lshl_b32 s35, s35, 12
v_mfma_f32_16x16x32_bf16 v[148:151], a[112:115], a[36:39], v[148:151]
ds_read_b128 a[96:99], v6 offset:8192
v_mfma_f32_16x16x32_bf16 v[152:155], a[116:119], a[36:39], v[152:155]
buffer_load_dwordx4 a[24:27], v4, s[40:43], s35 offen offset:0 sc1
v_mfma_f32_16x16x32_bf16 v[136:139], a[116:119], a[32:35], v[136:139]
ds_read_b128 a[100:103], v6 offset:9216
v_mfma_f32_16x16x32_bf16 v[140:143], a[120:123], a[32:35], v[140:143]
ds_read_b128 a[104:107], v6 offset:10240
v_mfma_f32_16x16x32_bf16 v[156:159], a[120:123], a[36:39], v[156:159]
ds_read_b128 a[108:111], v6 offset:11264
v_mfma_f32_16x16x32_bf16 v[160:163], a[124:127], a[36:39], v[160:163]
buffer_load_dwordx4 a[28:31], v4, s[40:43], s35 offen offset:1024 sc1
v_mfma_f32_16x16x32_bf16 v[144:147], a[124:127], a[32:35], v[144:147]
s_waitcnt vmcnt(8) lgkmcnt(4)
v_mfma_f32_16x16x32_bf16 v[132:135], a[128:131], a[40:43], v[132:135]
s_cmp_eq_u32 s3, 6
s_cselect_b32 s35, 30, 22
s_lshl_b32 s35, s35, 12
v_mfma_f32_16x16x32_bf16 v[148:151], a[128:131], a[44:47], v[148:151]
ds_read_b128 a[112:115], v6 offset:12288
v_mfma_f32_16x16x32_bf16 v[152:155], a[132:135], a[44:47], v[152:155]
buffer_load_dwordx4 a[32:35], v4, s[40:43], s35 offen offset:0 sc1
v_mfma_f32_16x16x32_bf16 v[136:139], a[132:135], a[40:43], v[136:139]
ds_read_b128 a[116:119], v6 offset:13312
v_mfma_f32_16x16x32_bf16 v[140:143], a[136:139], a[40:43], v[140:143]
ds_read_b128 a[120:123], v6 offset:14336
v_mfma_f32_16x16x32_bf16 v[156:159], a[136:139], a[44:47], v[156:159]
ds_read_b128 a[124:127], v6 offset:15360
v_mfma_f32_16x16x32_bf16 v[160:163], a[140:143], a[44:47], v[160:163]
buffer_load_dwordx4 a[36:39], v4, s[40:43], s35 offen offset:1024 sc1
v_mfma_f32_16x16x32_bf16 v[144:147], a[140:143], a[40:43], v[144:147]
s_waitcnt vmcnt(8) lgkmcnt(4)
v_mfma_f32_16x16x32_bf16 v[132:135], a[96:99], a[0:3], v[132:135]
s_cmp_eq_u32 s3, 7
s_cselect_b32 s35, 31, 23
s_lshl_b32 s35, s35, 12
v_mfma_f32_16x16x32_bf16 v[148:151], a[96:99], a[4:7], v[148:151]
ds_read_b128 a[128:131], v6 offset:16384
v_mfma_f32_16x16x32_bf16 v[152:155], a[100:103], a[4:7], v[152:155]
buffer_load_dwordx4 a[40:43], v4, s[40:43], s35 offen offset:0 sc1
v_mfma_f32_16x16x32_bf16 v[136:139], a[100:103], a[0:3], v[136:139]
ds_read_b128 a[132:135], v6 offset:17408
v_mfma_f32_16x16x32_bf16 v[140:143], a[104:107], a[0:3], v[140:143]
ds_read_b128 a[136:139], v6 offset:18432
v_mfma_f32_16x16x32_bf16 v[156:159], a[104:107], a[4:7], v[156:159]
ds_read_b128 a[140:143], v6 offset:19456
v_mfma_f32_16x16x32_bf16 v[160:163], a[108:111], a[4:7], v[160:163]
buffer_load_dwordx4 a[44:47], v4, s[40:43], s35 offen offset:1024 sc1
v_mfma_f32_16x16x32_bf16 v[144:147], a[108:111], a[0:3], v[144:147]
s_waitcnt vmcnt(8) lgkmcnt(4)
v_mfma_f32_16x16x32_bf16 v[132:135], a[112:115], a[8:11], v[132:135]
s_cmp_eq_u32 s3, 0
s_cselect_b32 s35, 0, 24
s_lshl_b32 s35, s35, 12
v_mfma_f32_16x16x32_bf16 v[148:151], a[112:115], a[12:15], v[148:151]
ds_read_b128 a[96:99], v6 offset:20480
v_mfma_f32_16x16x32_bf16 v[152:155], a[116:119], a[12:15], v[152:155]
buffer_load_dwordx4 a[0:3], v4, s[40:43], s35 offen offset:0 sc1
v_mfma_f32_16x16x32_bf16 v[136:139], a[116:119], a[8:11], v[136:139]
ds_read_b128 a[100:103], v6 offset:21504
v_mfma_f32_16x16x32_bf16 v[140:143], a[120:123], a[8:11], v[140:143]
ds_read_b128 a[104:107], v6 offset:22528
v_mfma_f32_16x16x32_bf16 v[156:159], a[120:123], a[12:15], v[156:159]
ds_read_b128 a[108:111], v6 offset:23552
v_mfma_f32_16x16x32_bf16 v[160:163], a[124:127], a[12:15], v[160:163]
buffer_load_dwordx4 a[4:7], v4, s[40:43], s35 offen offset:1024 sc1
v_mfma_f32_16x16x32_bf16 v[144:147], a[124:127], a[8:11], v[144:147]
s_waitcnt vmcnt(8) lgkmcnt(4)
v_mfma_f32_16x16x32_bf16 v[132:135], a[128:131], a[16:19], v[132:135]
s_cmp_eq_u32 s3, 1
s_cselect_b32 s35, 1, 25
s_lshl_b32 s35, s35, 12
v_mfma_f32_16x16x32_bf16 v[148:151], a[128:131], a[20:23], v[148:151]
ds_read_b128 a[112:115], v6 offset:24576
v_mfma_f32_16x16x32_bf16 v[152:155], a[132:135], a[20:23], v[152:155]
buffer_load_dwordx4 a[8:11], v4, s[40:43], s35 offen offset:0 sc1
v_mfma_f32_16x16x32_bf16 v[136:139], a[132:135], a[16:19], v[136:139]
ds_read_b128 a[116:119], v6 offset:25600
v_mfma_f32_16x16x32_bf16 v[140:143], a[136:139], a[16:19], v[140:143]
s_add_u32 s88, s67, 0xe0000
s_add_u32 s89, s66, 0xd0000
v_mfma_f32_16x16x32_bf16 v[156:159], a[136:139], a[20:23], v[156:159]
buffer_load_dword v11, v255, s[4:7], s88 offen sc1
v_mfma_f32_16x16x32_bf16 v[160:163], a[140:143], a[20:23], v[160:163]
buffer_load_dwordx4 a[12:15], v4, s[40:43], s35 offen offset:1024 sc1
v_mfma_f32_16x16x32_bf16 v[144:147], a[140:143], a[16:19], v[144:147]
ds_read_b128 a[120:123], v6 offset:26624
ds_read_b128 a[124:127], v6 offset:27648
s_waitcnt vmcnt(9) lgkmcnt(4)
v_mfma_f32_16x16x32_bf16 v[132:135], a[96:99], a[24:27], v[132:135]
s_cmp_eq_u32 s3, 2
s_cselect_b32 s35, 2, 26
s_lshl_b32 s35, s35, 12
v_mfma_f32_16x16x32_bf16 v[148:151], a[96:99], a[28:31], v[148:151]
buffer_load_dword v232, v255, s[4:7], s89 offen offset:64 sc1
v_mfma_f32_16x16x32_bf16 v[152:155], a[100:103], a[28:31], v[152:155]
buffer_load_dwordx4 a[16:19], v4, s[40:43], s35 offen offset:0 sc1
v_mfma_f32_16x16x32_bf16 v[136:139], a[100:103], a[24:27], v[136:139]
ds_read_b128 a[128:131], v6 offset:28672
v_mfma_f32_16x16x32_bf16 v[140:143], a[104:107], a[24:27], v[140:143]
ds_read_b128 a[132:135], v6 offset:29696
v_mfma_f32_16x16x32_bf16 v[156:159], a[104:107], a[28:31], v[156:159]
ds_read_b128 a[136:139], v6 offset:30720
v_mfma_f32_16x16x32_bf16 v[160:163], a[108:111], a[28:31], v[160:163]
buffer_load_dwordx4 a[20:23], v4, s[40:43], s35 offen offset:1024 sc1
v_mfma_f32_16x16x32_bf16 v[144:147], a[108:111], a[24:27], v[144:147]
ds_read_b128 a[140:143], v6 offset:31744
s_waitcnt vmcnt(10) lgkmcnt(4)
v_mfma_f32_16x16x32_bf16 v[132:135], a[112:115], a[32:35], v[132:135]
s_cmp_eq_u32 s3, 3
s_cselect_b32 s35, 3, 27
s_lshl_b32 s35, s35, 12
v_mfma_f32_16x16x32_bf16 v[148:151], a[112:115], a[36:39], v[148:151]
ds_read_b128 a[96:99], v6 offset:32768
v_mfma_f32_16x16x32_bf16 v[152:155], a[116:119], a[36:39], v[152:155]
buffer_load_dwordx4 a[24:27], v4, s[40:43], s35 offen offset:0 sc1
v_mfma_f32_16x16x32_bf16 v[136:139], a[116:119], a[32:35], v[136:139]
ds_read_b128 a[100:103], v6 offset:33792
v_mfma_f32_16x16x32_bf16 v[140:143], a[120:123], a[32:35], v[140:143]
ds_read_b128 a[104:107], v6 offset:34816
v_mfma_f32_16x16x32_bf16 v[156:159], a[120:123], a[36:39], v[156:159]
ds_read_b128 a[108:111], v6 offset:35840
v_mfma_f32_16x16x32_bf16 v[160:163], a[124:127], a[36:39], v[160:163]
buffer_load_dwordx4 a[28:31], v4, s[40:43], s35 offen offset:1024 sc1
v_mfma_f32_16x16x32_bf16 v[144:147], a[124:127], a[32:35], v[144:147]
s_waitcnt vmcnt(10) lgkmcnt(4)
v_mfma_f32_16x16x32_bf16 v[132:135], a[128:131], a[40:43], v[132:135]
s_cmp_eq_u32 s3, 4
s_cselect_b32 s35, 4, 28
s_lshl_b32 s35, s35, 12
v_mfma_f32_16x16x32_bf16 v[148:151], a[128:131], a[44:47], v[148:151]
ds_read_b128 a[112:115], v6 offset:36864
v_mfma_f32_16x16x32_bf16 v[152:155], a[132:135], a[44:47], v[152:155]
buffer_load_dwordx4 a[32:35], v4, s[40:43], s35 offen offset:0 sc1
v_mfma_f32_16x16x32_bf16 v[136:139], a[132:135], a[40:43], v[136:139]
ds_read_b128 a[116:119], v6 offset:37888
v_mfma_f32_16x16x32_bf16 v[140:143], a[136:139], a[40:43], v[140:143]
ds_read_b128 a[120:123], v6 offset:38912
v_mfma_f32_16x16x32_bf16 v[156:159], a[136:139], a[44:47], v[156:159]
ds_read_b128 a[124:127], v6 offset:39936
v_mfma_f32_16x16x32_bf16 v[160:163], a[140:143], a[44:47], v[160:163]
buffer_load_dwordx4 a[36:39], v4, s[40:43], s35 offen offset:1024 sc1
v_mfma_f32_16x16x32_bf16 v[144:147], a[140:143], a[40:43], v[144:147]
s_waitcnt vmcnt(10) lgkmcnt(4)
v_mfma_f32_16x16x32_bf16 v[132:135], a[96:99], a[0:3], v[132:135]
s_cmp_eq_u32 s3, 5
s_cselect_b32 s35, 5, 29
s_lshl_b32 s35, s35, 12
v_mfma_f32_16x16x32_bf16 v[148:151], a[96:99], a[4:7], v[148:151]
ds_read_b128 a[128:131], v6 offset:40960
v_mfma_f32_16x16x32_bf16 v[152:155], a[100:103], a[4:7], v[152:155]
buffer_load_dwordx4 a[40:43], v4, s[40:43], s35 offen offset:0 sc1
v_mfma_f32_16x16x32_bf16 v[136:139], a[100:103], a[0:3], v[136:139]
ds_read_b128 a[132:135], v6 offset:41984
v_mfma_f32_16x16x32_bf16 v[140:143], a[104:107], a[0:3], v[140:143]
ds_read_b128 a[136:139], v6 offset:43008
v_mfma_f32_16x16x32_bf16 v[156:159], a[104:107], a[4:7], v[156:159]
ds_read_b128 a[140:143], v6 offset:44032
v_mfma_f32_16x16x32_bf16 v[160:163], a[108:111], a[4:7], v[160:163]
buffer_load_dwordx4 a[44:47], v4, s[40:43], s35 offen offset:1024 sc1
v_mfma_f32_16x16x32_bf16 v[144:147], a[108:111], a[0:3], v[144:147]
s_waitcnt vmcnt(9) lgkmcnt(4)
v_mfma_f32_16x16x32_bf16 v[132:135], a[112:115], a[8:11], v[132:135]
s_cmp_eq_u32 s3, 6
s_cselect_b32 s35, 6, 30
s_lshl_b32 s35, s35, 12
v_mfma_f32_16x16x32_bf16 v[148:151], a[112:115], a[12:15], v[148:151]
ds_read_b128 a[96:99], v6 offset:45056
v_mfma_f32_16x16x32_bf16 v[152:155], a[116:119], a[12:15], v[152:155]
buffer_load_dwordx4 a[0:3], v4, s[40:43], s35 offen offset:0 sc1
v_mfma_f32_16x16x32_bf16 v[136:139], a[116:119], a[8:11], v[136:139]
ds_read_b128 a[100:103], v6 offset:46080
v_mfma_f32_16x16x32_bf16 v[140:143], a[120:123], a[8:11], v[140:143]
ds_read_b128 a[104:107], v6 offset:47104
v_mfma_f32_16x16x32_bf16 v[156:159], a[120:123], a[12:15], v[156:159]
ds_read_b128 a[108:111], v6 offset:48128
v_mfma_f32_16x16x32_bf16 v[160:163], a[124:127], a[12:15], v[160:163]
buffer_load_dwordx4 a[4:7], v4, s[40:43], s35 offen offset:1024 sc1
v_mfma_f32_16x16x32_bf16 v[144:147], a[124:127], a[8:11], v[144:147]
s_waitcnt vmcnt(8) lgkmcnt(4)
v_mfma_f32_16x16x32_bf16 v[132:135], a[128:131], a[16:19], v[132:135]
s_cmp_eq_u32 s3, 7
s_cselect_b32 s35, 7, 31
s_lshl_b32 s35, s35, 12
v_mfma_f32_16x16x32_bf16 v[148:151], a[128:131], a[20:23], v[148:151]
ds_read_b128 a[112:115], v6 offset:49152
v_mfma_f32_16x16x32_bf16 v[152:155], a[132:135], a[20:23], v[152:155]
buffer_load_dwordx4 a[8:11], v4, s[40:43], s35 offen offset:0 sc1
v_mfma_f32_16x16x32_bf16 v[136:139], a[132:135], a[16:19], v[136:139]
ds_read_b128 a[116:119], v6 offset:50176
v_mfma_f32_16x16x32_bf16 v[140:143], a[136:139], a[16:19], v[140:143]
ds_read_b128 a[120:123], v6 offset:51200
v_mfma_f32_16x16x32_bf16 v[156:159], a[136:139], a[20:23], v[156:159]
ds_read_b128 a[124:127], v6 offset:52224
v_mfma_f32_16x16x32_bf16 v[160:163], a[140:143], a[20:23], v[160:163]
buffer_load_dwordx4 a[12:15], v4, s[40:43], s35 offen offset:1024 sc1
v_mfma_f32_16x16x32_bf16 v[144:147], a[140:143], a[16:19], v[144:147]
s_waitcnt vmcnt(8) lgkmcnt(4)
v_cmp_ne_u32 vcc, v11, v15
s_cbranch_vccnz Ltr_8
Lte_10:
v_mfma_f32_16x16x32_bf16 v[132:135], a[96:99], a[24:27], v[132:135]
s_add_u32 m0, s18, 0x0
s_add_u32 s44, s50, 0x1400000
v_mfma_f32_16x16x32_bf16 v[148:151], a[96:99], a[28:31], v[148:151]
ds_read_b128 a[128:131], v6 offset:53248
v_mfma_f32_16x16x32_bf16 v[152:155], a[100:103], a[28:31], v[152:155]
buffer_load_dwordx4 v1, s[4:7], s44 offen offset:0 sc1 lds
v_mfma_f32_16x16x32_bf16 v[136:139], a[100:103], a[24:27], v[136:139]
ds_read_b128 a[132:135], v6 offset:54272
v_mfma_f32_16x16x32_bf16 v[140:143], a[104:107], a[24:27], v[140:143]
ds_read_b128 a[136:139], v6 offset:55296
v_mfma_f32_16x16x32_bf16 v[156:159], a[104:107], a[28:31], v[156:159]
ds_read_b128 a[140:143], v6 offset:56320
v_mfma_f32_16x16x32_bf16 v[160:163], a[108:111], a[28:31], v[160:163]
buffer_load_dwordx4 v1, s[4:7], s44 offen offset:1024 sc1 lds
v_mfma_f32_16x16x32_bf16 v[144:147], a[108:111], a[24:27], v[144:147]
s_waitcnt vmcnt(8) lgkmcnt(4)
v_mfma_f32_16x16x32_bf16 v[132:135], a[112:115], a[32:35], v[132:135]
ds_read_b128 a[96:99], v6 offset:57344
v_mfma_f32_16x16x32_bf16 v[148:151], a[112:115], a[36:39], v[148:151]
ds_read_b128 a[100:103], v6 offset:58368
v_mfma_f32_16x16x32_bf16 v[152:155], a[116:119], a[36:39], v[152:155]
buffer_load_dwordx4 v1, s[4:7], s44 offen offset:2048 sc1 lds
s_add_u32 m0, s18, 0x3000
v_mfma_f32_16x16x32_bf16 v[136:139], a[116:119], a[32:35], v[136:139]
s_add_u32 s44, s50, 0x1403000
ds_read_b128 a[104:107], v6 offset:59392
v_mfma_f32_16x16x32_bf16 v[140:143], a[120:123], a[32:35], v[140:143]
ds_read_b128 a[108:111], v6 offset:60416
v_mfma_f32_16x16x32_bf16 v[156:159], a[120:123], a[36:39], v[156:159]
v_mfma_f32_16x16x32_bf16 v[160:163], a[124:127], a[36:39], v[160:163]
v_mfma_f32_16x16x32_bf16 v[144:147], a[124:127], a[32:35], v[144:147]
buffer_load_dwordx4 v1, s[4:7], s44 offen offset:0 sc1 lds
s_waitcnt vmcnt(8) lgkmcnt(4)
v_mfma_f32_16x16x32_bf16 v[132:135], a[128:131], a[40:43], v[132:135]
ds_read_b128 a[112:115], v6 offset:61440
v_mfma_f32_16x16x32_bf16 v[148:151], a[128:131], a[44:47], v[148:151]
ds_read_b128 a[116:119], v6 offset:62464
v_mfma_f32_16x16x32_bf16 v[152:155], a[132:135], a[44:47], v[152:155]
ds_read_b128 a[120:123], v6 offset:63488
v_mfma_f32_16x16x32_bf16 v[136:139], a[132:135], a[40:43], v[136:139]
ds_read_b128 a[124:127], v6 offset:64512
v_mfma_f32_16x16x32_bf16 v[140:143], a[136:139], a[40:43], v[140:143]
buffer_load_dwordx4 v1, s[4:7], s44 offen offset:1024 sc1 lds
v_mfma_f32_16x16x32_bf16 v[156:159], a[136:139], a[44:47], v[156:159]
v_mfma_f32_16x16x32_bf16 v[160:163], a[140:143], a[44:47], v[160:163]
v_mfma_f32_16x16x32_bf16 v[144:147], a[140:143], a[40:43], v[144:147]
s_waitcnt vmcnt(7) lgkmcnt(4)
v_mfma_f32_16x16x32_bf16 v[132:135], a[96:99], a[0:3], v[132:135]
v_mfma_f32_16x16x32_bf16 v[148:151], a[96:99], a[4:7], v[148:151]
buffer_load_dwordx4 v1, s[4:7], s44 offen offset:2048 sc1 lds
v_mfma_f32_16x16x32_bf16 v[152:155], a[100:103], a[4:7], v[152:155]
v_mfma_f32_16x16x32_bf16 v[136:139], a[100:103], a[0:3], v[136:139]
v_mfma_f32_16x16x32_bf16 v[140:143], a[104:107], a[0:3], v[140:143]
v_mfma_f32_16x16x32_bf16 v[156:159], a[104:107], a[4:7], v[156:159]
v_mfma_f32_16x16x32_bf16 v[160:163], a[108:111], a[4:7], v[160:163]
v_mfma_f32_16x16x32_bf16 v[144:147], a[108:111], a[0:3], v[144:147]
s_waitcnt vmcnt(6) lgkmcnt(0)
v_mfma_f32_16x16x32_bf16 v[132:135], a[112:115], a[8:11], v[132:135]
v_mfma_f32_16x16x32_bf16 v[148:151], a[112:115], a[12:15], v[148:151]
v_mfma_f32_16x16x32_bf16 v[152:155], a[116:119], a[12:15], v[152:155]
v_mfma_f32_16x16x32_bf16 v[136:139], a[116:119], a[8:11], v[136:139]
v_mfma_f32_16x16x32_bf16 v[140:143], a[120:123], a[8:11], v[140:143]
v_mfma_f32_16x16x32_bf16 v[156:159], a[120:123], a[12:15], v[156:159]
v_mfma_f32_16x16x32_bf16 v[160:163], a[124:127], a[12:15], v[160:163]
v_mfma_f32_16x16x32_bf16 v[144:147], a[124:127], a[8:11], v[144:147]
s_lshl_b32 s36, s32, 13
v_cvt_pk_bf16_f32 v32, v132, v133
v_cvt_pk_bf16_f32 v33, v134, v135
s_nop 0
v_cvt_pk_bf16_f32 v34, v136, v137
v_cvt_pk_bf16_f32 v35, v138, v139
s_add_u32 s36, s36, 0x2200000
buffer_store_dwordx4 v[32:35], v4, s[4:7], s36 offen offset:0 sc1
v_cvt_pk_bf16_f32 v40, v148, v149
v_cvt_pk_bf16_f32 v41, v150, v151
v_cvt_pk_bf16_f32 v42, v152, v153
v_cvt_pk_bf16_f32 v43, v154, v155
v_cvt_pk_bf16_f32 v36, v140, v141
v_cvt_pk_bf16_f32 v37, v142, v143
v_cvt_pk_bf16_f32 v38, v144, v145
v_cvt_pk_bf16_f32 v39, v146, v147
s_add_u32 s37, s36, 4096
v_cvt_pk_bf16_f32 v44, v156, v157
v_cvt_pk_bf16_f32 v45, v158, v159
v_cvt_pk_bf16_f32 v46, v160, v161
buffer_store_dwordx4 v[40:43], v4, s[4:7], s36 offen offset:1024 sc1
v_cvt_pk_bf16_f32 v47, v162, v163
v_mfma_f32_16x16x32_bf16 v[96:99], v[32:35], v[32:35], 0
s_mov_b32 s38, 0x240000
s_add_u32 s92, s78, 0x40000
v_mfma_f32_16x16x32_bf16 v[92:95], v[16:19], v[32:35], 0
s_add_u32 s93, s79, 0x40000
s_add_u32 s40, s4, 0x2200000
v_mfma_f32_16x16x32_bf16 v[96:99], v[36:39], v[36:39], v[96:99]
s_addc_u32 s41, s5, 0
buffer_store_dwordx4 v[36:39], v4, s[4:7], s37 offen offset:0 sc1
v_mfma_f32_16x16x32_bf16 v[92:95], v[16:19], v[36:39], v[92:95]
s_nop 4
v_cndmask_b32 v96, v96, v97, s[46:47]
v_cndmask_b32 v98, v98, v99, s[46:47]
v_mfma_f32_16x16x32_bf16 v[104:107], v[40:43], v[40:43], 0
v_mfma_f32_16x16x32_bf16 v[100:103], v[16:19], v[40:43], 0
v_cndmask_b32 v93, v96, v98, s[48:49]
buffer_store_dwordx4 v[44:47], v4, s[4:7], s37 offen offset:1024 sc1
v_mfma_f32_16x16x32_bf16 v[104:107], v[44:47], v[44:47], v[104:107]
v_mfma_f32_16x16x32_bf16 v[100:103], v[16:19], v[44:47], v[100:103]
s_nop 6
v_cndmask_b32 v104, v104, v105, s[46:47]
L_stub4:
s_cbranch_execz L_wret1
v_cndmask_b32 v106, v106, v107, s[46:47]
buffer_store_dwordx2 v[92:93], v253, s[4:7], s38 offen offset:0 sc1
v_cndmask_b32 v101, v104, v106, s[48:49]
buffer_store_dwordx2 v[100:101], v253, s[4:7], s38 offen offset:2048 sc1
v_cmp_ne_u32 vcc, v232, v15
s_cbranch_vccnz Ltr_11
Lte_13:
s_barrier
s_add_u32 m0, s18, 0x6000
s_add_u32 s44, s50, 0x1406000
buffer_load_dwordx4 v1, s[4:7], s44 offen offset:0 sc1 lds
buffer_load_dwordx4 v1, s[4:7], s44 offen offset:1024 sc1 lds
buffer_load_dwordx4 v1, s[4:7], s44 offen offset:2048 sc1 lds
s_add_u32 m0, s18, 0x9000
s_add_u32 s44, s50, 0x1409000
buffer_load_dwordx4 v1, s[4:7], s44 offen offset:0 sc1 lds
buffer_load_dwordx4 v1, s[4:7], s44 offen offset:1024 sc1 lds
buffer_load_dwordx4 v1, s[4:7], s44 offen offset:2048 sc1 lds
s_waitcnt vmcnt(6)
s_barrier
s_cmp_lg_u32 s28, 1
s_cbranch_scc1 Lsg_14
buffer_atomic_add v12, v10, s[4:7], s92 offen sc1
Lsg_14:
s_mov_b64 exec, 0
s_cmp_eq_u32 s28, 1
s_cbranch_scc1 L_stub5
L_wret2:
s_mov_b64 exec, -1
s_cmp_lt_u32 s28, 2
s_cbranch_scc1 Lwd_15
s_add_u32 m0, s18, 0xa800
s_add_u32 s44, s50, 0x140a800
buffer_load_dwordx4 v1, s[4:7], s44 offen offset:0 sc1 lds
buffer_load_dwordx4 v1, s[4:7], s44 offen offset:1024 sc1 lds
buffer_load_dwordx4 v1, s[4:7], s44 offen offset:2048 sc1 lds
s_add_u32 m0, s18, 0xc000
s_add_u32 s44, s50, 0x140c000
buffer_load_dwordx4 v1, s[4:7], s44 offen offset:0 sc1 lds
buffer_load_dwordx4 v1, s[4:7], s44 offen offset:1024 sc1 lds
buffer_load_dwordx4 v1, s[4:7], s44 offen offset:2048 sc1 lds
s_add_u32 m0, s18, 0xd800
s_add_u32 s44, s50, 0x140d800
buffer_load_dwordx4 v1, s[4:7], s44 offen offset:0 sc1 lds
buffer_load_dwordx4 v1, s[4:7], s44 offen offset:1024 sc1 lds
buffer_load_dwordx4 v1, s[4:7], s44 offen offset:2048 sc1 lds
s_add_u32 m0, s18, 0xf000
s_add_u32 s44, s50, 0x140f000
buffer_load_dwordx4 v1, s[4:7], s44 offen offset:0 sc1 lds
buffer_load_dwordx4 v1, s[4:7], s44 offen offset:1024 sc1 lds
buffer_load_dwordx4 v1, s[4:7], s44 offen offset:2048 sc1 lds
s_add_u32 m0, s18, 0x10800
s_add_u32 s44, s50, 0x1410800
buffer_load_dwordx4 v1, s[4:7], s44 offen offset:0 sc1 lds
buffer_load_dwordx4 v1, s[4:7], s44 offen offset:1024 sc1 lds
buffer_load_dwordx4 v1, s[4:7], s44 offen offset:2048 sc1 lds
s_add_u32 m0, s18, 0x12000
s_add_u32 s44, s50, 0x1412000
buffer_load_dwordx4 v1, s[4:7], s44 offen offset:0 sc1 lds
buffer_load_dwordx4 v1, s[4:7], s44 offen offset:1024 sc1 lds
buffer_load_dwordx4 v1, s[4:7], s44 offen offset:2048 sc1 lds
s_add_u32 m0, s18, 0x13800
s_add_u32 s44, s50, 0x1413800
buffer_load_dwordx4 v1, s[4:7], s44 offen offset:0 sc1 lds
buffer_load_dwordx4 v1, s[4:7], s44 offen offset:1024 sc1 lds
buffer_load_dwordx4 v1, s[4:7], s44 offen offset:2048 sc1 lds
s_add_u32 m0, s18, 0x15000
s_add_u32 s44, s50, 0x1415000
buffer_load_dwordx4 v1, s[4:7], s44 offen offset:0 sc1 lds
buffer_load_dwordx4 v1, s[4:7], s44 offen offset:1024 sc1 lds
buffer_load_dwordx4 v1, s[4:7], s44 offen offset:2048 sc1 lds
s_add_u32 m0, s18, 0x16800
s_add_u32 s44, s50, 0x1416800
buffer_load_dwordx4 v1, s[4:7], s44 offen offset:0 sc1 lds
buffer_load_dwordx4 v1, s[4:7], s44 offen offset:1024 sc1 lds
buffer_load_dwordx4 v1, s[4:7], s44 offen offset:2048 sc1 lds
s_add_u32 m0, s18, 0x18000
s_add_u32 s44, s50, 0x1418000
buffer_load_dwordx4 v1, s[4:7], s44 offen offset:0 sc1 lds
buffer_load_dwordx4 v1, s[4:7], s44 offen offset:1024 sc1 lds
buffer_load_dwordx4 v1, s[4:7], s44 offen offset:2048 sc1 lds
s_add_u32 m0, s18, 0x19800
s_add_u32 s44, s50, 0x1419800
buffer_load_dwordx4 v1, s[4:7], s44 offen offset:0 sc1 lds
buffer_load_dwordx4 v1, s[4:7], s44 offen offset:1024 sc1 lds
buffer_load_dwordx4 v1, s[4:7], s44 offen offset:2048 sc1 lds
s_add_u32 m0, s18, 0x1b000
s_add_u32 s44, s50, 0x141b000
buffer_load_dwordx4 v1, s[4:7], s44 offen offset:0 sc1 lds
buffer_load_dwordx4 v1, s[4:7], s44 offen offset:1024 sc1 lds
buffer_load_dwordx4 v1, s[4:7], s44 offen offset:2048 sc1 lds
Lwd_15:
s_cmp_lg_u32 s28, 0
s_cbranch_scc1 Lpo_18
s_add_u32 s36, s67, 0x40000
s_mov_b32 s37, 0
v_mov_b32 v11, 0
buffer_atomic_add v11, v251, s[4:7], s36 offen sc0 sc1
s_sleep 4
Lpoll_16:
v_mov_b32 v234, 0
buffer_atomic_add v234, v251, s[4:7], s36 offen sc0 sc1
s_waitcnt vmcnt(1)
v_readfirstlane_b32 s38, v11
s_nop 0
s_cmp_ge_u32 s38, 32
s_cbranch_scc1 Lpe_17
v_mov_b32 v11, 0
buffer_atomic_add v11, v251, s[4:7], s36 offen sc0 sc1
s_waitcnt vmcnt(1)
v_readfirstlane_b32 s38, v234
s_nop 0
s_cmp_ge_u32 s38, 32
s_cbranch_scc1 Lpe_17
s_add_u32 s37, s37, 1
s_cmp_lt_u32 s37, 0x80000
s_cbranch_scc1 Lpoll_16
s_waitcnt vmcnt(0)
Lpo_18:
s_waitcnt vmcnt(36) lgkmcnt(0)
s_cmp_ge_u32 s28, 2
s_cbranch_scc1 Lw_19
s_waitcnt vmcnt(0)
Lw_19:
Lpe_17:
s_barrier
s_add_u32 s9, s66, 0x10080
s_mov_b32 s35, 0
s_mov_b32 s33, 0x1000
buffer_load_dwordx4 a[0:3], v2, s[40:43], s35 offen offset:0 sc1
buffer_load_dwordx4 a[4:7], v2, s[40:43], s33 offen offset:0 sc1
buffer_load_dwordx4 a[8:11], v2, s[40:43], s35 offen offset:1024 sc1
buffer_load_dwordx4 a[12:15], v2, s[40:43], s33 offen offset:1024 sc1
buffer_load_dwordx4 a[16:19], v2, s[40:43], s35 offen offset:2048 sc1
buffer_load_dwordx4 a[20:23], v2, s[40:43], s33 offen offset:2048 sc1
buffer_load_dwordx4 a[24:27], v2, s[40:43], s35 offen offset:3072 sc1
buffer_load_dwordx4 a[28:31], v2, s[40:43], s33 offen offset:3072 sc1
s_add_u32 s35, s35, 8192
s_add_u32 s33, s33, 8192
buffer_load_dwordx4 a[32:35], v2, s[40:43], s35 offen offset:0 sc1
buffer_load_dwordx4 a[36:39], v2, s[40:43], s33 offen offset:0 sc1
buffer_load_dwordx4 a[40:43], v2, s[40:43], s35 offen offset:1024 sc1
buffer_load_dwordx4 a[44:47], v2, s[40:43], s33 offen offset:1024 sc1
buffer_load_dwordx4 a[48:51], v2, s[40:43], s35 offen offset:2048 sc1
buffer_load_dwordx4 a[52:55], v2, s[40:43], s33 offen offset:2048 sc1
buffer_load_dwordx4 a[56:59], v2, s[40:43], s35 offen offset:3072 sc1
buffer_load_dwordx4 a[60:63], v2, s[40:43], s33 offen offset:3072 sc1
s_add_u32 s35, s35, 8192
s_add_u32 s33, s33, 8192
v_add_u32 v5, 0, v1
ds_read_b128 a[96:99], v5 offset:2048
ds_read_b128 a[100:103], v5 offset:8192
ds_read_b128 a[104:107], v5 offset:3072
ds_read_b128 a[108:111], v5 offset:9216
ds_read_b128 a[112:115], v5 offset:4096
ds_read_b128 a[116:119], v5 offset:10240
s_waitcnt vmcnt(14) lgkmcnt(4)
v_mfma_f32_16x16x32_bf16 v[140:143], a[96:99], a[0:3], 0
v_and_b32 v232, 15, v0
v_lshlrev_b32 v232, 7, v232
v_mfma_f32_16x16x32_bf16 v[140:143], a[100:103], a[4:7], v[140:143]
buffer_load_dwordx4 a[64:67], v2, s[40:43], s35 offen offset:0 sc1
s_waitcnt vmcnt(13)
v_mfma_f32_16x16x32_bf16 v[164:167], a[100:103], a[12:15], 0
v_lshrrev_b32 v233, 4, v0
v_lshlrev_b32 v233, 4, v233
v_mfma_f32_16x16x32_bf16 v[164:167], a[96:99], a[8:11], v[164:167]
v_add_u32 v232, v233, v232
s_mul_i32 s38, s30, 12288
s_waitcnt vmcnt(12)
v_mfma_f32_16x16x32_bf16 v[188:191], a[96:99], a[16:19], 0
s_add_u32 s38, s38, 0x380000
s_add_u32 s39, s28, 4
s_min_u32 s39, s39, 5
s_waitcnt vmcnt(11)
v_mfma_f32_16x16x32_bf16 v[188:191], a[100:103], a[20:23], v[188:191]
buffer_load_dwordx4 a[68:71], v2, s[40:43], s33 offen offset:0 sc1
s_lshl_b32 s36, s28, 11
s_waitcnt vmcnt(10)
v_mfma_f32_16x16x32_bf16 v[212:215], a[100:103], a[28:31], 0
s_add_u32 s36, s36, s38
s_lshl_b32 s37, s39, 11
s_add_u32 s37, s37, s38
v_mfma_f32_16x16x32_bf16 v[212:215], a[96:99], a[24:27], v[212:215]
ds_read_b128 a[128:131], v5 offset:5120
s_waitcnt lgkmcnt(4)
v_mfma_f32_16x16x32_bf16 v[216:219], a[104:107], a[24:27], 0
ds_read_b128 a[132:135], v5 offset:11264
s_waitcnt lgkmcnt(4)
v_mfma_f32_16x16x32_bf16 v[216:219], a[108:111], a[28:31], v[216:219]
ds_read_b128 a[136:139], v5 offset:0
v_mfma_f32_16x16x32_bf16 v[192:195], a[108:111], a[20:23], 0
buffer_load_dwordx4 v[48:51], v232, s[4:7], s36 offen sc1
v_mfma_f32_16x16x32_bf16 v[192:195], a[104:107], a[16:19], v[192:195]
ds_read_b128 a[140:143], v5 offset:6144
v_mfma_f32_16x16x32_bf16 v[168:171], a[104:107], a[8:11], 0
ds_read_b128 a[144:147], v5 offset:1024
v_mfma_f32_16x16x32_bf16 v[168:171], a[108:111], a[12:15], v[168:171]
ds_read_b128 a[148:151], v5 offset:7168
v_mfma_f32_16x16x32_bf16 v[144:147], a[108:111], a[4:7], 0
v_mfma_f32_16x16x32_bf16 v[144:147], a[104:107], a[0:3], v[144:147]
buffer_load_dwordx4 a[72:75], v2, s[40:43], s35 offen offset:1024 sc1
s_waitcnt lgkmcnt(7)
v_mfma_f32_16x16x32_bf16 v[148:151], a[112:115], a[0:3], 0
s_waitcnt lgkmcnt(6)
v_mfma_f32_16x16x32_bf16 v[148:151], a[116:119], a[4:7], v[148:151]
v_mfma_f32_16x16x32_bf16 v[172:175], a[116:119], a[12:15], 0
v_mfma_f32_16x16x32_bf16 v[172:175], a[112:115], a[8:11], v[172:175]
v_mfma_f32_16x16x32_bf16 v[196:199], a[112:115], a[16:19], 0
buffer_load_dwordx4 a[76:79], v2, s[40:43], s33 offen offset:1024 sc1
v_mfma_f32_16x16x32_bf16 v[196:199], a[116:119], a[20:23], v[196:199]
v_mfma_f32_16x16x32_bf16 v[220:223], a[116:119], a[28:31], 0
v_mfma_f32_16x16x32_bf16 v[220:223], a[112:115], a[24:27], v[220:223]
s_waitcnt lgkmcnt(0)
v_mfma_f32_16x16x32_bf16 v[224:227], a[128:131], a[24:27], 0
ds_read_b128 a[96:99], v5 offset:14336
v_mfma_f32_16x16x32_bf16 v[224:227], a[132:135], a[28:31], v[224:227]
buffer_load_dwordx4 a[80:83], v2, s[40:43], s35 offen offset:2048 sc1
v_mfma_f32_16x16x32_bf16 v[200:203], a[132:135], a[20:23], 0
ds_read_b128 a[100:103], v5 offset:20480
v_mfma_f32_16x16x32_bf16 v[200:203], a[128:131], a[16:19], v[200:203]
v_mfma_f32_16x16x32_bf16 v[176:179], a[128:131], a[8:11], 0
v_mfma_f32_16x16x32_bf16 v[176:179], a[132:135], a[12:15], v[176:179]
buffer_load_dwordx4 a[84:87], v2, s[40:43], s33 offen offset:2048 sc1
v_mfma_f32_16x16x32_bf16 v[152:155], a[132:135], a[4:7], 0
ds_read_b128 a[104:107], v5 offset:15360
v_mfma_f32_16x16x32_bf16 v[152:155], a[128:131], a[0:3], v[152:155]
v_mfma_f32_16x16x32_bf16 v[132:135], a[136:139], a[0:3], 0
ds_read_b128 a[108:111], v5 offset:21504
v_mfma_f32_16x16x32_bf16 v[132:135], a[140:143], a[4:7], v[132:135]
v_mfma_f32_16x16x32_bf16 v[156:159], a[140:143], a[12:15], 0
buffer_load_dwordx4 v[52:55], v232, s[4:7], s37 offen sc1
s_add_u32 m0, s18, 0x1e000
v_mfma_f32_16x16x32_bf16 v[156:159], a[136:139], a[8:11], v[156:159]
s_add_u32 s44, s50, 0x141e000
ds_read_b128 a[112:115], v5 offset:16384
v_mfma_f32_16x16x32_bf16 v[180:183], a[136:139], a[16:19], 0
v_mfma_f32_16x16x32_bf16 v[180:183], a[140:143], a[20:23], v[180:183]
ds_read_b128 a[116:119], v5 offset:22528
v_mfma_f32_16x16x32_bf16 v[204:207], a[140:143], a[28:31], 0
v_mfma_f32_16x16x32_bf16 v[204:207], a[136:139], a[24:27], v[204:207]
buffer_load_dwordx4 a[88:91], v2, s[40:43], s35 offen offset:3072 sc1
v_mfma_f32_16x16x32_bf16 v[208:211], a[144:147], a[24:27], 0
v_mfma_f32_16x16x32_bf16 v[208:211], a[148:151], a[28:31], v[208:211]
v_mfma_f32_16x16x32_bf16 v[184:187], a[148:151], a[20:23], 0
v_mfma_f32_16x16x32_bf16 v[184:187], a[144:147], a[16:19], v[184:187]
v_mfma_f32_16x16x32_bf16 v[160:163], a[144:147], a[8:11], 0
buffer_load_dwordx4 a[92:95], v2, s[40:43], s33 offen offset:3072 sc1
s_add_u32 s35, s35, 8192
v_mfma_f32_16x16x32_bf16 v[160:163], a[148:151], a[12:15], v[160:163]
s_add_u32 s33, s33, 8192
v_mfma_f32_16x16x32_bf16 v[136:139], a[148:151], a[4:7], 0
v_mfma_f32_16x16x32_bf16 v[136:139], a[144:147], a[0:3], v[136:139]
s_waitcnt vmcnt(10) lgkmcnt(0)
v_mfma_f32_16x16x32_bf16 v[140:143], a[96:99], a[32:35], v[140:143]
ds_read_b128 a[128:131], v5 offset:17408
v_mfma_f32_16x16x32_bf16 v[140:143], a[100:103], a[36:39], v[140:143]
buffer_load_dwordx4 a[0:3], v2, s[40:43], s35 offen offset:0 sc1
v_mfma_f32_16x16x32_bf16 v[164:167], a[100:103], a[44:47], v[164:167]
ds_read_b128 a[132:135], v5 offset:23552
v_mfma_f32_16x16x32_bf16 v[164:167], a[96:99], a[40:43], v[164:167]
v_mfma_f32_16x16x32_bf16 v[188:191], a[96:99], a[48:51], v[188:191]
v_mfma_f32_16x16x32_bf16 v[188:191], a[100:103], a[52:55], v[188:191]
buffer_load_dwordx4 a[4:7], v2, s[40:43], s33 offen offset:0 sc1
v_mfma_f32_16x16x32_bf16 v[212:215], a[100:103], a[60:63], v[212:215]
ds_read_b128 a[136:139], v5 offset:12288
v_mfma_f32_16x16x32_bf16 v[212:215], a[96:99], a[56:59], v[212:215]
v_mfma_f32_16x16x32_bf16 v[216:219], a[104:107], a[56:59], v[216:219]
ds_read_b128 a[140:143], v5 offset:18432
v_mfma_f32_16x16x32_bf16 v[216:219], a[108:111], a[60:63], v[216:219]
v_mfma_f32_16x16x32_bf16 v[192:195], a[108:111], a[52:55], v[192:195]
buffer_load_dwordx4 v1, s[4:7], s44 offen offset:0 sc1 lds
v_mfma_f32_16x16x32_bf16 v[192:195], a[104:107], a[48:51], v[192:195]
ds_read_b128 a[144:147], v5 offset:13312
v_mfma_f32_16x16x32_bf16 v[168:171], a[104:107], a[40:43], v[168:171]
v_mfma_f32_16x16x32_bf16 v[168:171], a[108:111], a[44:47], v[168:171]
ds_read_b128 a[148:151], v5 offset:19456
v_mfma_f32_16x16x32_bf16 v[144:147], a[108:111], a[36:39], v[144:147]
v_mfma_f32_16x16x32_bf16 v[144:147], a[104:107], a[32:35], v[144:147]
buffer_load_dwordx4 a[8:11], v2, s[40:43], s35 offen offset:1024 sc1
v_mfma_f32_16x16x32_bf16 v[148:151], a[112:115], a[32:35], v[148:151]
v_mfma_f32_16x16x32_bf16 v[148:151], a[116:119], a[36:39], v[148:151]
v_mfma_f32_16x16x32_bf16 v[172:175], a[116:119], a[44:47], v[172:175]
v_mfma_f32_16x16x32_bf16 v[172:175], a[112:115], a[40:43], v[172:175]
v_mfma_f32_16x16x32_bf16 v[196:199], a[112:115], a[48:51], v[196:199]
buffer_load_dwordx4 a[12:15], v2, s[40:43], s33 offen offset:1024 sc1
v_mfma_f32_16x16x32_bf16 v[196:199], a[116:119], a[52:55], v[196:199]
v_mfma_f32_16x16x32_bf16 v[220:223], a[116:119], a[60:63], v[220:223]
v_mfma_f32_16x16x32_bf16 v[220:223], a[112:115], a[56:59], v[220:223]
s_waitcnt lgkmcnt(0)
v_mfma_f32_16x16x32_bf16 v[224:227], a[128:131], a[56:59], v[224:227]
ds_read_b128 a[96:99], v5 offset:26624
v_mfma_f32_16x16x32_bf16 v[224:227], a[132:135], a[60:63], v[224:227]
buffer_load_dwordx4 a[16:19], v2, s[40:43], s35 offen offset:2048 sc1
v_mfma_f32_16x16x32_bf16 v[200:203], a[132:135], a[52:55], v[200:203]
ds_read_b128 a[100:103], v5 offset:32768
v_mfma_f32_16x16x32_bf16 v[200:203], a[128:131], a[48:51], v[200:203]
v_mfma_f32_16x16x32_bf16 v[176:179], a[128:131], a[40:43], v[176:179]
v_mfma_f32_16x16x32_bf16 v[176:179], a[132:135], a[44:47], v[176:179]
buffer_load_dwordx4 v1, s[4:7], s44 offen offset:1024 sc1 lds
v_mfma_f32_16x16x32_bf16 v[152:155], a[132:135], a[36:39], v[152:155]
ds_read_b128 a[104:107], v5 offset:27648
v_mfma_f32_16x16x32_bf16 v[152:155], a[128:131], a[32:35], v[152:155]
v_mfma_f32_16x16x32_bf16 v[132:135], a[136:139], a[32:35], v[132:135]
ds_read_b128 a[108:111], v5 offset:33792
v_mfma_f32_16x16x32_bf16 v[132:135], a[140:143], a[36:39], v[132:135]
buffer_load_dwordx4 a[20:23], v2, s[40:43], s33 offen offset:2048 sc1
v_mfma_f32_16x16x32_bf16 v[156:159], a[140:143], a[44:47], v[156:159]
ds_read_b128 a[112:115], v5 offset:28672
v_mfma_f32_16x16x32_bf16 v[156:159], a[136:139], a[40:43], v[156:159]
v_mfma_f32_16x16x32_bf16 v[180:183], a[136:139], a[48:51], v[180:183]
v_mfma_f32_16x16x32_bf16 v[180:183], a[140:143], a[52:55], v[180:183]
buffer_load_dwordx4 a[24:27], v2, s[40:43], s35 offen offset:3072 sc1
v_mfma_f32_16x16x32_bf16 v[204:207], a[140:143], a[60:63], v[204:207]
ds_read_b128 a[116:119], v5 offset:34816
v_mfma_f32_16x16x32_bf16 v[204:207], a[136:139], a[56:59], v[204:207]
v_mfma_f32_16x16x32_bf16 v[208:211], a[144:147], a[56:59], v[208:211]
v_mfma_f32_16x16x32_bf16 v[208:211], a[148:151], a[60:63], v[208:211]
buffer_load_dwordx4 v1, s[4:7], s44 offen offset:2048 sc1 lds
s_add_u32 m0, s18, 0x21000
v_mfma_f32_16x16x32_bf16 v[184:187], a[148:151], a[52:55], v[184:187]
s_add_u32 s44, s50, 0x1421000
v_mfma_f32_16x16x32_bf16 v[184:187], a[144:147], a[48:51], v[184:187]
v_mfma_f32_16x16x32_bf16 v[160:163], a[144:147], a[40:43], v[160:163]
v_mfma_f32_16x16x32_bf16 v[160:163], a[148:151], a[44:47], v[160:163]
buffer_load_dwordx4 a[28:31], v2, s[40:43], s33 offen offset:3072 sc1
s_add_u32 s35, s35, 8192
v_mfma_f32_16x16x32_bf16 v[136:139], a[148:151], a[36:39], v[136:139]
s_add_u32 s33, s33, 8192
v_mfma_f32_16x16x32_bf16 v[136:139], a[144:147], a[32:35], v[136:139]
s_waitcnt vmcnt(11) lgkmcnt(0)
v_mfma_f32_16x16x32_bf16 v[140:143], a[96:99], a[64:67], v[140:143]
ds_read_b128 a[128:131], v5 offset:29696
v_mfma_f32_16x16x32_bf16 v[140:143], a[100:103], a[68:71], v[140:143]
buffer_load_dwordx4 a[32:35], v2, s[40:43], s35 offen offset:0 sc1
v_mfma_f32_16x16x32_bf16 v[164:167], a[100:103], a[76:79], v[164:167]
ds_read_b128 a[132:135], v5 offset:35840
v_mfma_f32_16x16x32_bf16 v[164:167], a[96:99], a[72:75], v[164:167]
v_mfma_f32_16x16x32_bf16 v[188:191], a[96:99], a[80:83], v[188:191]
v_mfma_f32_16x16x32_bf16 v[188:191], a[100:103], a[84:87], v[188:191]
buffer_load_dwordx4 a[36:39], v2, s[40:43], s33 offen offset:0 sc1
v_mfma_f32_16x16x32_bf16 v[212:215], a[100:103], a[92:95], v[212:215]
ds_read_b128 a[136:139], v5 offset:24576
v_mfma_f32_16x16x32_bf16 v[212:215], a[96:99], a[88:91], v[212:215]
v_mfma_f32_16x16x32_bf16 v[216:219], a[104:107], a[88:91], v[216:219]
ds_read_b128 a[140:143], v5 offset:30720
v_mfma_f32_16x16x32_bf16 v[216:219], a[108:111], a[92:95], v[216:219]
v_mfma_f32_16x16x32_bf16 v[192:195], a[108:111], a[84:87], v[192:195]
buffer_load_dwordx4 v1, s[4:7], s44 offen offset:0 sc1 lds
v_mfma_f32_16x16x32_bf16 v[192:195], a[104:107], a[80:83], v[192:195]
ds_read_b128 a[144:147], v5 offset:25600
v_mfma_f32_16x16x32_bf16 v[168:171], a[104:107], a[72:75], v[168:171]
v_mfma_f32_16x16x32_bf16 v[168:171], a[108:111], a[76:79], v[168:171]
ds_read_b128 a[148:151], v5 offset:31744
v_mfma_f32_16x16x32_bf16 v[144:147], a[108:111], a[68:71], v[144:147]
v_mfma_f32_16x16x32_bf16 v[144:147], a[104:107], a[64:67], v[144:147]
buffer_load_dwordx4 a[40:43], v2, s[40:43], s35 offen offset:1024 sc1
v_mfma_f32_16x16x32_bf16 v[148:151], a[112:115], a[64:67], v[148:151]
v_mfma_f32_16x16x32_bf16 v[148:151], a[116:119], a[68:71], v[148:151]
v_mfma_f32_16x16x32_bf16 v[172:175], a[116:119], a[76:79], v[172:175]
v_mfma_f32_16x16x32_bf16 v[172:175], a[112:115], a[72:75], v[172:175]
v_mfma_f32_16x16x32_bf16 v[196:199], a[112:115], a[80:83], v[196:199]
buffer_load_dwordx4 a[44:47], v2, s[40:43], s33 offen offset:1024 sc1
v_mfma_f32_16x16x32_bf16 v[196:199], a[116:119], a[84:87], v[196:199]
v_mfma_f32_16x16x32_bf16 v[220:223], a[116:119], a[92:95], v[220:223]
v_mfma_f32_16x16x32_bf16 v[220:223], a[112:115], a[88:91], v[220:223]
s_waitcnt lgkmcnt(0)
v_mfma_f32_16x16x32_bf16 v[224:227], a[128:131], a[88:91], v[224:227]
ds_read_b128 a[96:99], v5 offset:38912
v_mfma_f32_16x16x32_bf16 v[224:227], a[132:135], a[92:95], v[224:227]
buffer_load_dwordx4 a[48:51], v2, s[40:43], s35 offen offset:2048 sc1
v_mfma_f32_16x16x32_bf16 v[200:203], a[132:135], a[84:87], v[200:203]
ds_read_b128 a[100:103], v5 offset:45056
v_mfma_f32_16x16x32_bf16 v[200:203], a[128:131], a[80:83], v[200:203]
v_mfma_f32_16x16x32_bf16 v[176:179], a[128:131], a[72:75], v[176:179]
v_mfma_f32_16x16x32_bf16 v[176:179], a[132:135], a[76:79], v[176:179]
buffer_load_dwordx4 a[52:55], v2, s[40:43], s33 offen offset:2048 sc1
v_mfma_f32_16x16x32_bf16 v[152:155], a[132:135], a[68:71], v[152:155]
ds_read_b128 a[104:107], v5 offset:39936
v_mfma_f32_16x16x32_bf16 v[152:155], a[128:131], a[64:67], v[152:155]
v_mfma_f32_16x16x32_bf16 v[132:135], a[136:139], a[64:67], v[132:135]
ds_read_b128 a[108:111], v5 offset:46080
v_mfma_f32_16x16x32_bf16 v[132:135], a[140:143], a[68:71], v[132:135]
v_mfma_f32_16x16x32_bf16 v[156:159], a[140:143], a[76:79], v[156:159]
buffer_load_dwordx4 v1, s[4:7], s44 offen offset:1024 sc1 lds
v_mfma_f32_16x16x32_bf16 v[156:159], a[136:139], a[72:75], v[156:159]
ds_read_b128 a[112:115], v5 offset:40960
v_mfma_f32_16x16x32_bf16 v[180:183], a[136:139], a[80:83], v[180:183]
v_mfma_f32_16x16x32_bf16 v[180:183], a[140:143], a[84:87], v[180:183]
ds_read_b128 a[116:119], v5 offset:47104
v_mfma_f32_16x16x32_bf16 v[204:207], a[140:143], a[92:95], v[204:207]
v_mfma_f32_16x16x32_bf16 v[204:207], a[136:139], a[88:91], v[204:207]
buffer_load_dwordx4 a[56:59], v2, s[40:43], s35 offen offset:3072 sc1
v_mfma_f32_16x16x32_bf16 v[208:211], a[144:147], a[88:91], v[208:211]
v_mfma_f32_16x16x32_bf16 v[208:211], a[148:151], a[92:95], v[208:211]
v_mfma_f32_16x16x32_bf16 v[184:187], a[148:151], a[84:87], v[184:187]
v_mfma_f32_16x16x32_bf16 v[184:187], a[144:147], a[80:83], v[184:187]
v_mfma_f32_16x16x32_bf16 v[160:163], a[144:147], a[72:75], v[160:163]
buffer_load_dwordx4 a[60:63], v2, s[40:43], s33 offen offset:3072 sc1
s_add_u32 s35, s35, 8192
v_mfma_f32_16x16x32_bf16 v[160:163], a[148:151], a[76:79], v[160:163]
s_add_u32 s33, s33, 8192
v_mfma_f32_16x16x32_bf16 v[136:139], a[148:151], a[68:71], v[136:139]
v_mfma_f32_16x16x32_bf16 v[136:139], a[144:147], a[64:67], v[136:139]
s_waitcnt vmcnt(10) lgkmcnt(0)
v_mfma_f32_16x16x32_bf16 v[140:143], a[96:99], a[0:3], v[140:143]
ds_read_b128 a[128:131], v5 offset:41984
v_mfma_f32_16x16x32_bf16 v[140:143], a[100:103], a[4:7], v[140:143]
buffer_load_dwordx4 a[64:67], v2, s[40:43], s35 offen offset:0 sc1
v_mfma_f32_16x16x32_bf16 v[164:167], a[100:103], a[12:15], v[164:167]
ds_read_b128 a[132:135], v5 offset:48128
v_mfma_f32_16x16x32_bf16 v[164:167], a[96:99], a[8:11], v[164:167]
v_mfma_f32_16x16x32_bf16 v[188:191], a[96:99], a[16:19], v[188:191]
v_mfma_f32_16x16x32_bf16 v[188:191], a[100:103], a[20:23], v[188:191]
buffer_load_dwordx4 a[68:71], v2, s[40:43], s33 offen offset:0 sc1
v_mfma_f32_16x16x32_bf16 v[212:215], a[100:103], a[28:31], v[212:215]
ds_read_b128 a[136:139], v5 offset:36864
v_mfma_f32_16x16x32_bf16 v[212:215], a[96:99], a[24:27], v[212:215]
v_mfma_f32_16x16x32_bf16 v[216:219], a[104:107], a[24:27], v[216:219]
ds_read_b128 a[140:143], v5 offset:43008
v_mfma_f32_16x16x32_bf16 v[216:219], a[108:111], a[28:31], v[216:219]
v_mfma_f32_16x16x32_bf16 v[192:195], a[108:111], a[20:23], v[192:195]
buffer_load_dwordx4 v1, s[4:7], s44 offen offset:2048 sc1 lds
s_add_u32 s88, s82, 0x240000
v_mfma_f32_16x16x32_bf16 v[192:195], a[104:107], a[16:19], v[192:195]
ds_read_b128 a[144:147], v5 offset:37888
v_mfma_f32_16x16x32_bf16 v[168:171], a[104:107], a[8:11], v[168:171]
v_mfma_f32_16x16x32_bf16 v[168:171], a[108:111], a[12:15], v[168:171]
ds_read_b128 a[148:151], v5 offset:44032
v_mfma_f32_16x16x32_bf16 v[144:147], a[108:111], a[4:7], v[144:147]
v_mfma_f32_16x16x32_bf16 v[144:147], a[104:107], a[0:3], v[144:147]
buffer_load_dwordx4 a[72:75], v2, s[40:43], s35 offen offset:1024 sc1
v_mfma_f32_16x16x32_bf16 v[148:151], a[112:115], a[0:3], v[148:151]
v_mfma_f32_16x16x32_bf16 v[148:151], a[116:119], a[4:7], v[148:151]
v_mfma_f32_16x16x32_bf16 v[172:175], a[116:119], a[12:15], v[172:175]
v_mfma_f32_16x16x32_bf16 v[172:175], a[112:115], a[8:11], v[172:175]
v_mfma_f32_16x16x32_bf16 v[196:199], a[112:115], a[16:19], v[196:199]
buffer_load_dwordx4 a[76:79], v2, s[40:43], s33 offen offset:1024 sc1
v_mfma_f32_16x16x32_bf16 v[196:199], a[116:119], a[20:23], v[196:199]
v_mfma_f32_16x16x32_bf16 v[220:223], a[116:119], a[28:31], v[220:223]
v_mfma_f32_16x16x32_bf16 v[220:223], a[112:115], a[24:27], v[220:223]
s_waitcnt lgkmcnt(0)
s_barrier
v_mfma_f32_16x16x32_bf16 v[224:227], a[128:131], a[24:27], v[224:227]
v_add_u32 v5, 49152, v1
v_mfma_f32_16x16x32_bf16 v[224:227], a[132:135], a[28:31], v[224:227]
buffer_load_dwordx4 a[80:83], v2, s[40:43], s35 offen offset:2048 sc1
v_mfma_f32_16x16x32_bf16 v[200:203], a[132:135], a[20:23], v[200:203]
ds_read_b128 a[96:99], v5 offset:2048
v_mfma_f32_16x16x32_bf16 v[200:203], a[128:131], a[16:19], v[200:203]
ds_read_b128 a[100:103], v5 offset:8192
v_mfma_f32_16x16x32_bf16 v[176:179], a[128:131], a[8:11], v[176:179]
v_mfma_f32_16x16x32_bf16 v[176:179], a[132:135], a[12:15], v[176:179]
buffer_load_dwordx4 a[84:87], v2, s[40:43], s33 offen offset:2048 sc1
v_mfma_f32_16x16x32_bf16 v[152:155], a[132:135], a[4:7], v[152:155]
ds_read_b128 a[104:107], v5 offset:3072
v_mfma_f32_16x16x32_bf16 v[152:155], a[128:131], a[0:3], v[152:155]
v_mfma_f32_16x16x32_bf16 v[132:135], a[136:139], a[0:3], v[132:135]
ds_read_b128 a[108:111], v5 offset:9216
v_mfma_f32_16x16x32_bf16 v[132:135], a[140:143], a[4:7], v[132:135]
v_mfma_f32_16x16x32_bf16 v[156:159], a[140:143], a[12:15], v[156:159]
buffer_load_dwordx4 v[92:95], v1, s[4:7], s88 offen offset:0 sc1
v_mfma_f32_16x16x32_bf16 v[156:159], a[136:139], a[8:11], v[156:159]
ds_read_b128 a[112:115], v5 offset:4096
v_mfma_f32_16x16x32_bf16 v[180:183], a[136:139], a[16:19], v[180:183]
v_mfma_f32_16x16x32_bf16 v[180:183], a[140:143], a[20:23], v[180:183]
ds_read_b128 a[116:119], v5 offset:10240
v_mfma_f32_16x16x32_bf16 v[204:207], a[140:143], a[28:31], v[204:207]
v_mfma_f32_16x16x32_bf16 v[204:207], a[136:139], a[24:27], v[204:207]
buffer_load_dwordx4 a[88:91], v2, s[40:43], s35 offen offset:3072 sc1
v_mfma_f32_16x16x32_bf16 v[208:211], a[144:147], a[24:27], v[208:211]
v_mfma_f32_16x16x32_bf16 v[208:211], a[148:151], a[28:31], v[208:211]
v_mfma_f32_16x16x32_bf16 v[184:187], a[148:151], a[20:23], v[184:187]
v_mfma_f32_16x16x32_bf16 v[184:187], a[144:147], a[16:19], v[184:187]
v_mfma_f32_16x16x32_bf16 v[160:163], a[144:147], a[8:11], v[160:163]
buffer_load_dwordx4 a[92:95], v2, s[40:43], s33 offen offset:3072 sc1
s_add_u32 s35, s35, 8192
v_mfma_f32_16x16x32_bf16 v[160:163], a[148:151], a[12:15], v[160:163]
s_add_u32 s33, s33, 8192
v_mfma_f32_16x16x32_bf16 v[136:139], a[148:151], a[4:7], v[136:139]
v_mfma_f32_16x16x32_bf16 v[136:139], a[144:147], a[0:3], v[136:139]
s_waitcnt vmcnt(10) lgkmcnt(0)
v_mfma_f32_16x16x32_bf16 v[140:143], a[96:99], a[32:35], v[140:143]
ds_read_b128 a[128:131], v5 offset:5120
v_mfma_f32_16x16x32_bf16 v[140:143], a[100:103], a[36:39], v[140:143]
buffer_load_dwordx4 a[0:3], v2, s[40:43], s35 offen offset:0 sc1
v_mfma_f32_16x16x32_bf16 v[164:167], a[100:103], a[44:47], v[164:167]
ds_read_b128 a[132:135], v5 offset:11264
v_mfma_f32_16x16x32_bf16 v[164:167], a[96:99], a[40:43], v[164:167]
v_mfma_f32_16x16x32_bf16 v[188:191], a[96:99], a[48:51], v[188:191]
v_mfma_f32_16x16x32_bf16 v[188:191], a[100:103], a[52:55], v[188:191]
buffer_load_dwordx4 a[4:7], v2, s[40:43], s33 offen offset:0 sc1
v_mfma_f32_16x16x32_bf16 v[212:215], a[100:103], a[60:63], v[212:215]
ds_read_b128 a[136:139], v5 offset:0
v_mfma_f32_16x16x32_bf16 v[212:215], a[96:99], a[56:59], v[212:215]
v_mfma_f32_16x16x32_bf16 v[216:219], a[104:107], a[56:59], v[216:219]
ds_read_b128 a[140:143], v5 offset:6144
v_mfma_f32_16x16x32_bf16 v[216:219], a[108:111], a[60:63], v[216:219]
v_mfma_f32_16x16x32_bf16 v[192:195], a[108:111], a[52:55], v[192:195]
buffer_load_dwordx4 v[96:99], v1, s[4:7], s88 offen offset:1024 sc1
v_mfma_f32_16x16x32_bf16 v[192:195], a[104:107], a[48:51], v[192:195]
ds_read_b128 a[144:147], v5 offset:1024
v_mfma_f32_16x16x32_bf16 v[168:171], a[104:107], a[40:43], v[168:171]
v_mfma_f32_16x16x32_bf16 v[168:171], a[108:111], a[44:47], v[168:171]
ds_read_b128 a[148:151], v5 offset:7168
v_mfma_f32_16x16x32_bf16 v[144:147], a[108:111], a[36:39], v[144:147]
v_mfma_f32_16x16x32_bf16 v[144:147], a[104:107], a[32:35], v[144:147]
buffer_load_dwordx4 a[8:11], v2, s[40:43], s35 offen offset:1024 sc1
v_mfma_f32_16x16x32_bf16 v[148:151], a[112:115], a[32:35], v[148:151]
v_mfma_f32_16x16x32_bf16 v[148:151], a[116:119], a[36:39], v[148:151]
v_mfma_f32_16x16x32_bf16 v[172:175], a[116:119], a[44:47], v[172:175]
v_mfma_f32_16x16x32_bf16 v[172:175], a[112:115], a[40:43], v[172:175]
v_mfma_f32_16x16x32_bf16 v[196:199], a[112:115], a[48:51], v[196:199]
buffer_load_dwordx4 a[12:15], v2, s[40:43], s33 offen offset:1024 sc1
v_mfma_f32_16x16x32_bf16 v[196:199], a[116:119], a[52:55], v[196:199]
v_mfma_f32_16x16x32_bf16 v[220:223], a[116:119], a[60:63], v[220:223]
v_mfma_f32_16x16x32_bf16 v[220:223], a[112:115], a[56:59], v[220:223]
s_waitcnt lgkmcnt(0)
v_mfma_f32_16x16x32_bf16 v[224:227], a[128:131], a[56:59], v[224:227]
ds_read_b128 a[96:99], v5 offset:14336
v_mfma_f32_16x16x32_bf16 v[224:227], a[132:135], a[60:63], v[224:227]
buffer_load_dwordx4 a[16:19], v2, s[40:43], s35 offen offset:2048 sc1
v_mfma_f32_16x16x32_bf16 v[200:203], a[132:135], a[52:55], v[200:203]
ds_read_b128 a[100:103], v5 offset:20480
v_mfma_f32_16x16x32_bf16 v[200:203], a[128:131], a[48:51], v[200:203]
v_mfma_f32_16x16x32_bf16 v[176:179], a[128:131], a[40:43], v[176:179]
v_mfma_f32_16x16x32_bf16 v[176:179], a[132:135], a[44:47], v[176:179]
buffer_load_dwordx4 v[100:103], v1, s[4:7], s88 offen offset:2048 sc1
v_mfma_f32_16x16x32_bf16 v[152:155], a[132:135], a[36:39], v[152:155]
ds_read_b128 a[104:107], v5 offset:15360
v_mfma_f32_16x16x32_bf16 v[152:155], a[128:131], a[32:35], v[152:155]
v_mfma_f32_16x16x32_bf16 v[132:135], a[136:139], a[32:35], v[132:135]
ds_read_b128 a[108:111], v5 offset:21504
v_mfma_f32_16x16x32_bf16 v[132:135], a[140:143], a[36:39], v[132:135]
buffer_load_dwordx4 a[20:23], v2, s[40:43], s33 offen offset:2048 sc1
v_mfma_f32_16x16x32_bf16 v[156:159], a[140:143], a[44:47], v[156:159]
ds_read_b128 a[112:115], v5 offset:16384
v_mfma_f32_16x16x32_bf16 v[156:159], a[136:139], a[40:43], v[156:159]
v_mfma_f32_16x16x32_bf16 v[180:183], a[136:139], a[48:51], v[180:183]
v_mfma_f32_16x16x32_bf16 v[180:183], a[140:143], a[52:55], v[180:183]
buffer_load_dwordx4 a[24:27], v2, s[40:43], s35 offen offset:3072 sc1
v_mfma_f32_16x16x32_bf16 v[204:207], a[140:143], a[60:63], v[204:207]
ds_read_b128 a[116:119], v5 offset:22528
v_mfma_f32_16x16x32_bf16 v[204:207], a[136:139], a[56:59], v[204:207]
v_mfma_f32_16x16x32_bf16 v[208:211], a[144:147], a[56:59], v[208:211]
v_mfma_f32_16x16x32_bf16 v[208:211], a[148:151], a[60:63], v[208:211]
buffer_load_dwordx4 v[104:107], v1, s[4:7], s88 offen offset:3072 sc1
s_add_u32 s88, s88, 4096
v_mfma_f32_16x16x32_bf16 v[184:187], a[148:151], a[52:55], v[184:187]
v_mfma_f32_16x16x32_bf16 v[184:187], a[144:147], a[48:51], v[184:187]
v_mfma_f32_16x16x32_bf16 v[160:163], a[144:147], a[40:43], v[160:163]
v_mfma_f32_16x16x32_bf16 v[160:163], a[148:151], a[44:47], v[160:163]
buffer_load_dwordx4 a[28:31], v2, s[40:43], s33 offen offset:3072 sc1
s_add_u32 s35, s35, 8192
L_stub5:
s_cbranch_execz L_stub6
v_mfma_f32_16x16x32_bf16 v[136:139], a[148:151], a[36:39], v[136:139]
s_add_u32 s33, s33, 8192
v_mfma_f32_16x16x32_bf16 v[136:139], a[144:147], a[32:35], v[136:139]
s_waitcnt vmcnt(11) lgkmcnt(0)
v_mfma_f32_16x16x32_bf16 v[140:143], a[96:99], a[64:67], v[140:143]
ds_read_b128 a[128:131], v5 offset:17408
v_mfma_f32_16x16x32_bf16 v[140:143], a[100:103], a[68:71], v[140:143]
buffer_load_dwordx4 a[32:35], v2, s[40:43], s35 offen offset:0 sc1
v_mfma_f32_16x16x32_bf16 v[164:167], a[100:103], a[76:79], v[164:167]
ds_read_b128 a[132:135], v5 offset:23552
v_mfma_f32_16x16x32_bf16 v[164:167], a[96:99], a[72:75], v[164:167]
v_mfma_f32_16x16x32_bf16 v[188:191], a[96:99], a[80:83], v[188:191]
v_mfma_f32_16x16x32_bf16 v[188:191], a[100:103], a[84:87], v[188:191]
buffer_load_dwordx4 a[36:39], v2, s[40:43], s33 offen offset:0 sc1
v_mfma_f32_16x16x32_bf16 v[212:215], a[100:103], a[92:95], v[212:215]
ds_read_b128 a[136:139], v5 offset:12288
v_mfma_f32_16x16x32_bf16 v[212:215], a[96:99], a[88:91], v[212:215]
v_mfma_f32_16x16x32_bf16 v[216:219], a[104:107], a[88:91], v[216:219]
ds_read_b128 a[140:143], v5 offset:18432
v_mfma_f32_16x16x32_bf16 v[216:219], a[108:111], a[92:95], v[216:219]
v_mfma_f32_16x16x32_bf16 v[192:195], a[108:111], a[84:87], v[192:195]
buffer_load_dwordx4 v[108:111], v1, s[4:7], s88 offen offset:0 sc1
v_mfma_f32_16x16x32_bf16 v[192:195], a[104:107], a[80:83], v[192:195]
ds_read_b128 a[144:147], v5 offset:13312
v_mfma_f32_16x16x32_bf16 v[168:171], a[104:107], a[72:75], v[168:171]
v_mfma_f32_16x16x32_bf16 v[168:171], a[108:111], a[76:79], v[168:171]
ds_read_b128 a[148:151], v5 offset:19456
v_mfma_f32_16x16x32_bf16 v[144:147], a[108:111], a[68:71], v[144:147]
v_mfma_f32_16x16x32_bf16 v[144:147], a[104:107], a[64:67], v[144:147]
buffer_load_dwordx4 a[40:43], v2, s[40:43], s35 offen offset:1024 sc1
v_mfma_f32_16x16x32_bf16 v[148:151], a[112:115], a[64:67], v[148:151]
v_mfma_f32_16x16x32_bf16 v[148:151], a[116:119], a[68:71], v[148:151]
v_mfma_f32_16x16x32_bf16 v[172:175], a[116:119], a[76:79], v[172:175]
v_mfma_f32_16x16x32_bf16 v[172:175], a[112:115], a[72:75], v[172:175]
v_mfma_f32_16x16x32_bf16 v[196:199], a[112:115], a[80:83], v[196:199]
buffer_load_dwordx4 a[44:47], v2, s[40:43], s33 offen offset:1024 sc1
v_mfma_f32_16x16x32_bf16 v[196:199], a[116:119], a[84:87], v[196:199]
v_mfma_f32_16x16x32_bf16 v[220:223], a[116:119], a[92:95], v[220:223]
v_mfma_f32_16x16x32_bf16 v[220:223], a[112:115], a[88:91], v[220:223]
s_waitcnt lgkmcnt(0)
v_mfma_f32_16x16x32_bf16 v[224:227], a[128:131], a[88:91], v[224:227]
ds_read_b128 a[96:99], v5 offset:26624
v_mfma_f32_16x16x32_bf16 v[224:227], a[132:135], a[92:95], v[224:227]
buffer_load_dwordx4 a[48:51], v2, s[40:43], s35 offen offset:2048 sc1
v_mfma_f32_16x16x32_bf16 v[200:203], a[132:135], a[84:87], v[200:203]
ds_read_b128 a[100:103], v5 offset:32768
v_mfma_f32_16x16x32_bf16 v[200:203], a[128:131], a[80:83], v[200:203]
v_mfma_f32_16x16x32_bf16 v[176:179], a[128:131], a[72:75], v[176:179]
v_mfma_f32_16x16x32_bf16 v[176:179], a[132:135], a[76:79], v[176:179]
buffer_load_dwordx4 a[52:55], v2, s[40:43], s33 offen offset:2048 sc1
v_mfma_f32_16x16x32_bf16 v[152:155], a[132:135], a[68:71], v[152:155]
ds_read_b128 a[104:107], v5 offset:27648
v_mfma_f32_16x16x32_bf16 v[152:155], a[128:131], a[64:67], v[152:155]
v_mfma_f32_16x16x32_bf16 v[132:135], a[136:139], a[64:67], v[132:135]
ds_read_b128 a[108:111], v5 offset:33792
v_mfma_f32_16x16x32_bf16 v[132:135], a[140:143], a[68:71], v[132:135]
v_mfma_f32_16x16x32_bf16 v[156:159], a[140:143], a[76:79], v[156:159]
buffer_load_dwordx4 v[112:115], v1, s[4:7], s88 offen offset:1024 sc1
v_mfma_f32_16x16x32_bf16 v[156:159], a[136:139], a[72:75], v[156:159]
ds_read_b128 a[112:115], v5 offset:28672
v_mfma_f32_16x16x32_bf16 v[180:183], a[136:139], a[80:83], v[180:183]
v_mfma_f32_16x16x32_bf16 v[180:183], a[140:143], a[84:87], v[180:183]
ds_read_b128 a[116:119], v5 offset:34816
v_mfma_f32_16x16x32_bf16 v[204:207], a[140:143], a[92:95], v[204:207]
v_mfma_f32_16x16x32_bf16 v[204:207], a[136:139], a[88:91], v[204:207]
buffer_load_dwordx4 a[56:59], v2, s[40:43], s35 offen offset:3072 sc1
v_mfma_f32_16x16x32_bf16 v[208:211], a[144:147], a[88:91], v[208:211]
v_mfma_f32_16x16x32_bf16 v[208:211], a[148:151], a[92:95], v[208:211]
v_mfma_f32_16x16x32_bf16 v[184:187], a[148:151], a[84:87], v[184:187]
v_mfma_f32_16x16x32_bf16 v[184:187], a[144:147], a[80:83], v[184:187]
v_mfma_f32_16x16x32_bf16 v[160:163], a[144:147], a[72:75], v[160:163]
buffer_load_dwordx4 a[60:63], v2, s[40:43], s33 offen offset:3072 sc1
s_add_u32 s35, s35, 8192
v_mfma_f32_16x16x32_bf16 v[160:163], a[148:151], a[76:79], v[160:163]
s_add_u32 s33, s33, 8192
v_mfma_f32_16x16x32_bf16 v[136:139], a[148:151], a[68:71], v[136:139]
v_mfma_f32_16x16x32_bf16 v[136:139], a[144:147], a[64:67], v[136:139]
s_waitcnt vmcnt(10) lgkmcnt(0)
v_mfma_f32_16x16x32_bf16 v[140:143], a[96:99], a[0:3], v[140:143]
ds_read_b128 a[128:131], v5 offset:29696
v_add_f32_dpp v48, v48, v48 row_ror:8 row_mask:0xf bank_mask:0xf
v_mfma_f32_16x16x32_bf16 v[140:143], a[100:103], a[4:7], v[140:143]
buffer_load_dwordx4 a[64:67], v2, s[40:43], s35 offen offset:0 sc1
v_mfma_f32_16x16x32_bf16 v[164:167], a[100:103], a[12:15], v[164:167]
ds_read_b128 a[132:135], v5 offset:35840
v_add_f32_dpp v49, v49, v49 row_ror:8 row_mask:0xf bank_mask:0xf
v_mfma_f32_16x16x32_bf16 v[164:167], a[96:99], a[8:11], v[164:167]
v_add_f32_dpp v50, v50, v50 row_ror:8 row_mask:0xf bank_mask:0xf
v_add_f32_dpp v51, v51, v51 row_ror:8 row_mask:0xf bank_mask:0xf
v_mfma_f32_16x16x32_bf16 v[188:191], a[96:99], a[16:19], v[188:191]
v_add_f32_dpp v52, v52, v52 row_ror:8 row_mask:0xf bank_mask:0xf
v_add_f32_dpp v53, v53, v53 row_ror:8 row_mask:0xf bank_mask:0xf
v_mfma_f32_16x16x32_bf16 v[188:191], a[100:103], a[20:23], v[188:191]
buffer_load_dwordx4 a[68:71], v2, s[40:43], s33 offen offset:0 sc1
v_mfma_f32_16x16x32_bf16 v[212:215], a[100:103], a[28:31], v[212:215]
ds_read_b128 a[136:139], v5 offset:24576
v_add_f32_dpp v54, v54, v54 row_ror:8 row_mask:0xf bank_mask:0xf
v_mfma_f32_16x16x32_bf16 v[212:215], a[96:99], a[24:27], v[212:215]
v_add_f32_dpp v55, v55, v55 row_ror:8 row_mask:0xf bank_mask:0xf
v_add_f32_dpp v48, v48, v48 row_ror:4 row_mask:0xf bank_mask:0xf
v_mfma_f32_16x16x32_bf16 v[216:219], a[104:107], a[24:27], v[216:219]
ds_read_b128 a[140:143], v5 offset:30720
v_add_f32_dpp v49, v49, v49 row_ror:4 row_mask:0xf bank_mask:0xf
v_mfma_f32_16x16x32_bf16 v[216:219], a[108:111], a[28:31], v[216:219]
v_add_f32_dpp v50, v50, v50 row_ror:4 row_mask:0xf bank_mask:0xf
v_mfma_f32_16x16x32_bf16 v[192:195], a[108:111], a[20:23], v[192:195]
buffer_load_dwordx4 v[116:119], v1, s[4:7], s88 offen offset:2048 sc1
v_mfma_f32_16x16x32_bf16 v[192:195], a[104:107], a[16:19], v[192:195]
ds_read_b128 a[144:147], v5 offset:25600
v_add_f32_dpp v51, v51, v51 row_ror:4 row_mask:0xf bank_mask:0xf
v_mfma_f32_16x16x32_bf16 v[168:171], a[104:107], a[8:11], v[168:171]
v_add_f32_dpp v52, v52, v52 row_ror:4 row_mask:0xf bank_mask:0xf
v_add_f32_dpp v53, v53, v53 row_ror:4 row_mask:0xf bank_mask:0xf
v_mfma_f32_16x16x32_bf16 v[168:171], a[108:111], a[12:15], v[168:171]
ds_read_b128 a[148:151], v5 offset:31744
v_add_f32_dpp v54, v54, v54 row_ror:4 row_mask:0xf bank_mask:0xf
v_mfma_f32_16x16x32_bf16 v[144:147], a[108:111], a[4:7], v[144:147]
v_add_f32_dpp v55, v55, v55 row_ror:4 row_mask:0xf bank_mask:0xf
v_mfma_f32_16x16x32_bf16 v[144:147], a[104:107], a[0:3], v[144:147]
buffer_load_dwordx4 a[72:75], v2, s[40:43], s35 offen offset:1024 sc1
v_mfma_f32_16x16x32_bf16 v[148:151], a[112:115], a[0:3], v[148:151]
v_add_f32_dpp v48, v48, v48 row_ror:2 row_mask:0xf bank_mask:0xf
v_add_f32_dpp v49, v49, v49 row_ror:2 row_mask:0xf bank_mask:0xf
v_mfma_f32_16x16x32_bf16 v[148:151], a[116:119], a[4:7], v[148:151]
v_add_f32_dpp v50, v50, v50 row_ror:2 row_mask:0xf bank_mask:0xf
v_mfma_f32_16x16x32_bf16 v[172:175], a[116:119], a[12:15], v[172:175]
v_add_f32_dpp v51, v51, v51 row_ror:2 row_mask:0xf bank_mask:0xf
v_mfma_f32_16x16x32_bf16 v[172:175], a[112:115], a[8:11], v[172:175]
v_add_f32_dpp v52, v52, v52 row_ror:2 row_mask:0xf bank_mask:0xf
v_mfma_f32_16x16x32_bf16 v[196:199], a[112:115], a[16:19], v[196:199]
buffer_load_dwordx4 a[76:79], v2, s[40:43], s33 offen offset:1024 sc1
v_mfma_f32_16x16x32_bf16 v[196:199], a[116:119], a[20:23], v[196:199]
v_add_f32_dpp v53, v53, v53 row_ror:2 row_mask:0xf bank_mask:0xf
v_add_f32_dpp v54, v54, v54 row_ror:2 row_mask:0xf bank_mask:0xf
v_mfma_f32_16x16x32_bf16 v[220:223], a[116:119], a[28:31], v[220:223]
v_add_f32_dpp v55, v55, v55 row_ror:2 row_mask:0xf bank_mask:0xf
v_mfma_f32_16x16x32_bf16 v[220:223], a[112:115], a[24:27], v[220:223]
v_add_f32_dpp v48, v48, v48 row_ror:1 row_mask:0xf bank_mask:0xf
s_waitcnt lgkmcnt(0)
v_mfma_f32_16x16x32_bf16 v[224:227], a[128:131], a[24:27], v[224:227]
ds_read_b128 a[96:99], v5 offset:38912
v_add_f32_dpp v49, v49, v49 row_ror:1 row_mask:0xf bank_mask:0xf
v_mfma_f32_16x16x32_bf16 v[224:227], a[132:135], a[28:31], v[224:227]
buffer_load_dwordx4 a[80:83], v2, s[40:43], s35 offen offset:2048 sc1
v_mfma_f32_16x16x32_bf16 v[200:203], a[132:135], a[20:23], v[200:203]
ds_read_b128 a[100:103], v5 offset:45056
v_add_f32_dpp v50, v50, v50 row_ror:1 row_mask:0xf bank_mask:0xf
v_mfma_f32_16x16x32_bf16 v[200:203], a[128:131], a[16:19], v[200:203]
v_add_f32_dpp v51, v51, v51 row_ror:1 row_mask:0xf bank_mask:0xf
v_add_f32_dpp v52, v52, v52 row_ror:1 row_mask:0xf bank_mask:0xf
v_mfma_f32_16x16x32_bf16 v[176:179], a[128:131], a[8:11], v[176:179]
v_add_f32_dpp v53, v53, v53 row_ror:1 row_mask:0xf bank_mask:0xf
v_add_f32_dpp v54, v54, v54 row_ror:1 row_mask:0xf bank_mask:0xf
v_mfma_f32_16x16x32_bf16 v[176:179], a[132:135], a[12:15], v[176:179]
buffer_load_dwordx4 a[84:87], v2, s[40:43], s33 offen offset:2048 sc1
v_mfma_f32_16x16x32_bf16 v[152:155], a[132:135], a[4:7], v[152:155]
ds_read_b128 a[104:107], v5 offset:39936
v_add_f32_dpp v55, v55, v55 row_ror:1 row_mask:0xf bank_mask:0xf
v_mfma_f32_16x16x32_bf16 v[152:155], a[128:131], a[0:3], v[152:155]
v_add_u32 v233, 159744, v233
s_lshl_b32 s36, s28, 6
v_mfma_f32_16x16x32_bf16 v[132:135], a[136:139], a[0:3], v[132:135]
ds_read_b128 a[108:111], v5 offset:46080
s_lshl_b32 s37, s39, 6
v_mfma_f32_16x16x32_bf16 v[132:135], a[140:143], a[4:7], v[132:135]
v_add_u32 v232, s36, v233
v_mfma_f32_16x16x32_bf16 v[156:159], a[140:143], a[12:15], v[156:159]
buffer_load_dwordx4 v[120:123], v1, s[4:7], s88 offen offset:3072 sc1
s_add_u32 m0, s18, 0x0
v_mfma_f32_16x16x32_bf16 v[156:159], a[136:139], a[8:11], v[156:159]
s_add_u32 s44, s50, 0x1424000
ds_read_b128 a[112:115], v5 offset:40960
v_mfma_f32_16x16x32_bf16 v[180:183], a[136:139], a[16:19], v[180:183]
v_add_u32 v235, s37, v233
v_mfma_f32_16x16x32_bf16 v[180:183], a[140:143], a[20:23], v[180:183]
ds_read_b128 a[116:119], v5 offset:47104
v_mfma_f32_16x16x32_bf16 v[204:207], a[140:143], a[28:31], v[204:207]
v_mfma_f32_16x16x32_bf16 v[204:207], a[136:139], a[24:27], v[204:207]
buffer_load_dwordx4 a[88:91], v2, s[40:43], s35 offen offset:3072 sc1
v_mfma_f32_16x16x32_bf16 v[208:211], a[144:147], a[24:27], v[208:211]
v_mfma_f32_16x16x32_bf16 v[208:211], a[148:151], a[28:31], v[208:211]
v_mfma_f32_16x16x32_bf16 v[184:187], a[148:151], a[20:23], v[184:187]
v_mfma_f32_16x16x32_bf16 v[184:187], a[144:147], a[16:19], v[184:187]
v_mfma_f32_16x16x32_bf16 v[160:163], a[144:147], a[8:11], v[160:163]
buffer_load_dwordx4 a[92:95], v2, s[40:43], s33 offen offset:3072 sc1
s_add_u32 s35, s35, 8192
v_mfma_f32_16x16x32_bf16 v[160:163], a[148:151], a[12:15], v[160:163]
s_add_u32 s33, s33, 8192
v_mfma_f32_16x16x32_bf16 v[136:139], a[148:151], a[4:7], v[136:139]
v_mfma_f32_16x16x32_bf16 v[136:139], a[144:147], a[0:3], v[136:139]
s_waitcnt vmcnt(10) lgkmcnt(0)
v_mfma_f32_16x16x32_bf16 v[140:143], a[96:99], a[32:35], v[140:143]
ds_read_b128 a[128:131], v5 offset:41984
v_mfma_f32_16x16x32_bf16 v[140:143], a[100:103], a[36:39], v[140:143]
buffer_load_dwordx4 a[0:3], v2, s[40:43], s35 offen offset:0 sc1
v_mfma_f32_16x16x32_bf16 v[164:167], a[100:103], a[44:47], v[164:167]
ds_read_b128 a[132:135], v5 offset:48128
v_mfma_f32_16x16x32_bf16 v[164:167], a[96:99], a[40:43], v[164:167]
ds_write_b128 v232, v[48:51]
v_mfma_f32_16x16x32_bf16 v[188:191], a[96:99], a[48:51], v[188:191]
ds_write_b128 v235, v[52:55]
v_mfma_f32_16x16x32_bf16 v[188:191], a[100:103], a[52:55], v[188:191]
buffer_load_dwordx4 v1, s[4:7], s44 offen offset:0 sc1 lds
v_mfma_f32_16x16x32_bf16 v[212:215], a[100:103], a[60:63], v[212:215]
ds_read_b128 a[136:139], v5 offset:36864
v_mfma_f32_16x16x32_bf16 v[212:215], a[96:99], a[56:59], v[212:215]
v_mfma_f32_16x16x32_bf16 v[216:219], a[104:107], a[56:59], v[216:219]
ds_read_b128 a[140:143], v5 offset:43008
v_mfma_f32_16x16x32_bf16 v[216:219], a[108:111], a[60:63], v[216:219]
buffer_load_dwordx4 a[4:7], v2, s[40:43], s33 offen offset:0 sc1
v_mfma_f32_16x16x32_bf16 v[192:195], a[108:111], a[52:55], v[192:195]
ds_read_b128 a[144:147], v5 offset:37888
v_mfma_f32_16x16x32_bf16 v[192:195], a[104:107], a[48:51], v[192:195]
v_mfma_f32_16x16x32_bf16 v[168:171], a[104:107], a[40:43], v[168:171]
v_mfma_f32_16x16x32_bf16 v[168:171], a[108:111], a[44:47], v[168:171]
buffer_load_dwordx4 a[8:11], v2, s[40:43], s35 offen offset:1024 sc1
v_mfma_f32_16x16x32_bf16 v[144:147], a[108:111], a[36:39], v[144:147]
ds_read_b128 a[148:151], v5 offset:44032
v_mfma_f32_16x16x32_bf16 v[144:147], a[104:107], a[32:35], v[144:147]
v_mfma_f32_16x16x32_bf16 v[148:151], a[112:115], a[32:35], v[148:151]
v_mfma_f32_16x16x32_bf16 v[148:151], a[116:119], a[36:39], v[148:151]
buffer_load_dwordx4 v1, s[4:7], s44 offen offset:1024 sc1 lds
v_mfma_f32_16x16x32_bf16 v[172:175], a[116:119], a[44:47], v[172:175]
v_mfma_f32_16x16x32_bf16 v[172:175], a[112:115], a[40:43], v[172:175]
v_mfma_f32_16x16x32_bf16 v[196:199], a[112:115], a[48:51], v[196:199]
v_mfma_f32_16x16x32_bf16 v[196:199], a[116:119], a[52:55], v[196:199]
buffer_load_dwordx4 a[12:15], v2, s[40:43], s33 offen offset:1024 sc1
v_mfma_f32_16x16x32_bf16 v[220:223], a[116:119], a[60:63], v[220:223]
v_mfma_f32_16x16x32_bf16 v[220:223], a[112:115], a[56:59], v[220:223]
s_waitcnt lgkmcnt(0)
s_barrier
v_mfma_f32_16x16x32_bf16 v[224:227], a[128:131], a[56:59], v[224:227]
v_add_u32 v5, 98304, v1
v_mfma_f32_16x16x32_bf16 v[224:227], a[132:135], a[60:63], v[224:227]
buffer_load_dwordx4 a[16:19], v2, s[40:43], s35 offen offset:2048 sc1
v_mfma_f32_16x16x32_bf16 v[200:203], a[132:135], a[52:55], v[200:203]
ds_read_b128 a[96:99], v5 offset:2048
v_mfma_f32_16x16x32_bf16 v[200:203], a[128:131], a[48:51], v[200:203]
ds_read_b128 a[100:103], v5 offset:8192
v_mfma_f32_16x16x32_bf16 v[176:179], a[128:131], a[40:43], v[176:179]
ds_read_b128 v[48:51], v233 offset:0
v_mfma_f32_16x16x32_bf16 v[176:179], a[132:135], a[44:47], v[176:179]
buffer_load_dwordx4 a[20:23], v2, s[40:43], s33 offen offset:2048 sc1
v_mfma_f32_16x16x32_bf16 v[152:155], a[132:135], a[36:39], v[152:155]
ds_read_b128 a[104:107], v5 offset:3072
v_mfma_f32_16x16x32_bf16 v[152:155], a[128:131], a[32:35], v[152:155]
v_mfma_f32_16x16x32_bf16 v[132:135], a[136:139], a[32:35], v[132:135]
ds_read_b128 a[108:111], v5 offset:9216
v_mfma_f32_16x16x32_bf16 v[132:135], a[140:143], a[36:39], v[132:135]
v_mfma_f32_16x16x32_bf16 v[156:159], a[140:143], a[44:47], v[156:159]
buffer_load_dwordx4 v1, s[4:7], s44 offen offset:2048 sc1 lds
s_add_u32 m0, s18, 0x3000
v_mfma_f32_16x16x32_bf16 v[156:159], a[136:139], a[40:43], v[156:159]
s_add_u32 s44, s50, 0x1427000
ds_read_b128 a[112:115], v5 offset:4096
v_mfma_f32_16x16x32_bf16 v[180:183], a[136:139], a[48:51], v[180:183]
ds_read_b128 v[52:55], v233 offset:64
v_mfma_f32_16x16x32_bf16 v[180:183], a[140:143], a[52:55], v[180:183]
ds_read_b128 a[116:119], v5 offset:10240
v_mfma_f32_16x16x32_bf16 v[204:207], a[140:143], a[60:63], v[204:207]
v_mfma_f32_16x16x32_bf16 v[204:207], a[136:139], a[56:59], v[204:207]
buffer_load_dwordx4 a[24:27], v2, s[40:43], s35 offen offset:3072 sc1
v_mfma_f32_16x16x32_bf16 v[208:211], a[144:147], a[56:59], v[208:211]
v_mfma_f32_16x16x32_bf16 v[208:211], a[148:151], a[60:63], v[208:211]
v_mfma_f32_16x16x32_bf16 v[184:187], a[148:151], a[52:55], v[184:187]
v_mfma_f32_16x16x32_bf16 v[184:187], a[144:147], a[48:51], v[184:187]
v_mfma_f32_16x16x32_bf16 v[160:163], a[144:147], a[40:43], v[160:163]
buffer_load_dwordx4 a[28:31], v2, s[40:43], s33 offen offset:3072 sc1
s_add_u32 s35, s35, 8192
v_mfma_f32_16x16x32_bf16 v[160:163], a[148:151], a[44:47], v[160:163]
s_add_u32 s33, s33, 8192
ds_read_b128 v[56:59], v233 offset:128
v_mfma_f32_16x16x32_bf16 v[136:139], a[148:151], a[36:39], v[136:139]
v_mfma_f32_16x16x32_bf16 v[136:139], a[144:147], a[32:35], v[136:139]
s_waitcnt vmcnt(11) lgkmcnt(1)
v_mfma_f32_16x16x32_bf16 v[140:143], a[96:99], a[64:67], v[140:143]
ds_read_b128 a[128:131], v5 offset:5120
v_mfma_f32_16x16x32_bf16 v[140:143], a[100:103], a[68:71], v[140:143]
buffer_load_dwordx4 a[32:35], v2, s[40:43], s35 offen offset:0 sc1
v_mfma_f32_16x16x32_bf16 v[164:167], a[100:103], a[76:79], v[164:167]
ds_read_b128 a[132:135], v5 offset:11264
v_mfma_f32_16x16x32_bf16 v[164:167], a[96:99], a[72:75], v[164:167]
v_mfma_f32_16x16x32_bf16 v[188:191], a[96:99], a[80:83], v[188:191]
v_mfma_f32_16x16x32_bf16 v[188:191], a[100:103], a[84:87], v[188:191]
buffer_load_dwordx4 a[36:39], v2, s[40:43], s33 offen offset:0 sc1
v_mfma_f32_16x16x32_bf16 v[212:215], a[100:103], a[92:95], v[212:215]
ds_read_b128 a[136:139], v5 offset:0
v_mfma_f32_16x16x32_bf16 v[212:215], a[96:99], a[88:91], v[212:215]
v_mfma_f32_16x16x32_bf16 v[216:219], a[104:107], a[88:91], v[216:219]
ds_read_b128 a[140:143], v5 offset:6144
v_mfma_f32_16x16x32_bf16 v[216:219], a[108:111], a[92:95], v[216:219]
ds_read_b128 v[60:63], v233 offset:192
v_mfma_f32_16x16x32_bf16 v[192:195], a[108:111], a[84:87], v[192:195]
buffer_load_dwordx4 v1, s[4:7], s44 offen offset:0 sc1 lds
v_mfma_f32_16x16x32_bf16 v[192:195], a[104:107], a[80:83], v[192:195]
ds_read_b128 a[144:147], v5 offset:1024
v_mfma_f32_16x16x32_bf16 v[168:171], a[104:107], a[72:75], v[168:171]
v_mfma_f32_16x16x32_bf16 v[168:171], a[108:111], a[76:79], v[168:171]
ds_read_b128 a[148:151], v5 offset:7168
v_mfma_f32_16x16x32_bf16 v[144:147], a[108:111], a[68:71], v[144:147]
v_mfma_f32_16x16x32_bf16 v[144:147], a[104:107], a[64:67], v[144:147]
buffer_load_dwordx4 a[40:43], v2, s[40:43], s35 offen offset:1024 sc1
v_mfma_f32_16x16x32_bf16 v[148:151], a[112:115], a[64:67], v[148:151]
v_mfma_f32_16x16x32_bf16 v[148:151], a[116:119], a[68:71], v[148:151]
v_mfma_f32_16x16x32_bf16 v[172:175], a[116:119], a[76:79], v[172:175]
ds_read_b128 v[64:67], v233 offset:256
v_mfma_f32_16x16x32_bf16 v[172:175], a[112:115], a[72:75], v[172:175]
v_mfma_f32_16x16x32_bf16 v[196:199], a[112:115], a[80:83], v[196:199]
buffer_load_dwordx4 a[44:47], v2, s[40:43], s33 offen offset:1024 sc1
v_mfma_f32_16x16x32_bf16 v[196:199], a[116:119], a[84:87], v[196:199]
v_mfma_f32_16x16x32_bf16 v[220:223], a[116:119], a[92:95], v[220:223]
v_mfma_f32_16x16x32_bf16 v[220:223], a[112:115], a[88:91], v[220:223]
s_waitcnt lgkmcnt(1)
v_mfma_f32_16x16x32_bf16 v[224:227], a[128:131], a[88:91], v[224:227]
ds_read_b128 a[96:99], v5 offset:14336
v_mfma_f32_16x16x32_bf16 v[224:227], a[132:135], a[92:95], v[224:227]
buffer_load_dwordx4 a[48:51], v2, s[40:43], s35 offen offset:2048 sc1
v_mfma_f32_16x16x32_bf16 v[200:203], a[132:135], a[84:87], v[200:203]
ds_read_b128 a[100:103], v5 offset:20480
v_mfma_f32_16x16x32_bf16 v[200:203], a[128:131], a[80:83], v[200:203]
v_mfma_f32_16x16x32_bf16 v[176:179], a[128:131], a[72:75], v[176:179]
v_mfma_f32_16x16x32_bf16 v[176:179], a[132:135], a[76:79], v[176:179]
buffer_load_dwordx4 a[52:55], v2, s[40:43], s33 offen offset:2048 sc1
v_mfma_f32_16x16x32_bf16 v[152:155], a[132:135], a[68:71], v[152:155]
ds_read_b128 a[104:107], v5 offset:15360
v_mfma_f32_16x16x32_bf16 v[152:155], a[128:131], a[64:67], v[152:155]
ds_read_b128 v[68:71], v233 offset:320
v_mfma_f32_16x16x32_bf16 v[132:135], a[136:139], a[64:67], v[132:135]
ds_read_b128 a[108:111], v5 offset:21504
v_mfma_f32_16x16x32_bf16 v[132:135], a[140:143], a[68:71], v[132:135]
v_mfma_f32_16x16x32_bf16 v[156:159], a[140:143], a[76:79], v[156:159]
buffer_load_dwordx4 v1, s[4:7], s44 offen offset:1024 sc1 lds
v_mfma_f32_16x16x32_bf16 v[156:159], a[136:139], a[72:75], v[156:159]
ds_read_b128 a[112:115], v5 offset:16384
v_mfma_f32_16x16x32_bf16 v[180:183], a[136:139], a[80:83], v[180:183]
v_mfma_f32_16x16x32_bf16 v[180:183], a[140:143], a[84:87], v[180:183]
ds_read_b128 a[116:119], v5 offset:22528
v_mfma_f32_16x16x32_bf16 v[204:207], a[140:143], a[92:95], v[204:207]
v_mfma_f32_16x16x32_bf16 v[204:207], a[136:139], a[88:91], v[204:207]
buffer_load_dwordx4 a[56:59], v2, s[40:43], s35 offen offset:3072 sc1
v_mfma_f32_16x16x32_bf16 v[208:211], a[144:147], a[88:91], v[208:211]
v_mfma_f32_16x16x32_bf16 v[208:211], a[148:151], a[92:95], v[208:211]
v_mfma_f32_16x16x32_bf16 v[184:187], a[148:151], a[84:87], v[184:187]
v_mfma_f32_16x16x32_bf16 v[184:187], a[144:147], a[80:83], v[184:187]
v_mfma_f32_16x16x32_bf16 v[160:163], a[144:147], a[72:75], v[160:163]
buffer_load_dwordx4 a[60:63], v2, s[40:43], s33 offen offset:3072 sc1
s_add_u32 s35, s35, 8192
v_mfma_f32_16x16x32_bf16 v[160:163], a[148:151], a[76:79], v[160:163]
s_add_u32 s33, s33, 8192
v_mfma_f32_16x16x32_bf16 v[136:139], a[148:151], a[68:71], v[136:139]
v_mfma_f32_16x16x32_bf16 v[136:139], a[144:147], a[64:67], v[136:139]
s_waitcnt vmcnt(10) lgkmcnt(0)
v_mfma_f32_16x16x32_bf16 v[140:143], a[96:99], a[0:3], v[140:143]
ds_read_b128 a[128:131], v5 offset:17408
v_add_f32 v92, v92, v96
v_mfma_f32_16x16x32_bf16 v[140:143], a[100:103], a[4:7], v[140:143]
buffer_load_dwordx4 a[64:67], v2, s[40:43], s35 offen offset:0 sc1
v_mfma_f32_16x16x32_bf16 v[164:167], a[100:103], a[12:15], v[164:167]
ds_read_b128 a[132:135], v5 offset:23552
v_add_f32 v100, v100, v104
v_mfma_f32_16x16x32_bf16 v[164:167], a[96:99], a[8:11], v[164:167]
v_add_f32 v108, v108, v112
v_add_f32 v116, v116, v120
v_mfma_f32_16x16x32_bf16 v[188:191], a[96:99], a[16:19], v[188:191]
v_add_f32 v93, v93, v97
v_add_f32 v101, v101, v105
v_mfma_f32_16x16x32_bf16 v[188:191], a[100:103], a[20:23], v[188:191]
buffer_load_dwordx4 a[68:71], v2, s[40:43], s33 offen offset:0 sc1
v_mfma_f32_16x16x32_bf16 v[212:215], a[100:103], a[28:31], v[212:215]
ds_read_b128 a[136:139], v5 offset:12288
v_add_f32 v109, v109, v113
v_mfma_f32_16x16x32_bf16 v[212:215], a[96:99], a[24:27], v[212:215]
v_add_f32 v117, v117, v121
v_add_f32 v94, v94, v98
v_mfma_f32_16x16x32_bf16 v[216:219], a[104:107], a[24:27], v[216:219]
ds_read_b128 a[140:143], v5 offset:18432
v_add_f32 v102, v102, v106
v_mfma_f32_16x16x32_bf16 v[216:219], a[108:111], a[28:31], v[216:219]
v_add_f32 v110, v110, v114
v_mfma_f32_16x16x32_bf16 v[192:195], a[108:111], a[20:23], v[192:195]
buffer_load_dwordx4 v1, s[4:7], s44 offen offset:2048 sc1 lds
s_add_u32 m0, s18, 0x6000
v_mfma_f32_16x16x32_bf16 v[192:195], a[104:107], a[16:19], v[192:195]
s_add_u32 s44, s50, 0x142a000
ds_read_b128 a[144:147], v5 offset:13312
v_mfma_f32_16x16x32_bf16 v[168:171], a[104:107], a[8:11], v[168:171]
v_add_f32 v118, v118, v122
v_add_f32 v95, v95, v99
v_mfma_f32_16x16x32_bf16 v[168:171], a[108:111], a[12:15], v[168:171]
ds_read_b128 a[148:151], v5 offset:19456
v_add_f32 v103, v103, v107
v_mfma_f32_16x16x32_bf16 v[144:147], a[108:111], a[4:7], v[144:147]
v_add_f32 v111, v111, v115
v_add_f32 v119, v119, v123
v_mfma_f32_16x16x32_bf16 v[144:147], a[104:107], a[0:3], v[144:147]
buffer_load_dwordx4 a[72:75], v2, s[40:43], s35 offen offset:1024 sc1
v_mfma_f32_16x16x32_bf16 v[148:151], a[112:115], a[0:3], v[148:151]
v_add_f32_dpp v92, v92, v92 row_ror:8 row_mask:0xf bank_mask:0xf
v_add_f32_dpp v100, v100, v100 row_ror:8 row_mask:0xf bank_mask:0xf
v_mfma_f32_16x16x32_bf16 v[148:151], a[116:119], a[4:7], v[148:151]
v_add_f32_dpp v108, v108, v108 row_ror:8 row_mask:0xf bank_mask:0xf
v_mfma_f32_16x16x32_bf16 v[172:175], a[116:119], a[12:15], v[172:175]
v_add_f32_dpp v116, v116, v116 row_ror:8 row_mask:0xf bank_mask:0xf
v_mfma_f32_16x16x32_bf16 v[172:175], a[112:115], a[8:11], v[172:175]
v_add_f32_dpp v93, v93, v93 row_ror:8 row_mask:0xf bank_mask:0xf
v_mfma_f32_16x16x32_bf16 v[196:199], a[112:115], a[16:19], v[196:199]
buffer_load_dwordx4 a[76:79], v2, s[40:43], s33 offen offset:1024 sc1
v_mfma_f32_16x16x32_bf16 v[196:199], a[116:119], a[20:23], v[196:199]
v_add_f32_dpp v101, v101, v101 row_ror:8 row_mask:0xf bank_mask:0xf
v_add_f32_dpp v109, v109, v109 row_ror:8 row_mask:0xf bank_mask:0xf
v_mfma_f32_16x16x32_bf16 v[220:223], a[116:119], a[28:31], v[220:223]
v_add_f32_dpp v117, v117, v117 row_ror:8 row_mask:0xf bank_mask:0xf
v_mfma_f32_16x16x32_bf16 v[220:223], a[112:115], a[24:27], v[220:223]
v_add_f32_dpp v92, v94, v94 row_ror:8 row_mask:0xf bank_mask:0xc
s_waitcnt lgkmcnt(0)
v_mfma_f32_16x16x32_bf16 v[224:227], a[128:131], a[24:27], v[224:227]
ds_read_b128 a[96:99], v5 offset:26624
v_accvgpr_write_b32 a216, v48
v_mfma_f32_16x16x32_bf16 v[224:227], a[132:135], a[28:31], v[224:227]
buffer_load_dwordx4 a[80:83], v2, s[40:43], s35 offen offset:2048 sc1
v_mfma_f32_16x16x32_bf16 v[200:203], a[132:135], a[20:23], v[200:203]
ds_read_b128 a[100:103], v5 offset:32768
v_add_f32_dpp v100, v102, v102 row_ror:8 row_mask:0xf bank_mask:0xc
v_mfma_f32_16x16x32_bf16 v[200:203], a[128:131], a[16:19], v[200:203]
v_accvgpr_write_b32 a217, v49
v_add_f32_dpp v108, v110, v110 row_ror:8 row_mask:0xf bank_mask:0xc
v_mfma_f32_16x16x32_bf16 v[176:179], a[128:131], a[8:11], v[176:179]
v_add_f32_dpp v116, v118, v118 row_ror:8 row_mask:0xf bank_mask:0xc
v_add_f32_dpp v93, v95, v95 row_ror:8 row_mask:0xf bank_mask:0xc
v_mfma_f32_16x16x32_bf16 v[176:179], a[132:135], a[12:15], v[176:179]
buffer_load_dwordx4 v1, s[4:7], s44 offen offset:0 sc1 lds
v_mfma_f32_16x16x32_bf16 v[152:155], a[132:135], a[4:7], v[152:155]
ds_read_b128 a[104:107], v5 offset:27648
v_accvgpr_write_b32 a218, v50
v_mfma_f32_16x16x32_bf16 v[152:155], a[128:131], a[0:3], v[152:155]
v_add_f32_dpp v101, v103, v103 row_ror:8 row_mask:0xf bank_mask:0xc
v_add_f32_dpp v109, v111, v111 row_ror:8 row_mask:0xf bank_mask:0xc
v_mfma_f32_16x16x32_bf16 v[132:135], a[136:139], a[0:3], v[132:135]
ds_read_b128 a[108:111], v5 offset:33792
v_add_f32_dpp v117, v119, v119 row_ror:8 row_mask:0xf bank_mask:0xc
v_mfma_f32_16x16x32_bf16 v[132:135], a[140:143], a[4:7], v[132:135]
buffer_load_dwordx4 a[84:87], v2, s[40:43], s33 offen offset:2048 sc1
v_mfma_f32_16x16x32_bf16 v[156:159], a[140:143], a[12:15], v[156:159]
ds_read_b128 a[112:115], v5 offset:28672
v_accvgpr_write_b32 a219, v51
v_mfma_f32_16x16x32_bf16 v[156:159], a[136:139], a[8:11], v[156:159]
v_permlane32_swap_b32 v92, v93
v_mfma_f32_16x16x32_bf16 v[180:183], a[136:139], a[16:19], v[180:183]
v_accvgpr_write_b32 a220, v52
v_mfma_f32_16x16x32_bf16 v[180:183], a[140:143], a[20:23], v[180:183]
buffer_load_dwordx4 a[88:91], v2, s[40:43], s35 offen offset:3072 sc1
v_mfma_f32_16x16x32_bf16 v[204:207], a[140:143], a[28:31], v[204:207]
ds_read_b128 a[116:119], v5 offset:34816
v_mfma_f32_16x16x32_bf16 v[204:207], a[136:139], a[24:27], v[204:207]
v_accvgpr_write_b32 a221, v53
v_mfma_f32_16x16x32_bf16 v[208:211], a[144:147], a[24:27], v[208:211]
v_permlane32_swap_b32 v100, v101
v_mfma_f32_16x16x32_bf16 v[208:211], a[148:151], a[28:31], v[208:211]
buffer_load_dwordx4 v1, s[4:7], s44 offen offset:1024 sc1 lds
v_mfma_f32_16x16x32_bf16 v[184:187], a[148:151], a[20:23], v[184:187]
v_accvgpr_write_b32 a222, v54
v_mfma_f32_16x16x32_bf16 v[184:187], a[144:147], a[16:19], v[184:187]
v_permlane32_swap_b32 v108, v109
v_mfma_f32_16x16x32_bf16 v[160:163], a[144:147], a[8:11], v[160:163]
v_permlane32_swap_b32 v116, v117
v_mfma_f32_16x16x32_bf16 v[160:163], a[148:151], a[12:15], v[160:163]
buffer_load_dwordx4 a[92:95], v2, s[40:43], s33 offen offset:3072 sc1
s_add_u32 s35, s35, 8192
v_mfma_f32_16x16x32_bf16 v[136:139], a[148:151], a[4:7], v[136:139]
s_add_u32 s33, s33, 8192
v_accvgpr_write_b32 a223, v55
v_mfma_f32_16x16x32_bf16 v[136:139], a[144:147], a[0:3], v[136:139]
v_add_f32 v92, v92, v93
s_waitcnt vmcnt(11) lgkmcnt(0)
v_mfma_f32_16x16x32_bf16 v[140:143], a[96:99], a[32:35], v[140:143]
ds_read_b128 a[128:131], v5 offset:29696
v_accvgpr_write_b32 a224, v56
v_mfma_f32_16x16x32_bf16 v[140:143], a[100:103], a[36:39], v[140:143]
buffer_load_dwordx4 a[0:3], v2, s[40:43], s35 offen offset:0 sc1
v_mfma_f32_16x16x32_bf16 v[164:167], a[100:103], a[44:47], v[164:167]
ds_read_b128 a[132:135], v5 offset:35840
v_add_f32 v100, v100, v101
v_mfma_f32_16x16x32_bf16 v[164:167], a[96:99], a[40:43], v[164:167]
v_accvgpr_write_b32 a225, v57
v_add_f32 v108, v108, v109
v_mfma_f32_16x16x32_bf16 v[188:191], a[96:99], a[48:51], v[188:191]
v_add_f32 v116, v116, v117
v_mov_b32 v94, v92
v_mfma_f32_16x16x32_bf16 v[188:191], a[100:103], a[52:55], v[188:191]
buffer_load_dwordx4 a[4:7], v2, s[40:43], s33 offen offset:0 sc1
v_mfma_f32_16x16x32_bf16 v[212:215], a[100:103], a[60:63], v[212:215]
ds_read_b128 a[136:139], v5 offset:24576
v_accvgpr_write_b32 a226, v58
v_mfma_f32_16x16x32_bf16 v[212:215], a[96:99], a[56:59], v[212:215]
v_mov_b32 v102, v100
v_mov_b32 v110, v108
v_mfma_f32_16x16x32_bf16 v[216:219], a[104:107], a[56:59], v[216:219]
ds_read_b128 a[140:143], v5 offset:30720
v_mov_b32 v118, v116
v_mfma_f32_16x16x32_bf16 v[216:219], a[108:111], a[60:63], v[216:219]
v_accvgpr_write_b32 a227, v59
v_mfma_f32_16x16x32_bf16 v[192:195], a[108:111], a[52:55], v[192:195]
buffer_load_dwordx4 v1, s[4:7], s44 offen offset:2048 sc1 lds
s_add_u32 m0, s18, 0x9000
v_mfma_f32_16x16x32_bf16 v[192:195], a[104:107], a[48:51], v[192:195]
s_add_u32 s44, s50, 0x142d000
ds_read_b128 a[144:147], v5 offset:25600
v_mfma_f32_16x16x32_bf16 v[168:171], a[104:107], a[40:43], v[168:171]
v_accvgpr_write_b32 a228, v60
v_mfma_f32_16x16x32_bf16 v[168:171], a[108:111], a[44:47], v[168:171]
ds_read_b128 a[148:151], v5 offset:31744
v_mfma_f32_16x16x32_bf16 v[144:147], a[108:111], a[36:39], v[144:147]
v_permlane16_swap_b32 v92, v94
v_mfma_f32_16x16x32_bf16 v[144:147], a[104:107], a[32:35], v[144:147]
buffer_load_dwordx4 a[8:11], v2, s[40:43], s35 offen offset:1024 sc1
v_mfma_f32_16x16x32_bf16 v[148:151], a[112:115], a[32:35], v[148:151]
v_accvgpr_write_b32 a229, v61
v_mfma_f32_16x16x32_bf16 v[148:151], a[116:119], a[36:39], v[148:151]
v_permlane16_swap_b32 v100, v102
v_mfma_f32_16x16x32_bf16 v[172:175], a[116:119], a[44:47], v[172:175]
v_accvgpr_write_b32 a230, v62
v_mfma_f32_16x16x32_bf16 v[172:175], a[112:115], a[40:43], v[172:175]
v_permlane16_swap_b32 v108, v110
v_mfma_f32_16x16x32_bf16 v[196:199], a[112:115], a[48:51], v[196:199]
buffer_load_dwordx4 a[12:15], v2, s[40:43], s33 offen offset:1024 sc1
v_mfma_f32_16x16x32_bf16 v[196:199], a[116:119], a[52:55], v[196:199]
v_accvgpr_write_b32 a231, v63
v_mfma_f32_16x16x32_bf16 v[220:223], a[116:119], a[60:63], v[220:223]
v_permlane16_swap_b32 v116, v118
v_mfma_f32_16x16x32_bf16 v[220:223], a[112:115], a[56:59], v[220:223]
v_add_f32 v92, v92, v94
s_waitcnt lgkmcnt(0)
v_mfma_f32_16x16x32_bf16 v[224:227], a[128:131], a[56:59], v[224:227]
ds_read_b128 a[96:99], v5 offset:38912
v_accvgpr_write_b32 a232, v64
v_mfma_f32_16x16x32_bf16 v[224:227], a[132:135], a[60:63], v[224:227]
buffer_load_dwordx4 a[16:19], v2, s[40:43], s35 offen offset:2048 sc1
L_stub6:
s_cbranch_execz L_stub7
v_mfma_f32_16x16x32_bf16 v[200:203], a[132:135], a[52:55], v[200:203]
ds_read_b128 a[100:103], v5 offset:45056
v_add_f32 v100, v100, v102
v_mfma_f32_16x16x32_bf16 v[200:203], a[128:131], a[48:51], v[200:203]
v_accvgpr_write_b32 a233, v65
v_add_f32 v108, v108, v110
v_mfma_f32_16x16x32_bf16 v[176:179], a[128:131], a[40:43], v[176:179]
v_add_f32 v116, v116, v118
v_mov_b32 v94, v92
v_mfma_f32_16x16x32_bf16 v[176:179], a[132:135], a[44:47], v[176:179]
buffer_load_dwordx4 a[20:23], v2, s[40:43], s33 offen offset:2048 sc1
v_mfma_f32_16x16x32_bf16 v[152:155], a[132:135], a[36:39], v[152:155]
ds_read_b128 a[104:107], v5 offset:39936
v_accvgpr_write_b32 a234, v66
v_mfma_f32_16x16x32_bf16 v[152:155], a[128:131], a[32:35], v[152:155]
v_mov_b32 v102, v100
v_mov_b32 v110, v108
v_mfma_f32_16x16x32_bf16 v[132:135], a[136:139], a[32:35], v[132:135]
ds_read_b128 a[108:111], v5 offset:46080
v_mov_b32 v118, v116
v_mfma_f32_16x16x32_bf16 v[132:135], a[140:143], a[36:39], v[132:135]
v_accvgpr_write_b32 a235, v67
v_mfma_f32_16x16x32_bf16 v[156:159], a[140:143], a[44:47], v[156:159]
buffer_load_dwordx4 v1, s[4:7], s44 offen offset:0 sc1 lds
v_mfma_f32_16x16x32_bf16 v[156:159], a[136:139], a[40:43], v[156:159]
ds_read_b128 a[112:115], v5 offset:40960
v_mfma_f32_16x16x32_bf16 v[180:183], a[136:139], a[48:51], v[180:183]
v_accvgpr_write_b32 a236, v68
v_mfma_f32_16x16x32_bf16 v[180:183], a[140:143], a[52:55], v[180:183]
ds_read_b128 a[116:119], v5 offset:47104
v_mfma_f32_16x16x32_bf16 v[204:207], a[140:143], a[60:63], v[204:207]
v_permlane32_swap_b32 v92, v94
v_mfma_f32_16x16x32_bf16 v[204:207], a[136:139], a[56:59], v[204:207]
buffer_load_dwordx4 a[24:27], v2, s[40:43], s35 offen offset:3072 sc1
v_mfma_f32_16x16x32_bf16 v[208:211], a[144:147], a[56:59], v[208:211]
v_accvgpr_write_b32 a237, v69
v_mfma_f32_16x16x32_bf16 v[208:211], a[148:151], a[60:63], v[208:211]
v_permlane32_swap_b32 v100, v102
v_mfma_f32_16x16x32_bf16 v[184:187], a[148:151], a[52:55], v[184:187]
v_accvgpr_write_b32 a238, v70
v_mfma_f32_16x16x32_bf16 v[184:187], a[144:147], a[48:51], v[184:187]
v_permlane32_swap_b32 v108, v110
v_mfma_f32_16x16x32_bf16 v[160:163], a[144:147], a[40:43], v[160:163]
buffer_load_dwordx4 a[28:31], v2, s[40:43], s33 offen offset:3072 sc1
s_add_u32 s35, s35, 8192
v_mfma_f32_16x16x32_bf16 v[160:163], a[148:151], a[44:47], v[160:163]
s_add_u32 s33, s33, 8192
v_accvgpr_write_b32 a239, v71
v_mfma_f32_16x16x32_bf16 v[136:139], a[148:151], a[36:39], v[136:139]
v_permlane32_swap_b32 v116, v118
v_mfma_f32_16x16x32_bf16 v[136:139], a[144:147], a[32:35], v[136:139]
v_mul_f32 v82, 0xba800000, v92
s_waitcnt vmcnt(10) lgkmcnt(0)
v_mfma_f32_16x16x32_bf16 v[140:143], a[96:99], a[64:67], v[140:143]
ds_read_b128 a[128:131], v5 offset:41984
v_mul_f32 v84, 0xba800000, v100
v_mfma_f32_16x16x32_bf16 v[140:143], a[100:103], a[68:71], v[140:143]
buffer_load_dwordx4 a[32:35], v2, s[40:43], s35 offen offset:0 sc1
v_mfma_f32_16x16x32_bf16 v[164:167], a[100:103], a[76:79], v[164:167]
ds_read_b128 a[132:135], v5 offset:48128
v_mul_f32 v86, 0xba800000, v108
v_mfma_f32_16x16x32_bf16 v[164:167], a[96:99], a[72:75], v[164:167]
v_mul_f32 v88, 0xba800000, v116
v_mul_f32 v94, 0x3a800000, v94
v_mfma_f32_16x16x32_bf16 v[188:191], a[96:99], a[80:83], v[188:191]
v_mul_f32 v102, 0x3a800000, v102
v_mul_f32 v110, 0x3a800000, v110
v_mfma_f32_16x16x32_bf16 v[188:191], a[100:103], a[84:87], v[188:191]
buffer_load_dwordx4 a[36:39], v2, s[40:43], s33 offen offset:0 sc1
v_mfma_f32_16x16x32_bf16 v[212:215], a[100:103], a[92:95], v[212:215]
ds_read_b128 a[136:139], v5 offset:36864
v_mul_f32 v118, 0x3a800000, v118
v_mfma_f32_16x16x32_bf16 v[212:215], a[96:99], a[88:91], v[212:215]
v_fma_f32 v94, -v82, v82, v94
v_fma_f32 v102, -v84, v84, v102
v_fma_f32 v110, -v86, v86, v110
v_fma_f32 v118, -v88, v88, v118
v_max_f32 v94, 0, v94
v_max_f32 v102, 0, v102
v_max_f32 v110, 0, v110
v_max_f32 v118, 0, v118
v_add_f32 v94, 0x3727c5ac, v94
v_add_f32 v102, 0x3727c5ac, v102
v_add_f32 v110, 0x3727c5ac, v110
v_add_f32 v118, 0x3727c5ac, v118
v_rsq_f32 v83, v94
v_rsq_f32 v85, v102
v_rsq_f32 v87, v110
v_rsq_f32 v89, v118
v_mfma_f32_16x16x32_bf16 v[216:219], a[104:107], a[88:91], v[216:219]
ds_read_b128 a[140:143], v5 offset:43008
v_mfma_f32_16x16x32_bf16 v[216:219], a[108:111], a[92:95], v[216:219]
v_mfma_f32_16x16x32_bf16 v[192:195], a[108:111], a[84:87], v[192:195]
buffer_load_dwordx4 v1, s[4:7], s44 offen offset:1024 sc1 lds
v_mfma_f32_16x16x32_bf16 v[192:195], a[104:107], a[80:83], v[192:195]
ds_read_b128 a[144:147], v5 offset:37888
v_fmac_f32 v140, v56, v82
v_mfma_f32_16x16x32_bf16 v[168:171], a[104:107], a[72:75], v[168:171]
v_fmac_f32 v164, v56, v84
v_mfma_f32_16x16x32_bf16 v[168:171], a[108:111], a[76:79], v[168:171]
ds_read_b128 a[148:151], v5 offset:44032
v_mfma_f32_16x16x32_bf16 v[144:147], a[108:111], a[68:71], v[144:147]
v_fmac_f32 v188, v56, v86
v_mfma_f32_16x16x32_bf16 v[144:147], a[104:107], a[64:67], v[144:147]
buffer_load_dwordx4 a[40:43], v2, s[40:43], s35 offen offset:1024 sc1
v_mfma_f32_16x16x32_bf16 v[148:151], a[112:115], a[64:67], v[148:151]
v_fmac_f32 v212, v56, v88
v_mfma_f32_16x16x32_bf16 v[148:151], a[116:119], a[68:71], v[148:151]
v_mfma_f32_16x16x32_bf16 v[172:175], a[116:119], a[76:79], v[172:175]
v_fmac_f32 v216, v60, v88
v_mfma_f32_16x16x32_bf16 v[172:175], a[112:115], a[72:75], v[172:175]
v_mfma_f32_16x16x32_bf16 v[196:199], a[112:115], a[80:83], v[196:199]
buffer_load_dwordx4 a[44:47], v2, s[40:43], s33 offen offset:1024 sc1
v_mfma_f32_16x16x32_bf16 v[196:199], a[116:119], a[84:87], v[196:199]
v_fmac_f32 v192, v60, v86
v_mfma_f32_16x16x32_bf16 v[220:223], a[116:119], a[92:95], v[220:223]
v_fmac_f32 v168, v60, v84
v_fmac_f32 v141, v57, v82
v_mfma_f32_16x16x32_bf16 v[220:223], a[112:115], a[88:91], v[220:223]
s_waitcnt lgkmcnt(0)
s_barrier
v_mfma_f32_16x16x32_bf16 v[224:227], a[128:131], a[88:91], v[224:227]
v_add_u32 v5, 0, v1
v_fmac_f32 v144, v60, v82
v_mfma_f32_16x16x32_bf16 v[224:227], a[132:135], a[92:95], v[224:227]
buffer_load_dwordx4 a[48:51], v2, s[40:43], s35 offen offset:2048 sc1
v_mfma_f32_16x16x32_bf16 v[200:203], a[132:135], a[84:87], v[200:203]
ds_read_b128 a[96:99], v5 offset:2048
v_fmac_f32 v148, v64, v82
v_mfma_f32_16x16x32_bf16 v[200:203], a[128:131], a[80:83], v[200:203]
ds_read_b128 a[100:103], v5 offset:8192
v_fmac_f32 v165, v57, v84
v_mfma_f32_16x16x32_bf16 v[176:179], a[128:131], a[72:75], v[176:179]
v_fmac_f32 v172, v64, v84
v_fmac_f32 v189, v57, v86
v_mfma_f32_16x16x32_bf16 v[176:179], a[132:135], a[76:79], v[176:179]
buffer_load_dwordx4 a[52:55], v2, s[40:43], s33 offen offset:2048 sc1
v_mfma_f32_16x16x32_bf16 v[152:155], a[132:135], a[68:71], v[152:155]
ds_read_b128 a[104:107], v5 offset:3072
v_fmac_f32 v196, v64, v86
v_mfma_f32_16x16x32_bf16 v[152:155], a[128:131], a[64:67], v[152:155]
v_fmac_f32 v213, v57, v88
v_fmac_f32 v217, v61, v88
v_mfma_f32_16x16x32_bf16 v[132:135], a[136:139], a[64:67], v[132:135]
ds_read_b128 a[108:111], v5 offset:9216
v_fmac_f32 v220, v64, v88
v_mfma_f32_16x16x32_bf16 v[132:135], a[140:143], a[68:71], v[132:135]
v_fmac_f32 v193, v61, v86
v_mfma_f32_16x16x32_bf16 v[156:159], a[140:143], a[76:79], v[156:159]
buffer_load_dwordx4 v1, s[4:7], s44 offen offset:2048 sc1 lds
s_add_u32 m0, s19, 49152
v_mfma_f32_16x16x32_bf16 v[156:159], a[136:139], a[72:75], v[156:159]
s_add_u32 s44, s85, 0xc04000
ds_read_b128 a[112:115], v5 offset:4096
v_mfma_f32_16x16x32_bf16 v[180:183], a[136:139], a[80:83], v[180:183]
v_fmac_f32 v224, v68, v88
v_fmac_f32 v200, v68, v86
v_mfma_f32_16x16x32_bf16 v[180:183], a[140:143], a[84:87], v[180:183]
ds_read_b128 a[116:119], v5 offset:10240
v_fmac_f32 v169, v61, v84
v_mfma_f32_16x16x32_bf16 v[204:207], a[140:143], a[92:95], v[204:207]
v_fmac_f32 v176, v68, v84
v_fmac_f32 v145, v61, v82
v_mfma_f32_16x16x32_bf16 v[204:207], a[136:139], a[88:91], v[204:207]
buffer_load_dwordx4 a[56:59], v2, s[40:43], s35 offen offset:3072 sc1
v_mfma_f32_16x16x32_bf16 v[208:211], a[144:147], a[88:91], v[208:211]
v_fmac_f32 v152, v68, v82
v_fmac_f32 v149, v65, v82
v_mfma_f32_16x16x32_bf16 v[208:211], a[148:151], a[92:95], v[208:211]
v_fmac_f32 v173, v65, v84
v_mfma_f32_16x16x32_bf16 v[184:187], a[148:151], a[84:87], v[184:187]
v_fmac_f32 v132, v48, v82
v_fmac_f32 v197, v65, v86
v_mfma_f32_16x16x32_bf16 v[184:187], a[144:147], a[80:83], v[184:187]
v_mfma_f32_16x16x32_bf16 v[160:163], a[144:147], a[72:75], v[160:163]
buffer_load_dwordx4 a[60:63], v2, s[40:43], s33 offen offset:3072 sc1
s_add_u32 s35, s35, 8192
v_mfma_f32_16x16x32_bf16 v[160:163], a[148:151], a[76:79], v[160:163]
s_add_u32 s33, s33, 8192
v_fmac_f32 v156, v48, v84
v_mfma_f32_16x16x32_bf16 v[136:139], a[148:151], a[68:71], v[136:139]
v_fmac_f32 v180, v48, v86
v_fmac_f32 v221, v65, v88
v_mfma_f32_16x16x32_bf16 v[136:139], a[144:147], a[64:67], v[136:139]
v_fmac_f32 v225, v69, v88
s_waitcnt vmcnt(10) lgkmcnt(0)
v_mfma_f32_16x16x32_bf16 v[140:143], a[96:99], a[0:3], v[140:143]
ds_read_b128 a[128:131], v5 offset:5120
v_fmac_f32 v204, v48, v88
v_mfma_f32_16x16x32_bf16 v[140:143], a[100:103], a[4:7], v[140:143]
buffer_load_dwordx4 a[64:67], v2, s[40:43], s35 offen offset:0 sc1
s_lshl_b32 s36, s28, 9
v_mfma_f32_16x16x32_bf16 v[164:167], a[100:103], a[12:15], v[164:167]
ds_read_b128 a[132:135], v5 offset:11264
v_fmac_f32 v208, v52, v88
v_mfma_f32_16x16x32_bf16 v[164:167], a[96:99], a[8:11], v[164:167]
v_fmac_f32 v201, v69, v86
v_fmac_f32 v177, v69, v84
v_mfma_f32_16x16x32_bf16 v[188:191], a[96:99], a[16:19], v[188:191]
v_fmac_f32 v184, v52, v86
v_fmac_f32 v153, v69, v82
v_mfma_f32_16x16x32_bf16 v[188:191], a[100:103], a[20:23], v[188:191]
buffer_load_dwordx4 a[68:71], v2, s[40:43], s33 offen offset:0 sc1
s_lshl_b32 s37, s30, 2
v_mfma_f32_16x16x32_bf16 v[212:215], a[100:103], a[28:31], v[212:215]
ds_read_b128 a[136:139], v5 offset:0
v_fmac_f32 v160, v52, v84
v_mfma_f32_16x16x32_bf16 v[212:215], a[96:99], a[24:27], v[212:215]
v_fmac_f32 v133, v49, v82
v_add_u32 v232, s19, v7
v_mfma_f32_16x16x32_bf16 v[216:219], a[104:107], a[24:27], v[216:219]
ds_read_b128 a[140:143], v5 offset:6144
v_fmac_f32 v136, v52, v82
v_mfma_f32_16x16x32_bf16 v[216:219], a[108:111], a[28:31], v[216:219]
buffer_load_dwordx4 a[72:75], v2, s[40:43], s35 offen offset:1024 sc1
s_add_u32 s37, s37, s28
v_mfma_f32_16x16x32_bf16 v[192:195], a[108:111], a[20:23], v[192:195]
ds_read_b128 a[144:147], v5 offset:1024
v_fmac_f32 v157, v49, v84
v_mfma_f32_16x16x32_bf16 v[192:195], a[104:107], a[16:19], v[192:195]
v_fmac_f32 v181, v49, v86
v_fmac_f32 v142, v58, v82
v_mfma_f32_16x16x32_bf16 v[168:171], a[104:107], a[8:11], v[168:171]
v_fmac_f32 v205, v49, v88
v_fmac_f32 v166, v58, v84
v_mfma_f32_16x16x32_bf16 v[168:171], a[108:111], a[12:15], v[168:171]
buffer_load_dwordx4 a[76:79], v2, s[40:43], s33 offen offset:1024 sc1
s_lshl_b32 s98, s37, 13
v_mfma_f32_16x16x32_bf16 v[144:147], a[108:111], a[4:7], v[144:147]
ds_read_b128 a[148:151], v5 offset:7168
v_fmac_f32 v209, v53, v88
v_mfma_f32_16x16x32_bf16 v[144:147], a[104:107], a[0:3], v[144:147]
v_fmac_f32 v190, v58, v86
s_add_u32 s98, s98, 0x400000
v_mfma_f32_16x16x32_bf16 v[148:151], a[112:115], a[0:3], v[148:151]
v_fmac_f32 v185, v53, v86
v_fmac_f32 v214, v58, v88
v_mfma_f32_16x16x32_bf16 v[148:151], a[116:119], a[4:7], v[148:151]
buffer_load_dwordx4 a[80:83], v2, s[40:43], s35 offen offset:2048 sc1
s_add_u32 s99, s98, 4096
v_mfma_f32_16x16x32_bf16 v[172:175], a[116:119], a[12:15], v[172:175]
v_fmac_f32 v161, v53, v84
v_fmac_f32 v218, v62, v88
v_mfma_f32_16x16x32_bf16 v[172:175], a[112:115], a[8:11], v[172:175]
s_lshl_b32 s100, s37, 10
s_add_u32 s100, s100, 0x800000
s_lshl_b32 s96, s29, 10
v_mfma_f32_16x16x32_bf16 v[196:199], a[112:115], a[16:19], v[196:199]
v_fmac_f32 v137, v53, v82
v_fmac_f32 v194, v62, v86
v_mfma_f32_16x16x32_bf16 v[196:199], a[116:119], a[20:23], v[196:199]
buffer_load_dwordx4 a[84:87], v2, s[40:43], s33 offen offset:2048 sc1
s_add_u32 s96, s96, s98
v_mfma_f32_16x16x32_bf16 v[220:223], a[116:119], a[28:31], v[220:223]
v_fmac_f32 v170, v62, v84
v_fmac_f32 v143, v59, v82
v_mfma_f32_16x16x32_bf16 v[220:223], a[112:115], a[24:27], v[220:223]
s_lshl_b32 s97, s29, 7
s_waitcnt lgkmcnt(0)
v_mfma_f32_16x16x32_bf16 v[224:227], a[128:131], a[24:27], v[224:227]
ds_read_b128 a[96:99], v5 offset:14336
v_fmac_f32 v146, v62, v82
v_mfma_f32_16x16x32_bf16 v[224:227], a[132:135], a[28:31], v[224:227]
buffer_load_dwordx4 a[88:91], v2, s[40:43], s35 offen offset:3072 sc1
s_add_u32 s97, s97, s100
v_mfma_f32_16x16x32_bf16 v[200:203], a[132:135], a[20:23], v[200:203]
ds_read_b128 a[100:103], v5 offset:20480
v_fmac_f32 v150, v66, v82
v_mfma_f32_16x16x32_bf16 v[200:203], a[128:131], a[16:19], v[200:203]
v_fmac_f32 v167, v59, v84
v_fmac_f32 v191, v59, v86
v_mfma_f32_16x16x32_bf16 v[176:179], a[128:131], a[8:11], v[176:179]
v_fmac_f32 v174, v66, v84
v_fmac_f32 v215, v59, v88
v_mfma_f32_16x16x32_bf16 v[176:179], a[132:135], a[12:15], v[176:179]
ds_read_b128 a[104:107], v5 offset:15360
s_lshl_b32 s88, s28, 6
v_mfma_f32_16x16x32_bf16 v[152:155], a[132:135], a[4:7], v[152:155]
v_fmac_f32 v198, v66, v86
v_fmac_f32 v219, v63, v88
v_mfma_f32_16x16x32_bf16 v[152:155], a[128:131], a[0:3], v[152:155]
buffer_load_dwordx4 v1, s[4:7], s44 offen offset:0 sc1 lds
s_add_u32 s94, s80, s88
v_mfma_f32_16x16x32_bf16 v[132:135], a[136:139], a[0:3], v[132:135]
ds_read_b128 a[108:111], v5 offset:21504
v_fmac_f32 v222, v66, v88
v_mfma_f32_16x16x32_bf16 v[132:135], a[140:143], a[4:7], v[132:135]
v_fmac_f32 v195, v63, v86
s_add_u32 s94, s94, 0x80000
v_mfma_f32_16x16x32_bf16 v[156:159], a[140:143], a[12:15], v[156:159]
ds_read_b128 a[112:115], v5 offset:16384
v_fmac_f32 v226, v70, v88
v_mfma_f32_16x16x32_bf16 v[156:159], a[136:139], a[8:11], v[156:159]
v_fmac_f32 v171, v63, v84
s_add_u32 s88, s88, s70
v_mfma_f32_16x16x32_bf16 v[180:183], a[136:139], a[16:19], v[180:183]
v_fmac_f32 v202, v70, v86
v_fmac_f32 v147, v63, v82
v_mfma_f32_16x16x32_bf16 v[180:183], a[140:143], a[20:23], v[180:183]
buffer_load_dwordx4 a[92:95], v2, s[40:43], s33 offen offset:3072 sc1
s_add_u32 s35, s35, 8192
v_mfma_f32_16x16x32_bf16 v[204:207], a[140:143], a[28:31], v[204:207]
s_add_u32 s33, s33, 8192
ds_read_b128 a[116:119], v5 offset:22528
v_mfma_f32_16x16x32_bf16 v[204:207], a[136:139], a[24:27], v[204:207]
v_fmac_f32 v178, v70, v84
v_fmac_f32 v151, v67, v82
v_mfma_f32_16x16x32_bf16 v[208:211], a[144:147], a[24:27], v[208:211]
v_fmac_f32 v154, v70, v82
v_fmac_f32 v175, v67, v84
v_mfma_f32_16x16x32_bf16 v[208:211], a[148:151], a[28:31], v[208:211]
s_add_u32 s89, s88, 0x80000
s_add_u32 s74, s71, 0x10080
s_lshl_b32 s73, s30, 12
v_mfma_f32_16x16x32_bf16 v[184:187], a[148:151], a[20:23], v[184:187]
v_fmac_f32 v134, v50, v82
v_fmac_f32 v199, v67, v86
v_mfma_f32_16x16x32_bf16 v[184:187], a[144:147], a[16:19], v[184:187]
buffer_load_dwordx4 v1, s[4:7], s44 offen offset:1024 sc1 lds
s_add_u32 s72, s73, 0x2600000
v_mfma_f32_16x16x32_bf16 v[160:163], a[144:147], a[8:11], v[160:163]
v_fmac_f32 v158, v50, v84
v_fmac_f32 v223, v67, v88
v_mfma_f32_16x16x32_bf16 v[160:163], a[148:151], a[12:15], v[160:163]
v_add_u32 v233, s19, v232
s_add_u32 s73, s73, 0x1e00000
v_mfma_f32_16x16x32_bf16 v[136:139], a[148:151], a[4:7], v[136:139]
v_fmac_f32 v182, v50, v86
v_fmac_f32 v227, v71, v88
v_mfma_f32_16x16x32_bf16 v[136:139], a[144:147], a[0:3], v[136:139]
s_waitcnt vmcnt(10) lgkmcnt(0)
s_barrier
v_mfma_f32_16x16x32_bf16 v[140:143], a[96:99], a[32:35], v[140:143]
ds_read_b128 a[128:131], v5 offset:17408
v_fmac_f32 v206, v50, v88
v_mfma_f32_16x16x32_bf16 v[140:143], a[100:103], a[36:39], v[140:143]
buffer_load_dwordx4 a[0:3], v2, s[40:43], s35 offen offset:0 sc1
s_lshr_b32 s38, s28, 1
v_mfma_f32_16x16x32_bf16 v[164:167], a[100:103], a[44:47], v[164:167]
ds_read_b128 a[132:135], v5 offset:23552
v_fmac_f32 v210, v54, v88
v_mfma_f32_16x16x32_bf16 v[164:167], a[96:99], a[40:43], v[164:167]
v_fmac_f32 v203, v71, v86
v_fmac_f32 v179, v71, v84
v_mfma_f32_16x16x32_bf16 v[188:191], a[96:99], a[48:51], v[188:191]
buffer_load_dwordx4 a[4:7], v2, s[40:43], s33 offen offset:0 sc1
s_and_b32 s39, s28, 1
v_mfma_f32_16x16x32_bf16 v[188:191], a[100:103], a[52:55], v[188:191]
ds_read_b128 a[136:139], v5 offset:26624
v_fmac_f32 v186, v54, v86
v_mfma_f32_16x16x32_bf16 v[212:215], a[100:103], a[60:63], v[212:215]
v_fmac_f32 v162, v54, v84
v_fmac_f32 v155, v71, v82
v_mfma_f32_16x16x32_bf16 v[212:215], a[96:99], a[56:59], v[212:215]
buffer_load_dwordx4 a[8:11], v2, s[40:43], s35 offen offset:1024 sc1
s_mul_i32 s38, s38, 3072
v_mfma_f32_16x16x32_bf16 v[216:219], a[104:107], a[56:59], v[216:219]
ds_read_b128 a[140:143], v5 offset:32768
v_fmac_f32 v138, v54, v82
v_mfma_f32_16x16x32_bf16 v[216:219], a[108:111], a[60:63], v[216:219]
v_fmac_f32 v135, v51, v82
v_fmac_f32 v159, v51, v84
v_mfma_f32_16x16x32_bf16 v[192:195], a[108:111], a[52:55], v[192:195]
buffer_load_dwordx4 a[12:15], v2, s[40:43], s33 offen offset:1024 sc1
s_lshl_b32 s39, s39, 3
v_mfma_f32_16x16x32_bf16 v[192:195], a[104:107], a[48:51], v[192:195]
ds_read_b128 a[144:147], v5 offset:27648
v_fmac_f32 v183, v51, v86
v_mfma_f32_16x16x32_bf16 v[168:171], a[104:107], a[40:43], v[168:171]
v_fmac_f32 v207, v51, v88
s_add_u32 s38, s38, s39
v_mfma_f32_16x16x32_bf16 v[168:171], a[108:111], a[44:47], v[168:171]
buffer_load_dwordx4 a[16:19], v2, s[40:43], s35 offen offset:2048 sc1
v_mfma_f32_16x16x32_bf16 v[144:147], a[108:111], a[36:39], v[144:147]
ds_read_b128 a[148:151], v5 offset:33792
v_fmac_f32 v211, v55, v88
v_mfma_f32_16x16x32_bf16 v[144:147], a[104:107], a[32:35], v[144:147]
v_mul_f32 v88, 0x3fb8aa3b, v89
v_and_b32 v248, 7, v0
v_mfma_f32_16x16x32_bf16 v[148:151], a[112:115], a[32:35], v[148:151]
buffer_load_dwordx4 a[20:23], v2, s[40:43], s33 offen offset:2048 sc1
v_mfma_f32_16x16x32_bf16 v[148:151], a[116:119], a[36:39], v[148:151]
v_fmac_f32 v187, v55, v86
v_lshlrev_b32 v248, 7, v248
v_mfma_f32_16x16x32_bf16 v[172:175], a[116:119], a[44:47], v[172:175]
v_fmac_f32 v163, v55, v84
v_mul_f32 v86, 0x3fb8aa3b, v87
v_mfma_f32_16x16x32_bf16 v[172:175], a[112:115], a[40:43], v[172:175]
buffer_load_dwordx4 a[24:27], v2, s[40:43], s35 offen offset:3072 sc1
v_mfma_f32_16x16x32_bf16 v[196:199], a[112:115], a[48:51], v[196:199]
v_fmac_f32 v139, v55, v82
v_mul_f32 v84, 0x3fb8aa3b, v85
v_mfma_f32_16x16x32_bf16 v[196:199], a[116:119], a[52:55], v[196:199]
v_mul_f32 v82, 0x3fb8aa3b, v83
v_lshrrev_b32 v249, 4, v0
v_mfma_f32_16x16x32_bf16 v[220:223], a[116:119], a[60:63], v[220:223]
buffer_load_dwordx4 a[28:31], v2, s[40:43], s33 offen offset:3072 sc1
s_add_u32 s35, s35, 8192
v_mfma_f32_16x16x32_bf16 v[220:223], a[112:115], a[56:59], v[220:223]
s_add_u32 s33, s33, 8192
s_waitcnt lgkmcnt(0)
v_mfma_f32_16x16x32_bf16 v[224:227], a[128:131], a[56:59], v[224:227]
ds_read_b128 a[96:99], v5 offset:28672
v_lshlrev_b32 v235, 8, v0
v_mfma_f32_16x16x32_bf16 v[224:227], a[132:135], a[60:63], v[224:227]
buffer_load_dwordx4 v1, s[4:7], s44 offen offset:2048 sc1 lds
v_mfma_f32_16x16x32_bf16 v[200:203], a[132:135], a[52:55], v[200:203]
ds_read_b128 a[100:103], v5 offset:34816
v_lshl_add_u32 v248, v249, 4, v248
v_mfma_f32_16x16x32_bf16 v[200:203], a[128:131], a[48:51], v[200:203]
v_add_u32 v234, s36, v8
v_cndmask_b32 v235, 2.0, v235, s[64:65]
v_mfma_f32_16x16x32_bf16 v[176:179], a[128:131], a[40:43], v[176:179]
v_mov_b32 v249, 0x3f80
v_mov_b32 v250, 1.0
v_mfma_f32_16x16x32_bf16 v[176:179], a[132:135], a[44:47], v[176:179]
ds_read_b128 a[104:107], v5 offset:29696
v_add_u32 v252, s38, v1
v_mfma_f32_16x16x32_bf16 v[152:155], a[132:135], a[36:39], v[152:155]
v_mfma_f32_16x16x32_bf16 v[152:155], a[128:131], a[32:35], v[152:155]
s_waitcnt vmcnt(18)
v_mfma_f32_16x16x32_bf16 v[140:143], a[136:139], a[64:67], v[140:143]
ds_read_b128 a[108:111], v5 offset:35840
s_waitcnt vmcnt(17)
v_mfma_f32_16x16x32_bf16 v[140:143], a[140:143], a[68:71], v[140:143]
s_waitcnt vmcnt(15)
v_mfma_f32_16x16x32_bf16 v[164:167], a[140:143], a[76:79], v[164:167]
ds_read_b128 a[112:115], v5 offset:38912
v_mfma_f32_16x16x32_bf16 v[164:167], a[136:139], a[72:75], v[164:167]
s_waitcnt vmcnt(14)
v_mfma_f32_16x16x32_bf16 v[188:191], a[136:139], a[80:83], v[188:191]
s_waitcnt vmcnt(13)
v_mfma_f32_16x16x32_bf16 v[188:191], a[140:143], a[84:87], v[188:191]
buffer_load_dwordx4 v1, s[4:7], s44 offen offset:3072 sc1 lds
s_add_u32 m0, s19, 65536
s_waitcnt vmcnt(11)
v_mfma_f32_16x16x32_bf16 v[212:215], a[140:143], a[92:95], v[212:215]
s_add_u32 s44, s84, 0xc08000
ds_read_b128 a[116:119], v5 offset:45056
v_mfma_f32_16x16x32_bf16 v[212:215], a[136:139], a[88:91], v[212:215]
v_mfma_f32_16x16x32_bf16 v[216:219], a[144:147], a[88:91], v[216:219]
v_mfma_f32_16x16x32_bf16 v[216:219], a[148:151], a[92:95], v[216:219]
v_mfma_f32_16x16x32_bf16 v[192:195], a[148:151], a[84:87], v[192:195]
v_mfma_f32_16x16x32_bf16 v[192:195], a[144:147], a[80:83], v[192:195]
v_mfma_f32_16x16x32_bf16 v[168:171], a[144:147], a[72:75], v[168:171]
v_mfma_f32_16x16x32_bf16 v[168:171], a[148:151], a[76:79], v[168:171]
v_mfma_f32_16x16x32_bf16 v[144:147], a[148:151], a[68:71], v[144:147]
v_mfma_f32_16x16x32_bf16 v[144:147], a[144:147], a[64:67], v[144:147]
s_waitcnt lgkmcnt(0)
v_mfma_f32_16x16x32_bf16 v[148:151], a[96:99], a[64:67], v[148:151]
ds_read_b128 a[128:131], v5 offset:39936
v_mfma_f32_16x16x32_bf16 v[148:151], a[100:103], a[68:71], v[148:151]
buffer_load_dwordx4 v1, s[4:7], s44 offen offset:0 sc1 lds
v_mfma_f32_16x16x32_bf16 v[172:175], a[100:103], a[76:79], v[172:175]
ds_read_b128 a[132:135], v5 offset:46080
v_mfma_f32_16x16x32_bf16 v[172:175], a[96:99], a[72:75], v[172:175]
v_mfma_f32_16x16x32_bf16 v[196:199], a[96:99], a[80:83], v[196:199]
v_mfma_f32_16x16x32_bf16 v[196:199], a[100:103], a[84:87], v[196:199]
buffer_load_dwordx4 v1, s[4:7], s44 offen offset:1024 sc1 lds
v_mfma_f32_16x16x32_bf16 v[220:223], a[100:103], a[92:95], v[220:223]
ds_read_b128 a[136:139], v5 offset:40960
v_mfma_f32_16x16x32_bf16 v[220:223], a[96:99], a[88:91], v[220:223]
v_mfma_f32_16x16x32_bf16 v[224:227], a[104:107], a[88:91], v[224:227]
ds_read_b128 a[140:143], v5 offset:47104
v_mfma_f32_16x16x32_bf16 v[224:227], a[108:111], a[92:95], v[224:227]
v_mfma_f32_16x16x32_bf16 v[200:203], a[108:111], a[84:87], v[200:203]
buffer_load_dwordx4 v1, s[4:7], s44 offen offset:2048 sc1 lds
v_mfma_f32_16x16x32_bf16 v[200:203], a[104:107], a[80:83], v[200:203]
ds_read_b128 a[144:147], v5 offset:41984
v_mfma_f32_16x16x32_bf16 v[176:179], a[104:107], a[72:75], v[176:179]
v_mfma_f32_16x16x32_bf16 v[176:179], a[108:111], a[76:79], v[176:179]
ds_read_b128 a[148:151], v5 offset:48128
v_mfma_f32_16x16x32_bf16 v[152:155], a[108:111], a[68:71], v[152:155]
v_mfma_f32_16x16x32_bf16 v[152:155], a[104:107], a[64:67], v[152:155]
buffer_load_dwordx4 v1, s[4:7], s44 offen offset:3072 sc1 lds
s_add_u32 m0, s19, 81920
s_waitcnt vmcnt(13)
v_mfma_f32_16x16x32_bf16 v[140:143], a[112:115], a[0:3], v[140:143]
s_add_u32 s44, s85, 0xc0c000
s_waitcnt vmcnt(12)
v_mfma_f32_16x16x32_bf16 v[140:143], a[116:119], a[4:7], v[140:143]
s_waitcnt vmcnt(10)
v_mfma_f32_16x16x32_bf16 v[164:167], a[116:119], a[12:15], v[164:167]
v_mfma_f32_16x16x32_bf16 v[164:167], a[112:115], a[8:11], v[164:167]
s_waitcnt vmcnt(9)
v_mfma_f32_16x16x32_bf16 v[188:191], a[112:115], a[16:19], v[188:191]
buffer_load_dwordx4 v1, s[4:7], s44 offen offset:0 sc1 lds
s_waitcnt vmcnt(9)
v_mfma_f32_16x16x32_bf16 v[188:191], a[116:119], a[20:23], v[188:191]
s_waitcnt vmcnt(7)
v_mfma_f32_16x16x32_bf16 v[212:215], a[116:119], a[28:31], v[212:215]
v_mfma_f32_16x16x32_bf16 v[212:215], a[112:115], a[24:27], v[212:215]
s_waitcnt lgkmcnt(0)
v_mfma_f32_16x16x32_bf16 v[216:219], a[128:131], a[24:27], v[216:219]
ds_read_b128 a[96:99], v5 offset:12288
v_cvt_pk_bf16_f32 v140, v140, v141
v_mfma_f32_16x16x32_bf16 v[216:219], a[132:135], a[28:31], v[216:219]
buffer_load_dwordx4 v1, s[4:7], s44 offen offset:1024 sc1 lds
v_mfma_f32_16x16x32_bf16 v[192:195], a[132:135], a[20:23], v[192:195]
ds_read_b128 a[100:103], v5 offset:18432
v_cvt_pk_bf16_f32 v141, v142, v143
v_mfma_f32_16x16x32_bf16 v[192:195], a[128:131], a[16:19], v[192:195]
v_cvt_pk_bf16_f32 v164, v164, v165
v_cvt_pk_bf16_f32 v165, v166, v167
v_mfma_f32_16x16x32_bf16 v[168:171], a[128:131], a[8:11], v[168:171]
v_cvt_pk_bf16_f32 v188, v188, v189
v_cvt_pk_bf16_f32 v189, v190, v191
v_mfma_f32_16x16x32_bf16 v[168:171], a[132:135], a[12:15], v[168:171]
buffer_load_dwordx4 v1, s[4:7], s44 offen offset:2048 sc1 lds
v_mfma_f32_16x16x32_bf16 v[144:147], a[132:135], a[4:7], v[144:147]
ds_read_b128 a[104:107], v5 offset:24576
v_cvt_pk_bf16_f32 v212, v212, v213
v_mfma_f32_16x16x32_bf16 v[144:147], a[128:131], a[0:3], v[144:147]
v_cvt_pk_bf16_f32 v213, v214, v215
v_mfma_f32_16x16x32_bf16 v[148:151], a[136:139], a[0:3], v[148:151]
ds_read_b128 a[108:111], v5 offset:30720
v_cvt_pk_bf16_f32 v214, v216, v217
v_mfma_f32_16x16x32_bf16 v[148:151], a[140:143], a[4:7], v[148:151]
v_cvt_pk_bf16_f32 v215, v218, v219
v_mfma_f32_16x16x32_bf16 v[172:175], a[140:143], a[12:15], v[172:175]
buffer_load_dwordx4 v1, s[4:7], s44 offen offset:3072 sc1 lds
s_add_u32 m0, s19, 147456
v_mfma_f32_16x16x32_bf16 v[172:175], a[136:139], a[8:11], v[172:175]
s_add_u32 s44, s87, 0xc1c000
ds_read_b128 a[112:115], v5 offset:36864
v_mfma_f32_16x16x32_bf16 v[196:199], a[136:139], a[16:19], v[196:199]
v_cvt_pk_bf16_f32 v166, v168, v169
v_cvt_pk_bf16_f32 v167, v170, v171
v_mfma_f32_16x16x32_bf16 v[196:199], a[140:143], a[20:23], v[196:199]
ds_read_b128 a[116:119], v5 offset:43008
v_cvt_pk_bf16_f32 v190, v192, v193
v_mfma_f32_16x16x32_bf16 v[220:223], a[140:143], a[28:31], v[220:223]
v_cvt_pk_bf16_f32 v142, v144, v145
v_cvt_pk_bf16_f32 v143, v146, v147
v_mfma_f32_16x16x32_bf16 v[220:223], a[136:139], a[24:27], v[220:223]
buffer_load_dwordx4 v1, s[4:7], s44 offen offset:0 sc1 lds
v_mfma_f32_16x16x32_bf16 v[224:227], a[144:147], a[24:27], v[224:227]
v_mfma_f32_16x16x32_bf16 v[92:95], a[240:243], v[140:143], 0
v_mfma_f32_16x16x32_bf16 v[224:227], a[148:151], a[28:31], v[224:227]
v_mfma_f32_16x16x32_bf16 v[96:99], a[244:247], v[140:143], 0
v_mfma_f32_16x16x32_bf16 v[200:203], a[148:151], a[20:23], v[200:203]
v_mfma_f32_16x16x32_bf16 v[100:103], a[240:243], v[164:167], 0
v_mfma_f32_16x16x32_bf16 v[200:203], a[144:147], a[16:19], v[200:203]
v_mfma_f32_16x16x32_bf16 v[104:107], a[244:247], v[164:167], 0
v_mfma_f32_16x16x32_bf16 v[176:179], a[144:147], a[8:11], v[176:179]
buffer_load_dwordx4 v1, s[4:7], s44 offen offset:1024 sc1 lds
v_mfma_f32_16x16x32_bf16 v[176:179], a[148:151], a[12:15], v[176:179]
v_max3_f32 v236, v92, v93, v94
v_max3_f32 v237, -v92, -v93, -v94
v_mfma_f32_16x16x32_bf16 v[152:155], a[148:151], a[4:7], v[152:155]
v_max3_f32 v236, v236, v95, v96
v_max3_f32 v237, v237, -v95, -v96
v_mfma_f32_16x16x32_bf16 v[152:155], a[144:147], a[0:3], v[152:155]
v_max3_f32 v236, v236, v97, v98
s_waitcnt lgkmcnt(0)
v_mfma_f32_16x16x32_bf16 v[132:135], a[96:99], a[32:35], v[132:135]
ds_read_b128 a[128:131], v5 offset:13312
v_max3_f32 v237, v237, -v97, -v98
v_mfma_f32_16x16x32_bf16 v[132:135], a[100:103], a[36:39], v[132:135]
buffer_load_dwordx4 v1, s[4:7], s44 offen offset:2048 sc1 lds
v_mfma_f32_16x16x32_bf16 v[156:159], a[100:103], a[44:47], v[156:159]
ds_read_b128 a[132:135], v5 offset:19456
v_max_f32 v236, v236, v99
v_mfma_f32_16x16x32_bf16 v[156:159], a[96:99], a[40:43], v[156:159]
v_max_f32_e64 v237, v237, -v99
v_max3_f32 v238, v100, v101, v102
v_mfma_f32_16x16x32_bf16 v[180:183], a[96:99], a[48:51], v[180:183]
v_permlane32_swap_b32 v236, v237
v_mfma_f32_16x16x32_bf16 v[180:183], a[100:103], a[52:55], v[180:183]
buffer_load_dwordx4 v1, s[4:7], s44 offen offset:3072 sc1 lds
s_add_u32 m0, s19, 98304
v_mfma_f32_16x16x32_bf16 v[204:207], a[100:103], a[60:63], v[204:207]
s_add_u32 s44, s84, 0xc10000
ds_read_b128 a[136:139], v5 offset:25600
v_mfma_f32_16x16x32_bf16 v[204:207], a[96:99], a[56:59], v[204:207]
v_max_f32 v236, v236, v237
v_mov_b32 v244, v236
v_mfma_f32_16x16x32_bf16 v[204:207], a[104:107], a[88:91], v[204:207]
ds_read_b128 a[140:143], v5 offset:31744
v_max3_f32 v239, -v100, -v101, -v102
v_mfma_f32_16x16x32_bf16 v[204:207], a[108:111], a[92:95], v[204:207]
v_permlane16_swap_b32 v236, v244
v_mfma_f32_16x16x32_bf16 v[180:183], a[108:111], a[84:87], v[180:183]
buffer_load_dwordx4 v1, s[4:7], s44 offen offset:0 sc1 lds
v_mfma_f32_16x16x32_bf16 v[180:183], a[104:107], a[80:83], v[180:183]
ds_read_b128 a[144:147], v5 offset:37888
v_max_f32 v236, v236, v244
v_mfma_f32_16x16x32_bf16 v[156:159], a[104:107], a[72:75], v[156:159]
v_mov_b32 v244, v236
v_max3_f32 v238, v238, v103, v104
v_mfma_f32_16x16x32_bf16 v[156:159], a[108:111], a[76:79], v[156:159]
ds_read_b128 a[148:151], v5 offset:44032
v_max3_f32 v239, v239, -v103, -v104
v_mfma_f32_16x16x32_bf16 v[132:135], a[108:111], a[68:71], v[132:135]
v_permlane32_swap_b32 v236, v244
v_mfma_f32_16x16x32_bf16 v[132:135], a[104:107], a[64:67], v[132:135]
buffer_load_dwordx4 v1, s[4:7], s44 offen offset:1024 sc1 lds
v_mfma_f32_16x16x32_bf16 v[132:135], a[112:115], a[0:3], v[132:135]
L_stub7:
s_cbranch_execz L_stub8
v_mul_f32_e64 v236, -v236, v82
v_mul_f32_e64 v237, -v244, v82
v_mfma_f32_16x16x32_bf16 v[132:135], a[116:119], a[4:7], v[132:135]
v_max3_f32 v238, v238, v105, v106
v_max3_f32 v239, v239, -v105, -v106
v_mfma_f32_16x16x32_bf16 v[156:159], a[116:119], a[12:15], v[156:159]
v_max_f32 v238, v238, v107
v_max_f32_e64 v239, v239, -v107
v_mfma_f32_16x16x32_bf16 v[156:159], a[112:115], a[8:11], v[156:159]
s_nop 0
v_permlane32_swap_b32 v238, v239
v_mfma_f32_16x16x32_bf16 v[180:183], a[112:115], a[16:19], v[180:183]
buffer_load_dwordx4 v1, s[4:7], s44 offen offset:2048 sc1 lds
v_mfma_f32_16x16x32_bf16 v[180:183], a[116:119], a[20:23], v[180:183]
v_max_f32 v238, v238, v239
v_mov_b32 v245, v238
v_mfma_f32_16x16x32_bf16 v[204:207], a[116:119], a[28:31], v[204:207]
s_nop 0
v_permlane16_swap_b32 v238, v245
v_mfma_f32_16x16x32_bf16 v[204:207], a[112:115], a[24:27], v[204:207]
s_waitcnt lgkmcnt(0)
s_barrier
v_mfma_f32_16x16x32_bf16 v[208:211], a[128:131], a[56:59], v[208:211]
v_max_f32 v238, v238, v245
v_mov_b32 v245, v238
v_mfma_f32_16x16x32_bf16 v[208:211], a[132:135], a[60:63], v[208:211]
buffer_load_dwordx4 v1, s[4:7], s44 offen offset:3072 sc1 lds
s_add_u32 m0, s19, 114688
v_mfma_f32_16x16x32_bf16 v[184:187], a[132:135], a[52:55], v[184:187]
s_add_u32 s44, s85, 0xc14000
v_cvt_pk_bf16_f32 v191, v194, v195
v_mfma_f32_16x16x32_bf16 v[184:187], a[128:131], a[48:51], v[184:187]
v_permlane32_swap_b32 v238, v245
v_mfma_f32_16x16x32_bf16 v[160:163], a[128:131], a[40:43], v[160:163]
v_mul_f32_e64 v238, -v238, v84
v_mul_f32_e64 v239, -v245, v84
v_mfma_f32_16x16x32_bf16 v[160:163], a[132:135], a[44:47], v[160:163]
buffer_load_dwordx4 v1, s[4:7], s44 offen offset:0 sc1 lds
v_mfma_f32_16x16x32_bf16 v[136:139], a[132:135], a[36:39], v[136:139]
v_mfma_f32_16x16x32_bf16 v[108:111], a[240:243], v[188:191], 0
v_mfma_f32_16x16x32_bf16 v[136:139], a[128:131], a[32:35], v[136:139]
v_mfma_f32_16x16x32_bf16 v[112:115], a[244:247], v[188:191], 0
v_mfma_f32_16x16x32_bf16 v[136:139], a[136:139], a[64:67], v[136:139]
v_mfma_f32_16x16x32_bf16 v[116:119], a[240:243], v[212:215], 0
v_mfma_f32_16x16x32_bf16 v[136:139], a[140:143], a[68:71], v[136:139]
v_mfma_f32_16x16x32_bf16 v[120:123], a[244:247], v[212:215], 0
v_mfma_f32_16x16x32_bf16 v[160:163], a[140:143], a[76:79], v[160:163]
buffer_load_dwordx4 v1, s[4:7], s44 offen offset:1024 sc1 lds
v_mfma_f32_16x16x32_bf16 v[160:163], a[136:139], a[72:75], v[160:163]
v_max3_f32 v240, v108, v109, v110
v_max3_f32 v241, -v108, -v109, -v110
v_mfma_f32_16x16x32_bf16 v[184:187], a[136:139], a[80:83], v[184:187]
v_max3_f32 v240, v240, v111, v112
v_max3_f32 v241, v241, -v111, -v112
v_mfma_f32_16x16x32_bf16 v[184:187], a[140:143], a[84:87], v[184:187]
v_max3_f32 v240, v240, v113, v114
v_max3_f32 v241, v241, -v113, -v114
v_mfma_f32_16x16x32_bf16 v[208:211], a[140:143], a[92:95], v[208:211]
v_max_f32 v240, v240, v115
v_max_f32_e64 v241, v241, -v115
v_mfma_f32_16x16x32_bf16 v[208:211], a[136:139], a[88:91], v[208:211]
buffer_load_dwordx4 v1, s[4:7], s44 offen offset:2048 sc1 lds
v_mfma_f32_16x16x32_bf16 v[208:211], a[144:147], a[24:27], v[208:211]
v_permlane32_swap_b32 v240, v241
v_mfma_f32_16x16x32_bf16 v[208:211], a[148:151], a[28:31], v[208:211]
v_max_f32 v240, v240, v241
v_mov_b32 v246, v240
v_mfma_f32_16x16x32_bf16 v[184:187], a[148:151], a[20:23], v[184:187]
s_nop 0
v_permlane16_swap_b32 v240, v246
v_mfma_f32_16x16x32_bf16 v[184:187], a[144:147], a[16:19], v[184:187]
v_max_f32 v240, v240, v246
v_mov_b32 v246, v240
v_mfma_f32_16x16x32_bf16 v[160:163], a[144:147], a[8:11], v[160:163]
buffer_load_dwordx4 v1, s[4:7], s44 offen offset:3072 sc1 lds
v_mfma_f32_16x16x32_bf16 v[160:163], a[148:151], a[12:15], v[160:163]
v_permlane32_swap_b32 v240, v246
v_mfma_f32_16x16x32_bf16 v[136:139], a[148:151], a[4:7], v[136:139]
v_mul_f32_e64 v240, -v240, v86
v_mul_f32_e64 v241, -v246, v86
v_mfma_f32_16x16x32_bf16 v[136:139], a[144:147], a[0:3], v[136:139]
v_max3_f32 v242, v116, v117, v118
v_max3_f32 v243, -v116, -v117, -v118
v_pk_mul_f32 v[148:149], v[148:149], v[82:83] op_sel:[0,1] op_sel_hi:[1,1]
v_pk_mul_f32 v[150:151], v[150:151], v[82:83] op_sel:[0,1] op_sel_hi:[1,1]
v_cvt_pk_bf16_f32 v148, v148, v149
v_cvt_pk_bf16_f32 v149, v150, v151
ds_write_b64 v232, v[148:149] offset:0
v_pk_mul_f32 v[152:153], v[152:153], v[82:83] op_sel:[0,1] op_sel_hi:[1,1]
v_pk_mul_f32 v[154:155], v[154:155], v[82:83] op_sel:[0,1] op_sel_hi:[1,1]
v_cvt_pk_bf16_f32 v150, v152, v153
v_cvt_pk_bf16_f32 v151, v154, v155
v_pk_mul_f32 v[172:173], v[172:173], v[84:85] op_sel:[0,1] op_sel_hi:[1,1]
v_pk_mul_f32 v[174:175], v[174:175], v[84:85] op_sel:[0,1] op_sel_hi:[1,1]
v_cvt_pk_bf16_f32 v172, v172, v173
v_cvt_pk_bf16_f32 v173, v174, v175
v_pk_mul_f32 v[176:177], v[176:177], v[84:85] op_sel:[0,1] op_sel_hi:[1,1]
v_pk_mul_f32 v[178:179], v[178:179], v[84:85] op_sel:[0,1] op_sel_hi:[1,1]
v_cvt_pk_bf16_f32 v174, v176, v177
v_cvt_pk_bf16_f32 v175, v178, v179
ds_write_b64 v232, v[150:151] offset:512
v_pk_mul_f32 v[196:197], v[196:197], v[86:87] op_sel:[0,1] op_sel_hi:[1,1]
v_pk_mul_f32 v[198:199], v[198:199], v[86:87] op_sel:[0,1] op_sel_hi:[1,1]
v_cvt_pk_bf16_f32 v196, v196, v197
v_cvt_pk_bf16_f32 v197, v198, v199
buffer_store_dwordx4 a[248:251], v254, s[4:7], s97 offen offset:0 sc1
v_pk_mul_f32 v[200:201], v[200:201], v[86:87] op_sel:[0,1] op_sel_hi:[1,1]
v_pk_mul_f32 v[202:203], v[202:203], v[86:87] op_sel:[0,1] op_sel_hi:[1,1]
v_cvt_pk_bf16_f32 v198, v200, v201
v_cvt_pk_bf16_f32 v199, v202, v203
ds_write_b64 v232, v[172:173] offset:1024
v_pk_mul_f32 v[220:221], v[220:221], v[88:89] op_sel:[0,1] op_sel_hi:[1,1]
v_pk_mul_f32 v[222:223], v[222:223], v[88:89] op_sel:[0,1] op_sel_hi:[1,1]
v_cvt_pk_bf16_f32 v220, v220, v221
v_cvt_pk_bf16_f32 v221, v222, v223
v_pk_fma_f32 v[48:49], v[92:93], v[82:83], v[236:237] op_sel:[0,0,0] op_sel_hi:[1,0,0]
v_pk_fma_f32 v[50:51], v[94:95], v[82:83], v[236:237] op_sel:[0,0,0] op_sel_hi:[1,0,0]
v_pk_fma_f32 v[52:53], v[96:97], v[82:83], v[236:237] op_sel:[0,0,0] op_sel_hi:[1,0,0]
v_pk_fma_f32 v[54:55], v[98:99], v[82:83], v[236:237] op_sel:[0,0,0] op_sel_hi:[1,0,0]
v_exp_f32 v48, v48
v_exp_f32 v49, v49
ds_write_b64 v232, v[174:175] offset:1536
v_exp_f32 v50, v50
v_exp_f32 v51, v51
v_exp_f32 v52, v52
v_exp_f32 v53, v53
v_exp_f32 v54, v54
v_exp_f32 v55, v55
ds_write_b64 v232, v[196:197] offset:2048
buffer_store_dwordx4 a[248:251], v1, s[4:7], s96 offen offset:0 sc1
v_cvt_pk_bf16_f32 v140, v48, v49
v_cvt_pk_bf16_f32 v141, v50, v51
v_cvt_pk_bf16_f32 v142, v52, v53
v_cvt_pk_bf16_f32 v143, v54, v55
v_pk_mul_f32 v[224:225], v[224:225], v[88:89] op_sel:[0,1] op_sel_hi:[1,1]
v_pk_mul_f32 v[226:227], v[226:227], v[88:89] op_sel:[0,1] op_sel_hi:[1,1]
v_cvt_pk_bf16_f32 v222, v224, v225
v_mfma_f32_16x16x32_bf16 v[148:151], v[16:19], v[140:143], 0
ds_write_b64 v232, v[198:199] offset:2560
v_cvt_pk_bf16_f32 v223, v226, v227
s_add_u32 m0, s19, 131072
v_pk_fma_f32 v[92:93], v[92:93], v[82:83], v[236:237] op_sel:[0,0,1] op_sel_hi:[1,0,1] neg_lo:[1,0,0] neg_hi:[1,0,0]
v_pk_fma_f32 v[94:95], v[94:95], v[82:83], v[236:237] op_sel:[0,0,1] op_sel_hi:[1,0,1] neg_lo:[1,0,0] neg_hi:[1,0,0]
v_pk_fma_f32 v[96:97], v[96:97], v[82:83], v[236:237] op_sel:[0,0,1] op_sel_hi:[1,0,1] neg_lo:[1,0,0] neg_hi:[1,0,0]
s_nop 1
v_rcp_f32 v148, v148
v_pk_fma_f32 v[98:99], v[98:99], v[82:83], v[236:237] op_sel:[0,0,1] op_sel_hi:[1,0,1] neg_lo:[1,0,0] neg_hi:[1,0,0]
v_pk_mul_f32 v[48:49], v[48:49], v[148:149] op_sel:[0,0] op_sel_hi:[1,0]
v_pk_mul_f32 v[50:51], v[50:51], v[148:149] op_sel:[0,0] op_sel_hi:[1,0]
v_cvt_pk_bf16_f32 v140, v48, v49
v_cvt_pk_bf16_f32 v141, v50, v51
ds_write_b64 v232, v[220:221] offset:3072
v_exp_f32 v92, v92
v_exp_f32 v93, v93
v_exp_f32 v94, v94
v_exp_f32 v95, v95
v_exp_f32 v96, v96
v_exp_f32 v97, v97
ds_write_b64 v232, v[222:223] offset:3584
v_exp_f32 v98, v98
v_exp_f32 v99, v99
s_add_u32 s44, s86, 0xc18000
v_cvt_pk_bf16_f32 v144, v92, v93
v_cvt_pk_bf16_f32 v145, v94, v95
v_cvt_pk_bf16_f32 v146, v96, v97
v_cvt_pk_bf16_f32 v147, v98, v99
buffer_load_dwordx4 v1, s[4:7], s44 offen offset:0 sc1 lds
v_pk_mul_f32 v[52:53], v[52:53], v[148:149] op_sel:[0,0] op_sel_hi:[1,0]
ds_write_b64 v233, v[140:141] offset:16384
v_pk_mul_f32 v[54:55], v[54:55], v[148:149] op_sel:[0,0] op_sel_hi:[1,0]
v_cvt_pk_bf16_f32 v142, v52, v53
v_mfma_f32_16x16x32_bf16 v[152:155], v[16:19], v[144:147], 0
v_cvt_pk_bf16_f32 v143, v54, v55
v_max3_f32 v242, v242, v119, v120
v_max3_f32 v243, v243, -v119, -v120
v_max3_f32 v242, v242, v121, v122
v_max3_f32 v243, v243, -v121, -v122
v_pk_fma_f32 v[56:57], v[100:101], v[84:85], v[238:239] op_sel:[0,0,0] op_sel_hi:[1,0,0]
v_pk_fma_f32 v[58:59], v[102:103], v[84:85], v[238:239] op_sel:[0,0,0] op_sel_hi:[1,0,0]
v_pk_fma_f32 v[60:61], v[104:105], v[84:85], v[238:239] op_sel:[0,0,0] op_sel_hi:[1,0,0]
ds_write_b64 v233, v[142:143] offset:16896
v_rcp_f32 v152, v152
v_pk_fma_f32 v[62:63], v[106:107], v[84:85], v[238:239] op_sel:[0,0,0] op_sel_hi:[1,0,0]
v_pk_mul_f32 v[92:93], v[92:93], v[152:153] op_sel:[0,0] op_sel_hi:[1,0]
v_pk_mul_f32 v[94:95], v[94:95], v[152:153] op_sel:[0,0] op_sel_hi:[1,0]
v_cvt_pk_bf16_f32 v144, v92, v93
v_cvt_pk_bf16_f32 v145, v94, v95
v_exp_f32 v56, v56
v_exp_f32 v57, v57
v_exp_f32 v58, v58
ds_write_b64 v233, v[144:145] offset:17408
v_exp_f32 v59, v59
v_exp_f32 v60, v60
v_exp_f32 v61, v61
v_exp_f32 v62, v62
v_exp_f32 v63, v63
buffer_load_dwordx4 v1, s[4:7], s44 offen offset:1024 sc1 lds
v_cvt_pk_bf16_f32 v164, v56, v57
v_cvt_pk_bf16_f32 v165, v58, v59
v_cvt_pk_bf16_f32 v166, v60, v61
v_cvt_pk_bf16_f32 v167, v62, v63
v_pk_mul_f32 v[96:97], v[96:97], v[152:153] op_sel:[0,0] op_sel_hi:[1,0]
v_pk_mul_f32 v[98:99], v[98:99], v[152:153] op_sel:[0,0] op_sel_hi:[1,0]
v_cvt_pk_bf16_f32 v146, v96, v97
v_mfma_f32_16x16x32_bf16 v[172:175], v[16:19], v[164:167], 0
v_cvt_pk_bf16_f32 v147, v98, v99
ds_write_b64 v233, v[146:147] offset:17920
v_max_f32 v242, v242, v123
v_pk_fma_f32 v[100:101], v[100:101], v[84:85], v[238:239] op_sel:[0,0,1] op_sel_hi:[1,0,1] neg_lo:[1,0,0] neg_hi:[1,0,0]
v_pk_fma_f32 v[102:103], v[102:103], v[84:85], v[238:239] op_sel:[0,0,1] op_sel_hi:[1,0,1] neg_lo:[1,0,0] neg_hi:[1,0,0]
v_pk_fma_f32 v[104:105], v[104:105], v[84:85], v[238:239] op_sel:[0,0,1] op_sel_hi:[1,0,1] neg_lo:[1,0,0] neg_hi:[1,0,0]
s_nop 1
v_rcp_f32 v172, v172
v_pk_fma_f32 v[106:107], v[106:107], v[84:85], v[238:239] op_sel:[0,0,1] op_sel_hi:[1,0,1] neg_lo:[1,0,0] neg_hi:[1,0,0]
v_pk_mul_f32 v[56:57], v[56:57], v[172:173] op_sel:[0,0] op_sel_hi:[1,0]
v_pk_mul_f32 v[58:59], v[58:59], v[172:173] op_sel:[0,0] op_sel_hi:[1,0]
v_cvt_pk_bf16_f32 v164, v56, v57
v_cvt_pk_bf16_f32 v165, v58, v59
v_exp_f32 v100, v100
ds_write_b64 v233, v[164:165] offset:18432
v_exp_f32 v101, v101
v_exp_f32 v102, v102
v_exp_f32 v103, v103
v_exp_f32 v104, v104
v_exp_f32 v105, v105
v_exp_f32 v106, v106
v_exp_f32 v107, v107
buffer_load_dwordx4 v1, s[4:7], s44 offen offset:2048 sc1 lds
v_cvt_pk_bf16_f32 v168, v100, v101
v_cvt_pk_bf16_f32 v169, v102, v103
v_cvt_pk_bf16_f32 v170, v104, v105
v_cvt_pk_bf16_f32 v171, v106, v107
v_pk_mul_f32 v[60:61], v[60:61], v[172:173] op_sel:[0,0] op_sel_hi:[1,0]
v_pk_mul_f32 v[62:63], v[62:63], v[172:173] op_sel:[0,0] op_sel_hi:[1,0]
v_cvt_pk_bf16_f32 v166, v60, v61
v_mfma_f32_16x16x32_bf16 v[176:179], v[16:19], v[168:171], 0
v_cvt_pk_bf16_f32 v167, v62, v63
ds_write_b64 v233, v[166:167] offset:18944
v_max_f32_e64 v243, v243, -v123
v_pk_fma_f32 v[64:65], v[108:109], v[86:87], v[240:241] op_sel:[0,0,0] op_sel_hi:[1,0,0]
v_pk_fma_f32 v[66:67], v[110:111], v[86:87], v[240:241] op_sel:[0,0,0] op_sel_hi:[1,0,0]
v_pk_fma_f32 v[68:69], v[112:113], v[86:87], v[240:241] op_sel:[0,0,0] op_sel_hi:[1,0,0]
s_nop 1
v_rcp_f32 v176, v176
v_pk_fma_f32 v[70:71], v[114:115], v[86:87], v[240:241] op_sel:[0,0,0] op_sel_hi:[1,0,0]
v_pk_mul_f32 v[100:101], v[100:101], v[176:177] op_sel:[0,0] op_sel_hi:[1,0]
v_pk_mul_f32 v[102:103], v[102:103], v[176:177] op_sel:[0,0] op_sel_hi:[1,0]
v_cvt_pk_bf16_f32 v168, v100, v101
v_cvt_pk_bf16_f32 v169, v102, v103
v_exp_f32 v64, v64
ds_write_b64 v233, v[168:169] offset:19456
buffer_load_dwordx4 v1, s[4:7], s44 offen offset:3072 sc1 lds
v_exp_f32 v65, v65
v_exp_f32 v66, v66
v_exp_f32 v67, v67
v_exp_f32 v68, v68
v_exp_f32 v69, v69
v_exp_f32 v70, v70
v_exp_f32 v71, v71
v_cvt_pk_bf16_f32 v188, v64, v65
v_cvt_pk_bf16_f32 v189, v66, v67
v_cvt_pk_bf16_f32 v190, v68, v69
v_cvt_pk_bf16_f32 v191, v70, v71
v_pk_mul_f32 v[104:105], v[104:105], v[176:177] op_sel:[0,0] op_sel_hi:[1,0]
v_pk_mul_f32 v[106:107], v[106:107], v[176:177] op_sel:[0,0] op_sel_hi:[1,0]
v_cvt_pk_bf16_f32 v170, v104, v105
v_mfma_f32_16x16x32_bf16 v[196:199], v[16:19], v[188:191], 0
v_cvt_pk_bf16_f32 v171, v106, v107
ds_write_b64 v233, v[170:171] offset:19968
buffer_store_dwordx4 a[248:251], v2, s[4:7], s72 offen offset:0 sc1
s_nop 4
v_rcp_f32 v196, v196
v_pk_fma_f32 v[108:109], v[108:109], v[86:87], v[240:241] op_sel:[0,0,1] op_sel_hi:[1,0,1] neg_lo:[1,0,0] neg_hi:[1,0,0]
v_pk_mul_f32 v[64:65], v[64:65], v[196:197] op_sel:[0,0] op_sel_hi:[1,0]
v_pk_mul_f32 v[66:67], v[66:67], v[196:197] op_sel:[0,0] op_sel_hi:[1,0]
v_cvt_pk_bf16_f32 v188, v64, v65
v_cvt_pk_bf16_f32 v189, v66, v67
v_pk_fma_f32 v[110:111], v[110:111], v[86:87], v[240:241] op_sel:[0,0,1] op_sel_hi:[1,0,1] neg_lo:[1,0,0] neg_hi:[1,0,0]
ds_write_b64 v233, v[188:189] offset:20480
v_pk_fma_f32 v[112:113], v[112:113], v[86:87], v[240:241] op_sel:[0,0,1] op_sel_hi:[1,0,1] neg_lo:[1,0,0] neg_hi:[1,0,0]
v_pk_fma_f32 v[114:115], v[114:115], v[86:87], v[240:241] op_sel:[0,0,1] op_sel_hi:[1,0,1] neg_lo:[1,0,0] neg_hi:[1,0,0]
v_exp_f32 v108, v108
v_exp_f32 v109, v109
v_exp_f32 v110, v110
v_exp_f32 v111, v111
v_exp_f32 v112, v112
v_exp_f32 v113, v113
v_exp_f32 v114, v114
v_exp_f32 v115, v115
v_cvt_pk_bf16_f32 v192, v108, v109
v_cvt_pk_bf16_f32 v193, v110, v111
v_cvt_pk_bf16_f32 v194, v112, v113
v_cvt_pk_bf16_f32 v195, v114, v115
v_pk_mul_f32 v[68:69], v[68:69], v[196:197] op_sel:[0,0] op_sel_hi:[1,0]
v_pk_mul_f32 v[70:71], v[70:71], v[196:197] op_sel:[0,0] op_sel_hi:[1,0]
v_permlane32_swap_b32 v242, v243
v_mfma_f32_16x16x32_bf16 v[200:203], v[16:19], v[192:195], 0
v_cvt_pk_bf16_f32 v190, v68, v69
v_cvt_pk_bf16_f32 v191, v70, v71
ds_write_b64 v233, v[190:191] offset:20992
v_max_f32 v242, v242, v243
v_mov_b32 v247, v242
buffer_store_dwordx4 a[248:251], v2, s[4:7], s72 offen offset:1024 sc1
s_nop 0
v_permlane16_swap_b32 v242, v247
v_rcp_f32 v200, v200
v_max_f32 v242, v242, v247
v_mov_b32 v247, v242
v_pk_mul_f32 v[108:109], v[108:109], v[200:201] op_sel:[0,0] op_sel_hi:[1,0]
v_pk_mul_f32 v[110:111], v[110:111], v[200:201] op_sel:[0,0] op_sel_hi:[1,0]
v_cvt_pk_bf16_f32 v192, v108, v109
v_cvt_pk_bf16_f32 v193, v110, v111
v_permlane32_swap_b32 v242, v247
ds_write_b64 v233, v[192:193] offset:21504
v_mul_f32_e64 v242, -v242, v88
v_mul_f32_e64 v243, -v247, v88
v_pk_fma_f32 v[124:125], v[116:117], v[88:89], v[242:243] op_sel:[0,0,0] op_sel_hi:[1,0,0]
v_pk_fma_f32 v[126:127], v[118:119], v[88:89], v[242:243] op_sel:[0,0,0] op_sel_hi:[1,0,0]
v_pk_fma_f32 v[128:129], v[120:121], v[88:89], v[242:243] op_sel:[0,0,0] op_sel_hi:[1,0,0]
v_pk_fma_f32 v[130:131], v[122:123], v[88:89], v[242:243] op_sel:[0,0,0] op_sel_hi:[1,0,0]
v_exp_f32 v124, v124
v_exp_f32 v125, v125
v_exp_f32 v126, v126
v_exp_f32 v127, v127
v_exp_f32 v128, v128
v_exp_f32 v129, v129
v_exp_f32 v130, v130
v_exp_f32 v131, v131
v_cvt_pk_bf16_f32 v212, v124, v125
v_cvt_pk_bf16_f32 v213, v126, v127
v_cvt_pk_bf16_f32 v214, v128, v129
v_cvt_pk_bf16_f32 v215, v130, v131
v_pk_mul_f32 v[112:113], v[112:113], v[200:201] op_sel:[0,0] op_sel_hi:[1,0]
v_pk_mul_f32 v[114:115], v[114:115], v[200:201] op_sel:[0,0] op_sel_hi:[1,0]
v_cvt_pk_bf16_f32 v194, v112, v113
v_mfma_f32_16x16x32_bf16 v[220:223], v[16:19], v[212:215], 0
v_cvt_pk_bf16_f32 v195, v114, v115
ds_write_b64 v233, v[194:195] offset:22016
buffer_store_dwordx4 a[248:251], v2, s[4:7], s72 offen offset:2048 sc1
s_nop 4
v_rcp_f32 v220, v220
v_pk_fma_f32 v[116:117], v[116:117], v[88:89], v[242:243] op_sel:[0,0,1] op_sel_hi:[1,0,1] neg_lo:[1,0,0] neg_hi:[1,0,0]
v_pk_mul_f32 v[124:125], v[124:125], v[220:221] op_sel:[0,0] op_sel_hi:[1,0]
v_pk_mul_f32 v[126:127], v[126:127], v[220:221] op_sel:[0,0] op_sel_hi:[1,0]
v_cvt_pk_bf16_f32 v212, v124, v125
v_cvt_pk_bf16_f32 v213, v126, v127
v_pk_fma_f32 v[118:119], v[118:119], v[88:89], v[242:243] op_sel:[0,0,1] op_sel_hi:[1,0,1] neg_lo:[1,0,0] neg_hi:[1,0,0]
ds_write_b64 v233, v[212:213] offset:22528
v_pk_fma_f32 v[120:121], v[120:121], v[88:89], v[242:243] op_sel:[0,0,1] op_sel_hi:[1,0,1] neg_lo:[1,0,0] neg_hi:[1,0,0]
v_pk_fma_f32 v[122:123], v[122:123], v[88:89], v[242:243] op_sel:[0,0,1] op_sel_hi:[1,0,1] neg_lo:[1,0,0] neg_hi:[1,0,0]
v_exp_f32 v116, v116
v_exp_f32 v117, v117
v_exp_f32 v118, v118
v_exp_f32 v119, v119
v_exp_f32 v120, v120
v_exp_f32 v121, v121
v_exp_f32 v122, v122
v_exp_f32 v123, v123
v_cvt_pk_bf16_f32 v216, v116, v117
v_cvt_pk_bf16_f32 v217, v118, v119
v_cvt_pk_bf16_f32 v218, v120, v121
v_cvt_pk_bf16_f32 v219, v122, v123
v_pk_mul_f32 v[128:129], v[128:129], v[220:221] op_sel:[0,0] op_sel_hi:[1,0]
v_pk_mul_f32 v[130:131], v[130:131], v[220:221] op_sel:[0,0] op_sel_hi:[1,0]
v_cvt_pk_bf16_f32 v214, v128, v129
v_mfma_f32_16x16x32_bf16 v[224:227], v[16:19], v[216:219], 0
v_cvt_pk_bf16_f32 v215, v130, v131
ds_write_b64 v233, v[214:215] offset:23040
buffer_store_dwordx4 a[248:251], v2, s[4:7], s72 offen offset:3072 sc1
s_nop 4
v_rcp_f32 v224, v224
s_nop 0
v_pk_mul_f32 v[116:117], v[116:117], v[224:225] op_sel:[0,0] op_sel_hi:[1,0]
v_pk_mul_f32 v[118:119], v[118:119], v[224:225] op_sel:[0,0] op_sel_hi:[1,0]
v_cvt_pk_bf16_f32 v216, v116, v117
v_cvt_pk_bf16_f32 v217, v118, v119
v_pk_mul_f32 v[120:121], v[120:121], v[224:225] op_sel:[0,0] op_sel_hi:[1,0]
ds_write_b64 v233, v[216:217] offset:23552
v_pk_mul_f32 v[122:123], v[122:123], v[224:225] op_sel:[0,0] op_sel_hi:[1,0]
v_cvt_pk_bf16_f32 v218, v120, v121
v_cvt_pk_bf16_f32 v219, v122, v123
ds_write_b64 v233, v[218:219] offset:24064
s_waitcnt vmcnt(8)
s_waitcnt lgkmcnt(0)
s_barrier
ds_read_b64_tr_b16 a[0:1], v234 offset:16384
ds_read_b64_tr_b16 a[2:3], v234 offset:18432
ds_read_b64_tr_b16 a[12:13], v234 offset:20480
ds_read_b64_tr_b16 a[14:15], v234 offset:22528
ds_read_b64_tr_b16 a[24:25], v234 offset:24576
ds_read_b64_tr_b16 a[26:27], v234 offset:26624
ds_read_b64_tr_b16 a[4:5], v8 offset:0
ds_read_b64_tr_b16 a[6:7], v8 offset:1024
ds_read_b64_tr_b16 a[8:9], v8 offset:512
ds_read_b64_tr_b16 a[10:11], v8 offset:1536
ds_read_b64_tr_b16 a[36:37], v234 offset:28672
ds_read_b64_tr_b16 a[38:39], v234 offset:30720
ds_read_b64_tr_b16 a[16:17], v8 offset:2048
ds_read_b64_tr_b16 a[18:19], v8 offset:3072
ds_read_b64_tr_b16 a[20:21], v8 offset:2560
ds_read_b64_tr_b16 a[22:23], v8 offset:3584
ds_read_b64_tr_b16 a[48:49], v234 offset:32768
ds_read_b64_tr_b16 a[50:51], v234 offset:34816
ds_read_b64_tr_b16 a[28:29], v8 offset:4096
ds_read_b64_tr_b16 a[30:31], v8 offset:5120
ds_read_b64_tr_b16 a[32:33], v8 offset:4608
ds_read_b64_tr_b16 a[34:35], v8 offset:5632
ds_read_b64_tr_b16 a[60:61], v234 offset:36864
ds_read_b64_tr_b16 a[62:63], v234 offset:38912
s_waitcnt lgkmcnt(14)
v_mfma_f32_16x16x32_bf16 v[100:103], a[0:3], v[16:19], 0
ds_read_b64_tr_b16 a[40:41], v8 offset:6144
ds_read_b64_tr_b16 a[42:43], v8 offset:7168
ds_read_b64_tr_b16 a[44:45], v8 offset:6656
ds_read_b64_tr_b16 a[46:47], v8 offset:7680
ds_read_b64_tr_b16 a[72:73], v234 offset:40960
ds_read_b64_tr_b16 a[74:75], v234 offset:43008
v_mfma_f32_16x16x32_bf16 v[100:103], a[12:15], v[16:19], v[100:103]
buffer_atomic_add v12, v235, s[4:7], s94 offen sc1
ds_read_b64_tr_b16 a[52:53], v8 offset:8192
ds_read_b64_tr_b16 a[54:55], v8 offset:9216
ds_read_b64_tr_b16 a[56:57], v8 offset:8704
ds_read_b64_tr_b16 a[58:59], v8 offset:9728
ds_read_b64_tr_b16 a[84:85], v234 offset:45056
ds_read_b64_tr_b16 a[86:87], v234 offset:47104
v_mfma_f32_16x16x32_bf16 v[100:103], a[24:27], v[16:19], v[100:103]
ds_read_b64_tr_b16 a[64:65], v8 offset:10240
ds_read_b64_tr_b16 a[66:67], v8 offset:11264
v_mfma_f32_16x16x32_bf16 v[92:95], a[0:3], a[4:7], 0
ds_read_b64_tr_b16 a[68:69], v8 offset:10752
ds_read_b64_tr_b16 a[70:71], v8 offset:11776
v_mfma_f32_16x16x32_bf16 v[96:99], a[0:3], a[8:11], 0
ds_read_b64_tr_b16 a[76:77], v8 offset:12288
s_waitcnt lgkmcnt(14)
v_mfma_f32_16x16x32_bf16 v[100:103], a[36:39], v[16:19], v[100:103]
ds_read_b64_tr_b16 a[78:79], v8 offset:13312
v_mfma_f32_16x16x32_bf16 v[92:95], a[12:15], a[16:19], v[92:95]
ds_read_b64_tr_b16 a[80:81], v8 offset:12800
ds_read_b64_tr_b16 a[82:83], v8 offset:13824
v_mfma_f32_16x16x32_bf16 v[96:99], a[12:15], a[20:23], v[96:99]
ds_read_b64_tr_b16 a[88:89], v8 offset:14336
v_mfma_f32_16x16x32_bf16 v[100:103], a[48:51], v[16:19], v[100:103]
ds_read_b64_tr_b16 a[90:91], v8 offset:15360
v_mfma_f32_16x16x32_bf16 v[92:95], a[24:27], a[28:31], v[92:95]
ds_read_b64_tr_b16 a[92:93], v8 offset:14848
ds_read_b64_tr_b16 a[94:95], v8 offset:15872
v_mfma_f32_16x16x32_bf16 v[96:99], a[24:27], a[32:35], v[96:99]
v_cvt_pk_bf16_f32 v132, v132, v133
v_cvt_pk_bf16_f32 v156, v156, v157
v_mfma_f32_16x16x32_bf16 v[100:103], a[60:63], v[16:19], v[100:103]
v_cvt_pk_bf16_f32 v180, v180, v181
v_cvt_pk_bf16_f32 v204, v204, v205
v_mfma_f32_16x16x32_bf16 v[92:95], a[36:39], a[40:43], v[92:95]
v_cvt_pk_bf16_f32 v133, v134, v135
v_cvt_pk_bf16_f32 v157, v158, v159
s_waitcnt lgkmcnt(14)
v_mfma_f32_16x16x32_bf16 v[96:99], a[36:39], a[44:47], v[96:99]
v_cvt_pk_bf16_f32 v181, v182, v183
v_cvt_pk_bf16_f32 v205, v206, v207
v_mfma_f32_16x16x32_bf16 v[100:103], a[72:75], v[16:19], v[100:103]
v_cvt_pk_bf16_f32 v134, v136, v137
v_cvt_pk_bf16_f32 v135, v138, v139
v_mfma_f32_16x16x32_bf16 v[92:95], a[48:51], a[52:55], v[92:95]
v_cvt_pk_bf16_f32 v158, v160, v161
v_cvt_pk_bf16_f32 v159, v162, v163
v_mfma_f32_16x16x32_bf16 v[96:99], a[48:51], a[56:59], v[96:99]
v_cvt_pk_bf16_f32 v182, v184, v185
v_cvt_pk_bf16_f32 v183, v186, v187
s_waitcnt lgkmcnt(12)
v_mfma_f32_16x16x32_bf16 v[100:103], a[84:87], v[16:19], v[100:103]
v_cvt_pk_bf16_f32 v206, v208, v209
v_cvt_pk_bf16_f32 v207, v210, v211
s_waitcnt lgkmcnt(10)
v_mfma_f32_16x16x32_bf16 v[92:95], a[60:63], a[64:67], v[92:95]
s_waitcnt lgkmcnt(8)
v_mfma_f32_16x16x32_bf16 v[96:99], a[60:63], a[68:71], v[96:99]
s_nop 1
v_min_u32 v100, -2, v100
v_min_u32 v101, -2, v101
s_waitcnt lgkmcnt(6)
v_mfma_f32_16x16x32_bf16 v[92:95], a[72:75], a[76:79], v[92:95]
v_min_u32 v102, -2, v102
v_min_u32 v103, -2, v103
s_waitcnt lgkmcnt(4)
v_mfma_f32_16x16x32_bf16 v[96:99], a[72:75], a[80:83], v[96:99]
buffer_store_dwordx4 v[100:103], v254, s[4:7], s97 offen sc1
s_waitcnt lgkmcnt(2)
v_mfma_f32_16x16x32_bf16 v[92:95], a[84:87], a[88:91], v[92:95]
s_waitcnt lgkmcnt(0)
v_mfma_f32_16x16x32_bf16 v[96:99], a[84:87], a[92:95], v[96:99]
s_nop 5
v_cvt_pk_bf16_f32 v92, v92, v93
v_cvt_pk_bf16_f32 v93, v94, v95
v_min_u32 v92, -2, v92
v_min_u32 v93, -2, v93
v_cvt_pk_bf16_f32 v94, v96, v97
v_cvt_pk_bf16_f32 v95, v98, v99
v_min_u32 v94, -2, v94
v_min_u32 v95, -2, v95
buffer_store_dwordx4 v[92:95], v1, s[4:7], s96 offen sc1
s_barrier
s_add_u32 m0, s19, 32768
s_add_u32 s44, s84, 0xc00000
buffer_load_dwordx4 v1, s[4:7], s44 offen offset:0 sc1 lds
v_mfma_f32_16x16x32_bf16 v[108:111], a[240:243], v[132:135], 0
v_mfma_f32_16x16x32_bf16 v[172:175], a[240:243], v[156:159], 0
v_mfma_f32_16x16x32_bf16 v[112:115], a[244:247], v[132:135], 0
s_nop 5
v_max3_f32 v236, v108, v109, v110
v_max3_f32 v237, -v108, -v109, -v110
v_mfma_f32_16x16x32_bf16 v[176:179], a[244:247], v[156:159], 0
v_max3_f32 v238, v172, v173, v174
v_max3_f32 v239, -v172, -v173, -v174
v_max3_f32 v236, v236, v111, v112
v_max3_f32 v237, v237, -v111, -v112
v_max3_f32 v236, v236, v113, v114
v_max3_f32 v237, v237, -v113, -v114
s_nop 1
v_max3_f32 v238, v238, v175, v176
v_max3_f32 v239, v239, -v175, -v176
v_max3_f32 v238, v238, v177, v178
v_max3_f32 v239, v239, -v177, -v178
v_max_f32 v236, v236, v115
buffer_load_dwordx4 v1, s[4:7], s44 offen offset:1024 sc1 lds
v_max_f32_e64 v237, v237, -v115
v_max_f32 v238, v238, v179
v_max_f32_e64 v239, v239, -v179
v_permlane32_swap_b32 v236, v237
s_nop 0
v_permlane32_swap_b32 v238, v239
v_mov_b32 v11, 0
buffer_atomic_add v11, v251, s[4:7], s89 offen sc0 sc1
v_max_f32 v236, v236, v237
v_max_f32 v238, v238, v239
v_mov_b32 v244, v236
v_mov_b32 v245, v238
s_nop 0
v_permlane16_swap_b32 v236, v244
v_permlane16_swap_b32 v238, v245
v_max_f32 v236, v236, v244
v_max_f32 v238, v238, v245
v_mov_b32 v244, v236
v_mov_b32 v245, v238
s_nop 0
v_permlane32_swap_b32 v236, v244
v_permlane32_swap_b32 v238, v245
v_mul_f32_e64 v236, -v236, v82
v_mul_f32_e64 v237, -v244, v82
buffer_load_dwordx4 v1, s[4:7], s44 offen offset:2048 sc1 lds
v_mul_f32_e64 v238, -v238, v84
v_mul_f32_e64 v239, -v245, v84
v_pk_fma_f32 v[116:117], v[108:109], v[82:83], v[236:237] op_sel:[0,0,0] op_sel_hi:[1,0,0]
v_pk_fma_f32 v[118:119], v[110:111], v[82:83], v[236:237] op_sel:[0,0,0] op_sel_hi:[1,0,0]
v_pk_fma_f32 v[120:121], v[112:113], v[82:83], v[236:237] op_sel:[0,0,0] op_sel_hi:[1,0,0]
v_pk_fma_f32 v[122:123], v[114:115], v[82:83], v[236:237] op_sel:[0,0,0] op_sel_hi:[1,0,0]
v_pk_fma_f32 v[148:149], v[172:173], v[84:85], v[238:239] op_sel:[0,0,0] op_sel_hi:[1,0,0]
v_pk_fma_f32 v[150:151], v[174:175], v[84:85], v[238:239] op_sel:[0,0,0] op_sel_hi:[1,0,0]
v_pk_fma_f32 v[152:153], v[176:177], v[84:85], v[238:239] op_sel:[0,0,0] op_sel_hi:[1,0,0]
v_pk_fma_f32 v[154:155], v[178:179], v[84:85], v[238:239] op_sel:[0,0,0] op_sel_hi:[1,0,0]
v_pk_fma_f32 v[108:109], v[108:109], v[82:83], v[236:237] op_sel:[0,0,1] op_sel_hi:[1,0,1] neg_lo:[1,0,0] neg_hi:[1,0,0]
v_pk_fma_f32 v[110:111], v[110:111], v[82:83], v[236:237] op_sel:[0,0,1] op_sel_hi:[1,0,1] neg_lo:[1,0,0] neg_hi:[1,0,0]
v_pk_fma_f32 v[112:113], v[112:113], v[82:83], v[236:237] op_sel:[0,0,1] op_sel_hi:[1,0,1] neg_lo:[1,0,0] neg_hi:[1,0,0]
v_pk_fma_f32 v[114:115], v[114:115], v[82:83], v[236:237] op_sel:[0,0,1] op_sel_hi:[1,0,1] neg_lo:[1,0,0] neg_hi:[1,0,0]
v_pk_fma_f32 v[172:173], v[172:173], v[84:85], v[238:239] op_sel:[0,0,1] op_sel_hi:[1,0,1] neg_lo:[1,0,0] neg_hi:[1,0,0]
v_pk_fma_f32 v[174:175], v[174:175], v[84:85], v[238:239] op_sel:[0,0,1] op_sel_hi:[1,0,1] neg_lo:[1,0,0] neg_hi:[1,0,0]
v_pk_fma_f32 v[176:177], v[176:177], v[84:85], v[238:239] op_sel:[0,0,1] op_sel_hi:[1,0,1] neg_lo:[1,0,0] neg_hi:[1,0,0]
v_pk_fma_f32 v[178:179], v[178:179], v[84:85], v[238:239] op_sel:[0,0,1] op_sel_hi:[1,0,1] neg_lo:[1,0,0] neg_hi:[1,0,0]
v_exp_f32 v116, v116
v_exp_f32 v108, v108
v_exp_f32 v117, v117
v_exp_f32 v109, v109
v_exp_f32 v118, v118
v_exp_f32 v110, v110
v_exp_f32 v119, v119
v_exp_f32 v111, v111
v_exp_f32 v120, v120
v_exp_f32 v112, v112
v_exp_f32 v121, v121
v_exp_f32 v113, v113
v_exp_f32 v122, v122
v_exp_f32 v114, v114
v_exp_f32 v123, v123
v_exp_f32 v115, v115
v_exp_f32 v148, v148
v_exp_f32 v172, v172
v_exp_f32 v149, v149
v_exp_f32 v173, v173
v_exp_f32 v150, v150
v_exp_f32 v174, v174
v_exp_f32 v151, v151
v_exp_f32 v175, v175
v_exp_f32 v152, v152
v_exp_f32 v176, v176
v_exp_f32 v153, v153
v_exp_f32 v177, v177
v_exp_f32 v154, v154
v_exp_f32 v178, v178
v_exp_f32 v155, v155
v_exp_f32 v179, v179
buffer_load_dwordx4 v1, s[4:7], s44 offen offset:3072 sc1 lds
v_cvt_pk_bf16_f32 v140, v116, v117
v_cvt_pk_bf16_f32 v141, v118, v119
v_cvt_pk_bf16_f32 v142, v120, v121
v_cvt_pk_bf16_f32 v143, v122, v123
v_cvt_pk_bf16_f32 v144, v108, v109
L_stub8:
s_cbranch_execz L_wret2
v_cvt_pk_bf16_f32 v145, v110, v111
v_cvt_pk_bf16_f32 v146, v112, v113
v_cvt_pk_bf16_f32 v147, v114, v115
v_cvt_pk_bf16_f32 v164, v148, v149
v_cvt_pk_bf16_f32 v165, v150, v151
v_cvt_pk_bf16_f32 v166, v152, v153
v_cvt_pk_bf16_f32 v167, v154, v155
v_cvt_pk_bf16_f32 v168, v172, v173
v_cvt_pk_bf16_f32 v169, v174, v175
v_cvt_pk_bf16_f32 v170, v176, v177
v_cvt_pk_bf16_f32 v171, v178, v179
s_waitcnt vmcnt(2)
v_readfirstlane_b32 s38, v11
s_nop 0
s_cmp_ge_u32 s38, 8
s_cbranch_scc1 Lpe_21
s_add_u32 s36, s88, 0x80000
s_mov_b32 s37, 0
Lpoll_20:
v_mov_b32 v11, 0
buffer_atomic_add v11, v251, s[4:7], s36 offen sc0 sc1
s_add_u32 s37, s37, 1
s_waitcnt vmcnt(0)
v_readfirstlane_b32 s38, v11
s_nop 0
s_cmp_ge_u32 s38, 8
s_cbranch_scc1 Lpe_21
s_cmp_lt_u32 s37, 0x100000
s_cbranch_scc1 Lpoll_20
Lpe_21:
buffer_load_dwordx4 v[48:51], v1, s[4:7], s98 offen offset:0 sc1
v_mfma_f32_16x16x32_bf16 v[108:111], a[240:243], v[180:183], 0
v_mfma_f32_16x16x32_bf16 v[220:223], a[240:243], v[204:207], 0
v_mfma_f32_16x16x32_bf16 v[112:115], a[244:247], v[180:183], 0
s_nop 5
v_max3_f32 v240, v108, v109, v110
v_max3_f32 v241, -v108, -v109, -v110
v_mfma_f32_16x16x32_bf16 v[224:227], a[244:247], v[204:207], 0
buffer_load_dwordx4 v[124:127], v248, s[4:7], s100 offen sc1
v_max3_f32 v242, v220, v221, v222
v_max3_f32 v243, -v220, -v221, -v222
v_max3_f32 v240, v240, v111, v112
v_max3_f32 v241, v241, -v111, -v112
v_max3_f32 v240, v240, v113, v114
s_nop 1
v_max3_f32 v242, v242, v223, v224
v_max3_f32 v243, v243, -v223, -v224
v_max3_f32 v241, v241, -v113, -v114
v_max3_f32 v242, v242, v225, v226
v_max3_f32 v243, v243, -v225, -v226
v_max_f32 v240, v240, v115
v_max_f32_e64 v241, v241, -v115
v_max_f32 v242, v242, v227
buffer_load_dwordx4 v[52:55], v1, s[4:7], s98 offen offset:1024 sc1
v_max_f32_e64 v243, v243, -v227
v_permlane32_swap_b32 v240, v241
s_nop 0
v_permlane32_swap_b32 v242, v243
v_max_f32 v240, v240, v241
v_max_f32 v242, v242, v243
v_mov_b32 v246, v240
v_mov_b32 v247, v242
s_nop 0
v_permlane16_swap_b32 v240, v246
v_permlane16_swap_b32 v242, v247
buffer_load_dwordx4 v[56:59], v1, s[4:7], s98 offen offset:2048 sc1
v_max_f32 v240, v240, v246
v_max_f32 v242, v242, v247
v_mov_b32 v246, v240
v_mov_b32 v247, v242
s_nop 0
v_permlane32_swap_b32 v240, v246
v_permlane32_swap_b32 v242, v247
v_mul_f32_e64 v240, -v240, v86
v_mul_f32_e64 v241, -v246, v86
v_mul_f32_e64 v242, -v242, v88
v_mul_f32_e64 v243, -v247, v88
buffer_load_dwordx4 v[60:63], v1, s[4:7], s98 offen offset:3072 sc1
v_pk_fma_f32 v[116:117], v[108:109], v[86:87], v[240:241] op_sel:[0,0,0] op_sel_hi:[1,0,0]
v_pk_fma_f32 v[118:119], v[110:111], v[86:87], v[240:241] op_sel:[0,0,0] op_sel_hi:[1,0,0]
v_pk_fma_f32 v[120:121], v[112:113], v[86:87], v[240:241] op_sel:[0,0,0] op_sel_hi:[1,0,0]
v_pk_fma_f32 v[122:123], v[114:115], v[86:87], v[240:241] op_sel:[0,0,0] op_sel_hi:[1,0,0]
v_pk_fma_f32 v[196:197], v[220:221], v[88:89], v[242:243] op_sel:[0,0,0] op_sel_hi:[1,0,0]
v_pk_fma_f32 v[198:199], v[222:223], v[88:89], v[242:243] op_sel:[0,0,0] op_sel_hi:[1,0,0]
v_pk_fma_f32 v[200:201], v[224:225], v[88:89], v[242:243] op_sel:[0,0,0] op_sel_hi:[1,0,0]
v_pk_fma_f32 v[202:203], v[226:227], v[88:89], v[242:243] op_sel:[0,0,0] op_sel_hi:[1,0,0]
v_pk_fma_f32 v[108:109], v[108:109], v[86:87], v[240:241] op_sel:[0,0,1] op_sel_hi:[1,0,1] neg_lo:[1,0,0] neg_hi:[1,0,0]
v_pk_fma_f32 v[110:111], v[110:111], v[86:87], v[240:241] op_sel:[0,0,1] op_sel_hi:[1,0,1] neg_lo:[1,0,0] neg_hi:[1,0,0]
v_pk_fma_f32 v[112:113], v[112:113], v[86:87], v[240:241] op_sel:[0,0,1] op_sel_hi:[1,0,1] neg_lo:[1,0,0] neg_hi:[1,0,0]
v_pk_fma_f32 v[114:115], v[114:115], v[86:87], v[240:241] op_sel:[0,0,1] op_sel_hi:[1,0,1] neg_lo:[1,0,0] neg_hi:[1,0,0]
v_pk_fma_f32 v[220:221], v[220:221], v[88:89], v[242:243] op_sel:[0,0,1] op_sel_hi:[1,0,1] neg_lo:[1,0,0] neg_hi:[1,0,0]
buffer_load_dwordx4 v[64:67], v1, s[4:7], s99 offen offset:0 sc1
v_pk_fma_f32 v[222:223], v[222:223], v[88:89], v[242:243] op_sel:[0,0,1] op_sel_hi:[1,0,1] neg_lo:[1,0,0] neg_hi:[1,0,0]
v_pk_fma_f32 v[224:225], v[224:225], v[88:89], v[242:243] op_sel:[0,0,1] op_sel_hi:[1,0,1] neg_lo:[1,0,0] neg_hi:[1,0,0]
v_pk_fma_f32 v[226:227], v[226:227], v[88:89], v[242:243] op_sel:[0,0,1] op_sel_hi:[1,0,1] neg_lo:[1,0,0] neg_hi:[1,0,0]
v_exp_f32 v116, v116
v_exp_f32 v108, v108
v_exp_f32 v117, v117
v_exp_f32 v109, v109
v_exp_f32 v118, v118
buffer_load_dwordx4 v[68:71], v1, s[4:7], s99 offen offset:1024 sc1
v_exp_f32 v110, v110
v_exp_f32 v119, v119
v_exp_f32 v111, v111
v_exp_f32 v120, v120
v_exp_f32 v112, v112
v_exp_f32 v121, v121
v_exp_f32 v113, v113
buffer_load_dwordx4 v[100:103], v1, s[4:7], s99 offen offset:2048 sc1
v_exp_f32 v122, v122
v_exp_f32 v114, v114
v_exp_f32 v123, v123
v_exp_f32 v115, v115
v_exp_f32 v196, v196
v_exp_f32 v220, v220
v_exp_f32 v197, v197
buffer_load_dwordx4 v[104:107], v1, s[4:7], s99 offen offset:3072 sc1
v_exp_f32 v221, v221
v_exp_f32 v198, v198
v_exp_f32 v222, v222
v_exp_f32 v199, v199
v_exp_f32 v223, v223
v_exp_f32 v200, v200
v_exp_f32 v224, v224
buffer_store_dwordx4 a[248:251], v2, s[4:7], s73 offen offset:0 sc1
v_exp_f32 v201, v201
v_exp_f32 v225, v225
v_exp_f32 v202, v202
v_exp_f32 v226, v226
v_exp_f32 v203, v203
v_exp_f32 v227, v227
v_cvt_pk_bf16_f32 v188, v116, v117
v_cvt_pk_bf16_f32 v189, v118, v119
v_cvt_pk_bf16_f32 v190, v120, v121
v_cvt_pk_bf16_f32 v191, v122, v123
v_cvt_pk_bf16_f32 v192, v108, v109
v_cvt_pk_bf16_f32 v193, v110, v111
v_cvt_pk_bf16_f32 v194, v112, v113
v_cvt_pk_bf16_f32 v195, v114, v115
v_cvt_pk_bf16_f32 v212, v196, v197
v_cvt_pk_bf16_f32 v213, v198, v199
v_cvt_pk_bf16_f32 v214, v200, v201
v_cvt_pk_bf16_f32 v215, v202, v203
v_cvt_pk_bf16_f32 v216, v220, v221
v_cvt_pk_bf16_f32 v217, v222, v223
v_cvt_pk_bf16_f32 v218, v224, v225
v_cvt_pk_bf16_f32 v219, v226, v227
buffer_store_dwordx4 a[248:251], v2, s[4:7], s73 offen offset:1024 sc1
s_waitcnt vmcnt(10)
v_lshlrev_b32 v92, 16, v48
v_and_b32 v93, 0xffff0000, v48
v_lshlrev_b32 v94, 16, v49
v_and_b32 v95, 0xffff0000, v49
v_lshlrev_b32 v96, 16, v50
v_and_b32 v97, 0xffff0000, v50
v_lshlrev_b32 v98, 16, v51
v_and_b32 v99, 0xffff0000, v51
s_waitcnt vmcnt(9)
v_add_f32_dpp v128, v124, v124 row_ror:4 row_mask:0xf bank_mask:0xf
v_add_f32_dpp v129, v125, v125 row_ror:4 row_mask:0xf bank_mask:0xf
v_add_f32_dpp v130, v126, v126 row_ror:4 row_mask:0xf bank_mask:0xf
v_add_f32_dpp v131, v127, v127 row_ror:4 row_mask:0xf bank_mask:0xf
v_add_f32_dpp v128, v128, v128 row_ror:2 row_mask:0xf bank_mask:0xf
v_add_f32_dpp v129, v129, v129 row_ror:2 row_mask:0xf bank_mask:0xf
v_add_f32_dpp v130, v130, v130 row_ror:2 row_mask:0xf bank_mask:0xf
buffer_store_dwordx4 a[248:251], v2, s[4:7], s73 offen offset:2048 sc1
v_add_f32_dpp v131, v131, v131 row_ror:2 row_mask:0xf bank_mask:0xf
v_add_f32_dpp v128, v128, v128 row_ror:1 row_mask:0xf bank_mask:0xf
v_add_f32_dpp v129, v129, v129 row_ror:1 row_mask:0xf bank_mask:0xf
v_add_f32_dpp v130, v130, v130 row_ror:1 row_mask:0xf bank_mask:0xf
v_add_f32_dpp v131, v131, v131 row_ror:1 row_mask:0xf bank_mask:0xf
s_waitcnt vmcnt(9)
v_dot2c_f32_bf16 v92, v52, v249
v_dot2c_f32_bf16 v93, v52, v250
v_dot2c_f32_bf16 v94, v53, v249
v_dot2c_f32_bf16 v95, v53, v250
v_dot2c_f32_bf16 v96, v54, v249
v_dot2c_f32_bf16 v97, v54, v250
v_dot2c_f32_bf16 v98, v55, v249
v_dot2c_f32_bf16 v99, v55, v250
v_fma_f32 v135, v129, v130, v131
s_waitcnt vmcnt(8)
v_dot2c_f32_bf16 v92, v56, v249
v_dot2c_f32_bf16 v93, v56, v250
v_dot2c_f32_bf16 v94, v57, v249
v_dot2c_f32_bf16 v95, v57, v250
v_dot2c_f32_bf16 v96, v58, v249
v_dot2c_f32_bf16 v97, v58, v250
v_dot2c_f32_bf16 v98, v59, v249
v_dot2c_f32_bf16 v99, v59, v250
buffer_store_dwordx4 a[248:251], v2, s[4:7], s73 offen offset:3072 sc1
s_waitcnt vmcnt(8)
v_dot2c_f32_bf16 v92, v60, v249
v_dot2c_f32_bf16 v93, v60, v250
v_dot2c_f32_bf16 v94, v61, v249
v_dot2c_f32_bf16 v95, v61, v250
v_dot2c_f32_bf16 v96, v62, v249
v_dot2c_f32_bf16 v97, v62, v250
v_dot2c_f32_bf16 v98, v63, v249
v_dot2c_f32_bf16 v99, v63, v250
s_waitcnt vmcnt(7)
v_dot2c_f32_bf16 v92, v64, v249
v_dot2c_f32_bf16 v93, v64, v250
v_dot2c_f32_bf16 v94, v65, v249
v_dot2c_f32_bf16 v95, v65, v250
v_dot2c_f32_bf16 v96, v66, v249
v_dot2c_f32_bf16 v97, v66, v250
v_dot2c_f32_bf16 v98, v67, v249
v_dot2c_f32_bf16 v99, v67, v250
s_waitcnt vmcnt(6)
v_dot2c_f32_bf16 v92, v68, v249
v_dot2c_f32_bf16 v93, v68, v250
v_dot2c_f32_bf16 v94, v69, v249
v_dot2c_f32_bf16 v95, v69, v250
v_dot2c_f32_bf16 v96, v70, v249
v_dot2c_f32_bf16 v97, v70, v250
v_dot2c_f32_bf16 v98, v71, v249
v_dot2c_f32_bf16 v99, v71, v250
s_waitcnt vmcnt(5)
v_dot2c_f32_bf16 v92, v100, v249
v_dot2c_f32_bf16 v93, v100, v250
v_dot2c_f32_bf16 v94, v101, v249
v_dot2c_f32_bf16 v95, v101, v250
v_dot2c_f32_bf16 v96, v102, v249
v_dot2c_f32_bf16 v97, v102, v250
v_dot2c_f32_bf16 v98, v103, v249
v_dot2c_f32_bf16 v99, v103, v250
s_waitcnt vmcnt(4)
v_dot2c_f32_bf16 v92, v104, v249
v_dot2c_f32_bf16 v93, v104, v250
v_dot2c_f32_bf16 v94, v105, v249
v_dot2c_f32_bf16 v95, v105, v250
v_dot2c_f32_bf16 v96, v106, v249
v_dot2c_f32_bf16 v97, v106, v250
v_dot2c_f32_bf16 v98, v107, v249
v_dot2c_f32_bf16 v99, v107, v250
v_fma_f32 v132, v92, v93, v94
v_fma_f32 v133, v95, v96, v97
s_nop 0
v_fma_f32 v134, v98, v99, v128
v_fma_f32 v132, v132, v133, v134
v_cmp_u_f32 vcc, v132, v135
s_cbranch_vccnz L_kvredo1
L_kvback1:
v_cvt_pk_bf16_f32 v128, v128, v129
v_cvt_pk_bf16_f32 v129, v130, v131
v_cvt_pk_bf16_f32 v92, v92, v93
v_cndmask_b32 v128, 0, v128, s[56:57]
v_cndmask_b32 v129, 0, v129, s[56:57]
v_cvt_pk_bf16_f32 v93, v94, v95
v_cvt_pk_bf16_f32 v94, v96, v97
v_cvt_pk_bf16_f32 v95, v98, v99
v_cndmask_b32 v128, v128, v16, s[58:59]
v_cndmask_b32 v129, v129, v16, s[58:59]
ds_write_b64 v252, v[92:93] offset:0
ds_write_b64 v252, v[94:95] offset:1024
ds_write_b64 v252, v[128:129] offset:2048
s_waitcnt lgkmcnt(0)
s_barrier
ds_read_b128 a[8:11], v1 offset:2048
ds_read_b128 a[20:23], v1 offset:5120
ds_read_b128 a[0:3], v1 offset:0
ds_read_b128 a[12:15], v1 offset:3072
ds_read_b128 a[4:7], v1 offset:1024
ds_read_b128 a[16:19], v1 offset:4096
s_waitcnt lgkmcnt(5)
v_mfma_f32_16x16x32_bf16 v[116:119], a[8:11], v[212:215], 0
s_waitcnt lgkmcnt(4)
v_mfma_f32_16x16x32_bf16 v[120:123], a[20:23], v[216:219], 0
s_waitcnt lgkmcnt(3)
v_mfma_f32_16x16x32_bf16 v[204:207], a[0:3], v[212:215], 0
s_nop 3
v_rcp_f32 v118, v117
s_waitcnt lgkmcnt(2)
v_mfma_f32_16x16x32_bf16 v[220:223], a[12:15], v[216:219], 0
v_rcp_f32 v119, v121
v_mul_f32 v116, v116, v118
v_fmac_f32 v116, v120, v119
v_mfma_f32_16x16x32_bf16 v[100:103], a[8:11], v[164:167], 0
v_add_f32 v116, 0x358637bd, v116
v_rcp_f32 v116, v116
s_waitcnt lgkmcnt(1)
v_mfma_f32_16x16x32_bf16 v[208:211], a[4:7], v[212:215], 0
v_mul_f32 v118, v118, v116
v_mul_f32 v119, v119, v116
v_mfma_f32_16x16x32_bf16 v[104:107], a[20:23], v[168:171], 0
v_mul_f32 v204, v204, v118
v_mul_f32 v205, v205, v118
s_waitcnt lgkmcnt(0)
v_mfma_f32_16x16x32_bf16 v[224:227], a[16:19], v[216:219], 0
v_mul_f32 v206, v206, v118
v_mul_f32 v207, v207, v118
v_fmac_f32 v204, v220, v119
v_fmac_f32 v205, v221, v119
v_rcp_f32 v102, v101
v_mul_f32 v208, v208, v118
v_mul_f32 v209, v209, v118
v_mul_f32 v210, v210, v118
v_mul_f32 v211, v211, v118
v_fmac_f32 v206, v222, v119
v_fmac_f32 v207, v223, v119
v_cvt_pk_bf16_f32 v204, v204, v205
v_rcp_f32 v103, v105
v_fmac_f32 v208, v224, v119
v_fmac_f32 v209, v225, v119
v_fmac_f32 v210, v226, v119
v_fmac_f32 v211, v227, v119
v_cvt_pk_bf16_f32 v205, v206, v207
v_cvt_pk_bf16_f32 v206, v208, v209
v_cvt_pk_bf16_f32 v207, v210, v211
v_mul_f32 v100, v100, v102
v_mfma_f32_16x16x32_bf16 v[156:159], a[0:3], v[164:167], 0
buffer_store_dwordx4 v[204:207], v2, s[4:7], s72 offen offset:3072 sc1
v_fmac_f32 v100, v104, v103
v_mfma_f32_16x16x32_bf16 v[172:175], a[12:15], v[168:171], 0
v_add_f32 v100, 0x358637bd, v100
v_rcp_f32 v100, v100
v_mfma_f32_16x16x32_bf16 v[108:111], a[8:11], v[188:191], 0
v_mul_f32 v102, v102, v100
v_mul_f32 v103, v103, v100
v_mfma_f32_16x16x32_bf16 v[160:163], a[4:7], v[164:167], 0
v_mul_f32 v156, v156, v102
v_mul_f32 v157, v157, v102
v_mfma_f32_16x16x32_bf16 v[112:115], a[20:23], v[192:195], 0
v_mul_f32 v158, v158, v102
v_mul_f32 v159, v159, v102
v_mfma_f32_16x16x32_bf16 v[176:179], a[16:19], v[168:171], 0
v_fmac_f32 v156, v172, v103
v_fmac_f32 v157, v173, v103
v_rcp_f32 v110, v109
v_mul_f32 v160, v160, v102
v_mul_f32 v161, v161, v102
v_mul_f32 v162, v162, v102
v_mul_f32 v163, v163, v102
v_fmac_f32 v158, v174, v103
v_fmac_f32 v159, v175, v103
v_cvt_pk_bf16_f32 v156, v156, v157
v_rcp_f32 v111, v113
v_fmac_f32 v160, v176, v103
v_fmac_f32 v161, v177, v103
v_fmac_f32 v162, v178, v103
v_fmac_f32 v163, v179, v103
v_cvt_pk_bf16_f32 v157, v158, v159
v_cvt_pk_bf16_f32 v158, v160, v161
v_cvt_pk_bf16_f32 v159, v162, v163
v_mul_f32 v108, v108, v110
v_mfma_f32_16x16x32_bf16 v[180:183], a[0:3], v[188:191], 0
buffer_store_dwordx4 v[156:159], v2, s[4:7], s72 offen offset:1024 sc1
v_fmac_f32 v108, v112, v111
v_mfma_f32_16x16x32_bf16 v[196:199], a[12:15], v[192:195], 0
v_add_f32 v108, 0x358637bd, v108
v_rcp_f32 v108, v108
v_mfma_f32_16x16x32_bf16 v[92:95], a[8:11], v[140:143], 0
v_mul_f32 v110, v110, v108
v_mul_f32 v111, v111, v108
v_mfma_f32_16x16x32_bf16 v[184:187], a[4:7], v[188:191], 0
v_mul_f32 v180, v180, v110
v_mul_f32 v181, v181, v110
v_mfma_f32_16x16x32_bf16 v[96:99], a[20:23], v[144:147], 0
v_mul_f32 v182, v182, v110
v_mul_f32 v183, v183, v110
v_mfma_f32_16x16x32_bf16 v[200:203], a[16:19], v[192:195], 0
v_fmac_f32 v180, v196, v111
v_fmac_f32 v181, v197, v111
v_rcp_f32 v94, v93
v_mul_f32 v184, v184, v110
v_mul_f32 v185, v185, v110
v_mul_f32 v186, v186, v110
v_mul_f32 v187, v187, v110
v_fmac_f32 v182, v198, v111
v_fmac_f32 v183, v199, v111
v_cvt_pk_bf16_f32 v180, v180, v181
v_rcp_f32 v95, v97
buffer_atomic_add v12, v10, s[4:7], s74 offen sc1
v_fmac_f32 v184, v200, v111
v_fmac_f32 v185, v201, v111
v_fmac_f32 v186, v202, v111
v_fmac_f32 v187, v203, v111
v_cvt_pk_bf16_f32 v181, v182, v183
v_cvt_pk_bf16_f32 v182, v184, v185
v_cvt_pk_bf16_f32 v183, v186, v187
v_mul_f32 v92, v92, v94
v_mfma_f32_16x16x32_bf16 v[132:135], a[0:3], v[140:143], 0
buffer_store_dwordx4 v[180:183], v2, s[4:7], s72 offen offset:2048 sc1
v_fmac_f32 v92, v96, v95
v_mfma_f32_16x16x32_bf16 v[148:151], a[12:15], v[144:147], 0
v_add_f32 v92, 0x358637bd, v92
v_rcp_f32 v92, v92
v_mfma_f32_16x16x32_bf16 v[136:139], a[4:7], v[140:143], 0
v_mul_f32 v94, v94, v92
v_mul_f32 v95, v95, v92
v_mfma_f32_16x16x32_bf16 v[152:155], a[16:19], v[144:147], 0
v_mul_f32 v132, v132, v94
v_mul_f32 v133, v133, v94
v_mul_f32 v134, v134, v94
v_mul_f32 v135, v135, v94
v_fmac_f32 v132, v148, v95
v_fmac_f32 v133, v149, v95
v_mul_f32 v136, v136, v94
v_mul_f32 v137, v137, v94
v_mul_f32 v138, v138, v94
v_mul_f32 v139, v139, v94
v_fmac_f32 v134, v150, v95
v_fmac_f32 v135, v151, v95
v_cvt_pk_bf16_f32 v132, v132, v133
v_fmac_f32 v136, v152, v95
v_fmac_f32 v137, v153, v95
v_fmac_f32 v138, v154, v95
v_fmac_f32 v139, v155, v95
v_cvt_pk_bf16_f32 v133, v134, v135
v_cvt_pk_bf16_f32 v134, v136, v137
v_cvt_pk_bf16_f32 v135, v138, v139
buffer_store_dwordx4 v[132:135], v2, s[4:7], s72 offen offset:0 sc1
s_add_u32 s92, s71, 0x10000
s_add_u32 s36, s66, 0x10080
s_add_u32 s40, s4, 0x2600000
s_addc_u32 s41, s5, 0
v_add_u32 v5, 32768, v1
v_add_u32 v6, 98304, v1
s_cmp_eq_u32 s3, 0
s_cselect_b32 s35, 8, 0
s_lshl_b32 s35, s35, 12
v_lshlrev_b32 v132, 16, v32
v_and_b32 v133, 0xffff0000, v32
v_lshlrev_b32 v134, 16, v33
v_and_b32 v135, 0xffff0000, v33
v_lshlrev_b32 v136, 16, v34
v_and_b32 v137, 0xffff0000, v34
v_lshlrev_b32 v138, 16, v35
v_and_b32 v139, 0xffff0000, v35
v_lshlrev_b32 v140, 16, v36
v_and_b32 v141, 0xffff0000, v36
v_lshlrev_b32 v142, 16, v37
v_and_b32 v143, 0xffff0000, v37
v_lshlrev_b32 v144, 16, v38
v_and_b32 v145, 0xffff0000, v38
v_lshlrev_b32 v146, 16, v39
v_and_b32 v147, 0xffff0000, v39
v_lshlrev_b32 v148, 16, v40
v_and_b32 v149, 0xffff0000, v40
v_lshlrev_b32 v150, 16, v41
v_and_b32 v151, 0xffff0000, v41
v_lshlrev_b32 v152, 16, v42
v_and_b32 v153, 0xffff0000, v42
v_lshlrev_b32 v154, 16, v43
v_and_b32 v155, 0xffff0000, v43
v_lshlrev_b32 v156, 16, v44
v_and_b32 v157, 0xffff0000, v44
v_lshlrev_b32 v158, 16, v45
v_and_b32 v159, 0xffff0000, v45
v_lshlrev_b32 v160, 16, v46
v_and_b32 v161, 0xffff0000, v46
v_lshlrev_b32 v162, 16, v47
v_and_b32 v163, 0xffff0000, v47
s_mov_b32 s95, -1
s_mov_b64 exec, 0
s_cmp_eq_u32 s28, 3
s_cbranch_scc1 L_stub9
s_cmp_eq_u32 s28, 2
s_cbranch_scc1 L_wret3
L_wret3:
s_mov_b64 exec, -1
s_cmp_lg_u32 s28, 0
s_cbranch_scc1 Lpo_24
s_add_u32 s36, s66, 0x10080
s_mov_b32 s37, 0
v_mov_b32 v11, 0
buffer_atomic_add v11, v251, s[4:7], s36 offen sc0 sc1
s_sleep 4
Lpoll_22:
v_mov_b32 v234, 0
buffer_atomic_add v234, v251, s[4:7], s36 offen sc0 sc1
s_waitcnt vmcnt(1)
v_readfirstlane_b32 s38, v11
s_nop 0
s_cmp_ge_u32 s38, 32
s_cbranch_scc1 Lpe_23
v_mov_b32 v11, 0
buffer_atomic_add v11, v251, s[4:7], s36 offen sc0 sc1
s_waitcnt vmcnt(1)
v_readfirstlane_b32 s38, v234
s_nop 0
s_cmp_ge_u32 s38, 32
s_cbranch_scc1 Lpe_23
s_add_u32 s37, s37, 1
s_cmp_lt_u32 s37, 0x80000
s_cbranch_scc1 Lpoll_22
s_waitcnt vmcnt(0)
Lpo_24:
s_waitcnt vmcnt(0)
Lpe_23:
s_barrier
L_k2go1:
buffer_load_dwordx4 a[0:3], v4, s[40:43], s35 offen offset:0 sc1
buffer_load_dwordx4 a[4:7], v4, s[40:43], s35 offen offset:1024 sc1
s_cmp_eq_u32 s3, 1
s_cselect_b32 s35, 9, 1
s_lshl_b32 s35, s35, 12
buffer_load_dwordx4 a[8:11], v4, s[40:43], s35 offen offset:0 sc1
buffer_load_dwordx4 a[12:15], v4, s[40:43], s35 offen offset:1024 sc1
s_cmp_eq_u32 s3, 2
s_cselect_b32 s35, 10, 2
s_lshl_b32 s35, s35, 12
buffer_load_dwordx4 a[16:19], v4, s[40:43], s35 offen offset:0 sc1
buffer_load_dwordx4 a[20:23], v4, s[40:43], s35 offen offset:1024 sc1
s_cmp_eq_u32 s3, 3
s_cselect_b32 s35, 11, 3
s_lshl_b32 s35, s35, 12
buffer_load_dwordx4 a[24:27], v4, s[40:43], s35 offen offset:0 sc1
buffer_load_dwordx4 a[28:31], v4, s[40:43], s35 offen offset:1024 sc1
s_cmp_eq_u32 s3, 4
s_cselect_b32 s35, 12, 4
s_lshl_b32 s35, s35, 12
buffer_load_dwordx4 a[32:35], v4, s[40:43], s35 offen offset:0 sc1
buffer_load_dwordx4 a[36:39], v4, s[40:43], s35 offen offset:1024 sc1
s_cmp_eq_u32 s3, 5
s_cselect_b32 s35, 13, 5
s_lshl_b32 s35, s35, 12
ds_read_b128 a[96:99], v5 offset:0
ds_read_b128 a[100:103], v5 offset:1024
ds_read_b128 a[104:107], v5 offset:2048
ds_read_b128 a[108:111], v5 offset:3072
ds_read_b128 a[112:115], v5 offset:4096
ds_read_b128 a[116:119], v5 offset:5120
ds_read_b128 a[120:123], v5 offset:6144
ds_read_b128 a[124:127], v5 offset:7168
s_waitcnt vmcnt(8) lgkmcnt(4)
v_mfma_f32_16x16x32_bf16 v[132:135], a[96:99], a[0:3], v[132:135]
ds_read_b128 a[128:131], v5 offset:8192
v_mfma_f32_16x16x32_bf16 v[148:151], a[96:99], a[4:7], v[148:151]
ds_read_b128 a[132:135], v5 offset:9216
v_mfma_f32_16x16x32_bf16 v[152:155], a[100:103], a[4:7], v[152:155]
buffer_load_dwordx4 a[40:43], v4, s[40:43], s35 offen offset:0 sc1
v_mfma_f32_16x16x32_bf16 v[136:139], a[100:103], a[0:3], v[136:139]
ds_read_b128 a[136:139], v5 offset:10240
v_mfma_f32_16x16x32_bf16 v[140:143], a[104:107], a[0:3], v[140:143]
ds_read_b128 a[140:143], v5 offset:11264
v_mfma_f32_16x16x32_bf16 v[156:159], a[104:107], a[4:7], v[156:159]
v_mfma_f32_16x16x32_bf16 v[160:163], a[108:111], a[4:7], v[160:163]
buffer_load_dwordx4 a[44:47], v4, s[40:43], s35 offen offset:1024 sc1
v_mfma_f32_16x16x32_bf16 v[144:147], a[108:111], a[0:3], v[144:147]
s_waitcnt vmcnt(8) lgkmcnt(4)
v_mfma_f32_16x16x32_bf16 v[132:135], a[112:115], a[8:11], v[132:135]
s_cmp_eq_u32 s3, 6
s_cselect_b32 s35, 14, 6
s_lshl_b32 s35, s35, 12
v_mfma_f32_16x16x32_bf16 v[148:151], a[112:115], a[12:15], v[148:151]
ds_read_b128 a[96:99], v5 offset:12288
v_mfma_f32_16x16x32_bf16 v[152:155], a[116:119], a[12:15], v[152:155]
buffer_load_dwordx4 a[0:3], v4, s[40:43], s35 offen offset:0 sc1
v_mfma_f32_16x16x32_bf16 v[136:139], a[116:119], a[8:11], v[136:139]
ds_read_b128 a[100:103], v5 offset:13312
v_mfma_f32_16x16x32_bf16 v[140:143], a[120:123], a[8:11], v[140:143]
ds_read_b128 a[104:107], v5 offset:14336
v_mfma_f32_16x16x32_bf16 v[156:159], a[120:123], a[12:15], v[156:159]
ds_read_b128 a[108:111], v5 offset:15360
v_mfma_f32_16x16x32_bf16 v[160:163], a[124:127], a[12:15], v[160:163]
buffer_load_dwordx4 a[4:7], v4, s[40:43], s35 offen offset:1024 sc1
v_mfma_f32_16x16x32_bf16 v[144:147], a[124:127], a[8:11], v[144:147]
s_waitcnt vmcnt(8) lgkmcnt(4)
v_mfma_f32_16x16x32_bf16 v[132:135], a[128:131], a[16:19], v[132:135]
s_cmp_eq_u32 s3, 7
s_cselect_b32 s35, 15, 7
s_lshl_b32 s35, s35, 12
v_mfma_f32_16x16x32_bf16 v[148:151], a[128:131], a[20:23], v[148:151]
ds_read_b128 a[112:115], v5 offset:16384
v_mfma_f32_16x16x32_bf16 v[152:155], a[132:135], a[20:23], v[152:155]
buffer_load_dwordx4 a[8:11], v4, s[40:43], s35 offen offset:0 sc1
v_mfma_f32_16x16x32_bf16 v[136:139], a[132:135], a[16:19], v[136:139]
ds_read_b128 a[116:119], v5 offset:17408
v_mfma_f32_16x16x32_bf16 v[140:143], a[136:139], a[16:19], v[140:143]
ds_read_b128 a[120:123], v5 offset:18432
v_mfma_f32_16x16x32_bf16 v[156:159], a[136:139], a[20:23], v[156:159]
ds_read_b128 a[124:127], v5 offset:19456
v_mfma_f32_16x16x32_bf16 v[160:163], a[140:143], a[20:23], v[160:163]
buffer_load_dwordx4 a[12:15], v4, s[40:43], s35 offen offset:1024 sc1
v_mfma_f32_16x16x32_bf16 v[144:147], a[140:143], a[16:19], v[144:147]
s_waitcnt vmcnt(8) lgkmcnt(4)
v_mfma_f32_16x16x32_bf16 v[132:135], a[96:99], a[24:27], v[132:135]
s_cmp_eq_u32 s3, 0
s_cselect_b32 s35, 16, 8
s_lshl_b32 s35, s35, 12
v_mfma_f32_16x16x32_bf16 v[148:151], a[96:99], a[28:31], v[148:151]
ds_read_b128 a[128:131], v5 offset:20480
v_mfma_f32_16x16x32_bf16 v[152:155], a[100:103], a[28:31], v[152:155]
buffer_load_dwordx4 a[16:19], v4, s[40:43], s35 offen offset:0 sc1
v_mfma_f32_16x16x32_bf16 v[136:139], a[100:103], a[24:27], v[136:139]
ds_read_b128 a[132:135], v5 offset:21504
v_mfma_f32_16x16x32_bf16 v[140:143], a[104:107], a[24:27], v[140:143]
ds_read_b128 a[136:139], v5 offset:22528
v_mfma_f32_16x16x32_bf16 v[156:159], a[104:107], a[28:31], v[156:159]
ds_read_b128 a[140:143], v5 offset:23552
v_mfma_f32_16x16x32_bf16 v[160:163], a[108:111], a[28:31], v[160:163]
buffer_load_dwordx4 a[20:23], v4, s[40:43], s35 offen offset:1024 sc1
v_mfma_f32_16x16x32_bf16 v[144:147], a[108:111], a[24:27], v[144:147]
s_waitcnt vmcnt(8) lgkmcnt(4)
v_mfma_f32_16x16x32_bf16 v[132:135], a[112:115], a[32:35], v[132:135]
s_cmp_eq_u32 s3, 1
s_cselect_b32 s35, 17, 9
s_lshl_b32 s35, s35, 12
v_mfma_f32_16x16x32_bf16 v[148:151], a[112:115], a[36:39], v[148:151]
ds_read_b128 a[96:99], v5 offset:24576
v_mfma_f32_16x16x32_bf16 v[152:155], a[116:119], a[36:39], v[152:155]
buffer_load_dwordx4 a[24:27], v4, s[40:43], s35 offen offset:0 sc1
v_mfma_f32_16x16x32_bf16 v[136:139], a[116:119], a[32:35], v[136:139]
ds_read_b128 a[100:103], v5 offset:25600
v_mfma_f32_16x16x32_bf16 v[140:143], a[120:123], a[32:35], v[140:143]
ds_read_b128 a[104:107], v5 offset:26624
v_mfma_f32_16x16x32_bf16 v[156:159], a[120:123], a[36:39], v[156:159]
ds_read_b128 a[108:111], v5 offset:27648
v_mfma_f32_16x16x32_bf16 v[160:163], a[124:127], a[36:39], v[160:163]
buffer_load_dwordx4 a[28:31], v4, s[40:43], s35 offen offset:1024 sc1
v_mfma_f32_16x16x32_bf16 v[144:147], a[124:127], a[32:35], v[144:147]
s_waitcnt vmcnt(8) lgkmcnt(4)
v_mfma_f32_16x16x32_bf16 v[132:135], a[128:131], a[40:43], v[132:135]
s_cmp_eq_u32 s3, 2
s_cselect_b32 s35, 18, 10
s_lshl_b32 s35, s35, 12
v_mfma_f32_16x16x32_bf16 v[148:151], a[128:131], a[44:47], v[148:151]
ds_read_b128 a[112:115], v5 offset:28672
v_mfma_f32_16x16x32_bf16 v[152:155], a[132:135], a[44:47], v[152:155]
buffer_load_dwordx4 a[32:35], v4, s[40:43], s35 offen offset:0 sc1
v_mfma_f32_16x16x32_bf16 v[136:139], a[132:135], a[40:43], v[136:139]
ds_read_b128 a[116:119], v5 offset:29696
v_mfma_f32_16x16x32_bf16 v[140:143], a[136:139], a[40:43], v[140:143]
ds_read_b128 a[120:123], v5 offset:30720
v_mfma_f32_16x16x32_bf16 v[156:159], a[136:139], a[44:47], v[156:159]
ds_read_b128 a[124:127], v5 offset:31744
v_mfma_f32_16x16x32_bf16 v[160:163], a[140:143], a[44:47], v[160:163]
buffer_load_dwordx4 a[36:39], v4, s[40:43], s35 offen offset:1024 sc1
v_mfma_f32_16x16x32_bf16 v[144:147], a[140:143], a[40:43], v[144:147]
s_waitcnt vmcnt(8) lgkmcnt(4)
v_mfma_f32_16x16x32_bf16 v[132:135], a[96:99], a[0:3], v[132:135]
s_cmp_eq_u32 s3, 3
s_cselect_b32 s35, 19, 11
s_lshl_b32 s35, s35, 12
v_mfma_f32_16x16x32_bf16 v[148:151], a[96:99], a[4:7], v[148:151]
ds_read_b128 a[128:131], v5 offset:32768
v_mfma_f32_16x16x32_bf16 v[152:155], a[100:103], a[4:7], v[152:155]
buffer_load_dwordx4 a[40:43], v4, s[40:43], s35 offen offset:0 sc1
v_mfma_f32_16x16x32_bf16 v[136:139], a[100:103], a[0:3], v[136:139]
ds_read_b128 a[132:135], v5 offset:33792
v_mfma_f32_16x16x32_bf16 v[140:143], a[104:107], a[0:3], v[140:143]
ds_read_b128 a[136:139], v5 offset:34816
v_mfma_f32_16x16x32_bf16 v[156:159], a[104:107], a[4:7], v[156:159]
ds_read_b128 a[140:143], v5 offset:35840
v_mfma_f32_16x16x32_bf16 v[160:163], a[108:111], a[4:7], v[160:163]
buffer_load_dwordx4 a[44:47], v4, s[40:43], s35 offen offset:1024 sc1
v_mfma_f32_16x16x32_bf16 v[144:147], a[108:111], a[0:3], v[144:147]
s_waitcnt vmcnt(8) lgkmcnt(4)
v_mfma_f32_16x16x32_bf16 v[132:135], a[112:115], a[8:11], v[132:135]
s_cmp_eq_u32 s3, 4
s_cselect_b32 s35, 20, 12
s_lshl_b32 s35, s35, 12
v_mfma_f32_16x16x32_bf16 v[148:151], a[112:115], a[12:15], v[148:151]
ds_read_b128 a[96:99], v5 offset:36864
v_mfma_f32_16x16x32_bf16 v[152:155], a[116:119], a[12:15], v[152:155]
buffer_load_dwordx4 a[0:3], v4, s[40:43], s35 offen offset:0 sc1
v_mfma_f32_16x16x32_bf16 v[136:139], a[116:119], a[8:11], v[136:139]
ds_read_b128 a[100:103], v5 offset:37888
v_mfma_f32_16x16x32_bf16 v[140:143], a[120:123], a[8:11], v[140:143]
ds_read_b128 a[104:107], v5 offset:38912
v_mfma_f32_16x16x32_bf16 v[156:159], a[120:123], a[12:15], v[156:159]
ds_read_b128 a[108:111], v5 offset:39936
v_mfma_f32_16x16x32_bf16 v[160:163], a[124:127], a[12:15], v[160:163]
buffer_load_dwordx4 a[4:7], v4, s[40:43], s35 offen offset:1024 sc1
v_mfma_f32_16x16x32_bf16 v[144:147], a[124:127], a[8:11], v[144:147]
s_waitcnt vmcnt(8) lgkmcnt(4)
v_mfma_f32_16x16x32_bf16 v[132:135], a[128:131], a[16:19], v[132:135]
s_cmp_eq_u32 s3, 5
s_cselect_b32 s35, 21, 13
s_lshl_b32 s35, s35, 12
v_mfma_f32_16x16x32_bf16 v[148:151], a[128:131], a[20:23], v[148:151]
ds_read_b128 a[112:115], v5 offset:40960
v_mfma_f32_16x16x32_bf16 v[152:155], a[132:135], a[20:23], v[152:155]
buffer_load_dwordx4 a[8:11], v4, s[40:43], s35 offen offset:0 sc1
v_mfma_f32_16x16x32_bf16 v[136:139], a[132:135], a[16:19], v[136:139]
ds_read_b128 a[116:119], v5 offset:41984
v_mfma_f32_16x16x32_bf16 v[140:143], a[136:139], a[16:19], v[140:143]
ds_read_b128 a[120:123], v5 offset:43008
v_mfma_f32_16x16x32_bf16 v[156:159], a[136:139], a[20:23], v[156:159]
ds_read_b128 a[124:127], v5 offset:44032
v_mfma_f32_16x16x32_bf16 v[160:163], a[140:143], a[20:23], v[160:163]
buffer_load_dwordx4 a[12:15], v4, s[40:43], s35 offen offset:1024 sc1
v_mfma_f32_16x16x32_bf16 v[144:147], a[140:143], a[16:19], v[144:147]
s_waitcnt vmcnt(8) lgkmcnt(4)
v_mfma_f32_16x16x32_bf16 v[132:135], a[96:99], a[24:27], v[132:135]
s_cmp_eq_u32 s3, 6
s_cselect_b32 s35, 22, 14
s_lshl_b32 s35, s35, 12
L_stub9:
s_cbranch_execz L_wret3
v_mfma_f32_16x16x32_bf16 v[148:151], a[96:99], a[28:31], v[148:151]
ds_read_b128 a[128:131], v5 offset:45056
v_mfma_f32_16x16x32_bf16 v[152:155], a[100:103], a[28:31], v[152:155]
buffer_load_dwordx4 a[16:19], v4, s[40:43], s35 offen offset:0 sc1
v_mfma_f32_16x16x32_bf16 v[136:139], a[100:103], a[24:27], v[136:139]
ds_read_b128 a[132:135], v5 offset:46080
v_mfma_f32_16x16x32_bf16 v[140:143], a[104:107], a[24:27], v[140:143]
ds_read_b128 a[136:139], v5 offset:47104
v_mfma_f32_16x16x32_bf16 v[156:159], a[104:107], a[28:31], v[156:159]
ds_read_b128 a[140:143], v5 offset:48128
v_mfma_f32_16x16x32_bf16 v[160:163], a[108:111], a[28:31], v[160:163]
buffer_load_dwordx4 a[20:23], v4, s[40:43], s35 offen offset:1024 sc1
v_mfma_f32_16x16x32_bf16 v[144:147], a[108:111], a[24:27], v[144:147]
s_waitcnt vmcnt(8) lgkmcnt(4)
v_mfma_f32_16x16x32_bf16 v[132:135], a[112:115], a[32:35], v[132:135]
s_cmp_eq_u32 s3, 7
s_cselect_b32 s35, 23, 15
s_lshl_b32 s35, s35, 12
v_mfma_f32_16x16x32_bf16 v[148:151], a[112:115], a[36:39], v[148:151]
ds_read_b128 a[96:99], v5 offset:49152
v_mfma_f32_16x16x32_bf16 v[152:155], a[116:119], a[36:39], v[152:155]
buffer_load_dwordx4 a[24:27], v4, s[40:43], s35 offen offset:0 sc1
v_mfma_f32_16x16x32_bf16 v[136:139], a[116:119], a[32:35], v[136:139]
ds_read_b128 a[100:103], v5 offset:50176
v_mfma_f32_16x16x32_bf16 v[140:143], a[120:123], a[32:35], v[140:143]
ds_read_b128 a[104:107], v5 offset:51200
v_mfma_f32_16x16x32_bf16 v[156:159], a[120:123], a[36:39], v[156:159]
ds_read_b128 a[108:111], v5 offset:52224
v_mfma_f32_16x16x32_bf16 v[160:163], a[124:127], a[36:39], v[160:163]
buffer_load_dwordx4 a[28:31], v4, s[40:43], s35 offen offset:1024 sc1
v_mfma_f32_16x16x32_bf16 v[144:147], a[124:127], a[32:35], v[144:147]
s_waitcnt vmcnt(8) lgkmcnt(4)
v_mfma_f32_16x16x32_bf16 v[132:135], a[128:131], a[40:43], v[132:135]
s_cmp_eq_u32 s3, 0
s_cselect_b32 s35, 24, 16
s_lshl_b32 s35, s35, 12
v_mfma_f32_16x16x32_bf16 v[148:151], a[128:131], a[44:47], v[148:151]
ds_read_b128 a[112:115], v5 offset:53248
v_mfma_f32_16x16x32_bf16 v[152:155], a[132:135], a[44:47], v[152:155]
buffer_load_dwordx4 a[32:35], v4, s[40:43], s35 offen offset:0 sc1
v_mfma_f32_16x16x32_bf16 v[136:139], a[132:135], a[40:43], v[136:139]
ds_read_b128 a[116:119], v5 offset:54272
v_mfma_f32_16x16x32_bf16 v[140:143], a[136:139], a[40:43], v[140:143]
ds_read_b128 a[120:123], v5 offset:55296
v_mfma_f32_16x16x32_bf16 v[156:159], a[136:139], a[44:47], v[156:159]
ds_read_b128 a[124:127], v5 offset:56320
v_mfma_f32_16x16x32_bf16 v[160:163], a[140:143], a[44:47], v[160:163]
buffer_load_dwordx4 a[36:39], v4, s[40:43], s35 offen offset:1024 sc1
v_mfma_f32_16x16x32_bf16 v[144:147], a[140:143], a[40:43], v[144:147]
s_waitcnt vmcnt(8) lgkmcnt(4)
v_mfma_f32_16x16x32_bf16 v[132:135], a[96:99], a[0:3], v[132:135]
s_cmp_eq_u32 s3, 1
s_cselect_b32 s35, 25, 17
s_lshl_b32 s35, s35, 12
v_mfma_f32_16x16x32_bf16 v[148:151], a[96:99], a[4:7], v[148:151]
ds_read_b128 a[128:131], v5 offset:57344
v_mfma_f32_16x16x32_bf16 v[152:155], a[100:103], a[4:7], v[152:155]
buffer_load_dwordx4 a[40:43], v4, s[40:43], s35 offen offset:0 sc1
v_mfma_f32_16x16x32_bf16 v[136:139], a[100:103], a[0:3], v[136:139]
ds_read_b128 a[132:135], v5 offset:58368
v_mfma_f32_16x16x32_bf16 v[140:143], a[104:107], a[0:3], v[140:143]
ds_read_b128 a[136:139], v5 offset:59392
v_mfma_f32_16x16x32_bf16 v[156:159], a[104:107], a[4:7], v[156:159]
ds_read_b128 a[140:143], v5 offset:60416
v_mfma_f32_16x16x32_bf16 v[160:163], a[108:111], a[4:7], v[160:163]
buffer_load_dwordx4 a[44:47], v4, s[40:43], s35 offen offset:1024 sc1
v_mfma_f32_16x16x32_bf16 v[144:147], a[108:111], a[0:3], v[144:147]
s_waitcnt vmcnt(8) lgkmcnt(4)
v_mfma_f32_16x16x32_bf16 v[132:135], a[112:115], a[8:11], v[132:135]
s_cmp_eq_u32 s3, 2
s_cselect_b32 s35, 26, 18
s_lshl_b32 s35, s35, 12
v_mfma_f32_16x16x32_bf16 v[148:151], a[112:115], a[12:15], v[148:151]
ds_read_b128 a[96:99], v5 offset:61440
v_mfma_f32_16x16x32_bf16 v[152:155], a[116:119], a[12:15], v[152:155]
buffer_load_dwordx4 a[0:3], v4, s[40:43], s35 offen offset:0 sc1
v_mfma_f32_16x16x32_bf16 v[136:139], a[116:119], a[8:11], v[136:139]
ds_read_b128 a[100:103], v5 offset:62464
v_mfma_f32_16x16x32_bf16 v[140:143], a[120:123], a[8:11], v[140:143]
ds_read_b128 a[104:107], v5 offset:63488
v_mfma_f32_16x16x32_bf16 v[156:159], a[120:123], a[12:15], v[156:159]
ds_read_b128 a[108:111], v5 offset:64512
v_mfma_f32_16x16x32_bf16 v[160:163], a[124:127], a[12:15], v[160:163]
buffer_load_dwordx4 a[4:7], v4, s[40:43], s35 offen offset:1024 sc1
v_mfma_f32_16x16x32_bf16 v[144:147], a[124:127], a[8:11], v[144:147]
s_waitcnt vmcnt(8) lgkmcnt(4)
v_mfma_f32_16x16x32_bf16 v[132:135], a[128:131], a[16:19], v[132:135]
s_cmp_eq_u32 s3, 3
s_cselect_b32 s35, 27, 19
s_lshl_b32 s35, s35, 12
v_mfma_f32_16x16x32_bf16 v[148:151], a[128:131], a[20:23], v[148:151]
ds_read_b128 a[112:115], v6 offset:0
v_mfma_f32_16x16x32_bf16 v[152:155], a[132:135], a[20:23], v[152:155]
buffer_load_dwordx4 a[8:11], v4, s[40:43], s35 offen offset:0 sc1
v_mfma_f32_16x16x32_bf16 v[136:139], a[132:135], a[16:19], v[136:139]
ds_read_b128 a[116:119], v6 offset:1024
v_mfma_f32_16x16x32_bf16 v[140:143], a[136:139], a[16:19], v[140:143]
ds_read_b128 a[120:123], v6 offset:2048
v_mfma_f32_16x16x32_bf16 v[156:159], a[136:139], a[20:23], v[156:159]
ds_read_b128 a[124:127], v6 offset:3072
v_mfma_f32_16x16x32_bf16 v[160:163], a[140:143], a[20:23], v[160:163]
buffer_load_dwordx4 a[12:15], v4, s[40:43], s35 offen offset:1024 sc1
v_mfma_f32_16x16x32_bf16 v[144:147], a[140:143], a[16:19], v[144:147]
s_waitcnt vmcnt(8) lgkmcnt(4)
v_mfma_f32_16x16x32_bf16 v[132:135], a[96:99], a[24:27], v[132:135]
s_cmp_eq_u32 s3, 4
s_cselect_b32 s35, 28, 20
s_lshl_b32 s35, s35, 12
v_mfma_f32_16x16x32_bf16 v[148:151], a[96:99], a[28:31], v[148:151]
ds_read_b128 a[128:131], v6 offset:4096
v_mfma_f32_16x16x32_bf16 v[152:155], a[100:103], a[28:31], v[152:155]
buffer_load_dwordx4 a[16:19], v4, s[40:43], s35 offen offset:0 sc1
v_mfma_f32_16x16x32_bf16 v[136:139], a[100:103], a[24:27], v[136:139]
ds_read_b128 a[132:135], v6 offset:5120
v_mfma_f32_16x16x32_bf16 v[140:143], a[104:107], a[24:27], v[140:143]
ds_read_b128 a[136:139], v6 offset:6144
v_mfma_f32_16x16x32_bf16 v[156:159], a[104:107], a[28:31], v[156:159]
ds_read_b128 a[140:143], v6 offset:7168
v_mfma_f32_16x16x32_bf16 v[160:163], a[108:111], a[28:31], v[160:163]
buffer_load_dwordx4 a[20:23], v4, s[40:43], s35 offen offset:1024 sc1
v_mfma_f32_16x16x32_bf16 v[144:147], a[108:111], a[24:27], v[144:147]
s_waitcnt vmcnt(8) lgkmcnt(4)
v_mfma_f32_16x16x32_bf16 v[132:135], a[112:115], a[32:35], v[132:135]
s_cmp_eq_u32 s3, 5
s_cselect_b32 s35, 29, 21
s_lshl_b32 s35, s35, 12
v_mfma_f32_16x16x32_bf16 v[148:151], a[112:115], a[36:39], v[148:151]
ds_read_b128 a[96:99], v6 offset:8192
v_mfma_f32_16x16x32_bf16 v[152:155], a[116:119], a[36:39], v[152:155]
buffer_load_dwordx4 a[24:27], v4, s[40:43], s35 offen offset:0 sc1
v_mfma_f32_16x16x32_bf16 v[136:139], a[116:119], a[32:35], v[136:139]
ds_read_b128 a[100:103], v6 offset:9216
v_mfma_f32_16x16x32_bf16 v[140:143], a[120:123], a[32:35], v[140:143]
ds_read_b128 a[104:107], v6 offset:10240
v_mfma_f32_16x16x32_bf16 v[156:159], a[120:123], a[36:39], v[156:159]
ds_read_b128 a[108:111], v6 offset:11264
v_mfma_f32_16x16x32_bf16 v[160:163], a[124:127], a[36:39], v[160:163]
buffer_load_dwordx4 a[28:31], v4, s[40:43], s35 offen offset:1024 sc1
v_mfma_f32_16x16x32_bf16 v[144:147], a[124:127], a[32:35], v[144:147]
s_waitcnt vmcnt(8) lgkmcnt(4)
v_mfma_f32_16x16x32_bf16 v[132:135], a[128:131], a[40:43], v[132:135]
s_cmp_eq_u32 s3, 6
s_cselect_b32 s35, 30, 22
s_lshl_b32 s35, s35, 12
v_mfma_f32_16x16x32_bf16 v[148:151], a[128:131], a[44:47], v[148:151]
ds_read_b128 a[112:115], v6 offset:12288
v_mfma_f32_16x16x32_bf16 v[152:155], a[132:135], a[44:47], v[152:155]
buffer_load_dwordx4 a[32:35], v4, s[40:43], s35 offen offset:0 sc1
v_mfma_f32_16x16x32_bf16 v[136:139], a[132:135], a[40:43], v[136:139]
ds_read_b128 a[116:119], v6 offset:13312
v_mfma_f32_16x16x32_bf16 v[140:143], a[136:139], a[40:43], v[140:143]
ds_read_b128 a[120:123], v6 offset:14336
v_mfma_f32_16x16x32_bf16 v[156:159], a[136:139], a[44:47], v[156:159]
ds_read_b128 a[124:127], v6 offset:15360
v_mfma_f32_16x16x32_bf16 v[160:163], a[140:143], a[44:47], v[160:163]
buffer_load_dwordx4 a[36:39], v4, s[40:43], s35 offen offset:1024 sc1
v_mfma_f32_16x16x32_bf16 v[144:147], a[140:143], a[40:43], v[144:147]
s_waitcnt vmcnt(8) lgkmcnt(4)
v_mfma_f32_16x16x32_bf16 v[132:135], a[96:99], a[0:3], v[132:135]
s_cmp_eq_u32 s3, 7
s_cselect_b32 s35, 31, 23
s_lshl_b32 s35, s35, 12
v_mfma_f32_16x16x32_bf16 v[148:151], a[96:99], a[4:7], v[148:151]
ds_read_b128 a[128:131], v6 offset:16384
v_mfma_f32_16x16x32_bf16 v[152:155], a[100:103], a[4:7], v[152:155]
buffer_load_dwordx4 a[40:43], v4, s[40:43], s35 offen offset:0 sc1
v_mfma_f32_16x16x32_bf16 v[136:139], a[100:103], a[0:3], v[136:139]
ds_read_b128 a[132:135], v6 offset:17408
v_mfma_f32_16x16x32_bf16 v[140:143], a[104:107], a[0:3], v[140:143]
ds_read_b128 a[136:139], v6 offset:18432
v_mfma_f32_16x16x32_bf16 v[156:159], a[104:107], a[4:7], v[156:159]
ds_read_b128 a[140:143], v6 offset:19456
v_mfma_f32_16x16x32_bf16 v[160:163], a[108:111], a[4:7], v[160:163]
buffer_load_dwordx4 a[44:47], v4, s[40:43], s35 offen offset:1024 sc1
v_mfma_f32_16x16x32_bf16 v[144:147], a[108:111], a[0:3], v[144:147]
s_waitcnt vmcnt(8) lgkmcnt(4)
v_mfma_f32_16x16x32_bf16 v[132:135], a[112:115], a[8:11], v[132:135]
s_cmp_eq_u32 s3, 0
s_cselect_b32 s35, 0, 24
s_lshl_b32 s35, s35, 12
v_mfma_f32_16x16x32_bf16 v[148:151], a[112:115], a[12:15], v[148:151]
ds_read_b128 a[96:99], v6 offset:20480
v_mfma_f32_16x16x32_bf16 v[152:155], a[116:119], a[12:15], v[152:155]
buffer_load_dwordx4 a[0:3], v4, s[40:43], s35 offen offset:0 sc1
v_mfma_f32_16x16x32_bf16 v[136:139], a[116:119], a[8:11], v[136:139]
ds_read_b128 a[100:103], v6 offset:21504
v_mfma_f32_16x16x32_bf16 v[140:143], a[120:123], a[8:11], v[140:143]
ds_read_b128 a[104:107], v6 offset:22528
v_mfma_f32_16x16x32_bf16 v[156:159], a[120:123], a[12:15], v[156:159]
ds_read_b128 a[108:111], v6 offset:23552
v_mfma_f32_16x16x32_bf16 v[160:163], a[124:127], a[12:15], v[160:163]
buffer_load_dwordx4 a[4:7], v4, s[40:43], s35 offen offset:1024 sc1
v_mfma_f32_16x16x32_bf16 v[144:147], a[124:127], a[8:11], v[144:147]
s_waitcnt vmcnt(8) lgkmcnt(4)
v_mfma_f32_16x16x32_bf16 v[132:135], a[128:131], a[16:19], v[132:135]
s_cmp_eq_u32 s3, 1
s_cselect_b32 s35, 1, 25
s_lshl_b32 s35, s35, 12
v_mfma_f32_16x16x32_bf16 v[148:151], a[128:131], a[20:23], v[148:151]
ds_read_b128 a[112:115], v6 offset:24576
v_mfma_f32_16x16x32_bf16 v[152:155], a[132:135], a[20:23], v[152:155]
buffer_load_dwordx4 a[8:11], v4, s[40:43], s35 offen offset:0 sc1
v_mfma_f32_16x16x32_bf16 v[136:139], a[132:135], a[16:19], v[136:139]
ds_read_b128 a[116:119], v6 offset:25600
v_mfma_f32_16x16x32_bf16 v[140:143], a[136:139], a[16:19], v[140:143]
ds_read_b128 a[120:123], v6 offset:26624
v_mfma_f32_16x16x32_bf16 v[156:159], a[136:139], a[20:23], v[156:159]
ds_read_b128 a[124:127], v6 offset:27648
v_mfma_f32_16x16x32_bf16 v[160:163], a[140:143], a[20:23], v[160:163]
buffer_load_dwordx4 a[12:15], v4, s[40:43], s35 offen offset:1024 sc1
v_mfma_f32_16x16x32_bf16 v[144:147], a[140:143], a[16:19], v[144:147]
s_waitcnt vmcnt(8) lgkmcnt(4)
v_mfma_f32_16x16x32_bf16 v[132:135], a[96:99], a[24:27], v[132:135]
s_cmp_eq_u32 s3, 2
s_cselect_b32 s35, 2, 26
s_lshl_b32 s35, s35, 12
v_mfma_f32_16x16x32_bf16 v[148:151], a[96:99], a[28:31], v[148:151]
ds_read_b128 a[128:131], v6 offset:28672
v_mfma_f32_16x16x32_bf16 v[152:155], a[100:103], a[28:31], v[152:155]
buffer_load_dwordx4 a[16:19], v4, s[40:43], s35 offen offset:0 sc1
v_mfma_f32_16x16x32_bf16 v[136:139], a[100:103], a[24:27], v[136:139]
ds_read_b128 a[132:135], v6 offset:29696
v_mfma_f32_16x16x32_bf16 v[140:143], a[104:107], a[24:27], v[140:143]
ds_read_b128 a[136:139], v6 offset:30720
v_mfma_f32_16x16x32_bf16 v[156:159], a[104:107], a[28:31], v[156:159]
ds_read_b128 a[140:143], v6 offset:31744
v_mfma_f32_16x16x32_bf16 v[160:163], a[108:111], a[28:31], v[160:163]
buffer_load_dwordx4 a[20:23], v4, s[40:43], s35 offen offset:1024 sc1
v_mfma_f32_16x16x32_bf16 v[144:147], a[108:111], a[24:27], v[144:147]
s_waitcnt vmcnt(8) lgkmcnt(4)
v_mfma_f32_16x16x32_bf16 v[132:135], a[112:115], a[32:35], v[132:135]
s_cmp_eq_u32 s3, 3
s_cselect_b32 s35, 3, 27
s_lshl_b32 s35, s35, 12
v_mfma_f32_16x16x32_bf16 v[148:151], a[112:115], a[36:39], v[148:151]
ds_read_b128 a[96:99], v6 offset:32768
v_mfma_f32_16x16x32_bf16 v[152:155], a[116:119], a[36:39], v[152:155]
buffer_load_dwordx4 a[24:27], v4, s[40:43], s35 offen offset:0 sc1
v_mfma_f32_16x16x32_bf16 v[136:139], a[116:119], a[32:35], v[136:139]
ds_read_b128 a[100:103], v6 offset:33792
v_mfma_f32_16x16x32_bf16 v[140:143], a[120:123], a[32:35], v[140:143]
ds_read_b128 a[104:107], v6 offset:34816
v_mfma_f32_16x16x32_bf16 v[156:159], a[120:123], a[36:39], v[156:159]
ds_read_b128 a[108:111], v6 offset:35840
v_mfma_f32_16x16x32_bf16 v[160:163], a[124:127], a[36:39], v[160:163]
buffer_load_dwordx4 a[28:31], v4, s[40:43], s35 offen offset:1024 sc1
v_mfma_f32_16x16x32_bf16 v[144:147], a[124:127], a[32:35], v[144:147]
s_waitcnt vmcnt(8) lgkmcnt(4)
v_mfma_f32_16x16x32_bf16 v[132:135], a[128:131], a[40:43], v[132:135]
s_cmp_eq_u32 s3, 4
s_cselect_b32 s35, 4, 28
s_lshl_b32 s35, s35, 12
v_mfma_f32_16x16x32_bf16 v[148:151], a[128:131], a[44:47], v[148:151]
ds_read_b128 a[112:115], v6 offset:36864
v_mfma_f32_16x16x32_bf16 v[152:155], a[132:135], a[44:47], v[152:155]
buffer_load_dwordx4 a[32:35], v4, s[40:43], s35 offen offset:0 sc1
v_mfma_f32_16x16x32_bf16 v[136:139], a[132:135], a[40:43], v[136:139]
ds_read_b128 a[116:119], v6 offset:37888
v_mfma_f32_16x16x32_bf16 v[140:143], a[136:139], a[40:43], v[140:143]
ds_read_b128 a[120:123], v6 offset:38912
v_mfma_f32_16x16x32_bf16 v[156:159], a[136:139], a[44:47], v[156:159]
ds_read_b128 a[124:127], v6 offset:39936
v_mfma_f32_16x16x32_bf16 v[160:163], a[140:143], a[44:47], v[160:163]
buffer_load_dwordx4 a[36:39], v4, s[40:43], s35 offen offset:1024 sc1
v_mfma_f32_16x16x32_bf16 v[144:147], a[140:143], a[40:43], v[144:147]
s_waitcnt vmcnt(8) lgkmcnt(4)
v_mfma_f32_16x16x32_bf16 v[132:135], a[96:99], a[0:3], v[132:135]
s_cmp_eq_u32 s3, 5
s_cselect_b32 s35, 5, 29
s_lshl_b32 s35, s35, 12
v_mfma_f32_16x16x32_bf16 v[148:151], a[96:99], a[4:7], v[148:151]
ds_read_b128 a[128:131], v6 offset:40960
v_mfma_f32_16x16x32_bf16 v[152:155], a[100:103], a[4:7], v[152:155]
buffer_load_dwordx4 a[40:43], v4, s[40:43], s35 offen offset:0 sc1
v_mfma_f32_16x16x32_bf16 v[136:139], a[100:103], a[0:3], v[136:139]
ds_read_b128 a[132:135], v6 offset:41984
v_mfma_f32_16x16x32_bf16 v[140:143], a[104:107], a[0:3], v[140:143]
ds_read_b128 a[136:139], v6 offset:43008
v_mfma_f32_16x16x32_bf16 v[156:159], a[104:107], a[4:7], v[156:159]
ds_read_b128 a[140:143], v6 offset:44032
v_mfma_f32_16x16x32_bf16 v[160:163], a[108:111], a[4:7], v[160:163]
buffer_load_dwordx4 a[44:47], v4, s[40:43], s35 offen offset:1024 sc1
v_mfma_f32_16x16x32_bf16 v[144:147], a[108:111], a[0:3], v[144:147]
s_waitcnt vmcnt(8) lgkmcnt(4)
v_mfma_f32_16x16x32_bf16 v[132:135], a[112:115], a[8:11], v[132:135]
s_cmp_eq_u32 s3, 6
s_cselect_b32 s35, 6, 30
s_lshl_b32 s35, s35, 12
v_mfma_f32_16x16x32_bf16 v[148:151], a[112:115], a[12:15], v[148:151]
ds_read_b128 a[96:99], v6 offset:45056
v_mfma_f32_16x16x32_bf16 v[152:155], a[116:119], a[12:15], v[152:155]
buffer_load_dwordx4 a[0:3], v4, s[40:43], s35 offen offset:0 sc1
v_mfma_f32_16x16x32_bf16 v[136:139], a[116:119], a[8:11], v[136:139]
ds_read_b128 a[100:103], v6 offset:46080
v_mfma_f32_16x16x32_bf16 v[140:143], a[120:123], a[8:11], v[140:143]
ds_read_b128 a[104:107], v6 offset:47104
v_mfma_f32_16x16x32_bf16 v[156:159], a[120:123], a[12:15], v[156:159]
ds_read_b128 a[108:111], v6 offset:48128
v_mfma_f32_16x16x32_bf16 v[160:163], a[124:127], a[12:15], v[160:163]
buffer_load_dwordx4 a[4:7], v4, s[40:43], s35 offen offset:1024 sc1
v_mfma_f32_16x16x32_bf16 v[144:147], a[124:127], a[8:11], v[144:147]
s_waitcnt vmcnt(8) lgkmcnt(4)
v_mfma_f32_16x16x32_bf16 v[132:135], a[128:131], a[16:19], v[132:135]
s_cmp_eq_u32 s3, 7
s_cselect_b32 s35, 7, 31
s_lshl_b32 s35, s35, 12
v_mfma_f32_16x16x32_bf16 v[148:151], a[128:131], a[20:23], v[148:151]
ds_read_b128 a[112:115], v6 offset:49152
v_mfma_f32_16x16x32_bf16 v[152:155], a[132:135], a[20:23], v[152:155]
buffer_load_dwordx4 a[8:11], v4, s[40:43], s35 offen offset:0 sc1
v_mfma_f32_16x16x32_bf16 v[136:139], a[132:135], a[16:19], v[136:139]
ds_read_b128 a[116:119], v6 offset:50176
v_mfma_f32_16x16x32_bf16 v[140:143], a[136:139], a[16:19], v[140:143]
ds_read_b128 a[120:123], v6 offset:51200
v_mfma_f32_16x16x32_bf16 v[156:159], a[136:139], a[20:23], v[156:159]
ds_read_b128 a[124:127], v6 offset:52224
v_mfma_f32_16x16x32_bf16 v[160:163], a[140:143], a[20:23], v[160:163]
buffer_load_dwordx4 a[12:15], v4, s[40:43], s35 offen offset:1024 sc1
v_mfma_f32_16x16x32_bf16 v[144:147], a[140:143], a[16:19], v[144:147]
s_waitcnt vmcnt(8) lgkmcnt(4)
v_mfma_f32_16x16x32_bf16 v[132:135], a[96:99], a[24:27], v[132:135]
s_add_u32 m0, s18, 0x0
s_add_u32 s44, s50, 0xe00000
v_mfma_f32_16x16x32_bf16 v[148:151], a[96:99], a[28:31], v[148:151]
ds_read_b128 a[128:131], v6 offset:53248
v_mfma_f32_16x16x32_bf16 v[152:155], a[100:103], a[28:31], v[152:155]
buffer_load_dwordx4 v1, s[4:7], s44 offen offset:0 sc1 lds
v_mfma_f32_16x16x32_bf16 v[136:139], a[100:103], a[24:27], v[136:139]
ds_read_b128 a[132:135], v6 offset:54272
v_mfma_f32_16x16x32_bf16 v[140:143], a[104:107], a[24:27], v[140:143]
ds_read_b128 a[136:139], v6 offset:55296
v_mfma_f32_16x16x32_bf16 v[156:159], a[104:107], a[28:31], v[156:159]
ds_read_b128 a[140:143], v6 offset:56320
v_mfma_f32_16x16x32_bf16 v[160:163], a[108:111], a[28:31], v[160:163]
buffer_load_dwordx4 v1, s[4:7], s44 offen offset:1024 sc1 lds
v_mfma_f32_16x16x32_bf16 v[144:147], a[108:111], a[24:27], v[144:147]
s_waitcnt vmcnt(8) lgkmcnt(4)
v_mfma_f32_16x16x32_bf16 v[132:135], a[112:115], a[32:35], v[132:135]
ds_read_b128 a[96:99], v6 offset:57344
v_mfma_f32_16x16x32_bf16 v[148:151], a[112:115], a[36:39], v[148:151]
ds_read_b128 a[100:103], v6 offset:58368
v_mfma_f32_16x16x32_bf16 v[152:155], a[116:119], a[36:39], v[152:155]
buffer_load_dwordx4 v1, s[4:7], s44 offen offset:2048 sc1 lds
s_add_u32 m0, s18, 0x3000
v_mfma_f32_16x16x32_bf16 v[136:139], a[116:119], a[32:35], v[136:139]
s_add_u32 s44, s50, 0xe03000
ds_read_b128 a[104:107], v6 offset:59392
v_mfma_f32_16x16x32_bf16 v[140:143], a[120:123], a[32:35], v[140:143]
ds_read_b128 a[108:111], v6 offset:60416
v_mfma_f32_16x16x32_bf16 v[156:159], a[120:123], a[36:39], v[156:159]
v_mfma_f32_16x16x32_bf16 v[160:163], a[124:127], a[36:39], v[160:163]
v_mfma_f32_16x16x32_bf16 v[144:147], a[124:127], a[32:35], v[144:147]
buffer_load_dwordx4 v1, s[4:7], s44 offen offset:0 sc1 lds
s_waitcnt vmcnt(8) lgkmcnt(4)
v_mfma_f32_16x16x32_bf16 v[132:135], a[128:131], a[40:43], v[132:135]
ds_read_b128 a[112:115], v6 offset:61440
v_mfma_f32_16x16x32_bf16 v[148:151], a[128:131], a[44:47], v[148:151]
ds_read_b128 a[116:119], v6 offset:62464
v_mfma_f32_16x16x32_bf16 v[152:155], a[132:135], a[44:47], v[152:155]
ds_read_b128 a[120:123], v6 offset:63488
v_mfma_f32_16x16x32_bf16 v[136:139], a[132:135], a[40:43], v[136:139]
ds_read_b128 a[124:127], v6 offset:64512
v_mfma_f32_16x16x32_bf16 v[140:143], a[136:139], a[40:43], v[140:143]
buffer_load_dwordx4 v1, s[4:7], s44 offen offset:1024 sc1 lds
v_mfma_f32_16x16x32_bf16 v[156:159], a[136:139], a[44:47], v[156:159]
v_mfma_f32_16x16x32_bf16 v[160:163], a[140:143], a[44:47], v[160:163]
v_mfma_f32_16x16x32_bf16 v[144:147], a[140:143], a[40:43], v[144:147]
s_waitcnt vmcnt(7) lgkmcnt(4)
v_mfma_f32_16x16x32_bf16 v[132:135], a[96:99], a[0:3], v[132:135]
v_mfma_f32_16x16x32_bf16 v[148:151], a[96:99], a[4:7], v[148:151]
buffer_load_dwordx4 v1, s[4:7], s44 offen offset:2048 sc1 lds
v_mfma_f32_16x16x32_bf16 v[152:155], a[100:103], a[4:7], v[152:155]
v_mfma_f32_16x16x32_bf16 v[136:139], a[100:103], a[0:3], v[136:139]
v_mfma_f32_16x16x32_bf16 v[140:143], a[104:107], a[0:3], v[140:143]
v_mfma_f32_16x16x32_bf16 v[156:159], a[104:107], a[4:7], v[156:159]
v_mfma_f32_16x16x32_bf16 v[160:163], a[108:111], a[4:7], v[160:163]
v_mfma_f32_16x16x32_bf16 v[144:147], a[108:111], a[0:3], v[144:147]
s_waitcnt vmcnt(6) lgkmcnt(0)
v_mfma_f32_16x16x32_bf16 v[132:135], a[112:115], a[8:11], v[132:135]
v_mfma_f32_16x16x32_bf16 v[148:151], a[112:115], a[12:15], v[148:151]
v_mfma_f32_16x16x32_bf16 v[152:155], a[116:119], a[12:15], v[152:155]
buffer_atomic_add v12, v10, s[4:7], s92 offen sc1
v_mfma_f32_16x16x32_bf16 v[136:139], a[116:119], a[8:11], v[136:139]
v_mfma_f32_16x16x32_bf16 v[140:143], a[120:123], a[8:11], v[140:143]
v_mfma_f32_16x16x32_bf16 v[156:159], a[120:123], a[12:15], v[156:159]
v_mfma_f32_16x16x32_bf16 v[160:163], a[124:127], a[12:15], v[160:163]
v_mfma_f32_16x16x32_bf16 v[144:147], a[124:127], a[8:11], v[144:147]
s_nop 0
v_cmp_u_f32 vcc, v132, v148
s_nop 0
s_and_b32 vcc_lo, vcc_lo, s95
s_cbranch_scc1 L_k2redo1
s_lshl_b32 s36, s32, 13
v_cvt_pk_bf16_f32 v32, v132, v133
v_cvt_pk_bf16_f32 v33, v134, v135
v_cvt_pk_bf16_f32 v34, v136, v137
v_cvt_pk_bf16_f32 v35, v138, v139
s_add_u32 s36, s36, 0x0
buffer_store_dwordx4 v[32:35], v4, s[12:15], s36 offen offset:0 sc1
v_cvt_pk_bf16_f32 v40, v148, v149
v_cvt_pk_bf16_f32 v41, v150, v151
v_cvt_pk_bf16_f32 v42, v152, v153
v_cvt_pk_bf16_f32 v43, v154, v155
v_cvt_pk_bf16_f32 v36, v140, v141
v_cvt_pk_bf16_f32 v37, v142, v143
v_cvt_pk_bf16_f32 v38, v144, v145
v_cvt_pk_bf16_f32 v39, v146, v147
s_add_u32 s37, s36, 4096
v_cvt_pk_bf16_f32 v44, v156, v157
v_cvt_pk_bf16_f32 v45, v158, v159
v_cvt_pk_bf16_f32 v46, v160, v161
buffer_store_dwordx4 v[40:43], v4, s[12:15], s36 offen offset:1024 sc1
v_cvt_pk_bf16_f32 v47, v162, v163
v_mfma_f32_16x16x32_bf16 v[96:99], v[32:35], v[32:35], 0
s_mov_b32 s38, 0x280000
s_add_u32 s92, s78, 0x50000
v_mfma_f32_16x16x32_bf16 v[92:95], v[16:19], v[32:35], 0
s_add_u32 s93, s79, 0x50000
s_mov_b64 s[40:41], s[12:13]
v_mfma_f32_16x16x32_bf16 v[96:99], v[36:39], v[36:39], v[96:99]
buffer_store_dwordx4 v[36:39], v4, s[12:15], s37 offen offset:0 sc1
v_mfma_f32_16x16x32_bf16 v[92:95], v[16:19], v[36:39], v[92:95]
s_nop 5
v_cndmask_b32 v96, v96, v97, s[46:47]
v_cndmask_b32 v98, v98, v99, s[46:47]
v_mfma_f32_16x16x32_bf16 v[104:107], v[40:43], v[40:43], 0
v_mfma_f32_16x16x32_bf16 v[100:103], v[16:19], v[40:43], 0
v_cndmask_b32 v93, v96, v98, s[48:49]
buffer_store_dwordx4 v[44:47], v4, s[12:15], s37 offen offset:1024 sc1
v_mfma_f32_16x16x32_bf16 v[104:107], v[44:47], v[44:47], v[104:107]
v_mfma_f32_16x16x32_bf16 v[100:103], v[16:19], v[44:47], v[100:103]
s_nop 6
v_cndmask_b32 v104, v104, v105, s[46:47]
v_cndmask_b32 v106, v106, v107, s[46:47]
buffer_store_dwordx2 v[92:93], v253, s[4:7], s38 offen offset:0 sc1
v_cndmask_b32 v101, v104, v106, s[48:49]
buffer_store_dwordx2 v[100:101], v253, s[4:7], s38 offen offset:2048 sc1
s_barrier
s_add_u32 m0, s18, 0x6000
s_add_u32 s44, s50, 0xe06000
buffer_load_dwordx4 v1, s[4:7], s44 offen offset:0 sc1 lds
buffer_load_dwordx4 v1, s[4:7], s44 offen offset:1024 sc1 lds
buffer_load_dwordx4 v1, s[4:7], s44 offen offset:2048 sc1 lds
s_add_u32 m0, s18, 0x9000
s_add_u32 s44, s50, 0xe09000
buffer_load_dwordx4 v1, s[4:7], s44 offen offset:0 sc1 lds
buffer_load_dwordx4 v1, s[4:7], s44 offen offset:1024 sc1 lds
buffer_load_dwordx4 v1, s[4:7], s44 offen offset:2048 sc1 lds
v_accvgpr_read_b32 v48, a188
v_accvgpr_read_b32 v49, a189
v_accvgpr_read_b32 v50, a190
v_accvgpr_read_b32 v51, a191
v_accvgpr_read_b32 v52, a192
v_accvgpr_read_b32 v53, a193
v_accvgpr_read_b32 v54, a194
v_accvgpr_read_b32 v55, a195
v_accvgpr_read_b32 v56, a196
v_accvgpr_read_b32 v57, a197
v_accvgpr_read_b32 v58, a198
v_accvgpr_read_b32 v59, a199
v_accvgpr_read_b32 v60, a200
v_accvgpr_read_b32 v61, a201
v_accvgpr_read_b32 v62, a202
v_accvgpr_read_b32 v63, a203
v_accvgpr_read_b32 v64, a204
v_accvgpr_read_b32 v65, a205
v_accvgpr_read_b32 v66, a206
v_accvgpr_read_b32 v67, a207
v_accvgpr_read_b32 v68, a208
v_accvgpr_read_b32 v69, a209
v_accvgpr_read_b32 v70, a210
v_accvgpr_read_b32 v71, a211
v_accvgpr_read_b32 v72, a212
v_accvgpr_read_b32 v73, a213
v_accvgpr_read_b32 v74, a214
v_accvgpr_read_b32 v75, a215
s_waitcnt vmcnt(6)
s_barrier
s_cmp_lg_u32 s28, 1
s_cbranch_scc1 Lsg_25
buffer_atomic_add v12, v10, s[4:7], s92 offen sc1
buffer_atomic_add v12, v10, s[4:7], s93 offen sc1
Lsg_25:
s_mov_b64 exec, 0
s_cmp_eq_u32 s28, 1
s_cbranch_scc1 L_stub10
L_wret4:
s_mov_b64 exec, -1
s_cmp_lt_u32 s28, 2
s_cbranch_scc1 Lwd_26
s_add_u32 m0, s18, 0xa800
s_add_u32 s44, s50, 0xe0a800
buffer_load_dwordx4 v1, s[4:7], s44 offen offset:0 sc1 lds
buffer_load_dwordx4 v1, s[4:7], s44 offen offset:1024 sc1 lds
buffer_load_dwordx4 v1, s[4:7], s44 offen offset:2048 sc1 lds
s_add_u32 m0, s18, 0xc000
s_add_u32 s44, s50, 0xe0c000
buffer_load_dwordx4 v1, s[4:7], s44 offen offset:0 sc1 lds
buffer_load_dwordx4 v1, s[4:7], s44 offen offset:1024 sc1 lds
buffer_load_dwordx4 v1, s[4:7], s44 offen offset:2048 sc1 lds
s_add_u32 m0, s18, 0xd800
s_add_u32 s44, s50, 0xe0d800
buffer_load_dwordx4 v1, s[4:7], s44 offen offset:0 sc1 lds
buffer_load_dwordx4 v1, s[4:7], s44 offen offset:1024 sc1 lds
buffer_load_dwordx4 v1, s[4:7], s44 offen offset:2048 sc1 lds
s_add_u32 m0, s18, 0xf000
s_add_u32 s44, s50, 0xe0f000
buffer_load_dwordx4 v1, s[4:7], s44 offen offset:0 sc1 lds
buffer_load_dwordx4 v1, s[4:7], s44 offen offset:1024 sc1 lds
buffer_load_dwordx4 v1, s[4:7], s44 offen offset:2048 sc1 lds
s_add_u32 m0, s18, 0x10800
s_add_u32 s44, s50, 0xe10800
buffer_load_dwordx4 v1, s[4:7], s44 offen offset:0 sc1 lds
buffer_load_dwordx4 v1, s[4:7], s44 offen offset:1024 sc1 lds
buffer_load_dwordx4 v1, s[4:7], s44 offen offset:2048 sc1 lds
s_add_u32 m0, s18, 0x12000
s_add_u32 s44, s50, 0xe12000
buffer_load_dwordx4 v1, s[4:7], s44 offen offset:0 sc1 lds
buffer_load_dwordx4 v1, s[4:7], s44 offen offset:1024 sc1 lds
buffer_load_dwordx4 v1, s[4:7], s44 offen offset:2048 sc1 lds
s_add_u32 m0, s18, 0x13800
s_add_u32 s44, s50, 0xe13800
buffer_load_dwordx4 v1, s[4:7], s44 offen offset:0 sc1 lds
buffer_load_dwordx4 v1, s[4:7], s44 offen offset:1024 sc1 lds
buffer_load_dwordx4 v1, s[4:7], s44 offen offset:2048 sc1 lds
s_add_u32 m0, s18, 0x15000
s_add_u32 s44, s50, 0xe15000
buffer_load_dwordx4 v1, s[4:7], s44 offen offset:0 sc1 lds
buffer_load_dwordx4 v1, s[4:7], s44 offen offset:1024 sc1 lds
buffer_load_dwordx4 v1, s[4:7], s44 offen offset:2048 sc1 lds
s_add_u32 m0, s18, 0x16800
s_add_u32 s44, s50, 0xe16800
buffer_load_dwordx4 v1, s[4:7], s44 offen offset:0 sc1 lds
buffer_load_dwordx4 v1, s[4:7], s44 offen offset:1024 sc1 lds
buffer_load_dwordx4 v1, s[4:7], s44 offen offset:2048 sc1 lds
s_add_u32 m0, s18, 0x18000
s_add_u32 s44, s50, 0xe18000
buffer_load_dwordx4 v1, s[4:7], s44 offen offset:0 sc1 lds
buffer_load_dwordx4 v1, s[4:7], s44 offen offset:1024 sc1 lds
buffer_load_dwordx4 v1, s[4:7], s44 offen offset:2048 sc1 lds
s_add_u32 m0, s18, 0x19800
s_add_u32 s44, s50, 0xe19800
buffer_load_dwordx4 v1, s[4:7], s44 offen offset:0 sc1 lds
buffer_load_dwordx4 v1, s[4:7], s44 offen offset:1024 sc1 lds
buffer_load_dwordx4 v1, s[4:7], s44 offen offset:2048 sc1 lds
s_add_u32 m0, s18, 0x1b000
s_add_u32 s44, s50, 0xe1b000
buffer_load_dwordx4 v1, s[4:7], s44 offen offset:0 sc1 lds
buffer_load_dwordx4 v1, s[4:7], s44 offen offset:1024 sc1 lds
buffer_load_dwordx4 v1, s[4:7], s44 offen offset:2048 sc1 lds
Lwd_26:
s_cmp_lg_u32 s28, 0
s_cbranch_scc1 Lpo_29
s_add_u32 s36, s67, 0x50000
s_mov_b32 s37, 0
v_mov_b32 v11, 0
buffer_atomic_add v11, v251, s[4:7], s36 offen sc0 sc1
s_sleep 4
Lpoll_27:
v_mov_b32 v234, 0
buffer_atomic_add v234, v251, s[4:7], s36 offen sc0 sc1
s_waitcnt vmcnt(1)
v_readfirstlane_b32 s38, v11
s_nop 0
s_cmp_ge_u32 s38, s54
s_cbranch_scc1 Lpe_28
v_mov_b32 v11, 0
buffer_atomic_add v11, v251, s[4:7], s36 offen sc0 sc1
s_waitcnt vmcnt(1)
v_readfirstlane_b32 s38, v234
L_stub10:
s_cbranch_execz L_stub11
s_nop 0
s_cmp_ge_u32 s38, s54
s_cbranch_scc1 Lpe_28
s_add_u32 s37, s37, 1
s_cmp_lt_u32 s37, 0x80000
s_cbranch_scc1 Lpoll_27
s_waitcnt vmcnt(0)
Lpo_29:
s_waitcnt vmcnt(36) lgkmcnt(0)
s_cmp_ge_u32 s28, 2
s_cbranch_scc1 Lw_30
s_waitcnt vmcnt(0)
Lw_30:
Lpe_28:
s_barrier
s_add_u32 s94, s71, 0x20080
s_add_u32 s9, s66, 0x20080
s_mov_b32 s35, 0
s_mov_b32 s33, 0x1000
buffer_load_dwordx4 a[0:3], v2, s[40:43], s35 offen offset:0 sc1
buffer_load_dwordx4 a[4:7], v2, s[40:43], s33 offen offset:0 sc1
buffer_load_dwordx4 a[8:11], v2, s[40:43], s35 offen offset:1024 sc1
buffer_load_dwordx4 a[12:15], v2, s[40:43], s33 offen offset:1024 sc1
buffer_load_dwordx4 a[16:19], v2, s[40:43], s35 offen offset:2048 sc1
buffer_load_dwordx4 a[20:23], v2, s[40:43], s33 offen offset:2048 sc1
buffer_load_dwordx4 a[24:27], v2, s[40:43], s35 offen offset:3072 sc1
buffer_load_dwordx4 a[28:31], v2, s[40:43], s33 offen offset:3072 sc1
s_add_u32 s35, s35, 8192
s_add_u32 s33, s33, 8192
s_add_u32 s63, s28, 0
s_lshl_b32 s63, s63, 12
buffer_load_dwordx4 a[160:163], v3, s[40:43], s63 offen sc1
buffer_load_dwordx4 a[32:35], v2, s[40:43], s35 offen offset:0 sc1
buffer_load_dwordx4 a[36:39], v2, s[40:43], s33 offen offset:0 sc1
buffer_load_dwordx4 a[40:43], v2, s[40:43], s35 offen offset:1024 sc1
buffer_load_dwordx4 a[44:47], v2, s[40:43], s33 offen offset:1024 sc1
buffer_load_dwordx4 a[48:51], v2, s[40:43], s35 offen offset:2048 sc1
buffer_load_dwordx4 a[52:55], v2, s[40:43], s33 offen offset:2048 sc1
buffer_load_dwordx4 a[56:59], v2, s[40:43], s35 offen offset:3072 sc1
buffer_load_dwordx4 a[60:63], v2, s[40:43], s33 offen offset:3072 sc1
s_add_u32 s35, s35, 8192
s_add_u32 s33, s33, 8192
v_add_u32 v5, 0, v1
v_add_u32 v6, s55, v5
ds_read_b128 a[96:99], v5 offset:2048
ds_read_b128 a[100:103], v5 offset:8192
ds_read_b128 a[104:107], v5 offset:3072
ds_read_b128 a[108:111], v5 offset:9216
ds_read_b128 a[112:115], v5 offset:4096
ds_read_b128 a[116:119], v5 offset:10240
ds_read_b128 a[120:123], v6 offset:2048
s_waitcnt vmcnt(15) lgkmcnt(5)
v_mfma_f32_16x16x32_bf16 v[140:143], a[96:99], a[0:3], 0
s_add_u32 s63, s28, 4
s_lshl_b32 s63, s63, 12
v_mfma_f32_16x16x32_bf16 v[140:143], a[100:103], a[4:7], v[140:143]
buffer_load_dwordx4 a[64:67], v2, s[40:43], s35 offen offset:0 sc1
s_waitcnt vmcnt(14)
v_mfma_f32_16x16x32_bf16 v[164:167], a[100:103], a[12:15], 0
ds_read_b128 a[128:131], v5 offset:5120
v_mfma_f32_16x16x32_bf16 v[164:167], a[96:99], a[8:11], v[164:167]
ds_read_b128 a[132:135], v5 offset:11264
s_waitcnt vmcnt(13)
v_mfma_f32_16x16x32_bf16 v[188:191], a[96:99], a[16:19], 0
ds_read_b128 a[136:139], v5 offset:0
s_waitcnt vmcnt(12)
v_mfma_f32_16x16x32_bf16 v[188:191], a[100:103], a[20:23], v[188:191]
s_waitcnt vmcnt(10)
v_mfma_f32_16x16x32_bf16 v[212:215], a[100:103], a[28:31], 0
buffer_load_dwordx4 a[68:71], v2, s[40:43], s33 offen offset:0 sc1
v_mfma_f32_16x16x32_bf16 v[212:215], a[96:99], a[24:27], v[212:215]
ds_read_b128 a[140:143], v5 offset:6144
s_waitcnt lgkmcnt(8)
v_mfma_f32_16x16x32_bf16 v[216:219], a[104:107], a[24:27], 0
s_waitcnt lgkmcnt(7)
v_mfma_f32_16x16x32_bf16 v[216:219], a[108:111], a[28:31], v[216:219]
ds_read_b128 a[144:147], v5 offset:1024
v_mfma_f32_16x16x32_bf16 v[192:195], a[108:111], a[20:23], 0
v_mfma_f32_16x16x32_bf16 v[192:195], a[104:107], a[16:19], v[192:195]
buffer_load_dwordx4 a[164:167], v3, s[40:43], s63 offen sc1
s_add_u32 m0, s18, 0x1e000
v_mfma_f32_16x16x32_bf16 v[168:171], a[104:107], a[8:11], 0
s_add_u32 s44, s50, 0xe1e000
ds_read_b128 a[148:151], v5 offset:7168
v_mfma_f32_16x16x32_bf16 v[168:171], a[108:111], a[12:15], v[168:171]
ds_read_b128 a[152:155], v6 offset:3072
v_mfma_f32_16x16x32_bf16 v[144:147], a[108:111], a[4:7], 0
v_mfma_f32_16x16x32_bf16 v[144:147], a[104:107], a[0:3], v[144:147]
s_waitcnt lgkmcnt(9)
v_mfma_f32_16x16x32_bf16 v[148:151], a[112:115], a[0:3], 0
buffer_load_dwordx4 a[72:75], v2, s[40:43], s35 offen offset:1024 sc1
s_waitcnt lgkmcnt(8)
v_mfma_f32_16x16x32_bf16 v[148:151], a[116:119], a[4:7], v[148:151]
v_mfma_f32_16x16x32_bf16 v[172:175], a[116:119], a[12:15], 0
v_mfma_f32_16x16x32_bf16 v[172:175], a[112:115], a[8:11], v[172:175]
v_mfma_f32_16x16x32_bf16 v[196:199], a[112:115], a[16:19], 0
v_mfma_f32_16x16x32_bf16 v[196:199], a[116:119], a[20:23], v[196:199]
buffer_load_dwordx4 a[76:79], v2, s[40:43], s33 offen offset:1024 sc1
v_mfma_f32_16x16x32_bf16 v[220:223], a[116:119], a[28:31], 0
v_mfma_f32_16x16x32_bf16 v[220:223], a[112:115], a[24:27], v[220:223]
s_waitcnt vmcnt(13) lgkmcnt(7)
v_mfma_f32_16x16x32_bf16 a[172:175], a[120:123], a[160:163], 0
s_waitcnt lgkmcnt(0)
v_mfma_f32_16x16x32_bf16 v[224:227], a[128:131], a[24:27], 0
ds_read_b128 a[96:99], v5 offset:14336
v_mfma_f32_16x16x32_bf16 v[224:227], a[132:135], a[28:31], v[224:227]
buffer_load_dwordx4 a[80:83], v2, s[40:43], s35 offen offset:2048 sc1
v_mfma_f32_16x16x32_bf16 v[200:203], a[132:135], a[20:23], 0
ds_read_b128 a[100:103], v5 offset:20480
v_mfma_f32_16x16x32_bf16 v[200:203], a[128:131], a[16:19], v[200:203]
v_mfma_f32_16x16x32_bf16 v[176:179], a[128:131], a[8:11], 0
ds_read_b128 a[104:107], v5 offset:15360
v_mfma_f32_16x16x32_bf16 v[176:179], a[132:135], a[12:15], v[176:179]
buffer_load_dwordx4 v1, s[4:7], s44 offen offset:0 sc1 lds
v_mfma_f32_16x16x32_bf16 v[152:155], a[132:135], a[4:7], 0
ds_read_b128 a[108:111], v5 offset:21504
v_mfma_f32_16x16x32_bf16 v[152:155], a[128:131], a[0:3], v[152:155]
v_mfma_f32_16x16x32_bf16 v[132:135], a[136:139], a[0:3], 0
v_mfma_f32_16x16x32_bf16 v[132:135], a[140:143], a[4:7], v[132:135]
buffer_load_dwordx4 a[84:87], v2, s[40:43], s33 offen offset:2048 sc1
v_mfma_f32_16x16x32_bf16 v[156:159], a[140:143], a[12:15], 0
ds_read_b128 a[112:115], v5 offset:16384
v_mfma_f32_16x16x32_bf16 v[156:159], a[136:139], a[8:11], v[156:159]
ds_read_b128 a[116:119], v5 offset:22528
v_mfma_f32_16x16x32_bf16 v[180:183], a[136:139], a[16:19], 0
v_mfma_f32_16x16x32_bf16 v[180:183], a[140:143], a[20:23], v[180:183]
buffer_load_dwordx4 a[88:91], v2, s[40:43], s35 offen offset:3072 sc1
v_mfma_f32_16x16x32_bf16 v[204:207], a[140:143], a[28:31], 0
ds_read_b128 a[120:123], v6 offset:4096
v_mfma_f32_16x16x32_bf16 v[204:207], a[136:139], a[24:27], v[204:207]
v_mfma_f32_16x16x32_bf16 v[208:211], a[144:147], a[24:27], 0
v_mfma_f32_16x16x32_bf16 v[208:211], a[148:151], a[28:31], v[208:211]
buffer_load_dwordx4 v1, s[4:7], s44 offen offset:1024 sc1 lds
v_mfma_f32_16x16x32_bf16 v[184:187], a[148:151], a[20:23], 0
v_mfma_f32_16x16x32_bf16 v[184:187], a[144:147], a[16:19], v[184:187]
v_mfma_f32_16x16x32_bf16 v[160:163], a[144:147], a[8:11], 0
v_mfma_f32_16x16x32_bf16 v[160:163], a[148:151], a[12:15], v[160:163]
buffer_load_dwordx4 a[92:95], v2, s[40:43], s33 offen offset:3072 sc1
s_add_u32 s35, s35, 8192
v_mfma_f32_16x16x32_bf16 v[136:139], a[148:151], a[4:7], 0
s_add_u32 s33, s33, 8192
v_mfma_f32_16x16x32_bf16 v[136:139], a[144:147], a[0:3], v[136:139]
v_mfma_f32_16x16x32_bf16 a[176:179], a[152:155], a[160:163], 0
s_waitcnt vmcnt(11) lgkmcnt(0)
v_mfma_f32_16x16x32_bf16 v[140:143], a[96:99], a[32:35], v[140:143]
ds_read_b128 a[128:131], v5 offset:17408
v_mfma_f32_16x16x32_bf16 v[140:143], a[100:103], a[36:39], v[140:143]
buffer_load_dwordx4 a[0:3], v2, s[40:43], s35 offen offset:0 sc1
v_mfma_f32_16x16x32_bf16 v[164:167], a[100:103], a[44:47], v[164:167]
ds_read_b128 a[132:135], v5 offset:23552
v_mfma_f32_16x16x32_bf16 v[164:167], a[96:99], a[40:43], v[164:167]
v_mfma_f32_16x16x32_bf16 v[188:191], a[96:99], a[48:51], v[188:191]
ds_read_b128 a[136:139], v5 offset:12288
v_mfma_f32_16x16x32_bf16 v[188:191], a[100:103], a[52:55], v[188:191]
buffer_load_dwordx4 v1, s[4:7], s44 offen offset:2048 sc1 lds
s_add_u32 m0, s18, 0x21000
v_mfma_f32_16x16x32_bf16 v[212:215], a[100:103], a[60:63], v[212:215]
s_add_u32 s44, s50, 0xe21000
ds_read_b128 a[140:143], v5 offset:18432
v_mfma_f32_16x16x32_bf16 v[212:215], a[96:99], a[56:59], v[212:215]
v_mfma_f32_16x16x32_bf16 v[216:219], a[104:107], a[56:59], v[216:219]
v_mfma_f32_16x16x32_bf16 v[216:219], a[108:111], a[60:63], v[216:219]
buffer_load_dwordx4 a[4:7], v2, s[40:43], s33 offen offset:0 sc1
v_mfma_f32_16x16x32_bf16 v[192:195], a[108:111], a[52:55], v[192:195]
ds_read_b128 a[144:147], v5 offset:13312
v_mfma_f32_16x16x32_bf16 v[192:195], a[104:107], a[48:51], v[192:195]
ds_read_b128 a[148:151], v5 offset:19456
v_mfma_f32_16x16x32_bf16 v[168:171], a[104:107], a[40:43], v[168:171]
v_mfma_f32_16x16x32_bf16 v[168:171], a[108:111], a[44:47], v[168:171]
buffer_load_dwordx4 a[8:11], v2, s[40:43], s35 offen offset:1024 sc1
v_mfma_f32_16x16x32_bf16 v[144:147], a[108:111], a[36:39], v[144:147]
ds_read_b128 a[152:155], v6 offset:5120
v_mfma_f32_16x16x32_bf16 v[144:147], a[104:107], a[32:35], v[144:147]
v_mfma_f32_16x16x32_bf16 v[148:151], a[112:115], a[32:35], v[148:151]
v_mfma_f32_16x16x32_bf16 v[148:151], a[116:119], a[36:39], v[148:151]
buffer_load_dwordx4 v1, s[4:7], s44 offen offset:0 sc1 lds
v_mfma_f32_16x16x32_bf16 v[172:175], a[116:119], a[44:47], v[172:175]
v_mfma_f32_16x16x32_bf16 v[172:175], a[112:115], a[40:43], v[172:175]
v_mfma_f32_16x16x32_bf16 v[196:199], a[112:115], a[48:51], v[196:199]
v_mfma_f32_16x16x32_bf16 v[196:199], a[116:119], a[52:55], v[196:199]
buffer_load_dwordx4 a[12:15], v2, s[40:43], s33 offen offset:1024 sc1
v_mfma_f32_16x16x32_bf16 v[220:223], a[116:119], a[60:63], v[220:223]
v_mfma_f32_16x16x32_bf16 v[220:223], a[112:115], a[56:59], v[220:223]
v_mfma_f32_16x16x32_bf16 a[180:183], a[120:123], a[160:163], 0
s_waitcnt lgkmcnt(0)
v_mfma_f32_16x16x32_bf16 v[224:227], a[128:131], a[56:59], v[224:227]
ds_read_b128 a[96:99], v5 offset:26624
v_mfma_f32_16x16x32_bf16 v[224:227], a[132:135], a[60:63], v[224:227]
buffer_load_dwordx4 a[16:19], v2, s[40:43], s35 offen offset:2048 sc1
v_mfma_f32_16x16x32_bf16 v[200:203], a[132:135], a[52:55], v[200:203]
ds_read_b128 a[100:103], v5 offset:32768
v_mfma_f32_16x16x32_bf16 v[200:203], a[128:131], a[48:51], v[200:203]
v_mfma_f32_16x16x32_bf16 v[176:179], a[128:131], a[40:43], v[176:179]
ds_read_b128 a[104:107], v5 offset:27648
v_mfma_f32_16x16x32_bf16 v[176:179], a[132:135], a[44:47], v[176:179]
v_mfma_f32_16x16x32_bf16 v[152:155], a[132:135], a[36:39], v[152:155]
buffer_load_dwordx4 a[20:23], v2, s[40:43], s33 offen offset:2048 sc1
v_mfma_f32_16x16x32_bf16 v[152:155], a[128:131], a[32:35], v[152:155]
ds_read_b128 a[108:111], v5 offset:33792
v_mfma_f32_16x16x32_bf16 v[132:135], a[136:139], a[32:35], v[132:135]
v_mfma_f32_16x16x32_bf16 v[132:135], a[140:143], a[36:39], v[132:135]
ds_read_b128 a[112:115], v5 offset:28672
v_mfma_f32_16x16x32_bf16 v[156:159], a[140:143], a[44:47], v[156:159]
v_mfma_f32_16x16x32_bf16 v[156:159], a[136:139], a[40:43], v[156:159]
buffer_load_dwordx4 v1, s[4:7], s44 offen offset:1024 sc1 lds
v_mfma_f32_16x16x32_bf16 v[180:183], a[136:139], a[48:51], v[180:183]
ds_read_b128 a[116:119], v5 offset:34816
v_mfma_f32_16x16x32_bf16 v[180:183], a[140:143], a[52:55], v[180:183]
ds_read_b128 a[120:123], v6 offset:26624
v_mfma_f32_16x16x32_bf16 v[204:207], a[140:143], a[60:63], v[204:207]
v_mfma_f32_16x16x32_bf16 v[204:207], a[136:139], a[56:59], v[204:207]
v_mfma_f32_16x16x32_bf16 v[208:211], a[144:147], a[56:59], v[208:211]
buffer_load_dwordx4 a[24:27], v2, s[40:43], s35 offen offset:3072 sc1
v_mfma_f32_16x16x32_bf16 v[208:211], a[148:151], a[60:63], v[208:211]
v_mfma_f32_16x16x32_bf16 v[184:187], a[148:151], a[52:55], v[184:187]
v_mfma_f32_16x16x32_bf16 v[184:187], a[144:147], a[48:51], v[184:187]
v_mfma_f32_16x16x32_bf16 v[160:163], a[144:147], a[40:43], v[160:163]
v_mfma_f32_16x16x32_bf16 v[160:163], a[148:151], a[44:47], v[160:163]
buffer_load_dwordx4 a[28:31], v2, s[40:43], s33 offen offset:3072 sc1
s_add_u32 s35, s35, 8192
v_mfma_f32_16x16x32_bf16 v[136:139], a[148:151], a[36:39], v[136:139]
s_add_u32 s33, s33, 8192
v_mfma_f32_16x16x32_bf16 v[136:139], a[144:147], a[32:35], v[136:139]
v_mfma_f32_16x16x32_bf16 a[184:187], a[152:155], a[160:163], 0
s_waitcnt vmcnt(11) lgkmcnt(0)
v_mfma_f32_16x16x32_bf16 v[140:143], a[96:99], a[64:67], v[140:143]
ds_read_b128 a[128:131], v5 offset:29696
v_mfma_f32_16x16x32_bf16 v[140:143], a[100:103], a[68:71], v[140:143]
buffer_load_dwordx4 a[32:35], v2, s[40:43], s35 offen offset:0 sc1
v_mfma_f32_16x16x32_bf16 v[164:167], a[100:103], a[76:79], v[164:167]
ds_read_b128 a[132:135], v5 offset:35840
v_mfma_f32_16x16x32_bf16 v[164:167], a[96:99], a[72:75], v[164:167]
v_mfma_f32_16x16x32_bf16 v[188:191], a[96:99], a[80:83], v[188:191]
ds_read_b128 a[136:139], v5 offset:24576
v_mfma_f32_16x16x32_bf16 v[188:191], a[100:103], a[84:87], v[188:191]
buffer_load_dwordx4 v1, s[4:7], s44 offen offset:2048 sc1 lds
s_add_u32 s63, s28, 8
v_mfma_f32_16x16x32_bf16 v[212:215], a[100:103], a[92:95], v[212:215]
s_lshl_b32 s63, s63, 12
ds_read_b128 a[140:143], v5 offset:30720
v_mfma_f32_16x16x32_bf16 v[212:215], a[96:99], a[88:91], v[212:215]
v_mfma_f32_16x16x32_bf16 v[216:219], a[104:107], a[88:91], v[216:219]
v_mfma_f32_16x16x32_bf16 v[216:219], a[108:111], a[92:95], v[216:219]
buffer_load_dwordx4 a[36:39], v2, s[40:43], s33 offen offset:0 sc1
v_mfma_f32_16x16x32_bf16 v[192:195], a[108:111], a[84:87], v[192:195]
ds_read_b128 a[144:147], v5 offset:25600
v_mfma_f32_16x16x32_bf16 v[192:195], a[104:107], a[80:83], v[192:195]
ds_read_b128 a[148:151], v5 offset:31744
v_mfma_f32_16x16x32_bf16 v[168:171], a[104:107], a[72:75], v[168:171]
v_mfma_f32_16x16x32_bf16 v[168:171], a[108:111], a[76:79], v[168:171]
buffer_load_dwordx4 a[40:43], v2, s[40:43], s35 offen offset:1024 sc1
v_mfma_f32_16x16x32_bf16 v[144:147], a[108:111], a[68:71], v[144:147]
ds_read_b128 a[152:155], v6 offset:27648
v_mfma_f32_16x16x32_bf16 v[144:147], a[104:107], a[64:67], v[144:147]
v_mfma_f32_16x16x32_bf16 v[148:151], a[112:115], a[64:67], v[148:151]
v_mfma_f32_16x16x32_bf16 v[148:151], a[116:119], a[68:71], v[148:151]
buffer_load_dwordx4 a[168:171], v3, s[40:43], s63 offen sc1
s_add_u32 s88, s82, 0x280000
v_mfma_f32_16x16x32_bf16 v[172:175], a[116:119], a[76:79], v[172:175]
v_mfma_f32_16x16x32_bf16 v[172:175], a[112:115], a[72:75], v[172:175]
v_mfma_f32_16x16x32_bf16 v[196:199], a[112:115], a[80:83], v[196:199]
v_mfma_f32_16x16x32_bf16 v[196:199], a[116:119], a[84:87], v[196:199]
buffer_load_dwordx4 a[44:47], v2, s[40:43], s33 offen offset:1024 sc1
v_mfma_f32_16x16x32_bf16 v[220:223], a[116:119], a[92:95], v[220:223]
v_mfma_f32_16x16x32_bf16 v[220:223], a[112:115], a[88:91], v[220:223]
v_mfma_f32_16x16x32_bf16 a[172:175], a[120:123], a[164:167], a[172:175]
s_waitcnt lgkmcnt(0)
v_mfma_f32_16x16x32_bf16 v[224:227], a[128:131], a[88:91], v[224:227]
ds_read_b128 a[96:99], v5 offset:38912
v_mfma_f32_16x16x32_bf16 v[224:227], a[132:135], a[92:95], v[224:227]
buffer_load_dwordx4 a[48:51], v2, s[40:43], s35 offen offset:2048 sc1
v_mfma_f32_16x16x32_bf16 v[200:203], a[132:135], a[84:87], v[200:203]
ds_read_b128 a[100:103], v5 offset:45056
v_mfma_f32_16x16x32_bf16 v[200:203], a[128:131], a[80:83], v[200:203]
v_mfma_f32_16x16x32_bf16 v[176:179], a[128:131], a[72:75], v[176:179]
ds_read_b128 a[104:107], v5 offset:39936
v_mfma_f32_16x16x32_bf16 v[176:179], a[132:135], a[76:79], v[176:179]
v_mfma_f32_16x16x32_bf16 v[152:155], a[132:135], a[68:71], v[152:155]
buffer_load_dwordx4 a[52:55], v2, s[40:43], s33 offen offset:2048 sc1
v_mfma_f32_16x16x32_bf16 v[152:155], a[128:131], a[64:67], v[152:155]
ds_read_b128 a[108:111], v5 offset:46080
v_mfma_f32_16x16x32_bf16 v[132:135], a[136:139], a[64:67], v[132:135]
v_mfma_f32_16x16x32_bf16 v[132:135], a[140:143], a[68:71], v[132:135]
ds_read_b128 a[112:115], v5 offset:40960
v_mfma_f32_16x16x32_bf16 v[156:159], a[140:143], a[76:79], v[156:159]
v_mfma_f32_16x16x32_bf16 v[156:159], a[136:139], a[72:75], v[156:159]
buffer_load_dwordx4 v[92:95], v1, s[4:7], s88 offen offset:0 sc1
v_mfma_f32_16x16x32_bf16 v[180:183], a[136:139], a[80:83], v[180:183]
ds_read_b128 a[116:119], v5 offset:47104
v_mfma_f32_16x16x32_bf16 v[180:183], a[140:143], a[84:87], v[180:183]
ds_read_b128 a[120:123], v6 offset:28672
v_mfma_f32_16x16x32_bf16 v[204:207], a[140:143], a[92:95], v[204:207]
v_mfma_f32_16x16x32_bf16 v[204:207], a[136:139], a[88:91], v[204:207]
v_mfma_f32_16x16x32_bf16 v[208:211], a[144:147], a[88:91], v[208:211]
buffer_load_dwordx4 a[56:59], v2, s[40:43], s35 offen offset:3072 sc1
v_mfma_f32_16x16x32_bf16 v[208:211], a[148:151], a[92:95], v[208:211]
v_mfma_f32_16x16x32_bf16 v[184:187], a[148:151], a[84:87], v[184:187]
v_mfma_f32_16x16x32_bf16 v[184:187], a[144:147], a[80:83], v[184:187]
v_mfma_f32_16x16x32_bf16 v[160:163], a[144:147], a[72:75], v[160:163]
v_mfma_f32_16x16x32_bf16 v[160:163], a[148:151], a[76:79], v[160:163]
buffer_load_dwordx4 a[60:63], v2, s[40:43], s33 offen offset:3072 sc1
s_add_u32 s35, s35, 8192
v_mfma_f32_16x16x32_bf16 v[136:139], a[148:151], a[68:71], v[136:139]
s_add_u32 s33, s33, 8192
v_mfma_f32_16x16x32_bf16 v[136:139], a[144:147], a[64:67], v[136:139]
v_mfma_f32_16x16x32_bf16 a[176:179], a[152:155], a[164:167], a[176:179]
s_waitcnt vmcnt(11) lgkmcnt(0)
v_mfma_f32_16x16x32_bf16 v[140:143], a[96:99], a[0:3], v[140:143]
ds_read_b128 a[128:131], v5 offset:41984
v_mfma_f32_16x16x32_bf16 v[140:143], a[100:103], a[4:7], v[140:143]
buffer_load_dwordx4 a[64:67], v2, s[40:43], s35 offen offset:0 sc1
v_mfma_f32_16x16x32_bf16 v[164:167], a[100:103], a[12:15], v[164:167]
ds_read_b128 a[132:135], v5 offset:48128
v_mfma_f32_16x16x32_bf16 v[164:167], a[96:99], a[8:11], v[164:167]
v_mfma_f32_16x16x32_bf16 v[188:191], a[96:99], a[16:19], v[188:191]
ds_read_b128 a[136:139], v5 offset:36864
v_mfma_f32_16x16x32_bf16 v[188:191], a[100:103], a[20:23], v[188:191]
buffer_load_dwordx4 v[96:99], v1, s[4:7], s88 offen offset:1024 sc1
v_mfma_f32_16x16x32_bf16 v[212:215], a[100:103], a[28:31], v[212:215]
ds_read_b128 a[140:143], v5 offset:43008
v_mfma_f32_16x16x32_bf16 v[212:215], a[96:99], a[24:27], v[212:215]
v_mfma_f32_16x16x32_bf16 v[216:219], a[104:107], a[24:27], v[216:219]
v_mfma_f32_16x16x32_bf16 v[216:219], a[108:111], a[28:31], v[216:219]
buffer_load_dwordx4 a[68:71], v2, s[40:43], s33 offen offset:0 sc1
v_mfma_f32_16x16x32_bf16 v[192:195], a[108:111], a[20:23], v[192:195]
ds_read_b128 a[144:147], v5 offset:37888
v_mfma_f32_16x16x32_bf16 v[192:195], a[104:107], a[16:19], v[192:195]
ds_read_b128 a[148:151], v5 offset:44032
v_mfma_f32_16x16x32_bf16 v[168:171], a[104:107], a[8:11], v[168:171]
v_mfma_f32_16x16x32_bf16 v[168:171], a[108:111], a[12:15], v[168:171]
buffer_load_dwordx4 a[72:75], v2, s[40:43], s35 offen offset:1024 sc1
v_mfma_f32_16x16x32_bf16 v[144:147], a[108:111], a[4:7], v[144:147]
ds_read_b128 a[152:155], v6 offset:29696
v_mfma_f32_16x16x32_bf16 v[144:147], a[104:107], a[0:3], v[144:147]
v_mfma_f32_16x16x32_bf16 v[148:151], a[112:115], a[0:3], v[148:151]
v_mfma_f32_16x16x32_bf16 v[148:151], a[116:119], a[4:7], v[148:151]
buffer_load_dwordx4 v[100:103], v1, s[4:7], s88 offen offset:2048 sc1
v_mfma_f32_16x16x32_bf16 v[172:175], a[116:119], a[12:15], v[172:175]
v_mfma_f32_16x16x32_bf16 v[172:175], a[112:115], a[8:11], v[172:175]
v_mfma_f32_16x16x32_bf16 v[196:199], a[112:115], a[16:19], v[196:199]
v_mfma_f32_16x16x32_bf16 v[196:199], a[116:119], a[20:23], v[196:199]
buffer_load_dwordx4 a[76:79], v2, s[40:43], s33 offen offset:1024 sc1
v_mfma_f32_16x16x32_bf16 v[220:223], a[116:119], a[28:31], v[220:223]
v_mfma_f32_16x16x32_bf16 v[220:223], a[112:115], a[24:27], v[220:223]
v_mfma_f32_16x16x32_bf16 a[180:183], a[120:123], a[164:167], a[180:183]
s_waitcnt lgkmcnt(0)
s_barrier
v_mfma_f32_16x16x32_bf16 v[224:227], a[128:131], a[24:27], v[224:227]
v_add_u32 v5, 49152, v1
v_add_u32 v6, s55, v5
v_mfma_f32_16x16x32_bf16 v[224:227], a[132:135], a[28:31], v[224:227]
buffer_load_dwordx4 a[80:83], v2, s[40:43], s35 offen offset:2048 sc1
v_mfma_f32_16x16x32_bf16 v[200:203], a[132:135], a[20:23], v[200:203]
ds_read_b128 a[96:99], v5 offset:2048
v_mfma_f32_16x16x32_bf16 v[200:203], a[128:131], a[16:19], v[200:203]
ds_read_b128 a[100:103], v5 offset:8192
v_mfma_f32_16x16x32_bf16 v[176:179], a[128:131], a[8:11], v[176:179]
ds_read_b128 a[104:107], v5 offset:3072
v_mfma_f32_16x16x32_bf16 v[176:179], a[132:135], a[12:15], v[176:179]
buffer_load_dwordx4 v[104:107], v1, s[4:7], s88 offen offset:3072 sc1
s_add_u32 s88, s88, 4096
v_mfma_f32_16x16x32_bf16 v[152:155], a[132:135], a[4:7], v[152:155]
ds_read_b128 a[108:111], v5 offset:9216
v_mfma_f32_16x16x32_bf16 v[152:155], a[128:131], a[0:3], v[152:155]
v_mfma_f32_16x16x32_bf16 v[132:135], a[136:139], a[0:3], v[132:135]
v_mfma_f32_16x16x32_bf16 v[132:135], a[140:143], a[4:7], v[132:135]
buffer_load_dwordx4 a[84:87], v2, s[40:43], s33 offen offset:2048 sc1
v_mfma_f32_16x16x32_bf16 v[156:159], a[140:143], a[12:15], v[156:159]
ds_read_b128 a[112:115], v5 offset:4096
v_mfma_f32_16x16x32_bf16 v[156:159], a[136:139], a[8:11], v[156:159]
ds_read_b128 a[116:119], v5 offset:10240
v_mfma_f32_16x16x32_bf16 v[180:183], a[136:139], a[16:19], v[180:183]
v_mfma_f32_16x16x32_bf16 v[180:183], a[140:143], a[20:23], v[180:183]
buffer_load_dwordx4 a[88:91], v2, s[40:43], s35 offen offset:3072 sc1
v_mfma_f32_16x16x32_bf16 v[204:207], a[140:143], a[28:31], v[204:207]
ds_read_b128 a[120:123], v6 offset:2048
v_mfma_f32_16x16x32_bf16 v[204:207], a[136:139], a[24:27], v[204:207]
v_mfma_f32_16x16x32_bf16 v[208:211], a[144:147], a[24:27], v[208:211]
v_mfma_f32_16x16x32_bf16 v[208:211], a[148:151], a[28:31], v[208:211]
buffer_load_dwordx4 v[108:111], v1, s[4:7], s88 offen offset:0 sc1
s_add_u32 s63, s28, 12
v_mfma_f32_16x16x32_bf16 v[184:187], a[148:151], a[20:23], v[184:187]
s_lshl_b32 s63, s63, 12
v_mfma_f32_16x16x32_bf16 v[184:187], a[144:147], a[16:19], v[184:187]
v_mfma_f32_16x16x32_bf16 v[160:163], a[144:147], a[8:11], v[160:163]
v_mfma_f32_16x16x32_bf16 v[160:163], a[148:151], a[12:15], v[160:163]
buffer_load_dwordx4 a[92:95], v2, s[40:43], s33 offen offset:3072 sc1
s_add_u32 s35, s35, 8192
v_mfma_f32_16x16x32_bf16 v[136:139], a[148:151], a[4:7], v[136:139]
s_add_u32 s33, s33, 8192
v_mfma_f32_16x16x32_bf16 v[136:139], a[144:147], a[0:3], v[136:139]
v_mfma_f32_16x16x32_bf16 a[184:187], a[152:155], a[164:167], a[184:187]
s_waitcnt vmcnt(12) lgkmcnt(0)
v_mfma_f32_16x16x32_bf16 v[140:143], a[96:99], a[32:35], v[140:143]
ds_read_b128 a[128:131], v5 offset:5120
v_mfma_f32_16x16x32_bf16 v[140:143], a[100:103], a[36:39], v[140:143]
buffer_load_dwordx4 a[0:3], v2, s[40:43], s35 offen offset:0 sc1
v_mfma_f32_16x16x32_bf16 v[164:167], a[100:103], a[44:47], v[164:167]
ds_read_b128 a[132:135], v5 offset:11264
v_mfma_f32_16x16x32_bf16 v[164:167], a[96:99], a[40:43], v[164:167]
v_mfma_f32_16x16x32_bf16 v[188:191], a[96:99], a[48:51], v[188:191]
ds_read_b128 a[136:139], v5 offset:0
v_mfma_f32_16x16x32_bf16 v[188:191], a[100:103], a[52:55], v[188:191]
v_mfma_f32_16x16x32_bf16 v[212:215], a[100:103], a[60:63], v[212:215]
buffer_load_dwordx4 a[4:7], v2, s[40:43], s33 offen offset:0 sc1
v_mfma_f32_16x16x32_bf16 v[212:215], a[96:99], a[56:59], v[212:215]
ds_read_b128 a[140:143], v5 offset:6144
v_mfma_f32_16x16x32_bf16 v[216:219], a[104:107], a[56:59], v[216:219]
v_mfma_f32_16x16x32_bf16 v[216:219], a[108:111], a[60:63], v[216:219]
ds_read_b128 a[144:147], v5 offset:1024
v_mfma_f32_16x16x32_bf16 v[192:195], a[108:111], a[52:55], v[192:195]
v_mfma_f32_16x16x32_bf16 v[192:195], a[104:107], a[48:51], v[192:195]
buffer_load_dwordx4 a[160:163], v3, s[40:43], s63 offen sc1
v_mfma_f32_16x16x32_bf16 v[168:171], a[104:107], a[40:43], v[168:171]
ds_read_b128 a[148:151], v5 offset:7168
v_mfma_f32_16x16x32_bf16 v[168:171], a[108:111], a[44:47], v[168:171]
ds_read_b128 a[152:155], v6 offset:3072
v_mfma_f32_16x16x32_bf16 v[144:147], a[108:111], a[36:39], v[144:147]
v_mfma_f32_16x16x32_bf16 v[144:147], a[104:107], a[32:35], v[144:147]
v_mfma_f32_16x16x32_bf16 v[148:151], a[112:115], a[32:35], v[148:151]
buffer_load_dwordx4 a[8:11], v2, s[40:43], s35 offen offset:1024 sc1
v_mfma_f32_16x16x32_bf16 v[148:151], a[116:119], a[36:39], v[148:151]
v_mfma_f32_16x16x32_bf16 v[172:175], a[116:119], a[44:47], v[172:175]
v_mfma_f32_16x16x32_bf16 v[172:175], a[112:115], a[40:43], v[172:175]
v_mfma_f32_16x16x32_bf16 v[196:199], a[112:115], a[48:51], v[196:199]
v_mfma_f32_16x16x32_bf16 v[196:199], a[116:119], a[52:55], v[196:199]
buffer_load_dwordx4 a[12:15], v2, s[40:43], s33 offen offset:1024 sc1
v_mfma_f32_16x16x32_bf16 v[220:223], a[116:119], a[60:63], v[220:223]
v_mfma_f32_16x16x32_bf16 v[220:223], a[112:115], a[56:59], v[220:223]
v_mfma_f32_16x16x32_bf16 a[172:175], a[120:123], a[168:171], a[172:175]
s_waitcnt lgkmcnt(0)
v_mfma_f32_16x16x32_bf16 v[224:227], a[128:131], a[56:59], v[224:227]
ds_read_b128 a[96:99], v5 offset:14336
v_mfma_f32_16x16x32_bf16 v[224:227], a[132:135], a[60:63], v[224:227]
buffer_load_dwordx4 a[16:19], v2, s[40:43], s35 offen offset:2048 sc1
v_mfma_f32_16x16x32_bf16 v[200:203], a[132:135], a[52:55], v[200:203]
ds_read_b128 a[100:103], v5 offset:20480
v_mfma_f32_16x16x32_bf16 v[200:203], a[128:131], a[48:51], v[200:203]
v_mfma_f32_16x16x32_bf16 v[176:179], a[128:131], a[40:43], v[176:179]
ds_read_b128 a[104:107], v5 offset:15360
v_mfma_f32_16x16x32_bf16 v[176:179], a[132:135], a[44:47], v[176:179]
buffer_load_dwordx4 v[112:115], v1, s[4:7], s88 offen offset:1024 sc1
v_mfma_f32_16x16x32_bf16 v[152:155], a[132:135], a[36:39], v[152:155]
ds_read_b128 a[108:111], v5 offset:21504
v_mfma_f32_16x16x32_bf16 v[152:155], a[128:131], a[32:35], v[152:155]
v_mfma_f32_16x16x32_bf16 v[132:135], a[136:139], a[32:35], v[132:135]
v_mfma_f32_16x16x32_bf16 v[132:135], a[140:143], a[36:39], v[132:135]
buffer_load_dwordx4 a[20:23], v2, s[40:43], s33 offen offset:2048 sc1
v_mfma_f32_16x16x32_bf16 v[156:159], a[140:143], a[44:47], v[156:159]
ds_read_b128 a[112:115], v5 offset:16384
v_mfma_f32_16x16x32_bf16 v[156:159], a[136:139], a[40:43], v[156:159]
ds_read_b128 a[116:119], v5 offset:22528
v_mfma_f32_16x16x32_bf16 v[180:183], a[136:139], a[48:51], v[180:183]
v_mfma_f32_16x16x32_bf16 v[180:183], a[140:143], a[52:55], v[180:183]
buffer_load_dwordx4 a[24:27], v2, s[40:43], s35 offen offset:3072 sc1
v_mfma_f32_16x16x32_bf16 v[204:207], a[140:143], a[60:63], v[204:207]
ds_read_b128 a[120:123], v6 offset:4096
v_mfma_f32_16x16x32_bf16 v[204:207], a[136:139], a[56:59], v[204:207]
v_mfma_f32_16x16x32_bf16 v[208:211], a[144:147], a[56:59], v[208:211]
v_mfma_f32_16x16x32_bf16 v[208:211], a[148:151], a[60:63], v[208:211]
buffer_load_dwordx4 v[116:119], v1, s[4:7], s88 offen offset:2048 sc1
v_mfma_f32_16x16x32_bf16 v[184:187], a[148:151], a[52:55], v[184:187]
v_mfma_f32_16x16x32_bf16 v[184:187], a[144:147], a[48:51], v[184:187]
v_mfma_f32_16x16x32_bf16 v[160:163], a[144:147], a[40:43], v[160:163]
v_mfma_f32_16x16x32_bf16 v[160:163], a[148:151], a[44:47], v[160:163]
buffer_load_dwordx4 a[28:31], v2, s[40:43], s33 offen offset:3072 sc1
s_add_u32 s35, s35, 8192
v_mfma_f32_16x16x32_bf16 v[136:139], a[148:151], a[36:39], v[136:139]
s_add_u32 s33, s33, 8192
v_mfma_f32_16x16x32_bf16 v[136:139], a[144:147], a[32:35], v[136:139]
v_mfma_f32_16x16x32_bf16 a[176:179], a[152:155], a[168:171], a[176:179]
s_waitcnt vmcnt(11) lgkmcnt(0)
v_mfma_f32_16x16x32_bf16 v[140:143], a[96:99], a[64:67], v[140:143]
ds_read_b128 a[128:131], v5 offset:17408
v_mfma_f32_16x16x32_bf16 v[140:143], a[100:103], a[68:71], v[140:143]
buffer_load_dwordx4 a[32:35], v2, s[40:43], s35 offen offset:0 sc1
v_mfma_f32_16x16x32_bf16 v[164:167], a[100:103], a[76:79], v[164:167]
ds_read_b128 a[132:135], v5 offset:23552
v_mfma_f32_16x16x32_bf16 v[164:167], a[96:99], a[72:75], v[164:167]
v_mfma_f32_16x16x32_bf16 v[188:191], a[96:99], a[80:83], v[188:191]
ds_read_b128 a[136:139], v5 offset:12288
v_mfma_f32_16x16x32_bf16 v[188:191], a[100:103], a[84:87], v[188:191]
v_mfma_f32_16x16x32_bf16 v[212:215], a[100:103], a[92:95], v[212:215]
buffer_load_dwordx4 a[36:39], v2, s[40:43], s33 offen offset:0 sc1
v_mfma_f32_16x16x32_bf16 v[212:215], a[96:99], a[88:91], v[212:215]
ds_read_b128 a[140:143], v5 offset:18432
v_mfma_f32_16x16x32_bf16 v[216:219], a[104:107], a[88:91], v[216:219]
v_mfma_f32_16x16x32_bf16 v[216:219], a[108:111], a[92:95], v[216:219]
ds_read_b128 a[144:147], v5 offset:13312
v_mfma_f32_16x16x32_bf16 v[192:195], a[108:111], a[84:87], v[192:195]
v_mfma_f32_16x16x32_bf16 v[192:195], a[104:107], a[80:83], v[192:195]
buffer_load_dwordx4 v[120:123], v1, s[4:7], s88 offen offset:3072 sc1
s_add_u32 s88, s83, 0x280000
v_mfma_f32_16x16x32_bf16 v[168:171], a[104:107], a[72:75], v[168:171]
ds_read_b128 a[148:151], v5 offset:19456
v_mfma_f32_16x16x32_bf16 v[168:171], a[108:111], a[76:79], v[168:171]
ds_read_b128 a[152:155], v6 offset:5120
v_mfma_f32_16x16x32_bf16 v[144:147], a[108:111], a[68:71], v[144:147]
v_mfma_f32_16x16x32_bf16 v[144:147], a[104:107], a[64:67], v[144:147]
v_mfma_f32_16x16x32_bf16 v[148:151], a[112:115], a[64:67], v[148:151]
buffer_load_dwordx4 a[40:43], v2, s[40:43], s35 offen offset:1024 sc1
v_mfma_f32_16x16x32_bf16 v[148:151], a[116:119], a[68:71], v[148:151]
v_mfma_f32_16x16x32_bf16 v[172:175], a[116:119], a[76:79], v[172:175]
v_mfma_f32_16x16x32_bf16 v[172:175], a[112:115], a[72:75], v[172:175]
v_mfma_f32_16x16x32_bf16 v[196:199], a[112:115], a[80:83], v[196:199]
v_mfma_f32_16x16x32_bf16 v[196:199], a[116:119], a[84:87], v[196:199]
buffer_load_dwordx4 a[44:47], v2, s[40:43], s33 offen offset:1024 sc1
v_mfma_f32_16x16x32_bf16 v[220:223], a[116:119], a[92:95], v[220:223]
v_mfma_f32_16x16x32_bf16 v[220:223], a[112:115], a[88:91], v[220:223]
v_mfma_f32_16x16x32_bf16 a[180:183], a[120:123], a[168:171], a[180:183]
s_waitcnt lgkmcnt(0)
v_mfma_f32_16x16x32_bf16 v[224:227], a[128:131], a[88:91], v[224:227]
ds_read_b128 a[96:99], v5 offset:26624
v_mfma_f32_16x16x32_bf16 v[224:227], a[132:135], a[92:95], v[224:227]
buffer_load_dwordx4 a[48:51], v2, s[40:43], s35 offen offset:2048 sc1
v_mfma_f32_16x16x32_bf16 v[200:203], a[132:135], a[84:87], v[200:203]
ds_read_b128 a[100:103], v5 offset:32768
v_mfma_f32_16x16x32_bf16 v[200:203], a[128:131], a[80:83], v[200:203]
v_mfma_f32_16x16x32_bf16 v[176:179], a[128:131], a[72:75], v[176:179]
ds_read_b128 a[104:107], v5 offset:27648
v_mfma_f32_16x16x32_bf16 v[176:179], a[132:135], a[76:79], v[176:179]
buffer_load_dwordx4 v[124:127], v1, s[4:7], s88 offen offset:0 sc1
v_mfma_f32_16x16x32_bf16 v[152:155], a[132:135], a[68:71], v[152:155]
ds_read_b128 a[108:111], v5 offset:33792
v_mfma_f32_16x16x32_bf16 v[152:155], a[128:131], a[64:67], v[152:155]
v_mfma_f32_16x16x32_bf16 v[132:135], a[136:139], a[64:67], v[132:135]
v_mfma_f32_16x16x32_bf16 v[132:135], a[140:143], a[68:71], v[132:135]
buffer_load_dwordx4 a[52:55], v2, s[40:43], s33 offen offset:2048 sc1
v_mfma_f32_16x16x32_bf16 v[156:159], a[140:143], a[76:79], v[156:159]
ds_read_b128 a[112:115], v5 offset:28672
v_mfma_f32_16x16x32_bf16 v[156:159], a[136:139], a[72:75], v[156:159]
ds_read_b128 a[116:119], v5 offset:34816
v_mfma_f32_16x16x32_bf16 v[180:183], a[136:139], a[80:83], v[180:183]
v_mfma_f32_16x16x32_bf16 v[180:183], a[140:143], a[84:87], v[180:183]
buffer_load_dwordx4 a[56:59], v2, s[40:43], s35 offen offset:3072 sc1
v_mfma_f32_16x16x32_bf16 v[204:207], a[140:143], a[92:95], v[204:207]
ds_read_b128 a[120:123], v6 offset:26624
L_stub11:
s_cbranch_execz L_stub12
v_mfma_f32_16x16x32_bf16 v[204:207], a[136:139], a[88:91], v[204:207]
v_mfma_f32_16x16x32_bf16 v[208:211], a[144:147], a[88:91], v[208:211]
v_mfma_f32_16x16x32_bf16 v[208:211], a[148:151], a[92:95], v[208:211]
buffer_load_dwordx4 v[128:131], v1, s[4:7], s88 offen offset:1024 sc1
s_add_u32 m0, s18, 0x0
v_mfma_f32_16x16x32_bf16 v[184:187], a[148:151], a[84:87], v[184:187]
s_add_u32 s44, s50, 0xe24000
v_mfma_f32_16x16x32_bf16 v[184:187], a[144:147], a[80:83], v[184:187]
v_mfma_f32_16x16x32_bf16 v[160:163], a[144:147], a[72:75], v[160:163]
v_mfma_f32_16x16x32_bf16 v[160:163], a[148:151], a[76:79], v[160:163]
buffer_load_dwordx4 a[60:63], v2, s[40:43], s33 offen offset:3072 sc1
s_add_u32 s35, s35, 8192
v_mfma_f32_16x16x32_bf16 v[136:139], a[148:151], a[68:71], v[136:139]
s_add_u32 s33, s33, 8192
v_mfma_f32_16x16x32_bf16 v[136:139], a[144:147], a[64:67], v[136:139]
v_mfma_f32_16x16x32_bf16 a[184:187], a[152:155], a[168:171], a[184:187]
s_waitcnt vmcnt(11) lgkmcnt(0)
v_mfma_f32_16x16x32_bf16 v[140:143], a[96:99], a[0:3], v[140:143]
ds_read_b128 a[128:131], v5 offset:29696
v_mfma_f32_16x16x32_bf16 v[140:143], a[100:103], a[4:7], v[140:143]
buffer_load_dwordx4 a[64:67], v2, s[40:43], s35 offen offset:0 sc1
v_mfma_f32_16x16x32_bf16 v[164:167], a[100:103], a[12:15], v[164:167]
ds_read_b128 a[132:135], v5 offset:35840
v_mfma_f32_16x16x32_bf16 v[164:167], a[96:99], a[8:11], v[164:167]
v_mfma_f32_16x16x32_bf16 v[188:191], a[96:99], a[16:19], v[188:191]
ds_read_b128 a[136:139], v5 offset:24576
v_mfma_f32_16x16x32_bf16 v[188:191], a[100:103], a[20:23], v[188:191]
buffer_load_dwordx4 v1, s[4:7], s44 offen offset:0 sc1 lds
s_add_u32 s63, s28, 16
v_mfma_f32_16x16x32_bf16 v[212:215], a[100:103], a[28:31], v[212:215]
s_lshl_b32 s63, s63, 12
ds_read_b128 a[140:143], v5 offset:30720
v_mfma_f32_16x16x32_bf16 v[212:215], a[96:99], a[24:27], v[212:215]
v_mfma_f32_16x16x32_bf16 v[216:219], a[104:107], a[24:27], v[216:219]
v_mfma_f32_16x16x32_bf16 v[216:219], a[108:111], a[28:31], v[216:219]
buffer_load_dwordx4 a[68:71], v2, s[40:43], s33 offen offset:0 sc1
v_mfma_f32_16x16x32_bf16 v[192:195], a[108:111], a[20:23], v[192:195]
ds_read_b128 a[144:147], v5 offset:25600
v_mfma_f32_16x16x32_bf16 v[192:195], a[104:107], a[16:19], v[192:195]
ds_read_b128 a[148:151], v5 offset:31744
v_mfma_f32_16x16x32_bf16 v[168:171], a[104:107], a[8:11], v[168:171]
v_mfma_f32_16x16x32_bf16 v[168:171], a[108:111], a[12:15], v[168:171]
buffer_load_dwordx4 a[72:75], v2, s[40:43], s35 offen offset:1024 sc1
v_mfma_f32_16x16x32_bf16 v[144:147], a[108:111], a[4:7], v[144:147]
ds_read_b128 a[152:155], v6 offset:27648
v_mfma_f32_16x16x32_bf16 v[144:147], a[104:107], a[0:3], v[144:147]
v_mfma_f32_16x16x32_bf16 v[148:151], a[112:115], a[0:3], v[148:151]
v_mfma_f32_16x16x32_bf16 v[148:151], a[116:119], a[4:7], v[148:151]
buffer_load_dwordx4 a[164:167], v3, s[40:43], s63 offen sc1
v_mfma_f32_16x16x32_bf16 v[172:175], a[116:119], a[12:15], v[172:175]
v_mfma_f32_16x16x32_bf16 v[172:175], a[112:115], a[8:11], v[172:175]
v_mfma_f32_16x16x32_bf16 v[196:199], a[112:115], a[16:19], v[196:199]
v_mfma_f32_16x16x32_bf16 v[196:199], a[116:119], a[20:23], v[196:199]
buffer_load_dwordx4 a[76:79], v2, s[40:43], s33 offen offset:1024 sc1
v_mfma_f32_16x16x32_bf16 v[220:223], a[116:119], a[28:31], v[220:223]
v_mfma_f32_16x16x32_bf16 v[220:223], a[112:115], a[24:27], v[220:223]
v_mfma_f32_16x16x32_bf16 a[172:175], a[120:123], a[160:163], a[172:175]
s_waitcnt lgkmcnt(0)
v_mfma_f32_16x16x32_bf16 v[224:227], a[128:131], a[24:27], v[224:227]
ds_read_b128 a[96:99], v5 offset:38912
v_mfma_f32_16x16x32_bf16 v[224:227], a[132:135], a[28:31], v[224:227]
buffer_load_dwordx4 a[80:83], v2, s[40:43], s35 offen offset:2048 sc1
v_mfma_f32_16x16x32_bf16 v[200:203], a[132:135], a[20:23], v[200:203]
ds_read_b128 a[100:103], v5 offset:45056
v_mfma_f32_16x16x32_bf16 v[200:203], a[128:131], a[16:19], v[200:203]
v_mfma_f32_16x16x32_bf16 v[176:179], a[128:131], a[8:11], v[176:179]
ds_read_b128 a[104:107], v5 offset:39936
v_mfma_f32_16x16x32_bf16 v[176:179], a[132:135], a[12:15], v[176:179]
v_mfma_f32_16x16x32_bf16 v[152:155], a[132:135], a[4:7], v[152:155]
buffer_load_dwordx4 a[84:87], v2, s[40:43], s33 offen offset:2048 sc1
v_mfma_f32_16x16x32_bf16 v[152:155], a[128:131], a[0:3], v[152:155]
ds_read_b128 a[108:111], v5 offset:46080
v_mfma_f32_16x16x32_bf16 v[132:135], a[136:139], a[0:3], v[132:135]
v_mfma_f32_16x16x32_bf16 v[132:135], a[140:143], a[4:7], v[132:135]
ds_read_b128 a[112:115], v5 offset:40960
v_mfma_f32_16x16x32_bf16 v[156:159], a[140:143], a[12:15], v[156:159]
v_mfma_f32_16x16x32_bf16 v[156:159], a[136:139], a[8:11], v[156:159]
buffer_load_dwordx4 v1, s[4:7], s44 offen offset:1024 sc1 lds
v_mfma_f32_16x16x32_bf16 v[180:183], a[136:139], a[16:19], v[180:183]
ds_read_b128 a[116:119], v5 offset:47104
v_mfma_f32_16x16x32_bf16 v[180:183], a[140:143], a[20:23], v[180:183]
ds_read_b128 a[120:123], v6 offset:28672
v_mfma_f32_16x16x32_bf16 v[204:207], a[140:143], a[28:31], v[204:207]
v_mfma_f32_16x16x32_bf16 v[204:207], a[136:139], a[24:27], v[204:207]
v_mfma_f32_16x16x32_bf16 v[208:211], a[144:147], a[24:27], v[208:211]
buffer_load_dwordx4 a[88:91], v2, s[40:43], s35 offen offset:3072 sc1
v_mfma_f32_16x16x32_bf16 v[208:211], a[148:151], a[28:31], v[208:211]
v_mfma_f32_16x16x32_bf16 v[184:187], a[148:151], a[20:23], v[184:187]
v_mfma_f32_16x16x32_bf16 v[184:187], a[144:147], a[16:19], v[184:187]
v_mfma_f32_16x16x32_bf16 v[160:163], a[144:147], a[8:11], v[160:163]
v_mfma_f32_16x16x32_bf16 v[160:163], a[148:151], a[12:15], v[160:163]
buffer_load_dwordx4 a[92:95], v2, s[40:43], s33 offen offset:3072 sc1
s_add_u32 s35, s35, 8192
v_mfma_f32_16x16x32_bf16 v[136:139], a[148:151], a[4:7], v[136:139]
s_add_u32 s33, s33, 8192
v_mfma_f32_16x16x32_bf16 v[136:139], a[144:147], a[0:3], v[136:139]
v_mfma_f32_16x16x32_bf16 a[176:179], a[152:155], a[160:163], a[176:179]
s_waitcnt vmcnt(11) lgkmcnt(0)
v_mfma_f32_16x16x32_bf16 v[140:143], a[96:99], a[32:35], v[140:143]
ds_read_b128 a[128:131], v5 offset:41984
v_mfma_f32_16x16x32_bf16 v[140:143], a[100:103], a[36:39], v[140:143]
buffer_load_dwordx4 a[0:3], v2, s[40:43], s35 offen offset:0 sc1
v_mfma_f32_16x16x32_bf16 v[164:167], a[100:103], a[44:47], v[164:167]
ds_read_b128 a[132:135], v5 offset:48128
v_mfma_f32_16x16x32_bf16 v[164:167], a[96:99], a[40:43], v[164:167]
v_mfma_f32_16x16x32_bf16 v[188:191], a[96:99], a[48:51], v[188:191]
ds_read_b128 a[136:139], v5 offset:36864
v_mfma_f32_16x16x32_bf16 v[188:191], a[100:103], a[52:55], v[188:191]
buffer_load_dwordx4 v1, s[4:7], s44 offen offset:2048 sc1 lds
s_add_u32 m0, s18, 0x3000
v_mfma_f32_16x16x32_bf16 v[212:215], a[100:103], a[60:63], v[212:215]
s_add_u32 s44, s50, 0xe27000
ds_read_b128 a[140:143], v5 offset:43008
v_mfma_f32_16x16x32_bf16 v[212:215], a[96:99], a[56:59], v[212:215]
v_mfma_f32_16x16x32_bf16 v[216:219], a[104:107], a[56:59], v[216:219]
v_mfma_f32_16x16x32_bf16 v[216:219], a[108:111], a[60:63], v[216:219]
buffer_load_dwordx4 a[4:7], v2, s[40:43], s33 offen offset:0 sc1
v_mfma_f32_16x16x32_bf16 v[192:195], a[108:111], a[52:55], v[192:195]
ds_read_b128 a[144:147], v5 offset:37888
v_mfma_f32_16x16x32_bf16 v[192:195], a[104:107], a[48:51], v[192:195]
ds_read_b128 a[148:151], v5 offset:44032
v_mfma_f32_16x16x32_bf16 v[168:171], a[104:107], a[40:43], v[168:171]
v_mfma_f32_16x16x32_bf16 v[168:171], a[108:111], a[44:47], v[168:171]
buffer_load_dwordx4 a[8:11], v2, s[40:43], s35 offen offset:1024 sc1
v_mfma_f32_16x16x32_bf16 v[144:147], a[108:111], a[36:39], v[144:147]
ds_read_b128 a[152:155], v6 offset:29696
v_mfma_f32_16x16x32_bf16 v[144:147], a[104:107], a[32:35], v[144:147]
v_mfma_f32_16x16x32_bf16 v[148:151], a[112:115], a[32:35], v[148:151]
v_mfma_f32_16x16x32_bf16 v[148:151], a[116:119], a[36:39], v[148:151]
buffer_load_dwordx4 v1, s[4:7], s44 offen offset:0 sc1 lds
v_mfma_f32_16x16x32_bf16 v[172:175], a[116:119], a[44:47], v[172:175]
v_mfma_f32_16x16x32_bf16 v[172:175], a[112:115], a[40:43], v[172:175]
v_mfma_f32_16x16x32_bf16 v[196:199], a[112:115], a[48:51], v[196:199]
v_mfma_f32_16x16x32_bf16 v[196:199], a[116:119], a[52:55], v[196:199]
buffer_load_dwordx4 a[12:15], v2, s[40:43], s33 offen offset:1024 sc1
v_mfma_f32_16x16x32_bf16 v[220:223], a[116:119], a[60:63], v[220:223]
v_mfma_f32_16x16x32_bf16 v[220:223], a[112:115], a[56:59], v[220:223]
v_mfma_f32_16x16x32_bf16 a[180:183], a[120:123], a[160:163], a[180:183]
s_waitcnt lgkmcnt(0)
s_barrier
v_mfma_f32_16x16x32_bf16 v[224:227], a[128:131], a[56:59], v[224:227]
v_add_u32 v5, 98304, v1
v_add_u32 v6, s55, v5
v_mfma_f32_16x16x32_bf16 v[224:227], a[132:135], a[60:63], v[224:227]
buffer_load_dwordx4 a[16:19], v2, s[40:43], s35 offen offset:2048 sc1
v_mfma_f32_16x16x32_bf16 v[200:203], a[132:135], a[52:55], v[200:203]
ds_read_b128 a[96:99], v5 offset:2048
v_mfma_f32_16x16x32_bf16 v[200:203], a[128:131], a[48:51], v[200:203]
ds_read_b128 a[100:103], v5 offset:8192
v_mfma_f32_16x16x32_bf16 v[176:179], a[128:131], a[40:43], v[176:179]
ds_read_b128 a[104:107], v5 offset:3072
v_mfma_f32_16x16x32_bf16 v[176:179], a[132:135], a[44:47], v[176:179]
v_mfma_f32_16x16x32_bf16 v[152:155], a[132:135], a[36:39], v[152:155]
buffer_load_dwordx4 a[20:23], v2, s[40:43], s33 offen offset:2048 sc1
v_mfma_f32_16x16x32_bf16 v[152:155], a[128:131], a[32:35], v[152:155]
ds_read_b128 a[108:111], v5 offset:9216
v_mfma_f32_16x16x32_bf16 v[132:135], a[136:139], a[32:35], v[132:135]
v_mfma_f32_16x16x32_bf16 v[132:135], a[140:143], a[36:39], v[132:135]
ds_read_b128 a[112:115], v5 offset:4096
v_mfma_f32_16x16x32_bf16 v[156:159], a[140:143], a[44:47], v[156:159]
v_mfma_f32_16x16x32_bf16 v[156:159], a[136:139], a[40:43], v[156:159]
buffer_load_dwordx4 v1, s[4:7], s44 offen offset:1024 sc1 lds
v_mfma_f32_16x16x32_bf16 v[180:183], a[136:139], a[48:51], v[180:183]
ds_read_b128 a[116:119], v5 offset:10240
v_mfma_f32_16x16x32_bf16 v[180:183], a[140:143], a[52:55], v[180:183]
ds_read_b128 a[120:123], v6 offset:2048
v_mfma_f32_16x16x32_bf16 v[204:207], a[140:143], a[60:63], v[204:207]
v_mfma_f32_16x16x32_bf16 v[204:207], a[136:139], a[56:59], v[204:207]
v_mfma_f32_16x16x32_bf16 v[208:211], a[144:147], a[56:59], v[208:211]
buffer_load_dwordx4 a[24:27], v2, s[40:43], s35 offen offset:3072 sc1
v_mfma_f32_16x16x32_bf16 v[208:211], a[148:151], a[60:63], v[208:211]
v_mfma_f32_16x16x32_bf16 v[184:187], a[148:151], a[52:55], v[184:187]
v_mfma_f32_16x16x32_bf16 v[184:187], a[144:147], a[48:51], v[184:187]
v_mfma_f32_16x16x32_bf16 v[160:163], a[144:147], a[40:43], v[160:163]
v_mfma_f32_16x16x32_bf16 v[160:163], a[148:151], a[44:47], v[160:163]
buffer_load_dwordx4 a[28:31], v2, s[40:43], s33 offen offset:3072 sc1
s_add_u32 s35, s35, 8192
v_mfma_f32_16x16x32_bf16 v[136:139], a[148:151], a[36:39], v[136:139]
s_add_u32 s33, s33, 8192
v_mfma_f32_16x16x32_bf16 v[136:139], a[144:147], a[32:35], v[136:139]
v_mfma_f32_16x16x32_bf16 a[184:187], a[152:155], a[160:163], a[184:187]
s_waitcnt vmcnt(11) lgkmcnt(0)
v_mfma_f32_16x16x32_bf16 v[140:143], a[96:99], a[64:67], v[140:143]
ds_read_b128 a[128:131], v5 offset:5120
v_mfma_f32_16x16x32_bf16 v[140:143], a[100:103], a[68:71], v[140:143]
buffer_load_dwordx4 a[32:35], v2, s[40:43], s35 offen offset:0 sc1
v_mfma_f32_16x16x32_bf16 v[164:167], a[100:103], a[76:79], v[164:167]
ds_read_b128 a[132:135], v5 offset:11264
v_mfma_f32_16x16x32_bf16 v[164:167], a[96:99], a[72:75], v[164:167]
v_mfma_f32_16x16x32_bf16 v[188:191], a[96:99], a[80:83], v[188:191]
ds_read_b128 a[136:139], v5 offset:0
v_mfma_f32_16x16x32_bf16 v[188:191], a[100:103], a[84:87], v[188:191]
buffer_load_dwordx4 v1, s[4:7], s44 offen offset:2048 sc1 lds
s_add_u32 s63, s28, 20
v_mfma_f32_16x16x32_bf16 v[212:215], a[100:103], a[92:95], v[212:215]
s_lshl_b32 s63, s63, 12
ds_read_b128 a[140:143], v5 offset:6144
v_mfma_f32_16x16x32_bf16 v[212:215], a[96:99], a[88:91], v[212:215]
v_mfma_f32_16x16x32_bf16 v[216:219], a[104:107], a[88:91], v[216:219]
v_mfma_f32_16x16x32_bf16 v[216:219], a[108:111], a[92:95], v[216:219]
buffer_load_dwordx4 a[36:39], v2, s[40:43], s33 offen offset:0 sc1
v_mfma_f32_16x16x32_bf16 v[192:195], a[108:111], a[84:87], v[192:195]
ds_read_b128 a[144:147], v5 offset:1024
v_mfma_f32_16x16x32_bf16 v[192:195], a[104:107], a[80:83], v[192:195]
ds_read_b128 a[148:151], v5 offset:7168
v_mfma_f32_16x16x32_bf16 v[168:171], a[104:107], a[72:75], v[168:171]
v_mfma_f32_16x16x32_bf16 v[168:171], a[108:111], a[76:79], v[168:171]
buffer_load_dwordx4 a[40:43], v2, s[40:43], s35 offen offset:1024 sc1
v_mfma_f32_16x16x32_bf16 v[144:147], a[108:111], a[68:71], v[144:147]
ds_read_b128 a[152:155], v6 offset:3072
v_mfma_f32_16x16x32_bf16 v[144:147], a[104:107], a[64:67], v[144:147]
v_mfma_f32_16x16x32_bf16 v[148:151], a[112:115], a[64:67], v[148:151]
v_mfma_f32_16x16x32_bf16 v[148:151], a[116:119], a[68:71], v[148:151]
buffer_load_dwordx4 a[168:171], v3, s[40:43], s63 offen sc1
s_add_u32 m0, s18, 0x6000
v_mfma_f32_16x16x32_bf16 v[172:175], a[116:119], a[76:79], v[172:175]
s_add_u32 s44, s50, 0xe2a000
v_mfma_f32_16x16x32_bf16 v[172:175], a[112:115], a[72:75], v[172:175]
v_mfma_f32_16x16x32_bf16 v[196:199], a[112:115], a[80:83], v[196:199]
v_mfma_f32_16x16x32_bf16 v[196:199], a[116:119], a[84:87], v[196:199]
buffer_load_dwordx4 a[44:47], v2, s[40:43], s33 offen offset:1024 sc1
v_mfma_f32_16x16x32_bf16 v[220:223], a[116:119], a[92:95], v[220:223]
v_mfma_f32_16x16x32_bf16 v[220:223], a[112:115], a[88:91], v[220:223]
v_mfma_f32_16x16x32_bf16 a[172:175], a[120:123], a[164:167], a[172:175]
s_waitcnt lgkmcnt(0)
v_mfma_f32_16x16x32_bf16 v[224:227], a[128:131], a[88:91], v[224:227]
ds_read_b128 a[96:99], v5 offset:14336
v_mfma_f32_16x16x32_bf16 v[224:227], a[132:135], a[92:95], v[224:227]
buffer_load_dwordx4 a[48:51], v2, s[40:43], s35 offen offset:2048 sc1
v_mfma_f32_16x16x32_bf16 v[200:203], a[132:135], a[84:87], v[200:203]
ds_read_b128 a[100:103], v5 offset:20480
v_mfma_f32_16x16x32_bf16 v[200:203], a[128:131], a[80:83], v[200:203]
v_mfma_f32_16x16x32_bf16 v[176:179], a[128:131], a[72:75], v[176:179]
ds_read_b128 a[104:107], v5 offset:15360
v_mfma_f32_16x16x32_bf16 v[176:179], a[132:135], a[76:79], v[176:179]
buffer_load_dwordx4 v1, s[4:7], s44 offen offset:0 sc1 lds
v_mfma_f32_16x16x32_bf16 v[152:155], a[132:135], a[68:71], v[152:155]
ds_read_b128 a[108:111], v5 offset:21504
v_mfma_f32_16x16x32_bf16 v[152:155], a[128:131], a[64:67], v[152:155]
v_mfma_f32_16x16x32_bf16 v[132:135], a[136:139], a[64:67], v[132:135]
v_mfma_f32_16x16x32_bf16 v[132:135], a[140:143], a[68:71], v[132:135]
buffer_load_dwordx4 a[52:55], v2, s[40:43], s33 offen offset:2048 sc1
v_mfma_f32_16x16x32_bf16 v[156:159], a[140:143], a[76:79], v[156:159]
ds_read_b128 a[112:115], v5 offset:16384
v_mfma_f32_16x16x32_bf16 v[156:159], a[136:139], a[72:75], v[156:159]
ds_read_b128 a[116:119], v5 offset:22528
v_mfma_f32_16x16x32_bf16 v[180:183], a[136:139], a[80:83], v[180:183]
v_mfma_f32_16x16x32_bf16 v[180:183], a[140:143], a[84:87], v[180:183]
buffer_load_dwordx4 a[56:59], v2, s[40:43], s35 offen offset:3072 sc1
v_mfma_f32_16x16x32_bf16 v[204:207], a[140:143], a[92:95], v[204:207]
ds_read_b128 a[120:123], v6 offset:4096
v_mfma_f32_16x16x32_bf16 v[204:207], a[136:139], a[88:91], v[204:207]
v_mfma_f32_16x16x32_bf16 v[208:211], a[144:147], a[88:91], v[208:211]
v_mfma_f32_16x16x32_bf16 v[208:211], a[148:151], a[92:95], v[208:211]
buffer_load_dwordx4 v1, s[4:7], s44 offen offset:1024 sc1 lds
v_mfma_f32_16x16x32_bf16 v[184:187], a[148:151], a[84:87], v[184:187]
v_mfma_f32_16x16x32_bf16 v[184:187], a[144:147], a[80:83], v[184:187]
v_mfma_f32_16x16x32_bf16 v[160:163], a[144:147], a[72:75], v[160:163]
v_mfma_f32_16x16x32_bf16 v[160:163], a[148:151], a[76:79], v[160:163]
buffer_load_dwordx4 a[60:63], v2, s[40:43], s33 offen offset:3072 sc1
s_add_u32 s35, s35, 8192
v_mfma_f32_16x16x32_bf16 v[136:139], a[148:151], a[68:71], v[136:139]
s_add_u32 s33, s33, 8192
v_mfma_f32_16x16x32_bf16 v[136:139], a[144:147], a[64:67], v[136:139]
v_mfma_f32_16x16x32_bf16 a[176:179], a[152:155], a[164:167], a[176:179]
s_waitcnt vmcnt(12) lgkmcnt(0)
v_mfma_f32_16x16x32_bf16 v[140:143], a[96:99], a[0:3], v[140:143]
ds_read_b128 a[128:131], v5 offset:17408
v_add_f32 v92, v92, v96
v_mfma_f32_16x16x32_bf16 v[140:143], a[100:103], a[4:7], v[140:143]
buffer_load_dwordx4 a[64:67], v2, s[40:43], s35 offen offset:0 sc1
v_mfma_f32_16x16x32_bf16 v[164:167], a[100:103], a[12:15], v[164:167]
ds_read_b128 a[132:135], v5 offset:23552
v_add_f32 v100, v100, v104
v_mfma_f32_16x16x32_bf16 v[164:167], a[96:99], a[8:11], v[164:167]
v_add_f32 v108, v108, v112
v_add_f32 v116, v116, v120
v_mfma_f32_16x16x32_bf16 v[188:191], a[96:99], a[16:19], v[188:191]
ds_read_b128 a[136:139], v5 offset:12288
v_add_f32 v124, v124, v128
v_mfma_f32_16x16x32_bf16 v[188:191], a[100:103], a[20:23], v[188:191]
v_add_f32 v93, v93, v97
v_add_f32 v101, v101, v105
v_mfma_f32_16x16x32_bf16 v[212:215], a[100:103], a[28:31], v[212:215]
buffer_load_dwordx4 a[68:71], v2, s[40:43], s33 offen offset:0 sc1
v_mfma_f32_16x16x32_bf16 v[212:215], a[96:99], a[24:27], v[212:215]
ds_read_b128 a[140:143], v5 offset:18432
v_add_f32 v109, v109, v113
v_mfma_f32_16x16x32_bf16 v[216:219], a[104:107], a[24:27], v[216:219]
v_add_f32 v117, v117, v121
v_add_f32 v125, v125, v129
v_mfma_f32_16x16x32_bf16 v[216:219], a[108:111], a[28:31], v[216:219]
ds_read_b128 a[144:147], v5 offset:13312
v_add_f32 v94, v94, v98
v_mfma_f32_16x16x32_bf16 v[192:195], a[108:111], a[20:23], v[192:195]
v_add_f32 v102, v102, v106
v_add_f32 v110, v110, v114
v_mfma_f32_16x16x32_bf16 v[192:195], a[104:107], a[16:19], v[192:195]
buffer_load_dwordx4 v1, s[4:7], s44 offen offset:2048 sc1 lds
s_add_u32 m0, s18, 0x9000
v_mfma_f32_16x16x32_bf16 v[168:171], a[104:107], a[8:11], v[168:171]
s_add_u32 s44, s50, 0xe2d000
ds_read_b128 a[148:151], v5 offset:19456
v_mfma_f32_16x16x32_bf16 v[168:171], a[108:111], a[12:15], v[168:171]
ds_read_b128 a[152:155], v6 offset:5120
v_add_f32 v118, v118, v122
v_mfma_f32_16x16x32_bf16 v[144:147], a[108:111], a[4:7], v[144:147]
v_add_f32 v126, v126, v130
v_add_f32 v95, v95, v99
v_mfma_f32_16x16x32_bf16 v[144:147], a[104:107], a[0:3], v[144:147]
v_add_f32 v103, v103, v107
v_add_f32 v111, v111, v115
v_mfma_f32_16x16x32_bf16 v[148:151], a[112:115], a[0:3], v[148:151]
buffer_load_dwordx4 a[72:75], v2, s[40:43], s35 offen offset:1024 sc1
v_mfma_f32_16x16x32_bf16 v[148:151], a[116:119], a[4:7], v[148:151]
v_add_f32 v119, v119, v123
v_add_f32 v127, v127, v131
v_mfma_f32_16x16x32_bf16 v[172:175], a[116:119], a[12:15], v[172:175]
v_add_f32_dpp v92, v92, v92 row_ror:8 row_mask:0xf bank_mask:0xf
v_add_f32_dpp v100, v100, v100 row_ror:8 row_mask:0xf bank_mask:0xf
v_mfma_f32_16x16x32_bf16 v[172:175], a[112:115], a[8:11], v[172:175]
v_add_f32_dpp v108, v108, v108 row_ror:8 row_mask:0xf bank_mask:0xf
v_add_f32_dpp v116, v116, v116 row_ror:8 row_mask:0xf bank_mask:0xf
v_mfma_f32_16x16x32_bf16 v[196:199], a[112:115], a[16:19], v[196:199]
v_add_f32_dpp v124, v124, v124 row_ror:8 row_mask:0xf bank_mask:0xf
v_add_f32_dpp v93, v93, v93 row_ror:8 row_mask:0xf bank_mask:0xf
v_mfma_f32_16x16x32_bf16 v[196:199], a[116:119], a[20:23], v[196:199]
buffer_load_dwordx4 a[76:79], v2, s[40:43], s33 offen offset:1024 sc1
v_mfma_f32_16x16x32_bf16 v[220:223], a[116:119], a[28:31], v[220:223]
v_add_f32_dpp v101, v101, v101 row_ror:8 row_mask:0xf bank_mask:0xf
v_add_f32_dpp v109, v109, v109 row_ror:8 row_mask:0xf bank_mask:0xf
v_mfma_f32_16x16x32_bf16 v[220:223], a[112:115], a[24:27], v[220:223]
v_add_f32_dpp v117, v117, v117 row_ror:8 row_mask:0xf bank_mask:0xf
v_add_f32_dpp v125, v125, v125 row_ror:8 row_mask:0xf bank_mask:0xf
v_mfma_f32_16x16x32_bf16 a[180:183], a[120:123], a[164:167], a[180:183]
v_add_f32_dpp v92, v94, v94 row_ror:8 row_mask:0xf bank_mask:0xc
s_waitcnt lgkmcnt(0)
v_mfma_f32_16x16x32_bf16 v[224:227], a[128:131], a[24:27], v[224:227]
ds_read_b128 a[96:99], v5 offset:26624
v_add_f32_dpp v100, v102, v102 row_ror:8 row_mask:0xf bank_mask:0xc
v_mfma_f32_16x16x32_bf16 v[224:227], a[132:135], a[28:31], v[224:227]
buffer_load_dwordx4 a[80:83], v2, s[40:43], s35 offen offset:2048 sc1
v_mfma_f32_16x16x32_bf16 v[200:203], a[132:135], a[20:23], v[200:203]
ds_read_b128 a[100:103], v5 offset:32768
v_add_f32_dpp v108, v110, v110 row_ror:8 row_mask:0xf bank_mask:0xc
v_mfma_f32_16x16x32_bf16 v[200:203], a[128:131], a[16:19], v[200:203]
v_add_f32_dpp v116, v118, v118 row_ror:8 row_mask:0xf bank_mask:0xc
v_add_f32_dpp v124, v126, v126 row_ror:8 row_mask:0xf bank_mask:0xc
v_mfma_f32_16x16x32_bf16 v[176:179], a[128:131], a[8:11], v[176:179]
ds_read_b128 a[104:107], v5 offset:27648
v_add_f32_dpp v93, v95, v95 row_ror:8 row_mask:0xf bank_mask:0xc
v_mfma_f32_16x16x32_bf16 v[176:179], a[132:135], a[12:15], v[176:179]
buffer_load_dwordx4 v1, s[4:7], s44 offen offset:0 sc1 lds
v_mfma_f32_16x16x32_bf16 v[152:155], a[132:135], a[4:7], v[152:155]
ds_read_b128 a[108:111], v5 offset:33792
v_add_f32_dpp v101, v103, v103 row_ror:8 row_mask:0xf bank_mask:0xc
v_mfma_f32_16x16x32_bf16 v[152:155], a[128:131], a[0:3], v[152:155]
v_add_f32_dpp v109, v111, v111 row_ror:8 row_mask:0xf bank_mask:0xc
v_add_f32_dpp v117, v119, v119 row_ror:8 row_mask:0xf bank_mask:0xc
v_mfma_f32_16x16x32_bf16 v[132:135], a[136:139], a[0:3], v[132:135]
v_add_f32_dpp v125, v127, v127 row_ror:8 row_mask:0xf bank_mask:0xc
v_mfma_f32_16x16x32_bf16 v[132:135], a[140:143], a[4:7], v[132:135]
buffer_load_dwordx4 a[84:87], v2, s[40:43], s33 offen offset:2048 sc1
v_mfma_f32_16x16x32_bf16 v[156:159], a[140:143], a[12:15], v[156:159]
ds_read_b128 a[112:115], v5 offset:28672
v_mfma_f32_16x16x32_bf16 v[156:159], a[136:139], a[8:11], v[156:159]
ds_read_b128 a[116:119], v5 offset:34816
v_mfma_f32_16x16x32_bf16 v[180:183], a[136:139], a[16:19], v[180:183]
v_permlane32_swap_b32 v92, v93
v_mfma_f32_16x16x32_bf16 v[180:183], a[140:143], a[20:23], v[180:183]
buffer_load_dwordx4 a[88:91], v2, s[40:43], s35 offen offset:3072 sc1
v_mfma_f32_16x16x32_bf16 v[204:207], a[140:143], a[28:31], v[204:207]
ds_read_b128 a[120:123], v6 offset:26624
v_mfma_f32_16x16x32_bf16 v[204:207], a[136:139], a[24:27], v[204:207]
v_permlane32_swap_b32 v100, v101
v_mfma_f32_16x16x32_bf16 v[208:211], a[144:147], a[24:27], v[208:211]
v_permlane32_swap_b32 v108, v109
v_mfma_f32_16x16x32_bf16 v[208:211], a[148:151], a[28:31], v[208:211]
buffer_load_dwordx4 v1, s[4:7], s44 offen offset:1024 sc1 lds
s_add_u32 s63, s28, 24
v_mfma_f32_16x16x32_bf16 v[184:187], a[148:151], a[20:23], v[184:187]
s_lshl_b32 s63, s63, 12
v_mfma_f32_16x16x32_bf16 v[184:187], a[144:147], a[16:19], v[184:187]
v_permlane32_swap_b32 v116, v117
v_mfma_f32_16x16x32_bf16 v[160:163], a[144:147], a[8:11], v[160:163]
v_permlane32_swap_b32 v124, v125
v_mfma_f32_16x16x32_bf16 v[160:163], a[148:151], a[12:15], v[160:163]
buffer_load_dwordx4 a[92:95], v2, s[40:43], s33 offen offset:3072 sc1
s_add_u32 s35, s35, 8192
v_mfma_f32_16x16x32_bf16 v[136:139], a[148:151], a[4:7], v[136:139]
s_add_u32 s33, s33, 8192
v_add_f32 v92, v92, v93
v_mfma_f32_16x16x32_bf16 v[136:139], a[144:147], a[0:3], v[136:139]
v_add_f32 v100, v100, v101
v_add_f32 v108, v108, v109
v_mfma_f32_16x16x32_bf16 a[184:187], a[152:155], a[164:167], a[184:187]
v_add_f32 v116, v116, v117
s_waitcnt vmcnt(11) lgkmcnt(0)
v_mfma_f32_16x16x32_bf16 v[140:143], a[96:99], a[32:35], v[140:143]
ds_read_b128 a[128:131], v5 offset:29696
v_add_f32 v124, v124, v125
v_mfma_f32_16x16x32_bf16 v[140:143], a[100:103], a[36:39], v[140:143]
buffer_load_dwordx4 a[0:3], v2, s[40:43], s35 offen offset:0 sc1
v_mfma_f32_16x16x32_bf16 v[164:167], a[100:103], a[44:47], v[164:167]
ds_read_b128 a[132:135], v5 offset:35840
v_mov_b32 v94, v92
v_mfma_f32_16x16x32_bf16 v[164:167], a[96:99], a[40:43], v[164:167]
v_mov_b32 v102, v100
v_mov_b32 v110, v108
v_mfma_f32_16x16x32_bf16 v[188:191], a[96:99], a[48:51], v[188:191]
ds_read_b128 a[136:139], v5 offset:24576
v_mov_b32 v118, v116
v_mfma_f32_16x16x32_bf16 v[188:191], a[100:103], a[52:55], v[188:191]
v_mov_b32 v126, v124
v_mfma_f32_16x16x32_bf16 v[212:215], a[100:103], a[60:63], v[212:215]
buffer_load_dwordx4 a[4:7], v2, s[40:43], s33 offen offset:0 sc1
v_mfma_f32_16x16x32_bf16 v[212:215], a[96:99], a[56:59], v[212:215]
ds_read_b128 a[140:143], v5 offset:30720
v_mfma_f32_16x16x32_bf16 v[216:219], a[104:107], a[56:59], v[216:219]
v_permlane16_swap_b32 v92, v94
v_mfma_f32_16x16x32_bf16 v[216:219], a[108:111], a[60:63], v[216:219]
ds_read_b128 a[144:147], v5 offset:25600
v_mfma_f32_16x16x32_bf16 v[192:195], a[108:111], a[52:55], v[192:195]
v_permlane16_swap_b32 v100, v102
v_mfma_f32_16x16x32_bf16 v[192:195], a[104:107], a[48:51], v[192:195]
buffer_load_dwordx4 a[160:163], v3, s[40:43], s63 offen sc1
v_mfma_f32_16x16x32_bf16 v[168:171], a[104:107], a[40:43], v[168:171]
ds_read_b128 a[148:151], v5 offset:31744
v_mfma_f32_16x16x32_bf16 v[168:171], a[108:111], a[44:47], v[168:171]
ds_read_b128 a[152:155], v6 offset:27648
v_mfma_f32_16x16x32_bf16 v[144:147], a[108:111], a[36:39], v[144:147]
v_permlane16_swap_b32 v108, v110
v_mfma_f32_16x16x32_bf16 v[144:147], a[104:107], a[32:35], v[144:147]
v_permlane16_swap_b32 v116, v118
v_mfma_f32_16x16x32_bf16 v[148:151], a[112:115], a[32:35], v[148:151]
buffer_load_dwordx4 a[8:11], v2, s[40:43], s35 offen offset:1024 sc1
v_mfma_f32_16x16x32_bf16 v[148:151], a[116:119], a[36:39], v[148:151]
v_permlane16_swap_b32 v124, v126
v_mfma_f32_16x16x32_bf16 v[172:175], a[116:119], a[44:47], v[172:175]
v_add_f32 v92, v92, v94
v_add_f32 v100, v100, v102
v_mfma_f32_16x16x32_bf16 v[172:175], a[112:115], a[40:43], v[172:175]
v_add_f32 v108, v108, v110
v_add_f32 v116, v116, v118
v_mfma_f32_16x16x32_bf16 v[196:199], a[112:115], a[48:51], v[196:199]
v_add_f32 v124, v124, v126
v_mov_b32 v94, v92
v_mfma_f32_16x16x32_bf16 v[196:199], a[116:119], a[52:55], v[196:199]
buffer_load_dwordx4 a[12:15], v2, s[40:43], s33 offen offset:1024 sc1
v_mfma_f32_16x16x32_bf16 v[220:223], a[116:119], a[60:63], v[220:223]
v_mov_b32 v102, v100
v_mov_b32 v110, v108
v_mfma_f32_16x16x32_bf16 v[220:223], a[112:115], a[56:59], v[220:223]
v_mov_b32 v118, v116
v_mov_b32 v126, v124
v_mfma_f32_16x16x32_bf16 a[172:175], a[120:123], a[168:171], a[172:175]
s_waitcnt lgkmcnt(0)
v_mfma_f32_16x16x32_bf16 v[224:227], a[128:131], a[56:59], v[224:227]
ds_read_b128 a[96:99], v5 offset:38912
v_mfma_f32_16x16x32_bf16 v[224:227], a[132:135], a[60:63], v[224:227]
buffer_load_dwordx4 a[16:19], v2, s[40:43], s35 offen offset:2048 sc1
v_mfma_f32_16x16x32_bf16 v[200:203], a[132:135], a[52:55], v[200:203]
ds_read_b128 a[100:103], v5 offset:45056
v_mfma_f32_16x16x32_bf16 v[200:203], a[128:131], a[48:51], v[200:203]
v_permlane32_swap_b32 v92, v94
v_mfma_f32_16x16x32_bf16 v[176:179], a[128:131], a[40:43], v[176:179]
ds_read_b128 a[104:107], v5 offset:39936
v_mfma_f32_16x16x32_bf16 v[176:179], a[132:135], a[44:47], v[176:179]
buffer_load_dwordx4 v1, s[4:7], s44 offen offset:2048 sc1 lds
s_add_u32 s63, s28, 28
v_mfma_f32_16x16x32_bf16 v[152:155], a[132:135], a[36:39], v[152:155]
s_lshl_b32 s63, s63, 12
ds_read_b128 a[108:111], v5 offset:46080
v_mfma_f32_16x16x32_bf16 v[152:155], a[128:131], a[32:35], v[152:155]
v_permlane32_swap_b32 v100, v102
v_mfma_f32_16x16x32_bf16 v[132:135], a[136:139], a[32:35], v[132:135]
v_permlane32_swap_b32 v108, v110
v_mfma_f32_16x16x32_bf16 v[132:135], a[140:143], a[36:39], v[132:135]
buffer_load_dwordx4 a[20:23], v2, s[40:43], s33 offen offset:2048 sc1
v_mfma_f32_16x16x32_bf16 v[156:159], a[140:143], a[44:47], v[156:159]
ds_read_b128 a[112:115], v5 offset:40960
v_mfma_f32_16x16x32_bf16 v[156:159], a[136:139], a[40:43], v[156:159]
ds_read_b128 a[116:119], v5 offset:47104
v_mfma_f32_16x16x32_bf16 v[180:183], a[136:139], a[48:51], v[180:183]
v_permlane32_swap_b32 v116, v118
v_mfma_f32_16x16x32_bf16 v[180:183], a[140:143], a[52:55], v[180:183]
buffer_load_dwordx4 a[24:27], v2, s[40:43], s35 offen offset:3072 sc1
v_mfma_f32_16x16x32_bf16 v[204:207], a[140:143], a[60:63], v[204:207]
ds_read_b128 a[120:123], v6 offset:28672
v_mfma_f32_16x16x32_bf16 v[204:207], a[136:139], a[56:59], v[204:207]
v_permlane32_swap_b32 v124, v126
v_mfma_f32_16x16x32_bf16 v[208:211], a[144:147], a[56:59], v[208:211]
v_mul_f32 v82, 0xba800000, v92
v_mul_f32 v84, 0xba800000, v100
v_mfma_f32_16x16x32_bf16 v[208:211], a[148:151], a[60:63], v[208:211]
buffer_load_dwordx4 a[164:167], v3, s[40:43], s63 offen sc1
s_add_u32 m0, s19, 49152
v_mfma_f32_16x16x32_bf16 v[184:187], a[148:151], a[52:55], v[184:187]
s_add_u32 s44, s85, 0xa04000
v_mul_f32 v86, 0xba800000, v108
v_mfma_f32_16x16x32_bf16 v[184:187], a[144:147], a[48:51], v[184:187]
v_mul_f32 v88, 0xba800000, v116
v_mul_f32 v90, 0xba800000, v124
v_mfma_f32_16x16x32_bf16 v[160:163], a[144:147], a[40:43], v[160:163]
v_mul_f32 v94, 0x3a800000, v94
v_mul_f32 v102, 0x3a800000, v102
v_mfma_f32_16x16x32_bf16 v[160:163], a[148:151], a[44:47], v[160:163]
buffer_load_dwordx4 a[28:31], v2, s[40:43], s33 offen offset:3072 sc1
s_add_u32 s35, s35, 8192
v_mfma_f32_16x16x32_bf16 v[136:139], a[148:151], a[36:39], v[136:139]
s_add_u32 s33, s33, 8192
v_mul_f32 v110, 0x3a800000, v110
v_mfma_f32_16x16x32_bf16 v[136:139], a[144:147], a[32:35], v[136:139]
v_mul_f32 v118, 0x3a800000, v118
v_mul_f32 v126, 0x3a800000, v126
v_mfma_f32_16x16x32_bf16 a[176:179], a[152:155], a[168:171], a[176:179]
v_fma_f32 v94, -v82, v82, v94
s_waitcnt vmcnt(11) lgkmcnt(0)
v_mfma_f32_16x16x32_bf16 v[140:143], a[96:99], a[64:67], v[140:143]
ds_read_b128 a[128:131], v5 offset:41984
v_fma_f32 v102, -v84, v84, v102
v_mfma_f32_16x16x32_bf16 v[140:143], a[100:103], a[68:71], v[140:143]
buffer_load_dwordx4 a[32:35], v2, s[40:43], s35 offen offset:0 sc1
v_mfma_f32_16x16x32_bf16 v[164:167], a[100:103], a[76:79], v[164:167]
ds_read_b128 a[132:135], v5 offset:48128
v_fma_f32 v110, -v86, v86, v110
v_mfma_f32_16x16x32_bf16 v[164:167], a[96:99], a[72:75], v[164:167]
v_fma_f32 v118, -v88, v88, v118
v_fma_f32 v126, -v90, v90, v126
v_mfma_f32_16x16x32_bf16 v[188:191], a[96:99], a[80:83], v[188:191]
ds_read_b128 a[136:139], v5 offset:36864
v_max_f32 v94, 0, v94
v_mfma_f32_16x16x32_bf16 v[188:191], a[100:103], a[84:87], v[188:191]
v_max_f32 v102, 0, v102
v_max_f32 v110, 0, v110
v_mfma_f32_16x16x32_bf16 v[212:215], a[100:103], a[92:95], v[212:215]
buffer_load_dwordx4 a[36:39], v2, s[40:43], s33 offen offset:0 sc1
v_mfma_f32_16x16x32_bf16 v[212:215], a[96:99], a[88:91], v[212:215]
ds_read_b128 a[140:143], v5 offset:43008
v_max_f32 v118, 0, v118
v_max_f32 v126, 0, v126
v_add_f32 v94, 0x3727c5ac, v94
v_add_f32 v102, 0x3727c5ac, v102
v_add_f32 v110, 0x3727c5ac, v110
v_add_f32 v118, 0x3727c5ac, v118
v_add_f32 v126, 0x3727c5ac, v126
v_rsq_f32 v83, v94
v_rsq_f32 v85, v102
v_rsq_f32 v87, v110
v_rsq_f32 v89, v118
v_rsq_f32 v91, v126
v_mfma_f32_16x16x32_bf16 v[216:219], a[104:107], a[88:91], v[216:219]
v_mfma_f32_16x16x32_bf16 v[216:219], a[108:111], a[92:95], v[216:219]
ds_read_b128 a[144:147], v5 offset:37888
v_mfma_f32_16x16x32_bf16 v[192:195], a[108:111], a[84:87], v[192:195]
L_stub12:
s_cbranch_execz L_stub13
v_fmac_f32 v140, v56, v82
v_mfma_f32_16x16x32_bf16 v[192:195], a[104:107], a[80:83], v[192:195]
buffer_load_dwordx4 v1, s[4:7], s44 offen offset:0 sc1 lds
v_mfma_f32_16x16x32_bf16 v[168:171], a[104:107], a[72:75], v[168:171]
ds_read_b128 a[148:151], v5 offset:44032
v_fmac_f32 v164, v56, v84
v_mfma_f32_16x16x32_bf16 v[168:171], a[108:111], a[76:79], v[168:171]
ds_read_b128 a[152:155], v6 offset:29696
v_mfma_f32_16x16x32_bf16 v[144:147], a[108:111], a[68:71], v[144:147]
v_fmac_f32 v188, v56, v86
v_mfma_f32_16x16x32_bf16 v[144:147], a[104:107], a[64:67], v[144:147]
v_mfma_f32_16x16x32_bf16 v[148:151], a[112:115], a[64:67], v[148:151]
buffer_load_dwordx4 a[40:43], v2, s[40:43], s35 offen offset:1024 sc1
v_mfma_f32_16x16x32_bf16 v[148:151], a[116:119], a[68:71], v[148:151]
v_fmac_f32 v212, v56, v88
v_mfma_f32_16x16x32_bf16 v[172:175], a[116:119], a[76:79], v[172:175]
v_fmac_f32 v216, v60, v88
v_mfma_f32_16x16x32_bf16 v[172:175], a[112:115], a[72:75], v[172:175]
v_mfma_f32_16x16x32_bf16 v[196:199], a[112:115], a[80:83], v[196:199]
v_fmac_f32 v192, v60, v86
v_mfma_f32_16x16x32_bf16 v[196:199], a[116:119], a[84:87], v[196:199]
buffer_load_dwordx4 a[44:47], v2, s[40:43], s33 offen offset:1024 sc1
v_mfma_f32_16x16x32_bf16 v[220:223], a[116:119], a[92:95], v[220:223]
v_fmac_f32 v168, v60, v84
v_fmac_f32 v141, v57, v82
v_mfma_f32_16x16x32_bf16 v[220:223], a[112:115], a[88:91], v[220:223]
v_mfma_f32_16x16x32_bf16 a[180:183], a[120:123], a[168:171], a[180:183]
s_waitcnt vmcnt(9) lgkmcnt(0)
s_barrier
v_mfma_f32_16x16x32_bf16 v[224:227], a[128:131], a[88:91], v[224:227]
v_add_u32 v5, 0, v1
v_add_u32 v6, s55, v5
v_mfma_f32_16x16x32_bf16 v[224:227], a[132:135], a[92:95], v[224:227]
buffer_load_dwordx4 a[48:51], v2, s[40:43], s35 offen offset:2048 sc1
v_mfma_f32_16x16x32_bf16 v[200:203], a[132:135], a[84:87], v[200:203]
ds_read_b128 a[96:99], v5 offset:2048
v_fmac_f32 v144, v60, v82
v_mfma_f32_16x16x32_bf16 v[200:203], a[128:131], a[80:83], v[200:203]
ds_read_b128 a[100:103], v5 offset:8192
v_fmac_f32 v148, v64, v82
v_mfma_f32_16x16x32_bf16 v[176:179], a[128:131], a[72:75], v[176:179]
ds_read_b128 a[104:107], v5 offset:3072
v_fmac_f32 v172, v64, v84
v_mfma_f32_16x16x32_bf16 v[176:179], a[132:135], a[76:79], v[176:179]
v_fmac_f32 v196, v64, v86
v_fmac_f32 v165, v57, v84
v_mfma_f32_16x16x32_bf16 v[152:155], a[132:135], a[68:71], v[152:155]
buffer_load_dwordx4 a[52:55], v2, s[40:43], s33 offen offset:2048 sc1
v_mfma_f32_16x16x32_bf16 v[152:155], a[128:131], a[64:67], v[152:155]
ds_read_b128 a[108:111], v5 offset:9216
v_fmac_f32 v220, v64, v88
v_mfma_f32_16x16x32_bf16 v[132:135], a[136:139], a[64:67], v[132:135]
ds_read_b128 a[112:115], v5 offset:4096
v_fmac_f32 v189, v57, v86
v_mfma_f32_16x16x32_bf16 v[132:135], a[140:143], a[68:71], v[132:135]
v_fmac_f32 v213, v57, v88
v_fmac_f32 v217, v61, v88
v_mfma_f32_16x16x32_bf16 v[156:159], a[140:143], a[76:79], v[156:159]
ds_read_b128 a[116:119], v5 offset:10240
v_fmac_f32 v224, v68, v88
v_mfma_f32_16x16x32_bf16 v[156:159], a[136:139], a[72:75], v[156:159]
buffer_load_dwordx4 v1, s[4:7], s44 offen offset:1024 sc1 lds
v_mfma_f32_16x16x32_bf16 v[180:183], a[136:139], a[80:83], v[180:183]
ds_read_b128 a[120:123], v6 offset:2048
v_fmac_f32 v200, v68, v86
v_mfma_f32_16x16x32_bf16 v[180:183], a[140:143], a[84:87], v[180:183]
v_fmac_f32 v193, v61, v86
v_fmac_f32 v169, v61, v84
v_mfma_f32_16x16x32_bf16 v[204:207], a[140:143], a[92:95], v[204:207]
ds_read_b128 a[124:127], v6 offset:26624
v_fmac_f32 v176, v68, v84
v_mfma_f32_16x16x32_bf16 v[204:207], a[136:139], a[88:91], v[204:207]
v_fmac_f32 v145, v61, v82
v_fmac_f32 v149, v65, v82
v_mfma_f32_16x16x32_bf16 v[208:211], a[144:147], a[88:91], v[208:211]
buffer_load_dwordx4 a[56:59], v2, s[40:43], s35 offen offset:3072 sc1
v_mfma_f32_16x16x32_bf16 v[208:211], a[148:151], a[92:95], v[208:211]
v_fmac_f32 v152, v68, v82
v_fmac_f32 v173, v65, v84
v_mfma_f32_16x16x32_bf16 v[184:187], a[148:151], a[84:87], v[184:187]
v_fmac_f32 v132, v48, v82
v_fmac_f32 v197, v65, v86
v_mfma_f32_16x16x32_bf16 v[184:187], a[144:147], a[80:83], v[184:187]
v_fmac_f32 v221, v65, v88
v_mfma_f32_16x16x32_bf16 v[160:163], a[144:147], a[72:75], v[160:163]
v_fmac_f32 v156, v48, v84
v_mfma_f32_16x16x32_bf16 v[160:163], a[148:151], a[76:79], v[160:163]
buffer_load_dwordx4 a[60:63], v2, s[40:43], s33 offen offset:3072 sc1
s_add_u32 s35, s35, 8192
v_mfma_f32_16x16x32_bf16 v[136:139], a[148:151], a[68:71], v[136:139]
s_add_u32 s33, s33, 8192
v_fmac_f32 v180, v48, v86
v_mfma_f32_16x16x32_bf16 v[136:139], a[144:147], a[64:67], v[136:139]
v_fmac_f32 v225, v69, v88
v_mfma_f32_16x16x32_bf16 a[184:187], a[152:155], a[168:171], a[184:187]
v_fmac_f32 v204, v48, v88
s_waitcnt vmcnt(10) lgkmcnt(0)
v_mfma_f32_16x16x32_bf16 v[140:143], a[96:99], a[0:3], v[140:143]
ds_read_b128 a[128:131], v5 offset:5120
v_fmac_f32 v201, v69, v86
v_mfma_f32_16x16x32_bf16 v[140:143], a[100:103], a[4:7], v[140:143]
buffer_load_dwordx4 a[64:67], v2, s[40:43], s35 offen offset:0 sc1
s_lshl_b32 s37, s28, 10
v_mfma_f32_16x16x32_bf16 v[164:167], a[100:103], a[12:15], v[164:167]
ds_read_b128 a[132:135], v5 offset:11264
v_fmac_f32 v208, v52, v88
v_mfma_f32_16x16x32_bf16 v[164:167], a[96:99], a[8:11], v[164:167]
v_fmac_f32 v184, v52, v86
v_fmac_f32 v177, v69, v84
v_mfma_f32_16x16x32_bf16 v[188:191], a[96:99], a[16:19], v[188:191]
ds_read_b128 a[136:139], v5 offset:0
v_fmac_f32 v153, v69, v82
v_mfma_f32_16x16x32_bf16 v[188:191], a[100:103], a[20:23], v[188:191]
buffer_load_dwordx4 a[68:71], v2, s[40:43], s33 offen offset:0 sc1
s_lshl_b32 s72, s30, 12
v_mfma_f32_16x16x32_bf16 v[212:215], a[100:103], a[28:31], v[212:215]
ds_read_b128 a[140:143], v5 offset:6144
v_fmac_f32 v160, v52, v84
v_mfma_f32_16x16x32_bf16 v[212:215], a[96:99], a[24:27], v[212:215]
v_fmac_f32 v136, v52, v82
v_fmac_f32 v133, v49, v82
v_mfma_f32_16x16x32_bf16 v[216:219], a[104:107], a[24:27], v[216:219]
ds_read_b128 a[144:147], v5 offset:1024
v_fmac_f32 v157, v49, v84
v_mfma_f32_16x16x32_bf16 v[216:219], a[108:111], a[28:31], v[216:219]
buffer_load_dwordx4 a[72:75], v2, s[40:43], s35 offen offset:1024 sc1
s_add_u32 s72, s72, 0x1e00000
v_mfma_f32_16x16x32_bf16 v[192:195], a[108:111], a[20:23], v[192:195]
ds_read_b128 a[148:151], v5 offset:7168
v_fmac_f32 v181, v49, v86
v_mfma_f32_16x16x32_bf16 v[192:195], a[104:107], a[16:19], v[192:195]
v_fmac_f32 v205, v49, v88
v_fmac_f32 v142, v58, v82
v_mfma_f32_16x16x32_bf16 v[168:171], a[104:107], a[8:11], v[168:171]
ds_read_b128 a[152:155], v6 offset:3072
v_fmac_f32 v166, v58, v84
v_mfma_f32_16x16x32_bf16 v[168:171], a[108:111], a[12:15], v[168:171]
v_fmac_f32 v209, v53, v88
v_add_u32 v233, s37, v1
v_mfma_f32_16x16x32_bf16 v[144:147], a[108:111], a[4:7], v[144:147]
buffer_load_dwordx4 a[76:79], v2, s[40:43], s33 offen offset:1024 sc1
v_mfma_f32_16x16x32_bf16 v[144:147], a[104:107], a[0:3], v[144:147]
ds_read_b128 a[156:159], v6 offset:27648
v_fmac_f32 v185, v53, v86
v_mfma_f32_16x16x32_bf16 v[148:151], a[112:115], a[0:3], v[148:151]
v_fmac_f32 v190, v58, v86
v_fmac_f32 v214, v58, v88
v_mfma_f32_16x16x32_bf16 v[148:151], a[116:119], a[4:7], v[148:151]
v_fmac_f32 v161, v53, v84
v_add_u32 v232, s19, v7
v_mfma_f32_16x16x32_bf16 v[172:175], a[116:119], a[12:15], v[172:175]
buffer_load_dwordx4 a[80:83], v2, s[40:43], s35 offen offset:2048 sc1
v_mfma_f32_16x16x32_bf16 v[172:175], a[112:115], a[8:11], v[172:175]
v_fmac_f32 v137, v53, v82
v_fmac_f32 v218, v62, v88
v_mfma_f32_16x16x32_bf16 v[196:199], a[112:115], a[16:19], v[196:199]
v_fmac_f32 v194, v62, v86
v_add_u32 v248, s19, v8
v_mfma_f32_16x16x32_bf16 v[196:199], a[116:119], a[20:23], v[196:199]
v_mfma_f32_16x16x32_bf16 v[220:223], a[116:119], a[28:31], v[220:223]
buffer_load_dwordx4 a[84:87], v2, s[40:43], s33 offen offset:2048 sc1
v_mfma_f32_16x16x32_bf16 v[220:223], a[112:115], a[24:27], v[220:223]
v_fmac_f32 v170, v62, v84
v_fmac_f32 v143, v59, v82
v_mfma_f32_16x16x32_bf16 a[172:175], a[120:123], a[160:163], a[172:175]
v_fmac_f32 v146, v62, v82
v_fmac_f32 v167, v59, v84
v_mfma_f32_16x16x32_bf16 a[172:175], a[124:127], a[164:167], a[172:175]
s_waitcnt lgkmcnt(0)
v_mfma_f32_16x16x32_bf16 v[224:227], a[128:131], a[24:27], v[224:227]
ds_read_b128 a[96:99], v5 offset:14336
v_fmac_f32 v150, v66, v82
v_mfma_f32_16x16x32_bf16 v[224:227], a[132:135], a[28:31], v[224:227]
buffer_load_dwordx4 a[88:91], v2, s[40:43], s35 offen offset:3072 sc1
v_mfma_f32_16x16x32_bf16 v[200:203], a[132:135], a[20:23], v[200:203]
ds_read_b128 a[100:103], v5 offset:20480
v_fmac_f32 v174, v66, v84
v_mfma_f32_16x16x32_bf16 v[200:203], a[128:131], a[16:19], v[200:203]
v_fmac_f32 v191, v59, v86
v_fmac_f32 v215, v59, v88
v_mfma_f32_16x16x32_bf16 v[176:179], a[128:131], a[8:11], v[176:179]
ds_read_b128 a[104:107], v5 offset:15360
v_fmac_f32 v198, v66, v86
v_mfma_f32_16x16x32_bf16 v[176:179], a[132:135], a[12:15], v[176:179]
v_fmac_f32 v219, v63, v88
v_mfma_f32_16x16x32_bf16 v[152:155], a[132:135], a[4:7], v[152:155]
buffer_load_dwordx4 v1, s[4:7], s44 offen offset:2048 sc1 lds
v_mfma_f32_16x16x32_bf16 v[152:155], a[128:131], a[0:3], v[152:155]
ds_read_b128 a[108:111], v5 offset:21504
v_fmac_f32 v222, v66, v88
v_mfma_f32_16x16x32_bf16 v[132:135], a[136:139], a[0:3], v[132:135]
ds_read_b128 a[112:115], v5 offset:16384
v_fmac_f32 v195, v63, v86
v_mfma_f32_16x16x32_bf16 v[132:135], a[140:143], a[4:7], v[132:135]
v_fmac_f32 v171, v63, v84
v_mfma_f32_16x16x32_bf16 v[156:159], a[140:143], a[12:15], v[156:159]
ds_read_b128 a[116:119], v5 offset:22528
v_fmac_f32 v226, v70, v88
v_mfma_f32_16x16x32_bf16 v[156:159], a[136:139], a[8:11], v[156:159]
buffer_load_dwordx4 v1, s[4:7], s44 offen offset:3072 sc1 lds
s_add_u32 m0, s19, 65536
v_mfma_f32_16x16x32_bf16 v[180:183], a[136:139], a[16:19], v[180:183]
s_add_u32 s44, s84, 0xa08000
ds_read_b128 a[120:123], v6 offset:4096
v_mfma_f32_16x16x32_bf16 v[180:183], a[140:143], a[20:23], v[180:183]
v_fmac_f32 v202, v70, v86
v_fmac_f32 v147, v63, v82
v_mfma_f32_16x16x32_bf16 v[204:207], a[140:143], a[28:31], v[204:207]
ds_read_b128 a[124:127], v6 offset:28672
v_fmac_f32 v178, v70, v84
v_mfma_f32_16x16x32_bf16 v[204:207], a[136:139], a[24:27], v[204:207]
v_fmac_f32 v151, v67, v82
v_fmac_f32 v175, v67, v84
v_mfma_f32_16x16x32_bf16 v[208:211], a[144:147], a[24:27], v[208:211]
buffer_load_dwordx4 a[92:95], v2, s[40:43], s33 offen offset:3072 sc1
s_add_u32 s35, s35, 8192
v_mfma_f32_16x16x32_bf16 v[208:211], a[148:151], a[28:31], v[208:211]
s_add_u32 s33, s33, 8192
v_fmac_f32 v154, v70, v82
v_mfma_f32_16x16x32_bf16 v[184:187], a[148:151], a[20:23], v[184:187]
v_fmac_f32 v134, v50, v82
v_fmac_f32 v199, v67, v86
v_mfma_f32_16x16x32_bf16 v[184:187], a[144:147], a[16:19], v[184:187]
v_fmac_f32 v223, v67, v88
v_mfma_f32_16x16x32_bf16 v[160:163], a[144:147], a[8:11], v[160:163]
v_fmac_f32 v158, v50, v84
v_mfma_f32_16x16x32_bf16 v[160:163], a[148:151], a[12:15], v[160:163]
buffer_load_dwordx4 v1, s[4:7], s44 offen offset:0 sc1 lds
v_mfma_f32_16x16x32_bf16 v[136:139], a[148:151], a[4:7], v[136:139]
v_fmac_f32 v182, v50, v86
v_fmac_f32 v227, v71, v88
v_mfma_f32_16x16x32_bf16 v[136:139], a[144:147], a[0:3], v[136:139]
v_mfma_f32_16x16x32_bf16 a[176:179], a[152:155], a[160:163], a[176:179]
v_fmac_f32 v206, v50, v88
v_fmac_f32 v203, v71, v86
v_mfma_f32_16x16x32_bf16 a[176:179], a[156:159], a[164:167], a[176:179]
s_waitcnt vmcnt(11) lgkmcnt(0)
v_mfma_f32_16x16x32_bf16 v[140:143], a[96:99], a[32:35], v[140:143]
ds_read_b128 a[128:131], v5 offset:17408
v_fmac_f32 v210, v54, v88
v_mfma_f32_16x16x32_bf16 v[140:143], a[100:103], a[36:39], v[140:143]
buffer_load_dwordx4 a[0:3], v2, s[40:43], s35 offen offset:0 sc1
v_mfma_f32_16x16x32_bf16 v[164:167], a[100:103], a[44:47], v[164:167]
ds_read_b128 a[132:135], v5 offset:23552
v_fmac_f32 v186, v54, v86
v_mfma_f32_16x16x32_bf16 v[164:167], a[96:99], a[40:43], v[164:167]
v_fmac_f32 v179, v71, v84
v_fmac_f32 v155, v71, v82
v_mfma_f32_16x16x32_bf16 v[188:191], a[96:99], a[48:51], v[188:191]
buffer_load_dwordx4 a[4:7], v2, s[40:43], s33 offen offset:0 sc1
v_mfma_f32_16x16x32_bf16 v[188:191], a[100:103], a[52:55], v[188:191]
ds_read_b128 a[136:139], v5 offset:26624
v_fmac_f32 v162, v54, v84
v_mfma_f32_16x16x32_bf16 v[212:215], a[100:103], a[60:63], v[212:215]
ds_read_b128 a[140:143], v5 offset:32768
v_fmac_f32 v138, v54, v82
v_mfma_f32_16x16x32_bf16 v[212:215], a[96:99], a[56:59], v[212:215]
buffer_load_dwordx4 a[8:11], v2, s[40:43], s35 offen offset:1024 sc1
v_mfma_f32_16x16x32_bf16 v[216:219], a[104:107], a[56:59], v[216:219]
ds_read_b128 a[144:147], v5 offset:27648
v_fmac_f32 v135, v51, v82
v_mfma_f32_16x16x32_bf16 v[216:219], a[108:111], a[60:63], v[216:219]
v_fmac_f32 v159, v51, v84
v_fmac_f32 v183, v51, v86
v_mfma_f32_16x16x32_bf16 v[192:195], a[108:111], a[52:55], v[192:195]
buffer_load_dwordx4 a[12:15], v2, s[40:43], s33 offen offset:1024 sc1
v_mfma_f32_16x16x32_bf16 v[192:195], a[104:107], a[48:51], v[192:195]
ds_read_b128 a[148:151], v5 offset:33792
v_fmac_f32 v207, v51, v88
v_mfma_f32_16x16x32_bf16 v[168:171], a[104:107], a[40:43], v[168:171]
ds_read_b128 a[152:155], v6 offset:5120
v_fmac_f32 v211, v55, v88
v_mfma_f32_16x16x32_bf16 v[168:171], a[108:111], a[44:47], v[168:171]
v_mul_f32 v88, 0x3e8293ee, v89
v_mfma_f32_16x16x32_bf16 v[144:147], a[108:111], a[36:39], v[144:147]
buffer_load_dwordx4 a[16:19], v2, s[40:43], s35 offen offset:2048 sc1
v_mfma_f32_16x16x32_bf16 v[144:147], a[104:107], a[32:35], v[144:147]
ds_read_b128 a[156:159], v6 offset:29696
v_fmac_f32 v187, v55, v86
v_mfma_f32_16x16x32_bf16 v[148:151], a[112:115], a[32:35], v[148:151]
v_fmac_f32 v163, v55, v84
v_mul_f32 v86, 0x3e8293ee, v87
v_mfma_f32_16x16x32_bf16 v[148:151], a[116:119], a[36:39], v[148:151]
buffer_load_dwordx4 a[20:23], v2, s[40:43], s33 offen offset:2048 sc1
v_mfma_f32_16x16x32_bf16 v[172:175], a[116:119], a[44:47], v[172:175]
v_fmac_f32 v139, v55, v82
v_mul_f32 v84, 0x3e8293ee, v85
v_mfma_f32_16x16x32_bf16 v[172:175], a[112:115], a[40:43], v[172:175]
v_mul_f32 v82, 0x3e8293ee, v83
v_mfma_f32_16x16x32_bf16 v[196:199], a[112:115], a[48:51], v[196:199]
buffer_load_dwordx4 a[24:27], v2, s[40:43], s35 offen offset:3072 sc1
v_mfma_f32_16x16x32_bf16 v[196:199], a[116:119], a[52:55], v[196:199]
v_mfma_f32_16x16x32_bf16 v[220:223], a[116:119], a[60:63], v[220:223]
v_mfma_f32_16x16x32_bf16 v[220:223], a[112:115], a[56:59], v[220:223]
buffer_load_dwordx4 a[28:31], v2, s[40:43], s33 offen offset:3072 sc1
s_add_u32 s35, s35, 8192
v_mfma_f32_16x16x32_bf16 a[180:183], a[120:123], a[160:163], a[180:183]
s_add_u32 s33, s33, 8192
v_mfma_f32_16x16x32_bf16 a[180:183], a[124:127], a[164:167], a[180:183]
s_waitcnt lgkmcnt(0)
v_mfma_f32_16x16x32_bf16 v[224:227], a[128:131], a[56:59], v[224:227]
ds_read_b128 a[96:99], v5 offset:28672
s_lshl_b32 s90, s28, 12
v_mfma_f32_16x16x32_bf16 v[224:227], a[132:135], a[60:63], v[224:227]
buffer_load_dwordx4 v1, s[4:7], s44 offen offset:1024 sc1 lds
s_add_u32 s90, s90, 147456
v_mfma_f32_16x16x32_bf16 v[200:203], a[132:135], a[52:55], v[200:203]
ds_read_b128 a[100:103], v5 offset:34816
v_add_u32 v234, s90, v1
v_mfma_f32_16x16x32_bf16 v[200:203], a[128:131], a[48:51], v[200:203]
s_lshl_b32 s90, s28, 10
s_add_u32 s90, s90, 147456
v_mfma_f32_16x16x32_bf16 v[176:179], a[128:131], a[40:43], v[176:179]
v_add_u32 v235, s90, v1
v_mfma_f32_16x16x32_bf16 v[176:179], a[132:135], a[44:47], v[176:179]
ds_read_b128 a[104:107], v5 offset:29696
v_mfma_f32_16x16x32_bf16 v[152:155], a[132:135], a[36:39], v[152:155]
v_mfma_f32_16x16x32_bf16 v[152:155], a[128:131], a[32:35], v[152:155]
s_waitcnt vmcnt(19)
v_mfma_f32_16x16x32_bf16 v[140:143], a[136:139], a[64:67], v[140:143]
ds_read_b128 a[108:111], v5 offset:35840
s_waitcnt vmcnt(18)
v_mfma_f32_16x16x32_bf16 v[140:143], a[140:143], a[68:71], v[140:143]
buffer_load_dwordx4 v1, s[4:7], s44 offen offset:2048 sc1 lds
s_waitcnt vmcnt(17)
v_mfma_f32_16x16x32_bf16 v[164:167], a[140:143], a[76:79], v[164:167]
ds_read_b128 a[112:115], v5 offset:38912
v_mfma_f32_16x16x32_bf16 v[164:167], a[136:139], a[72:75], v[164:167]
s_waitcnt vmcnt(16)
v_mfma_f32_16x16x32_bf16 v[188:191], a[136:139], a[80:83], v[188:191]
s_waitcnt vmcnt(15)
v_mfma_f32_16x16x32_bf16 v[188:191], a[140:143], a[84:87], v[188:191]
ds_read_b128 a[116:119], v5 offset:45056
s_waitcnt vmcnt(11)
v_mfma_f32_16x16x32_bf16 v[212:215], a[140:143], a[92:95], v[212:215]
v_mfma_f32_16x16x32_bf16 v[212:215], a[136:139], a[88:91], v[212:215]
v_mfma_f32_16x16x32_bf16 v[216:219], a[144:147], a[88:91], v[216:219]
v_mfma_f32_16x16x32_bf16 v[216:219], a[148:151], a[92:95], v[216:219]
v_mfma_f32_16x16x32_bf16 v[192:195], a[148:151], a[84:87], v[192:195]
buffer_load_dwordx4 v1, s[4:7], s44 offen offset:3072 sc1 lds
s_add_u32 m0, s19, 81920
v_mfma_f32_16x16x32_bf16 v[192:195], a[144:147], a[80:83], v[192:195]
s_add_u32 s44, s85, 0xa0c000
v_mfma_f32_16x16x32_bf16 v[168:171], a[144:147], a[72:75], v[168:171]
v_mfma_f32_16x16x32_bf16 v[168:171], a[148:151], a[76:79], v[168:171]
v_mfma_f32_16x16x32_bf16 v[144:147], a[148:151], a[68:71], v[144:147]
v_mfma_f32_16x16x32_bf16 v[144:147], a[144:147], a[64:67], v[144:147]
v_mfma_f32_16x16x32_bf16 a[184:187], a[152:155], a[160:163], a[184:187]
v_mfma_f32_16x16x32_bf16 a[184:187], a[156:159], a[164:167], a[184:187]
s_waitcnt lgkmcnt(0)
v_mfma_f32_16x16x32_bf16 v[148:151], a[96:99], a[64:67], v[148:151]
ds_read_b128 a[128:131], v5 offset:39936
v_mfma_f32_16x16x32_bf16 v[148:151], a[100:103], a[68:71], v[148:151]
buffer_load_dwordx4 v1, s[4:7], s44 offen offset:0 sc1 lds
v_mfma_f32_16x16x32_bf16 v[172:175], a[100:103], a[76:79], v[172:175]
ds_read_b128 a[132:135], v5 offset:46080
v_mfma_f32_16x16x32_bf16 v[172:175], a[96:99], a[72:75], v[172:175]
v_mfma_f32_16x16x32_bf16 v[196:199], a[96:99], a[80:83], v[196:199]
v_mfma_f32_16x16x32_bf16 v[196:199], a[100:103], a[84:87], v[196:199]
buffer_load_dwordx4 v1, s[4:7], s44 offen offset:1024 sc1 lds
v_mfma_f32_16x16x32_bf16 v[220:223], a[100:103], a[92:95], v[220:223]
ds_read_b128 a[136:139], v5 offset:40960
v_mfma_f32_16x16x32_bf16 v[220:223], a[96:99], a[88:91], v[220:223]
v_mfma_f32_16x16x32_bf16 v[224:227], a[104:107], a[88:91], v[224:227]
ds_read_b128 a[140:143], v5 offset:47104
v_mfma_f32_16x16x32_bf16 v[224:227], a[108:111], a[92:95], v[224:227]
v_mfma_f32_16x16x32_bf16 v[200:203], a[108:111], a[84:87], v[200:203]
buffer_load_dwordx4 v1, s[4:7], s44 offen offset:2048 sc1 lds
v_mfma_f32_16x16x32_bf16 v[200:203], a[104:107], a[80:83], v[200:203]
ds_read_b128 a[144:147], v5 offset:41984
v_mfma_f32_16x16x32_bf16 v[176:179], a[104:107], a[72:75], v[176:179]
ds_write_b128 v234, a[172:175] offset:0
v_mfma_f32_16x16x32_bf16 v[176:179], a[108:111], a[76:79], v[176:179]
ds_read_b128 a[148:151], v5 offset:48128
v_mfma_f32_16x16x32_bf16 v[152:155], a[108:111], a[68:71], v[152:155]
v_mfma_f32_16x16x32_bf16 v[152:155], a[104:107], a[64:67], v[152:155]
buffer_load_dwordx4 v1, s[4:7], s44 offen offset:3072 sc1 lds
s_add_u32 m0, s19, 98304
s_waitcnt vmcnt(14)
v_mfma_f32_16x16x32_bf16 v[140:143], a[112:115], a[0:3], v[140:143]
s_add_u32 s44, s84, 0xa10000
s_waitcnt vmcnt(13)
v_mfma_f32_16x16x32_bf16 v[140:143], a[116:119], a[4:7], v[140:143]
s_waitcnt vmcnt(11)
v_mfma_f32_16x16x32_bf16 v[164:167], a[116:119], a[12:15], v[164:167]
v_mfma_f32_16x16x32_bf16 v[164:167], a[112:115], a[8:11], v[164:167]
s_waitcnt vmcnt(10)
v_mfma_f32_16x16x32_bf16 v[188:191], a[112:115], a[16:19], v[188:191]
buffer_load_dwordx4 v1, s[4:7], s44 offen offset:0 sc1 lds
s_waitcnt vmcnt(10)
v_mfma_f32_16x16x32_bf16 v[188:191], a[116:119], a[20:23], v[188:191]
s_waitcnt vmcnt(8)
v_mfma_f32_16x16x32_bf16 v[212:215], a[116:119], a[28:31], v[212:215]
ds_write_b128 v234, a[176:179] offset:1024
v_mfma_f32_16x16x32_bf16 v[212:215], a[112:115], a[24:27], v[212:215]
s_waitcnt lgkmcnt(1)
v_mfma_f32_16x16x32_bf16 v[216:219], a[128:131], a[24:27], v[216:219]
ds_read_b128 a[96:99], v5 offset:12288
v_mul_f32 v140, v140, v83
v_mfma_f32_16x16x32_bf16 v[216:219], a[132:135], a[28:31], v[216:219]
buffer_load_dwordx4 v1, s[4:7], s44 offen offset:1024 sc1 lds
v_mfma_f32_16x16x32_bf16 v[192:195], a[132:135], a[20:23], v[192:195]
ds_read_b128 a[100:103], v5 offset:18432
v_mul_f32 v141, v141, v83
v_mfma_f32_16x16x32_bf16 v[192:195], a[128:131], a[16:19], v[192:195]
v_cvt_pk_bf16_f32 v140, v140, v141
v_mul_f32 v164, v164, v85
v_mfma_f32_16x16x32_bf16 v[168:171], a[128:131], a[8:11], v[168:171]
v_mul_f32 v165, v165, v85
v_cvt_pk_bf16_f32 v164, v164, v165
v_mfma_f32_16x16x32_bf16 v[168:171], a[132:135], a[12:15], v[168:171]
buffer_load_dwordx4 v1, s[4:7], s44 offen offset:2048 sc1 lds
v_mfma_f32_16x16x32_bf16 v[144:147], a[132:135], a[4:7], v[144:147]
ds_read_b128 a[104:107], v5 offset:24576
v_mul_f32 v212, v212, v89
v_mfma_f32_16x16x32_bf16 v[144:147], a[128:131], a[0:3], v[144:147]
v_mul_f32 v213, v213, v89
v_cvt_pk_bf16_f32 v212, v212, v213
v_mfma_f32_16x16x32_bf16 v[148:151], a[136:139], a[0:3], v[148:151]
ds_read_b128 a[108:111], v5 offset:30720
v_mul_f32 v214, v214, v89
v_mfma_f32_16x16x32_bf16 v[148:151], a[140:143], a[4:7], v[148:151]
v_mul_f32 v215, v215, v89
v_cvt_pk_bf16_f32 v213, v214, v215
v_mfma_f32_16x16x32_bf16 v[172:175], a[140:143], a[12:15], v[172:175]
buffer_load_dwordx4 v1, s[4:7], s44 offen offset:3072 sc1 lds
s_add_u32 m0, s19, 114688
v_mfma_f32_16x16x32_bf16 v[172:175], a[136:139], a[8:11], v[172:175]
s_add_u32 s44, s85, 0xa14000
ds_read_b128 a[112:115], v5 offset:36864
v_mfma_f32_16x16x32_bf16 v[196:199], a[136:139], a[16:19], v[196:199]
ds_write_b128 v234, a[180:183] offset:2048
v_mul_f32 v216, v216, v89
v_mfma_f32_16x16x32_bf16 v[196:199], a[140:143], a[20:23], v[196:199]
ds_read_b128 a[116:119], v5 offset:43008
v_mul_f32 v217, v217, v89
v_mfma_f32_16x16x32_bf16 v[220:223], a[140:143], a[28:31], v[220:223]
v_cvt_pk_bf16_f32 v214, v216, v217
v_mul_f32 v218, v218, v89
v_mfma_f32_16x16x32_bf16 v[220:223], a[136:139], a[24:27], v[220:223]
buffer_load_dwordx4 v1, s[4:7], s44 offen offset:0 sc1 lds
v_mfma_f32_16x16x32_bf16 v[224:227], a[144:147], a[24:27], v[224:227]
v_mul_f32 v219, v219, v89
v_cvt_pk_bf16_f32 v215, v218, v219
v_mfma_f32_16x16x32_bf16 v[224:227], a[148:151], a[28:31], v[224:227]
v_mul_f32 v148, v148, v83
v_mul_f32 v149, v149, v83
v_mfma_f32_16x16x32_bf16 v[200:203], a[148:151], a[20:23], v[200:203]
v_cvt_pk_bf16_f32 v148, v148, v149
v_mul_f32 v172, v172, v85
v_mfma_f32_16x16x32_bf16 v[200:203], a[144:147], a[16:19], v[200:203]
v_mul_f32 v173, v173, v85
v_cvt_pk_bf16_f32 v172, v172, v173
v_mfma_f32_16x16x32_bf16 v[176:179], a[144:147], a[8:11], v[176:179]
buffer_load_dwordx4 v1, s[4:7], s44 offen offset:1024 sc1 lds
v_mfma_f32_16x16x32_bf16 v[176:179], a[148:151], a[12:15], v[176:179]
v_mul_f32 v196, v196, v87
v_mul_f32 v197, v197, v87
v_mfma_f32_16x16x32_bf16 v[152:155], a[148:151], a[4:7], v[152:155]
ds_write_b128 v234, a[184:187] offset:3072
v_cvt_pk_bf16_f32 v196, v196, v197
v_mfma_f32_16x16x32_bf16 v[152:155], a[144:147], a[0:3], v[152:155]
v_mul_f32 v220, v220, v89
s_waitcnt lgkmcnt(1)
v_mfma_f32_16x16x32_bf16 v[132:135], a[96:99], a[32:35], v[132:135]
ds_read_b128 a[128:131], v5 offset:13312
v_mul_f32 v221, v221, v89
v_mfma_f32_16x16x32_bf16 v[132:135], a[100:103], a[36:39], v[132:135]
buffer_load_dwordx4 v1, s[4:7], s44 offen offset:2048 sc1 lds
v_mfma_f32_16x16x32_bf16 v[156:159], a[100:103], a[44:47], v[156:159]
ds_read_b128 a[132:135], v5 offset:19456
v_cvt_pk_bf16_f32 v220, v220, v221
v_mfma_f32_16x16x32_bf16 v[156:159], a[96:99], a[40:43], v[156:159]
v_mul_f32 v222, v222, v89
v_mul_f32 v223, v223, v89
v_mfma_f32_16x16x32_bf16 v[180:183], a[96:99], a[48:51], v[180:183]
v_cvt_pk_bf16_f32 v221, v222, v223
v_mul_f32 v224, v224, v89
v_mfma_f32_16x16x32_bf16 v[180:183], a[100:103], a[52:55], v[180:183]
buffer_load_dwordx4 v1, s[4:7], s44 offen offset:3072 sc1 lds
s_add_u32 m0, s19, 131072
v_mfma_f32_16x16x32_bf16 v[204:207], a[100:103], a[60:63], v[204:207]
s_add_u32 s44, s86, 0xa18000
ds_read_b128 a[136:139], v5 offset:25600
v_mfma_f32_16x16x32_bf16 v[204:207], a[96:99], a[56:59], v[204:207]
v_mul_f32 v225, v225, v89
v_cvt_pk_bf16_f32 v222, v224, v225
v_mfma_f32_16x16x32_bf16 v[204:207], a[104:107], a[88:91], v[204:207]
ds_read_b128 a[140:143], v5 offset:31744
v_mul_f32 v226, v226, v89
v_mfma_f32_16x16x32_bf16 v[204:207], a[108:111], a[92:95], v[204:207]
v_mul_f32 v227, v227, v89
v_cvt_pk_bf16_f32 v223, v226, v227
v_mfma_f32_16x16x32_bf16 v[180:183], a[108:111], a[84:87], v[180:183]
buffer_load_dwordx4 v1, s[4:7], s44 offen offset:0 sc1 lds
v_mfma_f32_16x16x32_bf16 v[180:183], a[104:107], a[80:83], v[180:183]
ds_read_b128 a[144:147], v5 offset:37888
v_mul_f32 v198, v198, v87
v_mfma_f32_16x16x32_bf16 v[156:159], a[104:107], a[72:75], v[156:159]
v_mul_f32 v199, v199, v87
v_cvt_pk_bf16_f32 v197, v198, v199
v_mfma_f32_16x16x32_bf16 v[156:159], a[108:111], a[76:79], v[156:159]
ds_read_b128 a[148:151], v5 offset:44032
v_mul_f32 v200, v200, v87
v_mfma_f32_16x16x32_bf16 v[132:135], a[108:111], a[68:71], v[132:135]
v_mul_f32 v201, v201, v87
v_cvt_pk_bf16_f32 v198, v200, v201
v_mfma_f32_16x16x32_bf16 v[132:135], a[104:107], a[64:67], v[132:135]
buffer_load_dwordx4 v1, s[4:7], s44 offen offset:1024 sc1 lds
v_mfma_f32_16x16x32_bf16 v[132:135], a[112:115], a[0:3], v[132:135]
v_mul_f32 v202, v202, v87
v_mul_f32 v203, v203, v87
v_mfma_f32_16x16x32_bf16 v[132:135], a[116:119], a[4:7], v[132:135]
v_cvt_pk_bf16_f32 v199, v202, v203
v_mul_f32 v174, v174, v85
v_mfma_f32_16x16x32_bf16 v[156:159], a[116:119], a[12:15], v[156:159]
v_mul_f32 v175, v175, v85
v_cvt_pk_bf16_f32 v173, v174, v175
v_mfma_f32_16x16x32_bf16 v[156:159], a[112:115], a[8:11], v[156:159]
v_mul_f32 v176, v176, v85
v_mul_f32 v177, v177, v85
v_mfma_f32_16x16x32_bf16 v[180:183], a[112:115], a[16:19], v[180:183]
buffer_load_dwordx4 v1, s[4:7], s44 offen offset:2048 sc1 lds
v_mfma_f32_16x16x32_bf16 v[180:183], a[116:119], a[20:23], v[180:183]
v_cvt_pk_bf16_f32 v174, v176, v177
v_mul_f32 v178, v178, v85
v_mfma_f32_16x16x32_bf16 v[204:207], a[116:119], a[28:31], v[204:207]
v_mul_f32 v179, v179, v85
v_cvt_pk_bf16_f32 v175, v178, v179
v_mfma_f32_16x16x32_bf16 v[204:207], a[112:115], a[24:27], v[204:207]
s_waitcnt lgkmcnt(0)
s_barrier
v_mfma_f32_16x16x32_bf16 v[208:211], a[128:131], a[56:59], v[208:211]
ds_read_b128 v[92:95], v235 offset:0
v_cvt_pk_bf16_f32 v132, v132, v133
v_mfma_f32_16x16x32_bf16 v[208:211], a[132:135], a[60:63], v[208:211]
buffer_load_dwordx4 v1, s[4:7], s44 offen offset:3072 sc1 lds
v_mfma_f32_16x16x32_bf16 v[184:187], a[132:135], a[52:55], v[184:187]
ds_read_b128 v[96:99], v235 offset:4096
v_cvt_pk_bf16_f32 v156, v156, v157
v_mfma_f32_16x16x32_bf16 v[184:187], a[128:131], a[48:51], v[184:187]
ds_write_b128 v233, v[212:215] offset:21504
v_cvt_pk_bf16_f32 v133, v134, v135
v_mfma_f32_16x16x32_bf16 v[160:163], a[128:131], a[40:43], v[160:163]
ds_read_b128 v[100:103], v235 offset:8192
v_cvt_pk_bf16_f32 v180, v180, v181
v_mfma_f32_16x16x32_bf16 v[160:163], a[132:135], a[44:47], v[160:163]
ds_write_b64 v232, v[220:221] offset:4096
v_cvt_pk_bf16_f32 v157, v158, v159
v_mfma_f32_16x16x32_bf16 v[136:139], a[132:135], a[36:39], v[136:139]
ds_read_b128 v[104:107], v235 offset:12288
v_cvt_pk_bf16_f32 v204, v204, v205
v_mfma_f32_16x16x32_bf16 v[136:139], a[128:131], a[32:35], v[136:139]
ds_write_b64 v232, v[222:223] offset:4608
v_cvt_pk_bf16_f32 v181, v182, v183
v_mfma_f32_16x16x32_bf16 v[136:139], a[136:139], a[64:67], v[136:139]
ds_write_b64 v232, v[196:197] offset:3072
v_cvt_pk_bf16_f32 v205, v206, v207
v_mfma_f32_16x16x32_bf16 v[136:139], a[140:143], a[68:71], v[136:139]
ds_write_b64 v232, v[198:199] offset:3584
v_mul_f32 v150, v150, v83
v_mfma_f32_16x16x32_bf16 v[160:163], a[140:143], a[76:79], v[160:163]
ds_write_b64 v232, v[172:173] offset:2048
v_mul_f32 v151, v151, v83
v_mfma_f32_16x16x32_bf16 v[160:163], a[136:139], a[72:75], v[160:163]
ds_write_b64 v232, v[174:175] offset:2560
v_cvt_pk_bf16_f32 v149, v150, v151
v_mfma_f32_16x16x32_bf16 v[184:187], a[136:139], a[80:83], v[184:187]
ds_write_b64 v232, v[148:149] offset:1024
s_waitcnt lgkmcnt(10)
v_add_f32 v92, v92, v96
v_mfma_f32_16x16x32_bf16 v[184:187], a[140:143], a[84:87], v[184:187]
v_add_f32 v93, v93, v97
v_add_f32 v94, v94, v98
v_mfma_f32_16x16x32_bf16 v[208:211], a[140:143], a[92:95], v[208:211]
s_waitcnt lgkmcnt(6)
v_add_f32 v100, v100, v104
v_add_f32 v101, v101, v105
v_mfma_f32_16x16x32_bf16 v[208:211], a[136:139], a[88:91], v[208:211]
v_add_f32 v102, v102, v106
v_add_f32 v95, v95, v99
v_mfma_f32_16x16x32_bf16 v[208:211], a[144:147], a[24:27], v[208:211]
v_add_f32 v103, v103, v107
v_add_f32 v228, v92, v100
v_mfma_f32_16x16x32_bf16 v[208:211], a[148:151], a[28:31], v[208:211]
v_add_f32 v229, v93, v101
v_add_f32 v230, v94, v102
v_mfma_f32_16x16x32_bf16 v[184:187], a[148:151], a[20:23], v[184:187]
v_add_f32 v231, v95, v103
v_fmac_f32 v228, v72, v90
v_mfma_f32_16x16x32_bf16 v[184:187], a[144:147], a[16:19], v[184:187]
v_fmac_f32 v229, v73, v90
v_fmac_f32 v230, v74, v90
v_mfma_f32_16x16x32_bf16 v[160:163], a[144:147], a[8:11], v[160:163]
v_fmac_f32 v231, v75, v90
v_mul_f32 v152, v152, v83
v_mfma_f32_16x16x32_bf16 v[160:163], a[148:151], a[12:15], v[160:163]
v_mul_f32 v153, v153, v83
v_cvt_pk_bf16_f32 v150, v152, v153
v_mfma_f32_16x16x32_bf16 v[136:139], a[148:151], a[4:7], v[136:139]
v_mul_f32 v154, v154, v83
v_mul_f32 v155, v155, v83
v_mfma_f32_16x16x32_bf16 v[136:139], a[144:147], a[0:3], v[136:139]
v_cvt_pk_bf16_f32 v151, v154, v155
v_mul_f32 v228, v228, v91
s_add_u32 m0, s19, 32768
s_add_u32 s44, s84, 0xa00000
buffer_load_dwordx4 v1, s[4:7], s44 offen offset:0 sc1 lds
L_stub13:
s_cbranch_execz L_wret4
v_mul_f32 v229, v229, v91
ds_write_b64 v232, v[150:151] offset:1536
v_pk_mul_f32 v[230:231], v[230:231], v[90:91] op_sel:[0,1] op_sel_hi:[1,1]
v_cvt_pk_bf16_f32 v228, v228, v229
v_pk_mul_f32 v[188:189], v[188:189], v[86:87] op_sel:[0,1] op_sel_hi:[1,1]
v_cvt_pk_bf16_f32 v229, v230, v231
v_pk_mul_f32 v[190:191], v[190:191], v[86:87] op_sel:[0,1] op_sel_hi:[1,1]
v_pk_mul_f32 v[166:167], v[166:167], v[84:85] op_sel:[0,1] op_sel_hi:[1,1]
v_pk_mul_f32 v[142:143], v[142:143], v[82:83] op_sel:[0,1] op_sel_hi:[1,1]
v_cvt_pk_bf16_f32 v188, v188, v189
v_pk_mul_f32 v[192:193], v[192:193], v[86:87] op_sel:[0,1] op_sel_hi:[1,1]
v_pk_mul_f32 v[194:195], v[194:195], v[86:87] op_sel:[0,1] op_sel_hi:[1,1]
v_pk_mul_f32 v[168:169], v[168:169], v[84:85] op_sel:[0,1] op_sel_hi:[1,1]
v_pk_mul_f32 v[170:171], v[170:171], v[84:85] op_sel:[0,1] op_sel_hi:[1,1]
v_pk_mul_f32 v[144:145], v[144:145], v[82:83] op_sel:[0,1] op_sel_hi:[1,1]
v_pk_mul_f32 v[146:147], v[146:147], v[82:83] op_sel:[0,1] op_sel_hi:[1,1]
ds_write_b64 v9, v[228:229]
v_cvt_pk_bf16_f32 v189, v190, v191
v_cvt_pk_bf16_f32 v165, v166, v167
v_cvt_pk_bf16_f32 v141, v142, v143
v_cvt_pk_bf16_f32 v190, v192, v193
v_cvt_pk_bf16_f32 v191, v194, v195
v_cvt_pk_bf16_f32 v166, v168, v169
buffer_load_dwordx4 v1, s[4:7], s44 offen offset:1024 sc1 lds
v_cvt_pk_bf16_f32 v167, v170, v171
v_cvt_pk_bf16_f32 v142, v144, v145
v_cvt_pk_bf16_f32 v143, v146, v147
v_cvt_pk_bf16_f32 v134, v136, v137
v_cvt_pk_bf16_f32 v135, v138, v139
v_cvt_pk_bf16_f32 v158, v160, v161
v_cvt_pk_bf16_f32 v159, v162, v163
v_cvt_pk_bf16_f32 v182, v184, v185
v_cvt_pk_bf16_f32 v183, v186, v187
v_cvt_pk_bf16_f32 v206, v208, v209
v_cvt_pk_bf16_f32 v207, v210, v211
buffer_load_dwordx4 v1, s[4:7], s44 offen offset:2048 sc1 lds
buffer_load_dwordx4 v1, s[4:7], s44 offen offset:3072 sc1 lds
s_waitcnt lgkmcnt(0)
s_barrier
s_add_u32 m0, s19, 147456
s_add_u32 s44, s87, 0xa1c000
buffer_load_dwordx4 v1, s[4:7], s44 offen offset:0 sc1 lds
v_mfma_f32_16x16x32_bf16 v[160:163], v[140:143], v[156:159], v[20:23]
ds_read_b128 a[0:3], v233 offset:20480
v_mfma_f32_16x16x32_bf16 v[176:179], v[164:167], v[156:159], v[24:27]
ds_read_b64_tr_b16 a[10:11], v248 offset:3072
v_mfma_f32_16x16x32_bf16 v[208:211], v[188:191], v[204:207], v[20:23]
ds_read_b64_tr_b16 a[12:13], v248 offset:4096
v_mfma_f32_16x16x32_bf16 v[224:227], v[212:215], v[204:207], v[24:27]
s_nop 3
v_max_f32 v176, v176, v160
v_max_f32 v177, v177, v161
v_max_f32 v178, v178, v162
v_max_f32 v179, v179, v163
v_max3_f32 v237, v176, v177, v178
v_max_f32 v237, v237, v179
ds_read_b64_tr_b16 a[22:23], v248 offset:3584
v_max_f32 v224, v224, v208
v_max_f32 v225, v225, v209
v_max_f32 v226, v226, v210
v_max_f32 v227, v227, v211
v_max3_f32 v239, v224, v225, v226
buffer_load_dwordx4 v1, s[4:7], s44 offen offset:1024 sc1 lds
v_max_f32 v239, v239, v227
ds_read_b64_tr_b16 a[24:25], v248 offset:4608
s_nop 0
v_permlane32_swap_b32 v239, v237
v_max_f32 v239, v239, v237
v_mov_b32 v242, v239
s_waitcnt lgkmcnt(4)
v_mfma_f32_16x16x32_bf16 v[136:139], a[0:3], v[132:135], v[76:79]
v_permlane16_swap_b32 v239, v242
v_max_f32 v239, v239, v242
v_mov_b32 v242, v239
v_mfma_f32_16x16x32_bf16 v[152:155], v[140:143], v[132:135], v[24:27]
s_nop 0
v_permlane32_swap_b32 v239, v242
v_mfma_f32_16x16x32_bf16 v[184:187], v[164:167], v[180:183], v[20:23]
v_mul_f32_e64 v89, -v239, v88
v_fma_f32 v224, v224, v88, v89
v_mfma_f32_16x16x32_bf16 v[200:203], v[188:191], v[180:183], v[24:27]
v_fma_f32 v225, v225, v88, v89
v_fma_f32 v226, v226, v88, v89
v_fma_f32 v227, v227, v88, v89
v_exp_f32 v224, v224
buffer_load_dwordx4 v1, s[4:7], s44 offen offset:2048 sc1 lds
v_exp_f32 v225, v225
v_exp_f32 v226, v226
v_exp_f32 v227, v227
v_max_f32 v152, v152, v136
v_max_f32 v153, v153, v137
v_max_f32 v154, v154, v138
v_max_f32 v200, v200, v184
v_max_f32 v201, v201, v185
v_max_f32 v202, v202, v186
v_cvt_pk_bf16_f32 v224, v224, v225
ds_read_b64_tr_b16 a[6:7], v248 offset:1024
ds_read_b64_tr_b16 a[8:9], v248 offset:2048
v_max_f32 v155, v155, v139
v_max3_f32 v236, v152, v153, v154
v_max_f32 v203, v203, v187
v_max3_f32 v238, v200, v201, v202
v_cvt_pk_bf16_f32 v225, v226, v227
ds_read_b64_tr_b16 a[18:19], v248 offset:1536
ds_read_b64_tr_b16 a[20:21], v248 offset:2560
v_max_f32 v236, v236, v155
buffer_load_dwordx4 v1, s[4:7], s44 offen offset:3072 sc1 lds
v_max_f32 v238, v238, v203
v_and_b32 v208, v224, v28
v_and_b32 v209, v225, v29
v_and_b32 v210, v224, v30
v_and_b32 v211, v225, v31
v_permlane32_swap_b32 v238, v236
s_nop 0
v_mfma_f32_16x16x32_bf16 v[216:219], v[16:19], v[208:211], 0
v_max_f32 v238, v238, v236
v_mul_f32_e64 v85, -v242, v84
s_waitcnt lgkmcnt(6)
v_mfma_f32_16x16x32_bf16 v[116:119], a[10:13], v[208:211], 0
v_mov_b32 v243, v238
v_fma_f32 v176, v176, v84, v85
v_fma_f32 v177, v177, v84, v85
v_fma_f32 v178, v178, v84, v85
v_fma_f32 v179, v179, v84, v85
s_waitcnt lgkmcnt(4)
v_mfma_f32_16x16x32_bf16 v[120:123], a[22:25], v[208:211], 0
v_exp_f32 v176, v176
v_exp_f32 v177, v177
v_exp_f32 v178, v178
v_exp_f32 v179, v179
v_permlane16_swap_b32 v238, v243
v_rcp_f32 v216, v216
v_cvt_pk_bf16_f32 v176, v176, v177
v_max_f32 v238, v238, v243
v_cvt_pk_bf16_f32 v177, v178, v179
v_mov_b32 v243, v238
v_and_b32 v160, v176, v28
v_and_b32 v161, v177, v29
v_and_b32 v162, v176, v30
v_and_b32 v163, v177, v31
v_pk_mul_f32 v[116:117], v[116:117], v[216:217] op_sel:[0,0] op_sel_hi:[1,0]
v_pk_mul_f32 v[118:119], v[118:119], v[216:217] op_sel:[0,0] op_sel_hi:[1,0]
v_cvt_pk_bf16_f32 v116, v116, v117
v_pk_mul_f32 v[120:121], v[120:121], v[216:217] op_sel:[0,0] op_sel_hi:[1,0]
v_permlane32_swap_b32 v238, v243
v_pk_mul_f32 v[122:123], v[122:123], v[216:217] op_sel:[0,0] op_sel_hi:[1,0]
v_cvt_pk_bf16_f32 v117, v118, v119
v_mfma_f32_16x16x32_bf16 v[168:171], v[16:19], v[160:163], 0
v_cvt_pk_bf16_f32 v118, v120, v121
v_cvt_pk_bf16_f32 v119, v122, v123
buffer_store_dwordx4 v[116:119], v2, s[4:7], s72 offen offset:3072 sc1
v_mul_f32_e64 v87, -v238, v86
s_waitcnt lgkmcnt(2)
v_mfma_f32_16x16x32_bf16 v[100:103], a[6:9], v[160:163], 0
v_fma_f32 v200, v200, v86, v87
v_fma_f32 v201, v201, v86, v87
v_fma_f32 v202, v202, v86, v87
v_fma_f32 v203, v203, v86, v87
s_waitcnt lgkmcnt(0)
v_mfma_f32_16x16x32_bf16 v[104:107], a[18:21], v[160:163], 0
v_exp_f32 v200, v200
v_exp_f32 v201, v201
v_exp_f32 v202, v202
v_exp_f32 v203, v203
v_rcp_f32 v168, v168
v_cvt_pk_bf16_f32 v200, v200, v201
ds_read_b64_tr_b16 a[4:5], v248 offset:0
v_cvt_pk_bf16_f32 v201, v202, v203
ds_read_b64_tr_b16 a[16:17], v248 offset:512
v_and_b32 v184, v200, v28
v_and_b32 v185, v201, v29
v_and_b32 v186, v200, v30
v_and_b32 v187, v201, v31
v_pk_mul_f32 v[100:101], v[100:101], v[168:169] op_sel:[0,0] op_sel_hi:[1,0]
v_pk_mul_f32 v[102:103], v[102:103], v[168:169] op_sel:[0,0] op_sel_hi:[1,0]
v_cvt_pk_bf16_f32 v100, v100, v101
v_pk_mul_f32 v[104:105], v[104:105], v[168:169] op_sel:[0,0] op_sel_hi:[1,0]
v_cvt_pk_bf16_f32 v101, v102, v103
v_pk_mul_f32 v[106:107], v[106:107], v[168:169] op_sel:[0,0] op_sel_hi:[1,0]
v_cvt_pk_bf16_f32 v102, v104, v105
v_mfma_f32_16x16x32_bf16 v[192:195], v[16:19], v[184:187], 0
v_cvt_pk_bf16_f32 v103, v106, v107
buffer_store_dwordx4 v[100:103], v2, s[4:7], s72 offen offset:1024 sc1
v_mul_f32_e64 v83, -v243, v82
v_mfma_f32_16x16x32_bf16 v[108:111], a[8:11], v[184:187], 0
v_fma_f32 v152, v152, v82, v83
v_fma_f32 v153, v153, v82, v83
v_fma_f32 v154, v154, v82, v83
v_fma_f32 v155, v155, v82, v83
v_mfma_f32_16x16x32_bf16 v[112:115], a[20:23], v[184:187], 0
v_exp_f32 v152, v152
v_exp_f32 v153, v153
buffer_atomic_add v12, v10, s[4:7], s94 offen sc1
v_exp_f32 v154, v154
v_exp_f32 v155, v155
v_rcp_f32 v192, v192
v_cvt_pk_bf16_f32 v152, v152, v153
v_cvt_pk_bf16_f32 v153, v154, v155
v_and_b32 v136, v152, v80
v_and_b32 v137, v153, v81
v_and_b32 v138, v152, v30
v_and_b32 v139, v153, v31
v_pk_mul_f32 v[108:109], v[108:109], v[192:193] op_sel:[0,0] op_sel_hi:[1,0]
v_pk_mul_f32 v[110:111], v[110:111], v[192:193] op_sel:[0,0] op_sel_hi:[1,0]
v_cvt_pk_bf16_f32 v108, v108, v109
v_pk_mul_f32 v[112:113], v[112:113], v[192:193] op_sel:[0,0] op_sel_hi:[1,0]
v_cvt_pk_bf16_f32 v109, v110, v111
v_pk_mul_f32 v[114:115], v[114:115], v[192:193] op_sel:[0,0] op_sel_hi:[1,0]
v_cvt_pk_bf16_f32 v110, v112, v113
v_mfma_f32_16x16x32_bf16 v[144:147], v[16:19], v[136:139], 0
v_cvt_pk_bf16_f32 v111, v114, v115
buffer_store_dwordx4 v[108:111], v2, s[4:7], s72 offen offset:2048 sc1
s_waitcnt lgkmcnt(1)
v_mfma_f32_16x16x32_bf16 v[92:95], a[4:7], v[136:139], 0
s_nop 3
v_rcp_f32 v144, v144
s_waitcnt lgkmcnt(0)
v_mfma_f32_16x16x32_bf16 v[96:99], a[16:19], v[136:139], 0
s_nop 0
v_pk_mul_f32 v[92:93], v[92:93], v[144:145] op_sel:[0,0] op_sel_hi:[1,0]
v_pk_mul_f32 v[94:95], v[94:95], v[144:145] op_sel:[0,0] op_sel_hi:[1,0]
v_cvt_pk_bf16_f32 v92, v92, v93
v_cvt_pk_bf16_f32 v93, v94, v95
s_nop 2
v_pk_mul_f32 v[96:97], v[96:97], v[144:145] op_sel:[0,0] op_sel_hi:[1,0]
v_pk_mul_f32 v[98:99], v[98:99], v[144:145] op_sel:[0,0] op_sel_hi:[1,0]
v_cvt_pk_bf16_f32 v94, v96, v97
v_cvt_pk_bf16_f32 v95, v98, v99
buffer_store_dwordx4 v[92:95], v2, s[4:7], s72 offen offset:0 sc1
s_add_u32 s92, s71, 0x20000
s_add_u32 s36, s66, 0x20080
s_add_u32 s40, s4, 0x1e00000
s_addc_u32 s41, s5, 0
v_add_u32 v5, 32768, v1
v_add_u32 v6, 98304, v1
s_cmp_eq_u32 s3, 0
s_cselect_b32 s35, 8, 0
s_lshl_b32 s35, s35, 12
v_lshlrev_b32 v132, 16, v32
v_and_b32 v133, 0xffff0000, v32
v_lshlrev_b32 v134, 16, v33
v_and_b32 v135, 0xffff0000, v33
v_lshlrev_b32 v136, 16, v34
v_and_b32 v137, 0xffff0000, v34
v_lshlrev_b32 v138, 16, v35
v_and_b32 v139, 0xffff0000, v35
v_lshlrev_b32 v140, 16, v36
v_and_b32 v141, 0xffff0000, v36
v_lshlrev_b32 v142, 16, v37
v_and_b32 v143, 0xffff0000, v37
v_lshlrev_b32 v144, 16, v38
v_and_b32 v145, 0xffff0000, v38
v_lshlrev_b32 v146, 16, v39
v_and_b32 v147, 0xffff0000, v39
v_lshlrev_b32 v148, 16, v40
v_and_b32 v149, 0xffff0000, v40
v_lshlrev_b32 v150, 16, v41
v_and_b32 v151, 0xffff0000, v41
v_lshlrev_b32 v152, 16, v42
v_and_b32 v153, 0xffff0000, v42
v_lshlrev_b32 v154, 16, v43
v_and_b32 v155, 0xffff0000, v43
v_lshlrev_b32 v156, 16, v44
v_and_b32 v157, 0xffff0000, v44
v_lshlrev_b32 v158, 16, v45
v_and_b32 v159, 0xffff0000, v45
v_lshlrev_b32 v160, 16, v46
v_and_b32 v161, 0xffff0000, v46
v_lshlrev_b32 v162, 16, v47
v_and_b32 v163, 0xffff0000, v47
s_mov_b32 s95, -1
s_mov_b64 exec, 0
s_cmp_eq_u32 s28, 3
s_cbranch_scc1 L_stub14
s_cmp_eq_u32 s28, 2
s_cbranch_scc1 L_wret5
L_wret5:
s_mov_b64 exec, -1
s_cmp_lg_u32 s28, 0
s_cbranch_scc1 Lpo_33
s_add_u32 s36, s66, 0x20080
s_mov_b32 s37, 0
v_mov_b32 v11, 0
buffer_atomic_add v11, v251, s[4:7], s36 offen sc0 sc1
s_sleep 4
Lpoll_31:
v_mov_b32 v234, 0
buffer_atomic_add v234, v251, s[4:7], s36 offen sc0 sc1
s_waitcnt vmcnt(1)
v_readfirstlane_b32 s38, v11
s_nop 0
s_cmp_ge_u32 s38, 32
s_cbranch_scc1 Lpe_32
v_mov_b32 v11, 0
buffer_atomic_add v11, v251, s[4:7], s36 offen sc0 sc1
s_waitcnt vmcnt(1)
v_readfirstlane_b32 s38, v234
s_nop 0
s_cmp_ge_u32 s38, 32
s_cbranch_scc1 Lpe_32
s_add_u32 s37, s37, 1
s_cmp_lt_u32 s37, 0x80000
s_cbranch_scc1 Lpoll_31
s_waitcnt vmcnt(0)
Lpo_33:
s_waitcnt vmcnt(0)
Lpe_32:
s_barrier
L_k2go2:
buffer_load_dwordx4 a[0:3], v4, s[40:43], s35 offen offset:0 sc1
buffer_load_dwordx4 a[4:7], v4, s[40:43], s35 offen offset:1024 sc1
s_cmp_eq_u32 s3, 1
s_cselect_b32 s35, 9, 1
s_lshl_b32 s35, s35, 12
buffer_load_dwordx4 a[8:11], v4, s[40:43], s35 offen offset:0 sc1
buffer_load_dwordx4 a[12:15], v4, s[40:43], s35 offen offset:1024 sc1
s_cmp_eq_u32 s3, 2
s_cselect_b32 s35, 10, 2
s_lshl_b32 s35, s35, 12
buffer_load_dwordx4 a[16:19], v4, s[40:43], s35 offen offset:0 sc1
buffer_load_dwordx4 a[20:23], v4, s[40:43], s35 offen offset:1024 sc1
s_cmp_eq_u32 s3, 3
s_cselect_b32 s35, 11, 3
s_lshl_b32 s35, s35, 12
buffer_load_dwordx4 a[24:27], v4, s[40:43], s35 offen offset:0 sc1
buffer_load_dwordx4 a[28:31], v4, s[40:43], s35 offen offset:1024 sc1
s_cmp_eq_u32 s3, 4
s_cselect_b32 s35, 12, 4
s_lshl_b32 s35, s35, 12
buffer_load_dwordx4 a[32:35], v4, s[40:43], s35 offen offset:0 sc1
buffer_load_dwordx4 a[36:39], v4, s[40:43], s35 offen offset:1024 sc1
s_cmp_eq_u32 s3, 5
s_cselect_b32 s35, 13, 5
s_lshl_b32 s35, s35, 12
ds_read_b128 a[96:99], v5 offset:0
ds_read_b128 a[100:103], v5 offset:1024
ds_read_b128 a[104:107], v5 offset:2048
ds_read_b128 a[108:111], v5 offset:3072
ds_read_b128 a[112:115], v5 offset:4096
ds_read_b128 a[116:119], v5 offset:5120
ds_read_b128 a[120:123], v5 offset:6144
ds_read_b128 a[124:127], v5 offset:7168
s_waitcnt vmcnt(8) lgkmcnt(4)
v_mfma_f32_16x16x32_bf16 v[132:135], a[96:99], a[0:3], v[132:135]
ds_read_b128 a[128:131], v5 offset:8192
v_mfma_f32_16x16x32_bf16 v[148:151], a[96:99], a[4:7], v[148:151]
ds_read_b128 a[132:135], v5 offset:9216
v_mfma_f32_16x16x32_bf16 v[152:155], a[100:103], a[4:7], v[152:155]
buffer_load_dwordx4 a[40:43], v4, s[40:43], s35 offen offset:0 sc1
v_mfma_f32_16x16x32_bf16 v[136:139], a[100:103], a[0:3], v[136:139]
ds_read_b128 a[136:139], v5 offset:10240
v_mfma_f32_16x16x32_bf16 v[140:143], a[104:107], a[0:3], v[140:143]
ds_read_b128 a[140:143], v5 offset:11264
v_mfma_f32_16x16x32_bf16 v[156:159], a[104:107], a[4:7], v[156:159]
v_mfma_f32_16x16x32_bf16 v[160:163], a[108:111], a[4:7], v[160:163]
buffer_load_dwordx4 a[44:47], v4, s[40:43], s35 offen offset:1024 sc1
v_mfma_f32_16x16x32_bf16 v[144:147], a[108:111], a[0:3], v[144:147]
s_waitcnt vmcnt(8) lgkmcnt(4)
v_mfma_f32_16x16x32_bf16 v[132:135], a[112:115], a[8:11], v[132:135]
s_cmp_eq_u32 s3, 6
s_cselect_b32 s35, 14, 6
s_lshl_b32 s35, s35, 12
v_mfma_f32_16x16x32_bf16 v[148:151], a[112:115], a[12:15], v[148:151]
ds_read_b128 a[96:99], v5 offset:12288
v_mfma_f32_16x16x32_bf16 v[152:155], a[116:119], a[12:15], v[152:155]
buffer_load_dwordx4 a[0:3], v4, s[40:43], s35 offen offset:0 sc1
v_mfma_f32_16x16x32_bf16 v[136:139], a[116:119], a[8:11], v[136:139]
ds_read_b128 a[100:103], v5 offset:13312
v_mfma_f32_16x16x32_bf16 v[140:143], a[120:123], a[8:11], v[140:143]
ds_read_b128 a[104:107], v5 offset:14336
v_mfma_f32_16x16x32_bf16 v[156:159], a[120:123], a[12:15], v[156:159]
ds_read_b128 a[108:111], v5 offset:15360
v_mfma_f32_16x16x32_bf16 v[160:163], a[124:127], a[12:15], v[160:163]
buffer_load_dwordx4 a[4:7], v4, s[40:43], s35 offen offset:1024 sc1
v_mfma_f32_16x16x32_bf16 v[144:147], a[124:127], a[8:11], v[144:147]
s_waitcnt vmcnt(8) lgkmcnt(4)
v_mfma_f32_16x16x32_bf16 v[132:135], a[128:131], a[16:19], v[132:135]
s_cmp_eq_u32 s3, 7
s_cselect_b32 s35, 15, 7
s_lshl_b32 s35, s35, 12
v_mfma_f32_16x16x32_bf16 v[148:151], a[128:131], a[20:23], v[148:151]
ds_read_b128 a[112:115], v5 offset:16384
v_mfma_f32_16x16x32_bf16 v[152:155], a[132:135], a[20:23], v[152:155]
buffer_load_dwordx4 a[8:11], v4, s[40:43], s35 offen offset:0 sc1
v_mfma_f32_16x16x32_bf16 v[136:139], a[132:135], a[16:19], v[136:139]
ds_read_b128 a[116:119], v5 offset:17408
v_mfma_f32_16x16x32_bf16 v[140:143], a[136:139], a[16:19], v[140:143]
ds_read_b128 a[120:123], v5 offset:18432
v_mfma_f32_16x16x32_bf16 v[156:159], a[136:139], a[20:23], v[156:159]
ds_read_b128 a[124:127], v5 offset:19456
v_mfma_f32_16x16x32_bf16 v[160:163], a[140:143], a[20:23], v[160:163]
buffer_load_dwordx4 a[12:15], v4, s[40:43], s35 offen offset:1024 sc1
v_mfma_f32_16x16x32_bf16 v[144:147], a[140:143], a[16:19], v[144:147]
s_waitcnt vmcnt(8) lgkmcnt(4)
v_mfma_f32_16x16x32_bf16 v[132:135], a[96:99], a[24:27], v[132:135]
s_cmp_eq_u32 s3, 0
s_cselect_b32 s35, 16, 8
s_lshl_b32 s35, s35, 12
v_mfma_f32_16x16x32_bf16 v[148:151], a[96:99], a[28:31], v[148:151]
ds_read_b128 a[128:131], v5 offset:20480
v_mfma_f32_16x16x32_bf16 v[152:155], a[100:103], a[28:31], v[152:155]
buffer_load_dwordx4 a[16:19], v4, s[40:43], s35 offen offset:0 sc1
v_mfma_f32_16x16x32_bf16 v[136:139], a[100:103], a[24:27], v[136:139]
ds_read_b128 a[132:135], v5 offset:21504
v_mfma_f32_16x16x32_bf16 v[140:143], a[104:107], a[24:27], v[140:143]
ds_read_b128 a[136:139], v5 offset:22528
v_mfma_f32_16x16x32_bf16 v[156:159], a[104:107], a[28:31], v[156:159]
ds_read_b128 a[140:143], v5 offset:23552
v_mfma_f32_16x16x32_bf16 v[160:163], a[108:111], a[28:31], v[160:163]
buffer_load_dwordx4 a[20:23], v4, s[40:43], s35 offen offset:1024 sc1
v_mfma_f32_16x16x32_bf16 v[144:147], a[108:111], a[24:27], v[144:147]
s_waitcnt vmcnt(8) lgkmcnt(4)
v_mfma_f32_16x16x32_bf16 v[132:135], a[112:115], a[32:35], v[132:135]
s_cmp_eq_u32 s3, 1
s_cselect_b32 s35, 17, 9
s_lshl_b32 s35, s35, 12
v_mfma_f32_16x16x32_bf16 v[148:151], a[112:115], a[36:39], v[148:151]
ds_read_b128 a[96:99], v5 offset:24576
v_mfma_f32_16x16x32_bf16 v[152:155], a[116:119], a[36:39], v[152:155]
buffer_load_dwordx4 a[24:27], v4, s[40:43], s35 offen offset:0 sc1
v_mfma_f32_16x16x32_bf16 v[136:139], a[116:119], a[32:35], v[136:139]
ds_read_b128 a[100:103], v5 offset:25600
v_mfma_f32_16x16x32_bf16 v[140:143], a[120:123], a[32:35], v[140:143]
ds_read_b128 a[104:107], v5 offset:26624
v_mfma_f32_16x16x32_bf16 v[156:159], a[120:123], a[36:39], v[156:159]
ds_read_b128 a[108:111], v5 offset:27648
v_mfma_f32_16x16x32_bf16 v[160:163], a[124:127], a[36:39], v[160:163]
buffer_load_dwordx4 a[28:31], v4, s[40:43], s35 offen offset:1024 sc1
v_mfma_f32_16x16x32_bf16 v[144:147], a[124:127], a[32:35], v[144:147]
s_waitcnt vmcnt(8) lgkmcnt(4)
v_mfma_f32_16x16x32_bf16 v[132:135], a[128:131], a[40:43], v[132:135]
s_cmp_eq_u32 s3, 2
s_cselect_b32 s35, 18, 10
s_lshl_b32 s35, s35, 12
v_mfma_f32_16x16x32_bf16 v[148:151], a[128:131], a[44:47], v[148:151]
ds_read_b128 a[112:115], v5 offset:28672
v_mfma_f32_16x16x32_bf16 v[152:155], a[132:135], a[44:47], v[152:155]
buffer_load_dwordx4 a[32:35], v4, s[40:43], s35 offen offset:0 sc1
v_mfma_f32_16x16x32_bf16 v[136:139], a[132:135], a[40:43], v[136:139]
ds_read_b128 a[116:119], v5 offset:29696
v_mfma_f32_16x16x32_bf16 v[140:143], a[136:139], a[40:43], v[140:143]
ds_read_b128 a[120:123], v5 offset:30720
v_mfma_f32_16x16x32_bf16 v[156:159], a[136:139], a[44:47], v[156:159]
ds_read_b128 a[124:127], v5 offset:31744
v_mfma_f32_16x16x32_bf16 v[160:163], a[140:143], a[44:47], v[160:163]
buffer_load_dwordx4 a[36:39], v4, s[40:43], s35 offen offset:1024 sc1
v_mfma_f32_16x16x32_bf16 v[144:147], a[140:143], a[40:43], v[144:147]
s_waitcnt vmcnt(8) lgkmcnt(4)
v_mfma_f32_16x16x32_bf16 v[132:135], a[96:99], a[0:3], v[132:135]
s_cmp_eq_u32 s3, 3
s_cselect_b32 s35, 19, 11
s_lshl_b32 s35, s35, 12
v_mfma_f32_16x16x32_bf16 v[148:151], a[96:99], a[4:7], v[148:151]
ds_read_b128 a[128:131], v5 offset:32768
v_mfma_f32_16x16x32_bf16 v[152:155], a[100:103], a[4:7], v[152:155]
buffer_load_dwordx4 a[40:43], v4, s[40:43], s35 offen offset:0 sc1
v_mfma_f32_16x16x32_bf16 v[136:139], a[100:103], a[0:3], v[136:139]
ds_read_b128 a[132:135], v5 offset:33792
v_mfma_f32_16x16x32_bf16 v[140:143], a[104:107], a[0:3], v[140:143]
ds_read_b128 a[136:139], v5 offset:34816
v_mfma_f32_16x16x32_bf16 v[156:159], a[104:107], a[4:7], v[156:159]
ds_read_b128 a[140:143], v5 offset:35840
v_mfma_f32_16x16x32_bf16 v[160:163], a[108:111], a[4:7], v[160:163]
buffer_load_dwordx4 a[44:47], v4, s[40:43], s35 offen offset:1024 sc1
v_mfma_f32_16x16x32_bf16 v[144:147], a[108:111], a[0:3], v[144:147]
s_waitcnt vmcnt(8) lgkmcnt(4)
v_mfma_f32_16x16x32_bf16 v[132:135], a[112:115], a[8:11], v[132:135]
s_cmp_eq_u32 s3, 4
s_cselect_b32 s35, 20, 12
s_lshl_b32 s35, s35, 12
v_mfma_f32_16x16x32_bf16 v[148:151], a[112:115], a[12:15], v[148:151]
ds_read_b128 a[96:99], v5 offset:36864
v_mfma_f32_16x16x32_bf16 v[152:155], a[116:119], a[12:15], v[152:155]
buffer_load_dwordx4 a[0:3], v4, s[40:43], s35 offen offset:0 sc1
v_mfma_f32_16x16x32_bf16 v[136:139], a[116:119], a[8:11], v[136:139]
ds_read_b128 a[100:103], v5 offset:37888
v_mfma_f32_16x16x32_bf16 v[140:143], a[120:123], a[8:11], v[140:143]
ds_read_b128 a[104:107], v5 offset:38912
v_mfma_f32_16x16x32_bf16 v[156:159], a[120:123], a[12:15], v[156:159]
ds_read_b128 a[108:111], v5 offset:39936
v_mfma_f32_16x16x32_bf16 v[160:163], a[124:127], a[12:15], v[160:163]
buffer_load_dwordx4 a[4:7], v4, s[40:43], s35 offen offset:1024 sc1
v_mfma_f32_16x16x32_bf16 v[144:147], a[124:127], a[8:11], v[144:147]
s_waitcnt vmcnt(8) lgkmcnt(4)
v_mfma_f32_16x16x32_bf16 v[132:135], a[128:131], a[16:19], v[132:135]
s_cmp_eq_u32 s3, 5
s_cselect_b32 s35, 21, 13
s_lshl_b32 s35, s35, 12
v_mfma_f32_16x16x32_bf16 v[148:151], a[128:131], a[20:23], v[148:151]
ds_read_b128 a[112:115], v5 offset:40960
v_mfma_f32_16x16x32_bf16 v[152:155], a[132:135], a[20:23], v[152:155]
buffer_load_dwordx4 a[8:11], v4, s[40:43], s35 offen offset:0 sc1
v_mfma_f32_16x16x32_bf16 v[136:139], a[132:135], a[16:19], v[136:139]
ds_read_b128 a[116:119], v5 offset:41984
v_mfma_f32_16x16x32_bf16 v[140:143], a[136:139], a[16:19], v[140:143]
ds_read_b128 a[120:123], v5 offset:43008
v_mfma_f32_16x16x32_bf16 v[156:159], a[136:139], a[20:23], v[156:159]
ds_read_b128 a[124:127], v5 offset:44032
v_mfma_f32_16x16x32_bf16 v[160:163], a[140:143], a[20:23], v[160:163]
buffer_load_dwordx4 a[12:15], v4, s[40:43], s35 offen offset:1024 sc1
v_mfma_f32_16x16x32_bf16 v[144:147], a[140:143], a[16:19], v[144:147]
s_waitcnt vmcnt(8) lgkmcnt(4)
v_mfma_f32_16x16x32_bf16 v[132:135], a[96:99], a[24:27], v[132:135]
s_cmp_eq_u32 s3, 6
s_cselect_b32 s35, 22, 14
s_lshl_b32 s35, s35, 12
v_mfma_f32_16x16x32_bf16 v[148:151], a[96:99], a[28:31], v[148:151]
ds_read_b128 a[128:131], v5 offset:45056
v_mfma_f32_16x16x32_bf16 v[152:155], a[100:103], a[28:31], v[152:155]
buffer_load_dwordx4 a[16:19], v4, s[40:43], s35 offen offset:0 sc1
v_mfma_f32_16x16x32_bf16 v[136:139], a[100:103], a[24:27], v[136:139]
ds_read_b128 a[132:135], v5 offset:46080
v_mfma_f32_16x16x32_bf16 v[140:143], a[104:107], a[24:27], v[140:143]
ds_read_b128 a[136:139], v5 offset:47104
v_mfma_f32_16x16x32_bf16 v[156:159], a[104:107], a[28:31], v[156:159]
ds_read_b128 a[140:143], v5 offset:48128
v_mfma_f32_16x16x32_bf16 v[160:163], a[108:111], a[28:31], v[160:163]
buffer_load_dwordx4 a[20:23], v4, s[40:43], s35 offen offset:1024 sc1
v_mfma_f32_16x16x32_bf16 v[144:147], a[108:111], a[24:27], v[144:147]
s_waitcnt vmcnt(8) lgkmcnt(4)
v_mfma_f32_16x16x32_bf16 v[132:135], a[112:115], a[32:35], v[132:135]
s_cmp_eq_u32 s3, 7
s_cselect_b32 s35, 23, 15
s_lshl_b32 s35, s35, 12
v_mfma_f32_16x16x32_bf16 v[148:151], a[112:115], a[36:39], v[148:151]
ds_read_b128 a[96:99], v5 offset:49152
v_mfma_f32_16x16x32_bf16 v[152:155], a[116:119], a[36:39], v[152:155]
buffer_load_dwordx4 a[24:27], v4, s[40:43], s35 offen offset:0 sc1
v_mfma_f32_16x16x32_bf16 v[136:139], a[116:119], a[32:35], v[136:139]
ds_read_b128 a[100:103], v5 offset:50176
v_mfma_f32_16x16x32_bf16 v[140:143], a[120:123], a[32:35], v[140:143]
ds_read_b128 a[104:107], v5 offset:51200
v_mfma_f32_16x16x32_bf16 v[156:159], a[120:123], a[36:39], v[156:159]
ds_read_b128 a[108:111], v5 offset:52224
v_mfma_f32_16x16x32_bf16 v[160:163], a[124:127], a[36:39], v[160:163]
buffer_load_dwordx4 a[28:31], v4, s[40:43], s35 offen offset:1024 sc1
v_mfma_f32_16x16x32_bf16 v[144:147], a[124:127], a[32:35], v[144:147]
s_waitcnt vmcnt(8) lgkmcnt(4)
v_mfma_f32_16x16x32_bf16 v[132:135], a[128:131], a[40:43], v[132:135]
s_cmp_eq_u32 s3, 0
s_cselect_b32 s35, 24, 16
s_lshl_b32 s35, s35, 12
v_mfma_f32_16x16x32_bf16 v[148:151], a[128:131], a[44:47], v[148:151]
ds_read_b128 a[112:115], v5 offset:53248
v_mfma_f32_16x16x32_bf16 v[152:155], a[132:135], a[44:47], v[152:155]
buffer_load_dwordx4 a[32:35], v4, s[40:43], s35 offen offset:0 sc1
v_mfma_f32_16x16x32_bf16 v[136:139], a[132:135], a[40:43], v[136:139]
ds_read_b128 a[116:119], v5 offset:54272
v_mfma_f32_16x16x32_bf16 v[140:143], a[136:139], a[40:43], v[140:143]
ds_read_b128 a[120:123], v5 offset:55296
v_mfma_f32_16x16x32_bf16 v[156:159], a[136:139], a[44:47], v[156:159]
ds_read_b128 a[124:127], v5 offset:56320
v_mfma_f32_16x16x32_bf16 v[160:163], a[140:143], a[44:47], v[160:163]
buffer_load_dwordx4 a[36:39], v4, s[40:43], s35 offen offset:1024 sc1
v_mfma_f32_16x16x32_bf16 v[144:147], a[140:143], a[40:43], v[144:147]
s_waitcnt vmcnt(8) lgkmcnt(4)
v_mfma_f32_16x16x32_bf16 v[132:135], a[96:99], a[0:3], v[132:135]
s_cmp_eq_u32 s3, 1
s_cselect_b32 s35, 25, 17
s_lshl_b32 s35, s35, 12
v_mfma_f32_16x16x32_bf16 v[148:151], a[96:99], a[4:7], v[148:151]
ds_read_b128 a[128:131], v5 offset:57344
v_mfma_f32_16x16x32_bf16 v[152:155], a[100:103], a[4:7], v[152:155]
buffer_load_dwordx4 a[40:43], v4, s[40:43], s35 offen offset:0 sc1
v_mfma_f32_16x16x32_bf16 v[136:139], a[100:103], a[0:3], v[136:139]
ds_read_b128 a[132:135], v5 offset:58368
v_mfma_f32_16x16x32_bf16 v[140:143], a[104:107], a[0:3], v[140:143]
ds_read_b128 a[136:139], v5 offset:59392
v_mfma_f32_16x16x32_bf16 v[156:159], a[104:107], a[4:7], v[156:159]
ds_read_b128 a[140:143], v5 offset:60416
v_mfma_f32_16x16x32_bf16 v[160:163], a[108:111], a[4:7], v[160:163]
buffer_load_dwordx4 a[44:47], v4, s[40:43], s35 offen offset:1024 sc1
v_mfma_f32_16x16x32_bf16 v[144:147], a[108:111], a[0:3], v[144:147]
s_waitcnt vmcnt(8) lgkmcnt(4)
v_mfma_f32_16x16x32_bf16 v[132:135], a[112:115], a[8:11], v[132:135]
s_cmp_eq_u32 s3, 2
s_cselect_b32 s35, 26, 18
s_lshl_b32 s35, s35, 12
v_mfma_f32_16x16x32_bf16 v[148:151], a[112:115], a[12:15], v[148:151]
ds_read_b128 a[96:99], v5 offset:61440
v_mfma_f32_16x16x32_bf16 v[152:155], a[116:119], a[12:15], v[152:155]
buffer_load_dwordx4 a[0:3], v4, s[40:43], s35 offen offset:0 sc1
v_mfma_f32_16x16x32_bf16 v[136:139], a[116:119], a[8:11], v[136:139]
ds_read_b128 a[100:103], v5 offset:62464
v_mfma_f32_16x16x32_bf16 v[140:143], a[120:123], a[8:11], v[140:143]
ds_read_b128 a[104:107], v5 offset:63488
v_mfma_f32_16x16x32_bf16 v[156:159], a[120:123], a[12:15], v[156:159]
ds_read_b128 a[108:111], v5 offset:64512
v_mfma_f32_16x16x32_bf16 v[160:163], a[124:127], a[12:15], v[160:163]
buffer_load_dwordx4 a[4:7], v4, s[40:43], s35 offen offset:1024 sc1
v_mfma_f32_16x16x32_bf16 v[144:147], a[124:127], a[8:11], v[144:147]
s_waitcnt vmcnt(8) lgkmcnt(4)
v_mfma_f32_16x16x32_bf16 v[132:135], a[128:131], a[16:19], v[132:135]
s_cmp_eq_u32 s3, 3
s_cselect_b32 s35, 27, 19
s_lshl_b32 s35, s35, 12
v_mfma_f32_16x16x32_bf16 v[148:151], a[128:131], a[20:23], v[148:151]
ds_read_b128 a[112:115], v6 offset:0
v_mfma_f32_16x16x32_bf16 v[152:155], a[132:135], a[20:23], v[152:155]
buffer_load_dwordx4 a[8:11], v4, s[40:43], s35 offen offset:0 sc1
v_mfma_f32_16x16x32_bf16 v[136:139], a[132:135], a[16:19], v[136:139]
ds_read_b128 a[116:119], v6 offset:1024
v_mfma_f32_16x16x32_bf16 v[140:143], a[136:139], a[16:19], v[140:143]
ds_read_b128 a[120:123], v6 offset:2048
v_mfma_f32_16x16x32_bf16 v[156:159], a[136:139], a[20:23], v[156:159]
ds_read_b128 a[124:127], v6 offset:3072
v_mfma_f32_16x16x32_bf16 v[160:163], a[140:143], a[20:23], v[160:163]
buffer_load_dwordx4 a[12:15], v4, s[40:43], s35 offen offset:1024 sc1
v_mfma_f32_16x16x32_bf16 v[144:147], a[140:143], a[16:19], v[144:147]
s_waitcnt vmcnt(8) lgkmcnt(4)
v_mfma_f32_16x16x32_bf16 v[132:135], a[96:99], a[24:27], v[132:135]
s_cmp_eq_u32 s3, 4
s_cselect_b32 s35, 28, 20
s_lshl_b32 s35, s35, 12
v_mfma_f32_16x16x32_bf16 v[148:151], a[96:99], a[28:31], v[148:151]
ds_read_b128 a[128:131], v6 offset:4096
v_mfma_f32_16x16x32_bf16 v[152:155], a[100:103], a[28:31], v[152:155]
buffer_load_dwordx4 a[16:19], v4, s[40:43], s35 offen offset:0 sc1
v_mfma_f32_16x16x32_bf16 v[136:139], a[100:103], a[24:27], v[136:139]
ds_read_b128 a[132:135], v6 offset:5120
v_mfma_f32_16x16x32_bf16 v[140:143], a[104:107], a[24:27], v[140:143]
ds_read_b128 a[136:139], v6 offset:6144
v_mfma_f32_16x16x32_bf16 v[156:159], a[104:107], a[28:31], v[156:159]
L_stub14:
s_cbranch_execz L_wret5
ds_read_b128 a[140:143], v6 offset:7168
v_mfma_f32_16x16x32_bf16 v[160:163], a[108:111], a[28:31], v[160:163]
buffer_load_dwordx4 a[20:23], v4, s[40:43], s35 offen offset:1024 sc1
v_mfma_f32_16x16x32_bf16 v[144:147], a[108:111], a[24:27], v[144:147]
s_waitcnt vmcnt(8) lgkmcnt(4)
v_mfma_f32_16x16x32_bf16 v[132:135], a[112:115], a[32:35], v[132:135]
s_cmp_eq_u32 s3, 5
s_cselect_b32 s35, 29, 21
s_lshl_b32 s35, s35, 12
v_mfma_f32_16x16x32_bf16 v[148:151], a[112:115], a[36:39], v[148:151]
ds_read_b128 a[96:99], v6 offset:8192
v_mfma_f32_16x16x32_bf16 v[152:155], a[116:119], a[36:39], v[152:155]
buffer_load_dwordx4 a[24:27], v4, s[40:43], s35 offen offset:0 sc1
v_mfma_f32_16x16x32_bf16 v[136:139], a[116:119], a[32:35], v[136:139]
ds_read_b128 a[100:103], v6 offset:9216
v_mfma_f32_16x16x32_bf16 v[140:143], a[120:123], a[32:35], v[140:143]
ds_read_b128 a[104:107], v6 offset:10240
v_mfma_f32_16x16x32_bf16 v[156:159], a[120:123], a[36:39], v[156:159]
ds_read_b128 a[108:111], v6 offset:11264
v_mfma_f32_16x16x32_bf16 v[160:163], a[124:127], a[36:39], v[160:163]
buffer_load_dwordx4 a[28:31], v4, s[40:43], s35 offen offset:1024 sc1
v_mfma_f32_16x16x32_bf16 v[144:147], a[124:127], a[32:35], v[144:147]
s_waitcnt vmcnt(8) lgkmcnt(4)
v_mfma_f32_16x16x32_bf16 v[132:135], a[128:131], a[40:43], v[132:135]
s_cmp_eq_u32 s3, 6
s_cselect_b32 s35, 30, 22
s_lshl_b32 s35, s35, 12
v_mfma_f32_16x16x32_bf16 v[148:151], a[128:131], a[44:47], v[148:151]
ds_read_b128 a[112:115], v6 offset:12288
v_mfma_f32_16x16x32_bf16 v[152:155], a[132:135], a[44:47], v[152:155]
buffer_load_dwordx4 a[32:35], v4, s[40:43], s35 offen offset:0 sc1
v_mfma_f32_16x16x32_bf16 v[136:139], a[132:135], a[40:43], v[136:139]
ds_read_b128 a[116:119], v6 offset:13312
v_mfma_f32_16x16x32_bf16 v[140:143], a[136:139], a[40:43], v[140:143]
ds_read_b128 a[120:123], v6 offset:14336
v_mfma_f32_16x16x32_bf16 v[156:159], a[136:139], a[44:47], v[156:159]
ds_read_b128 a[124:127], v6 offset:15360
v_mfma_f32_16x16x32_bf16 v[160:163], a[140:143], a[44:47], v[160:163]
buffer_load_dwordx4 a[36:39], v4, s[40:43], s35 offen offset:1024 sc1
v_mfma_f32_16x16x32_bf16 v[144:147], a[140:143], a[40:43], v[144:147]
s_waitcnt vmcnt(8) lgkmcnt(4)
v_mfma_f32_16x16x32_bf16 v[132:135], a[96:99], a[0:3], v[132:135]
s_cmp_eq_u32 s3, 7
s_cselect_b32 s35, 31, 23
s_lshl_b32 s35, s35, 12
v_mfma_f32_16x16x32_bf16 v[148:151], a[96:99], a[4:7], v[148:151]
ds_read_b128 a[128:131], v6 offset:16384
v_mfma_f32_16x16x32_bf16 v[152:155], a[100:103], a[4:7], v[152:155]
buffer_load_dwordx4 a[40:43], v4, s[40:43], s35 offen offset:0 sc1
v_mfma_f32_16x16x32_bf16 v[136:139], a[100:103], a[0:3], v[136:139]
ds_read_b128 a[132:135], v6 offset:17408
v_mfma_f32_16x16x32_bf16 v[140:143], a[104:107], a[0:3], v[140:143]
ds_read_b128 a[136:139], v6 offset:18432
v_mfma_f32_16x16x32_bf16 v[156:159], a[104:107], a[4:7], v[156:159]
ds_read_b128 a[140:143], v6 offset:19456
v_mfma_f32_16x16x32_bf16 v[160:163], a[108:111], a[4:7], v[160:163]
buffer_load_dwordx4 a[44:47], v4, s[40:43], s35 offen offset:1024 sc1
v_mfma_f32_16x16x32_bf16 v[144:147], a[108:111], a[0:3], v[144:147]
s_waitcnt vmcnt(8) lgkmcnt(4)
v_mfma_f32_16x16x32_bf16 v[132:135], a[112:115], a[8:11], v[132:135]
s_cmp_eq_u32 s3, 0
s_cselect_b32 s35, 0, 24
s_lshl_b32 s35, s35, 12
v_mfma_f32_16x16x32_bf16 v[148:151], a[112:115], a[12:15], v[148:151]
ds_read_b128 a[96:99], v6 offset:20480
v_mfma_f32_16x16x32_bf16 v[152:155], a[116:119], a[12:15], v[152:155]
buffer_load_dwordx4 a[0:3], v4, s[40:43], s35 offen offset:0 sc1
v_mfma_f32_16x16x32_bf16 v[136:139], a[116:119], a[8:11], v[136:139]
ds_read_b128 a[100:103], v6 offset:21504
v_mfma_f32_16x16x32_bf16 v[140:143], a[120:123], a[8:11], v[140:143]
ds_read_b128 a[104:107], v6 offset:22528
v_mfma_f32_16x16x32_bf16 v[156:159], a[120:123], a[12:15], v[156:159]
ds_read_b128 a[108:111], v6 offset:23552
v_mfma_f32_16x16x32_bf16 v[160:163], a[124:127], a[12:15], v[160:163]
buffer_load_dwordx4 a[4:7], v4, s[40:43], s35 offen offset:1024 sc1
v_mfma_f32_16x16x32_bf16 v[144:147], a[124:127], a[8:11], v[144:147]
s_waitcnt vmcnt(8) lgkmcnt(4)
v_mfma_f32_16x16x32_bf16 v[132:135], a[128:131], a[16:19], v[132:135]
s_cmp_eq_u32 s3, 1
s_cselect_b32 s35, 1, 25
s_lshl_b32 s35, s35, 12
v_mfma_f32_16x16x32_bf16 v[148:151], a[128:131], a[20:23], v[148:151]
ds_read_b128 a[112:115], v6 offset:24576
v_mfma_f32_16x16x32_bf16 v[152:155], a[132:135], a[20:23], v[152:155]
buffer_load_dwordx4 a[8:11], v4, s[40:43], s35 offen offset:0 sc1
v_mfma_f32_16x16x32_bf16 v[136:139], a[132:135], a[16:19], v[136:139]
ds_read_b128 a[116:119], v6 offset:25600
v_mfma_f32_16x16x32_bf16 v[140:143], a[136:139], a[16:19], v[140:143]
ds_read_b128 a[120:123], v6 offset:26624
v_mfma_f32_16x16x32_bf16 v[156:159], a[136:139], a[20:23], v[156:159]
ds_read_b128 a[124:127], v6 offset:27648
v_mfma_f32_16x16x32_bf16 v[160:163], a[140:143], a[20:23], v[160:163]
buffer_load_dwordx4 a[12:15], v4, s[40:43], s35 offen offset:1024 sc1
v_mfma_f32_16x16x32_bf16 v[144:147], a[140:143], a[16:19], v[144:147]
s_waitcnt vmcnt(8) lgkmcnt(4)
v_mfma_f32_16x16x32_bf16 v[132:135], a[96:99], a[24:27], v[132:135]
s_cmp_eq_u32 s3, 2
s_cselect_b32 s35, 2, 26
s_lshl_b32 s35, s35, 12
v_mfma_f32_16x16x32_bf16 v[148:151], a[96:99], a[28:31], v[148:151]
ds_read_b128 a[128:131], v6 offset:28672
v_mfma_f32_16x16x32_bf16 v[152:155], a[100:103], a[28:31], v[152:155]
buffer_load_dwordx4 a[16:19], v4, s[40:43], s35 offen offset:0 sc1
v_mfma_f32_16x16x32_bf16 v[136:139], a[100:103], a[24:27], v[136:139]
ds_read_b128 a[132:135], v6 offset:29696
v_mfma_f32_16x16x32_bf16 v[140:143], a[104:107], a[24:27], v[140:143]
ds_read_b128 a[136:139], v6 offset:30720
v_mfma_f32_16x16x32_bf16 v[156:159], a[104:107], a[28:31], v[156:159]
ds_read_b128 a[140:143], v6 offset:31744
v_mfma_f32_16x16x32_bf16 v[160:163], a[108:111], a[28:31], v[160:163]
buffer_load_dwordx4 a[20:23], v4, s[40:43], s35 offen offset:1024 sc1
v_mfma_f32_16x16x32_bf16 v[144:147], a[108:111], a[24:27], v[144:147]
s_waitcnt vmcnt(8) lgkmcnt(4)
v_mfma_f32_16x16x32_bf16 v[132:135], a[112:115], a[32:35], v[132:135]
s_cmp_eq_u32 s3, 3
s_cselect_b32 s35, 3, 27
s_lshl_b32 s35, s35, 12
v_mfma_f32_16x16x32_bf16 v[148:151], a[112:115], a[36:39], v[148:151]
ds_read_b128 a[96:99], v6 offset:32768
v_mfma_f32_16x16x32_bf16 v[152:155], a[116:119], a[36:39], v[152:155]
buffer_load_dwordx4 a[24:27], v4, s[40:43], s35 offen offset:0 sc1
v_mfma_f32_16x16x32_bf16 v[136:139], a[116:119], a[32:35], v[136:139]
ds_read_b128 a[100:103], v6 offset:33792
v_mfma_f32_16x16x32_bf16 v[140:143], a[120:123], a[32:35], v[140:143]
ds_read_b128 a[104:107], v6 offset:34816
v_mfma_f32_16x16x32_bf16 v[156:159], a[120:123], a[36:39], v[156:159]
ds_read_b128 a[108:111], v6 offset:35840
v_mfma_f32_16x16x32_bf16 v[160:163], a[124:127], a[36:39], v[160:163]
buffer_load_dwordx4 a[28:31], v4, s[40:43], s35 offen offset:1024 sc1
v_mfma_f32_16x16x32_bf16 v[144:147], a[124:127], a[32:35], v[144:147]
s_waitcnt vmcnt(8) lgkmcnt(4)
v_mfma_f32_16x16x32_bf16 v[132:135], a[128:131], a[40:43], v[132:135]
s_cmp_eq_u32 s3, 4
s_cselect_b32 s35, 4, 28
s_lshl_b32 s35, s35, 12
v_mfma_f32_16x16x32_bf16 v[148:151], a[128:131], a[44:47], v[148:151]
ds_read_b128 a[112:115], v6 offset:36864
v_mfma_f32_16x16x32_bf16 v[152:155], a[132:135], a[44:47], v[152:155]
buffer_load_dwordx4 a[32:35], v4, s[40:43], s35 offen offset:0 sc1
v_mfma_f32_16x16x32_bf16 v[136:139], a[132:135], a[40:43], v[136:139]
ds_read_b128 a[116:119], v6 offset:37888
v_mfma_f32_16x16x32_bf16 v[140:143], a[136:139], a[40:43], v[140:143]
ds_read_b128 a[120:123], v6 offset:38912
v_mfma_f32_16x16x32_bf16 v[156:159], a[136:139], a[44:47], v[156:159]
ds_read_b128 a[124:127], v6 offset:39936
v_mfma_f32_16x16x32_bf16 v[160:163], a[140:143], a[44:47], v[160:163]
buffer_load_dwordx4 a[36:39], v4, s[40:43], s35 offen offset:1024 sc1
v_mfma_f32_16x16x32_bf16 v[144:147], a[140:143], a[40:43], v[144:147]
s_waitcnt vmcnt(8) lgkmcnt(4)
v_mfma_f32_16x16x32_bf16 v[132:135], a[96:99], a[0:3], v[132:135]
s_cmp_eq_u32 s3, 5
s_cselect_b32 s35, 5, 29
s_lshl_b32 s35, s35, 12
v_mfma_f32_16x16x32_bf16 v[148:151], a[96:99], a[4:7], v[148:151]
ds_read_b128 a[128:131], v6 offset:40960
v_mfma_f32_16x16x32_bf16 v[152:155], a[100:103], a[4:7], v[152:155]
buffer_load_dwordx4 a[40:43], v4, s[40:43], s35 offen offset:0 sc1
v_mfma_f32_16x16x32_bf16 v[136:139], a[100:103], a[0:3], v[136:139]
ds_read_b128 a[132:135], v6 offset:41984
v_mfma_f32_16x16x32_bf16 v[140:143], a[104:107], a[0:3], v[140:143]
ds_read_b128 a[136:139], v6 offset:43008
v_mfma_f32_16x16x32_bf16 v[156:159], a[104:107], a[4:7], v[156:159]
ds_read_b128 a[140:143], v6 offset:44032
v_mfma_f32_16x16x32_bf16 v[160:163], a[108:111], a[4:7], v[160:163]
buffer_load_dwordx4 a[44:47], v4, s[40:43], s35 offen offset:1024 sc1
v_mfma_f32_16x16x32_bf16 v[144:147], a[108:111], a[0:3], v[144:147]
s_waitcnt vmcnt(8) lgkmcnt(4)
v_mfma_f32_16x16x32_bf16 v[132:135], a[112:115], a[8:11], v[132:135]
s_cmp_eq_u32 s3, 6
s_cselect_b32 s35, 6, 30
s_lshl_b32 s35, s35, 12
v_mfma_f32_16x16x32_bf16 v[148:151], a[112:115], a[12:15], v[148:151]
ds_read_b128 a[96:99], v6 offset:45056
v_mfma_f32_16x16x32_bf16 v[152:155], a[116:119], a[12:15], v[152:155]
buffer_load_dwordx4 a[0:3], v4, s[40:43], s35 offen offset:0 sc1
v_mfma_f32_16x16x32_bf16 v[136:139], a[116:119], a[8:11], v[136:139]
ds_read_b128 a[100:103], v6 offset:46080
v_mfma_f32_16x16x32_bf16 v[140:143], a[120:123], a[8:11], v[140:143]
ds_read_b128 a[104:107], v6 offset:47104
v_mfma_f32_16x16x32_bf16 v[156:159], a[120:123], a[12:15], v[156:159]
ds_read_b128 a[108:111], v6 offset:48128
v_mfma_f32_16x16x32_bf16 v[160:163], a[124:127], a[12:15], v[160:163]
buffer_load_dwordx4 a[4:7], v4, s[40:43], s35 offen offset:1024 sc1
v_mfma_f32_16x16x32_bf16 v[144:147], a[124:127], a[8:11], v[144:147]
s_waitcnt vmcnt(8) lgkmcnt(4)
v_mfma_f32_16x16x32_bf16 v[132:135], a[128:131], a[16:19], v[132:135]
s_cmp_eq_u32 s3, 7
s_cselect_b32 s35, 7, 31
s_lshl_b32 s35, s35, 12
v_mfma_f32_16x16x32_bf16 v[148:151], a[128:131], a[20:23], v[148:151]
ds_read_b128 a[112:115], v6 offset:49152
v_mfma_f32_16x16x32_bf16 v[152:155], a[132:135], a[20:23], v[152:155]
buffer_load_dwordx4 a[8:11], v4, s[40:43], s35 offen offset:0 sc1
v_mfma_f32_16x16x32_bf16 v[136:139], a[132:135], a[16:19], v[136:139]
ds_read_b128 a[116:119], v6 offset:50176
v_mfma_f32_16x16x32_bf16 v[140:143], a[136:139], a[16:19], v[140:143]
ds_read_b128 a[120:123], v6 offset:51200
v_mfma_f32_16x16x32_bf16 v[156:159], a[136:139], a[20:23], v[156:159]
ds_read_b128 a[124:127], v6 offset:52224
v_mfma_f32_16x16x32_bf16 v[160:163], a[140:143], a[20:23], v[160:163]
buffer_load_dwordx4 a[12:15], v4, s[40:43], s35 offen offset:1024 sc1
v_mfma_f32_16x16x32_bf16 v[144:147], a[140:143], a[16:19], v[144:147]
s_waitcnt vmcnt(8) lgkmcnt(4)
v_mfma_f32_16x16x32_bf16 v[132:135], a[96:99], a[24:27], v[132:135]
s_add_u32 m0, s18, 0x0
s_add_u32 s44, s50, 0x1400000
v_mfma_f32_16x16x32_bf16 v[148:151], a[96:99], a[28:31], v[148:151]
ds_read_b128 a[128:131], v6 offset:53248
v_mfma_f32_16x16x32_bf16 v[152:155], a[100:103], a[28:31], v[152:155]
buffer_load_dwordx4 v1, s[4:7], s44 offen offset:0 sc1 lds
v_mfma_f32_16x16x32_bf16 v[136:139], a[100:103], a[24:27], v[136:139]
ds_read_b128 a[132:135], v6 offset:54272
v_mfma_f32_16x16x32_bf16 v[140:143], a[104:107], a[24:27], v[140:143]
ds_read_b128 a[136:139], v6 offset:55296
v_mfma_f32_16x16x32_bf16 v[156:159], a[104:107], a[28:31], v[156:159]
ds_read_b128 a[140:143], v6 offset:56320
v_mfma_f32_16x16x32_bf16 v[160:163], a[108:111], a[28:31], v[160:163]
buffer_load_dwordx4 v1, s[4:7], s44 offen offset:1024 sc1 lds
v_mfma_f32_16x16x32_bf16 v[144:147], a[108:111], a[24:27], v[144:147]
s_waitcnt vmcnt(8) lgkmcnt(4)
v_mfma_f32_16x16x32_bf16 v[132:135], a[112:115], a[32:35], v[132:135]
ds_read_b128 a[96:99], v6 offset:57344
v_mfma_f32_16x16x32_bf16 v[148:151], a[112:115], a[36:39], v[148:151]
ds_read_b128 a[100:103], v6 offset:58368
v_mfma_f32_16x16x32_bf16 v[152:155], a[116:119], a[36:39], v[152:155]
buffer_load_dwordx4 v1, s[4:7], s44 offen offset:2048 sc1 lds
s_add_u32 m0, s18, 0x3000
v_mfma_f32_16x16x32_bf16 v[136:139], a[116:119], a[32:35], v[136:139]
s_add_u32 s44, s50, 0x1403000
ds_read_b128 a[104:107], v6 offset:59392
v_mfma_f32_16x16x32_bf16 v[140:143], a[120:123], a[32:35], v[140:143]
ds_read_b128 a[108:111], v6 offset:60416
v_mfma_f32_16x16x32_bf16 v[156:159], a[120:123], a[36:39], v[156:159]
v_mfma_f32_16x16x32_bf16 v[160:163], a[124:127], a[36:39], v[160:163]
v_mfma_f32_16x16x32_bf16 v[144:147], a[124:127], a[32:35], v[144:147]
buffer_load_dwordx4 v1, s[4:7], s44 offen offset:0 sc1 lds
s_waitcnt vmcnt(8) lgkmcnt(4)
v_mfma_f32_16x16x32_bf16 v[132:135], a[128:131], a[40:43], v[132:135]
ds_read_b128 a[112:115], v6 offset:61440
v_mfma_f32_16x16x32_bf16 v[148:151], a[128:131], a[44:47], v[148:151]
ds_read_b128 a[116:119], v6 offset:62464
v_mfma_f32_16x16x32_bf16 v[152:155], a[132:135], a[44:47], v[152:155]
ds_read_b128 a[120:123], v6 offset:63488
v_mfma_f32_16x16x32_bf16 v[136:139], a[132:135], a[40:43], v[136:139]
ds_read_b128 a[124:127], v6 offset:64512
v_mfma_f32_16x16x32_bf16 v[140:143], a[136:139], a[40:43], v[140:143]
buffer_load_dwordx4 v1, s[4:7], s44 offen offset:1024 sc1 lds
v_mfma_f32_16x16x32_bf16 v[156:159], a[136:139], a[44:47], v[156:159]
v_mfma_f32_16x16x32_bf16 v[160:163], a[140:143], a[44:47], v[160:163]
v_mfma_f32_16x16x32_bf16 v[144:147], a[140:143], a[40:43], v[144:147]
s_waitcnt vmcnt(7) lgkmcnt(4)
v_mfma_f32_16x16x32_bf16 v[132:135], a[96:99], a[0:3], v[132:135]
v_mfma_f32_16x16x32_bf16 v[148:151], a[96:99], a[4:7], v[148:151]
buffer_load_dwordx4 v1, s[4:7], s44 offen offset:2048 sc1 lds
v_mfma_f32_16x16x32_bf16 v[152:155], a[100:103], a[4:7], v[152:155]
v_mfma_f32_16x16x32_bf16 v[136:139], a[100:103], a[0:3], v[136:139]
v_mfma_f32_16x16x32_bf16 v[140:143], a[104:107], a[0:3], v[140:143]
v_mfma_f32_16x16x32_bf16 v[156:159], a[104:107], a[4:7], v[156:159]
v_mfma_f32_16x16x32_bf16 v[160:163], a[108:111], a[4:7], v[160:163]
v_mfma_f32_16x16x32_bf16 v[144:147], a[108:111], a[0:3], v[144:147]
s_waitcnt vmcnt(6) lgkmcnt(0)
v_mfma_f32_16x16x32_bf16 v[132:135], a[112:115], a[8:11], v[132:135]
v_mfma_f32_16x16x32_bf16 v[148:151], a[112:115], a[12:15], v[148:151]
v_mfma_f32_16x16x32_bf16 v[152:155], a[116:119], a[12:15], v[152:155]
buffer_atomic_add v12, v10, s[4:7], s92 offen sc1
v_mfma_f32_16x16x32_bf16 v[136:139], a[116:119], a[8:11], v[136:139]
v_mfma_f32_16x16x32_bf16 v[140:143], a[120:123], a[8:11], v[140:143]
v_mfma_f32_16x16x32_bf16 v[156:159], a[120:123], a[12:15], v[156:159]
v_mfma_f32_16x16x32_bf16 v[160:163], a[124:127], a[12:15], v[160:163]
v_mfma_f32_16x16x32_bf16 v[144:147], a[124:127], a[8:11], v[144:147]
s_nop 0
v_cmp_u_f32 vcc, v132, v148
s_nop 0
s_and_b32 vcc_lo, vcc_lo, s95
s_cbranch_scc1 L_k2redo2
s_lshl_b32 s36, s32, 13
v_cvt_pk_bf16_f32 v32, v132, v133
v_cvt_pk_bf16_f32 v33, v134, v135
v_cvt_pk_bf16_f32 v34, v136, v137
v_cvt_pk_bf16_f32 v35, v138, v139
s_add_u32 s36, s36, 0x2200000
buffer_store_dwordx4 v[32:35], v4, s[4:7], s36 offen offset:0 sc1
v_cvt_pk_bf16_f32 v40, v148, v149
v_cvt_pk_bf16_f32 v41, v150, v151
v_cvt_pk_bf16_f32 v42, v152, v153
v_cvt_pk_bf16_f32 v43, v154, v155
v_cvt_pk_bf16_f32 v36, v140, v141
v_cvt_pk_bf16_f32 v37, v142, v143
v_cvt_pk_bf16_f32 v38, v144, v145
v_cvt_pk_bf16_f32 v39, v146, v147
s_add_u32 s37, s36, 4096
v_cvt_pk_bf16_f32 v44, v156, v157
v_cvt_pk_bf16_f32 v45, v158, v159
v_cvt_pk_bf16_f32 v46, v160, v161
buffer_store_dwordx4 v[40:43], v4, s[4:7], s36 offen offset:1024 sc1
v_cvt_pk_bf16_f32 v47, v162, v163
v_mfma_f32_16x16x32_bf16 v[96:99], v[32:35], v[32:35], 0
s_mov_b32 s38, 0x2c0000
s_add_u32 s92, s78, 0x60000
v_mfma_f32_16x16x32_bf16 v[92:95], v[16:19], v[32:35], 0
s_add_u32 s93, s79, 0x60000
s_add_u32 s40, s4, 0x2200000
v_mfma_f32_16x16x32_bf16 v[96:99], v[36:39], v[36:39], v[96:99]
s_addc_u32 s41, s5, 0
buffer_store_dwordx4 v[36:39], v4, s[4:7], s37 offen offset:0 sc1
v_mfma_f32_16x16x32_bf16 v[92:95], v[16:19], v[36:39], v[92:95]
s_nop 4
v_cndmask_b32 v96, v96, v97, s[46:47]
v_cndmask_b32 v98, v98, v99, s[46:47]
v_mfma_f32_16x16x32_bf16 v[104:107], v[40:43], v[40:43], 0
v_mfma_f32_16x16x32_bf16 v[100:103], v[16:19], v[40:43], 0
v_cndmask_b32 v93, v96, v98, s[48:49]
buffer_store_dwordx4 v[44:47], v4, s[4:7], s37 offen offset:1024 sc1
v_mfma_f32_16x16x32_bf16 v[104:107], v[44:47], v[44:47], v[104:107]
v_mfma_f32_16x16x32_bf16 v[100:103], v[16:19], v[44:47], v[100:103]
s_nop 6
v_cndmask_b32 v104, v104, v105, s[46:47]
v_cndmask_b32 v106, v106, v107, s[46:47]
buffer_store_dwordx2 v[92:93], v253, s[4:7], s38 offen offset:0 sc1
v_cndmask_b32 v101, v104, v106, s[48:49]
buffer_store_dwordx2 v[100:101], v253, s[4:7], s38 offen offset:2048 sc1
s_barrier
s_add_u32 m0, s18, 0x6000
s_add_u32 s44, s50, 0x1406000
buffer_load_dwordx4 v1, s[4:7], s44 offen offset:0 sc1 lds
buffer_load_dwordx4 v1, s[4:7], s44 offen offset:1024 sc1 lds
buffer_load_dwordx4 v1, s[4:7], s44 offen offset:2048 sc1 lds
s_add_u32 m0, s18, 0x9000
s_add_u32 s44, s50, 0x1409000
buffer_load_dwordx4 v1, s[4:7], s44 offen offset:0 sc1 lds
buffer_load_dwordx4 v1, s[4:7], s44 offen offset:1024 sc1 lds
buffer_load_dwordx4 v1, s[4:7], s44 offen offset:2048 sc1 lds
v_accvgpr_read_b32 v48, a216
v_accvgpr_read_b32 v49, a217
v_accvgpr_read_b32 v50, a218
v_accvgpr_read_b32 v51, a219
v_accvgpr_read_b32 v52, a220
v_accvgpr_read_b32 v53, a221
v_accvgpr_read_b32 v54, a222
v_accvgpr_read_b32 v55, a223
v_accvgpr_read_b32 v56, a224
v_accvgpr_read_b32 v57, a225
v_accvgpr_read_b32 v58, a226
v_accvgpr_read_b32 v59, a227
v_accvgpr_read_b32 v60, a228
v_accvgpr_read_b32 v61, a229
v_accvgpr_read_b32 v62, a230
v_accvgpr_read_b32 v63, a231
v_accvgpr_read_b32 v64, a232
v_accvgpr_read_b32 v65, a233
v_accvgpr_read_b32 v66, a234
v_accvgpr_read_b32 v67, a235
v_accvgpr_read_b32 v68, a236
v_accvgpr_read_b32 v69, a237
v_accvgpr_read_b32 v70, a238
v_accvgpr_read_b32 v71, a239
s_waitcnt vmcnt(6)
s_barrier
s_cmp_lg_u32 s28, 1
s_cbranch_scc1 Lsg_34
buffer_atomic_add v12, v10, s[4:7], s92 offen sc1
Lsg_34:
s_mov_b64 exec, 0
s_cmp_eq_u32 s28, 1
s_cbranch_scc1 L_stub15
L_wret6:
s_mov_b64 exec, -1
s_cmp_lt_u32 s28, 2
s_cbranch_scc1 Lwd_35
s_add_u32 m0, s18, 0xa800
s_add_u32 s44, s50, 0x140a800
buffer_load_dwordx4 v1, s[4:7], s44 offen offset:0 sc1 lds
buffer_load_dwordx4 v1, s[4:7], s44 offen offset:1024 sc1 lds
buffer_load_dwordx4 v1, s[4:7], s44 offen offset:2048 sc1 lds
s_add_u32 m0, s18, 0xc000
s_add_u32 s44, s50, 0x140c000
buffer_load_dwordx4 v1, s[4:7], s44 offen offset:0 sc1 lds
buffer_load_dwordx4 v1, s[4:7], s44 offen offset:1024 sc1 lds
buffer_load_dwordx4 v1, s[4:7], s44 offen offset:2048 sc1 lds
s_add_u32 m0, s18, 0xd800
s_add_u32 s44, s50, 0x140d800
buffer_load_dwordx4 v1, s[4:7], s44 offen offset:0 sc1 lds
buffer_load_dwordx4 v1, s[4:7], s44 offen offset:1024 sc1 lds
buffer_load_dwordx4 v1, s[4:7], s44 offen offset:2048 sc1 lds
s_add_u32 m0, s18, 0xf000
s_add_u32 s44, s50, 0x140f000
buffer_load_dwordx4 v1, s[4:7], s44 offen offset:0 sc1 lds
buffer_load_dwordx4 v1, s[4:7], s44 offen offset:1024 sc1 lds
buffer_load_dwordx4 v1, s[4:7], s44 offen offset:2048 sc1 lds
s_add_u32 m0, s18, 0x10800
s_add_u32 s44, s50, 0x1410800
buffer_load_dwordx4 v1, s[4:7], s44 offen offset:0 sc1 lds
buffer_load_dwordx4 v1, s[4:7], s44 offen offset:1024 sc1 lds
buffer_load_dwordx4 v1, s[4:7], s44 offen offset:2048 sc1 lds
s_add_u32 m0, s18, 0x12000
s_add_u32 s44, s50, 0x1412000
buffer_load_dwordx4 v1, s[4:7], s44 offen offset:0 sc1 lds
buffer_load_dwordx4 v1, s[4:7], s44 offen offset:1024 sc1 lds
buffer_load_dwordx4 v1, s[4:7], s44 offen offset:2048 sc1 lds
s_add_u32 m0, s18, 0x13800
s_add_u32 s44, s50, 0x1413800
buffer_load_dwordx4 v1, s[4:7], s44 offen offset:0 sc1 lds
buffer_load_dwordx4 v1, s[4:7], s44 offen offset:1024 sc1 lds
buffer_load_dwordx4 v1, s[4:7], s44 offen offset:2048 sc1 lds
s_add_u32 m0, s18, 0x15000
s_add_u32 s44, s50, 0x1415000
buffer_load_dwordx4 v1, s[4:7], s44 offen offset:0 sc1 lds
buffer_load_dwordx4 v1, s[4:7], s44 offen offset:1024 sc1 lds
buffer_load_dwordx4 v1, s[4:7], s44 offen offset:2048 sc1 lds
s_add_u32 m0, s18, 0x16800
s_add_u32 s44, s50, 0x1416800
buffer_load_dwordx4 v1, s[4:7], s44 offen offset:0 sc1 lds
buffer_load_dwordx4 v1, s[4:7], s44 offen offset:1024 sc1 lds
buffer_load_dwordx4 v1, s[4:7], s44 offen offset:2048 sc1 lds
s_add_u32 m0, s18, 0x18000
s_add_u32 s44, s50, 0x1418000
buffer_load_dwordx4 v1, s[4:7], s44 offen offset:0 sc1 lds
buffer_load_dwordx4 v1, s[4:7], s44 offen offset:1024 sc1 lds
buffer_load_dwordx4 v1, s[4:7], s44 offen offset:2048 sc1 lds
s_add_u32 m0, s18, 0x19800
s_add_u32 s44, s50, 0x1419800
buffer_load_dwordx4 v1, s[4:7], s44 offen offset:0 sc1 lds
buffer_load_dwordx4 v1, s[4:7], s44 offen offset:1024 sc1 lds
buffer_load_dwordx4 v1, s[4:7], s44 offen offset:2048 sc1 lds
s_add_u32 m0, s18, 0x1b000
s_add_u32 s44, s50, 0x141b000
buffer_load_dwordx4 v1, s[4:7], s44 offen offset:0 sc1 lds
buffer_load_dwordx4 v1, s[4:7], s44 offen offset:1024 sc1 lds
buffer_load_dwordx4 v1, s[4:7], s44 offen offset:2048 sc1 lds
Lwd_35:
s_cmp_lg_u32 s28, 0
s_cbranch_scc1 Lpo_38
s_add_u32 s36, s67, 0x60000
s_mov_b32 s37, 0
v_mov_b32 v11, 0
buffer_atomic_add v11, v251, s[4:7], s36 offen sc0 sc1
s_sleep 4
Lpoll_36:
v_mov_b32 v234, 0
buffer_atomic_add v234, v251, s[4:7], s36 offen sc0 sc1
s_waitcnt vmcnt(1)
v_readfirstlane_b32 s38, v11
s_nop 0
s_cmp_ge_u32 s38, 32
s_cbranch_scc1 Lpe_37
v_mov_b32 v11, 0
buffer_atomic_add v11, v251, s[4:7], s36 offen sc0 sc1
s_waitcnt vmcnt(1)
v_readfirstlane_b32 s38, v234
s_nop 0
s_cmp_ge_u32 s38, 32
s_cbranch_scc1 Lpe_37
s_add_u32 s37, s37, 1
s_cmp_lt_u32 s37, 0x80000
s_cbranch_scc1 Lpoll_36
s_waitcnt vmcnt(0)
Lpo_38:
s_waitcnt vmcnt(36) lgkmcnt(0)
s_cmp_ge_u32 s28, 2
s_cbranch_scc1 Lw_39
s_waitcnt vmcnt(0)
Lw_39:
Lpe_37:
s_barrier
s_add_u32 s9, s66, 0x30080
s_mov_b32 s35, 0
s_mov_b32 s33, 0x1000
buffer_load_dwordx4 a[0:3], v2, s[40:43], s35 offen offset:0 sc1
buffer_load_dwordx4 a[4:7], v2, s[40:43], s33 offen offset:0 sc1
buffer_load_dwordx4 a[8:11], v2, s[40:43], s35 offen offset:1024 sc1
buffer_load_dwordx4 a[12:15], v2, s[40:43], s33 offen offset:1024 sc1
buffer_load_dwordx4 a[16:19], v2, s[40:43], s35 offen offset:2048 sc1
buffer_load_dwordx4 a[20:23], v2, s[40:43], s33 offen offset:2048 sc1
buffer_load_dwordx4 a[24:27], v2, s[40:43], s35 offen offset:3072 sc1
buffer_load_dwordx4 a[28:31], v2, s[40:43], s33 offen offset:3072 sc1
s_add_u32 s35, s35, 8192
s_add_u32 s33, s33, 8192
buffer_load_dwordx4 a[32:35], v2, s[40:43], s35 offen offset:0 sc1
buffer_load_dwordx4 a[36:39], v2, s[40:43], s33 offen offset:0 sc1
buffer_load_dwordx4 a[40:43], v2, s[40:43], s35 offen offset:1024 sc1
buffer_load_dwordx4 a[44:47], v2, s[40:43], s33 offen offset:1024 sc1
buffer_load_dwordx4 a[48:51], v2, s[40:43], s35 offen offset:2048 sc1
buffer_load_dwordx4 a[52:55], v2, s[40:43], s33 offen offset:2048 sc1
buffer_load_dwordx4 a[56:59], v2, s[40:43], s35 offen offset:3072 sc1
buffer_load_dwordx4 a[60:63], v2, s[40:43], s33 offen offset:3072 sc1
s_add_u32 s35, s35, 8192
s_add_u32 s33, s33, 8192
v_add_u32 v5, 0, v1
ds_read_b128 a[96:99], v5 offset:2048
ds_read_b128 a[100:103], v5 offset:8192
ds_read_b128 a[104:107], v5 offset:3072
ds_read_b128 a[108:111], v5 offset:9216
ds_read_b128 a[112:115], v5 offset:4096
ds_read_b128 a[116:119], v5 offset:10240
s_waitcnt vmcnt(14) lgkmcnt(4)
v_mfma_f32_16x16x32_bf16 v[140:143], a[96:99], a[0:3], 0
s_add_u32 m0, s18, 0x1e000
s_add_u32 s44, s50, 0x141e000
v_mfma_f32_16x16x32_bf16 v[140:143], a[100:103], a[4:7], v[140:143]
buffer_load_dwordx4 a[64:67], v2, s[40:43], s35 offen offset:0 sc1
s_waitcnt vmcnt(13)
v_mfma_f32_16x16x32_bf16 v[164:167], a[100:103], a[12:15], 0
ds_read_b128 a[128:131], v5 offset:5120
v_mfma_f32_16x16x32_bf16 v[164:167], a[96:99], a[8:11], v[164:167]
ds_read_b128 a[132:135], v5 offset:11264
s_waitcnt vmcnt(12)
v_mfma_f32_16x16x32_bf16 v[188:191], a[96:99], a[16:19], 0
s_waitcnt vmcnt(11)
v_mfma_f32_16x16x32_bf16 v[188:191], a[100:103], a[20:23], v[188:191]
buffer_load_dwordx4 a[68:71], v2, s[40:43], s33 offen offset:0 sc1
s_waitcnt vmcnt(10)
v_mfma_f32_16x16x32_bf16 v[212:215], a[100:103], a[28:31], 0
ds_read_b128 a[136:139], v5 offset:0
v_mfma_f32_16x16x32_bf16 v[212:215], a[96:99], a[24:27], v[212:215]
s_waitcnt lgkmcnt(6)
v_mfma_f32_16x16x32_bf16 v[216:219], a[104:107], a[24:27], 0
ds_read_b128 a[140:143], v5 offset:6144
s_waitcnt lgkmcnt(6)
v_mfma_f32_16x16x32_bf16 v[216:219], a[108:111], a[28:31], v[216:219]
v_mfma_f32_16x16x32_bf16 v[192:195], a[108:111], a[20:23], 0
buffer_load_dwordx4 v1, s[4:7], s44 offen offset:0 sc1 lds
v_mfma_f32_16x16x32_bf16 v[192:195], a[104:107], a[16:19], v[192:195]
ds_read_b128 a[144:147], v5 offset:1024
v_mfma_f32_16x16x32_bf16 v[168:171], a[104:107], a[8:11], 0
v_mfma_f32_16x16x32_bf16 v[168:171], a[108:111], a[12:15], v[168:171]
ds_read_b128 a[148:151], v5 offset:7168
v_mfma_f32_16x16x32_bf16 v[144:147], a[108:111], a[4:7], 0
v_mfma_f32_16x16x32_bf16 v[144:147], a[104:107], a[0:3], v[144:147]
buffer_load_dwordx4 a[72:75], v2, s[40:43], s35 offen offset:1024 sc1
s_waitcnt lgkmcnt(7)
v_mfma_f32_16x16x32_bf16 v[148:151], a[112:115], a[0:3], 0
s_waitcnt lgkmcnt(6)
v_mfma_f32_16x16x32_bf16 v[148:151], a[116:119], a[4:7], v[148:151]
v_mfma_f32_16x16x32_bf16 v[172:175], a[116:119], a[12:15], 0
v_mfma_f32_16x16x32_bf16 v[172:175], a[112:115], a[8:11], v[172:175]
v_mfma_f32_16x16x32_bf16 v[196:199], a[112:115], a[16:19], 0
buffer_load_dwordx4 a[76:79], v2, s[40:43], s33 offen offset:1024 sc1
v_mfma_f32_16x16x32_bf16 v[196:199], a[116:119], a[20:23], v[196:199]
v_mfma_f32_16x16x32_bf16 v[220:223], a[116:119], a[28:31], 0
v_mfma_f32_16x16x32_bf16 v[220:223], a[112:115], a[24:27], v[220:223]
s_waitcnt lgkmcnt(0)
v_mfma_f32_16x16x32_bf16 v[224:227], a[128:131], a[24:27], 0
ds_read_b128 a[96:99], v5 offset:14336
v_mfma_f32_16x16x32_bf16 v[224:227], a[132:135], a[28:31], v[224:227]
buffer_load_dwordx4 a[80:83], v2, s[40:43], s35 offen offset:2048 sc1
v_mfma_f32_16x16x32_bf16 v[200:203], a[132:135], a[20:23], 0
ds_read_b128 a[100:103], v5 offset:20480
v_mfma_f32_16x16x32_bf16 v[200:203], a[128:131], a[16:19], v[200:203]
v_mfma_f32_16x16x32_bf16 v[176:179], a[128:131], a[8:11], 0
v_mfma_f32_16x16x32_bf16 v[176:179], a[132:135], a[12:15], v[176:179]
buffer_load_dwordx4 a[84:87], v2, s[40:43], s33 offen offset:2048 sc1
v_mfma_f32_16x16x32_bf16 v[152:155], a[132:135], a[4:7], 0
ds_read_b128 a[104:107], v5 offset:15360
v_mfma_f32_16x16x32_bf16 v[152:155], a[128:131], a[0:3], v[152:155]
v_mfma_f32_16x16x32_bf16 v[132:135], a[136:139], a[0:3], 0
ds_read_b128 a[108:111], v5 offset:21504
v_mfma_f32_16x16x32_bf16 v[132:135], a[140:143], a[4:7], v[132:135]
v_mfma_f32_16x16x32_bf16 v[156:159], a[140:143], a[12:15], 0
buffer_load_dwordx4 v1, s[4:7], s44 offen offset:1024 sc1 lds
v_mfma_f32_16x16x32_bf16 v[156:159], a[136:139], a[8:11], v[156:159]
ds_read_b128 a[112:115], v5 offset:16384
v_mfma_f32_16x16x32_bf16 v[180:183], a[136:139], a[16:19], 0
v_mfma_f32_16x16x32_bf16 v[180:183], a[140:143], a[20:23], v[180:183]
ds_read_b128 a[116:119], v5 offset:22528
v_mfma_f32_16x16x32_bf16 v[204:207], a[140:143], a[28:31], 0
v_mfma_f32_16x16x32_bf16 v[204:207], a[136:139], a[24:27], v[204:207]
buffer_load_dwordx4 a[88:91], v2, s[40:43], s35 offen offset:3072 sc1
v_mfma_f32_16x16x32_bf16 v[208:211], a[144:147], a[24:27], 0
v_mfma_f32_16x16x32_bf16 v[208:211], a[148:151], a[28:31], v[208:211]
v_mfma_f32_16x16x32_bf16 v[184:187], a[148:151], a[20:23], 0
v_mfma_f32_16x16x32_bf16 v[184:187], a[144:147], a[16:19], v[184:187]
v_mfma_f32_16x16x32_bf16 v[160:163], a[144:147], a[8:11], 0
L_stub15:
s_cbranch_execz L_stub16
buffer_load_dwordx4 a[92:95], v2, s[40:43], s33 offen offset:3072 sc1
s_add_u32 s35, s35, 8192
v_mfma_f32_16x16x32_bf16 v[160:163], a[148:151], a[12:15], v[160:163]
s_add_u32 s33, s33, 8192
v_mfma_f32_16x16x32_bf16 v[136:139], a[148:151], a[4:7], 0
v_mfma_f32_16x16x32_bf16 v[136:139], a[144:147], a[0:3], v[136:139]
s_waitcnt vmcnt(10) lgkmcnt(0)
v_mfma_f32_16x16x32_bf16 v[140:143], a[96:99], a[32:35], v[140:143]
ds_read_b128 a[128:131], v5 offset:17408
v_mfma_f32_16x16x32_bf16 v[140:143], a[100:103], a[36:39], v[140:143]
buffer_load_dwordx4 a[0:3], v2, s[40:43], s35 offen offset:0 sc1
v_mfma_f32_16x16x32_bf16 v[164:167], a[100:103], a[44:47], v[164:167]
ds_read_b128 a[132:135], v5 offset:23552
v_mfma_f32_16x16x32_bf16 v[164:167], a[96:99], a[40:43], v[164:167]
v_mfma_f32_16x16x32_bf16 v[188:191], a[96:99], a[48:51], v[188:191]
v_mfma_f32_16x16x32_bf16 v[188:191], a[100:103], a[52:55], v[188:191]
buffer_load_dwordx4 a[4:7], v2, s[40:43], s33 offen offset:0 sc1
v_mfma_f32_16x16x32_bf16 v[212:215], a[100:103], a[60:63], v[212:215]
ds_read_b128 a[136:139], v5 offset:12288
v_mfma_f32_16x16x32_bf16 v[212:215], a[96:99], a[56:59], v[212:215]
v_mfma_f32_16x16x32_bf16 v[216:219], a[104:107], a[56:59], v[216:219]
ds_read_b128 a[140:143], v5 offset:18432
v_mfma_f32_16x16x32_bf16 v[216:219], a[108:111], a[60:63], v[216:219]
v_mfma_f32_16x16x32_bf16 v[192:195], a[108:111], a[52:55], v[192:195]
buffer_load_dwordx4 v1, s[4:7], s44 offen offset:2048 sc1 lds
s_add_u32 m0, s18, 0x21000
v_mfma_f32_16x16x32_bf16 v[192:195], a[104:107], a[48:51], v[192:195]
s_add_u32 s44, s50, 0x1421000
ds_read_b128 a[144:147], v5 offset:13312
v_mfma_f32_16x16x32_bf16 v[168:171], a[104:107], a[40:43], v[168:171]
v_mfma_f32_16x16x32_bf16 v[168:171], a[108:111], a[44:47], v[168:171]
ds_read_b128 a[148:151], v5 offset:19456
v_mfma_f32_16x16x32_bf16 v[144:147], a[108:111], a[36:39], v[144:147]
v_mfma_f32_16x16x32_bf16 v[144:147], a[104:107], a[32:35], v[144:147]
buffer_load_dwordx4 a[8:11], v2, s[40:43], s35 offen offset:1024 sc1
v_mfma_f32_16x16x32_bf16 v[148:151], a[112:115], a[32:35], v[148:151]
v_mfma_f32_16x16x32_bf16 v[148:151], a[116:119], a[36:39], v[148:151]
v_mfma_f32_16x16x32_bf16 v[172:175], a[116:119], a[44:47], v[172:175]
v_mfma_f32_16x16x32_bf16 v[172:175], a[112:115], a[40:43], v[172:175]
v_mfma_f32_16x16x32_bf16 v[196:199], a[112:115], a[48:51], v[196:199]
buffer_load_dwordx4 a[12:15], v2, s[40:43], s33 offen offset:1024 sc1
v_mfma_f32_16x16x32_bf16 v[196:199], a[116:119], a[52:55], v[196:199]
v_mfma_f32_16x16x32_bf16 v[220:223], a[116:119], a[60:63], v[220:223]
v_mfma_f32_16x16x32_bf16 v[220:223], a[112:115], a[56:59], v[220:223]
s_waitcnt lgkmcnt(0)
v_mfma_f32_16x16x32_bf16 v[224:227], a[128:131], a[56:59], v[224:227]
ds_read_b128 a[96:99], v5 offset:26624
v_mfma_f32_16x16x32_bf16 v[224:227], a[132:135], a[60:63], v[224:227]
buffer_load_dwordx4 a[16:19], v2, s[40:43], s35 offen offset:2048 sc1
v_mfma_f32_16x16x32_bf16 v[200:203], a[132:135], a[52:55], v[200:203]
ds_read_b128 a[100:103], v5 offset:32768
v_mfma_f32_16x16x32_bf16 v[200:203], a[128:131], a[48:51], v[200:203]
v_mfma_f32_16x16x32_bf16 v[176:179], a[128:131], a[40:43], v[176:179]
v_mfma_f32_16x16x32_bf16 v[176:179], a[132:135], a[44:47], v[176:179]
buffer_load_dwordx4 a[20:23], v2, s[40:43], s33 offen offset:2048 sc1
v_mfma_f32_16x16x32_bf16 v[152:155], a[132:135], a[36:39], v[152:155]
ds_read_b128 a[104:107], v5 offset:27648
v_mfma_f32_16x16x32_bf16 v[152:155], a[128:131], a[32:35], v[152:155]
v_mfma_f32_16x16x32_bf16 v[132:135], a[136:139], a[32:35], v[132:135]
ds_read_b128 a[108:111], v5 offset:33792
v_mfma_f32_16x16x32_bf16 v[132:135], a[140:143], a[36:39], v[132:135]
v_mfma_f32_16x16x32_bf16 v[156:159], a[140:143], a[44:47], v[156:159]
buffer_load_dwordx4 v1, s[4:7], s44 offen offset:0 sc1 lds
v_mfma_f32_16x16x32_bf16 v[156:159], a[136:139], a[40:43], v[156:159]
ds_read_b128 a[112:115], v5 offset:28672
v_mfma_f32_16x16x32_bf16 v[180:183], a[136:139], a[48:51], v[180:183]
v_mfma_f32_16x16x32_bf16 v[180:183], a[140:143], a[52:55], v[180:183]
ds_read_b128 a[116:119], v5 offset:34816
v_mfma_f32_16x16x32_bf16 v[204:207], a[140:143], a[60:63], v[204:207]
v_mfma_f32_16x16x32_bf16 v[204:207], a[136:139], a[56:59], v[204:207]
buffer_load_dwordx4 a[24:27], v2, s[40:43], s35 offen offset:3072 sc1
v_mfma_f32_16x16x32_bf16 v[208:211], a[144:147], a[56:59], v[208:211]
v_mfma_f32_16x16x32_bf16 v[208:211], a[148:151], a[60:63], v[208:211]
v_mfma_f32_16x16x32_bf16 v[184:187], a[148:151], a[52:55], v[184:187]
v_mfma_f32_16x16x32_bf16 v[184:187], a[144:147], a[48:51], v[184:187]
v_mfma_f32_16x16x32_bf16 v[160:163], a[144:147], a[40:43], v[160:163]
buffer_load_dwordx4 a[28:31], v2, s[40:43], s33 offen offset:3072 sc1
s_add_u32 s35, s35, 8192
v_mfma_f32_16x16x32_bf16 v[160:163], a[148:151], a[44:47], v[160:163]
s_add_u32 s33, s33, 8192
v_mfma_f32_16x16x32_bf16 v[136:139], a[148:151], a[36:39], v[136:139]
v_mfma_f32_16x16x32_bf16 v[136:139], a[144:147], a[32:35], v[136:139]
s_waitcnt vmcnt(10) lgkmcnt(0)
v_mfma_f32_16x16x32_bf16 v[140:143], a[96:99], a[64:67], v[140:143]
ds_read_b128 a[128:131], v5 offset:29696
v_mfma_f32_16x16x32_bf16 v[140:143], a[100:103], a[68:71], v[140:143]
buffer_load_dwordx4 a[32:35], v2, s[40:43], s35 offen offset:0 sc1
v_mfma_f32_16x16x32_bf16 v[164:167], a[100:103], a[76:79], v[164:167]
ds_read_b128 a[132:135], v5 offset:35840
v_mfma_f32_16x16x32_bf16 v[164:167], a[96:99], a[72:75], v[164:167]
v_mfma_f32_16x16x32_bf16 v[188:191], a[96:99], a[80:83], v[188:191]
v_mfma_f32_16x16x32_bf16 v[188:191], a[100:103], a[84:87], v[188:191]
buffer_load_dwordx4 a[36:39], v2, s[40:43], s33 offen offset:0 sc1
v_mfma_f32_16x16x32_bf16 v[212:215], a[100:103], a[92:95], v[212:215]
ds_read_b128 a[136:139], v5 offset:24576
v_mfma_f32_16x16x32_bf16 v[212:215], a[96:99], a[88:91], v[212:215]
v_mfma_f32_16x16x32_bf16 v[216:219], a[104:107], a[88:91], v[216:219]
ds_read_b128 a[140:143], v5 offset:30720
v_mfma_f32_16x16x32_bf16 v[216:219], a[108:111], a[92:95], v[216:219]
v_mfma_f32_16x16x32_bf16 v[192:195], a[108:111], a[84:87], v[192:195]
buffer_load_dwordx4 v1, s[4:7], s44 offen offset:1024 sc1 lds
v_mfma_f32_16x16x32_bf16 v[192:195], a[104:107], a[80:83], v[192:195]
ds_read_b128 a[144:147], v5 offset:25600
v_mfma_f32_16x16x32_bf16 v[168:171], a[104:107], a[72:75], v[168:171]
v_mfma_f32_16x16x32_bf16 v[168:171], a[108:111], a[76:79], v[168:171]
ds_read_b128 a[148:151], v5 offset:31744
v_mfma_f32_16x16x32_bf16 v[144:147], a[108:111], a[68:71], v[144:147]
v_mfma_f32_16x16x32_bf16 v[144:147], a[104:107], a[64:67], v[144:147]
buffer_load_dwordx4 a[40:43], v2, s[40:43], s35 offen offset:1024 sc1
v_mfma_f32_16x16x32_bf16 v[148:151], a[112:115], a[64:67], v[148:151]
v_mfma_f32_16x16x32_bf16 v[148:151], a[116:119], a[68:71], v[148:151]
v_mfma_f32_16x16x32_bf16 v[172:175], a[116:119], a[76:79], v[172:175]
v_mfma_f32_16x16x32_bf16 v[172:175], a[112:115], a[72:75], v[172:175]
v_mfma_f32_16x16x32_bf16 v[196:199], a[112:115], a[80:83], v[196:199]
buffer_load_dwordx4 a[44:47], v2, s[40:43], s33 offen offset:1024 sc1
v_mfma_f32_16x16x32_bf16 v[196:199], a[116:119], a[84:87], v[196:199]
v_mfma_f32_16x16x32_bf16 v[220:223], a[116:119], a[92:95], v[220:223]
v_mfma_f32_16x16x32_bf16 v[220:223], a[112:115], a[88:91], v[220:223]
s_waitcnt lgkmcnt(0)
v_mfma_f32_16x16x32_bf16 v[224:227], a[128:131], a[88:91], v[224:227]
ds_read_b128 a[96:99], v5 offset:38912
v_mfma_f32_16x16x32_bf16 v[224:227], a[132:135], a[92:95], v[224:227]
buffer_load_dwordx4 a[48:51], v2, s[40:43], s35 offen offset:2048 sc1
v_mfma_f32_16x16x32_bf16 v[200:203], a[132:135], a[84:87], v[200:203]
ds_read_b128 a[100:103], v5 offset:45056
v_mfma_f32_16x16x32_bf16 v[200:203], a[128:131], a[80:83], v[200:203]
v_mfma_f32_16x16x32_bf16 v[176:179], a[128:131], a[72:75], v[176:179]
v_mfma_f32_16x16x32_bf16 v[176:179], a[132:135], a[76:79], v[176:179]
buffer_load_dwordx4 v1, s[4:7], s44 offen offset:2048 sc1 lds
s_add_u32 s88, s82, 0x2c0000
v_mfma_f32_16x16x32_bf16 v[152:155], a[132:135], a[68:71], v[152:155]
ds_read_b128 a[104:107], v5 offset:39936
v_mfma_f32_16x16x32_bf16 v[152:155], a[128:131], a[64:67], v[152:155]
v_mfma_f32_16x16x32_bf16 v[132:135], a[136:139], a[64:67], v[132:135]
ds_read_b128 a[108:111], v5 offset:46080
v_mfma_f32_16x16x32_bf16 v[132:135], a[140:143], a[68:71], v[132:135]
buffer_load_dwordx4 a[52:55], v2, s[40:43], s33 offen offset:2048 sc1
v_mfma_f32_16x16x32_bf16 v[156:159], a[140:143], a[76:79], v[156:159]
ds_read_b128 a[112:115], v5 offset:40960
v_mfma_f32_16x16x32_bf16 v[156:159], a[136:139], a[72:75], v[156:159]
v_mfma_f32_16x16x32_bf16 v[180:183], a[136:139], a[80:83], v[180:183]
v_mfma_f32_16x16x32_bf16 v[180:183], a[140:143], a[84:87], v[180:183]
buffer_load_dwordx4 a[56:59], v2, s[40:43], s35 offen offset:3072 sc1
v_mfma_f32_16x16x32_bf16 v[204:207], a[140:143], a[92:95], v[204:207]
ds_read_b128 a[116:119], v5 offset:47104
v_mfma_f32_16x16x32_bf16 v[204:207], a[136:139], a[88:91], v[204:207]
v_mfma_f32_16x16x32_bf16 v[208:211], a[144:147], a[88:91], v[208:211]
v_mfma_f32_16x16x32_bf16 v[208:211], a[148:151], a[92:95], v[208:211]
buffer_load_dwordx4 v[92:95], v1, s[4:7], s88 offen offset:0 sc1
v_mfma_f32_16x16x32_bf16 v[184:187], a[148:151], a[84:87], v[184:187]
v_mfma_f32_16x16x32_bf16 v[184:187], a[144:147], a[80:83], v[184:187]
v_mfma_f32_16x16x32_bf16 v[160:163], a[144:147], a[72:75], v[160:163]
v_mfma_f32_16x16x32_bf16 v[160:163], a[148:151], a[76:79], v[160:163]
buffer_load_dwordx4 a[60:63], v2, s[40:43], s33 offen offset:3072 sc1
s_add_u32 s35, s35, 8192
v_mfma_f32_16x16x32_bf16 v[136:139], a[148:151], a[68:71], v[136:139]
s_add_u32 s33, s33, 8192
v_mfma_f32_16x16x32_bf16 v[136:139], a[144:147], a[64:67], v[136:139]
s_waitcnt vmcnt(11) lgkmcnt(0)
v_mfma_f32_16x16x32_bf16 v[140:143], a[96:99], a[0:3], v[140:143]
ds_read_b128 a[128:131], v5 offset:41984
v_mfma_f32_16x16x32_bf16 v[140:143], a[100:103], a[4:7], v[140:143]
buffer_load_dwordx4 a[64:67], v2, s[40:43], s35 offen offset:0 sc1
v_mfma_f32_16x16x32_bf16 v[164:167], a[100:103], a[12:15], v[164:167]
ds_read_b128 a[132:135], v5 offset:48128
v_mfma_f32_16x16x32_bf16 v[164:167], a[96:99], a[8:11], v[164:167]
v_mfma_f32_16x16x32_bf16 v[188:191], a[96:99], a[16:19], v[188:191]
v_mfma_f32_16x16x32_bf16 v[188:191], a[100:103], a[20:23], v[188:191]
buffer_load_dwordx4 a[68:71], v2, s[40:43], s33 offen offset:0 sc1
v_mfma_f32_16x16x32_bf16 v[212:215], a[100:103], a[28:31], v[212:215]
ds_read_b128 a[136:139], v5 offset:36864
v_mfma_f32_16x16x32_bf16 v[212:215], a[96:99], a[24:27], v[212:215]
v_mfma_f32_16x16x32_bf16 v[216:219], a[104:107], a[24:27], v[216:219]
ds_read_b128 a[140:143], v5 offset:43008
v_mfma_f32_16x16x32_bf16 v[216:219], a[108:111], a[28:31], v[216:219]
v_mfma_f32_16x16x32_bf16 v[192:195], a[108:111], a[20:23], v[192:195]
buffer_load_dwordx4 v[96:99], v1, s[4:7], s88 offen offset:1024 sc1
v_mfma_f32_16x16x32_bf16 v[192:195], a[104:107], a[16:19], v[192:195]
ds_read_b128 a[144:147], v5 offset:37888
v_mfma_f32_16x16x32_bf16 v[168:171], a[104:107], a[8:11], v[168:171]
v_mfma_f32_16x16x32_bf16 v[168:171], a[108:111], a[12:15], v[168:171]
ds_read_b128 a[148:151], v5 offset:44032
v_mfma_f32_16x16x32_bf16 v[144:147], a[108:111], a[4:7], v[144:147]
v_mfma_f32_16x16x32_bf16 v[144:147], a[104:107], a[0:3], v[144:147]
buffer_load_dwordx4 a[72:75], v2, s[40:43], s35 offen offset:1024 sc1
v_mfma_f32_16x16x32_bf16 v[148:151], a[112:115], a[0:3], v[148:151]
v_mfma_f32_16x16x32_bf16 v[148:151], a[116:119], a[4:7], v[148:151]
v_mfma_f32_16x16x32_bf16 v[172:175], a[116:119], a[12:15], v[172:175]
v_mfma_f32_16x16x32_bf16 v[172:175], a[112:115], a[8:11], v[172:175]
v_mfma_f32_16x16x32_bf16 v[196:199], a[112:115], a[16:19], v[196:199]
buffer_load_dwordx4 a[76:79], v2, s[40:43], s33 offen offset:1024 sc1
v_mfma_f32_16x16x32_bf16 v[196:199], a[116:119], a[20:23], v[196:199]
v_mfma_f32_16x16x32_bf16 v[220:223], a[116:119], a[28:31], v[220:223]
v_mfma_f32_16x16x32_bf16 v[220:223], a[112:115], a[24:27], v[220:223]
s_waitcnt lgkmcnt(0)
s_barrier
v_mfma_f32_16x16x32_bf16 v[224:227], a[128:131], a[24:27], v[224:227]
v_add_u32 v5, 49152, v1
v_mfma_f32_16x16x32_bf16 v[224:227], a[132:135], a[28:31], v[224:227]
buffer_load_dwordx4 a[80:83], v2, s[40:43], s35 offen offset:2048 sc1
v_mfma_f32_16x16x32_bf16 v[200:203], a[132:135], a[20:23], v[200:203]
ds_read_b128 a[96:99], v5 offset:2048
v_mfma_f32_16x16x32_bf16 v[200:203], a[128:131], a[16:19], v[200:203]
ds_read_b128 a[100:103], v5 offset:8192
v_mfma_f32_16x16x32_bf16 v[176:179], a[128:131], a[8:11], v[176:179]
v_mfma_f32_16x16x32_bf16 v[176:179], a[132:135], a[12:15], v[176:179]
buffer_load_dwordx4 a[84:87], v2, s[40:43], s33 offen offset:2048 sc1
v_mfma_f32_16x16x32_bf16 v[152:155], a[132:135], a[4:7], v[152:155]
ds_read_b128 a[104:107], v5 offset:3072
v_mfma_f32_16x16x32_bf16 v[152:155], a[128:131], a[0:3], v[152:155]
v_mfma_f32_16x16x32_bf16 v[132:135], a[136:139], a[0:3], v[132:135]
ds_read_b128 a[108:111], v5 offset:9216
v_mfma_f32_16x16x32_bf16 v[132:135], a[140:143], a[4:7], v[132:135]
v_mfma_f32_16x16x32_bf16 v[156:159], a[140:143], a[12:15], v[156:159]
buffer_load_dwordx4 v[100:103], v1, s[4:7], s88 offen offset:2048 sc1
v_mfma_f32_16x16x32_bf16 v[156:159], a[136:139], a[8:11], v[156:159]
ds_read_b128 a[112:115], v5 offset:4096
v_mfma_f32_16x16x32_bf16 v[180:183], a[136:139], a[16:19], v[180:183]
v_mfma_f32_16x16x32_bf16 v[180:183], a[140:143], a[20:23], v[180:183]
ds_read_b128 a[116:119], v5 offset:10240
v_mfma_f32_16x16x32_bf16 v[204:207], a[140:143], a[28:31], v[204:207]
v_mfma_f32_16x16x32_bf16 v[204:207], a[136:139], a[24:27], v[204:207]
buffer_load_dwordx4 a[88:91], v2, s[40:43], s35 offen offset:3072 sc1
v_mfma_f32_16x16x32_bf16 v[208:211], a[144:147], a[24:27], v[208:211]
v_mfma_f32_16x16x32_bf16 v[208:211], a[148:151], a[28:31], v[208:211]
v_mfma_f32_16x16x32_bf16 v[184:187], a[148:151], a[20:23], v[184:187]
v_mfma_f32_16x16x32_bf16 v[184:187], a[144:147], a[16:19], v[184:187]
v_mfma_f32_16x16x32_bf16 v[160:163], a[144:147], a[8:11], v[160:163]
buffer_load_dwordx4 a[92:95], v2, s[40:43], s33 offen offset:3072 sc1
s_add_u32 s35, s35, 8192
v_mfma_f32_16x16x32_bf16 v[160:163], a[148:151], a[12:15], v[160:163]
s_add_u32 s33, s33, 8192
v_mfma_f32_16x16x32_bf16 v[136:139], a[148:151], a[4:7], v[136:139]
v_mfma_f32_16x16x32_bf16 v[136:139], a[144:147], a[0:3], v[136:139]
s_waitcnt vmcnt(10) lgkmcnt(0)
v_mfma_f32_16x16x32_bf16 v[140:143], a[96:99], a[32:35], v[140:143]
ds_read_b128 a[128:131], v5 offset:5120
v_mfma_f32_16x16x32_bf16 v[140:143], a[100:103], a[36:39], v[140:143]
buffer_load_dwordx4 a[0:3], v2, s[40:43], s35 offen offset:0 sc1
v_mfma_f32_16x16x32_bf16 v[164:167], a[100:103], a[44:47], v[164:167]
ds_read_b128 a[132:135], v5 offset:11264
v_mfma_f32_16x16x32_bf16 v[164:167], a[96:99], a[40:43], v[164:167]
v_mfma_f32_16x16x32_bf16 v[188:191], a[96:99], a[48:51], v[188:191]
v_mfma_f32_16x16x32_bf16 v[188:191], a[100:103], a[52:55], v[188:191]
buffer_load_dwordx4 a[4:7], v2, s[40:43], s33 offen offset:0 sc1
v_mfma_f32_16x16x32_bf16 v[212:215], a[100:103], a[60:63], v[212:215]
ds_read_b128 a[136:139], v5 offset:0
v_mfma_f32_16x16x32_bf16 v[212:215], a[96:99], a[56:59], v[212:215]
v_mfma_f32_16x16x32_bf16 v[216:219], a[104:107], a[56:59], v[216:219]
ds_read_b128 a[140:143], v5 offset:6144
v_mfma_f32_16x16x32_bf16 v[216:219], a[108:111], a[60:63], v[216:219]
v_mfma_f32_16x16x32_bf16 v[192:195], a[108:111], a[52:55], v[192:195]
buffer_load_dwordx4 v[104:107], v1, s[4:7], s88 offen offset:3072 sc1
s_add_u32 s88, s88, 4096
v_mfma_f32_16x16x32_bf16 v[192:195], a[104:107], a[48:51], v[192:195]
ds_read_b128 a[144:147], v5 offset:1024
v_mfma_f32_16x16x32_bf16 v[168:171], a[104:107], a[40:43], v[168:171]
v_mfma_f32_16x16x32_bf16 v[168:171], a[108:111], a[44:47], v[168:171]
ds_read_b128 a[148:151], v5 offset:7168
v_mfma_f32_16x16x32_bf16 v[144:147], a[108:111], a[36:39], v[144:147]
v_mfma_f32_16x16x32_bf16 v[144:147], a[104:107], a[32:35], v[144:147]
buffer_load_dwordx4 a[8:11], v2, s[40:43], s35 offen offset:1024 sc1
v_mfma_f32_16x16x32_bf16 v[148:151], a[112:115], a[32:35], v[148:151]
v_mfma_f32_16x16x32_bf16 v[148:151], a[116:119], a[36:39], v[148:151]
v_mfma_f32_16x16x32_bf16 v[172:175], a[116:119], a[44:47], v[172:175]
v_mfma_f32_16x16x32_bf16 v[172:175], a[112:115], a[40:43], v[172:175]
v_mfma_f32_16x16x32_bf16 v[196:199], a[112:115], a[48:51], v[196:199]
buffer_load_dwordx4 a[12:15], v2, s[40:43], s33 offen offset:1024 sc1
v_mfma_f32_16x16x32_bf16 v[196:199], a[116:119], a[52:55], v[196:199]
v_mfma_f32_16x16x32_bf16 v[220:223], a[116:119], a[60:63], v[220:223]
v_mfma_f32_16x16x32_bf16 v[220:223], a[112:115], a[56:59], v[220:223]
s_waitcnt lgkmcnt(0)
v_mfma_f32_16x16x32_bf16 v[224:227], a[128:131], a[56:59], v[224:227]
ds_read_b128 a[96:99], v5 offset:14336
v_mfma_f32_16x16x32_bf16 v[224:227], a[132:135], a[60:63], v[224:227]
buffer_load_dwordx4 a[16:19], v2, s[40:43], s35 offen offset:2048 sc1
v_mfma_f32_16x16x32_bf16 v[200:203], a[132:135], a[52:55], v[200:203]
ds_read_b128 a[100:103], v5 offset:20480
v_mfma_f32_16x16x32_bf16 v[200:203], a[128:131], a[48:51], v[200:203]
v_mfma_f32_16x16x32_bf16 v[176:179], a[128:131], a[40:43], v[176:179]
v_mfma_f32_16x16x32_bf16 v[176:179], a[132:135], a[44:47], v[176:179]
buffer_load_dwordx4 a[20:23], v2, s[40:43], s33 offen offset:2048 sc1
v_mfma_f32_16x16x32_bf16 v[152:155], a[132:135], a[36:39], v[152:155]
ds_read_b128 a[104:107], v5 offset:15360
v_mfma_f32_16x16x32_bf16 v[152:155], a[128:131], a[32:35], v[152:155]
v_mfma_f32_16x16x32_bf16 v[132:135], a[136:139], a[32:35], v[132:135]
ds_read_b128 a[108:111], v5 offset:21504
v_mfma_f32_16x16x32_bf16 v[132:135], a[140:143], a[36:39], v[132:135]
v_mfma_f32_16x16x32_bf16 v[156:159], a[140:143], a[44:47], v[156:159]
buffer_load_dwordx4 v[108:111], v1, s[4:7], s88 offen offset:0 sc1
v_mfma_f32_16x16x32_bf16 v[156:159], a[136:139], a[40:43], v[156:159]
ds_read_b128 a[112:115], v5 offset:16384
v_mfma_f32_16x16x32_bf16 v[180:183], a[136:139], a[48:51], v[180:183]
v_mfma_f32_16x16x32_bf16 v[180:183], a[140:143], a[52:55], v[180:183]
ds_read_b128 a[116:119], v5 offset:22528
v_mfma_f32_16x16x32_bf16 v[204:207], a[140:143], a[60:63], v[204:207]
v_mfma_f32_16x16x32_bf16 v[204:207], a[136:139], a[56:59], v[204:207]
buffer_load_dwordx4 a[24:27], v2, s[40:43], s35 offen offset:3072 sc1
v_mfma_f32_16x16x32_bf16 v[208:211], a[144:147], a[56:59], v[208:211]
v_mfma_f32_16x16x32_bf16 v[208:211], a[148:151], a[60:63], v[208:211]
v_mfma_f32_16x16x32_bf16 v[184:187], a[148:151], a[52:55], v[184:187]
v_mfma_f32_16x16x32_bf16 v[184:187], a[144:147], a[48:51], v[184:187]
v_mfma_f32_16x16x32_bf16 v[160:163], a[144:147], a[40:43], v[160:163]
buffer_load_dwordx4 a[28:31], v2, s[40:43], s33 offen offset:3072 sc1
s_add_u32 s35, s35, 8192
v_mfma_f32_16x16x32_bf16 v[160:163], a[148:151], a[44:47], v[160:163]
s_add_u32 s33, s33, 8192
v_mfma_f32_16x16x32_bf16 v[136:139], a[148:151], a[36:39], v[136:139]
v_mfma_f32_16x16x32_bf16 v[136:139], a[144:147], a[32:35], v[136:139]
s_waitcnt vmcnt(10) lgkmcnt(0)
v_mfma_f32_16x16x32_bf16 v[140:143], a[96:99], a[64:67], v[140:143]
ds_read_b128 a[128:131], v5 offset:17408
v_mfma_f32_16x16x32_bf16 v[140:143], a[100:103], a[68:71], v[140:143]
buffer_load_dwordx4 a[32:35], v2, s[40:43], s35 offen offset:0 sc1
v_mfma_f32_16x16x32_bf16 v[164:167], a[100:103], a[76:79], v[164:167]
ds_read_b128 a[132:135], v5 offset:23552
v_mfma_f32_16x16x32_bf16 v[164:167], a[96:99], a[72:75], v[164:167]
v_mfma_f32_16x16x32_bf16 v[188:191], a[96:99], a[80:83], v[188:191]
v_mfma_f32_16x16x32_bf16 v[188:191], a[100:103], a[84:87], v[188:191]
buffer_load_dwordx4 a[36:39], v2, s[40:43], s33 offen offset:0 sc1
v_mfma_f32_16x16x32_bf16 v[212:215], a[100:103], a[92:95], v[212:215]
ds_read_b128 a[136:139], v5 offset:12288
v_mfma_f32_16x16x32_bf16 v[212:215], a[96:99], a[88:91], v[212:215]
v_mfma_f32_16x16x32_bf16 v[216:219], a[104:107], a[88:91], v[216:219]
ds_read_b128 a[140:143], v5 offset:18432
v_mfma_f32_16x16x32_bf16 v[216:219], a[108:111], a[92:95], v[216:219]
v_mfma_f32_16x16x32_bf16 v[192:195], a[108:111], a[84:87], v[192:195]
buffer_load_dwordx4 v[112:115], v1, s[4:7], s88 offen offset:1024 sc1
v_mfma_f32_16x16x32_bf16 v[192:195], a[104:107], a[80:83], v[192:195]
ds_read_b128 a[144:147], v5 offset:13312
v_mfma_f32_16x16x32_bf16 v[168:171], a[104:107], a[72:75], v[168:171]
v_mfma_f32_16x16x32_bf16 v[168:171], a[108:111], a[76:79], v[168:171]
ds_read_b128 a[148:151], v5 offset:19456
v_mfma_f32_16x16x32_bf16 v[144:147], a[108:111], a[68:71], v[144:147]
v_mfma_f32_16x16x32_bf16 v[144:147], a[104:107], a[64:67], v[144:147]
buffer_load_dwordx4 a[40:43], v2, s[40:43], s35 offen offset:1024 sc1
v_mfma_f32_16x16x32_bf16 v[148:151], a[112:115], a[64:67], v[148:151]
v_mfma_f32_16x16x32_bf16 v[148:151], a[116:119], a[68:71], v[148:151]
v_mfma_f32_16x16x32_bf16 v[172:175], a[116:119], a[76:79], v[172:175]
v_mfma_f32_16x16x32_bf16 v[172:175], a[112:115], a[72:75], v[172:175]
v_mfma_f32_16x16x32_bf16 v[196:199], a[112:115], a[80:83], v[196:199]
buffer_load_dwordx4 a[44:47], v2, s[40:43], s33 offen offset:1024 sc1
v_mfma_f32_16x16x32_bf16 v[196:199], a[116:119], a[84:87], v[196:199]
v_mfma_f32_16x16x32_bf16 v[220:223], a[116:119], a[92:95], v[220:223]
v_mfma_f32_16x16x32_bf16 v[220:223], a[112:115], a[88:91], v[220:223]
s_waitcnt lgkmcnt(0)
v_mfma_f32_16x16x32_bf16 v[224:227], a[128:131], a[88:91], v[224:227]
ds_read_b128 a[96:99], v5 offset:26624
v_mfma_f32_16x16x32_bf16 v[224:227], a[132:135], a[92:95], v[224:227]
buffer_load_dwordx4 a[48:51], v2, s[40:43], s35 offen offset:2048 sc1
v_mfma_f32_16x16x32_bf16 v[200:203], a[132:135], a[84:87], v[200:203]
ds_read_b128 a[100:103], v5 offset:32768
v_mfma_f32_16x16x32_bf16 v[200:203], a[128:131], a[80:83], v[200:203]
v_mfma_f32_16x16x32_bf16 v[176:179], a[128:131], a[72:75], v[176:179]
v_mfma_f32_16x16x32_bf16 v[176:179], a[132:135], a[76:79], v[176:179]
buffer_load_dwordx4 a[52:55], v2, s[40:43], s33 offen offset:2048 sc1
v_mfma_f32_16x16x32_bf16 v[152:155], a[132:135], a[68:71], v[152:155]
ds_read_b128 a[104:107], v5 offset:27648
v_mfma_f32_16x16x32_bf16 v[152:155], a[128:131], a[64:67], v[152:155]
v_mfma_f32_16x16x32_bf16 v[132:135], a[136:139], a[64:67], v[132:135]
ds_read_b128 a[108:111], v5 offset:33792
v_mfma_f32_16x16x32_bf16 v[132:135], a[140:143], a[68:71], v[132:135]
v_mfma_f32_16x16x32_bf16 v[156:159], a[140:143], a[76:79], v[156:159]
buffer_load_dwordx4 v[116:119], v1, s[4:7], s88 offen offset:2048 sc1
v_mfma_f32_16x16x32_bf16 v[156:159], a[136:139], a[72:75], v[156:159]
ds_read_b128 a[112:115], v5 offset:28672
v_mfma_f32_16x16x32_bf16 v[180:183], a[136:139], a[80:83], v[180:183]
v_mfma_f32_16x16x32_bf16 v[180:183], a[140:143], a[84:87], v[180:183]
ds_read_b128 a[116:119], v5 offset:34816
v_mfma_f32_16x16x32_bf16 v[204:207], a[140:143], a[92:95], v[204:207]
v_mfma_f32_16x16x32_bf16 v[204:207], a[136:139], a[88:91], v[204:207]
buffer_load_dwordx4 a[56:59], v2, s[40:43], s35 offen offset:3072 sc1
v_mfma_f32_16x16x32_bf16 v[208:211], a[144:147], a[88:91], v[208:211]
v_mfma_f32_16x16x32_bf16 v[208:211], a[148:151], a[92:95], v[208:211]
v_mfma_f32_16x16x32_bf16 v[184:187], a[148:151], a[84:87], v[184:187]
v_mfma_f32_16x16x32_bf16 v[184:187], a[144:147], a[80:83], v[184:187]
v_mfma_f32_16x16x32_bf16 v[160:163], a[144:147], a[72:75], v[160:163]
buffer_load_dwordx4 a[60:63], v2, s[40:43], s33 offen offset:3072 sc1
s_add_u32 s35, s35, 8192
v_mfma_f32_16x16x32_bf16 v[160:163], a[148:151], a[76:79], v[160:163]
s_add_u32 s33, s33, 8192
v_mfma_f32_16x16x32_bf16 v[136:139], a[148:151], a[68:71], v[136:139]
v_mfma_f32_16x16x32_bf16 v[136:139], a[144:147], a[64:67], v[136:139]
s_waitcnt vmcnt(10) lgkmcnt(0)
v_mfma_f32_16x16x32_bf16 v[140:143], a[96:99], a[0:3], v[140:143]
ds_read_b128 a[128:131], v5 offset:29696
v_mfma_f32_16x16x32_bf16 v[140:143], a[100:103], a[4:7], v[140:143]
buffer_load_dwordx4 a[64:67], v2, s[40:43], s35 offen offset:0 sc1
v_mfma_f32_16x16x32_bf16 v[164:167], a[100:103], a[12:15], v[164:167]
ds_read_b128 a[132:135], v5 offset:35840
v_mfma_f32_16x16x32_bf16 v[164:167], a[96:99], a[8:11], v[164:167]
v_mfma_f32_16x16x32_bf16 v[188:191], a[96:99], a[16:19], v[188:191]
v_mfma_f32_16x16x32_bf16 v[188:191], a[100:103], a[20:23], v[188:191]
buffer_load_dwordx4 a[68:71], v2, s[40:43], s33 offen offset:0 sc1
v_mfma_f32_16x16x32_bf16 v[212:215], a[100:103], a[28:31], v[212:215]
ds_read_b128 a[136:139], v5 offset:24576
v_mfma_f32_16x16x32_bf16 v[212:215], a[96:99], a[24:27], v[212:215]
v_mfma_f32_16x16x32_bf16 v[216:219], a[104:107], a[24:27], v[216:219]
ds_read_b128 a[140:143], v5 offset:30720
v_mfma_f32_16x16x32_bf16 v[216:219], a[108:111], a[28:31], v[216:219]
v_mfma_f32_16x16x32_bf16 v[192:195], a[108:111], a[20:23], v[192:195]
buffer_load_dwordx4 v[120:123], v1, s[4:7], s88 offen offset:3072 sc1
s_add_u32 m0, s18, 0x0
v_mfma_f32_16x16x32_bf16 v[192:195], a[104:107], a[16:19], v[192:195]
s_add_u32 s44, s50, 0x1424000
ds_read_b128 a[144:147], v5 offset:25600
v_mfma_f32_16x16x32_bf16 v[168:171], a[104:107], a[8:11], v[168:171]
v_mfma_f32_16x16x32_bf16 v[168:171], a[108:111], a[12:15], v[168:171]
ds_read_b128 a[148:151], v5 offset:31744
v_mfma_f32_16x16x32_bf16 v[144:147], a[108:111], a[4:7], v[144:147]
v_mfma_f32_16x16x32_bf16 v[144:147], a[104:107], a[0:3], v[144:147]
buffer_load_dwordx4 a[72:75], v2, s[40:43], s35 offen offset:1024 sc1
v_mfma_f32_16x16x32_bf16 v[148:151], a[112:115], a[0:3], v[148:151]
v_mfma_f32_16x16x32_bf16 v[148:151], a[116:119], a[4:7], v[148:151]
v_mfma_f32_16x16x32_bf16 v[172:175], a[116:119], a[12:15], v[172:175]
v_mfma_f32_16x16x32_bf16 v[172:175], a[112:115], a[8:11], v[172:175]
v_mfma_f32_16x16x32_bf16 v[196:199], a[112:115], a[16:19], v[196:199]
buffer_load_dwordx4 a[76:79], v2, s[40:43], s33 offen offset:1024 sc1
v_mfma_f32_16x16x32_bf16 v[196:199], a[116:119], a[20:23], v[196:199]
v_mfma_f32_16x16x32_bf16 v[220:223], a[116:119], a[28:31], v[220:223]
v_mfma_f32_16x16x32_bf16 v[220:223], a[112:115], a[24:27], v[220:223]
s_waitcnt lgkmcnt(0)
v_mfma_f32_16x16x32_bf16 v[224:227], a[128:131], a[24:27], v[224:227]
ds_read_b128 a[96:99], v5 offset:38912
v_mfma_f32_16x16x32_bf16 v[224:227], a[132:135], a[28:31], v[224:227]
buffer_load_dwordx4 a[80:83], v2, s[40:43], s35 offen offset:2048 sc1
v_mfma_f32_16x16x32_bf16 v[200:203], a[132:135], a[20:23], v[200:203]
ds_read_b128 a[100:103], v5 offset:45056
v_mfma_f32_16x16x32_bf16 v[200:203], a[128:131], a[16:19], v[200:203]
v_mfma_f32_16x16x32_bf16 v[176:179], a[128:131], a[8:11], v[176:179]
v_mfma_f32_16x16x32_bf16 v[176:179], a[132:135], a[12:15], v[176:179]
buffer_load_dwordx4 v1, s[4:7], s44 offen offset:0 sc1 lds
v_mfma_f32_16x16x32_bf16 v[152:155], a[132:135], a[4:7], v[152:155]
ds_read_b128 a[104:107], v5 offset:39936
v_mfma_f32_16x16x32_bf16 v[152:155], a[128:131], a[0:3], v[152:155]
v_mfma_f32_16x16x32_bf16 v[132:135], a[136:139], a[0:3], v[132:135]
ds_read_b128 a[108:111], v5 offset:46080
v_mfma_f32_16x16x32_bf16 v[132:135], a[140:143], a[4:7], v[132:135]
buffer_load_dwordx4 a[84:87], v2, s[40:43], s33 offen offset:2048 sc1
v_mfma_f32_16x16x32_bf16 v[156:159], a[140:143], a[12:15], v[156:159]
ds_read_b128 a[112:115], v5 offset:40960
v_mfma_f32_16x16x32_bf16 v[156:159], a[136:139], a[8:11], v[156:159]
v_mfma_f32_16x16x32_bf16 v[180:183], a[136:139], a[16:19], v[180:183]
v_mfma_f32_16x16x32_bf16 v[180:183], a[140:143], a[20:23], v[180:183]
buffer_load_dwordx4 a[88:91], v2, s[40:43], s35 offen offset:3072 sc1
v_mfma_f32_16x16x32_bf16 v[204:207], a[140:143], a[28:31], v[204:207]
ds_read_b128 a[116:119], v5 offset:47104
v_mfma_f32_16x16x32_bf16 v[204:207], a[136:139], a[24:27], v[204:207]
v_mfma_f32_16x16x32_bf16 v[208:211], a[144:147], a[24:27], v[208:211]
v_mfma_f32_16x16x32_bf16 v[208:211], a[148:151], a[28:31], v[208:211]
buffer_load_dwordx4 v1, s[4:7], s44 offen offset:1024 sc1 lds
v_mfma_f32_16x16x32_bf16 v[184:187], a[148:151], a[20:23], v[184:187]
v_mfma_f32_16x16x32_bf16 v[184:187], a[144:147], a[16:19], v[184:187]
v_mfma_f32_16x16x32_bf16 v[160:163], a[144:147], a[8:11], v[160:163]
v_mfma_f32_16x16x32_bf16 v[160:163], a[148:151], a[12:15], v[160:163]
buffer_load_dwordx4 a[92:95], v2, s[40:43], s33 offen offset:3072 sc1
s_add_u32 s35, s35, 8192
v_mfma_f32_16x16x32_bf16 v[136:139], a[148:151], a[4:7], v[136:139]
s_add_u32 s33, s33, 8192
v_mfma_f32_16x16x32_bf16 v[136:139], a[144:147], a[0:3], v[136:139]
s_waitcnt vmcnt(11) lgkmcnt(0)
v_mfma_f32_16x16x32_bf16 v[140:143], a[96:99], a[32:35], v[140:143]
ds_read_b128 a[128:131], v5 offset:41984
v_mfma_f32_16x16x32_bf16 v[140:143], a[100:103], a[36:39], v[140:143]
buffer_load_dwordx4 a[0:3], v2, s[40:43], s35 offen offset:0 sc1
v_mfma_f32_16x16x32_bf16 v[164:167], a[100:103], a[44:47], v[164:167]
ds_read_b128 a[132:135], v5 offset:48128
v_mfma_f32_16x16x32_bf16 v[164:167], a[96:99], a[40:43], v[164:167]
v_mfma_f32_16x16x32_bf16 v[188:191], a[96:99], a[48:51], v[188:191]
v_mfma_f32_16x16x32_bf16 v[188:191], a[100:103], a[52:55], v[188:191]
buffer_load_dwordx4 a[4:7], v2, s[40:43], s33 offen offset:0 sc1
v_mfma_f32_16x16x32_bf16 v[212:215], a[100:103], a[60:63], v[212:215]
ds_read_b128 a[136:139], v5 offset:36864
v_mfma_f32_16x16x32_bf16 v[212:215], a[96:99], a[56:59], v[212:215]
v_mfma_f32_16x16x32_bf16 v[216:219], a[104:107], a[56:59], v[216:219]
ds_read_b128 a[140:143], v5 offset:43008
v_mfma_f32_16x16x32_bf16 v[216:219], a[108:111], a[60:63], v[216:219]
v_mfma_f32_16x16x32_bf16 v[192:195], a[108:111], a[52:55], v[192:195]
buffer_load_dwordx4 v1, s[4:7], s44 offen offset:2048 sc1 lds
s_add_u32 m0, s18, 0x3000
v_mfma_f32_16x16x32_bf16 v[192:195], a[104:107], a[48:51], v[192:195]
s_add_u32 s44, s50, 0x1427000
ds_read_b128 a[144:147], v5 offset:37888
v_mfma_f32_16x16x32_bf16 v[168:171], a[104:107], a[40:43], v[168:171]
v_mfma_f32_16x16x32_bf16 v[168:171], a[108:111], a[44:47], v[168:171]
ds_read_b128 a[148:151], v5 offset:44032
v_mfma_f32_16x16x32_bf16 v[144:147], a[108:111], a[36:39], v[144:147]
v_mfma_f32_16x16x32_bf16 v[144:147], a[104:107], a[32:35], v[144:147]
buffer_load_dwordx4 a[8:11], v2, s[40:43], s35 offen offset:1024 sc1
v_mfma_f32_16x16x32_bf16 v[148:151], a[112:115], a[32:35], v[148:151]
v_mfma_f32_16x16x32_bf16 v[148:151], a[116:119], a[36:39], v[148:151]
v_mfma_f32_16x16x32_bf16 v[172:175], a[116:119], a[44:47], v[172:175]
v_mfma_f32_16x16x32_bf16 v[172:175], a[112:115], a[40:43], v[172:175]
v_mfma_f32_16x16x32_bf16 v[196:199], a[112:115], a[48:51], v[196:199]
buffer_load_dwordx4 a[12:15], v2, s[40:43], s33 offen offset:1024 sc1
v_mfma_f32_16x16x32_bf16 v[196:199], a[116:119], a[52:55], v[196:199]
v_mfma_f32_16x16x32_bf16 v[220:223], a[116:119], a[60:63], v[220:223]
v_mfma_f32_16x16x32_bf16 v[220:223], a[112:115], a[56:59], v[220:223]
s_waitcnt lgkmcnt(0)
s_barrier
v_mfma_f32_16x16x32_bf16 v[224:227], a[128:131], a[56:59], v[224:227]
v_add_u32 v5, 98304, v1
v_mfma_f32_16x16x32_bf16 v[224:227], a[132:135], a[60:63], v[224:227]
buffer_load_dwordx4 a[16:19], v2, s[40:43], s35 offen offset:2048 sc1
v_mfma_f32_16x16x32_bf16 v[200:203], a[132:135], a[52:55], v[200:203]
ds_read_b128 a[96:99], v5 offset:2048
v_mfma_f32_16x16x32_bf16 v[200:203], a[128:131], a[48:51], v[200:203]
ds_read_b128 a[100:103], v5 offset:8192
v_mfma_f32_16x16x32_bf16 v[176:179], a[128:131], a[40:43], v[176:179]
v_mfma_f32_16x16x32_bf16 v[176:179], a[132:135], a[44:47], v[176:179]
buffer_load_dwordx4 a[20:23], v2, s[40:43], s33 offen offset:2048 sc1
v_mfma_f32_16x16x32_bf16 v[152:155], a[132:135], a[36:39], v[152:155]
ds_read_b128 a[104:107], v5 offset:3072
v_mfma_f32_16x16x32_bf16 v[152:155], a[128:131], a[32:35], v[152:155]
v_mfma_f32_16x16x32_bf16 v[132:135], a[136:139], a[32:35], v[132:135]
ds_read_b128 a[108:111], v5 offset:9216
v_mfma_f32_16x16x32_bf16 v[132:135], a[140:143], a[36:39], v[132:135]
v_mfma_f32_16x16x32_bf16 v[156:159], a[140:143], a[44:47], v[156:159]
buffer_load_dwordx4 v1, s[4:7], s44 offen offset:0 sc1 lds
v_mfma_f32_16x16x32_bf16 v[156:159], a[136:139], a[40:43], v[156:159]
L_stub16:
s_cbranch_execz L_stub17
ds_read_b128 a[112:115], v5 offset:4096
v_mfma_f32_16x16x32_bf16 v[180:183], a[136:139], a[48:51], v[180:183]
v_mfma_f32_16x16x32_bf16 v[180:183], a[140:143], a[52:55], v[180:183]
ds_read_b128 a[116:119], v5 offset:10240
v_mfma_f32_16x16x32_bf16 v[204:207], a[140:143], a[60:63], v[204:207]
v_mfma_f32_16x16x32_bf16 v[204:207], a[136:139], a[56:59], v[204:207]
buffer_load_dwordx4 a[24:27], v2, s[40:43], s35 offen offset:3072 sc1
v_mfma_f32_16x16x32_bf16 v[208:211], a[144:147], a[56:59], v[208:211]
v_mfma_f32_16x16x32_bf16 v[208:211], a[148:151], a[60:63], v[208:211]
v_mfma_f32_16x16x32_bf16 v[184:187], a[148:151], a[52:55], v[184:187]
v_mfma_f32_16x16x32_bf16 v[184:187], a[144:147], a[48:51], v[184:187]
v_mfma_f32_16x16x32_bf16 v[160:163], a[144:147], a[40:43], v[160:163]
buffer_load_dwordx4 a[28:31], v2, s[40:43], s33 offen offset:3072 sc1
s_add_u32 s35, s35, 8192
v_mfma_f32_16x16x32_bf16 v[160:163], a[148:151], a[44:47], v[160:163]
s_add_u32 s33, s33, 8192
v_mfma_f32_16x16x32_bf16 v[136:139], a[148:151], a[36:39], v[136:139]
v_mfma_f32_16x16x32_bf16 v[136:139], a[144:147], a[32:35], v[136:139]
s_waitcnt vmcnt(10) lgkmcnt(0)
v_mfma_f32_16x16x32_bf16 v[140:143], a[96:99], a[64:67], v[140:143]
ds_read_b128 a[128:131], v5 offset:5120
v_mfma_f32_16x16x32_bf16 v[140:143], a[100:103], a[68:71], v[140:143]
buffer_load_dwordx4 a[32:35], v2, s[40:43], s35 offen offset:0 sc1
v_mfma_f32_16x16x32_bf16 v[164:167], a[100:103], a[76:79], v[164:167]
ds_read_b128 a[132:135], v5 offset:11264
v_mfma_f32_16x16x32_bf16 v[164:167], a[96:99], a[72:75], v[164:167]
v_mfma_f32_16x16x32_bf16 v[188:191], a[96:99], a[80:83], v[188:191]
v_mfma_f32_16x16x32_bf16 v[188:191], a[100:103], a[84:87], v[188:191]
buffer_load_dwordx4 a[36:39], v2, s[40:43], s33 offen offset:0 sc1
v_mfma_f32_16x16x32_bf16 v[212:215], a[100:103], a[92:95], v[212:215]
ds_read_b128 a[136:139], v5 offset:0
v_mfma_f32_16x16x32_bf16 v[212:215], a[96:99], a[88:91], v[212:215]
v_mfma_f32_16x16x32_bf16 v[216:219], a[104:107], a[88:91], v[216:219]
ds_read_b128 a[140:143], v5 offset:6144
v_mfma_f32_16x16x32_bf16 v[216:219], a[108:111], a[92:95], v[216:219]
v_mfma_f32_16x16x32_bf16 v[192:195], a[108:111], a[84:87], v[192:195]
buffer_load_dwordx4 v1, s[4:7], s44 offen offset:1024 sc1 lds
v_mfma_f32_16x16x32_bf16 v[192:195], a[104:107], a[80:83], v[192:195]
ds_read_b128 a[144:147], v5 offset:1024
v_mfma_f32_16x16x32_bf16 v[168:171], a[104:107], a[72:75], v[168:171]
v_mfma_f32_16x16x32_bf16 v[168:171], a[108:111], a[76:79], v[168:171]
ds_read_b128 a[148:151], v5 offset:7168
v_mfma_f32_16x16x32_bf16 v[144:147], a[108:111], a[68:71], v[144:147]
v_mfma_f32_16x16x32_bf16 v[144:147], a[104:107], a[64:67], v[144:147]
buffer_load_dwordx4 a[40:43], v2, s[40:43], s35 offen offset:1024 sc1
v_mfma_f32_16x16x32_bf16 v[148:151], a[112:115], a[64:67], v[148:151]
v_mfma_f32_16x16x32_bf16 v[148:151], a[116:119], a[68:71], v[148:151]
v_mfma_f32_16x16x32_bf16 v[172:175], a[116:119], a[76:79], v[172:175]
v_mfma_f32_16x16x32_bf16 v[172:175], a[112:115], a[72:75], v[172:175]
v_mfma_f32_16x16x32_bf16 v[196:199], a[112:115], a[80:83], v[196:199]
buffer_load_dwordx4 a[44:47], v2, s[40:43], s33 offen offset:1024 sc1
v_mfma_f32_16x16x32_bf16 v[196:199], a[116:119], a[84:87], v[196:199]
v_mfma_f32_16x16x32_bf16 v[220:223], a[116:119], a[92:95], v[220:223]
v_mfma_f32_16x16x32_bf16 v[220:223], a[112:115], a[88:91], v[220:223]
s_waitcnt lgkmcnt(0)
v_mfma_f32_16x16x32_bf16 v[224:227], a[128:131], a[88:91], v[224:227]
ds_read_b128 a[96:99], v5 offset:14336
v_mfma_f32_16x16x32_bf16 v[224:227], a[132:135], a[92:95], v[224:227]
buffer_load_dwordx4 a[48:51], v2, s[40:43], s35 offen offset:2048 sc1
v_mfma_f32_16x16x32_bf16 v[200:203], a[132:135], a[84:87], v[200:203]
ds_read_b128 a[100:103], v5 offset:20480
v_mfma_f32_16x16x32_bf16 v[200:203], a[128:131], a[80:83], v[200:203]
v_mfma_f32_16x16x32_bf16 v[176:179], a[128:131], a[72:75], v[176:179]
v_mfma_f32_16x16x32_bf16 v[176:179], a[132:135], a[76:79], v[176:179]
buffer_load_dwordx4 a[52:55], v2, s[40:43], s33 offen offset:2048 sc1
v_mfma_f32_16x16x32_bf16 v[152:155], a[132:135], a[68:71], v[152:155]
ds_read_b128 a[104:107], v5 offset:15360
v_mfma_f32_16x16x32_bf16 v[152:155], a[128:131], a[64:67], v[152:155]
v_mfma_f32_16x16x32_bf16 v[132:135], a[136:139], a[64:67], v[132:135]
ds_read_b128 a[108:111], v5 offset:21504
v_mfma_f32_16x16x32_bf16 v[132:135], a[140:143], a[68:71], v[132:135]
v_mfma_f32_16x16x32_bf16 v[156:159], a[140:143], a[76:79], v[156:159]
buffer_load_dwordx4 v1, s[4:7], s44 offen offset:2048 sc1 lds
s_add_u32 m0, s18, 0x6000
v_mfma_f32_16x16x32_bf16 v[156:159], a[136:139], a[72:75], v[156:159]
s_add_u32 s44, s50, 0x142a000
ds_read_b128 a[112:115], v5 offset:16384
v_mfma_f32_16x16x32_bf16 v[180:183], a[136:139], a[80:83], v[180:183]
v_mfma_f32_16x16x32_bf16 v[180:183], a[140:143], a[84:87], v[180:183]
ds_read_b128 a[116:119], v5 offset:22528
v_mfma_f32_16x16x32_bf16 v[204:207], a[140:143], a[92:95], v[204:207]
v_mfma_f32_16x16x32_bf16 v[204:207], a[136:139], a[88:91], v[204:207]
buffer_load_dwordx4 a[56:59], v2, s[40:43], s35 offen offset:3072 sc1
v_mfma_f32_16x16x32_bf16 v[208:211], a[144:147], a[88:91], v[208:211]
v_mfma_f32_16x16x32_bf16 v[208:211], a[148:151], a[92:95], v[208:211]
v_mfma_f32_16x16x32_bf16 v[184:187], a[148:151], a[84:87], v[184:187]
v_mfma_f32_16x16x32_bf16 v[184:187], a[144:147], a[80:83], v[184:187]
v_mfma_f32_16x16x32_bf16 v[160:163], a[144:147], a[72:75], v[160:163]
buffer_load_dwordx4 a[60:63], v2, s[40:43], s33 offen offset:3072 sc1
s_add_u32 s35, s35, 8192
v_mfma_f32_16x16x32_bf16 v[160:163], a[148:151], a[76:79], v[160:163]
s_add_u32 s33, s33, 8192
v_mfma_f32_16x16x32_bf16 v[136:139], a[148:151], a[68:71], v[136:139]
v_mfma_f32_16x16x32_bf16 v[136:139], a[144:147], a[64:67], v[136:139]
s_waitcnt vmcnt(10) lgkmcnt(0)
v_mfma_f32_16x16x32_bf16 v[140:143], a[96:99], a[0:3], v[140:143]
ds_read_b128 a[128:131], v5 offset:17408
v_add_f32 v92, v92, v96
v_mfma_f32_16x16x32_bf16 v[140:143], a[100:103], a[4:7], v[140:143]
buffer_load_dwordx4 a[64:67], v2, s[40:43], s35 offen offset:0 sc1
v_mfma_f32_16x16x32_bf16 v[164:167], a[100:103], a[12:15], v[164:167]
ds_read_b128 a[132:135], v5 offset:23552
v_add_f32 v100, v100, v104
v_mfma_f32_16x16x32_bf16 v[164:167], a[96:99], a[8:11], v[164:167]
v_add_f32 v108, v108, v112
v_add_f32 v116, v116, v120
v_mfma_f32_16x16x32_bf16 v[188:191], a[96:99], a[16:19], v[188:191]
v_add_f32 v93, v93, v97
v_add_f32 v101, v101, v105
v_mfma_f32_16x16x32_bf16 v[188:191], a[100:103], a[20:23], v[188:191]
buffer_load_dwordx4 a[68:71], v2, s[40:43], s33 offen offset:0 sc1
v_mfma_f32_16x16x32_bf16 v[212:215], a[100:103], a[28:31], v[212:215]
ds_read_b128 a[136:139], v5 offset:12288
v_add_f32 v109, v109, v113
v_mfma_f32_16x16x32_bf16 v[212:215], a[96:99], a[24:27], v[212:215]
v_add_f32 v117, v117, v121
v_add_f32 v94, v94, v98
v_mfma_f32_16x16x32_bf16 v[216:219], a[104:107], a[24:27], v[216:219]
ds_read_b128 a[140:143], v5 offset:18432
v_add_f32 v102, v102, v106
v_mfma_f32_16x16x32_bf16 v[216:219], a[108:111], a[28:31], v[216:219]
v_add_f32 v110, v110, v114
v_mfma_f32_16x16x32_bf16 v[192:195], a[108:111], a[20:23], v[192:195]
buffer_load_dwordx4 v1, s[4:7], s44 offen offset:0 sc1 lds
v_mfma_f32_16x16x32_bf16 v[192:195], a[104:107], a[16:19], v[192:195]
ds_read_b128 a[144:147], v5 offset:13312
v_add_f32 v118, v118, v122
v_mfma_f32_16x16x32_bf16 v[168:171], a[104:107], a[8:11], v[168:171]
v_add_f32 v95, v95, v99
v_add_f32 v103, v103, v107
v_mfma_f32_16x16x32_bf16 v[168:171], a[108:111], a[12:15], v[168:171]
ds_read_b128 a[148:151], v5 offset:19456
v_add_f32 v111, v111, v115
v_mfma_f32_16x16x32_bf16 v[144:147], a[108:111], a[4:7], v[144:147]
v_add_f32 v119, v119, v123
v_mfma_f32_16x16x32_bf16 v[144:147], a[104:107], a[0:3], v[144:147]
buffer_load_dwordx4 a[72:75], v2, s[40:43], s35 offen offset:1024 sc1
v_mfma_f32_16x16x32_bf16 v[148:151], a[112:115], a[0:3], v[148:151]
v_add_f32_dpp v92, v92, v92 row_ror:8 row_mask:0xf bank_mask:0xf
v_add_f32_dpp v100, v100, v100 row_ror:8 row_mask:0xf bank_mask:0xf
v_mfma_f32_16x16x32_bf16 v[148:151], a[116:119], a[4:7], v[148:151]
v_add_f32_dpp v108, v108, v108 row_ror:8 row_mask:0xf bank_mask:0xf
v_mfma_f32_16x16x32_bf16 v[172:175], a[116:119], a[12:15], v[172:175]
v_add_f32_dpp v116, v116, v116 row_ror:8 row_mask:0xf bank_mask:0xf
v_mfma_f32_16x16x32_bf16 v[172:175], a[112:115], a[8:11], v[172:175]
v_add_f32_dpp v93, v93, v93 row_ror:8 row_mask:0xf bank_mask:0xf
v_mfma_f32_16x16x32_bf16 v[196:199], a[112:115], a[16:19], v[196:199]
buffer_load_dwordx4 a[76:79], v2, s[40:43], s33 offen offset:1024 sc1
v_mfma_f32_16x16x32_bf16 v[196:199], a[116:119], a[20:23], v[196:199]
v_add_f32_dpp v101, v101, v101 row_ror:8 row_mask:0xf bank_mask:0xf
v_add_f32_dpp v109, v109, v109 row_ror:8 row_mask:0xf bank_mask:0xf
v_mfma_f32_16x16x32_bf16 v[220:223], a[116:119], a[28:31], v[220:223]
v_add_f32_dpp v117, v117, v117 row_ror:8 row_mask:0xf bank_mask:0xf
v_mfma_f32_16x16x32_bf16 v[220:223], a[112:115], a[24:27], v[220:223]
v_add_f32_dpp v92, v94, v94 row_ror:8 row_mask:0xf bank_mask:0xc
s_waitcnt lgkmcnt(0)
v_mfma_f32_16x16x32_bf16 v[224:227], a[128:131], a[24:27], v[224:227]
ds_read_b128 a[96:99], v5 offset:26624
v_add_f32_dpp v100, v102, v102 row_ror:8 row_mask:0xf bank_mask:0xc
v_mfma_f32_16x16x32_bf16 v[224:227], a[132:135], a[28:31], v[224:227]
buffer_load_dwordx4 a[80:83], v2, s[40:43], s35 offen offset:2048 sc1
v_mfma_f32_16x16x32_bf16 v[200:203], a[132:135], a[20:23], v[200:203]
ds_read_b128 a[100:103], v5 offset:32768
v_add_f32_dpp v108, v110, v110 row_ror:8 row_mask:0xf bank_mask:0xc
v_mfma_f32_16x16x32_bf16 v[200:203], a[128:131], a[16:19], v[200:203]
v_add_f32_dpp v116, v118, v118 row_ror:8 row_mask:0xf bank_mask:0xc
v_add_f32_dpp v93, v95, v95 row_ror:8 row_mask:0xf bank_mask:0xc
v_mfma_f32_16x16x32_bf16 v[176:179], a[128:131], a[8:11], v[176:179]
v_add_f32_dpp v101, v103, v103 row_ror:8 row_mask:0xf bank_mask:0xc
v_add_f32_dpp v109, v111, v111 row_ror:8 row_mask:0xf bank_mask:0xc
v_mfma_f32_16x16x32_bf16 v[176:179], a[132:135], a[12:15], v[176:179]
buffer_load_dwordx4 a[84:87], v2, s[40:43], s33 offen offset:2048 sc1
v_mfma_f32_16x16x32_bf16 v[152:155], a[132:135], a[4:7], v[152:155]
ds_read_b128 a[104:107], v5 offset:27648
v_add_f32_dpp v117, v119, v119 row_ror:8 row_mask:0xf bank_mask:0xc
v_mfma_f32_16x16x32_bf16 v[152:155], a[128:131], a[0:3], v[152:155]
v_permlane32_swap_b32 v92, v93
v_mfma_f32_16x16x32_bf16 v[132:135], a[136:139], a[0:3], v[132:135]
ds_read_b128 a[108:111], v5 offset:33792
v_mfma_f32_16x16x32_bf16 v[132:135], a[140:143], a[4:7], v[132:135]
v_permlane32_swap_b32 v100, v101
v_mfma_f32_16x16x32_bf16 v[156:159], a[140:143], a[12:15], v[156:159]
buffer_load_dwordx4 v1, s[4:7], s44 offen offset:1024 sc1 lds
v_mfma_f32_16x16x32_bf16 v[156:159], a[136:139], a[8:11], v[156:159]
ds_read_b128 a[112:115], v5 offset:28672
v_mfma_f32_16x16x32_bf16 v[180:183], a[136:139], a[16:19], v[180:183]
v_permlane32_swap_b32 v108, v109
v_mfma_f32_16x16x32_bf16 v[180:183], a[140:143], a[20:23], v[180:183]
ds_read_b128 a[116:119], v5 offset:34816
v_mfma_f32_16x16x32_bf16 v[204:207], a[140:143], a[28:31], v[204:207]
v_permlane32_swap_b32 v116, v117
v_mfma_f32_16x16x32_bf16 v[204:207], a[136:139], a[24:27], v[204:207]
buffer_load_dwordx4 a[88:91], v2, s[40:43], s35 offen offset:3072 sc1
v_mfma_f32_16x16x32_bf16 v[208:211], a[144:147], a[24:27], v[208:211]
v_add_f32 v92, v92, v93
v_add_f32 v100, v100, v101
v_mfma_f32_16x16x32_bf16 v[208:211], a[148:151], a[28:31], v[208:211]
v_add_f32 v108, v108, v109
v_add_f32 v116, v116, v117
v_mfma_f32_16x16x32_bf16 v[184:187], a[148:151], a[20:23], v[184:187]
v_mov_b32 v94, v92
v_mfma_f32_16x16x32_bf16 v[184:187], a[144:147], a[16:19], v[184:187]
v_mov_b32 v102, v100
v_mfma_f32_16x16x32_bf16 v[160:163], a[144:147], a[8:11], v[160:163]
buffer_load_dwordx4 a[92:95], v2, s[40:43], s33 offen offset:3072 sc1
s_add_u32 s35, s35, 8192
v_mfma_f32_16x16x32_bf16 v[160:163], a[148:151], a[12:15], v[160:163]
s_add_u32 s33, s33, 8192
v_mov_b32 v110, v108
v_mfma_f32_16x16x32_bf16 v[136:139], a[148:151], a[4:7], v[136:139]
v_mov_b32 v118, v116
v_mfma_f32_16x16x32_bf16 v[136:139], a[144:147], a[0:3], v[136:139]
s_waitcnt vmcnt(10) lgkmcnt(0)
v_mfma_f32_16x16x32_bf16 v[140:143], a[96:99], a[32:35], v[140:143]
ds_read_b128 a[128:131], v5 offset:29696
v_mfma_f32_16x16x32_bf16 v[140:143], a[100:103], a[36:39], v[140:143]
buffer_load_dwordx4 a[0:3], v2, s[40:43], s35 offen offset:0 sc1
v_mfma_f32_16x16x32_bf16 v[164:167], a[100:103], a[44:47], v[164:167]
ds_read_b128 a[132:135], v5 offset:35840
v_mfma_f32_16x16x32_bf16 v[164:167], a[96:99], a[40:43], v[164:167]
v_permlane16_swap_b32 v92, v94
v_mfma_f32_16x16x32_bf16 v[188:191], a[96:99], a[48:51], v[188:191]
v_permlane16_swap_b32 v100, v102
v_mfma_f32_16x16x32_bf16 v[188:191], a[100:103], a[52:55], v[188:191]
buffer_load_dwordx4 a[4:7], v2, s[40:43], s33 offen offset:0 sc1
v_mfma_f32_16x16x32_bf16 v[212:215], a[100:103], a[60:63], v[212:215]
ds_read_b128 a[136:139], v5 offset:24576
v_mfma_f32_16x16x32_bf16 v[212:215], a[96:99], a[56:59], v[212:215]
v_permlane16_swap_b32 v108, v110
v_mfma_f32_16x16x32_bf16 v[216:219], a[104:107], a[56:59], v[216:219]
ds_read_b128 a[140:143], v5 offset:30720
v_mfma_f32_16x16x32_bf16 v[216:219], a[108:111], a[60:63], v[216:219]
v_permlane16_swap_b32 v116, v118
v_mfma_f32_16x16x32_bf16 v[192:195], a[108:111], a[52:55], v[192:195]
buffer_load_dwordx4 v1, s[4:7], s44 offen offset:2048 sc1 lds
s_add_u32 m0, s18, 0x9000
v_mfma_f32_16x16x32_bf16 v[192:195], a[104:107], a[48:51], v[192:195]
s_add_u32 s44, s50, 0x142d000
ds_read_b128 a[144:147], v5 offset:25600
v_mfma_f32_16x16x32_bf16 v[168:171], a[104:107], a[40:43], v[168:171]
v_add_f32 v92, v92, v94
v_add_f32 v100, v100, v102
v_mfma_f32_16x16x32_bf16 v[168:171], a[108:111], a[44:47], v[168:171]
ds_read_b128 a[148:151], v5 offset:31744
v_add_f32 v108, v108, v110
v_mfma_f32_16x16x32_bf16 v[144:147], a[108:111], a[36:39], v[144:147]
v_add_f32 v116, v116, v118
v_mov_b32 v94, v92
v_mfma_f32_16x16x32_bf16 v[144:147], a[104:107], a[32:35], v[144:147]
buffer_load_dwordx4 a[8:11], v2, s[40:43], s35 offen offset:1024 sc1
v_mfma_f32_16x16x32_bf16 v[148:151], a[112:115], a[32:35], v[148:151]
v_mov_b32 v102, v100
v_mov_b32 v110, v108
v_mfma_f32_16x16x32_bf16 v[148:151], a[116:119], a[36:39], v[148:151]
v_mov_b32 v118, v116
v_mfma_f32_16x16x32_bf16 v[172:175], a[116:119], a[44:47], v[172:175]
v_permlane32_swap_b32 v92, v94
v_mfma_f32_16x16x32_bf16 v[172:175], a[112:115], a[40:43], v[172:175]
v_permlane32_swap_b32 v100, v102
v_mfma_f32_16x16x32_bf16 v[196:199], a[112:115], a[48:51], v[196:199]
buffer_load_dwordx4 a[12:15], v2, s[40:43], s33 offen offset:1024 sc1
v_mfma_f32_16x16x32_bf16 v[196:199], a[116:119], a[52:55], v[196:199]
v_permlane32_swap_b32 v108, v110
v_mfma_f32_16x16x32_bf16 v[220:223], a[116:119], a[60:63], v[220:223]
v_permlane32_swap_b32 v116, v118
v_mfma_f32_16x16x32_bf16 v[220:223], a[112:115], a[56:59], v[220:223]
v_mul_f32 v82, 0xba800000, v92
s_waitcnt lgkmcnt(0)
v_mfma_f32_16x16x32_bf16 v[224:227], a[128:131], a[56:59], v[224:227]
ds_read_b128 a[96:99], v5 offset:38912
v_mul_f32 v84, 0xba800000, v100
v_mfma_f32_16x16x32_bf16 v[224:227], a[132:135], a[60:63], v[224:227]
buffer_load_dwordx4 a[16:19], v2, s[40:43], s35 offen offset:2048 sc1
v_mfma_f32_16x16x32_bf16 v[200:203], a[132:135], a[52:55], v[200:203]
ds_read_b128 a[100:103], v5 offset:45056
v_mul_f32 v86, 0xba800000, v108
v_mfma_f32_16x16x32_bf16 v[200:203], a[128:131], a[48:51], v[200:203]
v_mul_f32 v88, 0xba800000, v116
v_mul_f32 v94, 0x3a800000, v94
v_mfma_f32_16x16x32_bf16 v[176:179], a[128:131], a[40:43], v[176:179]
v_mul_f32 v102, 0x3a800000, v102
v_mul_f32 v110, 0x3a800000, v110
v_mfma_f32_16x16x32_bf16 v[176:179], a[132:135], a[44:47], v[176:179]
buffer_load_dwordx4 v1, s[4:7], s44 offen offset:0 sc1 lds
v_mfma_f32_16x16x32_bf16 v[152:155], a[132:135], a[36:39], v[152:155]
ds_read_b128 a[104:107], v5 offset:39936
v_mul_f32 v118, 0x3a800000, v118
v_mfma_f32_16x16x32_bf16 v[152:155], a[128:131], a[32:35], v[152:155]
v_fma_f32 v94, -v82, v82, v94
v_fma_f32 v102, -v84, v84, v102
v_mfma_f32_16x16x32_bf16 v[132:135], a[136:139], a[32:35], v[132:135]
ds_read_b128 a[108:111], v5 offset:46080
v_fma_f32 v110, -v86, v86, v110
v_mfma_f32_16x16x32_bf16 v[132:135], a[140:143], a[36:39], v[132:135]
buffer_load_dwordx4 a[20:23], v2, s[40:43], s33 offen offset:2048 sc1
v_mfma_f32_16x16x32_bf16 v[156:159], a[140:143], a[44:47], v[156:159]
ds_read_b128 a[112:115], v5 offset:40960
v_fma_f32 v118, -v88, v88, v118
v_mfma_f32_16x16x32_bf16 v[156:159], a[136:139], a[40:43], v[156:159]
v_max_f32 v94, 0, v94
v_max_f32 v102, 0, v102
v_mfma_f32_16x16x32_bf16 v[180:183], a[136:139], a[48:51], v[180:183]
v_max_f32 v110, 0, v110
v_max_f32 v118, 0, v118
v_mfma_f32_16x16x32_bf16 v[180:183], a[140:143], a[52:55], v[180:183]
buffer_load_dwordx4 a[24:27], v2, s[40:43], s35 offen offset:3072 sc1
v_mfma_f32_16x16x32_bf16 v[204:207], a[140:143], a[60:63], v[204:207]
ds_read_b128 a[116:119], v5 offset:47104
v_add_f32 v94, 0x3727c5ac, v94
v_mfma_f32_16x16x32_bf16 v[204:207], a[136:139], a[56:59], v[204:207]
v_add_f32 v102, 0x3727c5ac, v102
v_add_f32 v110, 0x3727c5ac, v110
v_mfma_f32_16x16x32_bf16 v[208:211], a[144:147], a[56:59], v[208:211]
v_add_f32 v118, 0x3727c5ac, v118
v_mfma_f32_16x16x32_bf16 v[208:211], a[148:151], a[60:63], v[208:211]
buffer_load_dwordx4 v1, s[4:7], s44 offen offset:1024 sc1 lds
v_mfma_f32_16x16x32_bf16 v[184:187], a[148:151], a[52:55], v[184:187]
v_rsq_f32 v83, v94
v_mfma_f32_16x16x32_bf16 v[184:187], a[144:147], a[48:51], v[184:187]
v_rsq_f32 v85, v102
v_mfma_f32_16x16x32_bf16 v[160:163], a[144:147], a[40:43], v[160:163]
v_rsq_f32 v87, v110
v_mfma_f32_16x16x32_bf16 v[160:163], a[148:151], a[44:47], v[160:163]
buffer_load_dwordx4 a[28:31], v2, s[40:43], s33 offen offset:3072 sc1
s_add_u32 s35, s35, 8192
v_mfma_f32_16x16x32_bf16 v[136:139], a[148:151], a[36:39], v[136:139]
s_add_u32 s33, s33, 8192
v_mfma_f32_16x16x32_bf16 v[136:139], a[144:147], a[32:35], v[136:139]
s_waitcnt vmcnt(11) lgkmcnt(0)
v_mfma_f32_16x16x32_bf16 v[140:143], a[96:99], a[64:67], v[140:143]
ds_read_b128 a[128:131], v5 offset:41984
v_mfma_f32_16x16x32_bf16 v[140:143], a[100:103], a[68:71], v[140:143]
buffer_load_dwordx4 a[32:35], v2, s[40:43], s35 offen offset:0 sc1
v_mfma_f32_16x16x32_bf16 v[164:167], a[100:103], a[76:79], v[164:167]
ds_read_b128 a[132:135], v5 offset:48128
v_mfma_f32_16x16x32_bf16 v[164:167], a[96:99], a[72:75], v[164:167]
v_rsq_f32 v89, v118
v_mfma_f32_16x16x32_bf16 v[188:191], a[96:99], a[80:83], v[188:191]
v_mfma_f32_16x16x32_bf16 v[188:191], a[100:103], a[84:87], v[188:191]
buffer_load_dwordx4 a[36:39], v2, s[40:43], s33 offen offset:0 sc1
v_mfma_f32_16x16x32_bf16 v[212:215], a[100:103], a[92:95], v[212:215]
ds_read_b128 a[136:139], v5 offset:36864
v_mfma_f32_16x16x32_bf16 v[212:215], a[96:99], a[88:91], v[212:215]
v_mfma_f32_16x16x32_bf16 v[216:219], a[104:107], a[88:91], v[216:219]
ds_read_b128 a[140:143], v5 offset:43008
v_mfma_f32_16x16x32_bf16 v[216:219], a[108:111], a[92:95], v[216:219]
v_mfma_f32_16x16x32_bf16 v[192:195], a[108:111], a[84:87], v[192:195]
buffer_load_dwordx4 v1, s[4:7], s44 offen offset:2048 sc1 lds
s_add_u32 m0, s19, 49152
v_mfma_f32_16x16x32_bf16 v[192:195], a[104:107], a[80:83], v[192:195]
s_add_u32 s44, s85, 0xc04000
ds_read_b128 a[144:147], v5 offset:37888
v_mfma_f32_16x16x32_bf16 v[168:171], a[104:107], a[72:75], v[168:171]
v_fmac_f32 v140, v56, v82
v_fmac_f32 v164, v56, v84
v_mfma_f32_16x16x32_bf16 v[168:171], a[108:111], a[76:79], v[168:171]
ds_read_b128 a[148:151], v5 offset:44032
v_mfma_f32_16x16x32_bf16 v[144:147], a[108:111], a[68:71], v[144:147]
v_fmac_f32 v188, v56, v86
v_mfma_f32_16x16x32_bf16 v[144:147], a[104:107], a[64:67], v[144:147]
buffer_load_dwordx4 a[40:43], v2, s[40:43], s35 offen offset:1024 sc1
v_mfma_f32_16x16x32_bf16 v[148:151], a[112:115], a[64:67], v[148:151]
v_fmac_f32 v212, v56, v88
v_mfma_f32_16x16x32_bf16 v[148:151], a[116:119], a[68:71], v[148:151]
v_mfma_f32_16x16x32_bf16 v[172:175], a[116:119], a[76:79], v[172:175]
v_fmac_f32 v216, v60, v88
v_mfma_f32_16x16x32_bf16 v[172:175], a[112:115], a[72:75], v[172:175]
v_mfma_f32_16x16x32_bf16 v[196:199], a[112:115], a[80:83], v[196:199]
buffer_load_dwordx4 a[44:47], v2, s[40:43], s33 offen offset:1024 sc1
v_mfma_f32_16x16x32_bf16 v[196:199], a[116:119], a[84:87], v[196:199]
v_fmac_f32 v192, v60, v86
v_mfma_f32_16x16x32_bf16 v[220:223], a[116:119], a[92:95], v[220:223]
v_fmac_f32 v168, v60, v84
v_fmac_f32 v141, v57, v82
v_mfma_f32_16x16x32_bf16 v[220:223], a[112:115], a[88:91], v[220:223]
s_waitcnt lgkmcnt(0)
s_barrier
v_mfma_f32_16x16x32_bf16 v[224:227], a[128:131], a[88:91], v[224:227]
v_add_u32 v5, 0, v1
v_fmac_f32 v144, v60, v82
v_mfma_f32_16x16x32_bf16 v[224:227], a[132:135], a[92:95], v[224:227]
buffer_load_dwordx4 a[48:51], v2, s[40:43], s35 offen offset:2048 sc1
v_mfma_f32_16x16x32_bf16 v[200:203], a[132:135], a[84:87], v[200:203]
ds_read_b128 a[96:99], v5 offset:2048
v_fmac_f32 v148, v64, v82
v_mfma_f32_16x16x32_bf16 v[200:203], a[128:131], a[80:83], v[200:203]
ds_read_b128 a[100:103], v5 offset:8192
v_fmac_f32 v165, v57, v84
v_mfma_f32_16x16x32_bf16 v[176:179], a[128:131], a[72:75], v[176:179]
v_fmac_f32 v172, v64, v84
v_fmac_f32 v189, v57, v86
v_mfma_f32_16x16x32_bf16 v[176:179], a[132:135], a[76:79], v[176:179]
buffer_load_dwordx4 a[52:55], v2, s[40:43], s33 offen offset:2048 sc1
v_mfma_f32_16x16x32_bf16 v[152:155], a[132:135], a[68:71], v[152:155]
ds_read_b128 a[104:107], v5 offset:3072
v_fmac_f32 v196, v64, v86
v_mfma_f32_16x16x32_bf16 v[152:155], a[128:131], a[64:67], v[152:155]
v_fmac_f32 v213, v57, v88
v_fmac_f32 v217, v61, v88
v_mfma_f32_16x16x32_bf16 v[132:135], a[136:139], a[64:67], v[132:135]
ds_read_b128 a[108:111], v5 offset:9216
v_fmac_f32 v220, v64, v88
v_mfma_f32_16x16x32_bf16 v[132:135], a[140:143], a[68:71], v[132:135]
v_fmac_f32 v193, v61, v86
v_mfma_f32_16x16x32_bf16 v[156:159], a[140:143], a[76:79], v[156:159]
buffer_load_dwordx4 v1, s[4:7], s44 offen offset:0 sc1 lds
v_mfma_f32_16x16x32_bf16 v[156:159], a[136:139], a[72:75], v[156:159]
ds_read_b128 a[112:115], v5 offset:4096
v_fmac_f32 v224, v68, v88
v_mfma_f32_16x16x32_bf16 v[180:183], a[136:139], a[80:83], v[180:183]
v_fmac_f32 v200, v68, v86
v_fmac_f32 v169, v61, v84
v_mfma_f32_16x16x32_bf16 v[180:183], a[140:143], a[84:87], v[180:183]
ds_read_b128 a[116:119], v5 offset:10240
v_fmac_f32 v145, v61, v82
v_mfma_f32_16x16x32_bf16 v[204:207], a[140:143], a[92:95], v[204:207]
v_fmac_f32 v176, v68, v84
v_fmac_f32 v149, v65, v82
v_mfma_f32_16x16x32_bf16 v[204:207], a[136:139], a[88:91], v[204:207]
buffer_load_dwordx4 a[56:59], v2, s[40:43], s35 offen offset:3072 sc1
v_mfma_f32_16x16x32_bf16 v[208:211], a[144:147], a[88:91], v[208:211]
v_fmac_f32 v152, v68, v82
v_fmac_f32 v173, v65, v84
v_mfma_f32_16x16x32_bf16 v[208:211], a[148:151], a[92:95], v[208:211]
v_mfma_f32_16x16x32_bf16 v[184:187], a[148:151], a[84:87], v[184:187]
v_fmac_f32 v132, v48, v82
v_fmac_f32 v197, v65, v86
v_mfma_f32_16x16x32_bf16 v[184:187], a[144:147], a[80:83], v[184:187]
v_mfma_f32_16x16x32_bf16 v[160:163], a[144:147], a[72:75], v[160:163]
buffer_load_dwordx4 a[60:63], v2, s[40:43], s33 offen offset:3072 sc1
s_add_u32 s35, s35, 8192
v_mfma_f32_16x16x32_bf16 v[160:163], a[148:151], a[76:79], v[160:163]
s_add_u32 s33, s33, 8192
v_fmac_f32 v156, v48, v84
v_mfma_f32_16x16x32_bf16 v[136:139], a[148:151], a[68:71], v[136:139]
v_fmac_f32 v180, v48, v86
v_fmac_f32 v221, v65, v88
v_mfma_f32_16x16x32_bf16 v[136:139], a[144:147], a[64:67], v[136:139]
v_fmac_f32 v225, v69, v88
s_waitcnt vmcnt(10) lgkmcnt(0)
v_mfma_f32_16x16x32_bf16 v[140:143], a[96:99], a[0:3], v[140:143]
ds_read_b128 a[128:131], v5 offset:5120
v_fmac_f32 v204, v48, v88
v_mfma_f32_16x16x32_bf16 v[140:143], a[100:103], a[4:7], v[140:143]
buffer_load_dwordx4 a[64:67], v2, s[40:43], s35 offen offset:0 sc1
s_lshl_b32 s36, s28, 9
v_mfma_f32_16x16x32_bf16 v[164:167], a[100:103], a[12:15], v[164:167]
ds_read_b128 a[132:135], v5 offset:11264
v_fmac_f32 v208, v52, v88
v_mfma_f32_16x16x32_bf16 v[164:167], a[96:99], a[8:11], v[164:167]
v_fmac_f32 v201, v69, v86
v_fmac_f32 v177, v69, v84
v_mfma_f32_16x16x32_bf16 v[188:191], a[96:99], a[16:19], v[188:191]
v_fmac_f32 v184, v52, v86
v_fmac_f32 v153, v69, v82
v_mfma_f32_16x16x32_bf16 v[188:191], a[100:103], a[20:23], v[188:191]
buffer_load_dwordx4 a[68:71], v2, s[40:43], s33 offen offset:0 sc1
s_lshl_b32 s37, s30, 2
v_mfma_f32_16x16x32_bf16 v[212:215], a[100:103], a[28:31], v[212:215]
ds_read_b128 a[136:139], v5 offset:0
v_fmac_f32 v160, v52, v84
v_mfma_f32_16x16x32_bf16 v[212:215], a[96:99], a[24:27], v[212:215]
v_fmac_f32 v133, v49, v82
v_add_u32 v232, s19, v7
v_mfma_f32_16x16x32_bf16 v[216:219], a[104:107], a[24:27], v[216:219]
ds_read_b128 a[140:143], v5 offset:6144
v_fmac_f32 v136, v52, v82
v_mfma_f32_16x16x32_bf16 v[216:219], a[108:111], a[28:31], v[216:219]
buffer_load_dwordx4 a[72:75], v2, s[40:43], s35 offen offset:1024 sc1
s_add_u32 s37, s37, s28
v_mfma_f32_16x16x32_bf16 v[192:195], a[108:111], a[20:23], v[192:195]
ds_read_b128 a[144:147], v5 offset:1024
v_fmac_f32 v157, v49, v84
v_mfma_f32_16x16x32_bf16 v[192:195], a[104:107], a[16:19], v[192:195]
v_fmac_f32 v181, v49, v86
v_fmac_f32 v142, v58, v82
v_mfma_f32_16x16x32_bf16 v[168:171], a[104:107], a[8:11], v[168:171]
v_fmac_f32 v205, v49, v88
v_fmac_f32 v166, v58, v84
v_mfma_f32_16x16x32_bf16 v[168:171], a[108:111], a[12:15], v[168:171]
buffer_load_dwordx4 a[76:79], v2, s[40:43], s33 offen offset:1024 sc1
s_lshl_b32 s98, s37, 13
v_mfma_f32_16x16x32_bf16 v[144:147], a[108:111], a[4:7], v[144:147]
ds_read_b128 a[148:151], v5 offset:7168
v_fmac_f32 v209, v53, v88
v_mfma_f32_16x16x32_bf16 v[144:147], a[104:107], a[0:3], v[144:147]
v_fmac_f32 v190, v58, v86
s_add_u32 s98, s98, 0x400000
v_mfma_f32_16x16x32_bf16 v[148:151], a[112:115], a[0:3], v[148:151]
v_fmac_f32 v185, v53, v86
v_fmac_f32 v214, v58, v88
v_mfma_f32_16x16x32_bf16 v[148:151], a[116:119], a[4:7], v[148:151]
buffer_load_dwordx4 a[80:83], v2, s[40:43], s35 offen offset:2048 sc1
s_add_u32 s99, s98, 4096
v_mfma_f32_16x16x32_bf16 v[172:175], a[116:119], a[12:15], v[172:175]
v_fmac_f32 v161, v53, v84
v_fmac_f32 v218, v62, v88
v_mfma_f32_16x16x32_bf16 v[172:175], a[112:115], a[8:11], v[172:175]
s_lshl_b32 s100, s37, 10
s_add_u32 s100, s100, 0x820000
s_lshl_b32 s96, s29, 10
v_mfma_f32_16x16x32_bf16 v[196:199], a[112:115], a[16:19], v[196:199]
v_fmac_f32 v137, v53, v82
v_fmac_f32 v194, v62, v86
v_mfma_f32_16x16x32_bf16 v[196:199], a[116:119], a[20:23], v[196:199]
buffer_load_dwordx4 a[84:87], v2, s[40:43], s33 offen offset:2048 sc1
s_add_u32 s96, s96, s98
v_mfma_f32_16x16x32_bf16 v[220:223], a[116:119], a[28:31], v[220:223]
v_fmac_f32 v170, v62, v84
v_fmac_f32 v143, v59, v82
v_mfma_f32_16x16x32_bf16 v[220:223], a[112:115], a[24:27], v[220:223]
s_lshl_b32 s97, s29, 7
s_waitcnt lgkmcnt(0)
v_mfma_f32_16x16x32_bf16 v[224:227], a[128:131], a[24:27], v[224:227]
ds_read_b128 a[96:99], v5 offset:14336
v_fmac_f32 v146, v62, v82
v_mfma_f32_16x16x32_bf16 v[224:227], a[132:135], a[28:31], v[224:227]
buffer_load_dwordx4 a[88:91], v2, s[40:43], s35 offen offset:3072 sc1
s_add_u32 s97, s97, s100
v_mfma_f32_16x16x32_bf16 v[200:203], a[132:135], a[20:23], v[200:203]
ds_read_b128 a[100:103], v5 offset:20480
v_fmac_f32 v150, v66, v82
v_mfma_f32_16x16x32_bf16 v[200:203], a[128:131], a[16:19], v[200:203]
v_fmac_f32 v167, v59, v84
v_fmac_f32 v191, v59, v86
v_mfma_f32_16x16x32_bf16 v[176:179], a[128:131], a[8:11], v[176:179]
v_fmac_f32 v174, v66, v84
v_fmac_f32 v215, v59, v88
v_mfma_f32_16x16x32_bf16 v[176:179], a[132:135], a[12:15], v[176:179]
ds_read_b128 a[104:107], v5 offset:15360
s_lshl_b32 s88, s28, 6
v_mfma_f32_16x16x32_bf16 v[152:155], a[132:135], a[4:7], v[152:155]
v_fmac_f32 v198, v66, v86
v_fmac_f32 v219, v63, v88
v_mfma_f32_16x16x32_bf16 v[152:155], a[128:131], a[0:3], v[152:155]
buffer_load_dwordx4 v1, s[4:7], s44 offen offset:1024 sc1 lds
s_add_u32 s94, s80, s88
v_mfma_f32_16x16x32_bf16 v[132:135], a[136:139], a[0:3], v[132:135]
ds_read_b128 a[108:111], v5 offset:21504
v_fmac_f32 v222, v66, v88
v_mfma_f32_16x16x32_bf16 v[132:135], a[140:143], a[4:7], v[132:135]
v_fmac_f32 v195, v63, v86
s_add_u32 s94, s94, 0x90000
v_mfma_f32_16x16x32_bf16 v[156:159], a[140:143], a[12:15], v[156:159]
ds_read_b128 a[112:115], v5 offset:16384
v_fmac_f32 v226, v70, v88
v_mfma_f32_16x16x32_bf16 v[156:159], a[136:139], a[8:11], v[156:159]
v_fmac_f32 v171, v63, v84
s_add_u32 s88, s88, s70
v_mfma_f32_16x16x32_bf16 v[180:183], a[136:139], a[16:19], v[180:183]
v_fmac_f32 v202, v70, v86
v_fmac_f32 v147, v63, v82
v_mfma_f32_16x16x32_bf16 v[180:183], a[140:143], a[20:23], v[180:183]
buffer_load_dwordx4 a[92:95], v2, s[40:43], s33 offen offset:3072 sc1
s_add_u32 s35, s35, 8192
v_mfma_f32_16x16x32_bf16 v[204:207], a[140:143], a[28:31], v[204:207]
s_add_u32 s33, s33, 8192
ds_read_b128 a[116:119], v5 offset:22528
v_mfma_f32_16x16x32_bf16 v[204:207], a[136:139], a[24:27], v[204:207]
v_fmac_f32 v178, v70, v84
v_fmac_f32 v151, v67, v82
v_mfma_f32_16x16x32_bf16 v[208:211], a[144:147], a[24:27], v[208:211]
v_fmac_f32 v154, v70, v82
v_fmac_f32 v175, v67, v84
v_mfma_f32_16x16x32_bf16 v[208:211], a[148:151], a[28:31], v[208:211]
s_add_u32 s89, s88, 0x90000
s_add_u32 s74, s71, 0x30080
s_lshl_b32 s73, s30, 12
v_mfma_f32_16x16x32_bf16 v[184:187], a[148:151], a[20:23], v[184:187]
v_fmac_f32 v134, v50, v82
v_fmac_f32 v199, v67, v86
v_mfma_f32_16x16x32_bf16 v[184:187], a[144:147], a[16:19], v[184:187]
buffer_load_dwordx4 v1, s[4:7], s44 offen offset:2048 sc1 lds
s_add_u32 s72, s73, 0x2600000
v_mfma_f32_16x16x32_bf16 v[160:163], a[144:147], a[8:11], v[160:163]
v_fmac_f32 v158, v50, v84
v_fmac_f32 v223, v67, v88
v_mfma_f32_16x16x32_bf16 v[160:163], a[148:151], a[12:15], v[160:163]
v_add_u32 v233, s19, v232
s_add_u32 s73, s73, 0x1e00000
v_mfma_f32_16x16x32_bf16 v[136:139], a[148:151], a[4:7], v[136:139]
v_fmac_f32 v182, v50, v86
v_fmac_f32 v227, v71, v88
v_mfma_f32_16x16x32_bf16 v[136:139], a[144:147], a[0:3], v[136:139]
s_waitcnt vmcnt(10) lgkmcnt(0)
s_barrier
v_mfma_f32_16x16x32_bf16 v[140:143], a[96:99], a[32:35], v[140:143]
ds_read_b128 a[128:131], v5 offset:17408
v_fmac_f32 v206, v50, v88
v_mfma_f32_16x16x32_bf16 v[140:143], a[100:103], a[36:39], v[140:143]
buffer_load_dwordx4 a[0:3], v2, s[40:43], s35 offen offset:0 sc1
s_lshr_b32 s38, s28, 1
v_mfma_f32_16x16x32_bf16 v[164:167], a[100:103], a[44:47], v[164:167]
L_stub17:
s_cbranch_execz L_stub18
ds_read_b128 a[132:135], v5 offset:23552
v_fmac_f32 v210, v54, v88
v_mfma_f32_16x16x32_bf16 v[164:167], a[96:99], a[40:43], v[164:167]
v_fmac_f32 v203, v71, v86
v_fmac_f32 v179, v71, v84
v_mfma_f32_16x16x32_bf16 v[188:191], a[96:99], a[48:51], v[188:191]
buffer_load_dwordx4 a[4:7], v2, s[40:43], s33 offen offset:0 sc1
s_and_b32 s39, s28, 1
v_mfma_f32_16x16x32_bf16 v[188:191], a[100:103], a[52:55], v[188:191]
ds_read_b128 a[136:139], v5 offset:26624
v_fmac_f32 v186, v54, v86
v_mfma_f32_16x16x32_bf16 v[212:215], a[100:103], a[60:63], v[212:215]
v_fmac_f32 v162, v54, v84
v_fmac_f32 v155, v71, v82
v_mfma_f32_16x16x32_bf16 v[212:215], a[96:99], a[56:59], v[212:215]
buffer_load_dwordx4 a[8:11], v2, s[40:43], s35 offen offset:1024 sc1
s_mul_i32 s38, s38, 3072
v_mfma_f32_16x16x32_bf16 v[216:219], a[104:107], a[56:59], v[216:219]
ds_read_b128 a[140:143], v5 offset:32768
v_fmac_f32 v138, v54, v82
v_mfma_f32_16x16x32_bf16 v[216:219], a[108:111], a[60:63], v[216:219]
v_fmac_f32 v135, v51, v82
v_fmac_f32 v159, v51, v84
v_mfma_f32_16x16x32_bf16 v[192:195], a[108:111], a[52:55], v[192:195]
buffer_load_dwordx4 a[12:15], v2, s[40:43], s33 offen offset:1024 sc1
s_lshl_b32 s39, s39, 3
v_mfma_f32_16x16x32_bf16 v[192:195], a[104:107], a[48:51], v[192:195]
ds_read_b128 a[144:147], v5 offset:27648
v_fmac_f32 v183, v51, v86
v_mfma_f32_16x16x32_bf16 v[168:171], a[104:107], a[40:43], v[168:171]
v_fmac_f32 v207, v51, v88
s_add_u32 s38, s38, s39
v_mfma_f32_16x16x32_bf16 v[168:171], a[108:111], a[44:47], v[168:171]
buffer_load_dwordx4 a[16:19], v2, s[40:43], s35 offen offset:2048 sc1
v_mfma_f32_16x16x32_bf16 v[144:147], a[108:111], a[36:39], v[144:147]
ds_read_b128 a[148:151], v5 offset:33792
v_fmac_f32 v211, v55, v88
v_mfma_f32_16x16x32_bf16 v[144:147], a[104:107], a[32:35], v[144:147]
v_mul_f32 v88, 0x3fb8aa3b, v89
v_and_b32 v248, 7, v0
v_mfma_f32_16x16x32_bf16 v[148:151], a[112:115], a[32:35], v[148:151]
buffer_load_dwordx4 a[20:23], v2, s[40:43], s33 offen offset:2048 sc1
v_mfma_f32_16x16x32_bf16 v[148:151], a[116:119], a[36:39], v[148:151]
v_fmac_f32 v187, v55, v86
v_lshlrev_b32 v248, 7, v248
v_mfma_f32_16x16x32_bf16 v[172:175], a[116:119], a[44:47], v[172:175]
v_fmac_f32 v163, v55, v84
v_mul_f32 v86, 0x3fb8aa3b, v87
v_mfma_f32_16x16x32_bf16 v[172:175], a[112:115], a[40:43], v[172:175]
buffer_load_dwordx4 a[24:27], v2, s[40:43], s35 offen offset:3072 sc1
v_mfma_f32_16x16x32_bf16 v[196:199], a[112:115], a[48:51], v[196:199]
v_fmac_f32 v139, v55, v82
v_mul_f32 v84, 0x3fb8aa3b, v85
v_mfma_f32_16x16x32_bf16 v[196:199], a[116:119], a[52:55], v[196:199]
v_mul_f32 v82, 0x3fb8aa3b, v83
v_lshrrev_b32 v249, 4, v0
v_mfma_f32_16x16x32_bf16 v[220:223], a[116:119], a[60:63], v[220:223]
buffer_load_dwordx4 a[28:31], v2, s[40:43], s33 offen offset:3072 sc1
s_add_u32 s35, s35, 8192
v_mfma_f32_16x16x32_bf16 v[220:223], a[112:115], a[56:59], v[220:223]
s_add_u32 s33, s33, 8192
s_waitcnt lgkmcnt(0)
v_mfma_f32_16x16x32_bf16 v[224:227], a[128:131], a[56:59], v[224:227]
ds_read_b128 a[96:99], v5 offset:28672
v_lshlrev_b32 v235, 8, v0
v_mfma_f32_16x16x32_bf16 v[224:227], a[132:135], a[60:63], v[224:227]
buffer_load_dwordx4 v1, s[4:7], s44 offen offset:3072 sc1 lds
s_add_u32 m0, s19, 65536
v_mfma_f32_16x16x32_bf16 v[200:203], a[132:135], a[52:55], v[200:203]
s_add_u32 s44, s84, 0xc08000
ds_read_b128 a[100:103], v5 offset:34816
v_mfma_f32_16x16x32_bf16 v[200:203], a[128:131], a[48:51], v[200:203]
v_lshl_add_u32 v248, v249, 4, v248
v_add_u32 v234, s36, v8
v_mfma_f32_16x16x32_bf16 v[176:179], a[128:131], a[40:43], v[176:179]
v_cndmask_b32 v235, 2.0, v235, s[64:65]
v_mov_b32 v249, 0x3f80
v_mfma_f32_16x16x32_bf16 v[176:179], a[132:135], a[44:47], v[176:179]
ds_read_b128 a[104:107], v5 offset:29696
v_mov_b32 v250, 1.0
v_mfma_f32_16x16x32_bf16 v[152:155], a[132:135], a[36:39], v[152:155]
v_add_u32 v252, s38, v1
v_mfma_f32_16x16x32_bf16 v[152:155], a[128:131], a[32:35], v[152:155]
s_waitcnt vmcnt(18)
v_mfma_f32_16x16x32_bf16 v[140:143], a[136:139], a[64:67], v[140:143]
ds_read_b128 a[108:111], v5 offset:35840
s_waitcnt vmcnt(17)
v_mfma_f32_16x16x32_bf16 v[140:143], a[140:143], a[68:71], v[140:143]
s_waitcnt vmcnt(15)
v_mfma_f32_16x16x32_bf16 v[164:167], a[140:143], a[76:79], v[164:167]
ds_read_b128 a[112:115], v5 offset:38912
v_mfma_f32_16x16x32_bf16 v[164:167], a[136:139], a[72:75], v[164:167]
s_waitcnt vmcnt(14)
v_mfma_f32_16x16x32_bf16 v[188:191], a[136:139], a[80:83], v[188:191]
s_waitcnt vmcnt(13)
v_mfma_f32_16x16x32_bf16 v[188:191], a[140:143], a[84:87], v[188:191]
buffer_load_dwordx4 v1, s[4:7], s44 offen offset:0 sc1 lds
s_waitcnt vmcnt(11)
v_mfma_f32_16x16x32_bf16 v[212:215], a[140:143], a[92:95], v[212:215]
ds_read_b128 a[116:119], v5 offset:45056
v_mfma_f32_16x16x32_bf16 v[212:215], a[136:139], a[88:91], v[212:215]
v_mfma_f32_16x16x32_bf16 v[216:219], a[144:147], a[88:91], v[216:219]
v_mfma_f32_16x16x32_bf16 v[216:219], a[148:151], a[92:95], v[216:219]
v_mfma_f32_16x16x32_bf16 v[192:195], a[148:151], a[84:87], v[192:195]
v_mfma_f32_16x16x32_bf16 v[192:195], a[144:147], a[80:83], v[192:195]
v_mfma_f32_16x16x32_bf16 v[168:171], a[144:147], a[72:75], v[168:171]
v_mfma_f32_16x16x32_bf16 v[168:171], a[148:151], a[76:79], v[168:171]
v_mfma_f32_16x16x32_bf16 v[144:147], a[148:151], a[68:71], v[144:147]
v_mfma_f32_16x16x32_bf16 v[144:147], a[144:147], a[64:67], v[144:147]
s_waitcnt lgkmcnt(0)
v_mfma_f32_16x16x32_bf16 v[148:151], a[96:99], a[64:67], v[148:151]
ds_read_b128 a[128:131], v5 offset:39936
v_mfma_f32_16x16x32_bf16 v[148:151], a[100:103], a[68:71], v[148:151]
buffer_load_dwordx4 v1, s[4:7], s44 offen offset:1024 sc1 lds
v_mfma_f32_16x16x32_bf16 v[172:175], a[100:103], a[76:79], v[172:175]
ds_read_b128 a[132:135], v5 offset:46080
v_mfma_f32_16x16x32_bf16 v[172:175], a[96:99], a[72:75], v[172:175]
v_mfma_f32_16x16x32_bf16 v[196:199], a[96:99], a[80:83], v[196:199]
v_mfma_f32_16x16x32_bf16 v[196:199], a[100:103], a[84:87], v[196:199]
buffer_load_dwordx4 v1, s[4:7], s44 offen offset:2048 sc1 lds
v_mfma_f32_16x16x32_bf16 v[220:223], a[100:103], a[92:95], v[220:223]
ds_read_b128 a[136:139], v5 offset:40960
v_mfma_f32_16x16x32_bf16 v[220:223], a[96:99], a[88:91], v[220:223]
v_mfma_f32_16x16x32_bf16 v[224:227], a[104:107], a[88:91], v[224:227]
ds_read_b128 a[140:143], v5 offset:47104
v_mfma_f32_16x16x32_bf16 v[224:227], a[108:111], a[92:95], v[224:227]
v_mfma_f32_16x16x32_bf16 v[200:203], a[108:111], a[84:87], v[200:203]
buffer_load_dwordx4 v1, s[4:7], s44 offen offset:3072 sc1 lds
s_add_u32 m0, s19, 81920
v_mfma_f32_16x16x32_bf16 v[200:203], a[104:107], a[80:83], v[200:203]
s_add_u32 s44, s85, 0xc0c000
ds_read_b128 a[144:147], v5 offset:41984
v_mfma_f32_16x16x32_bf16 v[176:179], a[104:107], a[72:75], v[176:179]
v_mfma_f32_16x16x32_bf16 v[176:179], a[108:111], a[76:79], v[176:179]
ds_read_b128 a[148:151], v5 offset:48128
v_mfma_f32_16x16x32_bf16 v[152:155], a[108:111], a[68:71], v[152:155]
v_mfma_f32_16x16x32_bf16 v[152:155], a[104:107], a[64:67], v[152:155]
buffer_load_dwordx4 v1, s[4:7], s44 offen offset:0 sc1 lds
s_waitcnt vmcnt(13)
v_mfma_f32_16x16x32_bf16 v[140:143], a[112:115], a[0:3], v[140:143]
s_waitcnt vmcnt(12)
v_mfma_f32_16x16x32_bf16 v[140:143], a[116:119], a[4:7], v[140:143]
s_waitcnt vmcnt(10)
v_mfma_f32_16x16x32_bf16 v[164:167], a[116:119], a[12:15], v[164:167]
v_mfma_f32_16x16x32_bf16 v[164:167], a[112:115], a[8:11], v[164:167]
s_waitcnt vmcnt(9)
v_mfma_f32_16x16x32_bf16 v[188:191], a[112:115], a[16:19], v[188:191]
buffer_load_dwordx4 v1, s[4:7], s44 offen offset:1024 sc1 lds
s_waitcnt vmcnt(9)
v_mfma_f32_16x16x32_bf16 v[188:191], a[116:119], a[20:23], v[188:191]
s_waitcnt vmcnt(7)
v_mfma_f32_16x16x32_bf16 v[212:215], a[116:119], a[28:31], v[212:215]
v_mfma_f32_16x16x32_bf16 v[212:215], a[112:115], a[24:27], v[212:215]
s_waitcnt lgkmcnt(0)
v_mfma_f32_16x16x32_bf16 v[216:219], a[128:131], a[24:27], v[216:219]
ds_read_b128 a[96:99], v5 offset:12288
v_cvt_pk_bf16_f32 v140, v140, v141
v_mfma_f32_16x16x32_bf16 v[216:219], a[132:135], a[28:31], v[216:219]
buffer_load_dwordx4 v1, s[4:7], s44 offen offset:2048 sc1 lds
v_mfma_f32_16x16x32_bf16 v[192:195], a[132:135], a[20:23], v[192:195]
ds_read_b128 a[100:103], v5 offset:18432
v_cvt_pk_bf16_f32 v141, v142, v143
v_mfma_f32_16x16x32_bf16 v[192:195], a[128:131], a[16:19], v[192:195]
v_cvt_pk_bf16_f32 v164, v164, v165
v_cvt_pk_bf16_f32 v165, v166, v167
v_mfma_f32_16x16x32_bf16 v[168:171], a[128:131], a[8:11], v[168:171]
v_cvt_pk_bf16_f32 v188, v188, v189
v_cvt_pk_bf16_f32 v189, v190, v191
v_mfma_f32_16x16x32_bf16 v[168:171], a[132:135], a[12:15], v[168:171]
buffer_load_dwordx4 v1, s[4:7], s44 offen offset:3072 sc1 lds
s_add_u32 m0, s19, 147456
v_mfma_f32_16x16x32_bf16 v[144:147], a[132:135], a[4:7], v[144:147]
s_add_u32 s44, s87, 0xc1c000
ds_read_b128 a[104:107], v5 offset:24576
v_mfma_f32_16x16x32_bf16 v[144:147], a[128:131], a[0:3], v[144:147]
v_cvt_pk_bf16_f32 v212, v212, v213
v_cvt_pk_bf16_f32 v213, v214, v215
v_mfma_f32_16x16x32_bf16 v[148:151], a[136:139], a[0:3], v[148:151]
ds_read_b128 a[108:111], v5 offset:30720
v_cvt_pk_bf16_f32 v214, v216, v217
v_mfma_f32_16x16x32_bf16 v[148:151], a[140:143], a[4:7], v[148:151]
v_cvt_pk_bf16_f32 v215, v218, v219
v_mfma_f32_16x16x32_bf16 v[172:175], a[140:143], a[12:15], v[172:175]
buffer_load_dwordx4 v1, s[4:7], s44 offen offset:0 sc1 lds
v_mfma_f32_16x16x32_bf16 v[172:175], a[136:139], a[8:11], v[172:175]
ds_read_b128 a[112:115], v5 offset:36864
v_cvt_pk_bf16_f32 v190, v192, v193
v_mfma_f32_16x16x32_bf16 v[196:199], a[136:139], a[16:19], v[196:199]
v_cvt_pk_bf16_f32 v166, v168, v169
v_cvt_pk_bf16_f32 v167, v170, v171
v_mfma_f32_16x16x32_bf16 v[196:199], a[140:143], a[20:23], v[196:199]
ds_read_b128 a[116:119], v5 offset:43008
v_cvt_pk_bf16_f32 v191, v194, v195
v_mfma_f32_16x16x32_bf16 v[220:223], a[140:143], a[28:31], v[220:223]
v_cvt_pk_bf16_f32 v142, v144, v145
v_cvt_pk_bf16_f32 v143, v146, v147
v_mfma_f32_16x16x32_bf16 v[220:223], a[136:139], a[24:27], v[220:223]
buffer_load_dwordx4 v1, s[4:7], s44 offen offset:1024 sc1 lds
v_mfma_f32_16x16x32_bf16 v[224:227], a[144:147], a[24:27], v[224:227]
v_mfma_f32_16x16x32_bf16 v[92:95], a[240:243], v[140:143], 0
v_mfma_f32_16x16x32_bf16 v[224:227], a[148:151], a[28:31], v[224:227]
v_mfma_f32_16x16x32_bf16 v[96:99], a[244:247], v[140:143], 0
v_mfma_f32_16x16x32_bf16 v[200:203], a[148:151], a[20:23], v[200:203]
v_mfma_f32_16x16x32_bf16 v[100:103], a[240:243], v[164:167], 0
v_mfma_f32_16x16x32_bf16 v[200:203], a[144:147], a[16:19], v[200:203]
v_mfma_f32_16x16x32_bf16 v[104:107], a[244:247], v[164:167], 0
v_mfma_f32_16x16x32_bf16 v[176:179], a[144:147], a[8:11], v[176:179]
buffer_load_dwordx4 v1, s[4:7], s44 offen offset:2048 sc1 lds
v_mfma_f32_16x16x32_bf16 v[176:179], a[148:151], a[12:15], v[176:179]
v_max3_f32 v236, v92, v93, v94
v_max3_f32 v237, -v92, -v93, -v94
v_mfma_f32_16x16x32_bf16 v[152:155], a[148:151], a[4:7], v[152:155]
v_max3_f32 v236, v236, v95, v96
v_max3_f32 v237, v237, -v95, -v96
v_mfma_f32_16x16x32_bf16 v[152:155], a[144:147], a[0:3], v[152:155]
v_max3_f32 v236, v236, v97, v98
s_waitcnt lgkmcnt(0)
v_mfma_f32_16x16x32_bf16 v[132:135], a[96:99], a[32:35], v[132:135]
ds_read_b128 a[128:131], v5 offset:13312
v_max3_f32 v237, v237, -v97, -v98
v_mfma_f32_16x16x32_bf16 v[132:135], a[100:103], a[36:39], v[132:135]
buffer_load_dwordx4 v1, s[4:7], s44 offen offset:3072 sc1 lds
s_add_u32 m0, s19, 98304
v_mfma_f32_16x16x32_bf16 v[156:159], a[100:103], a[44:47], v[156:159]
s_add_u32 s44, s84, 0xc10000
ds_read_b128 a[132:135], v5 offset:19456
v_mfma_f32_16x16x32_bf16 v[156:159], a[96:99], a[40:43], v[156:159]
v_max_f32 v236, v236, v99
v_max_f32_e64 v237, v237, -v99
v_mfma_f32_16x16x32_bf16 v[180:183], a[96:99], a[48:51], v[180:183]
s_nop 0
v_permlane32_swap_b32 v236, v237
v_mfma_f32_16x16x32_bf16 v[180:183], a[100:103], a[52:55], v[180:183]
buffer_load_dwordx4 v1, s[4:7], s44 offen offset:0 sc1 lds
v_mfma_f32_16x16x32_bf16 v[204:207], a[100:103], a[60:63], v[204:207]
ds_read_b128 a[136:139], v5 offset:25600
v_max_f32 v236, v236, v237
v_mfma_f32_16x16x32_bf16 v[204:207], a[96:99], a[56:59], v[204:207]
v_mov_b32 v244, v236
v_max3_f32 v238, v100, v101, v102
v_mfma_f32_16x16x32_bf16 v[204:207], a[104:107], a[88:91], v[204:207]
ds_read_b128 a[140:143], v5 offset:31744
v_max3_f32 v239, -v100, -v101, -v102
v_mfma_f32_16x16x32_bf16 v[204:207], a[108:111], a[92:95], v[204:207]
v_permlane16_swap_b32 v236, v244
v_mfma_f32_16x16x32_bf16 v[180:183], a[108:111], a[84:87], v[180:183]
buffer_load_dwordx4 v1, s[4:7], s44 offen offset:1024 sc1 lds
v_mfma_f32_16x16x32_bf16 v[180:183], a[104:107], a[80:83], v[180:183]
ds_read_b128 a[144:147], v5 offset:37888
v_max_f32 v236, v236, v244
v_mfma_f32_16x16x32_bf16 v[156:159], a[104:107], a[72:75], v[156:159]
v_mov_b32 v244, v236
v_max3_f32 v238, v238, v103, v104
v_mfma_f32_16x16x32_bf16 v[156:159], a[108:111], a[76:79], v[156:159]
ds_read_b128 a[148:151], v5 offset:44032
v_max3_f32 v239, v239, -v103, -v104
v_mfma_f32_16x16x32_bf16 v[132:135], a[108:111], a[68:71], v[132:135]
v_permlane32_swap_b32 v236, v244
v_mfma_f32_16x16x32_bf16 v[132:135], a[104:107], a[64:67], v[132:135]
buffer_load_dwordx4 v1, s[4:7], s44 offen offset:2048 sc1 lds
v_mfma_f32_16x16x32_bf16 v[132:135], a[112:115], a[0:3], v[132:135]
v_mul_f32_e64 v236, -v236, v82
v_mul_f32_e64 v237, -v244, v82
v_mfma_f32_16x16x32_bf16 v[132:135], a[116:119], a[4:7], v[132:135]
v_max3_f32 v238, v238, v105, v106
v_max3_f32 v239, v239, -v105, -v106
v_mfma_f32_16x16x32_bf16 v[156:159], a[116:119], a[12:15], v[156:159]
v_max_f32 v238, v238, v107
v_max_f32_e64 v239, v239, -v107
v_mfma_f32_16x16x32_bf16 v[156:159], a[112:115], a[8:11], v[156:159]
s_nop 0
v_permlane32_swap_b32 v238, v239
v_mfma_f32_16x16x32_bf16 v[180:183], a[112:115], a[16:19], v[180:183]
buffer_load_dwordx4 v1, s[4:7], s44 offen offset:3072 sc1 lds
s_add_u32 m0, s19, 114688
v_mfma_f32_16x16x32_bf16 v[180:183], a[116:119], a[20:23], v[180:183]
s_add_u32 s44, s85, 0xc14000
v_max_f32 v238, v238, v239
v_mfma_f32_16x16x32_bf16 v[204:207], a[116:119], a[28:31], v[204:207]
v_mov_b32 v245, v238
v_mul_f32 v148, v148, v83
v_mfma_f32_16x16x32_bf16 v[204:207], a[112:115], a[24:27], v[204:207]
s_waitcnt lgkmcnt(0)
s_barrier
v_mfma_f32_16x16x32_bf16 v[208:211], a[128:131], a[56:59], v[208:211]
v_mul_f32 v149, v149, v83
v_cvt_pk_bf16_f32 v148, v148, v149
v_mfma_f32_16x16x32_bf16 v[208:211], a[132:135], a[60:63], v[208:211]
buffer_load_dwordx4 v1, s[4:7], s44 offen offset:0 sc1 lds
v_mfma_f32_16x16x32_bf16 v[184:187], a[132:135], a[52:55], v[184:187]
v_permlane16_swap_b32 v238, v245
v_mfma_f32_16x16x32_bf16 v[184:187], a[128:131], a[48:51], v[184:187]
v_max_f32 v238, v238, v245
v_mov_b32 v245, v238
v_mfma_f32_16x16x32_bf16 v[160:163], a[128:131], a[40:43], v[160:163]
s_nop 0
v_permlane32_swap_b32 v238, v245
v_mfma_f32_16x16x32_bf16 v[160:163], a[132:135], a[44:47], v[160:163]
v_mul_f32_e64 v238, -v238, v84
v_mul_f32_e64 v239, -v245, v84
v_mfma_f32_16x16x32_bf16 v[136:139], a[132:135], a[36:39], v[136:139]
v_mfma_f32_16x16x32_bf16 v[108:111], a[240:243], v[188:191], 0
v_mfma_f32_16x16x32_bf16 v[136:139], a[128:131], a[32:35], v[136:139]
buffer_load_dwordx4 v1, s[4:7], s44 offen offset:1024 sc1 lds
v_mfma_f32_16x16x32_bf16 v[136:139], a[136:139], a[64:67], v[136:139]
v_mfma_f32_16x16x32_bf16 v[112:115], a[244:247], v[188:191], 0
v_mfma_f32_16x16x32_bf16 v[136:139], a[140:143], a[68:71], v[136:139]
v_mfma_f32_16x16x32_bf16 v[116:119], a[240:243], v[212:215], 0
v_mfma_f32_16x16x32_bf16 v[160:163], a[140:143], a[76:79], v[160:163]
v_mfma_f32_16x16x32_bf16 v[120:123], a[244:247], v[212:215], 0
v_mfma_f32_16x16x32_bf16 v[160:163], a[136:139], a[72:75], v[160:163]
v_max3_f32 v240, v108, v109, v110
v_max3_f32 v241, -v108, -v109, -v110
v_mfma_f32_16x16x32_bf16 v[184:187], a[136:139], a[80:83], v[184:187]
v_mul_f32 v150, v150, v83
v_mul_f32 v151, v151, v83
v_mfma_f32_16x16x32_bf16 v[184:187], a[140:143], a[84:87], v[184:187]
buffer_load_dwordx4 v1, s[4:7], s44 offen offset:2048 sc1 lds
v_mfma_f32_16x16x32_bf16 v[208:211], a[140:143], a[92:95], v[208:211]
v_cvt_pk_bf16_f32 v149, v150, v151
v_max3_f32 v240, v240, v111, v112
v_mfma_f32_16x16x32_bf16 v[208:211], a[136:139], a[88:91], v[208:211]
ds_write_b64 v232, v[148:149] offset:0
v_max3_f32 v241, v241, -v111, -v112
v_mfma_f32_16x16x32_bf16 v[208:211], a[144:147], a[24:27], v[208:211]
v_max3_f32 v240, v240, v113, v114
v_max3_f32 v241, v241, -v113, -v114
v_mfma_f32_16x16x32_bf16 v[208:211], a[148:151], a[28:31], v[208:211]
v_max_f32 v240, v240, v115
v_max_f32_e64 v241, v241, -v115
v_mfma_f32_16x16x32_bf16 v[184:187], a[148:151], a[20:23], v[184:187]
s_nop 0
v_permlane32_swap_b32 v240, v241
v_mfma_f32_16x16x32_bf16 v[184:187], a[144:147], a[16:19], v[184:187]
buffer_load_dwordx4 v1, s[4:7], s44 offen offset:3072 sc1 lds
v_mfma_f32_16x16x32_bf16 v[160:163], a[144:147], a[8:11], v[160:163]
v_max_f32 v240, v240, v241
v_mov_b32 v246, v240
v_mfma_f32_16x16x32_bf16 v[160:163], a[148:151], a[12:15], v[160:163]
s_nop 0
v_permlane16_swap_b32 v240, v246
v_mfma_f32_16x16x32_bf16 v[136:139], a[148:151], a[4:7], v[136:139]
v_max_f32 v240, v240, v246
v_mov_b32 v246, v240
v_mfma_f32_16x16x32_bf16 v[136:139], a[144:147], a[0:3], v[136:139]
s_nop 0
v_permlane32_swap_b32 v240, v246
v_pk_mul_f32 v[152:153], v[152:153], v[82:83] op_sel:[0,1] op_sel_hi:[1,1]
v_pk_mul_f32 v[154:155], v[154:155], v[82:83] op_sel:[0,1] op_sel_hi:[1,1]
v_cvt_pk_bf16_f32 v150, v152, v153
v_cvt_pk_bf16_f32 v151, v154, v155
ds_write_b64 v232, v[150:151] offset:512
v_pk_mul_f32 v[172:173], v[172:173], v[84:85] op_sel:[0,1] op_sel_hi:[1,1]
v_pk_mul_f32 v[174:175], v[174:175], v[84:85] op_sel:[0,1] op_sel_hi:[1,1]
v_cvt_pk_bf16_f32 v172, v172, v173
v_cvt_pk_bf16_f32 v173, v174, v175
v_pk_mul_f32 v[176:177], v[176:177], v[84:85] op_sel:[0,1] op_sel_hi:[1,1]
v_pk_mul_f32 v[178:179], v[178:179], v[84:85] op_sel:[0,1] op_sel_hi:[1,1]
v_cvt_pk_bf16_f32 v174, v176, v177
v_cvt_pk_bf16_f32 v175, v178, v179
v_pk_mul_f32 v[196:197], v[196:197], v[86:87] op_sel:[0,1] op_sel_hi:[1,1]
v_pk_mul_f32 v[198:199], v[198:199], v[86:87] op_sel:[0,1] op_sel_hi:[1,1]
v_cvt_pk_bf16_f32 v196, v196, v197
v_cvt_pk_bf16_f32 v197, v198, v199
ds_write_b64 v232, v[172:173] offset:1024
buffer_store_dwordx4 a[248:251], v254, s[4:7], s97 offen offset:0 sc1
v_pk_mul_f32 v[200:201], v[200:201], v[86:87] op_sel:[0,1] op_sel_hi:[1,1]
v_pk_mul_f32 v[202:203], v[202:203], v[86:87] op_sel:[0,1] op_sel_hi:[1,1]
v_cvt_pk_bf16_f32 v198, v200, v201
v_cvt_pk_bf16_f32 v199, v202, v203
v_pk_mul_f32 v[220:221], v[220:221], v[88:89] op_sel:[0,1] op_sel_hi:[1,1]
v_pk_mul_f32 v[222:223], v[222:223], v[88:89] op_sel:[0,1] op_sel_hi:[1,1]
v_cvt_pk_bf16_f32 v220, v220, v221
v_cvt_pk_bf16_f32 v221, v222, v223
ds_write_b64 v232, v[174:175] offset:1536
v_pk_fma_f32 v[48:49], v[92:93], v[82:83], v[236:237] op_sel:[0,0,0] op_sel_hi:[1,0,0]
v_pk_fma_f32 v[50:51], v[94:95], v[82:83], v[236:237] op_sel:[0,0,0] op_sel_hi:[1,0,0]
v_pk_fma_f32 v[52:53], v[96:97], v[82:83], v[236:237] op_sel:[0,0,0] op_sel_hi:[1,0,0]
v_pk_fma_f32 v[54:55], v[98:99], v[82:83], v[236:237] op_sel:[0,0,0] op_sel_hi:[1,0,0]
v_exp_f32 v48, v48
v_exp_f32 v49, v49
v_exp_f32 v50, v50
v_exp_f32 v51, v51
ds_write_b64 v232, v[196:197] offset:2048
v_exp_f32 v52, v52
v_exp_f32 v53, v53
v_exp_f32 v54, v54
v_exp_f32 v55, v55
buffer_store_dwordx4 a[248:251], v1, s[4:7], s96 offen offset:0 sc1
ds_write_b64 v232, v[198:199] offset:2560
v_cvt_pk_bf16_f32 v140, v48, v49
v_cvt_pk_bf16_f32 v141, v50, v51
v_cvt_pk_bf16_f32 v142, v52, v53
v_cvt_pk_bf16_f32 v143, v54, v55
v_pk_mul_f32 v[224:225], v[224:225], v[88:89] op_sel:[0,1] op_sel_hi:[1,1]
v_pk_mul_f32 v[226:227], v[226:227], v[88:89] op_sel:[0,1] op_sel_hi:[1,1]
v_cvt_pk_bf16_f32 v222, v224, v225
v_mfma_f32_16x16x32_bf16 v[148:151], v[16:19], v[140:143], 0
v_cvt_pk_bf16_f32 v223, v226, v227
s_add_u32 m0, s19, 131072
s_add_u32 s44, s86, 0xc18000
ds_write_b64 v232, v[220:221] offset:3072
v_pk_fma_f32 v[92:93], v[92:93], v[82:83], v[236:237] op_sel:[0,0,1] op_sel_hi:[1,0,1] neg_lo:[1,0,0] neg_hi:[1,0,0]
v_pk_fma_f32 v[94:95], v[94:95], v[82:83], v[236:237] op_sel:[0,0,1] op_sel_hi:[1,0,1] neg_lo:[1,0,0] neg_hi:[1,0,0]
s_nop 1
v_rcp_f32 v148, v148
v_pk_fma_f32 v[96:97], v[96:97], v[82:83], v[236:237] op_sel:[0,0,1] op_sel_hi:[1,0,1] neg_lo:[1,0,0] neg_hi:[1,0,0]
v_pk_mul_f32 v[48:49], v[48:49], v[148:149] op_sel:[0,0] op_sel_hi:[1,0]
v_pk_mul_f32 v[50:51], v[50:51], v[148:149] op_sel:[0,0] op_sel_hi:[1,0]
v_cvt_pk_bf16_f32 v140, v48, v49
v_cvt_pk_bf16_f32 v141, v50, v51
v_pk_fma_f32 v[98:99], v[98:99], v[82:83], v[236:237] op_sel:[0,0,1] op_sel_hi:[1,0,1] neg_lo:[1,0,0] neg_hi:[1,0,0]
v_exp_f32 v92, v92
ds_write_b64 v232, v[222:223] offset:3584
v_exp_f32 v93, v93
v_exp_f32 v94, v94
v_exp_f32 v95, v95
v_exp_f32 v96, v96
v_exp_f32 v97, v97
v_exp_f32 v98, v98
ds_write_b64 v233, v[140:141] offset:16384
v_exp_f32 v99, v99
v_cvt_pk_bf16_f32 v144, v92, v93
v_cvt_pk_bf16_f32 v145, v94, v95
v_cvt_pk_bf16_f32 v146, v96, v97
v_cvt_pk_bf16_f32 v147, v98, v99
buffer_load_dwordx4 v1, s[4:7], s44 offen offset:0 sc1 lds
v_pk_mul_f32 v[52:53], v[52:53], v[148:149] op_sel:[0,0] op_sel_hi:[1,0]
v_cvt_pk_bf16_f32 v142, v52, v53
v_pk_mul_f32 v[54:55], v[54:55], v[148:149] op_sel:[0,0] op_sel_hi:[1,0]
v_cvt_pk_bf16_f32 v143, v54, v55
v_mfma_f32_16x16x32_bf16 v[152:155], v[16:19], v[144:147], 0
ds_write_b64 v233, v[142:143] offset:16896
v_mul_f32_e64 v240, -v240, v86
v_mul_f32_e64 v241, -v246, v86
v_pk_fma_f32 v[56:57], v[100:101], v[84:85], v[238:239] op_sel:[0,0,0] op_sel_hi:[1,0,0]
v_pk_fma_f32 v[58:59], v[102:103], v[84:85], v[238:239] op_sel:[0,0,0] op_sel_hi:[1,0,0]
v_pk_fma_f32 v[60:61], v[104:105], v[84:85], v[238:239] op_sel:[0,0,0] op_sel_hi:[1,0,0]
s_nop 1
v_rcp_f32 v152, v152
v_pk_fma_f32 v[62:63], v[106:107], v[84:85], v[238:239] op_sel:[0,0,0] op_sel_hi:[1,0,0]
v_pk_mul_f32 v[92:93], v[92:93], v[152:153] op_sel:[0,0] op_sel_hi:[1,0]
v_pk_mul_f32 v[94:95], v[94:95], v[152:153] op_sel:[0,0] op_sel_hi:[1,0]
v_cvt_pk_bf16_f32 v144, v92, v93
v_cvt_pk_bf16_f32 v145, v94, v95
ds_write_b64 v233, v[144:145] offset:17408
v_exp_f32 v56, v56
v_exp_f32 v57, v57
v_exp_f32 v58, v58
v_exp_f32 v59, v59
v_exp_f32 v60, v60
v_exp_f32 v61, v61
v_exp_f32 v62, v62
v_exp_f32 v63, v63
buffer_load_dwordx4 v1, s[4:7], s44 offen offset:1024 sc1 lds
v_cvt_pk_bf16_f32 v164, v56, v57
v_cvt_pk_bf16_f32 v165, v58, v59
v_cvt_pk_bf16_f32 v166, v60, v61
v_cvt_pk_bf16_f32 v167, v62, v63
v_pk_mul_f32 v[96:97], v[96:97], v[152:153] op_sel:[0,0] op_sel_hi:[1,0]
v_pk_mul_f32 v[98:99], v[98:99], v[152:153] op_sel:[0,0] op_sel_hi:[1,0]
v_cvt_pk_bf16_f32 v146, v96, v97
v_mfma_f32_16x16x32_bf16 v[172:175], v[16:19], v[164:167], 0
v_cvt_pk_bf16_f32 v147, v98, v99
ds_write_b64 v233, v[146:147] offset:17920
v_max3_f32 v242, v116, v117, v118
v_pk_fma_f32 v[100:101], v[100:101], v[84:85], v[238:239] op_sel:[0,0,1] op_sel_hi:[1,0,1] neg_lo:[1,0,0] neg_hi:[1,0,0]
v_pk_fma_f32 v[102:103], v[102:103], v[84:85], v[238:239] op_sel:[0,0,1] op_sel_hi:[1,0,1] neg_lo:[1,0,0] neg_hi:[1,0,0]
v_pk_fma_f32 v[104:105], v[104:105], v[84:85], v[238:239] op_sel:[0,0,1] op_sel_hi:[1,0,1] neg_lo:[1,0,0] neg_hi:[1,0,0]
s_nop 1
v_rcp_f32 v172, v172
v_pk_fma_f32 v[106:107], v[106:107], v[84:85], v[238:239] op_sel:[0,0,1] op_sel_hi:[1,0,1] neg_lo:[1,0,0] neg_hi:[1,0,0]
v_pk_mul_f32 v[56:57], v[56:57], v[172:173] op_sel:[0,0] op_sel_hi:[1,0]
v_pk_mul_f32 v[58:59], v[58:59], v[172:173] op_sel:[0,0] op_sel_hi:[1,0]
v_cvt_pk_bf16_f32 v164, v56, v57
v_cvt_pk_bf16_f32 v165, v58, v59
v_exp_f32 v100, v100
ds_write_b64 v233, v[164:165] offset:18432
v_exp_f32 v101, v101
v_exp_f32 v102, v102
v_exp_f32 v103, v103
v_exp_f32 v104, v104
v_exp_f32 v105, v105
v_exp_f32 v106, v106
v_exp_f32 v107, v107
buffer_load_dwordx4 v1, s[4:7], s44 offen offset:2048 sc1 lds
v_cvt_pk_bf16_f32 v168, v100, v101
v_cvt_pk_bf16_f32 v169, v102, v103
v_cvt_pk_bf16_f32 v170, v104, v105
v_cvt_pk_bf16_f32 v171, v106, v107
v_pk_mul_f32 v[60:61], v[60:61], v[172:173] op_sel:[0,0] op_sel_hi:[1,0]
v_pk_mul_f32 v[62:63], v[62:63], v[172:173] op_sel:[0,0] op_sel_hi:[1,0]
v_cvt_pk_bf16_f32 v166, v60, v61
v_mfma_f32_16x16x32_bf16 v[176:179], v[16:19], v[168:171], 0
v_cvt_pk_bf16_f32 v167, v62, v63
ds_write_b64 v233, v[166:167] offset:18944
v_max3_f32 v243, -v116, -v117, -v118
v_pk_fma_f32 v[64:65], v[108:109], v[86:87], v[240:241] op_sel:[0,0,0] op_sel_hi:[1,0,0]
v_pk_fma_f32 v[66:67], v[110:111], v[86:87], v[240:241] op_sel:[0,0,0] op_sel_hi:[1,0,0]
v_pk_fma_f32 v[68:69], v[112:113], v[86:87], v[240:241] op_sel:[0,0,0] op_sel_hi:[1,0,0]
s_nop 1
v_rcp_f32 v176, v176
v_pk_fma_f32 v[70:71], v[114:115], v[86:87], v[240:241] op_sel:[0,0,0] op_sel_hi:[1,0,0]
v_pk_mul_f32 v[100:101], v[100:101], v[176:177] op_sel:[0,0] op_sel_hi:[1,0]
v_pk_mul_f32 v[102:103], v[102:103], v[176:177] op_sel:[0,0] op_sel_hi:[1,0]
v_cvt_pk_bf16_f32 v168, v100, v101
v_cvt_pk_bf16_f32 v169, v102, v103
v_exp_f32 v64, v64
ds_write_b64 v233, v[168:169] offset:19456
buffer_load_dwordx4 v1, s[4:7], s44 offen offset:3072 sc1 lds
v_exp_f32 v65, v65
v_exp_f32 v66, v66
v_exp_f32 v67, v67
v_exp_f32 v68, v68
v_exp_f32 v69, v69
v_exp_f32 v70, v70
v_exp_f32 v71, v71
v_cvt_pk_bf16_f32 v188, v64, v65
v_cvt_pk_bf16_f32 v189, v66, v67
v_cvt_pk_bf16_f32 v190, v68, v69
v_cvt_pk_bf16_f32 v191, v70, v71
v_pk_mul_f32 v[104:105], v[104:105], v[176:177] op_sel:[0,0] op_sel_hi:[1,0]
v_pk_mul_f32 v[106:107], v[106:107], v[176:177] op_sel:[0,0] op_sel_hi:[1,0]
v_cvt_pk_bf16_f32 v170, v104, v105
v_mfma_f32_16x16x32_bf16 v[196:199], v[16:19], v[188:191], 0
v_cvt_pk_bf16_f32 v171, v106, v107
ds_write_b64 v233, v[170:171] offset:19968
buffer_store_dwordx4 a[248:251], v2, s[4:7], s72 offen offset:0 sc1
s_nop 4
v_rcp_f32 v196, v196
v_pk_fma_f32 v[108:109], v[108:109], v[86:87], v[240:241] op_sel:[0,0,1] op_sel_hi:[1,0,1] neg_lo:[1,0,0] neg_hi:[1,0,0]
v_pk_mul_f32 v[64:65], v[64:65], v[196:197] op_sel:[0,0] op_sel_hi:[1,0]
v_pk_mul_f32 v[66:67], v[66:67], v[196:197] op_sel:[0,0] op_sel_hi:[1,0]
v_cvt_pk_bf16_f32 v188, v64, v65
v_cvt_pk_bf16_f32 v189, v66, v67
v_pk_fma_f32 v[110:111], v[110:111], v[86:87], v[240:241] op_sel:[0,0,1] op_sel_hi:[1,0,1] neg_lo:[1,0,0] neg_hi:[1,0,0]
ds_write_b64 v233, v[188:189] offset:20480
v_pk_fma_f32 v[112:113], v[112:113], v[86:87], v[240:241] op_sel:[0,0,1] op_sel_hi:[1,0,1] neg_lo:[1,0,0] neg_hi:[1,0,0]
v_pk_fma_f32 v[114:115], v[114:115], v[86:87], v[240:241] op_sel:[0,0,1] op_sel_hi:[1,0,1] neg_lo:[1,0,0] neg_hi:[1,0,0]
v_exp_f32 v108, v108
v_exp_f32 v109, v109
v_exp_f32 v110, v110
v_exp_f32 v111, v111
v_exp_f32 v112, v112
v_exp_f32 v113, v113
v_exp_f32 v114, v114
v_exp_f32 v115, v115
v_max3_f32 v242, v242, v119, v120
v_max3_f32 v243, v243, -v119, -v120
v_max3_f32 v242, v242, v121, v122
v_max3_f32 v243, v243, -v121, -v122
v_max_f32 v242, v242, v123
v_max_f32_e64 v243, v243, -v123
v_cvt_pk_bf16_f32 v192, v108, v109
v_cvt_pk_bf16_f32 v193, v110, v111
v_cvt_pk_bf16_f32 v194, v112, v113
v_cvt_pk_bf16_f32 v195, v114, v115
v_pk_mul_f32 v[68:69], v[68:69], v[196:197] op_sel:[0,0] op_sel_hi:[1,0]
v_pk_mul_f32 v[70:71], v[70:71], v[196:197] op_sel:[0,0] op_sel_hi:[1,0]
v_permlane32_swap_b32 v242, v243
v_mfma_f32_16x16x32_bf16 v[200:203], v[16:19], v[192:195], 0
v_cvt_pk_bf16_f32 v190, v68, v69
v_cvt_pk_bf16_f32 v191, v70, v71
ds_write_b64 v233, v[190:191] offset:20992
v_max_f32 v242, v242, v243
v_mov_b32 v247, v242
buffer_store_dwordx4 a[248:251], v2, s[4:7], s72 offen offset:1024 sc1
s_nop 0
v_permlane16_swap_b32 v242, v247
v_rcp_f32 v200, v200
v_max_f32 v242, v242, v247
v_mov_b32 v247, v242
v_pk_mul_f32 v[108:109], v[108:109], v[200:201] op_sel:[0,0] op_sel_hi:[1,0]
v_pk_mul_f32 v[110:111], v[110:111], v[200:201] op_sel:[0,0] op_sel_hi:[1,0]
v_cvt_pk_bf16_f32 v192, v108, v109
v_cvt_pk_bf16_f32 v193, v110, v111
v_permlane32_swap_b32 v242, v247
ds_write_b64 v233, v[192:193] offset:21504
v_mul_f32_e64 v242, -v242, v88
v_mul_f32_e64 v243, -v247, v88
v_pk_fma_f32 v[124:125], v[116:117], v[88:89], v[242:243] op_sel:[0,0,0] op_sel_hi:[1,0,0]
v_pk_fma_f32 v[126:127], v[118:119], v[88:89], v[242:243] op_sel:[0,0,0] op_sel_hi:[1,0,0]
v_pk_fma_f32 v[128:129], v[120:121], v[88:89], v[242:243] op_sel:[0,0,0] op_sel_hi:[1,0,0]
v_pk_fma_f32 v[130:131], v[122:123], v[88:89], v[242:243] op_sel:[0,0,0] op_sel_hi:[1,0,0]
L_stub18:
s_cbranch_execz L_stub19
v_exp_f32 v124, v124
v_exp_f32 v125, v125
v_exp_f32 v126, v126
v_exp_f32 v127, v127
v_exp_f32 v128, v128
v_exp_f32 v129, v129
v_exp_f32 v130, v130
v_exp_f32 v131, v131
v_cvt_pk_bf16_f32 v212, v124, v125
v_cvt_pk_bf16_f32 v213, v126, v127
v_cvt_pk_bf16_f32 v214, v128, v129
v_cvt_pk_bf16_f32 v215, v130, v131
v_pk_mul_f32 v[112:113], v[112:113], v[200:201] op_sel:[0,0] op_sel_hi:[1,0]
v_pk_mul_f32 v[114:115], v[114:115], v[200:201] op_sel:[0,0] op_sel_hi:[1,0]
v_cvt_pk_bf16_f32 v194, v112, v113
v_mfma_f32_16x16x32_bf16 v[220:223], v[16:19], v[212:215], 0
v_cvt_pk_bf16_f32 v195, v114, v115
ds_write_b64 v233, v[194:195] offset:22016
buffer_store_dwordx4 a[248:251], v2, s[4:7], s72 offen offset:2048 sc1
s_nop 4
v_rcp_f32 v220, v220
v_pk_fma_f32 v[116:117], v[116:117], v[88:89], v[242:243] op_sel:[0,0,1] op_sel_hi:[1,0,1] neg_lo:[1,0,0] neg_hi:[1,0,0]
v_pk_mul_f32 v[124:125], v[124:125], v[220:221] op_sel:[0,0] op_sel_hi:[1,0]
v_pk_mul_f32 v[126:127], v[126:127], v[220:221] op_sel:[0,0] op_sel_hi:[1,0]
v_cvt_pk_bf16_f32 v212, v124, v125
v_cvt_pk_bf16_f32 v213, v126, v127
v_pk_fma_f32 v[118:119], v[118:119], v[88:89], v[242:243] op_sel:[0,0,1] op_sel_hi:[1,0,1] neg_lo:[1,0,0] neg_hi:[1,0,0]
ds_write_b64 v233, v[212:213] offset:22528
v_pk_fma_f32 v[120:121], v[120:121], v[88:89], v[242:243] op_sel:[0,0,1] op_sel_hi:[1,0,1] neg_lo:[1,0,0] neg_hi:[1,0,0]
v_pk_fma_f32 v[122:123], v[122:123], v[88:89], v[242:243] op_sel:[0,0,1] op_sel_hi:[1,0,1] neg_lo:[1,0,0] neg_hi:[1,0,0]
v_exp_f32 v116, v116
v_exp_f32 v117, v117
v_exp_f32 v118, v118
v_exp_f32 v119, v119
v_exp_f32 v120, v120
v_exp_f32 v121, v121
v_exp_f32 v122, v122
v_exp_f32 v123, v123
v_cvt_pk_bf16_f32 v216, v116, v117
v_cvt_pk_bf16_f32 v217, v118, v119
v_cvt_pk_bf16_f32 v218, v120, v121
v_cvt_pk_bf16_f32 v219, v122, v123
v_pk_mul_f32 v[128:129], v[128:129], v[220:221] op_sel:[0,0] op_sel_hi:[1,0]
v_pk_mul_f32 v[130:131], v[130:131], v[220:221] op_sel:[0,0] op_sel_hi:[1,0]
v_cvt_pk_bf16_f32 v214, v128, v129
v_mfma_f32_16x16x32_bf16 v[224:227], v[16:19], v[216:219], 0
v_cvt_pk_bf16_f32 v215, v130, v131
ds_write_b64 v233, v[214:215] offset:23040
buffer_store_dwordx4 a[248:251], v2, s[4:7], s72 offen offset:3072 sc1
s_nop 4
v_rcp_f32 v224, v224
s_nop 0
v_pk_mul_f32 v[116:117], v[116:117], v[224:225] op_sel:[0,0] op_sel_hi:[1,0]
v_pk_mul_f32 v[118:119], v[118:119], v[224:225] op_sel:[0,0] op_sel_hi:[1,0]
v_cvt_pk_bf16_f32 v216, v116, v117
v_cvt_pk_bf16_f32 v217, v118, v119
v_pk_mul_f32 v[120:121], v[120:121], v[224:225] op_sel:[0,0] op_sel_hi:[1,0]
ds_write_b64 v233, v[216:217] offset:23552
v_pk_mul_f32 v[122:123], v[122:123], v[224:225] op_sel:[0,0] op_sel_hi:[1,0]
v_cvt_pk_bf16_f32 v218, v120, v121
v_cvt_pk_bf16_f32 v219, v122, v123
ds_write_b64 v233, v[218:219] offset:24064
s_waitcnt vmcnt(8)
s_waitcnt lgkmcnt(0)
s_barrier
ds_read_b64_tr_b16 a[0:1], v234 offset:16384
ds_read_b64_tr_b16 a[2:3], v234 offset:18432
ds_read_b64_tr_b16 a[12:13], v234 offset:20480
ds_read_b64_tr_b16 a[14:15], v234 offset:22528
ds_read_b64_tr_b16 a[24:25], v234 offset:24576
ds_read_b64_tr_b16 a[26:27], v234 offset:26624
ds_read_b64_tr_b16 a[4:5], v8 offset:0
ds_read_b64_tr_b16 a[6:7], v8 offset:1024
ds_read_b64_tr_b16 a[8:9], v8 offset:512
ds_read_b64_tr_b16 a[10:11], v8 offset:1536
ds_read_b64_tr_b16 a[36:37], v234 offset:28672
ds_read_b64_tr_b16 a[38:39], v234 offset:30720
ds_read_b64_tr_b16 a[16:17], v8 offset:2048
ds_read_b64_tr_b16 a[18:19], v8 offset:3072
ds_read_b64_tr_b16 a[20:21], v8 offset:2560
ds_read_b64_tr_b16 a[22:23], v8 offset:3584
ds_read_b64_tr_b16 a[48:49], v234 offset:32768
ds_read_b64_tr_b16 a[50:51], v234 offset:34816
ds_read_b64_tr_b16 a[28:29], v8 offset:4096
ds_read_b64_tr_b16 a[30:31], v8 offset:5120
ds_read_b64_tr_b16 a[32:33], v8 offset:4608
ds_read_b64_tr_b16 a[34:35], v8 offset:5632
ds_read_b64_tr_b16 a[60:61], v234 offset:36864
ds_read_b64_tr_b16 a[62:63], v234 offset:38912
s_waitcnt lgkmcnt(14)
v_mfma_f32_16x16x32_bf16 v[100:103], a[0:3], v[16:19], 0
ds_read_b64_tr_b16 a[40:41], v8 offset:6144
ds_read_b64_tr_b16 a[42:43], v8 offset:7168
ds_read_b64_tr_b16 a[44:45], v8 offset:6656
ds_read_b64_tr_b16 a[46:47], v8 offset:7680
ds_read_b64_tr_b16 a[72:73], v234 offset:40960
ds_read_b64_tr_b16 a[74:75], v234 offset:43008
v_mfma_f32_16x16x32_bf16 v[100:103], a[12:15], v[16:19], v[100:103]
buffer_atomic_add v12, v235, s[4:7], s94 offen sc1
ds_read_b64_tr_b16 a[52:53], v8 offset:8192
ds_read_b64_tr_b16 a[54:55], v8 offset:9216
ds_read_b64_tr_b16 a[56:57], v8 offset:8704
ds_read_b64_tr_b16 a[58:59], v8 offset:9728
ds_read_b64_tr_b16 a[84:85], v234 offset:45056
ds_read_b64_tr_b16 a[86:87], v234 offset:47104
v_mfma_f32_16x16x32_bf16 v[100:103], a[24:27], v[16:19], v[100:103]
ds_read_b64_tr_b16 a[64:65], v8 offset:10240
ds_read_b64_tr_b16 a[66:67], v8 offset:11264
v_mfma_f32_16x16x32_bf16 v[92:95], a[0:3], a[4:7], 0
ds_read_b64_tr_b16 a[68:69], v8 offset:10752
ds_read_b64_tr_b16 a[70:71], v8 offset:11776
v_mfma_f32_16x16x32_bf16 v[96:99], a[0:3], a[8:11], 0
ds_read_b64_tr_b16 a[76:77], v8 offset:12288
s_waitcnt lgkmcnt(14)
v_mfma_f32_16x16x32_bf16 v[100:103], a[36:39], v[16:19], v[100:103]
ds_read_b64_tr_b16 a[78:79], v8 offset:13312
v_mfma_f32_16x16x32_bf16 v[92:95], a[12:15], a[16:19], v[92:95]
ds_read_b64_tr_b16 a[80:81], v8 offset:12800
ds_read_b64_tr_b16 a[82:83], v8 offset:13824
v_mfma_f32_16x16x32_bf16 v[96:99], a[12:15], a[20:23], v[96:99]
ds_read_b64_tr_b16 a[88:89], v8 offset:14336
v_mfma_f32_16x16x32_bf16 v[100:103], a[48:51], v[16:19], v[100:103]
ds_read_b64_tr_b16 a[90:91], v8 offset:15360
v_mfma_f32_16x16x32_bf16 v[92:95], a[24:27], a[28:31], v[92:95]
ds_read_b64_tr_b16 a[92:93], v8 offset:14848
ds_read_b64_tr_b16 a[94:95], v8 offset:15872
v_mfma_f32_16x16x32_bf16 v[96:99], a[24:27], a[32:35], v[96:99]
v_cvt_pk_bf16_f32 v132, v132, v133
v_cvt_pk_bf16_f32 v156, v156, v157
v_mfma_f32_16x16x32_bf16 v[100:103], a[60:63], v[16:19], v[100:103]
v_cvt_pk_bf16_f32 v180, v180, v181
v_cvt_pk_bf16_f32 v204, v204, v205
v_mfma_f32_16x16x32_bf16 v[92:95], a[36:39], a[40:43], v[92:95]
v_cvt_pk_bf16_f32 v133, v134, v135
v_cvt_pk_bf16_f32 v157, v158, v159
s_waitcnt lgkmcnt(14)
v_mfma_f32_16x16x32_bf16 v[96:99], a[36:39], a[44:47], v[96:99]
v_cvt_pk_bf16_f32 v181, v182, v183
v_cvt_pk_bf16_f32 v205, v206, v207
v_mfma_f32_16x16x32_bf16 v[100:103], a[72:75], v[16:19], v[100:103]
v_cvt_pk_bf16_f32 v134, v136, v137
v_cvt_pk_bf16_f32 v135, v138, v139
v_mfma_f32_16x16x32_bf16 v[92:95], a[48:51], a[52:55], v[92:95]
v_cvt_pk_bf16_f32 v158, v160, v161
v_cvt_pk_bf16_f32 v159, v162, v163
v_mfma_f32_16x16x32_bf16 v[96:99], a[48:51], a[56:59], v[96:99]
v_cvt_pk_bf16_f32 v182, v184, v185
v_cvt_pk_bf16_f32 v183, v186, v187
s_waitcnt lgkmcnt(12)
v_mfma_f32_16x16x32_bf16 v[100:103], a[84:87], v[16:19], v[100:103]
v_cvt_pk_bf16_f32 v206, v208, v209
v_cvt_pk_bf16_f32 v207, v210, v211
s_waitcnt lgkmcnt(10)
v_mfma_f32_16x16x32_bf16 v[92:95], a[60:63], a[64:67], v[92:95]
s_waitcnt lgkmcnt(8)
v_mfma_f32_16x16x32_bf16 v[96:99], a[60:63], a[68:71], v[96:99]
s_nop 1
v_min_u32 v100, -2, v100
v_min_u32 v101, -2, v101
s_waitcnt lgkmcnt(6)
v_mfma_f32_16x16x32_bf16 v[92:95], a[72:75], a[76:79], v[92:95]
v_min_u32 v102, -2, v102
v_min_u32 v103, -2, v103
s_waitcnt lgkmcnt(4)
v_mfma_f32_16x16x32_bf16 v[96:99], a[72:75], a[80:83], v[96:99]
buffer_store_dwordx4 v[100:103], v254, s[4:7], s97 offen sc1
s_waitcnt lgkmcnt(2)
v_mfma_f32_16x16x32_bf16 v[92:95], a[84:87], a[88:91], v[92:95]
s_waitcnt lgkmcnt(0)
v_mfma_f32_16x16x32_bf16 v[96:99], a[84:87], a[92:95], v[96:99]
s_nop 5
v_cvt_pk_bf16_f32 v92, v92, v93
v_cvt_pk_bf16_f32 v93, v94, v95
v_min_u32 v92, -2, v92
v_min_u32 v93, -2, v93
v_cvt_pk_bf16_f32 v94, v96, v97
v_cvt_pk_bf16_f32 v95, v98, v99
v_min_u32 v94, -2, v94
v_min_u32 v95, -2, v95
buffer_store_dwordx4 v[92:95], v1, s[4:7], s96 offen sc1
s_barrier
s_add_u32 m0, s19, 32768
s_add_u32 s44, s84, 0xc00000
buffer_load_dwordx4 v1, s[4:7], s44 offen offset:0 sc1 lds
v_mfma_f32_16x16x32_bf16 v[108:111], a[240:243], v[132:135], 0
v_mfma_f32_16x16x32_bf16 v[172:175], a[240:243], v[156:159], 0
v_mfma_f32_16x16x32_bf16 v[112:115], a[244:247], v[132:135], 0
s_nop 5
v_max3_f32 v236, v108, v109, v110
v_max3_f32 v237, -v108, -v109, -v110
v_mfma_f32_16x16x32_bf16 v[176:179], a[244:247], v[156:159], 0
v_max3_f32 v238, v172, v173, v174
v_max3_f32 v239, -v172, -v173, -v174
v_max3_f32 v236, v236, v111, v112
v_max3_f32 v237, v237, -v111, -v112
v_max3_f32 v236, v236, v113, v114
v_max3_f32 v237, v237, -v113, -v114
s_nop 1
v_max3_f32 v238, v238, v175, v176
v_max3_f32 v239, v239, -v175, -v176
v_max3_f32 v238, v238, v177, v178
v_max3_f32 v239, v239, -v177, -v178
v_max_f32 v236, v236, v115
buffer_load_dwordx4 v1, s[4:7], s44 offen offset:1024 sc1 lds
v_max_f32_e64 v237, v237, -v115
v_max_f32 v238, v238, v179
v_max_f32_e64 v239, v239, -v179
v_permlane32_swap_b32 v236, v237
s_nop 0
v_permlane32_swap_b32 v238, v239
v_mov_b32 v11, 0
buffer_atomic_add v11, v251, s[4:7], s89 offen sc0 sc1
v_max_f32 v236, v236, v237
v_max_f32 v238, v238, v239
v_mov_b32 v244, v236
v_mov_b32 v245, v238
s_nop 0
v_permlane16_swap_b32 v236, v244
v_permlane16_swap_b32 v238, v245
v_max_f32 v236, v236, v244
v_max_f32 v238, v238, v245
v_mov_b32 v244, v236
v_mov_b32 v245, v238
s_nop 0
v_permlane32_swap_b32 v236, v244
v_permlane32_swap_b32 v238, v245
v_mul_f32_e64 v236, -v236, v82
v_mul_f32_e64 v237, -v244, v82
buffer_load_dwordx4 v1, s[4:7], s44 offen offset:2048 sc1 lds
v_mul_f32_e64 v238, -v238, v84
v_mul_f32_e64 v239, -v245, v84
v_pk_fma_f32 v[116:117], v[108:109], v[82:83], v[236:237] op_sel:[0,0,0] op_sel_hi:[1,0,0]
v_pk_fma_f32 v[118:119], v[110:111], v[82:83], v[236:237] op_sel:[0,0,0] op_sel_hi:[1,0,0]
v_pk_fma_f32 v[120:121], v[112:113], v[82:83], v[236:237] op_sel:[0,0,0] op_sel_hi:[1,0,0]
v_pk_fma_f32 v[122:123], v[114:115], v[82:83], v[236:237] op_sel:[0,0,0] op_sel_hi:[1,0,0]
v_pk_fma_f32 v[148:149], v[172:173], v[84:85], v[238:239] op_sel:[0,0,0] op_sel_hi:[1,0,0]
v_pk_fma_f32 v[150:151], v[174:175], v[84:85], v[238:239] op_sel:[0,0,0] op_sel_hi:[1,0,0]
v_pk_fma_f32 v[152:153], v[176:177], v[84:85], v[238:239] op_sel:[0,0,0] op_sel_hi:[1,0,0]
v_pk_fma_f32 v[154:155], v[178:179], v[84:85], v[238:239] op_sel:[0,0,0] op_sel_hi:[1,0,0]
v_pk_fma_f32 v[108:109], v[108:109], v[82:83], v[236:237] op_sel:[0,0,1] op_sel_hi:[1,0,1] neg_lo:[1,0,0] neg_hi:[1,0,0]
v_pk_fma_f32 v[110:111], v[110:111], v[82:83], v[236:237] op_sel:[0,0,1] op_sel_hi:[1,0,1] neg_lo:[1,0,0] neg_hi:[1,0,0]
v_pk_fma_f32 v[112:113], v[112:113], v[82:83], v[236:237] op_sel:[0,0,1] op_sel_hi:[1,0,1] neg_lo:[1,0,0] neg_hi:[1,0,0]
v_pk_fma_f32 v[114:115], v[114:115], v[82:83], v[236:237] op_sel:[0,0,1] op_sel_hi:[1,0,1] neg_lo:[1,0,0] neg_hi:[1,0,0]
v_pk_fma_f32 v[172:173], v[172:173], v[84:85], v[238:239] op_sel:[0,0,1] op_sel_hi:[1,0,1] neg_lo:[1,0,0] neg_hi:[1,0,0]
v_pk_fma_f32 v[174:175], v[174:175], v[84:85], v[238:239] op_sel:[0,0,1] op_sel_hi:[1,0,1] neg_lo:[1,0,0] neg_hi:[1,0,0]
v_pk_fma_f32 v[176:177], v[176:177], v[84:85], v[238:239] op_sel:[0,0,1] op_sel_hi:[1,0,1] neg_lo:[1,0,0] neg_hi:[1,0,0]
v_pk_fma_f32 v[178:179], v[178:179], v[84:85], v[238:239] op_sel:[0,0,1] op_sel_hi:[1,0,1] neg_lo:[1,0,0] neg_hi:[1,0,0]
v_exp_f32 v116, v116
v_exp_f32 v108, v108
v_exp_f32 v117, v117
v_exp_f32 v109, v109
v_exp_f32 v118, v118
v_exp_f32 v110, v110
v_exp_f32 v119, v119
v_exp_f32 v111, v111
v_exp_f32 v120, v120
v_exp_f32 v112, v112
v_exp_f32 v121, v121
v_exp_f32 v113, v113
v_exp_f32 v122, v122
v_exp_f32 v114, v114
v_exp_f32 v123, v123
v_exp_f32 v115, v115
v_exp_f32 v148, v148
v_exp_f32 v172, v172
v_exp_f32 v149, v149
v_exp_f32 v173, v173
v_exp_f32 v150, v150
v_exp_f32 v174, v174
v_exp_f32 v151, v151
v_exp_f32 v175, v175
v_exp_f32 v152, v152
v_exp_f32 v176, v176
v_exp_f32 v153, v153
v_exp_f32 v177, v177
v_exp_f32 v154, v154
v_exp_f32 v178, v178
v_exp_f32 v155, v155
v_exp_f32 v179, v179
buffer_load_dwordx4 v1, s[4:7], s44 offen offset:3072 sc1 lds
v_cvt_pk_bf16_f32 v140, v116, v117
v_cvt_pk_bf16_f32 v141, v118, v119
v_cvt_pk_bf16_f32 v142, v120, v121
v_cvt_pk_bf16_f32 v143, v122, v123
v_cvt_pk_bf16_f32 v144, v108, v109
v_cvt_pk_bf16_f32 v145, v110, v111
v_cvt_pk_bf16_f32 v146, v112, v113
v_cvt_pk_bf16_f32 v147, v114, v115
v_cvt_pk_bf16_f32 v164, v148, v149
v_cvt_pk_bf16_f32 v165, v150, v151
v_cvt_pk_bf16_f32 v166, v152, v153
v_cvt_pk_bf16_f32 v167, v154, v155
v_cvt_pk_bf16_f32 v168, v172, v173
v_cvt_pk_bf16_f32 v169, v174, v175
v_cvt_pk_bf16_f32 v170, v176, v177
v_cvt_pk_bf16_f32 v171, v178, v179
s_waitcnt vmcnt(2)
v_readfirstlane_b32 s38, v11
s_nop 0
s_cmp_ge_u32 s38, 8
s_cbranch_scc1 Lpe_41
s_add_u32 s36, s88, 0x90000
s_mov_b32 s37, 0
Lpoll_40:
v_mov_b32 v11, 0
buffer_atomic_add v11, v251, s[4:7], s36 offen sc0 sc1
s_add_u32 s37, s37, 1
s_waitcnt vmcnt(0)
v_readfirstlane_b32 s38, v11
s_nop 0
s_cmp_ge_u32 s38, 8
s_cbranch_scc1 Lpe_41
s_cmp_lt_u32 s37, 0x100000
s_cbranch_scc1 Lpoll_40
Lpe_41:
buffer_load_dwordx4 v[48:51], v1, s[4:7], s98 offen offset:0 sc1
v_mfma_f32_16x16x32_bf16 v[108:111], a[240:243], v[180:183], 0
v_mfma_f32_16x16x32_bf16 v[220:223], a[240:243], v[204:207], 0
v_mfma_f32_16x16x32_bf16 v[112:115], a[244:247], v[180:183], 0
s_nop 5
v_max3_f32 v240, v108, v109, v110
v_max3_f32 v241, -v108, -v109, -v110
v_mfma_f32_16x16x32_bf16 v[224:227], a[244:247], v[204:207], 0
buffer_load_dwordx4 v[124:127], v248, s[4:7], s100 offen sc1
v_max3_f32 v242, v220, v221, v222
v_max3_f32 v243, -v220, -v221, -v222
v_max3_f32 v240, v240, v111, v112
v_max3_f32 v241, v241, -v111, -v112
v_max3_f32 v240, v240, v113, v114
s_nop 1
v_max3_f32 v242, v242, v223, v224
v_max3_f32 v243, v243, -v223, -v224
v_max3_f32 v241, v241, -v113, -v114
v_max3_f32 v242, v242, v225, v226
v_max3_f32 v243, v243, -v225, -v226
v_max_f32 v240, v240, v115
v_max_f32_e64 v241, v241, -v115
v_max_f32 v242, v242, v227
buffer_load_dwordx4 v[52:55], v1, s[4:7], s98 offen offset:1024 sc1
v_max_f32_e64 v243, v243, -v227
v_permlane32_swap_b32 v240, v241
s_nop 0
v_permlane32_swap_b32 v242, v243
v_max_f32 v240, v240, v241
v_max_f32 v242, v242, v243
v_mov_b32 v246, v240
v_mov_b32 v247, v242
s_nop 0
v_permlane16_swap_b32 v240, v246
v_permlane16_swap_b32 v242, v247
buffer_load_dwordx4 v[56:59], v1, s[4:7], s98 offen offset:2048 sc1
v_max_f32 v240, v240, v246
v_max_f32 v242, v242, v247
v_mov_b32 v246, v240
v_mov_b32 v247, v242
s_nop 0
v_permlane32_swap_b32 v240, v246
v_permlane32_swap_b32 v242, v247
v_mul_f32_e64 v240, -v240, v86
v_mul_f32_e64 v241, -v246, v86
v_mul_f32_e64 v242, -v242, v88
v_mul_f32_e64 v243, -v247, v88
buffer_load_dwordx4 v[60:63], v1, s[4:7], s98 offen offset:3072 sc1
v_pk_fma_f32 v[116:117], v[108:109], v[86:87], v[240:241] op_sel:[0,0,0] op_sel_hi:[1,0,0]
v_pk_fma_f32 v[118:119], v[110:111], v[86:87], v[240:241] op_sel:[0,0,0] op_sel_hi:[1,0,0]
v_pk_fma_f32 v[120:121], v[112:113], v[86:87], v[240:241] op_sel:[0,0,0] op_sel_hi:[1,0,0]
v_pk_fma_f32 v[122:123], v[114:115], v[86:87], v[240:241] op_sel:[0,0,0] op_sel_hi:[1,0,0]
v_pk_fma_f32 v[196:197], v[220:221], v[88:89], v[242:243] op_sel:[0,0,0] op_sel_hi:[1,0,0]
v_pk_fma_f32 v[198:199], v[222:223], v[88:89], v[242:243] op_sel:[0,0,0] op_sel_hi:[1,0,0]
v_pk_fma_f32 v[200:201], v[224:225], v[88:89], v[242:243] op_sel:[0,0,0] op_sel_hi:[1,0,0]
v_pk_fma_f32 v[202:203], v[226:227], v[88:89], v[242:243] op_sel:[0,0,0] op_sel_hi:[1,0,0]
v_pk_fma_f32 v[108:109], v[108:109], v[86:87], v[240:241] op_sel:[0,0,1] op_sel_hi:[1,0,1] neg_lo:[1,0,0] neg_hi:[1,0,0]
v_pk_fma_f32 v[110:111], v[110:111], v[86:87], v[240:241] op_sel:[0,0,1] op_sel_hi:[1,0,1] neg_lo:[1,0,0] neg_hi:[1,0,0]
v_pk_fma_f32 v[112:113], v[112:113], v[86:87], v[240:241] op_sel:[0,0,1] op_sel_hi:[1,0,1] neg_lo:[1,0,0] neg_hi:[1,0,0]
v_pk_fma_f32 v[114:115], v[114:115], v[86:87], v[240:241] op_sel:[0,0,1] op_sel_hi:[1,0,1] neg_lo:[1,0,0] neg_hi:[1,0,0]
v_pk_fma_f32 v[220:221], v[220:221], v[88:89], v[242:243] op_sel:[0,0,1] op_sel_hi:[1,0,1] neg_lo:[1,0,0] neg_hi:[1,0,0]
buffer_load_dwordx4 v[64:67], v1, s[4:7], s99 offen offset:0 sc1
v_pk_fma_f32 v[222:223], v[222:223], v[88:89], v[242:243] op_sel:[0,0,1] op_sel_hi:[1,0,1] neg_lo:[1,0,0] neg_hi:[1,0,0]
v_pk_fma_f32 v[224:225], v[224:225], v[88:89], v[242:243] op_sel:[0,0,1] op_sel_hi:[1,0,1] neg_lo:[1,0,0] neg_hi:[1,0,0]
v_pk_fma_f32 v[226:227], v[226:227], v[88:89], v[242:243] op_sel:[0,0,1] op_sel_hi:[1,0,1] neg_lo:[1,0,0] neg_hi:[1,0,0]
v_exp_f32 v116, v116
v_exp_f32 v108, v108
v_exp_f32 v117, v117
v_exp_f32 v109, v109
v_exp_f32 v118, v118
buffer_load_dwordx4 v[68:71], v1, s[4:7], s99 offen offset:1024 sc1
v_exp_f32 v110, v110
v_exp_f32 v119, v119
v_exp_f32 v111, v111
v_exp_f32 v120, v120
v_exp_f32 v112, v112
v_exp_f32 v121, v121
v_exp_f32 v113, v113
buffer_load_dwordx4 v[100:103], v1, s[4:7], s99 offen offset:2048 sc1
v_exp_f32 v122, v122
v_exp_f32 v114, v114
v_exp_f32 v123, v123
v_exp_f32 v115, v115
v_exp_f32 v196, v196
v_exp_f32 v220, v220
v_exp_f32 v197, v197
buffer_load_dwordx4 v[104:107], v1, s[4:7], s99 offen offset:3072 sc1
v_exp_f32 v221, v221
v_exp_f32 v198, v198
v_exp_f32 v222, v222
v_exp_f32 v199, v199
v_exp_f32 v223, v223
v_exp_f32 v200, v200
v_exp_f32 v224, v224
v_exp_f32 v201, v201
v_exp_f32 v225, v225
v_exp_f32 v202, v202
v_exp_f32 v226, v226
v_exp_f32 v203, v203
v_exp_f32 v227, v227
v_cvt_pk_bf16_f32 v188, v116, v117
v_cvt_pk_bf16_f32 v189, v118, v119
v_cvt_pk_bf16_f32 v190, v120, v121
v_cvt_pk_bf16_f32 v191, v122, v123
v_cvt_pk_bf16_f32 v192, v108, v109
v_cvt_pk_bf16_f32 v193, v110, v111
v_cvt_pk_bf16_f32 v194, v112, v113
v_cvt_pk_bf16_f32 v195, v114, v115
v_cvt_pk_bf16_f32 v212, v196, v197
v_cvt_pk_bf16_f32 v213, v198, v199
v_cvt_pk_bf16_f32 v214, v200, v201
v_cvt_pk_bf16_f32 v215, v202, v203
v_cvt_pk_bf16_f32 v216, v220, v221
v_cvt_pk_bf16_f32 v217, v222, v223
v_cvt_pk_bf16_f32 v218, v224, v225
v_cvt_pk_bf16_f32 v219, v226, v227
s_waitcnt vmcnt(8)
v_lshlrev_b32 v92, 16, v48
v_and_b32 v93, 0xffff0000, v48
v_lshlrev_b32 v94, 16, v49
v_and_b32 v95, 0xffff0000, v49
v_lshlrev_b32 v96, 16, v50
v_and_b32 v97, 0xffff0000, v50
v_lshlrev_b32 v98, 16, v51
v_and_b32 v99, 0xffff0000, v51
s_waitcnt vmcnt(7)
v_add_f32_dpp v128, v124, v124 row_ror:4 row_mask:0xf bank_mask:0xf
v_add_f32_dpp v129, v125, v125 row_ror:4 row_mask:0xf bank_mask:0xf
v_add_f32_dpp v130, v126, v126 row_ror:4 row_mask:0xf bank_mask:0xf
v_add_f32_dpp v131, v127, v127 row_ror:4 row_mask:0xf bank_mask:0xf
v_add_f32_dpp v128, v128, v128 row_ror:2 row_mask:0xf bank_mask:0xf
v_add_f32_dpp v129, v129, v129 row_ror:2 row_mask:0xf bank_mask:0xf
v_add_f32_dpp v130, v130, v130 row_ror:2 row_mask:0xf bank_mask:0xf
v_add_f32_dpp v131, v131, v131 row_ror:2 row_mask:0xf bank_mask:0xf
v_add_f32_dpp v128, v128, v128 row_ror:1 row_mask:0xf bank_mask:0xf
v_add_f32_dpp v129, v129, v129 row_ror:1 row_mask:0xf bank_mask:0xf
v_add_f32_dpp v130, v130, v130 row_ror:1 row_mask:0xf bank_mask:0xf
v_add_f32_dpp v131, v131, v131 row_ror:1 row_mask:0xf bank_mask:0xf
v_fma_f32 v135, v129, v130, v131
s_waitcnt vmcnt(6)
v_dot2c_f32_bf16 v92, v52, v249
v_dot2c_f32_bf16 v93, v52, v250
v_dot2c_f32_bf16 v94, v53, v249
v_dot2c_f32_bf16 v95, v53, v250
v_dot2c_f32_bf16 v96, v54, v249
v_dot2c_f32_bf16 v97, v54, v250
v_dot2c_f32_bf16 v98, v55, v249
v_dot2c_f32_bf16 v99, v55, v250
s_waitcnt vmcnt(5)
v_dot2c_f32_bf16 v92, v56, v249
v_dot2c_f32_bf16 v93, v56, v250
v_dot2c_f32_bf16 v94, v57, v249
v_dot2c_f32_bf16 v95, v57, v250
v_dot2c_f32_bf16 v96, v58, v249
v_dot2c_f32_bf16 v97, v58, v250
v_dot2c_f32_bf16 v98, v59, v249
v_dot2c_f32_bf16 v99, v59, v250
s_waitcnt vmcnt(4)
v_dot2c_f32_bf16 v92, v60, v249
v_dot2c_f32_bf16 v93, v60, v250
v_dot2c_f32_bf16 v94, v61, v249
v_dot2c_f32_bf16 v95, v61, v250
v_dot2c_f32_bf16 v96, v62, v249
v_dot2c_f32_bf16 v97, v62, v250
v_dot2c_f32_bf16 v98, v63, v249
v_dot2c_f32_bf16 v99, v63, v250
s_waitcnt vmcnt(3)
v_dot2c_f32_bf16 v92, v64, v249
v_dot2c_f32_bf16 v93, v64, v250
v_dot2c_f32_bf16 v94, v65, v249
v_dot2c_f32_bf16 v95, v65, v250
v_dot2c_f32_bf16 v96, v66, v249
v_dot2c_f32_bf16 v97, v66, v250
v_dot2c_f32_bf16 v98, v67, v249
v_dot2c_f32_bf16 v99, v67, v250
s_waitcnt vmcnt(2)
v_dot2c_f32_bf16 v92, v68, v249
v_dot2c_f32_bf16 v93, v68, v250
v_dot2c_f32_bf16 v94, v69, v249
v_dot2c_f32_bf16 v95, v69, v250
v_dot2c_f32_bf16 v96, v70, v249
v_dot2c_f32_bf16 v97, v70, v250
v_dot2c_f32_bf16 v98, v71, v249
v_dot2c_f32_bf16 v99, v71, v250
s_waitcnt vmcnt(1)
v_dot2c_f32_bf16 v92, v100, v249
v_dot2c_f32_bf16 v93, v100, v250
v_dot2c_f32_bf16 v94, v101, v249
v_dot2c_f32_bf16 v95, v101, v250
v_dot2c_f32_bf16 v96, v102, v249
v_dot2c_f32_bf16 v97, v102, v250
v_dot2c_f32_bf16 v98, v103, v249
v_dot2c_f32_bf16 v99, v103, v250
s_waitcnt vmcnt(0)
v_dot2c_f32_bf16 v92, v104, v249
v_dot2c_f32_bf16 v93, v104, v250
v_dot2c_f32_bf16 v94, v105, v249
v_dot2c_f32_bf16 v95, v105, v250
v_dot2c_f32_bf16 v96, v106, v249
v_dot2c_f32_bf16 v97, v106, v250
v_dot2c_f32_bf16 v98, v107, v249
v_dot2c_f32_bf16 v99, v107, v250
v_fma_f32 v132, v92, v93, v94
v_fma_f32 v133, v95, v96, v97
s_nop 0
v_fma_f32 v134, v98, v99, v128
v_fma_f32 v132, v132, v133, v134
v_cmp_u_f32 vcc, v132, v135
s_cbranch_vccnz L_kvredo3
L_kvback3:
v_cvt_pk_bf16_f32 v128, v128, v129
v_cvt_pk_bf16_f32 v129, v130, v131
v_cvt_pk_bf16_f32 v92, v92, v93
v_cndmask_b32 v128, 0, v128, s[56:57]
v_cndmask_b32 v129, 0, v129, s[56:57]
v_cvt_pk_bf16_f32 v93, v94, v95
v_cvt_pk_bf16_f32 v94, v96, v97
v_cvt_pk_bf16_f32 v95, v98, v99
v_cndmask_b32 v128, v128, v16, s[58:59]
v_cndmask_b32 v129, v129, v16, s[58:59]
ds_write_b64 v252, v[92:93] offset:0
ds_write_b64 v252, v[94:95] offset:1024
ds_write_b64 v252, v[128:129] offset:2048
s_waitcnt lgkmcnt(0)
s_barrier
ds_read_b128 a[8:11], v1 offset:2048
ds_read_b128 a[20:23], v1 offset:5120
ds_read_b128 a[0:3], v1 offset:0
ds_read_b128 a[12:15], v1 offset:3072
ds_read_b128 a[4:7], v1 offset:1024
ds_read_b128 a[16:19], v1 offset:4096
s_waitcnt lgkmcnt(5)
v_mfma_f32_16x16x32_bf16 v[116:119], a[8:11], v[212:215], 0
s_waitcnt lgkmcnt(4)
v_mfma_f32_16x16x32_bf16 v[120:123], a[20:23], v[216:219], 0
s_waitcnt lgkmcnt(3)
v_mfma_f32_16x16x32_bf16 v[204:207], a[0:3], v[212:215], 0
s_nop 3
v_rcp_f32 v118, v117
s_waitcnt lgkmcnt(2)
v_mfma_f32_16x16x32_bf16 v[220:223], a[12:15], v[216:219], 0
v_rcp_f32 v119, v121
v_mul_f32 v116, v116, v118
v_fmac_f32 v116, v120, v119
v_mfma_f32_16x16x32_bf16 v[100:103], a[8:11], v[164:167], 0
v_add_f32 v116, 0x358637bd, v116
v_rcp_f32 v116, v116
s_waitcnt lgkmcnt(1)
v_mfma_f32_16x16x32_bf16 v[208:211], a[4:7], v[212:215], 0
v_mul_f32 v118, v118, v116
v_mul_f32 v119, v119, v116
v_mfma_f32_16x16x32_bf16 v[104:107], a[20:23], v[168:171], 0
v_mul_f32 v204, v204, v118
v_mul_f32 v205, v205, v118
s_waitcnt lgkmcnt(0)
v_mfma_f32_16x16x32_bf16 v[224:227], a[16:19], v[216:219], 0
v_mul_f32 v206, v206, v118
v_mul_f32 v207, v207, v118
v_fmac_f32 v204, v220, v119
v_fmac_f32 v205, v221, v119
v_rcp_f32 v102, v101
v_mul_f32 v208, v208, v118
v_mul_f32 v209, v209, v118
v_mul_f32 v210, v210, v118
v_mul_f32 v211, v211, v118
v_fmac_f32 v206, v222, v119
v_fmac_f32 v207, v223, v119
v_cvt_pk_bf16_f32 v204, v204, v205
v_rcp_f32 v103, v105
v_fmac_f32 v208, v224, v119
v_fmac_f32 v209, v225, v119
v_fmac_f32 v210, v226, v119
v_fmac_f32 v211, v227, v119
v_cvt_pk_bf16_f32 v205, v206, v207
v_cvt_pk_bf16_f32 v206, v208, v209
v_cvt_pk_bf16_f32 v207, v210, v211
v_mul_f32 v100, v100, v102
v_mfma_f32_16x16x32_bf16 v[156:159], a[0:3], v[164:167], 0
buffer_store_dwordx4 v[204:207], v2, s[4:7], s72 offen offset:3072 sc1
v_fmac_f32 v100, v104, v103
v_mfma_f32_16x16x32_bf16 v[172:175], a[12:15], v[168:171], 0
v_add_f32 v100, 0x358637bd, v100
v_rcp_f32 v100, v100
v_mfma_f32_16x16x32_bf16 v[108:111], a[8:11], v[188:191], 0
v_mul_f32 v102, v102, v100
v_mul_f32 v103, v103, v100
v_mfma_f32_16x16x32_bf16 v[160:163], a[4:7], v[164:167], 0
v_mul_f32 v156, v156, v102
v_mul_f32 v157, v157, v102
v_mfma_f32_16x16x32_bf16 v[112:115], a[20:23], v[192:195], 0
v_mul_f32 v158, v158, v102
v_mul_f32 v159, v159, v102
v_mfma_f32_16x16x32_bf16 v[176:179], a[16:19], v[168:171], 0
v_fmac_f32 v156, v172, v103
v_fmac_f32 v157, v173, v103
v_rcp_f32 v110, v109
v_mul_f32 v160, v160, v102
v_mul_f32 v161, v161, v102
v_mul_f32 v162, v162, v102
v_mul_f32 v163, v163, v102
v_fmac_f32 v158, v174, v103
v_fmac_f32 v159, v175, v103
v_cvt_pk_bf16_f32 v156, v156, v157
v_rcp_f32 v111, v113
v_fmac_f32 v160, v176, v103
v_fmac_f32 v161, v177, v103
v_fmac_f32 v162, v178, v103
v_fmac_f32 v163, v179, v103
v_cvt_pk_bf16_f32 v157, v158, v159
v_cvt_pk_bf16_f32 v158, v160, v161
v_cvt_pk_bf16_f32 v159, v162, v163
v_mul_f32 v108, v108, v110
v_mfma_f32_16x16x32_bf16 v[180:183], a[0:3], v[188:191], 0
buffer_store_dwordx4 v[156:159], v2, s[4:7], s72 offen offset:1024 sc1
v_fmac_f32 v108, v112, v111
v_mfma_f32_16x16x32_bf16 v[196:199], a[12:15], v[192:195], 0
v_add_f32 v108, 0x358637bd, v108
v_rcp_f32 v108, v108
v_mfma_f32_16x16x32_bf16 v[92:95], a[8:11], v[140:143], 0
v_mul_f32 v110, v110, v108
v_mul_f32 v111, v111, v108
v_mfma_f32_16x16x32_bf16 v[184:187], a[4:7], v[188:191], 0
v_mul_f32 v180, v180, v110
v_mul_f32 v181, v181, v110
v_mfma_f32_16x16x32_bf16 v[96:99], a[20:23], v[144:147], 0
v_mul_f32 v182, v182, v110
v_mul_f32 v183, v183, v110
v_mfma_f32_16x16x32_bf16 v[200:203], a[16:19], v[192:195], 0
v_fmac_f32 v180, v196, v111
v_fmac_f32 v181, v197, v111
v_rcp_f32 v94, v93
v_mul_f32 v184, v184, v110
v_mul_f32 v185, v185, v110
v_mul_f32 v186, v186, v110
v_mul_f32 v187, v187, v110
v_fmac_f32 v182, v198, v111
v_fmac_f32 v183, v199, v111
v_cvt_pk_bf16_f32 v180, v180, v181
v_rcp_f32 v95, v97
buffer_atomic_add v12, v10, s[4:7], s74 offen sc1
v_fmac_f32 v184, v200, v111
v_fmac_f32 v185, v201, v111
v_fmac_f32 v186, v202, v111
v_fmac_f32 v187, v203, v111
v_cvt_pk_bf16_f32 v181, v182, v183
v_cvt_pk_bf16_f32 v182, v184, v185
v_cvt_pk_bf16_f32 v183, v186, v187
v_mul_f32 v92, v92, v94
v_mfma_f32_16x16x32_bf16 v[132:135], a[0:3], v[140:143], 0
buffer_store_dwordx4 v[180:183], v2, s[4:7], s72 offen offset:2048 sc1
v_fmac_f32 v92, v96, v95
v_mfma_f32_16x16x32_bf16 v[148:151], a[12:15], v[144:147], 0
v_add_f32 v92, 0x358637bd, v92
v_rcp_f32 v92, v92
v_mfma_f32_16x16x32_bf16 v[136:139], a[4:7], v[140:143], 0
v_mul_f32 v94, v94, v92
v_mul_f32 v95, v95, v92
v_mfma_f32_16x16x32_bf16 v[152:155], a[16:19], v[144:147], 0
v_mul_f32 v132, v132, v94
v_mul_f32 v133, v133, v94
v_mul_f32 v134, v134, v94
v_mul_f32 v135, v135, v94
v_fmac_f32 v132, v148, v95
L_stub19:
s_cbranch_execz L_wret6
v_fmac_f32 v133, v149, v95
v_mul_f32 v136, v136, v94
v_mul_f32 v137, v137, v94
v_mul_f32 v138, v138, v94
v_mul_f32 v139, v139, v94
v_fmac_f32 v134, v150, v95
v_fmac_f32 v135, v151, v95
v_cvt_pk_bf16_f32 v132, v132, v133
v_fmac_f32 v136, v152, v95
v_fmac_f32 v137, v153, v95
v_fmac_f32 v138, v154, v95
v_fmac_f32 v139, v155, v95
v_cvt_pk_bf16_f32 v133, v134, v135
v_cvt_pk_bf16_f32 v134, v136, v137
v_cvt_pk_bf16_f32 v135, v138, v139
buffer_store_dwordx4 v[132:135], v2, s[4:7], s72 offen offset:0 sc1
s_add_u32 s92, s71, 0x30000
s_add_u32 s36, s66, 0x30080
s_add_u32 s40, s4, 0x2600000
s_addc_u32 s41, s5, 0
v_add_u32 v5, 32768, v1
v_add_u32 v6, 98304, v1
s_cmp_eq_u32 s3, 0
s_cselect_b32 s35, 8, 0
s_lshl_b32 s35, s35, 12
v_lshlrev_b32 v132, 16, v32
v_and_b32 v133, 0xffff0000, v32
v_lshlrev_b32 v134, 16, v33
v_and_b32 v135, 0xffff0000, v33
v_lshlrev_b32 v136, 16, v34
v_and_b32 v137, 0xffff0000, v34
v_lshlrev_b32 v138, 16, v35
v_and_b32 v139, 0xffff0000, v35
v_lshlrev_b32 v140, 16, v36
v_and_b32 v141, 0xffff0000, v36
v_lshlrev_b32 v142, 16, v37
v_and_b32 v143, 0xffff0000, v37
v_lshlrev_b32 v144, 16, v38
v_and_b32 v145, 0xffff0000, v38
v_lshlrev_b32 v146, 16, v39
v_and_b32 v147, 0xffff0000, v39
v_lshlrev_b32 v148, 16, v40
v_and_b32 v149, 0xffff0000, v40
v_lshlrev_b32 v150, 16, v41
v_and_b32 v151, 0xffff0000, v41
v_lshlrev_b32 v152, 16, v42
v_and_b32 v153, 0xffff0000, v42
v_lshlrev_b32 v154, 16, v43
v_and_b32 v155, 0xffff0000, v43
v_lshlrev_b32 v156, 16, v44
v_and_b32 v157, 0xffff0000, v44
v_lshlrev_b32 v158, 16, v45
v_and_b32 v159, 0xffff0000, v45
v_lshlrev_b32 v160, 16, v46
v_and_b32 v161, 0xffff0000, v46
v_lshlrev_b32 v162, 16, v47
v_and_b32 v163, 0xffff0000, v47
s_mov_b32 s95, -1
s_mov_b64 exec, 0
s_cmp_eq_u32 s28, 3
s_cbranch_scc1 L_stub20
s_cmp_eq_u32 s28, 2
s_cbranch_scc1 L_wret7
L_wret7:
s_mov_b64 exec, -1
s_cmp_lg_u32 s28, 0
s_cbranch_scc1 Lpo_44
s_add_u32 s36, s66, 0x30080
s_mov_b32 s37, 0
v_mov_b32 v11, 0
buffer_atomic_add v11, v251, s[4:7], s36 offen sc0 sc1
s_sleep 4
Lpoll_42:
v_mov_b32 v234, 0
buffer_atomic_add v234, v251, s[4:7], s36 offen sc0 sc1
s_waitcnt vmcnt(1)
v_readfirstlane_b32 s38, v11
s_nop 0
s_cmp_ge_u32 s38, 32
s_cbranch_scc1 Lpe_43
v_mov_b32 v11, 0
buffer_atomic_add v11, v251, s[4:7], s36 offen sc0 sc1
s_waitcnt vmcnt(1)
v_readfirstlane_b32 s38, v234
s_nop 0
s_cmp_ge_u32 s38, 32
s_cbranch_scc1 Lpe_43
s_add_u32 s37, s37, 1
s_cmp_lt_u32 s37, 0x80000
s_cbranch_scc1 Lpoll_42
s_waitcnt vmcnt(0)
Lpo_44:
s_waitcnt vmcnt(0)
Lpe_43:
s_barrier
L_k2go3:
buffer_load_dwordx4 a[0:3], v4, s[40:43], s35 offen offset:0 sc1
buffer_load_dwordx4 a[4:7], v4, s[40:43], s35 offen offset:1024 sc1
s_cmp_eq_u32 s3, 1
s_cselect_b32 s35, 9, 1
s_lshl_b32 s35, s35, 12
buffer_load_dwordx4 a[8:11], v4, s[40:43], s35 offen offset:0 sc1
buffer_load_dwordx4 a[12:15], v4, s[40:43], s35 offen offset:1024 sc1
s_cmp_eq_u32 s3, 2
s_cselect_b32 s35, 10, 2
s_lshl_b32 s35, s35, 12
buffer_load_dwordx4 a[16:19], v4, s[40:43], s35 offen offset:0 sc1
buffer_load_dwordx4 a[20:23], v4, s[40:43], s35 offen offset:1024 sc1
s_cmp_eq_u32 s3, 3
s_cselect_b32 s35, 11, 3
s_lshl_b32 s35, s35, 12
buffer_load_dwordx4 a[24:27], v4, s[40:43], s35 offen offset:0 sc1
buffer_load_dwordx4 a[28:31], v4, s[40:43], s35 offen offset:1024 sc1
s_cmp_eq_u32 s3, 4
s_cselect_b32 s35, 12, 4
s_lshl_b32 s35, s35, 12
buffer_load_dwordx4 a[32:35], v4, s[40:43], s35 offen offset:0 sc1
buffer_load_dwordx4 a[36:39], v4, s[40:43], s35 offen offset:1024 sc1
s_cmp_eq_u32 s3, 5
s_cselect_b32 s35, 13, 5
s_lshl_b32 s35, s35, 12
ds_read_b128 a[96:99], v5 offset:0
ds_read_b128 a[100:103], v5 offset:1024
ds_read_b128 a[104:107], v5 offset:2048
ds_read_b128 a[108:111], v5 offset:3072
ds_read_b128 a[112:115], v5 offset:4096
ds_read_b128 a[116:119], v5 offset:5120
ds_read_b128 a[120:123], v5 offset:6144
ds_read_b128 a[124:127], v5 offset:7168
s_waitcnt vmcnt(8) lgkmcnt(4)
v_mfma_f32_16x16x32_bf16 v[132:135], a[96:99], a[0:3], v[132:135]
ds_read_b128 a[128:131], v5 offset:8192
v_mfma_f32_16x16x32_bf16 v[148:151], a[96:99], a[4:7], v[148:151]
ds_read_b128 a[132:135], v5 offset:9216
v_mfma_f32_16x16x32_bf16 v[152:155], a[100:103], a[4:7], v[152:155]
buffer_load_dwordx4 a[40:43], v4, s[40:43], s35 offen offset:0 sc1
v_mfma_f32_16x16x32_bf16 v[136:139], a[100:103], a[0:3], v[136:139]
ds_read_b128 a[136:139], v5 offset:10240
v_mfma_f32_16x16x32_bf16 v[140:143], a[104:107], a[0:3], v[140:143]
ds_read_b128 a[140:143], v5 offset:11264
v_mfma_f32_16x16x32_bf16 v[156:159], a[104:107], a[4:7], v[156:159]
v_mfma_f32_16x16x32_bf16 v[160:163], a[108:111], a[4:7], v[160:163]
buffer_load_dwordx4 a[44:47], v4, s[40:43], s35 offen offset:1024 sc1
v_mfma_f32_16x16x32_bf16 v[144:147], a[108:111], a[0:3], v[144:147]
s_waitcnt vmcnt(8) lgkmcnt(4)
v_mfma_f32_16x16x32_bf16 v[132:135], a[112:115], a[8:11], v[132:135]
s_cmp_eq_u32 s3, 6
s_cselect_b32 s35, 14, 6
s_lshl_b32 s35, s35, 12
v_mfma_f32_16x16x32_bf16 v[148:151], a[112:115], a[12:15], v[148:151]
ds_read_b128 a[96:99], v5 offset:12288
v_mfma_f32_16x16x32_bf16 v[152:155], a[116:119], a[12:15], v[152:155]
buffer_load_dwordx4 a[0:3], v4, s[40:43], s35 offen offset:0 sc1
v_mfma_f32_16x16x32_bf16 v[136:139], a[116:119], a[8:11], v[136:139]
ds_read_b128 a[100:103], v5 offset:13312
v_mfma_f32_16x16x32_bf16 v[140:143], a[120:123], a[8:11], v[140:143]
ds_read_b128 a[104:107], v5 offset:14336
v_mfma_f32_16x16x32_bf16 v[156:159], a[120:123], a[12:15], v[156:159]
ds_read_b128 a[108:111], v5 offset:15360
v_mfma_f32_16x16x32_bf16 v[160:163], a[124:127], a[12:15], v[160:163]
buffer_load_dwordx4 a[4:7], v4, s[40:43], s35 offen offset:1024 sc1
v_mfma_f32_16x16x32_bf16 v[144:147], a[124:127], a[8:11], v[144:147]
s_waitcnt vmcnt(8) lgkmcnt(4)
v_mfma_f32_16x16x32_bf16 v[132:135], a[128:131], a[16:19], v[132:135]
s_cmp_eq_u32 s3, 7
s_cselect_b32 s35, 15, 7
s_lshl_b32 s35, s35, 12
v_mfma_f32_16x16x32_bf16 v[148:151], a[128:131], a[20:23], v[148:151]
ds_read_b128 a[112:115], v5 offset:16384
v_mfma_f32_16x16x32_bf16 v[152:155], a[132:135], a[20:23], v[152:155]
buffer_load_dwordx4 a[8:11], v4, s[40:43], s35 offen offset:0 sc1
v_mfma_f32_16x16x32_bf16 v[136:139], a[132:135], a[16:19], v[136:139]
ds_read_b128 a[116:119], v5 offset:17408
v_mfma_f32_16x16x32_bf16 v[140:143], a[136:139], a[16:19], v[140:143]
ds_read_b128 a[120:123], v5 offset:18432
v_mfma_f32_16x16x32_bf16 v[156:159], a[136:139], a[20:23], v[156:159]
ds_read_b128 a[124:127], v5 offset:19456
v_mfma_f32_16x16x32_bf16 v[160:163], a[140:143], a[20:23], v[160:163]
buffer_load_dwordx4 a[12:15], v4, s[40:43], s35 offen offset:1024 sc1
v_mfma_f32_16x16x32_bf16 v[144:147], a[140:143], a[16:19], v[144:147]
s_waitcnt vmcnt(8) lgkmcnt(4)
v_mfma_f32_16x16x32_bf16 v[132:135], a[96:99], a[24:27], v[132:135]
s_cmp_eq_u32 s3, 0
s_cselect_b32 s35, 16, 8
s_lshl_b32 s35, s35, 12
v_mfma_f32_16x16x32_bf16 v[148:151], a[96:99], a[28:31], v[148:151]
ds_read_b128 a[128:131], v5 offset:20480
v_mfma_f32_16x16x32_bf16 v[152:155], a[100:103], a[28:31], v[152:155]
buffer_load_dwordx4 a[16:19], v4, s[40:43], s35 offen offset:0 sc1
v_mfma_f32_16x16x32_bf16 v[136:139], a[100:103], a[24:27], v[136:139]
ds_read_b128 a[132:135], v5 offset:21504
v_mfma_f32_16x16x32_bf16 v[140:143], a[104:107], a[24:27], v[140:143]
ds_read_b128 a[136:139], v5 offset:22528
v_mfma_f32_16x16x32_bf16 v[156:159], a[104:107], a[28:31], v[156:159]
ds_read_b128 a[140:143], v5 offset:23552
v_mfma_f32_16x16x32_bf16 v[160:163], a[108:111], a[28:31], v[160:163]
buffer_load_dwordx4 a[20:23], v4, s[40:43], s35 offen offset:1024 sc1
v_mfma_f32_16x16x32_bf16 v[144:147], a[108:111], a[24:27], v[144:147]
s_waitcnt vmcnt(8) lgkmcnt(4)
v_mfma_f32_16x16x32_bf16 v[132:135], a[112:115], a[32:35], v[132:135]
s_cmp_eq_u32 s3, 1
s_cselect_b32 s35, 17, 9
s_lshl_b32 s35, s35, 12
v_mfma_f32_16x16x32_bf16 v[148:151], a[112:115], a[36:39], v[148:151]
ds_read_b128 a[96:99], v5 offset:24576
v_mfma_f32_16x16x32_bf16 v[152:155], a[116:119], a[36:39], v[152:155]
buffer_load_dwordx4 a[24:27], v4, s[40:43], s35 offen offset:0 sc1
v_mfma_f32_16x16x32_bf16 v[136:139], a[116:119], a[32:35], v[136:139]
ds_read_b128 a[100:103], v5 offset:25600
v_mfma_f32_16x16x32_bf16 v[140:143], a[120:123], a[32:35], v[140:143]
ds_read_b128 a[104:107], v5 offset:26624
v_mfma_f32_16x16x32_bf16 v[156:159], a[120:123], a[36:39], v[156:159]
ds_read_b128 a[108:111], v5 offset:27648
v_mfma_f32_16x16x32_bf16 v[160:163], a[124:127], a[36:39], v[160:163]
buffer_load_dwordx4 a[28:31], v4, s[40:43], s35 offen offset:1024 sc1
v_mfma_f32_16x16x32_bf16 v[144:147], a[124:127], a[32:35], v[144:147]
s_waitcnt vmcnt(8) lgkmcnt(4)
v_mfma_f32_16x16x32_bf16 v[132:135], a[128:131], a[40:43], v[132:135]
s_cmp_eq_u32 s3, 2
s_cselect_b32 s35, 18, 10
s_lshl_b32 s35, s35, 12
v_mfma_f32_16x16x32_bf16 v[148:151], a[128:131], a[44:47], v[148:151]
ds_read_b128 a[112:115], v5 offset:28672
v_mfma_f32_16x16x32_bf16 v[152:155], a[132:135], a[44:47], v[152:155]
buffer_load_dwordx4 a[32:35], v4, s[40:43], s35 offen offset:0 sc1
v_mfma_f32_16x16x32_bf16 v[136:139], a[132:135], a[40:43], v[136:139]
ds_read_b128 a[116:119], v5 offset:29696
v_mfma_f32_16x16x32_bf16 v[140:143], a[136:139], a[40:43], v[140:143]
ds_read_b128 a[120:123], v5 offset:30720
v_mfma_f32_16x16x32_bf16 v[156:159], a[136:139], a[44:47], v[156:159]
ds_read_b128 a[124:127], v5 offset:31744
v_mfma_f32_16x16x32_bf16 v[160:163], a[140:143], a[44:47], v[160:163]
buffer_load_dwordx4 a[36:39], v4, s[40:43], s35 offen offset:1024 sc1
v_mfma_f32_16x16x32_bf16 v[144:147], a[140:143], a[40:43], v[144:147]
s_waitcnt vmcnt(8) lgkmcnt(4)
v_mfma_f32_16x16x32_bf16 v[132:135], a[96:99], a[0:3], v[132:135]
s_cmp_eq_u32 s3, 3
s_cselect_b32 s35, 19, 11
s_lshl_b32 s35, s35, 12
v_mfma_f32_16x16x32_bf16 v[148:151], a[96:99], a[4:7], v[148:151]
ds_read_b128 a[128:131], v5 offset:32768
v_mfma_f32_16x16x32_bf16 v[152:155], a[100:103], a[4:7], v[152:155]
buffer_load_dwordx4 a[40:43], v4, s[40:43], s35 offen offset:0 sc1
v_mfma_f32_16x16x32_bf16 v[136:139], a[100:103], a[0:3], v[136:139]
ds_read_b128 a[132:135], v5 offset:33792
v_mfma_f32_16x16x32_bf16 v[140:143], a[104:107], a[0:3], v[140:143]
ds_read_b128 a[136:139], v5 offset:34816
v_mfma_f32_16x16x32_bf16 v[156:159], a[104:107], a[4:7], v[156:159]
ds_read_b128 a[140:143], v5 offset:35840
v_mfma_f32_16x16x32_bf16 v[160:163], a[108:111], a[4:7], v[160:163]
buffer_load_dwordx4 a[44:47], v4, s[40:43], s35 offen offset:1024 sc1
v_mfma_f32_16x16x32_bf16 v[144:147], a[108:111], a[0:3], v[144:147]
s_waitcnt vmcnt(8) lgkmcnt(4)
v_mfma_f32_16x16x32_bf16 v[132:135], a[112:115], a[8:11], v[132:135]
s_cmp_eq_u32 s3, 4
s_cselect_b32 s35, 20, 12
s_lshl_b32 s35, s35, 12
v_mfma_f32_16x16x32_bf16 v[148:151], a[112:115], a[12:15], v[148:151]
ds_read_b128 a[96:99], v5 offset:36864
v_mfma_f32_16x16x32_bf16 v[152:155], a[116:119], a[12:15], v[152:155]
buffer_load_dwordx4 a[0:3], v4, s[40:43], s35 offen offset:0 sc1
v_mfma_f32_16x16x32_bf16 v[136:139], a[116:119], a[8:11], v[136:139]
ds_read_b128 a[100:103], v5 offset:37888
v_mfma_f32_16x16x32_bf16 v[140:143], a[120:123], a[8:11], v[140:143]
ds_read_b128 a[104:107], v5 offset:38912
v_mfma_f32_16x16x32_bf16 v[156:159], a[120:123], a[12:15], v[156:159]
ds_read_b128 a[108:111], v5 offset:39936
v_mfma_f32_16x16x32_bf16 v[160:163], a[124:127], a[12:15], v[160:163]
buffer_load_dwordx4 a[4:7], v4, s[40:43], s35 offen offset:1024 sc1
v_mfma_f32_16x16x32_bf16 v[144:147], a[124:127], a[8:11], v[144:147]
s_waitcnt vmcnt(8) lgkmcnt(4)
v_mfma_f32_16x16x32_bf16 v[132:135], a[128:131], a[16:19], v[132:135]
s_cmp_eq_u32 s3, 5
s_cselect_b32 s35, 21, 13
s_lshl_b32 s35, s35, 12
v_mfma_f32_16x16x32_bf16 v[148:151], a[128:131], a[20:23], v[148:151]
ds_read_b128 a[112:115], v5 offset:40960
v_mfma_f32_16x16x32_bf16 v[152:155], a[132:135], a[20:23], v[152:155]
buffer_load_dwordx4 a[8:11], v4, s[40:43], s35 offen offset:0 sc1
v_mfma_f32_16x16x32_bf16 v[136:139], a[132:135], a[16:19], v[136:139]
ds_read_b128 a[116:119], v5 offset:41984
v_mfma_f32_16x16x32_bf16 v[140:143], a[136:139], a[16:19], v[140:143]
ds_read_b128 a[120:123], v5 offset:43008
v_mfma_f32_16x16x32_bf16 v[156:159], a[136:139], a[20:23], v[156:159]
ds_read_b128 a[124:127], v5 offset:44032
v_mfma_f32_16x16x32_bf16 v[160:163], a[140:143], a[20:23], v[160:163]
buffer_load_dwordx4 a[12:15], v4, s[40:43], s35 offen offset:1024 sc1
v_mfma_f32_16x16x32_bf16 v[144:147], a[140:143], a[16:19], v[144:147]
s_waitcnt vmcnt(8) lgkmcnt(4)
v_mfma_f32_16x16x32_bf16 v[132:135], a[96:99], a[24:27], v[132:135]
s_cmp_eq_u32 s3, 6
s_cselect_b32 s35, 22, 14
s_lshl_b32 s35, s35, 12
v_mfma_f32_16x16x32_bf16 v[148:151], a[96:99], a[28:31], v[148:151]
ds_read_b128 a[128:131], v5 offset:45056
v_mfma_f32_16x16x32_bf16 v[152:155], a[100:103], a[28:31], v[152:155]
buffer_load_dwordx4 a[16:19], v4, s[40:43], s35 offen offset:0 sc1
v_mfma_f32_16x16x32_bf16 v[136:139], a[100:103], a[24:27], v[136:139]
ds_read_b128 a[132:135], v5 offset:46080
v_mfma_f32_16x16x32_bf16 v[140:143], a[104:107], a[24:27], v[140:143]
ds_read_b128 a[136:139], v5 offset:47104
v_mfma_f32_16x16x32_bf16 v[156:159], a[104:107], a[28:31], v[156:159]
ds_read_b128 a[140:143], v5 offset:48128
v_mfma_f32_16x16x32_bf16 v[160:163], a[108:111], a[28:31], v[160:163]
buffer_load_dwordx4 a[20:23], v4, s[40:43], s35 offen offset:1024 sc1
v_mfma_f32_16x16x32_bf16 v[144:147], a[108:111], a[24:27], v[144:147]
s_waitcnt vmcnt(8) lgkmcnt(4)
v_mfma_f32_16x16x32_bf16 v[132:135], a[112:115], a[32:35], v[132:135]
s_cmp_eq_u32 s3, 7
s_cselect_b32 s35, 23, 15
s_lshl_b32 s35, s35, 12
v_mfma_f32_16x16x32_bf16 v[148:151], a[112:115], a[36:39], v[148:151]
ds_read_b128 a[96:99], v5 offset:49152
v_mfma_f32_16x16x32_bf16 v[152:155], a[116:119], a[36:39], v[152:155]
buffer_load_dwordx4 a[24:27], v4, s[40:43], s35 offen offset:0 sc1
v_mfma_f32_16x16x32_bf16 v[136:139], a[116:119], a[32:35], v[136:139]
ds_read_b128 a[100:103], v5 offset:50176
v_mfma_f32_16x16x32_bf16 v[140:143], a[120:123], a[32:35], v[140:143]
ds_read_b128 a[104:107], v5 offset:51200
v_mfma_f32_16x16x32_bf16 v[156:159], a[120:123], a[36:39], v[156:159]
ds_read_b128 a[108:111], v5 offset:52224
v_mfma_f32_16x16x32_bf16 v[160:163], a[124:127], a[36:39], v[160:163]
buffer_load_dwordx4 a[28:31], v4, s[40:43], s35 offen offset:1024 sc1
v_mfma_f32_16x16x32_bf16 v[144:147], a[124:127], a[32:35], v[144:147]
s_waitcnt vmcnt(8) lgkmcnt(4)
v_mfma_f32_16x16x32_bf16 v[132:135], a[128:131], a[40:43], v[132:135]
s_cmp_eq_u32 s3, 0
s_cselect_b32 s35, 24, 16
s_lshl_b32 s35, s35, 12
v_mfma_f32_16x16x32_bf16 v[148:151], a[128:131], a[44:47], v[148:151]
ds_read_b128 a[112:115], v5 offset:53248
v_mfma_f32_16x16x32_bf16 v[152:155], a[132:135], a[44:47], v[152:155]
buffer_load_dwordx4 a[32:35], v4, s[40:43], s35 offen offset:0 sc1
v_mfma_f32_16x16x32_bf16 v[136:139], a[132:135], a[40:43], v[136:139]
ds_read_b128 a[116:119], v5 offset:54272
v_mfma_f32_16x16x32_bf16 v[140:143], a[136:139], a[40:43], v[140:143]
ds_read_b128 a[120:123], v5 offset:55296
v_mfma_f32_16x16x32_bf16 v[156:159], a[136:139], a[44:47], v[156:159]
ds_read_b128 a[124:127], v5 offset:56320
v_mfma_f32_16x16x32_bf16 v[160:163], a[140:143], a[44:47], v[160:163]
buffer_load_dwordx4 a[36:39], v4, s[40:43], s35 offen offset:1024 sc1
v_mfma_f32_16x16x32_bf16 v[144:147], a[140:143], a[40:43], v[144:147]
s_waitcnt vmcnt(8) lgkmcnt(4)
v_mfma_f32_16x16x32_bf16 v[132:135], a[96:99], a[0:3], v[132:135]
s_cmp_eq_u32 s3, 1
s_cselect_b32 s35, 25, 17
s_lshl_b32 s35, s35, 12
v_mfma_f32_16x16x32_bf16 v[148:151], a[96:99], a[4:7], v[148:151]
ds_read_b128 a[128:131], v5 offset:57344
v_mfma_f32_16x16x32_bf16 v[152:155], a[100:103], a[4:7], v[152:155]
buffer_load_dwordx4 a[40:43], v4, s[40:43], s35 offen offset:0 sc1
v_mfma_f32_16x16x32_bf16 v[136:139], a[100:103], a[0:3], v[136:139]
ds_read_b128 a[132:135], v5 offset:58368
v_mfma_f32_16x16x32_bf16 v[140:143], a[104:107], a[0:3], v[140:143]
ds_read_b128 a[136:139], v5 offset:59392
v_mfma_f32_16x16x32_bf16 v[156:159], a[104:107], a[4:7], v[156:159]
ds_read_b128 a[140:143], v5 offset:60416
v_mfma_f32_16x16x32_bf16 v[160:163], a[108:111], a[4:7], v[160:163]
buffer_load_dwordx4 a[44:47], v4, s[40:43], s35 offen offset:1024 sc1
v_mfma_f32_16x16x32_bf16 v[144:147], a[108:111], a[0:3], v[144:147]
s_waitcnt vmcnt(8) lgkmcnt(4)
v_mfma_f32_16x16x32_bf16 v[132:135], a[112:115], a[8:11], v[132:135]
s_cmp_eq_u32 s3, 2
s_cselect_b32 s35, 26, 18
s_lshl_b32 s35, s35, 12
v_mfma_f32_16x16x32_bf16 v[148:151], a[112:115], a[12:15], v[148:151]
ds_read_b128 a[96:99], v5 offset:61440
v_mfma_f32_16x16x32_bf16 v[152:155], a[116:119], a[12:15], v[152:155]
buffer_load_dwordx4 a[0:3], v4, s[40:43], s35 offen offset:0 sc1
v_mfma_f32_16x16x32_bf16 v[136:139], a[116:119], a[8:11], v[136:139]
ds_read_b128 a[100:103], v5 offset:62464
v_mfma_f32_16x16x32_bf16 v[140:143], a[120:123], a[8:11], v[140:143]
ds_read_b128 a[104:107], v5 offset:63488
v_mfma_f32_16x16x32_bf16 v[156:159], a[120:123], a[12:15], v[156:159]
ds_read_b128 a[108:111], v5 offset:64512
v_mfma_f32_16x16x32_bf16 v[160:163], a[124:127], a[12:15], v[160:163]
buffer_load_dwordx4 a[4:7], v4, s[40:43], s35 offen offset:1024 sc1
v_mfma_f32_16x16x32_bf16 v[144:147], a[124:127], a[8:11], v[144:147]
s_waitcnt vmcnt(8) lgkmcnt(4)
v_mfma_f32_16x16x32_bf16 v[132:135], a[128:131], a[16:19], v[132:135]
s_cmp_eq_u32 s3, 3
s_cselect_b32 s35, 27, 19
s_lshl_b32 s35, s35, 12
v_mfma_f32_16x16x32_bf16 v[148:151], a[128:131], a[20:23], v[148:151]
ds_read_b128 a[112:115], v6 offset:0
v_mfma_f32_16x16x32_bf16 v[152:155], a[132:135], a[20:23], v[152:155]
buffer_load_dwordx4 a[8:11], v4, s[40:43], s35 offen offset:0 sc1
v_mfma_f32_16x16x32_bf16 v[136:139], a[132:135], a[16:19], v[136:139]
ds_read_b128 a[116:119], v6 offset:1024
v_mfma_f32_16x16x32_bf16 v[140:143], a[136:139], a[16:19], v[140:143]
ds_read_b128 a[120:123], v6 offset:2048
v_mfma_f32_16x16x32_bf16 v[156:159], a[136:139], a[20:23], v[156:159]
ds_read_b128 a[124:127], v6 offset:3072
v_mfma_f32_16x16x32_bf16 v[160:163], a[140:143], a[20:23], v[160:163]
buffer_load_dwordx4 a[12:15], v4, s[40:43], s35 offen offset:1024 sc1
v_mfma_f32_16x16x32_bf16 v[144:147], a[140:143], a[16:19], v[144:147]
s_waitcnt vmcnt(8) lgkmcnt(4)
v_mfma_f32_16x16x32_bf16 v[132:135], a[96:99], a[24:27], v[132:135]
s_cmp_eq_u32 s3, 4
s_cselect_b32 s35, 28, 20
s_lshl_b32 s35, s35, 12
v_mfma_f32_16x16x32_bf16 v[148:151], a[96:99], a[28:31], v[148:151]
ds_read_b128 a[128:131], v6 offset:4096
v_mfma_f32_16x16x32_bf16 v[152:155], a[100:103], a[28:31], v[152:155]
buffer_load_dwordx4 a[16:19], v4, s[40:43], s35 offen offset:0 sc1
v_mfma_f32_16x16x32_bf16 v[136:139], a[100:103], a[24:27], v[136:139]
ds_read_b128 a[132:135], v6 offset:5120
v_mfma_f32_16x16x32_bf16 v[140:143], a[104:107], a[24:27], v[140:143]
ds_read_b128 a[136:139], v6 offset:6144
v_mfma_f32_16x16x32_bf16 v[156:159], a[104:107], a[28:31], v[156:159]
ds_read_b128 a[140:143], v6 offset:7168
v_mfma_f32_16x16x32_bf16 v[160:163], a[108:111], a[28:31], v[160:163]
buffer_load_dwordx4 a[20:23], v4, s[40:43], s35 offen offset:1024 sc1
v_mfma_f32_16x16x32_bf16 v[144:147], a[108:111], a[24:27], v[144:147]
s_waitcnt vmcnt(8) lgkmcnt(4)
v_mfma_f32_16x16x32_bf16 v[132:135], a[112:115], a[32:35], v[132:135]
s_cmp_eq_u32 s3, 5
s_cselect_b32 s35, 29, 21
s_lshl_b32 s35, s35, 12
v_mfma_f32_16x16x32_bf16 v[148:151], a[112:115], a[36:39], v[148:151]
ds_read_b128 a[96:99], v6 offset:8192
v_mfma_f32_16x16x32_bf16 v[152:155], a[116:119], a[36:39], v[152:155]
buffer_load_dwordx4 a[24:27], v4, s[40:43], s35 offen offset:0 sc1
v_mfma_f32_16x16x32_bf16 v[136:139], a[116:119], a[32:35], v[136:139]
ds_read_b128 a[100:103], v6 offset:9216
v_mfma_f32_16x16x32_bf16 v[140:143], a[120:123], a[32:35], v[140:143]
ds_read_b128 a[104:107], v6 offset:10240
v_mfma_f32_16x16x32_bf16 v[156:159], a[120:123], a[36:39], v[156:159]
ds_read_b128 a[108:111], v6 offset:11264
v_mfma_f32_16x16x32_bf16 v[160:163], a[124:127], a[36:39], v[160:163]
buffer_load_dwordx4 a[28:31], v4, s[40:43], s35 offen offset:1024 sc1
v_mfma_f32_16x16x32_bf16 v[144:147], a[124:127], a[32:35], v[144:147]
s_waitcnt vmcnt(8) lgkmcnt(4)
v_mfma_f32_16x16x32_bf16 v[132:135], a[128:131], a[40:43], v[132:135]
s_cmp_eq_u32 s3, 6
s_cselect_b32 s35, 30, 22
s_lshl_b32 s35, s35, 12
v_mfma_f32_16x16x32_bf16 v[148:151], a[128:131], a[44:47], v[148:151]
ds_read_b128 a[112:115], v6 offset:12288
v_mfma_f32_16x16x32_bf16 v[152:155], a[132:135], a[44:47], v[152:155]
buffer_load_dwordx4 a[32:35], v4, s[40:43], s35 offen offset:0 sc1
v_mfma_f32_16x16x32_bf16 v[136:139], a[132:135], a[40:43], v[136:139]
ds_read_b128 a[116:119], v6 offset:13312
v_mfma_f32_16x16x32_bf16 v[140:143], a[136:139], a[40:43], v[140:143]
ds_read_b128 a[120:123], v6 offset:14336
v_mfma_f32_16x16x32_bf16 v[156:159], a[136:139], a[44:47], v[156:159]
ds_read_b128 a[124:127], v6 offset:15360
v_mfma_f32_16x16x32_bf16 v[160:163], a[140:143], a[44:47], v[160:163]
buffer_load_dwordx4 a[36:39], v4, s[40:43], s35 offen offset:1024 sc1
v_mfma_f32_16x16x32_bf16 v[144:147], a[140:143], a[40:43], v[144:147]
s_waitcnt vmcnt(8) lgkmcnt(4)
v_mfma_f32_16x16x32_bf16 v[132:135], a[96:99], a[0:3], v[132:135]
s_cmp_eq_u32 s3, 7
s_cselect_b32 s35, 31, 23
s_lshl_b32 s35, s35, 12
v_mfma_f32_16x16x32_bf16 v[148:151], a[96:99], a[4:7], v[148:151]
ds_read_b128 a[128:131], v6 offset:16384
v_mfma_f32_16x16x32_bf16 v[152:155], a[100:103], a[4:7], v[152:155]
buffer_load_dwordx4 a[40:43], v4, s[40:43], s35 offen offset:0 sc1
v_mfma_f32_16x16x32_bf16 v[136:139], a[100:103], a[0:3], v[136:139]
ds_read_b128 a[132:135], v6 offset:17408
v_mfma_f32_16x16x32_bf16 v[140:143], a[104:107], a[0:3], v[140:143]
ds_read_b128 a[136:139], v6 offset:18432
v_mfma_f32_16x16x32_bf16 v[156:159], a[104:107], a[4:7], v[156:159]
ds_read_b128 a[140:143], v6 offset:19456
v_mfma_f32_16x16x32_bf16 v[160:163], a[108:111], a[4:7], v[160:163]
buffer_load_dwordx4 a[44:47], v4, s[40:43], s35 offen offset:1024 sc1
v_mfma_f32_16x16x32_bf16 v[144:147], a[108:111], a[0:3], v[144:147]
s_waitcnt vmcnt(8) lgkmcnt(4)
v_mfma_f32_16x16x32_bf16 v[132:135], a[112:115], a[8:11], v[132:135]
s_cmp_eq_u32 s3, 0
s_cselect_b32 s35, 0, 24
s_lshl_b32 s35, s35, 12
v_mfma_f32_16x16x32_bf16 v[148:151], a[112:115], a[12:15], v[148:151]
ds_read_b128 a[96:99], v6 offset:20480
v_mfma_f32_16x16x32_bf16 v[152:155], a[116:119], a[12:15], v[152:155]
buffer_load_dwordx4 a[0:3], v4, s[40:43], s35 offen offset:0 sc1
v_mfma_f32_16x16x32_bf16 v[136:139], a[116:119], a[8:11], v[136:139]
ds_read_b128 a[100:103], v6 offset:21504
v_mfma_f32_16x16x32_bf16 v[140:143], a[120:123], a[8:11], v[140:143]
ds_read_b128 a[104:107], v6 offset:22528
v_mfma_f32_16x16x32_bf16 v[156:159], a[120:123], a[12:15], v[156:159]
ds_read_b128 a[108:111], v6 offset:23552
v_mfma_f32_16x16x32_bf16 v[160:163], a[124:127], a[12:15], v[160:163]
buffer_load_dwordx4 a[4:7], v4, s[40:43], s35 offen offset:1024 sc1
v_mfma_f32_16x16x32_bf16 v[144:147], a[124:127], a[8:11], v[144:147]
s_waitcnt vmcnt(8) lgkmcnt(4)
v_mfma_f32_16x16x32_bf16 v[132:135], a[128:131], a[16:19], v[132:135]
s_cmp_eq_u32 s3, 1
s_cselect_b32 s35, 1, 25
s_lshl_b32 s35, s35, 12
v_mfma_f32_16x16x32_bf16 v[148:151], a[128:131], a[20:23], v[148:151]
ds_read_b128 a[112:115], v6 offset:24576
v_mfma_f32_16x16x32_bf16 v[152:155], a[132:135], a[20:23], v[152:155]
buffer_load_dwordx4 a[8:11], v4, s[40:43], s35 offen offset:0 sc1
v_mfma_f32_16x16x32_bf16 v[136:139], a[132:135], a[16:19], v[136:139]
ds_read_b128 a[116:119], v6 offset:25600
v_mfma_f32_16x16x32_bf16 v[140:143], a[136:139], a[16:19], v[140:143]
ds_read_b128 a[120:123], v6 offset:26624
v_mfma_f32_16x16x32_bf16 v[156:159], a[136:139], a[20:23], v[156:159]
ds_read_b128 a[124:127], v6 offset:27648
v_mfma_f32_16x16x32_bf16 v[160:163], a[140:143], a[20:23], v[160:163]
buffer_load_dwordx4 a[12:15], v4, s[40:43], s35 offen offset:1024 sc1
v_mfma_f32_16x16x32_bf16 v[144:147], a[140:143], a[16:19], v[144:147]
s_waitcnt vmcnt(8) lgkmcnt(4)
v_mfma_f32_16x16x32_bf16 v[132:135], a[96:99], a[24:27], v[132:135]
s_cmp_eq_u32 s3, 2
s_cselect_b32 s35, 2, 26
s_lshl_b32 s35, s35, 12
v_mfma_f32_16x16x32_bf16 v[148:151], a[96:99], a[28:31], v[148:151]
ds_read_b128 a[128:131], v6 offset:28672
v_mfma_f32_16x16x32_bf16 v[152:155], a[100:103], a[28:31], v[152:155]
buffer_load_dwordx4 a[16:19], v4, s[40:43], s35 offen offset:0 sc1
v_mfma_f32_16x16x32_bf16 v[136:139], a[100:103], a[24:27], v[136:139]
ds_read_b128 a[132:135], v6 offset:29696
v_mfma_f32_16x16x32_bf16 v[140:143], a[104:107], a[24:27], v[140:143]
ds_read_b128 a[136:139], v6 offset:30720
v_mfma_f32_16x16x32_bf16 v[156:159], a[104:107], a[28:31], v[156:159]
ds_read_b128 a[140:143], v6 offset:31744
v_mfma_f32_16x16x32_bf16 v[160:163], a[108:111], a[28:31], v[160:163]
buffer_load_dwordx4 a[20:23], v4, s[40:43], s35 offen offset:1024 sc1
v_mfma_f32_16x16x32_bf16 v[144:147], a[108:111], a[24:27], v[144:147]
s_waitcnt vmcnt(8) lgkmcnt(4)
v_mfma_f32_16x16x32_bf16 v[132:135], a[112:115], a[32:35], v[132:135]
s_cmp_eq_u32 s3, 3
s_cselect_b32 s35, 3, 27
s_lshl_b32 s35, s35, 12
v_mfma_f32_16x16x32_bf16 v[148:151], a[112:115], a[36:39], v[148:151]
ds_read_b128 a[96:99], v6 offset:32768
v_mfma_f32_16x16x32_bf16 v[152:155], a[116:119], a[36:39], v[152:155]
buffer_load_dwordx4 a[24:27], v4, s[40:43], s35 offen offset:0 sc1
v_mfma_f32_16x16x32_bf16 v[136:139], a[116:119], a[32:35], v[136:139]
ds_read_b128 a[100:103], v6 offset:33792
v_mfma_f32_16x16x32_bf16 v[140:143], a[120:123], a[32:35], v[140:143]
ds_read_b128 a[104:107], v6 offset:34816
v_mfma_f32_16x16x32_bf16 v[156:159], a[120:123], a[36:39], v[156:159]
ds_read_b128 a[108:111], v6 offset:35840
v_mfma_f32_16x16x32_bf16 v[160:163], a[124:127], a[36:39], v[160:163]
buffer_load_dwordx4 a[28:31], v4, s[40:43], s35 offen offset:1024 sc1
v_mfma_f32_16x16x32_bf16 v[144:147], a[124:127], a[32:35], v[144:147]
s_waitcnt vmcnt(8) lgkmcnt(4)
v_mfma_f32_16x16x32_bf16 v[132:135], a[128:131], a[40:43], v[132:135]
s_cmp_eq_u32 s3, 4
s_cselect_b32 s35, 4, 28
s_lshl_b32 s35, s35, 12
v_mfma_f32_16x16x32_bf16 v[148:151], a[128:131], a[44:47], v[148:151]
ds_read_b128 a[112:115], v6 offset:36864
v_mfma_f32_16x16x32_bf16 v[152:155], a[132:135], a[44:47], v[152:155]
buffer_load_dwordx4 a[32:35], v4, s[40:43], s35 offen offset:0 sc1
v_mfma_f32_16x16x32_bf16 v[136:139], a[132:135], a[40:43], v[136:139]
ds_read_b128 a[116:119], v6 offset:37888
v_mfma_f32_16x16x32_bf16 v[140:143], a[136:139], a[40:43], v[140:143]
ds_read_b128 a[120:123], v6 offset:38912
v_mfma_f32_16x16x32_bf16 v[156:159], a[136:139], a[44:47], v[156:159]
ds_read_b128 a[124:127], v6 offset:39936
v_mfma_f32_16x16x32_bf16 v[160:163], a[140:143], a[44:47], v[160:163]
buffer_load_dwordx4 a[36:39], v4, s[40:43], s35 offen offset:1024 sc1
v_mfma_f32_16x16x32_bf16 v[144:147], a[140:143], a[40:43], v[144:147]
s_waitcnt vmcnt(8) lgkmcnt(4)
v_mfma_f32_16x16x32_bf16 v[132:135], a[96:99], a[0:3], v[132:135]
s_cmp_eq_u32 s3, 5
s_cselect_b32 s35, 5, 29
s_lshl_b32 s35, s35, 12
v_mfma_f32_16x16x32_bf16 v[148:151], a[96:99], a[4:7], v[148:151]
ds_read_b128 a[128:131], v6 offset:40960
v_mfma_f32_16x16x32_bf16 v[152:155], a[100:103], a[4:7], v[152:155]
buffer_load_dwordx4 a[40:43], v4, s[40:43], s35 offen offset:0 sc1
v_mfma_f32_16x16x32_bf16 v[136:139], a[100:103], a[0:3], v[136:139]
ds_read_b128 a[132:135], v6 offset:41984
v_mfma_f32_16x16x32_bf16 v[140:143], a[104:107], a[0:3], v[140:143]
ds_read_b128 a[136:139], v6 offset:43008
v_mfma_f32_16x16x32_bf16 v[156:159], a[104:107], a[4:7], v[156:159]
ds_read_b128 a[140:143], v6 offset:44032
v_mfma_f32_16x16x32_bf16 v[160:163], a[108:111], a[4:7], v[160:163]
buffer_load_dwordx4 a[44:47], v4, s[40:43], s35 offen offset:1024 sc1
v_mfma_f32_16x16x32_bf16 v[144:147], a[108:111], a[0:3], v[144:147]
s_waitcnt vmcnt(8) lgkmcnt(4)
v_mfma_f32_16x16x32_bf16 v[132:135], a[112:115], a[8:11], v[132:135]
s_cmp_eq_u32 s3, 6
s_cselect_b32 s35, 6, 30
s_lshl_b32 s35, s35, 12
v_mfma_f32_16x16x32_bf16 v[148:151], a[112:115], a[12:15], v[148:151]
ds_read_b128 a[96:99], v6 offset:45056
v_mfma_f32_16x16x32_bf16 v[152:155], a[116:119], a[12:15], v[152:155]
buffer_load_dwordx4 a[0:3], v4, s[40:43], s35 offen offset:0 sc1
v_mfma_f32_16x16x32_bf16 v[136:139], a[116:119], a[8:11], v[136:139]
ds_read_b128 a[100:103], v6 offset:46080
v_mfma_f32_16x16x32_bf16 v[140:143], a[120:123], a[8:11], v[140:143]
ds_read_b128 a[104:107], v6 offset:47104
v_mfma_f32_16x16x32_bf16 v[156:159], a[120:123], a[12:15], v[156:159]
ds_read_b128 a[108:111], v6 offset:48128
v_mfma_f32_16x16x32_bf16 v[160:163], a[124:127], a[12:15], v[160:163]
buffer_load_dwordx4 a[4:7], v4, s[40:43], s35 offen offset:1024 sc1
v_mfma_f32_16x16x32_bf16 v[144:147], a[124:127], a[8:11], v[144:147]
s_waitcnt vmcnt(8) lgkmcnt(4)
v_mfma_f32_16x16x32_bf16 v[132:135], a[128:131], a[16:19], v[132:135]
s_cmp_eq_u32 s3, 7
s_cselect_b32 s35, 7, 31
s_lshl_b32 s35, s35, 12
v_mfma_f32_16x16x32_bf16 v[148:151], a[128:131], a[20:23], v[148:151]
ds_read_b128 a[112:115], v6 offset:49152
v_mfma_f32_16x16x32_bf16 v[152:155], a[132:135], a[20:23], v[152:155]
buffer_load_dwordx4 a[8:11], v4, s[40:43], s35 offen offset:0 sc1
v_mfma_f32_16x16x32_bf16 v[136:139], a[132:135], a[16:19], v[136:139]
ds_read_b128 a[116:119], v6 offset:50176
v_mfma_f32_16x16x32_bf16 v[140:143], a[136:139], a[16:19], v[140:143]
ds_read_b128 a[120:123], v6 offset:51200
L_stub20:
s_cbranch_execz L_wret7
v_mfma_f32_16x16x32_bf16 v[156:159], a[136:139], a[20:23], v[156:159]
ds_read_b128 a[124:127], v6 offset:52224
v_mfma_f32_16x16x32_bf16 v[160:163], a[140:143], a[20:23], v[160:163]
buffer_load_dwordx4 a[12:15], v4, s[40:43], s35 offen offset:1024 sc1
v_mfma_f32_16x16x32_bf16 v[144:147], a[140:143], a[16:19], v[144:147]
s_waitcnt vmcnt(8) lgkmcnt(4)
v_mfma_f32_16x16x32_bf16 v[132:135], a[96:99], a[24:27], v[132:135]
ds_read_b128 a[128:131], v6 offset:53248
v_mfma_f32_16x16x32_bf16 v[148:151], a[96:99], a[28:31], v[148:151]
ds_read_b128 a[132:135], v6 offset:54272
v_mfma_f32_16x16x32_bf16 v[152:155], a[100:103], a[28:31], v[152:155]
ds_read_b128 a[136:139], v6 offset:55296
v_mfma_f32_16x16x32_bf16 v[136:139], a[100:103], a[24:27], v[136:139]
ds_read_b128 a[140:143], v6 offset:56320
v_mfma_f32_16x16x32_bf16 v[140:143], a[104:107], a[24:27], v[140:143]
v_mfma_f32_16x16x32_bf16 v[156:159], a[104:107], a[28:31], v[156:159]
v_mfma_f32_16x16x32_bf16 v[160:163], a[108:111], a[28:31], v[160:163]
v_mfma_f32_16x16x32_bf16 v[144:147], a[108:111], a[24:27], v[144:147]
s_waitcnt vmcnt(6) lgkmcnt(4)
v_mfma_f32_16x16x32_bf16 v[132:135], a[112:115], a[32:35], v[132:135]
ds_read_b128 a[96:99], v6 offset:57344
v_mfma_f32_16x16x32_bf16 v[148:151], a[112:115], a[36:39], v[148:151]
ds_read_b128 a[100:103], v6 offset:58368
v_mfma_f32_16x16x32_bf16 v[152:155], a[116:119], a[36:39], v[152:155]
ds_read_b128 a[104:107], v6 offset:59392
v_mfma_f32_16x16x32_bf16 v[136:139], a[116:119], a[32:35], v[136:139]
ds_read_b128 a[108:111], v6 offset:60416
v_mfma_f32_16x16x32_bf16 v[140:143], a[120:123], a[32:35], v[140:143]
v_mfma_f32_16x16x32_bf16 v[156:159], a[120:123], a[36:39], v[156:159]
v_mfma_f32_16x16x32_bf16 v[160:163], a[124:127], a[36:39], v[160:163]
v_mfma_f32_16x16x32_bf16 v[144:147], a[124:127], a[32:35], v[144:147]
s_waitcnt vmcnt(4) lgkmcnt(4)
v_mfma_f32_16x16x32_bf16 v[132:135], a[128:131], a[40:43], v[132:135]
ds_read_b128 a[112:115], v6 offset:61440
v_mfma_f32_16x16x32_bf16 v[148:151], a[128:131], a[44:47], v[148:151]
ds_read_b128 a[116:119], v6 offset:62464
v_mfma_f32_16x16x32_bf16 v[152:155], a[132:135], a[44:47], v[152:155]
ds_read_b128 a[120:123], v6 offset:63488
v_mfma_f32_16x16x32_bf16 v[136:139], a[132:135], a[40:43], v[136:139]
ds_read_b128 a[124:127], v6 offset:64512
v_mfma_f32_16x16x32_bf16 v[140:143], a[136:139], a[40:43], v[140:143]
v_mfma_f32_16x16x32_bf16 v[156:159], a[136:139], a[44:47], v[156:159]
v_mfma_f32_16x16x32_bf16 v[160:163], a[140:143], a[44:47], v[160:163]
v_mfma_f32_16x16x32_bf16 v[144:147], a[140:143], a[40:43], v[144:147]
s_waitcnt vmcnt(2) lgkmcnt(4)
v_mfma_f32_16x16x32_bf16 v[132:135], a[96:99], a[0:3], v[132:135]
v_mfma_f32_16x16x32_bf16 v[148:151], a[96:99], a[4:7], v[148:151]
v_mfma_f32_16x16x32_bf16 v[152:155], a[100:103], a[4:7], v[152:155]
v_mfma_f32_16x16x32_bf16 v[136:139], a[100:103], a[0:3], v[136:139]
v_mfma_f32_16x16x32_bf16 v[140:143], a[104:107], a[0:3], v[140:143]
v_mfma_f32_16x16x32_bf16 v[156:159], a[104:107], a[4:7], v[156:159]
v_mfma_f32_16x16x32_bf16 v[160:163], a[108:111], a[4:7], v[160:163]
v_mfma_f32_16x16x32_bf16 v[144:147], a[108:111], a[0:3], v[144:147]
s_waitcnt vmcnt(0) lgkmcnt(0)
v_mfma_f32_16x16x32_bf16 v[132:135], a[112:115], a[8:11], v[132:135]
v_mfma_f32_16x16x32_bf16 v[148:151], a[112:115], a[12:15], v[148:151]
v_mfma_f32_16x16x32_bf16 v[152:155], a[116:119], a[12:15], v[152:155]
buffer_atomic_add v12, v10, s[4:7], s92 offen sc1
v_mfma_f32_16x16x32_bf16 v[136:139], a[116:119], a[8:11], v[136:139]
v_mfma_f32_16x16x32_bf16 v[140:143], a[120:123], a[8:11], v[140:143]
v_mfma_f32_16x16x32_bf16 v[156:159], a[120:123], a[12:15], v[156:159]
v_mfma_f32_16x16x32_bf16 v[160:163], a[124:127], a[12:15], v[160:163]
v_mfma_f32_16x16x32_bf16 v[144:147], a[124:127], a[8:11], v[144:147]
s_nop 0
v_cmp_u_f32 vcc, v132, v148
s_nop 0
s_and_b32 vcc_lo, vcc_lo, s95
s_cbranch_scc1 L_k2redo3
s_and_b32 s36, s31, 7
s_lshl_b32 s36, s36, 7
s_lshl_b32 s37, s28, 5
s_add_u32 s36, s36, s37
s_lshl_b32 s36, s36, 1
s_lshr_b32 s37, s31, 3
s_add_u32 s36, s36, s37
s_lshl_b32 s36, s36, 11
s_lshl_b32 s37, s32, 7
v_and_b32 v234, 15, v0
s_add_u32 s36, s36, s37
v_lshrrev_b32 v233, 4, v0
v_lshl_add_u32 v232, v234, 12, s36
v_cvt_pk_bf16_f32 v32, v132, v133
v_cvt_pk_bf16_f32 v33, v134, v135
v_cvt_pk_bf16_f32 v34, v136, v137
v_cvt_pk_bf16_f32 v35, v138, v139
v_lshl_add_u32 v232, v233, 4, v232
buffer_store_dwordx4 v[32:35], v232, s[12:15], 0 offen offset:0
v_cvt_pk_bf16_f32 v36, v140, v141
v_cvt_pk_bf16_f32 v37, v142, v143
v_cvt_pk_bf16_f32 v38, v144, v145
v_cvt_pk_bf16_f32 v39, v146, v147
v_cvt_pk_bf16_f32 v40, v148, v149
v_cvt_pk_bf16_f32 v41, v150, v151
v_cvt_pk_bf16_f32 v42, v152, v153
v_cvt_pk_bf16_f32 v43, v154, v155
s_mov_b32 s36, 0x10000
v_cvt_pk_bf16_f32 v44, v156, v157
v_cvt_pk_bf16_f32 v45, v158, v159
v_cvt_pk_bf16_f32 v46, v160, v161
buffer_store_dwordx4 v[36:39], v232, s[12:15], 0 offen offset:64
v_cvt_pk_bf16_f32 v47, v162, v163
buffer_store_dwordx4 v[40:43], v232, s[12:15], s36 offen offset:0
buffer_store_dwordx4 v[44:47], v232, s[12:15], s36 offen offset:64
s_or_b32 s36, s2, s28
s_cbranch_scc1 Lep_45
s_mov_b32 s36, 0xf0000
buffer_store_dword v15, off, s[4:7], s36 sc1
Lep_45:
L_end:
s_endpgm
Ltr_8:
s_add_u32 s52, s67, 0xe0000
s_mov_b32 s53, 0
Ltp_9:
s_sleep 2
v_mov_b32 v11, v15
s_mov_b64 exec, 0xffff
v_mov_b32 v11, 0
buffer_atomic_add v11, v255, s[4:7], s52 offen sc0 sc1
s_mov_b64 exec, -1
s_add_u32 s53, s53, 1
s_waitcnt vmcnt(0)
v_cmp_ne_u32 vcc, v11, v15
s_cbranch_vccz Lte_10
s_cmp_lt_u32 s53, 0x100000
s_cbranch_scc1 Ltp_9
s_branch Lte_10
Ltr_11:
s_add_u32 s52, s66, 0xd0040
s_mov_b32 s53, 0
Ltp_12:
s_sleep 2
v_mov_b32 v232, v15
s_mov_b64 exec, 0xffff
v_mov_b32 v232, 0
buffer_atomic_add v232, v255, s[4:7], s52 offen sc0 sc1
s_mov_b64 exec, -1
s_add_u32 s53, s53, 1
s_waitcnt vmcnt(0)
v_cmp_ne_u32 vcc, v232, v15
s_cbranch_vccz Lte_13
s_cmp_lt_u32 s53, 0x100000
s_cbranch_scc1 Ltp_12
s_branch Lte_13
L_kvredo1:
s_mov_b32 s88, 0
L_kvredo1b:
v_max_u32 v132, v48, v49
v_max3_u32 v132, v132, v50, v51
v_max3_u32 v132, v132, v52, v53
v_max3_u32 v132, v132, v54, v55
v_max3_u32 v132, v132, v56, v57
v_max3_u32 v132, v132, v58, v59
v_max3_u32 v132, v132, v60, v61
v_max3_u32 v132, v132, v62, v63
v_max3_u32 v132, v132, v64, v65
v_max3_u32 v132, v132, v66, v67
v_max3_u32 v132, v132, v68, v69
v_max3_u32 v132, v132, v70, v71
v_max3_u32 v132, v132, v100, v101
v_max3_u32 v132, v132, v102, v103
v_max3_u32 v132, v132, v104, v105
v_max3_u32 v132, v132, v106, v107
v_max3_u32 v132, v132, v124, v125
v_max3_u32 v132, v132, v126, v127
v_cmp_eq_u32 vcc, -1, v132
s_cbranch_vccz L_kvback1
s_add_u32 s88, s88, 1
s_cmp_gt_u32 s88, 0x80000
s_cbranch_scc1 L_kvback1
s_sleep 4
buffer_load_dwordx4 v[48:51], v1, s[4:7], s98 offen offset:0 sc1
buffer_load_dwordx4 v[124:127], v248, s[4:7], s100 offen sc1
buffer_load_dwordx4 v[52:55], v1, s[4:7], s98 offen offset:1024 sc1
buffer_load_dwordx4 v[56:59], v1, s[4:7], s98 offen offset:2048 sc1
buffer_load_dwordx4 v[60:63], v1, s[4:7], s98 offen offset:3072 sc1
buffer_load_dwordx4 v[64:67], v1, s[4:7], s99 offen offset:0 sc1
buffer_load_dwordx4 v[68:71], v1, s[4:7], s99 offen offset:1024 sc1
buffer_load_dwordx4 v[100:103], v1, s[4:7], s99 offen offset:2048 sc1
buffer_load_dwordx4 v[104:107], v1, s[4:7], s99 offen offset:3072 sc1
s_waitcnt vmcnt(8)
v_lshlrev_b32 v92, 16, v48
v_and_b32 v93, 0xffff0000, v48
v_lshlrev_b32 v94, 16, v49
v_and_b32 v95, 0xffff0000, v49
v_lshlrev_b32 v96, 16, v50
v_and_b32 v97, 0xffff0000, v50
v_lshlrev_b32 v98, 16, v51
v_and_b32 v99, 0xffff0000, v51
s_waitcnt vmcnt(7)
v_add_f32_dpp v128, v124, v124 row_ror:4 row_mask:0xf bank_mask:0xf
v_add_f32_dpp v129, v125, v125 row_ror:4 row_mask:0xf bank_mask:0xf
v_add_f32_dpp v130, v126, v126 row_ror:4 row_mask:0xf bank_mask:0xf
v_add_f32_dpp v131, v127, v127 row_ror:4 row_mask:0xf bank_mask:0xf
v_add_f32_dpp v128, v128, v128 row_ror:2 row_mask:0xf bank_mask:0xf
v_add_f32_dpp v129, v129, v129 row_ror:2 row_mask:0xf bank_mask:0xf
v_add_f32_dpp v130, v130, v130 row_ror:2 row_mask:0xf bank_mask:0xf
v_add_f32_dpp v131, v131, v131 row_ror:2 row_mask:0xf bank_mask:0xf
v_add_f32_dpp v128, v128, v128 row_ror:1 row_mask:0xf bank_mask:0xf
v_add_f32_dpp v129, v129, v129 row_ror:1 row_mask:0xf bank_mask:0xf
v_add_f32_dpp v130, v130, v130 row_ror:1 row_mask:0xf bank_mask:0xf
v_add_f32_dpp v131, v131, v131 row_ror:1 row_mask:0xf bank_mask:0xf
s_waitcnt vmcnt(6)
v_dot2c_f32_bf16 v92, v52, v249
v_dot2c_f32_bf16 v93, v52, v250
v_dot2c_f32_bf16 v94, v53, v249
v_dot2c_f32_bf16 v95, v53, v250
v_dot2c_f32_bf16 v96, v54, v249
v_dot2c_f32_bf16 v97, v54, v250
v_dot2c_f32_bf16 v98, v55, v249
v_dot2c_f32_bf16 v99, v55, v250
s_waitcnt vmcnt(5)
v_dot2c_f32_bf16 v92, v56, v249
v_dot2c_f32_bf16 v93, v56, v250
v_dot2c_f32_bf16 v94, v57, v249
v_dot2c_f32_bf16 v95, v57, v250
v_dot2c_f32_bf16 v96, v58, v249
v_dot2c_f32_bf16 v97, v58, v250
v_dot2c_f32_bf16 v98, v59, v249
v_dot2c_f32_bf16 v99, v59, v250
s_waitcnt vmcnt(4)
v_dot2c_f32_bf16 v92, v60, v249
v_dot2c_f32_bf16 v93, v60, v250
v_dot2c_f32_bf16 v94, v61, v249
v_dot2c_f32_bf16 v95, v61, v250
v_dot2c_f32_bf16 v96, v62, v249
v_dot2c_f32_bf16 v97, v62, v250
v_dot2c_f32_bf16 v98, v63, v249
v_dot2c_f32_bf16 v99, v63, v250
s_waitcnt vmcnt(3)
v_dot2c_f32_bf16 v92, v64, v249
v_dot2c_f32_bf16 v93, v64, v250
v_dot2c_f32_bf16 v94, v65, v249
v_dot2c_f32_bf16 v95, v65, v250
v_dot2c_f32_bf16 v96, v66, v249
v_dot2c_f32_bf16 v97, v66, v250
v_dot2c_f32_bf16 v98, v67, v249
v_dot2c_f32_bf16 v99, v67, v250
s_waitcnt vmcnt(2)
v_dot2c_f32_bf16 v92, v68, v249
v_dot2c_f32_bf16 v93, v68, v250
v_dot2c_f32_bf16 v94, v69, v249
v_dot2c_f32_bf16 v95, v69, v250
v_dot2c_f32_bf16 v96, v70, v249
v_dot2c_f32_bf16 v97, v70, v250
v_dot2c_f32_bf16 v98, v71, v249
v_dot2c_f32_bf16 v99, v71, v250
s_waitcnt vmcnt(1)
v_dot2c_f32_bf16 v92, v100, v249
v_dot2c_f32_bf16 v93, v100, v250
v_dot2c_f32_bf16 v94, v101, v249
v_dot2c_f32_bf16 v95, v101, v250
v_dot2c_f32_bf16 v96, v102, v249
v_dot2c_f32_bf16 v97, v102, v250
v_dot2c_f32_bf16 v98, v103, v249
v_dot2c_f32_bf16 v99, v103, v250
s_waitcnt vmcnt(0)
v_dot2c_f32_bf16 v92, v104, v249
v_dot2c_f32_bf16 v93, v104, v250
v_dot2c_f32_bf16 v94, v105, v249
v_dot2c_f32_bf16 v95, v105, v250
v_dot2c_f32_bf16 v96, v106, v249
v_dot2c_f32_bf16 v97, v106, v250
v_dot2c_f32_bf16 v98, v107, v249
v_dot2c_f32_bf16 v99, v107, v250
s_nop 2
s_branch L_kvredo1b
L_k2redo1:
s_mov_b32 s95, 0
s_mov_b32 s92, 0x40000000
s_mov_b32 s93, 0x40000000
s_mov_b32 s94, 0x40000000
s_add_u32 s36, s66, 0x10000
s_mov_b32 s37, 0
Lpoll_46:
v_mov_b32 v11, 0
buffer_atomic_add v11, v251, s[4:7], s36 offen sc0 sc1
s_add_u32 s37, s37, 1
s_waitcnt vmcnt(0)
v_readfirstlane_b32 s38, v11
s_nop 0
s_cmp_ge_u32 s38, 32
s_cbranch_scc1 Lpe_47
s_cmp_lt_u32 s37, 0x100000
s_cbranch_scc1 Lpoll_46
Lpe_47:
s_nop 7
s_cmp_eq_u32 s3, 0
s_cselect_b32 s35, 8, 0
s_lshl_b32 s35, s35, 12
v_lshlrev_b32 v132, 16, v32
v_and_b32 v133, 0xffff0000, v32
v_lshlrev_b32 v134, 16, v33
v_and_b32 v135, 0xffff0000, v33
v_lshlrev_b32 v136, 16, v34
v_and_b32 v137, 0xffff0000, v34
v_lshlrev_b32 v138, 16, v35
v_and_b32 v139, 0xffff0000, v35
v_lshlrev_b32 v140, 16, v36
v_and_b32 v141, 0xffff0000, v36
v_lshlrev_b32 v142, 16, v37
v_and_b32 v143, 0xffff0000, v37
v_lshlrev_b32 v144, 16, v38
v_and_b32 v145, 0xffff0000, v38
v_lshlrev_b32 v146, 16, v39
v_and_b32 v147, 0xffff0000, v39
v_lshlrev_b32 v148, 16, v40
v_and_b32 v149, 0xffff0000, v40
v_lshlrev_b32 v150, 16, v41
v_and_b32 v151, 0xffff0000, v41
v_lshlrev_b32 v152, 16, v42
v_and_b32 v153, 0xffff0000, v42
v_lshlrev_b32 v154, 16, v43
v_and_b32 v155, 0xffff0000, v43
v_lshlrev_b32 v156, 16, v44
v_and_b32 v157, 0xffff0000, v44
v_lshlrev_b32 v158, 16, v45
v_and_b32 v159, 0xffff0000, v45
v_lshlrev_b32 v160, 16, v46
v_and_b32 v161, 0xffff0000, v46
v_lshlrev_b32 v162, 16, v47
v_and_b32 v163, 0xffff0000, v47
s_branch L_k2go1
L_k2redo2:
s_mov_b32 s95, 0
s_mov_b32 s92, 0x40000000
s_mov_b32 s93, 0x40000000
s_mov_b32 s94, 0x40000000
s_add_u32 s36, s66, 0x20000
s_mov_b32 s37, 0
Lpoll_48:
v_mov_b32 v11, 0
buffer_atomic_add v11, v251, s[4:7], s36 offen sc0 sc1
s_add_u32 s37, s37, 1
s_waitcnt vmcnt(0)
v_readfirstlane_b32 s38, v11
s_nop 0
s_cmp_ge_u32 s38, 32
s_cbranch_scc1 Lpe_49
s_cmp_lt_u32 s37, 0x100000
s_cbranch_scc1 Lpoll_48
Lpe_49:
s_nop 7
s_cmp_eq_u32 s3, 0
s_cselect_b32 s35, 8, 0
s_lshl_b32 s35, s35, 12
v_lshlrev_b32 v132, 16, v32
v_and_b32 v133, 0xffff0000, v32
v_lshlrev_b32 v134, 16, v33
v_and_b32 v135, 0xffff0000, v33
v_lshlrev_b32 v136, 16, v34
v_and_b32 v137, 0xffff0000, v34
v_lshlrev_b32 v138, 16, v35
v_and_b32 v139, 0xffff0000, v35
v_lshlrev_b32 v140, 16, v36
v_and_b32 v141, 0xffff0000, v36
v_lshlrev_b32 v142, 16, v37
v_and_b32 v143, 0xffff0000, v37
v_lshlrev_b32 v144, 16, v38
v_and_b32 v145, 0xffff0000, v38
v_lshlrev_b32 v146, 16, v39
v_and_b32 v147, 0xffff0000, v39
v_lshlrev_b32 v148, 16, v40
v_and_b32 v149, 0xffff0000, v40
v_lshlrev_b32 v150, 16, v41
v_and_b32 v151, 0xffff0000, v41
v_lshlrev_b32 v152, 16, v42
v_and_b32 v153, 0xffff0000, v42
v_lshlrev_b32 v154, 16, v43
v_and_b32 v155, 0xffff0000, v43
v_lshlrev_b32 v156, 16, v44
v_and_b32 v157, 0xffff0000, v44
v_lshlrev_b32 v158, 16, v45
v_and_b32 v159, 0xffff0000, v45
v_lshlrev_b32 v160, 16, v46
v_and_b32 v161, 0xffff0000, v46
v_lshlrev_b32 v162, 16, v47
v_and_b32 v163, 0xffff0000, v47
s_branch L_k2go2
L_kvredo3:
s_mov_b32 s88, 0
L_kvredo3b:
v_max_u32 v132, v48, v49
v_max3_u32 v132, v132, v50, v51
v_max3_u32 v132, v132, v52, v53
v_max3_u32 v132, v132, v54, v55
v_max3_u32 v132, v132, v56, v57
v_max3_u32 v132, v132, v58, v59
v_max3_u32 v132, v132, v60, v61
v_max3_u32 v132, v132, v62, v63
v_max3_u32 v132, v132, v64, v65
v_max3_u32 v132, v132, v66, v67
v_max3_u32 v132, v132, v68, v69
v_max3_u32 v132, v132, v70, v71
v_max3_u32 v132, v132, v100, v101
v_max3_u32 v132, v132, v102, v103
v_max3_u32 v132, v132, v104, v105
v_max3_u32 v132, v132, v106, v107
v_max3_u32 v132, v132, v124, v125
v_max3_u32 v132, v132, v126, v127
v_cmp_eq_u32 vcc, -1, v132
s_cbranch_vccz L_kvback3
s_add_u32 s88, s88, 1
s_cmp_gt_u32 s88, 0x80000
s_cbranch_scc1 L_kvback3
s_sleep 4
buffer_load_dwordx4 v[48:51], v1, s[4:7], s98 offen offset:0 sc1
buffer_load_dwordx4 v[124:127], v248, s[4:7], s100 offen sc1
buffer_load_dwordx4 v[52:55], v1, s[4:7], s98 offen offset:1024 sc1
buffer_load_dwordx4 v[56:59], v1, s[4:7], s98 offen offset:2048 sc1
buffer_load_dwordx4 v[60:63], v1, s[4:7], s98 offen offset:3072 sc1
buffer_load_dwordx4 v[64:67], v1, s[4:7], s99 offen offset:0 sc1
buffer_load_dwordx4 v[68:71], v1, s[4:7], s99 offen offset:1024 sc1
buffer_load_dwordx4 v[100:103], v1, s[4:7], s99 offen offset:2048 sc1
buffer_load_dwordx4 v[104:107], v1, s[4:7], s99 offen offset:3072 sc1
s_waitcnt vmcnt(8)
v_lshlrev_b32 v92, 16, v48
v_and_b32 v93, 0xffff0000, v48
v_lshlrev_b32 v94, 16, v49
v_and_b32 v95, 0xffff0000, v49
v_lshlrev_b32 v96, 16, v50
v_and_b32 v97, 0xffff0000, v50
v_lshlrev_b32 v98, 16, v51
v_and_b32 v99, 0xffff0000, v51
s_waitcnt vmcnt(7)
v_add_f32_dpp v128, v124, v124 row_ror:4 row_mask:0xf bank_mask:0xf
v_add_f32_dpp v129, v125, v125 row_ror:4 row_mask:0xf bank_mask:0xf
v_add_f32_dpp v130, v126, v126 row_ror:4 row_mask:0xf bank_mask:0xf
v_add_f32_dpp v131, v127, v127 row_ror:4 row_mask:0xf bank_mask:0xf
v_add_f32_dpp v128, v128, v128 row_ror:2 row_mask:0xf bank_mask:0xf
v_add_f32_dpp v129, v129, v129 row_ror:2 row_mask:0xf bank_mask:0xf
v_add_f32_dpp v130, v130, v130 row_ror:2 row_mask:0xf bank_mask:0xf
v_add_f32_dpp v131, v131, v131 row_ror:2 row_mask:0xf bank_mask:0xf
v_add_f32_dpp v128, v128, v128 row_ror:1 row_mask:0xf bank_mask:0xf
v_add_f32_dpp v129, v129, v129 row_ror:1 row_mask:0xf bank_mask:0xf
v_add_f32_dpp v130, v130, v130 row_ror:1 row_mask:0xf bank_mask:0xf
v_add_f32_dpp v131, v131, v131 row_ror:1 row_mask:0xf bank_mask:0xf
s_waitcnt vmcnt(6)
v_dot2c_f32_bf16 v92, v52, v249
v_dot2c_f32_bf16 v93, v52, v250
v_dot2c_f32_bf16 v94, v53, v249
v_dot2c_f32_bf16 v95, v53, v250
v_dot2c_f32_bf16 v96, v54, v249
v_dot2c_f32_bf16 v97, v54, v250
v_dot2c_f32_bf16 v98, v55, v249
v_dot2c_f32_bf16 v99, v55, v250
s_waitcnt vmcnt(5)
v_dot2c_f32_bf16 v92, v56, v249
v_dot2c_f32_bf16 v93, v56, v250
v_dot2c_f32_bf16 v94, v57, v249
v_dot2c_f32_bf16 v95, v57, v250
v_dot2c_f32_bf16 v96, v58, v249
v_dot2c_f32_bf16 v97, v58, v250
v_dot2c_f32_bf16 v98, v59, v249
v_dot2c_f32_bf16 v99, v59, v250
s_waitcnt vmcnt(4)
v_dot2c_f32_bf16 v92, v60, v249
v_dot2c_f32_bf16 v93, v60, v250
v_dot2c_f32_bf16 v94, v61, v249
v_dot2c_f32_bf16 v95, v61, v250
v_dot2c_f32_bf16 v96, v62, v249
v_dot2c_f32_bf16 v97, v62, v250
v_dot2c_f32_bf16 v98, v63, v249
v_dot2c_f32_bf16 v99, v63, v250
s_waitcnt vmcnt(3)
v_dot2c_f32_bf16 v92, v64, v249
v_dot2c_f32_bf16 v93, v64, v250
v_dot2c_f32_bf16 v94, v65, v249
v_dot2c_f32_bf16 v95, v65, v250
v_dot2c_f32_bf16 v96, v66, v249
v_dot2c_f32_bf16 v97, v66, v250
v_dot2c_f32_bf16 v98, v67, v249
v_dot2c_f32_bf16 v99, v67, v250
s_waitcnt vmcnt(2)
v_dot2c_f32_bf16 v92, v68, v249
v_dot2c_f32_bf16 v93, v68, v250
v_dot2c_f32_bf16 v94, v69, v249
v_dot2c_f32_bf16 v95, v69, v250
v_dot2c_f32_bf16 v96, v70, v249
v_dot2c_f32_bf16 v97, v70, v250
v_dot2c_f32_bf16 v98, v71, v249
v_dot2c_f32_bf16 v99, v71, v250
s_waitcnt vmcnt(1)
v_dot2c_f32_bf16 v92, v100, v249
v_dot2c_f32_bf16 v93, v100, v250
v_dot2c_f32_bf16 v94, v101, v249
v_dot2c_f32_bf16 v95, v101, v250
v_dot2c_f32_bf16 v96, v102, v249
v_dot2c_f32_bf16 v97, v102, v250
v_dot2c_f32_bf16 v98, v103, v249
v_dot2c_f32_bf16 v99, v103, v250
s_waitcnt vmcnt(0)
v_dot2c_f32_bf16 v92, v104, v249
v_dot2c_f32_bf16 v93, v104, v250
v_dot2c_f32_bf16 v94, v105, v249
v_dot2c_f32_bf16 v95, v105, v250
v_dot2c_f32_bf16 v96, v106, v249
v_dot2c_f32_bf16 v97, v106, v250
v_dot2c_f32_bf16 v98, v107, v249
v_dot2c_f32_bf16 v99, v107, v250
s_nop 2
s_branch L_kvredo3b
L_k2redo3:
s_mov_b32 s95, 0
s_mov_b32 s92, 0x40000000
s_mov_b32 s93, 0x40000000
s_mov_b32 s94, 0x40000000
s_add_u32 s36, s66, 0x30000
s_mov_b32 s37, 0
Lpoll_50:
v_mov_b32 v11, 0
buffer_atomic_add v11, v251, s[4:7], s36 offen sc0 sc1
s_add_u32 s37, s37, 1
s_waitcnt vmcnt(0)
v_readfirstlane_b32 s38, v11
s_nop 0
s_cmp_ge_u32 s38, 32
s_cbranch_scc1 Lpe_51
s_cmp_lt_u32 s37, 0x100000
s_cbranch_scc1 Lpoll_50
Lpe_51:
s_nop 7
s_cmp_eq_u32 s3, 0
s_cselect_b32 s35, 8, 0
s_lshl_b32 s35, s35, 12
v_lshlrev_b32 v132, 16, v32
v_and_b32 v133, 0xffff0000, v32
v_lshlrev_b32 v134, 16, v33
v_and_b32 v135, 0xffff0000, v33
v_lshlrev_b32 v136, 16, v34
v_and_b32 v137, 0xffff0000, v34
v_lshlrev_b32 v138, 16, v35
v_and_b32 v139, 0xffff0000, v35
v_lshlrev_b32 v140, 16, v36
v_and_b32 v141, 0xffff0000, v36
v_lshlrev_b32 v142, 16, v37
v_and_b32 v143, 0xffff0000, v37
v_lshlrev_b32 v144, 16, v38
v_and_b32 v145, 0xffff0000, v38
v_lshlrev_b32 v146, 16, v39
v_and_b32 v147, 0xffff0000, v39
v_lshlrev_b32 v148, 16, v40
v_and_b32 v149, 0xffff0000, v40
v_lshlrev_b32 v150, 16, v41
v_and_b32 v151, 0xffff0000, v41
v_lshlrev_b32 v152, 16, v42
v_and_b32 v153, 0xffff0000, v42
v_lshlrev_b32 v154, 16, v43
v_and_b32 v155, 0xffff0000, v43
v_lshlrev_b32 v156, 16, v44
v_and_b32 v157, 0xffff0000, v44
v_lshlrev_b32 v158, 16, v45
v_and_b32 v159, 0xffff0000, v45
v_lshlrev_b32 v160, 16, v46
v_and_b32 v161, 0xffff0000, v46
v_lshlrev_b32 v162, 16, v47
v_and_b32 v163, 0xffff0000, v47
s_branch L_k2go3
L_code_end:
.section .rodata,"a"
.p2align 6
.amdhsa_kernel interleave_layers__sliding_local_dilated__linear_kernel_hedgehog__prompt_kernel
  .amdhsa_next_free_vgpr 512
  .amdhsa_next_free_sgpr 102
  .amdhsa_accum_offset 256
  .amdhsa_group_segment_fixed_size 0
  .amdhsa_kernarg_size 80
  .amdhsa_user_sgpr_count 2
  .amdhsa_user_sgpr_kernarg_segment_ptr 1
  .amdhsa_system_sgpr_workgroup_id_x 1
.end_amdhsa_kernel
```

```asm
; @launch grid=(256,1,1) block=(256,1,1) lds=163840
.amdgcn_target "amdgcn-amd-amdhsa--gfx950"
.text
.globl interleave_layers__sliding_local_dilated__linear_kernel_hedgehog__prompt_kernel
.p2align 8
.type interleave_layers__sliding_local_dilated__linear_kernel_hedgehog__prompt_kernel,@function
interleave_layers__sliding_local_dilated__linear_kernel_hedgehog__prompt_kernel:
s_cmp_ge_u32 s2, 256
s_cbranch_scc1 L_end
s_load_dwordx16 s[64:79], s[0:1], 0
s_load_dwordx4 s[80:83], s[0:1], 64
s_getpc_b64 s[24:25]
s_mov_b32 s26, (L_end - interleave_layers__sliding_local_dilated__linear_kernel_hedgehog__prompt_kernel - 64)
s_mov_b32 s27, 0x20000
v_lshlrev_b32 v1, 5, v0
buffer_load_dword v238, v1, s[24:27], 0 offen
v_lshrrev_b32 v1, 6, v0
v_and_b32 v0, 63, v0
v_readfirstlane_b32 s28, v1
s_and_b32 s36, s2, 7
s_lshr_b32 s37, s2, 3
s_and_b32 s38, s37, 3
s_lshr_b32 s39, s37, 2
s_and_b32 s29, s36, 1
s_lshl_b32 s32, s29, 3
s_lshl_b32 s29, s29, 2
s_add_u32 s29, s29, s38
s_add_u32 s32, s32, s39
s_lshr_b32 s36, s36, 1
s_lshl_b32 s30, s36, 3
s_add_u32 s30, s30, s39
s_lshl_b32 s31, s36, 2
s_add_u32 s31, s31, s38
s_and_b32 s32, s36, 1
s_lshl_b32 s32, s32, 3
s_add_u32 s32, s32, s39
s_and_b32 s31, s2, 1
s_lshl_b32 s31, s31, 3
s_add_u32 s31, s31, s38
s_and_b32 s3, s2, 4
s_add_u32 s31, s31, s3
s_mov_b32 s3, s39
s_and_b32 s35, s2, 7
s_lshl_b32 s35, s35, 5
s_add_u32 s35, s35, s37
s_mul_i32 s33, s39, 0
s_and_b32 s33, s33, 31
s_mul_i32 s34, s39, 0
s_and_b32 s34, s34, 31
v_lshlrev_b32 v1, 4, v0
v_lshrrev_b32 v233, 4, v0
v_and_b32 v234, 15, v0
s_and_b32 s88, s31, 7
s_lshl_b32 s88, s88, 7
s_lshl_b32 s37, s28, 5
s_add_u32 s88, s88, s37
s_lshl_b32 s88, s88, 1
s_lshr_b32 s37, s31, 3
s_add_u32 s88, s88, s37
s_lshl_b32 s88, s88, 11
s_lshl_b32 s37, s32, 7
s_add_u32 s88, s88, s37
v_lshrrev_b32 v235, 3, v0
v_and_b32 v236, 7, v0
v_xor_b32 v232, v236, v233
v_lshlrev_b32 v232, 4, v232
v_lshl_add_u32 v232, v235, 12, v232
v_xor_b32 v246, 64, v232
v_lshlrev_b32 v236, 4, v236
v_lshl_add_u32 v237, v235, 11, v236
v_mul_u32_u24 v235, 6144, v235
v_add_u32 v235, v235, v236
s_lshr_b32 s36, s35, 4
s_lshl_b32 s36, s36, 2
s_add_u32 s36, s36, s28
s_mul_i32 s36, s36, 98304
s_and_b32 s37, s35, 15
s_lshl_b32 s37, s37, 7
s_add_u32 s36, s36, s37
s_lshl_b32 s37, s28, 11
s_mov_b32 s39, 0x10000
s_mov_b32 s10, 0x400000
s_mov_b32 s11, 0x20000
s_mov_b32 s22, 0x600000
s_mov_b32 s23, 0x20000
s_mov_b32 s6, 0x10000000
s_mov_b32 s7, 0x20000
s_mov_b32 s44, 0xf0000
s_waitcnt lgkmcnt(0)
s_mov_b64 s[8:9], s[64:65]
s_mov_b64 s[20:21], s[66:67]
s_lshl_b32 s39, s37, 1
s_add_u32 m0, s37, 0
s_add_u32 s38, s36, 0
buffer_load_dwordx4 v235, s[20:23], s38 offen nt lds
s_add_u32 m0, s37, 1024
s_add_u32 s38, s36, 49152
buffer_load_dwordx4 v235, s[20:23], s38 offen nt lds
s_add_u32 m0, s37, 8192
s_add_u32 s38, s36, 2048
buffer_load_dwordx4 v235, s[20:23], s38 offen nt lds
s_add_u32 m0, s37, 9216
s_add_u32 s38, s36, 51200
buffer_load_dwordx4 v235, s[20:23], s38 offen nt lds
s_add_u32 m0, s37, 16384
s_add_u32 s38, s36, 4096
buffer_load_dwordx4 v235, s[20:23], s38 offen nt lds
s_add_u32 m0, s37, 17408
s_add_u32 s38, s36, 53248
buffer_load_dwordx4 v235, s[20:23], s38 offen nt lds
s_add_u32 m0, s39, 24576
s_add_u32 s38, s88, 0
buffer_load_dwordx4 v232, s[8:11], s38 offen nt lds
s_add_u32 m0, s39, 25600
s_add_u32 s38, s88, 32768
buffer_load_dwordx4 v246, s[8:11], s38 offen nt lds
s_add_u32 m0, s39, 26624
s_add_u32 s38, s88, 65536
buffer_load_dwordx4 v232, s[8:11], s38 offen nt lds
s_add_u32 m0, s39, 27648
s_add_u32 s38, s88, 98304
buffer_load_dwordx4 v246, s[8:11], s38 offen nt lds
s_mov_b32 s37, s39
v_lshrrev_b32 v232, 1, v234
v_xor_b32 v232, v232, v233
v_lshlrev_b32 v232, 4, v232
v_lshl_add_u32 v232, v234, 7, v232
v_add_u32 v232, s37, v232
s_add_u32 s4, s82, 0x0
s_addc_u32 s5, s83, 0
s_mov_b32 s12, s78
s_mov_b32 s13, s79
s_mov_b32 s14, 0x400000
s_mov_b32 s15, 0x20000
s_mov_b32 s42, 0x400000
s_mov_b32 s43, 0x20000
v_mov_b32 v12, 1
s_mov_b64 s[40:41], s[12:13]
s_mov_b32 s64, 0xff
s_mov_b32 s65, 0
s_and_b32 s81, s29, 3
s_lshl_b32 s66, s31, 4
s_add_u32 s66, s66, s32
s_lshl_b32 s66, s66, 8
s_lshl_b32 s67, s29, 5
s_add_u32 s67, s67, s30
s_lshl_b32 s67, s67, 8
s_lshl_b32 s80, s30, 11
s_lshl_b32 s70, s29, 8
s_add_u32 s70, s70, s80
s_lshl_b32 s71, s29, 13
s_lshr_b32 s78, s31, 1
s_lshl_b32 s78, s78, 13
s_add_u32 s79, s78, 8192
s_bitcmp1_b32 s31, 0
s_cselect_b32 s79, s79, 0x40000000
s_and_b32 s36, s31, 7
s_cmp_eq_u32 s36, 7
s_cselect_b32 s79, 0x40000000, s79
v_mov_b32 v240, 0
v_mov_b32 v241, 0
v_mov_b32 v242, 0
v_mov_b32 v243, 0
v_mov_b32 v228, v235
v_mov_b32 v229, v237
s_lshr_b32 s36, s35, 4
s_lshl_b32 s36, s36, 2
s_add_u32 s36, s36, s28
s_and_b32 s37, s35, 15
s_lshl_b32 s37, s37, 7
s_lshl_b32 s16, s36, 15
s_add_u32 s16, s16, s37
s_mul_i32 s17, s36, 98304
s_add_u32 s17, s17, s37
v_mov_b32 v16, 0x3f803f80
v_mov_b32 v17, 0x3f803f80
v_mov_b32 v18, 0x3f803f80
v_mov_b32 v19, 0x3f803f80
s_mov_b32 s46, 0xaaaaaaaa
s_mov_b32 s47, 0xaaaaaaaa
s_mov_b32 s48, 0xcccccccc
s_mov_b32 s49, 0xcccccccc
s_lshl_b32 s36, s31, 1
s_lshr_b32 s37, s28, 1
s_add_u32 s36, s36, s37
s_lshl_b32 s36, s36, 17
s_and_b32 s37, s28, 1
s_lshl_b32 s37, s37, 11
s_add_u32 s36, s36, s37
v_add_u32 v4, s36, v1
s_lshl_b32 s38, s31, 2
s_add_u32 s38, s38, s28
s_lshl_b32 s38, s38, 12
s_lshl_b32 s39, s32, 7
s_add_u32 s38, s38, s39
v_lshrrev_b32 v244, 2, v234
v_cmp_eq_u32 vcc, v244, v233
v_and_b32 v244, 7, v234
v_lshl_add_u32 v244, v244, 4, s38
v_and_b32 v245, 8, v234
v_add_u32 v244, v244, v245
v_cndmask_b32 v253, 2.0, v244, vcc
v_lshlrev_b32 v244, 4, v233
v_lshl_add_u32 v244, v234, 6, v244
v_cmp_gt_u32 vcc, 2, v234
s_nop 1
v_cndmask_b32 v254, 2.0, v244, vcc
v_lshrrev_b32 v248, 4, v0
v_lshlrev_b32 v248, 10, v248
v_bfe_u32 v249, v0, 2, 2
v_lshl_add_u32 v248, v249, 7, v248
v_and_b32 v251, 3, v0
v_lshl_add_u32 v248, v251, 3, v248
s_lshr_b32 s36, s28, 1
s_lshl_b32 s36, s36, 6
s_and_b32 s37, s28, 1
s_mul_i32 s38, s37, 8224
s_add_u32 s38, s38, s36
s_mul_i32 s39, s37, 16352
s_add_u32 s39, s39, s36
v_add_u32 v249, s39, v248
v_add_u32 v248, s38, v248
s_and_b32 s38, s35, 15
s_lshl_b32 s38, s38, 1
s_lshr_b32 s36, s28, 1
s_add_u32 s38, s38, s36
s_lshr_b32 s36, s35, 4
s_mul_i32 s96, s38, 196608
s_mul_i32 s44, s36, 12288
s_add_u32 s96, s96, s44
s_mul_i32 s44, s37, 3072
s_add_u32 s96, s96, s44
s_add_u32 s96, s96, 0xe00000
s_add_u32 s97, s96, 6144
s_mul_i32 s38, s38, 6
s_mul_i32 s37, s37, 3
s_add_u32 s38, s38, s37
s_lshl_b32 s38, s38, 11
s_lshl_b32 s36, s36, 7
s_add_u32 s38, s38, s36
s_add_u32 s98, s38, 0x300000
s_add_u32 s99, s98, 4096
v_lshrrev_b32 v247, 2, v0
v_lshlrev_b32 v250, 7, v247
v_lshl_add_u32 v250, v251, 4, v250
s_lshr_b32 s36, s28, 1
s_lshl_b32 s36, s36, 12
s_and_b32 s37, s28, 1
s_lshl_b32 s37, s37, 6
s_add_u32 s36, s36, s37
s_add_u32 s36, s36, 147456
v_add_u32 v250, s36, v250
v_subrev_u32 v230, 122880, v250
s_and_b32 s36, s35, 15
s_lshl_b32 s36, s36, 17
s_lshr_b32 s37, s35, 4
s_lshl_b32 s37, s37, 13
s_add_u32 s36, s36, s37
s_lshl_b32 s37, s28, 11
s_add_u32 s36, s36, s37
s_add_u32 s100, s36, 0xa00000
s_add_u32 s101, s36, 0xc00000
v_lshlrev_b32 v247, 6, v247
v_lshl_add_u32 v251, v251, 3, v247
v_add_u32 v251, 155648, v251
v_xor_b32 v236, 64, v232
s_mov_b64 s[20:21], s[68:69]
s_mov_b32 s22, 0x200000
s_lshl_b32 s37, s28, 11
s_add_u32 m0, s37, 147456
s_add_u32 s36, s16, 0
buffer_load_dwordx4 v229, s[20:23], s36 offen nt lds
s_add_u32 m0, s37, 148480
s_add_u32 s36, s16, 16384
buffer_load_dwordx4 v229, s[20:23], s36 offen nt lds
s_add_u32 s36, s67, 0xc0000
s_add_u32 s37, s66, 0xd0000
s_cmp_eq_u32 s28, 2
s_cselect_b32 s36, s37, s36
s_cmp_eq_u32 s28, 1
s_cselect_b32 s37, 128, 0
s_add_u32 s36, s36, s37
s_cmp_eq_u32 s28, 3
s_cselect_b32 s37, 0x20000, 0
s_add_u32 s36, s36, s37
s_mov_b64 exec, 1
buffer_atomic_add v240, off, s[4:7], s36 sc1
s_mov_b64 exec, -1
s_mov_b32 s36, 0xf0000
buffer_load_dword v11, off, s[4:7], s36 sc1
s_lshr_b32 s36, s2, 3
s_lshl_b32 s36, s36, 2
s_add_u32 s36, s36, s28
s_lshl_b32 s36, s36, 10
buffer_load_dwordx4 a[0:3], v1, s[24:27], s36 offen
s_mov_b64 s[20:21], s[74:75]
s_mov_b32 s22, 0x10000
s_and_b32 s36, s28, 1
s_lshl_b32 s36, s36, 10
s_add_u32 m0, s36, 155648
s_lshl_b32 s37, s30, 11
s_add_u32 s36, s36, s37
buffer_load_dwordx4 v1, s[20:23], s36 offen lds
s_waitcnt vmcnt(6)
ds_read_b128 v[32:35], v232 offset:24576
ds_read_b128 v[36:39], v236 offset:24576
ds_read_b128 v[40:43], v232 offset:26624
ds_read_b128 v[44:47], v236 offset:26624
s_barrier
ds_read_b64_tr_b16 a[188:189], v248 offset:0
ds_read_b64_tr_b16 a[190:191], v248 offset:512
ds_read_b64_tr_b16 a[192:193], v248 offset:4096
ds_read_b64_tr_b16 a[194:195], v248 offset:4608
ds_read_b64_tr_b16 a[196:197], v249 offset:32
ds_read_b64_tr_b16 a[198:199], v249 offset:544
ds_read_b64_tr_b16 a[200:201], v249 offset:4128
ds_read_b64_tr_b16 a[202:203], v249 offset:4640
ds_read_b64_tr_b16 a[204:205], v248 offset:8192
ds_read_b64_tr_b16 a[206:207], v248 offset:8704
ds_read_b64_tr_b16 a[208:209], v248 offset:12288
ds_read_b64_tr_b16 a[210:211], v248 offset:12800
s_lshl_b32 s36, s32, 13
s_add_u32 s36, s36, 0x0
s_add_u32 s37, s36, 4096
s_mov_b32 s38, 0x200000
s_waitcnt lgkmcnt(14)
v_mfma_f32_16x16x32_bf16 v[96:99], v[32:35], v[32:35], 0
v_mfma_f32_16x16x32_bf16 v[92:95], v[16:19], v[32:35], 0
buffer_store_dwordx4 v[32:35], v4, s[12:15], s36 offen offset:0 sc1
s_waitcnt lgkmcnt(13)
v_mfma_f32_16x16x32_bf16 v[104:107], v[40:43], v[40:43], 0
v_mfma_f32_16x16x32_bf16 v[100:103], v[16:19], v[40:43], 0
buffer_store_dwordx4 v[40:43], v4, s[12:15], s36 offen offset:1024 sc1
v_mfma_f32_16x16x32_bf16 v[96:99], v[36:39], v[36:39], v[96:99]
v_mfma_f32_16x16x32_bf16 v[92:95], v[16:19], v[36:39], v[92:95]
buffer_store_dwordx4 v[36:39], v4, s[12:15], s37 offen offset:0 sc1
s_waitcnt lgkmcnt(12)
v_mfma_f32_16x16x32_bf16 v[104:107], v[44:47], v[44:47], v[104:107]
v_mfma_f32_16x16x32_bf16 v[100:103], v[16:19], v[44:47], v[100:103]
buffer_store_dwordx4 v[44:47], v4, s[12:15], s37 offen offset:1024 sc1
s_nop 1
v_cndmask_b32 v96, v96, v97, s[46:47]
v_cndmask_b32 v98, v98, v99, s[46:47]
v_cndmask_b32 v93, v96, v98, s[48:49]
buffer_store_dwordx2 v[92:93], v253, s[4:7], s38 offen offset:0 sc1
v_cndmask_b32 v104, v104, v105, s[46:47]
v_cndmask_b32 v106, v106, v107, s[46:47]
v_cndmask_b32 v101, v104, v106, s[48:49]
buffer_store_dwordx2 v[100:101], v253, s[4:7], s38 offen offset:2048 sc1
s_waitcnt lgkmcnt(10)
v_mfma_f32_16x16x32_bf16 v[108:111], a[188:191], v[16:19], 0
s_waitcnt lgkmcnt(6)
v_mfma_f32_16x16x32_bf16 v[112:115], a[196:199], v[16:19], 0
s_waitcnt lgkmcnt(2)
v_mfma_f32_16x16x32_bf16 v[116:119], a[204:207], v[16:19], 0
v_mfma_f32_16x16x32_bf16 v[108:111], a[192:195], v[16:19], v[108:111]
v_mfma_f32_16x16x32_bf16 v[112:115], a[200:203], v[16:19], v[112:115]
s_waitcnt lgkmcnt(0)
v_mfma_f32_16x16x32_bf16 v[116:119], a[208:211], v[16:19], v[116:119]
buffer_store_dwordx4 a[188:191], v1, s[4:7], s96 offen offset:0 sc1
buffer_store_dwordx4 a[192:195], v1, s[4:7], s97 offen offset:0 sc1
buffer_store_dwordx4 a[196:199], v1, s[4:7], s96 offen offset:1024 sc1
buffer_store_dwordx4 a[200:203], v1, s[4:7], s97 offen offset:1024 sc1
buffer_store_dwordx4 a[204:207], v1, s[4:7], s96 offen offset:2048 sc1
buffer_store_dwordx4 a[208:211], v1, s[4:7], s97 offen offset:2048 sc1
buffer_store_dwordx4 v[108:111], v254, s[4:7], s98 offen offset:0 sc1
buffer_store_dwordx4 v[112:115], v254, s[4:7], s98 offen offset:2048 sc1
buffer_store_dwordx4 v[116:119], v254, s[4:7], s99 offen offset:0 sc1
v_lshlrev_b32 v239, 16, v233
v_lshl_add_u32 v239, v234, 4, v239
s_cmp_eq_u32 s28, 0
s_cselect_b32 s36, s66, s67
s_cmp_eq_u32 s28, 2
s_cselect_b32 s36, s70, s36
s_lshl_b32 s37, s28, 18
s_add_u32 s36, s36, s37
s_cmp_eq_u32 s28, 3
s_cselect_b32 s36, 0x40000000, s36
buffer_store_dwordx4 v[240:243], v239, s[4:7], s36 offen sc1
s_waitcnt vmcnt(20)
s_barrier
ds_read_b64_tr_b16 a[212:213], v250 offset:0
ds_read_b64_tr_b16 a[214:215], v250 offset:2048
ds_read_b64_tr_b16 a[216:217], v250 offset:8
ds_read_b64_tr_b16 a[218:219], v250 offset:2056
s_waitcnt lgkmcnt(2)
buffer_store_dwordx4 a[212:215], v1, s[4:7], s100 offen offset:0 sc1
s_waitcnt lgkmcnt(0)
buffer_store_dwordx4 a[216:219], v1, s[4:7], s100 offen offset:1024 sc1
s_mov_b32 s56, 0x11111111
s_mov_b32 s57, 0x11111111
s_mov_b32 s58, 0x22222222
s_mov_b32 s59, 0x22222222
s_mul_i32 s18, s28, 3072
s_lshl_b32 s19, s28, 12
s_mul_i32 s50, s30, 196608
s_add_u32 s50, s50, s18
s_lshl_b32 s36, s32, 17
s_add_u32 s36, s36, s19
s_add_u32 s37, s28, 0
s_cmp_eq_u32 s37, s3
s_cselect_b32 s37, 32768, 0
s_add_u32 s84, s36, s37
s_mul_i32 s37, s37, 3
s_sub_u32 s86, s36, s37
s_add_u32 s37, s28, 4
s_cmp_eq_u32 s37, s3
s_cselect_b32 s37, 32768, 0
s_add_u32 s85, s36, s37
s_mul_i32 s37, s37, 3
s_sub_u32 s87, s36, s37
s_mul_i32 s55, s28, 6144
v_accvgpr_write_b32 a248, -1
v_accvgpr_write_b32 a249, -1
v_accvgpr_write_b32 a250, -1
v_accvgpr_write_b32 a251, -1
s_lshl_b32 s36, s29, 2
s_add_u32 s36, s36, s28
s_lshl_b32 s37, s36, 17
v_add_u32 v2, s37, v1
s_lshl_b32 s82, s36, 13
s_and_b32 s38, s29, 3
s_cmp_eq_u32 s38, 0
s_cselect_b32 s38, 0, 0x1f400
s_cselect_b32 s39, 0, 2048
s_cselect_b32 s54, 32, 48
s_lshl_b32 s37, s29, 19
s_sub_u32 s37, s37, s38
v_add_u32 v3, s37, v1
v_cmp_le_u32 vcc, 8, v234
s_nop 1
v_cndmask_b32 v3, 2.0, v3, vcc
s_lshl_b32 s37, s29, 15
s_sub_u32 s83, s37, s39
s_cmp_eq_u32 s28, 1
s_cselect_b32 vcc_lo, -1, 0
s_mov_b32 vcc_hi, 0
v_lshlrev_b32 v244, 8, v0
v_cndmask_b32 v10, 2.0, v244, vcc
v_and_b32 v244, 1, v233
v_lshl_add_u32 v244, v244, 3, v234
v_and_b32 v244, 15, v244
v_lshrrev_b32 v245, 1, v233
v_lshl_add_u32 v244, v245, 4, v244
v_lshrrev_b32 v245, 3, v234
v_lshl_add_u32 v244, v245, 5, v244
v_lshlrev_b32 v7, 3, v244
v_lshrrev_b32 v246, 2, v0
v_and_b32 v247, 3, v0
v_and_b32 v244, 1, v247
v_lshl_add_u32 v244, v244, 3, v246
v_and_b32 v244, 15, v244
v_lshrrev_b32 v245, 1, v247
v_lshl_add_u32 v244, v245, 4, v244
v_lshrrev_b32 v245, 3, v246
v_lshl_add_u32 v244, v245, 5, v244
v_lshlrev_b32 v8, 3, v244
s_and_b32 s36, s28, 1
s_lshl_b32 s37, s36, 3
s_add_u32 s37, s37, 20480
s_lshl_b32 s36, s36, 9
v_add_u32 v244, s37, v1
v_add_u32 v245, s36, v7
s_cmp_lt_u32 s28, 2
s_cselect_b64 vcc, -1, 0
v_cndmask_b32 v9, v245, v244, vcc
v_lshlrev_b32 v239, 2, v233
v_sub_u32 v239, v239, v234
v_mov_b32 v247, 0xf149f2ca
v_add_u32 v246, 7, v239
v_cmp_gt_u32 vcc, 8, v246
v_mov_b32 v244, 0xffff
s_nop 0
v_cndmask_b32 v24, v247, 0, vcc
v_cndmask_b32 v244, 0, v244, vcc
v_mov_b32 v30, v244
v_add_u32 v246, 0, v239
v_cmp_le_i32 vcc, 9, v246
v_mov_b32 v244, 0xffff
s_nop 0
v_cndmask_b32 v20, v247, 0, vcc
v_cndmask_b32 v244, 0, v244, vcc
v_mov_b32 v28, v244
v_add_u32 v246, 8, v239
v_cmp_gt_u32 vcc, 8, v246
v_mov_b32 v244, 0xffff0000
s_nop 0
v_cndmask_b32 v25, v247, 0, vcc
v_cndmask_b32 v244, 0, v244, vcc
v_or_b32 v30, v30, v244
v_add_u32 v246, 1, v239
v_cmp_le_i32 vcc, 9, v246
v_mov_b32 v244, 0xffff0000
s_nop 0
v_cndmask_b32 v21, v247, 0, vcc
v_cndmask_b32 v244, 0, v244, vcc
v_or_b32 v28, v28, v244
v_add_u32 v246, 9, v239
v_cmp_gt_u32 vcc, 8, v246
v_mov_b32 v244, 0xffff
s_nop 0
v_cndmask_b32 v26, v247, 0, vcc
v_cndmask_b32 v244, 0, v244, vcc
v_mov_b32 v31, v244
v_add_u32 v246, 2, v239
v_cmp_le_i32 vcc, 9, v246
v_mov_b32 v244, 0xffff
s_nop 0
v_cndmask_b32 v22, v247, 0, vcc
v_cndmask_b32 v244, 0, v244, vcc
v_mov_b32 v29, v244
v_add_u32 v246, 10, v239
v_cmp_gt_u32 vcc, 8, v246
v_mov_b32 v244, 0xffff0000
s_nop 0
v_cndmask_b32 v27, v247, 0, vcc
v_cndmask_b32 v244, 0, v244, vcc
v_or_b32 v31, v31, v244
v_add_u32 v246, 3, v239
v_cmp_le_i32 vcc, 9, v246
v_mov_b32 v244, 0xffff0000
s_nop 0
v_cndmask_b32 v23, v247, 0, vcc
v_cndmask_b32 v244, 0, v244, vcc
v_or_b32 v29, v29, v244
s_and_b32 s36, s29, 3
s_or_b32 s36, s36, s28
s_cmp_eq_u32 s36, 0
s_cselect_b64 vcc, -1, 0
v_cndmask_b32 v76, v20, v247, vcc
v_cndmask_b32 v77, v21, v247, vcc
v_cndmask_b32 v78, v22, v247, vcc
v_cndmask_b32 v79, v23, v247, vcc
v_cndmask_b32 v80, v28, 0, vcc
v_cndmask_b32 v81, v29, 0, vcc
s_mov_b32 s36, 0x9e3779b1
s_waitcnt vmcnt(20)
v_mul_lo_u32 v15, v11, s36
v_add_u32 v15, 0x7f4a7c15, v15
s_and_b32 s36, s31, 1
s_lshl_b32 s36, s36, 4
s_add_u32 s36, s36, s32
s_lshl_b32 s36, s36, 2
s_add_u32 s92, s78, s36
s_add_u32 s92, s92, 0xc0000
s_lshl_b32 s36, s32, 2
s_add_u32 s93, s79, s36
s_add_u32 s93, s93, 0xc0080
s_and_b32 s94, s35, 15
s_lshl_b32 s94, s94, 9
s_lshr_b32 s36, s35, 4
s_lshl_b32 s36, s36, 2
s_add_u32 s94, s94, s36
s_add_u32 s94, s94, 0xc00c0
v_lshrrev_b32 v240, 1, v0
v_lshlrev_b32 v240, 13, v240
v_and_b32 v241, 1, v0
v_lshl_add_u32 v240, v241, 8, v240
s_mov_b32 vcc_lo, 0xffff
s_mov_b32 vcc_hi, 0
v_cndmask_b32 v240, 2.0, v240, vcc
v_lshlrev_b32 v241, 2, v0
v_add_u32 v248, 0, v248
v_add_u32 v249, 0, v249
s_add_u32 s96, s96, 0x600000
s_add_u32 s98, s98, 0x80000
s_add_u32 s97, s97, 0x600000
s_add_u32 s99, s99, 0x80000
s_cmp_eq_u32 s28, 1
s_cselect_b32 vcc_lo, 0xffff, 0
v_lshlrev_b32 v252, 12, v0
v_cndmask_b32 v252, 2.0, v252, vcc
v_cndmask_b32 v14, 2.0, v240, vcc
s_and_b32 s62, s35, 15
s_lshl_b32 s62, s62, 8
s_lshr_b32 s36, s35, 4
s_lshl_b32 s36, s36, 2
s_add_u32 s62, s62, s36
s_add_u32 s62, s62, 0xd0000
s_add_u32 s8, s94, 0x1ff40
v_and_b32 v255, 15, v0
v_lshlrev_b32 v255, 2, v255
s_waitcnt vmcnt(0)
s_barrier
s_cmp_lg_u32 s28, 1
s_cbranch_scc1 Lg1s_1
buffer_atomic_swap v15, v10, s[4:7], s92 offen sc1
buffer_atomic_swap v15, v10, s[4:7], s93 offen sc1
buffer_atomic_swap v15, v240, s[4:7], s94 offen sc1
buffer_atomic_swap v15, v252, s[4:7], s62 offen sc1
Lg1s_1:
s_branch L_aligned
.p2align 12
L_aligned:
s_mov_b64 s[20:21], s[76:77]
s_mov_b32 s22, 0x200000
s_add_u32 s89, s16, 0
buffer_load_dwordx4 a[220:223], v229, s[20:23], s89 offen nt
s_mov_b64 s[20:21], s[76:77]
s_mov_b32 s22, 0x200000
s_add_u32 s89, s16, 16384
buffer_load_dwordx4 a[224:227], v229, s[20:23], s89 offen nt
s_mov_b64 s[20:21], s[72:73]
s_mov_b32 s22, 0x600000
s_add_u32 s89, s17, 0
buffer_load_dwordx4 a[188:191], v228, s[20:23], s89 offen nt
s_mov_b64 s[20:21], s[72:73]
s_mov_b32 s22, 0x600000
s_add_u32 s89, s17, 49152
buffer_load_dwordx4 a[192:195], v228, s[20:23], s89 offen nt
s_mov_b64 s[20:21], s[72:73]
s_mov_b32 s22, 0x600000
s_add_u32 s89, s17, 2048
buffer_load_dwordx4 a[196:199], v228, s[20:23], s89 offen nt
s_mov_b64 s[20:21], s[72:73]
s_mov_b32 s22, 0x600000
s_add_u32 s89, s17, 51200
buffer_load_dwordx4 a[200:203], v228, s[20:23], s89 offen nt
s_mov_b64 s[20:21], s[72:73]
s_mov_b32 s22, 0x600000
s_add_u32 s89, s17, 4096
buffer_load_dwordx4 a[204:207], v228, s[20:23], s89 offen nt
s_mov_b64 s[20:21], s[72:73]
s_mov_b32 s22, 0x600000
s_add_u32 s89, s17, 53248
buffer_load_dwordx4 a[208:211], v228, s[20:23], s89 offen nt
s_add_u32 s89, s66, 0xd0000
ds_read_b64_tr_b16 a[240:241], v251 offset:0
ds_read_b64_tr_b16 a[242:243], v251 offset:1024
ds_read_b64_tr_b16 a[244:245], v251 offset:32
ds_read_b64_tr_b16 a[246:247], v251 offset:1056
s_lshl_b32 s36, s28, 11
v_add_u32 v231, s36, v1
s_waitcnt lgkmcnt(0)
v_add_u32 v231, 0, v231
v_cmp_eq_u32 vcc, 0, v0
s_nop 1
v_cndmask_b32 v251, 2.0, v0, vcc
s_mov_b64 exec, 0
s_cmp_eq_u32 s28, 3
s_cbranch_scc1 L_stub0
s_cmp_eq_u32 s28, 2
s_cbranch_scc1 L_stub1
s_cmp_eq_u32 s28, 1
s_cbranch_scc1 L_stub2
L_wret0:
s_mov_b64 exec, -1
s_cmp_lg_u32 s28, 0
s_cbranch_scc1 Lg1e_3
s_cmp_eq_u32 s54, 32
s_cselect_b32 s39, 0xffff0000, -1
s_mov_b32 s38, -1
s_add_u32 s36, s67, 0xc0000
s_mov_b32 s37, 0
Lg1p_2:
v_mov_b32 v11, 0
buffer_atomic_add v11, v241, s[4:7], s36 offen sc0 sc1
s_add_u32 s37, s37, 1
v_mov_b32 v242, v15
s_mov_b64 exec, 0xffff
v_mov_b32 v242, 0
buffer_atomic_add v242, v241, s[4:7], s89 offen sc0 sc1
s_mov_b64 exec, -1
s_waitcnt vmcnt(0)
v_cmp_ne_u32 vcc, v11, v15
v_cmp_ne_u32 s[52:53], v242, v15
s_and_b64 vcc, vcc, s[38:39]
s_or_b64 vcc, vcc, s[52:53]
s_cbranch_scc0 Lg1e_3
s_cmp_lt_u32 s37, 0x100000
s_cbranch_scc1 Lg1p_2
Lg1e_3:
s_barrier
s_add_u32 s94, s71, 0x80
s_add_u32 s9, s66, 0x80
s_add_u32 m0, s18, 0x0
s_add_u32 s44, s50, 0xe00000
buffer_load_dwordx4 v1, s[4:7], s44 offen offset:0 sc1 lds
buffer_load_dwordx4 v1, s[4:7], s44 offen offset:1024 sc1 lds
buffer_load_dwordx4 v1, s[4:7], s44 offen offset:2048 sc1 lds
s_add_u32 m0, s18, 0x3000
s_add_u32 s44, s50, 0xe03000
buffer_load_dwordx4 v1, s[4:7], s44 offen offset:0 sc1 lds
buffer_load_dwordx4 v1, s[4:7], s44 offen offset:1024 sc1 lds
buffer_load_dwordx4 v1, s[4:7], s44 offen offset:2048 sc1 lds
s_add_u32 m0, s18, 0x6000
s_add_u32 s44, s50, 0xe06000
buffer_load_dwordx4 v1, s[4:7], s44 offen offset:0 sc1 lds
buffer_load_dwordx4 v1, s[4:7], s44 offen offset:1024 sc1 lds
buffer_load_dwordx4 v1, s[4:7], s44 offen offset:2048 sc1 lds
s_add_u32 m0, s18, 0x9000
s_add_u32 s44, s50, 0xe09000
buffer_load_dwordx4 v1, s[4:7], s44 offen offset:0 sc1 lds
buffer_load_dwordx4 v1, s[4:7], s44 offen offset:1024 sc1 lds
buffer_load_dwordx4 v1, s[4:7], s44 offen offset:2048 sc1 lds
s_mov_b32 s35, 0
s_mov_b32 s33, 0x1000
buffer_load_dwordx4 a[0:3], v2, s[40:43], s35 offen offset:0 sc1
buffer_load_dwordx4 a[4:7], v2, s[40:43], s33 offen offset:0 sc1
buffer_load_dwordx4 a[8:11], v2, s[40:43], s35 offen offset:1024 sc1
buffer_load_dwordx4 a[12:15], v2, s[40:43], s33 offen offset:1024 sc1
buffer_load_dwordx4 a[16:19], v2, s[40:43], s35 offen offset:2048 sc1
buffer_load_dwordx4 a[20:23], v2, s[40:43], s33 offen offset:2048 sc1
buffer_load_dwordx4 a[24:27], v2, s[40:43], s35 offen offset:3072 sc1
buffer_load_dwordx4 a[28:31], v2, s[40:43], s33 offen offset:3072 sc1
s_add_u32 s35, s35, 8192
s_add_u32 s33, s33, 8192
s_add_u32 s63, s28, 0
s_lshl_b32 s63, s63, 12
buffer_load_dwordx4 a[160:163], v3, s[40:43], s63 offen sc1
buffer_load_dwordx4 a[32:35], v2, s[40:43], s35 offen offset:0 sc1
buffer_load_dwordx4 a[36:39], v2, s[40:43], s33 offen offset:0 sc1
buffer_load_dwordx4 a[40:43], v2, s[40:43], s35 offen offset:1024 sc1
buffer_load_dwordx4 a[44:47], v2, s[40:43], s33 offen offset:1024 sc1
buffer_load_dwordx4 a[48:51], v2, s[40:43], s35 offen offset:2048 sc1
buffer_load_dwordx4 a[52:55], v2, s[40:43], s33 offen offset:2048 sc1
buffer_load_dwordx4 a[56:59], v2, s[40:43], s35 offen offset:3072 sc1
buffer_load_dwordx4 a[60:63], v2, s[40:43], s33 offen offset:3072 sc1
s_add_u32 s35, s35, 8192
s_add_u32 s33, s33, 8192
s_waitcnt vmcnt(17)
s_barrier
v_add_u32 v5, 0, v1
v_add_u32 v6, s55, v5
ds_read_b128 a[96:99], v5 offset:2048
ds_read_b128 a[100:103], v5 offset:8192
ds_read_b128 a[104:107], v5 offset:3072
ds_read_b128 a[108:111], v5 offset:9216
ds_read_b128 a[112:115], v5 offset:4096
ds_read_b128 a[116:119], v5 offset:10240
ds_read_b128 a[120:123], v6 offset:2048
s_waitcnt vmcnt(15) lgkmcnt(5)
v_mfma_f32_16x16x32_bf16 v[140:143], a[96:99], a[0:3], 0
s_add_u32 m0, s18, 0xc000
s_add_u32 s44, s50, 0xe0c000
v_mfma_f32_16x16x32_bf16 v[140:143], a[100:103], a[4:7], v[140:143]
buffer_load_dwordx4 a[64:67], v2, s[40:43], s35 offen offset:0 sc1
s_waitcnt vmcnt(14)
v_mfma_f32_16x16x32_bf16 v[164:167], a[100:103], a[12:15], 0
ds_read_b128 a[128:131], v5 offset:5120
v_mfma_f32_16x16x32_bf16 v[164:167], a[96:99], a[8:11], v[164:167]
ds_read_b128 a[132:135], v5 offset:11264
s_waitcnt vmcnt(13)
v_mfma_f32_16x16x32_bf16 v[188:191], a[96:99], a[16:19], 0
ds_read_b128 a[136:139], v5 offset:0
s_waitcnt vmcnt(12)
v_mfma_f32_16x16x32_bf16 v[188:191], a[100:103], a[20:23], v[188:191]
buffer_load_dwordx4 v1, s[4:7], s44 offen offset:0 sc1 lds
s_add_u32 s63, s28, 4
s_waitcnt vmcnt(11)
v_mfma_f32_16x16x32_bf16 v[212:215], a[100:103], a[28:31], 0
s_lshl_b32 s63, s63, 12
ds_read_b128 a[140:143], v5 offset:6144
v_mfma_f32_16x16x32_bf16 v[212:215], a[96:99], a[24:27], v[212:215]
s_waitcnt lgkmcnt(8)
v_mfma_f32_16x16x32_bf16 v[216:219], a[104:107], a[24:27], 0
s_waitcnt lgkmcnt(7)
v_mfma_f32_16x16x32_bf16 v[216:219], a[108:111], a[28:31], v[216:219]
buffer_load_dwordx4 a[68:71], v2, s[40:43], s33 offen offset:0 sc1
v_mfma_f32_16x16x32_bf16 v[192:195], a[108:111], a[20:23], 0
ds_read_b128 a[144:147], v5 offset:1024
v_mfma_f32_16x16x32_bf16 v[192:195], a[104:107], a[16:19], v[192:195]
ds_read_b128 a[148:151], v5 offset:7168
v_mfma_f32_16x16x32_bf16 v[168:171], a[104:107], a[8:11], 0
v_mfma_f32_16x16x32_bf16 v[168:171], a[108:111], a[12:15], v[168:171]
buffer_load_dwordx4 a[72:75], v2, s[40:43], s35 offen offset:1024 sc1
v_mfma_f32_16x16x32_bf16 v[144:147], a[108:111], a[4:7], 0
ds_read_b128 a[152:155], v6 offset:3072
v_mfma_f32_16x16x32_bf16 v[144:147], a[104:107], a[0:3], v[144:147]
s_waitcnt lgkmcnt(9)
v_mfma_f32_16x16x32_bf16 v[148:151], a[112:115], a[0:3], 0
s_waitcnt lgkmcnt(8)
v_mfma_f32_16x16x32_bf16 v[148:151], a[116:119], a[4:7], v[148:151]
buffer_load_dwordx4 a[164:167], v3, s[40:43], s63 offen sc1
v_mfma_f32_16x16x32_bf16 v[172:175], a[116:119], a[12:15], 0
v_mfma_f32_16x16x32_bf16 v[172:175], a[112:115], a[8:11], v[172:175]
v_mfma_f32_16x16x32_bf16 v[196:199], a[112:115], a[16:19], 0
v_mfma_f32_16x16x32_bf16 v[196:199], a[116:119], a[20:23], v[196:199]
buffer_load_dwordx4 a[76:79], v2, s[40:43], s33 offen offset:1024 sc1
v_mfma_f32_16x16x32_bf16 v[220:223], a[116:119], a[28:31], 0
v_mfma_f32_16x16x32_bf16 v[220:223], a[112:115], a[24:27], v[220:223]
s_waitcnt vmcnt(14) lgkmcnt(7)
v_mfma_f32_16x16x32_bf16 a[172:175], a[120:123], a[160:163], 0
s_waitcnt lgkmcnt(0)
v_mfma_f32_16x16x32_bf16 v[224:227], a[128:131], a[24:27], 0
ds_read_b128 a[96:99], v5 offset:14336
v_mfma_f32_16x16x32_bf16 v[224:227], a[132:135], a[28:31], v[224:227]
buffer_load_dwordx4 a[80:83], v2, s[40:43], s35 offen offset:2048 sc1
v_mfma_f32_16x16x32_bf16 v[200:203], a[132:135], a[20:23], 0
ds_read_b128 a[100:103], v5 offset:20480
v_mfma_f32_16x16x32_bf16 v[200:203], a[128:131], a[16:19], v[200:203]
v_mfma_f32_16x16x32_bf16 v[176:179], a[128:131], a[8:11], 0
buffer_load_dwordx4 v1, s[4:7], s44 offen offset:1024 sc1 lds
v_mfma_f32_16x16x32_bf16 v[176:179], a[132:135], a[12:15], v[176:179]
ds_read_b128 a[104:107], v5 offset:15360
v_mfma_f32_16x16x32_bf16 v[152:155], a[132:135], a[4:7], 0
ds_read_b128 a[108:111], v5 offset:21504
v_mfma_f32_16x16x32_bf16 v[152:155], a[128:131], a[0:3], v[152:155]
v_mfma_f32_16x16x32_bf16 v[132:135], a[136:139], a[0:3], 0
buffer_load_dwordx4 a[84:87], v2, s[40:43], s33 offen offset:2048 sc1
v_mfma_f32_16x16x32_bf16 v[132:135], a[140:143], a[4:7], v[132:135]
ds_read_b128 a[112:115], v5 offset:16384
v_mfma_f32_16x16x32_bf16 v[156:159], a[140:143], a[12:15], 0
v_mfma_f32_16x16x32_bf16 v[156:159], a[136:139], a[8:11], v[156:159]
buffer_load_dwordx4 v1, s[4:7], s44 offen offset:2048 sc1 lds
s_add_u32 m0, s18, 0xf000
v_mfma_f32_16x16x32_bf16 v[180:183], a[136:139], a[16:19], 0
s_add_u32 s44, s50, 0xe0f000
ds_read_b128 a[116:119], v5 offset:22528
v_mfma_f32_16x16x32_bf16 v[180:183], a[140:143], a[20:23], v[180:183]
ds_read_b128 a[120:123], v6 offset:4096
v_mfma_f32_16x16x32_bf16 v[204:207], a[140:143], a[28:31], 0
v_mfma_f32_16x16x32_bf16 v[204:207], a[136:139], a[24:27], v[204:207]
buffer_load_dwordx4 a[88:91], v2, s[40:43], s35 offen offset:3072 sc1
v_mfma_f32_16x16x32_bf16 v[208:211], a[144:147], a[24:27], 0
v_mfma_f32_16x16x32_bf16 v[208:211], a[148:151], a[28:31], v[208:211]
v_mfma_f32_16x16x32_bf16 v[184:187], a[148:151], a[20:23], 0
buffer_load_dwordx4 v1, s[4:7], s44 offen offset:0 sc1 lds
v_mfma_f32_16x16x32_bf16 v[184:187], a[144:147], a[16:19], v[184:187]
v_mfma_f32_16x16x32_bf16 v[160:163], a[144:147], a[8:11], 0
v_mfma_f32_16x16x32_bf16 v[160:163], a[148:151], a[12:15], v[160:163]
v_mfma_f32_16x16x32_bf16 v[136:139], a[148:151], a[4:7], 0
buffer_load_dwordx4 a[92:95], v2, s[40:43], s33 offen offset:3072 sc1
s_add_u32 s35, s35, 8192
v_mfma_f32_16x16x32_bf16 v[136:139], a[144:147], a[0:3], v[136:139]
s_add_u32 s33, s33, 8192
v_mfma_f32_16x16x32_bf16 a[176:179], a[152:155], a[160:163], 0
s_waitcnt vmcnt(13) lgkmcnt(0)
v_mfma_f32_16x16x32_bf16 v[140:143], a[96:99], a[32:35], v[140:143]
ds_read_b128 a[128:131], v5 offset:17408
v_mfma_f32_16x16x32_bf16 v[140:143], a[100:103], a[36:39], v[140:143]
buffer_load_dwordx4 a[0:3], v2, s[40:43], s35 offen offset:0 sc1
v_mfma_f32_16x16x32_bf16 v[164:167], a[100:103], a[44:47], v[164:167]
ds_read_b128 a[132:135], v5 offset:23552
v_mfma_f32_16x16x32_bf16 v[164:167], a[96:99], a[40:43], v[164:167]
v_mfma_f32_16x16x32_bf16 v[188:191], a[96:99], a[48:51], v[188:191]
ds_read_b128 a[136:139], v5 offset:12288
v_mfma_f32_16x16x32_bf16 v[188:191], a[100:103], a[52:55], v[188:191]
buffer_load_dwordx4 v1, s[4:7], s44 offen offset:1024 sc1 lds
v_mfma_f32_16x16x32_bf16 v[212:215], a[100:103], a[60:63], v[212:215]
ds_read_b128 a[140:143], v5 offset:18432
v_mfma_f32_16x16x32_bf16 v[212:215], a[96:99], a[56:59], v[212:215]
v_mfma_f32_16x16x32_bf16 v[216:219], a[104:107], a[56:59], v[216:219]
v_mfma_f32_16x16x32_bf16 v[216:219], a[108:111], a[60:63], v[216:219]
buffer_load_dwordx4 a[4:7], v2, s[40:43], s33 offen offset:0 sc1
v_mfma_f32_16x16x32_bf16 v[192:195], a[108:111], a[52:55], v[192:195]
ds_read_b128 a[144:147], v5 offset:13312
v_mfma_f32_16x16x32_bf16 v[192:195], a[104:107], a[48:51], v[192:195]
ds_read_b128 a[148:151], v5 offset:19456
v_mfma_f32_16x16x32_bf16 v[168:171], a[104:107], a[40:43], v[168:171]
v_mfma_f32_16x16x32_bf16 v[168:171], a[108:111], a[44:47], v[168:171]
buffer_load_dwordx4 a[8:11], v2, s[40:43], s35 offen offset:1024 sc1
v_mfma_f32_16x16x32_bf16 v[144:147], a[108:111], a[36:39], v[144:147]
ds_read_b128 a[152:155], v6 offset:5120
v_mfma_f32_16x16x32_bf16 v[144:147], a[104:107], a[32:35], v[144:147]
v_mfma_f32_16x16x32_bf16 v[148:151], a[112:115], a[32:35], v[148:151]
v_mfma_f32_16x16x32_bf16 v[148:151], a[116:119], a[36:39], v[148:151]
buffer_load_dwordx4 v1, s[4:7], s44 offen offset:2048 sc1 lds
s_add_u32 m0, s18, 0x12000
v_mfma_f32_16x16x32_bf16 v[172:175], a[116:119], a[44:47], v[172:175]
s_add_u32 s44, s50, 0xe12000
v_mfma_f32_16x16x32_bf16 v[172:175], a[112:115], a[40:43], v[172:175]
v_mfma_f32_16x16x32_bf16 v[196:199], a[112:115], a[48:51], v[196:199]
v_mfma_f32_16x16x32_bf16 v[196:199], a[116:119], a[52:55], v[196:199]
buffer_load_dwordx4 a[12:15], v2, s[40:43], s33 offen offset:1024 sc1
v_mfma_f32_16x16x32_bf16 v[220:223], a[116:119], a[60:63], v[220:223]
v_mfma_f32_16x16x32_bf16 v[220:223], a[112:115], a[56:59], v[220:223]
v_mfma_f32_16x16x32_bf16 a[180:183], a[120:123], a[160:163], 0
s_waitcnt lgkmcnt(0)
v_mfma_f32_16x16x32_bf16 v[224:227], a[128:131], a[56:59], v[224:227]
ds_read_b128 a[96:99], v5 offset:26624
v_mfma_f32_16x16x32_bf16 v[224:227], a[132:135], a[60:63], v[224:227]
buffer_load_dwordx4 a[16:19], v2, s[40:43], s35 offen offset:2048 sc1
v_mfma_f32_16x16x32_bf16 v[200:203], a[132:135], a[52:55], v[200:203]
ds_read_b128 a[100:103], v5 offset:32768
v_mfma_f32_16x16x32_bf16 v[200:203], a[128:131], a[48:51], v[200:203]
v_mfma_f32_16x16x32_bf16 v[176:179], a[128:131], a[40:43], v[176:179]
buffer_load_dwordx4 v1, s[4:7], s44 offen offset:0 sc1 lds
v_mfma_f32_16x16x32_bf16 v[176:179], a[132:135], a[44:47], v[176:179]
ds_read_b128 a[104:107], v5 offset:27648
v_mfma_f32_16x16x32_bf16 v[152:155], a[132:135], a[36:39], v[152:155]
ds_read_b128 a[108:111], v5 offset:33792
v_mfma_f32_16x16x32_bf16 v[152:155], a[128:131], a[32:35], v[152:155]
v_mfma_f32_16x16x32_bf16 v[132:135], a[136:139], a[32:35], v[132:135]
buffer_load_dwordx4 a[20:23], v2, s[40:43], s33 offen offset:2048 sc1
v_mfma_f32_16x16x32_bf16 v[132:135], a[140:143], a[36:39], v[132:135]
ds_read_b128 a[112:115], v5 offset:28672
v_mfma_f32_16x16x32_bf16 v[156:159], a[140:143], a[44:47], v[156:159]
v_mfma_f32_16x16x32_bf16 v[156:159], a[136:139], a[40:43], v[156:159]
buffer_load_dwordx4 v1, s[4:7], s44 offen offset:1024 sc1 lds
v_mfma_f32_16x16x32_bf16 v[180:183], a[136:139], a[48:51], v[180:183]
ds_read_b128 a[116:119], v5 offset:34816
v_mfma_f32_16x16x32_bf16 v[180:183], a[140:143], a[52:55], v[180:183]
ds_read_b128 a[120:123], v6 offset:26624
v_mfma_f32_16x16x32_bf16 v[204:207], a[140:143], a[60:63], v[204:207]
v_mfma_f32_16x16x32_bf16 v[204:207], a[136:139], a[56:59], v[204:207]
buffer_load_dwordx4 a[24:27], v2, s[40:43], s35 offen offset:3072 sc1
v_mfma_f32_16x16x32_bf16 v[208:211], a[144:147], a[56:59], v[208:211]
v_mfma_f32_16x16x32_bf16 v[208:211], a[148:151], a[60:63], v[208:211]
v_mfma_f32_16x16x32_bf16 v[184:187], a[148:151], a[52:55], v[184:187]
buffer_load_dwordx4 v1, s[4:7], s44 offen offset:2048 sc1 lds
s_add_u32 m0, s18, 0x15000
v_mfma_f32_16x16x32_bf16 v[184:187], a[144:147], a[48:51], v[184:187]
s_add_u32 s44, s50, 0xe15000
v_mfma_f32_16x16x32_bf16 v[160:163], a[144:147], a[40:43], v[160:163]
v_mfma_f32_16x16x32_bf16 v[160:163], a[148:151], a[44:47], v[160:163]
v_mfma_f32_16x16x32_bf16 v[136:139], a[148:151], a[36:39], v[136:139]
buffer_load_dwordx4 a[28:31], v2, s[40:43], s33 offen offset:3072 sc1
s_add_u32 s35, s35, 8192
v_mfma_f32_16x16x32_bf16 v[136:139], a[144:147], a[32:35], v[136:139]
s_add_u32 s33, s33, 8192
v_mfma_f32_16x16x32_bf16 a[184:187], a[152:155], a[160:163], 0
s_waitcnt vmcnt(13) lgkmcnt(0)
v_mfma_f32_16x16x32_bf16 v[140:143], a[96:99], a[64:67], v[140:143]
ds_read_b128 a[128:131], v5 offset:29696
v_mfma_f32_16x16x32_bf16 v[140:143], a[100:103], a[68:71], v[140:143]
buffer_load_dwordx4 a[32:35], v2, s[40:43], s35 offen offset:0 sc1
v_mfma_f32_16x16x32_bf16 v[164:167], a[100:103], a[76:79], v[164:167]
ds_read_b128 a[132:135], v5 offset:35840
v_mfma_f32_16x16x32_bf16 v[164:167], a[96:99], a[72:75], v[164:167]
v_mfma_f32_16x16x32_bf16 v[188:191], a[96:99], a[80:83], v[188:191]
ds_read_b128 a[136:139], v5 offset:24576
v_mfma_f32_16x16x32_bf16 v[188:191], a[100:103], a[84:87], v[188:191]
buffer_load_dwordx4 v1, s[4:7], s44 offen offset:0 sc1 lds
s_add_u32 s63, s28, 8
v_mfma_f32_16x16x32_bf16 v[212:215], a[100:103], a[92:95], v[212:215]
s_lshl_b32 s63, s63, 12
ds_read_b128 a[140:143], v5 offset:30720
v_mfma_f32_16x16x32_bf16 v[212:215], a[96:99], a[88:91], v[212:215]
v_mfma_f32_16x16x32_bf16 v[216:219], a[104:107], a[88:91], v[216:219]
v_mfma_f32_16x16x32_bf16 v[216:219], a[108:111], a[92:95], v[216:219]
buffer_load_dwordx4 a[36:39], v2, s[40:43], s33 offen offset:0 sc1
v_mfma_f32_16x16x32_bf16 v[192:195], a[108:111], a[84:87], v[192:195]
ds_read_b128 a[144:147], v5 offset:25600
v_mfma_f32_16x16x32_bf16 v[192:195], a[104:107], a[80:83], v[192:195]
ds_read_b128 a[148:151], v5 offset:31744
v_mfma_f32_16x16x32_bf16 v[168:171], a[104:107], a[72:75], v[168:171]
v_mfma_f32_16x16x32_bf16 v[168:171], a[108:111], a[76:79], v[168:171]
buffer_load_dwordx4 a[40:43], v2, s[40:43], s35 offen offset:1024 sc1
v_mfma_f32_16x16x32_bf16 v[144:147], a[108:111], a[68:71], v[144:147]
ds_read_b128 a[152:155], v6 offset:27648
v_mfma_f32_16x16x32_bf16 v[144:147], a[104:107], a[64:67], v[144:147]
v_mfma_f32_16x16x32_bf16 v[148:151], a[112:115], a[64:67], v[148:151]
v_mfma_f32_16x16x32_bf16 v[148:151], a[116:119], a[68:71], v[148:151]
buffer_load_dwordx4 a[168:171], v3, s[40:43], s63 offen sc1
v_mfma_f32_16x16x32_bf16 v[172:175], a[116:119], a[76:79], v[172:175]
v_mfma_f32_16x16x32_bf16 v[172:175], a[112:115], a[72:75], v[172:175]
v_mfma_f32_16x16x32_bf16 v[196:199], a[112:115], a[80:83], v[196:199]
v_mfma_f32_16x16x32_bf16 v[196:199], a[116:119], a[84:87], v[196:199]
buffer_load_dwordx4 a[44:47], v2, s[40:43], s33 offen offset:1024 sc1
v_mfma_f32_16x16x32_bf16 v[220:223], a[116:119], a[92:95], v[220:223]
v_mfma_f32_16x16x32_bf16 v[220:223], a[112:115], a[88:91], v[220:223]
v_mfma_f32_16x16x32_bf16 a[172:175], a[120:123], a[164:167], a[172:175]
s_waitcnt lgkmcnt(0)
v_mfma_f32_16x16x32_bf16 v[224:227], a[128:131], a[88:91], v[224:227]
ds_read_b128 a[96:99], v5 offset:38912
v_mfma_f32_16x16x32_bf16 v[224:227], a[132:135], a[92:95], v[224:227]
buffer_load_dwordx4 a[48:51], v2, s[40:43], s35 offen offset:2048 sc1
v_mfma_f32_16x16x32_bf16 v[200:203], a[132:135], a[84:87], v[200:203]
ds_read_b128 a[100:103], v5 offset:45056
v_mfma_f32_16x16x32_bf16 v[200:203], a[128:131], a[80:83], v[200:203]
v_mfma_f32_16x16x32_bf16 v[176:179], a[128:131], a[72:75], v[176:179]
buffer_load_dwordx4 v1, s[4:7], s44 offen offset:1024 sc1 lds
v_mfma_f32_16x16x32_bf16 v[176:179], a[132:135], a[76:79], v[176:179]
ds_read_b128 a[104:107], v5 offset:39936
v_mfma_f32_16x16x32_bf16 v[152:155], a[132:135], a[68:71], v[152:155]
ds_read_b128 a[108:111], v5 offset:46080
v_mfma_f32_16x16x32_bf16 v[152:155], a[128:131], a[64:67], v[152:155]
v_mfma_f32_16x16x32_bf16 v[132:135], a[136:139], a[64:67], v[132:135]
buffer_load_dwordx4 a[52:55], v2, s[40:43], s33 offen offset:2048 sc1
v_mfma_f32_16x16x32_bf16 v[132:135], a[140:143], a[68:71], v[132:135]
ds_read_b128 a[112:115], v5 offset:40960
v_mfma_f32_16x16x32_bf16 v[156:159], a[140:143], a[76:79], v[156:159]
v_mfma_f32_16x16x32_bf16 v[156:159], a[136:139], a[72:75], v[156:159]
buffer_load_dwordx4 v1, s[4:7], s44 offen offset:2048 sc1 lds
v_mfma_f32_16x16x32_bf16 v[180:183], a[136:139], a[80:83], v[180:183]
v_and_b32 v232, 15, v0
v_lshlrev_b32 v232, 7, v232
v_mfma_f32_16x16x32_bf16 v[180:183], a[140:143], a[84:87], v[180:183]
v_lshrrev_b32 v233, 4, v0
v_lshlrev_b32 v233, 4, v233
v_mfma_f32_16x16x32_bf16 v[204:207], a[140:143], a[92:95], v[204:207]
v_add_u32 v232, v233, v232
s_mul_i32 s38, s30, 12288
v_mfma_f32_16x16x32_bf16 v[204:207], a[136:139], a[88:91], v[204:207]
buffer_load_dwordx4 a[56:59], v2, s[40:43], s35 offen offset:3072 sc1
s_add_u32 s38, s38, 0x300000
v_mfma_f32_16x16x32_bf16 v[208:211], a[144:147], a[88:91], v[208:211]
s_add_u32 s39, s28, 4
s_min_u32 s39, s39, 5
s_lshl_b32 s36, s28, 11
v_mfma_f32_16x16x32_bf16 v[208:211], a[148:151], a[92:95], v[208:211]
s_add_u32 s36, s36, s38
s_lshl_b32 s37, s39, 11
s_add_u32 s37, s37, s38
v_mfma_f32_16x16x32_bf16 v[184:187], a[148:151], a[84:87], v[184:187]
buffer_load_dwordx4 v[48:51], v232, s[4:7], s36 offen sc1
v_mfma_f32_16x16x32_bf16 v[184:187], a[144:147], a[80:83], v[184:187]
ds_read_b128 a[116:119], v5 offset:47104
v_mfma_f32_16x16x32_bf16 v[160:163], a[144:147], a[72:75], v[160:163]
ds_read_b128 a[120:123], v6 offset:28672
v_mfma_f32_16x16x32_bf16 v[160:163], a[148:151], a[76:79], v[160:163]
v_mfma_f32_16x16x32_bf16 v[136:139], a[148:151], a[68:71], v[136:139]
buffer_load_dwordx4 a[60:63], v2, s[40:43], s33 offen offset:3072 sc1
s_add_u32 s35, s35, 8192
v_mfma_f32_16x16x32_bf16 v[136:139], a[144:147], a[64:67], v[136:139]
s_add_u32 s33, s33, 8192
v_mfma_f32_16x16x32_bf16 a[176:179], a[152:155], a[164:167], a[176:179]
s_waitcnt vmcnt(13) lgkmcnt(0)
v_mfma_f32_16x16x32_bf16 v[140:143], a[96:99], a[0:3], v[140:143]
ds_read_b128 a[128:131], v5 offset:41984
v_mfma_f32_16x16x32_bf16 v[140:143], a[100:103], a[4:7], v[140:143]
buffer_load_dwordx4 a[64:67], v2, s[40:43], s35 offen offset:0 sc1
v_mfma_f32_16x16x32_bf16 v[164:167], a[100:103], a[12:15], v[164:167]
ds_read_b128 a[132:135], v5 offset:48128
v_mfma_f32_16x16x32_bf16 v[164:167], a[96:99], a[8:11], v[164:167]
v_mfma_f32_16x16x32_bf16 v[188:191], a[96:99], a[16:19], v[188:191]
ds_read_b128 a[136:139], v5 offset:36864
v_mfma_f32_16x16x32_bf16 v[188:191], a[100:103], a[20:23], v[188:191]
buffer_load_dwordx4 v[52:55], v232, s[4:7], s37 offen sc1
s_add_u32 m0, s18, 0x18000
v_mfma_f32_16x16x32_bf16 v[212:215], a[100:103], a[28:31], v[212:215]
s_add_u32 s44, s50, 0xe18000
ds_read_b128 a[140:143], v5 offset:43008
v_mfma_f32_16x16x32_bf16 v[212:215], a[96:99], a[24:27], v[212:215]
v_mfma_f32_16x16x32_bf16 v[216:219], a[104:107], a[24:27], v[216:219]
v_mfma_f32_16x16x32_bf16 v[216:219], a[108:111], a[28:31], v[216:219]
buffer_load_dwordx4 a[68:71], v2, s[40:43], s33 offen offset:0 sc1
v_mfma_f32_16x16x32_bf16 v[192:195], a[108:111], a[20:23], v[192:195]
ds_read_b128 a[144:147], v5 offset:37888
v_mfma_f32_16x16x32_bf16 v[192:195], a[104:107], a[16:19], v[192:195]
ds_read_b128 a[148:151], v5 offset:44032
v_mfma_f32_16x16x32_bf16 v[168:171], a[104:107], a[8:11], v[168:171]
v_mfma_f32_16x16x32_bf16 v[168:171], a[108:111], a[12:15], v[168:171]
buffer_load_dwordx4 a[72:75], v2, s[40:43], s35 offen offset:1024 sc1
v_mfma_f32_16x16x32_bf16 v[144:147], a[108:111], a[4:7], v[144:147]
ds_read_b128 a[152:155], v6 offset:29696
v_mfma_f32_16x16x32_bf16 v[144:147], a[104:107], a[0:3], v[144:147]
v_mfma_f32_16x16x32_bf16 v[148:151], a[112:115], a[0:3], v[148:151]
v_mfma_f32_16x16x32_bf16 v[148:151], a[116:119], a[4:7], v[148:151]
buffer_load_dwordx4 v1, s[4:7], s44 offen offset:0 sc1 lds
v_mfma_f32_16x16x32_bf16 v[172:175], a[116:119], a[12:15], v[172:175]
v_mfma_f32_16x16x32_bf16 v[172:175], a[112:115], a[8:11], v[172:175]
v_mfma_f32_16x16x32_bf16 v[196:199], a[112:115], a[16:19], v[196:199]
v_mfma_f32_16x16x32_bf16 v[196:199], a[116:119], a[20:23], v[196:199]
buffer_load_dwordx4 a[76:79], v2, s[40:43], s33 offen offset:1024 sc1
v_mfma_f32_16x16x32_bf16 v[220:223], a[116:119], a[28:31], v[220:223]
v_mfma_f32_16x16x32_bf16 v[220:223], a[112:115], a[24:27], v[220:223]
v_mfma_f32_16x16x32_bf16 a[180:183], a[120:123], a[164:167], a[180:183]
s_waitcnt lgkmcnt(0)
s_barrier
v_mfma_f32_16x16x32_bf16 v[224:227], a[128:131], a[24:27], v[224:227]
v_add_u32 v5, 49152, v1
v_add_u32 v6, s55, v5
v_mfma_f32_16x16x32_bf16 v[224:227], a[132:135], a[28:31], v[224:227]
buffer_load_dwordx4 a[80:83], v2, s[40:43], s35 offen offset:2048 sc1
v_mfma_f32_16x16x32_bf16 v[200:203], a[132:135], a[20:23], v[200:203]
ds_read_b128 a[96:99], v5 offset:2048
v_mfma_f32_16x16x32_bf16 v[200:203], a[128:131], a[16:19], v[200:203]
ds_read_b128 a[100:103], v5 offset:8192
v_mfma_f32_16x16x32_bf16 v[176:179], a[128:131], a[8:11], v[176:179]
buffer_load_dwordx4 v1, s[4:7], s44 offen offset:1024 sc1 lds
v_mfma_f32_16x16x32_bf16 v[176:179], a[132:135], a[12:15], v[176:179]
ds_read_b128 a[104:107], v5 offset:3072
v_mfma_f32_16x16x32_bf16 v[152:155], a[132:135], a[4:7], v[152:155]
ds_read_b128 a[108:111], v5 offset:9216
v_mfma_f32_16x16x32_bf16 v[152:155], a[128:131], a[0:3], v[152:155]
ds_write_b128 v231, a[220:223] offset:24576
v_mfma_f32_16x16x32_bf16 v[132:135], a[136:139], a[0:3], v[132:135]
buffer_load_dwordx4 a[84:87], v2, s[40:43], s33 offen offset:2048 sc1
v_mfma_f32_16x16x32_bf16 v[132:135], a[140:143], a[4:7], v[132:135]
ds_read_b128 a[112:115], v5 offset:4096
v_mfma_f32_16x16x32_bf16 v[156:159], a[140:143], a[12:15], v[156:159]
v_mfma_f32_16x16x32_bf16 v[156:159], a[136:139], a[8:11], v[156:159]
buffer_load_dwordx4 v1, s[4:7], s44 offen offset:2048 sc1 lds
s_add_u32 m0, s18, 0x1b000
v_mfma_f32_16x16x32_bf16 v[180:183], a[136:139], a[16:19], v[180:183]
s_add_u32 s44, s50, 0xe1b000
ds_read_b128 a[116:119], v5 offset:10240
v_mfma_f32_16x16x32_bf16 v[180:183], a[140:143], a[20:23], v[180:183]
ds_read_b128 a[120:123], v6 offset:2048
v_mfma_f32_16x16x32_bf16 v[204:207], a[140:143], a[28:31], v[204:207]
ds_write_b128 v231, a[224:227] offset:25600
v_mfma_f32_16x16x32_bf16 v[204:207], a[136:139], a[24:27], v[204:207]
buffer_load_dwordx4 a[88:91], v2, s[40:43], s35 offen offset:3072 sc1
v_mfma_f32_16x16x32_bf16 v[208:211], a[144:147], a[24:27], v[208:211]
v_mfma_f32_16x16x32_bf16 v[208:211], a[148:151], a[28:31], v[208:211]
v_mfma_f32_16x16x32_bf16 v[184:187], a[148:151], a[20:23], v[184:187]
buffer_load_dwordx4 v1, s[4:7], s44 offen offset:0 sc1 lds
v_mfma_f32_16x16x32_bf16 v[184:187], a[144:147], a[16:19], v[184:187]
v_mfma_f32_16x16x32_bf16 v[160:163], a[144:147], a[8:11], v[160:163]
v_mfma_f32_16x16x32_bf16 v[160:163], a[148:151], a[12:15], v[160:163]
v_mfma_f32_16x16x32_bf16 v[136:139], a[148:151], a[4:7], v[136:139]
buffer_load_dwordx4 a[92:95], v2, s[40:43], s33 offen offset:3072 sc1
s_add_u32 s35, s35, 8192
v_mfma_f32_16x16x32_bf16 v[136:139], a[144:147], a[0:3], v[136:139]
s_add_u32 s33, s33, 8192
ds_write_b128 v231, a[188:191] offset:0
v_mfma_f32_16x16x32_bf16 a[184:187], a[152:155], a[164:167], a[184:187]
s_waitcnt vmcnt(13) lgkmcnt(2)
v_mfma_f32_16x16x32_bf16 v[140:143], a[96:99], a[32:35], v[140:143]
ds_read_b128 a[128:131], v5 offset:5120
v_mfma_f32_16x16x32_bf16 v[140:143], a[100:103], a[36:39], v[140:143]
buffer_load_dwordx4 a[0:3], v2, s[40:43], s35 offen offset:0 sc1
v_mfma_f32_16x16x32_bf16 v[164:167], a[100:103], a[44:47], v[164:167]
ds_read_b128 a[132:135], v5 offset:11264
v_mfma_f32_16x16x32_bf16 v[164:167], a[96:99], a[40:43], v[164:167]
v_mfma_f32_16x16x32_bf16 v[188:191], a[96:99], a[48:51], v[188:191]
ds_read_b128 a[136:139], v5 offset:0
v_mfma_f32_16x16x32_bf16 v[188:191], a[100:103], a[52:55], v[188:191]
buffer_load_dwordx4 v1, s[4:7], s44 offen offset:1024 sc1 lds
s_add_u32 s63, s28, 12
v_mfma_f32_16x16x32_bf16 v[212:215], a[100:103], a[60:63], v[212:215]
s_lshl_b32 s63, s63, 12
ds_read_b128 a[140:143], v5 offset:6144
v_mfma_f32_16x16x32_bf16 v[212:215], a[96:99], a[56:59], v[212:215]
v_mfma_f32_16x16x32_bf16 v[216:219], a[104:107], a[56:59], v[216:219]
ds_write_b128 v231, a[192:195] offset:1024
v_mfma_f32_16x16x32_bf16 v[216:219], a[108:111], a[60:63], v[216:219]
buffer_load_dwordx4 a[4:7], v2, s[40:43], s33 offen offset:0 sc1
v_mfma_f32_16x16x32_bf16 v[192:195], a[108:111], a[52:55], v[192:195]
ds_read_b128 a[144:147], v5 offset:1024
v_mfma_f32_16x16x32_bf16 v[192:195], a[104:107], a[48:51], v[192:195]
ds_read_b128 a[148:151], v5 offset:7168
v_mfma_f32_16x16x32_bf16 v[168:171], a[104:107], a[40:43], v[168:171]
v_mfma_f32_16x16x32_bf16 v[168:171], a[108:111], a[44:47], v[168:171]
buffer_load_dwordx4 a[8:11], v2, s[40:43], s35 offen offset:1024 sc1
v_mfma_f32_16x16x32_bf16 v[144:147], a[108:111], a[36:39], v[144:147]
ds_read_b128 a[152:155], v6 offset:3072
v_mfma_f32_16x16x32_bf16 v[144:147], a[104:107], a[32:35], v[144:147]
v_mfma_f32_16x16x32_bf16 v[148:151], a[112:115], a[32:35], v[148:151]
v_mfma_f32_16x16x32_bf16 v[148:151], a[116:119], a[36:39], v[148:151]
buffer_load_dwordx4 a[160:163], v3, s[40:43], s63 offen sc1
v_mfma_f32_16x16x32_bf16 v[172:175], a[116:119], a[44:47], v[172:175]
v_mfma_f32_16x16x32_bf16 v[172:175], a[112:115], a[40:43], v[172:175]
ds_write_b128 v231, a[196:199] offset:8192
v_mfma_f32_16x16x32_bf16 v[196:199], a[112:115], a[48:51], v[196:199]
v_mfma_f32_16x16x32_bf16 v[196:199], a[116:119], a[52:55], v[196:199]
buffer_load_dwordx4 a[12:15], v2, s[40:43], s33 offen offset:1024 sc1
v_mfma_f32_16x16x32_bf16 v[220:223], a[116:119], a[60:63], v[220:223]
v_mfma_f32_16x16x32_bf16 v[220:223], a[112:115], a[56:59], v[220:223]
v_mfma_f32_16x16x32_bf16 a[172:175], a[120:123], a[168:171], a[172:175]
s_waitcnt lgkmcnt(1)
v_mfma_f32_16x16x32_bf16 v[224:227], a[128:131], a[56:59], v[224:227]
ds_read_b128 a[96:99], v5 offset:14336
v_mfma_f32_16x16x32_bf16 v[224:227], a[132:135], a[60:63], v[224:227]
buffer_load_dwordx4 a[16:19], v2, s[40:43], s35 offen offset:2048 sc1
v_mfma_f32_16x16x32_bf16 v[200:203], a[132:135], a[52:55], v[200:203]
ds_read_b128 a[100:103], v5 offset:20480
v_mfma_f32_16x16x32_bf16 v[200:203], a[128:131], a[48:51], v[200:203]
v_mfma_f32_16x16x32_bf16 v[176:179], a[128:131], a[40:43], v[176:179]
buffer_load_dwordx4 v1, s[4:7], s44 offen offset:2048 sc1 lds
s_add_u32 s88, s82, 0x200000
L_stub0:
s_cbranch_execz L_wret0
v_mfma_f32_16x16x32_bf16 v[176:179], a[132:135], a[44:47], v[176:179]
ds_read_b128 a[104:107], v5 offset:15360
v_mfma_f32_16x16x32_bf16 v[152:155], a[132:135], a[36:39], v[152:155]
ds_read_b128 a[108:111], v5 offset:21504
v_mfma_f32_16x16x32_bf16 v[152:155], a[128:131], a[32:35], v[152:155]
ds_write_b128 v231, a[200:203] offset:9216
v_mfma_f32_16x16x32_bf16 v[132:135], a[136:139], a[32:35], v[132:135]
buffer_load_dwordx4 a[20:23], v2, s[40:43], s33 offen offset:2048 sc1
v_mfma_f32_16x16x32_bf16 v[132:135], a[140:143], a[36:39], v[132:135]
ds_read_b128 a[112:115], v5 offset:16384
v_mfma_f32_16x16x32_bf16 v[156:159], a[140:143], a[44:47], v[156:159]
v_mfma_f32_16x16x32_bf16 v[156:159], a[136:139], a[40:43], v[156:159]
buffer_load_dwordx4 v[92:95], v1, s[4:7], s88 offen offset:0 sc1
v_mfma_f32_16x16x32_bf16 v[180:183], a[136:139], a[48:51], v[180:183]
ds_read_b128 a[116:119], v5 offset:22528
v_mfma_f32_16x16x32_bf16 v[180:183], a[140:143], a[52:55], v[180:183]
ds_read_b128 a[120:123], v6 offset:4096
v_mfma_f32_16x16x32_bf16 v[204:207], a[140:143], a[60:63], v[204:207]
v_mfma_f32_16x16x32_bf16 v[204:207], a[136:139], a[56:59], v[204:207]
buffer_load_dwordx4 a[24:27], v2, s[40:43], s35 offen offset:3072 sc1
v_mfma_f32_16x16x32_bf16 v[208:211], a[144:147], a[56:59], v[208:211]
ds_write_b128 v231, a[204:207] offset:16384
v_mfma_f32_16x16x32_bf16 v[208:211], a[148:151], a[60:63], v[208:211]
v_mfma_f32_16x16x32_bf16 v[184:187], a[148:151], a[52:55], v[184:187]
buffer_load_dwordx4 v[96:99], v1, s[4:7], s88 offen offset:1024 sc1
v_mfma_f32_16x16x32_bf16 v[184:187], a[144:147], a[48:51], v[184:187]
v_mfma_f32_16x16x32_bf16 v[160:163], a[144:147], a[40:43], v[160:163]
v_mfma_f32_16x16x32_bf16 v[160:163], a[148:151], a[44:47], v[160:163]
v_mfma_f32_16x16x32_bf16 v[136:139], a[148:151], a[36:39], v[136:139]
buffer_load_dwordx4 a[28:31], v2, s[40:43], s33 offen offset:3072 sc1
s_add_u32 s35, s35, 8192
v_mfma_f32_16x16x32_bf16 v[136:139], a[144:147], a[32:35], v[136:139]
s_add_u32 s33, s33, 8192
v_mfma_f32_16x16x32_bf16 a[176:179], a[152:155], a[168:171], a[176:179]
s_waitcnt vmcnt(13) lgkmcnt(1)
v_mfma_f32_16x16x32_bf16 v[140:143], a[96:99], a[64:67], v[140:143]
ds_read_b128 a[128:131], v5 offset:17408
v_mfma_f32_16x16x32_bf16 v[140:143], a[100:103], a[68:71], v[140:143]
buffer_load_dwordx4 a[32:35], v2, s[40:43], s35 offen offset:0 sc1
v_mfma_f32_16x16x32_bf16 v[164:167], a[100:103], a[76:79], v[164:167]
ds_read_b128 a[132:135], v5 offset:23552
v_mfma_f32_16x16x32_bf16 v[164:167], a[96:99], a[72:75], v[164:167]
ds_write_b128 v231, a[208:211] offset:17408
v_mfma_f32_16x16x32_bf16 v[188:191], a[96:99], a[80:83], v[188:191]
ds_read_b128 a[136:139], v5 offset:12288
v_mfma_f32_16x16x32_bf16 v[188:191], a[100:103], a[84:87], v[188:191]
buffer_load_dwordx4 v[100:103], v1, s[4:7], s88 offen offset:2048 sc1
v_mfma_f32_16x16x32_bf16 v[212:215], a[100:103], a[92:95], v[212:215]
ds_read_b128 a[140:143], v5 offset:18432
v_mfma_f32_16x16x32_bf16 v[212:215], a[96:99], a[88:91], v[212:215]
v_mfma_f32_16x16x32_bf16 v[216:219], a[104:107], a[88:91], v[216:219]
v_mfma_f32_16x16x32_bf16 v[216:219], a[108:111], a[92:95], v[216:219]
buffer_load_dwordx4 a[36:39], v2, s[40:43], s33 offen offset:0 sc1
v_mfma_f32_16x16x32_bf16 v[192:195], a[108:111], a[84:87], v[192:195]
ds_read_b128 a[144:147], v5 offset:13312
v_mfma_f32_16x16x32_bf16 v[192:195], a[104:107], a[80:83], v[192:195]
ds_read_b128 a[148:151], v5 offset:19456
v_mfma_f32_16x16x32_bf16 v[168:171], a[104:107], a[72:75], v[168:171]
v_mfma_f32_16x16x32_bf16 v[168:171], a[108:111], a[76:79], v[168:171]
buffer_load_dwordx4 a[40:43], v2, s[40:43], s35 offen offset:1024 sc1
v_mfma_f32_16x16x32_bf16 v[144:147], a[108:111], a[68:71], v[144:147]
ds_read_b128 a[152:155], v6 offset:5120
v_mfma_f32_16x16x32_bf16 v[144:147], a[104:107], a[64:67], v[144:147]
v_mfma_f32_16x16x32_bf16 v[148:151], a[112:115], a[64:67], v[148:151]
v_mfma_f32_16x16x32_bf16 v[148:151], a[116:119], a[68:71], v[148:151]
buffer_load_dwordx4 v[104:107], v1, s[4:7], s88 offen offset:3072 sc1
s_add_u32 s88, s88, 4096
v_mfma_f32_16x16x32_bf16 v[172:175], a[116:119], a[76:79], v[172:175]
v_mfma_f32_16x16x32_bf16 v[172:175], a[112:115], a[72:75], v[172:175]
v_mfma_f32_16x16x32_bf16 v[196:199], a[112:115], a[80:83], v[196:199]
v_mfma_f32_16x16x32_bf16 v[196:199], a[116:119], a[84:87], v[196:199]
buffer_load_dwordx4 a[44:47], v2, s[40:43], s33 offen offset:1024 sc1
v_mfma_f32_16x16x32_bf16 v[220:223], a[116:119], a[92:95], v[220:223]
v_mfma_f32_16x16x32_bf16 v[220:223], a[112:115], a[88:91], v[220:223]
v_mfma_f32_16x16x32_bf16 a[180:183], a[120:123], a[168:171], a[180:183]
s_waitcnt lgkmcnt(0)
s_barrier
v_mfma_f32_16x16x32_bf16 v[224:227], a[128:131], a[88:91], v[224:227]
ds_read_b128 a[96:99], v5 offset:26624
v_mfma_f32_16x16x32_bf16 v[224:227], a[132:135], a[92:95], v[224:227]
buffer_load_dwordx4 a[48:51], v2, s[40:43], s35 offen offset:2048 sc1
v_mfma_f32_16x16x32_bf16 v[200:203], a[132:135], a[84:87], v[200:203]
ds_read_b128 a[100:103], v5 offset:32768
v_mfma_f32_16x16x32_bf16 v[200:203], a[128:131], a[80:83], v[200:203]
ds_read_b64_tr_b16 a[220:221], v230 offset:0
v_mfma_f32_16x16x32_bf16 v[176:179], a[128:131], a[72:75], v[176:179]
buffer_load_dwordx4 v[108:111], v1, s[4:7], s88 offen offset:0 sc1
v_mfma_f32_16x16x32_bf16 v[176:179], a[132:135], a[76:79], v[176:179]
ds_read_b128 a[104:107], v5 offset:27648
v_mfma_f32_16x16x32_bf16 v[152:155], a[132:135], a[68:71], v[152:155]
ds_read_b128 a[108:111], v5 offset:33792
v_mfma_f32_16x16x32_bf16 v[152:155], a[128:131], a[64:67], v[152:155]
ds_read_b64_tr_b16 a[222:223], v230 offset:2048
v_mfma_f32_16x16x32_bf16 v[132:135], a[136:139], a[64:67], v[132:135]
buffer_load_dwordx4 a[52:55], v2, s[40:43], s33 offen offset:2048 sc1
v_mfma_f32_16x16x32_bf16 v[132:135], a[140:143], a[68:71], v[132:135]
ds_read_b128 a[112:115], v5 offset:28672
v_mfma_f32_16x16x32_bf16 v[156:159], a[140:143], a[76:79], v[156:159]
v_mfma_f32_16x16x32_bf16 v[156:159], a[136:139], a[72:75], v[156:159]
buffer_load_dwordx4 v[112:115], v1, s[4:7], s88 offen offset:1024 sc1
v_mfma_f32_16x16x32_bf16 v[180:183], a[136:139], a[80:83], v[180:183]
ds_read_b128 a[116:119], v5 offset:34816
v_mfma_f32_16x16x32_bf16 v[180:183], a[140:143], a[84:87], v[180:183]
ds_read_b128 a[120:123], v6 offset:26624
v_mfma_f32_16x16x32_bf16 v[204:207], a[140:143], a[92:95], v[204:207]
ds_read_b64_tr_b16 a[224:225], v230 offset:8
v_mfma_f32_16x16x32_bf16 v[204:207], a[136:139], a[88:91], v[204:207]
buffer_load_dwordx4 a[56:59], v2, s[40:43], s35 offen offset:3072 sc1
v_mfma_f32_16x16x32_bf16 v[208:211], a[144:147], a[88:91], v[208:211]
v_mfma_f32_16x16x32_bf16 v[208:211], a[148:151], a[92:95], v[208:211]
ds_read_b64_tr_b16 a[226:227], v230 offset:2056
v_mfma_f32_16x16x32_bf16 v[184:187], a[148:151], a[84:87], v[184:187]
buffer_load_dwordx4 v[116:119], v1, s[4:7], s88 offen offset:2048 sc1
v_mfma_f32_16x16x32_bf16 v[184:187], a[144:147], a[80:83], v[184:187]
v_mfma_f32_16x16x32_bf16 v[160:163], a[144:147], a[72:75], v[160:163]
v_mfma_f32_16x16x32_bf16 v[160:163], a[148:151], a[76:79], v[160:163]
v_mfma_f32_16x16x32_bf16 v[136:139], a[148:151], a[68:71], v[136:139]
buffer_load_dwordx4 a[60:63], v2, s[40:43], s33 offen offset:3072 sc1
s_add_u32 s35, s35, 8192
v_mfma_f32_16x16x32_bf16 v[136:139], a[144:147], a[64:67], v[136:139]
s_add_u32 s33, s33, 8192
ds_read_b64_tr_b16 a[188:189], v248 offset:0
v_mfma_f32_16x16x32_bf16 a[184:187], a[152:155], a[168:171], a[184:187]
s_waitcnt vmcnt(13) lgkmcnt(3)
v_mfma_f32_16x16x32_bf16 v[140:143], a[96:99], a[0:3], v[140:143]
ds_read_b128 a[128:131], v5 offset:29696
v_add_f32_dpp v48, v48, v48 row_ror:8 row_mask:0xf bank_mask:0xf
v_mfma_f32_16x16x32_bf16 v[140:143], a[100:103], a[4:7], v[140:143]
buffer_load_dwordx4 a[64:67], v2, s[40:43], s35 offen offset:0 sc1
v_mfma_f32_16x16x32_bf16 v[164:167], a[100:103], a[12:15], v[164:167]
ds_read_b128 a[132:135], v5 offset:35840
v_add_f32_dpp v49, v49, v49 row_ror:8 row_mask:0xf bank_mask:0xf
v_mfma_f32_16x16x32_bf16 v[164:167], a[96:99], a[8:11], v[164:167]
ds_read_b64_tr_b16 a[190:191], v248 offset:512
v_add_f32_dpp v50, v50, v50 row_ror:8 row_mask:0xf bank_mask:0xf
v_mfma_f32_16x16x32_bf16 v[188:191], a[96:99], a[16:19], v[188:191]
ds_read_b128 a[136:139], v5 offset:24576
v_add_f32_dpp v51, v51, v51 row_ror:8 row_mask:0xf bank_mask:0xf
v_mfma_f32_16x16x32_bf16 v[188:191], a[100:103], a[20:23], v[188:191]
buffer_load_dwordx4 v[120:123], v1, s[4:7], s88 offen offset:3072 sc1
s_add_u32 s63, s28, 16
v_mfma_f32_16x16x32_bf16 v[212:215], a[100:103], a[28:31], v[212:215]
s_lshl_b32 s63, s63, 12
ds_read_b128 a[140:143], v5 offset:30720
v_mfma_f32_16x16x32_bf16 v[212:215], a[96:99], a[24:27], v[212:215]
v_add_f32_dpp v52, v52, v52 row_ror:8 row_mask:0xf bank_mask:0xf
v_add_f32_dpp v53, v53, v53 row_ror:8 row_mask:0xf bank_mask:0xf
v_mfma_f32_16x16x32_bf16 v[216:219], a[104:107], a[24:27], v[216:219]
v_add_f32_dpp v54, v54, v54 row_ror:8 row_mask:0xf bank_mask:0xf
v_add_f32_dpp v55, v55, v55 row_ror:8 row_mask:0xf bank_mask:0xf
v_mfma_f32_16x16x32_bf16 v[216:219], a[108:111], a[28:31], v[216:219]
buffer_load_dwordx4 a[68:71], v2, s[40:43], s33 offen offset:0 sc1
v_mfma_f32_16x16x32_bf16 v[192:195], a[108:111], a[20:23], v[192:195]
ds_read_b128 a[144:147], v5 offset:25600
v_add_f32_dpp v48, v48, v48 row_ror:4 row_mask:0xf bank_mask:0xf
v_mfma_f32_16x16x32_bf16 v[192:195], a[104:107], a[16:19], v[192:195]
ds_read_b128 a[148:151], v5 offset:31744
v_add_f32_dpp v49, v49, v49 row_ror:4 row_mask:0xf bank_mask:0xf
v_mfma_f32_16x16x32_bf16 v[168:171], a[104:107], a[8:11], v[168:171]
ds_read_b64_tr_b16 a[192:193], v248 offset:4096
v_add_f32_dpp v50, v50, v50 row_ror:4 row_mask:0xf bank_mask:0xf
v_mfma_f32_16x16x32_bf16 v[168:171], a[108:111], a[12:15], v[168:171]
buffer_load_dwordx4 a[72:75], v2, s[40:43], s35 offen offset:1024 sc1
v_mfma_f32_16x16x32_bf16 v[144:147], a[108:111], a[4:7], v[144:147]
ds_read_b128 a[152:155], v6 offset:27648
v_add_f32_dpp v51, v51, v51 row_ror:4 row_mask:0xf bank_mask:0xf
v_mfma_f32_16x16x32_bf16 v[144:147], a[104:107], a[0:3], v[144:147]
ds_read_b64_tr_b16 a[194:195], v248 offset:4608
v_add_f32_dpp v52, v52, v52 row_ror:4 row_mask:0xf bank_mask:0xf
v_mfma_f32_16x16x32_bf16 v[148:151], a[112:115], a[0:3], v[148:151]
v_add_f32_dpp v53, v53, v53 row_ror:4 row_mask:0xf bank_mask:0xf
v_add_f32_dpp v54, v54, v54 row_ror:4 row_mask:0xf bank_mask:0xf
v_mfma_f32_16x16x32_bf16 v[148:151], a[116:119], a[4:7], v[148:151]
buffer_load_dwordx4 a[164:167], v3, s[40:43], s63 offen sc1
s_add_u32 s88, s83, 0x200000
v_mfma_f32_16x16x32_bf16 v[172:175], a[116:119], a[12:15], v[172:175]
v_add_f32_dpp v55, v55, v55 row_ror:4 row_mask:0xf bank_mask:0xf
v_add_f32_dpp v48, v48, v48 row_ror:2 row_mask:0xf bank_mask:0xf
v_mfma_f32_16x16x32_bf16 v[172:175], a[112:115], a[8:11], v[172:175]
v_add_f32_dpp v49, v49, v49 row_ror:2 row_mask:0xf bank_mask:0xf
v_add_f32_dpp v50, v50, v50 row_ror:2 row_mask:0xf bank_mask:0xf
v_mfma_f32_16x16x32_bf16 v[196:199], a[112:115], a[16:19], v[196:199]
v_add_f32_dpp v51, v51, v51 row_ror:2 row_mask:0xf bank_mask:0xf
v_add_f32_dpp v52, v52, v52 row_ror:2 row_mask:0xf bank_mask:0xf
v_mfma_f32_16x16x32_bf16 v[196:199], a[116:119], a[20:23], v[196:199]
buffer_load_dwordx4 a[76:79], v2, s[40:43], s33 offen offset:1024 sc1
v_mfma_f32_16x16x32_bf16 v[220:223], a[116:119], a[28:31], v[220:223]
ds_read_b64_tr_b16 a[196:197], v249 offset:32
v_add_f32_dpp v53, v53, v53 row_ror:2 row_mask:0xf bank_mask:0xf
v_mfma_f32_16x16x32_bf16 v[220:223], a[112:115], a[24:27], v[220:223]
v_add_f32_dpp v54, v54, v54 row_ror:2 row_mask:0xf bank_mask:0xf
v_add_f32_dpp v55, v55, v55 row_ror:2 row_mask:0xf bank_mask:0xf
v_mfma_f32_16x16x32_bf16 a[172:175], a[120:123], a[160:163], a[172:175]
v_add_f32_dpp v48, v48, v48 row_ror:1 row_mask:0xf bank_mask:0xf
s_waitcnt lgkmcnt(2)
v_mfma_f32_16x16x32_bf16 v[224:227], a[128:131], a[24:27], v[224:227]
ds_read_b128 a[96:99], v5 offset:38912
v_add_f32_dpp v49, v49, v49 row_ror:1 row_mask:0xf bank_mask:0xf
v_mfma_f32_16x16x32_bf16 v[224:227], a[132:135], a[28:31], v[224:227]
buffer_load_dwordx4 a[80:83], v2, s[40:43], s35 offen offset:2048 sc1
v_mfma_f32_16x16x32_bf16 v[200:203], a[132:135], a[20:23], v[200:203]
ds_read_b128 a[100:103], v5 offset:45056
v_add_f32_dpp v50, v50, v50 row_ror:1 row_mask:0xf bank_mask:0xf
v_mfma_f32_16x16x32_bf16 v[200:203], a[128:131], a[16:19], v[200:203]
ds_read_b64_tr_b16 a[198:199], v249 offset:544
v_add_f32_dpp v51, v51, v51 row_ror:1 row_mask:0xf bank_mask:0xf
v_mfma_f32_16x16x32_bf16 v[176:179], a[128:131], a[8:11], v[176:179]
buffer_load_dwordx4 v[124:127], v1, s[4:7], s88 offen offset:0 sc1
v_mfma_f32_16x16x32_bf16 v[176:179], a[132:135], a[12:15], v[176:179]
ds_read_b128 a[104:107], v5 offset:39936
v_add_f32_dpp v52, v52, v52 row_ror:1 row_mask:0xf bank_mask:0xf
v_mfma_f32_16x16x32_bf16 v[152:155], a[132:135], a[4:7], v[152:155]
ds_read_b128 a[108:111], v5 offset:46080
v_add_f32_dpp v53, v53, v53 row_ror:1 row_mask:0xf bank_mask:0xf
v_mfma_f32_16x16x32_bf16 v[152:155], a[128:131], a[0:3], v[152:155]
ds_read_b64_tr_b16 a[200:201], v249 offset:4128
v_add_f32_dpp v54, v54, v54 row_ror:1 row_mask:0xf bank_mask:0xf
v_mfma_f32_16x16x32_bf16 v[132:135], a[136:139], a[0:3], v[132:135]
buffer_load_dwordx4 a[84:87], v2, s[40:43], s33 offen offset:2048 sc1
v_mfma_f32_16x16x32_bf16 v[132:135], a[140:143], a[4:7], v[132:135]
ds_read_b128 a[112:115], v5 offset:40960
v_add_f32_dpp v55, v55, v55 row_ror:1 row_mask:0xf bank_mask:0xf
v_mfma_f32_16x16x32_bf16 v[156:159], a[140:143], a[12:15], v[156:159]
v_add_u32 v233, 159744, v233
s_lshl_b32 s36, s28, 6
v_mfma_f32_16x16x32_bf16 v[156:159], a[136:139], a[8:11], v[156:159]
buffer_load_dwordx4 v[128:131], v1, s[4:7], s88 offen offset:1024 sc1
s_add_u32 m0, s18, 0x1e000
v_mfma_f32_16x16x32_bf16 v[180:183], a[136:139], a[16:19], v[180:183]
s_add_u32 s44, s50, 0xe1e000
ds_read_b128 a[116:119], v5 offset:47104
v_mfma_f32_16x16x32_bf16 v[180:183], a[140:143], a[20:23], v[180:183]
ds_read_b128 a[120:123], v6 offset:28672
s_lshl_b32 s37, s39, 6
v_mfma_f32_16x16x32_bf16 v[204:207], a[140:143], a[28:31], v[204:207]
ds_read_b64_tr_b16 a[202:203], v249 offset:4640
v_add_u32 v232, s36, v233
v_mfma_f32_16x16x32_bf16 v[204:207], a[136:139], a[24:27], v[204:207]
buffer_load_dwordx4 a[88:91], v2, s[40:43], s35 offen offset:3072 sc1
v_mfma_f32_16x16x32_bf16 v[208:211], a[144:147], a[24:27], v[208:211]
v_add_u32 v235, s37, v233
v_mfma_f32_16x16x32_bf16 v[208:211], a[148:151], a[28:31], v[208:211]
v_mfma_f32_16x16x32_bf16 v[184:187], a[148:151], a[20:23], v[184:187]
buffer_load_dwordx4 v1, s[4:7], s44 offen offset:0 sc1 lds
v_mfma_f32_16x16x32_bf16 v[184:187], a[144:147], a[16:19], v[184:187]
ds_read_b64_tr_b16 a[204:205], v248 offset:8192
v_mfma_f32_16x16x32_bf16 v[160:163], a[144:147], a[8:11], v[160:163]
v_mfma_f32_16x16x32_bf16 v[160:163], a[148:151], a[12:15], v[160:163]
v_mfma_f32_16x16x32_bf16 v[136:139], a[148:151], a[4:7], v[136:139]
buffer_load_dwordx4 a[92:95], v2, s[40:43], s33 offen offset:3072 sc1
s_add_u32 s35, s35, 8192
v_mfma_f32_16x16x32_bf16 v[136:139], a[144:147], a[0:3], v[136:139]
s_add_u32 s33, s33, 8192
v_mfma_f32_16x16x32_bf16 a[176:179], a[152:155], a[160:163], a[176:179]
ds_read_b64_tr_b16 a[206:207], v248 offset:8704
s_waitcnt vmcnt(13) lgkmcnt(3)
v_mfma_f32_16x16x32_bf16 v[140:143], a[96:99], a[32:35], v[140:143]
ds_read_b128 a[128:131], v5 offset:41984
v_mfma_f32_16x16x32_bf16 v[140:143], a[100:103], a[36:39], v[140:143]
buffer_load_dwordx4 a[0:3], v2, s[40:43], s35 offen offset:0 sc1
v_mfma_f32_16x16x32_bf16 v[164:167], a[100:103], a[44:47], v[164:167]
ds_read_b128 a[132:135], v5 offset:48128
v_mfma_f32_16x16x32_bf16 v[164:167], a[96:99], a[40:43], v[164:167]
ds_write_b128 v232, v[48:51]
v_mfma_f32_16x16x32_bf16 v[188:191], a[96:99], a[48:51], v[188:191]
ds_read_b128 a[136:139], v5 offset:36864
v_mfma_f32_16x16x32_bf16 v[188:191], a[100:103], a[52:55], v[188:191]
buffer_load_dwordx4 v1, s[4:7], s44 offen offset:1024 sc1 lds
v_mfma_f32_16x16x32_bf16 v[212:215], a[100:103], a[60:63], v[212:215]
ds_read_b128 a[140:143], v5 offset:43008
v_mfma_f32_16x16x32_bf16 v[212:215], a[96:99], a[56:59], v[212:215]
ds_read_b64_tr_b16 a[208:209], v248 offset:12288
v_mfma_f32_16x16x32_bf16 v[216:219], a[104:107], a[56:59], v[216:219]
ds_write_b128 v235, v[52:55]
v_mfma_f32_16x16x32_bf16 v[216:219], a[108:111], a[60:63], v[216:219]
buffer_load_dwordx4 a[4:7], v2, s[40:43], s33 offen offset:0 sc1
v_mfma_f32_16x16x32_bf16 v[192:195], a[108:111], a[52:55], v[192:195]
ds_read_b128 a[144:147], v5 offset:37888
v_mfma_f32_16x16x32_bf16 v[192:195], a[104:107], a[48:51], v[192:195]
ds_read_b128 a[148:151], v5 offset:44032
v_mfma_f32_16x16x32_bf16 v[168:171], a[104:107], a[40:43], v[168:171]
ds_read_b64_tr_b16 a[210:211], v248 offset:12800
v_mfma_f32_16x16x32_bf16 v[168:171], a[108:111], a[44:47], v[168:171]
buffer_load_dwordx4 a[8:11], v2, s[40:43], s35 offen offset:1024 sc1
v_mfma_f32_16x16x32_bf16 v[144:147], a[108:111], a[36:39], v[144:147]
ds_read_b128 a[152:155], v6 offset:29696
v_mfma_f32_16x16x32_bf16 v[144:147], a[104:107], a[32:35], v[144:147]
v_mfma_f32_16x16x32_bf16 v[148:151], a[112:115], a[32:35], v[148:151]
v_mfma_f32_16x16x32_bf16 v[148:151], a[116:119], a[36:39], v[148:151]
buffer_load_dwordx4 v1, s[4:7], s44 offen offset:2048 sc1 lds
s_add_u32 m0, s18, 0x21000
v_mfma_f32_16x16x32_bf16 v[172:175], a[116:119], a[44:47], v[172:175]
s_add_u32 s44, s50, 0xe21000
v_mfma_f32_16x16x32_bf16 v[172:175], a[112:115], a[40:43], v[172:175]
v_mfma_f32_16x16x32_bf16 v[196:199], a[112:115], a[48:51], v[196:199]
v_mfma_f32_16x16x32_bf16 v[196:199], a[116:119], a[52:55], v[196:199]
buffer_load_dwordx4 a[12:15], v2, s[40:43], s33 offen offset:1024 sc1
v_mfma_f32_16x16x32_bf16 v[220:223], a[116:119], a[60:63], v[220:223]
v_mfma_f32_16x16x32_bf16 v[220:223], a[112:115], a[56:59], v[220:223]
v_mfma_f32_16x16x32_bf16 a[180:183], a[120:123], a[160:163], a[180:183]
s_waitcnt lgkmcnt(0)
s_barrier
v_mfma_f32_16x16x32_bf16 v[224:227], a[128:131], a[56:59], v[224:227]
v_add_u32 v5, 98304, v1
v_add_u32 v6, s55, v5
v_mfma_f32_16x16x32_bf16 v[224:227], a[132:135], a[60:63], v[224:227]
buffer_load_dwordx4 a[16:19], v2, s[40:43], s35 offen offset:2048 sc1
v_mfma_f32_16x16x32_bf16 v[200:203], a[132:135], a[52:55], v[200:203]
ds_read_b128 a[96:99], v5 offset:2048
v_mfma_f32_16x16x32_bf16 v[200:203], a[128:131], a[48:51], v[200:203]
ds_read_b128 a[100:103], v5 offset:8192
v_mfma_f32_16x16x32_bf16 v[176:179], a[128:131], a[40:43], v[176:179]
buffer_load_dwordx4 v1, s[4:7], s44 offen offset:0 sc1 lds
v_mfma_f32_16x16x32_bf16 v[176:179], a[132:135], a[44:47], v[176:179]
ds_read_b128 a[104:107], v5 offset:3072
v_mfma_f32_16x16x32_bf16 v[152:155], a[132:135], a[36:39], v[152:155]
ds_read_b128 a[108:111], v5 offset:9216
v_mfma_f32_16x16x32_bf16 v[152:155], a[128:131], a[32:35], v[152:155]
ds_read_b128 v[48:51], v233 offset:0
v_mfma_f32_16x16x32_bf16 v[132:135], a[136:139], a[32:35], v[132:135]
buffer_load_dwordx4 a[20:23], v2, s[40:43], s33 offen offset:2048 sc1
v_mfma_f32_16x16x32_bf16 v[132:135], a[140:143], a[36:39], v[132:135]
ds_read_b128 a[112:115], v5 offset:4096
v_mfma_f32_16x16x32_bf16 v[156:159], a[140:143], a[44:47], v[156:159]
ds_read_b128 v[52:55], v233 offset:64
v_mfma_f32_16x16x32_bf16 v[156:159], a[136:139], a[40:43], v[156:159]
buffer_load_dwordx4 v1, s[4:7], s44 offen offset:1024 sc1 lds
v_mfma_f32_16x16x32_bf16 v[180:183], a[136:139], a[48:51], v[180:183]
ds_read_b128 a[116:119], v5 offset:10240
v_mfma_f32_16x16x32_bf16 v[180:183], a[140:143], a[52:55], v[180:183]
ds_read_b128 a[120:123], v6 offset:2048
v_mfma_f32_16x16x32_bf16 v[204:207], a[140:143], a[60:63], v[204:207]
v_mfma_f32_16x16x32_bf16 v[204:207], a[136:139], a[56:59], v[204:207]
buffer_load_dwordx4 a[24:27], v2, s[40:43], s35 offen offset:3072 sc1
v_mfma_f32_16x16x32_bf16 v[208:211], a[144:147], a[56:59], v[208:211]
v_mfma_f32_16x16x32_bf16 v[208:211], a[148:151], a[60:63], v[208:211]
v_mfma_f32_16x16x32_bf16 v[184:187], a[148:151], a[52:55], v[184:187]
buffer_load_dwordx4 v1, s[4:7], s44 offen offset:2048 sc1 lds
s_add_u32 m0, s18, 0x0
v_mfma_f32_16x16x32_bf16 v[184:187], a[144:147], a[48:51], v[184:187]
s_add_u32 s44, s50, 0xe24000
ds_read_b128 v[56:59], v233 offset:128
v_mfma_f32_16x16x32_bf16 v[160:163], a[144:147], a[40:43], v[160:163]
v_mfma_f32_16x16x32_bf16 v[160:163], a[148:151], a[44:47], v[160:163]
v_mfma_f32_16x16x32_bf16 v[136:139], a[148:151], a[36:39], v[136:139]
buffer_load_dwordx4 a[28:31], v2, s[40:43], s33 offen offset:3072 sc1
s_add_u32 s35, s35, 8192
v_mfma_f32_16x16x32_bf16 v[136:139], a[144:147], a[32:35], v[136:139]
s_add_u32 s33, s33, 8192
v_mfma_f32_16x16x32_bf16 a[184:187], a[152:155], a[160:163], a[184:187]
s_waitcnt vmcnt(13) lgkmcnt(1)
v_mfma_f32_16x16x32_bf16 v[140:143], a[96:99], a[64:67], v[140:143]
ds_read_b128 a[128:131], v5 offset:5120
v_mfma_f32_16x16x32_bf16 v[140:143], a[100:103], a[68:71], v[140:143]
buffer_load_dwordx4 a[32:35], v2, s[40:43], s35 offen offset:0 sc1
v_mfma_f32_16x16x32_bf16 v[164:167], a[100:103], a[76:79], v[164:167]
ds_read_b128 a[132:135], v5 offset:11264
v_mfma_f32_16x16x32_bf16 v[164:167], a[96:99], a[72:75], v[164:167]
v_mfma_f32_16x16x32_bf16 v[236:239], a[188:191], v[16:19], 0
v_mfma_f32_16x16x32_bf16 v[188:191], a[96:99], a[80:83], v[188:191]
ds_read_b128 a[136:139], v5 offset:0
v_mfma_f32_16x16x32_bf16 v[188:191], a[100:103], a[84:87], v[188:191]
buffer_load_dwordx4 v1, s[4:7], s44 offen offset:0 sc1 lds
s_add_u32 s63, s28, 20
v_mfma_f32_16x16x32_bf16 v[212:215], a[100:103], a[92:95], v[212:215]
s_lshl_b32 s63, s63, 12
ds_read_b128 a[140:143], v5 offset:6144
v_mfma_f32_16x16x32_bf16 v[212:215], a[96:99], a[88:91], v[212:215]
v_mfma_f32_16x16x32_bf16 v[240:243], a[196:199], v[16:19], 0
v_mfma_f32_16x16x32_bf16 v[216:219], a[104:107], a[88:91], v[216:219]
v_mfma_f32_16x16x32_bf16 v[244:247], a[204:207], v[16:19], 0
v_mfma_f32_16x16x32_bf16 v[216:219], a[108:111], a[92:95], v[216:219]
buffer_load_dwordx4 a[36:39], v2, s[40:43], s33 offen offset:0 sc1
v_mfma_f32_16x16x32_bf16 v[192:195], a[108:111], a[84:87], v[192:195]
ds_read_b128 a[144:147], v5 offset:1024
v_mfma_f32_16x16x32_bf16 v[192:195], a[104:107], a[80:83], v[192:195]
ds_read_b128 a[148:151], v5 offset:7168
v_mfma_f32_16x16x32_bf16 v[168:171], a[104:107], a[72:75], v[168:171]
v_mfma_f32_16x16x32_bf16 v[236:239], a[192:195], v[16:19], v[236:239]
v_mfma_f32_16x16x32_bf16 v[168:171], a[108:111], a[76:79], v[168:171]
buffer_load_dwordx4 a[40:43], v2, s[40:43], s35 offen offset:1024 sc1
v_mfma_f32_16x16x32_bf16 v[144:147], a[108:111], a[68:71], v[144:147]
ds_read_b128 a[152:155], v6 offset:3072
v_mfma_f32_16x16x32_bf16 v[144:147], a[104:107], a[64:67], v[144:147]
ds_read_b128 v[60:63], v233 offset:192
v_mfma_f32_16x16x32_bf16 v[148:151], a[112:115], a[64:67], v[148:151]
v_mfma_f32_16x16x32_bf16 v[240:243], a[200:203], v[16:19], v[240:243]
v_mfma_f32_16x16x32_bf16 v[148:151], a[116:119], a[68:71], v[148:151]
buffer_load_dwordx4 a[168:171], v3, s[40:43], s63 offen sc1
v_mfma_f32_16x16x32_bf16 v[172:175], a[116:119], a[76:79], v[172:175]
ds_read_b128 v[64:67], v233 offset:256
v_mfma_f32_16x16x32_bf16 v[172:175], a[112:115], a[72:75], v[172:175]
v_mfma_f32_16x16x32_bf16 v[196:199], a[112:115], a[80:83], v[196:199]
v_mfma_f32_16x16x32_bf16 v[244:247], a[208:211], v[16:19], v[244:247]
v_mfma_f32_16x16x32_bf16 v[196:199], a[116:119], a[84:87], v[196:199]
buffer_load_dwordx4 a[44:47], v2, s[40:43], s33 offen offset:1024 sc1
v_mfma_f32_16x16x32_bf16 v[220:223], a[116:119], a[92:95], v[220:223]
ds_read_b128 v[68:71], v233 offset:320
v_mfma_f32_16x16x32_bf16 v[220:223], a[112:115], a[88:91], v[220:223]
v_mfma_f32_16x16x32_bf16 a[172:175], a[120:123], a[164:167], a[172:175]
s_waitcnt lgkmcnt(3)
v_mfma_f32_16x16x32_bf16 v[224:227], a[128:131], a[88:91], v[224:227]
ds_read_b128 a[96:99], v5 offset:14336
v_mfma_f32_16x16x32_bf16 v[224:227], a[132:135], a[92:95], v[224:227]
buffer_load_dwordx4 a[48:51], v2, s[40:43], s35 offen offset:2048 sc1
v_mfma_f32_16x16x32_bf16 v[200:203], a[132:135], a[84:87], v[200:203]
ds_read_b128 a[100:103], v5 offset:20480
v_mfma_f32_16x16x32_bf16 v[200:203], a[128:131], a[80:83], v[200:203]
v_mfma_f32_16x16x32_bf16 v[176:179], a[128:131], a[72:75], v[176:179]
buffer_load_dwordx4 v1, s[4:7], s44 offen offset:1024 sc1 lds
v_mfma_f32_16x16x32_bf16 v[176:179], a[132:135], a[76:79], v[176:179]
ds_read_b128 a[104:107], v5 offset:15360
v_mfma_f32_16x16x32_bf16 v[152:155], a[132:135], a[68:71], v[152:155]
ds_read_b128 a[108:111], v5 offset:21504
v_mfma_f32_16x16x32_bf16 v[152:155], a[128:131], a[64:67], v[152:155]
ds_read_b128 v[72:75], v232 offset:128
v_mfma_f32_16x16x32_bf16 v[132:135], a[136:139], a[64:67], v[132:135]
buffer_load_dwordx4 a[52:55], v2, s[40:43], s33 offen offset:2048 sc1
v_mfma_f32_16x16x32_bf16 v[132:135], a[140:143], a[68:71], v[132:135]
ds_read_b128 a[112:115], v5 offset:16384
v_mfma_f32_16x16x32_bf16 v[156:159], a[140:143], a[76:79], v[156:159]
v_mfma_f32_16x16x32_bf16 v[156:159], a[136:139], a[72:75], v[156:159]
buffer_load_dwordx4 v1, s[4:7], s44 offen offset:2048 sc1 lds
s_add_u32 m0, s18, 0x3000
v_mfma_f32_16x16x32_bf16 v[180:183], a[136:139], a[80:83], v[180:183]
s_add_u32 s44, s50, 0xe27000
ds_read_b128 a[116:119], v5 offset:22528
v_mfma_f32_16x16x32_bf16 v[180:183], a[140:143], a[84:87], v[180:183]
ds_read_b128 a[120:123], v6 offset:4096
v_mfma_f32_16x16x32_bf16 v[204:207], a[140:143], a[92:95], v[204:207]
v_mfma_f32_16x16x32_bf16 v[204:207], a[136:139], a[88:91], v[204:207]
buffer_load_dwordx4 a[56:59], v2, s[40:43], s35 offen offset:3072 sc1
v_mfma_f32_16x16x32_bf16 v[208:211], a[144:147], a[88:91], v[208:211]
v_mfma_f32_16x16x32_bf16 v[208:211], a[148:151], a[92:95], v[208:211]
v_mfma_f32_16x16x32_bf16 v[184:187], a[148:151], a[84:87], v[184:187]
buffer_load_dwordx4 v1, s[4:7], s44 offen offset:0 sc1 lds
v_mfma_f32_16x16x32_bf16 v[184:187], a[144:147], a[80:83], v[184:187]
v_mfma_f32_16x16x32_bf16 v[160:163], a[144:147], a[72:75], v[160:163]
v_mfma_f32_16x16x32_bf16 v[160:163], a[148:151], a[76:79], v[160:163]
v_mfma_f32_16x16x32_bf16 v[136:139], a[148:151], a[68:71], v[136:139]
buffer_load_dwordx4 a[60:63], v2, s[40:43], s33 offen offset:3072 sc1
s_add_u32 s35, s35, 8192
v_mfma_f32_16x16x32_bf16 v[136:139], a[144:147], a[64:67], v[136:139]
s_add_u32 s33, s33, 8192
v_mfma_f32_16x16x32_bf16 a[176:179], a[152:155], a[164:167], a[176:179]
s_waitcnt vmcnt(13) lgkmcnt(0)
v_mfma_f32_16x16x32_bf16 v[140:143], a[96:99], a[0:3], v[140:143]
ds_read_b128 a[128:131], v5 offset:17408
v_add_f32 v92, v92, v96
v_mfma_f32_16x16x32_bf16 v[140:143], a[100:103], a[4:7], v[140:143]
buffer_load_dwordx4 a[64:67], v2, s[40:43], s35 offen offset:0 sc1
v_mfma_f32_16x16x32_bf16 v[164:167], a[100:103], a[12:15], v[164:167]
ds_read_b128 a[132:135], v5 offset:23552
v_add_f32 v100, v100, v104
v_mfma_f32_16x16x32_bf16 v[164:167], a[96:99], a[8:11], v[164:167]
v_add_f32 v108, v108, v112
v_add_f32 v116, v116, v120
v_mfma_f32_16x16x32_bf16 v[188:191], a[96:99], a[16:19], v[188:191]
ds_read_b128 a[136:139], v5 offset:12288
v_add_f32 v124, v124, v128
v_mfma_f32_16x16x32_bf16 v[188:191], a[100:103], a[20:23], v[188:191]
buffer_load_dwordx4 v1, s[4:7], s44 offen offset:1024 sc1 lds
v_mfma_f32_16x16x32_bf16 v[212:215], a[100:103], a[28:31], v[212:215]
ds_read_b128 a[140:143], v5 offset:18432
v_add_f32 v93, v93, v97
v_mfma_f32_16x16x32_bf16 v[212:215], a[96:99], a[24:27], v[212:215]
v_add_f32 v101, v101, v105
v_add_f32 v109, v109, v113
v_mfma_f32_16x16x32_bf16 v[216:219], a[104:107], a[24:27], v[216:219]
v_add_f32 v117, v117, v121
v_add_f32 v125, v125, v129
v_mfma_f32_16x16x32_bf16 v[216:219], a[108:111], a[28:31], v[216:219]
buffer_load_dwordx4 a[68:71], v2, s[40:43], s33 offen offset:0 sc1
v_mfma_f32_16x16x32_bf16 v[192:195], a[108:111], a[20:23], v[192:195]
ds_read_b128 a[144:147], v5 offset:13312
v_add_f32 v94, v94, v98
v_mfma_f32_16x16x32_bf16 v[192:195], a[104:107], a[16:19], v[192:195]
ds_read_b128 a[148:151], v5 offset:19456
v_add_f32 v102, v102, v106
v_mfma_f32_16x16x32_bf16 v[168:171], a[104:107], a[8:11], v[168:171]
v_add_f32 v110, v110, v114
v_add_f32 v118, v118, v122
v_mfma_f32_16x16x32_bf16 v[168:171], a[108:111], a[12:15], v[168:171]
buffer_load_dwordx4 a[72:75], v2, s[40:43], s35 offen offset:1024 sc1
v_mfma_f32_16x16x32_bf16 v[144:147], a[108:111], a[4:7], v[144:147]
ds_read_b128 a[152:155], v6 offset:5120
v_add_f32 v126, v126, v130
v_mfma_f32_16x16x32_bf16 v[144:147], a[104:107], a[0:3], v[144:147]
v_add_f32 v95, v95, v99
v_add_f32 v103, v103, v107
v_mfma_f32_16x16x32_bf16 v[148:151], a[112:115], a[0:3], v[148:151]
v_add_f32 v111, v111, v115
v_add_f32 v119, v119, v123
v_mfma_f32_16x16x32_bf16 v[148:151], a[116:119], a[4:7], v[148:151]
buffer_load_dwordx4 v1, s[4:7], s44 offen offset:2048 sc1 lds
s_add_u32 m0, s18, 0x6000
v_mfma_f32_16x16x32_bf16 v[172:175], a[116:119], a[12:15], v[172:175]
s_add_u32 s44, s50, 0xe2a000
v_add_f32 v127, v127, v131
v_mfma_f32_16x16x32_bf16 v[172:175], a[112:115], a[8:11], v[172:175]
v_add_f32_dpp v92, v92, v92 row_ror:8 row_mask:0xf bank_mask:0xf
v_add_f32_dpp v100, v100, v100 row_ror:8 row_mask:0xf bank_mask:0xf
v_mfma_f32_16x16x32_bf16 v[196:199], a[112:115], a[16:19], v[196:199]
v_add_f32_dpp v108, v108, v108 row_ror:8 row_mask:0xf bank_mask:0xf
v_add_f32_dpp v116, v116, v116 row_ror:8 row_mask:0xf bank_mask:0xf
v_mfma_f32_16x16x32_bf16 v[196:199], a[116:119], a[20:23], v[196:199]
buffer_load_dwordx4 a[76:79], v2, s[40:43], s33 offen offset:1024 sc1
v_mfma_f32_16x16x32_bf16 v[220:223], a[116:119], a[28:31], v[220:223]
v_add_f32_dpp v124, v124, v124 row_ror:8 row_mask:0xf bank_mask:0xf
v_add_f32_dpp v93, v93, v93 row_ror:8 row_mask:0xf bank_mask:0xf
v_mfma_f32_16x16x32_bf16 v[220:223], a[112:115], a[24:27], v[220:223]
v_add_f32_dpp v101, v101, v101 row_ror:8 row_mask:0xf bank_mask:0xf
v_add_f32_dpp v109, v109, v109 row_ror:8 row_mask:0xf bank_mask:0xf
v_mfma_f32_16x16x32_bf16 a[180:183], a[120:123], a[164:167], a[180:183]
s_waitcnt lgkmcnt(0)
s_barrier
v_mfma_f32_16x16x32_bf16 v[224:227], a[128:131], a[24:27], v[224:227]
ds_read_b128 a[96:99], v5 offset:26624
v_add_f32_dpp v117, v117, v117 row_ror:8 row_mask:0xf bank_mask:0xf
v_mfma_f32_16x16x32_bf16 v[224:227], a[132:135], a[28:31], v[224:227]
buffer_load_dwordx4 a[80:83], v2, s[40:43], s35 offen offset:2048 sc1
v_mfma_f32_16x16x32_bf16 v[200:203], a[132:135], a[20:23], v[200:203]
ds_read_b128 a[100:103], v5 offset:32768
v_add_f32_dpp v125, v125, v125 row_ror:8 row_mask:0xf bank_mask:0xf
v_mfma_f32_16x16x32_bf16 v[200:203], a[128:131], a[16:19], v[200:203]
v_add_f32_dpp v92, v94, v94 row_ror:8 row_mask:0xf bank_mask:0xc
v_add_f32_dpp v100, v102, v102 row_ror:8 row_mask:0xf bank_mask:0xc
v_mfma_f32_16x16x32_bf16 v[176:179], a[128:131], a[8:11], v[176:179]
buffer_load_dwordx4 v1, s[4:7], s44 offen offset:0 sc1 lds
v_mfma_f32_16x16x32_bf16 v[176:179], a[132:135], a[12:15], v[176:179]
ds_read_b128 a[104:107], v5 offset:27648
v_add_f32_dpp v108, v110, v110 row_ror:8 row_mask:0xf bank_mask:0xc
v_mfma_f32_16x16x32_bf16 v[152:155], a[132:135], a[4:7], v[152:155]
L_stub1:
s_cbranch_execz L_wret0
ds_read_b128 a[108:111], v5 offset:33792
v_add_f32_dpp v116, v118, v118 row_ror:8 row_mask:0xf bank_mask:0xc
v_mfma_f32_16x16x32_bf16 v[152:155], a[128:131], a[0:3], v[152:155]
v_add_f32_dpp v124, v126, v126 row_ror:8 row_mask:0xf bank_mask:0xc
v_add_f32_dpp v93, v95, v95 row_ror:8 row_mask:0xf bank_mask:0xc
v_mfma_f32_16x16x32_bf16 v[132:135], a[136:139], a[0:3], v[132:135]
buffer_load_dwordx4 a[84:87], v2, s[40:43], s33 offen offset:2048 sc1
v_mfma_f32_16x16x32_bf16 v[132:135], a[140:143], a[4:7], v[132:135]
ds_read_b128 a[112:115], v5 offset:28672
v_add_f32_dpp v101, v103, v103 row_ror:8 row_mask:0xf bank_mask:0xc
v_mfma_f32_16x16x32_bf16 v[156:159], a[140:143], a[12:15], v[156:159]
v_add_f32_dpp v109, v111, v111 row_ror:8 row_mask:0xf bank_mask:0xc
v_add_f32_dpp v117, v119, v119 row_ror:8 row_mask:0xf bank_mask:0xc
v_mfma_f32_16x16x32_bf16 v[156:159], a[136:139], a[8:11], v[156:159]
buffer_load_dwordx4 v1, s[4:7], s44 offen offset:1024 sc1 lds
v_mfma_f32_16x16x32_bf16 v[180:183], a[136:139], a[16:19], v[180:183]
ds_read_b128 a[116:119], v5 offset:34816
v_add_f32_dpp v125, v127, v127 row_ror:8 row_mask:0xf bank_mask:0xc
v_mfma_f32_16x16x32_bf16 v[180:183], a[140:143], a[20:23], v[180:183]
ds_read_b128 a[120:123], v6 offset:26624
v_mfma_f32_16x16x32_bf16 v[204:207], a[140:143], a[28:31], v[204:207]
v_permlane32_swap_b32 v92, v93
v_mfma_f32_16x16x32_bf16 v[204:207], a[136:139], a[24:27], v[204:207]
buffer_load_dwordx4 a[88:91], v2, s[40:43], s35 offen offset:3072 sc1
v_mfma_f32_16x16x32_bf16 v[208:211], a[144:147], a[24:27], v[208:211]
v_permlane32_swap_b32 v100, v101
v_mfma_f32_16x16x32_bf16 v[208:211], a[148:151], a[28:31], v[208:211]
v_permlane32_swap_b32 v108, v109
v_mfma_f32_16x16x32_bf16 v[184:187], a[148:151], a[20:23], v[184:187]
buffer_load_dwordx4 v1, s[4:7], s44 offen offset:2048 sc1 lds
s_add_u32 m0, s18, 0x9000
v_mfma_f32_16x16x32_bf16 v[184:187], a[144:147], a[16:19], v[184:187]
s_add_u32 s44, s50, 0xe2d000
v_mfma_f32_16x16x32_bf16 v[160:163], a[144:147], a[8:11], v[160:163]
v_permlane32_swap_b32 v116, v117
v_mfma_f32_16x16x32_bf16 v[160:163], a[148:151], a[12:15], v[160:163]
v_permlane32_swap_b32 v124, v125
v_mfma_f32_16x16x32_bf16 v[136:139], a[148:151], a[4:7], v[136:139]
buffer_load_dwordx4 a[92:95], v2, s[40:43], s33 offen offset:3072 sc1
s_add_u32 s35, s35, 8192
v_mfma_f32_16x16x32_bf16 v[136:139], a[144:147], a[0:3], v[136:139]
s_add_u32 s33, s33, 8192
v_add_f32 v92, v92, v93
v_mfma_f32_16x16x32_bf16 a[184:187], a[152:155], a[164:167], a[184:187]
v_add_f32 v100, v100, v101
s_waitcnt vmcnt(13) lgkmcnt(0)
v_mfma_f32_16x16x32_bf16 v[140:143], a[96:99], a[32:35], v[140:143]
ds_read_b128 a[128:131], v5 offset:29696
v_add_f32 v108, v108, v109
v_mfma_f32_16x16x32_bf16 v[140:143], a[100:103], a[36:39], v[140:143]
buffer_load_dwordx4 a[0:3], v2, s[40:43], s35 offen offset:0 sc1
v_mfma_f32_16x16x32_bf16 v[164:167], a[100:103], a[44:47], v[164:167]
ds_read_b128 a[132:135], v5 offset:35840
v_add_f32 v116, v116, v117
v_mfma_f32_16x16x32_bf16 v[164:167], a[96:99], a[40:43], v[164:167]
v_add_f32 v124, v124, v125
v_mov_b32 v94, v92
v_mfma_f32_16x16x32_bf16 v[188:191], a[96:99], a[48:51], v[188:191]
ds_read_b128 a[136:139], v5 offset:24576
v_mov_b32 v102, v100
v_mfma_f32_16x16x32_bf16 v[188:191], a[100:103], a[52:55], v[188:191]
buffer_load_dwordx4 v1, s[4:7], s44 offen offset:0 sc1 lds
s_add_u32 s63, s28, 24
v_mfma_f32_16x16x32_bf16 v[212:215], a[100:103], a[60:63], v[212:215]
s_lshl_b32 s63, s63, 12
ds_read_b128 a[140:143], v5 offset:30720
v_mfma_f32_16x16x32_bf16 v[212:215], a[96:99], a[56:59], v[212:215]
v_mov_b32 v110, v108
v_mov_b32 v118, v116
v_mfma_f32_16x16x32_bf16 v[216:219], a[104:107], a[56:59], v[216:219]
v_mov_b32 v126, v124
v_mfma_f32_16x16x32_bf16 v[216:219], a[108:111], a[60:63], v[216:219]
buffer_load_dwordx4 a[4:7], v2, s[40:43], s33 offen offset:0 sc1
v_mfma_f32_16x16x32_bf16 v[192:195], a[108:111], a[52:55], v[192:195]
ds_read_b128 a[144:147], v5 offset:25600
v_mfma_f32_16x16x32_bf16 v[192:195], a[104:107], a[48:51], v[192:195]
ds_read_b128 a[148:151], v5 offset:31744
v_mfma_f32_16x16x32_bf16 v[168:171], a[104:107], a[40:43], v[168:171]
v_permlane16_swap_b32 v92, v94
v_mfma_f32_16x16x32_bf16 v[168:171], a[108:111], a[44:47], v[168:171]
buffer_load_dwordx4 a[8:11], v2, s[40:43], s35 offen offset:1024 sc1
v_mfma_f32_16x16x32_bf16 v[144:147], a[108:111], a[36:39], v[144:147]
ds_read_b128 a[152:155], v6 offset:27648
v_mfma_f32_16x16x32_bf16 v[144:147], a[104:107], a[32:35], v[144:147]
v_permlane16_swap_b32 v100, v102
v_mfma_f32_16x16x32_bf16 v[148:151], a[112:115], a[32:35], v[148:151]
v_permlane16_swap_b32 v108, v110
v_mfma_f32_16x16x32_bf16 v[148:151], a[116:119], a[36:39], v[148:151]
buffer_load_dwordx4 a[160:163], v3, s[40:43], s63 offen sc1
v_mfma_f32_16x16x32_bf16 v[172:175], a[116:119], a[44:47], v[172:175]
v_permlane16_swap_b32 v116, v118
v_mfma_f32_16x16x32_bf16 v[172:175], a[112:115], a[40:43], v[172:175]
v_permlane16_swap_b32 v124, v126
v_mfma_f32_16x16x32_bf16 v[196:199], a[112:115], a[48:51], v[196:199]
v_add_f32 v92, v92, v94
v_add_f32 v100, v100, v102
v_mfma_f32_16x16x32_bf16 v[196:199], a[116:119], a[52:55], v[196:199]
buffer_load_dwordx4 a[12:15], v2, s[40:43], s33 offen offset:1024 sc1
v_mfma_f32_16x16x32_bf16 v[220:223], a[116:119], a[60:63], v[220:223]
v_add_f32 v108, v108, v110
v_add_f32 v116, v116, v118
v_mfma_f32_16x16x32_bf16 v[220:223], a[112:115], a[56:59], v[220:223]
v_add_f32 v124, v124, v126
v_mov_b32 v94, v92
v_mfma_f32_16x16x32_bf16 a[172:175], a[120:123], a[168:171], a[172:175]
v_mov_b32 v102, v100
s_waitcnt lgkmcnt(0)
v_mfma_f32_16x16x32_bf16 v[224:227], a[128:131], a[56:59], v[224:227]
ds_read_b128 a[96:99], v5 offset:38912
v_mov_b32 v110, v108
v_mfma_f32_16x16x32_bf16 v[224:227], a[132:135], a[60:63], v[224:227]
buffer_load_dwordx4 a[16:19], v2, s[40:43], s35 offen offset:2048 sc1
v_mfma_f32_16x16x32_bf16 v[200:203], a[132:135], a[52:55], v[200:203]
ds_read_b128 a[100:103], v5 offset:45056
v_mov_b32 v118, v116
v_mfma_f32_16x16x32_bf16 v[200:203], a[128:131], a[48:51], v[200:203]
v_mov_b32 v126, v124
v_mfma_f32_16x16x32_bf16 v[176:179], a[128:131], a[40:43], v[176:179]
buffer_load_dwordx4 v1, s[4:7], s44 offen offset:1024 sc1 lds
v_mfma_f32_16x16x32_bf16 v[176:179], a[132:135], a[44:47], v[176:179]
ds_read_b128 a[104:107], v5 offset:39936
v_mfma_f32_16x16x32_bf16 v[152:155], a[132:135], a[36:39], v[152:155]
ds_read_b128 a[108:111], v5 offset:46080
v_mfma_f32_16x16x32_bf16 v[152:155], a[128:131], a[32:35], v[152:155]
v_permlane32_swap_b32 v92, v94
v_mfma_f32_16x16x32_bf16 v[132:135], a[136:139], a[32:35], v[132:135]
buffer_load_dwordx4 a[20:23], v2, s[40:43], s33 offen offset:2048 sc1
v_mfma_f32_16x16x32_bf16 v[132:135], a[140:143], a[36:39], v[132:135]
ds_read_b128 a[112:115], v5 offset:40960
v_mfma_f32_16x16x32_bf16 v[156:159], a[140:143], a[44:47], v[156:159]
v_permlane32_swap_b32 v100, v102
v_mfma_f32_16x16x32_bf16 v[156:159], a[136:139], a[40:43], v[156:159]
buffer_load_dwordx4 v1, s[4:7], s44 offen offset:2048 sc1 lds
s_add_u32 s63, s28, 28
v_mfma_f32_16x16x32_bf16 v[180:183], a[136:139], a[48:51], v[180:183]
s_lshl_b32 s63, s63, 12
ds_read_b128 a[116:119], v5 offset:47104
v_mfma_f32_16x16x32_bf16 v[180:183], a[140:143], a[52:55], v[180:183]
ds_read_b128 a[120:123], v6 offset:28672
v_mfma_f32_16x16x32_bf16 v[204:207], a[140:143], a[60:63], v[204:207]
v_permlane32_swap_b32 v108, v110
v_mfma_f32_16x16x32_bf16 v[204:207], a[136:139], a[56:59], v[204:207]
buffer_load_dwordx4 a[24:27], v2, s[40:43], s35 offen offset:3072 sc1
v_mfma_f32_16x16x32_bf16 v[208:211], a[144:147], a[56:59], v[208:211]
v_permlane32_swap_b32 v116, v118
v_mfma_f32_16x16x32_bf16 v[208:211], a[148:151], a[60:63], v[208:211]
v_permlane32_swap_b32 v124, v126
v_mfma_f32_16x16x32_bf16 v[184:187], a[148:151], a[52:55], v[184:187]
buffer_load_dwordx4 a[164:167], v3, s[40:43], s63 offen sc1
s_add_u32 m0, s19, 49152
v_mfma_f32_16x16x32_bf16 v[184:187], a[144:147], a[48:51], v[184:187]
s_add_u32 s44, s85, 0xa04000
v_mul_f32 v82, 0xba800000, v92
v_mfma_f32_16x16x32_bf16 v[160:163], a[144:147], a[40:43], v[160:163]
v_mul_f32 v84, 0xba800000, v100
v_mul_f32 v86, 0xba800000, v108
v_mfma_f32_16x16x32_bf16 v[160:163], a[148:151], a[44:47], v[160:163]
v_mul_f32 v88, 0xba800000, v116
v_mul_f32 v90, 0xba800000, v124
v_mfma_f32_16x16x32_bf16 v[136:139], a[148:151], a[36:39], v[136:139]
buffer_load_dwordx4 a[28:31], v2, s[40:43], s33 offen offset:3072 sc1
s_add_u32 s35, s35, 8192
v_mfma_f32_16x16x32_bf16 v[136:139], a[144:147], a[32:35], v[136:139]
s_add_u32 s33, s33, 8192
v_mul_f32 v94, 0x3a800000, v94
v_mfma_f32_16x16x32_bf16 a[176:179], a[152:155], a[168:171], a[176:179]
v_mul_f32 v102, 0x3a800000, v102
s_waitcnt vmcnt(13) lgkmcnt(0)
v_mfma_f32_16x16x32_bf16 v[140:143], a[96:99], a[64:67], v[140:143]
ds_read_b128 a[128:131], v5 offset:41984
v_mul_f32 v110, 0x3a800000, v110
v_mfma_f32_16x16x32_bf16 v[140:143], a[100:103], a[68:71], v[140:143]
buffer_load_dwordx4 a[32:35], v2, s[40:43], s35 offen offset:0 sc1
v_mfma_f32_16x16x32_bf16 v[164:167], a[100:103], a[76:79], v[164:167]
ds_read_b128 a[132:135], v5 offset:48128
v_mul_f32 v118, 0x3a800000, v118
v_mfma_f32_16x16x32_bf16 v[164:167], a[96:99], a[72:75], v[164:167]
v_mul_f32 v126, 0x3a800000, v126
v_fma_f32 v94, -v82, v82, v94
v_mfma_f32_16x16x32_bf16 v[188:191], a[96:99], a[80:83], v[188:191]
ds_read_b128 a[136:139], v5 offset:36864
v_fma_f32 v102, -v84, v84, v102
v_mfma_f32_16x16x32_bf16 v[188:191], a[100:103], a[84:87], v[188:191]
buffer_load_dwordx4 v1, s[4:7], s44 offen offset:0 sc1 lds
v_mfma_f32_16x16x32_bf16 v[212:215], a[100:103], a[92:95], v[212:215]
ds_read_b128 a[140:143], v5 offset:43008
v_fma_f32 v110, -v86, v86, v110
v_mfma_f32_16x16x32_bf16 v[212:215], a[96:99], a[88:91], v[212:215]
v_fma_f32 v118, -v88, v88, v118
v_fma_f32 v126, -v90, v90, v126
v_max_f32 v94, 0, v94
v_max_f32 v102, 0, v102
v_max_f32 v110, 0, v110
v_max_f32 v118, 0, v118
v_max_f32 v126, 0, v126
v_add_f32 v94, 0x3727c5ac, v94
v_add_f32 v102, 0x3727c5ac, v102
v_add_f32 v110, 0x3727c5ac, v110
v_add_f32 v118, 0x3727c5ac, v118
v_add_f32 v126, 0x3727c5ac, v126
v_rsq_f32 v83, v94
v_rsq_f32 v85, v102
v_rsq_f32 v87, v110
v_rsq_f32 v89, v118
v_rsq_f32 v91, v126
v_mfma_f32_16x16x32_bf16 v[216:219], a[104:107], a[88:91], v[216:219]
v_mfma_f32_16x16x32_bf16 v[216:219], a[108:111], a[92:95], v[216:219]
buffer_load_dwordx4 a[36:39], v2, s[40:43], s33 offen offset:0 sc1
v_mfma_f32_16x16x32_bf16 v[192:195], a[108:111], a[84:87], v[192:195]
ds_read_b128 a[144:147], v5 offset:37888
v_fmac_f32 v140, v56, v82
v_mfma_f32_16x16x32_bf16 v[192:195], a[104:107], a[80:83], v[192:195]
ds_read_b128 a[148:151], v5 offset:44032
v_mfma_f32_16x16x32_bf16 v[168:171], a[104:107], a[72:75], v[168:171]
v_fmac_f32 v164, v56, v84
v_mfma_f32_16x16x32_bf16 v[168:171], a[108:111], a[76:79], v[168:171]
buffer_load_dwordx4 a[40:43], v2, s[40:43], s35 offen offset:1024 sc1
v_mfma_f32_16x16x32_bf16 v[144:147], a[108:111], a[68:71], v[144:147]
ds_read_b128 a[152:155], v6 offset:29696
v_fmac_f32 v188, v56, v86
v_mfma_f32_16x16x32_bf16 v[144:147], a[104:107], a[64:67], v[144:147]
v_mfma_f32_16x16x32_bf16 v[148:151], a[112:115], a[64:67], v[148:151]
v_fmac_f32 v212, v56, v88
v_mfma_f32_16x16x32_bf16 v[148:151], a[116:119], a[68:71], v[148:151]
buffer_load_dwordx4 v1, s[4:7], s44 offen offset:1024 sc1 lds
v_mfma_f32_16x16x32_bf16 v[172:175], a[116:119], a[76:79], v[172:175]
v_fmac_f32 v216, v60, v88
v_mfma_f32_16x16x32_bf16 v[172:175], a[112:115], a[72:75], v[172:175]
v_mfma_f32_16x16x32_bf16 v[196:199], a[112:115], a[80:83], v[196:199]
v_fmac_f32 v192, v60, v86
v_mfma_f32_16x16x32_bf16 v[196:199], a[116:119], a[84:87], v[196:199]
buffer_load_dwordx4 a[44:47], v2, s[40:43], s33 offen offset:1024 sc1
v_mfma_f32_16x16x32_bf16 v[220:223], a[116:119], a[92:95], v[220:223]
v_fmac_f32 v168, v60, v84
v_fmac_f32 v141, v57, v82
v_mfma_f32_16x16x32_bf16 v[220:223], a[112:115], a[88:91], v[220:223]
v_mfma_f32_16x16x32_bf16 a[180:183], a[120:123], a[168:171], a[180:183]
s_waitcnt vmcnt(9) lgkmcnt(0)
s_barrier
v_mfma_f32_16x16x32_bf16 v[224:227], a[128:131], a[88:91], v[224:227]
v_add_u32 v5, 0, v1
v_add_u32 v6, s55, v5
v_mfma_f32_16x16x32_bf16 v[224:227], a[132:135], a[92:95], v[224:227]
buffer_load_dwordx4 a[48:51], v2, s[40:43], s35 offen offset:2048 sc1
v_mfma_f32_16x16x32_bf16 v[200:203], a[132:135], a[84:87], v[200:203]
ds_read_b128 a[96:99], v5 offset:2048
v_fmac_f32 v144, v60, v82
v_mfma_f32_16x16x32_bf16 v[200:203], a[128:131], a[80:83], v[200:203]
ds_read_b128 a[100:103], v5 offset:8192
v_fmac_f32 v148, v64, v82
v_mfma_f32_16x16x32_bf16 v[176:179], a[128:131], a[72:75], v[176:179]
buffer_load_dwordx4 v1, s[4:7], s44 offen offset:2048 sc1 lds
v_mfma_f32_16x16x32_bf16 v[176:179], a[132:135], a[76:79], v[176:179]
ds_read_b128 a[104:107], v5 offset:3072
v_fmac_f32 v172, v64, v84
v_mfma_f32_16x16x32_bf16 v[152:155], a[132:135], a[68:71], v[152:155]
ds_read_b128 a[108:111], v5 offset:9216
v_fmac_f32 v196, v64, v86
v_mfma_f32_16x16x32_bf16 v[152:155], a[128:131], a[64:67], v[152:155]
v_fmac_f32 v220, v64, v88
v_fmac_f32 v165, v57, v84
v_mfma_f32_16x16x32_bf16 v[132:135], a[136:139], a[64:67], v[132:135]
buffer_load_dwordx4 a[52:55], v2, s[40:43], s33 offen offset:2048 sc1
v_mfma_f32_16x16x32_bf16 v[132:135], a[140:143], a[68:71], v[132:135]
ds_read_b128 a[112:115], v5 offset:4096
v_fmac_f32 v189, v57, v86
v_mfma_f32_16x16x32_bf16 v[156:159], a[140:143], a[76:79], v[156:159]
ds_read_b128 a[116:119], v5 offset:10240
v_fmac_f32 v224, v68, v88
v_mfma_f32_16x16x32_bf16 v[156:159], a[136:139], a[72:75], v[156:159]
buffer_load_dwordx4 v1, s[4:7], s44 offen offset:3072 sc1 lds
s_add_u32 m0, s19, 65536
v_mfma_f32_16x16x32_bf16 v[180:183], a[136:139], a[80:83], v[180:183]
s_add_u32 s44, s84, 0xa08000
ds_read_b128 a[120:123], v6 offset:2048
v_mfma_f32_16x16x32_bf16 v[180:183], a[140:143], a[84:87], v[180:183]
v_fmac_f32 v200, v68, v86
v_fmac_f32 v213, v57, v88
v_mfma_f32_16x16x32_bf16 v[204:207], a[140:143], a[92:95], v[204:207]
ds_read_b128 a[124:127], v6 offset:26624
v_fmac_f32 v176, v68, v84
v_mfma_f32_16x16x32_bf16 v[204:207], a[136:139], a[88:91], v[204:207]
buffer_load_dwordx4 a[56:59], v2, s[40:43], s35 offen offset:3072 sc1
v_mfma_f32_16x16x32_bf16 v[208:211], a[144:147], a[88:91], v[208:211]
v_fmac_f32 v152, v68, v82
v_fmac_f32 v217, v61, v88
v_mfma_f32_16x16x32_bf16 v[208:211], a[148:151], a[92:95], v[208:211]
v_fmac_f32 v193, v61, v86
v_fmac_f32 v169, v61, v84
v_mfma_f32_16x16x32_bf16 v[184:187], a[148:151], a[84:87], v[184:187]
buffer_load_dwordx4 v1, s[4:7], s44 offen offset:0 sc1 lds
v_mfma_f32_16x16x32_bf16 v[184:187], a[144:147], a[80:83], v[184:187]
v_fmac_f32 v132, v48, v82
v_fmac_f32 v145, v61, v82
v_mfma_f32_16x16x32_bf16 v[160:163], a[144:147], a[72:75], v[160:163]
v_fmac_f32 v156, v48, v84
v_fmac_f32 v149, v65, v82
v_mfma_f32_16x16x32_bf16 v[160:163], a[148:151], a[76:79], v[160:163]
v_fmac_f32 v173, v65, v84
v_fmac_f32 v197, v65, v86
v_mfma_f32_16x16x32_bf16 v[136:139], a[148:151], a[68:71], v[136:139]
buffer_load_dwordx4 a[60:63], v2, s[40:43], s33 offen offset:3072 sc1
s_add_u32 s35, s35, 8192
v_mfma_f32_16x16x32_bf16 v[136:139], a[144:147], a[64:67], v[136:139]
s_add_u32 s33, s33, 8192
v_fmac_f32 v180, v48, v86
v_mfma_f32_16x16x32_bf16 a[184:187], a[152:155], a[168:171], a[184:187]
v_fmac_f32 v204, v48, v88
s_waitcnt vmcnt(13) lgkmcnt(0)
v_mfma_f32_16x16x32_bf16 v[140:143], a[96:99], a[0:3], v[140:143]
ds_read_b128 a[128:131], v5 offset:5120
v_fmac_f32 v221, v65, v88
v_mfma_f32_16x16x32_bf16 v[140:143], a[100:103], a[4:7], v[140:143]
buffer_load_dwordx4 a[64:67], v2, s[40:43], s35 offen offset:0 sc1
s_lshl_b32 s37, s28, 10
v_mfma_f32_16x16x32_bf16 v[164:167], a[100:103], a[12:15], v[164:167]
ds_read_b128 a[132:135], v5 offset:11264
v_fmac_f32 v208, v52, v88
v_mfma_f32_16x16x32_bf16 v[164:167], a[96:99], a[8:11], v[164:167]
v_fmac_f32 v184, v52, v86
v_fmac_f32 v225, v69, v88
v_mfma_f32_16x16x32_bf16 v[188:191], a[96:99], a[16:19], v[188:191]
buffer_load_dwordx4 a[68:71], v2, s[40:43], s33 offen offset:0 sc1
s_lshl_b32 s72, s30, 12
v_mfma_f32_16x16x32_bf16 v[188:191], a[100:103], a[20:23], v[188:191]
ds_read_b128 a[136:139], v5 offset:0
v_fmac_f32 v160, v52, v84
v_mfma_f32_16x16x32_bf16 v[212:215], a[100:103], a[28:31], v[212:215]
ds_read_b128 a[140:143], v5 offset:6144
v_fmac_f32 v201, v69, v86
v_mfma_f32_16x16x32_bf16 v[212:215], a[96:99], a[24:27], v[212:215]
v_fmac_f32 v136, v52, v82
v_fmac_f32 v177, v69, v84
v_mfma_f32_16x16x32_bf16 v[216:219], a[104:107], a[24:27], v[216:219]
buffer_load_dwordx4 v1, s[4:7], s44 offen offset:1024 sc1 lds
s_add_u32 s72, s72, 0x1e00000
v_mfma_f32_16x16x32_bf16 v[216:219], a[108:111], a[28:31], v[216:219]
ds_read_b128 a[144:147], v5 offset:1024
v_fmac_f32 v153, v69, v82
v_mfma_f32_16x16x32_bf16 v[192:195], a[108:111], a[20:23], v[192:195]
ds_read_b128 a[148:151], v5 offset:7168
v_fmac_f32 v133, v49, v82
v_mfma_f32_16x16x32_bf16 v[192:195], a[104:107], a[16:19], v[192:195]
v_fmac_f32 v157, v49, v84
v_fmac_f32 v181, v49, v86
v_mfma_f32_16x16x32_bf16 v[168:171], a[104:107], a[8:11], v[168:171]
buffer_load_dwordx4 a[72:75], v2, s[40:43], s35 offen offset:1024 sc1
v_mfma_f32_16x16x32_bf16 v[168:171], a[108:111], a[12:15], v[168:171]
ds_read_b128 a[152:155], v6 offset:3072
v_fmac_f32 v205, v49, v88
v_mfma_f32_16x16x32_bf16 v[144:147], a[108:111], a[4:7], v[144:147]
ds_read_b128 a[156:159], v6 offset:27648
v_fmac_f32 v209, v53, v88
v_mfma_f32_16x16x32_bf16 v[144:147], a[104:107], a[0:3], v[144:147]
buffer_load_dwordx4 a[76:79], v2, s[40:43], s33 offen offset:1024 sc1
v_mfma_f32_16x16x32_bf16 v[148:151], a[112:115], a[0:3], v[148:151]
v_fmac_f32 v185, v53, v86
v_fmac_f32 v142, v58, v82
v_mfma_f32_16x16x32_bf16 v[148:151], a[116:119], a[4:7], v[148:151]
v_fmac_f32 v161, v53, v84
v_fmac_f32 v166, v58, v84
v_mfma_f32_16x16x32_bf16 v[172:175], a[116:119], a[12:15], v[172:175]
v_fmac_f32 v190, v58, v86
v_fmac_f32 v214, v58, v88
v_mfma_f32_16x16x32_bf16 v[172:175], a[112:115], a[8:11], v[172:175]
buffer_load_dwordx4 a[80:83], v2, s[40:43], s35 offen offset:2048 sc1
v_mfma_f32_16x16x32_bf16 v[196:199], a[112:115], a[16:19], v[196:199]
v_fmac_f32 v137, v53, v82
v_fmac_f32 v218, v62, v88
v_mfma_f32_16x16x32_bf16 v[196:199], a[116:119], a[20:23], v[196:199]
v_fmac_f32 v194, v62, v86
v_add_u32 v233, s37, v1
v_mfma_f32_16x16x32_bf16 v[220:223], a[116:119], a[28:31], v[220:223]
v_fmac_f32 v170, v62, v84
v_fmac_f32 v143, v59, v82
v_mfma_f32_16x16x32_bf16 v[220:223], a[112:115], a[24:27], v[220:223]
buffer_load_dwordx4 a[84:87], v2, s[40:43], s33 offen offset:2048 sc1
v_mfma_f32_16x16x32_bf16 a[172:175], a[120:123], a[160:163], a[172:175]
v_fmac_f32 v146, v62, v82
v_fmac_f32 v167, v59, v84
v_mfma_f32_16x16x32_bf16 a[172:175], a[124:127], a[164:167], a[172:175]
v_add_u32 v232, s19, v7
s_waitcnt lgkmcnt(0)
v_mfma_f32_16x16x32_bf16 v[224:227], a[128:131], a[24:27], v[224:227]
ds_read_b128 a[96:99], v5 offset:14336
v_fmac_f32 v150, v66, v82
v_mfma_f32_16x16x32_bf16 v[224:227], a[132:135], a[28:31], v[224:227]
buffer_load_dwordx4 a[88:91], v2, s[40:43], s35 offen offset:3072 sc1
v_mfma_f32_16x16x32_bf16 v[200:203], a[132:135], a[20:23], v[200:203]
ds_read_b128 a[100:103], v5 offset:20480
v_fmac_f32 v174, v66, v84
v_mfma_f32_16x16x32_bf16 v[200:203], a[128:131], a[16:19], v[200:203]
v_fmac_f32 v191, v59, v86
v_fmac_f32 v215, v59, v88
v_mfma_f32_16x16x32_bf16 v[176:179], a[128:131], a[8:11], v[176:179]
buffer_load_dwordx4 v1, s[4:7], s44 offen offset:2048 sc1 lds
v_mfma_f32_16x16x32_bf16 v[176:179], a[132:135], a[12:15], v[176:179]
ds_read_b128 a[104:107], v5 offset:15360
v_fmac_f32 v198, v66, v86
v_mfma_f32_16x16x32_bf16 v[152:155], a[132:135], a[4:7], v[152:155]
ds_read_b128 a[108:111], v5 offset:21504
v_fmac_f32 v222, v66, v88
v_mfma_f32_16x16x32_bf16 v[152:155], a[128:131], a[0:3], v[152:155]
v_fmac_f32 v219, v63, v88
v_fmac_f32 v195, v63, v86
v_mfma_f32_16x16x32_bf16 v[132:135], a[136:139], a[0:3], v[132:135]
buffer_load_dwordx4 v1, s[4:7], s44 offen offset:3072 sc1 lds
s_add_u32 m0, s19, 81920
v_mfma_f32_16x16x32_bf16 v[132:135], a[140:143], a[4:7], v[132:135]
s_add_u32 s44, s85, 0xa0c000
ds_read_b128 a[112:115], v5 offset:16384
v_mfma_f32_16x16x32_bf16 v[156:159], a[140:143], a[12:15], v[156:159]
ds_read_b128 a[116:119], v5 offset:22528
v_fmac_f32 v226, v70, v88
v_mfma_f32_16x16x32_bf16 v[156:159], a[136:139], a[8:11], v[156:159]
v_fmac_f32 v171, v63, v84
v_fmac_f32 v147, v63, v82
v_mfma_f32_16x16x32_bf16 v[180:183], a[136:139], a[16:19], v[180:183]
buffer_load_dwordx4 v1, s[4:7], s44 offen offset:0 sc1 lds
v_mfma_f32_16x16x32_bf16 v[180:183], a[140:143], a[20:23], v[180:183]
ds_read_b128 a[120:123], v6 offset:4096
v_fmac_f32 v202, v70, v86
v_mfma_f32_16x16x32_bf16 v[204:207], a[140:143], a[28:31], v[204:207]
ds_read_b128 a[124:127], v6 offset:28672
v_fmac_f32 v178, v70, v84
v_mfma_f32_16x16x32_bf16 v[204:207], a[136:139], a[24:27], v[204:207]
buffer_load_dwordx4 a[92:95], v2, s[40:43], s33 offen offset:3072 sc1
s_add_u32 s35, s35, 8192
v_mfma_f32_16x16x32_bf16 v[208:211], a[144:147], a[24:27], v[208:211]
s_add_u32 s33, s33, 8192
v_fmac_f32 v154, v70, v82
v_mfma_f32_16x16x32_bf16 v[208:211], a[148:151], a[28:31], v[208:211]
v_fmac_f32 v151, v67, v82
v_fmac_f32 v175, v67, v84
v_mfma_f32_16x16x32_bf16 v[184:187], a[148:151], a[20:23], v[184:187]
v_fmac_f32 v134, v50, v82
v_fmac_f32 v199, v67, v86
v_mfma_f32_16x16x32_bf16 v[184:187], a[144:147], a[16:19], v[184:187]
buffer_load_dwordx4 v1, s[4:7], s44 offen offset:1024 sc1 lds
v_mfma_f32_16x16x32_bf16 v[160:163], a[144:147], a[8:11], v[160:163]
v_fmac_f32 v158, v50, v84
v_fmac_f32 v223, v67, v88
v_mfma_f32_16x16x32_bf16 v[160:163], a[148:151], a[12:15], v[160:163]
v_add_u32 v248, s19, v8
v_mfma_f32_16x16x32_bf16 v[136:139], a[148:151], a[4:7], v[136:139]
v_fmac_f32 v182, v50, v86
v_fmac_f32 v227, v71, v88
v_mfma_f32_16x16x32_bf16 v[136:139], a[144:147], a[0:3], v[136:139]
buffer_load_dwordx4 v1, s[4:7], s44 offen offset:2048 sc1 lds
v_mfma_f32_16x16x32_bf16 a[176:179], a[152:155], a[160:163], a[176:179]
v_fmac_f32 v206, v50, v88
v_fmac_f32 v203, v71, v86
v_mfma_f32_16x16x32_bf16 a[176:179], a[156:159], a[164:167], a[176:179]
s_waitcnt vmcnt(14) lgkmcnt(0)
v_mfma_f32_16x16x32_bf16 v[140:143], a[96:99], a[32:35], v[140:143]
ds_read_b128 a[128:131], v5 offset:17408
v_fmac_f32 v210, v54, v88
v_mfma_f32_16x16x32_bf16 v[140:143], a[100:103], a[36:39], v[140:143]
buffer_load_dwordx4 a[0:3], v2, s[40:43], s35 offen offset:0 sc1
v_mfma_f32_16x16x32_bf16 v[164:167], a[100:103], a[44:47], v[164:167]
ds_read_b128 a[132:135], v5 offset:23552
v_fmac_f32 v186, v54, v86
v_mfma_f32_16x16x32_bf16 v[164:167], a[96:99], a[40:43], v[164:167]
v_fmac_f32 v179, v71, v84
v_fmac_f32 v155, v71, v82
v_mfma_f32_16x16x32_bf16 v[188:191], a[96:99], a[48:51], v[188:191]
buffer_load_dwordx4 a[4:7], v2, s[40:43], s33 offen offset:0 sc1
v_mfma_f32_16x16x32_bf16 v[188:191], a[100:103], a[52:55], v[188:191]
ds_read_b128 a[136:139], v5 offset:26624
v_fmac_f32 v162, v54, v84
v_mfma_f32_16x16x32_bf16 v[212:215], a[100:103], a[60:63], v[212:215]
ds_read_b128 a[140:143], v5 offset:32768
v_fmac_f32 v138, v54, v82
v_mfma_f32_16x16x32_bf16 v[212:215], a[96:99], a[56:59], v[212:215]
buffer_load_dwordx4 a[8:11], v2, s[40:43], s35 offen offset:1024 sc1
v_mfma_f32_16x16x32_bf16 v[216:219], a[104:107], a[56:59], v[216:219]
ds_read_b128 a[144:147], v5 offset:27648
v_fmac_f32 v135, v51, v82
v_mfma_f32_16x16x32_bf16 v[216:219], a[108:111], a[60:63], v[216:219]
v_fmac_f32 v159, v51, v84
v_fmac_f32 v183, v51, v86
v_mfma_f32_16x16x32_bf16 v[192:195], a[108:111], a[52:55], v[192:195]
buffer_load_dwordx4 a[12:15], v2, s[40:43], s33 offen offset:1024 sc1
v_mfma_f32_16x16x32_bf16 v[192:195], a[104:107], a[48:51], v[192:195]
ds_read_b128 a[148:151], v5 offset:33792
v_fmac_f32 v207, v51, v88
v_mfma_f32_16x16x32_bf16 v[168:171], a[104:107], a[40:43], v[168:171]
ds_read_b128 a[152:155], v6 offset:5120
v_fmac_f32 v211, v55, v88
v_mfma_f32_16x16x32_bf16 v[168:171], a[108:111], a[44:47], v[168:171]
v_mul_f32 v88, 0x3e8293ee, v89
v_mfma_f32_16x16x32_bf16 v[144:147], a[108:111], a[36:39], v[144:147]
buffer_load_dwordx4 a[16:19], v2, s[40:43], s35 offen offset:2048 sc1
v_mfma_f32_16x16x32_bf16 v[144:147], a[104:107], a[32:35], v[144:147]
ds_read_b128 a[156:159], v6 offset:29696
v_fmac_f32 v187, v55, v86
v_mfma_f32_16x16x32_bf16 v[148:151], a[112:115], a[32:35], v[148:151]
v_fmac_f32 v163, v55, v84
v_mul_f32 v86, 0x3e8293ee, v87
v_mfma_f32_16x16x32_bf16 v[148:151], a[116:119], a[36:39], v[148:151]
buffer_load_dwordx4 a[20:23], v2, s[40:43], s33 offen offset:2048 sc1
v_mfma_f32_16x16x32_bf16 v[172:175], a[116:119], a[44:47], v[172:175]
v_fmac_f32 v139, v55, v82
v_mul_f32 v84, 0x3e8293ee, v85
v_mfma_f32_16x16x32_bf16 v[172:175], a[112:115], a[40:43], v[172:175]
v_mul_f32 v82, 0x3e8293ee, v83
v_mfma_f32_16x16x32_bf16 v[196:199], a[112:115], a[48:51], v[196:199]
buffer_load_dwordx4 a[24:27], v2, s[40:43], s35 offen offset:3072 sc1
v_mfma_f32_16x16x32_bf16 v[196:199], a[116:119], a[52:55], v[196:199]
v_mfma_f32_16x16x32_bf16 v[220:223], a[116:119], a[60:63], v[220:223]
v_mfma_f32_16x16x32_bf16 v[220:223], a[112:115], a[56:59], v[220:223]
buffer_load_dwordx4 a[28:31], v2, s[40:43], s33 offen offset:3072 sc1
s_add_u32 s35, s35, 8192
v_mfma_f32_16x16x32_bf16 a[180:183], a[120:123], a[160:163], a[180:183]
s_add_u32 s33, s33, 8192
v_mfma_f32_16x16x32_bf16 a[180:183], a[124:127], a[164:167], a[180:183]
s_waitcnt lgkmcnt(0)
v_mfma_f32_16x16x32_bf16 v[224:227], a[128:131], a[56:59], v[224:227]
ds_read_b128 a[96:99], v5 offset:28672
s_lshl_b32 s90, s28, 12
v_mfma_f32_16x16x32_bf16 v[224:227], a[132:135], a[60:63], v[224:227]
buffer_load_dwordx4 v1, s[4:7], s44 offen offset:3072 sc1 lds
s_add_u32 s90, s90, 147456
v_mfma_f32_16x16x32_bf16 v[200:203], a[132:135], a[52:55], v[200:203]
ds_read_b128 a[100:103], v5 offset:34816
v_add_u32 v234, s90, v1
v_mfma_f32_16x16x32_bf16 v[200:203], a[128:131], a[48:51], v[200:203]
s_lshl_b32 s90, s28, 10
s_add_u32 s90, s90, 147456
v_mfma_f32_16x16x32_bf16 v[176:179], a[128:131], a[40:43], v[176:179]
v_add_u32 v235, s90, v1
v_mfma_f32_16x16x32_bf16 v[176:179], a[132:135], a[44:47], v[176:179]
ds_read_b128 a[104:107], v5 offset:29696
v_mfma_f32_16x16x32_bf16 v[152:155], a[132:135], a[36:39], v[152:155]
v_mfma_f32_16x16x32_bf16 v[152:155], a[128:131], a[32:35], v[152:155]
s_waitcnt vmcnt(22)
v_mfma_f32_16x16x32_bf16 v[140:143], a[136:139], a[64:67], v[140:143]
ds_read_b128 a[108:111], v5 offset:35840
s_waitcnt vmcnt(21)
v_mfma_f32_16x16x32_bf16 v[140:143], a[140:143], a[68:71], v[140:143]
s_waitcnt vmcnt(18)
v_mfma_f32_16x16x32_bf16 v[164:167], a[140:143], a[76:79], v[164:167]
ds_read_b128 a[112:115], v5 offset:38912
v_mfma_f32_16x16x32_bf16 v[164:167], a[136:139], a[72:75], v[164:167]
s_waitcnt vmcnt(17)
v_mfma_f32_16x16x32_bf16 v[188:191], a[136:139], a[80:83], v[188:191]
s_waitcnt vmcnt(16)
v_mfma_f32_16x16x32_bf16 v[188:191], a[140:143], a[84:87], v[188:191]
ds_read_b128 a[116:119], v5 offset:45056
s_waitcnt vmcnt(11)
v_mfma_f32_16x16x32_bf16 v[212:215], a[140:143], a[92:95], v[212:215]
v_mfma_f32_16x16x32_bf16 v[212:215], a[136:139], a[88:91], v[212:215]
v_mfma_f32_16x16x32_bf16 v[216:219], a[144:147], a[88:91], v[216:219]
v_mfma_f32_16x16x32_bf16 v[216:219], a[148:151], a[92:95], v[216:219]
v_mfma_f32_16x16x32_bf16 v[192:195], a[148:151], a[84:87], v[192:195]
v_mfma_f32_16x16x32_bf16 v[192:195], a[144:147], a[80:83], v[192:195]
v_mfma_f32_16x16x32_bf16 v[168:171], a[144:147], a[72:75], v[168:171]
v_mfma_f32_16x16x32_bf16 v[168:171], a[148:151], a[76:79], v[168:171]
v_mfma_f32_16x16x32_bf16 v[144:147], a[148:151], a[68:71], v[144:147]
v_mfma_f32_16x16x32_bf16 v[144:147], a[144:147], a[64:67], v[144:147]
v_mfma_f32_16x16x32_bf16 a[184:187], a[152:155], a[160:163], a[184:187]
v_mfma_f32_16x16x32_bf16 a[184:187], a[156:159], a[164:167], a[184:187]
s_waitcnt lgkmcnt(0)
v_mfma_f32_16x16x32_bf16 v[148:151], a[96:99], a[64:67], v[148:151]
ds_read_b128 a[128:131], v5 offset:39936
v_mfma_f32_16x16x32_bf16 v[148:151], a[100:103], a[68:71], v[148:151]
buffer_store_dwordx4 a[220:223], v1, s[4:7], s101 offen offset:0 sc1
v_mfma_f32_16x16x32_bf16 v[172:175], a[100:103], a[76:79], v[172:175]
ds_read_b128 a[132:135], v5 offset:46080
v_mfma_f32_16x16x32_bf16 v[172:175], a[96:99], a[72:75], v[172:175]
v_mfma_f32_16x16x32_bf16 v[196:199], a[96:99], a[80:83], v[196:199]
v_mfma_f32_16x16x32_bf16 v[196:199], a[100:103], a[84:87], v[196:199]
ds_read_b128 a[136:139], v5 offset:40960
v_mfma_f32_16x16x32_bf16 v[220:223], a[100:103], a[92:95], v[220:223]
v_mfma_f32_16x16x32_bf16 v[220:223], a[96:99], a[88:91], v[220:223]
v_mfma_f32_16x16x32_bf16 v[224:227], a[104:107], a[88:91], v[224:227]
ds_read_b128 a[140:143], v5 offset:47104
v_mfma_f32_16x16x32_bf16 v[224:227], a[108:111], a[92:95], v[224:227]
buffer_store_dwordx4 a[224:227], v1, s[4:7], s101 offen offset:1024 sc1
v_mfma_f32_16x16x32_bf16 v[200:203], a[108:111], a[84:87], v[200:203]
ds_read_b128 a[144:147], v5 offset:41984
v_mfma_f32_16x16x32_bf16 v[200:203], a[104:107], a[80:83], v[200:203]
ds_write_b128 v234, a[172:175] offset:0
v_mfma_f32_16x16x32_bf16 v[176:179], a[104:107], a[72:75], v[176:179]
v_mfma_f32_16x16x32_bf16 v[176:179], a[108:111], a[76:79], v[176:179]
ds_read_b128 a[148:151], v5 offset:48128
v_mfma_f32_16x16x32_bf16 v[152:155], a[108:111], a[68:71], v[152:155]
v_mfma_f32_16x16x32_bf16 v[152:155], a[104:107], a[64:67], v[152:155]
s_waitcnt vmcnt(10)
v_mfma_f32_16x16x32_bf16 v[140:143], a[112:115], a[0:3], v[140:143]
s_waitcnt vmcnt(9)
v_mfma_f32_16x16x32_bf16 v[140:143], a[116:119], a[4:7], v[140:143]
buffer_store_dwordx4 a[188:191], v1, s[4:7], s96 offen offset:0 sc1
s_waitcnt vmcnt(8)
v_mfma_f32_16x16x32_bf16 v[164:167], a[116:119], a[12:15], v[164:167]
v_mfma_f32_16x16x32_bf16 v[164:167], a[112:115], a[8:11], v[164:167]
s_waitcnt vmcnt(7)
v_mfma_f32_16x16x32_bf16 v[188:191], a[112:115], a[16:19], v[188:191]
s_waitcnt vmcnt(6)
v_mfma_f32_16x16x32_bf16 v[188:191], a[116:119], a[20:23], v[188:191]
L_stub2:
s_cbranch_execz L_wret0
s_waitcnt vmcnt(4)
v_mfma_f32_16x16x32_bf16 v[212:215], a[116:119], a[28:31], v[212:215]
ds_write_b128 v234, a[176:179] offset:1024
v_mfma_f32_16x16x32_bf16 v[212:215], a[112:115], a[24:27], v[212:215]
s_waitcnt lgkmcnt(1)
v_mfma_f32_16x16x32_bf16 v[216:219], a[128:131], a[24:27], v[216:219]
ds_read_b128 a[96:99], v5 offset:12288
v_mul_f32 v140, v140, v83
v_mfma_f32_16x16x32_bf16 v[216:219], a[132:135], a[28:31], v[216:219]
buffer_store_dwordx4 a[192:195], v1, s[4:7], s97 offen offset:0 sc1
v_mfma_f32_16x16x32_bf16 v[192:195], a[132:135], a[20:23], v[192:195]
ds_read_b128 a[100:103], v5 offset:18432
v_mul_f32 v141, v141, v83
v_mfma_f32_16x16x32_bf16 v[192:195], a[128:131], a[16:19], v[192:195]
v_cvt_pk_bf16_f32 v140, v140, v141
v_mul_f32 v164, v164, v85
v_mfma_f32_16x16x32_bf16 v[168:171], a[128:131], a[8:11], v[168:171]
v_mul_f32 v165, v165, v85
v_cvt_pk_bf16_f32 v164, v164, v165
v_mfma_f32_16x16x32_bf16 v[168:171], a[132:135], a[12:15], v[168:171]
ds_read_b128 a[104:107], v5 offset:24576
v_mul_f32 v188, v188, v87
v_mfma_f32_16x16x32_bf16 v[144:147], a[132:135], a[4:7], v[144:147]
v_mul_f32 v189, v189, v87
v_cvt_pk_bf16_f32 v188, v188, v189
v_mfma_f32_16x16x32_bf16 v[144:147], a[128:131], a[0:3], v[144:147]
v_mul_f32 v212, v212, v89
v_mul_f32 v213, v213, v89
v_mfma_f32_16x16x32_bf16 v[148:151], a[136:139], a[0:3], v[148:151]
ds_read_b128 a[108:111], v5 offset:30720
v_cvt_pk_bf16_f32 v212, v212, v213
v_mfma_f32_16x16x32_bf16 v[148:151], a[140:143], a[4:7], v[148:151]
buffer_store_dwordx4 a[196:199], v1, s[4:7], s96 offen offset:1024 sc1
v_mfma_f32_16x16x32_bf16 v[172:175], a[140:143], a[12:15], v[172:175]
ds_read_b128 a[112:115], v5 offset:36864
v_mul_f32 v214, v214, v89
v_mfma_f32_16x16x32_bf16 v[172:175], a[136:139], a[8:11], v[172:175]
ds_write_b128 v234, a[180:183] offset:2048
v_mul_f32 v215, v215, v89
v_mfma_f32_16x16x32_bf16 v[196:199], a[136:139], a[16:19], v[196:199]
v_cvt_pk_bf16_f32 v213, v214, v215
v_mul_f32 v216, v216, v89
v_mfma_f32_16x16x32_bf16 v[196:199], a[140:143], a[20:23], v[196:199]
ds_read_b128 a[116:119], v5 offset:43008
v_mul_f32 v217, v217, v89
v_mfma_f32_16x16x32_bf16 v[220:223], a[140:143], a[28:31], v[220:223]
v_cvt_pk_bf16_f32 v214, v216, v217
v_mul_f32 v218, v218, v89
v_mfma_f32_16x16x32_bf16 v[220:223], a[136:139], a[24:27], v[220:223]
v_mul_f32 v219, v219, v89
v_cvt_pk_bf16_f32 v215, v218, v219
v_mfma_f32_16x16x32_bf16 v[224:227], a[144:147], a[24:27], v[224:227]
v_mul_f32 v148, v148, v83
v_mul_f32 v149, v149, v83
v_mfma_f32_16x16x32_bf16 v[224:227], a[148:151], a[28:31], v[224:227]
buffer_store_dwordx4 a[200:203], v1, s[4:7], s97 offen offset:1024 sc1
v_mfma_f32_16x16x32_bf16 v[200:203], a[148:151], a[20:23], v[200:203]
v_cvt_pk_bf16_f32 v148, v148, v149
v_mul_f32 v172, v172, v85
v_mfma_f32_16x16x32_bf16 v[200:203], a[144:147], a[16:19], v[200:203]
v_mul_f32 v173, v173, v85
v_cvt_pk_bf16_f32 v172, v172, v173
v_mfma_f32_16x16x32_bf16 v[176:179], a[144:147], a[8:11], v[176:179]
v_mul_f32 v196, v196, v87
v_mul_f32 v197, v197, v87
v_mfma_f32_16x16x32_bf16 v[176:179], a[148:151], a[12:15], v[176:179]
v_cvt_pk_bf16_f32 v196, v196, v197
v_mul_f32 v198, v198, v87
v_mfma_f32_16x16x32_bf16 v[152:155], a[148:151], a[4:7], v[152:155]
ds_write_b128 v234, a[184:187] offset:3072
v_mul_f32 v199, v199, v87
v_mfma_f32_16x16x32_bf16 v[152:155], a[144:147], a[0:3], v[152:155]
v_cvt_pk_bf16_f32 v197, v198, v199
s_waitcnt lgkmcnt(1)
v_mfma_f32_16x16x32_bf16 v[132:135], a[96:99], a[32:35], v[132:135]
ds_read_b128 a[128:131], v5 offset:13312
v_mul_f32 v220, v220, v89
v_mfma_f32_16x16x32_bf16 v[132:135], a[100:103], a[36:39], v[132:135]
buffer_store_dwordx4 a[204:207], v1, s[4:7], s96 offen offset:2048 sc1
v_mfma_f32_16x16x32_bf16 v[156:159], a[100:103], a[44:47], v[156:159]
ds_read_b128 a[132:135], v5 offset:19456
v_mul_f32 v221, v221, v89
v_mfma_f32_16x16x32_bf16 v[156:159], a[96:99], a[40:43], v[156:159]
v_cvt_pk_bf16_f32 v220, v220, v221
v_mul_f32 v222, v222, v89
v_mfma_f32_16x16x32_bf16 v[180:183], a[96:99], a[48:51], v[180:183]
v_mul_f32 v223, v223, v89
v_cvt_pk_bf16_f32 v221, v222, v223
v_mfma_f32_16x16x32_bf16 v[180:183], a[100:103], a[52:55], v[180:183]
ds_read_b128 a[136:139], v5 offset:25600
v_mul_f32 v224, v224, v89
v_mfma_f32_16x16x32_bf16 v[204:207], a[100:103], a[60:63], v[204:207]
v_mul_f32 v225, v225, v89
v_cvt_pk_bf16_f32 v222, v224, v225
v_mfma_f32_16x16x32_bf16 v[204:207], a[96:99], a[56:59], v[204:207]
v_mul_f32 v226, v226, v89
v_mul_f32 v227, v227, v89
v_mfma_f32_16x16x32_bf16 v[204:207], a[104:107], a[88:91], v[204:207]
ds_read_b128 a[140:143], v5 offset:31744
v_cvt_pk_bf16_f32 v223, v226, v227
v_mfma_f32_16x16x32_bf16 v[204:207], a[108:111], a[92:95], v[204:207]
buffer_store_dwordx4 a[208:211], v1, s[4:7], s97 offen offset:2048 sc1
v_mfma_f32_16x16x32_bf16 v[180:183], a[108:111], a[84:87], v[180:183]
ds_read_b128 a[144:147], v5 offset:37888
v_mul_f32 v200, v200, v87
v_mfma_f32_16x16x32_bf16 v[180:183], a[104:107], a[80:83], v[180:183]
v_mul_f32 v201, v201, v87
v_cvt_pk_bf16_f32 v198, v200, v201
v_mfma_f32_16x16x32_bf16 v[156:159], a[104:107], a[72:75], v[156:159]
v_mul_f32 v202, v202, v87
v_mul_f32 v203, v203, v87
v_mfma_f32_16x16x32_bf16 v[156:159], a[108:111], a[76:79], v[156:159]
ds_read_b128 a[148:151], v5 offset:44032
v_cvt_pk_bf16_f32 v199, v202, v203
v_mfma_f32_16x16x32_bf16 v[132:135], a[108:111], a[68:71], v[132:135]
v_mul_f32 v174, v174, v85
v_mul_f32 v175, v175, v85
v_mfma_f32_16x16x32_bf16 v[132:135], a[104:107], a[64:67], v[132:135]
v_cvt_pk_bf16_f32 v173, v174, v175
v_mul_f32 v176, v176, v85
v_mfma_f32_16x16x32_bf16 v[132:135], a[112:115], a[0:3], v[132:135]
v_mul_f32 v177, v177, v85
v_cvt_pk_bf16_f32 v174, v176, v177
v_mfma_f32_16x16x32_bf16 v[132:135], a[116:119], a[4:7], v[132:135]
buffer_store_dwordx4 v[236:239], v254, s[4:7], s98 offen offset:0 sc1
v_mfma_f32_16x16x32_bf16 v[156:159], a[116:119], a[12:15], v[156:159]
v_mul_f32 v178, v178, v85
v_mul_f32 v179, v179, v85
v_mfma_f32_16x16x32_bf16 v[156:159], a[112:115], a[8:11], v[156:159]
v_cvt_pk_bf16_f32 v175, v178, v179
v_mul_f32 v150, v150, v83
v_mfma_f32_16x16x32_bf16 v[180:183], a[112:115], a[16:19], v[180:183]
v_mul_f32 v151, v151, v83
v_cvt_pk_bf16_f32 v149, v150, v151
v_mfma_f32_16x16x32_bf16 v[180:183], a[116:119], a[20:23], v[180:183]
v_mul_f32 v152, v152, v83
v_mul_f32 v153, v153, v83
v_mfma_f32_16x16x32_bf16 v[204:207], a[116:119], a[28:31], v[204:207]
v_cvt_pk_bf16_f32 v150, v152, v153
v_mul_f32 v154, v154, v83
v_mfma_f32_16x16x32_bf16 v[204:207], a[112:115], a[24:27], v[204:207]
s_waitcnt lgkmcnt(0)
s_barrier
v_mfma_f32_16x16x32_bf16 v[208:211], a[128:131], a[56:59], v[208:211]
ds_read_b128 v[92:95], v235 offset:0
v_mul_f32 v155, v155, v83
v_mfma_f32_16x16x32_bf16 v[208:211], a[132:135], a[60:63], v[208:211]
buffer_store_dwordx4 v[240:243], v254, s[4:7], s98 offen offset:2048 sc1
v_mfma_f32_16x16x32_bf16 v[184:187], a[132:135], a[52:55], v[184:187]
ds_read_b128 v[96:99], v235 offset:4096
v_cvt_pk_bf16_f32 v151, v154, v155
v_mfma_f32_16x16x32_bf16 v[184:187], a[128:131], a[48:51], v[184:187]
ds_write_b128 v233, v[212:215] offset:21504
v_cvt_pk_bf16_f32 v132, v132, v133
v_mfma_f32_16x16x32_bf16 v[160:163], a[128:131], a[40:43], v[160:163]
ds_read_b128 v[100:103], v235 offset:8192
v_cvt_pk_bf16_f32 v156, v156, v157
v_mfma_f32_16x16x32_bf16 v[160:163], a[132:135], a[44:47], v[160:163]
ds_write_b64 v232, v[220:221] offset:4096
v_cvt_pk_bf16_f32 v180, v180, v181
v_mfma_f32_16x16x32_bf16 v[136:139], a[132:135], a[36:39], v[136:139]
ds_read_b128 v[104:107], v235 offset:12288
v_cvt_pk_bf16_f32 v204, v204, v205
v_mfma_f32_16x16x32_bf16 v[136:139], a[128:131], a[32:35], v[136:139]
ds_write_b64 v232, v[222:223] offset:4608
v_cvt_pk_bf16_f32 v133, v134, v135
v_mfma_f32_16x16x32_bf16 v[136:139], a[136:139], a[64:67], v[136:139]
ds_write_b64 v232, v[196:197] offset:3072
v_cvt_pk_bf16_f32 v157, v158, v159
v_mfma_f32_16x16x32_bf16 v[136:139], a[140:143], a[68:71], v[136:139]
ds_write_b64 v232, v[198:199] offset:3584
v_cvt_pk_bf16_f32 v181, v182, v183
v_mfma_f32_16x16x32_bf16 v[160:163], a[140:143], a[76:79], v[160:163]
ds_write_b64 v232, v[172:173] offset:2048
s_waitcnt lgkmcnt(8)
v_add_f32 v92, v92, v96
v_mfma_f32_16x16x32_bf16 v[160:163], a[136:139], a[72:75], v[160:163]
ds_write_b64 v232, v[174:175] offset:2560
v_add_f32 v93, v93, v97
v_mfma_f32_16x16x32_bf16 v[184:187], a[136:139], a[80:83], v[184:187]
ds_write_b64 v232, v[148:149] offset:1024
v_add_f32 v94, v94, v98
v_mfma_f32_16x16x32_bf16 v[184:187], a[140:143], a[84:87], v[184:187]
buffer_store_dwordx4 v[244:247], v254, s[4:7], s99 offen offset:0 sc1
v_mfma_f32_16x16x32_bf16 v[208:211], a[140:143], a[92:95], v[208:211]
s_waitcnt lgkmcnt(6)
v_add_f32 v100, v100, v104
v_add_f32 v101, v101, v105
v_mfma_f32_16x16x32_bf16 v[208:211], a[136:139], a[88:91], v[208:211]
v_add_f32 v102, v102, v106
v_add_f32 v95, v95, v99
v_mfma_f32_16x16x32_bf16 v[208:211], a[144:147], a[24:27], v[208:211]
v_add_f32 v103, v103, v107
v_add_f32 v228, v92, v100
v_mfma_f32_16x16x32_bf16 v[208:211], a[148:151], a[28:31], v[208:211]
v_add_f32 v229, v93, v101
v_add_f32 v230, v94, v102
v_mfma_f32_16x16x32_bf16 v[184:187], a[148:151], a[20:23], v[184:187]
ds_write_b64 v232, v[150:151] offset:1536
v_add_f32 v231, v95, v103
v_mfma_f32_16x16x32_bf16 v[184:187], a[144:147], a[16:19], v[184:187]
v_fmac_f32 v228, v72, v90
v_fmac_f32 v229, v73, v90
v_mfma_f32_16x16x32_bf16 v[160:163], a[144:147], a[8:11], v[160:163]
v_fmac_f32 v230, v74, v90
v_fmac_f32 v231, v75, v90
v_mfma_f32_16x16x32_bf16 v[160:163], a[148:151], a[12:15], v[160:163]
v_cvt_pk_bf16_f32 v205, v206, v207
v_mul_f32 v228, v228, v91
v_mfma_f32_16x16x32_bf16 v[136:139], a[148:151], a[4:7], v[136:139]
v_mul_f32 v229, v229, v91
v_cvt_pk_bf16_f32 v228, v228, v229
v_mfma_f32_16x16x32_bf16 v[136:139], a[144:147], a[0:3], v[136:139]
v_mul_f32 v230, v230, v91
v_mul_f32 v231, v231, v91
s_add_u32 m0, s19, 32768
s_add_u32 s44, s84, 0xa00000
buffer_load_dwordx4 v1, s[4:7], s44 offen offset:0 sc1 lds
v_cvt_pk_bf16_f32 v229, v230, v231
v_pk_mul_f32 v[190:191], v[190:191], v[86:87] op_sel:[0,1] op_sel_hi:[1,1]
v_pk_mul_f32 v[166:167], v[166:167], v[84:85] op_sel:[0,1] op_sel_hi:[1,1]
v_pk_mul_f32 v[142:143], v[142:143], v[82:83] op_sel:[0,1] op_sel_hi:[1,1]
v_pk_mul_f32 v[192:193], v[192:193], v[86:87] op_sel:[0,1] op_sel_hi:[1,1]
v_pk_mul_f32 v[194:195], v[194:195], v[86:87] op_sel:[0,1] op_sel_hi:[1,1]
v_pk_mul_f32 v[168:169], v[168:169], v[84:85] op_sel:[0,1] op_sel_hi:[1,1]
v_pk_mul_f32 v[170:171], v[170:171], v[84:85] op_sel:[0,1] op_sel_hi:[1,1]
v_pk_mul_f32 v[144:145], v[144:145], v[82:83] op_sel:[0,1] op_sel_hi:[1,1]
v_pk_mul_f32 v[146:147], v[146:147], v[82:83] op_sel:[0,1] op_sel_hi:[1,1]
ds_write_b64 v9, v[228:229]
v_cvt_pk_bf16_f32 v189, v190, v191
v_cvt_pk_bf16_f32 v165, v166, v167
v_cvt_pk_bf16_f32 v141, v142, v143
v_cvt_pk_bf16_f32 v190, v192, v193
v_cvt_pk_bf16_f32 v191, v194, v195
v_cvt_pk_bf16_f32 v166, v168, v169
v_cvt_pk_bf16_f32 v167, v170, v171
v_cvt_pk_bf16_f32 v142, v144, v145
v_cvt_pk_bf16_f32 v143, v146, v147
v_cvt_pk_bf16_f32 v134, v136, v137
v_cvt_pk_bf16_f32 v135, v138, v139
v_cvt_pk_bf16_f32 v158, v160, v161
v_cvt_pk_bf16_f32 v159, v162, v163
v_cvt_pk_bf16_f32 v182, v184, v185
buffer_load_dwordx4 v1, s[4:7], s44 offen offset:1024 sc1 lds
v_cvt_pk_bf16_f32 v183, v186, v187
v_cvt_pk_bf16_f32 v206, v208, v209
v_cvt_pk_bf16_f32 v207, v210, v211
buffer_load_dwordx4 v1, s[4:7], s44 offen offset:2048 sc1 lds
buffer_load_dwordx4 v1, s[4:7], s44 offen offset:3072 sc1 lds
s_add_u32 m0, s19, 98304
s_add_u32 s44, s84, 0xa10000
buffer_load_dwordx4 v1, s[4:7], s44 offen offset:0 sc1 lds
buffer_load_dwordx4 v1, s[4:7], s44 offen offset:1024 sc1 lds
buffer_load_dwordx4 v1, s[4:7], s44 offen offset:2048 sc1 lds
buffer_load_dwordx4 v1, s[4:7], s44 offen offset:3072 sc1 lds
s_waitcnt lgkmcnt(0)
s_barrier
s_add_u32 m0, s19, 114688
s_add_u32 s44, s85, 0xa14000
buffer_load_dwordx4 v1, s[4:7], s44 offen offset:0 sc1 lds
v_mfma_f32_16x16x32_bf16 v[160:163], v[140:143], v[156:159], v[20:23]
ds_read_b128 a[0:3], v233 offset:20480
v_mfma_f32_16x16x32_bf16 v[176:179], v[164:167], v[156:159], v[24:27]
ds_read_b64_tr_b16 a[10:11], v248 offset:3072
v_mfma_f32_16x16x32_bf16 v[208:211], v[188:191], v[204:207], v[20:23]
ds_read_b64_tr_b16 a[12:13], v248 offset:4096
v_mfma_f32_16x16x32_bf16 v[224:227], v[212:215], v[204:207], v[24:27]
s_nop 3
v_max_f32 v176, v176, v160
v_max_f32 v177, v177, v161
v_max_f32 v178, v178, v162
v_max_f32 v179, v179, v163
v_max3_f32 v237, v176, v177, v178
v_max_f32 v237, v237, v179
ds_read_b64_tr_b16 a[22:23], v248 offset:3584
v_max_f32 v224, v224, v208
v_max_f32 v225, v225, v209
v_max_f32 v226, v226, v210
v_max_f32 v227, v227, v211
v_max3_f32 v239, v224, v225, v226
buffer_load_dwordx4 v1, s[4:7], s44 offen offset:1024 sc1 lds
v_max_f32 v239, v239, v227
ds_read_b64_tr_b16 a[24:25], v248 offset:4608
s_nop 0
v_permlane32_swap_b32 v239, v237
v_max_f32 v239, v239, v237
v_mov_b32 v242, v239
s_waitcnt lgkmcnt(4)
v_mfma_f32_16x16x32_bf16 v[136:139], a[0:3], v[132:135], v[76:79]
v_permlane16_swap_b32 v239, v242
v_max_f32 v239, v239, v242
v_mov_b32 v242, v239
v_mfma_f32_16x16x32_bf16 v[152:155], v[140:143], v[132:135], v[24:27]
s_nop 0
v_permlane32_swap_b32 v239, v242
v_mfma_f32_16x16x32_bf16 v[184:187], v[164:167], v[180:183], v[20:23]
v_mul_f32_e64 v89, -v239, v88
v_fma_f32 v224, v224, v88, v89
v_mfma_f32_16x16x32_bf16 v[200:203], v[188:191], v[180:183], v[24:27]
v_fma_f32 v225, v225, v88, v89
v_fma_f32 v226, v226, v88, v89
v_fma_f32 v227, v227, v88, v89
v_exp_f32 v224, v224
buffer_load_dwordx4 v1, s[4:7], s44 offen offset:2048 sc1 lds
v_exp_f32 v225, v225
v_exp_f32 v226, v226
v_exp_f32 v227, v227
v_max_f32 v152, v152, v136
v_max_f32 v153, v153, v137
v_max_f32 v154, v154, v138
v_max_f32 v200, v200, v184
v_max_f32 v201, v201, v185
v_max_f32 v202, v202, v186
v_cvt_pk_bf16_f32 v224, v224, v225
ds_read_b64_tr_b16 a[6:7], v248 offset:1024
ds_read_b64_tr_b16 a[8:9], v248 offset:2048
v_max_f32 v155, v155, v139
v_max3_f32 v236, v152, v153, v154
v_max_f32 v203, v203, v187
v_max3_f32 v238, v200, v201, v202
v_cvt_pk_bf16_f32 v225, v226, v227
ds_read_b64_tr_b16 a[18:19], v248 offset:1536
ds_read_b64_tr_b16 a[20:21], v248 offset:2560
v_max_f32 v236, v236, v155
buffer_load_dwordx4 v1, s[4:7], s44 offen offset:3072 sc1 lds
s_add_u32 m0, s19, 131072
s_add_u32 s44, s86, 0xa18000
v_max_f32 v238, v238, v203
v_and_b32 v208, v224, v28
v_and_b32 v209, v225, v29
v_and_b32 v210, v224, v30
v_and_b32 v211, v225, v31
v_permlane32_swap_b32 v238, v236
s_nop 0
v_mfma_f32_16x16x32_bf16 v[216:219], v[16:19], v[208:211], 0
v_max_f32 v238, v238, v236
v_mul_f32_e64 v85, -v242, v84
s_waitcnt lgkmcnt(6)
v_mfma_f32_16x16x32_bf16 v[116:119], a[10:13], v[208:211], 0
v_mov_b32 v243, v238
v_fma_f32 v176, v176, v84, v85
v_fma_f32 v177, v177, v84, v85
v_fma_f32 v178, v178, v84, v85
v_fma_f32 v179, v179, v84, v85
s_waitcnt lgkmcnt(4)
v_mfma_f32_16x16x32_bf16 v[120:123], a[22:25], v[208:211], 0
v_exp_f32 v176, v176
v_exp_f32 v177, v177
v_exp_f32 v178, v178
buffer_load_dwordx4 v1, s[4:7], s44 offen offset:0 sc1 lds
v_exp_f32 v179, v179
v_permlane16_swap_b32 v238, v243
v_rcp_f32 v216, v216
v_cvt_pk_bf16_f32 v176, v176, v177
v_max_f32 v238, v238, v243
v_cvt_pk_bf16_f32 v177, v178, v179
v_mov_b32 v243, v238
v_and_b32 v160, v176, v28
v_and_b32 v161, v177, v29
v_and_b32 v162, v176, v30
v_and_b32 v163, v177, v31
v_pk_mul_f32 v[116:117], v[116:117], v[216:217] op_sel:[0,0] op_sel_hi:[1,0]
v_pk_mul_f32 v[118:119], v[118:119], v[216:217] op_sel:[0,0] op_sel_hi:[1,0]
v_cvt_pk_bf16_f32 v116, v116, v117
v_pk_mul_f32 v[120:121], v[120:121], v[216:217] op_sel:[0,0] op_sel_hi:[1,0]
v_permlane32_swap_b32 v238, v243
v_pk_mul_f32 v[122:123], v[122:123], v[216:217] op_sel:[0,0] op_sel_hi:[1,0]
v_cvt_pk_bf16_f32 v117, v118, v119
v_mfma_f32_16x16x32_bf16 v[168:171], v[16:19], v[160:163], 0
v_cvt_pk_bf16_f32 v118, v120, v121
v_cvt_pk_bf16_f32 v119, v122, v123
v_mul_f32_e64 v87, -v238, v86
buffer_load_dwordx4 v1, s[4:7], s44 offen offset:1024 sc1 lds
s_waitcnt lgkmcnt(2)
v_mfma_f32_16x16x32_bf16 v[100:103], a[6:9], v[160:163], 0
v_fma_f32 v200, v200, v86, v87
v_fma_f32 v201, v201, v86, v87
v_fma_f32 v202, v202, v86, v87
v_fma_f32 v203, v203, v86, v87
s_waitcnt lgkmcnt(0)
v_mfma_f32_16x16x32_bf16 v[104:107], a[18:21], v[160:163], 0
v_exp_f32 v200, v200
v_exp_f32 v201, v201
v_exp_f32 v202, v202
v_exp_f32 v203, v203
v_rcp_f32 v168, v168
v_cvt_pk_bf16_f32 v200, v200, v201
ds_read_b64_tr_b16 a[4:5], v248 offset:0
v_cvt_pk_bf16_f32 v201, v202, v203
ds_read_b64_tr_b16 a[16:17], v248 offset:512
v_and_b32 v184, v200, v28
v_and_b32 v185, v201, v29
v_and_b32 v186, v200, v30
buffer_load_dwordx4 v1, s[4:7], s44 offen offset:2048 sc1 lds
v_and_b32 v187, v201, v31
v_pk_mul_f32 v[100:101], v[100:101], v[168:169] op_sel:[0,0] op_sel_hi:[1,0]
v_pk_mul_f32 v[102:103], v[102:103], v[168:169] op_sel:[0,0] op_sel_hi:[1,0]
v_cvt_pk_bf16_f32 v100, v100, v101
v_pk_mul_f32 v[104:105], v[104:105], v[168:169] op_sel:[0,0] op_sel_hi:[1,0]
v_cvt_pk_bf16_f32 v101, v102, v103
v_pk_mul_f32 v[106:107], v[106:107], v[168:169] op_sel:[0,0] op_sel_hi:[1,0]
v_cvt_pk_bf16_f32 v102, v104, v105
v_mfma_f32_16x16x32_bf16 v[192:195], v[16:19], v[184:187], 0
v_cvt_pk_bf16_f32 v103, v106, v107
v_mul_f32_e64 v83, -v243, v82
v_mfma_f32_16x16x32_bf16 v[108:111], a[8:11], v[184:187], 0
v_fma_f32 v152, v152, v82, v83
v_fma_f32 v153, v153, v82, v83
v_fma_f32 v154, v154, v82, v83
v_fma_f32 v155, v155, v82, v83
v_mfma_f32_16x16x32_bf16 v[112:115], a[20:23], v[184:187], 0
v_exp_f32 v152, v152
v_exp_f32 v153, v153
v_exp_f32 v154, v154
v_exp_f32 v155, v155
buffer_load_dwordx4 v1, s[4:7], s44 offen offset:3072 sc1 lds
v_rcp_f32 v192, v192
v_cvt_pk_bf16_f32 v152, v152, v153
v_cvt_pk_bf16_f32 v153, v154, v155
v_and_b32 v136, v152, v80
v_and_b32 v137, v153, v81
v_and_b32 v138, v152, v30
v_and_b32 v139, v153, v31
v_pk_mul_f32 v[108:109], v[108:109], v[192:193] op_sel:[0,0] op_sel_hi:[1,0]
v_pk_mul_f32 v[110:111], v[110:111], v[192:193] op_sel:[0,0] op_sel_hi:[1,0]
v_cvt_pk_bf16_f32 v108, v108, v109
v_pk_mul_f32 v[112:113], v[112:113], v[192:193] op_sel:[0,0] op_sel_hi:[1,0]
v_cvt_pk_bf16_f32 v109, v110, v111
v_pk_mul_f32 v[114:115], v[114:115], v[192:193] op_sel:[0,0] op_sel_hi:[1,0]
v_cvt_pk_bf16_f32 v110, v112, v113
v_mfma_f32_16x16x32_bf16 v[144:147], v[16:19], v[136:139], 0
v_cvt_pk_bf16_f32 v111, v114, v115
s_waitcnt lgkmcnt(1)
v_mfma_f32_16x16x32_bf16 v[92:95], a[4:7], v[136:139], 0
s_waitcnt lgkmcnt(0)
v_mfma_f32_16x16x32_bf16 v[96:99], a[16:19], v[136:139], 0
s_nop 2
v_rcp_f32 v144, v144
buffer_store_dwordx4 v[116:119], v2, s[4:7], s72 offen offset:3072 sc1
s_nop 0
v_pk_mul_f32 v[92:93], v[92:93], v[144:145] op_sel:[0,0] op_sel_hi:[1,0]
v_pk_mul_f32 v[94:95], v[94:95], v[144:145] op_sel:[0,0] op_sel_hi:[1,0]
v_cvt_pk_bf16_f32 v92, v92, v93
v_pk_mul_f32 v[96:97], v[96:97], v[144:145] op_sel:[0,0] op_sel_hi:[1,0]
v_pk_mul_f32 v[98:99], v[98:99], v[144:145] op_sel:[0,0] op_sel_hi:[1,0]
v_cvt_pk_bf16_f32 v93, v94, v95
v_cvt_pk_bf16_f32 v94, v96, v97
v_cvt_pk_bf16_f32 v95, v98, v99
buffer_store_dwordx4 v[100:103], v2, s[4:7], s72 offen offset:1024 sc1
buffer_store_dwordx4 v[108:111], v2, s[4:7], s72 offen offset:2048 sc1
buffer_store_dwordx4 v[92:95], v2, s[4:7], s72 offen offset:0 sc1
s_add_u32 s92, s71, 0x0
v_accvgpr_write_b32 a188, v48
v_accvgpr_write_b32 a189, v49
v_accvgpr_write_b32 a190, v50
v_accvgpr_write_b32 a191, v51
v_accvgpr_write_b32 a192, v52
v_accvgpr_write_b32 a193, v53
v_accvgpr_write_b32 a194, v54
v_accvgpr_write_b32 a195, v55
v_accvgpr_write_b32 a196, v56
v_accvgpr_write_b32 a197, v57
v_accvgpr_write_b32 a198, v58
v_accvgpr_write_b32 a199, v59
v_accvgpr_write_b32 a200, v60
v_accvgpr_write_b32 a201, v61
v_accvgpr_write_b32 a202, v62
v_accvgpr_write_b32 a203, v63
v_accvgpr_write_b32 a204, v64
v_accvgpr_write_b32 a205, v65
v_accvgpr_write_b32 a206, v66
v_accvgpr_write_b32 a207, v67
v_accvgpr_write_b32 a208, v68
v_accvgpr_write_b32 a209, v69
v_accvgpr_write_b32 a210, v70
v_accvgpr_write_b32 a211, v71
v_accvgpr_write_b32 a212, v72
v_accvgpr_write_b32 a213, v73
v_accvgpr_write_b32 a214, v74
v_accvgpr_write_b32 a215, v75
s_add_u32 s40, s4, 0x1e00000
s_addc_u32 s41, s5, 0
v_add_u32 v5, 32768, v1
v_add_u32 v6, 98304, v1
s_cmp_eq_u32 s3, 0
s_cselect_b32 s35, 8, 0
s_lshl_b32 s35, s35, 12
v_lshlrev_b32 v132, 16, v32
v_and_b32 v133, 0xffff0000, v32
v_lshlrev_b32 v134, 16, v33
v_and_b32 v135, 0xffff0000, v33
v_lshlrev_b32 v136, 16, v34
v_and_b32 v137, 0xffff0000, v34
v_lshlrev_b32 v138, 16, v35
v_and_b32 v139, 0xffff0000, v35
v_lshlrev_b32 v140, 16, v36
v_and_b32 v141, 0xffff0000, v36
v_lshlrev_b32 v142, 16, v37
v_and_b32 v143, 0xffff0000, v37
v_lshlrev_b32 v144, 16, v38
v_and_b32 v145, 0xffff0000, v38
v_lshlrev_b32 v146, 16, v39
v_and_b32 v147, 0xffff0000, v39
v_lshlrev_b32 v148, 16, v40
v_and_b32 v149, 0xffff0000, v40
v_lshlrev_b32 v150, 16, v41
v_and_b32 v151, 0xffff0000, v41
v_lshlrev_b32 v152, 16, v42
v_and_b32 v153, 0xffff0000, v42
v_lshlrev_b32 v154, 16, v43
v_and_b32 v155, 0xffff0000, v43
v_lshlrev_b32 v156, 16, v44
v_and_b32 v157, 0xffff0000, v44
v_lshlrev_b32 v158, 16, v45
v_and_b32 v159, 0xffff0000, v45
v_lshlrev_b32 v160, 16, v46
v_and_b32 v161, 0xffff0000, v46
v_lshlrev_b32 v162, 16, v47
v_and_b32 v163, 0xffff0000, v47
s_waitcnt vmcnt(0)
s_barrier
s_cmp_lg_u32 s28, 1
s_cbranch_scc1 Lsg_4
buffer_atomic_add v12, v10, s[4:7], s92 offen sc1
buffer_atomic_swap v15, v14, s[4:7], s8 offen sc1
buffer_atomic_swap v15, v252, s[4:7], s62 offen offset:64 sc1
Lsg_4:
s_mov_b64 exec, 0
s_cmp_eq_u32 s28, 1
s_cbranch_scc1 L_stub3
L_wret1:
s_mov_b64 exec, -1
s_add_u32 m0, s19, 147456
s_add_u32 s44, s87, 0xa1c000
buffer_load_dwordx4 v1, s[4:7], s44 offen offset:0 sc1 lds
buffer_load_dwordx4 v1, s[4:7], s44 offen offset:1024 sc1 lds
buffer_load_dwordx4 v1, s[4:7], s44 offen offset:2048 sc1 lds
buffer_load_dwordx4 v1, s[4:7], s44 offen offset:3072 sc1 lds
s_cmp_lg_u32 s28, 0
s_cbranch_scc1 Lpo_7
s_add_u32 s36, s66, 0x0
s_mov_b32 s37, 0
v_mov_b32 v11, 0
buffer_atomic_add v11, v251, s[4:7], s36 offen sc0 sc1
s_sleep 4
Lpoll_5:
v_mov_b32 v234, 0
buffer_atomic_add v234, v251, s[4:7], s36 offen sc0 sc1
s_waitcnt vmcnt(1)
v_readfirstlane_b32 s38, v11
s_nop 0
s_cmp_ge_u32 s38, 32
s_cbranch_scc1 Lpe_6
v_mov_b32 v11, 0
buffer_atomic_add v11, v251, s[4:7], s36 offen sc0 sc1
s_waitcnt vmcnt(1)
v_readfirstlane_b32 s38, v234
s_nop 0
s_cmp_ge_u32 s38, 32
s_cbranch_scc1 Lpe_6
s_add_u32 s37, s37, 1
s_cmp_lt_u32 s37, 0x80000
s_cbranch_scc1 Lpoll_5
s_waitcnt vmcnt(0)
Lpo_7:
s_waitcnt vmcnt(0)
Lpe_6:
s_barrier
L_k2go0:
buffer_load_dwordx4 a[0:3], v4, s[40:43], s35 offen offset:0 sc1
buffer_load_dwordx4 a[4:7], v4, s[40:43], s35 offen offset:1024 sc1
s_cmp_eq_u32 s3, 1
s_cselect_b32 s35, 9, 1
s_lshl_b32 s35, s35, 12
buffer_load_dwordx4 a[8:11], v4, s[40:43], s35 offen offset:0 sc1
buffer_load_dwordx4 a[12:15], v4, s[40:43], s35 offen offset:1024 sc1
s_cmp_eq_u32 s3, 2
s_cselect_b32 s35, 10, 2
s_lshl_b32 s35, s35, 12
buffer_load_dwordx4 a[16:19], v4, s[40:43], s35 offen offset:0 sc1
buffer_load_dwordx4 a[20:23], v4, s[40:43], s35 offen offset:1024 sc1
s_cmp_eq_u32 s3, 3
s_cselect_b32 s35, 11, 3
s_lshl_b32 s35, s35, 12
buffer_load_dwordx4 a[24:27], v4, s[40:43], s35 offen offset:0 sc1
buffer_load_dwordx4 a[28:31], v4, s[40:43], s35 offen offset:1024 sc1
s_cmp_eq_u32 s3, 4
s_cselect_b32 s35, 12, 4
s_lshl_b32 s35, s35, 12
buffer_load_dwordx4 a[32:35], v4, s[40:43], s35 offen offset:0 sc1
buffer_load_dwordx4 a[36:39], v4, s[40:43], s35 offen offset:1024 sc1
s_cmp_eq_u32 s3, 5
s_cselect_b32 s35, 13, 5
s_lshl_b32 s35, s35, 12
buffer_load_dwordx4 a[40:43], v4, s[40:43], s35 offen offset:0 sc1
buffer_load_dwordx4 a[44:47], v4, s[40:43], s35 offen offset:1024 sc1
s_cmp_eq_u32 s3, 6
s_cselect_b32 s35, 14, 6
s_lshl_b32 s35, s35, 12
ds_read_b128 a[96:99], v5 offset:0
ds_read_b128 a[100:103], v5 offset:1024
ds_read_b128 a[104:107], v5 offset:2048
ds_read_b128 a[108:111], v5 offset:3072
ds_read_b128 a[112:115], v5 offset:4096
ds_read_b128 a[116:119], v5 offset:5120
ds_read_b128 a[120:123], v5 offset:6144
ds_read_b128 a[124:127], v5 offset:7168
s_waitcnt vmcnt(10) lgkmcnt(4)
v_mfma_f32_16x16x32_bf16 v[132:135], a[96:99], a[0:3], v[132:135]
ds_read_b128 a[128:131], v5 offset:8192
v_mfma_f32_16x16x32_bf16 v[148:151], a[96:99], a[4:7], v[148:151]
ds_read_b128 a[132:135], v5 offset:9216
v_mfma_f32_16x16x32_bf16 v[152:155], a[100:103], a[4:7], v[152:155]
buffer_load_dwordx4 a[48:51], v4, s[40:43], s35 offen offset:0 sc1
v_mfma_f32_16x16x32_bf16 v[136:139], a[100:103], a[0:3], v[136:139]
ds_read_b128 a[136:139], v5 offset:10240
v_mfma_f32_16x16x32_bf16 v[140:143], a[104:107], a[0:3], v[140:143]
ds_read_b128 a[140:143], v5 offset:11264
v_mfma_f32_16x16x32_bf16 v[156:159], a[104:107], a[4:7], v[156:159]
v_mfma_f32_16x16x32_bf16 v[160:163], a[108:111], a[4:7], v[160:163]
buffer_load_dwordx4 a[52:55], v4, s[40:43], s35 offen offset:1024 sc1
v_mfma_f32_16x16x32_bf16 v[144:147], a[108:111], a[0:3], v[144:147]
s_waitcnt vmcnt(10) lgkmcnt(4)
v_mfma_f32_16x16x32_bf16 v[132:135], a[112:115], a[8:11], v[132:135]
s_cmp_eq_u32 s3, 7
s_cselect_b32 s35, 15, 7
s_lshl_b32 s35, s35, 12
v_mfma_f32_16x16x32_bf16 v[148:151], a[112:115], a[12:15], v[148:151]
ds_read_b128 a[96:99], v5 offset:12288
v_mfma_f32_16x16x32_bf16 v[152:155], a[116:119], a[12:15], v[152:155]
buffer_load_dwordx4 a[0:3], v4, s[40:43], s35 offen offset:0 sc1
v_mfma_f32_16x16x32_bf16 v[136:139], a[116:119], a[8:11], v[136:139]
ds_read_b128 a[100:103], v5 offset:13312
v_mfma_f32_16x16x32_bf16 v[140:143], a[120:123], a[8:11], v[140:143]
L_stub3:
s_cbranch_execz L_stub4
ds_read_b128 a[104:107], v5 offset:14336
v_mfma_f32_16x16x32_bf16 v[156:159], a[120:123], a[12:15], v[156:159]
ds_read_b128 a[108:111], v5 offset:15360
v_mfma_f32_16x16x32_bf16 v[160:163], a[124:127], a[12:15], v[160:163]
buffer_load_dwordx4 a[4:7], v4, s[40:43], s35 offen offset:1024 sc1
v_mfma_f32_16x16x32_bf16 v[144:147], a[124:127], a[8:11], v[144:147]
s_waitcnt vmcnt(10) lgkmcnt(4)
v_mfma_f32_16x16x32_bf16 v[132:135], a[128:131], a[16:19], v[132:135]
s_cmp_eq_u32 s3, 0
s_cselect_b32 s35, 16, 8
s_lshl_b32 s35, s35, 12
v_mfma_f32_16x16x32_bf16 v[148:151], a[128:131], a[20:23], v[148:151]
ds_read_b128 a[112:115], v5 offset:16384
v_mfma_f32_16x16x32_bf16 v[152:155], a[132:135], a[20:23], v[152:155]
buffer_load_dwordx4 a[8:11], v4, s[40:43], s35 offen offset:0 sc1
v_mfma_f32_16x16x32_bf16 v[136:139], a[132:135], a[16:19], v[136:139]
ds_read_b128 a[116:119], v5 offset:17408
v_mfma_f32_16x16x32_bf16 v[140:143], a[136:139], a[16:19], v[140:143]
ds_read_b128 a[120:123], v5 offset:18432
v_mfma_f32_16x16x32_bf16 v[156:159], a[136:139], a[20:23], v[156:159]
ds_read_b128 a[124:127], v5 offset:19456
v_mfma_f32_16x16x32_bf16 v[160:163], a[140:143], a[20:23], v[160:163]
buffer_load_dwordx4 a[12:15], v4, s[40:43], s35 offen offset:1024 sc1
v_mfma_f32_16x16x32_bf16 v[144:147], a[140:143], a[16:19], v[144:147]
s_waitcnt vmcnt(10) lgkmcnt(4)
v_mfma_f32_16x16x32_bf16 v[132:135], a[96:99], a[24:27], v[132:135]
s_cmp_eq_u32 s3, 1
s_cselect_b32 s35, 17, 9
s_lshl_b32 s35, s35, 12
v_mfma_f32_16x16x32_bf16 v[148:151], a[96:99], a[28:31], v[148:151]
ds_read_b128 a[128:131], v5 offset:20480
v_mfma_f32_16x16x32_bf16 v[152:155], a[100:103], a[28:31], v[152:155]
buffer_load_dwordx4 a[16:19], v4, s[40:43], s35 offen offset:0 sc1
v_mfma_f32_16x16x32_bf16 v[136:139], a[100:103], a[24:27], v[136:139]
ds_read_b128 a[132:135], v5 offset:21504
v_mfma_f32_16x16x32_bf16 v[140:143], a[104:107], a[24:27], v[140:143]
ds_read_b128 a[136:139], v5 offset:22528
v_mfma_f32_16x16x32_bf16 v[156:159], a[104:107], a[28:31], v[156:159]
ds_read_b128 a[140:143], v5 offset:23552
v_mfma_f32_16x16x32_bf16 v[160:163], a[108:111], a[28:31], v[160:163]
buffer_load_dwordx4 a[20:23], v4, s[40:43], s35 offen offset:1024 sc1
v_mfma_f32_16x16x32_bf16 v[144:147], a[108:111], a[24:27], v[144:147]
s_waitcnt vmcnt(10) lgkmcnt(4)
v_mfma_f32_16x16x32_bf16 v[132:135], a[112:115], a[32:35], v[132:135]
s_cmp_eq_u32 s3, 2
s_cselect_b32 s35, 18, 10
s_lshl_b32 s35, s35, 12
v_mfma_f32_16x16x32_bf16 v[148:151], a[112:115], a[36:39], v[148:151]
ds_read_b128 a[96:99], v5 offset:24576
v_mfma_f32_16x16x32_bf16 v[152:155], a[116:119], a[36:39], v[152:155]
buffer_load_dwordx4 a[24:27], v4, s[40:43], s35 offen offset:0 sc1
v_mfma_f32_16x16x32_bf16 v[136:139], a[116:119], a[32:35], v[136:139]
ds_read_b128 a[100:103], v5 offset:25600
v_mfma_f32_16x16x32_bf16 v[140:143], a[120:123], a[32:35], v[140:143]
ds_read_b128 a[104:107], v5 offset:26624
v_mfma_f32_16x16x32_bf16 v[156:159], a[120:123], a[36:39], v[156:159]
ds_read_b128 a[108:111], v5 offset:27648
v_mfma_f32_16x16x32_bf16 v[160:163], a[124:127], a[36:39], v[160:163]
buffer_load_dwordx4 a[28:31], v4, s[40:43], s35 offen offset:1024 sc1
v_mfma_f32_16x16x32_bf16 v[144:147], a[124:127], a[32:35], v[144:147]
s_waitcnt vmcnt(10) lgkmcnt(4)
v_mfma_f32_16x16x32_bf16 v[132:135], a[128:131], a[40:43], v[132:135]
s_cmp_eq_u32 s3, 3
s_cselect_b32 s35, 19, 11
s_lshl_b32 s35, s35, 12
v_mfma_f32_16x16x32_bf16 v[148:151], a[128:131], a[44:47], v[148:151]
ds_read_b128 a[112:115], v5 offset:28672
v_mfma_f32_16x16x32_bf16 v[152:155], a[132:135], a[44:47], v[152:155]
buffer_load_dwordx4 a[32:35], v4, s[40:43], s35 offen offset:0 sc1
v_mfma_f32_16x16x32_bf16 v[136:139], a[132:135], a[40:43], v[136:139]
ds_read_b128 a[116:119], v5 offset:29696
v_mfma_f32_16x16x32_bf16 v[140:143], a[136:139], a[40:43], v[140:143]
ds_read_b128 a[120:123], v5 offset:30720
v_mfma_f32_16x16x32_bf16 v[156:159], a[136:139], a[44:47], v[156:159]
ds_read_b128 a[124:127], v5 offset:31744
v_mfma_f32_16x16x32_bf16 v[160:163], a[140:143], a[44:47], v[160:163]
buffer_load_dwordx4 a[36:39], v4, s[40:43], s35 offen offset:1024 sc1
v_mfma_f32_16x16x32_bf16 v[144:147], a[140:143], a[40:43], v[144:147]
s_waitcnt vmcnt(10) lgkmcnt(4)
v_mfma_f32_16x16x32_bf16 v[132:135], a[96:99], a[48:51], v[132:135]
s_cmp_eq_u32 s3, 4
s_cselect_b32 s35, 20, 12
s_lshl_b32 s35, s35, 12
v_mfma_f32_16x16x32_bf16 v[148:151], a[96:99], a[52:55], v[148:151]
ds_read_b128 a[128:131], v5 offset:32768
v_mfma_f32_16x16x32_bf16 v[152:155], a[100:103], a[52:55], v[152:155]
buffer_load_dwordx4 a[40:43], v4, s[40:43], s35 offen offset:0 sc1
v_mfma_f32_16x16x32_bf16 v[136:139], a[100:103], a[48:51], v[136:139]
ds_read_b128 a[132:135], v5 offset:33792
v_mfma_f32_16x16x32_bf16 v[140:143], a[104:107], a[48:51], v[140:143]
ds_read_b128 a[136:139], v5 offset:34816
v_mfma_f32_16x16x32_bf16 v[156:159], a[104:107], a[52:55], v[156:159]
ds_read_b128 a[140:143], v5 offset:35840
v_mfma_f32_16x16x32_bf16 v[160:163], a[108:111], a[52:55], v[160:163]
buffer_load_dwordx4 a[44:47], v4, s[40:43], s35 offen offset:1024 sc1
v_mfma_f32_16x16x32_bf16 v[144:147], a[108:111], a[48:51], v[144:147]
s_waitcnt vmcnt(10) lgkmcnt(4)
v_mfma_f32_16x16x32_bf16 v[132:135], a[112:115], a[0:3], v[132:135]
s_cmp_eq_u32 s3, 5
s_cselect_b32 s35, 21, 13
s_lshl_b32 s35, s35, 12
v_mfma_f32_16x16x32_bf16 v[148:151], a[112:115], a[4:7], v[148:151]
ds_read_b128 a[96:99], v5 offset:36864
v_mfma_f32_16x16x32_bf16 v[152:155], a[116:119], a[4:7], v[152:155]
buffer_load_dwordx4 a[48:51], v4, s[40:43], s35 offen offset:0 sc1
v_mfma_f32_16x16x32_bf16 v[136:139], a[116:119], a[0:3], v[136:139]
ds_read_b128 a[100:103], v5 offset:37888
v_mfma_f32_16x16x32_bf16 v[140:143], a[120:123], a[0:3], v[140:143]
ds_read_b128 a[104:107], v5 offset:38912
v_mfma_f32_16x16x32_bf16 v[156:159], a[120:123], a[4:7], v[156:159]
ds_read_b128 a[108:111], v5 offset:39936
v_mfma_f32_16x16x32_bf16 v[160:163], a[124:127], a[4:7], v[160:163]
buffer_load_dwordx4 a[52:55], v4, s[40:43], s35 offen offset:1024 sc1
v_mfma_f32_16x16x32_bf16 v[144:147], a[124:127], a[0:3], v[144:147]
s_waitcnt vmcnt(10) lgkmcnt(4)
v_mfma_f32_16x16x32_bf16 v[132:135], a[128:131], a[8:11], v[132:135]
s_cmp_eq_u32 s3, 6
s_cselect_b32 s35, 22, 14
s_lshl_b32 s35, s35, 12
v_mfma_f32_16x16x32_bf16 v[148:151], a[128:131], a[12:15], v[148:151]
ds_read_b128 a[112:115], v5 offset:40960
v_mfma_f32_16x16x32_bf16 v[152:155], a[132:135], a[12:15], v[152:155]
buffer_load_dwordx4 a[0:3], v4, s[40:43], s35 offen offset:0 sc1
v_mfma_f32_16x16x32_bf16 v[136:139], a[132:135], a[8:11], v[136:139]
ds_read_b128 a[116:119], v5 offset:41984
v_mfma_f32_16x16x32_bf16 v[140:143], a[136:139], a[8:11], v[140:143]
ds_read_b128 a[120:123], v5 offset:43008
v_mfma_f32_16x16x32_bf16 v[156:159], a[136:139], a[12:15], v[156:159]
ds_read_b128 a[124:127], v5 offset:44032
v_mfma_f32_16x16x32_bf16 v[160:163], a[140:143], a[12:15], v[160:163]
buffer_load_dwordx4 a[4:7], v4, s[40:43], s35 offen offset:1024 sc1
v_mfma_f32_16x16x32_bf16 v[144:147], a[140:143], a[8:11], v[144:147]
s_waitcnt vmcnt(10) lgkmcnt(4)
v_mfma_f32_16x16x32_bf16 v[132:135], a[96:99], a[16:19], v[132:135]
s_cmp_eq_u32 s3, 7
s_cselect_b32 s35, 23, 15
s_lshl_b32 s35, s35, 12
v_mfma_f32_16x16x32_bf16 v[148:151], a[96:99], a[20:23], v[148:151]
ds_read_b128 a[128:131], v5 offset:45056
v_mfma_f32_16x16x32_bf16 v[152:155], a[100:103], a[20:23], v[152:155]
buffer_load_dwordx4 a[8:11], v4, s[40:43], s35 offen offset:0 sc1
v_mfma_f32_16x16x32_bf16 v[136:139], a[100:103], a[16:19], v[136:139]
ds_read_b128 a[132:135], v5 offset:46080
v_mfma_f32_16x16x32_bf16 v[140:143], a[104:107], a[16:19], v[140:143]
ds_read_b128 a[136:139], v5 offset:47104
v_mfma_f32_16x16x32_bf16 v[156:159], a[104:107], a[20:23], v[156:159]
ds_read_b128 a[140:143], v5 offset:48128
v_mfma_f32_16x16x32_bf16 v[160:163], a[108:111], a[20:23], v[160:163]
buffer_load_dwordx4 a[12:15], v4, s[40:43], s35 offen offset:1024 sc1
v_mfma_f32_16x16x32_bf16 v[144:147], a[108:111], a[16:19], v[144:147]
s_waitcnt vmcnt(10) lgkmcnt(4)
v_mfma_f32_16x16x32_bf16 v[132:135], a[112:115], a[24:27], v[132:135]
s_cmp_eq_u32 s3, 0
s_cselect_b32 s35, 24, 16
s_lshl_b32 s35, s35, 12
v_mfma_f32_16x16x32_bf16 v[148:151], a[112:115], a[28:31], v[148:151]
ds_read_b128 a[96:99], v5 offset:49152
v_mfma_f32_16x16x32_bf16 v[152:155], a[116:119], a[28:31], v[152:155]
buffer_load_dwordx4 a[16:19], v4, s[40:43], s35 offen offset:0 sc1
v_mfma_f32_16x16x32_bf16 v[136:139], a[116:119], a[24:27], v[136:139]
ds_read_b128 a[100:103], v5 offset:50176
v_mfma_f32_16x16x32_bf16 v[140:143], a[120:123], a[24:27], v[140:143]
ds_read_b128 a[104:107], v5 offset:51200
v_mfma_f32_16x16x32_bf16 v[156:159], a[120:123], a[28:31], v[156:159]
ds_read_b128 a[108:111], v5 offset:52224
v_mfma_f32_16x16x32_bf16 v[160:163], a[124:127], a[28:31], v[160:163]
buffer_load_dwordx4 a[20:23], v4, s[40:43], s35 offen offset:1024 sc1
v_mfma_f32_16x16x32_bf16 v[144:147], a[124:127], a[24:27], v[144:147]
s_waitcnt vmcnt(10) lgkmcnt(4)
v_mfma_f32_16x16x32_bf16 v[132:135], a[128:131], a[32:35], v[132:135]
s_cmp_eq_u32 s3, 1
s_cselect_b32 s35, 25, 17
s_lshl_b32 s35, s35, 12
v_mfma_f32_16x16x32_bf16 v[148:151], a[128:131], a[36:39], v[148:151]
ds_read_b128 a[112:115], v5 offset:53248
v_mfma_f32_16x16x32_bf16 v[152:155], a[132:135], a[36:39], v[152:155]
buffer_load_dwordx4 a[24:27], v4, s[40:43], s35 offen offset:0 sc1
v_mfma_f32_16x16x32_bf16 v[136:139], a[132:135], a[32:35], v[136:139]
ds_read_b128 a[116:119], v5 offset:54272
v_mfma_f32_16x16x32_bf16 v[140:143], a[136:139], a[32:35], v[140:143]
ds_read_b128 a[120:123], v5 offset:55296
v_mfma_f32_16x16x32_bf16 v[156:159], a[136:139], a[36:39], v[156:159]
ds_read_b128 a[124:127], v5 offset:56320
v_mfma_f32_16x16x32_bf16 v[160:163], a[140:143], a[36:39], v[160:163]
buffer_load_dwordx4 a[28:31], v4, s[40:43], s35 offen offset:1024 sc1
v_mfma_f32_16x16x32_bf16 v[144:147], a[140:143], a[32:35], v[144:147]
s_waitcnt vmcnt(10) lgkmcnt(4)
v_mfma_f32_16x16x32_bf16 v[132:135], a[96:99], a[40:43], v[132:135]
s_cmp_eq_u32 s3, 2
s_cselect_b32 s35, 26, 18
s_lshl_b32 s35, s35, 12
v_mfma_f32_16x16x32_bf16 v[148:151], a[96:99], a[44:47], v[148:151]
ds_read_b128 a[128:131], v5 offset:57344
v_mfma_f32_16x16x32_bf16 v[152:155], a[100:103], a[44:47], v[152:155]
buffer_load_dwordx4 a[32:35], v4, s[40:43], s35 offen offset:0 sc1
v_mfma_f32_16x16x32_bf16 v[136:139], a[100:103], a[40:43], v[136:139]
ds_read_b128 a[132:135], v5 offset:58368
v_mfma_f32_16x16x32_bf16 v[140:143], a[104:107], a[40:43], v[140:143]
ds_read_b128 a[136:139], v5 offset:59392
v_mfma_f32_16x16x32_bf16 v[156:159], a[104:107], a[44:47], v[156:159]
ds_read_b128 a[140:143], v5 offset:60416
v_mfma_f32_16x16x32_bf16 v[160:163], a[108:111], a[44:47], v[160:163]
buffer_load_dwordx4 a[36:39], v4, s[40:43], s35 offen offset:1024 sc1
v_mfma_f32_16x16x32_bf16 v[144:147], a[108:111], a[40:43], v[144:147]
s_waitcnt vmcnt(10) lgkmcnt(4)
v_mfma_f32_16x16x32_bf16 v[132:135], a[112:115], a[48:51], v[132:135]
s_cmp_eq_u32 s3, 3
s_cselect_b32 s35, 27, 19
s_lshl_b32 s35, s35, 12
v_mfma_f32_16x16x32_bf16 v[148:151], a[112:115], a[52:55], v[148:151]
ds_read_b128 a[96:99], v5 offset:61440
v_mfma_f32_16x16x32_bf16 v[152:155], a[116:119], a[52:55], v[152:155]
buffer_load_dwordx4 a[40:43], v4, s[40:43], s35 offen offset:0 sc1
v_mfma_f32_16x16x32_bf16 v[136:139], a[116:119], a[48:51], v[136:139]
ds_read_b128 a[100:103], v5 offset:62464
v_mfma_f32_16x16x32_bf16 v[140:143], a[120:123], a[48:51], v[140:143]
ds_read_b128 a[104:107], v5 offset:63488
v_mfma_f32_16x16x32_bf16 v[156:159], a[120:123], a[52:55], v[156:159]
ds_read_b128 a[108:111], v5 offset:64512
v_mfma_f32_16x16x32_bf16 v[160:163], a[124:127], a[52:55], v[160:163]
buffer_load_dwordx4 a[44:47], v4, s[40:43], s35 offen offset:1024 sc1
v_mfma_f32_16x16x32_bf16 v[144:147], a[124:127], a[48:51], v[144:147]
s_waitcnt vmcnt(10) lgkmcnt(4)
v_mfma_f32_16x16x32_bf16 v[132:135], a[128:131], a[0:3], v[132:135]
s_cmp_eq_u32 s3, 4
s_cselect_b32 s35, 28, 20
s_lshl_b32 s35, s35, 12
v_mfma_f32_16x16x32_bf16 v[148:151], a[128:131], a[4:7], v[148:151]
ds_read_b128 a[112:115], v6 offset:0
v_mfma_f32_16x16x32_bf16 v[152:155], a[132:135], a[4:7], v[152:155]
buffer_load_dwordx4 a[48:51], v4, s[40:43], s35 offen offset:0 sc1
v_mfma_f32_16x16x32_bf16 v[136:139], a[132:135], a[0:3], v[136:139]
ds_read_b128 a[116:119], v6 offset:1024
v_mfma_f32_16x16x32_bf16 v[140:143], a[136:139], a[0:3], v[140:143]
ds_read_b128 a[120:123], v6 offset:2048
v_mfma_f32_16x16x32_bf16 v[156:159], a[136:139], a[4:7], v[156:159]
ds_read_b128 a[124:127], v6 offset:3072
v_mfma_f32_16x16x32_bf16 v[160:163], a[140:143], a[4:7], v[160:163]
buffer_load_dwordx4 a[52:55], v4, s[40:43], s35 offen offset:1024 sc1
v_mfma_f32_16x16x32_bf16 v[144:147], a[140:143], a[0:3], v[144:147]
s_waitcnt vmcnt(10) lgkmcnt(4)
v_mfma_f32_16x16x32_bf16 v[132:135], a[96:99], a[8:11], v[132:135]
s_cmp_eq_u32 s3, 5
s_cselect_b32 s35, 29, 21
s_lshl_b32 s35, s35, 12
v_mfma_f32_16x16x32_bf16 v[148:151], a[96:99], a[12:15], v[148:151]
ds_read_b128 a[128:131], v6 offset:4096
v_mfma_f32_16x16x32_bf16 v[152:155], a[100:103], a[12:15], v[152:155]
buffer_load_dwordx4 a[0:3], v4, s[40:43], s35 offen offset:0 sc1
v_mfma_f32_16x16x32_bf16 v[136:139], a[100:103], a[8:11], v[136:139]
ds_read_b128 a[132:135], v6 offset:5120
v_mfma_f32_16x16x32_bf16 v[140:143], a[104:107], a[8:11], v[140:143]
ds_read_b128 a[136:139], v6 offset:6144
v_mfma_f32_16x16x32_bf16 v[156:159], a[104:107], a[12:15], v[156:159]
ds_read_b128 a[140:143], v6 offset:7168
v_mfma_f32_16x16x32_bf16 v[160:163], a[108:111], a[12:15], v[160:163]
buffer_load_dwordx4 a[4:7], v4, s[40:43], s35 offen offset:1024 sc1
v_mfma_f32_16x16x32_bf16 v[144:147], a[108:111], a[8:11], v[144:147]
s_waitcnt vmcnt(10) lgkmcnt(4)
v_mfma_f32_16x16x32_bf16 v[132:135], a[112:115], a[16:19], v[132:135]
s_cmp_eq_u32 s3, 6
s_cselect_b32 s35, 30, 22
s_lshl_b32 s35, s35, 12
v_mfma_f32_16x16x32_bf16 v[148:151], a[112:115], a[20:23], v[148:151]
ds_read_b128 a[96:99], v6 offset:8192
v_mfma_f32_16x16x32_bf16 v[152:155], a[116:119], a[20:23], v[152:155]
buffer_load_dwordx4 a[8:11], v4, s[40:43], s35 offen offset:0 sc1
v_mfma_f32_16x16x32_bf16 v[136:139], a[116:119], a[16:19], v[136:139]
ds_read_b128 a[100:103], v6 offset:9216
v_mfma_f32_16x16x32_bf16 v[140:143], a[120:123], a[16:19], v[140:143]
ds_read_b128 a[104:107], v6 offset:10240
v_mfma_f32_16x16x32_bf16 v[156:159], a[120:123], a[20:23], v[156:159]
ds_read_b128 a[108:111], v6 offset:11264
v_mfma_f32_16x16x32_bf16 v[160:163], a[124:127], a[20:23], v[160:163]
buffer_load_dwordx4 a[12:15], v4, s[40:43], s35 offen offset:1024 sc1
v_mfma_f32_16x16x32_bf16 v[144:147], a[124:127], a[16:19], v[144:147]
s_waitcnt vmcnt(10) lgkmcnt(4)
v_mfma_f32_16x16x32_bf16 v[132:135], a[128:131], a[24:27], v[132:135]
s_cmp_eq_u32 s3, 7
s_cselect_b32 s35, 31, 23
s_lshl_b32 s35, s35, 12
v_mfma_f32_16x16x32_bf16 v[148:151], a[128:131], a[28:31], v[148:151]
ds_read_b128 a[112:115], v6 offset:12288
v_mfma_f32_16x16x32_bf16 v[152:155], a[132:135], a[28:31], v[152:155]
buffer_load_dwordx4 a[16:19], v4, s[40:43], s35 offen offset:0 sc1
v_mfma_f32_16x16x32_bf16 v[136:139], a[132:135], a[24:27], v[136:139]
ds_read_b128 a[116:119], v6 offset:13312
v_mfma_f32_16x16x32_bf16 v[140:143], a[136:139], a[24:27], v[140:143]
ds_read_b128 a[120:123], v6 offset:14336
v_mfma_f32_16x16x32_bf16 v[156:159], a[136:139], a[28:31], v[156:159]
ds_read_b128 a[124:127], v6 offset:15360
v_mfma_f32_16x16x32_bf16 v[160:163], a[140:143], a[28:31], v[160:163]
buffer_load_dwordx4 a[20:23], v4, s[40:43], s35 offen offset:1024 sc1
v_mfma_f32_16x16x32_bf16 v[144:147], a[140:143], a[24:27], v[144:147]
s_waitcnt vmcnt(10) lgkmcnt(4)
v_mfma_f32_16x16x32_bf16 v[132:135], a[96:99], a[32:35], v[132:135]
s_cmp_eq_u32 s3, 0
s_cselect_b32 s35, 0, 24
s_lshl_b32 s35, s35, 12
v_mfma_f32_16x16x32_bf16 v[148:151], a[96:99], a[36:39], v[148:151]
ds_read_b128 a[128:131], v6 offset:16384
v_mfma_f32_16x16x32_bf16 v[152:155], a[100:103], a[36:39], v[152:155]
buffer_load_dwordx4 a[24:27], v4, s[40:43], s35 offen offset:0 sc1
v_mfma_f32_16x16x32_bf16 v[136:139], a[100:103], a[32:35], v[136:139]
ds_read_b128 a[132:135], v6 offset:17408
v_mfma_f32_16x16x32_bf16 v[140:143], a[104:107], a[32:35], v[140:143]
ds_read_b128 a[136:139], v6 offset:18432
v_mfma_f32_16x16x32_bf16 v[156:159], a[104:107], a[36:39], v[156:159]
ds_read_b128 a[140:143], v6 offset:19456
v_mfma_f32_16x16x32_bf16 v[160:163], a[108:111], a[36:39], v[160:163]
buffer_load_dwordx4 a[28:31], v4, s[40:43], s35 offen offset:1024 sc1
v_mfma_f32_16x16x32_bf16 v[144:147], a[108:111], a[32:35], v[144:147]
s_waitcnt vmcnt(10) lgkmcnt(4)
v_mfma_f32_16x16x32_bf16 v[132:135], a[112:115], a[40:43], v[132:135]
s_cmp_eq_u32 s3, 1
s_cselect_b32 s35, 1, 25
s_lshl_b32 s35, s35, 12
v_mfma_f32_16x16x32_bf16 v[148:151], a[112:115], a[44:47], v[148:151]
ds_read_b128 a[96:99], v6 offset:20480
v_mfma_f32_16x16x32_bf16 v[152:155], a[116:119], a[44:47], v[152:155]
buffer_load_dwordx4 a[32:35], v4, s[40:43], s35 offen offset:0 sc1
v_mfma_f32_16x16x32_bf16 v[136:139], a[116:119], a[40:43], v[136:139]
ds_read_b128 a[100:103], v6 offset:21504
v_mfma_f32_16x16x32_bf16 v[140:143], a[120:123], a[40:43], v[140:143]
ds_read_b128 a[104:107], v6 offset:22528
v_mfma_f32_16x16x32_bf16 v[156:159], a[120:123], a[44:47], v[156:159]
ds_read_b128 a[108:111], v6 offset:23552
v_mfma_f32_16x16x32_bf16 v[160:163], a[124:127], a[44:47], v[160:163]
buffer_load_dwordx4 a[36:39], v4, s[40:43], s35 offen offset:1024 sc1
v_mfma_f32_16x16x32_bf16 v[144:147], a[124:127], a[40:43], v[144:147]
s_waitcnt vmcnt(10) lgkmcnt(4)
v_mfma_f32_16x16x32_bf16 v[132:135], a[128:131], a[48:51], v[132:135]
s_cmp_eq_u32 s3, 2
s_cselect_b32 s35, 2, 26
s_lshl_b32 s35, s35, 12
v_mfma_f32_16x16x32_bf16 v[148:151], a[128:131], a[52:55], v[148:151]
ds_read_b128 a[112:115], v6 offset:24576
v_mfma_f32_16x16x32_bf16 v[152:155], a[132:135], a[52:55], v[152:155]
buffer_load_dwordx4 a[40:43], v4, s[40:43], s35 offen offset:0 sc1
v_mfma_f32_16x16x32_bf16 v[136:139], a[132:135], a[48:51], v[136:139]
ds_read_b128 a[116:119], v6 offset:25600
v_mfma_f32_16x16x32_bf16 v[140:143], a[136:139], a[48:51], v[140:143]
s_add_u32 s88, s67, 0xe0000
s_add_u32 s89, s66, 0xd0000
v_mfma_f32_16x16x32_bf16 v[156:159], a[136:139], a[52:55], v[156:159]
buffer_load_dword v11, v255, s[4:7], s88 offen sc1
v_mfma_f32_16x16x32_bf16 v[160:163], a[140:143], a[52:55], v[160:163]
buffer_load_dwordx4 a[44:47], v4, s[40:43], s35 offen offset:1024 sc1
v_mfma_f32_16x16x32_bf16 v[144:147], a[140:143], a[48:51], v[144:147]
ds_read_b128 a[120:123], v6 offset:26624
ds_read_b128 a[124:127], v6 offset:27648
s_waitcnt vmcnt(11) lgkmcnt(4)
v_mfma_f32_16x16x32_bf16 v[132:135], a[96:99], a[0:3], v[132:135]
s_cmp_eq_u32 s3, 3
s_cselect_b32 s35, 3, 27
s_lshl_b32 s35, s35, 12
v_mfma_f32_16x16x32_bf16 v[148:151], a[96:99], a[4:7], v[148:151]
buffer_load_dword v232, v255, s[4:7], s89 offen offset:64 sc1
v_mfma_f32_16x16x32_bf16 v[152:155], a[100:103], a[4:7], v[152:155]
buffer_load_dwordx4 a[48:51], v4, s[40:43], s35 offen offset:0 sc1
v_mfma_f32_16x16x32_bf16 v[136:139], a[100:103], a[0:3], v[136:139]
ds_read_b128 a[128:131], v6 offset:28672
v_mfma_f32_16x16x32_bf16 v[140:143], a[104:107], a[0:3], v[140:143]
ds_read_b128 a[132:135], v6 offset:29696
v_mfma_f32_16x16x32_bf16 v[156:159], a[104:107], a[4:7], v[156:159]
ds_read_b128 a[136:139], v6 offset:30720
v_mfma_f32_16x16x32_bf16 v[160:163], a[108:111], a[4:7], v[160:163]
buffer_load_dwordx4 a[52:55], v4, s[40:43], s35 offen offset:1024 sc1
v_mfma_f32_16x16x32_bf16 v[144:147], a[108:111], a[0:3], v[144:147]
ds_read_b128 a[140:143], v6 offset:31744
s_waitcnt vmcnt(12) lgkmcnt(4)
v_mfma_f32_16x16x32_bf16 v[132:135], a[112:115], a[8:11], v[132:135]
s_cmp_eq_u32 s3, 4
s_cselect_b32 s35, 4, 28
s_lshl_b32 s35, s35, 12
v_mfma_f32_16x16x32_bf16 v[148:151], a[112:115], a[12:15], v[148:151]
ds_read_b128 a[96:99], v6 offset:32768
v_mfma_f32_16x16x32_bf16 v[152:155], a[116:119], a[12:15], v[152:155]
buffer_load_dwordx4 a[0:3], v4, s[40:43], s35 offen offset:0 sc1
v_mfma_f32_16x16x32_bf16 v[136:139], a[116:119], a[8:11], v[136:139]
ds_read_b128 a[100:103], v6 offset:33792
v_mfma_f32_16x16x32_bf16 v[140:143], a[120:123], a[8:11], v[140:143]
ds_read_b128 a[104:107], v6 offset:34816
v_mfma_f32_16x16x32_bf16 v[156:159], a[120:123], a[12:15], v[156:159]
ds_read_b128 a[108:111], v6 offset:35840
v_mfma_f32_16x16x32_bf16 v[160:163], a[124:127], a[12:15], v[160:163]
buffer_load_dwordx4 a[4:7], v4, s[40:43], s35 offen offset:1024 sc1
v_mfma_f32_16x16x32_bf16 v[144:147], a[124:127], a[8:11], v[144:147]
s_waitcnt vmcnt(12) lgkmcnt(4)
v_mfma_f32_16x16x32_bf16 v[132:135], a[128:131], a[16:19], v[132:135]
s_cmp_eq_u32 s3, 5
s_cselect_b32 s35, 5, 29
s_lshl_b32 s35, s35, 12
v_mfma_f32_16x16x32_bf16 v[148:151], a[128:131], a[20:23], v[148:151]
ds_read_b128 a[112:115], v6 offset:36864
v_mfma_f32_16x16x32_bf16 v[152:155], a[132:135], a[20:23], v[152:155]
buffer_load_dwordx4 a[8:11], v4, s[40:43], s35 offen offset:0 sc1
v_mfma_f32_16x16x32_bf16 v[136:139], a[132:135], a[16:19], v[136:139]
ds_read_b128 a[116:119], v6 offset:37888
v_mfma_f32_16x16x32_bf16 v[140:143], a[136:139], a[16:19], v[140:143]
ds_read_b128 a[120:123], v6 offset:38912
v_mfma_f32_16x16x32_bf16 v[156:159], a[136:139], a[20:23], v[156:159]
ds_read_b128 a[124:127], v6 offset:39936
v_mfma_f32_16x16x32_bf16 v[160:163], a[140:143], a[20:23], v[160:163]
buffer_load_dwordx4 a[12:15], v4, s[40:43], s35 offen offset:1024 sc1
v_mfma_f32_16x16x32_bf16 v[144:147], a[140:143], a[16:19], v[144:147]
s_waitcnt vmcnt(12) lgkmcnt(4)
v_mfma_f32_16x16x32_bf16 v[132:135], a[96:99], a[24:27], v[132:135]
s_cmp_eq_u32 s3, 6
s_cselect_b32 s35, 6, 30
s_lshl_b32 s35, s35, 12
v_mfma_f32_16x16x32_bf16 v[148:151], a[96:99], a[28:31], v[148:151]
ds_read_b128 a[128:131], v6 offset:40960
v_mfma_f32_16x16x32_bf16 v[152:155], a[100:103], a[28:31], v[152:155]
buffer_load_dwordx4 a[16:19], v4, s[40:43], s35 offen offset:0 sc1
v_mfma_f32_16x16x32_bf16 v[136:139], a[100:103], a[24:27], v[136:139]
ds_read_b128 a[132:135], v6 offset:41984
v_mfma_f32_16x16x32_bf16 v[140:143], a[104:107], a[24:27], v[140:143]
ds_read_b128 a[136:139], v6 offset:43008
v_mfma_f32_16x16x32_bf16 v[156:159], a[104:107], a[28:31], v[156:159]
ds_read_b128 a[140:143], v6 offset:44032
v_mfma_f32_16x16x32_bf16 v[160:163], a[108:111], a[28:31], v[160:163]
buffer_load_dwordx4 a[20:23], v4, s[40:43], s35 offen offset:1024 sc1
v_mfma_f32_16x16x32_bf16 v[144:147], a[108:111], a[24:27], v[144:147]
s_waitcnt vmcnt(12) lgkmcnt(4)
v_mfma_f32_16x16x32_bf16 v[132:135], a[112:115], a[32:35], v[132:135]
s_cmp_eq_u32 s3, 7
s_cselect_b32 s35, 7, 31
s_lshl_b32 s35, s35, 12
v_mfma_f32_16x16x32_bf16 v[148:151], a[112:115], a[36:39], v[148:151]
ds_read_b128 a[96:99], v6 offset:45056
v_mfma_f32_16x16x32_bf16 v[152:155], a[116:119], a[36:39], v[152:155]
buffer_load_dwordx4 a[24:27], v4, s[40:43], s35 offen offset:0 sc1
v_mfma_f32_16x16x32_bf16 v[136:139], a[116:119], a[32:35], v[136:139]
ds_read_b128 a[100:103], v6 offset:46080
v_mfma_f32_16x16x32_bf16 v[140:143], a[120:123], a[32:35], v[140:143]
ds_read_b128 a[104:107], v6 offset:47104
v_mfma_f32_16x16x32_bf16 v[156:159], a[120:123], a[36:39], v[156:159]
ds_read_b128 a[108:111], v6 offset:48128
v_mfma_f32_16x16x32_bf16 v[160:163], a[124:127], a[36:39], v[160:163]
buffer_load_dwordx4 a[28:31], v4, s[40:43], s35 offen offset:1024 sc1
v_mfma_f32_16x16x32_bf16 v[144:147], a[124:127], a[32:35], v[144:147]
s_waitcnt vmcnt(11) lgkmcnt(4)
v_cmp_ne_u32 vcc, v11, v15
s_cbranch_vccnz Ltr_8
Lte_10:
v_mfma_f32_16x16x32_bf16 v[132:135], a[128:131], a[40:43], v[132:135]
s_add_u32 m0, s18, 0x0
s_add_u32 s44, s50, 0x1400000
v_mfma_f32_16x16x32_bf16 v[148:151], a[128:131], a[44:47], v[148:151]
ds_read_b128 a[112:115], v6 offset:49152
v_mfma_f32_16x16x32_bf16 v[152:155], a[132:135], a[44:47], v[152:155]
buffer_load_dwordx4 v1, s[4:7], s44 offen offset:0 sc1 lds
v_mfma_f32_16x16x32_bf16 v[136:139], a[132:135], a[40:43], v[136:139]
ds_read_b128 a[116:119], v6 offset:50176
v_mfma_f32_16x16x32_bf16 v[140:143], a[136:139], a[40:43], v[140:143]
ds_read_b128 a[120:123], v6 offset:51200
v_mfma_f32_16x16x32_bf16 v[156:159], a[136:139], a[44:47], v[156:159]
ds_read_b128 a[124:127], v6 offset:52224
v_mfma_f32_16x16x32_bf16 v[160:163], a[140:143], a[44:47], v[160:163]
buffer_load_dwordx4 v1, s[4:7], s44 offen offset:1024 sc1 lds
v_mfma_f32_16x16x32_bf16 v[144:147], a[140:143], a[40:43], v[144:147]
s_waitcnt vmcnt(10) lgkmcnt(4)
v_mfma_f32_16x16x32_bf16 v[132:135], a[96:99], a[48:51], v[132:135]
ds_read_b128 a[128:131], v6 offset:53248
v_mfma_f32_16x16x32_bf16 v[148:151], a[96:99], a[52:55], v[148:151]
ds_read_b128 a[132:135], v6 offset:54272
v_mfma_f32_16x16x32_bf16 v[152:155], a[100:103], a[52:55], v[152:155]
ds_read_b128 a[136:139], v6 offset:55296
v_mfma_f32_16x16x32_bf16 v[136:139], a[100:103], a[48:51], v[136:139]
ds_read_b128 a[140:143], v6 offset:56320
v_mfma_f32_16x16x32_bf16 v[140:143], a[104:107], a[48:51], v[140:143]
buffer_load_dwordx4 v1, s[4:7], s44 offen offset:2048 sc1 lds
s_add_u32 m0, s18, 0x3000
v_mfma_f32_16x16x32_bf16 v[156:159], a[104:107], a[52:55], v[156:159]
s_add_u32 s44, s50, 0x1403000
v_mfma_f32_16x16x32_bf16 v[160:163], a[108:111], a[52:55], v[160:163]
v_mfma_f32_16x16x32_bf16 v[144:147], a[108:111], a[48:51], v[144:147]
s_waitcnt vmcnt(9) lgkmcnt(4)
v_mfma_f32_16x16x32_bf16 v[132:135], a[112:115], a[0:3], v[132:135]
ds_read_b128 a[96:99], v6 offset:57344
v_mfma_f32_16x16x32_bf16 v[148:151], a[112:115], a[4:7], v[148:151]
ds_read_b128 a[100:103], v6 offset:58368
v_mfma_f32_16x16x32_bf16 v[152:155], a[116:119], a[4:7], v[152:155]
ds_read_b128 a[104:107], v6 offset:59392
v_mfma_f32_16x16x32_bf16 v[136:139], a[116:119], a[0:3], v[136:139]
buffer_load_dwordx4 v1, s[4:7], s44 offen offset:0 sc1 lds
v_mfma_f32_16x16x32_bf16 v[140:143], a[120:123], a[0:3], v[140:143]
ds_read_b128 a[108:111], v6 offset:60416
v_mfma_f32_16x16x32_bf16 v[156:159], a[120:123], a[4:7], v[156:159]
v_mfma_f32_16x16x32_bf16 v[160:163], a[124:127], a[4:7], v[160:163]
v_mfma_f32_16x16x32_bf16 v[144:147], a[124:127], a[0:3], v[144:147]
s_waitcnt vmcnt(8) lgkmcnt(4)
v_mfma_f32_16x16x32_bf16 v[132:135], a[128:131], a[8:11], v[132:135]
ds_read_b128 a[112:115], v6 offset:61440
v_mfma_f32_16x16x32_bf16 v[148:151], a[128:131], a[12:15], v[148:151]
buffer_load_dwordx4 v1, s[4:7], s44 offen offset:1024 sc1 lds
v_mfma_f32_16x16x32_bf16 v[152:155], a[132:135], a[12:15], v[152:155]
ds_read_b128 a[116:119], v6 offset:62464
v_mfma_f32_16x16x32_bf16 v[136:139], a[132:135], a[8:11], v[136:139]
ds_read_b128 a[120:123], v6 offset:63488
v_mfma_f32_16x16x32_bf16 v[140:143], a[136:139], a[8:11], v[140:143]
ds_read_b128 a[124:127], v6 offset:64512
v_mfma_f32_16x16x32_bf16 v[156:159], a[136:139], a[12:15], v[156:159]
v_mfma_f32_16x16x32_bf16 v[160:163], a[140:143], a[12:15], v[160:163]
v_mfma_f32_16x16x32_bf16 v[144:147], a[140:143], a[8:11], v[144:147]
buffer_load_dwordx4 v1, s[4:7], s44 offen offset:2048 sc1 lds
s_waitcnt vmcnt(8) lgkmcnt(4)
v_mfma_f32_16x16x32_bf16 v[132:135], a[96:99], a[16:19], v[132:135]
v_mfma_f32_16x16x32_bf16 v[148:151], a[96:99], a[20:23], v[148:151]
v_mfma_f32_16x16x32_bf16 v[152:155], a[100:103], a[20:23], v[152:155]
v_mfma_f32_16x16x32_bf16 v[136:139], a[100:103], a[16:19], v[136:139]
v_mfma_f32_16x16x32_bf16 v[140:143], a[104:107], a[16:19], v[140:143]
v_mfma_f32_16x16x32_bf16 v[156:159], a[104:107], a[20:23], v[156:159]
v_mfma_f32_16x16x32_bf16 v[160:163], a[108:111], a[20:23], v[160:163]
v_mfma_f32_16x16x32_bf16 v[144:147], a[108:111], a[16:19], v[144:147]
s_waitcnt vmcnt(6) lgkmcnt(0)
v_mfma_f32_16x16x32_bf16 v[132:135], a[112:115], a[24:27], v[132:135]
v_mfma_f32_16x16x32_bf16 v[148:151], a[112:115], a[28:31], v[148:151]
v_mfma_f32_16x16x32_bf16 v[152:155], a[116:119], a[28:31], v[152:155]
v_mfma_f32_16x16x32_bf16 v[136:139], a[116:119], a[24:27], v[136:139]
v_mfma_f32_16x16x32_bf16 v[140:143], a[120:123], a[24:27], v[140:143]
v_mfma_f32_16x16x32_bf16 v[156:159], a[120:123], a[28:31], v[156:159]
v_mfma_f32_16x16x32_bf16 v[160:163], a[124:127], a[28:31], v[160:163]
v_mfma_f32_16x16x32_bf16 v[144:147], a[124:127], a[24:27], v[144:147]
s_lshl_b32 s36, s32, 13
v_cvt_pk_bf16_f32 v32, v132, v133
v_cvt_pk_bf16_f32 v33, v134, v135
s_nop 0
v_cvt_pk_bf16_f32 v34, v136, v137
v_cvt_pk_bf16_f32 v35, v138, v139
s_add_u32 s36, s36, 0x2200000
buffer_store_dwordx4 v[32:35], v4, s[4:7], s36 offen offset:0 sc1
v_cvt_pk_bf16_f32 v40, v148, v149
v_cvt_pk_bf16_f32 v41, v150, v151
v_cvt_pk_bf16_f32 v42, v152, v153
v_cvt_pk_bf16_f32 v43, v154, v155
v_cvt_pk_bf16_f32 v36, v140, v141
v_cvt_pk_bf16_f32 v37, v142, v143
v_cvt_pk_bf16_f32 v38, v144, v145
v_cvt_pk_bf16_f32 v39, v146, v147
s_add_u32 s37, s36, 4096
v_cvt_pk_bf16_f32 v44, v156, v157
v_cvt_pk_bf16_f32 v45, v158, v159
v_cvt_pk_bf16_f32 v46, v160, v161
buffer_store_dwordx4 v[40:43], v4, s[4:7], s36 offen offset:1024 sc1
v_cvt_pk_bf16_f32 v47, v162, v163
v_mfma_f32_16x16x32_bf16 v[96:99], v[32:35], v[32:35], 0
s_mov_b32 s38, 0x240000
s_add_u32 s92, s78, 0x40000
v_mfma_f32_16x16x32_bf16 v[92:95], v[16:19], v[32:35], 0
s_add_u32 s93, s79, 0x40000
s_add_u32 s40, s4, 0x2200000
v_mfma_f32_16x16x32_bf16 v[96:99], v[36:39], v[36:39], v[96:99]
s_addc_u32 s41, s5, 0
buffer_store_dwordx4 v[36:39], v4, s[4:7], s37 offen offset:0 sc1
v_mfma_f32_16x16x32_bf16 v[92:95], v[16:19], v[36:39], v[92:95]
s_nop 4
v_cndmask_b32 v96, v96, v97, s[46:47]
v_cndmask_b32 v98, v98, v99, s[46:47]
v_mfma_f32_16x16x32_bf16 v[104:107], v[40:43], v[40:43], 0
v_mfma_f32_16x16x32_bf16 v[100:103], v[16:19], v[40:43], 0
v_cndmask_b32 v93, v96, v98, s[48:49]
buffer_store_dwordx4 v[44:47], v4, s[4:7], s37 offen offset:1024 sc1
v_mfma_f32_16x16x32_bf16 v[104:107], v[44:47], v[44:47], v[104:107]
v_mfma_f32_16x16x32_bf16 v[100:103], v[16:19], v[44:47], v[100:103]
s_nop 6
v_cndmask_b32 v104, v104, v105, s[46:47]
L_stub4:
s_cbranch_execz L_wret1
v_cndmask_b32 v106, v106, v107, s[46:47]
buffer_store_dwordx2 v[92:93], v253, s[4:7], s38 offen offset:0 sc1
v_cndmask_b32 v101, v104, v106, s[48:49]
buffer_store_dwordx2 v[100:101], v253, s[4:7], s38 offen offset:2048 sc1
v_cmp_ne_u32 vcc, v232, v15
s_cbranch_vccnz Ltr_11
Lte_13:
s_barrier
s_add_u32 m0, s18, 0x6000
s_add_u32 s44, s50, 0x1406000
buffer_load_dwordx4 v1, s[4:7], s44 offen offset:0 sc1 lds
buffer_load_dwordx4 v1, s[4:7], s44 offen offset:1024 sc1 lds
buffer_load_dwordx4 v1, s[4:7], s44 offen offset:2048 sc1 lds
s_add_u32 m0, s18, 0x9000
s_add_u32 s44, s50, 0x1409000
buffer_load_dwordx4 v1, s[4:7], s44 offen offset:0 sc1 lds
buffer_load_dwordx4 v1, s[4:7], s44 offen offset:1024 sc1 lds
buffer_load_dwordx4 v1, s[4:7], s44 offen offset:2048 sc1 lds
s_waitcnt vmcnt(6)
s_barrier
s_cmp_lg_u32 s28, 1
s_cbranch_scc1 Lsg_14
buffer_atomic_add v12, v10, s[4:7], s92 offen sc1
Lsg_14:
s_mov_b64 exec, 0
s_cmp_eq_u32 s28, 1
s_cbranch_scc1 L_stub5
L_wret2:
s_mov_b64 exec, -1
s_cmp_lt_u32 s28, 2
s_cbranch_scc1 Lwd_15
s_add_u32 m0, s18, 0xa800
s_add_u32 s44, s50, 0x140a800
buffer_load_dwordx4 v1, s[4:7], s44 offen offset:0 sc1 lds
buffer_load_dwordx4 v1, s[4:7], s44 offen offset:1024 sc1 lds
buffer_load_dwordx4 v1, s[4:7], s44 offen offset:2048 sc1 lds
s_add_u32 m0, s18, 0xc000
s_add_u32 s44, s50, 0x140c000
buffer_load_dwordx4 v1, s[4:7], s44 offen offset:0 sc1 lds
buffer_load_dwordx4 v1, s[4:7], s44 offen offset:1024 sc1 lds
buffer_load_dwordx4 v1, s[4:7], s44 offen offset:2048 sc1 lds
s_add_u32 m0, s18, 0xd800
s_add_u32 s44, s50, 0x140d800
buffer_load_dwordx4 v1, s[4:7], s44 offen offset:0 sc1 lds
buffer_load_dwordx4 v1, s[4:7], s44 offen offset:1024 sc1 lds
buffer_load_dwordx4 v1, s[4:7], s44 offen offset:2048 sc1 lds
s_add_u32 m0, s18, 0xf000
s_add_u32 s44, s50, 0x140f000
buffer_load_dwordx4 v1, s[4:7], s44 offen offset:0 sc1 lds
buffer_load_dwordx4 v1, s[4:7], s44 offen offset:1024 sc1 lds
buffer_load_dwordx4 v1, s[4:7], s44 offen offset:2048 sc1 lds
s_add_u32 m0, s18, 0x10800
s_add_u32 s44, s50, 0x1410800
buffer_load_dwordx4 v1, s[4:7], s44 offen offset:0 sc1 lds
buffer_load_dwordx4 v1, s[4:7], s44 offen offset:1024 sc1 lds
buffer_load_dwordx4 v1, s[4:7], s44 offen offset:2048 sc1 lds
s_add_u32 m0, s18, 0x12000
s_add_u32 s44, s50, 0x1412000
buffer_load_dwordx4 v1, s[4:7], s44 offen offset:0 sc1 lds
buffer_load_dwordx4 v1, s[4:7], s44 offen offset:1024 sc1 lds
buffer_load_dwordx4 v1, s[4:7], s44 offen offset:2048 sc1 lds
s_add_u32 m0, s18, 0x13800
s_add_u32 s44, s50, 0x1413800
buffer_load_dwordx4 v1, s[4:7], s44 offen offset:0 sc1 lds
buffer_load_dwordx4 v1, s[4:7], s44 offen offset:1024 sc1 lds
buffer_load_dwordx4 v1, s[4:7], s44 offen offset:2048 sc1 lds
s_add_u32 m0, s18, 0x15000
s_add_u32 s44, s50, 0x1415000
buffer_load_dwordx4 v1, s[4:7], s44 offen offset:0 sc1 lds
buffer_load_dwordx4 v1, s[4:7], s44 offen offset:1024 sc1 lds
buffer_load_dwordx4 v1, s[4:7], s44 offen offset:2048 sc1 lds
s_add_u32 m0, s18, 0x16800
s_add_u32 s44, s50, 0x1416800
buffer_load_dwordx4 v1, s[4:7], s44 offen offset:0 sc1 lds
buffer_load_dwordx4 v1, s[4:7], s44 offen offset:1024 sc1 lds
buffer_load_dwordx4 v1, s[4:7], s44 offen offset:2048 sc1 lds
s_add_u32 m0, s18, 0x18000
s_add_u32 s44, s50, 0x1418000
buffer_load_dwordx4 v1, s[4:7], s44 offen offset:0 sc1 lds
buffer_load_dwordx4 v1, s[4:7], s44 offen offset:1024 sc1 lds
buffer_load_dwordx4 v1, s[4:7], s44 offen offset:2048 sc1 lds
s_add_u32 m0, s18, 0x19800
s_add_u32 s44, s50, 0x1419800
buffer_load_dwordx4 v1, s[4:7], s44 offen offset:0 sc1 lds
buffer_load_dwordx4 v1, s[4:7], s44 offen offset:1024 sc1 lds
buffer_load_dwordx4 v1, s[4:7], s44 offen offset:2048 sc1 lds
s_add_u32 m0, s18, 0x1b000
s_add_u32 s44, s50, 0x141b000
buffer_load_dwordx4 v1, s[4:7], s44 offen offset:0 sc1 lds
buffer_load_dwordx4 v1, s[4:7], s44 offen offset:1024 sc1 lds
buffer_load_dwordx4 v1, s[4:7], s44 offen offset:2048 sc1 lds
Lwd_15:
s_cmp_lg_u32 s28, 0
s_cbranch_scc1 Lpo_18
s_add_u32 s36, s67, 0x40000
s_mov_b32 s37, 0
v_mov_b32 v11, 0
buffer_atomic_add v11, v251, s[4:7], s36 offen sc0 sc1
s_sleep 4
Lpoll_16:
v_mov_b32 v234, 0
buffer_atomic_add v234, v251, s[4:7], s36 offen sc0 sc1
s_waitcnt vmcnt(1)
v_readfirstlane_b32 s38, v11
s_nop 0
s_cmp_ge_u32 s38, 32
s_cbranch_scc1 Lpe_17
v_mov_b32 v11, 0
buffer_atomic_add v11, v251, s[4:7], s36 offen sc0 sc1
s_waitcnt vmcnt(1)
v_readfirstlane_b32 s38, v234
s_nop 0
s_cmp_ge_u32 s38, 32
s_cbranch_scc1 Lpe_17
s_add_u32 s37, s37, 1
s_cmp_lt_u32 s37, 0x80000
s_cbranch_scc1 Lpoll_16
s_waitcnt vmcnt(0)
Lpo_18:
s_waitcnt vmcnt(36) lgkmcnt(0)
s_cmp_ge_u32 s28, 2
s_cbranch_scc1 Lw_19
s_waitcnt vmcnt(0)
Lw_19:
Lpe_17:
s_barrier
s_add_u32 s9, s66, 0x10080
s_mov_b32 s35, 0
s_mov_b32 s33, 0x1000
buffer_load_dwordx4 a[0:3], v2, s[40:43], s35 offen offset:0 sc1
buffer_load_dwordx4 a[4:7], v2, s[40:43], s33 offen offset:0 sc1
buffer_load_dwordx4 a[8:11], v2, s[40:43], s35 offen offset:1024 sc1
buffer_load_dwordx4 a[12:15], v2, s[40:43], s33 offen offset:1024 sc1
buffer_load_dwordx4 a[16:19], v2, s[40:43], s35 offen offset:2048 sc1
buffer_load_dwordx4 a[20:23], v2, s[40:43], s33 offen offset:2048 sc1
buffer_load_dwordx4 a[24:27], v2, s[40:43], s35 offen offset:3072 sc1
buffer_load_dwordx4 a[28:31], v2, s[40:43], s33 offen offset:3072 sc1
s_add_u32 s35, s35, 8192
s_add_u32 s33, s33, 8192
buffer_load_dwordx4 a[32:35], v2, s[40:43], s35 offen offset:0 sc1
buffer_load_dwordx4 a[36:39], v2, s[40:43], s33 offen offset:0 sc1
buffer_load_dwordx4 a[40:43], v2, s[40:43], s35 offen offset:1024 sc1
buffer_load_dwordx4 a[44:47], v2, s[40:43], s33 offen offset:1024 sc1
buffer_load_dwordx4 a[48:51], v2, s[40:43], s35 offen offset:2048 sc1
buffer_load_dwordx4 a[52:55], v2, s[40:43], s33 offen offset:2048 sc1
buffer_load_dwordx4 a[56:59], v2, s[40:43], s35 offen offset:3072 sc1
buffer_load_dwordx4 a[60:63], v2, s[40:43], s33 offen offset:3072 sc1
s_add_u32 s35, s35, 8192
s_add_u32 s33, s33, 8192
v_add_u32 v5, 0, v1
ds_read_b128 a[96:99], v5 offset:2048
ds_read_b128 a[100:103], v5 offset:8192
ds_read_b128 a[104:107], v5 offset:3072
ds_read_b128 a[108:111], v5 offset:9216
ds_read_b128 a[112:115], v5 offset:4096
ds_read_b128 a[116:119], v5 offset:10240
s_waitcnt vmcnt(14) lgkmcnt(4)
v_mfma_f32_16x16x32_bf16 v[140:143], a[96:99], a[0:3], 0
v_and_b32 v232, 15, v0
v_lshlrev_b32 v232, 7, v232
v_mfma_f32_16x16x32_bf16 v[140:143], a[100:103], a[4:7], v[140:143]
buffer_load_dwordx4 a[64:67], v2, s[40:43], s35 offen offset:0 sc1
s_waitcnt vmcnt(13)
v_mfma_f32_16x16x32_bf16 v[164:167], a[100:103], a[12:15], 0
v_lshrrev_b32 v233, 4, v0
v_lshlrev_b32 v233, 4, v233
v_mfma_f32_16x16x32_bf16 v[164:167], a[96:99], a[8:11], v[164:167]
v_add_u32 v232, v233, v232
s_mul_i32 s38, s30, 12288
s_waitcnt vmcnt(12)
v_mfma_f32_16x16x32_bf16 v[188:191], a[96:99], a[16:19], 0
s_add_u32 s38, s38, 0x380000
s_add_u32 s39, s28, 4
s_min_u32 s39, s39, 5
s_waitcnt vmcnt(11)
v_mfma_f32_16x16x32_bf16 v[188:191], a[100:103], a[20:23], v[188:191]
buffer_load_dwordx4 a[68:71], v2, s[40:43], s33 offen offset:0 sc1
s_lshl_b32 s36, s28, 11
s_waitcnt vmcnt(10)
v_mfma_f32_16x16x32_bf16 v[212:215], a[100:103], a[28:31], 0
s_add_u32 s36, s36, s38
s_lshl_b32 s37, s39, 11
s_add_u32 s37, s37, s38
v_mfma_f32_16x16x32_bf16 v[212:215], a[96:99], a[24:27], v[212:215]
ds_read_b128 a[128:131], v5 offset:5120
s_waitcnt lgkmcnt(4)
v_mfma_f32_16x16x32_bf16 v[216:219], a[104:107], a[24:27], 0
ds_read_b128 a[132:135], v5 offset:11264
s_waitcnt lgkmcnt(4)
v_mfma_f32_16x16x32_bf16 v[216:219], a[108:111], a[28:31], v[216:219]
ds_read_b128 a[136:139], v5 offset:0
v_mfma_f32_16x16x32_bf16 v[192:195], a[108:111], a[20:23], 0
buffer_load_dwordx4 v[48:51], v232, s[4:7], s36 offen sc1
v_mfma_f32_16x16x32_bf16 v[192:195], a[104:107], a[16:19], v[192:195]
ds_read_b128 a[140:143], v5 offset:6144
v_mfma_f32_16x16x32_bf16 v[168:171], a[104:107], a[8:11], 0
ds_read_b128 a[144:147], v5 offset:1024
v_mfma_f32_16x16x32_bf16 v[168:171], a[108:111], a[12:15], v[168:171]
ds_read_b128 a[148:151], v5 offset:7168
v_mfma_f32_16x16x32_bf16 v[144:147], a[108:111], a[4:7], 0
v_mfma_f32_16x16x32_bf16 v[144:147], a[104:107], a[0:3], v[144:147]
buffer_load_dwordx4 a[72:75], v2, s[40:43], s35 offen offset:1024 sc1
s_waitcnt lgkmcnt(7)
v_mfma_f32_16x16x32_bf16 v[148:151], a[112:115], a[0:3], 0
s_waitcnt lgkmcnt(6)
v_mfma_f32_16x16x32_bf16 v[148:151], a[116:119], a[4:7], v[148:151]
v_mfma_f32_16x16x32_bf16 v[172:175], a[116:119], a[12:15], 0
v_mfma_f32_16x16x32_bf16 v[172:175], a[112:115], a[8:11], v[172:175]
v_mfma_f32_16x16x32_bf16 v[196:199], a[112:115], a[16:19], 0
buffer_load_dwordx4 a[76:79], v2, s[40:43], s33 offen offset:1024 sc1
v_mfma_f32_16x16x32_bf16 v[196:199], a[116:119], a[20:23], v[196:199]
v_mfma_f32_16x16x32_bf16 v[220:223], a[116:119], a[28:31], 0
v_mfma_f32_16x16x32_bf16 v[220:223], a[112:115], a[24:27], v[220:223]
s_waitcnt lgkmcnt(0)
v_mfma_f32_16x16x32_bf16 v[224:227], a[128:131], a[24:27], 0
ds_read_b128 a[96:99], v5 offset:14336
v_mfma_f32_16x16x32_bf16 v[224:227], a[132:135], a[28:31], v[224:227]
buffer_load_dwordx4 a[80:83], v2, s[40:43], s35 offen offset:2048 sc1
v_mfma_f32_16x16x32_bf16 v[200:203], a[132:135], a[20:23], 0
ds_read_b128 a[100:103], v5 offset:20480
v_mfma_f32_16x16x32_bf16 v[200:203], a[128:131], a[16:19], v[200:203]
v_mfma_f32_16x16x32_bf16 v[176:179], a[128:131], a[8:11], 0
v_mfma_f32_16x16x32_bf16 v[176:179], a[132:135], a[12:15], v[176:179]
buffer_load_dwordx4 a[84:87], v2, s[40:43], s33 offen offset:2048 sc1
v_mfma_f32_16x16x32_bf16 v[152:155], a[132:135], a[4:7], 0
ds_read_b128 a[104:107], v5 offset:15360
v_mfma_f32_16x16x32_bf16 v[152:155], a[128:131], a[0:3], v[152:155]
v_mfma_f32_16x16x32_bf16 v[132:135], a[136:139], a[0:3], 0
ds_read_b128 a[108:111], v5 offset:21504
v_mfma_f32_16x16x32_bf16 v[132:135], a[140:143], a[4:7], v[132:135]
v_mfma_f32_16x16x32_bf16 v[156:159], a[140:143], a[12:15], 0
buffer_load_dwordx4 v[52:55], v232, s[4:7], s37 offen sc1
s_add_u32 m0, s18, 0x1e000
v_mfma_f32_16x16x32_bf16 v[156:159], a[136:139], a[8:11], v[156:159]
s_add_u32 s44, s50, 0x141e000
ds_read_b128 a[112:115], v5 offset:16384
v_mfma_f32_16x16x32_bf16 v[180:183], a[136:139], a[16:19], 0
v_mfma_f32_16x16x32_bf16 v[180:183], a[140:143], a[20:23], v[180:183]
ds_read_b128 a[116:119], v5 offset:22528
v_mfma_f32_16x16x32_bf16 v[204:207], a[140:143], a[28:31], 0
v_mfma_f32_16x16x32_bf16 v[204:207], a[136:139], a[24:27], v[204:207]
buffer_load_dwordx4 a[88:91], v2, s[40:43], s35 offen offset:3072 sc1
v_mfma_f32_16x16x32_bf16 v[208:211], a[144:147], a[24:27], 0
v_mfma_f32_16x16x32_bf16 v[208:211], a[148:151], a[28:31], v[208:211]
v_mfma_f32_16x16x32_bf16 v[184:187], a[148:151], a[20:23], 0
v_mfma_f32_16x16x32_bf16 v[184:187], a[144:147], a[16:19], v[184:187]
v_mfma_f32_16x16x32_bf16 v[160:163], a[144:147], a[8:11], 0
buffer_load_dwordx4 a[92:95], v2, s[40:43], s33 offen offset:3072 sc1
s_add_u32 s35, s35, 8192
v_mfma_f32_16x16x32_bf16 v[160:163], a[148:151], a[12:15], v[160:163]
s_add_u32 s33, s33, 8192
v_mfma_f32_16x16x32_bf16 v[136:139], a[148:151], a[4:7], 0
v_mfma_f32_16x16x32_bf16 v[136:139], a[144:147], a[0:3], v[136:139]
s_waitcnt vmcnt(10) lgkmcnt(0)
v_mfma_f32_16x16x32_bf16 v[140:143], a[96:99], a[32:35], v[140:143]
ds_read_b128 a[128:131], v5 offset:17408
v_mfma_f32_16x16x32_bf16 v[140:143], a[100:103], a[36:39], v[140:143]
buffer_load_dwordx4 a[0:3], v2, s[40:43], s35 offen offset:0 sc1
v_mfma_f32_16x16x32_bf16 v[164:167], a[100:103], a[44:47], v[164:167]
ds_read_b128 a[132:135], v5 offset:23552
v_mfma_f32_16x16x32_bf16 v[164:167], a[96:99], a[40:43], v[164:167]
v_mfma_f32_16x16x32_bf16 v[188:191], a[96:99], a[48:51], v[188:191]
v_mfma_f32_16x16x32_bf16 v[188:191], a[100:103], a[52:55], v[188:191]
buffer_load_dwordx4 a[4:7], v2, s[40:43], s33 offen offset:0 sc1
v_mfma_f32_16x16x32_bf16 v[212:215], a[100:103], a[60:63], v[212:215]
ds_read_b128 a[136:139], v5 offset:12288
v_mfma_f32_16x16x32_bf16 v[212:215], a[96:99], a[56:59], v[212:215]
v_mfma_f32_16x16x32_bf16 v[216:219], a[104:107], a[56:59], v[216:219]
ds_read_b128 a[140:143], v5 offset:18432
v_mfma_f32_16x16x32_bf16 v[216:219], a[108:111], a[60:63], v[216:219]
v_mfma_f32_16x16x32_bf16 v[192:195], a[108:111], a[52:55], v[192:195]
buffer_load_dwordx4 v1, s[4:7], s44 offen offset:0 sc1 lds
v_mfma_f32_16x16x32_bf16 v[192:195], a[104:107], a[48:51], v[192:195]
ds_read_b128 a[144:147], v5 offset:13312
v_mfma_f32_16x16x32_bf16 v[168:171], a[104:107], a[40:43], v[168:171]
v_mfma_f32_16x16x32_bf16 v[168:171], a[108:111], a[44:47], v[168:171]
ds_read_b128 a[148:151], v5 offset:19456
v_mfma_f32_16x16x32_bf16 v[144:147], a[108:111], a[36:39], v[144:147]
v_mfma_f32_16x16x32_bf16 v[144:147], a[104:107], a[32:35], v[144:147]
buffer_load_dwordx4 a[8:11], v2, s[40:43], s35 offen offset:1024 sc1
v_mfma_f32_16x16x32_bf16 v[148:151], a[112:115], a[32:35], v[148:151]
v_mfma_f32_16x16x32_bf16 v[148:151], a[116:119], a[36:39], v[148:151]
v_mfma_f32_16x16x32_bf16 v[172:175], a[116:119], a[44:47], v[172:175]
v_mfma_f32_16x16x32_bf16 v[172:175], a[112:115], a[40:43], v[172:175]
v_mfma_f32_16x16x32_bf16 v[196:199], a[112:115], a[48:51], v[196:199]
buffer_load_dwordx4 a[12:15], v2, s[40:43], s33 offen offset:1024 sc1
v_mfma_f32_16x16x32_bf16 v[196:199], a[116:119], a[52:55], v[196:199]
v_mfma_f32_16x16x32_bf16 v[220:223], a[116:119], a[60:63], v[220:223]
v_mfma_f32_16x16x32_bf16 v[220:223], a[112:115], a[56:59], v[220:223]
s_waitcnt lgkmcnt(0)
v_mfma_f32_16x16x32_bf16 v[224:227], a[128:131], a[56:59], v[224:227]
ds_read_b128 a[96:99], v5 offset:26624
v_mfma_f32_16x16x32_bf16 v[224:227], a[132:135], a[60:63], v[224:227]
buffer_load_dwordx4 a[16:19], v2, s[40:43], s35 offen offset:2048 sc1
v_mfma_f32_16x16x32_bf16 v[200:203], a[132:135], a[52:55], v[200:203]
ds_read_b128 a[100:103], v5 offset:32768
v_mfma_f32_16x16x32_bf16 v[200:203], a[128:131], a[48:51], v[200:203]
v_mfma_f32_16x16x32_bf16 v[176:179], a[128:131], a[40:43], v[176:179]
v_mfma_f32_16x16x32_bf16 v[176:179], a[132:135], a[44:47], v[176:179]
buffer_load_dwordx4 v1, s[4:7], s44 offen offset:1024 sc1 lds
v_mfma_f32_16x16x32_bf16 v[152:155], a[132:135], a[36:39], v[152:155]
ds_read_b128 a[104:107], v5 offset:27648
v_mfma_f32_16x16x32_bf16 v[152:155], a[128:131], a[32:35], v[152:155]
v_mfma_f32_16x16x32_bf16 v[132:135], a[136:139], a[32:35], v[132:135]
ds_read_b128 a[108:111], v5 offset:33792
v_mfma_f32_16x16x32_bf16 v[132:135], a[140:143], a[36:39], v[132:135]
buffer_load_dwordx4 a[20:23], v2, s[40:43], s33 offen offset:2048 sc1
v_mfma_f32_16x16x32_bf16 v[156:159], a[140:143], a[44:47], v[156:159]
ds_read_b128 a[112:115], v5 offset:28672
v_mfma_f32_16x16x32_bf16 v[156:159], a[136:139], a[40:43], v[156:159]
v_mfma_f32_16x16x32_bf16 v[180:183], a[136:139], a[48:51], v[180:183]
v_mfma_f32_16x16x32_bf16 v[180:183], a[140:143], a[52:55], v[180:183]
buffer_load_dwordx4 a[24:27], v2, s[40:43], s35 offen offset:3072 sc1
v_mfma_f32_16x16x32_bf16 v[204:207], a[140:143], a[60:63], v[204:207]
ds_read_b128 a[116:119], v5 offset:34816
v_mfma_f32_16x16x32_bf16 v[204:207], a[136:139], a[56:59], v[204:207]
v_mfma_f32_16x16x32_bf16 v[208:211], a[144:147], a[56:59], v[208:211]
v_mfma_f32_16x16x32_bf16 v[208:211], a[148:151], a[60:63], v[208:211]
buffer_load_dwordx4 v1, s[4:7], s44 offen offset:2048 sc1 lds
s_add_u32 m0, s18, 0x21000
v_mfma_f32_16x16x32_bf16 v[184:187], a[148:151], a[52:55], v[184:187]
s_add_u32 s44, s50, 0x1421000
v_mfma_f32_16x16x32_bf16 v[184:187], a[144:147], a[48:51], v[184:187]
v_mfma_f32_16x16x32_bf16 v[160:163], a[144:147], a[40:43], v[160:163]
v_mfma_f32_16x16x32_bf16 v[160:163], a[148:151], a[44:47], v[160:163]
buffer_load_dwordx4 a[28:31], v2, s[40:43], s33 offen offset:3072 sc1
s_add_u32 s35, s35, 8192
v_mfma_f32_16x16x32_bf16 v[136:139], a[148:151], a[36:39], v[136:139]
s_add_u32 s33, s33, 8192
v_mfma_f32_16x16x32_bf16 v[136:139], a[144:147], a[32:35], v[136:139]
s_waitcnt vmcnt(11) lgkmcnt(0)
v_mfma_f32_16x16x32_bf16 v[140:143], a[96:99], a[64:67], v[140:143]
ds_read_b128 a[128:131], v5 offset:29696
v_mfma_f32_16x16x32_bf16 v[140:143], a[100:103], a[68:71], v[140:143]
buffer_load_dwordx4 a[32:35], v2, s[40:43], s35 offen offset:0 sc1
v_mfma_f32_16x16x32_bf16 v[164:167], a[100:103], a[76:79], v[164:167]
ds_read_b128 a[132:135], v5 offset:35840
v_mfma_f32_16x16x32_bf16 v[164:167], a[96:99], a[72:75], v[164:167]
v_mfma_f32_16x16x32_bf16 v[188:191], a[96:99], a[80:83], v[188:191]
v_mfma_f32_16x16x32_bf16 v[188:191], a[100:103], a[84:87], v[188:191]
buffer_load_dwordx4 a[36:39], v2, s[40:43], s33 offen offset:0 sc1
v_mfma_f32_16x16x32_bf16 v[212:215], a[100:103], a[92:95], v[212:215]
ds_read_b128 a[136:139], v5 offset:24576
v_mfma_f32_16x16x32_bf16 v[212:215], a[96:99], a[88:91], v[212:215]
v_mfma_f32_16x16x32_bf16 v[216:219], a[104:107], a[88:91], v[216:219]
ds_read_b128 a[140:143], v5 offset:30720
v_mfma_f32_16x16x32_bf16 v[216:219], a[108:111], a[92:95], v[216:219]
v_mfma_f32_16x16x32_bf16 v[192:195], a[108:111], a[84:87], v[192:195]
buffer_load_dwordx4 v1, s[4:7], s44 offen offset:0 sc1 lds
v_mfma_f32_16x16x32_bf16 v[192:195], a[104:107], a[80:83], v[192:195]
ds_read_b128 a[144:147], v5 offset:25600
v_mfma_f32_16x16x32_bf16 v[168:171], a[104:107], a[72:75], v[168:171]
v_mfma_f32_16x16x32_bf16 v[168:171], a[108:111], a[76:79], v[168:171]
ds_read_b128 a[148:151], v5 offset:31744
v_mfma_f32_16x16x32_bf16 v[144:147], a[108:111], a[68:71], v[144:147]
v_mfma_f32_16x16x32_bf16 v[144:147], a[104:107], a[64:67], v[144:147]
buffer_load_dwordx4 a[40:43], v2, s[40:43], s35 offen offset:1024 sc1
v_mfma_f32_16x16x32_bf16 v[148:151], a[112:115], a[64:67], v[148:151]
v_mfma_f32_16x16x32_bf16 v[148:151], a[116:119], a[68:71], v[148:151]
v_mfma_f32_16x16x32_bf16 v[172:175], a[116:119], a[76:79], v[172:175]
v_mfma_f32_16x16x32_bf16 v[172:175], a[112:115], a[72:75], v[172:175]
v_mfma_f32_16x16x32_bf16 v[196:199], a[112:115], a[80:83], v[196:199]
buffer_load_dwordx4 a[44:47], v2, s[40:43], s33 offen offset:1024 sc1
v_mfma_f32_16x16x32_bf16 v[196:199], a[116:119], a[84:87], v[196:199]
v_mfma_f32_16x16x32_bf16 v[220:223], a[116:119], a[92:95], v[220:223]
v_mfma_f32_16x16x32_bf16 v[220:223], a[112:115], a[88:91], v[220:223]
s_waitcnt lgkmcnt(0)
v_mfma_f32_16x16x32_bf16 v[224:227], a[128:131], a[88:91], v[224:227]
ds_read_b128 a[96:99], v5 offset:38912
v_mfma_f32_16x16x32_bf16 v[224:227], a[132:135], a[92:95], v[224:227]
buffer_load_dwordx4 a[48:51], v2, s[40:43], s35 offen offset:2048 sc1
v_mfma_f32_16x16x32_bf16 v[200:203], a[132:135], a[84:87], v[200:203]
ds_read_b128 a[100:103], v5 offset:45056
v_mfma_f32_16x16x32_bf16 v[200:203], a[128:131], a[80:83], v[200:203]
v_mfma_f32_16x16x32_bf16 v[176:179], a[128:131], a[72:75], v[176:179]
v_mfma_f32_16x16x32_bf16 v[176:179], a[132:135], a[76:79], v[176:179]
buffer_load_dwordx4 a[52:55], v2, s[40:43], s33 offen offset:2048 sc1
v_mfma_f32_16x16x32_bf16 v[152:155], a[132:135], a[68:71], v[152:155]
ds_read_b128 a[104:107], v5 offset:39936
v_mfma_f32_16x16x32_bf16 v[152:155], a[128:131], a[64:67], v[152:155]
v_mfma_f32_16x16x32_bf16 v[132:135], a[136:139], a[64:67], v[132:135]
ds_read_b128 a[108:111], v5 offset:46080
v_mfma_f32_16x16x32_bf16 v[132:135], a[140:143], a[68:71], v[132:135]
v_mfma_f32_16x16x32_bf16 v[156:159], a[140:143], a[76:79], v[156:159]
buffer_load_dwordx4 v1, s[4:7], s44 offen offset:1024 sc1 lds
v_mfma_f32_16x16x32_bf16 v[156:159], a[136:139], a[72:75], v[156:159]
ds_read_b128 a[112:115], v5 offset:40960
v_mfma_f32_16x16x32_bf16 v[180:183], a[136:139], a[80:83], v[180:183]
v_mfma_f32_16x16x32_bf16 v[180:183], a[140:143], a[84:87], v[180:183]
ds_read_b128 a[116:119], v5 offset:47104
v_mfma_f32_16x16x32_bf16 v[204:207], a[140:143], a[92:95], v[204:207]
v_mfma_f32_16x16x32_bf16 v[204:207], a[136:139], a[88:91], v[204:207]
buffer_load_dwordx4 a[56:59], v2, s[40:43], s35 offen offset:3072 sc1
v_mfma_f32_16x16x32_bf16 v[208:211], a[144:147], a[88:91], v[208:211]
v_mfma_f32_16x16x32_bf16 v[208:211], a[148:151], a[92:95], v[208:211]
v_mfma_f32_16x16x32_bf16 v[184:187], a[148:151], a[84:87], v[184:187]
v_mfma_f32_16x16x32_bf16 v[184:187], a[144:147], a[80:83], v[184:187]
v_mfma_f32_16x16x32_bf16 v[160:163], a[144:147], a[72:75], v[160:163]
buffer_load_dwordx4 a[60:63], v2, s[40:43], s33 offen offset:3072 sc1
s_add_u32 s35, s35, 8192
v_mfma_f32_16x16x32_bf16 v[160:163], a[148:151], a[76:79], v[160:163]
s_add_u32 s33, s33, 8192
v_mfma_f32_16x16x32_bf16 v[136:139], a[148:151], a[68:71], v[136:139]
v_mfma_f32_16x16x32_bf16 v[136:139], a[144:147], a[64:67], v[136:139]
s_waitcnt vmcnt(10) lgkmcnt(0)
v_mfma_f32_16x16x32_bf16 v[140:143], a[96:99], a[0:3], v[140:143]
ds_read_b128 a[128:131], v5 offset:41984
v_mfma_f32_16x16x32_bf16 v[140:143], a[100:103], a[4:7], v[140:143]
buffer_load_dwordx4 a[64:67], v2, s[40:43], s35 offen offset:0 sc1
v_mfma_f32_16x16x32_bf16 v[164:167], a[100:103], a[12:15], v[164:167]
ds_read_b128 a[132:135], v5 offset:48128
v_mfma_f32_16x16x32_bf16 v[164:167], a[96:99], a[8:11], v[164:167]
v_mfma_f32_16x16x32_bf16 v[188:191], a[96:99], a[16:19], v[188:191]
v_mfma_f32_16x16x32_bf16 v[188:191], a[100:103], a[20:23], v[188:191]
buffer_load_dwordx4 a[68:71], v2, s[40:43], s33 offen offset:0 sc1
v_mfma_f32_16x16x32_bf16 v[212:215], a[100:103], a[28:31], v[212:215]
ds_read_b128 a[136:139], v5 offset:36864
v_mfma_f32_16x16x32_bf16 v[212:215], a[96:99], a[24:27], v[212:215]
v_mfma_f32_16x16x32_bf16 v[216:219], a[104:107], a[24:27], v[216:219]
ds_read_b128 a[140:143], v5 offset:43008
v_mfma_f32_16x16x32_bf16 v[216:219], a[108:111], a[28:31], v[216:219]
v_mfma_f32_16x16x32_bf16 v[192:195], a[108:111], a[20:23], v[192:195]
buffer_load_dwordx4 v1, s[4:7], s44 offen offset:2048 sc1 lds
s_add_u32 s88, s82, 0x240000
v_mfma_f32_16x16x32_bf16 v[192:195], a[104:107], a[16:19], v[192:195]
ds_read_b128 a[144:147], v5 offset:37888
v_mfma_f32_16x16x32_bf16 v[168:171], a[104:107], a[8:11], v[168:171]
v_mfma_f32_16x16x32_bf16 v[168:171], a[108:111], a[12:15], v[168:171]
ds_read_b128 a[148:151], v5 offset:44032
v_mfma_f32_16x16x32_bf16 v[144:147], a[108:111], a[4:7], v[144:147]
v_mfma_f32_16x16x32_bf16 v[144:147], a[104:107], a[0:3], v[144:147]
buffer_load_dwordx4 a[72:75], v2, s[40:43], s35 offen offset:1024 sc1
v_mfma_f32_16x16x32_bf16 v[148:151], a[112:115], a[0:3], v[148:151]
v_mfma_f32_16x16x32_bf16 v[148:151], a[116:119], a[4:7], v[148:151]
v_mfma_f32_16x16x32_bf16 v[172:175], a[116:119], a[12:15], v[172:175]
v_mfma_f32_16x16x32_bf16 v[172:175], a[112:115], a[8:11], v[172:175]
v_mfma_f32_16x16x32_bf16 v[196:199], a[112:115], a[16:19], v[196:199]
buffer_load_dwordx4 a[76:79], v2, s[40:43], s33 offen offset:1024 sc1
v_mfma_f32_16x16x32_bf16 v[196:199], a[116:119], a[20:23], v[196:199]
v_mfma_f32_16x16x32_bf16 v[220:223], a[116:119], a[28:31], v[220:223]
v_mfma_f32_16x16x32_bf16 v[220:223], a[112:115], a[24:27], v[220:223]
s_waitcnt lgkmcnt(0)
s_barrier
v_mfma_f32_16x16x32_bf16 v[224:227], a[128:131], a[24:27], v[224:227]
v_add_u32 v5, 49152, v1
v_mfma_f32_16x16x32_bf16 v[224:227], a[132:135], a[28:31], v[224:227]
buffer_load_dwordx4 a[80:83], v2, s[40:43], s35 offen offset:2048 sc1
v_mfma_f32_16x16x32_bf16 v[200:203], a[132:135], a[20:23], v[200:203]
ds_read_b128 a[96:99], v5 offset:2048
v_mfma_f32_16x16x32_bf16 v[200:203], a[128:131], a[16:19], v[200:203]
ds_read_b128 a[100:103], v5 offset:8192
v_mfma_f32_16x16x32_bf16 v[176:179], a[128:131], a[8:11], v[176:179]
v_mfma_f32_16x16x32_bf16 v[176:179], a[132:135], a[12:15], v[176:179]
buffer_load_dwordx4 a[84:87], v2, s[40:43], s33 offen offset:2048 sc1
v_mfma_f32_16x16x32_bf16 v[152:155], a[132:135], a[4:7], v[152:155]
ds_read_b128 a[104:107], v5 offset:3072
v_mfma_f32_16x16x32_bf16 v[152:155], a[128:131], a[0:3], v[152:155]
v_mfma_f32_16x16x32_bf16 v[132:135], a[136:139], a[0:3], v[132:135]
ds_read_b128 a[108:111], v5 offset:9216
v_mfma_f32_16x16x32_bf16 v[132:135], a[140:143], a[4:7], v[132:135]
v_mfma_f32_16x16x32_bf16 v[156:159], a[140:143], a[12:15], v[156:159]
buffer_load_dwordx4 v[92:95], v1, s[4:7], s88 offen offset:0 sc1
v_mfma_f32_16x16x32_bf16 v[156:159], a[136:139], a[8:11], v[156:159]
ds_read_b128 a[112:115], v5 offset:4096
v_mfma_f32_16x16x32_bf16 v[180:183], a[136:139], a[16:19], v[180:183]
v_mfma_f32_16x16x32_bf16 v[180:183], a[140:143], a[20:23], v[180:183]
ds_read_b128 a[116:119], v5 offset:10240
v_mfma_f32_16x16x32_bf16 v[204:207], a[140:143], a[28:31], v[204:207]
v_mfma_f32_16x16x32_bf16 v[204:207], a[136:139], a[24:27], v[204:207]
buffer_load_dwordx4 a[88:91], v2, s[40:43], s35 offen offset:3072 sc1
v_mfma_f32_16x16x32_bf16 v[208:211], a[144:147], a[24:27], v[208:211]
v_mfma_f32_16x16x32_bf16 v[208:211], a[148:151], a[28:31], v[208:211]
v_mfma_f32_16x16x32_bf16 v[184:187], a[148:151], a[20:23], v[184:187]
v_mfma_f32_16x16x32_bf16 v[184:187], a[144:147], a[16:19], v[184:187]
v_mfma_f32_16x16x32_bf16 v[160:163], a[144:147], a[8:11], v[160:163]
buffer_load_dwordx4 a[92:95], v2, s[40:43], s33 offen offset:3072 sc1
s_add_u32 s35, s35, 8192
v_mfma_f32_16x16x32_bf16 v[160:163], a[148:151], a[12:15], v[160:163]
s_add_u32 s33, s33, 8192
v_mfma_f32_16x16x32_bf16 v[136:139], a[148:151], a[4:7], v[136:139]
v_mfma_f32_16x16x32_bf16 v[136:139], a[144:147], a[0:3], v[136:139]
s_waitcnt vmcnt(10) lgkmcnt(0)
v_mfma_f32_16x16x32_bf16 v[140:143], a[96:99], a[32:35], v[140:143]
ds_read_b128 a[128:131], v5 offset:5120
v_mfma_f32_16x16x32_bf16 v[140:143], a[100:103], a[36:39], v[140:143]
buffer_load_dwordx4 a[0:3], v2, s[40:43], s35 offen offset:0 sc1
v_mfma_f32_16x16x32_bf16 v[164:167], a[100:103], a[44:47], v[164:167]
ds_read_b128 a[132:135], v5 offset:11264
v_mfma_f32_16x16x32_bf16 v[164:167], a[96:99], a[40:43], v[164:167]
v_mfma_f32_16x16x32_bf16 v[188:191], a[96:99], a[48:51], v[188:191]
v_mfma_f32_16x16x32_bf16 v[188:191], a[100:103], a[52:55], v[188:191]
buffer_load_dwordx4 a[4:7], v2, s[40:43], s33 offen offset:0 sc1
v_mfma_f32_16x16x32_bf16 v[212:215], a[100:103], a[60:63], v[212:215]
ds_read_b128 a[136:139], v5 offset:0
v_mfma_f32_16x16x32_bf16 v[212:215], a[96:99], a[56:59], v[212:215]
v_mfma_f32_16x16x32_bf16 v[216:219], a[104:107], a[56:59], v[216:219]
ds_read_b128 a[140:143], v5 offset:6144
v_mfma_f32_16x16x32_bf16 v[216:219], a[108:111], a[60:63], v[216:219]
v_mfma_f32_16x16x32_bf16 v[192:195], a[108:111], a[52:55], v[192:195]
buffer_load_dwordx4 v[96:99], v1, s[4:7], s88 offen offset:1024 sc1
v_mfma_f32_16x16x32_bf16 v[192:195], a[104:107], a[48:51], v[192:195]
ds_read_b128 a[144:147], v5 offset:1024
v_mfma_f32_16x16x32_bf16 v[168:171], a[104:107], a[40:43], v[168:171]
v_mfma_f32_16x16x32_bf16 v[168:171], a[108:111], a[44:47], v[168:171]
ds_read_b128 a[148:151], v5 offset:7168
v_mfma_f32_16x16x32_bf16 v[144:147], a[108:111], a[36:39], v[144:147]
v_mfma_f32_16x16x32_bf16 v[144:147], a[104:107], a[32:35], v[144:147]
buffer_load_dwordx4 a[8:11], v2, s[40:43], s35 offen offset:1024 sc1
v_mfma_f32_16x16x32_bf16 v[148:151], a[112:115], a[32:35], v[148:151]
v_mfma_f32_16x16x32_bf16 v[148:151], a[116:119], a[36:39], v[148:151]
v_mfma_f32_16x16x32_bf16 v[172:175], a[116:119], a[44:47], v[172:175]
v_mfma_f32_16x16x32_bf16 v[172:175], a[112:115], a[40:43], v[172:175]
v_mfma_f32_16x16x32_bf16 v[196:199], a[112:115], a[48:51], v[196:199]
buffer_load_dwordx4 a[12:15], v2, s[40:43], s33 offen offset:1024 sc1
v_mfma_f32_16x16x32_bf16 v[196:199], a[116:119], a[52:55], v[196:199]
v_mfma_f32_16x16x32_bf16 v[220:223], a[116:119], a[60:63], v[220:223]
v_mfma_f32_16x16x32_bf16 v[220:223], a[112:115], a[56:59], v[220:223]
s_waitcnt lgkmcnt(0)
v_mfma_f32_16x16x32_bf16 v[224:227], a[128:131], a[56:59], v[224:227]
ds_read_b128 a[96:99], v5 offset:14336
v_mfma_f32_16x16x32_bf16 v[224:227], a[132:135], a[60:63], v[224:227]
buffer_load_dwordx4 a[16:19], v2, s[40:43], s35 offen offset:2048 sc1
v_mfma_f32_16x16x32_bf16 v[200:203], a[132:135], a[52:55], v[200:203]
ds_read_b128 a[100:103], v5 offset:20480
v_mfma_f32_16x16x32_bf16 v[200:203], a[128:131], a[48:51], v[200:203]
v_mfma_f32_16x16x32_bf16 v[176:179], a[128:131], a[40:43], v[176:179]
v_mfma_f32_16x16x32_bf16 v[176:179], a[132:135], a[44:47], v[176:179]
buffer_load_dwordx4 v[100:103], v1, s[4:7], s88 offen offset:2048 sc1
v_mfma_f32_16x16x32_bf16 v[152:155], a[132:135], a[36:39], v[152:155]
ds_read_b128 a[104:107], v5 offset:15360
v_mfma_f32_16x16x32_bf16 v[152:155], a[128:131], a[32:35], v[152:155]
v_mfma_f32_16x16x32_bf16 v[132:135], a[136:139], a[32:35], v[132:135]
ds_read_b128 a[108:111], v5 offset:21504
v_mfma_f32_16x16x32_bf16 v[132:135], a[140:143], a[36:39], v[132:135]
buffer_load_dwordx4 a[20:23], v2, s[40:43], s33 offen offset:2048 sc1
v_mfma_f32_16x16x32_bf16 v[156:159], a[140:143], a[44:47], v[156:159]
ds_read_b128 a[112:115], v5 offset:16384
v_mfma_f32_16x16x32_bf16 v[156:159], a[136:139], a[40:43], v[156:159]
v_mfma_f32_16x16x32_bf16 v[180:183], a[136:139], a[48:51], v[180:183]
v_mfma_f32_16x16x32_bf16 v[180:183], a[140:143], a[52:55], v[180:183]
buffer_load_dwordx4 a[24:27], v2, s[40:43], s35 offen offset:3072 sc1
v_mfma_f32_16x16x32_bf16 v[204:207], a[140:143], a[60:63], v[204:207]
ds_read_b128 a[116:119], v5 offset:22528
v_mfma_f32_16x16x32_bf16 v[204:207], a[136:139], a[56:59], v[204:207]
v_mfma_f32_16x16x32_bf16 v[208:211], a[144:147], a[56:59], v[208:211]
v_mfma_f32_16x16x32_bf16 v[208:211], a[148:151], a[60:63], v[208:211]
buffer_load_dwordx4 v[104:107], v1, s[4:7], s88 offen offset:3072 sc1
s_add_u32 s88, s88, 4096
v_mfma_f32_16x16x32_bf16 v[184:187], a[148:151], a[52:55], v[184:187]
v_mfma_f32_16x16x32_bf16 v[184:187], a[144:147], a[48:51], v[184:187]
v_mfma_f32_16x16x32_bf16 v[160:163], a[144:147], a[40:43], v[160:163]
v_mfma_f32_16x16x32_bf16 v[160:163], a[148:151], a[44:47], v[160:163]
buffer_load_dwordx4 a[28:31], v2, s[40:43], s33 offen offset:3072 sc1
s_add_u32 s35, s35, 8192
L_stub5:
s_cbranch_execz L_stub6
v_mfma_f32_16x16x32_bf16 v[136:139], a[148:151], a[36:39], v[136:139]
s_add_u32 s33, s33, 8192
v_mfma_f32_16x16x32_bf16 v[136:139], a[144:147], a[32:35], v[136:139]
s_waitcnt vmcnt(11) lgkmcnt(0)
v_mfma_f32_16x16x32_bf16 v[140:143], a[96:99], a[64:67], v[140:143]
ds_read_b128 a[128:131], v5 offset:17408
v_mfma_f32_16x16x32_bf16 v[140:143], a[100:103], a[68:71], v[140:143]
buffer_load_dwordx4 a[32:35], v2, s[40:43], s35 offen offset:0 sc1
v_mfma_f32_16x16x32_bf16 v[164:167], a[100:103], a[76:79], v[164:167]
ds_read_b128 a[132:135], v5 offset:23552
v_mfma_f32_16x16x32_bf16 v[164:167], a[96:99], a[72:75], v[164:167]
v_mfma_f32_16x16x32_bf16 v[188:191], a[96:99], a[80:83], v[188:191]
v_mfma_f32_16x16x32_bf16 v[188:191], a[100:103], a[84:87], v[188:191]
buffer_load_dwordx4 a[36:39], v2, s[40:43], s33 offen offset:0 sc1
v_mfma_f32_16x16x32_bf16 v[212:215], a[100:103], a[92:95], v[212:215]
ds_read_b128 a[136:139], v5 offset:12288
v_mfma_f32_16x16x32_bf16 v[212:215], a[96:99], a[88:91], v[212:215]
v_mfma_f32_16x16x32_bf16 v[216:219], a[104:107], a[88:91], v[216:219]
ds_read_b128 a[140:143], v5 offset:18432
v_mfma_f32_16x16x32_bf16 v[216:219], a[108:111], a[92:95], v[216:219]
v_mfma_f32_16x16x32_bf16 v[192:195], a[108:111], a[84:87], v[192:195]
buffer_load_dwordx4 v[108:111], v1, s[4:7], s88 offen offset:0 sc1
v_mfma_f32_16x16x32_bf16 v[192:195], a[104:107], a[80:83], v[192:195]
ds_read_b128 a[144:147], v5 offset:13312
v_mfma_f32_16x16x32_bf16 v[168:171], a[104:107], a[72:75], v[168:171]
v_mfma_f32_16x16x32_bf16 v[168:171], a[108:111], a[76:79], v[168:171]
ds_read_b128 a[148:151], v5 offset:19456
v_mfma_f32_16x16x32_bf16 v[144:147], a[108:111], a[68:71], v[144:147]
v_mfma_f32_16x16x32_bf16 v[144:147], a[104:107], a[64:67], v[144:147]
buffer_load_dwordx4 a[40:43], v2, s[40:43], s35 offen offset:1024 sc1
v_mfma_f32_16x16x32_bf16 v[148:151], a[112:115], a[64:67], v[148:151]
v_mfma_f32_16x16x32_bf16 v[148:151], a[116:119], a[68:71], v[148:151]
v_mfma_f32_16x16x32_bf16 v[172:175], a[116:119], a[76:79], v[172:175]
v_mfma_f32_16x16x32_bf16 v[172:175], a[112:115], a[72:75], v[172:175]
v_mfma_f32_16x16x32_bf16 v[196:199], a[112:115], a[80:83], v[196:199]
buffer_load_dwordx4 a[44:47], v2, s[40:43], s33 offen offset:1024 sc1
v_mfma_f32_16x16x32_bf16 v[196:199], a[116:119], a[84:87], v[196:199]
v_mfma_f32_16x16x32_bf16 v[220:223], a[116:119], a[92:95], v[220:223]
v_mfma_f32_16x16x32_bf16 v[220:223], a[112:115], a[88:91], v[220:223]
s_waitcnt lgkmcnt(0)
v_mfma_f32_16x16x32_bf16 v[224:227], a[128:131], a[88:91], v[224:227]
ds_read_b128 a[96:99], v5 offset:26624
v_mfma_f32_16x16x32_bf16 v[224:227], a[132:135], a[92:95], v[224:227]
buffer_load_dwordx4 a[48:51], v2, s[40:43], s35 offen offset:2048 sc1
v_mfma_f32_16x16x32_bf16 v[200:203], a[132:135], a[84:87], v[200:203]
ds_read_b128 a[100:103], v5 offset:32768
v_mfma_f32_16x16x32_bf16 v[200:203], a[128:131], a[80:83], v[200:203]
v_mfma_f32_16x16x32_bf16 v[176:179], a[128:131], a[72:75], v[176:179]
v_mfma_f32_16x16x32_bf16 v[176:179], a[132:135], a[76:79], v[176:179]
buffer_load_dwordx4 a[52:55], v2, s[40:43], s33 offen offset:2048 sc1
v_mfma_f32_16x16x32_bf16 v[152:155], a[132:135], a[68:71], v[152:155]
ds_read_b128 a[104:107], v5 offset:27648
v_mfma_f32_16x16x32_bf16 v[152:155], a[128:131], a[64:67], v[152:155]
v_mfma_f32_16x16x32_bf16 v[132:135], a[136:139], a[64:67], v[132:135]
ds_read_b128 a[108:111], v5 offset:33792
v_mfma_f32_16x16x32_bf16 v[132:135], a[140:143], a[68:71], v[132:135]
v_mfma_f32_16x16x32_bf16 v[156:159], a[140:143], a[76:79], v[156:159]
buffer_load_dwordx4 v[112:115], v1, s[4:7], s88 offen offset:1024 sc1
v_mfma_f32_16x16x32_bf16 v[156:159], a[136:139], a[72:75], v[156:159]
ds_read_b128 a[112:115], v5 offset:28672
v_mfma_f32_16x16x32_bf16 v[180:183], a[136:139], a[80:83], v[180:183]
v_mfma_f32_16x16x32_bf16 v[180:183], a[140:143], a[84:87], v[180:183]
ds_read_b128 a[116:119], v5 offset:34816
v_mfma_f32_16x16x32_bf16 v[204:207], a[140:143], a[92:95], v[204:207]
v_mfma_f32_16x16x32_bf16 v[204:207], a[136:139], a[88:91], v[204:207]
buffer_load_dwordx4 a[56:59], v2, s[40:43], s35 offen offset:3072 sc1
v_mfma_f32_16x16x32_bf16 v[208:211], a[144:147], a[88:91], v[208:211]
v_mfma_f32_16x16x32_bf16 v[208:211], a[148:151], a[92:95], v[208:211]
v_mfma_f32_16x16x32_bf16 v[184:187], a[148:151], a[84:87], v[184:187]
v_mfma_f32_16x16x32_bf16 v[184:187], a[144:147], a[80:83], v[184:187]
v_mfma_f32_16x16x32_bf16 v[160:163], a[144:147], a[72:75], v[160:163]
buffer_load_dwordx4 a[60:63], v2, s[40:43], s33 offen offset:3072 sc1
s_add_u32 s35, s35, 8192
v_mfma_f32_16x16x32_bf16 v[160:163], a[148:151], a[76:79], v[160:163]
s_add_u32 s33, s33, 8192
v_mfma_f32_16x16x32_bf16 v[136:139], a[148:151], a[68:71], v[136:139]
v_mfma_f32_16x16x32_bf16 v[136:139], a[144:147], a[64:67], v[136:139]
s_waitcnt vmcnt(10) lgkmcnt(0)
v_mfma_f32_16x16x32_bf16 v[140:143], a[96:99], a[0:3], v[140:143]
ds_read_b128 a[128:131], v5 offset:29696
v_add_f32_dpp v48, v48, v48 row_ror:8 row_mask:0xf bank_mask:0xf
v_mfma_f32_16x16x32_bf16 v[140:143], a[100:103], a[4:7], v[140:143]
buffer_load_dwordx4 a[64:67], v2, s[40:43], s35 offen offset:0 sc1
v_mfma_f32_16x16x32_bf16 v[164:167], a[100:103], a[12:15], v[164:167]
ds_read_b128 a[132:135], v5 offset:35840
v_add_f32_dpp v49, v49, v49 row_ror:8 row_mask:0xf bank_mask:0xf
v_mfma_f32_16x16x32_bf16 v[164:167], a[96:99], a[8:11], v[164:167]
v_add_f32_dpp v50, v50, v50 row_ror:8 row_mask:0xf bank_mask:0xf
v_add_f32_dpp v51, v51, v51 row_ror:8 row_mask:0xf bank_mask:0xf
v_mfma_f32_16x16x32_bf16 v[188:191], a[96:99], a[16:19], v[188:191]
v_add_f32_dpp v52, v52, v52 row_ror:8 row_mask:0xf bank_mask:0xf
v_add_f32_dpp v53, v53, v53 row_ror:8 row_mask:0xf bank_mask:0xf
v_mfma_f32_16x16x32_bf16 v[188:191], a[100:103], a[20:23], v[188:191]
buffer_load_dwordx4 a[68:71], v2, s[40:43], s33 offen offset:0 sc1
v_mfma_f32_16x16x32_bf16 v[212:215], a[100:103], a[28:31], v[212:215]
ds_read_b128 a[136:139], v5 offset:24576
v_add_f32_dpp v54, v54, v54 row_ror:8 row_mask:0xf bank_mask:0xf
v_mfma_f32_16x16x32_bf16 v[212:215], a[96:99], a[24:27], v[212:215]
v_add_f32_dpp v55, v55, v55 row_ror:8 row_mask:0xf bank_mask:0xf
v_add_f32_dpp v48, v48, v48 row_ror:4 row_mask:0xf bank_mask:0xf
v_mfma_f32_16x16x32_bf16 v[216:219], a[104:107], a[24:27], v[216:219]
ds_read_b128 a[140:143], v5 offset:30720
v_add_f32_dpp v49, v49, v49 row_ror:4 row_mask:0xf bank_mask:0xf
v_mfma_f32_16x16x32_bf16 v[216:219], a[108:111], a[28:31], v[216:219]
v_add_f32_dpp v50, v50, v50 row_ror:4 row_mask:0xf bank_mask:0xf
v_mfma_f32_16x16x32_bf16 v[192:195], a[108:111], a[20:23], v[192:195]
buffer_load_dwordx4 v[116:119], v1, s[4:7], s88 offen offset:2048 sc1
v_mfma_f32_16x16x32_bf16 v[192:195], a[104:107], a[16:19], v[192:195]
ds_read_b128 a[144:147], v5 offset:25600
v_add_f32_dpp v51, v51, v51 row_ror:4 row_mask:0xf bank_mask:0xf
v_mfma_f32_16x16x32_bf16 v[168:171], a[104:107], a[8:11], v[168:171]
v_add_f32_dpp v52, v52, v52 row_ror:4 row_mask:0xf bank_mask:0xf
v_add_f32_dpp v53, v53, v53 row_ror:4 row_mask:0xf bank_mask:0xf
v_mfma_f32_16x16x32_bf16 v[168:171], a[108:111], a[12:15], v[168:171]
ds_read_b128 a[148:151], v5 offset:31744
v_add_f32_dpp v54, v54, v54 row_ror:4 row_mask:0xf bank_mask:0xf
v_mfma_f32_16x16x32_bf16 v[144:147], a[108:111], a[4:7], v[144:147]
v_add_f32_dpp v55, v55, v55 row_ror:4 row_mask:0xf bank_mask:0xf
v_mfma_f32_16x16x32_bf16 v[144:147], a[104:107], a[0:3], v[144:147]
buffer_load_dwordx4 a[72:75], v2, s[40:43], s35 offen offset:1024 sc1
v_mfma_f32_16x16x32_bf16 v[148:151], a[112:115], a[0:3], v[148:151]
v_add_f32_dpp v48, v48, v48 row_ror:2 row_mask:0xf bank_mask:0xf
v_add_f32_dpp v49, v49, v49 row_ror:2 row_mask:0xf bank_mask:0xf
v_mfma_f32_16x16x32_bf16 v[148:151], a[116:119], a[4:7], v[148:151]
v_add_f32_dpp v50, v50, v50 row_ror:2 row_mask:0xf bank_mask:0xf
v_mfma_f32_16x16x32_bf16 v[172:175], a[116:119], a[12:15], v[172:175]
v_add_f32_dpp v51, v51, v51 row_ror:2 row_mask:0xf bank_mask:0xf
v_mfma_f32_16x16x32_bf16 v[172:175], a[112:115], a[8:11], v[172:175]
v_add_f32_dpp v52, v52, v52 row_ror:2 row_mask:0xf bank_mask:0xf
v_mfma_f32_16x16x32_bf16 v[196:199], a[112:115], a[16:19], v[196:199]
buffer_load_dwordx4 a[76:79], v2, s[40:43], s33 offen offset:1024 sc1
v_mfma_f32_16x16x32_bf16 v[196:199], a[116:119], a[20:23], v[196:199]
v_add_f32_dpp v53, v53, v53 row_ror:2 row_mask:0xf bank_mask:0xf
v_add_f32_dpp v54, v54, v54 row_ror:2 row_mask:0xf bank_mask:0xf
v_mfma_f32_16x16x32_bf16 v[220:223], a[116:119], a[28:31], v[220:223]
v_add_f32_dpp v55, v55, v55 row_ror:2 row_mask:0xf bank_mask:0xf
v_mfma_f32_16x16x32_bf16 v[220:223], a[112:115], a[24:27], v[220:223]
v_add_f32_dpp v48, v48, v48 row_ror:1 row_mask:0xf bank_mask:0xf
s_waitcnt lgkmcnt(0)
v_mfma_f32_16x16x32_bf16 v[224:227], a[128:131], a[24:27], v[224:227]
ds_read_b128 a[96:99], v5 offset:38912
v_add_f32_dpp v49, v49, v49 row_ror:1 row_mask:0xf bank_mask:0xf
v_mfma_f32_16x16x32_bf16 v[224:227], a[132:135], a[28:31], v[224:227]
buffer_load_dwordx4 a[80:83], v2, s[40:43], s35 offen offset:2048 sc1
v_mfma_f32_16x16x32_bf16 v[200:203], a[132:135], a[20:23], v[200:203]
ds_read_b128 a[100:103], v5 offset:45056
v_add_f32_dpp v50, v50, v50 row_ror:1 row_mask:0xf bank_mask:0xf
v_mfma_f32_16x16x32_bf16 v[200:203], a[128:131], a[16:19], v[200:203]
v_add_f32_dpp v51, v51, v51 row_ror:1 row_mask:0xf bank_mask:0xf
v_add_f32_dpp v52, v52, v52 row_ror:1 row_mask:0xf bank_mask:0xf
v_mfma_f32_16x16x32_bf16 v[176:179], a[128:131], a[8:11], v[176:179]
v_add_f32_dpp v53, v53, v53 row_ror:1 row_mask:0xf bank_mask:0xf
v_add_f32_dpp v54, v54, v54 row_ror:1 row_mask:0xf bank_mask:0xf
v_mfma_f32_16x16x32_bf16 v[176:179], a[132:135], a[12:15], v[176:179]
buffer_load_dwordx4 a[84:87], v2, s[40:43], s33 offen offset:2048 sc1
v_mfma_f32_16x16x32_bf16 v[152:155], a[132:135], a[4:7], v[152:155]
ds_read_b128 a[104:107], v5 offset:39936
v_add_f32_dpp v55, v55, v55 row_ror:1 row_mask:0xf bank_mask:0xf
v_mfma_f32_16x16x32_bf16 v[152:155], a[128:131], a[0:3], v[152:155]
v_add_u32 v233, 159744, v233
s_lshl_b32 s36, s28, 6
v_mfma_f32_16x16x32_bf16 v[132:135], a[136:139], a[0:3], v[132:135]
ds_read_b128 a[108:111], v5 offset:46080
s_lshl_b32 s37, s39, 6
v_mfma_f32_16x16x32_bf16 v[132:135], a[140:143], a[4:7], v[132:135]
v_add_u32 v232, s36, v233
v_mfma_f32_16x16x32_bf16 v[156:159], a[140:143], a[12:15], v[156:159]
buffer_load_dwordx4 v[120:123], v1, s[4:7], s88 offen offset:3072 sc1
s_add_u32 m0, s18, 0x0
v_mfma_f32_16x16x32_bf16 v[156:159], a[136:139], a[8:11], v[156:159]
s_add_u32 s44, s50, 0x1424000
ds_read_b128 a[112:115], v5 offset:40960
v_mfma_f32_16x16x32_bf16 v[180:183], a[136:139], a[16:19], v[180:183]
v_add_u32 v235, s37, v233
v_mfma_f32_16x16x32_bf16 v[180:183], a[140:143], a[20:23], v[180:183]
ds_read_b128 a[116:119], v5 offset:47104
v_mfma_f32_16x16x32_bf16 v[204:207], a[140:143], a[28:31], v[204:207]
v_mfma_f32_16x16x32_bf16 v[204:207], a[136:139], a[24:27], v[204:207]
buffer_load_dwordx4 a[88:91], v2, s[40:43], s35 offen offset:3072 sc1
v_mfma_f32_16x16x32_bf16 v[208:211], a[144:147], a[24:27], v[208:211]
v_mfma_f32_16x16x32_bf16 v[208:211], a[148:151], a[28:31], v[208:211]
v_mfma_f32_16x16x32_bf16 v[184:187], a[148:151], a[20:23], v[184:187]
v_mfma_f32_16x16x32_bf16 v[184:187], a[144:147], a[16:19], v[184:187]
v_mfma_f32_16x16x32_bf16 v[160:163], a[144:147], a[8:11], v[160:163]
buffer_load_dwordx4 a[92:95], v2, s[40:43], s33 offen offset:3072 sc1
s_add_u32 s35, s35, 8192
v_mfma_f32_16x16x32_bf16 v[160:163], a[148:151], a[12:15], v[160:163]
s_add_u32 s33, s33, 8192
v_mfma_f32_16x16x32_bf16 v[136:139], a[148:151], a[4:7], v[136:139]
v_mfma_f32_16x16x32_bf16 v[136:139], a[144:147], a[0:3], v[136:139]
s_waitcnt vmcnt(10) lgkmcnt(0)
v_mfma_f32_16x16x32_bf16 v[140:143], a[96:99], a[32:35], v[140:143]
ds_read_b128 a[128:131], v5 offset:41984
v_mfma_f32_16x16x32_bf16 v[140:143], a[100:103], a[36:39], v[140:143]
buffer_load_dwordx4 a[0:3], v2, s[40:43], s35 offen offset:0 sc1
v_mfma_f32_16x16x32_bf16 v[164:167], a[100:103], a[44:47], v[164:167]
ds_read_b128 a[132:135], v5 offset:48128
v_mfma_f32_16x16x32_bf16 v[164:167], a[96:99], a[40:43], v[164:167]
ds_write_b128 v232, v[48:51]
v_mfma_f32_16x16x32_bf16 v[188:191], a[96:99], a[48:51], v[188:191]
ds_write_b128 v235, v[52:55]
v_mfma_f32_16x16x32_bf16 v[188:191], a[100:103], a[52:55], v[188:191]
buffer_load_dwordx4 v1, s[4:7], s44 offen offset:0 sc1 lds
v_mfma_f32_16x16x32_bf16 v[212:215], a[100:103], a[60:63], v[212:215]
ds_read_b128 a[136:139], v5 offset:36864
v_mfma_f32_16x16x32_bf16 v[212:215], a[96:99], a[56:59], v[212:215]
v_mfma_f32_16x16x32_bf16 v[216:219], a[104:107], a[56:59], v[216:219]
ds_read_b128 a[140:143], v5 offset:43008
v_mfma_f32_16x16x32_bf16 v[216:219], a[108:111], a[60:63], v[216:219]
buffer_load_dwordx4 a[4:7], v2, s[40:43], s33 offen offset:0 sc1
v_mfma_f32_16x16x32_bf16 v[192:195], a[108:111], a[52:55], v[192:195]
ds_read_b128 a[144:147], v5 offset:37888
v_mfma_f32_16x16x32_bf16 v[192:195], a[104:107], a[48:51], v[192:195]
v_mfma_f32_16x16x32_bf16 v[168:171], a[104:107], a[40:43], v[168:171]
v_mfma_f32_16x16x32_bf16 v[168:171], a[108:111], a[44:47], v[168:171]
buffer_load_dwordx4 a[8:11], v2, s[40:43], s35 offen offset:1024 sc1
v_mfma_f32_16x16x32_bf16 v[144:147], a[108:111], a[36:39], v[144:147]
ds_read_b128 a[148:151], v5 offset:44032
v_mfma_f32_16x16x32_bf16 v[144:147], a[104:107], a[32:35], v[144:147]
v_mfma_f32_16x16x32_bf16 v[148:151], a[112:115], a[32:35], v[148:151]
v_mfma_f32_16x16x32_bf16 v[148:151], a[116:119], a[36:39], v[148:151]
buffer_load_dwordx4 v1, s[4:7], s44 offen offset:1024 sc1 lds
v_mfma_f32_16x16x32_bf16 v[172:175], a[116:119], a[44:47], v[172:175]
v_mfma_f32_16x16x32_bf16 v[172:175], a[112:115], a[40:43], v[172:175]
v_mfma_f32_16x16x32_bf16 v[196:199], a[112:115], a[48:51], v[196:199]
v_mfma_f32_16x16x32_bf16 v[196:199], a[116:119], a[52:55], v[196:199]
buffer_load_dwordx4 a[12:15], v2, s[40:43], s33 offen offset:1024 sc1
v_mfma_f32_16x16x32_bf16 v[220:223], a[116:119], a[60:63], v[220:223]
v_mfma_f32_16x16x32_bf16 v[220:223], a[112:115], a[56:59], v[220:223]
s_waitcnt lgkmcnt(0)
s_barrier
v_mfma_f32_16x16x32_bf16 v[224:227], a[128:131], a[56:59], v[224:227]
v_add_u32 v5, 98304, v1
v_mfma_f32_16x16x32_bf16 v[224:227], a[132:135], a[60:63], v[224:227]
buffer_load_dwordx4 a[16:19], v2, s[40:43], s35 offen offset:2048 sc1
v_mfma_f32_16x16x32_bf16 v[200:203], a[132:135], a[52:55], v[200:203]
ds_read_b128 a[96:99], v5 offset:2048
v_mfma_f32_16x16x32_bf16 v[200:203], a[128:131], a[48:51], v[200:203]
ds_read_b128 a[100:103], v5 offset:8192
v_mfma_f32_16x16x32_bf16 v[176:179], a[128:131], a[40:43], v[176:179]
ds_read_b128 v[48:51], v233 offset:0
v_mfma_f32_16x16x32_bf16 v[176:179], a[132:135], a[44:47], v[176:179]
buffer_load_dwordx4 a[20:23], v2, s[40:43], s33 offen offset:2048 sc1
v_mfma_f32_16x16x32_bf16 v[152:155], a[132:135], a[36:39], v[152:155]
ds_read_b128 a[104:107], v5 offset:3072
v_mfma_f32_16x16x32_bf16 v[152:155], a[128:131], a[32:35], v[152:155]
v_mfma_f32_16x16x32_bf16 v[132:135], a[136:139], a[32:35], v[132:135]
ds_read_b128 a[108:111], v5 offset:9216
v_mfma_f32_16x16x32_bf16 v[132:135], a[140:143], a[36:39], v[132:135]
v_mfma_f32_16x16x32_bf16 v[156:159], a[140:143], a[44:47], v[156:159]
buffer_load_dwordx4 v1, s[4:7], s44 offen offset:2048 sc1 lds
s_add_u32 m0, s18, 0x3000
v_mfma_f32_16x16x32_bf16 v[156:159], a[136:139], a[40:43], v[156:159]
s_add_u32 s44, s50, 0x1427000
ds_read_b128 a[112:115], v5 offset:4096
v_mfma_f32_16x16x32_bf16 v[180:183], a[136:139], a[48:51], v[180:183]
ds_read_b128 v[52:55], v233 offset:64
v_mfma_f32_16x16x32_bf16 v[180:183], a[140:143], a[52:55], v[180:183]
ds_read_b128 a[116:119], v5 offset:10240
v_mfma_f32_16x16x32_bf16 v[204:207], a[140:143], a[60:63], v[204:207]
v_mfma_f32_16x16x32_bf16 v[204:207], a[136:139], a[56:59], v[204:207]
buffer_load_dwordx4 a[24:27], v2, s[40:43], s35 offen offset:3072 sc1
v_mfma_f32_16x16x32_bf16 v[208:211], a[144:147], a[56:59], v[208:211]
v_mfma_f32_16x16x32_bf16 v[208:211], a[148:151], a[60:63], v[208:211]
v_mfma_f32_16x16x32_bf16 v[184:187], a[148:151], a[52:55], v[184:187]
v_mfma_f32_16x16x32_bf16 v[184:187], a[144:147], a[48:51], v[184:187]
v_mfma_f32_16x16x32_bf16 v[160:163], a[144:147], a[40:43], v[160:163]
buffer_load_dwordx4 a[28:31], v2, s[40:43], s33 offen offset:3072 sc1
s_add_u32 s35, s35, 8192
v_mfma_f32_16x16x32_bf16 v[160:163], a[148:151], a[44:47], v[160:163]
s_add_u32 s33, s33, 8192
ds_read_b128 v[56:59], v233 offset:128
v_mfma_f32_16x16x32_bf16 v[136:139], a[148:151], a[36:39], v[136:139]
v_mfma_f32_16x16x32_bf16 v[136:139], a[144:147], a[32:35], v[136:139]
s_waitcnt vmcnt(11) lgkmcnt(1)
v_mfma_f32_16x16x32_bf16 v[140:143], a[96:99], a[64:67], v[140:143]
ds_read_b128 a[128:131], v5 offset:5120
v_mfma_f32_16x16x32_bf16 v[140:143], a[100:103], a[68:71], v[140:143]
buffer_load_dwordx4 a[32:35], v2, s[40:43], s35 offen offset:0 sc1
v_mfma_f32_16x16x32_bf16 v[164:167], a[100:103], a[76:79], v[164:167]
ds_read_b128 a[132:135], v5 offset:11264
v_mfma_f32_16x16x32_bf16 v[164:167], a[96:99], a[72:75], v[164:167]
v_mfma_f32_16x16x32_bf16 v[188:191], a[96:99], a[80:83], v[188:191]
v_mfma_f32_16x16x32_bf16 v[188:191], a[100:103], a[84:87], v[188:191]
buffer_load_dwordx4 a[36:39], v2, s[40:43], s33 offen offset:0 sc1
v_mfma_f32_16x16x32_bf16 v[212:215], a[100:103], a[92:95], v[212:215]
ds_read_b128 a[136:139], v5 offset:0
v_mfma_f32_16x16x32_bf16 v[212:215], a[96:99], a[88:91], v[212:215]
v_mfma_f32_16x16x32_bf16 v[216:219], a[104:107], a[88:91], v[216:219]
ds_read_b128 a[140:143], v5 offset:6144
v_mfma_f32_16x16x32_bf16 v[216:219], a[108:111], a[92:95], v[216:219]
ds_read_b128 v[60:63], v233 offset:192
v_mfma_f32_16x16x32_bf16 v[192:195], a[108:111], a[84:87], v[192:195]
buffer_load_dwordx4 v1, s[4:7], s44 offen offset:0 sc1 lds
v_mfma_f32_16x16x32_bf16 v[192:195], a[104:107], a[80:83], v[192:195]
ds_read_b128 a[144:147], v5 offset:1024
v_mfma_f32_16x16x32_bf16 v[168:171], a[104:107], a[72:75], v[168:171]
v_mfma_f32_16x16x32_bf16 v[168:171], a[108:111], a[76:79], v[168:171]
ds_read_b128 a[148:151], v5 offset:7168
v_mfma_f32_16x16x32_bf16 v[144:147], a[108:111], a[68:71], v[144:147]
v_mfma_f32_16x16x32_bf16 v[144:147], a[104:107], a[64:67], v[144:147]
buffer_load_dwordx4 a[40:43], v2, s[40:43], s35 offen offset:1024 sc1
v_mfma_f32_16x16x32_bf16 v[148:151], a[112:115], a[64:67], v[148:151]
v_mfma_f32_16x16x32_bf16 v[148:151], a[116:119], a[68:71], v[148:151]
v_mfma_f32_16x16x32_bf16 v[172:175], a[116:119], a[76:79], v[172:175]
ds_read_b128 v[64:67], v233 offset:256
v_mfma_f32_16x16x32_bf16 v[172:175], a[112:115], a[72:75], v[172:175]
v_mfma_f32_16x16x32_bf16 v[196:199], a[112:115], a[80:83], v[196:199]
buffer_load_dwordx4 a[44:47], v2, s[40:43], s33 offen offset:1024 sc1
v_mfma_f32_16x16x32_bf16 v[196:199], a[116:119], a[84:87], v[196:199]
v_mfma_f32_16x16x32_bf16 v[220:223], a[116:119], a[92:95], v[220:223]
v_mfma_f32_16x16x32_bf16 v[220:223], a[112:115], a[88:91], v[220:223]
s_waitcnt lgkmcnt(1)
v_mfma_f32_16x16x32_bf16 v[224:227], a[128:131], a[88:91], v[224:227]
ds_read_b128 a[96:99], v5 offset:14336
v_mfma_f32_16x16x32_bf16 v[224:227], a[132:135], a[92:95], v[224:227]
buffer_load_dwordx4 a[48:51], v2, s[40:43], s35 offen offset:2048 sc1
v_mfma_f32_16x16x32_bf16 v[200:203], a[132:135], a[84:87], v[200:203]
ds_read_b128 a[100:103], v5 offset:20480
v_mfma_f32_16x16x32_bf16 v[200:203], a[128:131], a[80:83], v[200:203]
v_mfma_f32_16x16x32_bf16 v[176:179], a[128:131], a[72:75], v[176:179]
v_mfma_f32_16x16x32_bf16 v[176:179], a[132:135], a[76:79], v[176:179]
buffer_load_dwordx4 a[52:55], v2, s[40:43], s33 offen offset:2048 sc1
v_mfma_f32_16x16x32_bf16 v[152:155], a[132:135], a[68:71], v[152:155]
ds_read_b128 a[104:107], v5 offset:15360
v_mfma_f32_16x16x32_bf16 v[152:155], a[128:131], a[64:67], v[152:155]
ds_read_b128 v[68:71], v233 offset:320
v_mfma_f32_16x16x32_bf16 v[132:135], a[136:139], a[64:67], v[132:135]
ds_read_b128 a[108:111], v5 offset:21504
v_mfma_f32_16x16x32_bf16 v[132:135], a[140:143], a[68:71], v[132:135]
v_mfma_f32_16x16x32_bf16 v[156:159], a[140:143], a[76:79], v[156:159]
buffer_load_dwordx4 v1, s[4:7], s44 offen offset:1024 sc1 lds
v_mfma_f32_16x16x32_bf16 v[156:159], a[136:139], a[72:75], v[156:159]
ds_read_b128 a[112:115], v5 offset:16384
v_mfma_f32_16x16x32_bf16 v[180:183], a[136:139], a[80:83], v[180:183]
v_mfma_f32_16x16x32_bf16 v[180:183], a[140:143], a[84:87], v[180:183]
ds_read_b128 a[116:119], v5 offset:22528
v_mfma_f32_16x16x32_bf16 v[204:207], a[140:143], a[92:95], v[204:207]
v_mfma_f32_16x16x32_bf16 v[204:207], a[136:139], a[88:91], v[204:207]
buffer_load_dwordx4 a[56:59], v2, s[40:43], s35 offen offset:3072 sc1
v_mfma_f32_16x16x32_bf16 v[208:211], a[144:147], a[88:91], v[208:211]
v_mfma_f32_16x16x32_bf16 v[208:211], a[148:151], a[92:95], v[208:211]
v_mfma_f32_16x16x32_bf16 v[184:187], a[148:151], a[84:87], v[184:187]
v_mfma_f32_16x16x32_bf16 v[184:187], a[144:147], a[80:83], v[184:187]
v_mfma_f32_16x16x32_bf16 v[160:163], a[144:147], a[72:75], v[160:163]
buffer_load_dwordx4 a[60:63], v2, s[40:43], s33 offen offset:3072 sc1
s_add_u32 s35, s35, 8192
v_mfma_f32_16x16x32_bf16 v[160:163], a[148:151], a[76:79], v[160:163]
s_add_u32 s33, s33, 8192
v_mfma_f32_16x16x32_bf16 v[136:139], a[148:151], a[68:71], v[136:139]
v_mfma_f32_16x16x32_bf16 v[136:139], a[144:147], a[64:67], v[136:139]
s_waitcnt vmcnt(10) lgkmcnt(0)
v_mfma_f32_16x16x32_bf16 v[140:143], a[96:99], a[0:3], v[140:143]
ds_read_b128 a[128:131], v5 offset:17408
v_add_f32 v92, v92, v96
v_mfma_f32_16x16x32_bf16 v[140:143], a[100:103], a[4:7], v[140:143]
buffer_load_dwordx4 a[64:67], v2, s[40:43], s35 offen offset:0 sc1
v_mfma_f32_16x16x32_bf16 v[164:167], a[100:103], a[12:15], v[164:167]
ds_read_b128 a[132:135], v5 offset:23552
v_add_f32 v100, v100, v104
v_mfma_f32_16x16x32_bf16 v[164:167], a[96:99], a[8:11], v[164:167]
v_add_f32 v108, v108, v112
v_add_f32 v116, v116, v120
v_mfma_f32_16x16x32_bf16 v[188:191], a[96:99], a[16:19], v[188:191]
v_add_f32 v93, v93, v97
v_add_f32 v101, v101, v105
v_mfma_f32_16x16x32_bf16 v[188:191], a[100:103], a[20:23], v[188:191]
buffer_load_dwordx4 a[68:71], v2, s[40:43], s33 offen offset:0 sc1
v_mfma_f32_16x16x32_bf16 v[212:215], a[100:103], a[28:31], v[212:215]
ds_read_b128 a[136:139], v5 offset:12288
v_add_f32 v109, v109, v113
v_mfma_f32_16x16x32_bf16 v[212:215], a[96:99], a[24:27], v[212:215]
v_add_f32 v117, v117, v121
v_add_f32 v94, v94, v98
v_mfma_f32_16x16x32_bf16 v[216:219], a[104:107], a[24:27], v[216:219]
ds_read_b128 a[140:143], v5 offset:18432
v_add_f32 v102, v102, v106
v_mfma_f32_16x16x32_bf16 v[216:219], a[108:111], a[28:31], v[216:219]
v_add_f32 v110, v110, v114
v_mfma_f32_16x16x32_bf16 v[192:195], a[108:111], a[20:23], v[192:195]
buffer_load_dwordx4 v1, s[4:7], s44 offen offset:2048 sc1 lds
s_add_u32 m0, s18, 0x6000
v_mfma_f32_16x16x32_bf16 v[192:195], a[104:107], a[16:19], v[192:195]
s_add_u32 s44, s50, 0x142a000
ds_read_b128 a[144:147], v5 offset:13312
v_mfma_f32_16x16x32_bf16 v[168:171], a[104:107], a[8:11], v[168:171]
v_add_f32 v118, v118, v122
v_add_f32 v95, v95, v99
v_mfma_f32_16x16x32_bf16 v[168:171], a[108:111], a[12:15], v[168:171]
ds_read_b128 a[148:151], v5 offset:19456
v_add_f32 v103, v103, v107
v_mfma_f32_16x16x32_bf16 v[144:147], a[108:111], a[4:7], v[144:147]
v_add_f32 v111, v111, v115
v_add_f32 v119, v119, v123
v_mfma_f32_16x16x32_bf16 v[144:147], a[104:107], a[0:3], v[144:147]
buffer_load_dwordx4 a[72:75], v2, s[40:43], s35 offen offset:1024 sc1
v_mfma_f32_16x16x32_bf16 v[148:151], a[112:115], a[0:3], v[148:151]
v_add_f32_dpp v92, v92, v92 row_ror:8 row_mask:0xf bank_mask:0xf
v_add_f32_dpp v100, v100, v100 row_ror:8 row_mask:0xf bank_mask:0xf
v_mfma_f32_16x16x32_bf16 v[148:151], a[116:119], a[4:7], v[148:151]
v_add_f32_dpp v108, v108, v108 row_ror:8 row_mask:0xf bank_mask:0xf
v_mfma_f32_16x16x32_bf16 v[172:175], a[116:119], a[12:15], v[172:175]
v_add_f32_dpp v116, v116, v116 row_ror:8 row_mask:0xf bank_mask:0xf
v_mfma_f32_16x16x32_bf16 v[172:175], a[112:115], a[8:11], v[172:175]
v_add_f32_dpp v93, v93, v93 row_ror:8 row_mask:0xf bank_mask:0xf
v_mfma_f32_16x16x32_bf16 v[196:199], a[112:115], a[16:19], v[196:199]
buffer_load_dwordx4 a[76:79], v2, s[40:43], s33 offen offset:1024 sc1
v_mfma_f32_16x16x32_bf16 v[196:199], a[116:119], a[20:23], v[196:199]
v_add_f32_dpp v101, v101, v101 row_ror:8 row_mask:0xf bank_mask:0xf
v_add_f32_dpp v109, v109, v109 row_ror:8 row_mask:0xf bank_mask:0xf
v_mfma_f32_16x16x32_bf16 v[220:223], a[116:119], a[28:31], v[220:223]
v_add_f32_dpp v117, v117, v117 row_ror:8 row_mask:0xf bank_mask:0xf
v_mfma_f32_16x16x32_bf16 v[220:223], a[112:115], a[24:27], v[220:223]
v_add_f32_dpp v92, v94, v94 row_ror:8 row_mask:0xf bank_mask:0xc
s_waitcnt lgkmcnt(0)
v_mfma_f32_16x16x32_bf16 v[224:227], a[128:131], a[24:27], v[224:227]
ds_read_b128 a[96:99], v5 offset:26624
v_accvgpr_write_b32 a216, v48
v_mfma_f32_16x16x32_bf16 v[224:227], a[132:135], a[28:31], v[224:227]
buffer_load_dwordx4 a[80:83], v2, s[40:43], s35 offen offset:2048 sc1
v_mfma_f32_16x16x32_bf16 v[200:203], a[132:135], a[20:23], v[200:203]
ds_read_b128 a[100:103], v5 offset:32768
v_add_f32_dpp v100, v102, v102 row_ror:8 row_mask:0xf bank_mask:0xc
v_mfma_f32_16x16x32_bf16 v[200:203], a[128:131], a[16:19], v[200:203]
v_accvgpr_write_b32 a217, v49
v_add_f32_dpp v108, v110, v110 row_ror:8 row_mask:0xf bank_mask:0xc
v_mfma_f32_16x16x32_bf16 v[176:179], a[128:131], a[8:11], v[176:179]
v_add_f32_dpp v116, v118, v118 row_ror:8 row_mask:0xf bank_mask:0xc
v_add_f32_dpp v93, v95, v95 row_ror:8 row_mask:0xf bank_mask:0xc
v_mfma_f32_16x16x32_bf16 v[176:179], a[132:135], a[12:15], v[176:179]
buffer_load_dwordx4 v1, s[4:7], s44 offen offset:0 sc1 lds
v_mfma_f32_16x16x32_bf16 v[152:155], a[132:135], a[4:7], v[152:155]
ds_read_b128 a[104:107], v5 offset:27648
v_accvgpr_write_b32 a218, v50
v_mfma_f32_16x16x32_bf16 v[152:155], a[128:131], a[0:3], v[152:155]
v_add_f32_dpp v101, v103, v103 row_ror:8 row_mask:0xf bank_mask:0xc
v_add_f32_dpp v109, v111, v111 row_ror:8 row_mask:0xf bank_mask:0xc
v_mfma_f32_16x16x32_bf16 v[132:135], a[136:139], a[0:3], v[132:135]
ds_read_b128 a[108:111], v5 offset:33792
v_add_f32_dpp v117, v119, v119 row_ror:8 row_mask:0xf bank_mask:0xc
v_mfma_f32_16x16x32_bf16 v[132:135], a[140:143], a[4:7], v[132:135]
buffer_load_dwordx4 a[84:87], v2, s[40:43], s33 offen offset:2048 sc1
v_mfma_f32_16x16x32_bf16 v[156:159], a[140:143], a[12:15], v[156:159]
ds_read_b128 a[112:115], v5 offset:28672
v_accvgpr_write_b32 a219, v51
v_mfma_f32_16x16x32_bf16 v[156:159], a[136:139], a[8:11], v[156:159]
v_permlane32_swap_b32 v92, v93
v_mfma_f32_16x16x32_bf16 v[180:183], a[136:139], a[16:19], v[180:183]
v_accvgpr_write_b32 a220, v52
v_mfma_f32_16x16x32_bf16 v[180:183], a[140:143], a[20:23], v[180:183]
buffer_load_dwordx4 a[88:91], v2, s[40:43], s35 offen offset:3072 sc1
v_mfma_f32_16x16x32_bf16 v[204:207], a[140:143], a[28:31], v[204:207]
ds_read_b128 a[116:119], v5 offset:34816
v_mfma_f32_16x16x32_bf16 v[204:207], a[136:139], a[24:27], v[204:207]
v_accvgpr_write_b32 a221, v53
v_mfma_f32_16x16x32_bf16 v[208:211], a[144:147], a[24:27], v[208:211]
v_permlane32_swap_b32 v100, v101
v_mfma_f32_16x16x32_bf16 v[208:211], a[148:151], a[28:31], v[208:211]
buffer_load_dwordx4 v1, s[4:7], s44 offen offset:1024 sc1 lds
v_mfma_f32_16x16x32_bf16 v[184:187], a[148:151], a[20:23], v[184:187]
v_accvgpr_write_b32 a222, v54
v_mfma_f32_16x16x32_bf16 v[184:187], a[144:147], a[16:19], v[184:187]
v_permlane32_swap_b32 v108, v109
v_mfma_f32_16x16x32_bf16 v[160:163], a[144:147], a[8:11], v[160:163]
v_permlane32_swap_b32 v116, v117
v_mfma_f32_16x16x32_bf16 v[160:163], a[148:151], a[12:15], v[160:163]
buffer_load_dwordx4 a[92:95], v2, s[40:43], s33 offen offset:3072 sc1
s_add_u32 s35, s35, 8192
v_mfma_f32_16x16x32_bf16 v[136:139], a[148:151], a[4:7], v[136:139]
s_add_u32 s33, s33, 8192
v_accvgpr_write_b32 a223, v55
v_mfma_f32_16x16x32_bf16 v[136:139], a[144:147], a[0:3], v[136:139]
v_add_f32 v92, v92, v93
s_waitcnt vmcnt(11) lgkmcnt(0)
v_mfma_f32_16x16x32_bf16 v[140:143], a[96:99], a[32:35], v[140:143]
ds_read_b128 a[128:131], v5 offset:29696
v_accvgpr_write_b32 a224, v56
v_mfma_f32_16x16x32_bf16 v[140:143], a[100:103], a[36:39], v[140:143]
buffer_load_dwordx4 a[0:3], v2, s[40:43], s35 offen offset:0 sc1
v_mfma_f32_16x16x32_bf16 v[164:167], a[100:103], a[44:47], v[164:167]
ds_read_b128 a[132:135], v5 offset:35840
v_add_f32 v100, v100, v101
v_mfma_f32_16x16x32_bf16 v[164:167], a[96:99], a[40:43], v[164:167]
v_accvgpr_write_b32 a225, v57
v_add_f32 v108, v108, v109
v_mfma_f32_16x16x32_bf16 v[188:191], a[96:99], a[48:51], v[188:191]
v_add_f32 v116, v116, v117
v_mov_b32 v94, v92
v_mfma_f32_16x16x32_bf16 v[188:191], a[100:103], a[52:55], v[188:191]
buffer_load_dwordx4 a[4:7], v2, s[40:43], s33 offen offset:0 sc1
v_mfma_f32_16x16x32_bf16 v[212:215], a[100:103], a[60:63], v[212:215]
ds_read_b128 a[136:139], v5 offset:24576
v_accvgpr_write_b32 a226, v58
v_mfma_f32_16x16x32_bf16 v[212:215], a[96:99], a[56:59], v[212:215]
v_mov_b32 v102, v100
v_mov_b32 v110, v108
v_mfma_f32_16x16x32_bf16 v[216:219], a[104:107], a[56:59], v[216:219]
ds_read_b128 a[140:143], v5 offset:30720
v_mov_b32 v118, v116
v_mfma_f32_16x16x32_bf16 v[216:219], a[108:111], a[60:63], v[216:219]
v_accvgpr_write_b32 a227, v59
v_mfma_f32_16x16x32_bf16 v[192:195], a[108:111], a[52:55], v[192:195]
buffer_load_dwordx4 v1, s[4:7], s44 offen offset:2048 sc1 lds
s_add_u32 m0, s18, 0x9000
v_mfma_f32_16x16x32_bf16 v[192:195], a[104:107], a[48:51], v[192:195]
s_add_u32 s44, s50, 0x142d000
ds_read_b128 a[144:147], v5 offset:25600
v_mfma_f32_16x16x32_bf16 v[168:171], a[104:107], a[40:43], v[168:171]
v_accvgpr_write_b32 a228, v60
v_mfma_f32_16x16x32_bf16 v[168:171], a[108:111], a[44:47], v[168:171]
ds_read_b128 a[148:151], v5 offset:31744
v_mfma_f32_16x16x32_bf16 v[144:147], a[108:111], a[36:39], v[144:147]
v_permlane16_swap_b32 v92, v94
v_mfma_f32_16x16x32_bf16 v[144:147], a[104:107], a[32:35], v[144:147]
buffer_load_dwordx4 a[8:11], v2, s[40:43], s35 offen offset:1024 sc1
v_mfma_f32_16x16x32_bf16 v[148:151], a[112:115], a[32:35], v[148:151]
v_accvgpr_write_b32 a229, v61
v_mfma_f32_16x16x32_bf16 v[148:151], a[116:119], a[36:39], v[148:151]
v_permlane16_swap_b32 v100, v102
v_mfma_f32_16x16x32_bf16 v[172:175], a[116:119], a[44:47], v[172:175]
v_accvgpr_write_b32 a230, v62
v_mfma_f32_16x16x32_bf16 v[172:175], a[112:115], a[40:43], v[172:175]
v_permlane16_swap_b32 v108, v110
v_mfma_f32_16x16x32_bf16 v[196:199], a[112:115], a[48:51], v[196:199]
buffer_load_dwordx4 a[12:15], v2, s[40:43], s33 offen offset:1024 sc1
v_mfma_f32_16x16x32_bf16 v[196:199], a[116:119], a[52:55], v[196:199]
v_accvgpr_write_b32 a231, v63
v_mfma_f32_16x16x32_bf16 v[220:223], a[116:119], a[60:63], v[220:223]
v_permlane16_swap_b32 v116, v118
v_mfma_f32_16x16x32_bf16 v[220:223], a[112:115], a[56:59], v[220:223]
v_add_f32 v92, v92, v94
s_waitcnt lgkmcnt(0)
v_mfma_f32_16x16x32_bf16 v[224:227], a[128:131], a[56:59], v[224:227]
ds_read_b128 a[96:99], v5 offset:38912
v_accvgpr_write_b32 a232, v64
v_mfma_f32_16x16x32_bf16 v[224:227], a[132:135], a[60:63], v[224:227]
buffer_load_dwordx4 a[16:19], v2, s[40:43], s35 offen offset:2048 sc1
L_stub6:
s_cbranch_execz L_stub7
v_mfma_f32_16x16x32_bf16 v[200:203], a[132:135], a[52:55], v[200:203]
ds_read_b128 a[100:103], v5 offset:45056
v_add_f32 v100, v100, v102
v_mfma_f32_16x16x32_bf16 v[200:203], a[128:131], a[48:51], v[200:203]
v_accvgpr_write_b32 a233, v65
v_add_f32 v108, v108, v110
v_mfma_f32_16x16x32_bf16 v[176:179], a[128:131], a[40:43], v[176:179]
v_add_f32 v116, v116, v118
v_mov_b32 v94, v92
v_mfma_f32_16x16x32_bf16 v[176:179], a[132:135], a[44:47], v[176:179]
buffer_load_dwordx4 a[20:23], v2, s[40:43], s33 offen offset:2048 sc1
v_mfma_f32_16x16x32_bf16 v[152:155], a[132:135], a[36:39], v[152:155]
ds_read_b128 a[104:107], v5 offset:39936
v_accvgpr_write_b32 a234, v66
v_mfma_f32_16x16x32_bf16 v[152:155], a[128:131], a[32:35], v[152:155]
v_mov_b32 v102, v100
v_mov_b32 v110, v108
v_mfma_f32_16x16x32_bf16 v[132:135], a[136:139], a[32:35], v[132:135]
ds_read_b128 a[108:111], v5 offset:46080
v_mov_b32 v118, v116
v_mfma_f32_16x16x32_bf16 v[132:135], a[140:143], a[36:39], v[132:135]
v_accvgpr_write_b32 a235, v67
v_mfma_f32_16x16x32_bf16 v[156:159], a[140:143], a[44:47], v[156:159]
buffer_load_dwordx4 v1, s[4:7], s44 offen offset:0 sc1 lds
v_mfma_f32_16x16x32_bf16 v[156:159], a[136:139], a[40:43], v[156:159]
ds_read_b128 a[112:115], v5 offset:40960
v_mfma_f32_16x16x32_bf16 v[180:183], a[136:139], a[48:51], v[180:183]
v_accvgpr_write_b32 a236, v68
v_mfma_f32_16x16x32_bf16 v[180:183], a[140:143], a[52:55], v[180:183]
ds_read_b128 a[116:119], v5 offset:47104
v_mfma_f32_16x16x32_bf16 v[204:207], a[140:143], a[60:63], v[204:207]
v_permlane32_swap_b32 v92, v94
v_mfma_f32_16x16x32_bf16 v[204:207], a[136:139], a[56:59], v[204:207]
buffer_load_dwordx4 a[24:27], v2, s[40:43], s35 offen offset:3072 sc1
v_mfma_f32_16x16x32_bf16 v[208:211], a[144:147], a[56:59], v[208:211]
v_accvgpr_write_b32 a237, v69
v_mfma_f32_16x16x32_bf16 v[208:211], a[148:151], a[60:63], v[208:211]
v_permlane32_swap_b32 v100, v102
v_mfma_f32_16x16x32_bf16 v[184:187], a[148:151], a[52:55], v[184:187]
v_accvgpr_write_b32 a238, v70
v_mfma_f32_16x16x32_bf16 v[184:187], a[144:147], a[48:51], v[184:187]
v_permlane32_swap_b32 v108, v110
v_mfma_f32_16x16x32_bf16 v[160:163], a[144:147], a[40:43], v[160:163]
buffer_load_dwordx4 a[28:31], v2, s[40:43], s33 offen offset:3072 sc1
s_add_u32 s35, s35, 8192
v_mfma_f32_16x16x32_bf16 v[160:163], a[148:151], a[44:47], v[160:163]
s_add_u32 s33, s33, 8192
v_accvgpr_write_b32 a239, v71
v_mfma_f32_16x16x32_bf16 v[136:139], a[148:151], a[36:39], v[136:139]
v_permlane32_swap_b32 v116, v118
v_mfma_f32_16x16x32_bf16 v[136:139], a[144:147], a[32:35], v[136:139]
v_mul_f32 v82, 0xba800000, v92
s_waitcnt vmcnt(10) lgkmcnt(0)
v_mfma_f32_16x16x32_bf16 v[140:143], a[96:99], a[64:67], v[140:143]
ds_read_b128 a[128:131], v5 offset:41984
v_mul_f32 v84, 0xba800000, v100
v_mfma_f32_16x16x32_bf16 v[140:143], a[100:103], a[68:71], v[140:143]
buffer_load_dwordx4 a[32:35], v2, s[40:43], s35 offen offset:0 sc1
v_mfma_f32_16x16x32_bf16 v[164:167], a[100:103], a[76:79], v[164:167]
ds_read_b128 a[132:135], v5 offset:48128
v_mul_f32 v86, 0xba800000, v108
v_mfma_f32_16x16x32_bf16 v[164:167], a[96:99], a[72:75], v[164:167]
v_mul_f32 v88, 0xba800000, v116
v_mul_f32 v94, 0x3a800000, v94
v_mfma_f32_16x16x32_bf16 v[188:191], a[96:99], a[80:83], v[188:191]
v_mul_f32 v102, 0x3a800000, v102
v_mul_f32 v110, 0x3a800000, v110
v_mfma_f32_16x16x32_bf16 v[188:191], a[100:103], a[84:87], v[188:191]
buffer_load_dwordx4 a[36:39], v2, s[40:43], s33 offen offset:0 sc1
v_mfma_f32_16x16x32_bf16 v[212:215], a[100:103], a[92:95], v[212:215]
ds_read_b128 a[136:139], v5 offset:36864
v_mul_f32 v118, 0x3a800000, v118
v_mfma_f32_16x16x32_bf16 v[212:215], a[96:99], a[88:91], v[212:215]
v_fma_f32 v94, -v82, v82, v94
v_fma_f32 v102, -v84, v84, v102
v_fma_f32 v110, -v86, v86, v110
v_fma_f32 v118, -v88, v88, v118
v_max_f32 v94, 0, v94
v_max_f32 v102, 0, v102
v_max_f32 v110, 0, v110
v_max_f32 v118, 0, v118
v_add_f32 v94, 0x3727c5ac, v94
v_add_f32 v102, 0x3727c5ac, v102
v_add_f32 v110, 0x3727c5ac, v110
v_add_f32 v118, 0x3727c5ac, v118
v_rsq_f32 v83, v94
v_rsq_f32 v85, v102
v_rsq_f32 v87, v110
v_rsq_f32 v89, v118
v_mfma_f32_16x16x32_bf16 v[216:219], a[104:107], a[88:91], v[216:219]
ds_read_b128 a[140:143], v5 offset:43008
v_mfma_f32_16x16x32_bf16 v[216:219], a[108:111], a[92:95], v[216:219]
v_mfma_f32_16x16x32_bf16 v[192:195], a[108:111], a[84:87], v[192:195]
buffer_load_dwordx4 v1, s[4:7], s44 offen offset:1024 sc1 lds
v_mfma_f32_16x16x32_bf16 v[192:195], a[104:107], a[80:83], v[192:195]
ds_read_b128 a[144:147], v5 offset:37888
v_fmac_f32 v140, v56, v82
v_mfma_f32_16x16x32_bf16 v[168:171], a[104:107], a[72:75], v[168:171]
v_fmac_f32 v164, v56, v84
v_mfma_f32_16x16x32_bf16 v[168:171], a[108:111], a[76:79], v[168:171]
ds_read_b128 a[148:151], v5 offset:44032
v_mfma_f32_16x16x32_bf16 v[144:147], a[108:111], a[68:71], v[144:147]
v_fmac_f32 v188, v56, v86
v_mfma_f32_16x16x32_bf16 v[144:147], a[104:107], a[64:67], v[144:147]
buffer_load_dwordx4 a[40:43], v2, s[40:43], s35 offen offset:1024 sc1
v_mfma_f32_16x16x32_bf16 v[148:151], a[112:115], a[64:67], v[148:151]
v_fmac_f32 v212, v56, v88
v_mfma_f32_16x16x32_bf16 v[148:151], a[116:119], a[68:71], v[148:151]
v_mfma_f32_16x16x32_bf16 v[172:175], a[116:119], a[76:79], v[172:175]
v_fmac_f32 v216, v60, v88
v_mfma_f32_16x16x32_bf16 v[172:175], a[112:115], a[72:75], v[172:175]
v_mfma_f32_16x16x32_bf16 v[196:199], a[112:115], a[80:83], v[196:199]
buffer_load_dwordx4 a[44:47], v2, s[40:43], s33 offen offset:1024 sc1
v_mfma_f32_16x16x32_bf16 v[196:199], a[116:119], a[84:87], v[196:199]
v_fmac_f32 v192, v60, v86
v_mfma_f32_16x16x32_bf16 v[220:223], a[116:119], a[92:95], v[220:223]
v_fmac_f32 v168, v60, v84
v_fmac_f32 v141, v57, v82
v_mfma_f32_16x16x32_bf16 v[220:223], a[112:115], a[88:91], v[220:223]
s_waitcnt lgkmcnt(0)
s_barrier
v_mfma_f32_16x16x32_bf16 v[224:227], a[128:131], a[88:91], v[224:227]
v_add_u32 v5, 0, v1
v_fmac_f32 v144, v60, v82
v_mfma_f32_16x16x32_bf16 v[224:227], a[132:135], a[92:95], v[224:227]
buffer_load_dwordx4 a[48:51], v2, s[40:43], s35 offen offset:2048 sc1
v_mfma_f32_16x16x32_bf16 v[200:203], a[132:135], a[84:87], v[200:203]
ds_read_b128 a[96:99], v5 offset:2048
v_fmac_f32 v148, v64, v82
v_mfma_f32_16x16x32_bf16 v[200:203], a[128:131], a[80:83], v[200:203]
ds_read_b128 a[100:103], v5 offset:8192
v_fmac_f32 v165, v57, v84
v_mfma_f32_16x16x32_bf16 v[176:179], a[128:131], a[72:75], v[176:179]
v_fmac_f32 v172, v64, v84
v_fmac_f32 v189, v57, v86
v_mfma_f32_16x16x32_bf16 v[176:179], a[132:135], a[76:79], v[176:179]
buffer_load_dwordx4 a[52:55], v2, s[40:43], s33 offen offset:2048 sc1
v_mfma_f32_16x16x32_bf16 v[152:155], a[132:135], a[68:71], v[152:155]
ds_read_b128 a[104:107], v5 offset:3072
v_fmac_f32 v196, v64, v86
v_mfma_f32_16x16x32_bf16 v[152:155], a[128:131], a[64:67], v[152:155]
v_fmac_f32 v213, v57, v88
v_fmac_f32 v217, v61, v88
v_mfma_f32_16x16x32_bf16 v[132:135], a[136:139], a[64:67], v[132:135]
ds_read_b128 a[108:111], v5 offset:9216
v_fmac_f32 v220, v64, v88
v_mfma_f32_16x16x32_bf16 v[132:135], a[140:143], a[68:71], v[132:135]
v_fmac_f32 v193, v61, v86
v_mfma_f32_16x16x32_bf16 v[156:159], a[140:143], a[76:79], v[156:159]
buffer_load_dwordx4 v1, s[4:7], s44 offen offset:2048 sc1 lds
s_add_u32 m0, s19, 49152
v_mfma_f32_16x16x32_bf16 v[156:159], a[136:139], a[72:75], v[156:159]
s_add_u32 s44, s85, 0xc04000
ds_read_b128 a[112:115], v5 offset:4096
v_mfma_f32_16x16x32_bf16 v[180:183], a[136:139], a[80:83], v[180:183]
v_fmac_f32 v224, v68, v88
v_fmac_f32 v200, v68, v86
v_mfma_f32_16x16x32_bf16 v[180:183], a[140:143], a[84:87], v[180:183]
ds_read_b128 a[116:119], v5 offset:10240
v_fmac_f32 v169, v61, v84
v_mfma_f32_16x16x32_bf16 v[204:207], a[140:143], a[92:95], v[204:207]
v_fmac_f32 v176, v68, v84
v_fmac_f32 v145, v61, v82
v_mfma_f32_16x16x32_bf16 v[204:207], a[136:139], a[88:91], v[204:207]
buffer_load_dwordx4 a[56:59], v2, s[40:43], s35 offen offset:3072 sc1
v_mfma_f32_16x16x32_bf16 v[208:211], a[144:147], a[88:91], v[208:211]
v_fmac_f32 v152, v68, v82
v_fmac_f32 v149, v65, v82
v_mfma_f32_16x16x32_bf16 v[208:211], a[148:151], a[92:95], v[208:211]
v_fmac_f32 v173, v65, v84
v_mfma_f32_16x16x32_bf16 v[184:187], a[148:151], a[84:87], v[184:187]
v_fmac_f32 v132, v48, v82
v_fmac_f32 v197, v65, v86
v_mfma_f32_16x16x32_bf16 v[184:187], a[144:147], a[80:83], v[184:187]
v_mfma_f32_16x16x32_bf16 v[160:163], a[144:147], a[72:75], v[160:163]
buffer_load_dwordx4 a[60:63], v2, s[40:43], s33 offen offset:3072 sc1
s_add_u32 s35, s35, 8192
v_mfma_f32_16x16x32_bf16 v[160:163], a[148:151], a[76:79], v[160:163]
s_add_u32 s33, s33, 8192
v_fmac_f32 v156, v48, v84
v_mfma_f32_16x16x32_bf16 v[136:139], a[148:151], a[68:71], v[136:139]
v_fmac_f32 v180, v48, v86
v_fmac_f32 v221, v65, v88
v_mfma_f32_16x16x32_bf16 v[136:139], a[144:147], a[64:67], v[136:139]
v_fmac_f32 v225, v69, v88
s_waitcnt vmcnt(10) lgkmcnt(0)
v_mfma_f32_16x16x32_bf16 v[140:143], a[96:99], a[0:3], v[140:143]
ds_read_b128 a[128:131], v5 offset:5120
v_fmac_f32 v204, v48, v88
v_mfma_f32_16x16x32_bf16 v[140:143], a[100:103], a[4:7], v[140:143]
buffer_load_dwordx4 a[64:67], v2, s[40:43], s35 offen offset:0 sc1
s_lshl_b32 s36, s28, 9
v_mfma_f32_16x16x32_bf16 v[164:167], a[100:103], a[12:15], v[164:167]
ds_read_b128 a[132:135], v5 offset:11264
v_fmac_f32 v208, v52, v88
v_mfma_f32_16x16x32_bf16 v[164:167], a[96:99], a[8:11], v[164:167]
v_fmac_f32 v201, v69, v86
v_fmac_f32 v177, v69, v84
v_mfma_f32_16x16x32_bf16 v[188:191], a[96:99], a[16:19], v[188:191]
v_fmac_f32 v184, v52, v86
v_fmac_f32 v153, v69, v82
v_mfma_f32_16x16x32_bf16 v[188:191], a[100:103], a[20:23], v[188:191]
buffer_load_dwordx4 a[68:71], v2, s[40:43], s33 offen offset:0 sc1
s_lshl_b32 s37, s30, 2
v_mfma_f32_16x16x32_bf16 v[212:215], a[100:103], a[28:31], v[212:215]
ds_read_b128 a[136:139], v5 offset:0
v_fmac_f32 v160, v52, v84
v_mfma_f32_16x16x32_bf16 v[212:215], a[96:99], a[24:27], v[212:215]
v_fmac_f32 v133, v49, v82
v_add_u32 v232, s19, v7
v_mfma_f32_16x16x32_bf16 v[216:219], a[104:107], a[24:27], v[216:219]
ds_read_b128 a[140:143], v5 offset:6144
v_fmac_f32 v136, v52, v82
v_mfma_f32_16x16x32_bf16 v[216:219], a[108:111], a[28:31], v[216:219]
buffer_load_dwordx4 a[72:75], v2, s[40:43], s35 offen offset:1024 sc1
s_add_u32 s37, s37, s28
v_mfma_f32_16x16x32_bf16 v[192:195], a[108:111], a[20:23], v[192:195]
ds_read_b128 a[144:147], v5 offset:1024
v_fmac_f32 v157, v49, v84
v_mfma_f32_16x16x32_bf16 v[192:195], a[104:107], a[16:19], v[192:195]
v_fmac_f32 v181, v49, v86
v_fmac_f32 v142, v58, v82
v_mfma_f32_16x16x32_bf16 v[168:171], a[104:107], a[8:11], v[168:171]
v_fmac_f32 v205, v49, v88
v_fmac_f32 v166, v58, v84
v_mfma_f32_16x16x32_bf16 v[168:171], a[108:111], a[12:15], v[168:171]
buffer_load_dwordx4 a[76:79], v2, s[40:43], s33 offen offset:1024 sc1
s_lshl_b32 s98, s37, 13
v_mfma_f32_16x16x32_bf16 v[144:147], a[108:111], a[4:7], v[144:147]
ds_read_b128 a[148:151], v5 offset:7168
v_fmac_f32 v209, v53, v88
v_mfma_f32_16x16x32_bf16 v[144:147], a[104:107], a[0:3], v[144:147]
v_fmac_f32 v190, v58, v86
s_add_u32 s98, s98, 0x400000
v_mfma_f32_16x16x32_bf16 v[148:151], a[112:115], a[0:3], v[148:151]
v_fmac_f32 v185, v53, v86
v_fmac_f32 v214, v58, v88
v_mfma_f32_16x16x32_bf16 v[148:151], a[116:119], a[4:7], v[148:151]
buffer_load_dwordx4 a[80:83], v2, s[40:43], s35 offen offset:2048 sc1
s_add_u32 s99, s98, 4096
v_mfma_f32_16x16x32_bf16 v[172:175], a[116:119], a[12:15], v[172:175]
v_fmac_f32 v161, v53, v84
v_fmac_f32 v218, v62, v88
v_mfma_f32_16x16x32_bf16 v[172:175], a[112:115], a[8:11], v[172:175]
s_lshl_b32 s100, s37, 10
s_add_u32 s100, s100, 0x800000
s_lshl_b32 s96, s29, 10
v_mfma_f32_16x16x32_bf16 v[196:199], a[112:115], a[16:19], v[196:199]
v_fmac_f32 v137, v53, v82
v_fmac_f32 v194, v62, v86
v_mfma_f32_16x16x32_bf16 v[196:199], a[116:119], a[20:23], v[196:199]
buffer_load_dwordx4 a[84:87], v2, s[40:43], s33 offen offset:2048 sc1
s_add_u32 s96, s96, s98
v_mfma_f32_16x16x32_bf16 v[220:223], a[116:119], a[28:31], v[220:223]
v_fmac_f32 v170, v62, v84
v_fmac_f32 v143, v59, v82
v_mfma_f32_16x16x32_bf16 v[220:223], a[112:115], a[24:27], v[220:223]
s_lshl_b32 s97, s29, 7
s_waitcnt lgkmcnt(0)
v_mfma_f32_16x16x32_bf16 v[224:227], a[128:131], a[24:27], v[224:227]
ds_read_b128 a[96:99], v5 offset:14336
v_fmac_f32 v146, v62, v82
v_mfma_f32_16x16x32_bf16 v[224:227], a[132:135], a[28:31], v[224:227]
buffer_load_dwordx4 a[88:91], v2, s[40:43], s35 offen offset:3072 sc1
s_add_u32 s97, s97, s100
v_mfma_f32_16x16x32_bf16 v[200:203], a[132:135], a[20:23], v[200:203]
ds_read_b128 a[100:103], v5 offset:20480
v_fmac_f32 v150, v66, v82
v_mfma_f32_16x16x32_bf16 v[200:203], a[128:131], a[16:19], v[200:203]
v_fmac_f32 v167, v59, v84
v_fmac_f32 v191, v59, v86
v_mfma_f32_16x16x32_bf16 v[176:179], a[128:131], a[8:11], v[176:179]
v_fmac_f32 v174, v66, v84
v_fmac_f32 v215, v59, v88
v_mfma_f32_16x16x32_bf16 v[176:179], a[132:135], a[12:15], v[176:179]
ds_read_b128 a[104:107], v5 offset:15360
s_lshl_b32 s88, s28, 6
v_mfma_f32_16x16x32_bf16 v[152:155], a[132:135], a[4:7], v[152:155]
v_fmac_f32 v198, v66, v86
v_fmac_f32 v219, v63, v88
v_mfma_f32_16x16x32_bf16 v[152:155], a[128:131], a[0:3], v[152:155]
buffer_load_dwordx4 v1, s[4:7], s44 offen offset:0 sc1 lds
s_add_u32 s94, s80, s88
v_mfma_f32_16x16x32_bf16 v[132:135], a[136:139], a[0:3], v[132:135]
ds_read_b128 a[108:111], v5 offset:21504
v_fmac_f32 v222, v66, v88
v_mfma_f32_16x16x32_bf16 v[132:135], a[140:143], a[4:7], v[132:135]
v_fmac_f32 v195, v63, v86
s_add_u32 s94, s94, 0x80000
v_mfma_f32_16x16x32_bf16 v[156:159], a[140:143], a[12:15], v[156:159]
ds_read_b128 a[112:115], v5 offset:16384
v_fmac_f32 v226, v70, v88
v_mfma_f32_16x16x32_bf16 v[156:159], a[136:139], a[8:11], v[156:159]
v_fmac_f32 v171, v63, v84
s_add_u32 s88, s88, s70
v_mfma_f32_16x16x32_bf16 v[180:183], a[136:139], a[16:19], v[180:183]
v_fmac_f32 v202, v70, v86
v_fmac_f32 v147, v63, v82
v_mfma_f32_16x16x32_bf16 v[180:183], a[140:143], a[20:23], v[180:183]
buffer_load_dwordx4 a[92:95], v2, s[40:43], s33 offen offset:3072 sc1
s_add_u32 s35, s35, 8192
v_mfma_f32_16x16x32_bf16 v[204:207], a[140:143], a[28:31], v[204:207]
s_add_u32 s33, s33, 8192
ds_read_b128 a[116:119], v5 offset:22528
v_mfma_f32_16x16x32_bf16 v[204:207], a[136:139], a[24:27], v[204:207]
v_fmac_f32 v178, v70, v84
v_fmac_f32 v151, v67, v82
v_mfma_f32_16x16x32_bf16 v[208:211], a[144:147], a[24:27], v[208:211]
v_fmac_f32 v154, v70, v82
v_fmac_f32 v175, v67, v84
v_mfma_f32_16x16x32_bf16 v[208:211], a[148:151], a[28:31], v[208:211]
s_add_u32 s89, s88, 0x80000
s_add_u32 s74, s71, 0x10080
s_lshl_b32 s73, s30, 12
v_mfma_f32_16x16x32_bf16 v[184:187], a[148:151], a[20:23], v[184:187]
v_fmac_f32 v134, v50, v82
v_fmac_f32 v199, v67, v86
v_mfma_f32_16x16x32_bf16 v[184:187], a[144:147], a[16:19], v[184:187]
buffer_load_dwordx4 v1, s[4:7], s44 offen offset:1024 sc1 lds
s_add_u32 s72, s73, 0x2600000
v_mfma_f32_16x16x32_bf16 v[160:163], a[144:147], a[8:11], v[160:163]
v_fmac_f32 v158, v50, v84
v_fmac_f32 v223, v67, v88
v_mfma_f32_16x16x32_bf16 v[160:163], a[148:151], a[12:15], v[160:163]
v_add_u32 v233, s19, v232
s_add_u32 s73, s73, 0x1e00000
v_mfma_f32_16x16x32_bf16 v[136:139], a[148:151], a[4:7], v[136:139]
v_fmac_f32 v182, v50, v86
v_fmac_f32 v227, v71, v88
v_mfma_f32_16x16x32_bf16 v[136:139], a[144:147], a[0:3], v[136:139]
s_waitcnt vmcnt(10) lgkmcnt(0)
s_barrier
v_mfma_f32_16x16x32_bf16 v[140:143], a[96:99], a[32:35], v[140:143]
ds_read_b128 a[128:131], v5 offset:17408
v_fmac_f32 v206, v50, v88
v_mfma_f32_16x16x32_bf16 v[140:143], a[100:103], a[36:39], v[140:143]
buffer_load_dwordx4 a[0:3], v2, s[40:43], s35 offen offset:0 sc1
s_lshr_b32 s38, s28, 1
v_mfma_f32_16x16x32_bf16 v[164:167], a[100:103], a[44:47], v[164:167]
ds_read_b128 a[132:135], v5 offset:23552
v_fmac_f32 v210, v54, v88
v_mfma_f32_16x16x32_bf16 v[164:167], a[96:99], a[40:43], v[164:167]
v_fmac_f32 v203, v71, v86
v_fmac_f32 v179, v71, v84
v_mfma_f32_16x16x32_bf16 v[188:191], a[96:99], a[48:51], v[188:191]
buffer_load_dwordx4 a[4:7], v2, s[40:43], s33 offen offset:0 sc1
s_and_b32 s39, s28, 1
v_mfma_f32_16x16x32_bf16 v[188:191], a[100:103], a[52:55], v[188:191]
ds_read_b128 a[136:139], v5 offset:26624
v_fmac_f32 v186, v54, v86
v_mfma_f32_16x16x32_bf16 v[212:215], a[100:103], a[60:63], v[212:215]
v_fmac_f32 v162, v54, v84
v_fmac_f32 v155, v71, v82
v_mfma_f32_16x16x32_bf16 v[212:215], a[96:99], a[56:59], v[212:215]
buffer_load_dwordx4 a[8:11], v2, s[40:43], s35 offen offset:1024 sc1
s_mul_i32 s38, s38, 3072
v_mfma_f32_16x16x32_bf16 v[216:219], a[104:107], a[56:59], v[216:219]
ds_read_b128 a[140:143], v5 offset:32768
v_fmac_f32 v138, v54, v82
v_mfma_f32_16x16x32_bf16 v[216:219], a[108:111], a[60:63], v[216:219]
v_fmac_f32 v135, v51, v82
v_fmac_f32 v159, v51, v84
v_mfma_f32_16x16x32_bf16 v[192:195], a[108:111], a[52:55], v[192:195]
buffer_load_dwordx4 a[12:15], v2, s[40:43], s33 offen offset:1024 sc1
s_lshl_b32 s39, s39, 3
v_mfma_f32_16x16x32_bf16 v[192:195], a[104:107], a[48:51], v[192:195]
ds_read_b128 a[144:147], v5 offset:27648
v_fmac_f32 v183, v51, v86
v_mfma_f32_16x16x32_bf16 v[168:171], a[104:107], a[40:43], v[168:171]
v_fmac_f32 v207, v51, v88
s_add_u32 s38, s38, s39
v_mfma_f32_16x16x32_bf16 v[168:171], a[108:111], a[44:47], v[168:171]
buffer_load_dwordx4 a[16:19], v2, s[40:43], s35 offen offset:2048 sc1
v_mfma_f32_16x16x32_bf16 v[144:147], a[108:111], a[36:39], v[144:147]
ds_read_b128 a[148:151], v5 offset:33792
v_fmac_f32 v211, v55, v88
v_mfma_f32_16x16x32_bf16 v[144:147], a[104:107], a[32:35], v[144:147]
v_mul_f32 v88, 0x3fb8aa3b, v89
v_and_b32 v248, 7, v0
v_mfma_f32_16x16x32_bf16 v[148:151], a[112:115], a[32:35], v[148:151]
buffer_load_dwordx4 a[20:23], v2, s[40:43], s33 offen offset:2048 sc1
v_mfma_f32_16x16x32_bf16 v[148:151], a[116:119], a[36:39], v[148:151]
v_fmac_f32 v187, v55, v86
v_lshlrev_b32 v248, 7, v248
v_mfma_f32_16x16x32_bf16 v[172:175], a[116:119], a[44:47], v[172:175]
v_fmac_f32 v163, v55, v84
v_mul_f32 v86, 0x3fb8aa3b, v87
v_mfma_f32_16x16x32_bf16 v[172:175], a[112:115], a[40:43], v[172:175]
buffer_load_dwordx4 a[24:27], v2, s[40:43], s35 offen offset:3072 sc1
v_mfma_f32_16x16x32_bf16 v[196:199], a[112:115], a[48:51], v[196:199]
v_fmac_f32 v139, v55, v82
v_mul_f32 v84, 0x3fb8aa3b, v85
v_mfma_f32_16x16x32_bf16 v[196:199], a[116:119], a[52:55], v[196:199]
v_mul_f32 v82, 0x3fb8aa3b, v83
v_lshrrev_b32 v249, 4, v0
v_mfma_f32_16x16x32_bf16 v[220:223], a[116:119], a[60:63], v[220:223]
buffer_load_dwordx4 a[28:31], v2, s[40:43], s33 offen offset:3072 sc1
s_add_u32 s35, s35, 8192
v_mfma_f32_16x16x32_bf16 v[220:223], a[112:115], a[56:59], v[220:223]
s_add_u32 s33, s33, 8192
s_waitcnt lgkmcnt(0)
v_mfma_f32_16x16x32_bf16 v[224:227], a[128:131], a[56:59], v[224:227]
ds_read_b128 a[96:99], v5 offset:28672
v_lshlrev_b32 v235, 8, v0
v_mfma_f32_16x16x32_bf16 v[224:227], a[132:135], a[60:63], v[224:227]
buffer_load_dwordx4 v1, s[4:7], s44 offen offset:2048 sc1 lds
v_mfma_f32_16x16x32_bf16 v[200:203], a[132:135], a[52:55], v[200:203]
ds_read_b128 a[100:103], v5 offset:34816
v_lshl_add_u32 v248, v249, 4, v248
v_mfma_f32_16x16x32_bf16 v[200:203], a[128:131], a[48:51], v[200:203]
v_add_u32 v234, s36, v8
v_cndmask_b32 v235, 2.0, v235, s[64:65]
v_mfma_f32_16x16x32_bf16 v[176:179], a[128:131], a[40:43], v[176:179]
v_mov_b32 v249, 0x3f80
v_mov_b32 v250, 1.0
v_mfma_f32_16x16x32_bf16 v[176:179], a[132:135], a[44:47], v[176:179]
ds_read_b128 a[104:107], v5 offset:29696
v_add_u32 v252, s38, v1
v_mfma_f32_16x16x32_bf16 v[152:155], a[132:135], a[36:39], v[152:155]
v_mfma_f32_16x16x32_bf16 v[152:155], a[128:131], a[32:35], v[152:155]
s_waitcnt vmcnt(18)
v_mfma_f32_16x16x32_bf16 v[140:143], a[136:139], a[64:67], v[140:143]
ds_read_b128 a[108:111], v5 offset:35840
s_waitcnt vmcnt(17)
v_mfma_f32_16x16x32_bf16 v[140:143], a[140:143], a[68:71], v[140:143]
s_waitcnt vmcnt(15)
v_mfma_f32_16x16x32_bf16 v[164:167], a[140:143], a[76:79], v[164:167]
ds_read_b128 a[112:115], v5 offset:38912
v_mfma_f32_16x16x32_bf16 v[164:167], a[136:139], a[72:75], v[164:167]
s_waitcnt vmcnt(14)
v_mfma_f32_16x16x32_bf16 v[188:191], a[136:139], a[80:83], v[188:191]
s_waitcnt vmcnt(13)
v_mfma_f32_16x16x32_bf16 v[188:191], a[140:143], a[84:87], v[188:191]
buffer_load_dwordx4 v1, s[4:7], s44 offen offset:3072 sc1 lds
s_add_u32 m0, s19, 65536
s_waitcnt vmcnt(11)
v_mfma_f32_16x16x32_bf16 v[212:215], a[140:143], a[92:95], v[212:215]
s_add_u32 s44, s84, 0xc08000
ds_read_b128 a[116:119], v5 offset:45056
v_mfma_f32_16x16x32_bf16 v[212:215], a[136:139], a[88:91], v[212:215]
v_mfma_f32_16x16x32_bf16 v[216:219], a[144:147], a[88:91], v[216:219]
v_mfma_f32_16x16x32_bf16 v[216:219], a[148:151], a[92:95], v[216:219]
v_mfma_f32_16x16x32_bf16 v[192:195], a[148:151], a[84:87], v[192:195]
v_mfma_f32_16x16x32_bf16 v[192:195], a[144:147], a[80:83], v[192:195]
v_mfma_f32_16x16x32_bf16 v[168:171], a[144:147], a[72:75], v[168:171]
v_mfma_f32_16x16x32_bf16 v[168:171], a[148:151], a[76:79], v[168:171]
v_mfma_f32_16x16x32_bf16 v[144:147], a[148:151], a[68:71], v[144:147]
v_mfma_f32_16x16x32_bf16 v[144:147], a[144:147], a[64:67], v[144:147]
s_waitcnt lgkmcnt(0)
v_mfma_f32_16x16x32_bf16 v[148:151], a[96:99], a[64:67], v[148:151]
ds_read_b128 a[128:131], v5 offset:39936
v_mfma_f32_16x16x32_bf16 v[148:151], a[100:103], a[68:71], v[148:151]
buffer_load_dwordx4 v1, s[4:7], s44 offen offset:0 sc1 lds
v_mfma_f32_16x16x32_bf16 v[172:175], a[100:103], a[76:79], v[172:175]
ds_read_b128 a[132:135], v5 offset:46080
v_mfma_f32_16x16x32_bf16 v[172:175], a[96:99], a[72:75], v[172:175]
v_mfma_f32_16x16x32_bf16 v[196:199], a[96:99], a[80:83], v[196:199]
v_mfma_f32_16x16x32_bf16 v[196:199], a[100:103], a[84:87], v[196:199]
buffer_load_dwordx4 v1, s[4:7], s44 offen offset:1024 sc1 lds
v_mfma_f32_16x16x32_bf16 v[220:223], a[100:103], a[92:95], v[220:223]
ds_read_b128 a[136:139], v5 offset:40960
v_mfma_f32_16x16x32_bf16 v[220:223], a[96:99], a[88:91], v[220:223]
v_mfma_f32_16x16x32_bf16 v[224:227], a[104:107], a[88:91], v[224:227]
ds_read_b128 a[140:143], v5 offset:47104
v_mfma_f32_16x16x32_bf16 v[224:227], a[108:111], a[92:95], v[224:227]
v_mfma_f32_16x16x32_bf16 v[200:203], a[108:111], a[84:87], v[200:203]
buffer_load_dwordx4 v1, s[4:7], s44 offen offset:2048 sc1 lds
v_mfma_f32_16x16x32_bf16 v[200:203], a[104:107], a[80:83], v[200:203]
ds_read_b128 a[144:147], v5 offset:41984
v_mfma_f32_16x16x32_bf16 v[176:179], a[104:107], a[72:75], v[176:179]
v_mfma_f32_16x16x32_bf16 v[176:179], a[108:111], a[76:79], v[176:179]
ds_read_b128 a[148:151], v5 offset:48128
v_mfma_f32_16x16x32_bf16 v[152:155], a[108:111], a[68:71], v[152:155]
v_mfma_f32_16x16x32_bf16 v[152:155], a[104:107], a[64:67], v[152:155]
buffer_load_dwordx4 v1, s[4:7], s44 offen offset:3072 sc1 lds
s_add_u32 m0, s19, 81920
s_waitcnt vmcnt(13)
v_mfma_f32_16x16x32_bf16 v[140:143], a[112:115], a[0:3], v[140:143]
s_add_u32 s44, s85, 0xc0c000
s_waitcnt vmcnt(12)
v_mfma_f32_16x16x32_bf16 v[140:143], a[116:119], a[4:7], v[140:143]
s_waitcnt vmcnt(10)
v_mfma_f32_16x16x32_bf16 v[164:167], a[116:119], a[12:15], v[164:167]
v_mfma_f32_16x16x32_bf16 v[164:167], a[112:115], a[8:11], v[164:167]
s_waitcnt vmcnt(9)
v_mfma_f32_16x16x32_bf16 v[188:191], a[112:115], a[16:19], v[188:191]
buffer_load_dwordx4 v1, s[4:7], s44 offen offset:0 sc1 lds
s_waitcnt vmcnt(9)
v_mfma_f32_16x16x32_bf16 v[188:191], a[116:119], a[20:23], v[188:191]
s_waitcnt vmcnt(7)
v_mfma_f32_16x16x32_bf16 v[212:215], a[116:119], a[28:31], v[212:215]
v_mfma_f32_16x16x32_bf16 v[212:215], a[112:115], a[24:27], v[212:215]
s_waitcnt lgkmcnt(0)
v_mfma_f32_16x16x32_bf16 v[216:219], a[128:131], a[24:27], v[216:219]
ds_read_b128 a[96:99], v5 offset:12288
v_cvt_pk_bf16_f32 v140, v140, v141
v_mfma_f32_16x16x32_bf16 v[216:219], a[132:135], a[28:31], v[216:219]
buffer_load_dwordx4 v1, s[4:7], s44 offen offset:1024 sc1 lds
v_mfma_f32_16x16x32_bf16 v[192:195], a[132:135], a[20:23], v[192:195]
ds_read_b128 a[100:103], v5 offset:18432
v_cvt_pk_bf16_f32 v141, v142, v143
v_mfma_f32_16x16x32_bf16 v[192:195], a[128:131], a[16:19], v[192:195]
v_cvt_pk_bf16_f32 v164, v164, v165
v_cvt_pk_bf16_f32 v165, v166, v167
v_mfma_f32_16x16x32_bf16 v[168:171], a[128:131], a[8:11], v[168:171]
v_cvt_pk_bf16_f32 v188, v188, v189
v_cvt_pk_bf16_f32 v189, v190, v191
v_mfma_f32_16x16x32_bf16 v[168:171], a[132:135], a[12:15], v[168:171]
buffer_load_dwordx4 v1, s[4:7], s44 offen offset:2048 sc1 lds
v_mfma_f32_16x16x32_bf16 v[144:147], a[132:135], a[4:7], v[144:147]
ds_read_b128 a[104:107], v5 offset:24576
v_cvt_pk_bf16_f32 v212, v212, v213
v_mfma_f32_16x16x32_bf16 v[144:147], a[128:131], a[0:3], v[144:147]
v_cvt_pk_bf16_f32 v213, v214, v215
v_mfma_f32_16x16x32_bf16 v[148:151], a[136:139], a[0:3], v[148:151]
ds_read_b128 a[108:111], v5 offset:30720
v_cvt_pk_bf16_f32 v214, v216, v217
v_mfma_f32_16x16x32_bf16 v[148:151], a[140:143], a[4:7], v[148:151]
v_cvt_pk_bf16_f32 v215, v218, v219
v_mfma_f32_16x16x32_bf16 v[172:175], a[140:143], a[12:15], v[172:175]
buffer_load_dwordx4 v1, s[4:7], s44 offen offset:3072 sc1 lds
s_add_u32 m0, s19, 147456
v_mfma_f32_16x16x32_bf16 v[172:175], a[136:139], a[8:11], v[172:175]
s_add_u32 s44, s87, 0xc1c000
ds_read_b128 a[112:115], v5 offset:36864
v_mfma_f32_16x16x32_bf16 v[196:199], a[136:139], a[16:19], v[196:199]
v_cvt_pk_bf16_f32 v166, v168, v169
v_cvt_pk_bf16_f32 v167, v170, v171
v_mfma_f32_16x16x32_bf16 v[196:199], a[140:143], a[20:23], v[196:199]
ds_read_b128 a[116:119], v5 offset:43008
v_cvt_pk_bf16_f32 v190, v192, v193
v_mfma_f32_16x16x32_bf16 v[220:223], a[140:143], a[28:31], v[220:223]
v_cvt_pk_bf16_f32 v142, v144, v145
v_cvt_pk_bf16_f32 v143, v146, v147
v_mfma_f32_16x16x32_bf16 v[220:223], a[136:139], a[24:27], v[220:223]
buffer_load_dwordx4 v1, s[4:7], s44 offen offset:0 sc1 lds
v_mfma_f32_16x16x32_bf16 v[224:227], a[144:147], a[24:27], v[224:227]
v_mfma_f32_16x16x32_bf16 v[92:95], a[240:243], v[140:143], 0
v_mfma_f32_16x16x32_bf16 v[224:227], a[148:151], a[28:31], v[224:227]
v_mfma_f32_16x16x32_bf16 v[96:99], a[244:247], v[140:143], 0
v_mfma_f32_16x16x32_bf16 v[200:203], a[148:151], a[20:23], v[200:203]
v_mfma_f32_16x16x32_bf16 v[100:103], a[240:243], v[164:167], 0
v_mfma_f32_16x16x32_bf16 v[200:203], a[144:147], a[16:19], v[200:203]
v_mfma_f32_16x16x32_bf16 v[104:107], a[244:247], v[164:167], 0
v_mfma_f32_16x16x32_bf16 v[176:179], a[144:147], a[8:11], v[176:179]
buffer_load_dwordx4 v1, s[4:7], s44 offen offset:1024 sc1 lds
v_mfma_f32_16x16x32_bf16 v[176:179], a[148:151], a[12:15], v[176:179]
v_max3_f32 v236, v92, v93, v94
v_max3_f32 v237, -v92, -v93, -v94
v_mfma_f32_16x16x32_bf16 v[152:155], a[148:151], a[4:7], v[152:155]
v_max3_f32 v236, v236, v95, v96
v_max3_f32 v237, v237, -v95, -v96
v_mfma_f32_16x16x32_bf16 v[152:155], a[144:147], a[0:3], v[152:155]
v_max3_f32 v236, v236, v97, v98
s_waitcnt lgkmcnt(0)
v_mfma_f32_16x16x32_bf16 v[132:135], a[96:99], a[32:35], v[132:135]
ds_read_b128 a[128:131], v5 offset:13312
v_max3_f32 v237, v237, -v97, -v98
v_mfma_f32_16x16x32_bf16 v[132:135], a[100:103], a[36:39], v[132:135]
buffer_load_dwordx4 v1, s[4:7], s44 offen offset:2048 sc1 lds
v_mfma_f32_16x16x32_bf16 v[156:159], a[100:103], a[44:47], v[156:159]
ds_read_b128 a[132:135], v5 offset:19456
v_max_f32 v236, v236, v99
v_mfma_f32_16x16x32_bf16 v[156:159], a[96:99], a[40:43], v[156:159]
v_max_f32_e64 v237, v237, -v99
v_max3_f32 v238, v100, v101, v102
v_mfma_f32_16x16x32_bf16 v[180:183], a[96:99], a[48:51], v[180:183]
v_permlane32_swap_b32 v236, v237
v_mfma_f32_16x16x32_bf16 v[180:183], a[100:103], a[52:55], v[180:183]
buffer_load_dwordx4 v1, s[4:7], s44 offen offset:3072 sc1 lds
s_add_u32 m0, s19, 98304
v_mfma_f32_16x16x32_bf16 v[204:207], a[100:103], a[60:63], v[204:207]
s_add_u32 s44, s84, 0xc10000
ds_read_b128 a[136:139], v5 offset:25600
v_mfma_f32_16x16x32_bf16 v[204:207], a[96:99], a[56:59], v[204:207]
v_max_f32 v236, v236, v237
v_mov_b32 v244, v236
v_mfma_f32_16x16x32_bf16 v[204:207], a[104:107], a[88:91], v[204:207]
ds_read_b128 a[140:143], v5 offset:31744
v_max3_f32 v239, -v100, -v101, -v102
v_mfma_f32_16x16x32_bf16 v[204:207], a[108:111], a[92:95], v[204:207]
v_permlane16_swap_b32 v236, v244
v_mfma_f32_16x16x32_bf16 v[180:183], a[108:111], a[84:87], v[180:183]
buffer_load_dwordx4 v1, s[4:7], s44 offen offset:0 sc1 lds
v_mfma_f32_16x16x32_bf16 v[180:183], a[104:107], a[80:83], v[180:183]
ds_read_b128 a[144:147], v5 offset:37888
v_max_f32 v236, v236, v244
v_mfma_f32_16x16x32_bf16 v[156:159], a[104:107], a[72:75], v[156:159]
v_mov_b32 v244, v236
v_max3_f32 v238, v238, v103, v104
v_mfma_f32_16x16x32_bf16 v[156:159], a[108:111], a[76:79], v[156:159]
ds_read_b128 a[148:151], v5 offset:44032
v_max3_f32 v239, v239, -v103, -v104
v_mfma_f32_16x16x32_bf16 v[132:135], a[108:111], a[68:71], v[132:135]
v_permlane32_swap_b32 v236, v244
v_mfma_f32_16x16x32_bf16 v[132:135], a[104:107], a[64:67], v[132:135]
buffer_load_dwordx4 v1, s[4:7], s44 offen offset:1024 sc1 lds
v_mfma_f32_16x16x32_bf16 v[132:135], a[112:115], a[0:3], v[132:135]
L_stub7:
s_cbranch_execz L_stub8
v_mul_f32_e64 v236, -v236, v82
v_mul_f32_e64 v237, -v244, v82
v_mfma_f32_16x16x32_bf16 v[132:135], a[116:119], a[4:7], v[132:135]
v_max3_f32 v238, v238, v105, v106
v_max3_f32 v239, v239, -v105, -v106
v_mfma_f32_16x16x32_bf16 v[156:159], a[116:119], a[12:15], v[156:159]
v_max_f32 v238, v238, v107
v_max_f32_e64 v239, v239, -v107
v_mfma_f32_16x16x32_bf16 v[156:159], a[112:115], a[8:11], v[156:159]
s_nop 0
v_permlane32_swap_b32 v238, v239
v_mfma_f32_16x16x32_bf16 v[180:183], a[112:115], a[16:19], v[180:183]
buffer_load_dwordx4 v1, s[4:7], s44 offen offset:2048 sc1 lds
v_mfma_f32_16x16x32_bf16 v[180:183], a[116:119], a[20:23], v[180:183]
v_max_f32 v238, v238, v239
v_mov_b32 v245, v238
v_mfma_f32_16x16x32_bf16 v[204:207], a[116:119], a[28:31], v[204:207]
s_nop 0
v_permlane16_swap_b32 v238, v245
v_mfma_f32_16x16x32_bf16 v[204:207], a[112:115], a[24:27], v[204:207]
s_waitcnt lgkmcnt(0)
s_barrier
v_mfma_f32_16x16x32_bf16 v[208:211], a[128:131], a[56:59], v[208:211]
v_max_f32 v238, v238, v245
v_mov_b32 v245, v238
v_mfma_f32_16x16x32_bf16 v[208:211], a[132:135], a[60:63], v[208:211]
buffer_load_dwordx4 v1, s[4:7], s44 offen offset:3072 sc1 lds
s_add_u32 m0, s19, 114688
v_mfma_f32_16x16x32_bf16 v[184:187], a[132:135], a[52:55], v[184:187]
s_add_u32 s44, s85, 0xc14000
v_cvt_pk_bf16_f32 v191, v194, v195
v_mfma_f32_16x16x32_bf16 v[184:187], a[128:131], a[48:51], v[184:187]
v_permlane32_swap_b32 v238, v245
v_mfma_f32_16x16x32_bf16 v[160:163], a[128:131], a[40:43], v[160:163]
v_mul_f32_e64 v238, -v238, v84
v_mul_f32_e64 v239, -v245, v84
v_mfma_f32_16x16x32_bf16 v[160:163], a[132:135], a[44:47], v[160:163]
buffer_load_dwordx4 v1, s[4:7], s44 offen offset:0 sc1 lds
v_mfma_f32_16x16x32_bf16 v[136:139], a[132:135], a[36:39], v[136:139]
v_mfma_f32_16x16x32_bf16 v[108:111], a[240:243], v[188:191], 0
v_mfma_f32_16x16x32_bf16 v[136:139], a[128:131], a[32:35], v[136:139]
v_mfma_f32_16x16x32_bf16 v[112:115], a[244:247], v[188:191], 0
v_mfma_f32_16x16x32_bf16 v[136:139], a[136:139], a[64:67], v[136:139]
v_mfma_f32_16x16x32_bf16 v[116:119], a[240:243], v[212:215], 0
v_mfma_f32_16x16x32_bf16 v[136:139], a[140:143], a[68:71], v[136:139]
v_mfma_f32_16x16x32_bf16 v[120:123], a[244:247], v[212:215], 0
v_mfma_f32_16x16x32_bf16 v[160:163], a[140:143], a[76:79], v[160:163]
buffer_load_dwordx4 v1, s[4:7], s44 offen offset:1024 sc1 lds
v_mfma_f32_16x16x32_bf16 v[160:163], a[136:139], a[72:75], v[160:163]
v_max3_f32 v240, v108, v109, v110
v_max3_f32 v241, -v108, -v109, -v110
v_mfma_f32_16x16x32_bf16 v[184:187], a[136:139], a[80:83], v[184:187]
v_max3_f32 v240, v240, v111, v112
v_max3_f32 v241, v241, -v111, -v112
v_mfma_f32_16x16x32_bf16 v[184:187], a[140:143], a[84:87], v[184:187]
v_max3_f32 v240, v240, v113, v114
v_max3_f32 v241, v241, -v113, -v114
v_mfma_f32_16x16x32_bf16 v[208:211], a[140:143], a[92:95], v[208:211]
v_max_f32 v240, v240, v115
v_max_f32_e64 v241, v241, -v115
v_mfma_f32_16x16x32_bf16 v[208:211], a[136:139], a[88:91], v[208:211]
buffer_load_dwordx4 v1, s[4:7], s44 offen offset:2048 sc1 lds
v_mfma_f32_16x16x32_bf16 v[208:211], a[144:147], a[24:27], v[208:211]
v_permlane32_swap_b32 v240, v241
v_mfma_f32_16x16x32_bf16 v[208:211], a[148:151], a[28:31], v[208:211]
v_max_f32 v240, v240, v241
v_mov_b32 v246, v240
v_mfma_f32_16x16x32_bf16 v[184:187], a[148:151], a[20:23], v[184:187]
s_nop 0
v_permlane16_swap_b32 v240, v246
v_mfma_f32_16x16x32_bf16 v[184:187], a[144:147], a[16:19], v[184:187]
v_max_f32 v240, v240, v246
v_mov_b32 v246, v240
v_mfma_f32_16x16x32_bf16 v[160:163], a[144:147], a[8:11], v[160:163]
buffer_load_dwordx4 v1, s[4:7], s44 offen offset:3072 sc1 lds
v_mfma_f32_16x16x32_bf16 v[160:163], a[148:151], a[12:15], v[160:163]
v_permlane32_swap_b32 v240, v246
v_mfma_f32_16x16x32_bf16 v[136:139], a[148:151], a[4:7], v[136:139]
v_mul_f32_e64 v240, -v240, v86
v_mul_f32_e64 v241, -v246, v86
v_mfma_f32_16x16x32_bf16 v[136:139], a[144:147], a[0:3], v[136:139]
v_max3_f32 v242, v116, v117, v118
v_max3_f32 v243, -v116, -v117, -v118
v_pk_mul_f32 v[148:149], v[148:149], v[82:83] op_sel:[0,1] op_sel_hi:[1,1]
v_pk_mul_f32 v[150:151], v[150:151], v[82:83] op_sel:[0,1] op_sel_hi:[1,1]
v_cvt_pk_bf16_f32 v148, v148, v149
v_cvt_pk_bf16_f32 v149, v150, v151
ds_write_b64 v232, v[148:149] offset:0
v_pk_mul_f32 v[152:153], v[152:153], v[82:83] op_sel:[0,1] op_sel_hi:[1,1]
v_pk_mul_f32 v[154:155], v[154:155], v[82:83] op_sel:[0,1] op_sel_hi:[1,1]
v_cvt_pk_bf16_f32 v150, v152, v153
v_cvt_pk_bf16_f32 v151, v154, v155
v_pk_mul_f32 v[172:173], v[172:173], v[84:85] op_sel:[0,1] op_sel_hi:[1,1]
v_pk_mul_f32 v[174:175], v[174:175], v[84:85] op_sel:[0,1] op_sel_hi:[1,1]
v_cvt_pk_bf16_f32 v172, v172, v173
v_cvt_pk_bf16_f32 v173, v174, v175
v_pk_mul_f32 v[176:177], v[176:177], v[84:85] op_sel:[0,1] op_sel_hi:[1,1]
v_pk_mul_f32 v[178:179], v[178:179], v[84:85] op_sel:[0,1] op_sel_hi:[1,1]
v_cvt_pk_bf16_f32 v174, v176, v177
v_cvt_pk_bf16_f32 v175, v178, v179
ds_write_b64 v232, v[150:151] offset:512
v_pk_mul_f32 v[196:197], v[196:197], v[86:87] op_sel:[0,1] op_sel_hi:[1,1]
v_pk_mul_f32 v[198:199], v[198:199], v[86:87] op_sel:[0,1] op_sel_hi:[1,1]
v_cvt_pk_bf16_f32 v196, v196, v197
v_cvt_pk_bf16_f32 v197, v198, v199
buffer_store_dwordx4 a[248:251], v254, s[4:7], s97 offen offset:0 sc1
v_pk_mul_f32 v[200:201], v[200:201], v[86:87] op_sel:[0,1] op_sel_hi:[1,1]
v_pk_mul_f32 v[202:203], v[202:203], v[86:87] op_sel:[0,1] op_sel_hi:[1,1]
v_cvt_pk_bf16_f32 v198, v200, v201
v_cvt_pk_bf16_f32 v199, v202, v203
ds_write_b64 v232, v[172:173] offset:1024
v_pk_mul_f32 v[220:221], v[220:221], v[88:89] op_sel:[0,1] op_sel_hi:[1,1]
v_pk_mul_f32 v[222:223], v[222:223], v[88:89] op_sel:[0,1] op_sel_hi:[1,1]
v_cvt_pk_bf16_f32 v220, v220, v221
v_cvt_pk_bf16_f32 v221, v222, v223
v_pk_fma_f32 v[48:49], v[92:93], v[82:83], v[236:237] op_sel:[0,0,0] op_sel_hi:[1,0,0]
v_pk_fma_f32 v[50:51], v[94:95], v[82:83], v[236:237] op_sel:[0,0,0] op_sel_hi:[1,0,0]
v_pk_fma_f32 v[52:53], v[96:97], v[82:83], v[236:237] op_sel:[0,0,0] op_sel_hi:[1,0,0]
v_pk_fma_f32 v[54:55], v[98:99], v[82:83], v[236:237] op_sel:[0,0,0] op_sel_hi:[1,0,0]
v_exp_f32 v48, v48
v_exp_f32 v49, v49
ds_write_b64 v232, v[174:175] offset:1536
v_exp_f32 v50, v50
v_exp_f32 v51, v51
v_exp_f32 v52, v52
v_exp_f32 v53, v53
v_exp_f32 v54, v54
v_exp_f32 v55, v55
ds_write_b64 v232, v[196:197] offset:2048
buffer_store_dwordx4 a[248:251], v1, s[4:7], s96 offen offset:0 sc1
v_cvt_pk_bf16_f32 v140, v48, v49
v_cvt_pk_bf16_f32 v141, v50, v51
v_cvt_pk_bf16_f32 v142, v52, v53
v_cvt_pk_bf16_f32 v143, v54, v55
v_pk_mul_f32 v[224:225], v[224:225], v[88:89] op_sel:[0,1] op_sel_hi:[1,1]
v_pk_mul_f32 v[226:227], v[226:227], v[88:89] op_sel:[0,1] op_sel_hi:[1,1]
v_cvt_pk_bf16_f32 v222, v224, v225
v_mfma_f32_16x16x32_bf16 v[148:151], v[16:19], v[140:143], 0
ds_write_b64 v232, v[198:199] offset:2560
v_cvt_pk_bf16_f32 v223, v226, v227
s_add_u32 m0, s19, 131072
v_pk_fma_f32 v[92:93], v[92:93], v[82:83], v[236:237] op_sel:[0,0,1] op_sel_hi:[1,0,1] neg_lo:[1,0,0] neg_hi:[1,0,0]
v_pk_fma_f32 v[94:95], v[94:95], v[82:83], v[236:237] op_sel:[0,0,1] op_sel_hi:[1,0,1] neg_lo:[1,0,0] neg_hi:[1,0,0]
v_pk_fma_f32 v[96:97], v[96:97], v[82:83], v[236:237] op_sel:[0,0,1] op_sel_hi:[1,0,1] neg_lo:[1,0,0] neg_hi:[1,0,0]
s_nop 1
v_rcp_f32 v148, v148
v_pk_fma_f32 v[98:99], v[98:99], v[82:83], v[236:237] op_sel:[0,0,1] op_sel_hi:[1,0,1] neg_lo:[1,0,0] neg_hi:[1,0,0]
v_pk_mul_f32 v[48:49], v[48:49], v[148:149] op_sel:[0,0] op_sel_hi:[1,0]
v_pk_mul_f32 v[50:51], v[50:51], v[148:149] op_sel:[0,0] op_sel_hi:[1,0]
v_cvt_pk_bf16_f32 v140, v48, v49
v_cvt_pk_bf16_f32 v141, v50, v51
ds_write_b64 v232, v[220:221] offset:3072
v_exp_f32 v92, v92
v_exp_f32 v93, v93
v_exp_f32 v94, v94
v_exp_f32 v95, v95
v_exp_f32 v96, v96
v_exp_f32 v97, v97
ds_write_b64 v232, v[222:223] offset:3584
v_exp_f32 v98, v98
v_exp_f32 v99, v99
s_add_u32 s44, s86, 0xc18000
v_cvt_pk_bf16_f32 v144, v92, v93
v_cvt_pk_bf16_f32 v145, v94, v95
v_cvt_pk_bf16_f32 v146, v96, v97
v_cvt_pk_bf16_f32 v147, v98, v99
buffer_load_dwordx4 v1, s[4:7], s44 offen offset:0 sc1 lds
v_pk_mul_f32 v[52:53], v[52:53], v[148:149] op_sel:[0,0] op_sel_hi:[1,0]
ds_write_b64 v233, v[140:141] offset:16384
v_pk_mul_f32 v[54:55], v[54:55], v[148:149] op_sel:[0,0] op_sel_hi:[1,0]
v_cvt_pk_bf16_f32 v142, v52, v53
v_mfma_f32_16x16x32_bf16 v[152:155], v[16:19], v[144:147], 0
v_cvt_pk_bf16_f32 v143, v54, v55
v_max3_f32 v242, v242, v119, v120
v_max3_f32 v243, v243, -v119, -v120
v_max3_f32 v242, v242, v121, v122
v_max3_f32 v243, v243, -v121, -v122
v_pk_fma_f32 v[56:57], v[100:101], v[84:85], v[238:239] op_sel:[0,0,0] op_sel_hi:[1,0,0]
v_pk_fma_f32 v[58:59], v[102:103], v[84:85], v[238:239] op_sel:[0,0,0] op_sel_hi:[1,0,0]
v_pk_fma_f32 v[60:61], v[104:105], v[84:85], v[238:239] op_sel:[0,0,0] op_sel_hi:[1,0,0]
ds_write_b64 v233, v[142:143] offset:16896
v_rcp_f32 v152, v152
v_pk_fma_f32 v[62:63], v[106:107], v[84:85], v[238:239] op_sel:[0,0,0] op_sel_hi:[1,0,0]
v_pk_mul_f32 v[92:93], v[92:93], v[152:153] op_sel:[0,0] op_sel_hi:[1,0]
v_pk_mul_f32 v[94:95], v[94:95], v[152:153] op_sel:[0,0] op_sel_hi:[1,0]
v_cvt_pk_bf16_f32 v144, v92, v93
v_cvt_pk_bf16_f32 v145, v94, v95
v_exp_f32 v56, v56
v_exp_f32 v57, v57
v_exp_f32 v58, v58
ds_write_b64 v233, v[144:145] offset:17408
v_exp_f32 v59, v59
v_exp_f32 v60, v60
v_exp_f32 v61, v61
v_exp_f32 v62, v62
v_exp_f32 v63, v63
buffer_load_dwordx4 v1, s[4:7], s44 offen offset:1024 sc1 lds
v_cvt_pk_bf16_f32 v164, v56, v57
v_cvt_pk_bf16_f32 v165, v58, v59
v_cvt_pk_bf16_f32 v166, v60, v61
v_cvt_pk_bf16_f32 v167, v62, v63
v_pk_mul_f32 v[96:97], v[96:97], v[152:153] op_sel:[0,0] op_sel_hi:[1,0]
v_pk_mul_f32 v[98:99], v[98:99], v[152:153] op_sel:[0,0] op_sel_hi:[1,0]
v_cvt_pk_bf16_f32 v146, v96, v97
v_mfma_f32_16x16x32_bf16 v[172:175], v[16:19], v[164:167], 0
v_cvt_pk_bf16_f32 v147, v98, v99
ds_write_b64 v233, v[146:147] offset:17920
v_max_f32 v242, v242, v123
v_pk_fma_f32 v[100:101], v[100:101], v[84:85], v[238:239] op_sel:[0,0,1] op_sel_hi:[1,0,1] neg_lo:[1,0,0] neg_hi:[1,0,0]
v_pk_fma_f32 v[102:103], v[102:103], v[84:85], v[238:239] op_sel:[0,0,1] op_sel_hi:[1,0,1] neg_lo:[1,0,0] neg_hi:[1,0,0]
v_pk_fma_f32 v[104:105], v[104:105], v[84:85], v[238:239] op_sel:[0,0,1] op_sel_hi:[1,0,1] neg_lo:[1,0,0] neg_hi:[1,0,0]
s_nop 1
v_rcp_f32 v172, v172
v_pk_fma_f32 v[106:107], v[106:107], v[84:85], v[238:239] op_sel:[0,0,1] op_sel_hi:[1,0,1] neg_lo:[1,0,0] neg_hi:[1,0,0]
v_pk_mul_f32 v[56:57], v[56:57], v[172:173] op_sel:[0,0] op_sel_hi:[1,0]
v_pk_mul_f32 v[58:59], v[58:59], v[172:173] op_sel:[0,0] op_sel_hi:[1,0]
v_cvt_pk_bf16_f32 v164, v56, v57
v_cvt_pk_bf16_f32 v165, v58, v59
v_exp_f32 v100, v100
ds_write_b64 v233, v[164:165] offset:18432
v_exp_f32 v101, v101
v_exp_f32 v102, v102
v_exp_f32 v103, v103
v_exp_f32 v104, v104
v_exp_f32 v105, v105
v_exp_f32 v106, v106
v_exp_f32 v107, v107
buffer_load_dwordx4 v1, s[4:7], s44 offen offset:2048 sc1 lds
v_cvt_pk_bf16_f32 v168, v100, v101
v_cvt_pk_bf16_f32 v169, v102, v103
v_cvt_pk_bf16_f32 v170, v104, v105
v_cvt_pk_bf16_f32 v171, v106, v107
v_pk_mul_f32 v[60:61], v[60:61], v[172:173] op_sel:[0,0] op_sel_hi:[1,0]
v_pk_mul_f32 v[62:63], v[62:63], v[172:173] op_sel:[0,0] op_sel_hi:[1,0]
v_cvt_pk_bf16_f32 v166, v60, v61
v_mfma_f32_16x16x32_bf16 v[176:179], v[16:19], v[168:171], 0
v_cvt_pk_bf16_f32 v167, v62, v63
ds_write_b64 v233, v[166:167] offset:18944
v_max_f32_e64 v243, v243, -v123
v_pk_fma_f32 v[64:65], v[108:109], v[86:87], v[240:241] op_sel:[0,0,0] op_sel_hi:[1,0,0]
v_pk_fma_f32 v[66:67], v[110:111], v[86:87], v[240:241] op_sel:[0,0,0] op_sel_hi:[1,0,0]
v_pk_fma_f32 v[68:69], v[112:113], v[86:87], v[240:241] op_sel:[0,0,0] op_sel_hi:[1,0,0]
s_nop 1
v_rcp_f32 v176, v176
v_pk_fma_f32 v[70:71], v[114:115], v[86:87], v[240:241] op_sel:[0,0,0] op_sel_hi:[1,0,0]
v_pk_mul_f32 v[100:101], v[100:101], v[176:177] op_sel:[0,0] op_sel_hi:[1,0]
v_pk_mul_f32 v[102:103], v[102:103], v[176:177] op_sel:[0,0] op_sel_hi:[1,0]
v_cvt_pk_bf16_f32 v168, v100, v101
v_cvt_pk_bf16_f32 v169, v102, v103
v_exp_f32 v64, v64
ds_write_b64 v233, v[168:169] offset:19456
buffer_load_dwordx4 v1, s[4:7], s44 offen offset:3072 sc1 lds
v_exp_f32 v65, v65
v_exp_f32 v66, v66
v_exp_f32 v67, v67
v_exp_f32 v68, v68
v_exp_f32 v69, v69
v_exp_f32 v70, v70
v_exp_f32 v71, v71
v_cvt_pk_bf16_f32 v188, v64, v65
v_cvt_pk_bf16_f32 v189, v66, v67
v_cvt_pk_bf16_f32 v190, v68, v69
v_cvt_pk_bf16_f32 v191, v70, v71
v_pk_mul_f32 v[104:105], v[104:105], v[176:177] op_sel:[0,0] op_sel_hi:[1,0]
v_pk_mul_f32 v[106:107], v[106:107], v[176:177] op_sel:[0,0] op_sel_hi:[1,0]
v_cvt_pk_bf16_f32 v170, v104, v105
v_mfma_f32_16x16x32_bf16 v[196:199], v[16:19], v[188:191], 0
v_cvt_pk_bf16_f32 v171, v106, v107
ds_write_b64 v233, v[170:171] offset:19968
buffer_store_dwordx4 a[248:251], v2, s[4:7], s72 offen offset:0 sc1
s_nop 4
v_rcp_f32 v196, v196
v_pk_fma_f32 v[108:109], v[108:109], v[86:87], v[240:241] op_sel:[0,0,1] op_sel_hi:[1,0,1] neg_lo:[1,0,0] neg_hi:[1,0,0]
v_pk_mul_f32 v[64:65], v[64:65], v[196:197] op_sel:[0,0] op_sel_hi:[1,0]
v_pk_mul_f32 v[66:67], v[66:67], v[196:197] op_sel:[0,0] op_sel_hi:[1,0]
v_cvt_pk_bf16_f32 v188, v64, v65
v_cvt_pk_bf16_f32 v189, v66, v67
v_pk_fma_f32 v[110:111], v[110:111], v[86:87], v[240:241] op_sel:[0,0,1] op_sel_hi:[1,0,1] neg_lo:[1,0,0] neg_hi:[1,0,0]
ds_write_b64 v233, v[188:189] offset:20480
v_pk_fma_f32 v[112:113], v[112:113], v[86:87], v[240:241] op_sel:[0,0,1] op_sel_hi:[1,0,1] neg_lo:[1,0,0] neg_hi:[1,0,0]
v_pk_fma_f32 v[114:115], v[114:115], v[86:87], v[240:241] op_sel:[0,0,1] op_sel_hi:[1,0,1] neg_lo:[1,0,0] neg_hi:[1,0,0]
v_exp_f32 v108, v108
v_exp_f32 v109, v109
v_exp_f32 v110, v110
v_exp_f32 v111, v111
v_exp_f32 v112, v112
v_exp_f32 v113, v113
v_exp_f32 v114, v114
v_exp_f32 v115, v115
v_cvt_pk_bf16_f32 v192, v108, v109
v_cvt_pk_bf16_f32 v193, v110, v111
v_cvt_pk_bf16_f32 v194, v112, v113
v_cvt_pk_bf16_f32 v195, v114, v115
v_pk_mul_f32 v[68:69], v[68:69], v[196:197] op_sel:[0,0] op_sel_hi:[1,0]
v_pk_mul_f32 v[70:71], v[70:71], v[196:197] op_sel:[0,0] op_sel_hi:[1,0]
v_permlane32_swap_b32 v242, v243
v_mfma_f32_16x16x32_bf16 v[200:203], v[16:19], v[192:195], 0
v_cvt_pk_bf16_f32 v190, v68, v69
v_cvt_pk_bf16_f32 v191, v70, v71
ds_write_b64 v233, v[190:191] offset:20992
v_max_f32 v242, v242, v243
v_mov_b32 v247, v242
buffer_store_dwordx4 a[248:251], v2, s[4:7], s72 offen offset:1024 sc1
s_nop 0
v_permlane16_swap_b32 v242, v247
v_rcp_f32 v200, v200
v_max_f32 v242, v242, v247
v_mov_b32 v247, v242
v_pk_mul_f32 v[108:109], v[108:109], v[200:201] op_sel:[0,0] op_sel_hi:[1,0]
v_pk_mul_f32 v[110:111], v[110:111], v[200:201] op_sel:[0,0] op_sel_hi:[1,0]
v_cvt_pk_bf16_f32 v192, v108, v109
v_cvt_pk_bf16_f32 v193, v110, v111
v_permlane32_swap_b32 v242, v247
ds_write_b64 v233, v[192:193] offset:21504
v_mul_f32_e64 v242, -v242, v88
v_mul_f32_e64 v243, -v247, v88
v_pk_fma_f32 v[124:125], v[116:117], v[88:89], v[242:243] op_sel:[0,0,0] op_sel_hi:[1,0,0]
v_pk_fma_f32 v[126:127], v[118:119], v[88:89], v[242:243] op_sel:[0,0,0] op_sel_hi:[1,0,0]
v_pk_fma_f32 v[128:129], v[120:121], v[88:89], v[242:243] op_sel:[0,0,0] op_sel_hi:[1,0,0]
v_pk_fma_f32 v[130:131], v[122:123], v[88:89], v[242:243] op_sel:[0,0,0] op_sel_hi:[1,0,0]
v_exp_f32 v124, v124
v_exp_f32 v125, v125
v_exp_f32 v126, v126
v_exp_f32 v127, v127
v_exp_f32 v128, v128
v_exp_f32 v129, v129
v_exp_f32 v130, v130
v_exp_f32 v131, v131
v_cvt_pk_bf16_f32 v212, v124, v125
v_cvt_pk_bf16_f32 v213, v126, v127
v_cvt_pk_bf16_f32 v214, v128, v129
v_cvt_pk_bf16_f32 v215, v130, v131
v_pk_mul_f32 v[112:113], v[112:113], v[200:201] op_sel:[0,0] op_sel_hi:[1,0]
v_pk_mul_f32 v[114:115], v[114:115], v[200:201] op_sel:[0,0] op_sel_hi:[1,0]
v_cvt_pk_bf16_f32 v194, v112, v113
v_mfma_f32_16x16x32_bf16 v[220:223], v[16:19], v[212:215], 0
v_cvt_pk_bf16_f32 v195, v114, v115
ds_write_b64 v233, v[194:195] offset:22016
buffer_store_dwordx4 a[248:251], v2, s[4:7], s72 offen offset:2048 sc1
s_nop 4
v_rcp_f32 v220, v220
v_pk_fma_f32 v[116:117], v[116:117], v[88:89], v[242:243] op_sel:[0,0,1] op_sel_hi:[1,0,1] neg_lo:[1,0,0] neg_hi:[1,0,0]
v_pk_mul_f32 v[124:125], v[124:125], v[220:221] op_sel:[0,0] op_sel_hi:[1,0]
v_pk_mul_f32 v[126:127], v[126:127], v[220:221] op_sel:[0,0] op_sel_hi:[1,0]
v_cvt_pk_bf16_f32 v212, v124, v125
v_cvt_pk_bf16_f32 v213, v126, v127
v_pk_fma_f32 v[118:119], v[118:119], v[88:89], v[242:243] op_sel:[0,0,1] op_sel_hi:[1,0,1] neg_lo:[1,0,0] neg_hi:[1,0,0]
ds_write_b64 v233, v[212:213] offset:22528
v_pk_fma_f32 v[120:121], v[120:121], v[88:89], v[242:243] op_sel:[0,0,1] op_sel_hi:[1,0,1] neg_lo:[1,0,0] neg_hi:[1,0,0]
v_pk_fma_f32 v[122:123], v[122:123], v[88:89], v[242:243] op_sel:[0,0,1] op_sel_hi:[1,0,1] neg_lo:[1,0,0] neg_hi:[1,0,0]
v_exp_f32 v116, v116
v_exp_f32 v117, v117
v_exp_f32 v118, v118
v_exp_f32 v119, v119
v_exp_f32 v120, v120
v_exp_f32 v121, v121
v_exp_f32 v122, v122
v_exp_f32 v123, v123
v_cvt_pk_bf16_f32 v216, v116, v117
v_cvt_pk_bf16_f32 v217, v118, v119
v_cvt_pk_bf16_f32 v218, v120, v121
v_cvt_pk_bf16_f32 v219, v122, v123
v_pk_mul_f32 v[128:129], v[128:129], v[220:221] op_sel:[0,0] op_sel_hi:[1,0]
v_pk_mul_f32 v[130:131], v[130:131], v[220:221] op_sel:[0,0] op_sel_hi:[1,0]
v_cvt_pk_bf16_f32 v214, v128, v129
v_mfma_f32_16x16x32_bf16 v[224:227], v[16:19], v[216:219], 0
v_cvt_pk_bf16_f32 v215, v130, v131
ds_write_b64 v233, v[214:215] offset:23040
buffer_store_dwordx4 a[248:251], v2, s[4:7], s72 offen offset:3072 sc1
s_nop 4
v_rcp_f32 v224, v224
s_nop 0
v_pk_mul_f32 v[116:117], v[116:117], v[224:225] op_sel:[0,0] op_sel_hi:[1,0]
v_pk_mul_f32 v[118:119], v[118:119], v[224:225] op_sel:[0,0] op_sel_hi:[1,0]
v_cvt_pk_bf16_f32 v216, v116, v117
v_cvt_pk_bf16_f32 v217, v118, v119
v_pk_mul_f32 v[120:121], v[120:121], v[224:225] op_sel:[0,0] op_sel_hi:[1,0]
ds_write_b64 v233, v[216:217] offset:23552
v_pk_mul_f32 v[122:123], v[122:123], v[224:225] op_sel:[0,0] op_sel_hi:[1,0]
v_cvt_pk_bf16_f32 v218, v120, v121
v_cvt_pk_bf16_f32 v219, v122, v123
ds_write_b64 v233, v[218:219] offset:24064
s_waitcnt vmcnt(8)
s_waitcnt lgkmcnt(0)
s_barrier
ds_read_b64_tr_b16 a[0:1], v234 offset:16384
ds_read_b64_tr_b16 a[2:3], v234 offset:18432
ds_read_b64_tr_b16 a[12:13], v234 offset:20480
ds_read_b64_tr_b16 a[14:15], v234 offset:22528
ds_read_b64_tr_b16 a[24:25], v234 offset:24576
ds_read_b64_tr_b16 a[26:27], v234 offset:26624
ds_read_b64_tr_b16 a[4:5], v8 offset:0
ds_read_b64_tr_b16 a[6:7], v8 offset:1024
ds_read_b64_tr_b16 a[8:9], v8 offset:512
ds_read_b64_tr_b16 a[10:11], v8 offset:1536
ds_read_b64_tr_b16 a[36:37], v234 offset:28672
ds_read_b64_tr_b16 a[38:39], v234 offset:30720
ds_read_b64_tr_b16 a[16:17], v8 offset:2048
ds_read_b64_tr_b16 a[18:19], v8 offset:3072
ds_read_b64_tr_b16 a[20:21], v8 offset:2560
ds_read_b64_tr_b16 a[22:23], v8 offset:3584
ds_read_b64_tr_b16 a[48:49], v234 offset:32768
ds_read_b64_tr_b16 a[50:51], v234 offset:34816
ds_read_b64_tr_b16 a[28:29], v8 offset:4096
ds_read_b64_tr_b16 a[30:31], v8 offset:5120
ds_read_b64_tr_b16 a[32:33], v8 offset:4608
ds_read_b64_tr_b16 a[34:35], v8 offset:5632
ds_read_b64_tr_b16 a[60:61], v234 offset:36864
ds_read_b64_tr_b16 a[62:63], v234 offset:38912
s_waitcnt lgkmcnt(14)
v_mfma_f32_16x16x32_bf16 v[100:103], a[0:3], v[16:19], 0
ds_read_b64_tr_b16 a[40:41], v8 offset:6144
ds_read_b64_tr_b16 a[42:43], v8 offset:7168
ds_read_b64_tr_b16 a[44:45], v8 offset:6656
ds_read_b64_tr_b16 a[46:47], v8 offset:7680
ds_read_b64_tr_b16 a[72:73], v234 offset:40960
ds_read_b64_tr_b16 a[74:75], v234 offset:43008
v_mfma_f32_16x16x32_bf16 v[100:103], a[12:15], v[16:19], v[100:103]
buffer_atomic_add v12, v235, s[4:7], s94 offen sc1
ds_read_b64_tr_b16 a[52:53], v8 offset:8192
ds_read_b64_tr_b16 a[54:55], v8 offset:9216
ds_read_b64_tr_b16 a[56:57], v8 offset:8704
ds_read_b64_tr_b16 a[58:59], v8 offset:9728
ds_read_b64_tr_b16 a[84:85], v234 offset:45056
ds_read_b64_tr_b16 a[86:87], v234 offset:47104
v_mfma_f32_16x16x32_bf16 v[100:103], a[24:27], v[16:19], v[100:103]
ds_read_b64_tr_b16 a[64:65], v8 offset:10240
ds_read_b64_tr_b16 a[66:67], v8 offset:11264
v_mfma_f32_16x16x32_bf16 v[92:95], a[0:3], a[4:7], 0
ds_read_b64_tr_b16 a[68:69], v8 offset:10752
ds_read_b64_tr_b16 a[70:71], v8 offset:11776
v_mfma_f32_16x16x32_bf16 v[96:99], a[0:3], a[8:11], 0
ds_read_b64_tr_b16 a[76:77], v8 offset:12288
s_waitcnt lgkmcnt(14)
v_mfma_f32_16x16x32_bf16 v[100:103], a[36:39], v[16:19], v[100:103]
ds_read_b64_tr_b16 a[78:79], v8 offset:13312
v_mfma_f32_16x16x32_bf16 v[92:95], a[12:15], a[16:19], v[92:95]
ds_read_b64_tr_b16 a[80:81], v8 offset:12800
ds_read_b64_tr_b16 a[82:83], v8 offset:13824
v_mfma_f32_16x16x32_bf16 v[96:99], a[12:15], a[20:23], v[96:99]
ds_read_b64_tr_b16 a[88:89], v8 offset:14336
v_mfma_f32_16x16x32_bf16 v[100:103], a[48:51], v[16:19], v[100:103]
ds_read_b64_tr_b16 a[90:91], v8 offset:15360
v_mfma_f32_16x16x32_bf16 v[92:95], a[24:27], a[28:31], v[92:95]
ds_read_b64_tr_b16 a[92:93], v8 offset:14848
ds_read_b64_tr_b16 a[94:95], v8 offset:15872
v_mfma_f32_16x16x32_bf16 v[96:99], a[24:27], a[32:35], v[96:99]
v_cvt_pk_bf16_f32 v132, v132, v133
v_cvt_pk_bf16_f32 v156, v156, v157
v_mfma_f32_16x16x32_bf16 v[100:103], a[60:63], v[16:19], v[100:103]
v_cvt_pk_bf16_f32 v180, v180, v181
v_cvt_pk_bf16_f32 v204, v204, v205
v_mfma_f32_16x16x32_bf16 v[92:95], a[36:39], a[40:43], v[92:95]
v_cvt_pk_bf16_f32 v133, v134, v135
v_cvt_pk_bf16_f32 v157, v158, v159
s_waitcnt lgkmcnt(14)
v_mfma_f32_16x16x32_bf16 v[96:99], a[36:39], a[44:47], v[96:99]
v_cvt_pk_bf16_f32 v181, v182, v183
v_cvt_pk_bf16_f32 v205, v206, v207
v_mfma_f32_16x16x32_bf16 v[100:103], a[72:75], v[16:19], v[100:103]
v_cvt_pk_bf16_f32 v134, v136, v137
v_cvt_pk_bf16_f32 v135, v138, v139
v_mfma_f32_16x16x32_bf16 v[92:95], a[48:51], a[52:55], v[92:95]
v_cvt_pk_bf16_f32 v158, v160, v161
v_cvt_pk_bf16_f32 v159, v162, v163
v_mfma_f32_16x16x32_bf16 v[96:99], a[48:51], a[56:59], v[96:99]
v_cvt_pk_bf16_f32 v182, v184, v185
v_cvt_pk_bf16_f32 v183, v186, v187
s_waitcnt lgkmcnt(12)
v_mfma_f32_16x16x32_bf16 v[100:103], a[84:87], v[16:19], v[100:103]
v_cvt_pk_bf16_f32 v206, v208, v209
v_cvt_pk_bf16_f32 v207, v210, v211
s_waitcnt lgkmcnt(10)
v_mfma_f32_16x16x32_bf16 v[92:95], a[60:63], a[64:67], v[92:95]
s_waitcnt lgkmcnt(8)
v_mfma_f32_16x16x32_bf16 v[96:99], a[60:63], a[68:71], v[96:99]
s_nop 1
v_min_u32 v100, -2, v100
v_min_u32 v101, -2, v101
s_waitcnt lgkmcnt(6)
v_mfma_f32_16x16x32_bf16 v[92:95], a[72:75], a[76:79], v[92:95]
v_min_u32 v102, -2, v102
v_min_u32 v103, -2, v103
s_waitcnt lgkmcnt(4)
v_mfma_f32_16x16x32_bf16 v[96:99], a[72:75], a[80:83], v[96:99]
buffer_store_dwordx4 v[100:103], v254, s[4:7], s97 offen sc1
s_waitcnt lgkmcnt(2)
v_mfma_f32_16x16x32_bf16 v[92:95], a[84:87], a[88:91], v[92:95]
s_waitcnt lgkmcnt(0)
v_mfma_f32_16x16x32_bf16 v[96:99], a[84:87], a[92:95], v[96:99]
s_nop 5
v_cvt_pk_bf16_f32 v92, v92, v93
v_cvt_pk_bf16_f32 v93, v94, v95
v_min_u32 v92, -2, v92
v_min_u32 v93, -2, v93
v_cvt_pk_bf16_f32 v94, v96, v97
v_cvt_pk_bf16_f32 v95, v98, v99
v_min_u32 v94, -2, v94
v_min_u32 v95, -2, v95
buffer_store_dwordx4 v[92:95], v1, s[4:7], s96 offen sc1
s_barrier
s_add_u32 m0, s19, 32768
s_add_u32 s44, s84, 0xc00000
buffer_load_dwordx4 v1, s[4:7], s44 offen offset:0 sc1 lds
v_mfma_f32_16x16x32_bf16 v[108:111], a[240:243], v[132:135], 0
v_mfma_f32_16x16x32_bf16 v[172:175], a[240:243], v[156:159], 0
v_mfma_f32_16x16x32_bf16 v[112:115], a[244:247], v[132:135], 0
s_nop 5
v_max3_f32 v236, v108, v109, v110
v_max3_f32 v237, -v108, -v109, -v110
v_mfma_f32_16x16x32_bf16 v[176:179], a[244:247], v[156:159], 0
v_max3_f32 v238, v172, v173, v174
v_max3_f32 v239, -v172, -v173, -v174
v_max3_f32 v236, v236, v111, v112
v_max3_f32 v237, v237, -v111, -v112
v_max3_f32 v236, v236, v113, v114
v_max3_f32 v237, v237, -v113, -v114
s_nop 1
v_max3_f32 v238, v238, v175, v176
v_max3_f32 v239, v239, -v175, -v176
v_max3_f32 v238, v238, v177, v178
v_max3_f32 v239, v239, -v177, -v178
v_max_f32 v236, v236, v115
buffer_load_dwordx4 v1, s[4:7], s44 offen offset:1024 sc1 lds
v_max_f32_e64 v237, v237, -v115
v_max_f32 v238, v238, v179
v_max_f32_e64 v239, v239, -v179
v_permlane32_swap_b32 v236, v237
s_nop 0
v_permlane32_swap_b32 v238, v239
v_mov_b32 v11, 0
buffer_atomic_add v11, v251, s[4:7], s89 offen sc0 sc1
v_max_f32 v236, v236, v237
v_max_f32 v238, v238, v239
v_mov_b32 v244, v236
v_mov_b32 v245, v238
s_nop 0
v_permlane16_swap_b32 v236, v244
v_permlane16_swap_b32 v238, v245
v_max_f32 v236, v236, v244
v_max_f32 v238, v238, v245
v_mov_b32 v244, v236
v_mov_b32 v245, v238
s_nop 0
v_permlane32_swap_b32 v236, v244
v_permlane32_swap_b32 v238, v245
v_mul_f32_e64 v236, -v236, v82
v_mul_f32_e64 v237, -v244, v82
buffer_load_dwordx4 v1, s[4:7], s44 offen offset:2048 sc1 lds
v_mul_f32_e64 v238, -v238, v84
v_mul_f32_e64 v239, -v245, v84
v_pk_fma_f32 v[116:117], v[108:109], v[82:83], v[236:237] op_sel:[0,0,0] op_sel_hi:[1,0,0]
v_pk_fma_f32 v[118:119], v[110:111], v[82:83], v[236:237] op_sel:[0,0,0] op_sel_hi:[1,0,0]
v_pk_fma_f32 v[120:121], v[112:113], v[82:83], v[236:237] op_sel:[0,0,0] op_sel_hi:[1,0,0]
v_pk_fma_f32 v[122:123], v[114:115], v[82:83], v[236:237] op_sel:[0,0,0] op_sel_hi:[1,0,0]
v_pk_fma_f32 v[148:149], v[172:173], v[84:85], v[238:239] op_sel:[0,0,0] op_sel_hi:[1,0,0]
v_pk_fma_f32 v[150:151], v[174:175], v[84:85], v[238:239] op_sel:[0,0,0] op_sel_hi:[1,0,0]
v_pk_fma_f32 v[152:153], v[176:177], v[84:85], v[238:239] op_sel:[0,0,0] op_sel_hi:[1,0,0]
v_pk_fma_f32 v[154:155], v[178:179], v[84:85], v[238:239] op_sel:[0,0,0] op_sel_hi:[1,0,0]
v_pk_fma_f32 v[108:109], v[108:109], v[82:83], v[236:237] op_sel:[0,0,1] op_sel_hi:[1,0,1] neg_lo:[1,0,0] neg_hi:[1,0,0]
v_pk_fma_f32 v[110:111], v[110:111], v[82:83], v[236:237] op_sel:[0,0,1] op_sel_hi:[1,0,1] neg_lo:[1,0,0] neg_hi:[1,0,0]
v_pk_fma_f32 v[112:113], v[112:113], v[82:83], v[236:237] op_sel:[0,0,1] op_sel_hi:[1,0,1] neg_lo:[1,0,0] neg_hi:[1,0,0]
v_pk_fma_f32 v[114:115], v[114:115], v[82:83], v[236:237] op_sel:[0,0,1] op_sel_hi:[1,0,1] neg_lo:[1,0,0] neg_hi:[1,0,0]
v_pk_fma_f32 v[172:173], v[172:173], v[84:85], v[238:239] op_sel:[0,0,1] op_sel_hi:[1,0,1] neg_lo:[1,0,0] neg_hi:[1,0,0]
v_pk_fma_f32 v[174:175], v[174:175], v[84:85], v[238:239] op_sel:[0,0,1] op_sel_hi:[1,0,1] neg_lo:[1,0,0] neg_hi:[1,0,0]
v_pk_fma_f32 v[176:177], v[176:177], v[84:85], v[238:239] op_sel:[0,0,1] op_sel_hi:[1,0,1] neg_lo:[1,0,0] neg_hi:[1,0,0]
v_pk_fma_f32 v[178:179], v[178:179], v[84:85], v[238:239] op_sel:[0,0,1] op_sel_hi:[1,0,1] neg_lo:[1,0,0] neg_hi:[1,0,0]
v_exp_f32 v116, v116
v_exp_f32 v108, v108
v_exp_f32 v117, v117
v_exp_f32 v109, v109
v_exp_f32 v118, v118
v_exp_f32 v110, v110
v_exp_f32 v119, v119
v_exp_f32 v111, v111
v_exp_f32 v120, v120
v_exp_f32 v112, v112
v_exp_f32 v121, v121
v_exp_f32 v113, v113
v_exp_f32 v122, v122
v_exp_f32 v114, v114
v_exp_f32 v123, v123
v_exp_f32 v115, v115
v_exp_f32 v148, v148
v_exp_f32 v172, v172
v_exp_f32 v149, v149
v_exp_f32 v173, v173
v_exp_f32 v150, v150
v_exp_f32 v174, v174
v_exp_f32 v151, v151
v_exp_f32 v175, v175
v_exp_f32 v152, v152
v_exp_f32 v176, v176
v_exp_f32 v153, v153
v_exp_f32 v177, v177
v_exp_f32 v154, v154
v_exp_f32 v178, v178
v_exp_f32 v155, v155
v_exp_f32 v179, v179
buffer_load_dwordx4 v1, s[4:7], s44 offen offset:3072 sc1 lds
v_cvt_pk_bf16_f32 v140, v116, v117
v_cvt_pk_bf16_f32 v141, v118, v119
v_cvt_pk_bf16_f32 v142, v120, v121
v_cvt_pk_bf16_f32 v143, v122, v123
v_cvt_pk_bf16_f32 v144, v108, v109
L_stub8:
s_cbranch_execz L_wret2
v_cvt_pk_bf16_f32 v145, v110, v111
v_cvt_pk_bf16_f32 v146, v112, v113
v_cvt_pk_bf16_f32 v147, v114, v115
v_cvt_pk_bf16_f32 v164, v148, v149
v_cvt_pk_bf16_f32 v165, v150, v151
v_cvt_pk_bf16_f32 v166, v152, v153
v_cvt_pk_bf16_f32 v167, v154, v155
v_cvt_pk_bf16_f32 v168, v172, v173
v_cvt_pk_bf16_f32 v169, v174, v175
v_cvt_pk_bf16_f32 v170, v176, v177
v_cvt_pk_bf16_f32 v171, v178, v179
s_waitcnt vmcnt(2)
v_readfirstlane_b32 s38, v11
s_nop 0
s_cmp_ge_u32 s38, 8
s_cbranch_scc1 Lpe_21
s_add_u32 s36, s88, 0x80000
s_mov_b32 s37, 0
Lpoll_20:
v_mov_b32 v11, 0
buffer_atomic_add v11, v251, s[4:7], s36 offen sc0 sc1
s_add_u32 s37, s37, 1
s_waitcnt vmcnt(0)
v_readfirstlane_b32 s38, v11
s_nop 0
s_cmp_ge_u32 s38, 8
s_cbranch_scc1 Lpe_21
s_cmp_lt_u32 s37, 0x100000
s_cbranch_scc1 Lpoll_20
Lpe_21:
buffer_load_dwordx4 v[48:51], v1, s[4:7], s98 offen offset:0 sc1
v_mfma_f32_16x16x32_bf16 v[108:111], a[240:243], v[180:183], 0
v_mfma_f32_16x16x32_bf16 v[220:223], a[240:243], v[204:207], 0
v_mfma_f32_16x16x32_bf16 v[112:115], a[244:247], v[180:183], 0
s_nop 5
v_max3_f32 v240, v108, v109, v110
v_max3_f32 v241, -v108, -v109, -v110
v_mfma_f32_16x16x32_bf16 v[224:227], a[244:247], v[204:207], 0
buffer_load_dwordx4 v[124:127], v248, s[4:7], s100 offen sc1
v_max3_f32 v242, v220, v221, v222
v_max3_f32 v243, -v220, -v221, -v222
v_max3_f32 v240, v240, v111, v112
v_max3_f32 v241, v241, -v111, -v112
v_max3_f32 v240, v240, v113, v114
s_nop 1
v_max3_f32 v242, v242, v223, v224
v_max3_f32 v243, v243, -v223, -v224
v_max3_f32 v241, v241, -v113, -v114
v_max3_f32 v242, v242, v225, v226
v_max3_f32 v243, v243, -v225, -v226
v_max_f32 v240, v240, v115
v_max_f32_e64 v241, v241, -v115
v_max_f32 v242, v242, v227
buffer_load_dwordx4 v[52:55], v1, s[4:7], s98 offen offset:1024 sc1
v_max_f32_e64 v243, v243, -v227
v_permlane32_swap_b32 v240, v241
s_nop 0
v_permlane32_swap_b32 v242, v243
v_max_f32 v240, v240, v241
v_max_f32 v242, v242, v243
v_mov_b32 v246, v240
v_mov_b32 v247, v242
s_nop 0
v_permlane16_swap_b32 v240, v246
v_permlane16_swap_b32 v242, v247
buffer_load_dwordx4 v[56:59], v1, s[4:7], s98 offen offset:2048 sc1
v_max_f32 v240, v240, v246
v_max_f32 v242, v242, v247
v_mov_b32 v246, v240
v_mov_b32 v247, v242
s_nop 0
v_permlane32_swap_b32 v240, v246
v_permlane32_swap_b32 v242, v247
v_mul_f32_e64 v240, -v240, v86
v_mul_f32_e64 v241, -v246, v86
v_mul_f32_e64 v242, -v242, v88
v_mul_f32_e64 v243, -v247, v88
buffer_load_dwordx4 v[60:63], v1, s[4:7], s98 offen offset:3072 sc1
v_pk_fma_f32 v[116:117], v[108:109], v[86:87], v[240:241] op_sel:[0,0,0] op_sel_hi:[1,0,0]
v_pk_fma_f32 v[118:119], v[110:111], v[86:87], v[240:241] op_sel:[0,0,0] op_sel_hi:[1,0,0]
v_pk_fma_f32 v[120:121], v[112:113], v[86:87], v[240:241] op_sel:[0,0,0] op_sel_hi:[1,0,0]
v_pk_fma_f32 v[122:123], v[114:115], v[86:87], v[240:241] op_sel:[0,0,0] op_sel_hi:[1,0,0]
v_pk_fma_f32 v[196:197], v[220:221], v[88:89], v[242:243] op_sel:[0,0,0] op_sel_hi:[1,0,0]
v_pk_fma_f32 v[198:199], v[222:223], v[88:89], v[242:243] op_sel:[0,0,0] op_sel_hi:[1,0,0]
v_pk_fma_f32 v[200:201], v[224:225], v[88:89], v[242:243] op_sel:[0,0,0] op_sel_hi:[1,0,0]
v_pk_fma_f32 v[202:203], v[226:227], v[88:89], v[242:243] op_sel:[0,0,0] op_sel_hi:[1,0,0]
v_pk_fma_f32 v[108:109], v[108:109], v[86:87], v[240:241] op_sel:[0,0,1] op_sel_hi:[1,0,1] neg_lo:[1,0,0] neg_hi:[1,0,0]
v_pk_fma_f32 v[110:111], v[110:111], v[86:87], v[240:241] op_sel:[0,0,1] op_sel_hi:[1,0,1] neg_lo:[1,0,0] neg_hi:[1,0,0]
v_pk_fma_f32 v[112:113], v[112:113], v[86:87], v[240:241] op_sel:[0,0,1] op_sel_hi:[1,0,1] neg_lo:[1,0,0] neg_hi:[1,0,0]
v_pk_fma_f32 v[114:115], v[114:115], v[86:87], v[240:241] op_sel:[0,0,1] op_sel_hi:[1,0,1] neg_lo:[1,0,0] neg_hi:[1,0,0]
v_pk_fma_f32 v[220:221], v[220:221], v[88:89], v[242:243] op_sel:[0,0,1] op_sel_hi:[1,0,1] neg_lo:[1,0,0] neg_hi:[1,0,0]
buffer_load_dwordx4 v[64:67], v1, s[4:7], s99 offen offset:0 sc1
v_pk_fma_f32 v[222:223], v[222:223], v[88:89], v[242:243] op_sel:[0,0,1] op_sel_hi:[1,0,1] neg_lo:[1,0,0] neg_hi:[1,0,0]
v_pk_fma_f32 v[224:225], v[224:225], v[88:89], v[242:243] op_sel:[0,0,1] op_sel_hi:[1,0,1] neg_lo:[1,0,0] neg_hi:[1,0,0]
v_pk_fma_f32 v[226:227], v[226:227], v[88:89], v[242:243] op_sel:[0,0,1] op_sel_hi:[1,0,1] neg_lo:[1,0,0] neg_hi:[1,0,0]
v_exp_f32 v116, v116
v_exp_f32 v108, v108
v_exp_f32 v117, v117
v_exp_f32 v109, v109
v_exp_f32 v118, v118
buffer_load_dwordx4 v[68:71], v1, s[4:7], s99 offen offset:1024 sc1
v_exp_f32 v110, v110
v_exp_f32 v119, v119
v_exp_f32 v111, v111
v_exp_f32 v120, v120
v_exp_f32 v112, v112
v_exp_f32 v121, v121
v_exp_f32 v113, v113
buffer_load_dwordx4 v[100:103], v1, s[4:7], s99 offen offset:2048 sc1
v_exp_f32 v122, v122
v_exp_f32 v114, v114
v_exp_f32 v123, v123
v_exp_f32 v115, v115
v_exp_f32 v196, v196
v_exp_f32 v220, v220
v_exp_f32 v197, v197
buffer_load_dwordx4 v[104:107], v1, s[4:7], s99 offen offset:3072 sc1
v_exp_f32 v221, v221
v_exp_f32 v198, v198
v_exp_f32 v222, v222
v_exp_f32 v199, v199
v_exp_f32 v223, v223
v_exp_f32 v200, v200
v_exp_f32 v224, v224
buffer_store_dwordx4 a[248:251], v2, s[4:7], s73 offen offset:0 sc1
v_exp_f32 v201, v201
v_exp_f32 v225, v225
v_exp_f32 v202, v202
v_exp_f32 v226, v226
v_exp_f32 v203, v203
v_exp_f32 v227, v227
v_cvt_pk_bf16_f32 v188, v116, v117
v_cvt_pk_bf16_f32 v189, v118, v119
v_cvt_pk_bf16_f32 v190, v120, v121
v_cvt_pk_bf16_f32 v191, v122, v123
v_cvt_pk_bf16_f32 v192, v108, v109
v_cvt_pk_bf16_f32 v193, v110, v111
v_cvt_pk_bf16_f32 v194, v112, v113
v_cvt_pk_bf16_f32 v195, v114, v115
v_cvt_pk_bf16_f32 v212, v196, v197
v_cvt_pk_bf16_f32 v213, v198, v199
v_cvt_pk_bf16_f32 v214, v200, v201
v_cvt_pk_bf16_f32 v215, v202, v203
v_cvt_pk_bf16_f32 v216, v220, v221
v_cvt_pk_bf16_f32 v217, v222, v223
v_cvt_pk_bf16_f32 v218, v224, v225
v_cvt_pk_bf16_f32 v219, v226, v227
buffer_store_dwordx4 a[248:251], v2, s[4:7], s73 offen offset:1024 sc1
s_waitcnt vmcnt(10)
v_lshlrev_b32 v92, 16, v48
v_and_b32 v93, 0xffff0000, v48
v_lshlrev_b32 v94, 16, v49
v_and_b32 v95, 0xffff0000, v49
v_lshlrev_b32 v96, 16, v50
v_and_b32 v97, 0xffff0000, v50
v_lshlrev_b32 v98, 16, v51
v_and_b32 v99, 0xffff0000, v51
s_waitcnt vmcnt(9)
v_add_f32_dpp v128, v124, v124 row_ror:4 row_mask:0xf bank_mask:0xf
v_add_f32_dpp v129, v125, v125 row_ror:4 row_mask:0xf bank_mask:0xf
v_add_f32_dpp v130, v126, v126 row_ror:4 row_mask:0xf bank_mask:0xf
v_add_f32_dpp v131, v127, v127 row_ror:4 row_mask:0xf bank_mask:0xf
v_add_f32_dpp v128, v128, v128 row_ror:2 row_mask:0xf bank_mask:0xf
v_add_f32_dpp v129, v129, v129 row_ror:2 row_mask:0xf bank_mask:0xf
v_add_f32_dpp v130, v130, v130 row_ror:2 row_mask:0xf bank_mask:0xf
buffer_store_dwordx4 a[248:251], v2, s[4:7], s73 offen offset:2048 sc1
v_add_f32_dpp v131, v131, v131 row_ror:2 row_mask:0xf bank_mask:0xf
v_add_f32_dpp v128, v128, v128 row_ror:1 row_mask:0xf bank_mask:0xf
v_add_f32_dpp v129, v129, v129 row_ror:1 row_mask:0xf bank_mask:0xf
v_add_f32_dpp v130, v130, v130 row_ror:1 row_mask:0xf bank_mask:0xf
v_add_f32_dpp v131, v131, v131 row_ror:1 row_mask:0xf bank_mask:0xf
s_waitcnt vmcnt(9)
v_dot2c_f32_bf16 v92, v52, v249
v_dot2c_f32_bf16 v93, v52, v250
v_dot2c_f32_bf16 v94, v53, v249
v_dot2c_f32_bf16 v95, v53, v250
v_dot2c_f32_bf16 v96, v54, v249
v_dot2c_f32_bf16 v97, v54, v250
v_dot2c_f32_bf16 v98, v55, v249
v_dot2c_f32_bf16 v99, v55, v250
v_fma_f32 v135, v129, v130, v131
s_waitcnt vmcnt(8)
v_dot2c_f32_bf16 v92, v56, v249
v_dot2c_f32_bf16 v93, v56, v250
v_dot2c_f32_bf16 v94, v57, v249
v_dot2c_f32_bf16 v95, v57, v250
v_dot2c_f32_bf16 v96, v58, v249
v_dot2c_f32_bf16 v97, v58, v250
v_dot2c_f32_bf16 v98, v59, v249
v_dot2c_f32_bf16 v99, v59, v250
buffer_store_dwordx4 a[248:251], v2, s[4:7], s73 offen offset:3072 sc1
s_waitcnt vmcnt(8)
v_dot2c_f32_bf16 v92, v60, v249
v_dot2c_f32_bf16 v93, v60, v250
v_dot2c_f32_bf16 v94, v61, v249
v_dot2c_f32_bf16 v95, v61, v250
v_dot2c_f32_bf16 v96, v62, v249
v_dot2c_f32_bf16 v97, v62, v250
v_dot2c_f32_bf16 v98, v63, v249
v_dot2c_f32_bf16 v99, v63, v250
s_waitcnt vmcnt(7)
v_dot2c_f32_bf16 v92, v64, v249
v_dot2c_f32_bf16 v93, v64, v250
v_dot2c_f32_bf16 v94, v65, v249
v_dot2c_f32_bf16 v95, v65, v250
v_dot2c_f32_bf16 v96, v66, v249
v_dot2c_f32_bf16 v97, v66, v250
v_dot2c_f32_bf16 v98, v67, v249
v_dot2c_f32_bf16 v99, v67, v250
s_waitcnt vmcnt(6)
v_dot2c_f32_bf16 v92, v68, v249
v_dot2c_f32_bf16 v93, v68, v250
v_dot2c_f32_bf16 v94, v69, v249
v_dot2c_f32_bf16 v95, v69, v250
v_dot2c_f32_bf16 v96, v70, v249
v_dot2c_f32_bf16 v97, v70, v250
v_dot2c_f32_bf16 v98, v71, v249
v_dot2c_f32_bf16 v99, v71, v250
s_waitcnt vmcnt(5)
v_dot2c_f32_bf16 v92, v100, v249
v_dot2c_f32_bf16 v93, v100, v250
v_dot2c_f32_bf16 v94, v101, v249
v_dot2c_f32_bf16 v95, v101, v250
v_dot2c_f32_bf16 v96, v102, v249
v_dot2c_f32_bf16 v97, v102, v250
v_dot2c_f32_bf16 v98, v103, v249
v_dot2c_f32_bf16 v99, v103, v250
s_waitcnt vmcnt(4)
v_dot2c_f32_bf16 v92, v104, v249
v_dot2c_f32_bf16 v93, v104, v250
v_dot2c_f32_bf16 v94, v105, v249
v_dot2c_f32_bf16 v95, v105, v250
v_dot2c_f32_bf16 v96, v106, v249
v_dot2c_f32_bf16 v97, v106, v250
v_dot2c_f32_bf16 v98, v107, v249
v_dot2c_f32_bf16 v99, v107, v250
v_fma_f32 v132, v92, v93, v94
v_fma_f32 v133, v95, v96, v97
s_nop 0
v_fma_f32 v134, v98, v99, v128
v_fma_f32 v132, v132, v133, v134
v_cmp_u_f32 vcc, v132, v135
s_cbranch_vccnz L_kvredo1
L_kvback1:
v_cvt_pk_bf16_f32 v128, v128, v129
v_cvt_pk_bf16_f32 v129, v130, v131
v_cvt_pk_bf16_f32 v92, v92, v93
v_cndmask_b32 v128, 0, v128, s[56:57]
v_cndmask_b32 v129, 0, v129, s[56:57]
v_cvt_pk_bf16_f32 v93, v94, v95
v_cvt_pk_bf16_f32 v94, v96, v97
v_cvt_pk_bf16_f32 v95, v98, v99
v_cndmask_b32 v128, v128, v16, s[58:59]
v_cndmask_b32 v129, v129, v16, s[58:59]
ds_write_b64 v252, v[92:93] offset:0
ds_write_b64 v252, v[94:95] offset:1024
ds_write_b64 v252, v[128:129] offset:2048
s_waitcnt lgkmcnt(0)
s_barrier
ds_read_b128 a[8:11], v1 offset:2048
ds_read_b128 a[20:23], v1 offset:5120
ds_read_b128 a[0:3], v1 offset:0
ds_read_b128 a[12:15], v1 offset:3072
ds_read_b128 a[4:7], v1 offset:1024
ds_read_b128 a[16:19], v1 offset:4096
s_waitcnt lgkmcnt(5)
v_mfma_f32_16x16x32_bf16 v[116:119], a[8:11], v[212:215], 0
s_waitcnt lgkmcnt(4)
v_mfma_f32_16x16x32_bf16 v[120:123], a[20:23], v[216:219], 0
s_waitcnt lgkmcnt(3)
v_mfma_f32_16x16x32_bf16 v[204:207], a[0:3], v[212:215], 0
s_nop 3
v_rcp_f32 v118, v117
s_waitcnt lgkmcnt(2)
v_mfma_f32_16x16x32_bf16 v[220:223], a[12:15], v[216:219], 0
v_rcp_f32 v119, v121
v_mul_f32 v116, v116, v118
v_fmac_f32 v116, v120, v119
v_mfma_f32_16x16x32_bf16 v[100:103], a[8:11], v[164:167], 0
v_add_f32 v116, 0x358637bd, v116
v_rcp_f32 v116, v116
s_waitcnt lgkmcnt(1)
v_mfma_f32_16x16x32_bf16 v[208:211], a[4:7], v[212:215], 0
v_mul_f32 v118, v118, v116
v_mul_f32 v119, v119, v116
v_mfma_f32_16x16x32_bf16 v[104:107], a[20:23], v[168:171], 0
v_mul_f32 v204, v204, v118
v_mul_f32 v205, v205, v118
s_waitcnt lgkmcnt(0)
v_mfma_f32_16x16x32_bf16 v[224:227], a[16:19], v[216:219], 0
v_mul_f32 v206, v206, v118
v_mul_f32 v207, v207, v118
v_fmac_f32 v204, v220, v119
v_fmac_f32 v205, v221, v119
v_rcp_f32 v102, v101
v_mul_f32 v208, v208, v118
v_mul_f32 v209, v209, v118
v_mul_f32 v210, v210, v118
v_mul_f32 v211, v211, v118
v_fmac_f32 v206, v222, v119
v_fmac_f32 v207, v223, v119
v_cvt_pk_bf16_f32 v204, v204, v205
v_rcp_f32 v103, v105
v_fmac_f32 v208, v224, v119
v_fmac_f32 v209, v225, v119
v_fmac_f32 v210, v226, v119
v_fmac_f32 v211, v227, v119
v_cvt_pk_bf16_f32 v205, v206, v207
v_cvt_pk_bf16_f32 v206, v208, v209
v_cvt_pk_bf16_f32 v207, v210, v211
v_mul_f32 v100, v100, v102
v_mfma_f32_16x16x32_bf16 v[156:159], a[0:3], v[164:167], 0
buffer_store_dwordx4 v[204:207], v2, s[4:7], s72 offen offset:3072 sc1
v_fmac_f32 v100, v104, v103
v_mfma_f32_16x16x32_bf16 v[172:175], a[12:15], v[168:171], 0
v_add_f32 v100, 0x358637bd, v100
v_rcp_f32 v100, v100
v_mfma_f32_16x16x32_bf16 v[108:111], a[8:11], v[188:191], 0
v_mul_f32 v102, v102, v100
v_mul_f32 v103, v103, v100
v_mfma_f32_16x16x32_bf16 v[160:163], a[4:7], v[164:167], 0
v_mul_f32 v156, v156, v102
v_mul_f32 v157, v157, v102
v_mfma_f32_16x16x32_bf16 v[112:115], a[20:23], v[192:195], 0
v_mul_f32 v158, v158, v102
v_mul_f32 v159, v159, v102
v_mfma_f32_16x16x32_bf16 v[176:179], a[16:19], v[168:171], 0
v_fmac_f32 v156, v172, v103
v_fmac_f32 v157, v173, v103
v_rcp_f32 v110, v109
v_mul_f32 v160, v160, v102
v_mul_f32 v161, v161, v102
v_mul_f32 v162, v162, v102
v_mul_f32 v163, v163, v102
v_fmac_f32 v158, v174, v103
v_fmac_f32 v159, v175, v103
v_cvt_pk_bf16_f32 v156, v156, v157
v_rcp_f32 v111, v113
v_fmac_f32 v160, v176, v103
v_fmac_f32 v161, v177, v103
v_fmac_f32 v162, v178, v103
v_fmac_f32 v163, v179, v103
v_cvt_pk_bf16_f32 v157, v158, v159
v_cvt_pk_bf16_f32 v158, v160, v161
v_cvt_pk_bf16_f32 v159, v162, v163
v_mul_f32 v108, v108, v110
v_mfma_f32_16x16x32_bf16 v[180:183], a[0:3], v[188:191], 0
buffer_store_dwordx4 v[156:159], v2, s[4:7], s72 offen offset:1024 sc1
v_fmac_f32 v108, v112, v111
v_mfma_f32_16x16x32_bf16 v[196:199], a[12:15], v[192:195], 0
v_add_f32 v108, 0x358637bd, v108
v_rcp_f32 v108, v108
v_mfma_f32_16x16x32_bf16 v[92:95], a[8:11], v[140:143], 0
v_mul_f32 v110, v110, v108
v_mul_f32 v111, v111, v108
v_mfma_f32_16x16x32_bf16 v[184:187], a[4:7], v[188:191], 0
v_mul_f32 v180, v180, v110
v_mul_f32 v181, v181, v110
v_mfma_f32_16x16x32_bf16 v[96:99], a[20:23], v[144:147], 0
v_mul_f32 v182, v182, v110
v_mul_f32 v183, v183, v110
v_mfma_f32_16x16x32_bf16 v[200:203], a[16:19], v[192:195], 0
v_fmac_f32 v180, v196, v111
v_fmac_f32 v181, v197, v111
v_rcp_f32 v94, v93
v_mul_f32 v184, v184, v110
v_mul_f32 v185, v185, v110
v_mul_f32 v186, v186, v110
v_mul_f32 v187, v187, v110
v_fmac_f32 v182, v198, v111
v_fmac_f32 v183, v199, v111
v_cvt_pk_bf16_f32 v180, v180, v181
v_rcp_f32 v95, v97
buffer_atomic_add v12, v10, s[4:7], s74 offen sc1
v_fmac_f32 v184, v200, v111
v_fmac_f32 v185, v201, v111
v_fmac_f32 v186, v202, v111
v_fmac_f32 v187, v203, v111
v_cvt_pk_bf16_f32 v181, v182, v183
v_cvt_pk_bf16_f32 v182, v184, v185
v_cvt_pk_bf16_f32 v183, v186, v187
v_mul_f32 v92, v92, v94
v_mfma_f32_16x16x32_bf16 v[132:135], a[0:3], v[140:143], 0
buffer_store_dwordx4 v[180:183], v2, s[4:7], s72 offen offset:2048 sc1
v_fmac_f32 v92, v96, v95
v_mfma_f32_16x16x32_bf16 v[148:151], a[12:15], v[144:147], 0
v_add_f32 v92, 0x358637bd, v92
v_rcp_f32 v92, v92
v_mfma_f32_16x16x32_bf16 v[136:139], a[4:7], v[140:143], 0
v_mul_f32 v94, v94, v92
v_mul_f32 v95, v95, v92
v_mfma_f32_16x16x32_bf16 v[152:155], a[16:19], v[144:147], 0
v_mul_f32 v132, v132, v94
v_mul_f32 v133, v133, v94
v_mul_f32 v134, v134, v94
v_mul_f32 v135, v135, v94
v_fmac_f32 v132, v148, v95
v_fmac_f32 v133, v149, v95
v_mul_f32 v136, v136, v94
v_mul_f32 v137, v137, v94
v_mul_f32 v138, v138, v94
v_mul_f32 v139, v139, v94
v_fmac_f32 v134, v150, v95
v_fmac_f32 v135, v151, v95
v_cvt_pk_bf16_f32 v132, v132, v133
v_fmac_f32 v136, v152, v95
v_fmac_f32 v137, v153, v95
v_fmac_f32 v138, v154, v95
v_fmac_f32 v139, v155, v95
v_cvt_pk_bf16_f32 v133, v134, v135
v_cvt_pk_bf16_f32 v134, v136, v137
v_cvt_pk_bf16_f32 v135, v138, v139
buffer_store_dwordx4 v[132:135], v2, s[4:7], s72 offen offset:0 sc1
s_add_u32 s92, s71, 0x10000
s_add_u32 s36, s66, 0x10080
s_add_u32 s40, s4, 0x2600000
s_addc_u32 s41, s5, 0
v_add_u32 v5, 32768, v1
v_add_u32 v6, 98304, v1
s_cmp_eq_u32 s3, 0
s_cselect_b32 s35, 8, 0
s_lshl_b32 s35, s35, 12
v_lshlrev_b32 v132, 16, v32
v_and_b32 v133, 0xffff0000, v32
v_lshlrev_b32 v134, 16, v33
v_and_b32 v135, 0xffff0000, v33
v_lshlrev_b32 v136, 16, v34
v_and_b32 v137, 0xffff0000, v34
v_lshlrev_b32 v138, 16, v35
v_and_b32 v139, 0xffff0000, v35
v_lshlrev_b32 v140, 16, v36
v_and_b32 v141, 0xffff0000, v36
v_lshlrev_b32 v142, 16, v37
v_and_b32 v143, 0xffff0000, v37
v_lshlrev_b32 v144, 16, v38
v_and_b32 v145, 0xffff0000, v38
v_lshlrev_b32 v146, 16, v39
v_and_b32 v147, 0xffff0000, v39
v_lshlrev_b32 v148, 16, v40
v_and_b32 v149, 0xffff0000, v40
v_lshlrev_b32 v150, 16, v41
v_and_b32 v151, 0xffff0000, v41
v_lshlrev_b32 v152, 16, v42
v_and_b32 v153, 0xffff0000, v42
v_lshlrev_b32 v154, 16, v43
v_and_b32 v155, 0xffff0000, v43
v_lshlrev_b32 v156, 16, v44
v_and_b32 v157, 0xffff0000, v44
v_lshlrev_b32 v158, 16, v45
v_and_b32 v159, 0xffff0000, v45
v_lshlrev_b32 v160, 16, v46
v_and_b32 v161, 0xffff0000, v46
v_lshlrev_b32 v162, 16, v47
v_and_b32 v163, 0xffff0000, v47
s_mov_b32 s95, -1
s_mov_b64 exec, 0
s_cmp_eq_u32 s28, 3
s_cbranch_scc1 L_stub9
s_cmp_eq_u32 s28, 2
s_cbranch_scc1 L_wret3
L_wret3:
s_mov_b64 exec, -1
s_cmp_lg_u32 s28, 0
s_cbranch_scc1 Lpo_24
s_add_u32 s36, s66, 0x10080
s_mov_b32 s37, 0
v_mov_b32 v11, 0
buffer_atomic_add v11, v251, s[4:7], s36 offen sc0 sc1
s_sleep 4
Lpoll_22:
v_mov_b32 v234, 0
buffer_atomic_add v234, v251, s[4:7], s36 offen sc0 sc1
s_waitcnt vmcnt(1)
v_readfirstlane_b32 s38, v11
s_nop 0
s_cmp_ge_u32 s38, 32
s_cbranch_scc1 Lpe_23
v_mov_b32 v11, 0
buffer_atomic_add v11, v251, s[4:7], s36 offen sc0 sc1
s_waitcnt vmcnt(1)
v_readfirstlane_b32 s38, v234
s_nop 0
s_cmp_ge_u32 s38, 32
s_cbranch_scc1 Lpe_23
s_add_u32 s37, s37, 1
s_cmp_lt_u32 s37, 0x80000
s_cbranch_scc1 Lpoll_22
s_waitcnt vmcnt(0)
Lpo_24:
s_waitcnt vmcnt(0)
Lpe_23:
s_barrier
L_k2go1:
buffer_load_dwordx4 a[0:3], v4, s[40:43], s35 offen offset:0 sc1
buffer_load_dwordx4 a[4:7], v4, s[40:43], s35 offen offset:1024 sc1
s_cmp_eq_u32 s3, 1
s_cselect_b32 s35, 9, 1
s_lshl_b32 s35, s35, 12
buffer_load_dwordx4 a[8:11], v4, s[40:43], s35 offen offset:0 sc1
buffer_load_dwordx4 a[12:15], v4, s[40:43], s35 offen offset:1024 sc1
s_cmp_eq_u32 s3, 2
s_cselect_b32 s35, 10, 2
s_lshl_b32 s35, s35, 12
buffer_load_dwordx4 a[16:19], v4, s[40:43], s35 offen offset:0 sc1
buffer_load_dwordx4 a[20:23], v4, s[40:43], s35 offen offset:1024 sc1
s_cmp_eq_u32 s3, 3
s_cselect_b32 s35, 11, 3
s_lshl_b32 s35, s35, 12
buffer_load_dwordx4 a[24:27], v4, s[40:43], s35 offen offset:0 sc1
buffer_load_dwordx4 a[28:31], v4, s[40:43], s35 offen offset:1024 sc1
s_cmp_eq_u32 s3, 4
s_cselect_b32 s35, 12, 4
s_lshl_b32 s35, s35, 12
buffer_load_dwordx4 a[32:35], v4, s[40:43], s35 offen offset:0 sc1
buffer_load_dwordx4 a[36:39], v4, s[40:43], s35 offen offset:1024 sc1
s_cmp_eq_u32 s3, 5
s_cselect_b32 s35, 13, 5
s_lshl_b32 s35, s35, 12
buffer_load_dwordx4 a[40:43], v4, s[40:43], s35 offen offset:0 sc1
buffer_load_dwordx4 a[44:47], v4, s[40:43], s35 offen offset:1024 sc1
s_cmp_eq_u32 s3, 6
s_cselect_b32 s35, 14, 6
s_lshl_b32 s35, s35, 12
ds_read_b128 a[96:99], v5 offset:0
ds_read_b128 a[100:103], v5 offset:1024
ds_read_b128 a[104:107], v5 offset:2048
ds_read_b128 a[108:111], v5 offset:3072
ds_read_b128 a[112:115], v5 offset:4096
ds_read_b128 a[116:119], v5 offset:5120
ds_read_b128 a[120:123], v5 offset:6144
ds_read_b128 a[124:127], v5 offset:7168
s_waitcnt vmcnt(10) lgkmcnt(4)
v_mfma_f32_16x16x32_bf16 v[132:135], a[96:99], a[0:3], v[132:135]
ds_read_b128 a[128:131], v5 offset:8192
v_mfma_f32_16x16x32_bf16 v[148:151], a[96:99], a[4:7], v[148:151]
ds_read_b128 a[132:135], v5 offset:9216
v_mfma_f32_16x16x32_bf16 v[152:155], a[100:103], a[4:7], v[152:155]
buffer_load_dwordx4 a[48:51], v4, s[40:43], s35 offen offset:0 sc1
v_mfma_f32_16x16x32_bf16 v[136:139], a[100:103], a[0:3], v[136:139]
ds_read_b128 a[136:139], v5 offset:10240
v_mfma_f32_16x16x32_bf16 v[140:143], a[104:107], a[0:3], v[140:143]
ds_read_b128 a[140:143], v5 offset:11264
v_mfma_f32_16x16x32_bf16 v[156:159], a[104:107], a[4:7], v[156:159]
v_mfma_f32_16x16x32_bf16 v[160:163], a[108:111], a[4:7], v[160:163]
buffer_load_dwordx4 a[52:55], v4, s[40:43], s35 offen offset:1024 sc1
v_mfma_f32_16x16x32_bf16 v[144:147], a[108:111], a[0:3], v[144:147]
s_waitcnt vmcnt(10) lgkmcnt(4)
v_mfma_f32_16x16x32_bf16 v[132:135], a[112:115], a[8:11], v[132:135]
s_cmp_eq_u32 s3, 7
s_cselect_b32 s35, 15, 7
s_lshl_b32 s35, s35, 12
v_mfma_f32_16x16x32_bf16 v[148:151], a[112:115], a[12:15], v[148:151]
ds_read_b128 a[96:99], v5 offset:12288
v_mfma_f32_16x16x32_bf16 v[152:155], a[116:119], a[12:15], v[152:155]
buffer_load_dwordx4 a[0:3], v4, s[40:43], s35 offen offset:0 sc1
v_mfma_f32_16x16x32_bf16 v[136:139], a[116:119], a[8:11], v[136:139]
ds_read_b128 a[100:103], v5 offset:13312
v_mfma_f32_16x16x32_bf16 v[140:143], a[120:123], a[8:11], v[140:143]
ds_read_b128 a[104:107], v5 offset:14336
v_mfma_f32_16x16x32_bf16 v[156:159], a[120:123], a[12:15], v[156:159]
ds_read_b128 a[108:111], v5 offset:15360
v_mfma_f32_16x16x32_bf16 v[160:163], a[124:127], a[12:15], v[160:163]
buffer_load_dwordx4 a[4:7], v4, s[40:43], s35 offen offset:1024 sc1
v_mfma_f32_16x16x32_bf16 v[144:147], a[124:127], a[8:11], v[144:147]
s_waitcnt vmcnt(10) lgkmcnt(4)
v_mfma_f32_16x16x32_bf16 v[132:135], a[128:131], a[16:19], v[132:135]
s_cmp_eq_u32 s3, 0
s_cselect_b32 s35, 16, 8
s_lshl_b32 s35, s35, 12
v_mfma_f32_16x16x32_bf16 v[148:151], a[128:131], a[20:23], v[148:151]
ds_read_b128 a[112:115], v5 offset:16384
v_mfma_f32_16x16x32_bf16 v[152:155], a[132:135], a[20:23], v[152:155]
buffer_load_dwordx4 a[8:11], v4, s[40:43], s35 offen offset:0 sc1
v_mfma_f32_16x16x32_bf16 v[136:139], a[132:135], a[16:19], v[136:139]
ds_read_b128 a[116:119], v5 offset:17408
v_mfma_f32_16x16x32_bf16 v[140:143], a[136:139], a[16:19], v[140:143]
ds_read_b128 a[120:123], v5 offset:18432
v_mfma_f32_16x16x32_bf16 v[156:159], a[136:139], a[20:23], v[156:159]
ds_read_b128 a[124:127], v5 offset:19456
v_mfma_f32_16x16x32_bf16 v[160:163], a[140:143], a[20:23], v[160:163]
buffer_load_dwordx4 a[12:15], v4, s[40:43], s35 offen offset:1024 sc1
v_mfma_f32_16x16x32_bf16 v[144:147], a[140:143], a[16:19], v[144:147]
s_waitcnt vmcnt(10) lgkmcnt(4)
v_mfma_f32_16x16x32_bf16 v[132:135], a[96:99], a[24:27], v[132:135]
s_cmp_eq_u32 s3, 1
s_cselect_b32 s35, 17, 9
s_lshl_b32 s35, s35, 12
v_mfma_f32_16x16x32_bf16 v[148:151], a[96:99], a[28:31], v[148:151]
ds_read_b128 a[128:131], v5 offset:20480
v_mfma_f32_16x16x32_bf16 v[152:155], a[100:103], a[28:31], v[152:155]
buffer_load_dwordx4 a[16:19], v4, s[40:43], s35 offen offset:0 sc1
v_mfma_f32_16x16x32_bf16 v[136:139], a[100:103], a[24:27], v[136:139]
ds_read_b128 a[132:135], v5 offset:21504
v_mfma_f32_16x16x32_bf16 v[140:143], a[104:107], a[24:27], v[140:143]
ds_read_b128 a[136:139], v5 offset:22528
v_mfma_f32_16x16x32_bf16 v[156:159], a[104:107], a[28:31], v[156:159]
ds_read_b128 a[140:143], v5 offset:23552
v_mfma_f32_16x16x32_bf16 v[160:163], a[108:111], a[28:31], v[160:163]
buffer_load_dwordx4 a[20:23], v4, s[40:43], s35 offen offset:1024 sc1
v_mfma_f32_16x16x32_bf16 v[144:147], a[108:111], a[24:27], v[144:147]
s_waitcnt vmcnt(10) lgkmcnt(4)
v_mfma_f32_16x16x32_bf16 v[132:135], a[112:115], a[32:35], v[132:135]
s_cmp_eq_u32 s3, 2
s_cselect_b32 s35, 18, 10
s_lshl_b32 s35, s35, 12
v_mfma_f32_16x16x32_bf16 v[148:151], a[112:115], a[36:39], v[148:151]
ds_read_b128 a[96:99], v5 offset:24576
v_mfma_f32_16x16x32_bf16 v[152:155], a[116:119], a[36:39], v[152:155]
buffer_load_dwordx4 a[24:27], v4, s[40:43], s35 offen offset:0 sc1
v_mfma_f32_16x16x32_bf16 v[136:139], a[116:119], a[32:35], v[136:139]
ds_read_b128 a[100:103], v5 offset:25600
v_mfma_f32_16x16x32_bf16 v[140:143], a[120:123], a[32:35], v[140:143]
ds_read_b128 a[104:107], v5 offset:26624
v_mfma_f32_16x16x32_bf16 v[156:159], a[120:123], a[36:39], v[156:159]
ds_read_b128 a[108:111], v5 offset:27648
v_mfma_f32_16x16x32_bf16 v[160:163], a[124:127], a[36:39], v[160:163]
buffer_load_dwordx4 a[28:31], v4, s[40:43], s35 offen offset:1024 sc1
v_mfma_f32_16x16x32_bf16 v[144:147], a[124:127], a[32:35], v[144:147]
s_waitcnt vmcnt(10) lgkmcnt(4)
v_mfma_f32_16x16x32_bf16 v[132:135], a[128:131], a[40:43], v[132:135]
s_cmp_eq_u32 s3, 3
s_cselect_b32 s35, 19, 11
s_lshl_b32 s35, s35, 12
v_mfma_f32_16x16x32_bf16 v[148:151], a[128:131], a[44:47], v[148:151]
ds_read_b128 a[112:115], v5 offset:28672
v_mfma_f32_16x16x32_bf16 v[152:155], a[132:135], a[44:47], v[152:155]
buffer_load_dwordx4 a[32:35], v4, s[40:43], s35 offen offset:0 sc1
v_mfma_f32_16x16x32_bf16 v[136:139], a[132:135], a[40:43], v[136:139]
ds_read_b128 a[116:119], v5 offset:29696
v_mfma_f32_16x16x32_bf16 v[140:143], a[136:139], a[40:43], v[140:143]
ds_read_b128 a[120:123], v5 offset:30720
v_mfma_f32_16x16x32_bf16 v[156:159], a[136:139], a[44:47], v[156:159]
ds_read_b128 a[124:127], v5 offset:31744
v_mfma_f32_16x16x32_bf16 v[160:163], a[140:143], a[44:47], v[160:163]
buffer_load_dwordx4 a[36:39], v4, s[40:43], s35 offen offset:1024 sc1
v_mfma_f32_16x16x32_bf16 v[144:147], a[140:143], a[40:43], v[144:147]
s_waitcnt vmcnt(10) lgkmcnt(4)
v_mfma_f32_16x16x32_bf16 v[132:135], a[96:99], a[48:51], v[132:135]
s_cmp_eq_u32 s3, 4
s_cselect_b32 s35, 20, 12
s_lshl_b32 s35, s35, 12
v_mfma_f32_16x16x32_bf16 v[148:151], a[96:99], a[52:55], v[148:151]
ds_read_b128 a[128:131], v5 offset:32768
v_mfma_f32_16x16x32_bf16 v[152:155], a[100:103], a[52:55], v[152:155]
buffer_load_dwordx4 a[40:43], v4, s[40:43], s35 offen offset:0 sc1
v_mfma_f32_16x16x32_bf16 v[136:139], a[100:103], a[48:51], v[136:139]
ds_read_b128 a[132:135], v5 offset:33792
v_mfma_f32_16x16x32_bf16 v[140:143], a[104:107], a[48:51], v[140:143]
ds_read_b128 a[136:139], v5 offset:34816
v_mfma_f32_16x16x32_bf16 v[156:159], a[104:107], a[52:55], v[156:159]
ds_read_b128 a[140:143], v5 offset:35840
v_mfma_f32_16x16x32_bf16 v[160:163], a[108:111], a[52:55], v[160:163]
buffer_load_dwordx4 a[44:47], v4, s[40:43], s35 offen offset:1024 sc1
v_mfma_f32_16x16x32_bf16 v[144:147], a[108:111], a[48:51], v[144:147]
s_waitcnt vmcnt(10) lgkmcnt(4)
v_mfma_f32_16x16x32_bf16 v[132:135], a[112:115], a[0:3], v[132:135]
s_cmp_eq_u32 s3, 5
s_cselect_b32 s35, 21, 13
s_lshl_b32 s35, s35, 12
v_mfma_f32_16x16x32_bf16 v[148:151], a[112:115], a[4:7], v[148:151]
ds_read_b128 a[96:99], v5 offset:36864
v_mfma_f32_16x16x32_bf16 v[152:155], a[116:119], a[4:7], v[152:155]
buffer_load_dwordx4 a[48:51], v4, s[40:43], s35 offen offset:0 sc1
v_mfma_f32_16x16x32_bf16 v[136:139], a[116:119], a[0:3], v[136:139]
ds_read_b128 a[100:103], v5 offset:37888
v_mfma_f32_16x16x32_bf16 v[140:143], a[120:123], a[0:3], v[140:143]
ds_read_b128 a[104:107], v5 offset:38912
v_mfma_f32_16x16x32_bf16 v[156:159], a[120:123], a[4:7], v[156:159]
ds_read_b128 a[108:111], v5 offset:39936
v_mfma_f32_16x16x32_bf16 v[160:163], a[124:127], a[4:7], v[160:163]
buffer_load_dwordx4 a[52:55], v4, s[40:43], s35 offen offset:1024 sc1
v_mfma_f32_16x16x32_bf16 v[144:147], a[124:127], a[0:3], v[144:147]
s_waitcnt vmcnt(10) lgkmcnt(4)
v_mfma_f32_16x16x32_bf16 v[132:135], a[128:131], a[8:11], v[132:135]
s_cmp_eq_u32 s3, 6
s_cselect_b32 s35, 22, 14
s_lshl_b32 s35, s35, 12
v_mfma_f32_16x16x32_bf16 v[148:151], a[128:131], a[12:15], v[148:151]
ds_read_b128 a[112:115], v5 offset:40960
v_mfma_f32_16x16x32_bf16 v[152:155], a[132:135], a[12:15], v[152:155]
buffer_load_dwordx4 a[0:3], v4, s[40:43], s35 offen offset:0 sc1
v_mfma_f32_16x16x32_bf16 v[136:139], a[132:135], a[8:11], v[136:139]
ds_read_b128 a[116:119], v5 offset:41984
v_mfma_f32_16x16x32_bf16 v[140:143], a[136:139], a[8:11], v[140:143]
ds_read_b128 a[120:123], v5 offset:43008
v_mfma_f32_16x16x32_bf16 v[156:159], a[136:139], a[12:15], v[156:159]
ds_read_b128 a[124:127], v5 offset:44032
v_mfma_f32_16x16x32_bf16 v[160:163], a[140:143], a[12:15], v[160:163]
buffer_load_dwordx4 a[4:7], v4, s[40:43], s35 offen offset:1024 sc1
v_mfma_f32_16x16x32_bf16 v[144:147], a[140:143], a[8:11], v[144:147]
L_stub9:
s_cbranch_execz L_wret3
s_waitcnt vmcnt(10) lgkmcnt(4)
v_mfma_f32_16x16x32_bf16 v[132:135], a[96:99], a[16:19], v[132:135]
s_cmp_eq_u32 s3, 7
s_cselect_b32 s35, 23, 15
s_lshl_b32 s35, s35, 12
v_mfma_f32_16x16x32_bf16 v[148:151], a[96:99], a[20:23], v[148:151]
ds_read_b128 a[128:131], v5 offset:45056
v_mfma_f32_16x16x32_bf16 v[152:155], a[100:103], a[20:23], v[152:155]
buffer_load_dwordx4 a[8:11], v4, s[40:43], s35 offen offset:0 sc1
v_mfma_f32_16x16x32_bf16 v[136:139], a[100:103], a[16:19], v[136:139]
ds_read_b128 a[132:135], v5 offset:46080
v_mfma_f32_16x16x32_bf16 v[140:143], a[104:107], a[16:19], v[140:143]
ds_read_b128 a[136:139], v5 offset:47104
v_mfma_f32_16x16x32_bf16 v[156:159], a[104:107], a[20:23], v[156:159]
ds_read_b128 a[140:143], v5 offset:48128
v_mfma_f32_16x16x32_bf16 v[160:163], a[108:111], a[20:23], v[160:163]
buffer_load_dwordx4 a[12:15], v4, s[40:43], s35 offen offset:1024 sc1
v_mfma_f32_16x16x32_bf16 v[144:147], a[108:111], a[16:19], v[144:147]
s_waitcnt vmcnt(10) lgkmcnt(4)
v_mfma_f32_16x16x32_bf16 v[132:135], a[112:115], a[24:27], v[132:135]
s_cmp_eq_u32 s3, 0
s_cselect_b32 s35, 24, 16
s_lshl_b32 s35, s35, 12
v_mfma_f32_16x16x32_bf16 v[148:151], a[112:115], a[28:31], v[148:151]
ds_read_b128 a[96:99], v5 offset:49152
v_mfma_f32_16x16x32_bf16 v[152:155], a[116:119], a[28:31], v[152:155]
buffer_load_dwordx4 a[16:19], v4, s[40:43], s35 offen offset:0 sc1
v_mfma_f32_16x16x32_bf16 v[136:139], a[116:119], a[24:27], v[136:139]
ds_read_b128 a[100:103], v5 offset:50176
v_mfma_f32_16x16x32_bf16 v[140:143], a[120:123], a[24:27], v[140:143]
ds_read_b128 a[104:107], v5 offset:51200
v_mfma_f32_16x16x32_bf16 v[156:159], a[120:123], a[28:31], v[156:159]
ds_read_b128 a[108:111], v5 offset:52224
v_mfma_f32_16x16x32_bf16 v[160:163], a[124:127], a[28:31], v[160:163]
buffer_load_dwordx4 a[20:23], v4, s[40:43], s35 offen offset:1024 sc1
v_mfma_f32_16x16x32_bf16 v[144:147], a[124:127], a[24:27], v[144:147]
s_waitcnt vmcnt(10) lgkmcnt(4)
v_mfma_f32_16x16x32_bf16 v[132:135], a[128:131], a[32:35], v[132:135]
s_cmp_eq_u32 s3, 1
s_cselect_b32 s35, 25, 17
s_lshl_b32 s35, s35, 12
v_mfma_f32_16x16x32_bf16 v[148:151], a[128:131], a[36:39], v[148:151]
ds_read_b128 a[112:115], v5 offset:53248
v_mfma_f32_16x16x32_bf16 v[152:155], a[132:135], a[36:39], v[152:155]
buffer_load_dwordx4 a[24:27], v4, s[40:43], s35 offen offset:0 sc1
v_mfma_f32_16x16x32_bf16 v[136:139], a[132:135], a[32:35], v[136:139]
ds_read_b128 a[116:119], v5 offset:54272
v_mfma_f32_16x16x32_bf16 v[140:143], a[136:139], a[32:35], v[140:143]
ds_read_b128 a[120:123], v5 offset:55296
v_mfma_f32_16x16x32_bf16 v[156:159], a[136:139], a[36:39], v[156:159]
ds_read_b128 a[124:127], v5 offset:56320
v_mfma_f32_16x16x32_bf16 v[160:163], a[140:143], a[36:39], v[160:163]
buffer_load_dwordx4 a[28:31], v4, s[40:43], s35 offen offset:1024 sc1
v_mfma_f32_16x16x32_bf16 v[144:147], a[140:143], a[32:35], v[144:147]
s_waitcnt vmcnt(10) lgkmcnt(4)
v_mfma_f32_16x16x32_bf16 v[132:135], a[96:99], a[40:43], v[132:135]
s_cmp_eq_u32 s3, 2
s_cselect_b32 s35, 26, 18
s_lshl_b32 s35, s35, 12
v_mfma_f32_16x16x32_bf16 v[148:151], a[96:99], a[44:47], v[148:151]
ds_read_b128 a[128:131], v5 offset:57344
v_mfma_f32_16x16x32_bf16 v[152:155], a[100:103], a[44:47], v[152:155]
buffer_load_dwordx4 a[32:35], v4, s[40:43], s35 offen offset:0 sc1
v_mfma_f32_16x16x32_bf16 v[136:139], a[100:103], a[40:43], v[136:139]
ds_read_b128 a[132:135], v5 offset:58368
v_mfma_f32_16x16x32_bf16 v[140:143], a[104:107], a[40:43], v[140:143]
ds_read_b128 a[136:139], v5 offset:59392
v_mfma_f32_16x16x32_bf16 v[156:159], a[104:107], a[44:47], v[156:159]
ds_read_b128 a[140:143], v5 offset:60416
v_mfma_f32_16x16x32_bf16 v[160:163], a[108:111], a[44:47], v[160:163]
buffer_load_dwordx4 a[36:39], v4, s[40:43], s35 offen offset:1024 sc1
v_mfma_f32_16x16x32_bf16 v[144:147], a[108:111], a[40:43], v[144:147]
s_waitcnt vmcnt(10) lgkmcnt(4)
v_mfma_f32_16x16x32_bf16 v[132:135], a[112:115], a[48:51], v[132:135]
s_cmp_eq_u32 s3, 3
s_cselect_b32 s35, 27, 19
s_lshl_b32 s35, s35, 12
v_mfma_f32_16x16x32_bf16 v[148:151], a[112:115], a[52:55], v[148:151]
ds_read_b128 a[96:99], v5 offset:61440
v_mfma_f32_16x16x32_bf16 v[152:155], a[116:119], a[52:55], v[152:155]
buffer_load_dwordx4 a[40:43], v4, s[40:43], s35 offen offset:0 sc1
v_mfma_f32_16x16x32_bf16 v[136:139], a[116:119], a[48:51], v[136:139]
ds_read_b128 a[100:103], v5 offset:62464
v_mfma_f32_16x16x32_bf16 v[140:143], a[120:123], a[48:51], v[140:143]
ds_read_b128 a[104:107], v5 offset:63488
v_mfma_f32_16x16x32_bf16 v[156:159], a[120:123], a[52:55], v[156:159]
ds_read_b128 a[108:111], v5 offset:64512
v_mfma_f32_16x16x32_bf16 v[160:163], a[124:127], a[52:55], v[160:163]
buffer_load_dwordx4 a[44:47], v4, s[40:43], s35 offen offset:1024 sc1
v_mfma_f32_16x16x32_bf16 v[144:147], a[124:127], a[48:51], v[144:147]
s_waitcnt vmcnt(10) lgkmcnt(4)
v_mfma_f32_16x16x32_bf16 v[132:135], a[128:131], a[0:3], v[132:135]
s_cmp_eq_u32 s3, 4
s_cselect_b32 s35, 28, 20
s_lshl_b32 s35, s35, 12
v_mfma_f32_16x16x32_bf16 v[148:151], a[128:131], a[4:7], v[148:151]
ds_read_b128 a[112:115], v6 offset:0
v_mfma_f32_16x16x32_bf16 v[152:155], a[132:135], a[4:7], v[152:155]
buffer_load_dwordx4 a[48:51], v4, s[40:43], s35 offen offset:0 sc1
v_mfma_f32_16x16x32_bf16 v[136:139], a[132:135], a[0:3], v[136:139]
ds_read_b128 a[116:119], v6 offset:1024
v_mfma_f32_16x16x32_bf16 v[140:143], a[136:139], a[0:3], v[140:143]
ds_read_b128 a[120:123], v6 offset:2048
v_mfma_f32_16x16x32_bf16 v[156:159], a[136:139], a[4:7], v[156:159]
ds_read_b128 a[124:127], v6 offset:3072
v_mfma_f32_16x16x32_bf16 v[160:163], a[140:143], a[4:7], v[160:163]
buffer_load_dwordx4 a[52:55], v4, s[40:43], s35 offen offset:1024 sc1
v_mfma_f32_16x16x32_bf16 v[144:147], a[140:143], a[0:3], v[144:147]
s_waitcnt vmcnt(10) lgkmcnt(4)
v_mfma_f32_16x16x32_bf16 v[132:135], a[96:99], a[8:11], v[132:135]
s_cmp_eq_u32 s3, 5
s_cselect_b32 s35, 29, 21
s_lshl_b32 s35, s35, 12
v_mfma_f32_16x16x32_bf16 v[148:151], a[96:99], a[12:15], v[148:151]
ds_read_b128 a[128:131], v6 offset:4096
v_mfma_f32_16x16x32_bf16 v[152:155], a[100:103], a[12:15], v[152:155]
buffer_load_dwordx4 a[0:3], v4, s[40:43], s35 offen offset:0 sc1
v_mfma_f32_16x16x32_bf16 v[136:139], a[100:103], a[8:11], v[136:139]
ds_read_b128 a[132:135], v6 offset:5120
v_mfma_f32_16x16x32_bf16 v[140:143], a[104:107], a[8:11], v[140:143]
ds_read_b128 a[136:139], v6 offset:6144
v_mfma_f32_16x16x32_bf16 v[156:159], a[104:107], a[12:15], v[156:159]
ds_read_b128 a[140:143], v6 offset:7168
v_mfma_f32_16x16x32_bf16 v[160:163], a[108:111], a[12:15], v[160:163]
buffer_load_dwordx4 a[4:7], v4, s[40:43], s35 offen offset:1024 sc1
v_mfma_f32_16x16x32_bf16 v[144:147], a[108:111], a[8:11], v[144:147]
s_waitcnt vmcnt(10) lgkmcnt(4)
v_mfma_f32_16x16x32_bf16 v[132:135], a[112:115], a[16:19], v[132:135]
s_cmp_eq_u32 s3, 6
s_cselect_b32 s35, 30, 22
s_lshl_b32 s35, s35, 12
v_mfma_f32_16x16x32_bf16 v[148:151], a[112:115], a[20:23], v[148:151]
ds_read_b128 a[96:99], v6 offset:8192
v_mfma_f32_16x16x32_bf16 v[152:155], a[116:119], a[20:23], v[152:155]
buffer_load_dwordx4 a[8:11], v4, s[40:43], s35 offen offset:0 sc1
v_mfma_f32_16x16x32_bf16 v[136:139], a[116:119], a[16:19], v[136:139]
ds_read_b128 a[100:103], v6 offset:9216
v_mfma_f32_16x16x32_bf16 v[140:143], a[120:123], a[16:19], v[140:143]
ds_read_b128 a[104:107], v6 offset:10240
v_mfma_f32_16x16x32_bf16 v[156:159], a[120:123], a[20:23], v[156:159]
ds_read_b128 a[108:111], v6 offset:11264
v_mfma_f32_16x16x32_bf16 v[160:163], a[124:127], a[20:23], v[160:163]
buffer_load_dwordx4 a[12:15], v4, s[40:43], s35 offen offset:1024 sc1
v_mfma_f32_16x16x32_bf16 v[144:147], a[124:127], a[16:19], v[144:147]
s_waitcnt vmcnt(10) lgkmcnt(4)
v_mfma_f32_16x16x32_bf16 v[132:135], a[128:131], a[24:27], v[132:135]
s_cmp_eq_u32 s3, 7
s_cselect_b32 s35, 31, 23
s_lshl_b32 s35, s35, 12
v_mfma_f32_16x16x32_bf16 v[148:151], a[128:131], a[28:31], v[148:151]
ds_read_b128 a[112:115], v6 offset:12288
v_mfma_f32_16x16x32_bf16 v[152:155], a[132:135], a[28:31], v[152:155]
buffer_load_dwordx4 a[16:19], v4, s[40:43], s35 offen offset:0 sc1
v_mfma_f32_16x16x32_bf16 v[136:139], a[132:135], a[24:27], v[136:139]
ds_read_b128 a[116:119], v6 offset:13312
v_mfma_f32_16x16x32_bf16 v[140:143], a[136:139], a[24:27], v[140:143]
ds_read_b128 a[120:123], v6 offset:14336
v_mfma_f32_16x16x32_bf16 v[156:159], a[136:139], a[28:31], v[156:159]
ds_read_b128 a[124:127], v6 offset:15360
v_mfma_f32_16x16x32_bf16 v[160:163], a[140:143], a[28:31], v[160:163]
buffer_load_dwordx4 a[20:23], v4, s[40:43], s35 offen offset:1024 sc1
v_mfma_f32_16x16x32_bf16 v[144:147], a[140:143], a[24:27], v[144:147]
s_waitcnt vmcnt(10) lgkmcnt(4)
v_mfma_f32_16x16x32_bf16 v[132:135], a[96:99], a[32:35], v[132:135]
s_cmp_eq_u32 s3, 0
s_cselect_b32 s35, 0, 24
s_lshl_b32 s35, s35, 12
v_mfma_f32_16x16x32_bf16 v[148:151], a[96:99], a[36:39], v[148:151]
ds_read_b128 a[128:131], v6 offset:16384
v_mfma_f32_16x16x32_bf16 v[152:155], a[100:103], a[36:39], v[152:155]
buffer_load_dwordx4 a[24:27], v4, s[40:43], s35 offen offset:0 sc1
v_mfma_f32_16x16x32_bf16 v[136:139], a[100:103], a[32:35], v[136:139]
ds_read_b128 a[132:135], v6 offset:17408
v_mfma_f32_16x16x32_bf16 v[140:143], a[104:107], a[32:35], v[140:143]
ds_read_b128 a[136:139], v6 offset:18432
v_mfma_f32_16x16x32_bf16 v[156:159], a[104:107], a[36:39], v[156:159]
ds_read_b128 a[140:143], v6 offset:19456
v_mfma_f32_16x16x32_bf16 v[160:163], a[108:111], a[36:39], v[160:163]
buffer_load_dwordx4 a[28:31], v4, s[40:43], s35 offen offset:1024 sc1
v_mfma_f32_16x16x32_bf16 v[144:147], a[108:111], a[32:35], v[144:147]
s_waitcnt vmcnt(10) lgkmcnt(4)
v_mfma_f32_16x16x32_bf16 v[132:135], a[112:115], a[40:43], v[132:135]
s_cmp_eq_u32 s3, 1
s_cselect_b32 s35, 1, 25
s_lshl_b32 s35, s35, 12
v_mfma_f32_16x16x32_bf16 v[148:151], a[112:115], a[44:47], v[148:151]
ds_read_b128 a[96:99], v6 offset:20480
v_mfma_f32_16x16x32_bf16 v[152:155], a[116:119], a[44:47], v[152:155]
buffer_load_dwordx4 a[32:35], v4, s[40:43], s35 offen offset:0 sc1
v_mfma_f32_16x16x32_bf16 v[136:139], a[116:119], a[40:43], v[136:139]
ds_read_b128 a[100:103], v6 offset:21504
v_mfma_f32_16x16x32_bf16 v[140:143], a[120:123], a[40:43], v[140:143]
ds_read_b128 a[104:107], v6 offset:22528
v_mfma_f32_16x16x32_bf16 v[156:159], a[120:123], a[44:47], v[156:159]
ds_read_b128 a[108:111], v6 offset:23552
v_mfma_f32_16x16x32_bf16 v[160:163], a[124:127], a[44:47], v[160:163]
buffer_load_dwordx4 a[36:39], v4, s[40:43], s35 offen offset:1024 sc1
v_mfma_f32_16x16x32_bf16 v[144:147], a[124:127], a[40:43], v[144:147]
s_waitcnt vmcnt(10) lgkmcnt(4)
v_mfma_f32_16x16x32_bf16 v[132:135], a[128:131], a[48:51], v[132:135]
s_cmp_eq_u32 s3, 2
s_cselect_b32 s35, 2, 26
s_lshl_b32 s35, s35, 12
v_mfma_f32_16x16x32_bf16 v[148:151], a[128:131], a[52:55], v[148:151]
ds_read_b128 a[112:115], v6 offset:24576
v_mfma_f32_16x16x32_bf16 v[152:155], a[132:135], a[52:55], v[152:155]
buffer_load_dwordx4 a[40:43], v4, s[40:43], s35 offen offset:0 sc1
v_mfma_f32_16x16x32_bf16 v[136:139], a[132:135], a[48:51], v[136:139]
ds_read_b128 a[116:119], v6 offset:25600
v_mfma_f32_16x16x32_bf16 v[140:143], a[136:139], a[48:51], v[140:143]
ds_read_b128 a[120:123], v6 offset:26624
v_mfma_f32_16x16x32_bf16 v[156:159], a[136:139], a[52:55], v[156:159]
ds_read_b128 a[124:127], v6 offset:27648
v_mfma_f32_16x16x32_bf16 v[160:163], a[140:143], a[52:55], v[160:163]
buffer_load_dwordx4 a[44:47], v4, s[40:43], s35 offen offset:1024 sc1
v_mfma_f32_16x16x32_bf16 v[144:147], a[140:143], a[48:51], v[144:147]
s_waitcnt vmcnt(10) lgkmcnt(4)
v_mfma_f32_16x16x32_bf16 v[132:135], a[96:99], a[0:3], v[132:135]
s_cmp_eq_u32 s3, 3
s_cselect_b32 s35, 3, 27
s_lshl_b32 s35, s35, 12
v_mfma_f32_16x16x32_bf16 v[148:151], a[96:99], a[4:7], v[148:151]
ds_read_b128 a[128:131], v6 offset:28672
v_mfma_f32_16x16x32_bf16 v[152:155], a[100:103], a[4:7], v[152:155]
buffer_load_dwordx4 a[48:51], v4, s[40:43], s35 offen offset:0 sc1
v_mfma_f32_16x16x32_bf16 v[136:139], a[100:103], a[0:3], v[136:139]
ds_read_b128 a[132:135], v6 offset:29696
v_mfma_f32_16x16x32_bf16 v[140:143], a[104:107], a[0:3], v[140:143]
ds_read_b128 a[136:139], v6 offset:30720
v_mfma_f32_16x16x32_bf16 v[156:159], a[104:107], a[4:7], v[156:159]
ds_read_b128 a[140:143], v6 offset:31744
v_mfma_f32_16x16x32_bf16 v[160:163], a[108:111], a[4:7], v[160:163]
buffer_load_dwordx4 a[52:55], v4, s[40:43], s35 offen offset:1024 sc1
v_mfma_f32_16x16x32_bf16 v[144:147], a[108:111], a[0:3], v[144:147]
s_waitcnt vmcnt(10) lgkmcnt(4)
v_mfma_f32_16x16x32_bf16 v[132:135], a[112:115], a[8:11], v[132:135]
s_cmp_eq_u32 s3, 4
s_cselect_b32 s35, 4, 28
s_lshl_b32 s35, s35, 12
v_mfma_f32_16x16x32_bf16 v[148:151], a[112:115], a[12:15], v[148:151]
ds_read_b128 a[96:99], v6 offset:32768
v_mfma_f32_16x16x32_bf16 v[152:155], a[116:119], a[12:15], v[152:155]
buffer_load_dwordx4 a[0:3], v4, s[40:43], s35 offen offset:0 sc1
v_mfma_f32_16x16x32_bf16 v[136:139], a[116:119], a[8:11], v[136:139]
ds_read_b128 a[100:103], v6 offset:33792
v_mfma_f32_16x16x32_bf16 v[140:143], a[120:123], a[8:11], v[140:143]
ds_read_b128 a[104:107], v6 offset:34816
v_mfma_f32_16x16x32_bf16 v[156:159], a[120:123], a[12:15], v[156:159]
ds_read_b128 a[108:111], v6 offset:35840
v_mfma_f32_16x16x32_bf16 v[160:163], a[124:127], a[12:15], v[160:163]
buffer_load_dwordx4 a[4:7], v4, s[40:43], s35 offen offset:1024 sc1
v_mfma_f32_16x16x32_bf16 v[144:147], a[124:127], a[8:11], v[144:147]
s_waitcnt vmcnt(10) lgkmcnt(4)
v_mfma_f32_16x16x32_bf16 v[132:135], a[128:131], a[16:19], v[132:135]
s_cmp_eq_u32 s3, 5
s_cselect_b32 s35, 5, 29
s_lshl_b32 s35, s35, 12
v_mfma_f32_16x16x32_bf16 v[148:151], a[128:131], a[20:23], v[148:151]
ds_read_b128 a[112:115], v6 offset:36864
v_mfma_f32_16x16x32_bf16 v[152:155], a[132:135], a[20:23], v[152:155]
buffer_load_dwordx4 a[8:11], v4, s[40:43], s35 offen offset:0 sc1
v_mfma_f32_16x16x32_bf16 v[136:139], a[132:135], a[16:19], v[136:139]
ds_read_b128 a[116:119], v6 offset:37888
v_mfma_f32_16x16x32_bf16 v[140:143], a[136:139], a[16:19], v[140:143]
ds_read_b128 a[120:123], v6 offset:38912
v_mfma_f32_16x16x32_bf16 v[156:159], a[136:139], a[20:23], v[156:159]
ds_read_b128 a[124:127], v6 offset:39936
v_mfma_f32_16x16x32_bf16 v[160:163], a[140:143], a[20:23], v[160:163]
buffer_load_dwordx4 a[12:15], v4, s[40:43], s35 offen offset:1024 sc1
v_mfma_f32_16x16x32_bf16 v[144:147], a[140:143], a[16:19], v[144:147]
s_waitcnt vmcnt(10) lgkmcnt(4)
v_mfma_f32_16x16x32_bf16 v[132:135], a[96:99], a[24:27], v[132:135]
s_cmp_eq_u32 s3, 6
s_cselect_b32 s35, 6, 30
s_lshl_b32 s35, s35, 12
v_mfma_f32_16x16x32_bf16 v[148:151], a[96:99], a[28:31], v[148:151]
ds_read_b128 a[128:131], v6 offset:40960
v_mfma_f32_16x16x32_bf16 v[152:155], a[100:103], a[28:31], v[152:155]
buffer_load_dwordx4 a[16:19], v4, s[40:43], s35 offen offset:0 sc1
v_mfma_f32_16x16x32_bf16 v[136:139], a[100:103], a[24:27], v[136:139]
ds_read_b128 a[132:135], v6 offset:41984
v_mfma_f32_16x16x32_bf16 v[140:143], a[104:107], a[24:27], v[140:143]
ds_read_b128 a[136:139], v6 offset:43008
v_mfma_f32_16x16x32_bf16 v[156:159], a[104:107], a[28:31], v[156:159]
ds_read_b128 a[140:143], v6 offset:44032
v_mfma_f32_16x16x32_bf16 v[160:163], a[108:111], a[28:31], v[160:163]
buffer_load_dwordx4 a[20:23], v4, s[40:43], s35 offen offset:1024 sc1
v_mfma_f32_16x16x32_bf16 v[144:147], a[108:111], a[24:27], v[144:147]
s_waitcnt vmcnt(10) lgkmcnt(4)
v_mfma_f32_16x16x32_bf16 v[132:135], a[112:115], a[32:35], v[132:135]
s_cmp_eq_u32 s3, 7
s_cselect_b32 s35, 7, 31
s_lshl_b32 s35, s35, 12
v_mfma_f32_16x16x32_bf16 v[148:151], a[112:115], a[36:39], v[148:151]
ds_read_b128 a[96:99], v6 offset:45056
v_mfma_f32_16x16x32_bf16 v[152:155], a[116:119], a[36:39], v[152:155]
buffer_load_dwordx4 a[24:27], v4, s[40:43], s35 offen offset:0 sc1
v_mfma_f32_16x16x32_bf16 v[136:139], a[116:119], a[32:35], v[136:139]
ds_read_b128 a[100:103], v6 offset:46080
v_mfma_f32_16x16x32_bf16 v[140:143], a[120:123], a[32:35], v[140:143]
ds_read_b128 a[104:107], v6 offset:47104
v_mfma_f32_16x16x32_bf16 v[156:159], a[120:123], a[36:39], v[156:159]
ds_read_b128 a[108:111], v6 offset:48128
v_mfma_f32_16x16x32_bf16 v[160:163], a[124:127], a[36:39], v[160:163]
buffer_load_dwordx4 a[28:31], v4, s[40:43], s35 offen offset:1024 sc1
v_mfma_f32_16x16x32_bf16 v[144:147], a[124:127], a[32:35], v[144:147]
s_waitcnt vmcnt(10) lgkmcnt(4)
v_mfma_f32_16x16x32_bf16 v[132:135], a[128:131], a[40:43], v[132:135]
s_add_u32 m0, s18, 0x0
s_add_u32 s44, s50, 0xe00000
v_mfma_f32_16x16x32_bf16 v[148:151], a[128:131], a[44:47], v[148:151]
ds_read_b128 a[112:115], v6 offset:49152
v_mfma_f32_16x16x32_bf16 v[152:155], a[132:135], a[44:47], v[152:155]
buffer_load_dwordx4 v1, s[4:7], s44 offen offset:0 sc1 lds
v_mfma_f32_16x16x32_bf16 v[136:139], a[132:135], a[40:43], v[136:139]
ds_read_b128 a[116:119], v6 offset:50176
v_mfma_f32_16x16x32_bf16 v[140:143], a[136:139], a[40:43], v[140:143]
ds_read_b128 a[120:123], v6 offset:51200
v_mfma_f32_16x16x32_bf16 v[156:159], a[136:139], a[44:47], v[156:159]
ds_read_b128 a[124:127], v6 offset:52224
v_mfma_f32_16x16x32_bf16 v[160:163], a[140:143], a[44:47], v[160:163]
buffer_load_dwordx4 v1, s[4:7], s44 offen offset:1024 sc1 lds
v_mfma_f32_16x16x32_bf16 v[144:147], a[140:143], a[40:43], v[144:147]
s_waitcnt vmcnt(10) lgkmcnt(4)
v_mfma_f32_16x16x32_bf16 v[132:135], a[96:99], a[48:51], v[132:135]
ds_read_b128 a[128:131], v6 offset:53248
v_mfma_f32_16x16x32_bf16 v[148:151], a[96:99], a[52:55], v[148:151]
ds_read_b128 a[132:135], v6 offset:54272
v_mfma_f32_16x16x32_bf16 v[152:155], a[100:103], a[52:55], v[152:155]
ds_read_b128 a[136:139], v6 offset:55296
v_mfma_f32_16x16x32_bf16 v[136:139], a[100:103], a[48:51], v[136:139]
ds_read_b128 a[140:143], v6 offset:56320
v_mfma_f32_16x16x32_bf16 v[140:143], a[104:107], a[48:51], v[140:143]
buffer_load_dwordx4 v1, s[4:7], s44 offen offset:2048 sc1 lds
s_add_u32 m0, s18, 0x3000
v_mfma_f32_16x16x32_bf16 v[156:159], a[104:107], a[52:55], v[156:159]
s_add_u32 s44, s50, 0xe03000
v_mfma_f32_16x16x32_bf16 v[160:163], a[108:111], a[52:55], v[160:163]
v_mfma_f32_16x16x32_bf16 v[144:147], a[108:111], a[48:51], v[144:147]
s_waitcnt vmcnt(9) lgkmcnt(4)
v_mfma_f32_16x16x32_bf16 v[132:135], a[112:115], a[0:3], v[132:135]
ds_read_b128 a[96:99], v6 offset:57344
v_mfma_f32_16x16x32_bf16 v[148:151], a[112:115], a[4:7], v[148:151]
ds_read_b128 a[100:103], v6 offset:58368
v_mfma_f32_16x16x32_bf16 v[152:155], a[116:119], a[4:7], v[152:155]
ds_read_b128 a[104:107], v6 offset:59392
v_mfma_f32_16x16x32_bf16 v[136:139], a[116:119], a[0:3], v[136:139]
buffer_load_dwordx4 v1, s[4:7], s44 offen offset:0 sc1 lds
v_mfma_f32_16x16x32_bf16 v[140:143], a[120:123], a[0:3], v[140:143]
ds_read_b128 a[108:111], v6 offset:60416
v_mfma_f32_16x16x32_bf16 v[156:159], a[120:123], a[4:7], v[156:159]
v_mfma_f32_16x16x32_bf16 v[160:163], a[124:127], a[4:7], v[160:163]
v_mfma_f32_16x16x32_bf16 v[144:147], a[124:127], a[0:3], v[144:147]
s_waitcnt vmcnt(8) lgkmcnt(4)
v_mfma_f32_16x16x32_bf16 v[132:135], a[128:131], a[8:11], v[132:135]
ds_read_b128 a[112:115], v6 offset:61440
v_mfma_f32_16x16x32_bf16 v[148:151], a[128:131], a[12:15], v[148:151]
buffer_load_dwordx4 v1, s[4:7], s44 offen offset:1024 sc1 lds
v_mfma_f32_16x16x32_bf16 v[152:155], a[132:135], a[12:15], v[152:155]
ds_read_b128 a[116:119], v6 offset:62464
v_mfma_f32_16x16x32_bf16 v[136:139], a[132:135], a[8:11], v[136:139]
ds_read_b128 a[120:123], v6 offset:63488
v_mfma_f32_16x16x32_bf16 v[140:143], a[136:139], a[8:11], v[140:143]
ds_read_b128 a[124:127], v6 offset:64512
v_mfma_f32_16x16x32_bf16 v[156:159], a[136:139], a[12:15], v[156:159]
v_mfma_f32_16x16x32_bf16 v[160:163], a[140:143], a[12:15], v[160:163]
v_mfma_f32_16x16x32_bf16 v[144:147], a[140:143], a[8:11], v[144:147]
buffer_load_dwordx4 v1, s[4:7], s44 offen offset:2048 sc1 lds
s_waitcnt vmcnt(8) lgkmcnt(4)
v_mfma_f32_16x16x32_bf16 v[132:135], a[96:99], a[16:19], v[132:135]
v_mfma_f32_16x16x32_bf16 v[148:151], a[96:99], a[20:23], v[148:151]
v_mfma_f32_16x16x32_bf16 v[152:155], a[100:103], a[20:23], v[152:155]
v_mfma_f32_16x16x32_bf16 v[136:139], a[100:103], a[16:19], v[136:139]
v_mfma_f32_16x16x32_bf16 v[140:143], a[104:107], a[16:19], v[140:143]
v_mfma_f32_16x16x32_bf16 v[156:159], a[104:107], a[20:23], v[156:159]
v_mfma_f32_16x16x32_bf16 v[160:163], a[108:111], a[20:23], v[160:163]
v_mfma_f32_16x16x32_bf16 v[144:147], a[108:111], a[16:19], v[144:147]
s_waitcnt vmcnt(6) lgkmcnt(0)
v_mfma_f32_16x16x32_bf16 v[132:135], a[112:115], a[24:27], v[132:135]
v_mfma_f32_16x16x32_bf16 v[148:151], a[112:115], a[28:31], v[148:151]
v_mfma_f32_16x16x32_bf16 v[152:155], a[116:119], a[28:31], v[152:155]
buffer_atomic_add v12, v10, s[4:7], s92 offen sc1
v_mfma_f32_16x16x32_bf16 v[136:139], a[116:119], a[24:27], v[136:139]
v_mfma_f32_16x16x32_bf16 v[140:143], a[120:123], a[24:27], v[140:143]
v_mfma_f32_16x16x32_bf16 v[156:159], a[120:123], a[28:31], v[156:159]
v_mfma_f32_16x16x32_bf16 v[160:163], a[124:127], a[28:31], v[160:163]
v_mfma_f32_16x16x32_bf16 v[144:147], a[124:127], a[24:27], v[144:147]
s_nop 0
v_cmp_u_f32 vcc, v132, v148
s_nop 0
s_and_b32 vcc_lo, vcc_lo, s95
s_cbranch_scc1 L_k2redo1
s_lshl_b32 s36, s32, 13
v_cvt_pk_bf16_f32 v32, v132, v133
v_cvt_pk_bf16_f32 v33, v134, v135
v_cvt_pk_bf16_f32 v34, v136, v137
v_cvt_pk_bf16_f32 v35, v138, v139
s_add_u32 s36, s36, 0x0
buffer_store_dwordx4 v[32:35], v4, s[12:15], s36 offen offset:0 sc1
v_cvt_pk_bf16_f32 v40, v148, v149
v_cvt_pk_bf16_f32 v41, v150, v151
v_cvt_pk_bf16_f32 v42, v152, v153
v_cvt_pk_bf16_f32 v43, v154, v155
v_cvt_pk_bf16_f32 v36, v140, v141
v_cvt_pk_bf16_f32 v37, v142, v143
v_cvt_pk_bf16_f32 v38, v144, v145
v_cvt_pk_bf16_f32 v39, v146, v147
s_add_u32 s37, s36, 4096
v_cvt_pk_bf16_f32 v44, v156, v157
v_cvt_pk_bf16_f32 v45, v158, v159
v_cvt_pk_bf16_f32 v46, v160, v161
buffer_store_dwordx4 v[40:43], v4, s[12:15], s36 offen offset:1024 sc1
v_cvt_pk_bf16_f32 v47, v162, v163
v_mfma_f32_16x16x32_bf16 v[96:99], v[32:35], v[32:35], 0
s_mov_b32 s38, 0x280000
s_add_u32 s92, s78, 0x50000
v_mfma_f32_16x16x32_bf16 v[92:95], v[16:19], v[32:35], 0
s_add_u32 s93, s79, 0x50000
s_mov_b64 s[40:41], s[12:13]
v_mfma_f32_16x16x32_bf16 v[96:99], v[36:39], v[36:39], v[96:99]
buffer_store_dwordx4 v[36:39], v4, s[12:15], s37 offen offset:0 sc1
v_mfma_f32_16x16x32_bf16 v[92:95], v[16:19], v[36:39], v[92:95]
s_nop 5
v_cndmask_b32 v96, v96, v97, s[46:47]
v_cndmask_b32 v98, v98, v99, s[46:47]
v_mfma_f32_16x16x32_bf16 v[104:107], v[40:43], v[40:43], 0
v_mfma_f32_16x16x32_bf16 v[100:103], v[16:19], v[40:43], 0
v_cndmask_b32 v93, v96, v98, s[48:49]
buffer_store_dwordx4 v[44:47], v4, s[12:15], s37 offen offset:1024 sc1
v_mfma_f32_16x16x32_bf16 v[104:107], v[44:47], v[44:47], v[104:107]
v_mfma_f32_16x16x32_bf16 v[100:103], v[16:19], v[44:47], v[100:103]
s_nop 6
v_cndmask_b32 v104, v104, v105, s[46:47]
v_cndmask_b32 v106, v106, v107, s[46:47]
buffer_store_dwordx2 v[92:93], v253, s[4:7], s38 offen offset:0 sc1
v_cndmask_b32 v101, v104, v106, s[48:49]
buffer_store_dwordx2 v[100:101], v253, s[4:7], s38 offen offset:2048 sc1
s_barrier
s_add_u32 m0, s18, 0x6000
s_add_u32 s44, s50, 0xe06000
buffer_load_dwordx4 v1, s[4:7], s44 offen offset:0 sc1 lds
buffer_load_dwordx4 v1, s[4:7], s44 offen offset:1024 sc1 lds
buffer_load_dwordx4 v1, s[4:7], s44 offen offset:2048 sc1 lds
s_add_u32 m0, s18, 0x9000
s_add_u32 s44, s50, 0xe09000
buffer_load_dwordx4 v1, s[4:7], s44 offen offset:0 sc1 lds
buffer_load_dwordx4 v1, s[4:7], s44 offen offset:1024 sc1 lds
buffer_load_dwordx4 v1, s[4:7], s44 offen offset:2048 sc1 lds
v_accvgpr_read_b32 v48, a188
v_accvgpr_read_b32 v49, a189
v_accvgpr_read_b32 v50, a190
v_accvgpr_read_b32 v51, a191
v_accvgpr_read_b32 v52, a192
v_accvgpr_read_b32 v53, a193
v_accvgpr_read_b32 v54, a194
v_accvgpr_read_b32 v55, a195
v_accvgpr_read_b32 v56, a196
v_accvgpr_read_b32 v57, a197
v_accvgpr_read_b32 v58, a198
v_accvgpr_read_b32 v59, a199
v_accvgpr_read_b32 v60, a200
v_accvgpr_read_b32 v61, a201
v_accvgpr_read_b32 v62, a202
v_accvgpr_read_b32 v63, a203
v_accvgpr_read_b32 v64, a204
v_accvgpr_read_b32 v65, a205
v_accvgpr_read_b32 v66, a206
v_accvgpr_read_b32 v67, a207
v_accvgpr_read_b32 v68, a208
v_accvgpr_read_b32 v69, a209
v_accvgpr_read_b32 v70, a210
v_accvgpr_read_b32 v71, a211
v_accvgpr_read_b32 v72, a212
v_accvgpr_read_b32 v73, a213
v_accvgpr_read_b32 v74, a214
v_accvgpr_read_b32 v75, a215
s_waitcnt vmcnt(6)
s_barrier
s_cmp_lg_u32 s28, 1
s_cbranch_scc1 Lsg_25
buffer_atomic_add v12, v10, s[4:7], s92 offen sc1
buffer_atomic_add v12, v10, s[4:7], s93 offen sc1
Lsg_25:
s_mov_b64 exec, 0
s_cmp_eq_u32 s28, 1
s_cbranch_scc1 L_stub10
L_wret4:
s_mov_b64 exec, -1
s_cmp_lt_u32 s28, 2
s_cbranch_scc1 Lwd_26
s_add_u32 m0, s18, 0xa800
s_add_u32 s44, s50, 0xe0a800
buffer_load_dwordx4 v1, s[4:7], s44 offen offset:0 sc1 lds
buffer_load_dwordx4 v1, s[4:7], s44 offen offset:1024 sc1 lds
buffer_load_dwordx4 v1, s[4:7], s44 offen offset:2048 sc1 lds
s_add_u32 m0, s18, 0xc000
s_add_u32 s44, s50, 0xe0c000
buffer_load_dwordx4 v1, s[4:7], s44 offen offset:0 sc1 lds
buffer_load_dwordx4 v1, s[4:7], s44 offen offset:1024 sc1 lds
buffer_load_dwordx4 v1, s[4:7], s44 offen offset:2048 sc1 lds
s_add_u32 m0, s18, 0xd800
s_add_u32 s44, s50, 0xe0d800
buffer_load_dwordx4 v1, s[4:7], s44 offen offset:0 sc1 lds
buffer_load_dwordx4 v1, s[4:7], s44 offen offset:1024 sc1 lds
buffer_load_dwordx4 v1, s[4:7], s44 offen offset:2048 sc1 lds
s_add_u32 m0, s18, 0xf000
s_add_u32 s44, s50, 0xe0f000
buffer_load_dwordx4 v1, s[4:7], s44 offen offset:0 sc1 lds
buffer_load_dwordx4 v1, s[4:7], s44 offen offset:1024 sc1 lds
buffer_load_dwordx4 v1, s[4:7], s44 offen offset:2048 sc1 lds
s_add_u32 m0, s18, 0x10800
s_add_u32 s44, s50, 0xe10800
buffer_load_dwordx4 v1, s[4:7], s44 offen offset:0 sc1 lds
buffer_load_dwordx4 v1, s[4:7], s44 offen offset:1024 sc1 lds
buffer_load_dwordx4 v1, s[4:7], s44 offen offset:2048 sc1 lds
s_add_u32 m0, s18, 0x12000
s_add_u32 s44, s50, 0xe12000
buffer_load_dwordx4 v1, s[4:7], s44 offen offset:0 sc1 lds
buffer_load_dwordx4 v1, s[4:7], s44 offen offset:1024 sc1 lds
buffer_load_dwordx4 v1, s[4:7], s44 offen offset:2048 sc1 lds
s_add_u32 m0, s18, 0x13800
s_add_u32 s44, s50, 0xe13800
buffer_load_dwordx4 v1, s[4:7], s44 offen offset:0 sc1 lds
buffer_load_dwordx4 v1, s[4:7], s44 offen offset:1024 sc1 lds
buffer_load_dwordx4 v1, s[4:7], s44 offen offset:2048 sc1 lds
s_add_u32 m0, s18, 0x15000
s_add_u32 s44, s50, 0xe15000
buffer_load_dwordx4 v1, s[4:7], s44 offen offset:0 sc1 lds
buffer_load_dwordx4 v1, s[4:7], s44 offen offset:1024 sc1 lds
buffer_load_dwordx4 v1, s[4:7], s44 offen offset:2048 sc1 lds
s_add_u32 m0, s18, 0x16800
s_add_u32 s44, s50, 0xe16800
buffer_load_dwordx4 v1, s[4:7], s44 offen offset:0 sc1 lds
buffer_load_dwordx4 v1, s[4:7], s44 offen offset:1024 sc1 lds
buffer_load_dwordx4 v1, s[4:7], s44 offen offset:2048 sc1 lds
s_add_u32 m0, s18, 0x18000
s_add_u32 s44, s50, 0xe18000
buffer_load_dwordx4 v1, s[4:7], s44 offen offset:0 sc1 lds
buffer_load_dwordx4 v1, s[4:7], s44 offen offset:1024 sc1 lds
buffer_load_dwordx4 v1, s[4:7], s44 offen offset:2048 sc1 lds
s_add_u32 m0, s18, 0x19800
s_add_u32 s44, s50, 0xe19800
buffer_load_dwordx4 v1, s[4:7], s44 offen offset:0 sc1 lds
buffer_load_dwordx4 v1, s[4:7], s44 offen offset:1024 sc1 lds
buffer_load_dwordx4 v1, s[4:7], s44 offen offset:2048 sc1 lds
s_add_u32 m0, s18, 0x1b000
s_add_u32 s44, s50, 0xe1b000
buffer_load_dwordx4 v1, s[4:7], s44 offen offset:0 sc1 lds
buffer_load_dwordx4 v1, s[4:7], s44 offen offset:1024 sc1 lds
buffer_load_dwordx4 v1, s[4:7], s44 offen offset:2048 sc1 lds
Lwd_26:
s_cmp_lg_u32 s28, 0
s_cbranch_scc1 Lpo_29
s_add_u32 s36, s67, 0x50000
s_mov_b32 s37, 0
v_mov_b32 v11, 0
buffer_atomic_add v11, v251, s[4:7], s36 offen sc0 sc1
s_sleep 4
Lpoll_27:
v_mov_b32 v234, 0
buffer_atomic_add v234, v251, s[4:7], s36 offen sc0 sc1
s_waitcnt vmcnt(1)
v_readfirstlane_b32 s38, v11
s_nop 0
s_cmp_ge_u32 s38, s54
s_cbranch_scc1 Lpe_28
v_mov_b32 v11, 0
buffer_atomic_add v11, v251, s[4:7], s36 offen sc0 sc1
s_waitcnt vmcnt(1)
v_readfirstlane_b32 s38, v234
L_stub10:
s_cbranch_execz L_stub11
s_nop 0
s_cmp_ge_u32 s38, s54
s_cbranch_scc1 Lpe_28
s_add_u32 s37, s37, 1
s_cmp_lt_u32 s37, 0x80000
s_cbranch_scc1 Lpoll_27
s_waitcnt vmcnt(0)
Lpo_29:
s_waitcnt vmcnt(36) lgkmcnt(0)
s_cmp_ge_u32 s28, 2
s_cbranch_scc1 Lw_30
s_waitcnt vmcnt(0)
Lw_30:
Lpe_28:
s_barrier
s_add_u32 s94, s71, 0x20080
s_add_u32 s9, s66, 0x20080
s_mov_b32 s35, 0
s_mov_b32 s33, 0x1000
buffer_load_dwordx4 a[0:3], v2, s[40:43], s35 offen offset:0 sc1
buffer_load_dwordx4 a[4:7], v2, s[40:43], s33 offen offset:0 sc1
buffer_load_dwordx4 a[8:11], v2, s[40:43], s35 offen offset:1024 sc1
buffer_load_dwordx4 a[12:15], v2, s[40:43], s33 offen offset:1024 sc1
buffer_load_dwordx4 a[16:19], v2, s[40:43], s35 offen offset:2048 sc1
buffer_load_dwordx4 a[20:23], v2, s[40:43], s33 offen offset:2048 sc1
buffer_load_dwordx4 a[24:27], v2, s[40:43], s35 offen offset:3072 sc1
buffer_load_dwordx4 a[28:31], v2, s[40:43], s33 offen offset:3072 sc1
s_add_u32 s35, s35, 8192
s_add_u32 s33, s33, 8192
s_add_u32 s63, s28, 0
s_lshl_b32 s63, s63, 12
buffer_load_dwordx4 a[160:163], v3, s[40:43], s63 offen sc1
buffer_load_dwordx4 a[32:35], v2, s[40:43], s35 offen offset:0 sc1
buffer_load_dwordx4 a[36:39], v2, s[40:43], s33 offen offset:0 sc1
buffer_load_dwordx4 a[40:43], v2, s[40:43], s35 offen offset:1024 sc1
buffer_load_dwordx4 a[44:47], v2, s[40:43], s33 offen offset:1024 sc1
buffer_load_dwordx4 a[48:51], v2, s[40:43], s35 offen offset:2048 sc1
buffer_load_dwordx4 a[52:55], v2, s[40:43], s33 offen offset:2048 sc1
buffer_load_dwordx4 a[56:59], v2, s[40:43], s35 offen offset:3072 sc1
buffer_load_dwordx4 a[60:63], v2, s[40:43], s33 offen offset:3072 sc1
s_add_u32 s35, s35, 8192
s_add_u32 s33, s33, 8192
v_add_u32 v5, 0, v1
v_add_u32 v6, s55, v5
ds_read_b128 a[96:99], v5 offset:2048
ds_read_b128 a[100:103], v5 offset:8192
ds_read_b128 a[104:107], v5 offset:3072
ds_read_b128 a[108:111], v5 offset:9216
ds_read_b128 a[112:115], v5 offset:4096
ds_read_b128 a[116:119], v5 offset:10240
ds_read_b128 a[120:123], v6 offset:2048
s_waitcnt vmcnt(15) lgkmcnt(5)
v_mfma_f32_16x16x32_bf16 v[140:143], a[96:99], a[0:3], 0
s_add_u32 s63, s28, 4
s_lshl_b32 s63, s63, 12
v_mfma_f32_16x16x32_bf16 v[140:143], a[100:103], a[4:7], v[140:143]
buffer_load_dwordx4 a[64:67], v2, s[40:43], s35 offen offset:0 sc1
s_waitcnt vmcnt(14)
v_mfma_f32_16x16x32_bf16 v[164:167], a[100:103], a[12:15], 0
ds_read_b128 a[128:131], v5 offset:5120
v_mfma_f32_16x16x32_bf16 v[164:167], a[96:99], a[8:11], v[164:167]
ds_read_b128 a[132:135], v5 offset:11264
s_waitcnt vmcnt(13)
v_mfma_f32_16x16x32_bf16 v[188:191], a[96:99], a[16:19], 0
ds_read_b128 a[136:139], v5 offset:0
s_waitcnt vmcnt(12)
v_mfma_f32_16x16x32_bf16 v[188:191], a[100:103], a[20:23], v[188:191]
s_waitcnt vmcnt(10)
v_mfma_f32_16x16x32_bf16 v[212:215], a[100:103], a[28:31], 0
buffer_load_dwordx4 a[68:71], v2, s[40:43], s33 offen offset:0 sc1
v_mfma_f32_16x16x32_bf16 v[212:215], a[96:99], a[24:27], v[212:215]
ds_read_b128 a[140:143], v5 offset:6144
s_waitcnt lgkmcnt(8)
v_mfma_f32_16x16x32_bf16 v[216:219], a[104:107], a[24:27], 0
s_waitcnt lgkmcnt(7)
v_mfma_f32_16x16x32_bf16 v[216:219], a[108:111], a[28:31], v[216:219]
ds_read_b128 a[144:147], v5 offset:1024
v_mfma_f32_16x16x32_bf16 v[192:195], a[108:111], a[20:23], 0
v_mfma_f32_16x16x32_bf16 v[192:195], a[104:107], a[16:19], v[192:195]
buffer_load_dwordx4 a[164:167], v3, s[40:43], s63 offen sc1
s_add_u32 m0, s18, 0x1e000
v_mfma_f32_16x16x32_bf16 v[168:171], a[104:107], a[8:11], 0
s_add_u32 s44, s50, 0xe1e000
ds_read_b128 a[148:151], v5 offset:7168
v_mfma_f32_16x16x32_bf16 v[168:171], a[108:111], a[12:15], v[168:171]
ds_read_b128 a[152:155], v6 offset:3072
v_mfma_f32_16x16x32_bf16 v[144:147], a[108:111], a[4:7], 0
v_mfma_f32_16x16x32_bf16 v[144:147], a[104:107], a[0:3], v[144:147]
s_waitcnt lgkmcnt(9)
v_mfma_f32_16x16x32_bf16 v[148:151], a[112:115], a[0:3], 0
buffer_load_dwordx4 a[72:75], v2, s[40:43], s35 offen offset:1024 sc1
s_waitcnt lgkmcnt(8)
v_mfma_f32_16x16x32_bf16 v[148:151], a[116:119], a[4:7], v[148:151]
v_mfma_f32_16x16x32_bf16 v[172:175], a[116:119], a[12:15], 0
v_mfma_f32_16x16x32_bf16 v[172:175], a[112:115], a[8:11], v[172:175]
v_mfma_f32_16x16x32_bf16 v[196:199], a[112:115], a[16:19], 0
v_mfma_f32_16x16x32_bf16 v[196:199], a[116:119], a[20:23], v[196:199]
buffer_load_dwordx4 a[76:79], v2, s[40:43], s33 offen offset:1024 sc1
v_mfma_f32_16x16x32_bf16 v[220:223], a[116:119], a[28:31], 0
v_mfma_f32_16x16x32_bf16 v[220:223], a[112:115], a[24:27], v[220:223]
s_waitcnt vmcnt(13) lgkmcnt(7)
v_mfma_f32_16x16x32_bf16 a[172:175], a[120:123], a[160:163], 0
s_waitcnt lgkmcnt(0)
v_mfma_f32_16x16x32_bf16 v[224:227], a[128:131], a[24:27], 0
ds_read_b128 a[96:99], v5 offset:14336
v_mfma_f32_16x16x32_bf16 v[224:227], a[132:135], a[28:31], v[224:227]
buffer_load_dwordx4 a[80:83], v2, s[40:43], s35 offen offset:2048 sc1
v_mfma_f32_16x16x32_bf16 v[200:203], a[132:135], a[20:23], 0
ds_read_b128 a[100:103], v5 offset:20480
v_mfma_f32_16x16x32_bf16 v[200:203], a[128:131], a[16:19], v[200:203]
v_mfma_f32_16x16x32_bf16 v[176:179], a[128:131], a[8:11], 0
ds_read_b128 a[104:107], v5 offset:15360
v_mfma_f32_16x16x32_bf16 v[176:179], a[132:135], a[12:15], v[176:179]
buffer_load_dwordx4 v1, s[4:7], s44 offen offset:0 sc1 lds
v_mfma_f32_16x16x32_bf16 v[152:155], a[132:135], a[4:7], 0
ds_read_b128 a[108:111], v5 offset:21504
v_mfma_f32_16x16x32_bf16 v[152:155], a[128:131], a[0:3], v[152:155]
v_mfma_f32_16x16x32_bf16 v[132:135], a[136:139], a[0:3], 0
v_mfma_f32_16x16x32_bf16 v[132:135], a[140:143], a[4:7], v[132:135]
buffer_load_dwordx4 a[84:87], v2, s[40:43], s33 offen offset:2048 sc1
v_mfma_f32_16x16x32_bf16 v[156:159], a[140:143], a[12:15], 0
ds_read_b128 a[112:115], v5 offset:16384
v_mfma_f32_16x16x32_bf16 v[156:159], a[136:139], a[8:11], v[156:159]
ds_read_b128 a[116:119], v5 offset:22528
v_mfma_f32_16x16x32_bf16 v[180:183], a[136:139], a[16:19], 0
v_mfma_f32_16x16x32_bf16 v[180:183], a[140:143], a[20:23], v[180:183]
buffer_load_dwordx4 a[88:91], v2, s[40:43], s35 offen offset:3072 sc1
v_mfma_f32_16x16x32_bf16 v[204:207], a[140:143], a[28:31], 0
ds_read_b128 a[120:123], v6 offset:4096
v_mfma_f32_16x16x32_bf16 v[204:207], a[136:139], a[24:27], v[204:207]
v_mfma_f32_16x16x32_bf16 v[208:211], a[144:147], a[24:27], 0
v_mfma_f32_16x16x32_bf16 v[208:211], a[148:151], a[28:31], v[208:211]
buffer_load_dwordx4 v1, s[4:7], s44 offen offset:1024 sc1 lds
v_mfma_f32_16x16x32_bf16 v[184:187], a[148:151], a[20:23], 0
v_mfma_f32_16x16x32_bf16 v[184:187], a[144:147], a[16:19], v[184:187]
v_mfma_f32_16x16x32_bf16 v[160:163], a[144:147], a[8:11], 0
v_mfma_f32_16x16x32_bf16 v[160:163], a[148:151], a[12:15], v[160:163]
buffer_load_dwordx4 a[92:95], v2, s[40:43], s33 offen offset:3072 sc1
s_add_u32 s35, s35, 8192
v_mfma_f32_16x16x32_bf16 v[136:139], a[148:151], a[4:7], 0
s_add_u32 s33, s33, 8192
v_mfma_f32_16x16x32_bf16 v[136:139], a[144:147], a[0:3], v[136:139]
v_mfma_f32_16x16x32_bf16 a[176:179], a[152:155], a[160:163], 0
s_waitcnt vmcnt(11) lgkmcnt(0)
v_mfma_f32_16x16x32_bf16 v[140:143], a[96:99], a[32:35], v[140:143]
ds_read_b128 a[128:131], v5 offset:17408
v_mfma_f32_16x16x32_bf16 v[140:143], a[100:103], a[36:39], v[140:143]
buffer_load_dwordx4 a[0:3], v2, s[40:43], s35 offen offset:0 sc1
v_mfma_f32_16x16x32_bf16 v[164:167], a[100:103], a[44:47], v[164:167]
ds_read_b128 a[132:135], v5 offset:23552
v_mfma_f32_16x16x32_bf16 v[164:167], a[96:99], a[40:43], v[164:167]
v_mfma_f32_16x16x32_bf16 v[188:191], a[96:99], a[48:51], v[188:191]
ds_read_b128 a[136:139], v5 offset:12288
v_mfma_f32_16x16x32_bf16 v[188:191], a[100:103], a[52:55], v[188:191]
buffer_load_dwordx4 v1, s[4:7], s44 offen offset:2048 sc1 lds
s_add_u32 m0, s18, 0x21000
v_mfma_f32_16x16x32_bf16 v[212:215], a[100:103], a[60:63], v[212:215]
s_add_u32 s44, s50, 0xe21000
ds_read_b128 a[140:143], v5 offset:18432
v_mfma_f32_16x16x32_bf16 v[212:215], a[96:99], a[56:59], v[212:215]
v_mfma_f32_16x16x32_bf16 v[216:219], a[104:107], a[56:59], v[216:219]
v_mfma_f32_16x16x32_bf16 v[216:219], a[108:111], a[60:63], v[216:219]
buffer_load_dwordx4 a[4:7], v2, s[40:43], s33 offen offset:0 sc1
v_mfma_f32_16x16x32_bf16 v[192:195], a[108:111], a[52:55], v[192:195]
ds_read_b128 a[144:147], v5 offset:13312
v_mfma_f32_16x16x32_bf16 v[192:195], a[104:107], a[48:51], v[192:195]
ds_read_b128 a[148:151], v5 offset:19456
v_mfma_f32_16x16x32_bf16 v[168:171], a[104:107], a[40:43], v[168:171]
v_mfma_f32_16x16x32_bf16 v[168:171], a[108:111], a[44:47], v[168:171]
buffer_load_dwordx4 a[8:11], v2, s[40:43], s35 offen offset:1024 sc1
v_mfma_f32_16x16x32_bf16 v[144:147], a[108:111], a[36:39], v[144:147]
ds_read_b128 a[152:155], v6 offset:5120
v_mfma_f32_16x16x32_bf16 v[144:147], a[104:107], a[32:35], v[144:147]
v_mfma_f32_16x16x32_bf16 v[148:151], a[112:115], a[32:35], v[148:151]
v_mfma_f32_16x16x32_bf16 v[148:151], a[116:119], a[36:39], v[148:151]
buffer_load_dwordx4 v1, s[4:7], s44 offen offset:0 sc1 lds
v_mfma_f32_16x16x32_bf16 v[172:175], a[116:119], a[44:47], v[172:175]
v_mfma_f32_16x16x32_bf16 v[172:175], a[112:115], a[40:43], v[172:175]
v_mfma_f32_16x16x32_bf16 v[196:199], a[112:115], a[48:51], v[196:199]
v_mfma_f32_16x16x32_bf16 v[196:199], a[116:119], a[52:55], v[196:199]
buffer_load_dwordx4 a[12:15], v2, s[40:43], s33 offen offset:1024 sc1
v_mfma_f32_16x16x32_bf16 v[220:223], a[116:119], a[60:63], v[220:223]
v_mfma_f32_16x16x32_bf16 v[220:223], a[112:115], a[56:59], v[220:223]
v_mfma_f32_16x16x32_bf16 a[180:183], a[120:123], a[160:163], 0
s_waitcnt lgkmcnt(0)
v_mfma_f32_16x16x32_bf16 v[224:227], a[128:131], a[56:59], v[224:227]
ds_read_b128 a[96:99], v5 offset:26624
v_mfma_f32_16x16x32_bf16 v[224:227], a[132:135], a[60:63], v[224:227]
buffer_load_dwordx4 a[16:19], v2, s[40:43], s35 offen offset:2048 sc1
v_mfma_f32_16x16x32_bf16 v[200:203], a[132:135], a[52:55], v[200:203]
ds_read_b128 a[100:103], v5 offset:32768
v_mfma_f32_16x16x32_bf16 v[200:203], a[128:131], a[48:51], v[200:203]
v_mfma_f32_16x16x32_bf16 v[176:179], a[128:131], a[40:43], v[176:179]
ds_read_b128 a[104:107], v5 offset:27648
v_mfma_f32_16x16x32_bf16 v[176:179], a[132:135], a[44:47], v[176:179]
v_mfma_f32_16x16x32_bf16 v[152:155], a[132:135], a[36:39], v[152:155]
buffer_load_dwordx4 a[20:23], v2, s[40:43], s33 offen offset:2048 sc1
v_mfma_f32_16x16x32_bf16 v[152:155], a[128:131], a[32:35], v[152:155]
ds_read_b128 a[108:111], v5 offset:33792
v_mfma_f32_16x16x32_bf16 v[132:135], a[136:139], a[32:35], v[132:135]
v_mfma_f32_16x16x32_bf16 v[132:135], a[140:143], a[36:39], v[132:135]
ds_read_b128 a[112:115], v5 offset:28672
v_mfma_f32_16x16x32_bf16 v[156:159], a[140:143], a[44:47], v[156:159]
v_mfma_f32_16x16x32_bf16 v[156:159], a[136:139], a[40:43], v[156:159]
buffer_load_dwordx4 v1, s[4:7], s44 offen offset:1024 sc1 lds
v_mfma_f32_16x16x32_bf16 v[180:183], a[136:139], a[48:51], v[180:183]
ds_read_b128 a[116:119], v5 offset:34816
v_mfma_f32_16x16x32_bf16 v[180:183], a[140:143], a[52:55], v[180:183]
ds_read_b128 a[120:123], v6 offset:26624
v_mfma_f32_16x16x32_bf16 v[204:207], a[140:143], a[60:63], v[204:207]
v_mfma_f32_16x16x32_bf16 v[204:207], a[136:139], a[56:59], v[204:207]
v_mfma_f32_16x16x32_bf16 v[208:211], a[144:147], a[56:59], v[208:211]
buffer_load_dwordx4 a[24:27], v2, s[40:43], s35 offen offset:3072 sc1
v_mfma_f32_16x16x32_bf16 v[208:211], a[148:151], a[60:63], v[208:211]
v_mfma_f32_16x16x32_bf16 v[184:187], a[148:151], a[52:55], v[184:187]
v_mfma_f32_16x16x32_bf16 v[184:187], a[144:147], a[48:51], v[184:187]
v_mfma_f32_16x16x32_bf16 v[160:163], a[144:147], a[40:43], v[160:163]
v_mfma_f32_16x16x32_bf16 v[160:163], a[148:151], a[44:47], v[160:163]
buffer_load_dwordx4 a[28:31], v2, s[40:43], s33 offen offset:3072 sc1
s_add_u32 s35, s35, 8192
v_mfma_f32_16x16x32_bf16 v[136:139], a[148:151], a[36:39], v[136:139]
s_add_u32 s33, s33, 8192
v_mfma_f32_16x16x32_bf16 v[136:139], a[144:147], a[32:35], v[136:139]
v_mfma_f32_16x16x32_bf16 a[184:187], a[152:155], a[160:163], 0
s_waitcnt vmcnt(11) lgkmcnt(0)
v_mfma_f32_16x16x32_bf16 v[140:143], a[96:99], a[64:67], v[140:143]
ds_read_b128 a[128:131], v5 offset:29696
v_mfma_f32_16x16x32_bf16 v[140:143], a[100:103], a[68:71], v[140:143]
buffer_load_dwordx4 a[32:35], v2, s[40:43], s35 offen offset:0 sc1
v_mfma_f32_16x16x32_bf16 v[164:167], a[100:103], a[76:79], v[164:167]
ds_read_b128 a[132:135], v5 offset:35840
v_mfma_f32_16x16x32_bf16 v[164:167], a[96:99], a[72:75], v[164:167]
v_mfma_f32_16x16x32_bf16 v[188:191], a[96:99], a[80:83], v[188:191]
ds_read_b128 a[136:139], v5 offset:24576
v_mfma_f32_16x16x32_bf16 v[188:191], a[100:103], a[84:87], v[188:191]
buffer_load_dwordx4 v1, s[4:7], s44 offen offset:2048 sc1 lds
s_add_u32 s63, s28, 8
v_mfma_f32_16x16x32_bf16 v[212:215], a[100:103], a[92:95], v[212:215]
s_lshl_b32 s63, s63, 12
ds_read_b128 a[140:143], v5 offset:30720
v_mfma_f32_16x16x32_bf16 v[212:215], a[96:99], a[88:91], v[212:215]
v_mfma_f32_16x16x32_bf16 v[216:219], a[104:107], a[88:91], v[216:219]
v_mfma_f32_16x16x32_bf16 v[216:219], a[108:111], a[92:95], v[216:219]
buffer_load_dwordx4 a[36:39], v2, s[40:43], s33 offen offset:0 sc1
v_mfma_f32_16x16x32_bf16 v[192:195], a[108:111], a[84:87], v[192:195]
ds_read_b128 a[144:147], v5 offset:25600
v_mfma_f32_16x16x32_bf16 v[192:195], a[104:107], a[80:83], v[192:195]
ds_read_b128 a[148:151], v5 offset:31744
v_mfma_f32_16x16x32_bf16 v[168:171], a[104:107], a[72:75], v[168:171]
v_mfma_f32_16x16x32_bf16 v[168:171], a[108:111], a[76:79], v[168:171]
buffer_load_dwordx4 a[40:43], v2, s[40:43], s35 offen offset:1024 sc1
v_mfma_f32_16x16x32_bf16 v[144:147], a[108:111], a[68:71], v[144:147]
ds_read_b128 a[152:155], v6 offset:27648
v_mfma_f32_16x16x32_bf16 v[144:147], a[104:107], a[64:67], v[144:147]
v_mfma_f32_16x16x32_bf16 v[148:151], a[112:115], a[64:67], v[148:151]
v_mfma_f32_16x16x32_bf16 v[148:151], a[116:119], a[68:71], v[148:151]
buffer_load_dwordx4 a[168:171], v3, s[40:43], s63 offen sc1
s_add_u32 s88, s82, 0x280000
v_mfma_f32_16x16x32_bf16 v[172:175], a[116:119], a[76:79], v[172:175]
v_mfma_f32_16x16x32_bf16 v[172:175], a[112:115], a[72:75], v[172:175]
v_mfma_f32_16x16x32_bf16 v[196:199], a[112:115], a[80:83], v[196:199]
v_mfma_f32_16x16x32_bf16 v[196:199], a[116:119], a[84:87], v[196:199]
buffer_load_dwordx4 a[44:47], v2, s[40:43], s33 offen offset:1024 sc1
v_mfma_f32_16x16x32_bf16 v[220:223], a[116:119], a[92:95], v[220:223]
v_mfma_f32_16x16x32_bf16 v[220:223], a[112:115], a[88:91], v[220:223]
v_mfma_f32_16x16x32_bf16 a[172:175], a[120:123], a[164:167], a[172:175]
s_waitcnt lgkmcnt(0)
v_mfma_f32_16x16x32_bf16 v[224:227], a[128:131], a[88:91], v[224:227]
ds_read_b128 a[96:99], v5 offset:38912
v_mfma_f32_16x16x32_bf16 v[224:227], a[132:135], a[92:95], v[224:227]
buffer_load_dwordx4 a[48:51], v2, s[40:43], s35 offen offset:2048 sc1
v_mfma_f32_16x16x32_bf16 v[200:203], a[132:135], a[84:87], v[200:203]
ds_read_b128 a[100:103], v5 offset:45056
v_mfma_f32_16x16x32_bf16 v[200:203], a[128:131], a[80:83], v[200:203]
v_mfma_f32_16x16x32_bf16 v[176:179], a[128:131], a[72:75], v[176:179]
ds_read_b128 a[104:107], v5 offset:39936
v_mfma_f32_16x16x32_bf16 v[176:179], a[132:135], a[76:79], v[176:179]
v_mfma_f32_16x16x32_bf16 v[152:155], a[132:135], a[68:71], v[152:155]
buffer_load_dwordx4 a[52:55], v2, s[40:43], s33 offen offset:2048 sc1
v_mfma_f32_16x16x32_bf16 v[152:155], a[128:131], a[64:67], v[152:155]
ds_read_b128 a[108:111], v5 offset:46080
v_mfma_f32_16x16x32_bf16 v[132:135], a[136:139], a[64:67], v[132:135]
v_mfma_f32_16x16x32_bf16 v[132:135], a[140:143], a[68:71], v[132:135]
ds_read_b128 a[112:115], v5 offset:40960
v_mfma_f32_16x16x32_bf16 v[156:159], a[140:143], a[76:79], v[156:159]
v_mfma_f32_16x16x32_bf16 v[156:159], a[136:139], a[72:75], v[156:159]
buffer_load_dwordx4 v[92:95], v1, s[4:7], s88 offen offset:0 sc1
v_mfma_f32_16x16x32_bf16 v[180:183], a[136:139], a[80:83], v[180:183]
ds_read_b128 a[116:119], v5 offset:47104
v_mfma_f32_16x16x32_bf16 v[180:183], a[140:143], a[84:87], v[180:183]
ds_read_b128 a[120:123], v6 offset:28672
v_mfma_f32_16x16x32_bf16 v[204:207], a[140:143], a[92:95], v[204:207]
v_mfma_f32_16x16x32_bf16 v[204:207], a[136:139], a[88:91], v[204:207]
v_mfma_f32_16x16x32_bf16 v[208:211], a[144:147], a[88:91], v[208:211]
buffer_load_dwordx4 a[56:59], v2, s[40:43], s35 offen offset:3072 sc1
v_mfma_f32_16x16x32_bf16 v[208:211], a[148:151], a[92:95], v[208:211]
v_mfma_f32_16x16x32_bf16 v[184:187], a[148:151], a[84:87], v[184:187]
v_mfma_f32_16x16x32_bf16 v[184:187], a[144:147], a[80:83], v[184:187]
v_mfma_f32_16x16x32_bf16 v[160:163], a[144:147], a[72:75], v[160:163]
v_mfma_f32_16x16x32_bf16 v[160:163], a[148:151], a[76:79], v[160:163]
buffer_load_dwordx4 a[60:63], v2, s[40:43], s33 offen offset:3072 sc1
s_add_u32 s35, s35, 8192
v_mfma_f32_16x16x32_bf16 v[136:139], a[148:151], a[68:71], v[136:139]
s_add_u32 s33, s33, 8192
v_mfma_f32_16x16x32_bf16 v[136:139], a[144:147], a[64:67], v[136:139]
v_mfma_f32_16x16x32_bf16 a[176:179], a[152:155], a[164:167], a[176:179]
s_waitcnt vmcnt(11) lgkmcnt(0)
v_mfma_f32_16x16x32_bf16 v[140:143], a[96:99], a[0:3], v[140:143]
ds_read_b128 a[128:131], v5 offset:41984
v_mfma_f32_16x16x32_bf16 v[140:143], a[100:103], a[4:7], v[140:143]
buffer_load_dwordx4 a[64:67], v2, s[40:43], s35 offen offset:0 sc1
v_mfma_f32_16x16x32_bf16 v[164:167], a[100:103], a[12:15], v[164:167]
ds_read_b128 a[132:135], v5 offset:48128
v_mfma_f32_16x16x32_bf16 v[164:167], a[96:99], a[8:11], v[164:167]
v_mfma_f32_16x16x32_bf16 v[188:191], a[96:99], a[16:19], v[188:191]
ds_read_b128 a[136:139], v5 offset:36864
v_mfma_f32_16x16x32_bf16 v[188:191], a[100:103], a[20:23], v[188:191]
buffer_load_dwordx4 v[96:99], v1, s[4:7], s88 offen offset:1024 sc1
v_mfma_f32_16x16x32_bf16 v[212:215], a[100:103], a[28:31], v[212:215]
ds_read_b128 a[140:143], v5 offset:43008
v_mfma_f32_16x16x32_bf16 v[212:215], a[96:99], a[24:27], v[212:215]
v_mfma_f32_16x16x32_bf16 v[216:219], a[104:107], a[24:27], v[216:219]
v_mfma_f32_16x16x32_bf16 v[216:219], a[108:111], a[28:31], v[216:219]
buffer_load_dwordx4 a[68:71], v2, s[40:43], s33 offen offset:0 sc1
v_mfma_f32_16x16x32_bf16 v[192:195], a[108:111], a[20:23], v[192:195]
ds_read_b128 a[144:147], v5 offset:37888
v_mfma_f32_16x16x32_bf16 v[192:195], a[104:107], a[16:19], v[192:195]
ds_read_b128 a[148:151], v5 offset:44032
v_mfma_f32_16x16x32_bf16 v[168:171], a[104:107], a[8:11], v[168:171]
v_mfma_f32_16x16x32_bf16 v[168:171], a[108:111], a[12:15], v[168:171]
buffer_load_dwordx4 a[72:75], v2, s[40:43], s35 offen offset:1024 sc1
v_mfma_f32_16x16x32_bf16 v[144:147], a[108:111], a[4:7], v[144:147]
ds_read_b128 a[152:155], v6 offset:29696
v_mfma_f32_16x16x32_bf16 v[144:147], a[104:107], a[0:3], v[144:147]
v_mfma_f32_16x16x32_bf16 v[148:151], a[112:115], a[0:3], v[148:151]
v_mfma_f32_16x16x32_bf16 v[148:151], a[116:119], a[4:7], v[148:151]
buffer_load_dwordx4 v[100:103], v1, s[4:7], s88 offen offset:2048 sc1
v_mfma_f32_16x16x32_bf16 v[172:175], a[116:119], a[12:15], v[172:175]
v_mfma_f32_16x16x32_bf16 v[172:175], a[112:115], a[8:11], v[172:175]
v_mfma_f32_16x16x32_bf16 v[196:199], a[112:115], a[16:19], v[196:199]
v_mfma_f32_16x16x32_bf16 v[196:199], a[116:119], a[20:23], v[196:199]
buffer_load_dwordx4 a[76:79], v2, s[40:43], s33 offen offset:1024 sc1
v_mfma_f32_16x16x32_bf16 v[220:223], a[116:119], a[28:31], v[220:223]
v_mfma_f32_16x16x32_bf16 v[220:223], a[112:115], a[24:27], v[220:223]
v_mfma_f32_16x16x32_bf16 a[180:183], a[120:123], a[164:167], a[180:183]
s_waitcnt lgkmcnt(0)
s_barrier
v_mfma_f32_16x16x32_bf16 v[224:227], a[128:131], a[24:27], v[224:227]
v_add_u32 v5, 49152, v1
v_add_u32 v6, s55, v5
v_mfma_f32_16x16x32_bf16 v[224:227], a[132:135], a[28:31], v[224:227]
buffer_load_dwordx4 a[80:83], v2, s[40:43], s35 offen offset:2048 sc1
v_mfma_f32_16x16x32_bf16 v[200:203], a[132:135], a[20:23], v[200:203]
ds_read_b128 a[96:99], v5 offset:2048
v_mfma_f32_16x16x32_bf16 v[200:203], a[128:131], a[16:19], v[200:203]
ds_read_b128 a[100:103], v5 offset:8192
v_mfma_f32_16x16x32_bf16 v[176:179], a[128:131], a[8:11], v[176:179]
ds_read_b128 a[104:107], v5 offset:3072
v_mfma_f32_16x16x32_bf16 v[176:179], a[132:135], a[12:15], v[176:179]
buffer_load_dwordx4 v[104:107], v1, s[4:7], s88 offen offset:3072 sc1
s_add_u32 s88, s88, 4096
v_mfma_f32_16x16x32_bf16 v[152:155], a[132:135], a[4:7], v[152:155]
ds_read_b128 a[108:111], v5 offset:9216
v_mfma_f32_16x16x32_bf16 v[152:155], a[128:131], a[0:3], v[152:155]
v_mfma_f32_16x16x32_bf16 v[132:135], a[136:139], a[0:3], v[132:135]
v_mfma_f32_16x16x32_bf16 v[132:135], a[140:143], a[4:7], v[132:135]
buffer_load_dwordx4 a[84:87], v2, s[40:43], s33 offen offset:2048 sc1
v_mfma_f32_16x16x32_bf16 v[156:159], a[140:143], a[12:15], v[156:159]
ds_read_b128 a[112:115], v5 offset:4096
v_mfma_f32_16x16x32_bf16 v[156:159], a[136:139], a[8:11], v[156:159]
ds_read_b128 a[116:119], v5 offset:10240
v_mfma_f32_16x16x32_bf16 v[180:183], a[136:139], a[16:19], v[180:183]
v_mfma_f32_16x16x32_bf16 v[180:183], a[140:143], a[20:23], v[180:183]
buffer_load_dwordx4 a[88:91], v2, s[40:43], s35 offen offset:3072 sc1
v_mfma_f32_16x16x32_bf16 v[204:207], a[140:143], a[28:31], v[204:207]
ds_read_b128 a[120:123], v6 offset:2048
v_mfma_f32_16x16x32_bf16 v[204:207], a[136:139], a[24:27], v[204:207]
v_mfma_f32_16x16x32_bf16 v[208:211], a[144:147], a[24:27], v[208:211]
v_mfma_f32_16x16x32_bf16 v[208:211], a[148:151], a[28:31], v[208:211]
buffer_load_dwordx4 v[108:111], v1, s[4:7], s88 offen offset:0 sc1
s_add_u32 s63, s28, 12
v_mfma_f32_16x16x32_bf16 v[184:187], a[148:151], a[20:23], v[184:187]
s_lshl_b32 s63, s63, 12
v_mfma_f32_16x16x32_bf16 v[184:187], a[144:147], a[16:19], v[184:187]
v_mfma_f32_16x16x32_bf16 v[160:163], a[144:147], a[8:11], v[160:163]
v_mfma_f32_16x16x32_bf16 v[160:163], a[148:151], a[12:15], v[160:163]
buffer_load_dwordx4 a[92:95], v2, s[40:43], s33 offen offset:3072 sc1
s_add_u32 s35, s35, 8192
v_mfma_f32_16x16x32_bf16 v[136:139], a[148:151], a[4:7], v[136:139]
s_add_u32 s33, s33, 8192
v_mfma_f32_16x16x32_bf16 v[136:139], a[144:147], a[0:3], v[136:139]
v_mfma_f32_16x16x32_bf16 a[184:187], a[152:155], a[164:167], a[184:187]
s_waitcnt vmcnt(12) lgkmcnt(0)
v_mfma_f32_16x16x32_bf16 v[140:143], a[96:99], a[32:35], v[140:143]
ds_read_b128 a[128:131], v5 offset:5120
v_mfma_f32_16x16x32_bf16 v[140:143], a[100:103], a[36:39], v[140:143]
buffer_load_dwordx4 a[0:3], v2, s[40:43], s35 offen offset:0 sc1
v_mfma_f32_16x16x32_bf16 v[164:167], a[100:103], a[44:47], v[164:167]
ds_read_b128 a[132:135], v5 offset:11264
v_mfma_f32_16x16x32_bf16 v[164:167], a[96:99], a[40:43], v[164:167]
v_mfma_f32_16x16x32_bf16 v[188:191], a[96:99], a[48:51], v[188:191]
ds_read_b128 a[136:139], v5 offset:0
v_mfma_f32_16x16x32_bf16 v[188:191], a[100:103], a[52:55], v[188:191]
v_mfma_f32_16x16x32_bf16 v[212:215], a[100:103], a[60:63], v[212:215]
buffer_load_dwordx4 a[4:7], v2, s[40:43], s33 offen offset:0 sc1
v_mfma_f32_16x16x32_bf16 v[212:215], a[96:99], a[56:59], v[212:215]
ds_read_b128 a[140:143], v5 offset:6144
v_mfma_f32_16x16x32_bf16 v[216:219], a[104:107], a[56:59], v[216:219]
v_mfma_f32_16x16x32_bf16 v[216:219], a[108:111], a[60:63], v[216:219]
ds_read_b128 a[144:147], v5 offset:1024
v_mfma_f32_16x16x32_bf16 v[192:195], a[108:111], a[52:55], v[192:195]
v_mfma_f32_16x16x32_bf16 v[192:195], a[104:107], a[48:51], v[192:195]
buffer_load_dwordx4 a[160:163], v3, s[40:43], s63 offen sc1
v_mfma_f32_16x16x32_bf16 v[168:171], a[104:107], a[40:43], v[168:171]
ds_read_b128 a[148:151], v5 offset:7168
v_mfma_f32_16x16x32_bf16 v[168:171], a[108:111], a[44:47], v[168:171]
ds_read_b128 a[152:155], v6 offset:3072
v_mfma_f32_16x16x32_bf16 v[144:147], a[108:111], a[36:39], v[144:147]
v_mfma_f32_16x16x32_bf16 v[144:147], a[104:107], a[32:35], v[144:147]
v_mfma_f32_16x16x32_bf16 v[148:151], a[112:115], a[32:35], v[148:151]
buffer_load_dwordx4 a[8:11], v2, s[40:43], s35 offen offset:1024 sc1
v_mfma_f32_16x16x32_bf16 v[148:151], a[116:119], a[36:39], v[148:151]
v_mfma_f32_16x16x32_bf16 v[172:175], a[116:119], a[44:47], v[172:175]
v_mfma_f32_16x16x32_bf16 v[172:175], a[112:115], a[40:43], v[172:175]
v_mfma_f32_16x16x32_bf16 v[196:199], a[112:115], a[48:51], v[196:199]
v_mfma_f32_16x16x32_bf16 v[196:199], a[116:119], a[52:55], v[196:199]
buffer_load_dwordx4 a[12:15], v2, s[40:43], s33 offen offset:1024 sc1
v_mfma_f32_16x16x32_bf16 v[220:223], a[116:119], a[60:63], v[220:223]
v_mfma_f32_16x16x32_bf16 v[220:223], a[112:115], a[56:59], v[220:223]
v_mfma_f32_16x16x32_bf16 a[172:175], a[120:123], a[168:171], a[172:175]
s_waitcnt lgkmcnt(0)
v_mfma_f32_16x16x32_bf16 v[224:227], a[128:131], a[56:59], v[224:227]
ds_read_b128 a[96:99], v5 offset:14336
v_mfma_f32_16x16x32_bf16 v[224:227], a[132:135], a[60:63], v[224:227]
buffer_load_dwordx4 a[16:19], v2, s[40:43], s35 offen offset:2048 sc1
v_mfma_f32_16x16x32_bf16 v[200:203], a[132:135], a[52:55], v[200:203]
ds_read_b128 a[100:103], v5 offset:20480
v_mfma_f32_16x16x32_bf16 v[200:203], a[128:131], a[48:51], v[200:203]
v_mfma_f32_16x16x32_bf16 v[176:179], a[128:131], a[40:43], v[176:179]
ds_read_b128 a[104:107], v5 offset:15360
v_mfma_f32_16x16x32_bf16 v[176:179], a[132:135], a[44:47], v[176:179]
buffer_load_dwordx4 v[112:115], v1, s[4:7], s88 offen offset:1024 sc1
v_mfma_f32_16x16x32_bf16 v[152:155], a[132:135], a[36:39], v[152:155]
ds_read_b128 a[108:111], v5 offset:21504
v_mfma_f32_16x16x32_bf16 v[152:155], a[128:131], a[32:35], v[152:155]
v_mfma_f32_16x16x32_bf16 v[132:135], a[136:139], a[32:35], v[132:135]
v_mfma_f32_16x16x32_bf16 v[132:135], a[140:143], a[36:39], v[132:135]
buffer_load_dwordx4 a[20:23], v2, s[40:43], s33 offen offset:2048 sc1
v_mfma_f32_16x16x32_bf16 v[156:159], a[140:143], a[44:47], v[156:159]
ds_read_b128 a[112:115], v5 offset:16384
v_mfma_f32_16x16x32_bf16 v[156:159], a[136:139], a[40:43], v[156:159]
ds_read_b128 a[116:119], v5 offset:22528
v_mfma_f32_16x16x32_bf16 v[180:183], a[136:139], a[48:51], v[180:183]
v_mfma_f32_16x16x32_bf16 v[180:183], a[140:143], a[52:55], v[180:183]
buffer_load_dwordx4 a[24:27], v2, s[40:43], s35 offen offset:3072 sc1
v_mfma_f32_16x16x32_bf16 v[204:207], a[140:143], a[60:63], v[204:207]
ds_read_b128 a[120:123], v6 offset:4096
v_mfma_f32_16x16x32_bf16 v[204:207], a[136:139], a[56:59], v[204:207]
v_mfma_f32_16x16x32_bf16 v[208:211], a[144:147], a[56:59], v[208:211]
v_mfma_f32_16x16x32_bf16 v[208:211], a[148:151], a[60:63], v[208:211]
buffer_load_dwordx4 v[116:119], v1, s[4:7], s88 offen offset:2048 sc1
v_mfma_f32_16x16x32_bf16 v[184:187], a[148:151], a[52:55], v[184:187]
v_mfma_f32_16x16x32_bf16 v[184:187], a[144:147], a[48:51], v[184:187]
v_mfma_f32_16x16x32_bf16 v[160:163], a[144:147], a[40:43], v[160:163]
v_mfma_f32_16x16x32_bf16 v[160:163], a[148:151], a[44:47], v[160:163]
buffer_load_dwordx4 a[28:31], v2, s[40:43], s33 offen offset:3072 sc1
s_add_u32 s35, s35, 8192
v_mfma_f32_16x16x32_bf16 v[136:139], a[148:151], a[36:39], v[136:139]
s_add_u32 s33, s33, 8192
v_mfma_f32_16x16x32_bf16 v[136:139], a[144:147], a[32:35], v[136:139]
v_mfma_f32_16x16x32_bf16 a[176:179], a[152:155], a[168:171], a[176:179]
s_waitcnt vmcnt(11) lgkmcnt(0)
v_mfma_f32_16x16x32_bf16 v[140:143], a[96:99], a[64:67], v[140:143]
ds_read_b128 a[128:131], v5 offset:17408
v_mfma_f32_16x16x32_bf16 v[140:143], a[100:103], a[68:71], v[140:143]
buffer_load_dwordx4 a[32:35], v2, s[40:43], s35 offen offset:0 sc1
v_mfma_f32_16x16x32_bf16 v[164:167], a[100:103], a[76:79], v[164:167]
ds_read_b128 a[132:135], v5 offset:23552
v_mfma_f32_16x16x32_bf16 v[164:167], a[96:99], a[72:75], v[164:167]
v_mfma_f32_16x16x32_bf16 v[188:191], a[96:99], a[80:83], v[188:191]
ds_read_b128 a[136:139], v5 offset:12288
v_mfma_f32_16x16x32_bf16 v[188:191], a[100:103], a[84:87], v[188:191]
v_mfma_f32_16x16x32_bf16 v[212:215], a[100:103], a[92:95], v[212:215]
buffer_load_dwordx4 a[36:39], v2, s[40:43], s33 offen offset:0 sc1
v_mfma_f32_16x16x32_bf16 v[212:215], a[96:99], a[88:91], v[212:215]
ds_read_b128 a[140:143], v5 offset:18432
v_mfma_f32_16x16x32_bf16 v[216:219], a[104:107], a[88:91], v[216:219]
v_mfma_f32_16x16x32_bf16 v[216:219], a[108:111], a[92:95], v[216:219]
ds_read_b128 a[144:147], v5 offset:13312
v_mfma_f32_16x16x32_bf16 v[192:195], a[108:111], a[84:87], v[192:195]
v_mfma_f32_16x16x32_bf16 v[192:195], a[104:107], a[80:83], v[192:195]
buffer_load_dwordx4 v[120:123], v1, s[4:7], s88 offen offset:3072 sc1
s_add_u32 s88, s83, 0x280000
v_mfma_f32_16x16x32_bf16 v[168:171], a[104:107], a[72:75], v[168:171]
ds_read_b128 a[148:151], v5 offset:19456
v_mfma_f32_16x16x32_bf16 v[168:171], a[108:111], a[76:79], v[168:171]
ds_read_b128 a[152:155], v6 offset:5120
v_mfma_f32_16x16x32_bf16 v[144:147], a[108:111], a[68:71], v[144:147]
v_mfma_f32_16x16x32_bf16 v[144:147], a[104:107], a[64:67], v[144:147]
v_mfma_f32_16x16x32_bf16 v[148:151], a[112:115], a[64:67], v[148:151]
buffer_load_dwordx4 a[40:43], v2, s[40:43], s35 offen offset:1024 sc1
v_mfma_f32_16x16x32_bf16 v[148:151], a[116:119], a[68:71], v[148:151]
v_mfma_f32_16x16x32_bf16 v[172:175], a[116:119], a[76:79], v[172:175]
v_mfma_f32_16x16x32_bf16 v[172:175], a[112:115], a[72:75], v[172:175]
v_mfma_f32_16x16x32_bf16 v[196:199], a[112:115], a[80:83], v[196:199]
v_mfma_f32_16x16x32_bf16 v[196:199], a[116:119], a[84:87], v[196:199]
buffer_load_dwordx4 a[44:47], v2, s[40:43], s33 offen offset:1024 sc1
v_mfma_f32_16x16x32_bf16 v[220:223], a[116:119], a[92:95], v[220:223]
v_mfma_f32_16x16x32_bf16 v[220:223], a[112:115], a[88:91], v[220:223]
v_mfma_f32_16x16x32_bf16 a[180:183], a[120:123], a[168:171], a[180:183]
s_waitcnt lgkmcnt(0)
v_mfma_f32_16x16x32_bf16 v[224:227], a[128:131], a[88:91], v[224:227]
ds_read_b128 a[96:99], v5 offset:26624
v_mfma_f32_16x16x32_bf16 v[224:227], a[132:135], a[92:95], v[224:227]
buffer_load_dwordx4 a[48:51], v2, s[40:43], s35 offen offset:2048 sc1
v_mfma_f32_16x16x32_bf16 v[200:203], a[132:135], a[84:87], v[200:203]
ds_read_b128 a[100:103], v5 offset:32768
v_mfma_f32_16x16x32_bf16 v[200:203], a[128:131], a[80:83], v[200:203]
v_mfma_f32_16x16x32_bf16 v[176:179], a[128:131], a[72:75], v[176:179]
ds_read_b128 a[104:107], v5 offset:27648
v_mfma_f32_16x16x32_bf16 v[176:179], a[132:135], a[76:79], v[176:179]
buffer_load_dwordx4 v[124:127], v1, s[4:7], s88 offen offset:0 sc1
v_mfma_f32_16x16x32_bf16 v[152:155], a[132:135], a[68:71], v[152:155]
ds_read_b128 a[108:111], v5 offset:33792
v_mfma_f32_16x16x32_bf16 v[152:155], a[128:131], a[64:67], v[152:155]
v_mfma_f32_16x16x32_bf16 v[132:135], a[136:139], a[64:67], v[132:135]
v_mfma_f32_16x16x32_bf16 v[132:135], a[140:143], a[68:71], v[132:135]
buffer_load_dwordx4 a[52:55], v2, s[40:43], s33 offen offset:2048 sc1
v_mfma_f32_16x16x32_bf16 v[156:159], a[140:143], a[76:79], v[156:159]
ds_read_b128 a[112:115], v5 offset:28672
v_mfma_f32_16x16x32_bf16 v[156:159], a[136:139], a[72:75], v[156:159]
ds_read_b128 a[116:119], v5 offset:34816
v_mfma_f32_16x16x32_bf16 v[180:183], a[136:139], a[80:83], v[180:183]
v_mfma_f32_16x16x32_bf16 v[180:183], a[140:143], a[84:87], v[180:183]
buffer_load_dwordx4 a[56:59], v2, s[40:43], s35 offen offset:3072 sc1
v_mfma_f32_16x16x32_bf16 v[204:207], a[140:143], a[92:95], v[204:207]
ds_read_b128 a[120:123], v6 offset:26624
L_stub11:
s_cbranch_execz L_stub12
v_mfma_f32_16x16x32_bf16 v[204:207], a[136:139], a[88:91], v[204:207]
v_mfma_f32_16x16x32_bf16 v[208:211], a[144:147], a[88:91], v[208:211]
v_mfma_f32_16x16x32_bf16 v[208:211], a[148:151], a[92:95], v[208:211]
buffer_load_dwordx4 v[128:131], v1, s[4:7], s88 offen offset:1024 sc1
s_add_u32 m0, s18, 0x0
v_mfma_f32_16x16x32_bf16 v[184:187], a[148:151], a[84:87], v[184:187]
s_add_u32 s44, s50, 0xe24000
v_mfma_f32_16x16x32_bf16 v[184:187], a[144:147], a[80:83], v[184:187]
v_mfma_f32_16x16x32_bf16 v[160:163], a[144:147], a[72:75], v[160:163]
v_mfma_f32_16x16x32_bf16 v[160:163], a[148:151], a[76:79], v[160:163]
buffer_load_dwordx4 a[60:63], v2, s[40:43], s33 offen offset:3072 sc1
s_add_u32 s35, s35, 8192
v_mfma_f32_16x16x32_bf16 v[136:139], a[148:151], a[68:71], v[136:139]
s_add_u32 s33, s33, 8192
v_mfma_f32_16x16x32_bf16 v[136:139], a[144:147], a[64:67], v[136:139]
v_mfma_f32_16x16x32_bf16 a[184:187], a[152:155], a[168:171], a[184:187]
s_waitcnt vmcnt(11) lgkmcnt(0)
v_mfma_f32_16x16x32_bf16 v[140:143], a[96:99], a[0:3], v[140:143]
ds_read_b128 a[128:131], v5 offset:29696
v_mfma_f32_16x16x32_bf16 v[140:143], a[100:103], a[4:7], v[140:143]
buffer_load_dwordx4 a[64:67], v2, s[40:43], s35 offen offset:0 sc1
v_mfma_f32_16x16x32_bf16 v[164:167], a[100:103], a[12:15], v[164:167]
ds_read_b128 a[132:135], v5 offset:35840
v_mfma_f32_16x16x32_bf16 v[164:167], a[96:99], a[8:11], v[164:167]
v_mfma_f32_16x16x32_bf16 v[188:191], a[96:99], a[16:19], v[188:191]
ds_read_b128 a[136:139], v5 offset:24576
v_mfma_f32_16x16x32_bf16 v[188:191], a[100:103], a[20:23], v[188:191]
buffer_load_dwordx4 v1, s[4:7], s44 offen offset:0 sc1 lds
s_add_u32 s63, s28, 16
v_mfma_f32_16x16x32_bf16 v[212:215], a[100:103], a[28:31], v[212:215]
s_lshl_b32 s63, s63, 12
ds_read_b128 a[140:143], v5 offset:30720
v_mfma_f32_16x16x32_bf16 v[212:215], a[96:99], a[24:27], v[212:215]
v_mfma_f32_16x16x32_bf16 v[216:219], a[104:107], a[24:27], v[216:219]
v_mfma_f32_16x16x32_bf16 v[216:219], a[108:111], a[28:31], v[216:219]
buffer_load_dwordx4 a[68:71], v2, s[40:43], s33 offen offset:0 sc1
v_mfma_f32_16x16x32_bf16 v[192:195], a[108:111], a[20:23], v[192:195]
ds_read_b128 a[144:147], v5 offset:25600
v_mfma_f32_16x16x32_bf16 v[192:195], a[104:107], a[16:19], v[192:195]
ds_read_b128 a[148:151], v5 offset:31744
v_mfma_f32_16x16x32_bf16 v[168:171], a[104:107], a[8:11], v[168:171]
v_mfma_f32_16x16x32_bf16 v[168:171], a[108:111], a[12:15], v[168:171]
buffer_load_dwordx4 a[72:75], v2, s[40:43], s35 offen offset:1024 sc1
v_mfma_f32_16x16x32_bf16 v[144:147], a[108:111], a[4:7], v[144:147]
ds_read_b128 a[152:155], v6 offset:27648
v_mfma_f32_16x16x32_bf16 v[144:147], a[104:107], a[0:3], v[144:147]
v_mfma_f32_16x16x32_bf16 v[148:151], a[112:115], a[0:3], v[148:151]
v_mfma_f32_16x16x32_bf16 v[148:151], a[116:119], a[4:7], v[148:151]
buffer_load_dwordx4 a[164:167], v3, s[40:43], s63 offen sc1
v_mfma_f32_16x16x32_bf16 v[172:175], a[116:119], a[12:15], v[172:175]
v_mfma_f32_16x16x32_bf16 v[172:175], a[112:115], a[8:11], v[172:175]
v_mfma_f32_16x16x32_bf16 v[196:199], a[112:115], a[16:19], v[196:199]
v_mfma_f32_16x16x32_bf16 v[196:199], a[116:119], a[20:23], v[196:199]
buffer_load_dwordx4 a[76:79], v2, s[40:43], s33 offen offset:1024 sc1
v_mfma_f32_16x16x32_bf16 v[220:223], a[116:119], a[28:31], v[220:223]
v_mfma_f32_16x16x32_bf16 v[220:223], a[112:115], a[24:27], v[220:223]
v_mfma_f32_16x16x32_bf16 a[172:175], a[120:123], a[160:163], a[172:175]
s_waitcnt lgkmcnt(0)
v_mfma_f32_16x16x32_bf16 v[224:227], a[128:131], a[24:27], v[224:227]
ds_read_b128 a[96:99], v5 offset:38912
v_mfma_f32_16x16x32_bf16 v[224:227], a[132:135], a[28:31], v[224:227]
buffer_load_dwordx4 a[80:83], v2, s[40:43], s35 offen offset:2048 sc1
v_mfma_f32_16x16x32_bf16 v[200:203], a[132:135], a[20:23], v[200:203]
ds_read_b128 a[100:103], v5 offset:45056
v_mfma_f32_16x16x32_bf16 v[200:203], a[128:131], a[16:19], v[200:203]
v_mfma_f32_16x16x32_bf16 v[176:179], a[128:131], a[8:11], v[176:179]
ds_read_b128 a[104:107], v5 offset:39936
v_mfma_f32_16x16x32_bf16 v[176:179], a[132:135], a[12:15], v[176:179]
v_mfma_f32_16x16x32_bf16 v[152:155], a[132:135], a[4:7], v[152:155]
buffer_load_dwordx4 a[84:87], v2, s[40:43], s33 offen offset:2048 sc1
v_mfma_f32_16x16x32_bf16 v[152:155], a[128:131], a[0:3], v[152:155]
ds_read_b128 a[108:111], v5 offset:46080
v_mfma_f32_16x16x32_bf16 v[132:135], a[136:139], a[0:3], v[132:135]
v_mfma_f32_16x16x32_bf16 v[132:135], a[140:143], a[4:7], v[132:135]
ds_read_b128 a[112:115], v5 offset:40960
v_mfma_f32_16x16x32_bf16 v[156:159], a[140:143], a[12:15], v[156:159]
v_mfma_f32_16x16x32_bf16 v[156:159], a[136:139], a[8:11], v[156:159]
buffer_load_dwordx4 v1, s[4:7], s44 offen offset:1024 sc1 lds
v_mfma_f32_16x16x32_bf16 v[180:183], a[136:139], a[16:19], v[180:183]
ds_read_b128 a[116:119], v5 offset:47104
v_mfma_f32_16x16x32_bf16 v[180:183], a[140:143], a[20:23], v[180:183]
ds_read_b128 a[120:123], v6 offset:28672
v_mfma_f32_16x16x32_bf16 v[204:207], a[140:143], a[28:31], v[204:207]
v_mfma_f32_16x16x32_bf16 v[204:207], a[136:139], a[24:27], v[204:207]
v_mfma_f32_16x16x32_bf16 v[208:211], a[144:147], a[24:27], v[208:211]
buffer_load_dwordx4 a[88:91], v2, s[40:43], s35 offen offset:3072 sc1
v_mfma_f32_16x16x32_bf16 v[208:211], a[148:151], a[28:31], v[208:211]
v_mfma_f32_16x16x32_bf16 v[184:187], a[148:151], a[20:23], v[184:187]
v_mfma_f32_16x16x32_bf16 v[184:187], a[144:147], a[16:19], v[184:187]
v_mfma_f32_16x16x32_bf16 v[160:163], a[144:147], a[8:11], v[160:163]
v_mfma_f32_16x16x32_bf16 v[160:163], a[148:151], a[12:15], v[160:163]
buffer_load_dwordx4 a[92:95], v2, s[40:43], s33 offen offset:3072 sc1
s_add_u32 s35, s35, 8192
v_mfma_f32_16x16x32_bf16 v[136:139], a[148:151], a[4:7], v[136:139]
s_add_u32 s33, s33, 8192
v_mfma_f32_16x16x32_bf16 v[136:139], a[144:147], a[0:3], v[136:139]
v_mfma_f32_16x16x32_bf16 a[176:179], a[152:155], a[160:163], a[176:179]
s_waitcnt vmcnt(11) lgkmcnt(0)
v_mfma_f32_16x16x32_bf16 v[140:143], a[96:99], a[32:35], v[140:143]
ds_read_b128 a[128:131], v5 offset:41984
v_mfma_f32_16x16x32_bf16 v[140:143], a[100:103], a[36:39], v[140:143]
buffer_load_dwordx4 a[0:3], v2, s[40:43], s35 offen offset:0 sc1
v_mfma_f32_16x16x32_bf16 v[164:167], a[100:103], a[44:47], v[164:167]
ds_read_b128 a[132:135], v5 offset:48128
v_mfma_f32_16x16x32_bf16 v[164:167], a[96:99], a[40:43], v[164:167]
v_mfma_f32_16x16x32_bf16 v[188:191], a[96:99], a[48:51], v[188:191]
ds_read_b128 a[136:139], v5 offset:36864
v_mfma_f32_16x16x32_bf16 v[188:191], a[100:103], a[52:55], v[188:191]
buffer_load_dwordx4 v1, s[4:7], s44 offen offset:2048 sc1 lds
s_add_u32 m0, s18, 0x3000
v_mfma_f32_16x16x32_bf16 v[212:215], a[100:103], a[60:63], v[212:215]
s_add_u32 s44, s50, 0xe27000
ds_read_b128 a[140:143], v5 offset:43008
v_mfma_f32_16x16x32_bf16 v[212:215], a[96:99], a[56:59], v[212:215]
v_mfma_f32_16x16x32_bf16 v[216:219], a[104:107], a[56:59], v[216:219]
v_mfma_f32_16x16x32_bf16 v[216:219], a[108:111], a[60:63], v[216:219]
buffer_load_dwordx4 a[4:7], v2, s[40:43], s33 offen offset:0 sc1
v_mfma_f32_16x16x32_bf16 v[192:195], a[108:111], a[52:55], v[192:195]
ds_read_b128 a[144:147], v5 offset:37888
v_mfma_f32_16x16x32_bf16 v[192:195], a[104:107], a[48:51], v[192:195]
ds_read_b128 a[148:151], v5 offset:44032
v_mfma_f32_16x16x32_bf16 v[168:171], a[104:107], a[40:43], v[168:171]
v_mfma_f32_16x16x32_bf16 v[168:171], a[108:111], a[44:47], v[168:171]
buffer_load_dwordx4 a[8:11], v2, s[40:43], s35 offen offset:1024 sc1
v_mfma_f32_16x16x32_bf16 v[144:147], a[108:111], a[36:39], v[144:147]
ds_read_b128 a[152:155], v6 offset:29696
v_mfma_f32_16x16x32_bf16 v[144:147], a[104:107], a[32:35], v[144:147]
v_mfma_f32_16x16x32_bf16 v[148:151], a[112:115], a[32:35], v[148:151]
v_mfma_f32_16x16x32_bf16 v[148:151], a[116:119], a[36:39], v[148:151]
buffer_load_dwordx4 v1, s[4:7], s44 offen offset:0 sc1 lds
v_mfma_f32_16x16x32_bf16 v[172:175], a[116:119], a[44:47], v[172:175]
v_mfma_f32_16x16x32_bf16 v[172:175], a[112:115], a[40:43], v[172:175]
v_mfma_f32_16x16x32_bf16 v[196:199], a[112:115], a[48:51], v[196:199]
v_mfma_f32_16x16x32_bf16 v[196:199], a[116:119], a[52:55], v[196:199]
buffer_load_dwordx4 a[12:15], v2, s[40:43], s33 offen offset:1024 sc1
v_mfma_f32_16x16x32_bf16 v[220:223], a[116:119], a[60:63], v[220:223]
v_mfma_f32_16x16x32_bf16 v[220:223], a[112:115], a[56:59], v[220:223]
v_mfma_f32_16x16x32_bf16 a[180:183], a[120:123], a[160:163], a[180:183]
s_waitcnt lgkmcnt(0)
s_barrier
v_mfma_f32_16x16x32_bf16 v[224:227], a[128:131], a[56:59], v[224:227]
v_add_u32 v5, 98304, v1
v_add_u32 v6, s55, v5
v_mfma_f32_16x16x32_bf16 v[224:227], a[132:135], a[60:63], v[224:227]
buffer_load_dwordx4 a[16:19], v2, s[40:43], s35 offen offset:2048 sc1
v_mfma_f32_16x16x32_bf16 v[200:203], a[132:135], a[52:55], v[200:203]
ds_read_b128 a[96:99], v5 offset:2048
v_mfma_f32_16x16x32_bf16 v[200:203], a[128:131], a[48:51], v[200:203]
ds_read_b128 a[100:103], v5 offset:8192
v_mfma_f32_16x16x32_bf16 v[176:179], a[128:131], a[40:43], v[176:179]
ds_read_b128 a[104:107], v5 offset:3072
v_mfma_f32_16x16x32_bf16 v[176:179], a[132:135], a[44:47], v[176:179]
v_mfma_f32_16x16x32_bf16 v[152:155], a[132:135], a[36:39], v[152:155]
buffer_load_dwordx4 a[20:23], v2, s[40:43], s33 offen offset:2048 sc1
v_mfma_f32_16x16x32_bf16 v[152:155], a[128:131], a[32:35], v[152:155]
ds_read_b128 a[108:111], v5 offset:9216
v_mfma_f32_16x16x32_bf16 v[132:135], a[136:139], a[32:35], v[132:135]
v_mfma_f32_16x16x32_bf16 v[132:135], a[140:143], a[36:39], v[132:135]
ds_read_b128 a[112:115], v5 offset:4096
v_mfma_f32_16x16x32_bf16 v[156:159], a[140:143], a[44:47], v[156:159]
v_mfma_f32_16x16x32_bf16 v[156:159], a[136:139], a[40:43], v[156:159]
buffer_load_dwordx4 v1, s[4:7], s44 offen offset:1024 sc1 lds
v_mfma_f32_16x16x32_bf16 v[180:183], a[136:139], a[48:51], v[180:183]
ds_read_b128 a[116:119], v5 offset:10240
v_mfma_f32_16x16x32_bf16 v[180:183], a[140:143], a[52:55], v[180:183]
ds_read_b128 a[120:123], v6 offset:2048
v_mfma_f32_16x16x32_bf16 v[204:207], a[140:143], a[60:63], v[204:207]
v_mfma_f32_16x16x32_bf16 v[204:207], a[136:139], a[56:59], v[204:207]
v_mfma_f32_16x16x32_bf16 v[208:211], a[144:147], a[56:59], v[208:211]
buffer_load_dwordx4 a[24:27], v2, s[40:43], s35 offen offset:3072 sc1
v_mfma_f32_16x16x32_bf16 v[208:211], a[148:151], a[60:63], v[208:211]
v_mfma_f32_16x16x32_bf16 v[184:187], a[148:151], a[52:55], v[184:187]
v_mfma_f32_16x16x32_bf16 v[184:187], a[144:147], a[48:51], v[184:187]
v_mfma_f32_16x16x32_bf16 v[160:163], a[144:147], a[40:43], v[160:163]
v_mfma_f32_16x16x32_bf16 v[160:163], a[148:151], a[44:47], v[160:163]
buffer_load_dwordx4 a[28:31], v2, s[40:43], s33 offen offset:3072 sc1
s_add_u32 s35, s35, 8192
v_mfma_f32_16x16x32_bf16 v[136:139], a[148:151], a[36:39], v[136:139]
s_add_u32 s33, s33, 8192
v_mfma_f32_16x16x32_bf16 v[136:139], a[144:147], a[32:35], v[136:139]
v_mfma_f32_16x16x32_bf16 a[184:187], a[152:155], a[160:163], a[184:187]
s_waitcnt vmcnt(11) lgkmcnt(0)
v_mfma_f32_16x16x32_bf16 v[140:143], a[96:99], a[64:67], v[140:143]
ds_read_b128 a[128:131], v5 offset:5120
v_mfma_f32_16x16x32_bf16 v[140:143], a[100:103], a[68:71], v[140:143]
buffer_load_dwordx4 a[32:35], v2, s[40:43], s35 offen offset:0 sc1
v_mfma_f32_16x16x32_bf16 v[164:167], a[100:103], a[76:79], v[164:167]
ds_read_b128 a[132:135], v5 offset:11264
v_mfma_f32_16x16x32_bf16 v[164:167], a[96:99], a[72:75], v[164:167]
v_mfma_f32_16x16x32_bf16 v[188:191], a[96:99], a[80:83], v[188:191]
ds_read_b128 a[136:139], v5 offset:0
v_mfma_f32_16x16x32_bf16 v[188:191], a[100:103], a[84:87], v[188:191]
buffer_load_dwordx4 v1, s[4:7], s44 offen offset:2048 sc1 lds
s_add_u32 s63, s28, 20
v_mfma_f32_16x16x32_bf16 v[212:215], a[100:103], a[92:95], v[212:215]
s_lshl_b32 s63, s63, 12
ds_read_b128 a[140:143], v5 offset:6144
v_mfma_f32_16x16x32_bf16 v[212:215], a[96:99], a[88:91], v[212:215]
v_mfma_f32_16x16x32_bf16 v[216:219], a[104:107], a[88:91], v[216:219]
v_mfma_f32_16x16x32_bf16 v[216:219], a[108:111], a[92:95], v[216:219]
buffer_load_dwordx4 a[36:39], v2, s[40:43], s33 offen offset:0 sc1
v_mfma_f32_16x16x32_bf16 v[192:195], a[108:111], a[84:87], v[192:195]
ds_read_b128 a[144:147], v5 offset:1024
v_mfma_f32_16x16x32_bf16 v[192:195], a[104:107], a[80:83], v[192:195]
ds_read_b128 a[148:151], v5 offset:7168
v_mfma_f32_16x16x32_bf16 v[168:171], a[104:107], a[72:75], v[168:171]
v_mfma_f32_16x16x32_bf16 v[168:171], a[108:111], a[76:79], v[168:171]
buffer_load_dwordx4 a[40:43], v2, s[40:43], s35 offen offset:1024 sc1
v_mfma_f32_16x16x32_bf16 v[144:147], a[108:111], a[68:71], v[144:147]
ds_read_b128 a[152:155], v6 offset:3072
v_mfma_f32_16x16x32_bf16 v[144:147], a[104:107], a[64:67], v[144:147]
v_mfma_f32_16x16x32_bf16 v[148:151], a[112:115], a[64:67], v[148:151]
v_mfma_f32_16x16x32_bf16 v[148:151], a[116:119], a[68:71], v[148:151]
buffer_load_dwordx4 a[168:171], v3, s[40:43], s63 offen sc1
s_add_u32 m0, s18, 0x6000
v_mfma_f32_16x16x32_bf16 v[172:175], a[116:119], a[76:79], v[172:175]
s_add_u32 s44, s50, 0xe2a000
v_mfma_f32_16x16x32_bf16 v[172:175], a[112:115], a[72:75], v[172:175]
v_mfma_f32_16x16x32_bf16 v[196:199], a[112:115], a[80:83], v[196:199]
v_mfma_f32_16x16x32_bf16 v[196:199], a[116:119], a[84:87], v[196:199]
buffer_load_dwordx4 a[44:47], v2, s[40:43], s33 offen offset:1024 sc1
v_mfma_f32_16x16x32_bf16 v[220:223], a[116:119], a[92:95], v[220:223]
v_mfma_f32_16x16x32_bf16 v[220:223], a[112:115], a[88:91], v[220:223]
v_mfma_f32_16x16x32_bf16 a[172:175], a[120:123], a[164:167], a[172:175]
s_waitcnt lgkmcnt(0)
v_mfma_f32_16x16x32_bf16 v[224:227], a[128:131], a[88:91], v[224:227]
ds_read_b128 a[96:99], v5 offset:14336
v_mfma_f32_16x16x32_bf16 v[224:227], a[132:135], a[92:95], v[224:227]
buffer_load_dwordx4 a[48:51], v2, s[40:43], s35 offen offset:2048 sc1
v_mfma_f32_16x16x32_bf16 v[200:203], a[132:135], a[84:87], v[200:203]
ds_read_b128 a[100:103], v5 offset:20480
v_mfma_f32_16x16x32_bf16 v[200:203], a[128:131], a[80:83], v[200:203]
v_mfma_f32_16x16x32_bf16 v[176:179], a[128:131], a[72:75], v[176:179]
ds_read_b128 a[104:107], v5 offset:15360
v_mfma_f32_16x16x32_bf16 v[176:179], a[132:135], a[76:79], v[176:179]
buffer_load_dwordx4 v1, s[4:7], s44 offen offset:0 sc1 lds
v_mfma_f32_16x16x32_bf16 v[152:155], a[132:135], a[68:71], v[152:155]
ds_read_b128 a[108:111], v5 offset:21504
v_mfma_f32_16x16x32_bf16 v[152:155], a[128:131], a[64:67], v[152:155]
v_mfma_f32_16x16x32_bf16 v[132:135], a[136:139], a[64:67], v[132:135]
v_mfma_f32_16x16x32_bf16 v[132:135], a[140:143], a[68:71], v[132:135]
buffer_load_dwordx4 a[52:55], v2, s[40:43], s33 offen offset:2048 sc1
v_mfma_f32_16x16x32_bf16 v[156:159], a[140:143], a[76:79], v[156:159]
ds_read_b128 a[112:115], v5 offset:16384
v_mfma_f32_16x16x32_bf16 v[156:159], a[136:139], a[72:75], v[156:159]
ds_read_b128 a[116:119], v5 offset:22528
v_mfma_f32_16x16x32_bf16 v[180:183], a[136:139], a[80:83], v[180:183]
v_mfma_f32_16x16x32_bf16 v[180:183], a[140:143], a[84:87], v[180:183]
buffer_load_dwordx4 a[56:59], v2, s[40:43], s35 offen offset:3072 sc1
v_mfma_f32_16x16x32_bf16 v[204:207], a[140:143], a[92:95], v[204:207]
ds_read_b128 a[120:123], v6 offset:4096
v_mfma_f32_16x16x32_bf16 v[204:207], a[136:139], a[88:91], v[204:207]
v_mfma_f32_16x16x32_bf16 v[208:211], a[144:147], a[88:91], v[208:211]
v_mfma_f32_16x16x32_bf16 v[208:211], a[148:151], a[92:95], v[208:211]
buffer_load_dwordx4 v1, s[4:7], s44 offen offset:1024 sc1 lds
v_mfma_f32_16x16x32_bf16 v[184:187], a[148:151], a[84:87], v[184:187]
v_mfma_f32_16x16x32_bf16 v[184:187], a[144:147], a[80:83], v[184:187]
v_mfma_f32_16x16x32_bf16 v[160:163], a[144:147], a[72:75], v[160:163]
v_mfma_f32_16x16x32_bf16 v[160:163], a[148:151], a[76:79], v[160:163]
buffer_load_dwordx4 a[60:63], v2, s[40:43], s33 offen offset:3072 sc1
s_add_u32 s35, s35, 8192
v_mfma_f32_16x16x32_bf16 v[136:139], a[148:151], a[68:71], v[136:139]
s_add_u32 s33, s33, 8192
v_mfma_f32_16x16x32_bf16 v[136:139], a[144:147], a[64:67], v[136:139]
v_mfma_f32_16x16x32_bf16 a[176:179], a[152:155], a[164:167], a[176:179]
s_waitcnt vmcnt(12) lgkmcnt(0)
v_mfma_f32_16x16x32_bf16 v[140:143], a[96:99], a[0:3], v[140:143]
ds_read_b128 a[128:131], v5 offset:17408
v_add_f32 v92, v92, v96
v_mfma_f32_16x16x32_bf16 v[140:143], a[100:103], a[4:7], v[140:143]
buffer_load_dwordx4 a[64:67], v2, s[40:43], s35 offen offset:0 sc1
v_mfma_f32_16x16x32_bf16 v[164:167], a[100:103], a[12:15], v[164:167]
ds_read_b128 a[132:135], v5 offset:23552
v_add_f32 v100, v100, v104
v_mfma_f32_16x16x32_bf16 v[164:167], a[96:99], a[8:11], v[164:167]
v_add_f32 v108, v108, v112
v_add_f32 v116, v116, v120
v_mfma_f32_16x16x32_bf16 v[188:191], a[96:99], a[16:19], v[188:191]
ds_read_b128 a[136:139], v5 offset:12288
v_add_f32 v124, v124, v128
v_mfma_f32_16x16x32_bf16 v[188:191], a[100:103], a[20:23], v[188:191]
v_add_f32 v93, v93, v97
v_add_f32 v101, v101, v105
v_mfma_f32_16x16x32_bf16 v[212:215], a[100:103], a[28:31], v[212:215]
buffer_load_dwordx4 a[68:71], v2, s[40:43], s33 offen offset:0 sc1
v_mfma_f32_16x16x32_bf16 v[212:215], a[96:99], a[24:27], v[212:215]
ds_read_b128 a[140:143], v5 offset:18432
v_add_f32 v109, v109, v113
v_mfma_f32_16x16x32_bf16 v[216:219], a[104:107], a[24:27], v[216:219]
v_add_f32 v117, v117, v121
v_add_f32 v125, v125, v129
v_mfma_f32_16x16x32_bf16 v[216:219], a[108:111], a[28:31], v[216:219]
ds_read_b128 a[144:147], v5 offset:13312
v_add_f32 v94, v94, v98
v_mfma_f32_16x16x32_bf16 v[192:195], a[108:111], a[20:23], v[192:195]
v_add_f32 v102, v102, v106
v_add_f32 v110, v110, v114
v_mfma_f32_16x16x32_bf16 v[192:195], a[104:107], a[16:19], v[192:195]
buffer_load_dwordx4 v1, s[4:7], s44 offen offset:2048 sc1 lds
s_add_u32 m0, s18, 0x9000
v_mfma_f32_16x16x32_bf16 v[168:171], a[104:107], a[8:11], v[168:171]
s_add_u32 s44, s50, 0xe2d000
ds_read_b128 a[148:151], v5 offset:19456
v_mfma_f32_16x16x32_bf16 v[168:171], a[108:111], a[12:15], v[168:171]
ds_read_b128 a[152:155], v6 offset:5120
v_add_f32 v118, v118, v122
v_mfma_f32_16x16x32_bf16 v[144:147], a[108:111], a[4:7], v[144:147]
v_add_f32 v126, v126, v130
v_add_f32 v95, v95, v99
v_mfma_f32_16x16x32_bf16 v[144:147], a[104:107], a[0:3], v[144:147]
v_add_f32 v103, v103, v107
v_add_f32 v111, v111, v115
v_mfma_f32_16x16x32_bf16 v[148:151], a[112:115], a[0:3], v[148:151]
buffer_load_dwordx4 a[72:75], v2, s[40:43], s35 offen offset:1024 sc1
v_mfma_f32_16x16x32_bf16 v[148:151], a[116:119], a[4:7], v[148:151]
v_add_f32 v119, v119, v123
v_add_f32 v127, v127, v131
v_mfma_f32_16x16x32_bf16 v[172:175], a[116:119], a[12:15], v[172:175]
v_add_f32_dpp v92, v92, v92 row_ror:8 row_mask:0xf bank_mask:0xf
v_add_f32_dpp v100, v100, v100 row_ror:8 row_mask:0xf bank_mask:0xf
v_mfma_f32_16x16x32_bf16 v[172:175], a[112:115], a[8:11], v[172:175]
v_add_f32_dpp v108, v108, v108 row_ror:8 row_mask:0xf bank_mask:0xf
v_add_f32_dpp v116, v116, v116 row_ror:8 row_mask:0xf bank_mask:0xf
v_mfma_f32_16x16x32_bf16 v[196:199], a[112:115], a[16:19], v[196:199]
v_add_f32_dpp v124, v124, v124 row_ror:8 row_mask:0xf bank_mask:0xf
v_add_f32_dpp v93, v93, v93 row_ror:8 row_mask:0xf bank_mask:0xf
v_mfma_f32_16x16x32_bf16 v[196:199], a[116:119], a[20:23], v[196:199]
buffer_load_dwordx4 a[76:79], v2, s[40:43], s33 offen offset:1024 sc1
v_mfma_f32_16x16x32_bf16 v[220:223], a[116:119], a[28:31], v[220:223]
v_add_f32_dpp v101, v101, v101 row_ror:8 row_mask:0xf bank_mask:0xf
v_add_f32_dpp v109, v109, v109 row_ror:8 row_mask:0xf bank_mask:0xf
v_mfma_f32_16x16x32_bf16 v[220:223], a[112:115], a[24:27], v[220:223]
v_add_f32_dpp v117, v117, v117 row_ror:8 row_mask:0xf bank_mask:0xf
v_add_f32_dpp v125, v125, v125 row_ror:8 row_mask:0xf bank_mask:0xf
v_mfma_f32_16x16x32_bf16 a[180:183], a[120:123], a[164:167], a[180:183]
v_add_f32_dpp v92, v94, v94 row_ror:8 row_mask:0xf bank_mask:0xc
s_waitcnt lgkmcnt(0)
v_mfma_f32_16x16x32_bf16 v[224:227], a[128:131], a[24:27], v[224:227]
ds_read_b128 a[96:99], v5 offset:26624
v_add_f32_dpp v100, v102, v102 row_ror:8 row_mask:0xf bank_mask:0xc
v_mfma_f32_16x16x32_bf16 v[224:227], a[132:135], a[28:31], v[224:227]
buffer_load_dwordx4 a[80:83], v2, s[40:43], s35 offen offset:2048 sc1
v_mfma_f32_16x16x32_bf16 v[200:203], a[132:135], a[20:23], v[200:203]
ds_read_b128 a[100:103], v5 offset:32768
v_add_f32_dpp v108, v110, v110 row_ror:8 row_mask:0xf bank_mask:0xc
v_mfma_f32_16x16x32_bf16 v[200:203], a[128:131], a[16:19], v[200:203]
v_add_f32_dpp v116, v118, v118 row_ror:8 row_mask:0xf bank_mask:0xc
v_add_f32_dpp v124, v126, v126 row_ror:8 row_mask:0xf bank_mask:0xc
v_mfma_f32_16x16x32_bf16 v[176:179], a[128:131], a[8:11], v[176:179]
ds_read_b128 a[104:107], v5 offset:27648
v_add_f32_dpp v93, v95, v95 row_ror:8 row_mask:0xf bank_mask:0xc
v_mfma_f32_16x16x32_bf16 v[176:179], a[132:135], a[12:15], v[176:179]
buffer_load_dwordx4 v1, s[4:7], s44 offen offset:0 sc1 lds
v_mfma_f32_16x16x32_bf16 v[152:155], a[132:135], a[4:7], v[152:155]
ds_read_b128 a[108:111], v5 offset:33792
v_add_f32_dpp v101, v103, v103 row_ror:8 row_mask:0xf bank_mask:0xc
v_mfma_f32_16x16x32_bf16 v[152:155], a[128:131], a[0:3], v[152:155]
v_add_f32_dpp v109, v111, v111 row_ror:8 row_mask:0xf bank_mask:0xc
v_add_f32_dpp v117, v119, v119 row_ror:8 row_mask:0xf bank_mask:0xc
v_mfma_f32_16x16x32_bf16 v[132:135], a[136:139], a[0:3], v[132:135]
v_add_f32_dpp v125, v127, v127 row_ror:8 row_mask:0xf bank_mask:0xc
v_mfma_f32_16x16x32_bf16 v[132:135], a[140:143], a[4:7], v[132:135]
buffer_load_dwordx4 a[84:87], v2, s[40:43], s33 offen offset:2048 sc1
v_mfma_f32_16x16x32_bf16 v[156:159], a[140:143], a[12:15], v[156:159]
ds_read_b128 a[112:115], v5 offset:28672
v_mfma_f32_16x16x32_bf16 v[156:159], a[136:139], a[8:11], v[156:159]
ds_read_b128 a[116:119], v5 offset:34816
v_mfma_f32_16x16x32_bf16 v[180:183], a[136:139], a[16:19], v[180:183]
v_permlane32_swap_b32 v92, v93
v_mfma_f32_16x16x32_bf16 v[180:183], a[140:143], a[20:23], v[180:183]
buffer_load_dwordx4 a[88:91], v2, s[40:43], s35 offen offset:3072 sc1
v_mfma_f32_16x16x32_bf16 v[204:207], a[140:143], a[28:31], v[204:207]
ds_read_b128 a[120:123], v6 offset:26624
v_mfma_f32_16x16x32_bf16 v[204:207], a[136:139], a[24:27], v[204:207]
v_permlane32_swap_b32 v100, v101
v_mfma_f32_16x16x32_bf16 v[208:211], a[144:147], a[24:27], v[208:211]
v_permlane32_swap_b32 v108, v109
v_mfma_f32_16x16x32_bf16 v[208:211], a[148:151], a[28:31], v[208:211]
buffer_load_dwordx4 v1, s[4:7], s44 offen offset:1024 sc1 lds
s_add_u32 s63, s28, 24
v_mfma_f32_16x16x32_bf16 v[184:187], a[148:151], a[20:23], v[184:187]
s_lshl_b32 s63, s63, 12
v_mfma_f32_16x16x32_bf16 v[184:187], a[144:147], a[16:19], v[184:187]
v_permlane32_swap_b32 v116, v117
v_mfma_f32_16x16x32_bf16 v[160:163], a[144:147], a[8:11], v[160:163]
v_permlane32_swap_b32 v124, v125
v_mfma_f32_16x16x32_bf16 v[160:163], a[148:151], a[12:15], v[160:163]
buffer_load_dwordx4 a[92:95], v2, s[40:43], s33 offen offset:3072 sc1
s_add_u32 s35, s35, 8192
v_mfma_f32_16x16x32_bf16 v[136:139], a[148:151], a[4:7], v[136:139]
s_add_u32 s33, s33, 8192
v_add_f32 v92, v92, v93
v_mfma_f32_16x16x32_bf16 v[136:139], a[144:147], a[0:3], v[136:139]
v_add_f32 v100, v100, v101
v_add_f32 v108, v108, v109
v_mfma_f32_16x16x32_bf16 a[184:187], a[152:155], a[164:167], a[184:187]
v_add_f32 v116, v116, v117
s_waitcnt vmcnt(11) lgkmcnt(0)
v_mfma_f32_16x16x32_bf16 v[140:143], a[96:99], a[32:35], v[140:143]
ds_read_b128 a[128:131], v5 offset:29696
v_add_f32 v124, v124, v125
v_mfma_f32_16x16x32_bf16 v[140:143], a[100:103], a[36:39], v[140:143]
buffer_load_dwordx4 a[0:3], v2, s[40:43], s35 offen offset:0 sc1
v_mfma_f32_16x16x32_bf16 v[164:167], a[100:103], a[44:47], v[164:167]
ds_read_b128 a[132:135], v5 offset:35840
v_mov_b32 v94, v92
v_mfma_f32_16x16x32_bf16 v[164:167], a[96:99], a[40:43], v[164:167]
v_mov_b32 v102, v100
v_mov_b32 v110, v108
v_mfma_f32_16x16x32_bf16 v[188:191], a[96:99], a[48:51], v[188:191]
ds_read_b128 a[136:139], v5 offset:24576
v_mov_b32 v118, v116
v_mfma_f32_16x16x32_bf16 v[188:191], a[100:103], a[52:55], v[188:191]
v_mov_b32 v126, v124
v_mfma_f32_16x16x32_bf16 v[212:215], a[100:103], a[60:63], v[212:215]
buffer_load_dwordx4 a[4:7], v2, s[40:43], s33 offen offset:0 sc1
v_mfma_f32_16x16x32_bf16 v[212:215], a[96:99], a[56:59], v[212:215]
ds_read_b128 a[140:143], v5 offset:30720
v_mfma_f32_16x16x32_bf16 v[216:219], a[104:107], a[56:59], v[216:219]
v_permlane16_swap_b32 v92, v94
v_mfma_f32_16x16x32_bf16 v[216:219], a[108:111], a[60:63], v[216:219]
ds_read_b128 a[144:147], v5 offset:25600
v_mfma_f32_16x16x32_bf16 v[192:195], a[108:111], a[52:55], v[192:195]
v_permlane16_swap_b32 v100, v102
v_mfma_f32_16x16x32_bf16 v[192:195], a[104:107], a[48:51], v[192:195]
buffer_load_dwordx4 a[160:163], v3, s[40:43], s63 offen sc1
v_mfma_f32_16x16x32_bf16 v[168:171], a[104:107], a[40:43], v[168:171]
ds_read_b128 a[148:151], v5 offset:31744
v_mfma_f32_16x16x32_bf16 v[168:171], a[108:111], a[44:47], v[168:171]
ds_read_b128 a[152:155], v6 offset:27648
v_mfma_f32_16x16x32_bf16 v[144:147], a[108:111], a[36:39], v[144:147]
v_permlane16_swap_b32 v108, v110
v_mfma_f32_16x16x32_bf16 v[144:147], a[104:107], a[32:35], v[144:147]
v_permlane16_swap_b32 v116, v118
v_mfma_f32_16x16x32_bf16 v[148:151], a[112:115], a[32:35], v[148:151]
buffer_load_dwordx4 a[8:11], v2, s[40:43], s35 offen offset:1024 sc1
v_mfma_f32_16x16x32_bf16 v[148:151], a[116:119], a[36:39], v[148:151]
v_permlane16_swap_b32 v124, v126
v_mfma_f32_16x16x32_bf16 v[172:175], a[116:119], a[44:47], v[172:175]
v_add_f32 v92, v92, v94
v_add_f32 v100, v100, v102
v_mfma_f32_16x16x32_bf16 v[172:175], a[112:115], a[40:43], v[172:175]
v_add_f32 v108, v108, v110
v_add_f32 v116, v116, v118
v_mfma_f32_16x16x32_bf16 v[196:199], a[112:115], a[48:51], v[196:199]
v_add_f32 v124, v124, v126
v_mov_b32 v94, v92
v_mfma_f32_16x16x32_bf16 v[196:199], a[116:119], a[52:55], v[196:199]
buffer_load_dwordx4 a[12:15], v2, s[40:43], s33 offen offset:1024 sc1
v_mfma_f32_16x16x32_bf16 v[220:223], a[116:119], a[60:63], v[220:223]
v_mov_b32 v102, v100
v_mov_b32 v110, v108
v_mfma_f32_16x16x32_bf16 v[220:223], a[112:115], a[56:59], v[220:223]
v_mov_b32 v118, v116
v_mov_b32 v126, v124
v_mfma_f32_16x16x32_bf16 a[172:175], a[120:123], a[168:171], a[172:175]
s_waitcnt lgkmcnt(0)
v_mfma_f32_16x16x32_bf16 v[224:227], a[128:131], a[56:59], v[224:227]
ds_read_b128 a[96:99], v5 offset:38912
v_mfma_f32_16x16x32_bf16 v[224:227], a[132:135], a[60:63], v[224:227]
buffer_load_dwordx4 a[16:19], v2, s[40:43], s35 offen offset:2048 sc1
v_mfma_f32_16x16x32_bf16 v[200:203], a[132:135], a[52:55], v[200:203]
ds_read_b128 a[100:103], v5 offset:45056
v_mfma_f32_16x16x32_bf16 v[200:203], a[128:131], a[48:51], v[200:203]
v_permlane32_swap_b32 v92, v94
v_mfma_f32_16x16x32_bf16 v[176:179], a[128:131], a[40:43], v[176:179]
ds_read_b128 a[104:107], v5 offset:39936
v_mfma_f32_16x16x32_bf16 v[176:179], a[132:135], a[44:47], v[176:179]
buffer_load_dwordx4 v1, s[4:7], s44 offen offset:2048 sc1 lds
s_add_u32 s63, s28, 28
v_mfma_f32_16x16x32_bf16 v[152:155], a[132:135], a[36:39], v[152:155]
s_lshl_b32 s63, s63, 12
ds_read_b128 a[108:111], v5 offset:46080
v_mfma_f32_16x16x32_bf16 v[152:155], a[128:131], a[32:35], v[152:155]
v_permlane32_swap_b32 v100, v102
v_mfma_f32_16x16x32_bf16 v[132:135], a[136:139], a[32:35], v[132:135]
v_permlane32_swap_b32 v108, v110
v_mfma_f32_16x16x32_bf16 v[132:135], a[140:143], a[36:39], v[132:135]
buffer_load_dwordx4 a[20:23], v2, s[40:43], s33 offen offset:2048 sc1
v_mfma_f32_16x16x32_bf16 v[156:159], a[140:143], a[44:47], v[156:159]
ds_read_b128 a[112:115], v5 offset:40960
v_mfma_f32_16x16x32_bf16 v[156:159], a[136:139], a[40:43], v[156:159]
ds_read_b128 a[116:119], v5 offset:47104
v_mfma_f32_16x16x32_bf16 v[180:183], a[136:139], a[48:51], v[180:183]
v_permlane32_swap_b32 v116, v118
v_mfma_f32_16x16x32_bf16 v[180:183], a[140:143], a[52:55], v[180:183]
buffer_load_dwordx4 a[24:27], v2, s[40:43], s35 offen offset:3072 sc1
v_mfma_f32_16x16x32_bf16 v[204:207], a[140:143], a[60:63], v[204:207]
ds_read_b128 a[120:123], v6 offset:28672
v_mfma_f32_16x16x32_bf16 v[204:207], a[136:139], a[56:59], v[204:207]
v_permlane32_swap_b32 v124, v126
v_mfma_f32_16x16x32_bf16 v[208:211], a[144:147], a[56:59], v[208:211]
v_mul_f32 v82, 0xba800000, v92
v_mul_f32 v84, 0xba800000, v100
v_mfma_f32_16x16x32_bf16 v[208:211], a[148:151], a[60:63], v[208:211]
buffer_load_dwordx4 a[164:167], v3, s[40:43], s63 offen sc1
s_add_u32 m0, s19, 49152
v_mfma_f32_16x16x32_bf16 v[184:187], a[148:151], a[52:55], v[184:187]
s_add_u32 s44, s85, 0xa04000
v_mul_f32 v86, 0xba800000, v108
v_mfma_f32_16x16x32_bf16 v[184:187], a[144:147], a[48:51], v[184:187]
v_mul_f32 v88, 0xba800000, v116
v_mul_f32 v90, 0xba800000, v124
v_mfma_f32_16x16x32_bf16 v[160:163], a[144:147], a[40:43], v[160:163]
v_mul_f32 v94, 0x3a800000, v94
v_mul_f32 v102, 0x3a800000, v102
v_mfma_f32_16x16x32_bf16 v[160:163], a[148:151], a[44:47], v[160:163]
buffer_load_dwordx4 a[28:31], v2, s[40:43], s33 offen offset:3072 sc1
s_add_u32 s35, s35, 8192
v_mfma_f32_16x16x32_bf16 v[136:139], a[148:151], a[36:39], v[136:139]
s_add_u32 s33, s33, 8192
v_mul_f32 v110, 0x3a800000, v110
v_mfma_f32_16x16x32_bf16 v[136:139], a[144:147], a[32:35], v[136:139]
v_mul_f32 v118, 0x3a800000, v118
v_mul_f32 v126, 0x3a800000, v126
v_mfma_f32_16x16x32_bf16 a[176:179], a[152:155], a[168:171], a[176:179]
v_fma_f32 v94, -v82, v82, v94
s_waitcnt vmcnt(11) lgkmcnt(0)
v_mfma_f32_16x16x32_bf16 v[140:143], a[96:99], a[64:67], v[140:143]
ds_read_b128 a[128:131], v5 offset:41984
v_fma_f32 v102, -v84, v84, v102
v_mfma_f32_16x16x32_bf16 v[140:143], a[100:103], a[68:71], v[140:143]
buffer_load_dwordx4 a[32:35], v2, s[40:43], s35 offen offset:0 sc1
v_mfma_f32_16x16x32_bf16 v[164:167], a[100:103], a[76:79], v[164:167]
ds_read_b128 a[132:135], v5 offset:48128
v_fma_f32 v110, -v86, v86, v110
v_mfma_f32_16x16x32_bf16 v[164:167], a[96:99], a[72:75], v[164:167]
v_fma_f32 v118, -v88, v88, v118
v_fma_f32 v126, -v90, v90, v126
v_mfma_f32_16x16x32_bf16 v[188:191], a[96:99], a[80:83], v[188:191]
ds_read_b128 a[136:139], v5 offset:36864
v_max_f32 v94, 0, v94
v_mfma_f32_16x16x32_bf16 v[188:191], a[100:103], a[84:87], v[188:191]
v_max_f32 v102, 0, v102
v_max_f32 v110, 0, v110
v_mfma_f32_16x16x32_bf16 v[212:215], a[100:103], a[92:95], v[212:215]
buffer_load_dwordx4 a[36:39], v2, s[40:43], s33 offen offset:0 sc1
v_mfma_f32_16x16x32_bf16 v[212:215], a[96:99], a[88:91], v[212:215]
ds_read_b128 a[140:143], v5 offset:43008
v_max_f32 v118, 0, v118
v_max_f32 v126, 0, v126
v_add_f32 v94, 0x3727c5ac, v94
v_add_f32 v102, 0x3727c5ac, v102
v_add_f32 v110, 0x3727c5ac, v110
v_add_f32 v118, 0x3727c5ac, v118
v_add_f32 v126, 0x3727c5ac, v126
v_rsq_f32 v83, v94
v_rsq_f32 v85, v102
v_rsq_f32 v87, v110
v_rsq_f32 v89, v118
v_rsq_f32 v91, v126
v_mfma_f32_16x16x32_bf16 v[216:219], a[104:107], a[88:91], v[216:219]
v_mfma_f32_16x16x32_bf16 v[216:219], a[108:111], a[92:95], v[216:219]
ds_read_b128 a[144:147], v5 offset:37888
v_mfma_f32_16x16x32_bf16 v[192:195], a[108:111], a[84:87], v[192:195]
L_stub12:
s_cbranch_execz L_stub13
v_fmac_f32 v140, v56, v82
v_mfma_f32_16x16x32_bf16 v[192:195], a[104:107], a[80:83], v[192:195]
buffer_load_dwordx4 v1, s[4:7], s44 offen offset:0 sc1 lds
v_mfma_f32_16x16x32_bf16 v[168:171], a[104:107], a[72:75], v[168:171]
ds_read_b128 a[148:151], v5 offset:44032
v_fmac_f32 v164, v56, v84
v_mfma_f32_16x16x32_bf16 v[168:171], a[108:111], a[76:79], v[168:171]
ds_read_b128 a[152:155], v6 offset:29696
v_mfma_f32_16x16x32_bf16 v[144:147], a[108:111], a[68:71], v[144:147]
v_fmac_f32 v188, v56, v86
v_mfma_f32_16x16x32_bf16 v[144:147], a[104:107], a[64:67], v[144:147]
v_mfma_f32_16x16x32_bf16 v[148:151], a[112:115], a[64:67], v[148:151]
buffer_load_dwordx4 a[40:43], v2, s[40:43], s35 offen offset:1024 sc1
v_mfma_f32_16x16x32_bf16 v[148:151], a[116:119], a[68:71], v[148:151]
v_fmac_f32 v212, v56, v88
v_mfma_f32_16x16x32_bf16 v[172:175], a[116:119], a[76:79], v[172:175]
v_fmac_f32 v216, v60, v88
v_mfma_f32_16x16x32_bf16 v[172:175], a[112:115], a[72:75], v[172:175]
v_mfma_f32_16x16x32_bf16 v[196:199], a[112:115], a[80:83], v[196:199]
v_fmac_f32 v192, v60, v86
v_mfma_f32_16x16x32_bf16 v[196:199], a[116:119], a[84:87], v[196:199]
buffer_load_dwordx4 a[44:47], v2, s[40:43], s33 offen offset:1024 sc1
v_mfma_f32_16x16x32_bf16 v[220:223], a[116:119], a[92:95], v[220:223]
v_fmac_f32 v168, v60, v84
v_fmac_f32 v141, v57, v82
v_mfma_f32_16x16x32_bf16 v[220:223], a[112:115], a[88:91], v[220:223]
v_mfma_f32_16x16x32_bf16 a[180:183], a[120:123], a[168:171], a[180:183]
s_waitcnt vmcnt(9) lgkmcnt(0)
s_barrier
v_mfma_f32_16x16x32_bf16 v[224:227], a[128:131], a[88:91], v[224:227]
v_add_u32 v5, 0, v1
v_add_u32 v6, s55, v5
v_mfma_f32_16x16x32_bf16 v[224:227], a[132:135], a[92:95], v[224:227]
buffer_load_dwordx4 a[48:51], v2, s[40:43], s35 offen offset:2048 sc1
v_mfma_f32_16x16x32_bf16 v[200:203], a[132:135], a[84:87], v[200:203]
ds_read_b128 a[96:99], v5 offset:2048
v_fmac_f32 v144, v60, v82
v_mfma_f32_16x16x32_bf16 v[200:203], a[128:131], a[80:83], v[200:203]
ds_read_b128 a[100:103], v5 offset:8192
v_fmac_f32 v148, v64, v82
v_mfma_f32_16x16x32_bf16 v[176:179], a[128:131], a[72:75], v[176:179]
ds_read_b128 a[104:107], v5 offset:3072
v_fmac_f32 v172, v64, v84
v_mfma_f32_16x16x32_bf16 v[176:179], a[132:135], a[76:79], v[176:179]
v_fmac_f32 v196, v64, v86
v_fmac_f32 v165, v57, v84
v_mfma_f32_16x16x32_bf16 v[152:155], a[132:135], a[68:71], v[152:155]
buffer_load_dwordx4 a[52:55], v2, s[40:43], s33 offen offset:2048 sc1
v_mfma_f32_16x16x32_bf16 v[152:155], a[128:131], a[64:67], v[152:155]
ds_read_b128 a[108:111], v5 offset:9216
v_fmac_f32 v220, v64, v88
v_mfma_f32_16x16x32_bf16 v[132:135], a[136:139], a[64:67], v[132:135]
ds_read_b128 a[112:115], v5 offset:4096
v_fmac_f32 v189, v57, v86
v_mfma_f32_16x16x32_bf16 v[132:135], a[140:143], a[68:71], v[132:135]
v_fmac_f32 v213, v57, v88
v_fmac_f32 v217, v61, v88
v_mfma_f32_16x16x32_bf16 v[156:159], a[140:143], a[76:79], v[156:159]
ds_read_b128 a[116:119], v5 offset:10240
v_fmac_f32 v224, v68, v88
v_mfma_f32_16x16x32_bf16 v[156:159], a[136:139], a[72:75], v[156:159]
buffer_load_dwordx4 v1, s[4:7], s44 offen offset:1024 sc1 lds
v_mfma_f32_16x16x32_bf16 v[180:183], a[136:139], a[80:83], v[180:183]
ds_read_b128 a[120:123], v6 offset:2048
v_fmac_f32 v200, v68, v86
v_mfma_f32_16x16x32_bf16 v[180:183], a[140:143], a[84:87], v[180:183]
v_fmac_f32 v193, v61, v86
v_fmac_f32 v169, v61, v84
v_mfma_f32_16x16x32_bf16 v[204:207], a[140:143], a[92:95], v[204:207]
ds_read_b128 a[124:127], v6 offset:26624
v_fmac_f32 v176, v68, v84
v_mfma_f32_16x16x32_bf16 v[204:207], a[136:139], a[88:91], v[204:207]
v_fmac_f32 v145, v61, v82
v_fmac_f32 v149, v65, v82
v_mfma_f32_16x16x32_bf16 v[208:211], a[144:147], a[88:91], v[208:211]
buffer_load_dwordx4 a[56:59], v2, s[40:43], s35 offen offset:3072 sc1
v_mfma_f32_16x16x32_bf16 v[208:211], a[148:151], a[92:95], v[208:211]
v_fmac_f32 v152, v68, v82
v_fmac_f32 v173, v65, v84
v_mfma_f32_16x16x32_bf16 v[184:187], a[148:151], a[84:87], v[184:187]
v_fmac_f32 v132, v48, v82
v_fmac_f32 v197, v65, v86
v_mfma_f32_16x16x32_bf16 v[184:187], a[144:147], a[80:83], v[184:187]
v_fmac_f32 v221, v65, v88
v_mfma_f32_16x16x32_bf16 v[160:163], a[144:147], a[72:75], v[160:163]
v_fmac_f32 v156, v48, v84
v_mfma_f32_16x16x32_bf16 v[160:163], a[148:151], a[76:79], v[160:163]
buffer_load_dwordx4 a[60:63], v2, s[40:43], s33 offen offset:3072 sc1
s_add_u32 s35, s35, 8192
v_mfma_f32_16x16x32_bf16 v[136:139], a[148:151], a[68:71], v[136:139]
s_add_u32 s33, s33, 8192
v_fmac_f32 v180, v48, v86
v_mfma_f32_16x16x32_bf16 v[136:139], a[144:147], a[64:67], v[136:139]
v_fmac_f32 v225, v69, v88
v_mfma_f32_16x16x32_bf16 a[184:187], a[152:155], a[168:171], a[184:187]
v_fmac_f32 v204, v48, v88
s_waitcnt vmcnt(10) lgkmcnt(0)
v_mfma_f32_16x16x32_bf16 v[140:143], a[96:99], a[0:3], v[140:143]
ds_read_b128 a[128:131], v5 offset:5120
v_fmac_f32 v201, v69, v86
v_mfma_f32_16x16x32_bf16 v[140:143], a[100:103], a[4:7], v[140:143]
buffer_load_dwordx4 a[64:67], v2, s[40:43], s35 offen offset:0 sc1
s_lshl_b32 s37, s28, 10
v_mfma_f32_16x16x32_bf16 v[164:167], a[100:103], a[12:15], v[164:167]
ds_read_b128 a[132:135], v5 offset:11264
v_fmac_f32 v208, v52, v88
v_mfma_f32_16x16x32_bf16 v[164:167], a[96:99], a[8:11], v[164:167]
v_fmac_f32 v184, v52, v86
v_fmac_f32 v177, v69, v84
v_mfma_f32_16x16x32_bf16 v[188:191], a[96:99], a[16:19], v[188:191]
ds_read_b128 a[136:139], v5 offset:0
v_fmac_f32 v153, v69, v82
v_mfma_f32_16x16x32_bf16 v[188:191], a[100:103], a[20:23], v[188:191]
buffer_load_dwordx4 a[68:71], v2, s[40:43], s33 offen offset:0 sc1
s_lshl_b32 s72, s30, 12
v_mfma_f32_16x16x32_bf16 v[212:215], a[100:103], a[28:31], v[212:215]
ds_read_b128 a[140:143], v5 offset:6144
v_fmac_f32 v160, v52, v84
v_mfma_f32_16x16x32_bf16 v[212:215], a[96:99], a[24:27], v[212:215]
v_fmac_f32 v136, v52, v82
v_fmac_f32 v133, v49, v82
v_mfma_f32_16x16x32_bf16 v[216:219], a[104:107], a[24:27], v[216:219]
ds_read_b128 a[144:147], v5 offset:1024
v_fmac_f32 v157, v49, v84
v_mfma_f32_16x16x32_bf16 v[216:219], a[108:111], a[28:31], v[216:219]
buffer_load_dwordx4 a[72:75], v2, s[40:43], s35 offen offset:1024 sc1
s_add_u32 s72, s72, 0x1e00000
v_mfma_f32_16x16x32_bf16 v[192:195], a[108:111], a[20:23], v[192:195]
ds_read_b128 a[148:151], v5 offset:7168
v_fmac_f32 v181, v49, v86
v_mfma_f32_16x16x32_bf16 v[192:195], a[104:107], a[16:19], v[192:195]
v_fmac_f32 v205, v49, v88
v_fmac_f32 v142, v58, v82
v_mfma_f32_16x16x32_bf16 v[168:171], a[104:107], a[8:11], v[168:171]
ds_read_b128 a[152:155], v6 offset:3072
v_fmac_f32 v166, v58, v84
v_mfma_f32_16x16x32_bf16 v[168:171], a[108:111], a[12:15], v[168:171]
v_fmac_f32 v209, v53, v88
v_add_u32 v233, s37, v1
v_mfma_f32_16x16x32_bf16 v[144:147], a[108:111], a[4:7], v[144:147]
buffer_load_dwordx4 a[76:79], v2, s[40:43], s33 offen offset:1024 sc1
v_mfma_f32_16x16x32_bf16 v[144:147], a[104:107], a[0:3], v[144:147]
ds_read_b128 a[156:159], v6 offset:27648
v_fmac_f32 v185, v53, v86
v_mfma_f32_16x16x32_bf16 v[148:151], a[112:115], a[0:3], v[148:151]
v_fmac_f32 v190, v58, v86
v_fmac_f32 v214, v58, v88
v_mfma_f32_16x16x32_bf16 v[148:151], a[116:119], a[4:7], v[148:151]
v_fmac_f32 v161, v53, v84
v_add_u32 v232, s19, v7
v_mfma_f32_16x16x32_bf16 v[172:175], a[116:119], a[12:15], v[172:175]
buffer_load_dwordx4 a[80:83], v2, s[40:43], s35 offen offset:2048 sc1
v_mfma_f32_16x16x32_bf16 v[172:175], a[112:115], a[8:11], v[172:175]
v_fmac_f32 v137, v53, v82
v_fmac_f32 v218, v62, v88
v_mfma_f32_16x16x32_bf16 v[196:199], a[112:115], a[16:19], v[196:199]
v_fmac_f32 v194, v62, v86
v_add_u32 v248, s19, v8
v_mfma_f32_16x16x32_bf16 v[196:199], a[116:119], a[20:23], v[196:199]
v_mfma_f32_16x16x32_bf16 v[220:223], a[116:119], a[28:31], v[220:223]
buffer_load_dwordx4 a[84:87], v2, s[40:43], s33 offen offset:2048 sc1
v_mfma_f32_16x16x32_bf16 v[220:223], a[112:115], a[24:27], v[220:223]
v_fmac_f32 v170, v62, v84
v_fmac_f32 v143, v59, v82
v_mfma_f32_16x16x32_bf16 a[172:175], a[120:123], a[160:163], a[172:175]
v_fmac_f32 v146, v62, v82
v_fmac_f32 v167, v59, v84
v_mfma_f32_16x16x32_bf16 a[172:175], a[124:127], a[164:167], a[172:175]
s_waitcnt lgkmcnt(0)
v_mfma_f32_16x16x32_bf16 v[224:227], a[128:131], a[24:27], v[224:227]
ds_read_b128 a[96:99], v5 offset:14336
v_fmac_f32 v150, v66, v82
v_mfma_f32_16x16x32_bf16 v[224:227], a[132:135], a[28:31], v[224:227]
buffer_load_dwordx4 a[88:91], v2, s[40:43], s35 offen offset:3072 sc1
v_mfma_f32_16x16x32_bf16 v[200:203], a[132:135], a[20:23], v[200:203]
ds_read_b128 a[100:103], v5 offset:20480
v_fmac_f32 v174, v66, v84
v_mfma_f32_16x16x32_bf16 v[200:203], a[128:131], a[16:19], v[200:203]
v_fmac_f32 v191, v59, v86
v_fmac_f32 v215, v59, v88
v_mfma_f32_16x16x32_bf16 v[176:179], a[128:131], a[8:11], v[176:179]
ds_read_b128 a[104:107], v5 offset:15360
v_fmac_f32 v198, v66, v86
v_mfma_f32_16x16x32_bf16 v[176:179], a[132:135], a[12:15], v[176:179]
v_fmac_f32 v219, v63, v88
v_mfma_f32_16x16x32_bf16 v[152:155], a[132:135], a[4:7], v[152:155]
buffer_load_dwordx4 v1, s[4:7], s44 offen offset:2048 sc1 lds
v_mfma_f32_16x16x32_bf16 v[152:155], a[128:131], a[0:3], v[152:155]
ds_read_b128 a[108:111], v5 offset:21504
v_fmac_f32 v222, v66, v88
v_mfma_f32_16x16x32_bf16 v[132:135], a[136:139], a[0:3], v[132:135]
ds_read_b128 a[112:115], v5 offset:16384
v_fmac_f32 v195, v63, v86
v_mfma_f32_16x16x32_bf16 v[132:135], a[140:143], a[4:7], v[132:135]
v_fmac_f32 v171, v63, v84
v_mfma_f32_16x16x32_bf16 v[156:159], a[140:143], a[12:15], v[156:159]
ds_read_b128 a[116:119], v5 offset:22528
v_fmac_f32 v226, v70, v88
v_mfma_f32_16x16x32_bf16 v[156:159], a[136:139], a[8:11], v[156:159]
buffer_load_dwordx4 v1, s[4:7], s44 offen offset:3072 sc1 lds
s_add_u32 m0, s19, 65536
v_mfma_f32_16x16x32_bf16 v[180:183], a[136:139], a[16:19], v[180:183]
s_add_u32 s44, s84, 0xa08000
ds_read_b128 a[120:123], v6 offset:4096
v_mfma_f32_16x16x32_bf16 v[180:183], a[140:143], a[20:23], v[180:183]
v_fmac_f32 v202, v70, v86
v_fmac_f32 v147, v63, v82
v_mfma_f32_16x16x32_bf16 v[204:207], a[140:143], a[28:31], v[204:207]
ds_read_b128 a[124:127], v6 offset:28672
v_fmac_f32 v178, v70, v84
v_mfma_f32_16x16x32_bf16 v[204:207], a[136:139], a[24:27], v[204:207]
v_fmac_f32 v151, v67, v82
v_fmac_f32 v175, v67, v84
v_mfma_f32_16x16x32_bf16 v[208:211], a[144:147], a[24:27], v[208:211]
buffer_load_dwordx4 a[92:95], v2, s[40:43], s33 offen offset:3072 sc1
s_add_u32 s35, s35, 8192
v_mfma_f32_16x16x32_bf16 v[208:211], a[148:151], a[28:31], v[208:211]
s_add_u32 s33, s33, 8192
v_fmac_f32 v154, v70, v82
v_mfma_f32_16x16x32_bf16 v[184:187], a[148:151], a[20:23], v[184:187]
v_fmac_f32 v134, v50, v82
v_fmac_f32 v199, v67, v86
v_mfma_f32_16x16x32_bf16 v[184:187], a[144:147], a[16:19], v[184:187]
v_fmac_f32 v223, v67, v88
v_mfma_f32_16x16x32_bf16 v[160:163], a[144:147], a[8:11], v[160:163]
v_fmac_f32 v158, v50, v84
v_mfma_f32_16x16x32_bf16 v[160:163], a[148:151], a[12:15], v[160:163]
buffer_load_dwordx4 v1, s[4:7], s44 offen offset:0 sc1 lds
v_mfma_f32_16x16x32_bf16 v[136:139], a[148:151], a[4:7], v[136:139]
v_fmac_f32 v182, v50, v86
v_fmac_f32 v227, v71, v88
v_mfma_f32_16x16x32_bf16 v[136:139], a[144:147], a[0:3], v[136:139]
v_mfma_f32_16x16x32_bf16 a[176:179], a[152:155], a[160:163], a[176:179]
v_fmac_f32 v206, v50, v88
v_fmac_f32 v203, v71, v86
v_mfma_f32_16x16x32_bf16 a[176:179], a[156:159], a[164:167], a[176:179]
s_waitcnt vmcnt(11) lgkmcnt(0)
v_mfma_f32_16x16x32_bf16 v[140:143], a[96:99], a[32:35], v[140:143]
ds_read_b128 a[128:131], v5 offset:17408
v_fmac_f32 v210, v54, v88
v_mfma_f32_16x16x32_bf16 v[140:143], a[100:103], a[36:39], v[140:143]
buffer_load_dwordx4 a[0:3], v2, s[40:43], s35 offen offset:0 sc1
v_mfma_f32_16x16x32_bf16 v[164:167], a[100:103], a[44:47], v[164:167]
ds_read_b128 a[132:135], v5 offset:23552
v_fmac_f32 v186, v54, v86
v_mfma_f32_16x16x32_bf16 v[164:167], a[96:99], a[40:43], v[164:167]
v_fmac_f32 v179, v71, v84
v_fmac_f32 v155, v71, v82
v_mfma_f32_16x16x32_bf16 v[188:191], a[96:99], a[48:51], v[188:191]
buffer_load_dwordx4 a[4:7], v2, s[40:43], s33 offen offset:0 sc1
v_mfma_f32_16x16x32_bf16 v[188:191], a[100:103], a[52:55], v[188:191]
ds_read_b128 a[136:139], v5 offset:26624
v_fmac_f32 v162, v54, v84
v_mfma_f32_16x16x32_bf16 v[212:215], a[100:103], a[60:63], v[212:215]
ds_read_b128 a[140:143], v5 offset:32768
v_fmac_f32 v138, v54, v82
v_mfma_f32_16x16x32_bf16 v[212:215], a[96:99], a[56:59], v[212:215]
buffer_load_dwordx4 a[8:11], v2, s[40:43], s35 offen offset:1024 sc1
v_mfma_f32_16x16x32_bf16 v[216:219], a[104:107], a[56:59], v[216:219]
ds_read_b128 a[144:147], v5 offset:27648
v_fmac_f32 v135, v51, v82
v_mfma_f32_16x16x32_bf16 v[216:219], a[108:111], a[60:63], v[216:219]
v_fmac_f32 v159, v51, v84
v_fmac_f32 v183, v51, v86
v_mfma_f32_16x16x32_bf16 v[192:195], a[108:111], a[52:55], v[192:195]
buffer_load_dwordx4 a[12:15], v2, s[40:43], s33 offen offset:1024 sc1
v_mfma_f32_16x16x32_bf16 v[192:195], a[104:107], a[48:51], v[192:195]
ds_read_b128 a[148:151], v5 offset:33792
v_fmac_f32 v207, v51, v88
v_mfma_f32_16x16x32_bf16 v[168:171], a[104:107], a[40:43], v[168:171]
ds_read_b128 a[152:155], v6 offset:5120
v_fmac_f32 v211, v55, v88
v_mfma_f32_16x16x32_bf16 v[168:171], a[108:111], a[44:47], v[168:171]
v_mul_f32 v88, 0x3e8293ee, v89
v_mfma_f32_16x16x32_bf16 v[144:147], a[108:111], a[36:39], v[144:147]
buffer_load_dwordx4 a[16:19], v2, s[40:43], s35 offen offset:2048 sc1
v_mfma_f32_16x16x32_bf16 v[144:147], a[104:107], a[32:35], v[144:147]
ds_read_b128 a[156:159], v6 offset:29696
v_fmac_f32 v187, v55, v86
v_mfma_f32_16x16x32_bf16 v[148:151], a[112:115], a[32:35], v[148:151]
v_fmac_f32 v163, v55, v84
v_mul_f32 v86, 0x3e8293ee, v87
v_mfma_f32_16x16x32_bf16 v[148:151], a[116:119], a[36:39], v[148:151]
buffer_load_dwordx4 a[20:23], v2, s[40:43], s33 offen offset:2048 sc1
v_mfma_f32_16x16x32_bf16 v[172:175], a[116:119], a[44:47], v[172:175]
v_fmac_f32 v139, v55, v82
v_mul_f32 v84, 0x3e8293ee, v85
v_mfma_f32_16x16x32_bf16 v[172:175], a[112:115], a[40:43], v[172:175]
v_mul_f32 v82, 0x3e8293ee, v83
v_mfma_f32_16x16x32_bf16 v[196:199], a[112:115], a[48:51], v[196:199]
buffer_load_dwordx4 a[24:27], v2, s[40:43], s35 offen offset:3072 sc1
v_mfma_f32_16x16x32_bf16 v[196:199], a[116:119], a[52:55], v[196:199]
v_mfma_f32_16x16x32_bf16 v[220:223], a[116:119], a[60:63], v[220:223]
v_mfma_f32_16x16x32_bf16 v[220:223], a[112:115], a[56:59], v[220:223]
buffer_load_dwordx4 a[28:31], v2, s[40:43], s33 offen offset:3072 sc1
s_add_u32 s35, s35, 8192
v_mfma_f32_16x16x32_bf16 a[180:183], a[120:123], a[160:163], a[180:183]
s_add_u32 s33, s33, 8192
v_mfma_f32_16x16x32_bf16 a[180:183], a[124:127], a[164:167], a[180:183]
s_waitcnt lgkmcnt(0)
v_mfma_f32_16x16x32_bf16 v[224:227], a[128:131], a[56:59], v[224:227]
ds_read_b128 a[96:99], v5 offset:28672
s_lshl_b32 s90, s28, 12
v_mfma_f32_16x16x32_bf16 v[224:227], a[132:135], a[60:63], v[224:227]
buffer_load_dwordx4 v1, s[4:7], s44 offen offset:1024 sc1 lds
s_add_u32 s90, s90, 147456
v_mfma_f32_16x16x32_bf16 v[200:203], a[132:135], a[52:55], v[200:203]
ds_read_b128 a[100:103], v5 offset:34816
v_add_u32 v234, s90, v1
v_mfma_f32_16x16x32_bf16 v[200:203], a[128:131], a[48:51], v[200:203]
s_lshl_b32 s90, s28, 10
s_add_u32 s90, s90, 147456
v_mfma_f32_16x16x32_bf16 v[176:179], a[128:131], a[40:43], v[176:179]
v_add_u32 v235, s90, v1
v_mfma_f32_16x16x32_bf16 v[176:179], a[132:135], a[44:47], v[176:179]
ds_read_b128 a[104:107], v5 offset:29696
v_mfma_f32_16x16x32_bf16 v[152:155], a[132:135], a[36:39], v[152:155]
v_mfma_f32_16x16x32_bf16 v[152:155], a[128:131], a[32:35], v[152:155]
s_waitcnt vmcnt(19)
v_mfma_f32_16x16x32_bf16 v[140:143], a[136:139], a[64:67], v[140:143]
ds_read_b128 a[108:111], v5 offset:35840
s_waitcnt vmcnt(18)
v_mfma_f32_16x16x32_bf16 v[140:143], a[140:143], a[68:71], v[140:143]
buffer_load_dwordx4 v1, s[4:7], s44 offen offset:2048 sc1 lds
s_waitcnt vmcnt(17)
v_mfma_f32_16x16x32_bf16 v[164:167], a[140:143], a[76:79], v[164:167]
ds_read_b128 a[112:115], v5 offset:38912
v_mfma_f32_16x16x32_bf16 v[164:167], a[136:139], a[72:75], v[164:167]
s_waitcnt vmcnt(16)
v_mfma_f32_16x16x32_bf16 v[188:191], a[136:139], a[80:83], v[188:191]
s_waitcnt vmcnt(15)
v_mfma_f32_16x16x32_bf16 v[188:191], a[140:143], a[84:87], v[188:191]
ds_read_b128 a[116:119], v5 offset:45056
s_waitcnt vmcnt(11)
v_mfma_f32_16x16x32_bf16 v[212:215], a[140:143], a[92:95], v[212:215]
v_mfma_f32_16x16x32_bf16 v[212:215], a[136:139], a[88:91], v[212:215]
v_mfma_f32_16x16x32_bf16 v[216:219], a[144:147], a[88:91], v[216:219]
v_mfma_f32_16x16x32_bf16 v[216:219], a[148:151], a[92:95], v[216:219]
v_mfma_f32_16x16x32_bf16 v[192:195], a[148:151], a[84:87], v[192:195]
buffer_load_dwordx4 v1, s[4:7], s44 offen offset:3072 sc1 lds
s_add_u32 m0, s19, 81920
v_mfma_f32_16x16x32_bf16 v[192:195], a[144:147], a[80:83], v[192:195]
s_add_u32 s44, s85, 0xa0c000
v_mfma_f32_16x16x32_bf16 v[168:171], a[144:147], a[72:75], v[168:171]
v_mfma_f32_16x16x32_bf16 v[168:171], a[148:151], a[76:79], v[168:171]
v_mfma_f32_16x16x32_bf16 v[144:147], a[148:151], a[68:71], v[144:147]
v_mfma_f32_16x16x32_bf16 v[144:147], a[144:147], a[64:67], v[144:147]
v_mfma_f32_16x16x32_bf16 a[184:187], a[152:155], a[160:163], a[184:187]
v_mfma_f32_16x16x32_bf16 a[184:187], a[156:159], a[164:167], a[184:187]
s_waitcnt lgkmcnt(0)
v_mfma_f32_16x16x32_bf16 v[148:151], a[96:99], a[64:67], v[148:151]
ds_read_b128 a[128:131], v5 offset:39936
v_mfma_f32_16x16x32_bf16 v[148:151], a[100:103], a[68:71], v[148:151]
buffer_load_dwordx4 v1, s[4:7], s44 offen offset:0 sc1 lds
v_mfma_f32_16x16x32_bf16 v[172:175], a[100:103], a[76:79], v[172:175]
ds_read_b128 a[132:135], v5 offset:46080
v_mfma_f32_16x16x32_bf16 v[172:175], a[96:99], a[72:75], v[172:175]
v_mfma_f32_16x16x32_bf16 v[196:199], a[96:99], a[80:83], v[196:199]
v_mfma_f32_16x16x32_bf16 v[196:199], a[100:103], a[84:87], v[196:199]
buffer_load_dwordx4 v1, s[4:7], s44 offen offset:1024 sc1 lds
v_mfma_f32_16x16x32_bf16 v[220:223], a[100:103], a[92:95], v[220:223]
ds_read_b128 a[136:139], v5 offset:40960
v_mfma_f32_16x16x32_bf16 v[220:223], a[96:99], a[88:91], v[220:223]
v_mfma_f32_16x16x32_bf16 v[224:227], a[104:107], a[88:91], v[224:227]
ds_read_b128 a[140:143], v5 offset:47104
v_mfma_f32_16x16x32_bf16 v[224:227], a[108:111], a[92:95], v[224:227]
v_mfma_f32_16x16x32_bf16 v[200:203], a[108:111], a[84:87], v[200:203]
buffer_load_dwordx4 v1, s[4:7], s44 offen offset:2048 sc1 lds
v_mfma_f32_16x16x32_bf16 v[200:203], a[104:107], a[80:83], v[200:203]
ds_read_b128 a[144:147], v5 offset:41984
v_mfma_f32_16x16x32_bf16 v[176:179], a[104:107], a[72:75], v[176:179]
ds_write_b128 v234, a[172:175] offset:0
v_mfma_f32_16x16x32_bf16 v[176:179], a[108:111], a[76:79], v[176:179]
ds_read_b128 a[148:151], v5 offset:48128
v_mfma_f32_16x16x32_bf16 v[152:155], a[108:111], a[68:71], v[152:155]
v_mfma_f32_16x16x32_bf16 v[152:155], a[104:107], a[64:67], v[152:155]
buffer_load_dwordx4 v1, s[4:7], s44 offen offset:3072 sc1 lds
s_add_u32 m0, s19, 98304
s_waitcnt vmcnt(14)
v_mfma_f32_16x16x32_bf16 v[140:143], a[112:115], a[0:3], v[140:143]
s_add_u32 s44, s84, 0xa10000
s_waitcnt vmcnt(13)
v_mfma_f32_16x16x32_bf16 v[140:143], a[116:119], a[4:7], v[140:143]
s_waitcnt vmcnt(11)
v_mfma_f32_16x16x32_bf16 v[164:167], a[116:119], a[12:15], v[164:167]
v_mfma_f32_16x16x32_bf16 v[164:167], a[112:115], a[8:11], v[164:167]
s_waitcnt vmcnt(10)
v_mfma_f32_16x16x32_bf16 v[188:191], a[112:115], a[16:19], v[188:191]
buffer_load_dwordx4 v1, s[4:7], s44 offen offset:0 sc1 lds
s_waitcnt vmcnt(10)
v_mfma_f32_16x16x32_bf16 v[188:191], a[116:119], a[20:23], v[188:191]
s_waitcnt vmcnt(8)
v_mfma_f32_16x16x32_bf16 v[212:215], a[116:119], a[28:31], v[212:215]
ds_write_b128 v234, a[176:179] offset:1024
v_mfma_f32_16x16x32_bf16 v[212:215], a[112:115], a[24:27], v[212:215]
s_waitcnt lgkmcnt(1)
v_mfma_f32_16x16x32_bf16 v[216:219], a[128:131], a[24:27], v[216:219]
ds_read_b128 a[96:99], v5 offset:12288
v_mul_f32 v140, v140, v83
v_mfma_f32_16x16x32_bf16 v[216:219], a[132:135], a[28:31], v[216:219]
buffer_load_dwordx4 v1, s[4:7], s44 offen offset:1024 sc1 lds
v_mfma_f32_16x16x32_bf16 v[192:195], a[132:135], a[20:23], v[192:195]
ds_read_b128 a[100:103], v5 offset:18432
v_mul_f32 v141, v141, v83
v_mfma_f32_16x16x32_bf16 v[192:195], a[128:131], a[16:19], v[192:195]
v_cvt_pk_bf16_f32 v140, v140, v141
v_mul_f32 v164, v164, v85
v_mfma_f32_16x16x32_bf16 v[168:171], a[128:131], a[8:11], v[168:171]
v_mul_f32 v165, v165, v85
v_cvt_pk_bf16_f32 v164, v164, v165
v_mfma_f32_16x16x32_bf16 v[168:171], a[132:135], a[12:15], v[168:171]
buffer_load_dwordx4 v1, s[4:7], s44 offen offset:2048 sc1 lds
v_mfma_f32_16x16x32_bf16 v[144:147], a[132:135], a[4:7], v[144:147]
ds_read_b128 a[104:107], v5 offset:24576
v_mul_f32 v212, v212, v89
v_mfma_f32_16x16x32_bf16 v[144:147], a[128:131], a[0:3], v[144:147]
v_mul_f32 v213, v213, v89
v_cvt_pk_bf16_f32 v212, v212, v213
v_mfma_f32_16x16x32_bf16 v[148:151], a[136:139], a[0:3], v[148:151]
ds_read_b128 a[108:111], v5 offset:30720
v_mul_f32 v214, v214, v89
v_mfma_f32_16x16x32_bf16 v[148:151], a[140:143], a[4:7], v[148:151]
v_mul_f32 v215, v215, v89
v_cvt_pk_bf16_f32 v213, v214, v215
v_mfma_f32_16x16x32_bf16 v[172:175], a[140:143], a[12:15], v[172:175]
buffer_load_dwordx4 v1, s[4:7], s44 offen offset:3072 sc1 lds
s_add_u32 m0, s19, 114688
v_mfma_f32_16x16x32_bf16 v[172:175], a[136:139], a[8:11], v[172:175]
s_add_u32 s44, s85, 0xa14000
ds_read_b128 a[112:115], v5 offset:36864
v_mfma_f32_16x16x32_bf16 v[196:199], a[136:139], a[16:19], v[196:199]
ds_write_b128 v234, a[180:183] offset:2048
v_mul_f32 v216, v216, v89
v_mfma_f32_16x16x32_bf16 v[196:199], a[140:143], a[20:23], v[196:199]
ds_read_b128 a[116:119], v5 offset:43008
v_mul_f32 v217, v217, v89
v_mfma_f32_16x16x32_bf16 v[220:223], a[140:143], a[28:31], v[220:223]
v_cvt_pk_bf16_f32 v214, v216, v217
v_mul_f32 v218, v218, v89
v_mfma_f32_16x16x32_bf16 v[220:223], a[136:139], a[24:27], v[220:223]
buffer_load_dwordx4 v1, s[4:7], s44 offen offset:0 sc1 lds
v_mfma_f32_16x16x32_bf16 v[224:227], a[144:147], a[24:27], v[224:227]
v_mul_f32 v219, v219, v89
v_cvt_pk_bf16_f32 v215, v218, v219
v_mfma_f32_16x16x32_bf16 v[224:227], a[148:151], a[28:31], v[224:227]
v_mul_f32 v148, v148, v83
v_mul_f32 v149, v149, v83
v_mfma_f32_16x16x32_bf16 v[200:203], a[148:151], a[20:23], v[200:203]
v_cvt_pk_bf16_f32 v148, v148, v149
v_mul_f32 v172, v172, v85
v_mfma_f32_16x16x32_bf16 v[200:203], a[144:147], a[16:19], v[200:203]
v_mul_f32 v173, v173, v85
v_cvt_pk_bf16_f32 v172, v172, v173
v_mfma_f32_16x16x32_bf16 v[176:179], a[144:147], a[8:11], v[176:179]
buffer_load_dwordx4 v1, s[4:7], s44 offen offset:1024 sc1 lds
v_mfma_f32_16x16x32_bf16 v[176:179], a[148:151], a[12:15], v[176:179]
v_mul_f32 v196, v196, v87
v_mul_f32 v197, v197, v87
v_mfma_f32_16x16x32_bf16 v[152:155], a[148:151], a[4:7], v[152:155]
ds_write_b128 v234, a[184:187] offset:3072
v_cvt_pk_bf16_f32 v196, v196, v197
v_mfma_f32_16x16x32_bf16 v[152:155], a[144:147], a[0:3], v[152:155]
v_mul_f32 v220, v220, v89
s_waitcnt lgkmcnt(1)
v_mfma_f32_16x16x32_bf16 v[132:135], a[96:99], a[32:35], v[132:135]
ds_read_b128 a[128:131], v5 offset:13312
v_mul_f32 v221, v221, v89
v_mfma_f32_16x16x32_bf16 v[132:135], a[100:103], a[36:39], v[132:135]
buffer_load_dwordx4 v1, s[4:7], s44 offen offset:2048 sc1 lds
v_mfma_f32_16x16x32_bf16 v[156:159], a[100:103], a[44:47], v[156:159]
ds_read_b128 a[132:135], v5 offset:19456
v_cvt_pk_bf16_f32 v220, v220, v221
v_mfma_f32_16x16x32_bf16 v[156:159], a[96:99], a[40:43], v[156:159]
v_mul_f32 v222, v222, v89
v_mul_f32 v223, v223, v89
v_mfma_f32_16x16x32_bf16 v[180:183], a[96:99], a[48:51], v[180:183]
v_cvt_pk_bf16_f32 v221, v222, v223
v_mul_f32 v224, v224, v89
v_mfma_f32_16x16x32_bf16 v[180:183], a[100:103], a[52:55], v[180:183]
buffer_load_dwordx4 v1, s[4:7], s44 offen offset:3072 sc1 lds
s_add_u32 m0, s19, 131072
v_mfma_f32_16x16x32_bf16 v[204:207], a[100:103], a[60:63], v[204:207]
s_add_u32 s44, s86, 0xa18000
ds_read_b128 a[136:139], v5 offset:25600
v_mfma_f32_16x16x32_bf16 v[204:207], a[96:99], a[56:59], v[204:207]
v_mul_f32 v225, v225, v89
v_cvt_pk_bf16_f32 v222, v224, v225
v_mfma_f32_16x16x32_bf16 v[204:207], a[104:107], a[88:91], v[204:207]
ds_read_b128 a[140:143], v5 offset:31744
v_mul_f32 v226, v226, v89
v_mfma_f32_16x16x32_bf16 v[204:207], a[108:111], a[92:95], v[204:207]
v_mul_f32 v227, v227, v89
v_cvt_pk_bf16_f32 v223, v226, v227
v_mfma_f32_16x16x32_bf16 v[180:183], a[108:111], a[84:87], v[180:183]
buffer_load_dwordx4 v1, s[4:7], s44 offen offset:0 sc1 lds
v_mfma_f32_16x16x32_bf16 v[180:183], a[104:107], a[80:83], v[180:183]
ds_read_b128 a[144:147], v5 offset:37888
v_mul_f32 v198, v198, v87
v_mfma_f32_16x16x32_bf16 v[156:159], a[104:107], a[72:75], v[156:159]
v_mul_f32 v199, v199, v87
v_cvt_pk_bf16_f32 v197, v198, v199
v_mfma_f32_16x16x32_bf16 v[156:159], a[108:111], a[76:79], v[156:159]
ds_read_b128 a[148:151], v5 offset:44032
v_mul_f32 v200, v200, v87
v_mfma_f32_16x16x32_bf16 v[132:135], a[108:111], a[68:71], v[132:135]
v_mul_f32 v201, v201, v87
v_cvt_pk_bf16_f32 v198, v200, v201
v_mfma_f32_16x16x32_bf16 v[132:135], a[104:107], a[64:67], v[132:135]
buffer_load_dwordx4 v1, s[4:7], s44 offen offset:1024 sc1 lds
v_mfma_f32_16x16x32_bf16 v[132:135], a[112:115], a[0:3], v[132:135]
v_mul_f32 v202, v202, v87
v_mul_f32 v203, v203, v87
v_mfma_f32_16x16x32_bf16 v[132:135], a[116:119], a[4:7], v[132:135]
v_cvt_pk_bf16_f32 v199, v202, v203
v_mul_f32 v174, v174, v85
v_mfma_f32_16x16x32_bf16 v[156:159], a[116:119], a[12:15], v[156:159]
v_mul_f32 v175, v175, v85
v_cvt_pk_bf16_f32 v173, v174, v175
v_mfma_f32_16x16x32_bf16 v[156:159], a[112:115], a[8:11], v[156:159]
v_mul_f32 v176, v176, v85
v_mul_f32 v177, v177, v85
v_mfma_f32_16x16x32_bf16 v[180:183], a[112:115], a[16:19], v[180:183]
buffer_load_dwordx4 v1, s[4:7], s44 offen offset:2048 sc1 lds
v_mfma_f32_16x16x32_bf16 v[180:183], a[116:119], a[20:23], v[180:183]
v_cvt_pk_bf16_f32 v174, v176, v177
v_mul_f32 v178, v178, v85
v_mfma_f32_16x16x32_bf16 v[204:207], a[116:119], a[28:31], v[204:207]
v_mul_f32 v179, v179, v85
v_cvt_pk_bf16_f32 v175, v178, v179
v_mfma_f32_16x16x32_bf16 v[204:207], a[112:115], a[24:27], v[204:207]
s_waitcnt lgkmcnt(0)
s_barrier
v_mfma_f32_16x16x32_bf16 v[208:211], a[128:131], a[56:59], v[208:211]
ds_read_b128 v[92:95], v235 offset:0
v_cvt_pk_bf16_f32 v132, v132, v133
v_mfma_f32_16x16x32_bf16 v[208:211], a[132:135], a[60:63], v[208:211]
buffer_load_dwordx4 v1, s[4:7], s44 offen offset:3072 sc1 lds
v_mfma_f32_16x16x32_bf16 v[184:187], a[132:135], a[52:55], v[184:187]
ds_read_b128 v[96:99], v235 offset:4096
v_cvt_pk_bf16_f32 v156, v156, v157
v_mfma_f32_16x16x32_bf16 v[184:187], a[128:131], a[48:51], v[184:187]
ds_write_b128 v233, v[212:215] offset:21504
v_cvt_pk_bf16_f32 v133, v134, v135
v_mfma_f32_16x16x32_bf16 v[160:163], a[128:131], a[40:43], v[160:163]
ds_read_b128 v[100:103], v235 offset:8192
v_cvt_pk_bf16_f32 v180, v180, v181
v_mfma_f32_16x16x32_bf16 v[160:163], a[132:135], a[44:47], v[160:163]
ds_write_b64 v232, v[220:221] offset:4096
v_cvt_pk_bf16_f32 v157, v158, v159
v_mfma_f32_16x16x32_bf16 v[136:139], a[132:135], a[36:39], v[136:139]
ds_read_b128 v[104:107], v235 offset:12288
v_cvt_pk_bf16_f32 v204, v204, v205
v_mfma_f32_16x16x32_bf16 v[136:139], a[128:131], a[32:35], v[136:139]
ds_write_b64 v232, v[222:223] offset:4608
v_cvt_pk_bf16_f32 v181, v182, v183
v_mfma_f32_16x16x32_bf16 v[136:139], a[136:139], a[64:67], v[136:139]
ds_write_b64 v232, v[196:197] offset:3072
v_cvt_pk_bf16_f32 v205, v206, v207
v_mfma_f32_16x16x32_bf16 v[136:139], a[140:143], a[68:71], v[136:139]
ds_write_b64 v232, v[198:199] offset:3584
v_mul_f32 v150, v150, v83
v_mfma_f32_16x16x32_bf16 v[160:163], a[140:143], a[76:79], v[160:163]
ds_write_b64 v232, v[172:173] offset:2048
v_mul_f32 v151, v151, v83
v_mfma_f32_16x16x32_bf16 v[160:163], a[136:139], a[72:75], v[160:163]
ds_write_b64 v232, v[174:175] offset:2560
v_cvt_pk_bf16_f32 v149, v150, v151
v_mfma_f32_16x16x32_bf16 v[184:187], a[136:139], a[80:83], v[184:187]
ds_write_b64 v232, v[148:149] offset:1024
s_waitcnt lgkmcnt(10)
v_add_f32 v92, v92, v96
v_mfma_f32_16x16x32_bf16 v[184:187], a[140:143], a[84:87], v[184:187]
v_add_f32 v93, v93, v97
v_add_f32 v94, v94, v98
v_mfma_f32_16x16x32_bf16 v[208:211], a[140:143], a[92:95], v[208:211]
s_waitcnt lgkmcnt(6)
v_add_f32 v100, v100, v104
v_add_f32 v101, v101, v105
v_mfma_f32_16x16x32_bf16 v[208:211], a[136:139], a[88:91], v[208:211]
v_add_f32 v102, v102, v106
v_add_f32 v95, v95, v99
v_mfma_f32_16x16x32_bf16 v[208:211], a[144:147], a[24:27], v[208:211]
v_add_f32 v103, v103, v107
v_add_f32 v228, v92, v100
v_mfma_f32_16x16x32_bf16 v[208:211], a[148:151], a[28:31], v[208:211]
v_add_f32 v229, v93, v101
v_add_f32 v230, v94, v102
v_mfma_f32_16x16x32_bf16 v[184:187], a[148:151], a[20:23], v[184:187]
v_add_f32 v231, v95, v103
v_fmac_f32 v228, v72, v90
v_mfma_f32_16x16x32_bf16 v[184:187], a[144:147], a[16:19], v[184:187]
v_fmac_f32 v229, v73, v90
v_fmac_f32 v230, v74, v90
v_mfma_f32_16x16x32_bf16 v[160:163], a[144:147], a[8:11], v[160:163]
v_fmac_f32 v231, v75, v90
v_mul_f32 v152, v152, v83
v_mfma_f32_16x16x32_bf16 v[160:163], a[148:151], a[12:15], v[160:163]
v_mul_f32 v153, v153, v83
v_cvt_pk_bf16_f32 v150, v152, v153
v_mfma_f32_16x16x32_bf16 v[136:139], a[148:151], a[4:7], v[136:139]
v_mul_f32 v154, v154, v83
v_mul_f32 v155, v155, v83
v_mfma_f32_16x16x32_bf16 v[136:139], a[144:147], a[0:3], v[136:139]
v_cvt_pk_bf16_f32 v151, v154, v155
v_mul_f32 v228, v228, v91
s_add_u32 m0, s19, 32768
s_add_u32 s44, s84, 0xa00000
buffer_load_dwordx4 v1, s[4:7], s44 offen offset:0 sc1 lds
L_stub13:
s_cbranch_execz L_wret4
v_mul_f32 v229, v229, v91
ds_write_b64 v232, v[150:151] offset:1536
v_pk_mul_f32 v[230:231], v[230:231], v[90:91] op_sel:[0,1] op_sel_hi:[1,1]
v_cvt_pk_bf16_f32 v228, v228, v229
v_pk_mul_f32 v[188:189], v[188:189], v[86:87] op_sel:[0,1] op_sel_hi:[1,1]
v_cvt_pk_bf16_f32 v229, v230, v231
v_pk_mul_f32 v[190:191], v[190:191], v[86:87] op_sel:[0,1] op_sel_hi:[1,1]
v_pk_mul_f32 v[166:167], v[166:167], v[84:85] op_sel:[0,1] op_sel_hi:[1,1]
v_pk_mul_f32 v[142:143], v[142:143], v[82:83] op_sel:[0,1] op_sel_hi:[1,1]
v_cvt_pk_bf16_f32 v188, v188, v189
v_pk_mul_f32 v[192:193], v[192:193], v[86:87] op_sel:[0,1] op_sel_hi:[1,1]
v_pk_mul_f32 v[194:195], v[194:195], v[86:87] op_sel:[0,1] op_sel_hi:[1,1]
v_pk_mul_f32 v[168:169], v[168:169], v[84:85] op_sel:[0,1] op_sel_hi:[1,1]
v_pk_mul_f32 v[170:171], v[170:171], v[84:85] op_sel:[0,1] op_sel_hi:[1,1]
v_pk_mul_f32 v[144:145], v[144:145], v[82:83] op_sel:[0,1] op_sel_hi:[1,1]
v_pk_mul_f32 v[146:147], v[146:147], v[82:83] op_sel:[0,1] op_sel_hi:[1,1]
ds_write_b64 v9, v[228:229]
v_cvt_pk_bf16_f32 v189, v190, v191
v_cvt_pk_bf16_f32 v165, v166, v167
v_cvt_pk_bf16_f32 v141, v142, v143
v_cvt_pk_bf16_f32 v190, v192, v193
v_cvt_pk_bf16_f32 v191, v194, v195
v_cvt_pk_bf16_f32 v166, v168, v169
buffer_load_dwordx4 v1, s[4:7], s44 offen offset:1024 sc1 lds
v_cvt_pk_bf16_f32 v167, v170, v171
v_cvt_pk_bf16_f32 v142, v144, v145
v_cvt_pk_bf16_f32 v143, v146, v147
v_cvt_pk_bf16_f32 v134, v136, v137
v_cvt_pk_bf16_f32 v135, v138, v139
v_cvt_pk_bf16_f32 v158, v160, v161
v_cvt_pk_bf16_f32 v159, v162, v163
v_cvt_pk_bf16_f32 v182, v184, v185
v_cvt_pk_bf16_f32 v183, v186, v187
v_cvt_pk_bf16_f32 v206, v208, v209
v_cvt_pk_bf16_f32 v207, v210, v211
buffer_load_dwordx4 v1, s[4:7], s44 offen offset:2048 sc1 lds
buffer_load_dwordx4 v1, s[4:7], s44 offen offset:3072 sc1 lds
s_waitcnt lgkmcnt(0)
s_barrier
s_add_u32 m0, s19, 147456
s_add_u32 s44, s87, 0xa1c000
buffer_load_dwordx4 v1, s[4:7], s44 offen offset:0 sc1 lds
v_mfma_f32_16x16x32_bf16 v[160:163], v[140:143], v[156:159], v[20:23]
ds_read_b128 a[0:3], v233 offset:20480
v_mfma_f32_16x16x32_bf16 v[176:179], v[164:167], v[156:159], v[24:27]
ds_read_b64_tr_b16 a[10:11], v248 offset:3072
v_mfma_f32_16x16x32_bf16 v[208:211], v[188:191], v[204:207], v[20:23]
ds_read_b64_tr_b16 a[12:13], v248 offset:4096
v_mfma_f32_16x16x32_bf16 v[224:227], v[212:215], v[204:207], v[24:27]
s_nop 3
v_max_f32 v176, v176, v160
v_max_f32 v177, v177, v161
v_max_f32 v178, v178, v162
v_max_f32 v179, v179, v163
v_max3_f32 v237, v176, v177, v178
v_max_f32 v237, v237, v179
ds_read_b64_tr_b16 a[22:23], v248 offset:3584
v_max_f32 v224, v224, v208
v_max_f32 v225, v225, v209
v_max_f32 v226, v226, v210
v_max_f32 v227, v227, v211
v_max3_f32 v239, v224, v225, v226
buffer_load_dwordx4 v1, s[4:7], s44 offen offset:1024 sc1 lds
v_max_f32 v239, v239, v227
ds_read_b64_tr_b16 a[24:25], v248 offset:4608
s_nop 0
v_permlane32_swap_b32 v239, v237
v_max_f32 v239, v239, v237
v_mov_b32 v242, v239
s_waitcnt lgkmcnt(4)
v_mfma_f32_16x16x32_bf16 v[136:139], a[0:3], v[132:135], v[76:79]
v_permlane16_swap_b32 v239, v242
v_max_f32 v239, v239, v242
v_mov_b32 v242, v239
v_mfma_f32_16x16x32_bf16 v[152:155], v[140:143], v[132:135], v[24:27]
s_nop 0
v_permlane32_swap_b32 v239, v242
v_mfma_f32_16x16x32_bf16 v[184:187], v[164:167], v[180:183], v[20:23]
v_mul_f32_e64 v89, -v239, v88
v_fma_f32 v224, v224, v88, v89
v_mfma_f32_16x16x32_bf16 v[200:203], v[188:191], v[180:183], v[24:27]
v_fma_f32 v225, v225, v88, v89
v_fma_f32 v226, v226, v88, v89
v_fma_f32 v227, v227, v88, v89
v_exp_f32 v224, v224
buffer_load_dwordx4 v1, s[4:7], s44 offen offset:2048 sc1 lds
v_exp_f32 v225, v225
v_exp_f32 v226, v226
v_exp_f32 v227, v227
v_max_f32 v152, v152, v136
v_max_f32 v153, v153, v137
v_max_f32 v154, v154, v138
v_max_f32 v200, v200, v184
v_max_f32 v201, v201, v185
v_max_f32 v202, v202, v186
v_cvt_pk_bf16_f32 v224, v224, v225
ds_read_b64_tr_b16 a[6:7], v248 offset:1024
ds_read_b64_tr_b16 a[8:9], v248 offset:2048
v_max_f32 v155, v155, v139
v_max3_f32 v236, v152, v153, v154
v_max_f32 v203, v203, v187
v_max3_f32 v238, v200, v201, v202
v_cvt_pk_bf16_f32 v225, v226, v227
ds_read_b64_tr_b16 a[18:19], v248 offset:1536
ds_read_b64_tr_b16 a[20:21], v248 offset:2560
v_max_f32 v236, v236, v155
buffer_load_dwordx4 v1, s[4:7], s44 offen offset:3072 sc1 lds
v_max_f32 v238, v238, v203
v_and_b32 v208, v224, v28
v_and_b32 v209, v225, v29
v_and_b32 v210, v224, v30
v_and_b32 v211, v225, v31
v_permlane32_swap_b32 v238, v236
s_nop 0
v_mfma_f32_16x16x32_bf16 v[216:219], v[16:19], v[208:211], 0
v_max_f32 v238, v238, v236
v_mul_f32_e64 v85, -v242, v84
s_waitcnt lgkmcnt(6)
v_mfma_f32_16x16x32_bf16 v[116:119], a[10:13], v[208:211], 0
v_mov_b32 v243, v238
v_fma_f32 v176, v176, v84, v85
v_fma_f32 v177, v177, v84, v85
v_fma_f32 v178, v178, v84, v85
v_fma_f32 v179, v179, v84, v85
s_waitcnt lgkmcnt(4)
v_mfma_f32_16x16x32_bf16 v[120:123], a[22:25], v[208:211], 0
v_exp_f32 v176, v176
v_exp_f32 v177, v177
v_exp_f32 v178, v178
v_exp_f32 v179, v179
v_permlane16_swap_b32 v238, v243
v_rcp_f32 v216, v216
v_cvt_pk_bf16_f32 v176, v176, v177
v_max_f32 v238, v238, v243
v_cvt_pk_bf16_f32 v177, v178, v179
v_mov_b32 v243, v238
v_and_b32 v160, v176, v28
v_and_b32 v161, v177, v29
v_and_b32 v162, v176, v30
v_and_b32 v163, v177, v31
v_pk_mul_f32 v[116:117], v[116:117], v[216:217] op_sel:[0,0] op_sel_hi:[1,0]
v_pk_mul_f32 v[118:119], v[118:119], v[216:217] op_sel:[0,0] op_sel_hi:[1,0]
v_cvt_pk_bf16_f32 v116, v116, v117
v_pk_mul_f32 v[120:121], v[120:121], v[216:217] op_sel:[0,0] op_sel_hi:[1,0]
v_permlane32_swap_b32 v238, v243
v_pk_mul_f32 v[122:123], v[122:123], v[216:217] op_sel:[0,0] op_sel_hi:[1,0]
v_cvt_pk_bf16_f32 v117, v118, v119
v_mfma_f32_16x16x32_bf16 v[168:171], v[16:19], v[160:163], 0
v_cvt_pk_bf16_f32 v118, v120, v121
v_cvt_pk_bf16_f32 v119, v122, v123
buffer_store_dwordx4 v[116:119], v2, s[4:7], s72 offen offset:3072 sc1
v_mul_f32_e64 v87, -v238, v86
s_waitcnt lgkmcnt(2)
v_mfma_f32_16x16x32_bf16 v[100:103], a[6:9], v[160:163], 0
v_fma_f32 v200, v200, v86, v87
v_fma_f32 v201, v201, v86, v87
v_fma_f32 v202, v202, v86, v87
v_fma_f32 v203, v203, v86, v87
s_waitcnt lgkmcnt(0)
v_mfma_f32_16x16x32_bf16 v[104:107], a[18:21], v[160:163], 0
v_exp_f32 v200, v200
v_exp_f32 v201, v201
v_exp_f32 v202, v202
v_exp_f32 v203, v203
v_rcp_f32 v168, v168
v_cvt_pk_bf16_f32 v200, v200, v201
ds_read_b64_tr_b16 a[4:5], v248 offset:0
v_cvt_pk_bf16_f32 v201, v202, v203
ds_read_b64_tr_b16 a[16:17], v248 offset:512
v_and_b32 v184, v200, v28
v_and_b32 v185, v201, v29
v_and_b32 v186, v200, v30
v_and_b32 v187, v201, v31
v_pk_mul_f32 v[100:101], v[100:101], v[168:169] op_sel:[0,0] op_sel_hi:[1,0]
v_pk_mul_f32 v[102:103], v[102:103], v[168:169] op_sel:[0,0] op_sel_hi:[1,0]
v_cvt_pk_bf16_f32 v100, v100, v101
v_pk_mul_f32 v[104:105], v[104:105], v[168:169] op_sel:[0,0] op_sel_hi:[1,0]
v_cvt_pk_bf16_f32 v101, v102, v103
v_pk_mul_f32 v[106:107], v[106:107], v[168:169] op_sel:[0,0] op_sel_hi:[1,0]
v_cvt_pk_bf16_f32 v102, v104, v105
v_mfma_f32_16x16x32_bf16 v[192:195], v[16:19], v[184:187], 0
v_cvt_pk_bf16_f32 v103, v106, v107
buffer_store_dwordx4 v[100:103], v2, s[4:7], s72 offen offset:1024 sc1
v_mul_f32_e64 v83, -v243, v82
v_mfma_f32_16x16x32_bf16 v[108:111], a[8:11], v[184:187], 0
v_fma_f32 v152, v152, v82, v83
v_fma_f32 v153, v153, v82, v83
v_fma_f32 v154, v154, v82, v83
v_fma_f32 v155, v155, v82, v83
v_mfma_f32_16x16x32_bf16 v[112:115], a[20:23], v[184:187], 0
v_exp_f32 v152, v152
v_exp_f32 v153, v153
buffer_atomic_add v12, v10, s[4:7], s94 offen sc1
v_exp_f32 v154, v154
v_exp_f32 v155, v155
v_rcp_f32 v192, v192
v_cvt_pk_bf16_f32 v152, v152, v153
v_cvt_pk_bf16_f32 v153, v154, v155
v_and_b32 v136, v152, v80
v_and_b32 v137, v153, v81
v_and_b32 v138, v152, v30
v_and_b32 v139, v153, v31
v_pk_mul_f32 v[108:109], v[108:109], v[192:193] op_sel:[0,0] op_sel_hi:[1,0]
v_pk_mul_f32 v[110:111], v[110:111], v[192:193] op_sel:[0,0] op_sel_hi:[1,0]
v_cvt_pk_bf16_f32 v108, v108, v109
v_pk_mul_f32 v[112:113], v[112:113], v[192:193] op_sel:[0,0] op_sel_hi:[1,0]
v_cvt_pk_bf16_f32 v109, v110, v111
v_pk_mul_f32 v[114:115], v[114:115], v[192:193] op_sel:[0,0] op_sel_hi:[1,0]
v_cvt_pk_bf16_f32 v110, v112, v113
v_mfma_f32_16x16x32_bf16 v[144:147], v[16:19], v[136:139], 0
v_cvt_pk_bf16_f32 v111, v114, v115
buffer_store_dwordx4 v[108:111], v2, s[4:7], s72 offen offset:2048 sc1
s_waitcnt lgkmcnt(1)
v_mfma_f32_16x16x32_bf16 v[92:95], a[4:7], v[136:139], 0
s_nop 3
v_rcp_f32 v144, v144
s_waitcnt lgkmcnt(0)
v_mfma_f32_16x16x32_bf16 v[96:99], a[16:19], v[136:139], 0
s_nop 0
v_pk_mul_f32 v[92:93], v[92:93], v[144:145] op_sel:[0,0] op_sel_hi:[1,0]
v_pk_mul_f32 v[94:95], v[94:95], v[144:145] op_sel:[0,0] op_sel_hi:[1,0]
v_cvt_pk_bf16_f32 v92, v92, v93
v_cvt_pk_bf16_f32 v93, v94, v95
s_nop 2
v_pk_mul_f32 v[96:97], v[96:97], v[144:145] op_sel:[0,0] op_sel_hi:[1,0]
v_pk_mul_f32 v[98:99], v[98:99], v[144:145] op_sel:[0,0] op_sel_hi:[1,0]
v_cvt_pk_bf16_f32 v94, v96, v97
v_cvt_pk_bf16_f32 v95, v98, v99
buffer_store_dwordx4 v[92:95], v2, s[4:7], s72 offen offset:0 sc1
s_add_u32 s92, s71, 0x20000
s_add_u32 s36, s66, 0x20080
s_add_u32 s40, s4, 0x1e00000
s_addc_u32 s41, s5, 0
v_add_u32 v5, 32768, v1
v_add_u32 v6, 98304, v1
s_cmp_eq_u32 s3, 0
s_cselect_b32 s35, 8, 0
s_lshl_b32 s35, s35, 12
v_lshlrev_b32 v132, 16, v32
v_and_b32 v133, 0xffff0000, v32
v_lshlrev_b32 v134, 16, v33
v_and_b32 v135, 0xffff0000, v33
v_lshlrev_b32 v136, 16, v34
v_and_b32 v137, 0xffff0000, v34
v_lshlrev_b32 v138, 16, v35
v_and_b32 v139, 0xffff0000, v35
v_lshlrev_b32 v140, 16, v36
v_and_b32 v141, 0xffff0000, v36
v_lshlrev_b32 v142, 16, v37
v_and_b32 v143, 0xffff0000, v37
v_lshlrev_b32 v144, 16, v38
v_and_b32 v145, 0xffff0000, v38
v_lshlrev_b32 v146, 16, v39
v_and_b32 v147, 0xffff0000, v39
v_lshlrev_b32 v148, 16, v40
v_and_b32 v149, 0xffff0000, v40
v_lshlrev_b32 v150, 16, v41
v_and_b32 v151, 0xffff0000, v41
v_lshlrev_b32 v152, 16, v42
v_and_b32 v153, 0xffff0000, v42
v_lshlrev_b32 v154, 16, v43
v_and_b32 v155, 0xffff0000, v43
v_lshlrev_b32 v156, 16, v44
v_and_b32 v157, 0xffff0000, v44
v_lshlrev_b32 v158, 16, v45
v_and_b32 v159, 0xffff0000, v45
v_lshlrev_b32 v160, 16, v46
v_and_b32 v161, 0xffff0000, v46
v_lshlrev_b32 v162, 16, v47
v_and_b32 v163, 0xffff0000, v47
s_mov_b32 s95, -1
s_mov_b64 exec, 0
s_cmp_eq_u32 s28, 3
s_cbranch_scc1 L_stub14
s_cmp_eq_u32 s28, 2
s_cbranch_scc1 L_wret5
L_wret5:
s_mov_b64 exec, -1
s_cmp_lg_u32 s28, 0
s_cbranch_scc1 Lpo_33
s_add_u32 s36, s66, 0x20080
s_mov_b32 s37, 0
v_mov_b32 v11, 0
buffer_atomic_add v11, v251, s[4:7], s36 offen sc0 sc1
s_sleep 4
Lpoll_31:
v_mov_b32 v234, 0
buffer_atomic_add v234, v251, s[4:7], s36 offen sc0 sc1
s_waitcnt vmcnt(1)
v_readfirstlane_b32 s38, v11
s_nop 0
s_cmp_ge_u32 s38, 32
s_cbranch_scc1 Lpe_32
v_mov_b32 v11, 0
buffer_atomic_add v11, v251, s[4:7], s36 offen sc0 sc1
s_waitcnt vmcnt(1)
v_readfirstlane_b32 s38, v234
s_nop 0
s_cmp_ge_u32 s38, 32
s_cbranch_scc1 Lpe_32
s_add_u32 s37, s37, 1
s_cmp_lt_u32 s37, 0x80000
s_cbranch_scc1 Lpoll_31
s_waitcnt vmcnt(0)
Lpo_33:
s_waitcnt vmcnt(0)
Lpe_32:
s_barrier
L_k2go2:
buffer_load_dwordx4 a[0:3], v4, s[40:43], s35 offen offset:0 sc1
buffer_load_dwordx4 a[4:7], v4, s[40:43], s35 offen offset:1024 sc1
s_cmp_eq_u32 s3, 1
s_cselect_b32 s35, 9, 1
s_lshl_b32 s35, s35, 12
buffer_load_dwordx4 a[8:11], v4, s[40:43], s35 offen offset:0 sc1
buffer_load_dwordx4 a[12:15], v4, s[40:43], s35 offen offset:1024 sc1
s_cmp_eq_u32 s3, 2
s_cselect_b32 s35, 10, 2
s_lshl_b32 s35, s35, 12
buffer_load_dwordx4 a[16:19], v4, s[40:43], s35 offen offset:0 sc1
buffer_load_dwordx4 a[20:23], v4, s[40:43], s35 offen offset:1024 sc1
s_cmp_eq_u32 s3, 3
s_cselect_b32 s35, 11, 3
s_lshl_b32 s35, s35, 12
buffer_load_dwordx4 a[24:27], v4, s[40:43], s35 offen offset:0 sc1
buffer_load_dwordx4 a[28:31], v4, s[40:43], s35 offen offset:1024 sc1
s_cmp_eq_u32 s3, 4
s_cselect_b32 s35, 12, 4
s_lshl_b32 s35, s35, 12
buffer_load_dwordx4 a[32:35], v4, s[40:43], s35 offen offset:0 sc1
buffer_load_dwordx4 a[36:39], v4, s[40:43], s35 offen offset:1024 sc1
s_cmp_eq_u32 s3, 5
s_cselect_b32 s35, 13, 5
s_lshl_b32 s35, s35, 12
buffer_load_dwordx4 a[40:43], v4, s[40:43], s35 offen offset:0 sc1
buffer_load_dwordx4 a[44:47], v4, s[40:43], s35 offen offset:1024 sc1
s_cmp_eq_u32 s3, 6
s_cselect_b32 s35, 14, 6
s_lshl_b32 s35, s35, 12
ds_read_b128 a[96:99], v5 offset:0
ds_read_b128 a[100:103], v5 offset:1024
ds_read_b128 a[104:107], v5 offset:2048
ds_read_b128 a[108:111], v5 offset:3072
ds_read_b128 a[112:115], v5 offset:4096
ds_read_b128 a[116:119], v5 offset:5120
ds_read_b128 a[120:123], v5 offset:6144
ds_read_b128 a[124:127], v5 offset:7168
s_waitcnt vmcnt(10) lgkmcnt(4)
v_mfma_f32_16x16x32_bf16 v[132:135], a[96:99], a[0:3], v[132:135]
ds_read_b128 a[128:131], v5 offset:8192
v_mfma_f32_16x16x32_bf16 v[148:151], a[96:99], a[4:7], v[148:151]
ds_read_b128 a[132:135], v5 offset:9216
v_mfma_f32_16x16x32_bf16 v[152:155], a[100:103], a[4:7], v[152:155]
buffer_load_dwordx4 a[48:51], v4, s[40:43], s35 offen offset:0 sc1
v_mfma_f32_16x16x32_bf16 v[136:139], a[100:103], a[0:3], v[136:139]
ds_read_b128 a[136:139], v5 offset:10240
v_mfma_f32_16x16x32_bf16 v[140:143], a[104:107], a[0:3], v[140:143]
ds_read_b128 a[140:143], v5 offset:11264
v_mfma_f32_16x16x32_bf16 v[156:159], a[104:107], a[4:7], v[156:159]
v_mfma_f32_16x16x32_bf16 v[160:163], a[108:111], a[4:7], v[160:163]
buffer_load_dwordx4 a[52:55], v4, s[40:43], s35 offen offset:1024 sc1
v_mfma_f32_16x16x32_bf16 v[144:147], a[108:111], a[0:3], v[144:147]
s_waitcnt vmcnt(10) lgkmcnt(4)
v_mfma_f32_16x16x32_bf16 v[132:135], a[112:115], a[8:11], v[132:135]
s_cmp_eq_u32 s3, 7
s_cselect_b32 s35, 15, 7
s_lshl_b32 s35, s35, 12
v_mfma_f32_16x16x32_bf16 v[148:151], a[112:115], a[12:15], v[148:151]
ds_read_b128 a[96:99], v5 offset:12288
v_mfma_f32_16x16x32_bf16 v[152:155], a[116:119], a[12:15], v[152:155]
buffer_load_dwordx4 a[0:3], v4, s[40:43], s35 offen offset:0 sc1
v_mfma_f32_16x16x32_bf16 v[136:139], a[116:119], a[8:11], v[136:139]
ds_read_b128 a[100:103], v5 offset:13312
v_mfma_f32_16x16x32_bf16 v[140:143], a[120:123], a[8:11], v[140:143]
ds_read_b128 a[104:107], v5 offset:14336
v_mfma_f32_16x16x32_bf16 v[156:159], a[120:123], a[12:15], v[156:159]
ds_read_b128 a[108:111], v5 offset:15360
v_mfma_f32_16x16x32_bf16 v[160:163], a[124:127], a[12:15], v[160:163]
buffer_load_dwordx4 a[4:7], v4, s[40:43], s35 offen offset:1024 sc1
v_mfma_f32_16x16x32_bf16 v[144:147], a[124:127], a[8:11], v[144:147]
s_waitcnt vmcnt(10) lgkmcnt(4)
v_mfma_f32_16x16x32_bf16 v[132:135], a[128:131], a[16:19], v[132:135]
s_cmp_eq_u32 s3, 0
s_cselect_b32 s35, 16, 8
s_lshl_b32 s35, s35, 12
v_mfma_f32_16x16x32_bf16 v[148:151], a[128:131], a[20:23], v[148:151]
ds_read_b128 a[112:115], v5 offset:16384
v_mfma_f32_16x16x32_bf16 v[152:155], a[132:135], a[20:23], v[152:155]
buffer_load_dwordx4 a[8:11], v4, s[40:43], s35 offen offset:0 sc1
v_mfma_f32_16x16x32_bf16 v[136:139], a[132:135], a[16:19], v[136:139]
ds_read_b128 a[116:119], v5 offset:17408
v_mfma_f32_16x16x32_bf16 v[140:143], a[136:139], a[16:19], v[140:143]
ds_read_b128 a[120:123], v5 offset:18432
v_mfma_f32_16x16x32_bf16 v[156:159], a[136:139], a[20:23], v[156:159]
ds_read_b128 a[124:127], v5 offset:19456
v_mfma_f32_16x16x32_bf16 v[160:163], a[140:143], a[20:23], v[160:163]
buffer_load_dwordx4 a[12:15], v4, s[40:43], s35 offen offset:1024 sc1
v_mfma_f32_16x16x32_bf16 v[144:147], a[140:143], a[16:19], v[144:147]
s_waitcnt vmcnt(10) lgkmcnt(4)
v_mfma_f32_16x16x32_bf16 v[132:135], a[96:99], a[24:27], v[132:135]
s_cmp_eq_u32 s3, 1
s_cselect_b32 s35, 17, 9
s_lshl_b32 s35, s35, 12
v_mfma_f32_16x16x32_bf16 v[148:151], a[96:99], a[28:31], v[148:151]
ds_read_b128 a[128:131], v5 offset:20480
v_mfma_f32_16x16x32_bf16 v[152:155], a[100:103], a[28:31], v[152:155]
buffer_load_dwordx4 a[16:19], v4, s[40:43], s35 offen offset:0 sc1
v_mfma_f32_16x16x32_bf16 v[136:139], a[100:103], a[24:27], v[136:139]
ds_read_b128 a[132:135], v5 offset:21504
v_mfma_f32_16x16x32_bf16 v[140:143], a[104:107], a[24:27], v[140:143]
ds_read_b128 a[136:139], v5 offset:22528
v_mfma_f32_16x16x32_bf16 v[156:159], a[104:107], a[28:31], v[156:159]
ds_read_b128 a[140:143], v5 offset:23552
v_mfma_f32_16x16x32_bf16 v[160:163], a[108:111], a[28:31], v[160:163]
buffer_load_dwordx4 a[20:23], v4, s[40:43], s35 offen offset:1024 sc1
v_mfma_f32_16x16x32_bf16 v[144:147], a[108:111], a[24:27], v[144:147]
s_waitcnt vmcnt(10) lgkmcnt(4)
v_mfma_f32_16x16x32_bf16 v[132:135], a[112:115], a[32:35], v[132:135]
s_cmp_eq_u32 s3, 2
s_cselect_b32 s35, 18, 10
s_lshl_b32 s35, s35, 12
v_mfma_f32_16x16x32_bf16 v[148:151], a[112:115], a[36:39], v[148:151]
ds_read_b128 a[96:99], v5 offset:24576
v_mfma_f32_16x16x32_bf16 v[152:155], a[116:119], a[36:39], v[152:155]
buffer_load_dwordx4 a[24:27], v4, s[40:43], s35 offen offset:0 sc1
v_mfma_f32_16x16x32_bf16 v[136:139], a[116:119], a[32:35], v[136:139]
ds_read_b128 a[100:103], v5 offset:25600
v_mfma_f32_16x16x32_bf16 v[140:143], a[120:123], a[32:35], v[140:143]
ds_read_b128 a[104:107], v5 offset:26624
v_mfma_f32_16x16x32_bf16 v[156:159], a[120:123], a[36:39], v[156:159]
ds_read_b128 a[108:111], v5 offset:27648
v_mfma_f32_16x16x32_bf16 v[160:163], a[124:127], a[36:39], v[160:163]
buffer_load_dwordx4 a[28:31], v4, s[40:43], s35 offen offset:1024 sc1
v_mfma_f32_16x16x32_bf16 v[144:147], a[124:127], a[32:35], v[144:147]
s_waitcnt vmcnt(10) lgkmcnt(4)
v_mfma_f32_16x16x32_bf16 v[132:135], a[128:131], a[40:43], v[132:135]
s_cmp_eq_u32 s3, 3
s_cselect_b32 s35, 19, 11
s_lshl_b32 s35, s35, 12
v_mfma_f32_16x16x32_bf16 v[148:151], a[128:131], a[44:47], v[148:151]
ds_read_b128 a[112:115], v5 offset:28672
v_mfma_f32_16x16x32_bf16 v[152:155], a[132:135], a[44:47], v[152:155]
buffer_load_dwordx4 a[32:35], v4, s[40:43], s35 offen offset:0 sc1
v_mfma_f32_16x16x32_bf16 v[136:139], a[132:135], a[40:43], v[136:139]
ds_read_b128 a[116:119], v5 offset:29696
v_mfma_f32_16x16x32_bf16 v[140:143], a[136:139], a[40:43], v[140:143]
ds_read_b128 a[120:123], v5 offset:30720
v_mfma_f32_16x16x32_bf16 v[156:159], a[136:139], a[44:47], v[156:159]
ds_read_b128 a[124:127], v5 offset:31744
v_mfma_f32_16x16x32_bf16 v[160:163], a[140:143], a[44:47], v[160:163]
buffer_load_dwordx4 a[36:39], v4, s[40:43], s35 offen offset:1024 sc1
v_mfma_f32_16x16x32_bf16 v[144:147], a[140:143], a[40:43], v[144:147]
s_waitcnt vmcnt(10) lgkmcnt(4)
v_mfma_f32_16x16x32_bf16 v[132:135], a[96:99], a[48:51], v[132:135]
s_cmp_eq_u32 s3, 4
s_cselect_b32 s35, 20, 12
s_lshl_b32 s35, s35, 12
v_mfma_f32_16x16x32_bf16 v[148:151], a[96:99], a[52:55], v[148:151]
ds_read_b128 a[128:131], v5 offset:32768
v_mfma_f32_16x16x32_bf16 v[152:155], a[100:103], a[52:55], v[152:155]
buffer_load_dwordx4 a[40:43], v4, s[40:43], s35 offen offset:0 sc1
v_mfma_f32_16x16x32_bf16 v[136:139], a[100:103], a[48:51], v[136:139]
ds_read_b128 a[132:135], v5 offset:33792
v_mfma_f32_16x16x32_bf16 v[140:143], a[104:107], a[48:51], v[140:143]
ds_read_b128 a[136:139], v5 offset:34816
v_mfma_f32_16x16x32_bf16 v[156:159], a[104:107], a[52:55], v[156:159]
ds_read_b128 a[140:143], v5 offset:35840
v_mfma_f32_16x16x32_bf16 v[160:163], a[108:111], a[52:55], v[160:163]
buffer_load_dwordx4 a[44:47], v4, s[40:43], s35 offen offset:1024 sc1
v_mfma_f32_16x16x32_bf16 v[144:147], a[108:111], a[48:51], v[144:147]
s_waitcnt vmcnt(10) lgkmcnt(4)
v_mfma_f32_16x16x32_bf16 v[132:135], a[112:115], a[0:3], v[132:135]
s_cmp_eq_u32 s3, 5
s_cselect_b32 s35, 21, 13
s_lshl_b32 s35, s35, 12
v_mfma_f32_16x16x32_bf16 v[148:151], a[112:115], a[4:7], v[148:151]
ds_read_b128 a[96:99], v5 offset:36864
v_mfma_f32_16x16x32_bf16 v[152:155], a[116:119], a[4:7], v[152:155]
buffer_load_dwordx4 a[48:51], v4, s[40:43], s35 offen offset:0 sc1
v_mfma_f32_16x16x32_bf16 v[136:139], a[116:119], a[0:3], v[136:139]
ds_read_b128 a[100:103], v5 offset:37888
v_mfma_f32_16x16x32_bf16 v[140:143], a[120:123], a[0:3], v[140:143]
ds_read_b128 a[104:107], v5 offset:38912
v_mfma_f32_16x16x32_bf16 v[156:159], a[120:123], a[4:7], v[156:159]
ds_read_b128 a[108:111], v5 offset:39936
v_mfma_f32_16x16x32_bf16 v[160:163], a[124:127], a[4:7], v[160:163]
buffer_load_dwordx4 a[52:55], v4, s[40:43], s35 offen offset:1024 sc1
v_mfma_f32_16x16x32_bf16 v[144:147], a[124:127], a[0:3], v[144:147]
s_waitcnt vmcnt(10) lgkmcnt(4)
v_mfma_f32_16x16x32_bf16 v[132:135], a[128:131], a[8:11], v[132:135]
s_cmp_eq_u32 s3, 6
s_cselect_b32 s35, 22, 14
s_lshl_b32 s35, s35, 12
v_mfma_f32_16x16x32_bf16 v[148:151], a[128:131], a[12:15], v[148:151]
ds_read_b128 a[112:115], v5 offset:40960
v_mfma_f32_16x16x32_bf16 v[152:155], a[132:135], a[12:15], v[152:155]
buffer_load_dwordx4 a[0:3], v4, s[40:43], s35 offen offset:0 sc1
v_mfma_f32_16x16x32_bf16 v[136:139], a[132:135], a[8:11], v[136:139]
ds_read_b128 a[116:119], v5 offset:41984
v_mfma_f32_16x16x32_bf16 v[140:143], a[136:139], a[8:11], v[140:143]
ds_read_b128 a[120:123], v5 offset:43008
v_mfma_f32_16x16x32_bf16 v[156:159], a[136:139], a[12:15], v[156:159]
ds_read_b128 a[124:127], v5 offset:44032
v_mfma_f32_16x16x32_bf16 v[160:163], a[140:143], a[12:15], v[160:163]
buffer_load_dwordx4 a[4:7], v4, s[40:43], s35 offen offset:1024 sc1
v_mfma_f32_16x16x32_bf16 v[144:147], a[140:143], a[8:11], v[144:147]
s_waitcnt vmcnt(10) lgkmcnt(4)
v_mfma_f32_16x16x32_bf16 v[132:135], a[96:99], a[16:19], v[132:135]
s_cmp_eq_u32 s3, 7
s_cselect_b32 s35, 23, 15
s_lshl_b32 s35, s35, 12
v_mfma_f32_16x16x32_bf16 v[148:151], a[96:99], a[20:23], v[148:151]
ds_read_b128 a[128:131], v5 offset:45056
v_mfma_f32_16x16x32_bf16 v[152:155], a[100:103], a[20:23], v[152:155]
buffer_load_dwordx4 a[8:11], v4, s[40:43], s35 offen offset:0 sc1
v_mfma_f32_16x16x32_bf16 v[136:139], a[100:103], a[16:19], v[136:139]
ds_read_b128 a[132:135], v5 offset:46080
v_mfma_f32_16x16x32_bf16 v[140:143], a[104:107], a[16:19], v[140:143]
ds_read_b128 a[136:139], v5 offset:47104
v_mfma_f32_16x16x32_bf16 v[156:159], a[104:107], a[20:23], v[156:159]
ds_read_b128 a[140:143], v5 offset:48128
v_mfma_f32_16x16x32_bf16 v[160:163], a[108:111], a[20:23], v[160:163]
buffer_load_dwordx4 a[12:15], v4, s[40:43], s35 offen offset:1024 sc1
v_mfma_f32_16x16x32_bf16 v[144:147], a[108:111], a[16:19], v[144:147]
s_waitcnt vmcnt(10) lgkmcnt(4)
v_mfma_f32_16x16x32_bf16 v[132:135], a[112:115], a[24:27], v[132:135]
s_cmp_eq_u32 s3, 0
s_cselect_b32 s35, 24, 16
s_lshl_b32 s35, s35, 12
v_mfma_f32_16x16x32_bf16 v[148:151], a[112:115], a[28:31], v[148:151]
ds_read_b128 a[96:99], v5 offset:49152
v_mfma_f32_16x16x32_bf16 v[152:155], a[116:119], a[28:31], v[152:155]
buffer_load_dwordx4 a[16:19], v4, s[40:43], s35 offen offset:0 sc1
v_mfma_f32_16x16x32_bf16 v[136:139], a[116:119], a[24:27], v[136:139]
ds_read_b128 a[100:103], v5 offset:50176
v_mfma_f32_16x16x32_bf16 v[140:143], a[120:123], a[24:27], v[140:143]
ds_read_b128 a[104:107], v5 offset:51200
v_mfma_f32_16x16x32_bf16 v[156:159], a[120:123], a[28:31], v[156:159]
ds_read_b128 a[108:111], v5 offset:52224
v_mfma_f32_16x16x32_bf16 v[160:163], a[124:127], a[28:31], v[160:163]
buffer_load_dwordx4 a[20:23], v4, s[40:43], s35 offen offset:1024 sc1
v_mfma_f32_16x16x32_bf16 v[144:147], a[124:127], a[24:27], v[144:147]
s_waitcnt vmcnt(10) lgkmcnt(4)
v_mfma_f32_16x16x32_bf16 v[132:135], a[128:131], a[32:35], v[132:135]
s_cmp_eq_u32 s3, 1
s_cselect_b32 s35, 25, 17
s_lshl_b32 s35, s35, 12
v_mfma_f32_16x16x32_bf16 v[148:151], a[128:131], a[36:39], v[148:151]
ds_read_b128 a[112:115], v5 offset:53248
v_mfma_f32_16x16x32_bf16 v[152:155], a[132:135], a[36:39], v[152:155]
buffer_load_dwordx4 a[24:27], v4, s[40:43], s35 offen offset:0 sc1
v_mfma_f32_16x16x32_bf16 v[136:139], a[132:135], a[32:35], v[136:139]
ds_read_b128 a[116:119], v5 offset:54272
v_mfma_f32_16x16x32_bf16 v[140:143], a[136:139], a[32:35], v[140:143]
ds_read_b128 a[120:123], v5 offset:55296
v_mfma_f32_16x16x32_bf16 v[156:159], a[136:139], a[36:39], v[156:159]
ds_read_b128 a[124:127], v5 offset:56320
v_mfma_f32_16x16x32_bf16 v[160:163], a[140:143], a[36:39], v[160:163]
buffer_load_dwordx4 a[28:31], v4, s[40:43], s35 offen offset:1024 sc1
v_mfma_f32_16x16x32_bf16 v[144:147], a[140:143], a[32:35], v[144:147]
s_waitcnt vmcnt(10) lgkmcnt(4)
v_mfma_f32_16x16x32_bf16 v[132:135], a[96:99], a[40:43], v[132:135]
s_cmp_eq_u32 s3, 2
s_cselect_b32 s35, 26, 18
s_lshl_b32 s35, s35, 12
v_mfma_f32_16x16x32_bf16 v[148:151], a[96:99], a[44:47], v[148:151]
ds_read_b128 a[128:131], v5 offset:57344
v_mfma_f32_16x16x32_bf16 v[152:155], a[100:103], a[44:47], v[152:155]
buffer_load_dwordx4 a[32:35], v4, s[40:43], s35 offen offset:0 sc1
v_mfma_f32_16x16x32_bf16 v[136:139], a[100:103], a[40:43], v[136:139]
ds_read_b128 a[132:135], v5 offset:58368
v_mfma_f32_16x16x32_bf16 v[140:143], a[104:107], a[40:43], v[140:143]
ds_read_b128 a[136:139], v5 offset:59392
v_mfma_f32_16x16x32_bf16 v[156:159], a[104:107], a[44:47], v[156:159]
ds_read_b128 a[140:143], v5 offset:60416
v_mfma_f32_16x16x32_bf16 v[160:163], a[108:111], a[44:47], v[160:163]
buffer_load_dwordx4 a[36:39], v4, s[40:43], s35 offen offset:1024 sc1
v_mfma_f32_16x16x32_bf16 v[144:147], a[108:111], a[40:43], v[144:147]
s_waitcnt vmcnt(10) lgkmcnt(4)
v_mfma_f32_16x16x32_bf16 v[132:135], a[112:115], a[48:51], v[132:135]
s_cmp_eq_u32 s3, 3
s_cselect_b32 s35, 27, 19
s_lshl_b32 s35, s35, 12
v_mfma_f32_16x16x32_bf16 v[148:151], a[112:115], a[52:55], v[148:151]
ds_read_b128 a[96:99], v5 offset:61440
v_mfma_f32_16x16x32_bf16 v[152:155], a[116:119], a[52:55], v[152:155]
buffer_load_dwordx4 a[40:43], v4, s[40:43], s35 offen offset:0 sc1
v_mfma_f32_16x16x32_bf16 v[136:139], a[116:119], a[48:51], v[136:139]
ds_read_b128 a[100:103], v5 offset:62464
v_mfma_f32_16x16x32_bf16 v[140:143], a[120:123], a[48:51], v[140:143]
ds_read_b128 a[104:107], v5 offset:63488
v_mfma_f32_16x16x32_bf16 v[156:159], a[120:123], a[52:55], v[156:159]
ds_read_b128 a[108:111], v5 offset:64512
v_mfma_f32_16x16x32_bf16 v[160:163], a[124:127], a[52:55], v[160:163]
buffer_load_dwordx4 a[44:47], v4, s[40:43], s35 offen offset:1024 sc1
v_mfma_f32_16x16x32_bf16 v[144:147], a[124:127], a[48:51], v[144:147]
s_waitcnt vmcnt(10) lgkmcnt(4)
v_mfma_f32_16x16x32_bf16 v[132:135], a[128:131], a[0:3], v[132:135]
s_cmp_eq_u32 s3, 4
s_cselect_b32 s35, 28, 20
s_lshl_b32 s35, s35, 12
v_mfma_f32_16x16x32_bf16 v[148:151], a[128:131], a[4:7], v[148:151]
ds_read_b128 a[112:115], v6 offset:0
v_mfma_f32_16x16x32_bf16 v[152:155], a[132:135], a[4:7], v[152:155]
buffer_load_dwordx4 a[48:51], v4, s[40:43], s35 offen offset:0 sc1
v_mfma_f32_16x16x32_bf16 v[136:139], a[132:135], a[0:3], v[136:139]
ds_read_b128 a[116:119], v6 offset:1024
v_mfma_f32_16x16x32_bf16 v[140:143], a[136:139], a[0:3], v[140:143]
ds_read_b128 a[120:123], v6 offset:2048
v_mfma_f32_16x16x32_bf16 v[156:159], a[136:139], a[4:7], v[156:159]
ds_read_b128 a[124:127], v6 offset:3072
v_mfma_f32_16x16x32_bf16 v[160:163], a[140:143], a[4:7], v[160:163]
buffer_load_dwordx4 a[52:55], v4, s[40:43], s35 offen offset:1024 sc1
v_mfma_f32_16x16x32_bf16 v[144:147], a[140:143], a[0:3], v[144:147]
s_waitcnt vmcnt(10) lgkmcnt(4)
v_mfma_f32_16x16x32_bf16 v[132:135], a[96:99], a[8:11], v[132:135]
s_cmp_eq_u32 s3, 5
s_cselect_b32 s35, 29, 21
s_lshl_b32 s35, s35, 12
v_mfma_f32_16x16x32_bf16 v[148:151], a[96:99], a[12:15], v[148:151]
ds_read_b128 a[128:131], v6 offset:4096
v_mfma_f32_16x16x32_bf16 v[152:155], a[100:103], a[12:15], v[152:155]
buffer_load_dwordx4 a[0:3], v4, s[40:43], s35 offen offset:0 sc1
v_mfma_f32_16x16x32_bf16 v[136:139], a[100:103], a[8:11], v[136:139]
L_stub14:
s_cbranch_execz L_wret5
ds_read_b128 a[132:135], v6 offset:5120
v_mfma_f32_16x16x32_bf16 v[140:143], a[104:107], a[8:11], v[140:143]
ds_read_b128 a[136:139], v6 offset:6144
v_mfma_f32_16x16x32_bf16 v[156:159], a[104:107], a[12:15], v[156:159]
ds_read_b128 a[140:143], v6 offset:7168
v_mfma_f32_16x16x32_bf16 v[160:163], a[108:111], a[12:15], v[160:163]
buffer_load_dwordx4 a[4:7], v4, s[40:43], s35 offen offset:1024 sc1
v_mfma_f32_16x16x32_bf16 v[144:147], a[108:111], a[8:11], v[144:147]
s_waitcnt vmcnt(10) lgkmcnt(4)
v_mfma_f32_16x16x32_bf16 v[132:135], a[112:115], a[16:19], v[132:135]
s_cmp_eq_u32 s3, 6
s_cselect_b32 s35, 30, 22
s_lshl_b32 s35, s35, 12
v_mfma_f32_16x16x32_bf16 v[148:151], a[112:115], a[20:23], v[148:151]
ds_read_b128 a[96:99], v6 offset:8192
v_mfma_f32_16x16x32_bf16 v[152:155], a[116:119], a[20:23], v[152:155]
buffer_load_dwordx4 a[8:11], v4, s[40:43], s35 offen offset:0 sc1
v_mfma_f32_16x16x32_bf16 v[136:139], a[116:119], a[16:19], v[136:139]
ds_read_b128 a[100:103], v6 offset:9216
v_mfma_f32_16x16x32_bf16 v[140:143], a[120:123], a[16:19], v[140:143]
ds_read_b128 a[104:107], v6 offset:10240
v_mfma_f32_16x16x32_bf16 v[156:159], a[120:123], a[20:23], v[156:159]
ds_read_b128 a[108:111], v6 offset:11264
v_mfma_f32_16x16x32_bf16 v[160:163], a[124:127], a[20:23], v[160:163]
buffer_load_dwordx4 a[12:15], v4, s[40:43], s35 offen offset:1024 sc1
v_mfma_f32_16x16x32_bf16 v[144:147], a[124:127], a[16:19], v[144:147]
s_waitcnt vmcnt(10) lgkmcnt(4)
v_mfma_f32_16x16x32_bf16 v[132:135], a[128:131], a[24:27], v[132:135]
s_cmp_eq_u32 s3, 7
s_cselect_b32 s35, 31, 23
s_lshl_b32 s35, s35, 12
v_mfma_f32_16x16x32_bf16 v[148:151], a[128:131], a[28:31], v[148:151]
ds_read_b128 a[112:115], v6 offset:12288
v_mfma_f32_16x16x32_bf16 v[152:155], a[132:135], a[28:31], v[152:155]
buffer_load_dwordx4 a[16:19], v4, s[40:43], s35 offen offset:0 sc1
v_mfma_f32_16x16x32_bf16 v[136:139], a[132:135], a[24:27], v[136:139]
ds_read_b128 a[116:119], v6 offset:13312
v_mfma_f32_16x16x32_bf16 v[140:143], a[136:139], a[24:27], v[140:143]
ds_read_b128 a[120:123], v6 offset:14336
v_mfma_f32_16x16x32_bf16 v[156:159], a[136:139], a[28:31], v[156:159]
ds_read_b128 a[124:127], v6 offset:15360
v_mfma_f32_16x16x32_bf16 v[160:163], a[140:143], a[28:31], v[160:163]
buffer_load_dwordx4 a[20:23], v4, s[40:43], s35 offen offset:1024 sc1
v_mfma_f32_16x16x32_bf16 v[144:147], a[140:143], a[24:27], v[144:147]
s_waitcnt vmcnt(10) lgkmcnt(4)
v_mfma_f32_16x16x32_bf16 v[132:135], a[96:99], a[32:35], v[132:135]
s_cmp_eq_u32 s3, 0
s_cselect_b32 s35, 0, 24
s_lshl_b32 s35, s35, 12
v_mfma_f32_16x16x32_bf16 v[148:151], a[96:99], a[36:39], v[148:151]
ds_read_b128 a[128:131], v6 offset:16384
v_mfma_f32_16x16x32_bf16 v[152:155], a[100:103], a[36:39], v[152:155]
buffer_load_dwordx4 a[24:27], v4, s[40:43], s35 offen offset:0 sc1
v_mfma_f32_16x16x32_bf16 v[136:139], a[100:103], a[32:35], v[136:139]
ds_read_b128 a[132:135], v6 offset:17408
v_mfma_f32_16x16x32_bf16 v[140:143], a[104:107], a[32:35], v[140:143]
ds_read_b128 a[136:139], v6 offset:18432
v_mfma_f32_16x16x32_bf16 v[156:159], a[104:107], a[36:39], v[156:159]
ds_read_b128 a[140:143], v6 offset:19456
v_mfma_f32_16x16x32_bf16 v[160:163], a[108:111], a[36:39], v[160:163]
buffer_load_dwordx4 a[28:31], v4, s[40:43], s35 offen offset:1024 sc1
v_mfma_f32_16x16x32_bf16 v[144:147], a[108:111], a[32:35], v[144:147]
s_waitcnt vmcnt(10) lgkmcnt(4)
v_mfma_f32_16x16x32_bf16 v[132:135], a[112:115], a[40:43], v[132:135]
s_cmp_eq_u32 s3, 1
s_cselect_b32 s35, 1, 25
s_lshl_b32 s35, s35, 12
v_mfma_f32_16x16x32_bf16 v[148:151], a[112:115], a[44:47], v[148:151]
ds_read_b128 a[96:99], v6 offset:20480
v_mfma_f32_16x16x32_bf16 v[152:155], a[116:119], a[44:47], v[152:155]
buffer_load_dwordx4 a[32:35], v4, s[40:43], s35 offen offset:0 sc1
v_mfma_f32_16x16x32_bf16 v[136:139], a[116:119], a[40:43], v[136:139]
ds_read_b128 a[100:103], v6 offset:21504
v_mfma_f32_16x16x32_bf16 v[140:143], a[120:123], a[40:43], v[140:143]
ds_read_b128 a[104:107], v6 offset:22528
v_mfma_f32_16x16x32_bf16 v[156:159], a[120:123], a[44:47], v[156:159]
ds_read_b128 a[108:111], v6 offset:23552
v_mfma_f32_16x16x32_bf16 v[160:163], a[124:127], a[44:47], v[160:163]
buffer_load_dwordx4 a[36:39], v4, s[40:43], s35 offen offset:1024 sc1
v_mfma_f32_16x16x32_bf16 v[144:147], a[124:127], a[40:43], v[144:147]
s_waitcnt vmcnt(10) lgkmcnt(4)
v_mfma_f32_16x16x32_bf16 v[132:135], a[128:131], a[48:51], v[132:135]
s_cmp_eq_u32 s3, 2
s_cselect_b32 s35, 2, 26
s_lshl_b32 s35, s35, 12
v_mfma_f32_16x16x32_bf16 v[148:151], a[128:131], a[52:55], v[148:151]
ds_read_b128 a[112:115], v6 offset:24576
v_mfma_f32_16x16x32_bf16 v[152:155], a[132:135], a[52:55], v[152:155]
buffer_load_dwordx4 a[40:43], v4, s[40:43], s35 offen offset:0 sc1
v_mfma_f32_16x16x32_bf16 v[136:139], a[132:135], a[48:51], v[136:139]
ds_read_b128 a[116:119], v6 offset:25600
v_mfma_f32_16x16x32_bf16 v[140:143], a[136:139], a[48:51], v[140:143]
ds_read_b128 a[120:123], v6 offset:26624
v_mfma_f32_16x16x32_bf16 v[156:159], a[136:139], a[52:55], v[156:159]
ds_read_b128 a[124:127], v6 offset:27648
v_mfma_f32_16x16x32_bf16 v[160:163], a[140:143], a[52:55], v[160:163]
buffer_load_dwordx4 a[44:47], v4, s[40:43], s35 offen offset:1024 sc1
v_mfma_f32_16x16x32_bf16 v[144:147], a[140:143], a[48:51], v[144:147]
s_waitcnt vmcnt(10) lgkmcnt(4)
v_mfma_f32_16x16x32_bf16 v[132:135], a[96:99], a[0:3], v[132:135]
s_cmp_eq_u32 s3, 3
s_cselect_b32 s35, 3, 27
s_lshl_b32 s35, s35, 12
v_mfma_f32_16x16x32_bf16 v[148:151], a[96:99], a[4:7], v[148:151]
ds_read_b128 a[128:131], v6 offset:28672
v_mfma_f32_16x16x32_bf16 v[152:155], a[100:103], a[4:7], v[152:155]
buffer_load_dwordx4 a[48:51], v4, s[40:43], s35 offen offset:0 sc1
v_mfma_f32_16x16x32_bf16 v[136:139], a[100:103], a[0:3], v[136:139]
ds_read_b128 a[132:135], v6 offset:29696
v_mfma_f32_16x16x32_bf16 v[140:143], a[104:107], a[0:3], v[140:143]
ds_read_b128 a[136:139], v6 offset:30720
v_mfma_f32_16x16x32_bf16 v[156:159], a[104:107], a[4:7], v[156:159]
ds_read_b128 a[140:143], v6 offset:31744
v_mfma_f32_16x16x32_bf16 v[160:163], a[108:111], a[4:7], v[160:163]
buffer_load_dwordx4 a[52:55], v4, s[40:43], s35 offen offset:1024 sc1
v_mfma_f32_16x16x32_bf16 v[144:147], a[108:111], a[0:3], v[144:147]
s_waitcnt vmcnt(10) lgkmcnt(4)
v_mfma_f32_16x16x32_bf16 v[132:135], a[112:115], a[8:11], v[132:135]
s_cmp_eq_u32 s3, 4
s_cselect_b32 s35, 4, 28
s_lshl_b32 s35, s35, 12
v_mfma_f32_16x16x32_bf16 v[148:151], a[112:115], a[12:15], v[148:151]
ds_read_b128 a[96:99], v6 offset:32768
v_mfma_f32_16x16x32_bf16 v[152:155], a[116:119], a[12:15], v[152:155]
buffer_load_dwordx4 a[0:3], v4, s[40:43], s35 offen offset:0 sc1
v_mfma_f32_16x16x32_bf16 v[136:139], a[116:119], a[8:11], v[136:139]
ds_read_b128 a[100:103], v6 offset:33792
v_mfma_f32_16x16x32_bf16 v[140:143], a[120:123], a[8:11], v[140:143]
ds_read_b128 a[104:107], v6 offset:34816
v_mfma_f32_16x16x32_bf16 v[156:159], a[120:123], a[12:15], v[156:159]
ds_read_b128 a[108:111], v6 offset:35840
v_mfma_f32_16x16x32_bf16 v[160:163], a[124:127], a[12:15], v[160:163]
buffer_load_dwordx4 a[4:7], v4, s[40:43], s35 offen offset:1024 sc1
v_mfma_f32_16x16x32_bf16 v[144:147], a[124:127], a[8:11], v[144:147]
s_waitcnt vmcnt(10) lgkmcnt(4)
v_mfma_f32_16x16x32_bf16 v[132:135], a[128:131], a[16:19], v[132:135]
s_cmp_eq_u32 s3, 5
s_cselect_b32 s35, 5, 29
s_lshl_b32 s35, s35, 12
v_mfma_f32_16x16x32_bf16 v[148:151], a[128:131], a[20:23], v[148:151]
ds_read_b128 a[112:115], v6 offset:36864
v_mfma_f32_16x16x32_bf16 v[152:155], a[132:135], a[20:23], v[152:155]
buffer_load_dwordx4 a[8:11], v4, s[40:43], s35 offen offset:0 sc1
v_mfma_f32_16x16x32_bf16 v[136:139], a[132:135], a[16:19], v[136:139]
ds_read_b128 a[116:119], v6 offset:37888
v_mfma_f32_16x16x32_bf16 v[140:143], a[136:139], a[16:19], v[140:143]
ds_read_b128 a[120:123], v6 offset:38912
v_mfma_f32_16x16x32_bf16 v[156:159], a[136:139], a[20:23], v[156:159]
ds_read_b128 a[124:127], v6 offset:39936
v_mfma_f32_16x16x32_bf16 v[160:163], a[140:143], a[20:23], v[160:163]
buffer_load_dwordx4 a[12:15], v4, s[40:43], s35 offen offset:1024 sc1
v_mfma_f32_16x16x32_bf16 v[144:147], a[140:143], a[16:19], v[144:147]
s_waitcnt vmcnt(10) lgkmcnt(4)
v_mfma_f32_16x16x32_bf16 v[132:135], a[96:99], a[24:27], v[132:135]
s_cmp_eq_u32 s3, 6
s_cselect_b32 s35, 6, 30
s_lshl_b32 s35, s35, 12
v_mfma_f32_16x16x32_bf16 v[148:151], a[96:99], a[28:31], v[148:151]
ds_read_b128 a[128:131], v6 offset:40960
v_mfma_f32_16x16x32_bf16 v[152:155], a[100:103], a[28:31], v[152:155]
buffer_load_dwordx4 a[16:19], v4, s[40:43], s35 offen offset:0 sc1
v_mfma_f32_16x16x32_bf16 v[136:139], a[100:103], a[24:27], v[136:139]
ds_read_b128 a[132:135], v6 offset:41984
v_mfma_f32_16x16x32_bf16 v[140:143], a[104:107], a[24:27], v[140:143]
ds_read_b128 a[136:139], v6 offset:43008
v_mfma_f32_16x16x32_bf16 v[156:159], a[104:107], a[28:31], v[156:159]
ds_read_b128 a[140:143], v6 offset:44032
v_mfma_f32_16x16x32_bf16 v[160:163], a[108:111], a[28:31], v[160:163]
buffer_load_dwordx4 a[20:23], v4, s[40:43], s35 offen offset:1024 sc1
v_mfma_f32_16x16x32_bf16 v[144:147], a[108:111], a[24:27], v[144:147]
s_waitcnt vmcnt(10) lgkmcnt(4)
v_mfma_f32_16x16x32_bf16 v[132:135], a[112:115], a[32:35], v[132:135]
s_cmp_eq_u32 s3, 7
s_cselect_b32 s35, 7, 31
s_lshl_b32 s35, s35, 12
v_mfma_f32_16x16x32_bf16 v[148:151], a[112:115], a[36:39], v[148:151]
ds_read_b128 a[96:99], v6 offset:45056
v_mfma_f32_16x16x32_bf16 v[152:155], a[116:119], a[36:39], v[152:155]
buffer_load_dwordx4 a[24:27], v4, s[40:43], s35 offen offset:0 sc1
v_mfma_f32_16x16x32_bf16 v[136:139], a[116:119], a[32:35], v[136:139]
ds_read_b128 a[100:103], v6 offset:46080
v_mfma_f32_16x16x32_bf16 v[140:143], a[120:123], a[32:35], v[140:143]
ds_read_b128 a[104:107], v6 offset:47104
v_mfma_f32_16x16x32_bf16 v[156:159], a[120:123], a[36:39], v[156:159]
ds_read_b128 a[108:111], v6 offset:48128
v_mfma_f32_16x16x32_bf16 v[160:163], a[124:127], a[36:39], v[160:163]
buffer_load_dwordx4 a[28:31], v4, s[40:43], s35 offen offset:1024 sc1
v_mfma_f32_16x16x32_bf16 v[144:147], a[124:127], a[32:35], v[144:147]
s_waitcnt vmcnt(10) lgkmcnt(4)
v_mfma_f32_16x16x32_bf16 v[132:135], a[128:131], a[40:43], v[132:135]
s_add_u32 m0, s18, 0x0
s_add_u32 s44, s50, 0x1400000
v_mfma_f32_16x16x32_bf16 v[148:151], a[128:131], a[44:47], v[148:151]
ds_read_b128 a[112:115], v6 offset:49152
v_mfma_f32_16x16x32_bf16 v[152:155], a[132:135], a[44:47], v[152:155]
buffer_load_dwordx4 v1, s[4:7], s44 offen offset:0 sc1 lds
v_mfma_f32_16x16x32_bf16 v[136:139], a[132:135], a[40:43], v[136:139]
ds_read_b128 a[116:119], v6 offset:50176
v_mfma_f32_16x16x32_bf16 v[140:143], a[136:139], a[40:43], v[140:143]
ds_read_b128 a[120:123], v6 offset:51200
v_mfma_f32_16x16x32_bf16 v[156:159], a[136:139], a[44:47], v[156:159]
ds_read_b128 a[124:127], v6 offset:52224
v_mfma_f32_16x16x32_bf16 v[160:163], a[140:143], a[44:47], v[160:163]
buffer_load_dwordx4 v1, s[4:7], s44 offen offset:1024 sc1 lds
v_mfma_f32_16x16x32_bf16 v[144:147], a[140:143], a[40:43], v[144:147]
s_waitcnt vmcnt(10) lgkmcnt(4)
v_mfma_f32_16x16x32_bf16 v[132:135], a[96:99], a[48:51], v[132:135]
ds_read_b128 a[128:131], v6 offset:53248
v_mfma_f32_16x16x32_bf16 v[148:151], a[96:99], a[52:55], v[148:151]
ds_read_b128 a[132:135], v6 offset:54272
v_mfma_f32_16x16x32_bf16 v[152:155], a[100:103], a[52:55], v[152:155]
ds_read_b128 a[136:139], v6 offset:55296
v_mfma_f32_16x16x32_bf16 v[136:139], a[100:103], a[48:51], v[136:139]
ds_read_b128 a[140:143], v6 offset:56320
v_mfma_f32_16x16x32_bf16 v[140:143], a[104:107], a[48:51], v[140:143]
buffer_load_dwordx4 v1, s[4:7], s44 offen offset:2048 sc1 lds
s_add_u32 m0, s18, 0x3000
v_mfma_f32_16x16x32_bf16 v[156:159], a[104:107], a[52:55], v[156:159]
s_add_u32 s44, s50, 0x1403000
v_mfma_f32_16x16x32_bf16 v[160:163], a[108:111], a[52:55], v[160:163]
v_mfma_f32_16x16x32_bf16 v[144:147], a[108:111], a[48:51], v[144:147]
s_waitcnt vmcnt(9) lgkmcnt(4)
v_mfma_f32_16x16x32_bf16 v[132:135], a[112:115], a[0:3], v[132:135]
ds_read_b128 a[96:99], v6 offset:57344
v_mfma_f32_16x16x32_bf16 v[148:151], a[112:115], a[4:7], v[148:151]
ds_read_b128 a[100:103], v6 offset:58368
v_mfma_f32_16x16x32_bf16 v[152:155], a[116:119], a[4:7], v[152:155]
ds_read_b128 a[104:107], v6 offset:59392
v_mfma_f32_16x16x32_bf16 v[136:139], a[116:119], a[0:3], v[136:139]
buffer_load_dwordx4 v1, s[4:7], s44 offen offset:0 sc1 lds
v_mfma_f32_16x16x32_bf16 v[140:143], a[120:123], a[0:3], v[140:143]
ds_read_b128 a[108:111], v6 offset:60416
v_mfma_f32_16x16x32_bf16 v[156:159], a[120:123], a[4:7], v[156:159]
v_mfma_f32_16x16x32_bf16 v[160:163], a[124:127], a[4:7], v[160:163]
v_mfma_f32_16x16x32_bf16 v[144:147], a[124:127], a[0:3], v[144:147]
s_waitcnt vmcnt(8) lgkmcnt(4)
v_mfma_f32_16x16x32_bf16 v[132:135], a[128:131], a[8:11], v[132:135]
ds_read_b128 a[112:115], v6 offset:61440
v_mfma_f32_16x16x32_bf16 v[148:151], a[128:131], a[12:15], v[148:151]
buffer_load_dwordx4 v1, s[4:7], s44 offen offset:1024 sc1 lds
v_mfma_f32_16x16x32_bf16 v[152:155], a[132:135], a[12:15], v[152:155]
ds_read_b128 a[116:119], v6 offset:62464
v_mfma_f32_16x16x32_bf16 v[136:139], a[132:135], a[8:11], v[136:139]
ds_read_b128 a[120:123], v6 offset:63488
v_mfma_f32_16x16x32_bf16 v[140:143], a[136:139], a[8:11], v[140:143]
ds_read_b128 a[124:127], v6 offset:64512
v_mfma_f32_16x16x32_bf16 v[156:159], a[136:139], a[12:15], v[156:159]
v_mfma_f32_16x16x32_bf16 v[160:163], a[140:143], a[12:15], v[160:163]
v_mfma_f32_16x16x32_bf16 v[144:147], a[140:143], a[8:11], v[144:147]
buffer_load_dwordx4 v1, s[4:7], s44 offen offset:2048 sc1 lds
s_waitcnt vmcnt(8) lgkmcnt(4)
v_mfma_f32_16x16x32_bf16 v[132:135], a[96:99], a[16:19], v[132:135]
v_mfma_f32_16x16x32_bf16 v[148:151], a[96:99], a[20:23], v[148:151]
v_mfma_f32_16x16x32_bf16 v[152:155], a[100:103], a[20:23], v[152:155]
v_mfma_f32_16x16x32_bf16 v[136:139], a[100:103], a[16:19], v[136:139]
v_mfma_f32_16x16x32_bf16 v[140:143], a[104:107], a[16:19], v[140:143]
v_mfma_f32_16x16x32_bf16 v[156:159], a[104:107], a[20:23], v[156:159]
v_mfma_f32_16x16x32_bf16 v[160:163], a[108:111], a[20:23], v[160:163]
v_mfma_f32_16x16x32_bf16 v[144:147], a[108:111], a[16:19], v[144:147]
s_waitcnt vmcnt(6) lgkmcnt(0)
v_mfma_f32_16x16x32_bf16 v[132:135], a[112:115], a[24:27], v[132:135]
v_mfma_f32_16x16x32_bf16 v[148:151], a[112:115], a[28:31], v[148:151]
v_mfma_f32_16x16x32_bf16 v[152:155], a[116:119], a[28:31], v[152:155]
buffer_atomic_add v12, v10, s[4:7], s92 offen sc1
v_mfma_f32_16x16x32_bf16 v[136:139], a[116:119], a[24:27], v[136:139]
v_mfma_f32_16x16x32_bf16 v[140:143], a[120:123], a[24:27], v[140:143]
v_mfma_f32_16x16x32_bf16 v[156:159], a[120:123], a[28:31], v[156:159]
v_mfma_f32_16x16x32_bf16 v[160:163], a[124:127], a[28:31], v[160:163]
v_mfma_f32_16x16x32_bf16 v[144:147], a[124:127], a[24:27], v[144:147]
s_nop 0
v_cmp_u_f32 vcc, v132, v148
s_nop 0
s_and_b32 vcc_lo, vcc_lo, s95
s_cbranch_scc1 L_k2redo2
s_lshl_b32 s36, s32, 13
v_cvt_pk_bf16_f32 v32, v132, v133
v_cvt_pk_bf16_f32 v33, v134, v135
v_cvt_pk_bf16_f32 v34, v136, v137
v_cvt_pk_bf16_f32 v35, v138, v139
s_add_u32 s36, s36, 0x2200000
buffer_store_dwordx4 v[32:35], v4, s[4:7], s36 offen offset:0 sc1
v_cvt_pk_bf16_f32 v40, v148, v149
v_cvt_pk_bf16_f32 v41, v150, v151
v_cvt_pk_bf16_f32 v42, v152, v153
v_cvt_pk_bf16_f32 v43, v154, v155
v_cvt_pk_bf16_f32 v36, v140, v141
v_cvt_pk_bf16_f32 v37, v142, v143
v_cvt_pk_bf16_f32 v38, v144, v145
v_cvt_pk_bf16_f32 v39, v146, v147
s_add_u32 s37, s36, 4096
v_cvt_pk_bf16_f32 v44, v156, v157
v_cvt_pk_bf16_f32 v45, v158, v159
v_cvt_pk_bf16_f32 v46, v160, v161
buffer_store_dwordx4 v[40:43], v4, s[4:7], s36 offen offset:1024 sc1
v_cvt_pk_bf16_f32 v47, v162, v163
v_mfma_f32_16x16x32_bf16 v[96:99], v[32:35], v[32:35], 0
s_mov_b32 s38, 0x2c0000
s_add_u32 s92, s78, 0x60000
v_mfma_f32_16x16x32_bf16 v[92:95], v[16:19], v[32:35], 0
s_add_u32 s93, s79, 0x60000
s_add_u32 s40, s4, 0x2200000
v_mfma_f32_16x16x32_bf16 v[96:99], v[36:39], v[36:39], v[96:99]
s_addc_u32 s41, s5, 0
buffer_store_dwordx4 v[36:39], v4, s[4:7], s37 offen offset:0 sc1
v_mfma_f32_16x16x32_bf16 v[92:95], v[16:19], v[36:39], v[92:95]
s_nop 4
v_cndmask_b32 v96, v96, v97, s[46:47]
v_cndmask_b32 v98, v98, v99, s[46:47]
v_mfma_f32_16x16x32_bf16 v[104:107], v[40:43], v[40:43], 0
v_mfma_f32_16x16x32_bf16 v[100:103], v[16:19], v[40:43], 0
v_cndmask_b32 v93, v96, v98, s[48:49]
buffer_store_dwordx4 v[44:47], v4, s[4:7], s37 offen offset:1024 sc1
v_mfma_f32_16x16x32_bf16 v[104:107], v[44:47], v[44:47], v[104:107]
v_mfma_f32_16x16x32_bf16 v[100:103], v[16:19], v[44:47], v[100:103]
s_nop 6
v_cndmask_b32 v104, v104, v105, s[46:47]
v_cndmask_b32 v106, v106, v107, s[46:47]
buffer_store_dwordx2 v[92:93], v253, s[4:7], s38 offen offset:0 sc1
v_cndmask_b32 v101, v104, v106, s[48:49]
buffer_store_dwordx2 v[100:101], v253, s[4:7], s38 offen offset:2048 sc1
s_barrier
s_add_u32 m0, s18, 0x6000
s_add_u32 s44, s50, 0x1406000
buffer_load_dwordx4 v1, s[4:7], s44 offen offset:0 sc1 lds
buffer_load_dwordx4 v1, s[4:7], s44 offen offset:1024 sc1 lds
buffer_load_dwordx4 v1, s[4:7], s44 offen offset:2048 sc1 lds
s_add_u32 m0, s18, 0x9000
s_add_u32 s44, s50, 0x1409000
buffer_load_dwordx4 v1, s[4:7], s44 offen offset:0 sc1 lds
buffer_load_dwordx4 v1, s[4:7], s44 offen offset:1024 sc1 lds
buffer_load_dwordx4 v1, s[4:7], s44 offen offset:2048 sc1 lds
v_accvgpr_read_b32 v48, a216
v_accvgpr_read_b32 v49, a217
v_accvgpr_read_b32 v50, a218
v_accvgpr_read_b32 v51, a219
v_accvgpr_read_b32 v52, a220
v_accvgpr_read_b32 v53, a221
v_accvgpr_read_b32 v54, a222
v_accvgpr_read_b32 v55, a223
v_accvgpr_read_b32 v56, a224
v_accvgpr_read_b32 v57, a225
v_accvgpr_read_b32 v58, a226
v_accvgpr_read_b32 v59, a227
v_accvgpr_read_b32 v60, a228
v_accvgpr_read_b32 v61, a229
v_accvgpr_read_b32 v62, a230
v_accvgpr_read_b32 v63, a231
v_accvgpr_read_b32 v64, a232
v_accvgpr_read_b32 v65, a233
v_accvgpr_read_b32 v66, a234
v_accvgpr_read_b32 v67, a235
v_accvgpr_read_b32 v68, a236
v_accvgpr_read_b32 v69, a237
v_accvgpr_read_b32 v70, a238
v_accvgpr_read_b32 v71, a239
s_waitcnt vmcnt(6)
s_barrier
s_cmp_lg_u32 s28, 1
s_cbranch_scc1 Lsg_34
buffer_atomic_add v12, v10, s[4:7], s92 offen sc1
Lsg_34:
s_mov_b64 exec, 0
s_cmp_eq_u32 s28, 1
s_cbranch_scc1 L_stub15
L_wret6:
s_mov_b64 exec, -1
s_cmp_lt_u32 s28, 2
s_cbranch_scc1 Lwd_35
s_add_u32 m0, s18, 0xa800
s_add_u32 s44, s50, 0x140a800
buffer_load_dwordx4 v1, s[4:7], s44 offen offset:0 sc1 lds
buffer_load_dwordx4 v1, s[4:7], s44 offen offset:1024 sc1 lds
buffer_load_dwordx4 v1, s[4:7], s44 offen offset:2048 sc1 lds
s_add_u32 m0, s18, 0xc000
s_add_u32 s44, s50, 0x140c000
buffer_load_dwordx4 v1, s[4:7], s44 offen offset:0 sc1 lds
buffer_load_dwordx4 v1, s[4:7], s44 offen offset:1024 sc1 lds
buffer_load_dwordx4 v1, s[4:7], s44 offen offset:2048 sc1 lds
s_add_u32 m0, s18, 0xd800
s_add_u32 s44, s50, 0x140d800
buffer_load_dwordx4 v1, s[4:7], s44 offen offset:0 sc1 lds
buffer_load_dwordx4 v1, s[4:7], s44 offen offset:1024 sc1 lds
buffer_load_dwordx4 v1, s[4:7], s44 offen offset:2048 sc1 lds
s_add_u32 m0, s18, 0xf000
s_add_u32 s44, s50, 0x140f000
buffer_load_dwordx4 v1, s[4:7], s44 offen offset:0 sc1 lds
buffer_load_dwordx4 v1, s[4:7], s44 offen offset:1024 sc1 lds
buffer_load_dwordx4 v1, s[4:7], s44 offen offset:2048 sc1 lds
s_add_u32 m0, s18, 0x10800
s_add_u32 s44, s50, 0x1410800
buffer_load_dwordx4 v1, s[4:7], s44 offen offset:0 sc1 lds
buffer_load_dwordx4 v1, s[4:7], s44 offen offset:1024 sc1 lds
buffer_load_dwordx4 v1, s[4:7], s44 offen offset:2048 sc1 lds
s_add_u32 m0, s18, 0x12000
s_add_u32 s44, s50, 0x1412000
buffer_load_dwordx4 v1, s[4:7], s44 offen offset:0 sc1 lds
buffer_load_dwordx4 v1, s[4:7], s44 offen offset:1024 sc1 lds
buffer_load_dwordx4 v1, s[4:7], s44 offen offset:2048 sc1 lds
s_add_u32 m0, s18, 0x13800
s_add_u32 s44, s50, 0x1413800
buffer_load_dwordx4 v1, s[4:7], s44 offen offset:0 sc1 lds
buffer_load_dwordx4 v1, s[4:7], s44 offen offset:1024 sc1 lds
buffer_load_dwordx4 v1, s[4:7], s44 offen offset:2048 sc1 lds
s_add_u32 m0, s18, 0x15000
s_add_u32 s44, s50, 0x1415000
buffer_load_dwordx4 v1, s[4:7], s44 offen offset:0 sc1 lds
buffer_load_dwordx4 v1, s[4:7], s44 offen offset:1024 sc1 lds
buffer_load_dwordx4 v1, s[4:7], s44 offen offset:2048 sc1 lds
s_add_u32 m0, s18, 0x16800
s_add_u32 s44, s50, 0x1416800
buffer_load_dwordx4 v1, s[4:7], s44 offen offset:0 sc1 lds
buffer_load_dwordx4 v1, s[4:7], s44 offen offset:1024 sc1 lds
buffer_load_dwordx4 v1, s[4:7], s44 offen offset:2048 sc1 lds
s_add_u32 m0, s18, 0x18000
s_add_u32 s44, s50, 0x1418000
buffer_load_dwordx4 v1, s[4:7], s44 offen offset:0 sc1 lds
buffer_load_dwordx4 v1, s[4:7], s44 offen offset:1024 sc1 lds
buffer_load_dwordx4 v1, s[4:7], s44 offen offset:2048 sc1 lds
s_add_u32 m0, s18, 0x19800
s_add_u32 s44, s50, 0x1419800
buffer_load_dwordx4 v1, s[4:7], s44 offen offset:0 sc1 lds
buffer_load_dwordx4 v1, s[4:7], s44 offen offset:1024 sc1 lds
buffer_load_dwordx4 v1, s[4:7], s44 offen offset:2048 sc1 lds
s_add_u32 m0, s18, 0x1b000
s_add_u32 s44, s50, 0x141b000
buffer_load_dwordx4 v1, s[4:7], s44 offen offset:0 sc1 lds
buffer_load_dwordx4 v1, s[4:7], s44 offen offset:1024 sc1 lds
buffer_load_dwordx4 v1, s[4:7], s44 offen offset:2048 sc1 lds
Lwd_35:
s_cmp_lg_u32 s28, 0
s_cbranch_scc1 Lpo_38
s_add_u32 s36, s67, 0x60000
s_mov_b32 s37, 0
v_mov_b32 v11, 0
buffer_atomic_add v11, v251, s[4:7], s36 offen sc0 sc1
s_sleep 4
Lpoll_36:
v_mov_b32 v234, 0
buffer_atomic_add v234, v251, s[4:7], s36 offen sc0 sc1
s_waitcnt vmcnt(1)
v_readfirstlane_b32 s38, v11
s_nop 0
s_cmp_ge_u32 s38, 32
s_cbranch_scc1 Lpe_37
v_mov_b32 v11, 0
buffer_atomic_add v11, v251, s[4:7], s36 offen sc0 sc1
s_waitcnt vmcnt(1)
v_readfirstlane_b32 s38, v234
s_nop 0
s_cmp_ge_u32 s38, 32
s_cbranch_scc1 Lpe_37
s_add_u32 s37, s37, 1
s_cmp_lt_u32 s37, 0x80000
s_cbranch_scc1 Lpoll_36
s_waitcnt vmcnt(0)
Lpo_38:
s_waitcnt vmcnt(36) lgkmcnt(0)
s_cmp_ge_u32 s28, 2
s_cbranch_scc1 Lw_39
s_waitcnt vmcnt(0)
Lw_39:
Lpe_37:
s_barrier
s_add_u32 s9, s66, 0x30080
s_mov_b32 s35, 0
s_mov_b32 s33, 0x1000
buffer_load_dwordx4 a[0:3], v2, s[40:43], s35 offen offset:0 sc1
buffer_load_dwordx4 a[4:7], v2, s[40:43], s33 offen offset:0 sc1
buffer_load_dwordx4 a[8:11], v2, s[40:43], s35 offen offset:1024 sc1
buffer_load_dwordx4 a[12:15], v2, s[40:43], s33 offen offset:1024 sc1
buffer_load_dwordx4 a[16:19], v2, s[40:43], s35 offen offset:2048 sc1
buffer_load_dwordx4 a[20:23], v2, s[40:43], s33 offen offset:2048 sc1
buffer_load_dwordx4 a[24:27], v2, s[40:43], s35 offen offset:3072 sc1
buffer_load_dwordx4 a[28:31], v2, s[40:43], s33 offen offset:3072 sc1
s_add_u32 s35, s35, 8192
s_add_u32 s33, s33, 8192
buffer_load_dwordx4 a[32:35], v2, s[40:43], s35 offen offset:0 sc1
buffer_load_dwordx4 a[36:39], v2, s[40:43], s33 offen offset:0 sc1
buffer_load_dwordx4 a[40:43], v2, s[40:43], s35 offen offset:1024 sc1
buffer_load_dwordx4 a[44:47], v2, s[40:43], s33 offen offset:1024 sc1
buffer_load_dwordx4 a[48:51], v2, s[40:43], s35 offen offset:2048 sc1
buffer_load_dwordx4 a[52:55], v2, s[40:43], s33 offen offset:2048 sc1
buffer_load_dwordx4 a[56:59], v2, s[40:43], s35 offen offset:3072 sc1
buffer_load_dwordx4 a[60:63], v2, s[40:43], s33 offen offset:3072 sc1
s_add_u32 s35, s35, 8192
s_add_u32 s33, s33, 8192
v_add_u32 v5, 0, v1
ds_read_b128 a[96:99], v5 offset:2048
ds_read_b128 a[100:103], v5 offset:8192
ds_read_b128 a[104:107], v5 offset:3072
ds_read_b128 a[108:111], v5 offset:9216
ds_read_b128 a[112:115], v5 offset:4096
ds_read_b128 a[116:119], v5 offset:10240
s_waitcnt vmcnt(14) lgkmcnt(4)
v_mfma_f32_16x16x32_bf16 v[140:143], a[96:99], a[0:3], 0
s_add_u32 m0, s18, 0x1e000
s_add_u32 s44, s50, 0x141e000
v_mfma_f32_16x16x32_bf16 v[140:143], a[100:103], a[4:7], v[140:143]
buffer_load_dwordx4 a[64:67], v2, s[40:43], s35 offen offset:0 sc1
s_waitcnt vmcnt(13)
v_mfma_f32_16x16x32_bf16 v[164:167], a[100:103], a[12:15], 0
ds_read_b128 a[128:131], v5 offset:5120
v_mfma_f32_16x16x32_bf16 v[164:167], a[96:99], a[8:11], v[164:167]
ds_read_b128 a[132:135], v5 offset:11264
s_waitcnt vmcnt(12)
v_mfma_f32_16x16x32_bf16 v[188:191], a[96:99], a[16:19], 0
s_waitcnt vmcnt(11)
v_mfma_f32_16x16x32_bf16 v[188:191], a[100:103], a[20:23], v[188:191]
buffer_load_dwordx4 a[68:71], v2, s[40:43], s33 offen offset:0 sc1
s_waitcnt vmcnt(10)
v_mfma_f32_16x16x32_bf16 v[212:215], a[100:103], a[28:31], 0
ds_read_b128 a[136:139], v5 offset:0
v_mfma_f32_16x16x32_bf16 v[212:215], a[96:99], a[24:27], v[212:215]
s_waitcnt lgkmcnt(6)
v_mfma_f32_16x16x32_bf16 v[216:219], a[104:107], a[24:27], 0
ds_read_b128 a[140:143], v5 offset:6144
s_waitcnt lgkmcnt(6)
v_mfma_f32_16x16x32_bf16 v[216:219], a[108:111], a[28:31], v[216:219]
v_mfma_f32_16x16x32_bf16 v[192:195], a[108:111], a[20:23], 0
buffer_load_dwordx4 v1, s[4:7], s44 offen offset:0 sc1 lds
v_mfma_f32_16x16x32_bf16 v[192:195], a[104:107], a[16:19], v[192:195]
ds_read_b128 a[144:147], v5 offset:1024
v_mfma_f32_16x16x32_bf16 v[168:171], a[104:107], a[8:11], 0
v_mfma_f32_16x16x32_bf16 v[168:171], a[108:111], a[12:15], v[168:171]
ds_read_b128 a[148:151], v5 offset:7168
v_mfma_f32_16x16x32_bf16 v[144:147], a[108:111], a[4:7], 0
v_mfma_f32_16x16x32_bf16 v[144:147], a[104:107], a[0:3], v[144:147]
buffer_load_dwordx4 a[72:75], v2, s[40:43], s35 offen offset:1024 sc1
s_waitcnt lgkmcnt(7)
v_mfma_f32_16x16x32_bf16 v[148:151], a[112:115], a[0:3], 0
s_waitcnt lgkmcnt(6)
v_mfma_f32_16x16x32_bf16 v[148:151], a[116:119], a[4:7], v[148:151]
v_mfma_f32_16x16x32_bf16 v[172:175], a[116:119], a[12:15], 0
v_mfma_f32_16x16x32_bf16 v[172:175], a[112:115], a[8:11], v[172:175]
v_mfma_f32_16x16x32_bf16 v[196:199], a[112:115], a[16:19], 0
buffer_load_dwordx4 a[76:79], v2, s[40:43], s33 offen offset:1024 sc1
v_mfma_f32_16x16x32_bf16 v[196:199], a[116:119], a[20:23], v[196:199]
v_mfma_f32_16x16x32_bf16 v[220:223], a[116:119], a[28:31], 0
v_mfma_f32_16x16x32_bf16 v[220:223], a[112:115], a[24:27], v[220:223]
s_waitcnt lgkmcnt(0)
v_mfma_f32_16x16x32_bf16 v[224:227], a[128:131], a[24:27], 0
ds_read_b128 a[96:99], v5 offset:14336
v_mfma_f32_16x16x32_bf16 v[224:227], a[132:135], a[28:31], v[224:227]
buffer_load_dwordx4 a[80:83], v2, s[40:43], s35 offen offset:2048 sc1
v_mfma_f32_16x16x32_bf16 v[200:203], a[132:135], a[20:23], 0
ds_read_b128 a[100:103], v5 offset:20480
v_mfma_f32_16x16x32_bf16 v[200:203], a[128:131], a[16:19], v[200:203]
v_mfma_f32_16x16x32_bf16 v[176:179], a[128:131], a[8:11], 0
v_mfma_f32_16x16x32_bf16 v[176:179], a[132:135], a[12:15], v[176:179]
buffer_load_dwordx4 a[84:87], v2, s[40:43], s33 offen offset:2048 sc1
v_mfma_f32_16x16x32_bf16 v[152:155], a[132:135], a[4:7], 0
ds_read_b128 a[104:107], v5 offset:15360
v_mfma_f32_16x16x32_bf16 v[152:155], a[128:131], a[0:3], v[152:155]
v_mfma_f32_16x16x32_bf16 v[132:135], a[136:139], a[0:3], 0
ds_read_b128 a[108:111], v5 offset:21504
v_mfma_f32_16x16x32_bf16 v[132:135], a[140:143], a[4:7], v[132:135]
v_mfma_f32_16x16x32_bf16 v[156:159], a[140:143], a[12:15], 0
buffer_load_dwordx4 v1, s[4:7], s44 offen offset:1024 sc1 lds
v_mfma_f32_16x16x32_bf16 v[156:159], a[136:139], a[8:11], v[156:159]
ds_read_b128 a[112:115], v5 offset:16384
v_mfma_f32_16x16x32_bf16 v[180:183], a[136:139], a[16:19], 0
v_mfma_f32_16x16x32_bf16 v[180:183], a[140:143], a[20:23], v[180:183]
ds_read_b128 a[116:119], v5 offset:22528
v_mfma_f32_16x16x32_bf16 v[204:207], a[140:143], a[28:31], 0
v_mfma_f32_16x16x32_bf16 v[204:207], a[136:139], a[24:27], v[204:207]
buffer_load_dwordx4 a[88:91], v2, s[40:43], s35 offen offset:3072 sc1
v_mfma_f32_16x16x32_bf16 v[208:211], a[144:147], a[24:27], 0
v_mfma_f32_16x16x32_bf16 v[208:211], a[148:151], a[28:31], v[208:211]
v_mfma_f32_16x16x32_bf16 v[184:187], a[148:151], a[20:23], 0
v_mfma_f32_16x16x32_bf16 v[184:187], a[144:147], a[16:19], v[184:187]
v_mfma_f32_16x16x32_bf16 v[160:163], a[144:147], a[8:11], 0
L_stub15:
s_cbranch_execz L_stub16
buffer_load_dwordx4 a[92:95], v2, s[40:43], s33 offen offset:3072 sc1
s_add_u32 s35, s35, 8192
v_mfma_f32_16x16x32_bf16 v[160:163], a[148:151], a[12:15], v[160:163]
s_add_u32 s33, s33, 8192
v_mfma_f32_16x16x32_bf16 v[136:139], a[148:151], a[4:7], 0
v_mfma_f32_16x16x32_bf16 v[136:139], a[144:147], a[0:3], v[136:139]
s_waitcnt vmcnt(10) lgkmcnt(0)
v_mfma_f32_16x16x32_bf16 v[140:143], a[96:99], a[32:35], v[140:143]
ds_read_b128 a[128:131], v5 offset:17408
v_mfma_f32_16x16x32_bf16 v[140:143], a[100:103], a[36:39], v[140:143]
buffer_load_dwordx4 a[0:3], v2, s[40:43], s35 offen offset:0 sc1
v_mfma_f32_16x16x32_bf16 v[164:167], a[100:103], a[44:47], v[164:167]
ds_read_b128 a[132:135], v5 offset:23552
v_mfma_f32_16x16x32_bf16 v[164:167], a[96:99], a[40:43], v[164:167]
v_mfma_f32_16x16x32_bf16 v[188:191], a[96:99], a[48:51], v[188:191]
v_mfma_f32_16x16x32_bf16 v[188:191], a[100:103], a[52:55], v[188:191]
buffer_load_dwordx4 a[4:7], v2, s[40:43], s33 offen offset:0 sc1
v_mfma_f32_16x16x32_bf16 v[212:215], a[100:103], a[60:63], v[212:215]
ds_read_b128 a[136:139], v5 offset:12288
v_mfma_f32_16x16x32_bf16 v[212:215], a[96:99], a[56:59], v[212:215]
v_mfma_f32_16x16x32_bf16 v[216:219], a[104:107], a[56:59], v[216:219]
ds_read_b128 a[140:143], v5 offset:18432
v_mfma_f32_16x16x32_bf16 v[216:219], a[108:111], a[60:63], v[216:219]
v_mfma_f32_16x16x32_bf16 v[192:195], a[108:111], a[52:55], v[192:195]
buffer_load_dwordx4 v1, s[4:7], s44 offen offset:2048 sc1 lds
s_add_u32 m0, s18, 0x21000
v_mfma_f32_16x16x32_bf16 v[192:195], a[104:107], a[48:51], v[192:195]
s_add_u32 s44, s50, 0x1421000
ds_read_b128 a[144:147], v5 offset:13312
v_mfma_f32_16x16x32_bf16 v[168:171], a[104:107], a[40:43], v[168:171]
v_mfma_f32_16x16x32_bf16 v[168:171], a[108:111], a[44:47], v[168:171]
ds_read_b128 a[148:151], v5 offset:19456
v_mfma_f32_16x16x32_bf16 v[144:147], a[108:111], a[36:39], v[144:147]
v_mfma_f32_16x16x32_bf16 v[144:147], a[104:107], a[32:35], v[144:147]
buffer_load_dwordx4 a[8:11], v2, s[40:43], s35 offen offset:1024 sc1
v_mfma_f32_16x16x32_bf16 v[148:151], a[112:115], a[32:35], v[148:151]
v_mfma_f32_16x16x32_bf16 v[148:151], a[116:119], a[36:39], v[148:151]
v_mfma_f32_16x16x32_bf16 v[172:175], a[116:119], a[44:47], v[172:175]
v_mfma_f32_16x16x32_bf16 v[172:175], a[112:115], a[40:43], v[172:175]
v_mfma_f32_16x16x32_bf16 v[196:199], a[112:115], a[48:51], v[196:199]
buffer_load_dwordx4 a[12:15], v2, s[40:43], s33 offen offset:1024 sc1
v_mfma_f32_16x16x32_bf16 v[196:199], a[116:119], a[52:55], v[196:199]
v_mfma_f32_16x16x32_bf16 v[220:223], a[116:119], a[60:63], v[220:223]
v_mfma_f32_16x16x32_bf16 v[220:223], a[112:115], a[56:59], v[220:223]
s_waitcnt lgkmcnt(0)
v_mfma_f32_16x16x32_bf16 v[224:227], a[128:131], a[56:59], v[224:227]
ds_read_b128 a[96:99], v5 offset:26624
v_mfma_f32_16x16x32_bf16 v[224:227], a[132:135], a[60:63], v[224:227]
buffer_load_dwordx4 a[16:19], v2, s[40:43], s35 offen offset:2048 sc1
v_mfma_f32_16x16x32_bf16 v[200:203], a[132:135], a[52:55], v[200:203]
ds_read_b128 a[100:103], v5 offset:32768
v_mfma_f32_16x16x32_bf16 v[200:203], a[128:131], a[48:51], v[200:203]
v_mfma_f32_16x16x32_bf16 v[176:179], a[128:131], a[40:43], v[176:179]
v_mfma_f32_16x16x32_bf16 v[176:179], a[132:135], a[44:47], v[176:179]
buffer_load_dwordx4 a[20:23], v2, s[40:43], s33 offen offset:2048 sc1
v_mfma_f32_16x16x32_bf16 v[152:155], a[132:135], a[36:39], v[152:155]
ds_read_b128 a[104:107], v5 offset:27648
v_mfma_f32_16x16x32_bf16 v[152:155], a[128:131], a[32:35], v[152:155]
v_mfma_f32_16x16x32_bf16 v[132:135], a[136:139], a[32:35], v[132:135]
ds_read_b128 a[108:111], v5 offset:33792
v_mfma_f32_16x16x32_bf16 v[132:135], a[140:143], a[36:39], v[132:135]
v_mfma_f32_16x16x32_bf16 v[156:159], a[140:143], a[44:47], v[156:159]
buffer_load_dwordx4 v1, s[4:7], s44 offen offset:0 sc1 lds
v_mfma_f32_16x16x32_bf16 v[156:159], a[136:139], a[40:43], v[156:159]
ds_read_b128 a[112:115], v5 offset:28672
v_mfma_f32_16x16x32_bf16 v[180:183], a[136:139], a[48:51], v[180:183]
v_mfma_f32_16x16x32_bf16 v[180:183], a[140:143], a[52:55], v[180:183]
ds_read_b128 a[116:119], v5 offset:34816
v_mfma_f32_16x16x32_bf16 v[204:207], a[140:143], a[60:63], v[204:207]
v_mfma_f32_16x16x32_bf16 v[204:207], a[136:139], a[56:59], v[204:207]
buffer_load_dwordx4 a[24:27], v2, s[40:43], s35 offen offset:3072 sc1
v_mfma_f32_16x16x32_bf16 v[208:211], a[144:147], a[56:59], v[208:211]
v_mfma_f32_16x16x32_bf16 v[208:211], a[148:151], a[60:63], v[208:211]
v_mfma_f32_16x16x32_bf16 v[184:187], a[148:151], a[52:55], v[184:187]
v_mfma_f32_16x16x32_bf16 v[184:187], a[144:147], a[48:51], v[184:187]
v_mfma_f32_16x16x32_bf16 v[160:163], a[144:147], a[40:43], v[160:163]
buffer_load_dwordx4 a[28:31], v2, s[40:43], s33 offen offset:3072 sc1
s_add_u32 s35, s35, 8192
v_mfma_f32_16x16x32_bf16 v[160:163], a[148:151], a[44:47], v[160:163]
s_add_u32 s33, s33, 8192
v_mfma_f32_16x16x32_bf16 v[136:139], a[148:151], a[36:39], v[136:139]
v_mfma_f32_16x16x32_bf16 v[136:139], a[144:147], a[32:35], v[136:139]
s_waitcnt vmcnt(10) lgkmcnt(0)
v_mfma_f32_16x16x32_bf16 v[140:143], a[96:99], a[64:67], v[140:143]
ds_read_b128 a[128:131], v5 offset:29696
v_mfma_f32_16x16x32_bf16 v[140:143], a[100:103], a[68:71], v[140:143]
buffer_load_dwordx4 a[32:35], v2, s[40:43], s35 offen offset:0 sc1
v_mfma_f32_16x16x32_bf16 v[164:167], a[100:103], a[76:79], v[164:167]
ds_read_b128 a[132:135], v5 offset:35840
v_mfma_f32_16x16x32_bf16 v[164:167], a[96:99], a[72:75], v[164:167]
v_mfma_f32_16x16x32_bf16 v[188:191], a[96:99], a[80:83], v[188:191]
v_mfma_f32_16x16x32_bf16 v[188:191], a[100:103], a[84:87], v[188:191]
buffer_load_dwordx4 a[36:39], v2, s[40:43], s33 offen offset:0 sc1
v_mfma_f32_16x16x32_bf16 v[212:215], a[100:103], a[92:95], v[212:215]
ds_read_b128 a[136:139], v5 offset:24576
v_mfma_f32_16x16x32_bf16 v[212:215], a[96:99], a[88:91], v[212:215]
v_mfma_f32_16x16x32_bf16 v[216:219], a[104:107], a[88:91], v[216:219]
ds_read_b128 a[140:143], v5 offset:30720
v_mfma_f32_16x16x32_bf16 v[216:219], a[108:111], a[92:95], v[216:219]
v_mfma_f32_16x16x32_bf16 v[192:195], a[108:111], a[84:87], v[192:195]
buffer_load_dwordx4 v1, s[4:7], s44 offen offset:1024 sc1 lds
v_mfma_f32_16x16x32_bf16 v[192:195], a[104:107], a[80:83], v[192:195]
ds_read_b128 a[144:147], v5 offset:25600
v_mfma_f32_16x16x32_bf16 v[168:171], a[104:107], a[72:75], v[168:171]
v_mfma_f32_16x16x32_bf16 v[168:171], a[108:111], a[76:79], v[168:171]
ds_read_b128 a[148:151], v5 offset:31744
v_mfma_f32_16x16x32_bf16 v[144:147], a[108:111], a[68:71], v[144:147]
v_mfma_f32_16x16x32_bf16 v[144:147], a[104:107], a[64:67], v[144:147]
buffer_load_dwordx4 a[40:43], v2, s[40:43], s35 offen offset:1024 sc1
v_mfma_f32_16x16x32_bf16 v[148:151], a[112:115], a[64:67], v[148:151]
v_mfma_f32_16x16x32_bf16 v[148:151], a[116:119], a[68:71], v[148:151]
v_mfma_f32_16x16x32_bf16 v[172:175], a[116:119], a[76:79], v[172:175]
v_mfma_f32_16x16x32_bf16 v[172:175], a[112:115], a[72:75], v[172:175]
v_mfma_f32_16x16x32_bf16 v[196:199], a[112:115], a[80:83], v[196:199]
buffer_load_dwordx4 a[44:47], v2, s[40:43], s33 offen offset:1024 sc1
v_mfma_f32_16x16x32_bf16 v[196:199], a[116:119], a[84:87], v[196:199]
v_mfma_f32_16x16x32_bf16 v[220:223], a[116:119], a[92:95], v[220:223]
v_mfma_f32_16x16x32_bf16 v[220:223], a[112:115], a[88:91], v[220:223]
s_waitcnt lgkmcnt(0)
v_mfma_f32_16x16x32_bf16 v[224:227], a[128:131], a[88:91], v[224:227]
ds_read_b128 a[96:99], v5 offset:38912
v_mfma_f32_16x16x32_bf16 v[224:227], a[132:135], a[92:95], v[224:227]
buffer_load_dwordx4 a[48:51], v2, s[40:43], s35 offen offset:2048 sc1
v_mfma_f32_16x16x32_bf16 v[200:203], a[132:135], a[84:87], v[200:203]
ds_read_b128 a[100:103], v5 offset:45056
v_mfma_f32_16x16x32_bf16 v[200:203], a[128:131], a[80:83], v[200:203]
v_mfma_f32_16x16x32_bf16 v[176:179], a[128:131], a[72:75], v[176:179]
v_mfma_f32_16x16x32_bf16 v[176:179], a[132:135], a[76:79], v[176:179]
buffer_load_dwordx4 v1, s[4:7], s44 offen offset:2048 sc1 lds
s_add_u32 s88, s82, 0x2c0000
v_mfma_f32_16x16x32_bf16 v[152:155], a[132:135], a[68:71], v[152:155]
ds_read_b128 a[104:107], v5 offset:39936
v_mfma_f32_16x16x32_bf16 v[152:155], a[128:131], a[64:67], v[152:155]
v_mfma_f32_16x16x32_bf16 v[132:135], a[136:139], a[64:67], v[132:135]
ds_read_b128 a[108:111], v5 offset:46080
v_mfma_f32_16x16x32_bf16 v[132:135], a[140:143], a[68:71], v[132:135]
buffer_load_dwordx4 a[52:55], v2, s[40:43], s33 offen offset:2048 sc1
v_mfma_f32_16x16x32_bf16 v[156:159], a[140:143], a[76:79], v[156:159]
ds_read_b128 a[112:115], v5 offset:40960
v_mfma_f32_16x16x32_bf16 v[156:159], a[136:139], a[72:75], v[156:159]
v_mfma_f32_16x16x32_bf16 v[180:183], a[136:139], a[80:83], v[180:183]
v_mfma_f32_16x16x32_bf16 v[180:183], a[140:143], a[84:87], v[180:183]
buffer_load_dwordx4 a[56:59], v2, s[40:43], s35 offen offset:3072 sc1
v_mfma_f32_16x16x32_bf16 v[204:207], a[140:143], a[92:95], v[204:207]
ds_read_b128 a[116:119], v5 offset:47104
v_mfma_f32_16x16x32_bf16 v[204:207], a[136:139], a[88:91], v[204:207]
v_mfma_f32_16x16x32_bf16 v[208:211], a[144:147], a[88:91], v[208:211]
v_mfma_f32_16x16x32_bf16 v[208:211], a[148:151], a[92:95], v[208:211]
buffer_load_dwordx4 v[92:95], v1, s[4:7], s88 offen offset:0 sc1
v_mfma_f32_16x16x32_bf16 v[184:187], a[148:151], a[84:87], v[184:187]
v_mfma_f32_16x16x32_bf16 v[184:187], a[144:147], a[80:83], v[184:187]
v_mfma_f32_16x16x32_bf16 v[160:163], a[144:147], a[72:75], v[160:163]
v_mfma_f32_16x16x32_bf16 v[160:163], a[148:151], a[76:79], v[160:163]
buffer_load_dwordx4 a[60:63], v2, s[40:43], s33 offen offset:3072 sc1
s_add_u32 s35, s35, 8192
v_mfma_f32_16x16x32_bf16 v[136:139], a[148:151], a[68:71], v[136:139]
s_add_u32 s33, s33, 8192
v_mfma_f32_16x16x32_bf16 v[136:139], a[144:147], a[64:67], v[136:139]
s_waitcnt vmcnt(11) lgkmcnt(0)
v_mfma_f32_16x16x32_bf16 v[140:143], a[96:99], a[0:3], v[140:143]
ds_read_b128 a[128:131], v5 offset:41984
v_mfma_f32_16x16x32_bf16 v[140:143], a[100:103], a[4:7], v[140:143]
buffer_load_dwordx4 a[64:67], v2, s[40:43], s35 offen offset:0 sc1
v_mfma_f32_16x16x32_bf16 v[164:167], a[100:103], a[12:15], v[164:167]
ds_read_b128 a[132:135], v5 offset:48128
v_mfma_f32_16x16x32_bf16 v[164:167], a[96:99], a[8:11], v[164:167]
v_mfma_f32_16x16x32_bf16 v[188:191], a[96:99], a[16:19], v[188:191]
v_mfma_f32_16x16x32_bf16 v[188:191], a[100:103], a[20:23], v[188:191]
buffer_load_dwordx4 a[68:71], v2, s[40:43], s33 offen offset:0 sc1
v_mfma_f32_16x16x32_bf16 v[212:215], a[100:103], a[28:31], v[212:215]
ds_read_b128 a[136:139], v5 offset:36864
v_mfma_f32_16x16x32_bf16 v[212:215], a[96:99], a[24:27], v[212:215]
v_mfma_f32_16x16x32_bf16 v[216:219], a[104:107], a[24:27], v[216:219]
ds_read_b128 a[140:143], v5 offset:43008
v_mfma_f32_16x16x32_bf16 v[216:219], a[108:111], a[28:31], v[216:219]
v_mfma_f32_16x16x32_bf16 v[192:195], a[108:111], a[20:23], v[192:195]
buffer_load_dwordx4 v[96:99], v1, s[4:7], s88 offen offset:1024 sc1
v_mfma_f32_16x16x32_bf16 v[192:195], a[104:107], a[16:19], v[192:195]
ds_read_b128 a[144:147], v5 offset:37888
v_mfma_f32_16x16x32_bf16 v[168:171], a[104:107], a[8:11], v[168:171]
v_mfma_f32_16x16x32_bf16 v[168:171], a[108:111], a[12:15], v[168:171]
ds_read_b128 a[148:151], v5 offset:44032
v_mfma_f32_16x16x32_bf16 v[144:147], a[108:111], a[4:7], v[144:147]
v_mfma_f32_16x16x32_bf16 v[144:147], a[104:107], a[0:3], v[144:147]
buffer_load_dwordx4 a[72:75], v2, s[40:43], s35 offen offset:1024 sc1
v_mfma_f32_16x16x32_bf16 v[148:151], a[112:115], a[0:3], v[148:151]
v_mfma_f32_16x16x32_bf16 v[148:151], a[116:119], a[4:7], v[148:151]
v_mfma_f32_16x16x32_bf16 v[172:175], a[116:119], a[12:15], v[172:175]
v_mfma_f32_16x16x32_bf16 v[172:175], a[112:115], a[8:11], v[172:175]
v_mfma_f32_16x16x32_bf16 v[196:199], a[112:115], a[16:19], v[196:199]
buffer_load_dwordx4 a[76:79], v2, s[40:43], s33 offen offset:1024 sc1
v_mfma_f32_16x16x32_bf16 v[196:199], a[116:119], a[20:23], v[196:199]
v_mfma_f32_16x16x32_bf16 v[220:223], a[116:119], a[28:31], v[220:223]
v_mfma_f32_16x16x32_bf16 v[220:223], a[112:115], a[24:27], v[220:223]
s_waitcnt lgkmcnt(0)
s_barrier
v_mfma_f32_16x16x32_bf16 v[224:227], a[128:131], a[24:27], v[224:227]
v_add_u32 v5, 49152, v1
v_mfma_f32_16x16x32_bf16 v[224:227], a[132:135], a[28:31], v[224:227]
buffer_load_dwordx4 a[80:83], v2, s[40:43], s35 offen offset:2048 sc1
v_mfma_f32_16x16x32_bf16 v[200:203], a[132:135], a[20:23], v[200:203]
ds_read_b128 a[96:99], v5 offset:2048
v_mfma_f32_16x16x32_bf16 v[200:203], a[128:131], a[16:19], v[200:203]
ds_read_b128 a[100:103], v5 offset:8192
v_mfma_f32_16x16x32_bf16 v[176:179], a[128:131], a[8:11], v[176:179]
v_mfma_f32_16x16x32_bf16 v[176:179], a[132:135], a[12:15], v[176:179]
buffer_load_dwordx4 a[84:87], v2, s[40:43], s33 offen offset:2048 sc1
v_mfma_f32_16x16x32_bf16 v[152:155], a[132:135], a[4:7], v[152:155]
ds_read_b128 a[104:107], v5 offset:3072
v_mfma_f32_16x16x32_bf16 v[152:155], a[128:131], a[0:3], v[152:155]
v_mfma_f32_16x16x32_bf16 v[132:135], a[136:139], a[0:3], v[132:135]
ds_read_b128 a[108:111], v5 offset:9216
v_mfma_f32_16x16x32_bf16 v[132:135], a[140:143], a[4:7], v[132:135]
v_mfma_f32_16x16x32_bf16 v[156:159], a[140:143], a[12:15], v[156:159]
buffer_load_dwordx4 v[100:103], v1, s[4:7], s88 offen offset:2048 sc1
v_mfma_f32_16x16x32_bf16 v[156:159], a[136:139], a[8:11], v[156:159]
ds_read_b128 a[112:115], v5 offset:4096
v_mfma_f32_16x16x32_bf16 v[180:183], a[136:139], a[16:19], v[180:183]
v_mfma_f32_16x16x32_bf16 v[180:183], a[140:143], a[20:23], v[180:183]
ds_read_b128 a[116:119], v5 offset:10240
v_mfma_f32_16x16x32_bf16 v[204:207], a[140:143], a[28:31], v[204:207]
v_mfma_f32_16x16x32_bf16 v[204:207], a[136:139], a[24:27], v[204:207]
buffer_load_dwordx4 a[88:91], v2, s[40:43], s35 offen offset:3072 sc1
v_mfma_f32_16x16x32_bf16 v[208:211], a[144:147], a[24:27], v[208:211]
v_mfma_f32_16x16x32_bf16 v[208:211], a[148:151], a[28:31], v[208:211]
v_mfma_f32_16x16x32_bf16 v[184:187], a[148:151], a[20:23], v[184:187]
v_mfma_f32_16x16x32_bf16 v[184:187], a[144:147], a[16:19], v[184:187]
v_mfma_f32_16x16x32_bf16 v[160:163], a[144:147], a[8:11], v[160:163]
buffer_load_dwordx4 a[92:95], v2, s[40:43], s33 offen offset:3072 sc1
s_add_u32 s35, s35, 8192
v_mfma_f32_16x16x32_bf16 v[160:163], a[148:151], a[12:15], v[160:163]
s_add_u32 s33, s33, 8192
v_mfma_f32_16x16x32_bf16 v[136:139], a[148:151], a[4:7], v[136:139]
v_mfma_f32_16x16x32_bf16 v[136:139], a[144:147], a[0:3], v[136:139]
s_waitcnt vmcnt(10) lgkmcnt(0)
v_mfma_f32_16x16x32_bf16 v[140:143], a[96:99], a[32:35], v[140:143]
ds_read_b128 a[128:131], v5 offset:5120
v_mfma_f32_16x16x32_bf16 v[140:143], a[100:103], a[36:39], v[140:143]
buffer_load_dwordx4 a[0:3], v2, s[40:43], s35 offen offset:0 sc1
v_mfma_f32_16x16x32_bf16 v[164:167], a[100:103], a[44:47], v[164:167]
ds_read_b128 a[132:135], v5 offset:11264
v_mfma_f32_16x16x32_bf16 v[164:167], a[96:99], a[40:43], v[164:167]
v_mfma_f32_16x16x32_bf16 v[188:191], a[96:99], a[48:51], v[188:191]
v_mfma_f32_16x16x32_bf16 v[188:191], a[100:103], a[52:55], v[188:191]
buffer_load_dwordx4 a[4:7], v2, s[40:43], s33 offen offset:0 sc1
v_mfma_f32_16x16x32_bf16 v[212:215], a[100:103], a[60:63], v[212:215]
ds_read_b128 a[136:139], v5 offset:0
v_mfma_f32_16x16x32_bf16 v[212:215], a[96:99], a[56:59], v[212:215]
v_mfma_f32_16x16x32_bf16 v[216:219], a[104:107], a[56:59], v[216:219]
ds_read_b128 a[140:143], v5 offset:6144
v_mfma_f32_16x16x32_bf16 v[216:219], a[108:111], a[60:63], v[216:219]
v_mfma_f32_16x16x32_bf16 v[192:195], a[108:111], a[52:55], v[192:195]
buffer_load_dwordx4 v[104:107], v1, s[4:7], s88 offen offset:3072 sc1
s_add_u32 s88, s88, 4096
v_mfma_f32_16x16x32_bf16 v[192:195], a[104:107], a[48:51], v[192:195]
ds_read_b128 a[144:147], v5 offset:1024
v_mfma_f32_16x16x32_bf16 v[168:171], a[104:107], a[40:43], v[168:171]
v_mfma_f32_16x16x32_bf16 v[168:171], a[108:111], a[44:47], v[168:171]
ds_read_b128 a[148:151], v5 offset:7168
v_mfma_f32_16x16x32_bf16 v[144:147], a[108:111], a[36:39], v[144:147]
v_mfma_f32_16x16x32_bf16 v[144:147], a[104:107], a[32:35], v[144:147]
buffer_load_dwordx4 a[8:11], v2, s[40:43], s35 offen offset:1024 sc1
v_mfma_f32_16x16x32_bf16 v[148:151], a[112:115], a[32:35], v[148:151]
v_mfma_f32_16x16x32_bf16 v[148:151], a[116:119], a[36:39], v[148:151]
v_mfma_f32_16x16x32_bf16 v[172:175], a[116:119], a[44:47], v[172:175]
v_mfma_f32_16x16x32_bf16 v[172:175], a[112:115], a[40:43], v[172:175]
v_mfma_f32_16x16x32_bf16 v[196:199], a[112:115], a[48:51], v[196:199]
buffer_load_dwordx4 a[12:15], v2, s[40:43], s33 offen offset:1024 sc1
v_mfma_f32_16x16x32_bf16 v[196:199], a[116:119], a[52:55], v[196:199]
v_mfma_f32_16x16x32_bf16 v[220:223], a[116:119], a[60:63], v[220:223]
v_mfma_f32_16x16x32_bf16 v[220:223], a[112:115], a[56:59], v[220:223]
s_waitcnt lgkmcnt(0)
v_mfma_f32_16x16x32_bf16 v[224:227], a[128:131], a[56:59], v[224:227]
ds_read_b128 a[96:99], v5 offset:14336
v_mfma_f32_16x16x32_bf16 v[224:227], a[132:135], a[60:63], v[224:227]
buffer_load_dwordx4 a[16:19], v2, s[40:43], s35 offen offset:2048 sc1
v_mfma_f32_16x16x32_bf16 v[200:203], a[132:135], a[52:55], v[200:203]
ds_read_b128 a[100:103], v5 offset:20480
v_mfma_f32_16x16x32_bf16 v[200:203], a[128:131], a[48:51], v[200:203]
v_mfma_f32_16x16x32_bf16 v[176:179], a[128:131], a[40:43], v[176:179]
v_mfma_f32_16x16x32_bf16 v[176:179], a[132:135], a[44:47], v[176:179]
buffer_load_dwordx4 a[20:23], v2, s[40:43], s33 offen offset:2048 sc1
v_mfma_f32_16x16x32_bf16 v[152:155], a[132:135], a[36:39], v[152:155]
ds_read_b128 a[104:107], v5 offset:15360
v_mfma_f32_16x16x32_bf16 v[152:155], a[128:131], a[32:35], v[152:155]
v_mfma_f32_16x16x32_bf16 v[132:135], a[136:139], a[32:35], v[132:135]
ds_read_b128 a[108:111], v5 offset:21504
v_mfma_f32_16x16x32_bf16 v[132:135], a[140:143], a[36:39], v[132:135]
v_mfma_f32_16x16x32_bf16 v[156:159], a[140:143], a[44:47], v[156:159]
buffer_load_dwordx4 v[108:111], v1, s[4:7], s88 offen offset:0 sc1
v_mfma_f32_16x16x32_bf16 v[156:159], a[136:139], a[40:43], v[156:159]
ds_read_b128 a[112:115], v5 offset:16384
v_mfma_f32_16x16x32_bf16 v[180:183], a[136:139], a[48:51], v[180:183]
v_mfma_f32_16x16x32_bf16 v[180:183], a[140:143], a[52:55], v[180:183]
ds_read_b128 a[116:119], v5 offset:22528
v_mfma_f32_16x16x32_bf16 v[204:207], a[140:143], a[60:63], v[204:207]
v_mfma_f32_16x16x32_bf16 v[204:207], a[136:139], a[56:59], v[204:207]
buffer_load_dwordx4 a[24:27], v2, s[40:43], s35 offen offset:3072 sc1
v_mfma_f32_16x16x32_bf16 v[208:211], a[144:147], a[56:59], v[208:211]
v_mfma_f32_16x16x32_bf16 v[208:211], a[148:151], a[60:63], v[208:211]
v_mfma_f32_16x16x32_bf16 v[184:187], a[148:151], a[52:55], v[184:187]
v_mfma_f32_16x16x32_bf16 v[184:187], a[144:147], a[48:51], v[184:187]
v_mfma_f32_16x16x32_bf16 v[160:163], a[144:147], a[40:43], v[160:163]
buffer_load_dwordx4 a[28:31], v2, s[40:43], s33 offen offset:3072 sc1
s_add_u32 s35, s35, 8192
v_mfma_f32_16x16x32_bf16 v[160:163], a[148:151], a[44:47], v[160:163]
s_add_u32 s33, s33, 8192
v_mfma_f32_16x16x32_bf16 v[136:139], a[148:151], a[36:39], v[136:139]
v_mfma_f32_16x16x32_bf16 v[136:139], a[144:147], a[32:35], v[136:139]
s_waitcnt vmcnt(10) lgkmcnt(0)
v_mfma_f32_16x16x32_bf16 v[140:143], a[96:99], a[64:67], v[140:143]
ds_read_b128 a[128:131], v5 offset:17408
v_mfma_f32_16x16x32_bf16 v[140:143], a[100:103], a[68:71], v[140:143]
buffer_load_dwordx4 a[32:35], v2, s[40:43], s35 offen offset:0 sc1
v_mfma_f32_16x16x32_bf16 v[164:167], a[100:103], a[76:79], v[164:167]
ds_read_b128 a[132:135], v5 offset:23552
v_mfma_f32_16x16x32_bf16 v[164:167], a[96:99], a[72:75], v[164:167]
v_mfma_f32_16x16x32_bf16 v[188:191], a[96:99], a[80:83], v[188:191]
v_mfma_f32_16x16x32_bf16 v[188:191], a[100:103], a[84:87], v[188:191]
buffer_load_dwordx4 a[36:39], v2, s[40:43], s33 offen offset:0 sc1
v_mfma_f32_16x16x32_bf16 v[212:215], a[100:103], a[92:95], v[212:215]
ds_read_b128 a[136:139], v5 offset:12288
v_mfma_f32_16x16x32_bf16 v[212:215], a[96:99], a[88:91], v[212:215]
v_mfma_f32_16x16x32_bf16 v[216:219], a[104:107], a[88:91], v[216:219]
ds_read_b128 a[140:143], v5 offset:18432
v_mfma_f32_16x16x32_bf16 v[216:219], a[108:111], a[92:95], v[216:219]
v_mfma_f32_16x16x32_bf16 v[192:195], a[108:111], a[84:87], v[192:195]
buffer_load_dwordx4 v[112:115], v1, s[4:7], s88 offen offset:1024 sc1
v_mfma_f32_16x16x32_bf16 v[192:195], a[104:107], a[80:83], v[192:195]
ds_read_b128 a[144:147], v5 offset:13312
v_mfma_f32_16x16x32_bf16 v[168:171], a[104:107], a[72:75], v[168:171]
v_mfma_f32_16x16x32_bf16 v[168:171], a[108:111], a[76:79], v[168:171]
ds_read_b128 a[148:151], v5 offset:19456
v_mfma_f32_16x16x32_bf16 v[144:147], a[108:111], a[68:71], v[144:147]
v_mfma_f32_16x16x32_bf16 v[144:147], a[104:107], a[64:67], v[144:147]
buffer_load_dwordx4 a[40:43], v2, s[40:43], s35 offen offset:1024 sc1
v_mfma_f32_16x16x32_bf16 v[148:151], a[112:115], a[64:67], v[148:151]
v_mfma_f32_16x16x32_bf16 v[148:151], a[116:119], a[68:71], v[148:151]
v_mfma_f32_16x16x32_bf16 v[172:175], a[116:119], a[76:79], v[172:175]
v_mfma_f32_16x16x32_bf16 v[172:175], a[112:115], a[72:75], v[172:175]
v_mfma_f32_16x16x32_bf16 v[196:199], a[112:115], a[80:83], v[196:199]
buffer_load_dwordx4 a[44:47], v2, s[40:43], s33 offen offset:1024 sc1
v_mfma_f32_16x16x32_bf16 v[196:199], a[116:119], a[84:87], v[196:199]
v_mfma_f32_16x16x32_bf16 v[220:223], a[116:119], a[92:95], v[220:223]
v_mfma_f32_16x16x32_bf16 v[220:223], a[112:115], a[88:91], v[220:223]
s_waitcnt lgkmcnt(0)
v_mfma_f32_16x16x32_bf16 v[224:227], a[128:131], a[88:91], v[224:227]
ds_read_b128 a[96:99], v5 offset:26624
v_mfma_f32_16x16x32_bf16 v[224:227], a[132:135], a[92:95], v[224:227]
buffer_load_dwordx4 a[48:51], v2, s[40:43], s35 offen offset:2048 sc1
v_mfma_f32_16x16x32_bf16 v[200:203], a[132:135], a[84:87], v[200:203]
ds_read_b128 a[100:103], v5 offset:32768
v_mfma_f32_16x16x32_bf16 v[200:203], a[128:131], a[80:83], v[200:203]
v_mfma_f32_16x16x32_bf16 v[176:179], a[128:131], a[72:75], v[176:179]
v_mfma_f32_16x16x32_bf16 v[176:179], a[132:135], a[76:79], v[176:179]
buffer_load_dwordx4 a[52:55], v2, s[40:43], s33 offen offset:2048 sc1
v_mfma_f32_16x16x32_bf16 v[152:155], a[132:135], a[68:71], v[152:155]
ds_read_b128 a[104:107], v5 offset:27648
v_mfma_f32_16x16x32_bf16 v[152:155], a[128:131], a[64:67], v[152:155]
v_mfma_f32_16x16x32_bf16 v[132:135], a[136:139], a[64:67], v[132:135]
ds_read_b128 a[108:111], v5 offset:33792
v_mfma_f32_16x16x32_bf16 v[132:135], a[140:143], a[68:71], v[132:135]
v_mfma_f32_16x16x32_bf16 v[156:159], a[140:143], a[76:79], v[156:159]
buffer_load_dwordx4 v[116:119], v1, s[4:7], s88 offen offset:2048 sc1
v_mfma_f32_16x16x32_bf16 v[156:159], a[136:139], a[72:75], v[156:159]
ds_read_b128 a[112:115], v5 offset:28672
v_mfma_f32_16x16x32_bf16 v[180:183], a[136:139], a[80:83], v[180:183]
v_mfma_f32_16x16x32_bf16 v[180:183], a[140:143], a[84:87], v[180:183]
ds_read_b128 a[116:119], v5 offset:34816
v_mfma_f32_16x16x32_bf16 v[204:207], a[140:143], a[92:95], v[204:207]
v_mfma_f32_16x16x32_bf16 v[204:207], a[136:139], a[88:91], v[204:207]
buffer_load_dwordx4 a[56:59], v2, s[40:43], s35 offen offset:3072 sc1
v_mfma_f32_16x16x32_bf16 v[208:211], a[144:147], a[88:91], v[208:211]
v_mfma_f32_16x16x32_bf16 v[208:211], a[148:151], a[92:95], v[208:211]
v_mfma_f32_16x16x32_bf16 v[184:187], a[148:151], a[84:87], v[184:187]
v_mfma_f32_16x16x32_bf16 v[184:187], a[144:147], a[80:83], v[184:187]
v_mfma_f32_16x16x32_bf16 v[160:163], a[144:147], a[72:75], v[160:163]
buffer_load_dwordx4 a[60:63], v2, s[40:43], s33 offen offset:3072 sc1
s_add_u32 s35, s35, 8192
v_mfma_f32_16x16x32_bf16 v[160:163], a[148:151], a[76:79], v[160:163]
s_add_u32 s33, s33, 8192
v_mfma_f32_16x16x32_bf16 v[136:139], a[148:151], a[68:71], v[136:139]
v_mfma_f32_16x16x32_bf16 v[136:139], a[144:147], a[64:67], v[136:139]
s_waitcnt vmcnt(10) lgkmcnt(0)
v_mfma_f32_16x16x32_bf16 v[140:143], a[96:99], a[0:3], v[140:143]
ds_read_b128 a[128:131], v5 offset:29696
v_mfma_f32_16x16x32_bf16 v[140:143], a[100:103], a[4:7], v[140:143]
buffer_load_dwordx4 a[64:67], v2, s[40:43], s35 offen offset:0 sc1
v_mfma_f32_16x16x32_bf16 v[164:167], a[100:103], a[12:15], v[164:167]
ds_read_b128 a[132:135], v5 offset:35840
v_mfma_f32_16x16x32_bf16 v[164:167], a[96:99], a[8:11], v[164:167]
v_mfma_f32_16x16x32_bf16 v[188:191], a[96:99], a[16:19], v[188:191]
v_mfma_f32_16x16x32_bf16 v[188:191], a[100:103], a[20:23], v[188:191]
buffer_load_dwordx4 a[68:71], v2, s[40:43], s33 offen offset:0 sc1
v_mfma_f32_16x16x32_bf16 v[212:215], a[100:103], a[28:31], v[212:215]
ds_read_b128 a[136:139], v5 offset:24576
v_mfma_f32_16x16x32_bf16 v[212:215], a[96:99], a[24:27], v[212:215]
v_mfma_f32_16x16x32_bf16 v[216:219], a[104:107], a[24:27], v[216:219]
ds_read_b128 a[140:143], v5 offset:30720
v_mfma_f32_16x16x32_bf16 v[216:219], a[108:111], a[28:31], v[216:219]
v_mfma_f32_16x16x32_bf16 v[192:195], a[108:111], a[20:23], v[192:195]
buffer_load_dwordx4 v[120:123], v1, s[4:7], s88 offen offset:3072 sc1
s_add_u32 m0, s18, 0x0
v_mfma_f32_16x16x32_bf16 v[192:195], a[104:107], a[16:19], v[192:195]
s_add_u32 s44, s50, 0x1424000
ds_read_b128 a[144:147], v5 offset:25600
v_mfma_f32_16x16x32_bf16 v[168:171], a[104:107], a[8:11], v[168:171]
v_mfma_f32_16x16x32_bf16 v[168:171], a[108:111], a[12:15], v[168:171]
ds_read_b128 a[148:151], v5 offset:31744
v_mfma_f32_16x16x32_bf16 v[144:147], a[108:111], a[4:7], v[144:147]
v_mfma_f32_16x16x32_bf16 v[144:147], a[104:107], a[0:3], v[144:147]
buffer_load_dwordx4 a[72:75], v2, s[40:43], s35 offen offset:1024 sc1
v_mfma_f32_16x16x32_bf16 v[148:151], a[112:115], a[0:3], v[148:151]
v_mfma_f32_16x16x32_bf16 v[148:151], a[116:119], a[4:7], v[148:151]
v_mfma_f32_16x16x32_bf16 v[172:175], a[116:119], a[12:15], v[172:175]
v_mfma_f32_16x16x32_bf16 v[172:175], a[112:115], a[8:11], v[172:175]
v_mfma_f32_16x16x32_bf16 v[196:199], a[112:115], a[16:19], v[196:199]
buffer_load_dwordx4 a[76:79], v2, s[40:43], s33 offen offset:1024 sc1
v_mfma_f32_16x16x32_bf16 v[196:199], a[116:119], a[20:23], v[196:199]
v_mfma_f32_16x16x32_bf16 v[220:223], a[116:119], a[28:31], v[220:223]
v_mfma_f32_16x16x32_bf16 v[220:223], a[112:115], a[24:27], v[220:223]
s_waitcnt lgkmcnt(0)
v_mfma_f32_16x16x32_bf16 v[224:227], a[128:131], a[24:27], v[224:227]
ds_read_b128 a[96:99], v5 offset:38912
v_mfma_f32_16x16x32_bf16 v[224:227], a[132:135], a[28:31], v[224:227]
buffer_load_dwordx4 a[80:83], v2, s[40:43], s35 offen offset:2048 sc1
v_mfma_f32_16x16x32_bf16 v[200:203], a[132:135], a[20:23], v[200:203]
ds_read_b128 a[100:103], v5 offset:45056
v_mfma_f32_16x16x32_bf16 v[200:203], a[128:131], a[16:19], v[200:203]
v_mfma_f32_16x16x32_bf16 v[176:179], a[128:131], a[8:11], v[176:179]
v_mfma_f32_16x16x32_bf16 v[176:179], a[132:135], a[12:15], v[176:179]
buffer_load_dwordx4 v1, s[4:7], s44 offen offset:0 sc1 lds
v_mfma_f32_16x16x32_bf16 v[152:155], a[132:135], a[4:7], v[152:155]
ds_read_b128 a[104:107], v5 offset:39936
v_mfma_f32_16x16x32_bf16 v[152:155], a[128:131], a[0:3], v[152:155]
v_mfma_f32_16x16x32_bf16 v[132:135], a[136:139], a[0:3], v[132:135]
ds_read_b128 a[108:111], v5 offset:46080
v_mfma_f32_16x16x32_bf16 v[132:135], a[140:143], a[4:7], v[132:135]
buffer_load_dwordx4 a[84:87], v2, s[40:43], s33 offen offset:2048 sc1
v_mfma_f32_16x16x32_bf16 v[156:159], a[140:143], a[12:15], v[156:159]
ds_read_b128 a[112:115], v5 offset:40960
v_mfma_f32_16x16x32_bf16 v[156:159], a[136:139], a[8:11], v[156:159]
v_mfma_f32_16x16x32_bf16 v[180:183], a[136:139], a[16:19], v[180:183]
v_mfma_f32_16x16x32_bf16 v[180:183], a[140:143], a[20:23], v[180:183]
buffer_load_dwordx4 a[88:91], v2, s[40:43], s35 offen offset:3072 sc1
v_mfma_f32_16x16x32_bf16 v[204:207], a[140:143], a[28:31], v[204:207]
ds_read_b128 a[116:119], v5 offset:47104
v_mfma_f32_16x16x32_bf16 v[204:207], a[136:139], a[24:27], v[204:207]
v_mfma_f32_16x16x32_bf16 v[208:211], a[144:147], a[24:27], v[208:211]
v_mfma_f32_16x16x32_bf16 v[208:211], a[148:151], a[28:31], v[208:211]
buffer_load_dwordx4 v1, s[4:7], s44 offen offset:1024 sc1 lds
v_mfma_f32_16x16x32_bf16 v[184:187], a[148:151], a[20:23], v[184:187]
v_mfma_f32_16x16x32_bf16 v[184:187], a[144:147], a[16:19], v[184:187]
v_mfma_f32_16x16x32_bf16 v[160:163], a[144:147], a[8:11], v[160:163]
v_mfma_f32_16x16x32_bf16 v[160:163], a[148:151], a[12:15], v[160:163]
buffer_load_dwordx4 a[92:95], v2, s[40:43], s33 offen offset:3072 sc1
s_add_u32 s35, s35, 8192
v_mfma_f32_16x16x32_bf16 v[136:139], a[148:151], a[4:7], v[136:139]
s_add_u32 s33, s33, 8192
v_mfma_f32_16x16x32_bf16 v[136:139], a[144:147], a[0:3], v[136:139]
s_waitcnt vmcnt(11) lgkmcnt(0)
v_mfma_f32_16x16x32_bf16 v[140:143], a[96:99], a[32:35], v[140:143]
ds_read_b128 a[128:131], v5 offset:41984
v_mfma_f32_16x16x32_bf16 v[140:143], a[100:103], a[36:39], v[140:143]
buffer_load_dwordx4 a[0:3], v2, s[40:43], s35 offen offset:0 sc1
v_mfma_f32_16x16x32_bf16 v[164:167], a[100:103], a[44:47], v[164:167]
ds_read_b128 a[132:135], v5 offset:48128
v_mfma_f32_16x16x32_bf16 v[164:167], a[96:99], a[40:43], v[164:167]
v_mfma_f32_16x16x32_bf16 v[188:191], a[96:99], a[48:51], v[188:191]
v_mfma_f32_16x16x32_bf16 v[188:191], a[100:103], a[52:55], v[188:191]
buffer_load_dwordx4 a[4:7], v2, s[40:43], s33 offen offset:0 sc1
v_mfma_f32_16x16x32_bf16 v[212:215], a[100:103], a[60:63], v[212:215]
ds_read_b128 a[136:139], v5 offset:36864
v_mfma_f32_16x16x32_bf16 v[212:215], a[96:99], a[56:59], v[212:215]
v_mfma_f32_16x16x32_bf16 v[216:219], a[104:107], a[56:59], v[216:219]
ds_read_b128 a[140:143], v5 offset:43008
v_mfma_f32_16x16x32_bf16 v[216:219], a[108:111], a[60:63], v[216:219]
v_mfma_f32_16x16x32_bf16 v[192:195], a[108:111], a[52:55], v[192:195]
buffer_load_dwordx4 v1, s[4:7], s44 offen offset:2048 sc1 lds
s_add_u32 m0, s18, 0x3000
v_mfma_f32_16x16x32_bf16 v[192:195], a[104:107], a[48:51], v[192:195]
s_add_u32 s44, s50, 0x1427000
ds_read_b128 a[144:147], v5 offset:37888
v_mfma_f32_16x16x32_bf16 v[168:171], a[104:107], a[40:43], v[168:171]
v_mfma_f32_16x16x32_bf16 v[168:171], a[108:111], a[44:47], v[168:171]
ds_read_b128 a[148:151], v5 offset:44032
v_mfma_f32_16x16x32_bf16 v[144:147], a[108:111], a[36:39], v[144:147]
v_mfma_f32_16x16x32_bf16 v[144:147], a[104:107], a[32:35], v[144:147]
buffer_load_dwordx4 a[8:11], v2, s[40:43], s35 offen offset:1024 sc1
v_mfma_f32_16x16x32_bf16 v[148:151], a[112:115], a[32:35], v[148:151]
v_mfma_f32_16x16x32_bf16 v[148:151], a[116:119], a[36:39], v[148:151]
v_mfma_f32_16x16x32_bf16 v[172:175], a[116:119], a[44:47], v[172:175]
v_mfma_f32_16x16x32_bf16 v[172:175], a[112:115], a[40:43], v[172:175]
v_mfma_f32_16x16x32_bf16 v[196:199], a[112:115], a[48:51], v[196:199]
buffer_load_dwordx4 a[12:15], v2, s[40:43], s33 offen offset:1024 sc1
v_mfma_f32_16x16x32_bf16 v[196:199], a[116:119], a[52:55], v[196:199]
v_mfma_f32_16x16x32_bf16 v[220:223], a[116:119], a[60:63], v[220:223]
v_mfma_f32_16x16x32_bf16 v[220:223], a[112:115], a[56:59], v[220:223]
s_waitcnt lgkmcnt(0)
s_barrier
v_mfma_f32_16x16x32_bf16 v[224:227], a[128:131], a[56:59], v[224:227]
v_add_u32 v5, 98304, v1
v_mfma_f32_16x16x32_bf16 v[224:227], a[132:135], a[60:63], v[224:227]
buffer_load_dwordx4 a[16:19], v2, s[40:43], s35 offen offset:2048 sc1
v_mfma_f32_16x16x32_bf16 v[200:203], a[132:135], a[52:55], v[200:203]
ds_read_b128 a[96:99], v5 offset:2048
v_mfma_f32_16x16x32_bf16 v[200:203], a[128:131], a[48:51], v[200:203]
ds_read_b128 a[100:103], v5 offset:8192
v_mfma_f32_16x16x32_bf16 v[176:179], a[128:131], a[40:43], v[176:179]
v_mfma_f32_16x16x32_bf16 v[176:179], a[132:135], a[44:47], v[176:179]
buffer_load_dwordx4 a[20:23], v2, s[40:43], s33 offen offset:2048 sc1
v_mfma_f32_16x16x32_bf16 v[152:155], a[132:135], a[36:39], v[152:155]
ds_read_b128 a[104:107], v5 offset:3072
v_mfma_f32_16x16x32_bf16 v[152:155], a[128:131], a[32:35], v[152:155]
v_mfma_f32_16x16x32_bf16 v[132:135], a[136:139], a[32:35], v[132:135]
ds_read_b128 a[108:111], v5 offset:9216
v_mfma_f32_16x16x32_bf16 v[132:135], a[140:143], a[36:39], v[132:135]
v_mfma_f32_16x16x32_bf16 v[156:159], a[140:143], a[44:47], v[156:159]
buffer_load_dwordx4 v1, s[4:7], s44 offen offset:0 sc1 lds
v_mfma_f32_16x16x32_bf16 v[156:159], a[136:139], a[40:43], v[156:159]
L_stub16:
s_cbranch_execz L_stub17
ds_read_b128 a[112:115], v5 offset:4096
v_mfma_f32_16x16x32_bf16 v[180:183], a[136:139], a[48:51], v[180:183]
v_mfma_f32_16x16x32_bf16 v[180:183], a[140:143], a[52:55], v[180:183]
ds_read_b128 a[116:119], v5 offset:10240
v_mfma_f32_16x16x32_bf16 v[204:207], a[140:143], a[60:63], v[204:207]
v_mfma_f32_16x16x32_bf16 v[204:207], a[136:139], a[56:59], v[204:207]
buffer_load_dwordx4 a[24:27], v2, s[40:43], s35 offen offset:3072 sc1
v_mfma_f32_16x16x32_bf16 v[208:211], a[144:147], a[56:59], v[208:211]
v_mfma_f32_16x16x32_bf16 v[208:211], a[148:151], a[60:63], v[208:211]
v_mfma_f32_16x16x32_bf16 v[184:187], a[148:151], a[52:55], v[184:187]
v_mfma_f32_16x16x32_bf16 v[184:187], a[144:147], a[48:51], v[184:187]
v_mfma_f32_16x16x32_bf16 v[160:163], a[144:147], a[40:43], v[160:163]
buffer_load_dwordx4 a[28:31], v2, s[40:43], s33 offen offset:3072 sc1
s_add_u32 s35, s35, 8192
v_mfma_f32_16x16x32_bf16 v[160:163], a[148:151], a[44:47], v[160:163]
s_add_u32 s33, s33, 8192
v_mfma_f32_16x16x32_bf16 v[136:139], a[148:151], a[36:39], v[136:139]
v_mfma_f32_16x16x32_bf16 v[136:139], a[144:147], a[32:35], v[136:139]
s_waitcnt vmcnt(10) lgkmcnt(0)
v_mfma_f32_16x16x32_bf16 v[140:143], a[96:99], a[64:67], v[140:143]
ds_read_b128 a[128:131], v5 offset:5120
v_mfma_f32_16x16x32_bf16 v[140:143], a[100:103], a[68:71], v[140:143]
buffer_load_dwordx4 a[32:35], v2, s[40:43], s35 offen offset:0 sc1
v_mfma_f32_16x16x32_bf16 v[164:167], a[100:103], a[76:79], v[164:167]
ds_read_b128 a[132:135], v5 offset:11264
v_mfma_f32_16x16x32_bf16 v[164:167], a[96:99], a[72:75], v[164:167]
v_mfma_f32_16x16x32_bf16 v[188:191], a[96:99], a[80:83], v[188:191]
v_mfma_f32_16x16x32_bf16 v[188:191], a[100:103], a[84:87], v[188:191]
buffer_load_dwordx4 a[36:39], v2, s[40:43], s33 offen offset:0 sc1
v_mfma_f32_16x16x32_bf16 v[212:215], a[100:103], a[92:95], v[212:215]
ds_read_b128 a[136:139], v5 offset:0
v_mfma_f32_16x16x32_bf16 v[212:215], a[96:99], a[88:91], v[212:215]
v_mfma_f32_16x16x32_bf16 v[216:219], a[104:107], a[88:91], v[216:219]
ds_read_b128 a[140:143], v5 offset:6144
v_mfma_f32_16x16x32_bf16 v[216:219], a[108:111], a[92:95], v[216:219]
v_mfma_f32_16x16x32_bf16 v[192:195], a[108:111], a[84:87], v[192:195]
buffer_load_dwordx4 v1, s[4:7], s44 offen offset:1024 sc1 lds
v_mfma_f32_16x16x32_bf16 v[192:195], a[104:107], a[80:83], v[192:195]
ds_read_b128 a[144:147], v5 offset:1024
v_mfma_f32_16x16x32_bf16 v[168:171], a[104:107], a[72:75], v[168:171]
v_mfma_f32_16x16x32_bf16 v[168:171], a[108:111], a[76:79], v[168:171]
ds_read_b128 a[148:151], v5 offset:7168
v_mfma_f32_16x16x32_bf16 v[144:147], a[108:111], a[68:71], v[144:147]
v_mfma_f32_16x16x32_bf16 v[144:147], a[104:107], a[64:67], v[144:147]
buffer_load_dwordx4 a[40:43], v2, s[40:43], s35 offen offset:1024 sc1
v_mfma_f32_16x16x32_bf16 v[148:151], a[112:115], a[64:67], v[148:151]
v_mfma_f32_16x16x32_bf16 v[148:151], a[116:119], a[68:71], v[148:151]
v_mfma_f32_16x16x32_bf16 v[172:175], a[116:119], a[76:79], v[172:175]
v_mfma_f32_16x16x32_bf16 v[172:175], a[112:115], a[72:75], v[172:175]
v_mfma_f32_16x16x32_bf16 v[196:199], a[112:115], a[80:83], v[196:199]
buffer_load_dwordx4 a[44:47], v2, s[40:43], s33 offen offset:1024 sc1
v_mfma_f32_16x16x32_bf16 v[196:199], a[116:119], a[84:87], v[196:199]
v_mfma_f32_16x16x32_bf16 v[220:223], a[116:119], a[92:95], v[220:223]
v_mfma_f32_16x16x32_bf16 v[220:223], a[112:115], a[88:91], v[220:223]
s_waitcnt lgkmcnt(0)
v_mfma_f32_16x16x32_bf16 v[224:227], a[128:131], a[88:91], v[224:227]
ds_read_b128 a[96:99], v5 offset:14336
v_mfma_f32_16x16x32_bf16 v[224:227], a[132:135], a[92:95], v[224:227]
buffer_load_dwordx4 a[48:51], v2, s[40:43], s35 offen offset:2048 sc1
v_mfma_f32_16x16x32_bf16 v[200:203], a[132:135], a[84:87], v[200:203]
ds_read_b128 a[100:103], v5 offset:20480
v_mfma_f32_16x16x32_bf16 v[200:203], a[128:131], a[80:83], v[200:203]
v_mfma_f32_16x16x32_bf16 v[176:179], a[128:131], a[72:75], v[176:179]
v_mfma_f32_16x16x32_bf16 v[176:179], a[132:135], a[76:79], v[176:179]
buffer_load_dwordx4 a[52:55], v2, s[40:43], s33 offen offset:2048 sc1
v_mfma_f32_16x16x32_bf16 v[152:155], a[132:135], a[68:71], v[152:155]
ds_read_b128 a[104:107], v5 offset:15360
v_mfma_f32_16x16x32_bf16 v[152:155], a[128:131], a[64:67], v[152:155]
v_mfma_f32_16x16x32_bf16 v[132:135], a[136:139], a[64:67], v[132:135]
ds_read_b128 a[108:111], v5 offset:21504
v_mfma_f32_16x16x32_bf16 v[132:135], a[140:143], a[68:71], v[132:135]
v_mfma_f32_16x16x32_bf16 v[156:159], a[140:143], a[76:79], v[156:159]
buffer_load_dwordx4 v1, s[4:7], s44 offen offset:2048 sc1 lds
s_add_u32 m0, s18, 0x6000
v_mfma_f32_16x16x32_bf16 v[156:159], a[136:139], a[72:75], v[156:159]
s_add_u32 s44, s50, 0x142a000
ds_read_b128 a[112:115], v5 offset:16384
v_mfma_f32_16x16x32_bf16 v[180:183], a[136:139], a[80:83], v[180:183]
v_mfma_f32_16x16x32_bf16 v[180:183], a[140:143], a[84:87], v[180:183]
ds_read_b128 a[116:119], v5 offset:22528
v_mfma_f32_16x16x32_bf16 v[204:207], a[140:143], a[92:95], v[204:207]
v_mfma_f32_16x16x32_bf16 v[204:207], a[136:139], a[88:91], v[204:207]
buffer_load_dwordx4 a[56:59], v2, s[40:43], s35 offen offset:3072 sc1
v_mfma_f32_16x16x32_bf16 v[208:211], a[144:147], a[88:91], v[208:211]
v_mfma_f32_16x16x32_bf16 v[208:211], a[148:151], a[92:95], v[208:211]
v_mfma_f32_16x16x32_bf16 v[184:187], a[148:151], a[84:87], v[184:187]
v_mfma_f32_16x16x32_bf16 v[184:187], a[144:147], a[80:83], v[184:187]
v_mfma_f32_16x16x32_bf16 v[160:163], a[144:147], a[72:75], v[160:163]
buffer_load_dwordx4 a[60:63], v2, s[40:43], s33 offen offset:3072 sc1
s_add_u32 s35, s35, 8192
v_mfma_f32_16x16x32_bf16 v[160:163], a[148:151], a[76:79], v[160:163]
s_add_u32 s33, s33, 8192
v_mfma_f32_16x16x32_bf16 v[136:139], a[148:151], a[68:71], v[136:139]
v_mfma_f32_16x16x32_bf16 v[136:139], a[144:147], a[64:67], v[136:139]
s_waitcnt vmcnt(10) lgkmcnt(0)
v_mfma_f32_16x16x32_bf16 v[140:143], a[96:99], a[0:3], v[140:143]
ds_read_b128 a[128:131], v5 offset:17408
v_add_f32 v92, v92, v96
v_mfma_f32_16x16x32_bf16 v[140:143], a[100:103], a[4:7], v[140:143]
buffer_load_dwordx4 a[64:67], v2, s[40:43], s35 offen offset:0 sc1
v_mfma_f32_16x16x32_bf16 v[164:167], a[100:103], a[12:15], v[164:167]
ds_read_b128 a[132:135], v5 offset:23552
v_add_f32 v100, v100, v104
v_mfma_f32_16x16x32_bf16 v[164:167], a[96:99], a[8:11], v[164:167]
v_add_f32 v108, v108, v112
v_add_f32 v116, v116, v120
v_mfma_f32_16x16x32_bf16 v[188:191], a[96:99], a[16:19], v[188:191]
v_add_f32 v93, v93, v97
v_add_f32 v101, v101, v105
v_mfma_f32_16x16x32_bf16 v[188:191], a[100:103], a[20:23], v[188:191]
buffer_load_dwordx4 a[68:71], v2, s[40:43], s33 offen offset:0 sc1
v_mfma_f32_16x16x32_bf16 v[212:215], a[100:103], a[28:31], v[212:215]
ds_read_b128 a[136:139], v5 offset:12288
v_add_f32 v109, v109, v113
v_mfma_f32_16x16x32_bf16 v[212:215], a[96:99], a[24:27], v[212:215]
v_add_f32 v117, v117, v121
v_add_f32 v94, v94, v98
v_mfma_f32_16x16x32_bf16 v[216:219], a[104:107], a[24:27], v[216:219]
ds_read_b128 a[140:143], v5 offset:18432
v_add_f32 v102, v102, v106
v_mfma_f32_16x16x32_bf16 v[216:219], a[108:111], a[28:31], v[216:219]
v_add_f32 v110, v110, v114
v_mfma_f32_16x16x32_bf16 v[192:195], a[108:111], a[20:23], v[192:195]
buffer_load_dwordx4 v1, s[4:7], s44 offen offset:0 sc1 lds
v_mfma_f32_16x16x32_bf16 v[192:195], a[104:107], a[16:19], v[192:195]
ds_read_b128 a[144:147], v5 offset:13312
v_add_f32 v118, v118, v122
v_mfma_f32_16x16x32_bf16 v[168:171], a[104:107], a[8:11], v[168:171]
v_add_f32 v95, v95, v99
v_add_f32 v103, v103, v107
v_mfma_f32_16x16x32_bf16 v[168:171], a[108:111], a[12:15], v[168:171]
ds_read_b128 a[148:151], v5 offset:19456
v_add_f32 v111, v111, v115
v_mfma_f32_16x16x32_bf16 v[144:147], a[108:111], a[4:7], v[144:147]
v_add_f32 v119, v119, v123
v_mfma_f32_16x16x32_bf16 v[144:147], a[104:107], a[0:3], v[144:147]
buffer_load_dwordx4 a[72:75], v2, s[40:43], s35 offen offset:1024 sc1
v_mfma_f32_16x16x32_bf16 v[148:151], a[112:115], a[0:3], v[148:151]
v_add_f32_dpp v92, v92, v92 row_ror:8 row_mask:0xf bank_mask:0xf
v_add_f32_dpp v100, v100, v100 row_ror:8 row_mask:0xf bank_mask:0xf
v_mfma_f32_16x16x32_bf16 v[148:151], a[116:119], a[4:7], v[148:151]
v_add_f32_dpp v108, v108, v108 row_ror:8 row_mask:0xf bank_mask:0xf
v_mfma_f32_16x16x32_bf16 v[172:175], a[116:119], a[12:15], v[172:175]
v_add_f32_dpp v116, v116, v116 row_ror:8 row_mask:0xf bank_mask:0xf
v_mfma_f32_16x16x32_bf16 v[172:175], a[112:115], a[8:11], v[172:175]
v_add_f32_dpp v93, v93, v93 row_ror:8 row_mask:0xf bank_mask:0xf
v_mfma_f32_16x16x32_bf16 v[196:199], a[112:115], a[16:19], v[196:199]
buffer_load_dwordx4 a[76:79], v2, s[40:43], s33 offen offset:1024 sc1
v_mfma_f32_16x16x32_bf16 v[196:199], a[116:119], a[20:23], v[196:199]
v_add_f32_dpp v101, v101, v101 row_ror:8 row_mask:0xf bank_mask:0xf
v_add_f32_dpp v109, v109, v109 row_ror:8 row_mask:0xf bank_mask:0xf
v_mfma_f32_16x16x32_bf16 v[220:223], a[116:119], a[28:31], v[220:223]
v_add_f32_dpp v117, v117, v117 row_ror:8 row_mask:0xf bank_mask:0xf
v_mfma_f32_16x16x32_bf16 v[220:223], a[112:115], a[24:27], v[220:223]
v_add_f32_dpp v92, v94, v94 row_ror:8 row_mask:0xf bank_mask:0xc
s_waitcnt lgkmcnt(0)
v_mfma_f32_16x16x32_bf16 v[224:227], a[128:131], a[24:27], v[224:227]
ds_read_b128 a[96:99], v5 offset:26624
v_add_f32_dpp v100, v102, v102 row_ror:8 row_mask:0xf bank_mask:0xc
v_mfma_f32_16x16x32_bf16 v[224:227], a[132:135], a[28:31], v[224:227]
buffer_load_dwordx4 a[80:83], v2, s[40:43], s35 offen offset:2048 sc1
v_mfma_f32_16x16x32_bf16 v[200:203], a[132:135], a[20:23], v[200:203]
ds_read_b128 a[100:103], v5 offset:32768
v_add_f32_dpp v108, v110, v110 row_ror:8 row_mask:0xf bank_mask:0xc
v_mfma_f32_16x16x32_bf16 v[200:203], a[128:131], a[16:19], v[200:203]
v_add_f32_dpp v116, v118, v118 row_ror:8 row_mask:0xf bank_mask:0xc
v_add_f32_dpp v93, v95, v95 row_ror:8 row_mask:0xf bank_mask:0xc
v_mfma_f32_16x16x32_bf16 v[176:179], a[128:131], a[8:11], v[176:179]
v_add_f32_dpp v101, v103, v103 row_ror:8 row_mask:0xf bank_mask:0xc
v_add_f32_dpp v109, v111, v111 row_ror:8 row_mask:0xf bank_mask:0xc
v_mfma_f32_16x16x32_bf16 v[176:179], a[132:135], a[12:15], v[176:179]
buffer_load_dwordx4 a[84:87], v2, s[40:43], s33 offen offset:2048 sc1
v_mfma_f32_16x16x32_bf16 v[152:155], a[132:135], a[4:7], v[152:155]
ds_read_b128 a[104:107], v5 offset:27648
v_add_f32_dpp v117, v119, v119 row_ror:8 row_mask:0xf bank_mask:0xc
v_mfma_f32_16x16x32_bf16 v[152:155], a[128:131], a[0:3], v[152:155]
v_permlane32_swap_b32 v92, v93
v_mfma_f32_16x16x32_bf16 v[132:135], a[136:139], a[0:3], v[132:135]
ds_read_b128 a[108:111], v5 offset:33792
v_mfma_f32_16x16x32_bf16 v[132:135], a[140:143], a[4:7], v[132:135]
v_permlane32_swap_b32 v100, v101
v_mfma_f32_16x16x32_bf16 v[156:159], a[140:143], a[12:15], v[156:159]
buffer_load_dwordx4 v1, s[4:7], s44 offen offset:1024 sc1 lds
v_mfma_f32_16x16x32_bf16 v[156:159], a[136:139], a[8:11], v[156:159]
ds_read_b128 a[112:115], v5 offset:28672
v_mfma_f32_16x16x32_bf16 v[180:183], a[136:139], a[16:19], v[180:183]
v_permlane32_swap_b32 v108, v109
v_mfma_f32_16x16x32_bf16 v[180:183], a[140:143], a[20:23], v[180:183]
ds_read_b128 a[116:119], v5 offset:34816
v_mfma_f32_16x16x32_bf16 v[204:207], a[140:143], a[28:31], v[204:207]
v_permlane32_swap_b32 v116, v117
v_mfma_f32_16x16x32_bf16 v[204:207], a[136:139], a[24:27], v[204:207]
buffer_load_dwordx4 a[88:91], v2, s[40:43], s35 offen offset:3072 sc1
v_mfma_f32_16x16x32_bf16 v[208:211], a[144:147], a[24:27], v[208:211]
v_add_f32 v92, v92, v93
v_add_f32 v100, v100, v101
v_mfma_f32_16x16x32_bf16 v[208:211], a[148:151], a[28:31], v[208:211]
v_add_f32 v108, v108, v109
v_add_f32 v116, v116, v117
v_mfma_f32_16x16x32_bf16 v[184:187], a[148:151], a[20:23], v[184:187]
v_mov_b32 v94, v92
v_mfma_f32_16x16x32_bf16 v[184:187], a[144:147], a[16:19], v[184:187]
v_mov_b32 v102, v100
v_mfma_f32_16x16x32_bf16 v[160:163], a[144:147], a[8:11], v[160:163]
buffer_load_dwordx4 a[92:95], v2, s[40:43], s33 offen offset:3072 sc1
s_add_u32 s35, s35, 8192
v_mfma_f32_16x16x32_bf16 v[160:163], a[148:151], a[12:15], v[160:163]
s_add_u32 s33, s33, 8192
v_mov_b32 v110, v108
v_mfma_f32_16x16x32_bf16 v[136:139], a[148:151], a[4:7], v[136:139]
v_mov_b32 v118, v116
v_mfma_f32_16x16x32_bf16 v[136:139], a[144:147], a[0:3], v[136:139]
s_waitcnt vmcnt(10) lgkmcnt(0)
v_mfma_f32_16x16x32_bf16 v[140:143], a[96:99], a[32:35], v[140:143]
ds_read_b128 a[128:131], v5 offset:29696
v_mfma_f32_16x16x32_bf16 v[140:143], a[100:103], a[36:39], v[140:143]
buffer_load_dwordx4 a[0:3], v2, s[40:43], s35 offen offset:0 sc1
v_mfma_f32_16x16x32_bf16 v[164:167], a[100:103], a[44:47], v[164:167]
ds_read_b128 a[132:135], v5 offset:35840
v_mfma_f32_16x16x32_bf16 v[164:167], a[96:99], a[40:43], v[164:167]
v_permlane16_swap_b32 v92, v94
v_mfma_f32_16x16x32_bf16 v[188:191], a[96:99], a[48:51], v[188:191]
v_permlane16_swap_b32 v100, v102
v_mfma_f32_16x16x32_bf16 v[188:191], a[100:103], a[52:55], v[188:191]
buffer_load_dwordx4 a[4:7], v2, s[40:43], s33 offen offset:0 sc1
v_mfma_f32_16x16x32_bf16 v[212:215], a[100:103], a[60:63], v[212:215]
ds_read_b128 a[136:139], v5 offset:24576
v_mfma_f32_16x16x32_bf16 v[212:215], a[96:99], a[56:59], v[212:215]
v_permlane16_swap_b32 v108, v110
v_mfma_f32_16x16x32_bf16 v[216:219], a[104:107], a[56:59], v[216:219]
ds_read_b128 a[140:143], v5 offset:30720
v_mfma_f32_16x16x32_bf16 v[216:219], a[108:111], a[60:63], v[216:219]
v_permlane16_swap_b32 v116, v118
v_mfma_f32_16x16x32_bf16 v[192:195], a[108:111], a[52:55], v[192:195]
buffer_load_dwordx4 v1, s[4:7], s44 offen offset:2048 sc1 lds
s_add_u32 m0, s18, 0x9000
v_mfma_f32_16x16x32_bf16 v[192:195], a[104:107], a[48:51], v[192:195]
s_add_u32 s44, s50, 0x142d000
ds_read_b128 a[144:147], v5 offset:25600
v_mfma_f32_16x16x32_bf16 v[168:171], a[104:107], a[40:43], v[168:171]
v_add_f32 v92, v92, v94
v_add_f32 v100, v100, v102
v_mfma_f32_16x16x32_bf16 v[168:171], a[108:111], a[44:47], v[168:171]
ds_read_b128 a[148:151], v5 offset:31744
v_add_f32 v108, v108, v110
v_mfma_f32_16x16x32_bf16 v[144:147], a[108:111], a[36:39], v[144:147]
v_add_f32 v116, v116, v118
v_mov_b32 v94, v92
v_mfma_f32_16x16x32_bf16 v[144:147], a[104:107], a[32:35], v[144:147]
buffer_load_dwordx4 a[8:11], v2, s[40:43], s35 offen offset:1024 sc1
v_mfma_f32_16x16x32_bf16 v[148:151], a[112:115], a[32:35], v[148:151]
v_mov_b32 v102, v100
v_mov_b32 v110, v108
v_mfma_f32_16x16x32_bf16 v[148:151], a[116:119], a[36:39], v[148:151]
v_mov_b32 v118, v116
v_mfma_f32_16x16x32_bf16 v[172:175], a[116:119], a[44:47], v[172:175]
v_permlane32_swap_b32 v92, v94
v_mfma_f32_16x16x32_bf16 v[172:175], a[112:115], a[40:43], v[172:175]
v_permlane32_swap_b32 v100, v102
v_mfma_f32_16x16x32_bf16 v[196:199], a[112:115], a[48:51], v[196:199]
buffer_load_dwordx4 a[12:15], v2, s[40:43], s33 offen offset:1024 sc1
v_mfma_f32_16x16x32_bf16 v[196:199], a[116:119], a[52:55], v[196:199]
v_permlane32_swap_b32 v108, v110
v_mfma_f32_16x16x32_bf16 v[220:223], a[116:119], a[60:63], v[220:223]
v_permlane32_swap_b32 v116, v118
v_mfma_f32_16x16x32_bf16 v[220:223], a[112:115], a[56:59], v[220:223]
v_mul_f32 v82, 0xba800000, v92
s_waitcnt lgkmcnt(0)
v_mfma_f32_16x16x32_bf16 v[224:227], a[128:131], a[56:59], v[224:227]
ds_read_b128 a[96:99], v5 offset:38912
v_mul_f32 v84, 0xba800000, v100
v_mfma_f32_16x16x32_bf16 v[224:227], a[132:135], a[60:63], v[224:227]
buffer_load_dwordx4 a[16:19], v2, s[40:43], s35 offen offset:2048 sc1
v_mfma_f32_16x16x32_bf16 v[200:203], a[132:135], a[52:55], v[200:203]
ds_read_b128 a[100:103], v5 offset:45056
v_mul_f32 v86, 0xba800000, v108
v_mfma_f32_16x16x32_bf16 v[200:203], a[128:131], a[48:51], v[200:203]
v_mul_f32 v88, 0xba800000, v116
v_mul_f32 v94, 0x3a800000, v94
v_mfma_f32_16x16x32_bf16 v[176:179], a[128:131], a[40:43], v[176:179]
v_mul_f32 v102, 0x3a800000, v102
v_mul_f32 v110, 0x3a800000, v110
v_mfma_f32_16x16x32_bf16 v[176:179], a[132:135], a[44:47], v[176:179]
buffer_load_dwordx4 v1, s[4:7], s44 offen offset:0 sc1 lds
v_mfma_f32_16x16x32_bf16 v[152:155], a[132:135], a[36:39], v[152:155]
ds_read_b128 a[104:107], v5 offset:39936
v_mul_f32 v118, 0x3a800000, v118
v_mfma_f32_16x16x32_bf16 v[152:155], a[128:131], a[32:35], v[152:155]
v_fma_f32 v94, -v82, v82, v94
v_fma_f32 v102, -v84, v84, v102
v_mfma_f32_16x16x32_bf16 v[132:135], a[136:139], a[32:35], v[132:135]
ds_read_b128 a[108:111], v5 offset:46080
v_fma_f32 v110, -v86, v86, v110
v_mfma_f32_16x16x32_bf16 v[132:135], a[140:143], a[36:39], v[132:135]
buffer_load_dwordx4 a[20:23], v2, s[40:43], s33 offen offset:2048 sc1
v_mfma_f32_16x16x32_bf16 v[156:159], a[140:143], a[44:47], v[156:159]
ds_read_b128 a[112:115], v5 offset:40960
v_fma_f32 v118, -v88, v88, v118
v_mfma_f32_16x16x32_bf16 v[156:159], a[136:139], a[40:43], v[156:159]
v_max_f32 v94, 0, v94
v_max_f32 v102, 0, v102
v_mfma_f32_16x16x32_bf16 v[180:183], a[136:139], a[48:51], v[180:183]
v_max_f32 v110, 0, v110
v_max_f32 v118, 0, v118
v_mfma_f32_16x16x32_bf16 v[180:183], a[140:143], a[52:55], v[180:183]
buffer_load_dwordx4 a[24:27], v2, s[40:43], s35 offen offset:3072 sc1
v_mfma_f32_16x16x32_bf16 v[204:207], a[140:143], a[60:63], v[204:207]
ds_read_b128 a[116:119], v5 offset:47104
v_add_f32 v94, 0x3727c5ac, v94
v_mfma_f32_16x16x32_bf16 v[204:207], a[136:139], a[56:59], v[204:207]
v_add_f32 v102, 0x3727c5ac, v102
v_add_f32 v110, 0x3727c5ac, v110
v_mfma_f32_16x16x32_bf16 v[208:211], a[144:147], a[56:59], v[208:211]
v_add_f32 v118, 0x3727c5ac, v118
v_mfma_f32_16x16x32_bf16 v[208:211], a[148:151], a[60:63], v[208:211]
buffer_load_dwordx4 v1, s[4:7], s44 offen offset:1024 sc1 lds
v_mfma_f32_16x16x32_bf16 v[184:187], a[148:151], a[52:55], v[184:187]
v_rsq_f32 v83, v94
v_mfma_f32_16x16x32_bf16 v[184:187], a[144:147], a[48:51], v[184:187]
v_rsq_f32 v85, v102
v_mfma_f32_16x16x32_bf16 v[160:163], a[144:147], a[40:43], v[160:163]
v_rsq_f32 v87, v110
v_mfma_f32_16x16x32_bf16 v[160:163], a[148:151], a[44:47], v[160:163]
buffer_load_dwordx4 a[28:31], v2, s[40:43], s33 offen offset:3072 sc1
s_add_u32 s35, s35, 8192
v_mfma_f32_16x16x32_bf16 v[136:139], a[148:151], a[36:39], v[136:139]
s_add_u32 s33, s33, 8192
v_mfma_f32_16x16x32_bf16 v[136:139], a[144:147], a[32:35], v[136:139]
s_waitcnt vmcnt(11) lgkmcnt(0)
v_mfma_f32_16x16x32_bf16 v[140:143], a[96:99], a[64:67], v[140:143]
ds_read_b128 a[128:131], v5 offset:41984
v_mfma_f32_16x16x32_bf16 v[140:143], a[100:103], a[68:71], v[140:143]
buffer_load_dwordx4 a[32:35], v2, s[40:43], s35 offen offset:0 sc1
v_mfma_f32_16x16x32_bf16 v[164:167], a[100:103], a[76:79], v[164:167]
ds_read_b128 a[132:135], v5 offset:48128
v_mfma_f32_16x16x32_bf16 v[164:167], a[96:99], a[72:75], v[164:167]
v_rsq_f32 v89, v118
v_mfma_f32_16x16x32_bf16 v[188:191], a[96:99], a[80:83], v[188:191]
v_mfma_f32_16x16x32_bf16 v[188:191], a[100:103], a[84:87], v[188:191]
buffer_load_dwordx4 a[36:39], v2, s[40:43], s33 offen offset:0 sc1
v_mfma_f32_16x16x32_bf16 v[212:215], a[100:103], a[92:95], v[212:215]
ds_read_b128 a[136:139], v5 offset:36864
v_mfma_f32_16x16x32_bf16 v[212:215], a[96:99], a[88:91], v[212:215]
v_mfma_f32_16x16x32_bf16 v[216:219], a[104:107], a[88:91], v[216:219]
ds_read_b128 a[140:143], v5 offset:43008
v_mfma_f32_16x16x32_bf16 v[216:219], a[108:111], a[92:95], v[216:219]
v_mfma_f32_16x16x32_bf16 v[192:195], a[108:111], a[84:87], v[192:195]
buffer_load_dwordx4 v1, s[4:7], s44 offen offset:2048 sc1 lds
s_add_u32 m0, s19, 49152
v_mfma_f32_16x16x32_bf16 v[192:195], a[104:107], a[80:83], v[192:195]
s_add_u32 s44, s85, 0xc04000
ds_read_b128 a[144:147], v5 offset:37888
v_mfma_f32_16x16x32_bf16 v[168:171], a[104:107], a[72:75], v[168:171]
v_fmac_f32 v140, v56, v82
v_fmac_f32 v164, v56, v84
v_mfma_f32_16x16x32_bf16 v[168:171], a[108:111], a[76:79], v[168:171]
ds_read_b128 a[148:151], v5 offset:44032
v_mfma_f32_16x16x32_bf16 v[144:147], a[108:111], a[68:71], v[144:147]
v_fmac_f32 v188, v56, v86
v_mfma_f32_16x16x32_bf16 v[144:147], a[104:107], a[64:67], v[144:147]
buffer_load_dwordx4 a[40:43], v2, s[40:43], s35 offen offset:1024 sc1
v_mfma_f32_16x16x32_bf16 v[148:151], a[112:115], a[64:67], v[148:151]
v_fmac_f32 v212, v56, v88
v_mfma_f32_16x16x32_bf16 v[148:151], a[116:119], a[68:71], v[148:151]
v_mfma_f32_16x16x32_bf16 v[172:175], a[116:119], a[76:79], v[172:175]
v_fmac_f32 v216, v60, v88
v_mfma_f32_16x16x32_bf16 v[172:175], a[112:115], a[72:75], v[172:175]
v_mfma_f32_16x16x32_bf16 v[196:199], a[112:115], a[80:83], v[196:199]
buffer_load_dwordx4 a[44:47], v2, s[40:43], s33 offen offset:1024 sc1
v_mfma_f32_16x16x32_bf16 v[196:199], a[116:119], a[84:87], v[196:199]
v_fmac_f32 v192, v60, v86
v_mfma_f32_16x16x32_bf16 v[220:223], a[116:119], a[92:95], v[220:223]
v_fmac_f32 v168, v60, v84
v_fmac_f32 v141, v57, v82
v_mfma_f32_16x16x32_bf16 v[220:223], a[112:115], a[88:91], v[220:223]
s_waitcnt lgkmcnt(0)
s_barrier
v_mfma_f32_16x16x32_bf16 v[224:227], a[128:131], a[88:91], v[224:227]
v_add_u32 v5, 0, v1
v_fmac_f32 v144, v60, v82
v_mfma_f32_16x16x32_bf16 v[224:227], a[132:135], a[92:95], v[224:227]
buffer_load_dwordx4 a[48:51], v2, s[40:43], s35 offen offset:2048 sc1
v_mfma_f32_16x16x32_bf16 v[200:203], a[132:135], a[84:87], v[200:203]
ds_read_b128 a[96:99], v5 offset:2048
v_fmac_f32 v148, v64, v82
v_mfma_f32_16x16x32_bf16 v[200:203], a[128:131], a[80:83], v[200:203]
ds_read_b128 a[100:103], v5 offset:8192
v_fmac_f32 v165, v57, v84
v_mfma_f32_16x16x32_bf16 v[176:179], a[128:131], a[72:75], v[176:179]
v_fmac_f32 v172, v64, v84
v_fmac_f32 v189, v57, v86
v_mfma_f32_16x16x32_bf16 v[176:179], a[132:135], a[76:79], v[176:179]
buffer_load_dwordx4 a[52:55], v2, s[40:43], s33 offen offset:2048 sc1
v_mfma_f32_16x16x32_bf16 v[152:155], a[132:135], a[68:71], v[152:155]
ds_read_b128 a[104:107], v5 offset:3072
v_fmac_f32 v196, v64, v86
v_mfma_f32_16x16x32_bf16 v[152:155], a[128:131], a[64:67], v[152:155]
v_fmac_f32 v213, v57, v88
v_fmac_f32 v217, v61, v88
v_mfma_f32_16x16x32_bf16 v[132:135], a[136:139], a[64:67], v[132:135]
ds_read_b128 a[108:111], v5 offset:9216
v_fmac_f32 v220, v64, v88
v_mfma_f32_16x16x32_bf16 v[132:135], a[140:143], a[68:71], v[132:135]
v_fmac_f32 v193, v61, v86
v_mfma_f32_16x16x32_bf16 v[156:159], a[140:143], a[76:79], v[156:159]
buffer_load_dwordx4 v1, s[4:7], s44 offen offset:0 sc1 lds
v_mfma_f32_16x16x32_bf16 v[156:159], a[136:139], a[72:75], v[156:159]
ds_read_b128 a[112:115], v5 offset:4096
v_fmac_f32 v224, v68, v88
v_mfma_f32_16x16x32_bf16 v[180:183], a[136:139], a[80:83], v[180:183]
v_fmac_f32 v200, v68, v86
v_fmac_f32 v169, v61, v84
v_mfma_f32_16x16x32_bf16 v[180:183], a[140:143], a[84:87], v[180:183]
ds_read_b128 a[116:119], v5 offset:10240
v_fmac_f32 v145, v61, v82
v_mfma_f32_16x16x32_bf16 v[204:207], a[140:143], a[92:95], v[204:207]
v_fmac_f32 v176, v68, v84
v_fmac_f32 v149, v65, v82
v_mfma_f32_16x16x32_bf16 v[204:207], a[136:139], a[88:91], v[204:207]
buffer_load_dwordx4 a[56:59], v2, s[40:43], s35 offen offset:3072 sc1
v_mfma_f32_16x16x32_bf16 v[208:211], a[144:147], a[88:91], v[208:211]
v_fmac_f32 v152, v68, v82
v_fmac_f32 v173, v65, v84
v_mfma_f32_16x16x32_bf16 v[208:211], a[148:151], a[92:95], v[208:211]
v_mfma_f32_16x16x32_bf16 v[184:187], a[148:151], a[84:87], v[184:187]
v_fmac_f32 v132, v48, v82
v_fmac_f32 v197, v65, v86
v_mfma_f32_16x16x32_bf16 v[184:187], a[144:147], a[80:83], v[184:187]
v_mfma_f32_16x16x32_bf16 v[160:163], a[144:147], a[72:75], v[160:163]
buffer_load_dwordx4 a[60:63], v2, s[40:43], s33 offen offset:3072 sc1
s_add_u32 s35, s35, 8192
v_mfma_f32_16x16x32_bf16 v[160:163], a[148:151], a[76:79], v[160:163]
s_add_u32 s33, s33, 8192
v_fmac_f32 v156, v48, v84
v_mfma_f32_16x16x32_bf16 v[136:139], a[148:151], a[68:71], v[136:139]
v_fmac_f32 v180, v48, v86
v_fmac_f32 v221, v65, v88
v_mfma_f32_16x16x32_bf16 v[136:139], a[144:147], a[64:67], v[136:139]
v_fmac_f32 v225, v69, v88
s_waitcnt vmcnt(10) lgkmcnt(0)
v_mfma_f32_16x16x32_bf16 v[140:143], a[96:99], a[0:3], v[140:143]
ds_read_b128 a[128:131], v5 offset:5120
v_fmac_f32 v204, v48, v88
v_mfma_f32_16x16x32_bf16 v[140:143], a[100:103], a[4:7], v[140:143]
buffer_load_dwordx4 a[64:67], v2, s[40:43], s35 offen offset:0 sc1
s_lshl_b32 s36, s28, 9
v_mfma_f32_16x16x32_bf16 v[164:167], a[100:103], a[12:15], v[164:167]
ds_read_b128 a[132:135], v5 offset:11264
v_fmac_f32 v208, v52, v88
v_mfma_f32_16x16x32_bf16 v[164:167], a[96:99], a[8:11], v[164:167]
v_fmac_f32 v201, v69, v86
v_fmac_f32 v177, v69, v84
v_mfma_f32_16x16x32_bf16 v[188:191], a[96:99], a[16:19], v[188:191]
v_fmac_f32 v184, v52, v86
v_fmac_f32 v153, v69, v82
v_mfma_f32_16x16x32_bf16 v[188:191], a[100:103], a[20:23], v[188:191]
buffer_load_dwordx4 a[68:71], v2, s[40:43], s33 offen offset:0 sc1
s_lshl_b32 s37, s30, 2
v_mfma_f32_16x16x32_bf16 v[212:215], a[100:103], a[28:31], v[212:215]
ds_read_b128 a[136:139], v5 offset:0
v_fmac_f32 v160, v52, v84
v_mfma_f32_16x16x32_bf16 v[212:215], a[96:99], a[24:27], v[212:215]
v_fmac_f32 v133, v49, v82
v_add_u32 v232, s19, v7
v_mfma_f32_16x16x32_bf16 v[216:219], a[104:107], a[24:27], v[216:219]
ds_read_b128 a[140:143], v5 offset:6144
v_fmac_f32 v136, v52, v82
v_mfma_f32_16x16x32_bf16 v[216:219], a[108:111], a[28:31], v[216:219]
buffer_load_dwordx4 a[72:75], v2, s[40:43], s35 offen offset:1024 sc1
s_add_u32 s37, s37, s28
v_mfma_f32_16x16x32_bf16 v[192:195], a[108:111], a[20:23], v[192:195]
ds_read_b128 a[144:147], v5 offset:1024
v_fmac_f32 v157, v49, v84
v_mfma_f32_16x16x32_bf16 v[192:195], a[104:107], a[16:19], v[192:195]
v_fmac_f32 v181, v49, v86
v_fmac_f32 v142, v58, v82
v_mfma_f32_16x16x32_bf16 v[168:171], a[104:107], a[8:11], v[168:171]
v_fmac_f32 v205, v49, v88
v_fmac_f32 v166, v58, v84
v_mfma_f32_16x16x32_bf16 v[168:171], a[108:111], a[12:15], v[168:171]
buffer_load_dwordx4 a[76:79], v2, s[40:43], s33 offen offset:1024 sc1
s_lshl_b32 s98, s37, 13
v_mfma_f32_16x16x32_bf16 v[144:147], a[108:111], a[4:7], v[144:147]
ds_read_b128 a[148:151], v5 offset:7168
v_fmac_f32 v209, v53, v88
v_mfma_f32_16x16x32_bf16 v[144:147], a[104:107], a[0:3], v[144:147]
v_fmac_f32 v190, v58, v86
s_add_u32 s98, s98, 0x400000
v_mfma_f32_16x16x32_bf16 v[148:151], a[112:115], a[0:3], v[148:151]
v_fmac_f32 v185, v53, v86
v_fmac_f32 v214, v58, v88
v_mfma_f32_16x16x32_bf16 v[148:151], a[116:119], a[4:7], v[148:151]
buffer_load_dwordx4 a[80:83], v2, s[40:43], s35 offen offset:2048 sc1
s_add_u32 s99, s98, 4096
v_mfma_f32_16x16x32_bf16 v[172:175], a[116:119], a[12:15], v[172:175]
v_fmac_f32 v161, v53, v84
v_fmac_f32 v218, v62, v88
v_mfma_f32_16x16x32_bf16 v[172:175], a[112:115], a[8:11], v[172:175]
s_lshl_b32 s100, s37, 10
s_add_u32 s100, s100, 0x820000
s_lshl_b32 s96, s29, 10
v_mfma_f32_16x16x32_bf16 v[196:199], a[112:115], a[16:19], v[196:199]
v_fmac_f32 v137, v53, v82
v_fmac_f32 v194, v62, v86
v_mfma_f32_16x16x32_bf16 v[196:199], a[116:119], a[20:23], v[196:199]
buffer_load_dwordx4 a[84:87], v2, s[40:43], s33 offen offset:2048 sc1
s_add_u32 s96, s96, s98
v_mfma_f32_16x16x32_bf16 v[220:223], a[116:119], a[28:31], v[220:223]
v_fmac_f32 v170, v62, v84
v_fmac_f32 v143, v59, v82
v_mfma_f32_16x16x32_bf16 v[220:223], a[112:115], a[24:27], v[220:223]
s_lshl_b32 s97, s29, 7
s_waitcnt lgkmcnt(0)
v_mfma_f32_16x16x32_bf16 v[224:227], a[128:131], a[24:27], v[224:227]
ds_read_b128 a[96:99], v5 offset:14336
v_fmac_f32 v146, v62, v82
v_mfma_f32_16x16x32_bf16 v[224:227], a[132:135], a[28:31], v[224:227]
buffer_load_dwordx4 a[88:91], v2, s[40:43], s35 offen offset:3072 sc1
s_add_u32 s97, s97, s100
v_mfma_f32_16x16x32_bf16 v[200:203], a[132:135], a[20:23], v[200:203]
ds_read_b128 a[100:103], v5 offset:20480
v_fmac_f32 v150, v66, v82
v_mfma_f32_16x16x32_bf16 v[200:203], a[128:131], a[16:19], v[200:203]
v_fmac_f32 v167, v59, v84
v_fmac_f32 v191, v59, v86
v_mfma_f32_16x16x32_bf16 v[176:179], a[128:131], a[8:11], v[176:179]
v_fmac_f32 v174, v66, v84
v_fmac_f32 v215, v59, v88
v_mfma_f32_16x16x32_bf16 v[176:179], a[132:135], a[12:15], v[176:179]
ds_read_b128 a[104:107], v5 offset:15360
s_lshl_b32 s88, s28, 6
v_mfma_f32_16x16x32_bf16 v[152:155], a[132:135], a[4:7], v[152:155]
v_fmac_f32 v198, v66, v86
v_fmac_f32 v219, v63, v88
v_mfma_f32_16x16x32_bf16 v[152:155], a[128:131], a[0:3], v[152:155]
buffer_load_dwordx4 v1, s[4:7], s44 offen offset:1024 sc1 lds
s_add_u32 s94, s80, s88
v_mfma_f32_16x16x32_bf16 v[132:135], a[136:139], a[0:3], v[132:135]
ds_read_b128 a[108:111], v5 offset:21504
v_fmac_f32 v222, v66, v88
v_mfma_f32_16x16x32_bf16 v[132:135], a[140:143], a[4:7], v[132:135]
v_fmac_f32 v195, v63, v86
s_add_u32 s94, s94, 0x90000
v_mfma_f32_16x16x32_bf16 v[156:159], a[140:143], a[12:15], v[156:159]
ds_read_b128 a[112:115], v5 offset:16384
v_fmac_f32 v226, v70, v88
v_mfma_f32_16x16x32_bf16 v[156:159], a[136:139], a[8:11], v[156:159]
v_fmac_f32 v171, v63, v84
s_add_u32 s88, s88, s70
v_mfma_f32_16x16x32_bf16 v[180:183], a[136:139], a[16:19], v[180:183]
v_fmac_f32 v202, v70, v86
v_fmac_f32 v147, v63, v82
v_mfma_f32_16x16x32_bf16 v[180:183], a[140:143], a[20:23], v[180:183]
buffer_load_dwordx4 a[92:95], v2, s[40:43], s33 offen offset:3072 sc1
s_add_u32 s35, s35, 8192
v_mfma_f32_16x16x32_bf16 v[204:207], a[140:143], a[28:31], v[204:207]
s_add_u32 s33, s33, 8192
ds_read_b128 a[116:119], v5 offset:22528
v_mfma_f32_16x16x32_bf16 v[204:207], a[136:139], a[24:27], v[204:207]
v_fmac_f32 v178, v70, v84
v_fmac_f32 v151, v67, v82
v_mfma_f32_16x16x32_bf16 v[208:211], a[144:147], a[24:27], v[208:211]
v_fmac_f32 v154, v70, v82
v_fmac_f32 v175, v67, v84
v_mfma_f32_16x16x32_bf16 v[208:211], a[148:151], a[28:31], v[208:211]
s_add_u32 s89, s88, 0x90000
s_add_u32 s74, s71, 0x30080
s_lshl_b32 s73, s30, 12
v_mfma_f32_16x16x32_bf16 v[184:187], a[148:151], a[20:23], v[184:187]
v_fmac_f32 v134, v50, v82
v_fmac_f32 v199, v67, v86
v_mfma_f32_16x16x32_bf16 v[184:187], a[144:147], a[16:19], v[184:187]
buffer_load_dwordx4 v1, s[4:7], s44 offen offset:2048 sc1 lds
s_add_u32 s72, s73, 0x2600000
v_mfma_f32_16x16x32_bf16 v[160:163], a[144:147], a[8:11], v[160:163]
v_fmac_f32 v158, v50, v84
v_fmac_f32 v223, v67, v88
v_mfma_f32_16x16x32_bf16 v[160:163], a[148:151], a[12:15], v[160:163]
v_add_u32 v233, s19, v232
s_add_u32 s73, s73, 0x1e00000
v_mfma_f32_16x16x32_bf16 v[136:139], a[148:151], a[4:7], v[136:139]
v_fmac_f32 v182, v50, v86
v_fmac_f32 v227, v71, v88
v_mfma_f32_16x16x32_bf16 v[136:139], a[144:147], a[0:3], v[136:139]
s_waitcnt vmcnt(10) lgkmcnt(0)
s_barrier
v_mfma_f32_16x16x32_bf16 v[140:143], a[96:99], a[32:35], v[140:143]
ds_read_b128 a[128:131], v5 offset:17408
v_fmac_f32 v206, v50, v88
v_mfma_f32_16x16x32_bf16 v[140:143], a[100:103], a[36:39], v[140:143]
buffer_load_dwordx4 a[0:3], v2, s[40:43], s35 offen offset:0 sc1
s_lshr_b32 s38, s28, 1
v_mfma_f32_16x16x32_bf16 v[164:167], a[100:103], a[44:47], v[164:167]
L_stub17:
s_cbranch_execz L_stub18
ds_read_b128 a[132:135], v5 offset:23552
v_fmac_f32 v210, v54, v88
v_mfma_f32_16x16x32_bf16 v[164:167], a[96:99], a[40:43], v[164:167]
v_fmac_f32 v203, v71, v86
v_fmac_f32 v179, v71, v84
v_mfma_f32_16x16x32_bf16 v[188:191], a[96:99], a[48:51], v[188:191]
buffer_load_dwordx4 a[4:7], v2, s[40:43], s33 offen offset:0 sc1
s_and_b32 s39, s28, 1
v_mfma_f32_16x16x32_bf16 v[188:191], a[100:103], a[52:55], v[188:191]
ds_read_b128 a[136:139], v5 offset:26624
v_fmac_f32 v186, v54, v86
v_mfma_f32_16x16x32_bf16 v[212:215], a[100:103], a[60:63], v[212:215]
v_fmac_f32 v162, v54, v84
v_fmac_f32 v155, v71, v82
v_mfma_f32_16x16x32_bf16 v[212:215], a[96:99], a[56:59], v[212:215]
buffer_load_dwordx4 a[8:11], v2, s[40:43], s35 offen offset:1024 sc1
s_mul_i32 s38, s38, 3072
v_mfma_f32_16x16x32_bf16 v[216:219], a[104:107], a[56:59], v[216:219]
ds_read_b128 a[140:143], v5 offset:32768
v_fmac_f32 v138, v54, v82
v_mfma_f32_16x16x32_bf16 v[216:219], a[108:111], a[60:63], v[216:219]
v_fmac_f32 v135, v51, v82
v_fmac_f32 v159, v51, v84
v_mfma_f32_16x16x32_bf16 v[192:195], a[108:111], a[52:55], v[192:195]
buffer_load_dwordx4 a[12:15], v2, s[40:43], s33 offen offset:1024 sc1
s_lshl_b32 s39, s39, 3
v_mfma_f32_16x16x32_bf16 v[192:195], a[104:107], a[48:51], v[192:195]
ds_read_b128 a[144:147], v5 offset:27648
v_fmac_f32 v183, v51, v86
v_mfma_f32_16x16x32_bf16 v[168:171], a[104:107], a[40:43], v[168:171]
v_fmac_f32 v207, v51, v88
s_add_u32 s38, s38, s39
v_mfma_f32_16x16x32_bf16 v[168:171], a[108:111], a[44:47], v[168:171]
buffer_load_dwordx4 a[16:19], v2, s[40:43], s35 offen offset:2048 sc1
v_mfma_f32_16x16x32_bf16 v[144:147], a[108:111], a[36:39], v[144:147]
ds_read_b128 a[148:151], v5 offset:33792
v_fmac_f32 v211, v55, v88
v_mfma_f32_16x16x32_bf16 v[144:147], a[104:107], a[32:35], v[144:147]
v_mul_f32 v88, 0x3fb8aa3b, v89
v_and_b32 v248, 7, v0
v_mfma_f32_16x16x32_bf16 v[148:151], a[112:115], a[32:35], v[148:151]
buffer_load_dwordx4 a[20:23], v2, s[40:43], s33 offen offset:2048 sc1
v_mfma_f32_16x16x32_bf16 v[148:151], a[116:119], a[36:39], v[148:151]
v_fmac_f32 v187, v55, v86
v_lshlrev_b32 v248, 7, v248
v_mfma_f32_16x16x32_bf16 v[172:175], a[116:119], a[44:47], v[172:175]
v_fmac_f32 v163, v55, v84
v_mul_f32 v86, 0x3fb8aa3b, v87
v_mfma_f32_16x16x32_bf16 v[172:175], a[112:115], a[40:43], v[172:175]
buffer_load_dwordx4 a[24:27], v2, s[40:43], s35 offen offset:3072 sc1
v_mfma_f32_16x16x32_bf16 v[196:199], a[112:115], a[48:51], v[196:199]
v_fmac_f32 v139, v55, v82
v_mul_f32 v84, 0x3fb8aa3b, v85
v_mfma_f32_16x16x32_bf16 v[196:199], a[116:119], a[52:55], v[196:199]
v_mul_f32 v82, 0x3fb8aa3b, v83
v_lshrrev_b32 v249, 4, v0
v_mfma_f32_16x16x32_bf16 v[220:223], a[116:119], a[60:63], v[220:223]
buffer_load_dwordx4 a[28:31], v2, s[40:43], s33 offen offset:3072 sc1
s_add_u32 s35, s35, 8192
v_mfma_f32_16x16x32_bf16 v[220:223], a[112:115], a[56:59], v[220:223]
s_add_u32 s33, s33, 8192
s_waitcnt lgkmcnt(0)
v_mfma_f32_16x16x32_bf16 v[224:227], a[128:131], a[56:59], v[224:227]
ds_read_b128 a[96:99], v5 offset:28672
v_lshlrev_b32 v235, 8, v0
v_mfma_f32_16x16x32_bf16 v[224:227], a[132:135], a[60:63], v[224:227]
buffer_load_dwordx4 v1, s[4:7], s44 offen offset:3072 sc1 lds
s_add_u32 m0, s19, 65536
v_mfma_f32_16x16x32_bf16 v[200:203], a[132:135], a[52:55], v[200:203]
s_add_u32 s44, s84, 0xc08000
ds_read_b128 a[100:103], v5 offset:34816
v_mfma_f32_16x16x32_bf16 v[200:203], a[128:131], a[48:51], v[200:203]
v_lshl_add_u32 v248, v249, 4, v248
v_add_u32 v234, s36, v8
v_mfma_f32_16x16x32_bf16 v[176:179], a[128:131], a[40:43], v[176:179]
v_cndmask_b32 v235, 2.0, v235, s[64:65]
v_mov_b32 v249, 0x3f80
v_mfma_f32_16x16x32_bf16 v[176:179], a[132:135], a[44:47], v[176:179]
ds_read_b128 a[104:107], v5 offset:29696
v_mov_b32 v250, 1.0
v_mfma_f32_16x16x32_bf16 v[152:155], a[132:135], a[36:39], v[152:155]
v_add_u32 v252, s38, v1
v_mfma_f32_16x16x32_bf16 v[152:155], a[128:131], a[32:35], v[152:155]
s_waitcnt vmcnt(18)
v_mfma_f32_16x16x32_bf16 v[140:143], a[136:139], a[64:67], v[140:143]
ds_read_b128 a[108:111], v5 offset:35840
s_waitcnt vmcnt(17)
v_mfma_f32_16x16x32_bf16 v[140:143], a[140:143], a[68:71], v[140:143]
s_waitcnt vmcnt(15)
v_mfma_f32_16x16x32_bf16 v[164:167], a[140:143], a[76:79], v[164:167]
ds_read_b128 a[112:115], v5 offset:38912
v_mfma_f32_16x16x32_bf16 v[164:167], a[136:139], a[72:75], v[164:167]
s_waitcnt vmcnt(14)
v_mfma_f32_16x16x32_bf16 v[188:191], a[136:139], a[80:83], v[188:191]
s_waitcnt vmcnt(13)
v_mfma_f32_16x16x32_bf16 v[188:191], a[140:143], a[84:87], v[188:191]
buffer_load_dwordx4 v1, s[4:7], s44 offen offset:0 sc1 lds
s_waitcnt vmcnt(11)
v_mfma_f32_16x16x32_bf16 v[212:215], a[140:143], a[92:95], v[212:215]
ds_read_b128 a[116:119], v5 offset:45056
v_mfma_f32_16x16x32_bf16 v[212:215], a[136:139], a[88:91], v[212:215]
v_mfma_f32_16x16x32_bf16 v[216:219], a[144:147], a[88:91], v[216:219]
v_mfma_f32_16x16x32_bf16 v[216:219], a[148:151], a[92:95], v[216:219]
v_mfma_f32_16x16x32_bf16 v[192:195], a[148:151], a[84:87], v[192:195]
v_mfma_f32_16x16x32_bf16 v[192:195], a[144:147], a[80:83], v[192:195]
v_mfma_f32_16x16x32_bf16 v[168:171], a[144:147], a[72:75], v[168:171]
v_mfma_f32_16x16x32_bf16 v[168:171], a[148:151], a[76:79], v[168:171]
v_mfma_f32_16x16x32_bf16 v[144:147], a[148:151], a[68:71], v[144:147]
v_mfma_f32_16x16x32_bf16 v[144:147], a[144:147], a[64:67], v[144:147]
s_waitcnt lgkmcnt(0)
v_mfma_f32_16x16x32_bf16 v[148:151], a[96:99], a[64:67], v[148:151]
ds_read_b128 a[128:131], v5 offset:39936
v_mfma_f32_16x16x32_bf16 v[148:151], a[100:103], a[68:71], v[148:151]
buffer_load_dwordx4 v1, s[4:7], s44 offen offset:1024 sc1 lds
v_mfma_f32_16x16x32_bf16 v[172:175], a[100:103], a[76:79], v[172:175]
ds_read_b128 a[132:135], v5 offset:46080
v_mfma_f32_16x16x32_bf16 v[172:175], a[96:99], a[72:75], v[172:175]
v_mfma_f32_16x16x32_bf16 v[196:199], a[96:99], a[80:83], v[196:199]
v_mfma_f32_16x16x32_bf16 v[196:199], a[100:103], a[84:87], v[196:199]
buffer_load_dwordx4 v1, s[4:7], s44 offen offset:2048 sc1 lds
v_mfma_f32_16x16x32_bf16 v[220:223], a[100:103], a[92:95], v[220:223]
ds_read_b128 a[136:139], v5 offset:40960
v_mfma_f32_16x16x32_bf16 v[220:223], a[96:99], a[88:91], v[220:223]
v_mfma_f32_16x16x32_bf16 v[224:227], a[104:107], a[88:91], v[224:227]
ds_read_b128 a[140:143], v5 offset:47104
v_mfma_f32_16x16x32_bf16 v[224:227], a[108:111], a[92:95], v[224:227]
v_mfma_f32_16x16x32_bf16 v[200:203], a[108:111], a[84:87], v[200:203]
buffer_load_dwordx4 v1, s[4:7], s44 offen offset:3072 sc1 lds
s_add_u32 m0, s19, 81920
v_mfma_f32_16x16x32_bf16 v[200:203], a[104:107], a[80:83], v[200:203]
s_add_u32 s44, s85, 0xc0c000
ds_read_b128 a[144:147], v5 offset:41984
v_mfma_f32_16x16x32_bf16 v[176:179], a[104:107], a[72:75], v[176:179]
v_mfma_f32_16x16x32_bf16 v[176:179], a[108:111], a[76:79], v[176:179]
ds_read_b128 a[148:151], v5 offset:48128
v_mfma_f32_16x16x32_bf16 v[152:155], a[108:111], a[68:71], v[152:155]
v_mfma_f32_16x16x32_bf16 v[152:155], a[104:107], a[64:67], v[152:155]
buffer_load_dwordx4 v1, s[4:7], s44 offen offset:0 sc1 lds
s_waitcnt vmcnt(13)
v_mfma_f32_16x16x32_bf16 v[140:143], a[112:115], a[0:3], v[140:143]
s_waitcnt vmcnt(12)
v_mfma_f32_16x16x32_bf16 v[140:143], a[116:119], a[4:7], v[140:143]
s_waitcnt vmcnt(10)
v_mfma_f32_16x16x32_bf16 v[164:167], a[116:119], a[12:15], v[164:167]
v_mfma_f32_16x16x32_bf16 v[164:167], a[112:115], a[8:11], v[164:167]
s_waitcnt vmcnt(9)
v_mfma_f32_16x16x32_bf16 v[188:191], a[112:115], a[16:19], v[188:191]
buffer_load_dwordx4 v1, s[4:7], s44 offen offset:1024 sc1 lds
s_waitcnt vmcnt(9)
v_mfma_f32_16x16x32_bf16 v[188:191], a[116:119], a[20:23], v[188:191]
s_waitcnt vmcnt(7)
v_mfma_f32_16x16x32_bf16 v[212:215], a[116:119], a[28:31], v[212:215]
v_mfma_f32_16x16x32_bf16 v[212:215], a[112:115], a[24:27], v[212:215]
s_waitcnt lgkmcnt(0)
v_mfma_f32_16x16x32_bf16 v[216:219], a[128:131], a[24:27], v[216:219]
ds_read_b128 a[96:99], v5 offset:12288
v_cvt_pk_bf16_f32 v140, v140, v141
v_mfma_f32_16x16x32_bf16 v[216:219], a[132:135], a[28:31], v[216:219]
buffer_load_dwordx4 v1, s[4:7], s44 offen offset:2048 sc1 lds
v_mfma_f32_16x16x32_bf16 v[192:195], a[132:135], a[20:23], v[192:195]
ds_read_b128 a[100:103], v5 offset:18432
v_cvt_pk_bf16_f32 v141, v142, v143
v_mfma_f32_16x16x32_bf16 v[192:195], a[128:131], a[16:19], v[192:195]
v_cvt_pk_bf16_f32 v164, v164, v165
v_cvt_pk_bf16_f32 v165, v166, v167
v_mfma_f32_16x16x32_bf16 v[168:171], a[128:131], a[8:11], v[168:171]
v_cvt_pk_bf16_f32 v188, v188, v189
v_cvt_pk_bf16_f32 v189, v190, v191
v_mfma_f32_16x16x32_bf16 v[168:171], a[132:135], a[12:15], v[168:171]
buffer_load_dwordx4 v1, s[4:7], s44 offen offset:3072 sc1 lds
s_add_u32 m0, s19, 147456
v_mfma_f32_16x16x32_bf16 v[144:147], a[132:135], a[4:7], v[144:147]
s_add_u32 s44, s87, 0xc1c000
ds_read_b128 a[104:107], v5 offset:24576
v_mfma_f32_16x16x32_bf16 v[144:147], a[128:131], a[0:3], v[144:147]
v_cvt_pk_bf16_f32 v212, v212, v213
v_cvt_pk_bf16_f32 v213, v214, v215
v_mfma_f32_16x16x32_bf16 v[148:151], a[136:139], a[0:3], v[148:151]
ds_read_b128 a[108:111], v5 offset:30720
v_cvt_pk_bf16_f32 v214, v216, v217
v_mfma_f32_16x16x32_bf16 v[148:151], a[140:143], a[4:7], v[148:151]
v_cvt_pk_bf16_f32 v215, v218, v219
v_mfma_f32_16x16x32_bf16 v[172:175], a[140:143], a[12:15], v[172:175]
buffer_load_dwordx4 v1, s[4:7], s44 offen offset:0 sc1 lds
v_mfma_f32_16x16x32_bf16 v[172:175], a[136:139], a[8:11], v[172:175]
ds_read_b128 a[112:115], v5 offset:36864
v_cvt_pk_bf16_f32 v190, v192, v193
v_mfma_f32_16x16x32_bf16 v[196:199], a[136:139], a[16:19], v[196:199]
v_cvt_pk_bf16_f32 v166, v168, v169
v_cvt_pk_bf16_f32 v167, v170, v171
v_mfma_f32_16x16x32_bf16 v[196:199], a[140:143], a[20:23], v[196:199]
ds_read_b128 a[116:119], v5 offset:43008
v_cvt_pk_bf16_f32 v191, v194, v195
v_mfma_f32_16x16x32_bf16 v[220:223], a[140:143], a[28:31], v[220:223]
v_cvt_pk_bf16_f32 v142, v144, v145
v_cvt_pk_bf16_f32 v143, v146, v147
v_mfma_f32_16x16x32_bf16 v[220:223], a[136:139], a[24:27], v[220:223]
buffer_load_dwordx4 v1, s[4:7], s44 offen offset:1024 sc1 lds
v_mfma_f32_16x16x32_bf16 v[224:227], a[144:147], a[24:27], v[224:227]
v_mfma_f32_16x16x32_bf16 v[92:95], a[240:243], v[140:143], 0
v_mfma_f32_16x16x32_bf16 v[224:227], a[148:151], a[28:31], v[224:227]
v_mfma_f32_16x16x32_bf16 v[96:99], a[244:247], v[140:143], 0
v_mfma_f32_16x16x32_bf16 v[200:203], a[148:151], a[20:23], v[200:203]
v_mfma_f32_16x16x32_bf16 v[100:103], a[240:243], v[164:167], 0
v_mfma_f32_16x16x32_bf16 v[200:203], a[144:147], a[16:19], v[200:203]
v_mfma_f32_16x16x32_bf16 v[104:107], a[244:247], v[164:167], 0
v_mfma_f32_16x16x32_bf16 v[176:179], a[144:147], a[8:11], v[176:179]
buffer_load_dwordx4 v1, s[4:7], s44 offen offset:2048 sc1 lds
v_mfma_f32_16x16x32_bf16 v[176:179], a[148:151], a[12:15], v[176:179]
v_max3_f32 v236, v92, v93, v94
v_max3_f32 v237, -v92, -v93, -v94
v_mfma_f32_16x16x32_bf16 v[152:155], a[148:151], a[4:7], v[152:155]
v_max3_f32 v236, v236, v95, v96
v_max3_f32 v237, v237, -v95, -v96
v_mfma_f32_16x16x32_bf16 v[152:155], a[144:147], a[0:3], v[152:155]
v_max3_f32 v236, v236, v97, v98
s_waitcnt lgkmcnt(0)
v_mfma_f32_16x16x32_bf16 v[132:135], a[96:99], a[32:35], v[132:135]
ds_read_b128 a[128:131], v5 offset:13312
v_max3_f32 v237, v237, -v97, -v98
v_mfma_f32_16x16x32_bf16 v[132:135], a[100:103], a[36:39], v[132:135]
buffer_load_dwordx4 v1, s[4:7], s44 offen offset:3072 sc1 lds
s_add_u32 m0, s19, 98304
v_mfma_f32_16x16x32_bf16 v[156:159], a[100:103], a[44:47], v[156:159]
s_add_u32 s44, s84, 0xc10000
ds_read_b128 a[132:135], v5 offset:19456
v_mfma_f32_16x16x32_bf16 v[156:159], a[96:99], a[40:43], v[156:159]
v_max_f32 v236, v236, v99
v_max_f32_e64 v237, v237, -v99
v_mfma_f32_16x16x32_bf16 v[180:183], a[96:99], a[48:51], v[180:183]
s_nop 0
v_permlane32_swap_b32 v236, v237
v_mfma_f32_16x16x32_bf16 v[180:183], a[100:103], a[52:55], v[180:183]
buffer_load_dwordx4 v1, s[4:7], s44 offen offset:0 sc1 lds
v_mfma_f32_16x16x32_bf16 v[204:207], a[100:103], a[60:63], v[204:207]
ds_read_b128 a[136:139], v5 offset:25600
v_max_f32 v236, v236, v237
v_mfma_f32_16x16x32_bf16 v[204:207], a[96:99], a[56:59], v[204:207]
v_mov_b32 v244, v236
v_max3_f32 v238, v100, v101, v102
v_mfma_f32_16x16x32_bf16 v[204:207], a[104:107], a[88:91], v[204:207]
ds_read_b128 a[140:143], v5 offset:31744
v_max3_f32 v239, -v100, -v101, -v102
v_mfma_f32_16x16x32_bf16 v[204:207], a[108:111], a[92:95], v[204:207]
v_permlane16_swap_b32 v236, v244
v_mfma_f32_16x16x32_bf16 v[180:183], a[108:111], a[84:87], v[180:183]
buffer_load_dwordx4 v1, s[4:7], s44 offen offset:1024 sc1 lds
v_mfma_f32_16x16x32_bf16 v[180:183], a[104:107], a[80:83], v[180:183]
ds_read_b128 a[144:147], v5 offset:37888
v_max_f32 v236, v236, v244
v_mfma_f32_16x16x32_bf16 v[156:159], a[104:107], a[72:75], v[156:159]
v_mov_b32 v244, v236
v_max3_f32 v238, v238, v103, v104
v_mfma_f32_16x16x32_bf16 v[156:159], a[108:111], a[76:79], v[156:159]
ds_read_b128 a[148:151], v5 offset:44032
v_max3_f32 v239, v239, -v103, -v104
v_mfma_f32_16x16x32_bf16 v[132:135], a[108:111], a[68:71], v[132:135]
v_permlane32_swap_b32 v236, v244
v_mfma_f32_16x16x32_bf16 v[132:135], a[104:107], a[64:67], v[132:135]
buffer_load_dwordx4 v1, s[4:7], s44 offen offset:2048 sc1 lds
v_mfma_f32_16x16x32_bf16 v[132:135], a[112:115], a[0:3], v[132:135]
v_mul_f32_e64 v236, -v236, v82
v_mul_f32_e64 v237, -v244, v82
v_mfma_f32_16x16x32_bf16 v[132:135], a[116:119], a[4:7], v[132:135]
v_max3_f32 v238, v238, v105, v106
v_max3_f32 v239, v239, -v105, -v106
v_mfma_f32_16x16x32_bf16 v[156:159], a[116:119], a[12:15], v[156:159]
v_max_f32 v238, v238, v107
v_max_f32_e64 v239, v239, -v107
v_mfma_f32_16x16x32_bf16 v[156:159], a[112:115], a[8:11], v[156:159]
s_nop 0
v_permlane32_swap_b32 v238, v239
v_mfma_f32_16x16x32_bf16 v[180:183], a[112:115], a[16:19], v[180:183]
buffer_load_dwordx4 v1, s[4:7], s44 offen offset:3072 sc1 lds
s_add_u32 m0, s19, 114688
v_mfma_f32_16x16x32_bf16 v[180:183], a[116:119], a[20:23], v[180:183]
s_add_u32 s44, s85, 0xc14000
v_max_f32 v238, v238, v239
v_mfma_f32_16x16x32_bf16 v[204:207], a[116:119], a[28:31], v[204:207]
v_mov_b32 v245, v238
v_mul_f32 v148, v148, v83
v_mfma_f32_16x16x32_bf16 v[204:207], a[112:115], a[24:27], v[204:207]
s_waitcnt lgkmcnt(0)
s_barrier
v_mfma_f32_16x16x32_bf16 v[208:211], a[128:131], a[56:59], v[208:211]
v_mul_f32 v149, v149, v83
v_cvt_pk_bf16_f32 v148, v148, v149
v_mfma_f32_16x16x32_bf16 v[208:211], a[132:135], a[60:63], v[208:211]
buffer_load_dwordx4 v1, s[4:7], s44 offen offset:0 sc1 lds
v_mfma_f32_16x16x32_bf16 v[184:187], a[132:135], a[52:55], v[184:187]
v_permlane16_swap_b32 v238, v245
v_mfma_f32_16x16x32_bf16 v[184:187], a[128:131], a[48:51], v[184:187]
v_max_f32 v238, v238, v245
v_mov_b32 v245, v238
v_mfma_f32_16x16x32_bf16 v[160:163], a[128:131], a[40:43], v[160:163]
s_nop 0
v_permlane32_swap_b32 v238, v245
v_mfma_f32_16x16x32_bf16 v[160:163], a[132:135], a[44:47], v[160:163]
v_mul_f32_e64 v238, -v238, v84
v_mul_f32_e64 v239, -v245, v84
v_mfma_f32_16x16x32_bf16 v[136:139], a[132:135], a[36:39], v[136:139]
v_mfma_f32_16x16x32_bf16 v[108:111], a[240:243], v[188:191], 0
v_mfma_f32_16x16x32_bf16 v[136:139], a[128:131], a[32:35], v[136:139]
buffer_load_dwordx4 v1, s[4:7], s44 offen offset:1024 sc1 lds
v_mfma_f32_16x16x32_bf16 v[136:139], a[136:139], a[64:67], v[136:139]
v_mfma_f32_16x16x32_bf16 v[112:115], a[244:247], v[188:191], 0
v_mfma_f32_16x16x32_bf16 v[136:139], a[140:143], a[68:71], v[136:139]
v_mfma_f32_16x16x32_bf16 v[116:119], a[240:243], v[212:215], 0
v_mfma_f32_16x16x32_bf16 v[160:163], a[140:143], a[76:79], v[160:163]
v_mfma_f32_16x16x32_bf16 v[120:123], a[244:247], v[212:215], 0
v_mfma_f32_16x16x32_bf16 v[160:163], a[136:139], a[72:75], v[160:163]
v_max3_f32 v240, v108, v109, v110
v_max3_f32 v241, -v108, -v109, -v110
v_mfma_f32_16x16x32_bf16 v[184:187], a[136:139], a[80:83], v[184:187]
v_mul_f32 v150, v150, v83
v_mul_f32 v151, v151, v83
v_mfma_f32_16x16x32_bf16 v[184:187], a[140:143], a[84:87], v[184:187]
buffer_load_dwordx4 v1, s[4:7], s44 offen offset:2048 sc1 lds
v_mfma_f32_16x16x32_bf16 v[208:211], a[140:143], a[92:95], v[208:211]
v_cvt_pk_bf16_f32 v149, v150, v151
v_max3_f32 v240, v240, v111, v112
v_mfma_f32_16x16x32_bf16 v[208:211], a[136:139], a[88:91], v[208:211]
ds_write_b64 v232, v[148:149] offset:0
v_max3_f32 v241, v241, -v111, -v112
v_mfma_f32_16x16x32_bf16 v[208:211], a[144:147], a[24:27], v[208:211]
v_max3_f32 v240, v240, v113, v114
v_max3_f32 v241, v241, -v113, -v114
v_mfma_f32_16x16x32_bf16 v[208:211], a[148:151], a[28:31], v[208:211]
v_max_f32 v240, v240, v115
v_max_f32_e64 v241, v241, -v115
v_mfma_f32_16x16x32_bf16 v[184:187], a[148:151], a[20:23], v[184:187]
s_nop 0
v_permlane32_swap_b32 v240, v241
v_mfma_f32_16x16x32_bf16 v[184:187], a[144:147], a[16:19], v[184:187]
buffer_load_dwordx4 v1, s[4:7], s44 offen offset:3072 sc1 lds
v_mfma_f32_16x16x32_bf16 v[160:163], a[144:147], a[8:11], v[160:163]
v_max_f32 v240, v240, v241
v_mov_b32 v246, v240
v_mfma_f32_16x16x32_bf16 v[160:163], a[148:151], a[12:15], v[160:163]
s_nop 0
v_permlane16_swap_b32 v240, v246
v_mfma_f32_16x16x32_bf16 v[136:139], a[148:151], a[4:7], v[136:139]
v_max_f32 v240, v240, v246
v_mov_b32 v246, v240
v_mfma_f32_16x16x32_bf16 v[136:139], a[144:147], a[0:3], v[136:139]
s_nop 0
v_permlane32_swap_b32 v240, v246
v_pk_mul_f32 v[152:153], v[152:153], v[82:83] op_sel:[0,1] op_sel_hi:[1,1]
v_pk_mul_f32 v[154:155], v[154:155], v[82:83] op_sel:[0,1] op_sel_hi:[1,1]
v_cvt_pk_bf16_f32 v150, v152, v153
v_cvt_pk_bf16_f32 v151, v154, v155
ds_write_b64 v232, v[150:151] offset:512
v_pk_mul_f32 v[172:173], v[172:173], v[84:85] op_sel:[0,1] op_sel_hi:[1,1]
v_pk_mul_f32 v[174:175], v[174:175], v[84:85] op_sel:[0,1] op_sel_hi:[1,1]
v_cvt_pk_bf16_f32 v172, v172, v173
v_cvt_pk_bf16_f32 v173, v174, v175
v_pk_mul_f32 v[176:177], v[176:177], v[84:85] op_sel:[0,1] op_sel_hi:[1,1]
v_pk_mul_f32 v[178:179], v[178:179], v[84:85] op_sel:[0,1] op_sel_hi:[1,1]
v_cvt_pk_bf16_f32 v174, v176, v177
v_cvt_pk_bf16_f32 v175, v178, v179
v_pk_mul_f32 v[196:197], v[196:197], v[86:87] op_sel:[0,1] op_sel_hi:[1,1]
v_pk_mul_f32 v[198:199], v[198:199], v[86:87] op_sel:[0,1] op_sel_hi:[1,1]
v_cvt_pk_bf16_f32 v196, v196, v197
v_cvt_pk_bf16_f32 v197, v198, v199
ds_write_b64 v232, v[172:173] offset:1024
buffer_store_dwordx4 a[248:251], v254, s[4:7], s97 offen offset:0 sc1
v_pk_mul_f32 v[200:201], v[200:201], v[86:87] op_sel:[0,1] op_sel_hi:[1,1]
v_pk_mul_f32 v[202:203], v[202:203], v[86:87] op_sel:[0,1] op_sel_hi:[1,1]
v_cvt_pk_bf16_f32 v198, v200, v201
v_cvt_pk_bf16_f32 v199, v202, v203
v_pk_mul_f32 v[220:221], v[220:221], v[88:89] op_sel:[0,1] op_sel_hi:[1,1]
v_pk_mul_f32 v[222:223], v[222:223], v[88:89] op_sel:[0,1] op_sel_hi:[1,1]
v_cvt_pk_bf16_f32 v220, v220, v221
v_cvt_pk_bf16_f32 v221, v222, v223
ds_write_b64 v232, v[174:175] offset:1536
v_pk_fma_f32 v[48:49], v[92:93], v[82:83], v[236:237] op_sel:[0,0,0] op_sel_hi:[1,0,0]
v_pk_fma_f32 v[50:51], v[94:95], v[82:83], v[236:237] op_sel:[0,0,0] op_sel_hi:[1,0,0]
v_pk_fma_f32 v[52:53], v[96:97], v[82:83], v[236:237] op_sel:[0,0,0] op_sel_hi:[1,0,0]
v_pk_fma_f32 v[54:55], v[98:99], v[82:83], v[236:237] op_sel:[0,0,0] op_sel_hi:[1,0,0]
v_exp_f32 v48, v48
v_exp_f32 v49, v49
v_exp_f32 v50, v50
v_exp_f32 v51, v51
ds_write_b64 v232, v[196:197] offset:2048
v_exp_f32 v52, v52
v_exp_f32 v53, v53
v_exp_f32 v54, v54
v_exp_f32 v55, v55
buffer_store_dwordx4 a[248:251], v1, s[4:7], s96 offen offset:0 sc1
ds_write_b64 v232, v[198:199] offset:2560
v_cvt_pk_bf16_f32 v140, v48, v49
v_cvt_pk_bf16_f32 v141, v50, v51
v_cvt_pk_bf16_f32 v142, v52, v53
v_cvt_pk_bf16_f32 v143, v54, v55
v_pk_mul_f32 v[224:225], v[224:225], v[88:89] op_sel:[0,1] op_sel_hi:[1,1]
v_pk_mul_f32 v[226:227], v[226:227], v[88:89] op_sel:[0,1] op_sel_hi:[1,1]
v_cvt_pk_bf16_f32 v222, v224, v225
v_mfma_f32_16x16x32_bf16 v[148:151], v[16:19], v[140:143], 0
v_cvt_pk_bf16_f32 v223, v226, v227
s_add_u32 m0, s19, 131072
s_add_u32 s44, s86, 0xc18000
ds_write_b64 v232, v[220:221] offset:3072
v_pk_fma_f32 v[92:93], v[92:93], v[82:83], v[236:237] op_sel:[0,0,1] op_sel_hi:[1,0,1] neg_lo:[1,0,0] neg_hi:[1,0,0]
v_pk_fma_f32 v[94:95], v[94:95], v[82:83], v[236:237] op_sel:[0,0,1] op_sel_hi:[1,0,1] neg_lo:[1,0,0] neg_hi:[1,0,0]
s_nop 1
v_rcp_f32 v148, v148
v_pk_fma_f32 v[96:97], v[96:97], v[82:83], v[236:237] op_sel:[0,0,1] op_sel_hi:[1,0,1] neg_lo:[1,0,0] neg_hi:[1,0,0]
v_pk_mul_f32 v[48:49], v[48:49], v[148:149] op_sel:[0,0] op_sel_hi:[1,0]
v_pk_mul_f32 v[50:51], v[50:51], v[148:149] op_sel:[0,0] op_sel_hi:[1,0]
v_cvt_pk_bf16_f32 v140, v48, v49
v_cvt_pk_bf16_f32 v141, v50, v51
v_pk_fma_f32 v[98:99], v[98:99], v[82:83], v[236:237] op_sel:[0,0,1] op_sel_hi:[1,0,1] neg_lo:[1,0,0] neg_hi:[1,0,0]
v_exp_f32 v92, v92
ds_write_b64 v232, v[222:223] offset:3584
v_exp_f32 v93, v93
v_exp_f32 v94, v94
v_exp_f32 v95, v95
v_exp_f32 v96, v96
v_exp_f32 v97, v97
v_exp_f32 v98, v98
ds_write_b64 v233, v[140:141] offset:16384
v_exp_f32 v99, v99
v_cvt_pk_bf16_f32 v144, v92, v93
v_cvt_pk_bf16_f32 v145, v94, v95
v_cvt_pk_bf16_f32 v146, v96, v97
v_cvt_pk_bf16_f32 v147, v98, v99
buffer_load_dwordx4 v1, s[4:7], s44 offen offset:0 sc1 lds
v_pk_mul_f32 v[52:53], v[52:53], v[148:149] op_sel:[0,0] op_sel_hi:[1,0]
v_cvt_pk_bf16_f32 v142, v52, v53
v_pk_mul_f32 v[54:55], v[54:55], v[148:149] op_sel:[0,0] op_sel_hi:[1,0]
v_cvt_pk_bf16_f32 v143, v54, v55
v_mfma_f32_16x16x32_bf16 v[152:155], v[16:19], v[144:147], 0
ds_write_b64 v233, v[142:143] offset:16896
v_mul_f32_e64 v240, -v240, v86
v_mul_f32_e64 v241, -v246, v86
v_pk_fma_f32 v[56:57], v[100:101], v[84:85], v[238:239] op_sel:[0,0,0] op_sel_hi:[1,0,0]
v_pk_fma_f32 v[58:59], v[102:103], v[84:85], v[238:239] op_sel:[0,0,0] op_sel_hi:[1,0,0]
v_pk_fma_f32 v[60:61], v[104:105], v[84:85], v[238:239] op_sel:[0,0,0] op_sel_hi:[1,0,0]
s_nop 1
v_rcp_f32 v152, v152
v_pk_fma_f32 v[62:63], v[106:107], v[84:85], v[238:239] op_sel:[0,0,0] op_sel_hi:[1,0,0]
v_pk_mul_f32 v[92:93], v[92:93], v[152:153] op_sel:[0,0] op_sel_hi:[1,0]
v_pk_mul_f32 v[94:95], v[94:95], v[152:153] op_sel:[0,0] op_sel_hi:[1,0]
v_cvt_pk_bf16_f32 v144, v92, v93
v_cvt_pk_bf16_f32 v145, v94, v95
ds_write_b64 v233, v[144:145] offset:17408
v_exp_f32 v56, v56
v_exp_f32 v57, v57
v_exp_f32 v58, v58
v_exp_f32 v59, v59
v_exp_f32 v60, v60
v_exp_f32 v61, v61
v_exp_f32 v62, v62
v_exp_f32 v63, v63
buffer_load_dwordx4 v1, s[4:7], s44 offen offset:1024 sc1 lds
v_cvt_pk_bf16_f32 v164, v56, v57
v_cvt_pk_bf16_f32 v165, v58, v59
v_cvt_pk_bf16_f32 v166, v60, v61
v_cvt_pk_bf16_f32 v167, v62, v63
v_pk_mul_f32 v[96:97], v[96:97], v[152:153] op_sel:[0,0] op_sel_hi:[1,0]
v_pk_mul_f32 v[98:99], v[98:99], v[152:153] op_sel:[0,0] op_sel_hi:[1,0]
v_cvt_pk_bf16_f32 v146, v96, v97
v_mfma_f32_16x16x32_bf16 v[172:175], v[16:19], v[164:167], 0
v_cvt_pk_bf16_f32 v147, v98, v99
ds_write_b64 v233, v[146:147] offset:17920
v_max3_f32 v242, v116, v117, v118
v_pk_fma_f32 v[100:101], v[100:101], v[84:85], v[238:239] op_sel:[0,0,1] op_sel_hi:[1,0,1] neg_lo:[1,0,0] neg_hi:[1,0,0]
v_pk_fma_f32 v[102:103], v[102:103], v[84:85], v[238:239] op_sel:[0,0,1] op_sel_hi:[1,0,1] neg_lo:[1,0,0] neg_hi:[1,0,0]
v_pk_fma_f32 v[104:105], v[104:105], v[84:85], v[238:239] op_sel:[0,0,1] op_sel_hi:[1,0,1] neg_lo:[1,0,0] neg_hi:[1,0,0]
s_nop 1
v_rcp_f32 v172, v172
v_pk_fma_f32 v[106:107], v[106:107], v[84:85], v[238:239] op_sel:[0,0,1] op_sel_hi:[1,0,1] neg_lo:[1,0,0] neg_hi:[1,0,0]
v_pk_mul_f32 v[56:57], v[56:57], v[172:173] op_sel:[0,0] op_sel_hi:[1,0]
v_pk_mul_f32 v[58:59], v[58:59], v[172:173] op_sel:[0,0] op_sel_hi:[1,0]
v_cvt_pk_bf16_f32 v164, v56, v57
v_cvt_pk_bf16_f32 v165, v58, v59
v_exp_f32 v100, v100
ds_write_b64 v233, v[164:165] offset:18432
v_exp_f32 v101, v101
v_exp_f32 v102, v102
v_exp_f32 v103, v103
v_exp_f32 v104, v104
v_exp_f32 v105, v105
v_exp_f32 v106, v106
v_exp_f32 v107, v107
buffer_load_dwordx4 v1, s[4:7], s44 offen offset:2048 sc1 lds
v_cvt_pk_bf16_f32 v168, v100, v101
v_cvt_pk_bf16_f32 v169, v102, v103
v_cvt_pk_bf16_f32 v170, v104, v105
v_cvt_pk_bf16_f32 v171, v106, v107
v_pk_mul_f32 v[60:61], v[60:61], v[172:173] op_sel:[0,0] op_sel_hi:[1,0]
v_pk_mul_f32 v[62:63], v[62:63], v[172:173] op_sel:[0,0] op_sel_hi:[1,0]
v_cvt_pk_bf16_f32 v166, v60, v61
v_mfma_f32_16x16x32_bf16 v[176:179], v[16:19], v[168:171], 0
v_cvt_pk_bf16_f32 v167, v62, v63
ds_write_b64 v233, v[166:167] offset:18944
v_max3_f32 v243, -v116, -v117, -v118
v_pk_fma_f32 v[64:65], v[108:109], v[86:87], v[240:241] op_sel:[0,0,0] op_sel_hi:[1,0,0]
v_pk_fma_f32 v[66:67], v[110:111], v[86:87], v[240:241] op_sel:[0,0,0] op_sel_hi:[1,0,0]
v_pk_fma_f32 v[68:69], v[112:113], v[86:87], v[240:241] op_sel:[0,0,0] op_sel_hi:[1,0,0]
s_nop 1
v_rcp_f32 v176, v176
v_pk_fma_f32 v[70:71], v[114:115], v[86:87], v[240:241] op_sel:[0,0,0] op_sel_hi:[1,0,0]
v_pk_mul_f32 v[100:101], v[100:101], v[176:177] op_sel:[0,0] op_sel_hi:[1,0]
v_pk_mul_f32 v[102:103], v[102:103], v[176:177] op_sel:[0,0] op_sel_hi:[1,0]
v_cvt_pk_bf16_f32 v168, v100, v101
v_cvt_pk_bf16_f32 v169, v102, v103
v_exp_f32 v64, v64
ds_write_b64 v233, v[168:169] offset:19456
buffer_load_dwordx4 v1, s[4:7], s44 offen offset:3072 sc1 lds
v_exp_f32 v65, v65
v_exp_f32 v66, v66
v_exp_f32 v67, v67
v_exp_f32 v68, v68
v_exp_f32 v69, v69
v_exp_f32 v70, v70
v_exp_f32 v71, v71
v_cvt_pk_bf16_f32 v188, v64, v65
v_cvt_pk_bf16_f32 v189, v66, v67
v_cvt_pk_bf16_f32 v190, v68, v69
v_cvt_pk_bf16_f32 v191, v70, v71
v_pk_mul_f32 v[104:105], v[104:105], v[176:177] op_sel:[0,0] op_sel_hi:[1,0]
v_pk_mul_f32 v[106:107], v[106:107], v[176:177] op_sel:[0,0] op_sel_hi:[1,0]
v_cvt_pk_bf16_f32 v170, v104, v105
v_mfma_f32_16x16x32_bf16 v[196:199], v[16:19], v[188:191], 0
v_cvt_pk_bf16_f32 v171, v106, v107
ds_write_b64 v233, v[170:171] offset:19968
buffer_store_dwordx4 a[248:251], v2, s[4:7], s72 offen offset:0 sc1
s_nop 4
v_rcp_f32 v196, v196
v_pk_fma_f32 v[108:109], v[108:109], v[86:87], v[240:241] op_sel:[0,0,1] op_sel_hi:[1,0,1] neg_lo:[1,0,0] neg_hi:[1,0,0]
v_pk_mul_f32 v[64:65], v[64:65], v[196:197] op_sel:[0,0] op_sel_hi:[1,0]
v_pk_mul_f32 v[66:67], v[66:67], v[196:197] op_sel:[0,0] op_sel_hi:[1,0]
v_cvt_pk_bf16_f32 v188, v64, v65
v_cvt_pk_bf16_f32 v189, v66, v67
v_pk_fma_f32 v[110:111], v[110:111], v[86:87], v[240:241] op_sel:[0,0,1] op_sel_hi:[1,0,1] neg_lo:[1,0,0] neg_hi:[1,0,0]
ds_write_b64 v233, v[188:189] offset:20480
v_pk_fma_f32 v[112:113], v[112:113], v[86:87], v[240:241] op_sel:[0,0,1] op_sel_hi:[1,0,1] neg_lo:[1,0,0] neg_hi:[1,0,0]
v_pk_fma_f32 v[114:115], v[114:115], v[86:87], v[240:241] op_sel:[0,0,1] op_sel_hi:[1,0,1] neg_lo:[1,0,0] neg_hi:[1,0,0]
v_exp_f32 v108, v108
v_exp_f32 v109, v109
v_exp_f32 v110, v110
v_exp_f32 v111, v111
v_exp_f32 v112, v112
v_exp_f32 v113, v113
v_exp_f32 v114, v114
v_exp_f32 v115, v115
v_max3_f32 v242, v242, v119, v120
v_max3_f32 v243, v243, -v119, -v120
v_max3_f32 v242, v242, v121, v122
v_max3_f32 v243, v243, -v121, -v122
v_max_f32 v242, v242, v123
v_max_f32_e64 v243, v243, -v123
v_cvt_pk_bf16_f32 v192, v108, v109
v_cvt_pk_bf16_f32 v193, v110, v111
v_cvt_pk_bf16_f32 v194, v112, v113
v_cvt_pk_bf16_f32 v195, v114, v115
v_pk_mul_f32 v[68:69], v[68:69], v[196:197] op_sel:[0,0] op_sel_hi:[1,0]
v_pk_mul_f32 v[70:71], v[70:71], v[196:197] op_sel:[0,0] op_sel_hi:[1,0]
v_permlane32_swap_b32 v242, v243
v_mfma_f32_16x16x32_bf16 v[200:203], v[16:19], v[192:195], 0
v_cvt_pk_bf16_f32 v190, v68, v69
v_cvt_pk_bf16_f32 v191, v70, v71
ds_write_b64 v233, v[190:191] offset:20992
v_max_f32 v242, v242, v243
v_mov_b32 v247, v242
buffer_store_dwordx4 a[248:251], v2, s[4:7], s72 offen offset:1024 sc1
s_nop 0
v_permlane16_swap_b32 v242, v247
v_rcp_f32 v200, v200
v_max_f32 v242, v242, v247
v_mov_b32 v247, v242
v_pk_mul_f32 v[108:109], v[108:109], v[200:201] op_sel:[0,0] op_sel_hi:[1,0]
v_pk_mul_f32 v[110:111], v[110:111], v[200:201] op_sel:[0,0] op_sel_hi:[1,0]
v_cvt_pk_bf16_f32 v192, v108, v109
v_cvt_pk_bf16_f32 v193, v110, v111
v_permlane32_swap_b32 v242, v247
ds_write_b64 v233, v[192:193] offset:21504
v_mul_f32_e64 v242, -v242, v88
v_mul_f32_e64 v243, -v247, v88
v_pk_fma_f32 v[124:125], v[116:117], v[88:89], v[242:243] op_sel:[0,0,0] op_sel_hi:[1,0,0]
v_pk_fma_f32 v[126:127], v[118:119], v[88:89], v[242:243] op_sel:[0,0,0] op_sel_hi:[1,0,0]
v_pk_fma_f32 v[128:129], v[120:121], v[88:89], v[242:243] op_sel:[0,0,0] op_sel_hi:[1,0,0]
v_pk_fma_f32 v[130:131], v[122:123], v[88:89], v[242:243] op_sel:[0,0,0] op_sel_hi:[1,0,0]
L_stub18:
s_cbranch_execz L_stub19
v_exp_f32 v124, v124
v_exp_f32 v125, v125
v_exp_f32 v126, v126
v_exp_f32 v127, v127
v_exp_f32 v128, v128
v_exp_f32 v129, v129
v_exp_f32 v130, v130
v_exp_f32 v131, v131
v_cvt_pk_bf16_f32 v212, v124, v125
v_cvt_pk_bf16_f32 v213, v126, v127
v_cvt_pk_bf16_f32 v214, v128, v129
v_cvt_pk_bf16_f32 v215, v130, v131
v_pk_mul_f32 v[112:113], v[112:113], v[200:201] op_sel:[0,0] op_sel_hi:[1,0]
v_pk_mul_f32 v[114:115], v[114:115], v[200:201] op_sel:[0,0] op_sel_hi:[1,0]
v_cvt_pk_bf16_f32 v194, v112, v113
v_mfma_f32_16x16x32_bf16 v[220:223], v[16:19], v[212:215], 0
v_cvt_pk_bf16_f32 v195, v114, v115
ds_write_b64 v233, v[194:195] offset:22016
buffer_store_dwordx4 a[248:251], v2, s[4:7], s72 offen offset:2048 sc1
s_nop 4
v_rcp_f32 v220, v220
v_pk_fma_f32 v[116:117], v[116:117], v[88:89], v[242:243] op_sel:[0,0,1] op_sel_hi:[1,0,1] neg_lo:[1,0,0] neg_hi:[1,0,0]
v_pk_mul_f32 v[124:125], v[124:125], v[220:221] op_sel:[0,0] op_sel_hi:[1,0]
v_pk_mul_f32 v[126:127], v[126:127], v[220:221] op_sel:[0,0] op_sel_hi:[1,0]
v_cvt_pk_bf16_f32 v212, v124, v125
v_cvt_pk_bf16_f32 v213, v126, v127
v_pk_fma_f32 v[118:119], v[118:119], v[88:89], v[242:243] op_sel:[0,0,1] op_sel_hi:[1,0,1] neg_lo:[1,0,0] neg_hi:[1,0,0]
ds_write_b64 v233, v[212:213] offset:22528
v_pk_fma_f32 v[120:121], v[120:121], v[88:89], v[242:243] op_sel:[0,0,1] op_sel_hi:[1,0,1] neg_lo:[1,0,0] neg_hi:[1,0,0]
v_pk_fma_f32 v[122:123], v[122:123], v[88:89], v[242:243] op_sel:[0,0,1] op_sel_hi:[1,0,1] neg_lo:[1,0,0] neg_hi:[1,0,0]
v_exp_f32 v116, v116
v_exp_f32 v117, v117
v_exp_f32 v118, v118
v_exp_f32 v119, v119
v_exp_f32 v120, v120
v_exp_f32 v121, v121
v_exp_f32 v122, v122
v_exp_f32 v123, v123
v_cvt_pk_bf16_f32 v216, v116, v117
v_cvt_pk_bf16_f32 v217, v118, v119
v_cvt_pk_bf16_f32 v218, v120, v121
v_cvt_pk_bf16_f32 v219, v122, v123
v_pk_mul_f32 v[128:129], v[128:129], v[220:221] op_sel:[0,0] op_sel_hi:[1,0]
v_pk_mul_f32 v[130:131], v[130:131], v[220:221] op_sel:[0,0] op_sel_hi:[1,0]
v_cvt_pk_bf16_f32 v214, v128, v129
v_mfma_f32_16x16x32_bf16 v[224:227], v[16:19], v[216:219], 0
v_cvt_pk_bf16_f32 v215, v130, v131
ds_write_b64 v233, v[214:215] offset:23040
buffer_store_dwordx4 a[248:251], v2, s[4:7], s72 offen offset:3072 sc1
s_nop 4
v_rcp_f32 v224, v224
s_nop 0
v_pk_mul_f32 v[116:117], v[116:117], v[224:225] op_sel:[0,0] op_sel_hi:[1,0]
v_pk_mul_f32 v[118:119], v[118:119], v[224:225] op_sel:[0,0] op_sel_hi:[1,0]
v_cvt_pk_bf16_f32 v216, v116, v117
v_cvt_pk_bf16_f32 v217, v118, v119
v_pk_mul_f32 v[120:121], v[120:121], v[224:225] op_sel:[0,0] op_sel_hi:[1,0]
ds_write_b64 v233, v[216:217] offset:23552
v_pk_mul_f32 v[122:123], v[122:123], v[224:225] op_sel:[0,0] op_sel_hi:[1,0]
v_cvt_pk_bf16_f32 v218, v120, v121
v_cvt_pk_bf16_f32 v219, v122, v123
ds_write_b64 v233, v[218:219] offset:24064
s_waitcnt vmcnt(8)
s_waitcnt lgkmcnt(0)
s_barrier
ds_read_b64_tr_b16 a[0:1], v234 offset:16384
ds_read_b64_tr_b16 a[2:3], v234 offset:18432
ds_read_b64_tr_b16 a[12:13], v234 offset:20480
ds_read_b64_tr_b16 a[14:15], v234 offset:22528
ds_read_b64_tr_b16 a[24:25], v234 offset:24576
ds_read_b64_tr_b16 a[26:27], v234 offset:26624
ds_read_b64_tr_b16 a[4:5], v8 offset:0
ds_read_b64_tr_b16 a[6:7], v8 offset:1024
ds_read_b64_tr_b16 a[8:9], v8 offset:512
ds_read_b64_tr_b16 a[10:11], v8 offset:1536
ds_read_b64_tr_b16 a[36:37], v234 offset:28672
ds_read_b64_tr_b16 a[38:39], v234 offset:30720
ds_read_b64_tr_b16 a[16:17], v8 offset:2048
ds_read_b64_tr_b16 a[18:19], v8 offset:3072
ds_read_b64_tr_b16 a[20:21], v8 offset:2560
ds_read_b64_tr_b16 a[22:23], v8 offset:3584
ds_read_b64_tr_b16 a[48:49], v234 offset:32768
ds_read_b64_tr_b16 a[50:51], v234 offset:34816
ds_read_b64_tr_b16 a[28:29], v8 offset:4096
ds_read_b64_tr_b16 a[30:31], v8 offset:5120
ds_read_b64_tr_b16 a[32:33], v8 offset:4608
ds_read_b64_tr_b16 a[34:35], v8 offset:5632
ds_read_b64_tr_b16 a[60:61], v234 offset:36864
ds_read_b64_tr_b16 a[62:63], v234 offset:38912
s_waitcnt lgkmcnt(14)
v_mfma_f32_16x16x32_bf16 v[100:103], a[0:3], v[16:19], 0
ds_read_b64_tr_b16 a[40:41], v8 offset:6144
ds_read_b64_tr_b16 a[42:43], v8 offset:7168
ds_read_b64_tr_b16 a[44:45], v8 offset:6656
ds_read_b64_tr_b16 a[46:47], v8 offset:7680
ds_read_b64_tr_b16 a[72:73], v234 offset:40960
ds_read_b64_tr_b16 a[74:75], v234 offset:43008
v_mfma_f32_16x16x32_bf16 v[100:103], a[12:15], v[16:19], v[100:103]
buffer_atomic_add v12, v235, s[4:7], s94 offen sc1
ds_read_b64_tr_b16 a[52:53], v8 offset:8192
ds_read_b64_tr_b16 a[54:55], v8 offset:9216
ds_read_b64_tr_b16 a[56:57], v8 offset:8704
ds_read_b64_tr_b16 a[58:59], v8 offset:9728
ds_read_b64_tr_b16 a[84:85], v234 offset:45056
ds_read_b64_tr_b16 a[86:87], v234 offset:47104
v_mfma_f32_16x16x32_bf16 v[100:103], a[24:27], v[16:19], v[100:103]
ds_read_b64_tr_b16 a[64:65], v8 offset:10240
ds_read_b64_tr_b16 a[66:67], v8 offset:11264
v_mfma_f32_16x16x32_bf16 v[92:95], a[0:3], a[4:7], 0
ds_read_b64_tr_b16 a[68:69], v8 offset:10752
ds_read_b64_tr_b16 a[70:71], v8 offset:11776
v_mfma_f32_16x16x32_bf16 v[96:99], a[0:3], a[8:11], 0
ds_read_b64_tr_b16 a[76:77], v8 offset:12288
s_waitcnt lgkmcnt(14)
v_mfma_f32_16x16x32_bf16 v[100:103], a[36:39], v[16:19], v[100:103]
ds_read_b64_tr_b16 a[78:79], v8 offset:13312
v_mfma_f32_16x16x32_bf16 v[92:95], a[12:15], a[16:19], v[92:95]
ds_read_b64_tr_b16 a[80:81], v8 offset:12800
ds_read_b64_tr_b16 a[82:83], v8 offset:13824
v_mfma_f32_16x16x32_bf16 v[96:99], a[12:15], a[20:23], v[96:99]
ds_read_b64_tr_b16 a[88:89], v8 offset:14336
v_mfma_f32_16x16x32_bf16 v[100:103], a[48:51], v[16:19], v[100:103]
ds_read_b64_tr_b16 a[90:91], v8 offset:15360
v_mfma_f32_16x16x32_bf16 v[92:95], a[24:27], a[28:31], v[92:95]
ds_read_b64_tr_b16 a[92:93], v8 offset:14848
ds_read_b64_tr_b16 a[94:95], v8 offset:15872
v_mfma_f32_16x16x32_bf16 v[96:99], a[24:27], a[32:35], v[96:99]
v_cvt_pk_bf16_f32 v132, v132, v133
v_cvt_pk_bf16_f32 v156, v156, v157
v_mfma_f32_16x16x32_bf16 v[100:103], a[60:63], v[16:19], v[100:103]
v_cvt_pk_bf16_f32 v180, v180, v181
v_cvt_pk_bf16_f32 v204, v204, v205
v_mfma_f32_16x16x32_bf16 v[92:95], a[36:39], a[40:43], v[92:95]
v_cvt_pk_bf16_f32 v133, v134, v135
v_cvt_pk_bf16_f32 v157, v158, v159
s_waitcnt lgkmcnt(14)
v_mfma_f32_16x16x32_bf16 v[96:99], a[36:39], a[44:47], v[96:99]
v_cvt_pk_bf16_f32 v181, v182, v183
v_cvt_pk_bf16_f32 v205, v206, v207
v_mfma_f32_16x16x32_bf16 v[100:103], a[72:75], v[16:19], v[100:103]
v_cvt_pk_bf16_f32 v134, v136, v137
v_cvt_pk_bf16_f32 v135, v138, v139
v_mfma_f32_16x16x32_bf16 v[92:95], a[48:51], a[52:55], v[92:95]
v_cvt_pk_bf16_f32 v158, v160, v161
v_cvt_pk_bf16_f32 v159, v162, v163
v_mfma_f32_16x16x32_bf16 v[96:99], a[48:51], a[56:59], v[96:99]
v_cvt_pk_bf16_f32 v182, v184, v185
v_cvt_pk_bf16_f32 v183, v186, v187
s_waitcnt lgkmcnt(12)
v_mfma_f32_16x16x32_bf16 v[100:103], a[84:87], v[16:19], v[100:103]
v_cvt_pk_bf16_f32 v206, v208, v209
v_cvt_pk_bf16_f32 v207, v210, v211
s_waitcnt lgkmcnt(10)
v_mfma_f32_16x16x32_bf16 v[92:95], a[60:63], a[64:67], v[92:95]
s_waitcnt lgkmcnt(8)
v_mfma_f32_16x16x32_bf16 v[96:99], a[60:63], a[68:71], v[96:99]
s_nop 1
v_min_u32 v100, -2, v100
v_min_u32 v101, -2, v101
s_waitcnt lgkmcnt(6)
v_mfma_f32_16x16x32_bf16 v[92:95], a[72:75], a[76:79], v[92:95]
v_min_u32 v102, -2, v102
v_min_u32 v103, -2, v103
s_waitcnt lgkmcnt(4)
v_mfma_f32_16x16x32_bf16 v[96:99], a[72:75], a[80:83], v[96:99]
buffer_store_dwordx4 v[100:103], v254, s[4:7], s97 offen sc1
s_waitcnt lgkmcnt(2)
v_mfma_f32_16x16x32_bf16 v[92:95], a[84:87], a[88:91], v[92:95]
s_waitcnt lgkmcnt(0)
v_mfma_f32_16x16x32_bf16 v[96:99], a[84:87], a[92:95], v[96:99]
s_nop 5
v_cvt_pk_bf16_f32 v92, v92, v93
v_cvt_pk_bf16_f32 v93, v94, v95
v_min_u32 v92, -2, v92
v_min_u32 v93, -2, v93
v_cvt_pk_bf16_f32 v94, v96, v97
v_cvt_pk_bf16_f32 v95, v98, v99
v_min_u32 v94, -2, v94
v_min_u32 v95, -2, v95
buffer_store_dwordx4 v[92:95], v1, s[4:7], s96 offen sc1
s_barrier
s_add_u32 m0, s19, 32768
s_add_u32 s44, s84, 0xc00000
buffer_load_dwordx4 v1, s[4:7], s44 offen offset:0 sc1 lds
v_mfma_f32_16x16x32_bf16 v[108:111], a[240:243], v[132:135], 0
v_mfma_f32_16x16x32_bf16 v[172:175], a[240:243], v[156:159], 0
v_mfma_f32_16x16x32_bf16 v[112:115], a[244:247], v[132:135], 0
s_nop 5
v_max3_f32 v236, v108, v109, v110
v_max3_f32 v237, -v108, -v109, -v110
v_mfma_f32_16x16x32_bf16 v[176:179], a[244:247], v[156:159], 0
v_max3_f32 v238, v172, v173, v174
v_max3_f32 v239, -v172, -v173, -v174
v_max3_f32 v236, v236, v111, v112
v_max3_f32 v237, v237, -v111, -v112
v_max3_f32 v236, v236, v113, v114
v_max3_f32 v237, v237, -v113, -v114
s_nop 1
v_max3_f32 v238, v238, v175, v176
v_max3_f32 v239, v239, -v175, -v176
v_max3_f32 v238, v238, v177, v178
v_max3_f32 v239, v239, -v177, -v178
v_max_f32 v236, v236, v115
buffer_load_dwordx4 v1, s[4:7], s44 offen offset:1024 sc1 lds
v_max_f32_e64 v237, v237, -v115
v_max_f32 v238, v238, v179
v_max_f32_e64 v239, v239, -v179
v_permlane32_swap_b32 v236, v237
s_nop 0
v_permlane32_swap_b32 v238, v239
v_mov_b32 v11, 0
buffer_atomic_add v11, v251, s[4:7], s89 offen sc0 sc1
v_max_f32 v236, v236, v237
v_max_f32 v238, v238, v239
v_mov_b32 v244, v236
v_mov_b32 v245, v238
s_nop 0
v_permlane16_swap_b32 v236, v244
v_permlane16_swap_b32 v238, v245
v_max_f32 v236, v236, v244
v_max_f32 v238, v238, v245
v_mov_b32 v244, v236
v_mov_b32 v245, v238
s_nop 0
v_permlane32_swap_b32 v236, v244
v_permlane32_swap_b32 v238, v245
v_mul_f32_e64 v236, -v236, v82
v_mul_f32_e64 v237, -v244, v82
buffer_load_dwordx4 v1, s[4:7], s44 offen offset:2048 sc1 lds
v_mul_f32_e64 v238, -v238, v84
v_mul_f32_e64 v239, -v245, v84
v_pk_fma_f32 v[116:117], v[108:109], v[82:83], v[236:237] op_sel:[0,0,0] op_sel_hi:[1,0,0]
v_pk_fma_f32 v[118:119], v[110:111], v[82:83], v[236:237] op_sel:[0,0,0] op_sel_hi:[1,0,0]
v_pk_fma_f32 v[120:121], v[112:113], v[82:83], v[236:237] op_sel:[0,0,0] op_sel_hi:[1,0,0]
v_pk_fma_f32 v[122:123], v[114:115], v[82:83], v[236:237] op_sel:[0,0,0] op_sel_hi:[1,0,0]
v_pk_fma_f32 v[148:149], v[172:173], v[84:85], v[238:239] op_sel:[0,0,0] op_sel_hi:[1,0,0]
v_pk_fma_f32 v[150:151], v[174:175], v[84:85], v[238:239] op_sel:[0,0,0] op_sel_hi:[1,0,0]
v_pk_fma_f32 v[152:153], v[176:177], v[84:85], v[238:239] op_sel:[0,0,0] op_sel_hi:[1,0,0]
v_pk_fma_f32 v[154:155], v[178:179], v[84:85], v[238:239] op_sel:[0,0,0] op_sel_hi:[1,0,0]
v_pk_fma_f32 v[108:109], v[108:109], v[82:83], v[236:237] op_sel:[0,0,1] op_sel_hi:[1,0,1] neg_lo:[1,0,0] neg_hi:[1,0,0]
v_pk_fma_f32 v[110:111], v[110:111], v[82:83], v[236:237] op_sel:[0,0,1] op_sel_hi:[1,0,1] neg_lo:[1,0,0] neg_hi:[1,0,0]
v_pk_fma_f32 v[112:113], v[112:113], v[82:83], v[236:237] op_sel:[0,0,1] op_sel_hi:[1,0,1] neg_lo:[1,0,0] neg_hi:[1,0,0]
v_pk_fma_f32 v[114:115], v[114:115], v[82:83], v[236:237] op_sel:[0,0,1] op_sel_hi:[1,0,1] neg_lo:[1,0,0] neg_hi:[1,0,0]
v_pk_fma_f32 v[172:173], v[172:173], v[84:85], v[238:239] op_sel:[0,0,1] op_sel_hi:[1,0,1] neg_lo:[1,0,0] neg_hi:[1,0,0]
v_pk_fma_f32 v[174:175], v[174:175], v[84:85], v[238:239] op_sel:[0,0,1] op_sel_hi:[1,0,1] neg_lo:[1,0,0] neg_hi:[1,0,0]
v_pk_fma_f32 v[176:177], v[176:177], v[84:85], v[238:239] op_sel:[0,0,1] op_sel_hi:[1,0,1] neg_lo:[1,0,0] neg_hi:[1,0,0]
v_pk_fma_f32 v[178:179], v[178:179], v[84:85], v[238:239] op_sel:[0,0,1] op_sel_hi:[1,0,1] neg_lo:[1,0,0] neg_hi:[1,0,0]
v_exp_f32 v116, v116
v_exp_f32 v108, v108
v_exp_f32 v117, v117
v_exp_f32 v109, v109
v_exp_f32 v118, v118
v_exp_f32 v110, v110
v_exp_f32 v119, v119
v_exp_f32 v111, v111
v_exp_f32 v120, v120
v_exp_f32 v112, v112
v_exp_f32 v121, v121
v_exp_f32 v113, v113
v_exp_f32 v122, v122
v_exp_f32 v114, v114
v_exp_f32 v123, v123
v_exp_f32 v115, v115
v_exp_f32 v148, v148
v_exp_f32 v172, v172
v_exp_f32 v149, v149
v_exp_f32 v173, v173
v_exp_f32 v150, v150
v_exp_f32 v174, v174
v_exp_f32 v151, v151
v_exp_f32 v175, v175
v_exp_f32 v152, v152
v_exp_f32 v176, v176
v_exp_f32 v153, v153
v_exp_f32 v177, v177
v_exp_f32 v154, v154
v_exp_f32 v178, v178
v_exp_f32 v155, v155
v_exp_f32 v179, v179
buffer_load_dwordx4 v1, s[4:7], s44 offen offset:3072 sc1 lds
v_cvt_pk_bf16_f32 v140, v116, v117
v_cvt_pk_bf16_f32 v141, v118, v119
v_cvt_pk_bf16_f32 v142, v120, v121
v_cvt_pk_bf16_f32 v143, v122, v123
v_cvt_pk_bf16_f32 v144, v108, v109
v_cvt_pk_bf16_f32 v145, v110, v111
v_cvt_pk_bf16_f32 v146, v112, v113
v_cvt_pk_bf16_f32 v147, v114, v115
v_cvt_pk_bf16_f32 v164, v148, v149
v_cvt_pk_bf16_f32 v165, v150, v151
v_cvt_pk_bf16_f32 v166, v152, v153
v_cvt_pk_bf16_f32 v167, v154, v155
v_cvt_pk_bf16_f32 v168, v172, v173
v_cvt_pk_bf16_f32 v169, v174, v175
v_cvt_pk_bf16_f32 v170, v176, v177
v_cvt_pk_bf16_f32 v171, v178, v179
s_waitcnt vmcnt(2)
v_readfirstlane_b32 s38, v11
s_nop 0
s_cmp_ge_u32 s38, 8
s_cbranch_scc1 Lpe_41
s_add_u32 s36, s88, 0x90000
s_mov_b32 s37, 0
Lpoll_40:
v_mov_b32 v11, 0
buffer_atomic_add v11, v251, s[4:7], s36 offen sc0 sc1
s_add_u32 s37, s37, 1
s_waitcnt vmcnt(0)
v_readfirstlane_b32 s38, v11
s_nop 0
s_cmp_ge_u32 s38, 8
s_cbranch_scc1 Lpe_41
s_cmp_lt_u32 s37, 0x100000
s_cbranch_scc1 Lpoll_40
Lpe_41:
buffer_load_dwordx4 v[48:51], v1, s[4:7], s98 offen offset:0 sc1
v_mfma_f32_16x16x32_bf16 v[108:111], a[240:243], v[180:183], 0
v_mfma_f32_16x16x32_bf16 v[220:223], a[240:243], v[204:207], 0
v_mfma_f32_16x16x32_bf16 v[112:115], a[244:247], v[180:183], 0
s_nop 5
v_max3_f32 v240, v108, v109, v110
v_max3_f32 v241, -v108, -v109, -v110
v_mfma_f32_16x16x32_bf16 v[224:227], a[244:247], v[204:207], 0
buffer_load_dwordx4 v[124:127], v248, s[4:7], s100 offen sc1
v_max3_f32 v242, v220, v221, v222
v_max3_f32 v243, -v220, -v221, -v222
v_max3_f32 v240, v240, v111, v112
v_max3_f32 v241, v241, -v111, -v112
v_max3_f32 v240, v240, v113, v114
s_nop 1
v_max3_f32 v242, v242, v223, v224
v_max3_f32 v243, v243, -v223, -v224
v_max3_f32 v241, v241, -v113, -v114
v_max3_f32 v242, v242, v225, v226
v_max3_f32 v243, v243, -v225, -v226
v_max_f32 v240, v240, v115
v_max_f32_e64 v241, v241, -v115
v_max_f32 v242, v242, v227
buffer_load_dwordx4 v[52:55], v1, s[4:7], s98 offen offset:1024 sc1
v_max_f32_e64 v243, v243, -v227
v_permlane32_swap_b32 v240, v241
s_nop 0
v_permlane32_swap_b32 v242, v243
v_max_f32 v240, v240, v241
v_max_f32 v242, v242, v243
v_mov_b32 v246, v240
v_mov_b32 v247, v242
s_nop 0
v_permlane16_swap_b32 v240, v246
v_permlane16_swap_b32 v242, v247
buffer_load_dwordx4 v[56:59], v1, s[4:7], s98 offen offset:2048 sc1
v_max_f32 v240, v240, v246
v_max_f32 v242, v242, v247
v_mov_b32 v246, v240
v_mov_b32 v247, v242
s_nop 0
v_permlane32_swap_b32 v240, v246
v_permlane32_swap_b32 v242, v247
v_mul_f32_e64 v240, -v240, v86
v_mul_f32_e64 v241, -v246, v86
v_mul_f32_e64 v242, -v242, v88
v_mul_f32_e64 v243, -v247, v88
buffer_load_dwordx4 v[60:63], v1, s[4:7], s98 offen offset:3072 sc1
v_pk_fma_f32 v[116:117], v[108:109], v[86:87], v[240:241] op_sel:[0,0,0] op_sel_hi:[1,0,0]
v_pk_fma_f32 v[118:119], v[110:111], v[86:87], v[240:241] op_sel:[0,0,0] op_sel_hi:[1,0,0]
v_pk_fma_f32 v[120:121], v[112:113], v[86:87], v[240:241] op_sel:[0,0,0] op_sel_hi:[1,0,0]
v_pk_fma_f32 v[122:123], v[114:115], v[86:87], v[240:241] op_sel:[0,0,0] op_sel_hi:[1,0,0]
v_pk_fma_f32 v[196:197], v[220:221], v[88:89], v[242:243] op_sel:[0,0,0] op_sel_hi:[1,0,0]
v_pk_fma_f32 v[198:199], v[222:223], v[88:89], v[242:243] op_sel:[0,0,0] op_sel_hi:[1,0,0]
v_pk_fma_f32 v[200:201], v[224:225], v[88:89], v[242:243] op_sel:[0,0,0] op_sel_hi:[1,0,0]
v_pk_fma_f32 v[202:203], v[226:227], v[88:89], v[242:243] op_sel:[0,0,0] op_sel_hi:[1,0,0]
v_pk_fma_f32 v[108:109], v[108:109], v[86:87], v[240:241] op_sel:[0,0,1] op_sel_hi:[1,0,1] neg_lo:[1,0,0] neg_hi:[1,0,0]
v_pk_fma_f32 v[110:111], v[110:111], v[86:87], v[240:241] op_sel:[0,0,1] op_sel_hi:[1,0,1] neg_lo:[1,0,0] neg_hi:[1,0,0]
v_pk_fma_f32 v[112:113], v[112:113], v[86:87], v[240:241] op_sel:[0,0,1] op_sel_hi:[1,0,1] neg_lo:[1,0,0] neg_hi:[1,0,0]
v_pk_fma_f32 v[114:115], v[114:115], v[86:87], v[240:241] op_sel:[0,0,1] op_sel_hi:[1,0,1] neg_lo:[1,0,0] neg_hi:[1,0,0]
v_pk_fma_f32 v[220:221], v[220:221], v[88:89], v[242:243] op_sel:[0,0,1] op_sel_hi:[1,0,1] neg_lo:[1,0,0] neg_hi:[1,0,0]
buffer_load_dwordx4 v[64:67], v1, s[4:7], s99 offen offset:0 sc1
v_pk_fma_f32 v[222:223], v[222:223], v[88:89], v[242:243] op_sel:[0,0,1] op_sel_hi:[1,0,1] neg_lo:[1,0,0] neg_hi:[1,0,0]
v_pk_fma_f32 v[224:225], v[224:225], v[88:89], v[242:243] op_sel:[0,0,1] op_sel_hi:[1,0,1] neg_lo:[1,0,0] neg_hi:[1,0,0]
v_pk_fma_f32 v[226:227], v[226:227], v[88:89], v[242:243] op_sel:[0,0,1] op_sel_hi:[1,0,1] neg_lo:[1,0,0] neg_hi:[1,0,0]
v_exp_f32 v116, v116
v_exp_f32 v108, v108
v_exp_f32 v117, v117
v_exp_f32 v109, v109
v_exp_f32 v118, v118
buffer_load_dwordx4 v[68:71], v1, s[4:7], s99 offen offset:1024 sc1
v_exp_f32 v110, v110
v_exp_f32 v119, v119
v_exp_f32 v111, v111
v_exp_f32 v120, v120
v_exp_f32 v112, v112
v_exp_f32 v121, v121
v_exp_f32 v113, v113
buffer_load_dwordx4 v[100:103], v1, s[4:7], s99 offen offset:2048 sc1
v_exp_f32 v122, v122
v_exp_f32 v114, v114
v_exp_f32 v123, v123
v_exp_f32 v115, v115
v_exp_f32 v196, v196
v_exp_f32 v220, v220
v_exp_f32 v197, v197
buffer_load_dwordx4 v[104:107], v1, s[4:7], s99 offen offset:3072 sc1
v_exp_f32 v221, v221
v_exp_f32 v198, v198
v_exp_f32 v222, v222
v_exp_f32 v199, v199
v_exp_f32 v223, v223
v_exp_f32 v200, v200
v_exp_f32 v224, v224
v_exp_f32 v201, v201
v_exp_f32 v225, v225
v_exp_f32 v202, v202
v_exp_f32 v226, v226
v_exp_f32 v203, v203
v_exp_f32 v227, v227
v_cvt_pk_bf16_f32 v188, v116, v117
v_cvt_pk_bf16_f32 v189, v118, v119
v_cvt_pk_bf16_f32 v190, v120, v121
v_cvt_pk_bf16_f32 v191, v122, v123
v_cvt_pk_bf16_f32 v192, v108, v109
v_cvt_pk_bf16_f32 v193, v110, v111
v_cvt_pk_bf16_f32 v194, v112, v113
v_cvt_pk_bf16_f32 v195, v114, v115
v_cvt_pk_bf16_f32 v212, v196, v197
v_cvt_pk_bf16_f32 v213, v198, v199
v_cvt_pk_bf16_f32 v214, v200, v201
v_cvt_pk_bf16_f32 v215, v202, v203
v_cvt_pk_bf16_f32 v216, v220, v221
v_cvt_pk_bf16_f32 v217, v222, v223
v_cvt_pk_bf16_f32 v218, v224, v225
v_cvt_pk_bf16_f32 v219, v226, v227
s_waitcnt vmcnt(8)
v_lshlrev_b32 v92, 16, v48
v_and_b32 v93, 0xffff0000, v48
v_lshlrev_b32 v94, 16, v49
v_and_b32 v95, 0xffff0000, v49
v_lshlrev_b32 v96, 16, v50
v_and_b32 v97, 0xffff0000, v50
v_lshlrev_b32 v98, 16, v51
v_and_b32 v99, 0xffff0000, v51
s_waitcnt vmcnt(7)
v_add_f32_dpp v128, v124, v124 row_ror:4 row_mask:0xf bank_mask:0xf
v_add_f32_dpp v129, v125, v125 row_ror:4 row_mask:0xf bank_mask:0xf
v_add_f32_dpp v130, v126, v126 row_ror:4 row_mask:0xf bank_mask:0xf
v_add_f32_dpp v131, v127, v127 row_ror:4 row_mask:0xf bank_mask:0xf
v_add_f32_dpp v128, v128, v128 row_ror:2 row_mask:0xf bank_mask:0xf
v_add_f32_dpp v129, v129, v129 row_ror:2 row_mask:0xf bank_mask:0xf
v_add_f32_dpp v130, v130, v130 row_ror:2 row_mask:0xf bank_mask:0xf
v_add_f32_dpp v131, v131, v131 row_ror:2 row_mask:0xf bank_mask:0xf
v_add_f32_dpp v128, v128, v128 row_ror:1 row_mask:0xf bank_mask:0xf
v_add_f32_dpp v129, v129, v129 row_ror:1 row_mask:0xf bank_mask:0xf
v_add_f32_dpp v130, v130, v130 row_ror:1 row_mask:0xf bank_mask:0xf
v_add_f32_dpp v131, v131, v131 row_ror:1 row_mask:0xf bank_mask:0xf
v_fma_f32 v135, v129, v130, v131
s_waitcnt vmcnt(6)
v_dot2c_f32_bf16 v92, v52, v249
v_dot2c_f32_bf16 v93, v52, v250
v_dot2c_f32_bf16 v94, v53, v249
v_dot2c_f32_bf16 v95, v53, v250
v_dot2c_f32_bf16 v96, v54, v249
v_dot2c_f32_bf16 v97, v54, v250
v_dot2c_f32_bf16 v98, v55, v249
v_dot2c_f32_bf16 v99, v55, v250
s_waitcnt vmcnt(5)
v_dot2c_f32_bf16 v92, v56, v249
v_dot2c_f32_bf16 v93, v56, v250
v_dot2c_f32_bf16 v94, v57, v249
v_dot2c_f32_bf16 v95, v57, v250
v_dot2c_f32_bf16 v96, v58, v249
v_dot2c_f32_bf16 v97, v58, v250
v_dot2c_f32_bf16 v98, v59, v249
v_dot2c_f32_bf16 v99, v59, v250
s_waitcnt vmcnt(4)
v_dot2c_f32_bf16 v92, v60, v249
v_dot2c_f32_bf16 v93, v60, v250
v_dot2c_f32_bf16 v94, v61, v249
v_dot2c_f32_bf16 v95, v61, v250
v_dot2c_f32_bf16 v96, v62, v249
v_dot2c_f32_bf16 v97, v62, v250
v_dot2c_f32_bf16 v98, v63, v249
v_dot2c_f32_bf16 v99, v63, v250
s_waitcnt vmcnt(3)
v_dot2c_f32_bf16 v92, v64, v249
v_dot2c_f32_bf16 v93, v64, v250
v_dot2c_f32_bf16 v94, v65, v249
v_dot2c_f32_bf16 v95, v65, v250
v_dot2c_f32_bf16 v96, v66, v249
v_dot2c_f32_bf16 v97, v66, v250
v_dot2c_f32_bf16 v98, v67, v249
v_dot2c_f32_bf16 v99, v67, v250
s_waitcnt vmcnt(2)
v_dot2c_f32_bf16 v92, v68, v249
v_dot2c_f32_bf16 v93, v68, v250
v_dot2c_f32_bf16 v94, v69, v249
v_dot2c_f32_bf16 v95, v69, v250
v_dot2c_f32_bf16 v96, v70, v249
v_dot2c_f32_bf16 v97, v70, v250
v_dot2c_f32_bf16 v98, v71, v249
v_dot2c_f32_bf16 v99, v71, v250
s_waitcnt vmcnt(1)
v_dot2c_f32_bf16 v92, v100, v249
v_dot2c_f32_bf16 v93, v100, v250
v_dot2c_f32_bf16 v94, v101, v249
v_dot2c_f32_bf16 v95, v101, v250
v_dot2c_f32_bf16 v96, v102, v249
v_dot2c_f32_bf16 v97, v102, v250
v_dot2c_f32_bf16 v98, v103, v249
v_dot2c_f32_bf16 v99, v103, v250
s_waitcnt vmcnt(0)
v_dot2c_f32_bf16 v92, v104, v249
v_dot2c_f32_bf16 v93, v104, v250
v_dot2c_f32_bf16 v94, v105, v249
v_dot2c_f32_bf16 v95, v105, v250
v_dot2c_f32_bf16 v96, v106, v249
v_dot2c_f32_bf16 v97, v106, v250
v_dot2c_f32_bf16 v98, v107, v249
v_dot2c_f32_bf16 v99, v107, v250
v_fma_f32 v132, v92, v93, v94
v_fma_f32 v133, v95, v96, v97
s_nop 0
v_fma_f32 v134, v98, v99, v128
v_fma_f32 v132, v132, v133, v134
v_cmp_u_f32 vcc, v132, v135
s_cbranch_vccnz L_kvredo3
L_kvback3:
v_cvt_pk_bf16_f32 v128, v128, v129
v_cvt_pk_bf16_f32 v129, v130, v131
v_cvt_pk_bf16_f32 v92, v92, v93
v_cndmask_b32 v128, 0, v128, s[56:57]
v_cndmask_b32 v129, 0, v129, s[56:57]
v_cvt_pk_bf16_f32 v93, v94, v95
v_cvt_pk_bf16_f32 v94, v96, v97
v_cvt_pk_bf16_f32 v95, v98, v99
v_cndmask_b32 v128, v128, v16, s[58:59]
v_cndmask_b32 v129, v129, v16, s[58:59]
ds_write_b64 v252, v[92:93] offset:0
ds_write_b64 v252, v[94:95] offset:1024
ds_write_b64 v252, v[128:129] offset:2048
s_waitcnt lgkmcnt(0)
s_barrier
ds_read_b128 a[8:11], v1 offset:2048
ds_read_b128 a[20:23], v1 offset:5120
ds_read_b128 a[0:3], v1 offset:0
ds_read_b128 a[12:15], v1 offset:3072
ds_read_b128 a[4:7], v1 offset:1024
ds_read_b128 a[16:19], v1 offset:4096
s_waitcnt lgkmcnt(5)
v_mfma_f32_16x16x32_bf16 v[116:119], a[8:11], v[212:215], 0
s_waitcnt lgkmcnt(4)
v_mfma_f32_16x16x32_bf16 v[120:123], a[20:23], v[216:219], 0
s_waitcnt lgkmcnt(3)
v_mfma_f32_16x16x32_bf16 v[204:207], a[0:3], v[212:215], 0
s_nop 3
v_rcp_f32 v118, v117
s_waitcnt lgkmcnt(2)
v_mfma_f32_16x16x32_bf16 v[220:223], a[12:15], v[216:219], 0
v_rcp_f32 v119, v121
v_mul_f32 v116, v116, v118
v_fmac_f32 v116, v120, v119
v_mfma_f32_16x16x32_bf16 v[100:103], a[8:11], v[164:167], 0
v_add_f32 v116, 0x358637bd, v116
v_rcp_f32 v116, v116
s_waitcnt lgkmcnt(1)
v_mfma_f32_16x16x32_bf16 v[208:211], a[4:7], v[212:215], 0
v_mul_f32 v118, v118, v116
v_mul_f32 v119, v119, v116
v_mfma_f32_16x16x32_bf16 v[104:107], a[20:23], v[168:171], 0
v_mul_f32 v204, v204, v118
v_mul_f32 v205, v205, v118
s_waitcnt lgkmcnt(0)
v_mfma_f32_16x16x32_bf16 v[224:227], a[16:19], v[216:219], 0
v_mul_f32 v206, v206, v118
v_mul_f32 v207, v207, v118
v_fmac_f32 v204, v220, v119
v_fmac_f32 v205, v221, v119
v_rcp_f32 v102, v101
v_mul_f32 v208, v208, v118
v_mul_f32 v209, v209, v118
v_mul_f32 v210, v210, v118
v_mul_f32 v211, v211, v118
v_fmac_f32 v206, v222, v119
v_fmac_f32 v207, v223, v119
v_cvt_pk_bf16_f32 v204, v204, v205
v_rcp_f32 v103, v105
v_fmac_f32 v208, v224, v119
v_fmac_f32 v209, v225, v119
v_fmac_f32 v210, v226, v119
v_fmac_f32 v211, v227, v119
v_cvt_pk_bf16_f32 v205, v206, v207
v_cvt_pk_bf16_f32 v206, v208, v209
v_cvt_pk_bf16_f32 v207, v210, v211
v_mul_f32 v100, v100, v102
v_mfma_f32_16x16x32_bf16 v[156:159], a[0:3], v[164:167], 0
buffer_store_dwordx4 v[204:207], v2, s[4:7], s72 offen offset:3072 sc1
v_fmac_f32 v100, v104, v103
v_mfma_f32_16x16x32_bf16 v[172:175], a[12:15], v[168:171], 0
v_add_f32 v100, 0x358637bd, v100
v_rcp_f32 v100, v100
v_mfma_f32_16x16x32_bf16 v[108:111], a[8:11], v[188:191], 0
v_mul_f32 v102, v102, v100
v_mul_f32 v103, v103, v100
v_mfma_f32_16x16x32_bf16 v[160:163], a[4:7], v[164:167], 0
v_mul_f32 v156, v156, v102
v_mul_f32 v157, v157, v102
v_mfma_f32_16x16x32_bf16 v[112:115], a[20:23], v[192:195], 0
v_mul_f32 v158, v158, v102
v_mul_f32 v159, v159, v102
v_mfma_f32_16x16x32_bf16 v[176:179], a[16:19], v[168:171], 0
v_fmac_f32 v156, v172, v103
v_fmac_f32 v157, v173, v103
v_rcp_f32 v110, v109
v_mul_f32 v160, v160, v102
v_mul_f32 v161, v161, v102
v_mul_f32 v162, v162, v102
v_mul_f32 v163, v163, v102
v_fmac_f32 v158, v174, v103
v_fmac_f32 v159, v175, v103
v_cvt_pk_bf16_f32 v156, v156, v157
v_rcp_f32 v111, v113
v_fmac_f32 v160, v176, v103
v_fmac_f32 v161, v177, v103
v_fmac_f32 v162, v178, v103
v_fmac_f32 v163, v179, v103
v_cvt_pk_bf16_f32 v157, v158, v159
v_cvt_pk_bf16_f32 v158, v160, v161
v_cvt_pk_bf16_f32 v159, v162, v163
v_mul_f32 v108, v108, v110
v_mfma_f32_16x16x32_bf16 v[180:183], a[0:3], v[188:191], 0
buffer_store_dwordx4 v[156:159], v2, s[4:7], s72 offen offset:1024 sc1
v_fmac_f32 v108, v112, v111
v_mfma_f32_16x16x32_bf16 v[196:199], a[12:15], v[192:195], 0
v_add_f32 v108, 0x358637bd, v108
v_rcp_f32 v108, v108
v_mfma_f32_16x16x32_bf16 v[92:95], a[8:11], v[140:143], 0
v_mul_f32 v110, v110, v108
v_mul_f32 v111, v111, v108
v_mfma_f32_16x16x32_bf16 v[184:187], a[4:7], v[188:191], 0
v_mul_f32 v180, v180, v110
v_mul_f32 v181, v181, v110
v_mfma_f32_16x16x32_bf16 v[96:99], a[20:23], v[144:147], 0
v_mul_f32 v182, v182, v110
v_mul_f32 v183, v183, v110
v_mfma_f32_16x16x32_bf16 v[200:203], a[16:19], v[192:195], 0
v_fmac_f32 v180, v196, v111
v_fmac_f32 v181, v197, v111
v_rcp_f32 v94, v93
v_mul_f32 v184, v184, v110
v_mul_f32 v185, v185, v110
v_mul_f32 v186, v186, v110
v_mul_f32 v187, v187, v110
v_fmac_f32 v182, v198, v111
v_fmac_f32 v183, v199, v111
v_cvt_pk_bf16_f32 v180, v180, v181
v_rcp_f32 v95, v97
buffer_atomic_add v12, v10, s[4:7], s74 offen sc1
v_fmac_f32 v184, v200, v111
v_fmac_f32 v185, v201, v111
v_fmac_f32 v186, v202, v111
v_fmac_f32 v187, v203, v111
v_cvt_pk_bf16_f32 v181, v182, v183
v_cvt_pk_bf16_f32 v182, v184, v185
v_cvt_pk_bf16_f32 v183, v186, v187
v_mul_f32 v92, v92, v94
v_mfma_f32_16x16x32_bf16 v[132:135], a[0:3], v[140:143], 0
buffer_store_dwordx4 v[180:183], v2, s[4:7], s72 offen offset:2048 sc1
v_fmac_f32 v92, v96, v95
v_mfma_f32_16x16x32_bf16 v[148:151], a[12:15], v[144:147], 0
v_add_f32 v92, 0x358637bd, v92
v_rcp_f32 v92, v92
v_mfma_f32_16x16x32_bf16 v[136:139], a[4:7], v[140:143], 0
v_mul_f32 v94, v94, v92
v_mul_f32 v95, v95, v92
v_mfma_f32_16x16x32_bf16 v[152:155], a[16:19], v[144:147], 0
v_mul_f32 v132, v132, v94
v_mul_f32 v133, v133, v94
v_mul_f32 v134, v134, v94
v_mul_f32 v135, v135, v94
v_fmac_f32 v132, v148, v95
L_stub19:
s_cbranch_execz L_wret6
v_fmac_f32 v133, v149, v95
v_mul_f32 v136, v136, v94
v_mul_f32 v137, v137, v94
v_mul_f32 v138, v138, v94
v_mul_f32 v139, v139, v94
v_fmac_f32 v134, v150, v95
v_fmac_f32 v135, v151, v95
v_cvt_pk_bf16_f32 v132, v132, v133
v_fmac_f32 v136, v152, v95
v_fmac_f32 v137, v153, v95
v_fmac_f32 v138, v154, v95
v_fmac_f32 v139, v155, v95
v_cvt_pk_bf16_f32 v133, v134, v135
v_cvt_pk_bf16_f32 v134, v136, v137
v_cvt_pk_bf16_f32 v135, v138, v139
buffer_store_dwordx4 v[132:135], v2, s[4:7], s72 offen offset:0 sc1
s_add_u32 s92, s71, 0x30000
s_add_u32 s36, s66, 0x30080
s_add_u32 s40, s4, 0x2600000
s_addc_u32 s41, s5, 0
v_add_u32 v5, 32768, v1
v_add_u32 v6, 98304, v1
s_cmp_eq_u32 s3, 0
s_cselect_b32 s35, 8, 0
s_lshl_b32 s35, s35, 12
v_lshlrev_b32 v132, 16, v32
v_and_b32 v133, 0xffff0000, v32
v_lshlrev_b32 v134, 16, v33
v_and_b32 v135, 0xffff0000, v33
v_lshlrev_b32 v136, 16, v34
v_and_b32 v137, 0xffff0000, v34
v_lshlrev_b32 v138, 16, v35
v_and_b32 v139, 0xffff0000, v35
v_lshlrev_b32 v140, 16, v36
v_and_b32 v141, 0xffff0000, v36
v_lshlrev_b32 v142, 16, v37
v_and_b32 v143, 0xffff0000, v37
v_lshlrev_b32 v144, 16, v38
v_and_b32 v145, 0xffff0000, v38
v_lshlrev_b32 v146, 16, v39
v_and_b32 v147, 0xffff0000, v39
v_lshlrev_b32 v148, 16, v40
v_and_b32 v149, 0xffff0000, v40
v_lshlrev_b32 v150, 16, v41
v_and_b32 v151, 0xffff0000, v41
v_lshlrev_b32 v152, 16, v42
v_and_b32 v153, 0xffff0000, v42
v_lshlrev_b32 v154, 16, v43
v_and_b32 v155, 0xffff0000, v43
v_lshlrev_b32 v156, 16, v44
v_and_b32 v157, 0xffff0000, v44
v_lshlrev_b32 v158, 16, v45
v_and_b32 v159, 0xffff0000, v45
v_lshlrev_b32 v160, 16, v46
v_and_b32 v161, 0xffff0000, v46
v_lshlrev_b32 v162, 16, v47
v_and_b32 v163, 0xffff0000, v47
s_mov_b32 s95, -1
s_mov_b64 exec, 0
s_cmp_eq_u32 s28, 3
s_cbranch_scc1 L_stub20
s_cmp_eq_u32 s28, 2
s_cbranch_scc1 L_wret7
L_wret7:
s_mov_b64 exec, -1
s_cmp_lg_u32 s28, 0
s_cbranch_scc1 Lpo_44
s_add_u32 s36, s66, 0x30080
s_mov_b32 s37, 0
v_mov_b32 v11, 0
buffer_atomic_add v11, v251, s[4:7], s36 offen sc0 sc1
s_sleep 4
Lpoll_42:
v_mov_b32 v234, 0
buffer_atomic_add v234, v251, s[4:7], s36 offen sc0 sc1
s_waitcnt vmcnt(1)
v_readfirstlane_b32 s38, v11
s_nop 0
s_cmp_ge_u32 s38, 32
s_cbranch_scc1 Lpe_43
v_mov_b32 v11, 0
buffer_atomic_add v11, v251, s[4:7], s36 offen sc0 sc1
s_waitcnt vmcnt(1)
v_readfirstlane_b32 s38, v234
s_nop 0
s_cmp_ge_u32 s38, 32
s_cbranch_scc1 Lpe_43
s_add_u32 s37, s37, 1
s_cmp_lt_u32 s37, 0x80000
s_cbranch_scc1 Lpoll_42
s_waitcnt vmcnt(0)
Lpo_44:
s_waitcnt vmcnt(0)
Lpe_43:
s_barrier
L_k2go3:
buffer_load_dwordx4 a[0:3], v4, s[40:43], s35 offen offset:0 sc1
buffer_load_dwordx4 a[4:7], v4, s[40:43], s35 offen offset:1024 sc1
s_cmp_eq_u32 s3, 1
s_cselect_b32 s35, 9, 1
s_lshl_b32 s35, s35, 12
buffer_load_dwordx4 a[8:11], v4, s[40:43], s35 offen offset:0 sc1
buffer_load_dwordx4 a[12:15], v4, s[40:43], s35 offen offset:1024 sc1
s_cmp_eq_u32 s3, 2
s_cselect_b32 s35, 10, 2
s_lshl_b32 s35, s35, 12
buffer_load_dwordx4 a[16:19], v4, s[40:43], s35 offen offset:0 sc1
buffer_load_dwordx4 a[20:23], v4, s[40:43], s35 offen offset:1024 sc1
s_cmp_eq_u32 s3, 3
s_cselect_b32 s35, 11, 3
s_lshl_b32 s35, s35, 12
buffer_load_dwordx4 a[24:27], v4, s[40:43], s35 offen offset:0 sc1
buffer_load_dwordx4 a[28:31], v4, s[40:43], s35 offen offset:1024 sc1
s_cmp_eq_u32 s3, 4
s_cselect_b32 s35, 12, 4
s_lshl_b32 s35, s35, 12
buffer_load_dwordx4 a[32:35], v4, s[40:43], s35 offen offset:0 sc1
buffer_load_dwordx4 a[36:39], v4, s[40:43], s35 offen offset:1024 sc1
s_cmp_eq_u32 s3, 5
s_cselect_b32 s35, 13, 5
s_lshl_b32 s35, s35, 12
buffer_load_dwordx4 a[40:43], v4, s[40:43], s35 offen offset:0 sc1
buffer_load_dwordx4 a[44:47], v4, s[40:43], s35 offen offset:1024 sc1
s_cmp_eq_u32 s3, 6
s_cselect_b32 s35, 14, 6
s_lshl_b32 s35, s35, 12
ds_read_b128 a[96:99], v5 offset:0
ds_read_b128 a[100:103], v5 offset:1024
ds_read_b128 a[104:107], v5 offset:2048
ds_read_b128 a[108:111], v5 offset:3072
ds_read_b128 a[112:115], v5 offset:4096
ds_read_b128 a[116:119], v5 offset:5120
ds_read_b128 a[120:123], v5 offset:6144
ds_read_b128 a[124:127], v5 offset:7168
s_waitcnt vmcnt(10) lgkmcnt(4)
v_mfma_f32_16x16x32_bf16 v[132:135], a[96:99], a[0:3], v[132:135]
ds_read_b128 a[128:131], v5 offset:8192
v_mfma_f32_16x16x32_bf16 v[148:151], a[96:99], a[4:7], v[148:151]
ds_read_b128 a[132:135], v5 offset:9216
v_mfma_f32_16x16x32_bf16 v[152:155], a[100:103], a[4:7], v[152:155]
buffer_load_dwordx4 a[48:51], v4, s[40:43], s35 offen offset:0 sc1
v_mfma_f32_16x16x32_bf16 v[136:139], a[100:103], a[0:3], v[136:139]
ds_read_b128 a[136:139], v5 offset:10240
v_mfma_f32_16x16x32_bf16 v[140:143], a[104:107], a[0:3], v[140:143]
ds_read_b128 a[140:143], v5 offset:11264
v_mfma_f32_16x16x32_bf16 v[156:159], a[104:107], a[4:7], v[156:159]
v_mfma_f32_16x16x32_bf16 v[160:163], a[108:111], a[4:7], v[160:163]
buffer_load_dwordx4 a[52:55], v4, s[40:43], s35 offen offset:1024 sc1
v_mfma_f32_16x16x32_bf16 v[144:147], a[108:111], a[0:3], v[144:147]
s_waitcnt vmcnt(10) lgkmcnt(4)
v_mfma_f32_16x16x32_bf16 v[132:135], a[112:115], a[8:11], v[132:135]
s_cmp_eq_u32 s3, 7
s_cselect_b32 s35, 15, 7
s_lshl_b32 s35, s35, 12
v_mfma_f32_16x16x32_bf16 v[148:151], a[112:115], a[12:15], v[148:151]
ds_read_b128 a[96:99], v5 offset:12288
v_mfma_f32_16x16x32_bf16 v[152:155], a[116:119], a[12:15], v[152:155]
buffer_load_dwordx4 a[0:3], v4, s[40:43], s35 offen offset:0 sc1
v_mfma_f32_16x16x32_bf16 v[136:139], a[116:119], a[8:11], v[136:139]
ds_read_b128 a[100:103], v5 offset:13312
v_mfma_f32_16x16x32_bf16 v[140:143], a[120:123], a[8:11], v[140:143]
ds_read_b128 a[104:107], v5 offset:14336
v_mfma_f32_16x16x32_bf16 v[156:159], a[120:123], a[12:15], v[156:159]
ds_read_b128 a[108:111], v5 offset:15360
v_mfma_f32_16x16x32_bf16 v[160:163], a[124:127], a[12:15], v[160:163]
buffer_load_dwordx4 a[4:7], v4, s[40:43], s35 offen offset:1024 sc1
v_mfma_f32_16x16x32_bf16 v[144:147], a[124:127], a[8:11], v[144:147]
s_waitcnt vmcnt(10) lgkmcnt(4)
v_mfma_f32_16x16x32_bf16 v[132:135], a[128:131], a[16:19], v[132:135]
s_cmp_eq_u32 s3, 0
s_cselect_b32 s35, 16, 8
s_lshl_b32 s35, s35, 12
v_mfma_f32_16x16x32_bf16 v[148:151], a[128:131], a[20:23], v[148:151]
ds_read_b128 a[112:115], v5 offset:16384
v_mfma_f32_16x16x32_bf16 v[152:155], a[132:135], a[20:23], v[152:155]
buffer_load_dwordx4 a[8:11], v4, s[40:43], s35 offen offset:0 sc1
v_mfma_f32_16x16x32_bf16 v[136:139], a[132:135], a[16:19], v[136:139]
ds_read_b128 a[116:119], v5 offset:17408
v_mfma_f32_16x16x32_bf16 v[140:143], a[136:139], a[16:19], v[140:143]
ds_read_b128 a[120:123], v5 offset:18432
v_mfma_f32_16x16x32_bf16 v[156:159], a[136:139], a[20:23], v[156:159]
ds_read_b128 a[124:127], v5 offset:19456
v_mfma_f32_16x16x32_bf16 v[160:163], a[140:143], a[20:23], v[160:163]
buffer_load_dwordx4 a[12:15], v4, s[40:43], s35 offen offset:1024 sc1
v_mfma_f32_16x16x32_bf16 v[144:147], a[140:143], a[16:19], v[144:147]
s_waitcnt vmcnt(10) lgkmcnt(4)
v_mfma_f32_16x16x32_bf16 v[132:135], a[96:99], a[24:27], v[132:135]
s_cmp_eq_u32 s3, 1
s_cselect_b32 s35, 17, 9
s_lshl_b32 s35, s35, 12
v_mfma_f32_16x16x32_bf16 v[148:151], a[96:99], a[28:31], v[148:151]
ds_read_b128 a[128:131], v5 offset:20480
v_mfma_f32_16x16x32_bf16 v[152:155], a[100:103], a[28:31], v[152:155]
buffer_load_dwordx4 a[16:19], v4, s[40:43], s35 offen offset:0 sc1
v_mfma_f32_16x16x32_bf16 v[136:139], a[100:103], a[24:27], v[136:139]
ds_read_b128 a[132:135], v5 offset:21504
v_mfma_f32_16x16x32_bf16 v[140:143], a[104:107], a[24:27], v[140:143]
ds_read_b128 a[136:139], v5 offset:22528
v_mfma_f32_16x16x32_bf16 v[156:159], a[104:107], a[28:31], v[156:159]
ds_read_b128 a[140:143], v5 offset:23552
v_mfma_f32_16x16x32_bf16 v[160:163], a[108:111], a[28:31], v[160:163]
buffer_load_dwordx4 a[20:23], v4, s[40:43], s35 offen offset:1024 sc1
v_mfma_f32_16x16x32_bf16 v[144:147], a[108:111], a[24:27], v[144:147]
s_waitcnt vmcnt(10) lgkmcnt(4)
v_mfma_f32_16x16x32_bf16 v[132:135], a[112:115], a[32:35], v[132:135]
s_cmp_eq_u32 s3, 2
s_cselect_b32 s35, 18, 10
s_lshl_b32 s35, s35, 12
v_mfma_f32_16x16x32_bf16 v[148:151], a[112:115], a[36:39], v[148:151]
ds_read_b128 a[96:99], v5 offset:24576
v_mfma_f32_16x16x32_bf16 v[152:155], a[116:119], a[36:39], v[152:155]
buffer_load_dwordx4 a[24:27], v4, s[40:43], s35 offen offset:0 sc1
v_mfma_f32_16x16x32_bf16 v[136:139], a[116:119], a[32:35], v[136:139]
ds_read_b128 a[100:103], v5 offset:25600
v_mfma_f32_16x16x32_bf16 v[140:143], a[120:123], a[32:35], v[140:143]
ds_read_b128 a[104:107], v5 offset:26624
v_mfma_f32_16x16x32_bf16 v[156:159], a[120:123], a[36:39], v[156:159]
ds_read_b128 a[108:111], v5 offset:27648
v_mfma_f32_16x16x32_bf16 v[160:163], a[124:127], a[36:39], v[160:163]
buffer_load_dwordx4 a[28:31], v4, s[40:43], s35 offen offset:1024 sc1
v_mfma_f32_16x16x32_bf16 v[144:147], a[124:127], a[32:35], v[144:147]
s_waitcnt vmcnt(10) lgkmcnt(4)
v_mfma_f32_16x16x32_bf16 v[132:135], a[128:131], a[40:43], v[132:135]
s_cmp_eq_u32 s3, 3
s_cselect_b32 s35, 19, 11
s_lshl_b32 s35, s35, 12
v_mfma_f32_16x16x32_bf16 v[148:151], a[128:131], a[44:47], v[148:151]
ds_read_b128 a[112:115], v5 offset:28672
v_mfma_f32_16x16x32_bf16 v[152:155], a[132:135], a[44:47], v[152:155]
buffer_load_dwordx4 a[32:35], v4, s[40:43], s35 offen offset:0 sc1
v_mfma_f32_16x16x32_bf16 v[136:139], a[132:135], a[40:43], v[136:139]
ds_read_b128 a[116:119], v5 offset:29696
v_mfma_f32_16x16x32_bf16 v[140:143], a[136:139], a[40:43], v[140:143]
ds_read_b128 a[120:123], v5 offset:30720
v_mfma_f32_16x16x32_bf16 v[156:159], a[136:139], a[44:47], v[156:159]
ds_read_b128 a[124:127], v5 offset:31744
v_mfma_f32_16x16x32_bf16 v[160:163], a[140:143], a[44:47], v[160:163]
buffer_load_dwordx4 a[36:39], v4, s[40:43], s35 offen offset:1024 sc1
v_mfma_f32_16x16x32_bf16 v[144:147], a[140:143], a[40:43], v[144:147]
s_waitcnt vmcnt(10) lgkmcnt(4)
v_mfma_f32_16x16x32_bf16 v[132:135], a[96:99], a[48:51], v[132:135]
s_cmp_eq_u32 s3, 4
s_cselect_b32 s35, 20, 12
s_lshl_b32 s35, s35, 12
v_mfma_f32_16x16x32_bf16 v[148:151], a[96:99], a[52:55], v[148:151]
ds_read_b128 a[128:131], v5 offset:32768
v_mfma_f32_16x16x32_bf16 v[152:155], a[100:103], a[52:55], v[152:155]
buffer_load_dwordx4 a[40:43], v4, s[40:43], s35 offen offset:0 sc1
v_mfma_f32_16x16x32_bf16 v[136:139], a[100:103], a[48:51], v[136:139]
ds_read_b128 a[132:135], v5 offset:33792
v_mfma_f32_16x16x32_bf16 v[140:143], a[104:107], a[48:51], v[140:143]
ds_read_b128 a[136:139], v5 offset:34816
v_mfma_f32_16x16x32_bf16 v[156:159], a[104:107], a[52:55], v[156:159]
ds_read_b128 a[140:143], v5 offset:35840
v_mfma_f32_16x16x32_bf16 v[160:163], a[108:111], a[52:55], v[160:163]
buffer_load_dwordx4 a[44:47], v4, s[40:43], s35 offen offset:1024 sc1
v_mfma_f32_16x16x32_bf16 v[144:147], a[108:111], a[48:51], v[144:147]
s_waitcnt vmcnt(10) lgkmcnt(4)
v_mfma_f32_16x16x32_bf16 v[132:135], a[112:115], a[0:3], v[132:135]
s_cmp_eq_u32 s3, 5
s_cselect_b32 s35, 21, 13
s_lshl_b32 s35, s35, 12
v_mfma_f32_16x16x32_bf16 v[148:151], a[112:115], a[4:7], v[148:151]
ds_read_b128 a[96:99], v5 offset:36864
v_mfma_f32_16x16x32_bf16 v[152:155], a[116:119], a[4:7], v[152:155]
buffer_load_dwordx4 a[48:51], v4, s[40:43], s35 offen offset:0 sc1
v_mfma_f32_16x16x32_bf16 v[136:139], a[116:119], a[0:3], v[136:139]
ds_read_b128 a[100:103], v5 offset:37888
v_mfma_f32_16x16x32_bf16 v[140:143], a[120:123], a[0:3], v[140:143]
ds_read_b128 a[104:107], v5 offset:38912
v_mfma_f32_16x16x32_bf16 v[156:159], a[120:123], a[4:7], v[156:159]
ds_read_b128 a[108:111], v5 offset:39936
v_mfma_f32_16x16x32_bf16 v[160:163], a[124:127], a[4:7], v[160:163]
buffer_load_dwordx4 a[52:55], v4, s[40:43], s35 offen offset:1024 sc1
v_mfma_f32_16x16x32_bf16 v[144:147], a[124:127], a[0:3], v[144:147]
s_waitcnt vmcnt(10) lgkmcnt(4)
v_mfma_f32_16x16x32_bf16 v[132:135], a[128:131], a[8:11], v[132:135]
s_cmp_eq_u32 s3, 6
s_cselect_b32 s35, 22, 14
s_lshl_b32 s35, s35, 12
v_mfma_f32_16x16x32_bf16 v[148:151], a[128:131], a[12:15], v[148:151]
ds_read_b128 a[112:115], v5 offset:40960
v_mfma_f32_16x16x32_bf16 v[152:155], a[132:135], a[12:15], v[152:155]
buffer_load_dwordx4 a[0:3], v4, s[40:43], s35 offen offset:0 sc1
v_mfma_f32_16x16x32_bf16 v[136:139], a[132:135], a[8:11], v[136:139]
ds_read_b128 a[116:119], v5 offset:41984
v_mfma_f32_16x16x32_bf16 v[140:143], a[136:139], a[8:11], v[140:143]
ds_read_b128 a[120:123], v5 offset:43008
v_mfma_f32_16x16x32_bf16 v[156:159], a[136:139], a[12:15], v[156:159]
ds_read_b128 a[124:127], v5 offset:44032
v_mfma_f32_16x16x32_bf16 v[160:163], a[140:143], a[12:15], v[160:163]
buffer_load_dwordx4 a[4:7], v4, s[40:43], s35 offen offset:1024 sc1
v_mfma_f32_16x16x32_bf16 v[144:147], a[140:143], a[8:11], v[144:147]
s_waitcnt vmcnt(10) lgkmcnt(4)
v_mfma_f32_16x16x32_bf16 v[132:135], a[96:99], a[16:19], v[132:135]
s_cmp_eq_u32 s3, 7
s_cselect_b32 s35, 23, 15
s_lshl_b32 s35, s35, 12
v_mfma_f32_16x16x32_bf16 v[148:151], a[96:99], a[20:23], v[148:151]
ds_read_b128 a[128:131], v5 offset:45056
v_mfma_f32_16x16x32_bf16 v[152:155], a[100:103], a[20:23], v[152:155]
buffer_load_dwordx4 a[8:11], v4, s[40:43], s35 offen offset:0 sc1
v_mfma_f32_16x16x32_bf16 v[136:139], a[100:103], a[16:19], v[136:139]
ds_read_b128 a[132:135], v5 offset:46080
v_mfma_f32_16x16x32_bf16 v[140:143], a[104:107], a[16:19], v[140:143]
ds_read_b128 a[136:139], v5 offset:47104
v_mfma_f32_16x16x32_bf16 v[156:159], a[104:107], a[20:23], v[156:159]
ds_read_b128 a[140:143], v5 offset:48128
v_mfma_f32_16x16x32_bf16 v[160:163], a[108:111], a[20:23], v[160:163]
buffer_load_dwordx4 a[12:15], v4, s[40:43], s35 offen offset:1024 sc1
v_mfma_f32_16x16x32_bf16 v[144:147], a[108:111], a[16:19], v[144:147]
s_waitcnt vmcnt(10) lgkmcnt(4)
v_mfma_f32_16x16x32_bf16 v[132:135], a[112:115], a[24:27], v[132:135]
s_cmp_eq_u32 s3, 0
s_cselect_b32 s35, 24, 16
s_lshl_b32 s35, s35, 12
v_mfma_f32_16x16x32_bf16 v[148:151], a[112:115], a[28:31], v[148:151]
ds_read_b128 a[96:99], v5 offset:49152
v_mfma_f32_16x16x32_bf16 v[152:155], a[116:119], a[28:31], v[152:155]
buffer_load_dwordx4 a[16:19], v4, s[40:43], s35 offen offset:0 sc1
v_mfma_f32_16x16x32_bf16 v[136:139], a[116:119], a[24:27], v[136:139]
ds_read_b128 a[100:103], v5 offset:50176
v_mfma_f32_16x16x32_bf16 v[140:143], a[120:123], a[24:27], v[140:143]
ds_read_b128 a[104:107], v5 offset:51200
v_mfma_f32_16x16x32_bf16 v[156:159], a[120:123], a[28:31], v[156:159]
ds_read_b128 a[108:111], v5 offset:52224
v_mfma_f32_16x16x32_bf16 v[160:163], a[124:127], a[28:31], v[160:163]
buffer_load_dwordx4 a[20:23], v4, s[40:43], s35 offen offset:1024 sc1
v_mfma_f32_16x16x32_bf16 v[144:147], a[124:127], a[24:27], v[144:147]
s_waitcnt vmcnt(10) lgkmcnt(4)
v_mfma_f32_16x16x32_bf16 v[132:135], a[128:131], a[32:35], v[132:135]
s_cmp_eq_u32 s3, 1
s_cselect_b32 s35, 25, 17
s_lshl_b32 s35, s35, 12
v_mfma_f32_16x16x32_bf16 v[148:151], a[128:131], a[36:39], v[148:151]
ds_read_b128 a[112:115], v5 offset:53248
v_mfma_f32_16x16x32_bf16 v[152:155], a[132:135], a[36:39], v[152:155]
buffer_load_dwordx4 a[24:27], v4, s[40:43], s35 offen offset:0 sc1
v_mfma_f32_16x16x32_bf16 v[136:139], a[132:135], a[32:35], v[136:139]
ds_read_b128 a[116:119], v5 offset:54272
v_mfma_f32_16x16x32_bf16 v[140:143], a[136:139], a[32:35], v[140:143]
ds_read_b128 a[120:123], v5 offset:55296
v_mfma_f32_16x16x32_bf16 v[156:159], a[136:139], a[36:39], v[156:159]
ds_read_b128 a[124:127], v5 offset:56320
v_mfma_f32_16x16x32_bf16 v[160:163], a[140:143], a[36:39], v[160:163]
buffer_load_dwordx4 a[28:31], v4, s[40:43], s35 offen offset:1024 sc1
v_mfma_f32_16x16x32_bf16 v[144:147], a[140:143], a[32:35], v[144:147]
s_waitcnt vmcnt(10) lgkmcnt(4)
v_mfma_f32_16x16x32_bf16 v[132:135], a[96:99], a[40:43], v[132:135]
s_cmp_eq_u32 s3, 2
s_cselect_b32 s35, 26, 18
s_lshl_b32 s35, s35, 12
v_mfma_f32_16x16x32_bf16 v[148:151], a[96:99], a[44:47], v[148:151]
ds_read_b128 a[128:131], v5 offset:57344
v_mfma_f32_16x16x32_bf16 v[152:155], a[100:103], a[44:47], v[152:155]
buffer_load_dwordx4 a[32:35], v4, s[40:43], s35 offen offset:0 sc1
v_mfma_f32_16x16x32_bf16 v[136:139], a[100:103], a[40:43], v[136:139]
ds_read_b128 a[132:135], v5 offset:58368
v_mfma_f32_16x16x32_bf16 v[140:143], a[104:107], a[40:43], v[140:143]
ds_read_b128 a[136:139], v5 offset:59392
v_mfma_f32_16x16x32_bf16 v[156:159], a[104:107], a[44:47], v[156:159]
ds_read_b128 a[140:143], v5 offset:60416
v_mfma_f32_16x16x32_bf16 v[160:163], a[108:111], a[44:47], v[160:163]
buffer_load_dwordx4 a[36:39], v4, s[40:43], s35 offen offset:1024 sc1
v_mfma_f32_16x16x32_bf16 v[144:147], a[108:111], a[40:43], v[144:147]
s_waitcnt vmcnt(10) lgkmcnt(4)
v_mfma_f32_16x16x32_bf16 v[132:135], a[112:115], a[48:51], v[132:135]
s_cmp_eq_u32 s3, 3
s_cselect_b32 s35, 27, 19
s_lshl_b32 s35, s35, 12
v_mfma_f32_16x16x32_bf16 v[148:151], a[112:115], a[52:55], v[148:151]
ds_read_b128 a[96:99], v5 offset:61440
v_mfma_f32_16x16x32_bf16 v[152:155], a[116:119], a[52:55], v[152:155]
buffer_load_dwordx4 a[40:43], v4, s[40:43], s35 offen offset:0 sc1
v_mfma_f32_16x16x32_bf16 v[136:139], a[116:119], a[48:51], v[136:139]
ds_read_b128 a[100:103], v5 offset:62464
v_mfma_f32_16x16x32_bf16 v[140:143], a[120:123], a[48:51], v[140:143]
ds_read_b128 a[104:107], v5 offset:63488
v_mfma_f32_16x16x32_bf16 v[156:159], a[120:123], a[52:55], v[156:159]
ds_read_b128 a[108:111], v5 offset:64512
v_mfma_f32_16x16x32_bf16 v[160:163], a[124:127], a[52:55], v[160:163]
buffer_load_dwordx4 a[44:47], v4, s[40:43], s35 offen offset:1024 sc1
v_mfma_f32_16x16x32_bf16 v[144:147], a[124:127], a[48:51], v[144:147]
s_waitcnt vmcnt(10) lgkmcnt(4)
v_mfma_f32_16x16x32_bf16 v[132:135], a[128:131], a[0:3], v[132:135]
s_cmp_eq_u32 s3, 4
s_cselect_b32 s35, 28, 20
s_lshl_b32 s35, s35, 12
v_mfma_f32_16x16x32_bf16 v[148:151], a[128:131], a[4:7], v[148:151]
ds_read_b128 a[112:115], v6 offset:0
v_mfma_f32_16x16x32_bf16 v[152:155], a[132:135], a[4:7], v[152:155]
buffer_load_dwordx4 a[48:51], v4, s[40:43], s35 offen offset:0 sc1
v_mfma_f32_16x16x32_bf16 v[136:139], a[132:135], a[0:3], v[136:139]
ds_read_b128 a[116:119], v6 offset:1024
v_mfma_f32_16x16x32_bf16 v[140:143], a[136:139], a[0:3], v[140:143]
ds_read_b128 a[120:123], v6 offset:2048
v_mfma_f32_16x16x32_bf16 v[156:159], a[136:139], a[4:7], v[156:159]
ds_read_b128 a[124:127], v6 offset:3072
v_mfma_f32_16x16x32_bf16 v[160:163], a[140:143], a[4:7], v[160:163]
buffer_load_dwordx4 a[52:55], v4, s[40:43], s35 offen offset:1024 sc1
v_mfma_f32_16x16x32_bf16 v[144:147], a[140:143], a[0:3], v[144:147]
s_waitcnt vmcnt(10) lgkmcnt(4)
v_mfma_f32_16x16x32_bf16 v[132:135], a[96:99], a[8:11], v[132:135]
s_cmp_eq_u32 s3, 5
s_cselect_b32 s35, 29, 21
s_lshl_b32 s35, s35, 12
v_mfma_f32_16x16x32_bf16 v[148:151], a[96:99], a[12:15], v[148:151]
ds_read_b128 a[128:131], v6 offset:4096
v_mfma_f32_16x16x32_bf16 v[152:155], a[100:103], a[12:15], v[152:155]
buffer_load_dwordx4 a[0:3], v4, s[40:43], s35 offen offset:0 sc1
v_mfma_f32_16x16x32_bf16 v[136:139], a[100:103], a[8:11], v[136:139]
ds_read_b128 a[132:135], v6 offset:5120
v_mfma_f32_16x16x32_bf16 v[140:143], a[104:107], a[8:11], v[140:143]
ds_read_b128 a[136:139], v6 offset:6144
v_mfma_f32_16x16x32_bf16 v[156:159], a[104:107], a[12:15], v[156:159]
ds_read_b128 a[140:143], v6 offset:7168
v_mfma_f32_16x16x32_bf16 v[160:163], a[108:111], a[12:15], v[160:163]
buffer_load_dwordx4 a[4:7], v4, s[40:43], s35 offen offset:1024 sc1
v_mfma_f32_16x16x32_bf16 v[144:147], a[108:111], a[8:11], v[144:147]
s_waitcnt vmcnt(10) lgkmcnt(4)
v_mfma_f32_16x16x32_bf16 v[132:135], a[112:115], a[16:19], v[132:135]
s_cmp_eq_u32 s3, 6
s_cselect_b32 s35, 30, 22
s_lshl_b32 s35, s35, 12
v_mfma_f32_16x16x32_bf16 v[148:151], a[112:115], a[20:23], v[148:151]
ds_read_b128 a[96:99], v6 offset:8192
v_mfma_f32_16x16x32_bf16 v[152:155], a[116:119], a[20:23], v[152:155]
buffer_load_dwordx4 a[8:11], v4, s[40:43], s35 offen offset:0 sc1
v_mfma_f32_16x16x32_bf16 v[136:139], a[116:119], a[16:19], v[136:139]
ds_read_b128 a[100:103], v6 offset:9216
v_mfma_f32_16x16x32_bf16 v[140:143], a[120:123], a[16:19], v[140:143]
ds_read_b128 a[104:107], v6 offset:10240
v_mfma_f32_16x16x32_bf16 v[156:159], a[120:123], a[20:23], v[156:159]
ds_read_b128 a[108:111], v6 offset:11264
v_mfma_f32_16x16x32_bf16 v[160:163], a[124:127], a[20:23], v[160:163]
buffer_load_dwordx4 a[12:15], v4, s[40:43], s35 offen offset:1024 sc1
v_mfma_f32_16x16x32_bf16 v[144:147], a[124:127], a[16:19], v[144:147]
s_waitcnt vmcnt(10) lgkmcnt(4)
v_mfma_f32_16x16x32_bf16 v[132:135], a[128:131], a[24:27], v[132:135]
s_cmp_eq_u32 s3, 7
s_cselect_b32 s35, 31, 23
s_lshl_b32 s35, s35, 12
v_mfma_f32_16x16x32_bf16 v[148:151], a[128:131], a[28:31], v[148:151]
ds_read_b128 a[112:115], v6 offset:12288
v_mfma_f32_16x16x32_bf16 v[152:155], a[132:135], a[28:31], v[152:155]
buffer_load_dwordx4 a[16:19], v4, s[40:43], s35 offen offset:0 sc1
v_mfma_f32_16x16x32_bf16 v[136:139], a[132:135], a[24:27], v[136:139]
ds_read_b128 a[116:119], v6 offset:13312
v_mfma_f32_16x16x32_bf16 v[140:143], a[136:139], a[24:27], v[140:143]
ds_read_b128 a[120:123], v6 offset:14336
v_mfma_f32_16x16x32_bf16 v[156:159], a[136:139], a[28:31], v[156:159]
ds_read_b128 a[124:127], v6 offset:15360
v_mfma_f32_16x16x32_bf16 v[160:163], a[140:143], a[28:31], v[160:163]
buffer_load_dwordx4 a[20:23], v4, s[40:43], s35 offen offset:1024 sc1
v_mfma_f32_16x16x32_bf16 v[144:147], a[140:143], a[24:27], v[144:147]
s_waitcnt vmcnt(10) lgkmcnt(4)
v_mfma_f32_16x16x32_bf16 v[132:135], a[96:99], a[32:35], v[132:135]
s_cmp_eq_u32 s3, 0
s_cselect_b32 s35, 0, 24
s_lshl_b32 s35, s35, 12
v_mfma_f32_16x16x32_bf16 v[148:151], a[96:99], a[36:39], v[148:151]
ds_read_b128 a[128:131], v6 offset:16384
v_mfma_f32_16x16x32_bf16 v[152:155], a[100:103], a[36:39], v[152:155]
buffer_load_dwordx4 a[24:27], v4, s[40:43], s35 offen offset:0 sc1
v_mfma_f32_16x16x32_bf16 v[136:139], a[100:103], a[32:35], v[136:139]
ds_read_b128 a[132:135], v6 offset:17408
v_mfma_f32_16x16x32_bf16 v[140:143], a[104:107], a[32:35], v[140:143]
ds_read_b128 a[136:139], v6 offset:18432
v_mfma_f32_16x16x32_bf16 v[156:159], a[104:107], a[36:39], v[156:159]
ds_read_b128 a[140:143], v6 offset:19456
v_mfma_f32_16x16x32_bf16 v[160:163], a[108:111], a[36:39], v[160:163]
buffer_load_dwordx4 a[28:31], v4, s[40:43], s35 offen offset:1024 sc1
v_mfma_f32_16x16x32_bf16 v[144:147], a[108:111], a[32:35], v[144:147]
s_waitcnt vmcnt(10) lgkmcnt(4)
v_mfma_f32_16x16x32_bf16 v[132:135], a[112:115], a[40:43], v[132:135]
s_cmp_eq_u32 s3, 1
s_cselect_b32 s35, 1, 25
s_lshl_b32 s35, s35, 12
v_mfma_f32_16x16x32_bf16 v[148:151], a[112:115], a[44:47], v[148:151]
ds_read_b128 a[96:99], v6 offset:20480
v_mfma_f32_16x16x32_bf16 v[152:155], a[116:119], a[44:47], v[152:155]
buffer_load_dwordx4 a[32:35], v4, s[40:43], s35 offen offset:0 sc1
v_mfma_f32_16x16x32_bf16 v[136:139], a[116:119], a[40:43], v[136:139]
ds_read_b128 a[100:103], v6 offset:21504
v_mfma_f32_16x16x32_bf16 v[140:143], a[120:123], a[40:43], v[140:143]
ds_read_b128 a[104:107], v6 offset:22528
v_mfma_f32_16x16x32_bf16 v[156:159], a[120:123], a[44:47], v[156:159]
ds_read_b128 a[108:111], v6 offset:23552
v_mfma_f32_16x16x32_bf16 v[160:163], a[124:127], a[44:47], v[160:163]
buffer_load_dwordx4 a[36:39], v4, s[40:43], s35 offen offset:1024 sc1
v_mfma_f32_16x16x32_bf16 v[144:147], a[124:127], a[40:43], v[144:147]
s_waitcnt vmcnt(10) lgkmcnt(4)
v_mfma_f32_16x16x32_bf16 v[132:135], a[128:131], a[48:51], v[132:135]
s_cmp_eq_u32 s3, 2
s_cselect_b32 s35, 2, 26
s_lshl_b32 s35, s35, 12
v_mfma_f32_16x16x32_bf16 v[148:151], a[128:131], a[52:55], v[148:151]
ds_read_b128 a[112:115], v6 offset:24576
v_mfma_f32_16x16x32_bf16 v[152:155], a[132:135], a[52:55], v[152:155]
buffer_load_dwordx4 a[40:43], v4, s[40:43], s35 offen offset:0 sc1
v_mfma_f32_16x16x32_bf16 v[136:139], a[132:135], a[48:51], v[136:139]
ds_read_b128 a[116:119], v6 offset:25600
v_mfma_f32_16x16x32_bf16 v[140:143], a[136:139], a[48:51], v[140:143]
ds_read_b128 a[120:123], v6 offset:26624
v_mfma_f32_16x16x32_bf16 v[156:159], a[136:139], a[52:55], v[156:159]
ds_read_b128 a[124:127], v6 offset:27648
v_mfma_f32_16x16x32_bf16 v[160:163], a[140:143], a[52:55], v[160:163]
buffer_load_dwordx4 a[44:47], v4, s[40:43], s35 offen offset:1024 sc1
v_mfma_f32_16x16x32_bf16 v[144:147], a[140:143], a[48:51], v[144:147]
s_waitcnt vmcnt(10) lgkmcnt(4)
v_mfma_f32_16x16x32_bf16 v[132:135], a[96:99], a[0:3], v[132:135]
s_cmp_eq_u32 s3, 3
s_cselect_b32 s35, 3, 27
s_lshl_b32 s35, s35, 12
v_mfma_f32_16x16x32_bf16 v[148:151], a[96:99], a[4:7], v[148:151]
ds_read_b128 a[128:131], v6 offset:28672
v_mfma_f32_16x16x32_bf16 v[152:155], a[100:103], a[4:7], v[152:155]
buffer_load_dwordx4 a[48:51], v4, s[40:43], s35 offen offset:0 sc1
v_mfma_f32_16x16x32_bf16 v[136:139], a[100:103], a[0:3], v[136:139]
ds_read_b128 a[132:135], v6 offset:29696
v_mfma_f32_16x16x32_bf16 v[140:143], a[104:107], a[0:3], v[140:143]
ds_read_b128 a[136:139], v6 offset:30720
v_mfma_f32_16x16x32_bf16 v[156:159], a[104:107], a[4:7], v[156:159]
ds_read_b128 a[140:143], v6 offset:31744
v_mfma_f32_16x16x32_bf16 v[160:163], a[108:111], a[4:7], v[160:163]
buffer_load_dwordx4 a[52:55], v4, s[40:43], s35 offen offset:1024 sc1
v_mfma_f32_16x16x32_bf16 v[144:147], a[108:111], a[0:3], v[144:147]
s_waitcnt vmcnt(10) lgkmcnt(4)
v_mfma_f32_16x16x32_bf16 v[132:135], a[112:115], a[8:11], v[132:135]
s_cmp_eq_u32 s3, 4
s_cselect_b32 s35, 4, 28
s_lshl_b32 s35, s35, 12
v_mfma_f32_16x16x32_bf16 v[148:151], a[112:115], a[12:15], v[148:151]
ds_read_b128 a[96:99], v6 offset:32768
v_mfma_f32_16x16x32_bf16 v[152:155], a[116:119], a[12:15], v[152:155]
buffer_load_dwordx4 a[0:3], v4, s[40:43], s35 offen offset:0 sc1
v_mfma_f32_16x16x32_bf16 v[136:139], a[116:119], a[8:11], v[136:139]
ds_read_b128 a[100:103], v6 offset:33792
v_mfma_f32_16x16x32_bf16 v[140:143], a[120:123], a[8:11], v[140:143]
ds_read_b128 a[104:107], v6 offset:34816
v_mfma_f32_16x16x32_bf16 v[156:159], a[120:123], a[12:15], v[156:159]
ds_read_b128 a[108:111], v6 offset:35840
v_mfma_f32_16x16x32_bf16 v[160:163], a[124:127], a[12:15], v[160:163]
buffer_load_dwordx4 a[4:7], v4, s[40:43], s35 offen offset:1024 sc1
v_mfma_f32_16x16x32_bf16 v[144:147], a[124:127], a[8:11], v[144:147]
s_waitcnt vmcnt(10) lgkmcnt(4)
v_mfma_f32_16x16x32_bf16 v[132:135], a[128:131], a[16:19], v[132:135]
s_cmp_eq_u32 s3, 5
s_cselect_b32 s35, 5, 29
s_lshl_b32 s35, s35, 12
v_mfma_f32_16x16x32_bf16 v[148:151], a[128:131], a[20:23], v[148:151]
ds_read_b128 a[112:115], v6 offset:36864
v_mfma_f32_16x16x32_bf16 v[152:155], a[132:135], a[20:23], v[152:155]
buffer_load_dwordx4 a[8:11], v4, s[40:43], s35 offen offset:0 sc1
v_mfma_f32_16x16x32_bf16 v[136:139], a[132:135], a[16:19], v[136:139]
ds_read_b128 a[116:119], v6 offset:37888
v_mfma_f32_16x16x32_bf16 v[140:143], a[136:139], a[16:19], v[140:143]
ds_read_b128 a[120:123], v6 offset:38912
v_mfma_f32_16x16x32_bf16 v[156:159], a[136:139], a[20:23], v[156:159]
ds_read_b128 a[124:127], v6 offset:39936
v_mfma_f32_16x16x32_bf16 v[160:163], a[140:143], a[20:23], v[160:163]
buffer_load_dwordx4 a[12:15], v4, s[40:43], s35 offen offset:1024 sc1
v_mfma_f32_16x16x32_bf16 v[144:147], a[140:143], a[16:19], v[144:147]
s_waitcnt vmcnt(10) lgkmcnt(4)
v_mfma_f32_16x16x32_bf16 v[132:135], a[96:99], a[24:27], v[132:135]
s_cmp_eq_u32 s3, 6
s_cselect_b32 s35, 6, 30
s_lshl_b32 s35, s35, 12
v_mfma_f32_16x16x32_bf16 v[148:151], a[96:99], a[28:31], v[148:151]
ds_read_b128 a[128:131], v6 offset:40960
v_mfma_f32_16x16x32_bf16 v[152:155], a[100:103], a[28:31], v[152:155]
buffer_load_dwordx4 a[16:19], v4, s[40:43], s35 offen offset:0 sc1
v_mfma_f32_16x16x32_bf16 v[136:139], a[100:103], a[24:27], v[136:139]
ds_read_b128 a[132:135], v6 offset:41984
v_mfma_f32_16x16x32_bf16 v[140:143], a[104:107], a[24:27], v[140:143]
ds_read_b128 a[136:139], v6 offset:43008
v_mfma_f32_16x16x32_bf16 v[156:159], a[104:107], a[28:31], v[156:159]
ds_read_b128 a[140:143], v6 offset:44032
v_mfma_f32_16x16x32_bf16 v[160:163], a[108:111], a[28:31], v[160:163]
buffer_load_dwordx4 a[20:23], v4, s[40:43], s35 offen offset:1024 sc1
v_mfma_f32_16x16x32_bf16 v[144:147], a[108:111], a[24:27], v[144:147]
s_waitcnt vmcnt(10) lgkmcnt(4)
v_mfma_f32_16x16x32_bf16 v[132:135], a[112:115], a[32:35], v[132:135]
s_cmp_eq_u32 s3, 7
s_cselect_b32 s35, 7, 31
s_lshl_b32 s35, s35, 12
v_mfma_f32_16x16x32_bf16 v[148:151], a[112:115], a[36:39], v[148:151]
ds_read_b128 a[96:99], v6 offset:45056
v_mfma_f32_16x16x32_bf16 v[152:155], a[116:119], a[36:39], v[152:155]
buffer_load_dwordx4 a[24:27], v4, s[40:43], s35 offen offset:0 sc1
v_mfma_f32_16x16x32_bf16 v[136:139], a[116:119], a[32:35], v[136:139]
ds_read_b128 a[100:103], v6 offset:46080
v_mfma_f32_16x16x32_bf16 v[140:143], a[120:123], a[32:35], v[140:143]
ds_read_b128 a[104:107], v6 offset:47104
v_mfma_f32_16x16x32_bf16 v[156:159], a[120:123], a[36:39], v[156:159]
ds_read_b128 a[108:111], v6 offset:48128
v_mfma_f32_16x16x32_bf16 v[160:163], a[124:127], a[36:39], v[160:163]
buffer_load_dwordx4 a[28:31], v4, s[40:43], s35 offen offset:1024 sc1
v_mfma_f32_16x16x32_bf16 v[144:147], a[124:127], a[32:35], v[144:147]
s_waitcnt vmcnt(10) lgkmcnt(4)
v_mfma_f32_16x16x32_bf16 v[132:135], a[128:131], a[40:43], v[132:135]
ds_read_b128 a[112:115], v6 offset:49152
v_mfma_f32_16x16x32_bf16 v[148:151], a[128:131], a[44:47], v[148:151]
ds_read_b128 a[116:119], v6 offset:50176
v_mfma_f32_16x16x32_bf16 v[152:155], a[132:135], a[44:47], v[152:155]
ds_read_b128 a[120:123], v6 offset:51200
v_mfma_f32_16x16x32_bf16 v[136:139], a[132:135], a[40:43], v[136:139]
L_stub20:
s_cbranch_execz L_wret7
ds_read_b128 a[124:127], v6 offset:52224
v_mfma_f32_16x16x32_bf16 v[140:143], a[136:139], a[40:43], v[140:143]
v_mfma_f32_16x16x32_bf16 v[156:159], a[136:139], a[44:47], v[156:159]
v_mfma_f32_16x16x32_bf16 v[160:163], a[140:143], a[44:47], v[160:163]
v_mfma_f32_16x16x32_bf16 v[144:147], a[140:143], a[40:43], v[144:147]
s_waitcnt vmcnt(8) lgkmcnt(4)
v_mfma_f32_16x16x32_bf16 v[132:135], a[96:99], a[48:51], v[132:135]
ds_read_b128 a[128:131], v6 offset:53248
v_mfma_f32_16x16x32_bf16 v[148:151], a[96:99], a[52:55], v[148:151]
ds_read_b128 a[132:135], v6 offset:54272
v_mfma_f32_16x16x32_bf16 v[152:155], a[100:103], a[52:55], v[152:155]
ds_read_b128 a[136:139], v6 offset:55296
v_mfma_f32_16x16x32_bf16 v[136:139], a[100:103], a[48:51], v[136:139]
ds_read_b128 a[140:143], v6 offset:56320
v_mfma_f32_16x16x32_bf16 v[140:143], a[104:107], a[48:51], v[140:143]
v_mfma_f32_16x16x32_bf16 v[156:159], a[104:107], a[52:55], v[156:159]
v_mfma_f32_16x16x32_bf16 v[160:163], a[108:111], a[52:55], v[160:163]
v_mfma_f32_16x16x32_bf16 v[144:147], a[108:111], a[48:51], v[144:147]
s_waitcnt vmcnt(6) lgkmcnt(4)
v_mfma_f32_16x16x32_bf16 v[132:135], a[112:115], a[0:3], v[132:135]
ds_read_b128 a[96:99], v6 offset:57344
v_mfma_f32_16x16x32_bf16 v[148:151], a[112:115], a[4:7], v[148:151]
ds_read_b128 a[100:103], v6 offset:58368
v_mfma_f32_16x16x32_bf16 v[152:155], a[116:119], a[4:7], v[152:155]
ds_read_b128 a[104:107], v6 offset:59392
v_mfma_f32_16x16x32_bf16 v[136:139], a[116:119], a[0:3], v[136:139]
ds_read_b128 a[108:111], v6 offset:60416
v_mfma_f32_16x16x32_bf16 v[140:143], a[120:123], a[0:3], v[140:143]
v_mfma_f32_16x16x32_bf16 v[156:159], a[120:123], a[4:7], v[156:159]
v_mfma_f32_16x16x32_bf16 v[160:163], a[124:127], a[4:7], v[160:163]
v_mfma_f32_16x16x32_bf16 v[144:147], a[124:127], a[0:3], v[144:147]
s_waitcnt vmcnt(4) lgkmcnt(4)
v_mfma_f32_16x16x32_bf16 v[132:135], a[128:131], a[8:11], v[132:135]
ds_read_b128 a[112:115], v6 offset:61440
v_mfma_f32_16x16x32_bf16 v[148:151], a[128:131], a[12:15], v[148:151]
ds_read_b128 a[116:119], v6 offset:62464
v_mfma_f32_16x16x32_bf16 v[152:155], a[132:135], a[12:15], v[152:155]
ds_read_b128 a[120:123], v6 offset:63488
v_mfma_f32_16x16x32_bf16 v[136:139], a[132:135], a[8:11], v[136:139]
ds_read_b128 a[124:127], v6 offset:64512
v_mfma_f32_16x16x32_bf16 v[140:143], a[136:139], a[8:11], v[140:143]
v_mfma_f32_16x16x32_bf16 v[156:159], a[136:139], a[12:15], v[156:159]
v_mfma_f32_16x16x32_bf16 v[160:163], a[140:143], a[12:15], v[160:163]
v_mfma_f32_16x16x32_bf16 v[144:147], a[140:143], a[8:11], v[144:147]
s_waitcnt vmcnt(2) lgkmcnt(4)
v_mfma_f32_16x16x32_bf16 v[132:135], a[96:99], a[16:19], v[132:135]
v_mfma_f32_16x16x32_bf16 v[148:151], a[96:99], a[20:23], v[148:151]
v_mfma_f32_16x16x32_bf16 v[152:155], a[100:103], a[20:23], v[152:155]
v_mfma_f32_16x16x32_bf16 v[136:139], a[100:103], a[16:19], v[136:139]
v_mfma_f32_16x16x32_bf16 v[140:143], a[104:107], a[16:19], v[140:143]
v_mfma_f32_16x16x32_bf16 v[156:159], a[104:107], a[20:23], v[156:159]
v_mfma_f32_16x16x32_bf16 v[160:163], a[108:111], a[20:23], v[160:163]
v_mfma_f32_16x16x32_bf16 v[144:147], a[108:111], a[16:19], v[144:147]
s_waitcnt vmcnt(0) lgkmcnt(0)
v_mfma_f32_16x16x32_bf16 v[132:135], a[112:115], a[24:27], v[132:135]
v_mfma_f32_16x16x32_bf16 v[148:151], a[112:115], a[28:31], v[148:151]
v_mfma_f32_16x16x32_bf16 v[152:155], a[116:119], a[28:31], v[152:155]
buffer_atomic_add v12, v10, s[4:7], s92 offen sc1
v_mfma_f32_16x16x32_bf16 v[136:139], a[116:119], a[24:27], v[136:139]
v_mfma_f32_16x16x32_bf16 v[140:143], a[120:123], a[24:27], v[140:143]
v_mfma_f32_16x16x32_bf16 v[156:159], a[120:123], a[28:31], v[156:159]
v_mfma_f32_16x16x32_bf16 v[160:163], a[124:127], a[28:31], v[160:163]
v_mfma_f32_16x16x32_bf16 v[144:147], a[124:127], a[24:27], v[144:147]
s_nop 0
v_cmp_u_f32 vcc, v132, v148
s_nop 0
s_and_b32 vcc_lo, vcc_lo, s95
s_cbranch_scc1 L_k2redo3
s_and_b32 s36, s31, 7
s_lshl_b32 s36, s36, 7
s_lshl_b32 s37, s28, 5
s_add_u32 s36, s36, s37
s_lshl_b32 s36, s36, 1
s_lshr_b32 s37, s31, 3
s_add_u32 s36, s36, s37
s_lshl_b32 s36, s36, 11
s_lshl_b32 s37, s32, 7
v_and_b32 v234, 15, v0
s_add_u32 s36, s36, s37
v_lshrrev_b32 v233, 4, v0
v_lshl_add_u32 v232, v234, 12, s36
v_cvt_pk_bf16_f32 v32, v132, v133
v_cvt_pk_bf16_f32 v33, v134, v135
v_cvt_pk_bf16_f32 v34, v136, v137
v_cvt_pk_bf16_f32 v35, v138, v139
v_lshl_add_u32 v232, v233, 4, v232
buffer_store_dwordx4 v[32:35], v232, s[12:15], 0 offen offset:0
v_cvt_pk_bf16_f32 v36, v140, v141
v_cvt_pk_bf16_f32 v37, v142, v143
v_cvt_pk_bf16_f32 v38, v144, v145
v_cvt_pk_bf16_f32 v39, v146, v147
v_cvt_pk_bf16_f32 v40, v148, v149
v_cvt_pk_bf16_f32 v41, v150, v151
v_cvt_pk_bf16_f32 v42, v152, v153
v_cvt_pk_bf16_f32 v43, v154, v155
s_mov_b32 s36, 0x10000
v_cvt_pk_bf16_f32 v44, v156, v157
v_cvt_pk_bf16_f32 v45, v158, v159
v_cvt_pk_bf16_f32 v46, v160, v161
buffer_store_dwordx4 v[36:39], v232, s[12:15], 0 offen offset:64
v_cvt_pk_bf16_f32 v47, v162, v163
buffer_store_dwordx4 v[40:43], v232, s[12:15], s36 offen offset:0
buffer_store_dwordx4 v[44:47], v232, s[12:15], s36 offen offset:64
s_or_b32 s36, s2, s28
s_cbranch_scc1 Lep_45
s_mov_b32 s36, 0xf0000
buffer_store_dword v15, off, s[4:7], s36 sc1
Lep_45:
L_end:
s_endpgm
Ltr_8:
s_add_u32 s52, s67, 0xe0000
s_mov_b32 s53, 0
Ltp_9:
s_sleep 2
v_mov_b32 v11, v15
s_mov_b64 exec, 0xffff
v_mov_b32 v11, 0
buffer_atomic_add v11, v255, s[4:7], s52 offen sc0 sc1
s_mov_b64 exec, -1
s_add_u32 s53, s53, 1
s_waitcnt vmcnt(0)
v_cmp_ne_u32 vcc, v11, v15
s_cbranch_vccz Lte_10
s_cmp_lt_u32 s53, 0x100000
s_cbranch_scc1 Ltp_9
s_branch Lte_10
Ltr_11:
s_add_u32 s52, s66, 0xd0040
s_mov_b32 s53, 0
Ltp_12:
s_sleep 2
v_mov_b32 v232, v15
s_mov_b64 exec, 0xffff
v_mov_b32 v232, 0
buffer_atomic_add v232, v255, s[4:7], s52 offen sc0 sc1
s_mov_b64 exec, -1
s_add_u32 s53, s53, 1
s_waitcnt vmcnt(0)
v_cmp_ne_u32 vcc, v232, v15
s_cbranch_vccz Lte_13
s_cmp_lt_u32 s53, 0x100000
s_cbranch_scc1 Ltp_12
s_branch Lte_13
L_kvredo1:
s_mov_b32 s88, 0
L_kvredo1b:
v_max_u32 v132, v48, v49
v_max3_u32 v132, v132, v50, v51
v_max3_u32 v132, v132, v52, v53
v_max3_u32 v132, v132, v54, v55
v_max3_u32 v132, v132, v56, v57
v_max3_u32 v132, v132, v58, v59
v_max3_u32 v132, v132, v60, v61
v_max3_u32 v132, v132, v62, v63
v_max3_u32 v132, v132, v64, v65
v_max3_u32 v132, v132, v66, v67
v_max3_u32 v132, v132, v68, v69
v_max3_u32 v132, v132, v70, v71
v_max3_u32 v132, v132, v100, v101
v_max3_u32 v132, v132, v102, v103
v_max3_u32 v132, v132, v104, v105
v_max3_u32 v132, v132, v106, v107
v_max3_u32 v132, v132, v124, v125
v_max3_u32 v132, v132, v126, v127
v_cmp_eq_u32 vcc, -1, v132
s_cbranch_vccz L_kvback1
s_add_u32 s88, s88, 1
s_cmp_gt_u32 s88, 0x80000
s_cbranch_scc1 L_kvback1
s_sleep 4
buffer_load_dwordx4 v[48:51], v1, s[4:7], s98 offen offset:0 sc1
buffer_load_dwordx4 v[124:127], v248, s[4:7], s100 offen sc1
buffer_load_dwordx4 v[52:55], v1, s[4:7], s98 offen offset:1024 sc1
buffer_load_dwordx4 v[56:59], v1, s[4:7], s98 offen offset:2048 sc1
buffer_load_dwordx4 v[60:63], v1, s[4:7], s98 offen offset:3072 sc1
buffer_load_dwordx4 v[64:67], v1, s[4:7], s99 offen offset:0 sc1
buffer_load_dwordx4 v[68:71], v1, s[4:7], s99 offen offset:1024 sc1
buffer_load_dwordx4 v[100:103], v1, s[4:7], s99 offen offset:2048 sc1
buffer_load_dwordx4 v[104:107], v1, s[4:7], s99 offen offset:3072 sc1
s_waitcnt vmcnt(8)
v_lshlrev_b32 v92, 16, v48
v_and_b32 v93, 0xffff0000, v48
v_lshlrev_b32 v94, 16, v49
v_and_b32 v95, 0xffff0000, v49
v_lshlrev_b32 v96, 16, v50
v_and_b32 v97, 0xffff0000, v50
v_lshlrev_b32 v98, 16, v51
v_and_b32 v99, 0xffff0000, v51
s_waitcnt vmcnt(7)
v_add_f32_dpp v128, v124, v124 row_ror:4 row_mask:0xf bank_mask:0xf
v_add_f32_dpp v129, v125, v125 row_ror:4 row_mask:0xf bank_mask:0xf
v_add_f32_dpp v130, v126, v126 row_ror:4 row_mask:0xf bank_mask:0xf
v_add_f32_dpp v131, v127, v127 row_ror:4 row_mask:0xf bank_mask:0xf
v_add_f32_dpp v128, v128, v128 row_ror:2 row_mask:0xf bank_mask:0xf
v_add_f32_dpp v129, v129, v129 row_ror:2 row_mask:0xf bank_mask:0xf
v_add_f32_dpp v130, v130, v130 row_ror:2 row_mask:0xf bank_mask:0xf
v_add_f32_dpp v131, v131, v131 row_ror:2 row_mask:0xf bank_mask:0xf
v_add_f32_dpp v128, v128, v128 row_ror:1 row_mask:0xf bank_mask:0xf
v_add_f32_dpp v129, v129, v129 row_ror:1 row_mask:0xf bank_mask:0xf
v_add_f32_dpp v130, v130, v130 row_ror:1 row_mask:0xf bank_mask:0xf
v_add_f32_dpp v131, v131, v131 row_ror:1 row_mask:0xf bank_mask:0xf
s_waitcnt vmcnt(6)
v_dot2c_f32_bf16 v92, v52, v249
v_dot2c_f32_bf16 v93, v52, v250
v_dot2c_f32_bf16 v94, v53, v249
v_dot2c_f32_bf16 v95, v53, v250
v_dot2c_f32_bf16 v96, v54, v249
v_dot2c_f32_bf16 v97, v54, v250
v_dot2c_f32_bf16 v98, v55, v249
v_dot2c_f32_bf16 v99, v55, v250
s_waitcnt vmcnt(5)
v_dot2c_f32_bf16 v92, v56, v249
v_dot2c_f32_bf16 v93, v56, v250
v_dot2c_f32_bf16 v94, v57, v249
v_dot2c_f32_bf16 v95, v57, v250
v_dot2c_f32_bf16 v96, v58, v249
v_dot2c_f32_bf16 v97, v58, v250
v_dot2c_f32_bf16 v98, v59, v249
v_dot2c_f32_bf16 v99, v59, v250
s_waitcnt vmcnt(4)
v_dot2c_f32_bf16 v92, v60, v249
v_dot2c_f32_bf16 v93, v60, v250
v_dot2c_f32_bf16 v94, v61, v249
v_dot2c_f32_bf16 v95, v61, v250
v_dot2c_f32_bf16 v96, v62, v249
v_dot2c_f32_bf16 v97, v62, v250
v_dot2c_f32_bf16 v98, v63, v249
v_dot2c_f32_bf16 v99, v63, v250
s_waitcnt vmcnt(3)
v_dot2c_f32_bf16 v92, v64, v249
v_dot2c_f32_bf16 v93, v64, v250
v_dot2c_f32_bf16 v94, v65, v249
v_dot2c_f32_bf16 v95, v65, v250
v_dot2c_f32_bf16 v96, v66, v249
v_dot2c_f32_bf16 v97, v66, v250
v_dot2c_f32_bf16 v98, v67, v249
v_dot2c_f32_bf16 v99, v67, v250
s_waitcnt vmcnt(2)
v_dot2c_f32_bf16 v92, v68, v249
v_dot2c_f32_bf16 v93, v68, v250
v_dot2c_f32_bf16 v94, v69, v249
v_dot2c_f32_bf16 v95, v69, v250
v_dot2c_f32_bf16 v96, v70, v249
v_dot2c_f32_bf16 v97, v70, v250
v_dot2c_f32_bf16 v98, v71, v249
v_dot2c_f32_bf16 v99, v71, v250
s_waitcnt vmcnt(1)
v_dot2c_f32_bf16 v92, v100, v249
v_dot2c_f32_bf16 v93, v100, v250
v_dot2c_f32_bf16 v94, v101, v249
v_dot2c_f32_bf16 v95, v101, v250
v_dot2c_f32_bf16 v96, v102, v249
v_dot2c_f32_bf16 v97, v102, v250
v_dot2c_f32_bf16 v98, v103, v249
v_dot2c_f32_bf16 v99, v103, v250
s_waitcnt vmcnt(0)
v_dot2c_f32_bf16 v92, v104, v249
v_dot2c_f32_bf16 v93, v104, v250
v_dot2c_f32_bf16 v94, v105, v249
v_dot2c_f32_bf16 v95, v105, v250
v_dot2c_f32_bf16 v96, v106, v249
v_dot2c_f32_bf16 v97, v106, v250
v_dot2c_f32_bf16 v98, v107, v249
v_dot2c_f32_bf16 v99, v107, v250
s_nop 2
s_branch L_kvredo1b
L_k2redo1:
s_mov_b32 s95, 0
s_mov_b32 s92, 0x40000000
s_mov_b32 s93, 0x40000000
s_mov_b32 s94, 0x40000000
s_add_u32 s36, s66, 0x10000
s_mov_b32 s37, 0
Lpoll_46:
v_mov_b32 v11, 0
buffer_atomic_add v11, v251, s[4:7], s36 offen sc0 sc1
s_add_u32 s37, s37, 1
s_waitcnt vmcnt(0)
v_readfirstlane_b32 s38, v11
s_nop 0
s_cmp_ge_u32 s38, 32
s_cbranch_scc1 Lpe_47
s_cmp_lt_u32 s37, 0x100000
s_cbranch_scc1 Lpoll_46
Lpe_47:
s_nop 7
s_cmp_eq_u32 s3, 0
s_cselect_b32 s35, 8, 0
s_lshl_b32 s35, s35, 12
v_lshlrev_b32 v132, 16, v32
v_and_b32 v133, 0xffff0000, v32
v_lshlrev_b32 v134, 16, v33
v_and_b32 v135, 0xffff0000, v33
v_lshlrev_b32 v136, 16, v34
v_and_b32 v137, 0xffff0000, v34
v_lshlrev_b32 v138, 16, v35
v_and_b32 v139, 0xffff0000, v35
v_lshlrev_b32 v140, 16, v36
v_and_b32 v141, 0xffff0000, v36
v_lshlrev_b32 v142, 16, v37
v_and_b32 v143, 0xffff0000, v37
v_lshlrev_b32 v144, 16, v38
v_and_b32 v145, 0xffff0000, v38
v_lshlrev_b32 v146, 16, v39
v_and_b32 v147, 0xffff0000, v39
v_lshlrev_b32 v148, 16, v40
v_and_b32 v149, 0xffff0000, v40
v_lshlrev_b32 v150, 16, v41
v_and_b32 v151, 0xffff0000, v41
v_lshlrev_b32 v152, 16, v42
v_and_b32 v153, 0xffff0000, v42
v_lshlrev_b32 v154, 16, v43
v_and_b32 v155, 0xffff0000, v43
v_lshlrev_b32 v156, 16, v44
v_and_b32 v157, 0xffff0000, v44
v_lshlrev_b32 v158, 16, v45
v_and_b32 v159, 0xffff0000, v45
v_lshlrev_b32 v160, 16, v46
v_and_b32 v161, 0xffff0000, v46
v_lshlrev_b32 v162, 16, v47
v_and_b32 v163, 0xffff0000, v47
s_branch L_k2go1
L_k2redo2:
s_mov_b32 s95, 0
s_mov_b32 s92, 0x40000000
s_mov_b32 s93, 0x40000000
s_mov_b32 s94, 0x40000000
s_add_u32 s36, s66, 0x20000
s_mov_b32 s37, 0
Lpoll_48:
v_mov_b32 v11, 0
buffer_atomic_add v11, v251, s[4:7], s36 offen sc0 sc1
s_add_u32 s37, s37, 1
s_waitcnt vmcnt(0)
v_readfirstlane_b32 s38, v11
s_nop 0
s_cmp_ge_u32 s38, 32
s_cbranch_scc1 Lpe_49
s_cmp_lt_u32 s37, 0x100000
s_cbranch_scc1 Lpoll_48
Lpe_49:
s_nop 7
s_cmp_eq_u32 s3, 0
s_cselect_b32 s35, 8, 0
s_lshl_b32 s35, s35, 12
v_lshlrev_b32 v132, 16, v32
v_and_b32 v133, 0xffff0000, v32
v_lshlrev_b32 v134, 16, v33
v_and_b32 v135, 0xffff0000, v33
v_lshlrev_b32 v136, 16, v34
v_and_b32 v137, 0xffff0000, v34
v_lshlrev_b32 v138, 16, v35
v_and_b32 v139, 0xffff0000, v35
v_lshlrev_b32 v140, 16, v36
v_and_b32 v141, 0xffff0000, v36
v_lshlrev_b32 v142, 16, v37
v_and_b32 v143, 0xffff0000, v37
v_lshlrev_b32 v144, 16, v38
v_and_b32 v145, 0xffff0000, v38
v_lshlrev_b32 v146, 16, v39
v_and_b32 v147, 0xffff0000, v39
v_lshlrev_b32 v148, 16, v40
v_and_b32 v149, 0xffff0000, v40
v_lshlrev_b32 v150, 16, v41
v_and_b32 v151, 0xffff0000, v41
v_lshlrev_b32 v152, 16, v42
v_and_b32 v153, 0xffff0000, v42
v_lshlrev_b32 v154, 16, v43
v_and_b32 v155, 0xffff0000, v43
v_lshlrev_b32 v156, 16, v44
v_and_b32 v157, 0xffff0000, v44
v_lshlrev_b32 v158, 16, v45
v_and_b32 v159, 0xffff0000, v45
v_lshlrev_b32 v160, 16, v46
v_and_b32 v161, 0xffff0000, v46
v_lshlrev_b32 v162, 16, v47
v_and_b32 v163, 0xffff0000, v47
s_branch L_k2go2
L_kvredo3:
s_mov_b32 s88, 0
L_kvredo3b:
v_max_u32 v132, v48, v49
v_max3_u32 v132, v132, v50, v51
v_max3_u32 v132, v132, v52, v53
v_max3_u32 v132, v132, v54, v55
v_max3_u32 v132, v132, v56, v57
v_max3_u32 v132, v132, v58, v59
v_max3_u32 v132, v132, v60, v61
v_max3_u32 v132, v132, v62, v63
v_max3_u32 v132, v132, v64, v65
v_max3_u32 v132, v132, v66, v67
v_max3_u32 v132, v132, v68, v69
v_max3_u32 v132, v132, v70, v71
v_max3_u32 v132, v132, v100, v101
v_max3_u32 v132, v132, v102, v103
v_max3_u32 v132, v132, v104, v105
v_max3_u32 v132, v132, v106, v107
v_max3_u32 v132, v132, v124, v125
v_max3_u32 v132, v132, v126, v127
v_cmp_eq_u32 vcc, -1, v132
s_cbranch_vccz L_kvback3
s_add_u32 s88, s88, 1
s_cmp_gt_u32 s88, 0x80000
s_cbranch_scc1 L_kvback3
s_sleep 4
buffer_load_dwordx4 v[48:51], v1, s[4:7], s98 offen offset:0 sc1
buffer_load_dwordx4 v[124:127], v248, s[4:7], s100 offen sc1
buffer_load_dwordx4 v[52:55], v1, s[4:7], s98 offen offset:1024 sc1
buffer_load_dwordx4 v[56:59], v1, s[4:7], s98 offen offset:2048 sc1
buffer_load_dwordx4 v[60:63], v1, s[4:7], s98 offen offset:3072 sc1
buffer_load_dwordx4 v[64:67], v1, s[4:7], s99 offen offset:0 sc1
buffer_load_dwordx4 v[68:71], v1, s[4:7], s99 offen offset:1024 sc1
buffer_load_dwordx4 v[100:103], v1, s[4:7], s99 offen offset:2048 sc1
buffer_load_dwordx4 v[104:107], v1, s[4:7], s99 offen offset:3072 sc1
s_waitcnt vmcnt(8)
v_lshlrev_b32 v92, 16, v48
v_and_b32 v93, 0xffff0000, v48
v_lshlrev_b32 v94, 16, v49
v_and_b32 v95, 0xffff0000, v49
v_lshlrev_b32 v96, 16, v50
v_and_b32 v97, 0xffff0000, v50
v_lshlrev_b32 v98, 16, v51
v_and_b32 v99, 0xffff0000, v51
s_waitcnt vmcnt(7)
v_add_f32_dpp v128, v124, v124 row_ror:4 row_mask:0xf bank_mask:0xf
v_add_f32_dpp v129, v125, v125 row_ror:4 row_mask:0xf bank_mask:0xf
v_add_f32_dpp v130, v126, v126 row_ror:4 row_mask:0xf bank_mask:0xf
v_add_f32_dpp v131, v127, v127 row_ror:4 row_mask:0xf bank_mask:0xf
v_add_f32_dpp v128, v128, v128 row_ror:2 row_mask:0xf bank_mask:0xf
v_add_f32_dpp v129, v129, v129 row_ror:2 row_mask:0xf bank_mask:0xf
v_add_f32_dpp v130, v130, v130 row_ror:2 row_mask:0xf bank_mask:0xf
v_add_f32_dpp v131, v131, v131 row_ror:2 row_mask:0xf bank_mask:0xf
v_add_f32_dpp v128, v128, v128 row_ror:1 row_mask:0xf bank_mask:0xf
v_add_f32_dpp v129, v129, v129 row_ror:1 row_mask:0xf bank_mask:0xf
v_add_f32_dpp v130, v130, v130 row_ror:1 row_mask:0xf bank_mask:0xf
v_add_f32_dpp v131, v131, v131 row_ror:1 row_mask:0xf bank_mask:0xf
s_waitcnt vmcnt(6)
v_dot2c_f32_bf16 v92, v52, v249
v_dot2c_f32_bf16 v93, v52, v250
v_dot2c_f32_bf16 v94, v53, v249
v_dot2c_f32_bf16 v95, v53, v250
v_dot2c_f32_bf16 v96, v54, v249
v_dot2c_f32_bf16 v97, v54, v250
v_dot2c_f32_bf16 v98, v55, v249
v_dot2c_f32_bf16 v99, v55, v250
s_waitcnt vmcnt(5)
v_dot2c_f32_bf16 v92, v56, v249
v_dot2c_f32_bf16 v93, v56, v250
v_dot2c_f32_bf16 v94, v57, v249
v_dot2c_f32_bf16 v95, v57, v250
v_dot2c_f32_bf16 v96, v58, v249
v_dot2c_f32_bf16 v97, v58, v250
v_dot2c_f32_bf16 v98, v59, v249
v_dot2c_f32_bf16 v99, v59, v250
s_waitcnt vmcnt(4)
v_dot2c_f32_bf16 v92, v60, v249
v_dot2c_f32_bf16 v93, v60, v250
v_dot2c_f32_bf16 v94, v61, v249
v_dot2c_f32_bf16 v95, v61, v250
v_dot2c_f32_bf16 v96, v62, v249
v_dot2c_f32_bf16 v97, v62, v250
v_dot2c_f32_bf16 v98, v63, v249
v_dot2c_f32_bf16 v99, v63, v250
s_waitcnt vmcnt(3)
v_dot2c_f32_bf16 v92, v64, v249
v_dot2c_f32_bf16 v93, v64, v250
v_dot2c_f32_bf16 v94, v65, v249
v_dot2c_f32_bf16 v95, v65, v250
v_dot2c_f32_bf16 v96, v66, v249
v_dot2c_f32_bf16 v97, v66, v250
v_dot2c_f32_bf16 v98, v67, v249
v_dot2c_f32_bf16 v99, v67, v250
s_waitcnt vmcnt(2)
v_dot2c_f32_bf16 v92, v68, v249
v_dot2c_f32_bf16 v93, v68, v250
v_dot2c_f32_bf16 v94, v69, v249
v_dot2c_f32_bf16 v95, v69, v250
v_dot2c_f32_bf16 v96, v70, v249
v_dot2c_f32_bf16 v97, v70, v250
v_dot2c_f32_bf16 v98, v71, v249
v_dot2c_f32_bf16 v99, v71, v250
s_waitcnt vmcnt(1)
v_dot2c_f32_bf16 v92, v100, v249
v_dot2c_f32_bf16 v93, v100, v250
v_dot2c_f32_bf16 v94, v101, v249
v_dot2c_f32_bf16 v95, v101, v250
v_dot2c_f32_bf16 v96, v102, v249
v_dot2c_f32_bf16 v97, v102, v250
v_dot2c_f32_bf16 v98, v103, v249
v_dot2c_f32_bf16 v99, v103, v250
s_waitcnt vmcnt(0)
v_dot2c_f32_bf16 v92, v104, v249
v_dot2c_f32_bf16 v93, v104, v250
v_dot2c_f32_bf16 v94, v105, v249
v_dot2c_f32_bf16 v95, v105, v250
v_dot2c_f32_bf16 v96, v106, v249
v_dot2c_f32_bf16 v97, v106, v250
v_dot2c_f32_bf16 v98, v107, v249
v_dot2c_f32_bf16 v99, v107, v250
s_nop 2
s_branch L_kvredo3b
L_k2redo3:
s_mov_b32 s95, 0
s_mov_b32 s92, 0x40000000
s_mov_b32 s93, 0x40000000
s_mov_b32 s94, 0x40000000
s_add_u32 s36, s66, 0x30000
s_mov_b32 s37, 0
Lpoll_50:
v_mov_b32 v11, 0
buffer_atomic_add v11, v251, s[4:7], s36 offen sc0 sc1
s_add_u32 s37, s37, 1
s_waitcnt vmcnt(0)
v_readfirstlane_b32 s38, v11
s_nop 0
s_cmp_ge_u32 s38, 32
s_cbranch_scc1 Lpe_51
s_cmp_lt_u32 s37, 0x100000
s_cbranch_scc1 Lpoll_50
Lpe_51:
s_nop 7
s_cmp_eq_u32 s3, 0
s_cselect_b32 s35, 8, 0
s_lshl_b32 s35, s35, 12
v_lshlrev_b32 v132, 16, v32
v_and_b32 v133, 0xffff0000, v32
v_lshlrev_b32 v134, 16, v33
v_and_b32 v135, 0xffff0000, v33
v_lshlrev_b32 v136, 16, v34
v_and_b32 v137, 0xffff0000, v34
v_lshlrev_b32 v138, 16, v35
v_and_b32 v139, 0xffff0000, v35
v_lshlrev_b32 v140, 16, v36
v_and_b32 v141, 0xffff0000, v36
v_lshlrev_b32 v142, 16, v37
v_and_b32 v143, 0xffff0000, v37
v_lshlrev_b32 v144, 16, v38
v_and_b32 v145, 0xffff0000, v38
v_lshlrev_b32 v146, 16, v39
v_and_b32 v147, 0xffff0000, v39
v_lshlrev_b32 v148, 16, v40
v_and_b32 v149, 0xffff0000, v40
v_lshlrev_b32 v150, 16, v41
v_and_b32 v151, 0xffff0000, v41
v_lshlrev_b32 v152, 16, v42
v_and_b32 v153, 0xffff0000, v42
v_lshlrev_b32 v154, 16, v43
v_and_b32 v155, 0xffff0000, v43
v_lshlrev_b32 v156, 16, v44
v_and_b32 v157, 0xffff0000, v44
v_lshlrev_b32 v158, 16, v45
v_and_b32 v159, 0xffff0000, v45
v_lshlrev_b32 v160, 16, v46
v_and_b32 v161, 0xffff0000, v46
v_lshlrev_b32 v162, 16, v47
v_and_b32 v163, 0xffff0000, v47
s_branch L_k2go3
L_code_end:
.section .rodata,"a"
.p2align 6
.amdhsa_kernel interleave_layers__sliding_local_dilated__linear_kernel_hedgehog__prompt_kernel
  .amdhsa_next_free_vgpr 512
  .amdhsa_next_free_sgpr 102
  .amdhsa_accum_offset 256
  .amdhsa_group_segment_fixed_size 0
  .amdhsa_kernarg_size 80
  .amdhsa_user_sgpr_count 2
  .amdhsa_user_sgpr_kernarg_segment_ptr 1
  .amdhsa_system_sgpr_workgroup_id_x 1
.end_amdhsa_kernel
```

```asm
; @launch grid=(256,1,1) block=(256,1,1) lds=163840
.amdgcn_target "amdgcn-amd-amdhsa--gfx950"
.text
.globl interleave_layers__sliding_local_dilated__linear_kernel_hedgehog__prompt_kernel
.p2align 8
.type interleave_layers__sliding_local_dilated__linear_kernel_hedgehog__prompt_kernel,@function
interleave_layers__sliding_local_dilated__linear_kernel_hedgehog__prompt_kernel:
s_cmp_ge_u32 s2, 256
s_cbranch_scc1 L_end
s_load_dwordx16 s[64:79], s[0:1], 0
s_load_dwordx4 s[80:83], s[0:1], 64
s_getpc_b64 s[24:25]
s_mov_b32 s26, (L_end - interleave_layers__sliding_local_dilated__linear_kernel_hedgehog__prompt_kernel - 64)
s_mov_b32 s27, 0x20000
v_lshlrev_b32 v1, 5, v0
buffer_load_dword v238, v1, s[24:27], 0 offen
v_lshrrev_b32 v1, 6, v0
v_and_b32 v0, 63, v0
v_readfirstlane_b32 s28, v1
s_and_b32 s36, s2, 7
s_lshr_b32 s37, s2, 3
s_and_b32 s38, s37, 3
s_lshr_b32 s39, s37, 2
s_and_b32 s29, s36, 1
s_lshl_b32 s32, s29, 3
s_lshl_b32 s29, s29, 2
s_add_u32 s29, s29, s38
s_add_u32 s32, s32, s39
s_lshr_b32 s36, s36, 1
s_lshl_b32 s30, s36, 3
s_add_u32 s30, s30, s39
s_lshl_b32 s31, s36, 2
s_add_u32 s31, s31, s38
s_and_b32 s32, s36, 1
s_lshl_b32 s32, s32, 3
s_add_u32 s32, s32, s39
s_and_b32 s31, s2, 1
s_lshl_b32 s31, s31, 3
s_add_u32 s31, s31, s38
s_and_b32 s3, s2, 4
s_add_u32 s31, s31, s3
s_mov_b32 s3, s39
s_and_b32 s35, s2, 7
s_lshl_b32 s35, s35, 5
s_add_u32 s35, s35, s37
s_mul_i32 s33, s39, 0
s_and_b32 s33, s33, 31
s_mul_i32 s34, s39, 0
s_and_b32 s34, s34, 31
v_lshlrev_b32 v1, 4, v0
v_lshrrev_b32 v233, 4, v0
v_and_b32 v234, 15, v0
s_and_b32 s88, s31, 7
s_lshl_b32 s88, s88, 7
s_lshl_b32 s37, s28, 5
s_add_u32 s88, s88, s37
s_lshl_b32 s88, s88, 1
s_lshr_b32 s37, s31, 3
s_add_u32 s88, s88, s37
s_lshl_b32 s88, s88, 11
s_lshl_b32 s37, s32, 7
s_add_u32 s88, s88, s37
v_lshrrev_b32 v235, 3, v0
v_and_b32 v236, 7, v0
v_xor_b32 v232, v236, v233
v_lshlrev_b32 v232, 4, v232
v_lshl_add_u32 v232, v235, 12, v232
v_xor_b32 v246, 64, v232
v_lshlrev_b32 v236, 4, v236
v_lshl_add_u32 v237, v235, 11, v236
v_mul_u32_u24 v235, 6144, v235
v_add_u32 v235, v235, v236
s_lshr_b32 s36, s35, 4
s_lshl_b32 s36, s36, 2
s_add_u32 s36, s36, s28
s_mul_i32 s36, s36, 98304
s_and_b32 s37, s35, 15
s_lshl_b32 s37, s37, 7
s_add_u32 s36, s36, s37
s_lshl_b32 s37, s28, 11
s_mov_b32 s39, 0x10000
s_mov_b32 s10, 0x400000
s_mov_b32 s11, 0x20000
s_mov_b32 s22, 0x600000
s_mov_b32 s23, 0x20000
s_mov_b32 s6, 0x10000000
s_mov_b32 s7, 0x20000
s_mov_b32 s44, 0xf0000
s_waitcnt lgkmcnt(0)
s_mov_b64 s[8:9], s[64:65]
s_mov_b64 s[20:21], s[66:67]
s_lshl_b32 s39, s37, 1
s_add_u32 m0, s37, 0
s_add_u32 s38, s36, 0
buffer_load_dwordx4 v235, s[20:23], s38 offen nt lds
s_add_u32 m0, s37, 1024
s_add_u32 s38, s36, 49152
buffer_load_dwordx4 v235, s[20:23], s38 offen nt lds
s_add_u32 m0, s37, 8192
s_add_u32 s38, s36, 2048
buffer_load_dwordx4 v235, s[20:23], s38 offen nt lds
s_add_u32 m0, s37, 9216
s_add_u32 s38, s36, 51200
buffer_load_dwordx4 v235, s[20:23], s38 offen nt lds
s_add_u32 m0, s37, 16384
s_add_u32 s38, s36, 4096
buffer_load_dwordx4 v235, s[20:23], s38 offen nt lds
s_add_u32 m0, s37, 17408
s_add_u32 s38, s36, 53248
buffer_load_dwordx4 v235, s[20:23], s38 offen nt lds
s_add_u32 m0, s39, 24576
s_add_u32 s38, s88, 0
buffer_load_dwordx4 v232, s[8:11], s38 offen nt lds
s_add_u32 m0, s39, 25600
s_add_u32 s38, s88, 32768
buffer_load_dwordx4 v246, s[8:11], s38 offen nt lds
s_add_u32 m0, s39, 26624
s_add_u32 s38, s88, 65536
buffer_load_dwordx4 v232, s[8:11], s38 offen nt lds
s_add_u32 m0, s39, 27648
s_add_u32 s38, s88, 98304
buffer_load_dwordx4 v246, s[8:11], s38 offen nt lds
s_mov_b32 s37, s39
v_lshrrev_b32 v232, 1, v234
v_xor_b32 v232, v232, v233
v_lshlrev_b32 v232, 4, v232
v_lshl_add_u32 v232, v234, 7, v232
v_add_u32 v232, s37, v232
s_add_u32 s4, s82, 0x0
s_addc_u32 s5, s83, 0
s_mov_b32 s12, s78
s_mov_b32 s13, s79
s_mov_b32 s14, 0x400000
s_mov_b32 s15, 0x20000
s_mov_b32 s42, 0x400000
s_mov_b32 s43, 0x20000
v_mov_b32 v12, 1
s_mov_b64 s[40:41], s[12:13]
s_mov_b32 s64, 0xff
s_mov_b32 s65, 0
s_and_b32 s81, s29, 3
s_lshl_b32 s66, s31, 4
s_add_u32 s66, s66, s32
s_lshl_b32 s66, s66, 8
s_lshl_b32 s67, s29, 5
s_add_u32 s67, s67, s30
s_lshl_b32 s67, s67, 8
s_lshl_b32 s80, s30, 11
s_lshl_b32 s70, s29, 8
s_add_u32 s70, s70, s80
s_lshl_b32 s71, s29, 13
s_lshr_b32 s78, s31, 1
s_lshl_b32 s78, s78, 13
s_add_u32 s79, s78, 8192
s_bitcmp1_b32 s31, 0
s_cselect_b32 s79, s79, 0x40000000
s_and_b32 s36, s31, 7
s_cmp_eq_u32 s36, 7
s_cselect_b32 s79, 0x40000000, s79
v_mov_b32 v240, 0
v_mov_b32 v241, 0
v_mov_b32 v242, 0
v_mov_b32 v243, 0
v_mov_b32 v228, v235
v_mov_b32 v229, v237
s_lshr_b32 s36, s35, 4
s_lshl_b32 s36, s36, 2
s_add_u32 s36, s36, s28
s_and_b32 s37, s35, 15
s_lshl_b32 s37, s37, 7
s_lshl_b32 s16, s36, 15
s_add_u32 s16, s16, s37
s_mul_i32 s17, s36, 98304
s_add_u32 s17, s17, s37
v_mov_b32 v16, 0x3f803f80
v_mov_b32 v17, 0x3f803f80
v_mov_b32 v18, 0x3f803f80
v_mov_b32 v19, 0x3f803f80
s_mov_b32 s46, 0xaaaaaaaa
s_mov_b32 s47, 0xaaaaaaaa
s_mov_b32 s48, 0xcccccccc
s_mov_b32 s49, 0xcccccccc
s_lshl_b32 s36, s31, 1
s_lshr_b32 s37, s28, 1
s_add_u32 s36, s36, s37
s_lshl_b32 s36, s36, 17
s_and_b32 s37, s28, 1
s_lshl_b32 s37, s37, 11
s_add_u32 s36, s36, s37
v_add_u32 v4, s36, v1
s_lshl_b32 s38, s31, 2
s_add_u32 s38, s38, s28
s_lshl_b32 s38, s38, 12
s_lshl_b32 s39, s32, 7
s_add_u32 s38, s38, s39
v_lshrrev_b32 v244, 2, v234
v_cmp_eq_u32 vcc, v244, v233
v_and_b32 v244, 7, v234
v_lshl_add_u32 v244, v244, 4, s38
v_and_b32 v245, 8, v234
v_add_u32 v244, v244, v245
v_cndmask_b32 v253, 2.0, v244, vcc
v_lshlrev_b32 v244, 4, v233
v_lshl_add_u32 v244, v234, 6, v244
v_cmp_gt_u32 vcc, 2, v234
s_nop 1
v_cndmask_b32 v254, 2.0, v244, vcc
v_lshrrev_b32 v248, 4, v0
v_lshlrev_b32 v248, 10, v248
v_bfe_u32 v249, v0, 2, 2
v_lshl_add_u32 v248, v249, 7, v248
v_and_b32 v251, 3, v0
v_lshl_add_u32 v248, v251, 3, v248
s_lshr_b32 s36, s28, 1
s_lshl_b32 s36, s36, 6
s_and_b32 s37, s28, 1
s_mul_i32 s38, s37, 8224
s_add_u32 s38, s38, s36
s_mul_i32 s39, s37, 16352
s_add_u32 s39, s39, s36
v_add_u32 v249, s39, v248
v_add_u32 v248, s38, v248
s_and_b32 s38, s35, 15
s_lshl_b32 s38, s38, 1
s_lshr_b32 s36, s28, 1
s_add_u32 s38, s38, s36
s_lshr_b32 s36, s35, 4
s_mul_i32 s96, s38, 196608
s_mul_i32 s44, s36, 12288
s_add_u32 s96, s96, s44
s_mul_i32 s44, s37, 3072
s_add_u32 s96, s96, s44
s_add_u32 s96, s96, 0xe00000
s_add_u32 s97, s96, 6144
s_mul_i32 s38, s38, 6
s_mul_i32 s37, s37, 3
s_add_u32 s38, s38, s37
s_lshl_b32 s38, s38, 11
s_lshl_b32 s36, s36, 7
s_add_u32 s38, s38, s36
s_add_u32 s98, s38, 0x300000
s_add_u32 s99, s98, 4096
v_lshrrev_b32 v247, 2, v0
v_lshlrev_b32 v250, 7, v247
v_lshl_add_u32 v250, v251, 4, v250
s_lshr_b32 s36, s28, 1
s_lshl_b32 s36, s36, 12
s_and_b32 s37, s28, 1
s_lshl_b32 s37, s37, 6
s_add_u32 s36, s36, s37
s_add_u32 s36, s36, 147456
v_add_u32 v250, s36, v250
v_subrev_u32 v230, 122880, v250
s_and_b32 s36, s35, 15
s_lshl_b32 s36, s36, 17
s_lshr_b32 s37, s35, 4
s_lshl_b32 s37, s37, 13
s_add_u32 s36, s36, s37
s_lshl_b32 s37, s28, 11
s_add_u32 s36, s36, s37
s_add_u32 s100, s36, 0xa00000
s_add_u32 s101, s36, 0xc00000
v_lshlrev_b32 v247, 6, v247
v_lshl_add_u32 v251, v251, 3, v247
v_add_u32 v251, 155648, v251
v_xor_b32 v236, 64, v232
s_mov_b64 s[20:21], s[68:69]
s_mov_b32 s22, 0x200000
s_lshl_b32 s37, s28, 11
s_add_u32 m0, s37, 147456
s_add_u32 s36, s16, 0
buffer_load_dwordx4 v229, s[20:23], s36 offen nt lds
s_add_u32 m0, s37, 148480
s_add_u32 s36, s16, 16384
buffer_load_dwordx4 v229, s[20:23], s36 offen nt lds
s_add_u32 s36, s67, 0xc0000
s_add_u32 s37, s66, 0xd0000
s_cmp_eq_u32 s28, 2
s_cselect_b32 s36, s37, s36
s_cmp_eq_u32 s28, 1
s_cselect_b32 s37, 128, 0
s_add_u32 s36, s36, s37
s_cmp_eq_u32 s28, 3
s_cselect_b32 s37, 0x20000, 0
s_add_u32 s36, s36, s37
s_mov_b64 exec, 1
buffer_atomic_add v240, off, s[4:7], s36 sc1
s_mov_b64 exec, -1
s_mov_b32 s36, 0xf0000
buffer_load_dword v11, off, s[4:7], s36 sc1
s_lshr_b32 s36, s2, 3
s_lshl_b32 s36, s36, 2
s_add_u32 s36, s36, s28
s_lshl_b32 s36, s36, 10
buffer_load_dwordx4 a[0:3], v1, s[24:27], s36 offen
s_mov_b64 s[20:21], s[74:75]
s_mov_b32 s22, 0x10000
s_and_b32 s36, s28, 1
s_lshl_b32 s36, s36, 10
s_add_u32 m0, s36, 155648
s_lshl_b32 s37, s30, 11
s_add_u32 s36, s36, s37
buffer_load_dwordx4 v1, s[20:23], s36 offen lds
s_waitcnt vmcnt(6)
ds_read_b128 v[32:35], v232 offset:24576
ds_read_b128 v[36:39], v236 offset:24576
ds_read_b128 v[40:43], v232 offset:26624
ds_read_b128 v[44:47], v236 offset:26624
s_barrier
ds_read_b64_tr_b16 a[188:189], v248 offset:0
ds_read_b64_tr_b16 a[190:191], v248 offset:512
ds_read_b64_tr_b16 a[192:193], v248 offset:4096
ds_read_b64_tr_b16 a[194:195], v248 offset:4608
ds_read_b64_tr_b16 a[196:197], v249 offset:32
ds_read_b64_tr_b16 a[198:199], v249 offset:544
ds_read_b64_tr_b16 a[200:201], v249 offset:4128
ds_read_b64_tr_b16 a[202:203], v249 offset:4640
ds_read_b64_tr_b16 a[204:205], v248 offset:8192
ds_read_b64_tr_b16 a[206:207], v248 offset:8704
ds_read_b64_tr_b16 a[208:209], v248 offset:12288
ds_read_b64_tr_b16 a[210:211], v248 offset:12800
s_lshl_b32 s36, s32, 13
s_add_u32 s36, s36, 0x0
s_add_u32 s37, s36, 4096
s_mov_b32 s38, 0x200000
s_waitcnt lgkmcnt(14)
v_mfma_f32_16x16x32_bf16 v[96:99], v[32:35], v[32:35], 0
v_mfma_f32_16x16x32_bf16 v[92:95], v[16:19], v[32:35], 0
buffer_store_dwordx4 v[32:35], v4, s[12:15], s36 offen offset:0 sc1
s_waitcnt lgkmcnt(13)
v_mfma_f32_16x16x32_bf16 v[104:107], v[40:43], v[40:43], 0
v_mfma_f32_16x16x32_bf16 v[100:103], v[16:19], v[40:43], 0
buffer_store_dwordx4 v[40:43], v4, s[12:15], s36 offen offset:1024 sc1
v_mfma_f32_16x16x32_bf16 v[96:99], v[36:39], v[36:39], v[96:99]
v_mfma_f32_16x16x32_bf16 v[92:95], v[16:19], v[36:39], v[92:95]
buffer_store_dwordx4 v[36:39], v4, s[12:15], s37 offen offset:0 sc1
s_waitcnt lgkmcnt(12)
v_mfma_f32_16x16x32_bf16 v[104:107], v[44:47], v[44:47], v[104:107]
v_mfma_f32_16x16x32_bf16 v[100:103], v[16:19], v[44:47], v[100:103]
buffer_store_dwordx4 v[44:47], v4, s[12:15], s37 offen offset:1024 sc1
s_nop 1
v_cndmask_b32 v96, v96, v97, s[46:47]
v_cndmask_b32 v98, v98, v99, s[46:47]
v_cndmask_b32 v93, v96, v98, s[48:49]
buffer_store_dwordx2 v[92:93], v253, s[4:7], s38 offen offset:0 sc1
v_cndmask_b32 v104, v104, v105, s[46:47]
v_cndmask_b32 v106, v106, v107, s[46:47]
v_cndmask_b32 v101, v104, v106, s[48:49]
buffer_store_dwordx2 v[100:101], v253, s[4:7], s38 offen offset:2048 sc1
s_waitcnt lgkmcnt(10)
v_mfma_f32_16x16x32_bf16 v[108:111], a[188:191], v[16:19], 0
s_waitcnt lgkmcnt(6)
v_mfma_f32_16x16x32_bf16 v[112:115], a[196:199], v[16:19], 0
s_waitcnt lgkmcnt(2)
v_mfma_f32_16x16x32_bf16 v[116:119], a[204:207], v[16:19], 0
v_mfma_f32_16x16x32_bf16 v[108:111], a[192:195], v[16:19], v[108:111]
v_mfma_f32_16x16x32_bf16 v[112:115], a[200:203], v[16:19], v[112:115]
s_waitcnt lgkmcnt(0)
v_mfma_f32_16x16x32_bf16 v[116:119], a[208:211], v[16:19], v[116:119]
buffer_store_dwordx4 a[188:191], v1, s[4:7], s96 offen offset:0 sc1
buffer_store_dwordx4 a[192:195], v1, s[4:7], s97 offen offset:0 sc1
buffer_store_dwordx4 a[196:199], v1, s[4:7], s96 offen offset:1024 sc1
buffer_store_dwordx4 a[200:203], v1, s[4:7], s97 offen offset:1024 sc1
buffer_store_dwordx4 a[204:207], v1, s[4:7], s96 offen offset:2048 sc1
buffer_store_dwordx4 a[208:211], v1, s[4:7], s97 offen offset:2048 sc1
buffer_store_dwordx4 v[108:111], v254, s[4:7], s98 offen offset:0 sc1
buffer_store_dwordx4 v[112:115], v254, s[4:7], s98 offen offset:2048 sc1
buffer_store_dwordx4 v[116:119], v254, s[4:7], s99 offen offset:0 sc1
v_lshlrev_b32 v239, 16, v233
v_lshl_add_u32 v239, v234, 4, v239
s_cmp_eq_u32 s28, 0
s_cselect_b32 s36, s66, s67
s_cmp_eq_u32 s28, 2
s_cselect_b32 s36, s70, s36
s_lshl_b32 s37, s28, 18
s_add_u32 s36, s36, s37
s_cmp_eq_u32 s28, 3
s_cselect_b32 s36, 0x40000000, s36
buffer_store_dwordx4 v[240:243], v239, s[4:7], s36 offen sc1
s_waitcnt vmcnt(20)
s_barrier
ds_read_b64_tr_b16 a[212:213], v250 offset:0
ds_read_b64_tr_b16 a[214:215], v250 offset:2048
ds_read_b64_tr_b16 a[216:217], v250 offset:8
ds_read_b64_tr_b16 a[218:219], v250 offset:2056
s_waitcnt lgkmcnt(2)
buffer_store_dwordx4 a[212:215], v1, s[4:7], s100 offen offset:0 sc1
s_waitcnt lgkmcnt(0)
buffer_store_dwordx4 a[216:219], v1, s[4:7], s100 offen offset:1024 sc1
s_mov_b32 s56, 0x11111111
s_mov_b32 s57, 0x11111111
s_mov_b32 s58, 0x22222222
s_mov_b32 s59, 0x22222222
s_mul_i32 s18, s28, 3072
s_lshl_b32 s19, s28, 12
s_mul_i32 s50, s30, 196608
s_add_u32 s50, s50, s18
s_lshl_b32 s36, s32, 17
s_add_u32 s36, s36, s19
s_add_u32 s37, s28, 0
s_cmp_eq_u32 s37, s3
s_cselect_b32 s37, 32768, 0
s_add_u32 s84, s36, s37
s_mul_i32 s37, s37, 3
s_sub_u32 s86, s36, s37
s_add_u32 s37, s28, 4
s_cmp_eq_u32 s37, s3
s_cselect_b32 s37, 32768, 0
s_add_u32 s85, s36, s37
s_mul_i32 s37, s37, 3
s_sub_u32 s87, s36, s37
s_mul_i32 s55, s28, 6144
v_accvgpr_write_b32 a248, -1
v_accvgpr_write_b32 a249, -1
v_accvgpr_write_b32 a250, -1
v_accvgpr_write_b32 a251, -1
s_lshl_b32 s36, s29, 2
s_add_u32 s36, s36, s28
s_lshl_b32 s37, s36, 17
v_add_u32 v2, s37, v1
s_lshl_b32 s82, s36, 13
s_and_b32 s38, s29, 3
s_cmp_eq_u32 s38, 0
s_cselect_b32 s38, 0, 0x1f400
s_cselect_b32 s39, 0, 2048
s_cselect_b32 s54, 32, 48
s_lshl_b32 s37, s29, 19
s_sub_u32 s37, s37, s38
v_add_u32 v3, s37, v1
v_cmp_le_u32 vcc, 8, v234
s_nop 1
v_cndmask_b32 v3, 2.0, v3, vcc
s_lshl_b32 s37, s29, 15
s_sub_u32 s83, s37, s39
s_cmp_eq_u32 s28, 0
s_cselect_b32 vcc_lo, -1, 0
s_mov_b32 vcc_hi, 0
v_lshlrev_b32 v244, 8, v0
v_cndmask_b32 v10, 2.0, v244, vcc
v_and_b32 v244, 1, v233
v_lshl_add_u32 v244, v244, 3, v234
v_and_b32 v244, 15, v244
v_lshrrev_b32 v245, 1, v233
v_lshl_add_u32 v244, v245, 4, v244
v_lshrrev_b32 v245, 3, v234
v_lshl_add_u32 v244, v245, 5, v244
v_lshlrev_b32 v7, 3, v244
v_lshrrev_b32 v246, 2, v0
v_and_b32 v247, 3, v0
v_and_b32 v244, 1, v247
v_lshl_add_u32 v244, v244, 3, v246
v_and_b32 v244, 15, v244
v_lshrrev_b32 v245, 1, v247
v_lshl_add_u32 v244, v245, 4, v244
v_lshrrev_b32 v245, 3, v246
v_lshl_add_u32 v244, v245, 5, v244
v_lshlrev_b32 v8, 3, v244
s_and_b32 s36, s28, 1
s_lshl_b32 s37, s36, 3
s_add_u32 s37, s37, 20480
s_lshl_b32 s36, s36, 9
v_add_u32 v244, s37, v1
v_add_u32 v245, s36, v7
s_cmp_lt_u32 s28, 2
s_cselect_b64 vcc, -1, 0
v_cndmask_b32 v9, v245, v244, vcc
s_cmp_eq_u32 s28, 3
s_cselect_b64 vcc, -1, 0
v_cndmask_b32 v3, 2.0, v1, vcc
s_lshl_b32 s83, s67, 3
s_cmp_eq_u32 s54, 32
s_cselect_b32 s36, 1, s28
s_cmp_eq_u32 s36, 0
s_cselect_b64 vcc, -1, 0
v_cndmask_b32 v9, 2.0, v1, vcc
v_lshlrev_b32 v239, 2, v233
v_sub_u32 v239, v239, v234
v_mov_b32 v247, 0xf149f2ca
v_add_u32 v246, 7, v239
v_cmp_gt_u32 vcc, 8, v246
v_mov_b32 v244, 0xffff
s_nop 0
v_cndmask_b32 v24, v247, 0, vcc
v_cndmask_b32 v244, 0, v244, vcc
v_mov_b32 v30, v244
v_add_u32 v246, 0, v239
v_cmp_le_i32 vcc, 9, v246
v_mov_b32 v244, 0xffff
s_nop 0
v_cndmask_b32 v20, v247, 0, vcc
v_cndmask_b32 v244, 0, v244, vcc
v_mov_b32 v28, v244
v_add_u32 v246, 8, v239
v_cmp_gt_u32 vcc, 8, v246
v_mov_b32 v244, 0xffff0000
s_nop 0
v_cndmask_b32 v25, v247, 0, vcc
v_cndmask_b32 v244, 0, v244, vcc
v_or_b32 v30, v30, v244
v_add_u32 v246, 1, v239
v_cmp_le_i32 vcc, 9, v246
v_mov_b32 v244, 0xffff0000
s_nop 0
v_cndmask_b32 v21, v247, 0, vcc
v_cndmask_b32 v244, 0, v244, vcc
v_or_b32 v28, v28, v244
v_add_u32 v246, 9, v239
v_cmp_gt_u32 vcc, 8, v246
v_mov_b32 v244, 0xffff
s_nop 0
v_cndmask_b32 v26, v247, 0, vcc
v_cndmask_b32 v244, 0, v244, vcc
v_mov_b32 v31, v244
v_add_u32 v246, 2, v239
v_cmp_le_i32 vcc, 9, v246
v_mov_b32 v244, 0xffff
s_nop 0
v_cndmask_b32 v22, v247, 0, vcc
v_cndmask_b32 v244, 0, v244, vcc
v_mov_b32 v29, v244
v_add_u32 v246, 10, v239
v_cmp_gt_u32 vcc, 8, v246
v_mov_b32 v244, 0xffff0000
s_nop 0
v_cndmask_b32 v27, v247, 0, vcc
v_cndmask_b32 v244, 0, v244, vcc
v_or_b32 v31, v31, v244
v_add_u32 v246, 3, v239
v_cmp_le_i32 vcc, 9, v246
v_mov_b32 v244, 0xffff0000
s_nop 0
v_cndmask_b32 v23, v247, 0, vcc
v_cndmask_b32 v244, 0, v244, vcc
v_or_b32 v29, v29, v244
s_and_b32 s36, s29, 3
s_or_b32 s36, s36, s28
s_cmp_eq_u32 s36, 0
s_cselect_b64 vcc, -1, 0
v_cndmask_b32 v76, v20, v247, vcc
v_cndmask_b32 v77, v21, v247, vcc
v_cndmask_b32 v78, v22, v247, vcc
v_cndmask_b32 v79, v23, v247, vcc
v_cndmask_b32 v80, v28, 0, vcc
v_cndmask_b32 v81, v29, 0, vcc
s_add_u32 s91, s83, 0x900000
buffer_store_dwordx4 a[248:251], v3, s[4:7], s91 offen offset:0 sc1
buffer_store_dwordx4 a[248:251], v3, s[4:7], s91 offen offset:1024 sc1
s_mov_b32 s36, 0x9e3779b1
s_waitcnt vmcnt(22)
v_mul_lo_u32 v15, v11, s36
v_add_u32 v15, 0x7f4a7c15, v15
s_and_b32 s36, s31, 1
s_lshl_b32 s36, s36, 4
s_add_u32 s36, s36, s32
s_lshl_b32 s36, s36, 2
s_add_u32 s92, s78, s36
s_add_u32 s92, s92, 0xc0000
s_lshl_b32 s36, s32, 2
s_add_u32 s93, s79, s36
s_add_u32 s93, s93, 0xc0080
s_and_b32 s94, s35, 15
s_lshl_b32 s94, s94, 9
s_lshr_b32 s36, s35, 4
s_lshl_b32 s36, s36, 2
s_add_u32 s94, s94, s36
s_add_u32 s94, s94, 0xc00c0
v_lshrrev_b32 v240, 1, v0
v_lshlrev_b32 v240, 13, v240
v_and_b32 v241, 1, v0
v_lshl_add_u32 v240, v241, 8, v240
s_mov_b32 vcc_lo, 0xffff
s_mov_b32 vcc_hi, 0
v_cndmask_b32 v240, 2.0, v240, vcc
v_lshlrev_b32 v241, 2, v0
v_add_u32 v248, 0, v248
v_add_u32 v249, 0, v249
s_add_u32 s96, s96, 0x600000
s_add_u32 s98, s98, 0x80000
s_add_u32 s97, s97, 0x600000
s_add_u32 s99, s99, 0x80000
s_cmp_eq_u32 s28, 0
s_cselect_b32 vcc_lo, 0xffff, 0
v_lshlrev_b32 v252, 12, v0
v_cndmask_b32 v252, 2.0, v252, vcc
v_cndmask_b32 v14, 2.0, v240, vcc
s_and_b32 s62, s35, 15
s_lshl_b32 s62, s62, 8
s_lshr_b32 s36, s35, 4
s_lshl_b32 s36, s36, 2
s_add_u32 s62, s62, s36
s_add_u32 s62, s62, 0xd0000
s_add_u32 s8, s94, 0x1ff40
v_and_b32 v255, 15, v0
v_lshlrev_b32 v255, 2, v255
s_waitcnt vmcnt(0)
s_barrier
s_cmp_lg_u32 s28, 0
s_cbranch_scc1 Lg1s_1
buffer_atomic_swap v15, v10, s[4:7], s92 offen sc1
s_add_u32 s36, s67, 0xc2080
s_cmp_eq_u32 s81, 3
s_cselect_b32 s36, 0x40000000, s36
s_mov_b64 exec, 1
buffer_atomic_swap v15, off, s[4:7], s36 sc1
s_mov_b64 exec, -1
buffer_atomic_swap v15, v240, s[4:7], s94 offen sc1
buffer_atomic_swap v15, v252, s[4:7], s62 offen sc1
Lg1s_1:
s_branch L_aligned
.p2align 12
L_aligned:
s_mov_b64 s[20:21], s[76:77]
s_mov_b32 s22, 0x200000
s_add_u32 s89, s16, 0
buffer_load_dwordx4 a[220:223], v229, s[20:23], s89 offen nt
s_mov_b64 s[20:21], s[76:77]
s_mov_b32 s22, 0x200000
s_add_u32 s89, s16, 16384
buffer_load_dwordx4 a[224:227], v229, s[20:23], s89 offen nt
s_mov_b64 s[20:21], s[72:73]
s_mov_b32 s22, 0x600000
s_add_u32 s89, s17, 0
buffer_load_dwordx4 a[188:191], v228, s[20:23], s89 offen nt
s_mov_b64 s[20:21], s[72:73]
s_mov_b32 s22, 0x600000
s_add_u32 s89, s17, 49152
buffer_load_dwordx4 a[192:195], v228, s[20:23], s89 offen nt
s_mov_b64 s[20:21], s[72:73]
s_mov_b32 s22, 0x600000
s_add_u32 s89, s17, 2048
buffer_load_dwordx4 a[196:199], v228, s[20:23], s89 offen nt
s_mov_b64 s[20:21], s[72:73]
s_mov_b32 s22, 0x600000
s_add_u32 s89, s17, 51200
buffer_load_dwordx4 a[200:203], v228, s[20:23], s89 offen nt
s_mov_b64 s[20:21], s[72:73]
s_mov_b32 s22, 0x600000
s_add_u32 s89, s17, 4096
buffer_load_dwordx4 a[204:207], v228, s[20:23], s89 offen nt
s_mov_b64 s[20:21], s[72:73]
s_mov_b32 s22, 0x600000
s_add_u32 s89, s17, 53248
buffer_load_dwordx4 a[208:211], v228, s[20:23], s89 offen nt
s_add_u32 s89, s66, 0xd0000
ds_read_b64_tr_b16 a[240:241], v251 offset:0
ds_read_b64_tr_b16 a[242:243], v251 offset:1024
ds_read_b64_tr_b16 a[244:245], v251 offset:32
ds_read_b64_tr_b16 a[246:247], v251 offset:1056
s_lshl_b32 s36, s28, 11
v_add_u32 v231, s36, v1
s_waitcnt lgkmcnt(0)
v_add_u32 v231, 0, v231
v_cmp_eq_u32 vcc, 0, v0
s_nop 1
v_cndmask_b32 v251, 2.0, v0, vcc
s_mov_b64 exec, 0
s_cmp_eq_u32 s28, 3
s_cbranch_scc1 L_stub0
s_cmp_eq_u32 s28, 2
s_cbranch_scc1 L_stub1
s_cmp_eq_u32 s28, 0
s_cbranch_scc1 L_stub2
L_wret0:
s_mov_b64 exec, -1
s_cmp_lg_u32 s28, 1
s_cbranch_scc1 Lg1e_3
s_cmp_eq_u32 s54, 32
s_cselect_b32 s39, 0, 1
s_or_b32 s39, s39, 0xffff0000
s_mov_b32 s38, -1
s_add_u32 s36, s67, 0xc0000
s_mov_b32 s37, 0
Lg1p_2:
v_mov_b32 v11, 0
buffer_atomic_add v11, v241, s[4:7], s36 offen sc0 sc1
s_add_u32 s37, s37, 1
v_mov_b32 v242, v15
s_mov_b64 exec, 0xffff
v_mov_b32 v242, 0
buffer_atomic_add v242, v241, s[4:7], s89 offen sc0 sc1
s_mov_b64 exec, -1
s_waitcnt vmcnt(0)
v_cmp_ne_u32 vcc, v11, v15
v_cmp_ne_u32 s[52:53], v242, v15
s_and_b64 vcc, vcc, s[38:39]
s_or_b64 vcc, vcc, s[52:53]
s_cbranch_scc0 Lg1e_3
s_cmp_lt_u32 s37, 0x100000
s_cbranch_scc1 Lg1p_2
Lg1e_3:
s_barrier
s_add_u32 s94, s71, 0x80
s_add_u32 s9, s66, 0x80
s_add_u32 m0, s18, 0x0
s_add_u32 s44, s50, 0xe00000
buffer_load_dwordx4 v1, s[4:7], s44 offen offset:0 sc1 lds
buffer_load_dwordx4 v1, s[4:7], s44 offen offset:1024 sc1 lds
buffer_load_dwordx4 v1, s[4:7], s44 offen offset:2048 sc1 lds
s_add_u32 m0, s18, 0x3000
s_add_u32 s44, s50, 0xe03000
buffer_load_dwordx4 v1, s[4:7], s44 offen offset:0 sc1 lds
buffer_load_dwordx4 v1, s[4:7], s44 offen offset:1024 sc1 lds
buffer_load_dwordx4 v1, s[4:7], s44 offen offset:2048 sc1 lds
s_add_u32 m0, s18, 0x6000
s_add_u32 s44, s50, 0xe06000
buffer_load_dwordx4 v1, s[4:7], s44 offen offset:0 sc1 lds
buffer_load_dwordx4 v1, s[4:7], s44 offen offset:1024 sc1 lds
buffer_load_dwordx4 v1, s[4:7], s44 offen offset:2048 sc1 lds
s_add_u32 m0, s18, 0x9000
s_add_u32 s44, s50, 0xe09000
buffer_load_dwordx4 v1, s[4:7], s44 offen offset:0 sc1 lds
buffer_load_dwordx4 v1, s[4:7], s44 offen offset:1024 sc1 lds
buffer_load_dwordx4 v1, s[4:7], s44 offen offset:2048 sc1 lds
s_mov_b32 s35, 0
s_mov_b32 s33, 0x1000
buffer_load_dwordx4 a[0:3], v2, s[40:43], s35 offen offset:0 sc1
buffer_load_dwordx4 a[4:7], v2, s[40:43], s33 offen offset:0 sc1
buffer_load_dwordx4 a[8:11], v2, s[40:43], s35 offen offset:1024 sc1
buffer_load_dwordx4 a[12:15], v2, s[40:43], s33 offen offset:1024 sc1
buffer_load_dwordx4 a[16:19], v2, s[40:43], s35 offen offset:2048 sc1
buffer_load_dwordx4 a[20:23], v2, s[40:43], s33 offen offset:2048 sc1
buffer_load_dwordx4 a[24:27], v2, s[40:43], s35 offen offset:3072 sc1
buffer_load_dwordx4 a[28:31], v2, s[40:43], s33 offen offset:3072 sc1
s_add_u32 s35, s35, 8192
s_add_u32 s33, s33, 8192
buffer_load_dwordx4 a[32:35], v2, s[40:43], s35 offen offset:0 sc1
buffer_load_dwordx4 a[36:39], v2, s[40:43], s33 offen offset:0 sc1
buffer_load_dwordx4 a[40:43], v2, s[40:43], s35 offen offset:1024 sc1
buffer_load_dwordx4 a[44:47], v2, s[40:43], s33 offen offset:1024 sc1
buffer_load_dwordx4 a[48:51], v2, s[40:43], s35 offen offset:2048 sc1
buffer_load_dwordx4 a[52:55], v2, s[40:43], s33 offen offset:2048 sc1
buffer_load_dwordx4 a[56:59], v2, s[40:43], s35 offen offset:3072 sc1
buffer_load_dwordx4 a[60:63], v2, s[40:43], s33 offen offset:3072 sc1
s_add_u32 s35, s35, 8192
s_add_u32 s33, s33, 8192
s_waitcnt vmcnt(16)
s_barrier
v_add_u32 v5, 0, v1
ds_read_b128 a[96:99], v5 offset:2048
ds_read_b128 a[100:103], v5 offset:8192
ds_read_b128 a[104:107], v5 offset:3072
ds_read_b128 a[108:111], v5 offset:9216
ds_read_b128 a[112:115], v5 offset:4096
ds_read_b128 a[116:119], v5 offset:10240
s_waitcnt vmcnt(14) lgkmcnt(4)
v_mfma_f32_16x16x32_bf16 v[140:143], a[96:99], a[0:3], 0
s_add_u32 m0, s18, 0xc000
s_add_u32 s44, s50, 0xe0c000
v_mfma_f32_16x16x32_bf16 v[140:143], a[100:103], a[4:7], v[140:143]
buffer_load_dwordx4 a[64:67], v2, s[40:43], s35 offen offset:0 sc1
s_waitcnt vmcnt(13)
v_mfma_f32_16x16x32_bf16 v[164:167], a[100:103], a[12:15], 0
ds_read_b128 a[128:131], v5 offset:5120
v_mfma_f32_16x16x32_bf16 v[164:167], a[96:99], a[8:11], v[164:167]
ds_read_b128 a[132:135], v5 offset:11264
s_waitcnt vmcnt(12)
v_mfma_f32_16x16x32_bf16 v[188:191], a[96:99], a[16:19], 0
s_waitcnt vmcnt(11)
v_mfma_f32_16x16x32_bf16 v[188:191], a[100:103], a[20:23], v[188:191]
buffer_load_dwordx4 v1, s[4:7], s44 offen offset:0 sc1 lds
s_waitcnt vmcnt(10)
v_mfma_f32_16x16x32_bf16 v[212:215], a[100:103], a[28:31], 0
ds_read_b128 a[136:139], v5 offset:0
v_mfma_f32_16x16x32_bf16 v[212:215], a[96:99], a[24:27], v[212:215]
s_waitcnt lgkmcnt(6)
v_mfma_f32_16x16x32_bf16 v[216:219], a[104:107], a[24:27], 0
ds_read_b128 a[140:143], v5 offset:6144
s_waitcnt lgkmcnt(6)
v_mfma_f32_16x16x32_bf16 v[216:219], a[108:111], a[28:31], v[216:219]
buffer_load_dwordx4 a[68:71], v2, s[40:43], s33 offen offset:0 sc1
v_mfma_f32_16x16x32_bf16 v[192:195], a[108:111], a[20:23], 0
ds_read_b128 a[144:147], v5 offset:1024
v_mfma_f32_16x16x32_bf16 v[192:195], a[104:107], a[16:19], v[192:195]
v_mfma_f32_16x16x32_bf16 v[168:171], a[104:107], a[8:11], 0
v_mfma_f32_16x16x32_bf16 v[168:171], a[108:111], a[12:15], v[168:171]
buffer_load_dwordx4 a[72:75], v2, s[40:43], s35 offen offset:1024 sc1
v_mfma_f32_16x16x32_bf16 v[144:147], a[108:111], a[4:7], 0
ds_read_b128 a[148:151], v5 offset:7168
v_mfma_f32_16x16x32_bf16 v[144:147], a[104:107], a[0:3], v[144:147]
s_waitcnt lgkmcnt(7)
v_mfma_f32_16x16x32_bf16 v[148:151], a[112:115], a[0:3], 0
s_waitcnt lgkmcnt(6)
v_mfma_f32_16x16x32_bf16 v[148:151], a[116:119], a[4:7], v[148:151]
buffer_load_dwordx4 v1, s[4:7], s44 offen offset:1024 sc1 lds
v_mfma_f32_16x16x32_bf16 v[172:175], a[116:119], a[12:15], 0
v_mfma_f32_16x16x32_bf16 v[172:175], a[112:115], a[8:11], v[172:175]
v_mfma_f32_16x16x32_bf16 v[196:199], a[112:115], a[16:19], 0
v_mfma_f32_16x16x32_bf16 v[196:199], a[116:119], a[20:23], v[196:199]
buffer_load_dwordx4 a[76:79], v2, s[40:43], s33 offen offset:1024 sc1
v_mfma_f32_16x16x32_bf16 v[220:223], a[116:119], a[28:31], 0
v_mfma_f32_16x16x32_bf16 v[220:223], a[112:115], a[24:27], v[220:223]
s_waitcnt lgkmcnt(0)
v_mfma_f32_16x16x32_bf16 v[224:227], a[128:131], a[24:27], 0
ds_read_b128 a[96:99], v5 offset:14336
v_mfma_f32_16x16x32_bf16 v[224:227], a[132:135], a[28:31], v[224:227]
buffer_load_dwordx4 a[80:83], v2, s[40:43], s35 offen offset:2048 sc1
v_mfma_f32_16x16x32_bf16 v[200:203], a[132:135], a[20:23], 0
ds_read_b128 a[100:103], v5 offset:20480
v_mfma_f32_16x16x32_bf16 v[200:203], a[128:131], a[16:19], v[200:203]
v_mfma_f32_16x16x32_bf16 v[176:179], a[128:131], a[8:11], 0
v_mfma_f32_16x16x32_bf16 v[176:179], a[132:135], a[12:15], v[176:179]
buffer_load_dwordx4 v1, s[4:7], s44 offen offset:2048 sc1 lds
s_add_u32 m0, s18, 0xf000
v_mfma_f32_16x16x32_bf16 v[152:155], a[132:135], a[4:7], 0
s_add_u32 s44, s50, 0xe0f000
ds_read_b128 a[104:107], v5 offset:15360
v_mfma_f32_16x16x32_bf16 v[152:155], a[128:131], a[0:3], v[152:155]
v_mfma_f32_16x16x32_bf16 v[132:135], a[136:139], a[0:3], 0
ds_read_b128 a[108:111], v5 offset:21504
v_mfma_f32_16x16x32_bf16 v[132:135], a[140:143], a[4:7], v[132:135]
buffer_load_dwordx4 a[84:87], v2, s[40:43], s33 offen offset:2048 sc1
v_mfma_f32_16x16x32_bf16 v[156:159], a[140:143], a[12:15], 0
ds_read_b128 a[112:115], v5 offset:16384
v_mfma_f32_16x16x32_bf16 v[156:159], a[136:139], a[8:11], v[156:159]
v_mfma_f32_16x16x32_bf16 v[180:183], a[136:139], a[16:19], 0
v_mfma_f32_16x16x32_bf16 v[180:183], a[140:143], a[20:23], v[180:183]
buffer_load_dwordx4 a[88:91], v2, s[40:43], s35 offen offset:3072 sc1
v_mfma_f32_16x16x32_bf16 v[204:207], a[140:143], a[28:31], 0
ds_read_b128 a[116:119], v5 offset:22528
v_mfma_f32_16x16x32_bf16 v[204:207], a[136:139], a[24:27], v[204:207]
v_mfma_f32_16x16x32_bf16 v[208:211], a[144:147], a[24:27], 0
v_mfma_f32_16x16x32_bf16 v[208:211], a[148:151], a[28:31], v[208:211]
buffer_load_dwordx4 v1, s[4:7], s44 offen offset:0 sc1 lds
v_mfma_f32_16x16x32_bf16 v[184:187], a[148:151], a[20:23], 0
v_mfma_f32_16x16x32_bf16 v[184:187], a[144:147], a[16:19], v[184:187]
v_mfma_f32_16x16x32_bf16 v[160:163], a[144:147], a[8:11], 0
v_mfma_f32_16x16x32_bf16 v[160:163], a[148:151], a[12:15], v[160:163]
buffer_load_dwordx4 a[92:95], v2, s[40:43], s33 offen offset:3072 sc1
s_add_u32 s35, s35, 8192
v_mfma_f32_16x16x32_bf16 v[136:139], a[148:151], a[4:7], 0
s_add_u32 s33, s33, 8192
v_mfma_f32_16x16x32_bf16 v[136:139], a[144:147], a[0:3], v[136:139]
s_waitcnt vmcnt(12) lgkmcnt(0)
v_mfma_f32_16x16x32_bf16 v[140:143], a[96:99], a[32:35], v[140:143]
ds_read_b128 a[128:131], v5 offset:17408
v_mfma_f32_16x16x32_bf16 v[140:143], a[100:103], a[36:39], v[140:143]
buffer_load_dwordx4 a[0:3], v2, s[40:43], s35 offen offset:0 sc1
v_mfma_f32_16x16x32_bf16 v[164:167], a[100:103], a[44:47], v[164:167]
ds_read_b128 a[132:135], v5 offset:23552
v_mfma_f32_16x16x32_bf16 v[164:167], a[96:99], a[40:43], v[164:167]
v_mfma_f32_16x16x32_bf16 v[188:191], a[96:99], a[48:51], v[188:191]
v_mfma_f32_16x16x32_bf16 v[188:191], a[100:103], a[52:55], v[188:191]
buffer_load_dwordx4 v1, s[4:7], s44 offen offset:1024 sc1 lds
v_mfma_f32_16x16x32_bf16 v[212:215], a[100:103], a[60:63], v[212:215]
ds_read_b128 a[136:139], v5 offset:12288
v_mfma_f32_16x16x32_bf16 v[212:215], a[96:99], a[56:59], v[212:215]
v_mfma_f32_16x16x32_bf16 v[216:219], a[104:107], a[56:59], v[216:219]
ds_read_b128 a[140:143], v5 offset:18432
v_mfma_f32_16x16x32_bf16 v[216:219], a[108:111], a[60:63], v[216:219]
buffer_load_dwordx4 a[4:7], v2, s[40:43], s33 offen offset:0 sc1
v_mfma_f32_16x16x32_bf16 v[192:195], a[108:111], a[52:55], v[192:195]
ds_read_b128 a[144:147], v5 offset:13312
v_mfma_f32_16x16x32_bf16 v[192:195], a[104:107], a[48:51], v[192:195]
v_mfma_f32_16x16x32_bf16 v[168:171], a[104:107], a[40:43], v[168:171]
v_mfma_f32_16x16x32_bf16 v[168:171], a[108:111], a[44:47], v[168:171]
buffer_load_dwordx4 a[8:11], v2, s[40:43], s35 offen offset:1024 sc1
v_mfma_f32_16x16x32_bf16 v[144:147], a[108:111], a[36:39], v[144:147]
ds_read_b128 a[148:151], v5 offset:19456
v_mfma_f32_16x16x32_bf16 v[144:147], a[104:107], a[32:35], v[144:147]
v_mfma_f32_16x16x32_bf16 v[148:151], a[112:115], a[32:35], v[148:151]
v_mfma_f32_16x16x32_bf16 v[148:151], a[116:119], a[36:39], v[148:151]
buffer_load_dwordx4 v1, s[4:7], s44 offen offset:2048 sc1 lds
s_add_u32 m0, s18, 0x12000
v_mfma_f32_16x16x32_bf16 v[172:175], a[116:119], a[44:47], v[172:175]
s_add_u32 s44, s50, 0xe12000
v_mfma_f32_16x16x32_bf16 v[172:175], a[112:115], a[40:43], v[172:175]
v_mfma_f32_16x16x32_bf16 v[196:199], a[112:115], a[48:51], v[196:199]
v_mfma_f32_16x16x32_bf16 v[196:199], a[116:119], a[52:55], v[196:199]
buffer_load_dwordx4 a[12:15], v2, s[40:43], s33 offen offset:1024 sc1
v_mfma_f32_16x16x32_bf16 v[220:223], a[116:119], a[60:63], v[220:223]
v_mfma_f32_16x16x32_bf16 v[220:223], a[112:115], a[56:59], v[220:223]
s_waitcnt lgkmcnt(0)
v_mfma_f32_16x16x32_bf16 v[224:227], a[128:131], a[56:59], v[224:227]
ds_read_b128 a[96:99], v5 offset:26624
v_mfma_f32_16x16x32_bf16 v[224:227], a[132:135], a[60:63], v[224:227]
buffer_load_dwordx4 a[16:19], v2, s[40:43], s35 offen offset:2048 sc1
v_mfma_f32_16x16x32_bf16 v[200:203], a[132:135], a[52:55], v[200:203]
ds_read_b128 a[100:103], v5 offset:32768
v_mfma_f32_16x16x32_bf16 v[200:203], a[128:131], a[48:51], v[200:203]
v_mfma_f32_16x16x32_bf16 v[176:179], a[128:131], a[40:43], v[176:179]
v_mfma_f32_16x16x32_bf16 v[176:179], a[132:135], a[44:47], v[176:179]
buffer_load_dwordx4 v1, s[4:7], s44 offen offset:0 sc1 lds
v_mfma_f32_16x16x32_bf16 v[152:155], a[132:135], a[36:39], v[152:155]
ds_read_b128 a[104:107], v5 offset:27648
v_mfma_f32_16x16x32_bf16 v[152:155], a[128:131], a[32:35], v[152:155]
v_mfma_f32_16x16x32_bf16 v[132:135], a[136:139], a[32:35], v[132:135]
ds_read_b128 a[108:111], v5 offset:33792
v_mfma_f32_16x16x32_bf16 v[132:135], a[140:143], a[36:39], v[132:135]
buffer_load_dwordx4 a[20:23], v2, s[40:43], s33 offen offset:2048 sc1
v_mfma_f32_16x16x32_bf16 v[156:159], a[140:143], a[44:47], v[156:159]
ds_read_b128 a[112:115], v5 offset:28672
v_mfma_f32_16x16x32_bf16 v[156:159], a[136:139], a[40:43], v[156:159]
v_mfma_f32_16x16x32_bf16 v[180:183], a[136:139], a[48:51], v[180:183]
v_mfma_f32_16x16x32_bf16 v[180:183], a[140:143], a[52:55], v[180:183]
buffer_load_dwordx4 a[24:27], v2, s[40:43], s35 offen offset:3072 sc1
v_mfma_f32_16x16x32_bf16 v[204:207], a[140:143], a[60:63], v[204:207]
ds_read_b128 a[116:119], v5 offset:34816
v_mfma_f32_16x16x32_bf16 v[204:207], a[136:139], a[56:59], v[204:207]
v_mfma_f32_16x16x32_bf16 v[208:211], a[144:147], a[56:59], v[208:211]
v_mfma_f32_16x16x32_bf16 v[208:211], a[148:151], a[60:63], v[208:211]
buffer_load_dwordx4 v1, s[4:7], s44 offen offset:1024 sc1 lds
v_mfma_f32_16x16x32_bf16 v[184:187], a[148:151], a[52:55], v[184:187]
v_mfma_f32_16x16x32_bf16 v[184:187], a[144:147], a[48:51], v[184:187]
v_mfma_f32_16x16x32_bf16 v[160:163], a[144:147], a[40:43], v[160:163]
v_mfma_f32_16x16x32_bf16 v[160:163], a[148:151], a[44:47], v[160:163]
buffer_load_dwordx4 a[28:31], v2, s[40:43], s33 offen offset:3072 sc1
s_add_u32 s35, s35, 8192
v_mfma_f32_16x16x32_bf16 v[136:139], a[148:151], a[36:39], v[136:139]
s_add_u32 s33, s33, 8192
v_mfma_f32_16x16x32_bf16 v[136:139], a[144:147], a[32:35], v[136:139]
s_waitcnt vmcnt(12) lgkmcnt(0)
v_mfma_f32_16x16x32_bf16 v[140:143], a[96:99], a[64:67], v[140:143]
ds_read_b128 a[128:131], v5 offset:29696
v_mfma_f32_16x16x32_bf16 v[140:143], a[100:103], a[68:71], v[140:143]
buffer_load_dwordx4 a[32:35], v2, s[40:43], s35 offen offset:0 sc1
v_mfma_f32_16x16x32_bf16 v[164:167], a[100:103], a[76:79], v[164:167]
ds_read_b128 a[132:135], v5 offset:35840
v_mfma_f32_16x16x32_bf16 v[164:167], a[96:99], a[72:75], v[164:167]
v_mfma_f32_16x16x32_bf16 v[188:191], a[96:99], a[80:83], v[188:191]
v_mfma_f32_16x16x32_bf16 v[188:191], a[100:103], a[84:87], v[188:191]
buffer_load_dwordx4 v1, s[4:7], s44 offen offset:2048 sc1 lds
s_add_u32 m0, s18, 0x15000
v_mfma_f32_16x16x32_bf16 v[212:215], a[100:103], a[92:95], v[212:215]
s_add_u32 s44, s50, 0xe15000
ds_read_b128 a[136:139], v5 offset:24576
v_mfma_f32_16x16x32_bf16 v[212:215], a[96:99], a[88:91], v[212:215]
v_mfma_f32_16x16x32_bf16 v[216:219], a[104:107], a[88:91], v[216:219]
ds_read_b128 a[140:143], v5 offset:30720
v_mfma_f32_16x16x32_bf16 v[216:219], a[108:111], a[92:95], v[216:219]
buffer_load_dwordx4 a[36:39], v2, s[40:43], s33 offen offset:0 sc1
v_mfma_f32_16x16x32_bf16 v[192:195], a[108:111], a[84:87], v[192:195]
ds_read_b128 a[144:147], v5 offset:25600
v_mfma_f32_16x16x32_bf16 v[192:195], a[104:107], a[80:83], v[192:195]
v_mfma_f32_16x16x32_bf16 v[168:171], a[104:107], a[72:75], v[168:171]
v_mfma_f32_16x16x32_bf16 v[168:171], a[108:111], a[76:79], v[168:171]
buffer_load_dwordx4 a[40:43], v2, s[40:43], s35 offen offset:1024 sc1
v_mfma_f32_16x16x32_bf16 v[144:147], a[108:111], a[68:71], v[144:147]
ds_read_b128 a[148:151], v5 offset:31744
v_mfma_f32_16x16x32_bf16 v[144:147], a[104:107], a[64:67], v[144:147]
v_mfma_f32_16x16x32_bf16 v[148:151], a[112:115], a[64:67], v[148:151]
v_mfma_f32_16x16x32_bf16 v[148:151], a[116:119], a[68:71], v[148:151]
buffer_load_dwordx4 v1, s[4:7], s44 offen offset:0 sc1 lds
v_mfma_f32_16x16x32_bf16 v[172:175], a[116:119], a[76:79], v[172:175]
v_mfma_f32_16x16x32_bf16 v[172:175], a[112:115], a[72:75], v[172:175]
v_mfma_f32_16x16x32_bf16 v[196:199], a[112:115], a[80:83], v[196:199]
v_mfma_f32_16x16x32_bf16 v[196:199], a[116:119], a[84:87], v[196:199]
buffer_load_dwordx4 a[44:47], v2, s[40:43], s33 offen offset:1024 sc1
v_mfma_f32_16x16x32_bf16 v[220:223], a[116:119], a[92:95], v[220:223]
v_mfma_f32_16x16x32_bf16 v[220:223], a[112:115], a[88:91], v[220:223]
s_waitcnt lgkmcnt(0)
v_mfma_f32_16x16x32_bf16 v[224:227], a[128:131], a[88:91], v[224:227]
ds_read_b128 a[96:99], v5 offset:38912
v_mfma_f32_16x16x32_bf16 v[224:227], a[132:135], a[92:95], v[224:227]
buffer_load_dwordx4 a[48:51], v2, s[40:43], s35 offen offset:2048 sc1
v_mfma_f32_16x16x32_bf16 v[200:203], a[132:135], a[84:87], v[200:203]
ds_read_b128 a[100:103], v5 offset:45056
v_mfma_f32_16x16x32_bf16 v[200:203], a[128:131], a[80:83], v[200:203]
v_mfma_f32_16x16x32_bf16 v[176:179], a[128:131], a[72:75], v[176:179]
v_mfma_f32_16x16x32_bf16 v[176:179], a[132:135], a[76:79], v[176:179]
buffer_load_dwordx4 v1, s[4:7], s44 offen offset:1024 sc1 lds
v_mfma_f32_16x16x32_bf16 v[152:155], a[132:135], a[68:71], v[152:155]
ds_read_b128 a[104:107], v5 offset:39936
v_mfma_f32_16x16x32_bf16 v[152:155], a[128:131], a[64:67], v[152:155]
v_mfma_f32_16x16x32_bf16 v[132:135], a[136:139], a[64:67], v[132:135]
ds_read_b128 a[108:111], v5 offset:46080
v_mfma_f32_16x16x32_bf16 v[132:135], a[140:143], a[68:71], v[132:135]
buffer_load_dwordx4 a[52:55], v2, s[40:43], s33 offen offset:2048 sc1
v_mfma_f32_16x16x32_bf16 v[156:159], a[140:143], a[76:79], v[156:159]
ds_read_b128 a[112:115], v5 offset:40960
v_mfma_f32_16x16x32_bf16 v[156:159], a[136:139], a[72:75], v[156:159]
v_mfma_f32_16x16x32_bf16 v[180:183], a[136:139], a[80:83], v[180:183]
v_mfma_f32_16x16x32_bf16 v[180:183], a[140:143], a[84:87], v[180:183]
buffer_load_dwordx4 a[56:59], v2, s[40:43], s35 offen offset:3072 sc1
v_mfma_f32_16x16x32_bf16 v[204:207], a[140:143], a[92:95], v[204:207]
ds_read_b128 a[116:119], v5 offset:47104
v_mfma_f32_16x16x32_bf16 v[204:207], a[136:139], a[88:91], v[204:207]
v_mfma_f32_16x16x32_bf16 v[208:211], a[144:147], a[88:91], v[208:211]
v_mfma_f32_16x16x32_bf16 v[208:211], a[148:151], a[92:95], v[208:211]
buffer_load_dwordx4 v1, s[4:7], s44 offen offset:2048 sc1 lds
v_mfma_f32_16x16x32_bf16 v[184:187], a[148:151], a[84:87], v[184:187]
v_and_b32 v232, 15, v0
v_lshlrev_b32 v232, 7, v232
v_mfma_f32_16x16x32_bf16 v[184:187], a[144:147], a[80:83], v[184:187]
v_lshrrev_b32 v233, 4, v0
v_lshlrev_b32 v233, 4, v233
v_mfma_f32_16x16x32_bf16 v[160:163], a[144:147], a[72:75], v[160:163]
v_add_u32 v232, v233, v232
s_mul_i32 s38, s30, 12288
v_mfma_f32_16x16x32_bf16 v[160:163], a[148:151], a[76:79], v[160:163]
buffer_load_dwordx4 a[60:63], v2, s[40:43], s33 offen offset:3072 sc1
s_add_u32 s35, s35, 8192
v_mfma_f32_16x16x32_bf16 v[136:139], a[148:151], a[68:71], v[136:139]
s_add_u32 s33, s33, 8192
s_add_u32 s38, s38, 0x300000
s_add_u32 s39, s28, 4
v_mfma_f32_16x16x32_bf16 v[136:139], a[144:147], a[64:67], v[136:139]
s_min_u32 s39, s39, 5
s_waitcnt vmcnt(12) lgkmcnt(0)
v_mfma_f32_16x16x32_bf16 v[140:143], a[96:99], a[0:3], v[140:143]
s_lshl_b32 s36, s28, 11
s_add_u32 s36, s36, s38
s_lshl_b32 s37, s39, 11
v_mfma_f32_16x16x32_bf16 v[140:143], a[100:103], a[4:7], v[140:143]
buffer_load_dwordx4 a[64:67], v2, s[40:43], s35 offen offset:0 sc1
s_add_u32 s37, s37, s38
v_mfma_f32_16x16x32_bf16 v[164:167], a[100:103], a[12:15], v[164:167]
ds_read_b128 a[128:131], v5 offset:41984
v_mfma_f32_16x16x32_bf16 v[164:167], a[96:99], a[8:11], v[164:167]
ds_read_b128 a[132:135], v5 offset:48128
v_mfma_f32_16x16x32_bf16 v[188:191], a[96:99], a[16:19], v[188:191]
v_mfma_f32_16x16x32_bf16 v[188:191], a[100:103], a[20:23], v[188:191]
buffer_load_dwordx4 v[48:51], v232, s[4:7], s36 offen sc1
v_mfma_f32_16x16x32_bf16 v[212:215], a[100:103], a[28:31], v[212:215]
ds_read_b128 a[136:139], v5 offset:36864
v_mfma_f32_16x16x32_bf16 v[212:215], a[96:99], a[24:27], v[212:215]
v_mfma_f32_16x16x32_bf16 v[216:219], a[104:107], a[24:27], v[216:219]
ds_read_b128 a[140:143], v5 offset:43008
v_mfma_f32_16x16x32_bf16 v[216:219], a[108:111], a[28:31], v[216:219]
buffer_load_dwordx4 a[68:71], v2, s[40:43], s33 offen offset:0 sc1
v_mfma_f32_16x16x32_bf16 v[192:195], a[108:111], a[20:23], v[192:195]
ds_read_b128 a[144:147], v5 offset:37888
v_mfma_f32_16x16x32_bf16 v[192:195], a[104:107], a[16:19], v[192:195]
v_mfma_f32_16x16x32_bf16 v[168:171], a[104:107], a[8:11], v[168:171]
v_mfma_f32_16x16x32_bf16 v[168:171], a[108:111], a[12:15], v[168:171]
buffer_load_dwordx4 a[72:75], v2, s[40:43], s35 offen offset:1024 sc1
v_mfma_f32_16x16x32_bf16 v[144:147], a[108:111], a[4:7], v[144:147]
ds_read_b128 a[148:151], v5 offset:44032
v_mfma_f32_16x16x32_bf16 v[144:147], a[104:107], a[0:3], v[144:147]
v_mfma_f32_16x16x32_bf16 v[148:151], a[112:115], a[0:3], v[148:151]
v_mfma_f32_16x16x32_bf16 v[148:151], a[116:119], a[4:7], v[148:151]
buffer_load_dwordx4 v[52:55], v232, s[4:7], s37 offen sc1
s_add_u32 m0, s18, 0x18000
v_mfma_f32_16x16x32_bf16 v[172:175], a[116:119], a[12:15], v[172:175]
s_add_u32 s44, s50, 0xe18000
v_mfma_f32_16x16x32_bf16 v[172:175], a[112:115], a[8:11], v[172:175]
v_mfma_f32_16x16x32_bf16 v[196:199], a[112:115], a[16:19], v[196:199]
v_mfma_f32_16x16x32_bf16 v[196:199], a[116:119], a[20:23], v[196:199]
buffer_load_dwordx4 a[76:79], v2, s[40:43], s33 offen offset:1024 sc1
v_mfma_f32_16x16x32_bf16 v[220:223], a[116:119], a[28:31], v[220:223]
v_mfma_f32_16x16x32_bf16 v[220:223], a[112:115], a[24:27], v[220:223]
s_waitcnt lgkmcnt(0)
s_barrier
v_mfma_f32_16x16x32_bf16 v[224:227], a[128:131], a[24:27], v[224:227]
v_add_u32 v5, 49152, v1
v_mfma_f32_16x16x32_bf16 v[224:227], a[132:135], a[28:31], v[224:227]
buffer_load_dwordx4 a[80:83], v2, s[40:43], s35 offen offset:2048 sc1
v_mfma_f32_16x16x32_bf16 v[200:203], a[132:135], a[20:23], v[200:203]
ds_read_b128 a[96:99], v5 offset:2048
v_mfma_f32_16x16x32_bf16 v[200:203], a[128:131], a[16:19], v[200:203]
ds_read_b128 a[100:103], v5 offset:8192
v_mfma_f32_16x16x32_bf16 v[176:179], a[128:131], a[8:11], v[176:179]
ds_write_b128 v231, a[220:223] offset:24576
v_mfma_f32_16x16x32_bf16 v[176:179], a[132:135], a[12:15], v[176:179]
buffer_load_dwordx4 v1, s[4:7], s44 offen offset:0 sc1 lds
v_mfma_f32_16x16x32_bf16 v[152:155], a[132:135], a[4:7], v[152:155]
ds_read_b128 a[104:107], v5 offset:3072
v_mfma_f32_16x16x32_bf16 v[152:155], a[128:131], a[0:3], v[152:155]
v_mfma_f32_16x16x32_bf16 v[132:135], a[136:139], a[0:3], v[132:135]
ds_read_b128 a[108:111], v5 offset:9216
v_mfma_f32_16x16x32_bf16 v[132:135], a[140:143], a[4:7], v[132:135]
buffer_load_dwordx4 a[84:87], v2, s[40:43], s33 offen offset:2048 sc1
v_mfma_f32_16x16x32_bf16 v[156:159], a[140:143], a[12:15], v[156:159]
ds_read_b128 a[112:115], v5 offset:4096
v_mfma_f32_16x16x32_bf16 v[156:159], a[136:139], a[8:11], v[156:159]
ds_write_b128 v231, a[224:227] offset:25600
v_mfma_f32_16x16x32_bf16 v[180:183], a[136:139], a[16:19], v[180:183]
v_mfma_f32_16x16x32_bf16 v[180:183], a[140:143], a[20:23], v[180:183]
buffer_load_dwordx4 a[88:91], v2, s[40:43], s35 offen offset:3072 sc1
v_mfma_f32_16x16x32_bf16 v[204:207], a[140:143], a[28:31], v[204:207]
ds_read_b128 a[116:119], v5 offset:10240
v_mfma_f32_16x16x32_bf16 v[204:207], a[136:139], a[24:27], v[204:207]
v_mfma_f32_16x16x32_bf16 v[208:211], a[144:147], a[24:27], v[208:211]
v_mfma_f32_16x16x32_bf16 v[208:211], a[148:151], a[28:31], v[208:211]
buffer_load_dwordx4 v1, s[4:7], s44 offen offset:1024 sc1 lds
v_mfma_f32_16x16x32_bf16 v[184:187], a[148:151], a[20:23], v[184:187]
v_mfma_f32_16x16x32_bf16 v[184:187], a[144:147], a[16:19], v[184:187]
v_mfma_f32_16x16x32_bf16 v[160:163], a[144:147], a[8:11], v[160:163]
v_mfma_f32_16x16x32_bf16 v[160:163], a[148:151], a[12:15], v[160:163]
buffer_load_dwordx4 a[92:95], v2, s[40:43], s33 offen offset:3072 sc1
s_add_u32 s35, s35, 8192
v_mfma_f32_16x16x32_bf16 v[136:139], a[148:151], a[4:7], v[136:139]
s_add_u32 s33, s33, 8192
ds_write_b128 v231, a[188:191] offset:0
v_mfma_f32_16x16x32_bf16 v[136:139], a[144:147], a[0:3], v[136:139]
s_waitcnt vmcnt(12) lgkmcnt(1)
v_mfma_f32_16x16x32_bf16 v[140:143], a[96:99], a[32:35], v[140:143]
ds_read_b128 a[128:131], v5 offset:5120
v_mfma_f32_16x16x32_bf16 v[140:143], a[100:103], a[36:39], v[140:143]
buffer_load_dwordx4 a[0:3], v2, s[40:43], s35 offen offset:0 sc1
v_mfma_f32_16x16x32_bf16 v[164:167], a[100:103], a[44:47], v[164:167]
ds_read_b128 a[132:135], v5 offset:11264
v_mfma_f32_16x16x32_bf16 v[164:167], a[96:99], a[40:43], v[164:167]
v_mfma_f32_16x16x32_bf16 v[188:191], a[96:99], a[48:51], v[188:191]
v_mfma_f32_16x16x32_bf16 v[188:191], a[100:103], a[52:55], v[188:191]
buffer_load_dwordx4 v1, s[4:7], s44 offen offset:2048 sc1 lds
s_add_u32 m0, s18, 0x1b000
v_mfma_f32_16x16x32_bf16 v[212:215], a[100:103], a[60:63], v[212:215]
s_add_u32 s44, s50, 0xe1b000
ds_read_b128 a[136:139], v5 offset:0
v_mfma_f32_16x16x32_bf16 v[212:215], a[96:99], a[56:59], v[212:215]
ds_write_b128 v231, a[192:195] offset:1024
v_mfma_f32_16x16x32_bf16 v[216:219], a[104:107], a[56:59], v[216:219]
ds_read_b128 a[140:143], v5 offset:6144
v_mfma_f32_16x16x32_bf16 v[216:219], a[108:111], a[60:63], v[216:219]
buffer_load_dwordx4 a[4:7], v2, s[40:43], s33 offen offset:0 sc1
v_mfma_f32_16x16x32_bf16 v[192:195], a[108:111], a[52:55], v[192:195]
ds_read_b128 a[144:147], v5 offset:1024
v_mfma_f32_16x16x32_bf16 v[192:195], a[104:107], a[48:51], v[192:195]
v_mfma_f32_16x16x32_bf16 v[168:171], a[104:107], a[40:43], v[168:171]
v_mfma_f32_16x16x32_bf16 v[168:171], a[108:111], a[44:47], v[168:171]
buffer_load_dwordx4 a[8:11], v2, s[40:43], s35 offen offset:1024 sc1
v_mfma_f32_16x16x32_bf16 v[144:147], a[108:111], a[36:39], v[144:147]
ds_read_b128 a[148:151], v5 offset:7168
v_mfma_f32_16x16x32_bf16 v[144:147], a[104:107], a[32:35], v[144:147]
v_mfma_f32_16x16x32_bf16 v[148:151], a[112:115], a[32:35], v[148:151]
v_mfma_f32_16x16x32_bf16 v[148:151], a[116:119], a[36:39], v[148:151]
buffer_load_dwordx4 v1, s[4:7], s44 offen offset:0 sc1 lds
v_mfma_f32_16x16x32_bf16 v[172:175], a[116:119], a[44:47], v[172:175]
ds_write_b128 v231, a[196:199] offset:8192
v_mfma_f32_16x16x32_bf16 v[172:175], a[112:115], a[40:43], v[172:175]
v_mfma_f32_16x16x32_bf16 v[196:199], a[112:115], a[48:51], v[196:199]
v_mfma_f32_16x16x32_bf16 v[196:199], a[116:119], a[52:55], v[196:199]
buffer_load_dwordx4 a[12:15], v2, s[40:43], s33 offen offset:1024 sc1
v_mfma_f32_16x16x32_bf16 v[220:223], a[116:119], a[60:63], v[220:223]
v_mfma_f32_16x16x32_bf16 v[220:223], a[112:115], a[56:59], v[220:223]
s_waitcnt lgkmcnt(1)
v_mfma_f32_16x16x32_bf16 v[224:227], a[128:131], a[56:59], v[224:227]
ds_read_b128 a[96:99], v5 offset:14336
v_mfma_f32_16x16x32_bf16 v[224:227], a[132:135], a[60:63], v[224:227]
buffer_load_dwordx4 a[16:19], v2, s[40:43], s35 offen offset:2048 sc1
v_mfma_f32_16x16x32_bf16 v[200:203], a[132:135], a[52:55], v[200:203]
ds_read_b128 a[100:103], v5 offset:20480
v_mfma_f32_16x16x32_bf16 v[200:203], a[128:131], a[48:51], v[200:203]
v_mfma_f32_16x16x32_bf16 v[176:179], a[128:131], a[40:43], v[176:179]
v_mfma_f32_16x16x32_bf16 v[176:179], a[132:135], a[44:47], v[176:179]
buffer_load_dwordx4 v1, s[4:7], s44 offen offset:1024 sc1 lds
v_mfma_f32_16x16x32_bf16 v[152:155], a[132:135], a[36:39], v[152:155]
ds_read_b128 a[104:107], v5 offset:15360
v_mfma_f32_16x16x32_bf16 v[152:155], a[128:131], a[32:35], v[152:155]
ds_write_b128 v231, a[200:203] offset:9216
v_mfma_f32_16x16x32_bf16 v[132:135], a[136:139], a[32:35], v[132:135]
ds_read_b128 a[108:111], v5 offset:21504
v_mfma_f32_16x16x32_bf16 v[132:135], a[140:143], a[36:39], v[132:135]
buffer_load_dwordx4 a[20:23], v2, s[40:43], s33 offen offset:2048 sc1
v_mfma_f32_16x16x32_bf16 v[156:159], a[140:143], a[44:47], v[156:159]
ds_read_b128 a[112:115], v5 offset:16384
v_mfma_f32_16x16x32_bf16 v[156:159], a[136:139], a[40:43], v[156:159]
v_mfma_f32_16x16x32_bf16 v[180:183], a[136:139], a[48:51], v[180:183]
v_mfma_f32_16x16x32_bf16 v[180:183], a[140:143], a[52:55], v[180:183]
buffer_load_dwordx4 a[24:27], v2, s[40:43], s35 offen offset:3072 sc1
v_mfma_f32_16x16x32_bf16 v[204:207], a[140:143], a[60:63], v[204:207]
ds_read_b128 a[116:119], v5 offset:22528
v_mfma_f32_16x16x32_bf16 v[204:207], a[136:139], a[56:59], v[204:207]
ds_write_b128 v231, a[204:207] offset:16384
v_mfma_f32_16x16x32_bf16 v[208:211], a[144:147], a[56:59], v[208:211]
v_mfma_f32_16x16x32_bf16 v[208:211], a[148:151], a[60:63], v[208:211]
buffer_load_dwordx4 v1, s[4:7], s44 offen offset:2048 sc1 lds
s_add_u32 s88, s82, 0x200000
v_mfma_f32_16x16x32_bf16 v[184:187], a[148:151], a[52:55], v[184:187]
v_mfma_f32_16x16x32_bf16 v[184:187], a[144:147], a[48:51], v[184:187]
v_mfma_f32_16x16x32_bf16 v[160:163], a[144:147], a[40:43], v[160:163]
v_mfma_f32_16x16x32_bf16 v[160:163], a[148:151], a[44:47], v[160:163]
buffer_load_dwordx4 a[28:31], v2, s[40:43], s33 offen offset:3072 sc1
s_add_u32 s35, s35, 8192
v_mfma_f32_16x16x32_bf16 v[136:139], a[148:151], a[36:39], v[136:139]
L_stub0:
s_cbranch_execz L_wret0
s_add_u32 s33, s33, 8192
v_mfma_f32_16x16x32_bf16 v[136:139], a[144:147], a[32:35], v[136:139]
s_waitcnt vmcnt(12) lgkmcnt(1)
v_mfma_f32_16x16x32_bf16 v[140:143], a[96:99], a[64:67], v[140:143]
ds_read_b128 a[128:131], v5 offset:17408
v_mfma_f32_16x16x32_bf16 v[140:143], a[100:103], a[68:71], v[140:143]
buffer_load_dwordx4 a[32:35], v2, s[40:43], s35 offen offset:0 sc1
v_mfma_f32_16x16x32_bf16 v[164:167], a[100:103], a[76:79], v[164:167]
ds_read_b128 a[132:135], v5 offset:23552
v_mfma_f32_16x16x32_bf16 v[164:167], a[96:99], a[72:75], v[164:167]
ds_write_b128 v231, a[208:211] offset:17408
v_mfma_f32_16x16x32_bf16 v[188:191], a[96:99], a[80:83], v[188:191]
v_mfma_f32_16x16x32_bf16 v[188:191], a[100:103], a[84:87], v[188:191]
buffer_load_dwordx4 v[92:95], v1, s[4:7], s88 offen offset:0 sc1
v_mfma_f32_16x16x32_bf16 v[212:215], a[100:103], a[92:95], v[212:215]
ds_read_b128 a[136:139], v5 offset:12288
v_mfma_f32_16x16x32_bf16 v[212:215], a[96:99], a[88:91], v[212:215]
v_mfma_f32_16x16x32_bf16 v[216:219], a[104:107], a[88:91], v[216:219]
ds_read_b128 a[140:143], v5 offset:18432
v_mfma_f32_16x16x32_bf16 v[216:219], a[108:111], a[92:95], v[216:219]
buffer_load_dwordx4 a[36:39], v2, s[40:43], s33 offen offset:0 sc1
v_mfma_f32_16x16x32_bf16 v[192:195], a[108:111], a[84:87], v[192:195]
ds_read_b128 a[144:147], v5 offset:13312
v_mfma_f32_16x16x32_bf16 v[192:195], a[104:107], a[80:83], v[192:195]
v_mfma_f32_16x16x32_bf16 v[168:171], a[104:107], a[72:75], v[168:171]
v_mfma_f32_16x16x32_bf16 v[168:171], a[108:111], a[76:79], v[168:171]
buffer_load_dwordx4 a[40:43], v2, s[40:43], s35 offen offset:1024 sc1
v_mfma_f32_16x16x32_bf16 v[144:147], a[108:111], a[68:71], v[144:147]
ds_read_b128 a[148:151], v5 offset:19456
v_mfma_f32_16x16x32_bf16 v[144:147], a[104:107], a[64:67], v[144:147]
v_mfma_f32_16x16x32_bf16 v[148:151], a[112:115], a[64:67], v[148:151]
v_mfma_f32_16x16x32_bf16 v[148:151], a[116:119], a[68:71], v[148:151]
buffer_load_dwordx4 v[96:99], v1, s[4:7], s88 offen offset:1024 sc1
v_mfma_f32_16x16x32_bf16 v[172:175], a[116:119], a[76:79], v[172:175]
v_mfma_f32_16x16x32_bf16 v[172:175], a[112:115], a[72:75], v[172:175]
v_mfma_f32_16x16x32_bf16 v[196:199], a[112:115], a[80:83], v[196:199]
v_mfma_f32_16x16x32_bf16 v[196:199], a[116:119], a[84:87], v[196:199]
buffer_load_dwordx4 a[44:47], v2, s[40:43], s33 offen offset:1024 sc1
v_mfma_f32_16x16x32_bf16 v[220:223], a[116:119], a[92:95], v[220:223]
v_mfma_f32_16x16x32_bf16 v[220:223], a[112:115], a[88:91], v[220:223]
s_waitcnt lgkmcnt(0)
s_barrier
v_mfma_f32_16x16x32_bf16 v[224:227], a[128:131], a[88:91], v[224:227]
ds_read_b128 a[96:99], v5 offset:26624
v_mfma_f32_16x16x32_bf16 v[224:227], a[132:135], a[92:95], v[224:227]
buffer_load_dwordx4 a[48:51], v2, s[40:43], s35 offen offset:2048 sc1
v_mfma_f32_16x16x32_bf16 v[200:203], a[132:135], a[84:87], v[200:203]
ds_read_b128 a[100:103], v5 offset:32768
v_mfma_f32_16x16x32_bf16 v[200:203], a[128:131], a[80:83], v[200:203]
ds_read_b64_tr_b16 a[220:221], v230 offset:0
v_mfma_f32_16x16x32_bf16 v[176:179], a[128:131], a[72:75], v[176:179]
buffer_load_dwordx4 v[100:103], v1, s[4:7], s88 offen offset:2048 sc1
v_mfma_f32_16x16x32_bf16 v[176:179], a[132:135], a[76:79], v[176:179]
ds_read_b128 a[104:107], v5 offset:27648
v_mfma_f32_16x16x32_bf16 v[152:155], a[132:135], a[68:71], v[152:155]
ds_read_b64_tr_b16 a[222:223], v230 offset:2048
v_mfma_f32_16x16x32_bf16 v[152:155], a[128:131], a[64:67], v[152:155]
buffer_load_dwordx4 a[52:55], v2, s[40:43], s33 offen offset:2048 sc1
v_mfma_f32_16x16x32_bf16 v[132:135], a[136:139], a[64:67], v[132:135]
ds_read_b128 a[108:111], v5 offset:33792
v_mfma_f32_16x16x32_bf16 v[132:135], a[140:143], a[68:71], v[132:135]
v_mfma_f32_16x16x32_bf16 v[156:159], a[140:143], a[76:79], v[156:159]
ds_read_b128 a[112:115], v5 offset:28672
v_mfma_f32_16x16x32_bf16 v[156:159], a[136:139], a[72:75], v[156:159]
buffer_load_dwordx4 v[104:107], v1, s[4:7], s88 offen offset:3072 sc1
s_add_u32 s88, s88, 4096
v_mfma_f32_16x16x32_bf16 v[180:183], a[136:139], a[80:83], v[180:183]
ds_read_b64_tr_b16 a[224:225], v230 offset:8
v_mfma_f32_16x16x32_bf16 v[180:183], a[140:143], a[84:87], v[180:183]
ds_read_b128 a[116:119], v5 offset:34816
v_mfma_f32_16x16x32_bf16 v[204:207], a[140:143], a[92:95], v[204:207]
buffer_load_dwordx4 a[56:59], v2, s[40:43], s35 offen offset:3072 sc1
v_mfma_f32_16x16x32_bf16 v[204:207], a[136:139], a[88:91], v[204:207]
v_mfma_f32_16x16x32_bf16 v[208:211], a[144:147], a[88:91], v[208:211]
ds_read_b64_tr_b16 a[226:227], v230 offset:2056
v_mfma_f32_16x16x32_bf16 v[208:211], a[148:151], a[92:95], v[208:211]
v_mfma_f32_16x16x32_bf16 v[184:187], a[148:151], a[84:87], v[184:187]
buffer_load_dwordx4 v[108:111], v1, s[4:7], s88 offen offset:0 sc1
v_mfma_f32_16x16x32_bf16 v[184:187], a[144:147], a[80:83], v[184:187]
v_mfma_f32_16x16x32_bf16 v[160:163], a[144:147], a[72:75], v[160:163]
v_mfma_f32_16x16x32_bf16 v[160:163], a[148:151], a[76:79], v[160:163]
buffer_load_dwordx4 a[60:63], v2, s[40:43], s33 offen offset:3072 sc1
s_add_u32 s35, s35, 8192
v_mfma_f32_16x16x32_bf16 v[136:139], a[148:151], a[68:71], v[136:139]
s_add_u32 s33, s33, 8192
ds_read_b64_tr_b16 a[188:189], v248 offset:0
v_mfma_f32_16x16x32_bf16 v[136:139], a[144:147], a[64:67], v[136:139]
s_waitcnt vmcnt(13) lgkmcnt(2)
v_mfma_f32_16x16x32_bf16 v[140:143], a[96:99], a[0:3], v[140:143]
ds_read_b128 a[128:131], v5 offset:29696
v_add_f32_dpp v48, v48, v48 row_ror:8 row_mask:0xf bank_mask:0xf
v_mfma_f32_16x16x32_bf16 v[140:143], a[100:103], a[4:7], v[140:143]
buffer_load_dwordx4 a[64:67], v2, s[40:43], s35 offen offset:0 sc1
v_mfma_f32_16x16x32_bf16 v[164:167], a[100:103], a[12:15], v[164:167]
ds_read_b128 a[132:135], v5 offset:35840
v_add_f32_dpp v49, v49, v49 row_ror:8 row_mask:0xf bank_mask:0xf
v_mfma_f32_16x16x32_bf16 v[164:167], a[96:99], a[8:11], v[164:167]
ds_read_b64_tr_b16 a[190:191], v248 offset:512
v_add_f32_dpp v50, v50, v50 row_ror:8 row_mask:0xf bank_mask:0xf
v_mfma_f32_16x16x32_bf16 v[188:191], a[96:99], a[16:19], v[188:191]
v_add_f32_dpp v51, v51, v51 row_ror:8 row_mask:0xf bank_mask:0xf
v_add_f32_dpp v52, v52, v52 row_ror:8 row_mask:0xf bank_mask:0xf
v_mfma_f32_16x16x32_bf16 v[188:191], a[100:103], a[20:23], v[188:191]
buffer_load_dwordx4 v[112:115], v1, s[4:7], s88 offen offset:1024 sc1
v_mfma_f32_16x16x32_bf16 v[212:215], a[100:103], a[28:31], v[212:215]
ds_read_b128 a[136:139], v5 offset:24576
v_add_f32_dpp v53, v53, v53 row_ror:8 row_mask:0xf bank_mask:0xf
v_mfma_f32_16x16x32_bf16 v[212:215], a[96:99], a[24:27], v[212:215]
v_add_f32_dpp v54, v54, v54 row_ror:8 row_mask:0xf bank_mask:0xf
v_add_f32_dpp v55, v55, v55 row_ror:8 row_mask:0xf bank_mask:0xf
v_mfma_f32_16x16x32_bf16 v[216:219], a[104:107], a[24:27], v[216:219]
ds_read_b128 a[140:143], v5 offset:30720
v_add_f32_dpp v48, v48, v48 row_ror:4 row_mask:0xf bank_mask:0xf
v_mfma_f32_16x16x32_bf16 v[216:219], a[108:111], a[28:31], v[216:219]
buffer_load_dwordx4 a[68:71], v2, s[40:43], s33 offen offset:0 sc1
v_mfma_f32_16x16x32_bf16 v[192:195], a[108:111], a[20:23], v[192:195]
ds_read_b128 a[144:147], v5 offset:25600
v_add_f32_dpp v49, v49, v49 row_ror:4 row_mask:0xf bank_mask:0xf
v_mfma_f32_16x16x32_bf16 v[192:195], a[104:107], a[16:19], v[192:195]
ds_read_b64_tr_b16 a[192:193], v248 offset:4096
v_add_f32_dpp v50, v50, v50 row_ror:4 row_mask:0xf bank_mask:0xf
v_mfma_f32_16x16x32_bf16 v[168:171], a[104:107], a[8:11], v[168:171]
v_add_f32_dpp v51, v51, v51 row_ror:4 row_mask:0xf bank_mask:0xf
v_add_f32_dpp v52, v52, v52 row_ror:4 row_mask:0xf bank_mask:0xf
v_mfma_f32_16x16x32_bf16 v[168:171], a[108:111], a[12:15], v[168:171]
buffer_load_dwordx4 a[72:75], v2, s[40:43], s35 offen offset:1024 sc1
v_mfma_f32_16x16x32_bf16 v[144:147], a[108:111], a[4:7], v[144:147]
ds_read_b128 a[148:151], v5 offset:31744
v_add_f32_dpp v53, v53, v53 row_ror:4 row_mask:0xf bank_mask:0xf
v_mfma_f32_16x16x32_bf16 v[144:147], a[104:107], a[0:3], v[144:147]
ds_read_b64_tr_b16 a[194:195], v248 offset:4608
v_add_f32_dpp v54, v54, v54 row_ror:4 row_mask:0xf bank_mask:0xf
v_mfma_f32_16x16x32_bf16 v[148:151], a[112:115], a[0:3], v[148:151]
v_add_f32_dpp v55, v55, v55 row_ror:4 row_mask:0xf bank_mask:0xf
v_add_f32_dpp v48, v48, v48 row_ror:2 row_mask:0xf bank_mask:0xf
v_mfma_f32_16x16x32_bf16 v[148:151], a[116:119], a[4:7], v[148:151]
buffer_load_dwordx4 v[116:119], v1, s[4:7], s88 offen offset:2048 sc1
v_mfma_f32_16x16x32_bf16 v[172:175], a[116:119], a[12:15], v[172:175]
v_add_f32_dpp v49, v49, v49 row_ror:2 row_mask:0xf bank_mask:0xf
v_add_f32_dpp v50, v50, v50 row_ror:2 row_mask:0xf bank_mask:0xf
v_mfma_f32_16x16x32_bf16 v[172:175], a[112:115], a[8:11], v[172:175]
v_add_f32_dpp v51, v51, v51 row_ror:2 row_mask:0xf bank_mask:0xf
v_add_f32_dpp v52, v52, v52 row_ror:2 row_mask:0xf bank_mask:0xf
v_mfma_f32_16x16x32_bf16 v[196:199], a[112:115], a[16:19], v[196:199]
ds_read_b64_tr_b16 a[196:197], v249 offset:32
v_add_f32_dpp v53, v53, v53 row_ror:2 row_mask:0xf bank_mask:0xf
v_mfma_f32_16x16x32_bf16 v[196:199], a[116:119], a[20:23], v[196:199]
buffer_load_dwordx4 a[76:79], v2, s[40:43], s33 offen offset:1024 sc1
v_mfma_f32_16x16x32_bf16 v[220:223], a[116:119], a[28:31], v[220:223]
v_add_f32_dpp v54, v54, v54 row_ror:2 row_mask:0xf bank_mask:0xf
v_add_f32_dpp v55, v55, v55 row_ror:2 row_mask:0xf bank_mask:0xf
v_mfma_f32_16x16x32_bf16 v[220:223], a[112:115], a[24:27], v[220:223]
v_add_f32_dpp v48, v48, v48 row_ror:1 row_mask:0xf bank_mask:0xf
s_waitcnt lgkmcnt(2)
v_mfma_f32_16x16x32_bf16 v[224:227], a[128:131], a[24:27], v[224:227]
ds_read_b128 a[96:99], v5 offset:38912
v_add_f32_dpp v49, v49, v49 row_ror:1 row_mask:0xf bank_mask:0xf
v_mfma_f32_16x16x32_bf16 v[224:227], a[132:135], a[28:31], v[224:227]
buffer_load_dwordx4 a[80:83], v2, s[40:43], s35 offen offset:2048 sc1
v_mfma_f32_16x16x32_bf16 v[200:203], a[132:135], a[20:23], v[200:203]
ds_read_b128 a[100:103], v5 offset:45056
v_add_f32_dpp v50, v50, v50 row_ror:1 row_mask:0xf bank_mask:0xf
v_mfma_f32_16x16x32_bf16 v[200:203], a[128:131], a[16:19], v[200:203]
ds_read_b64_tr_b16 a[198:199], v249 offset:544
v_add_f32_dpp v51, v51, v51 row_ror:1 row_mask:0xf bank_mask:0xf
v_mfma_f32_16x16x32_bf16 v[176:179], a[128:131], a[8:11], v[176:179]
v_add_f32_dpp v52, v52, v52 row_ror:1 row_mask:0xf bank_mask:0xf
v_add_f32_dpp v53, v53, v53 row_ror:1 row_mask:0xf bank_mask:0xf
v_mfma_f32_16x16x32_bf16 v[176:179], a[132:135], a[12:15], v[176:179]
buffer_load_dwordx4 v[120:123], v1, s[4:7], s88 offen offset:3072 sc1
s_add_u32 m0, s18, 0x1e000
v_mfma_f32_16x16x32_bf16 v[152:155], a[132:135], a[4:7], v[152:155]
s_add_u32 s44, s50, 0xe1e000
ds_read_b128 a[104:107], v5 offset:39936
v_mfma_f32_16x16x32_bf16 v[152:155], a[128:131], a[0:3], v[152:155]
ds_read_b64_tr_b16 a[200:201], v249 offset:4128
v_add_f32_dpp v54, v54, v54 row_ror:1 row_mask:0xf bank_mask:0xf
v_mfma_f32_16x16x32_bf16 v[132:135], a[136:139], a[0:3], v[132:135]
ds_read_b128 a[108:111], v5 offset:46080
v_add_f32_dpp v55, v55, v55 row_ror:1 row_mask:0xf bank_mask:0xf
v_mfma_f32_16x16x32_bf16 v[132:135], a[140:143], a[4:7], v[132:135]
buffer_load_dwordx4 a[84:87], v2, s[40:43], s33 offen offset:2048 sc1
v_mfma_f32_16x16x32_bf16 v[156:159], a[140:143], a[12:15], v[156:159]
ds_read_b128 a[112:115], v5 offset:40960
v_add_u32 v233, 159744, v233
v_mfma_f32_16x16x32_bf16 v[156:159], a[136:139], a[8:11], v[156:159]
s_lshl_b32 s36, s28, 6
s_lshl_b32 s37, s39, 6
v_mfma_f32_16x16x32_bf16 v[180:183], a[136:139], a[16:19], v[180:183]
ds_read_b64_tr_b16 a[202:203], v249 offset:4640
v_add_u32 v232, s36, v233
v_mfma_f32_16x16x32_bf16 v[180:183], a[140:143], a[20:23], v[180:183]
buffer_load_dwordx4 a[88:91], v2, s[40:43], s35 offen offset:3072 sc1
v_mfma_f32_16x16x32_bf16 v[204:207], a[140:143], a[28:31], v[204:207]
ds_read_b128 a[116:119], v5 offset:47104
v_add_u32 v235, s37, v233
v_mfma_f32_16x16x32_bf16 v[204:207], a[136:139], a[24:27], v[204:207]
v_mfma_f32_16x16x32_bf16 v[208:211], a[144:147], a[24:27], v[208:211]
v_mfma_f32_16x16x32_bf16 v[208:211], a[148:151], a[28:31], v[208:211]
buffer_load_dwordx4 v1, s[4:7], s44 offen offset:0 sc1 lds
v_mfma_f32_16x16x32_bf16 v[184:187], a[148:151], a[20:23], v[184:187]
ds_read_b64_tr_b16 a[204:205], v248 offset:8192
v_mfma_f32_16x16x32_bf16 v[184:187], a[144:147], a[16:19], v[184:187]
v_mfma_f32_16x16x32_bf16 v[160:163], a[144:147], a[8:11], v[160:163]
v_mfma_f32_16x16x32_bf16 v[160:163], a[148:151], a[12:15], v[160:163]
buffer_load_dwordx4 a[92:95], v2, s[40:43], s33 offen offset:3072 sc1
s_add_u32 s35, s35, 8192
v_mfma_f32_16x16x32_bf16 v[136:139], a[148:151], a[4:7], v[136:139]
s_add_u32 s33, s33, 8192
v_mfma_f32_16x16x32_bf16 v[136:139], a[144:147], a[0:3], v[136:139]
ds_read_b64_tr_b16 a[206:207], v248 offset:8704
s_waitcnt vmcnt(12) lgkmcnt(2)
v_mfma_f32_16x16x32_bf16 v[140:143], a[96:99], a[32:35], v[140:143]
ds_read_b128 a[128:131], v5 offset:41984
v_mfma_f32_16x16x32_bf16 v[140:143], a[100:103], a[36:39], v[140:143]
buffer_load_dwordx4 a[0:3], v2, s[40:43], s35 offen offset:0 sc1
v_mfma_f32_16x16x32_bf16 v[164:167], a[100:103], a[44:47], v[164:167]
ds_read_b128 a[132:135], v5 offset:48128
v_mfma_f32_16x16x32_bf16 v[164:167], a[96:99], a[40:43], v[164:167]
ds_write_b128 v232, v[48:51]
v_mfma_f32_16x16x32_bf16 v[188:191], a[96:99], a[48:51], v[188:191]
ds_write_b128 v235, v[52:55]
v_mfma_f32_16x16x32_bf16 v[188:191], a[100:103], a[52:55], v[188:191]
buffer_load_dwordx4 v1, s[4:7], s44 offen offset:1024 sc1 lds
v_mfma_f32_16x16x32_bf16 v[212:215], a[100:103], a[60:63], v[212:215]
ds_read_b128 a[136:139], v5 offset:36864
v_mfma_f32_16x16x32_bf16 v[212:215], a[96:99], a[56:59], v[212:215]
ds_read_b64_tr_b16 a[208:209], v248 offset:12288
v_mfma_f32_16x16x32_bf16 v[216:219], a[104:107], a[56:59], v[216:219]
ds_read_b128 a[140:143], v5 offset:43008
v_mfma_f32_16x16x32_bf16 v[216:219], a[108:111], a[60:63], v[216:219]
buffer_load_dwordx4 a[4:7], v2, s[40:43], s33 offen offset:0 sc1
v_mfma_f32_16x16x32_bf16 v[192:195], a[108:111], a[52:55], v[192:195]
ds_read_b128 a[144:147], v5 offset:37888
v_mfma_f32_16x16x32_bf16 v[192:195], a[104:107], a[48:51], v[192:195]
ds_read_b64_tr_b16 a[210:211], v248 offset:12800
v_mfma_f32_16x16x32_bf16 v[168:171], a[104:107], a[40:43], v[168:171]
v_mfma_f32_16x16x32_bf16 v[168:171], a[108:111], a[44:47], v[168:171]
buffer_load_dwordx4 a[8:11], v2, s[40:43], s35 offen offset:1024 sc1
v_mfma_f32_16x16x32_bf16 v[144:147], a[108:111], a[36:39], v[144:147]
ds_read_b128 a[148:151], v5 offset:44032
v_mfma_f32_16x16x32_bf16 v[144:147], a[104:107], a[32:35], v[144:147]
v_mfma_f32_16x16x32_bf16 v[148:151], a[112:115], a[32:35], v[148:151]
v_mfma_f32_16x16x32_bf16 v[148:151], a[116:119], a[36:39], v[148:151]
buffer_load_dwordx4 v1, s[4:7], s44 offen offset:2048 sc1 lds
s_add_u32 m0, s18, 0x21000
v_mfma_f32_16x16x32_bf16 v[172:175], a[116:119], a[44:47], v[172:175]
s_add_u32 s44, s50, 0xe21000
v_mfma_f32_16x16x32_bf16 v[172:175], a[112:115], a[40:43], v[172:175]
v_mfma_f32_16x16x32_bf16 v[196:199], a[112:115], a[48:51], v[196:199]
v_mfma_f32_16x16x32_bf16 v[196:199], a[116:119], a[52:55], v[196:199]
buffer_load_dwordx4 a[12:15], v2, s[40:43], s33 offen offset:1024 sc1
v_mfma_f32_16x16x32_bf16 v[220:223], a[116:119], a[60:63], v[220:223]
v_mfma_f32_16x16x32_bf16 v[220:223], a[112:115], a[56:59], v[220:223]
s_waitcnt lgkmcnt(0)
s_barrier
v_mfma_f32_16x16x32_bf16 v[224:227], a[128:131], a[56:59], v[224:227]
v_add_u32 v5, 98304, v1
v_mfma_f32_16x16x32_bf16 v[224:227], a[132:135], a[60:63], v[224:227]
buffer_load_dwordx4 a[16:19], v2, s[40:43], s35 offen offset:2048 sc1
v_mfma_f32_16x16x32_bf16 v[200:203], a[132:135], a[52:55], v[200:203]
ds_read_b128 a[96:99], v5 offset:2048
v_mfma_f32_16x16x32_bf16 v[200:203], a[128:131], a[48:51], v[200:203]
ds_read_b128 a[100:103], v5 offset:8192
v_mfma_f32_16x16x32_bf16 v[176:179], a[128:131], a[40:43], v[176:179]
ds_read_b128 v[48:51], v233 offset:0
v_mfma_f32_16x16x32_bf16 v[176:179], a[132:135], a[44:47], v[176:179]
buffer_load_dwordx4 v1, s[4:7], s44 offen offset:0 sc1 lds
v_mfma_f32_16x16x32_bf16 v[152:155], a[132:135], a[36:39], v[152:155]
ds_read_b128 a[104:107], v5 offset:3072
v_mfma_f32_16x16x32_bf16 v[152:155], a[128:131], a[32:35], v[152:155]
v_mfma_f32_16x16x32_bf16 v[132:135], a[136:139], a[32:35], v[132:135]
ds_read_b128 a[108:111], v5 offset:9216
v_mfma_f32_16x16x32_bf16 v[132:135], a[140:143], a[36:39], v[132:135]
buffer_load_dwordx4 a[20:23], v2, s[40:43], s33 offen offset:2048 sc1
v_mfma_f32_16x16x32_bf16 v[156:159], a[140:143], a[44:47], v[156:159]
ds_read_b128 a[112:115], v5 offset:4096
v_mfma_f32_16x16x32_bf16 v[156:159], a[136:139], a[40:43], v[156:159]
ds_read_b128 v[52:55], v233 offset:64
v_mfma_f32_16x16x32_bf16 v[180:183], a[136:139], a[48:51], v[180:183]
v_mfma_f32_16x16x32_bf16 v[180:183], a[140:143], a[52:55], v[180:183]
buffer_load_dwordx4 a[24:27], v2, s[40:43], s35 offen offset:3072 sc1
v_mfma_f32_16x16x32_bf16 v[204:207], a[140:143], a[60:63], v[204:207]
ds_read_b128 a[116:119], v5 offset:10240
v_mfma_f32_16x16x32_bf16 v[204:207], a[136:139], a[56:59], v[204:207]
v_mfma_f32_16x16x32_bf16 v[208:211], a[144:147], a[56:59], v[208:211]
v_mfma_f32_16x16x32_bf16 v[208:211], a[148:151], a[60:63], v[208:211]
buffer_load_dwordx4 v1, s[4:7], s44 offen offset:1024 sc1 lds
v_mfma_f32_16x16x32_bf16 v[184:187], a[148:151], a[52:55], v[184:187]
v_mfma_f32_16x16x32_bf16 v[184:187], a[144:147], a[48:51], v[184:187]
v_mfma_f32_16x16x32_bf16 v[160:163], a[144:147], a[40:43], v[160:163]
v_mfma_f32_16x16x32_bf16 v[160:163], a[148:151], a[44:47], v[160:163]
buffer_load_dwordx4 a[28:31], v2, s[40:43], s33 offen offset:3072 sc1
s_add_u32 s35, s35, 8192
v_mfma_f32_16x16x32_bf16 v[136:139], a[148:151], a[36:39], v[136:139]
s_add_u32 s33, s33, 8192
ds_read_b128 v[56:59], v233 offset:128
v_mfma_f32_16x16x32_bf16 v[136:139], a[144:147], a[32:35], v[136:139]
s_waitcnt vmcnt(12) lgkmcnt(1)
v_mfma_f32_16x16x32_bf16 v[140:143], a[96:99], a[64:67], v[140:143]
ds_read_b128 a[128:131], v5 offset:5120
v_mfma_f32_16x16x32_bf16 v[140:143], a[100:103], a[68:71], v[140:143]
buffer_load_dwordx4 a[32:35], v2, s[40:43], s35 offen offset:0 sc1
v_mfma_f32_16x16x32_bf16 v[164:167], a[100:103], a[76:79], v[164:167]
ds_read_b128 a[132:135], v5 offset:11264
v_mfma_f32_16x16x32_bf16 v[164:167], a[96:99], a[72:75], v[164:167]
v_mfma_f32_16x16x32_bf16 v[236:239], a[188:191], v[16:19], 0
v_mfma_f32_16x16x32_bf16 v[188:191], a[96:99], a[80:83], v[188:191]
v_mfma_f32_16x16x32_bf16 v[240:243], a[196:199], v[16:19], 0
v_mfma_f32_16x16x32_bf16 v[188:191], a[100:103], a[84:87], v[188:191]
buffer_load_dwordx4 v1, s[4:7], s44 offen offset:2048 sc1 lds
s_add_u32 m0, s18, 0x0
v_mfma_f32_16x16x32_bf16 v[212:215], a[100:103], a[92:95], v[212:215]
s_add_u32 s44, s50, 0xe24000
ds_read_b128 a[136:139], v5 offset:0
v_mfma_f32_16x16x32_bf16 v[212:215], a[96:99], a[88:91], v[212:215]
v_mfma_f32_16x16x32_bf16 v[216:219], a[104:107], a[88:91], v[216:219]
ds_read_b128 a[140:143], v5 offset:6144
v_mfma_f32_16x16x32_bf16 v[216:219], a[108:111], a[92:95], v[216:219]
buffer_load_dwordx4 a[36:39], v2, s[40:43], s33 offen offset:0 sc1
v_mfma_f32_16x16x32_bf16 v[192:195], a[108:111], a[84:87], v[192:195]
ds_read_b128 a[144:147], v5 offset:1024
v_mfma_f32_16x16x32_bf16 v[192:195], a[104:107], a[80:83], v[192:195]
v_mfma_f32_16x16x32_bf16 v[244:247], a[204:207], v[16:19], 0
v_mfma_f32_16x16x32_bf16 v[168:171], a[104:107], a[72:75], v[168:171]
v_mfma_f32_16x16x32_bf16 v[236:239], a[192:195], v[16:19], v[236:239]
v_mfma_f32_16x16x32_bf16 v[168:171], a[108:111], a[76:79], v[168:171]
buffer_load_dwordx4 a[40:43], v2, s[40:43], s35 offen offset:1024 sc1
v_mfma_f32_16x16x32_bf16 v[144:147], a[108:111], a[68:71], v[144:147]
ds_read_b128 a[148:151], v5 offset:7168
v_mfma_f32_16x16x32_bf16 v[144:147], a[104:107], a[64:67], v[144:147]
ds_read_b128 v[60:63], v233 offset:192
v_mfma_f32_16x16x32_bf16 v[148:151], a[112:115], a[64:67], v[148:151]
v_mfma_f32_16x16x32_bf16 v[240:243], a[200:203], v[16:19], v[240:243]
v_mfma_f32_16x16x32_bf16 v[148:151], a[116:119], a[68:71], v[148:151]
buffer_load_dwordx4 v1, s[4:7], s44 offen offset:0 sc1 lds
v_mfma_f32_16x16x32_bf16 v[172:175], a[116:119], a[76:79], v[172:175]
ds_read_b128 v[64:67], v233 offset:256
v_mfma_f32_16x16x32_bf16 v[172:175], a[112:115], a[72:75], v[172:175]
v_mfma_f32_16x16x32_bf16 v[196:199], a[112:115], a[80:83], v[196:199]
v_mfma_f32_16x16x32_bf16 v[244:247], a[208:211], v[16:19], v[244:247]
v_mfma_f32_16x16x32_bf16 v[196:199], a[116:119], a[84:87], v[196:199]
buffer_load_dwordx4 a[44:47], v2, s[40:43], s33 offen offset:1024 sc1
v_mfma_f32_16x16x32_bf16 v[220:223], a[116:119], a[92:95], v[220:223]
v_mfma_f32_16x16x32_bf16 v[220:223], a[112:115], a[88:91], v[220:223]
s_waitcnt lgkmcnt(2)
v_mfma_f32_16x16x32_bf16 v[224:227], a[128:131], a[88:91], v[224:227]
ds_read_b128 a[96:99], v5 offset:14336
v_mfma_f32_16x16x32_bf16 v[224:227], a[132:135], a[92:95], v[224:227]
buffer_load_dwordx4 a[48:51], v2, s[40:43], s35 offen offset:2048 sc1
v_mfma_f32_16x16x32_bf16 v[200:203], a[132:135], a[84:87], v[200:203]
ds_read_b128 a[100:103], v5 offset:20480
v_mfma_f32_16x16x32_bf16 v[200:203], a[128:131], a[80:83], v[200:203]
v_mfma_f32_16x16x32_bf16 v[176:179], a[128:131], a[72:75], v[176:179]
v_mfma_f32_16x16x32_bf16 v[176:179], a[132:135], a[76:79], v[176:179]
buffer_load_dwordx4 v1, s[4:7], s44 offen offset:1024 sc1 lds
v_mfma_f32_16x16x32_bf16 v[152:155], a[132:135], a[68:71], v[152:155]
ds_read_b128 a[104:107], v5 offset:15360
v_mfma_f32_16x16x32_bf16 v[152:155], a[128:131], a[64:67], v[152:155]
ds_read_b128 v[68:71], v233 offset:320
v_mfma_f32_16x16x32_bf16 v[132:135], a[136:139], a[64:67], v[132:135]
ds_read_b128 a[108:111], v5 offset:21504
v_mfma_f32_16x16x32_bf16 v[132:135], a[140:143], a[68:71], v[132:135]
buffer_load_dwordx4 a[52:55], v2, s[40:43], s33 offen offset:2048 sc1
v_mfma_f32_16x16x32_bf16 v[156:159], a[140:143], a[76:79], v[156:159]
ds_read_b128 a[112:115], v5 offset:16384
v_mfma_f32_16x16x32_bf16 v[156:159], a[136:139], a[72:75], v[156:159]
v_mfma_f32_16x16x32_bf16 v[180:183], a[136:139], a[80:83], v[180:183]
v_mfma_f32_16x16x32_bf16 v[180:183], a[140:143], a[84:87], v[180:183]
buffer_load_dwordx4 a[56:59], v2, s[40:43], s35 offen offset:3072 sc1
v_mfma_f32_16x16x32_bf16 v[204:207], a[140:143], a[92:95], v[204:207]
ds_read_b128 a[116:119], v5 offset:22528
v_mfma_f32_16x16x32_bf16 v[204:207], a[136:139], a[88:91], v[204:207]
v_mfma_f32_16x16x32_bf16 v[208:211], a[144:147], a[88:91], v[208:211]
v_mfma_f32_16x16x32_bf16 v[208:211], a[148:151], a[92:95], v[208:211]
buffer_load_dwordx4 v1, s[4:7], s44 offen offset:2048 sc1 lds
s_add_u32 m0, s18, 0x3000
v_mfma_f32_16x16x32_bf16 v[184:187], a[148:151], a[84:87], v[184:187]
s_add_u32 s44, s50, 0xe27000
v_mfma_f32_16x16x32_bf16 v[184:187], a[144:147], a[80:83], v[184:187]
v_mfma_f32_16x16x32_bf16 v[160:163], a[144:147], a[72:75], v[160:163]
v_mfma_f32_16x16x32_bf16 v[160:163], a[148:151], a[76:79], v[160:163]
buffer_load_dwordx4 a[60:63], v2, s[40:43], s33 offen offset:3072 sc1
s_add_u32 s35, s35, 8192
v_mfma_f32_16x16x32_bf16 v[136:139], a[148:151], a[68:71], v[136:139]
s_add_u32 s33, s33, 8192
v_mfma_f32_16x16x32_bf16 v[136:139], a[144:147], a[64:67], v[136:139]
s_waitcnt vmcnt(12) lgkmcnt(0)
v_mfma_f32_16x16x32_bf16 v[140:143], a[96:99], a[0:3], v[140:143]
ds_read_b128 a[128:131], v5 offset:17408
v_add_f32 v92, v92, v96
v_mfma_f32_16x16x32_bf16 v[140:143], a[100:103], a[4:7], v[140:143]
buffer_load_dwordx4 a[64:67], v2, s[40:43], s35 offen offset:0 sc1
v_mfma_f32_16x16x32_bf16 v[164:167], a[100:103], a[12:15], v[164:167]
ds_read_b128 a[132:135], v5 offset:23552
v_add_f32 v100, v100, v104
v_mfma_f32_16x16x32_bf16 v[164:167], a[96:99], a[8:11], v[164:167]
v_add_f32 v108, v108, v112
v_add_f32 v116, v116, v120
v_mfma_f32_16x16x32_bf16 v[188:191], a[96:99], a[16:19], v[188:191]
v_add_f32 v93, v93, v97
v_add_f32 v101, v101, v105
v_mfma_f32_16x16x32_bf16 v[188:191], a[100:103], a[20:23], v[188:191]
buffer_load_dwordx4 v1, s[4:7], s44 offen offset:0 sc1 lds
v_mfma_f32_16x16x32_bf16 v[212:215], a[100:103], a[28:31], v[212:215]
ds_read_b128 a[136:139], v5 offset:12288
v_add_f32 v109, v109, v113
v_mfma_f32_16x16x32_bf16 v[212:215], a[96:99], a[24:27], v[212:215]
v_add_f32 v117, v117, v121
v_add_f32 v94, v94, v98
v_mfma_f32_16x16x32_bf16 v[216:219], a[104:107], a[24:27], v[216:219]
ds_read_b128 a[140:143], v5 offset:18432
v_add_f32 v102, v102, v106
v_mfma_f32_16x16x32_bf16 v[216:219], a[108:111], a[28:31], v[216:219]
buffer_load_dwordx4 a[68:71], v2, s[40:43], s33 offen offset:0 sc1
v_mfma_f32_16x16x32_bf16 v[192:195], a[108:111], a[20:23], v[192:195]
ds_read_b128 a[144:147], v5 offset:13312
v_add_f32 v110, v110, v114
v_mfma_f32_16x16x32_bf16 v[192:195], a[104:107], a[16:19], v[192:195]
v_add_f32 v118, v118, v122
v_add_f32 v95, v95, v99
v_mfma_f32_16x16x32_bf16 v[168:171], a[104:107], a[8:11], v[168:171]
v_add_f32 v103, v103, v107
v_mfma_f32_16x16x32_bf16 v[168:171], a[108:111], a[12:15], v[168:171]
buffer_load_dwordx4 a[72:75], v2, s[40:43], s35 offen offset:1024 sc1
v_mfma_f32_16x16x32_bf16 v[144:147], a[108:111], a[4:7], v[144:147]
ds_read_b128 a[148:151], v5 offset:19456
v_add_f32 v111, v111, v115
v_mfma_f32_16x16x32_bf16 v[144:147], a[104:107], a[0:3], v[144:147]
v_add_f32 v119, v119, v123
v_add_f32_dpp v92, v92, v92 row_ror:8 row_mask:0xf bank_mask:0xf
v_mfma_f32_16x16x32_bf16 v[148:151], a[112:115], a[0:3], v[148:151]
v_add_f32_dpp v100, v100, v100 row_ror:8 row_mask:0xf bank_mask:0xf
v_mfma_f32_16x16x32_bf16 v[148:151], a[116:119], a[4:7], v[148:151]
buffer_load_dwordx4 v1, s[4:7], s44 offen offset:1024 sc1 lds
v_mfma_f32_16x16x32_bf16 v[172:175], a[116:119], a[12:15], v[172:175]
v_add_f32_dpp v108, v108, v108 row_ror:8 row_mask:0xf bank_mask:0xf
v_add_f32_dpp v116, v116, v116 row_ror:8 row_mask:0xf bank_mask:0xf
v_mfma_f32_16x16x32_bf16 v[172:175], a[112:115], a[8:11], v[172:175]
v_add_f32_dpp v93, v93, v93 row_ror:8 row_mask:0xf bank_mask:0xf
v_mfma_f32_16x16x32_bf16 v[196:199], a[112:115], a[16:19], v[196:199]
v_add_f32_dpp v101, v101, v101 row_ror:8 row_mask:0xf bank_mask:0xf
v_mfma_f32_16x16x32_bf16 v[196:199], a[116:119], a[20:23], v[196:199]
buffer_load_dwordx4 a[76:79], v2, s[40:43], s33 offen offset:1024 sc1
v_mfma_f32_16x16x32_bf16 v[220:223], a[116:119], a[28:31], v[220:223]
v_add_f32_dpp v109, v109, v109 row_ror:8 row_mask:0xf bank_mask:0xf
v_add_f32_dpp v117, v117, v117 row_ror:8 row_mask:0xf bank_mask:0xf
v_mfma_f32_16x16x32_bf16 v[220:223], a[112:115], a[24:27], v[220:223]
s_waitcnt vmcnt(16) lgkmcnt(0)
s_barrier
v_mfma_f32_16x16x32_bf16 v[224:227], a[128:131], a[24:27], v[224:227]
ds_read_b128 a[96:99], v5 offset:26624
v_add_f32_dpp v92, v94, v94 row_ror:8 row_mask:0xf bank_mask:0xc
v_mfma_f32_16x16x32_bf16 v[224:227], a[132:135], a[28:31], v[224:227]
buffer_load_dwordx4 a[80:83], v2, s[40:43], s35 offen offset:2048 sc1
v_mfma_f32_16x16x32_bf16 v[200:203], a[132:135], a[20:23], v[200:203]
ds_read_b128 a[100:103], v5 offset:32768
v_add_f32_dpp v100, v102, v102 row_ror:8 row_mask:0xf bank_mask:0xc
v_mfma_f32_16x16x32_bf16 v[200:203], a[128:131], a[16:19], v[200:203]
v_add_f32_dpp v108, v110, v110 row_ror:8 row_mask:0xf bank_mask:0xc
v_add_f32_dpp v116, v118, v118 row_ror:8 row_mask:0xf bank_mask:0xc
v_mfma_f32_16x16x32_bf16 v[176:179], a[128:131], a[8:11], v[176:179]
v_add_f32_dpp v93, v95, v95 row_ror:8 row_mask:0xf bank_mask:0xc
v_add_f32_dpp v101, v103, v103 row_ror:8 row_mask:0xf bank_mask:0xc
v_mfma_f32_16x16x32_bf16 v[176:179], a[132:135], a[12:15], v[176:179]
buffer_load_dwordx4 v1, s[4:7], s44 offen offset:2048 sc1 lds
s_add_u32 m0, s18, 0x6000
v_mfma_f32_16x16x32_bf16 v[152:155], a[132:135], a[4:7], v[152:155]
s_add_u32 s44, s50, 0xe2a000
ds_read_b128 a[104:107], v5 offset:27648
v_mfma_f32_16x16x32_bf16 v[152:155], a[128:131], a[0:3], v[152:155]
v_add_f32_dpp v109, v111, v111 row_ror:8 row_mask:0xf bank_mask:0xc
v_add_f32_dpp v117, v119, v119 row_ror:8 row_mask:0xf bank_mask:0xc
v_mfma_f32_16x16x32_bf16 v[132:135], a[136:139], a[0:3], v[132:135]
ds_read_b128 a[108:111], v5 offset:33792
v_mfma_f32_16x16x32_bf16 v[132:135], a[140:143], a[4:7], v[132:135]
buffer_load_dwordx4 a[84:87], v2, s[40:43], s33 offen offset:2048 sc1
v_mfma_f32_16x16x32_bf16 v[156:159], a[140:143], a[12:15], v[156:159]
ds_read_b128 a[112:115], v5 offset:28672
v_mfma_f32_16x16x32_bf16 v[156:159], a[136:139], a[8:11], v[156:159]
v_permlane32_swap_b32 v92, v93
v_mfma_f32_16x16x32_bf16 v[180:183], a[136:139], a[16:19], v[180:183]
v_permlane32_swap_b32 v100, v101
v_mfma_f32_16x16x32_bf16 v[180:183], a[140:143], a[20:23], v[180:183]
buffer_load_dwordx4 a[88:91], v2, s[40:43], s35 offen offset:3072 sc1
v_mfma_f32_16x16x32_bf16 v[204:207], a[140:143], a[28:31], v[204:207]
ds_read_b128 a[116:119], v5 offset:34816
v_mfma_f32_16x16x32_bf16 v[204:207], a[136:139], a[24:27], v[204:207]
v_permlane32_swap_b32 v108, v109
v_mfma_f32_16x16x32_bf16 v[208:211], a[144:147], a[24:27], v[208:211]
v_permlane32_swap_b32 v116, v117
v_mfma_f32_16x16x32_bf16 v[208:211], a[148:151], a[28:31], v[208:211]
buffer_load_dwordx4 v1, s[4:7], s44 offen offset:0 sc1 lds
v_mfma_f32_16x16x32_bf16 v[184:187], a[148:151], a[20:23], v[184:187]
v_add_f32 v92, v92, v93
v_add_f32 v100, v100, v101
v_mfma_f32_16x16x32_bf16 v[184:187], a[144:147], a[16:19], v[184:187]
v_add_f32 v108, v108, v109
v_add_f32 v116, v116, v117
v_mfma_f32_16x16x32_bf16 v[160:163], a[144:147], a[8:11], v[160:163]
v_mov_b32 v94, v92
v_mov_b32 v102, v100
v_mfma_f32_16x16x32_bf16 v[160:163], a[148:151], a[12:15], v[160:163]
buffer_load_dwordx4 a[92:95], v2, s[40:43], s33 offen offset:3072 sc1
s_add_u32 s35, s35, 8192
v_mfma_f32_16x16x32_bf16 v[136:139], a[148:151], a[4:7], v[136:139]
s_add_u32 s33, s33, 8192
v_mov_b32 v110, v108
v_mfma_f32_16x16x32_bf16 v[136:139], a[144:147], a[0:3], v[136:139]
v_mov_b32 v118, v116
s_waitcnt vmcnt(12) lgkmcnt(0)
v_mfma_f32_16x16x32_bf16 v[140:143], a[96:99], a[32:35], v[140:143]
ds_read_b128 a[128:131], v5 offset:29696
v_mfma_f32_16x16x32_bf16 v[140:143], a[100:103], a[36:39], v[140:143]
buffer_load_dwordx4 a[0:3], v2, s[40:43], s35 offen offset:0 sc1
v_mfma_f32_16x16x32_bf16 v[164:167], a[100:103], a[44:47], v[164:167]
ds_read_b128 a[132:135], v5 offset:35840
v_mfma_f32_16x16x32_bf16 v[164:167], a[96:99], a[40:43], v[164:167]
v_permlane16_swap_b32 v92, v94
v_mfma_f32_16x16x32_bf16 v[188:191], a[96:99], a[48:51], v[188:191]
v_permlane16_swap_b32 v100, v102
v_mfma_f32_16x16x32_bf16 v[188:191], a[100:103], a[52:55], v[188:191]
buffer_load_dwordx4 v1, s[4:7], s44 offen offset:1024 sc1 lds
v_mfma_f32_16x16x32_bf16 v[212:215], a[100:103], a[60:63], v[212:215]
ds_read_b128 a[136:139], v5 offset:24576
v_mfma_f32_16x16x32_bf16 v[212:215], a[96:99], a[56:59], v[212:215]
v_permlane16_swap_b32 v108, v110
v_mfma_f32_16x16x32_bf16 v[216:219], a[104:107], a[56:59], v[216:219]
ds_read_b128 a[140:143], v5 offset:30720
v_mfma_f32_16x16x32_bf16 v[216:219], a[108:111], a[60:63], v[216:219]
buffer_load_dwordx4 a[4:7], v2, s[40:43], s33 offen offset:0 sc1
v_mfma_f32_16x16x32_bf16 v[192:195], a[108:111], a[52:55], v[192:195]
ds_read_b128 a[144:147], v5 offset:25600
v_mfma_f32_16x16x32_bf16 v[192:195], a[104:107], a[48:51], v[192:195]
v_permlane16_swap_b32 v116, v118
v_mfma_f32_16x16x32_bf16 v[168:171], a[104:107], a[40:43], v[168:171]
v_add_f32 v92, v92, v94
v_add_f32 v100, v100, v102
L_stub1:
s_cbranch_execz L_wret0
v_mfma_f32_16x16x32_bf16 v[168:171], a[108:111], a[44:47], v[168:171]
buffer_load_dwordx4 a[8:11], v2, s[40:43], s35 offen offset:1024 sc1
v_mfma_f32_16x16x32_bf16 v[144:147], a[108:111], a[36:39], v[144:147]
ds_read_b128 a[148:151], v5 offset:31744
v_add_f32 v108, v108, v110
v_mfma_f32_16x16x32_bf16 v[144:147], a[104:107], a[32:35], v[144:147]
v_add_f32 v116, v116, v118
v_mov_b32 v94, v92
v_mfma_f32_16x16x32_bf16 v[148:151], a[112:115], a[32:35], v[148:151]
v_mov_b32 v102, v100
v_mov_b32 v110, v108
v_mfma_f32_16x16x32_bf16 v[148:151], a[116:119], a[36:39], v[148:151]
buffer_load_dwordx4 v1, s[4:7], s44 offen offset:2048 sc1 lds
s_add_u32 m0, s18, 0x9000
v_mfma_f32_16x16x32_bf16 v[172:175], a[116:119], a[44:47], v[172:175]
s_add_u32 s44, s50, 0xe2d000
v_mov_b32 v118, v116
v_mfma_f32_16x16x32_bf16 v[172:175], a[112:115], a[40:43], v[172:175]
v_permlane32_swap_b32 v92, v94
v_mfma_f32_16x16x32_bf16 v[196:199], a[112:115], a[48:51], v[196:199]
v_permlane32_swap_b32 v100, v102
v_mfma_f32_16x16x32_bf16 v[196:199], a[116:119], a[52:55], v[196:199]
buffer_load_dwordx4 a[12:15], v2, s[40:43], s33 offen offset:1024 sc1
v_mfma_f32_16x16x32_bf16 v[220:223], a[116:119], a[60:63], v[220:223]
v_permlane32_swap_b32 v108, v110
v_mfma_f32_16x16x32_bf16 v[220:223], a[112:115], a[56:59], v[220:223]
s_waitcnt lgkmcnt(0)
v_mfma_f32_16x16x32_bf16 v[224:227], a[128:131], a[56:59], v[224:227]
ds_read_b128 a[96:99], v5 offset:38912
v_mfma_f32_16x16x32_bf16 v[224:227], a[132:135], a[60:63], v[224:227]
buffer_load_dwordx4 a[16:19], v2, s[40:43], s35 offen offset:2048 sc1
v_mfma_f32_16x16x32_bf16 v[200:203], a[132:135], a[52:55], v[200:203]
ds_read_b128 a[100:103], v5 offset:45056
v_mfma_f32_16x16x32_bf16 v[200:203], a[128:131], a[48:51], v[200:203]
v_permlane32_swap_b32 v116, v118
v_mfma_f32_16x16x32_bf16 v[176:179], a[128:131], a[40:43], v[176:179]
v_mul_f32 v82, 0xba800000, v92
v_mul_f32 v84, 0xba800000, v100
v_mfma_f32_16x16x32_bf16 v[176:179], a[132:135], a[44:47], v[176:179]
buffer_load_dwordx4 v1, s[4:7], s44 offen offset:0 sc1 lds
v_mfma_f32_16x16x32_bf16 v[152:155], a[132:135], a[36:39], v[152:155]
ds_read_b128 a[104:107], v5 offset:39936
v_mul_f32 v86, 0xba800000, v108
v_mfma_f32_16x16x32_bf16 v[152:155], a[128:131], a[32:35], v[152:155]
v_mul_f32 v88, 0xba800000, v116
v_mul_f32 v94, 0x3a800000, v94
v_mfma_f32_16x16x32_bf16 v[132:135], a[136:139], a[32:35], v[132:135]
ds_read_b128 a[108:111], v5 offset:46080
v_mul_f32 v102, 0x3a800000, v102
v_mfma_f32_16x16x32_bf16 v[132:135], a[140:143], a[36:39], v[132:135]
buffer_load_dwordx4 a[20:23], v2, s[40:43], s33 offen offset:2048 sc1
v_mfma_f32_16x16x32_bf16 v[156:159], a[140:143], a[44:47], v[156:159]
ds_read_b128 a[112:115], v5 offset:40960
v_mul_f32 v110, 0x3a800000, v110
v_mfma_f32_16x16x32_bf16 v[156:159], a[136:139], a[40:43], v[156:159]
v_mul_f32 v118, 0x3a800000, v118
v_fma_f32 v94, -v82, v82, v94
v_mfma_f32_16x16x32_bf16 v[180:183], a[136:139], a[48:51], v[180:183]
v_fma_f32 v102, -v84, v84, v102
v_fma_f32 v110, -v86, v86, v110
v_mfma_f32_16x16x32_bf16 v[180:183], a[140:143], a[52:55], v[180:183]
buffer_load_dwordx4 a[24:27], v2, s[40:43], s35 offen offset:3072 sc1
v_mfma_f32_16x16x32_bf16 v[204:207], a[140:143], a[60:63], v[204:207]
ds_read_b128 a[116:119], v5 offset:47104
v_fma_f32 v118, -v88, v88, v118
v_mfma_f32_16x16x32_bf16 v[204:207], a[136:139], a[56:59], v[204:207]
v_max_f32 v94, 0, v94
v_max_f32 v102, 0, v102
v_mfma_f32_16x16x32_bf16 v[208:211], a[144:147], a[56:59], v[208:211]
v_max_f32 v110, 0, v110
v_max_f32 v118, 0, v118
v_mfma_f32_16x16x32_bf16 v[208:211], a[148:151], a[60:63], v[208:211]
buffer_load_dwordx4 v1, s[4:7], s44 offen offset:1024 sc1 lds
v_mfma_f32_16x16x32_bf16 v[184:187], a[148:151], a[52:55], v[184:187]
v_add_f32 v94, 0x3727c5ac, v94
v_add_f32 v102, 0x3727c5ac, v102
v_mfma_f32_16x16x32_bf16 v[184:187], a[144:147], a[48:51], v[184:187]
v_add_f32 v110, 0x3727c5ac, v110
v_add_f32 v118, 0x3727c5ac, v118
v_mfma_f32_16x16x32_bf16 v[160:163], a[144:147], a[40:43], v[160:163]
v_rsq_f32 v83, v94
v_mfma_f32_16x16x32_bf16 v[160:163], a[148:151], a[44:47], v[160:163]
buffer_load_dwordx4 a[28:31], v2, s[40:43], s33 offen offset:3072 sc1
s_add_u32 s35, s35, 8192
v_mfma_f32_16x16x32_bf16 v[136:139], a[148:151], a[36:39], v[136:139]
s_add_u32 s33, s33, 8192
v_mfma_f32_16x16x32_bf16 v[136:139], a[144:147], a[32:35], v[136:139]
s_waitcnt vmcnt(12) lgkmcnt(0)
v_mfma_f32_16x16x32_bf16 v[140:143], a[96:99], a[64:67], v[140:143]
ds_read_b128 a[128:131], v5 offset:41984
v_mfma_f32_16x16x32_bf16 v[140:143], a[100:103], a[68:71], v[140:143]
buffer_load_dwordx4 a[32:35], v2, s[40:43], s35 offen offset:0 sc1
v_mfma_f32_16x16x32_bf16 v[164:167], a[100:103], a[76:79], v[164:167]
ds_read_b128 a[132:135], v5 offset:48128
v_mfma_f32_16x16x32_bf16 v[164:167], a[96:99], a[72:75], v[164:167]
v_rsq_f32 v85, v102
v_mfma_f32_16x16x32_bf16 v[188:191], a[96:99], a[80:83], v[188:191]
v_rsq_f32 v87, v110
v_mfma_f32_16x16x32_bf16 v[188:191], a[100:103], a[84:87], v[188:191]
buffer_load_dwordx4 v1, s[4:7], s44 offen offset:2048 sc1 lds
s_add_u32 m0, s19, 49152
v_mfma_f32_16x16x32_bf16 v[212:215], a[100:103], a[92:95], v[212:215]
s_add_u32 s44, s85, 0xa04000
ds_read_b128 a[136:139], v5 offset:36864
v_mfma_f32_16x16x32_bf16 v[212:215], a[96:99], a[88:91], v[212:215]
v_rsq_f32 v89, v118
v_mfma_f32_16x16x32_bf16 v[216:219], a[104:107], a[88:91], v[216:219]
ds_read_b128 a[140:143], v5 offset:43008
v_mfma_f32_16x16x32_bf16 v[216:219], a[108:111], a[92:95], v[216:219]
buffer_load_dwordx4 a[36:39], v2, s[40:43], s33 offen offset:0 sc1
v_mfma_f32_16x16x32_bf16 v[192:195], a[108:111], a[84:87], v[192:195]
ds_read_b128 a[144:147], v5 offset:37888
v_fmac_f32 v140, v56, v82
v_mfma_f32_16x16x32_bf16 v[192:195], a[104:107], a[80:83], v[192:195]
v_mfma_f32_16x16x32_bf16 v[168:171], a[104:107], a[72:75], v[168:171]
v_fmac_f32 v164, v56, v84
v_mfma_f32_16x16x32_bf16 v[168:171], a[108:111], a[76:79], v[168:171]
buffer_load_dwordx4 a[40:43], v2, s[40:43], s35 offen offset:1024 sc1
v_mfma_f32_16x16x32_bf16 v[144:147], a[108:111], a[68:71], v[144:147]
ds_read_b128 a[148:151], v5 offset:44032
v_fmac_f32 v188, v56, v86
v_mfma_f32_16x16x32_bf16 v[144:147], a[104:107], a[64:67], v[144:147]
v_mfma_f32_16x16x32_bf16 v[148:151], a[112:115], a[64:67], v[148:151]
v_fmac_f32 v212, v56, v88
v_mfma_f32_16x16x32_bf16 v[148:151], a[116:119], a[68:71], v[148:151]
buffer_load_dwordx4 v1, s[4:7], s44 offen offset:0 sc1 lds
v_mfma_f32_16x16x32_bf16 v[172:175], a[116:119], a[76:79], v[172:175]
v_fmac_f32 v216, v60, v88
v_mfma_f32_16x16x32_bf16 v[172:175], a[112:115], a[72:75], v[172:175]
v_mfma_f32_16x16x32_bf16 v[196:199], a[112:115], a[80:83], v[196:199]
v_fmac_f32 v192, v60, v86
v_mfma_f32_16x16x32_bf16 v[196:199], a[116:119], a[84:87], v[196:199]
buffer_load_dwordx4 a[44:47], v2, s[40:43], s33 offen offset:1024 sc1
v_mfma_f32_16x16x32_bf16 v[220:223], a[116:119], a[92:95], v[220:223]
v_fmac_f32 v168, v60, v84
v_fmac_f32 v141, v57, v82
v_mfma_f32_16x16x32_bf16 v[220:223], a[112:115], a[88:91], v[220:223]
s_waitcnt lgkmcnt(0)
s_barrier
v_mfma_f32_16x16x32_bf16 v[224:227], a[128:131], a[88:91], v[224:227]
v_add_u32 v5, 0, v1
v_fmac_f32 v144, v60, v82
v_mfma_f32_16x16x32_bf16 v[224:227], a[132:135], a[92:95], v[224:227]
buffer_load_dwordx4 a[48:51], v2, s[40:43], s35 offen offset:2048 sc1
v_mfma_f32_16x16x32_bf16 v[200:203], a[132:135], a[84:87], v[200:203]
ds_read_b128 a[96:99], v5 offset:2048
v_fmac_f32 v148, v64, v82
v_mfma_f32_16x16x32_bf16 v[200:203], a[128:131], a[80:83], v[200:203]
ds_read_b128 a[100:103], v5 offset:8192
v_fmac_f32 v165, v57, v84
v_mfma_f32_16x16x32_bf16 v[176:179], a[128:131], a[72:75], v[176:179]
v_fmac_f32 v172, v64, v84
v_fmac_f32 v189, v57, v86
v_mfma_f32_16x16x32_bf16 v[176:179], a[132:135], a[76:79], v[176:179]
buffer_load_dwordx4 v1, s[4:7], s44 offen offset:1024 sc1 lds
v_mfma_f32_16x16x32_bf16 v[152:155], a[132:135], a[68:71], v[152:155]
ds_read_b128 a[104:107], v5 offset:3072
v_fmac_f32 v196, v64, v86
v_mfma_f32_16x16x32_bf16 v[152:155], a[128:131], a[64:67], v[152:155]
v_fmac_f32 v213, v57, v88
v_fmac_f32 v217, v61, v88
v_mfma_f32_16x16x32_bf16 v[132:135], a[136:139], a[64:67], v[132:135]
ds_read_b128 a[108:111], v5 offset:9216
v_fmac_f32 v220, v64, v88
v_mfma_f32_16x16x32_bf16 v[132:135], a[140:143], a[68:71], v[132:135]
buffer_load_dwordx4 a[52:55], v2, s[40:43], s33 offen offset:2048 sc1
v_mfma_f32_16x16x32_bf16 v[156:159], a[140:143], a[76:79], v[156:159]
ds_read_b128 a[112:115], v5 offset:4096
v_fmac_f32 v224, v68, v88
v_mfma_f32_16x16x32_bf16 v[156:159], a[136:139], a[72:75], v[156:159]
v_fmac_f32 v193, v61, v86
v_fmac_f32 v169, v61, v84
v_mfma_f32_16x16x32_bf16 v[180:183], a[136:139], a[80:83], v[180:183]
v_fmac_f32 v200, v68, v86
v_fmac_f32 v145, v61, v82
v_mfma_f32_16x16x32_bf16 v[180:183], a[140:143], a[84:87], v[180:183]
buffer_load_dwordx4 a[56:59], v2, s[40:43], s35 offen offset:3072 sc1
v_mfma_f32_16x16x32_bf16 v[204:207], a[140:143], a[92:95], v[204:207]
ds_read_b128 a[116:119], v5 offset:10240
v_fmac_f32 v176, v68, v84
v_mfma_f32_16x16x32_bf16 v[204:207], a[136:139], a[88:91], v[204:207]
v_fmac_f32 v149, v65, v82
v_mfma_f32_16x16x32_bf16 v[208:211], a[144:147], a[88:91], v[208:211]
v_fmac_f32 v152, v68, v82
v_fmac_f32 v173, v65, v84
v_mfma_f32_16x16x32_bf16 v[208:211], a[148:151], a[92:95], v[208:211]
buffer_load_dwordx4 v1, s[4:7], s44 offen offset:2048 sc1 lds
v_mfma_f32_16x16x32_bf16 v[184:187], a[148:151], a[84:87], v[184:187]
v_fmac_f32 v132, v48, v82
v_fmac_f32 v197, v65, v86
v_mfma_f32_16x16x32_bf16 v[184:187], a[144:147], a[80:83], v[184:187]
v_mfma_f32_16x16x32_bf16 v[160:163], a[144:147], a[72:75], v[160:163]
v_fmac_f32 v156, v48, v84
v_fmac_f32 v221, v65, v88
v_mfma_f32_16x16x32_bf16 v[160:163], a[148:151], a[76:79], v[160:163]
buffer_load_dwordx4 a[60:63], v2, s[40:43], s33 offen offset:3072 sc1
s_add_u32 s35, s35, 8192
v_mfma_f32_16x16x32_bf16 v[136:139], a[148:151], a[68:71], v[136:139]
s_add_u32 s33, s33, 8192
v_fmac_f32 v180, v48, v86
v_mfma_f32_16x16x32_bf16 v[136:139], a[144:147], a[64:67], v[136:139]
v_fmac_f32 v225, v69, v88
s_waitcnt vmcnt(12) lgkmcnt(0)
v_mfma_f32_16x16x32_bf16 v[140:143], a[96:99], a[0:3], v[140:143]
ds_read_b128 a[128:131], v5 offset:5120
v_fmac_f32 v204, v48, v88
v_mfma_f32_16x16x32_bf16 v[140:143], a[100:103], a[4:7], v[140:143]
buffer_load_dwordx4 a[64:67], v2, s[40:43], s35 offen offset:0 sc1
s_lshl_b32 s37, s28, 10
v_mfma_f32_16x16x32_bf16 v[164:167], a[100:103], a[12:15], v[164:167]
ds_read_b128 a[132:135], v5 offset:11264
v_fmac_f32 v208, v52, v88
v_mfma_f32_16x16x32_bf16 v[164:167], a[96:99], a[8:11], v[164:167]
v_fmac_f32 v201, v69, v86
v_fmac_f32 v177, v69, v84
v_mfma_f32_16x16x32_bf16 v[188:191], a[96:99], a[16:19], v[188:191]
v_fmac_f32 v184, v52, v86
v_fmac_f32 v153, v69, v82
v_mfma_f32_16x16x32_bf16 v[188:191], a[100:103], a[20:23], v[188:191]
buffer_load_dwordx4 a[68:71], v2, s[40:43], s33 offen offset:0 sc1
s_lshl_b32 s72, s30, 12
v_mfma_f32_16x16x32_bf16 v[212:215], a[100:103], a[28:31], v[212:215]
ds_read_b128 a[136:139], v5 offset:0
v_fmac_f32 v160, v52, v84
v_mfma_f32_16x16x32_bf16 v[212:215], a[96:99], a[24:27], v[212:215]
v_fmac_f32 v133, v49, v82
s_add_u32 s72, s72, 0x1e00000
v_mfma_f32_16x16x32_bf16 v[216:219], a[104:107], a[24:27], v[216:219]
ds_read_b128 a[140:143], v5 offset:6144
v_fmac_f32 v136, v52, v82
v_mfma_f32_16x16x32_bf16 v[216:219], a[108:111], a[28:31], v[216:219]
buffer_load_dwordx4 a[72:75], v2, s[40:43], s35 offen offset:1024 sc1
s_add_u32 s63, s83, 0x900000
v_mfma_f32_16x16x32_bf16 v[192:195], a[108:111], a[20:23], v[192:195]
ds_read_b128 a[144:147], v5 offset:1024
v_fmac_f32 v157, v49, v84
v_mfma_f32_16x16x32_bf16 v[192:195], a[104:107], a[16:19], v[192:195]
v_fmac_f32 v181, v49, v86
v_fmac_f32 v142, v58, v82
v_mfma_f32_16x16x32_bf16 v[168:171], a[104:107], a[8:11], v[168:171]
v_fmac_f32 v205, v49, v88
v_fmac_f32 v166, v58, v84
v_mfma_f32_16x16x32_bf16 v[168:171], a[108:111], a[12:15], v[168:171]
buffer_load_dwordx4 a[76:79], v2, s[40:43], s33 offen offset:1024 sc1
s_sub_u32 s55, s63, 0x10000
v_mfma_f32_16x16x32_bf16 v[144:147], a[108:111], a[4:7], v[144:147]
ds_read_b128 a[148:151], v5 offset:7168
v_fmac_f32 v209, v53, v88
v_mfma_f32_16x16x32_bf16 v[144:147], a[104:107], a[0:3], v[144:147]
v_fmac_f32 v190, v58, v86
v_add_u32 v233, s37, v1
v_mfma_f32_16x16x32_bf16 v[148:151], a[112:115], a[0:3], v[148:151]
v_fmac_f32 v185, v53, v86
v_fmac_f32 v214, v58, v88
v_mfma_f32_16x16x32_bf16 v[148:151], a[116:119], a[4:7], v[148:151]
buffer_load_dwordx4 a[80:83], v2, s[40:43], s35 offen offset:2048 sc1
v_mfma_f32_16x16x32_bf16 v[172:175], a[116:119], a[12:15], v[172:175]
v_fmac_f32 v161, v53, v84
v_fmac_f32 v218, v62, v88
v_mfma_f32_16x16x32_bf16 v[172:175], a[112:115], a[8:11], v[172:175]
v_add_u32 v232, s19, v7
v_add_u32 v248, s19, v8
v_mfma_f32_16x16x32_bf16 v[196:199], a[112:115], a[16:19], v[196:199]
v_fmac_f32 v137, v53, v82
v_fmac_f32 v194, v62, v86
v_mfma_f32_16x16x32_bf16 v[196:199], a[116:119], a[20:23], v[196:199]
buffer_load_dwordx4 a[84:87], v2, s[40:43], s33 offen offset:2048 sc1
v_mfma_f32_16x16x32_bf16 v[220:223], a[116:119], a[28:31], v[220:223]
v_fmac_f32 v170, v62, v84
v_fmac_f32 v143, v59, v82
v_mfma_f32_16x16x32_bf16 v[220:223], a[112:115], a[24:27], v[220:223]
s_waitcnt lgkmcnt(0)
v_mfma_f32_16x16x32_bf16 v[224:227], a[128:131], a[24:27], v[224:227]
ds_read_b128 a[96:99], v5 offset:14336
v_fmac_f32 v146, v62, v82
v_mfma_f32_16x16x32_bf16 v[224:227], a[132:135], a[28:31], v[224:227]
buffer_load_dwordx4 a[88:91], v2, s[40:43], s35 offen offset:3072 sc1
v_mfma_f32_16x16x32_bf16 v[200:203], a[132:135], a[20:23], v[200:203]
ds_read_b128 a[100:103], v5 offset:20480
v_fmac_f32 v150, v66, v82
v_mfma_f32_16x16x32_bf16 v[200:203], a[128:131], a[16:19], v[200:203]
v_fmac_f32 v167, v59, v84
v_fmac_f32 v191, v59, v86
v_mfma_f32_16x16x32_bf16 v[176:179], a[128:131], a[8:11], v[176:179]
v_fmac_f32 v174, v66, v84
v_fmac_f32 v215, v59, v88
v_mfma_f32_16x16x32_bf16 v[176:179], a[132:135], a[12:15], v[176:179]
buffer_load_dwordx4 v1, s[4:7], s44 offen offset:3072 sc1 lds
s_add_u32 m0, s19, 65536
v_mfma_f32_16x16x32_bf16 v[152:155], a[132:135], a[4:7], v[152:155]
s_add_u32 s44, s84, 0xa08000
ds_read_b128 a[104:107], v5 offset:15360
v_mfma_f32_16x16x32_bf16 v[152:155], a[128:131], a[0:3], v[152:155]
v_fmac_f32 v198, v66, v86
v_fmac_f32 v219, v63, v88
v_mfma_f32_16x16x32_bf16 v[132:135], a[136:139], a[0:3], v[132:135]
ds_read_b128 a[108:111], v5 offset:21504
v_fmac_f32 v222, v66, v88
v_mfma_f32_16x16x32_bf16 v[132:135], a[140:143], a[4:7], v[132:135]
buffer_load_dwordx4 v1, s[4:7], s44 offen offset:0 sc1 lds
v_mfma_f32_16x16x32_bf16 v[156:159], a[140:143], a[12:15], v[156:159]
ds_read_b128 a[112:115], v5 offset:16384
v_fmac_f32 v226, v70, v88
v_mfma_f32_16x16x32_bf16 v[156:159], a[136:139], a[8:11], v[156:159]
v_fmac_f32 v195, v63, v86
v_fmac_f32 v171, v63, v84
v_mfma_f32_16x16x32_bf16 v[180:183], a[136:139], a[16:19], v[180:183]
v_fmac_f32 v202, v70, v86
v_fmac_f32 v147, v63, v82
v_mfma_f32_16x16x32_bf16 v[180:183], a[140:143], a[20:23], v[180:183]
buffer_load_dwordx4 a[92:95], v2, s[40:43], s33 offen offset:3072 sc1
s_add_u32 s35, s35, 8192
v_mfma_f32_16x16x32_bf16 v[204:207], a[140:143], a[28:31], v[204:207]
s_add_u32 s33, s33, 8192
ds_read_b128 a[116:119], v5 offset:22528
v_mfma_f32_16x16x32_bf16 v[204:207], a[136:139], a[24:27], v[204:207]
v_fmac_f32 v178, v70, v84
v_fmac_f32 v151, v67, v82
v_mfma_f32_16x16x32_bf16 v[208:211], a[144:147], a[24:27], v[208:211]
v_fmac_f32 v154, v70, v82
v_fmac_f32 v175, v67, v84
v_mfma_f32_16x16x32_bf16 v[208:211], a[148:151], a[28:31], v[208:211]
buffer_load_dwordx4 v1, s[4:7], s44 offen offset:1024 sc1 lds
v_mfma_f32_16x16x32_bf16 v[184:187], a[148:151], a[20:23], v[184:187]
v_fmac_f32 v134, v50, v82
v_fmac_f32 v199, v67, v86
v_mfma_f32_16x16x32_bf16 v[184:187], a[144:147], a[16:19], v[184:187]
v_mfma_f32_16x16x32_bf16 v[160:163], a[144:147], a[8:11], v[160:163]
v_fmac_f32 v158, v50, v84
v_fmac_f32 v223, v67, v88
v_mfma_f32_16x16x32_bf16 v[160:163], a[148:151], a[12:15], v[160:163]
buffer_load_dwordx4 v1, s[4:7], s44 offen offset:2048 sc1 lds
v_mfma_f32_16x16x32_bf16 v[136:139], a[148:151], a[4:7], v[136:139]
v_fmac_f32 v182, v50, v86
v_fmac_f32 v227, v71, v88
v_mfma_f32_16x16x32_bf16 v[136:139], a[144:147], a[0:3], v[136:139]
s_waitcnt vmcnt(12) lgkmcnt(0)
s_barrier
v_mfma_f32_16x16x32_bf16 v[140:143], a[96:99], a[32:35], v[140:143]
ds_read_b128 a[128:131], v5 offset:17408
v_fmac_f32 v206, v50, v88
v_mfma_f32_16x16x32_bf16 v[140:143], a[100:103], a[36:39], v[140:143]
buffer_load_dwordx4 a[0:3], v2, s[40:43], s35 offen offset:0 sc1
v_mfma_f32_16x16x32_bf16 v[164:167], a[100:103], a[44:47], v[164:167]
ds_read_b128 a[132:135], v5 offset:23552
v_fmac_f32 v210, v54, v88
v_mfma_f32_16x16x32_bf16 v[164:167], a[96:99], a[40:43], v[164:167]
v_fmac_f32 v203, v71, v86
v_fmac_f32 v179, v71, v84
v_mfma_f32_16x16x32_bf16 v[188:191], a[96:99], a[48:51], v[188:191]
buffer_load_dwordx4 a[4:7], v2, s[40:43], s33 offen offset:0 sc1
v_mfma_f32_16x16x32_bf16 v[188:191], a[100:103], a[52:55], v[188:191]
ds_read_b128 a[136:139], v5 offset:26624
v_fmac_f32 v186, v54, v86
v_mfma_f32_16x16x32_bf16 v[212:215], a[100:103], a[60:63], v[212:215]
v_fmac_f32 v162, v54, v84
v_fmac_f32 v155, v71, v82
v_mfma_f32_16x16x32_bf16 v[212:215], a[96:99], a[56:59], v[212:215]
buffer_load_dwordx4 a[8:11], v2, s[40:43], s35 offen offset:1024 sc1
v_mfma_f32_16x16x32_bf16 v[216:219], a[104:107], a[56:59], v[216:219]
ds_read_b128 a[140:143], v5 offset:32768
v_fmac_f32 v138, v54, v82
v_mfma_f32_16x16x32_bf16 v[216:219], a[108:111], a[60:63], v[216:219]
v_fmac_f32 v135, v51, v82
v_fmac_f32 v159, v51, v84
v_mfma_f32_16x16x32_bf16 v[192:195], a[108:111], a[52:55], v[192:195]
buffer_load_dwordx4 a[12:15], v2, s[40:43], s33 offen offset:1024 sc1
v_mfma_f32_16x16x32_bf16 v[192:195], a[104:107], a[48:51], v[192:195]
ds_read_b128 a[144:147], v5 offset:27648
v_fmac_f32 v183, v51, v86
v_mfma_f32_16x16x32_bf16 v[168:171], a[104:107], a[40:43], v[168:171]
v_fmac_f32 v207, v51, v88
v_mfma_f32_16x16x32_bf16 v[168:171], a[108:111], a[44:47], v[168:171]
buffer_load_dwordx4 a[16:19], v2, s[40:43], s35 offen offset:2048 sc1
v_mfma_f32_16x16x32_bf16 v[144:147], a[108:111], a[36:39], v[144:147]
ds_read_b128 a[148:151], v5 offset:33792
v_fmac_f32 v211, v55, v88
v_mfma_f32_16x16x32_bf16 v[144:147], a[104:107], a[32:35], v[144:147]
v_mul_f32 v88, 0x3e8293ee, v89
v_mfma_f32_16x16x32_bf16 v[148:151], a[112:115], a[32:35], v[148:151]
buffer_load_dwordx4 a[20:23], v2, s[40:43], s33 offen offset:2048 sc1
v_mfma_f32_16x16x32_bf16 v[148:151], a[116:119], a[36:39], v[148:151]
v_fmac_f32 v187, v55, v86
v_mfma_f32_16x16x32_bf16 v[172:175], a[116:119], a[44:47], v[172:175]
v_fmac_f32 v163, v55, v84
v_mul_f32 v86, 0x3e8293ee, v87
v_mfma_f32_16x16x32_bf16 v[172:175], a[112:115], a[40:43], v[172:175]
buffer_load_dwordx4 a[24:27], v2, s[40:43], s35 offen offset:3072 sc1
v_mfma_f32_16x16x32_bf16 v[196:199], a[112:115], a[48:51], v[196:199]
v_fmac_f32 v139, v55, v82
v_mul_f32 v84, 0x3e8293ee, v85
v_mfma_f32_16x16x32_bf16 v[196:199], a[116:119], a[52:55], v[196:199]
v_mul_f32 v82, 0x3e8293ee, v83
v_mfma_f32_16x16x32_bf16 v[220:223], a[116:119], a[60:63], v[220:223]
buffer_load_dwordx4 a[28:31], v2, s[40:43], s33 offen offset:3072 sc1
s_add_u32 s35, s35, 8192
v_mfma_f32_16x16x32_bf16 v[220:223], a[112:115], a[56:59], v[220:223]
s_add_u32 s33, s33, 8192
s_waitcnt lgkmcnt(0)
v_mfma_f32_16x16x32_bf16 v[224:227], a[128:131], a[56:59], v[224:227]
ds_read_b128 a[96:99], v5 offset:28672
v_mfma_f32_16x16x32_bf16 v[224:227], a[132:135], a[60:63], v[224:227]
buffer_load_dwordx4 v1, s[4:7], s44 offen offset:3072 sc1 lds
s_add_u32 m0, s19, 81920
v_mfma_f32_16x16x32_bf16 v[200:203], a[132:135], a[52:55], v[200:203]
s_add_u32 s44, s85, 0xa0c000
ds_read_b128 a[100:103], v5 offset:34816
v_mfma_f32_16x16x32_bf16 v[200:203], a[128:131], a[48:51], v[200:203]
v_mfma_f32_16x16x32_bf16 v[176:179], a[128:131], a[40:43], v[176:179]
v_mfma_f32_16x16x32_bf16 v[176:179], a[132:135], a[44:47], v[176:179]
buffer_load_dwordx4 v1, s[4:7], s44 offen offset:0 sc1 lds
v_mfma_f32_16x16x32_bf16 v[152:155], a[132:135], a[36:39], v[152:155]
ds_read_b128 a[104:107], v5 offset:29696
v_mfma_f32_16x16x32_bf16 v[152:155], a[128:131], a[32:35], v[152:155]
s_waitcnt vmcnt(21)
v_mfma_f32_16x16x32_bf16 v[140:143], a[136:139], a[64:67], v[140:143]
ds_read_b128 a[108:111], v5 offset:35840
s_waitcnt vmcnt(20)
v_mfma_f32_16x16x32_bf16 v[140:143], a[140:143], a[68:71], v[140:143]
s_waitcnt vmcnt(18)
v_mfma_f32_16x16x32_bf16 v[164:167], a[140:143], a[76:79], v[164:167]
buffer_load_dwordx4 v1, s[4:7], s44 offen offset:1024 sc1 lds
v_mfma_f32_16x16x32_bf16 v[164:167], a[136:139], a[72:75], v[164:167]
ds_read_b128 a[112:115], v5 offset:38912
s_waitcnt vmcnt(18)
v_mfma_f32_16x16x32_bf16 v[188:191], a[136:139], a[80:83], v[188:191]
s_waitcnt vmcnt(17)
v_mfma_f32_16x16x32_bf16 v[188:191], a[140:143], a[84:87], v[188:191]
ds_read_b128 a[116:119], v5 offset:45056
s_waitcnt vmcnt(13)
v_mfma_f32_16x16x32_bf16 v[212:215], a[140:143], a[92:95], v[212:215]
v_mfma_f32_16x16x32_bf16 v[212:215], a[136:139], a[88:91], v[212:215]
buffer_load_dwordx4 v1, s[4:7], s44 offen offset:2048 sc1 lds
v_mfma_f32_16x16x32_bf16 v[216:219], a[144:147], a[88:91], v[216:219]
v_mfma_f32_16x16x32_bf16 v[216:219], a[148:151], a[92:95], v[216:219]
v_mfma_f32_16x16x32_bf16 v[192:195], a[148:151], a[84:87], v[192:195]
v_mfma_f32_16x16x32_bf16 v[192:195], a[144:147], a[80:83], v[192:195]
v_mfma_f32_16x16x32_bf16 v[168:171], a[144:147], a[72:75], v[168:171]
buffer_load_dwordx4 v1, s[4:7], s44 offen offset:3072 sc1 lds
v_mfma_f32_16x16x32_bf16 v[168:171], a[148:151], a[76:79], v[168:171]
v_mfma_f32_16x16x32_bf16 v[144:147], a[148:151], a[68:71], v[144:147]
v_mfma_f32_16x16x32_bf16 v[144:147], a[144:147], a[64:67], v[144:147]
s_waitcnt lgkmcnt(0)
v_mfma_f32_16x16x32_bf16 v[148:151], a[96:99], a[64:67], v[148:151]
ds_read_b128 a[128:131], v5 offset:39936
v_mfma_f32_16x16x32_bf16 v[148:151], a[100:103], a[68:71], v[148:151]
buffer_store_dwordx4 a[220:223], v1, s[4:7], s101 offen offset:0 sc1
v_mfma_f32_16x16x32_bf16 v[172:175], a[100:103], a[76:79], v[172:175]
ds_read_b128 a[132:135], v5 offset:46080
v_mfma_f32_16x16x32_bf16 v[172:175], a[96:99], a[72:75], v[172:175]
v_mfma_f32_16x16x32_bf16 v[196:199], a[96:99], a[80:83], v[196:199]
v_mfma_f32_16x16x32_bf16 v[196:199], a[100:103], a[84:87], v[196:199]
ds_read_b128 a[136:139], v5 offset:40960
v_mfma_f32_16x16x32_bf16 v[220:223], a[100:103], a[92:95], v[220:223]
v_mfma_f32_16x16x32_bf16 v[220:223], a[96:99], a[88:91], v[220:223]
v_mfma_f32_16x16x32_bf16 v[224:227], a[104:107], a[88:91], v[224:227]
ds_read_b128 a[140:143], v5 offset:47104
v_mfma_f32_16x16x32_bf16 v[224:227], a[108:111], a[92:95], v[224:227]
buffer_store_dwordx4 a[224:227], v1, s[4:7], s101 offen offset:1024 sc1
v_mfma_f32_16x16x32_bf16 v[200:203], a[108:111], a[84:87], v[200:203]
ds_read_b128 a[144:147], v5 offset:41984
v_mfma_f32_16x16x32_bf16 v[200:203], a[104:107], a[80:83], v[200:203]
v_mfma_f32_16x16x32_bf16 v[176:179], a[104:107], a[72:75], v[176:179]
v_mfma_f32_16x16x32_bf16 v[176:179], a[108:111], a[76:79], v[176:179]
ds_read_b128 a[148:151], v5 offset:48128
v_mfma_f32_16x16x32_bf16 v[152:155], a[108:111], a[68:71], v[152:155]
v_mfma_f32_16x16x32_bf16 v[152:155], a[104:107], a[64:67], v[152:155]
s_waitcnt vmcnt(14)
v_mfma_f32_16x16x32_bf16 v[140:143], a[112:115], a[0:3], v[140:143]
s_waitcnt vmcnt(13)
v_mfma_f32_16x16x32_bf16 v[140:143], a[116:119], a[4:7], v[140:143]
buffer_store_dwordx4 a[188:191], v1, s[4:7], s96 offen offset:0 sc1
s_waitcnt vmcnt(12)
v_mfma_f32_16x16x32_bf16 v[164:167], a[116:119], a[12:15], v[164:167]
v_mfma_f32_16x16x32_bf16 v[164:167], a[112:115], a[8:11], v[164:167]
s_waitcnt vmcnt(11)
v_mfma_f32_16x16x32_bf16 v[188:191], a[112:115], a[16:19], v[188:191]
s_waitcnt vmcnt(10)
v_mfma_f32_16x16x32_bf16 v[188:191], a[116:119], a[20:23], v[188:191]
s_waitcnt vmcnt(8)
v_mfma_f32_16x16x32_bf16 v[212:215], a[116:119], a[28:31], v[212:215]
v_mfma_f32_16x16x32_bf16 v[212:215], a[112:115], a[24:27], v[212:215]
s_waitcnt lgkmcnt(0)
v_mfma_f32_16x16x32_bf16 v[216:219], a[128:131], a[24:27], v[216:219]
ds_read_b128 a[96:99], v5 offset:12288
v_mul_f32 v140, v140, v83
v_mfma_f32_16x16x32_bf16 v[216:219], a[132:135], a[28:31], v[216:219]
buffer_store_dwordx4 a[192:195], v1, s[4:7], s97 offen offset:0 sc1
v_mfma_f32_16x16x32_bf16 v[192:195], a[132:135], a[20:23], v[192:195]
ds_read_b128 a[100:103], v5 offset:18432
v_mul_f32 v141, v141, v83
v_mfma_f32_16x16x32_bf16 v[192:195], a[128:131], a[16:19], v[192:195]
v_cvt_pk_bf16_f32 v140, v140, v141
v_mul_f32 v164, v164, v85
v_mfma_f32_16x16x32_bf16 v[168:171], a[128:131], a[8:11], v[168:171]
v_mul_f32 v165, v165, v85
v_cvt_pk_bf16_f32 v164, v164, v165
v_mfma_f32_16x16x32_bf16 v[168:171], a[132:135], a[12:15], v[168:171]
ds_read_b128 a[104:107], v5 offset:24576
v_mul_f32 v188, v188, v87
v_mfma_f32_16x16x32_bf16 v[144:147], a[132:135], a[4:7], v[144:147]
v_mul_f32 v212, v212, v89
v_mul_f32 v213, v213, v89
v_mfma_f32_16x16x32_bf16 v[144:147], a[128:131], a[0:3], v[144:147]
v_mul_f32 v214, v214, v89
v_mul_f32 v215, v215, v89
v_mfma_f32_16x16x32_bf16 v[148:151], a[136:139], a[0:3], v[148:151]
ds_read_b128 a[108:111], v5 offset:30720
v_cvt_pk_bf16_f32 v212, v212, v213
v_mfma_f32_16x16x32_bf16 v[148:151], a[140:143], a[4:7], v[148:151]
buffer_store_dwordx4 a[196:199], v1, s[4:7], s96 offen offset:1024 sc1
v_mfma_f32_16x16x32_bf16 v[172:175], a[140:143], a[12:15], v[172:175]
ds_read_b128 a[112:115], v5 offset:36864
v_mul_f32 v216, v216, v89
v_mfma_f32_16x16x32_bf16 v[172:175], a[136:139], a[8:11], v[172:175]
v_mul_f32 v217, v217, v89
v_mul_f32 v218, v218, v89
v_mfma_f32_16x16x32_bf16 v[196:199], a[136:139], a[16:19], v[196:199]
v_mul_f32 v219, v219, v89
v_cvt_pk_bf16_f32 v213, v214, v215
v_mfma_f32_16x16x32_bf16 v[196:199], a[140:143], a[20:23], v[196:199]
ds_read_b128 a[116:119], v5 offset:43008
v_cvt_pk_bf16_f32 v214, v216, v217
v_mfma_f32_16x16x32_bf16 v[220:223], a[140:143], a[28:31], v[220:223]
v_cvt_pk_bf16_f32 v215, v218, v219
v_min_u32 v212, -2, v212
v_mfma_f32_16x16x32_bf16 v[220:223], a[136:139], a[24:27], v[220:223]
v_min_u32 v213, -2, v213
v_min_u32 v214, -2, v214
v_mfma_f32_16x16x32_bf16 v[224:227], a[144:147], a[24:27], v[224:227]
v_min_u32 v215, -2, v215
v_mul_f32 v189, v189, v87
v_mfma_f32_16x16x32_bf16 v[224:227], a[148:151], a[28:31], v[224:227]
buffer_store_dwordx4 a[200:203], v1, s[4:7], s97 offen offset:1024 sc1
v_mfma_f32_16x16x32_bf16 v[200:203], a[148:151], a[20:23], v[200:203]
buffer_store_dwordx4 v[212:215], v3, s[4:7], s63 offen offset:0 sc1
v_mfma_f32_16x16x32_bf16 v[200:203], a[144:147], a[16:19], v[200:203]
v_cvt_pk_bf16_f32 v188, v188, v189
v_mul_f32 v172, v172, v85
v_mfma_f32_16x16x32_bf16 v[176:179], a[144:147], a[8:11], v[176:179]
v_mul_f32 v173, v173, v85
v_cvt_pk_bf16_f32 v172, v172, v173
v_mfma_f32_16x16x32_bf16 v[176:179], a[148:151], a[12:15], v[176:179]
v_mul_f32 v196, v196, v87
v_mul_f32 v197, v197, v87
v_mfma_f32_16x16x32_bf16 v[152:155], a[148:151], a[4:7], v[152:155]
v_mul_f32 v220, v220, v89
v_mul_f32 v221, v221, v89
v_mfma_f32_16x16x32_bf16 v[152:155], a[144:147], a[0:3], v[152:155]
v_mul_f32 v222, v222, v89
s_waitcnt lgkmcnt(0)
v_mfma_f32_16x16x32_bf16 v[132:135], a[96:99], a[32:35], v[132:135]
ds_read_b128 a[128:131], v5 offset:13312
v_mul_f32 v223, v223, v89
v_mfma_f32_16x16x32_bf16 v[132:135], a[100:103], a[36:39], v[132:135]
buffer_store_dwordx4 a[204:207], v1, s[4:7], s96 offen offset:2048 sc1
v_mfma_f32_16x16x32_bf16 v[156:159], a[100:103], a[44:47], v[156:159]
ds_read_b128 a[132:135], v5 offset:19456
v_cvt_pk_bf16_f32 v220, v220, v221
v_mfma_f32_16x16x32_bf16 v[156:159], a[96:99], a[40:43], v[156:159]
v_mul_f32 v224, v224, v89
v_mul_f32 v225, v225, v89
v_mfma_f32_16x16x32_bf16 v[180:183], a[96:99], a[48:51], v[180:183]
v_mul_f32 v226, v226, v89
v_mul_f32 v227, v227, v89
v_mfma_f32_16x16x32_bf16 v[180:183], a[100:103], a[52:55], v[180:183]
ds_read_b128 a[136:139], v5 offset:25600
v_cvt_pk_bf16_f32 v221, v222, v223
v_mfma_f32_16x16x32_bf16 v[204:207], a[100:103], a[60:63], v[204:207]
v_cvt_pk_bf16_f32 v222, v224, v225
v_cvt_pk_bf16_f32 v223, v226, v227
v_mfma_f32_16x16x32_bf16 v[204:207], a[96:99], a[56:59], v[204:207]
v_min_u32 v220, -2, v220
v_min_u32 v221, -2, v221
v_mfma_f32_16x16x32_bf16 v[204:207], a[104:107], a[88:91], v[204:207]
ds_read_b128 a[140:143], v5 offset:31744
v_min_u32 v222, -2, v222
v_mfma_f32_16x16x32_bf16 v[204:207], a[108:111], a[92:95], v[204:207]
buffer_store_dwordx4 a[208:211], v1, s[4:7], s97 offen offset:2048 sc1
v_mfma_f32_16x16x32_bf16 v[180:183], a[108:111], a[84:87], v[180:183]
ds_read_b128 a[144:147], v5 offset:37888
v_min_u32 v223, -2, v223
v_mfma_f32_16x16x32_bf16 v[180:183], a[104:107], a[80:83], v[180:183]
buffer_store_dwordx4 v[220:223], v3, s[4:7], s63 offen offset:1024 sc1
v_mfma_f32_16x16x32_bf16 v[156:159], a[104:107], a[72:75], v[156:159]
v_cvt_pk_bf16_f32 v196, v196, v197
v_mul_f32 v198, v198, v87
v_mfma_f32_16x16x32_bf16 v[156:159], a[108:111], a[76:79], v[156:159]
ds_read_b128 a[148:151], v5 offset:44032
v_mul_f32 v199, v199, v87
v_mfma_f32_16x16x32_bf16 v[132:135], a[108:111], a[68:71], v[132:135]
v_cvt_pk_bf16_f32 v197, v198, v199
v_mul_f32 v200, v200, v87
v_mfma_f32_16x16x32_bf16 v[132:135], a[104:107], a[64:67], v[132:135]
v_mul_f32 v201, v201, v87
v_cvt_pk_bf16_f32 v198, v200, v201
v_mfma_f32_16x16x32_bf16 v[132:135], a[112:115], a[0:3], v[132:135]
v_mul_f32 v202, v202, v87
v_mul_f32 v203, v203, v87
v_mfma_f32_16x16x32_bf16 v[132:135], a[116:119], a[4:7], v[132:135]
buffer_store_dwordx4 v[236:239], v254, s[4:7], s98 offen offset:0 sc1
v_mfma_f32_16x16x32_bf16 v[156:159], a[116:119], a[12:15], v[156:159]
v_cvt_pk_bf16_f32 v199, v202, v203
v_mul_f32 v174, v174, v85
L_stub2:
s_cbranch_execz L_wret0
v_mfma_f32_16x16x32_bf16 v[156:159], a[112:115], a[8:11], v[156:159]
v_mul_f32 v175, v175, v85
v_cvt_pk_bf16_f32 v173, v174, v175
v_mfma_f32_16x16x32_bf16 v[180:183], a[112:115], a[16:19], v[180:183]
v_mul_f32 v176, v176, v85
v_mul_f32 v177, v177, v85
v_mfma_f32_16x16x32_bf16 v[180:183], a[116:119], a[20:23], v[180:183]
v_cvt_pk_bf16_f32 v174, v176, v177
v_mul_f32 v178, v178, v85
v_mfma_f32_16x16x32_bf16 v[204:207], a[116:119], a[28:31], v[204:207]
v_mul_f32 v179, v179, v85
v_cvt_pk_bf16_f32 v175, v178, v179
v_mfma_f32_16x16x32_bf16 v[204:207], a[112:115], a[24:27], v[204:207]
s_waitcnt lgkmcnt(0)
s_barrier
v_mfma_f32_16x16x32_bf16 v[208:211], a[128:131], a[56:59], v[208:211]
ds_write_b128 v233, v[212:215] offset:21504
v_cvt_pk_bf16_f32 v132, v132, v133
v_mfma_f32_16x16x32_bf16 v[208:211], a[132:135], a[60:63], v[208:211]
buffer_store_dwordx4 v[240:243], v254, s[4:7], s98 offen offset:2048 sc1
v_mfma_f32_16x16x32_bf16 v[184:187], a[132:135], a[52:55], v[184:187]
ds_write_b64 v232, v[220:221] offset:4096
v_cvt_pk_bf16_f32 v156, v156, v157
v_mfma_f32_16x16x32_bf16 v[184:187], a[128:131], a[48:51], v[184:187]
ds_write_b64 v232, v[222:223] offset:4608
v_cvt_pk_bf16_f32 v133, v134, v135
v_mfma_f32_16x16x32_bf16 v[160:163], a[128:131], a[40:43], v[160:163]
ds_write_b64 v232, v[196:197] offset:3072
v_cvt_pk_bf16_f32 v180, v180, v181
v_mfma_f32_16x16x32_bf16 v[160:163], a[132:135], a[44:47], v[160:163]
ds_write_b64 v232, v[198:199] offset:3584
v_cvt_pk_bf16_f32 v157, v158, v159
v_mfma_f32_16x16x32_bf16 v[136:139], a[132:135], a[36:39], v[136:139]
ds_write_b64 v232, v[172:173] offset:2048
v_cvt_pk_bf16_f32 v204, v204, v205
v_mfma_f32_16x16x32_bf16 v[136:139], a[128:131], a[32:35], v[136:139]
ds_write_b64 v232, v[174:175] offset:2560
v_cvt_pk_bf16_f32 v181, v182, v183
v_mfma_f32_16x16x32_bf16 v[136:139], a[136:139], a[64:67], v[136:139]
v_cvt_pk_bf16_f32 v205, v206, v207
v_mul_f32 v148, v148, v83
v_mfma_f32_16x16x32_bf16 v[136:139], a[140:143], a[68:71], v[136:139]
v_mul_f32 v149, v149, v83
v_cvt_pk_bf16_f32 v148, v148, v149
v_mfma_f32_16x16x32_bf16 v[160:163], a[140:143], a[76:79], v[160:163]
v_mul_f32 v150, v150, v83
v_mul_f32 v151, v151, v83
v_mfma_f32_16x16x32_bf16 v[160:163], a[136:139], a[72:75], v[160:163]
v_cvt_pk_bf16_f32 v149, v150, v151
v_mul_f32 v152, v152, v83
v_mfma_f32_16x16x32_bf16 v[184:187], a[136:139], a[80:83], v[184:187]
ds_write_b64 v232, v[148:149] offset:1024
v_mul_f32 v153, v153, v83
v_mfma_f32_16x16x32_bf16 v[184:187], a[140:143], a[84:87], v[184:187]
buffer_store_dwordx4 v[244:247], v254, s[4:7], s99 offen offset:0 sc1
v_mfma_f32_16x16x32_bf16 v[208:211], a[140:143], a[92:95], v[208:211]
v_cvt_pk_bf16_f32 v150, v152, v153
v_mul_f32 v154, v154, v83
v_mfma_f32_16x16x32_bf16 v[208:211], a[136:139], a[88:91], v[208:211]
v_mul_f32 v155, v155, v83
v_cvt_pk_bf16_f32 v151, v154, v155
v_mfma_f32_16x16x32_bf16 v[208:211], a[144:147], a[24:27], v[208:211]
ds_write_b64 v232, v[150:151] offset:1536
v_mul_f32 v190, v190, v87
v_mfma_f32_16x16x32_bf16 v[208:211], a[148:151], a[28:31], v[208:211]
v_mul_f32 v191, v191, v87
v_cvt_pk_bf16_f32 v189, v190, v191
v_mfma_f32_16x16x32_bf16 v[184:187], a[148:151], a[20:23], v[184:187]
v_mul_f32 v166, v166, v85
v_mul_f32 v167, v167, v85
v_mfma_f32_16x16x32_bf16 v[184:187], a[144:147], a[16:19], v[184:187]
v_cvt_pk_bf16_f32 v165, v166, v167
v_mul_f32 v142, v142, v83
v_mfma_f32_16x16x32_bf16 v[160:163], a[144:147], a[8:11], v[160:163]
v_mul_f32 v143, v143, v83
v_cvt_pk_bf16_f32 v141, v142, v143
v_mfma_f32_16x16x32_bf16 v[160:163], a[148:151], a[12:15], v[160:163]
v_mul_f32 v192, v192, v87
v_mul_f32 v193, v193, v87
v_mfma_f32_16x16x32_bf16 v[136:139], a[148:151], a[4:7], v[136:139]
v_cvt_pk_bf16_f32 v190, v192, v193
v_mul_f32 v194, v194, v87
v_mfma_f32_16x16x32_bf16 v[136:139], a[144:147], a[0:3], v[136:139]
v_mul_f32 v195, v195, v87
v_cvt_pk_bf16_f32 v191, v194, v195
s_add_u32 m0, s19, 32768
s_add_u32 s44, s84, 0xa00000
buffer_load_dwordx4 v1, s[4:7], s44 offen offset:0 sc1 lds
v_pk_mul_f32 v[168:169], v[168:169], v[84:85] op_sel:[0,1] op_sel_hi:[1,1]
v_pk_mul_f32 v[170:171], v[170:171], v[84:85] op_sel:[0,1] op_sel_hi:[1,1]
v_pk_mul_f32 v[144:145], v[144:145], v[82:83] op_sel:[0,1] op_sel_hi:[1,1]
v_pk_mul_f32 v[146:147], v[146:147], v[82:83] op_sel:[0,1] op_sel_hi:[1,1]
v_cvt_pk_bf16_f32 v166, v168, v169
v_cvt_pk_bf16_f32 v167, v170, v171
v_cvt_pk_bf16_f32 v142, v144, v145
v_cvt_pk_bf16_f32 v143, v146, v147
v_cvt_pk_bf16_f32 v134, v136, v137
v_cvt_pk_bf16_f32 v135, v138, v139
v_cvt_pk_bf16_f32 v158, v160, v161
v_cvt_pk_bf16_f32 v159, v162, v163
v_cvt_pk_bf16_f32 v182, v184, v185
v_cvt_pk_bf16_f32 v183, v186, v187
v_cvt_pk_bf16_f32 v206, v208, v209
v_cvt_pk_bf16_f32 v207, v210, v211
buffer_load_dwordx4 v1, s[4:7], s44 offen offset:1024 sc1 lds
buffer_load_dwordx4 v1, s[4:7], s44 offen offset:2048 sc1 lds
buffer_load_dwordx4 v1, s[4:7], s44 offen offset:3072 sc1 lds
s_add_u32 m0, s19, 98304
s_add_u32 s44, s84, 0xa10000
buffer_load_dwordx4 v1, s[4:7], s44 offen offset:0 sc1 lds
buffer_load_dwordx4 v1, s[4:7], s44 offen offset:1024 sc1 lds
buffer_load_dwordx4 v1, s[4:7], s44 offen offset:2048 sc1 lds
buffer_load_dwordx4 v1, s[4:7], s44 offen offset:3072 sc1 lds
s_waitcnt lgkmcnt(0)
s_barrier
s_add_u32 m0, s19, 114688
s_add_u32 s44, s85, 0xa14000
buffer_load_dwordx4 v1, s[4:7], s44 offen offset:0 sc1 lds
v_mfma_f32_16x16x32_bf16 v[208:211], v[188:191], v[204:207], v[20:23]
ds_read_b64_tr_b16 a[10:11], v248 offset:3072
v_mfma_f32_16x16x32_bf16 v[224:227], v[212:215], v[204:207], v[24:27]
ds_read_b64_tr_b16 a[12:13], v248 offset:4096
v_mfma_f32_16x16x32_bf16 v[160:163], v[140:143], v[156:159], v[20:23]
ds_read_b64_tr_b16 a[22:23], v248 offset:3584
v_mfma_f32_16x16x32_bf16 v[176:179], v[164:167], v[156:159], v[24:27]
s_nop 3
v_max_f32 v224, v224, v208
v_max_f32 v225, v225, v209
v_max_f32 v226, v226, v210
v_max_f32 v227, v227, v211
v_max3_f32 v239, v224, v225, v226
v_max_f32 v239, v239, v227
ds_read_b64_tr_b16 a[24:25], v248 offset:4608
v_max_f32 v176, v176, v160
v_max_f32 v177, v177, v161
v_max_f32 v178, v178, v162
v_max_f32 v179, v179, v163
v_max3_f32 v237, v176, v177, v178
buffer_load_dwordx4 v1, s[4:7], s44 offen offset:1024 sc1 lds
v_max_f32 v237, v237, v179
ds_read_b64_tr_b16 a[6:7], v248 offset:1024
s_nop 0
v_permlane32_swap_b32 v239, v237
v_max_f32 v239, v239, v237
v_mov_b32 v242, v239
ds_read_b64_tr_b16 a[8:9], v248 offset:2048
s_nop 0
v_permlane16_swap_b32 v239, v242
v_max_f32 v239, v239, v242
v_mov_b32 v242, v239
ds_read_b64_tr_b16 a[18:19], v248 offset:1536
s_nop 0
v_permlane32_swap_b32 v239, v242
v_mul_f32_e64 v89, -v239, v88
v_fma_f32 v224, v224, v88, v89
v_fma_f32 v225, v225, v88, v89
v_fma_f32 v226, v226, v88, v89
v_fma_f32 v227, v227, v88, v89
buffer_load_dwordx4 v[228:231], v9, s[4:7], s55 offen sc1
buffer_load_dwordx4 v[72:75], v9, s[4:7], s55 offen offset:1024 sc1
v_exp_f32 v224, v224
v_exp_f32 v225, v225
v_exp_f32 v226, v226
buffer_load_dwordx4 v1, s[4:7], s44 offen offset:2048 sc1 lds
v_exp_f32 v227, v227
v_cvt_pk_bf16_f32 v224, v224, v225
v_cvt_pk_bf16_f32 v225, v226, v227
ds_read_b64_tr_b16 a[20:21], v248 offset:2560
v_and_b32 v208, v224, v28
v_and_b32 v209, v225, v29
v_and_b32 v210, v224, v30
v_and_b32 v211, v225, v31
v_mul_f32_e64 v85, -v242, v84
v_fma_f32 v176, v176, v84, v85
v_mfma_f32_16x16x32_bf16 v[216:219], v[16:19], v[208:211], 0
v_fma_f32 v177, v177, v84, v85
v_fma_f32 v178, v178, v84, v85
s_waitcnt lgkmcnt(6)
v_mfma_f32_16x16x32_bf16 v[116:119], a[10:13], v[208:211], 0
v_fma_f32 v179, v179, v84, v85
v_exp_f32 v176, v176
s_waitcnt lgkmcnt(4)
v_mfma_f32_16x16x32_bf16 v[120:123], a[22:25], v[208:211], 0
v_exp_f32 v177, v177
v_exp_f32 v178, v178
buffer_load_dwordx4 v1, s[4:7], s44 offen offset:3072 sc1 lds
v_exp_f32 v179, v179
v_rcp_f32 v216, v216
v_cvt_pk_bf16_f32 v176, v176, v177
v_cvt_pk_bf16_f32 v177, v178, v179
v_and_b32 v160, v176, v28
v_and_b32 v161, v177, v29
v_and_b32 v162, v176, v30
v_and_b32 v163, v177, v31
v_pk_mul_f32 v[116:117], v[116:117], v[216:217] op_sel:[0,0] op_sel_hi:[1,0]
v_cvt_pk_bf16_f32 v116, v116, v117
v_pk_mul_f32 v[118:119], v[118:119], v[216:217] op_sel:[0,0] op_sel_hi:[1,0]
v_cvt_pk_bf16_f32 v117, v118, v119
v_pk_mul_f32 v[120:121], v[120:121], v[216:217] op_sel:[0,0] op_sel_hi:[1,0]
v_cvt_pk_bf16_f32 v118, v120, v121
v_pk_mul_f32 v[122:123], v[122:123], v[216:217] op_sel:[0,0] op_sel_hi:[1,0]
v_cvt_pk_bf16_f32 v119, v122, v123
v_mfma_f32_16x16x32_bf16 v[168:171], v[16:19], v[160:163], 0
s_waitcnt lgkmcnt(2)
v_mfma_f32_16x16x32_bf16 v[100:103], a[6:9], v[160:163], 0
s_waitcnt lgkmcnt(0)
v_mfma_f32_16x16x32_bf16 v[104:107], a[18:21], v[160:163], 0
buffer_store_dwordx4 v[116:119], v2, s[4:7], s72 offen offset:3072 sc1
v_mfma_f32_16x16x32_bf16 v[184:187], v[164:167], v[180:183], v[20:23]
s_nop 1
v_rcp_f32 v168, v168
v_mfma_f32_16x16x32_bf16 v[200:203], v[188:191], v[180:183], v[24:27]
v_pk_mul_f32 v[100:101], v[100:101], v[168:169] op_sel:[0,0] op_sel_hi:[1,0]
v_pk_mul_f32 v[102:103], v[102:103], v[168:169] op_sel:[0,0] op_sel_hi:[1,0]
v_cvt_pk_bf16_f32 v100, v100, v101
v_pk_mul_f32 v[104:105], v[104:105], v[168:169] op_sel:[0,0] op_sel_hi:[1,0]
v_pk_mul_f32 v[106:107], v[106:107], v[168:169] op_sel:[0,0] op_sel_hi:[1,0]
v_cvt_pk_bf16_f32 v101, v102, v103
v_cvt_pk_bf16_f32 v102, v104, v105
v_cvt_pk_bf16_f32 v103, v106, v107
v_max_f32 v200, v200, v184
v_max_f32 v201, v201, v185
v_max_f32 v202, v202, v186
buffer_store_dwordx4 v[100:103], v2, s[4:7], s72 offen offset:1024 sc1
v_max_f32 v203, v203, v187
v_max3_f32 v238, v200, v201, v202
v_max_f32 v238, v238, v203
s_cmp_lg_u32 s28, 0
s_cbranch_scc1 Lhx_4
s_waitcnt vmcnt(5)
v_max3_u32 v244, v228, v229, v230
s_waitcnt vmcnt(4)
v_max3_u32 v244, v244, v231, v72
v_max3_u32 v244, v244, v73, v74
v_max_u32 v244, v244, v75
v_cmp_eq_u32 vcc, -1, v244
s_cbranch_vccnz L_hxredo0
L_hxback0:
ds_write_b128 v233, v[228:231] offset:20480
ds_write_b64 v232, v[72:73] offset:0
ds_write_b64 v232, v[74:75] offset:512
Lhx_4:
ds_read_b128 a[0:3], v233 offset:20480
v_mfma_f32_16x16x32_bf16 v[152:155], v[140:143], v[132:135], v[24:27]
ds_read_b64_tr_b16 a[4:5], v248 offset:0
ds_read_b64_tr_b16 a[16:17], v248 offset:512
s_waitcnt lgkmcnt(2)
v_mfma_f32_16x16x32_bf16 v[136:139], a[0:3], v[132:135], v[76:79]
s_nop 7
v_max_f32 v152, v152, v136
v_max_f32 v153, v153, v137
v_max_f32 v154, v154, v138
v_max_f32 v155, v155, v139
v_max3_f32 v236, v152, v153, v154
v_max_f32 v236, v236, v155
s_nop 1
v_permlane32_swap_b32 v238, v236
v_max_f32 v238, v238, v236
v_mov_b32 v243, v238
s_nop 1
v_permlane16_swap_b32 v238, v243
v_max_f32 v238, v238, v243
v_mov_b32 v243, v238
s_nop 1
v_permlane32_swap_b32 v238, v243
v_mul_f32_e64 v87, -v238, v86
v_fma_f32 v200, v200, v86, v87
v_fma_f32 v201, v201, v86, v87
v_fma_f32 v202, v202, v86, v87
v_fma_f32 v203, v203, v86, v87
v_exp_f32 v200, v200
v_exp_f32 v201, v201
v_exp_f32 v202, v202
v_exp_f32 v203, v203
v_cvt_pk_bf16_f32 v200, v200, v201
v_cvt_pk_bf16_f32 v201, v202, v203
v_and_b32 v184, v200, v28
v_and_b32 v185, v201, v29
v_and_b32 v186, v200, v30
v_and_b32 v187, v201, v31
v_mul_f32_e64 v83, -v243, v82
v_fma_f32 v152, v152, v82, v83
v_mfma_f32_16x16x32_bf16 v[192:195], v[16:19], v[184:187], 0
v_fma_f32 v153, v153, v82, v83
v_fma_f32 v154, v154, v82, v83
v_mfma_f32_16x16x32_bf16 v[108:111], a[8:11], v[184:187], 0
v_fma_f32 v155, v155, v82, v83
v_exp_f32 v152, v152
v_mfma_f32_16x16x32_bf16 v[112:115], a[20:23], v[184:187], 0
v_exp_f32 v153, v153
v_exp_f32 v154, v154
v_exp_f32 v155, v155
v_rcp_f32 v192, v192
v_cvt_pk_bf16_f32 v152, v152, v153
v_cvt_pk_bf16_f32 v153, v154, v155
v_and_b32 v136, v152, v80
v_and_b32 v137, v153, v81
v_and_b32 v138, v152, v30
v_and_b32 v139, v153, v31
v_pk_mul_f32 v[108:109], v[108:109], v[192:193] op_sel:[0,0] op_sel_hi:[1,0]
v_pk_mul_f32 v[110:111], v[110:111], v[192:193] op_sel:[0,0] op_sel_hi:[1,0]
v_cvt_pk_bf16_f32 v108, v108, v109
v_pk_mul_f32 v[112:113], v[112:113], v[192:193] op_sel:[0,0] op_sel_hi:[1,0]
v_cvt_pk_bf16_f32 v109, v110, v111
v_pk_mul_f32 v[114:115], v[114:115], v[192:193] op_sel:[0,0] op_sel_hi:[1,0]
v_cvt_pk_bf16_f32 v110, v112, v113
v_mfma_f32_16x16x32_bf16 v[144:147], v[16:19], v[136:139], 0
v_cvt_pk_bf16_f32 v111, v114, v115
buffer_store_dwordx4 v[108:111], v2, s[4:7], s72 offen offset:2048 sc1
s_waitcnt lgkmcnt(1)
v_mfma_f32_16x16x32_bf16 v[92:95], a[4:7], v[136:139], 0
s_nop 3
v_rcp_f32 v144, v144
s_waitcnt lgkmcnt(0)
v_mfma_f32_16x16x32_bf16 v[96:99], a[16:19], v[136:139], 0
s_nop 0
v_pk_mul_f32 v[92:93], v[92:93], v[144:145] op_sel:[0,0] op_sel_hi:[1,0]
v_pk_mul_f32 v[94:95], v[94:95], v[144:145] op_sel:[0,0] op_sel_hi:[1,0]
v_cvt_pk_bf16_f32 v92, v92, v93
v_cvt_pk_bf16_f32 v93, v94, v95
s_nop 2
v_pk_mul_f32 v[96:97], v[96:97], v[144:145] op_sel:[0,0] op_sel_hi:[1,0]
v_pk_mul_f32 v[98:99], v[98:99], v[144:145] op_sel:[0,0] op_sel_hi:[1,0]
v_cvt_pk_bf16_f32 v94, v96, v97
v_cvt_pk_bf16_f32 v95, v98, v99
buffer_store_dwordx4 v[92:95], v2, s[4:7], s72 offen offset:0 sc1
s_add_u32 s92, s71, 0x0
v_accvgpr_write_b32 a188, v48
v_accvgpr_write_b32 a189, v49
v_accvgpr_write_b32 a190, v50
v_accvgpr_write_b32 a191, v51
v_accvgpr_write_b32 a192, v52
v_accvgpr_write_b32 a193, v53
v_accvgpr_write_b32 a194, v54
v_accvgpr_write_b32 a195, v55
v_accvgpr_write_b32 a196, v56
v_accvgpr_write_b32 a197, v57
v_accvgpr_write_b32 a198, v58
v_accvgpr_write_b32 a199, v59
v_accvgpr_write_b32 a200, v60
v_accvgpr_write_b32 a201, v61
v_accvgpr_write_b32 a202, v62
v_accvgpr_write_b32 a203, v63
v_accvgpr_write_b32 a204, v64
v_accvgpr_write_b32 a205, v65
v_accvgpr_write_b32 a206, v66
v_accvgpr_write_b32 a207, v67
v_accvgpr_write_b32 a208, v68
v_accvgpr_write_b32 a209, v69
v_accvgpr_write_b32 a210, v70
v_accvgpr_write_b32 a211, v71
s_add_u32 s40, s4, 0x1e00000
s_addc_u32 s41, s5, 0
v_add_u32 v5, 32768, v1
v_add_u32 v6, 98304, v1
s_cmp_eq_u32 s3, 0
s_cselect_b32 s35, 8, 0
s_lshl_b32 s35, s35, 12
v_lshlrev_b32 v132, 16, v32
v_and_b32 v133, 0xffff0000, v32
v_lshlrev_b32 v134, 16, v33
v_and_b32 v135, 0xffff0000, v33
v_lshlrev_b32 v136, 16, v34
v_and_b32 v137, 0xffff0000, v34
v_lshlrev_b32 v138, 16, v35
v_and_b32 v139, 0xffff0000, v35
v_lshlrev_b32 v140, 16, v36
v_and_b32 v141, 0xffff0000, v36
v_lshlrev_b32 v142, 16, v37
v_and_b32 v143, 0xffff0000, v37
v_lshlrev_b32 v144, 16, v38
v_and_b32 v145, 0xffff0000, v38
v_lshlrev_b32 v146, 16, v39
v_and_b32 v147, 0xffff0000, v39
v_lshlrev_b32 v148, 16, v40
v_and_b32 v149, 0xffff0000, v40
v_lshlrev_b32 v150, 16, v41
v_and_b32 v151, 0xffff0000, v41
v_lshlrev_b32 v152, 16, v42
v_and_b32 v153, 0xffff0000, v42
v_lshlrev_b32 v154, 16, v43
v_and_b32 v155, 0xffff0000, v43
v_lshlrev_b32 v156, 16, v44
v_and_b32 v157, 0xffff0000, v44
v_lshlrev_b32 v158, 16, v45
v_and_b32 v159, 0xffff0000, v45
v_lshlrev_b32 v160, 16, v46
v_and_b32 v161, 0xffff0000, v46
v_lshlrev_b32 v162, 16, v47
v_and_b32 v163, 0xffff0000, v47
s_waitcnt vmcnt(0)
s_barrier
s_cmp_lg_u32 s28, 0
s_cbranch_scc1 Lsg_5
buffer_atomic_add v12, v10, s[4:7], s92 offen sc1
buffer_atomic_swap v15, v14, s[4:7], s8 offen sc1
buffer_atomic_swap v15, v252, s[4:7], s62 offen offset:64 sc1
Lsg_5:
s_mov_b64 exec, 0
s_cmp_eq_u32 s28, 0
s_cbranch_scc1 L_stub3
L_wret1:
s_mov_b64 exec, -1
s_add_u32 m0, s19, 131072
s_add_u32 s44, s86, 0xa18000
buffer_load_dwordx4 v1, s[4:7], s44 offen offset:0 sc1 lds
buffer_load_dwordx4 v1, s[4:7], s44 offen offset:1024 sc1 lds
buffer_load_dwordx4 v1, s[4:7], s44 offen offset:2048 sc1 lds
buffer_load_dwordx4 v1, s[4:7], s44 offen offset:3072 sc1 lds
s_add_u32 m0, s19, 147456
s_add_u32 s44, s87, 0xa1c000
buffer_load_dwordx4 v1, s[4:7], s44 offen offset:0 sc1 lds
buffer_load_dwordx4 v1, s[4:7], s44 offen offset:1024 sc1 lds
buffer_load_dwordx4 v1, s[4:7], s44 offen offset:2048 sc1 lds
buffer_load_dwordx4 v1, s[4:7], s44 offen offset:3072 sc1 lds
s_cmp_lg_u32 s28, 1
s_cbranch_scc1 Lpo_8
s_add_u32 s36, s66, 0x0
s_mov_b32 s37, 0
v_mov_b32 v11, 0
buffer_atomic_add v11, v251, s[4:7], s36 offen sc0 sc1
s_sleep 4
Lpoll_6:
v_mov_b32 v234, 0
buffer_atomic_add v234, v251, s[4:7], s36 offen sc0 sc1
s_waitcnt vmcnt(1)
v_readfirstlane_b32 s38, v11
s_nop 0
s_cmp_ge_u32 s38, 32
s_cbranch_scc1 Lpe_7
v_mov_b32 v11, 0
buffer_atomic_add v11, v251, s[4:7], s36 offen sc0 sc1
s_waitcnt vmcnt(1)
v_readfirstlane_b32 s38, v234
s_nop 0
s_cmp_ge_u32 s38, 32
s_cbranch_scc1 Lpe_7
s_add_u32 s37, s37, 1
s_cmp_lt_u32 s37, 0x80000
s_cbranch_scc1 Lpoll_6
s_waitcnt vmcnt(0)
Lpo_8:
s_waitcnt vmcnt(0)
Lpe_7:
s_barrier
L_k2go0:
buffer_load_dwordx4 a[0:3], v4, s[40:43], s35 offen offset:0 sc1
buffer_load_dwordx4 a[4:7], v4, s[40:43], s35 offen offset:1024 sc1
s_cmp_eq_u32 s3, 1
s_cselect_b32 s35, 9, 1
s_lshl_b32 s35, s35, 12
buffer_load_dwordx4 a[8:11], v4, s[40:43], s35 offen offset:0 sc1
buffer_load_dwordx4 a[12:15], v4, s[40:43], s35 offen offset:1024 sc1
s_cmp_eq_u32 s3, 2
s_cselect_b32 s35, 10, 2
s_lshl_b32 s35, s35, 12
buffer_load_dwordx4 a[16:19], v4, s[40:43], s35 offen offset:0 sc1
buffer_load_dwordx4 a[20:23], v4, s[40:43], s35 offen offset:1024 sc1
s_cmp_eq_u32 s3, 3
s_cselect_b32 s35, 11, 3
s_lshl_b32 s35, s35, 12
buffer_load_dwordx4 a[24:27], v4, s[40:43], s35 offen offset:0 sc1
buffer_load_dwordx4 a[28:31], v4, s[40:43], s35 offen offset:1024 sc1
s_cmp_eq_u32 s3, 4
s_cselect_b32 s35, 12, 4
s_lshl_b32 s35, s35, 12
buffer_load_dwordx4 a[32:35], v4, s[40:43], s35 offen offset:0 sc1
buffer_load_dwordx4 a[36:39], v4, s[40:43], s35 offen offset:1024 sc1
s_cmp_eq_u32 s3, 5
s_cselect_b32 s35, 13, 5
s_lshl_b32 s35, s35, 12
buffer_load_dwordx4 a[40:43], v4, s[40:43], s35 offen offset:0 sc1
buffer_load_dwordx4 a[44:47], v4, s[40:43], s35 offen offset:1024 sc1
s_cmp_eq_u32 s3, 6
s_cselect_b32 s35, 14, 6
s_lshl_b32 s35, s35, 12
ds_read_b128 a[96:99], v5 offset:0
ds_read_b128 a[100:103], v5 offset:1024
ds_read_b128 a[104:107], v5 offset:2048
ds_read_b128 a[108:111], v5 offset:3072
ds_read_b128 a[112:115], v5 offset:4096
ds_read_b128 a[116:119], v5 offset:5120
ds_read_b128 a[120:123], v5 offset:6144
ds_read_b128 a[124:127], v5 offset:7168
s_waitcnt vmcnt(10) lgkmcnt(4)
v_mfma_f32_16x16x32_bf16 v[132:135], a[96:99], a[0:3], v[132:135]
ds_read_b128 a[128:131], v5 offset:8192
v_mfma_f32_16x16x32_bf16 v[148:151], a[96:99], a[4:7], v[148:151]
ds_read_b128 a[132:135], v5 offset:9216
v_mfma_f32_16x16x32_bf16 v[152:155], a[100:103], a[4:7], v[152:155]
buffer_load_dwordx4 a[48:51], v4, s[40:43], s35 offen offset:0 sc1
v_mfma_f32_16x16x32_bf16 v[136:139], a[100:103], a[0:3], v[136:139]
ds_read_b128 a[136:139], v5 offset:10240
v_mfma_f32_16x16x32_bf16 v[140:143], a[104:107], a[0:3], v[140:143]
ds_read_b128 a[140:143], v5 offset:11264
v_mfma_f32_16x16x32_bf16 v[156:159], a[104:107], a[4:7], v[156:159]
v_mfma_f32_16x16x32_bf16 v[160:163], a[108:111], a[4:7], v[160:163]
buffer_load_dwordx4 a[52:55], v4, s[40:43], s35 offen offset:1024 sc1
v_mfma_f32_16x16x32_bf16 v[144:147], a[108:111], a[0:3], v[144:147]
s_waitcnt vmcnt(10) lgkmcnt(4)
v_mfma_f32_16x16x32_bf16 v[132:135], a[112:115], a[8:11], v[132:135]
s_cmp_eq_u32 s3, 7
s_cselect_b32 s35, 15, 7
s_lshl_b32 s35, s35, 12
v_mfma_f32_16x16x32_bf16 v[148:151], a[112:115], a[12:15], v[148:151]
ds_read_b128 a[96:99], v5 offset:12288
v_mfma_f32_16x16x32_bf16 v[152:155], a[116:119], a[12:15], v[152:155]
buffer_load_dwordx4 a[0:3], v4, s[40:43], s35 offen offset:0 sc1
v_mfma_f32_16x16x32_bf16 v[136:139], a[116:119], a[8:11], v[136:139]
ds_read_b128 a[100:103], v5 offset:13312
v_mfma_f32_16x16x32_bf16 v[140:143], a[120:123], a[8:11], v[140:143]
ds_read_b128 a[104:107], v5 offset:14336
v_mfma_f32_16x16x32_bf16 v[156:159], a[120:123], a[12:15], v[156:159]
ds_read_b128 a[108:111], v5 offset:15360
v_mfma_f32_16x16x32_bf16 v[160:163], a[124:127], a[12:15], v[160:163]
buffer_load_dwordx4 a[4:7], v4, s[40:43], s35 offen offset:1024 sc1
v_mfma_f32_16x16x32_bf16 v[144:147], a[124:127], a[8:11], v[144:147]
s_waitcnt vmcnt(10) lgkmcnt(4)
v_mfma_f32_16x16x32_bf16 v[132:135], a[128:131], a[16:19], v[132:135]
s_cmp_eq_u32 s3, 0
s_cselect_b32 s35, 16, 8
s_lshl_b32 s35, s35, 12
v_mfma_f32_16x16x32_bf16 v[148:151], a[128:131], a[20:23], v[148:151]
ds_read_b128 a[112:115], v5 offset:16384
v_mfma_f32_16x16x32_bf16 v[152:155], a[132:135], a[20:23], v[152:155]
buffer_load_dwordx4 a[8:11], v4, s[40:43], s35 offen offset:0 sc1
v_mfma_f32_16x16x32_bf16 v[136:139], a[132:135], a[16:19], v[136:139]
ds_read_b128 a[116:119], v5 offset:17408
v_mfma_f32_16x16x32_bf16 v[140:143], a[136:139], a[16:19], v[140:143]
ds_read_b128 a[120:123], v5 offset:18432
v_mfma_f32_16x16x32_bf16 v[156:159], a[136:139], a[20:23], v[156:159]
ds_read_b128 a[124:127], v5 offset:19456
v_mfma_f32_16x16x32_bf16 v[160:163], a[140:143], a[20:23], v[160:163]
buffer_load_dwordx4 a[12:15], v4, s[40:43], s35 offen offset:1024 sc1
v_mfma_f32_16x16x32_bf16 v[144:147], a[140:143], a[16:19], v[144:147]
s_waitcnt vmcnt(10) lgkmcnt(4)
v_mfma_f32_16x16x32_bf16 v[132:135], a[96:99], a[24:27], v[132:135]
s_cmp_eq_u32 s3, 1
s_cselect_b32 s35, 17, 9
s_lshl_b32 s35, s35, 12
v_mfma_f32_16x16x32_bf16 v[148:151], a[96:99], a[28:31], v[148:151]
ds_read_b128 a[128:131], v5 offset:20480
v_mfma_f32_16x16x32_bf16 v[152:155], a[100:103], a[28:31], v[152:155]
buffer_load_dwordx4 a[16:19], v4, s[40:43], s35 offen offset:0 sc1
v_mfma_f32_16x16x32_bf16 v[136:139], a[100:103], a[24:27], v[136:139]
ds_read_b128 a[132:135], v5 offset:21504
v_mfma_f32_16x16x32_bf16 v[140:143], a[104:107], a[24:27], v[140:143]
ds_read_b128 a[136:139], v5 offset:22528
v_mfma_f32_16x16x32_bf16 v[156:159], a[104:107], a[28:31], v[156:159]
ds_read_b128 a[140:143], v5 offset:23552
v_mfma_f32_16x16x32_bf16 v[160:163], a[108:111], a[28:31], v[160:163]
buffer_load_dwordx4 a[20:23], v4, s[40:43], s35 offen offset:1024 sc1
v_mfma_f32_16x16x32_bf16 v[144:147], a[108:111], a[24:27], v[144:147]
s_waitcnt vmcnt(10) lgkmcnt(4)
v_mfma_f32_16x16x32_bf16 v[132:135], a[112:115], a[32:35], v[132:135]
s_cmp_eq_u32 s3, 2
s_cselect_b32 s35, 18, 10
s_lshl_b32 s35, s35, 12
v_mfma_f32_16x16x32_bf16 v[148:151], a[112:115], a[36:39], v[148:151]
ds_read_b128 a[96:99], v5 offset:24576
v_mfma_f32_16x16x32_bf16 v[152:155], a[116:119], a[36:39], v[152:155]
buffer_load_dwordx4 a[24:27], v4, s[40:43], s35 offen offset:0 sc1
v_mfma_f32_16x16x32_bf16 v[136:139], a[116:119], a[32:35], v[136:139]
ds_read_b128 a[100:103], v5 offset:25600
v_mfma_f32_16x16x32_bf16 v[140:143], a[120:123], a[32:35], v[140:143]
ds_read_b128 a[104:107], v5 offset:26624
v_mfma_f32_16x16x32_bf16 v[156:159], a[120:123], a[36:39], v[156:159]
ds_read_b128 a[108:111], v5 offset:27648
v_mfma_f32_16x16x32_bf16 v[160:163], a[124:127], a[36:39], v[160:163]
buffer_load_dwordx4 a[28:31], v4, s[40:43], s35 offen offset:1024 sc1
v_mfma_f32_16x16x32_bf16 v[144:147], a[124:127], a[32:35], v[144:147]
s_waitcnt vmcnt(10) lgkmcnt(4)
v_mfma_f32_16x16x32_bf16 v[132:135], a[128:131], a[40:43], v[132:135]
s_cmp_eq_u32 s3, 3
s_cselect_b32 s35, 19, 11
s_lshl_b32 s35, s35, 12
v_mfma_f32_16x16x32_bf16 v[148:151], a[128:131], a[44:47], v[148:151]
ds_read_b128 a[112:115], v5 offset:28672
v_mfma_f32_16x16x32_bf16 v[152:155], a[132:135], a[44:47], v[152:155]
buffer_load_dwordx4 a[32:35], v4, s[40:43], s35 offen offset:0 sc1
v_mfma_f32_16x16x32_bf16 v[136:139], a[132:135], a[40:43], v[136:139]
ds_read_b128 a[116:119], v5 offset:29696
v_mfma_f32_16x16x32_bf16 v[140:143], a[136:139], a[40:43], v[140:143]
ds_read_b128 a[120:123], v5 offset:30720
v_mfma_f32_16x16x32_bf16 v[156:159], a[136:139], a[44:47], v[156:159]
ds_read_b128 a[124:127], v5 offset:31744
v_mfma_f32_16x16x32_bf16 v[160:163], a[140:143], a[44:47], v[160:163]
buffer_load_dwordx4 a[36:39], v4, s[40:43], s35 offen offset:1024 sc1
v_mfma_f32_16x16x32_bf16 v[144:147], a[140:143], a[40:43], v[144:147]
s_waitcnt vmcnt(10) lgkmcnt(4)
v_mfma_f32_16x16x32_bf16 v[132:135], a[96:99], a[48:51], v[132:135]
s_cmp_eq_u32 s3, 4
s_cselect_b32 s35, 20, 12
s_lshl_b32 s35, s35, 12
v_mfma_f32_16x16x32_bf16 v[148:151], a[96:99], a[52:55], v[148:151]
ds_read_b128 a[128:131], v5 offset:32768
v_mfma_f32_16x16x32_bf16 v[152:155], a[100:103], a[52:55], v[152:155]
buffer_load_dwordx4 a[40:43], v4, s[40:43], s35 offen offset:0 sc1
v_mfma_f32_16x16x32_bf16 v[136:139], a[100:103], a[48:51], v[136:139]
ds_read_b128 a[132:135], v5 offset:33792
v_mfma_f32_16x16x32_bf16 v[140:143], a[104:107], a[48:51], v[140:143]
ds_read_b128 a[136:139], v5 offset:34816
v_mfma_f32_16x16x32_bf16 v[156:159], a[104:107], a[52:55], v[156:159]
ds_read_b128 a[140:143], v5 offset:35840
v_mfma_f32_16x16x32_bf16 v[160:163], a[108:111], a[52:55], v[160:163]
buffer_load_dwordx4 a[44:47], v4, s[40:43], s35 offen offset:1024 sc1
v_mfma_f32_16x16x32_bf16 v[144:147], a[108:111], a[48:51], v[144:147]
s_waitcnt vmcnt(10) lgkmcnt(4)
v_mfma_f32_16x16x32_bf16 v[132:135], a[112:115], a[0:3], v[132:135]
s_cmp_eq_u32 s3, 5
s_cselect_b32 s35, 21, 13
s_lshl_b32 s35, s35, 12
v_mfma_f32_16x16x32_bf16 v[148:151], a[112:115], a[4:7], v[148:151]
ds_read_b128 a[96:99], v5 offset:36864
v_mfma_f32_16x16x32_bf16 v[152:155], a[116:119], a[4:7], v[152:155]
buffer_load_dwordx4 a[48:51], v4, s[40:43], s35 offen offset:0 sc1
v_mfma_f32_16x16x32_bf16 v[136:139], a[116:119], a[0:3], v[136:139]
ds_read_b128 a[100:103], v5 offset:37888
v_mfma_f32_16x16x32_bf16 v[140:143], a[120:123], a[0:3], v[140:143]
ds_read_b128 a[104:107], v5 offset:38912
v_mfma_f32_16x16x32_bf16 v[156:159], a[120:123], a[4:7], v[156:159]
ds_read_b128 a[108:111], v5 offset:39936
v_mfma_f32_16x16x32_bf16 v[160:163], a[124:127], a[4:7], v[160:163]
buffer_load_dwordx4 a[52:55], v4, s[40:43], s35 offen offset:1024 sc1
v_mfma_f32_16x16x32_bf16 v[144:147], a[124:127], a[0:3], v[144:147]
s_waitcnt vmcnt(10) lgkmcnt(4)
v_mfma_f32_16x16x32_bf16 v[132:135], a[128:131], a[8:11], v[132:135]
s_cmp_eq_u32 s3, 6
s_cselect_b32 s35, 22, 14
s_lshl_b32 s35, s35, 12
v_mfma_f32_16x16x32_bf16 v[148:151], a[128:131], a[12:15], v[148:151]
ds_read_b128 a[112:115], v5 offset:40960
v_mfma_f32_16x16x32_bf16 v[152:155], a[132:135], a[12:15], v[152:155]
L_stub3:
s_cbranch_execz L_wret1
buffer_load_dwordx4 a[0:3], v4, s[40:43], s35 offen offset:0 sc1
v_mfma_f32_16x16x32_bf16 v[136:139], a[132:135], a[8:11], v[136:139]
ds_read_b128 a[116:119], v5 offset:41984
v_mfma_f32_16x16x32_bf16 v[140:143], a[136:139], a[8:11], v[140:143]
ds_read_b128 a[120:123], v5 offset:43008
v_mfma_f32_16x16x32_bf16 v[156:159], a[136:139], a[12:15], v[156:159]
ds_read_b128 a[124:127], v5 offset:44032
v_mfma_f32_16x16x32_bf16 v[160:163], a[140:143], a[12:15], v[160:163]
buffer_load_dwordx4 a[4:7], v4, s[40:43], s35 offen offset:1024 sc1
v_mfma_f32_16x16x32_bf16 v[144:147], a[140:143], a[8:11], v[144:147]
s_waitcnt vmcnt(10) lgkmcnt(4)
v_mfma_f32_16x16x32_bf16 v[132:135], a[96:99], a[16:19], v[132:135]
s_cmp_eq_u32 s3, 7
s_cselect_b32 s35, 23, 15
s_lshl_b32 s35, s35, 12
v_mfma_f32_16x16x32_bf16 v[148:151], a[96:99], a[20:23], v[148:151]
ds_read_b128 a[128:131], v5 offset:45056
v_mfma_f32_16x16x32_bf16 v[152:155], a[100:103], a[20:23], v[152:155]
buffer_load_dwordx4 a[8:11], v4, s[40:43], s35 offen offset:0 sc1
v_mfma_f32_16x16x32_bf16 v[136:139], a[100:103], a[16:19], v[136:139]
ds_read_b128 a[132:135], v5 offset:46080
v_mfma_f32_16x16x32_bf16 v[140:143], a[104:107], a[16:19], v[140:143]
ds_read_b128 a[136:139], v5 offset:47104
v_mfma_f32_16x16x32_bf16 v[156:159], a[104:107], a[20:23], v[156:159]
ds_read_b128 a[140:143], v5 offset:48128
v_mfma_f32_16x16x32_bf16 v[160:163], a[108:111], a[20:23], v[160:163]
buffer_load_dwordx4 a[12:15], v4, s[40:43], s35 offen offset:1024 sc1
v_mfma_f32_16x16x32_bf16 v[144:147], a[108:111], a[16:19], v[144:147]
s_waitcnt vmcnt(10) lgkmcnt(4)
v_mfma_f32_16x16x32_bf16 v[132:135], a[112:115], a[24:27], v[132:135]
s_cmp_eq_u32 s3, 0
s_cselect_b32 s35, 24, 16
s_lshl_b32 s35, s35, 12
v_mfma_f32_16x16x32_bf16 v[148:151], a[112:115], a[28:31], v[148:151]
ds_read_b128 a[96:99], v5 offset:49152
v_mfma_f32_16x16x32_bf16 v[152:155], a[116:119], a[28:31], v[152:155]
buffer_load_dwordx4 a[16:19], v4, s[40:43], s35 offen offset:0 sc1
v_mfma_f32_16x16x32_bf16 v[136:139], a[116:119], a[24:27], v[136:139]
ds_read_b128 a[100:103], v5 offset:50176
v_mfma_f32_16x16x32_bf16 v[140:143], a[120:123], a[24:27], v[140:143]
ds_read_b128 a[104:107], v5 offset:51200
v_mfma_f32_16x16x32_bf16 v[156:159], a[120:123], a[28:31], v[156:159]
ds_read_b128 a[108:111], v5 offset:52224
v_mfma_f32_16x16x32_bf16 v[160:163], a[124:127], a[28:31], v[160:163]
buffer_load_dwordx4 a[20:23], v4, s[40:43], s35 offen offset:1024 sc1
v_mfma_f32_16x16x32_bf16 v[144:147], a[124:127], a[24:27], v[144:147]
s_waitcnt vmcnt(10) lgkmcnt(4)
v_mfma_f32_16x16x32_bf16 v[132:135], a[128:131], a[32:35], v[132:135]
s_cmp_eq_u32 s3, 1
s_cselect_b32 s35, 25, 17
s_lshl_b32 s35, s35, 12
v_mfma_f32_16x16x32_bf16 v[148:151], a[128:131], a[36:39], v[148:151]
ds_read_b128 a[112:115], v5 offset:53248
v_mfma_f32_16x16x32_bf16 v[152:155], a[132:135], a[36:39], v[152:155]
buffer_load_dwordx4 a[24:27], v4, s[40:43], s35 offen offset:0 sc1
v_mfma_f32_16x16x32_bf16 v[136:139], a[132:135], a[32:35], v[136:139]
ds_read_b128 a[116:119], v5 offset:54272
v_mfma_f32_16x16x32_bf16 v[140:143], a[136:139], a[32:35], v[140:143]
ds_read_b128 a[120:123], v5 offset:55296
v_mfma_f32_16x16x32_bf16 v[156:159], a[136:139], a[36:39], v[156:159]
ds_read_b128 a[124:127], v5 offset:56320
v_mfma_f32_16x16x32_bf16 v[160:163], a[140:143], a[36:39], v[160:163]
buffer_load_dwordx4 a[28:31], v4, s[40:43], s35 offen offset:1024 sc1
v_mfma_f32_16x16x32_bf16 v[144:147], a[140:143], a[32:35], v[144:147]
s_waitcnt vmcnt(10) lgkmcnt(4)
v_mfma_f32_16x16x32_bf16 v[132:135], a[96:99], a[40:43], v[132:135]
s_cmp_eq_u32 s3, 2
s_cselect_b32 s35, 26, 18
s_lshl_b32 s35, s35, 12
v_mfma_f32_16x16x32_bf16 v[148:151], a[96:99], a[44:47], v[148:151]
ds_read_b128 a[128:131], v5 offset:57344
v_mfma_f32_16x16x32_bf16 v[152:155], a[100:103], a[44:47], v[152:155]
buffer_load_dwordx4 a[32:35], v4, s[40:43], s35 offen offset:0 sc1
v_mfma_f32_16x16x32_bf16 v[136:139], a[100:103], a[40:43], v[136:139]
ds_read_b128 a[132:135], v5 offset:58368
v_mfma_f32_16x16x32_bf16 v[140:143], a[104:107], a[40:43], v[140:143]
ds_read_b128 a[136:139], v5 offset:59392
v_mfma_f32_16x16x32_bf16 v[156:159], a[104:107], a[44:47], v[156:159]
ds_read_b128 a[140:143], v5 offset:60416
v_mfma_f32_16x16x32_bf16 v[160:163], a[108:111], a[44:47], v[160:163]
buffer_load_dwordx4 a[36:39], v4, s[40:43], s35 offen offset:1024 sc1
v_mfma_f32_16x16x32_bf16 v[144:147], a[108:111], a[40:43], v[144:147]
s_waitcnt vmcnt(10) lgkmcnt(4)
v_mfma_f32_16x16x32_bf16 v[132:135], a[112:115], a[48:51], v[132:135]
s_cmp_eq_u32 s3, 3
s_cselect_b32 s35, 27, 19
s_lshl_b32 s35, s35, 12
v_mfma_f32_16x16x32_bf16 v[148:151], a[112:115], a[52:55], v[148:151]
ds_read_b128 a[96:99], v5 offset:61440
v_mfma_f32_16x16x32_bf16 v[152:155], a[116:119], a[52:55], v[152:155]
buffer_load_dwordx4 a[40:43], v4, s[40:43], s35 offen offset:0 sc1
v_mfma_f32_16x16x32_bf16 v[136:139], a[116:119], a[48:51], v[136:139]
ds_read_b128 a[100:103], v5 offset:62464
v_mfma_f32_16x16x32_bf16 v[140:143], a[120:123], a[48:51], v[140:143]
ds_read_b128 a[104:107], v5 offset:63488
v_mfma_f32_16x16x32_bf16 v[156:159], a[120:123], a[52:55], v[156:159]
ds_read_b128 a[108:111], v5 offset:64512
v_mfma_f32_16x16x32_bf16 v[160:163], a[124:127], a[52:55], v[160:163]
buffer_load_dwordx4 a[44:47], v4, s[40:43], s35 offen offset:1024 sc1
v_mfma_f32_16x16x32_bf16 v[144:147], a[124:127], a[48:51], v[144:147]
s_waitcnt vmcnt(10) lgkmcnt(4)
v_mfma_f32_16x16x32_bf16 v[132:135], a[128:131], a[0:3], v[132:135]
s_cmp_eq_u32 s3, 4
s_cselect_b32 s35, 28, 20
s_lshl_b32 s35, s35, 12
v_mfma_f32_16x16x32_bf16 v[148:151], a[128:131], a[4:7], v[148:151]
ds_read_b128 a[112:115], v6 offset:0
v_mfma_f32_16x16x32_bf16 v[152:155], a[132:135], a[4:7], v[152:155]
buffer_load_dwordx4 a[48:51], v4, s[40:43], s35 offen offset:0 sc1
v_mfma_f32_16x16x32_bf16 v[136:139], a[132:135], a[0:3], v[136:139]
ds_read_b128 a[116:119], v6 offset:1024
v_mfma_f32_16x16x32_bf16 v[140:143], a[136:139], a[0:3], v[140:143]
ds_read_b128 a[120:123], v6 offset:2048
v_mfma_f32_16x16x32_bf16 v[156:159], a[136:139], a[4:7], v[156:159]
ds_read_b128 a[124:127], v6 offset:3072
v_mfma_f32_16x16x32_bf16 v[160:163], a[140:143], a[4:7], v[160:163]
buffer_load_dwordx4 a[52:55], v4, s[40:43], s35 offen offset:1024 sc1
v_mfma_f32_16x16x32_bf16 v[144:147], a[140:143], a[0:3], v[144:147]
s_waitcnt vmcnt(10) lgkmcnt(4)
v_mfma_f32_16x16x32_bf16 v[132:135], a[96:99], a[8:11], v[132:135]
s_cmp_eq_u32 s3, 5
s_cselect_b32 s35, 29, 21
s_lshl_b32 s35, s35, 12
v_mfma_f32_16x16x32_bf16 v[148:151], a[96:99], a[12:15], v[148:151]
ds_read_b128 a[128:131], v6 offset:4096
v_mfma_f32_16x16x32_bf16 v[152:155], a[100:103], a[12:15], v[152:155]
buffer_load_dwordx4 a[0:3], v4, s[40:43], s35 offen offset:0 sc1
v_mfma_f32_16x16x32_bf16 v[136:139], a[100:103], a[8:11], v[136:139]
ds_read_b128 a[132:135], v6 offset:5120
v_mfma_f32_16x16x32_bf16 v[140:143], a[104:107], a[8:11], v[140:143]
ds_read_b128 a[136:139], v6 offset:6144
v_mfma_f32_16x16x32_bf16 v[156:159], a[104:107], a[12:15], v[156:159]
ds_read_b128 a[140:143], v6 offset:7168
v_mfma_f32_16x16x32_bf16 v[160:163], a[108:111], a[12:15], v[160:163]
buffer_load_dwordx4 a[4:7], v4, s[40:43], s35 offen offset:1024 sc1
v_mfma_f32_16x16x32_bf16 v[144:147], a[108:111], a[8:11], v[144:147]
s_waitcnt vmcnt(10) lgkmcnt(4)
v_mfma_f32_16x16x32_bf16 v[132:135], a[112:115], a[16:19], v[132:135]
s_cmp_eq_u32 s3, 6
s_cselect_b32 s35, 30, 22
s_lshl_b32 s35, s35, 12
v_mfma_f32_16x16x32_bf16 v[148:151], a[112:115], a[20:23], v[148:151]
ds_read_b128 a[96:99], v6 offset:8192
v_mfma_f32_16x16x32_bf16 v[152:155], a[116:119], a[20:23], v[152:155]
buffer_load_dwordx4 a[8:11], v4, s[40:43], s35 offen offset:0 sc1
v_mfma_f32_16x16x32_bf16 v[136:139], a[116:119], a[16:19], v[136:139]
ds_read_b128 a[100:103], v6 offset:9216
v_mfma_f32_16x16x32_bf16 v[140:143], a[120:123], a[16:19], v[140:143]
ds_read_b128 a[104:107], v6 offset:10240
v_mfma_f32_16x16x32_bf16 v[156:159], a[120:123], a[20:23], v[156:159]
ds_read_b128 a[108:111], v6 offset:11264
v_mfma_f32_16x16x32_bf16 v[160:163], a[124:127], a[20:23], v[160:163]
buffer_load_dwordx4 a[12:15], v4, s[40:43], s35 offen offset:1024 sc1
v_mfma_f32_16x16x32_bf16 v[144:147], a[124:127], a[16:19], v[144:147]
s_waitcnt vmcnt(10) lgkmcnt(4)
v_mfma_f32_16x16x32_bf16 v[132:135], a[128:131], a[24:27], v[132:135]
s_cmp_eq_u32 s3, 7
s_cselect_b32 s35, 31, 23
s_lshl_b32 s35, s35, 12
v_mfma_f32_16x16x32_bf16 v[148:151], a[128:131], a[28:31], v[148:151]
ds_read_b128 a[112:115], v6 offset:12288
v_mfma_f32_16x16x32_bf16 v[152:155], a[132:135], a[28:31], v[152:155]
buffer_load_dwordx4 a[16:19], v4, s[40:43], s35 offen offset:0 sc1
v_mfma_f32_16x16x32_bf16 v[136:139], a[132:135], a[24:27], v[136:139]
ds_read_b128 a[116:119], v6 offset:13312
v_mfma_f32_16x16x32_bf16 v[140:143], a[136:139], a[24:27], v[140:143]
ds_read_b128 a[120:123], v6 offset:14336
v_mfma_f32_16x16x32_bf16 v[156:159], a[136:139], a[28:31], v[156:159]
ds_read_b128 a[124:127], v6 offset:15360
v_mfma_f32_16x16x32_bf16 v[160:163], a[140:143], a[28:31], v[160:163]
buffer_load_dwordx4 a[20:23], v4, s[40:43], s35 offen offset:1024 sc1
v_mfma_f32_16x16x32_bf16 v[144:147], a[140:143], a[24:27], v[144:147]
s_waitcnt vmcnt(10) lgkmcnt(4)
v_mfma_f32_16x16x32_bf16 v[132:135], a[96:99], a[32:35], v[132:135]
s_cmp_eq_u32 s3, 0
s_cselect_b32 s35, 0, 24
s_lshl_b32 s35, s35, 12
v_mfma_f32_16x16x32_bf16 v[148:151], a[96:99], a[36:39], v[148:151]
ds_read_b128 a[128:131], v6 offset:16384
v_mfma_f32_16x16x32_bf16 v[152:155], a[100:103], a[36:39], v[152:155]
buffer_load_dwordx4 a[24:27], v4, s[40:43], s35 offen offset:0 sc1
v_mfma_f32_16x16x32_bf16 v[136:139], a[100:103], a[32:35], v[136:139]
ds_read_b128 a[132:135], v6 offset:17408
v_mfma_f32_16x16x32_bf16 v[140:143], a[104:107], a[32:35], v[140:143]
ds_read_b128 a[136:139], v6 offset:18432
v_mfma_f32_16x16x32_bf16 v[156:159], a[104:107], a[36:39], v[156:159]
ds_read_b128 a[140:143], v6 offset:19456
v_mfma_f32_16x16x32_bf16 v[160:163], a[108:111], a[36:39], v[160:163]
buffer_load_dwordx4 a[28:31], v4, s[40:43], s35 offen offset:1024 sc1
v_mfma_f32_16x16x32_bf16 v[144:147], a[108:111], a[32:35], v[144:147]
s_waitcnt vmcnt(10) lgkmcnt(4)
v_mfma_f32_16x16x32_bf16 v[132:135], a[112:115], a[40:43], v[132:135]
s_cmp_eq_u32 s3, 1
s_cselect_b32 s35, 1, 25
s_lshl_b32 s35, s35, 12
v_mfma_f32_16x16x32_bf16 v[148:151], a[112:115], a[44:47], v[148:151]
ds_read_b128 a[96:99], v6 offset:20480
v_mfma_f32_16x16x32_bf16 v[152:155], a[116:119], a[44:47], v[152:155]
buffer_load_dwordx4 a[32:35], v4, s[40:43], s35 offen offset:0 sc1
v_mfma_f32_16x16x32_bf16 v[136:139], a[116:119], a[40:43], v[136:139]
ds_read_b128 a[100:103], v6 offset:21504
v_mfma_f32_16x16x32_bf16 v[140:143], a[120:123], a[40:43], v[140:143]
ds_read_b128 a[104:107], v6 offset:22528
v_mfma_f32_16x16x32_bf16 v[156:159], a[120:123], a[44:47], v[156:159]
ds_read_b128 a[108:111], v6 offset:23552
v_mfma_f32_16x16x32_bf16 v[160:163], a[124:127], a[44:47], v[160:163]
buffer_load_dwordx4 a[36:39], v4, s[40:43], s35 offen offset:1024 sc1
v_mfma_f32_16x16x32_bf16 v[144:147], a[124:127], a[40:43], v[144:147]
s_waitcnt vmcnt(10) lgkmcnt(4)
v_mfma_f32_16x16x32_bf16 v[132:135], a[128:131], a[48:51], v[132:135]
s_cmp_eq_u32 s3, 2
s_cselect_b32 s35, 2, 26
s_lshl_b32 s35, s35, 12
v_mfma_f32_16x16x32_bf16 v[148:151], a[128:131], a[52:55], v[148:151]
ds_read_b128 a[112:115], v6 offset:24576
v_mfma_f32_16x16x32_bf16 v[152:155], a[132:135], a[52:55], v[152:155]
buffer_load_dwordx4 a[40:43], v4, s[40:43], s35 offen offset:0 sc1
v_mfma_f32_16x16x32_bf16 v[136:139], a[132:135], a[48:51], v[136:139]
ds_read_b128 a[116:119], v6 offset:25600
v_mfma_f32_16x16x32_bf16 v[140:143], a[136:139], a[48:51], v[140:143]
s_add_u32 s88, s67, 0xe0000
s_add_u32 s89, s66, 0xd0000
v_mfma_f32_16x16x32_bf16 v[156:159], a[136:139], a[52:55], v[156:159]
buffer_load_dword v11, v255, s[4:7], s88 offen sc1
v_mfma_f32_16x16x32_bf16 v[160:163], a[140:143], a[52:55], v[160:163]
buffer_load_dwordx4 a[44:47], v4, s[40:43], s35 offen offset:1024 sc1
v_mfma_f32_16x16x32_bf16 v[144:147], a[140:143], a[48:51], v[144:147]
ds_read_b128 a[120:123], v6 offset:26624
ds_read_b128 a[124:127], v6 offset:27648
s_waitcnt vmcnt(11) lgkmcnt(4)
v_mfma_f32_16x16x32_bf16 v[132:135], a[96:99], a[0:3], v[132:135]
s_cmp_eq_u32 s3, 3
s_cselect_b32 s35, 3, 27
s_lshl_b32 s35, s35, 12
v_mfma_f32_16x16x32_bf16 v[148:151], a[96:99], a[4:7], v[148:151]
buffer_load_dword v232, v255, s[4:7], s89 offen offset:64 sc1
v_mfma_f32_16x16x32_bf16 v[152:155], a[100:103], a[4:7], v[152:155]
buffer_load_dwordx4 a[48:51], v4, s[40:43], s35 offen offset:0 sc1
v_mfma_f32_16x16x32_bf16 v[136:139], a[100:103], a[0:3], v[136:139]
ds_read_b128 a[128:131], v6 offset:28672
v_mfma_f32_16x16x32_bf16 v[140:143], a[104:107], a[0:3], v[140:143]
ds_read_b128 a[132:135], v6 offset:29696
v_mfma_f32_16x16x32_bf16 v[156:159], a[104:107], a[4:7], v[156:159]
ds_read_b128 a[136:139], v6 offset:30720
v_mfma_f32_16x16x32_bf16 v[160:163], a[108:111], a[4:7], v[160:163]
buffer_load_dwordx4 a[52:55], v4, s[40:43], s35 offen offset:1024 sc1
v_mfma_f32_16x16x32_bf16 v[144:147], a[108:111], a[0:3], v[144:147]
ds_read_b128 a[140:143], v6 offset:31744
s_waitcnt vmcnt(12) lgkmcnt(4)
v_mfma_f32_16x16x32_bf16 v[132:135], a[112:115], a[8:11], v[132:135]
s_cmp_eq_u32 s3, 4
s_cselect_b32 s35, 4, 28
s_lshl_b32 s35, s35, 12
v_mfma_f32_16x16x32_bf16 v[148:151], a[112:115], a[12:15], v[148:151]
ds_read_b128 a[96:99], v6 offset:32768
v_mfma_f32_16x16x32_bf16 v[152:155], a[116:119], a[12:15], v[152:155]
buffer_load_dwordx4 a[0:3], v4, s[40:43], s35 offen offset:0 sc1
v_mfma_f32_16x16x32_bf16 v[136:139], a[116:119], a[8:11], v[136:139]
ds_read_b128 a[100:103], v6 offset:33792
v_mfma_f32_16x16x32_bf16 v[140:143], a[120:123], a[8:11], v[140:143]
ds_read_b128 a[104:107], v6 offset:34816
v_mfma_f32_16x16x32_bf16 v[156:159], a[120:123], a[12:15], v[156:159]
ds_read_b128 a[108:111], v6 offset:35840
v_mfma_f32_16x16x32_bf16 v[160:163], a[124:127], a[12:15], v[160:163]
buffer_load_dwordx4 a[4:7], v4, s[40:43], s35 offen offset:1024 sc1
v_mfma_f32_16x16x32_bf16 v[144:147], a[124:127], a[8:11], v[144:147]
s_waitcnt vmcnt(12) lgkmcnt(4)
v_mfma_f32_16x16x32_bf16 v[132:135], a[128:131], a[16:19], v[132:135]
s_cmp_eq_u32 s3, 5
s_cselect_b32 s35, 5, 29
s_lshl_b32 s35, s35, 12
v_mfma_f32_16x16x32_bf16 v[148:151], a[128:131], a[20:23], v[148:151]
ds_read_b128 a[112:115], v6 offset:36864
v_mfma_f32_16x16x32_bf16 v[152:155], a[132:135], a[20:23], v[152:155]
buffer_load_dwordx4 a[8:11], v4, s[40:43], s35 offen offset:0 sc1
v_mfma_f32_16x16x32_bf16 v[136:139], a[132:135], a[16:19], v[136:139]
ds_read_b128 a[116:119], v6 offset:37888
v_mfma_f32_16x16x32_bf16 v[140:143], a[136:139], a[16:19], v[140:143]
ds_read_b128 a[120:123], v6 offset:38912
v_mfma_f32_16x16x32_bf16 v[156:159], a[136:139], a[20:23], v[156:159]
ds_read_b128 a[124:127], v6 offset:39936
v_mfma_f32_16x16x32_bf16 v[160:163], a[140:143], a[20:23], v[160:163]
buffer_load_dwordx4 a[12:15], v4, s[40:43], s35 offen offset:1024 sc1
v_mfma_f32_16x16x32_bf16 v[144:147], a[140:143], a[16:19], v[144:147]
s_waitcnt vmcnt(12) lgkmcnt(4)
v_mfma_f32_16x16x32_bf16 v[132:135], a[96:99], a[24:27], v[132:135]
s_cmp_eq_u32 s3, 6
s_cselect_b32 s35, 6, 30
s_lshl_b32 s35, s35, 12
v_mfma_f32_16x16x32_bf16 v[148:151], a[96:99], a[28:31], v[148:151]
ds_read_b128 a[128:131], v6 offset:40960
v_mfma_f32_16x16x32_bf16 v[152:155], a[100:103], a[28:31], v[152:155]
buffer_load_dwordx4 a[16:19], v4, s[40:43], s35 offen offset:0 sc1
v_mfma_f32_16x16x32_bf16 v[136:139], a[100:103], a[24:27], v[136:139]
ds_read_b128 a[132:135], v6 offset:41984
v_mfma_f32_16x16x32_bf16 v[140:143], a[104:107], a[24:27], v[140:143]
ds_read_b128 a[136:139], v6 offset:43008
v_mfma_f32_16x16x32_bf16 v[156:159], a[104:107], a[28:31], v[156:159]
ds_read_b128 a[140:143], v6 offset:44032
v_mfma_f32_16x16x32_bf16 v[160:163], a[108:111], a[28:31], v[160:163]
buffer_load_dwordx4 a[20:23], v4, s[40:43], s35 offen offset:1024 sc1
v_mfma_f32_16x16x32_bf16 v[144:147], a[108:111], a[24:27], v[144:147]
s_waitcnt vmcnt(12) lgkmcnt(4)
v_mfma_f32_16x16x32_bf16 v[132:135], a[112:115], a[32:35], v[132:135]
s_cmp_eq_u32 s3, 7
s_cselect_b32 s35, 7, 31
s_lshl_b32 s35, s35, 12
v_mfma_f32_16x16x32_bf16 v[148:151], a[112:115], a[36:39], v[148:151]
ds_read_b128 a[96:99], v6 offset:45056
v_mfma_f32_16x16x32_bf16 v[152:155], a[116:119], a[36:39], v[152:155]
buffer_load_dwordx4 a[24:27], v4, s[40:43], s35 offen offset:0 sc1
v_mfma_f32_16x16x32_bf16 v[136:139], a[116:119], a[32:35], v[136:139]
ds_read_b128 a[100:103], v6 offset:46080
v_mfma_f32_16x16x32_bf16 v[140:143], a[120:123], a[32:35], v[140:143]
ds_read_b128 a[104:107], v6 offset:47104
v_mfma_f32_16x16x32_bf16 v[156:159], a[120:123], a[36:39], v[156:159]
ds_read_b128 a[108:111], v6 offset:48128
v_mfma_f32_16x16x32_bf16 v[160:163], a[124:127], a[36:39], v[160:163]
buffer_load_dwordx4 a[28:31], v4, s[40:43], s35 offen offset:1024 sc1
v_mfma_f32_16x16x32_bf16 v[144:147], a[124:127], a[32:35], v[144:147]
s_waitcnt vmcnt(11) lgkmcnt(4)
v_cmp_ne_u32 vcc, v11, v15
s_cbranch_vccnz Ltr_9
Lte_11:
v_mfma_f32_16x16x32_bf16 v[132:135], a[128:131], a[40:43], v[132:135]
s_add_u32 m0, s18, 0x0
s_add_u32 s44, s50, 0x1400000
v_mfma_f32_16x16x32_bf16 v[148:151], a[128:131], a[44:47], v[148:151]
ds_read_b128 a[112:115], v6 offset:49152
v_mfma_f32_16x16x32_bf16 v[152:155], a[132:135], a[44:47], v[152:155]
buffer_load_dwordx4 v1, s[4:7], s44 offen offset:0 sc1 lds
v_mfma_f32_16x16x32_bf16 v[136:139], a[132:135], a[40:43], v[136:139]
ds_read_b128 a[116:119], v6 offset:50176
v_mfma_f32_16x16x32_bf16 v[140:143], a[136:139], a[40:43], v[140:143]
ds_read_b128 a[120:123], v6 offset:51200
v_mfma_f32_16x16x32_bf16 v[156:159], a[136:139], a[44:47], v[156:159]
ds_read_b128 a[124:127], v6 offset:52224
v_mfma_f32_16x16x32_bf16 v[160:163], a[140:143], a[44:47], v[160:163]
buffer_load_dwordx4 v1, s[4:7], s44 offen offset:1024 sc1 lds
v_mfma_f32_16x16x32_bf16 v[144:147], a[140:143], a[40:43], v[144:147]
s_waitcnt vmcnt(10) lgkmcnt(4)
v_mfma_f32_16x16x32_bf16 v[132:135], a[96:99], a[48:51], v[132:135]
ds_read_b128 a[128:131], v6 offset:53248
v_mfma_f32_16x16x32_bf16 v[148:151], a[96:99], a[52:55], v[148:151]
ds_read_b128 a[132:135], v6 offset:54272
v_mfma_f32_16x16x32_bf16 v[152:155], a[100:103], a[52:55], v[152:155]
ds_read_b128 a[136:139], v6 offset:55296
v_mfma_f32_16x16x32_bf16 v[136:139], a[100:103], a[48:51], v[136:139]
ds_read_b128 a[140:143], v6 offset:56320
v_mfma_f32_16x16x32_bf16 v[140:143], a[104:107], a[48:51], v[140:143]
buffer_load_dwordx4 v1, s[4:7], s44 offen offset:2048 sc1 lds
s_add_u32 m0, s18, 0x3000
v_mfma_f32_16x16x32_bf16 v[156:159], a[104:107], a[52:55], v[156:159]
s_add_u32 s44, s50, 0x1403000
v_mfma_f32_16x16x32_bf16 v[160:163], a[108:111], a[52:55], v[160:163]
v_mfma_f32_16x16x32_bf16 v[144:147], a[108:111], a[48:51], v[144:147]
s_waitcnt vmcnt(9) lgkmcnt(4)
v_mfma_f32_16x16x32_bf16 v[132:135], a[112:115], a[0:3], v[132:135]
ds_read_b128 a[96:99], v6 offset:57344
v_mfma_f32_16x16x32_bf16 v[148:151], a[112:115], a[4:7], v[148:151]
ds_read_b128 a[100:103], v6 offset:58368
v_mfma_f32_16x16x32_bf16 v[152:155], a[116:119], a[4:7], v[152:155]
ds_read_b128 a[104:107], v6 offset:59392
v_mfma_f32_16x16x32_bf16 v[136:139], a[116:119], a[0:3], v[136:139]
buffer_load_dwordx4 v1, s[4:7], s44 offen offset:0 sc1 lds
v_mfma_f32_16x16x32_bf16 v[140:143], a[120:123], a[0:3], v[140:143]
ds_read_b128 a[108:111], v6 offset:60416
v_mfma_f32_16x16x32_bf16 v[156:159], a[120:123], a[4:7], v[156:159]
v_mfma_f32_16x16x32_bf16 v[160:163], a[124:127], a[4:7], v[160:163]
v_mfma_f32_16x16x32_bf16 v[144:147], a[124:127], a[0:3], v[144:147]
s_waitcnt vmcnt(8) lgkmcnt(4)
v_mfma_f32_16x16x32_bf16 v[132:135], a[128:131], a[8:11], v[132:135]
ds_read_b128 a[112:115], v6 offset:61440
v_mfma_f32_16x16x32_bf16 v[148:151], a[128:131], a[12:15], v[148:151]
buffer_load_dwordx4 v1, s[4:7], s44 offen offset:1024 sc1 lds
v_mfma_f32_16x16x32_bf16 v[152:155], a[132:135], a[12:15], v[152:155]
ds_read_b128 a[116:119], v6 offset:62464
v_mfma_f32_16x16x32_bf16 v[136:139], a[132:135], a[8:11], v[136:139]
ds_read_b128 a[120:123], v6 offset:63488
v_mfma_f32_16x16x32_bf16 v[140:143], a[136:139], a[8:11], v[140:143]
ds_read_b128 a[124:127], v6 offset:64512
v_mfma_f32_16x16x32_bf16 v[156:159], a[136:139], a[12:15], v[156:159]
v_mfma_f32_16x16x32_bf16 v[160:163], a[140:143], a[12:15], v[160:163]
v_mfma_f32_16x16x32_bf16 v[144:147], a[140:143], a[8:11], v[144:147]
buffer_load_dwordx4 v1, s[4:7], s44 offen offset:2048 sc1 lds
s_waitcnt vmcnt(8) lgkmcnt(4)
v_mfma_f32_16x16x32_bf16 v[132:135], a[96:99], a[16:19], v[132:135]
v_mfma_f32_16x16x32_bf16 v[148:151], a[96:99], a[20:23], v[148:151]
v_mfma_f32_16x16x32_bf16 v[152:155], a[100:103], a[20:23], v[152:155]
v_mfma_f32_16x16x32_bf16 v[136:139], a[100:103], a[16:19], v[136:139]
v_mfma_f32_16x16x32_bf16 v[140:143], a[104:107], a[16:19], v[140:143]
v_mfma_f32_16x16x32_bf16 v[156:159], a[104:107], a[20:23], v[156:159]
v_mfma_f32_16x16x32_bf16 v[160:163], a[108:111], a[20:23], v[160:163]
v_mfma_f32_16x16x32_bf16 v[144:147], a[108:111], a[16:19], v[144:147]
s_waitcnt vmcnt(6) lgkmcnt(0)
v_mfma_f32_16x16x32_bf16 v[132:135], a[112:115], a[24:27], v[132:135]
v_mfma_f32_16x16x32_bf16 v[148:151], a[112:115], a[28:31], v[148:151]
v_mfma_f32_16x16x32_bf16 v[152:155], a[116:119], a[28:31], v[152:155]
v_mfma_f32_16x16x32_bf16 v[136:139], a[116:119], a[24:27], v[136:139]
v_mfma_f32_16x16x32_bf16 v[140:143], a[120:123], a[24:27], v[140:143]
v_mfma_f32_16x16x32_bf16 v[156:159], a[120:123], a[28:31], v[156:159]
v_mfma_f32_16x16x32_bf16 v[160:163], a[124:127], a[28:31], v[160:163]
v_mfma_f32_16x16x32_bf16 v[144:147], a[124:127], a[24:27], v[144:147]
s_lshl_b32 s36, s32, 13
v_cvt_pk_bf16_f32 v32, v132, v133
v_cvt_pk_bf16_f32 v33, v134, v135
s_nop 0
v_cvt_pk_bf16_f32 v34, v136, v137
v_cvt_pk_bf16_f32 v35, v138, v139
s_add_u32 s36, s36, 0x2200000
buffer_store_dwordx4 v[32:35], v4, s[4:7], s36 offen offset:0 sc1
v_cvt_pk_bf16_f32 v40, v148, v149
v_cvt_pk_bf16_f32 v41, v150, v151
v_cvt_pk_bf16_f32 v42, v152, v153
v_cvt_pk_bf16_f32 v43, v154, v155
v_cvt_pk_bf16_f32 v36, v140, v141
v_cvt_pk_bf16_f32 v37, v142, v143
v_cvt_pk_bf16_f32 v38, v144, v145
v_cvt_pk_bf16_f32 v39, v146, v147
s_add_u32 s37, s36, 4096
v_cvt_pk_bf16_f32 v44, v156, v157
v_cvt_pk_bf16_f32 v45, v158, v159
v_cvt_pk_bf16_f32 v46, v160, v161
buffer_store_dwordx4 v[40:43], v4, s[4:7], s36 offen offset:1024 sc1
v_cvt_pk_bf16_f32 v47, v162, v163
v_mfma_f32_16x16x32_bf16 v[96:99], v[32:35], v[32:35], 0
s_mov_b32 s38, 0x240000
s_add_u32 s92, s78, 0x40000
v_mfma_f32_16x16x32_bf16 v[92:95], v[16:19], v[32:35], 0
s_add_u32 s93, s79, 0x40000
s_add_u32 s40, s4, 0x2200000
v_mfma_f32_16x16x32_bf16 v[96:99], v[36:39], v[36:39], v[96:99]
s_addc_u32 s41, s5, 0
buffer_store_dwordx4 v[36:39], v4, s[4:7], s37 offen offset:0 sc1
v_mfma_f32_16x16x32_bf16 v[92:95], v[16:19], v[36:39], v[92:95]
s_nop 4
v_cndmask_b32 v96, v96, v97, s[46:47]
v_cndmask_b32 v98, v98, v99, s[46:47]
v_mfma_f32_16x16x32_bf16 v[104:107], v[40:43], v[40:43], 0
v_mfma_f32_16x16x32_bf16 v[100:103], v[16:19], v[40:43], 0
v_cndmask_b32 v93, v96, v98, s[48:49]
buffer_store_dwordx4 v[44:47], v4, s[4:7], s37 offen offset:1024 sc1
v_mfma_f32_16x16x32_bf16 v[104:107], v[44:47], v[44:47], v[104:107]
v_mfma_f32_16x16x32_bf16 v[100:103], v[16:19], v[44:47], v[100:103]
s_nop 6
v_cndmask_b32 v104, v104, v105, s[46:47]
v_cndmask_b32 v106, v106, v107, s[46:47]
buffer_store_dwordx2 v[92:93], v253, s[4:7], s38 offen offset:0 sc1
v_cndmask_b32 v101, v104, v106, s[48:49]
buffer_store_dwordx2 v[100:101], v253, s[4:7], s38 offen offset:2048 sc1
v_cmp_ne_u32 vcc, v232, v15
s_cbranch_vccnz Ltr_12
Lte_14:
s_barrier
s_add_u32 m0, s18, 0x6000
s_add_u32 s44, s50, 0x1406000
buffer_load_dwordx4 v1, s[4:7], s44 offen offset:0 sc1 lds
buffer_load_dwordx4 v1, s[4:7], s44 offen offset:1024 sc1 lds
buffer_load_dwordx4 v1, s[4:7], s44 offen offset:2048 sc1 lds
s_add_u32 m0, s18, 0x9000
s_add_u32 s44, s50, 0x1409000
buffer_load_dwordx4 v1, s[4:7], s44 offen offset:0 sc1 lds
buffer_load_dwordx4 v1, s[4:7], s44 offen offset:1024 sc1 lds
buffer_load_dwordx4 v1, s[4:7], s44 offen offset:2048 sc1 lds
s_waitcnt vmcnt(6)
s_barrier
s_cmp_lg_u32 s28, 0
s_cbranch_scc1 Lsg_15
buffer_atomic_add v12, v10, s[4:7], s92 offen sc1
Lsg_15:
s_mov_b64 exec, 0
s_cmp_eq_u32 s28, 0
s_cbranch_scc1 L_stub4
L_wret2:
s_mov_b64 exec, -1
s_cmp_lt_u32 s28, 2
s_cbranch_scc1 Lwd_16
s_add_u32 m0, s18, 0xa800
s_add_u32 s44, s50, 0x140a800
buffer_load_dwordx4 v1, s[4:7], s44 offen offset:0 sc1 lds
buffer_load_dwordx4 v1, s[4:7], s44 offen offset:1024 sc1 lds
buffer_load_dwordx4 v1, s[4:7], s44 offen offset:2048 sc1 lds
s_add_u32 m0, s18, 0xc000
s_add_u32 s44, s50, 0x140c000
buffer_load_dwordx4 v1, s[4:7], s44 offen offset:0 sc1 lds
buffer_load_dwordx4 v1, s[4:7], s44 offen offset:1024 sc1 lds
buffer_load_dwordx4 v1, s[4:7], s44 offen offset:2048 sc1 lds
s_add_u32 m0, s18, 0xd800
s_add_u32 s44, s50, 0x140d800
buffer_load_dwordx4 v1, s[4:7], s44 offen offset:0 sc1 lds
buffer_load_dwordx4 v1, s[4:7], s44 offen offset:1024 sc1 lds
buffer_load_dwordx4 v1, s[4:7], s44 offen offset:2048 sc1 lds
s_add_u32 m0, s18, 0xf000
s_add_u32 s44, s50, 0x140f000
buffer_load_dwordx4 v1, s[4:7], s44 offen offset:0 sc1 lds
buffer_load_dwordx4 v1, s[4:7], s44 offen offset:1024 sc1 lds
buffer_load_dwordx4 v1, s[4:7], s44 offen offset:2048 sc1 lds
s_add_u32 m0, s18, 0x10800
s_add_u32 s44, s50, 0x1410800
buffer_load_dwordx4 v1, s[4:7], s44 offen offset:0 sc1 lds
buffer_load_dwordx4 v1, s[4:7], s44 offen offset:1024 sc1 lds
buffer_load_dwordx4 v1, s[4:7], s44 offen offset:2048 sc1 lds
s_add_u32 m0, s18, 0x12000
s_add_u32 s44, s50, 0x1412000
buffer_load_dwordx4 v1, s[4:7], s44 offen offset:0 sc1 lds
buffer_load_dwordx4 v1, s[4:7], s44 offen offset:1024 sc1 lds
buffer_load_dwordx4 v1, s[4:7], s44 offen offset:2048 sc1 lds
s_add_u32 m0, s18, 0x13800
s_add_u32 s44, s50, 0x1413800
buffer_load_dwordx4 v1, s[4:7], s44 offen offset:0 sc1 lds
buffer_load_dwordx4 v1, s[4:7], s44 offen offset:1024 sc1 lds
buffer_load_dwordx4 v1, s[4:7], s44 offen offset:2048 sc1 lds
s_add_u32 m0, s18, 0x15000
s_add_u32 s44, s50, 0x1415000
buffer_load_dwordx4 v1, s[4:7], s44 offen offset:0 sc1 lds
buffer_load_dwordx4 v1, s[4:7], s44 offen offset:1024 sc1 lds
buffer_load_dwordx4 v1, s[4:7], s44 offen offset:2048 sc1 lds
s_add_u32 m0, s18, 0x16800
s_add_u32 s44, s50, 0x1416800
buffer_load_dwordx4 v1, s[4:7], s44 offen offset:0 sc1 lds
buffer_load_dwordx4 v1, s[4:7], s44 offen offset:1024 sc1 lds
buffer_load_dwordx4 v1, s[4:7], s44 offen offset:2048 sc1 lds
s_add_u32 m0, s18, 0x18000
s_add_u32 s44, s50, 0x1418000
buffer_load_dwordx4 v1, s[4:7], s44 offen offset:0 sc1 lds
buffer_load_dwordx4 v1, s[4:7], s44 offen offset:1024 sc1 lds
buffer_load_dwordx4 v1, s[4:7], s44 offen offset:2048 sc1 lds
Lwd_16:
s_cmp_lg_u32 s28, 1
s_cbranch_scc1 Lpo_19
s_add_u32 s36, s67, 0x40000
s_mov_b32 s37, 0
v_mov_b32 v11, 0
buffer_atomic_add v11, v251, s[4:7], s36 offen sc0 sc1
s_sleep 4
Lpoll_17:
v_mov_b32 v234, 0
buffer_atomic_add v234, v251, s[4:7], s36 offen sc0 sc1
s_waitcnt vmcnt(1)
v_readfirstlane_b32 s38, v11
s_nop 0
s_cmp_ge_u32 s38, 32
s_cbranch_scc1 Lpe_18
v_mov_b32 v11, 0
buffer_atomic_add v11, v251, s[4:7], s36 offen sc0 sc1
s_waitcnt vmcnt(1)
v_readfirstlane_b32 s38, v234
s_nop 0
s_cmp_ge_u32 s38, 32
s_cbranch_scc1 Lpe_18
s_add_u32 s37, s37, 1
s_cmp_lt_u32 s37, 0x80000
s_cbranch_scc1 Lpoll_17
s_waitcnt vmcnt(0)
Lpo_19:
s_waitcnt vmcnt(30) lgkmcnt(0)
s_cmp_ge_u32 s28, 2
s_cbranch_scc1 Lw_20
s_waitcnt vmcnt(0)
Lw_20:
Lpe_18:
s_barrier
s_add_u32 s9, s66, 0x10080
s_mov_b32 s35, 0
s_mov_b32 s33, 0x1000
buffer_load_dwordx4 a[0:3], v2, s[40:43], s35 offen offset:0 sc1
buffer_load_dwordx4 a[4:7], v2, s[40:43], s33 offen offset:0 sc1
buffer_load_dwordx4 a[8:11], v2, s[40:43], s35 offen offset:1024 sc1
buffer_load_dwordx4 a[12:15], v2, s[40:43], s33 offen offset:1024 sc1
buffer_load_dwordx4 a[16:19], v2, s[40:43], s35 offen offset:2048 sc1
buffer_load_dwordx4 a[20:23], v2, s[40:43], s33 offen offset:2048 sc1
buffer_load_dwordx4 a[24:27], v2, s[40:43], s35 offen offset:3072 sc1
buffer_load_dwordx4 a[28:31], v2, s[40:43], s33 offen offset:3072 sc1
s_add_u32 s35, s35, 8192
s_add_u32 s33, s33, 8192
buffer_load_dwordx4 a[32:35], v2, s[40:43], s35 offen offset:0 sc1
buffer_load_dwordx4 a[36:39], v2, s[40:43], s33 offen offset:0 sc1
buffer_load_dwordx4 a[40:43], v2, s[40:43], s35 offen offset:1024 sc1
buffer_load_dwordx4 a[44:47], v2, s[40:43], s33 offen offset:1024 sc1
buffer_load_dwordx4 a[48:51], v2, s[40:43], s35 offen offset:2048 sc1
buffer_load_dwordx4 a[52:55], v2, s[40:43], s33 offen offset:2048 sc1
L_stub4:
s_cbranch_execz L_stub5
buffer_load_dwordx4 a[56:59], v2, s[40:43], s35 offen offset:3072 sc1
buffer_load_dwordx4 a[60:63], v2, s[40:43], s33 offen offset:3072 sc1
s_add_u32 s35, s35, 8192
s_add_u32 s33, s33, 8192
v_add_u32 v5, 0, v1
ds_read_b128 a[96:99], v5 offset:2048
ds_read_b128 a[100:103], v5 offset:8192
ds_read_b128 a[104:107], v5 offset:3072
ds_read_b128 a[108:111], v5 offset:9216
ds_read_b128 a[112:115], v5 offset:4096
ds_read_b128 a[116:119], v5 offset:10240
s_waitcnt vmcnt(14) lgkmcnt(4)
v_mfma_f32_16x16x32_bf16 v[140:143], a[96:99], a[0:3], 0
v_and_b32 v232, 15, v0
v_lshlrev_b32 v232, 7, v232
v_mfma_f32_16x16x32_bf16 v[140:143], a[100:103], a[4:7], v[140:143]
buffer_load_dwordx4 a[64:67], v2, s[40:43], s35 offen offset:0 sc1
s_waitcnt vmcnt(13)
v_mfma_f32_16x16x32_bf16 v[164:167], a[100:103], a[12:15], 0
v_lshrrev_b32 v233, 4, v0
v_lshlrev_b32 v233, 4, v233
v_mfma_f32_16x16x32_bf16 v[164:167], a[96:99], a[8:11], v[164:167]
v_add_u32 v232, v233, v232
s_mul_i32 s38, s30, 12288
s_waitcnt vmcnt(12)
v_mfma_f32_16x16x32_bf16 v[188:191], a[96:99], a[16:19], 0
s_add_u32 s38, s38, 0x380000
s_add_u32 s39, s28, 4
s_min_u32 s39, s39, 5
s_waitcnt vmcnt(11)
v_mfma_f32_16x16x32_bf16 v[188:191], a[100:103], a[20:23], v[188:191]
buffer_load_dwordx4 a[68:71], v2, s[40:43], s33 offen offset:0 sc1
s_lshl_b32 s36, s28, 11
s_waitcnt vmcnt(10)
v_mfma_f32_16x16x32_bf16 v[212:215], a[100:103], a[28:31], 0
s_add_u32 s36, s36, s38
s_lshl_b32 s37, s39, 11
s_add_u32 s37, s37, s38
v_mfma_f32_16x16x32_bf16 v[212:215], a[96:99], a[24:27], v[212:215]
ds_read_b128 a[128:131], v5 offset:5120
s_waitcnt lgkmcnt(4)
v_mfma_f32_16x16x32_bf16 v[216:219], a[104:107], a[24:27], 0
ds_read_b128 a[132:135], v5 offset:11264
s_waitcnt lgkmcnt(4)
v_mfma_f32_16x16x32_bf16 v[216:219], a[108:111], a[28:31], v[216:219]
ds_read_b128 a[136:139], v5 offset:0
v_mfma_f32_16x16x32_bf16 v[192:195], a[108:111], a[20:23], 0
buffer_load_dwordx4 v[48:51], v232, s[4:7], s36 offen sc1
v_mfma_f32_16x16x32_bf16 v[192:195], a[104:107], a[16:19], v[192:195]
ds_read_b128 a[140:143], v5 offset:6144
v_mfma_f32_16x16x32_bf16 v[168:171], a[104:107], a[8:11], 0
ds_read_b128 a[144:147], v5 offset:1024
v_mfma_f32_16x16x32_bf16 v[168:171], a[108:111], a[12:15], v[168:171]
ds_read_b128 a[148:151], v5 offset:7168
v_mfma_f32_16x16x32_bf16 v[144:147], a[108:111], a[4:7], 0
v_mfma_f32_16x16x32_bf16 v[144:147], a[104:107], a[0:3], v[144:147]
buffer_load_dwordx4 a[72:75], v2, s[40:43], s35 offen offset:1024 sc1
s_waitcnt lgkmcnt(7)
v_mfma_f32_16x16x32_bf16 v[148:151], a[112:115], a[0:3], 0
s_waitcnt lgkmcnt(6)
v_mfma_f32_16x16x32_bf16 v[148:151], a[116:119], a[4:7], v[148:151]
v_mfma_f32_16x16x32_bf16 v[172:175], a[116:119], a[12:15], 0
v_mfma_f32_16x16x32_bf16 v[172:175], a[112:115], a[8:11], v[172:175]
v_mfma_f32_16x16x32_bf16 v[196:199], a[112:115], a[16:19], 0
buffer_load_dwordx4 a[76:79], v2, s[40:43], s33 offen offset:1024 sc1
v_mfma_f32_16x16x32_bf16 v[196:199], a[116:119], a[20:23], v[196:199]
v_mfma_f32_16x16x32_bf16 v[220:223], a[116:119], a[28:31], 0
v_mfma_f32_16x16x32_bf16 v[220:223], a[112:115], a[24:27], v[220:223]
s_waitcnt lgkmcnt(0)
v_mfma_f32_16x16x32_bf16 v[224:227], a[128:131], a[24:27], 0
ds_read_b128 a[96:99], v5 offset:14336
v_mfma_f32_16x16x32_bf16 v[224:227], a[132:135], a[28:31], v[224:227]
buffer_load_dwordx4 a[80:83], v2, s[40:43], s35 offen offset:2048 sc1
v_mfma_f32_16x16x32_bf16 v[200:203], a[132:135], a[20:23], 0
ds_read_b128 a[100:103], v5 offset:20480
v_mfma_f32_16x16x32_bf16 v[200:203], a[128:131], a[16:19], v[200:203]
v_mfma_f32_16x16x32_bf16 v[176:179], a[128:131], a[8:11], 0
v_mfma_f32_16x16x32_bf16 v[176:179], a[132:135], a[12:15], v[176:179]
buffer_load_dwordx4 a[84:87], v2, s[40:43], s33 offen offset:2048 sc1
v_mfma_f32_16x16x32_bf16 v[152:155], a[132:135], a[4:7], 0
ds_read_b128 a[104:107], v5 offset:15360
v_mfma_f32_16x16x32_bf16 v[152:155], a[128:131], a[0:3], v[152:155]
v_mfma_f32_16x16x32_bf16 v[132:135], a[136:139], a[0:3], 0
ds_read_b128 a[108:111], v5 offset:21504
v_mfma_f32_16x16x32_bf16 v[132:135], a[140:143], a[4:7], v[132:135]
v_mfma_f32_16x16x32_bf16 v[156:159], a[140:143], a[12:15], 0
buffer_load_dwordx4 v[52:55], v232, s[4:7], s37 offen sc1
s_add_u32 m0, s18, 0x1b000
v_mfma_f32_16x16x32_bf16 v[156:159], a[136:139], a[8:11], v[156:159]
s_add_u32 s44, s50, 0x141b000
ds_read_b128 a[112:115], v5 offset:16384
v_mfma_f32_16x16x32_bf16 v[180:183], a[136:139], a[16:19], 0
v_mfma_f32_16x16x32_bf16 v[180:183], a[140:143], a[20:23], v[180:183]
ds_read_b128 a[116:119], v5 offset:22528
v_mfma_f32_16x16x32_bf16 v[204:207], a[140:143], a[28:31], 0
v_mfma_f32_16x16x32_bf16 v[204:207], a[136:139], a[24:27], v[204:207]
buffer_load_dwordx4 a[88:91], v2, s[40:43], s35 offen offset:3072 sc1
v_mfma_f32_16x16x32_bf16 v[208:211], a[144:147], a[24:27], 0
v_mfma_f32_16x16x32_bf16 v[208:211], a[148:151], a[28:31], v[208:211]
v_mfma_f32_16x16x32_bf16 v[184:187], a[148:151], a[20:23], 0
v_mfma_f32_16x16x32_bf16 v[184:187], a[144:147], a[16:19], v[184:187]
v_mfma_f32_16x16x32_bf16 v[160:163], a[144:147], a[8:11], 0
buffer_load_dwordx4 a[92:95], v2, s[40:43], s33 offen offset:3072 sc1
s_add_u32 s35, s35, 8192
v_mfma_f32_16x16x32_bf16 v[160:163], a[148:151], a[12:15], v[160:163]
s_add_u32 s33, s33, 8192
v_mfma_f32_16x16x32_bf16 v[136:139], a[148:151], a[4:7], 0
v_mfma_f32_16x16x32_bf16 v[136:139], a[144:147], a[0:3], v[136:139]
s_waitcnt vmcnt(10) lgkmcnt(0)
v_mfma_f32_16x16x32_bf16 v[140:143], a[96:99], a[32:35], v[140:143]
ds_read_b128 a[128:131], v5 offset:17408
v_mfma_f32_16x16x32_bf16 v[140:143], a[100:103], a[36:39], v[140:143]
buffer_load_dwordx4 a[0:3], v2, s[40:43], s35 offen offset:0 sc1
v_mfma_f32_16x16x32_bf16 v[164:167], a[100:103], a[44:47], v[164:167]
ds_read_b128 a[132:135], v5 offset:23552
v_mfma_f32_16x16x32_bf16 v[164:167], a[96:99], a[40:43], v[164:167]
v_mfma_f32_16x16x32_bf16 v[188:191], a[96:99], a[48:51], v[188:191]
v_mfma_f32_16x16x32_bf16 v[188:191], a[100:103], a[52:55], v[188:191]
buffer_load_dwordx4 v1, s[4:7], s44 offen offset:0 sc1 lds
v_mfma_f32_16x16x32_bf16 v[212:215], a[100:103], a[60:63], v[212:215]
ds_read_b128 a[136:139], v5 offset:12288
v_mfma_f32_16x16x32_bf16 v[212:215], a[96:99], a[56:59], v[212:215]
v_mfma_f32_16x16x32_bf16 v[216:219], a[104:107], a[56:59], v[216:219]
ds_read_b128 a[140:143], v5 offset:18432
v_mfma_f32_16x16x32_bf16 v[216:219], a[108:111], a[60:63], v[216:219]
buffer_load_dwordx4 a[4:7], v2, s[40:43], s33 offen offset:0 sc1
v_mfma_f32_16x16x32_bf16 v[192:195], a[108:111], a[52:55], v[192:195]
ds_read_b128 a[144:147], v5 offset:13312
v_mfma_f32_16x16x32_bf16 v[192:195], a[104:107], a[48:51], v[192:195]
v_mfma_f32_16x16x32_bf16 v[168:171], a[104:107], a[40:43], v[168:171]
v_mfma_f32_16x16x32_bf16 v[168:171], a[108:111], a[44:47], v[168:171]
buffer_load_dwordx4 a[8:11], v2, s[40:43], s35 offen offset:1024 sc1
v_mfma_f32_16x16x32_bf16 v[144:147], a[108:111], a[36:39], v[144:147]
ds_read_b128 a[148:151], v5 offset:19456
v_mfma_f32_16x16x32_bf16 v[144:147], a[104:107], a[32:35], v[144:147]
v_mfma_f32_16x16x32_bf16 v[148:151], a[112:115], a[32:35], v[148:151]
v_mfma_f32_16x16x32_bf16 v[148:151], a[116:119], a[36:39], v[148:151]
buffer_load_dwordx4 v1, s[4:7], s44 offen offset:1024 sc1 lds
v_mfma_f32_16x16x32_bf16 v[172:175], a[116:119], a[44:47], v[172:175]
v_mfma_f32_16x16x32_bf16 v[172:175], a[112:115], a[40:43], v[172:175]
v_mfma_f32_16x16x32_bf16 v[196:199], a[112:115], a[48:51], v[196:199]
v_mfma_f32_16x16x32_bf16 v[196:199], a[116:119], a[52:55], v[196:199]
buffer_load_dwordx4 a[12:15], v2, s[40:43], s33 offen offset:1024 sc1
v_mfma_f32_16x16x32_bf16 v[220:223], a[116:119], a[60:63], v[220:223]
v_mfma_f32_16x16x32_bf16 v[220:223], a[112:115], a[56:59], v[220:223]
s_waitcnt lgkmcnt(0)
v_mfma_f32_16x16x32_bf16 v[224:227], a[128:131], a[56:59], v[224:227]
ds_read_b128 a[96:99], v5 offset:26624
v_mfma_f32_16x16x32_bf16 v[224:227], a[132:135], a[60:63], v[224:227]
buffer_load_dwordx4 a[16:19], v2, s[40:43], s35 offen offset:2048 sc1
v_mfma_f32_16x16x32_bf16 v[200:203], a[132:135], a[52:55], v[200:203]
ds_read_b128 a[100:103], v5 offset:32768
v_mfma_f32_16x16x32_bf16 v[200:203], a[128:131], a[48:51], v[200:203]
v_mfma_f32_16x16x32_bf16 v[176:179], a[128:131], a[40:43], v[176:179]
v_mfma_f32_16x16x32_bf16 v[176:179], a[132:135], a[44:47], v[176:179]
buffer_load_dwordx4 a[20:23], v2, s[40:43], s33 offen offset:2048 sc1
v_mfma_f32_16x16x32_bf16 v[152:155], a[132:135], a[36:39], v[152:155]
ds_read_b128 a[104:107], v5 offset:27648
v_mfma_f32_16x16x32_bf16 v[152:155], a[128:131], a[32:35], v[152:155]
v_mfma_f32_16x16x32_bf16 v[132:135], a[136:139], a[32:35], v[132:135]
ds_read_b128 a[108:111], v5 offset:33792
v_mfma_f32_16x16x32_bf16 v[132:135], a[140:143], a[36:39], v[132:135]
v_mfma_f32_16x16x32_bf16 v[156:159], a[140:143], a[44:47], v[156:159]
buffer_load_dwordx4 v1, s[4:7], s44 offen offset:2048 sc1 lds
s_add_u32 m0, s18, 0x1e000
v_mfma_f32_16x16x32_bf16 v[156:159], a[136:139], a[40:43], v[156:159]
s_add_u32 s44, s50, 0x141e000
ds_read_b128 a[112:115], v5 offset:28672
v_mfma_f32_16x16x32_bf16 v[180:183], a[136:139], a[48:51], v[180:183]
v_mfma_f32_16x16x32_bf16 v[180:183], a[140:143], a[52:55], v[180:183]
ds_read_b128 a[116:119], v5 offset:34816
v_mfma_f32_16x16x32_bf16 v[204:207], a[140:143], a[60:63], v[204:207]
v_mfma_f32_16x16x32_bf16 v[204:207], a[136:139], a[56:59], v[204:207]
buffer_load_dwordx4 a[24:27], v2, s[40:43], s35 offen offset:3072 sc1
v_mfma_f32_16x16x32_bf16 v[208:211], a[144:147], a[56:59], v[208:211]
v_mfma_f32_16x16x32_bf16 v[208:211], a[148:151], a[60:63], v[208:211]
v_mfma_f32_16x16x32_bf16 v[184:187], a[148:151], a[52:55], v[184:187]
v_mfma_f32_16x16x32_bf16 v[184:187], a[144:147], a[48:51], v[184:187]
v_mfma_f32_16x16x32_bf16 v[160:163], a[144:147], a[40:43], v[160:163]
buffer_load_dwordx4 a[28:31], v2, s[40:43], s33 offen offset:3072 sc1
s_add_u32 s35, s35, 8192
v_mfma_f32_16x16x32_bf16 v[160:163], a[148:151], a[44:47], v[160:163]
s_add_u32 s33, s33, 8192
v_mfma_f32_16x16x32_bf16 v[136:139], a[148:151], a[36:39], v[136:139]
v_mfma_f32_16x16x32_bf16 v[136:139], a[144:147], a[32:35], v[136:139]
s_waitcnt vmcnt(11) lgkmcnt(0)
v_mfma_f32_16x16x32_bf16 v[140:143], a[96:99], a[64:67], v[140:143]
ds_read_b128 a[128:131], v5 offset:29696
v_mfma_f32_16x16x32_bf16 v[140:143], a[100:103], a[68:71], v[140:143]
buffer_load_dwordx4 a[32:35], v2, s[40:43], s35 offen offset:0 sc1
v_mfma_f32_16x16x32_bf16 v[164:167], a[100:103], a[76:79], v[164:167]
ds_read_b128 a[132:135], v5 offset:35840
v_mfma_f32_16x16x32_bf16 v[164:167], a[96:99], a[72:75], v[164:167]
v_mfma_f32_16x16x32_bf16 v[188:191], a[96:99], a[80:83], v[188:191]
v_mfma_f32_16x16x32_bf16 v[188:191], a[100:103], a[84:87], v[188:191]
buffer_load_dwordx4 a[36:39], v2, s[40:43], s33 offen offset:0 sc1
v_mfma_f32_16x16x32_bf16 v[212:215], a[100:103], a[92:95], v[212:215]
ds_read_b128 a[136:139], v5 offset:24576
v_mfma_f32_16x16x32_bf16 v[212:215], a[96:99], a[88:91], v[212:215]
v_mfma_f32_16x16x32_bf16 v[216:219], a[104:107], a[88:91], v[216:219]
ds_read_b128 a[140:143], v5 offset:30720
v_mfma_f32_16x16x32_bf16 v[216:219], a[108:111], a[92:95], v[216:219]
v_mfma_f32_16x16x32_bf16 v[192:195], a[108:111], a[84:87], v[192:195]
buffer_load_dwordx4 v1, s[4:7], s44 offen offset:0 sc1 lds
v_mfma_f32_16x16x32_bf16 v[192:195], a[104:107], a[80:83], v[192:195]
ds_read_b128 a[144:147], v5 offset:25600
v_mfma_f32_16x16x32_bf16 v[168:171], a[104:107], a[72:75], v[168:171]
v_mfma_f32_16x16x32_bf16 v[168:171], a[108:111], a[76:79], v[168:171]
ds_read_b128 a[148:151], v5 offset:31744
v_mfma_f32_16x16x32_bf16 v[144:147], a[108:111], a[68:71], v[144:147]
v_mfma_f32_16x16x32_bf16 v[144:147], a[104:107], a[64:67], v[144:147]
buffer_load_dwordx4 a[40:43], v2, s[40:43], s35 offen offset:1024 sc1
v_mfma_f32_16x16x32_bf16 v[148:151], a[112:115], a[64:67], v[148:151]
v_mfma_f32_16x16x32_bf16 v[148:151], a[116:119], a[68:71], v[148:151]
v_mfma_f32_16x16x32_bf16 v[172:175], a[116:119], a[76:79], v[172:175]
v_mfma_f32_16x16x32_bf16 v[172:175], a[112:115], a[72:75], v[172:175]
v_mfma_f32_16x16x32_bf16 v[196:199], a[112:115], a[80:83], v[196:199]
buffer_load_dwordx4 a[44:47], v2, s[40:43], s33 offen offset:1024 sc1
v_mfma_f32_16x16x32_bf16 v[196:199], a[116:119], a[84:87], v[196:199]
v_mfma_f32_16x16x32_bf16 v[220:223], a[116:119], a[92:95], v[220:223]
v_mfma_f32_16x16x32_bf16 v[220:223], a[112:115], a[88:91], v[220:223]
s_waitcnt lgkmcnt(0)
v_mfma_f32_16x16x32_bf16 v[224:227], a[128:131], a[88:91], v[224:227]
ds_read_b128 a[96:99], v5 offset:38912
v_mfma_f32_16x16x32_bf16 v[224:227], a[132:135], a[92:95], v[224:227]
buffer_load_dwordx4 a[48:51], v2, s[40:43], s35 offen offset:2048 sc1
v_mfma_f32_16x16x32_bf16 v[200:203], a[132:135], a[84:87], v[200:203]
ds_read_b128 a[100:103], v5 offset:45056
v_mfma_f32_16x16x32_bf16 v[200:203], a[128:131], a[80:83], v[200:203]
v_mfma_f32_16x16x32_bf16 v[176:179], a[128:131], a[72:75], v[176:179]
v_mfma_f32_16x16x32_bf16 v[176:179], a[132:135], a[76:79], v[176:179]
buffer_load_dwordx4 v1, s[4:7], s44 offen offset:1024 sc1 lds
v_mfma_f32_16x16x32_bf16 v[152:155], a[132:135], a[68:71], v[152:155]
ds_read_b128 a[104:107], v5 offset:39936
v_mfma_f32_16x16x32_bf16 v[152:155], a[128:131], a[64:67], v[152:155]
v_mfma_f32_16x16x32_bf16 v[132:135], a[136:139], a[64:67], v[132:135]
ds_read_b128 a[108:111], v5 offset:46080
v_mfma_f32_16x16x32_bf16 v[132:135], a[140:143], a[68:71], v[132:135]
buffer_load_dwordx4 a[52:55], v2, s[40:43], s33 offen offset:2048 sc1
v_mfma_f32_16x16x32_bf16 v[156:159], a[140:143], a[76:79], v[156:159]
ds_read_b128 a[112:115], v5 offset:40960
v_mfma_f32_16x16x32_bf16 v[156:159], a[136:139], a[72:75], v[156:159]
v_mfma_f32_16x16x32_bf16 v[180:183], a[136:139], a[80:83], v[180:183]
v_mfma_f32_16x16x32_bf16 v[180:183], a[140:143], a[84:87], v[180:183]
buffer_load_dwordx4 a[56:59], v2, s[40:43], s35 offen offset:3072 sc1
v_mfma_f32_16x16x32_bf16 v[204:207], a[140:143], a[92:95], v[204:207]
ds_read_b128 a[116:119], v5 offset:47104
v_mfma_f32_16x16x32_bf16 v[204:207], a[136:139], a[88:91], v[204:207]
v_mfma_f32_16x16x32_bf16 v[208:211], a[144:147], a[88:91], v[208:211]
v_mfma_f32_16x16x32_bf16 v[208:211], a[148:151], a[92:95], v[208:211]
buffer_load_dwordx4 v1, s[4:7], s44 offen offset:2048 sc1 lds
s_add_u32 m0, s18, 0x21000
v_mfma_f32_16x16x32_bf16 v[184:187], a[148:151], a[84:87], v[184:187]
s_add_u32 s44, s50, 0x1421000
v_mfma_f32_16x16x32_bf16 v[184:187], a[144:147], a[80:83], v[184:187]
v_mfma_f32_16x16x32_bf16 v[160:163], a[144:147], a[72:75], v[160:163]
v_mfma_f32_16x16x32_bf16 v[160:163], a[148:151], a[76:79], v[160:163]
buffer_load_dwordx4 a[60:63], v2, s[40:43], s33 offen offset:3072 sc1
s_add_u32 s35, s35, 8192
v_mfma_f32_16x16x32_bf16 v[136:139], a[148:151], a[68:71], v[136:139]
s_add_u32 s33, s33, 8192
v_mfma_f32_16x16x32_bf16 v[136:139], a[144:147], a[64:67], v[136:139]
s_waitcnt vmcnt(11) lgkmcnt(0)
v_mfma_f32_16x16x32_bf16 v[140:143], a[96:99], a[0:3], v[140:143]
ds_read_b128 a[128:131], v5 offset:41984
v_mfma_f32_16x16x32_bf16 v[140:143], a[100:103], a[4:7], v[140:143]
buffer_load_dwordx4 a[64:67], v2, s[40:43], s35 offen offset:0 sc1
v_mfma_f32_16x16x32_bf16 v[164:167], a[100:103], a[12:15], v[164:167]
ds_read_b128 a[132:135], v5 offset:48128
v_mfma_f32_16x16x32_bf16 v[164:167], a[96:99], a[8:11], v[164:167]
v_mfma_f32_16x16x32_bf16 v[188:191], a[96:99], a[16:19], v[188:191]
v_mfma_f32_16x16x32_bf16 v[188:191], a[100:103], a[20:23], v[188:191]
buffer_load_dwordx4 a[68:71], v2, s[40:43], s33 offen offset:0 sc1
v_mfma_f32_16x16x32_bf16 v[212:215], a[100:103], a[28:31], v[212:215]
ds_read_b128 a[136:139], v5 offset:36864
v_mfma_f32_16x16x32_bf16 v[212:215], a[96:99], a[24:27], v[212:215]
v_mfma_f32_16x16x32_bf16 v[216:219], a[104:107], a[24:27], v[216:219]
ds_read_b128 a[140:143], v5 offset:43008
v_mfma_f32_16x16x32_bf16 v[216:219], a[108:111], a[28:31], v[216:219]
v_mfma_f32_16x16x32_bf16 v[192:195], a[108:111], a[20:23], v[192:195]
buffer_load_dwordx4 v1, s[4:7], s44 offen offset:0 sc1 lds
v_mfma_f32_16x16x32_bf16 v[192:195], a[104:107], a[16:19], v[192:195]
ds_read_b128 a[144:147], v5 offset:37888
v_mfma_f32_16x16x32_bf16 v[168:171], a[104:107], a[8:11], v[168:171]
v_mfma_f32_16x16x32_bf16 v[168:171], a[108:111], a[12:15], v[168:171]
ds_read_b128 a[148:151], v5 offset:44032
v_mfma_f32_16x16x32_bf16 v[144:147], a[108:111], a[4:7], v[144:147]
v_mfma_f32_16x16x32_bf16 v[144:147], a[104:107], a[0:3], v[144:147]
buffer_load_dwordx4 a[72:75], v2, s[40:43], s35 offen offset:1024 sc1
v_mfma_f32_16x16x32_bf16 v[148:151], a[112:115], a[0:3], v[148:151]
v_mfma_f32_16x16x32_bf16 v[148:151], a[116:119], a[4:7], v[148:151]
v_mfma_f32_16x16x32_bf16 v[172:175], a[116:119], a[12:15], v[172:175]
v_mfma_f32_16x16x32_bf16 v[172:175], a[112:115], a[8:11], v[172:175]
v_mfma_f32_16x16x32_bf16 v[196:199], a[112:115], a[16:19], v[196:199]
buffer_load_dwordx4 a[76:79], v2, s[40:43], s33 offen offset:1024 sc1
v_mfma_f32_16x16x32_bf16 v[196:199], a[116:119], a[20:23], v[196:199]
v_mfma_f32_16x16x32_bf16 v[220:223], a[116:119], a[28:31], v[220:223]
v_mfma_f32_16x16x32_bf16 v[220:223], a[112:115], a[24:27], v[220:223]
s_waitcnt lgkmcnt(0)
s_barrier
v_mfma_f32_16x16x32_bf16 v[224:227], a[128:131], a[24:27], v[224:227]
v_add_u32 v5, 49152, v1
v_mfma_f32_16x16x32_bf16 v[224:227], a[132:135], a[28:31], v[224:227]
buffer_load_dwordx4 a[80:83], v2, s[40:43], s35 offen offset:2048 sc1
v_mfma_f32_16x16x32_bf16 v[200:203], a[132:135], a[20:23], v[200:203]
ds_read_b128 a[96:99], v5 offset:2048
v_mfma_f32_16x16x32_bf16 v[200:203], a[128:131], a[16:19], v[200:203]
ds_read_b128 a[100:103], v5 offset:8192
v_mfma_f32_16x16x32_bf16 v[176:179], a[128:131], a[8:11], v[176:179]
v_mfma_f32_16x16x32_bf16 v[176:179], a[132:135], a[12:15], v[176:179]
buffer_load_dwordx4 a[84:87], v2, s[40:43], s33 offen offset:2048 sc1
v_mfma_f32_16x16x32_bf16 v[152:155], a[132:135], a[4:7], v[152:155]
ds_read_b128 a[104:107], v5 offset:3072
v_mfma_f32_16x16x32_bf16 v[152:155], a[128:131], a[0:3], v[152:155]
v_mfma_f32_16x16x32_bf16 v[132:135], a[136:139], a[0:3], v[132:135]
ds_read_b128 a[108:111], v5 offset:9216
v_mfma_f32_16x16x32_bf16 v[132:135], a[140:143], a[4:7], v[132:135]
v_mfma_f32_16x16x32_bf16 v[156:159], a[140:143], a[12:15], v[156:159]
buffer_load_dwordx4 v1, s[4:7], s44 offen offset:1024 sc1 lds
v_mfma_f32_16x16x32_bf16 v[156:159], a[136:139], a[8:11], v[156:159]
ds_read_b128 a[112:115], v5 offset:4096
v_mfma_f32_16x16x32_bf16 v[180:183], a[136:139], a[16:19], v[180:183]
v_mfma_f32_16x16x32_bf16 v[180:183], a[140:143], a[20:23], v[180:183]
ds_read_b128 a[116:119], v5 offset:10240
v_mfma_f32_16x16x32_bf16 v[204:207], a[140:143], a[28:31], v[204:207]
v_mfma_f32_16x16x32_bf16 v[204:207], a[136:139], a[24:27], v[204:207]
buffer_load_dwordx4 a[88:91], v2, s[40:43], s35 offen offset:3072 sc1
v_mfma_f32_16x16x32_bf16 v[208:211], a[144:147], a[24:27], v[208:211]
v_mfma_f32_16x16x32_bf16 v[208:211], a[148:151], a[28:31], v[208:211]
v_mfma_f32_16x16x32_bf16 v[184:187], a[148:151], a[20:23], v[184:187]
v_mfma_f32_16x16x32_bf16 v[184:187], a[144:147], a[16:19], v[184:187]
v_mfma_f32_16x16x32_bf16 v[160:163], a[144:147], a[8:11], v[160:163]
buffer_load_dwordx4 a[92:95], v2, s[40:43], s33 offen offset:3072 sc1
s_add_u32 s35, s35, 8192
v_mfma_f32_16x16x32_bf16 v[160:163], a[148:151], a[12:15], v[160:163]
s_add_u32 s33, s33, 8192
v_mfma_f32_16x16x32_bf16 v[136:139], a[148:151], a[4:7], v[136:139]
v_mfma_f32_16x16x32_bf16 v[136:139], a[144:147], a[0:3], v[136:139]
s_waitcnt vmcnt(10) lgkmcnt(0)
v_mfma_f32_16x16x32_bf16 v[140:143], a[96:99], a[32:35], v[140:143]
ds_read_b128 a[128:131], v5 offset:5120
v_mfma_f32_16x16x32_bf16 v[140:143], a[100:103], a[36:39], v[140:143]
buffer_load_dwordx4 a[0:3], v2, s[40:43], s35 offen offset:0 sc1
v_mfma_f32_16x16x32_bf16 v[164:167], a[100:103], a[44:47], v[164:167]
ds_read_b128 a[132:135], v5 offset:11264
v_mfma_f32_16x16x32_bf16 v[164:167], a[96:99], a[40:43], v[164:167]
v_mfma_f32_16x16x32_bf16 v[188:191], a[96:99], a[48:51], v[188:191]
v_mfma_f32_16x16x32_bf16 v[188:191], a[100:103], a[52:55], v[188:191]
buffer_load_dwordx4 v1, s[4:7], s44 offen offset:2048 sc1 lds
s_add_u32 s88, s82, 0x240000
v_mfma_f32_16x16x32_bf16 v[212:215], a[100:103], a[60:63], v[212:215]
ds_read_b128 a[136:139], v5 offset:0
v_mfma_f32_16x16x32_bf16 v[212:215], a[96:99], a[56:59], v[212:215]
v_mfma_f32_16x16x32_bf16 v[216:219], a[104:107], a[56:59], v[216:219]
ds_read_b128 a[140:143], v5 offset:6144
v_mfma_f32_16x16x32_bf16 v[216:219], a[108:111], a[60:63], v[216:219]
buffer_load_dwordx4 a[4:7], v2, s[40:43], s33 offen offset:0 sc1
v_mfma_f32_16x16x32_bf16 v[192:195], a[108:111], a[52:55], v[192:195]
ds_read_b128 a[144:147], v5 offset:1024
v_mfma_f32_16x16x32_bf16 v[192:195], a[104:107], a[48:51], v[192:195]
v_mfma_f32_16x16x32_bf16 v[168:171], a[104:107], a[40:43], v[168:171]
v_mfma_f32_16x16x32_bf16 v[168:171], a[108:111], a[44:47], v[168:171]
buffer_load_dwordx4 a[8:11], v2, s[40:43], s35 offen offset:1024 sc1
v_mfma_f32_16x16x32_bf16 v[144:147], a[108:111], a[36:39], v[144:147]
ds_read_b128 a[148:151], v5 offset:7168
v_mfma_f32_16x16x32_bf16 v[144:147], a[104:107], a[32:35], v[144:147]
v_mfma_f32_16x16x32_bf16 v[148:151], a[112:115], a[32:35], v[148:151]
v_mfma_f32_16x16x32_bf16 v[148:151], a[116:119], a[36:39], v[148:151]
buffer_load_dwordx4 v[92:95], v1, s[4:7], s88 offen offset:0 sc1
v_mfma_f32_16x16x32_bf16 v[172:175], a[116:119], a[44:47], v[172:175]
v_mfma_f32_16x16x32_bf16 v[172:175], a[112:115], a[40:43], v[172:175]
v_mfma_f32_16x16x32_bf16 v[196:199], a[112:115], a[48:51], v[196:199]
v_mfma_f32_16x16x32_bf16 v[196:199], a[116:119], a[52:55], v[196:199]
buffer_load_dwordx4 a[12:15], v2, s[40:43], s33 offen offset:1024 sc1
v_mfma_f32_16x16x32_bf16 v[220:223], a[116:119], a[60:63], v[220:223]
v_mfma_f32_16x16x32_bf16 v[220:223], a[112:115], a[56:59], v[220:223]
s_waitcnt lgkmcnt(0)
v_mfma_f32_16x16x32_bf16 v[224:227], a[128:131], a[56:59], v[224:227]
ds_read_b128 a[96:99], v5 offset:14336
v_mfma_f32_16x16x32_bf16 v[224:227], a[132:135], a[60:63], v[224:227]
buffer_load_dwordx4 a[16:19], v2, s[40:43], s35 offen offset:2048 sc1
v_mfma_f32_16x16x32_bf16 v[200:203], a[132:135], a[52:55], v[200:203]
ds_read_b128 a[100:103], v5 offset:20480
v_mfma_f32_16x16x32_bf16 v[200:203], a[128:131], a[48:51], v[200:203]
v_mfma_f32_16x16x32_bf16 v[176:179], a[128:131], a[40:43], v[176:179]
v_mfma_f32_16x16x32_bf16 v[176:179], a[132:135], a[44:47], v[176:179]
buffer_load_dwordx4 a[20:23], v2, s[40:43], s33 offen offset:2048 sc1
v_mfma_f32_16x16x32_bf16 v[152:155], a[132:135], a[36:39], v[152:155]
ds_read_b128 a[104:107], v5 offset:15360
v_mfma_f32_16x16x32_bf16 v[152:155], a[128:131], a[32:35], v[152:155]
v_mfma_f32_16x16x32_bf16 v[132:135], a[136:139], a[32:35], v[132:135]
ds_read_b128 a[108:111], v5 offset:21504
v_mfma_f32_16x16x32_bf16 v[132:135], a[140:143], a[36:39], v[132:135]
v_mfma_f32_16x16x32_bf16 v[156:159], a[140:143], a[44:47], v[156:159]
buffer_load_dwordx4 v[96:99], v1, s[4:7], s88 offen offset:1024 sc1
v_mfma_f32_16x16x32_bf16 v[156:159], a[136:139], a[40:43], v[156:159]
ds_read_b128 a[112:115], v5 offset:16384
v_mfma_f32_16x16x32_bf16 v[180:183], a[136:139], a[48:51], v[180:183]
v_mfma_f32_16x16x32_bf16 v[180:183], a[140:143], a[52:55], v[180:183]
ds_read_b128 a[116:119], v5 offset:22528
v_mfma_f32_16x16x32_bf16 v[204:207], a[140:143], a[60:63], v[204:207]
v_mfma_f32_16x16x32_bf16 v[204:207], a[136:139], a[56:59], v[204:207]
buffer_load_dwordx4 a[24:27], v2, s[40:43], s35 offen offset:3072 sc1
v_mfma_f32_16x16x32_bf16 v[208:211], a[144:147], a[56:59], v[208:211]
v_mfma_f32_16x16x32_bf16 v[208:211], a[148:151], a[60:63], v[208:211]
v_mfma_f32_16x16x32_bf16 v[184:187], a[148:151], a[52:55], v[184:187]
v_mfma_f32_16x16x32_bf16 v[184:187], a[144:147], a[48:51], v[184:187]
v_mfma_f32_16x16x32_bf16 v[160:163], a[144:147], a[40:43], v[160:163]
buffer_load_dwordx4 a[28:31], v2, s[40:43], s33 offen offset:3072 sc1
s_add_u32 s35, s35, 8192
v_mfma_f32_16x16x32_bf16 v[160:163], a[148:151], a[44:47], v[160:163]
s_add_u32 s33, s33, 8192
v_mfma_f32_16x16x32_bf16 v[136:139], a[148:151], a[36:39], v[136:139]
v_mfma_f32_16x16x32_bf16 v[136:139], a[144:147], a[32:35], v[136:139]
s_waitcnt vmcnt(11) lgkmcnt(0)
v_mfma_f32_16x16x32_bf16 v[140:143], a[96:99], a[64:67], v[140:143]
ds_read_b128 a[128:131], v5 offset:17408
v_mfma_f32_16x16x32_bf16 v[140:143], a[100:103], a[68:71], v[140:143]
buffer_load_dwordx4 a[32:35], v2, s[40:43], s35 offen offset:0 sc1
v_mfma_f32_16x16x32_bf16 v[164:167], a[100:103], a[76:79], v[164:167]
ds_read_b128 a[132:135], v5 offset:23552
v_mfma_f32_16x16x32_bf16 v[164:167], a[96:99], a[72:75], v[164:167]
v_mfma_f32_16x16x32_bf16 v[188:191], a[96:99], a[80:83], v[188:191]
v_mfma_f32_16x16x32_bf16 v[188:191], a[100:103], a[84:87], v[188:191]
buffer_load_dwordx4 a[36:39], v2, s[40:43], s33 offen offset:0 sc1
v_mfma_f32_16x16x32_bf16 v[212:215], a[100:103], a[92:95], v[212:215]
ds_read_b128 a[136:139], v5 offset:12288
v_mfma_f32_16x16x32_bf16 v[212:215], a[96:99], a[88:91], v[212:215]
v_mfma_f32_16x16x32_bf16 v[216:219], a[104:107], a[88:91], v[216:219]
ds_read_b128 a[140:143], v5 offset:18432
v_mfma_f32_16x16x32_bf16 v[216:219], a[108:111], a[92:95], v[216:219]
v_mfma_f32_16x16x32_bf16 v[192:195], a[108:111], a[84:87], v[192:195]
buffer_load_dwordx4 v[100:103], v1, s[4:7], s88 offen offset:2048 sc1
v_mfma_f32_16x16x32_bf16 v[192:195], a[104:107], a[80:83], v[192:195]
ds_read_b128 a[144:147], v5 offset:13312
v_mfma_f32_16x16x32_bf16 v[168:171], a[104:107], a[72:75], v[168:171]
v_mfma_f32_16x16x32_bf16 v[168:171], a[108:111], a[76:79], v[168:171]
ds_read_b128 a[148:151], v5 offset:19456
v_mfma_f32_16x16x32_bf16 v[144:147], a[108:111], a[68:71], v[144:147]
v_mfma_f32_16x16x32_bf16 v[144:147], a[104:107], a[64:67], v[144:147]
buffer_load_dwordx4 a[40:43], v2, s[40:43], s35 offen offset:1024 sc1
v_mfma_f32_16x16x32_bf16 v[148:151], a[112:115], a[64:67], v[148:151]
v_mfma_f32_16x16x32_bf16 v[148:151], a[116:119], a[68:71], v[148:151]
v_mfma_f32_16x16x32_bf16 v[172:175], a[116:119], a[76:79], v[172:175]
v_mfma_f32_16x16x32_bf16 v[172:175], a[112:115], a[72:75], v[172:175]
v_mfma_f32_16x16x32_bf16 v[196:199], a[112:115], a[80:83], v[196:199]
buffer_load_dwordx4 a[44:47], v2, s[40:43], s33 offen offset:1024 sc1
v_mfma_f32_16x16x32_bf16 v[196:199], a[116:119], a[84:87], v[196:199]
v_mfma_f32_16x16x32_bf16 v[220:223], a[116:119], a[92:95], v[220:223]
v_mfma_f32_16x16x32_bf16 v[220:223], a[112:115], a[88:91], v[220:223]
s_waitcnt lgkmcnt(0)
v_mfma_f32_16x16x32_bf16 v[224:227], a[128:131], a[88:91], v[224:227]
ds_read_b128 a[96:99], v5 offset:26624
v_mfma_f32_16x16x32_bf16 v[224:227], a[132:135], a[92:95], v[224:227]
buffer_load_dwordx4 a[48:51], v2, s[40:43], s35 offen offset:2048 sc1
v_mfma_f32_16x16x32_bf16 v[200:203], a[132:135], a[84:87], v[200:203]
ds_read_b128 a[100:103], v5 offset:32768
v_mfma_f32_16x16x32_bf16 v[200:203], a[128:131], a[80:83], v[200:203]
v_mfma_f32_16x16x32_bf16 v[176:179], a[128:131], a[72:75], v[176:179]
v_mfma_f32_16x16x32_bf16 v[176:179], a[132:135], a[76:79], v[176:179]
buffer_load_dwordx4 v[104:107], v1, s[4:7], s88 offen offset:3072 sc1
s_add_u32 s88, s88, 4096
v_mfma_f32_16x16x32_bf16 v[152:155], a[132:135], a[68:71], v[152:155]
ds_read_b128 a[104:107], v5 offset:27648
v_mfma_f32_16x16x32_bf16 v[152:155], a[128:131], a[64:67], v[152:155]
v_mfma_f32_16x16x32_bf16 v[132:135], a[136:139], a[64:67], v[132:135]
ds_read_b128 a[108:111], v5 offset:33792
v_mfma_f32_16x16x32_bf16 v[132:135], a[140:143], a[68:71], v[132:135]
buffer_load_dwordx4 a[52:55], v2, s[40:43], s33 offen offset:2048 sc1
v_mfma_f32_16x16x32_bf16 v[156:159], a[140:143], a[76:79], v[156:159]
ds_read_b128 a[112:115], v5 offset:28672
v_mfma_f32_16x16x32_bf16 v[156:159], a[136:139], a[72:75], v[156:159]
v_mfma_f32_16x16x32_bf16 v[180:183], a[136:139], a[80:83], v[180:183]
v_mfma_f32_16x16x32_bf16 v[180:183], a[140:143], a[84:87], v[180:183]
buffer_load_dwordx4 a[56:59], v2, s[40:43], s35 offen offset:3072 sc1
v_mfma_f32_16x16x32_bf16 v[204:207], a[140:143], a[92:95], v[204:207]
ds_read_b128 a[116:119], v5 offset:34816
v_mfma_f32_16x16x32_bf16 v[204:207], a[136:139], a[88:91], v[204:207]
v_mfma_f32_16x16x32_bf16 v[208:211], a[144:147], a[88:91], v[208:211]
v_mfma_f32_16x16x32_bf16 v[208:211], a[148:151], a[92:95], v[208:211]
buffer_load_dwordx4 v[108:111], v1, s[4:7], s88 offen offset:0 sc1
v_mfma_f32_16x16x32_bf16 v[184:187], a[148:151], a[84:87], v[184:187]
v_mfma_f32_16x16x32_bf16 v[184:187], a[144:147], a[80:83], v[184:187]
v_mfma_f32_16x16x32_bf16 v[160:163], a[144:147], a[72:75], v[160:163]
v_mfma_f32_16x16x32_bf16 v[160:163], a[148:151], a[76:79], v[160:163]
buffer_load_dwordx4 a[60:63], v2, s[40:43], s33 offen offset:3072 sc1
s_add_u32 s35, s35, 8192
v_mfma_f32_16x16x32_bf16 v[136:139], a[148:151], a[68:71], v[136:139]
s_add_u32 s33, s33, 8192
v_mfma_f32_16x16x32_bf16 v[136:139], a[144:147], a[64:67], v[136:139]
s_waitcnt vmcnt(11) lgkmcnt(0)
v_mfma_f32_16x16x32_bf16 v[140:143], a[96:99], a[0:3], v[140:143]
ds_read_b128 a[128:131], v5 offset:29696
v_add_f32_dpp v48, v48, v48 row_ror:8 row_mask:0xf bank_mask:0xf
v_mfma_f32_16x16x32_bf16 v[140:143], a[100:103], a[4:7], v[140:143]
buffer_load_dwordx4 a[64:67], v2, s[40:43], s35 offen offset:0 sc1
v_mfma_f32_16x16x32_bf16 v[164:167], a[100:103], a[12:15], v[164:167]
ds_read_b128 a[132:135], v5 offset:35840
v_add_f32_dpp v49, v49, v49 row_ror:8 row_mask:0xf bank_mask:0xf
v_mfma_f32_16x16x32_bf16 v[164:167], a[96:99], a[8:11], v[164:167]
v_add_f32_dpp v50, v50, v50 row_ror:8 row_mask:0xf bank_mask:0xf
v_add_f32_dpp v51, v51, v51 row_ror:8 row_mask:0xf bank_mask:0xf
v_mfma_f32_16x16x32_bf16 v[188:191], a[96:99], a[16:19], v[188:191]
v_add_f32_dpp v52, v52, v52 row_ror:8 row_mask:0xf bank_mask:0xf
v_add_f32_dpp v53, v53, v53 row_ror:8 row_mask:0xf bank_mask:0xf
v_mfma_f32_16x16x32_bf16 v[188:191], a[100:103], a[20:23], v[188:191]
buffer_load_dwordx4 a[68:71], v2, s[40:43], s33 offen offset:0 sc1
v_mfma_f32_16x16x32_bf16 v[212:215], a[100:103], a[28:31], v[212:215]
ds_read_b128 a[136:139], v5 offset:24576
v_add_f32_dpp v54, v54, v54 row_ror:8 row_mask:0xf bank_mask:0xf
v_mfma_f32_16x16x32_bf16 v[212:215], a[96:99], a[24:27], v[212:215]
v_add_f32_dpp v55, v55, v55 row_ror:8 row_mask:0xf bank_mask:0xf
v_add_f32_dpp v48, v48, v48 row_ror:4 row_mask:0xf bank_mask:0xf
v_mfma_f32_16x16x32_bf16 v[216:219], a[104:107], a[24:27], v[216:219]
ds_read_b128 a[140:143], v5 offset:30720
v_add_f32_dpp v49, v49, v49 row_ror:4 row_mask:0xf bank_mask:0xf
v_mfma_f32_16x16x32_bf16 v[216:219], a[108:111], a[28:31], v[216:219]
v_add_f32_dpp v50, v50, v50 row_ror:4 row_mask:0xf bank_mask:0xf
v_mfma_f32_16x16x32_bf16 v[192:195], a[108:111], a[20:23], v[192:195]
buffer_load_dwordx4 v[112:115], v1, s[4:7], s88 offen offset:1024 sc1
v_mfma_f32_16x16x32_bf16 v[192:195], a[104:107], a[16:19], v[192:195]
ds_read_b128 a[144:147], v5 offset:25600
v_add_f32_dpp v51, v51, v51 row_ror:4 row_mask:0xf bank_mask:0xf
v_mfma_f32_16x16x32_bf16 v[168:171], a[104:107], a[8:11], v[168:171]
v_add_f32_dpp v52, v52, v52 row_ror:4 row_mask:0xf bank_mask:0xf
v_add_f32_dpp v53, v53, v53 row_ror:4 row_mask:0xf bank_mask:0xf
v_mfma_f32_16x16x32_bf16 v[168:171], a[108:111], a[12:15], v[168:171]
ds_read_b128 a[148:151], v5 offset:31744
L_stub5:
s_cbranch_execz L_stub6
v_add_f32_dpp v54, v54, v54 row_ror:4 row_mask:0xf bank_mask:0xf
v_mfma_f32_16x16x32_bf16 v[144:147], a[108:111], a[4:7], v[144:147]
v_add_f32_dpp v55, v55, v55 row_ror:4 row_mask:0xf bank_mask:0xf
v_mfma_f32_16x16x32_bf16 v[144:147], a[104:107], a[0:3], v[144:147]
buffer_load_dwordx4 a[72:75], v2, s[40:43], s35 offen offset:1024 sc1
v_mfma_f32_16x16x32_bf16 v[148:151], a[112:115], a[0:3], v[148:151]
v_add_f32_dpp v48, v48, v48 row_ror:2 row_mask:0xf bank_mask:0xf
v_add_f32_dpp v49, v49, v49 row_ror:2 row_mask:0xf bank_mask:0xf
v_mfma_f32_16x16x32_bf16 v[148:151], a[116:119], a[4:7], v[148:151]
v_add_f32_dpp v50, v50, v50 row_ror:2 row_mask:0xf bank_mask:0xf
v_mfma_f32_16x16x32_bf16 v[172:175], a[116:119], a[12:15], v[172:175]
v_add_f32_dpp v51, v51, v51 row_ror:2 row_mask:0xf bank_mask:0xf
v_mfma_f32_16x16x32_bf16 v[172:175], a[112:115], a[8:11], v[172:175]
v_add_f32_dpp v52, v52, v52 row_ror:2 row_mask:0xf bank_mask:0xf
v_mfma_f32_16x16x32_bf16 v[196:199], a[112:115], a[16:19], v[196:199]
buffer_load_dwordx4 a[76:79], v2, s[40:43], s33 offen offset:1024 sc1
v_mfma_f32_16x16x32_bf16 v[196:199], a[116:119], a[20:23], v[196:199]
v_add_f32_dpp v53, v53, v53 row_ror:2 row_mask:0xf bank_mask:0xf
v_add_f32_dpp v54, v54, v54 row_ror:2 row_mask:0xf bank_mask:0xf
v_mfma_f32_16x16x32_bf16 v[220:223], a[116:119], a[28:31], v[220:223]
v_add_f32_dpp v55, v55, v55 row_ror:2 row_mask:0xf bank_mask:0xf
v_mfma_f32_16x16x32_bf16 v[220:223], a[112:115], a[24:27], v[220:223]
v_add_f32_dpp v48, v48, v48 row_ror:1 row_mask:0xf bank_mask:0xf
s_waitcnt lgkmcnt(0)
v_mfma_f32_16x16x32_bf16 v[224:227], a[128:131], a[24:27], v[224:227]
ds_read_b128 a[96:99], v5 offset:38912
v_add_f32_dpp v49, v49, v49 row_ror:1 row_mask:0xf bank_mask:0xf
v_mfma_f32_16x16x32_bf16 v[224:227], a[132:135], a[28:31], v[224:227]
buffer_load_dwordx4 a[80:83], v2, s[40:43], s35 offen offset:2048 sc1
v_mfma_f32_16x16x32_bf16 v[200:203], a[132:135], a[20:23], v[200:203]
ds_read_b128 a[100:103], v5 offset:45056
v_add_f32_dpp v50, v50, v50 row_ror:1 row_mask:0xf bank_mask:0xf
v_mfma_f32_16x16x32_bf16 v[200:203], a[128:131], a[16:19], v[200:203]
v_add_f32_dpp v51, v51, v51 row_ror:1 row_mask:0xf bank_mask:0xf
v_add_f32_dpp v52, v52, v52 row_ror:1 row_mask:0xf bank_mask:0xf
v_mfma_f32_16x16x32_bf16 v[176:179], a[128:131], a[8:11], v[176:179]
v_add_f32_dpp v53, v53, v53 row_ror:1 row_mask:0xf bank_mask:0xf
v_add_f32_dpp v54, v54, v54 row_ror:1 row_mask:0xf bank_mask:0xf
v_mfma_f32_16x16x32_bf16 v[176:179], a[132:135], a[12:15], v[176:179]
buffer_load_dwordx4 a[84:87], v2, s[40:43], s33 offen offset:2048 sc1
v_mfma_f32_16x16x32_bf16 v[152:155], a[132:135], a[4:7], v[152:155]
ds_read_b128 a[104:107], v5 offset:39936
v_add_f32_dpp v55, v55, v55 row_ror:1 row_mask:0xf bank_mask:0xf
v_mfma_f32_16x16x32_bf16 v[152:155], a[128:131], a[0:3], v[152:155]
v_add_u32 v233, 159744, v233
s_lshl_b32 s36, s28, 6
v_mfma_f32_16x16x32_bf16 v[132:135], a[136:139], a[0:3], v[132:135]
ds_read_b128 a[108:111], v5 offset:46080
s_lshl_b32 s37, s39, 6
v_mfma_f32_16x16x32_bf16 v[132:135], a[140:143], a[4:7], v[132:135]
v_add_u32 v232, s36, v233
v_mfma_f32_16x16x32_bf16 v[156:159], a[140:143], a[12:15], v[156:159]
buffer_load_dwordx4 v[116:119], v1, s[4:7], s88 offen offset:2048 sc1
v_mfma_f32_16x16x32_bf16 v[156:159], a[136:139], a[8:11], v[156:159]
ds_read_b128 a[112:115], v5 offset:40960
v_add_u32 v235, s37, v233
v_mfma_f32_16x16x32_bf16 v[180:183], a[136:139], a[16:19], v[180:183]
v_mfma_f32_16x16x32_bf16 v[180:183], a[140:143], a[20:23], v[180:183]
ds_read_b128 a[116:119], v5 offset:47104
v_mfma_f32_16x16x32_bf16 v[204:207], a[140:143], a[28:31], v[204:207]
v_mfma_f32_16x16x32_bf16 v[204:207], a[136:139], a[24:27], v[204:207]
buffer_load_dwordx4 a[88:91], v2, s[40:43], s35 offen offset:3072 sc1
v_mfma_f32_16x16x32_bf16 v[208:211], a[144:147], a[24:27], v[208:211]
v_mfma_f32_16x16x32_bf16 v[208:211], a[148:151], a[28:31], v[208:211]
v_mfma_f32_16x16x32_bf16 v[184:187], a[148:151], a[20:23], v[184:187]
v_mfma_f32_16x16x32_bf16 v[184:187], a[144:147], a[16:19], v[184:187]
v_mfma_f32_16x16x32_bf16 v[160:163], a[144:147], a[8:11], v[160:163]
buffer_load_dwordx4 a[92:95], v2, s[40:43], s33 offen offset:3072 sc1
s_add_u32 s35, s35, 8192
v_mfma_f32_16x16x32_bf16 v[160:163], a[148:151], a[12:15], v[160:163]
s_add_u32 s33, s33, 8192
v_mfma_f32_16x16x32_bf16 v[136:139], a[148:151], a[4:7], v[136:139]
v_mfma_f32_16x16x32_bf16 v[136:139], a[144:147], a[0:3], v[136:139]
s_waitcnt vmcnt(10) lgkmcnt(0)
v_mfma_f32_16x16x32_bf16 v[140:143], a[96:99], a[32:35], v[140:143]
ds_read_b128 a[128:131], v5 offset:41984
v_mfma_f32_16x16x32_bf16 v[140:143], a[100:103], a[36:39], v[140:143]
buffer_load_dwordx4 a[0:3], v2, s[40:43], s35 offen offset:0 sc1
v_mfma_f32_16x16x32_bf16 v[164:167], a[100:103], a[44:47], v[164:167]
ds_read_b128 a[132:135], v5 offset:48128
v_mfma_f32_16x16x32_bf16 v[164:167], a[96:99], a[40:43], v[164:167]
ds_write_b128 v232, v[48:51]
v_mfma_f32_16x16x32_bf16 v[188:191], a[96:99], a[48:51], v[188:191]
ds_write_b128 v235, v[52:55]
v_mfma_f32_16x16x32_bf16 v[188:191], a[100:103], a[52:55], v[188:191]
buffer_load_dwordx4 a[4:7], v2, s[40:43], s33 offen offset:0 sc1
v_mfma_f32_16x16x32_bf16 v[212:215], a[100:103], a[60:63], v[212:215]
ds_read_b128 a[136:139], v5 offset:36864
v_mfma_f32_16x16x32_bf16 v[212:215], a[96:99], a[56:59], v[212:215]
v_mfma_f32_16x16x32_bf16 v[216:219], a[104:107], a[56:59], v[216:219]
ds_read_b128 a[140:143], v5 offset:43008
v_mfma_f32_16x16x32_bf16 v[216:219], a[108:111], a[60:63], v[216:219]
v_mfma_f32_16x16x32_bf16 v[192:195], a[108:111], a[52:55], v[192:195]
buffer_load_dwordx4 v[120:123], v1, s[4:7], s88 offen offset:3072 sc1
s_add_u32 m0, s18, 0x0
v_mfma_f32_16x16x32_bf16 v[192:195], a[104:107], a[48:51], v[192:195]
s_add_u32 s44, s50, 0x1424000
ds_read_b128 a[144:147], v5 offset:37888
v_mfma_f32_16x16x32_bf16 v[168:171], a[104:107], a[40:43], v[168:171]
v_mfma_f32_16x16x32_bf16 v[168:171], a[108:111], a[44:47], v[168:171]
ds_read_b128 a[148:151], v5 offset:44032
v_mfma_f32_16x16x32_bf16 v[144:147], a[108:111], a[36:39], v[144:147]
v_mfma_f32_16x16x32_bf16 v[144:147], a[104:107], a[32:35], v[144:147]
buffer_load_dwordx4 a[8:11], v2, s[40:43], s35 offen offset:1024 sc1
v_mfma_f32_16x16x32_bf16 v[148:151], a[112:115], a[32:35], v[148:151]
v_mfma_f32_16x16x32_bf16 v[148:151], a[116:119], a[36:39], v[148:151]
v_mfma_f32_16x16x32_bf16 v[172:175], a[116:119], a[44:47], v[172:175]
v_mfma_f32_16x16x32_bf16 v[172:175], a[112:115], a[40:43], v[172:175]
v_mfma_f32_16x16x32_bf16 v[196:199], a[112:115], a[48:51], v[196:199]
buffer_load_dwordx4 a[12:15], v2, s[40:43], s33 offen offset:1024 sc1
v_mfma_f32_16x16x32_bf16 v[196:199], a[116:119], a[52:55], v[196:199]
v_mfma_f32_16x16x32_bf16 v[220:223], a[116:119], a[60:63], v[220:223]
v_mfma_f32_16x16x32_bf16 v[220:223], a[112:115], a[56:59], v[220:223]
s_waitcnt lgkmcnt(0)
s_barrier
v_mfma_f32_16x16x32_bf16 v[224:227], a[128:131], a[56:59], v[224:227]
v_add_u32 v5, 98304, v1
v_mfma_f32_16x16x32_bf16 v[224:227], a[132:135], a[60:63], v[224:227]
buffer_load_dwordx4 a[16:19], v2, s[40:43], s35 offen offset:2048 sc1
v_mfma_f32_16x16x32_bf16 v[200:203], a[132:135], a[52:55], v[200:203]
ds_read_b128 a[96:99], v5 offset:2048
v_mfma_f32_16x16x32_bf16 v[200:203], a[128:131], a[48:51], v[200:203]
ds_read_b128 a[100:103], v5 offset:8192
v_mfma_f32_16x16x32_bf16 v[176:179], a[128:131], a[40:43], v[176:179]
ds_read_b128 v[48:51], v233 offset:0
v_mfma_f32_16x16x32_bf16 v[176:179], a[132:135], a[44:47], v[176:179]
buffer_load_dwordx4 v1, s[4:7], s44 offen offset:0 sc1 lds
v_mfma_f32_16x16x32_bf16 v[152:155], a[132:135], a[36:39], v[152:155]
ds_read_b128 a[104:107], v5 offset:3072
v_mfma_f32_16x16x32_bf16 v[152:155], a[128:131], a[32:35], v[152:155]
v_mfma_f32_16x16x32_bf16 v[132:135], a[136:139], a[32:35], v[132:135]
ds_read_b128 a[108:111], v5 offset:9216
v_mfma_f32_16x16x32_bf16 v[132:135], a[140:143], a[36:39], v[132:135]
buffer_load_dwordx4 a[20:23], v2, s[40:43], s33 offen offset:2048 sc1
v_mfma_f32_16x16x32_bf16 v[156:159], a[140:143], a[44:47], v[156:159]
ds_read_b128 a[112:115], v5 offset:4096
v_mfma_f32_16x16x32_bf16 v[156:159], a[136:139], a[40:43], v[156:159]
ds_read_b128 v[52:55], v233 offset:64
v_mfma_f32_16x16x32_bf16 v[180:183], a[136:139], a[48:51], v[180:183]
v_mfma_f32_16x16x32_bf16 v[180:183], a[140:143], a[52:55], v[180:183]
buffer_load_dwordx4 a[24:27], v2, s[40:43], s35 offen offset:3072 sc1
v_mfma_f32_16x16x32_bf16 v[204:207], a[140:143], a[60:63], v[204:207]
ds_read_b128 a[116:119], v5 offset:10240
v_mfma_f32_16x16x32_bf16 v[204:207], a[136:139], a[56:59], v[204:207]
v_mfma_f32_16x16x32_bf16 v[208:211], a[144:147], a[56:59], v[208:211]
v_mfma_f32_16x16x32_bf16 v[208:211], a[148:151], a[60:63], v[208:211]
buffer_load_dwordx4 v1, s[4:7], s44 offen offset:1024 sc1 lds
v_mfma_f32_16x16x32_bf16 v[184:187], a[148:151], a[52:55], v[184:187]
v_mfma_f32_16x16x32_bf16 v[184:187], a[144:147], a[48:51], v[184:187]
v_mfma_f32_16x16x32_bf16 v[160:163], a[144:147], a[40:43], v[160:163]
v_mfma_f32_16x16x32_bf16 v[160:163], a[148:151], a[44:47], v[160:163]
buffer_load_dwordx4 a[28:31], v2, s[40:43], s33 offen offset:3072 sc1
s_add_u32 s35, s35, 8192
v_mfma_f32_16x16x32_bf16 v[136:139], a[148:151], a[36:39], v[136:139]
s_add_u32 s33, s33, 8192
ds_read_b128 v[56:59], v233 offset:128
v_mfma_f32_16x16x32_bf16 v[136:139], a[144:147], a[32:35], v[136:139]
s_waitcnt vmcnt(11) lgkmcnt(1)
v_mfma_f32_16x16x32_bf16 v[140:143], a[96:99], a[64:67], v[140:143]
ds_read_b128 a[128:131], v5 offset:5120
v_mfma_f32_16x16x32_bf16 v[140:143], a[100:103], a[68:71], v[140:143]
buffer_load_dwordx4 a[32:35], v2, s[40:43], s35 offen offset:0 sc1
v_mfma_f32_16x16x32_bf16 v[164:167], a[100:103], a[76:79], v[164:167]
ds_read_b128 a[132:135], v5 offset:11264
v_mfma_f32_16x16x32_bf16 v[164:167], a[96:99], a[72:75], v[164:167]
v_mfma_f32_16x16x32_bf16 v[188:191], a[96:99], a[80:83], v[188:191]
v_mfma_f32_16x16x32_bf16 v[188:191], a[100:103], a[84:87], v[188:191]
buffer_load_dwordx4 a[36:39], v2, s[40:43], s33 offen offset:0 sc1
v_mfma_f32_16x16x32_bf16 v[212:215], a[100:103], a[92:95], v[212:215]
ds_read_b128 a[136:139], v5 offset:0
v_mfma_f32_16x16x32_bf16 v[212:215], a[96:99], a[88:91], v[212:215]
v_mfma_f32_16x16x32_bf16 v[216:219], a[104:107], a[88:91], v[216:219]
ds_read_b128 a[140:143], v5 offset:6144
v_mfma_f32_16x16x32_bf16 v[216:219], a[108:111], a[92:95], v[216:219]
ds_read_b128 v[60:63], v233 offset:192
v_mfma_f32_16x16x32_bf16 v[192:195], a[108:111], a[84:87], v[192:195]
buffer_load_dwordx4 v1, s[4:7], s44 offen offset:2048 sc1 lds
s_add_u32 m0, s18, 0x3000
v_mfma_f32_16x16x32_bf16 v[192:195], a[104:107], a[80:83], v[192:195]
s_add_u32 s44, s50, 0x1427000
ds_read_b128 a[144:147], v5 offset:1024
v_mfma_f32_16x16x32_bf16 v[168:171], a[104:107], a[72:75], v[168:171]
v_mfma_f32_16x16x32_bf16 v[168:171], a[108:111], a[76:79], v[168:171]
ds_read_b128 a[148:151], v5 offset:7168
v_mfma_f32_16x16x32_bf16 v[144:147], a[108:111], a[68:71], v[144:147]
v_mfma_f32_16x16x32_bf16 v[144:147], a[104:107], a[64:67], v[144:147]
buffer_load_dwordx4 a[40:43], v2, s[40:43], s35 offen offset:1024 sc1
v_mfma_f32_16x16x32_bf16 v[148:151], a[112:115], a[64:67], v[148:151]
v_mfma_f32_16x16x32_bf16 v[148:151], a[116:119], a[68:71], v[148:151]
v_mfma_f32_16x16x32_bf16 v[172:175], a[116:119], a[76:79], v[172:175]
ds_read_b128 v[64:67], v233 offset:256
v_mfma_f32_16x16x32_bf16 v[172:175], a[112:115], a[72:75], v[172:175]
v_mfma_f32_16x16x32_bf16 v[196:199], a[112:115], a[80:83], v[196:199]
buffer_load_dwordx4 a[44:47], v2, s[40:43], s33 offen offset:1024 sc1
v_mfma_f32_16x16x32_bf16 v[196:199], a[116:119], a[84:87], v[196:199]
v_mfma_f32_16x16x32_bf16 v[220:223], a[116:119], a[92:95], v[220:223]
v_mfma_f32_16x16x32_bf16 v[220:223], a[112:115], a[88:91], v[220:223]
s_waitcnt lgkmcnt(1)
v_mfma_f32_16x16x32_bf16 v[224:227], a[128:131], a[88:91], v[224:227]
ds_read_b128 a[96:99], v5 offset:14336
v_mfma_f32_16x16x32_bf16 v[224:227], a[132:135], a[92:95], v[224:227]
buffer_load_dwordx4 a[48:51], v2, s[40:43], s35 offen offset:2048 sc1
v_mfma_f32_16x16x32_bf16 v[200:203], a[132:135], a[84:87], v[200:203]
ds_read_b128 a[100:103], v5 offset:20480
v_mfma_f32_16x16x32_bf16 v[200:203], a[128:131], a[80:83], v[200:203]
v_mfma_f32_16x16x32_bf16 v[176:179], a[128:131], a[72:75], v[176:179]
v_mfma_f32_16x16x32_bf16 v[176:179], a[132:135], a[76:79], v[176:179]
buffer_load_dwordx4 a[52:55], v2, s[40:43], s33 offen offset:2048 sc1
v_mfma_f32_16x16x32_bf16 v[152:155], a[132:135], a[68:71], v[152:155]
ds_read_b128 a[104:107], v5 offset:15360
v_mfma_f32_16x16x32_bf16 v[152:155], a[128:131], a[64:67], v[152:155]
ds_read_b128 v[68:71], v233 offset:320
v_mfma_f32_16x16x32_bf16 v[132:135], a[136:139], a[64:67], v[132:135]
ds_read_b128 a[108:111], v5 offset:21504
v_mfma_f32_16x16x32_bf16 v[132:135], a[140:143], a[68:71], v[132:135]
v_mfma_f32_16x16x32_bf16 v[156:159], a[140:143], a[76:79], v[156:159]
buffer_load_dwordx4 v1, s[4:7], s44 offen offset:0 sc1 lds
v_mfma_f32_16x16x32_bf16 v[156:159], a[136:139], a[72:75], v[156:159]
ds_read_b128 a[112:115], v5 offset:16384
v_mfma_f32_16x16x32_bf16 v[180:183], a[136:139], a[80:83], v[180:183]
v_mfma_f32_16x16x32_bf16 v[180:183], a[140:143], a[84:87], v[180:183]
ds_read_b128 a[116:119], v5 offset:22528
v_mfma_f32_16x16x32_bf16 v[204:207], a[140:143], a[92:95], v[204:207]
v_mfma_f32_16x16x32_bf16 v[204:207], a[136:139], a[88:91], v[204:207]
buffer_load_dwordx4 a[56:59], v2, s[40:43], s35 offen offset:3072 sc1
v_mfma_f32_16x16x32_bf16 v[208:211], a[144:147], a[88:91], v[208:211]
v_mfma_f32_16x16x32_bf16 v[208:211], a[148:151], a[92:95], v[208:211]
v_mfma_f32_16x16x32_bf16 v[184:187], a[148:151], a[84:87], v[184:187]
v_mfma_f32_16x16x32_bf16 v[184:187], a[144:147], a[80:83], v[184:187]
v_mfma_f32_16x16x32_bf16 v[160:163], a[144:147], a[72:75], v[160:163]
buffer_load_dwordx4 a[60:63], v2, s[40:43], s33 offen offset:3072 sc1
s_add_u32 s35, s35, 8192
v_mfma_f32_16x16x32_bf16 v[160:163], a[148:151], a[76:79], v[160:163]
s_add_u32 s33, s33, 8192
v_mfma_f32_16x16x32_bf16 v[136:139], a[148:151], a[68:71], v[136:139]
v_mfma_f32_16x16x32_bf16 v[136:139], a[144:147], a[64:67], v[136:139]
s_waitcnt vmcnt(10) lgkmcnt(0)
v_mfma_f32_16x16x32_bf16 v[140:143], a[96:99], a[0:3], v[140:143]
ds_read_b128 a[128:131], v5 offset:17408
v_add_f32 v92, v92, v96
v_mfma_f32_16x16x32_bf16 v[140:143], a[100:103], a[4:7], v[140:143]
buffer_load_dwordx4 a[64:67], v2, s[40:43], s35 offen offset:0 sc1
v_mfma_f32_16x16x32_bf16 v[164:167], a[100:103], a[12:15], v[164:167]
ds_read_b128 a[132:135], v5 offset:23552
v_add_f32 v100, v100, v104
v_mfma_f32_16x16x32_bf16 v[164:167], a[96:99], a[8:11], v[164:167]
v_add_f32 v108, v108, v112
v_add_f32 v116, v116, v120
v_mfma_f32_16x16x32_bf16 v[188:191], a[96:99], a[16:19], v[188:191]
v_add_f32 v93, v93, v97
v_add_f32 v101, v101, v105
v_mfma_f32_16x16x32_bf16 v[188:191], a[100:103], a[20:23], v[188:191]
buffer_load_dwordx4 v1, s[4:7], s44 offen offset:1024 sc1 lds
v_mfma_f32_16x16x32_bf16 v[212:215], a[100:103], a[28:31], v[212:215]
ds_read_b128 a[136:139], v5 offset:12288
v_add_f32 v109, v109, v113
v_mfma_f32_16x16x32_bf16 v[212:215], a[96:99], a[24:27], v[212:215]
v_add_f32 v117, v117, v121
v_add_f32 v94, v94, v98
v_mfma_f32_16x16x32_bf16 v[216:219], a[104:107], a[24:27], v[216:219]
ds_read_b128 a[140:143], v5 offset:18432
v_add_f32 v102, v102, v106
v_mfma_f32_16x16x32_bf16 v[216:219], a[108:111], a[28:31], v[216:219]
buffer_load_dwordx4 a[68:71], v2, s[40:43], s33 offen offset:0 sc1
v_mfma_f32_16x16x32_bf16 v[192:195], a[108:111], a[20:23], v[192:195]
ds_read_b128 a[144:147], v5 offset:13312
v_add_f32 v110, v110, v114
v_mfma_f32_16x16x32_bf16 v[192:195], a[104:107], a[16:19], v[192:195]
v_add_f32 v118, v118, v122
v_add_f32 v95, v95, v99
v_mfma_f32_16x16x32_bf16 v[168:171], a[104:107], a[8:11], v[168:171]
v_add_f32 v103, v103, v107
v_mfma_f32_16x16x32_bf16 v[168:171], a[108:111], a[12:15], v[168:171]
buffer_load_dwordx4 a[72:75], v2, s[40:43], s35 offen offset:1024 sc1
v_mfma_f32_16x16x32_bf16 v[144:147], a[108:111], a[4:7], v[144:147]
ds_read_b128 a[148:151], v5 offset:19456
v_add_f32 v111, v111, v115
v_mfma_f32_16x16x32_bf16 v[144:147], a[104:107], a[0:3], v[144:147]
v_add_f32 v119, v119, v123
v_add_f32_dpp v92, v92, v92 row_ror:8 row_mask:0xf bank_mask:0xf
v_mfma_f32_16x16x32_bf16 v[148:151], a[112:115], a[0:3], v[148:151]
v_add_f32_dpp v100, v100, v100 row_ror:8 row_mask:0xf bank_mask:0xf
v_mfma_f32_16x16x32_bf16 v[148:151], a[116:119], a[4:7], v[148:151]
buffer_load_dwordx4 v1, s[4:7], s44 offen offset:2048 sc1 lds
s_add_u32 m0, s18, 0x6000
v_mfma_f32_16x16x32_bf16 v[172:175], a[116:119], a[12:15], v[172:175]
s_add_u32 s44, s50, 0x142a000
v_add_f32_dpp v108, v108, v108 row_ror:8 row_mask:0xf bank_mask:0xf
v_mfma_f32_16x16x32_bf16 v[172:175], a[112:115], a[8:11], v[172:175]
v_add_f32_dpp v116, v116, v116 row_ror:8 row_mask:0xf bank_mask:0xf
v_add_f32_dpp v93, v93, v93 row_ror:8 row_mask:0xf bank_mask:0xf
v_mfma_f32_16x16x32_bf16 v[196:199], a[112:115], a[16:19], v[196:199]
v_add_f32_dpp v101, v101, v101 row_ror:8 row_mask:0xf bank_mask:0xf
v_mfma_f32_16x16x32_bf16 v[196:199], a[116:119], a[20:23], v[196:199]
buffer_load_dwordx4 a[76:79], v2, s[40:43], s33 offen offset:1024 sc1
v_mfma_f32_16x16x32_bf16 v[220:223], a[116:119], a[28:31], v[220:223]
v_add_f32_dpp v109, v109, v109 row_ror:8 row_mask:0xf bank_mask:0xf
v_add_f32_dpp v117, v117, v117 row_ror:8 row_mask:0xf bank_mask:0xf
v_mfma_f32_16x16x32_bf16 v[220:223], a[112:115], a[24:27], v[220:223]
v_add_f32_dpp v92, v94, v94 row_ror:8 row_mask:0xf bank_mask:0xc
s_waitcnt lgkmcnt(0)
v_mfma_f32_16x16x32_bf16 v[224:227], a[128:131], a[24:27], v[224:227]
ds_read_b128 a[96:99], v5 offset:26624
v_accvgpr_write_b32 a216, v48
v_mfma_f32_16x16x32_bf16 v[224:227], a[132:135], a[28:31], v[224:227]
buffer_load_dwordx4 a[80:83], v2, s[40:43], s35 offen offset:2048 sc1
v_mfma_f32_16x16x32_bf16 v[200:203], a[132:135], a[20:23], v[200:203]
ds_read_b128 a[100:103], v5 offset:32768
v_add_f32_dpp v100, v102, v102 row_ror:8 row_mask:0xf bank_mask:0xc
v_mfma_f32_16x16x32_bf16 v[200:203], a[128:131], a[16:19], v[200:203]
v_accvgpr_write_b32 a217, v49
v_add_f32_dpp v108, v110, v110 row_ror:8 row_mask:0xf bank_mask:0xc
v_mfma_f32_16x16x32_bf16 v[176:179], a[128:131], a[8:11], v[176:179]
v_add_f32_dpp v116, v118, v118 row_ror:8 row_mask:0xf bank_mask:0xc
v_add_f32_dpp v93, v95, v95 row_ror:8 row_mask:0xf bank_mask:0xc
v_mfma_f32_16x16x32_bf16 v[176:179], a[132:135], a[12:15], v[176:179]
buffer_load_dwordx4 a[84:87], v2, s[40:43], s33 offen offset:2048 sc1
v_mfma_f32_16x16x32_bf16 v[152:155], a[132:135], a[4:7], v[152:155]
ds_read_b128 a[104:107], v5 offset:27648
v_accvgpr_write_b32 a218, v50
v_mfma_f32_16x16x32_bf16 v[152:155], a[128:131], a[0:3], v[152:155]
v_add_f32_dpp v101, v103, v103 row_ror:8 row_mask:0xf bank_mask:0xc
v_add_f32_dpp v109, v111, v111 row_ror:8 row_mask:0xf bank_mask:0xc
v_mfma_f32_16x16x32_bf16 v[132:135], a[136:139], a[0:3], v[132:135]
ds_read_b128 a[108:111], v5 offset:33792
v_add_f32_dpp v117, v119, v119 row_ror:8 row_mask:0xf bank_mask:0xc
v_mfma_f32_16x16x32_bf16 v[132:135], a[140:143], a[4:7], v[132:135]
v_accvgpr_write_b32 a219, v51
v_mfma_f32_16x16x32_bf16 v[156:159], a[140:143], a[12:15], v[156:159]
buffer_load_dwordx4 v1, s[4:7], s44 offen offset:0 sc1 lds
v_mfma_f32_16x16x32_bf16 v[156:159], a[136:139], a[8:11], v[156:159]
ds_read_b128 a[112:115], v5 offset:28672
v_mfma_f32_16x16x32_bf16 v[180:183], a[136:139], a[16:19], v[180:183]
v_accvgpr_write_b32 a220, v52
v_mfma_f32_16x16x32_bf16 v[180:183], a[140:143], a[20:23], v[180:183]
ds_read_b128 a[116:119], v5 offset:34816
v_mfma_f32_16x16x32_bf16 v[204:207], a[140:143], a[28:31], v[204:207]
v_permlane32_swap_b32 v92, v93
v_mfma_f32_16x16x32_bf16 v[204:207], a[136:139], a[24:27], v[204:207]
buffer_load_dwordx4 a[88:91], v2, s[40:43], s35 offen offset:3072 sc1
v_mfma_f32_16x16x32_bf16 v[208:211], a[144:147], a[24:27], v[208:211]
v_accvgpr_write_b32 a221, v53
v_mfma_f32_16x16x32_bf16 v[208:211], a[148:151], a[28:31], v[208:211]
v_permlane32_swap_b32 v100, v101
v_mfma_f32_16x16x32_bf16 v[184:187], a[148:151], a[20:23], v[184:187]
v_accvgpr_write_b32 a222, v54
v_mfma_f32_16x16x32_bf16 v[184:187], a[144:147], a[16:19], v[184:187]
v_permlane32_swap_b32 v108, v109
v_mfma_f32_16x16x32_bf16 v[160:163], a[144:147], a[8:11], v[160:163]
buffer_load_dwordx4 a[92:95], v2, s[40:43], s33 offen offset:3072 sc1
s_add_u32 s35, s35, 8192
v_mfma_f32_16x16x32_bf16 v[160:163], a[148:151], a[12:15], v[160:163]
s_add_u32 s33, s33, 8192
v_accvgpr_write_b32 a223, v55
v_mfma_f32_16x16x32_bf16 v[136:139], a[148:151], a[4:7], v[136:139]
v_permlane32_swap_b32 v116, v117
v_mfma_f32_16x16x32_bf16 v[136:139], a[144:147], a[0:3], v[136:139]
v_add_f32 v92, v92, v93
s_waitcnt vmcnt(11) lgkmcnt(0)
v_mfma_f32_16x16x32_bf16 v[140:143], a[96:99], a[32:35], v[140:143]
ds_read_b128 a[128:131], v5 offset:29696
v_accvgpr_write_b32 a224, v56
v_mfma_f32_16x16x32_bf16 v[140:143], a[100:103], a[36:39], v[140:143]
buffer_load_dwordx4 a[0:3], v2, s[40:43], s35 offen offset:0 sc1
v_mfma_f32_16x16x32_bf16 v[164:167], a[100:103], a[44:47], v[164:167]
ds_read_b128 a[132:135], v5 offset:35840
v_add_f32 v100, v100, v101
v_mfma_f32_16x16x32_bf16 v[164:167], a[96:99], a[40:43], v[164:167]
v_accvgpr_write_b32 a225, v57
v_add_f32 v108, v108, v109
v_mfma_f32_16x16x32_bf16 v[188:191], a[96:99], a[48:51], v[188:191]
v_add_f32 v116, v116, v117
v_mov_b32 v94, v92
v_mfma_f32_16x16x32_bf16 v[188:191], a[100:103], a[52:55], v[188:191]
buffer_load_dwordx4 a[4:7], v2, s[40:43], s33 offen offset:0 sc1
v_mfma_f32_16x16x32_bf16 v[212:215], a[100:103], a[60:63], v[212:215]
ds_read_b128 a[136:139], v5 offset:24576
v_accvgpr_write_b32 a226, v58
v_mfma_f32_16x16x32_bf16 v[212:215], a[96:99], a[56:59], v[212:215]
v_mov_b32 v102, v100
v_mov_b32 v110, v108
v_mfma_f32_16x16x32_bf16 v[216:219], a[104:107], a[56:59], v[216:219]
ds_read_b128 a[140:143], v5 offset:30720
v_mov_b32 v118, v116
v_mfma_f32_16x16x32_bf16 v[216:219], a[108:111], a[60:63], v[216:219]
v_accvgpr_write_b32 a227, v59
v_mfma_f32_16x16x32_bf16 v[192:195], a[108:111], a[52:55], v[192:195]
buffer_load_dwordx4 v1, s[4:7], s44 offen offset:1024 sc1 lds
v_mfma_f32_16x16x32_bf16 v[192:195], a[104:107], a[48:51], v[192:195]
ds_read_b128 a[144:147], v5 offset:25600
v_mfma_f32_16x16x32_bf16 v[168:171], a[104:107], a[40:43], v[168:171]
v_accvgpr_write_b32 a228, v60
v_mfma_f32_16x16x32_bf16 v[168:171], a[108:111], a[44:47], v[168:171]
ds_read_b128 a[148:151], v5 offset:31744
v_mfma_f32_16x16x32_bf16 v[144:147], a[108:111], a[36:39], v[144:147]
v_permlane16_swap_b32 v92, v94
v_mfma_f32_16x16x32_bf16 v[144:147], a[104:107], a[32:35], v[144:147]
buffer_load_dwordx4 a[8:11], v2, s[40:43], s35 offen offset:1024 sc1
v_mfma_f32_16x16x32_bf16 v[148:151], a[112:115], a[32:35], v[148:151]
v_accvgpr_write_b32 a229, v61
v_mfma_f32_16x16x32_bf16 v[148:151], a[116:119], a[36:39], v[148:151]
v_permlane16_swap_b32 v100, v102
v_mfma_f32_16x16x32_bf16 v[172:175], a[116:119], a[44:47], v[172:175]
v_accvgpr_write_b32 a230, v62
v_mfma_f32_16x16x32_bf16 v[172:175], a[112:115], a[40:43], v[172:175]
v_permlane16_swap_b32 v108, v110
v_mfma_f32_16x16x32_bf16 v[196:199], a[112:115], a[48:51], v[196:199]
buffer_load_dwordx4 a[12:15], v2, s[40:43], s33 offen offset:1024 sc1
v_mfma_f32_16x16x32_bf16 v[196:199], a[116:119], a[52:55], v[196:199]
v_accvgpr_write_b32 a231, v63
v_mfma_f32_16x16x32_bf16 v[220:223], a[116:119], a[60:63], v[220:223]
v_permlane16_swap_b32 v116, v118
v_mfma_f32_16x16x32_bf16 v[220:223], a[112:115], a[56:59], v[220:223]
v_add_f32 v92, v92, v94
s_waitcnt lgkmcnt(0)
v_mfma_f32_16x16x32_bf16 v[224:227], a[128:131], a[56:59], v[224:227]
ds_read_b128 a[96:99], v5 offset:38912
v_accvgpr_write_b32 a232, v64
v_mfma_f32_16x16x32_bf16 v[224:227], a[132:135], a[60:63], v[224:227]
buffer_load_dwordx4 a[16:19], v2, s[40:43], s35 offen offset:2048 sc1
v_mfma_f32_16x16x32_bf16 v[200:203], a[132:135], a[52:55], v[200:203]
ds_read_b128 a[100:103], v5 offset:45056
v_add_f32 v100, v100, v102
v_mfma_f32_16x16x32_bf16 v[200:203], a[128:131], a[48:51], v[200:203]
v_accvgpr_write_b32 a233, v65
v_add_f32 v108, v108, v110
v_mfma_f32_16x16x32_bf16 v[176:179], a[128:131], a[40:43], v[176:179]
v_add_f32 v116, v116, v118
v_mov_b32 v94, v92
v_mfma_f32_16x16x32_bf16 v[176:179], a[132:135], a[44:47], v[176:179]
buffer_load_dwordx4 v1, s[4:7], s44 offen offset:2048 sc1 lds
s_add_u32 m0, s18, 0x9000
v_mfma_f32_16x16x32_bf16 v[152:155], a[132:135], a[36:39], v[152:155]
s_add_u32 s44, s50, 0x142d000
ds_read_b128 a[104:107], v5 offset:39936
v_mfma_f32_16x16x32_bf16 v[152:155], a[128:131], a[32:35], v[152:155]
v_accvgpr_write_b32 a234, v66
v_mov_b32 v102, v100
v_mfma_f32_16x16x32_bf16 v[132:135], a[136:139], a[32:35], v[132:135]
ds_read_b128 a[108:111], v5 offset:46080
v_mov_b32 v110, v108
v_mfma_f32_16x16x32_bf16 v[132:135], a[140:143], a[36:39], v[132:135]
buffer_load_dwordx4 a[20:23], v2, s[40:43], s33 offen offset:2048 sc1
v_mfma_f32_16x16x32_bf16 v[156:159], a[140:143], a[44:47], v[156:159]
ds_read_b128 a[112:115], v5 offset:40960
v_accvgpr_write_b32 a235, v67
v_mfma_f32_16x16x32_bf16 v[156:159], a[136:139], a[40:43], v[156:159]
v_mov_b32 v118, v116
v_mfma_f32_16x16x32_bf16 v[180:183], a[136:139], a[48:51], v[180:183]
v_accvgpr_write_b32 a236, v68
v_mfma_f32_16x16x32_bf16 v[180:183], a[140:143], a[52:55], v[180:183]
buffer_load_dwordx4 a[24:27], v2, s[40:43], s35 offen offset:3072 sc1
v_mfma_f32_16x16x32_bf16 v[204:207], a[140:143], a[60:63], v[204:207]
ds_read_b128 a[116:119], v5 offset:47104
v_mfma_f32_16x16x32_bf16 v[204:207], a[136:139], a[56:59], v[204:207]
v_accvgpr_write_b32 a237, v69
v_mfma_f32_16x16x32_bf16 v[208:211], a[144:147], a[56:59], v[208:211]
v_permlane32_swap_b32 v92, v94
v_mfma_f32_16x16x32_bf16 v[208:211], a[148:151], a[60:63], v[208:211]
buffer_load_dwordx4 v1, s[4:7], s44 offen offset:0 sc1 lds
v_mfma_f32_16x16x32_bf16 v[184:187], a[148:151], a[52:55], v[184:187]
v_accvgpr_write_b32 a238, v70
v_mfma_f32_16x16x32_bf16 v[184:187], a[144:147], a[48:51], v[184:187]
v_permlane32_swap_b32 v100, v102
v_mfma_f32_16x16x32_bf16 v[160:163], a[144:147], a[40:43], v[160:163]
v_permlane32_swap_b32 v108, v110
v_mfma_f32_16x16x32_bf16 v[160:163], a[148:151], a[44:47], v[160:163]
buffer_load_dwordx4 a[28:31], v2, s[40:43], s33 offen offset:3072 sc1
s_add_u32 s35, s35, 8192
v_mfma_f32_16x16x32_bf16 v[136:139], a[148:151], a[36:39], v[136:139]
s_add_u32 s33, s33, 8192
v_accvgpr_write_b32 a239, v71
v_mfma_f32_16x16x32_bf16 v[136:139], a[144:147], a[32:35], v[136:139]
s_waitcnt vmcnt(11) lgkmcnt(0)
v_mfma_f32_16x16x32_bf16 v[140:143], a[96:99], a[64:67], v[140:143]
ds_read_b128 a[128:131], v5 offset:41984
v_mfma_f32_16x16x32_bf16 v[140:143], a[100:103], a[68:71], v[140:143]
buffer_load_dwordx4 a[32:35], v2, s[40:43], s35 offen offset:0 sc1
v_mfma_f32_16x16x32_bf16 v[164:167], a[100:103], a[76:79], v[164:167]
ds_read_b128 a[132:135], v5 offset:48128
v_mfma_f32_16x16x32_bf16 v[164:167], a[96:99], a[72:75], v[164:167]
v_permlane32_swap_b32 v116, v118
v_mfma_f32_16x16x32_bf16 v[188:191], a[96:99], a[80:83], v[188:191]
v_mul_f32 v82, 0xba800000, v92
v_mul_f32 v84, 0xba800000, v100
v_mfma_f32_16x16x32_bf16 v[188:191], a[100:103], a[84:87], v[188:191]
buffer_load_dwordx4 a[36:39], v2, s[40:43], s33 offen offset:0 sc1
v_mfma_f32_16x16x32_bf16 v[212:215], a[100:103], a[92:95], v[212:215]
ds_read_b128 a[136:139], v5 offset:36864
v_mul_f32 v86, 0xba800000, v108
v_mfma_f32_16x16x32_bf16 v[212:215], a[96:99], a[88:91], v[212:215]
v_mul_f32 v88, 0xba800000, v116
v_mul_f32 v94, 0x3a800000, v94
v_mul_f32 v102, 0x3a800000, v102
v_mul_f32 v110, 0x3a800000, v110
v_mul_f32 v118, 0x3a800000, v118
v_fma_f32 v94, -v82, v82, v94
v_fma_f32 v102, -v84, v84, v102
v_fma_f32 v110, -v86, v86, v110
v_fma_f32 v118, -v88, v88, v118
v_max_f32 v94, 0, v94
v_max_f32 v102, 0, v102
v_max_f32 v110, 0, v110
v_max_f32 v118, 0, v118
v_add_f32 v94, 0x3727c5ac, v94
v_add_f32 v102, 0x3727c5ac, v102
v_add_f32 v110, 0x3727c5ac, v110
v_add_f32 v118, 0x3727c5ac, v118
v_rsq_f32 v83, v94
v_rsq_f32 v85, v102
v_rsq_f32 v87, v110
v_rsq_f32 v89, v118
v_mfma_f32_16x16x32_bf16 v[216:219], a[104:107], a[88:91], v[216:219]
ds_read_b128 a[140:143], v5 offset:43008
v_mfma_f32_16x16x32_bf16 v[216:219], a[108:111], a[92:95], v[216:219]
v_mfma_f32_16x16x32_bf16 v[192:195], a[108:111], a[84:87], v[192:195]
buffer_load_dwordx4 v1, s[4:7], s44 offen offset:1024 sc1 lds
v_mfma_f32_16x16x32_bf16 v[192:195], a[104:107], a[80:83], v[192:195]
ds_read_b128 a[144:147], v5 offset:37888
v_fmac_f32 v140, v56, v82
v_mfma_f32_16x16x32_bf16 v[168:171], a[104:107], a[72:75], v[168:171]
v_fmac_f32 v164, v56, v84
v_mfma_f32_16x16x32_bf16 v[168:171], a[108:111], a[76:79], v[168:171]
ds_read_b128 a[148:151], v5 offset:44032
v_mfma_f32_16x16x32_bf16 v[144:147], a[108:111], a[68:71], v[144:147]
v_fmac_f32 v188, v56, v86
v_mfma_f32_16x16x32_bf16 v[144:147], a[104:107], a[64:67], v[144:147]
buffer_load_dwordx4 a[40:43], v2, s[40:43], s35 offen offset:1024 sc1
v_mfma_f32_16x16x32_bf16 v[148:151], a[112:115], a[64:67], v[148:151]
v_fmac_f32 v212, v56, v88
v_mfma_f32_16x16x32_bf16 v[148:151], a[116:119], a[68:71], v[148:151]
v_mfma_f32_16x16x32_bf16 v[172:175], a[116:119], a[76:79], v[172:175]
v_fmac_f32 v216, v60, v88
v_mfma_f32_16x16x32_bf16 v[172:175], a[112:115], a[72:75], v[172:175]
v_mfma_f32_16x16x32_bf16 v[196:199], a[112:115], a[80:83], v[196:199]
buffer_load_dwordx4 a[44:47], v2, s[40:43], s33 offen offset:1024 sc1
v_mfma_f32_16x16x32_bf16 v[196:199], a[116:119], a[84:87], v[196:199]
v_fmac_f32 v192, v60, v86
v_mfma_f32_16x16x32_bf16 v[220:223], a[116:119], a[92:95], v[220:223]
v_fmac_f32 v168, v60, v84
v_fmac_f32 v141, v57, v82
v_mfma_f32_16x16x32_bf16 v[220:223], a[112:115], a[88:91], v[220:223]
s_waitcnt lgkmcnt(0)
s_barrier
v_mfma_f32_16x16x32_bf16 v[224:227], a[128:131], a[88:91], v[224:227]
v_add_u32 v5, 0, v1
v_fmac_f32 v144, v60, v82
v_mfma_f32_16x16x32_bf16 v[224:227], a[132:135], a[92:95], v[224:227]
buffer_load_dwordx4 a[48:51], v2, s[40:43], s35 offen offset:2048 sc1
v_mfma_f32_16x16x32_bf16 v[200:203], a[132:135], a[84:87], v[200:203]
ds_read_b128 a[96:99], v5 offset:2048
v_fmac_f32 v148, v64, v82
L_stub6:
s_cbranch_execz L_stub7
v_mfma_f32_16x16x32_bf16 v[200:203], a[128:131], a[80:83], v[200:203]
ds_read_b128 a[100:103], v5 offset:8192
v_fmac_f32 v165, v57, v84
v_mfma_f32_16x16x32_bf16 v[176:179], a[128:131], a[72:75], v[176:179]
v_fmac_f32 v172, v64, v84
v_fmac_f32 v189, v57, v86
v_mfma_f32_16x16x32_bf16 v[176:179], a[132:135], a[76:79], v[176:179]
buffer_load_dwordx4 a[52:55], v2, s[40:43], s33 offen offset:2048 sc1
v_mfma_f32_16x16x32_bf16 v[152:155], a[132:135], a[68:71], v[152:155]
ds_read_b128 a[104:107], v5 offset:3072
v_fmac_f32 v196, v64, v86
v_mfma_f32_16x16x32_bf16 v[152:155], a[128:131], a[64:67], v[152:155]
v_fmac_f32 v213, v57, v88
v_fmac_f32 v217, v61, v88
v_mfma_f32_16x16x32_bf16 v[132:135], a[136:139], a[64:67], v[132:135]
ds_read_b128 a[108:111], v5 offset:9216
v_fmac_f32 v220, v64, v88
v_mfma_f32_16x16x32_bf16 v[132:135], a[140:143], a[68:71], v[132:135]
v_fmac_f32 v193, v61, v86
v_mfma_f32_16x16x32_bf16 v[156:159], a[140:143], a[76:79], v[156:159]
buffer_load_dwordx4 v1, s[4:7], s44 offen offset:2048 sc1 lds
s_add_u32 m0, s19, 49152
v_mfma_f32_16x16x32_bf16 v[156:159], a[136:139], a[72:75], v[156:159]
s_add_u32 s44, s85, 0xc04000
ds_read_b128 a[112:115], v5 offset:4096
v_mfma_f32_16x16x32_bf16 v[180:183], a[136:139], a[80:83], v[180:183]
v_fmac_f32 v224, v68, v88
v_fmac_f32 v200, v68, v86
v_mfma_f32_16x16x32_bf16 v[180:183], a[140:143], a[84:87], v[180:183]
ds_read_b128 a[116:119], v5 offset:10240
v_fmac_f32 v169, v61, v84
v_mfma_f32_16x16x32_bf16 v[204:207], a[140:143], a[92:95], v[204:207]
v_fmac_f32 v176, v68, v84
v_fmac_f32 v145, v61, v82
v_mfma_f32_16x16x32_bf16 v[204:207], a[136:139], a[88:91], v[204:207]
buffer_load_dwordx4 a[56:59], v2, s[40:43], s35 offen offset:3072 sc1
v_mfma_f32_16x16x32_bf16 v[208:211], a[144:147], a[88:91], v[208:211]
v_fmac_f32 v152, v68, v82
v_fmac_f32 v149, v65, v82
v_mfma_f32_16x16x32_bf16 v[208:211], a[148:151], a[92:95], v[208:211]
v_fmac_f32 v173, v65, v84
v_mfma_f32_16x16x32_bf16 v[184:187], a[148:151], a[84:87], v[184:187]
v_fmac_f32 v132, v48, v82
v_fmac_f32 v197, v65, v86
v_mfma_f32_16x16x32_bf16 v[184:187], a[144:147], a[80:83], v[184:187]
v_mfma_f32_16x16x32_bf16 v[160:163], a[144:147], a[72:75], v[160:163]
buffer_load_dwordx4 a[60:63], v2, s[40:43], s33 offen offset:3072 sc1
s_add_u32 s35, s35, 8192
v_mfma_f32_16x16x32_bf16 v[160:163], a[148:151], a[76:79], v[160:163]
s_add_u32 s33, s33, 8192
v_fmac_f32 v156, v48, v84
v_mfma_f32_16x16x32_bf16 v[136:139], a[148:151], a[68:71], v[136:139]
v_fmac_f32 v180, v48, v86
v_fmac_f32 v221, v65, v88
v_mfma_f32_16x16x32_bf16 v[136:139], a[144:147], a[64:67], v[136:139]
v_fmac_f32 v225, v69, v88
s_waitcnt vmcnt(10) lgkmcnt(0)
v_mfma_f32_16x16x32_bf16 v[140:143], a[96:99], a[0:3], v[140:143]
ds_read_b128 a[128:131], v5 offset:5120
v_fmac_f32 v204, v48, v88
v_mfma_f32_16x16x32_bf16 v[140:143], a[100:103], a[4:7], v[140:143]
buffer_load_dwordx4 a[64:67], v2, s[40:43], s35 offen offset:0 sc1
s_lshl_b32 s36, s28, 9
v_mfma_f32_16x16x32_bf16 v[164:167], a[100:103], a[12:15], v[164:167]
ds_read_b128 a[132:135], v5 offset:11264
v_fmac_f32 v208, v52, v88
v_mfma_f32_16x16x32_bf16 v[164:167], a[96:99], a[8:11], v[164:167]
v_fmac_f32 v201, v69, v86
v_fmac_f32 v177, v69, v84
v_mfma_f32_16x16x32_bf16 v[188:191], a[96:99], a[16:19], v[188:191]
v_fmac_f32 v184, v52, v86
v_fmac_f32 v153, v69, v82
v_mfma_f32_16x16x32_bf16 v[188:191], a[100:103], a[20:23], v[188:191]
buffer_load_dwordx4 a[68:71], v2, s[40:43], s33 offen offset:0 sc1
s_lshl_b32 s37, s30, 2
v_mfma_f32_16x16x32_bf16 v[212:215], a[100:103], a[28:31], v[212:215]
ds_read_b128 a[136:139], v5 offset:0
v_fmac_f32 v160, v52, v84
v_mfma_f32_16x16x32_bf16 v[212:215], a[96:99], a[24:27], v[212:215]
v_fmac_f32 v133, v49, v82
v_add_u32 v232, s19, v7
v_mfma_f32_16x16x32_bf16 v[216:219], a[104:107], a[24:27], v[216:219]
ds_read_b128 a[140:143], v5 offset:6144
v_fmac_f32 v136, v52, v82
v_mfma_f32_16x16x32_bf16 v[216:219], a[108:111], a[28:31], v[216:219]
buffer_load_dwordx4 a[72:75], v2, s[40:43], s35 offen offset:1024 sc1
s_add_u32 s37, s37, s28
v_mfma_f32_16x16x32_bf16 v[192:195], a[108:111], a[20:23], v[192:195]
ds_read_b128 a[144:147], v5 offset:1024
v_fmac_f32 v157, v49, v84
v_mfma_f32_16x16x32_bf16 v[192:195], a[104:107], a[16:19], v[192:195]
v_fmac_f32 v181, v49, v86
v_fmac_f32 v142, v58, v82
v_mfma_f32_16x16x32_bf16 v[168:171], a[104:107], a[8:11], v[168:171]
v_fmac_f32 v205, v49, v88
v_fmac_f32 v166, v58, v84
v_mfma_f32_16x16x32_bf16 v[168:171], a[108:111], a[12:15], v[168:171]
buffer_load_dwordx4 a[76:79], v2, s[40:43], s33 offen offset:1024 sc1
s_lshl_b32 s98, s37, 13
v_mfma_f32_16x16x32_bf16 v[144:147], a[108:111], a[4:7], v[144:147]
ds_read_b128 a[148:151], v5 offset:7168
v_fmac_f32 v209, v53, v88
v_mfma_f32_16x16x32_bf16 v[144:147], a[104:107], a[0:3], v[144:147]
v_fmac_f32 v190, v58, v86
s_add_u32 s98, s98, 0x400000
v_mfma_f32_16x16x32_bf16 v[148:151], a[112:115], a[0:3], v[148:151]
v_fmac_f32 v185, v53, v86
v_fmac_f32 v214, v58, v88
v_mfma_f32_16x16x32_bf16 v[148:151], a[116:119], a[4:7], v[148:151]
buffer_load_dwordx4 a[80:83], v2, s[40:43], s35 offen offset:2048 sc1
s_add_u32 s99, s98, 4096
v_mfma_f32_16x16x32_bf16 v[172:175], a[116:119], a[12:15], v[172:175]
v_fmac_f32 v161, v53, v84
v_fmac_f32 v218, v62, v88
v_mfma_f32_16x16x32_bf16 v[172:175], a[112:115], a[8:11], v[172:175]
s_lshl_b32 s100, s37, 10
s_add_u32 s100, s100, 0x800000
s_lshl_b32 s96, s29, 10
v_mfma_f32_16x16x32_bf16 v[196:199], a[112:115], a[16:19], v[196:199]
v_fmac_f32 v137, v53, v82
v_fmac_f32 v194, v62, v86
v_mfma_f32_16x16x32_bf16 v[196:199], a[116:119], a[20:23], v[196:199]
buffer_load_dwordx4 a[84:87], v2, s[40:43], s33 offen offset:2048 sc1
s_add_u32 s96, s96, s98
v_mfma_f32_16x16x32_bf16 v[220:223], a[116:119], a[28:31], v[220:223]
v_fmac_f32 v170, v62, v84
v_fmac_f32 v143, v59, v82
v_mfma_f32_16x16x32_bf16 v[220:223], a[112:115], a[24:27], v[220:223]
s_lshl_b32 s97, s29, 7
s_waitcnt lgkmcnt(0)
v_mfma_f32_16x16x32_bf16 v[224:227], a[128:131], a[24:27], v[224:227]
ds_read_b128 a[96:99], v5 offset:14336
v_fmac_f32 v146, v62, v82
v_mfma_f32_16x16x32_bf16 v[224:227], a[132:135], a[28:31], v[224:227]
buffer_load_dwordx4 a[88:91], v2, s[40:43], s35 offen offset:3072 sc1
s_add_u32 s97, s97, s100
v_mfma_f32_16x16x32_bf16 v[200:203], a[132:135], a[20:23], v[200:203]
ds_read_b128 a[100:103], v5 offset:20480
v_fmac_f32 v150, v66, v82
v_mfma_f32_16x16x32_bf16 v[200:203], a[128:131], a[16:19], v[200:203]
v_fmac_f32 v167, v59, v84
v_fmac_f32 v191, v59, v86
v_mfma_f32_16x16x32_bf16 v[176:179], a[128:131], a[8:11], v[176:179]
v_fmac_f32 v174, v66, v84
v_fmac_f32 v215, v59, v88
v_mfma_f32_16x16x32_bf16 v[176:179], a[132:135], a[12:15], v[176:179]
ds_read_b128 a[104:107], v5 offset:15360
s_lshl_b32 s88, s28, 6
v_mfma_f32_16x16x32_bf16 v[152:155], a[132:135], a[4:7], v[152:155]
v_fmac_f32 v198, v66, v86
v_fmac_f32 v219, v63, v88
v_mfma_f32_16x16x32_bf16 v[152:155], a[128:131], a[0:3], v[152:155]
buffer_load_dwordx4 v1, s[4:7], s44 offen offset:0 sc1 lds
s_add_u32 s94, s80, s88
v_mfma_f32_16x16x32_bf16 v[132:135], a[136:139], a[0:3], v[132:135]
ds_read_b128 a[108:111], v5 offset:21504
v_fmac_f32 v222, v66, v88
v_mfma_f32_16x16x32_bf16 v[132:135], a[140:143], a[4:7], v[132:135]
v_fmac_f32 v195, v63, v86
s_add_u32 s94, s94, 0x80000
v_mfma_f32_16x16x32_bf16 v[156:159], a[140:143], a[12:15], v[156:159]
ds_read_b128 a[112:115], v5 offset:16384
v_fmac_f32 v226, v70, v88
v_mfma_f32_16x16x32_bf16 v[156:159], a[136:139], a[8:11], v[156:159]
v_fmac_f32 v171, v63, v84
s_add_u32 s88, s88, s70
v_mfma_f32_16x16x32_bf16 v[180:183], a[136:139], a[16:19], v[180:183]
v_fmac_f32 v202, v70, v86
v_fmac_f32 v147, v63, v82
v_mfma_f32_16x16x32_bf16 v[180:183], a[140:143], a[20:23], v[180:183]
buffer_load_dwordx4 a[92:95], v2, s[40:43], s33 offen offset:3072 sc1
s_add_u32 s35, s35, 8192
v_mfma_f32_16x16x32_bf16 v[204:207], a[140:143], a[28:31], v[204:207]
s_add_u32 s33, s33, 8192
ds_read_b128 a[116:119], v5 offset:22528
v_mfma_f32_16x16x32_bf16 v[204:207], a[136:139], a[24:27], v[204:207]
v_fmac_f32 v178, v70, v84
v_fmac_f32 v151, v67, v82
v_mfma_f32_16x16x32_bf16 v[208:211], a[144:147], a[24:27], v[208:211]
v_fmac_f32 v154, v70, v82
v_fmac_f32 v175, v67, v84
v_mfma_f32_16x16x32_bf16 v[208:211], a[148:151], a[28:31], v[208:211]
s_add_u32 s89, s88, 0x80000
s_add_u32 s74, s71, 0x10080
s_lshl_b32 s73, s30, 12
v_mfma_f32_16x16x32_bf16 v[184:187], a[148:151], a[20:23], v[184:187]
v_fmac_f32 v134, v50, v82
v_fmac_f32 v199, v67, v86
v_mfma_f32_16x16x32_bf16 v[184:187], a[144:147], a[16:19], v[184:187]
buffer_load_dwordx4 v1, s[4:7], s44 offen offset:1024 sc1 lds
s_add_u32 s72, s73, 0x2600000
v_mfma_f32_16x16x32_bf16 v[160:163], a[144:147], a[8:11], v[160:163]
v_fmac_f32 v158, v50, v84
v_fmac_f32 v223, v67, v88
v_mfma_f32_16x16x32_bf16 v[160:163], a[148:151], a[12:15], v[160:163]
s_add_u32 s73, s73, 0x1e00000
s_lshr_b32 s38, s28, 1
s_and_b32 s39, s28, 1
v_mfma_f32_16x16x32_bf16 v[136:139], a[148:151], a[4:7], v[136:139]
v_fmac_f32 v182, v50, v86
v_fmac_f32 v227, v71, v88
v_mfma_f32_16x16x32_bf16 v[136:139], a[144:147], a[0:3], v[136:139]
s_waitcnt vmcnt(10) lgkmcnt(0)
s_barrier
v_mfma_f32_16x16x32_bf16 v[140:143], a[96:99], a[32:35], v[140:143]
ds_read_b128 a[128:131], v5 offset:17408
v_fmac_f32 v206, v50, v88
v_mfma_f32_16x16x32_bf16 v[140:143], a[100:103], a[36:39], v[140:143]
buffer_load_dwordx4 a[0:3], v2, s[40:43], s35 offen offset:0 sc1
s_mul_i32 s38, s38, 3072
v_mfma_f32_16x16x32_bf16 v[164:167], a[100:103], a[44:47], v[164:167]
ds_read_b128 a[132:135], v5 offset:23552
v_fmac_f32 v210, v54, v88
v_mfma_f32_16x16x32_bf16 v[164:167], a[96:99], a[40:43], v[164:167]
v_fmac_f32 v203, v71, v86
v_fmac_f32 v179, v71, v84
v_mfma_f32_16x16x32_bf16 v[188:191], a[96:99], a[48:51], v[188:191]
buffer_load_dwordx4 a[4:7], v2, s[40:43], s33 offen offset:0 sc1
s_lshl_b32 s39, s39, 3
v_mfma_f32_16x16x32_bf16 v[188:191], a[100:103], a[52:55], v[188:191]
ds_read_b128 a[136:139], v5 offset:26624
v_fmac_f32 v186, v54, v86
v_mfma_f32_16x16x32_bf16 v[212:215], a[100:103], a[60:63], v[212:215]
v_fmac_f32 v162, v54, v84
v_fmac_f32 v155, v71, v82
v_mfma_f32_16x16x32_bf16 v[212:215], a[96:99], a[56:59], v[212:215]
buffer_load_dwordx4 a[8:11], v2, s[40:43], s35 offen offset:1024 sc1
s_add_u32 s38, s38, s39
v_mfma_f32_16x16x32_bf16 v[216:219], a[104:107], a[56:59], v[216:219]
ds_read_b128 a[140:143], v5 offset:32768
v_fmac_f32 v138, v54, v82
v_mfma_f32_16x16x32_bf16 v[216:219], a[108:111], a[60:63], v[216:219]
v_fmac_f32 v135, v51, v82
v_fmac_f32 v159, v51, v84
v_mfma_f32_16x16x32_bf16 v[192:195], a[108:111], a[52:55], v[192:195]
buffer_load_dwordx4 a[12:15], v2, s[40:43], s33 offen offset:1024 sc1
s_add_u32 s91, s83, 0x980000
v_mfma_f32_16x16x32_bf16 v[192:195], a[104:107], a[48:51], v[192:195]
ds_read_b128 a[144:147], v5 offset:27648
v_fmac_f32 v183, v51, v86
v_mfma_f32_16x16x32_bf16 v[168:171], a[104:107], a[40:43], v[168:171]
v_fmac_f32 v207, v51, v88
v_add_u32 v233, s19, v232
v_mfma_f32_16x16x32_bf16 v[168:171], a[108:111], a[44:47], v[168:171]
buffer_load_dwordx4 a[16:19], v2, s[40:43], s35 offen offset:2048 sc1
v_mfma_f32_16x16x32_bf16 v[144:147], a[108:111], a[36:39], v[144:147]
ds_read_b128 a[148:151], v5 offset:33792
v_fmac_f32 v211, v55, v88
v_mfma_f32_16x16x32_bf16 v[144:147], a[104:107], a[32:35], v[144:147]
v_mul_f32 v88, 0x3fb8aa3b, v89
v_and_b32 v248, 7, v0
v_mfma_f32_16x16x32_bf16 v[148:151], a[112:115], a[32:35], v[148:151]
buffer_load_dwordx4 a[20:23], v2, s[40:43], s33 offen offset:2048 sc1
v_mfma_f32_16x16x32_bf16 v[148:151], a[116:119], a[36:39], v[148:151]
v_fmac_f32 v187, v55, v86
v_lshlrev_b32 v248, 7, v248
v_mfma_f32_16x16x32_bf16 v[172:175], a[116:119], a[44:47], v[172:175]
v_fmac_f32 v163, v55, v84
v_mul_f32 v86, 0x3fb8aa3b, v87
v_mfma_f32_16x16x32_bf16 v[172:175], a[112:115], a[40:43], v[172:175]
buffer_load_dwordx4 a[24:27], v2, s[40:43], s35 offen offset:3072 sc1
v_mfma_f32_16x16x32_bf16 v[196:199], a[112:115], a[48:51], v[196:199]
v_fmac_f32 v139, v55, v82
v_mul_f32 v84, 0x3fb8aa3b, v85
v_mfma_f32_16x16x32_bf16 v[196:199], a[116:119], a[52:55], v[196:199]
v_mul_f32 v82, 0x3fb8aa3b, v83
v_lshrrev_b32 v249, 4, v0
v_mfma_f32_16x16x32_bf16 v[220:223], a[116:119], a[60:63], v[220:223]
buffer_load_dwordx4 a[28:31], v2, s[40:43], s33 offen offset:3072 sc1
s_add_u32 s35, s35, 8192
v_mfma_f32_16x16x32_bf16 v[220:223], a[112:115], a[56:59], v[220:223]
s_add_u32 s33, s33, 8192
s_waitcnt lgkmcnt(0)
v_mfma_f32_16x16x32_bf16 v[224:227], a[128:131], a[56:59], v[224:227]
ds_read_b128 a[96:99], v5 offset:28672
v_lshlrev_b32 v235, 8, v0
v_mfma_f32_16x16x32_bf16 v[224:227], a[132:135], a[60:63], v[224:227]
buffer_load_dwordx4 v1, s[4:7], s44 offen offset:2048 sc1 lds
v_mfma_f32_16x16x32_bf16 v[200:203], a[132:135], a[52:55], v[200:203]
ds_read_b128 a[100:103], v5 offset:34816
v_lshl_add_u32 v248, v249, 4, v248
v_mfma_f32_16x16x32_bf16 v[200:203], a[128:131], a[48:51], v[200:203]
v_add_u32 v234, s36, v8
v_cndmask_b32 v235, 2.0, v235, s[64:65]
v_mfma_f32_16x16x32_bf16 v[176:179], a[128:131], a[40:43], v[176:179]
v_mov_b32 v249, 0x3f80
v_mov_b32 v250, 1.0
v_mfma_f32_16x16x32_bf16 v[176:179], a[132:135], a[44:47], v[176:179]
ds_read_b128 a[104:107], v5 offset:29696
v_add_u32 v252, s38, v1
v_mfma_f32_16x16x32_bf16 v[152:155], a[132:135], a[36:39], v[152:155]
v_mfma_f32_16x16x32_bf16 v[152:155], a[128:131], a[32:35], v[152:155]
s_waitcnt vmcnt(18)
v_mfma_f32_16x16x32_bf16 v[140:143], a[136:139], a[64:67], v[140:143]
ds_read_b128 a[108:111], v5 offset:35840
s_waitcnt vmcnt(17)
v_mfma_f32_16x16x32_bf16 v[140:143], a[140:143], a[68:71], v[140:143]
s_waitcnt vmcnt(15)
v_mfma_f32_16x16x32_bf16 v[164:167], a[140:143], a[76:79], v[164:167]
ds_read_b128 a[112:115], v5 offset:38912
v_mfma_f32_16x16x32_bf16 v[164:167], a[136:139], a[72:75], v[164:167]
s_waitcnt vmcnt(14)
v_mfma_f32_16x16x32_bf16 v[188:191], a[136:139], a[80:83], v[188:191]
s_waitcnt vmcnt(13)
v_mfma_f32_16x16x32_bf16 v[188:191], a[140:143], a[84:87], v[188:191]
buffer_load_dwordx4 v1, s[4:7], s44 offen offset:3072 sc1 lds
s_add_u32 m0, s19, 65536
s_waitcnt vmcnt(11)
v_mfma_f32_16x16x32_bf16 v[212:215], a[140:143], a[92:95], v[212:215]
s_add_u32 s44, s84, 0xc08000
ds_read_b128 a[116:119], v5 offset:45056
v_mfma_f32_16x16x32_bf16 v[212:215], a[136:139], a[88:91], v[212:215]
v_mfma_f32_16x16x32_bf16 v[216:219], a[144:147], a[88:91], v[216:219]
v_mfma_f32_16x16x32_bf16 v[216:219], a[148:151], a[92:95], v[216:219]
v_mfma_f32_16x16x32_bf16 v[192:195], a[148:151], a[84:87], v[192:195]
v_mfma_f32_16x16x32_bf16 v[192:195], a[144:147], a[80:83], v[192:195]
v_mfma_f32_16x16x32_bf16 v[168:171], a[144:147], a[72:75], v[168:171]
v_mfma_f32_16x16x32_bf16 v[168:171], a[148:151], a[76:79], v[168:171]
v_mfma_f32_16x16x32_bf16 v[144:147], a[148:151], a[68:71], v[144:147]
v_mfma_f32_16x16x32_bf16 v[144:147], a[144:147], a[64:67], v[144:147]
s_waitcnt lgkmcnt(0)
v_mfma_f32_16x16x32_bf16 v[148:151], a[96:99], a[64:67], v[148:151]
ds_read_b128 a[128:131], v5 offset:39936
v_mfma_f32_16x16x32_bf16 v[148:151], a[100:103], a[68:71], v[148:151]
buffer_load_dwordx4 v1, s[4:7], s44 offen offset:0 sc1 lds
v_mfma_f32_16x16x32_bf16 v[172:175], a[100:103], a[76:79], v[172:175]
ds_read_b128 a[132:135], v5 offset:46080
v_mfma_f32_16x16x32_bf16 v[172:175], a[96:99], a[72:75], v[172:175]
v_mfma_f32_16x16x32_bf16 v[196:199], a[96:99], a[80:83], v[196:199]
v_mfma_f32_16x16x32_bf16 v[196:199], a[100:103], a[84:87], v[196:199]
buffer_load_dwordx4 v1, s[4:7], s44 offen offset:1024 sc1 lds
v_mfma_f32_16x16x32_bf16 v[220:223], a[100:103], a[92:95], v[220:223]
ds_read_b128 a[136:139], v5 offset:40960
v_mfma_f32_16x16x32_bf16 v[220:223], a[96:99], a[88:91], v[220:223]
v_mfma_f32_16x16x32_bf16 v[224:227], a[104:107], a[88:91], v[224:227]
ds_read_b128 a[140:143], v5 offset:47104
v_mfma_f32_16x16x32_bf16 v[224:227], a[108:111], a[92:95], v[224:227]
v_mfma_f32_16x16x32_bf16 v[200:203], a[108:111], a[84:87], v[200:203]
buffer_load_dwordx4 v1, s[4:7], s44 offen offset:2048 sc1 lds
v_mfma_f32_16x16x32_bf16 v[200:203], a[104:107], a[80:83], v[200:203]
ds_read_b128 a[144:147], v5 offset:41984
v_mfma_f32_16x16x32_bf16 v[176:179], a[104:107], a[72:75], v[176:179]
v_mfma_f32_16x16x32_bf16 v[176:179], a[108:111], a[76:79], v[176:179]
ds_read_b128 a[148:151], v5 offset:48128
v_mfma_f32_16x16x32_bf16 v[152:155], a[108:111], a[68:71], v[152:155]
v_mfma_f32_16x16x32_bf16 v[152:155], a[104:107], a[64:67], v[152:155]
buffer_load_dwordx4 v1, s[4:7], s44 offen offset:3072 sc1 lds
s_add_u32 m0, s19, 81920
s_waitcnt vmcnt(13)
v_mfma_f32_16x16x32_bf16 v[140:143], a[112:115], a[0:3], v[140:143]
s_add_u32 s44, s85, 0xc0c000
s_waitcnt vmcnt(12)
v_mfma_f32_16x16x32_bf16 v[140:143], a[116:119], a[4:7], v[140:143]
s_waitcnt vmcnt(10)
v_mfma_f32_16x16x32_bf16 v[164:167], a[116:119], a[12:15], v[164:167]
v_mfma_f32_16x16x32_bf16 v[164:167], a[112:115], a[8:11], v[164:167]
s_waitcnt vmcnt(9)
v_mfma_f32_16x16x32_bf16 v[188:191], a[112:115], a[16:19], v[188:191]
buffer_load_dwordx4 v1, s[4:7], s44 offen offset:0 sc1 lds
s_waitcnt vmcnt(9)
v_mfma_f32_16x16x32_bf16 v[188:191], a[116:119], a[20:23], v[188:191]
s_waitcnt vmcnt(7)
v_mfma_f32_16x16x32_bf16 v[212:215], a[116:119], a[28:31], v[212:215]
v_mfma_f32_16x16x32_bf16 v[212:215], a[112:115], a[24:27], v[212:215]
s_waitcnt lgkmcnt(0)
v_mfma_f32_16x16x32_bf16 v[216:219], a[128:131], a[24:27], v[216:219]
ds_read_b128 a[96:99], v5 offset:12288
v_cvt_pk_bf16_f32 v140, v140, v141
v_mfma_f32_16x16x32_bf16 v[216:219], a[132:135], a[28:31], v[216:219]
buffer_load_dwordx4 v1, s[4:7], s44 offen offset:1024 sc1 lds
v_mfma_f32_16x16x32_bf16 v[192:195], a[132:135], a[20:23], v[192:195]
ds_read_b128 a[100:103], v5 offset:18432
v_cvt_pk_bf16_f32 v141, v142, v143
v_mfma_f32_16x16x32_bf16 v[192:195], a[128:131], a[16:19], v[192:195]
v_cvt_pk_bf16_f32 v164, v164, v165
v_cvt_pk_bf16_f32 v165, v166, v167
v_mfma_f32_16x16x32_bf16 v[168:171], a[128:131], a[8:11], v[168:171]
v_cvt_pk_bf16_f32 v188, v188, v189
v_cvt_pk_bf16_f32 v189, v190, v191
v_mfma_f32_16x16x32_bf16 v[168:171], a[132:135], a[12:15], v[168:171]
buffer_load_dwordx4 v1, s[4:7], s44 offen offset:2048 sc1 lds
v_mfma_f32_16x16x32_bf16 v[144:147], a[132:135], a[4:7], v[144:147]
ds_read_b128 a[104:107], v5 offset:24576
v_cvt_pk_bf16_f32 v212, v212, v213
v_mfma_f32_16x16x32_bf16 v[144:147], a[128:131], a[0:3], v[144:147]
v_cvt_pk_bf16_f32 v213, v214, v215
v_mfma_f32_16x16x32_bf16 v[148:151], a[136:139], a[0:3], v[148:151]
ds_read_b128 a[108:111], v5 offset:30720
v_cvt_pk_bf16_f32 v214, v216, v217
v_mfma_f32_16x16x32_bf16 v[148:151], a[140:143], a[4:7], v[148:151]
v_cvt_pk_bf16_f32 v215, v218, v219
v_mfma_f32_16x16x32_bf16 v[172:175], a[140:143], a[12:15], v[172:175]
buffer_load_dwordx4 v1, s[4:7], s44 offen offset:3072 sc1 lds
s_add_u32 m0, s19, 147456
v_mfma_f32_16x16x32_bf16 v[172:175], a[136:139], a[8:11], v[172:175]
s_add_u32 s44, s87, 0xc1c000
ds_read_b128 a[112:115], v5 offset:36864
v_mfma_f32_16x16x32_bf16 v[196:199], a[136:139], a[16:19], v[196:199]
v_cvt_pk_bf16_f32 v166, v168, v169
v_cvt_pk_bf16_f32 v167, v170, v171
v_mfma_f32_16x16x32_bf16 v[196:199], a[140:143], a[20:23], v[196:199]
ds_read_b128 a[116:119], v5 offset:43008
v_cvt_pk_bf16_f32 v190, v192, v193
v_mfma_f32_16x16x32_bf16 v[220:223], a[140:143], a[28:31], v[220:223]
v_cvt_pk_bf16_f32 v142, v144, v145
v_cvt_pk_bf16_f32 v143, v146, v147
v_mfma_f32_16x16x32_bf16 v[220:223], a[136:139], a[24:27], v[220:223]
buffer_load_dwordx4 v1, s[4:7], s44 offen offset:0 sc1 lds
v_mfma_f32_16x16x32_bf16 v[224:227], a[144:147], a[24:27], v[224:227]
v_mfma_f32_16x16x32_bf16 v[92:95], a[240:243], v[140:143], 0
v_mfma_f32_16x16x32_bf16 v[224:227], a[148:151], a[28:31], v[224:227]
v_mfma_f32_16x16x32_bf16 v[96:99], a[244:247], v[140:143], 0
v_mfma_f32_16x16x32_bf16 v[200:203], a[148:151], a[20:23], v[200:203]
v_mfma_f32_16x16x32_bf16 v[100:103], a[240:243], v[164:167], 0
v_mfma_f32_16x16x32_bf16 v[200:203], a[144:147], a[16:19], v[200:203]
v_mfma_f32_16x16x32_bf16 v[104:107], a[244:247], v[164:167], 0
v_mfma_f32_16x16x32_bf16 v[176:179], a[144:147], a[8:11], v[176:179]
buffer_load_dwordx4 v1, s[4:7], s44 offen offset:1024 sc1 lds
v_mfma_f32_16x16x32_bf16 v[176:179], a[148:151], a[12:15], v[176:179]
v_max3_f32 v236, v92, v93, v94
v_max3_f32 v237, -v92, -v93, -v94
v_mfma_f32_16x16x32_bf16 v[152:155], a[148:151], a[4:7], v[152:155]
v_max3_f32 v236, v236, v95, v96
v_max3_f32 v237, v237, -v95, -v96
v_mfma_f32_16x16x32_bf16 v[152:155], a[144:147], a[0:3], v[152:155]
v_max3_f32 v236, v236, v97, v98
s_waitcnt lgkmcnt(0)
v_mfma_f32_16x16x32_bf16 v[132:135], a[96:99], a[32:35], v[132:135]
ds_read_b128 a[128:131], v5 offset:13312
v_max3_f32 v237, v237, -v97, -v98
v_mfma_f32_16x16x32_bf16 v[132:135], a[100:103], a[36:39], v[132:135]
buffer_load_dwordx4 v1, s[4:7], s44 offen offset:2048 sc1 lds
v_mfma_f32_16x16x32_bf16 v[156:159], a[100:103], a[44:47], v[156:159]
ds_read_b128 a[132:135], v5 offset:19456
v_max_f32 v236, v236, v99
v_mfma_f32_16x16x32_bf16 v[156:159], a[96:99], a[40:43], v[156:159]
v_max_f32_e64 v237, v237, -v99
v_max3_f32 v238, v100, v101, v102
v_mfma_f32_16x16x32_bf16 v[180:183], a[96:99], a[48:51], v[180:183]
v_permlane32_swap_b32 v236, v237
v_mfma_f32_16x16x32_bf16 v[180:183], a[100:103], a[52:55], v[180:183]
buffer_load_dwordx4 v1, s[4:7], s44 offen offset:3072 sc1 lds
s_add_u32 m0, s19, 98304
v_mfma_f32_16x16x32_bf16 v[204:207], a[100:103], a[60:63], v[204:207]
s_add_u32 s44, s84, 0xc10000
ds_read_b128 a[136:139], v5 offset:25600
v_mfma_f32_16x16x32_bf16 v[204:207], a[96:99], a[56:59], v[204:207]
v_max_f32 v236, v236, v237
v_mov_b32 v244, v236
v_mfma_f32_16x16x32_bf16 v[204:207], a[104:107], a[88:91], v[204:207]
ds_read_b128 a[140:143], v5 offset:31744
v_max3_f32 v239, -v100, -v101, -v102
v_mfma_f32_16x16x32_bf16 v[204:207], a[108:111], a[92:95], v[204:207]
v_permlane16_swap_b32 v236, v244
v_mfma_f32_16x16x32_bf16 v[180:183], a[108:111], a[84:87], v[180:183]
buffer_load_dwordx4 v1, s[4:7], s44 offen offset:0 sc1 lds
v_mfma_f32_16x16x32_bf16 v[180:183], a[104:107], a[80:83], v[180:183]
ds_read_b128 a[144:147], v5 offset:37888
v_max_f32 v236, v236, v244
v_mfma_f32_16x16x32_bf16 v[156:159], a[104:107], a[72:75], v[156:159]
v_mov_b32 v244, v236
v_max3_f32 v238, v238, v103, v104
v_mfma_f32_16x16x32_bf16 v[156:159], a[108:111], a[76:79], v[156:159]
ds_read_b128 a[148:151], v5 offset:44032
v_max3_f32 v239, v239, -v103, -v104
v_mfma_f32_16x16x32_bf16 v[132:135], a[108:111], a[68:71], v[132:135]
v_permlane32_swap_b32 v236, v244
v_mfma_f32_16x16x32_bf16 v[132:135], a[104:107], a[64:67], v[132:135]
buffer_load_dwordx4 v1, s[4:7], s44 offen offset:1024 sc1 lds
v_mfma_f32_16x16x32_bf16 v[132:135], a[112:115], a[0:3], v[132:135]
v_mul_f32_e64 v236, -v236, v82
v_mul_f32_e64 v237, -v244, v82
v_mfma_f32_16x16x32_bf16 v[132:135], a[116:119], a[4:7], v[132:135]
v_max3_f32 v238, v238, v105, v106
v_max3_f32 v239, v239, -v105, -v106
v_mfma_f32_16x16x32_bf16 v[156:159], a[116:119], a[12:15], v[156:159]
v_max_f32 v238, v238, v107
v_max_f32_e64 v239, v239, -v107
v_mfma_f32_16x16x32_bf16 v[156:159], a[112:115], a[8:11], v[156:159]
s_nop 0
v_permlane32_swap_b32 v238, v239
v_mfma_f32_16x16x32_bf16 v[180:183], a[112:115], a[16:19], v[180:183]
buffer_load_dwordx4 v1, s[4:7], s44 offen offset:2048 sc1 lds
v_mfma_f32_16x16x32_bf16 v[180:183], a[116:119], a[20:23], v[180:183]
v_max_f32 v238, v238, v239
v_mov_b32 v245, v238
v_mfma_f32_16x16x32_bf16 v[204:207], a[116:119], a[28:31], v[204:207]
s_nop 0
v_permlane16_swap_b32 v238, v245
v_mfma_f32_16x16x32_bf16 v[204:207], a[112:115], a[24:27], v[204:207]
s_waitcnt lgkmcnt(0)
s_barrier
v_mfma_f32_16x16x32_bf16 v[208:211], a[128:131], a[56:59], v[208:211]
v_max_f32 v238, v238, v245
v_mov_b32 v245, v238
v_mfma_f32_16x16x32_bf16 v[208:211], a[132:135], a[60:63], v[208:211]
buffer_load_dwordx4 v1, s[4:7], s44 offen offset:3072 sc1 lds
s_add_u32 m0, s19, 114688
v_mfma_f32_16x16x32_bf16 v[184:187], a[132:135], a[52:55], v[184:187]
s_add_u32 s44, s85, 0xc14000
v_cvt_pk_bf16_f32 v191, v194, v195
v_mfma_f32_16x16x32_bf16 v[184:187], a[128:131], a[48:51], v[184:187]
v_permlane32_swap_b32 v238, v245
v_mfma_f32_16x16x32_bf16 v[160:163], a[128:131], a[40:43], v[160:163]
v_mul_f32_e64 v238, -v238, v84
v_mul_f32_e64 v239, -v245, v84
v_mfma_f32_16x16x32_bf16 v[160:163], a[132:135], a[44:47], v[160:163]
buffer_load_dwordx4 v1, s[4:7], s44 offen offset:0 sc1 lds
v_mfma_f32_16x16x32_bf16 v[136:139], a[132:135], a[36:39], v[136:139]
v_mfma_f32_16x16x32_bf16 v[108:111], a[240:243], v[188:191], 0
v_mfma_f32_16x16x32_bf16 v[136:139], a[128:131], a[32:35], v[136:139]
v_mfma_f32_16x16x32_bf16 v[112:115], a[244:247], v[188:191], 0
v_mfma_f32_16x16x32_bf16 v[136:139], a[136:139], a[64:67], v[136:139]
v_mfma_f32_16x16x32_bf16 v[116:119], a[240:243], v[212:215], 0
v_mfma_f32_16x16x32_bf16 v[136:139], a[140:143], a[68:71], v[136:139]
v_mfma_f32_16x16x32_bf16 v[120:123], a[244:247], v[212:215], 0
v_mfma_f32_16x16x32_bf16 v[160:163], a[140:143], a[76:79], v[160:163]
buffer_load_dwordx4 v1, s[4:7], s44 offen offset:1024 sc1 lds
v_mfma_f32_16x16x32_bf16 v[160:163], a[136:139], a[72:75], v[160:163]
v_max3_f32 v240, v108, v109, v110
v_max3_f32 v241, -v108, -v109, -v110
v_mfma_f32_16x16x32_bf16 v[184:187], a[136:139], a[80:83], v[184:187]
v_max3_f32 v240, v240, v111, v112
v_max3_f32 v241, v241, -v111, -v112
v_mfma_f32_16x16x32_bf16 v[184:187], a[140:143], a[84:87], v[184:187]
v_max3_f32 v240, v240, v113, v114
v_max3_f32 v241, v241, -v113, -v114
v_mfma_f32_16x16x32_bf16 v[208:211], a[140:143], a[92:95], v[208:211]
v_max_f32 v240, v240, v115
v_max_f32_e64 v241, v241, -v115
v_mfma_f32_16x16x32_bf16 v[208:211], a[136:139], a[88:91], v[208:211]
buffer_load_dwordx4 v1, s[4:7], s44 offen offset:2048 sc1 lds
v_mfma_f32_16x16x32_bf16 v[208:211], a[144:147], a[24:27], v[208:211]
v_permlane32_swap_b32 v240, v241
v_mfma_f32_16x16x32_bf16 v[208:211], a[148:151], a[28:31], v[208:211]
v_max_f32 v240, v240, v241
v_mov_b32 v246, v240
v_mfma_f32_16x16x32_bf16 v[184:187], a[148:151], a[20:23], v[184:187]
s_nop 0
v_permlane16_swap_b32 v240, v246
v_mfma_f32_16x16x32_bf16 v[184:187], a[144:147], a[16:19], v[184:187]
v_max_f32 v240, v240, v246
v_mov_b32 v246, v240
v_mfma_f32_16x16x32_bf16 v[160:163], a[144:147], a[8:11], v[160:163]
buffer_load_dwordx4 v1, s[4:7], s44 offen offset:3072 sc1 lds
v_mfma_f32_16x16x32_bf16 v[160:163], a[148:151], a[12:15], v[160:163]
v_permlane32_swap_b32 v240, v246
v_mfma_f32_16x16x32_bf16 v[136:139], a[148:151], a[4:7], v[136:139]
v_mul_f32_e64 v240, -v240, v86
v_mul_f32_e64 v241, -v246, v86
v_mfma_f32_16x16x32_bf16 v[136:139], a[144:147], a[0:3], v[136:139]
v_max3_f32 v242, v116, v117, v118
v_max3_f32 v243, -v116, -v117, -v118
v_pk_mul_f32 v[148:149], v[148:149], v[82:83] op_sel:[0,1] op_sel_hi:[1,1]
v_pk_mul_f32 v[150:151], v[150:151], v[82:83] op_sel:[0,1] op_sel_hi:[1,1]
v_cvt_pk_bf16_f32 v148, v148, v149
v_cvt_pk_bf16_f32 v149, v150, v151
ds_write_b64 v232, v[148:149] offset:0
v_pk_mul_f32 v[152:153], v[152:153], v[82:83] op_sel:[0,1] op_sel_hi:[1,1]
v_pk_mul_f32 v[154:155], v[154:155], v[82:83] op_sel:[0,1] op_sel_hi:[1,1]
v_cvt_pk_bf16_f32 v150, v152, v153
v_cvt_pk_bf16_f32 v151, v154, v155
v_pk_mul_f32 v[172:173], v[172:173], v[84:85] op_sel:[0,1] op_sel_hi:[1,1]
v_pk_mul_f32 v[174:175], v[174:175], v[84:85] op_sel:[0,1] op_sel_hi:[1,1]
v_cvt_pk_bf16_f32 v172, v172, v173
buffer_store_dwordx4 a[248:251], v254, s[4:7], s97 offen offset:0 sc1
v_cvt_pk_bf16_f32 v173, v174, v175
ds_write_b64 v232, v[150:151] offset:512
v_pk_mul_f32 v[176:177], v[176:177], v[84:85] op_sel:[0,1] op_sel_hi:[1,1]
v_pk_mul_f32 v[178:179], v[178:179], v[84:85] op_sel:[0,1] op_sel_hi:[1,1]
v_cvt_pk_bf16_f32 v174, v176, v177
v_cvt_pk_bf16_f32 v175, v178, v179
v_pk_mul_f32 v[196:197], v[196:197], v[86:87] op_sel:[0,1] op_sel_hi:[1,1]
v_pk_mul_f32 v[198:199], v[198:199], v[86:87] op_sel:[0,1] op_sel_hi:[1,1]
v_cvt_pk_bf16_f32 v196, v196, v197
v_cvt_pk_bf16_f32 v197, v198, v199
v_pk_mul_f32 v[200:201], v[200:201], v[86:87] op_sel:[0,1] op_sel_hi:[1,1]
v_pk_mul_f32 v[202:203], v[202:203], v[86:87] op_sel:[0,1] op_sel_hi:[1,1]
v_cvt_pk_bf16_f32 v198, v200, v201
v_cvt_pk_bf16_f32 v199, v202, v203
ds_write_b64 v232, v[172:173] offset:1024
v_pk_mul_f32 v[220:221], v[220:221], v[88:89] op_sel:[0,1] op_sel_hi:[1,1]
v_pk_mul_f32 v[222:223], v[222:223], v[88:89] op_sel:[0,1] op_sel_hi:[1,1]
v_cvt_pk_bf16_f32 v220, v220, v221
v_cvt_pk_bf16_f32 v221, v222, v223
v_pk_fma_f32 v[48:49], v[92:93], v[82:83], v[236:237] op_sel:[0,0,0] op_sel_hi:[1,0,0]
v_pk_fma_f32 v[50:51], v[94:95], v[82:83], v[236:237] op_sel:[0,0,0] op_sel_hi:[1,0,0]
v_pk_fma_f32 v[52:53], v[96:97], v[82:83], v[236:237] op_sel:[0,0,0] op_sel_hi:[1,0,0]
v_pk_fma_f32 v[54:55], v[98:99], v[82:83], v[236:237] op_sel:[0,0,0] op_sel_hi:[1,0,0]
v_exp_f32 v48, v48
v_exp_f32 v49, v49
ds_write_b64 v232, v[174:175] offset:1536
buffer_store_dwordx4 a[248:251], v1, s[4:7], s96 offen offset:0 sc1
L_stub7:
s_cbranch_execz L_stub8
v_exp_f32 v50, v50
v_exp_f32 v51, v51
v_exp_f32 v52, v52
v_exp_f32 v53, v53
ds_write_b64 v232, v[196:197] offset:2048
v_exp_f32 v54, v54
v_exp_f32 v55, v55
v_cvt_pk_bf16_f32 v140, v48, v49
v_cvt_pk_bf16_f32 v141, v50, v51
v_cvt_pk_bf16_f32 v142, v52, v53
v_cvt_pk_bf16_f32 v143, v54, v55
v_pk_mul_f32 v[224:225], v[224:225], v[88:89] op_sel:[0,1] op_sel_hi:[1,1]
v_pk_mul_f32 v[226:227], v[226:227], v[88:89] op_sel:[0,1] op_sel_hi:[1,1]
v_cvt_pk_bf16_f32 v222, v224, v225
v_mfma_f32_16x16x32_bf16 v[148:151], v[16:19], v[140:143], 0
ds_write_b64 v232, v[198:199] offset:2560
v_cvt_pk_bf16_f32 v223, v226, v227
s_add_u32 m0, s19, 131072
v_pk_fma_f32 v[92:93], v[92:93], v[82:83], v[236:237] op_sel:[0,0,1] op_sel_hi:[1,0,1] neg_lo:[1,0,0] neg_hi:[1,0,0]
v_pk_fma_f32 v[94:95], v[94:95], v[82:83], v[236:237] op_sel:[0,0,1] op_sel_hi:[1,0,1] neg_lo:[1,0,0] neg_hi:[1,0,0]
v_pk_fma_f32 v[96:97], v[96:97], v[82:83], v[236:237] op_sel:[0,0,1] op_sel_hi:[1,0,1] neg_lo:[1,0,0] neg_hi:[1,0,0]
s_nop 1
v_rcp_f32 v148, v148
buffer_store_dwordx4 a[248:251], v3, s[4:7], s91 offen offset:0 sc1
v_pk_mul_f32 v[48:49], v[48:49], v[148:149] op_sel:[0,0] op_sel_hi:[1,0]
ds_write_b64 v232, v[220:221] offset:3072
v_pk_mul_f32 v[50:51], v[50:51], v[148:149] op_sel:[0,0] op_sel_hi:[1,0]
v_cvt_pk_bf16_f32 v140, v48, v49
v_cvt_pk_bf16_f32 v141, v50, v51
v_pk_fma_f32 v[98:99], v[98:99], v[82:83], v[236:237] op_sel:[0,0,1] op_sel_hi:[1,0,1] neg_lo:[1,0,0] neg_hi:[1,0,0]
v_exp_f32 v92, v92
v_exp_f32 v93, v93
buffer_store_dwordx4 a[248:251], v3, s[4:7], s91 offen offset:1024 sc1
ds_write_b64 v232, v[222:223] offset:3584
v_exp_f32 v94, v94
v_exp_f32 v95, v95
v_exp_f32 v96, v96
v_exp_f32 v97, v97
v_exp_f32 v98, v98
v_exp_f32 v99, v99
ds_write_b64 v233, v[140:141] offset:16384
s_add_u32 s44, s86, 0xc18000
v_cvt_pk_bf16_f32 v144, v92, v93
v_cvt_pk_bf16_f32 v145, v94, v95
v_cvt_pk_bf16_f32 v146, v96, v97
v_cvt_pk_bf16_f32 v147, v98, v99
buffer_load_dwordx4 v1, s[4:7], s44 offen offset:0 sc1 lds
v_pk_mul_f32 v[52:53], v[52:53], v[148:149] op_sel:[0,0] op_sel_hi:[1,0]
v_cvt_pk_bf16_f32 v142, v52, v53
v_pk_mul_f32 v[54:55], v[54:55], v[148:149] op_sel:[0,0] op_sel_hi:[1,0]
v_cvt_pk_bf16_f32 v143, v54, v55
v_mfma_f32_16x16x32_bf16 v[152:155], v[16:19], v[144:147], 0
ds_write_b64 v233, v[142:143] offset:16896
v_max3_f32 v242, v242, v119, v120
v_max3_f32 v243, v243, -v119, -v120
v_pk_fma_f32 v[56:57], v[100:101], v[84:85], v[238:239] op_sel:[0,0,0] op_sel_hi:[1,0,0]
v_pk_fma_f32 v[58:59], v[102:103], v[84:85], v[238:239] op_sel:[0,0,0] op_sel_hi:[1,0,0]
v_pk_fma_f32 v[60:61], v[104:105], v[84:85], v[238:239] op_sel:[0,0,0] op_sel_hi:[1,0,0]
s_nop 1
v_rcp_f32 v152, v152
v_pk_fma_f32 v[62:63], v[106:107], v[84:85], v[238:239] op_sel:[0,0,0] op_sel_hi:[1,0,0]
v_pk_mul_f32 v[92:93], v[92:93], v[152:153] op_sel:[0,0] op_sel_hi:[1,0]
v_pk_mul_f32 v[94:95], v[94:95], v[152:153] op_sel:[0,0] op_sel_hi:[1,0]
v_cvt_pk_bf16_f32 v144, v92, v93
v_cvt_pk_bf16_f32 v145, v94, v95
ds_write_b64 v233, v[144:145] offset:17408
v_exp_f32 v56, v56
v_exp_f32 v57, v57
v_exp_f32 v58, v58
v_exp_f32 v59, v59
v_exp_f32 v60, v60
v_exp_f32 v61, v61
v_exp_f32 v62, v62
v_exp_f32 v63, v63
buffer_load_dwordx4 v1, s[4:7], s44 offen offset:1024 sc1 lds
v_cvt_pk_bf16_f32 v164, v56, v57
v_cvt_pk_bf16_f32 v165, v58, v59
v_cvt_pk_bf16_f32 v166, v60, v61
v_cvt_pk_bf16_f32 v167, v62, v63
v_pk_mul_f32 v[96:97], v[96:97], v[152:153] op_sel:[0,0] op_sel_hi:[1,0]
v_pk_mul_f32 v[98:99], v[98:99], v[152:153] op_sel:[0,0] op_sel_hi:[1,0]
v_cvt_pk_bf16_f32 v146, v96, v97
v_mfma_f32_16x16x32_bf16 v[172:175], v[16:19], v[164:167], 0
v_cvt_pk_bf16_f32 v147, v98, v99
ds_write_b64 v233, v[146:147] offset:17920
v_max3_f32 v242, v242, v121, v122
v_pk_fma_f32 v[100:101], v[100:101], v[84:85], v[238:239] op_sel:[0,0,1] op_sel_hi:[1,0,1] neg_lo:[1,0,0] neg_hi:[1,0,0]
v_pk_fma_f32 v[102:103], v[102:103], v[84:85], v[238:239] op_sel:[0,0,1] op_sel_hi:[1,0,1] neg_lo:[1,0,0] neg_hi:[1,0,0]
v_pk_fma_f32 v[104:105], v[104:105], v[84:85], v[238:239] op_sel:[0,0,1] op_sel_hi:[1,0,1] neg_lo:[1,0,0] neg_hi:[1,0,0]
s_nop 1
v_rcp_f32 v172, v172
v_pk_fma_f32 v[106:107], v[106:107], v[84:85], v[238:239] op_sel:[0,0,1] op_sel_hi:[1,0,1] neg_lo:[1,0,0] neg_hi:[1,0,0]
v_pk_mul_f32 v[56:57], v[56:57], v[172:173] op_sel:[0,0] op_sel_hi:[1,0]
v_pk_mul_f32 v[58:59], v[58:59], v[172:173] op_sel:[0,0] op_sel_hi:[1,0]
v_cvt_pk_bf16_f32 v164, v56, v57
v_cvt_pk_bf16_f32 v165, v58, v59
v_exp_f32 v100, v100
ds_write_b64 v233, v[164:165] offset:18432
v_exp_f32 v101, v101
v_exp_f32 v102, v102
v_exp_f32 v103, v103
v_exp_f32 v104, v104
v_exp_f32 v105, v105
v_exp_f32 v106, v106
v_exp_f32 v107, v107
buffer_load_dwordx4 v1, s[4:7], s44 offen offset:2048 sc1 lds
v_cvt_pk_bf16_f32 v168, v100, v101
v_cvt_pk_bf16_f32 v169, v102, v103
v_cvt_pk_bf16_f32 v170, v104, v105
v_cvt_pk_bf16_f32 v171, v106, v107
v_pk_mul_f32 v[60:61], v[60:61], v[172:173] op_sel:[0,0] op_sel_hi:[1,0]
v_pk_mul_f32 v[62:63], v[62:63], v[172:173] op_sel:[0,0] op_sel_hi:[1,0]
v_cvt_pk_bf16_f32 v166, v60, v61
v_mfma_f32_16x16x32_bf16 v[176:179], v[16:19], v[168:171], 0
v_cvt_pk_bf16_f32 v167, v62, v63
ds_write_b64 v233, v[166:167] offset:18944
v_max3_f32 v243, v243, -v121, -v122
v_pk_fma_f32 v[64:65], v[108:109], v[86:87], v[240:241] op_sel:[0,0,0] op_sel_hi:[1,0,0]
v_pk_fma_f32 v[66:67], v[110:111], v[86:87], v[240:241] op_sel:[0,0,0] op_sel_hi:[1,0,0]
v_pk_fma_f32 v[68:69], v[112:113], v[86:87], v[240:241] op_sel:[0,0,0] op_sel_hi:[1,0,0]
s_nop 1
v_rcp_f32 v176, v176
v_pk_fma_f32 v[70:71], v[114:115], v[86:87], v[240:241] op_sel:[0,0,0] op_sel_hi:[1,0,0]
v_pk_mul_f32 v[100:101], v[100:101], v[176:177] op_sel:[0,0] op_sel_hi:[1,0]
v_pk_mul_f32 v[102:103], v[102:103], v[176:177] op_sel:[0,0] op_sel_hi:[1,0]
v_cvt_pk_bf16_f32 v168, v100, v101
v_cvt_pk_bf16_f32 v169, v102, v103
v_exp_f32 v64, v64
ds_write_b64 v233, v[168:169] offset:19456
buffer_load_dwordx4 v1, s[4:7], s44 offen offset:3072 sc1 lds
v_exp_f32 v65, v65
v_exp_f32 v66, v66
v_exp_f32 v67, v67
v_exp_f32 v68, v68
v_exp_f32 v69, v69
v_exp_f32 v70, v70
v_exp_f32 v71, v71
v_cvt_pk_bf16_f32 v188, v64, v65
v_cvt_pk_bf16_f32 v189, v66, v67
v_cvt_pk_bf16_f32 v190, v68, v69
v_cvt_pk_bf16_f32 v191, v70, v71
v_pk_mul_f32 v[104:105], v[104:105], v[176:177] op_sel:[0,0] op_sel_hi:[1,0]
v_pk_mul_f32 v[106:107], v[106:107], v[176:177] op_sel:[0,0] op_sel_hi:[1,0]
v_cvt_pk_bf16_f32 v170, v104, v105
v_mfma_f32_16x16x32_bf16 v[196:199], v[16:19], v[188:191], 0
v_cvt_pk_bf16_f32 v171, v106, v107
ds_write_b64 v233, v[170:171] offset:19968
buffer_store_dwordx4 a[248:251], v2, s[4:7], s72 offen offset:0 sc1
s_nop 4
v_rcp_f32 v196, v196
v_pk_fma_f32 v[108:109], v[108:109], v[86:87], v[240:241] op_sel:[0,0,1] op_sel_hi:[1,0,1] neg_lo:[1,0,0] neg_hi:[1,0,0]
v_pk_mul_f32 v[64:65], v[64:65], v[196:197] op_sel:[0,0] op_sel_hi:[1,0]
v_pk_mul_f32 v[66:67], v[66:67], v[196:197] op_sel:[0,0] op_sel_hi:[1,0]
v_cvt_pk_bf16_f32 v188, v64, v65
v_cvt_pk_bf16_f32 v189, v66, v67
v_pk_fma_f32 v[110:111], v[110:111], v[86:87], v[240:241] op_sel:[0,0,1] op_sel_hi:[1,0,1] neg_lo:[1,0,0] neg_hi:[1,0,0]
ds_write_b64 v233, v[188:189] offset:20480
v_pk_fma_f32 v[112:113], v[112:113], v[86:87], v[240:241] op_sel:[0,0,1] op_sel_hi:[1,0,1] neg_lo:[1,0,0] neg_hi:[1,0,0]
v_pk_fma_f32 v[114:115], v[114:115], v[86:87], v[240:241] op_sel:[0,0,1] op_sel_hi:[1,0,1] neg_lo:[1,0,0] neg_hi:[1,0,0]
v_exp_f32 v108, v108
v_exp_f32 v109, v109
v_exp_f32 v110, v110
v_exp_f32 v111, v111
v_exp_f32 v112, v112
v_exp_f32 v113, v113
v_exp_f32 v114, v114
v_exp_f32 v115, v115
v_max_f32 v242, v242, v123
v_max_f32_e64 v243, v243, -v123
v_cvt_pk_bf16_f32 v192, v108, v109
v_cvt_pk_bf16_f32 v193, v110, v111
v_cvt_pk_bf16_f32 v194, v112, v113
v_cvt_pk_bf16_f32 v195, v114, v115
v_pk_mul_f32 v[68:69], v[68:69], v[196:197] op_sel:[0,0] op_sel_hi:[1,0]
v_pk_mul_f32 v[70:71], v[70:71], v[196:197] op_sel:[0,0] op_sel_hi:[1,0]
v_permlane32_swap_b32 v242, v243
v_mfma_f32_16x16x32_bf16 v[200:203], v[16:19], v[192:195], 0
v_cvt_pk_bf16_f32 v190, v68, v69
v_cvt_pk_bf16_f32 v191, v70, v71
ds_write_b64 v233, v[190:191] offset:20992
v_max_f32 v242, v242, v243
v_mov_b32 v247, v242
buffer_store_dwordx4 a[248:251], v2, s[4:7], s72 offen offset:1024 sc1
s_nop 0
v_permlane16_swap_b32 v242, v247
v_rcp_f32 v200, v200
v_max_f32 v242, v242, v247
v_mov_b32 v247, v242
v_pk_mul_f32 v[108:109], v[108:109], v[200:201] op_sel:[0,0] op_sel_hi:[1,0]
v_pk_mul_f32 v[110:111], v[110:111], v[200:201] op_sel:[0,0] op_sel_hi:[1,0]
v_cvt_pk_bf16_f32 v192, v108, v109
v_cvt_pk_bf16_f32 v193, v110, v111
v_permlane32_swap_b32 v242, v247
ds_write_b64 v233, v[192:193] offset:21504
v_mul_f32_e64 v242, -v242, v88
v_mul_f32_e64 v243, -v247, v88
v_pk_fma_f32 v[124:125], v[116:117], v[88:89], v[242:243] op_sel:[0,0,0] op_sel_hi:[1,0,0]
v_pk_fma_f32 v[126:127], v[118:119], v[88:89], v[242:243] op_sel:[0,0,0] op_sel_hi:[1,0,0]
v_pk_fma_f32 v[128:129], v[120:121], v[88:89], v[242:243] op_sel:[0,0,0] op_sel_hi:[1,0,0]
v_pk_fma_f32 v[130:131], v[122:123], v[88:89], v[242:243] op_sel:[0,0,0] op_sel_hi:[1,0,0]
v_exp_f32 v124, v124
v_exp_f32 v125, v125
v_exp_f32 v126, v126
v_exp_f32 v127, v127
v_exp_f32 v128, v128
v_exp_f32 v129, v129
v_exp_f32 v130, v130
v_exp_f32 v131, v131
v_cvt_pk_bf16_f32 v212, v124, v125
v_cvt_pk_bf16_f32 v213, v126, v127
v_cvt_pk_bf16_f32 v214, v128, v129
v_cvt_pk_bf16_f32 v215, v130, v131
v_pk_mul_f32 v[112:113], v[112:113], v[200:201] op_sel:[0,0] op_sel_hi:[1,0]
v_pk_mul_f32 v[114:115], v[114:115], v[200:201] op_sel:[0,0] op_sel_hi:[1,0]
v_cvt_pk_bf16_f32 v194, v112, v113
v_mfma_f32_16x16x32_bf16 v[220:223], v[16:19], v[212:215], 0
v_cvt_pk_bf16_f32 v195, v114, v115
ds_write_b64 v233, v[194:195] offset:22016
buffer_store_dwordx4 a[248:251], v2, s[4:7], s72 offen offset:2048 sc1
s_nop 4
v_rcp_f32 v220, v220
v_pk_fma_f32 v[116:117], v[116:117], v[88:89], v[242:243] op_sel:[0,0,1] op_sel_hi:[1,0,1] neg_lo:[1,0,0] neg_hi:[1,0,0]
v_pk_mul_f32 v[124:125], v[124:125], v[220:221] op_sel:[0,0] op_sel_hi:[1,0]
v_pk_mul_f32 v[126:127], v[126:127], v[220:221] op_sel:[0,0] op_sel_hi:[1,0]
v_cvt_pk_bf16_f32 v212, v124, v125
v_cvt_pk_bf16_f32 v213, v126, v127
v_pk_fma_f32 v[118:119], v[118:119], v[88:89], v[242:243] op_sel:[0,0,1] op_sel_hi:[1,0,1] neg_lo:[1,0,0] neg_hi:[1,0,0]
ds_write_b64 v233, v[212:213] offset:22528
v_pk_fma_f32 v[120:121], v[120:121], v[88:89], v[242:243] op_sel:[0,0,1] op_sel_hi:[1,0,1] neg_lo:[1,0,0] neg_hi:[1,0,0]
v_pk_fma_f32 v[122:123], v[122:123], v[88:89], v[242:243] op_sel:[0,0,1] op_sel_hi:[1,0,1] neg_lo:[1,0,0] neg_hi:[1,0,0]
v_exp_f32 v116, v116
v_exp_f32 v117, v117
v_exp_f32 v118, v118
v_exp_f32 v119, v119
v_exp_f32 v120, v120
v_exp_f32 v121, v121
v_exp_f32 v122, v122
v_exp_f32 v123, v123
v_cvt_pk_bf16_f32 v216, v116, v117
v_cvt_pk_bf16_f32 v217, v118, v119
v_cvt_pk_bf16_f32 v218, v120, v121
v_cvt_pk_bf16_f32 v219, v122, v123
v_pk_mul_f32 v[128:129], v[128:129], v[220:221] op_sel:[0,0] op_sel_hi:[1,0]
v_pk_mul_f32 v[130:131], v[130:131], v[220:221] op_sel:[0,0] op_sel_hi:[1,0]
v_cvt_pk_bf16_f32 v214, v128, v129
v_mfma_f32_16x16x32_bf16 v[224:227], v[16:19], v[216:219], 0
v_cvt_pk_bf16_f32 v215, v130, v131
ds_write_b64 v233, v[214:215] offset:23040
buffer_store_dwordx4 a[248:251], v2, s[4:7], s72 offen offset:3072 sc1
s_nop 4
v_rcp_f32 v224, v224
s_nop 0
v_pk_mul_f32 v[116:117], v[116:117], v[224:225] op_sel:[0,0] op_sel_hi:[1,0]
v_pk_mul_f32 v[118:119], v[118:119], v[224:225] op_sel:[0,0] op_sel_hi:[1,0]
v_cvt_pk_bf16_f32 v216, v116, v117
v_cvt_pk_bf16_f32 v217, v118, v119
v_pk_mul_f32 v[120:121], v[120:121], v[224:225] op_sel:[0,0] op_sel_hi:[1,0]
ds_write_b64 v233, v[216:217] offset:23552
v_pk_mul_f32 v[122:123], v[122:123], v[224:225] op_sel:[0,0] op_sel_hi:[1,0]
v_cvt_pk_bf16_f32 v218, v120, v121
v_cvt_pk_bf16_f32 v219, v122, v123
ds_write_b64 v233, v[218:219] offset:24064
s_waitcnt vmcnt(8)
s_waitcnt lgkmcnt(0)
s_barrier
ds_read_b64_tr_b16 a[0:1], v234 offset:16384
ds_read_b64_tr_b16 a[2:3], v234 offset:18432
ds_read_b64_tr_b16 a[12:13], v234 offset:20480
ds_read_b64_tr_b16 a[14:15], v234 offset:22528
ds_read_b64_tr_b16 a[24:25], v234 offset:24576
ds_read_b64_tr_b16 a[26:27], v234 offset:26624
ds_read_b64_tr_b16 a[4:5], v8 offset:0
ds_read_b64_tr_b16 a[6:7], v8 offset:1024
ds_read_b64_tr_b16 a[8:9], v8 offset:512
ds_read_b64_tr_b16 a[10:11], v8 offset:1536
ds_read_b64_tr_b16 a[36:37], v234 offset:28672
ds_read_b64_tr_b16 a[38:39], v234 offset:30720
ds_read_b64_tr_b16 a[16:17], v8 offset:2048
ds_read_b64_tr_b16 a[18:19], v8 offset:3072
ds_read_b64_tr_b16 a[20:21], v8 offset:2560
ds_read_b64_tr_b16 a[22:23], v8 offset:3584
ds_read_b64_tr_b16 a[48:49], v234 offset:32768
ds_read_b64_tr_b16 a[50:51], v234 offset:34816
ds_read_b64_tr_b16 a[28:29], v8 offset:4096
ds_read_b64_tr_b16 a[30:31], v8 offset:5120
ds_read_b64_tr_b16 a[32:33], v8 offset:4608
ds_read_b64_tr_b16 a[34:35], v8 offset:5632
ds_read_b64_tr_b16 a[60:61], v234 offset:36864
ds_read_b64_tr_b16 a[62:63], v234 offset:38912
s_waitcnt lgkmcnt(14)
v_mfma_f32_16x16x32_bf16 v[100:103], a[0:3], v[16:19], 0
ds_read_b64_tr_b16 a[40:41], v8 offset:6144
ds_read_b64_tr_b16 a[42:43], v8 offset:7168
ds_read_b64_tr_b16 a[44:45], v8 offset:6656
ds_read_b64_tr_b16 a[46:47], v8 offset:7680
ds_read_b64_tr_b16 a[72:73], v234 offset:40960
ds_read_b64_tr_b16 a[74:75], v234 offset:43008
v_mfma_f32_16x16x32_bf16 v[100:103], a[12:15], v[16:19], v[100:103]
buffer_atomic_add v12, v235, s[4:7], s94 offen sc1
ds_read_b64_tr_b16 a[52:53], v8 offset:8192
ds_read_b64_tr_b16 a[54:55], v8 offset:9216
ds_read_b64_tr_b16 a[56:57], v8 offset:8704
ds_read_b64_tr_b16 a[58:59], v8 offset:9728
ds_read_b64_tr_b16 a[84:85], v234 offset:45056
ds_read_b64_tr_b16 a[86:87], v234 offset:47104
v_mfma_f32_16x16x32_bf16 v[100:103], a[24:27], v[16:19], v[100:103]
ds_read_b64_tr_b16 a[64:65], v8 offset:10240
ds_read_b64_tr_b16 a[66:67], v8 offset:11264
v_mfma_f32_16x16x32_bf16 v[92:95], a[0:3], a[4:7], 0
ds_read_b64_tr_b16 a[68:69], v8 offset:10752
ds_read_b64_tr_b16 a[70:71], v8 offset:11776
v_mfma_f32_16x16x32_bf16 v[96:99], a[0:3], a[8:11], 0
ds_read_b64_tr_b16 a[76:77], v8 offset:12288
s_waitcnt lgkmcnt(14)
v_mfma_f32_16x16x32_bf16 v[100:103], a[36:39], v[16:19], v[100:103]
ds_read_b64_tr_b16 a[78:79], v8 offset:13312
v_mfma_f32_16x16x32_bf16 v[92:95], a[12:15], a[16:19], v[92:95]
ds_read_b64_tr_b16 a[80:81], v8 offset:12800
ds_read_b64_tr_b16 a[82:83], v8 offset:13824
v_mfma_f32_16x16x32_bf16 v[96:99], a[12:15], a[20:23], v[96:99]
ds_read_b64_tr_b16 a[88:89], v8 offset:14336
v_mfma_f32_16x16x32_bf16 v[100:103], a[48:51], v[16:19], v[100:103]
ds_read_b64_tr_b16 a[90:91], v8 offset:15360
v_mfma_f32_16x16x32_bf16 v[92:95], a[24:27], a[28:31], v[92:95]
ds_read_b64_tr_b16 a[92:93], v8 offset:14848
ds_read_b64_tr_b16 a[94:95], v8 offset:15872
v_mfma_f32_16x16x32_bf16 v[96:99], a[24:27], a[32:35], v[96:99]
v_cvt_pk_bf16_f32 v132, v132, v133
v_cvt_pk_bf16_f32 v156, v156, v157
v_mfma_f32_16x16x32_bf16 v[100:103], a[60:63], v[16:19], v[100:103]
v_cvt_pk_bf16_f32 v180, v180, v181
v_cvt_pk_bf16_f32 v204, v204, v205
v_mfma_f32_16x16x32_bf16 v[92:95], a[36:39], a[40:43], v[92:95]
v_cvt_pk_bf16_f32 v133, v134, v135
v_cvt_pk_bf16_f32 v157, v158, v159
s_waitcnt lgkmcnt(14)
v_mfma_f32_16x16x32_bf16 v[96:99], a[36:39], a[44:47], v[96:99]
v_cvt_pk_bf16_f32 v181, v182, v183
v_cvt_pk_bf16_f32 v205, v206, v207
v_mfma_f32_16x16x32_bf16 v[100:103], a[72:75], v[16:19], v[100:103]
v_cvt_pk_bf16_f32 v134, v136, v137
v_cvt_pk_bf16_f32 v135, v138, v139
v_mfma_f32_16x16x32_bf16 v[92:95], a[48:51], a[52:55], v[92:95]
v_cvt_pk_bf16_f32 v158, v160, v161
v_cvt_pk_bf16_f32 v159, v162, v163
v_mfma_f32_16x16x32_bf16 v[96:99], a[48:51], a[56:59], v[96:99]
v_cvt_pk_bf16_f32 v182, v184, v185
v_cvt_pk_bf16_f32 v183, v186, v187
s_waitcnt lgkmcnt(12)
v_mfma_f32_16x16x32_bf16 v[100:103], a[84:87], v[16:19], v[100:103]
v_cvt_pk_bf16_f32 v206, v208, v209
v_cvt_pk_bf16_f32 v207, v210, v211
s_waitcnt lgkmcnt(10)
v_mfma_f32_16x16x32_bf16 v[92:95], a[60:63], a[64:67], v[92:95]
s_waitcnt lgkmcnt(8)
v_mfma_f32_16x16x32_bf16 v[96:99], a[60:63], a[68:71], v[96:99]
s_nop 1
v_min_u32 v100, -2, v100
v_min_u32 v101, -2, v101
s_waitcnt lgkmcnt(6)
v_mfma_f32_16x16x32_bf16 v[92:95], a[72:75], a[76:79], v[92:95]
v_min_u32 v102, -2, v102
v_min_u32 v103, -2, v103
s_waitcnt lgkmcnt(4)
v_mfma_f32_16x16x32_bf16 v[96:99], a[72:75], a[80:83], v[96:99]
buffer_store_dwordx4 v[100:103], v254, s[4:7], s97 offen sc1
s_waitcnt lgkmcnt(2)
v_mfma_f32_16x16x32_bf16 v[92:95], a[84:87], a[88:91], v[92:95]
s_waitcnt lgkmcnt(0)
v_mfma_f32_16x16x32_bf16 v[96:99], a[84:87], a[92:95], v[96:99]
s_nop 5
v_cvt_pk_bf16_f32 v92, v92, v93
v_cvt_pk_bf16_f32 v93, v94, v95
v_min_u32 v92, -2, v92
v_min_u32 v93, -2, v93
v_cvt_pk_bf16_f32 v94, v96, v97
v_cvt_pk_bf16_f32 v95, v98, v99
v_min_u32 v94, -2, v94
v_min_u32 v95, -2, v95
buffer_store_dwordx4 v[92:95], v1, s[4:7], s96 offen sc1
s_barrier
s_add_u32 m0, s19, 32768
s_add_u32 s44, s84, 0xc00000
buffer_load_dwordx4 v1, s[4:7], s44 offen offset:0 sc1 lds
v_mfma_f32_16x16x32_bf16 v[108:111], a[240:243], v[132:135], 0
v_mfma_f32_16x16x32_bf16 v[172:175], a[240:243], v[156:159], 0
v_mfma_f32_16x16x32_bf16 v[112:115], a[244:247], v[132:135], 0
s_nop 5
v_max3_f32 v236, v108, v109, v110
v_max3_f32 v237, -v108, -v109, -v110
v_mfma_f32_16x16x32_bf16 v[176:179], a[244:247], v[156:159], 0
v_max3_f32 v238, v172, v173, v174
v_max3_f32 v239, -v172, -v173, -v174
v_max3_f32 v236, v236, v111, v112
v_max3_f32 v237, v237, -v111, -v112
v_max3_f32 v236, v236, v113, v114
v_max3_f32 v237, v237, -v113, -v114
s_nop 1
v_max3_f32 v238, v238, v175, v176
v_max3_f32 v239, v239, -v175, -v176
v_max3_f32 v238, v238, v177, v178
v_max3_f32 v239, v239, -v177, -v178
v_max_f32 v236, v236, v115
buffer_load_dwordx4 v1, s[4:7], s44 offen offset:1024 sc1 lds
v_max_f32_e64 v237, v237, -v115
v_max_f32 v238, v238, v179
v_max_f32_e64 v239, v239, -v179
v_permlane32_swap_b32 v236, v237
s_nop 0
v_permlane32_swap_b32 v238, v239
v_mov_b32 v11, 0
buffer_atomic_add v11, v251, s[4:7], s89 offen sc0 sc1
v_max_f32 v236, v236, v237
v_max_f32 v238, v238, v239
v_mov_b32 v244, v236
v_mov_b32 v245, v238
s_nop 0
v_permlane16_swap_b32 v236, v244
v_permlane16_swap_b32 v238, v245
v_max_f32 v236, v236, v244
v_max_f32 v238, v238, v245
v_mov_b32 v244, v236
v_mov_b32 v245, v238
s_nop 0
v_permlane32_swap_b32 v236, v244
v_permlane32_swap_b32 v238, v245
v_mul_f32_e64 v236, -v236, v82
v_mul_f32_e64 v237, -v244, v82
buffer_load_dwordx4 v1, s[4:7], s44 offen offset:2048 sc1 lds
v_mul_f32_e64 v238, -v238, v84
v_mul_f32_e64 v239, -v245, v84
v_pk_fma_f32 v[116:117], v[108:109], v[82:83], v[236:237] op_sel:[0,0,0] op_sel_hi:[1,0,0]
v_pk_fma_f32 v[118:119], v[110:111], v[82:83], v[236:237] op_sel:[0,0,0] op_sel_hi:[1,0,0]
v_pk_fma_f32 v[120:121], v[112:113], v[82:83], v[236:237] op_sel:[0,0,0] op_sel_hi:[1,0,0]
v_pk_fma_f32 v[122:123], v[114:115], v[82:83], v[236:237] op_sel:[0,0,0] op_sel_hi:[1,0,0]
v_pk_fma_f32 v[148:149], v[172:173], v[84:85], v[238:239] op_sel:[0,0,0] op_sel_hi:[1,0,0]
v_pk_fma_f32 v[150:151], v[174:175], v[84:85], v[238:239] op_sel:[0,0,0] op_sel_hi:[1,0,0]
v_pk_fma_f32 v[152:153], v[176:177], v[84:85], v[238:239] op_sel:[0,0,0] op_sel_hi:[1,0,0]
v_pk_fma_f32 v[154:155], v[178:179], v[84:85], v[238:239] op_sel:[0,0,0] op_sel_hi:[1,0,0]
v_pk_fma_f32 v[108:109], v[108:109], v[82:83], v[236:237] op_sel:[0,0,1] op_sel_hi:[1,0,1] neg_lo:[1,0,0] neg_hi:[1,0,0]
v_pk_fma_f32 v[110:111], v[110:111], v[82:83], v[236:237] op_sel:[0,0,1] op_sel_hi:[1,0,1] neg_lo:[1,0,0] neg_hi:[1,0,0]
v_pk_fma_f32 v[112:113], v[112:113], v[82:83], v[236:237] op_sel:[0,0,1] op_sel_hi:[1,0,1] neg_lo:[1,0,0] neg_hi:[1,0,0]
v_pk_fma_f32 v[114:115], v[114:115], v[82:83], v[236:237] op_sel:[0,0,1] op_sel_hi:[1,0,1] neg_lo:[1,0,0] neg_hi:[1,0,0]
v_pk_fma_f32 v[172:173], v[172:173], v[84:85], v[238:239] op_sel:[0,0,1] op_sel_hi:[1,0,1] neg_lo:[1,0,0] neg_hi:[1,0,0]
v_pk_fma_f32 v[174:175], v[174:175], v[84:85], v[238:239] op_sel:[0,0,1] op_sel_hi:[1,0,1] neg_lo:[1,0,0] neg_hi:[1,0,0]
v_pk_fma_f32 v[176:177], v[176:177], v[84:85], v[238:239] op_sel:[0,0,1] op_sel_hi:[1,0,1] neg_lo:[1,0,0] neg_hi:[1,0,0]
v_pk_fma_f32 v[178:179], v[178:179], v[84:85], v[238:239] op_sel:[0,0,1] op_sel_hi:[1,0,1] neg_lo:[1,0,0] neg_hi:[1,0,0]
v_exp_f32 v116, v116
v_exp_f32 v108, v108
v_exp_f32 v117, v117
v_exp_f32 v109, v109
v_exp_f32 v118, v118
v_exp_f32 v110, v110
v_exp_f32 v119, v119
v_exp_f32 v111, v111
v_exp_f32 v120, v120
v_exp_f32 v112, v112
v_exp_f32 v121, v121
v_exp_f32 v113, v113
v_exp_f32 v122, v122
v_exp_f32 v114, v114
v_exp_f32 v123, v123
v_exp_f32 v115, v115
v_exp_f32 v148, v148
v_exp_f32 v172, v172
v_exp_f32 v149, v149
v_exp_f32 v173, v173
v_exp_f32 v150, v150
v_exp_f32 v174, v174
v_exp_f32 v151, v151
v_exp_f32 v175, v175
v_exp_f32 v152, v152
v_exp_f32 v176, v176
v_exp_f32 v153, v153
v_exp_f32 v177, v177
v_exp_f32 v154, v154
v_exp_f32 v178, v178
v_exp_f32 v155, v155
v_exp_f32 v179, v179
buffer_load_dwordx4 v1, s[4:7], s44 offen offset:3072 sc1 lds
v_cvt_pk_bf16_f32 v140, v116, v117
v_cvt_pk_bf16_f32 v141, v118, v119
v_cvt_pk_bf16_f32 v142, v120, v121
v_cvt_pk_bf16_f32 v143, v122, v123
v_cvt_pk_bf16_f32 v144, v108, v109
v_cvt_pk_bf16_f32 v145, v110, v111
v_cvt_pk_bf16_f32 v146, v112, v113
v_cvt_pk_bf16_f32 v147, v114, v115
v_cvt_pk_bf16_f32 v164, v148, v149
v_cvt_pk_bf16_f32 v165, v150, v151
v_cvt_pk_bf16_f32 v166, v152, v153
v_cvt_pk_bf16_f32 v167, v154, v155
v_cvt_pk_bf16_f32 v168, v172, v173
v_cvt_pk_bf16_f32 v169, v174, v175
v_cvt_pk_bf16_f32 v170, v176, v177
v_cvt_pk_bf16_f32 v171, v178, v179
s_waitcnt vmcnt(2)
v_readfirstlane_b32 s38, v11
s_nop 0
s_cmp_ge_u32 s38, 8
s_cbranch_scc1 Lpe_22
s_add_u32 s36, s88, 0x80000
s_mov_b32 s37, 0
Lpoll_21:
v_mov_b32 v11, 0
buffer_atomic_add v11, v251, s[4:7], s36 offen sc0 sc1
s_add_u32 s37, s37, 1
s_waitcnt vmcnt(0)
v_readfirstlane_b32 s38, v11
s_nop 0
s_cmp_ge_u32 s38, 8
s_cbranch_scc1 Lpe_22
s_cmp_lt_u32 s37, 0x100000
s_cbranch_scc1 Lpoll_21
Lpe_22:
buffer_load_dwordx4 v[48:51], v1, s[4:7], s98 offen offset:0 sc1
v_mfma_f32_16x16x32_bf16 v[108:111], a[240:243], v[180:183], 0
v_mfma_f32_16x16x32_bf16 v[220:223], a[240:243], v[204:207], 0
v_mfma_f32_16x16x32_bf16 v[112:115], a[244:247], v[180:183], 0
s_nop 5
v_max3_f32 v240, v108, v109, v110
v_max3_f32 v241, -v108, -v109, -v110
v_mfma_f32_16x16x32_bf16 v[224:227], a[244:247], v[204:207], 0
buffer_load_dwordx4 v[124:127], v248, s[4:7], s100 offen sc1
v_max3_f32 v242, v220, v221, v222
v_max3_f32 v243, -v220, -v221, -v222
v_max3_f32 v240, v240, v111, v112
v_max3_f32 v241, v241, -v111, -v112
v_max3_f32 v240, v240, v113, v114
s_nop 1
v_max3_f32 v242, v242, v223, v224
v_max3_f32 v243, v243, -v223, -v224
v_max3_f32 v241, v241, -v113, -v114
v_max3_f32 v242, v242, v225, v226
v_max3_f32 v243, v243, -v225, -v226
v_max_f32 v240, v240, v115
v_max_f32_e64 v241, v241, -v115
v_max_f32 v242, v242, v227
buffer_load_dwordx4 v[52:55], v1, s[4:7], s98 offen offset:1024 sc1
v_max_f32_e64 v243, v243, -v227
v_permlane32_swap_b32 v240, v241
s_nop 0
v_permlane32_swap_b32 v242, v243
v_max_f32 v240, v240, v241
v_max_f32 v242, v242, v243
v_mov_b32 v246, v240
v_mov_b32 v247, v242
s_nop 0
v_permlane16_swap_b32 v240, v246
v_permlane16_swap_b32 v242, v247
buffer_load_dwordx4 v[56:59], v1, s[4:7], s98 offen offset:2048 sc1
v_max_f32 v240, v240, v246
v_max_f32 v242, v242, v247
v_mov_b32 v246, v240
v_mov_b32 v247, v242
s_nop 0
v_permlane32_swap_b32 v240, v246
v_permlane32_swap_b32 v242, v247
v_mul_f32_e64 v240, -v240, v86
v_mul_f32_e64 v241, -v246, v86
v_mul_f32_e64 v242, -v242, v88
v_mul_f32_e64 v243, -v247, v88
buffer_load_dwordx4 v[60:63], v1, s[4:7], s98 offen offset:3072 sc1
v_pk_fma_f32 v[116:117], v[108:109], v[86:87], v[240:241] op_sel:[0,0,0] op_sel_hi:[1,0,0]
v_pk_fma_f32 v[118:119], v[110:111], v[86:87], v[240:241] op_sel:[0,0,0] op_sel_hi:[1,0,0]
v_pk_fma_f32 v[120:121], v[112:113], v[86:87], v[240:241] op_sel:[0,0,0] op_sel_hi:[1,0,0]
v_pk_fma_f32 v[122:123], v[114:115], v[86:87], v[240:241] op_sel:[0,0,0] op_sel_hi:[1,0,0]
v_pk_fma_f32 v[196:197], v[220:221], v[88:89], v[242:243] op_sel:[0,0,0] op_sel_hi:[1,0,0]
v_pk_fma_f32 v[198:199], v[222:223], v[88:89], v[242:243] op_sel:[0,0,0] op_sel_hi:[1,0,0]
v_pk_fma_f32 v[200:201], v[224:225], v[88:89], v[242:243] op_sel:[0,0,0] op_sel_hi:[1,0,0]
v_pk_fma_f32 v[202:203], v[226:227], v[88:89], v[242:243] op_sel:[0,0,0] op_sel_hi:[1,0,0]
v_pk_fma_f32 v[108:109], v[108:109], v[86:87], v[240:241] op_sel:[0,0,1] op_sel_hi:[1,0,1] neg_lo:[1,0,0] neg_hi:[1,0,0]
v_pk_fma_f32 v[110:111], v[110:111], v[86:87], v[240:241] op_sel:[0,0,1] op_sel_hi:[1,0,1] neg_lo:[1,0,0] neg_hi:[1,0,0]
v_pk_fma_f32 v[112:113], v[112:113], v[86:87], v[240:241] op_sel:[0,0,1] op_sel_hi:[1,0,1] neg_lo:[1,0,0] neg_hi:[1,0,0]
v_pk_fma_f32 v[114:115], v[114:115], v[86:87], v[240:241] op_sel:[0,0,1] op_sel_hi:[1,0,1] neg_lo:[1,0,0] neg_hi:[1,0,0]
v_pk_fma_f32 v[220:221], v[220:221], v[88:89], v[242:243] op_sel:[0,0,1] op_sel_hi:[1,0,1] neg_lo:[1,0,0] neg_hi:[1,0,0]
buffer_load_dwordx4 v[64:67], v1, s[4:7], s99 offen offset:0 sc1
v_pk_fma_f32 v[222:223], v[222:223], v[88:89], v[242:243] op_sel:[0,0,1] op_sel_hi:[1,0,1] neg_lo:[1,0,0] neg_hi:[1,0,0]
v_pk_fma_f32 v[224:225], v[224:225], v[88:89], v[242:243] op_sel:[0,0,1] op_sel_hi:[1,0,1] neg_lo:[1,0,0] neg_hi:[1,0,0]
v_pk_fma_f32 v[226:227], v[226:227], v[88:89], v[242:243] op_sel:[0,0,1] op_sel_hi:[1,0,1] neg_lo:[1,0,0] neg_hi:[1,0,0]
v_exp_f32 v116, v116
v_exp_f32 v108, v108
v_exp_f32 v117, v117
v_exp_f32 v109, v109
v_exp_f32 v118, v118
buffer_load_dwordx4 v[68:71], v1, s[4:7], s99 offen offset:1024 sc1
v_exp_f32 v110, v110
v_exp_f32 v119, v119
v_exp_f32 v111, v111
v_exp_f32 v120, v120
v_exp_f32 v112, v112
v_exp_f32 v121, v121
v_exp_f32 v113, v113
buffer_load_dwordx4 v[100:103], v1, s[4:7], s99 offen offset:2048 sc1
v_exp_f32 v122, v122
v_exp_f32 v114, v114
v_exp_f32 v123, v123
v_exp_f32 v115, v115
v_exp_f32 v196, v196
v_exp_f32 v220, v220
v_exp_f32 v197, v197
buffer_load_dwordx4 v[104:107], v1, s[4:7], s99 offen offset:3072 sc1
v_exp_f32 v221, v221
v_exp_f32 v198, v198
v_exp_f32 v222, v222
v_exp_f32 v199, v199
v_exp_f32 v223, v223
v_exp_f32 v200, v200
v_exp_f32 v224, v224
buffer_store_dwordx4 a[248:251], v2, s[4:7], s73 offen offset:0 sc1
v_exp_f32 v201, v201
v_exp_f32 v225, v225
v_exp_f32 v202, v202
v_exp_f32 v226, v226
v_exp_f32 v203, v203
v_exp_f32 v227, v227
v_cvt_pk_bf16_f32 v188, v116, v117
v_cvt_pk_bf16_f32 v189, v118, v119
v_cvt_pk_bf16_f32 v190, v120, v121
v_cvt_pk_bf16_f32 v191, v122, v123
v_cvt_pk_bf16_f32 v192, v108, v109
v_cvt_pk_bf16_f32 v193, v110, v111
v_cvt_pk_bf16_f32 v194, v112, v113
v_cvt_pk_bf16_f32 v195, v114, v115
v_cvt_pk_bf16_f32 v212, v196, v197
v_cvt_pk_bf16_f32 v213, v198, v199
v_cvt_pk_bf16_f32 v214, v200, v201
v_cvt_pk_bf16_f32 v215, v202, v203
v_cvt_pk_bf16_f32 v216, v220, v221
v_cvt_pk_bf16_f32 v217, v222, v223
L_stub8:
s_cbranch_execz L_wret2
v_cvt_pk_bf16_f32 v218, v224, v225
v_cvt_pk_bf16_f32 v219, v226, v227
buffer_store_dwordx4 a[248:251], v2, s[4:7], s73 offen offset:1024 sc1
s_waitcnt vmcnt(10)
v_lshlrev_b32 v92, 16, v48
v_and_b32 v93, 0xffff0000, v48
v_lshlrev_b32 v94, 16, v49
v_and_b32 v95, 0xffff0000, v49
v_lshlrev_b32 v96, 16, v50
v_and_b32 v97, 0xffff0000, v50
v_lshlrev_b32 v98, 16, v51
v_and_b32 v99, 0xffff0000, v51
s_waitcnt vmcnt(9)
v_add_f32_dpp v128, v124, v124 row_ror:4 row_mask:0xf bank_mask:0xf
v_add_f32_dpp v129, v125, v125 row_ror:4 row_mask:0xf bank_mask:0xf
v_add_f32_dpp v130, v126, v126 row_ror:4 row_mask:0xf bank_mask:0xf
v_add_f32_dpp v131, v127, v127 row_ror:4 row_mask:0xf bank_mask:0xf
v_add_f32_dpp v128, v128, v128 row_ror:2 row_mask:0xf bank_mask:0xf
v_add_f32_dpp v129, v129, v129 row_ror:2 row_mask:0xf bank_mask:0xf
v_add_f32_dpp v130, v130, v130 row_ror:2 row_mask:0xf bank_mask:0xf
buffer_store_dwordx4 a[248:251], v2, s[4:7], s73 offen offset:2048 sc1
v_add_f32_dpp v131, v131, v131 row_ror:2 row_mask:0xf bank_mask:0xf
v_add_f32_dpp v128, v128, v128 row_ror:1 row_mask:0xf bank_mask:0xf
v_add_f32_dpp v129, v129, v129 row_ror:1 row_mask:0xf bank_mask:0xf
v_add_f32_dpp v130, v130, v130 row_ror:1 row_mask:0xf bank_mask:0xf
v_add_f32_dpp v131, v131, v131 row_ror:1 row_mask:0xf bank_mask:0xf
s_waitcnt vmcnt(9)
v_dot2c_f32_bf16 v92, v52, v249
v_dot2c_f32_bf16 v93, v52, v250
v_dot2c_f32_bf16 v94, v53, v249
v_dot2c_f32_bf16 v95, v53, v250
v_dot2c_f32_bf16 v96, v54, v249
v_dot2c_f32_bf16 v97, v54, v250
v_dot2c_f32_bf16 v98, v55, v249
v_dot2c_f32_bf16 v99, v55, v250
v_fma_f32 v135, v129, v130, v131
s_waitcnt vmcnt(8)
v_dot2c_f32_bf16 v92, v56, v249
v_dot2c_f32_bf16 v93, v56, v250
v_dot2c_f32_bf16 v94, v57, v249
v_dot2c_f32_bf16 v95, v57, v250
v_dot2c_f32_bf16 v96, v58, v249
v_dot2c_f32_bf16 v97, v58, v250
v_dot2c_f32_bf16 v98, v59, v249
v_dot2c_f32_bf16 v99, v59, v250
buffer_store_dwordx4 a[248:251], v2, s[4:7], s73 offen offset:3072 sc1
s_waitcnt vmcnt(8)
v_dot2c_f32_bf16 v92, v60, v249
v_dot2c_f32_bf16 v93, v60, v250
v_dot2c_f32_bf16 v94, v61, v249
v_dot2c_f32_bf16 v95, v61, v250
v_dot2c_f32_bf16 v96, v62, v249
v_dot2c_f32_bf16 v97, v62, v250
v_dot2c_f32_bf16 v98, v63, v249
v_dot2c_f32_bf16 v99, v63, v250
s_waitcnt vmcnt(7)
v_dot2c_f32_bf16 v92, v64, v249
v_dot2c_f32_bf16 v93, v64, v250
v_dot2c_f32_bf16 v94, v65, v249
v_dot2c_f32_bf16 v95, v65, v250
v_dot2c_f32_bf16 v96, v66, v249
v_dot2c_f32_bf16 v97, v66, v250
v_dot2c_f32_bf16 v98, v67, v249
v_dot2c_f32_bf16 v99, v67, v250
s_waitcnt vmcnt(6)
v_dot2c_f32_bf16 v92, v68, v249
v_dot2c_f32_bf16 v93, v68, v250
v_dot2c_f32_bf16 v94, v69, v249
v_dot2c_f32_bf16 v95, v69, v250
v_dot2c_f32_bf16 v96, v70, v249
v_dot2c_f32_bf16 v97, v70, v250
v_dot2c_f32_bf16 v98, v71, v249
v_dot2c_f32_bf16 v99, v71, v250
s_waitcnt vmcnt(5)
v_dot2c_f32_bf16 v92, v100, v249
v_dot2c_f32_bf16 v93, v100, v250
v_dot2c_f32_bf16 v94, v101, v249
v_dot2c_f32_bf16 v95, v101, v250
v_dot2c_f32_bf16 v96, v102, v249
v_dot2c_f32_bf16 v97, v102, v250
v_dot2c_f32_bf16 v98, v103, v249
v_dot2c_f32_bf16 v99, v103, v250
s_waitcnt vmcnt(4)
v_dot2c_f32_bf16 v92, v104, v249
v_dot2c_f32_bf16 v93, v104, v250
v_dot2c_f32_bf16 v94, v105, v249
v_dot2c_f32_bf16 v95, v105, v250
v_dot2c_f32_bf16 v96, v106, v249
v_dot2c_f32_bf16 v97, v106, v250
v_dot2c_f32_bf16 v98, v107, v249
v_dot2c_f32_bf16 v99, v107, v250
v_fma_f32 v132, v92, v93, v94
v_fma_f32 v133, v95, v96, v97
s_nop 0
v_fma_f32 v134, v98, v99, v128
v_fma_f32 v132, v132, v133, v134
v_cmp_u_f32 vcc, v132, v135
s_cbranch_vccnz L_kvredo1
L_kvback1:
v_cvt_pk_bf16_f32 v128, v128, v129
v_cvt_pk_bf16_f32 v129, v130, v131
v_cvt_pk_bf16_f32 v92, v92, v93
v_cndmask_b32 v128, 0, v128, s[56:57]
v_cndmask_b32 v129, 0, v129, s[56:57]
v_cvt_pk_bf16_f32 v93, v94, v95
v_cvt_pk_bf16_f32 v94, v96, v97
v_cvt_pk_bf16_f32 v95, v98, v99
v_cndmask_b32 v128, v128, v16, s[58:59]
v_cndmask_b32 v129, v129, v16, s[58:59]
ds_write_b64 v252, v[92:93] offset:0
ds_write_b64 v252, v[94:95] offset:1024
ds_write_b64 v252, v[128:129] offset:2048
s_waitcnt lgkmcnt(0)
s_barrier
ds_read_b128 a[8:11], v1 offset:2048
ds_read_b128 a[20:23], v1 offset:5120
ds_read_b128 a[0:3], v1 offset:0
ds_read_b128 a[12:15], v1 offset:3072
ds_read_b128 a[4:7], v1 offset:1024
ds_read_b128 a[16:19], v1 offset:4096
s_waitcnt lgkmcnt(5)
v_mfma_f32_16x16x32_bf16 v[116:119], a[8:11], v[212:215], 0
s_waitcnt lgkmcnt(4)
v_mfma_f32_16x16x32_bf16 v[120:123], a[20:23], v[216:219], 0
s_waitcnt lgkmcnt(3)
v_mfma_f32_16x16x32_bf16 v[204:207], a[0:3], v[212:215], 0
s_nop 3
v_rcp_f32 v118, v117
s_waitcnt lgkmcnt(2)
v_mfma_f32_16x16x32_bf16 v[220:223], a[12:15], v[216:219], 0
v_rcp_f32 v119, v121
v_mul_f32 v116, v116, v118
v_fmac_f32 v116, v120, v119
v_mfma_f32_16x16x32_bf16 v[100:103], a[8:11], v[164:167], 0
v_add_f32 v116, 0x358637bd, v116
v_rcp_f32 v116, v116
s_waitcnt lgkmcnt(1)
v_mfma_f32_16x16x32_bf16 v[208:211], a[4:7], v[212:215], 0
v_mul_f32 v118, v118, v116
v_mul_f32 v119, v119, v116
v_mfma_f32_16x16x32_bf16 v[104:107], a[20:23], v[168:171], 0
v_mul_f32 v204, v204, v118
v_mul_f32 v205, v205, v118
s_waitcnt lgkmcnt(0)
v_mfma_f32_16x16x32_bf16 v[224:227], a[16:19], v[216:219], 0
v_mul_f32 v206, v206, v118
v_mul_f32 v207, v207, v118
v_fmac_f32 v204, v220, v119
v_fmac_f32 v205, v221, v119
v_rcp_f32 v102, v101
v_mul_f32 v208, v208, v118
v_mul_f32 v209, v209, v118
v_mul_f32 v210, v210, v118
v_mul_f32 v211, v211, v118
v_fmac_f32 v206, v222, v119
v_fmac_f32 v207, v223, v119
v_cvt_pk_bf16_f32 v204, v204, v205
v_rcp_f32 v103, v105
v_fmac_f32 v208, v224, v119
v_fmac_f32 v209, v225, v119
v_fmac_f32 v210, v226, v119
v_fmac_f32 v211, v227, v119
v_cvt_pk_bf16_f32 v205, v206, v207
v_cvt_pk_bf16_f32 v206, v208, v209
v_cvt_pk_bf16_f32 v207, v210, v211
v_mul_f32 v100, v100, v102
v_mfma_f32_16x16x32_bf16 v[156:159], a[0:3], v[164:167], 0
buffer_store_dwordx4 v[204:207], v2, s[4:7], s72 offen offset:3072 sc1
v_fmac_f32 v100, v104, v103
v_mfma_f32_16x16x32_bf16 v[172:175], a[12:15], v[168:171], 0
v_add_f32 v100, 0x358637bd, v100
v_rcp_f32 v100, v100
v_mfma_f32_16x16x32_bf16 v[108:111], a[8:11], v[188:191], 0
v_mul_f32 v102, v102, v100
v_mul_f32 v103, v103, v100
v_mfma_f32_16x16x32_bf16 v[160:163], a[4:7], v[164:167], 0
v_mul_f32 v156, v156, v102
v_mul_f32 v157, v157, v102
v_mfma_f32_16x16x32_bf16 v[112:115], a[20:23], v[192:195], 0
v_mul_f32 v158, v158, v102
v_mul_f32 v159, v159, v102
v_mfma_f32_16x16x32_bf16 v[176:179], a[16:19], v[168:171], 0
v_fmac_f32 v156, v172, v103
v_fmac_f32 v157, v173, v103
v_rcp_f32 v110, v109
v_mul_f32 v160, v160, v102
v_mul_f32 v161, v161, v102
v_mul_f32 v162, v162, v102
v_mul_f32 v163, v163, v102
v_fmac_f32 v158, v174, v103
v_fmac_f32 v159, v175, v103
v_cvt_pk_bf16_f32 v156, v156, v157
v_rcp_f32 v111, v113
v_fmac_f32 v160, v176, v103
v_fmac_f32 v161, v177, v103
v_fmac_f32 v162, v178, v103
v_fmac_f32 v163, v179, v103
v_cvt_pk_bf16_f32 v157, v158, v159
v_cvt_pk_bf16_f32 v158, v160, v161
v_cvt_pk_bf16_f32 v159, v162, v163
v_mul_f32 v108, v108, v110
v_mfma_f32_16x16x32_bf16 v[180:183], a[0:3], v[188:191], 0
buffer_store_dwordx4 v[156:159], v2, s[4:7], s72 offen offset:1024 sc1
v_fmac_f32 v108, v112, v111
v_mfma_f32_16x16x32_bf16 v[196:199], a[12:15], v[192:195], 0
v_add_f32 v108, 0x358637bd, v108
v_rcp_f32 v108, v108
v_mfma_f32_16x16x32_bf16 v[92:95], a[8:11], v[140:143], 0
v_mul_f32 v110, v110, v108
v_mul_f32 v111, v111, v108
v_mfma_f32_16x16x32_bf16 v[184:187], a[4:7], v[188:191], 0
v_mul_f32 v180, v180, v110
v_mul_f32 v181, v181, v110
v_mfma_f32_16x16x32_bf16 v[96:99], a[20:23], v[144:147], 0
v_mul_f32 v182, v182, v110
v_mul_f32 v183, v183, v110
v_mfma_f32_16x16x32_bf16 v[200:203], a[16:19], v[192:195], 0
v_fmac_f32 v180, v196, v111
v_fmac_f32 v181, v197, v111
v_rcp_f32 v94, v93
v_mul_f32 v184, v184, v110
v_mul_f32 v185, v185, v110
v_mul_f32 v186, v186, v110
v_mul_f32 v187, v187, v110
v_fmac_f32 v182, v198, v111
v_fmac_f32 v183, v199, v111
v_cvt_pk_bf16_f32 v180, v180, v181
v_rcp_f32 v95, v97
buffer_atomic_add v12, v10, s[4:7], s74 offen sc1
v_fmac_f32 v184, v200, v111
v_fmac_f32 v185, v201, v111
v_fmac_f32 v186, v202, v111
v_fmac_f32 v187, v203, v111
v_cvt_pk_bf16_f32 v181, v182, v183
v_cvt_pk_bf16_f32 v182, v184, v185
v_cvt_pk_bf16_f32 v183, v186, v187
v_mul_f32 v92, v92, v94
v_mfma_f32_16x16x32_bf16 v[132:135], a[0:3], v[140:143], 0
buffer_store_dwordx4 v[180:183], v2, s[4:7], s72 offen offset:2048 sc1
v_fmac_f32 v92, v96, v95
v_mfma_f32_16x16x32_bf16 v[148:151], a[12:15], v[144:147], 0
v_add_f32 v92, 0x358637bd, v92
v_rcp_f32 v92, v92
v_mfma_f32_16x16x32_bf16 v[136:139], a[4:7], v[140:143], 0
v_mul_f32 v94, v94, v92
v_mul_f32 v95, v95, v92
v_mfma_f32_16x16x32_bf16 v[152:155], a[16:19], v[144:147], 0
v_mul_f32 v132, v132, v94
v_mul_f32 v133, v133, v94
v_mul_f32 v134, v134, v94
v_mul_f32 v135, v135, v94
v_fmac_f32 v132, v148, v95
v_fmac_f32 v133, v149, v95
v_mul_f32 v136, v136, v94
v_mul_f32 v137, v137, v94
v_mul_f32 v138, v138, v94
v_mul_f32 v139, v139, v94
v_fmac_f32 v134, v150, v95
v_fmac_f32 v135, v151, v95
v_cvt_pk_bf16_f32 v132, v132, v133
v_fmac_f32 v136, v152, v95
v_fmac_f32 v137, v153, v95
v_fmac_f32 v138, v154, v95
v_fmac_f32 v139, v155, v95
v_cvt_pk_bf16_f32 v133, v134, v135
v_cvt_pk_bf16_f32 v134, v136, v137
v_cvt_pk_bf16_f32 v135, v138, v139
buffer_store_dwordx4 v[132:135], v2, s[4:7], s72 offen offset:0 sc1
s_add_u32 s92, s71, 0x10000
s_add_u32 s36, s66, 0x10080
s_add_u32 s40, s4, 0x2600000
s_addc_u32 s41, s5, 0
v_add_u32 v5, 32768, v1
v_add_u32 v6, 98304, v1
s_cmp_eq_u32 s3, 0
s_cselect_b32 s35, 8, 0
s_lshl_b32 s35, s35, 12
v_lshlrev_b32 v132, 16, v32
v_and_b32 v133, 0xffff0000, v32
v_lshlrev_b32 v134, 16, v33
v_and_b32 v135, 0xffff0000, v33
v_lshlrev_b32 v136, 16, v34
v_and_b32 v137, 0xffff0000, v34
v_lshlrev_b32 v138, 16, v35
v_and_b32 v139, 0xffff0000, v35
v_lshlrev_b32 v140, 16, v36
v_and_b32 v141, 0xffff0000, v36
v_lshlrev_b32 v142, 16, v37
v_and_b32 v143, 0xffff0000, v37
v_lshlrev_b32 v144, 16, v38
v_and_b32 v145, 0xffff0000, v38
v_lshlrev_b32 v146, 16, v39
v_and_b32 v147, 0xffff0000, v39
v_lshlrev_b32 v148, 16, v40
v_and_b32 v149, 0xffff0000, v40
v_lshlrev_b32 v150, 16, v41
v_and_b32 v151, 0xffff0000, v41
v_lshlrev_b32 v152, 16, v42
v_and_b32 v153, 0xffff0000, v42
v_lshlrev_b32 v154, 16, v43
v_and_b32 v155, 0xffff0000, v43
v_lshlrev_b32 v156, 16, v44
v_and_b32 v157, 0xffff0000, v44
v_lshlrev_b32 v158, 16, v45
v_and_b32 v159, 0xffff0000, v45
v_lshlrev_b32 v160, 16, v46
v_and_b32 v161, 0xffff0000, v46
v_lshlrev_b32 v162, 16, v47
v_and_b32 v163, 0xffff0000, v47
s_mov_b32 s95, -1
s_mov_b64 exec, 0
s_cmp_eq_u32 s28, 3
s_cbranch_scc1 L_stub9
s_cmp_eq_u32 s28, 2
s_cbranch_scc1 L_wret3
L_wret3:
s_mov_b64 exec, -1
s_cmp_lg_u32 s28, 1
s_cbranch_scc1 Lpo_25
s_add_u32 s36, s66, 0x10080
s_mov_b32 s37, 0
v_mov_b32 v11, 0
buffer_atomic_add v11, v251, s[4:7], s36 offen sc0 sc1
s_sleep 4
Lpoll_23:
v_mov_b32 v234, 0
buffer_atomic_add v234, v251, s[4:7], s36 offen sc0 sc1
s_waitcnt vmcnt(1)
v_readfirstlane_b32 s38, v11
s_nop 0
s_cmp_ge_u32 s38, 32
s_cbranch_scc1 Lpe_24
v_mov_b32 v11, 0
buffer_atomic_add v11, v251, s[4:7], s36 offen sc0 sc1
s_waitcnt vmcnt(1)
v_readfirstlane_b32 s38, v234
s_nop 0
s_cmp_ge_u32 s38, 32
s_cbranch_scc1 Lpe_24
s_add_u32 s37, s37, 1
s_cmp_lt_u32 s37, 0x80000
s_cbranch_scc1 Lpoll_23
s_waitcnt vmcnt(0)
Lpo_25:
s_waitcnt vmcnt(0)
Lpe_24:
s_barrier
L_k2go1:
buffer_load_dwordx4 a[0:3], v4, s[40:43], s35 offen offset:0 sc1
buffer_load_dwordx4 a[4:7], v4, s[40:43], s35 offen offset:1024 sc1
s_cmp_eq_u32 s3, 1
s_cselect_b32 s35, 9, 1
s_lshl_b32 s35, s35, 12
buffer_load_dwordx4 a[8:11], v4, s[40:43], s35 offen offset:0 sc1
buffer_load_dwordx4 a[12:15], v4, s[40:43], s35 offen offset:1024 sc1
s_cmp_eq_u32 s3, 2
s_cselect_b32 s35, 10, 2
s_lshl_b32 s35, s35, 12
buffer_load_dwordx4 a[16:19], v4, s[40:43], s35 offen offset:0 sc1
buffer_load_dwordx4 a[20:23], v4, s[40:43], s35 offen offset:1024 sc1
s_cmp_eq_u32 s3, 3
s_cselect_b32 s35, 11, 3
s_lshl_b32 s35, s35, 12
buffer_load_dwordx4 a[24:27], v4, s[40:43], s35 offen offset:0 sc1
buffer_load_dwordx4 a[28:31], v4, s[40:43], s35 offen offset:1024 sc1
s_cmp_eq_u32 s3, 4
s_cselect_b32 s35, 12, 4
s_lshl_b32 s35, s35, 12
buffer_load_dwordx4 a[32:35], v4, s[40:43], s35 offen offset:0 sc1
buffer_load_dwordx4 a[36:39], v4, s[40:43], s35 offen offset:1024 sc1
s_cmp_eq_u32 s3, 5
s_cselect_b32 s35, 13, 5
s_lshl_b32 s35, s35, 12
buffer_load_dwordx4 a[40:43], v4, s[40:43], s35 offen offset:0 sc1
buffer_load_dwordx4 a[44:47], v4, s[40:43], s35 offen offset:1024 sc1
s_cmp_eq_u32 s3, 6
s_cselect_b32 s35, 14, 6
s_lshl_b32 s35, s35, 12
ds_read_b128 a[96:99], v5 offset:0
ds_read_b128 a[100:103], v5 offset:1024
ds_read_b128 a[104:107], v5 offset:2048
ds_read_b128 a[108:111], v5 offset:3072
ds_read_b128 a[112:115], v5 offset:4096
ds_read_b128 a[116:119], v5 offset:5120
ds_read_b128 a[120:123], v5 offset:6144
ds_read_b128 a[124:127], v5 offset:7168
s_waitcnt vmcnt(10) lgkmcnt(4)
v_mfma_f32_16x16x32_bf16 v[132:135], a[96:99], a[0:3], v[132:135]
ds_read_b128 a[128:131], v5 offset:8192
v_mfma_f32_16x16x32_bf16 v[148:151], a[96:99], a[4:7], v[148:151]
ds_read_b128 a[132:135], v5 offset:9216
v_mfma_f32_16x16x32_bf16 v[152:155], a[100:103], a[4:7], v[152:155]
buffer_load_dwordx4 a[48:51], v4, s[40:43], s35 offen offset:0 sc1
v_mfma_f32_16x16x32_bf16 v[136:139], a[100:103], a[0:3], v[136:139]
ds_read_b128 a[136:139], v5 offset:10240
v_mfma_f32_16x16x32_bf16 v[140:143], a[104:107], a[0:3], v[140:143]
ds_read_b128 a[140:143], v5 offset:11264
v_mfma_f32_16x16x32_bf16 v[156:159], a[104:107], a[4:7], v[156:159]
v_mfma_f32_16x16x32_bf16 v[160:163], a[108:111], a[4:7], v[160:163]
buffer_load_dwordx4 a[52:55], v4, s[40:43], s35 offen offset:1024 sc1
v_mfma_f32_16x16x32_bf16 v[144:147], a[108:111], a[0:3], v[144:147]
s_waitcnt vmcnt(10) lgkmcnt(4)
v_mfma_f32_16x16x32_bf16 v[132:135], a[112:115], a[8:11], v[132:135]
s_cmp_eq_u32 s3, 7
s_cselect_b32 s35, 15, 7
s_lshl_b32 s35, s35, 12
v_mfma_f32_16x16x32_bf16 v[148:151], a[112:115], a[12:15], v[148:151]
ds_read_b128 a[96:99], v5 offset:12288
v_mfma_f32_16x16x32_bf16 v[152:155], a[116:119], a[12:15], v[152:155]
buffer_load_dwordx4 a[0:3], v4, s[40:43], s35 offen offset:0 sc1
v_mfma_f32_16x16x32_bf16 v[136:139], a[116:119], a[8:11], v[136:139]
ds_read_b128 a[100:103], v5 offset:13312
v_mfma_f32_16x16x32_bf16 v[140:143], a[120:123], a[8:11], v[140:143]
ds_read_b128 a[104:107], v5 offset:14336
v_mfma_f32_16x16x32_bf16 v[156:159], a[120:123], a[12:15], v[156:159]
ds_read_b128 a[108:111], v5 offset:15360
v_mfma_f32_16x16x32_bf16 v[160:163], a[124:127], a[12:15], v[160:163]
buffer_load_dwordx4 a[4:7], v4, s[40:43], s35 offen offset:1024 sc1
v_mfma_f32_16x16x32_bf16 v[144:147], a[124:127], a[8:11], v[144:147]
s_waitcnt vmcnt(10) lgkmcnt(4)
v_mfma_f32_16x16x32_bf16 v[132:135], a[128:131], a[16:19], v[132:135]
s_cmp_eq_u32 s3, 0
s_cselect_b32 s35, 16, 8
s_lshl_b32 s35, s35, 12
v_mfma_f32_16x16x32_bf16 v[148:151], a[128:131], a[20:23], v[148:151]
ds_read_b128 a[112:115], v5 offset:16384
v_mfma_f32_16x16x32_bf16 v[152:155], a[132:135], a[20:23], v[152:155]
buffer_load_dwordx4 a[8:11], v4, s[40:43], s35 offen offset:0 sc1
v_mfma_f32_16x16x32_bf16 v[136:139], a[132:135], a[16:19], v[136:139]
ds_read_b128 a[116:119], v5 offset:17408
v_mfma_f32_16x16x32_bf16 v[140:143], a[136:139], a[16:19], v[140:143]
ds_read_b128 a[120:123], v5 offset:18432
v_mfma_f32_16x16x32_bf16 v[156:159], a[136:139], a[20:23], v[156:159]
ds_read_b128 a[124:127], v5 offset:19456
v_mfma_f32_16x16x32_bf16 v[160:163], a[140:143], a[20:23], v[160:163]
buffer_load_dwordx4 a[12:15], v4, s[40:43], s35 offen offset:1024 sc1
v_mfma_f32_16x16x32_bf16 v[144:147], a[140:143], a[16:19], v[144:147]
s_waitcnt vmcnt(10) lgkmcnt(4)
v_mfma_f32_16x16x32_bf16 v[132:135], a[96:99], a[24:27], v[132:135]
s_cmp_eq_u32 s3, 1
s_cselect_b32 s35, 17, 9
s_lshl_b32 s35, s35, 12
v_mfma_f32_16x16x32_bf16 v[148:151], a[96:99], a[28:31], v[148:151]
ds_read_b128 a[128:131], v5 offset:20480
v_mfma_f32_16x16x32_bf16 v[152:155], a[100:103], a[28:31], v[152:155]
buffer_load_dwordx4 a[16:19], v4, s[40:43], s35 offen offset:0 sc1
v_mfma_f32_16x16x32_bf16 v[136:139], a[100:103], a[24:27], v[136:139]
ds_read_b128 a[132:135], v5 offset:21504
v_mfma_f32_16x16x32_bf16 v[140:143], a[104:107], a[24:27], v[140:143]
ds_read_b128 a[136:139], v5 offset:22528
v_mfma_f32_16x16x32_bf16 v[156:159], a[104:107], a[28:31], v[156:159]
ds_read_b128 a[140:143], v5 offset:23552
v_mfma_f32_16x16x32_bf16 v[160:163], a[108:111], a[28:31], v[160:163]
buffer_load_dwordx4 a[20:23], v4, s[40:43], s35 offen offset:1024 sc1
v_mfma_f32_16x16x32_bf16 v[144:147], a[108:111], a[24:27], v[144:147]
s_waitcnt vmcnt(10) lgkmcnt(4)
v_mfma_f32_16x16x32_bf16 v[132:135], a[112:115], a[32:35], v[132:135]
s_cmp_eq_u32 s3, 2
s_cselect_b32 s35, 18, 10
s_lshl_b32 s35, s35, 12
v_mfma_f32_16x16x32_bf16 v[148:151], a[112:115], a[36:39], v[148:151]
ds_read_b128 a[96:99], v5 offset:24576
v_mfma_f32_16x16x32_bf16 v[152:155], a[116:119], a[36:39], v[152:155]
buffer_load_dwordx4 a[24:27], v4, s[40:43], s35 offen offset:0 sc1
v_mfma_f32_16x16x32_bf16 v[136:139], a[116:119], a[32:35], v[136:139]
ds_read_b128 a[100:103], v5 offset:25600
v_mfma_f32_16x16x32_bf16 v[140:143], a[120:123], a[32:35], v[140:143]
ds_read_b128 a[104:107], v5 offset:26624
v_mfma_f32_16x16x32_bf16 v[156:159], a[120:123], a[36:39], v[156:159]
ds_read_b128 a[108:111], v5 offset:27648
v_mfma_f32_16x16x32_bf16 v[160:163], a[124:127], a[36:39], v[160:163]
buffer_load_dwordx4 a[28:31], v4, s[40:43], s35 offen offset:1024 sc1
v_mfma_f32_16x16x32_bf16 v[144:147], a[124:127], a[32:35], v[144:147]
s_waitcnt vmcnt(10) lgkmcnt(4)
v_mfma_f32_16x16x32_bf16 v[132:135], a[128:131], a[40:43], v[132:135]
s_cmp_eq_u32 s3, 3
s_cselect_b32 s35, 19, 11
s_lshl_b32 s35, s35, 12
v_mfma_f32_16x16x32_bf16 v[148:151], a[128:131], a[44:47], v[148:151]
ds_read_b128 a[112:115], v5 offset:28672
v_mfma_f32_16x16x32_bf16 v[152:155], a[132:135], a[44:47], v[152:155]
buffer_load_dwordx4 a[32:35], v4, s[40:43], s35 offen offset:0 sc1
v_mfma_f32_16x16x32_bf16 v[136:139], a[132:135], a[40:43], v[136:139]
ds_read_b128 a[116:119], v5 offset:29696
v_mfma_f32_16x16x32_bf16 v[140:143], a[136:139], a[40:43], v[140:143]
ds_read_b128 a[120:123], v5 offset:30720
v_mfma_f32_16x16x32_bf16 v[156:159], a[136:139], a[44:47], v[156:159]
ds_read_b128 a[124:127], v5 offset:31744
v_mfma_f32_16x16x32_bf16 v[160:163], a[140:143], a[44:47], v[160:163]
buffer_load_dwordx4 a[36:39], v4, s[40:43], s35 offen offset:1024 sc1
v_mfma_f32_16x16x32_bf16 v[144:147], a[140:143], a[40:43], v[144:147]
s_waitcnt vmcnt(10) lgkmcnt(4)
v_mfma_f32_16x16x32_bf16 v[132:135], a[96:99], a[48:51], v[132:135]
s_cmp_eq_u32 s3, 4
s_cselect_b32 s35, 20, 12
s_lshl_b32 s35, s35, 12
v_mfma_f32_16x16x32_bf16 v[148:151], a[96:99], a[52:55], v[148:151]
ds_read_b128 a[128:131], v5 offset:32768
v_mfma_f32_16x16x32_bf16 v[152:155], a[100:103], a[52:55], v[152:155]
buffer_load_dwordx4 a[40:43], v4, s[40:43], s35 offen offset:0 sc1
v_mfma_f32_16x16x32_bf16 v[136:139], a[100:103], a[48:51], v[136:139]
ds_read_b128 a[132:135], v5 offset:33792
v_mfma_f32_16x16x32_bf16 v[140:143], a[104:107], a[48:51], v[140:143]
ds_read_b128 a[136:139], v5 offset:34816
v_mfma_f32_16x16x32_bf16 v[156:159], a[104:107], a[52:55], v[156:159]
ds_read_b128 a[140:143], v5 offset:35840
v_mfma_f32_16x16x32_bf16 v[160:163], a[108:111], a[52:55], v[160:163]
buffer_load_dwordx4 a[44:47], v4, s[40:43], s35 offen offset:1024 sc1
v_mfma_f32_16x16x32_bf16 v[144:147], a[108:111], a[48:51], v[144:147]
s_waitcnt vmcnt(10) lgkmcnt(4)
v_mfma_f32_16x16x32_bf16 v[132:135], a[112:115], a[0:3], v[132:135]
s_cmp_eq_u32 s3, 5
s_cselect_b32 s35, 21, 13
s_lshl_b32 s35, s35, 12
v_mfma_f32_16x16x32_bf16 v[148:151], a[112:115], a[4:7], v[148:151]
ds_read_b128 a[96:99], v5 offset:36864
v_mfma_f32_16x16x32_bf16 v[152:155], a[116:119], a[4:7], v[152:155]
buffer_load_dwordx4 a[48:51], v4, s[40:43], s35 offen offset:0 sc1
v_mfma_f32_16x16x32_bf16 v[136:139], a[116:119], a[0:3], v[136:139]
ds_read_b128 a[100:103], v5 offset:37888
v_mfma_f32_16x16x32_bf16 v[140:143], a[120:123], a[0:3], v[140:143]
ds_read_b128 a[104:107], v5 offset:38912
v_mfma_f32_16x16x32_bf16 v[156:159], a[120:123], a[4:7], v[156:159]
ds_read_b128 a[108:111], v5 offset:39936
v_mfma_f32_16x16x32_bf16 v[160:163], a[124:127], a[4:7], v[160:163]
buffer_load_dwordx4 a[52:55], v4, s[40:43], s35 offen offset:1024 sc1
v_mfma_f32_16x16x32_bf16 v[144:147], a[124:127], a[0:3], v[144:147]
s_waitcnt vmcnt(10) lgkmcnt(4)
v_mfma_f32_16x16x32_bf16 v[132:135], a[128:131], a[8:11], v[132:135]
s_cmp_eq_u32 s3, 6
s_cselect_b32 s35, 22, 14
s_lshl_b32 s35, s35, 12
v_mfma_f32_16x16x32_bf16 v[148:151], a[128:131], a[12:15], v[148:151]
ds_read_b128 a[112:115], v5 offset:40960
v_mfma_f32_16x16x32_bf16 v[152:155], a[132:135], a[12:15], v[152:155]
buffer_load_dwordx4 a[0:3], v4, s[40:43], s35 offen offset:0 sc1
v_mfma_f32_16x16x32_bf16 v[136:139], a[132:135], a[8:11], v[136:139]
ds_read_b128 a[116:119], v5 offset:41984
v_mfma_f32_16x16x32_bf16 v[140:143], a[136:139], a[8:11], v[140:143]
ds_read_b128 a[120:123], v5 offset:43008
v_mfma_f32_16x16x32_bf16 v[156:159], a[136:139], a[12:15], v[156:159]
ds_read_b128 a[124:127], v5 offset:44032
v_mfma_f32_16x16x32_bf16 v[160:163], a[140:143], a[12:15], v[160:163]
buffer_load_dwordx4 a[4:7], v4, s[40:43], s35 offen offset:1024 sc1
v_mfma_f32_16x16x32_bf16 v[144:147], a[140:143], a[8:11], v[144:147]
s_waitcnt vmcnt(10) lgkmcnt(4)
v_mfma_f32_16x16x32_bf16 v[132:135], a[96:99], a[16:19], v[132:135]
s_cmp_eq_u32 s3, 7
s_cselect_b32 s35, 23, 15
s_lshl_b32 s35, s35, 12
v_mfma_f32_16x16x32_bf16 v[148:151], a[96:99], a[20:23], v[148:151]
ds_read_b128 a[128:131], v5 offset:45056
v_mfma_f32_16x16x32_bf16 v[152:155], a[100:103], a[20:23], v[152:155]
buffer_load_dwordx4 a[8:11], v4, s[40:43], s35 offen offset:0 sc1
v_mfma_f32_16x16x32_bf16 v[136:139], a[100:103], a[16:19], v[136:139]
ds_read_b128 a[132:135], v5 offset:46080
v_mfma_f32_16x16x32_bf16 v[140:143], a[104:107], a[16:19], v[140:143]
ds_read_b128 a[136:139], v5 offset:47104
v_mfma_f32_16x16x32_bf16 v[156:159], a[104:107], a[20:23], v[156:159]
ds_read_b128 a[140:143], v5 offset:48128
v_mfma_f32_16x16x32_bf16 v[160:163], a[108:111], a[20:23], v[160:163]
buffer_load_dwordx4 a[12:15], v4, s[40:43], s35 offen offset:1024 sc1
v_mfma_f32_16x16x32_bf16 v[144:147], a[108:111], a[16:19], v[144:147]
s_waitcnt vmcnt(10) lgkmcnt(4)
v_mfma_f32_16x16x32_bf16 v[132:135], a[112:115], a[24:27], v[132:135]
s_cmp_eq_u32 s3, 0
s_cselect_b32 s35, 24, 16
s_lshl_b32 s35, s35, 12
v_mfma_f32_16x16x32_bf16 v[148:151], a[112:115], a[28:31], v[148:151]
ds_read_b128 a[96:99], v5 offset:49152
v_mfma_f32_16x16x32_bf16 v[152:155], a[116:119], a[28:31], v[152:155]
buffer_load_dwordx4 a[16:19], v4, s[40:43], s35 offen offset:0 sc1
v_mfma_f32_16x16x32_bf16 v[136:139], a[116:119], a[24:27], v[136:139]
ds_read_b128 a[100:103], v5 offset:50176
v_mfma_f32_16x16x32_bf16 v[140:143], a[120:123], a[24:27], v[140:143]
ds_read_b128 a[104:107], v5 offset:51200
v_mfma_f32_16x16x32_bf16 v[156:159], a[120:123], a[28:31], v[156:159]
ds_read_b128 a[108:111], v5 offset:52224
v_mfma_f32_16x16x32_bf16 v[160:163], a[124:127], a[28:31], v[160:163]
buffer_load_dwordx4 a[20:23], v4, s[40:43], s35 offen offset:1024 sc1
v_mfma_f32_16x16x32_bf16 v[144:147], a[124:127], a[24:27], v[144:147]
s_waitcnt vmcnt(10) lgkmcnt(4)
v_mfma_f32_16x16x32_bf16 v[132:135], a[128:131], a[32:35], v[132:135]
s_cmp_eq_u32 s3, 1
s_cselect_b32 s35, 25, 17
s_lshl_b32 s35, s35, 12
v_mfma_f32_16x16x32_bf16 v[148:151], a[128:131], a[36:39], v[148:151]
ds_read_b128 a[112:115], v5 offset:53248
v_mfma_f32_16x16x32_bf16 v[152:155], a[132:135], a[36:39], v[152:155]
buffer_load_dwordx4 a[24:27], v4, s[40:43], s35 offen offset:0 sc1
v_mfma_f32_16x16x32_bf16 v[136:139], a[132:135], a[32:35], v[136:139]
ds_read_b128 a[116:119], v5 offset:54272
v_mfma_f32_16x16x32_bf16 v[140:143], a[136:139], a[32:35], v[140:143]
ds_read_b128 a[120:123], v5 offset:55296
v_mfma_f32_16x16x32_bf16 v[156:159], a[136:139], a[36:39], v[156:159]
ds_read_b128 a[124:127], v5 offset:56320
v_mfma_f32_16x16x32_bf16 v[160:163], a[140:143], a[36:39], v[160:163]
buffer_load_dwordx4 a[28:31], v4, s[40:43], s35 offen offset:1024 sc1
v_mfma_f32_16x16x32_bf16 v[144:147], a[140:143], a[32:35], v[144:147]
s_waitcnt vmcnt(10) lgkmcnt(4)
v_mfma_f32_16x16x32_bf16 v[132:135], a[96:99], a[40:43], v[132:135]
s_cmp_eq_u32 s3, 2
s_cselect_b32 s35, 26, 18
s_lshl_b32 s35, s35, 12
v_mfma_f32_16x16x32_bf16 v[148:151], a[96:99], a[44:47], v[148:151]
ds_read_b128 a[128:131], v5 offset:57344
v_mfma_f32_16x16x32_bf16 v[152:155], a[100:103], a[44:47], v[152:155]
buffer_load_dwordx4 a[32:35], v4, s[40:43], s35 offen offset:0 sc1
v_mfma_f32_16x16x32_bf16 v[136:139], a[100:103], a[40:43], v[136:139]
ds_read_b128 a[132:135], v5 offset:58368
v_mfma_f32_16x16x32_bf16 v[140:143], a[104:107], a[40:43], v[140:143]
ds_read_b128 a[136:139], v5 offset:59392
v_mfma_f32_16x16x32_bf16 v[156:159], a[104:107], a[44:47], v[156:159]
ds_read_b128 a[140:143], v5 offset:60416
v_mfma_f32_16x16x32_bf16 v[160:163], a[108:111], a[44:47], v[160:163]
buffer_load_dwordx4 a[36:39], v4, s[40:43], s35 offen offset:1024 sc1
v_mfma_f32_16x16x32_bf16 v[144:147], a[108:111], a[40:43], v[144:147]
s_waitcnt vmcnt(10) lgkmcnt(4)
v_mfma_f32_16x16x32_bf16 v[132:135], a[112:115], a[48:51], v[132:135]
s_cmp_eq_u32 s3, 3
s_cselect_b32 s35, 27, 19
s_lshl_b32 s35, s35, 12
v_mfma_f32_16x16x32_bf16 v[148:151], a[112:115], a[52:55], v[148:151]
ds_read_b128 a[96:99], v5 offset:61440
v_mfma_f32_16x16x32_bf16 v[152:155], a[116:119], a[52:55], v[152:155]
buffer_load_dwordx4 a[40:43], v4, s[40:43], s35 offen offset:0 sc1
v_mfma_f32_16x16x32_bf16 v[136:139], a[116:119], a[48:51], v[136:139]
ds_read_b128 a[100:103], v5 offset:62464
v_mfma_f32_16x16x32_bf16 v[140:143], a[120:123], a[48:51], v[140:143]
ds_read_b128 a[104:107], v5 offset:63488
v_mfma_f32_16x16x32_bf16 v[156:159], a[120:123], a[52:55], v[156:159]
ds_read_b128 a[108:111], v5 offset:64512
v_mfma_f32_16x16x32_bf16 v[160:163], a[124:127], a[52:55], v[160:163]
buffer_load_dwordx4 a[44:47], v4, s[40:43], s35 offen offset:1024 sc1
v_mfma_f32_16x16x32_bf16 v[144:147], a[124:127], a[48:51], v[144:147]
s_waitcnt vmcnt(10) lgkmcnt(4)
v_mfma_f32_16x16x32_bf16 v[132:135], a[128:131], a[0:3], v[132:135]
s_cmp_eq_u32 s3, 4
s_cselect_b32 s35, 28, 20
s_lshl_b32 s35, s35, 12
v_mfma_f32_16x16x32_bf16 v[148:151], a[128:131], a[4:7], v[148:151]
ds_read_b128 a[112:115], v6 offset:0
v_mfma_f32_16x16x32_bf16 v[152:155], a[132:135], a[4:7], v[152:155]
buffer_load_dwordx4 a[48:51], v4, s[40:43], s35 offen offset:0 sc1
v_mfma_f32_16x16x32_bf16 v[136:139], a[132:135], a[0:3], v[136:139]
ds_read_b128 a[116:119], v6 offset:1024
v_mfma_f32_16x16x32_bf16 v[140:143], a[136:139], a[0:3], v[140:143]
ds_read_b128 a[120:123], v6 offset:2048
v_mfma_f32_16x16x32_bf16 v[156:159], a[136:139], a[4:7], v[156:159]
ds_read_b128 a[124:127], v6 offset:3072
v_mfma_f32_16x16x32_bf16 v[160:163], a[140:143], a[4:7], v[160:163]
buffer_load_dwordx4 a[52:55], v4, s[40:43], s35 offen offset:1024 sc1
v_mfma_f32_16x16x32_bf16 v[144:147], a[140:143], a[0:3], v[144:147]
s_waitcnt vmcnt(10) lgkmcnt(4)
v_mfma_f32_16x16x32_bf16 v[132:135], a[96:99], a[8:11], v[132:135]
s_cmp_eq_u32 s3, 5
s_cselect_b32 s35, 29, 21
s_lshl_b32 s35, s35, 12
v_mfma_f32_16x16x32_bf16 v[148:151], a[96:99], a[12:15], v[148:151]
ds_read_b128 a[128:131], v6 offset:4096
v_mfma_f32_16x16x32_bf16 v[152:155], a[100:103], a[12:15], v[152:155]
buffer_load_dwordx4 a[0:3], v4, s[40:43], s35 offen offset:0 sc1
v_mfma_f32_16x16x32_bf16 v[136:139], a[100:103], a[8:11], v[136:139]
ds_read_b128 a[132:135], v6 offset:5120
v_mfma_f32_16x16x32_bf16 v[140:143], a[104:107], a[8:11], v[140:143]
ds_read_b128 a[136:139], v6 offset:6144
v_mfma_f32_16x16x32_bf16 v[156:159], a[104:107], a[12:15], v[156:159]
ds_read_b128 a[140:143], v6 offset:7168
L_stub9:
s_cbranch_execz L_wret3
v_mfma_f32_16x16x32_bf16 v[160:163], a[108:111], a[12:15], v[160:163]
buffer_load_dwordx4 a[4:7], v4, s[40:43], s35 offen offset:1024 sc1
v_mfma_f32_16x16x32_bf16 v[144:147], a[108:111], a[8:11], v[144:147]
s_waitcnt vmcnt(10) lgkmcnt(4)
v_mfma_f32_16x16x32_bf16 v[132:135], a[112:115], a[16:19], v[132:135]
s_cmp_eq_u32 s3, 6
s_cselect_b32 s35, 30, 22
s_lshl_b32 s35, s35, 12
v_mfma_f32_16x16x32_bf16 v[148:151], a[112:115], a[20:23], v[148:151]
ds_read_b128 a[96:99], v6 offset:8192
v_mfma_f32_16x16x32_bf16 v[152:155], a[116:119], a[20:23], v[152:155]
buffer_load_dwordx4 a[8:11], v4, s[40:43], s35 offen offset:0 sc1
v_mfma_f32_16x16x32_bf16 v[136:139], a[116:119], a[16:19], v[136:139]
ds_read_b128 a[100:103], v6 offset:9216
v_mfma_f32_16x16x32_bf16 v[140:143], a[120:123], a[16:19], v[140:143]
ds_read_b128 a[104:107], v6 offset:10240
v_mfma_f32_16x16x32_bf16 v[156:159], a[120:123], a[20:23], v[156:159]
ds_read_b128 a[108:111], v6 offset:11264
v_mfma_f32_16x16x32_bf16 v[160:163], a[124:127], a[20:23], v[160:163]
buffer_load_dwordx4 a[12:15], v4, s[40:43], s35 offen offset:1024 sc1
v_mfma_f32_16x16x32_bf16 v[144:147], a[124:127], a[16:19], v[144:147]
s_waitcnt vmcnt(10) lgkmcnt(4)
v_mfma_f32_16x16x32_bf16 v[132:135], a[128:131], a[24:27], v[132:135]
s_cmp_eq_u32 s3, 7
s_cselect_b32 s35, 31, 23
s_lshl_b32 s35, s35, 12
v_mfma_f32_16x16x32_bf16 v[148:151], a[128:131], a[28:31], v[148:151]
ds_read_b128 a[112:115], v6 offset:12288
v_mfma_f32_16x16x32_bf16 v[152:155], a[132:135], a[28:31], v[152:155]
buffer_load_dwordx4 a[16:19], v4, s[40:43], s35 offen offset:0 sc1
v_mfma_f32_16x16x32_bf16 v[136:139], a[132:135], a[24:27], v[136:139]
ds_read_b128 a[116:119], v6 offset:13312
v_mfma_f32_16x16x32_bf16 v[140:143], a[136:139], a[24:27], v[140:143]
ds_read_b128 a[120:123], v6 offset:14336
v_mfma_f32_16x16x32_bf16 v[156:159], a[136:139], a[28:31], v[156:159]
ds_read_b128 a[124:127], v6 offset:15360
v_mfma_f32_16x16x32_bf16 v[160:163], a[140:143], a[28:31], v[160:163]
buffer_load_dwordx4 a[20:23], v4, s[40:43], s35 offen offset:1024 sc1
v_mfma_f32_16x16x32_bf16 v[144:147], a[140:143], a[24:27], v[144:147]
s_waitcnt vmcnt(10) lgkmcnt(4)
v_mfma_f32_16x16x32_bf16 v[132:135], a[96:99], a[32:35], v[132:135]
s_cmp_eq_u32 s3, 0
s_cselect_b32 s35, 0, 24
s_lshl_b32 s35, s35, 12
v_mfma_f32_16x16x32_bf16 v[148:151], a[96:99], a[36:39], v[148:151]
ds_read_b128 a[128:131], v6 offset:16384
v_mfma_f32_16x16x32_bf16 v[152:155], a[100:103], a[36:39], v[152:155]
buffer_load_dwordx4 a[24:27], v4, s[40:43], s35 offen offset:0 sc1
v_mfma_f32_16x16x32_bf16 v[136:139], a[100:103], a[32:35], v[136:139]
ds_read_b128 a[132:135], v6 offset:17408
v_mfma_f32_16x16x32_bf16 v[140:143], a[104:107], a[32:35], v[140:143]
ds_read_b128 a[136:139], v6 offset:18432
v_mfma_f32_16x16x32_bf16 v[156:159], a[104:107], a[36:39], v[156:159]
ds_read_b128 a[140:143], v6 offset:19456
v_mfma_f32_16x16x32_bf16 v[160:163], a[108:111], a[36:39], v[160:163]
buffer_load_dwordx4 a[28:31], v4, s[40:43], s35 offen offset:1024 sc1
v_mfma_f32_16x16x32_bf16 v[144:147], a[108:111], a[32:35], v[144:147]
s_waitcnt vmcnt(10) lgkmcnt(4)
v_mfma_f32_16x16x32_bf16 v[132:135], a[112:115], a[40:43], v[132:135]
s_cmp_eq_u32 s3, 1
s_cselect_b32 s35, 1, 25
s_lshl_b32 s35, s35, 12
v_mfma_f32_16x16x32_bf16 v[148:151], a[112:115], a[44:47], v[148:151]
ds_read_b128 a[96:99], v6 offset:20480
v_mfma_f32_16x16x32_bf16 v[152:155], a[116:119], a[44:47], v[152:155]
buffer_load_dwordx4 a[32:35], v4, s[40:43], s35 offen offset:0 sc1
v_mfma_f32_16x16x32_bf16 v[136:139], a[116:119], a[40:43], v[136:139]
ds_read_b128 a[100:103], v6 offset:21504
v_mfma_f32_16x16x32_bf16 v[140:143], a[120:123], a[40:43], v[140:143]
ds_read_b128 a[104:107], v6 offset:22528
v_mfma_f32_16x16x32_bf16 v[156:159], a[120:123], a[44:47], v[156:159]
ds_read_b128 a[108:111], v6 offset:23552
v_mfma_f32_16x16x32_bf16 v[160:163], a[124:127], a[44:47], v[160:163]
buffer_load_dwordx4 a[36:39], v4, s[40:43], s35 offen offset:1024 sc1
v_mfma_f32_16x16x32_bf16 v[144:147], a[124:127], a[40:43], v[144:147]
s_waitcnt vmcnt(10) lgkmcnt(4)
v_mfma_f32_16x16x32_bf16 v[132:135], a[128:131], a[48:51], v[132:135]
s_cmp_eq_u32 s3, 2
s_cselect_b32 s35, 2, 26
s_lshl_b32 s35, s35, 12
v_mfma_f32_16x16x32_bf16 v[148:151], a[128:131], a[52:55], v[148:151]
ds_read_b128 a[112:115], v6 offset:24576
v_mfma_f32_16x16x32_bf16 v[152:155], a[132:135], a[52:55], v[152:155]
buffer_load_dwordx4 a[40:43], v4, s[40:43], s35 offen offset:0 sc1
v_mfma_f32_16x16x32_bf16 v[136:139], a[132:135], a[48:51], v[136:139]
ds_read_b128 a[116:119], v6 offset:25600
v_mfma_f32_16x16x32_bf16 v[140:143], a[136:139], a[48:51], v[140:143]
ds_read_b128 a[120:123], v6 offset:26624
v_mfma_f32_16x16x32_bf16 v[156:159], a[136:139], a[52:55], v[156:159]
ds_read_b128 a[124:127], v6 offset:27648
v_mfma_f32_16x16x32_bf16 v[160:163], a[140:143], a[52:55], v[160:163]
buffer_load_dwordx4 a[44:47], v4, s[40:43], s35 offen offset:1024 sc1
v_mfma_f32_16x16x32_bf16 v[144:147], a[140:143], a[48:51], v[144:147]
s_waitcnt vmcnt(10) lgkmcnt(4)
v_mfma_f32_16x16x32_bf16 v[132:135], a[96:99], a[0:3], v[132:135]
s_cmp_eq_u32 s3, 3
s_cselect_b32 s35, 3, 27
s_lshl_b32 s35, s35, 12
v_mfma_f32_16x16x32_bf16 v[148:151], a[96:99], a[4:7], v[148:151]
ds_read_b128 a[128:131], v6 offset:28672
v_mfma_f32_16x16x32_bf16 v[152:155], a[100:103], a[4:7], v[152:155]
buffer_load_dwordx4 a[48:51], v4, s[40:43], s35 offen offset:0 sc1
v_mfma_f32_16x16x32_bf16 v[136:139], a[100:103], a[0:3], v[136:139]
ds_read_b128 a[132:135], v6 offset:29696
v_mfma_f32_16x16x32_bf16 v[140:143], a[104:107], a[0:3], v[140:143]
ds_read_b128 a[136:139], v6 offset:30720
v_mfma_f32_16x16x32_bf16 v[156:159], a[104:107], a[4:7], v[156:159]
ds_read_b128 a[140:143], v6 offset:31744
v_mfma_f32_16x16x32_bf16 v[160:163], a[108:111], a[4:7], v[160:163]
buffer_load_dwordx4 a[52:55], v4, s[40:43], s35 offen offset:1024 sc1
v_mfma_f32_16x16x32_bf16 v[144:147], a[108:111], a[0:3], v[144:147]
s_waitcnt vmcnt(10) lgkmcnt(4)
v_mfma_f32_16x16x32_bf16 v[132:135], a[112:115], a[8:11], v[132:135]
s_cmp_eq_u32 s3, 4
s_cselect_b32 s35, 4, 28
s_lshl_b32 s35, s35, 12
v_mfma_f32_16x16x32_bf16 v[148:151], a[112:115], a[12:15], v[148:151]
ds_read_b128 a[96:99], v6 offset:32768
v_mfma_f32_16x16x32_bf16 v[152:155], a[116:119], a[12:15], v[152:155]
buffer_load_dwordx4 a[0:3], v4, s[40:43], s35 offen offset:0 sc1
v_mfma_f32_16x16x32_bf16 v[136:139], a[116:119], a[8:11], v[136:139]
ds_read_b128 a[100:103], v6 offset:33792
v_mfma_f32_16x16x32_bf16 v[140:143], a[120:123], a[8:11], v[140:143]
ds_read_b128 a[104:107], v6 offset:34816
v_mfma_f32_16x16x32_bf16 v[156:159], a[120:123], a[12:15], v[156:159]
ds_read_b128 a[108:111], v6 offset:35840
v_mfma_f32_16x16x32_bf16 v[160:163], a[124:127], a[12:15], v[160:163]
buffer_load_dwordx4 a[4:7], v4, s[40:43], s35 offen offset:1024 sc1
v_mfma_f32_16x16x32_bf16 v[144:147], a[124:127], a[8:11], v[144:147]
s_waitcnt vmcnt(10) lgkmcnt(4)
v_mfma_f32_16x16x32_bf16 v[132:135], a[128:131], a[16:19], v[132:135]
s_cmp_eq_u32 s3, 5
s_cselect_b32 s35, 5, 29
s_lshl_b32 s35, s35, 12
v_mfma_f32_16x16x32_bf16 v[148:151], a[128:131], a[20:23], v[148:151]
ds_read_b128 a[112:115], v6 offset:36864
v_mfma_f32_16x16x32_bf16 v[152:155], a[132:135], a[20:23], v[152:155]
buffer_load_dwordx4 a[8:11], v4, s[40:43], s35 offen offset:0 sc1
v_mfma_f32_16x16x32_bf16 v[136:139], a[132:135], a[16:19], v[136:139]
ds_read_b128 a[116:119], v6 offset:37888
v_mfma_f32_16x16x32_bf16 v[140:143], a[136:139], a[16:19], v[140:143]
ds_read_b128 a[120:123], v6 offset:38912
v_mfma_f32_16x16x32_bf16 v[156:159], a[136:139], a[20:23], v[156:159]
ds_read_b128 a[124:127], v6 offset:39936
v_mfma_f32_16x16x32_bf16 v[160:163], a[140:143], a[20:23], v[160:163]
buffer_load_dwordx4 a[12:15], v4, s[40:43], s35 offen offset:1024 sc1
v_mfma_f32_16x16x32_bf16 v[144:147], a[140:143], a[16:19], v[144:147]
s_waitcnt vmcnt(10) lgkmcnt(4)
v_mfma_f32_16x16x32_bf16 v[132:135], a[96:99], a[24:27], v[132:135]
s_cmp_eq_u32 s3, 6
s_cselect_b32 s35, 6, 30
s_lshl_b32 s35, s35, 12
v_mfma_f32_16x16x32_bf16 v[148:151], a[96:99], a[28:31], v[148:151]
ds_read_b128 a[128:131], v6 offset:40960
v_mfma_f32_16x16x32_bf16 v[152:155], a[100:103], a[28:31], v[152:155]
buffer_load_dwordx4 a[16:19], v4, s[40:43], s35 offen offset:0 sc1
v_mfma_f32_16x16x32_bf16 v[136:139], a[100:103], a[24:27], v[136:139]
ds_read_b128 a[132:135], v6 offset:41984
v_mfma_f32_16x16x32_bf16 v[140:143], a[104:107], a[24:27], v[140:143]
ds_read_b128 a[136:139], v6 offset:43008
v_mfma_f32_16x16x32_bf16 v[156:159], a[104:107], a[28:31], v[156:159]
ds_read_b128 a[140:143], v6 offset:44032
v_mfma_f32_16x16x32_bf16 v[160:163], a[108:111], a[28:31], v[160:163]
buffer_load_dwordx4 a[20:23], v4, s[40:43], s35 offen offset:1024 sc1
v_mfma_f32_16x16x32_bf16 v[144:147], a[108:111], a[24:27], v[144:147]
s_waitcnt vmcnt(10) lgkmcnt(4)
v_mfma_f32_16x16x32_bf16 v[132:135], a[112:115], a[32:35], v[132:135]
s_cmp_eq_u32 s3, 7
s_cselect_b32 s35, 7, 31
s_lshl_b32 s35, s35, 12
v_mfma_f32_16x16x32_bf16 v[148:151], a[112:115], a[36:39], v[148:151]
ds_read_b128 a[96:99], v6 offset:45056
v_mfma_f32_16x16x32_bf16 v[152:155], a[116:119], a[36:39], v[152:155]
buffer_load_dwordx4 a[24:27], v4, s[40:43], s35 offen offset:0 sc1
v_mfma_f32_16x16x32_bf16 v[136:139], a[116:119], a[32:35], v[136:139]
ds_read_b128 a[100:103], v6 offset:46080
v_mfma_f32_16x16x32_bf16 v[140:143], a[120:123], a[32:35], v[140:143]
ds_read_b128 a[104:107], v6 offset:47104
v_mfma_f32_16x16x32_bf16 v[156:159], a[120:123], a[36:39], v[156:159]
ds_read_b128 a[108:111], v6 offset:48128
v_mfma_f32_16x16x32_bf16 v[160:163], a[124:127], a[36:39], v[160:163]
buffer_load_dwordx4 a[28:31], v4, s[40:43], s35 offen offset:1024 sc1
v_mfma_f32_16x16x32_bf16 v[144:147], a[124:127], a[32:35], v[144:147]
s_waitcnt vmcnt(10) lgkmcnt(4)
v_mfma_f32_16x16x32_bf16 v[132:135], a[128:131], a[40:43], v[132:135]
s_add_u32 m0, s18, 0x0
s_add_u32 s44, s50, 0xe00000
v_mfma_f32_16x16x32_bf16 v[148:151], a[128:131], a[44:47], v[148:151]
ds_read_b128 a[112:115], v6 offset:49152
v_mfma_f32_16x16x32_bf16 v[152:155], a[132:135], a[44:47], v[152:155]
buffer_load_dwordx4 v1, s[4:7], s44 offen offset:0 sc1 lds
v_mfma_f32_16x16x32_bf16 v[136:139], a[132:135], a[40:43], v[136:139]
ds_read_b128 a[116:119], v6 offset:50176
v_mfma_f32_16x16x32_bf16 v[140:143], a[136:139], a[40:43], v[140:143]
ds_read_b128 a[120:123], v6 offset:51200
v_mfma_f32_16x16x32_bf16 v[156:159], a[136:139], a[44:47], v[156:159]
ds_read_b128 a[124:127], v6 offset:52224
v_mfma_f32_16x16x32_bf16 v[160:163], a[140:143], a[44:47], v[160:163]
buffer_load_dwordx4 v1, s[4:7], s44 offen offset:1024 sc1 lds
v_mfma_f32_16x16x32_bf16 v[144:147], a[140:143], a[40:43], v[144:147]
s_waitcnt vmcnt(10) lgkmcnt(4)
v_mfma_f32_16x16x32_bf16 v[132:135], a[96:99], a[48:51], v[132:135]
ds_read_b128 a[128:131], v6 offset:53248
v_mfma_f32_16x16x32_bf16 v[148:151], a[96:99], a[52:55], v[148:151]
ds_read_b128 a[132:135], v6 offset:54272
v_mfma_f32_16x16x32_bf16 v[152:155], a[100:103], a[52:55], v[152:155]
ds_read_b128 a[136:139], v6 offset:55296
v_mfma_f32_16x16x32_bf16 v[136:139], a[100:103], a[48:51], v[136:139]
ds_read_b128 a[140:143], v6 offset:56320
v_mfma_f32_16x16x32_bf16 v[140:143], a[104:107], a[48:51], v[140:143]
buffer_load_dwordx4 v1, s[4:7], s44 offen offset:2048 sc1 lds
s_add_u32 m0, s18, 0x3000
v_mfma_f32_16x16x32_bf16 v[156:159], a[104:107], a[52:55], v[156:159]
s_add_u32 s44, s50, 0xe03000
v_mfma_f32_16x16x32_bf16 v[160:163], a[108:111], a[52:55], v[160:163]
v_mfma_f32_16x16x32_bf16 v[144:147], a[108:111], a[48:51], v[144:147]
s_waitcnt vmcnt(9) lgkmcnt(4)
v_mfma_f32_16x16x32_bf16 v[132:135], a[112:115], a[0:3], v[132:135]
ds_read_b128 a[96:99], v6 offset:57344
v_mfma_f32_16x16x32_bf16 v[148:151], a[112:115], a[4:7], v[148:151]
ds_read_b128 a[100:103], v6 offset:58368
v_mfma_f32_16x16x32_bf16 v[152:155], a[116:119], a[4:7], v[152:155]
ds_read_b128 a[104:107], v6 offset:59392
v_mfma_f32_16x16x32_bf16 v[136:139], a[116:119], a[0:3], v[136:139]
buffer_load_dwordx4 v1, s[4:7], s44 offen offset:0 sc1 lds
v_mfma_f32_16x16x32_bf16 v[140:143], a[120:123], a[0:3], v[140:143]
ds_read_b128 a[108:111], v6 offset:60416
v_mfma_f32_16x16x32_bf16 v[156:159], a[120:123], a[4:7], v[156:159]
v_mfma_f32_16x16x32_bf16 v[160:163], a[124:127], a[4:7], v[160:163]
v_mfma_f32_16x16x32_bf16 v[144:147], a[124:127], a[0:3], v[144:147]
s_waitcnt vmcnt(8) lgkmcnt(4)
v_mfma_f32_16x16x32_bf16 v[132:135], a[128:131], a[8:11], v[132:135]
ds_read_b128 a[112:115], v6 offset:61440
v_mfma_f32_16x16x32_bf16 v[148:151], a[128:131], a[12:15], v[148:151]
buffer_load_dwordx4 v1, s[4:7], s44 offen offset:1024 sc1 lds
v_mfma_f32_16x16x32_bf16 v[152:155], a[132:135], a[12:15], v[152:155]
ds_read_b128 a[116:119], v6 offset:62464
v_mfma_f32_16x16x32_bf16 v[136:139], a[132:135], a[8:11], v[136:139]
ds_read_b128 a[120:123], v6 offset:63488
v_mfma_f32_16x16x32_bf16 v[140:143], a[136:139], a[8:11], v[140:143]
ds_read_b128 a[124:127], v6 offset:64512
v_mfma_f32_16x16x32_bf16 v[156:159], a[136:139], a[12:15], v[156:159]
v_mfma_f32_16x16x32_bf16 v[160:163], a[140:143], a[12:15], v[160:163]
v_mfma_f32_16x16x32_bf16 v[144:147], a[140:143], a[8:11], v[144:147]
buffer_load_dwordx4 v1, s[4:7], s44 offen offset:2048 sc1 lds
s_waitcnt vmcnt(8) lgkmcnt(4)
v_mfma_f32_16x16x32_bf16 v[132:135], a[96:99], a[16:19], v[132:135]
v_mfma_f32_16x16x32_bf16 v[148:151], a[96:99], a[20:23], v[148:151]
v_mfma_f32_16x16x32_bf16 v[152:155], a[100:103], a[20:23], v[152:155]
v_mfma_f32_16x16x32_bf16 v[136:139], a[100:103], a[16:19], v[136:139]
v_mfma_f32_16x16x32_bf16 v[140:143], a[104:107], a[16:19], v[140:143]
v_mfma_f32_16x16x32_bf16 v[156:159], a[104:107], a[20:23], v[156:159]
v_mfma_f32_16x16x32_bf16 v[160:163], a[108:111], a[20:23], v[160:163]
v_mfma_f32_16x16x32_bf16 v[144:147], a[108:111], a[16:19], v[144:147]
s_waitcnt vmcnt(6) lgkmcnt(0)
v_mfma_f32_16x16x32_bf16 v[132:135], a[112:115], a[24:27], v[132:135]
v_mfma_f32_16x16x32_bf16 v[148:151], a[112:115], a[28:31], v[148:151]
v_mfma_f32_16x16x32_bf16 v[152:155], a[116:119], a[28:31], v[152:155]
buffer_atomic_add v12, v10, s[4:7], s92 offen sc1
v_mfma_f32_16x16x32_bf16 v[136:139], a[116:119], a[24:27], v[136:139]
v_mfma_f32_16x16x32_bf16 v[140:143], a[120:123], a[24:27], v[140:143]
v_mfma_f32_16x16x32_bf16 v[156:159], a[120:123], a[28:31], v[156:159]
v_mfma_f32_16x16x32_bf16 v[160:163], a[124:127], a[28:31], v[160:163]
v_mfma_f32_16x16x32_bf16 v[144:147], a[124:127], a[24:27], v[144:147]
s_nop 0
v_cmp_u_f32 vcc, v132, v148
s_nop 0
s_and_b32 vcc_lo, vcc_lo, s95
s_cbranch_scc1 L_k2redo1
s_lshl_b32 s36, s32, 13
v_cvt_pk_bf16_f32 v32, v132, v133
v_cvt_pk_bf16_f32 v33, v134, v135
v_cvt_pk_bf16_f32 v34, v136, v137
v_cvt_pk_bf16_f32 v35, v138, v139
s_add_u32 s36, s36, 0x0
buffer_store_dwordx4 v[32:35], v4, s[12:15], s36 offen offset:0 sc1
v_cvt_pk_bf16_f32 v40, v148, v149
v_cvt_pk_bf16_f32 v41, v150, v151
v_cvt_pk_bf16_f32 v42, v152, v153
v_cvt_pk_bf16_f32 v43, v154, v155
v_cvt_pk_bf16_f32 v36, v140, v141
v_cvt_pk_bf16_f32 v37, v142, v143
v_cvt_pk_bf16_f32 v38, v144, v145
v_cvt_pk_bf16_f32 v39, v146, v147
s_add_u32 s37, s36, 4096
v_cvt_pk_bf16_f32 v44, v156, v157
v_cvt_pk_bf16_f32 v45, v158, v159
v_cvt_pk_bf16_f32 v46, v160, v161
buffer_store_dwordx4 v[40:43], v4, s[12:15], s36 offen offset:1024 sc1
v_cvt_pk_bf16_f32 v47, v162, v163
v_mfma_f32_16x16x32_bf16 v[96:99], v[32:35], v[32:35], 0
s_mov_b32 s38, 0x280000
s_add_u32 s92, s78, 0x50000
v_mfma_f32_16x16x32_bf16 v[92:95], v[16:19], v[32:35], 0
s_add_u32 s93, s79, 0x50000
s_mov_b64 s[40:41], s[12:13]
v_mfma_f32_16x16x32_bf16 v[96:99], v[36:39], v[36:39], v[96:99]
buffer_store_dwordx4 v[36:39], v4, s[12:15], s37 offen offset:0 sc1
v_mfma_f32_16x16x32_bf16 v[92:95], v[16:19], v[36:39], v[92:95]
s_nop 5
v_cndmask_b32 v96, v96, v97, s[46:47]
v_cndmask_b32 v98, v98, v99, s[46:47]
v_mfma_f32_16x16x32_bf16 v[104:107], v[40:43], v[40:43], 0
v_mfma_f32_16x16x32_bf16 v[100:103], v[16:19], v[40:43], 0
v_cndmask_b32 v93, v96, v98, s[48:49]
buffer_store_dwordx4 v[44:47], v4, s[12:15], s37 offen offset:1024 sc1
v_mfma_f32_16x16x32_bf16 v[104:107], v[44:47], v[44:47], v[104:107]
v_mfma_f32_16x16x32_bf16 v[100:103], v[16:19], v[44:47], v[100:103]
s_nop 6
v_cndmask_b32 v104, v104, v105, s[46:47]
v_cndmask_b32 v106, v106, v107, s[46:47]
buffer_store_dwordx2 v[92:93], v253, s[4:7], s38 offen offset:0 sc1
v_cndmask_b32 v101, v104, v106, s[48:49]
buffer_store_dwordx2 v[100:101], v253, s[4:7], s38 offen offset:2048 sc1
s_barrier
s_add_u32 m0, s18, 0x6000
s_add_u32 s44, s50, 0xe06000
buffer_load_dwordx4 v1, s[4:7], s44 offen offset:0 sc1 lds
buffer_load_dwordx4 v1, s[4:7], s44 offen offset:1024 sc1 lds
buffer_load_dwordx4 v1, s[4:7], s44 offen offset:2048 sc1 lds
s_add_u32 m0, s18, 0x9000
s_add_u32 s44, s50, 0xe09000
buffer_load_dwordx4 v1, s[4:7], s44 offen offset:0 sc1 lds
buffer_load_dwordx4 v1, s[4:7], s44 offen offset:1024 sc1 lds
buffer_load_dwordx4 v1, s[4:7], s44 offen offset:2048 sc1 lds
v_accvgpr_read_b32 v48, a188
v_accvgpr_read_b32 v49, a189
v_accvgpr_read_b32 v50, a190
v_accvgpr_read_b32 v51, a191
v_accvgpr_read_b32 v52, a192
v_accvgpr_read_b32 v53, a193
v_accvgpr_read_b32 v54, a194
v_accvgpr_read_b32 v55, a195
v_accvgpr_read_b32 v56, a196
v_accvgpr_read_b32 v57, a197
v_accvgpr_read_b32 v58, a198
v_accvgpr_read_b32 v59, a199
v_accvgpr_read_b32 v60, a200
v_accvgpr_read_b32 v61, a201
v_accvgpr_read_b32 v62, a202
v_accvgpr_read_b32 v63, a203
v_accvgpr_read_b32 v64, a204
v_accvgpr_read_b32 v65, a205
v_accvgpr_read_b32 v66, a206
v_accvgpr_read_b32 v67, a207
v_accvgpr_read_b32 v68, a208
v_accvgpr_read_b32 v69, a209
v_accvgpr_read_b32 v70, a210
v_accvgpr_read_b32 v71, a211
s_waitcnt vmcnt(6)
s_barrier
s_cmp_lg_u32 s28, 0
s_cbranch_scc1 Lsg_26
buffer_atomic_add v12, v10, s[4:7], s92 offen sc1
Lsg_26:
s_mov_b64 exec, 0
s_cmp_eq_u32 s28, 0
s_cbranch_scc1 L_stub10
L_wret4:
s_mov_b64 exec, -1
s_cmp_lt_u32 s28, 2
s_cbranch_scc1 Lwd_27
s_add_u32 m0, s18, 0xa800
s_add_u32 s44, s50, 0xe0a800
buffer_load_dwordx4 v1, s[4:7], s44 offen offset:0 sc1 lds
buffer_load_dwordx4 v1, s[4:7], s44 offen offset:1024 sc1 lds
buffer_load_dwordx4 v1, s[4:7], s44 offen offset:2048 sc1 lds
s_add_u32 m0, s18, 0xc000
s_add_u32 s44, s50, 0xe0c000
buffer_load_dwordx4 v1, s[4:7], s44 offen offset:0 sc1 lds
buffer_load_dwordx4 v1, s[4:7], s44 offen offset:1024 sc1 lds
buffer_load_dwordx4 v1, s[4:7], s44 offen offset:2048 sc1 lds
s_add_u32 m0, s18, 0xd800
s_add_u32 s44, s50, 0xe0d800
buffer_load_dwordx4 v1, s[4:7], s44 offen offset:0 sc1 lds
buffer_load_dwordx4 v1, s[4:7], s44 offen offset:1024 sc1 lds
buffer_load_dwordx4 v1, s[4:7], s44 offen offset:2048 sc1 lds
s_add_u32 m0, s18, 0xf000
s_add_u32 s44, s50, 0xe0f000
buffer_load_dwordx4 v1, s[4:7], s44 offen offset:0 sc1 lds
buffer_load_dwordx4 v1, s[4:7], s44 offen offset:1024 sc1 lds
buffer_load_dwordx4 v1, s[4:7], s44 offen offset:2048 sc1 lds
s_add_u32 m0, s18, 0x10800
s_add_u32 s44, s50, 0xe10800
buffer_load_dwordx4 v1, s[4:7], s44 offen offset:0 sc1 lds
buffer_load_dwordx4 v1, s[4:7], s44 offen offset:1024 sc1 lds
buffer_load_dwordx4 v1, s[4:7], s44 offen offset:2048 sc1 lds
s_add_u32 m0, s18, 0x12000
s_add_u32 s44, s50, 0xe12000
buffer_load_dwordx4 v1, s[4:7], s44 offen offset:0 sc1 lds
buffer_load_dwordx4 v1, s[4:7], s44 offen offset:1024 sc1 lds
buffer_load_dwordx4 v1, s[4:7], s44 offen offset:2048 sc1 lds
s_add_u32 m0, s18, 0x13800
s_add_u32 s44, s50, 0xe13800
buffer_load_dwordx4 v1, s[4:7], s44 offen offset:0 sc1 lds
buffer_load_dwordx4 v1, s[4:7], s44 offen offset:1024 sc1 lds
buffer_load_dwordx4 v1, s[4:7], s44 offen offset:2048 sc1 lds
s_add_u32 m0, s18, 0x15000
s_add_u32 s44, s50, 0xe15000
buffer_load_dwordx4 v1, s[4:7], s44 offen offset:0 sc1 lds
buffer_load_dwordx4 v1, s[4:7], s44 offen offset:1024 sc1 lds
buffer_load_dwordx4 v1, s[4:7], s44 offen offset:2048 sc1 lds
s_add_u32 m0, s18, 0x16800
s_add_u32 s44, s50, 0xe16800
buffer_load_dwordx4 v1, s[4:7], s44 offen offset:0 sc1 lds
buffer_load_dwordx4 v1, s[4:7], s44 offen offset:1024 sc1 lds
buffer_load_dwordx4 v1, s[4:7], s44 offen offset:2048 sc1 lds
s_add_u32 m0, s18, 0x18000
s_add_u32 s44, s50, 0xe18000
buffer_load_dwordx4 v1, s[4:7], s44 offen offset:0 sc1 lds
buffer_load_dwordx4 v1, s[4:7], s44 offen offset:1024 sc1 lds
buffer_load_dwordx4 v1, s[4:7], s44 offen offset:2048 sc1 lds
s_add_u32 m0, s18, 0x19800
s_add_u32 s44, s50, 0xe19800
buffer_load_dwordx4 v1, s[4:7], s44 offen offset:0 sc1 lds
buffer_load_dwordx4 v1, s[4:7], s44 offen offset:1024 sc1 lds
buffer_load_dwordx4 v1, s[4:7], s44 offen offset:2048 sc1 lds
s_add_u32 m0, s18, 0x1b000
s_add_u32 s44, s50, 0xe1b000
buffer_load_dwordx4 v1, s[4:7], s44 offen offset:0 sc1 lds
buffer_load_dwordx4 v1, s[4:7], s44 offen offset:1024 sc1 lds
buffer_load_dwordx4 v1, s[4:7], s44 offen offset:2048 sc1 lds
Lwd_27:
s_cmp_lg_u32 s28, 1
s_cbranch_scc1 Lpo_30
s_add_u32 s36, s67, 0x50000
s_mov_b32 s37, 0
v_mov_b32 v11, 0
buffer_atomic_add v11, v251, s[4:7], s36 offen sc0 sc1
s_sleep 4
Lpoll_28:
v_mov_b32 v234, 0
buffer_atomic_add v234, v251, s[4:7], s36 offen sc0 sc1
s_waitcnt vmcnt(1)
v_readfirstlane_b32 s38, v11
s_nop 0
s_cmp_ge_u32 s38, 32
s_cbranch_scc1 Lpe_29
v_mov_b32 v11, 0
buffer_atomic_add v11, v251, s[4:7], s36 offen sc0 sc1
s_waitcnt vmcnt(1)
v_readfirstlane_b32 s38, v234
s_nop 0
s_cmp_ge_u32 s38, 32
s_cbranch_scc1 Lpe_29
s_add_u32 s37, s37, 1
s_cmp_lt_u32 s37, 0x80000
s_cbranch_scc1 Lpoll_28
s_waitcnt vmcnt(0)
Lpo_30:
s_waitcnt vmcnt(36) lgkmcnt(0)
s_cmp_ge_u32 s28, 2
s_cbranch_scc1 Lw_31
s_waitcnt vmcnt(0)
Lw_31:
Lpe_29:
s_barrier
s_add_u32 s94, s71, 0x20080
s_add_u32 s9, s66, 0x20080
s_mov_b32 s35, 0
s_mov_b32 s33, 0x1000
buffer_load_dwordx4 a[0:3], v2, s[40:43], s35 offen offset:0 sc1
buffer_load_dwordx4 a[4:7], v2, s[40:43], s33 offen offset:0 sc1
buffer_load_dwordx4 a[8:11], v2, s[40:43], s35 offen offset:1024 sc1
buffer_load_dwordx4 a[12:15], v2, s[40:43], s33 offen offset:1024 sc1
buffer_load_dwordx4 a[16:19], v2, s[40:43], s35 offen offset:2048 sc1
buffer_load_dwordx4 a[20:23], v2, s[40:43], s33 offen offset:2048 sc1
buffer_load_dwordx4 a[24:27], v2, s[40:43], s35 offen offset:3072 sc1
buffer_load_dwordx4 a[28:31], v2, s[40:43], s33 offen offset:3072 sc1
s_add_u32 s35, s35, 8192
s_add_u32 s33, s33, 8192
buffer_load_dwordx4 a[32:35], v2, s[40:43], s35 offen offset:0 sc1
buffer_load_dwordx4 a[36:39], v2, s[40:43], s33 offen offset:0 sc1
buffer_load_dwordx4 a[40:43], v2, s[40:43], s35 offen offset:1024 sc1
buffer_load_dwordx4 a[44:47], v2, s[40:43], s33 offen offset:1024 sc1
buffer_load_dwordx4 a[48:51], v2, s[40:43], s35 offen offset:2048 sc1
buffer_load_dwordx4 a[52:55], v2, s[40:43], s33 offen offset:2048 sc1
buffer_load_dwordx4 a[56:59], v2, s[40:43], s35 offen offset:3072 sc1
buffer_load_dwordx4 a[60:63], v2, s[40:43], s33 offen offset:3072 sc1
s_add_u32 s35, s35, 8192
s_add_u32 s33, s33, 8192
v_add_u32 v5, 0, v1
ds_read_b128 a[96:99], v5 offset:2048
ds_read_b128 a[100:103], v5 offset:8192
ds_read_b128 a[104:107], v5 offset:3072
ds_read_b128 a[108:111], v5 offset:9216
ds_read_b128 a[112:115], v5 offset:4096
ds_read_b128 a[116:119], v5 offset:10240
s_waitcnt vmcnt(14) lgkmcnt(4)
v_mfma_f32_16x16x32_bf16 v[140:143], a[96:99], a[0:3], 0
s_add_u32 m0, s18, 0x1e000
s_add_u32 s44, s50, 0xe1e000
v_mfma_f32_16x16x32_bf16 v[140:143], a[100:103], a[4:7], v[140:143]
buffer_load_dwordx4 a[64:67], v2, s[40:43], s35 offen offset:0 sc1
s_waitcnt vmcnt(13)
v_mfma_f32_16x16x32_bf16 v[164:167], a[100:103], a[12:15], 0
ds_read_b128 a[128:131], v5 offset:5120
v_mfma_f32_16x16x32_bf16 v[164:167], a[96:99], a[8:11], v[164:167]
ds_read_b128 a[132:135], v5 offset:11264
s_waitcnt vmcnt(12)
v_mfma_f32_16x16x32_bf16 v[188:191], a[96:99], a[16:19], 0
s_waitcnt vmcnt(11)
v_mfma_f32_16x16x32_bf16 v[188:191], a[100:103], a[20:23], v[188:191]
buffer_load_dwordx4 a[68:71], v2, s[40:43], s33 offen offset:0 sc1
s_waitcnt vmcnt(10)
v_mfma_f32_16x16x32_bf16 v[212:215], a[100:103], a[28:31], 0
ds_read_b128 a[136:139], v5 offset:0
v_mfma_f32_16x16x32_bf16 v[212:215], a[96:99], a[24:27], v[212:215]
s_waitcnt lgkmcnt(6)
v_mfma_f32_16x16x32_bf16 v[216:219], a[104:107], a[24:27], 0
ds_read_b128 a[140:143], v5 offset:6144
s_waitcnt lgkmcnt(6)
v_mfma_f32_16x16x32_bf16 v[216:219], a[108:111], a[28:31], v[216:219]
v_mfma_f32_16x16x32_bf16 v[192:195], a[108:111], a[20:23], 0
buffer_load_dwordx4 v1, s[4:7], s44 offen offset:0 sc1 lds
v_mfma_f32_16x16x32_bf16 v[192:195], a[104:107], a[16:19], v[192:195]
ds_read_b128 a[144:147], v5 offset:1024
v_mfma_f32_16x16x32_bf16 v[168:171], a[104:107], a[8:11], 0
v_mfma_f32_16x16x32_bf16 v[168:171], a[108:111], a[12:15], v[168:171]
ds_read_b128 a[148:151], v5 offset:7168
v_mfma_f32_16x16x32_bf16 v[144:147], a[108:111], a[4:7], 0
v_mfma_f32_16x16x32_bf16 v[144:147], a[104:107], a[0:3], v[144:147]
buffer_load_dwordx4 a[72:75], v2, s[40:43], s35 offen offset:1024 sc1
s_waitcnt lgkmcnt(7)
v_mfma_f32_16x16x32_bf16 v[148:151], a[112:115], a[0:3], 0
s_waitcnt lgkmcnt(6)
v_mfma_f32_16x16x32_bf16 v[148:151], a[116:119], a[4:7], v[148:151]
v_mfma_f32_16x16x32_bf16 v[172:175], a[116:119], a[12:15], 0
v_mfma_f32_16x16x32_bf16 v[172:175], a[112:115], a[8:11], v[172:175]
v_mfma_f32_16x16x32_bf16 v[196:199], a[112:115], a[16:19], 0
buffer_load_dwordx4 a[76:79], v2, s[40:43], s33 offen offset:1024 sc1
v_mfma_f32_16x16x32_bf16 v[196:199], a[116:119], a[20:23], v[196:199]
v_mfma_f32_16x16x32_bf16 v[220:223], a[116:119], a[28:31], 0
v_mfma_f32_16x16x32_bf16 v[220:223], a[112:115], a[24:27], v[220:223]
s_waitcnt lgkmcnt(0)
v_mfma_f32_16x16x32_bf16 v[224:227], a[128:131], a[24:27], 0
ds_read_b128 a[96:99], v5 offset:14336
v_mfma_f32_16x16x32_bf16 v[224:227], a[132:135], a[28:31], v[224:227]
buffer_load_dwordx4 a[80:83], v2, s[40:43], s35 offen offset:2048 sc1
v_mfma_f32_16x16x32_bf16 v[200:203], a[132:135], a[20:23], 0
ds_read_b128 a[100:103], v5 offset:20480
v_mfma_f32_16x16x32_bf16 v[200:203], a[128:131], a[16:19], v[200:203]
v_mfma_f32_16x16x32_bf16 v[176:179], a[128:131], a[8:11], 0
v_mfma_f32_16x16x32_bf16 v[176:179], a[132:135], a[12:15], v[176:179]
buffer_load_dwordx4 a[84:87], v2, s[40:43], s33 offen offset:2048 sc1
v_mfma_f32_16x16x32_bf16 v[152:155], a[132:135], a[4:7], 0
ds_read_b128 a[104:107], v5 offset:15360
v_mfma_f32_16x16x32_bf16 v[152:155], a[128:131], a[0:3], v[152:155]
v_mfma_f32_16x16x32_bf16 v[132:135], a[136:139], a[0:3], 0
ds_read_b128 a[108:111], v5 offset:21504
v_mfma_f32_16x16x32_bf16 v[132:135], a[140:143], a[4:7], v[132:135]
v_mfma_f32_16x16x32_bf16 v[156:159], a[140:143], a[12:15], 0
buffer_load_dwordx4 v1, s[4:7], s44 offen offset:1024 sc1 lds
v_mfma_f32_16x16x32_bf16 v[156:159], a[136:139], a[8:11], v[156:159]
ds_read_b128 a[112:115], v5 offset:16384
v_mfma_f32_16x16x32_bf16 v[180:183], a[136:139], a[16:19], 0
v_mfma_f32_16x16x32_bf16 v[180:183], a[140:143], a[20:23], v[180:183]
ds_read_b128 a[116:119], v5 offset:22528
v_mfma_f32_16x16x32_bf16 v[204:207], a[140:143], a[28:31], 0
v_mfma_f32_16x16x32_bf16 v[204:207], a[136:139], a[24:27], v[204:207]
buffer_load_dwordx4 a[88:91], v2, s[40:43], s35 offen offset:3072 sc1
v_mfma_f32_16x16x32_bf16 v[208:211], a[144:147], a[24:27], 0
v_mfma_f32_16x16x32_bf16 v[208:211], a[148:151], a[28:31], v[208:211]
v_mfma_f32_16x16x32_bf16 v[184:187], a[148:151], a[20:23], 0
v_mfma_f32_16x16x32_bf16 v[184:187], a[144:147], a[16:19], v[184:187]
v_mfma_f32_16x16x32_bf16 v[160:163], a[144:147], a[8:11], 0
buffer_load_dwordx4 a[92:95], v2, s[40:43], s33 offen offset:3072 sc1
s_add_u32 s35, s35, 8192
v_mfma_f32_16x16x32_bf16 v[160:163], a[148:151], a[12:15], v[160:163]
s_add_u32 s33, s33, 8192
v_mfma_f32_16x16x32_bf16 v[136:139], a[148:151], a[4:7], 0
L_stub10:
s_cbranch_execz L_stub11
v_mfma_f32_16x16x32_bf16 v[136:139], a[144:147], a[0:3], v[136:139]
s_waitcnt vmcnt(10) lgkmcnt(0)
v_mfma_f32_16x16x32_bf16 v[140:143], a[96:99], a[32:35], v[140:143]
ds_read_b128 a[128:131], v5 offset:17408
v_mfma_f32_16x16x32_bf16 v[140:143], a[100:103], a[36:39], v[140:143]
buffer_load_dwordx4 a[0:3], v2, s[40:43], s35 offen offset:0 sc1
v_mfma_f32_16x16x32_bf16 v[164:167], a[100:103], a[44:47], v[164:167]
ds_read_b128 a[132:135], v5 offset:23552
v_mfma_f32_16x16x32_bf16 v[164:167], a[96:99], a[40:43], v[164:167]
v_mfma_f32_16x16x32_bf16 v[188:191], a[96:99], a[48:51], v[188:191]
v_mfma_f32_16x16x32_bf16 v[188:191], a[100:103], a[52:55], v[188:191]
buffer_load_dwordx4 a[4:7], v2, s[40:43], s33 offen offset:0 sc1
v_mfma_f32_16x16x32_bf16 v[212:215], a[100:103], a[60:63], v[212:215]
ds_read_b128 a[136:139], v5 offset:12288
v_mfma_f32_16x16x32_bf16 v[212:215], a[96:99], a[56:59], v[212:215]
v_mfma_f32_16x16x32_bf16 v[216:219], a[104:107], a[56:59], v[216:219]
ds_read_b128 a[140:143], v5 offset:18432
v_mfma_f32_16x16x32_bf16 v[216:219], a[108:111], a[60:63], v[216:219]
v_mfma_f32_16x16x32_bf16 v[192:195], a[108:111], a[52:55], v[192:195]
buffer_load_dwordx4 v1, s[4:7], s44 offen offset:2048 sc1 lds
s_add_u32 m0, s18, 0x21000
v_mfma_f32_16x16x32_bf16 v[192:195], a[104:107], a[48:51], v[192:195]
s_add_u32 s44, s50, 0xe21000
ds_read_b128 a[144:147], v5 offset:13312
v_mfma_f32_16x16x32_bf16 v[168:171], a[104:107], a[40:43], v[168:171]
v_mfma_f32_16x16x32_bf16 v[168:171], a[108:111], a[44:47], v[168:171]
ds_read_b128 a[148:151], v5 offset:19456
v_mfma_f32_16x16x32_bf16 v[144:147], a[108:111], a[36:39], v[144:147]
v_mfma_f32_16x16x32_bf16 v[144:147], a[104:107], a[32:35], v[144:147]
buffer_load_dwordx4 a[8:11], v2, s[40:43], s35 offen offset:1024 sc1
v_mfma_f32_16x16x32_bf16 v[148:151], a[112:115], a[32:35], v[148:151]
v_mfma_f32_16x16x32_bf16 v[148:151], a[116:119], a[36:39], v[148:151]
v_mfma_f32_16x16x32_bf16 v[172:175], a[116:119], a[44:47], v[172:175]
v_mfma_f32_16x16x32_bf16 v[172:175], a[112:115], a[40:43], v[172:175]
v_mfma_f32_16x16x32_bf16 v[196:199], a[112:115], a[48:51], v[196:199]
buffer_load_dwordx4 a[12:15], v2, s[40:43], s33 offen offset:1024 sc1
v_mfma_f32_16x16x32_bf16 v[196:199], a[116:119], a[52:55], v[196:199]
v_mfma_f32_16x16x32_bf16 v[220:223], a[116:119], a[60:63], v[220:223]
v_mfma_f32_16x16x32_bf16 v[220:223], a[112:115], a[56:59], v[220:223]
s_waitcnt lgkmcnt(0)
v_mfma_f32_16x16x32_bf16 v[224:227], a[128:131], a[56:59], v[224:227]
ds_read_b128 a[96:99], v5 offset:26624
v_mfma_f32_16x16x32_bf16 v[224:227], a[132:135], a[60:63], v[224:227]
buffer_load_dwordx4 a[16:19], v2, s[40:43], s35 offen offset:2048 sc1
v_mfma_f32_16x16x32_bf16 v[200:203], a[132:135], a[52:55], v[200:203]
ds_read_b128 a[100:103], v5 offset:32768
v_mfma_f32_16x16x32_bf16 v[200:203], a[128:131], a[48:51], v[200:203]
v_mfma_f32_16x16x32_bf16 v[176:179], a[128:131], a[40:43], v[176:179]
v_mfma_f32_16x16x32_bf16 v[176:179], a[132:135], a[44:47], v[176:179]
buffer_load_dwordx4 a[20:23], v2, s[40:43], s33 offen offset:2048 sc1
v_mfma_f32_16x16x32_bf16 v[152:155], a[132:135], a[36:39], v[152:155]
ds_read_b128 a[104:107], v5 offset:27648
v_mfma_f32_16x16x32_bf16 v[152:155], a[128:131], a[32:35], v[152:155]
v_mfma_f32_16x16x32_bf16 v[132:135], a[136:139], a[32:35], v[132:135]
ds_read_b128 a[108:111], v5 offset:33792
v_mfma_f32_16x16x32_bf16 v[132:135], a[140:143], a[36:39], v[132:135]
v_mfma_f32_16x16x32_bf16 v[156:159], a[140:143], a[44:47], v[156:159]
buffer_load_dwordx4 v1, s[4:7], s44 offen offset:0 sc1 lds
v_mfma_f32_16x16x32_bf16 v[156:159], a[136:139], a[40:43], v[156:159]
ds_read_b128 a[112:115], v5 offset:28672
v_mfma_f32_16x16x32_bf16 v[180:183], a[136:139], a[48:51], v[180:183]
v_mfma_f32_16x16x32_bf16 v[180:183], a[140:143], a[52:55], v[180:183]
ds_read_b128 a[116:119], v5 offset:34816
v_mfma_f32_16x16x32_bf16 v[204:207], a[140:143], a[60:63], v[204:207]
v_mfma_f32_16x16x32_bf16 v[204:207], a[136:139], a[56:59], v[204:207]
buffer_load_dwordx4 a[24:27], v2, s[40:43], s35 offen offset:3072 sc1
v_mfma_f32_16x16x32_bf16 v[208:211], a[144:147], a[56:59], v[208:211]
v_mfma_f32_16x16x32_bf16 v[208:211], a[148:151], a[60:63], v[208:211]
v_mfma_f32_16x16x32_bf16 v[184:187], a[148:151], a[52:55], v[184:187]
v_mfma_f32_16x16x32_bf16 v[184:187], a[144:147], a[48:51], v[184:187]
v_mfma_f32_16x16x32_bf16 v[160:163], a[144:147], a[40:43], v[160:163]
buffer_load_dwordx4 a[28:31], v2, s[40:43], s33 offen offset:3072 sc1
s_add_u32 s35, s35, 8192
v_mfma_f32_16x16x32_bf16 v[160:163], a[148:151], a[44:47], v[160:163]
s_add_u32 s33, s33, 8192
v_mfma_f32_16x16x32_bf16 v[136:139], a[148:151], a[36:39], v[136:139]
v_mfma_f32_16x16x32_bf16 v[136:139], a[144:147], a[32:35], v[136:139]
s_waitcnt vmcnt(10) lgkmcnt(0)
v_mfma_f32_16x16x32_bf16 v[140:143], a[96:99], a[64:67], v[140:143]
ds_read_b128 a[128:131], v5 offset:29696
v_mfma_f32_16x16x32_bf16 v[140:143], a[100:103], a[68:71], v[140:143]
buffer_load_dwordx4 a[32:35], v2, s[40:43], s35 offen offset:0 sc1
v_mfma_f32_16x16x32_bf16 v[164:167], a[100:103], a[76:79], v[164:167]
ds_read_b128 a[132:135], v5 offset:35840
v_mfma_f32_16x16x32_bf16 v[164:167], a[96:99], a[72:75], v[164:167]
v_mfma_f32_16x16x32_bf16 v[188:191], a[96:99], a[80:83], v[188:191]
v_mfma_f32_16x16x32_bf16 v[188:191], a[100:103], a[84:87], v[188:191]
buffer_load_dwordx4 a[36:39], v2, s[40:43], s33 offen offset:0 sc1
v_mfma_f32_16x16x32_bf16 v[212:215], a[100:103], a[92:95], v[212:215]
ds_read_b128 a[136:139], v5 offset:24576
v_mfma_f32_16x16x32_bf16 v[212:215], a[96:99], a[88:91], v[212:215]
v_mfma_f32_16x16x32_bf16 v[216:219], a[104:107], a[88:91], v[216:219]
ds_read_b128 a[140:143], v5 offset:30720
v_mfma_f32_16x16x32_bf16 v[216:219], a[108:111], a[92:95], v[216:219]
v_mfma_f32_16x16x32_bf16 v[192:195], a[108:111], a[84:87], v[192:195]
buffer_load_dwordx4 v1, s[4:7], s44 offen offset:1024 sc1 lds
v_mfma_f32_16x16x32_bf16 v[192:195], a[104:107], a[80:83], v[192:195]
ds_read_b128 a[144:147], v5 offset:25600
v_mfma_f32_16x16x32_bf16 v[168:171], a[104:107], a[72:75], v[168:171]
v_mfma_f32_16x16x32_bf16 v[168:171], a[108:111], a[76:79], v[168:171]
ds_read_b128 a[148:151], v5 offset:31744
v_mfma_f32_16x16x32_bf16 v[144:147], a[108:111], a[68:71], v[144:147]
v_mfma_f32_16x16x32_bf16 v[144:147], a[104:107], a[64:67], v[144:147]
buffer_load_dwordx4 a[40:43], v2, s[40:43], s35 offen offset:1024 sc1
v_mfma_f32_16x16x32_bf16 v[148:151], a[112:115], a[64:67], v[148:151]
v_mfma_f32_16x16x32_bf16 v[148:151], a[116:119], a[68:71], v[148:151]
v_mfma_f32_16x16x32_bf16 v[172:175], a[116:119], a[76:79], v[172:175]
v_mfma_f32_16x16x32_bf16 v[172:175], a[112:115], a[72:75], v[172:175]
v_mfma_f32_16x16x32_bf16 v[196:199], a[112:115], a[80:83], v[196:199]
buffer_load_dwordx4 a[44:47], v2, s[40:43], s33 offen offset:1024 sc1
v_mfma_f32_16x16x32_bf16 v[196:199], a[116:119], a[84:87], v[196:199]
v_mfma_f32_16x16x32_bf16 v[220:223], a[116:119], a[92:95], v[220:223]
v_mfma_f32_16x16x32_bf16 v[220:223], a[112:115], a[88:91], v[220:223]
s_waitcnt lgkmcnt(0)
v_mfma_f32_16x16x32_bf16 v[224:227], a[128:131], a[88:91], v[224:227]
ds_read_b128 a[96:99], v5 offset:38912
v_mfma_f32_16x16x32_bf16 v[224:227], a[132:135], a[92:95], v[224:227]
buffer_load_dwordx4 a[48:51], v2, s[40:43], s35 offen offset:2048 sc1
v_mfma_f32_16x16x32_bf16 v[200:203], a[132:135], a[84:87], v[200:203]
ds_read_b128 a[100:103], v5 offset:45056
v_mfma_f32_16x16x32_bf16 v[200:203], a[128:131], a[80:83], v[200:203]
v_mfma_f32_16x16x32_bf16 v[176:179], a[128:131], a[72:75], v[176:179]
v_mfma_f32_16x16x32_bf16 v[176:179], a[132:135], a[76:79], v[176:179]
buffer_load_dwordx4 v1, s[4:7], s44 offen offset:2048 sc1 lds
s_add_u32 s88, s82, 0x280000
v_mfma_f32_16x16x32_bf16 v[152:155], a[132:135], a[68:71], v[152:155]
ds_read_b128 a[104:107], v5 offset:39936
v_mfma_f32_16x16x32_bf16 v[152:155], a[128:131], a[64:67], v[152:155]
v_mfma_f32_16x16x32_bf16 v[132:135], a[136:139], a[64:67], v[132:135]
ds_read_b128 a[108:111], v5 offset:46080
v_mfma_f32_16x16x32_bf16 v[132:135], a[140:143], a[68:71], v[132:135]
buffer_load_dwordx4 a[52:55], v2, s[40:43], s33 offen offset:2048 sc1
v_mfma_f32_16x16x32_bf16 v[156:159], a[140:143], a[76:79], v[156:159]
ds_read_b128 a[112:115], v5 offset:40960
v_mfma_f32_16x16x32_bf16 v[156:159], a[136:139], a[72:75], v[156:159]
v_mfma_f32_16x16x32_bf16 v[180:183], a[136:139], a[80:83], v[180:183]
v_mfma_f32_16x16x32_bf16 v[180:183], a[140:143], a[84:87], v[180:183]
buffer_load_dwordx4 a[56:59], v2, s[40:43], s35 offen offset:3072 sc1
v_mfma_f32_16x16x32_bf16 v[204:207], a[140:143], a[92:95], v[204:207]
ds_read_b128 a[116:119], v5 offset:47104
v_mfma_f32_16x16x32_bf16 v[204:207], a[136:139], a[88:91], v[204:207]
v_mfma_f32_16x16x32_bf16 v[208:211], a[144:147], a[88:91], v[208:211]
v_mfma_f32_16x16x32_bf16 v[208:211], a[148:151], a[92:95], v[208:211]
buffer_load_dwordx4 v[92:95], v1, s[4:7], s88 offen offset:0 sc1
v_mfma_f32_16x16x32_bf16 v[184:187], a[148:151], a[84:87], v[184:187]
v_mfma_f32_16x16x32_bf16 v[184:187], a[144:147], a[80:83], v[184:187]
v_mfma_f32_16x16x32_bf16 v[160:163], a[144:147], a[72:75], v[160:163]
v_mfma_f32_16x16x32_bf16 v[160:163], a[148:151], a[76:79], v[160:163]
buffer_load_dwordx4 a[60:63], v2, s[40:43], s33 offen offset:3072 sc1
s_add_u32 s35, s35, 8192
v_mfma_f32_16x16x32_bf16 v[136:139], a[148:151], a[68:71], v[136:139]
s_add_u32 s33, s33, 8192
v_mfma_f32_16x16x32_bf16 v[136:139], a[144:147], a[64:67], v[136:139]
s_waitcnt vmcnt(11) lgkmcnt(0)
v_mfma_f32_16x16x32_bf16 v[140:143], a[96:99], a[0:3], v[140:143]
ds_read_b128 a[128:131], v5 offset:41984
v_mfma_f32_16x16x32_bf16 v[140:143], a[100:103], a[4:7], v[140:143]
buffer_load_dwordx4 a[64:67], v2, s[40:43], s35 offen offset:0 sc1
v_mfma_f32_16x16x32_bf16 v[164:167], a[100:103], a[12:15], v[164:167]
ds_read_b128 a[132:135], v5 offset:48128
v_mfma_f32_16x16x32_bf16 v[164:167], a[96:99], a[8:11], v[164:167]
v_mfma_f32_16x16x32_bf16 v[188:191], a[96:99], a[16:19], v[188:191]
v_mfma_f32_16x16x32_bf16 v[188:191], a[100:103], a[20:23], v[188:191]
buffer_load_dwordx4 a[68:71], v2, s[40:43], s33 offen offset:0 sc1
v_mfma_f32_16x16x32_bf16 v[212:215], a[100:103], a[28:31], v[212:215]
ds_read_b128 a[136:139], v5 offset:36864
v_mfma_f32_16x16x32_bf16 v[212:215], a[96:99], a[24:27], v[212:215]
v_mfma_f32_16x16x32_bf16 v[216:219], a[104:107], a[24:27], v[216:219]
ds_read_b128 a[140:143], v5 offset:43008
v_mfma_f32_16x16x32_bf16 v[216:219], a[108:111], a[28:31], v[216:219]
v_mfma_f32_16x16x32_bf16 v[192:195], a[108:111], a[20:23], v[192:195]
buffer_load_dwordx4 v[96:99], v1, s[4:7], s88 offen offset:1024 sc1
v_mfma_f32_16x16x32_bf16 v[192:195], a[104:107], a[16:19], v[192:195]
ds_read_b128 a[144:147], v5 offset:37888
v_mfma_f32_16x16x32_bf16 v[168:171], a[104:107], a[8:11], v[168:171]
v_mfma_f32_16x16x32_bf16 v[168:171], a[108:111], a[12:15], v[168:171]
ds_read_b128 a[148:151], v5 offset:44032
v_mfma_f32_16x16x32_bf16 v[144:147], a[108:111], a[4:7], v[144:147]
v_mfma_f32_16x16x32_bf16 v[144:147], a[104:107], a[0:3], v[144:147]
buffer_load_dwordx4 a[72:75], v2, s[40:43], s35 offen offset:1024 sc1
v_mfma_f32_16x16x32_bf16 v[148:151], a[112:115], a[0:3], v[148:151]
v_mfma_f32_16x16x32_bf16 v[148:151], a[116:119], a[4:7], v[148:151]
v_mfma_f32_16x16x32_bf16 v[172:175], a[116:119], a[12:15], v[172:175]
v_mfma_f32_16x16x32_bf16 v[172:175], a[112:115], a[8:11], v[172:175]
v_mfma_f32_16x16x32_bf16 v[196:199], a[112:115], a[16:19], v[196:199]
buffer_load_dwordx4 a[76:79], v2, s[40:43], s33 offen offset:1024 sc1
v_mfma_f32_16x16x32_bf16 v[196:199], a[116:119], a[20:23], v[196:199]
v_mfma_f32_16x16x32_bf16 v[220:223], a[116:119], a[28:31], v[220:223]
v_mfma_f32_16x16x32_bf16 v[220:223], a[112:115], a[24:27], v[220:223]
s_waitcnt lgkmcnt(0)
s_barrier
v_mfma_f32_16x16x32_bf16 v[224:227], a[128:131], a[24:27], v[224:227]
v_add_u32 v5, 49152, v1
v_mfma_f32_16x16x32_bf16 v[224:227], a[132:135], a[28:31], v[224:227]
buffer_load_dwordx4 a[80:83], v2, s[40:43], s35 offen offset:2048 sc1
v_mfma_f32_16x16x32_bf16 v[200:203], a[132:135], a[20:23], v[200:203]
ds_read_b128 a[96:99], v5 offset:2048
v_mfma_f32_16x16x32_bf16 v[200:203], a[128:131], a[16:19], v[200:203]
ds_read_b128 a[100:103], v5 offset:8192
v_mfma_f32_16x16x32_bf16 v[176:179], a[128:131], a[8:11], v[176:179]
v_mfma_f32_16x16x32_bf16 v[176:179], a[132:135], a[12:15], v[176:179]
buffer_load_dwordx4 a[84:87], v2, s[40:43], s33 offen offset:2048 sc1
v_mfma_f32_16x16x32_bf16 v[152:155], a[132:135], a[4:7], v[152:155]
ds_read_b128 a[104:107], v5 offset:3072
v_mfma_f32_16x16x32_bf16 v[152:155], a[128:131], a[0:3], v[152:155]
v_mfma_f32_16x16x32_bf16 v[132:135], a[136:139], a[0:3], v[132:135]
ds_read_b128 a[108:111], v5 offset:9216
v_mfma_f32_16x16x32_bf16 v[132:135], a[140:143], a[4:7], v[132:135]
v_mfma_f32_16x16x32_bf16 v[156:159], a[140:143], a[12:15], v[156:159]
buffer_load_dwordx4 v[100:103], v1, s[4:7], s88 offen offset:2048 sc1
v_mfma_f32_16x16x32_bf16 v[156:159], a[136:139], a[8:11], v[156:159]
ds_read_b128 a[112:115], v5 offset:4096
v_mfma_f32_16x16x32_bf16 v[180:183], a[136:139], a[16:19], v[180:183]
v_mfma_f32_16x16x32_bf16 v[180:183], a[140:143], a[20:23], v[180:183]
ds_read_b128 a[116:119], v5 offset:10240
v_mfma_f32_16x16x32_bf16 v[204:207], a[140:143], a[28:31], v[204:207]
v_mfma_f32_16x16x32_bf16 v[204:207], a[136:139], a[24:27], v[204:207]
buffer_load_dwordx4 a[88:91], v2, s[40:43], s35 offen offset:3072 sc1
v_mfma_f32_16x16x32_bf16 v[208:211], a[144:147], a[24:27], v[208:211]
v_mfma_f32_16x16x32_bf16 v[208:211], a[148:151], a[28:31], v[208:211]
v_mfma_f32_16x16x32_bf16 v[184:187], a[148:151], a[20:23], v[184:187]
v_mfma_f32_16x16x32_bf16 v[184:187], a[144:147], a[16:19], v[184:187]
v_mfma_f32_16x16x32_bf16 v[160:163], a[144:147], a[8:11], v[160:163]
buffer_load_dwordx4 a[92:95], v2, s[40:43], s33 offen offset:3072 sc1
s_add_u32 s35, s35, 8192
v_mfma_f32_16x16x32_bf16 v[160:163], a[148:151], a[12:15], v[160:163]
s_add_u32 s33, s33, 8192
v_mfma_f32_16x16x32_bf16 v[136:139], a[148:151], a[4:7], v[136:139]
v_mfma_f32_16x16x32_bf16 v[136:139], a[144:147], a[0:3], v[136:139]
s_waitcnt vmcnt(10) lgkmcnt(0)
v_mfma_f32_16x16x32_bf16 v[140:143], a[96:99], a[32:35], v[140:143]
ds_read_b128 a[128:131], v5 offset:5120
v_mfma_f32_16x16x32_bf16 v[140:143], a[100:103], a[36:39], v[140:143]
buffer_load_dwordx4 a[0:3], v2, s[40:43], s35 offen offset:0 sc1
v_mfma_f32_16x16x32_bf16 v[164:167], a[100:103], a[44:47], v[164:167]
ds_read_b128 a[132:135], v5 offset:11264
v_mfma_f32_16x16x32_bf16 v[164:167], a[96:99], a[40:43], v[164:167]
v_mfma_f32_16x16x32_bf16 v[188:191], a[96:99], a[48:51], v[188:191]
v_mfma_f32_16x16x32_bf16 v[188:191], a[100:103], a[52:55], v[188:191]
buffer_load_dwordx4 a[4:7], v2, s[40:43], s33 offen offset:0 sc1
v_mfma_f32_16x16x32_bf16 v[212:215], a[100:103], a[60:63], v[212:215]
ds_read_b128 a[136:139], v5 offset:0
v_mfma_f32_16x16x32_bf16 v[212:215], a[96:99], a[56:59], v[212:215]
v_mfma_f32_16x16x32_bf16 v[216:219], a[104:107], a[56:59], v[216:219]
ds_read_b128 a[140:143], v5 offset:6144
v_mfma_f32_16x16x32_bf16 v[216:219], a[108:111], a[60:63], v[216:219]
v_mfma_f32_16x16x32_bf16 v[192:195], a[108:111], a[52:55], v[192:195]
buffer_load_dwordx4 v[104:107], v1, s[4:7], s88 offen offset:3072 sc1
s_add_u32 s88, s88, 4096
v_mfma_f32_16x16x32_bf16 v[192:195], a[104:107], a[48:51], v[192:195]
ds_read_b128 a[144:147], v5 offset:1024
v_mfma_f32_16x16x32_bf16 v[168:171], a[104:107], a[40:43], v[168:171]
v_mfma_f32_16x16x32_bf16 v[168:171], a[108:111], a[44:47], v[168:171]
ds_read_b128 a[148:151], v5 offset:7168
v_mfma_f32_16x16x32_bf16 v[144:147], a[108:111], a[36:39], v[144:147]
v_mfma_f32_16x16x32_bf16 v[144:147], a[104:107], a[32:35], v[144:147]
buffer_load_dwordx4 a[8:11], v2, s[40:43], s35 offen offset:1024 sc1
v_mfma_f32_16x16x32_bf16 v[148:151], a[112:115], a[32:35], v[148:151]
v_mfma_f32_16x16x32_bf16 v[148:151], a[116:119], a[36:39], v[148:151]
v_mfma_f32_16x16x32_bf16 v[172:175], a[116:119], a[44:47], v[172:175]
v_mfma_f32_16x16x32_bf16 v[172:175], a[112:115], a[40:43], v[172:175]
v_mfma_f32_16x16x32_bf16 v[196:199], a[112:115], a[48:51], v[196:199]
buffer_load_dwordx4 a[12:15], v2, s[40:43], s33 offen offset:1024 sc1
v_mfma_f32_16x16x32_bf16 v[196:199], a[116:119], a[52:55], v[196:199]
v_mfma_f32_16x16x32_bf16 v[220:223], a[116:119], a[60:63], v[220:223]
v_mfma_f32_16x16x32_bf16 v[220:223], a[112:115], a[56:59], v[220:223]
s_waitcnt lgkmcnt(0)
v_mfma_f32_16x16x32_bf16 v[224:227], a[128:131], a[56:59], v[224:227]
ds_read_b128 a[96:99], v5 offset:14336
v_mfma_f32_16x16x32_bf16 v[224:227], a[132:135], a[60:63], v[224:227]
buffer_load_dwordx4 a[16:19], v2, s[40:43], s35 offen offset:2048 sc1
v_mfma_f32_16x16x32_bf16 v[200:203], a[132:135], a[52:55], v[200:203]
ds_read_b128 a[100:103], v5 offset:20480
v_mfma_f32_16x16x32_bf16 v[200:203], a[128:131], a[48:51], v[200:203]
v_mfma_f32_16x16x32_bf16 v[176:179], a[128:131], a[40:43], v[176:179]
v_mfma_f32_16x16x32_bf16 v[176:179], a[132:135], a[44:47], v[176:179]
buffer_load_dwordx4 a[20:23], v2, s[40:43], s33 offen offset:2048 sc1
v_mfma_f32_16x16x32_bf16 v[152:155], a[132:135], a[36:39], v[152:155]
ds_read_b128 a[104:107], v5 offset:15360
v_mfma_f32_16x16x32_bf16 v[152:155], a[128:131], a[32:35], v[152:155]
v_mfma_f32_16x16x32_bf16 v[132:135], a[136:139], a[32:35], v[132:135]
ds_read_b128 a[108:111], v5 offset:21504
v_mfma_f32_16x16x32_bf16 v[132:135], a[140:143], a[36:39], v[132:135]
v_mfma_f32_16x16x32_bf16 v[156:159], a[140:143], a[44:47], v[156:159]
buffer_load_dwordx4 v[108:111], v1, s[4:7], s88 offen offset:0 sc1
v_mfma_f32_16x16x32_bf16 v[156:159], a[136:139], a[40:43], v[156:159]
ds_read_b128 a[112:115], v5 offset:16384
v_mfma_f32_16x16x32_bf16 v[180:183], a[136:139], a[48:51], v[180:183]
v_mfma_f32_16x16x32_bf16 v[180:183], a[140:143], a[52:55], v[180:183]
ds_read_b128 a[116:119], v5 offset:22528
v_mfma_f32_16x16x32_bf16 v[204:207], a[140:143], a[60:63], v[204:207]
v_mfma_f32_16x16x32_bf16 v[204:207], a[136:139], a[56:59], v[204:207]
buffer_load_dwordx4 a[24:27], v2, s[40:43], s35 offen offset:3072 sc1
v_mfma_f32_16x16x32_bf16 v[208:211], a[144:147], a[56:59], v[208:211]
v_mfma_f32_16x16x32_bf16 v[208:211], a[148:151], a[60:63], v[208:211]
v_mfma_f32_16x16x32_bf16 v[184:187], a[148:151], a[52:55], v[184:187]
v_mfma_f32_16x16x32_bf16 v[184:187], a[144:147], a[48:51], v[184:187]
v_mfma_f32_16x16x32_bf16 v[160:163], a[144:147], a[40:43], v[160:163]
buffer_load_dwordx4 a[28:31], v2, s[40:43], s33 offen offset:3072 sc1
s_add_u32 s35, s35, 8192
v_mfma_f32_16x16x32_bf16 v[160:163], a[148:151], a[44:47], v[160:163]
s_add_u32 s33, s33, 8192
v_mfma_f32_16x16x32_bf16 v[136:139], a[148:151], a[36:39], v[136:139]
v_mfma_f32_16x16x32_bf16 v[136:139], a[144:147], a[32:35], v[136:139]
s_waitcnt vmcnt(10) lgkmcnt(0)
v_mfma_f32_16x16x32_bf16 v[140:143], a[96:99], a[64:67], v[140:143]
ds_read_b128 a[128:131], v5 offset:17408
v_mfma_f32_16x16x32_bf16 v[140:143], a[100:103], a[68:71], v[140:143]
buffer_load_dwordx4 a[32:35], v2, s[40:43], s35 offen offset:0 sc1
v_mfma_f32_16x16x32_bf16 v[164:167], a[100:103], a[76:79], v[164:167]
ds_read_b128 a[132:135], v5 offset:23552
v_mfma_f32_16x16x32_bf16 v[164:167], a[96:99], a[72:75], v[164:167]
v_mfma_f32_16x16x32_bf16 v[188:191], a[96:99], a[80:83], v[188:191]
v_mfma_f32_16x16x32_bf16 v[188:191], a[100:103], a[84:87], v[188:191]
buffer_load_dwordx4 a[36:39], v2, s[40:43], s33 offen offset:0 sc1
v_mfma_f32_16x16x32_bf16 v[212:215], a[100:103], a[92:95], v[212:215]
ds_read_b128 a[136:139], v5 offset:12288
v_mfma_f32_16x16x32_bf16 v[212:215], a[96:99], a[88:91], v[212:215]
v_mfma_f32_16x16x32_bf16 v[216:219], a[104:107], a[88:91], v[216:219]
ds_read_b128 a[140:143], v5 offset:18432
v_mfma_f32_16x16x32_bf16 v[216:219], a[108:111], a[92:95], v[216:219]
v_mfma_f32_16x16x32_bf16 v[192:195], a[108:111], a[84:87], v[192:195]
buffer_load_dwordx4 v[112:115], v1, s[4:7], s88 offen offset:1024 sc1
v_mfma_f32_16x16x32_bf16 v[192:195], a[104:107], a[80:83], v[192:195]
ds_read_b128 a[144:147], v5 offset:13312
v_mfma_f32_16x16x32_bf16 v[168:171], a[104:107], a[72:75], v[168:171]
v_mfma_f32_16x16x32_bf16 v[168:171], a[108:111], a[76:79], v[168:171]
ds_read_b128 a[148:151], v5 offset:19456
v_mfma_f32_16x16x32_bf16 v[144:147], a[108:111], a[68:71], v[144:147]
v_mfma_f32_16x16x32_bf16 v[144:147], a[104:107], a[64:67], v[144:147]
buffer_load_dwordx4 a[40:43], v2, s[40:43], s35 offen offset:1024 sc1
v_mfma_f32_16x16x32_bf16 v[148:151], a[112:115], a[64:67], v[148:151]
v_mfma_f32_16x16x32_bf16 v[148:151], a[116:119], a[68:71], v[148:151]
v_mfma_f32_16x16x32_bf16 v[172:175], a[116:119], a[76:79], v[172:175]
v_mfma_f32_16x16x32_bf16 v[172:175], a[112:115], a[72:75], v[172:175]
v_mfma_f32_16x16x32_bf16 v[196:199], a[112:115], a[80:83], v[196:199]
buffer_load_dwordx4 a[44:47], v2, s[40:43], s33 offen offset:1024 sc1
v_mfma_f32_16x16x32_bf16 v[196:199], a[116:119], a[84:87], v[196:199]
v_mfma_f32_16x16x32_bf16 v[220:223], a[116:119], a[92:95], v[220:223]
v_mfma_f32_16x16x32_bf16 v[220:223], a[112:115], a[88:91], v[220:223]
s_waitcnt lgkmcnt(0)
v_mfma_f32_16x16x32_bf16 v[224:227], a[128:131], a[88:91], v[224:227]
ds_read_b128 a[96:99], v5 offset:26624
v_mfma_f32_16x16x32_bf16 v[224:227], a[132:135], a[92:95], v[224:227]
buffer_load_dwordx4 a[48:51], v2, s[40:43], s35 offen offset:2048 sc1
v_mfma_f32_16x16x32_bf16 v[200:203], a[132:135], a[84:87], v[200:203]
ds_read_b128 a[100:103], v5 offset:32768
v_mfma_f32_16x16x32_bf16 v[200:203], a[128:131], a[80:83], v[200:203]
v_mfma_f32_16x16x32_bf16 v[176:179], a[128:131], a[72:75], v[176:179]
v_mfma_f32_16x16x32_bf16 v[176:179], a[132:135], a[76:79], v[176:179]
buffer_load_dwordx4 a[52:55], v2, s[40:43], s33 offen offset:2048 sc1
v_mfma_f32_16x16x32_bf16 v[152:155], a[132:135], a[68:71], v[152:155]
ds_read_b128 a[104:107], v5 offset:27648
v_mfma_f32_16x16x32_bf16 v[152:155], a[128:131], a[64:67], v[152:155]
v_mfma_f32_16x16x32_bf16 v[132:135], a[136:139], a[64:67], v[132:135]
ds_read_b128 a[108:111], v5 offset:33792
v_mfma_f32_16x16x32_bf16 v[132:135], a[140:143], a[68:71], v[132:135]
v_mfma_f32_16x16x32_bf16 v[156:159], a[140:143], a[76:79], v[156:159]
buffer_load_dwordx4 v[116:119], v1, s[4:7], s88 offen offset:2048 sc1
v_mfma_f32_16x16x32_bf16 v[156:159], a[136:139], a[72:75], v[156:159]
ds_read_b128 a[112:115], v5 offset:28672
v_mfma_f32_16x16x32_bf16 v[180:183], a[136:139], a[80:83], v[180:183]
v_mfma_f32_16x16x32_bf16 v[180:183], a[140:143], a[84:87], v[180:183]
ds_read_b128 a[116:119], v5 offset:34816
v_mfma_f32_16x16x32_bf16 v[204:207], a[140:143], a[92:95], v[204:207]
v_mfma_f32_16x16x32_bf16 v[204:207], a[136:139], a[88:91], v[204:207]
buffer_load_dwordx4 a[56:59], v2, s[40:43], s35 offen offset:3072 sc1
v_mfma_f32_16x16x32_bf16 v[208:211], a[144:147], a[88:91], v[208:211]
v_mfma_f32_16x16x32_bf16 v[208:211], a[148:151], a[92:95], v[208:211]
v_mfma_f32_16x16x32_bf16 v[184:187], a[148:151], a[84:87], v[184:187]
v_mfma_f32_16x16x32_bf16 v[184:187], a[144:147], a[80:83], v[184:187]
v_mfma_f32_16x16x32_bf16 v[160:163], a[144:147], a[72:75], v[160:163]
buffer_load_dwordx4 a[60:63], v2, s[40:43], s33 offen offset:3072 sc1
s_add_u32 s35, s35, 8192
v_mfma_f32_16x16x32_bf16 v[160:163], a[148:151], a[76:79], v[160:163]
s_add_u32 s33, s33, 8192
v_mfma_f32_16x16x32_bf16 v[136:139], a[148:151], a[68:71], v[136:139]
v_mfma_f32_16x16x32_bf16 v[136:139], a[144:147], a[64:67], v[136:139]
s_waitcnt vmcnt(10) lgkmcnt(0)
v_mfma_f32_16x16x32_bf16 v[140:143], a[96:99], a[0:3], v[140:143]
ds_read_b128 a[128:131], v5 offset:29696
v_mfma_f32_16x16x32_bf16 v[140:143], a[100:103], a[4:7], v[140:143]
buffer_load_dwordx4 a[64:67], v2, s[40:43], s35 offen offset:0 sc1
v_mfma_f32_16x16x32_bf16 v[164:167], a[100:103], a[12:15], v[164:167]
ds_read_b128 a[132:135], v5 offset:35840
v_mfma_f32_16x16x32_bf16 v[164:167], a[96:99], a[8:11], v[164:167]
v_mfma_f32_16x16x32_bf16 v[188:191], a[96:99], a[16:19], v[188:191]
v_mfma_f32_16x16x32_bf16 v[188:191], a[100:103], a[20:23], v[188:191]
buffer_load_dwordx4 a[68:71], v2, s[40:43], s33 offen offset:0 sc1
v_mfma_f32_16x16x32_bf16 v[212:215], a[100:103], a[28:31], v[212:215]
ds_read_b128 a[136:139], v5 offset:24576
v_mfma_f32_16x16x32_bf16 v[212:215], a[96:99], a[24:27], v[212:215]
v_mfma_f32_16x16x32_bf16 v[216:219], a[104:107], a[24:27], v[216:219]
ds_read_b128 a[140:143], v5 offset:30720
v_mfma_f32_16x16x32_bf16 v[216:219], a[108:111], a[28:31], v[216:219]
v_mfma_f32_16x16x32_bf16 v[192:195], a[108:111], a[20:23], v[192:195]
buffer_load_dwordx4 v[120:123], v1, s[4:7], s88 offen offset:3072 sc1
s_add_u32 m0, s18, 0x0
v_mfma_f32_16x16x32_bf16 v[192:195], a[104:107], a[16:19], v[192:195]
s_add_u32 s44, s50, 0xe24000
ds_read_b128 a[144:147], v5 offset:25600
v_mfma_f32_16x16x32_bf16 v[168:171], a[104:107], a[8:11], v[168:171]
v_mfma_f32_16x16x32_bf16 v[168:171], a[108:111], a[12:15], v[168:171]
ds_read_b128 a[148:151], v5 offset:31744
v_mfma_f32_16x16x32_bf16 v[144:147], a[108:111], a[4:7], v[144:147]
v_mfma_f32_16x16x32_bf16 v[144:147], a[104:107], a[0:3], v[144:147]
buffer_load_dwordx4 a[72:75], v2, s[40:43], s35 offen offset:1024 sc1
v_mfma_f32_16x16x32_bf16 v[148:151], a[112:115], a[0:3], v[148:151]
v_mfma_f32_16x16x32_bf16 v[148:151], a[116:119], a[4:7], v[148:151]
v_mfma_f32_16x16x32_bf16 v[172:175], a[116:119], a[12:15], v[172:175]
v_mfma_f32_16x16x32_bf16 v[172:175], a[112:115], a[8:11], v[172:175]
v_mfma_f32_16x16x32_bf16 v[196:199], a[112:115], a[16:19], v[196:199]
buffer_load_dwordx4 a[76:79], v2, s[40:43], s33 offen offset:1024 sc1
v_mfma_f32_16x16x32_bf16 v[196:199], a[116:119], a[20:23], v[196:199]
v_mfma_f32_16x16x32_bf16 v[220:223], a[116:119], a[28:31], v[220:223]
v_mfma_f32_16x16x32_bf16 v[220:223], a[112:115], a[24:27], v[220:223]
s_waitcnt lgkmcnt(0)
v_mfma_f32_16x16x32_bf16 v[224:227], a[128:131], a[24:27], v[224:227]
ds_read_b128 a[96:99], v5 offset:38912
v_mfma_f32_16x16x32_bf16 v[224:227], a[132:135], a[28:31], v[224:227]
buffer_load_dwordx4 a[80:83], v2, s[40:43], s35 offen offset:2048 sc1
v_mfma_f32_16x16x32_bf16 v[200:203], a[132:135], a[20:23], v[200:203]
ds_read_b128 a[100:103], v5 offset:45056
v_mfma_f32_16x16x32_bf16 v[200:203], a[128:131], a[16:19], v[200:203]
v_mfma_f32_16x16x32_bf16 v[176:179], a[128:131], a[8:11], v[176:179]
v_mfma_f32_16x16x32_bf16 v[176:179], a[132:135], a[12:15], v[176:179]
buffer_load_dwordx4 v1, s[4:7], s44 offen offset:0 sc1 lds
v_mfma_f32_16x16x32_bf16 v[152:155], a[132:135], a[4:7], v[152:155]
ds_read_b128 a[104:107], v5 offset:39936
v_mfma_f32_16x16x32_bf16 v[152:155], a[128:131], a[0:3], v[152:155]
v_mfma_f32_16x16x32_bf16 v[132:135], a[136:139], a[0:3], v[132:135]
ds_read_b128 a[108:111], v5 offset:46080
v_mfma_f32_16x16x32_bf16 v[132:135], a[140:143], a[4:7], v[132:135]
buffer_load_dwordx4 a[84:87], v2, s[40:43], s33 offen offset:2048 sc1
v_mfma_f32_16x16x32_bf16 v[156:159], a[140:143], a[12:15], v[156:159]
ds_read_b128 a[112:115], v5 offset:40960
v_mfma_f32_16x16x32_bf16 v[156:159], a[136:139], a[8:11], v[156:159]
v_mfma_f32_16x16x32_bf16 v[180:183], a[136:139], a[16:19], v[180:183]
v_mfma_f32_16x16x32_bf16 v[180:183], a[140:143], a[20:23], v[180:183]
buffer_load_dwordx4 a[88:91], v2, s[40:43], s35 offen offset:3072 sc1
v_mfma_f32_16x16x32_bf16 v[204:207], a[140:143], a[28:31], v[204:207]
ds_read_b128 a[116:119], v5 offset:47104
v_mfma_f32_16x16x32_bf16 v[204:207], a[136:139], a[24:27], v[204:207]
v_mfma_f32_16x16x32_bf16 v[208:211], a[144:147], a[24:27], v[208:211]
v_mfma_f32_16x16x32_bf16 v[208:211], a[148:151], a[28:31], v[208:211]
buffer_load_dwordx4 v1, s[4:7], s44 offen offset:1024 sc1 lds
v_mfma_f32_16x16x32_bf16 v[184:187], a[148:151], a[20:23], v[184:187]
v_mfma_f32_16x16x32_bf16 v[184:187], a[144:147], a[16:19], v[184:187]
v_mfma_f32_16x16x32_bf16 v[160:163], a[144:147], a[8:11], v[160:163]
v_mfma_f32_16x16x32_bf16 v[160:163], a[148:151], a[12:15], v[160:163]
buffer_load_dwordx4 a[92:95], v2, s[40:43], s33 offen offset:3072 sc1
s_add_u32 s35, s35, 8192
v_mfma_f32_16x16x32_bf16 v[136:139], a[148:151], a[4:7], v[136:139]
s_add_u32 s33, s33, 8192
v_mfma_f32_16x16x32_bf16 v[136:139], a[144:147], a[0:3], v[136:139]
s_waitcnt vmcnt(11) lgkmcnt(0)
v_mfma_f32_16x16x32_bf16 v[140:143], a[96:99], a[32:35], v[140:143]
ds_read_b128 a[128:131], v5 offset:41984
v_mfma_f32_16x16x32_bf16 v[140:143], a[100:103], a[36:39], v[140:143]
buffer_load_dwordx4 a[0:3], v2, s[40:43], s35 offen offset:0 sc1
v_mfma_f32_16x16x32_bf16 v[164:167], a[100:103], a[44:47], v[164:167]
ds_read_b128 a[132:135], v5 offset:48128
v_mfma_f32_16x16x32_bf16 v[164:167], a[96:99], a[40:43], v[164:167]
v_mfma_f32_16x16x32_bf16 v[188:191], a[96:99], a[48:51], v[188:191]
v_mfma_f32_16x16x32_bf16 v[188:191], a[100:103], a[52:55], v[188:191]
buffer_load_dwordx4 a[4:7], v2, s[40:43], s33 offen offset:0 sc1
v_mfma_f32_16x16x32_bf16 v[212:215], a[100:103], a[60:63], v[212:215]
ds_read_b128 a[136:139], v5 offset:36864
v_mfma_f32_16x16x32_bf16 v[212:215], a[96:99], a[56:59], v[212:215]
v_mfma_f32_16x16x32_bf16 v[216:219], a[104:107], a[56:59], v[216:219]
ds_read_b128 a[140:143], v5 offset:43008
v_mfma_f32_16x16x32_bf16 v[216:219], a[108:111], a[60:63], v[216:219]
v_mfma_f32_16x16x32_bf16 v[192:195], a[108:111], a[52:55], v[192:195]
buffer_load_dwordx4 v1, s[4:7], s44 offen offset:2048 sc1 lds
s_add_u32 m0, s18, 0x3000
v_mfma_f32_16x16x32_bf16 v[192:195], a[104:107], a[48:51], v[192:195]
s_add_u32 s44, s50, 0xe27000
ds_read_b128 a[144:147], v5 offset:37888
v_mfma_f32_16x16x32_bf16 v[168:171], a[104:107], a[40:43], v[168:171]
v_mfma_f32_16x16x32_bf16 v[168:171], a[108:111], a[44:47], v[168:171]
ds_read_b128 a[148:151], v5 offset:44032
v_mfma_f32_16x16x32_bf16 v[144:147], a[108:111], a[36:39], v[144:147]
v_mfma_f32_16x16x32_bf16 v[144:147], a[104:107], a[32:35], v[144:147]
buffer_load_dwordx4 a[8:11], v2, s[40:43], s35 offen offset:1024 sc1
v_mfma_f32_16x16x32_bf16 v[148:151], a[112:115], a[32:35], v[148:151]
v_mfma_f32_16x16x32_bf16 v[148:151], a[116:119], a[36:39], v[148:151]
v_mfma_f32_16x16x32_bf16 v[172:175], a[116:119], a[44:47], v[172:175]
v_mfma_f32_16x16x32_bf16 v[172:175], a[112:115], a[40:43], v[172:175]
v_mfma_f32_16x16x32_bf16 v[196:199], a[112:115], a[48:51], v[196:199]
buffer_load_dwordx4 a[12:15], v2, s[40:43], s33 offen offset:1024 sc1
v_mfma_f32_16x16x32_bf16 v[196:199], a[116:119], a[52:55], v[196:199]
v_mfma_f32_16x16x32_bf16 v[220:223], a[116:119], a[60:63], v[220:223]
v_mfma_f32_16x16x32_bf16 v[220:223], a[112:115], a[56:59], v[220:223]
s_waitcnt lgkmcnt(0)
s_barrier
v_mfma_f32_16x16x32_bf16 v[224:227], a[128:131], a[56:59], v[224:227]
v_add_u32 v5, 98304, v1
v_mfma_f32_16x16x32_bf16 v[224:227], a[132:135], a[60:63], v[224:227]
buffer_load_dwordx4 a[16:19], v2, s[40:43], s35 offen offset:2048 sc1
v_mfma_f32_16x16x32_bf16 v[200:203], a[132:135], a[52:55], v[200:203]
ds_read_b128 a[96:99], v5 offset:2048
v_mfma_f32_16x16x32_bf16 v[200:203], a[128:131], a[48:51], v[200:203]
ds_read_b128 a[100:103], v5 offset:8192
v_mfma_f32_16x16x32_bf16 v[176:179], a[128:131], a[40:43], v[176:179]
v_mfma_f32_16x16x32_bf16 v[176:179], a[132:135], a[44:47], v[176:179]
buffer_load_dwordx4 a[20:23], v2, s[40:43], s33 offen offset:2048 sc1
v_mfma_f32_16x16x32_bf16 v[152:155], a[132:135], a[36:39], v[152:155]
ds_read_b128 a[104:107], v5 offset:3072
v_mfma_f32_16x16x32_bf16 v[152:155], a[128:131], a[32:35], v[152:155]
v_mfma_f32_16x16x32_bf16 v[132:135], a[136:139], a[32:35], v[132:135]
ds_read_b128 a[108:111], v5 offset:9216
v_mfma_f32_16x16x32_bf16 v[132:135], a[140:143], a[36:39], v[132:135]
v_mfma_f32_16x16x32_bf16 v[156:159], a[140:143], a[44:47], v[156:159]
buffer_load_dwordx4 v1, s[4:7], s44 offen offset:0 sc1 lds
v_mfma_f32_16x16x32_bf16 v[156:159], a[136:139], a[40:43], v[156:159]
ds_read_b128 a[112:115], v5 offset:4096
v_mfma_f32_16x16x32_bf16 v[180:183], a[136:139], a[48:51], v[180:183]
v_mfma_f32_16x16x32_bf16 v[180:183], a[140:143], a[52:55], v[180:183]
ds_read_b128 a[116:119], v5 offset:10240
v_mfma_f32_16x16x32_bf16 v[204:207], a[140:143], a[60:63], v[204:207]
L_stub11:
s_cbranch_execz L_stub12
v_mfma_f32_16x16x32_bf16 v[204:207], a[136:139], a[56:59], v[204:207]
buffer_load_dwordx4 a[24:27], v2, s[40:43], s35 offen offset:3072 sc1
v_mfma_f32_16x16x32_bf16 v[208:211], a[144:147], a[56:59], v[208:211]
v_mfma_f32_16x16x32_bf16 v[208:211], a[148:151], a[60:63], v[208:211]
v_mfma_f32_16x16x32_bf16 v[184:187], a[148:151], a[52:55], v[184:187]
v_mfma_f32_16x16x32_bf16 v[184:187], a[144:147], a[48:51], v[184:187]
v_mfma_f32_16x16x32_bf16 v[160:163], a[144:147], a[40:43], v[160:163]
buffer_load_dwordx4 a[28:31], v2, s[40:43], s33 offen offset:3072 sc1
s_add_u32 s35, s35, 8192
v_mfma_f32_16x16x32_bf16 v[160:163], a[148:151], a[44:47], v[160:163]
s_add_u32 s33, s33, 8192
v_mfma_f32_16x16x32_bf16 v[136:139], a[148:151], a[36:39], v[136:139]
v_mfma_f32_16x16x32_bf16 v[136:139], a[144:147], a[32:35], v[136:139]
s_waitcnt vmcnt(10) lgkmcnt(0)
v_mfma_f32_16x16x32_bf16 v[140:143], a[96:99], a[64:67], v[140:143]
ds_read_b128 a[128:131], v5 offset:5120
v_mfma_f32_16x16x32_bf16 v[140:143], a[100:103], a[68:71], v[140:143]
buffer_load_dwordx4 a[32:35], v2, s[40:43], s35 offen offset:0 sc1
v_mfma_f32_16x16x32_bf16 v[164:167], a[100:103], a[76:79], v[164:167]
ds_read_b128 a[132:135], v5 offset:11264
v_mfma_f32_16x16x32_bf16 v[164:167], a[96:99], a[72:75], v[164:167]
v_mfma_f32_16x16x32_bf16 v[188:191], a[96:99], a[80:83], v[188:191]
v_mfma_f32_16x16x32_bf16 v[188:191], a[100:103], a[84:87], v[188:191]
buffer_load_dwordx4 a[36:39], v2, s[40:43], s33 offen offset:0 sc1
v_mfma_f32_16x16x32_bf16 v[212:215], a[100:103], a[92:95], v[212:215]
ds_read_b128 a[136:139], v5 offset:0
v_mfma_f32_16x16x32_bf16 v[212:215], a[96:99], a[88:91], v[212:215]
v_mfma_f32_16x16x32_bf16 v[216:219], a[104:107], a[88:91], v[216:219]
ds_read_b128 a[140:143], v5 offset:6144
v_mfma_f32_16x16x32_bf16 v[216:219], a[108:111], a[92:95], v[216:219]
v_mfma_f32_16x16x32_bf16 v[192:195], a[108:111], a[84:87], v[192:195]
buffer_load_dwordx4 v1, s[4:7], s44 offen offset:1024 sc1 lds
v_mfma_f32_16x16x32_bf16 v[192:195], a[104:107], a[80:83], v[192:195]
ds_read_b128 a[144:147], v5 offset:1024
v_mfma_f32_16x16x32_bf16 v[168:171], a[104:107], a[72:75], v[168:171]
v_mfma_f32_16x16x32_bf16 v[168:171], a[108:111], a[76:79], v[168:171]
ds_read_b128 a[148:151], v5 offset:7168
v_mfma_f32_16x16x32_bf16 v[144:147], a[108:111], a[68:71], v[144:147]
v_mfma_f32_16x16x32_bf16 v[144:147], a[104:107], a[64:67], v[144:147]
buffer_load_dwordx4 a[40:43], v2, s[40:43], s35 offen offset:1024 sc1
v_mfma_f32_16x16x32_bf16 v[148:151], a[112:115], a[64:67], v[148:151]
v_mfma_f32_16x16x32_bf16 v[148:151], a[116:119], a[68:71], v[148:151]
v_mfma_f32_16x16x32_bf16 v[172:175], a[116:119], a[76:79], v[172:175]
v_mfma_f32_16x16x32_bf16 v[172:175], a[112:115], a[72:75], v[172:175]
v_mfma_f32_16x16x32_bf16 v[196:199], a[112:115], a[80:83], v[196:199]
buffer_load_dwordx4 a[44:47], v2, s[40:43], s33 offen offset:1024 sc1
v_mfma_f32_16x16x32_bf16 v[196:199], a[116:119], a[84:87], v[196:199]
v_mfma_f32_16x16x32_bf16 v[220:223], a[116:119], a[92:95], v[220:223]
v_mfma_f32_16x16x32_bf16 v[220:223], a[112:115], a[88:91], v[220:223]
s_waitcnt lgkmcnt(0)
v_mfma_f32_16x16x32_bf16 v[224:227], a[128:131], a[88:91], v[224:227]
ds_read_b128 a[96:99], v5 offset:14336
v_mfma_f32_16x16x32_bf16 v[224:227], a[132:135], a[92:95], v[224:227]
buffer_load_dwordx4 a[48:51], v2, s[40:43], s35 offen offset:2048 sc1
v_mfma_f32_16x16x32_bf16 v[200:203], a[132:135], a[84:87], v[200:203]
ds_read_b128 a[100:103], v5 offset:20480
v_mfma_f32_16x16x32_bf16 v[200:203], a[128:131], a[80:83], v[200:203]
v_mfma_f32_16x16x32_bf16 v[176:179], a[128:131], a[72:75], v[176:179]
v_mfma_f32_16x16x32_bf16 v[176:179], a[132:135], a[76:79], v[176:179]
buffer_load_dwordx4 a[52:55], v2, s[40:43], s33 offen offset:2048 sc1
v_mfma_f32_16x16x32_bf16 v[152:155], a[132:135], a[68:71], v[152:155]
ds_read_b128 a[104:107], v5 offset:15360
v_mfma_f32_16x16x32_bf16 v[152:155], a[128:131], a[64:67], v[152:155]
v_mfma_f32_16x16x32_bf16 v[132:135], a[136:139], a[64:67], v[132:135]
ds_read_b128 a[108:111], v5 offset:21504
v_mfma_f32_16x16x32_bf16 v[132:135], a[140:143], a[68:71], v[132:135]
v_mfma_f32_16x16x32_bf16 v[156:159], a[140:143], a[76:79], v[156:159]
buffer_load_dwordx4 v1, s[4:7], s44 offen offset:2048 sc1 lds
s_add_u32 m0, s18, 0x6000
v_mfma_f32_16x16x32_bf16 v[156:159], a[136:139], a[72:75], v[156:159]
s_add_u32 s44, s50, 0xe2a000
ds_read_b128 a[112:115], v5 offset:16384
v_mfma_f32_16x16x32_bf16 v[180:183], a[136:139], a[80:83], v[180:183]
v_mfma_f32_16x16x32_bf16 v[180:183], a[140:143], a[84:87], v[180:183]
ds_read_b128 a[116:119], v5 offset:22528
v_mfma_f32_16x16x32_bf16 v[204:207], a[140:143], a[92:95], v[204:207]
v_mfma_f32_16x16x32_bf16 v[204:207], a[136:139], a[88:91], v[204:207]
buffer_load_dwordx4 a[56:59], v2, s[40:43], s35 offen offset:3072 sc1
v_mfma_f32_16x16x32_bf16 v[208:211], a[144:147], a[88:91], v[208:211]
v_mfma_f32_16x16x32_bf16 v[208:211], a[148:151], a[92:95], v[208:211]
v_mfma_f32_16x16x32_bf16 v[184:187], a[148:151], a[84:87], v[184:187]
v_mfma_f32_16x16x32_bf16 v[184:187], a[144:147], a[80:83], v[184:187]
v_mfma_f32_16x16x32_bf16 v[160:163], a[144:147], a[72:75], v[160:163]
buffer_load_dwordx4 a[60:63], v2, s[40:43], s33 offen offset:3072 sc1
s_add_u32 s35, s35, 8192
v_mfma_f32_16x16x32_bf16 v[160:163], a[148:151], a[76:79], v[160:163]
s_add_u32 s33, s33, 8192
v_mfma_f32_16x16x32_bf16 v[136:139], a[148:151], a[68:71], v[136:139]
v_mfma_f32_16x16x32_bf16 v[136:139], a[144:147], a[64:67], v[136:139]
s_waitcnt vmcnt(10) lgkmcnt(0)
v_mfma_f32_16x16x32_bf16 v[140:143], a[96:99], a[0:3], v[140:143]
ds_read_b128 a[128:131], v5 offset:17408
v_add_f32 v92, v92, v96
v_mfma_f32_16x16x32_bf16 v[140:143], a[100:103], a[4:7], v[140:143]
buffer_load_dwordx4 a[64:67], v2, s[40:43], s35 offen offset:0 sc1
v_mfma_f32_16x16x32_bf16 v[164:167], a[100:103], a[12:15], v[164:167]
ds_read_b128 a[132:135], v5 offset:23552
v_add_f32 v100, v100, v104
v_mfma_f32_16x16x32_bf16 v[164:167], a[96:99], a[8:11], v[164:167]
v_add_f32 v108, v108, v112
v_add_f32 v116, v116, v120
v_mfma_f32_16x16x32_bf16 v[188:191], a[96:99], a[16:19], v[188:191]
v_add_f32 v93, v93, v97
v_add_f32 v101, v101, v105
v_mfma_f32_16x16x32_bf16 v[188:191], a[100:103], a[20:23], v[188:191]
buffer_load_dwordx4 a[68:71], v2, s[40:43], s33 offen offset:0 sc1
v_mfma_f32_16x16x32_bf16 v[212:215], a[100:103], a[28:31], v[212:215]
ds_read_b128 a[136:139], v5 offset:12288
v_add_f32 v109, v109, v113
v_mfma_f32_16x16x32_bf16 v[212:215], a[96:99], a[24:27], v[212:215]
v_add_f32 v117, v117, v121
v_add_f32 v94, v94, v98
v_mfma_f32_16x16x32_bf16 v[216:219], a[104:107], a[24:27], v[216:219]
ds_read_b128 a[140:143], v5 offset:18432
v_add_f32 v102, v102, v106
v_mfma_f32_16x16x32_bf16 v[216:219], a[108:111], a[28:31], v[216:219]
v_add_f32 v110, v110, v114
v_mfma_f32_16x16x32_bf16 v[192:195], a[108:111], a[20:23], v[192:195]
buffer_load_dwordx4 v1, s[4:7], s44 offen offset:0 sc1 lds
v_mfma_f32_16x16x32_bf16 v[192:195], a[104:107], a[16:19], v[192:195]
ds_read_b128 a[144:147], v5 offset:13312
v_add_f32 v118, v118, v122
v_mfma_f32_16x16x32_bf16 v[168:171], a[104:107], a[8:11], v[168:171]
v_add_f32 v95, v95, v99
v_add_f32 v103, v103, v107
v_mfma_f32_16x16x32_bf16 v[168:171], a[108:111], a[12:15], v[168:171]
ds_read_b128 a[148:151], v5 offset:19456
v_add_f32 v111, v111, v115
v_mfma_f32_16x16x32_bf16 v[144:147], a[108:111], a[4:7], v[144:147]
v_add_f32 v119, v119, v123
v_mfma_f32_16x16x32_bf16 v[144:147], a[104:107], a[0:3], v[144:147]
buffer_load_dwordx4 a[72:75], v2, s[40:43], s35 offen offset:1024 sc1
v_mfma_f32_16x16x32_bf16 v[148:151], a[112:115], a[0:3], v[148:151]
v_add_f32_dpp v92, v92, v92 row_ror:8 row_mask:0xf bank_mask:0xf
v_add_f32_dpp v100, v100, v100 row_ror:8 row_mask:0xf bank_mask:0xf
v_mfma_f32_16x16x32_bf16 v[148:151], a[116:119], a[4:7], v[148:151]
v_add_f32_dpp v108, v108, v108 row_ror:8 row_mask:0xf bank_mask:0xf
v_mfma_f32_16x16x32_bf16 v[172:175], a[116:119], a[12:15], v[172:175]
v_add_f32_dpp v116, v116, v116 row_ror:8 row_mask:0xf bank_mask:0xf
v_mfma_f32_16x16x32_bf16 v[172:175], a[112:115], a[8:11], v[172:175]
v_add_f32_dpp v93, v93, v93 row_ror:8 row_mask:0xf bank_mask:0xf
v_mfma_f32_16x16x32_bf16 v[196:199], a[112:115], a[16:19], v[196:199]
buffer_load_dwordx4 a[76:79], v2, s[40:43], s33 offen offset:1024 sc1
v_mfma_f32_16x16x32_bf16 v[196:199], a[116:119], a[20:23], v[196:199]
v_add_f32_dpp v101, v101, v101 row_ror:8 row_mask:0xf bank_mask:0xf
v_add_f32_dpp v109, v109, v109 row_ror:8 row_mask:0xf bank_mask:0xf
v_mfma_f32_16x16x32_bf16 v[220:223], a[116:119], a[28:31], v[220:223]
v_add_f32_dpp v117, v117, v117 row_ror:8 row_mask:0xf bank_mask:0xf
v_mfma_f32_16x16x32_bf16 v[220:223], a[112:115], a[24:27], v[220:223]
v_add_f32_dpp v92, v94, v94 row_ror:8 row_mask:0xf bank_mask:0xc
s_waitcnt lgkmcnt(0)
v_mfma_f32_16x16x32_bf16 v[224:227], a[128:131], a[24:27], v[224:227]
ds_read_b128 a[96:99], v5 offset:26624
v_add_f32_dpp v100, v102, v102 row_ror:8 row_mask:0xf bank_mask:0xc
v_mfma_f32_16x16x32_bf16 v[224:227], a[132:135], a[28:31], v[224:227]
buffer_load_dwordx4 a[80:83], v2, s[40:43], s35 offen offset:2048 sc1
v_mfma_f32_16x16x32_bf16 v[200:203], a[132:135], a[20:23], v[200:203]
ds_read_b128 a[100:103], v5 offset:32768
v_add_f32_dpp v108, v110, v110 row_ror:8 row_mask:0xf bank_mask:0xc
v_mfma_f32_16x16x32_bf16 v[200:203], a[128:131], a[16:19], v[200:203]
v_add_f32_dpp v116, v118, v118 row_ror:8 row_mask:0xf bank_mask:0xc
v_add_f32_dpp v93, v95, v95 row_ror:8 row_mask:0xf bank_mask:0xc
v_mfma_f32_16x16x32_bf16 v[176:179], a[128:131], a[8:11], v[176:179]
v_add_f32_dpp v101, v103, v103 row_ror:8 row_mask:0xf bank_mask:0xc
v_add_f32_dpp v109, v111, v111 row_ror:8 row_mask:0xf bank_mask:0xc
v_mfma_f32_16x16x32_bf16 v[176:179], a[132:135], a[12:15], v[176:179]
buffer_load_dwordx4 a[84:87], v2, s[40:43], s33 offen offset:2048 sc1
v_mfma_f32_16x16x32_bf16 v[152:155], a[132:135], a[4:7], v[152:155]
ds_read_b128 a[104:107], v5 offset:27648
v_add_f32_dpp v117, v119, v119 row_ror:8 row_mask:0xf bank_mask:0xc
v_mfma_f32_16x16x32_bf16 v[152:155], a[128:131], a[0:3], v[152:155]
v_permlane32_swap_b32 v92, v93
v_mfma_f32_16x16x32_bf16 v[132:135], a[136:139], a[0:3], v[132:135]
ds_read_b128 a[108:111], v5 offset:33792
v_mfma_f32_16x16x32_bf16 v[132:135], a[140:143], a[4:7], v[132:135]
v_permlane32_swap_b32 v100, v101
v_mfma_f32_16x16x32_bf16 v[156:159], a[140:143], a[12:15], v[156:159]
buffer_load_dwordx4 v1, s[4:7], s44 offen offset:1024 sc1 lds
v_mfma_f32_16x16x32_bf16 v[156:159], a[136:139], a[8:11], v[156:159]
ds_read_b128 a[112:115], v5 offset:28672
v_mfma_f32_16x16x32_bf16 v[180:183], a[136:139], a[16:19], v[180:183]
v_permlane32_swap_b32 v108, v109
v_mfma_f32_16x16x32_bf16 v[180:183], a[140:143], a[20:23], v[180:183]
ds_read_b128 a[116:119], v5 offset:34816
v_mfma_f32_16x16x32_bf16 v[204:207], a[140:143], a[28:31], v[204:207]
v_permlane32_swap_b32 v116, v117
v_mfma_f32_16x16x32_bf16 v[204:207], a[136:139], a[24:27], v[204:207]
buffer_load_dwordx4 a[88:91], v2, s[40:43], s35 offen offset:3072 sc1
v_mfma_f32_16x16x32_bf16 v[208:211], a[144:147], a[24:27], v[208:211]
v_add_f32 v92, v92, v93
v_add_f32 v100, v100, v101
v_mfma_f32_16x16x32_bf16 v[208:211], a[148:151], a[28:31], v[208:211]
v_add_f32 v108, v108, v109
v_add_f32 v116, v116, v117
v_mfma_f32_16x16x32_bf16 v[184:187], a[148:151], a[20:23], v[184:187]
v_mov_b32 v94, v92
v_mfma_f32_16x16x32_bf16 v[184:187], a[144:147], a[16:19], v[184:187]
v_mov_b32 v102, v100
v_mfma_f32_16x16x32_bf16 v[160:163], a[144:147], a[8:11], v[160:163]
buffer_load_dwordx4 a[92:95], v2, s[40:43], s33 offen offset:3072 sc1
s_add_u32 s35, s35, 8192
v_mfma_f32_16x16x32_bf16 v[160:163], a[148:151], a[12:15], v[160:163]
s_add_u32 s33, s33, 8192
v_mov_b32 v110, v108
v_mfma_f32_16x16x32_bf16 v[136:139], a[148:151], a[4:7], v[136:139]
v_mov_b32 v118, v116
v_mfma_f32_16x16x32_bf16 v[136:139], a[144:147], a[0:3], v[136:139]
s_waitcnt vmcnt(10) lgkmcnt(0)
v_mfma_f32_16x16x32_bf16 v[140:143], a[96:99], a[32:35], v[140:143]
ds_read_b128 a[128:131], v5 offset:29696
v_mfma_f32_16x16x32_bf16 v[140:143], a[100:103], a[36:39], v[140:143]
buffer_load_dwordx4 a[0:3], v2, s[40:43], s35 offen offset:0 sc1
v_mfma_f32_16x16x32_bf16 v[164:167], a[100:103], a[44:47], v[164:167]
ds_read_b128 a[132:135], v5 offset:35840
v_mfma_f32_16x16x32_bf16 v[164:167], a[96:99], a[40:43], v[164:167]
v_permlane16_swap_b32 v92, v94
v_mfma_f32_16x16x32_bf16 v[188:191], a[96:99], a[48:51], v[188:191]
v_permlane16_swap_b32 v100, v102
v_mfma_f32_16x16x32_bf16 v[188:191], a[100:103], a[52:55], v[188:191]
buffer_load_dwordx4 a[4:7], v2, s[40:43], s33 offen offset:0 sc1
v_mfma_f32_16x16x32_bf16 v[212:215], a[100:103], a[60:63], v[212:215]
ds_read_b128 a[136:139], v5 offset:24576
v_mfma_f32_16x16x32_bf16 v[212:215], a[96:99], a[56:59], v[212:215]
v_permlane16_swap_b32 v108, v110
v_mfma_f32_16x16x32_bf16 v[216:219], a[104:107], a[56:59], v[216:219]
ds_read_b128 a[140:143], v5 offset:30720
v_mfma_f32_16x16x32_bf16 v[216:219], a[108:111], a[60:63], v[216:219]
v_permlane16_swap_b32 v116, v118
v_mfma_f32_16x16x32_bf16 v[192:195], a[108:111], a[52:55], v[192:195]
buffer_load_dwordx4 v1, s[4:7], s44 offen offset:2048 sc1 lds
s_add_u32 m0, s18, 0x9000
v_mfma_f32_16x16x32_bf16 v[192:195], a[104:107], a[48:51], v[192:195]
s_add_u32 s44, s50, 0xe2d000
ds_read_b128 a[144:147], v5 offset:25600
v_mfma_f32_16x16x32_bf16 v[168:171], a[104:107], a[40:43], v[168:171]
v_add_f32 v92, v92, v94
v_add_f32 v100, v100, v102
v_mfma_f32_16x16x32_bf16 v[168:171], a[108:111], a[44:47], v[168:171]
ds_read_b128 a[148:151], v5 offset:31744
v_add_f32 v108, v108, v110
v_mfma_f32_16x16x32_bf16 v[144:147], a[108:111], a[36:39], v[144:147]
v_add_f32 v116, v116, v118
v_mov_b32 v94, v92
v_mfma_f32_16x16x32_bf16 v[144:147], a[104:107], a[32:35], v[144:147]
buffer_load_dwordx4 a[8:11], v2, s[40:43], s35 offen offset:1024 sc1
v_mfma_f32_16x16x32_bf16 v[148:151], a[112:115], a[32:35], v[148:151]
v_mov_b32 v102, v100
v_mov_b32 v110, v108
v_mfma_f32_16x16x32_bf16 v[148:151], a[116:119], a[36:39], v[148:151]
v_mov_b32 v118, v116
v_mfma_f32_16x16x32_bf16 v[172:175], a[116:119], a[44:47], v[172:175]
v_permlane32_swap_b32 v92, v94
v_mfma_f32_16x16x32_bf16 v[172:175], a[112:115], a[40:43], v[172:175]
v_permlane32_swap_b32 v100, v102
v_mfma_f32_16x16x32_bf16 v[196:199], a[112:115], a[48:51], v[196:199]
buffer_load_dwordx4 a[12:15], v2, s[40:43], s33 offen offset:1024 sc1
v_mfma_f32_16x16x32_bf16 v[196:199], a[116:119], a[52:55], v[196:199]
v_permlane32_swap_b32 v108, v110
v_mfma_f32_16x16x32_bf16 v[220:223], a[116:119], a[60:63], v[220:223]
v_permlane32_swap_b32 v116, v118
v_mfma_f32_16x16x32_bf16 v[220:223], a[112:115], a[56:59], v[220:223]
v_mul_f32 v82, 0xba800000, v92
s_waitcnt lgkmcnt(0)
v_mfma_f32_16x16x32_bf16 v[224:227], a[128:131], a[56:59], v[224:227]
ds_read_b128 a[96:99], v5 offset:38912
v_mul_f32 v84, 0xba800000, v100
v_mfma_f32_16x16x32_bf16 v[224:227], a[132:135], a[60:63], v[224:227]
buffer_load_dwordx4 a[16:19], v2, s[40:43], s35 offen offset:2048 sc1
v_mfma_f32_16x16x32_bf16 v[200:203], a[132:135], a[52:55], v[200:203]
ds_read_b128 a[100:103], v5 offset:45056
v_mul_f32 v86, 0xba800000, v108
v_mfma_f32_16x16x32_bf16 v[200:203], a[128:131], a[48:51], v[200:203]
v_mul_f32 v88, 0xba800000, v116
v_mul_f32 v94, 0x3a800000, v94
v_mfma_f32_16x16x32_bf16 v[176:179], a[128:131], a[40:43], v[176:179]
v_mul_f32 v102, 0x3a800000, v102
v_mul_f32 v110, 0x3a800000, v110
v_mfma_f32_16x16x32_bf16 v[176:179], a[132:135], a[44:47], v[176:179]
buffer_load_dwordx4 v1, s[4:7], s44 offen offset:0 sc1 lds
v_mfma_f32_16x16x32_bf16 v[152:155], a[132:135], a[36:39], v[152:155]
ds_read_b128 a[104:107], v5 offset:39936
v_mul_f32 v118, 0x3a800000, v118
v_mfma_f32_16x16x32_bf16 v[152:155], a[128:131], a[32:35], v[152:155]
v_fma_f32 v94, -v82, v82, v94
v_fma_f32 v102, -v84, v84, v102
v_mfma_f32_16x16x32_bf16 v[132:135], a[136:139], a[32:35], v[132:135]
ds_read_b128 a[108:111], v5 offset:46080
v_fma_f32 v110, -v86, v86, v110
v_mfma_f32_16x16x32_bf16 v[132:135], a[140:143], a[36:39], v[132:135]
buffer_load_dwordx4 a[20:23], v2, s[40:43], s33 offen offset:2048 sc1
v_mfma_f32_16x16x32_bf16 v[156:159], a[140:143], a[44:47], v[156:159]
ds_read_b128 a[112:115], v5 offset:40960
v_fma_f32 v118, -v88, v88, v118
v_mfma_f32_16x16x32_bf16 v[156:159], a[136:139], a[40:43], v[156:159]
v_max_f32 v94, 0, v94
v_max_f32 v102, 0, v102
v_mfma_f32_16x16x32_bf16 v[180:183], a[136:139], a[48:51], v[180:183]
v_max_f32 v110, 0, v110
v_max_f32 v118, 0, v118
v_mfma_f32_16x16x32_bf16 v[180:183], a[140:143], a[52:55], v[180:183]
buffer_load_dwordx4 a[24:27], v2, s[40:43], s35 offen offset:3072 sc1
v_mfma_f32_16x16x32_bf16 v[204:207], a[140:143], a[60:63], v[204:207]
ds_read_b128 a[116:119], v5 offset:47104
v_add_f32 v94, 0x3727c5ac, v94
v_mfma_f32_16x16x32_bf16 v[204:207], a[136:139], a[56:59], v[204:207]
v_add_f32 v102, 0x3727c5ac, v102
v_add_f32 v110, 0x3727c5ac, v110
v_mfma_f32_16x16x32_bf16 v[208:211], a[144:147], a[56:59], v[208:211]
v_add_f32 v118, 0x3727c5ac, v118
v_mfma_f32_16x16x32_bf16 v[208:211], a[148:151], a[60:63], v[208:211]
buffer_load_dwordx4 v1, s[4:7], s44 offen offset:1024 sc1 lds
v_mfma_f32_16x16x32_bf16 v[184:187], a[148:151], a[52:55], v[184:187]
v_rsq_f32 v83, v94
v_mfma_f32_16x16x32_bf16 v[184:187], a[144:147], a[48:51], v[184:187]
v_rsq_f32 v85, v102
v_mfma_f32_16x16x32_bf16 v[160:163], a[144:147], a[40:43], v[160:163]
v_rsq_f32 v87, v110
v_mfma_f32_16x16x32_bf16 v[160:163], a[148:151], a[44:47], v[160:163]
buffer_load_dwordx4 a[28:31], v2, s[40:43], s33 offen offset:3072 sc1
s_add_u32 s35, s35, 8192
v_mfma_f32_16x16x32_bf16 v[136:139], a[148:151], a[36:39], v[136:139]
s_add_u32 s33, s33, 8192
v_mfma_f32_16x16x32_bf16 v[136:139], a[144:147], a[32:35], v[136:139]
s_waitcnt vmcnt(11) lgkmcnt(0)
v_mfma_f32_16x16x32_bf16 v[140:143], a[96:99], a[64:67], v[140:143]
ds_read_b128 a[128:131], v5 offset:41984
v_mfma_f32_16x16x32_bf16 v[140:143], a[100:103], a[68:71], v[140:143]
buffer_load_dwordx4 a[32:35], v2, s[40:43], s35 offen offset:0 sc1
v_mfma_f32_16x16x32_bf16 v[164:167], a[100:103], a[76:79], v[164:167]
ds_read_b128 a[132:135], v5 offset:48128
v_mfma_f32_16x16x32_bf16 v[164:167], a[96:99], a[72:75], v[164:167]
v_rsq_f32 v89, v118
v_mfma_f32_16x16x32_bf16 v[188:191], a[96:99], a[80:83], v[188:191]
v_mfma_f32_16x16x32_bf16 v[188:191], a[100:103], a[84:87], v[188:191]
buffer_load_dwordx4 a[36:39], v2, s[40:43], s33 offen offset:0 sc1
v_mfma_f32_16x16x32_bf16 v[212:215], a[100:103], a[92:95], v[212:215]
ds_read_b128 a[136:139], v5 offset:36864
v_mfma_f32_16x16x32_bf16 v[212:215], a[96:99], a[88:91], v[212:215]
v_mfma_f32_16x16x32_bf16 v[216:219], a[104:107], a[88:91], v[216:219]
ds_read_b128 a[140:143], v5 offset:43008
v_mfma_f32_16x16x32_bf16 v[216:219], a[108:111], a[92:95], v[216:219]
v_mfma_f32_16x16x32_bf16 v[192:195], a[108:111], a[84:87], v[192:195]
buffer_load_dwordx4 v1, s[4:7], s44 offen offset:2048 sc1 lds
s_add_u32 m0, s19, 49152
v_mfma_f32_16x16x32_bf16 v[192:195], a[104:107], a[80:83], v[192:195]
s_add_u32 s44, s85, 0xa04000
ds_read_b128 a[144:147], v5 offset:37888
v_mfma_f32_16x16x32_bf16 v[168:171], a[104:107], a[72:75], v[168:171]
v_fmac_f32 v140, v56, v82
v_fmac_f32 v164, v56, v84
v_mfma_f32_16x16x32_bf16 v[168:171], a[108:111], a[76:79], v[168:171]
ds_read_b128 a[148:151], v5 offset:44032
v_mfma_f32_16x16x32_bf16 v[144:147], a[108:111], a[68:71], v[144:147]
v_fmac_f32 v188, v56, v86
v_mfma_f32_16x16x32_bf16 v[144:147], a[104:107], a[64:67], v[144:147]
buffer_load_dwordx4 a[40:43], v2, s[40:43], s35 offen offset:1024 sc1
v_mfma_f32_16x16x32_bf16 v[148:151], a[112:115], a[64:67], v[148:151]
v_fmac_f32 v212, v56, v88
v_mfma_f32_16x16x32_bf16 v[148:151], a[116:119], a[68:71], v[148:151]
v_mfma_f32_16x16x32_bf16 v[172:175], a[116:119], a[76:79], v[172:175]
v_fmac_f32 v216, v60, v88
v_mfma_f32_16x16x32_bf16 v[172:175], a[112:115], a[72:75], v[172:175]
v_mfma_f32_16x16x32_bf16 v[196:199], a[112:115], a[80:83], v[196:199]
buffer_load_dwordx4 a[44:47], v2, s[40:43], s33 offen offset:1024 sc1
v_mfma_f32_16x16x32_bf16 v[196:199], a[116:119], a[84:87], v[196:199]
v_fmac_f32 v192, v60, v86
v_mfma_f32_16x16x32_bf16 v[220:223], a[116:119], a[92:95], v[220:223]
v_fmac_f32 v168, v60, v84
v_fmac_f32 v141, v57, v82
v_mfma_f32_16x16x32_bf16 v[220:223], a[112:115], a[88:91], v[220:223]
s_waitcnt lgkmcnt(0)
s_barrier
v_mfma_f32_16x16x32_bf16 v[224:227], a[128:131], a[88:91], v[224:227]
v_add_u32 v5, 0, v1
v_fmac_f32 v144, v60, v82
v_mfma_f32_16x16x32_bf16 v[224:227], a[132:135], a[92:95], v[224:227]
buffer_load_dwordx4 a[48:51], v2, s[40:43], s35 offen offset:2048 sc1
v_mfma_f32_16x16x32_bf16 v[200:203], a[132:135], a[84:87], v[200:203]
ds_read_b128 a[96:99], v5 offset:2048
v_fmac_f32 v148, v64, v82
v_mfma_f32_16x16x32_bf16 v[200:203], a[128:131], a[80:83], v[200:203]
ds_read_b128 a[100:103], v5 offset:8192
v_fmac_f32 v165, v57, v84
v_mfma_f32_16x16x32_bf16 v[176:179], a[128:131], a[72:75], v[176:179]
v_fmac_f32 v172, v64, v84
v_fmac_f32 v189, v57, v86
v_mfma_f32_16x16x32_bf16 v[176:179], a[132:135], a[76:79], v[176:179]
buffer_load_dwordx4 a[52:55], v2, s[40:43], s33 offen offset:2048 sc1
v_mfma_f32_16x16x32_bf16 v[152:155], a[132:135], a[68:71], v[152:155]
ds_read_b128 a[104:107], v5 offset:3072
v_fmac_f32 v196, v64, v86
v_mfma_f32_16x16x32_bf16 v[152:155], a[128:131], a[64:67], v[152:155]
v_fmac_f32 v213, v57, v88
v_fmac_f32 v217, v61, v88
v_mfma_f32_16x16x32_bf16 v[132:135], a[136:139], a[64:67], v[132:135]
ds_read_b128 a[108:111], v5 offset:9216
v_fmac_f32 v220, v64, v88
v_mfma_f32_16x16x32_bf16 v[132:135], a[140:143], a[68:71], v[132:135]
v_fmac_f32 v193, v61, v86
v_mfma_f32_16x16x32_bf16 v[156:159], a[140:143], a[76:79], v[156:159]
buffer_load_dwordx4 v1, s[4:7], s44 offen offset:0 sc1 lds
v_mfma_f32_16x16x32_bf16 v[156:159], a[136:139], a[72:75], v[156:159]
ds_read_b128 a[112:115], v5 offset:4096
v_fmac_f32 v224, v68, v88
v_mfma_f32_16x16x32_bf16 v[180:183], a[136:139], a[80:83], v[180:183]
v_fmac_f32 v200, v68, v86
v_fmac_f32 v169, v61, v84
v_mfma_f32_16x16x32_bf16 v[180:183], a[140:143], a[84:87], v[180:183]
ds_read_b128 a[116:119], v5 offset:10240
v_fmac_f32 v145, v61, v82
v_mfma_f32_16x16x32_bf16 v[204:207], a[140:143], a[92:95], v[204:207]
v_fmac_f32 v176, v68, v84
v_fmac_f32 v149, v65, v82
v_mfma_f32_16x16x32_bf16 v[204:207], a[136:139], a[88:91], v[204:207]
buffer_load_dwordx4 a[56:59], v2, s[40:43], s35 offen offset:3072 sc1
v_mfma_f32_16x16x32_bf16 v[208:211], a[144:147], a[88:91], v[208:211]
v_fmac_f32 v152, v68, v82
v_fmac_f32 v173, v65, v84
v_mfma_f32_16x16x32_bf16 v[208:211], a[148:151], a[92:95], v[208:211]
v_mfma_f32_16x16x32_bf16 v[184:187], a[148:151], a[84:87], v[184:187]
v_fmac_f32 v132, v48, v82
v_fmac_f32 v197, v65, v86
v_mfma_f32_16x16x32_bf16 v[184:187], a[144:147], a[80:83], v[184:187]
v_mfma_f32_16x16x32_bf16 v[160:163], a[144:147], a[72:75], v[160:163]
buffer_load_dwordx4 a[60:63], v2, s[40:43], s33 offen offset:3072 sc1
s_add_u32 s35, s35, 8192
v_mfma_f32_16x16x32_bf16 v[160:163], a[148:151], a[76:79], v[160:163]
s_add_u32 s33, s33, 8192
v_fmac_f32 v156, v48, v84
v_mfma_f32_16x16x32_bf16 v[136:139], a[148:151], a[68:71], v[136:139]
v_fmac_f32 v180, v48, v86
v_fmac_f32 v221, v65, v88
v_mfma_f32_16x16x32_bf16 v[136:139], a[144:147], a[64:67], v[136:139]
v_fmac_f32 v225, v69, v88
s_waitcnt vmcnt(10) lgkmcnt(0)
v_mfma_f32_16x16x32_bf16 v[140:143], a[96:99], a[0:3], v[140:143]
ds_read_b128 a[128:131], v5 offset:5120
v_fmac_f32 v204, v48, v88
v_mfma_f32_16x16x32_bf16 v[140:143], a[100:103], a[4:7], v[140:143]
buffer_load_dwordx4 a[64:67], v2, s[40:43], s35 offen offset:0 sc1
s_lshl_b32 s37, s28, 10
v_mfma_f32_16x16x32_bf16 v[164:167], a[100:103], a[12:15], v[164:167]
ds_read_b128 a[132:135], v5 offset:11264
v_fmac_f32 v208, v52, v88
v_mfma_f32_16x16x32_bf16 v[164:167], a[96:99], a[8:11], v[164:167]
v_fmac_f32 v201, v69, v86
v_fmac_f32 v177, v69, v84
v_mfma_f32_16x16x32_bf16 v[188:191], a[96:99], a[16:19], v[188:191]
v_fmac_f32 v184, v52, v86
v_fmac_f32 v153, v69, v82
v_mfma_f32_16x16x32_bf16 v[188:191], a[100:103], a[20:23], v[188:191]
buffer_load_dwordx4 a[68:71], v2, s[40:43], s33 offen offset:0 sc1
s_lshl_b32 s72, s30, 12
v_mfma_f32_16x16x32_bf16 v[212:215], a[100:103], a[28:31], v[212:215]
ds_read_b128 a[136:139], v5 offset:0
v_fmac_f32 v160, v52, v84
v_mfma_f32_16x16x32_bf16 v[212:215], a[96:99], a[24:27], v[212:215]
v_fmac_f32 v133, v49, v82
s_add_u32 s72, s72, 0x1e00000
v_mfma_f32_16x16x32_bf16 v[216:219], a[104:107], a[24:27], v[216:219]
ds_read_b128 a[140:143], v5 offset:6144
v_fmac_f32 v136, v52, v82
v_mfma_f32_16x16x32_bf16 v[216:219], a[108:111], a[28:31], v[216:219]
buffer_load_dwordx4 a[72:75], v2, s[40:43], s35 offen offset:1024 sc1
s_add_u32 s63, s83, 0x980000
v_mfma_f32_16x16x32_bf16 v[192:195], a[108:111], a[20:23], v[192:195]
ds_read_b128 a[144:147], v5 offset:1024
v_fmac_f32 v157, v49, v84
v_mfma_f32_16x16x32_bf16 v[192:195], a[104:107], a[16:19], v[192:195]
v_fmac_f32 v181, v49, v86
v_fmac_f32 v142, v58, v82
v_mfma_f32_16x16x32_bf16 v[168:171], a[104:107], a[8:11], v[168:171]
v_fmac_f32 v205, v49, v88
v_fmac_f32 v166, v58, v84
v_mfma_f32_16x16x32_bf16 v[168:171], a[108:111], a[12:15], v[168:171]
buffer_load_dwordx4 a[76:79], v2, s[40:43], s33 offen offset:1024 sc1
s_sub_u32 s55, s63, 0x10000
v_mfma_f32_16x16x32_bf16 v[144:147], a[108:111], a[4:7], v[144:147]
ds_read_b128 a[148:151], v5 offset:7168
v_fmac_f32 v209, v53, v88
v_mfma_f32_16x16x32_bf16 v[144:147], a[104:107], a[0:3], v[144:147]
v_fmac_f32 v190, v58, v86
v_add_u32 v233, s37, v1
v_mfma_f32_16x16x32_bf16 v[148:151], a[112:115], a[0:3], v[148:151]
v_fmac_f32 v185, v53, v86
v_fmac_f32 v214, v58, v88
v_mfma_f32_16x16x32_bf16 v[148:151], a[116:119], a[4:7], v[148:151]
buffer_load_dwordx4 a[80:83], v2, s[40:43], s35 offen offset:2048 sc1
v_mfma_f32_16x16x32_bf16 v[172:175], a[116:119], a[12:15], v[172:175]
v_fmac_f32 v161, v53, v84
v_fmac_f32 v218, v62, v88
v_mfma_f32_16x16x32_bf16 v[172:175], a[112:115], a[8:11], v[172:175]
v_add_u32 v232, s19, v7
v_add_u32 v248, s19, v8
v_mfma_f32_16x16x32_bf16 v[196:199], a[112:115], a[16:19], v[196:199]
v_fmac_f32 v137, v53, v82
v_fmac_f32 v194, v62, v86
v_mfma_f32_16x16x32_bf16 v[196:199], a[116:119], a[20:23], v[196:199]
buffer_load_dwordx4 a[84:87], v2, s[40:43], s33 offen offset:2048 sc1
v_mfma_f32_16x16x32_bf16 v[220:223], a[116:119], a[28:31], v[220:223]
v_fmac_f32 v170, v62, v84
v_fmac_f32 v143, v59, v82
v_mfma_f32_16x16x32_bf16 v[220:223], a[112:115], a[24:27], v[220:223]
s_waitcnt lgkmcnt(0)
v_mfma_f32_16x16x32_bf16 v[224:227], a[128:131], a[24:27], v[224:227]
ds_read_b128 a[96:99], v5 offset:14336
v_fmac_f32 v146, v62, v82
v_mfma_f32_16x16x32_bf16 v[224:227], a[132:135], a[28:31], v[224:227]
buffer_load_dwordx4 a[88:91], v2, s[40:43], s35 offen offset:3072 sc1
v_mfma_f32_16x16x32_bf16 v[200:203], a[132:135], a[20:23], v[200:203]
ds_read_b128 a[100:103], v5 offset:20480
v_fmac_f32 v150, v66, v82
v_mfma_f32_16x16x32_bf16 v[200:203], a[128:131], a[16:19], v[200:203]
v_fmac_f32 v167, v59, v84
v_fmac_f32 v191, v59, v86
v_mfma_f32_16x16x32_bf16 v[176:179], a[128:131], a[8:11], v[176:179]
v_fmac_f32 v174, v66, v84
v_fmac_f32 v215, v59, v88
v_mfma_f32_16x16x32_bf16 v[176:179], a[132:135], a[12:15], v[176:179]
ds_read_b128 a[104:107], v5 offset:15360
v_mfma_f32_16x16x32_bf16 v[152:155], a[132:135], a[4:7], v[152:155]
v_fmac_f32 v198, v66, v86
v_fmac_f32 v219, v63, v88
v_mfma_f32_16x16x32_bf16 v[152:155], a[128:131], a[0:3], v[152:155]
buffer_load_dwordx4 v1, s[4:7], s44 offen offset:1024 sc1 lds
v_mfma_f32_16x16x32_bf16 v[132:135], a[136:139], a[0:3], v[132:135]
ds_read_b128 a[108:111], v5 offset:21504
v_fmac_f32 v222, v66, v88
v_mfma_f32_16x16x32_bf16 v[132:135], a[140:143], a[4:7], v[132:135]
v_fmac_f32 v195, v63, v86
v_mfma_f32_16x16x32_bf16 v[156:159], a[140:143], a[12:15], v[156:159]
ds_read_b128 a[112:115], v5 offset:16384
v_fmac_f32 v226, v70, v88
v_mfma_f32_16x16x32_bf16 v[156:159], a[136:139], a[8:11], v[156:159]
v_fmac_f32 v171, v63, v84
v_mfma_f32_16x16x32_bf16 v[180:183], a[136:139], a[16:19], v[180:183]
v_fmac_f32 v202, v70, v86
v_fmac_f32 v147, v63, v82
v_mfma_f32_16x16x32_bf16 v[180:183], a[140:143], a[20:23], v[180:183]
buffer_load_dwordx4 a[92:95], v2, s[40:43], s33 offen offset:3072 sc1
s_add_u32 s35, s35, 8192
v_mfma_f32_16x16x32_bf16 v[204:207], a[140:143], a[28:31], v[204:207]
s_add_u32 s33, s33, 8192
ds_read_b128 a[116:119], v5 offset:22528
v_mfma_f32_16x16x32_bf16 v[204:207], a[136:139], a[24:27], v[204:207]
v_fmac_f32 v178, v70, v84
v_fmac_f32 v151, v67, v82
v_mfma_f32_16x16x32_bf16 v[208:211], a[144:147], a[24:27], v[208:211]
v_fmac_f32 v154, v70, v82
v_fmac_f32 v175, v67, v84
v_mfma_f32_16x16x32_bf16 v[208:211], a[148:151], a[28:31], v[208:211]
v_mfma_f32_16x16x32_bf16 v[184:187], a[148:151], a[20:23], v[184:187]
v_fmac_f32 v134, v50, v82
v_fmac_f32 v199, v67, v86
v_mfma_f32_16x16x32_bf16 v[184:187], a[144:147], a[16:19], v[184:187]
buffer_load_dwordx4 v1, s[4:7], s44 offen offset:2048 sc1 lds
v_mfma_f32_16x16x32_bf16 v[160:163], a[144:147], a[8:11], v[160:163]
v_fmac_f32 v158, v50, v84
v_fmac_f32 v223, v67, v88
v_mfma_f32_16x16x32_bf16 v[160:163], a[148:151], a[12:15], v[160:163]
v_mfma_f32_16x16x32_bf16 v[136:139], a[148:151], a[4:7], v[136:139]
v_fmac_f32 v182, v50, v86
v_fmac_f32 v227, v71, v88
v_mfma_f32_16x16x32_bf16 v[136:139], a[144:147], a[0:3], v[136:139]
s_waitcnt vmcnt(10) lgkmcnt(0)
s_barrier
v_mfma_f32_16x16x32_bf16 v[140:143], a[96:99], a[32:35], v[140:143]
ds_read_b128 a[128:131], v5 offset:17408
v_fmac_f32 v206, v50, v88
v_mfma_f32_16x16x32_bf16 v[140:143], a[100:103], a[36:39], v[140:143]
buffer_load_dwordx4 a[0:3], v2, s[40:43], s35 offen offset:0 sc1
v_mfma_f32_16x16x32_bf16 v[164:167], a[100:103], a[44:47], v[164:167]
ds_read_b128 a[132:135], v5 offset:23552
v_fmac_f32 v210, v54, v88
v_mfma_f32_16x16x32_bf16 v[164:167], a[96:99], a[40:43], v[164:167]
v_fmac_f32 v203, v71, v86
v_fmac_f32 v179, v71, v84
v_mfma_f32_16x16x32_bf16 v[188:191], a[96:99], a[48:51], v[188:191]
buffer_load_dwordx4 a[4:7], v2, s[40:43], s33 offen offset:0 sc1
v_mfma_f32_16x16x32_bf16 v[188:191], a[100:103], a[52:55], v[188:191]
ds_read_b128 a[136:139], v5 offset:26624
v_fmac_f32 v186, v54, v86
v_mfma_f32_16x16x32_bf16 v[212:215], a[100:103], a[60:63], v[212:215]
v_fmac_f32 v162, v54, v84
v_fmac_f32 v155, v71, v82
v_mfma_f32_16x16x32_bf16 v[212:215], a[96:99], a[56:59], v[212:215]
buffer_load_dwordx4 a[8:11], v2, s[40:43], s35 offen offset:1024 sc1
v_mfma_f32_16x16x32_bf16 v[216:219], a[104:107], a[56:59], v[216:219]
ds_read_b128 a[140:143], v5 offset:32768
v_fmac_f32 v138, v54, v82
v_mfma_f32_16x16x32_bf16 v[216:219], a[108:111], a[60:63], v[216:219]
L_stub12:
s_cbranch_execz L_wret4
v_fmac_f32 v135, v51, v82
v_fmac_f32 v159, v51, v84
v_mfma_f32_16x16x32_bf16 v[192:195], a[108:111], a[52:55], v[192:195]
buffer_load_dwordx4 a[12:15], v2, s[40:43], s33 offen offset:1024 sc1
v_mfma_f32_16x16x32_bf16 v[192:195], a[104:107], a[48:51], v[192:195]
ds_read_b128 a[144:147], v5 offset:27648
v_fmac_f32 v183, v51, v86
v_mfma_f32_16x16x32_bf16 v[168:171], a[104:107], a[40:43], v[168:171]
v_fmac_f32 v207, v51, v88
v_mfma_f32_16x16x32_bf16 v[168:171], a[108:111], a[44:47], v[168:171]
buffer_load_dwordx4 a[16:19], v2, s[40:43], s35 offen offset:2048 sc1
v_mfma_f32_16x16x32_bf16 v[144:147], a[108:111], a[36:39], v[144:147]
ds_read_b128 a[148:151], v5 offset:33792
v_fmac_f32 v211, v55, v88
v_mfma_f32_16x16x32_bf16 v[144:147], a[104:107], a[32:35], v[144:147]
v_mul_f32 v88, 0x3e8293ee, v89
v_mfma_f32_16x16x32_bf16 v[148:151], a[112:115], a[32:35], v[148:151]
buffer_load_dwordx4 a[20:23], v2, s[40:43], s33 offen offset:2048 sc1
v_mfma_f32_16x16x32_bf16 v[148:151], a[116:119], a[36:39], v[148:151]
v_fmac_f32 v187, v55, v86
v_mfma_f32_16x16x32_bf16 v[172:175], a[116:119], a[44:47], v[172:175]
v_fmac_f32 v163, v55, v84
v_mul_f32 v86, 0x3e8293ee, v87
v_mfma_f32_16x16x32_bf16 v[172:175], a[112:115], a[40:43], v[172:175]
buffer_load_dwordx4 a[24:27], v2, s[40:43], s35 offen offset:3072 sc1
v_mfma_f32_16x16x32_bf16 v[196:199], a[112:115], a[48:51], v[196:199]
v_fmac_f32 v139, v55, v82
v_mul_f32 v84, 0x3e8293ee, v85
v_mfma_f32_16x16x32_bf16 v[196:199], a[116:119], a[52:55], v[196:199]
v_mul_f32 v82, 0x3e8293ee, v83
v_mfma_f32_16x16x32_bf16 v[220:223], a[116:119], a[60:63], v[220:223]
buffer_load_dwordx4 a[28:31], v2, s[40:43], s33 offen offset:3072 sc1
s_add_u32 s35, s35, 8192
v_mfma_f32_16x16x32_bf16 v[220:223], a[112:115], a[56:59], v[220:223]
s_add_u32 s33, s33, 8192
s_waitcnt lgkmcnt(0)
v_mfma_f32_16x16x32_bf16 v[224:227], a[128:131], a[56:59], v[224:227]
ds_read_b128 a[96:99], v5 offset:28672
v_mfma_f32_16x16x32_bf16 v[224:227], a[132:135], a[60:63], v[224:227]
buffer_load_dwordx4 v1, s[4:7], s44 offen offset:3072 sc1 lds
s_add_u32 m0, s19, 65536
v_mfma_f32_16x16x32_bf16 v[200:203], a[132:135], a[52:55], v[200:203]
s_add_u32 s44, s84, 0xa08000
ds_read_b128 a[100:103], v5 offset:34816
v_mfma_f32_16x16x32_bf16 v[200:203], a[128:131], a[48:51], v[200:203]
v_mfma_f32_16x16x32_bf16 v[176:179], a[128:131], a[40:43], v[176:179]
v_mfma_f32_16x16x32_bf16 v[176:179], a[132:135], a[44:47], v[176:179]
ds_read_b128 a[104:107], v5 offset:29696
v_mfma_f32_16x16x32_bf16 v[152:155], a[132:135], a[36:39], v[152:155]
v_mfma_f32_16x16x32_bf16 v[152:155], a[128:131], a[32:35], v[152:155]
s_waitcnt vmcnt(18)
v_mfma_f32_16x16x32_bf16 v[140:143], a[136:139], a[64:67], v[140:143]
ds_read_b128 a[108:111], v5 offset:35840
s_waitcnt vmcnt(17)
v_mfma_f32_16x16x32_bf16 v[140:143], a[140:143], a[68:71], v[140:143]
s_waitcnt vmcnt(15)
v_mfma_f32_16x16x32_bf16 v[164:167], a[140:143], a[76:79], v[164:167]
ds_read_b128 a[112:115], v5 offset:38912
v_mfma_f32_16x16x32_bf16 v[164:167], a[136:139], a[72:75], v[164:167]
s_waitcnt vmcnt(14)
v_mfma_f32_16x16x32_bf16 v[188:191], a[136:139], a[80:83], v[188:191]
s_waitcnt vmcnt(13)
v_mfma_f32_16x16x32_bf16 v[188:191], a[140:143], a[84:87], v[188:191]
buffer_load_dwordx4 v1, s[4:7], s44 offen offset:0 sc1 lds
s_waitcnt vmcnt(11)
v_mfma_f32_16x16x32_bf16 v[212:215], a[140:143], a[92:95], v[212:215]
ds_read_b128 a[116:119], v5 offset:45056
v_mfma_f32_16x16x32_bf16 v[212:215], a[136:139], a[88:91], v[212:215]
v_mfma_f32_16x16x32_bf16 v[216:219], a[144:147], a[88:91], v[216:219]
v_mfma_f32_16x16x32_bf16 v[216:219], a[148:151], a[92:95], v[216:219]
v_mfma_f32_16x16x32_bf16 v[192:195], a[148:151], a[84:87], v[192:195]
v_mfma_f32_16x16x32_bf16 v[192:195], a[144:147], a[80:83], v[192:195]
v_mfma_f32_16x16x32_bf16 v[168:171], a[144:147], a[72:75], v[168:171]
v_mfma_f32_16x16x32_bf16 v[168:171], a[148:151], a[76:79], v[168:171]
v_mfma_f32_16x16x32_bf16 v[144:147], a[148:151], a[68:71], v[144:147]
v_mfma_f32_16x16x32_bf16 v[144:147], a[144:147], a[64:67], v[144:147]
s_waitcnt lgkmcnt(0)
v_mfma_f32_16x16x32_bf16 v[148:151], a[96:99], a[64:67], v[148:151]
ds_read_b128 a[128:131], v5 offset:39936
v_mfma_f32_16x16x32_bf16 v[148:151], a[100:103], a[68:71], v[148:151]
buffer_load_dwordx4 v1, s[4:7], s44 offen offset:1024 sc1 lds
v_mfma_f32_16x16x32_bf16 v[172:175], a[100:103], a[76:79], v[172:175]
ds_read_b128 a[132:135], v5 offset:46080
v_mfma_f32_16x16x32_bf16 v[172:175], a[96:99], a[72:75], v[172:175]
v_mfma_f32_16x16x32_bf16 v[196:199], a[96:99], a[80:83], v[196:199]
v_mfma_f32_16x16x32_bf16 v[196:199], a[100:103], a[84:87], v[196:199]
buffer_load_dwordx4 v1, s[4:7], s44 offen offset:2048 sc1 lds
v_mfma_f32_16x16x32_bf16 v[220:223], a[100:103], a[92:95], v[220:223]
ds_read_b128 a[136:139], v5 offset:40960
v_mfma_f32_16x16x32_bf16 v[220:223], a[96:99], a[88:91], v[220:223]
v_mfma_f32_16x16x32_bf16 v[224:227], a[104:107], a[88:91], v[224:227]
ds_read_b128 a[140:143], v5 offset:47104
v_mfma_f32_16x16x32_bf16 v[224:227], a[108:111], a[92:95], v[224:227]
v_mfma_f32_16x16x32_bf16 v[200:203], a[108:111], a[84:87], v[200:203]
buffer_load_dwordx4 v1, s[4:7], s44 offen offset:3072 sc1 lds
s_add_u32 m0, s19, 81920
v_mfma_f32_16x16x32_bf16 v[200:203], a[104:107], a[80:83], v[200:203]
s_add_u32 s44, s85, 0xa0c000
ds_read_b128 a[144:147], v5 offset:41984
v_mfma_f32_16x16x32_bf16 v[176:179], a[104:107], a[72:75], v[176:179]
v_mfma_f32_16x16x32_bf16 v[176:179], a[108:111], a[76:79], v[176:179]
ds_read_b128 a[148:151], v5 offset:48128
v_mfma_f32_16x16x32_bf16 v[152:155], a[108:111], a[68:71], v[152:155]
v_mfma_f32_16x16x32_bf16 v[152:155], a[104:107], a[64:67], v[152:155]
buffer_load_dwordx4 v1, s[4:7], s44 offen offset:0 sc1 lds
s_waitcnt vmcnt(13)
v_mfma_f32_16x16x32_bf16 v[140:143], a[112:115], a[0:3], v[140:143]
s_waitcnt vmcnt(12)
v_mfma_f32_16x16x32_bf16 v[140:143], a[116:119], a[4:7], v[140:143]
s_waitcnt vmcnt(10)
v_mfma_f32_16x16x32_bf16 v[164:167], a[116:119], a[12:15], v[164:167]
v_mfma_f32_16x16x32_bf16 v[164:167], a[112:115], a[8:11], v[164:167]
s_waitcnt vmcnt(9)
v_mfma_f32_16x16x32_bf16 v[188:191], a[112:115], a[16:19], v[188:191]
buffer_load_dwordx4 v1, s[4:7], s44 offen offset:1024 sc1 lds
s_waitcnt vmcnt(9)
v_mfma_f32_16x16x32_bf16 v[188:191], a[116:119], a[20:23], v[188:191]
s_waitcnt vmcnt(7)
v_mfma_f32_16x16x32_bf16 v[212:215], a[116:119], a[28:31], v[212:215]
v_mfma_f32_16x16x32_bf16 v[212:215], a[112:115], a[24:27], v[212:215]
s_waitcnt lgkmcnt(0)
v_mfma_f32_16x16x32_bf16 v[216:219], a[128:131], a[24:27], v[216:219]
ds_read_b128 a[96:99], v5 offset:12288
v_mul_f32 v140, v140, v83
v_mfma_f32_16x16x32_bf16 v[216:219], a[132:135], a[28:31], v[216:219]
buffer_load_dwordx4 v1, s[4:7], s44 offen offset:2048 sc1 lds
v_mfma_f32_16x16x32_bf16 v[192:195], a[132:135], a[20:23], v[192:195]
ds_read_b128 a[100:103], v5 offset:18432
v_mul_f32 v141, v141, v83
v_mfma_f32_16x16x32_bf16 v[192:195], a[128:131], a[16:19], v[192:195]
v_cvt_pk_bf16_f32 v140, v140, v141
v_mul_f32 v164, v164, v85
v_mfma_f32_16x16x32_bf16 v[168:171], a[128:131], a[8:11], v[168:171]
v_mul_f32 v165, v165, v85
v_cvt_pk_bf16_f32 v164, v164, v165
v_mfma_f32_16x16x32_bf16 v[168:171], a[132:135], a[12:15], v[168:171]
buffer_load_dwordx4 v1, s[4:7], s44 offen offset:3072 sc1 lds
s_add_u32 m0, s19, 147456
v_mfma_f32_16x16x32_bf16 v[144:147], a[132:135], a[4:7], v[144:147]
s_add_u32 s44, s87, 0xa1c000
ds_read_b128 a[104:107], v5 offset:24576
v_mfma_f32_16x16x32_bf16 v[144:147], a[128:131], a[0:3], v[144:147]
v_mul_f32 v212, v212, v89
v_mul_f32 v213, v213, v89
v_mfma_f32_16x16x32_bf16 v[148:151], a[136:139], a[0:3], v[148:151]
ds_read_b128 a[108:111], v5 offset:30720
v_mul_f32 v214, v214, v89
v_mfma_f32_16x16x32_bf16 v[148:151], a[140:143], a[4:7], v[148:151]
v_mul_f32 v215, v215, v89
v_cvt_pk_bf16_f32 v212, v212, v213
v_mfma_f32_16x16x32_bf16 v[172:175], a[140:143], a[12:15], v[172:175]
buffer_load_dwordx4 v1, s[4:7], s44 offen offset:0 sc1 lds
v_mfma_f32_16x16x32_bf16 v[172:175], a[136:139], a[8:11], v[172:175]
ds_read_b128 a[112:115], v5 offset:36864
v_mul_f32 v216, v216, v89
v_mfma_f32_16x16x32_bf16 v[196:199], a[136:139], a[16:19], v[196:199]
v_mul_f32 v217, v217, v89
v_mul_f32 v218, v218, v89
v_mfma_f32_16x16x32_bf16 v[196:199], a[140:143], a[20:23], v[196:199]
ds_read_b128 a[116:119], v5 offset:43008
v_mul_f32 v219, v219, v89
v_mfma_f32_16x16x32_bf16 v[220:223], a[140:143], a[28:31], v[220:223]
v_cvt_pk_bf16_f32 v213, v214, v215
v_cvt_pk_bf16_f32 v214, v216, v217
v_mfma_f32_16x16x32_bf16 v[220:223], a[136:139], a[24:27], v[220:223]
buffer_load_dwordx4 v1, s[4:7], s44 offen offset:1024 sc1 lds
v_mfma_f32_16x16x32_bf16 v[224:227], a[144:147], a[24:27], v[224:227]
v_cvt_pk_bf16_f32 v215, v218, v219
v_min_u32 v212, -2, v212
v_mfma_f32_16x16x32_bf16 v[224:227], a[148:151], a[28:31], v[224:227]
v_min_u32 v213, -2, v213
v_min_u32 v214, -2, v214
v_mfma_f32_16x16x32_bf16 v[200:203], a[148:151], a[20:23], v[200:203]
v_min_u32 v215, -2, v215
v_mul_f32 v172, v172, v85
v_mfma_f32_16x16x32_bf16 v[200:203], a[144:147], a[16:19], v[200:203]
buffer_store_dwordx4 v[212:215], v3, s[4:7], s63 offen offset:0 sc1
v_mfma_f32_16x16x32_bf16 v[176:179], a[144:147], a[8:11], v[176:179]
buffer_load_dwordx4 v1, s[4:7], s44 offen offset:2048 sc1 lds
v_mfma_f32_16x16x32_bf16 v[176:179], a[148:151], a[12:15], v[176:179]
v_mul_f32 v173, v173, v85
v_cvt_pk_bf16_f32 v172, v172, v173
v_mfma_f32_16x16x32_bf16 v[152:155], a[148:151], a[4:7], v[152:155]
v_mul_f32 v220, v220, v89
v_mul_f32 v221, v221, v89
v_mfma_f32_16x16x32_bf16 v[152:155], a[144:147], a[0:3], v[152:155]
v_mul_f32 v222, v222, v89
s_waitcnt lgkmcnt(0)
v_mfma_f32_16x16x32_bf16 v[132:135], a[96:99], a[32:35], v[132:135]
ds_read_b128 a[128:131], v5 offset:13312
v_mul_f32 v223, v223, v89
v_mfma_f32_16x16x32_bf16 v[132:135], a[100:103], a[36:39], v[132:135]
buffer_load_dwordx4 v1, s[4:7], s44 offen offset:3072 sc1 lds
s_add_u32 m0, s19, 98304
v_mfma_f32_16x16x32_bf16 v[156:159], a[100:103], a[44:47], v[156:159]
s_add_u32 s44, s84, 0xa10000
ds_read_b128 a[132:135], v5 offset:19456
v_mfma_f32_16x16x32_bf16 v[156:159], a[96:99], a[40:43], v[156:159]
v_cvt_pk_bf16_f32 v220, v220, v221
v_mul_f32 v224, v224, v89
v_mfma_f32_16x16x32_bf16 v[180:183], a[96:99], a[48:51], v[180:183]
v_mul_f32 v225, v225, v89
v_mul_f32 v226, v226, v89
v_mfma_f32_16x16x32_bf16 v[180:183], a[100:103], a[52:55], v[180:183]
buffer_load_dwordx4 v1, s[4:7], s44 offen offset:0 sc1 lds
v_mfma_f32_16x16x32_bf16 v[204:207], a[100:103], a[60:63], v[204:207]
ds_read_b128 a[136:139], v5 offset:25600
v_mul_f32 v227, v227, v89
v_mfma_f32_16x16x32_bf16 v[204:207], a[96:99], a[56:59], v[204:207]
v_cvt_pk_bf16_f32 v221, v222, v223
v_cvt_pk_bf16_f32 v222, v224, v225
v_mfma_f32_16x16x32_bf16 v[204:207], a[104:107], a[88:91], v[204:207]
ds_read_b128 a[140:143], v5 offset:31744
v_cvt_pk_bf16_f32 v223, v226, v227
v_mfma_f32_16x16x32_bf16 v[204:207], a[108:111], a[92:95], v[204:207]
v_min_u32 v220, -2, v220
v_min_u32 v221, -2, v221
v_mfma_f32_16x16x32_bf16 v[180:183], a[108:111], a[84:87], v[180:183]
buffer_load_dwordx4 v1, s[4:7], s44 offen offset:1024 sc1 lds
v_mfma_f32_16x16x32_bf16 v[180:183], a[104:107], a[80:83], v[180:183]
ds_read_b128 a[144:147], v5 offset:37888
v_min_u32 v222, -2, v222
v_mfma_f32_16x16x32_bf16 v[156:159], a[104:107], a[72:75], v[156:159]
v_min_u32 v223, -2, v223
v_mul_f32 v196, v196, v87
v_mfma_f32_16x16x32_bf16 v[156:159], a[108:111], a[76:79], v[156:159]
ds_read_b128 a[148:151], v5 offset:44032
v_mul_f32 v197, v197, v87
v_mfma_f32_16x16x32_bf16 v[132:135], a[108:111], a[68:71], v[132:135]
buffer_store_dwordx4 v[220:223], v3, s[4:7], s63 offen offset:1024 sc1
v_mfma_f32_16x16x32_bf16 v[132:135], a[104:107], a[64:67], v[132:135]
buffer_load_dwordx4 v1, s[4:7], s44 offen offset:2048 sc1 lds
v_mfma_f32_16x16x32_bf16 v[132:135], a[112:115], a[0:3], v[132:135]
v_cvt_pk_bf16_f32 v196, v196, v197
v_mul_f32 v198, v198, v87
v_mfma_f32_16x16x32_bf16 v[132:135], a[116:119], a[4:7], v[132:135]
v_mul_f32 v199, v199, v87
v_cvt_pk_bf16_f32 v197, v198, v199
v_mfma_f32_16x16x32_bf16 v[156:159], a[116:119], a[12:15], v[156:159]
v_mul_f32 v200, v200, v87
v_mul_f32 v201, v201, v87
v_mfma_f32_16x16x32_bf16 v[156:159], a[112:115], a[8:11], v[156:159]
v_cvt_pk_bf16_f32 v198, v200, v201
v_mul_f32 v202, v202, v87
v_mfma_f32_16x16x32_bf16 v[180:183], a[112:115], a[16:19], v[180:183]
buffer_load_dwordx4 v1, s[4:7], s44 offen offset:3072 sc1 lds
s_add_u32 m0, s19, 114688
v_mfma_f32_16x16x32_bf16 v[180:183], a[116:119], a[20:23], v[180:183]
s_add_u32 s44, s85, 0xa14000
v_mul_f32 v203, v203, v87
v_mfma_f32_16x16x32_bf16 v[204:207], a[116:119], a[28:31], v[204:207]
v_cvt_pk_bf16_f32 v199, v202, v203
v_mul_f32 v174, v174, v85
v_mfma_f32_16x16x32_bf16 v[204:207], a[112:115], a[24:27], v[204:207]
s_waitcnt lgkmcnt(0)
s_barrier
v_mfma_f32_16x16x32_bf16 v[208:211], a[128:131], a[56:59], v[208:211]
ds_write_b128 v233, v[212:215] offset:21504
v_mul_f32 v175, v175, v85
v_mfma_f32_16x16x32_bf16 v[208:211], a[132:135], a[60:63], v[208:211]
buffer_load_dwordx4 v1, s[4:7], s44 offen offset:0 sc1 lds
v_mfma_f32_16x16x32_bf16 v[184:187], a[132:135], a[52:55], v[184:187]
ds_write_b64 v232, v[220:221] offset:4096
v_cvt_pk_bf16_f32 v173, v174, v175
v_mfma_f32_16x16x32_bf16 v[184:187], a[128:131], a[48:51], v[184:187]
ds_write_b64 v232, v[222:223] offset:4608
v_cvt_pk_bf16_f32 v132, v132, v133
v_mfma_f32_16x16x32_bf16 v[160:163], a[128:131], a[40:43], v[160:163]
ds_write_b64 v232, v[196:197] offset:3072
v_cvt_pk_bf16_f32 v156, v156, v157
v_mfma_f32_16x16x32_bf16 v[160:163], a[132:135], a[44:47], v[160:163]
ds_write_b64 v232, v[198:199] offset:3584
v_cvt_pk_bf16_f32 v180, v180, v181
v_mfma_f32_16x16x32_bf16 v[136:139], a[132:135], a[36:39], v[136:139]
ds_write_b64 v232, v[172:173] offset:2048
v_cvt_pk_bf16_f32 v204, v204, v205
v_mfma_f32_16x16x32_bf16 v[136:139], a[128:131], a[32:35], v[136:139]
buffer_load_dwordx4 v1, s[4:7], s44 offen offset:1024 sc1 lds
v_mfma_f32_16x16x32_bf16 v[136:139], a[136:139], a[64:67], v[136:139]
v_cvt_pk_bf16_f32 v133, v134, v135
v_cvt_pk_bf16_f32 v157, v158, v159
v_mfma_f32_16x16x32_bf16 v[136:139], a[140:143], a[68:71], v[136:139]
v_cvt_pk_bf16_f32 v181, v182, v183
v_cvt_pk_bf16_f32 v205, v206, v207
v_mfma_f32_16x16x32_bf16 v[160:163], a[140:143], a[76:79], v[160:163]
v_mul_f32 v176, v176, v85
v_mul_f32 v177, v177, v85
v_mfma_f32_16x16x32_bf16 v[160:163], a[136:139], a[72:75], v[160:163]
v_cvt_pk_bf16_f32 v174, v176, v177
v_mul_f32 v178, v178, v85
v_mfma_f32_16x16x32_bf16 v[184:187], a[136:139], a[80:83], v[184:187]
v_mul_f32 v179, v179, v85
v_cvt_pk_bf16_f32 v175, v178, v179
v_mfma_f32_16x16x32_bf16 v[184:187], a[140:143], a[84:87], v[184:187]
buffer_load_dwordx4 v1, s[4:7], s44 offen offset:2048 sc1 lds
v_mfma_f32_16x16x32_bf16 v[208:211], a[140:143], a[92:95], v[208:211]
ds_write_b64 v232, v[174:175] offset:2560
v_mul_f32 v148, v148, v83
v_mfma_f32_16x16x32_bf16 v[208:211], a[136:139], a[88:91], v[208:211]
v_mul_f32 v149, v149, v83
v_cvt_pk_bf16_f32 v148, v148, v149
v_mfma_f32_16x16x32_bf16 v[208:211], a[144:147], a[24:27], v[208:211]
v_mul_f32 v150, v150, v83
v_mul_f32 v151, v151, v83
v_mfma_f32_16x16x32_bf16 v[208:211], a[148:151], a[28:31], v[208:211]
v_cvt_pk_bf16_f32 v149, v150, v151
v_mul_f32 v152, v152, v83
v_mfma_f32_16x16x32_bf16 v[184:187], a[148:151], a[20:23], v[184:187]
ds_write_b64 v232, v[148:149] offset:1024
v_mul_f32 v153, v153, v83
v_mfma_f32_16x16x32_bf16 v[184:187], a[144:147], a[16:19], v[184:187]
buffer_load_dwordx4 v1, s[4:7], s44 offen offset:3072 sc1 lds
v_mfma_f32_16x16x32_bf16 v[160:163], a[144:147], a[8:11], v[160:163]
v_cvt_pk_bf16_f32 v150, v152, v153
v_mul_f32 v154, v154, v83
v_mfma_f32_16x16x32_bf16 v[160:163], a[148:151], a[12:15], v[160:163]
v_mul_f32 v155, v155, v83
v_cvt_pk_bf16_f32 v151, v154, v155
v_mfma_f32_16x16x32_bf16 v[136:139], a[148:151], a[4:7], v[136:139]
ds_write_b64 v232, v[150:151] offset:1536
v_mul_f32 v188, v188, v87
v_mfma_f32_16x16x32_bf16 v[136:139], a[144:147], a[0:3], v[136:139]
v_mul_f32 v189, v189, v87
v_cvt_pk_bf16_f32 v188, v188, v189
s_add_u32 m0, s19, 32768
buffer_load_dwordx4 v[228:231], v9, s[4:7], s55 offen sc1
buffer_load_dwordx4 v[72:75], v9, s[4:7], s55 offen offset:1024 sc1
s_add_u32 s44, s84, 0xa00000
buffer_load_dwordx4 v1, s[4:7], s44 offen offset:0 sc1 lds
v_pk_mul_f32 v[190:191], v[190:191], v[86:87] op_sel:[0,1] op_sel_hi:[1,1]
v_pk_mul_f32 v[166:167], v[166:167], v[84:85] op_sel:[0,1] op_sel_hi:[1,1]
v_pk_mul_f32 v[142:143], v[142:143], v[82:83] op_sel:[0,1] op_sel_hi:[1,1]
v_pk_mul_f32 v[192:193], v[192:193], v[86:87] op_sel:[0,1] op_sel_hi:[1,1]
v_pk_mul_f32 v[194:195], v[194:195], v[86:87] op_sel:[0,1] op_sel_hi:[1,1]
v_pk_mul_f32 v[168:169], v[168:169], v[84:85] op_sel:[0,1] op_sel_hi:[1,1]
v_pk_mul_f32 v[170:171], v[170:171], v[84:85] op_sel:[0,1] op_sel_hi:[1,1]
v_pk_mul_f32 v[144:145], v[144:145], v[82:83] op_sel:[0,1] op_sel_hi:[1,1]
v_pk_mul_f32 v[146:147], v[146:147], v[82:83] op_sel:[0,1] op_sel_hi:[1,1]
v_cvt_pk_bf16_f32 v189, v190, v191
v_cvt_pk_bf16_f32 v165, v166, v167
v_cvt_pk_bf16_f32 v141, v142, v143
v_cvt_pk_bf16_f32 v190, v192, v193
v_cvt_pk_bf16_f32 v191, v194, v195
v_cvt_pk_bf16_f32 v166, v168, v169
v_cvt_pk_bf16_f32 v167, v170, v171
v_cvt_pk_bf16_f32 v142, v144, v145
v_cvt_pk_bf16_f32 v143, v146, v147
v_cvt_pk_bf16_f32 v134, v136, v137
v_cvt_pk_bf16_f32 v135, v138, v139
v_cvt_pk_bf16_f32 v158, v160, v161
v_cvt_pk_bf16_f32 v159, v162, v163
v_cvt_pk_bf16_f32 v182, v184, v185
v_cvt_pk_bf16_f32 v183, v186, v187
v_cvt_pk_bf16_f32 v206, v208, v209
v_cvt_pk_bf16_f32 v207, v210, v211
buffer_load_dwordx4 v1, s[4:7], s44 offen offset:1024 sc1 lds
buffer_load_dwordx4 v1, s[4:7], s44 offen offset:2048 sc1 lds
buffer_load_dwordx4 v1, s[4:7], s44 offen offset:3072 sc1 lds
s_waitcnt lgkmcnt(0)
s_barrier
s_add_u32 m0, s19, 131072
s_add_u32 s44, s86, 0xa18000
buffer_load_dwordx4 v1, s[4:7], s44 offen offset:0 sc1 lds
v_mfma_f32_16x16x32_bf16 v[208:211], v[188:191], v[204:207], v[20:23]
ds_read_b64_tr_b16 a[10:11], v248 offset:3072
v_mfma_f32_16x16x32_bf16 v[224:227], v[212:215], v[204:207], v[24:27]
ds_read_b64_tr_b16 a[12:13], v248 offset:4096
v_mfma_f32_16x16x32_bf16 v[160:163], v[140:143], v[156:159], v[20:23]
ds_read_b64_tr_b16 a[22:23], v248 offset:3584
v_mfma_f32_16x16x32_bf16 v[176:179], v[164:167], v[156:159], v[24:27]
s_nop 3
v_max_f32 v224, v224, v208
v_max_f32 v225, v225, v209
v_max_f32 v226, v226, v210
v_max_f32 v227, v227, v211
v_max3_f32 v239, v224, v225, v226
v_max_f32 v239, v239, v227
ds_read_b64_tr_b16 a[24:25], v248 offset:4608
v_max_f32 v176, v176, v160
v_max_f32 v177, v177, v161
v_max_f32 v178, v178, v162
v_max_f32 v179, v179, v163
v_max3_f32 v237, v176, v177, v178
buffer_load_dwordx4 v1, s[4:7], s44 offen offset:1024 sc1 lds
v_max_f32 v237, v237, v179
v_mfma_f32_16x16x32_bf16 v[184:187], v[164:167], v[180:183], v[20:23]
s_nop 0
v_permlane32_swap_b32 v239, v237
v_max_f32 v239, v239, v237
v_mov_b32 v242, v239
v_mfma_f32_16x16x32_bf16 v[200:203], v[188:191], v[180:183], v[24:27]
s_nop 0
v_permlane16_swap_b32 v239, v242
v_max_f32 v239, v239, v242
v_mov_b32 v242, v239
ds_read_b64_tr_b16 a[6:7], v248 offset:1024
s_nop 0
v_permlane32_swap_b32 v239, v242
v_mul_f32_e64 v89, -v239, v88
v_fma_f32 v224, v224, v88, v89
v_fma_f32 v225, v225, v88, v89
v_fma_f32 v226, v226, v88, v89
v_fma_f32 v227, v227, v88, v89
v_exp_f32 v224, v224
v_exp_f32 v225, v225
v_exp_f32 v226, v226
buffer_load_dwordx4 v1, s[4:7], s44 offen offset:2048 sc1 lds
v_exp_f32 v227, v227
v_cvt_pk_bf16_f32 v224, v224, v225
v_cvt_pk_bf16_f32 v225, v226, v227
v_and_b32 v208, v224, v28
v_and_b32 v209, v225, v29
v_and_b32 v210, v224, v30
v_and_b32 v211, v225, v31
v_max_f32 v200, v200, v184
v_max_f32 v201, v201, v185
v_mfma_f32_16x16x32_bf16 v[216:219], v[16:19], v[208:211], 0
v_max_f32 v202, v202, v186
v_max_f32 v203, v203, v187
s_waitcnt lgkmcnt(3)
v_mfma_f32_16x16x32_bf16 v[116:119], a[10:13], v[208:211], 0
v_max3_f32 v238, v200, v201, v202
ds_read_b64_tr_b16 a[18:19], v248 offset:1536
s_waitcnt lgkmcnt(2)
v_mfma_f32_16x16x32_bf16 v[120:123], a[22:25], v[208:211], 0
v_rcp_f32 v216, v216
ds_read_b64_tr_b16 a[8:9], v248 offset:2048
ds_read_b64_tr_b16 a[20:21], v248 offset:2560
buffer_load_dwordx4 v1, s[4:7], s44 offen offset:3072 sc1 lds
v_pk_mul_f32 v[116:117], v[116:117], v[216:217] op_sel:[0,0] op_sel_hi:[1,0]
v_pk_mul_f32 v[118:119], v[118:119], v[216:217] op_sel:[0,0] op_sel_hi:[1,0]
v_cvt_pk_bf16_f32 v116, v116, v117
s_nop 0
v_pk_mul_f32 v[120:121], v[120:121], v[216:217] op_sel:[0,0] op_sel_hi:[1,0]
v_pk_mul_f32 v[122:123], v[122:123], v[216:217] op_sel:[0,0] op_sel_hi:[1,0]
v_cvt_pk_bf16_f32 v117, v118, v119
v_cvt_pk_bf16_f32 v118, v120, v121
v_cvt_pk_bf16_f32 v119, v122, v123
v_max_f32 v238, v238, v203
buffer_store_dwordx4 v[116:119], v2, s[4:7], s72 offen offset:3072 sc1
s_waitcnt lgkmcnt(0)
s_cmp_lg_u32 s28, 0
s_cbranch_scc1 Lhx_32
s_waitcnt vmcnt(10)
v_max3_u32 v244, v228, v229, v230
s_waitcnt vmcnt(9)
v_max3_u32 v244, v244, v231, v72
v_max3_u32 v244, v244, v73, v74
v_max_u32 v244, v244, v75
v_cmp_eq_u32 vcc, -1, v244
s_cbranch_vccnz L_hxredo2
L_hxback2:
ds_write_b128 v233, v[228:231] offset:20480
ds_write_b64 v232, v[72:73] offset:0
ds_write_b64 v232, v[74:75] offset:512
Lhx_32:
ds_read_b128 a[0:3], v233 offset:20480
v_mfma_f32_16x16x32_bf16 v[152:155], v[140:143], v[132:135], v[24:27]
v_mul_f32_e64 v85, -v242, v84
v_fma_f32 v176, v176, v84, v85
v_fma_f32 v177, v177, v84, v85
v_fma_f32 v178, v178, v84, v85
v_fma_f32 v179, v179, v84, v85
v_exp_f32 v176, v176
v_exp_f32 v177, v177
v_exp_f32 v178, v178
v_exp_f32 v179, v179
v_cvt_pk_bf16_f32 v176, v176, v177
v_cvt_pk_bf16_f32 v177, v178, v179
v_and_b32 v160, v176, v28
v_and_b32 v161, v177, v29
v_and_b32 v162, v176, v30
v_and_b32 v163, v177, v31
ds_read_b64_tr_b16 a[4:5], v248 offset:0
s_nop 0
v_mfma_f32_16x16x32_bf16 v[168:171], v[16:19], v[160:163], 0
ds_read_b64_tr_b16 a[16:17], v248 offset:512
v_mfma_f32_16x16x32_bf16 v[100:103], a[6:9], v[160:163], 0
s_waitcnt lgkmcnt(2)
v_mfma_f32_16x16x32_bf16 v[136:139], a[0:3], v[132:135], v[76:79]
s_nop 3
v_rcp_f32 v168, v168
v_mfma_f32_16x16x32_bf16 v[104:107], a[18:21], v[160:163], 0
s_nop 1
v_max_f32 v152, v152, v136
v_max_f32 v153, v153, v137
v_max_f32 v154, v154, v138
v_max_f32 v155, v155, v139
v_max3_f32 v236, v152, v153, v154
v_max_f32 v236, v236, v155
v_pk_mul_f32 v[100:101], v[100:101], v[168:169] op_sel:[0,0] op_sel_hi:[1,0]
v_pk_mul_f32 v[102:103], v[102:103], v[168:169] op_sel:[0,0] op_sel_hi:[1,0]
v_permlane32_swap_b32 v238, v236
v_max_f32 v238, v238, v236
v_mov_b32 v243, v238
v_cvt_pk_bf16_f32 v100, v100, v101
v_pk_mul_f32 v[104:105], v[104:105], v[168:169] op_sel:[0,0] op_sel_hi:[1,0]
v_permlane16_swap_b32 v238, v243
v_max_f32 v238, v238, v243
v_mov_b32 v243, v238
v_pk_mul_f32 v[106:107], v[106:107], v[168:169] op_sel:[0,0] op_sel_hi:[1,0]
v_cvt_pk_bf16_f32 v101, v102, v103
v_permlane32_swap_b32 v238, v243
v_mul_f32_e64 v87, -v238, v86
v_fma_f32 v200, v200, v86, v87
v_fma_f32 v201, v201, v86, v87
v_fma_f32 v202, v202, v86, v87
v_fma_f32 v203, v203, v86, v87
v_exp_f32 v200, v200
v_exp_f32 v201, v201
v_exp_f32 v202, v202
v_exp_f32 v203, v203
v_cvt_pk_bf16_f32 v200, v200, v201
v_cvt_pk_bf16_f32 v201, v202, v203
v_and_b32 v184, v200, v28
v_and_b32 v185, v201, v29
v_and_b32 v186, v200, v30
v_and_b32 v187, v201, v31
v_cvt_pk_bf16_f32 v102, v104, v105
v_cvt_pk_bf16_f32 v103, v106, v107
v_mfma_f32_16x16x32_bf16 v[192:195], v[16:19], v[184:187], 0
buffer_store_dwordx4 v[100:103], v2, s[4:7], s72 offen offset:1024 sc1
v_mul_f32_e64 v83, -v243, v82
v_mfma_f32_16x16x32_bf16 v[108:111], a[8:11], v[184:187], 0
v_fma_f32 v152, v152, v82, v83
v_fma_f32 v153, v153, v82, v83
v_fma_f32 v154, v154, v82, v83
v_fma_f32 v155, v155, v82, v83
v_mfma_f32_16x16x32_bf16 v[112:115], a[20:23], v[184:187], 0
v_exp_f32 v152, v152
v_exp_f32 v153, v153
buffer_atomic_add v12, v10, s[4:7], s94 offen sc1
v_exp_f32 v154, v154
v_exp_f32 v155, v155
v_rcp_f32 v192, v192
v_cvt_pk_bf16_f32 v152, v152, v153
v_cvt_pk_bf16_f32 v153, v154, v155
v_and_b32 v136, v152, v80
v_and_b32 v137, v153, v81
v_and_b32 v138, v152, v30
v_and_b32 v139, v153, v31
v_pk_mul_f32 v[108:109], v[108:109], v[192:193] op_sel:[0,0] op_sel_hi:[1,0]
v_pk_mul_f32 v[110:111], v[110:111], v[192:193] op_sel:[0,0] op_sel_hi:[1,0]
v_cvt_pk_bf16_f32 v108, v108, v109
v_pk_mul_f32 v[112:113], v[112:113], v[192:193] op_sel:[0,0] op_sel_hi:[1,0]
v_cvt_pk_bf16_f32 v109, v110, v111
v_pk_mul_f32 v[114:115], v[114:115], v[192:193] op_sel:[0,0] op_sel_hi:[1,0]
v_cvt_pk_bf16_f32 v110, v112, v113
v_mfma_f32_16x16x32_bf16 v[144:147], v[16:19], v[136:139], 0
v_cvt_pk_bf16_f32 v111, v114, v115
buffer_store_dwordx4 v[108:111], v2, s[4:7], s72 offen offset:2048 sc1
s_waitcnt lgkmcnt(1)
v_mfma_f32_16x16x32_bf16 v[92:95], a[4:7], v[136:139], 0
s_nop 3
v_rcp_f32 v144, v144
s_waitcnt lgkmcnt(0)
v_mfma_f32_16x16x32_bf16 v[96:99], a[16:19], v[136:139], 0
s_nop 0
v_pk_mul_f32 v[92:93], v[92:93], v[144:145] op_sel:[0,0] op_sel_hi:[1,0]
v_pk_mul_f32 v[94:95], v[94:95], v[144:145] op_sel:[0,0] op_sel_hi:[1,0]
v_cvt_pk_bf16_f32 v92, v92, v93
v_cvt_pk_bf16_f32 v93, v94, v95
s_nop 2
v_pk_mul_f32 v[96:97], v[96:97], v[144:145] op_sel:[0,0] op_sel_hi:[1,0]
v_pk_mul_f32 v[98:99], v[98:99], v[144:145] op_sel:[0,0] op_sel_hi:[1,0]
v_cvt_pk_bf16_f32 v94, v96, v97
v_cvt_pk_bf16_f32 v95, v98, v99
buffer_store_dwordx4 v[92:95], v2, s[4:7], s72 offen offset:0 sc1
s_add_u32 s92, s71, 0x20000
s_add_u32 s36, s66, 0x20080
s_add_u32 s40, s4, 0x1e00000
s_addc_u32 s41, s5, 0
v_add_u32 v5, 32768, v1
v_add_u32 v6, 98304, v1
s_cmp_eq_u32 s3, 0
s_cselect_b32 s35, 8, 0
s_lshl_b32 s35, s35, 12
v_lshlrev_b32 v132, 16, v32
v_and_b32 v133, 0xffff0000, v32
v_lshlrev_b32 v134, 16, v33
v_and_b32 v135, 0xffff0000, v33
v_lshlrev_b32 v136, 16, v34
v_and_b32 v137, 0xffff0000, v34
v_lshlrev_b32 v138, 16, v35
v_and_b32 v139, 0xffff0000, v35
v_lshlrev_b32 v140, 16, v36
v_and_b32 v141, 0xffff0000, v36
v_lshlrev_b32 v142, 16, v37
v_and_b32 v143, 0xffff0000, v37
v_lshlrev_b32 v144, 16, v38
v_and_b32 v145, 0xffff0000, v38
v_lshlrev_b32 v146, 16, v39
v_and_b32 v147, 0xffff0000, v39
v_lshlrev_b32 v148, 16, v40
v_and_b32 v149, 0xffff0000, v40
v_lshlrev_b32 v150, 16, v41
v_and_b32 v151, 0xffff0000, v41
v_lshlrev_b32 v152, 16, v42
v_and_b32 v153, 0xffff0000, v42
v_lshlrev_b32 v154, 16, v43
v_and_b32 v155, 0xffff0000, v43
v_lshlrev_b32 v156, 16, v44
v_and_b32 v157, 0xffff0000, v44
v_lshlrev_b32 v158, 16, v45
v_and_b32 v159, 0xffff0000, v45
v_lshlrev_b32 v160, 16, v46
v_and_b32 v161, 0xffff0000, v46
v_lshlrev_b32 v162, 16, v47
v_and_b32 v163, 0xffff0000, v47
s_mov_b32 s95, -1
s_mov_b64 exec, 0
s_cmp_eq_u32 s28, 3
s_cbranch_scc1 L_stub13
s_cmp_eq_u32 s28, 2
s_cbranch_scc1 L_stub14
L_wret5:
s_mov_b64 exec, -1
L_stub13:
s_cbranch_execz L_wret5
s_cmp_lg_u32 s28, 1
s_cbranch_scc1 Lpo_35
s_add_u32 s36, s66, 0x20080
s_mov_b32 s37, 0
v_mov_b32 v11, 0
buffer_atomic_add v11, v251, s[4:7], s36 offen sc0 sc1
s_sleep 4
Lpoll_33:
v_mov_b32 v234, 0
buffer_atomic_add v234, v251, s[4:7], s36 offen sc0 sc1
s_waitcnt vmcnt(1)
v_readfirstlane_b32 s38, v11
s_nop 0
s_cmp_ge_u32 s38, 32
s_cbranch_scc1 Lpe_34
v_mov_b32 v11, 0
buffer_atomic_add v11, v251, s[4:7], s36 offen sc0 sc1
s_waitcnt vmcnt(1)
v_readfirstlane_b32 s38, v234
s_nop 0
s_cmp_ge_u32 s38, 32
s_cbranch_scc1 Lpe_34
s_add_u32 s37, s37, 1
s_cmp_lt_u32 s37, 0x80000
s_cbranch_scc1 Lpoll_33
s_waitcnt vmcnt(0)
Lpo_35:
s_waitcnt vmcnt(0)
Lpe_34:
s_barrier
L_k2go2:
buffer_load_dwordx4 a[0:3], v4, s[40:43], s35 offen offset:0 sc1
buffer_load_dwordx4 a[4:7], v4, s[40:43], s35 offen offset:1024 sc1
s_cmp_eq_u32 s3, 1
s_cselect_b32 s35, 9, 1
s_lshl_b32 s35, s35, 12
buffer_load_dwordx4 a[8:11], v4, s[40:43], s35 offen offset:0 sc1
buffer_load_dwordx4 a[12:15], v4, s[40:43], s35 offen offset:1024 sc1
s_cmp_eq_u32 s3, 2
s_cselect_b32 s35, 10, 2
s_lshl_b32 s35, s35, 12
buffer_load_dwordx4 a[16:19], v4, s[40:43], s35 offen offset:0 sc1
buffer_load_dwordx4 a[20:23], v4, s[40:43], s35 offen offset:1024 sc1
s_cmp_eq_u32 s3, 3
s_cselect_b32 s35, 11, 3
s_lshl_b32 s35, s35, 12
buffer_load_dwordx4 a[24:27], v4, s[40:43], s35 offen offset:0 sc1
buffer_load_dwordx4 a[28:31], v4, s[40:43], s35 offen offset:1024 sc1
s_cmp_eq_u32 s3, 4
s_cselect_b32 s35, 12, 4
s_lshl_b32 s35, s35, 12
buffer_load_dwordx4 a[32:35], v4, s[40:43], s35 offen offset:0 sc1
buffer_load_dwordx4 a[36:39], v4, s[40:43], s35 offen offset:1024 sc1
s_cmp_eq_u32 s3, 5
s_cselect_b32 s35, 13, 5
s_lshl_b32 s35, s35, 12
buffer_load_dwordx4 a[40:43], v4, s[40:43], s35 offen offset:0 sc1
buffer_load_dwordx4 a[44:47], v4, s[40:43], s35 offen offset:1024 sc1
s_cmp_eq_u32 s3, 6
s_cselect_b32 s35, 14, 6
s_lshl_b32 s35, s35, 12
ds_read_b128 a[96:99], v5 offset:0
ds_read_b128 a[100:103], v5 offset:1024
ds_read_b128 a[104:107], v5 offset:2048
ds_read_b128 a[108:111], v5 offset:3072
ds_read_b128 a[112:115], v5 offset:4096
ds_read_b128 a[116:119], v5 offset:5120
ds_read_b128 a[120:123], v5 offset:6144
ds_read_b128 a[124:127], v5 offset:7168
s_waitcnt vmcnt(10) lgkmcnt(4)
v_mfma_f32_16x16x32_bf16 v[132:135], a[96:99], a[0:3], v[132:135]
ds_read_b128 a[128:131], v5 offset:8192
v_mfma_f32_16x16x32_bf16 v[148:151], a[96:99], a[4:7], v[148:151]
ds_read_b128 a[132:135], v5 offset:9216
v_mfma_f32_16x16x32_bf16 v[152:155], a[100:103], a[4:7], v[152:155]
buffer_load_dwordx4 a[48:51], v4, s[40:43], s35 offen offset:0 sc1
v_mfma_f32_16x16x32_bf16 v[136:139], a[100:103], a[0:3], v[136:139]
ds_read_b128 a[136:139], v5 offset:10240
v_mfma_f32_16x16x32_bf16 v[140:143], a[104:107], a[0:3], v[140:143]
ds_read_b128 a[140:143], v5 offset:11264
v_mfma_f32_16x16x32_bf16 v[156:159], a[104:107], a[4:7], v[156:159]
v_mfma_f32_16x16x32_bf16 v[160:163], a[108:111], a[4:7], v[160:163]
buffer_load_dwordx4 a[52:55], v4, s[40:43], s35 offen offset:1024 sc1
v_mfma_f32_16x16x32_bf16 v[144:147], a[108:111], a[0:3], v[144:147]
s_waitcnt vmcnt(10) lgkmcnt(4)
v_mfma_f32_16x16x32_bf16 v[132:135], a[112:115], a[8:11], v[132:135]
s_cmp_eq_u32 s3, 7
s_cselect_b32 s35, 15, 7
s_lshl_b32 s35, s35, 12
v_mfma_f32_16x16x32_bf16 v[148:151], a[112:115], a[12:15], v[148:151]
ds_read_b128 a[96:99], v5 offset:12288
v_mfma_f32_16x16x32_bf16 v[152:155], a[116:119], a[12:15], v[152:155]
buffer_load_dwordx4 a[0:3], v4, s[40:43], s35 offen offset:0 sc1
v_mfma_f32_16x16x32_bf16 v[136:139], a[116:119], a[8:11], v[136:139]
ds_read_b128 a[100:103], v5 offset:13312
v_mfma_f32_16x16x32_bf16 v[140:143], a[120:123], a[8:11], v[140:143]
ds_read_b128 a[104:107], v5 offset:14336
v_mfma_f32_16x16x32_bf16 v[156:159], a[120:123], a[12:15], v[156:159]
ds_read_b128 a[108:111], v5 offset:15360
v_mfma_f32_16x16x32_bf16 v[160:163], a[124:127], a[12:15], v[160:163]
buffer_load_dwordx4 a[4:7], v4, s[40:43], s35 offen offset:1024 sc1
v_mfma_f32_16x16x32_bf16 v[144:147], a[124:127], a[8:11], v[144:147]
s_waitcnt vmcnt(10) lgkmcnt(4)
v_mfma_f32_16x16x32_bf16 v[132:135], a[128:131], a[16:19], v[132:135]
s_cmp_eq_u32 s3, 0
s_cselect_b32 s35, 16, 8
s_lshl_b32 s35, s35, 12
v_mfma_f32_16x16x32_bf16 v[148:151], a[128:131], a[20:23], v[148:151]
ds_read_b128 a[112:115], v5 offset:16384
v_mfma_f32_16x16x32_bf16 v[152:155], a[132:135], a[20:23], v[152:155]
buffer_load_dwordx4 a[8:11], v4, s[40:43], s35 offen offset:0 sc1
v_mfma_f32_16x16x32_bf16 v[136:139], a[132:135], a[16:19], v[136:139]
ds_read_b128 a[116:119], v5 offset:17408
v_mfma_f32_16x16x32_bf16 v[140:143], a[136:139], a[16:19], v[140:143]
ds_read_b128 a[120:123], v5 offset:18432
v_mfma_f32_16x16x32_bf16 v[156:159], a[136:139], a[20:23], v[156:159]
ds_read_b128 a[124:127], v5 offset:19456
v_mfma_f32_16x16x32_bf16 v[160:163], a[140:143], a[20:23], v[160:163]
buffer_load_dwordx4 a[12:15], v4, s[40:43], s35 offen offset:1024 sc1
v_mfma_f32_16x16x32_bf16 v[144:147], a[140:143], a[16:19], v[144:147]
s_waitcnt vmcnt(10) lgkmcnt(4)
v_mfma_f32_16x16x32_bf16 v[132:135], a[96:99], a[24:27], v[132:135]
s_cmp_eq_u32 s3, 1
s_cselect_b32 s35, 17, 9
s_lshl_b32 s35, s35, 12
v_mfma_f32_16x16x32_bf16 v[148:151], a[96:99], a[28:31], v[148:151]
ds_read_b128 a[128:131], v5 offset:20480
v_mfma_f32_16x16x32_bf16 v[152:155], a[100:103], a[28:31], v[152:155]
buffer_load_dwordx4 a[16:19], v4, s[40:43], s35 offen offset:0 sc1
v_mfma_f32_16x16x32_bf16 v[136:139], a[100:103], a[24:27], v[136:139]
ds_read_b128 a[132:135], v5 offset:21504
v_mfma_f32_16x16x32_bf16 v[140:143], a[104:107], a[24:27], v[140:143]
ds_read_b128 a[136:139], v5 offset:22528
v_mfma_f32_16x16x32_bf16 v[156:159], a[104:107], a[28:31], v[156:159]
ds_read_b128 a[140:143], v5 offset:23552
v_mfma_f32_16x16x32_bf16 v[160:163], a[108:111], a[28:31], v[160:163]
buffer_load_dwordx4 a[20:23], v4, s[40:43], s35 offen offset:1024 sc1
v_mfma_f32_16x16x32_bf16 v[144:147], a[108:111], a[24:27], v[144:147]
s_waitcnt vmcnt(10) lgkmcnt(4)
v_mfma_f32_16x16x32_bf16 v[132:135], a[112:115], a[32:35], v[132:135]
s_cmp_eq_u32 s3, 2
s_cselect_b32 s35, 18, 10
s_lshl_b32 s35, s35, 12
v_mfma_f32_16x16x32_bf16 v[148:151], a[112:115], a[36:39], v[148:151]
ds_read_b128 a[96:99], v5 offset:24576
v_mfma_f32_16x16x32_bf16 v[152:155], a[116:119], a[36:39], v[152:155]
buffer_load_dwordx4 a[24:27], v4, s[40:43], s35 offen offset:0 sc1
v_mfma_f32_16x16x32_bf16 v[136:139], a[116:119], a[32:35], v[136:139]
ds_read_b128 a[100:103], v5 offset:25600
v_mfma_f32_16x16x32_bf16 v[140:143], a[120:123], a[32:35], v[140:143]
ds_read_b128 a[104:107], v5 offset:26624
v_mfma_f32_16x16x32_bf16 v[156:159], a[120:123], a[36:39], v[156:159]
ds_read_b128 a[108:111], v5 offset:27648
v_mfma_f32_16x16x32_bf16 v[160:163], a[124:127], a[36:39], v[160:163]
buffer_load_dwordx4 a[28:31], v4, s[40:43], s35 offen offset:1024 sc1
v_mfma_f32_16x16x32_bf16 v[144:147], a[124:127], a[32:35], v[144:147]
s_waitcnt vmcnt(10) lgkmcnt(4)
v_mfma_f32_16x16x32_bf16 v[132:135], a[128:131], a[40:43], v[132:135]
s_cmp_eq_u32 s3, 3
s_cselect_b32 s35, 19, 11
s_lshl_b32 s35, s35, 12
v_mfma_f32_16x16x32_bf16 v[148:151], a[128:131], a[44:47], v[148:151]
ds_read_b128 a[112:115], v5 offset:28672
v_mfma_f32_16x16x32_bf16 v[152:155], a[132:135], a[44:47], v[152:155]
buffer_load_dwordx4 a[32:35], v4, s[40:43], s35 offen offset:0 sc1
v_mfma_f32_16x16x32_bf16 v[136:139], a[132:135], a[40:43], v[136:139]
ds_read_b128 a[116:119], v5 offset:29696
v_mfma_f32_16x16x32_bf16 v[140:143], a[136:139], a[40:43], v[140:143]
ds_read_b128 a[120:123], v5 offset:30720
v_mfma_f32_16x16x32_bf16 v[156:159], a[136:139], a[44:47], v[156:159]
ds_read_b128 a[124:127], v5 offset:31744
v_mfma_f32_16x16x32_bf16 v[160:163], a[140:143], a[44:47], v[160:163]
buffer_load_dwordx4 a[36:39], v4, s[40:43], s35 offen offset:1024 sc1
v_mfma_f32_16x16x32_bf16 v[144:147], a[140:143], a[40:43], v[144:147]
s_waitcnt vmcnt(10) lgkmcnt(4)
v_mfma_f32_16x16x32_bf16 v[132:135], a[96:99], a[48:51], v[132:135]
s_cmp_eq_u32 s3, 4
s_cselect_b32 s35, 20, 12
s_lshl_b32 s35, s35, 12
v_mfma_f32_16x16x32_bf16 v[148:151], a[96:99], a[52:55], v[148:151]
ds_read_b128 a[128:131], v5 offset:32768
v_mfma_f32_16x16x32_bf16 v[152:155], a[100:103], a[52:55], v[152:155]
buffer_load_dwordx4 a[40:43], v4, s[40:43], s35 offen offset:0 sc1
v_mfma_f32_16x16x32_bf16 v[136:139], a[100:103], a[48:51], v[136:139]
ds_read_b128 a[132:135], v5 offset:33792
v_mfma_f32_16x16x32_bf16 v[140:143], a[104:107], a[48:51], v[140:143]
ds_read_b128 a[136:139], v5 offset:34816
v_mfma_f32_16x16x32_bf16 v[156:159], a[104:107], a[52:55], v[156:159]
ds_read_b128 a[140:143], v5 offset:35840
v_mfma_f32_16x16x32_bf16 v[160:163], a[108:111], a[52:55], v[160:163]
buffer_load_dwordx4 a[44:47], v4, s[40:43], s35 offen offset:1024 sc1
v_mfma_f32_16x16x32_bf16 v[144:147], a[108:111], a[48:51], v[144:147]
s_waitcnt vmcnt(10) lgkmcnt(4)
v_mfma_f32_16x16x32_bf16 v[132:135], a[112:115], a[0:3], v[132:135]
s_cmp_eq_u32 s3, 5
s_cselect_b32 s35, 21, 13
s_lshl_b32 s35, s35, 12
v_mfma_f32_16x16x32_bf16 v[148:151], a[112:115], a[4:7], v[148:151]
ds_read_b128 a[96:99], v5 offset:36864
v_mfma_f32_16x16x32_bf16 v[152:155], a[116:119], a[4:7], v[152:155]
buffer_load_dwordx4 a[48:51], v4, s[40:43], s35 offen offset:0 sc1
v_mfma_f32_16x16x32_bf16 v[136:139], a[116:119], a[0:3], v[136:139]
ds_read_b128 a[100:103], v5 offset:37888
v_mfma_f32_16x16x32_bf16 v[140:143], a[120:123], a[0:3], v[140:143]
ds_read_b128 a[104:107], v5 offset:38912
v_mfma_f32_16x16x32_bf16 v[156:159], a[120:123], a[4:7], v[156:159]
ds_read_b128 a[108:111], v5 offset:39936
v_mfma_f32_16x16x32_bf16 v[160:163], a[124:127], a[4:7], v[160:163]
buffer_load_dwordx4 a[52:55], v4, s[40:43], s35 offen offset:1024 sc1
v_mfma_f32_16x16x32_bf16 v[144:147], a[124:127], a[0:3], v[144:147]
s_waitcnt vmcnt(10) lgkmcnt(4)
v_mfma_f32_16x16x32_bf16 v[132:135], a[128:131], a[8:11], v[132:135]
s_cmp_eq_u32 s3, 6
s_cselect_b32 s35, 22, 14
s_lshl_b32 s35, s35, 12
v_mfma_f32_16x16x32_bf16 v[148:151], a[128:131], a[12:15], v[148:151]
ds_read_b128 a[112:115], v5 offset:40960
v_mfma_f32_16x16x32_bf16 v[152:155], a[132:135], a[12:15], v[152:155]
buffer_load_dwordx4 a[0:3], v4, s[40:43], s35 offen offset:0 sc1
v_mfma_f32_16x16x32_bf16 v[136:139], a[132:135], a[8:11], v[136:139]
ds_read_b128 a[116:119], v5 offset:41984
v_mfma_f32_16x16x32_bf16 v[140:143], a[136:139], a[8:11], v[140:143]
ds_read_b128 a[120:123], v5 offset:43008
v_mfma_f32_16x16x32_bf16 v[156:159], a[136:139], a[12:15], v[156:159]
ds_read_b128 a[124:127], v5 offset:44032
v_mfma_f32_16x16x32_bf16 v[160:163], a[140:143], a[12:15], v[160:163]
buffer_load_dwordx4 a[4:7], v4, s[40:43], s35 offen offset:1024 sc1
v_mfma_f32_16x16x32_bf16 v[144:147], a[140:143], a[8:11], v[144:147]
s_waitcnt vmcnt(10) lgkmcnt(4)
v_mfma_f32_16x16x32_bf16 v[132:135], a[96:99], a[16:19], v[132:135]
s_cmp_eq_u32 s3, 7
s_cselect_b32 s35, 23, 15
s_lshl_b32 s35, s35, 12
v_mfma_f32_16x16x32_bf16 v[148:151], a[96:99], a[20:23], v[148:151]
ds_read_b128 a[128:131], v5 offset:45056
v_mfma_f32_16x16x32_bf16 v[152:155], a[100:103], a[20:23], v[152:155]
buffer_load_dwordx4 a[8:11], v4, s[40:43], s35 offen offset:0 sc1
v_mfma_f32_16x16x32_bf16 v[136:139], a[100:103], a[16:19], v[136:139]
ds_read_b128 a[132:135], v5 offset:46080
v_mfma_f32_16x16x32_bf16 v[140:143], a[104:107], a[16:19], v[140:143]
ds_read_b128 a[136:139], v5 offset:47104
v_mfma_f32_16x16x32_bf16 v[156:159], a[104:107], a[20:23], v[156:159]
ds_read_b128 a[140:143], v5 offset:48128
v_mfma_f32_16x16x32_bf16 v[160:163], a[108:111], a[20:23], v[160:163]
buffer_load_dwordx4 a[12:15], v4, s[40:43], s35 offen offset:1024 sc1
v_mfma_f32_16x16x32_bf16 v[144:147], a[108:111], a[16:19], v[144:147]
s_waitcnt vmcnt(10) lgkmcnt(4)
v_mfma_f32_16x16x32_bf16 v[132:135], a[112:115], a[24:27], v[132:135]
s_cmp_eq_u32 s3, 0
s_cselect_b32 s35, 24, 16
s_lshl_b32 s35, s35, 12
v_mfma_f32_16x16x32_bf16 v[148:151], a[112:115], a[28:31], v[148:151]
ds_read_b128 a[96:99], v5 offset:49152
v_mfma_f32_16x16x32_bf16 v[152:155], a[116:119], a[28:31], v[152:155]
buffer_load_dwordx4 a[16:19], v4, s[40:43], s35 offen offset:0 sc1
v_mfma_f32_16x16x32_bf16 v[136:139], a[116:119], a[24:27], v[136:139]
ds_read_b128 a[100:103], v5 offset:50176
v_mfma_f32_16x16x32_bf16 v[140:143], a[120:123], a[24:27], v[140:143]
ds_read_b128 a[104:107], v5 offset:51200
v_mfma_f32_16x16x32_bf16 v[156:159], a[120:123], a[28:31], v[156:159]
ds_read_b128 a[108:111], v5 offset:52224
v_mfma_f32_16x16x32_bf16 v[160:163], a[124:127], a[28:31], v[160:163]
buffer_load_dwordx4 a[20:23], v4, s[40:43], s35 offen offset:1024 sc1
v_mfma_f32_16x16x32_bf16 v[144:147], a[124:127], a[24:27], v[144:147]
s_waitcnt vmcnt(10) lgkmcnt(4)
v_mfma_f32_16x16x32_bf16 v[132:135], a[128:131], a[32:35], v[132:135]
s_cmp_eq_u32 s3, 1
s_cselect_b32 s35, 25, 17
s_lshl_b32 s35, s35, 12
v_mfma_f32_16x16x32_bf16 v[148:151], a[128:131], a[36:39], v[148:151]
ds_read_b128 a[112:115], v5 offset:53248
v_mfma_f32_16x16x32_bf16 v[152:155], a[132:135], a[36:39], v[152:155]
buffer_load_dwordx4 a[24:27], v4, s[40:43], s35 offen offset:0 sc1
v_mfma_f32_16x16x32_bf16 v[136:139], a[132:135], a[32:35], v[136:139]
ds_read_b128 a[116:119], v5 offset:54272
v_mfma_f32_16x16x32_bf16 v[140:143], a[136:139], a[32:35], v[140:143]
ds_read_b128 a[120:123], v5 offset:55296
v_mfma_f32_16x16x32_bf16 v[156:159], a[136:139], a[36:39], v[156:159]
ds_read_b128 a[124:127], v5 offset:56320
v_mfma_f32_16x16x32_bf16 v[160:163], a[140:143], a[36:39], v[160:163]
buffer_load_dwordx4 a[28:31], v4, s[40:43], s35 offen offset:1024 sc1
v_mfma_f32_16x16x32_bf16 v[144:147], a[140:143], a[32:35], v[144:147]
s_waitcnt vmcnt(10) lgkmcnt(4)
v_mfma_f32_16x16x32_bf16 v[132:135], a[96:99], a[40:43], v[132:135]
s_cmp_eq_u32 s3, 2
s_cselect_b32 s35, 26, 18
s_lshl_b32 s35, s35, 12
v_mfma_f32_16x16x32_bf16 v[148:151], a[96:99], a[44:47], v[148:151]
ds_read_b128 a[128:131], v5 offset:57344
v_mfma_f32_16x16x32_bf16 v[152:155], a[100:103], a[44:47], v[152:155]
buffer_load_dwordx4 a[32:35], v4, s[40:43], s35 offen offset:0 sc1
v_mfma_f32_16x16x32_bf16 v[136:139], a[100:103], a[40:43], v[136:139]
ds_read_b128 a[132:135], v5 offset:58368
v_mfma_f32_16x16x32_bf16 v[140:143], a[104:107], a[40:43], v[140:143]
ds_read_b128 a[136:139], v5 offset:59392
v_mfma_f32_16x16x32_bf16 v[156:159], a[104:107], a[44:47], v[156:159]
ds_read_b128 a[140:143], v5 offset:60416
v_mfma_f32_16x16x32_bf16 v[160:163], a[108:111], a[44:47], v[160:163]
buffer_load_dwordx4 a[36:39], v4, s[40:43], s35 offen offset:1024 sc1
v_mfma_f32_16x16x32_bf16 v[144:147], a[108:111], a[40:43], v[144:147]
s_waitcnt vmcnt(10) lgkmcnt(4)
v_mfma_f32_16x16x32_bf16 v[132:135], a[112:115], a[48:51], v[132:135]
s_cmp_eq_u32 s3, 3
s_cselect_b32 s35, 27, 19
s_lshl_b32 s35, s35, 12
v_mfma_f32_16x16x32_bf16 v[148:151], a[112:115], a[52:55], v[148:151]
ds_read_b128 a[96:99], v5 offset:61440
v_mfma_f32_16x16x32_bf16 v[152:155], a[116:119], a[52:55], v[152:155]
buffer_load_dwordx4 a[40:43], v4, s[40:43], s35 offen offset:0 sc1
v_mfma_f32_16x16x32_bf16 v[136:139], a[116:119], a[48:51], v[136:139]
ds_read_b128 a[100:103], v5 offset:62464
v_mfma_f32_16x16x32_bf16 v[140:143], a[120:123], a[48:51], v[140:143]
ds_read_b128 a[104:107], v5 offset:63488
v_mfma_f32_16x16x32_bf16 v[156:159], a[120:123], a[52:55], v[156:159]
ds_read_b128 a[108:111], v5 offset:64512
v_mfma_f32_16x16x32_bf16 v[160:163], a[124:127], a[52:55], v[160:163]
buffer_load_dwordx4 a[44:47], v4, s[40:43], s35 offen offset:1024 sc1
v_mfma_f32_16x16x32_bf16 v[144:147], a[124:127], a[48:51], v[144:147]
s_waitcnt vmcnt(10) lgkmcnt(4)
v_mfma_f32_16x16x32_bf16 v[132:135], a[128:131], a[0:3], v[132:135]
s_cmp_eq_u32 s3, 4
s_cselect_b32 s35, 28, 20
s_lshl_b32 s35, s35, 12
v_mfma_f32_16x16x32_bf16 v[148:151], a[128:131], a[4:7], v[148:151]
ds_read_b128 a[112:115], v6 offset:0
v_mfma_f32_16x16x32_bf16 v[152:155], a[132:135], a[4:7], v[152:155]
buffer_load_dwordx4 a[48:51], v4, s[40:43], s35 offen offset:0 sc1
v_mfma_f32_16x16x32_bf16 v[136:139], a[132:135], a[0:3], v[136:139]
ds_read_b128 a[116:119], v6 offset:1024
v_mfma_f32_16x16x32_bf16 v[140:143], a[136:139], a[0:3], v[140:143]
ds_read_b128 a[120:123], v6 offset:2048
v_mfma_f32_16x16x32_bf16 v[156:159], a[136:139], a[4:7], v[156:159]
ds_read_b128 a[124:127], v6 offset:3072
v_mfma_f32_16x16x32_bf16 v[160:163], a[140:143], a[4:7], v[160:163]
buffer_load_dwordx4 a[52:55], v4, s[40:43], s35 offen offset:1024 sc1
v_mfma_f32_16x16x32_bf16 v[144:147], a[140:143], a[0:3], v[144:147]
s_waitcnt vmcnt(10) lgkmcnt(4)
v_mfma_f32_16x16x32_bf16 v[132:135], a[96:99], a[8:11], v[132:135]
s_cmp_eq_u32 s3, 5
s_cselect_b32 s35, 29, 21
s_lshl_b32 s35, s35, 12
v_mfma_f32_16x16x32_bf16 v[148:151], a[96:99], a[12:15], v[148:151]
ds_read_b128 a[128:131], v6 offset:4096
v_mfma_f32_16x16x32_bf16 v[152:155], a[100:103], a[12:15], v[152:155]
buffer_load_dwordx4 a[0:3], v4, s[40:43], s35 offen offset:0 sc1
v_mfma_f32_16x16x32_bf16 v[136:139], a[100:103], a[8:11], v[136:139]
ds_read_b128 a[132:135], v6 offset:5120
v_mfma_f32_16x16x32_bf16 v[140:143], a[104:107], a[8:11], v[140:143]
ds_read_b128 a[136:139], v6 offset:6144
v_mfma_f32_16x16x32_bf16 v[156:159], a[104:107], a[12:15], v[156:159]
ds_read_b128 a[140:143], v6 offset:7168
v_mfma_f32_16x16x32_bf16 v[160:163], a[108:111], a[12:15], v[160:163]
buffer_load_dwordx4 a[4:7], v4, s[40:43], s35 offen offset:1024 sc1
v_mfma_f32_16x16x32_bf16 v[144:147], a[108:111], a[8:11], v[144:147]
s_waitcnt vmcnt(10) lgkmcnt(4)
v_mfma_f32_16x16x32_bf16 v[132:135], a[112:115], a[16:19], v[132:135]
s_cmp_eq_u32 s3, 6
s_cselect_b32 s35, 30, 22
s_lshl_b32 s35, s35, 12
v_mfma_f32_16x16x32_bf16 v[148:151], a[112:115], a[20:23], v[148:151]
ds_read_b128 a[96:99], v6 offset:8192
v_mfma_f32_16x16x32_bf16 v[152:155], a[116:119], a[20:23], v[152:155]
buffer_load_dwordx4 a[8:11], v4, s[40:43], s35 offen offset:0 sc1
v_mfma_f32_16x16x32_bf16 v[136:139], a[116:119], a[16:19], v[136:139]
ds_read_b128 a[100:103], v6 offset:9216
v_mfma_f32_16x16x32_bf16 v[140:143], a[120:123], a[16:19], v[140:143]
ds_read_b128 a[104:107], v6 offset:10240
v_mfma_f32_16x16x32_bf16 v[156:159], a[120:123], a[20:23], v[156:159]
ds_read_b128 a[108:111], v6 offset:11264
v_mfma_f32_16x16x32_bf16 v[160:163], a[124:127], a[20:23], v[160:163]
buffer_load_dwordx4 a[12:15], v4, s[40:43], s35 offen offset:1024 sc1
v_mfma_f32_16x16x32_bf16 v[144:147], a[124:127], a[16:19], v[144:147]
s_waitcnt vmcnt(10) lgkmcnt(4)
v_mfma_f32_16x16x32_bf16 v[132:135], a[128:131], a[24:27], v[132:135]
s_cmp_eq_u32 s3, 7
s_cselect_b32 s35, 31, 23
s_lshl_b32 s35, s35, 12
v_mfma_f32_16x16x32_bf16 v[148:151], a[128:131], a[28:31], v[148:151]
ds_read_b128 a[112:115], v6 offset:12288
v_mfma_f32_16x16x32_bf16 v[152:155], a[132:135], a[28:31], v[152:155]
buffer_load_dwordx4 a[16:19], v4, s[40:43], s35 offen offset:0 sc1
v_mfma_f32_16x16x32_bf16 v[136:139], a[132:135], a[24:27], v[136:139]
ds_read_b128 a[116:119], v6 offset:13312
v_mfma_f32_16x16x32_bf16 v[140:143], a[136:139], a[24:27], v[140:143]
ds_read_b128 a[120:123], v6 offset:14336
v_mfma_f32_16x16x32_bf16 v[156:159], a[136:139], a[28:31], v[156:159]
ds_read_b128 a[124:127], v6 offset:15360
v_mfma_f32_16x16x32_bf16 v[160:163], a[140:143], a[28:31], v[160:163]
buffer_load_dwordx4 a[20:23], v4, s[40:43], s35 offen offset:1024 sc1
v_mfma_f32_16x16x32_bf16 v[144:147], a[140:143], a[24:27], v[144:147]
s_waitcnt vmcnt(10) lgkmcnt(4)
v_mfma_f32_16x16x32_bf16 v[132:135], a[96:99], a[32:35], v[132:135]
s_cmp_eq_u32 s3, 0
s_cselect_b32 s35, 0, 24
s_lshl_b32 s35, s35, 12
v_mfma_f32_16x16x32_bf16 v[148:151], a[96:99], a[36:39], v[148:151]
ds_read_b128 a[128:131], v6 offset:16384
v_mfma_f32_16x16x32_bf16 v[152:155], a[100:103], a[36:39], v[152:155]
buffer_load_dwordx4 a[24:27], v4, s[40:43], s35 offen offset:0 sc1
v_mfma_f32_16x16x32_bf16 v[136:139], a[100:103], a[32:35], v[136:139]
ds_read_b128 a[132:135], v6 offset:17408
v_mfma_f32_16x16x32_bf16 v[140:143], a[104:107], a[32:35], v[140:143]
ds_read_b128 a[136:139], v6 offset:18432
v_mfma_f32_16x16x32_bf16 v[156:159], a[104:107], a[36:39], v[156:159]
ds_read_b128 a[140:143], v6 offset:19456
v_mfma_f32_16x16x32_bf16 v[160:163], a[108:111], a[36:39], v[160:163]
buffer_load_dwordx4 a[28:31], v4, s[40:43], s35 offen offset:1024 sc1
v_mfma_f32_16x16x32_bf16 v[144:147], a[108:111], a[32:35], v[144:147]
s_waitcnt vmcnt(10) lgkmcnt(4)
v_mfma_f32_16x16x32_bf16 v[132:135], a[112:115], a[40:43], v[132:135]
s_cmp_eq_u32 s3, 1
s_cselect_b32 s35, 1, 25
s_lshl_b32 s35, s35, 12
v_mfma_f32_16x16x32_bf16 v[148:151], a[112:115], a[44:47], v[148:151]
ds_read_b128 a[96:99], v6 offset:20480
v_mfma_f32_16x16x32_bf16 v[152:155], a[116:119], a[44:47], v[152:155]
buffer_load_dwordx4 a[32:35], v4, s[40:43], s35 offen offset:0 sc1
v_mfma_f32_16x16x32_bf16 v[136:139], a[116:119], a[40:43], v[136:139]
ds_read_b128 a[100:103], v6 offset:21504
v_mfma_f32_16x16x32_bf16 v[140:143], a[120:123], a[40:43], v[140:143]
ds_read_b128 a[104:107], v6 offset:22528
v_mfma_f32_16x16x32_bf16 v[156:159], a[120:123], a[44:47], v[156:159]
ds_read_b128 a[108:111], v6 offset:23552
v_mfma_f32_16x16x32_bf16 v[160:163], a[124:127], a[44:47], v[160:163]
buffer_load_dwordx4 a[36:39], v4, s[40:43], s35 offen offset:1024 sc1
v_mfma_f32_16x16x32_bf16 v[144:147], a[124:127], a[40:43], v[144:147]
s_waitcnt vmcnt(10) lgkmcnt(4)
v_mfma_f32_16x16x32_bf16 v[132:135], a[128:131], a[48:51], v[132:135]
s_cmp_eq_u32 s3, 2
s_cselect_b32 s35, 2, 26
s_lshl_b32 s35, s35, 12
v_mfma_f32_16x16x32_bf16 v[148:151], a[128:131], a[52:55], v[148:151]
ds_read_b128 a[112:115], v6 offset:24576
v_mfma_f32_16x16x32_bf16 v[152:155], a[132:135], a[52:55], v[152:155]
buffer_load_dwordx4 a[40:43], v4, s[40:43], s35 offen offset:0 sc1
v_mfma_f32_16x16x32_bf16 v[136:139], a[132:135], a[48:51], v[136:139]
ds_read_b128 a[116:119], v6 offset:25600
v_mfma_f32_16x16x32_bf16 v[140:143], a[136:139], a[48:51], v[140:143]
ds_read_b128 a[120:123], v6 offset:26624
v_mfma_f32_16x16x32_bf16 v[156:159], a[136:139], a[52:55], v[156:159]
ds_read_b128 a[124:127], v6 offset:27648
v_mfma_f32_16x16x32_bf16 v[160:163], a[140:143], a[52:55], v[160:163]
buffer_load_dwordx4 a[44:47], v4, s[40:43], s35 offen offset:1024 sc1
v_mfma_f32_16x16x32_bf16 v[144:147], a[140:143], a[48:51], v[144:147]
s_waitcnt vmcnt(10) lgkmcnt(4)
v_mfma_f32_16x16x32_bf16 v[132:135], a[96:99], a[0:3], v[132:135]
s_cmp_eq_u32 s3, 3
s_cselect_b32 s35, 3, 27
s_lshl_b32 s35, s35, 12
v_mfma_f32_16x16x32_bf16 v[148:151], a[96:99], a[4:7], v[148:151]
ds_read_b128 a[128:131], v6 offset:28672
v_mfma_f32_16x16x32_bf16 v[152:155], a[100:103], a[4:7], v[152:155]
buffer_load_dwordx4 a[48:51], v4, s[40:43], s35 offen offset:0 sc1
v_mfma_f32_16x16x32_bf16 v[136:139], a[100:103], a[0:3], v[136:139]
ds_read_b128 a[132:135], v6 offset:29696
v_mfma_f32_16x16x32_bf16 v[140:143], a[104:107], a[0:3], v[140:143]
ds_read_b128 a[136:139], v6 offset:30720
v_mfma_f32_16x16x32_bf16 v[156:159], a[104:107], a[4:7], v[156:159]
ds_read_b128 a[140:143], v6 offset:31744
v_mfma_f32_16x16x32_bf16 v[160:163], a[108:111], a[4:7], v[160:163]
buffer_load_dwordx4 a[52:55], v4, s[40:43], s35 offen offset:1024 sc1
v_mfma_f32_16x16x32_bf16 v[144:147], a[108:111], a[0:3], v[144:147]
s_waitcnt vmcnt(10) lgkmcnt(4)
v_mfma_f32_16x16x32_bf16 v[132:135], a[112:115], a[8:11], v[132:135]
s_cmp_eq_u32 s3, 4
s_cselect_b32 s35, 4, 28
s_lshl_b32 s35, s35, 12
v_mfma_f32_16x16x32_bf16 v[148:151], a[112:115], a[12:15], v[148:151]
ds_read_b128 a[96:99], v6 offset:32768
v_mfma_f32_16x16x32_bf16 v[152:155], a[116:119], a[12:15], v[152:155]
buffer_load_dwordx4 a[0:3], v4, s[40:43], s35 offen offset:0 sc1
v_mfma_f32_16x16x32_bf16 v[136:139], a[116:119], a[8:11], v[136:139]
ds_read_b128 a[100:103], v6 offset:33792
v_mfma_f32_16x16x32_bf16 v[140:143], a[120:123], a[8:11], v[140:143]
ds_read_b128 a[104:107], v6 offset:34816
v_mfma_f32_16x16x32_bf16 v[156:159], a[120:123], a[12:15], v[156:159]
ds_read_b128 a[108:111], v6 offset:35840
v_mfma_f32_16x16x32_bf16 v[160:163], a[124:127], a[12:15], v[160:163]
buffer_load_dwordx4 a[4:7], v4, s[40:43], s35 offen offset:1024 sc1
v_mfma_f32_16x16x32_bf16 v[144:147], a[124:127], a[8:11], v[144:147]
s_waitcnt vmcnt(10) lgkmcnt(4)
v_mfma_f32_16x16x32_bf16 v[132:135], a[128:131], a[16:19], v[132:135]
s_cmp_eq_u32 s3, 5
s_cselect_b32 s35, 5, 29
s_lshl_b32 s35, s35, 12
v_mfma_f32_16x16x32_bf16 v[148:151], a[128:131], a[20:23], v[148:151]
ds_read_b128 a[112:115], v6 offset:36864
v_mfma_f32_16x16x32_bf16 v[152:155], a[132:135], a[20:23], v[152:155]
buffer_load_dwordx4 a[8:11], v4, s[40:43], s35 offen offset:0 sc1
v_mfma_f32_16x16x32_bf16 v[136:139], a[132:135], a[16:19], v[136:139]
ds_read_b128 a[116:119], v6 offset:37888
v_mfma_f32_16x16x32_bf16 v[140:143], a[136:139], a[16:19], v[140:143]
ds_read_b128 a[120:123], v6 offset:38912
v_mfma_f32_16x16x32_bf16 v[156:159], a[136:139], a[20:23], v[156:159]
ds_read_b128 a[124:127], v6 offset:39936
v_mfma_f32_16x16x32_bf16 v[160:163], a[140:143], a[20:23], v[160:163]
buffer_load_dwordx4 a[12:15], v4, s[40:43], s35 offen offset:1024 sc1
v_mfma_f32_16x16x32_bf16 v[144:147], a[140:143], a[16:19], v[144:147]
s_waitcnt vmcnt(10) lgkmcnt(4)
v_mfma_f32_16x16x32_bf16 v[132:135], a[96:99], a[24:27], v[132:135]
s_cmp_eq_u32 s3, 6
s_cselect_b32 s35, 6, 30
s_lshl_b32 s35, s35, 12
v_mfma_f32_16x16x32_bf16 v[148:151], a[96:99], a[28:31], v[148:151]
ds_read_b128 a[128:131], v6 offset:40960
v_mfma_f32_16x16x32_bf16 v[152:155], a[100:103], a[28:31], v[152:155]
buffer_load_dwordx4 a[16:19], v4, s[40:43], s35 offen offset:0 sc1
v_mfma_f32_16x16x32_bf16 v[136:139], a[100:103], a[24:27], v[136:139]
ds_read_b128 a[132:135], v6 offset:41984
v_mfma_f32_16x16x32_bf16 v[140:143], a[104:107], a[24:27], v[140:143]
ds_read_b128 a[136:139], v6 offset:43008
v_mfma_f32_16x16x32_bf16 v[156:159], a[104:107], a[28:31], v[156:159]
ds_read_b128 a[140:143], v6 offset:44032
v_mfma_f32_16x16x32_bf16 v[160:163], a[108:111], a[28:31], v[160:163]
buffer_load_dwordx4 a[20:23], v4, s[40:43], s35 offen offset:1024 sc1
v_mfma_f32_16x16x32_bf16 v[144:147], a[108:111], a[24:27], v[144:147]
s_waitcnt vmcnt(10) lgkmcnt(4)
v_mfma_f32_16x16x32_bf16 v[132:135], a[112:115], a[32:35], v[132:135]
s_cmp_eq_u32 s3, 7
s_cselect_b32 s35, 7, 31
s_lshl_b32 s35, s35, 12
v_mfma_f32_16x16x32_bf16 v[148:151], a[112:115], a[36:39], v[148:151]
ds_read_b128 a[96:99], v6 offset:45056
v_mfma_f32_16x16x32_bf16 v[152:155], a[116:119], a[36:39], v[152:155]
buffer_load_dwordx4 a[24:27], v4, s[40:43], s35 offen offset:0 sc1
v_mfma_f32_16x16x32_bf16 v[136:139], a[116:119], a[32:35], v[136:139]
ds_read_b128 a[100:103], v6 offset:46080
v_mfma_f32_16x16x32_bf16 v[140:143], a[120:123], a[32:35], v[140:143]
ds_read_b128 a[104:107], v6 offset:47104
v_mfma_f32_16x16x32_bf16 v[156:159], a[120:123], a[36:39], v[156:159]
ds_read_b128 a[108:111], v6 offset:48128
v_mfma_f32_16x16x32_bf16 v[160:163], a[124:127], a[36:39], v[160:163]
buffer_load_dwordx4 a[28:31], v4, s[40:43], s35 offen offset:1024 sc1
v_mfma_f32_16x16x32_bf16 v[144:147], a[124:127], a[32:35], v[144:147]
s_waitcnt vmcnt(10) lgkmcnt(4)
v_mfma_f32_16x16x32_bf16 v[132:135], a[128:131], a[40:43], v[132:135]
s_add_u32 m0, s18, 0x0
s_add_u32 s44, s50, 0x1400000
v_mfma_f32_16x16x32_bf16 v[148:151], a[128:131], a[44:47], v[148:151]
ds_read_b128 a[112:115], v6 offset:49152
v_mfma_f32_16x16x32_bf16 v[152:155], a[132:135], a[44:47], v[152:155]
buffer_load_dwordx4 v1, s[4:7], s44 offen offset:0 sc1 lds
v_mfma_f32_16x16x32_bf16 v[136:139], a[132:135], a[40:43], v[136:139]
ds_read_b128 a[116:119], v6 offset:50176
v_mfma_f32_16x16x32_bf16 v[140:143], a[136:139], a[40:43], v[140:143]
ds_read_b128 a[120:123], v6 offset:51200
v_mfma_f32_16x16x32_bf16 v[156:159], a[136:139], a[44:47], v[156:159]
ds_read_b128 a[124:127], v6 offset:52224
v_mfma_f32_16x16x32_bf16 v[160:163], a[140:143], a[44:47], v[160:163]
buffer_load_dwordx4 v1, s[4:7], s44 offen offset:1024 sc1 lds
v_mfma_f32_16x16x32_bf16 v[144:147], a[140:143], a[40:43], v[144:147]
s_waitcnt vmcnt(10) lgkmcnt(4)
v_mfma_f32_16x16x32_bf16 v[132:135], a[96:99], a[48:51], v[132:135]
ds_read_b128 a[128:131], v6 offset:53248
v_mfma_f32_16x16x32_bf16 v[148:151], a[96:99], a[52:55], v[148:151]
ds_read_b128 a[132:135], v6 offset:54272
v_mfma_f32_16x16x32_bf16 v[152:155], a[100:103], a[52:55], v[152:155]
ds_read_b128 a[136:139], v6 offset:55296
v_mfma_f32_16x16x32_bf16 v[136:139], a[100:103], a[48:51], v[136:139]
ds_read_b128 a[140:143], v6 offset:56320
v_mfma_f32_16x16x32_bf16 v[140:143], a[104:107], a[48:51], v[140:143]
buffer_load_dwordx4 v1, s[4:7], s44 offen offset:2048 sc1 lds
s_add_u32 m0, s18, 0x3000
v_mfma_f32_16x16x32_bf16 v[156:159], a[104:107], a[52:55], v[156:159]
s_add_u32 s44, s50, 0x1403000
v_mfma_f32_16x16x32_bf16 v[160:163], a[108:111], a[52:55], v[160:163]
v_mfma_f32_16x16x32_bf16 v[144:147], a[108:111], a[48:51], v[144:147]
s_waitcnt vmcnt(9) lgkmcnt(4)
v_mfma_f32_16x16x32_bf16 v[132:135], a[112:115], a[0:3], v[132:135]
ds_read_b128 a[96:99], v6 offset:57344
v_mfma_f32_16x16x32_bf16 v[148:151], a[112:115], a[4:7], v[148:151]
ds_read_b128 a[100:103], v6 offset:58368
v_mfma_f32_16x16x32_bf16 v[152:155], a[116:119], a[4:7], v[152:155]
ds_read_b128 a[104:107], v6 offset:59392
v_mfma_f32_16x16x32_bf16 v[136:139], a[116:119], a[0:3], v[136:139]
buffer_load_dwordx4 v1, s[4:7], s44 offen offset:0 sc1 lds
v_mfma_f32_16x16x32_bf16 v[140:143], a[120:123], a[0:3], v[140:143]
ds_read_b128 a[108:111], v6 offset:60416
v_mfma_f32_16x16x32_bf16 v[156:159], a[120:123], a[4:7], v[156:159]
v_mfma_f32_16x16x32_bf16 v[160:163], a[124:127], a[4:7], v[160:163]
v_mfma_f32_16x16x32_bf16 v[144:147], a[124:127], a[0:3], v[144:147]
s_waitcnt vmcnt(8) lgkmcnt(4)
v_mfma_f32_16x16x32_bf16 v[132:135], a[128:131], a[8:11], v[132:135]
ds_read_b128 a[112:115], v6 offset:61440
v_mfma_f32_16x16x32_bf16 v[148:151], a[128:131], a[12:15], v[148:151]
buffer_load_dwordx4 v1, s[4:7], s44 offen offset:1024 sc1 lds
v_mfma_f32_16x16x32_bf16 v[152:155], a[132:135], a[12:15], v[152:155]
L_stub14:
s_cbranch_execz L_wret5
ds_read_b128 a[116:119], v6 offset:62464
v_mfma_f32_16x16x32_bf16 v[136:139], a[132:135], a[8:11], v[136:139]
ds_read_b128 a[120:123], v6 offset:63488
v_mfma_f32_16x16x32_bf16 v[140:143], a[136:139], a[8:11], v[140:143]
ds_read_b128 a[124:127], v6 offset:64512
v_mfma_f32_16x16x32_bf16 v[156:159], a[136:139], a[12:15], v[156:159]
v_mfma_f32_16x16x32_bf16 v[160:163], a[140:143], a[12:15], v[160:163]
v_mfma_f32_16x16x32_bf16 v[144:147], a[140:143], a[8:11], v[144:147]
buffer_load_dwordx4 v1, s[4:7], s44 offen offset:2048 sc1 lds
s_waitcnt vmcnt(8) lgkmcnt(4)
v_mfma_f32_16x16x32_bf16 v[132:135], a[96:99], a[16:19], v[132:135]
v_mfma_f32_16x16x32_bf16 v[148:151], a[96:99], a[20:23], v[148:151]
v_mfma_f32_16x16x32_bf16 v[152:155], a[100:103], a[20:23], v[152:155]
v_mfma_f32_16x16x32_bf16 v[136:139], a[100:103], a[16:19], v[136:139]
v_mfma_f32_16x16x32_bf16 v[140:143], a[104:107], a[16:19], v[140:143]
v_mfma_f32_16x16x32_bf16 v[156:159], a[104:107], a[20:23], v[156:159]
v_mfma_f32_16x16x32_bf16 v[160:163], a[108:111], a[20:23], v[160:163]
v_mfma_f32_16x16x32_bf16 v[144:147], a[108:111], a[16:19], v[144:147]
s_waitcnt vmcnt(6) lgkmcnt(0)
v_mfma_f32_16x16x32_bf16 v[132:135], a[112:115], a[24:27], v[132:135]
v_mfma_f32_16x16x32_bf16 v[148:151], a[112:115], a[28:31], v[148:151]
v_mfma_f32_16x16x32_bf16 v[152:155], a[116:119], a[28:31], v[152:155]
buffer_atomic_add v12, v10, s[4:7], s92 offen sc1
v_mfma_f32_16x16x32_bf16 v[136:139], a[116:119], a[24:27], v[136:139]
v_mfma_f32_16x16x32_bf16 v[140:143], a[120:123], a[24:27], v[140:143]
v_mfma_f32_16x16x32_bf16 v[156:159], a[120:123], a[28:31], v[156:159]
v_mfma_f32_16x16x32_bf16 v[160:163], a[124:127], a[28:31], v[160:163]
v_mfma_f32_16x16x32_bf16 v[144:147], a[124:127], a[24:27], v[144:147]
s_nop 0
v_cmp_u_f32 vcc, v132, v148
s_nop 0
s_and_b32 vcc_lo, vcc_lo, s95
s_cbranch_scc1 L_k2redo2
s_lshl_b32 s36, s32, 13
v_cvt_pk_bf16_f32 v32, v132, v133
v_cvt_pk_bf16_f32 v33, v134, v135
v_cvt_pk_bf16_f32 v34, v136, v137
v_cvt_pk_bf16_f32 v35, v138, v139
s_add_u32 s36, s36, 0x2200000
buffer_store_dwordx4 v[32:35], v4, s[4:7], s36 offen offset:0 sc1
v_cvt_pk_bf16_f32 v40, v148, v149
v_cvt_pk_bf16_f32 v41, v150, v151
v_cvt_pk_bf16_f32 v42, v152, v153
v_cvt_pk_bf16_f32 v43, v154, v155
v_cvt_pk_bf16_f32 v36, v140, v141
v_cvt_pk_bf16_f32 v37, v142, v143
v_cvt_pk_bf16_f32 v38, v144, v145
v_cvt_pk_bf16_f32 v39, v146, v147
s_add_u32 s37, s36, 4096
v_cvt_pk_bf16_f32 v44, v156, v157
v_cvt_pk_bf16_f32 v45, v158, v159
v_cvt_pk_bf16_f32 v46, v160, v161
buffer_store_dwordx4 v[40:43], v4, s[4:7], s36 offen offset:1024 sc1
v_cvt_pk_bf16_f32 v47, v162, v163
v_mfma_f32_16x16x32_bf16 v[96:99], v[32:35], v[32:35], 0
s_mov_b32 s38, 0x2c0000
s_add_u32 s92, s78, 0x60000
v_mfma_f32_16x16x32_bf16 v[92:95], v[16:19], v[32:35], 0
s_add_u32 s93, s79, 0x60000
s_add_u32 s40, s4, 0x2200000
v_mfma_f32_16x16x32_bf16 v[96:99], v[36:39], v[36:39], v[96:99]
s_addc_u32 s41, s5, 0
buffer_store_dwordx4 v[36:39], v4, s[4:7], s37 offen offset:0 sc1
v_mfma_f32_16x16x32_bf16 v[92:95], v[16:19], v[36:39], v[92:95]
s_nop 4
v_cndmask_b32 v96, v96, v97, s[46:47]
v_cndmask_b32 v98, v98, v99, s[46:47]
v_mfma_f32_16x16x32_bf16 v[104:107], v[40:43], v[40:43], 0
v_mfma_f32_16x16x32_bf16 v[100:103], v[16:19], v[40:43], 0
v_cndmask_b32 v93, v96, v98, s[48:49]
buffer_store_dwordx4 v[44:47], v4, s[4:7], s37 offen offset:1024 sc1
v_mfma_f32_16x16x32_bf16 v[104:107], v[44:47], v[44:47], v[104:107]
v_mfma_f32_16x16x32_bf16 v[100:103], v[16:19], v[44:47], v[100:103]
s_nop 6
v_cndmask_b32 v104, v104, v105, s[46:47]
v_cndmask_b32 v106, v106, v107, s[46:47]
buffer_store_dwordx2 v[92:93], v253, s[4:7], s38 offen offset:0 sc1
v_cndmask_b32 v101, v104, v106, s[48:49]
buffer_store_dwordx2 v[100:101], v253, s[4:7], s38 offen offset:2048 sc1
s_barrier
s_add_u32 m0, s18, 0x6000
s_add_u32 s44, s50, 0x1406000
buffer_load_dwordx4 v1, s[4:7], s44 offen offset:0 sc1 lds
buffer_load_dwordx4 v1, s[4:7], s44 offen offset:1024 sc1 lds
buffer_load_dwordx4 v1, s[4:7], s44 offen offset:2048 sc1 lds
s_add_u32 m0, s18, 0x9000
s_add_u32 s44, s50, 0x1409000
buffer_load_dwordx4 v1, s[4:7], s44 offen offset:0 sc1 lds
buffer_load_dwordx4 v1, s[4:7], s44 offen offset:1024 sc1 lds
buffer_load_dwordx4 v1, s[4:7], s44 offen offset:2048 sc1 lds
v_accvgpr_read_b32 v48, a216
v_accvgpr_read_b32 v49, a217
v_accvgpr_read_b32 v50, a218
v_accvgpr_read_b32 v51, a219
v_accvgpr_read_b32 v52, a220
v_accvgpr_read_b32 v53, a221
v_accvgpr_read_b32 v54, a222
v_accvgpr_read_b32 v55, a223
v_accvgpr_read_b32 v56, a224
v_accvgpr_read_b32 v57, a225
v_accvgpr_read_b32 v58, a226
v_accvgpr_read_b32 v59, a227
v_accvgpr_read_b32 v60, a228
v_accvgpr_read_b32 v61, a229
v_accvgpr_read_b32 v62, a230
v_accvgpr_read_b32 v63, a231
v_accvgpr_read_b32 v64, a232
v_accvgpr_read_b32 v65, a233
v_accvgpr_read_b32 v66, a234
v_accvgpr_read_b32 v67, a235
v_accvgpr_read_b32 v68, a236
v_accvgpr_read_b32 v69, a237
v_accvgpr_read_b32 v70, a238
v_accvgpr_read_b32 v71, a239
s_waitcnt vmcnt(6)
s_barrier
s_cmp_lg_u32 s28, 0
s_cbranch_scc1 Lsg_36
buffer_atomic_add v12, v10, s[4:7], s92 offen sc1
Lsg_36:
s_mov_b64 exec, 0
s_cmp_eq_u32 s28, 0
s_cbranch_scc1 L_stub15
L_wret6:
s_mov_b64 exec, -1
s_cmp_lt_u32 s28, 2
s_cbranch_scc1 Lwd_37
s_add_u32 m0, s18, 0xa800
s_add_u32 s44, s50, 0x140a800
buffer_load_dwordx4 v1, s[4:7], s44 offen offset:0 sc1 lds
buffer_load_dwordx4 v1, s[4:7], s44 offen offset:1024 sc1 lds
buffer_load_dwordx4 v1, s[4:7], s44 offen offset:2048 sc1 lds
s_add_u32 m0, s18, 0xc000
s_add_u32 s44, s50, 0x140c000
buffer_load_dwordx4 v1, s[4:7], s44 offen offset:0 sc1 lds
buffer_load_dwordx4 v1, s[4:7], s44 offen offset:1024 sc1 lds
buffer_load_dwordx4 v1, s[4:7], s44 offen offset:2048 sc1 lds
s_add_u32 m0, s18, 0xd800
s_add_u32 s44, s50, 0x140d800
buffer_load_dwordx4 v1, s[4:7], s44 offen offset:0 sc1 lds
buffer_load_dwordx4 v1, s[4:7], s44 offen offset:1024 sc1 lds
buffer_load_dwordx4 v1, s[4:7], s44 offen offset:2048 sc1 lds
s_add_u32 m0, s18, 0xf000
s_add_u32 s44, s50, 0x140f000
buffer_load_dwordx4 v1, s[4:7], s44 offen offset:0 sc1 lds
buffer_load_dwordx4 v1, s[4:7], s44 offen offset:1024 sc1 lds
buffer_load_dwordx4 v1, s[4:7], s44 offen offset:2048 sc1 lds
s_add_u32 m0, s18, 0x10800
s_add_u32 s44, s50, 0x1410800
buffer_load_dwordx4 v1, s[4:7], s44 offen offset:0 sc1 lds
buffer_load_dwordx4 v1, s[4:7], s44 offen offset:1024 sc1 lds
buffer_load_dwordx4 v1, s[4:7], s44 offen offset:2048 sc1 lds
s_add_u32 m0, s18, 0x12000
s_add_u32 s44, s50, 0x1412000
buffer_load_dwordx4 v1, s[4:7], s44 offen offset:0 sc1 lds
buffer_load_dwordx4 v1, s[4:7], s44 offen offset:1024 sc1 lds
buffer_load_dwordx4 v1, s[4:7], s44 offen offset:2048 sc1 lds
s_add_u32 m0, s18, 0x13800
s_add_u32 s44, s50, 0x1413800
buffer_load_dwordx4 v1, s[4:7], s44 offen offset:0 sc1 lds
buffer_load_dwordx4 v1, s[4:7], s44 offen offset:1024 sc1 lds
buffer_load_dwordx4 v1, s[4:7], s44 offen offset:2048 sc1 lds
s_add_u32 m0, s18, 0x15000
s_add_u32 s44, s50, 0x1415000
buffer_load_dwordx4 v1, s[4:7], s44 offen offset:0 sc1 lds
buffer_load_dwordx4 v1, s[4:7], s44 offen offset:1024 sc1 lds
buffer_load_dwordx4 v1, s[4:7], s44 offen offset:2048 sc1 lds
s_add_u32 m0, s18, 0x16800
s_add_u32 s44, s50, 0x1416800
buffer_load_dwordx4 v1, s[4:7], s44 offen offset:0 sc1 lds
buffer_load_dwordx4 v1, s[4:7], s44 offen offset:1024 sc1 lds
buffer_load_dwordx4 v1, s[4:7], s44 offen offset:2048 sc1 lds
s_add_u32 m0, s18, 0x18000
s_add_u32 s44, s50, 0x1418000
buffer_load_dwordx4 v1, s[4:7], s44 offen offset:0 sc1 lds
buffer_load_dwordx4 v1, s[4:7], s44 offen offset:1024 sc1 lds
buffer_load_dwordx4 v1, s[4:7], s44 offen offset:2048 sc1 lds
Lwd_37:
s_cmp_lg_u32 s28, 1
s_cbranch_scc1 Lpo_40
s_add_u32 s36, s67, 0x60000
s_mov_b32 s37, 0
v_mov_b32 v11, 0
buffer_atomic_add v11, v251, s[4:7], s36 offen sc0 sc1
s_sleep 4
Lpoll_38:
v_mov_b32 v234, 0
buffer_atomic_add v234, v251, s[4:7], s36 offen sc0 sc1
s_waitcnt vmcnt(1)
v_readfirstlane_b32 s38, v11
s_nop 0
s_cmp_ge_u32 s38, 32
s_cbranch_scc1 Lpe_39
v_mov_b32 v11, 0
buffer_atomic_add v11, v251, s[4:7], s36 offen sc0 sc1
s_waitcnt vmcnt(1)
v_readfirstlane_b32 s38, v234
s_nop 0
s_cmp_ge_u32 s38, 32
s_cbranch_scc1 Lpe_39
s_add_u32 s37, s37, 1
s_cmp_lt_u32 s37, 0x80000
s_cbranch_scc1 Lpoll_38
s_waitcnt vmcnt(0)
Lpo_40:
s_waitcnt vmcnt(30) lgkmcnt(0)
s_cmp_ge_u32 s28, 2
s_cbranch_scc1 Lw_41
s_waitcnt vmcnt(0)
Lw_41:
Lpe_39:
s_barrier
s_add_u32 s9, s66, 0x30080
s_mov_b32 s35, 0
s_mov_b32 s33, 0x1000
buffer_load_dwordx4 a[0:3], v2, s[40:43], s35 offen offset:0 sc1
buffer_load_dwordx4 a[4:7], v2, s[40:43], s33 offen offset:0 sc1
buffer_load_dwordx4 a[8:11], v2, s[40:43], s35 offen offset:1024 sc1
buffer_load_dwordx4 a[12:15], v2, s[40:43], s33 offen offset:1024 sc1
buffer_load_dwordx4 a[16:19], v2, s[40:43], s35 offen offset:2048 sc1
buffer_load_dwordx4 a[20:23], v2, s[40:43], s33 offen offset:2048 sc1
buffer_load_dwordx4 a[24:27], v2, s[40:43], s35 offen offset:3072 sc1
buffer_load_dwordx4 a[28:31], v2, s[40:43], s33 offen offset:3072 sc1
s_add_u32 s35, s35, 8192
s_add_u32 s33, s33, 8192
buffer_load_dwordx4 a[32:35], v2, s[40:43], s35 offen offset:0 sc1
buffer_load_dwordx4 a[36:39], v2, s[40:43], s33 offen offset:0 sc1
buffer_load_dwordx4 a[40:43], v2, s[40:43], s35 offen offset:1024 sc1
buffer_load_dwordx4 a[44:47], v2, s[40:43], s33 offen offset:1024 sc1
buffer_load_dwordx4 a[48:51], v2, s[40:43], s35 offen offset:2048 sc1
buffer_load_dwordx4 a[52:55], v2, s[40:43], s33 offen offset:2048 sc1
buffer_load_dwordx4 a[56:59], v2, s[40:43], s35 offen offset:3072 sc1
buffer_load_dwordx4 a[60:63], v2, s[40:43], s33 offen offset:3072 sc1
s_add_u32 s35, s35, 8192
s_add_u32 s33, s33, 8192
v_add_u32 v5, 0, v1
ds_read_b128 a[96:99], v5 offset:2048
ds_read_b128 a[100:103], v5 offset:8192
ds_read_b128 a[104:107], v5 offset:3072
ds_read_b128 a[108:111], v5 offset:9216
ds_read_b128 a[112:115], v5 offset:4096
ds_read_b128 a[116:119], v5 offset:10240
s_waitcnt vmcnt(14) lgkmcnt(4)
v_mfma_f32_16x16x32_bf16 v[140:143], a[96:99], a[0:3], 0
s_add_u32 m0, s18, 0x1b000
s_add_u32 s44, s50, 0x141b000
v_mfma_f32_16x16x32_bf16 v[140:143], a[100:103], a[4:7], v[140:143]
buffer_load_dwordx4 a[64:67], v2, s[40:43], s35 offen offset:0 sc1
s_waitcnt vmcnt(13)
v_mfma_f32_16x16x32_bf16 v[164:167], a[100:103], a[12:15], 0
ds_read_b128 a[128:131], v5 offset:5120
v_mfma_f32_16x16x32_bf16 v[164:167], a[96:99], a[8:11], v[164:167]
ds_read_b128 a[132:135], v5 offset:11264
s_waitcnt vmcnt(12)
v_mfma_f32_16x16x32_bf16 v[188:191], a[96:99], a[16:19], 0
s_waitcnt vmcnt(11)
v_mfma_f32_16x16x32_bf16 v[188:191], a[100:103], a[20:23], v[188:191]
buffer_load_dwordx4 a[68:71], v2, s[40:43], s33 offen offset:0 sc1
s_waitcnt vmcnt(10)
v_mfma_f32_16x16x32_bf16 v[212:215], a[100:103], a[28:31], 0
ds_read_b128 a[136:139], v5 offset:0
v_mfma_f32_16x16x32_bf16 v[212:215], a[96:99], a[24:27], v[212:215]
s_waitcnt lgkmcnt(6)
v_mfma_f32_16x16x32_bf16 v[216:219], a[104:107], a[24:27], 0
ds_read_b128 a[140:143], v5 offset:6144
s_waitcnt lgkmcnt(6)
v_mfma_f32_16x16x32_bf16 v[216:219], a[108:111], a[28:31], v[216:219]
v_mfma_f32_16x16x32_bf16 v[192:195], a[108:111], a[20:23], 0
buffer_load_dwordx4 v1, s[4:7], s44 offen offset:0 sc1 lds
v_mfma_f32_16x16x32_bf16 v[192:195], a[104:107], a[16:19], v[192:195]
ds_read_b128 a[144:147], v5 offset:1024
v_mfma_f32_16x16x32_bf16 v[168:171], a[104:107], a[8:11], 0
v_mfma_f32_16x16x32_bf16 v[168:171], a[108:111], a[12:15], v[168:171]
ds_read_b128 a[148:151], v5 offset:7168
v_mfma_f32_16x16x32_bf16 v[144:147], a[108:111], a[4:7], 0
v_mfma_f32_16x16x32_bf16 v[144:147], a[104:107], a[0:3], v[144:147]
buffer_load_dwordx4 a[72:75], v2, s[40:43], s35 offen offset:1024 sc1
s_waitcnt lgkmcnt(7)
v_mfma_f32_16x16x32_bf16 v[148:151], a[112:115], a[0:3], 0
s_waitcnt lgkmcnt(6)
v_mfma_f32_16x16x32_bf16 v[148:151], a[116:119], a[4:7], v[148:151]
v_mfma_f32_16x16x32_bf16 v[172:175], a[116:119], a[12:15], 0
v_mfma_f32_16x16x32_bf16 v[172:175], a[112:115], a[8:11], v[172:175]
v_mfma_f32_16x16x32_bf16 v[196:199], a[112:115], a[16:19], 0
buffer_load_dwordx4 a[76:79], v2, s[40:43], s33 offen offset:1024 sc1
v_mfma_f32_16x16x32_bf16 v[196:199], a[116:119], a[20:23], v[196:199]
v_mfma_f32_16x16x32_bf16 v[220:223], a[116:119], a[28:31], 0
v_mfma_f32_16x16x32_bf16 v[220:223], a[112:115], a[24:27], v[220:223]
s_waitcnt lgkmcnt(0)
v_mfma_f32_16x16x32_bf16 v[224:227], a[128:131], a[24:27], 0
ds_read_b128 a[96:99], v5 offset:14336
v_mfma_f32_16x16x32_bf16 v[224:227], a[132:135], a[28:31], v[224:227]
buffer_load_dwordx4 a[80:83], v2, s[40:43], s35 offen offset:2048 sc1
v_mfma_f32_16x16x32_bf16 v[200:203], a[132:135], a[20:23], 0
ds_read_b128 a[100:103], v5 offset:20480
v_mfma_f32_16x16x32_bf16 v[200:203], a[128:131], a[16:19], v[200:203]
v_mfma_f32_16x16x32_bf16 v[176:179], a[128:131], a[8:11], 0
v_mfma_f32_16x16x32_bf16 v[176:179], a[132:135], a[12:15], v[176:179]
buffer_load_dwordx4 a[84:87], v2, s[40:43], s33 offen offset:2048 sc1
v_mfma_f32_16x16x32_bf16 v[152:155], a[132:135], a[4:7], 0
ds_read_b128 a[104:107], v5 offset:15360
v_mfma_f32_16x16x32_bf16 v[152:155], a[128:131], a[0:3], v[152:155]
v_mfma_f32_16x16x32_bf16 v[132:135], a[136:139], a[0:3], 0
ds_read_b128 a[108:111], v5 offset:21504
v_mfma_f32_16x16x32_bf16 v[132:135], a[140:143], a[4:7], v[132:135]
v_mfma_f32_16x16x32_bf16 v[156:159], a[140:143], a[12:15], 0
buffer_load_dwordx4 v1, s[4:7], s44 offen offset:1024 sc1 lds
v_mfma_f32_16x16x32_bf16 v[156:159], a[136:139], a[8:11], v[156:159]
ds_read_b128 a[112:115], v5 offset:16384
v_mfma_f32_16x16x32_bf16 v[180:183], a[136:139], a[16:19], 0
v_mfma_f32_16x16x32_bf16 v[180:183], a[140:143], a[20:23], v[180:183]
ds_read_b128 a[116:119], v5 offset:22528
v_mfma_f32_16x16x32_bf16 v[204:207], a[140:143], a[28:31], 0
v_mfma_f32_16x16x32_bf16 v[204:207], a[136:139], a[24:27], v[204:207]
buffer_load_dwordx4 a[88:91], v2, s[40:43], s35 offen offset:3072 sc1
v_mfma_f32_16x16x32_bf16 v[208:211], a[144:147], a[24:27], 0
v_mfma_f32_16x16x32_bf16 v[208:211], a[148:151], a[28:31], v[208:211]
v_mfma_f32_16x16x32_bf16 v[184:187], a[148:151], a[20:23], 0
v_mfma_f32_16x16x32_bf16 v[184:187], a[144:147], a[16:19], v[184:187]
v_mfma_f32_16x16x32_bf16 v[160:163], a[144:147], a[8:11], 0
buffer_load_dwordx4 a[92:95], v2, s[40:43], s33 offen offset:3072 sc1
s_add_u32 s35, s35, 8192
v_mfma_f32_16x16x32_bf16 v[160:163], a[148:151], a[12:15], v[160:163]
s_add_u32 s33, s33, 8192
v_mfma_f32_16x16x32_bf16 v[136:139], a[148:151], a[4:7], 0
v_mfma_f32_16x16x32_bf16 v[136:139], a[144:147], a[0:3], v[136:139]
s_waitcnt vmcnt(10) lgkmcnt(0)
v_mfma_f32_16x16x32_bf16 v[140:143], a[96:99], a[32:35], v[140:143]
ds_read_b128 a[128:131], v5 offset:17408
v_mfma_f32_16x16x32_bf16 v[140:143], a[100:103], a[36:39], v[140:143]
buffer_load_dwordx4 a[0:3], v2, s[40:43], s35 offen offset:0 sc1
v_mfma_f32_16x16x32_bf16 v[164:167], a[100:103], a[44:47], v[164:167]
ds_read_b128 a[132:135], v5 offset:23552
v_mfma_f32_16x16x32_bf16 v[164:167], a[96:99], a[40:43], v[164:167]
v_mfma_f32_16x16x32_bf16 v[188:191], a[96:99], a[48:51], v[188:191]
v_mfma_f32_16x16x32_bf16 v[188:191], a[100:103], a[52:55], v[188:191]
buffer_load_dwordx4 v1, s[4:7], s44 offen offset:2048 sc1 lds
s_add_u32 m0, s18, 0x1e000
v_mfma_f32_16x16x32_bf16 v[212:215], a[100:103], a[60:63], v[212:215]
s_add_u32 s44, s50, 0x141e000
ds_read_b128 a[136:139], v5 offset:12288
v_mfma_f32_16x16x32_bf16 v[212:215], a[96:99], a[56:59], v[212:215]
v_mfma_f32_16x16x32_bf16 v[216:219], a[104:107], a[56:59], v[216:219]
ds_read_b128 a[140:143], v5 offset:18432
v_mfma_f32_16x16x32_bf16 v[216:219], a[108:111], a[60:63], v[216:219]
buffer_load_dwordx4 a[4:7], v2, s[40:43], s33 offen offset:0 sc1
v_mfma_f32_16x16x32_bf16 v[192:195], a[108:111], a[52:55], v[192:195]
ds_read_b128 a[144:147], v5 offset:13312
v_mfma_f32_16x16x32_bf16 v[192:195], a[104:107], a[48:51], v[192:195]
v_mfma_f32_16x16x32_bf16 v[168:171], a[104:107], a[40:43], v[168:171]
v_mfma_f32_16x16x32_bf16 v[168:171], a[108:111], a[44:47], v[168:171]
buffer_load_dwordx4 a[8:11], v2, s[40:43], s35 offen offset:1024 sc1
v_mfma_f32_16x16x32_bf16 v[144:147], a[108:111], a[36:39], v[144:147]
ds_read_b128 a[148:151], v5 offset:19456
v_mfma_f32_16x16x32_bf16 v[144:147], a[104:107], a[32:35], v[144:147]
v_mfma_f32_16x16x32_bf16 v[148:151], a[112:115], a[32:35], v[148:151]
v_mfma_f32_16x16x32_bf16 v[148:151], a[116:119], a[36:39], v[148:151]
buffer_load_dwordx4 v1, s[4:7], s44 offen offset:0 sc1 lds
v_mfma_f32_16x16x32_bf16 v[172:175], a[116:119], a[44:47], v[172:175]
v_mfma_f32_16x16x32_bf16 v[172:175], a[112:115], a[40:43], v[172:175]
v_mfma_f32_16x16x32_bf16 v[196:199], a[112:115], a[48:51], v[196:199]
v_mfma_f32_16x16x32_bf16 v[196:199], a[116:119], a[52:55], v[196:199]
buffer_load_dwordx4 a[12:15], v2, s[40:43], s33 offen offset:1024 sc1
v_mfma_f32_16x16x32_bf16 v[220:223], a[116:119], a[60:63], v[220:223]
v_mfma_f32_16x16x32_bf16 v[220:223], a[112:115], a[56:59], v[220:223]
s_waitcnt lgkmcnt(0)
v_mfma_f32_16x16x32_bf16 v[224:227], a[128:131], a[56:59], v[224:227]
ds_read_b128 a[96:99], v5 offset:26624
v_mfma_f32_16x16x32_bf16 v[224:227], a[132:135], a[60:63], v[224:227]
buffer_load_dwordx4 a[16:19], v2, s[40:43], s35 offen offset:2048 sc1
v_mfma_f32_16x16x32_bf16 v[200:203], a[132:135], a[52:55], v[200:203]
ds_read_b128 a[100:103], v5 offset:32768
v_mfma_f32_16x16x32_bf16 v[200:203], a[128:131], a[48:51], v[200:203]
v_mfma_f32_16x16x32_bf16 v[176:179], a[128:131], a[40:43], v[176:179]
v_mfma_f32_16x16x32_bf16 v[176:179], a[132:135], a[44:47], v[176:179]
buffer_load_dwordx4 a[20:23], v2, s[40:43], s33 offen offset:2048 sc1
v_mfma_f32_16x16x32_bf16 v[152:155], a[132:135], a[36:39], v[152:155]
ds_read_b128 a[104:107], v5 offset:27648
v_mfma_f32_16x16x32_bf16 v[152:155], a[128:131], a[32:35], v[152:155]
v_mfma_f32_16x16x32_bf16 v[132:135], a[136:139], a[32:35], v[132:135]
ds_read_b128 a[108:111], v5 offset:33792
v_mfma_f32_16x16x32_bf16 v[132:135], a[140:143], a[36:39], v[132:135]
v_mfma_f32_16x16x32_bf16 v[156:159], a[140:143], a[44:47], v[156:159]
buffer_load_dwordx4 v1, s[4:7], s44 offen offset:1024 sc1 lds
v_mfma_f32_16x16x32_bf16 v[156:159], a[136:139], a[40:43], v[156:159]
ds_read_b128 a[112:115], v5 offset:28672
v_mfma_f32_16x16x32_bf16 v[180:183], a[136:139], a[48:51], v[180:183]
v_mfma_f32_16x16x32_bf16 v[180:183], a[140:143], a[52:55], v[180:183]
ds_read_b128 a[116:119], v5 offset:34816
v_mfma_f32_16x16x32_bf16 v[204:207], a[140:143], a[60:63], v[204:207]
v_mfma_f32_16x16x32_bf16 v[204:207], a[136:139], a[56:59], v[204:207]
buffer_load_dwordx4 a[24:27], v2, s[40:43], s35 offen offset:3072 sc1
v_mfma_f32_16x16x32_bf16 v[208:211], a[144:147], a[56:59], v[208:211]
v_mfma_f32_16x16x32_bf16 v[208:211], a[148:151], a[60:63], v[208:211]
v_mfma_f32_16x16x32_bf16 v[184:187], a[148:151], a[52:55], v[184:187]
v_mfma_f32_16x16x32_bf16 v[184:187], a[144:147], a[48:51], v[184:187]
v_mfma_f32_16x16x32_bf16 v[160:163], a[144:147], a[40:43], v[160:163]
buffer_load_dwordx4 a[28:31], v2, s[40:43], s33 offen offset:3072 sc1
s_add_u32 s35, s35, 8192
v_mfma_f32_16x16x32_bf16 v[160:163], a[148:151], a[44:47], v[160:163]
s_add_u32 s33, s33, 8192
v_mfma_f32_16x16x32_bf16 v[136:139], a[148:151], a[36:39], v[136:139]
v_mfma_f32_16x16x32_bf16 v[136:139], a[144:147], a[32:35], v[136:139]
s_waitcnt vmcnt(11) lgkmcnt(0)
v_mfma_f32_16x16x32_bf16 v[140:143], a[96:99], a[64:67], v[140:143]
ds_read_b128 a[128:131], v5 offset:29696
v_mfma_f32_16x16x32_bf16 v[140:143], a[100:103], a[68:71], v[140:143]
buffer_load_dwordx4 a[32:35], v2, s[40:43], s35 offen offset:0 sc1
v_mfma_f32_16x16x32_bf16 v[164:167], a[100:103], a[76:79], v[164:167]
ds_read_b128 a[132:135], v5 offset:35840
v_mfma_f32_16x16x32_bf16 v[164:167], a[96:99], a[72:75], v[164:167]
v_mfma_f32_16x16x32_bf16 v[188:191], a[96:99], a[80:83], v[188:191]
v_mfma_f32_16x16x32_bf16 v[188:191], a[100:103], a[84:87], v[188:191]
buffer_load_dwordx4 a[36:39], v2, s[40:43], s33 offen offset:0 sc1
v_mfma_f32_16x16x32_bf16 v[212:215], a[100:103], a[92:95], v[212:215]
ds_read_b128 a[136:139], v5 offset:24576
v_mfma_f32_16x16x32_bf16 v[212:215], a[96:99], a[88:91], v[212:215]
v_mfma_f32_16x16x32_bf16 v[216:219], a[104:107], a[88:91], v[216:219]
ds_read_b128 a[140:143], v5 offset:30720
v_mfma_f32_16x16x32_bf16 v[216:219], a[108:111], a[92:95], v[216:219]
v_mfma_f32_16x16x32_bf16 v[192:195], a[108:111], a[84:87], v[192:195]
buffer_load_dwordx4 v1, s[4:7], s44 offen offset:2048 sc1 lds
s_add_u32 m0, s18, 0x21000
v_mfma_f32_16x16x32_bf16 v[192:195], a[104:107], a[80:83], v[192:195]
s_add_u32 s44, s50, 0x1421000
ds_read_b128 a[144:147], v5 offset:25600
v_mfma_f32_16x16x32_bf16 v[168:171], a[104:107], a[72:75], v[168:171]
v_mfma_f32_16x16x32_bf16 v[168:171], a[108:111], a[76:79], v[168:171]
ds_read_b128 a[148:151], v5 offset:31744
v_mfma_f32_16x16x32_bf16 v[144:147], a[108:111], a[68:71], v[144:147]
v_mfma_f32_16x16x32_bf16 v[144:147], a[104:107], a[64:67], v[144:147]
buffer_load_dwordx4 a[40:43], v2, s[40:43], s35 offen offset:1024 sc1
v_mfma_f32_16x16x32_bf16 v[148:151], a[112:115], a[64:67], v[148:151]
v_mfma_f32_16x16x32_bf16 v[148:151], a[116:119], a[68:71], v[148:151]
v_mfma_f32_16x16x32_bf16 v[172:175], a[116:119], a[76:79], v[172:175]
v_mfma_f32_16x16x32_bf16 v[172:175], a[112:115], a[72:75], v[172:175]
v_mfma_f32_16x16x32_bf16 v[196:199], a[112:115], a[80:83], v[196:199]
buffer_load_dwordx4 a[44:47], v2, s[40:43], s33 offen offset:1024 sc1
v_mfma_f32_16x16x32_bf16 v[196:199], a[116:119], a[84:87], v[196:199]
v_mfma_f32_16x16x32_bf16 v[220:223], a[116:119], a[92:95], v[220:223]
v_mfma_f32_16x16x32_bf16 v[220:223], a[112:115], a[88:91], v[220:223]
s_waitcnt lgkmcnt(0)
v_mfma_f32_16x16x32_bf16 v[224:227], a[128:131], a[88:91], v[224:227]
ds_read_b128 a[96:99], v5 offset:38912
v_mfma_f32_16x16x32_bf16 v[224:227], a[132:135], a[92:95], v[224:227]
buffer_load_dwordx4 a[48:51], v2, s[40:43], s35 offen offset:2048 sc1
v_mfma_f32_16x16x32_bf16 v[200:203], a[132:135], a[84:87], v[200:203]
ds_read_b128 a[100:103], v5 offset:45056
v_mfma_f32_16x16x32_bf16 v[200:203], a[128:131], a[80:83], v[200:203]
v_mfma_f32_16x16x32_bf16 v[176:179], a[128:131], a[72:75], v[176:179]
v_mfma_f32_16x16x32_bf16 v[176:179], a[132:135], a[76:79], v[176:179]
buffer_load_dwordx4 a[52:55], v2, s[40:43], s33 offen offset:2048 sc1
v_mfma_f32_16x16x32_bf16 v[152:155], a[132:135], a[68:71], v[152:155]
ds_read_b128 a[104:107], v5 offset:39936
v_mfma_f32_16x16x32_bf16 v[152:155], a[128:131], a[64:67], v[152:155]
v_mfma_f32_16x16x32_bf16 v[132:135], a[136:139], a[64:67], v[132:135]
ds_read_b128 a[108:111], v5 offset:46080
v_mfma_f32_16x16x32_bf16 v[132:135], a[140:143], a[68:71], v[132:135]
v_mfma_f32_16x16x32_bf16 v[156:159], a[140:143], a[76:79], v[156:159]
buffer_load_dwordx4 v1, s[4:7], s44 offen offset:0 sc1 lds
v_mfma_f32_16x16x32_bf16 v[156:159], a[136:139], a[72:75], v[156:159]
ds_read_b128 a[112:115], v5 offset:40960
v_mfma_f32_16x16x32_bf16 v[180:183], a[136:139], a[80:83], v[180:183]
v_mfma_f32_16x16x32_bf16 v[180:183], a[140:143], a[84:87], v[180:183]
ds_read_b128 a[116:119], v5 offset:47104
v_mfma_f32_16x16x32_bf16 v[204:207], a[140:143], a[92:95], v[204:207]
v_mfma_f32_16x16x32_bf16 v[204:207], a[136:139], a[88:91], v[204:207]
buffer_load_dwordx4 a[56:59], v2, s[40:43], s35 offen offset:3072 sc1
v_mfma_f32_16x16x32_bf16 v[208:211], a[144:147], a[88:91], v[208:211]
v_mfma_f32_16x16x32_bf16 v[208:211], a[148:151], a[92:95], v[208:211]
v_mfma_f32_16x16x32_bf16 v[184:187], a[148:151], a[84:87], v[184:187]
v_mfma_f32_16x16x32_bf16 v[184:187], a[144:147], a[80:83], v[184:187]
v_mfma_f32_16x16x32_bf16 v[160:163], a[144:147], a[72:75], v[160:163]
buffer_load_dwordx4 a[60:63], v2, s[40:43], s33 offen offset:3072 sc1
s_add_u32 s35, s35, 8192
v_mfma_f32_16x16x32_bf16 v[160:163], a[148:151], a[76:79], v[160:163]
s_add_u32 s33, s33, 8192
v_mfma_f32_16x16x32_bf16 v[136:139], a[148:151], a[68:71], v[136:139]
v_mfma_f32_16x16x32_bf16 v[136:139], a[144:147], a[64:67], v[136:139]
s_waitcnt vmcnt(10) lgkmcnt(0)
v_mfma_f32_16x16x32_bf16 v[140:143], a[96:99], a[0:3], v[140:143]
ds_read_b128 a[128:131], v5 offset:41984
v_mfma_f32_16x16x32_bf16 v[140:143], a[100:103], a[4:7], v[140:143]
buffer_load_dwordx4 a[64:67], v2, s[40:43], s35 offen offset:0 sc1
v_mfma_f32_16x16x32_bf16 v[164:167], a[100:103], a[12:15], v[164:167]
ds_read_b128 a[132:135], v5 offset:48128
v_mfma_f32_16x16x32_bf16 v[164:167], a[96:99], a[8:11], v[164:167]
v_mfma_f32_16x16x32_bf16 v[188:191], a[96:99], a[16:19], v[188:191]
v_mfma_f32_16x16x32_bf16 v[188:191], a[100:103], a[20:23], v[188:191]
buffer_load_dwordx4 v1, s[4:7], s44 offen offset:1024 sc1 lds
v_mfma_f32_16x16x32_bf16 v[212:215], a[100:103], a[28:31], v[212:215]
ds_read_b128 a[136:139], v5 offset:36864
v_mfma_f32_16x16x32_bf16 v[212:215], a[96:99], a[24:27], v[212:215]
v_mfma_f32_16x16x32_bf16 v[216:219], a[104:107], a[24:27], v[216:219]
ds_read_b128 a[140:143], v5 offset:43008
v_mfma_f32_16x16x32_bf16 v[216:219], a[108:111], a[28:31], v[216:219]
buffer_load_dwordx4 a[68:71], v2, s[40:43], s33 offen offset:0 sc1
v_mfma_f32_16x16x32_bf16 v[192:195], a[108:111], a[20:23], v[192:195]
ds_read_b128 a[144:147], v5 offset:37888
v_mfma_f32_16x16x32_bf16 v[192:195], a[104:107], a[16:19], v[192:195]
v_mfma_f32_16x16x32_bf16 v[168:171], a[104:107], a[8:11], v[168:171]
v_mfma_f32_16x16x32_bf16 v[168:171], a[108:111], a[12:15], v[168:171]
buffer_load_dwordx4 a[72:75], v2, s[40:43], s35 offen offset:1024 sc1
v_mfma_f32_16x16x32_bf16 v[144:147], a[108:111], a[4:7], v[144:147]
ds_read_b128 a[148:151], v5 offset:44032
v_mfma_f32_16x16x32_bf16 v[144:147], a[104:107], a[0:3], v[144:147]
v_mfma_f32_16x16x32_bf16 v[148:151], a[112:115], a[0:3], v[148:151]
v_mfma_f32_16x16x32_bf16 v[148:151], a[116:119], a[4:7], v[148:151]
buffer_load_dwordx4 v1, s[4:7], s44 offen offset:2048 sc1 lds
s_add_u32 s88, s82, 0x2c0000
v_mfma_f32_16x16x32_bf16 v[172:175], a[116:119], a[12:15], v[172:175]
v_mfma_f32_16x16x32_bf16 v[172:175], a[112:115], a[8:11], v[172:175]
v_mfma_f32_16x16x32_bf16 v[196:199], a[112:115], a[16:19], v[196:199]
v_mfma_f32_16x16x32_bf16 v[196:199], a[116:119], a[20:23], v[196:199]
buffer_load_dwordx4 a[76:79], v2, s[40:43], s33 offen offset:1024 sc1
v_mfma_f32_16x16x32_bf16 v[220:223], a[116:119], a[28:31], v[220:223]
v_mfma_f32_16x16x32_bf16 v[220:223], a[112:115], a[24:27], v[220:223]
s_waitcnt lgkmcnt(0)
s_barrier
v_mfma_f32_16x16x32_bf16 v[224:227], a[128:131], a[24:27], v[224:227]
v_add_u32 v5, 49152, v1
v_mfma_f32_16x16x32_bf16 v[224:227], a[132:135], a[28:31], v[224:227]
buffer_load_dwordx4 a[80:83], v2, s[40:43], s35 offen offset:2048 sc1
v_mfma_f32_16x16x32_bf16 v[200:203], a[132:135], a[20:23], v[200:203]
ds_read_b128 a[96:99], v5 offset:2048
v_mfma_f32_16x16x32_bf16 v[200:203], a[128:131], a[16:19], v[200:203]
ds_read_b128 a[100:103], v5 offset:8192
v_mfma_f32_16x16x32_bf16 v[176:179], a[128:131], a[8:11], v[176:179]
v_mfma_f32_16x16x32_bf16 v[176:179], a[132:135], a[12:15], v[176:179]
buffer_load_dwordx4 a[84:87], v2, s[40:43], s33 offen offset:2048 sc1
v_mfma_f32_16x16x32_bf16 v[152:155], a[132:135], a[4:7], v[152:155]
ds_read_b128 a[104:107], v5 offset:3072
v_mfma_f32_16x16x32_bf16 v[152:155], a[128:131], a[0:3], v[152:155]
v_mfma_f32_16x16x32_bf16 v[132:135], a[136:139], a[0:3], v[132:135]
ds_read_b128 a[108:111], v5 offset:9216
v_mfma_f32_16x16x32_bf16 v[132:135], a[140:143], a[4:7], v[132:135]
v_mfma_f32_16x16x32_bf16 v[156:159], a[140:143], a[12:15], v[156:159]
buffer_load_dwordx4 v[92:95], v1, s[4:7], s88 offen offset:0 sc1
v_mfma_f32_16x16x32_bf16 v[156:159], a[136:139], a[8:11], v[156:159]
ds_read_b128 a[112:115], v5 offset:4096
v_mfma_f32_16x16x32_bf16 v[180:183], a[136:139], a[16:19], v[180:183]
v_mfma_f32_16x16x32_bf16 v[180:183], a[140:143], a[20:23], v[180:183]
ds_read_b128 a[116:119], v5 offset:10240
v_mfma_f32_16x16x32_bf16 v[204:207], a[140:143], a[28:31], v[204:207]
v_mfma_f32_16x16x32_bf16 v[204:207], a[136:139], a[24:27], v[204:207]
buffer_load_dwordx4 a[88:91], v2, s[40:43], s35 offen offset:3072 sc1
v_mfma_f32_16x16x32_bf16 v[208:211], a[144:147], a[24:27], v[208:211]
v_mfma_f32_16x16x32_bf16 v[208:211], a[148:151], a[28:31], v[208:211]
v_mfma_f32_16x16x32_bf16 v[184:187], a[148:151], a[20:23], v[184:187]
v_mfma_f32_16x16x32_bf16 v[184:187], a[144:147], a[16:19], v[184:187]
v_mfma_f32_16x16x32_bf16 v[160:163], a[144:147], a[8:11], v[160:163]
buffer_load_dwordx4 a[92:95], v2, s[40:43], s33 offen offset:3072 sc1
L_stub15:
s_cbranch_execz L_stub16
s_add_u32 s35, s35, 8192
v_mfma_f32_16x16x32_bf16 v[160:163], a[148:151], a[12:15], v[160:163]
s_add_u32 s33, s33, 8192
v_mfma_f32_16x16x32_bf16 v[136:139], a[148:151], a[4:7], v[136:139]
v_mfma_f32_16x16x32_bf16 v[136:139], a[144:147], a[0:3], v[136:139]
s_waitcnt vmcnt(11) lgkmcnt(0)
v_mfma_f32_16x16x32_bf16 v[140:143], a[96:99], a[32:35], v[140:143]
ds_read_b128 a[128:131], v5 offset:5120
v_mfma_f32_16x16x32_bf16 v[140:143], a[100:103], a[36:39], v[140:143]
buffer_load_dwordx4 a[0:3], v2, s[40:43], s35 offen offset:0 sc1
v_mfma_f32_16x16x32_bf16 v[164:167], a[100:103], a[44:47], v[164:167]
ds_read_b128 a[132:135], v5 offset:11264
v_mfma_f32_16x16x32_bf16 v[164:167], a[96:99], a[40:43], v[164:167]
v_mfma_f32_16x16x32_bf16 v[188:191], a[96:99], a[48:51], v[188:191]
v_mfma_f32_16x16x32_bf16 v[188:191], a[100:103], a[52:55], v[188:191]
buffer_load_dwordx4 a[4:7], v2, s[40:43], s33 offen offset:0 sc1
v_mfma_f32_16x16x32_bf16 v[212:215], a[100:103], a[60:63], v[212:215]
ds_read_b128 a[136:139], v5 offset:0
v_mfma_f32_16x16x32_bf16 v[212:215], a[96:99], a[56:59], v[212:215]
v_mfma_f32_16x16x32_bf16 v[216:219], a[104:107], a[56:59], v[216:219]
ds_read_b128 a[140:143], v5 offset:6144
v_mfma_f32_16x16x32_bf16 v[216:219], a[108:111], a[60:63], v[216:219]
v_mfma_f32_16x16x32_bf16 v[192:195], a[108:111], a[52:55], v[192:195]
buffer_load_dwordx4 v[96:99], v1, s[4:7], s88 offen offset:1024 sc1
v_mfma_f32_16x16x32_bf16 v[192:195], a[104:107], a[48:51], v[192:195]
ds_read_b128 a[144:147], v5 offset:1024
v_mfma_f32_16x16x32_bf16 v[168:171], a[104:107], a[40:43], v[168:171]
v_mfma_f32_16x16x32_bf16 v[168:171], a[108:111], a[44:47], v[168:171]
ds_read_b128 a[148:151], v5 offset:7168
v_mfma_f32_16x16x32_bf16 v[144:147], a[108:111], a[36:39], v[144:147]
v_mfma_f32_16x16x32_bf16 v[144:147], a[104:107], a[32:35], v[144:147]
buffer_load_dwordx4 a[8:11], v2, s[40:43], s35 offen offset:1024 sc1
v_mfma_f32_16x16x32_bf16 v[148:151], a[112:115], a[32:35], v[148:151]
v_mfma_f32_16x16x32_bf16 v[148:151], a[116:119], a[36:39], v[148:151]
v_mfma_f32_16x16x32_bf16 v[172:175], a[116:119], a[44:47], v[172:175]
v_mfma_f32_16x16x32_bf16 v[172:175], a[112:115], a[40:43], v[172:175]
v_mfma_f32_16x16x32_bf16 v[196:199], a[112:115], a[48:51], v[196:199]
buffer_load_dwordx4 a[12:15], v2, s[40:43], s33 offen offset:1024 sc1
v_mfma_f32_16x16x32_bf16 v[196:199], a[116:119], a[52:55], v[196:199]
v_mfma_f32_16x16x32_bf16 v[220:223], a[116:119], a[60:63], v[220:223]
v_mfma_f32_16x16x32_bf16 v[220:223], a[112:115], a[56:59], v[220:223]
s_waitcnt lgkmcnt(0)
v_mfma_f32_16x16x32_bf16 v[224:227], a[128:131], a[56:59], v[224:227]
ds_read_b128 a[96:99], v5 offset:14336
v_mfma_f32_16x16x32_bf16 v[224:227], a[132:135], a[60:63], v[224:227]
buffer_load_dwordx4 a[16:19], v2, s[40:43], s35 offen offset:2048 sc1
v_mfma_f32_16x16x32_bf16 v[200:203], a[132:135], a[52:55], v[200:203]
ds_read_b128 a[100:103], v5 offset:20480
v_mfma_f32_16x16x32_bf16 v[200:203], a[128:131], a[48:51], v[200:203]
v_mfma_f32_16x16x32_bf16 v[176:179], a[128:131], a[40:43], v[176:179]
v_mfma_f32_16x16x32_bf16 v[176:179], a[132:135], a[44:47], v[176:179]
buffer_load_dwordx4 a[20:23], v2, s[40:43], s33 offen offset:2048 sc1
v_mfma_f32_16x16x32_bf16 v[152:155], a[132:135], a[36:39], v[152:155]
ds_read_b128 a[104:107], v5 offset:15360
v_mfma_f32_16x16x32_bf16 v[152:155], a[128:131], a[32:35], v[152:155]
v_mfma_f32_16x16x32_bf16 v[132:135], a[136:139], a[32:35], v[132:135]
ds_read_b128 a[108:111], v5 offset:21504
v_mfma_f32_16x16x32_bf16 v[132:135], a[140:143], a[36:39], v[132:135]
v_mfma_f32_16x16x32_bf16 v[156:159], a[140:143], a[44:47], v[156:159]
buffer_load_dwordx4 v[100:103], v1, s[4:7], s88 offen offset:2048 sc1
v_mfma_f32_16x16x32_bf16 v[156:159], a[136:139], a[40:43], v[156:159]
ds_read_b128 a[112:115], v5 offset:16384
v_mfma_f32_16x16x32_bf16 v[180:183], a[136:139], a[48:51], v[180:183]
v_mfma_f32_16x16x32_bf16 v[180:183], a[140:143], a[52:55], v[180:183]
ds_read_b128 a[116:119], v5 offset:22528
v_mfma_f32_16x16x32_bf16 v[204:207], a[140:143], a[60:63], v[204:207]
v_mfma_f32_16x16x32_bf16 v[204:207], a[136:139], a[56:59], v[204:207]
buffer_load_dwordx4 a[24:27], v2, s[40:43], s35 offen offset:3072 sc1
v_mfma_f32_16x16x32_bf16 v[208:211], a[144:147], a[56:59], v[208:211]
v_mfma_f32_16x16x32_bf16 v[208:211], a[148:151], a[60:63], v[208:211]
v_mfma_f32_16x16x32_bf16 v[184:187], a[148:151], a[52:55], v[184:187]
v_mfma_f32_16x16x32_bf16 v[184:187], a[144:147], a[48:51], v[184:187]
v_mfma_f32_16x16x32_bf16 v[160:163], a[144:147], a[40:43], v[160:163]
buffer_load_dwordx4 a[28:31], v2, s[40:43], s33 offen offset:3072 sc1
s_add_u32 s35, s35, 8192
v_mfma_f32_16x16x32_bf16 v[160:163], a[148:151], a[44:47], v[160:163]
s_add_u32 s33, s33, 8192
v_mfma_f32_16x16x32_bf16 v[136:139], a[148:151], a[36:39], v[136:139]
v_mfma_f32_16x16x32_bf16 v[136:139], a[144:147], a[32:35], v[136:139]
s_waitcnt vmcnt(10) lgkmcnt(0)
v_mfma_f32_16x16x32_bf16 v[140:143], a[96:99], a[64:67], v[140:143]
ds_read_b128 a[128:131], v5 offset:17408
v_mfma_f32_16x16x32_bf16 v[140:143], a[100:103], a[68:71], v[140:143]
buffer_load_dwordx4 a[32:35], v2, s[40:43], s35 offen offset:0 sc1
v_mfma_f32_16x16x32_bf16 v[164:167], a[100:103], a[76:79], v[164:167]
ds_read_b128 a[132:135], v5 offset:23552
v_mfma_f32_16x16x32_bf16 v[164:167], a[96:99], a[72:75], v[164:167]
v_mfma_f32_16x16x32_bf16 v[188:191], a[96:99], a[80:83], v[188:191]
v_mfma_f32_16x16x32_bf16 v[188:191], a[100:103], a[84:87], v[188:191]
buffer_load_dwordx4 v[104:107], v1, s[4:7], s88 offen offset:3072 sc1
s_add_u32 s88, s88, 4096
v_mfma_f32_16x16x32_bf16 v[212:215], a[100:103], a[92:95], v[212:215]
ds_read_b128 a[136:139], v5 offset:12288
v_mfma_f32_16x16x32_bf16 v[212:215], a[96:99], a[88:91], v[212:215]
v_mfma_f32_16x16x32_bf16 v[216:219], a[104:107], a[88:91], v[216:219]
ds_read_b128 a[140:143], v5 offset:18432
v_mfma_f32_16x16x32_bf16 v[216:219], a[108:111], a[92:95], v[216:219]
buffer_load_dwordx4 a[36:39], v2, s[40:43], s33 offen offset:0 sc1
v_mfma_f32_16x16x32_bf16 v[192:195], a[108:111], a[84:87], v[192:195]
ds_read_b128 a[144:147], v5 offset:13312
v_mfma_f32_16x16x32_bf16 v[192:195], a[104:107], a[80:83], v[192:195]
v_mfma_f32_16x16x32_bf16 v[168:171], a[104:107], a[72:75], v[168:171]
v_mfma_f32_16x16x32_bf16 v[168:171], a[108:111], a[76:79], v[168:171]
buffer_load_dwordx4 a[40:43], v2, s[40:43], s35 offen offset:1024 sc1
v_mfma_f32_16x16x32_bf16 v[144:147], a[108:111], a[68:71], v[144:147]
ds_read_b128 a[148:151], v5 offset:19456
v_mfma_f32_16x16x32_bf16 v[144:147], a[104:107], a[64:67], v[144:147]
v_mfma_f32_16x16x32_bf16 v[148:151], a[112:115], a[64:67], v[148:151]
v_mfma_f32_16x16x32_bf16 v[148:151], a[116:119], a[68:71], v[148:151]
buffer_load_dwordx4 v[108:111], v1, s[4:7], s88 offen offset:0 sc1
v_mfma_f32_16x16x32_bf16 v[172:175], a[116:119], a[76:79], v[172:175]
v_mfma_f32_16x16x32_bf16 v[172:175], a[112:115], a[72:75], v[172:175]
v_mfma_f32_16x16x32_bf16 v[196:199], a[112:115], a[80:83], v[196:199]
v_mfma_f32_16x16x32_bf16 v[196:199], a[116:119], a[84:87], v[196:199]
buffer_load_dwordx4 a[44:47], v2, s[40:43], s33 offen offset:1024 sc1
v_mfma_f32_16x16x32_bf16 v[220:223], a[116:119], a[92:95], v[220:223]
v_mfma_f32_16x16x32_bf16 v[220:223], a[112:115], a[88:91], v[220:223]
s_waitcnt lgkmcnt(0)
v_mfma_f32_16x16x32_bf16 v[224:227], a[128:131], a[88:91], v[224:227]
ds_read_b128 a[96:99], v5 offset:26624
v_mfma_f32_16x16x32_bf16 v[224:227], a[132:135], a[92:95], v[224:227]
buffer_load_dwordx4 a[48:51], v2, s[40:43], s35 offen offset:2048 sc1
v_mfma_f32_16x16x32_bf16 v[200:203], a[132:135], a[84:87], v[200:203]
ds_read_b128 a[100:103], v5 offset:32768
v_mfma_f32_16x16x32_bf16 v[200:203], a[128:131], a[80:83], v[200:203]
v_mfma_f32_16x16x32_bf16 v[176:179], a[128:131], a[72:75], v[176:179]
v_mfma_f32_16x16x32_bf16 v[176:179], a[132:135], a[76:79], v[176:179]
buffer_load_dwordx4 a[52:55], v2, s[40:43], s33 offen offset:2048 sc1
v_mfma_f32_16x16x32_bf16 v[152:155], a[132:135], a[68:71], v[152:155]
ds_read_b128 a[104:107], v5 offset:27648
v_mfma_f32_16x16x32_bf16 v[152:155], a[128:131], a[64:67], v[152:155]
v_mfma_f32_16x16x32_bf16 v[132:135], a[136:139], a[64:67], v[132:135]
ds_read_b128 a[108:111], v5 offset:33792
v_mfma_f32_16x16x32_bf16 v[132:135], a[140:143], a[68:71], v[132:135]
v_mfma_f32_16x16x32_bf16 v[156:159], a[140:143], a[76:79], v[156:159]
buffer_load_dwordx4 v[112:115], v1, s[4:7], s88 offen offset:1024 sc1
v_mfma_f32_16x16x32_bf16 v[156:159], a[136:139], a[72:75], v[156:159]
ds_read_b128 a[112:115], v5 offset:28672
v_mfma_f32_16x16x32_bf16 v[180:183], a[136:139], a[80:83], v[180:183]
v_mfma_f32_16x16x32_bf16 v[180:183], a[140:143], a[84:87], v[180:183]
ds_read_b128 a[116:119], v5 offset:34816
v_mfma_f32_16x16x32_bf16 v[204:207], a[140:143], a[92:95], v[204:207]
v_mfma_f32_16x16x32_bf16 v[204:207], a[136:139], a[88:91], v[204:207]
buffer_load_dwordx4 a[56:59], v2, s[40:43], s35 offen offset:3072 sc1
v_mfma_f32_16x16x32_bf16 v[208:211], a[144:147], a[88:91], v[208:211]
v_mfma_f32_16x16x32_bf16 v[208:211], a[148:151], a[92:95], v[208:211]
v_mfma_f32_16x16x32_bf16 v[184:187], a[148:151], a[84:87], v[184:187]
v_mfma_f32_16x16x32_bf16 v[184:187], a[144:147], a[80:83], v[184:187]
v_mfma_f32_16x16x32_bf16 v[160:163], a[144:147], a[72:75], v[160:163]
buffer_load_dwordx4 a[60:63], v2, s[40:43], s33 offen offset:3072 sc1
s_add_u32 s35, s35, 8192
v_mfma_f32_16x16x32_bf16 v[160:163], a[148:151], a[76:79], v[160:163]
s_add_u32 s33, s33, 8192
v_mfma_f32_16x16x32_bf16 v[136:139], a[148:151], a[68:71], v[136:139]
v_mfma_f32_16x16x32_bf16 v[136:139], a[144:147], a[64:67], v[136:139]
s_waitcnt vmcnt(11) lgkmcnt(0)
v_mfma_f32_16x16x32_bf16 v[140:143], a[96:99], a[0:3], v[140:143]
ds_read_b128 a[128:131], v5 offset:29696
v_mfma_f32_16x16x32_bf16 v[140:143], a[100:103], a[4:7], v[140:143]
buffer_load_dwordx4 a[64:67], v2, s[40:43], s35 offen offset:0 sc1
v_mfma_f32_16x16x32_bf16 v[164:167], a[100:103], a[12:15], v[164:167]
ds_read_b128 a[132:135], v5 offset:35840
v_mfma_f32_16x16x32_bf16 v[164:167], a[96:99], a[8:11], v[164:167]
v_mfma_f32_16x16x32_bf16 v[188:191], a[96:99], a[16:19], v[188:191]
v_mfma_f32_16x16x32_bf16 v[188:191], a[100:103], a[20:23], v[188:191]
buffer_load_dwordx4 a[68:71], v2, s[40:43], s33 offen offset:0 sc1
v_mfma_f32_16x16x32_bf16 v[212:215], a[100:103], a[28:31], v[212:215]
ds_read_b128 a[136:139], v5 offset:24576
v_mfma_f32_16x16x32_bf16 v[212:215], a[96:99], a[24:27], v[212:215]
v_mfma_f32_16x16x32_bf16 v[216:219], a[104:107], a[24:27], v[216:219]
ds_read_b128 a[140:143], v5 offset:30720
v_mfma_f32_16x16x32_bf16 v[216:219], a[108:111], a[28:31], v[216:219]
v_mfma_f32_16x16x32_bf16 v[192:195], a[108:111], a[20:23], v[192:195]
buffer_load_dwordx4 v[116:119], v1, s[4:7], s88 offen offset:2048 sc1
v_mfma_f32_16x16x32_bf16 v[192:195], a[104:107], a[16:19], v[192:195]
ds_read_b128 a[144:147], v5 offset:25600
v_mfma_f32_16x16x32_bf16 v[168:171], a[104:107], a[8:11], v[168:171]
v_mfma_f32_16x16x32_bf16 v[168:171], a[108:111], a[12:15], v[168:171]
ds_read_b128 a[148:151], v5 offset:31744
v_mfma_f32_16x16x32_bf16 v[144:147], a[108:111], a[4:7], v[144:147]
v_mfma_f32_16x16x32_bf16 v[144:147], a[104:107], a[0:3], v[144:147]
buffer_load_dwordx4 a[72:75], v2, s[40:43], s35 offen offset:1024 sc1
v_mfma_f32_16x16x32_bf16 v[148:151], a[112:115], a[0:3], v[148:151]
v_mfma_f32_16x16x32_bf16 v[148:151], a[116:119], a[4:7], v[148:151]
v_mfma_f32_16x16x32_bf16 v[172:175], a[116:119], a[12:15], v[172:175]
v_mfma_f32_16x16x32_bf16 v[172:175], a[112:115], a[8:11], v[172:175]
v_mfma_f32_16x16x32_bf16 v[196:199], a[112:115], a[16:19], v[196:199]
buffer_load_dwordx4 a[76:79], v2, s[40:43], s33 offen offset:1024 sc1
v_mfma_f32_16x16x32_bf16 v[196:199], a[116:119], a[20:23], v[196:199]
v_mfma_f32_16x16x32_bf16 v[220:223], a[116:119], a[28:31], v[220:223]
v_mfma_f32_16x16x32_bf16 v[220:223], a[112:115], a[24:27], v[220:223]
s_waitcnt lgkmcnt(0)
v_mfma_f32_16x16x32_bf16 v[224:227], a[128:131], a[24:27], v[224:227]
ds_read_b128 a[96:99], v5 offset:38912
v_mfma_f32_16x16x32_bf16 v[224:227], a[132:135], a[28:31], v[224:227]
buffer_load_dwordx4 a[80:83], v2, s[40:43], s35 offen offset:2048 sc1
v_mfma_f32_16x16x32_bf16 v[200:203], a[132:135], a[20:23], v[200:203]
ds_read_b128 a[100:103], v5 offset:45056
v_mfma_f32_16x16x32_bf16 v[200:203], a[128:131], a[16:19], v[200:203]
v_mfma_f32_16x16x32_bf16 v[176:179], a[128:131], a[8:11], v[176:179]
v_mfma_f32_16x16x32_bf16 v[176:179], a[132:135], a[12:15], v[176:179]
buffer_load_dwordx4 a[84:87], v2, s[40:43], s33 offen offset:2048 sc1
v_mfma_f32_16x16x32_bf16 v[152:155], a[132:135], a[4:7], v[152:155]
ds_read_b128 a[104:107], v5 offset:39936
v_mfma_f32_16x16x32_bf16 v[152:155], a[128:131], a[0:3], v[152:155]
v_mfma_f32_16x16x32_bf16 v[132:135], a[136:139], a[0:3], v[132:135]
ds_read_b128 a[108:111], v5 offset:46080
v_mfma_f32_16x16x32_bf16 v[132:135], a[140:143], a[4:7], v[132:135]
v_mfma_f32_16x16x32_bf16 v[156:159], a[140:143], a[12:15], v[156:159]
buffer_load_dwordx4 v[120:123], v1, s[4:7], s88 offen offset:3072 sc1
s_add_u32 m0, s18, 0x0
v_mfma_f32_16x16x32_bf16 v[156:159], a[136:139], a[8:11], v[156:159]
s_add_u32 s44, s50, 0x1424000
ds_read_b128 a[112:115], v5 offset:40960
v_mfma_f32_16x16x32_bf16 v[180:183], a[136:139], a[16:19], v[180:183]
v_mfma_f32_16x16x32_bf16 v[180:183], a[140:143], a[20:23], v[180:183]
ds_read_b128 a[116:119], v5 offset:47104
v_mfma_f32_16x16x32_bf16 v[204:207], a[140:143], a[28:31], v[204:207]
v_mfma_f32_16x16x32_bf16 v[204:207], a[136:139], a[24:27], v[204:207]
buffer_load_dwordx4 a[88:91], v2, s[40:43], s35 offen offset:3072 sc1
v_mfma_f32_16x16x32_bf16 v[208:211], a[144:147], a[24:27], v[208:211]
v_mfma_f32_16x16x32_bf16 v[208:211], a[148:151], a[28:31], v[208:211]
v_mfma_f32_16x16x32_bf16 v[184:187], a[148:151], a[20:23], v[184:187]
v_mfma_f32_16x16x32_bf16 v[184:187], a[144:147], a[16:19], v[184:187]
v_mfma_f32_16x16x32_bf16 v[160:163], a[144:147], a[8:11], v[160:163]
buffer_load_dwordx4 a[92:95], v2, s[40:43], s33 offen offset:3072 sc1
s_add_u32 s35, s35, 8192
v_mfma_f32_16x16x32_bf16 v[160:163], a[148:151], a[12:15], v[160:163]
s_add_u32 s33, s33, 8192
v_mfma_f32_16x16x32_bf16 v[136:139], a[148:151], a[4:7], v[136:139]
v_mfma_f32_16x16x32_bf16 v[136:139], a[144:147], a[0:3], v[136:139]
s_waitcnt vmcnt(10) lgkmcnt(0)
v_mfma_f32_16x16x32_bf16 v[140:143], a[96:99], a[32:35], v[140:143]
ds_read_b128 a[128:131], v5 offset:41984
v_mfma_f32_16x16x32_bf16 v[140:143], a[100:103], a[36:39], v[140:143]
buffer_load_dwordx4 a[0:3], v2, s[40:43], s35 offen offset:0 sc1
v_mfma_f32_16x16x32_bf16 v[164:167], a[100:103], a[44:47], v[164:167]
ds_read_b128 a[132:135], v5 offset:48128
v_mfma_f32_16x16x32_bf16 v[164:167], a[96:99], a[40:43], v[164:167]
v_mfma_f32_16x16x32_bf16 v[188:191], a[96:99], a[48:51], v[188:191]
v_mfma_f32_16x16x32_bf16 v[188:191], a[100:103], a[52:55], v[188:191]
buffer_load_dwordx4 v1, s[4:7], s44 offen offset:0 sc1 lds
v_mfma_f32_16x16x32_bf16 v[212:215], a[100:103], a[60:63], v[212:215]
ds_read_b128 a[136:139], v5 offset:36864
v_mfma_f32_16x16x32_bf16 v[212:215], a[96:99], a[56:59], v[212:215]
v_mfma_f32_16x16x32_bf16 v[216:219], a[104:107], a[56:59], v[216:219]
ds_read_b128 a[140:143], v5 offset:43008
v_mfma_f32_16x16x32_bf16 v[216:219], a[108:111], a[60:63], v[216:219]
buffer_load_dwordx4 a[4:7], v2, s[40:43], s33 offen offset:0 sc1
v_mfma_f32_16x16x32_bf16 v[192:195], a[108:111], a[52:55], v[192:195]
ds_read_b128 a[144:147], v5 offset:37888
v_mfma_f32_16x16x32_bf16 v[192:195], a[104:107], a[48:51], v[192:195]
v_mfma_f32_16x16x32_bf16 v[168:171], a[104:107], a[40:43], v[168:171]
v_mfma_f32_16x16x32_bf16 v[168:171], a[108:111], a[44:47], v[168:171]
buffer_load_dwordx4 a[8:11], v2, s[40:43], s35 offen offset:1024 sc1
v_mfma_f32_16x16x32_bf16 v[144:147], a[108:111], a[36:39], v[144:147]
ds_read_b128 a[148:151], v5 offset:44032
v_mfma_f32_16x16x32_bf16 v[144:147], a[104:107], a[32:35], v[144:147]
v_mfma_f32_16x16x32_bf16 v[148:151], a[112:115], a[32:35], v[148:151]
v_mfma_f32_16x16x32_bf16 v[148:151], a[116:119], a[36:39], v[148:151]
buffer_load_dwordx4 v1, s[4:7], s44 offen offset:1024 sc1 lds
v_mfma_f32_16x16x32_bf16 v[172:175], a[116:119], a[44:47], v[172:175]
v_mfma_f32_16x16x32_bf16 v[172:175], a[112:115], a[40:43], v[172:175]
v_mfma_f32_16x16x32_bf16 v[196:199], a[112:115], a[48:51], v[196:199]
v_mfma_f32_16x16x32_bf16 v[196:199], a[116:119], a[52:55], v[196:199]
buffer_load_dwordx4 a[12:15], v2, s[40:43], s33 offen offset:1024 sc1
v_mfma_f32_16x16x32_bf16 v[220:223], a[116:119], a[60:63], v[220:223]
v_mfma_f32_16x16x32_bf16 v[220:223], a[112:115], a[56:59], v[220:223]
s_waitcnt lgkmcnt(0)
s_barrier
v_mfma_f32_16x16x32_bf16 v[224:227], a[128:131], a[56:59], v[224:227]
v_add_u32 v5, 98304, v1
v_mfma_f32_16x16x32_bf16 v[224:227], a[132:135], a[60:63], v[224:227]
buffer_load_dwordx4 a[16:19], v2, s[40:43], s35 offen offset:2048 sc1
v_mfma_f32_16x16x32_bf16 v[200:203], a[132:135], a[52:55], v[200:203]
ds_read_b128 a[96:99], v5 offset:2048
v_mfma_f32_16x16x32_bf16 v[200:203], a[128:131], a[48:51], v[200:203]
ds_read_b128 a[100:103], v5 offset:8192
v_mfma_f32_16x16x32_bf16 v[176:179], a[128:131], a[40:43], v[176:179]
v_mfma_f32_16x16x32_bf16 v[176:179], a[132:135], a[44:47], v[176:179]
buffer_load_dwordx4 a[20:23], v2, s[40:43], s33 offen offset:2048 sc1
v_mfma_f32_16x16x32_bf16 v[152:155], a[132:135], a[36:39], v[152:155]
ds_read_b128 a[104:107], v5 offset:3072
v_mfma_f32_16x16x32_bf16 v[152:155], a[128:131], a[32:35], v[152:155]
v_mfma_f32_16x16x32_bf16 v[132:135], a[136:139], a[32:35], v[132:135]
ds_read_b128 a[108:111], v5 offset:9216
v_mfma_f32_16x16x32_bf16 v[132:135], a[140:143], a[36:39], v[132:135]
v_mfma_f32_16x16x32_bf16 v[156:159], a[140:143], a[44:47], v[156:159]
buffer_load_dwordx4 v1, s[4:7], s44 offen offset:2048 sc1 lds
s_add_u32 m0, s18, 0x3000
v_mfma_f32_16x16x32_bf16 v[156:159], a[136:139], a[40:43], v[156:159]
s_add_u32 s44, s50, 0x1427000
ds_read_b128 a[112:115], v5 offset:4096
v_mfma_f32_16x16x32_bf16 v[180:183], a[136:139], a[48:51], v[180:183]
v_mfma_f32_16x16x32_bf16 v[180:183], a[140:143], a[52:55], v[180:183]
ds_read_b128 a[116:119], v5 offset:10240
v_mfma_f32_16x16x32_bf16 v[204:207], a[140:143], a[60:63], v[204:207]
v_mfma_f32_16x16x32_bf16 v[204:207], a[136:139], a[56:59], v[204:207]
buffer_load_dwordx4 a[24:27], v2, s[40:43], s35 offen offset:3072 sc1
v_mfma_f32_16x16x32_bf16 v[208:211], a[144:147], a[56:59], v[208:211]
v_mfma_f32_16x16x32_bf16 v[208:211], a[148:151], a[60:63], v[208:211]
v_mfma_f32_16x16x32_bf16 v[184:187], a[148:151], a[52:55], v[184:187]
v_mfma_f32_16x16x32_bf16 v[184:187], a[144:147], a[48:51], v[184:187]
v_mfma_f32_16x16x32_bf16 v[160:163], a[144:147], a[40:43], v[160:163]
buffer_load_dwordx4 a[28:31], v2, s[40:43], s33 offen offset:3072 sc1
s_add_u32 s35, s35, 8192
v_mfma_f32_16x16x32_bf16 v[160:163], a[148:151], a[44:47], v[160:163]
s_add_u32 s33, s33, 8192
v_mfma_f32_16x16x32_bf16 v[136:139], a[148:151], a[36:39], v[136:139]
v_mfma_f32_16x16x32_bf16 v[136:139], a[144:147], a[32:35], v[136:139]
s_waitcnt vmcnt(11) lgkmcnt(0)
v_mfma_f32_16x16x32_bf16 v[140:143], a[96:99], a[64:67], v[140:143]
ds_read_b128 a[128:131], v5 offset:5120
v_mfma_f32_16x16x32_bf16 v[140:143], a[100:103], a[68:71], v[140:143]
buffer_load_dwordx4 a[32:35], v2, s[40:43], s35 offen offset:0 sc1
v_mfma_f32_16x16x32_bf16 v[164:167], a[100:103], a[76:79], v[164:167]
ds_read_b128 a[132:135], v5 offset:11264
v_mfma_f32_16x16x32_bf16 v[164:167], a[96:99], a[72:75], v[164:167]
v_mfma_f32_16x16x32_bf16 v[188:191], a[96:99], a[80:83], v[188:191]
v_mfma_f32_16x16x32_bf16 v[188:191], a[100:103], a[84:87], v[188:191]
buffer_load_dwordx4 a[36:39], v2, s[40:43], s33 offen offset:0 sc1
v_mfma_f32_16x16x32_bf16 v[212:215], a[100:103], a[92:95], v[212:215]
ds_read_b128 a[136:139], v5 offset:0
v_mfma_f32_16x16x32_bf16 v[212:215], a[96:99], a[88:91], v[212:215]
v_mfma_f32_16x16x32_bf16 v[216:219], a[104:107], a[88:91], v[216:219]
ds_read_b128 a[140:143], v5 offset:6144
v_mfma_f32_16x16x32_bf16 v[216:219], a[108:111], a[92:95], v[216:219]
v_mfma_f32_16x16x32_bf16 v[192:195], a[108:111], a[84:87], v[192:195]
buffer_load_dwordx4 v1, s[4:7], s44 offen offset:0 sc1 lds
v_mfma_f32_16x16x32_bf16 v[192:195], a[104:107], a[80:83], v[192:195]
ds_read_b128 a[144:147], v5 offset:1024
v_mfma_f32_16x16x32_bf16 v[168:171], a[104:107], a[72:75], v[168:171]
v_mfma_f32_16x16x32_bf16 v[168:171], a[108:111], a[76:79], v[168:171]
ds_read_b128 a[148:151], v5 offset:7168
v_mfma_f32_16x16x32_bf16 v[144:147], a[108:111], a[68:71], v[144:147]
v_mfma_f32_16x16x32_bf16 v[144:147], a[104:107], a[64:67], v[144:147]
buffer_load_dwordx4 a[40:43], v2, s[40:43], s35 offen offset:1024 sc1
v_mfma_f32_16x16x32_bf16 v[148:151], a[112:115], a[64:67], v[148:151]
v_mfma_f32_16x16x32_bf16 v[148:151], a[116:119], a[68:71], v[148:151]
v_mfma_f32_16x16x32_bf16 v[172:175], a[116:119], a[76:79], v[172:175]
v_mfma_f32_16x16x32_bf16 v[172:175], a[112:115], a[72:75], v[172:175]
v_mfma_f32_16x16x32_bf16 v[196:199], a[112:115], a[80:83], v[196:199]
buffer_load_dwordx4 a[44:47], v2, s[40:43], s33 offen offset:1024 sc1
v_mfma_f32_16x16x32_bf16 v[196:199], a[116:119], a[84:87], v[196:199]
v_mfma_f32_16x16x32_bf16 v[220:223], a[116:119], a[92:95], v[220:223]
v_mfma_f32_16x16x32_bf16 v[220:223], a[112:115], a[88:91], v[220:223]
s_waitcnt lgkmcnt(0)
v_mfma_f32_16x16x32_bf16 v[224:227], a[128:131], a[88:91], v[224:227]
ds_read_b128 a[96:99], v5 offset:14336
v_mfma_f32_16x16x32_bf16 v[224:227], a[132:135], a[92:95], v[224:227]
buffer_load_dwordx4 a[48:51], v2, s[40:43], s35 offen offset:2048 sc1
v_mfma_f32_16x16x32_bf16 v[200:203], a[132:135], a[84:87], v[200:203]
ds_read_b128 a[100:103], v5 offset:20480
v_mfma_f32_16x16x32_bf16 v[200:203], a[128:131], a[80:83], v[200:203]
v_mfma_f32_16x16x32_bf16 v[176:179], a[128:131], a[72:75], v[176:179]
v_mfma_f32_16x16x32_bf16 v[176:179], a[132:135], a[76:79], v[176:179]
buffer_load_dwordx4 a[52:55], v2, s[40:43], s33 offen offset:2048 sc1
v_mfma_f32_16x16x32_bf16 v[152:155], a[132:135], a[68:71], v[152:155]
ds_read_b128 a[104:107], v5 offset:15360
v_mfma_f32_16x16x32_bf16 v[152:155], a[128:131], a[64:67], v[152:155]
v_mfma_f32_16x16x32_bf16 v[132:135], a[136:139], a[64:67], v[132:135]
ds_read_b128 a[108:111], v5 offset:21504
v_mfma_f32_16x16x32_bf16 v[132:135], a[140:143], a[68:71], v[132:135]
v_mfma_f32_16x16x32_bf16 v[156:159], a[140:143], a[76:79], v[156:159]
buffer_load_dwordx4 v1, s[4:7], s44 offen offset:1024 sc1 lds
v_mfma_f32_16x16x32_bf16 v[156:159], a[136:139], a[72:75], v[156:159]
ds_read_b128 a[112:115], v5 offset:16384
v_mfma_f32_16x16x32_bf16 v[180:183], a[136:139], a[80:83], v[180:183]
v_mfma_f32_16x16x32_bf16 v[180:183], a[140:143], a[84:87], v[180:183]
ds_read_b128 a[116:119], v5 offset:22528
v_mfma_f32_16x16x32_bf16 v[204:207], a[140:143], a[92:95], v[204:207]
v_mfma_f32_16x16x32_bf16 v[204:207], a[136:139], a[88:91], v[204:207]
buffer_load_dwordx4 a[56:59], v2, s[40:43], s35 offen offset:3072 sc1
v_mfma_f32_16x16x32_bf16 v[208:211], a[144:147], a[88:91], v[208:211]
v_mfma_f32_16x16x32_bf16 v[208:211], a[148:151], a[92:95], v[208:211]
v_mfma_f32_16x16x32_bf16 v[184:187], a[148:151], a[84:87], v[184:187]
v_mfma_f32_16x16x32_bf16 v[184:187], a[144:147], a[80:83], v[184:187]
v_mfma_f32_16x16x32_bf16 v[160:163], a[144:147], a[72:75], v[160:163]
buffer_load_dwordx4 a[60:63], v2, s[40:43], s33 offen offset:3072 sc1
s_add_u32 s35, s35, 8192
v_mfma_f32_16x16x32_bf16 v[160:163], a[148:151], a[76:79], v[160:163]
s_add_u32 s33, s33, 8192
v_mfma_f32_16x16x32_bf16 v[136:139], a[148:151], a[68:71], v[136:139]
v_mfma_f32_16x16x32_bf16 v[136:139], a[144:147], a[64:67], v[136:139]
s_waitcnt vmcnt(10) lgkmcnt(0)
v_mfma_f32_16x16x32_bf16 v[140:143], a[96:99], a[0:3], v[140:143]
ds_read_b128 a[128:131], v5 offset:17408
v_add_f32 v92, v92, v96
v_mfma_f32_16x16x32_bf16 v[140:143], a[100:103], a[4:7], v[140:143]
buffer_load_dwordx4 a[64:67], v2, s[40:43], s35 offen offset:0 sc1
v_mfma_f32_16x16x32_bf16 v[164:167], a[100:103], a[12:15], v[164:167]
ds_read_b128 a[132:135], v5 offset:23552
v_add_f32 v100, v100, v104
v_mfma_f32_16x16x32_bf16 v[164:167], a[96:99], a[8:11], v[164:167]
v_add_f32 v108, v108, v112
v_add_f32 v116, v116, v120
v_mfma_f32_16x16x32_bf16 v[188:191], a[96:99], a[16:19], v[188:191]
v_add_f32 v93, v93, v97
v_add_f32 v101, v101, v105
v_mfma_f32_16x16x32_bf16 v[188:191], a[100:103], a[20:23], v[188:191]
buffer_load_dwordx4 v1, s[4:7], s44 offen offset:2048 sc1 lds
s_add_u32 m0, s18, 0x6000
v_mfma_f32_16x16x32_bf16 v[212:215], a[100:103], a[28:31], v[212:215]
s_add_u32 s44, s50, 0x142a000
ds_read_b128 a[136:139], v5 offset:12288
v_mfma_f32_16x16x32_bf16 v[212:215], a[96:99], a[24:27], v[212:215]
v_add_f32 v109, v109, v113
v_add_f32 v117, v117, v121
v_mfma_f32_16x16x32_bf16 v[216:219], a[104:107], a[24:27], v[216:219]
ds_read_b128 a[140:143], v5 offset:18432
v_add_f32 v94, v94, v98
v_mfma_f32_16x16x32_bf16 v[216:219], a[108:111], a[28:31], v[216:219]
buffer_load_dwordx4 a[68:71], v2, s[40:43], s33 offen offset:0 sc1
v_mfma_f32_16x16x32_bf16 v[192:195], a[108:111], a[20:23], v[192:195]
ds_read_b128 a[144:147], v5 offset:13312
v_add_f32 v102, v102, v106
v_mfma_f32_16x16x32_bf16 v[192:195], a[104:107], a[16:19], v[192:195]
v_add_f32 v110, v110, v114
v_add_f32 v118, v118, v122
v_mfma_f32_16x16x32_bf16 v[168:171], a[104:107], a[8:11], v[168:171]
v_add_f32 v95, v95, v99
v_add_f32 v103, v103, v107
v_mfma_f32_16x16x32_bf16 v[168:171], a[108:111], a[12:15], v[168:171]
buffer_load_dwordx4 a[72:75], v2, s[40:43], s35 offen offset:1024 sc1
v_mfma_f32_16x16x32_bf16 v[144:147], a[108:111], a[4:7], v[144:147]
ds_read_b128 a[148:151], v5 offset:19456
v_add_f32 v111, v111, v115
v_mfma_f32_16x16x32_bf16 v[144:147], a[104:107], a[0:3], v[144:147]
v_add_f32 v119, v119, v123
v_add_f32_dpp v92, v92, v92 row_ror:8 row_mask:0xf bank_mask:0xf
v_mfma_f32_16x16x32_bf16 v[148:151], a[112:115], a[0:3], v[148:151]
v_add_f32_dpp v100, v100, v100 row_ror:8 row_mask:0xf bank_mask:0xf
v_mfma_f32_16x16x32_bf16 v[148:151], a[116:119], a[4:7], v[148:151]
buffer_load_dwordx4 v1, s[4:7], s44 offen offset:0 sc1 lds
v_mfma_f32_16x16x32_bf16 v[172:175], a[116:119], a[12:15], v[172:175]
v_add_f32_dpp v108, v108, v108 row_ror:8 row_mask:0xf bank_mask:0xf
v_add_f32_dpp v116, v116, v116 row_ror:8 row_mask:0xf bank_mask:0xf
v_mfma_f32_16x16x32_bf16 v[172:175], a[112:115], a[8:11], v[172:175]
v_add_f32_dpp v93, v93, v93 row_ror:8 row_mask:0xf bank_mask:0xf
v_mfma_f32_16x16x32_bf16 v[196:199], a[112:115], a[16:19], v[196:199]
v_add_f32_dpp v101, v101, v101 row_ror:8 row_mask:0xf bank_mask:0xf
v_mfma_f32_16x16x32_bf16 v[196:199], a[116:119], a[20:23], v[196:199]
buffer_load_dwordx4 a[76:79], v2, s[40:43], s33 offen offset:1024 sc1
v_mfma_f32_16x16x32_bf16 v[220:223], a[116:119], a[28:31], v[220:223]
v_add_f32_dpp v109, v109, v109 row_ror:8 row_mask:0xf bank_mask:0xf
v_add_f32_dpp v117, v117, v117 row_ror:8 row_mask:0xf bank_mask:0xf
v_mfma_f32_16x16x32_bf16 v[220:223], a[112:115], a[24:27], v[220:223]
v_add_f32_dpp v92, v94, v94 row_ror:8 row_mask:0xf bank_mask:0xc
s_waitcnt lgkmcnt(0)
v_mfma_f32_16x16x32_bf16 v[224:227], a[128:131], a[24:27], v[224:227]
ds_read_b128 a[96:99], v5 offset:26624
v_add_f32_dpp v100, v102, v102 row_ror:8 row_mask:0xf bank_mask:0xc
v_mfma_f32_16x16x32_bf16 v[224:227], a[132:135], a[28:31], v[224:227]
buffer_load_dwordx4 a[80:83], v2, s[40:43], s35 offen offset:2048 sc1
v_mfma_f32_16x16x32_bf16 v[200:203], a[132:135], a[20:23], v[200:203]
ds_read_b128 a[100:103], v5 offset:32768
v_add_f32_dpp v108, v110, v110 row_ror:8 row_mask:0xf bank_mask:0xc
v_mfma_f32_16x16x32_bf16 v[200:203], a[128:131], a[16:19], v[200:203]
v_add_f32_dpp v116, v118, v118 row_ror:8 row_mask:0xf bank_mask:0xc
v_add_f32_dpp v93, v95, v95 row_ror:8 row_mask:0xf bank_mask:0xc
v_mfma_f32_16x16x32_bf16 v[176:179], a[128:131], a[8:11], v[176:179]
v_add_f32_dpp v101, v103, v103 row_ror:8 row_mask:0xf bank_mask:0xc
v_add_f32_dpp v109, v111, v111 row_ror:8 row_mask:0xf bank_mask:0xc
v_mfma_f32_16x16x32_bf16 v[176:179], a[132:135], a[12:15], v[176:179]
buffer_load_dwordx4 a[84:87], v2, s[40:43], s33 offen offset:2048 sc1
v_mfma_f32_16x16x32_bf16 v[152:155], a[132:135], a[4:7], v[152:155]
ds_read_b128 a[104:107], v5 offset:27648
v_add_f32_dpp v117, v119, v119 row_ror:8 row_mask:0xf bank_mask:0xc
v_mfma_f32_16x16x32_bf16 v[152:155], a[128:131], a[0:3], v[152:155]
v_permlane32_swap_b32 v92, v93
v_mfma_f32_16x16x32_bf16 v[132:135], a[136:139], a[0:3], v[132:135]
ds_read_b128 a[108:111], v5 offset:33792
v_mfma_f32_16x16x32_bf16 v[132:135], a[140:143], a[4:7], v[132:135]
v_permlane32_swap_b32 v100, v101
v_mfma_f32_16x16x32_bf16 v[156:159], a[140:143], a[12:15], v[156:159]
buffer_load_dwordx4 v1, s[4:7], s44 offen offset:1024 sc1 lds
v_mfma_f32_16x16x32_bf16 v[156:159], a[136:139], a[8:11], v[156:159]
ds_read_b128 a[112:115], v5 offset:28672
v_mfma_f32_16x16x32_bf16 v[180:183], a[136:139], a[16:19], v[180:183]
v_permlane32_swap_b32 v108, v109
v_mfma_f32_16x16x32_bf16 v[180:183], a[140:143], a[20:23], v[180:183]
ds_read_b128 a[116:119], v5 offset:34816
v_mfma_f32_16x16x32_bf16 v[204:207], a[140:143], a[28:31], v[204:207]
v_permlane32_swap_b32 v116, v117
v_mfma_f32_16x16x32_bf16 v[204:207], a[136:139], a[24:27], v[204:207]
buffer_load_dwordx4 a[88:91], v2, s[40:43], s35 offen offset:3072 sc1
v_mfma_f32_16x16x32_bf16 v[208:211], a[144:147], a[24:27], v[208:211]
v_add_f32 v92, v92, v93
v_add_f32 v100, v100, v101
v_mfma_f32_16x16x32_bf16 v[208:211], a[148:151], a[28:31], v[208:211]
v_add_f32 v108, v108, v109
v_add_f32 v116, v116, v117
v_mfma_f32_16x16x32_bf16 v[184:187], a[148:151], a[20:23], v[184:187]
v_mov_b32 v94, v92
v_mfma_f32_16x16x32_bf16 v[184:187], a[144:147], a[16:19], v[184:187]
v_mov_b32 v102, v100
v_mfma_f32_16x16x32_bf16 v[160:163], a[144:147], a[8:11], v[160:163]
buffer_load_dwordx4 a[92:95], v2, s[40:43], s33 offen offset:3072 sc1
s_add_u32 s35, s35, 8192
v_mfma_f32_16x16x32_bf16 v[160:163], a[148:151], a[12:15], v[160:163]
s_add_u32 s33, s33, 8192
v_mov_b32 v110, v108
v_mfma_f32_16x16x32_bf16 v[136:139], a[148:151], a[4:7], v[136:139]
v_mov_b32 v118, v116
v_mfma_f32_16x16x32_bf16 v[136:139], a[144:147], a[0:3], v[136:139]
s_waitcnt vmcnt(11) lgkmcnt(0)
v_mfma_f32_16x16x32_bf16 v[140:143], a[96:99], a[32:35], v[140:143]
ds_read_b128 a[128:131], v5 offset:29696
v_mfma_f32_16x16x32_bf16 v[140:143], a[100:103], a[36:39], v[140:143]
buffer_load_dwordx4 a[0:3], v2, s[40:43], s35 offen offset:0 sc1
v_mfma_f32_16x16x32_bf16 v[164:167], a[100:103], a[44:47], v[164:167]
ds_read_b128 a[132:135], v5 offset:35840
v_mfma_f32_16x16x32_bf16 v[164:167], a[96:99], a[40:43], v[164:167]
v_permlane16_swap_b32 v92, v94
v_mfma_f32_16x16x32_bf16 v[188:191], a[96:99], a[48:51], v[188:191]
v_permlane16_swap_b32 v100, v102
v_mfma_f32_16x16x32_bf16 v[188:191], a[100:103], a[52:55], v[188:191]
buffer_load_dwordx4 a[4:7], v2, s[40:43], s33 offen offset:0 sc1
v_mfma_f32_16x16x32_bf16 v[212:215], a[100:103], a[60:63], v[212:215]
ds_read_b128 a[136:139], v5 offset:24576
v_mfma_f32_16x16x32_bf16 v[212:215], a[96:99], a[56:59], v[212:215]
v_permlane16_swap_b32 v108, v110
v_mfma_f32_16x16x32_bf16 v[216:219], a[104:107], a[56:59], v[216:219]
ds_read_b128 a[140:143], v5 offset:30720
v_mfma_f32_16x16x32_bf16 v[216:219], a[108:111], a[60:63], v[216:219]
v_permlane16_swap_b32 v116, v118
v_mfma_f32_16x16x32_bf16 v[192:195], a[108:111], a[52:55], v[192:195]
buffer_load_dwordx4 v1, s[4:7], s44 offen offset:2048 sc1 lds
s_add_u32 m0, s18, 0x9000
v_mfma_f32_16x16x32_bf16 v[192:195], a[104:107], a[48:51], v[192:195]
s_add_u32 s44, s50, 0x142d000
ds_read_b128 a[144:147], v5 offset:25600
v_mfma_f32_16x16x32_bf16 v[168:171], a[104:107], a[40:43], v[168:171]
v_add_f32 v92, v92, v94
v_add_f32 v100, v100, v102
v_mfma_f32_16x16x32_bf16 v[168:171], a[108:111], a[44:47], v[168:171]
L_stub16:
s_cbranch_execz L_stub17
ds_read_b128 a[148:151], v5 offset:31744
v_add_f32 v108, v108, v110
v_mfma_f32_16x16x32_bf16 v[144:147], a[108:111], a[36:39], v[144:147]
v_add_f32 v116, v116, v118
v_mov_b32 v94, v92
v_mfma_f32_16x16x32_bf16 v[144:147], a[104:107], a[32:35], v[144:147]
buffer_load_dwordx4 a[8:11], v2, s[40:43], s35 offen offset:1024 sc1
v_mfma_f32_16x16x32_bf16 v[148:151], a[112:115], a[32:35], v[148:151]
v_mov_b32 v102, v100
v_mov_b32 v110, v108
v_mfma_f32_16x16x32_bf16 v[148:151], a[116:119], a[36:39], v[148:151]
v_mov_b32 v118, v116
v_mfma_f32_16x16x32_bf16 v[172:175], a[116:119], a[44:47], v[172:175]
v_permlane32_swap_b32 v92, v94
v_mfma_f32_16x16x32_bf16 v[172:175], a[112:115], a[40:43], v[172:175]
v_permlane32_swap_b32 v100, v102
v_mfma_f32_16x16x32_bf16 v[196:199], a[112:115], a[48:51], v[196:199]
buffer_load_dwordx4 a[12:15], v2, s[40:43], s33 offen offset:1024 sc1
v_mfma_f32_16x16x32_bf16 v[196:199], a[116:119], a[52:55], v[196:199]
v_permlane32_swap_b32 v108, v110
v_mfma_f32_16x16x32_bf16 v[220:223], a[116:119], a[60:63], v[220:223]
v_permlane32_swap_b32 v116, v118
v_mfma_f32_16x16x32_bf16 v[220:223], a[112:115], a[56:59], v[220:223]
v_mul_f32 v82, 0xba800000, v92
s_waitcnt lgkmcnt(0)
v_mfma_f32_16x16x32_bf16 v[224:227], a[128:131], a[56:59], v[224:227]
ds_read_b128 a[96:99], v5 offset:38912
v_mul_f32 v84, 0xba800000, v100
v_mfma_f32_16x16x32_bf16 v[224:227], a[132:135], a[60:63], v[224:227]
buffer_load_dwordx4 a[16:19], v2, s[40:43], s35 offen offset:2048 sc1
v_mfma_f32_16x16x32_bf16 v[200:203], a[132:135], a[52:55], v[200:203]
ds_read_b128 a[100:103], v5 offset:45056
v_mul_f32 v86, 0xba800000, v108
v_mfma_f32_16x16x32_bf16 v[200:203], a[128:131], a[48:51], v[200:203]
v_mul_f32 v88, 0xba800000, v116
v_mul_f32 v94, 0x3a800000, v94
v_mfma_f32_16x16x32_bf16 v[176:179], a[128:131], a[40:43], v[176:179]
v_mul_f32 v102, 0x3a800000, v102
v_mul_f32 v110, 0x3a800000, v110
v_mfma_f32_16x16x32_bf16 v[176:179], a[132:135], a[44:47], v[176:179]
buffer_load_dwordx4 a[20:23], v2, s[40:43], s33 offen offset:2048 sc1
v_mfma_f32_16x16x32_bf16 v[152:155], a[132:135], a[36:39], v[152:155]
ds_read_b128 a[104:107], v5 offset:39936
v_mul_f32 v118, 0x3a800000, v118
v_mfma_f32_16x16x32_bf16 v[152:155], a[128:131], a[32:35], v[152:155]
v_fma_f32 v94, -v82, v82, v94
v_fma_f32 v102, -v84, v84, v102
v_mfma_f32_16x16x32_bf16 v[132:135], a[136:139], a[32:35], v[132:135]
ds_read_b128 a[108:111], v5 offset:46080
v_fma_f32 v110, -v86, v86, v110
v_mfma_f32_16x16x32_bf16 v[132:135], a[140:143], a[36:39], v[132:135]
v_fma_f32 v118, -v88, v88, v118
v_max_f32 v94, 0, v94
v_mfma_f32_16x16x32_bf16 v[156:159], a[140:143], a[44:47], v[156:159]
buffer_load_dwordx4 v1, s[4:7], s44 offen offset:0 sc1 lds
v_mfma_f32_16x16x32_bf16 v[156:159], a[136:139], a[40:43], v[156:159]
ds_read_b128 a[112:115], v5 offset:40960
v_max_f32 v102, 0, v102
v_mfma_f32_16x16x32_bf16 v[180:183], a[136:139], a[48:51], v[180:183]
v_max_f32 v110, 0, v110
v_max_f32 v118, 0, v118
v_mfma_f32_16x16x32_bf16 v[180:183], a[140:143], a[52:55], v[180:183]
ds_read_b128 a[116:119], v5 offset:47104
v_add_f32 v94, 0x3727c5ac, v94
v_mfma_f32_16x16x32_bf16 v[204:207], a[140:143], a[60:63], v[204:207]
v_add_f32 v102, 0x3727c5ac, v102
v_add_f32 v110, 0x3727c5ac, v110
v_mfma_f32_16x16x32_bf16 v[204:207], a[136:139], a[56:59], v[204:207]
buffer_load_dwordx4 a[24:27], v2, s[40:43], s35 offen offset:3072 sc1
v_mfma_f32_16x16x32_bf16 v[208:211], a[144:147], a[56:59], v[208:211]
v_add_f32 v118, 0x3727c5ac, v118
v_mfma_f32_16x16x32_bf16 v[208:211], a[148:151], a[60:63], v[208:211]
v_rsq_f32 v83, v94
v_mfma_f32_16x16x32_bf16 v[184:187], a[148:151], a[52:55], v[184:187]
v_rsq_f32 v85, v102
v_mfma_f32_16x16x32_bf16 v[184:187], a[144:147], a[48:51], v[184:187]
v_mfma_f32_16x16x32_bf16 v[160:163], a[144:147], a[40:43], v[160:163]
buffer_load_dwordx4 a[28:31], v2, s[40:43], s33 offen offset:3072 sc1
s_add_u32 s35, s35, 8192
v_mfma_f32_16x16x32_bf16 v[160:163], a[148:151], a[44:47], v[160:163]
s_add_u32 s33, s33, 8192
v_mfma_f32_16x16x32_bf16 v[136:139], a[148:151], a[36:39], v[136:139]
v_rsq_f32 v87, v110
v_mfma_f32_16x16x32_bf16 v[136:139], a[144:147], a[32:35], v[136:139]
s_waitcnt vmcnt(10) lgkmcnt(0)
v_mfma_f32_16x16x32_bf16 v[140:143], a[96:99], a[64:67], v[140:143]
ds_read_b128 a[128:131], v5 offset:41984
v_mfma_f32_16x16x32_bf16 v[140:143], a[100:103], a[68:71], v[140:143]
buffer_load_dwordx4 a[32:35], v2, s[40:43], s35 offen offset:0 sc1
v_mfma_f32_16x16x32_bf16 v[164:167], a[100:103], a[76:79], v[164:167]
ds_read_b128 a[132:135], v5 offset:48128
v_mfma_f32_16x16x32_bf16 v[164:167], a[96:99], a[72:75], v[164:167]
v_rsq_f32 v89, v118
v_mfma_f32_16x16x32_bf16 v[188:191], a[96:99], a[80:83], v[188:191]
v_mfma_f32_16x16x32_bf16 v[188:191], a[100:103], a[84:87], v[188:191]
buffer_load_dwordx4 v1, s[4:7], s44 offen offset:1024 sc1 lds
v_mfma_f32_16x16x32_bf16 v[212:215], a[100:103], a[92:95], v[212:215]
ds_read_b128 a[136:139], v5 offset:36864
v_mfma_f32_16x16x32_bf16 v[212:215], a[96:99], a[88:91], v[212:215]
v_mfma_f32_16x16x32_bf16 v[216:219], a[104:107], a[88:91], v[216:219]
ds_read_b128 a[140:143], v5 offset:43008
v_mfma_f32_16x16x32_bf16 v[216:219], a[108:111], a[92:95], v[216:219]
buffer_load_dwordx4 a[36:39], v2, s[40:43], s33 offen offset:0 sc1
v_mfma_f32_16x16x32_bf16 v[192:195], a[108:111], a[84:87], v[192:195]
ds_read_b128 a[144:147], v5 offset:37888
v_fmac_f32 v140, v56, v82
v_mfma_f32_16x16x32_bf16 v[192:195], a[104:107], a[80:83], v[192:195]
v_mfma_f32_16x16x32_bf16 v[168:171], a[104:107], a[72:75], v[168:171]
v_fmac_f32 v164, v56, v84
v_mfma_f32_16x16x32_bf16 v[168:171], a[108:111], a[76:79], v[168:171]
buffer_load_dwordx4 a[40:43], v2, s[40:43], s35 offen offset:1024 sc1
v_mfma_f32_16x16x32_bf16 v[144:147], a[108:111], a[68:71], v[144:147]
ds_read_b128 a[148:151], v5 offset:44032
v_fmac_f32 v188, v56, v86
v_mfma_f32_16x16x32_bf16 v[144:147], a[104:107], a[64:67], v[144:147]
v_mfma_f32_16x16x32_bf16 v[148:151], a[112:115], a[64:67], v[148:151]
v_fmac_f32 v212, v56, v88
v_mfma_f32_16x16x32_bf16 v[148:151], a[116:119], a[68:71], v[148:151]
buffer_load_dwordx4 v1, s[4:7], s44 offen offset:2048 sc1 lds
s_add_u32 m0, s19, 49152
v_mfma_f32_16x16x32_bf16 v[172:175], a[116:119], a[76:79], v[172:175]
s_add_u32 s44, s85, 0xc04000
v_fmac_f32 v216, v60, v88
v_mfma_f32_16x16x32_bf16 v[172:175], a[112:115], a[72:75], v[172:175]
v_mfma_f32_16x16x32_bf16 v[196:199], a[112:115], a[80:83], v[196:199]
v_fmac_f32 v192, v60, v86
v_mfma_f32_16x16x32_bf16 v[196:199], a[116:119], a[84:87], v[196:199]
buffer_load_dwordx4 a[44:47], v2, s[40:43], s33 offen offset:1024 sc1
v_mfma_f32_16x16x32_bf16 v[220:223], a[116:119], a[92:95], v[220:223]
v_fmac_f32 v168, v60, v84
v_fmac_f32 v141, v57, v82
v_mfma_f32_16x16x32_bf16 v[220:223], a[112:115], a[88:91], v[220:223]
s_waitcnt lgkmcnt(0)
s_barrier
v_mfma_f32_16x16x32_bf16 v[224:227], a[128:131], a[88:91], v[224:227]
v_add_u32 v5, 0, v1
v_fmac_f32 v144, v60, v82
v_mfma_f32_16x16x32_bf16 v[224:227], a[132:135], a[92:95], v[224:227]
buffer_load_dwordx4 a[48:51], v2, s[40:43], s35 offen offset:2048 sc1
v_mfma_f32_16x16x32_bf16 v[200:203], a[132:135], a[84:87], v[200:203]
ds_read_b128 a[96:99], v5 offset:2048
v_fmac_f32 v148, v64, v82
v_mfma_f32_16x16x32_bf16 v[200:203], a[128:131], a[80:83], v[200:203]
ds_read_b128 a[100:103], v5 offset:8192
v_fmac_f32 v165, v57, v84
v_mfma_f32_16x16x32_bf16 v[176:179], a[128:131], a[72:75], v[176:179]
v_fmac_f32 v172, v64, v84
v_fmac_f32 v189, v57, v86
v_mfma_f32_16x16x32_bf16 v[176:179], a[132:135], a[76:79], v[176:179]
buffer_load_dwordx4 a[52:55], v2, s[40:43], s33 offen offset:2048 sc1
v_mfma_f32_16x16x32_bf16 v[152:155], a[132:135], a[68:71], v[152:155]
ds_read_b128 a[104:107], v5 offset:3072
v_fmac_f32 v196, v64, v86
v_mfma_f32_16x16x32_bf16 v[152:155], a[128:131], a[64:67], v[152:155]
v_fmac_f32 v213, v57, v88
v_fmac_f32 v217, v61, v88
v_mfma_f32_16x16x32_bf16 v[132:135], a[136:139], a[64:67], v[132:135]
ds_read_b128 a[108:111], v5 offset:9216
v_fmac_f32 v220, v64, v88
v_mfma_f32_16x16x32_bf16 v[132:135], a[140:143], a[68:71], v[132:135]
v_fmac_f32 v193, v61, v86
v_mfma_f32_16x16x32_bf16 v[156:159], a[140:143], a[76:79], v[156:159]
buffer_load_dwordx4 v1, s[4:7], s44 offen offset:0 sc1 lds
v_mfma_f32_16x16x32_bf16 v[156:159], a[136:139], a[72:75], v[156:159]
ds_read_b128 a[112:115], v5 offset:4096
v_fmac_f32 v224, v68, v88
v_mfma_f32_16x16x32_bf16 v[180:183], a[136:139], a[80:83], v[180:183]
v_fmac_f32 v200, v68, v86
v_fmac_f32 v169, v61, v84
v_mfma_f32_16x16x32_bf16 v[180:183], a[140:143], a[84:87], v[180:183]
ds_read_b128 a[116:119], v5 offset:10240
v_fmac_f32 v145, v61, v82
v_mfma_f32_16x16x32_bf16 v[204:207], a[140:143], a[92:95], v[204:207]
v_fmac_f32 v176, v68, v84
v_fmac_f32 v149, v65, v82
v_mfma_f32_16x16x32_bf16 v[204:207], a[136:139], a[88:91], v[204:207]
buffer_load_dwordx4 a[56:59], v2, s[40:43], s35 offen offset:3072 sc1
v_mfma_f32_16x16x32_bf16 v[208:211], a[144:147], a[88:91], v[208:211]
v_fmac_f32 v152, v68, v82
v_fmac_f32 v173, v65, v84
v_mfma_f32_16x16x32_bf16 v[208:211], a[148:151], a[92:95], v[208:211]
v_mfma_f32_16x16x32_bf16 v[184:187], a[148:151], a[84:87], v[184:187]
v_fmac_f32 v132, v48, v82
v_fmac_f32 v197, v65, v86
v_mfma_f32_16x16x32_bf16 v[184:187], a[144:147], a[80:83], v[184:187]
v_mfma_f32_16x16x32_bf16 v[160:163], a[144:147], a[72:75], v[160:163]
buffer_load_dwordx4 a[60:63], v2, s[40:43], s33 offen offset:3072 sc1
s_add_u32 s35, s35, 8192
v_mfma_f32_16x16x32_bf16 v[160:163], a[148:151], a[76:79], v[160:163]
s_add_u32 s33, s33, 8192
v_fmac_f32 v156, v48, v84
v_mfma_f32_16x16x32_bf16 v[136:139], a[148:151], a[68:71], v[136:139]
v_fmac_f32 v180, v48, v86
v_fmac_f32 v221, v65, v88
v_mfma_f32_16x16x32_bf16 v[136:139], a[144:147], a[64:67], v[136:139]
v_fmac_f32 v225, v69, v88
s_waitcnt vmcnt(11) lgkmcnt(0)
v_mfma_f32_16x16x32_bf16 v[140:143], a[96:99], a[0:3], v[140:143]
ds_read_b128 a[128:131], v5 offset:5120
v_fmac_f32 v204, v48, v88
v_mfma_f32_16x16x32_bf16 v[140:143], a[100:103], a[4:7], v[140:143]
buffer_load_dwordx4 a[64:67], v2, s[40:43], s35 offen offset:0 sc1
s_lshl_b32 s36, s28, 9
v_mfma_f32_16x16x32_bf16 v[164:167], a[100:103], a[12:15], v[164:167]
ds_read_b128 a[132:135], v5 offset:11264
v_fmac_f32 v208, v52, v88
v_mfma_f32_16x16x32_bf16 v[164:167], a[96:99], a[8:11], v[164:167]
v_fmac_f32 v201, v69, v86
v_fmac_f32 v177, v69, v84
v_mfma_f32_16x16x32_bf16 v[188:191], a[96:99], a[16:19], v[188:191]
v_fmac_f32 v184, v52, v86
v_fmac_f32 v153, v69, v82
v_mfma_f32_16x16x32_bf16 v[188:191], a[100:103], a[20:23], v[188:191]
buffer_load_dwordx4 a[68:71], v2, s[40:43], s33 offen offset:0 sc1
s_lshl_b32 s37, s30, 2
v_mfma_f32_16x16x32_bf16 v[212:215], a[100:103], a[28:31], v[212:215]
ds_read_b128 a[136:139], v5 offset:0
v_fmac_f32 v160, v52, v84
v_mfma_f32_16x16x32_bf16 v[212:215], a[96:99], a[24:27], v[212:215]
v_fmac_f32 v133, v49, v82
v_add_u32 v232, s19, v7
v_mfma_f32_16x16x32_bf16 v[216:219], a[104:107], a[24:27], v[216:219]
ds_read_b128 a[140:143], v5 offset:6144
v_fmac_f32 v136, v52, v82
v_mfma_f32_16x16x32_bf16 v[216:219], a[108:111], a[28:31], v[216:219]
buffer_load_dwordx4 a[72:75], v2, s[40:43], s35 offen offset:1024 sc1
s_add_u32 s37, s37, s28
v_mfma_f32_16x16x32_bf16 v[192:195], a[108:111], a[20:23], v[192:195]
ds_read_b128 a[144:147], v5 offset:1024
v_fmac_f32 v157, v49, v84
v_mfma_f32_16x16x32_bf16 v[192:195], a[104:107], a[16:19], v[192:195]
v_fmac_f32 v181, v49, v86
v_fmac_f32 v142, v58, v82
v_mfma_f32_16x16x32_bf16 v[168:171], a[104:107], a[8:11], v[168:171]
v_fmac_f32 v205, v49, v88
v_fmac_f32 v166, v58, v84
v_mfma_f32_16x16x32_bf16 v[168:171], a[108:111], a[12:15], v[168:171]
buffer_load_dwordx4 a[76:79], v2, s[40:43], s33 offen offset:1024 sc1
s_lshl_b32 s98, s37, 13
v_mfma_f32_16x16x32_bf16 v[144:147], a[108:111], a[4:7], v[144:147]
ds_read_b128 a[148:151], v5 offset:7168
v_fmac_f32 v209, v53, v88
v_mfma_f32_16x16x32_bf16 v[144:147], a[104:107], a[0:3], v[144:147]
v_fmac_f32 v190, v58, v86
s_add_u32 s98, s98, 0x400000
v_mfma_f32_16x16x32_bf16 v[148:151], a[112:115], a[0:3], v[148:151]
v_fmac_f32 v185, v53, v86
v_fmac_f32 v214, v58, v88
v_mfma_f32_16x16x32_bf16 v[148:151], a[116:119], a[4:7], v[148:151]
buffer_load_dwordx4 a[80:83], v2, s[40:43], s35 offen offset:2048 sc1
s_add_u32 s99, s98, 4096
v_mfma_f32_16x16x32_bf16 v[172:175], a[116:119], a[12:15], v[172:175]
v_fmac_f32 v161, v53, v84
v_fmac_f32 v218, v62, v88
v_mfma_f32_16x16x32_bf16 v[172:175], a[112:115], a[8:11], v[172:175]
s_lshl_b32 s100, s37, 10
s_add_u32 s100, s100, 0x820000
s_lshl_b32 s96, s29, 10
v_mfma_f32_16x16x32_bf16 v[196:199], a[112:115], a[16:19], v[196:199]
v_fmac_f32 v137, v53, v82
v_fmac_f32 v194, v62, v86
v_mfma_f32_16x16x32_bf16 v[196:199], a[116:119], a[20:23], v[196:199]
buffer_load_dwordx4 a[84:87], v2, s[40:43], s33 offen offset:2048 sc1
s_add_u32 s96, s96, s98
v_mfma_f32_16x16x32_bf16 v[220:223], a[116:119], a[28:31], v[220:223]
v_fmac_f32 v170, v62, v84
v_fmac_f32 v143, v59, v82
v_mfma_f32_16x16x32_bf16 v[220:223], a[112:115], a[24:27], v[220:223]
s_lshl_b32 s97, s29, 7
s_waitcnt lgkmcnt(0)
v_mfma_f32_16x16x32_bf16 v[224:227], a[128:131], a[24:27], v[224:227]
ds_read_b128 a[96:99], v5 offset:14336
v_fmac_f32 v146, v62, v82
v_mfma_f32_16x16x32_bf16 v[224:227], a[132:135], a[28:31], v[224:227]
buffer_load_dwordx4 a[88:91], v2, s[40:43], s35 offen offset:3072 sc1
s_add_u32 s97, s97, s100
v_mfma_f32_16x16x32_bf16 v[200:203], a[132:135], a[20:23], v[200:203]
ds_read_b128 a[100:103], v5 offset:20480
v_fmac_f32 v150, v66, v82
v_mfma_f32_16x16x32_bf16 v[200:203], a[128:131], a[16:19], v[200:203]
v_fmac_f32 v167, v59, v84
v_fmac_f32 v191, v59, v86
v_mfma_f32_16x16x32_bf16 v[176:179], a[128:131], a[8:11], v[176:179]
v_fmac_f32 v174, v66, v84
v_fmac_f32 v215, v59, v88
v_mfma_f32_16x16x32_bf16 v[176:179], a[132:135], a[12:15], v[176:179]
ds_read_b128 a[104:107], v5 offset:15360
s_lshl_b32 s88, s28, 6
v_mfma_f32_16x16x32_bf16 v[152:155], a[132:135], a[4:7], v[152:155]
v_fmac_f32 v198, v66, v86
v_fmac_f32 v219, v63, v88
v_mfma_f32_16x16x32_bf16 v[152:155], a[128:131], a[0:3], v[152:155]
buffer_load_dwordx4 v1, s[4:7], s44 offen offset:1024 sc1 lds
s_add_u32 s94, s80, s88
v_mfma_f32_16x16x32_bf16 v[132:135], a[136:139], a[0:3], v[132:135]
ds_read_b128 a[108:111], v5 offset:21504
v_fmac_f32 v222, v66, v88
v_mfma_f32_16x16x32_bf16 v[132:135], a[140:143], a[4:7], v[132:135]
v_fmac_f32 v195, v63, v86
s_add_u32 s94, s94, 0x90000
v_mfma_f32_16x16x32_bf16 v[156:159], a[140:143], a[12:15], v[156:159]
ds_read_b128 a[112:115], v5 offset:16384
v_fmac_f32 v226, v70, v88
v_mfma_f32_16x16x32_bf16 v[156:159], a[136:139], a[8:11], v[156:159]
v_fmac_f32 v171, v63, v84
s_add_u32 s88, s88, s70
v_mfma_f32_16x16x32_bf16 v[180:183], a[136:139], a[16:19], v[180:183]
v_fmac_f32 v202, v70, v86
v_fmac_f32 v147, v63, v82
v_mfma_f32_16x16x32_bf16 v[180:183], a[140:143], a[20:23], v[180:183]
buffer_load_dwordx4 a[92:95], v2, s[40:43], s33 offen offset:3072 sc1
s_add_u32 s35, s35, 8192
v_mfma_f32_16x16x32_bf16 v[204:207], a[140:143], a[28:31], v[204:207]
s_add_u32 s33, s33, 8192
ds_read_b128 a[116:119], v5 offset:22528
v_mfma_f32_16x16x32_bf16 v[204:207], a[136:139], a[24:27], v[204:207]
v_fmac_f32 v178, v70, v84
v_fmac_f32 v151, v67, v82
v_mfma_f32_16x16x32_bf16 v[208:211], a[144:147], a[24:27], v[208:211]
v_fmac_f32 v154, v70, v82
v_fmac_f32 v175, v67, v84
v_mfma_f32_16x16x32_bf16 v[208:211], a[148:151], a[28:31], v[208:211]
s_add_u32 s89, s88, 0x90000
s_add_u32 s74, s71, 0x30080
s_lshl_b32 s73, s30, 12
v_mfma_f32_16x16x32_bf16 v[184:187], a[148:151], a[20:23], v[184:187]
v_fmac_f32 v134, v50, v82
v_fmac_f32 v199, v67, v86
v_mfma_f32_16x16x32_bf16 v[184:187], a[144:147], a[16:19], v[184:187]
buffer_load_dwordx4 v1, s[4:7], s44 offen offset:2048 sc1 lds
s_add_u32 s72, s73, 0x2600000
v_mfma_f32_16x16x32_bf16 v[160:163], a[144:147], a[8:11], v[160:163]
v_fmac_f32 v158, v50, v84
v_fmac_f32 v223, v67, v88
v_mfma_f32_16x16x32_bf16 v[160:163], a[148:151], a[12:15], v[160:163]
v_add_u32 v233, s19, v232
s_add_u32 s73, s73, 0x1e00000
v_mfma_f32_16x16x32_bf16 v[136:139], a[148:151], a[4:7], v[136:139]
v_fmac_f32 v182, v50, v86
v_fmac_f32 v227, v71, v88
v_mfma_f32_16x16x32_bf16 v[136:139], a[144:147], a[0:3], v[136:139]
s_waitcnt vmcnt(10) lgkmcnt(0)
s_barrier
v_mfma_f32_16x16x32_bf16 v[140:143], a[96:99], a[32:35], v[140:143]
ds_read_b128 a[128:131], v5 offset:17408
v_fmac_f32 v206, v50, v88
v_mfma_f32_16x16x32_bf16 v[140:143], a[100:103], a[36:39], v[140:143]
buffer_load_dwordx4 a[0:3], v2, s[40:43], s35 offen offset:0 sc1
s_lshr_b32 s38, s28, 1
v_mfma_f32_16x16x32_bf16 v[164:167], a[100:103], a[44:47], v[164:167]
ds_read_b128 a[132:135], v5 offset:23552
v_fmac_f32 v210, v54, v88
v_mfma_f32_16x16x32_bf16 v[164:167], a[96:99], a[40:43], v[164:167]
v_fmac_f32 v203, v71, v86
v_fmac_f32 v179, v71, v84
v_mfma_f32_16x16x32_bf16 v[188:191], a[96:99], a[48:51], v[188:191]
buffer_load_dwordx4 a[4:7], v2, s[40:43], s33 offen offset:0 sc1
s_and_b32 s39, s28, 1
v_mfma_f32_16x16x32_bf16 v[188:191], a[100:103], a[52:55], v[188:191]
ds_read_b128 a[136:139], v5 offset:26624
v_fmac_f32 v186, v54, v86
v_mfma_f32_16x16x32_bf16 v[212:215], a[100:103], a[60:63], v[212:215]
v_fmac_f32 v162, v54, v84
v_fmac_f32 v155, v71, v82
v_mfma_f32_16x16x32_bf16 v[212:215], a[96:99], a[56:59], v[212:215]
buffer_load_dwordx4 a[8:11], v2, s[40:43], s35 offen offset:1024 sc1
s_mul_i32 s38, s38, 3072
v_mfma_f32_16x16x32_bf16 v[216:219], a[104:107], a[56:59], v[216:219]
ds_read_b128 a[140:143], v5 offset:32768
v_fmac_f32 v138, v54, v82
v_mfma_f32_16x16x32_bf16 v[216:219], a[108:111], a[60:63], v[216:219]
v_fmac_f32 v135, v51, v82
v_fmac_f32 v159, v51, v84
v_mfma_f32_16x16x32_bf16 v[192:195], a[108:111], a[52:55], v[192:195]
buffer_load_dwordx4 a[12:15], v2, s[40:43], s33 offen offset:1024 sc1
s_lshl_b32 s39, s39, 3
v_mfma_f32_16x16x32_bf16 v[192:195], a[104:107], a[48:51], v[192:195]
ds_read_b128 a[144:147], v5 offset:27648
v_fmac_f32 v183, v51, v86
v_mfma_f32_16x16x32_bf16 v[168:171], a[104:107], a[40:43], v[168:171]
v_fmac_f32 v207, v51, v88
s_add_u32 s38, s38, s39
v_mfma_f32_16x16x32_bf16 v[168:171], a[108:111], a[44:47], v[168:171]
buffer_load_dwordx4 a[16:19], v2, s[40:43], s35 offen offset:2048 sc1
v_mfma_f32_16x16x32_bf16 v[144:147], a[108:111], a[36:39], v[144:147]
ds_read_b128 a[148:151], v5 offset:33792
v_fmac_f32 v211, v55, v88
v_mfma_f32_16x16x32_bf16 v[144:147], a[104:107], a[32:35], v[144:147]
v_mul_f32 v88, 0x3fb8aa3b, v89
v_and_b32 v248, 7, v0
v_mfma_f32_16x16x32_bf16 v[148:151], a[112:115], a[32:35], v[148:151]
buffer_load_dwordx4 a[20:23], v2, s[40:43], s33 offen offset:2048 sc1
v_mfma_f32_16x16x32_bf16 v[148:151], a[116:119], a[36:39], v[148:151]
v_fmac_f32 v187, v55, v86
v_lshlrev_b32 v248, 7, v248
v_mfma_f32_16x16x32_bf16 v[172:175], a[116:119], a[44:47], v[172:175]
v_fmac_f32 v163, v55, v84
v_mul_f32 v86, 0x3fb8aa3b, v87
v_mfma_f32_16x16x32_bf16 v[172:175], a[112:115], a[40:43], v[172:175]
buffer_load_dwordx4 a[24:27], v2, s[40:43], s35 offen offset:3072 sc1
v_mfma_f32_16x16x32_bf16 v[196:199], a[112:115], a[48:51], v[196:199]
v_fmac_f32 v139, v55, v82
v_mul_f32 v84, 0x3fb8aa3b, v85
v_mfma_f32_16x16x32_bf16 v[196:199], a[116:119], a[52:55], v[196:199]
v_mul_f32 v82, 0x3fb8aa3b, v83
v_lshrrev_b32 v249, 4, v0
v_mfma_f32_16x16x32_bf16 v[220:223], a[116:119], a[60:63], v[220:223]
buffer_load_dwordx4 a[28:31], v2, s[40:43], s33 offen offset:3072 sc1
s_add_u32 s35, s35, 8192
v_mfma_f32_16x16x32_bf16 v[220:223], a[112:115], a[56:59], v[220:223]
s_add_u32 s33, s33, 8192
s_waitcnt lgkmcnt(0)
v_mfma_f32_16x16x32_bf16 v[224:227], a[128:131], a[56:59], v[224:227]
ds_read_b128 a[96:99], v5 offset:28672
v_lshlrev_b32 v235, 8, v0
v_mfma_f32_16x16x32_bf16 v[224:227], a[132:135], a[60:63], v[224:227]
buffer_load_dwordx4 v1, s[4:7], s44 offen offset:3072 sc1 lds
s_add_u32 m0, s19, 65536
v_mfma_f32_16x16x32_bf16 v[200:203], a[132:135], a[52:55], v[200:203]
s_add_u32 s44, s84, 0xc08000
ds_read_b128 a[100:103], v5 offset:34816
v_mfma_f32_16x16x32_bf16 v[200:203], a[128:131], a[48:51], v[200:203]
v_lshl_add_u32 v248, v249, 4, v248
v_add_u32 v234, s36, v8
v_mfma_f32_16x16x32_bf16 v[176:179], a[128:131], a[40:43], v[176:179]
v_cndmask_b32 v235, 2.0, v235, s[64:65]
v_mov_b32 v249, 0x3f80
v_mfma_f32_16x16x32_bf16 v[176:179], a[132:135], a[44:47], v[176:179]
ds_read_b128 a[104:107], v5 offset:29696
v_mov_b32 v250, 1.0
v_mfma_f32_16x16x32_bf16 v[152:155], a[132:135], a[36:39], v[152:155]
v_add_u32 v252, s38, v1
v_mfma_f32_16x16x32_bf16 v[152:155], a[128:131], a[32:35], v[152:155]
s_waitcnt vmcnt(18)
v_mfma_f32_16x16x32_bf16 v[140:143], a[136:139], a[64:67], v[140:143]
ds_read_b128 a[108:111], v5 offset:35840
s_waitcnt vmcnt(17)
v_mfma_f32_16x16x32_bf16 v[140:143], a[140:143], a[68:71], v[140:143]
s_waitcnt vmcnt(15)
v_mfma_f32_16x16x32_bf16 v[164:167], a[140:143], a[76:79], v[164:167]
ds_read_b128 a[112:115], v5 offset:38912
v_mfma_f32_16x16x32_bf16 v[164:167], a[136:139], a[72:75], v[164:167]
s_waitcnt vmcnt(14)
v_mfma_f32_16x16x32_bf16 v[188:191], a[136:139], a[80:83], v[188:191]
s_waitcnt vmcnt(13)
v_mfma_f32_16x16x32_bf16 v[188:191], a[140:143], a[84:87], v[188:191]
buffer_load_dwordx4 v1, s[4:7], s44 offen offset:0 sc1 lds
s_waitcnt vmcnt(11)
v_mfma_f32_16x16x32_bf16 v[212:215], a[140:143], a[92:95], v[212:215]
ds_read_b128 a[116:119], v5 offset:45056
v_mfma_f32_16x16x32_bf16 v[212:215], a[136:139], a[88:91], v[212:215]
v_mfma_f32_16x16x32_bf16 v[216:219], a[144:147], a[88:91], v[216:219]
v_mfma_f32_16x16x32_bf16 v[216:219], a[148:151], a[92:95], v[216:219]
v_mfma_f32_16x16x32_bf16 v[192:195], a[148:151], a[84:87], v[192:195]
v_mfma_f32_16x16x32_bf16 v[192:195], a[144:147], a[80:83], v[192:195]
v_mfma_f32_16x16x32_bf16 v[168:171], a[144:147], a[72:75], v[168:171]
v_mfma_f32_16x16x32_bf16 v[168:171], a[148:151], a[76:79], v[168:171]
v_mfma_f32_16x16x32_bf16 v[144:147], a[148:151], a[68:71], v[144:147]
v_mfma_f32_16x16x32_bf16 v[144:147], a[144:147], a[64:67], v[144:147]
s_waitcnt lgkmcnt(0)
v_mfma_f32_16x16x32_bf16 v[148:151], a[96:99], a[64:67], v[148:151]
ds_read_b128 a[128:131], v5 offset:39936
v_mfma_f32_16x16x32_bf16 v[148:151], a[100:103], a[68:71], v[148:151]
buffer_load_dwordx4 v1, s[4:7], s44 offen offset:1024 sc1 lds
v_mfma_f32_16x16x32_bf16 v[172:175], a[100:103], a[76:79], v[172:175]
ds_read_b128 a[132:135], v5 offset:46080
v_mfma_f32_16x16x32_bf16 v[172:175], a[96:99], a[72:75], v[172:175]
v_mfma_f32_16x16x32_bf16 v[196:199], a[96:99], a[80:83], v[196:199]
v_mfma_f32_16x16x32_bf16 v[196:199], a[100:103], a[84:87], v[196:199]
buffer_load_dwordx4 v1, s[4:7], s44 offen offset:2048 sc1 lds
v_mfma_f32_16x16x32_bf16 v[220:223], a[100:103], a[92:95], v[220:223]
ds_read_b128 a[136:139], v5 offset:40960
v_mfma_f32_16x16x32_bf16 v[220:223], a[96:99], a[88:91], v[220:223]
v_mfma_f32_16x16x32_bf16 v[224:227], a[104:107], a[88:91], v[224:227]
ds_read_b128 a[140:143], v5 offset:47104
v_mfma_f32_16x16x32_bf16 v[224:227], a[108:111], a[92:95], v[224:227]
v_mfma_f32_16x16x32_bf16 v[200:203], a[108:111], a[84:87], v[200:203]
buffer_load_dwordx4 v1, s[4:7], s44 offen offset:3072 sc1 lds
s_add_u32 m0, s19, 81920
v_mfma_f32_16x16x32_bf16 v[200:203], a[104:107], a[80:83], v[200:203]
s_add_u32 s44, s85, 0xc0c000
ds_read_b128 a[144:147], v5 offset:41984
v_mfma_f32_16x16x32_bf16 v[176:179], a[104:107], a[72:75], v[176:179]
v_mfma_f32_16x16x32_bf16 v[176:179], a[108:111], a[76:79], v[176:179]
ds_read_b128 a[148:151], v5 offset:48128
v_mfma_f32_16x16x32_bf16 v[152:155], a[108:111], a[68:71], v[152:155]
v_mfma_f32_16x16x32_bf16 v[152:155], a[104:107], a[64:67], v[152:155]
buffer_load_dwordx4 v1, s[4:7], s44 offen offset:0 sc1 lds
s_waitcnt vmcnt(13)
v_mfma_f32_16x16x32_bf16 v[140:143], a[112:115], a[0:3], v[140:143]
s_waitcnt vmcnt(12)
v_mfma_f32_16x16x32_bf16 v[140:143], a[116:119], a[4:7], v[140:143]
s_waitcnt vmcnt(10)
v_mfma_f32_16x16x32_bf16 v[164:167], a[116:119], a[12:15], v[164:167]
v_mfma_f32_16x16x32_bf16 v[164:167], a[112:115], a[8:11], v[164:167]
s_waitcnt vmcnt(9)
v_mfma_f32_16x16x32_bf16 v[188:191], a[112:115], a[16:19], v[188:191]
buffer_load_dwordx4 v1, s[4:7], s44 offen offset:1024 sc1 lds
s_waitcnt vmcnt(9)
v_mfma_f32_16x16x32_bf16 v[188:191], a[116:119], a[20:23], v[188:191]
s_waitcnt vmcnt(7)
v_mfma_f32_16x16x32_bf16 v[212:215], a[116:119], a[28:31], v[212:215]
v_mfma_f32_16x16x32_bf16 v[212:215], a[112:115], a[24:27], v[212:215]
s_waitcnt lgkmcnt(0)
v_mfma_f32_16x16x32_bf16 v[216:219], a[128:131], a[24:27], v[216:219]
ds_read_b128 a[96:99], v5 offset:12288
v_cvt_pk_bf16_f32 v140, v140, v141
v_mfma_f32_16x16x32_bf16 v[216:219], a[132:135], a[28:31], v[216:219]
buffer_load_dwordx4 v1, s[4:7], s44 offen offset:2048 sc1 lds
v_mfma_f32_16x16x32_bf16 v[192:195], a[132:135], a[20:23], v[192:195]
ds_read_b128 a[100:103], v5 offset:18432
v_cvt_pk_bf16_f32 v141, v142, v143
v_mfma_f32_16x16x32_bf16 v[192:195], a[128:131], a[16:19], v[192:195]
v_cvt_pk_bf16_f32 v164, v164, v165
v_cvt_pk_bf16_f32 v165, v166, v167
v_mfma_f32_16x16x32_bf16 v[168:171], a[128:131], a[8:11], v[168:171]
v_cvt_pk_bf16_f32 v188, v188, v189
v_cvt_pk_bf16_f32 v189, v190, v191
v_mfma_f32_16x16x32_bf16 v[168:171], a[132:135], a[12:15], v[168:171]
buffer_load_dwordx4 v1, s[4:7], s44 offen offset:3072 sc1 lds
s_add_u32 m0, s19, 147456
v_mfma_f32_16x16x32_bf16 v[144:147], a[132:135], a[4:7], v[144:147]
s_add_u32 s44, s87, 0xc1c000
ds_read_b128 a[104:107], v5 offset:24576
v_mfma_f32_16x16x32_bf16 v[144:147], a[128:131], a[0:3], v[144:147]
v_cvt_pk_bf16_f32 v212, v212, v213
v_cvt_pk_bf16_f32 v213, v214, v215
v_mfma_f32_16x16x32_bf16 v[148:151], a[136:139], a[0:3], v[148:151]
ds_read_b128 a[108:111], v5 offset:30720
v_cvt_pk_bf16_f32 v214, v216, v217
v_mfma_f32_16x16x32_bf16 v[148:151], a[140:143], a[4:7], v[148:151]
v_cvt_pk_bf16_f32 v215, v218, v219
v_mfma_f32_16x16x32_bf16 v[172:175], a[140:143], a[12:15], v[172:175]
buffer_load_dwordx4 v1, s[4:7], s44 offen offset:0 sc1 lds
v_mfma_f32_16x16x32_bf16 v[172:175], a[136:139], a[8:11], v[172:175]
ds_read_b128 a[112:115], v5 offset:36864
v_cvt_pk_bf16_f32 v190, v192, v193
v_mfma_f32_16x16x32_bf16 v[196:199], a[136:139], a[16:19], v[196:199]
v_cvt_pk_bf16_f32 v166, v168, v169
v_cvt_pk_bf16_f32 v167, v170, v171
v_mfma_f32_16x16x32_bf16 v[196:199], a[140:143], a[20:23], v[196:199]
ds_read_b128 a[116:119], v5 offset:43008
v_cvt_pk_bf16_f32 v191, v194, v195
v_mfma_f32_16x16x32_bf16 v[220:223], a[140:143], a[28:31], v[220:223]
v_cvt_pk_bf16_f32 v142, v144, v145
v_cvt_pk_bf16_f32 v143, v146, v147
v_mfma_f32_16x16x32_bf16 v[220:223], a[136:139], a[24:27], v[220:223]
buffer_load_dwordx4 v1, s[4:7], s44 offen offset:1024 sc1 lds
v_mfma_f32_16x16x32_bf16 v[224:227], a[144:147], a[24:27], v[224:227]
v_mfma_f32_16x16x32_bf16 v[92:95], a[240:243], v[140:143], 0
v_mfma_f32_16x16x32_bf16 v[224:227], a[148:151], a[28:31], v[224:227]
v_mfma_f32_16x16x32_bf16 v[96:99], a[244:247], v[140:143], 0
v_mfma_f32_16x16x32_bf16 v[200:203], a[148:151], a[20:23], v[200:203]
v_mfma_f32_16x16x32_bf16 v[100:103], a[240:243], v[164:167], 0
v_mfma_f32_16x16x32_bf16 v[200:203], a[144:147], a[16:19], v[200:203]
v_mfma_f32_16x16x32_bf16 v[104:107], a[244:247], v[164:167], 0
v_mfma_f32_16x16x32_bf16 v[176:179], a[144:147], a[8:11], v[176:179]
buffer_load_dwordx4 v1, s[4:7], s44 offen offset:2048 sc1 lds
v_mfma_f32_16x16x32_bf16 v[176:179], a[148:151], a[12:15], v[176:179]
v_max3_f32 v236, v92, v93, v94
v_max3_f32 v237, -v92, -v93, -v94
v_mfma_f32_16x16x32_bf16 v[152:155], a[148:151], a[4:7], v[152:155]
v_max3_f32 v236, v236, v95, v96
v_max3_f32 v237, v237, -v95, -v96
v_mfma_f32_16x16x32_bf16 v[152:155], a[144:147], a[0:3], v[152:155]
v_max3_f32 v236, v236, v97, v98
s_waitcnt lgkmcnt(0)
v_mfma_f32_16x16x32_bf16 v[132:135], a[96:99], a[32:35], v[132:135]
ds_read_b128 a[128:131], v5 offset:13312
v_max3_f32 v237, v237, -v97, -v98
v_mfma_f32_16x16x32_bf16 v[132:135], a[100:103], a[36:39], v[132:135]
buffer_load_dwordx4 v1, s[4:7], s44 offen offset:3072 sc1 lds
s_add_u32 m0, s19, 98304
v_mfma_f32_16x16x32_bf16 v[156:159], a[100:103], a[44:47], v[156:159]
s_add_u32 s44, s84, 0xc10000
ds_read_b128 a[132:135], v5 offset:19456
v_mfma_f32_16x16x32_bf16 v[156:159], a[96:99], a[40:43], v[156:159]
v_max_f32 v236, v236, v99
v_max_f32_e64 v237, v237, -v99
v_mfma_f32_16x16x32_bf16 v[180:183], a[96:99], a[48:51], v[180:183]
s_nop 0
v_permlane32_swap_b32 v236, v237
v_mfma_f32_16x16x32_bf16 v[180:183], a[100:103], a[52:55], v[180:183]
buffer_load_dwordx4 v1, s[4:7], s44 offen offset:0 sc1 lds
v_mfma_f32_16x16x32_bf16 v[204:207], a[100:103], a[60:63], v[204:207]
ds_read_b128 a[136:139], v5 offset:25600
v_max_f32 v236, v236, v237
v_mfma_f32_16x16x32_bf16 v[204:207], a[96:99], a[56:59], v[204:207]
v_mov_b32 v244, v236
v_max3_f32 v238, v100, v101, v102
v_mfma_f32_16x16x32_bf16 v[204:207], a[104:107], a[88:91], v[204:207]
ds_read_b128 a[140:143], v5 offset:31744
v_max3_f32 v239, -v100, -v101, -v102
v_mfma_f32_16x16x32_bf16 v[204:207], a[108:111], a[92:95], v[204:207]
v_permlane16_swap_b32 v236, v244
v_mfma_f32_16x16x32_bf16 v[180:183], a[108:111], a[84:87], v[180:183]
buffer_load_dwordx4 v1, s[4:7], s44 offen offset:1024 sc1 lds
L_stub17:
s_cbranch_execz L_stub18
v_mfma_f32_16x16x32_bf16 v[180:183], a[104:107], a[80:83], v[180:183]
ds_read_b128 a[144:147], v5 offset:37888
v_max_f32 v236, v236, v244
v_mfma_f32_16x16x32_bf16 v[156:159], a[104:107], a[72:75], v[156:159]
v_mov_b32 v244, v236
v_max3_f32 v238, v238, v103, v104
v_mfma_f32_16x16x32_bf16 v[156:159], a[108:111], a[76:79], v[156:159]
ds_read_b128 a[148:151], v5 offset:44032
v_max3_f32 v239, v239, -v103, -v104
v_mfma_f32_16x16x32_bf16 v[132:135], a[108:111], a[68:71], v[132:135]
v_permlane32_swap_b32 v236, v244
v_mfma_f32_16x16x32_bf16 v[132:135], a[104:107], a[64:67], v[132:135]
buffer_load_dwordx4 v1, s[4:7], s44 offen offset:2048 sc1 lds
v_mfma_f32_16x16x32_bf16 v[132:135], a[112:115], a[0:3], v[132:135]
v_mul_f32_e64 v236, -v236, v82
v_mul_f32_e64 v237, -v244, v82
v_mfma_f32_16x16x32_bf16 v[132:135], a[116:119], a[4:7], v[132:135]
v_max3_f32 v238, v238, v105, v106
v_max3_f32 v239, v239, -v105, -v106
v_mfma_f32_16x16x32_bf16 v[156:159], a[116:119], a[12:15], v[156:159]
v_max_f32 v238, v238, v107
v_max_f32_e64 v239, v239, -v107
v_mfma_f32_16x16x32_bf16 v[156:159], a[112:115], a[8:11], v[156:159]
s_nop 0
v_permlane32_swap_b32 v238, v239
v_mfma_f32_16x16x32_bf16 v[180:183], a[112:115], a[16:19], v[180:183]
buffer_load_dwordx4 v1, s[4:7], s44 offen offset:3072 sc1 lds
s_add_u32 m0, s19, 114688
v_mfma_f32_16x16x32_bf16 v[180:183], a[116:119], a[20:23], v[180:183]
s_add_u32 s44, s85, 0xc14000
v_max_f32 v238, v238, v239
v_mfma_f32_16x16x32_bf16 v[204:207], a[116:119], a[28:31], v[204:207]
v_mov_b32 v245, v238
v_mul_f32 v148, v148, v83
v_mfma_f32_16x16x32_bf16 v[204:207], a[112:115], a[24:27], v[204:207]
s_waitcnt lgkmcnt(0)
s_barrier
v_mfma_f32_16x16x32_bf16 v[208:211], a[128:131], a[56:59], v[208:211]
v_mul_f32 v149, v149, v83
v_cvt_pk_bf16_f32 v148, v148, v149
v_mfma_f32_16x16x32_bf16 v[208:211], a[132:135], a[60:63], v[208:211]
buffer_load_dwordx4 v1, s[4:7], s44 offen offset:0 sc1 lds
v_mfma_f32_16x16x32_bf16 v[184:187], a[132:135], a[52:55], v[184:187]
v_permlane16_swap_b32 v238, v245
v_mfma_f32_16x16x32_bf16 v[184:187], a[128:131], a[48:51], v[184:187]
v_max_f32 v238, v238, v245
v_mov_b32 v245, v238
v_mfma_f32_16x16x32_bf16 v[160:163], a[128:131], a[40:43], v[160:163]
s_nop 0
v_permlane32_swap_b32 v238, v245
v_mfma_f32_16x16x32_bf16 v[160:163], a[132:135], a[44:47], v[160:163]
v_mul_f32_e64 v238, -v238, v84
v_mul_f32_e64 v239, -v245, v84
v_mfma_f32_16x16x32_bf16 v[136:139], a[132:135], a[36:39], v[136:139]
v_mfma_f32_16x16x32_bf16 v[108:111], a[240:243], v[188:191], 0
v_mfma_f32_16x16x32_bf16 v[136:139], a[128:131], a[32:35], v[136:139]
buffer_load_dwordx4 v1, s[4:7], s44 offen offset:1024 sc1 lds
v_mfma_f32_16x16x32_bf16 v[136:139], a[136:139], a[64:67], v[136:139]
v_mfma_f32_16x16x32_bf16 v[112:115], a[244:247], v[188:191], 0
v_mfma_f32_16x16x32_bf16 v[136:139], a[140:143], a[68:71], v[136:139]
v_mfma_f32_16x16x32_bf16 v[116:119], a[240:243], v[212:215], 0
v_mfma_f32_16x16x32_bf16 v[160:163], a[140:143], a[76:79], v[160:163]
v_mfma_f32_16x16x32_bf16 v[120:123], a[244:247], v[212:215], 0
v_mfma_f32_16x16x32_bf16 v[160:163], a[136:139], a[72:75], v[160:163]
v_max3_f32 v240, v108, v109, v110
v_max3_f32 v241, -v108, -v109, -v110
v_mfma_f32_16x16x32_bf16 v[184:187], a[136:139], a[80:83], v[184:187]
v_mul_f32 v150, v150, v83
v_mul_f32 v151, v151, v83
v_mfma_f32_16x16x32_bf16 v[184:187], a[140:143], a[84:87], v[184:187]
buffer_load_dwordx4 v1, s[4:7], s44 offen offset:2048 sc1 lds
v_mfma_f32_16x16x32_bf16 v[208:211], a[140:143], a[92:95], v[208:211]
v_cvt_pk_bf16_f32 v149, v150, v151
v_max3_f32 v240, v240, v111, v112
v_mfma_f32_16x16x32_bf16 v[208:211], a[136:139], a[88:91], v[208:211]
ds_write_b64 v232, v[148:149] offset:0
v_max3_f32 v241, v241, -v111, -v112
v_mfma_f32_16x16x32_bf16 v[208:211], a[144:147], a[24:27], v[208:211]
v_max3_f32 v240, v240, v113, v114
v_max3_f32 v241, v241, -v113, -v114
v_mfma_f32_16x16x32_bf16 v[208:211], a[148:151], a[28:31], v[208:211]
v_max_f32 v240, v240, v115
v_max_f32_e64 v241, v241, -v115
v_mfma_f32_16x16x32_bf16 v[184:187], a[148:151], a[20:23], v[184:187]
s_nop 0
v_permlane32_swap_b32 v240, v241
v_mfma_f32_16x16x32_bf16 v[184:187], a[144:147], a[16:19], v[184:187]
buffer_load_dwordx4 v1, s[4:7], s44 offen offset:3072 sc1 lds
v_mfma_f32_16x16x32_bf16 v[160:163], a[144:147], a[8:11], v[160:163]
v_max_f32 v240, v240, v241
v_mov_b32 v246, v240
v_mfma_f32_16x16x32_bf16 v[160:163], a[148:151], a[12:15], v[160:163]
s_nop 0
v_permlane16_swap_b32 v240, v246
v_mfma_f32_16x16x32_bf16 v[136:139], a[148:151], a[4:7], v[136:139]
v_max_f32 v240, v240, v246
v_mov_b32 v246, v240
v_mfma_f32_16x16x32_bf16 v[136:139], a[144:147], a[0:3], v[136:139]
s_nop 0
v_permlane32_swap_b32 v240, v246
v_pk_mul_f32 v[152:153], v[152:153], v[82:83] op_sel:[0,1] op_sel_hi:[1,1]
v_pk_mul_f32 v[154:155], v[154:155], v[82:83] op_sel:[0,1] op_sel_hi:[1,1]
v_cvt_pk_bf16_f32 v150, v152, v153
v_cvt_pk_bf16_f32 v151, v154, v155
ds_write_b64 v232, v[150:151] offset:512
v_pk_mul_f32 v[172:173], v[172:173], v[84:85] op_sel:[0,1] op_sel_hi:[1,1]
v_pk_mul_f32 v[174:175], v[174:175], v[84:85] op_sel:[0,1] op_sel_hi:[1,1]
v_cvt_pk_bf16_f32 v172, v172, v173
v_cvt_pk_bf16_f32 v173, v174, v175
v_pk_mul_f32 v[176:177], v[176:177], v[84:85] op_sel:[0,1] op_sel_hi:[1,1]
v_pk_mul_f32 v[178:179], v[178:179], v[84:85] op_sel:[0,1] op_sel_hi:[1,1]
v_cvt_pk_bf16_f32 v174, v176, v177
v_cvt_pk_bf16_f32 v175, v178, v179
v_pk_mul_f32 v[196:197], v[196:197], v[86:87] op_sel:[0,1] op_sel_hi:[1,1]
v_pk_mul_f32 v[198:199], v[198:199], v[86:87] op_sel:[0,1] op_sel_hi:[1,1]
v_cvt_pk_bf16_f32 v196, v196, v197
v_cvt_pk_bf16_f32 v197, v198, v199
ds_write_b64 v232, v[172:173] offset:1024
buffer_store_dwordx4 a[248:251], v254, s[4:7], s97 offen offset:0 sc1
v_pk_mul_f32 v[200:201], v[200:201], v[86:87] op_sel:[0,1] op_sel_hi:[1,1]
v_pk_mul_f32 v[202:203], v[202:203], v[86:87] op_sel:[0,1] op_sel_hi:[1,1]
v_cvt_pk_bf16_f32 v198, v200, v201
v_cvt_pk_bf16_f32 v199, v202, v203
v_pk_mul_f32 v[220:221], v[220:221], v[88:89] op_sel:[0,1] op_sel_hi:[1,1]
v_pk_mul_f32 v[222:223], v[222:223], v[88:89] op_sel:[0,1] op_sel_hi:[1,1]
v_cvt_pk_bf16_f32 v220, v220, v221
v_cvt_pk_bf16_f32 v221, v222, v223
ds_write_b64 v232, v[174:175] offset:1536
v_pk_fma_f32 v[48:49], v[92:93], v[82:83], v[236:237] op_sel:[0,0,0] op_sel_hi:[1,0,0]
v_pk_fma_f32 v[50:51], v[94:95], v[82:83], v[236:237] op_sel:[0,0,0] op_sel_hi:[1,0,0]
v_pk_fma_f32 v[52:53], v[96:97], v[82:83], v[236:237] op_sel:[0,0,0] op_sel_hi:[1,0,0]
v_pk_fma_f32 v[54:55], v[98:99], v[82:83], v[236:237] op_sel:[0,0,0] op_sel_hi:[1,0,0]
v_exp_f32 v48, v48
v_exp_f32 v49, v49
v_exp_f32 v50, v50
v_exp_f32 v51, v51
ds_write_b64 v232, v[196:197] offset:2048
v_exp_f32 v52, v52
v_exp_f32 v53, v53
v_exp_f32 v54, v54
v_exp_f32 v55, v55
buffer_store_dwordx4 a[248:251], v1, s[4:7], s96 offen offset:0 sc1
ds_write_b64 v232, v[198:199] offset:2560
v_cvt_pk_bf16_f32 v140, v48, v49
v_cvt_pk_bf16_f32 v141, v50, v51
v_cvt_pk_bf16_f32 v142, v52, v53
v_cvt_pk_bf16_f32 v143, v54, v55
v_pk_mul_f32 v[224:225], v[224:225], v[88:89] op_sel:[0,1] op_sel_hi:[1,1]
v_pk_mul_f32 v[226:227], v[226:227], v[88:89] op_sel:[0,1] op_sel_hi:[1,1]
v_cvt_pk_bf16_f32 v222, v224, v225
v_mfma_f32_16x16x32_bf16 v[148:151], v[16:19], v[140:143], 0
v_cvt_pk_bf16_f32 v223, v226, v227
s_add_u32 m0, s19, 131072
s_add_u32 s44, s86, 0xc18000
ds_write_b64 v232, v[220:221] offset:3072
v_pk_fma_f32 v[92:93], v[92:93], v[82:83], v[236:237] op_sel:[0,0,1] op_sel_hi:[1,0,1] neg_lo:[1,0,0] neg_hi:[1,0,0]
v_pk_fma_f32 v[94:95], v[94:95], v[82:83], v[236:237] op_sel:[0,0,1] op_sel_hi:[1,0,1] neg_lo:[1,0,0] neg_hi:[1,0,0]
s_nop 1
v_rcp_f32 v148, v148
v_pk_fma_f32 v[96:97], v[96:97], v[82:83], v[236:237] op_sel:[0,0,1] op_sel_hi:[1,0,1] neg_lo:[1,0,0] neg_hi:[1,0,0]
v_pk_mul_f32 v[48:49], v[48:49], v[148:149] op_sel:[0,0] op_sel_hi:[1,0]
v_pk_mul_f32 v[50:51], v[50:51], v[148:149] op_sel:[0,0] op_sel_hi:[1,0]
v_cvt_pk_bf16_f32 v140, v48, v49
v_cvt_pk_bf16_f32 v141, v50, v51
v_pk_fma_f32 v[98:99], v[98:99], v[82:83], v[236:237] op_sel:[0,0,1] op_sel_hi:[1,0,1] neg_lo:[1,0,0] neg_hi:[1,0,0]
v_exp_f32 v92, v92
ds_write_b64 v232, v[222:223] offset:3584
v_exp_f32 v93, v93
v_exp_f32 v94, v94
v_exp_f32 v95, v95
v_exp_f32 v96, v96
v_exp_f32 v97, v97
v_exp_f32 v98, v98
ds_write_b64 v233, v[140:141] offset:16384
v_exp_f32 v99, v99
v_cvt_pk_bf16_f32 v144, v92, v93
v_cvt_pk_bf16_f32 v145, v94, v95
v_cvt_pk_bf16_f32 v146, v96, v97
v_cvt_pk_bf16_f32 v147, v98, v99
buffer_load_dwordx4 v1, s[4:7], s44 offen offset:0 sc1 lds
v_pk_mul_f32 v[52:53], v[52:53], v[148:149] op_sel:[0,0] op_sel_hi:[1,0]
v_cvt_pk_bf16_f32 v142, v52, v53
v_pk_mul_f32 v[54:55], v[54:55], v[148:149] op_sel:[0,0] op_sel_hi:[1,0]
v_cvt_pk_bf16_f32 v143, v54, v55
v_mfma_f32_16x16x32_bf16 v[152:155], v[16:19], v[144:147], 0
ds_write_b64 v233, v[142:143] offset:16896
v_mul_f32_e64 v240, -v240, v86
v_mul_f32_e64 v241, -v246, v86
v_pk_fma_f32 v[56:57], v[100:101], v[84:85], v[238:239] op_sel:[0,0,0] op_sel_hi:[1,0,0]
v_pk_fma_f32 v[58:59], v[102:103], v[84:85], v[238:239] op_sel:[0,0,0] op_sel_hi:[1,0,0]
v_pk_fma_f32 v[60:61], v[104:105], v[84:85], v[238:239] op_sel:[0,0,0] op_sel_hi:[1,0,0]
s_nop 1
v_rcp_f32 v152, v152
v_pk_fma_f32 v[62:63], v[106:107], v[84:85], v[238:239] op_sel:[0,0,0] op_sel_hi:[1,0,0]
v_pk_mul_f32 v[92:93], v[92:93], v[152:153] op_sel:[0,0] op_sel_hi:[1,0]
v_pk_mul_f32 v[94:95], v[94:95], v[152:153] op_sel:[0,0] op_sel_hi:[1,0]
v_cvt_pk_bf16_f32 v144, v92, v93
v_cvt_pk_bf16_f32 v145, v94, v95
ds_write_b64 v233, v[144:145] offset:17408
v_exp_f32 v56, v56
v_exp_f32 v57, v57
v_exp_f32 v58, v58
v_exp_f32 v59, v59
v_exp_f32 v60, v60
v_exp_f32 v61, v61
v_exp_f32 v62, v62
v_exp_f32 v63, v63
buffer_load_dwordx4 v1, s[4:7], s44 offen offset:1024 sc1 lds
v_cvt_pk_bf16_f32 v164, v56, v57
v_cvt_pk_bf16_f32 v165, v58, v59
v_cvt_pk_bf16_f32 v166, v60, v61
v_cvt_pk_bf16_f32 v167, v62, v63
v_pk_mul_f32 v[96:97], v[96:97], v[152:153] op_sel:[0,0] op_sel_hi:[1,0]
v_pk_mul_f32 v[98:99], v[98:99], v[152:153] op_sel:[0,0] op_sel_hi:[1,0]
v_cvt_pk_bf16_f32 v146, v96, v97
v_mfma_f32_16x16x32_bf16 v[172:175], v[16:19], v[164:167], 0
v_cvt_pk_bf16_f32 v147, v98, v99
ds_write_b64 v233, v[146:147] offset:17920
v_max3_f32 v242, v116, v117, v118
v_pk_fma_f32 v[100:101], v[100:101], v[84:85], v[238:239] op_sel:[0,0,1] op_sel_hi:[1,0,1] neg_lo:[1,0,0] neg_hi:[1,0,0]
v_pk_fma_f32 v[102:103], v[102:103], v[84:85], v[238:239] op_sel:[0,0,1] op_sel_hi:[1,0,1] neg_lo:[1,0,0] neg_hi:[1,0,0]
v_pk_fma_f32 v[104:105], v[104:105], v[84:85], v[238:239] op_sel:[0,0,1] op_sel_hi:[1,0,1] neg_lo:[1,0,0] neg_hi:[1,0,0]
s_nop 1
v_rcp_f32 v172, v172
v_pk_fma_f32 v[106:107], v[106:107], v[84:85], v[238:239] op_sel:[0,0,1] op_sel_hi:[1,0,1] neg_lo:[1,0,0] neg_hi:[1,0,0]
v_pk_mul_f32 v[56:57], v[56:57], v[172:173] op_sel:[0,0] op_sel_hi:[1,0]
v_pk_mul_f32 v[58:59], v[58:59], v[172:173] op_sel:[0,0] op_sel_hi:[1,0]
v_cvt_pk_bf16_f32 v164, v56, v57
v_cvt_pk_bf16_f32 v165, v58, v59
v_exp_f32 v100, v100
ds_write_b64 v233, v[164:165] offset:18432
v_exp_f32 v101, v101
v_exp_f32 v102, v102
v_exp_f32 v103, v103
v_exp_f32 v104, v104
v_exp_f32 v105, v105
v_exp_f32 v106, v106
v_exp_f32 v107, v107
buffer_load_dwordx4 v1, s[4:7], s44 offen offset:2048 sc1 lds
v_cvt_pk_bf16_f32 v168, v100, v101
v_cvt_pk_bf16_f32 v169, v102, v103
v_cvt_pk_bf16_f32 v170, v104, v105
v_cvt_pk_bf16_f32 v171, v106, v107
v_pk_mul_f32 v[60:61], v[60:61], v[172:173] op_sel:[0,0] op_sel_hi:[1,0]
v_pk_mul_f32 v[62:63], v[62:63], v[172:173] op_sel:[0,0] op_sel_hi:[1,0]
v_cvt_pk_bf16_f32 v166, v60, v61
v_mfma_f32_16x16x32_bf16 v[176:179], v[16:19], v[168:171], 0
v_cvt_pk_bf16_f32 v167, v62, v63
ds_write_b64 v233, v[166:167] offset:18944
v_max3_f32 v243, -v116, -v117, -v118
v_pk_fma_f32 v[64:65], v[108:109], v[86:87], v[240:241] op_sel:[0,0,0] op_sel_hi:[1,0,0]
v_pk_fma_f32 v[66:67], v[110:111], v[86:87], v[240:241] op_sel:[0,0,0] op_sel_hi:[1,0,0]
v_pk_fma_f32 v[68:69], v[112:113], v[86:87], v[240:241] op_sel:[0,0,0] op_sel_hi:[1,0,0]
s_nop 1
v_rcp_f32 v176, v176
v_pk_fma_f32 v[70:71], v[114:115], v[86:87], v[240:241] op_sel:[0,0,0] op_sel_hi:[1,0,0]
v_pk_mul_f32 v[100:101], v[100:101], v[176:177] op_sel:[0,0] op_sel_hi:[1,0]
v_pk_mul_f32 v[102:103], v[102:103], v[176:177] op_sel:[0,0] op_sel_hi:[1,0]
v_cvt_pk_bf16_f32 v168, v100, v101
v_cvt_pk_bf16_f32 v169, v102, v103
v_exp_f32 v64, v64
ds_write_b64 v233, v[168:169] offset:19456
buffer_load_dwordx4 v1, s[4:7], s44 offen offset:3072 sc1 lds
v_exp_f32 v65, v65
v_exp_f32 v66, v66
v_exp_f32 v67, v67
v_exp_f32 v68, v68
v_exp_f32 v69, v69
v_exp_f32 v70, v70
v_exp_f32 v71, v71
v_cvt_pk_bf16_f32 v188, v64, v65
v_cvt_pk_bf16_f32 v189, v66, v67
v_cvt_pk_bf16_f32 v190, v68, v69
v_cvt_pk_bf16_f32 v191, v70, v71
v_pk_mul_f32 v[104:105], v[104:105], v[176:177] op_sel:[0,0] op_sel_hi:[1,0]
v_pk_mul_f32 v[106:107], v[106:107], v[176:177] op_sel:[0,0] op_sel_hi:[1,0]
v_cvt_pk_bf16_f32 v170, v104, v105
v_mfma_f32_16x16x32_bf16 v[196:199], v[16:19], v[188:191], 0
v_cvt_pk_bf16_f32 v171, v106, v107
ds_write_b64 v233, v[170:171] offset:19968
buffer_store_dwordx4 a[248:251], v2, s[4:7], s72 offen offset:0 sc1
s_nop 4
v_rcp_f32 v196, v196
v_pk_fma_f32 v[108:109], v[108:109], v[86:87], v[240:241] op_sel:[0,0,1] op_sel_hi:[1,0,1] neg_lo:[1,0,0] neg_hi:[1,0,0]
v_pk_mul_f32 v[64:65], v[64:65], v[196:197] op_sel:[0,0] op_sel_hi:[1,0]
v_pk_mul_f32 v[66:67], v[66:67], v[196:197] op_sel:[0,0] op_sel_hi:[1,0]
v_cvt_pk_bf16_f32 v188, v64, v65
v_cvt_pk_bf16_f32 v189, v66, v67
v_pk_fma_f32 v[110:111], v[110:111], v[86:87], v[240:241] op_sel:[0,0,1] op_sel_hi:[1,0,1] neg_lo:[1,0,0] neg_hi:[1,0,0]
ds_write_b64 v233, v[188:189] offset:20480
v_pk_fma_f32 v[112:113], v[112:113], v[86:87], v[240:241] op_sel:[0,0,1] op_sel_hi:[1,0,1] neg_lo:[1,0,0] neg_hi:[1,0,0]
v_pk_fma_f32 v[114:115], v[114:115], v[86:87], v[240:241] op_sel:[0,0,1] op_sel_hi:[1,0,1] neg_lo:[1,0,0] neg_hi:[1,0,0]
v_exp_f32 v108, v108
v_exp_f32 v109, v109
v_exp_f32 v110, v110
v_exp_f32 v111, v111
v_exp_f32 v112, v112
v_exp_f32 v113, v113
v_exp_f32 v114, v114
v_exp_f32 v115, v115
v_max3_f32 v242, v242, v119, v120
v_max3_f32 v243, v243, -v119, -v120
v_max3_f32 v242, v242, v121, v122
v_max3_f32 v243, v243, -v121, -v122
v_max_f32 v242, v242, v123
v_max_f32_e64 v243, v243, -v123
v_cvt_pk_bf16_f32 v192, v108, v109
v_cvt_pk_bf16_f32 v193, v110, v111
v_cvt_pk_bf16_f32 v194, v112, v113
v_cvt_pk_bf16_f32 v195, v114, v115
v_pk_mul_f32 v[68:69], v[68:69], v[196:197] op_sel:[0,0] op_sel_hi:[1,0]
v_pk_mul_f32 v[70:71], v[70:71], v[196:197] op_sel:[0,0] op_sel_hi:[1,0]
v_permlane32_swap_b32 v242, v243
v_mfma_f32_16x16x32_bf16 v[200:203], v[16:19], v[192:195], 0
v_cvt_pk_bf16_f32 v190, v68, v69
v_cvt_pk_bf16_f32 v191, v70, v71
ds_write_b64 v233, v[190:191] offset:20992
v_max_f32 v242, v242, v243
v_mov_b32 v247, v242
buffer_store_dwordx4 a[248:251], v2, s[4:7], s72 offen offset:1024 sc1
s_nop 0
v_permlane16_swap_b32 v242, v247
v_rcp_f32 v200, v200
v_max_f32 v242, v242, v247
v_mov_b32 v247, v242
v_pk_mul_f32 v[108:109], v[108:109], v[200:201] op_sel:[0,0] op_sel_hi:[1,0]
v_pk_mul_f32 v[110:111], v[110:111], v[200:201] op_sel:[0,0] op_sel_hi:[1,0]
v_cvt_pk_bf16_f32 v192, v108, v109
v_cvt_pk_bf16_f32 v193, v110, v111
v_permlane32_swap_b32 v242, v247
ds_write_b64 v233, v[192:193] offset:21504
v_mul_f32_e64 v242, -v242, v88
v_mul_f32_e64 v243, -v247, v88
v_pk_fma_f32 v[124:125], v[116:117], v[88:89], v[242:243] op_sel:[0,0,0] op_sel_hi:[1,0,0]
v_pk_fma_f32 v[126:127], v[118:119], v[88:89], v[242:243] op_sel:[0,0,0] op_sel_hi:[1,0,0]
v_pk_fma_f32 v[128:129], v[120:121], v[88:89], v[242:243] op_sel:[0,0,0] op_sel_hi:[1,0,0]
v_pk_fma_f32 v[130:131], v[122:123], v[88:89], v[242:243] op_sel:[0,0,0] op_sel_hi:[1,0,0]
v_exp_f32 v124, v124
v_exp_f32 v125, v125
v_exp_f32 v126, v126
v_exp_f32 v127, v127
v_exp_f32 v128, v128
v_exp_f32 v129, v129
v_exp_f32 v130, v130
v_exp_f32 v131, v131
v_cvt_pk_bf16_f32 v212, v124, v125
v_cvt_pk_bf16_f32 v213, v126, v127
v_cvt_pk_bf16_f32 v214, v128, v129
v_cvt_pk_bf16_f32 v215, v130, v131
v_pk_mul_f32 v[112:113], v[112:113], v[200:201] op_sel:[0,0] op_sel_hi:[1,0]
v_pk_mul_f32 v[114:115], v[114:115], v[200:201] op_sel:[0,0] op_sel_hi:[1,0]
v_cvt_pk_bf16_f32 v194, v112, v113
v_mfma_f32_16x16x32_bf16 v[220:223], v[16:19], v[212:215], 0
v_cvt_pk_bf16_f32 v195, v114, v115
ds_write_b64 v233, v[194:195] offset:22016
buffer_store_dwordx4 a[248:251], v2, s[4:7], s72 offen offset:2048 sc1
s_nop 4
v_rcp_f32 v220, v220
v_pk_fma_f32 v[116:117], v[116:117], v[88:89], v[242:243] op_sel:[0,0,1] op_sel_hi:[1,0,1] neg_lo:[1,0,0] neg_hi:[1,0,0]
v_pk_mul_f32 v[124:125], v[124:125], v[220:221] op_sel:[0,0] op_sel_hi:[1,0]
v_pk_mul_f32 v[126:127], v[126:127], v[220:221] op_sel:[0,0] op_sel_hi:[1,0]
v_cvt_pk_bf16_f32 v212, v124, v125
v_cvt_pk_bf16_f32 v213, v126, v127
v_pk_fma_f32 v[118:119], v[118:119], v[88:89], v[242:243] op_sel:[0,0,1] op_sel_hi:[1,0,1] neg_lo:[1,0,0] neg_hi:[1,0,0]
ds_write_b64 v233, v[212:213] offset:22528
v_pk_fma_f32 v[120:121], v[120:121], v[88:89], v[242:243] op_sel:[0,0,1] op_sel_hi:[1,0,1] neg_lo:[1,0,0] neg_hi:[1,0,0]
v_pk_fma_f32 v[122:123], v[122:123], v[88:89], v[242:243] op_sel:[0,0,1] op_sel_hi:[1,0,1] neg_lo:[1,0,0] neg_hi:[1,0,0]
v_exp_f32 v116, v116
v_exp_f32 v117, v117
v_exp_f32 v118, v118
v_exp_f32 v119, v119
v_exp_f32 v120, v120
v_exp_f32 v121, v121
v_exp_f32 v122, v122
v_exp_f32 v123, v123
v_cvt_pk_bf16_f32 v216, v116, v117
v_cvt_pk_bf16_f32 v217, v118, v119
v_cvt_pk_bf16_f32 v218, v120, v121
v_cvt_pk_bf16_f32 v219, v122, v123
v_pk_mul_f32 v[128:129], v[128:129], v[220:221] op_sel:[0,0] op_sel_hi:[1,0]
v_pk_mul_f32 v[130:131], v[130:131], v[220:221] op_sel:[0,0] op_sel_hi:[1,0]
v_cvt_pk_bf16_f32 v214, v128, v129
v_mfma_f32_16x16x32_bf16 v[224:227], v[16:19], v[216:219], 0
v_cvt_pk_bf16_f32 v215, v130, v131
ds_write_b64 v233, v[214:215] offset:23040
buffer_store_dwordx4 a[248:251], v2, s[4:7], s72 offen offset:3072 sc1
s_nop 4
v_rcp_f32 v224, v224
s_nop 0
v_pk_mul_f32 v[116:117], v[116:117], v[224:225] op_sel:[0,0] op_sel_hi:[1,0]
v_pk_mul_f32 v[118:119], v[118:119], v[224:225] op_sel:[0,0] op_sel_hi:[1,0]
v_cvt_pk_bf16_f32 v216, v116, v117
v_cvt_pk_bf16_f32 v217, v118, v119
v_pk_mul_f32 v[120:121], v[120:121], v[224:225] op_sel:[0,0] op_sel_hi:[1,0]
ds_write_b64 v233, v[216:217] offset:23552
v_pk_mul_f32 v[122:123], v[122:123], v[224:225] op_sel:[0,0] op_sel_hi:[1,0]
v_cvt_pk_bf16_f32 v218, v120, v121
v_cvt_pk_bf16_f32 v219, v122, v123
ds_write_b64 v233, v[218:219] offset:24064
s_waitcnt vmcnt(8)
s_waitcnt lgkmcnt(0)
s_barrier
ds_read_b64_tr_b16 a[0:1], v234 offset:16384
ds_read_b64_tr_b16 a[2:3], v234 offset:18432
ds_read_b64_tr_b16 a[12:13], v234 offset:20480
ds_read_b64_tr_b16 a[14:15], v234 offset:22528
ds_read_b64_tr_b16 a[24:25], v234 offset:24576
ds_read_b64_tr_b16 a[26:27], v234 offset:26624
ds_read_b64_tr_b16 a[4:5], v8 offset:0
ds_read_b64_tr_b16 a[6:7], v8 offset:1024
ds_read_b64_tr_b16 a[8:9], v8 offset:512
ds_read_b64_tr_b16 a[10:11], v8 offset:1536
ds_read_b64_tr_b16 a[36:37], v234 offset:28672
ds_read_b64_tr_b16 a[38:39], v234 offset:30720
ds_read_b64_tr_b16 a[16:17], v8 offset:2048
ds_read_b64_tr_b16 a[18:19], v8 offset:3072
ds_read_b64_tr_b16 a[20:21], v8 offset:2560
ds_read_b64_tr_b16 a[22:23], v8 offset:3584
ds_read_b64_tr_b16 a[48:49], v234 offset:32768
ds_read_b64_tr_b16 a[50:51], v234 offset:34816
ds_read_b64_tr_b16 a[28:29], v8 offset:4096
ds_read_b64_tr_b16 a[30:31], v8 offset:5120
ds_read_b64_tr_b16 a[32:33], v8 offset:4608
ds_read_b64_tr_b16 a[34:35], v8 offset:5632
ds_read_b64_tr_b16 a[60:61], v234 offset:36864
ds_read_b64_tr_b16 a[62:63], v234 offset:38912
s_waitcnt lgkmcnt(14)
v_mfma_f32_16x16x32_bf16 v[100:103], a[0:3], v[16:19], 0
ds_read_b64_tr_b16 a[40:41], v8 offset:6144
ds_read_b64_tr_b16 a[42:43], v8 offset:7168
ds_read_b64_tr_b16 a[44:45], v8 offset:6656
ds_read_b64_tr_b16 a[46:47], v8 offset:7680
ds_read_b64_tr_b16 a[72:73], v234 offset:40960
ds_read_b64_tr_b16 a[74:75], v234 offset:43008
v_mfma_f32_16x16x32_bf16 v[100:103], a[12:15], v[16:19], v[100:103]
buffer_atomic_add v12, v235, s[4:7], s94 offen sc1
ds_read_b64_tr_b16 a[52:53], v8 offset:8192
ds_read_b64_tr_b16 a[54:55], v8 offset:9216
ds_read_b64_tr_b16 a[56:57], v8 offset:8704
ds_read_b64_tr_b16 a[58:59], v8 offset:9728
ds_read_b64_tr_b16 a[84:85], v234 offset:45056
ds_read_b64_tr_b16 a[86:87], v234 offset:47104
v_mfma_f32_16x16x32_bf16 v[100:103], a[24:27], v[16:19], v[100:103]
ds_read_b64_tr_b16 a[64:65], v8 offset:10240
ds_read_b64_tr_b16 a[66:67], v8 offset:11264
v_mfma_f32_16x16x32_bf16 v[92:95], a[0:3], a[4:7], 0
ds_read_b64_tr_b16 a[68:69], v8 offset:10752
ds_read_b64_tr_b16 a[70:71], v8 offset:11776
v_mfma_f32_16x16x32_bf16 v[96:99], a[0:3], a[8:11], 0
ds_read_b64_tr_b16 a[76:77], v8 offset:12288
s_waitcnt lgkmcnt(14)
v_mfma_f32_16x16x32_bf16 v[100:103], a[36:39], v[16:19], v[100:103]
ds_read_b64_tr_b16 a[78:79], v8 offset:13312
v_mfma_f32_16x16x32_bf16 v[92:95], a[12:15], a[16:19], v[92:95]
ds_read_b64_tr_b16 a[80:81], v8 offset:12800
ds_read_b64_tr_b16 a[82:83], v8 offset:13824
v_mfma_f32_16x16x32_bf16 v[96:99], a[12:15], a[20:23], v[96:99]
ds_read_b64_tr_b16 a[88:89], v8 offset:14336
v_mfma_f32_16x16x32_bf16 v[100:103], a[48:51], v[16:19], v[100:103]
ds_read_b64_tr_b16 a[90:91], v8 offset:15360
v_mfma_f32_16x16x32_bf16 v[92:95], a[24:27], a[28:31], v[92:95]
ds_read_b64_tr_b16 a[92:93], v8 offset:14848
ds_read_b64_tr_b16 a[94:95], v8 offset:15872
v_mfma_f32_16x16x32_bf16 v[96:99], a[24:27], a[32:35], v[96:99]
v_cvt_pk_bf16_f32 v132, v132, v133
v_cvt_pk_bf16_f32 v156, v156, v157
v_mfma_f32_16x16x32_bf16 v[100:103], a[60:63], v[16:19], v[100:103]
v_cvt_pk_bf16_f32 v180, v180, v181
v_cvt_pk_bf16_f32 v204, v204, v205
v_mfma_f32_16x16x32_bf16 v[92:95], a[36:39], a[40:43], v[92:95]
v_cvt_pk_bf16_f32 v133, v134, v135
v_cvt_pk_bf16_f32 v157, v158, v159
s_waitcnt lgkmcnt(14)
v_mfma_f32_16x16x32_bf16 v[96:99], a[36:39], a[44:47], v[96:99]
v_cvt_pk_bf16_f32 v181, v182, v183
v_cvt_pk_bf16_f32 v205, v206, v207
v_mfma_f32_16x16x32_bf16 v[100:103], a[72:75], v[16:19], v[100:103]
v_cvt_pk_bf16_f32 v134, v136, v137
v_cvt_pk_bf16_f32 v135, v138, v139
v_mfma_f32_16x16x32_bf16 v[92:95], a[48:51], a[52:55], v[92:95]
v_cvt_pk_bf16_f32 v158, v160, v161
v_cvt_pk_bf16_f32 v159, v162, v163
v_mfma_f32_16x16x32_bf16 v[96:99], a[48:51], a[56:59], v[96:99]
v_cvt_pk_bf16_f32 v182, v184, v185
v_cvt_pk_bf16_f32 v183, v186, v187
s_waitcnt lgkmcnt(12)
v_mfma_f32_16x16x32_bf16 v[100:103], a[84:87], v[16:19], v[100:103]
v_cvt_pk_bf16_f32 v206, v208, v209
v_cvt_pk_bf16_f32 v207, v210, v211
s_waitcnt lgkmcnt(10)
v_mfma_f32_16x16x32_bf16 v[92:95], a[60:63], a[64:67], v[92:95]
s_waitcnt lgkmcnt(8)
v_mfma_f32_16x16x32_bf16 v[96:99], a[60:63], a[68:71], v[96:99]
s_nop 1
v_min_u32 v100, -2, v100
v_min_u32 v101, -2, v101
s_waitcnt lgkmcnt(6)
v_mfma_f32_16x16x32_bf16 v[92:95], a[72:75], a[76:79], v[92:95]
v_min_u32 v102, -2, v102
v_min_u32 v103, -2, v103
s_waitcnt lgkmcnt(4)
v_mfma_f32_16x16x32_bf16 v[96:99], a[72:75], a[80:83], v[96:99]
buffer_store_dwordx4 v[100:103], v254, s[4:7], s97 offen sc1
s_waitcnt lgkmcnt(2)
v_mfma_f32_16x16x32_bf16 v[92:95], a[84:87], a[88:91], v[92:95]
s_waitcnt lgkmcnt(0)
v_mfma_f32_16x16x32_bf16 v[96:99], a[84:87], a[92:95], v[96:99]
s_nop 5
v_cvt_pk_bf16_f32 v92, v92, v93
v_cvt_pk_bf16_f32 v93, v94, v95
v_min_u32 v92, -2, v92
v_min_u32 v93, -2, v93
v_cvt_pk_bf16_f32 v94, v96, v97
v_cvt_pk_bf16_f32 v95, v98, v99
v_min_u32 v94, -2, v94
v_min_u32 v95, -2, v95
buffer_store_dwordx4 v[92:95], v1, s[4:7], s96 offen sc1
s_barrier
s_add_u32 m0, s19, 32768
s_add_u32 s44, s84, 0xc00000
buffer_load_dwordx4 v1, s[4:7], s44 offen offset:0 sc1 lds
v_mfma_f32_16x16x32_bf16 v[108:111], a[240:243], v[132:135], 0
v_mfma_f32_16x16x32_bf16 v[172:175], a[240:243], v[156:159], 0
v_mfma_f32_16x16x32_bf16 v[112:115], a[244:247], v[132:135], 0
s_nop 5
v_max3_f32 v236, v108, v109, v110
v_max3_f32 v237, -v108, -v109, -v110
v_mfma_f32_16x16x32_bf16 v[176:179], a[244:247], v[156:159], 0
v_max3_f32 v238, v172, v173, v174
v_max3_f32 v239, -v172, -v173, -v174
v_max3_f32 v236, v236, v111, v112
v_max3_f32 v237, v237, -v111, -v112
v_max3_f32 v236, v236, v113, v114
v_max3_f32 v237, v237, -v113, -v114
s_nop 1
v_max3_f32 v238, v238, v175, v176
v_max3_f32 v239, v239, -v175, -v176
v_max3_f32 v238, v238, v177, v178
v_max3_f32 v239, v239, -v177, -v178
v_max_f32 v236, v236, v115
buffer_load_dwordx4 v1, s[4:7], s44 offen offset:1024 sc1 lds
v_max_f32_e64 v237, v237, -v115
v_max_f32 v238, v238, v179
v_max_f32_e64 v239, v239, -v179
v_permlane32_swap_b32 v236, v237
s_nop 0
v_permlane32_swap_b32 v238, v239
v_mov_b32 v11, 0
buffer_atomic_add v11, v251, s[4:7], s89 offen sc0 sc1
v_max_f32 v236, v236, v237
v_max_f32 v238, v238, v239
v_mov_b32 v244, v236
v_mov_b32 v245, v238
s_nop 0
v_permlane16_swap_b32 v236, v244
v_permlane16_swap_b32 v238, v245
v_max_f32 v236, v236, v244
v_max_f32 v238, v238, v245
v_mov_b32 v244, v236
v_mov_b32 v245, v238
s_nop 0
v_permlane32_swap_b32 v236, v244
v_permlane32_swap_b32 v238, v245
v_mul_f32_e64 v236, -v236, v82
v_mul_f32_e64 v237, -v244, v82
buffer_load_dwordx4 v1, s[4:7], s44 offen offset:2048 sc1 lds
v_mul_f32_e64 v238, -v238, v84
v_mul_f32_e64 v239, -v245, v84
v_pk_fma_f32 v[116:117], v[108:109], v[82:83], v[236:237] op_sel:[0,0,0] op_sel_hi:[1,0,0]
v_pk_fma_f32 v[118:119], v[110:111], v[82:83], v[236:237] op_sel:[0,0,0] op_sel_hi:[1,0,0]
v_pk_fma_f32 v[120:121], v[112:113], v[82:83], v[236:237] op_sel:[0,0,0] op_sel_hi:[1,0,0]
v_pk_fma_f32 v[122:123], v[114:115], v[82:83], v[236:237] op_sel:[0,0,0] op_sel_hi:[1,0,0]
v_pk_fma_f32 v[148:149], v[172:173], v[84:85], v[238:239] op_sel:[0,0,0] op_sel_hi:[1,0,0]
v_pk_fma_f32 v[150:151], v[174:175], v[84:85], v[238:239] op_sel:[0,0,0] op_sel_hi:[1,0,0]
v_pk_fma_f32 v[152:153], v[176:177], v[84:85], v[238:239] op_sel:[0,0,0] op_sel_hi:[1,0,0]
v_pk_fma_f32 v[154:155], v[178:179], v[84:85], v[238:239] op_sel:[0,0,0] op_sel_hi:[1,0,0]
v_pk_fma_f32 v[108:109], v[108:109], v[82:83], v[236:237] op_sel:[0,0,1] op_sel_hi:[1,0,1] neg_lo:[1,0,0] neg_hi:[1,0,0]
v_pk_fma_f32 v[110:111], v[110:111], v[82:83], v[236:237] op_sel:[0,0,1] op_sel_hi:[1,0,1] neg_lo:[1,0,0] neg_hi:[1,0,0]
v_pk_fma_f32 v[112:113], v[112:113], v[82:83], v[236:237] op_sel:[0,0,1] op_sel_hi:[1,0,1] neg_lo:[1,0,0] neg_hi:[1,0,0]
v_pk_fma_f32 v[114:115], v[114:115], v[82:83], v[236:237] op_sel:[0,0,1] op_sel_hi:[1,0,1] neg_lo:[1,0,0] neg_hi:[1,0,0]
v_pk_fma_f32 v[172:173], v[172:173], v[84:85], v[238:239] op_sel:[0,0,1] op_sel_hi:[1,0,1] neg_lo:[1,0,0] neg_hi:[1,0,0]
v_pk_fma_f32 v[174:175], v[174:175], v[84:85], v[238:239] op_sel:[0,0,1] op_sel_hi:[1,0,1] neg_lo:[1,0,0] neg_hi:[1,0,0]
v_pk_fma_f32 v[176:177], v[176:177], v[84:85], v[238:239] op_sel:[0,0,1] op_sel_hi:[1,0,1] neg_lo:[1,0,0] neg_hi:[1,0,0]
v_pk_fma_f32 v[178:179], v[178:179], v[84:85], v[238:239] op_sel:[0,0,1] op_sel_hi:[1,0,1] neg_lo:[1,0,0] neg_hi:[1,0,0]
v_exp_f32 v116, v116
v_exp_f32 v108, v108
v_exp_f32 v117, v117
v_exp_f32 v109, v109
v_exp_f32 v118, v118
v_exp_f32 v110, v110
v_exp_f32 v119, v119
v_exp_f32 v111, v111
v_exp_f32 v120, v120
v_exp_f32 v112, v112
v_exp_f32 v121, v121
v_exp_f32 v113, v113
v_exp_f32 v122, v122
v_exp_f32 v114, v114
v_exp_f32 v123, v123
v_exp_f32 v115, v115
v_exp_f32 v148, v148
v_exp_f32 v172, v172
v_exp_f32 v149, v149
L_stub18:
s_cbranch_execz L_wret6
v_exp_f32 v173, v173
v_exp_f32 v150, v150
v_exp_f32 v174, v174
v_exp_f32 v151, v151
v_exp_f32 v175, v175
v_exp_f32 v152, v152
v_exp_f32 v176, v176
v_exp_f32 v153, v153
v_exp_f32 v177, v177
v_exp_f32 v154, v154
v_exp_f32 v178, v178
v_exp_f32 v155, v155
v_exp_f32 v179, v179
buffer_load_dwordx4 v1, s[4:7], s44 offen offset:3072 sc1 lds
v_cvt_pk_bf16_f32 v140, v116, v117
v_cvt_pk_bf16_f32 v141, v118, v119
v_cvt_pk_bf16_f32 v142, v120, v121
v_cvt_pk_bf16_f32 v143, v122, v123
v_cvt_pk_bf16_f32 v144, v108, v109
v_cvt_pk_bf16_f32 v145, v110, v111
v_cvt_pk_bf16_f32 v146, v112, v113
v_cvt_pk_bf16_f32 v147, v114, v115
v_cvt_pk_bf16_f32 v164, v148, v149
v_cvt_pk_bf16_f32 v165, v150, v151
v_cvt_pk_bf16_f32 v166, v152, v153
v_cvt_pk_bf16_f32 v167, v154, v155
v_cvt_pk_bf16_f32 v168, v172, v173
v_cvt_pk_bf16_f32 v169, v174, v175
v_cvt_pk_bf16_f32 v170, v176, v177
v_cvt_pk_bf16_f32 v171, v178, v179
s_waitcnt vmcnt(2)
v_readfirstlane_b32 s38, v11
s_nop 0
s_cmp_ge_u32 s38, 8
s_cbranch_scc1 Lpe_43
s_add_u32 s36, s88, 0x90000
s_mov_b32 s37, 0
Lpoll_42:
v_mov_b32 v11, 0
buffer_atomic_add v11, v251, s[4:7], s36 offen sc0 sc1
s_add_u32 s37, s37, 1
s_waitcnt vmcnt(0)
v_readfirstlane_b32 s38, v11
s_nop 0
s_cmp_ge_u32 s38, 8
s_cbranch_scc1 Lpe_43
s_cmp_lt_u32 s37, 0x100000
s_cbranch_scc1 Lpoll_42
Lpe_43:
buffer_load_dwordx4 v[48:51], v1, s[4:7], s98 offen offset:0 sc1
v_mfma_f32_16x16x32_bf16 v[108:111], a[240:243], v[180:183], 0
v_mfma_f32_16x16x32_bf16 v[220:223], a[240:243], v[204:207], 0
v_mfma_f32_16x16x32_bf16 v[112:115], a[244:247], v[180:183], 0
s_nop 5
v_max3_f32 v240, v108, v109, v110
v_max3_f32 v241, -v108, -v109, -v110
v_mfma_f32_16x16x32_bf16 v[224:227], a[244:247], v[204:207], 0
buffer_load_dwordx4 v[124:127], v248, s[4:7], s100 offen sc1
v_max3_f32 v242, v220, v221, v222
v_max3_f32 v243, -v220, -v221, -v222
v_max3_f32 v240, v240, v111, v112
v_max3_f32 v241, v241, -v111, -v112
v_max3_f32 v240, v240, v113, v114
s_nop 1
v_max3_f32 v242, v242, v223, v224
v_max3_f32 v243, v243, -v223, -v224
v_max3_f32 v241, v241, -v113, -v114
v_max3_f32 v242, v242, v225, v226
v_max3_f32 v243, v243, -v225, -v226
v_max_f32 v240, v240, v115
v_max_f32_e64 v241, v241, -v115
v_max_f32 v242, v242, v227
buffer_load_dwordx4 v[52:55], v1, s[4:7], s98 offen offset:1024 sc1
v_max_f32_e64 v243, v243, -v227
v_permlane32_swap_b32 v240, v241
s_nop 0
v_permlane32_swap_b32 v242, v243
v_max_f32 v240, v240, v241
v_max_f32 v242, v242, v243
v_mov_b32 v246, v240
v_mov_b32 v247, v242
s_nop 0
v_permlane16_swap_b32 v240, v246
v_permlane16_swap_b32 v242, v247
buffer_load_dwordx4 v[56:59], v1, s[4:7], s98 offen offset:2048 sc1
v_max_f32 v240, v240, v246
v_max_f32 v242, v242, v247
v_mov_b32 v246, v240
v_mov_b32 v247, v242
s_nop 0
v_permlane32_swap_b32 v240, v246
v_permlane32_swap_b32 v242, v247
v_mul_f32_e64 v240, -v240, v86
v_mul_f32_e64 v241, -v246, v86
v_mul_f32_e64 v242, -v242, v88
v_mul_f32_e64 v243, -v247, v88
buffer_load_dwordx4 v[60:63], v1, s[4:7], s98 offen offset:3072 sc1
v_pk_fma_f32 v[116:117], v[108:109], v[86:87], v[240:241] op_sel:[0,0,0] op_sel_hi:[1,0,0]
v_pk_fma_f32 v[118:119], v[110:111], v[86:87], v[240:241] op_sel:[0,0,0] op_sel_hi:[1,0,0]
v_pk_fma_f32 v[120:121], v[112:113], v[86:87], v[240:241] op_sel:[0,0,0] op_sel_hi:[1,0,0]
v_pk_fma_f32 v[122:123], v[114:115], v[86:87], v[240:241] op_sel:[0,0,0] op_sel_hi:[1,0,0]
v_pk_fma_f32 v[196:197], v[220:221], v[88:89], v[242:243] op_sel:[0,0,0] op_sel_hi:[1,0,0]
v_pk_fma_f32 v[198:199], v[222:223], v[88:89], v[242:243] op_sel:[0,0,0] op_sel_hi:[1,0,0]
v_pk_fma_f32 v[200:201], v[224:225], v[88:89], v[242:243] op_sel:[0,0,0] op_sel_hi:[1,0,0]
v_pk_fma_f32 v[202:203], v[226:227], v[88:89], v[242:243] op_sel:[0,0,0] op_sel_hi:[1,0,0]
v_pk_fma_f32 v[108:109], v[108:109], v[86:87], v[240:241] op_sel:[0,0,1] op_sel_hi:[1,0,1] neg_lo:[1,0,0] neg_hi:[1,0,0]
v_pk_fma_f32 v[110:111], v[110:111], v[86:87], v[240:241] op_sel:[0,0,1] op_sel_hi:[1,0,1] neg_lo:[1,0,0] neg_hi:[1,0,0]
v_pk_fma_f32 v[112:113], v[112:113], v[86:87], v[240:241] op_sel:[0,0,1] op_sel_hi:[1,0,1] neg_lo:[1,0,0] neg_hi:[1,0,0]
v_pk_fma_f32 v[114:115], v[114:115], v[86:87], v[240:241] op_sel:[0,0,1] op_sel_hi:[1,0,1] neg_lo:[1,0,0] neg_hi:[1,0,0]
v_pk_fma_f32 v[220:221], v[220:221], v[88:89], v[242:243] op_sel:[0,0,1] op_sel_hi:[1,0,1] neg_lo:[1,0,0] neg_hi:[1,0,0]
buffer_load_dwordx4 v[64:67], v1, s[4:7], s99 offen offset:0 sc1
v_pk_fma_f32 v[222:223], v[222:223], v[88:89], v[242:243] op_sel:[0,0,1] op_sel_hi:[1,0,1] neg_lo:[1,0,0] neg_hi:[1,0,0]
v_pk_fma_f32 v[224:225], v[224:225], v[88:89], v[242:243] op_sel:[0,0,1] op_sel_hi:[1,0,1] neg_lo:[1,0,0] neg_hi:[1,0,0]
v_pk_fma_f32 v[226:227], v[226:227], v[88:89], v[242:243] op_sel:[0,0,1] op_sel_hi:[1,0,1] neg_lo:[1,0,0] neg_hi:[1,0,0]
v_exp_f32 v116, v116
v_exp_f32 v108, v108
v_exp_f32 v117, v117
v_exp_f32 v109, v109
v_exp_f32 v118, v118
buffer_load_dwordx4 v[68:71], v1, s[4:7], s99 offen offset:1024 sc1
v_exp_f32 v110, v110
v_exp_f32 v119, v119
v_exp_f32 v111, v111
v_exp_f32 v120, v120
v_exp_f32 v112, v112
v_exp_f32 v121, v121
v_exp_f32 v113, v113
buffer_load_dwordx4 v[100:103], v1, s[4:7], s99 offen offset:2048 sc1
v_exp_f32 v122, v122
v_exp_f32 v114, v114
v_exp_f32 v123, v123
v_exp_f32 v115, v115
v_exp_f32 v196, v196
v_exp_f32 v220, v220
v_exp_f32 v197, v197
buffer_load_dwordx4 v[104:107], v1, s[4:7], s99 offen offset:3072 sc1
v_exp_f32 v221, v221
v_exp_f32 v198, v198
v_exp_f32 v222, v222
v_exp_f32 v199, v199
v_exp_f32 v223, v223
v_exp_f32 v200, v200
v_exp_f32 v224, v224
v_exp_f32 v201, v201
v_exp_f32 v225, v225
v_exp_f32 v202, v202
v_exp_f32 v226, v226
v_exp_f32 v203, v203
v_exp_f32 v227, v227
v_cvt_pk_bf16_f32 v188, v116, v117
v_cvt_pk_bf16_f32 v189, v118, v119
v_cvt_pk_bf16_f32 v190, v120, v121
v_cvt_pk_bf16_f32 v191, v122, v123
v_cvt_pk_bf16_f32 v192, v108, v109
v_cvt_pk_bf16_f32 v193, v110, v111
v_cvt_pk_bf16_f32 v194, v112, v113
v_cvt_pk_bf16_f32 v195, v114, v115
v_cvt_pk_bf16_f32 v212, v196, v197
v_cvt_pk_bf16_f32 v213, v198, v199
v_cvt_pk_bf16_f32 v214, v200, v201
v_cvt_pk_bf16_f32 v215, v202, v203
v_cvt_pk_bf16_f32 v216, v220, v221
v_cvt_pk_bf16_f32 v217, v222, v223
v_cvt_pk_bf16_f32 v218, v224, v225
v_cvt_pk_bf16_f32 v219, v226, v227
s_waitcnt vmcnt(8)
v_lshlrev_b32 v92, 16, v48
v_and_b32 v93, 0xffff0000, v48
v_lshlrev_b32 v94, 16, v49
v_and_b32 v95, 0xffff0000, v49
v_lshlrev_b32 v96, 16, v50
v_and_b32 v97, 0xffff0000, v50
v_lshlrev_b32 v98, 16, v51
v_and_b32 v99, 0xffff0000, v51
s_waitcnt vmcnt(7)
v_add_f32_dpp v128, v124, v124 row_ror:4 row_mask:0xf bank_mask:0xf
v_add_f32_dpp v129, v125, v125 row_ror:4 row_mask:0xf bank_mask:0xf
v_add_f32_dpp v130, v126, v126 row_ror:4 row_mask:0xf bank_mask:0xf
v_add_f32_dpp v131, v127, v127 row_ror:4 row_mask:0xf bank_mask:0xf
v_add_f32_dpp v128, v128, v128 row_ror:2 row_mask:0xf bank_mask:0xf
v_add_f32_dpp v129, v129, v129 row_ror:2 row_mask:0xf bank_mask:0xf
v_add_f32_dpp v130, v130, v130 row_ror:2 row_mask:0xf bank_mask:0xf
v_add_f32_dpp v131, v131, v131 row_ror:2 row_mask:0xf bank_mask:0xf
v_add_f32_dpp v128, v128, v128 row_ror:1 row_mask:0xf bank_mask:0xf
v_add_f32_dpp v129, v129, v129 row_ror:1 row_mask:0xf bank_mask:0xf
v_add_f32_dpp v130, v130, v130 row_ror:1 row_mask:0xf bank_mask:0xf
v_add_f32_dpp v131, v131, v131 row_ror:1 row_mask:0xf bank_mask:0xf
v_fma_f32 v135, v129, v130, v131
s_waitcnt vmcnt(6)
v_dot2c_f32_bf16 v92, v52, v249
v_dot2c_f32_bf16 v93, v52, v250
v_dot2c_f32_bf16 v94, v53, v249
v_dot2c_f32_bf16 v95, v53, v250
v_dot2c_f32_bf16 v96, v54, v249
v_dot2c_f32_bf16 v97, v54, v250
v_dot2c_f32_bf16 v98, v55, v249
v_dot2c_f32_bf16 v99, v55, v250
s_waitcnt vmcnt(5)
v_dot2c_f32_bf16 v92, v56, v249
v_dot2c_f32_bf16 v93, v56, v250
v_dot2c_f32_bf16 v94, v57, v249
v_dot2c_f32_bf16 v95, v57, v250
v_dot2c_f32_bf16 v96, v58, v249
v_dot2c_f32_bf16 v97, v58, v250
v_dot2c_f32_bf16 v98, v59, v249
v_dot2c_f32_bf16 v99, v59, v250
s_waitcnt vmcnt(4)
v_dot2c_f32_bf16 v92, v60, v249
v_dot2c_f32_bf16 v93, v60, v250
v_dot2c_f32_bf16 v94, v61, v249
v_dot2c_f32_bf16 v95, v61, v250
v_dot2c_f32_bf16 v96, v62, v249
v_dot2c_f32_bf16 v97, v62, v250
v_dot2c_f32_bf16 v98, v63, v249
v_dot2c_f32_bf16 v99, v63, v250
s_waitcnt vmcnt(3)
v_dot2c_f32_bf16 v92, v64, v249
v_dot2c_f32_bf16 v93, v64, v250
v_dot2c_f32_bf16 v94, v65, v249
v_dot2c_f32_bf16 v95, v65, v250
v_dot2c_f32_bf16 v96, v66, v249
v_dot2c_f32_bf16 v97, v66, v250
v_dot2c_f32_bf16 v98, v67, v249
v_dot2c_f32_bf16 v99, v67, v250
s_waitcnt vmcnt(2)
v_dot2c_f32_bf16 v92, v68, v249
v_dot2c_f32_bf16 v93, v68, v250
v_dot2c_f32_bf16 v94, v69, v249
v_dot2c_f32_bf16 v95, v69, v250
v_dot2c_f32_bf16 v96, v70, v249
v_dot2c_f32_bf16 v97, v70, v250
v_dot2c_f32_bf16 v98, v71, v249
v_dot2c_f32_bf16 v99, v71, v250
s_waitcnt vmcnt(1)
v_dot2c_f32_bf16 v92, v100, v249
v_dot2c_f32_bf16 v93, v100, v250
v_dot2c_f32_bf16 v94, v101, v249
v_dot2c_f32_bf16 v95, v101, v250
v_dot2c_f32_bf16 v96, v102, v249
v_dot2c_f32_bf16 v97, v102, v250
v_dot2c_f32_bf16 v98, v103, v249
v_dot2c_f32_bf16 v99, v103, v250
s_waitcnt vmcnt(0)
v_dot2c_f32_bf16 v92, v104, v249
v_dot2c_f32_bf16 v93, v104, v250
v_dot2c_f32_bf16 v94, v105, v249
v_dot2c_f32_bf16 v95, v105, v250
v_dot2c_f32_bf16 v96, v106, v249
v_dot2c_f32_bf16 v97, v106, v250
v_dot2c_f32_bf16 v98, v107, v249
v_dot2c_f32_bf16 v99, v107, v250
v_fma_f32 v132, v92, v93, v94
v_fma_f32 v133, v95, v96, v97
s_nop 0
v_fma_f32 v134, v98, v99, v128
v_fma_f32 v132, v132, v133, v134
v_cmp_u_f32 vcc, v132, v135
s_cbranch_vccnz L_kvredo3
L_kvback3:
v_cvt_pk_bf16_f32 v128, v128, v129
v_cvt_pk_bf16_f32 v129, v130, v131
v_cvt_pk_bf16_f32 v92, v92, v93
v_cndmask_b32 v128, 0, v128, s[56:57]
v_cndmask_b32 v129, 0, v129, s[56:57]
v_cvt_pk_bf16_f32 v93, v94, v95
v_cvt_pk_bf16_f32 v94, v96, v97
v_cvt_pk_bf16_f32 v95, v98, v99
v_cndmask_b32 v128, v128, v16, s[58:59]
v_cndmask_b32 v129, v129, v16, s[58:59]
ds_write_b64 v252, v[92:93] offset:0
ds_write_b64 v252, v[94:95] offset:1024
ds_write_b64 v252, v[128:129] offset:2048
s_waitcnt lgkmcnt(0)
s_barrier
ds_read_b128 a[8:11], v1 offset:2048
ds_read_b128 a[20:23], v1 offset:5120
ds_read_b128 a[0:3], v1 offset:0
ds_read_b128 a[12:15], v1 offset:3072
ds_read_b128 a[4:7], v1 offset:1024
ds_read_b128 a[16:19], v1 offset:4096
s_waitcnt lgkmcnt(5)
v_mfma_f32_16x16x32_bf16 v[116:119], a[8:11], v[212:215], 0
s_waitcnt lgkmcnt(4)
v_mfma_f32_16x16x32_bf16 v[120:123], a[20:23], v[216:219], 0
s_waitcnt lgkmcnt(3)
v_mfma_f32_16x16x32_bf16 v[204:207], a[0:3], v[212:215], 0
s_nop 3
v_rcp_f32 v118, v117
s_waitcnt lgkmcnt(2)
v_mfma_f32_16x16x32_bf16 v[220:223], a[12:15], v[216:219], 0
v_rcp_f32 v119, v121
v_mul_f32 v116, v116, v118
v_fmac_f32 v116, v120, v119
v_mfma_f32_16x16x32_bf16 v[100:103], a[8:11], v[164:167], 0
v_add_f32 v116, 0x358637bd, v116
v_rcp_f32 v116, v116
s_waitcnt lgkmcnt(1)
v_mfma_f32_16x16x32_bf16 v[208:211], a[4:7], v[212:215], 0
v_mul_f32 v118, v118, v116
v_mul_f32 v119, v119, v116
v_mfma_f32_16x16x32_bf16 v[104:107], a[20:23], v[168:171], 0
v_mul_f32 v204, v204, v118
v_mul_f32 v205, v205, v118
s_waitcnt lgkmcnt(0)
v_mfma_f32_16x16x32_bf16 v[224:227], a[16:19], v[216:219], 0
v_mul_f32 v206, v206, v118
v_mul_f32 v207, v207, v118
v_fmac_f32 v204, v220, v119
v_fmac_f32 v205, v221, v119
v_rcp_f32 v102, v101
v_mul_f32 v208, v208, v118
v_mul_f32 v209, v209, v118
v_mul_f32 v210, v210, v118
v_mul_f32 v211, v211, v118
v_fmac_f32 v206, v222, v119
v_fmac_f32 v207, v223, v119
v_cvt_pk_bf16_f32 v204, v204, v205
v_rcp_f32 v103, v105
v_fmac_f32 v208, v224, v119
v_fmac_f32 v209, v225, v119
v_fmac_f32 v210, v226, v119
v_fmac_f32 v211, v227, v119
v_cvt_pk_bf16_f32 v205, v206, v207
v_cvt_pk_bf16_f32 v206, v208, v209
v_cvt_pk_bf16_f32 v207, v210, v211
v_mul_f32 v100, v100, v102
v_mfma_f32_16x16x32_bf16 v[156:159], a[0:3], v[164:167], 0
buffer_store_dwordx4 v[204:207], v2, s[4:7], s72 offen offset:3072 sc1
v_fmac_f32 v100, v104, v103
v_mfma_f32_16x16x32_bf16 v[172:175], a[12:15], v[168:171], 0
v_add_f32 v100, 0x358637bd, v100
v_rcp_f32 v100, v100
v_mfma_f32_16x16x32_bf16 v[108:111], a[8:11], v[188:191], 0
v_mul_f32 v102, v102, v100
v_mul_f32 v103, v103, v100
v_mfma_f32_16x16x32_bf16 v[160:163], a[4:7], v[164:167], 0
v_mul_f32 v156, v156, v102
v_mul_f32 v157, v157, v102
v_mfma_f32_16x16x32_bf16 v[112:115], a[20:23], v[192:195], 0
v_mul_f32 v158, v158, v102
v_mul_f32 v159, v159, v102
v_mfma_f32_16x16x32_bf16 v[176:179], a[16:19], v[168:171], 0
v_fmac_f32 v156, v172, v103
v_fmac_f32 v157, v173, v103
v_rcp_f32 v110, v109
v_mul_f32 v160, v160, v102
v_mul_f32 v161, v161, v102
v_mul_f32 v162, v162, v102
v_mul_f32 v163, v163, v102
v_fmac_f32 v158, v174, v103
v_fmac_f32 v159, v175, v103
v_cvt_pk_bf16_f32 v156, v156, v157
v_rcp_f32 v111, v113
v_fmac_f32 v160, v176, v103
v_fmac_f32 v161, v177, v103
v_fmac_f32 v162, v178, v103
v_fmac_f32 v163, v179, v103
v_cvt_pk_bf16_f32 v157, v158, v159
v_cvt_pk_bf16_f32 v158, v160, v161
v_cvt_pk_bf16_f32 v159, v162, v163
v_mul_f32 v108, v108, v110
v_mfma_f32_16x16x32_bf16 v[180:183], a[0:3], v[188:191], 0
buffer_store_dwordx4 v[156:159], v2, s[4:7], s72 offen offset:1024 sc1
v_fmac_f32 v108, v112, v111
v_mfma_f32_16x16x32_bf16 v[196:199], a[12:15], v[192:195], 0
v_add_f32 v108, 0x358637bd, v108
v_rcp_f32 v108, v108
v_mfma_f32_16x16x32_bf16 v[92:95], a[8:11], v[140:143], 0
v_mul_f32 v110, v110, v108
v_mul_f32 v111, v111, v108
v_mfma_f32_16x16x32_bf16 v[184:187], a[4:7], v[188:191], 0
v_mul_f32 v180, v180, v110
v_mul_f32 v181, v181, v110
v_mfma_f32_16x16x32_bf16 v[96:99], a[20:23], v[144:147], 0
v_mul_f32 v182, v182, v110
v_mul_f32 v183, v183, v110
v_mfma_f32_16x16x32_bf16 v[200:203], a[16:19], v[192:195], 0
v_fmac_f32 v180, v196, v111
v_fmac_f32 v181, v197, v111
v_rcp_f32 v94, v93
v_mul_f32 v184, v184, v110
v_mul_f32 v185, v185, v110
v_mul_f32 v186, v186, v110
v_mul_f32 v187, v187, v110
v_fmac_f32 v182, v198, v111
v_fmac_f32 v183, v199, v111
v_cvt_pk_bf16_f32 v180, v180, v181
v_rcp_f32 v95, v97
buffer_atomic_add v12, v10, s[4:7], s74 offen sc1
v_fmac_f32 v184, v200, v111
v_fmac_f32 v185, v201, v111
v_fmac_f32 v186, v202, v111
v_fmac_f32 v187, v203, v111
v_cvt_pk_bf16_f32 v181, v182, v183
v_cvt_pk_bf16_f32 v182, v184, v185
v_cvt_pk_bf16_f32 v183, v186, v187
v_mul_f32 v92, v92, v94
v_mfma_f32_16x16x32_bf16 v[132:135], a[0:3], v[140:143], 0
buffer_store_dwordx4 v[180:183], v2, s[4:7], s72 offen offset:2048 sc1
v_fmac_f32 v92, v96, v95
v_mfma_f32_16x16x32_bf16 v[148:151], a[12:15], v[144:147], 0
v_add_f32 v92, 0x358637bd, v92
v_rcp_f32 v92, v92
v_mfma_f32_16x16x32_bf16 v[136:139], a[4:7], v[140:143], 0
v_mul_f32 v94, v94, v92
v_mul_f32 v95, v95, v92
v_mfma_f32_16x16x32_bf16 v[152:155], a[16:19], v[144:147], 0
v_mul_f32 v132, v132, v94
v_mul_f32 v133, v133, v94
v_mul_f32 v134, v134, v94
v_mul_f32 v135, v135, v94
v_fmac_f32 v132, v148, v95
v_fmac_f32 v133, v149, v95
v_mul_f32 v136, v136, v94
v_mul_f32 v137, v137, v94
v_mul_f32 v138, v138, v94
v_mul_f32 v139, v139, v94
v_fmac_f32 v134, v150, v95
v_fmac_f32 v135, v151, v95
v_cvt_pk_bf16_f32 v132, v132, v133
v_fmac_f32 v136, v152, v95
v_fmac_f32 v137, v153, v95
v_fmac_f32 v138, v154, v95
v_fmac_f32 v139, v155, v95
v_cvt_pk_bf16_f32 v133, v134, v135
v_cvt_pk_bf16_f32 v134, v136, v137
v_cvt_pk_bf16_f32 v135, v138, v139
buffer_store_dwordx4 v[132:135], v2, s[4:7], s72 offen offset:0 sc1
s_add_u32 s92, s71, 0x30000
s_add_u32 s36, s66, 0x30080
s_add_u32 s40, s4, 0x2600000
s_addc_u32 s41, s5, 0
v_add_u32 v5, 32768, v1
v_add_u32 v6, 98304, v1
s_cmp_eq_u32 s3, 0
s_cselect_b32 s35, 8, 0
s_lshl_b32 s35, s35, 12
v_lshlrev_b32 v132, 16, v32
v_and_b32 v133, 0xffff0000, v32
v_lshlrev_b32 v134, 16, v33
v_and_b32 v135, 0xffff0000, v33
v_lshlrev_b32 v136, 16, v34
v_and_b32 v137, 0xffff0000, v34
v_lshlrev_b32 v138, 16, v35
v_and_b32 v139, 0xffff0000, v35
v_lshlrev_b32 v140, 16, v36
v_and_b32 v141, 0xffff0000, v36
v_lshlrev_b32 v142, 16, v37
v_and_b32 v143, 0xffff0000, v37
v_lshlrev_b32 v144, 16, v38
v_and_b32 v145, 0xffff0000, v38
v_lshlrev_b32 v146, 16, v39
v_and_b32 v147, 0xffff0000, v39
v_lshlrev_b32 v148, 16, v40
v_and_b32 v149, 0xffff0000, v40
v_lshlrev_b32 v150, 16, v41
v_and_b32 v151, 0xffff0000, v41
v_lshlrev_b32 v152, 16, v42
v_and_b32 v153, 0xffff0000, v42
v_lshlrev_b32 v154, 16, v43
v_and_b32 v155, 0xffff0000, v43
v_lshlrev_b32 v156, 16, v44
v_and_b32 v157, 0xffff0000, v44
v_lshlrev_b32 v158, 16, v45
v_and_b32 v159, 0xffff0000, v45
v_lshlrev_b32 v160, 16, v46
v_and_b32 v161, 0xffff0000, v46
v_lshlrev_b32 v162, 16, v47
v_and_b32 v163, 0xffff0000, v47
s_mov_b32 s95, -1
s_mov_b64 exec, 0
s_cmp_eq_u32 s28, 3
s_cbranch_scc1 L_stub19
s_cmp_eq_u32 s28, 2
s_cbranch_scc1 L_wret7
L_wret7:
s_mov_b64 exec, -1
s_cmp_lg_u32 s28, 1
s_cbranch_scc1 Lpo_46
s_add_u32 s36, s66, 0x30080
s_mov_b32 s37, 0
v_mov_b32 v11, 0
buffer_atomic_add v11, v251, s[4:7], s36 offen sc0 sc1
s_sleep 4
Lpoll_44:
v_mov_b32 v234, 0
buffer_atomic_add v234, v251, s[4:7], s36 offen sc0 sc1
s_waitcnt vmcnt(1)
v_readfirstlane_b32 s38, v11
s_nop 0
s_cmp_ge_u32 s38, 32
s_cbranch_scc1 Lpe_45
v_mov_b32 v11, 0
buffer_atomic_add v11, v251, s[4:7], s36 offen sc0 sc1
s_waitcnt vmcnt(1)
v_readfirstlane_b32 s38, v234
s_nop 0
s_cmp_ge_u32 s38, 32
s_cbranch_scc1 Lpe_45
s_add_u32 s37, s37, 1
s_cmp_lt_u32 s37, 0x80000
s_cbranch_scc1 Lpoll_44
s_waitcnt vmcnt(0)
Lpo_46:
s_waitcnt vmcnt(0)
Lpe_45:
s_barrier
L_k2go3:
buffer_load_dwordx4 a[0:3], v4, s[40:43], s35 offen offset:0 sc1
buffer_load_dwordx4 a[4:7], v4, s[40:43], s35 offen offset:1024 sc1
s_cmp_eq_u32 s3, 1
s_cselect_b32 s35, 9, 1
s_lshl_b32 s35, s35, 12
buffer_load_dwordx4 a[8:11], v4, s[40:43], s35 offen offset:0 sc1
buffer_load_dwordx4 a[12:15], v4, s[40:43], s35 offen offset:1024 sc1
s_cmp_eq_u32 s3, 2
s_cselect_b32 s35, 10, 2
s_lshl_b32 s35, s35, 12
buffer_load_dwordx4 a[16:19], v4, s[40:43], s35 offen offset:0 sc1
buffer_load_dwordx4 a[20:23], v4, s[40:43], s35 offen offset:1024 sc1
s_cmp_eq_u32 s3, 3
s_cselect_b32 s35, 11, 3
s_lshl_b32 s35, s35, 12
buffer_load_dwordx4 a[24:27], v4, s[40:43], s35 offen offset:0 sc1
buffer_load_dwordx4 a[28:31], v4, s[40:43], s35 offen offset:1024 sc1
s_cmp_eq_u32 s3, 4
s_cselect_b32 s35, 12, 4
s_lshl_b32 s35, s35, 12
buffer_load_dwordx4 a[32:35], v4, s[40:43], s35 offen offset:0 sc1
buffer_load_dwordx4 a[36:39], v4, s[40:43], s35 offen offset:1024 sc1
s_cmp_eq_u32 s3, 5
s_cselect_b32 s35, 13, 5
s_lshl_b32 s35, s35, 12
buffer_load_dwordx4 a[40:43], v4, s[40:43], s35 offen offset:0 sc1
buffer_load_dwordx4 a[44:47], v4, s[40:43], s35 offen offset:1024 sc1
s_cmp_eq_u32 s3, 6
s_cselect_b32 s35, 14, 6
s_lshl_b32 s35, s35, 12
ds_read_b128 a[96:99], v5 offset:0
ds_read_b128 a[100:103], v5 offset:1024
ds_read_b128 a[104:107], v5 offset:2048
ds_read_b128 a[108:111], v5 offset:3072
ds_read_b128 a[112:115], v5 offset:4096
ds_read_b128 a[116:119], v5 offset:5120
ds_read_b128 a[120:123], v5 offset:6144
ds_read_b128 a[124:127], v5 offset:7168
s_waitcnt vmcnt(10) lgkmcnt(4)
v_mfma_f32_16x16x32_bf16 v[132:135], a[96:99], a[0:3], v[132:135]
ds_read_b128 a[128:131], v5 offset:8192
v_mfma_f32_16x16x32_bf16 v[148:151], a[96:99], a[4:7], v[148:151]
ds_read_b128 a[132:135], v5 offset:9216
v_mfma_f32_16x16x32_bf16 v[152:155], a[100:103], a[4:7], v[152:155]
buffer_load_dwordx4 a[48:51], v4, s[40:43], s35 offen offset:0 sc1
v_mfma_f32_16x16x32_bf16 v[136:139], a[100:103], a[0:3], v[136:139]
ds_read_b128 a[136:139], v5 offset:10240
v_mfma_f32_16x16x32_bf16 v[140:143], a[104:107], a[0:3], v[140:143]
ds_read_b128 a[140:143], v5 offset:11264
v_mfma_f32_16x16x32_bf16 v[156:159], a[104:107], a[4:7], v[156:159]
v_mfma_f32_16x16x32_bf16 v[160:163], a[108:111], a[4:7], v[160:163]
buffer_load_dwordx4 a[52:55], v4, s[40:43], s35 offen offset:1024 sc1
v_mfma_f32_16x16x32_bf16 v[144:147], a[108:111], a[0:3], v[144:147]
s_waitcnt vmcnt(10) lgkmcnt(4)
v_mfma_f32_16x16x32_bf16 v[132:135], a[112:115], a[8:11], v[132:135]
s_cmp_eq_u32 s3, 7
s_cselect_b32 s35, 15, 7
s_lshl_b32 s35, s35, 12
v_mfma_f32_16x16x32_bf16 v[148:151], a[112:115], a[12:15], v[148:151]
ds_read_b128 a[96:99], v5 offset:12288
v_mfma_f32_16x16x32_bf16 v[152:155], a[116:119], a[12:15], v[152:155]
buffer_load_dwordx4 a[0:3], v4, s[40:43], s35 offen offset:0 sc1
v_mfma_f32_16x16x32_bf16 v[136:139], a[116:119], a[8:11], v[136:139]
ds_read_b128 a[100:103], v5 offset:13312
v_mfma_f32_16x16x32_bf16 v[140:143], a[120:123], a[8:11], v[140:143]
ds_read_b128 a[104:107], v5 offset:14336
v_mfma_f32_16x16x32_bf16 v[156:159], a[120:123], a[12:15], v[156:159]
ds_read_b128 a[108:111], v5 offset:15360
v_mfma_f32_16x16x32_bf16 v[160:163], a[124:127], a[12:15], v[160:163]
buffer_load_dwordx4 a[4:7], v4, s[40:43], s35 offen offset:1024 sc1
v_mfma_f32_16x16x32_bf16 v[144:147], a[124:127], a[8:11], v[144:147]
s_waitcnt vmcnt(10) lgkmcnt(4)
v_mfma_f32_16x16x32_bf16 v[132:135], a[128:131], a[16:19], v[132:135]
s_cmp_eq_u32 s3, 0
s_cselect_b32 s35, 16, 8
s_lshl_b32 s35, s35, 12
v_mfma_f32_16x16x32_bf16 v[148:151], a[128:131], a[20:23], v[148:151]
ds_read_b128 a[112:115], v5 offset:16384
v_mfma_f32_16x16x32_bf16 v[152:155], a[132:135], a[20:23], v[152:155]
buffer_load_dwordx4 a[8:11], v4, s[40:43], s35 offen offset:0 sc1
v_mfma_f32_16x16x32_bf16 v[136:139], a[132:135], a[16:19], v[136:139]
ds_read_b128 a[116:119], v5 offset:17408
v_mfma_f32_16x16x32_bf16 v[140:143], a[136:139], a[16:19], v[140:143]
ds_read_b128 a[120:123], v5 offset:18432
v_mfma_f32_16x16x32_bf16 v[156:159], a[136:139], a[20:23], v[156:159]
ds_read_b128 a[124:127], v5 offset:19456
v_mfma_f32_16x16x32_bf16 v[160:163], a[140:143], a[20:23], v[160:163]
buffer_load_dwordx4 a[12:15], v4, s[40:43], s35 offen offset:1024 sc1
v_mfma_f32_16x16x32_bf16 v[144:147], a[140:143], a[16:19], v[144:147]
s_waitcnt vmcnt(10) lgkmcnt(4)
v_mfma_f32_16x16x32_bf16 v[132:135], a[96:99], a[24:27], v[132:135]
s_cmp_eq_u32 s3, 1
s_cselect_b32 s35, 17, 9
s_lshl_b32 s35, s35, 12
v_mfma_f32_16x16x32_bf16 v[148:151], a[96:99], a[28:31], v[148:151]
ds_read_b128 a[128:131], v5 offset:20480
v_mfma_f32_16x16x32_bf16 v[152:155], a[100:103], a[28:31], v[152:155]
buffer_load_dwordx4 a[16:19], v4, s[40:43], s35 offen offset:0 sc1
v_mfma_f32_16x16x32_bf16 v[136:139], a[100:103], a[24:27], v[136:139]
ds_read_b128 a[132:135], v5 offset:21504
v_mfma_f32_16x16x32_bf16 v[140:143], a[104:107], a[24:27], v[140:143]
ds_read_b128 a[136:139], v5 offset:22528
v_mfma_f32_16x16x32_bf16 v[156:159], a[104:107], a[28:31], v[156:159]
ds_read_b128 a[140:143], v5 offset:23552
v_mfma_f32_16x16x32_bf16 v[160:163], a[108:111], a[28:31], v[160:163]
buffer_load_dwordx4 a[20:23], v4, s[40:43], s35 offen offset:1024 sc1
v_mfma_f32_16x16x32_bf16 v[144:147], a[108:111], a[24:27], v[144:147]
s_waitcnt vmcnt(10) lgkmcnt(4)
v_mfma_f32_16x16x32_bf16 v[132:135], a[112:115], a[32:35], v[132:135]
s_cmp_eq_u32 s3, 2
s_cselect_b32 s35, 18, 10
s_lshl_b32 s35, s35, 12
v_mfma_f32_16x16x32_bf16 v[148:151], a[112:115], a[36:39], v[148:151]
ds_read_b128 a[96:99], v5 offset:24576
v_mfma_f32_16x16x32_bf16 v[152:155], a[116:119], a[36:39], v[152:155]
buffer_load_dwordx4 a[24:27], v4, s[40:43], s35 offen offset:0 sc1
v_mfma_f32_16x16x32_bf16 v[136:139], a[116:119], a[32:35], v[136:139]
ds_read_b128 a[100:103], v5 offset:25600
v_mfma_f32_16x16x32_bf16 v[140:143], a[120:123], a[32:35], v[140:143]
ds_read_b128 a[104:107], v5 offset:26624
v_mfma_f32_16x16x32_bf16 v[156:159], a[120:123], a[36:39], v[156:159]
ds_read_b128 a[108:111], v5 offset:27648
v_mfma_f32_16x16x32_bf16 v[160:163], a[124:127], a[36:39], v[160:163]
buffer_load_dwordx4 a[28:31], v4, s[40:43], s35 offen offset:1024 sc1
v_mfma_f32_16x16x32_bf16 v[144:147], a[124:127], a[32:35], v[144:147]
s_waitcnt vmcnt(10) lgkmcnt(4)
v_mfma_f32_16x16x32_bf16 v[132:135], a[128:131], a[40:43], v[132:135]
s_cmp_eq_u32 s3, 3
s_cselect_b32 s35, 19, 11
s_lshl_b32 s35, s35, 12
v_mfma_f32_16x16x32_bf16 v[148:151], a[128:131], a[44:47], v[148:151]
ds_read_b128 a[112:115], v5 offset:28672
v_mfma_f32_16x16x32_bf16 v[152:155], a[132:135], a[44:47], v[152:155]
buffer_load_dwordx4 a[32:35], v4, s[40:43], s35 offen offset:0 sc1
v_mfma_f32_16x16x32_bf16 v[136:139], a[132:135], a[40:43], v[136:139]
ds_read_b128 a[116:119], v5 offset:29696
v_mfma_f32_16x16x32_bf16 v[140:143], a[136:139], a[40:43], v[140:143]
ds_read_b128 a[120:123], v5 offset:30720
v_mfma_f32_16x16x32_bf16 v[156:159], a[136:139], a[44:47], v[156:159]
ds_read_b128 a[124:127], v5 offset:31744
v_mfma_f32_16x16x32_bf16 v[160:163], a[140:143], a[44:47], v[160:163]
buffer_load_dwordx4 a[36:39], v4, s[40:43], s35 offen offset:1024 sc1
v_mfma_f32_16x16x32_bf16 v[144:147], a[140:143], a[40:43], v[144:147]
s_waitcnt vmcnt(10) lgkmcnt(4)
v_mfma_f32_16x16x32_bf16 v[132:135], a[96:99], a[48:51], v[132:135]
s_cmp_eq_u32 s3, 4
s_cselect_b32 s35, 20, 12
s_lshl_b32 s35, s35, 12
v_mfma_f32_16x16x32_bf16 v[148:151], a[96:99], a[52:55], v[148:151]
ds_read_b128 a[128:131], v5 offset:32768
v_mfma_f32_16x16x32_bf16 v[152:155], a[100:103], a[52:55], v[152:155]
buffer_load_dwordx4 a[40:43], v4, s[40:43], s35 offen offset:0 sc1
v_mfma_f32_16x16x32_bf16 v[136:139], a[100:103], a[48:51], v[136:139]
ds_read_b128 a[132:135], v5 offset:33792
v_mfma_f32_16x16x32_bf16 v[140:143], a[104:107], a[48:51], v[140:143]
ds_read_b128 a[136:139], v5 offset:34816
v_mfma_f32_16x16x32_bf16 v[156:159], a[104:107], a[52:55], v[156:159]
ds_read_b128 a[140:143], v5 offset:35840
v_mfma_f32_16x16x32_bf16 v[160:163], a[108:111], a[52:55], v[160:163]
buffer_load_dwordx4 a[44:47], v4, s[40:43], s35 offen offset:1024 sc1
v_mfma_f32_16x16x32_bf16 v[144:147], a[108:111], a[48:51], v[144:147]
s_waitcnt vmcnt(10) lgkmcnt(4)
v_mfma_f32_16x16x32_bf16 v[132:135], a[112:115], a[0:3], v[132:135]
s_cmp_eq_u32 s3, 5
s_cselect_b32 s35, 21, 13
s_lshl_b32 s35, s35, 12
v_mfma_f32_16x16x32_bf16 v[148:151], a[112:115], a[4:7], v[148:151]
ds_read_b128 a[96:99], v5 offset:36864
v_mfma_f32_16x16x32_bf16 v[152:155], a[116:119], a[4:7], v[152:155]
buffer_load_dwordx4 a[48:51], v4, s[40:43], s35 offen offset:0 sc1
v_mfma_f32_16x16x32_bf16 v[136:139], a[116:119], a[0:3], v[136:139]
ds_read_b128 a[100:103], v5 offset:37888
v_mfma_f32_16x16x32_bf16 v[140:143], a[120:123], a[0:3], v[140:143]
ds_read_b128 a[104:107], v5 offset:38912
v_mfma_f32_16x16x32_bf16 v[156:159], a[120:123], a[4:7], v[156:159]
ds_read_b128 a[108:111], v5 offset:39936
v_mfma_f32_16x16x32_bf16 v[160:163], a[124:127], a[4:7], v[160:163]
buffer_load_dwordx4 a[52:55], v4, s[40:43], s35 offen offset:1024 sc1
v_mfma_f32_16x16x32_bf16 v[144:147], a[124:127], a[0:3], v[144:147]
s_waitcnt vmcnt(10) lgkmcnt(4)
v_mfma_f32_16x16x32_bf16 v[132:135], a[128:131], a[8:11], v[132:135]
s_cmp_eq_u32 s3, 6
s_cselect_b32 s35, 22, 14
s_lshl_b32 s35, s35, 12
v_mfma_f32_16x16x32_bf16 v[148:151], a[128:131], a[12:15], v[148:151]
ds_read_b128 a[112:115], v5 offset:40960
v_mfma_f32_16x16x32_bf16 v[152:155], a[132:135], a[12:15], v[152:155]
buffer_load_dwordx4 a[0:3], v4, s[40:43], s35 offen offset:0 sc1
L_stub19:
s_cbranch_execz L_wret7
v_mfma_f32_16x16x32_bf16 v[136:139], a[132:135], a[8:11], v[136:139]
ds_read_b128 a[116:119], v5 offset:41984
v_mfma_f32_16x16x32_bf16 v[140:143], a[136:139], a[8:11], v[140:143]
ds_read_b128 a[120:123], v5 offset:43008
v_mfma_f32_16x16x32_bf16 v[156:159], a[136:139], a[12:15], v[156:159]
ds_read_b128 a[124:127], v5 offset:44032
v_mfma_f32_16x16x32_bf16 v[160:163], a[140:143], a[12:15], v[160:163]
buffer_load_dwordx4 a[4:7], v4, s[40:43], s35 offen offset:1024 sc1
v_mfma_f32_16x16x32_bf16 v[144:147], a[140:143], a[8:11], v[144:147]
s_waitcnt vmcnt(10) lgkmcnt(4)
v_mfma_f32_16x16x32_bf16 v[132:135], a[96:99], a[16:19], v[132:135]
s_cmp_eq_u32 s3, 7
s_cselect_b32 s35, 23, 15
s_lshl_b32 s35, s35, 12
v_mfma_f32_16x16x32_bf16 v[148:151], a[96:99], a[20:23], v[148:151]
ds_read_b128 a[128:131], v5 offset:45056
v_mfma_f32_16x16x32_bf16 v[152:155], a[100:103], a[20:23], v[152:155]
buffer_load_dwordx4 a[8:11], v4, s[40:43], s35 offen offset:0 sc1
v_mfma_f32_16x16x32_bf16 v[136:139], a[100:103], a[16:19], v[136:139]
ds_read_b128 a[132:135], v5 offset:46080
v_mfma_f32_16x16x32_bf16 v[140:143], a[104:107], a[16:19], v[140:143]
ds_read_b128 a[136:139], v5 offset:47104
v_mfma_f32_16x16x32_bf16 v[156:159], a[104:107], a[20:23], v[156:159]
ds_read_b128 a[140:143], v5 offset:48128
v_mfma_f32_16x16x32_bf16 v[160:163], a[108:111], a[20:23], v[160:163]
buffer_load_dwordx4 a[12:15], v4, s[40:43], s35 offen offset:1024 sc1
v_mfma_f32_16x16x32_bf16 v[144:147], a[108:111], a[16:19], v[144:147]
s_waitcnt vmcnt(10) lgkmcnt(4)
v_mfma_f32_16x16x32_bf16 v[132:135], a[112:115], a[24:27], v[132:135]
s_cmp_eq_u32 s3, 0
s_cselect_b32 s35, 24, 16
s_lshl_b32 s35, s35, 12
v_mfma_f32_16x16x32_bf16 v[148:151], a[112:115], a[28:31], v[148:151]
ds_read_b128 a[96:99], v5 offset:49152
v_mfma_f32_16x16x32_bf16 v[152:155], a[116:119], a[28:31], v[152:155]
buffer_load_dwordx4 a[16:19], v4, s[40:43], s35 offen offset:0 sc1
v_mfma_f32_16x16x32_bf16 v[136:139], a[116:119], a[24:27], v[136:139]
ds_read_b128 a[100:103], v5 offset:50176
v_mfma_f32_16x16x32_bf16 v[140:143], a[120:123], a[24:27], v[140:143]
ds_read_b128 a[104:107], v5 offset:51200
v_mfma_f32_16x16x32_bf16 v[156:159], a[120:123], a[28:31], v[156:159]
ds_read_b128 a[108:111], v5 offset:52224
v_mfma_f32_16x16x32_bf16 v[160:163], a[124:127], a[28:31], v[160:163]
buffer_load_dwordx4 a[20:23], v4, s[40:43], s35 offen offset:1024 sc1
v_mfma_f32_16x16x32_bf16 v[144:147], a[124:127], a[24:27], v[144:147]
s_waitcnt vmcnt(10) lgkmcnt(4)
v_mfma_f32_16x16x32_bf16 v[132:135], a[128:131], a[32:35], v[132:135]
s_cmp_eq_u32 s3, 1
s_cselect_b32 s35, 25, 17
s_lshl_b32 s35, s35, 12
v_mfma_f32_16x16x32_bf16 v[148:151], a[128:131], a[36:39], v[148:151]
ds_read_b128 a[112:115], v5 offset:53248
v_mfma_f32_16x16x32_bf16 v[152:155], a[132:135], a[36:39], v[152:155]
buffer_load_dwordx4 a[24:27], v4, s[40:43], s35 offen offset:0 sc1
v_mfma_f32_16x16x32_bf16 v[136:139], a[132:135], a[32:35], v[136:139]
ds_read_b128 a[116:119], v5 offset:54272
v_mfma_f32_16x16x32_bf16 v[140:143], a[136:139], a[32:35], v[140:143]
ds_read_b128 a[120:123], v5 offset:55296
v_mfma_f32_16x16x32_bf16 v[156:159], a[136:139], a[36:39], v[156:159]
ds_read_b128 a[124:127], v5 offset:56320
v_mfma_f32_16x16x32_bf16 v[160:163], a[140:143], a[36:39], v[160:163]
buffer_load_dwordx4 a[28:31], v4, s[40:43], s35 offen offset:1024 sc1
v_mfma_f32_16x16x32_bf16 v[144:147], a[140:143], a[32:35], v[144:147]
s_waitcnt vmcnt(10) lgkmcnt(4)
v_mfma_f32_16x16x32_bf16 v[132:135], a[96:99], a[40:43], v[132:135]
s_cmp_eq_u32 s3, 2
s_cselect_b32 s35, 26, 18
s_lshl_b32 s35, s35, 12
v_mfma_f32_16x16x32_bf16 v[148:151], a[96:99], a[44:47], v[148:151]
ds_read_b128 a[128:131], v5 offset:57344
v_mfma_f32_16x16x32_bf16 v[152:155], a[100:103], a[44:47], v[152:155]
buffer_load_dwordx4 a[32:35], v4, s[40:43], s35 offen offset:0 sc1
v_mfma_f32_16x16x32_bf16 v[136:139], a[100:103], a[40:43], v[136:139]
ds_read_b128 a[132:135], v5 offset:58368
v_mfma_f32_16x16x32_bf16 v[140:143], a[104:107], a[40:43], v[140:143]
ds_read_b128 a[136:139], v5 offset:59392
v_mfma_f32_16x16x32_bf16 v[156:159], a[104:107], a[44:47], v[156:159]
ds_read_b128 a[140:143], v5 offset:60416
v_mfma_f32_16x16x32_bf16 v[160:163], a[108:111], a[44:47], v[160:163]
buffer_load_dwordx4 a[36:39], v4, s[40:43], s35 offen offset:1024 sc1
v_mfma_f32_16x16x32_bf16 v[144:147], a[108:111], a[40:43], v[144:147]
s_waitcnt vmcnt(10) lgkmcnt(4)
v_mfma_f32_16x16x32_bf16 v[132:135], a[112:115], a[48:51], v[132:135]
s_cmp_eq_u32 s3, 3
s_cselect_b32 s35, 27, 19
s_lshl_b32 s35, s35, 12
v_mfma_f32_16x16x32_bf16 v[148:151], a[112:115], a[52:55], v[148:151]
ds_read_b128 a[96:99], v5 offset:61440
v_mfma_f32_16x16x32_bf16 v[152:155], a[116:119], a[52:55], v[152:155]
buffer_load_dwordx4 a[40:43], v4, s[40:43], s35 offen offset:0 sc1
v_mfma_f32_16x16x32_bf16 v[136:139], a[116:119], a[48:51], v[136:139]
ds_read_b128 a[100:103], v5 offset:62464
v_mfma_f32_16x16x32_bf16 v[140:143], a[120:123], a[48:51], v[140:143]
ds_read_b128 a[104:107], v5 offset:63488
v_mfma_f32_16x16x32_bf16 v[156:159], a[120:123], a[52:55], v[156:159]
ds_read_b128 a[108:111], v5 offset:64512
v_mfma_f32_16x16x32_bf16 v[160:163], a[124:127], a[52:55], v[160:163]
buffer_load_dwordx4 a[44:47], v4, s[40:43], s35 offen offset:1024 sc1
v_mfma_f32_16x16x32_bf16 v[144:147], a[124:127], a[48:51], v[144:147]
s_waitcnt vmcnt(10) lgkmcnt(4)
v_mfma_f32_16x16x32_bf16 v[132:135], a[128:131], a[0:3], v[132:135]
s_cmp_eq_u32 s3, 4
s_cselect_b32 s35, 28, 20
s_lshl_b32 s35, s35, 12
v_mfma_f32_16x16x32_bf16 v[148:151], a[128:131], a[4:7], v[148:151]
ds_read_b128 a[112:115], v6 offset:0
v_mfma_f32_16x16x32_bf16 v[152:155], a[132:135], a[4:7], v[152:155]
buffer_load_dwordx4 a[48:51], v4, s[40:43], s35 offen offset:0 sc1
v_mfma_f32_16x16x32_bf16 v[136:139], a[132:135], a[0:3], v[136:139]
ds_read_b128 a[116:119], v6 offset:1024
v_mfma_f32_16x16x32_bf16 v[140:143], a[136:139], a[0:3], v[140:143]
ds_read_b128 a[120:123], v6 offset:2048
v_mfma_f32_16x16x32_bf16 v[156:159], a[136:139], a[4:7], v[156:159]
ds_read_b128 a[124:127], v6 offset:3072
v_mfma_f32_16x16x32_bf16 v[160:163], a[140:143], a[4:7], v[160:163]
buffer_load_dwordx4 a[52:55], v4, s[40:43], s35 offen offset:1024 sc1
v_mfma_f32_16x16x32_bf16 v[144:147], a[140:143], a[0:3], v[144:147]
s_waitcnt vmcnt(10) lgkmcnt(4)
v_mfma_f32_16x16x32_bf16 v[132:135], a[96:99], a[8:11], v[132:135]
s_cmp_eq_u32 s3, 5
s_cselect_b32 s35, 29, 21
s_lshl_b32 s35, s35, 12
v_mfma_f32_16x16x32_bf16 v[148:151], a[96:99], a[12:15], v[148:151]
ds_read_b128 a[128:131], v6 offset:4096
v_mfma_f32_16x16x32_bf16 v[152:155], a[100:103], a[12:15], v[152:155]
buffer_load_dwordx4 a[0:3], v4, s[40:43], s35 offen offset:0 sc1
v_mfma_f32_16x16x32_bf16 v[136:139], a[100:103], a[8:11], v[136:139]
ds_read_b128 a[132:135], v6 offset:5120
v_mfma_f32_16x16x32_bf16 v[140:143], a[104:107], a[8:11], v[140:143]
ds_read_b128 a[136:139], v6 offset:6144
v_mfma_f32_16x16x32_bf16 v[156:159], a[104:107], a[12:15], v[156:159]
ds_read_b128 a[140:143], v6 offset:7168
v_mfma_f32_16x16x32_bf16 v[160:163], a[108:111], a[12:15], v[160:163]
buffer_load_dwordx4 a[4:7], v4, s[40:43], s35 offen offset:1024 sc1
v_mfma_f32_16x16x32_bf16 v[144:147], a[108:111], a[8:11], v[144:147]
s_waitcnt vmcnt(10) lgkmcnt(4)
v_mfma_f32_16x16x32_bf16 v[132:135], a[112:115], a[16:19], v[132:135]
s_cmp_eq_u32 s3, 6
s_cselect_b32 s35, 30, 22
s_lshl_b32 s35, s35, 12
v_mfma_f32_16x16x32_bf16 v[148:151], a[112:115], a[20:23], v[148:151]
ds_read_b128 a[96:99], v6 offset:8192
v_mfma_f32_16x16x32_bf16 v[152:155], a[116:119], a[20:23], v[152:155]
buffer_load_dwordx4 a[8:11], v4, s[40:43], s35 offen offset:0 sc1
v_mfma_f32_16x16x32_bf16 v[136:139], a[116:119], a[16:19], v[136:139]
ds_read_b128 a[100:103], v6 offset:9216
v_mfma_f32_16x16x32_bf16 v[140:143], a[120:123], a[16:19], v[140:143]
ds_read_b128 a[104:107], v6 offset:10240
v_mfma_f32_16x16x32_bf16 v[156:159], a[120:123], a[20:23], v[156:159]
ds_read_b128 a[108:111], v6 offset:11264
v_mfma_f32_16x16x32_bf16 v[160:163], a[124:127], a[20:23], v[160:163]
buffer_load_dwordx4 a[12:15], v4, s[40:43], s35 offen offset:1024 sc1
v_mfma_f32_16x16x32_bf16 v[144:147], a[124:127], a[16:19], v[144:147]
s_waitcnt vmcnt(10) lgkmcnt(4)
v_mfma_f32_16x16x32_bf16 v[132:135], a[128:131], a[24:27], v[132:135]
s_cmp_eq_u32 s3, 7
s_cselect_b32 s35, 31, 23
s_lshl_b32 s35, s35, 12
v_mfma_f32_16x16x32_bf16 v[148:151], a[128:131], a[28:31], v[148:151]
ds_read_b128 a[112:115], v6 offset:12288
v_mfma_f32_16x16x32_bf16 v[152:155], a[132:135], a[28:31], v[152:155]
buffer_load_dwordx4 a[16:19], v4, s[40:43], s35 offen offset:0 sc1
v_mfma_f32_16x16x32_bf16 v[136:139], a[132:135], a[24:27], v[136:139]
ds_read_b128 a[116:119], v6 offset:13312
v_mfma_f32_16x16x32_bf16 v[140:143], a[136:139], a[24:27], v[140:143]
ds_read_b128 a[120:123], v6 offset:14336
v_mfma_f32_16x16x32_bf16 v[156:159], a[136:139], a[28:31], v[156:159]
ds_read_b128 a[124:127], v6 offset:15360
v_mfma_f32_16x16x32_bf16 v[160:163], a[140:143], a[28:31], v[160:163]
buffer_load_dwordx4 a[20:23], v4, s[40:43], s35 offen offset:1024 sc1
v_mfma_f32_16x16x32_bf16 v[144:147], a[140:143], a[24:27], v[144:147]
s_waitcnt vmcnt(10) lgkmcnt(4)
v_mfma_f32_16x16x32_bf16 v[132:135], a[96:99], a[32:35], v[132:135]
s_cmp_eq_u32 s3, 0
s_cselect_b32 s35, 0, 24
s_lshl_b32 s35, s35, 12
v_mfma_f32_16x16x32_bf16 v[148:151], a[96:99], a[36:39], v[148:151]
ds_read_b128 a[128:131], v6 offset:16384
v_mfma_f32_16x16x32_bf16 v[152:155], a[100:103], a[36:39], v[152:155]
buffer_load_dwordx4 a[24:27], v4, s[40:43], s35 offen offset:0 sc1
v_mfma_f32_16x16x32_bf16 v[136:139], a[100:103], a[32:35], v[136:139]
ds_read_b128 a[132:135], v6 offset:17408
v_mfma_f32_16x16x32_bf16 v[140:143], a[104:107], a[32:35], v[140:143]
ds_read_b128 a[136:139], v6 offset:18432
v_mfma_f32_16x16x32_bf16 v[156:159], a[104:107], a[36:39], v[156:159]
ds_read_b128 a[140:143], v6 offset:19456
v_mfma_f32_16x16x32_bf16 v[160:163], a[108:111], a[36:39], v[160:163]
buffer_load_dwordx4 a[28:31], v4, s[40:43], s35 offen offset:1024 sc1
v_mfma_f32_16x16x32_bf16 v[144:147], a[108:111], a[32:35], v[144:147]
s_waitcnt vmcnt(10) lgkmcnt(4)
v_mfma_f32_16x16x32_bf16 v[132:135], a[112:115], a[40:43], v[132:135]
s_cmp_eq_u32 s3, 1
s_cselect_b32 s35, 1, 25
s_lshl_b32 s35, s35, 12
v_mfma_f32_16x16x32_bf16 v[148:151], a[112:115], a[44:47], v[148:151]
ds_read_b128 a[96:99], v6 offset:20480
v_mfma_f32_16x16x32_bf16 v[152:155], a[116:119], a[44:47], v[152:155]
buffer_load_dwordx4 a[32:35], v4, s[40:43], s35 offen offset:0 sc1
v_mfma_f32_16x16x32_bf16 v[136:139], a[116:119], a[40:43], v[136:139]
ds_read_b128 a[100:103], v6 offset:21504
v_mfma_f32_16x16x32_bf16 v[140:143], a[120:123], a[40:43], v[140:143]
ds_read_b128 a[104:107], v6 offset:22528
v_mfma_f32_16x16x32_bf16 v[156:159], a[120:123], a[44:47], v[156:159]
ds_read_b128 a[108:111], v6 offset:23552
v_mfma_f32_16x16x32_bf16 v[160:163], a[124:127], a[44:47], v[160:163]
buffer_load_dwordx4 a[36:39], v4, s[40:43], s35 offen offset:1024 sc1
v_mfma_f32_16x16x32_bf16 v[144:147], a[124:127], a[40:43], v[144:147]
s_waitcnt vmcnt(10) lgkmcnt(4)
v_mfma_f32_16x16x32_bf16 v[132:135], a[128:131], a[48:51], v[132:135]
s_cmp_eq_u32 s3, 2
s_cselect_b32 s35, 2, 26
s_lshl_b32 s35, s35, 12
v_mfma_f32_16x16x32_bf16 v[148:151], a[128:131], a[52:55], v[148:151]
ds_read_b128 a[112:115], v6 offset:24576
v_mfma_f32_16x16x32_bf16 v[152:155], a[132:135], a[52:55], v[152:155]
buffer_load_dwordx4 a[40:43], v4, s[40:43], s35 offen offset:0 sc1
v_mfma_f32_16x16x32_bf16 v[136:139], a[132:135], a[48:51], v[136:139]
ds_read_b128 a[116:119], v6 offset:25600
v_mfma_f32_16x16x32_bf16 v[140:143], a[136:139], a[48:51], v[140:143]
ds_read_b128 a[120:123], v6 offset:26624
v_mfma_f32_16x16x32_bf16 v[156:159], a[136:139], a[52:55], v[156:159]
ds_read_b128 a[124:127], v6 offset:27648
v_mfma_f32_16x16x32_bf16 v[160:163], a[140:143], a[52:55], v[160:163]
buffer_load_dwordx4 a[44:47], v4, s[40:43], s35 offen offset:1024 sc1
v_mfma_f32_16x16x32_bf16 v[144:147], a[140:143], a[48:51], v[144:147]
s_waitcnt vmcnt(10) lgkmcnt(4)
v_mfma_f32_16x16x32_bf16 v[132:135], a[96:99], a[0:3], v[132:135]
s_cmp_eq_u32 s3, 3
s_cselect_b32 s35, 3, 27
s_lshl_b32 s35, s35, 12
v_mfma_f32_16x16x32_bf16 v[148:151], a[96:99], a[4:7], v[148:151]
ds_read_b128 a[128:131], v6 offset:28672
v_mfma_f32_16x16x32_bf16 v[152:155], a[100:103], a[4:7], v[152:155]
buffer_load_dwordx4 a[48:51], v4, s[40:43], s35 offen offset:0 sc1
v_mfma_f32_16x16x32_bf16 v[136:139], a[100:103], a[0:3], v[136:139]
ds_read_b128 a[132:135], v6 offset:29696
v_mfma_f32_16x16x32_bf16 v[140:143], a[104:107], a[0:3], v[140:143]
ds_read_b128 a[136:139], v6 offset:30720
v_mfma_f32_16x16x32_bf16 v[156:159], a[104:107], a[4:7], v[156:159]
ds_read_b128 a[140:143], v6 offset:31744
v_mfma_f32_16x16x32_bf16 v[160:163], a[108:111], a[4:7], v[160:163]
buffer_load_dwordx4 a[52:55], v4, s[40:43], s35 offen offset:1024 sc1
v_mfma_f32_16x16x32_bf16 v[144:147], a[108:111], a[0:3], v[144:147]
s_waitcnt vmcnt(10) lgkmcnt(4)
v_mfma_f32_16x16x32_bf16 v[132:135], a[112:115], a[8:11], v[132:135]
s_cmp_eq_u32 s3, 4
s_cselect_b32 s35, 4, 28
s_lshl_b32 s35, s35, 12
v_mfma_f32_16x16x32_bf16 v[148:151], a[112:115], a[12:15], v[148:151]
ds_read_b128 a[96:99], v6 offset:32768
v_mfma_f32_16x16x32_bf16 v[152:155], a[116:119], a[12:15], v[152:155]
buffer_load_dwordx4 a[0:3], v4, s[40:43], s35 offen offset:0 sc1
v_mfma_f32_16x16x32_bf16 v[136:139], a[116:119], a[8:11], v[136:139]
ds_read_b128 a[100:103], v6 offset:33792
v_mfma_f32_16x16x32_bf16 v[140:143], a[120:123], a[8:11], v[140:143]
ds_read_b128 a[104:107], v6 offset:34816
v_mfma_f32_16x16x32_bf16 v[156:159], a[120:123], a[12:15], v[156:159]
ds_read_b128 a[108:111], v6 offset:35840
v_mfma_f32_16x16x32_bf16 v[160:163], a[124:127], a[12:15], v[160:163]
buffer_load_dwordx4 a[4:7], v4, s[40:43], s35 offen offset:1024 sc1
v_mfma_f32_16x16x32_bf16 v[144:147], a[124:127], a[8:11], v[144:147]
s_waitcnt vmcnt(10) lgkmcnt(4)
v_mfma_f32_16x16x32_bf16 v[132:135], a[128:131], a[16:19], v[132:135]
s_cmp_eq_u32 s3, 5
s_cselect_b32 s35, 5, 29
s_lshl_b32 s35, s35, 12
v_mfma_f32_16x16x32_bf16 v[148:151], a[128:131], a[20:23], v[148:151]
ds_read_b128 a[112:115], v6 offset:36864
v_mfma_f32_16x16x32_bf16 v[152:155], a[132:135], a[20:23], v[152:155]
buffer_load_dwordx4 a[8:11], v4, s[40:43], s35 offen offset:0 sc1
v_mfma_f32_16x16x32_bf16 v[136:139], a[132:135], a[16:19], v[136:139]
ds_read_b128 a[116:119], v6 offset:37888
v_mfma_f32_16x16x32_bf16 v[140:143], a[136:139], a[16:19], v[140:143]
ds_read_b128 a[120:123], v6 offset:38912
v_mfma_f32_16x16x32_bf16 v[156:159], a[136:139], a[20:23], v[156:159]
ds_read_b128 a[124:127], v6 offset:39936
v_mfma_f32_16x16x32_bf16 v[160:163], a[140:143], a[20:23], v[160:163]
buffer_load_dwordx4 a[12:15], v4, s[40:43], s35 offen offset:1024 sc1
v_mfma_f32_16x16x32_bf16 v[144:147], a[140:143], a[16:19], v[144:147]
s_waitcnt vmcnt(10) lgkmcnt(4)
v_mfma_f32_16x16x32_bf16 v[132:135], a[96:99], a[24:27], v[132:135]
s_cmp_eq_u32 s3, 6
s_cselect_b32 s35, 6, 30
s_lshl_b32 s35, s35, 12
v_mfma_f32_16x16x32_bf16 v[148:151], a[96:99], a[28:31], v[148:151]
ds_read_b128 a[128:131], v6 offset:40960
v_mfma_f32_16x16x32_bf16 v[152:155], a[100:103], a[28:31], v[152:155]
buffer_load_dwordx4 a[16:19], v4, s[40:43], s35 offen offset:0 sc1
v_mfma_f32_16x16x32_bf16 v[136:139], a[100:103], a[24:27], v[136:139]
ds_read_b128 a[132:135], v6 offset:41984
v_mfma_f32_16x16x32_bf16 v[140:143], a[104:107], a[24:27], v[140:143]
ds_read_b128 a[136:139], v6 offset:43008
v_mfma_f32_16x16x32_bf16 v[156:159], a[104:107], a[28:31], v[156:159]
ds_read_b128 a[140:143], v6 offset:44032
v_mfma_f32_16x16x32_bf16 v[160:163], a[108:111], a[28:31], v[160:163]
buffer_load_dwordx4 a[20:23], v4, s[40:43], s35 offen offset:1024 sc1
v_mfma_f32_16x16x32_bf16 v[144:147], a[108:111], a[24:27], v[144:147]
s_waitcnt vmcnt(10) lgkmcnt(4)
v_mfma_f32_16x16x32_bf16 v[132:135], a[112:115], a[32:35], v[132:135]
s_cmp_eq_u32 s3, 7
s_cselect_b32 s35, 7, 31
s_lshl_b32 s35, s35, 12
v_mfma_f32_16x16x32_bf16 v[148:151], a[112:115], a[36:39], v[148:151]
ds_read_b128 a[96:99], v6 offset:45056
v_mfma_f32_16x16x32_bf16 v[152:155], a[116:119], a[36:39], v[152:155]
buffer_load_dwordx4 a[24:27], v4, s[40:43], s35 offen offset:0 sc1
v_mfma_f32_16x16x32_bf16 v[136:139], a[116:119], a[32:35], v[136:139]
ds_read_b128 a[100:103], v6 offset:46080
v_mfma_f32_16x16x32_bf16 v[140:143], a[120:123], a[32:35], v[140:143]
ds_read_b128 a[104:107], v6 offset:47104
v_mfma_f32_16x16x32_bf16 v[156:159], a[120:123], a[36:39], v[156:159]
ds_read_b128 a[108:111], v6 offset:48128
v_mfma_f32_16x16x32_bf16 v[160:163], a[124:127], a[36:39], v[160:163]
buffer_load_dwordx4 a[28:31], v4, s[40:43], s35 offen offset:1024 sc1
v_mfma_f32_16x16x32_bf16 v[144:147], a[124:127], a[32:35], v[144:147]
s_waitcnt vmcnt(10) lgkmcnt(4)
v_mfma_f32_16x16x32_bf16 v[132:135], a[128:131], a[40:43], v[132:135]
ds_read_b128 a[112:115], v6 offset:49152
v_mfma_f32_16x16x32_bf16 v[148:151], a[128:131], a[44:47], v[148:151]
ds_read_b128 a[116:119], v6 offset:50176
v_mfma_f32_16x16x32_bf16 v[152:155], a[132:135], a[44:47], v[152:155]
ds_read_b128 a[120:123], v6 offset:51200
v_mfma_f32_16x16x32_bf16 v[136:139], a[132:135], a[40:43], v[136:139]
ds_read_b128 a[124:127], v6 offset:52224
v_mfma_f32_16x16x32_bf16 v[140:143], a[136:139], a[40:43], v[140:143]
v_mfma_f32_16x16x32_bf16 v[156:159], a[136:139], a[44:47], v[156:159]
v_mfma_f32_16x16x32_bf16 v[160:163], a[140:143], a[44:47], v[160:163]
v_mfma_f32_16x16x32_bf16 v[144:147], a[140:143], a[40:43], v[144:147]
s_waitcnt vmcnt(8) lgkmcnt(4)
v_mfma_f32_16x16x32_bf16 v[132:135], a[96:99], a[48:51], v[132:135]
ds_read_b128 a[128:131], v6 offset:53248
v_mfma_f32_16x16x32_bf16 v[148:151], a[96:99], a[52:55], v[148:151]
ds_read_b128 a[132:135], v6 offset:54272
v_mfma_f32_16x16x32_bf16 v[152:155], a[100:103], a[52:55], v[152:155]
ds_read_b128 a[136:139], v6 offset:55296
v_mfma_f32_16x16x32_bf16 v[136:139], a[100:103], a[48:51], v[136:139]
ds_read_b128 a[140:143], v6 offset:56320
v_mfma_f32_16x16x32_bf16 v[140:143], a[104:107], a[48:51], v[140:143]
v_mfma_f32_16x16x32_bf16 v[156:159], a[104:107], a[52:55], v[156:159]
v_mfma_f32_16x16x32_bf16 v[160:163], a[108:111], a[52:55], v[160:163]
v_mfma_f32_16x16x32_bf16 v[144:147], a[108:111], a[48:51], v[144:147]
s_waitcnt vmcnt(6) lgkmcnt(4)
v_mfma_f32_16x16x32_bf16 v[132:135], a[112:115], a[0:3], v[132:135]
ds_read_b128 a[96:99], v6 offset:57344
v_mfma_f32_16x16x32_bf16 v[148:151], a[112:115], a[4:7], v[148:151]
ds_read_b128 a[100:103], v6 offset:58368
v_mfma_f32_16x16x32_bf16 v[152:155], a[116:119], a[4:7], v[152:155]
ds_read_b128 a[104:107], v6 offset:59392
v_mfma_f32_16x16x32_bf16 v[136:139], a[116:119], a[0:3], v[136:139]
ds_read_b128 a[108:111], v6 offset:60416
v_mfma_f32_16x16x32_bf16 v[140:143], a[120:123], a[0:3], v[140:143]
v_mfma_f32_16x16x32_bf16 v[156:159], a[120:123], a[4:7], v[156:159]
v_mfma_f32_16x16x32_bf16 v[160:163], a[124:127], a[4:7], v[160:163]
v_mfma_f32_16x16x32_bf16 v[144:147], a[124:127], a[0:3], v[144:147]
s_waitcnt vmcnt(4) lgkmcnt(4)
v_mfma_f32_16x16x32_bf16 v[132:135], a[128:131], a[8:11], v[132:135]
ds_read_b128 a[112:115], v6 offset:61440
v_mfma_f32_16x16x32_bf16 v[148:151], a[128:131], a[12:15], v[148:151]
ds_read_b128 a[116:119], v6 offset:62464
v_mfma_f32_16x16x32_bf16 v[152:155], a[132:135], a[12:15], v[152:155]
ds_read_b128 a[120:123], v6 offset:63488
v_mfma_f32_16x16x32_bf16 v[136:139], a[132:135], a[8:11], v[136:139]
ds_read_b128 a[124:127], v6 offset:64512
v_mfma_f32_16x16x32_bf16 v[140:143], a[136:139], a[8:11], v[140:143]
v_mfma_f32_16x16x32_bf16 v[156:159], a[136:139], a[12:15], v[156:159]
v_mfma_f32_16x16x32_bf16 v[160:163], a[140:143], a[12:15], v[160:163]
v_mfma_f32_16x16x32_bf16 v[144:147], a[140:143], a[8:11], v[144:147]
s_waitcnt vmcnt(2) lgkmcnt(4)
v_mfma_f32_16x16x32_bf16 v[132:135], a[96:99], a[16:19], v[132:135]
v_mfma_f32_16x16x32_bf16 v[148:151], a[96:99], a[20:23], v[148:151]
v_mfma_f32_16x16x32_bf16 v[152:155], a[100:103], a[20:23], v[152:155]
v_mfma_f32_16x16x32_bf16 v[136:139], a[100:103], a[16:19], v[136:139]
v_mfma_f32_16x16x32_bf16 v[140:143], a[104:107], a[16:19], v[140:143]
v_mfma_f32_16x16x32_bf16 v[156:159], a[104:107], a[20:23], v[156:159]
v_mfma_f32_16x16x32_bf16 v[160:163], a[108:111], a[20:23], v[160:163]
v_mfma_f32_16x16x32_bf16 v[144:147], a[108:111], a[16:19], v[144:147]
s_waitcnt vmcnt(0) lgkmcnt(0)
v_mfma_f32_16x16x32_bf16 v[132:135], a[112:115], a[24:27], v[132:135]
v_mfma_f32_16x16x32_bf16 v[148:151], a[112:115], a[28:31], v[148:151]
v_mfma_f32_16x16x32_bf16 v[152:155], a[116:119], a[28:31], v[152:155]
buffer_atomic_add v12, v10, s[4:7], s92 offen sc1
v_mfma_f32_16x16x32_bf16 v[136:139], a[116:119], a[24:27], v[136:139]
v_mfma_f32_16x16x32_bf16 v[140:143], a[120:123], a[24:27], v[140:143]
v_mfma_f32_16x16x32_bf16 v[156:159], a[120:123], a[28:31], v[156:159]
v_mfma_f32_16x16x32_bf16 v[160:163], a[124:127], a[28:31], v[160:163]
v_mfma_f32_16x16x32_bf16 v[144:147], a[124:127], a[24:27], v[144:147]
s_nop 0
v_cmp_u_f32 vcc, v132, v148
s_nop 0
s_and_b32 vcc_lo, vcc_lo, s95
s_cbranch_scc1 L_k2redo3
s_and_b32 s36, s31, 7
s_lshl_b32 s36, s36, 7
s_lshl_b32 s37, s28, 5
s_add_u32 s36, s36, s37
s_lshl_b32 s36, s36, 1
s_lshr_b32 s37, s31, 3
s_add_u32 s36, s36, s37
s_lshl_b32 s36, s36, 11
s_lshl_b32 s37, s32, 7
v_and_b32 v234, 15, v0
s_add_u32 s36, s36, s37
v_lshrrev_b32 v233, 4, v0
v_lshl_add_u32 v232, v234, 12, s36
v_cvt_pk_bf16_f32 v32, v132, v133
v_cvt_pk_bf16_f32 v33, v134, v135
v_cvt_pk_bf16_f32 v34, v136, v137
v_cvt_pk_bf16_f32 v35, v138, v139
v_lshl_add_u32 v232, v233, 4, v232
buffer_store_dwordx4 v[32:35], v232, s[12:15], 0 offen offset:0
v_cvt_pk_bf16_f32 v36, v140, v141
v_cvt_pk_bf16_f32 v37, v142, v143
v_cvt_pk_bf16_f32 v38, v144, v145
v_cvt_pk_bf16_f32 v39, v146, v147
v_cvt_pk_bf16_f32 v40, v148, v149
v_cvt_pk_bf16_f32 v41, v150, v151
v_cvt_pk_bf16_f32 v42, v152, v153
v_cvt_pk_bf16_f32 v43, v154, v155
s_mov_b32 s36, 0x10000
v_cvt_pk_bf16_f32 v44, v156, v157
v_cvt_pk_bf16_f32 v45, v158, v159
v_cvt_pk_bf16_f32 v46, v160, v161
buffer_store_dwordx4 v[36:39], v232, s[12:15], 0 offen offset:64
v_cvt_pk_bf16_f32 v47, v162, v163
buffer_store_dwordx4 v[40:43], v232, s[12:15], s36 offen offset:0
buffer_store_dwordx4 v[44:47], v232, s[12:15], s36 offen offset:64
s_or_b32 s36, s2, s28
s_cbranch_scc1 Lep_47
s_mov_b32 s36, 0xf0000
buffer_store_dword v15, off, s[4:7], s36 sc1
Lep_47:
L_end:
s_endpgm
L_hxredo0:
s_mov_b32 s37, 0
L_hxredo0b:
s_sleep 2
buffer_load_dwordx4 v[228:231], v9, s[4:7], s55 offen sc1
buffer_load_dwordx4 v[72:75], v9, s[4:7], s55 offen offset:1024 sc1
s_waitcnt vmcnt(1)
v_max3_u32 v244, v228, v229, v230
s_waitcnt vmcnt(0)
v_max3_u32 v244, v244, v231, v72
v_max3_u32 v244, v244, v73, v74
v_max_u32 v244, v244, v75
v_cmp_eq_u32 vcc, -1, v244
s_cbranch_vccz L_hxback0
s_add_u32 s37, s37, 1
s_cmp_lt_u32 s37, 0x100000
s_cbranch_scc1 L_hxredo0b
s_branch L_hxback0
Ltr_9:
s_add_u32 s52, s67, 0xe0000
s_mov_b32 s53, 0
Ltp_10:
s_sleep 2
v_mov_b32 v11, v15
s_mov_b64 exec, 0xffff
v_mov_b32 v11, 0
buffer_atomic_add v11, v255, s[4:7], s52 offen sc0 sc1
s_mov_b64 exec, -1
s_add_u32 s53, s53, 1
s_waitcnt vmcnt(0)
v_cmp_ne_u32 vcc, v11, v15
s_cbranch_vccz Lte_11
s_cmp_lt_u32 s53, 0x100000
s_cbranch_scc1 Ltp_10
s_branch Lte_11
Ltr_12:
s_add_u32 s52, s66, 0xd0040
s_mov_b32 s53, 0
Ltp_13:
s_sleep 2
v_mov_b32 v232, v15
s_mov_b64 exec, 0xffff
v_mov_b32 v232, 0
buffer_atomic_add v232, v255, s[4:7], s52 offen sc0 sc1
s_mov_b64 exec, -1
s_add_u32 s53, s53, 1
s_waitcnt vmcnt(0)
v_cmp_ne_u32 vcc, v232, v15
s_cbranch_vccz Lte_14
s_cmp_lt_u32 s53, 0x100000
s_cbranch_scc1 Ltp_13
s_branch Lte_14
L_kvredo1:
s_mov_b32 s88, 0
L_kvredo1b:
v_max_u32 v132, v48, v49
v_max3_u32 v132, v132, v50, v51
v_max3_u32 v132, v132, v52, v53
v_max3_u32 v132, v132, v54, v55
v_max3_u32 v132, v132, v56, v57
v_max3_u32 v132, v132, v58, v59
v_max3_u32 v132, v132, v60, v61
v_max3_u32 v132, v132, v62, v63
v_max3_u32 v132, v132, v64, v65
v_max3_u32 v132, v132, v66, v67
v_max3_u32 v132, v132, v68, v69
v_max3_u32 v132, v132, v70, v71
v_max3_u32 v132, v132, v100, v101
v_max3_u32 v132, v132, v102, v103
v_max3_u32 v132, v132, v104, v105
v_max3_u32 v132, v132, v106, v107
v_max3_u32 v132, v132, v124, v125
v_max3_u32 v132, v132, v126, v127
v_cmp_eq_u32 vcc, -1, v132
s_cbranch_vccz L_kvback1
s_add_u32 s88, s88, 1
s_cmp_gt_u32 s88, 0x80000
s_cbranch_scc1 L_kvback1
s_sleep 4
buffer_load_dwordx4 v[48:51], v1, s[4:7], s98 offen offset:0 sc1
buffer_load_dwordx4 v[124:127], v248, s[4:7], s100 offen sc1
buffer_load_dwordx4 v[52:55], v1, s[4:7], s98 offen offset:1024 sc1
buffer_load_dwordx4 v[56:59], v1, s[4:7], s98 offen offset:2048 sc1
buffer_load_dwordx4 v[60:63], v1, s[4:7], s98 offen offset:3072 sc1
buffer_load_dwordx4 v[64:67], v1, s[4:7], s99 offen offset:0 sc1
buffer_load_dwordx4 v[68:71], v1, s[4:7], s99 offen offset:1024 sc1
buffer_load_dwordx4 v[100:103], v1, s[4:7], s99 offen offset:2048 sc1
buffer_load_dwordx4 v[104:107], v1, s[4:7], s99 offen offset:3072 sc1
s_waitcnt vmcnt(8)
v_lshlrev_b32 v92, 16, v48
v_and_b32 v93, 0xffff0000, v48
v_lshlrev_b32 v94, 16, v49
v_and_b32 v95, 0xffff0000, v49
v_lshlrev_b32 v96, 16, v50
v_and_b32 v97, 0xffff0000, v50
v_lshlrev_b32 v98, 16, v51
v_and_b32 v99, 0xffff0000, v51
s_waitcnt vmcnt(7)
v_add_f32_dpp v128, v124, v124 row_ror:4 row_mask:0xf bank_mask:0xf
v_add_f32_dpp v129, v125, v125 row_ror:4 row_mask:0xf bank_mask:0xf
v_add_f32_dpp v130, v126, v126 row_ror:4 row_mask:0xf bank_mask:0xf
v_add_f32_dpp v131, v127, v127 row_ror:4 row_mask:0xf bank_mask:0xf
v_add_f32_dpp v128, v128, v128 row_ror:2 row_mask:0xf bank_mask:0xf
v_add_f32_dpp v129, v129, v129 row_ror:2 row_mask:0xf bank_mask:0xf
v_add_f32_dpp v130, v130, v130 row_ror:2 row_mask:0xf bank_mask:0xf
v_add_f32_dpp v131, v131, v131 row_ror:2 row_mask:0xf bank_mask:0xf
v_add_f32_dpp v128, v128, v128 row_ror:1 row_mask:0xf bank_mask:0xf
v_add_f32_dpp v129, v129, v129 row_ror:1 row_mask:0xf bank_mask:0xf
v_add_f32_dpp v130, v130, v130 row_ror:1 row_mask:0xf bank_mask:0xf
v_add_f32_dpp v131, v131, v131 row_ror:1 row_mask:0xf bank_mask:0xf
s_waitcnt vmcnt(6)
v_dot2c_f32_bf16 v92, v52, v249
v_dot2c_f32_bf16 v93, v52, v250
v_dot2c_f32_bf16 v94, v53, v249
v_dot2c_f32_bf16 v95, v53, v250
v_dot2c_f32_bf16 v96, v54, v249
v_dot2c_f32_bf16 v97, v54, v250
v_dot2c_f32_bf16 v98, v55, v249
v_dot2c_f32_bf16 v99, v55, v250
s_waitcnt vmcnt(5)
v_dot2c_f32_bf16 v92, v56, v249
v_dot2c_f32_bf16 v93, v56, v250
v_dot2c_f32_bf16 v94, v57, v249
v_dot2c_f32_bf16 v95, v57, v250
v_dot2c_f32_bf16 v96, v58, v249
v_dot2c_f32_bf16 v97, v58, v250
v_dot2c_f32_bf16 v98, v59, v249
v_dot2c_f32_bf16 v99, v59, v250
s_waitcnt vmcnt(4)
v_dot2c_f32_bf16 v92, v60, v249
v_dot2c_f32_bf16 v93, v60, v250
v_dot2c_f32_bf16 v94, v61, v249
v_dot2c_f32_bf16 v95, v61, v250
v_dot2c_f32_bf16 v96, v62, v249
v_dot2c_f32_bf16 v97, v62, v250
v_dot2c_f32_bf16 v98, v63, v249
v_dot2c_f32_bf16 v99, v63, v250
s_waitcnt vmcnt(3)
v_dot2c_f32_bf16 v92, v64, v249
v_dot2c_f32_bf16 v93, v64, v250
v_dot2c_f32_bf16 v94, v65, v249
v_dot2c_f32_bf16 v95, v65, v250
v_dot2c_f32_bf16 v96, v66, v249
v_dot2c_f32_bf16 v97, v66, v250
v_dot2c_f32_bf16 v98, v67, v249
v_dot2c_f32_bf16 v99, v67, v250
s_waitcnt vmcnt(2)
v_dot2c_f32_bf16 v92, v68, v249
v_dot2c_f32_bf16 v93, v68, v250
v_dot2c_f32_bf16 v94, v69, v249
v_dot2c_f32_bf16 v95, v69, v250
v_dot2c_f32_bf16 v96, v70, v249
v_dot2c_f32_bf16 v97, v70, v250
v_dot2c_f32_bf16 v98, v71, v249
v_dot2c_f32_bf16 v99, v71, v250
s_waitcnt vmcnt(1)
v_dot2c_f32_bf16 v92, v100, v249
v_dot2c_f32_bf16 v93, v100, v250
v_dot2c_f32_bf16 v94, v101, v249
v_dot2c_f32_bf16 v95, v101, v250
v_dot2c_f32_bf16 v96, v102, v249
v_dot2c_f32_bf16 v97, v102, v250
v_dot2c_f32_bf16 v98, v103, v249
v_dot2c_f32_bf16 v99, v103, v250
s_waitcnt vmcnt(0)
v_dot2c_f32_bf16 v92, v104, v249
v_dot2c_f32_bf16 v93, v104, v250
v_dot2c_f32_bf16 v94, v105, v249
v_dot2c_f32_bf16 v95, v105, v250
v_dot2c_f32_bf16 v96, v106, v249
v_dot2c_f32_bf16 v97, v106, v250
v_dot2c_f32_bf16 v98, v107, v249
v_dot2c_f32_bf16 v99, v107, v250
s_nop 2
s_branch L_kvredo1b
L_k2redo1:
s_mov_b32 s95, 0
s_mov_b32 s92, 0x40000000
s_mov_b32 s93, 0x40000000
s_mov_b32 s94, 0x40000000
s_add_u32 s36, s66, 0x10000
s_mov_b32 s37, 0
Lpoll_48:
v_mov_b32 v11, 0
buffer_atomic_add v11, v251, s[4:7], s36 offen sc0 sc1
s_add_u32 s37, s37, 1
s_waitcnt vmcnt(0)
v_readfirstlane_b32 s38, v11
s_nop 0
s_cmp_ge_u32 s38, 32
s_cbranch_scc1 Lpe_49
s_cmp_lt_u32 s37, 0x100000
s_cbranch_scc1 Lpoll_48
Lpe_49:
s_nop 7
s_cmp_eq_u32 s3, 0
s_cselect_b32 s35, 8, 0
s_lshl_b32 s35, s35, 12
v_lshlrev_b32 v132, 16, v32
v_and_b32 v133, 0xffff0000, v32
v_lshlrev_b32 v134, 16, v33
v_and_b32 v135, 0xffff0000, v33
v_lshlrev_b32 v136, 16, v34
v_and_b32 v137, 0xffff0000, v34
v_lshlrev_b32 v138, 16, v35
v_and_b32 v139, 0xffff0000, v35
v_lshlrev_b32 v140, 16, v36
v_and_b32 v141, 0xffff0000, v36
v_lshlrev_b32 v142, 16, v37
v_and_b32 v143, 0xffff0000, v37
v_lshlrev_b32 v144, 16, v38
v_and_b32 v145, 0xffff0000, v38
v_lshlrev_b32 v146, 16, v39
v_and_b32 v147, 0xffff0000, v39
v_lshlrev_b32 v148, 16, v40
v_and_b32 v149, 0xffff0000, v40
v_lshlrev_b32 v150, 16, v41
v_and_b32 v151, 0xffff0000, v41
v_lshlrev_b32 v152, 16, v42
v_and_b32 v153, 0xffff0000, v42
v_lshlrev_b32 v154, 16, v43
v_and_b32 v155, 0xffff0000, v43
v_lshlrev_b32 v156, 16, v44
v_and_b32 v157, 0xffff0000, v44
v_lshlrev_b32 v158, 16, v45
v_and_b32 v159, 0xffff0000, v45
v_lshlrev_b32 v160, 16, v46
v_and_b32 v161, 0xffff0000, v46
v_lshlrev_b32 v162, 16, v47
v_and_b32 v163, 0xffff0000, v47
s_branch L_k2go1
L_hxredo2:
s_mov_b32 s37, 0
L_hxredo2b:
s_sleep 2
buffer_load_dwordx4 v[228:231], v9, s[4:7], s55 offen sc1
buffer_load_dwordx4 v[72:75], v9, s[4:7], s55 offen offset:1024 sc1
s_waitcnt vmcnt(1)
v_max3_u32 v244, v228, v229, v230
s_waitcnt vmcnt(0)
v_max3_u32 v244, v244, v231, v72
v_max3_u32 v244, v244, v73, v74
v_max_u32 v244, v244, v75
v_cmp_eq_u32 vcc, -1, v244
s_cbranch_vccz L_hxback2
s_add_u32 s37, s37, 1
s_cmp_lt_u32 s37, 0x100000
s_cbranch_scc1 L_hxredo2b
s_branch L_hxback2
L_k2redo2:
s_mov_b32 s95, 0
s_mov_b32 s92, 0x40000000
s_mov_b32 s93, 0x40000000
s_mov_b32 s94, 0x40000000
s_add_u32 s36, s66, 0x20000
s_mov_b32 s37, 0
Lpoll_50:
v_mov_b32 v11, 0
buffer_atomic_add v11, v251, s[4:7], s36 offen sc0 sc1
s_add_u32 s37, s37, 1
s_waitcnt vmcnt(0)
v_readfirstlane_b32 s38, v11
s_nop 0
s_cmp_ge_u32 s38, 32
s_cbranch_scc1 Lpe_51
s_cmp_lt_u32 s37, 0x100000
s_cbranch_scc1 Lpoll_50
Lpe_51:
s_nop 7
s_cmp_eq_u32 s3, 0
s_cselect_b32 s35, 8, 0
s_lshl_b32 s35, s35, 12
v_lshlrev_b32 v132, 16, v32
v_and_b32 v133, 0xffff0000, v32
v_lshlrev_b32 v134, 16, v33
v_and_b32 v135, 0xffff0000, v33
v_lshlrev_b32 v136, 16, v34
v_and_b32 v137, 0xffff0000, v34
v_lshlrev_b32 v138, 16, v35
v_and_b32 v139, 0xffff0000, v35
v_lshlrev_b32 v140, 16, v36
v_and_b32 v141, 0xffff0000, v36
v_lshlrev_b32 v142, 16, v37
v_and_b32 v143, 0xffff0000, v37
v_lshlrev_b32 v144, 16, v38
v_and_b32 v145, 0xffff0000, v38
v_lshlrev_b32 v146, 16, v39
v_and_b32 v147, 0xffff0000, v39
v_lshlrev_b32 v148, 16, v40
v_and_b32 v149, 0xffff0000, v40
v_lshlrev_b32 v150, 16, v41
v_and_b32 v151, 0xffff0000, v41
v_lshlrev_b32 v152, 16, v42
v_and_b32 v153, 0xffff0000, v42
v_lshlrev_b32 v154, 16, v43
v_and_b32 v155, 0xffff0000, v43
v_lshlrev_b32 v156, 16, v44
v_and_b32 v157, 0xffff0000, v44
v_lshlrev_b32 v158, 16, v45
v_and_b32 v159, 0xffff0000, v45
v_lshlrev_b32 v160, 16, v46
v_and_b32 v161, 0xffff0000, v46
v_lshlrev_b32 v162, 16, v47
v_and_b32 v163, 0xffff0000, v47
s_branch L_k2go2
L_kvredo3:
s_mov_b32 s88, 0
L_kvredo3b:
v_max_u32 v132, v48, v49
v_max3_u32 v132, v132, v50, v51
v_max3_u32 v132, v132, v52, v53
v_max3_u32 v132, v132, v54, v55
v_max3_u32 v132, v132, v56, v57
v_max3_u32 v132, v132, v58, v59
v_max3_u32 v132, v132, v60, v61
v_max3_u32 v132, v132, v62, v63
v_max3_u32 v132, v132, v64, v65
v_max3_u32 v132, v132, v66, v67
v_max3_u32 v132, v132, v68, v69
v_max3_u32 v132, v132, v70, v71
v_max3_u32 v132, v132, v100, v101
v_max3_u32 v132, v132, v102, v103
v_max3_u32 v132, v132, v104, v105
v_max3_u32 v132, v132, v106, v107
v_max3_u32 v132, v132, v124, v125
v_max3_u32 v132, v132, v126, v127
v_cmp_eq_u32 vcc, -1, v132
s_cbranch_vccz L_kvback3
s_add_u32 s88, s88, 1
s_cmp_gt_u32 s88, 0x80000
s_cbranch_scc1 L_kvback3
s_sleep 4
buffer_load_dwordx4 v[48:51], v1, s[4:7], s98 offen offset:0 sc1
buffer_load_dwordx4 v[124:127], v248, s[4:7], s100 offen sc1
buffer_load_dwordx4 v[52:55], v1, s[4:7], s98 offen offset:1024 sc1
buffer_load_dwordx4 v[56:59], v1, s[4:7], s98 offen offset:2048 sc1
buffer_load_dwordx4 v[60:63], v1, s[4:7], s98 offen offset:3072 sc1
buffer_load_dwordx4 v[64:67], v1, s[4:7], s99 offen offset:0 sc1
buffer_load_dwordx4 v[68:71], v1, s[4:7], s99 offen offset:1024 sc1
buffer_load_dwordx4 v[100:103], v1, s[4:7], s99 offen offset:2048 sc1
buffer_load_dwordx4 v[104:107], v1, s[4:7], s99 offen offset:3072 sc1
s_waitcnt vmcnt(8)
v_lshlrev_b32 v92, 16, v48
v_and_b32 v93, 0xffff0000, v48
v_lshlrev_b32 v94, 16, v49
v_and_b32 v95, 0xffff0000, v49
v_lshlrev_b32 v96, 16, v50
v_and_b32 v97, 0xffff0000, v50
v_lshlrev_b32 v98, 16, v51
v_and_b32 v99, 0xffff0000, v51
s_waitcnt vmcnt(7)
v_add_f32_dpp v128, v124, v124 row_ror:4 row_mask:0xf bank_mask:0xf
v_add_f32_dpp v129, v125, v125 row_ror:4 row_mask:0xf bank_mask:0xf
v_add_f32_dpp v130, v126, v126 row_ror:4 row_mask:0xf bank_mask:0xf
v_add_f32_dpp v131, v127, v127 row_ror:4 row_mask:0xf bank_mask:0xf
v_add_f32_dpp v128, v128, v128 row_ror:2 row_mask:0xf bank_mask:0xf
v_add_f32_dpp v129, v129, v129 row_ror:2 row_mask:0xf bank_mask:0xf
v_add_f32_dpp v130, v130, v130 row_ror:2 row_mask:0xf bank_mask:0xf
v_add_f32_dpp v131, v131, v131 row_ror:2 row_mask:0xf bank_mask:0xf
v_add_f32_dpp v128, v128, v128 row_ror:1 row_mask:0xf bank_mask:0xf
v_add_f32_dpp v129, v129, v129 row_ror:1 row_mask:0xf bank_mask:0xf
v_add_f32_dpp v130, v130, v130 row_ror:1 row_mask:0xf bank_mask:0xf
v_add_f32_dpp v131, v131, v131 row_ror:1 row_mask:0xf bank_mask:0xf
s_waitcnt vmcnt(6)
v_dot2c_f32_bf16 v92, v52, v249
v_dot2c_f32_bf16 v93, v52, v250
v_dot2c_f32_bf16 v94, v53, v249
v_dot2c_f32_bf16 v95, v53, v250
v_dot2c_f32_bf16 v96, v54, v249
v_dot2c_f32_bf16 v97, v54, v250
v_dot2c_f32_bf16 v98, v55, v249
v_dot2c_f32_bf16 v99, v55, v250
s_waitcnt vmcnt(5)
v_dot2c_f32_bf16 v92, v56, v249
v_dot2c_f32_bf16 v93, v56, v250
v_dot2c_f32_bf16 v94, v57, v249
v_dot2c_f32_bf16 v95, v57, v250
v_dot2c_f32_bf16 v96, v58, v249
v_dot2c_f32_bf16 v97, v58, v250
v_dot2c_f32_bf16 v98, v59, v249
v_dot2c_f32_bf16 v99, v59, v250
s_waitcnt vmcnt(4)
v_dot2c_f32_bf16 v92, v60, v249
v_dot2c_f32_bf16 v93, v60, v250
v_dot2c_f32_bf16 v94, v61, v249
v_dot2c_f32_bf16 v95, v61, v250
v_dot2c_f32_bf16 v96, v62, v249
v_dot2c_f32_bf16 v97, v62, v250
v_dot2c_f32_bf16 v98, v63, v249
v_dot2c_f32_bf16 v99, v63, v250
s_waitcnt vmcnt(3)
v_dot2c_f32_bf16 v92, v64, v249
v_dot2c_f32_bf16 v93, v64, v250
v_dot2c_f32_bf16 v94, v65, v249
v_dot2c_f32_bf16 v95, v65, v250
v_dot2c_f32_bf16 v96, v66, v249
v_dot2c_f32_bf16 v97, v66, v250
v_dot2c_f32_bf16 v98, v67, v249
v_dot2c_f32_bf16 v99, v67, v250
s_waitcnt vmcnt(2)
v_dot2c_f32_bf16 v92, v68, v249
v_dot2c_f32_bf16 v93, v68, v250
v_dot2c_f32_bf16 v94, v69, v249
v_dot2c_f32_bf16 v95, v69, v250
v_dot2c_f32_bf16 v96, v70, v249
v_dot2c_f32_bf16 v97, v70, v250
v_dot2c_f32_bf16 v98, v71, v249
v_dot2c_f32_bf16 v99, v71, v250
s_waitcnt vmcnt(1)
v_dot2c_f32_bf16 v92, v100, v249
v_dot2c_f32_bf16 v93, v100, v250
v_dot2c_f32_bf16 v94, v101, v249
v_dot2c_f32_bf16 v95, v101, v250
v_dot2c_f32_bf16 v96, v102, v249
v_dot2c_f32_bf16 v97, v102, v250
v_dot2c_f32_bf16 v98, v103, v249
v_dot2c_f32_bf16 v99, v103, v250
s_waitcnt vmcnt(0)
v_dot2c_f32_bf16 v92, v104, v249
v_dot2c_f32_bf16 v93, v104, v250
v_dot2c_f32_bf16 v94, v105, v249
v_dot2c_f32_bf16 v95, v105, v250
v_dot2c_f32_bf16 v96, v106, v249
v_dot2c_f32_bf16 v97, v106, v250
v_dot2c_f32_bf16 v98, v107, v249
v_dot2c_f32_bf16 v99, v107, v250
s_nop 2
s_branch L_kvredo3b
L_k2redo3:
s_mov_b32 s95, 0
s_mov_b32 s92, 0x40000000
s_mov_b32 s93, 0x40000000
s_mov_b32 s94, 0x40000000
s_add_u32 s36, s66, 0x30000
s_mov_b32 s37, 0
Lpoll_52:
v_mov_b32 v11, 0
buffer_atomic_add v11, v251, s[4:7], s36 offen sc0 sc1
s_add_u32 s37, s37, 1
s_waitcnt vmcnt(0)
v_readfirstlane_b32 s38, v11
s_nop 0
s_cmp_ge_u32 s38, 32
s_cbranch_scc1 Lpe_53
s_cmp_lt_u32 s37, 0x100000
s_cbranch_scc1 Lpoll_52
Lpe_53:
s_nop 7
s_cmp_eq_u32 s3, 0
s_cselect_b32 s35, 8, 0
s_lshl_b32 s35, s35, 12
v_lshlrev_b32 v132, 16, v32
v_and_b32 v133, 0xffff0000, v32
v_lshlrev_b32 v134, 16, v33
v_and_b32 v135, 0xffff0000, v33
v_lshlrev_b32 v136, 16, v34
v_and_b32 v137, 0xffff0000, v34
v_lshlrev_b32 v138, 16, v35
v_and_b32 v139, 0xffff0000, v35
v_lshlrev_b32 v140, 16, v36
v_and_b32 v141, 0xffff0000, v36
v_lshlrev_b32 v142, 16, v37
v_and_b32 v143, 0xffff0000, v37
v_lshlrev_b32 v144, 16, v38
v_and_b32 v145, 0xffff0000, v38
v_lshlrev_b32 v146, 16, v39
v_and_b32 v147, 0xffff0000, v39
v_lshlrev_b32 v148, 16, v40
v_and_b32 v149, 0xffff0000, v40
v_lshlrev_b32 v150, 16, v41
v_and_b32 v151, 0xffff0000, v41
v_lshlrev_b32 v152, 16, v42
v_and_b32 v153, 0xffff0000, v42
v_lshlrev_b32 v154, 16, v43
v_and_b32 v155, 0xffff0000, v43
v_lshlrev_b32 v156, 16, v44
v_and_b32 v157, 0xffff0000, v44
v_lshlrev_b32 v158, 16, v45
v_and_b32 v159, 0xffff0000, v45
v_lshlrev_b32 v160, 16, v46
v_and_b32 v161, 0xffff0000, v46
v_lshlrev_b32 v162, 16, v47
v_and_b32 v163, 0xffff0000, v47
s_branch L_k2go3
L_code_end:
.section .rodata,"a"
.p2align 6
.amdhsa_kernel interleave_layers__sliding_local_dilated__linear_kernel_hedgehog__prompt_kernel
  .amdhsa_next_free_vgpr 512
  .amdhsa_next_free_sgpr 102
  .amdhsa_accum_offset 256
  .amdhsa_group_segment_fixed_size 0
  .amdhsa_kernarg_size 80
  .amdhsa_user_sgpr_count 2
  .amdhsa_user_sgpr_kernarg_segment_ptr 1
  .amdhsa_system_sgpr_workgroup_id_x 1
.end_amdhsa_kernel
```

```asm
; @launch grid=(256,1,1) block=(256,1,1) lds=163840
.amdgcn_target "amdgcn-amd-amdhsa--gfx950"
.text
.globl interleave_layers__sliding_local_dilated__linear_kernel_hedgehog__prompt_kernel
.p2align 8
.type interleave_layers__sliding_local_dilated__linear_kernel_hedgehog__prompt_kernel,@function
interleave_layers__sliding_local_dilated__linear_kernel_hedgehog__prompt_kernel:
s_cmp_ge_u32 s2, 256
s_cbranch_scc1 L_end
s_load_dwordx16 s[64:79], s[0:1], 0
s_load_dwordx4 s[80:83], s[0:1], 64
s_getpc_b64 s[24:25]
s_mov_b32 s26, (L_end - interleave_layers__sliding_local_dilated__linear_kernel_hedgehog__prompt_kernel - 64)
s_mov_b32 s27, 0x20000
v_lshlrev_b32 v1, 5, v0
buffer_load_dword v238, v1, s[24:27], 0 offen
v_lshrrev_b32 v1, 6, v0
v_and_b32 v0, 63, v0
v_readfirstlane_b32 s28, v1
s_and_b32 s36, s2, 7
s_lshr_b32 s37, s2, 3
s_and_b32 s38, s37, 3
s_lshr_b32 s39, s37, 2
s_and_b32 s29, s36, 1
s_lshl_b32 s32, s29, 3
s_lshl_b32 s29, s29, 2
s_add_u32 s29, s29, s38
s_add_u32 s32, s32, s39
s_lshr_b32 s36, s36, 1
s_lshl_b32 s30, s36, 3
s_add_u32 s30, s30, s39
s_lshl_b32 s31, s36, 2
s_add_u32 s31, s31, s38
s_and_b32 s32, s36, 1
s_lshl_b32 s32, s32, 3
s_add_u32 s32, s32, s39
s_and_b32 s31, s2, 1
s_lshl_b32 s31, s31, 3
s_add_u32 s31, s31, s38
s_and_b32 s3, s2, 4
s_add_u32 s31, s31, s3
s_and_b32 s29, s2, 4
s_lshl_b32 s31, s29, 1
s_add_u32 s29, s29, s38
s_and_b32 s30, s2, 3
s_lshl_b32 s30, s30, 3
s_add_u32 s30, s30, s39
s_and_b32 s3, s2, 2
s_lshl_b32 s3, s3, 1
s_add_u32 s31, s31, s3
s_add_u32 s31, s31, s38
s_and_b32 s32, s2, 1
s_lshl_b32 s32, s32, 3
s_add_u32 s32, s32, s39
s_mov_b32 s3, s39
s_and_b32 s35, s2, 7
s_lshl_b32 s35, s35, 5
s_add_u32 s35, s35, s37
s_mul_i32 s33, s39, 0
s_and_b32 s33, s33, 31
v_lshlrev_b32 v1, 4, v0
v_lshrrev_b32 v233, 4, v0
v_and_b32 v234, 15, v0
s_and_b32 s88, s31, 7
s_lshl_b32 s88, s88, 7
s_lshl_b32 s37, s28, 5
s_add_u32 s88, s88, s37
s_lshl_b32 s88, s88, 1
s_lshr_b32 s37, s31, 3
s_add_u32 s88, s88, s37
s_lshl_b32 s88, s88, 11
s_lshl_b32 s37, s32, 7
s_add_u32 s88, s88, s37
v_lshrrev_b32 v235, 3, v0
v_and_b32 v236, 7, v0
v_xor_b32 v232, v236, v233
v_lshlrev_b32 v232, 4, v232
v_lshl_add_u32 v232, v235, 12, v232
v_xor_b32 v246, 64, v232
v_lshlrev_b32 v236, 4, v236
v_lshl_add_u32 v237, v235, 11, v236
v_mul_u32_u24 v235, 6144, v235
v_add_u32 v235, v235, v236
s_lshr_b32 s36, s35, 4
s_lshl_b32 s36, s36, 2
s_add_u32 s36, s36, s28
s_mul_i32 s36, s36, 98304
s_and_b32 s37, s35, 15
s_lshl_b32 s37, s37, 7
s_add_u32 s36, s36, s37
s_lshl_b32 s37, s28, 11
s_mov_b32 s39, 0x10000
s_mov_b32 s10, 0x400000
s_mov_b32 s11, 0x20000
s_mov_b32 s22, 0x600000
s_mov_b32 s23, 0x20000
s_mov_b32 s6, 0x10000000
s_mov_b32 s7, 0x20000
s_mov_b32 s44, 0xf0000
s_waitcnt lgkmcnt(0)
s_mov_b64 s[8:9], s[64:65]
s_mov_b64 s[20:21], s[66:67]
s_lshl_b32 s39, s37, 1
s_add_u32 m0, s37, 0
s_add_u32 s38, s36, 0
buffer_load_dwordx4 v235, s[20:23], s38 offen nt lds
s_add_u32 m0, s37, 1024
s_add_u32 s38, s36, 49152
buffer_load_dwordx4 v235, s[20:23], s38 offen nt lds
s_add_u32 m0, s37, 8192
s_add_u32 s38, s36, 2048
buffer_load_dwordx4 v235, s[20:23], s38 offen nt lds
s_add_u32 m0, s37, 9216
s_add_u32 s38, s36, 51200
buffer_load_dwordx4 v235, s[20:23], s38 offen nt lds
s_add_u32 m0, s37, 16384
s_add_u32 s38, s36, 4096
buffer_load_dwordx4 v235, s[20:23], s38 offen nt lds
s_add_u32 m0, s37, 17408
s_add_u32 s38, s36, 53248
buffer_load_dwordx4 v235, s[20:23], s38 offen nt lds
s_add_u32 m0, s39, 24576
s_add_u32 s38, s88, 0
buffer_load_dwordx4 v232, s[8:11], s38 offen nt lds
s_add_u32 m0, s39, 25600
s_add_u32 s38, s88, 32768
buffer_load_dwordx4 v246, s[8:11], s38 offen nt lds
s_add_u32 m0, s39, 26624
s_add_u32 s38, s88, 65536
buffer_load_dwordx4 v232, s[8:11], s38 offen nt lds
s_add_u32 m0, s39, 27648
s_add_u32 s38, s88, 98304
buffer_load_dwordx4 v246, s[8:11], s38 offen nt lds
s_mov_b32 s37, s39
v_lshrrev_b32 v232, 1, v234
v_xor_b32 v232, v232, v233
v_lshlrev_b32 v232, 4, v232
v_lshl_add_u32 v232, v234, 7, v232
v_add_u32 v232, s37, v232
s_add_u32 s4, s82, 0x0
s_addc_u32 s5, s83, 0
s_mov_b64 s[92:93], s[80:81]
s_mov_b32 s12, s78
s_mov_b32 s13, s79
s_mov_b32 s14, 0x400000
s_mov_b32 s15, 0x20000
s_mov_b32 s42, 0x400000
s_mov_b32 s43, 0x20000
v_mov_b32 v12, 1
s_mov_b64 s[40:41], s[12:13]
s_mov_b32 s64, 0xff
s_mov_b32 s65, 0
s_and_b32 s81, s29, 3
s_lshl_b32 s66, s31, 4
s_add_u32 s66, s66, s32
s_lshl_b32 s66, s66, 8
s_lshl_b32 s67, s29, 5
s_add_u32 s67, s67, s30
s_lshl_b32 s67, s67, 8
s_lshl_b32 s80, s30, 11
s_lshl_b32 s70, s29, 8
s_add_u32 s70, s70, s80
s_lshl_b32 s71, s29, 13
s_lshr_b32 s78, s31, 1
s_lshl_b32 s78, s78, 13
s_add_u32 s79, s78, 8192
s_bitcmp1_b32 s31, 0
s_cselect_b32 s79, s79, 0x40000000
s_and_b32 s36, s31, 7
s_cmp_eq_u32 s36, 7
s_cselect_b32 s79, 0x40000000, s79
v_mov_b32 v240, 0
v_mov_b32 v241, 0
v_mov_b32 v242, 0
v_mov_b32 v243, 0
v_mov_b32 v228, v235
v_mov_b32 v229, v237
s_lshr_b32 s36, s35, 4
s_lshl_b32 s36, s36, 2
s_add_u32 s36, s36, s28
s_and_b32 s37, s35, 15
s_lshl_b32 s37, s37, 7
s_lshl_b32 s16, s36, 15
s_add_u32 s16, s16, s37
s_mul_i32 s17, s36, 98304
s_add_u32 s17, s17, s37
v_mov_b32 v16, 0x3f803f80
v_mov_b32 v17, 0x3f803f80
v_mov_b32 v18, 0x3f803f80
v_mov_b32 v19, 0x3f803f80
s_mov_b32 s46, 0xaaaaaaaa
s_mov_b32 s47, 0xaaaaaaaa
s_mov_b32 s48, 0xcccccccc
s_mov_b32 s49, 0xcccccccc
s_lshl_b32 s36, s31, 1
s_lshr_b32 s37, s28, 1
s_add_u32 s36, s36, s37
s_mul_i32 s36, s36, 131072
s_and_b32 s37, s28, 1
s_lshl_b32 s37, s37, 11
s_add_u32 s36, s36, s37
v_add_u32 v4, s36, v1
s_lshl_b32 s38, s31, 2
s_add_u32 s38, s38, s28
s_lshl_b32 s38, s38, 12
s_lshl_b32 s39, s32, 7
s_add_u32 s38, s38, s39
v_lshrrev_b32 v244, 2, v234
v_cmp_eq_u32 vcc, v244, v233
v_and_b32 v244, 7, v234
v_lshl_add_u32 v244, v244, 4, s38
v_and_b32 v245, 8, v234
v_add_u32 v244, v244, v245
v_cndmask_b32 v253, 2.0, v244, vcc
v_lshlrev_b32 v244, 4, v233
v_lshl_add_u32 v244, v234, 6, v244
v_cmp_gt_u32 vcc, 2, v234
s_nop 1
v_cndmask_b32 v254, 2.0, v244, vcc
v_lshrrev_b32 v248, 4, v0
v_lshlrev_b32 v248, 10, v248
v_bfe_u32 v249, v0, 2, 2
v_lshl_add_u32 v248, v249, 7, v248
v_and_b32 v251, 3, v0
v_lshl_add_u32 v248, v251, 3, v248
s_lshr_b32 s36, s28, 1
s_lshl_b32 s36, s36, 6
s_and_b32 s37, s28, 1
s_mul_i32 s38, s37, 8224
s_add_u32 s38, s38, s36
s_mul_i32 s39, s37, 16352
s_add_u32 s39, s39, s36
v_add_u32 v249, s39, v248
v_add_u32 v248, s38, v248
s_and_b32 s38, s35, 15
s_lshl_b32 s38, s38, 1
s_lshr_b32 s36, s28, 1
s_add_u32 s38, s38, s36
s_lshr_b32 s36, s35, 4
s_mul_i32 s96, s38, 196608
s_lshr_b32 s44, s36, 3
s_mul_i32 s44, s44, 98304
s_add_u32 s96, s96, s44
s_add_u32 s96, s96, 0x2c00000
s_and_b32 s44, s36, 7
s_mul_i32 s97, s44, 12288
s_mul_i32 s44, s37, 3072
s_add_u32 s97, s97, s44
s_mul_i32 s38, s38, 6
s_mul_i32 s37, s37, 3
s_add_u32 s38, s38, s37
s_lshl_b32 s38, s38, 11
s_lshl_b32 s36, s36, 7
s_add_u32 s38, s38, s36
s_add_u32 s98, s38, 0x300000
s_add_u32 s99, s98, 4096
v_lshrrev_b32 v247, 2, v0
v_lshlrev_b32 v250, 7, v247
v_lshl_add_u32 v250, v251, 4, v250
s_lshr_b32 s36, s28, 1
s_lshl_b32 s36, s36, 12
s_and_b32 s37, s28, 1
s_lshl_b32 s37, s37, 6
s_add_u32 s36, s36, s37
s_add_u32 s36, s36, 147456
v_add_u32 v250, s36, v250
v_subrev_u32 v230, 122880, v250
s_and_b32 s36, s35, 15
s_lshl_b32 s36, s36, 17
s_lshr_b32 s37, s35, 4
s_lshl_b32 s37, s37, 13
s_add_u32 s36, s36, s37
s_lshl_b32 s37, s28, 11
s_add_u32 s36, s36, s37
s_add_u32 s100, s36, 0xa00000
s_add_u32 s101, s36, 0xc00000
v_lshlrev_b32 v247, 6, v247
v_lshl_add_u32 v251, v251, 3, v247
v_add_u32 v251, 155648, v251
v_xor_b32 v236, 64, v232
s_mov_b64 s[20:21], s[68:69]
s_mov_b32 s22, 0x200000
s_lshl_b32 s37, s28, 11
s_add_u32 m0, s37, 147456
s_add_u32 s36, s16, 0
buffer_load_dwordx4 v229, s[20:23], s36 offen nt lds
s_add_u32 m0, s37, 148480
s_add_u32 s36, s16, 16384
buffer_load_dwordx4 v229, s[20:23], s36 offen nt lds
s_add_u32 s36, s67, 0xc0000
s_add_u32 s37, s66, 0xd0000
s_cmp_eq_u32 s28, 2
s_cselect_b32 s36, s37, s36
s_cmp_eq_u32 s28, 1
s_cselect_b32 s37, 128, 0
s_add_u32 s36, s36, s37
s_cmp_eq_u32 s28, 3
s_cselect_b32 s37, 0x20000, 0
s_add_u32 s36, s36, s37
s_mov_b64 exec, 1
buffer_atomic_add v240, off, s[4:7], s36 sc1
s_mov_b64 exec, -1
s_mov_b32 s36, 0xf0000
buffer_load_dword v11, off, s[4:7], s36 sc1
s_lshr_b32 s36, s2, 3
s_lshl_b32 s36, s36, 2
s_add_u32 s36, s36, s28
s_lshl_b32 s36, s36, 10
buffer_load_dwordx4 a[0:3], v1, s[24:27], s36 offen
s_mov_b64 s[24:25], s[92:93]
s_mov_b32 s26, 256
s_mov_b64 s[20:21], s[74:75]
s_mov_b32 s22, 0x10000
s_and_b32 s36, s28, 1
s_lshl_b32 s36, s36, 10
s_add_u32 m0, s36, 155648
s_lshl_b32 s37, s30, 11
s_add_u32 s36, s36, s37
buffer_load_dwordx4 v1, s[20:23], s36 offen lds
s_waitcnt vmcnt(6)
ds_read_b128 v[32:35], v232 offset:24576
ds_read_b128 v[36:39], v236 offset:24576
ds_read_b128 v[40:43], v232 offset:26624
ds_read_b128 v[44:47], v236 offset:26624
s_barrier
ds_read_b64_tr_b16 a[188:189], v248 offset:0
ds_read_b64_tr_b16 a[190:191], v248 offset:512
ds_read_b64_tr_b16 a[192:193], v248 offset:4096
ds_read_b64_tr_b16 a[194:195], v248 offset:4608
ds_read_b64_tr_b16 a[196:197], v249 offset:32
ds_read_b64_tr_b16 a[198:199], v249 offset:544
ds_read_b64_tr_b16 a[200:201], v249 offset:4128
ds_read_b64_tr_b16 a[202:203], v249 offset:4640
ds_read_b64_tr_b16 a[204:205], v248 offset:8192
ds_read_b64_tr_b16 a[206:207], v248 offset:8704
ds_read_b64_tr_b16 a[208:209], v248 offset:12288
ds_read_b64_tr_b16 a[210:211], v248 offset:12800
s_lshl_b32 s36, s32, 13
s_add_u32 s36, s36, 0x0
s_add_u32 s37, s36, 4096
s_mov_b32 s38, 0x200000
s_waitcnt lgkmcnt(14)
v_mfma_f32_16x16x32_bf16 v[96:99], v[32:35], v[32:35], 0
v_mfma_f32_16x16x32_bf16 v[92:95], v[16:19], v[32:35], 0
buffer_store_dwordx4 v[32:35], v4, s[12:15], s36 offen offset:0 sc1
s_waitcnt lgkmcnt(13)
v_mfma_f32_16x16x32_bf16 v[104:107], v[40:43], v[40:43], 0
v_mfma_f32_16x16x32_bf16 v[100:103], v[16:19], v[40:43], 0
buffer_store_dwordx4 v[40:43], v4, s[12:15], s36 offen offset:1024 sc1
v_mfma_f32_16x16x32_bf16 v[96:99], v[36:39], v[36:39], v[96:99]
v_mfma_f32_16x16x32_bf16 v[92:95], v[16:19], v[36:39], v[92:95]
buffer_store_dwordx4 v[36:39], v4, s[12:15], s37 offen offset:0 sc1
s_waitcnt lgkmcnt(12)
v_mfma_f32_16x16x32_bf16 v[104:107], v[44:47], v[44:47], v[104:107]
v_mfma_f32_16x16x32_bf16 v[100:103], v[16:19], v[44:47], v[100:103]
buffer_store_dwordx4 v[44:47], v4, s[12:15], s37 offen offset:1024 sc1
s_nop 1
v_cndmask_b32 v96, v96, v97, s[46:47]
v_cndmask_b32 v98, v98, v99, s[46:47]
v_cndmask_b32 v93, v96, v98, s[48:49]
buffer_store_dwordx2 v[92:93], v253, s[4:7], s38 offen offset:0 sc1
v_cndmask_b32 v104, v104, v105, s[46:47]
v_cndmask_b32 v106, v106, v107, s[46:47]
v_cndmask_b32 v101, v104, v106, s[48:49]
buffer_store_dwordx2 v[100:101], v253, s[4:7], s38 offen offset:2048 sc1
s_waitcnt lgkmcnt(10)
v_mfma_f32_16x16x32_bf16 v[108:111], a[188:191], v[16:19], 0
s_waitcnt lgkmcnt(6)
v_mfma_f32_16x16x32_bf16 v[112:115], a[196:199], v[16:19], 0
s_waitcnt lgkmcnt(2)
v_mfma_f32_16x16x32_bf16 v[116:119], a[204:207], v[16:19], 0
v_mfma_f32_16x16x32_bf16 v[108:111], a[192:195], v[16:19], v[108:111]
v_mfma_f32_16x16x32_bf16 v[112:115], a[200:203], v[16:19], v[112:115]
s_waitcnt lgkmcnt(0)
v_mfma_f32_16x16x32_bf16 v[116:119], a[208:211], v[16:19], v[116:119]
s_add_u32 s36, s97, 0
s_add_u32 s36, s36, s96
buffer_store_dwordx4 a[188:191], v1, s[4:7], s36 offen sc1
s_add_u32 s36, s97, 6144
s_add_u32 s36, s36, s96
buffer_store_dwordx4 a[192:195], v1, s[4:7], s36 offen sc1
s_add_u32 s36, s97, 1024
s_add_u32 s36, s36, s96
buffer_store_dwordx4 a[196:199], v1, s[4:7], s36 offen sc1
s_add_u32 s36, s97, 7168
s_add_u32 s36, s36, s96
buffer_store_dwordx4 a[200:203], v1, s[4:7], s36 offen sc1
s_add_u32 s36, s97, 2048
s_add_u32 s36, s36, s96
buffer_store_dwordx4 a[204:207], v1, s[4:7], s36 offen sc1
s_add_u32 s36, s97, 8192
s_add_u32 s36, s36, s96
buffer_store_dwordx4 a[208:211], v1, s[4:7], s36 offen sc1
buffer_store_dwordx4 v[108:111], v254, s[4:7], s98 offen offset:0 sc1
buffer_store_dwordx4 v[112:115], v254, s[4:7], s98 offen offset:2048 sc1
buffer_store_dwordx4 v[116:119], v254, s[4:7], s99 offen offset:0 sc1
v_lshlrev_b32 v239, 16, v233
v_lshl_add_u32 v239, v234, 4, v239
s_cmp_eq_u32 s28, 0
s_cselect_b32 s36, s66, s67
s_cmp_eq_u32 s28, 2
s_cselect_b32 s36, s70, s36
s_lshl_b32 s37, s28, 18
s_add_u32 s36, s36, s37
s_cmp_eq_u32 s28, 3
s_cselect_b32 s36, 0x40000000, s36
buffer_store_dwordx4 v[240:243], v239, s[4:7], s36 offen sc1
s_add_u32 s36, s36, 0x1a00000
buffer_store_dwordx4 v[240:243], v239, s[4:7], s36 offen sc1
s_waitcnt vmcnt(21)
s_barrier
ds_read_b64_tr_b16 a[212:213], v250 offset:0
ds_read_b64_tr_b16 a[214:215], v250 offset:2048
ds_read_b64_tr_b16 a[216:217], v250 offset:8
ds_read_b64_tr_b16 a[218:219], v250 offset:2056
s_waitcnt lgkmcnt(2)
buffer_store_dwordx4 a[212:215], v1, s[4:7], s100 offen offset:0 sc1
s_waitcnt lgkmcnt(0)
buffer_store_dwordx4 a[216:219], v1, s[4:7], s100 offen offset:1024 sc1
s_mov_b32 s56, 0x11111111
s_mov_b32 s57, 0x11111111
s_mov_b32 s58, 0x22222222
s_mov_b32 s59, 0x22222222
s_lshl_b32 s18, s28, 11
s_lshl_b32 s19, s28, 12
s_mul_i32 s50, s30, 196608
s_add_u32 s50, s50, s18
s_add_u32 s45, s50, 8192
s_lshl_b32 s36, s32, 17
s_add_u32 s36, s36, s19
s_add_u32 s37, s28, 0
s_cmp_eq_u32 s37, s3
s_cselect_b32 s37, 0, 0
s_add_u32 s84, s36, s37
s_mul_i32 s37, s37, 3
s_sub_u32 s86, s36, s37
s_add_u32 s37, s28, 4
s_cmp_eq_u32 s37, s3
s_cselect_b32 s37, 0, 0
s_add_u32 s85, s36, s37
s_mul_i32 s37, s37, 3
s_sub_u32 s87, s36, s37
s_mul_i32 s55, s28, 6144
v_accvgpr_write_b32 a248, -1
v_accvgpr_write_b32 a249, -1
v_accvgpr_write_b32 a250, -1
v_accvgpr_write_b32 a251, -1
s_lshl_b32 s36, s29, 2
s_add_u32 s36, s36, s28
s_mul_i32 s37, s36, 131072
v_add_u32 v2, s37, v1
s_lshl_b32 s82, s36, 13
s_and_b32 s38, s29, 3
s_cmp_eq_u32 s38, 0
s_cselect_b32 s38, 0, 0x1f400
s_cselect_b32 s39, 0, 2048
s_cselect_b32 s54, 32, 48
s_lshl_b32 s37, s29, 19
s_sub_u32 s37, s37, s38
v_add_u32 v3, s37, v1
v_cmp_le_u32 vcc, 8, v234
s_nop 1
v_cndmask_b32 v3, 2.0, v3, vcc
s_lshl_b32 s37, s29, 15
s_sub_u32 s83, s37, s39
s_cmp_eq_u32 s28, 0
s_cselect_b32 vcc_lo, -1, 0
s_mov_b32 vcc_hi, 0
v_lshlrev_b32 v244, 8, v0
v_cndmask_b32 v10, 2.0, v244, vcc
v_and_b32 v244, 1, v233
v_lshl_add_u32 v244, v244, 3, v234
v_and_b32 v244, 15, v244
v_lshrrev_b32 v245, 1, v233
v_lshl_add_u32 v244, v245, 4, v244
v_lshrrev_b32 v245, 3, v234
v_lshl_add_u32 v244, v245, 5, v244
v_lshlrev_b32 v7, 3, v244
v_lshrrev_b32 v246, 2, v0
v_and_b32 v247, 3, v0
v_and_b32 v244, 1, v247
v_lshl_add_u32 v244, v244, 3, v246
v_and_b32 v244, 15, v244
v_lshrrev_b32 v245, 1, v247
v_lshl_add_u32 v244, v245, 4, v244
v_lshrrev_b32 v245, 3, v246
v_lshl_add_u32 v244, v245, 5, v244
v_lshlrev_b32 v8, 3, v244
s_and_b32 s36, s28, 1
s_lshl_b32 s37, s36, 3
s_add_u32 s37, s37, 20480
s_lshl_b32 s36, s36, 9
v_add_u32 v244, s37, v1
v_add_u32 v245, s36, v7
s_cmp_lt_u32 s28, 2
s_cselect_b64 vcc, -1, 0
v_cndmask_b32 v9, v245, v244, vcc
s_cmp_eq_u32 s28, 3
s_cselect_b64 vcc, -1, 0
v_cndmask_b32 v3, 2.0, v1, vcc
s_lshl_b32 s83, s67, 3
s_cmp_eq_u32 s54, 32
s_cselect_b32 s36, 1, s28
s_cmp_eq_u32 s36, 0
s_cselect_b64 vcc, -1, 0
v_cndmask_b32 v9, 2.0, v1, vcc
v_lshlrev_b32 v239, 2, v233
v_sub_u32 v239, v239, v234
v_mov_b32 v247, 0xf149f2ca
v_add_u32 v246, 7, v239
v_cmp_gt_u32 vcc, 8, v246
v_mov_b32 v244, 0xffff
s_nop 0
v_cndmask_b32 v24, v247, 0, vcc
v_cndmask_b32 v244, 0, v244, vcc
v_mov_b32 v30, v244
v_add_u32 v246, 0, v239
v_cmp_le_i32 vcc, 9, v246
v_mov_b32 v244, 0xffff
s_nop 0
v_cndmask_b32 v20, v247, 0, vcc
v_cndmask_b32 v244, 0, v244, vcc
v_mov_b32 v28, v244
v_add_u32 v246, 8, v239
v_cmp_gt_u32 vcc, 8, v246
v_mov_b32 v244, 0xffff0000
s_nop 0
v_cndmask_b32 v25, v247, 0, vcc
v_cndmask_b32 v244, 0, v244, vcc
v_or_b32 v30, v30, v244
v_add_u32 v246, 1, v239
v_cmp_le_i32 vcc, 9, v246
v_mov_b32 v244, 0xffff0000
s_nop 0
v_cndmask_b32 v21, v247, 0, vcc
v_cndmask_b32 v244, 0, v244, vcc
v_or_b32 v28, v28, v244
v_add_u32 v246, 9, v239
v_cmp_gt_u32 vcc, 8, v246
v_mov_b32 v244, 0xffff
s_nop 0
v_cndmask_b32 v26, v247, 0, vcc
v_cndmask_b32 v244, 0, v244, vcc
v_mov_b32 v31, v244
v_add_u32 v246, 2, v239
v_cmp_le_i32 vcc, 9, v246
v_mov_b32 v244, 0xffff
s_nop 0
v_cndmask_b32 v22, v247, 0, vcc
v_cndmask_b32 v244, 0, v244, vcc
v_mov_b32 v29, v244
v_add_u32 v246, 10, v239
v_cmp_gt_u32 vcc, 8, v246
v_mov_b32 v244, 0xffff0000
s_nop 0
v_cndmask_b32 v27, v247, 0, vcc
v_cndmask_b32 v244, 0, v244, vcc
v_or_b32 v31, v31, v244
v_add_u32 v246, 3, v239
v_cmp_le_i32 vcc, 9, v246
v_mov_b32 v244, 0xffff0000
s_nop 0
v_cndmask_b32 v23, v247, 0, vcc
v_cndmask_b32 v244, 0, v244, vcc
v_or_b32 v29, v29, v244
s_and_b32 s36, s29, 3
s_or_b32 s36, s36, s28
s_cmp_eq_u32 s36, 0
s_cselect_b64 vcc, -1, 0
v_cndmask_b32 v76, v20, v247, vcc
v_cndmask_b32 v77, v21, v247, vcc
v_cndmask_b32 v78, v22, v247, vcc
v_cndmask_b32 v79, v23, v247, vcc
v_cndmask_b32 v80, v28, 0, vcc
v_cndmask_b32 v81, v29, 0, vcc
s_add_u32 s91, s83, 0x900000
buffer_store_dwordx4 a[248:251], v3, s[4:7], s91 offen offset:0 sc1
buffer_store_dwordx4 a[248:251], v3, s[4:7], s91 offen offset:1024 sc1
s_mov_b32 s36, 0x9e3779b1
s_waitcnt vmcnt(23)
v_mul_lo_u32 v15, v11, s36
v_add_u32 v15, 0x7f4a7c15, v15
s_and_b32 s36, s31, 1
s_lshl_b32 s36, s36, 4
s_add_u32 s36, s36, s32
s_lshl_b32 s36, s36, 2
s_add_u32 s92, s78, s36
s_add_u32 s92, s92, 0xc0000
s_lshl_b32 s36, s32, 2
s_add_u32 s93, s79, s36
s_add_u32 s93, s93, 0xc0080
s_and_b32 s94, s35, 15
s_lshl_b32 s94, s94, 9
s_lshr_b32 s36, s35, 4
s_lshl_b32 s36, s36, 2
s_add_u32 s94, s94, s36
s_add_u32 s94, s94, 0xc00c0
v_lshrrev_b32 v240, 1, v0
v_lshlrev_b32 v240, 13, v240
v_and_b32 v241, 1, v0
v_lshl_add_u32 v240, v241, 8, v240
s_mov_b32 vcc_lo, 0xffff
s_mov_b32 vcc_hi, 0
v_cndmask_b32 v240, 2.0, v240, vcc
v_lshlrev_b32 v241, 2, v0
v_add_u32 v248, 0, v248
v_add_u32 v249, 0, v249
s_add_u32 s96, s96, 0x400000
s_add_u32 s98, s98, 0x80000
s_add_u32 s96, s96, 0x400000
s_add_u32 s99, s99, 0x80000
s_cmp_eq_u32 s28, 0
s_cselect_b32 vcc_lo, 0xffff, 0
v_lshlrev_b32 v252, 12, v0
v_cndmask_b32 v252, 2.0, v252, vcc
v_cndmask_b32 v14, 2.0, v240, vcc
s_and_b32 s62, s35, 15
s_lshl_b32 s62, s62, 8
s_lshr_b32 s36, s35, 4
s_lshl_b32 s36, s36, 2
s_add_u32 s62, s62, s36
s_add_u32 s62, s62, 0xd0000
s_add_u32 s8, s94, 0x1ff40
v_and_b32 v255, 15, v0
v_lshlrev_b32 v255, 2, v255
s_waitcnt vmcnt(0)
s_barrier
s_cmp_lg_u32 s28, 0
s_cbranch_scc1 Lg1s_1
buffer_atomic_swap v15, v10, s[4:7], s92 offen sc1
s_add_u32 s36, s67, 0xc2080
s_cmp_eq_u32 s81, 3
s_cselect_b32 s36, 0x40000000, s36
s_mov_b64 exec, 1
buffer_atomic_swap v15, off, s[4:7], s36 sc1
s_mov_b64 exec, -1
buffer_atomic_swap v15, v240, s[4:7], s94 offen sc1
buffer_atomic_swap v15, v252, s[4:7], s62 offen sc1
Lg1s_1:
s_branch L_aligned
.p2align 12
L_aligned:
s_mov_b64 s[20:21], s[76:77]
s_mov_b32 s22, 0x200000
s_add_u32 s89, s16, 0
buffer_load_dwordx4 a[220:223], v229, s[20:23], s89 offen nt
s_mov_b64 s[20:21], s[76:77]
s_mov_b32 s22, 0x200000
s_add_u32 s89, s16, 16384
buffer_load_dwordx4 a[224:227], v229, s[20:23], s89 offen nt
s_mov_b64 s[20:21], s[72:73]
s_mov_b32 s22, 0x600000
s_add_u32 s89, s17, 0
buffer_load_dwordx4 a[188:191], v228, s[20:23], s89 offen nt
s_mov_b64 s[20:21], s[72:73]
s_mov_b32 s22, 0x600000
s_add_u32 s89, s17, 49152
buffer_load_dwordx4 a[192:195], v228, s[20:23], s89 offen nt
s_mov_b64 s[20:21], s[72:73]
s_mov_b32 s22, 0x600000
s_add_u32 s89, s17, 2048
buffer_load_dwordx4 a[196:199], v228, s[20:23], s89 offen nt
s_mov_b64 s[20:21], s[72:73]
s_mov_b32 s22, 0x600000
s_add_u32 s89, s17, 51200
buffer_load_dwordx4 a[200:203], v228, s[20:23], s89 offen nt
s_mov_b64 s[20:21], s[72:73]
s_mov_b32 s22, 0x600000
s_add_u32 s89, s17, 4096
buffer_load_dwordx4 a[204:207], v228, s[20:23], s89 offen nt
s_mov_b64 s[20:21], s[72:73]
s_mov_b32 s22, 0x600000
s_add_u32 s89, s17, 53248
buffer_load_dwordx4 a[208:211], v228, s[20:23], s89 offen nt
s_add_u32 s89, s66, 0xd0000
ds_read_b64_tr_b16 a[240:241], v251 offset:0
ds_read_b64_tr_b16 a[242:243], v251 offset:1024
ds_read_b64_tr_b16 a[244:245], v251 offset:32
ds_read_b64_tr_b16 a[246:247], v251 offset:1056
s_lshl_b32 s36, s28, 11
v_add_u32 v231, s36, v1
s_waitcnt lgkmcnt(0)
v_add_u32 v231, 0, v231
v_cmp_eq_u32 vcc, 0, v0
s_nop 1
v_cndmask_b32 v251, 2.0, v0, vcc
s_cmp_lg_u32 s28, 2
s_cbranch_scc1 Lvote_4
s_cmp_ge_u32 s2, 64
s_cbranch_scc1 Lvote_4
s_add_u32 s36, s70, 0xa0000
s_memtime s[52:53]
s_waitcnt lgkmcnt(0)
s_load_dword s37, s[4:5], s36
s_waitcnt lgkmcnt(0)
s_memtime s[60:61]
s_waitcnt lgkmcnt(0)
s_sub_u32 s38, s60, s52
s_add_u32 s36, s70, 0x1aa0000
s_memtime s[52:53]
s_waitcnt lgkmcnt(0)
s_load_dword s37, s[4:5], s36
s_waitcnt lgkmcnt(0)
s_memtime s[60:61]
s_waitcnt lgkmcnt(0)
s_sub_u32 s39, s60, s52
s_add_u32 s36, s70, 0xa0080
s_memtime s[52:53]
s_waitcnt lgkmcnt(0)
s_load_dword s37, s[4:5], s36
s_waitcnt lgkmcnt(0)
s_memtime s[60:61]
s_waitcnt lgkmcnt(0)
s_sub_u32 s37, s60, s52
s_min_u32 s38, s38, s37
s_add_u32 s36, s70, 0x1aa0080
s_memtime s[52:53]
s_waitcnt lgkmcnt(0)
s_load_dword s37, s[4:5], s36
s_waitcnt lgkmcnt(0)
s_memtime s[60:61]
s_waitcnt lgkmcnt(0)
s_sub_u32 s37, s60, s52
s_min_u32 s39, s39, s37
s_cmp_lt_u32 s38, s39
s_cselect_b32 s36, 0, 1
s_bfe_u32 s37, s70, 0x1000d
s_xor_b32 s36, s36, s37
s_lshr_b32 s37, s29, 2
s_xor_b32 s36, s36, s37
s_add_u32 s36, s36, 0x10000
v_mov_b32 v242, s36
s_and_b32 s36, s2, 1
s_lshl_b32 s36, s36, 7
buffer_atomic_add v242, v251, s[24:27], s36 offen sc1
Lvote_4:
s_mov_b64 exec, 0
s_cmp_eq_u32 s28, 3
s_cbranch_scc1 L_stub0
s_cmp_eq_u32 s28, 0
s_cbranch_scc1 L_stub1
s_cmp_eq_u32 s28, 2
s_cbranch_scc1 L_stub2
L_wret0:
s_mov_b64 exec, -1
s_cmp_lg_u32 s28, 1
s_cbranch_scc1 Lg1e_3
s_cmp_eq_u32 s54, 32
s_cselect_b32 s39, 0, 1
s_or_b32 s39, s39, 0xffff0000
s_mov_b32 s38, -1
s_add_u32 s36, s67, 0xc0000
s_mov_b32 s37, 0
Lg1p_2:
v_mov_b32 v11, 0
buffer_atomic_add v11, v241, s[4:7], s36 offen sc0 sc1
s_add_u32 s37, s37, 1
v_mov_b32 v242, v15
s_mov_b64 exec, 0xffff
v_mov_b32 v242, 0
buffer_atomic_add v242, v241, s[4:7], s89 offen sc0 sc1
s_mov_b64 exec, -1
s_waitcnt vmcnt(0)
v_cmp_ne_u32 vcc, v11, v15
v_cmp_ne_u32 s[52:53], v242, v15
s_and_b64 vcc, vcc, s[38:39]
s_or_b64 vcc, vcc, s[52:53]
s_cbranch_scc0 Lg1e_3
s_cmp_lt_u32 s37, 0x100000
s_cbranch_scc1 Lg1p_2
Lg1e_3:
s_barrier
s_add_u32 s94, s71, 0x80
s_add_u32 m0, s18, 0x0
s_add_u32 s44, s50, 0x2c00000
buffer_load_dwordx4 v1, s[4:7], s44 offen offset:0 sc1 lds
buffer_load_dwordx4 v1, s[4:7], s44 offen offset:1024 sc1 lds
s_add_u32 m0, s18, 0x2000
s_add_u32 s44, s50, 0x2c02000
buffer_load_dwordx4 v1, s[4:7], s44 offen offset:0 sc1 lds
buffer_load_dwordx4 v1, s[4:7], s44 offen offset:1024 sc1 lds
s_add_u32 m0, s18, 0x4000
s_add_u32 s44, s50, 0x2c04000
buffer_load_dwordx4 v1, s[4:7], s44 offen offset:0 sc1 lds
buffer_load_dwordx4 v1, s[4:7], s44 offen offset:1024 sc1 lds
s_add_u32 m0, s18, 0x6000
s_add_u32 s44, s50, 0x2c06000
buffer_load_dwordx4 v1, s[4:7], s44 offen offset:0 sc1 lds
buffer_load_dwordx4 v1, s[4:7], s44 offen offset:1024 sc1 lds
s_add_u32 m0, s18, 0x8000
s_add_u32 s44, s50, 0x2c08000
buffer_load_dwordx4 v1, s[4:7], s44 offen offset:0 sc1 lds
buffer_load_dwordx4 v1, s[4:7], s44 offen offset:1024 sc1 lds
s_add_u32 m0, s18, 0xa000
s_add_u32 s44, s50, 0x2c0a000
buffer_load_dwordx4 v1, s[4:7], s44 offen offset:0 sc1 lds
buffer_load_dwordx4 v1, s[4:7], s44 offen offset:1024 sc1 lds
s_mov_b32 s35, 0
s_add_u32 s33, s35, 0x1000
buffer_load_dwordx4 a[0:3], v2, s[40:43], s35 offen offset:0 sc1
buffer_load_dwordx4 a[4:7], v2, s[40:43], s33 offen offset:0 sc1
buffer_load_dwordx4 a[8:11], v2, s[40:43], s35 offen offset:1024 sc1
buffer_load_dwordx4 a[12:15], v2, s[40:43], s33 offen offset:1024 sc1
buffer_load_dwordx4 a[16:19], v2, s[40:43], s35 offen offset:2048 sc1
buffer_load_dwordx4 a[20:23], v2, s[40:43], s33 offen offset:2048 sc1
buffer_load_dwordx4 a[24:27], v2, s[40:43], s35 offen offset:3072 sc1
buffer_load_dwordx4 a[28:31], v2, s[40:43], s33 offen offset:3072 sc1
s_add_u32 s35, s35, 0x2000
s_add_u32 s33, s33, 0x2000
buffer_load_dwordx4 a[32:35], v2, s[40:43], s35 offen offset:0 sc1
buffer_load_dwordx4 a[36:39], v2, s[40:43], s33 offen offset:0 sc1
buffer_load_dwordx4 a[40:43], v2, s[40:43], s35 offen offset:1024 sc1
buffer_load_dwordx4 a[44:47], v2, s[40:43], s33 offen offset:1024 sc1
buffer_load_dwordx4 a[48:51], v2, s[40:43], s35 offen offset:2048 sc1
buffer_load_dwordx4 a[52:55], v2, s[40:43], s33 offen offset:2048 sc1
buffer_load_dwordx4 a[56:59], v2, s[40:43], s35 offen offset:3072 sc1
buffer_load_dwordx4 a[60:63], v2, s[40:43], s33 offen offset:3072 sc1
s_add_u32 s35, s35, 0x2000
s_add_u32 s33, s33, 0x2000
s_waitcnt vmcnt(16)
s_barrier
v_add_u32 v5, 0, v1
ds_read_b128 a[96:99], v5 offset:2048
ds_read_b128 a[100:103], v5 offset:8192
ds_read_b128 a[104:107], v5 offset:3072
ds_read_b128 a[108:111], v5 offset:9216
ds_read_b128 a[112:115], v5 offset:4096
ds_read_b128 a[116:119], v5 offset:10240
s_waitcnt vmcnt(14) lgkmcnt(4)
v_mfma_f32_16x16x32_bf16 v[140:143], a[96:99], a[0:3], 0
s_add_u32 m0, s18, 0xc000
s_add_u32 s44, s50, 0x2c0c000
v_mfma_f32_16x16x32_bf16 v[140:143], a[100:103], a[4:7], v[140:143]
buffer_load_dwordx4 a[64:67], v2, s[40:43], s35 offen offset:0 sc1
s_waitcnt vmcnt(13)
v_mfma_f32_16x16x32_bf16 v[164:167], a[100:103], a[12:15], 0
ds_read_b128 a[128:131], v5 offset:5120
v_mfma_f32_16x16x32_bf16 v[164:167], a[96:99], a[8:11], v[164:167]
ds_read_b128 a[132:135], v5 offset:11264
s_waitcnt vmcnt(12)
v_mfma_f32_16x16x32_bf16 v[188:191], a[96:99], a[16:19], 0
s_waitcnt vmcnt(11)
v_mfma_f32_16x16x32_bf16 v[188:191], a[100:103], a[20:23], v[188:191]
buffer_load_dwordx4 v1, s[4:7], s44 offen offset:0 sc1 lds
s_waitcnt vmcnt(10)
v_mfma_f32_16x16x32_bf16 v[212:215], a[100:103], a[28:31], 0
ds_read_b128 a[136:139], v5 offset:0
v_mfma_f32_16x16x32_bf16 v[212:215], a[96:99], a[24:27], v[212:215]
s_waitcnt lgkmcnt(6)
v_mfma_f32_16x16x32_bf16 v[216:219], a[104:107], a[24:27], 0
ds_read_b128 a[140:143], v5 offset:6144
s_waitcnt lgkmcnt(6)
v_mfma_f32_16x16x32_bf16 v[216:219], a[108:111], a[28:31], v[216:219]
buffer_load_dwordx4 a[68:71], v2, s[40:43], s33 offen offset:0 sc1
v_mfma_f32_16x16x32_bf16 v[192:195], a[108:111], a[20:23], 0
ds_read_b128 a[144:147], v5 offset:1024
v_mfma_f32_16x16x32_bf16 v[192:195], a[104:107], a[16:19], v[192:195]
v_mfma_f32_16x16x32_bf16 v[168:171], a[104:107], a[8:11], 0
v_mfma_f32_16x16x32_bf16 v[168:171], a[108:111], a[12:15], v[168:171]
buffer_load_dwordx4 a[72:75], v2, s[40:43], s35 offen offset:1024 sc1
v_mfma_f32_16x16x32_bf16 v[144:147], a[108:111], a[4:7], 0
ds_read_b128 a[148:151], v5 offset:7168
v_mfma_f32_16x16x32_bf16 v[144:147], a[104:107], a[0:3], v[144:147]
s_waitcnt lgkmcnt(7)
v_mfma_f32_16x16x32_bf16 v[148:151], a[112:115], a[0:3], 0
s_waitcnt lgkmcnt(6)
v_mfma_f32_16x16x32_bf16 v[148:151], a[116:119], a[4:7], v[148:151]
buffer_load_dwordx4 v1, s[4:7], s44 offen offset:1024 sc1 lds
s_add_u32 m0, s18, 0xe000
v_mfma_f32_16x16x32_bf16 v[172:175], a[116:119], a[12:15], 0
s_add_u32 s44, s50, 0x2c0e000
v_mfma_f32_16x16x32_bf16 v[172:175], a[112:115], a[8:11], v[172:175]
v_mfma_f32_16x16x32_bf16 v[196:199], a[112:115], a[16:19], 0
v_mfma_f32_16x16x32_bf16 v[196:199], a[116:119], a[20:23], v[196:199]
buffer_load_dwordx4 a[76:79], v2, s[40:43], s33 offen offset:1024 sc1
v_mfma_f32_16x16x32_bf16 v[220:223], a[116:119], a[28:31], 0
v_mfma_f32_16x16x32_bf16 v[220:223], a[112:115], a[24:27], v[220:223]
s_waitcnt lgkmcnt(0)
v_mfma_f32_16x16x32_bf16 v[224:227], a[128:131], a[24:27], 0
ds_read_b128 a[96:99], v5 offset:14336
v_mfma_f32_16x16x32_bf16 v[224:227], a[132:135], a[28:31], v[224:227]
buffer_load_dwordx4 a[80:83], v2, s[40:43], s35 offen offset:2048 sc1
v_mfma_f32_16x16x32_bf16 v[200:203], a[132:135], a[20:23], 0
ds_read_b128 a[100:103], v5 offset:20480
v_mfma_f32_16x16x32_bf16 v[200:203], a[128:131], a[16:19], v[200:203]
v_mfma_f32_16x16x32_bf16 v[176:179], a[128:131], a[8:11], 0
v_mfma_f32_16x16x32_bf16 v[176:179], a[132:135], a[12:15], v[176:179]
buffer_load_dwordx4 v1, s[4:7], s44 offen offset:0 sc1 lds
v_mfma_f32_16x16x32_bf16 v[152:155], a[132:135], a[4:7], 0
ds_read_b128 a[104:107], v5 offset:15360
v_mfma_f32_16x16x32_bf16 v[152:155], a[128:131], a[0:3], v[152:155]
v_mfma_f32_16x16x32_bf16 v[132:135], a[136:139], a[0:3], 0
ds_read_b128 a[108:111], v5 offset:21504
v_mfma_f32_16x16x32_bf16 v[132:135], a[140:143], a[4:7], v[132:135]
buffer_load_dwordx4 a[84:87], v2, s[40:43], s33 offen offset:2048 sc1
v_mfma_f32_16x16x32_bf16 v[156:159], a[140:143], a[12:15], 0
ds_read_b128 a[112:115], v5 offset:16384
v_mfma_f32_16x16x32_bf16 v[156:159], a[136:139], a[8:11], v[156:159]
v_mfma_f32_16x16x32_bf16 v[180:183], a[136:139], a[16:19], 0
v_mfma_f32_16x16x32_bf16 v[180:183], a[140:143], a[20:23], v[180:183]
buffer_load_dwordx4 a[88:91], v2, s[40:43], s35 offen offset:3072 sc1
v_mfma_f32_16x16x32_bf16 v[204:207], a[140:143], a[28:31], 0
ds_read_b128 a[116:119], v5 offset:22528
v_mfma_f32_16x16x32_bf16 v[204:207], a[136:139], a[24:27], v[204:207]
v_mfma_f32_16x16x32_bf16 v[208:211], a[144:147], a[24:27], 0
v_mfma_f32_16x16x32_bf16 v[208:211], a[148:151], a[28:31], v[208:211]
buffer_load_dwordx4 v1, s[4:7], s44 offen offset:1024 sc1 lds
s_add_u32 m0, s18, 0x10000
v_mfma_f32_16x16x32_bf16 v[184:187], a[148:151], a[20:23], 0
s_add_u32 s44, s50, 0x2c10000
v_mfma_f32_16x16x32_bf16 v[184:187], a[144:147], a[16:19], v[184:187]
v_mfma_f32_16x16x32_bf16 v[160:163], a[144:147], a[8:11], 0
v_mfma_f32_16x16x32_bf16 v[160:163], a[148:151], a[12:15], v[160:163]
buffer_load_dwordx4 a[92:95], v2, s[40:43], s33 offen offset:3072 sc1
s_add_u32 s35, s35, 0x2000
v_mfma_f32_16x16x32_bf16 v[136:139], a[148:151], a[4:7], 0
s_add_u32 s33, s33, 0x2000
v_mfma_f32_16x16x32_bf16 v[136:139], a[144:147], a[0:3], v[136:139]
s_waitcnt vmcnt(12) lgkmcnt(0)
v_mfma_f32_16x16x32_bf16 v[140:143], a[96:99], a[32:35], v[140:143]
ds_read_b128 a[128:131], v5 offset:17408
v_mfma_f32_16x16x32_bf16 v[140:143], a[100:103], a[36:39], v[140:143]
buffer_load_dwordx4 a[0:3], v2, s[40:43], s35 offen offset:0 sc1
v_mfma_f32_16x16x32_bf16 v[164:167], a[100:103], a[44:47], v[164:167]
ds_read_b128 a[132:135], v5 offset:23552
v_mfma_f32_16x16x32_bf16 v[164:167], a[96:99], a[40:43], v[164:167]
v_mfma_f32_16x16x32_bf16 v[188:191], a[96:99], a[48:51], v[188:191]
v_mfma_f32_16x16x32_bf16 v[188:191], a[100:103], a[52:55], v[188:191]
buffer_load_dwordx4 v1, s[4:7], s44 offen offset:0 sc1 lds
v_mfma_f32_16x16x32_bf16 v[212:215], a[100:103], a[60:63], v[212:215]
ds_read_b128 a[136:139], v5 offset:12288
v_mfma_f32_16x16x32_bf16 v[212:215], a[96:99], a[56:59], v[212:215]
v_mfma_f32_16x16x32_bf16 v[216:219], a[104:107], a[56:59], v[216:219]
ds_read_b128 a[140:143], v5 offset:18432
v_mfma_f32_16x16x32_bf16 v[216:219], a[108:111], a[60:63], v[216:219]
buffer_load_dwordx4 a[4:7], v2, s[40:43], s33 offen offset:0 sc1
v_mfma_f32_16x16x32_bf16 v[192:195], a[108:111], a[52:55], v[192:195]
ds_read_b128 a[144:147], v5 offset:13312
v_mfma_f32_16x16x32_bf16 v[192:195], a[104:107], a[48:51], v[192:195]
v_mfma_f32_16x16x32_bf16 v[168:171], a[104:107], a[40:43], v[168:171]
v_mfma_f32_16x16x32_bf16 v[168:171], a[108:111], a[44:47], v[168:171]
buffer_load_dwordx4 a[8:11], v2, s[40:43], s35 offen offset:1024 sc1
v_mfma_f32_16x16x32_bf16 v[144:147], a[108:111], a[36:39], v[144:147]
ds_read_b128 a[148:151], v5 offset:19456
v_mfma_f32_16x16x32_bf16 v[144:147], a[104:107], a[32:35], v[144:147]
v_mfma_f32_16x16x32_bf16 v[148:151], a[112:115], a[32:35], v[148:151]
v_mfma_f32_16x16x32_bf16 v[148:151], a[116:119], a[36:39], v[148:151]
buffer_load_dwordx4 v1, s[4:7], s44 offen offset:1024 sc1 lds
s_add_u32 m0, s18, 0x12000
v_mfma_f32_16x16x32_bf16 v[172:175], a[116:119], a[44:47], v[172:175]
s_add_u32 s44, s50, 0x2c12000
v_mfma_f32_16x16x32_bf16 v[172:175], a[112:115], a[40:43], v[172:175]
v_mfma_f32_16x16x32_bf16 v[196:199], a[112:115], a[48:51], v[196:199]
v_mfma_f32_16x16x32_bf16 v[196:199], a[116:119], a[52:55], v[196:199]
buffer_load_dwordx4 a[12:15], v2, s[40:43], s33 offen offset:1024 sc1
v_mfma_f32_16x16x32_bf16 v[220:223], a[116:119], a[60:63], v[220:223]
v_mfma_f32_16x16x32_bf16 v[220:223], a[112:115], a[56:59], v[220:223]
s_waitcnt lgkmcnt(0)
v_mfma_f32_16x16x32_bf16 v[224:227], a[128:131], a[56:59], v[224:227]
ds_read_b128 a[96:99], v5 offset:26624
v_mfma_f32_16x16x32_bf16 v[224:227], a[132:135], a[60:63], v[224:227]
buffer_load_dwordx4 a[16:19], v2, s[40:43], s35 offen offset:2048 sc1
v_mfma_f32_16x16x32_bf16 v[200:203], a[132:135], a[52:55], v[200:203]
ds_read_b128 a[100:103], v5 offset:32768
v_mfma_f32_16x16x32_bf16 v[200:203], a[128:131], a[48:51], v[200:203]
v_mfma_f32_16x16x32_bf16 v[176:179], a[128:131], a[40:43], v[176:179]
v_mfma_f32_16x16x32_bf16 v[176:179], a[132:135], a[44:47], v[176:179]
buffer_load_dwordx4 v1, s[4:7], s44 offen offset:0 sc1 lds
v_mfma_f32_16x16x32_bf16 v[152:155], a[132:135], a[36:39], v[152:155]
ds_read_b128 a[104:107], v5 offset:27648
v_mfma_f32_16x16x32_bf16 v[152:155], a[128:131], a[32:35], v[152:155]
v_mfma_f32_16x16x32_bf16 v[132:135], a[136:139], a[32:35], v[132:135]
ds_read_b128 a[108:111], v5 offset:33792
v_mfma_f32_16x16x32_bf16 v[132:135], a[140:143], a[36:39], v[132:135]
buffer_load_dwordx4 a[20:23], v2, s[40:43], s33 offen offset:2048 sc1
v_mfma_f32_16x16x32_bf16 v[156:159], a[140:143], a[44:47], v[156:159]
ds_read_b128 a[112:115], v5 offset:28672
v_mfma_f32_16x16x32_bf16 v[156:159], a[136:139], a[40:43], v[156:159]
v_mfma_f32_16x16x32_bf16 v[180:183], a[136:139], a[48:51], v[180:183]
v_mfma_f32_16x16x32_bf16 v[180:183], a[140:143], a[52:55], v[180:183]
buffer_load_dwordx4 a[24:27], v2, s[40:43], s35 offen offset:3072 sc1
v_mfma_f32_16x16x32_bf16 v[204:207], a[140:143], a[60:63], v[204:207]
ds_read_b128 a[116:119], v5 offset:34816
v_mfma_f32_16x16x32_bf16 v[204:207], a[136:139], a[56:59], v[204:207]
v_mfma_f32_16x16x32_bf16 v[208:211], a[144:147], a[56:59], v[208:211]
v_mfma_f32_16x16x32_bf16 v[208:211], a[148:151], a[60:63], v[208:211]
buffer_load_dwordx4 v1, s[4:7], s44 offen offset:1024 sc1 lds
s_add_u32 m0, s18, 0x14000
v_mfma_f32_16x16x32_bf16 v[184:187], a[148:151], a[52:55], v[184:187]
s_add_u32 s44, s50, 0x2c14000
v_mfma_f32_16x16x32_bf16 v[184:187], a[144:147], a[48:51], v[184:187]
v_mfma_f32_16x16x32_bf16 v[160:163], a[144:147], a[40:43], v[160:163]
v_mfma_f32_16x16x32_bf16 v[160:163], a[148:151], a[44:47], v[160:163]
buffer_load_dwordx4 a[28:31], v2, s[40:43], s33 offen offset:3072 sc1
s_add_u32 s35, s35, 0x2000
v_mfma_f32_16x16x32_bf16 v[136:139], a[148:151], a[36:39], v[136:139]
s_add_u32 s33, s33, 0x2000
v_mfma_f32_16x16x32_bf16 v[136:139], a[144:147], a[32:35], v[136:139]
s_waitcnt vmcnt(12) lgkmcnt(0)
v_mfma_f32_16x16x32_bf16 v[140:143], a[96:99], a[64:67], v[140:143]
ds_read_b128 a[128:131], v5 offset:29696
v_mfma_f32_16x16x32_bf16 v[140:143], a[100:103], a[68:71], v[140:143]
buffer_load_dwordx4 a[32:35], v2, s[40:43], s35 offen offset:0 sc1
v_mfma_f32_16x16x32_bf16 v[164:167], a[100:103], a[76:79], v[164:167]
ds_read_b128 a[132:135], v5 offset:35840
v_mfma_f32_16x16x32_bf16 v[164:167], a[96:99], a[72:75], v[164:167]
v_mfma_f32_16x16x32_bf16 v[188:191], a[96:99], a[80:83], v[188:191]
v_mfma_f32_16x16x32_bf16 v[188:191], a[100:103], a[84:87], v[188:191]
buffer_load_dwordx4 v1, s[4:7], s44 offen offset:0 sc1 lds
v_mfma_f32_16x16x32_bf16 v[212:215], a[100:103], a[92:95], v[212:215]
ds_read_b128 a[136:139], v5 offset:24576
v_mfma_f32_16x16x32_bf16 v[212:215], a[96:99], a[88:91], v[212:215]
v_mfma_f32_16x16x32_bf16 v[216:219], a[104:107], a[88:91], v[216:219]
ds_read_b128 a[140:143], v5 offset:30720
v_mfma_f32_16x16x32_bf16 v[216:219], a[108:111], a[92:95], v[216:219]
buffer_load_dwordx4 a[36:39], v2, s[40:43], s33 offen offset:0 sc1
v_mfma_f32_16x16x32_bf16 v[192:195], a[108:111], a[84:87], v[192:195]
ds_read_b128 a[144:147], v5 offset:25600
v_mfma_f32_16x16x32_bf16 v[192:195], a[104:107], a[80:83], v[192:195]
v_mfma_f32_16x16x32_bf16 v[168:171], a[104:107], a[72:75], v[168:171]
v_mfma_f32_16x16x32_bf16 v[168:171], a[108:111], a[76:79], v[168:171]
buffer_load_dwordx4 a[40:43], v2, s[40:43], s35 offen offset:1024 sc1
v_mfma_f32_16x16x32_bf16 v[144:147], a[108:111], a[68:71], v[144:147]
ds_read_b128 a[148:151], v5 offset:31744
v_mfma_f32_16x16x32_bf16 v[144:147], a[104:107], a[64:67], v[144:147]
v_mfma_f32_16x16x32_bf16 v[148:151], a[112:115], a[64:67], v[148:151]
v_mfma_f32_16x16x32_bf16 v[148:151], a[116:119], a[68:71], v[148:151]
buffer_load_dwordx4 v1, s[4:7], s44 offen offset:1024 sc1 lds
s_add_u32 m0, s18, 0x16000
v_mfma_f32_16x16x32_bf16 v[172:175], a[116:119], a[76:79], v[172:175]
s_add_u32 s44, s50, 0x2c16000
v_mfma_f32_16x16x32_bf16 v[172:175], a[112:115], a[72:75], v[172:175]
v_mfma_f32_16x16x32_bf16 v[196:199], a[112:115], a[80:83], v[196:199]
v_mfma_f32_16x16x32_bf16 v[196:199], a[116:119], a[84:87], v[196:199]
buffer_load_dwordx4 a[44:47], v2, s[40:43], s33 offen offset:1024 sc1
v_mfma_f32_16x16x32_bf16 v[220:223], a[116:119], a[92:95], v[220:223]
v_mfma_f32_16x16x32_bf16 v[220:223], a[112:115], a[88:91], v[220:223]
s_waitcnt lgkmcnt(0)
v_mfma_f32_16x16x32_bf16 v[224:227], a[128:131], a[88:91], v[224:227]
ds_read_b128 a[96:99], v5 offset:38912
v_mfma_f32_16x16x32_bf16 v[224:227], a[132:135], a[92:95], v[224:227]
buffer_load_dwordx4 a[48:51], v2, s[40:43], s35 offen offset:2048 sc1
v_mfma_f32_16x16x32_bf16 v[200:203], a[132:135], a[84:87], v[200:203]
ds_read_b128 a[100:103], v5 offset:45056
v_mfma_f32_16x16x32_bf16 v[200:203], a[128:131], a[80:83], v[200:203]
v_mfma_f32_16x16x32_bf16 v[176:179], a[128:131], a[72:75], v[176:179]
buffer_load_dwordx4 v1, s[4:7], s44 offen offset:0 sc1 lds
v_mfma_f32_16x16x32_bf16 v[176:179], a[132:135], a[76:79], v[176:179]
ds_read_b128 a[104:107], v5 offset:39936
v_mfma_f32_16x16x32_bf16 v[152:155], a[132:135], a[68:71], v[152:155]
v_mfma_f32_16x16x32_bf16 v[152:155], a[128:131], a[64:67], v[152:155]
buffer_load_dwordx4 a[52:55], v2, s[40:43], s33 offen offset:2048 sc1
v_mfma_f32_16x16x32_bf16 v[132:135], a[136:139], a[64:67], v[132:135]
ds_read_b128 a[108:111], v5 offset:46080
v_mfma_f32_16x16x32_bf16 v[132:135], a[140:143], a[68:71], v[132:135]
v_mfma_f32_16x16x32_bf16 v[156:159], a[140:143], a[76:79], v[156:159]
ds_read_b128 a[112:115], v5 offset:40960
v_mfma_f32_16x16x32_bf16 v[156:159], a[136:139], a[72:75], v[156:159]
buffer_load_dwordx4 v1, s[4:7], s44 offen offset:1024 sc1 lds
v_mfma_f32_16x16x32_bf16 v[180:183], a[136:139], a[80:83], v[180:183]
v_and_b32 v232, 15, v0
v_lshlrev_b32 v232, 7, v232
v_mfma_f32_16x16x32_bf16 v[180:183], a[140:143], a[84:87], v[180:183]
v_lshrrev_b32 v233, 4, v0
v_lshlrev_b32 v233, 4, v233
v_mfma_f32_16x16x32_bf16 v[204:207], a[140:143], a[92:95], v[204:207]
buffer_load_dwordx4 a[56:59], v2, s[40:43], s35 offen offset:3072 sc1
v_mfma_f32_16x16x32_bf16 v[204:207], a[136:139], a[88:91], v[204:207]
v_add_u32 v232, v233, v232
s_mul_i32 s38, s30, 12288
v_mfma_f32_16x16x32_bf16 v[208:211], a[144:147], a[88:91], v[208:211]
s_add_u32 s38, s38, 0x300000
s_add_u32 s39, s28, 4
s_min_u32 s39, s39, 5
v_mfma_f32_16x16x32_bf16 v[208:211], a[148:151], a[92:95], v[208:211]
s_lshl_b32 s36, s28, 11
s_add_u32 s36, s36, s38
s_lshl_b32 s37, s39, 11
s_add_u32 s37, s37, s38
v_mfma_f32_16x16x32_bf16 v[184:187], a[148:151], a[84:87], v[184:187]
buffer_load_dwordx4 v[48:51], v232, s[4:7], s36 offen sc1
v_mfma_f32_16x16x32_bf16 v[184:187], a[144:147], a[80:83], v[184:187]
ds_read_b128 a[116:119], v5 offset:47104
v_mfma_f32_16x16x32_bf16 v[160:163], a[144:147], a[72:75], v[160:163]
v_mfma_f32_16x16x32_bf16 v[160:163], a[148:151], a[76:79], v[160:163]
buffer_load_dwordx4 a[60:63], v2, s[40:43], s33 offen offset:3072 sc1
s_add_u32 s35, s35, 0x2000
v_mfma_f32_16x16x32_bf16 v[136:139], a[148:151], a[68:71], v[136:139]
s_add_u32 s33, s33, 0x2000
v_mfma_f32_16x16x32_bf16 v[136:139], a[144:147], a[64:67], v[136:139]
s_waitcnt vmcnt(13) lgkmcnt(0)
v_mfma_f32_16x16x32_bf16 v[140:143], a[96:99], a[0:3], v[140:143]
ds_read_b128 a[128:131], v5 offset:41984
v_mfma_f32_16x16x32_bf16 v[140:143], a[100:103], a[4:7], v[140:143]
buffer_load_dwordx4 a[64:67], v2, s[40:43], s35 offen offset:0 sc1
v_mfma_f32_16x16x32_bf16 v[164:167], a[100:103], a[12:15], v[164:167]
ds_read_b128 a[132:135], v5 offset:48128
v_mfma_f32_16x16x32_bf16 v[164:167], a[96:99], a[8:11], v[164:167]
v_mfma_f32_16x16x32_bf16 v[188:191], a[96:99], a[16:19], v[188:191]
v_mfma_f32_16x16x32_bf16 v[188:191], a[100:103], a[20:23], v[188:191]
buffer_load_dwordx4 v[52:55], v232, s[4:7], s37 offen sc1
s_add_u32 m0, s18, 0x18000
v_mfma_f32_16x16x32_bf16 v[212:215], a[100:103], a[28:31], v[212:215]
s_add_u32 s44, s50, 0x2c18000
ds_read_b128 a[136:139], v5 offset:36864
v_mfma_f32_16x16x32_bf16 v[212:215], a[96:99], a[24:27], v[212:215]
v_mfma_f32_16x16x32_bf16 v[216:219], a[104:107], a[24:27], v[216:219]
ds_read_b128 a[140:143], v5 offset:43008
v_mfma_f32_16x16x32_bf16 v[216:219], a[108:111], a[28:31], v[216:219]
buffer_load_dwordx4 a[68:71], v2, s[40:43], s33 offen offset:0 sc1
v_mfma_f32_16x16x32_bf16 v[192:195], a[108:111], a[20:23], v[192:195]
ds_read_b128 a[144:147], v5 offset:37888
v_mfma_f32_16x16x32_bf16 v[192:195], a[104:107], a[16:19], v[192:195]
v_mfma_f32_16x16x32_bf16 v[168:171], a[104:107], a[8:11], v[168:171]
v_mfma_f32_16x16x32_bf16 v[168:171], a[108:111], a[12:15], v[168:171]
buffer_load_dwordx4 a[72:75], v2, s[40:43], s35 offen offset:1024 sc1
v_mfma_f32_16x16x32_bf16 v[144:147], a[108:111], a[4:7], v[144:147]
ds_read_b128 a[148:151], v5 offset:44032
v_mfma_f32_16x16x32_bf16 v[144:147], a[104:107], a[0:3], v[144:147]
v_mfma_f32_16x16x32_bf16 v[148:151], a[112:115], a[0:3], v[148:151]
v_mfma_f32_16x16x32_bf16 v[148:151], a[116:119], a[4:7], v[148:151]
buffer_load_dwordx4 v1, s[4:7], s44 offen offset:0 sc1 lds
v_mfma_f32_16x16x32_bf16 v[172:175], a[116:119], a[12:15], v[172:175]
v_mfma_f32_16x16x32_bf16 v[172:175], a[112:115], a[8:11], v[172:175]
v_mfma_f32_16x16x32_bf16 v[196:199], a[112:115], a[16:19], v[196:199]
v_mfma_f32_16x16x32_bf16 v[196:199], a[116:119], a[20:23], v[196:199]
buffer_load_dwordx4 a[76:79], v2, s[40:43], s33 offen offset:1024 sc1
v_mfma_f32_16x16x32_bf16 v[220:223], a[116:119], a[28:31], v[220:223]
v_mfma_f32_16x16x32_bf16 v[220:223], a[112:115], a[24:27], v[220:223]
s_waitcnt lgkmcnt(0)
s_barrier
v_mfma_f32_16x16x32_bf16 v[224:227], a[128:131], a[24:27], v[224:227]
v_add_u32 v5, 49152, v1
v_mfma_f32_16x16x32_bf16 v[224:227], a[132:135], a[28:31], v[224:227]
buffer_load_dwordx4 a[80:83], v2, s[40:43], s35 offen offset:2048 sc1
v_mfma_f32_16x16x32_bf16 v[200:203], a[132:135], a[20:23], v[200:203]
ds_read_b128 a[96:99], v5 offset:2048
v_mfma_f32_16x16x32_bf16 v[200:203], a[128:131], a[16:19], v[200:203]
ds_read_b128 a[100:103], v5 offset:8192
v_mfma_f32_16x16x32_bf16 v[176:179], a[128:131], a[8:11], v[176:179]
ds_write_b128 v231, a[220:223] offset:24576
v_mfma_f32_16x16x32_bf16 v[176:179], a[132:135], a[12:15], v[176:179]
buffer_load_dwordx4 v1, s[4:7], s44 offen offset:1024 sc1 lds
s_add_u32 m0, s18, 0x1a000
v_mfma_f32_16x16x32_bf16 v[152:155], a[132:135], a[4:7], v[152:155]
s_add_u32 s44, s50, 0x2c1a000
ds_read_b128 a[104:107], v5 offset:3072
v_mfma_f32_16x16x32_bf16 v[152:155], a[128:131], a[0:3], v[152:155]
v_mfma_f32_16x16x32_bf16 v[132:135], a[136:139], a[0:3], v[132:135]
ds_read_b128 a[108:111], v5 offset:9216
v_mfma_f32_16x16x32_bf16 v[132:135], a[140:143], a[4:7], v[132:135]
buffer_load_dwordx4 a[84:87], v2, s[40:43], s33 offen offset:2048 sc1
v_mfma_f32_16x16x32_bf16 v[156:159], a[140:143], a[12:15], v[156:159]
ds_read_b128 a[112:115], v5 offset:4096
v_mfma_f32_16x16x32_bf16 v[156:159], a[136:139], a[8:11], v[156:159]
ds_write_b128 v231, a[224:227] offset:25600
v_mfma_f32_16x16x32_bf16 v[180:183], a[136:139], a[16:19], v[180:183]
v_mfma_f32_16x16x32_bf16 v[180:183], a[140:143], a[20:23], v[180:183]
buffer_load_dwordx4 a[88:91], v2, s[40:43], s35 offen offset:3072 sc1
v_mfma_f32_16x16x32_bf16 v[204:207], a[140:143], a[28:31], v[204:207]
ds_read_b128 a[116:119], v5 offset:10240
v_mfma_f32_16x16x32_bf16 v[204:207], a[136:139], a[24:27], v[204:207]
v_mfma_f32_16x16x32_bf16 v[208:211], a[144:147], a[24:27], v[208:211]
v_mfma_f32_16x16x32_bf16 v[208:211], a[148:151], a[28:31], v[208:211]
buffer_load_dwordx4 v1, s[4:7], s44 offen offset:0 sc1 lds
v_mfma_f32_16x16x32_bf16 v[184:187], a[148:151], a[20:23], v[184:187]
v_mfma_f32_16x16x32_bf16 v[184:187], a[144:147], a[16:19], v[184:187]
v_mfma_f32_16x16x32_bf16 v[160:163], a[144:147], a[8:11], v[160:163]
v_mfma_f32_16x16x32_bf16 v[160:163], a[148:151], a[12:15], v[160:163]
buffer_load_dwordx4 a[92:95], v2, s[40:43], s33 offen offset:3072 sc1
s_add_u32 s35, s35, 0x2000
v_mfma_f32_16x16x32_bf16 v[136:139], a[148:151], a[4:7], v[136:139]
s_add_u32 s33, s33, 0x2000
ds_write_b128 v231, a[188:191] offset:0
v_mfma_f32_16x16x32_bf16 v[136:139], a[144:147], a[0:3], v[136:139]
s_waitcnt vmcnt(12) lgkmcnt(1)
v_mfma_f32_16x16x32_bf16 v[140:143], a[96:99], a[32:35], v[140:143]
ds_read_b128 a[128:131], v5 offset:5120
v_mfma_f32_16x16x32_bf16 v[140:143], a[100:103], a[36:39], v[140:143]
buffer_load_dwordx4 a[0:3], v2, s[40:43], s35 offen offset:0 sc1
v_mfma_f32_16x16x32_bf16 v[164:167], a[100:103], a[44:47], v[164:167]
ds_read_b128 a[132:135], v5 offset:11264
v_mfma_f32_16x16x32_bf16 v[164:167], a[96:99], a[40:43], v[164:167]
v_mfma_f32_16x16x32_bf16 v[188:191], a[96:99], a[48:51], v[188:191]
v_mfma_f32_16x16x32_bf16 v[188:191], a[100:103], a[52:55], v[188:191]
buffer_load_dwordx4 v1, s[4:7], s44 offen offset:1024 sc1 lds
s_add_u32 m0, s18, 0x1c000
v_mfma_f32_16x16x32_bf16 v[212:215], a[100:103], a[60:63], v[212:215]
s_add_u32 s44, s50, 0x2c1c000
ds_read_b128 a[136:139], v5 offset:0
v_mfma_f32_16x16x32_bf16 v[212:215], a[96:99], a[56:59], v[212:215]
ds_write_b128 v231, a[192:195] offset:1024
v_mfma_f32_16x16x32_bf16 v[216:219], a[104:107], a[56:59], v[216:219]
ds_read_b128 a[140:143], v5 offset:6144
v_mfma_f32_16x16x32_bf16 v[216:219], a[108:111], a[60:63], v[216:219]
buffer_load_dwordx4 a[4:7], v2, s[40:43], s33 offen offset:0 sc1
v_mfma_f32_16x16x32_bf16 v[192:195], a[108:111], a[52:55], v[192:195]
ds_read_b128 a[144:147], v5 offset:1024
v_mfma_f32_16x16x32_bf16 v[192:195], a[104:107], a[48:51], v[192:195]
v_mfma_f32_16x16x32_bf16 v[168:171], a[104:107], a[40:43], v[168:171]
v_mfma_f32_16x16x32_bf16 v[168:171], a[108:111], a[44:47], v[168:171]
buffer_load_dwordx4 a[8:11], v2, s[40:43], s35 offen offset:1024 sc1
v_mfma_f32_16x16x32_bf16 v[144:147], a[108:111], a[36:39], v[144:147]
ds_read_b128 a[148:151], v5 offset:7168
v_mfma_f32_16x16x32_bf16 v[144:147], a[104:107], a[32:35], v[144:147]
v_mfma_f32_16x16x32_bf16 v[148:151], a[112:115], a[32:35], v[148:151]
v_mfma_f32_16x16x32_bf16 v[148:151], a[116:119], a[36:39], v[148:151]
buffer_load_dwordx4 v1, s[4:7], s44 offen offset:0 sc1 lds
v_mfma_f32_16x16x32_bf16 v[172:175], a[116:119], a[44:47], v[172:175]
ds_write_b128 v231, a[196:199] offset:8192
v_mfma_f32_16x16x32_bf16 v[172:175], a[112:115], a[40:43], v[172:175]
v_mfma_f32_16x16x32_bf16 v[196:199], a[112:115], a[48:51], v[196:199]
L_stub0:
s_cbranch_execz L_wret0
v_mfma_f32_16x16x32_bf16 v[196:199], a[116:119], a[52:55], v[196:199]
buffer_load_dwordx4 a[12:15], v2, s[40:43], s33 offen offset:1024 sc1
v_mfma_f32_16x16x32_bf16 v[220:223], a[116:119], a[60:63], v[220:223]
v_mfma_f32_16x16x32_bf16 v[220:223], a[112:115], a[56:59], v[220:223]
s_waitcnt lgkmcnt(1)
v_mfma_f32_16x16x32_bf16 v[224:227], a[128:131], a[56:59], v[224:227]
ds_read_b128 a[96:99], v5 offset:14336
v_mfma_f32_16x16x32_bf16 v[224:227], a[132:135], a[60:63], v[224:227]
buffer_load_dwordx4 a[16:19], v2, s[40:43], s35 offen offset:2048 sc1
v_mfma_f32_16x16x32_bf16 v[200:203], a[132:135], a[52:55], v[200:203]
ds_read_b128 a[100:103], v5 offset:20480
v_mfma_f32_16x16x32_bf16 v[200:203], a[128:131], a[48:51], v[200:203]
v_mfma_f32_16x16x32_bf16 v[176:179], a[128:131], a[40:43], v[176:179]
v_mfma_f32_16x16x32_bf16 v[176:179], a[132:135], a[44:47], v[176:179]
buffer_load_dwordx4 v1, s[4:7], s44 offen offset:1024 sc1 lds
s_add_u32 s88, s82, 0x200000
v_mfma_f32_16x16x32_bf16 v[152:155], a[132:135], a[36:39], v[152:155]
ds_read_b128 a[104:107], v5 offset:15360
v_mfma_f32_16x16x32_bf16 v[152:155], a[128:131], a[32:35], v[152:155]
ds_write_b128 v231, a[200:203] offset:9216
v_mfma_f32_16x16x32_bf16 v[132:135], a[136:139], a[32:35], v[132:135]
ds_read_b128 a[108:111], v5 offset:21504
v_mfma_f32_16x16x32_bf16 v[132:135], a[140:143], a[36:39], v[132:135]
buffer_load_dwordx4 a[20:23], v2, s[40:43], s33 offen offset:2048 sc1
v_mfma_f32_16x16x32_bf16 v[156:159], a[140:143], a[44:47], v[156:159]
ds_read_b128 a[112:115], v5 offset:16384
v_mfma_f32_16x16x32_bf16 v[156:159], a[136:139], a[40:43], v[156:159]
v_mfma_f32_16x16x32_bf16 v[180:183], a[136:139], a[48:51], v[180:183]
v_mfma_f32_16x16x32_bf16 v[180:183], a[140:143], a[52:55], v[180:183]
buffer_load_dwordx4 a[24:27], v2, s[40:43], s35 offen offset:3072 sc1
v_mfma_f32_16x16x32_bf16 v[204:207], a[140:143], a[60:63], v[204:207]
ds_read_b128 a[116:119], v5 offset:22528
v_mfma_f32_16x16x32_bf16 v[204:207], a[136:139], a[56:59], v[204:207]
ds_write_b128 v231, a[204:207] offset:16384
v_mfma_f32_16x16x32_bf16 v[208:211], a[144:147], a[56:59], v[208:211]
v_mfma_f32_16x16x32_bf16 v[208:211], a[148:151], a[60:63], v[208:211]
buffer_load_dwordx4 v[92:95], v1, s[4:7], s88 offen offset:0 sc1
v_mfma_f32_16x16x32_bf16 v[184:187], a[148:151], a[52:55], v[184:187]
v_mfma_f32_16x16x32_bf16 v[184:187], a[144:147], a[48:51], v[184:187]
v_mfma_f32_16x16x32_bf16 v[160:163], a[144:147], a[40:43], v[160:163]
v_mfma_f32_16x16x32_bf16 v[160:163], a[148:151], a[44:47], v[160:163]
buffer_load_dwordx4 a[28:31], v2, s[40:43], s33 offen offset:3072 sc1
s_add_u32 s35, s35, 0x2000
v_mfma_f32_16x16x32_bf16 v[136:139], a[148:151], a[36:39], v[136:139]
s_add_u32 s33, s33, 0x2000
v_mfma_f32_16x16x32_bf16 v[136:139], a[144:147], a[32:35], v[136:139]
s_waitcnt vmcnt(12) lgkmcnt(1)
v_mfma_f32_16x16x32_bf16 v[140:143], a[96:99], a[64:67], v[140:143]
ds_read_b128 a[128:131], v5 offset:17408
v_mfma_f32_16x16x32_bf16 v[140:143], a[100:103], a[68:71], v[140:143]
buffer_load_dwordx4 a[32:35], v2, s[40:43], s35 offen offset:0 sc1
v_mfma_f32_16x16x32_bf16 v[164:167], a[100:103], a[76:79], v[164:167]
ds_read_b128 a[132:135], v5 offset:23552
v_mfma_f32_16x16x32_bf16 v[164:167], a[96:99], a[72:75], v[164:167]
ds_write_b128 v231, a[208:211] offset:17408
v_mfma_f32_16x16x32_bf16 v[188:191], a[96:99], a[80:83], v[188:191]
v_mfma_f32_16x16x32_bf16 v[188:191], a[100:103], a[84:87], v[188:191]
buffer_load_dwordx4 v[96:99], v1, s[4:7], s88 offen offset:1024 sc1
v_mfma_f32_16x16x32_bf16 v[212:215], a[100:103], a[92:95], v[212:215]
ds_read_b128 a[136:139], v5 offset:12288
v_mfma_f32_16x16x32_bf16 v[212:215], a[96:99], a[88:91], v[212:215]
v_mfma_f32_16x16x32_bf16 v[216:219], a[104:107], a[88:91], v[216:219]
ds_read_b128 a[140:143], v5 offset:18432
v_mfma_f32_16x16x32_bf16 v[216:219], a[108:111], a[92:95], v[216:219]
buffer_load_dwordx4 a[36:39], v2, s[40:43], s33 offen offset:0 sc1
v_mfma_f32_16x16x32_bf16 v[192:195], a[108:111], a[84:87], v[192:195]
ds_read_b128 a[144:147], v5 offset:13312
v_mfma_f32_16x16x32_bf16 v[192:195], a[104:107], a[80:83], v[192:195]
v_mfma_f32_16x16x32_bf16 v[168:171], a[104:107], a[72:75], v[168:171]
v_mfma_f32_16x16x32_bf16 v[168:171], a[108:111], a[76:79], v[168:171]
buffer_load_dwordx4 a[40:43], v2, s[40:43], s35 offen offset:1024 sc1
v_mfma_f32_16x16x32_bf16 v[144:147], a[108:111], a[68:71], v[144:147]
ds_read_b128 a[148:151], v5 offset:19456
v_mfma_f32_16x16x32_bf16 v[144:147], a[104:107], a[64:67], v[144:147]
v_mfma_f32_16x16x32_bf16 v[148:151], a[112:115], a[64:67], v[148:151]
v_mfma_f32_16x16x32_bf16 v[148:151], a[116:119], a[68:71], v[148:151]
buffer_load_dwordx4 v[100:103], v1, s[4:7], s88 offen offset:2048 sc1
v_mfma_f32_16x16x32_bf16 v[172:175], a[116:119], a[76:79], v[172:175]
v_mfma_f32_16x16x32_bf16 v[172:175], a[112:115], a[72:75], v[172:175]
v_mfma_f32_16x16x32_bf16 v[196:199], a[112:115], a[80:83], v[196:199]
v_mfma_f32_16x16x32_bf16 v[196:199], a[116:119], a[84:87], v[196:199]
buffer_load_dwordx4 a[44:47], v2, s[40:43], s33 offen offset:1024 sc1
v_mfma_f32_16x16x32_bf16 v[220:223], a[116:119], a[92:95], v[220:223]
v_mfma_f32_16x16x32_bf16 v[220:223], a[112:115], a[88:91], v[220:223]
s_waitcnt lgkmcnt(0)
s_barrier
v_mfma_f32_16x16x32_bf16 v[224:227], a[128:131], a[88:91], v[224:227]
ds_read_b128 a[96:99], v5 offset:26624
v_mfma_f32_16x16x32_bf16 v[224:227], a[132:135], a[92:95], v[224:227]
buffer_load_dwordx4 a[48:51], v2, s[40:43], s35 offen offset:2048 sc1
v_mfma_f32_16x16x32_bf16 v[200:203], a[132:135], a[84:87], v[200:203]
ds_read_b128 a[100:103], v5 offset:32768
v_mfma_f32_16x16x32_bf16 v[200:203], a[128:131], a[80:83], v[200:203]
ds_read_b64_tr_b16 a[220:221], v230 offset:0
v_mfma_f32_16x16x32_bf16 v[176:179], a[128:131], a[72:75], v[176:179]
v_mfma_f32_16x16x32_bf16 v[176:179], a[132:135], a[76:79], v[176:179]
buffer_load_dwordx4 v[104:107], v1, s[4:7], s88 offen offset:3072 sc1
s_add_u32 s88, s88, 4096
v_mfma_f32_16x16x32_bf16 v[152:155], a[132:135], a[68:71], v[152:155]
ds_read_b128 a[104:107], v5 offset:27648
v_mfma_f32_16x16x32_bf16 v[152:155], a[128:131], a[64:67], v[152:155]
ds_read_b64_tr_b16 a[222:223], v230 offset:2048
v_mfma_f32_16x16x32_bf16 v[132:135], a[136:139], a[64:67], v[132:135]
ds_read_b128 a[108:111], v5 offset:33792
v_mfma_f32_16x16x32_bf16 v[132:135], a[140:143], a[68:71], v[132:135]
buffer_load_dwordx4 a[52:55], v2, s[40:43], s33 offen offset:2048 sc1
v_mfma_f32_16x16x32_bf16 v[156:159], a[140:143], a[76:79], v[156:159]
ds_read_b128 a[112:115], v5 offset:28672
v_mfma_f32_16x16x32_bf16 v[156:159], a[136:139], a[72:75], v[156:159]
ds_read_b64_tr_b16 a[224:225], v230 offset:8
v_mfma_f32_16x16x32_bf16 v[180:183], a[136:139], a[80:83], v[180:183]
v_mfma_f32_16x16x32_bf16 v[180:183], a[140:143], a[84:87], v[180:183]
buffer_load_dwordx4 a[56:59], v2, s[40:43], s35 offen offset:3072 sc1
v_mfma_f32_16x16x32_bf16 v[204:207], a[140:143], a[92:95], v[204:207]
ds_read_b128 a[116:119], v5 offset:34816
v_mfma_f32_16x16x32_bf16 v[204:207], a[136:139], a[88:91], v[204:207]
v_mfma_f32_16x16x32_bf16 v[208:211], a[144:147], a[88:91], v[208:211]
ds_read_b64_tr_b16 a[226:227], v230 offset:2056
v_mfma_f32_16x16x32_bf16 v[208:211], a[148:151], a[92:95], v[208:211]
buffer_load_dwordx4 v[108:111], v1, s[4:7], s88 offen offset:0 sc1
v_mfma_f32_16x16x32_bf16 v[184:187], a[148:151], a[84:87], v[184:187]
v_mfma_f32_16x16x32_bf16 v[184:187], a[144:147], a[80:83], v[184:187]
v_mfma_f32_16x16x32_bf16 v[160:163], a[144:147], a[72:75], v[160:163]
v_mfma_f32_16x16x32_bf16 v[160:163], a[148:151], a[76:79], v[160:163]
buffer_load_dwordx4 a[60:63], v2, s[40:43], s33 offen offset:3072 sc1
s_add_u32 s35, s35, 0x2000
v_mfma_f32_16x16x32_bf16 v[136:139], a[148:151], a[68:71], v[136:139]
s_add_u32 s33, s33, 0x2000
ds_read_b64_tr_b16 a[188:189], v248 offset:0
v_mfma_f32_16x16x32_bf16 v[136:139], a[144:147], a[64:67], v[136:139]
s_waitcnt vmcnt(12) lgkmcnt(2)
v_mfma_f32_16x16x32_bf16 v[140:143], a[96:99], a[0:3], v[140:143]
ds_read_b128 a[128:131], v5 offset:29696
v_add_f32_dpp v48, v48, v48 row_ror:8 row_mask:0xf bank_mask:0xf
v_mfma_f32_16x16x32_bf16 v[140:143], a[100:103], a[4:7], v[140:143]
buffer_load_dwordx4 a[64:67], v2, s[40:43], s35 offen offset:0 sc1
v_mfma_f32_16x16x32_bf16 v[164:167], a[100:103], a[12:15], v[164:167]
ds_read_b128 a[132:135], v5 offset:35840
v_add_f32_dpp v49, v49, v49 row_ror:8 row_mask:0xf bank_mask:0xf
v_mfma_f32_16x16x32_bf16 v[164:167], a[96:99], a[8:11], v[164:167]
ds_read_b64_tr_b16 a[190:191], v248 offset:512
v_add_f32_dpp v50, v50, v50 row_ror:8 row_mask:0xf bank_mask:0xf
v_mfma_f32_16x16x32_bf16 v[188:191], a[96:99], a[16:19], v[188:191]
v_add_f32_dpp v51, v51, v51 row_ror:8 row_mask:0xf bank_mask:0xf
v_add_f32_dpp v52, v52, v52 row_ror:8 row_mask:0xf bank_mask:0xf
v_mfma_f32_16x16x32_bf16 v[188:191], a[100:103], a[20:23], v[188:191]
buffer_load_dwordx4 v[112:115], v1, s[4:7], s88 offen offset:1024 sc1
v_mfma_f32_16x16x32_bf16 v[212:215], a[100:103], a[28:31], v[212:215]
ds_read_b128 a[136:139], v5 offset:24576
v_add_f32_dpp v53, v53, v53 row_ror:8 row_mask:0xf bank_mask:0xf
v_mfma_f32_16x16x32_bf16 v[212:215], a[96:99], a[24:27], v[212:215]
v_add_f32_dpp v54, v54, v54 row_ror:8 row_mask:0xf bank_mask:0xf
v_add_f32_dpp v55, v55, v55 row_ror:8 row_mask:0xf bank_mask:0xf
v_mfma_f32_16x16x32_bf16 v[216:219], a[104:107], a[24:27], v[216:219]
ds_read_b128 a[140:143], v5 offset:30720
v_add_f32_dpp v48, v48, v48 row_ror:4 row_mask:0xf bank_mask:0xf
v_mfma_f32_16x16x32_bf16 v[216:219], a[108:111], a[28:31], v[216:219]
buffer_load_dwordx4 a[68:71], v2, s[40:43], s33 offen offset:0 sc1
v_mfma_f32_16x16x32_bf16 v[192:195], a[108:111], a[20:23], v[192:195]
ds_read_b128 a[144:147], v5 offset:25600
v_add_f32_dpp v49, v49, v49 row_ror:4 row_mask:0xf bank_mask:0xf
v_mfma_f32_16x16x32_bf16 v[192:195], a[104:107], a[16:19], v[192:195]
ds_read_b64_tr_b16 a[192:193], v248 offset:4096
v_add_f32_dpp v50, v50, v50 row_ror:4 row_mask:0xf bank_mask:0xf
v_mfma_f32_16x16x32_bf16 v[168:171], a[104:107], a[8:11], v[168:171]
v_add_f32_dpp v51, v51, v51 row_ror:4 row_mask:0xf bank_mask:0xf
v_add_f32_dpp v52, v52, v52 row_ror:4 row_mask:0xf bank_mask:0xf
v_mfma_f32_16x16x32_bf16 v[168:171], a[108:111], a[12:15], v[168:171]
buffer_load_dwordx4 a[72:75], v2, s[40:43], s35 offen offset:1024 sc1
v_mfma_f32_16x16x32_bf16 v[144:147], a[108:111], a[4:7], v[144:147]
ds_read_b128 a[148:151], v5 offset:31744
v_add_f32_dpp v53, v53, v53 row_ror:4 row_mask:0xf bank_mask:0xf
v_mfma_f32_16x16x32_bf16 v[144:147], a[104:107], a[0:3], v[144:147]
ds_read_b64_tr_b16 a[194:195], v248 offset:4608
v_add_f32_dpp v54, v54, v54 row_ror:4 row_mask:0xf bank_mask:0xf
v_mfma_f32_16x16x32_bf16 v[148:151], a[112:115], a[0:3], v[148:151]
v_add_f32_dpp v55, v55, v55 row_ror:4 row_mask:0xf bank_mask:0xf
v_add_f32_dpp v48, v48, v48 row_ror:2 row_mask:0xf bank_mask:0xf
v_mfma_f32_16x16x32_bf16 v[148:151], a[116:119], a[4:7], v[148:151]
buffer_load_dwordx4 v[116:119], v1, s[4:7], s88 offen offset:2048 sc1
v_mfma_f32_16x16x32_bf16 v[172:175], a[116:119], a[12:15], v[172:175]
v_add_f32_dpp v49, v49, v49 row_ror:2 row_mask:0xf bank_mask:0xf
v_add_f32_dpp v50, v50, v50 row_ror:2 row_mask:0xf bank_mask:0xf
v_mfma_f32_16x16x32_bf16 v[172:175], a[112:115], a[8:11], v[172:175]
v_add_f32_dpp v51, v51, v51 row_ror:2 row_mask:0xf bank_mask:0xf
v_add_f32_dpp v52, v52, v52 row_ror:2 row_mask:0xf bank_mask:0xf
v_mfma_f32_16x16x32_bf16 v[196:199], a[112:115], a[16:19], v[196:199]
ds_read_b64_tr_b16 a[196:197], v249 offset:32
v_add_f32_dpp v53, v53, v53 row_ror:2 row_mask:0xf bank_mask:0xf
v_mfma_f32_16x16x32_bf16 v[196:199], a[116:119], a[20:23], v[196:199]
buffer_load_dwordx4 a[76:79], v2, s[40:43], s33 offen offset:1024 sc1
v_mfma_f32_16x16x32_bf16 v[220:223], a[116:119], a[28:31], v[220:223]
v_add_f32_dpp v54, v54, v54 row_ror:2 row_mask:0xf bank_mask:0xf
v_add_f32_dpp v55, v55, v55 row_ror:2 row_mask:0xf bank_mask:0xf
v_mfma_f32_16x16x32_bf16 v[220:223], a[112:115], a[24:27], v[220:223]
v_add_f32_dpp v48, v48, v48 row_ror:1 row_mask:0xf bank_mask:0xf
s_waitcnt lgkmcnt(2)
v_mfma_f32_16x16x32_bf16 v[224:227], a[128:131], a[24:27], v[224:227]
ds_read_b128 a[96:99], v5 offset:38912
v_add_f32_dpp v49, v49, v49 row_ror:1 row_mask:0xf bank_mask:0xf
v_mfma_f32_16x16x32_bf16 v[224:227], a[132:135], a[28:31], v[224:227]
buffer_load_dwordx4 a[80:83], v2, s[40:43], s35 offen offset:2048 sc1
v_mfma_f32_16x16x32_bf16 v[200:203], a[132:135], a[20:23], v[200:203]
ds_read_b128 a[100:103], v5 offset:45056
v_add_f32_dpp v50, v50, v50 row_ror:1 row_mask:0xf bank_mask:0xf
v_mfma_f32_16x16x32_bf16 v[200:203], a[128:131], a[16:19], v[200:203]
ds_read_b64_tr_b16 a[198:199], v249 offset:544
v_add_f32_dpp v51, v51, v51 row_ror:1 row_mask:0xf bank_mask:0xf
v_mfma_f32_16x16x32_bf16 v[176:179], a[128:131], a[8:11], v[176:179]
buffer_load_dwordx4 v[120:123], v1, s[4:7], s88 offen offset:3072 sc1
s_add_u32 m0, s18, 0x1e000
v_mfma_f32_16x16x32_bf16 v[176:179], a[132:135], a[12:15], v[176:179]
s_add_u32 s44, s50, 0x2c1e000
ds_read_b128 a[104:107], v5 offset:39936
v_mfma_f32_16x16x32_bf16 v[152:155], a[132:135], a[4:7], v[152:155]
v_add_f32_dpp v52, v52, v52 row_ror:1 row_mask:0xf bank_mask:0xf
v_add_f32_dpp v53, v53, v53 row_ror:1 row_mask:0xf bank_mask:0xf
v_mfma_f32_16x16x32_bf16 v[152:155], a[128:131], a[0:3], v[152:155]
buffer_load_dwordx4 a[84:87], v2, s[40:43], s33 offen offset:2048 sc1
v_mfma_f32_16x16x32_bf16 v[132:135], a[136:139], a[0:3], v[132:135]
ds_read_b128 a[108:111], v5 offset:46080
v_add_f32_dpp v54, v54, v54 row_ror:1 row_mask:0xf bank_mask:0xf
v_mfma_f32_16x16x32_bf16 v[132:135], a[140:143], a[4:7], v[132:135]
ds_read_b64_tr_b16 a[200:201], v249 offset:4128
v_add_f32_dpp v55, v55, v55 row_ror:1 row_mask:0xf bank_mask:0xf
v_mfma_f32_16x16x32_bf16 v[156:159], a[140:143], a[12:15], v[156:159]
ds_read_b128 a[112:115], v5 offset:40960
v_add_u32 v233, 159744, v233
v_mfma_f32_16x16x32_bf16 v[156:159], a[136:139], a[8:11], v[156:159]
buffer_load_dwordx4 v1, s[4:7], s44 offen offset:0 sc1 lds
s_lshl_b32 s36, s28, 6
v_mfma_f32_16x16x32_bf16 v[180:183], a[136:139], a[16:19], v[180:183]
ds_read_b64_tr_b16 a[202:203], v249 offset:4640
s_lshl_b32 s37, s39, 6
v_mfma_f32_16x16x32_bf16 v[180:183], a[140:143], a[20:23], v[180:183]
ds_read_b128 a[116:119], v5 offset:47104
v_add_u32 v232, s36, v233
v_mfma_f32_16x16x32_bf16 v[204:207], a[140:143], a[28:31], v[204:207]
buffer_load_dwordx4 a[88:91], v2, s[40:43], s35 offen offset:3072 sc1
v_mfma_f32_16x16x32_bf16 v[204:207], a[136:139], a[24:27], v[204:207]
v_add_u32 v235, s37, v233
v_mfma_f32_16x16x32_bf16 v[208:211], a[144:147], a[24:27], v[208:211]
v_mfma_f32_16x16x32_bf16 v[208:211], a[148:151], a[28:31], v[208:211]
v_mfma_f32_16x16x32_bf16 v[184:187], a[148:151], a[20:23], v[184:187]
buffer_load_dwordx4 v1, s[4:7], s44 offen offset:1024 sc1 lds
s_add_u32 m0, s18, 0x20000
v_mfma_f32_16x16x32_bf16 v[184:187], a[144:147], a[16:19], v[184:187]
s_add_u32 s44, s50, 0x2c20000
ds_read_b64_tr_b16 a[204:205], v248 offset:8192
v_mfma_f32_16x16x32_bf16 v[160:163], a[144:147], a[8:11], v[160:163]
v_mfma_f32_16x16x32_bf16 v[160:163], a[148:151], a[12:15], v[160:163]
buffer_load_dwordx4 a[92:95], v2, s[40:43], s33 offen offset:3072 sc1
s_add_u32 s35, s35, 0x2000
v_mfma_f32_16x16x32_bf16 v[136:139], a[148:151], a[4:7], v[136:139]
s_add_u32 s33, s33, 0x2000
v_mfma_f32_16x16x32_bf16 v[136:139], a[144:147], a[0:3], v[136:139]
ds_read_b64_tr_b16 a[206:207], v248 offset:8704
s_waitcnt vmcnt(13) lgkmcnt(2)
v_mfma_f32_16x16x32_bf16 v[140:143], a[96:99], a[32:35], v[140:143]
ds_read_b128 a[128:131], v5 offset:41984
v_mfma_f32_16x16x32_bf16 v[140:143], a[100:103], a[36:39], v[140:143]
buffer_load_dwordx4 a[0:3], v2, s[40:43], s35 offen offset:0 sc1
v_mfma_f32_16x16x32_bf16 v[164:167], a[100:103], a[44:47], v[164:167]
ds_read_b128 a[132:135], v5 offset:48128
v_mfma_f32_16x16x32_bf16 v[164:167], a[96:99], a[40:43], v[164:167]
ds_write_b128 v232, v[48:51]
v_mfma_f32_16x16x32_bf16 v[188:191], a[96:99], a[48:51], v[188:191]
ds_write_b128 v235, v[52:55]
v_mfma_f32_16x16x32_bf16 v[188:191], a[100:103], a[52:55], v[188:191]
buffer_load_dwordx4 v1, s[4:7], s44 offen offset:0 sc1 lds
v_mfma_f32_16x16x32_bf16 v[212:215], a[100:103], a[60:63], v[212:215]
ds_read_b128 a[136:139], v5 offset:36864
v_mfma_f32_16x16x32_bf16 v[212:215], a[96:99], a[56:59], v[212:215]
ds_read_b64_tr_b16 a[208:209], v248 offset:12288
v_mfma_f32_16x16x32_bf16 v[216:219], a[104:107], a[56:59], v[216:219]
ds_read_b128 a[140:143], v5 offset:43008
v_mfma_f32_16x16x32_bf16 v[216:219], a[108:111], a[60:63], v[216:219]
buffer_load_dwordx4 a[4:7], v2, s[40:43], s33 offen offset:0 sc1
v_mfma_f32_16x16x32_bf16 v[192:195], a[108:111], a[52:55], v[192:195]
ds_read_b128 a[144:147], v5 offset:37888
v_mfma_f32_16x16x32_bf16 v[192:195], a[104:107], a[48:51], v[192:195]
ds_read_b64_tr_b16 a[210:211], v248 offset:12800
v_mfma_f32_16x16x32_bf16 v[168:171], a[104:107], a[40:43], v[168:171]
v_mfma_f32_16x16x32_bf16 v[168:171], a[108:111], a[44:47], v[168:171]
ds_read_b128 a[148:151], v5 offset:44032
v_mfma_f32_16x16x32_bf16 v[144:147], a[108:111], a[36:39], v[144:147]
buffer_load_dwordx4 a[8:11], v2, s[40:43], s35 offen offset:1024 sc1
v_mfma_f32_16x16x32_bf16 v[144:147], a[104:107], a[32:35], v[144:147]
v_mfma_f32_16x16x32_bf16 v[148:151], a[112:115], a[32:35], v[148:151]
v_mfma_f32_16x16x32_bf16 v[148:151], a[116:119], a[36:39], v[148:151]
v_mfma_f32_16x16x32_bf16 v[172:175], a[116:119], a[44:47], v[172:175]
buffer_load_dword v11, v1, s[24:27], 0 offen sc1
v_mfma_f32_16x16x32_bf16 v[172:175], a[112:115], a[40:43], v[172:175]
v_mfma_f32_16x16x32_bf16 v[196:199], a[112:115], a[48:51], v[196:199]
buffer_load_dwordx4 a[12:15], v2, s[40:43], s33 offen offset:1024 sc1
v_mfma_f32_16x16x32_bf16 v[196:199], a[116:119], a[52:55], v[196:199]
v_mfma_f32_16x16x32_bf16 v[220:223], a[116:119], a[60:63], v[220:223]
v_mfma_f32_16x16x32_bf16 v[220:223], a[112:115], a[56:59], v[220:223]
s_waitcnt lgkmcnt(0)
s_barrier
v_mfma_f32_16x16x32_bf16 v[224:227], a[128:131], a[56:59], v[224:227]
v_add_u32 v5, 98304, v1
v_mfma_f32_16x16x32_bf16 v[224:227], a[132:135], a[60:63], v[224:227]
buffer_load_dwordx4 a[16:19], v2, s[40:43], s35 offen offset:2048 sc1
v_mfma_f32_16x16x32_bf16 v[200:203], a[132:135], a[52:55], v[200:203]
ds_read_b128 a[96:99], v5 offset:2048
v_mfma_f32_16x16x32_bf16 v[200:203], a[128:131], a[48:51], v[200:203]
ds_read_b128 a[100:103], v5 offset:8192
v_mfma_f32_16x16x32_bf16 v[176:179], a[128:131], a[40:43], v[176:179]
ds_read_b128 v[48:51], v233 offset:0
v_mfma_f32_16x16x32_bf16 v[176:179], a[132:135], a[44:47], v[176:179]
buffer_load_dwordx4 v1, s[4:7], s44 offen offset:1024 sc1 lds
s_add_u32 m0, s18, 0x22000
v_mfma_f32_16x16x32_bf16 v[152:155], a[132:135], a[36:39], v[152:155]
s_add_u32 s44, s50, 0x2c22000
ds_read_b128 a[104:107], v5 offset:3072
v_mfma_f32_16x16x32_bf16 v[152:155], a[128:131], a[32:35], v[152:155]
v_mfma_f32_16x16x32_bf16 v[132:135], a[136:139], a[32:35], v[132:135]
ds_read_b128 a[108:111], v5 offset:9216
v_mfma_f32_16x16x32_bf16 v[132:135], a[140:143], a[36:39], v[132:135]
buffer_load_dwordx4 a[20:23], v2, s[40:43], s33 offen offset:2048 sc1
v_mfma_f32_16x16x32_bf16 v[156:159], a[140:143], a[44:47], v[156:159]
ds_read_b128 a[112:115], v5 offset:4096
v_mfma_f32_16x16x32_bf16 v[156:159], a[136:139], a[40:43], v[156:159]
ds_read_b128 v[52:55], v233 offset:64
v_mfma_f32_16x16x32_bf16 v[180:183], a[136:139], a[48:51], v[180:183]
v_mfma_f32_16x16x32_bf16 v[180:183], a[140:143], a[52:55], v[180:183]
buffer_load_dwordx4 a[24:27], v2, s[40:43], s35 offen offset:3072 sc1
v_mfma_f32_16x16x32_bf16 v[204:207], a[140:143], a[60:63], v[204:207]
ds_read_b128 a[116:119], v5 offset:10240
v_mfma_f32_16x16x32_bf16 v[204:207], a[136:139], a[56:59], v[204:207]
v_mfma_f32_16x16x32_bf16 v[208:211], a[144:147], a[56:59], v[208:211]
v_mfma_f32_16x16x32_bf16 v[208:211], a[148:151], a[60:63], v[208:211]
buffer_load_dwordx4 v1, s[4:7], s44 offen offset:0 sc1 lds
v_mfma_f32_16x16x32_bf16 v[184:187], a[148:151], a[52:55], v[184:187]
v_mfma_f32_16x16x32_bf16 v[184:187], a[144:147], a[48:51], v[184:187]
v_mfma_f32_16x16x32_bf16 v[160:163], a[144:147], a[40:43], v[160:163]
v_mfma_f32_16x16x32_bf16 v[160:163], a[148:151], a[44:47], v[160:163]
buffer_load_dwordx4 a[28:31], v2, s[40:43], s33 offen offset:3072 sc1
s_add_u32 s35, s35, 0x2000
v_mfma_f32_16x16x32_bf16 v[136:139], a[148:151], a[36:39], v[136:139]
s_add_u32 s33, s33, 0x2000
ds_read_b128 v[56:59], v233 offset:128
v_mfma_f32_16x16x32_bf16 v[136:139], a[144:147], a[32:35], v[136:139]
s_waitcnt vmcnt(12) lgkmcnt(1)
v_mfma_f32_16x16x32_bf16 v[140:143], a[96:99], a[64:67], v[140:143]
ds_read_b128 a[128:131], v5 offset:5120
v_mfma_f32_16x16x32_bf16 v[140:143], a[100:103], a[68:71], v[140:143]
buffer_load_dwordx4 a[32:35], v2, s[40:43], s35 offen offset:0 sc1
v_mfma_f32_16x16x32_bf16 v[164:167], a[100:103], a[76:79], v[164:167]
ds_read_b128 a[132:135], v5 offset:11264
v_mfma_f32_16x16x32_bf16 v[164:167], a[96:99], a[72:75], v[164:167]
v_mfma_f32_16x16x32_bf16 v[236:239], a[188:191], v[16:19], 0
v_mfma_f32_16x16x32_bf16 v[188:191], a[96:99], a[80:83], v[188:191]
v_mfma_f32_16x16x32_bf16 v[240:243], a[196:199], v[16:19], 0
v_mfma_f32_16x16x32_bf16 v[188:191], a[100:103], a[84:87], v[188:191]
buffer_load_dwordx4 v1, s[4:7], s44 offen offset:1024 sc1 lds
s_add_u32 m0, s18, 0x0
v_mfma_f32_16x16x32_bf16 v[212:215], a[100:103], a[92:95], v[212:215]
s_add_u32 s44, s50, 0x2c24000
ds_read_b128 a[136:139], v5 offset:0
v_mfma_f32_16x16x32_bf16 v[212:215], a[96:99], a[88:91], v[212:215]
v_mfma_f32_16x16x32_bf16 v[216:219], a[104:107], a[88:91], v[216:219]
ds_read_b128 a[140:143], v5 offset:6144
v_mfma_f32_16x16x32_bf16 v[216:219], a[108:111], a[92:95], v[216:219]
buffer_load_dwordx4 a[36:39], v2, s[40:43], s33 offen offset:0 sc1
v_mfma_f32_16x16x32_bf16 v[192:195], a[108:111], a[84:87], v[192:195]
ds_read_b128 a[144:147], v5 offset:1024
v_mfma_f32_16x16x32_bf16 v[192:195], a[104:107], a[80:83], v[192:195]
v_mfma_f32_16x16x32_bf16 v[244:247], a[204:207], v[16:19], 0
v_mfma_f32_16x16x32_bf16 v[168:171], a[104:107], a[72:75], v[168:171]
v_mfma_f32_16x16x32_bf16 v[236:239], a[192:195], v[16:19], v[236:239]
v_mfma_f32_16x16x32_bf16 v[168:171], a[108:111], a[76:79], v[168:171]
buffer_load_dwordx4 a[40:43], v2, s[40:43], s35 offen offset:1024 sc1
v_mfma_f32_16x16x32_bf16 v[144:147], a[108:111], a[68:71], v[144:147]
ds_read_b128 a[148:151], v5 offset:7168
v_mfma_f32_16x16x32_bf16 v[144:147], a[104:107], a[64:67], v[144:147]
ds_read_b128 v[60:63], v233 offset:192
v_mfma_f32_16x16x32_bf16 v[148:151], a[112:115], a[64:67], v[148:151]
v_mfma_f32_16x16x32_bf16 v[240:243], a[200:203], v[16:19], v[240:243]
v_mfma_f32_16x16x32_bf16 v[148:151], a[116:119], a[68:71], v[148:151]
buffer_load_dwordx4 v1, s[4:7], s44 offen offset:0 sc1 lds
v_mfma_f32_16x16x32_bf16 v[172:175], a[116:119], a[76:79], v[172:175]
ds_read_b128 v[64:67], v233 offset:256
v_mfma_f32_16x16x32_bf16 v[172:175], a[112:115], a[72:75], v[172:175]
v_mfma_f32_16x16x32_bf16 v[196:199], a[112:115], a[80:83], v[196:199]
v_mfma_f32_16x16x32_bf16 v[244:247], a[208:211], v[16:19], v[244:247]
v_mfma_f32_16x16x32_bf16 v[196:199], a[116:119], a[84:87], v[196:199]
buffer_load_dwordx4 a[44:47], v2, s[40:43], s33 offen offset:1024 sc1
v_mfma_f32_16x16x32_bf16 v[220:223], a[116:119], a[92:95], v[220:223]
v_mfma_f32_16x16x32_bf16 v[220:223], a[112:115], a[88:91], v[220:223]
s_waitcnt lgkmcnt(2)
v_mfma_f32_16x16x32_bf16 v[224:227], a[128:131], a[88:91], v[224:227]
ds_read_b128 a[96:99], v5 offset:14336
v_mfma_f32_16x16x32_bf16 v[224:227], a[132:135], a[92:95], v[224:227]
buffer_load_dwordx4 a[48:51], v2, s[40:43], s35 offen offset:2048 sc1
v_mfma_f32_16x16x32_bf16 v[200:203], a[132:135], a[84:87], v[200:203]
ds_read_b128 a[100:103], v5 offset:20480
v_mfma_f32_16x16x32_bf16 v[200:203], a[128:131], a[80:83], v[200:203]
v_mfma_f32_16x16x32_bf16 v[176:179], a[128:131], a[72:75], v[176:179]
buffer_load_dwordx4 v1, s[4:7], s44 offen offset:1024 sc1 lds
s_add_u32 m0, s18, 0x2000
v_mfma_f32_16x16x32_bf16 v[176:179], a[132:135], a[76:79], v[176:179]
s_add_u32 s44, s50, 0x2c26000
ds_read_b128 a[104:107], v5 offset:15360
v_mfma_f32_16x16x32_bf16 v[152:155], a[132:135], a[68:71], v[152:155]
ds_read_b128 v[68:71], v233 offset:320
v_mfma_f32_16x16x32_bf16 v[152:155], a[128:131], a[64:67], v[152:155]
buffer_load_dwordx4 a[52:55], v2, s[40:43], s33 offen offset:2048 sc1
v_mfma_f32_16x16x32_bf16 v[132:135], a[136:139], a[64:67], v[132:135]
ds_read_b128 a[108:111], v5 offset:21504
v_mfma_f32_16x16x32_bf16 v[132:135], a[140:143], a[68:71], v[132:135]
v_mfma_f32_16x16x32_bf16 v[156:159], a[140:143], a[76:79], v[156:159]
ds_read_b128 a[112:115], v5 offset:16384
v_mfma_f32_16x16x32_bf16 v[156:159], a[136:139], a[72:75], v[156:159]
buffer_load_dwordx4 v1, s[4:7], s44 offen offset:0 sc1 lds
v_mfma_f32_16x16x32_bf16 v[180:183], a[136:139], a[80:83], v[180:183]
v_mfma_f32_16x16x32_bf16 v[180:183], a[140:143], a[84:87], v[180:183]
ds_read_b128 a[116:119], v5 offset:22528
v_mfma_f32_16x16x32_bf16 v[204:207], a[140:143], a[92:95], v[204:207]
buffer_load_dwordx4 a[56:59], v2, s[40:43], s35 offen offset:3072 sc1
v_mfma_f32_16x16x32_bf16 v[204:207], a[136:139], a[88:91], v[204:207]
v_mfma_f32_16x16x32_bf16 v[208:211], a[144:147], a[88:91], v[208:211]
v_mfma_f32_16x16x32_bf16 v[208:211], a[148:151], a[92:95], v[208:211]
v_mfma_f32_16x16x32_bf16 v[184:187], a[148:151], a[84:87], v[184:187]
buffer_load_dwordx4 v1, s[4:7], s44 offen offset:1024 sc1 lds
s_add_u32 m0, s18, 0x4000
v_mfma_f32_16x16x32_bf16 v[184:187], a[144:147], a[80:83], v[184:187]
s_add_u32 s44, s50, 0x2c28000
v_mfma_f32_16x16x32_bf16 v[160:163], a[144:147], a[72:75], v[160:163]
v_mfma_f32_16x16x32_bf16 v[160:163], a[148:151], a[76:79], v[160:163]
buffer_load_dwordx4 a[60:63], v2, s[40:43], s33 offen offset:3072 sc1
s_add_u32 s35, s35, 0x2000
v_mfma_f32_16x16x32_bf16 v[136:139], a[148:151], a[68:71], v[136:139]
s_add_u32 s33, s33, 0x2000
v_mfma_f32_16x16x32_bf16 v[136:139], a[144:147], a[64:67], v[136:139]
s_waitcnt vmcnt(13) lgkmcnt(0)
v_mfma_f32_16x16x32_bf16 v[140:143], a[96:99], a[0:3], v[140:143]
ds_read_b128 a[128:131], v5 offset:17408
v_add_f32 v92, v92, v96
v_mfma_f32_16x16x32_bf16 v[140:143], a[100:103], a[4:7], v[140:143]
buffer_load_dwordx4 a[64:67], v2, s[40:43], s35 offen offset:0 sc1
v_mfma_f32_16x16x32_bf16 v[164:167], a[100:103], a[12:15], v[164:167]
ds_read_b128 a[132:135], v5 offset:23552
v_add_f32 v100, v100, v104
v_mfma_f32_16x16x32_bf16 v[164:167], a[96:99], a[8:11], v[164:167]
v_add_f32 v108, v108, v112
v_add_f32 v116, v116, v120
v_mfma_f32_16x16x32_bf16 v[188:191], a[96:99], a[16:19], v[188:191]
v_add_f32 v93, v93, v97
v_add_f32 v101, v101, v105
v_mfma_f32_16x16x32_bf16 v[188:191], a[100:103], a[20:23], v[188:191]
buffer_load_dwordx4 v1, s[4:7], s44 offen offset:0 sc1 lds
v_mfma_f32_16x16x32_bf16 v[212:215], a[100:103], a[28:31], v[212:215]
ds_read_b128 a[136:139], v5 offset:12288
v_add_f32 v109, v109, v113
v_mfma_f32_16x16x32_bf16 v[212:215], a[96:99], a[24:27], v[212:215]
v_add_f32 v117, v117, v121
v_add_f32 v94, v94, v98
v_mfma_f32_16x16x32_bf16 v[216:219], a[104:107], a[24:27], v[216:219]
ds_read_b128 a[140:143], v5 offset:18432
v_add_f32 v102, v102, v106
v_mfma_f32_16x16x32_bf16 v[216:219], a[108:111], a[28:31], v[216:219]
buffer_load_dwordx4 a[68:71], v2, s[40:43], s33 offen offset:0 sc1
v_mfma_f32_16x16x32_bf16 v[192:195], a[108:111], a[20:23], v[192:195]
ds_read_b128 a[144:147], v5 offset:13312
v_add_f32 v110, v110, v114
v_mfma_f32_16x16x32_bf16 v[192:195], a[104:107], a[16:19], v[192:195]
v_add_f32 v118, v118, v122
v_add_f32 v95, v95, v99
v_mfma_f32_16x16x32_bf16 v[168:171], a[104:107], a[8:11], v[168:171]
v_add_f32 v103, v103, v107
v_mfma_f32_16x16x32_bf16 v[168:171], a[108:111], a[12:15], v[168:171]
buffer_load_dwordx4 a[72:75], v2, s[40:43], s35 offen offset:1024 sc1
v_mfma_f32_16x16x32_bf16 v[144:147], a[108:111], a[4:7], v[144:147]
ds_read_b128 a[148:151], v5 offset:19456
v_add_f32 v111, v111, v115
v_mfma_f32_16x16x32_bf16 v[144:147], a[104:107], a[0:3], v[144:147]
v_add_f32 v119, v119, v123
v_add_f32_dpp v92, v92, v92 row_ror:8 row_mask:0xf bank_mask:0xf
v_mfma_f32_16x16x32_bf16 v[148:151], a[112:115], a[0:3], v[148:151]
v_add_f32_dpp v100, v100, v100 row_ror:8 row_mask:0xf bank_mask:0xf
v_mfma_f32_16x16x32_bf16 v[148:151], a[116:119], a[4:7], v[148:151]
buffer_load_dwordx4 v1, s[4:7], s44 offen offset:1024 sc1 lds
s_add_u32 m0, s18, 0x6000
v_mfma_f32_16x16x32_bf16 v[172:175], a[116:119], a[12:15], v[172:175]
s_add_u32 s44, s50, 0x2c2a000
v_add_f32_dpp v108, v108, v108 row_ror:8 row_mask:0xf bank_mask:0xf
v_mfma_f32_16x16x32_bf16 v[172:175], a[112:115], a[8:11], v[172:175]
v_add_f32_dpp v116, v116, v116 row_ror:8 row_mask:0xf bank_mask:0xf
v_add_f32_dpp v93, v93, v93 row_ror:8 row_mask:0xf bank_mask:0xf
v_mfma_f32_16x16x32_bf16 v[196:199], a[112:115], a[16:19], v[196:199]
v_add_f32_dpp v101, v101, v101 row_ror:8 row_mask:0xf bank_mask:0xf
v_mfma_f32_16x16x32_bf16 v[196:199], a[116:119], a[20:23], v[196:199]
buffer_load_dwordx4 a[76:79], v2, s[40:43], s33 offen offset:1024 sc1
v_mfma_f32_16x16x32_bf16 v[220:223], a[116:119], a[28:31], v[220:223]
v_add_f32_dpp v109, v109, v109 row_ror:8 row_mask:0xf bank_mask:0xf
v_add_f32_dpp v117, v117, v117 row_ror:8 row_mask:0xf bank_mask:0xf
v_mfma_f32_16x16x32_bf16 v[220:223], a[112:115], a[24:27], v[220:223]
s_waitcnt vmcnt(17) lgkmcnt(0)
s_barrier
v_mfma_f32_16x16x32_bf16 v[224:227], a[128:131], a[24:27], v[224:227]
ds_read_b128 a[96:99], v5 offset:26624
v_add_f32_dpp v92, v94, v94 row_ror:8 row_mask:0xf bank_mask:0xc
v_mfma_f32_16x16x32_bf16 v[224:227], a[132:135], a[28:31], v[224:227]
buffer_load_dwordx4 a[80:83], v2, s[40:43], s35 offen offset:2048 sc1
v_mfma_f32_16x16x32_bf16 v[200:203], a[132:135], a[20:23], v[200:203]
ds_read_b128 a[100:103], v5 offset:32768
v_add_f32_dpp v100, v102, v102 row_ror:8 row_mask:0xf bank_mask:0xc
v_mfma_f32_16x16x32_bf16 v[200:203], a[128:131], a[16:19], v[200:203]
v_add_f32_dpp v108, v110, v110 row_ror:8 row_mask:0xf bank_mask:0xc
v_add_f32_dpp v116, v118, v118 row_ror:8 row_mask:0xf bank_mask:0xc
v_mfma_f32_16x16x32_bf16 v[176:179], a[128:131], a[8:11], v[176:179]
v_add_f32_dpp v93, v95, v95 row_ror:8 row_mask:0xf bank_mask:0xc
v_add_f32_dpp v101, v103, v103 row_ror:8 row_mask:0xf bank_mask:0xc
v_mfma_f32_16x16x32_bf16 v[176:179], a[132:135], a[12:15], v[176:179]
buffer_load_dwordx4 v1, s[4:7], s44 offen offset:0 sc1 lds
v_mfma_f32_16x16x32_bf16 v[152:155], a[132:135], a[4:7], v[152:155]
ds_read_b128 a[104:107], v5 offset:27648
v_add_f32_dpp v109, v111, v111 row_ror:8 row_mask:0xf bank_mask:0xc
v_mfma_f32_16x16x32_bf16 v[152:155], a[128:131], a[0:3], v[152:155]
v_add_f32_dpp v117, v119, v119 row_ror:8 row_mask:0xf bank_mask:0xc
v_mfma_f32_16x16x32_bf16 v[132:135], a[136:139], a[0:3], v[132:135]
ds_read_b128 a[108:111], v5 offset:33792
v_mfma_f32_16x16x32_bf16 v[132:135], a[140:143], a[4:7], v[132:135]
buffer_load_dwordx4 a[84:87], v2, s[40:43], s33 offen offset:2048 sc1
v_mfma_f32_16x16x32_bf16 v[156:159], a[140:143], a[12:15], v[156:159]
ds_read_b128 a[112:115], v5 offset:28672
v_mfma_f32_16x16x32_bf16 v[156:159], a[136:139], a[8:11], v[156:159]
L_stub1:
s_cbranch_execz L_wret0
v_permlane32_swap_b32 v92, v93
v_mfma_f32_16x16x32_bf16 v[180:183], a[136:139], a[16:19], v[180:183]
v_permlane32_swap_b32 v100, v101
v_mfma_f32_16x16x32_bf16 v[180:183], a[140:143], a[20:23], v[180:183]
buffer_load_dwordx4 a[88:91], v2, s[40:43], s35 offen offset:3072 sc1
v_mfma_f32_16x16x32_bf16 v[204:207], a[140:143], a[28:31], v[204:207]
ds_read_b128 a[116:119], v5 offset:34816
v_mfma_f32_16x16x32_bf16 v[204:207], a[136:139], a[24:27], v[204:207]
v_permlane32_swap_b32 v108, v109
v_mfma_f32_16x16x32_bf16 v[208:211], a[144:147], a[24:27], v[208:211]
v_permlane32_swap_b32 v116, v117
v_mfma_f32_16x16x32_bf16 v[208:211], a[148:151], a[28:31], v[208:211]
buffer_load_dwordx4 v1, s[4:7], s44 offen offset:1024 sc1 lds
s_add_u32 m0, s18, 0x8000
v_mfma_f32_16x16x32_bf16 v[184:187], a[148:151], a[20:23], v[184:187]
s_add_u32 s44, s50, 0x2c2c000
v_add_f32 v92, v92, v93
v_mfma_f32_16x16x32_bf16 v[184:187], a[144:147], a[16:19], v[184:187]
v_add_f32 v100, v100, v101
v_add_f32 v108, v108, v109
v_mfma_f32_16x16x32_bf16 v[160:163], a[144:147], a[8:11], v[160:163]
v_add_f32 v116, v116, v117
v_mov_b32 v94, v92
v_mfma_f32_16x16x32_bf16 v[160:163], a[148:151], a[12:15], v[160:163]
buffer_load_dwordx4 a[92:95], v2, s[40:43], s33 offen offset:3072 sc1
s_add_u32 s35, s35, 0x2000
v_mfma_f32_16x16x32_bf16 v[136:139], a[148:151], a[4:7], v[136:139]
s_add_u32 s33, s33, 0x2000
v_mov_b32 v102, v100
v_mfma_f32_16x16x32_bf16 v[136:139], a[144:147], a[0:3], v[136:139]
v_mov_b32 v110, v108
s_waitcnt vmcnt(12) lgkmcnt(0)
v_readlane_b32 s51, v11, 0
v_readlane_b32 s52, v11, 8
s_nop 0
s_add_u32 s51, s51, s52
s_cmp_lt_u32 s51, 0x400000
s_cbranch_scc1 Ltal_5
Ltab_6:
s_cmp_gt_u32 s51, 0x400020
s_cselect_b32 s51, 1, 0
v_mfma_f32_16x16x32_bf16 v[140:143], a[96:99], a[32:35], v[140:143]
ds_read_b128 a[128:131], v5 offset:29696
v_mov_b32 v118, v116
v_mfma_f32_16x16x32_bf16 v[140:143], a[100:103], a[36:39], v[140:143]
buffer_load_dwordx4 a[0:3], v2, s[40:43], s35 offen offset:0 sc1
v_mfma_f32_16x16x32_bf16 v[164:167], a[100:103], a[44:47], v[164:167]
ds_read_b128 a[132:135], v5 offset:35840
v_mfma_f32_16x16x32_bf16 v[164:167], a[96:99], a[40:43], v[164:167]
v_permlane16_swap_b32 v92, v94
v_mfma_f32_16x16x32_bf16 v[188:191], a[96:99], a[48:51], v[188:191]
v_permlane16_swap_b32 v100, v102
v_mfma_f32_16x16x32_bf16 v[188:191], a[100:103], a[52:55], v[188:191]
buffer_load_dwordx4 v1, s[4:7], s44 offen offset:0 sc1 lds
v_mfma_f32_16x16x32_bf16 v[212:215], a[100:103], a[60:63], v[212:215]
ds_read_b128 a[136:139], v5 offset:24576
v_mfma_f32_16x16x32_bf16 v[212:215], a[96:99], a[56:59], v[212:215]
v_permlane16_swap_b32 v108, v110
v_mfma_f32_16x16x32_bf16 v[216:219], a[104:107], a[56:59], v[216:219]
ds_read_b128 a[140:143], v5 offset:30720
v_mfma_f32_16x16x32_bf16 v[216:219], a[108:111], a[60:63], v[216:219]
buffer_load_dwordx4 a[4:7], v2, s[40:43], s33 offen offset:0 sc1
v_mfma_f32_16x16x32_bf16 v[192:195], a[108:111], a[52:55], v[192:195]
ds_read_b128 a[144:147], v5 offset:25600
v_mfma_f32_16x16x32_bf16 v[192:195], a[104:107], a[48:51], v[192:195]
v_permlane16_swap_b32 v116, v118
v_mfma_f32_16x16x32_bf16 v[168:171], a[104:107], a[40:43], v[168:171]
v_add_f32 v92, v92, v94
v_add_f32 v100, v100, v102
v_mfma_f32_16x16x32_bf16 v[168:171], a[108:111], a[44:47], v[168:171]
buffer_load_dwordx4 a[8:11], v2, s[40:43], s35 offen offset:1024 sc1
v_mfma_f32_16x16x32_bf16 v[144:147], a[108:111], a[36:39], v[144:147]
ds_read_b128 a[148:151], v5 offset:31744
v_add_f32 v108, v108, v110
v_mfma_f32_16x16x32_bf16 v[144:147], a[104:107], a[32:35], v[144:147]
v_add_f32 v116, v116, v118
v_mov_b32 v94, v92
v_mfma_f32_16x16x32_bf16 v[148:151], a[112:115], a[32:35], v[148:151]
v_mov_b32 v102, v100
v_mov_b32 v110, v108
v_mfma_f32_16x16x32_bf16 v[148:151], a[116:119], a[36:39], v[148:151]
buffer_load_dwordx4 v1, s[4:7], s44 offen offset:1024 sc1 lds
s_add_u32 m0, s18, 0xa000
v_mfma_f32_16x16x32_bf16 v[172:175], a[116:119], a[44:47], v[172:175]
s_add_u32 s44, s50, 0x2c2e000
v_mov_b32 v118, v116
v_mfma_f32_16x16x32_bf16 v[172:175], a[112:115], a[40:43], v[172:175]
v_permlane32_swap_b32 v92, v94
v_mfma_f32_16x16x32_bf16 v[196:199], a[112:115], a[48:51], v[196:199]
v_permlane32_swap_b32 v100, v102
v_mfma_f32_16x16x32_bf16 v[196:199], a[116:119], a[52:55], v[196:199]
buffer_load_dwordx4 a[12:15], v2, s[40:43], s33 offen offset:1024 sc1
v_mfma_f32_16x16x32_bf16 v[220:223], a[116:119], a[60:63], v[220:223]
v_permlane32_swap_b32 v108, v110
v_mfma_f32_16x16x32_bf16 v[220:223], a[112:115], a[56:59], v[220:223]
s_waitcnt lgkmcnt(0)
v_mfma_f32_16x16x32_bf16 v[224:227], a[128:131], a[56:59], v[224:227]
ds_read_b128 a[96:99], v5 offset:38912
v_mfma_f32_16x16x32_bf16 v[224:227], a[132:135], a[60:63], v[224:227]
buffer_load_dwordx4 a[16:19], v2, s[40:43], s35 offen offset:2048 sc1
v_mfma_f32_16x16x32_bf16 v[200:203], a[132:135], a[52:55], v[200:203]
ds_read_b128 a[100:103], v5 offset:45056
v_mfma_f32_16x16x32_bf16 v[200:203], a[128:131], a[48:51], v[200:203]
v_permlane32_swap_b32 v116, v118
v_mfma_f32_16x16x32_bf16 v[176:179], a[128:131], a[40:43], v[176:179]
v_mul_f32 v82, 0xba800000, v92
v_mul_f32 v84, 0xba800000, v100
v_mfma_f32_16x16x32_bf16 v[176:179], a[132:135], a[44:47], v[176:179]
buffer_load_dwordx4 v1, s[4:7], s44 offen offset:0 sc1 lds
v_mfma_f32_16x16x32_bf16 v[152:155], a[132:135], a[36:39], v[152:155]
ds_read_b128 a[104:107], v5 offset:39936
v_mul_f32 v86, 0xba800000, v108
v_mfma_f32_16x16x32_bf16 v[152:155], a[128:131], a[32:35], v[152:155]
v_mul_f32 v88, 0xba800000, v116
v_mul_f32 v94, 0x3a800000, v94
v_mfma_f32_16x16x32_bf16 v[132:135], a[136:139], a[32:35], v[132:135]
ds_read_b128 a[108:111], v5 offset:46080
v_mul_f32 v102, 0x3a800000, v102
v_mfma_f32_16x16x32_bf16 v[132:135], a[140:143], a[36:39], v[132:135]
buffer_load_dwordx4 a[20:23], v2, s[40:43], s33 offen offset:2048 sc1
v_mfma_f32_16x16x32_bf16 v[156:159], a[140:143], a[44:47], v[156:159]
ds_read_b128 a[112:115], v5 offset:40960
v_mul_f32 v110, 0x3a800000, v110
v_mfma_f32_16x16x32_bf16 v[156:159], a[136:139], a[40:43], v[156:159]
v_mul_f32 v118, 0x3a800000, v118
v_fma_f32 v94, -v82, v82, v94
v_mfma_f32_16x16x32_bf16 v[180:183], a[136:139], a[48:51], v[180:183]
v_fma_f32 v102, -v84, v84, v102
v_fma_f32 v110, -v86, v86, v110
v_mfma_f32_16x16x32_bf16 v[180:183], a[140:143], a[52:55], v[180:183]
buffer_load_dwordx4 a[24:27], v2, s[40:43], s35 offen offset:3072 sc1
v_mfma_f32_16x16x32_bf16 v[204:207], a[140:143], a[60:63], v[204:207]
ds_read_b128 a[116:119], v5 offset:47104
v_fma_f32 v118, -v88, v88, v118
v_mfma_f32_16x16x32_bf16 v[204:207], a[136:139], a[56:59], v[204:207]
v_max_f32 v94, 0, v94
v_max_f32 v102, 0, v102
v_mfma_f32_16x16x32_bf16 v[208:211], a[144:147], a[56:59], v[208:211]
v_max_f32 v110, 0, v110
v_max_f32 v118, 0, v118
v_mfma_f32_16x16x32_bf16 v[208:211], a[148:151], a[60:63], v[208:211]
buffer_load_dwordx4 v1, s[4:7], s44 offen offset:1024 sc1 lds
s_add_u32 m0, s19, 49152
v_mfma_f32_16x16x32_bf16 v[184:187], a[148:151], a[52:55], v[184:187]
s_add_u32 s44, s85, 0xa04000
v_add_f32 v94, 0x3727c5ac, v94
v_mfma_f32_16x16x32_bf16 v[184:187], a[144:147], a[48:51], v[184:187]
v_add_f32 v102, 0x3727c5ac, v102
v_add_f32 v110, 0x3727c5ac, v110
v_mfma_f32_16x16x32_bf16 v[160:163], a[144:147], a[40:43], v[160:163]
v_add_f32 v118, 0x3727c5ac, v118
v_mfma_f32_16x16x32_bf16 v[160:163], a[148:151], a[44:47], v[160:163]
buffer_load_dwordx4 a[28:31], v2, s[40:43], s33 offen offset:3072 sc1
s_add_u32 s35, s35, 0x2000
v_mfma_f32_16x16x32_bf16 v[136:139], a[148:151], a[36:39], v[136:139]
s_add_u32 s33, s33, 0x2000
v_mfma_f32_16x16x32_bf16 v[136:139], a[144:147], a[32:35], v[136:139]
s_waitcnt vmcnt(12) lgkmcnt(0)
v_mfma_f32_16x16x32_bf16 v[140:143], a[96:99], a[64:67], v[140:143]
ds_read_b128 a[128:131], v5 offset:41984
v_mfma_f32_16x16x32_bf16 v[140:143], a[100:103], a[68:71], v[140:143]
buffer_load_dwordx4 a[32:35], v2, s[40:43], s35 offen offset:0 sc1
v_mfma_f32_16x16x32_bf16 v[164:167], a[100:103], a[76:79], v[164:167]
ds_read_b128 a[132:135], v5 offset:48128
v_mfma_f32_16x16x32_bf16 v[164:167], a[96:99], a[72:75], v[164:167]
v_rsq_f32 v83, v94
v_mfma_f32_16x16x32_bf16 v[188:191], a[96:99], a[80:83], v[188:191]
v_rsq_f32 v85, v102
v_mfma_f32_16x16x32_bf16 v[188:191], a[100:103], a[84:87], v[188:191]
buffer_load_dwordx4 v1, s[4:7], s44 offen offset:0 sc1 lds
v_mfma_f32_16x16x32_bf16 v[212:215], a[100:103], a[92:95], v[212:215]
ds_read_b128 a[136:139], v5 offset:36864
v_mfma_f32_16x16x32_bf16 v[212:215], a[96:99], a[88:91], v[212:215]
v_rsq_f32 v87, v110
v_rsq_f32 v89, v118
v_mfma_f32_16x16x32_bf16 v[216:219], a[104:107], a[88:91], v[216:219]
ds_read_b128 a[140:143], v5 offset:43008
v_mfma_f32_16x16x32_bf16 v[216:219], a[108:111], a[92:95], v[216:219]
buffer_load_dwordx4 a[36:39], v2, s[40:43], s33 offen offset:0 sc1
v_mfma_f32_16x16x32_bf16 v[192:195], a[108:111], a[84:87], v[192:195]
ds_read_b128 a[144:147], v5 offset:37888
v_fmac_f32 v140, v56, v82
v_mfma_f32_16x16x32_bf16 v[192:195], a[104:107], a[80:83], v[192:195]
v_mfma_f32_16x16x32_bf16 v[168:171], a[104:107], a[72:75], v[168:171]
v_fmac_f32 v164, v56, v84
v_mfma_f32_16x16x32_bf16 v[168:171], a[108:111], a[76:79], v[168:171]
buffer_load_dwordx4 a[40:43], v2, s[40:43], s35 offen offset:1024 sc1
v_mfma_f32_16x16x32_bf16 v[144:147], a[108:111], a[68:71], v[144:147]
ds_read_b128 a[148:151], v5 offset:44032
v_fmac_f32 v188, v56, v86
v_mfma_f32_16x16x32_bf16 v[144:147], a[104:107], a[64:67], v[144:147]
v_mfma_f32_16x16x32_bf16 v[148:151], a[112:115], a[64:67], v[148:151]
v_fmac_f32 v212, v56, v88
v_mfma_f32_16x16x32_bf16 v[148:151], a[116:119], a[68:71], v[148:151]
buffer_load_dwordx4 v1, s[4:7], s44 offen offset:1024 sc1 lds
v_mfma_f32_16x16x32_bf16 v[172:175], a[116:119], a[76:79], v[172:175]
v_fmac_f32 v216, v60, v88
v_mfma_f32_16x16x32_bf16 v[172:175], a[112:115], a[72:75], v[172:175]
v_mfma_f32_16x16x32_bf16 v[196:199], a[112:115], a[80:83], v[196:199]
v_fmac_f32 v192, v60, v86
v_mfma_f32_16x16x32_bf16 v[196:199], a[116:119], a[84:87], v[196:199]
buffer_load_dwordx4 a[44:47], v2, s[40:43], s33 offen offset:1024 sc1
v_mfma_f32_16x16x32_bf16 v[220:223], a[116:119], a[92:95], v[220:223]
v_fmac_f32 v168, v60, v84
v_fmac_f32 v141, v57, v82
v_mfma_f32_16x16x32_bf16 v[220:223], a[112:115], a[88:91], v[220:223]
s_waitcnt lgkmcnt(0)
s_barrier
v_mfma_f32_16x16x32_bf16 v[224:227], a[128:131], a[88:91], v[224:227]
v_add_u32 v5, 0, v1
v_fmac_f32 v144, v60, v82
v_mfma_f32_16x16x32_bf16 v[224:227], a[132:135], a[92:95], v[224:227]
buffer_load_dwordx4 a[48:51], v2, s[40:43], s35 offen offset:2048 sc1
v_mfma_f32_16x16x32_bf16 v[200:203], a[132:135], a[84:87], v[200:203]
ds_read_b128 a[96:99], v5 offset:2048
v_fmac_f32 v148, v64, v82
v_mfma_f32_16x16x32_bf16 v[200:203], a[128:131], a[80:83], v[200:203]
ds_read_b128 a[100:103], v5 offset:8192
v_fmac_f32 v165, v57, v84
v_mfma_f32_16x16x32_bf16 v[176:179], a[128:131], a[72:75], v[176:179]
v_fmac_f32 v172, v64, v84
v_fmac_f32 v189, v57, v86
v_mfma_f32_16x16x32_bf16 v[176:179], a[132:135], a[76:79], v[176:179]
buffer_load_dwordx4 v1, s[4:7], s44 offen offset:2048 sc1 lds
v_mfma_f32_16x16x32_bf16 v[152:155], a[132:135], a[68:71], v[152:155]
ds_read_b128 a[104:107], v5 offset:3072
v_fmac_f32 v196, v64, v86
v_mfma_f32_16x16x32_bf16 v[152:155], a[128:131], a[64:67], v[152:155]
v_fmac_f32 v213, v57, v88
v_fmac_f32 v217, v61, v88
v_mfma_f32_16x16x32_bf16 v[132:135], a[136:139], a[64:67], v[132:135]
ds_read_b128 a[108:111], v5 offset:9216
v_fmac_f32 v220, v64, v88
v_mfma_f32_16x16x32_bf16 v[132:135], a[140:143], a[68:71], v[132:135]
buffer_load_dwordx4 a[52:55], v2, s[40:43], s33 offen offset:2048 sc1
v_mfma_f32_16x16x32_bf16 v[156:159], a[140:143], a[76:79], v[156:159]
ds_read_b128 a[112:115], v5 offset:4096
v_fmac_f32 v224, v68, v88
v_mfma_f32_16x16x32_bf16 v[156:159], a[136:139], a[72:75], v[156:159]
v_fmac_f32 v193, v61, v86
v_fmac_f32 v169, v61, v84
v_mfma_f32_16x16x32_bf16 v[180:183], a[136:139], a[80:83], v[180:183]
v_fmac_f32 v200, v68, v86
v_fmac_f32 v145, v61, v82
v_mfma_f32_16x16x32_bf16 v[180:183], a[140:143], a[84:87], v[180:183]
buffer_load_dwordx4 a[56:59], v2, s[40:43], s35 offen offset:3072 sc1
v_mfma_f32_16x16x32_bf16 v[204:207], a[140:143], a[92:95], v[204:207]
ds_read_b128 a[116:119], v5 offset:10240
v_fmac_f32 v176, v68, v84
v_mfma_f32_16x16x32_bf16 v[204:207], a[136:139], a[88:91], v[204:207]
v_fmac_f32 v149, v65, v82
v_mfma_f32_16x16x32_bf16 v[208:211], a[144:147], a[88:91], v[208:211]
v_fmac_f32 v152, v68, v82
v_fmac_f32 v173, v65, v84
v_mfma_f32_16x16x32_bf16 v[208:211], a[148:151], a[92:95], v[208:211]
buffer_load_dwordx4 v1, s[4:7], s44 offen offset:3072 sc1 lds
s_add_u32 m0, s19, 65536
v_mfma_f32_16x16x32_bf16 v[184:187], a[148:151], a[84:87], v[184:187]
s_add_u32 s44, s84, 0xa08000
v_fmac_f32 v132, v48, v82
v_mfma_f32_16x16x32_bf16 v[184:187], a[144:147], a[80:83], v[184:187]
v_fmac_f32 v197, v65, v86
v_mfma_f32_16x16x32_bf16 v[160:163], a[144:147], a[72:75], v[160:163]
v_fmac_f32 v156, v48, v84
v_fmac_f32 v221, v65, v88
v_mfma_f32_16x16x32_bf16 v[160:163], a[148:151], a[76:79], v[160:163]
buffer_load_dwordx4 a[60:63], v2, s[40:43], s33 offen offset:3072 sc1
s_add_u32 s35, s35, 0x2000
v_mfma_f32_16x16x32_bf16 v[136:139], a[148:151], a[68:71], v[136:139]
s_add_u32 s33, s33, 0x2000
v_fmac_f32 v180, v48, v86
v_mfma_f32_16x16x32_bf16 v[136:139], a[144:147], a[64:67], v[136:139]
v_fmac_f32 v225, v69, v88
s_waitcnt vmcnt(12) lgkmcnt(0)
v_mfma_f32_16x16x32_bf16 v[140:143], a[96:99], a[0:3], v[140:143]
ds_read_b128 a[128:131], v5 offset:5120
v_fmac_f32 v204, v48, v88
v_mfma_f32_16x16x32_bf16 v[140:143], a[100:103], a[4:7], v[140:143]
buffer_load_dwordx4 a[64:67], v2, s[40:43], s35 offen offset:0 sc1
s_lshl_b32 s37, s28, 10
v_mfma_f32_16x16x32_bf16 v[164:167], a[100:103], a[12:15], v[164:167]
ds_read_b128 a[132:135], v5 offset:11264
v_fmac_f32 v208, v52, v88
v_mfma_f32_16x16x32_bf16 v[164:167], a[96:99], a[8:11], v[164:167]
v_fmac_f32 v201, v69, v86
v_fmac_f32 v177, v69, v84
v_mfma_f32_16x16x32_bf16 v[188:191], a[96:99], a[16:19], v[188:191]
v_fmac_f32 v184, v52, v86
v_fmac_f32 v153, v69, v82
v_mfma_f32_16x16x32_bf16 v[188:191], a[100:103], a[20:23], v[188:191]
buffer_load_dwordx4 a[68:71], v2, s[40:43], s33 offen offset:0 sc1
s_lshr_b32 s79, s30, 1
v_mfma_f32_16x16x32_bf16 v[212:215], a[100:103], a[28:31], v[212:215]
ds_read_b128 a[136:139], v5 offset:0
v_fmac_f32 v160, v52, v84
v_mfma_f32_16x16x32_bf16 v[212:215], a[96:99], a[24:27], v[212:215]
v_fmac_f32 v133, v49, v82
s_lshr_b32 s36, s79, 3
v_mfma_f32_16x16x32_bf16 v[216:219], a[104:107], a[24:27], v[216:219]
ds_read_b128 a[140:143], v5 offset:6144
v_fmac_f32 v136, v52, v82
v_mfma_f32_16x16x32_bf16 v[216:219], a[108:111], a[28:31], v[216:219]
buffer_load_dwordx4 a[72:75], v2, s[40:43], s35 offen offset:1024 sc1
s_and_b32 s79, s79, 7
v_mfma_f32_16x16x32_bf16 v[192:195], a[108:111], a[20:23], v[192:195]
ds_read_b128 a[144:147], v5 offset:1024
v_fmac_f32 v157, v49, v84
v_mfma_f32_16x16x32_bf16 v[192:195], a[104:107], a[16:19], v[192:195]
v_fmac_f32 v181, v49, v86
v_fmac_f32 v142, v58, v82
v_mfma_f32_16x16x32_bf16 v[168:171], a[104:107], a[8:11], v[168:171]
v_fmac_f32 v205, v49, v88
v_fmac_f32 v166, v58, v84
v_mfma_f32_16x16x32_bf16 v[168:171], a[108:111], a[12:15], v[168:171]
buffer_load_dwordx4 a[76:79], v2, s[40:43], s33 offen offset:1024 sc1
s_mul_i32 s36, s36, 524288
v_mfma_f32_16x16x32_bf16 v[144:147], a[108:111], a[4:7], v[144:147]
ds_read_b128 a[148:151], v5 offset:7168
v_fmac_f32 v209, v53, v88
v_mfma_f32_16x16x32_bf16 v[144:147], a[104:107], a[0:3], v[144:147]
v_fmac_f32 v190, v58, v86
s_lshl_b32 s79, s79, 14
v_mfma_f32_16x16x32_bf16 v[148:151], a[112:115], a[0:3], v[148:151]
v_fmac_f32 v185, v53, v86
v_fmac_f32 v214, v58, v88
v_mfma_f32_16x16x32_bf16 v[148:151], a[116:119], a[4:7], v[148:151]
buffer_load_dwordx4 a[80:83], v2, s[40:43], s35 offen offset:2048 sc1
s_add_u32 s79, s79, s36
v_mfma_f32_16x16x32_bf16 v[172:175], a[116:119], a[12:15], v[172:175]
v_fmac_f32 v161, v53, v84
v_fmac_f32 v218, v62, v88
v_mfma_f32_16x16x32_bf16 v[172:175], a[112:115], a[8:11], v[172:175]
s_and_b32 s36, s30, 1
s_lshl_b32 s36, s36, 12
s_add_u32 s79, s79, s36
v_mfma_f32_16x16x32_bf16 v[196:199], a[112:115], a[16:19], v[196:199]
v_fmac_f32 v137, v53, v82
v_fmac_f32 v194, v62, v86
v_mfma_f32_16x16x32_bf16 v[196:199], a[116:119], a[20:23], v[196:199]
buffer_load_dwordx4 a[84:87], v2, s[40:43], s33 offen offset:2048 sc1
s_lshr_b32 s39, s29, 2
v_mfma_f32_16x16x32_bf16 v[220:223], a[116:119], a[28:31], v[220:223]
v_fmac_f32 v170, v62, v84
v_fmac_f32 v143, v59, v82
v_mfma_f32_16x16x32_bf16 v[220:223], a[112:115], a[24:27], v[220:223]
s_xor_b32 s39, s39, s51
s_waitcnt lgkmcnt(0)
v_mfma_f32_16x16x32_bf16 v[224:227], a[128:131], a[24:27], v[224:227]
ds_read_b128 a[96:99], v5 offset:14336
v_fmac_f32 v146, v62, v82
v_mfma_f32_16x16x32_bf16 v[224:227], a[132:135], a[28:31], v[224:227]
buffer_load_dwordx4 a[88:91], v2, s[40:43], s35 offen offset:3072 sc1
s_lshl_b32 s36, s81, 2
v_mfma_f32_16x16x32_bf16 v[200:203], a[132:135], a[20:23], v[200:203]
ds_read_b128 a[100:103], v5 offset:20480
v_fmac_f32 v150, v66, v82
v_mfma_f32_16x16x32_bf16 v[200:203], a[128:131], a[16:19], v[200:203]
v_fmac_f32 v167, v59, v84
v_fmac_f32 v191, v59, v86
v_mfma_f32_16x16x32_bf16 v[176:179], a[128:131], a[8:11], v[176:179]
buffer_load_dwordx4 v1, s[4:7], s44 offen offset:0 sc1 lds
s_add_u32 s36, s36, s28
v_mfma_f32_16x16x32_bf16 v[176:179], a[132:135], a[12:15], v[176:179]
ds_read_b128 a[104:107], v5 offset:15360
v_fmac_f32 v174, v66, v84
v_mfma_f32_16x16x32_bf16 v[152:155], a[132:135], a[4:7], v[152:155]
v_fmac_f32 v198, v66, v86
v_fmac_f32 v215, v59, v88
v_mfma_f32_16x16x32_bf16 v[152:155], a[128:131], a[0:3], v[152:155]
buffer_load_dwordx4 v1, s[4:7], s44 offen offset:1024 sc1 lds
s_xor_b32 s91, s39, 1
v_mfma_f32_16x16x32_bf16 v[132:135], a[136:139], a[0:3], v[132:135]
ds_read_b128 a[108:111], v5 offset:21504
v_fmac_f32 v222, v66, v88
v_mfma_f32_16x16x32_bf16 v[132:135], a[140:143], a[4:7], v[132:135]
v_fmac_f32 v219, v63, v88
v_fmac_f32 v195, v63, v86
v_mfma_f32_16x16x32_bf16 v[156:159], a[140:143], a[12:15], v[156:159]
ds_read_b128 a[112:115], v5 offset:16384
v_fmac_f32 v226, v70, v88
v_mfma_f32_16x16x32_bf16 v[156:159], a[136:139], a[8:11], v[156:159]
buffer_load_dwordx4 v1, s[4:7], s44 offen offset:2048 sc1 lds
s_lshl_b32 s91, s91, 13
v_mfma_f32_16x16x32_bf16 v[180:183], a[136:139], a[16:19], v[180:183]
v_fmac_f32 v202, v70, v86
v_fmac_f32 v171, v63, v84
v_mfma_f32_16x16x32_bf16 v[180:183], a[140:143], a[20:23], v[180:183]
ds_read_b128 a[116:119], v5 offset:22528
v_fmac_f32 v147, v63, v82
v_mfma_f32_16x16x32_bf16 v[204:207], a[140:143], a[28:31], v[204:207]
buffer_load_dwordx4 a[92:95], v2, s[40:43], s33 offen offset:3072 sc1
s_add_u32 s35, s35, 0x2000
v_mfma_f32_16x16x32_bf16 v[204:207], a[136:139], a[24:27], v[204:207]
s_add_u32 s33, s33, 0x2000
v_fmac_f32 v178, v70, v84
v_mfma_f32_16x16x32_bf16 v[208:211], a[144:147], a[24:27], v[208:211]
v_fmac_f32 v154, v70, v82
v_fmac_f32 v151, v67, v82
v_mfma_f32_16x16x32_bf16 v[208:211], a[148:151], a[28:31], v[208:211]
v_fmac_f32 v175, v67, v84
s_lshl_b32 s82, s36, 14
v_mfma_f32_16x16x32_bf16 v[184:187], a[148:151], a[20:23], v[184:187]
buffer_load_dwordx4 v1, s[4:7], s44 offen offset:3072 sc1 lds
s_add_u32 m0, s19, 81920
v_mfma_f32_16x16x32_bf16 v[184:187], a[144:147], a[16:19], v[184:187]
s_add_u32 s44, s85, 0xa0c000
v_fmac_f32 v134, v50, v82
v_mfma_f32_16x16x32_bf16 v[160:163], a[144:147], a[8:11], v[160:163]
v_fmac_f32 v158, v50, v84
v_fmac_f32 v199, v67, v86
v_mfma_f32_16x16x32_bf16 v[160:163], a[148:151], a[12:15], v[160:163]
buffer_load_dwordx4 v1, s[4:7], s44 offen offset:0 sc1 lds
s_add_u32 s82, s82, s91
v_mfma_f32_16x16x32_bf16 v[136:139], a[148:151], a[4:7], v[136:139]
v_fmac_f32 v182, v50, v86
v_fmac_f32 v223, v67, v88
v_mfma_f32_16x16x32_bf16 v[136:139], a[144:147], a[0:3], v[136:139]
s_waitcnt vmcnt(13) lgkmcnt(0)
s_barrier
v_mfma_f32_16x16x32_bf16 v[140:143], a[96:99], a[32:35], v[140:143]
ds_read_b128 a[128:131], v5 offset:17408
v_fmac_f32 v206, v50, v88
v_mfma_f32_16x16x32_bf16 v[140:143], a[100:103], a[36:39], v[140:143]
buffer_load_dwordx4 a[0:3], v2, s[40:43], s35 offen offset:0 sc1
s_lshr_b32 s38, s36, 3
v_mfma_f32_16x16x32_bf16 v[164:167], a[100:103], a[44:47], v[164:167]
ds_read_b128 a[132:135], v5 offset:23552
v_fmac_f32 v210, v54, v88
v_mfma_f32_16x16x32_bf16 v[164:167], a[96:99], a[40:43], v[164:167]
v_fmac_f32 v227, v71, v88
v_fmac_f32 v203, v71, v86
v_mfma_f32_16x16x32_bf16 v[188:191], a[96:99], a[48:51], v[188:191]
buffer_load_dwordx4 a[4:7], v2, s[40:43], s33 offen offset:0 sc1
s_xor_b32 s38, s38, s39
v_mfma_f32_16x16x32_bf16 v[188:191], a[100:103], a[52:55], v[188:191]
ds_read_b128 a[136:139], v5 offset:26624
v_fmac_f32 v186, v54, v86
v_mfma_f32_16x16x32_bf16 v[212:215], a[100:103], a[60:63], v[212:215]
v_fmac_f32 v162, v54, v84
v_fmac_f32 v179, v71, v84
v_mfma_f32_16x16x32_bf16 v[212:215], a[96:99], a[56:59], v[212:215]
buffer_load_dwordx4 a[8:11], v2, s[40:43], s35 offen offset:1024 sc1
s_lshl_b32 s38, s38, 13
v_mfma_f32_16x16x32_bf16 v[216:219], a[104:107], a[56:59], v[216:219]
ds_read_b128 a[140:143], v5 offset:32768
v_fmac_f32 v138, v54, v82
v_mfma_f32_16x16x32_bf16 v[216:219], a[108:111], a[60:63], v[216:219]
v_fmac_f32 v155, v71, v82
v_fmac_f32 v135, v51, v82
v_mfma_f32_16x16x32_bf16 v[192:195], a[108:111], a[52:55], v[192:195]
buffer_load_dwordx4 a[12:15], v2, s[40:43], s33 offen offset:1024 sc1
s_and_b32 s89, s36, 12
v_mfma_f32_16x16x32_bf16 v[192:195], a[104:107], a[48:51], v[192:195]
ds_read_b128 a[144:147], v5 offset:27648
v_fmac_f32 v159, v51, v84
v_mfma_f32_16x16x32_bf16 v[168:171], a[104:107], a[40:43], v[168:171]
v_fmac_f32 v183, v51, v86
v_fmac_f32 v207, v51, v88
v_mfma_f32_16x16x32_bf16 v[168:171], a[108:111], a[44:47], v[168:171]
buffer_load_dwordx4 a[16:19], v2, s[40:43], s35 offen offset:2048 sc1
s_add_u32 s36, s36, s89
v_mfma_f32_16x16x32_bf16 v[144:147], a[108:111], a[36:39], v[144:147]
ds_read_b128 a[148:151], v5 offset:33792
v_fmac_f32 v211, v55, v88
v_mfma_f32_16x16x32_bf16 v[144:147], a[104:107], a[32:35], v[144:147]
s_lshl_b32 s36, s36, 17
s_add_u32 s36, s36, s38
s_and_b32 s38, s29, 1
v_mfma_f32_16x16x32_bf16 v[148:151], a[112:115], a[32:35], v[148:151]
buffer_load_dwordx4 a[20:23], v2, s[40:43], s33 offen offset:2048 sc1
s_xor_b32 s38, s38, s39
v_mfma_f32_16x16x32_bf16 v[148:151], a[116:119], a[36:39], v[148:151]
v_fmac_f32 v187, v55, v86
s_mul_i32 s38, s38, 0x1a00000
v_mfma_f32_16x16x32_bf16 v[172:175], a[116:119], a[44:47], v[172:175]
v_fmac_f32 v163, v55, v84
s_add_u32 s71, s71, s38
v_mfma_f32_16x16x32_bf16 v[172:175], a[112:115], a[40:43], v[172:175]
buffer_load_dwordx4 a[24:27], v2, s[40:43], s35 offen offset:3072 sc1
s_add_u32 s34, s67, s38
v_mfma_f32_16x16x32_bf16 v[196:199], a[112:115], a[48:51], v[196:199]
v_fmac_f32 v139, v55, v82
s_lshl_b32 s38, s31, 1
v_mfma_f32_16x16x32_bf16 v[196:199], a[116:119], a[52:55], v[196:199]
s_lshr_b32 s90, s28, 1
s_add_u32 s38, s38, s90
s_lshl_b32 s90, s38, 13
v_mfma_f32_16x16x32_bf16 v[220:223], a[116:119], a[60:63], v[220:223]
buffer_load_dwordx4 a[28:31], v2, s[40:43], s33 offen offset:3072 sc1
s_add_u32 s35, s35, 0x2000
v_mfma_f32_16x16x32_bf16 v[220:223], a[112:115], a[56:59], v[220:223]
s_add_u32 s33, s33, 0x2000
s_waitcnt lgkmcnt(0)
v_mfma_f32_16x16x32_bf16 v[224:227], a[128:131], a[56:59], v[224:227]
ds_read_b128 a[96:99], v5 offset:28672
s_sub_u32 s91, s91, s90
v_mfma_f32_16x16x32_bf16 v[224:227], a[132:135], a[60:63], v[224:227]
buffer_load_dwordx4 v1, s[4:7], s44 offen offset:1024 sc1 lds
s_and_b32 s38, s38, 15
v_mfma_f32_16x16x32_bf16 v[200:203], a[132:135], a[52:55], v[200:203]
ds_read_b128 a[100:103], v5 offset:34816
s_lshl_b32 s90, s38, 14
v_mfma_f32_16x16x32_bf16 v[200:203], a[128:131], a[48:51], v[200:203]
s_add_u32 s91, s91, s90
s_lshr_b32 s90, s38, 3
s_xor_b32 s90, s90, s39
v_mfma_f32_16x16x32_bf16 v[176:179], a[128:131], a[40:43], v[176:179]
s_lshl_b32 s90, s90, 13
s_and_b32 s89, s38, 12
s_add_u32 s38, s38, s89
v_mfma_f32_16x16x32_bf16 v[176:179], a[132:135], a[44:47], v[176:179]
ds_read_b128 a[104:107], v5 offset:29696
s_lshl_b32 s38, s38, 17
v_mfma_f32_16x16x32_bf16 v[152:155], a[132:135], a[36:39], v[152:155]
s_add_u32 s38, s38, s90
s_and_b32 s90, s28, 1
s_lshl_b32 s90, s90, 11
v_mfma_f32_16x16x32_bf16 v[152:155], a[128:131], a[32:35], v[152:155]
s_add_u32 s38, s38, s90
s_lshr_b32 s90, s31, 1
s_and_b32 s90, s90, 1
s_waitcnt vmcnt(21)
v_mfma_f32_16x16x32_bf16 v[140:143], a[136:139], a[64:67], v[140:143]
ds_read_b128 a[108:111], v5 offset:35840
v_mul_f32 v88, 0x3e8293ee, v89
s_waitcnt vmcnt(20)
v_mfma_f32_16x16x32_bf16 v[140:143], a[140:143], a[68:71], v[140:143]
buffer_load_dwordx4 v1, s[4:7], s44 offen offset:2048 sc1 lds
s_xor_b32 s90, s90, s39
s_waitcnt vmcnt(19)
v_mfma_f32_16x16x32_bf16 v[164:167], a[140:143], a[76:79], v[164:167]
ds_read_b128 a[112:115], v5 offset:38912
s_mul_i32 s90, s90, 0x1a00000
v_mfma_f32_16x16x32_bf16 v[164:167], a[136:139], a[72:75], v[164:167]
s_add_u32 s78, s78, s90
s_add_u32 s11, s66, s90
s_add_u32 s72, s79, 0x2400000
s_waitcnt vmcnt(18)
v_mfma_f32_16x16x32_bf16 v[188:191], a[136:139], a[80:83], v[188:191]
s_add_u32 s63, s83, 0x900000
v_add_u32 v2, s36, v1
s_waitcnt vmcnt(17)
v_mfma_f32_16x16x32_bf16 v[188:191], a[140:143], a[84:87], v[188:191]
ds_read_b128 a[116:119], v5 offset:45056
s_sub_u32 s55, s63, 65536
s_waitcnt vmcnt(12)
v_mfma_f32_16x16x32_bf16 v[212:215], a[140:143], a[92:95], v[212:215]
s_bfe_u32 s36, s83, 0x5000d
s_lshl_b32 s36, s36, 14
s_and_b32 s83, s83, 0x1800
v_mfma_f32_16x16x32_bf16 v[212:215], a[136:139], a[88:91], v[212:215]
s_add_u32 s83, s83, s36
s_lshl_b32 s36, s39, 13
s_add_u32 s83, s83, s36
v_mfma_f32_16x16x32_bf16 v[216:219], a[144:147], a[88:91], v[216:219]
v_add_u32 v233, s37, v1
v_add_u32 v232, s19, v7
v_mfma_f32_16x16x32_bf16 v[216:219], a[148:151], a[92:95], v[216:219]
buffer_load_dwordx4 v1, s[4:7], s44 offen offset:3072 sc1 lds
v_mfma_f32_16x16x32_bf16 v[192:195], a[148:151], a[84:87], v[192:195]
v_mul_f32 v86, 0x3e8293ee, v87
v_mul_f32 v84, 0x3e8293ee, v85
v_mfma_f32_16x16x32_bf16 v[192:195], a[144:147], a[80:83], v[192:195]
v_mul_f32 v82, 0x3e8293ee, v83
v_add_u32 v248, s19, v8
v_mfma_f32_16x16x32_bf16 v[168:171], a[144:147], a[72:75], v[168:171]
v_add_u32 v253, s91, v253
v_add_u32 v4, s38, v1
v_mfma_f32_16x16x32_bf16 v[168:171], a[148:151], a[76:79], v[168:171]
v_mfma_f32_16x16x32_bf16 v[144:147], a[148:151], a[68:71], v[144:147]
v_mfma_f32_16x16x32_bf16 v[144:147], a[144:147], a[64:67], v[144:147]
s_waitcnt lgkmcnt(0)
v_mfma_f32_16x16x32_bf16 v[148:151], a[96:99], a[64:67], v[148:151]
ds_read_b128 a[128:131], v5 offset:39936
v_mfma_f32_16x16x32_bf16 v[148:151], a[100:103], a[68:71], v[148:151]
buffer_store_dwordx4 a[220:223], v1, s[4:7], s101 offen offset:0 sc1
v_mfma_f32_16x16x32_bf16 v[172:175], a[100:103], a[76:79], v[172:175]
ds_read_b128 a[132:135], v5 offset:46080
v_mfma_f32_16x16x32_bf16 v[172:175], a[96:99], a[72:75], v[172:175]
v_mfma_f32_16x16x32_bf16 v[196:199], a[96:99], a[80:83], v[196:199]
v_mfma_f32_16x16x32_bf16 v[196:199], a[100:103], a[84:87], v[196:199]
ds_read_b128 a[136:139], v5 offset:40960
v_mfma_f32_16x16x32_bf16 v[220:223], a[100:103], a[92:95], v[220:223]
v_mfma_f32_16x16x32_bf16 v[220:223], a[96:99], a[88:91], v[220:223]
v_mfma_f32_16x16x32_bf16 v[224:227], a[104:107], a[88:91], v[224:227]
ds_read_b128 a[140:143], v5 offset:47104
v_mfma_f32_16x16x32_bf16 v[224:227], a[108:111], a[92:95], v[224:227]
buffer_store_dwordx4 a[224:227], v1, s[4:7], s101 offen offset:1024 sc1
s_add_u32 s16, s97, 0
v_mfma_f32_16x16x32_bf16 v[200:203], a[108:111], a[84:87], v[200:203]
s_add_u32 s16, s16, s96
ds_read_b128 a[144:147], v5 offset:41984
v_mfma_f32_16x16x32_bf16 v[200:203], a[104:107], a[80:83], v[200:203]
v_mfma_f32_16x16x32_bf16 v[176:179], a[104:107], a[72:75], v[176:179]
v_mfma_f32_16x16x32_bf16 v[176:179], a[108:111], a[76:79], v[176:179]
ds_read_b128 a[148:151], v5 offset:48128
v_mfma_f32_16x16x32_bf16 v[152:155], a[108:111], a[68:71], v[152:155]
v_mfma_f32_16x16x32_bf16 v[152:155], a[104:107], a[64:67], v[152:155]
s_waitcnt vmcnt(12)
v_mfma_f32_16x16x32_bf16 v[140:143], a[112:115], a[0:3], v[140:143]
s_waitcnt vmcnt(11)
v_mfma_f32_16x16x32_bf16 v[140:143], a[116:119], a[4:7], v[140:143]
buffer_store_dwordx4 a[188:191], v1, s[4:7], s16 offen sc1
s_add_u32 s16, s97, 6144
s_waitcnt vmcnt(10)
v_mfma_f32_16x16x32_bf16 v[164:167], a[116:119], a[12:15], v[164:167]
s_add_u32 s16, s16, s96
v_mfma_f32_16x16x32_bf16 v[164:167], a[112:115], a[8:11], v[164:167]
s_waitcnt vmcnt(9)
v_mfma_f32_16x16x32_bf16 v[188:191], a[112:115], a[16:19], v[188:191]
s_waitcnt vmcnt(8)
v_mfma_f32_16x16x32_bf16 v[188:191], a[116:119], a[20:23], v[188:191]
s_waitcnt vmcnt(6)
v_mfma_f32_16x16x32_bf16 v[212:215], a[116:119], a[28:31], v[212:215]
v_mfma_f32_16x16x32_bf16 v[212:215], a[112:115], a[24:27], v[212:215]
s_waitcnt lgkmcnt(0)
v_mfma_f32_16x16x32_bf16 v[216:219], a[128:131], a[24:27], v[216:219]
ds_read_b128 a[96:99], v5 offset:12288
v_mul_f32 v140, v140, v83
v_mfma_f32_16x16x32_bf16 v[216:219], a[132:135], a[28:31], v[216:219]
buffer_store_dwordx4 a[192:195], v1, s[4:7], s16 offen sc1
s_add_u32 s16, s97, 1024
v_mfma_f32_16x16x32_bf16 v[192:195], a[132:135], a[20:23], v[192:195]
s_add_u32 s16, s16, s96
ds_read_b128 a[100:103], v5 offset:18432
v_mfma_f32_16x16x32_bf16 v[192:195], a[128:131], a[16:19], v[192:195]
L_stub2:
s_cbranch_execz L_wret0
v_mul_f32 v141, v141, v83
v_cvt_pk_bf16_f32 v140, v140, v141
v_mfma_f32_16x16x32_bf16 v[168:171], a[128:131], a[8:11], v[168:171]
v_mul_f32 v188, v188, v87
v_mul_f32 v189, v189, v87
v_mfma_f32_16x16x32_bf16 v[168:171], a[132:135], a[12:15], v[168:171]
ds_read_b128 a[104:107], v5 offset:24576
v_cvt_pk_bf16_f32 v188, v188, v189
v_mfma_f32_16x16x32_bf16 v[144:147], a[132:135], a[4:7], v[144:147]
v_mul_f32 v212, v212, v89
v_mul_f32 v213, v213, v89
v_mfma_f32_16x16x32_bf16 v[144:147], a[128:131], a[0:3], v[144:147]
v_mul_f32 v214, v214, v89
v_mul_f32 v215, v215, v89
v_mfma_f32_16x16x32_bf16 v[148:151], a[136:139], a[0:3], v[148:151]
ds_read_b128 a[108:111], v5 offset:30720
v_cvt_pk_bf16_f32 v212, v212, v213
v_mfma_f32_16x16x32_bf16 v[148:151], a[140:143], a[4:7], v[148:151]
buffer_store_dwordx4 a[196:199], v1, s[4:7], s16 offen sc1
s_add_u32 s16, s97, 7168
v_mfma_f32_16x16x32_bf16 v[172:175], a[140:143], a[12:15], v[172:175]
s_add_u32 s16, s16, s96
ds_read_b128 a[112:115], v5 offset:36864
v_mfma_f32_16x16x32_bf16 v[172:175], a[136:139], a[8:11], v[172:175]
v_mul_f32 v216, v216, v89
v_mul_f32 v217, v217, v89
v_mfma_f32_16x16x32_bf16 v[196:199], a[136:139], a[16:19], v[196:199]
v_mul_f32 v218, v218, v89
v_mul_f32 v219, v219, v89
v_mfma_f32_16x16x32_bf16 v[196:199], a[140:143], a[20:23], v[196:199]
ds_read_b128 a[116:119], v5 offset:43008
v_cvt_pk_bf16_f32 v213, v214, v215
v_mfma_f32_16x16x32_bf16 v[220:223], a[140:143], a[28:31], v[220:223]
v_cvt_pk_bf16_f32 v214, v216, v217
v_cvt_pk_bf16_f32 v215, v218, v219
v_mfma_f32_16x16x32_bf16 v[220:223], a[136:139], a[24:27], v[220:223]
v_min_u32 v212, -2, v212
v_min_u32 v213, -2, v213
v_mfma_f32_16x16x32_bf16 v[224:227], a[144:147], a[24:27], v[224:227]
v_min_u32 v214, -2, v214
v_min_u32 v215, -2, v215
v_mfma_f32_16x16x32_bf16 v[224:227], a[148:151], a[28:31], v[224:227]
buffer_store_dwordx4 a[200:203], v1, s[4:7], s16 offen sc1
s_add_u32 s16, s97, 2048
v_mfma_f32_16x16x32_bf16 v[200:203], a[148:151], a[20:23], v[200:203]
s_add_u32 s16, s16, s96
buffer_store_dwordx4 v[212:215], v3, s[4:7], s63 offen offset:0 sc1
v_mfma_f32_16x16x32_bf16 v[200:203], a[144:147], a[16:19], v[200:203]
v_mul_f32 v172, v172, v85
v_mul_f32 v173, v173, v85
v_mfma_f32_16x16x32_bf16 v[176:179], a[144:147], a[8:11], v[176:179]
v_cvt_pk_bf16_f32 v172, v172, v173
v_mul_f32 v196, v196, v87
v_mfma_f32_16x16x32_bf16 v[176:179], a[148:151], a[12:15], v[176:179]
v_mul_f32 v197, v197, v87
v_cvt_pk_bf16_f32 v196, v196, v197
v_mfma_f32_16x16x32_bf16 v[152:155], a[148:151], a[4:7], v[152:155]
v_mul_f32 v220, v220, v89
v_mul_f32 v221, v221, v89
v_mfma_f32_16x16x32_bf16 v[152:155], a[144:147], a[0:3], v[152:155]
v_mul_f32 v222, v222, v89
s_waitcnt lgkmcnt(0)
v_mfma_f32_16x16x32_bf16 v[132:135], a[96:99], a[32:35], v[132:135]
ds_read_b128 a[128:131], v5 offset:13312
v_mul_f32 v223, v223, v89
v_mfma_f32_16x16x32_bf16 v[132:135], a[100:103], a[36:39], v[132:135]
buffer_store_dwordx4 a[204:207], v1, s[4:7], s16 offen sc1
s_add_u32 s16, s97, 8192
v_mfma_f32_16x16x32_bf16 v[156:159], a[100:103], a[44:47], v[156:159]
s_add_u32 s16, s16, s96
ds_read_b128 a[132:135], v5 offset:19456
v_mfma_f32_16x16x32_bf16 v[156:159], a[96:99], a[40:43], v[156:159]
v_cvt_pk_bf16_f32 v220, v220, v221
v_mul_f32 v224, v224, v89
v_mfma_f32_16x16x32_bf16 v[180:183], a[96:99], a[48:51], v[180:183]
v_mul_f32 v225, v225, v89
v_mul_f32 v226, v226, v89
v_mfma_f32_16x16x32_bf16 v[180:183], a[100:103], a[52:55], v[180:183]
ds_read_b128 a[136:139], v5 offset:25600
v_mul_f32 v227, v227, v89
v_mfma_f32_16x16x32_bf16 v[204:207], a[100:103], a[60:63], v[204:207]
v_cvt_pk_bf16_f32 v221, v222, v223
v_cvt_pk_bf16_f32 v222, v224, v225
v_mfma_f32_16x16x32_bf16 v[204:207], a[96:99], a[56:59], v[204:207]
v_cvt_pk_bf16_f32 v223, v226, v227
v_min_u32 v220, -2, v220
v_mfma_f32_16x16x32_bf16 v[204:207], a[104:107], a[88:91], v[204:207]
ds_read_b128 a[140:143], v5 offset:31744
v_min_u32 v221, -2, v221
v_mfma_f32_16x16x32_bf16 v[204:207], a[108:111], a[92:95], v[204:207]
buffer_store_dwordx4 a[208:211], v1, s[4:7], s16 offen sc1
v_mfma_f32_16x16x32_bf16 v[180:183], a[108:111], a[84:87], v[180:183]
ds_read_b128 a[144:147], v5 offset:37888
v_min_u32 v222, -2, v222
v_mfma_f32_16x16x32_bf16 v[180:183], a[104:107], a[80:83], v[180:183]
v_min_u32 v223, -2, v223
v_mul_f32 v198, v198, v87
v_mfma_f32_16x16x32_bf16 v[156:159], a[104:107], a[72:75], v[156:159]
buffer_store_dwordx4 v[220:223], v3, s[4:7], s63 offen offset:1024 sc1
v_mfma_f32_16x16x32_bf16 v[156:159], a[108:111], a[76:79], v[156:159]
ds_read_b128 a[148:151], v5 offset:44032
v_mul_f32 v199, v199, v87
v_mfma_f32_16x16x32_bf16 v[132:135], a[108:111], a[68:71], v[132:135]
v_cvt_pk_bf16_f32 v197, v198, v199
v_mul_f32 v200, v200, v87
v_mfma_f32_16x16x32_bf16 v[132:135], a[104:107], a[64:67], v[132:135]
v_mul_f32 v201, v201, v87
v_cvt_pk_bf16_f32 v198, v200, v201
v_mfma_f32_16x16x32_bf16 v[132:135], a[112:115], a[0:3], v[132:135]
v_mul_f32 v202, v202, v87
v_mul_f32 v203, v203, v87
v_mfma_f32_16x16x32_bf16 v[132:135], a[116:119], a[4:7], v[132:135]
buffer_store_dwordx4 v[236:239], v254, s[4:7], s98 offen offset:0 sc1
v_mfma_f32_16x16x32_bf16 v[156:159], a[116:119], a[12:15], v[156:159]
v_cvt_pk_bf16_f32 v199, v202, v203
v_mul_f32 v174, v174, v85
v_mfma_f32_16x16x32_bf16 v[156:159], a[112:115], a[8:11], v[156:159]
v_mul_f32 v175, v175, v85
v_cvt_pk_bf16_f32 v173, v174, v175
v_mfma_f32_16x16x32_bf16 v[180:183], a[112:115], a[16:19], v[180:183]
v_mul_f32 v176, v176, v85
v_mul_f32 v177, v177, v85
v_mfma_f32_16x16x32_bf16 v[180:183], a[116:119], a[20:23], v[180:183]
v_cvt_pk_bf16_f32 v174, v176, v177
v_mul_f32 v178, v178, v85
v_mfma_f32_16x16x32_bf16 v[204:207], a[116:119], a[28:31], v[204:207]
v_mul_f32 v179, v179, v85
v_cvt_pk_bf16_f32 v175, v178, v179
v_mfma_f32_16x16x32_bf16 v[204:207], a[112:115], a[24:27], v[204:207]
s_waitcnt lgkmcnt(0)
s_barrier
v_mfma_f32_16x16x32_bf16 v[208:211], a[128:131], a[56:59], v[208:211]
ds_write_b128 v233, v[212:215] offset:21504
v_cvt_pk_bf16_f32 v132, v132, v133
v_mfma_f32_16x16x32_bf16 v[208:211], a[132:135], a[60:63], v[208:211]
buffer_store_dwordx4 v[240:243], v254, s[4:7], s98 offen offset:2048 sc1
v_mfma_f32_16x16x32_bf16 v[184:187], a[132:135], a[52:55], v[184:187]
ds_write_b64 v232, v[220:221] offset:4096
v_cvt_pk_bf16_f32 v156, v156, v157
v_mfma_f32_16x16x32_bf16 v[184:187], a[128:131], a[48:51], v[184:187]
ds_write_b64 v232, v[222:223] offset:4608
v_cvt_pk_bf16_f32 v133, v134, v135
v_mfma_f32_16x16x32_bf16 v[160:163], a[128:131], a[40:43], v[160:163]
ds_write_b64 v232, v[196:197] offset:3072
v_cvt_pk_bf16_f32 v180, v180, v181
v_mfma_f32_16x16x32_bf16 v[160:163], a[132:135], a[44:47], v[160:163]
ds_write_b64 v232, v[198:199] offset:3584
v_cvt_pk_bf16_f32 v157, v158, v159
v_mfma_f32_16x16x32_bf16 v[136:139], a[132:135], a[36:39], v[136:139]
ds_write_b64 v232, v[172:173] offset:2048
v_cvt_pk_bf16_f32 v204, v204, v205
v_mfma_f32_16x16x32_bf16 v[136:139], a[128:131], a[32:35], v[136:139]
ds_write_b64 v232, v[174:175] offset:2560
v_cvt_pk_bf16_f32 v181, v182, v183
v_mfma_f32_16x16x32_bf16 v[136:139], a[136:139], a[64:67], v[136:139]
v_cvt_pk_bf16_f32 v205, v206, v207
v_mul_f32 v148, v148, v83
v_mfma_f32_16x16x32_bf16 v[136:139], a[140:143], a[68:71], v[136:139]
v_mul_f32 v149, v149, v83
v_cvt_pk_bf16_f32 v148, v148, v149
v_mfma_f32_16x16x32_bf16 v[160:163], a[140:143], a[76:79], v[160:163]
v_mul_f32 v150, v150, v83
v_mul_f32 v151, v151, v83
v_mfma_f32_16x16x32_bf16 v[160:163], a[136:139], a[72:75], v[160:163]
v_cvt_pk_bf16_f32 v149, v150, v151
v_mul_f32 v152, v152, v83
v_mfma_f32_16x16x32_bf16 v[184:187], a[136:139], a[80:83], v[184:187]
ds_write_b64 v232, v[148:149] offset:1024
v_mul_f32 v153, v153, v83
v_mfma_f32_16x16x32_bf16 v[184:187], a[140:143], a[84:87], v[184:187]
buffer_store_dwordx4 v[244:247], v254, s[4:7], s99 offen offset:0 sc1
v_mfma_f32_16x16x32_bf16 v[208:211], a[140:143], a[92:95], v[208:211]
v_cvt_pk_bf16_f32 v150, v152, v153
v_mul_f32 v154, v154, v83
v_mfma_f32_16x16x32_bf16 v[208:211], a[136:139], a[88:91], v[208:211]
v_mul_f32 v155, v155, v83
v_cvt_pk_bf16_f32 v151, v154, v155
v_mfma_f32_16x16x32_bf16 v[208:211], a[144:147], a[24:27], v[208:211]
ds_write_b64 v232, v[150:151] offset:1536
v_mul_f32 v164, v164, v85
v_mfma_f32_16x16x32_bf16 v[208:211], a[148:151], a[28:31], v[208:211]
v_mul_f32 v165, v165, v85
v_cvt_pk_bf16_f32 v164, v164, v165
v_mfma_f32_16x16x32_bf16 v[184:187], a[148:151], a[20:23], v[184:187]
v_mul_f32 v190, v190, v87
v_mul_f32 v191, v191, v87
v_mfma_f32_16x16x32_bf16 v[184:187], a[144:147], a[16:19], v[184:187]
v_cvt_pk_bf16_f32 v189, v190, v191
v_mul_f32 v166, v166, v85
v_mfma_f32_16x16x32_bf16 v[160:163], a[144:147], a[8:11], v[160:163]
v_mul_f32 v167, v167, v85
v_cvt_pk_bf16_f32 v165, v166, v167
v_mfma_f32_16x16x32_bf16 v[160:163], a[148:151], a[12:15], v[160:163]
v_mul_f32 v142, v142, v83
v_mul_f32 v143, v143, v83
v_mfma_f32_16x16x32_bf16 v[136:139], a[148:151], a[4:7], v[136:139]
v_cvt_pk_bf16_f32 v141, v142, v143
v_mul_f32 v192, v192, v87
v_mfma_f32_16x16x32_bf16 v[136:139], a[144:147], a[0:3], v[136:139]
v_mul_f32 v193, v193, v87
v_cvt_pk_bf16_f32 v190, v192, v193
s_add_u32 m0, s19, 32768
s_add_u32 s44, s84, 0xa00000
buffer_load_dwordx4 v1, s[4:7], s44 offen offset:0 sc1 lds
v_pk_mul_f32 v[194:195], v[194:195], v[86:87] op_sel:[0,1] op_sel_hi:[1,1]
v_pk_mul_f32 v[168:169], v[168:169], v[84:85] op_sel:[0,1] op_sel_hi:[1,1]
v_pk_mul_f32 v[170:171], v[170:171], v[84:85] op_sel:[0,1] op_sel_hi:[1,1]
v_pk_mul_f32 v[144:145], v[144:145], v[82:83] op_sel:[0,1] op_sel_hi:[1,1]
v_pk_mul_f32 v[146:147], v[146:147], v[82:83] op_sel:[0,1] op_sel_hi:[1,1]
v_cvt_pk_bf16_f32 v191, v194, v195
v_cvt_pk_bf16_f32 v166, v168, v169
v_cvt_pk_bf16_f32 v167, v170, v171
v_cvt_pk_bf16_f32 v142, v144, v145
v_cvt_pk_bf16_f32 v143, v146, v147
v_cvt_pk_bf16_f32 v134, v136, v137
v_cvt_pk_bf16_f32 v135, v138, v139
v_cvt_pk_bf16_f32 v158, v160, v161
v_cvt_pk_bf16_f32 v159, v162, v163
v_cvt_pk_bf16_f32 v182, v184, v185
v_cvt_pk_bf16_f32 v183, v186, v187
v_cvt_pk_bf16_f32 v206, v208, v209
v_cvt_pk_bf16_f32 v207, v210, v211
buffer_load_dwordx4 v1, s[4:7], s44 offen offset:1024 sc1 lds
buffer_load_dwordx4 v1, s[4:7], s44 offen offset:2048 sc1 lds
buffer_load_dwordx4 v1, s[4:7], s44 offen offset:3072 sc1 lds
s_add_u32 m0, s19, 98304
s_add_u32 s44, s84, 0xa10000
buffer_load_dwordx4 v1, s[4:7], s44 offen offset:0 sc1 lds
buffer_load_dwordx4 v1, s[4:7], s44 offen offset:1024 sc1 lds
buffer_load_dwordx4 v1, s[4:7], s44 offen offset:2048 sc1 lds
buffer_load_dwordx4 v1, s[4:7], s44 offen offset:3072 sc1 lds
s_waitcnt lgkmcnt(0)
s_barrier
s_add_u32 m0, s19, 114688
s_add_u32 s44, s85, 0xa14000
buffer_load_dwordx4 v1, s[4:7], s44 offen offset:0 sc1 lds
v_mfma_f32_16x16x32_bf16 v[208:211], v[188:191], v[204:207], v[20:23]
ds_read_b64_tr_b16 a[10:11], v248 offset:3072
v_mfma_f32_16x16x32_bf16 v[224:227], v[212:215], v[204:207], v[24:27]
ds_read_b64_tr_b16 a[12:13], v248 offset:4096
v_mfma_f32_16x16x32_bf16 v[160:163], v[140:143], v[156:159], v[20:23]
ds_read_b64_tr_b16 a[22:23], v248 offset:3584
v_mfma_f32_16x16x32_bf16 v[176:179], v[164:167], v[156:159], v[24:27]
s_nop 3
v_max_f32 v224, v224, v208
v_max_f32 v225, v225, v209
v_max_f32 v226, v226, v210
v_max_f32 v227, v227, v211
v_max3_f32 v239, v224, v225, v226
v_max_f32 v239, v239, v227
ds_read_b64_tr_b16 a[24:25], v248 offset:4608
v_max_f32 v176, v176, v160
v_max_f32 v177, v177, v161
v_max_f32 v178, v178, v162
v_max_f32 v179, v179, v163
v_max3_f32 v237, v176, v177, v178
buffer_load_dwordx4 v1, s[4:7], s44 offen offset:1024 sc1 lds
v_max_f32 v237, v237, v179
ds_read_b64_tr_b16 a[6:7], v248 offset:1024
s_nop 0
v_permlane32_swap_b32 v239, v237
v_max_f32 v239, v239, v237
v_mov_b32 v242, v239
ds_read_b64_tr_b16 a[8:9], v248 offset:2048
s_nop 0
v_permlane16_swap_b32 v239, v242
v_max_f32 v239, v239, v242
v_mov_b32 v242, v239
ds_read_b64_tr_b16 a[18:19], v248 offset:1536
s_nop 0
v_permlane32_swap_b32 v239, v242
v_mul_f32_e64 v89, -v239, v88
v_fma_f32 v224, v224, v88, v89
v_fma_f32 v225, v225, v88, v89
v_fma_f32 v226, v226, v88, v89
v_fma_f32 v227, v227, v88, v89
buffer_load_dwordx4 v[228:231], v9, s[4:7], s55 offen sc1
buffer_load_dwordx4 v[72:75], v9, s[4:7], s55 offen offset:1024 sc1
v_exp_f32 v224, v224
v_exp_f32 v225, v225
v_exp_f32 v226, v226
buffer_load_dwordx4 v1, s[4:7], s44 offen offset:2048 sc1 lds
v_exp_f32 v227, v227
v_cvt_pk_bf16_f32 v224, v224, v225
v_cvt_pk_bf16_f32 v225, v226, v227
ds_read_b64_tr_b16 a[20:21], v248 offset:2560
v_and_b32 v208, v224, v28
v_and_b32 v209, v225, v29
v_and_b32 v210, v224, v30
v_and_b32 v211, v225, v31
v_mul_f32_e64 v85, -v242, v84
v_fma_f32 v176, v176, v84, v85
v_mfma_f32_16x16x32_bf16 v[216:219], v[16:19], v[208:211], 0
v_fma_f32 v177, v177, v84, v85
v_fma_f32 v178, v178, v84, v85
s_waitcnt lgkmcnt(6)
v_mfma_f32_16x16x32_bf16 v[116:119], a[10:13], v[208:211], 0
v_fma_f32 v179, v179, v84, v85
v_exp_f32 v176, v176
s_waitcnt lgkmcnt(4)
v_mfma_f32_16x16x32_bf16 v[120:123], a[22:25], v[208:211], 0
v_exp_f32 v177, v177
v_exp_f32 v178, v178
buffer_load_dwordx4 v1, s[4:7], s44 offen offset:3072 sc1 lds
v_exp_f32 v179, v179
v_rcp_f32 v216, v216
v_cvt_pk_bf16_f32 v176, v176, v177
v_cvt_pk_bf16_f32 v177, v178, v179
v_and_b32 v160, v176, v28
v_and_b32 v161, v177, v29
v_and_b32 v162, v176, v30
v_and_b32 v163, v177, v31
v_pk_mul_f32 v[116:117], v[116:117], v[216:217] op_sel:[0,0] op_sel_hi:[1,0]
v_cvt_pk_bf16_f32 v116, v116, v117
v_pk_mul_f32 v[118:119], v[118:119], v[216:217] op_sel:[0,0] op_sel_hi:[1,0]
v_cvt_pk_bf16_f32 v117, v118, v119
v_pk_mul_f32 v[120:121], v[120:121], v[216:217] op_sel:[0,0] op_sel_hi:[1,0]
v_cvt_pk_bf16_f32 v118, v120, v121
v_pk_mul_f32 v[122:123], v[122:123], v[216:217] op_sel:[0,0] op_sel_hi:[1,0]
v_cvt_pk_bf16_f32 v119, v122, v123
v_mfma_f32_16x16x32_bf16 v[168:171], v[16:19], v[160:163], 0
s_waitcnt lgkmcnt(2)
v_mfma_f32_16x16x32_bf16 v[100:103], a[6:9], v[160:163], 0
s_waitcnt lgkmcnt(0)
v_mfma_f32_16x16x32_bf16 v[104:107], a[18:21], v[160:163], 0
buffer_store_dwordx4 v[116:119], v2, s[4:7], s72 offen offset:3072 sc1
v_mfma_f32_16x16x32_bf16 v[184:187], v[164:167], v[180:183], v[20:23]
s_nop 1
v_rcp_f32 v168, v168
v_mfma_f32_16x16x32_bf16 v[200:203], v[188:191], v[180:183], v[24:27]
v_pk_mul_f32 v[100:101], v[100:101], v[168:169] op_sel:[0,0] op_sel_hi:[1,0]
v_pk_mul_f32 v[102:103], v[102:103], v[168:169] op_sel:[0,0] op_sel_hi:[1,0]
v_cvt_pk_bf16_f32 v100, v100, v101
v_pk_mul_f32 v[104:105], v[104:105], v[168:169] op_sel:[0,0] op_sel_hi:[1,0]
v_pk_mul_f32 v[106:107], v[106:107], v[168:169] op_sel:[0,0] op_sel_hi:[1,0]
v_cvt_pk_bf16_f32 v101, v102, v103
v_cvt_pk_bf16_f32 v102, v104, v105
v_cvt_pk_bf16_f32 v103, v106, v107
v_max_f32 v200, v200, v184
v_max_f32 v201, v201, v185
v_max_f32 v202, v202, v186
buffer_store_dwordx4 v[100:103], v2, s[4:7], s72 offen offset:1024 sc1
v_max_f32 v203, v203, v187
v_max3_f32 v238, v200, v201, v202
v_max_f32 v238, v238, v203
s_cmp_lg_u32 s28, 0
s_cbranch_scc1 Lhx_7
s_waitcnt vmcnt(5)
v_max3_u32 v244, v228, v229, v230
s_waitcnt vmcnt(4)
v_max3_u32 v244, v244, v231, v72
v_max3_u32 v244, v244, v73, v74
v_max_u32 v244, v244, v75
v_cmp_eq_u32 vcc, -1, v244
s_cbranch_vccnz L_hxredo0
L_hxback0:
ds_write_b128 v233, v[228:231] offset:20480
ds_write_b64 v232, v[72:73] offset:0
ds_write_b64 v232, v[74:75] offset:512
Lhx_7:
ds_read_b128 a[0:3], v233 offset:20480
v_mfma_f32_16x16x32_bf16 v[152:155], v[140:143], v[132:135], v[24:27]
ds_read_b64_tr_b16 a[4:5], v248 offset:0
ds_read_b64_tr_b16 a[16:17], v248 offset:512
s_waitcnt lgkmcnt(2)
v_mfma_f32_16x16x32_bf16 v[136:139], a[0:3], v[132:135], v[76:79]
s_nop 7
v_max_f32 v152, v152, v136
v_max_f32 v153, v153, v137
v_max_f32 v154, v154, v138
v_max_f32 v155, v155, v139
v_max3_f32 v236, v152, v153, v154
v_max_f32 v236, v236, v155
s_nop 1
v_permlane32_swap_b32 v238, v236
v_max_f32 v238, v238, v236
v_mov_b32 v243, v238
s_nop 1
v_permlane16_swap_b32 v238, v243
v_max_f32 v238, v238, v243
v_mov_b32 v243, v238
s_nop 1
v_permlane32_swap_b32 v238, v243
v_mul_f32_e64 v87, -v238, v86
v_fma_f32 v200, v200, v86, v87
v_fma_f32 v201, v201, v86, v87
v_fma_f32 v202, v202, v86, v87
v_fma_f32 v203, v203, v86, v87
v_exp_f32 v200, v200
v_exp_f32 v201, v201
v_exp_f32 v202, v202
v_exp_f32 v203, v203
v_cvt_pk_bf16_f32 v200, v200, v201
v_cvt_pk_bf16_f32 v201, v202, v203
v_and_b32 v184, v200, v28
v_and_b32 v185, v201, v29
v_and_b32 v186, v200, v30
v_and_b32 v187, v201, v31
v_mul_f32_e64 v83, -v243, v82
v_fma_f32 v152, v152, v82, v83
v_mfma_f32_16x16x32_bf16 v[192:195], v[16:19], v[184:187], 0
v_fma_f32 v153, v153, v82, v83
v_fma_f32 v154, v154, v82, v83
v_mfma_f32_16x16x32_bf16 v[108:111], a[8:11], v[184:187], 0
v_fma_f32 v155, v155, v82, v83
v_exp_f32 v152, v152
v_mfma_f32_16x16x32_bf16 v[112:115], a[20:23], v[184:187], 0
v_exp_f32 v153, v153
v_exp_f32 v154, v154
v_exp_f32 v155, v155
v_rcp_f32 v192, v192
v_cvt_pk_bf16_f32 v152, v152, v153
v_cvt_pk_bf16_f32 v153, v154, v155
v_and_b32 v136, v152, v80
v_and_b32 v137, v153, v81
v_and_b32 v138, v152, v30
v_and_b32 v139, v153, v31
v_pk_mul_f32 v[108:109], v[108:109], v[192:193] op_sel:[0,0] op_sel_hi:[1,0]
v_pk_mul_f32 v[110:111], v[110:111], v[192:193] op_sel:[0,0] op_sel_hi:[1,0]
v_cvt_pk_bf16_f32 v108, v108, v109
v_pk_mul_f32 v[112:113], v[112:113], v[192:193] op_sel:[0,0] op_sel_hi:[1,0]
v_cvt_pk_bf16_f32 v109, v110, v111
v_pk_mul_f32 v[114:115], v[114:115], v[192:193] op_sel:[0,0] op_sel_hi:[1,0]
v_cvt_pk_bf16_f32 v110, v112, v113
v_mfma_f32_16x16x32_bf16 v[144:147], v[16:19], v[136:139], 0
v_cvt_pk_bf16_f32 v111, v114, v115
buffer_store_dwordx4 v[108:111], v2, s[4:7], s72 offen offset:2048 sc1
s_waitcnt lgkmcnt(1)
v_mfma_f32_16x16x32_bf16 v[92:95], a[4:7], v[136:139], 0
s_nop 3
v_rcp_f32 v144, v144
s_waitcnt lgkmcnt(0)
v_mfma_f32_16x16x32_bf16 v[96:99], a[16:19], v[136:139], 0
s_nop 0
v_pk_mul_f32 v[92:93], v[92:93], v[144:145] op_sel:[0,0] op_sel_hi:[1,0]
v_pk_mul_f32 v[94:95], v[94:95], v[144:145] op_sel:[0,0] op_sel_hi:[1,0]
v_cvt_pk_bf16_f32 v92, v92, v93
v_cvt_pk_bf16_f32 v93, v94, v95
s_nop 2
v_pk_mul_f32 v[96:97], v[96:97], v[144:145] op_sel:[0,0] op_sel_hi:[1,0]
v_pk_mul_f32 v[98:99], v[98:99], v[144:145] op_sel:[0,0] op_sel_hi:[1,0]
v_cvt_pk_bf16_f32 v94, v96, v97
v_cvt_pk_bf16_f32 v95, v98, v99
buffer_store_dwordx4 v[92:95], v2, s[4:7], s72 offen offset:0 sc1
s_add_u32 s92, s71, 0x0
v_accvgpr_write_b32 a188, v48
v_accvgpr_write_b32 a189, v49
v_accvgpr_write_b32 a190, v50
v_accvgpr_write_b32 a191, v51
v_accvgpr_write_b32 a192, v52
v_accvgpr_write_b32 a193, v53
v_accvgpr_write_b32 a194, v54
v_accvgpr_write_b32 a195, v55
v_accvgpr_write_b32 a196, v56
v_accvgpr_write_b32 a197, v57
v_accvgpr_write_b32 a198, v58
v_accvgpr_write_b32 a199, v59
v_accvgpr_write_b32 a200, v60
v_accvgpr_write_b32 a201, v61
v_accvgpr_write_b32 a202, v62
v_accvgpr_write_b32 a203, v63
v_accvgpr_write_b32 a204, v64
v_accvgpr_write_b32 a205, v65
v_accvgpr_write_b32 a206, v66
v_accvgpr_write_b32 a207, v67
v_accvgpr_write_b32 a208, v68
v_accvgpr_write_b32 a209, v69
v_accvgpr_write_b32 a210, v70
v_accvgpr_write_b32 a211, v71
s_add_u32 s40, s4, 0x2400000
s_addc_u32 s41, s5, 0
v_add_u32 v5, 32768, v1
v_add_u32 v6, 98304, v1
s_mov_b32 s35, 0
v_lshlrev_b32 v132, 16, v32
v_and_b32 v133, 0xffff0000, v32
v_lshlrev_b32 v134, 16, v33
v_and_b32 v135, 0xffff0000, v33
v_lshlrev_b32 v136, 16, v34
v_and_b32 v137, 0xffff0000, v34
v_lshlrev_b32 v138, 16, v35
v_and_b32 v139, 0xffff0000, v35
v_lshlrev_b32 v140, 16, v36
v_and_b32 v141, 0xffff0000, v36
v_lshlrev_b32 v142, 16, v37
v_and_b32 v143, 0xffff0000, v37
v_lshlrev_b32 v144, 16, v38
v_and_b32 v145, 0xffff0000, v38
v_lshlrev_b32 v146, 16, v39
v_and_b32 v147, 0xffff0000, v39
v_lshlrev_b32 v148, 16, v40
v_and_b32 v149, 0xffff0000, v40
v_lshlrev_b32 v150, 16, v41
v_and_b32 v151, 0xffff0000, v41
v_lshlrev_b32 v152, 16, v42
v_and_b32 v153, 0xffff0000, v42
v_lshlrev_b32 v154, 16, v43
v_and_b32 v155, 0xffff0000, v43
v_lshlrev_b32 v156, 16, v44
v_and_b32 v157, 0xffff0000, v44
v_lshlrev_b32 v158, 16, v45
v_and_b32 v159, 0xffff0000, v45
v_lshlrev_b32 v160, 16, v46
v_and_b32 v161, 0xffff0000, v46
v_lshlrev_b32 v162, 16, v47
v_and_b32 v163, 0xffff0000, v47
s_waitcnt vmcnt(0)
s_barrier
s_cmp_lg_u32 s28, 0
s_cbranch_scc1 Lsg_8
buffer_atomic_add v12, v10, s[4:7], s92 offen sc1
buffer_atomic_swap v15, v14, s[4:7], s8 offen sc1
buffer_atomic_swap v15, v252, s[4:7], s62 offen offset:64 sc1
Lsg_8:
s_mov_b64 exec, 0
s_cmp_eq_u32 s28, 0
s_cbranch_scc1 L_stub3
L_wret1:
s_mov_b64 exec, -1
s_add_u32 m0, s19, 131072
s_add_u32 s44, s86, 0xa18000
buffer_load_dwordx4 v1, s[4:7], s44 offen offset:0 sc1 lds
buffer_load_dwordx4 v1, s[4:7], s44 offen offset:1024 sc1 lds
buffer_load_dwordx4 v1, s[4:7], s44 offen offset:2048 sc1 lds
buffer_load_dwordx4 v1, s[4:7], s44 offen offset:3072 sc1 lds
s_add_u32 m0, s19, 147456
s_add_u32 s44, s87, 0xa1c000
buffer_load_dwordx4 v1, s[4:7], s44 offen offset:0 sc1 lds
buffer_load_dwordx4 v1, s[4:7], s44 offen offset:1024 sc1 lds
buffer_load_dwordx4 v1, s[4:7], s44 offen offset:2048 sc1 lds
buffer_load_dwordx4 v1, s[4:7], s44 offen offset:3072 sc1 lds
s_cmp_lg_u32 s28, 1
s_cbranch_scc1 Lpo_11
s_add_u32 s36, s11, 0x0
s_mov_b32 s37, 0
v_mov_b32 v11, 0
buffer_atomic_add v11, v251, s[4:7], s36 offen sc0 sc1
s_sleep 4
Lpoll_9:
v_mov_b32 v234, 0
buffer_atomic_add v234, v251, s[4:7], s36 offen sc0 sc1
s_waitcnt vmcnt(1)
v_readfirstlane_b32 s38, v11
s_nop 0
s_cmp_ge_u32 s38, 32
s_cbranch_scc1 Lpe_10
v_mov_b32 v11, 0
buffer_atomic_add v11, v251, s[4:7], s36 offen sc0 sc1
s_waitcnt vmcnt(1)
v_readfirstlane_b32 s38, v234
s_nop 0
s_cmp_ge_u32 s38, 32
s_cbranch_scc1 Lpe_10
s_add_u32 s37, s37, 1
s_cmp_lt_u32 s37, 0x80000
s_cbranch_scc1 Lpoll_9
s_waitcnt vmcnt(0)
Lpo_11:
s_waitcnt vmcnt(0)
Lpe_10:
s_barrier
L_k2go0:
buffer_load_dwordx4 a[0:3], v4, s[40:43], s35 offen offset:0 sc1
buffer_load_dwordx4 a[4:7], v4, s[40:43], s35 offen offset:1024 sc1
s_mov_b32 s35, 4096
buffer_load_dwordx4 a[8:11], v4, s[40:43], s35 offen offset:0 sc1
buffer_load_dwordx4 a[12:15], v4, s[40:43], s35 offen offset:1024 sc1
s_mov_b32 s35, 16384
buffer_load_dwordx4 a[16:19], v4, s[40:43], s35 offen offset:0 sc1
buffer_load_dwordx4 a[20:23], v4, s[40:43], s35 offen offset:1024 sc1
s_mov_b32 s35, 20480
buffer_load_dwordx4 a[24:27], v4, s[40:43], s35 offen offset:0 sc1
buffer_load_dwordx4 a[28:31], v4, s[40:43], s35 offen offset:1024 sc1
s_mov_b32 s35, 32768
buffer_load_dwordx4 a[32:35], v4, s[40:43], s35 offen offset:0 sc1
buffer_load_dwordx4 a[36:39], v4, s[40:43], s35 offen offset:1024 sc1
s_mov_b32 s35, 36864
buffer_load_dwordx4 a[40:43], v4, s[40:43], s35 offen offset:0 sc1
buffer_load_dwordx4 a[44:47], v4, s[40:43], s35 offen offset:1024 sc1
s_mov_b32 s35, 49152
ds_read_b128 a[96:99], v5 offset:0
ds_read_b128 a[100:103], v5 offset:1024
ds_read_b128 a[104:107], v5 offset:2048
ds_read_b128 a[108:111], v5 offset:3072
ds_read_b128 a[112:115], v5 offset:4096
ds_read_b128 a[116:119], v5 offset:5120
ds_read_b128 a[120:123], v5 offset:6144
ds_read_b128 a[124:127], v5 offset:7168
s_waitcnt vmcnt(10) lgkmcnt(4)
v_mfma_f32_16x16x32_bf16 v[132:135], a[96:99], a[0:3], v[132:135]
ds_read_b128 a[128:131], v5 offset:8192
v_mfma_f32_16x16x32_bf16 v[148:151], a[96:99], a[4:7], v[148:151]
ds_read_b128 a[132:135], v5 offset:9216
v_mfma_f32_16x16x32_bf16 v[152:155], a[100:103], a[4:7], v[152:155]
buffer_load_dwordx4 a[48:51], v4, s[40:43], s35 offen offset:0 sc1
v_mfma_f32_16x16x32_bf16 v[136:139], a[100:103], a[0:3], v[136:139]
ds_read_b128 a[136:139], v5 offset:10240
v_mfma_f32_16x16x32_bf16 v[140:143], a[104:107], a[0:3], v[140:143]
ds_read_b128 a[140:143], v5 offset:11264
v_mfma_f32_16x16x32_bf16 v[156:159], a[104:107], a[4:7], v[156:159]
v_mfma_f32_16x16x32_bf16 v[160:163], a[108:111], a[4:7], v[160:163]
buffer_load_dwordx4 a[52:55], v4, s[40:43], s35 offen offset:1024 sc1
s_mov_b32 s35, 53248
v_mfma_f32_16x16x32_bf16 v[144:147], a[108:111], a[0:3], v[144:147]
s_waitcnt vmcnt(10) lgkmcnt(4)
v_mfma_f32_16x16x32_bf16 v[132:135], a[112:115], a[8:11], v[132:135]
ds_read_b128 a[96:99], v5 offset:12288
v_mfma_f32_16x16x32_bf16 v[148:151], a[112:115], a[12:15], v[148:151]
ds_read_b128 a[100:103], v5 offset:13312
v_mfma_f32_16x16x32_bf16 v[152:155], a[116:119], a[12:15], v[152:155]
buffer_load_dwordx4 a[0:3], v4, s[40:43], s35 offen offset:0 sc1
v_mfma_f32_16x16x32_bf16 v[136:139], a[116:119], a[8:11], v[136:139]
ds_read_b128 a[104:107], v5 offset:14336
v_mfma_f32_16x16x32_bf16 v[140:143], a[120:123], a[8:11], v[140:143]
ds_read_b128 a[108:111], v5 offset:15360
v_mfma_f32_16x16x32_bf16 v[156:159], a[120:123], a[12:15], v[156:159]
v_mfma_f32_16x16x32_bf16 v[160:163], a[124:127], a[12:15], v[160:163]
buffer_load_dwordx4 a[4:7], v4, s[40:43], s35 offen offset:1024 sc1
s_mov_b32 s35, 65536
v_mfma_f32_16x16x32_bf16 v[144:147], a[124:127], a[8:11], v[144:147]
s_waitcnt vmcnt(10) lgkmcnt(4)
v_mfma_f32_16x16x32_bf16 v[132:135], a[128:131], a[16:19], v[132:135]
ds_read_b128 a[112:115], v5 offset:16384
v_mfma_f32_16x16x32_bf16 v[148:151], a[128:131], a[20:23], v[148:151]
ds_read_b128 a[116:119], v5 offset:17408
v_mfma_f32_16x16x32_bf16 v[152:155], a[132:135], a[20:23], v[152:155]
buffer_load_dwordx4 a[8:11], v4, s[40:43], s35 offen offset:0 sc1
v_mfma_f32_16x16x32_bf16 v[136:139], a[132:135], a[16:19], v[136:139]
L_stub3:
s_cbranch_execz L_wret1
ds_read_b128 a[120:123], v5 offset:18432
v_mfma_f32_16x16x32_bf16 v[140:143], a[136:139], a[16:19], v[140:143]
ds_read_b128 a[124:127], v5 offset:19456
v_mfma_f32_16x16x32_bf16 v[156:159], a[136:139], a[20:23], v[156:159]
v_mfma_f32_16x16x32_bf16 v[160:163], a[140:143], a[20:23], v[160:163]
buffer_load_dwordx4 a[12:15], v4, s[40:43], s35 offen offset:1024 sc1
s_mov_b32 s35, 69632
v_mfma_f32_16x16x32_bf16 v[144:147], a[140:143], a[16:19], v[144:147]
s_waitcnt vmcnt(10) lgkmcnt(4)
v_mfma_f32_16x16x32_bf16 v[132:135], a[96:99], a[24:27], v[132:135]
ds_read_b128 a[128:131], v5 offset:20480
v_mfma_f32_16x16x32_bf16 v[148:151], a[96:99], a[28:31], v[148:151]
ds_read_b128 a[132:135], v5 offset:21504
v_mfma_f32_16x16x32_bf16 v[152:155], a[100:103], a[28:31], v[152:155]
buffer_load_dwordx4 a[16:19], v4, s[40:43], s35 offen offset:0 sc1
v_mfma_f32_16x16x32_bf16 v[136:139], a[100:103], a[24:27], v[136:139]
ds_read_b128 a[136:139], v5 offset:22528
v_mfma_f32_16x16x32_bf16 v[140:143], a[104:107], a[24:27], v[140:143]
ds_read_b128 a[140:143], v5 offset:23552
v_mfma_f32_16x16x32_bf16 v[156:159], a[104:107], a[28:31], v[156:159]
v_mfma_f32_16x16x32_bf16 v[160:163], a[108:111], a[28:31], v[160:163]
buffer_load_dwordx4 a[20:23], v4, s[40:43], s35 offen offset:1024 sc1
s_mov_b32 s35, 81920
v_mfma_f32_16x16x32_bf16 v[144:147], a[108:111], a[24:27], v[144:147]
s_waitcnt vmcnt(10) lgkmcnt(4)
v_mfma_f32_16x16x32_bf16 v[132:135], a[112:115], a[32:35], v[132:135]
ds_read_b128 a[96:99], v5 offset:24576
v_mfma_f32_16x16x32_bf16 v[148:151], a[112:115], a[36:39], v[148:151]
ds_read_b128 a[100:103], v5 offset:25600
v_mfma_f32_16x16x32_bf16 v[152:155], a[116:119], a[36:39], v[152:155]
buffer_load_dwordx4 a[24:27], v4, s[40:43], s35 offen offset:0 sc1
v_mfma_f32_16x16x32_bf16 v[136:139], a[116:119], a[32:35], v[136:139]
ds_read_b128 a[104:107], v5 offset:26624
v_mfma_f32_16x16x32_bf16 v[140:143], a[120:123], a[32:35], v[140:143]
ds_read_b128 a[108:111], v5 offset:27648
v_mfma_f32_16x16x32_bf16 v[156:159], a[120:123], a[36:39], v[156:159]
v_mfma_f32_16x16x32_bf16 v[160:163], a[124:127], a[36:39], v[160:163]
buffer_load_dwordx4 a[28:31], v4, s[40:43], s35 offen offset:1024 sc1
s_mov_b32 s35, 86016
v_mfma_f32_16x16x32_bf16 v[144:147], a[124:127], a[32:35], v[144:147]
s_waitcnt vmcnt(10) lgkmcnt(4)
v_mfma_f32_16x16x32_bf16 v[132:135], a[128:131], a[40:43], v[132:135]
ds_read_b128 a[112:115], v5 offset:28672
v_mfma_f32_16x16x32_bf16 v[148:151], a[128:131], a[44:47], v[148:151]
ds_read_b128 a[116:119], v5 offset:29696
v_mfma_f32_16x16x32_bf16 v[152:155], a[132:135], a[44:47], v[152:155]
buffer_load_dwordx4 a[32:35], v4, s[40:43], s35 offen offset:0 sc1
v_mfma_f32_16x16x32_bf16 v[136:139], a[132:135], a[40:43], v[136:139]
ds_read_b128 a[120:123], v5 offset:30720
v_mfma_f32_16x16x32_bf16 v[140:143], a[136:139], a[40:43], v[140:143]
ds_read_b128 a[124:127], v5 offset:31744
v_mfma_f32_16x16x32_bf16 v[156:159], a[136:139], a[44:47], v[156:159]
v_mfma_f32_16x16x32_bf16 v[160:163], a[140:143], a[44:47], v[160:163]
buffer_load_dwordx4 a[36:39], v4, s[40:43], s35 offen offset:1024 sc1
s_mov_b32 s35, 98304
v_mfma_f32_16x16x32_bf16 v[144:147], a[140:143], a[40:43], v[144:147]
s_waitcnt vmcnt(10) lgkmcnt(4)
v_mfma_f32_16x16x32_bf16 v[132:135], a[96:99], a[48:51], v[132:135]
ds_read_b128 a[128:131], v5 offset:32768
v_mfma_f32_16x16x32_bf16 v[148:151], a[96:99], a[52:55], v[148:151]
ds_read_b128 a[132:135], v5 offset:33792
v_mfma_f32_16x16x32_bf16 v[152:155], a[100:103], a[52:55], v[152:155]
buffer_load_dwordx4 a[40:43], v4, s[40:43], s35 offen offset:0 sc1
v_mfma_f32_16x16x32_bf16 v[136:139], a[100:103], a[48:51], v[136:139]
ds_read_b128 a[136:139], v5 offset:34816
v_mfma_f32_16x16x32_bf16 v[140:143], a[104:107], a[48:51], v[140:143]
ds_read_b128 a[140:143], v5 offset:35840
v_mfma_f32_16x16x32_bf16 v[156:159], a[104:107], a[52:55], v[156:159]
v_mfma_f32_16x16x32_bf16 v[160:163], a[108:111], a[52:55], v[160:163]
buffer_load_dwordx4 a[44:47], v4, s[40:43], s35 offen offset:1024 sc1
s_mov_b32 s35, 102400
v_mfma_f32_16x16x32_bf16 v[144:147], a[108:111], a[48:51], v[144:147]
s_waitcnt vmcnt(10) lgkmcnt(4)
v_mfma_f32_16x16x32_bf16 v[132:135], a[112:115], a[0:3], v[132:135]
ds_read_b128 a[96:99], v5 offset:36864
v_mfma_f32_16x16x32_bf16 v[148:151], a[112:115], a[4:7], v[148:151]
ds_read_b128 a[100:103], v5 offset:37888
v_mfma_f32_16x16x32_bf16 v[152:155], a[116:119], a[4:7], v[152:155]
buffer_load_dwordx4 a[48:51], v4, s[40:43], s35 offen offset:0 sc1
v_mfma_f32_16x16x32_bf16 v[136:139], a[116:119], a[0:3], v[136:139]
ds_read_b128 a[104:107], v5 offset:38912
v_mfma_f32_16x16x32_bf16 v[140:143], a[120:123], a[0:3], v[140:143]
ds_read_b128 a[108:111], v5 offset:39936
v_mfma_f32_16x16x32_bf16 v[156:159], a[120:123], a[4:7], v[156:159]
v_mfma_f32_16x16x32_bf16 v[160:163], a[124:127], a[4:7], v[160:163]
buffer_load_dwordx4 a[52:55], v4, s[40:43], s35 offen offset:1024 sc1
s_mov_b32 s35, 114688
v_mfma_f32_16x16x32_bf16 v[144:147], a[124:127], a[0:3], v[144:147]
s_waitcnt vmcnt(10) lgkmcnt(4)
v_mfma_f32_16x16x32_bf16 v[132:135], a[128:131], a[8:11], v[132:135]
ds_read_b128 a[112:115], v5 offset:40960
v_mfma_f32_16x16x32_bf16 v[148:151], a[128:131], a[12:15], v[148:151]
ds_read_b128 a[116:119], v5 offset:41984
v_mfma_f32_16x16x32_bf16 v[152:155], a[132:135], a[12:15], v[152:155]
buffer_load_dwordx4 a[0:3], v4, s[40:43], s35 offen offset:0 sc1
v_mfma_f32_16x16x32_bf16 v[136:139], a[132:135], a[8:11], v[136:139]
ds_read_b128 a[120:123], v5 offset:43008
v_mfma_f32_16x16x32_bf16 v[140:143], a[136:139], a[8:11], v[140:143]
ds_read_b128 a[124:127], v5 offset:44032
v_mfma_f32_16x16x32_bf16 v[156:159], a[136:139], a[12:15], v[156:159]
v_mfma_f32_16x16x32_bf16 v[160:163], a[140:143], a[12:15], v[160:163]
buffer_load_dwordx4 a[4:7], v4, s[40:43], s35 offen offset:1024 sc1
s_mov_b32 s35, 118784
v_mfma_f32_16x16x32_bf16 v[144:147], a[140:143], a[8:11], v[144:147]
s_waitcnt vmcnt(10) lgkmcnt(4)
v_mfma_f32_16x16x32_bf16 v[132:135], a[96:99], a[16:19], v[132:135]
ds_read_b128 a[128:131], v5 offset:45056
v_mfma_f32_16x16x32_bf16 v[148:151], a[96:99], a[20:23], v[148:151]
ds_read_b128 a[132:135], v5 offset:46080
v_mfma_f32_16x16x32_bf16 v[152:155], a[100:103], a[20:23], v[152:155]
buffer_load_dwordx4 a[8:11], v4, s[40:43], s35 offen offset:0 sc1
v_mfma_f32_16x16x32_bf16 v[136:139], a[100:103], a[16:19], v[136:139]
ds_read_b128 a[136:139], v5 offset:47104
v_mfma_f32_16x16x32_bf16 v[140:143], a[104:107], a[16:19], v[140:143]
ds_read_b128 a[140:143], v5 offset:48128
v_mfma_f32_16x16x32_bf16 v[156:159], a[104:107], a[20:23], v[156:159]
v_mfma_f32_16x16x32_bf16 v[160:163], a[108:111], a[20:23], v[160:163]
buffer_load_dwordx4 a[12:15], v4, s[40:43], s35 offen offset:1024 sc1
s_mov_b32 s35, 524288
v_mfma_f32_16x16x32_bf16 v[144:147], a[108:111], a[16:19], v[144:147]
s_waitcnt vmcnt(10) lgkmcnt(4)
v_mfma_f32_16x16x32_bf16 v[132:135], a[112:115], a[24:27], v[132:135]
ds_read_b128 a[96:99], v5 offset:49152
v_mfma_f32_16x16x32_bf16 v[148:151], a[112:115], a[28:31], v[148:151]
ds_read_b128 a[100:103], v5 offset:50176
v_mfma_f32_16x16x32_bf16 v[152:155], a[116:119], a[28:31], v[152:155]
buffer_load_dwordx4 a[16:19], v4, s[40:43], s35 offen offset:0 sc1
v_mfma_f32_16x16x32_bf16 v[136:139], a[116:119], a[24:27], v[136:139]
ds_read_b128 a[104:107], v5 offset:51200
v_mfma_f32_16x16x32_bf16 v[140:143], a[120:123], a[24:27], v[140:143]
ds_read_b128 a[108:111], v5 offset:52224
v_mfma_f32_16x16x32_bf16 v[156:159], a[120:123], a[28:31], v[156:159]
v_mfma_f32_16x16x32_bf16 v[160:163], a[124:127], a[28:31], v[160:163]
buffer_load_dwordx4 a[20:23], v4, s[40:43], s35 offen offset:1024 sc1
s_mov_b32 s35, 528384
v_mfma_f32_16x16x32_bf16 v[144:147], a[124:127], a[24:27], v[144:147]
s_waitcnt vmcnt(10) lgkmcnt(4)
v_mfma_f32_16x16x32_bf16 v[132:135], a[128:131], a[32:35], v[132:135]
ds_read_b128 a[112:115], v5 offset:53248
v_mfma_f32_16x16x32_bf16 v[148:151], a[128:131], a[36:39], v[148:151]
ds_read_b128 a[116:119], v5 offset:54272
v_mfma_f32_16x16x32_bf16 v[152:155], a[132:135], a[36:39], v[152:155]
buffer_load_dwordx4 a[24:27], v4, s[40:43], s35 offen offset:0 sc1
v_mfma_f32_16x16x32_bf16 v[136:139], a[132:135], a[32:35], v[136:139]
ds_read_b128 a[120:123], v5 offset:55296
v_mfma_f32_16x16x32_bf16 v[140:143], a[136:139], a[32:35], v[140:143]
ds_read_b128 a[124:127], v5 offset:56320
v_mfma_f32_16x16x32_bf16 v[156:159], a[136:139], a[36:39], v[156:159]
v_mfma_f32_16x16x32_bf16 v[160:163], a[140:143], a[36:39], v[160:163]
buffer_load_dwordx4 a[28:31], v4, s[40:43], s35 offen offset:1024 sc1
s_mov_b32 s35, 540672
v_mfma_f32_16x16x32_bf16 v[144:147], a[140:143], a[32:35], v[144:147]
s_waitcnt vmcnt(10) lgkmcnt(4)
v_mfma_f32_16x16x32_bf16 v[132:135], a[96:99], a[40:43], v[132:135]
ds_read_b128 a[128:131], v5 offset:57344
v_mfma_f32_16x16x32_bf16 v[148:151], a[96:99], a[44:47], v[148:151]
ds_read_b128 a[132:135], v5 offset:58368
v_mfma_f32_16x16x32_bf16 v[152:155], a[100:103], a[44:47], v[152:155]
buffer_load_dwordx4 a[32:35], v4, s[40:43], s35 offen offset:0 sc1
v_mfma_f32_16x16x32_bf16 v[136:139], a[100:103], a[40:43], v[136:139]
ds_read_b128 a[136:139], v5 offset:59392
v_mfma_f32_16x16x32_bf16 v[140:143], a[104:107], a[40:43], v[140:143]
ds_read_b128 a[140:143], v5 offset:60416
v_mfma_f32_16x16x32_bf16 v[156:159], a[104:107], a[44:47], v[156:159]
v_mfma_f32_16x16x32_bf16 v[160:163], a[108:111], a[44:47], v[160:163]
buffer_load_dwordx4 a[36:39], v4, s[40:43], s35 offen offset:1024 sc1
s_mov_b32 s35, 544768
v_mfma_f32_16x16x32_bf16 v[144:147], a[108:111], a[40:43], v[144:147]
s_waitcnt vmcnt(10) lgkmcnt(4)
v_mfma_f32_16x16x32_bf16 v[132:135], a[112:115], a[48:51], v[132:135]
ds_read_b128 a[96:99], v5 offset:61440
v_mfma_f32_16x16x32_bf16 v[148:151], a[112:115], a[52:55], v[148:151]
ds_read_b128 a[100:103], v5 offset:62464
v_mfma_f32_16x16x32_bf16 v[152:155], a[116:119], a[52:55], v[152:155]
buffer_load_dwordx4 a[40:43], v4, s[40:43], s35 offen offset:0 sc1
v_mfma_f32_16x16x32_bf16 v[136:139], a[116:119], a[48:51], v[136:139]
ds_read_b128 a[104:107], v5 offset:63488
v_mfma_f32_16x16x32_bf16 v[140:143], a[120:123], a[48:51], v[140:143]
ds_read_b128 a[108:111], v5 offset:64512
v_mfma_f32_16x16x32_bf16 v[156:159], a[120:123], a[52:55], v[156:159]
v_mfma_f32_16x16x32_bf16 v[160:163], a[124:127], a[52:55], v[160:163]
buffer_load_dwordx4 a[44:47], v4, s[40:43], s35 offen offset:1024 sc1
s_mov_b32 s35, 557056
v_mfma_f32_16x16x32_bf16 v[144:147], a[124:127], a[48:51], v[144:147]
s_waitcnt vmcnt(10) lgkmcnt(4)
v_mfma_f32_16x16x32_bf16 v[132:135], a[128:131], a[0:3], v[132:135]
ds_read_b128 a[112:115], v6 offset:0
v_mfma_f32_16x16x32_bf16 v[148:151], a[128:131], a[4:7], v[148:151]
ds_read_b128 a[116:119], v6 offset:1024
v_mfma_f32_16x16x32_bf16 v[152:155], a[132:135], a[4:7], v[152:155]
buffer_load_dwordx4 a[48:51], v4, s[40:43], s35 offen offset:0 sc1
v_mfma_f32_16x16x32_bf16 v[136:139], a[132:135], a[0:3], v[136:139]
ds_read_b128 a[120:123], v6 offset:2048
v_mfma_f32_16x16x32_bf16 v[140:143], a[136:139], a[0:3], v[140:143]
ds_read_b128 a[124:127], v6 offset:3072
v_mfma_f32_16x16x32_bf16 v[156:159], a[136:139], a[4:7], v[156:159]
v_mfma_f32_16x16x32_bf16 v[160:163], a[140:143], a[4:7], v[160:163]
buffer_load_dwordx4 a[52:55], v4, s[40:43], s35 offen offset:1024 sc1
s_mov_b32 s35, 561152
v_mfma_f32_16x16x32_bf16 v[144:147], a[140:143], a[0:3], v[144:147]
s_waitcnt vmcnt(10) lgkmcnt(4)
v_mfma_f32_16x16x32_bf16 v[132:135], a[96:99], a[8:11], v[132:135]
ds_read_b128 a[128:131], v6 offset:4096
v_mfma_f32_16x16x32_bf16 v[148:151], a[96:99], a[12:15], v[148:151]
ds_read_b128 a[132:135], v6 offset:5120
v_mfma_f32_16x16x32_bf16 v[152:155], a[100:103], a[12:15], v[152:155]
buffer_load_dwordx4 a[0:3], v4, s[40:43], s35 offen offset:0 sc1
v_mfma_f32_16x16x32_bf16 v[136:139], a[100:103], a[8:11], v[136:139]
ds_read_b128 a[136:139], v6 offset:6144
v_mfma_f32_16x16x32_bf16 v[140:143], a[104:107], a[8:11], v[140:143]
ds_read_b128 a[140:143], v6 offset:7168
v_mfma_f32_16x16x32_bf16 v[156:159], a[104:107], a[12:15], v[156:159]
v_mfma_f32_16x16x32_bf16 v[160:163], a[108:111], a[12:15], v[160:163]
buffer_load_dwordx4 a[4:7], v4, s[40:43], s35 offen offset:1024 sc1
s_mov_b32 s35, 573440
v_mfma_f32_16x16x32_bf16 v[144:147], a[108:111], a[8:11], v[144:147]
s_waitcnt vmcnt(10) lgkmcnt(4)
v_mfma_f32_16x16x32_bf16 v[132:135], a[112:115], a[16:19], v[132:135]
ds_read_b128 a[96:99], v6 offset:8192
v_mfma_f32_16x16x32_bf16 v[148:151], a[112:115], a[20:23], v[148:151]
ds_read_b128 a[100:103], v6 offset:9216
v_mfma_f32_16x16x32_bf16 v[152:155], a[116:119], a[20:23], v[152:155]
buffer_load_dwordx4 a[8:11], v4, s[40:43], s35 offen offset:0 sc1
v_mfma_f32_16x16x32_bf16 v[136:139], a[116:119], a[16:19], v[136:139]
ds_read_b128 a[104:107], v6 offset:10240
v_mfma_f32_16x16x32_bf16 v[140:143], a[120:123], a[16:19], v[140:143]
ds_read_b128 a[108:111], v6 offset:11264
v_mfma_f32_16x16x32_bf16 v[156:159], a[120:123], a[20:23], v[156:159]
v_mfma_f32_16x16x32_bf16 v[160:163], a[124:127], a[20:23], v[160:163]
buffer_load_dwordx4 a[12:15], v4, s[40:43], s35 offen offset:1024 sc1
s_mov_b32 s35, 577536
v_mfma_f32_16x16x32_bf16 v[144:147], a[124:127], a[16:19], v[144:147]
s_waitcnt vmcnt(10) lgkmcnt(4)
v_mfma_f32_16x16x32_bf16 v[132:135], a[128:131], a[24:27], v[132:135]
ds_read_b128 a[112:115], v6 offset:12288
v_mfma_f32_16x16x32_bf16 v[148:151], a[128:131], a[28:31], v[148:151]
ds_read_b128 a[116:119], v6 offset:13312
v_mfma_f32_16x16x32_bf16 v[152:155], a[132:135], a[28:31], v[152:155]
buffer_load_dwordx4 a[16:19], v4, s[40:43], s35 offen offset:0 sc1
v_mfma_f32_16x16x32_bf16 v[136:139], a[132:135], a[24:27], v[136:139]
ds_read_b128 a[120:123], v6 offset:14336
v_mfma_f32_16x16x32_bf16 v[140:143], a[136:139], a[24:27], v[140:143]
ds_read_b128 a[124:127], v6 offset:15360
v_mfma_f32_16x16x32_bf16 v[156:159], a[136:139], a[28:31], v[156:159]
v_mfma_f32_16x16x32_bf16 v[160:163], a[140:143], a[28:31], v[160:163]
buffer_load_dwordx4 a[20:23], v4, s[40:43], s35 offen offset:1024 sc1
s_mov_b32 s35, 589824
v_mfma_f32_16x16x32_bf16 v[144:147], a[140:143], a[24:27], v[144:147]
s_waitcnt vmcnt(10) lgkmcnt(4)
v_mfma_f32_16x16x32_bf16 v[132:135], a[96:99], a[32:35], v[132:135]
ds_read_b128 a[128:131], v6 offset:16384
v_mfma_f32_16x16x32_bf16 v[148:151], a[96:99], a[36:39], v[148:151]
ds_read_b128 a[132:135], v6 offset:17408
v_mfma_f32_16x16x32_bf16 v[152:155], a[100:103], a[36:39], v[152:155]
buffer_load_dwordx4 a[24:27], v4, s[40:43], s35 offen offset:0 sc1
v_mfma_f32_16x16x32_bf16 v[136:139], a[100:103], a[32:35], v[136:139]
ds_read_b128 a[136:139], v6 offset:18432
v_mfma_f32_16x16x32_bf16 v[140:143], a[104:107], a[32:35], v[140:143]
ds_read_b128 a[140:143], v6 offset:19456
v_mfma_f32_16x16x32_bf16 v[156:159], a[104:107], a[36:39], v[156:159]
v_mfma_f32_16x16x32_bf16 v[160:163], a[108:111], a[36:39], v[160:163]
buffer_load_dwordx4 a[28:31], v4, s[40:43], s35 offen offset:1024 sc1
s_mov_b32 s35, 593920
v_mfma_f32_16x16x32_bf16 v[144:147], a[108:111], a[32:35], v[144:147]
s_waitcnt vmcnt(10) lgkmcnt(4)
v_mfma_f32_16x16x32_bf16 v[132:135], a[112:115], a[40:43], v[132:135]
ds_read_b128 a[96:99], v6 offset:20480
v_mfma_f32_16x16x32_bf16 v[148:151], a[112:115], a[44:47], v[148:151]
ds_read_b128 a[100:103], v6 offset:21504
v_mfma_f32_16x16x32_bf16 v[152:155], a[116:119], a[44:47], v[152:155]
buffer_load_dwordx4 a[32:35], v4, s[40:43], s35 offen offset:0 sc1
v_mfma_f32_16x16x32_bf16 v[136:139], a[116:119], a[40:43], v[136:139]
ds_read_b128 a[104:107], v6 offset:22528
v_mfma_f32_16x16x32_bf16 v[140:143], a[120:123], a[40:43], v[140:143]
ds_read_b128 a[108:111], v6 offset:23552
v_mfma_f32_16x16x32_bf16 v[156:159], a[120:123], a[44:47], v[156:159]
v_mfma_f32_16x16x32_bf16 v[160:163], a[124:127], a[44:47], v[160:163]
buffer_load_dwordx4 a[36:39], v4, s[40:43], s35 offen offset:1024 sc1
s_mov_b32 s35, 606208
v_mfma_f32_16x16x32_bf16 v[144:147], a[124:127], a[40:43], v[144:147]
s_waitcnt vmcnt(10) lgkmcnt(4)
v_mfma_f32_16x16x32_bf16 v[132:135], a[128:131], a[48:51], v[132:135]
ds_read_b128 a[112:115], v6 offset:24576
v_mfma_f32_16x16x32_bf16 v[148:151], a[128:131], a[52:55], v[148:151]
ds_read_b128 a[116:119], v6 offset:25600
v_mfma_f32_16x16x32_bf16 v[152:155], a[132:135], a[52:55], v[152:155]
buffer_load_dwordx4 a[40:43], v4, s[40:43], s35 offen offset:0 sc1
v_mfma_f32_16x16x32_bf16 v[136:139], a[132:135], a[48:51], v[136:139]
ds_read_b128 a[120:123], v6 offset:26624
v_mfma_f32_16x16x32_bf16 v[140:143], a[136:139], a[48:51], v[140:143]
s_add_u32 s88, s67, 0xe0000
s_add_u32 s89, s66, 0xd0000
v_mfma_f32_16x16x32_bf16 v[156:159], a[136:139], a[52:55], v[156:159]
buffer_load_dword v11, v255, s[4:7], s88 offen sc1
v_mfma_f32_16x16x32_bf16 v[160:163], a[140:143], a[52:55], v[160:163]
buffer_load_dwordx4 a[44:47], v4, s[40:43], s35 offen offset:1024 sc1
s_mov_b32 s35, 610304
v_mfma_f32_16x16x32_bf16 v[144:147], a[140:143], a[48:51], v[144:147]
ds_read_b128 a[124:127], v6 offset:27648
s_waitcnt vmcnt(11) lgkmcnt(4)
v_mfma_f32_16x16x32_bf16 v[132:135], a[96:99], a[0:3], v[132:135]
buffer_load_dword v232, v255, s[4:7], s89 offen offset:64 sc1
v_mfma_f32_16x16x32_bf16 v[148:151], a[96:99], a[4:7], v[148:151]
ds_read_b128 a[128:131], v6 offset:28672
v_mfma_f32_16x16x32_bf16 v[152:155], a[100:103], a[4:7], v[152:155]
buffer_load_dwordx4 a[48:51], v4, s[40:43], s35 offen offset:0 sc1
v_mfma_f32_16x16x32_bf16 v[136:139], a[100:103], a[0:3], v[136:139]
ds_read_b128 a[132:135], v6 offset:29696
v_mfma_f32_16x16x32_bf16 v[140:143], a[104:107], a[0:3], v[140:143]
ds_read_b128 a[136:139], v6 offset:30720
v_mfma_f32_16x16x32_bf16 v[156:159], a[104:107], a[4:7], v[156:159]
ds_read_b128 a[140:143], v6 offset:31744
v_mfma_f32_16x16x32_bf16 v[160:163], a[108:111], a[4:7], v[160:163]
buffer_load_dwordx4 a[52:55], v4, s[40:43], s35 offen offset:1024 sc1
s_mov_b32 s35, 622592
v_mfma_f32_16x16x32_bf16 v[144:147], a[108:111], a[0:3], v[144:147]
s_waitcnt vmcnt(12) lgkmcnt(4)
v_mfma_f32_16x16x32_bf16 v[132:135], a[112:115], a[8:11], v[132:135]
ds_read_b128 a[96:99], v6 offset:32768
v_mfma_f32_16x16x32_bf16 v[148:151], a[112:115], a[12:15], v[148:151]
ds_read_b128 a[100:103], v6 offset:33792
v_mfma_f32_16x16x32_bf16 v[152:155], a[116:119], a[12:15], v[152:155]
buffer_load_dwordx4 a[0:3], v4, s[40:43], s35 offen offset:0 sc1
v_mfma_f32_16x16x32_bf16 v[136:139], a[116:119], a[8:11], v[136:139]
ds_read_b128 a[104:107], v6 offset:34816
v_mfma_f32_16x16x32_bf16 v[140:143], a[120:123], a[8:11], v[140:143]
ds_read_b128 a[108:111], v6 offset:35840
v_mfma_f32_16x16x32_bf16 v[156:159], a[120:123], a[12:15], v[156:159]
v_mfma_f32_16x16x32_bf16 v[160:163], a[124:127], a[12:15], v[160:163]
buffer_load_dwordx4 a[4:7], v4, s[40:43], s35 offen offset:1024 sc1
s_mov_b32 s35, 626688
v_mfma_f32_16x16x32_bf16 v[144:147], a[124:127], a[8:11], v[144:147]
s_waitcnt vmcnt(12) lgkmcnt(4)
v_mfma_f32_16x16x32_bf16 v[132:135], a[128:131], a[16:19], v[132:135]
ds_read_b128 a[112:115], v6 offset:36864
v_mfma_f32_16x16x32_bf16 v[148:151], a[128:131], a[20:23], v[148:151]
ds_read_b128 a[116:119], v6 offset:37888
v_mfma_f32_16x16x32_bf16 v[152:155], a[132:135], a[20:23], v[152:155]
buffer_load_dwordx4 a[8:11], v4, s[40:43], s35 offen offset:0 sc1
v_mfma_f32_16x16x32_bf16 v[136:139], a[132:135], a[16:19], v[136:139]
ds_read_b128 a[120:123], v6 offset:38912
v_mfma_f32_16x16x32_bf16 v[140:143], a[136:139], a[16:19], v[140:143]
ds_read_b128 a[124:127], v6 offset:39936
v_mfma_f32_16x16x32_bf16 v[156:159], a[136:139], a[20:23], v[156:159]
v_mfma_f32_16x16x32_bf16 v[160:163], a[140:143], a[20:23], v[160:163]
buffer_load_dwordx4 a[12:15], v4, s[40:43], s35 offen offset:1024 sc1
s_mov_b32 s35, 638976
v_mfma_f32_16x16x32_bf16 v[144:147], a[140:143], a[16:19], v[144:147]
s_waitcnt vmcnt(12) lgkmcnt(4)
v_mfma_f32_16x16x32_bf16 v[132:135], a[96:99], a[24:27], v[132:135]
ds_read_b128 a[128:131], v6 offset:40960
v_mfma_f32_16x16x32_bf16 v[148:151], a[96:99], a[28:31], v[148:151]
ds_read_b128 a[132:135], v6 offset:41984
v_mfma_f32_16x16x32_bf16 v[152:155], a[100:103], a[28:31], v[152:155]
buffer_load_dwordx4 a[16:19], v4, s[40:43], s35 offen offset:0 sc1
v_mfma_f32_16x16x32_bf16 v[136:139], a[100:103], a[24:27], v[136:139]
ds_read_b128 a[136:139], v6 offset:43008
v_mfma_f32_16x16x32_bf16 v[140:143], a[104:107], a[24:27], v[140:143]
ds_read_b128 a[140:143], v6 offset:44032
v_mfma_f32_16x16x32_bf16 v[156:159], a[104:107], a[28:31], v[156:159]
v_mfma_f32_16x16x32_bf16 v[160:163], a[108:111], a[28:31], v[160:163]
buffer_load_dwordx4 a[20:23], v4, s[40:43], s35 offen offset:1024 sc1
s_mov_b32 s35, 643072
v_mfma_f32_16x16x32_bf16 v[144:147], a[108:111], a[24:27], v[144:147]
s_waitcnt vmcnt(12) lgkmcnt(4)
v_mfma_f32_16x16x32_bf16 v[132:135], a[112:115], a[32:35], v[132:135]
ds_read_b128 a[96:99], v6 offset:45056
v_mfma_f32_16x16x32_bf16 v[148:151], a[112:115], a[36:39], v[148:151]
ds_read_b128 a[100:103], v6 offset:46080
v_mfma_f32_16x16x32_bf16 v[152:155], a[116:119], a[36:39], v[152:155]
buffer_load_dwordx4 a[24:27], v4, s[40:43], s35 offen offset:0 sc1
v_mfma_f32_16x16x32_bf16 v[136:139], a[116:119], a[32:35], v[136:139]
ds_read_b128 a[104:107], v6 offset:47104
v_mfma_f32_16x16x32_bf16 v[140:143], a[120:123], a[32:35], v[140:143]
ds_read_b128 a[108:111], v6 offset:48128
v_mfma_f32_16x16x32_bf16 v[156:159], a[120:123], a[36:39], v[156:159]
v_mfma_f32_16x16x32_bf16 v[160:163], a[124:127], a[36:39], v[160:163]
buffer_load_dwordx4 a[28:31], v4, s[40:43], s35 offen offset:1024 sc1
s_mov_b32 s35, 1048576
v_mfma_f32_16x16x32_bf16 v[144:147], a[124:127], a[32:35], v[144:147]
s_waitcnt vmcnt(11) lgkmcnt(4)
v_cmp_ne_u32 vcc, v11, v15
s_cbranch_vccnz Ltr_12
Lte_14:
v_mfma_f32_16x16x32_bf16 v[132:135], a[128:131], a[40:43], v[132:135]
s_add_u32 m0, s18, 0x0
s_add_u32 s44, s50, 0x3400000
v_mfma_f32_16x16x32_bf16 v[148:151], a[128:131], a[44:47], v[148:151]
ds_read_b128 a[112:115], v6 offset:49152
v_mfma_f32_16x16x32_bf16 v[152:155], a[132:135], a[44:47], v[152:155]
buffer_load_dwordx4 v1, s[4:7], s44 offen offset:0 sc1 lds
v_mfma_f32_16x16x32_bf16 v[136:139], a[132:135], a[40:43], v[136:139]
ds_read_b128 a[116:119], v6 offset:50176
v_mfma_f32_16x16x32_bf16 v[140:143], a[136:139], a[40:43], v[140:143]
ds_read_b128 a[120:123], v6 offset:51200
v_mfma_f32_16x16x32_bf16 v[156:159], a[136:139], a[44:47], v[156:159]
ds_read_b128 a[124:127], v6 offset:52224
v_mfma_f32_16x16x32_bf16 v[160:163], a[140:143], a[44:47], v[160:163]
buffer_load_dwordx4 v1, s[4:7], s44 offen offset:1024 sc1 lds
s_add_u32 m0, s18, 0x2000
v_mfma_f32_16x16x32_bf16 v[144:147], a[140:143], a[40:43], v[144:147]
s_add_u32 s44, s50, 0x3402000
s_waitcnt vmcnt(10) lgkmcnt(4)
v_mfma_f32_16x16x32_bf16 v[132:135], a[96:99], a[48:51], v[132:135]
ds_read_b128 a[128:131], v6 offset:53248
v_mfma_f32_16x16x32_bf16 v[148:151], a[96:99], a[52:55], v[148:151]
ds_read_b128 a[132:135], v6 offset:54272
v_mfma_f32_16x16x32_bf16 v[152:155], a[100:103], a[52:55], v[152:155]
buffer_load_dwordx4 v1, s[4:7], s44 offen offset:0 sc1 lds
v_mfma_f32_16x16x32_bf16 v[136:139], a[100:103], a[48:51], v[136:139]
ds_read_b128 a[136:139], v6 offset:55296
v_mfma_f32_16x16x32_bf16 v[140:143], a[104:107], a[48:51], v[140:143]
ds_read_b128 a[140:143], v6 offset:56320
v_mfma_f32_16x16x32_bf16 v[156:159], a[104:107], a[52:55], v[156:159]
v_mfma_f32_16x16x32_bf16 v[160:163], a[108:111], a[52:55], v[160:163]
buffer_load_dwordx4 v1, s[4:7], s44 offen offset:1024 sc1 lds
s_add_u32 m0, s18, 0x4000
v_mfma_f32_16x16x32_bf16 v[144:147], a[108:111], a[48:51], v[144:147]
s_add_u32 s44, s50, 0x3404000
s_waitcnt vmcnt(10) lgkmcnt(4)
v_mfma_f32_16x16x32_bf16 v[132:135], a[112:115], a[0:3], v[132:135]
ds_read_b128 a[96:99], v6 offset:57344
v_mfma_f32_16x16x32_bf16 v[148:151], a[112:115], a[4:7], v[148:151]
ds_read_b128 a[100:103], v6 offset:58368
v_mfma_f32_16x16x32_bf16 v[152:155], a[116:119], a[4:7], v[152:155]
ds_read_b128 a[104:107], v6 offset:59392
v_mfma_f32_16x16x32_bf16 v[136:139], a[116:119], a[0:3], v[136:139]
buffer_load_dwordx4 v1, s[4:7], s44 offen offset:0 sc1 lds
v_mfma_f32_16x16x32_bf16 v[140:143], a[120:123], a[0:3], v[140:143]
ds_read_b128 a[108:111], v6 offset:60416
v_mfma_f32_16x16x32_bf16 v[156:159], a[120:123], a[4:7], v[156:159]
v_mfma_f32_16x16x32_bf16 v[160:163], a[124:127], a[4:7], v[160:163]
v_mfma_f32_16x16x32_bf16 v[144:147], a[124:127], a[0:3], v[144:147]
buffer_load_dwordx4 v1, s[4:7], s44 offen offset:1024 sc1 lds
s_waitcnt vmcnt(10) lgkmcnt(4)
v_mfma_f32_16x16x32_bf16 v[132:135], a[128:131], a[8:11], v[132:135]
s_add_u32 m0, s18, 0x6000
s_add_u32 s44, s50, 0x3406000
v_mfma_f32_16x16x32_bf16 v[148:151], a[128:131], a[12:15], v[148:151]
ds_read_b128 a[112:115], v6 offset:61440
v_mfma_f32_16x16x32_bf16 v[152:155], a[132:135], a[12:15], v[152:155]
ds_read_b128 a[116:119], v6 offset:62464
v_mfma_f32_16x16x32_bf16 v[136:139], a[132:135], a[8:11], v[136:139]
ds_read_b128 a[120:123], v6 offset:63488
v_mfma_f32_16x16x32_bf16 v[140:143], a[136:139], a[8:11], v[140:143]
buffer_load_dwordx4 v1, s[4:7], s44 offen offset:0 sc1 lds
v_mfma_f32_16x16x32_bf16 v[156:159], a[136:139], a[12:15], v[156:159]
ds_read_b128 a[124:127], v6 offset:64512
v_mfma_f32_16x16x32_bf16 v[160:163], a[140:143], a[12:15], v[160:163]
v_mfma_f32_16x16x32_bf16 v[144:147], a[140:143], a[8:11], v[144:147]
s_waitcnt vmcnt(9) lgkmcnt(4)
v_mfma_f32_16x16x32_bf16 v[132:135], a[96:99], a[16:19], v[132:135]
v_mfma_f32_16x16x32_bf16 v[148:151], a[96:99], a[20:23], v[148:151]
buffer_load_dwordx4 v1, s[4:7], s44 offen offset:1024 sc1 lds
v_mfma_f32_16x16x32_bf16 v[152:155], a[100:103], a[20:23], v[152:155]
v_mfma_f32_16x16x32_bf16 v[136:139], a[100:103], a[16:19], v[136:139]
v_mfma_f32_16x16x32_bf16 v[140:143], a[104:107], a[16:19], v[140:143]
v_mfma_f32_16x16x32_bf16 v[156:159], a[104:107], a[20:23], v[156:159]
v_mfma_f32_16x16x32_bf16 v[160:163], a[108:111], a[20:23], v[160:163]
v_mfma_f32_16x16x32_bf16 v[144:147], a[108:111], a[16:19], v[144:147]
s_waitcnt vmcnt(8) lgkmcnt(0)
v_mfma_f32_16x16x32_bf16 v[132:135], a[112:115], a[24:27], v[132:135]
v_mfma_f32_16x16x32_bf16 v[148:151], a[112:115], a[28:31], v[148:151]
v_mfma_f32_16x16x32_bf16 v[152:155], a[116:119], a[28:31], v[152:155]
v_mfma_f32_16x16x32_bf16 v[136:139], a[116:119], a[24:27], v[136:139]
v_mfma_f32_16x16x32_bf16 v[140:143], a[120:123], a[24:27], v[140:143]
v_mfma_f32_16x16x32_bf16 v[156:159], a[120:123], a[28:31], v[156:159]
v_mfma_f32_16x16x32_bf16 v[160:163], a[124:127], a[28:31], v[160:163]
v_mfma_f32_16x16x32_bf16 v[144:147], a[124:127], a[24:27], v[144:147]
s_lshr_b32 s37, s32, 3
s_and_b32 s36, s32, 7
s_mul_i32 s37, s37, 524288
s_lshl_b32 s36, s36, 14
s_add_u32 s36, s36, s37
v_cvt_pk_bf16_f32 v32, v132, v133
v_cvt_pk_bf16_f32 v33, v134, v135
v_cvt_pk_bf16_f32 v34, v136, v137
v_cvt_pk_bf16_f32 v35, v138, v139
s_add_u32 s36, s36, 0x1c00000
buffer_store_dwordx4 v[32:35], v4, s[4:7], s36 offen offset:0 sc1
v_cvt_pk_bf16_f32 v40, v148, v149
v_cvt_pk_bf16_f32 v41, v150, v151
v_cvt_pk_bf16_f32 v42, v152, v153
v_cvt_pk_bf16_f32 v43, v154, v155
v_cvt_pk_bf16_f32 v36, v140, v141
v_cvt_pk_bf16_f32 v37, v142, v143
v_cvt_pk_bf16_f32 v38, v144, v145
v_cvt_pk_bf16_f32 v39, v146, v147
s_add_u32 s37, s36, 4096
v_cvt_pk_bf16_f32 v44, v156, v157
v_cvt_pk_bf16_f32 v45, v158, v159
v_cvt_pk_bf16_f32 v46, v160, v161
buffer_store_dwordx4 v[40:43], v4, s[4:7], s36 offen offset:1024 sc1
v_cvt_pk_bf16_f32 v47, v162, v163
v_mfma_f32_16x16x32_bf16 v[96:99], v[32:35], v[32:35], 0
s_mov_b32 s38, 0x240000
s_add_u32 s92, s78, 0x40000
v_mfma_f32_16x16x32_bf16 v[92:95], v[16:19], v[32:35], 0
s_add_u32 s40, s4, 0x1c00000
s_addc_u32 s41, s5, 0
v_mfma_f32_16x16x32_bf16 v[96:99], v[36:39], v[36:39], v[96:99]
buffer_store_dwordx4 v[36:39], v4, s[4:7], s37 offen offset:0 sc1
v_mfma_f32_16x16x32_bf16 v[92:95], v[16:19], v[36:39], v[92:95]
s_nop 5
v_cndmask_b32 v96, v96, v97, s[46:47]
v_cndmask_b32 v98, v98, v99, s[46:47]
v_mfma_f32_16x16x32_bf16 v[104:107], v[40:43], v[40:43], 0
v_mfma_f32_16x16x32_bf16 v[100:103], v[16:19], v[40:43], 0
v_cndmask_b32 v93, v96, v98, s[48:49]
buffer_store_dwordx4 v[44:47], v4, s[4:7], s37 offen offset:1024 sc1
v_mfma_f32_16x16x32_bf16 v[104:107], v[44:47], v[44:47], v[104:107]
v_mfma_f32_16x16x32_bf16 v[100:103], v[16:19], v[44:47], v[100:103]
s_nop 6
v_cndmask_b32 v104, v104, v105, s[46:47]
v_cndmask_b32 v106, v106, v107, s[46:47]
buffer_store_dwordx2 v[92:93], v253, s[4:7], s38 offen offset:0 sc1
v_cndmask_b32 v101, v104, v106, s[48:49]
buffer_store_dwordx2 v[100:101], v253, s[4:7], s38 offen offset:2048 sc1
v_cmp_ne_u32 vcc, v232, v15
s_cbranch_vccnz Ltr_15
Lte_17:
s_barrier
s_add_u32 m0, s18, 0x8000
s_add_u32 s44, s50, 0x3408000
buffer_load_dwordx4 v1, s[4:7], s44 offen offset:0 sc1 lds
buffer_load_dwordx4 v1, s[4:7], s44 offen offset:1024 sc1 lds
s_add_u32 m0, s18, 0xa000
s_add_u32 s44, s50, 0x340a000
buffer_load_dwordx4 v1, s[4:7], s44 offen offset:0 sc1 lds
buffer_load_dwordx4 v1, s[4:7], s44 offen offset:1024 sc1 lds
s_waitcnt vmcnt(4)
s_barrier
s_cmp_lg_u32 s28, 0
s_cbranch_scc1 Lsg_18
buffer_atomic_add v12, v10, s[4:7], s92 offen sc1
Lsg_18:
s_mov_b64 exec, 0
s_cmp_eq_u32 s28, 0
s_cbranch_scc1 L_stub4
L_wret2:
s_mov_b64 exec, -1
L_stub4:
s_cbranch_execz L_stub5
s_cmp_lt_u32 s28, 2
s_cbranch_scc1 Lwd_19
s_add_u32 m0, s19, 0xa000
s_add_u32 s44, s50, 0x340a000
s_add_u32 s44, s44, s18
buffer_load_dwordx4 v1, s[4:7], s44 offen offset:0 sc1 lds
buffer_load_dwordx4 v1, s[4:7], s44 offen offset:1024 sc1 lds
buffer_load_dwordx4 v1, s[4:7], s44 offen offset:2048 sc1 lds
buffer_load_dwordx4 v1, s[4:7], s44 offen offset:3072 sc1 lds
s_add_u32 m0, s19, 0xc000
s_add_u32 s44, s50, 0x340c000
s_add_u32 s44, s44, s18
buffer_load_dwordx4 v1, s[4:7], s44 offen offset:0 sc1 lds
buffer_load_dwordx4 v1, s[4:7], s44 offen offset:1024 sc1 lds
buffer_load_dwordx4 v1, s[4:7], s44 offen offset:2048 sc1 lds
buffer_load_dwordx4 v1, s[4:7], s44 offen offset:3072 sc1 lds
s_add_u32 m0, s19, 0xe000
s_add_u32 s44, s50, 0x340e000
s_add_u32 s44, s44, s18
buffer_load_dwordx4 v1, s[4:7], s44 offen offset:0 sc1 lds
buffer_load_dwordx4 v1, s[4:7], s44 offen offset:1024 sc1 lds
buffer_load_dwordx4 v1, s[4:7], s44 offen offset:2048 sc1 lds
buffer_load_dwordx4 v1, s[4:7], s44 offen offset:3072 sc1 lds
s_add_u32 m0, s19, 0x10000
s_add_u32 s44, s50, 0x3410000
s_add_u32 s44, s44, s18
buffer_load_dwordx4 v1, s[4:7], s44 offen offset:0 sc1 lds
buffer_load_dwordx4 v1, s[4:7], s44 offen offset:1024 sc1 lds
buffer_load_dwordx4 v1, s[4:7], s44 offen offset:2048 sc1 lds
buffer_load_dwordx4 v1, s[4:7], s44 offen offset:3072 sc1 lds
s_add_u32 m0, s19, 0x12000
s_add_u32 s44, s50, 0x3412000
s_add_u32 s44, s44, s18
buffer_load_dwordx4 v1, s[4:7], s44 offen offset:0 sc1 lds
buffer_load_dwordx4 v1, s[4:7], s44 offen offset:1024 sc1 lds
buffer_load_dwordx4 v1, s[4:7], s44 offen offset:2048 sc1 lds
buffer_load_dwordx4 v1, s[4:7], s44 offen offset:3072 sc1 lds
s_add_u32 m0, s19, 0x14000
s_add_u32 s44, s50, 0x3414000
s_add_u32 s44, s44, s18
buffer_load_dwordx4 v1, s[4:7], s44 offen offset:0 sc1 lds
buffer_load_dwordx4 v1, s[4:7], s44 offen offset:1024 sc1 lds
buffer_load_dwordx4 v1, s[4:7], s44 offen offset:2048 sc1 lds
buffer_load_dwordx4 v1, s[4:7], s44 offen offset:3072 sc1 lds
s_add_u32 m0, s19, 0x16000
s_add_u32 s44, s50, 0x3416000
s_add_u32 s44, s44, s18
buffer_load_dwordx4 v1, s[4:7], s44 offen offset:0 sc1 lds
buffer_load_dwordx4 v1, s[4:7], s44 offen offset:1024 sc1 lds
buffer_load_dwordx4 v1, s[4:7], s44 offen offset:2048 sc1 lds
buffer_load_dwordx4 v1, s[4:7], s44 offen offset:3072 sc1 lds
s_add_u32 m0, s19, 0x18000
s_add_u32 s44, s50, 0x3418000
s_add_u32 s44, s44, s18
buffer_load_dwordx4 v1, s[4:7], s44 offen offset:0 sc1 lds
buffer_load_dwordx4 v1, s[4:7], s44 offen offset:1024 sc1 lds
buffer_load_dwordx4 v1, s[4:7], s44 offen offset:2048 sc1 lds
buffer_load_dwordx4 v1, s[4:7], s44 offen offset:3072 sc1 lds
Lwd_19:
s_cmp_lg_u32 s28, 1
s_cbranch_scc1 Lpo_22
s_add_u32 s36, s34, 0x40000
s_mov_b32 s37, 0
v_mov_b32 v11, 0
buffer_atomic_add v11, v251, s[4:7], s36 offen sc0 sc1
s_sleep 4
Lpoll_20:
v_mov_b32 v234, 0
buffer_atomic_add v234, v251, s[4:7], s36 offen sc0 sc1
s_waitcnt vmcnt(1)
v_readfirstlane_b32 s38, v11
s_nop 0
s_cmp_ge_u32 s38, 32
s_cbranch_scc1 Lpe_21
v_mov_b32 v11, 0
buffer_atomic_add v11, v251, s[4:7], s36 offen sc0 sc1
s_waitcnt vmcnt(1)
v_readfirstlane_b32 s38, v234
s_nop 0
s_cmp_ge_u32 s38, 32
s_cbranch_scc1 Lpe_21
s_add_u32 s37, s37, 1
s_cmp_lt_u32 s37, 0x80000
s_cbranch_scc1 Lpoll_20
s_waitcnt vmcnt(0)
Lpo_22:
s_waitcnt vmcnt(32) lgkmcnt(0)
s_cmp_ge_u32 s28, 2
s_cbranch_scc1 Lw_23
s_waitcnt vmcnt(0)
Lw_23:
Lpe_21:
s_barrier
s_mov_b32 s35, 0
s_add_u32 s33, s35, 0x1000
buffer_load_dwordx4 a[0:3], v2, s[40:43], s35 offen offset:0 sc1
buffer_load_dwordx4 a[4:7], v2, s[40:43], s33 offen offset:0 sc1
buffer_load_dwordx4 a[8:11], v2, s[40:43], s35 offen offset:1024 sc1
buffer_load_dwordx4 a[12:15], v2, s[40:43], s33 offen offset:1024 sc1
buffer_load_dwordx4 a[16:19], v2, s[40:43], s35 offen offset:2048 sc1
buffer_load_dwordx4 a[20:23], v2, s[40:43], s33 offen offset:2048 sc1
buffer_load_dwordx4 a[24:27], v2, s[40:43], s35 offen offset:3072 sc1
buffer_load_dwordx4 a[28:31], v2, s[40:43], s33 offen offset:3072 sc1
s_add_u32 s35, s35, 0x4000
s_add_u32 s33, s33, 0x4000
buffer_load_dwordx4 a[32:35], v2, s[40:43], s35 offen offset:0 sc1
buffer_load_dwordx4 a[36:39], v2, s[40:43], s33 offen offset:0 sc1
buffer_load_dwordx4 a[40:43], v2, s[40:43], s35 offen offset:1024 sc1
buffer_load_dwordx4 a[44:47], v2, s[40:43], s33 offen offset:1024 sc1
buffer_load_dwordx4 a[48:51], v2, s[40:43], s35 offen offset:2048 sc1
buffer_load_dwordx4 a[52:55], v2, s[40:43], s33 offen offset:2048 sc1
buffer_load_dwordx4 a[56:59], v2, s[40:43], s35 offen offset:3072 sc1
buffer_load_dwordx4 a[60:63], v2, s[40:43], s33 offen offset:3072 sc1
s_add_u32 s35, s35, 0x4000
s_add_u32 s33, s33, 0x4000
v_add_u32 v5, 0, v1
ds_read_b128 a[96:99], v5 offset:2048
ds_read_b128 a[100:103], v5 offset:8192
ds_read_b128 a[104:107], v5 offset:3072
ds_read_b128 a[108:111], v5 offset:9216
ds_read_b128 a[112:115], v5 offset:4096
ds_read_b128 a[116:119], v5 offset:10240
s_waitcnt vmcnt(14) lgkmcnt(4)
v_mfma_f32_16x16x32_bf16 v[140:143], a[96:99], a[0:3], 0
v_and_b32 v232, 15, v0
v_lshlrev_b32 v232, 7, v232
v_mfma_f32_16x16x32_bf16 v[140:143], a[100:103], a[4:7], v[140:143]
buffer_load_dwordx4 a[64:67], v2, s[40:43], s35 offen offset:0 sc1
s_waitcnt vmcnt(13)
v_mfma_f32_16x16x32_bf16 v[164:167], a[100:103], a[12:15], 0
v_lshrrev_b32 v233, 4, v0
v_lshlrev_b32 v233, 4, v233
v_mfma_f32_16x16x32_bf16 v[164:167], a[96:99], a[8:11], v[164:167]
v_add_u32 v232, v233, v232
s_mul_i32 s38, s30, 12288
s_waitcnt vmcnt(12)
v_mfma_f32_16x16x32_bf16 v[188:191], a[96:99], a[16:19], 0
s_add_u32 s38, s38, 0x380000
s_add_u32 s39, s28, 4
s_min_u32 s39, s39, 5
s_waitcnt vmcnt(11)
v_mfma_f32_16x16x32_bf16 v[188:191], a[100:103], a[20:23], v[188:191]
buffer_load_dwordx4 a[68:71], v2, s[40:43], s33 offen offset:0 sc1
s_lshl_b32 s36, s28, 11
s_waitcnt vmcnt(10)
v_mfma_f32_16x16x32_bf16 v[212:215], a[100:103], a[28:31], 0
s_add_u32 s36, s36, s38
s_lshl_b32 s37, s39, 11
s_add_u32 s37, s37, s38
v_mfma_f32_16x16x32_bf16 v[212:215], a[96:99], a[24:27], v[212:215]
ds_read_b128 a[128:131], v5 offset:5120
s_waitcnt lgkmcnt(4)
v_mfma_f32_16x16x32_bf16 v[216:219], a[104:107], a[24:27], 0
ds_read_b128 a[132:135], v5 offset:11264
s_waitcnt lgkmcnt(4)
v_mfma_f32_16x16x32_bf16 v[216:219], a[108:111], a[28:31], v[216:219]
ds_read_b128 a[136:139], v5 offset:0
v_mfma_f32_16x16x32_bf16 v[192:195], a[108:111], a[20:23], 0
buffer_load_dwordx4 v[48:51], v232, s[4:7], s36 offen sc1
v_mfma_f32_16x16x32_bf16 v[192:195], a[104:107], a[16:19], v[192:195]
ds_read_b128 a[140:143], v5 offset:6144
v_mfma_f32_16x16x32_bf16 v[168:171], a[104:107], a[8:11], 0
ds_read_b128 a[144:147], v5 offset:1024
v_mfma_f32_16x16x32_bf16 v[168:171], a[108:111], a[12:15], v[168:171]
ds_read_b128 a[148:151], v5 offset:7168
v_mfma_f32_16x16x32_bf16 v[144:147], a[108:111], a[4:7], 0
v_mfma_f32_16x16x32_bf16 v[144:147], a[104:107], a[0:3], v[144:147]
buffer_load_dwordx4 a[72:75], v2, s[40:43], s35 offen offset:1024 sc1
s_waitcnt lgkmcnt(7)
v_mfma_f32_16x16x32_bf16 v[148:151], a[112:115], a[0:3], 0
s_waitcnt lgkmcnt(6)
v_mfma_f32_16x16x32_bf16 v[148:151], a[116:119], a[4:7], v[148:151]
v_mfma_f32_16x16x32_bf16 v[172:175], a[116:119], a[12:15], 0
v_mfma_f32_16x16x32_bf16 v[172:175], a[112:115], a[8:11], v[172:175]
v_mfma_f32_16x16x32_bf16 v[196:199], a[112:115], a[16:19], 0
buffer_load_dwordx4 a[76:79], v2, s[40:43], s33 offen offset:1024 sc1
v_mfma_f32_16x16x32_bf16 v[196:199], a[116:119], a[20:23], v[196:199]
v_mfma_f32_16x16x32_bf16 v[220:223], a[116:119], a[28:31], 0
v_mfma_f32_16x16x32_bf16 v[220:223], a[112:115], a[24:27], v[220:223]
s_waitcnt lgkmcnt(0)
v_mfma_f32_16x16x32_bf16 v[224:227], a[128:131], a[24:27], 0
ds_read_b128 a[96:99], v5 offset:14336
v_mfma_f32_16x16x32_bf16 v[224:227], a[132:135], a[28:31], v[224:227]
buffer_load_dwordx4 a[80:83], v2, s[40:43], s35 offen offset:2048 sc1
v_mfma_f32_16x16x32_bf16 v[200:203], a[132:135], a[20:23], 0
ds_read_b128 a[100:103], v5 offset:20480
v_mfma_f32_16x16x32_bf16 v[200:203], a[128:131], a[16:19], v[200:203]
v_mfma_f32_16x16x32_bf16 v[176:179], a[128:131], a[8:11], 0
v_mfma_f32_16x16x32_bf16 v[176:179], a[132:135], a[12:15], v[176:179]
buffer_load_dwordx4 a[84:87], v2, s[40:43], s33 offen offset:2048 sc1
v_mfma_f32_16x16x32_bf16 v[152:155], a[132:135], a[4:7], 0
ds_read_b128 a[104:107], v5 offset:15360
v_mfma_f32_16x16x32_bf16 v[152:155], a[128:131], a[0:3], v[152:155]
v_mfma_f32_16x16x32_bf16 v[132:135], a[136:139], a[0:3], 0
ds_read_b128 a[108:111], v5 offset:21504
v_mfma_f32_16x16x32_bf16 v[132:135], a[140:143], a[4:7], v[132:135]
v_mfma_f32_16x16x32_bf16 v[156:159], a[140:143], a[12:15], 0
buffer_load_dwordx4 v[52:55], v232, s[4:7], s37 offen sc1
s_add_u32 m0, s18, 0x1c000
v_mfma_f32_16x16x32_bf16 v[156:159], a[136:139], a[8:11], v[156:159]
s_add_u32 s44, s50, 0x341c000
ds_read_b128 a[112:115], v5 offset:16384
v_mfma_f32_16x16x32_bf16 v[180:183], a[136:139], a[16:19], 0
v_mfma_f32_16x16x32_bf16 v[180:183], a[140:143], a[20:23], v[180:183]
ds_read_b128 a[116:119], v5 offset:22528
v_mfma_f32_16x16x32_bf16 v[204:207], a[140:143], a[28:31], 0
v_mfma_f32_16x16x32_bf16 v[204:207], a[136:139], a[24:27], v[204:207]
buffer_load_dwordx4 a[88:91], v2, s[40:43], s35 offen offset:3072 sc1
v_mfma_f32_16x16x32_bf16 v[208:211], a[144:147], a[24:27], 0
v_mfma_f32_16x16x32_bf16 v[208:211], a[148:151], a[28:31], v[208:211]
v_mfma_f32_16x16x32_bf16 v[184:187], a[148:151], a[20:23], 0
v_mfma_f32_16x16x32_bf16 v[184:187], a[144:147], a[16:19], v[184:187]
v_mfma_f32_16x16x32_bf16 v[160:163], a[144:147], a[8:11], 0
buffer_load_dwordx4 a[92:95], v2, s[40:43], s33 offen offset:3072 sc1
s_add_u32 s35, s35, 0x4000
v_mfma_f32_16x16x32_bf16 v[160:163], a[148:151], a[12:15], v[160:163]
s_add_u32 s33, s33, 0x4000
v_mfma_f32_16x16x32_bf16 v[136:139], a[148:151], a[4:7], 0
v_mfma_f32_16x16x32_bf16 v[136:139], a[144:147], a[0:3], v[136:139]
s_waitcnt vmcnt(10) lgkmcnt(0)
v_mfma_f32_16x16x32_bf16 v[140:143], a[96:99], a[32:35], v[140:143]
ds_read_b128 a[128:131], v5 offset:17408
v_mfma_f32_16x16x32_bf16 v[140:143], a[100:103], a[36:39], v[140:143]
buffer_load_dwordx4 a[0:3], v2, s[40:43], s35 offen offset:0 sc1
v_mfma_f32_16x16x32_bf16 v[164:167], a[100:103], a[44:47], v[164:167]
ds_read_b128 a[132:135], v5 offset:23552
v_mfma_f32_16x16x32_bf16 v[164:167], a[96:99], a[40:43], v[164:167]
v_mfma_f32_16x16x32_bf16 v[188:191], a[96:99], a[48:51], v[188:191]
v_mfma_f32_16x16x32_bf16 v[188:191], a[100:103], a[52:55], v[188:191]
buffer_load_dwordx4 v1, s[4:7], s44 offen offset:0 sc1 lds
v_mfma_f32_16x16x32_bf16 v[212:215], a[100:103], a[60:63], v[212:215]
ds_read_b128 a[136:139], v5 offset:12288
v_mfma_f32_16x16x32_bf16 v[212:215], a[96:99], a[56:59], v[212:215]
v_mfma_f32_16x16x32_bf16 v[216:219], a[104:107], a[56:59], v[216:219]
ds_read_b128 a[140:143], v5 offset:18432
v_mfma_f32_16x16x32_bf16 v[216:219], a[108:111], a[60:63], v[216:219]
buffer_load_dwordx4 a[4:7], v2, s[40:43], s33 offen offset:0 sc1
v_mfma_f32_16x16x32_bf16 v[192:195], a[108:111], a[52:55], v[192:195]
ds_read_b128 a[144:147], v5 offset:13312
v_mfma_f32_16x16x32_bf16 v[192:195], a[104:107], a[48:51], v[192:195]
v_mfma_f32_16x16x32_bf16 v[168:171], a[104:107], a[40:43], v[168:171]
v_mfma_f32_16x16x32_bf16 v[168:171], a[108:111], a[44:47], v[168:171]
buffer_load_dwordx4 a[8:11], v2, s[40:43], s35 offen offset:1024 sc1
v_mfma_f32_16x16x32_bf16 v[144:147], a[108:111], a[36:39], v[144:147]
ds_read_b128 a[148:151], v5 offset:19456
v_mfma_f32_16x16x32_bf16 v[144:147], a[104:107], a[32:35], v[144:147]
v_mfma_f32_16x16x32_bf16 v[148:151], a[112:115], a[32:35], v[148:151]
v_mfma_f32_16x16x32_bf16 v[148:151], a[116:119], a[36:39], v[148:151]
buffer_load_dwordx4 v1, s[4:7], s44 offen offset:1024 sc1 lds
s_add_u32 m0, s18, 0x1e000
v_mfma_f32_16x16x32_bf16 v[172:175], a[116:119], a[44:47], v[172:175]
s_add_u32 s44, s50, 0x341e000
v_mfma_f32_16x16x32_bf16 v[172:175], a[112:115], a[40:43], v[172:175]
v_mfma_f32_16x16x32_bf16 v[196:199], a[112:115], a[48:51], v[196:199]
v_mfma_f32_16x16x32_bf16 v[196:199], a[116:119], a[52:55], v[196:199]
buffer_load_dwordx4 a[12:15], v2, s[40:43], s33 offen offset:1024 sc1
v_mfma_f32_16x16x32_bf16 v[220:223], a[116:119], a[60:63], v[220:223]
v_mfma_f32_16x16x32_bf16 v[220:223], a[112:115], a[56:59], v[220:223]
s_waitcnt lgkmcnt(0)
v_mfma_f32_16x16x32_bf16 v[224:227], a[128:131], a[56:59], v[224:227]
ds_read_b128 a[96:99], v5 offset:26624
v_mfma_f32_16x16x32_bf16 v[224:227], a[132:135], a[60:63], v[224:227]
buffer_load_dwordx4 a[16:19], v2, s[40:43], s35 offen offset:2048 sc1
v_mfma_f32_16x16x32_bf16 v[200:203], a[132:135], a[52:55], v[200:203]
ds_read_b128 a[100:103], v5 offset:32768
v_mfma_f32_16x16x32_bf16 v[200:203], a[128:131], a[48:51], v[200:203]
v_mfma_f32_16x16x32_bf16 v[176:179], a[128:131], a[40:43], v[176:179]
v_mfma_f32_16x16x32_bf16 v[176:179], a[132:135], a[44:47], v[176:179]
buffer_load_dwordx4 a[20:23], v2, s[40:43], s33 offen offset:2048 sc1
v_mfma_f32_16x16x32_bf16 v[152:155], a[132:135], a[36:39], v[152:155]
ds_read_b128 a[104:107], v5 offset:27648
v_mfma_f32_16x16x32_bf16 v[152:155], a[128:131], a[32:35], v[152:155]
v_mfma_f32_16x16x32_bf16 v[132:135], a[136:139], a[32:35], v[132:135]
ds_read_b128 a[108:111], v5 offset:33792
v_mfma_f32_16x16x32_bf16 v[132:135], a[140:143], a[36:39], v[132:135]
v_mfma_f32_16x16x32_bf16 v[156:159], a[140:143], a[44:47], v[156:159]
buffer_load_dwordx4 v1, s[4:7], s44 offen offset:0 sc1 lds
v_mfma_f32_16x16x32_bf16 v[156:159], a[136:139], a[40:43], v[156:159]
ds_read_b128 a[112:115], v5 offset:28672
v_mfma_f32_16x16x32_bf16 v[180:183], a[136:139], a[48:51], v[180:183]
v_mfma_f32_16x16x32_bf16 v[180:183], a[140:143], a[52:55], v[180:183]
ds_read_b128 a[116:119], v5 offset:34816
v_mfma_f32_16x16x32_bf16 v[204:207], a[140:143], a[60:63], v[204:207]
v_mfma_f32_16x16x32_bf16 v[204:207], a[136:139], a[56:59], v[204:207]
buffer_load_dwordx4 a[24:27], v2, s[40:43], s35 offen offset:3072 sc1
v_mfma_f32_16x16x32_bf16 v[208:211], a[144:147], a[56:59], v[208:211]
v_mfma_f32_16x16x32_bf16 v[208:211], a[148:151], a[60:63], v[208:211]
v_mfma_f32_16x16x32_bf16 v[184:187], a[148:151], a[52:55], v[184:187]
v_mfma_f32_16x16x32_bf16 v[184:187], a[144:147], a[48:51], v[184:187]
v_mfma_f32_16x16x32_bf16 v[160:163], a[144:147], a[40:43], v[160:163]
buffer_load_dwordx4 a[28:31], v2, s[40:43], s33 offen offset:3072 sc1
s_add_u32 s35, s35, 0x4000
v_mfma_f32_16x16x32_bf16 v[160:163], a[148:151], a[44:47], v[160:163]
s_add_u32 s33, s33, 0x4000
v_mfma_f32_16x16x32_bf16 v[136:139], a[148:151], a[36:39], v[136:139]
v_mfma_f32_16x16x32_bf16 v[136:139], a[144:147], a[32:35], v[136:139]
s_waitcnt vmcnt(11) lgkmcnt(0)
v_mfma_f32_16x16x32_bf16 v[140:143], a[96:99], a[64:67], v[140:143]
ds_read_b128 a[128:131], v5 offset:29696
v_mfma_f32_16x16x32_bf16 v[140:143], a[100:103], a[68:71], v[140:143]
buffer_load_dwordx4 a[32:35], v2, s[40:43], s35 offen offset:0 sc1
v_mfma_f32_16x16x32_bf16 v[164:167], a[100:103], a[76:79], v[164:167]
ds_read_b128 a[132:135], v5 offset:35840
v_mfma_f32_16x16x32_bf16 v[164:167], a[96:99], a[72:75], v[164:167]
v_mfma_f32_16x16x32_bf16 v[188:191], a[96:99], a[80:83], v[188:191]
v_mfma_f32_16x16x32_bf16 v[188:191], a[100:103], a[84:87], v[188:191]
buffer_load_dwordx4 a[36:39], v2, s[40:43], s33 offen offset:0 sc1
v_mfma_f32_16x16x32_bf16 v[212:215], a[100:103], a[92:95], v[212:215]
ds_read_b128 a[136:139], v5 offset:24576
v_mfma_f32_16x16x32_bf16 v[212:215], a[96:99], a[88:91], v[212:215]
v_mfma_f32_16x16x32_bf16 v[216:219], a[104:107], a[88:91], v[216:219]
ds_read_b128 a[140:143], v5 offset:30720
v_mfma_f32_16x16x32_bf16 v[216:219], a[108:111], a[92:95], v[216:219]
v_mfma_f32_16x16x32_bf16 v[192:195], a[108:111], a[84:87], v[192:195]
buffer_load_dwordx4 v1, s[4:7], s44 offen offset:1024 sc1 lds
s_add_u32 m0, s18, 0x20000
v_mfma_f32_16x16x32_bf16 v[192:195], a[104:107], a[80:83], v[192:195]
s_add_u32 s44, s50, 0x3420000
ds_read_b128 a[144:147], v5 offset:25600
v_mfma_f32_16x16x32_bf16 v[168:171], a[104:107], a[72:75], v[168:171]
v_mfma_f32_16x16x32_bf16 v[168:171], a[108:111], a[76:79], v[168:171]
ds_read_b128 a[148:151], v5 offset:31744
v_mfma_f32_16x16x32_bf16 v[144:147], a[108:111], a[68:71], v[144:147]
v_mfma_f32_16x16x32_bf16 v[144:147], a[104:107], a[64:67], v[144:147]
buffer_load_dwordx4 a[40:43], v2, s[40:43], s35 offen offset:1024 sc1
v_mfma_f32_16x16x32_bf16 v[148:151], a[112:115], a[64:67], v[148:151]
v_mfma_f32_16x16x32_bf16 v[148:151], a[116:119], a[68:71], v[148:151]
v_mfma_f32_16x16x32_bf16 v[172:175], a[116:119], a[76:79], v[172:175]
v_mfma_f32_16x16x32_bf16 v[172:175], a[112:115], a[72:75], v[172:175]
v_mfma_f32_16x16x32_bf16 v[196:199], a[112:115], a[80:83], v[196:199]
buffer_load_dwordx4 a[44:47], v2, s[40:43], s33 offen offset:1024 sc1
v_mfma_f32_16x16x32_bf16 v[196:199], a[116:119], a[84:87], v[196:199]
v_mfma_f32_16x16x32_bf16 v[220:223], a[116:119], a[92:95], v[220:223]
v_mfma_f32_16x16x32_bf16 v[220:223], a[112:115], a[88:91], v[220:223]
s_waitcnt lgkmcnt(0)
v_mfma_f32_16x16x32_bf16 v[224:227], a[128:131], a[88:91], v[224:227]
ds_read_b128 a[96:99], v5 offset:38912
v_mfma_f32_16x16x32_bf16 v[224:227], a[132:135], a[92:95], v[224:227]
buffer_load_dwordx4 a[48:51], v2, s[40:43], s35 offen offset:2048 sc1
v_mfma_f32_16x16x32_bf16 v[200:203], a[132:135], a[84:87], v[200:203]
ds_read_b128 a[100:103], v5 offset:45056
v_mfma_f32_16x16x32_bf16 v[200:203], a[128:131], a[80:83], v[200:203]
v_mfma_f32_16x16x32_bf16 v[176:179], a[128:131], a[72:75], v[176:179]
v_mfma_f32_16x16x32_bf16 v[176:179], a[132:135], a[76:79], v[176:179]
buffer_load_dwordx4 a[52:55], v2, s[40:43], s33 offen offset:2048 sc1
v_mfma_f32_16x16x32_bf16 v[152:155], a[132:135], a[68:71], v[152:155]
ds_read_b128 a[104:107], v5 offset:39936
v_mfma_f32_16x16x32_bf16 v[152:155], a[128:131], a[64:67], v[152:155]
v_mfma_f32_16x16x32_bf16 v[132:135], a[136:139], a[64:67], v[132:135]
ds_read_b128 a[108:111], v5 offset:46080
v_mfma_f32_16x16x32_bf16 v[132:135], a[140:143], a[68:71], v[132:135]
v_mfma_f32_16x16x32_bf16 v[156:159], a[140:143], a[76:79], v[156:159]
buffer_load_dwordx4 v1, s[4:7], s44 offen offset:0 sc1 lds
v_mfma_f32_16x16x32_bf16 v[156:159], a[136:139], a[72:75], v[156:159]
ds_read_b128 a[112:115], v5 offset:40960
v_mfma_f32_16x16x32_bf16 v[180:183], a[136:139], a[80:83], v[180:183]
v_mfma_f32_16x16x32_bf16 v[180:183], a[140:143], a[84:87], v[180:183]
ds_read_b128 a[116:119], v5 offset:47104
v_mfma_f32_16x16x32_bf16 v[204:207], a[140:143], a[92:95], v[204:207]
v_mfma_f32_16x16x32_bf16 v[204:207], a[136:139], a[88:91], v[204:207]
buffer_load_dwordx4 a[56:59], v2, s[40:43], s35 offen offset:3072 sc1
v_mfma_f32_16x16x32_bf16 v[208:211], a[144:147], a[88:91], v[208:211]
v_mfma_f32_16x16x32_bf16 v[208:211], a[148:151], a[92:95], v[208:211]
v_mfma_f32_16x16x32_bf16 v[184:187], a[148:151], a[84:87], v[184:187]
v_mfma_f32_16x16x32_bf16 v[184:187], a[144:147], a[80:83], v[184:187]
v_mfma_f32_16x16x32_bf16 v[160:163], a[144:147], a[72:75], v[160:163]
buffer_load_dwordx4 a[60:63], v2, s[40:43], s33 offen offset:3072 sc1
s_add_u32 s35, s35, 0x4000
v_mfma_f32_16x16x32_bf16 v[160:163], a[148:151], a[76:79], v[160:163]
s_add_u32 s33, s33, 0x4000
v_mfma_f32_16x16x32_bf16 v[136:139], a[148:151], a[68:71], v[136:139]
v_mfma_f32_16x16x32_bf16 v[136:139], a[144:147], a[64:67], v[136:139]
s_waitcnt vmcnt(10) lgkmcnt(0)
v_mfma_f32_16x16x32_bf16 v[140:143], a[96:99], a[0:3], v[140:143]
ds_read_b128 a[128:131], v5 offset:41984
v_mfma_f32_16x16x32_bf16 v[140:143], a[100:103], a[4:7], v[140:143]
buffer_load_dwordx4 a[64:67], v2, s[40:43], s35 offen offset:0 sc1
v_mfma_f32_16x16x32_bf16 v[164:167], a[100:103], a[12:15], v[164:167]
ds_read_b128 a[132:135], v5 offset:48128
v_mfma_f32_16x16x32_bf16 v[164:167], a[96:99], a[8:11], v[164:167]
v_mfma_f32_16x16x32_bf16 v[188:191], a[96:99], a[16:19], v[188:191]
v_mfma_f32_16x16x32_bf16 v[188:191], a[100:103], a[20:23], v[188:191]
buffer_load_dwordx4 v1, s[4:7], s44 offen offset:1024 sc1 lds
s_add_u32 m0, s18, 0x22000
v_mfma_f32_16x16x32_bf16 v[212:215], a[100:103], a[28:31], v[212:215]
s_add_u32 s44, s50, 0x3422000
ds_read_b128 a[136:139], v5 offset:36864
v_mfma_f32_16x16x32_bf16 v[212:215], a[96:99], a[24:27], v[212:215]
v_mfma_f32_16x16x32_bf16 v[216:219], a[104:107], a[24:27], v[216:219]
ds_read_b128 a[140:143], v5 offset:43008
v_mfma_f32_16x16x32_bf16 v[216:219], a[108:111], a[28:31], v[216:219]
buffer_load_dwordx4 a[68:71], v2, s[40:43], s33 offen offset:0 sc1
v_mfma_f32_16x16x32_bf16 v[192:195], a[108:111], a[20:23], v[192:195]
ds_read_b128 a[144:147], v5 offset:37888
v_mfma_f32_16x16x32_bf16 v[192:195], a[104:107], a[16:19], v[192:195]
v_mfma_f32_16x16x32_bf16 v[168:171], a[104:107], a[8:11], v[168:171]
v_mfma_f32_16x16x32_bf16 v[168:171], a[108:111], a[12:15], v[168:171]
buffer_load_dwordx4 a[72:75], v2, s[40:43], s35 offen offset:1024 sc1
v_mfma_f32_16x16x32_bf16 v[144:147], a[108:111], a[4:7], v[144:147]
ds_read_b128 a[148:151], v5 offset:44032
v_mfma_f32_16x16x32_bf16 v[144:147], a[104:107], a[0:3], v[144:147]
v_mfma_f32_16x16x32_bf16 v[148:151], a[112:115], a[0:3], v[148:151]
v_mfma_f32_16x16x32_bf16 v[148:151], a[116:119], a[4:7], v[148:151]
buffer_load_dwordx4 v1, s[4:7], s44 offen offset:0 sc1 lds
v_mfma_f32_16x16x32_bf16 v[172:175], a[116:119], a[12:15], v[172:175]
v_mfma_f32_16x16x32_bf16 v[172:175], a[112:115], a[8:11], v[172:175]
v_mfma_f32_16x16x32_bf16 v[196:199], a[112:115], a[16:19], v[196:199]
v_mfma_f32_16x16x32_bf16 v[196:199], a[116:119], a[20:23], v[196:199]
buffer_load_dwordx4 a[76:79], v2, s[40:43], s33 offen offset:1024 sc1
v_mfma_f32_16x16x32_bf16 v[220:223], a[116:119], a[28:31], v[220:223]
v_mfma_f32_16x16x32_bf16 v[220:223], a[112:115], a[24:27], v[220:223]
s_waitcnt lgkmcnt(0)
s_barrier
v_mfma_f32_16x16x32_bf16 v[224:227], a[128:131], a[24:27], v[224:227]
v_add_u32 v5, 49152, v1
v_mfma_f32_16x16x32_bf16 v[224:227], a[132:135], a[28:31], v[224:227]
buffer_load_dwordx4 a[80:83], v2, s[40:43], s35 offen offset:2048 sc1
v_mfma_f32_16x16x32_bf16 v[200:203], a[132:135], a[20:23], v[200:203]
ds_read_b128 a[96:99], v5 offset:2048
v_mfma_f32_16x16x32_bf16 v[200:203], a[128:131], a[16:19], v[200:203]
ds_read_b128 a[100:103], v5 offset:8192
v_mfma_f32_16x16x32_bf16 v[176:179], a[128:131], a[8:11], v[176:179]
v_mfma_f32_16x16x32_bf16 v[176:179], a[132:135], a[12:15], v[176:179]
buffer_load_dwordx4 a[84:87], v2, s[40:43], s33 offen offset:2048 sc1
v_mfma_f32_16x16x32_bf16 v[152:155], a[132:135], a[4:7], v[152:155]
ds_read_b128 a[104:107], v5 offset:3072
v_mfma_f32_16x16x32_bf16 v[152:155], a[128:131], a[0:3], v[152:155]
v_mfma_f32_16x16x32_bf16 v[132:135], a[136:139], a[0:3], v[132:135]
ds_read_b128 a[108:111], v5 offset:9216
v_mfma_f32_16x16x32_bf16 v[132:135], a[140:143], a[4:7], v[132:135]
v_mfma_f32_16x16x32_bf16 v[156:159], a[140:143], a[12:15], v[156:159]
buffer_load_dwordx4 v1, s[4:7], s44 offen offset:1024 sc1 lds
s_add_u32 s88, s82, 0x240000
v_mfma_f32_16x16x32_bf16 v[156:159], a[136:139], a[8:11], v[156:159]
ds_read_b128 a[112:115], v5 offset:4096
v_mfma_f32_16x16x32_bf16 v[180:183], a[136:139], a[16:19], v[180:183]
v_mfma_f32_16x16x32_bf16 v[180:183], a[140:143], a[20:23], v[180:183]
ds_read_b128 a[116:119], v5 offset:10240
v_mfma_f32_16x16x32_bf16 v[204:207], a[140:143], a[28:31], v[204:207]
v_mfma_f32_16x16x32_bf16 v[204:207], a[136:139], a[24:27], v[204:207]
buffer_load_dwordx4 a[88:91], v2, s[40:43], s35 offen offset:3072 sc1
v_mfma_f32_16x16x32_bf16 v[208:211], a[144:147], a[24:27], v[208:211]
v_mfma_f32_16x16x32_bf16 v[208:211], a[148:151], a[28:31], v[208:211]
v_mfma_f32_16x16x32_bf16 v[184:187], a[148:151], a[20:23], v[184:187]
v_mfma_f32_16x16x32_bf16 v[184:187], a[144:147], a[16:19], v[184:187]
v_mfma_f32_16x16x32_bf16 v[160:163], a[144:147], a[8:11], v[160:163]
buffer_load_dwordx4 a[92:95], v2, s[40:43], s33 offen offset:3072 sc1
s_add_u32 s35, s35, 0x4000
v_mfma_f32_16x16x32_bf16 v[160:163], a[148:151], a[12:15], v[160:163]
s_add_u32 s33, s33, 0x4000
v_mfma_f32_16x16x32_bf16 v[136:139], a[148:151], a[4:7], v[136:139]
v_mfma_f32_16x16x32_bf16 v[136:139], a[144:147], a[0:3], v[136:139]
s_waitcnt vmcnt(11) lgkmcnt(0)
v_mfma_f32_16x16x32_bf16 v[140:143], a[96:99], a[32:35], v[140:143]
ds_read_b128 a[128:131], v5 offset:5120
v_mfma_f32_16x16x32_bf16 v[140:143], a[100:103], a[36:39], v[140:143]
buffer_load_dwordx4 a[0:3], v2, s[40:43], s35 offen offset:0 sc1
v_mfma_f32_16x16x32_bf16 v[164:167], a[100:103], a[44:47], v[164:167]
ds_read_b128 a[132:135], v5 offset:11264
v_mfma_f32_16x16x32_bf16 v[164:167], a[96:99], a[40:43], v[164:167]
v_mfma_f32_16x16x32_bf16 v[188:191], a[96:99], a[48:51], v[188:191]
v_mfma_f32_16x16x32_bf16 v[188:191], a[100:103], a[52:55], v[188:191]
buffer_load_dwordx4 a[4:7], v2, s[40:43], s33 offen offset:0 sc1
v_mfma_f32_16x16x32_bf16 v[212:215], a[100:103], a[60:63], v[212:215]
ds_read_b128 a[136:139], v5 offset:0
v_mfma_f32_16x16x32_bf16 v[212:215], a[96:99], a[56:59], v[212:215]
v_mfma_f32_16x16x32_bf16 v[216:219], a[104:107], a[56:59], v[216:219]
ds_read_b128 a[140:143], v5 offset:6144
v_mfma_f32_16x16x32_bf16 v[216:219], a[108:111], a[60:63], v[216:219]
v_mfma_f32_16x16x32_bf16 v[192:195], a[108:111], a[52:55], v[192:195]
buffer_load_dwordx4 v[92:95], v1, s[4:7], s88 offen offset:0 sc1
v_mfma_f32_16x16x32_bf16 v[192:195], a[104:107], a[48:51], v[192:195]
ds_read_b128 a[144:147], v5 offset:1024
v_mfma_f32_16x16x32_bf16 v[168:171], a[104:107], a[40:43], v[168:171]
v_mfma_f32_16x16x32_bf16 v[168:171], a[108:111], a[44:47], v[168:171]
ds_read_b128 a[148:151], v5 offset:7168
v_mfma_f32_16x16x32_bf16 v[144:147], a[108:111], a[36:39], v[144:147]
v_mfma_f32_16x16x32_bf16 v[144:147], a[104:107], a[32:35], v[144:147]
buffer_load_dwordx4 a[8:11], v2, s[40:43], s35 offen offset:1024 sc1
v_mfma_f32_16x16x32_bf16 v[148:151], a[112:115], a[32:35], v[148:151]
v_mfma_f32_16x16x32_bf16 v[148:151], a[116:119], a[36:39], v[148:151]
v_mfma_f32_16x16x32_bf16 v[172:175], a[116:119], a[44:47], v[172:175]
v_mfma_f32_16x16x32_bf16 v[172:175], a[112:115], a[40:43], v[172:175]
v_mfma_f32_16x16x32_bf16 v[196:199], a[112:115], a[48:51], v[196:199]
buffer_load_dwordx4 a[12:15], v2, s[40:43], s33 offen offset:1024 sc1
v_mfma_f32_16x16x32_bf16 v[196:199], a[116:119], a[52:55], v[196:199]
v_mfma_f32_16x16x32_bf16 v[220:223], a[116:119], a[60:63], v[220:223]
v_mfma_f32_16x16x32_bf16 v[220:223], a[112:115], a[56:59], v[220:223]
s_waitcnt lgkmcnt(0)
v_mfma_f32_16x16x32_bf16 v[224:227], a[128:131], a[56:59], v[224:227]
ds_read_b128 a[96:99], v5 offset:14336
v_mfma_f32_16x16x32_bf16 v[224:227], a[132:135], a[60:63], v[224:227]
buffer_load_dwordx4 a[16:19], v2, s[40:43], s35 offen offset:2048 sc1
v_mfma_f32_16x16x32_bf16 v[200:203], a[132:135], a[52:55], v[200:203]
ds_read_b128 a[100:103], v5 offset:20480
v_mfma_f32_16x16x32_bf16 v[200:203], a[128:131], a[48:51], v[200:203]
v_mfma_f32_16x16x32_bf16 v[176:179], a[128:131], a[40:43], v[176:179]
v_mfma_f32_16x16x32_bf16 v[176:179], a[132:135], a[44:47], v[176:179]
buffer_load_dwordx4 a[20:23], v2, s[40:43], s33 offen offset:2048 sc1
v_mfma_f32_16x16x32_bf16 v[152:155], a[132:135], a[36:39], v[152:155]
ds_read_b128 a[104:107], v5 offset:15360
v_mfma_f32_16x16x32_bf16 v[152:155], a[128:131], a[32:35], v[152:155]
v_mfma_f32_16x16x32_bf16 v[132:135], a[136:139], a[32:35], v[132:135]
ds_read_b128 a[108:111], v5 offset:21504
v_mfma_f32_16x16x32_bf16 v[132:135], a[140:143], a[36:39], v[132:135]
v_mfma_f32_16x16x32_bf16 v[156:159], a[140:143], a[44:47], v[156:159]
buffer_load_dwordx4 v[96:99], v1, s[4:7], s88 offen offset:1024 sc1
v_mfma_f32_16x16x32_bf16 v[156:159], a[136:139], a[40:43], v[156:159]
ds_read_b128 a[112:115], v5 offset:16384
v_mfma_f32_16x16x32_bf16 v[180:183], a[136:139], a[48:51], v[180:183]
v_mfma_f32_16x16x32_bf16 v[180:183], a[140:143], a[52:55], v[180:183]
ds_read_b128 a[116:119], v5 offset:22528
v_mfma_f32_16x16x32_bf16 v[204:207], a[140:143], a[60:63], v[204:207]
v_mfma_f32_16x16x32_bf16 v[204:207], a[136:139], a[56:59], v[204:207]
buffer_load_dwordx4 a[24:27], v2, s[40:43], s35 offen offset:3072 sc1
v_mfma_f32_16x16x32_bf16 v[208:211], a[144:147], a[56:59], v[208:211]
v_mfma_f32_16x16x32_bf16 v[208:211], a[148:151], a[60:63], v[208:211]
v_mfma_f32_16x16x32_bf16 v[184:187], a[148:151], a[52:55], v[184:187]
v_mfma_f32_16x16x32_bf16 v[184:187], a[144:147], a[48:51], v[184:187]
v_mfma_f32_16x16x32_bf16 v[160:163], a[144:147], a[40:43], v[160:163]
buffer_load_dwordx4 a[28:31], v2, s[40:43], s33 offen offset:3072 sc1
s_add_u32 s35, s35, 0x4000
v_mfma_f32_16x16x32_bf16 v[160:163], a[148:151], a[44:47], v[160:163]
s_add_u32 s33, s33, 0x4000
v_mfma_f32_16x16x32_bf16 v[136:139], a[148:151], a[36:39], v[136:139]
v_mfma_f32_16x16x32_bf16 v[136:139], a[144:147], a[32:35], v[136:139]
s_waitcnt vmcnt(10) lgkmcnt(0)
v_mfma_f32_16x16x32_bf16 v[140:143], a[96:99], a[64:67], v[140:143]
ds_read_b128 a[128:131], v5 offset:17408
v_mfma_f32_16x16x32_bf16 v[140:143], a[100:103], a[68:71], v[140:143]
buffer_load_dwordx4 a[32:35], v2, s[40:43], s35 offen offset:0 sc1
v_mfma_f32_16x16x32_bf16 v[164:167], a[100:103], a[76:79], v[164:167]
ds_read_b128 a[132:135], v5 offset:23552
v_mfma_f32_16x16x32_bf16 v[164:167], a[96:99], a[72:75], v[164:167]
v_mfma_f32_16x16x32_bf16 v[188:191], a[96:99], a[80:83], v[188:191]
v_mfma_f32_16x16x32_bf16 v[188:191], a[100:103], a[84:87], v[188:191]
buffer_load_dwordx4 v[100:103], v1, s[4:7], s88 offen offset:2048 sc1
v_mfma_f32_16x16x32_bf16 v[212:215], a[100:103], a[92:95], v[212:215]
ds_read_b128 a[136:139], v5 offset:12288
v_mfma_f32_16x16x32_bf16 v[212:215], a[96:99], a[88:91], v[212:215]
v_mfma_f32_16x16x32_bf16 v[216:219], a[104:107], a[88:91], v[216:219]
ds_read_b128 a[140:143], v5 offset:18432
v_mfma_f32_16x16x32_bf16 v[216:219], a[108:111], a[92:95], v[216:219]
buffer_load_dwordx4 a[36:39], v2, s[40:43], s33 offen offset:0 sc1
v_mfma_f32_16x16x32_bf16 v[192:195], a[108:111], a[84:87], v[192:195]
ds_read_b128 a[144:147], v5 offset:13312
v_mfma_f32_16x16x32_bf16 v[192:195], a[104:107], a[80:83], v[192:195]
v_mfma_f32_16x16x32_bf16 v[168:171], a[104:107], a[72:75], v[168:171]
v_mfma_f32_16x16x32_bf16 v[168:171], a[108:111], a[76:79], v[168:171]
buffer_load_dwordx4 a[40:43], v2, s[40:43], s35 offen offset:1024 sc1
L_stub5:
s_cbranch_execz L_stub6
v_mfma_f32_16x16x32_bf16 v[144:147], a[108:111], a[68:71], v[144:147]
ds_read_b128 a[148:151], v5 offset:19456
v_mfma_f32_16x16x32_bf16 v[144:147], a[104:107], a[64:67], v[144:147]
v_mfma_f32_16x16x32_bf16 v[148:151], a[112:115], a[64:67], v[148:151]
v_mfma_f32_16x16x32_bf16 v[148:151], a[116:119], a[68:71], v[148:151]
buffer_load_dwordx4 v[104:107], v1, s[4:7], s88 offen offset:3072 sc1
s_add_u32 s88, s88, 4096
v_mfma_f32_16x16x32_bf16 v[172:175], a[116:119], a[76:79], v[172:175]
v_mfma_f32_16x16x32_bf16 v[172:175], a[112:115], a[72:75], v[172:175]
v_mfma_f32_16x16x32_bf16 v[196:199], a[112:115], a[80:83], v[196:199]
v_mfma_f32_16x16x32_bf16 v[196:199], a[116:119], a[84:87], v[196:199]
buffer_load_dwordx4 a[44:47], v2, s[40:43], s33 offen offset:1024 sc1
v_mfma_f32_16x16x32_bf16 v[220:223], a[116:119], a[92:95], v[220:223]
v_mfma_f32_16x16x32_bf16 v[220:223], a[112:115], a[88:91], v[220:223]
s_waitcnt lgkmcnt(0)
v_mfma_f32_16x16x32_bf16 v[224:227], a[128:131], a[88:91], v[224:227]
ds_read_b128 a[96:99], v5 offset:26624
v_mfma_f32_16x16x32_bf16 v[224:227], a[132:135], a[92:95], v[224:227]
buffer_load_dwordx4 a[48:51], v2, s[40:43], s35 offen offset:2048 sc1
v_mfma_f32_16x16x32_bf16 v[200:203], a[132:135], a[84:87], v[200:203]
ds_read_b128 a[100:103], v5 offset:32768
v_mfma_f32_16x16x32_bf16 v[200:203], a[128:131], a[80:83], v[200:203]
v_mfma_f32_16x16x32_bf16 v[176:179], a[128:131], a[72:75], v[176:179]
v_mfma_f32_16x16x32_bf16 v[176:179], a[132:135], a[76:79], v[176:179]
buffer_load_dwordx4 a[52:55], v2, s[40:43], s33 offen offset:2048 sc1
v_mfma_f32_16x16x32_bf16 v[152:155], a[132:135], a[68:71], v[152:155]
ds_read_b128 a[104:107], v5 offset:27648
v_mfma_f32_16x16x32_bf16 v[152:155], a[128:131], a[64:67], v[152:155]
v_mfma_f32_16x16x32_bf16 v[132:135], a[136:139], a[64:67], v[132:135]
ds_read_b128 a[108:111], v5 offset:33792
v_mfma_f32_16x16x32_bf16 v[132:135], a[140:143], a[68:71], v[132:135]
v_mfma_f32_16x16x32_bf16 v[156:159], a[140:143], a[76:79], v[156:159]
buffer_load_dwordx4 v[108:111], v1, s[4:7], s88 offen offset:0 sc1
v_mfma_f32_16x16x32_bf16 v[156:159], a[136:139], a[72:75], v[156:159]
ds_read_b128 a[112:115], v5 offset:28672
v_mfma_f32_16x16x32_bf16 v[180:183], a[136:139], a[80:83], v[180:183]
v_mfma_f32_16x16x32_bf16 v[180:183], a[140:143], a[84:87], v[180:183]
ds_read_b128 a[116:119], v5 offset:34816
v_mfma_f32_16x16x32_bf16 v[204:207], a[140:143], a[92:95], v[204:207]
v_mfma_f32_16x16x32_bf16 v[204:207], a[136:139], a[88:91], v[204:207]
buffer_load_dwordx4 a[56:59], v2, s[40:43], s35 offen offset:3072 sc1
v_mfma_f32_16x16x32_bf16 v[208:211], a[144:147], a[88:91], v[208:211]
v_mfma_f32_16x16x32_bf16 v[208:211], a[148:151], a[92:95], v[208:211]
v_mfma_f32_16x16x32_bf16 v[184:187], a[148:151], a[84:87], v[184:187]
v_mfma_f32_16x16x32_bf16 v[184:187], a[144:147], a[80:83], v[184:187]
v_mfma_f32_16x16x32_bf16 v[160:163], a[144:147], a[72:75], v[160:163]
buffer_load_dwordx4 a[60:63], v2, s[40:43], s33 offen offset:3072 sc1
s_add_u32 s35, s35, 0x64000
v_mfma_f32_16x16x32_bf16 v[160:163], a[148:151], a[76:79], v[160:163]
s_add_u32 s33, s33, 0x64000
v_mfma_f32_16x16x32_bf16 v[136:139], a[148:151], a[68:71], v[136:139]
v_mfma_f32_16x16x32_bf16 v[136:139], a[144:147], a[64:67], v[136:139]
s_waitcnt vmcnt(11) lgkmcnt(0)
v_mfma_f32_16x16x32_bf16 v[140:143], a[96:99], a[0:3], v[140:143]
ds_read_b128 a[128:131], v5 offset:29696
v_add_f32_dpp v48, v48, v48 row_ror:8 row_mask:0xf bank_mask:0xf
v_mfma_f32_16x16x32_bf16 v[140:143], a[100:103], a[4:7], v[140:143]
buffer_load_dwordx4 a[64:67], v2, s[40:43], s35 offen offset:0 sc1
v_mfma_f32_16x16x32_bf16 v[164:167], a[100:103], a[12:15], v[164:167]
ds_read_b128 a[132:135], v5 offset:35840
v_add_f32_dpp v49, v49, v49 row_ror:8 row_mask:0xf bank_mask:0xf
v_mfma_f32_16x16x32_bf16 v[164:167], a[96:99], a[8:11], v[164:167]
v_add_f32_dpp v50, v50, v50 row_ror:8 row_mask:0xf bank_mask:0xf
v_add_f32_dpp v51, v51, v51 row_ror:8 row_mask:0xf bank_mask:0xf
v_mfma_f32_16x16x32_bf16 v[188:191], a[96:99], a[16:19], v[188:191]
v_add_f32_dpp v52, v52, v52 row_ror:8 row_mask:0xf bank_mask:0xf
v_add_f32_dpp v53, v53, v53 row_ror:8 row_mask:0xf bank_mask:0xf
v_mfma_f32_16x16x32_bf16 v[188:191], a[100:103], a[20:23], v[188:191]
buffer_load_dwordx4 a[68:71], v2, s[40:43], s33 offen offset:0 sc1
v_mfma_f32_16x16x32_bf16 v[212:215], a[100:103], a[28:31], v[212:215]
ds_read_b128 a[136:139], v5 offset:24576
v_add_f32_dpp v54, v54, v54 row_ror:8 row_mask:0xf bank_mask:0xf
v_mfma_f32_16x16x32_bf16 v[212:215], a[96:99], a[24:27], v[212:215]
v_add_f32_dpp v55, v55, v55 row_ror:8 row_mask:0xf bank_mask:0xf
v_add_f32_dpp v48, v48, v48 row_ror:4 row_mask:0xf bank_mask:0xf
v_mfma_f32_16x16x32_bf16 v[216:219], a[104:107], a[24:27], v[216:219]
ds_read_b128 a[140:143], v5 offset:30720
v_add_f32_dpp v49, v49, v49 row_ror:4 row_mask:0xf bank_mask:0xf
v_mfma_f32_16x16x32_bf16 v[216:219], a[108:111], a[28:31], v[216:219]
v_add_f32_dpp v50, v50, v50 row_ror:4 row_mask:0xf bank_mask:0xf
v_mfma_f32_16x16x32_bf16 v[192:195], a[108:111], a[20:23], v[192:195]
buffer_load_dwordx4 v[112:115], v1, s[4:7], s88 offen offset:1024 sc1
v_mfma_f32_16x16x32_bf16 v[192:195], a[104:107], a[16:19], v[192:195]
ds_read_b128 a[144:147], v5 offset:25600
v_add_f32_dpp v51, v51, v51 row_ror:4 row_mask:0xf bank_mask:0xf
v_mfma_f32_16x16x32_bf16 v[168:171], a[104:107], a[8:11], v[168:171]
v_add_f32_dpp v52, v52, v52 row_ror:4 row_mask:0xf bank_mask:0xf
v_add_f32_dpp v53, v53, v53 row_ror:4 row_mask:0xf bank_mask:0xf
v_mfma_f32_16x16x32_bf16 v[168:171], a[108:111], a[12:15], v[168:171]
ds_read_b128 a[148:151], v5 offset:31744
v_add_f32_dpp v54, v54, v54 row_ror:4 row_mask:0xf bank_mask:0xf
v_mfma_f32_16x16x32_bf16 v[144:147], a[108:111], a[4:7], v[144:147]
v_add_f32_dpp v55, v55, v55 row_ror:4 row_mask:0xf bank_mask:0xf
v_mfma_f32_16x16x32_bf16 v[144:147], a[104:107], a[0:3], v[144:147]
buffer_load_dwordx4 a[72:75], v2, s[40:43], s35 offen offset:1024 sc1
v_mfma_f32_16x16x32_bf16 v[148:151], a[112:115], a[0:3], v[148:151]
v_add_f32_dpp v48, v48, v48 row_ror:2 row_mask:0xf bank_mask:0xf
v_add_f32_dpp v49, v49, v49 row_ror:2 row_mask:0xf bank_mask:0xf
v_mfma_f32_16x16x32_bf16 v[148:151], a[116:119], a[4:7], v[148:151]
v_add_f32_dpp v50, v50, v50 row_ror:2 row_mask:0xf bank_mask:0xf
v_mfma_f32_16x16x32_bf16 v[172:175], a[116:119], a[12:15], v[172:175]
v_add_f32_dpp v51, v51, v51 row_ror:2 row_mask:0xf bank_mask:0xf
v_mfma_f32_16x16x32_bf16 v[172:175], a[112:115], a[8:11], v[172:175]
v_add_f32_dpp v52, v52, v52 row_ror:2 row_mask:0xf bank_mask:0xf
v_mfma_f32_16x16x32_bf16 v[196:199], a[112:115], a[16:19], v[196:199]
buffer_load_dwordx4 a[76:79], v2, s[40:43], s33 offen offset:1024 sc1
v_mfma_f32_16x16x32_bf16 v[196:199], a[116:119], a[20:23], v[196:199]
v_add_f32_dpp v53, v53, v53 row_ror:2 row_mask:0xf bank_mask:0xf
v_add_f32_dpp v54, v54, v54 row_ror:2 row_mask:0xf bank_mask:0xf
v_mfma_f32_16x16x32_bf16 v[220:223], a[116:119], a[28:31], v[220:223]
v_add_f32_dpp v55, v55, v55 row_ror:2 row_mask:0xf bank_mask:0xf
v_mfma_f32_16x16x32_bf16 v[220:223], a[112:115], a[24:27], v[220:223]
v_add_f32_dpp v48, v48, v48 row_ror:1 row_mask:0xf bank_mask:0xf
s_waitcnt lgkmcnt(0)
v_mfma_f32_16x16x32_bf16 v[224:227], a[128:131], a[24:27], v[224:227]
ds_read_b128 a[96:99], v5 offset:38912
v_add_f32_dpp v49, v49, v49 row_ror:1 row_mask:0xf bank_mask:0xf
v_mfma_f32_16x16x32_bf16 v[224:227], a[132:135], a[28:31], v[224:227]
buffer_load_dwordx4 a[80:83], v2, s[40:43], s35 offen offset:2048 sc1
v_mfma_f32_16x16x32_bf16 v[200:203], a[132:135], a[20:23], v[200:203]
ds_read_b128 a[100:103], v5 offset:45056
v_add_f32_dpp v50, v50, v50 row_ror:1 row_mask:0xf bank_mask:0xf
v_mfma_f32_16x16x32_bf16 v[200:203], a[128:131], a[16:19], v[200:203]
v_add_f32_dpp v51, v51, v51 row_ror:1 row_mask:0xf bank_mask:0xf
v_add_f32_dpp v52, v52, v52 row_ror:1 row_mask:0xf bank_mask:0xf
v_mfma_f32_16x16x32_bf16 v[176:179], a[128:131], a[8:11], v[176:179]
v_add_f32_dpp v53, v53, v53 row_ror:1 row_mask:0xf bank_mask:0xf
v_add_f32_dpp v54, v54, v54 row_ror:1 row_mask:0xf bank_mask:0xf
v_mfma_f32_16x16x32_bf16 v[176:179], a[132:135], a[12:15], v[176:179]
buffer_load_dwordx4 a[84:87], v2, s[40:43], s33 offen offset:2048 sc1
v_mfma_f32_16x16x32_bf16 v[152:155], a[132:135], a[4:7], v[152:155]
ds_read_b128 a[104:107], v5 offset:39936
v_add_f32_dpp v55, v55, v55 row_ror:1 row_mask:0xf bank_mask:0xf
v_mfma_f32_16x16x32_bf16 v[152:155], a[128:131], a[0:3], v[152:155]
v_add_u32 v233, 159744, v233
s_lshl_b32 s36, s28, 6
v_mfma_f32_16x16x32_bf16 v[132:135], a[136:139], a[0:3], v[132:135]
ds_read_b128 a[108:111], v5 offset:46080
s_lshl_b32 s37, s39, 6
v_mfma_f32_16x16x32_bf16 v[132:135], a[140:143], a[4:7], v[132:135]
v_add_u32 v232, s36, v233
v_mfma_f32_16x16x32_bf16 v[156:159], a[140:143], a[12:15], v[156:159]
buffer_load_dwordx4 v[116:119], v1, s[4:7], s88 offen offset:2048 sc1
v_mfma_f32_16x16x32_bf16 v[156:159], a[136:139], a[8:11], v[156:159]
ds_read_b128 a[112:115], v5 offset:40960
v_add_u32 v235, s37, v233
v_mfma_f32_16x16x32_bf16 v[180:183], a[136:139], a[16:19], v[180:183]
v_mfma_f32_16x16x32_bf16 v[180:183], a[140:143], a[20:23], v[180:183]
ds_read_b128 a[116:119], v5 offset:47104
v_mfma_f32_16x16x32_bf16 v[204:207], a[140:143], a[28:31], v[204:207]
v_mfma_f32_16x16x32_bf16 v[204:207], a[136:139], a[24:27], v[204:207]
buffer_load_dwordx4 a[88:91], v2, s[40:43], s35 offen offset:3072 sc1
v_mfma_f32_16x16x32_bf16 v[208:211], a[144:147], a[24:27], v[208:211]
v_mfma_f32_16x16x32_bf16 v[208:211], a[148:151], a[28:31], v[208:211]
v_mfma_f32_16x16x32_bf16 v[184:187], a[148:151], a[20:23], v[184:187]
v_mfma_f32_16x16x32_bf16 v[184:187], a[144:147], a[16:19], v[184:187]
v_mfma_f32_16x16x32_bf16 v[160:163], a[144:147], a[8:11], v[160:163]
buffer_load_dwordx4 a[92:95], v2, s[40:43], s33 offen offset:3072 sc1
s_add_u32 s35, s35, 0x4000
v_mfma_f32_16x16x32_bf16 v[160:163], a[148:151], a[12:15], v[160:163]
s_add_u32 s33, s33, 0x4000
v_mfma_f32_16x16x32_bf16 v[136:139], a[148:151], a[4:7], v[136:139]
v_mfma_f32_16x16x32_bf16 v[136:139], a[144:147], a[0:3], v[136:139]
s_waitcnt vmcnt(10) lgkmcnt(0)
v_mfma_f32_16x16x32_bf16 v[140:143], a[96:99], a[32:35], v[140:143]
ds_read_b128 a[128:131], v5 offset:41984
v_mfma_f32_16x16x32_bf16 v[140:143], a[100:103], a[36:39], v[140:143]
buffer_load_dwordx4 a[0:3], v2, s[40:43], s35 offen offset:0 sc1
v_mfma_f32_16x16x32_bf16 v[164:167], a[100:103], a[44:47], v[164:167]
ds_read_b128 a[132:135], v5 offset:48128
v_mfma_f32_16x16x32_bf16 v[164:167], a[96:99], a[40:43], v[164:167]
ds_write_b128 v232, v[48:51]
v_mfma_f32_16x16x32_bf16 v[188:191], a[96:99], a[48:51], v[188:191]
ds_write_b128 v235, v[52:55]
v_mfma_f32_16x16x32_bf16 v[188:191], a[100:103], a[52:55], v[188:191]
buffer_load_dwordx4 v[120:123], v1, s[4:7], s88 offen offset:3072 sc1
s_add_u32 m0, s18, 0x0
v_mfma_f32_16x16x32_bf16 v[212:215], a[100:103], a[60:63], v[212:215]
s_add_u32 s44, s50, 0x3424000
ds_read_b128 a[136:139], v5 offset:36864
v_mfma_f32_16x16x32_bf16 v[212:215], a[96:99], a[56:59], v[212:215]
v_mfma_f32_16x16x32_bf16 v[216:219], a[104:107], a[56:59], v[216:219]
ds_read_b128 a[140:143], v5 offset:43008
v_mfma_f32_16x16x32_bf16 v[216:219], a[108:111], a[60:63], v[216:219]
buffer_load_dwordx4 a[4:7], v2, s[40:43], s33 offen offset:0 sc1
v_mfma_f32_16x16x32_bf16 v[192:195], a[108:111], a[52:55], v[192:195]
ds_read_b128 a[144:147], v5 offset:37888
v_mfma_f32_16x16x32_bf16 v[192:195], a[104:107], a[48:51], v[192:195]
v_mfma_f32_16x16x32_bf16 v[168:171], a[104:107], a[40:43], v[168:171]
v_mfma_f32_16x16x32_bf16 v[168:171], a[108:111], a[44:47], v[168:171]
buffer_load_dwordx4 a[8:11], v2, s[40:43], s35 offen offset:1024 sc1
v_mfma_f32_16x16x32_bf16 v[144:147], a[108:111], a[36:39], v[144:147]
ds_read_b128 a[148:151], v5 offset:44032
v_mfma_f32_16x16x32_bf16 v[144:147], a[104:107], a[32:35], v[144:147]
v_mfma_f32_16x16x32_bf16 v[148:151], a[112:115], a[32:35], v[148:151]
v_mfma_f32_16x16x32_bf16 v[148:151], a[116:119], a[36:39], v[148:151]
buffer_load_dwordx4 v1, s[4:7], s44 offen offset:0 sc1 lds
v_mfma_f32_16x16x32_bf16 v[172:175], a[116:119], a[44:47], v[172:175]
v_mfma_f32_16x16x32_bf16 v[172:175], a[112:115], a[40:43], v[172:175]
v_mfma_f32_16x16x32_bf16 v[196:199], a[112:115], a[48:51], v[196:199]
v_mfma_f32_16x16x32_bf16 v[196:199], a[116:119], a[52:55], v[196:199]
buffer_load_dwordx4 a[12:15], v2, s[40:43], s33 offen offset:1024 sc1
v_mfma_f32_16x16x32_bf16 v[220:223], a[116:119], a[60:63], v[220:223]
v_mfma_f32_16x16x32_bf16 v[220:223], a[112:115], a[56:59], v[220:223]
s_waitcnt lgkmcnt(0)
s_barrier
v_mfma_f32_16x16x32_bf16 v[224:227], a[128:131], a[56:59], v[224:227]
v_add_u32 v5, 98304, v1
v_mfma_f32_16x16x32_bf16 v[224:227], a[132:135], a[60:63], v[224:227]
buffer_load_dwordx4 a[16:19], v2, s[40:43], s35 offen offset:2048 sc1
v_mfma_f32_16x16x32_bf16 v[200:203], a[132:135], a[52:55], v[200:203]
ds_read_b128 a[96:99], v5 offset:2048
v_mfma_f32_16x16x32_bf16 v[200:203], a[128:131], a[48:51], v[200:203]
ds_read_b128 a[100:103], v5 offset:8192
v_mfma_f32_16x16x32_bf16 v[176:179], a[128:131], a[40:43], v[176:179]
ds_read_b128 v[48:51], v233 offset:0
v_mfma_f32_16x16x32_bf16 v[176:179], a[132:135], a[44:47], v[176:179]
buffer_load_dwordx4 a[20:23], v2, s[40:43], s33 offen offset:2048 sc1
v_mfma_f32_16x16x32_bf16 v[152:155], a[132:135], a[36:39], v[152:155]
ds_read_b128 a[104:107], v5 offset:3072
v_mfma_f32_16x16x32_bf16 v[152:155], a[128:131], a[32:35], v[152:155]
v_mfma_f32_16x16x32_bf16 v[132:135], a[136:139], a[32:35], v[132:135]
ds_read_b128 a[108:111], v5 offset:9216
v_mfma_f32_16x16x32_bf16 v[132:135], a[140:143], a[36:39], v[132:135]
v_mfma_f32_16x16x32_bf16 v[156:159], a[140:143], a[44:47], v[156:159]
buffer_load_dwordx4 v1, s[4:7], s44 offen offset:1024 sc1 lds
s_add_u32 m0, s18, 0x2000
v_mfma_f32_16x16x32_bf16 v[156:159], a[136:139], a[40:43], v[156:159]
s_add_u32 s44, s50, 0x3426000
ds_read_b128 a[112:115], v5 offset:4096
v_mfma_f32_16x16x32_bf16 v[180:183], a[136:139], a[48:51], v[180:183]
ds_read_b128 v[52:55], v233 offset:64
v_mfma_f32_16x16x32_bf16 v[180:183], a[140:143], a[52:55], v[180:183]
ds_read_b128 a[116:119], v5 offset:10240
v_mfma_f32_16x16x32_bf16 v[204:207], a[140:143], a[60:63], v[204:207]
v_mfma_f32_16x16x32_bf16 v[204:207], a[136:139], a[56:59], v[204:207]
buffer_load_dwordx4 a[24:27], v2, s[40:43], s35 offen offset:3072 sc1
v_mfma_f32_16x16x32_bf16 v[208:211], a[144:147], a[56:59], v[208:211]
v_mfma_f32_16x16x32_bf16 v[208:211], a[148:151], a[60:63], v[208:211]
v_mfma_f32_16x16x32_bf16 v[184:187], a[148:151], a[52:55], v[184:187]
v_mfma_f32_16x16x32_bf16 v[184:187], a[144:147], a[48:51], v[184:187]
v_mfma_f32_16x16x32_bf16 v[160:163], a[144:147], a[40:43], v[160:163]
buffer_load_dwordx4 a[28:31], v2, s[40:43], s33 offen offset:3072 sc1
s_add_u32 s35, s35, 0x4000
v_mfma_f32_16x16x32_bf16 v[160:163], a[148:151], a[44:47], v[160:163]
s_add_u32 s33, s33, 0x4000
ds_read_b128 v[56:59], v233 offset:128
v_mfma_f32_16x16x32_bf16 v[136:139], a[148:151], a[36:39], v[136:139]
v_mfma_f32_16x16x32_bf16 v[136:139], a[144:147], a[32:35], v[136:139]
s_waitcnt vmcnt(11) lgkmcnt(1)
v_mfma_f32_16x16x32_bf16 v[140:143], a[96:99], a[64:67], v[140:143]
ds_read_b128 a[128:131], v5 offset:5120
v_mfma_f32_16x16x32_bf16 v[140:143], a[100:103], a[68:71], v[140:143]
buffer_load_dwordx4 a[32:35], v2, s[40:43], s35 offen offset:0 sc1
v_mfma_f32_16x16x32_bf16 v[164:167], a[100:103], a[76:79], v[164:167]
ds_read_b128 a[132:135], v5 offset:11264
v_mfma_f32_16x16x32_bf16 v[164:167], a[96:99], a[72:75], v[164:167]
v_mfma_f32_16x16x32_bf16 v[188:191], a[96:99], a[80:83], v[188:191]
v_mfma_f32_16x16x32_bf16 v[188:191], a[100:103], a[84:87], v[188:191]
buffer_load_dwordx4 a[36:39], v2, s[40:43], s33 offen offset:0 sc1
v_mfma_f32_16x16x32_bf16 v[212:215], a[100:103], a[92:95], v[212:215]
ds_read_b128 a[136:139], v5 offset:0
v_mfma_f32_16x16x32_bf16 v[212:215], a[96:99], a[88:91], v[212:215]
v_mfma_f32_16x16x32_bf16 v[216:219], a[104:107], a[88:91], v[216:219]
ds_read_b128 a[140:143], v5 offset:6144
v_mfma_f32_16x16x32_bf16 v[216:219], a[108:111], a[92:95], v[216:219]
ds_read_b128 v[60:63], v233 offset:192
v_mfma_f32_16x16x32_bf16 v[192:195], a[108:111], a[84:87], v[192:195]
buffer_load_dwordx4 v1, s[4:7], s44 offen offset:0 sc1 lds
v_mfma_f32_16x16x32_bf16 v[192:195], a[104:107], a[80:83], v[192:195]
ds_read_b128 a[144:147], v5 offset:1024
v_mfma_f32_16x16x32_bf16 v[168:171], a[104:107], a[72:75], v[168:171]
v_mfma_f32_16x16x32_bf16 v[168:171], a[108:111], a[76:79], v[168:171]
ds_read_b128 a[148:151], v5 offset:7168
v_mfma_f32_16x16x32_bf16 v[144:147], a[108:111], a[68:71], v[144:147]
v_mfma_f32_16x16x32_bf16 v[144:147], a[104:107], a[64:67], v[144:147]
buffer_load_dwordx4 a[40:43], v2, s[40:43], s35 offen offset:1024 sc1
v_mfma_f32_16x16x32_bf16 v[148:151], a[112:115], a[64:67], v[148:151]
v_mfma_f32_16x16x32_bf16 v[148:151], a[116:119], a[68:71], v[148:151]
v_mfma_f32_16x16x32_bf16 v[172:175], a[116:119], a[76:79], v[172:175]
ds_read_b128 v[64:67], v233 offset:256
v_mfma_f32_16x16x32_bf16 v[172:175], a[112:115], a[72:75], v[172:175]
v_mfma_f32_16x16x32_bf16 v[196:199], a[112:115], a[80:83], v[196:199]
buffer_load_dwordx4 a[44:47], v2, s[40:43], s33 offen offset:1024 sc1
v_mfma_f32_16x16x32_bf16 v[196:199], a[116:119], a[84:87], v[196:199]
v_mfma_f32_16x16x32_bf16 v[220:223], a[116:119], a[92:95], v[220:223]
v_mfma_f32_16x16x32_bf16 v[220:223], a[112:115], a[88:91], v[220:223]
s_waitcnt lgkmcnt(1)
v_mfma_f32_16x16x32_bf16 v[224:227], a[128:131], a[88:91], v[224:227]
ds_read_b128 a[96:99], v5 offset:14336
v_mfma_f32_16x16x32_bf16 v[224:227], a[132:135], a[92:95], v[224:227]
buffer_load_dwordx4 a[48:51], v2, s[40:43], s35 offen offset:2048 sc1
v_mfma_f32_16x16x32_bf16 v[200:203], a[132:135], a[84:87], v[200:203]
ds_read_b128 a[100:103], v5 offset:20480
v_mfma_f32_16x16x32_bf16 v[200:203], a[128:131], a[80:83], v[200:203]
v_mfma_f32_16x16x32_bf16 v[176:179], a[128:131], a[72:75], v[176:179]
v_mfma_f32_16x16x32_bf16 v[176:179], a[132:135], a[76:79], v[176:179]
buffer_load_dwordx4 a[52:55], v2, s[40:43], s33 offen offset:2048 sc1
v_mfma_f32_16x16x32_bf16 v[152:155], a[132:135], a[68:71], v[152:155]
ds_read_b128 a[104:107], v5 offset:15360
v_mfma_f32_16x16x32_bf16 v[152:155], a[128:131], a[64:67], v[152:155]
ds_read_b128 v[68:71], v233 offset:320
v_mfma_f32_16x16x32_bf16 v[132:135], a[136:139], a[64:67], v[132:135]
ds_read_b128 a[108:111], v5 offset:21504
v_mfma_f32_16x16x32_bf16 v[132:135], a[140:143], a[68:71], v[132:135]
v_mfma_f32_16x16x32_bf16 v[156:159], a[140:143], a[76:79], v[156:159]
buffer_load_dwordx4 v1, s[4:7], s44 offen offset:1024 sc1 lds
s_add_u32 m0, s18, 0x4000
v_mfma_f32_16x16x32_bf16 v[156:159], a[136:139], a[72:75], v[156:159]
s_add_u32 s44, s50, 0x3428000
ds_read_b128 a[112:115], v5 offset:16384
v_mfma_f32_16x16x32_bf16 v[180:183], a[136:139], a[80:83], v[180:183]
v_mfma_f32_16x16x32_bf16 v[180:183], a[140:143], a[84:87], v[180:183]
ds_read_b128 a[116:119], v5 offset:22528
v_mfma_f32_16x16x32_bf16 v[204:207], a[140:143], a[92:95], v[204:207]
v_mfma_f32_16x16x32_bf16 v[204:207], a[136:139], a[88:91], v[204:207]
buffer_load_dwordx4 a[56:59], v2, s[40:43], s35 offen offset:3072 sc1
v_mfma_f32_16x16x32_bf16 v[208:211], a[144:147], a[88:91], v[208:211]
v_mfma_f32_16x16x32_bf16 v[208:211], a[148:151], a[92:95], v[208:211]
v_mfma_f32_16x16x32_bf16 v[184:187], a[148:151], a[84:87], v[184:187]
v_mfma_f32_16x16x32_bf16 v[184:187], a[144:147], a[80:83], v[184:187]
v_mfma_f32_16x16x32_bf16 v[160:163], a[144:147], a[72:75], v[160:163]
buffer_load_dwordx4 a[60:63], v2, s[40:43], s33 offen offset:3072 sc1
s_add_u32 s35, s35, 0x4000
v_mfma_f32_16x16x32_bf16 v[160:163], a[148:151], a[76:79], v[160:163]
s_add_u32 s33, s33, 0x4000
v_mfma_f32_16x16x32_bf16 v[136:139], a[148:151], a[68:71], v[136:139]
v_mfma_f32_16x16x32_bf16 v[136:139], a[144:147], a[64:67], v[136:139]
s_waitcnt vmcnt(10) lgkmcnt(0)
v_mfma_f32_16x16x32_bf16 v[140:143], a[96:99], a[0:3], v[140:143]
ds_read_b128 a[128:131], v5 offset:17408
v_add_f32 v92, v92, v96
v_mfma_f32_16x16x32_bf16 v[140:143], a[100:103], a[4:7], v[140:143]
buffer_load_dwordx4 a[64:67], v2, s[40:43], s35 offen offset:0 sc1
v_mfma_f32_16x16x32_bf16 v[164:167], a[100:103], a[12:15], v[164:167]
ds_read_b128 a[132:135], v5 offset:23552
v_add_f32 v100, v100, v104
v_mfma_f32_16x16x32_bf16 v[164:167], a[96:99], a[8:11], v[164:167]
v_add_f32 v108, v108, v112
v_add_f32 v116, v116, v120
v_mfma_f32_16x16x32_bf16 v[188:191], a[96:99], a[16:19], v[188:191]
v_add_f32 v93, v93, v97
v_add_f32 v101, v101, v105
v_mfma_f32_16x16x32_bf16 v[188:191], a[100:103], a[20:23], v[188:191]
buffer_load_dwordx4 v1, s[4:7], s44 offen offset:0 sc1 lds
v_mfma_f32_16x16x32_bf16 v[212:215], a[100:103], a[28:31], v[212:215]
ds_read_b128 a[136:139], v5 offset:12288
v_add_f32 v109, v109, v113
v_mfma_f32_16x16x32_bf16 v[212:215], a[96:99], a[24:27], v[212:215]
v_add_f32 v117, v117, v121
v_add_f32 v94, v94, v98
v_mfma_f32_16x16x32_bf16 v[216:219], a[104:107], a[24:27], v[216:219]
ds_read_b128 a[140:143], v5 offset:18432
v_add_f32 v102, v102, v106
v_mfma_f32_16x16x32_bf16 v[216:219], a[108:111], a[28:31], v[216:219]
buffer_load_dwordx4 a[68:71], v2, s[40:43], s33 offen offset:0 sc1
v_mfma_f32_16x16x32_bf16 v[192:195], a[108:111], a[20:23], v[192:195]
ds_read_b128 a[144:147], v5 offset:13312
v_add_f32 v110, v110, v114
v_mfma_f32_16x16x32_bf16 v[192:195], a[104:107], a[16:19], v[192:195]
v_add_f32 v118, v118, v122
v_add_f32 v95, v95, v99
v_mfma_f32_16x16x32_bf16 v[168:171], a[104:107], a[8:11], v[168:171]
v_add_f32 v103, v103, v107
v_mfma_f32_16x16x32_bf16 v[168:171], a[108:111], a[12:15], v[168:171]
buffer_load_dwordx4 a[72:75], v2, s[40:43], s35 offen offset:1024 sc1
v_mfma_f32_16x16x32_bf16 v[144:147], a[108:111], a[4:7], v[144:147]
ds_read_b128 a[148:151], v5 offset:19456
v_add_f32 v111, v111, v115
v_mfma_f32_16x16x32_bf16 v[144:147], a[104:107], a[0:3], v[144:147]
v_add_f32 v119, v119, v123
v_add_f32_dpp v92, v92, v92 row_ror:8 row_mask:0xf bank_mask:0xf
v_mfma_f32_16x16x32_bf16 v[148:151], a[112:115], a[0:3], v[148:151]
v_add_f32_dpp v100, v100, v100 row_ror:8 row_mask:0xf bank_mask:0xf
v_mfma_f32_16x16x32_bf16 v[148:151], a[116:119], a[4:7], v[148:151]
buffer_load_dwordx4 v1, s[4:7], s44 offen offset:1024 sc1 lds
s_add_u32 m0, s18, 0x6000
v_mfma_f32_16x16x32_bf16 v[172:175], a[116:119], a[12:15], v[172:175]
s_add_u32 s44, s50, 0x342a000
v_add_f32_dpp v108, v108, v108 row_ror:8 row_mask:0xf bank_mask:0xf
v_mfma_f32_16x16x32_bf16 v[172:175], a[112:115], a[8:11], v[172:175]
v_add_f32_dpp v116, v116, v116 row_ror:8 row_mask:0xf bank_mask:0xf
v_add_f32_dpp v93, v93, v93 row_ror:8 row_mask:0xf bank_mask:0xf
v_mfma_f32_16x16x32_bf16 v[196:199], a[112:115], a[16:19], v[196:199]
v_add_f32_dpp v101, v101, v101 row_ror:8 row_mask:0xf bank_mask:0xf
v_mfma_f32_16x16x32_bf16 v[196:199], a[116:119], a[20:23], v[196:199]
buffer_load_dwordx4 a[76:79], v2, s[40:43], s33 offen offset:1024 sc1
v_mfma_f32_16x16x32_bf16 v[220:223], a[116:119], a[28:31], v[220:223]
v_add_f32_dpp v109, v109, v109 row_ror:8 row_mask:0xf bank_mask:0xf
v_add_f32_dpp v117, v117, v117 row_ror:8 row_mask:0xf bank_mask:0xf
v_mfma_f32_16x16x32_bf16 v[220:223], a[112:115], a[24:27], v[220:223]
v_add_f32_dpp v92, v94, v94 row_ror:8 row_mask:0xf bank_mask:0xc
s_waitcnt lgkmcnt(0)
v_mfma_f32_16x16x32_bf16 v[224:227], a[128:131], a[24:27], v[224:227]
ds_read_b128 a[96:99], v5 offset:26624
v_accvgpr_write_b32 a216, v48
v_mfma_f32_16x16x32_bf16 v[224:227], a[132:135], a[28:31], v[224:227]
buffer_load_dwordx4 a[80:83], v2, s[40:43], s35 offen offset:2048 sc1
v_mfma_f32_16x16x32_bf16 v[200:203], a[132:135], a[20:23], v[200:203]
ds_read_b128 a[100:103], v5 offset:32768
v_add_f32_dpp v100, v102, v102 row_ror:8 row_mask:0xf bank_mask:0xc
v_mfma_f32_16x16x32_bf16 v[200:203], a[128:131], a[16:19], v[200:203]
v_accvgpr_write_b32 a217, v49
v_add_f32_dpp v108, v110, v110 row_ror:8 row_mask:0xf bank_mask:0xc
v_mfma_f32_16x16x32_bf16 v[176:179], a[128:131], a[8:11], v[176:179]
v_add_f32_dpp v116, v118, v118 row_ror:8 row_mask:0xf bank_mask:0xc
v_add_f32_dpp v93, v95, v95 row_ror:8 row_mask:0xf bank_mask:0xc
v_mfma_f32_16x16x32_bf16 v[176:179], a[132:135], a[12:15], v[176:179]
buffer_load_dwordx4 a[84:87], v2, s[40:43], s33 offen offset:2048 sc1
v_mfma_f32_16x16x32_bf16 v[152:155], a[132:135], a[4:7], v[152:155]
ds_read_b128 a[104:107], v5 offset:27648
v_accvgpr_write_b32 a218, v50
v_mfma_f32_16x16x32_bf16 v[152:155], a[128:131], a[0:3], v[152:155]
v_add_f32_dpp v101, v103, v103 row_ror:8 row_mask:0xf bank_mask:0xc
v_add_f32_dpp v109, v111, v111 row_ror:8 row_mask:0xf bank_mask:0xc
v_mfma_f32_16x16x32_bf16 v[132:135], a[136:139], a[0:3], v[132:135]
ds_read_b128 a[108:111], v5 offset:33792
v_add_f32_dpp v117, v119, v119 row_ror:8 row_mask:0xf bank_mask:0xc
v_mfma_f32_16x16x32_bf16 v[132:135], a[140:143], a[4:7], v[132:135]
v_accvgpr_write_b32 a219, v51
v_mfma_f32_16x16x32_bf16 v[156:159], a[140:143], a[12:15], v[156:159]
buffer_load_dwordx4 v1, s[4:7], s44 offen offset:0 sc1 lds
v_mfma_f32_16x16x32_bf16 v[156:159], a[136:139], a[8:11], v[156:159]
ds_read_b128 a[112:115], v5 offset:28672
v_mfma_f32_16x16x32_bf16 v[180:183], a[136:139], a[16:19], v[180:183]
v_accvgpr_write_b32 a220, v52
v_mfma_f32_16x16x32_bf16 v[180:183], a[140:143], a[20:23], v[180:183]
ds_read_b128 a[116:119], v5 offset:34816
v_mfma_f32_16x16x32_bf16 v[204:207], a[140:143], a[28:31], v[204:207]
v_permlane32_swap_b32 v92, v93
v_mfma_f32_16x16x32_bf16 v[204:207], a[136:139], a[24:27], v[204:207]
buffer_load_dwordx4 a[88:91], v2, s[40:43], s35 offen offset:3072 sc1
v_mfma_f32_16x16x32_bf16 v[208:211], a[144:147], a[24:27], v[208:211]
v_accvgpr_write_b32 a221, v53
v_mfma_f32_16x16x32_bf16 v[208:211], a[148:151], a[28:31], v[208:211]
v_permlane32_swap_b32 v100, v101
v_mfma_f32_16x16x32_bf16 v[184:187], a[148:151], a[20:23], v[184:187]
v_accvgpr_write_b32 a222, v54
v_mfma_f32_16x16x32_bf16 v[184:187], a[144:147], a[16:19], v[184:187]
v_permlane32_swap_b32 v108, v109
v_mfma_f32_16x16x32_bf16 v[160:163], a[144:147], a[8:11], v[160:163]
buffer_load_dwordx4 a[92:95], v2, s[40:43], s33 offen offset:3072 sc1
s_add_u32 s35, s35, 0x4000
v_mfma_f32_16x16x32_bf16 v[160:163], a[148:151], a[12:15], v[160:163]
s_add_u32 s33, s33, 0x4000
v_accvgpr_write_b32 a223, v55
v_mfma_f32_16x16x32_bf16 v[136:139], a[148:151], a[4:7], v[136:139]
v_permlane32_swap_b32 v116, v117
v_mfma_f32_16x16x32_bf16 v[136:139], a[144:147], a[0:3], v[136:139]
v_add_f32 v92, v92, v93
s_waitcnt vmcnt(11) lgkmcnt(0)
v_mfma_f32_16x16x32_bf16 v[140:143], a[96:99], a[32:35], v[140:143]
ds_read_b128 a[128:131], v5 offset:29696
v_accvgpr_write_b32 a224, v56
v_mfma_f32_16x16x32_bf16 v[140:143], a[100:103], a[36:39], v[140:143]
buffer_load_dwordx4 a[0:3], v2, s[40:43], s35 offen offset:0 sc1
v_mfma_f32_16x16x32_bf16 v[164:167], a[100:103], a[44:47], v[164:167]
ds_read_b128 a[132:135], v5 offset:35840
v_add_f32 v100, v100, v101
v_mfma_f32_16x16x32_bf16 v[164:167], a[96:99], a[40:43], v[164:167]
v_accvgpr_write_b32 a225, v57
v_add_f32 v108, v108, v109
v_mfma_f32_16x16x32_bf16 v[188:191], a[96:99], a[48:51], v[188:191]
v_add_f32 v116, v116, v117
v_mov_b32 v94, v92
v_mfma_f32_16x16x32_bf16 v[188:191], a[100:103], a[52:55], v[188:191]
buffer_load_dwordx4 a[4:7], v2, s[40:43], s33 offen offset:0 sc1
v_mfma_f32_16x16x32_bf16 v[212:215], a[100:103], a[60:63], v[212:215]
ds_read_b128 a[136:139], v5 offset:24576
v_accvgpr_write_b32 a226, v58
v_mfma_f32_16x16x32_bf16 v[212:215], a[96:99], a[56:59], v[212:215]
v_mov_b32 v102, v100
v_mov_b32 v110, v108
v_mfma_f32_16x16x32_bf16 v[216:219], a[104:107], a[56:59], v[216:219]
ds_read_b128 a[140:143], v5 offset:30720
v_mov_b32 v118, v116
v_mfma_f32_16x16x32_bf16 v[216:219], a[108:111], a[60:63], v[216:219]
v_accvgpr_write_b32 a227, v59
v_mfma_f32_16x16x32_bf16 v[192:195], a[108:111], a[52:55], v[192:195]
buffer_load_dwordx4 v1, s[4:7], s44 offen offset:1024 sc1 lds
s_add_u32 m0, s18, 0x8000
v_mfma_f32_16x16x32_bf16 v[192:195], a[104:107], a[48:51], v[192:195]
s_add_u32 s44, s50, 0x342c000
ds_read_b128 a[144:147], v5 offset:25600
v_mfma_f32_16x16x32_bf16 v[168:171], a[104:107], a[40:43], v[168:171]
v_accvgpr_write_b32 a228, v60
v_mfma_f32_16x16x32_bf16 v[168:171], a[108:111], a[44:47], v[168:171]
ds_read_b128 a[148:151], v5 offset:31744
v_mfma_f32_16x16x32_bf16 v[144:147], a[108:111], a[36:39], v[144:147]
v_permlane16_swap_b32 v92, v94
v_mfma_f32_16x16x32_bf16 v[144:147], a[104:107], a[32:35], v[144:147]
buffer_load_dwordx4 a[8:11], v2, s[40:43], s35 offen offset:1024 sc1
v_mfma_f32_16x16x32_bf16 v[148:151], a[112:115], a[32:35], v[148:151]
v_accvgpr_write_b32 a229, v61
v_mfma_f32_16x16x32_bf16 v[148:151], a[116:119], a[36:39], v[148:151]
v_permlane16_swap_b32 v100, v102
v_mfma_f32_16x16x32_bf16 v[172:175], a[116:119], a[44:47], v[172:175]
v_accvgpr_write_b32 a230, v62
v_mfma_f32_16x16x32_bf16 v[172:175], a[112:115], a[40:43], v[172:175]
v_permlane16_swap_b32 v108, v110
v_mfma_f32_16x16x32_bf16 v[196:199], a[112:115], a[48:51], v[196:199]
buffer_load_dwordx4 a[12:15], v2, s[40:43], s33 offen offset:1024 sc1
v_mfma_f32_16x16x32_bf16 v[196:199], a[116:119], a[52:55], v[196:199]
v_accvgpr_write_b32 a231, v63
v_mfma_f32_16x16x32_bf16 v[220:223], a[116:119], a[60:63], v[220:223]
v_permlane16_swap_b32 v116, v118
v_mfma_f32_16x16x32_bf16 v[220:223], a[112:115], a[56:59], v[220:223]
v_add_f32 v92, v92, v94
s_waitcnt lgkmcnt(0)
v_mfma_f32_16x16x32_bf16 v[224:227], a[128:131], a[56:59], v[224:227]
ds_read_b128 a[96:99], v5 offset:38912
v_accvgpr_write_b32 a232, v64
v_mfma_f32_16x16x32_bf16 v[224:227], a[132:135], a[60:63], v[224:227]
buffer_load_dwordx4 a[16:19], v2, s[40:43], s35 offen offset:2048 sc1
v_mfma_f32_16x16x32_bf16 v[200:203], a[132:135], a[52:55], v[200:203]
ds_read_b128 a[100:103], v5 offset:45056
v_add_f32 v100, v100, v102
v_mfma_f32_16x16x32_bf16 v[200:203], a[128:131], a[48:51], v[200:203]
v_accvgpr_write_b32 a233, v65
v_add_f32 v108, v108, v110
v_mfma_f32_16x16x32_bf16 v[176:179], a[128:131], a[40:43], v[176:179]
v_add_f32 v116, v116, v118
v_mov_b32 v94, v92
v_mfma_f32_16x16x32_bf16 v[176:179], a[132:135], a[44:47], v[176:179]
buffer_load_dwordx4 a[20:23], v2, s[40:43], s33 offen offset:2048 sc1
v_mfma_f32_16x16x32_bf16 v[152:155], a[132:135], a[36:39], v[152:155]
ds_read_b128 a[104:107], v5 offset:39936
v_accvgpr_write_b32 a234, v66
v_mfma_f32_16x16x32_bf16 v[152:155], a[128:131], a[32:35], v[152:155]
v_mov_b32 v102, v100
v_mov_b32 v110, v108
v_mfma_f32_16x16x32_bf16 v[132:135], a[136:139], a[32:35], v[132:135]
ds_read_b128 a[108:111], v5 offset:46080
v_mov_b32 v118, v116
v_mfma_f32_16x16x32_bf16 v[132:135], a[140:143], a[36:39], v[132:135]
v_accvgpr_write_b32 a235, v67
v_mfma_f32_16x16x32_bf16 v[156:159], a[140:143], a[44:47], v[156:159]
buffer_load_dwordx4 v1, s[4:7], s44 offen offset:0 sc1 lds
v_mfma_f32_16x16x32_bf16 v[156:159], a[136:139], a[40:43], v[156:159]
ds_read_b128 a[112:115], v5 offset:40960
L_stub6:
s_cbranch_execz L_stub7
v_mfma_f32_16x16x32_bf16 v[180:183], a[136:139], a[48:51], v[180:183]
v_accvgpr_write_b32 a236, v68
v_mfma_f32_16x16x32_bf16 v[180:183], a[140:143], a[52:55], v[180:183]
ds_read_b128 a[116:119], v5 offset:47104
v_mfma_f32_16x16x32_bf16 v[204:207], a[140:143], a[60:63], v[204:207]
v_permlane32_swap_b32 v92, v94
v_mfma_f32_16x16x32_bf16 v[204:207], a[136:139], a[56:59], v[204:207]
buffer_load_dwordx4 a[24:27], v2, s[40:43], s35 offen offset:3072 sc1
v_mfma_f32_16x16x32_bf16 v[208:211], a[144:147], a[56:59], v[208:211]
v_accvgpr_write_b32 a237, v69
v_mfma_f32_16x16x32_bf16 v[208:211], a[148:151], a[60:63], v[208:211]
v_permlane32_swap_b32 v100, v102
v_mfma_f32_16x16x32_bf16 v[184:187], a[148:151], a[52:55], v[184:187]
v_accvgpr_write_b32 a238, v70
v_mfma_f32_16x16x32_bf16 v[184:187], a[144:147], a[48:51], v[184:187]
v_permlane32_swap_b32 v108, v110
v_mfma_f32_16x16x32_bf16 v[160:163], a[144:147], a[40:43], v[160:163]
buffer_load_dwordx4 a[28:31], v2, s[40:43], s33 offen offset:3072 sc1
s_add_u32 s35, s35, 0x4000
v_mfma_f32_16x16x32_bf16 v[160:163], a[148:151], a[44:47], v[160:163]
s_add_u32 s33, s33, 0x4000
v_accvgpr_write_b32 a239, v71
v_mfma_f32_16x16x32_bf16 v[136:139], a[148:151], a[36:39], v[136:139]
v_permlane32_swap_b32 v116, v118
v_mfma_f32_16x16x32_bf16 v[136:139], a[144:147], a[32:35], v[136:139]
v_mul_f32 v82, 0xba800000, v92
s_waitcnt vmcnt(10) lgkmcnt(0)
v_mfma_f32_16x16x32_bf16 v[140:143], a[96:99], a[64:67], v[140:143]
ds_read_b128 a[128:131], v5 offset:41984
v_mul_f32 v84, 0xba800000, v100
v_mfma_f32_16x16x32_bf16 v[140:143], a[100:103], a[68:71], v[140:143]
buffer_load_dwordx4 a[32:35], v2, s[40:43], s35 offen offset:0 sc1
v_mfma_f32_16x16x32_bf16 v[164:167], a[100:103], a[76:79], v[164:167]
ds_read_b128 a[132:135], v5 offset:48128
v_mul_f32 v86, 0xba800000, v108
v_mfma_f32_16x16x32_bf16 v[164:167], a[96:99], a[72:75], v[164:167]
v_mul_f32 v88, 0xba800000, v116
v_mul_f32 v94, 0x3a800000, v94
v_mfma_f32_16x16x32_bf16 v[188:191], a[96:99], a[80:83], v[188:191]
v_mul_f32 v102, 0x3a800000, v102
v_mul_f32 v110, 0x3a800000, v110
v_mfma_f32_16x16x32_bf16 v[188:191], a[100:103], a[84:87], v[188:191]
buffer_load_dwordx4 v1, s[4:7], s44 offen offset:1024 sc1 lds
s_add_u32 m0, s18, 0xa000
v_mfma_f32_16x16x32_bf16 v[212:215], a[100:103], a[92:95], v[212:215]
s_add_u32 s44, s50, 0x342e000
ds_read_b128 a[136:139], v5 offset:36864
v_mfma_f32_16x16x32_bf16 v[212:215], a[96:99], a[88:91], v[212:215]
v_mul_f32 v118, 0x3a800000, v118
v_fma_f32 v94, -v82, v82, v94
v_fma_f32 v102, -v84, v84, v102
v_fma_f32 v110, -v86, v86, v110
v_fma_f32 v118, -v88, v88, v118
v_max_f32 v94, 0, v94
v_max_f32 v102, 0, v102
v_max_f32 v110, 0, v110
v_max_f32 v118, 0, v118
v_add_f32 v94, 0x3727c5ac, v94
v_add_f32 v102, 0x3727c5ac, v102
v_add_f32 v110, 0x3727c5ac, v110
v_add_f32 v118, 0x3727c5ac, v118
v_rsq_f32 v83, v94
v_rsq_f32 v85, v102
v_rsq_f32 v87, v110
v_rsq_f32 v89, v118
v_mfma_f32_16x16x32_bf16 v[216:219], a[104:107], a[88:91], v[216:219]
ds_read_b128 a[140:143], v5 offset:43008
v_mfma_f32_16x16x32_bf16 v[216:219], a[108:111], a[92:95], v[216:219]
buffer_load_dwordx4 a[36:39], v2, s[40:43], s33 offen offset:0 sc1
v_mfma_f32_16x16x32_bf16 v[192:195], a[108:111], a[84:87], v[192:195]
ds_read_b128 a[144:147], v5 offset:37888
v_fmac_f32 v140, v56, v82
v_mfma_f32_16x16x32_bf16 v[192:195], a[104:107], a[80:83], v[192:195]
v_mfma_f32_16x16x32_bf16 v[168:171], a[104:107], a[72:75], v[168:171]
v_fmac_f32 v164, v56, v84
v_mfma_f32_16x16x32_bf16 v[168:171], a[108:111], a[76:79], v[168:171]
buffer_load_dwordx4 a[40:43], v2, s[40:43], s35 offen offset:1024 sc1
v_mfma_f32_16x16x32_bf16 v[144:147], a[108:111], a[68:71], v[144:147]
ds_read_b128 a[148:151], v5 offset:44032
v_fmac_f32 v188, v56, v86
v_mfma_f32_16x16x32_bf16 v[144:147], a[104:107], a[64:67], v[144:147]
v_mfma_f32_16x16x32_bf16 v[148:151], a[112:115], a[64:67], v[148:151]
v_fmac_f32 v212, v56, v88
v_mfma_f32_16x16x32_bf16 v[148:151], a[116:119], a[68:71], v[148:151]
buffer_load_dwordx4 v1, s[4:7], s44 offen offset:0 sc1 lds
v_mfma_f32_16x16x32_bf16 v[172:175], a[116:119], a[76:79], v[172:175]
v_fmac_f32 v216, v60, v88
v_mfma_f32_16x16x32_bf16 v[172:175], a[112:115], a[72:75], v[172:175]
v_mfma_f32_16x16x32_bf16 v[196:199], a[112:115], a[80:83], v[196:199]
v_fmac_f32 v192, v60, v86
v_mfma_f32_16x16x32_bf16 v[196:199], a[116:119], a[84:87], v[196:199]
buffer_load_dwordx4 a[44:47], v2, s[40:43], s33 offen offset:1024 sc1
v_mfma_f32_16x16x32_bf16 v[220:223], a[116:119], a[92:95], v[220:223]
v_fmac_f32 v168, v60, v84
v_fmac_f32 v141, v57, v82
v_mfma_f32_16x16x32_bf16 v[220:223], a[112:115], a[88:91], v[220:223]
s_waitcnt lgkmcnt(0)
s_barrier
v_mfma_f32_16x16x32_bf16 v[224:227], a[128:131], a[88:91], v[224:227]
v_add_u32 v5, 0, v1
v_fmac_f32 v144, v60, v82
v_mfma_f32_16x16x32_bf16 v[224:227], a[132:135], a[92:95], v[224:227]
buffer_load_dwordx4 a[48:51], v2, s[40:43], s35 offen offset:2048 sc1
v_mfma_f32_16x16x32_bf16 v[200:203], a[132:135], a[84:87], v[200:203]
ds_read_b128 a[96:99], v5 offset:2048
v_fmac_f32 v148, v64, v82
v_mfma_f32_16x16x32_bf16 v[200:203], a[128:131], a[80:83], v[200:203]
ds_read_b128 a[100:103], v5 offset:8192
v_fmac_f32 v165, v57, v84
v_mfma_f32_16x16x32_bf16 v[176:179], a[128:131], a[72:75], v[176:179]
v_fmac_f32 v172, v64, v84
v_fmac_f32 v189, v57, v86
v_mfma_f32_16x16x32_bf16 v[176:179], a[132:135], a[76:79], v[176:179]
buffer_load_dwordx4 a[52:55], v2, s[40:43], s33 offen offset:2048 sc1
v_mfma_f32_16x16x32_bf16 v[152:155], a[132:135], a[68:71], v[152:155]
ds_read_b128 a[104:107], v5 offset:3072
v_fmac_f32 v196, v64, v86
v_mfma_f32_16x16x32_bf16 v[152:155], a[128:131], a[64:67], v[152:155]
v_fmac_f32 v213, v57, v88
v_fmac_f32 v217, v61, v88
v_mfma_f32_16x16x32_bf16 v[132:135], a[136:139], a[64:67], v[132:135]
ds_read_b128 a[108:111], v5 offset:9216
v_fmac_f32 v220, v64, v88
v_mfma_f32_16x16x32_bf16 v[132:135], a[140:143], a[68:71], v[132:135]
v_fmac_f32 v193, v61, v86
v_mfma_f32_16x16x32_bf16 v[156:159], a[140:143], a[76:79], v[156:159]
buffer_load_dwordx4 v1, s[4:7], s44 offen offset:1024 sc1 lds
s_add_u32 m0, s19, 49152
v_mfma_f32_16x16x32_bf16 v[156:159], a[136:139], a[72:75], v[156:159]
s_add_u32 s44, s85, 0xc04000
ds_read_b128 a[112:115], v5 offset:4096
v_mfma_f32_16x16x32_bf16 v[180:183], a[136:139], a[80:83], v[180:183]
v_fmac_f32 v224, v68, v88
v_fmac_f32 v200, v68, v86
v_mfma_f32_16x16x32_bf16 v[180:183], a[140:143], a[84:87], v[180:183]
ds_read_b128 a[116:119], v5 offset:10240
v_fmac_f32 v169, v61, v84
v_mfma_f32_16x16x32_bf16 v[204:207], a[140:143], a[92:95], v[204:207]
v_fmac_f32 v176, v68, v84
v_fmac_f32 v145, v61, v82
v_mfma_f32_16x16x32_bf16 v[204:207], a[136:139], a[88:91], v[204:207]
buffer_load_dwordx4 a[56:59], v2, s[40:43], s35 offen offset:3072 sc1
v_mfma_f32_16x16x32_bf16 v[208:211], a[144:147], a[88:91], v[208:211]
v_fmac_f32 v152, v68, v82
v_fmac_f32 v149, v65, v82
v_mfma_f32_16x16x32_bf16 v[208:211], a[148:151], a[92:95], v[208:211]
v_fmac_f32 v173, v65, v84
v_mfma_f32_16x16x32_bf16 v[184:187], a[148:151], a[84:87], v[184:187]
v_fmac_f32 v132, v48, v82
v_fmac_f32 v197, v65, v86
v_mfma_f32_16x16x32_bf16 v[184:187], a[144:147], a[80:83], v[184:187]
v_mfma_f32_16x16x32_bf16 v[160:163], a[144:147], a[72:75], v[160:163]
buffer_load_dwordx4 a[60:63], v2, s[40:43], s33 offen offset:3072 sc1
s_add_u32 s35, s35, 0x4000
v_mfma_f32_16x16x32_bf16 v[160:163], a[148:151], a[76:79], v[160:163]
s_add_u32 s33, s33, 0x4000
v_fmac_f32 v156, v48, v84
v_mfma_f32_16x16x32_bf16 v[136:139], a[148:151], a[68:71], v[136:139]
v_fmac_f32 v180, v48, v86
v_fmac_f32 v221, v65, v88
v_mfma_f32_16x16x32_bf16 v[136:139], a[144:147], a[64:67], v[136:139]
v_fmac_f32 v225, v69, v88
s_waitcnt vmcnt(11) lgkmcnt(0)
v_mfma_f32_16x16x32_bf16 v[140:143], a[96:99], a[0:3], v[140:143]
ds_read_b128 a[128:131], v5 offset:5120
v_fmac_f32 v204, v48, v88
v_mfma_f32_16x16x32_bf16 v[140:143], a[100:103], a[4:7], v[140:143]
buffer_load_dwordx4 a[64:67], v2, s[40:43], s35 offen offset:0 sc1
s_lshl_b32 s36, s28, 9
v_mfma_f32_16x16x32_bf16 v[164:167], a[100:103], a[12:15], v[164:167]
ds_read_b128 a[132:135], v5 offset:11264
v_fmac_f32 v208, v52, v88
v_mfma_f32_16x16x32_bf16 v[164:167], a[96:99], a[8:11], v[164:167]
v_fmac_f32 v201, v69, v86
v_fmac_f32 v177, v69, v84
v_mfma_f32_16x16x32_bf16 v[188:191], a[96:99], a[16:19], v[188:191]
v_fmac_f32 v184, v52, v86
v_fmac_f32 v153, v69, v82
v_mfma_f32_16x16x32_bf16 v[188:191], a[100:103], a[20:23], v[188:191]
buffer_load_dwordx4 a[68:71], v2, s[40:43], s33 offen offset:0 sc1
s_lshl_b32 s37, s30, 2
v_mfma_f32_16x16x32_bf16 v[212:215], a[100:103], a[28:31], v[212:215]
ds_read_b128 a[136:139], v5 offset:0
v_fmac_f32 v160, v52, v84
v_mfma_f32_16x16x32_bf16 v[212:215], a[96:99], a[24:27], v[212:215]
v_fmac_f32 v133, v49, v82
s_add_u32 s37, s37, s28
v_mfma_f32_16x16x32_bf16 v[216:219], a[104:107], a[24:27], v[216:219]
ds_read_b128 a[140:143], v5 offset:6144
v_fmac_f32 v136, v52, v82
v_mfma_f32_16x16x32_bf16 v[216:219], a[108:111], a[28:31], v[216:219]
buffer_load_dwordx4 a[72:75], v2, s[40:43], s35 offen offset:1024 sc1
s_lshr_b32 s98, s37, 1
v_mfma_f32_16x16x32_bf16 v[192:195], a[108:111], a[20:23], v[192:195]
ds_read_b128 a[144:147], v5 offset:1024
v_fmac_f32 v157, v49, v84
v_mfma_f32_16x16x32_bf16 v[192:195], a[104:107], a[16:19], v[192:195]
v_fmac_f32 v181, v49, v86
v_fmac_f32 v142, v58, v82
v_mfma_f32_16x16x32_bf16 v[168:171], a[104:107], a[8:11], v[168:171]
v_fmac_f32 v205, v49, v88
v_fmac_f32 v166, v58, v84
v_mfma_f32_16x16x32_bf16 v[168:171], a[108:111], a[12:15], v[168:171]
buffer_load_dwordx4 a[76:79], v2, s[40:43], s33 offen offset:1024 sc1
s_lshl_b32 s98, s98, 14
v_mfma_f32_16x16x32_bf16 v[144:147], a[108:111], a[4:7], v[144:147]
ds_read_b128 a[148:151], v5 offset:7168
v_fmac_f32 v209, v53, v88
v_mfma_f32_16x16x32_bf16 v[144:147], a[104:107], a[0:3], v[144:147]
v_fmac_f32 v190, v58, v86
s_and_b32 s99, s19, 0x1000
v_mfma_f32_16x16x32_bf16 v[148:151], a[112:115], a[0:3], v[148:151]
v_fmac_f32 v185, v53, v86
v_fmac_f32 v214, v58, v88
v_mfma_f32_16x16x32_bf16 v[148:151], a[116:119], a[4:7], v[148:151]
buffer_load_dwordx4 a[80:83], v2, s[40:43], s35 offen offset:2048 sc1
s_add_u32 s98, s98, s99
v_mfma_f32_16x16x32_bf16 v[172:175], a[116:119], a[12:15], v[172:175]
v_fmac_f32 v161, v53, v84
v_fmac_f32 v218, v62, v88
v_mfma_f32_16x16x32_bf16 v[172:175], a[112:115], a[8:11], v[172:175]
v_add_u32 v232, s19, v7
s_lshl_b32 s90, s51, 13
v_mfma_f32_16x16x32_bf16 v[196:199], a[112:115], a[16:19], v[196:199]
v_fmac_f32 v137, v53, v82
v_fmac_f32 v194, v62, v86
v_mfma_f32_16x16x32_bf16 v[196:199], a[116:119], a[20:23], v[196:199]
buffer_load_dwordx4 a[84:87], v2, s[40:43], s33 offen offset:2048 sc1
s_add_u32 s98, s98, s90
v_mfma_f32_16x16x32_bf16 v[220:223], a[116:119], a[28:31], v[220:223]
v_fmac_f32 v170, v62, v84
v_fmac_f32 v143, v59, v82
v_mfma_f32_16x16x32_bf16 v[220:223], a[112:115], a[24:27], v[220:223]
s_add_u32 s98, s98, 0x400000
s_waitcnt lgkmcnt(0)
v_mfma_f32_16x16x32_bf16 v[224:227], a[128:131], a[24:27], v[224:227]
ds_read_b128 a[96:99], v5 offset:14336
v_fmac_f32 v146, v62, v82
v_mfma_f32_16x16x32_bf16 v[224:227], a[132:135], a[28:31], v[224:227]
buffer_load_dwordx4 a[88:91], v2, s[40:43], s35 offen offset:3072 sc1
s_xor_b32 s99, s98, 0x2000
v_mfma_f32_16x16x32_bf16 v[200:203], a[132:135], a[20:23], v[200:203]
ds_read_b128 a[100:103], v5 offset:20480
v_fmac_f32 v150, v66, v82
v_mfma_f32_16x16x32_bf16 v[200:203], a[128:131], a[16:19], v[200:203]
v_fmac_f32 v167, v59, v84
v_fmac_f32 v191, v59, v86
v_mfma_f32_16x16x32_bf16 v[176:179], a[128:131], a[8:11], v[176:179]
v_fmac_f32 v174, v66, v84
v_fmac_f32 v215, v59, v88
v_mfma_f32_16x16x32_bf16 v[176:179], a[132:135], a[12:15], v[176:179]
ds_read_b128 a[104:107], v5 offset:15360
s_and_b32 s91, s29, 4
v_mfma_f32_16x16x32_bf16 v[152:155], a[132:135], a[4:7], v[152:155]
v_fmac_f32 v198, v66, v86
v_fmac_f32 v219, v63, v88
v_mfma_f32_16x16x32_bf16 v[152:155], a[128:131], a[0:3], v[152:155]
buffer_load_dwordx4 v1, s[4:7], s44 offen offset:0 sc1 lds
s_lshl_b32 s91, s91, 11
v_mfma_f32_16x16x32_bf16 v[132:135], a[136:139], a[0:3], v[132:135]
ds_read_b128 a[108:111], v5 offset:21504
v_fmac_f32 v222, v66, v88
v_mfma_f32_16x16x32_bf16 v[132:135], a[140:143], a[4:7], v[132:135]
v_fmac_f32 v195, v63, v86
s_xor_b32 s96, s98, s91
v_mfma_f32_16x16x32_bf16 v[156:159], a[140:143], a[12:15], v[156:159]
ds_read_b128 a[112:115], v5 offset:16384
v_fmac_f32 v226, v70, v88
v_mfma_f32_16x16x32_bf16 v[156:159], a[136:139], a[8:11], v[156:159]
v_fmac_f32 v171, v63, v84
s_lshl_b32 s97, s81, 10
v_mfma_f32_16x16x32_bf16 v[180:183], a[136:139], a[16:19], v[180:183]
v_fmac_f32 v202, v70, v86
v_fmac_f32 v147, v63, v82
v_mfma_f32_16x16x32_bf16 v[180:183], a[140:143], a[20:23], v[180:183]
buffer_load_dwordx4 a[92:95], v2, s[40:43], s33 offen offset:3072 sc1
s_add_u32 s35, s35, 0x4000
v_mfma_f32_16x16x32_bf16 v[204:207], a[140:143], a[28:31], v[204:207]
s_add_u32 s33, s33, 0x4000
ds_read_b128 a[116:119], v5 offset:22528
v_mfma_f32_16x16x32_bf16 v[204:207], a[136:139], a[24:27], v[204:207]
v_fmac_f32 v178, v70, v84
v_fmac_f32 v151, v67, v82
v_mfma_f32_16x16x32_bf16 v[208:211], a[144:147], a[24:27], v[208:211]
v_fmac_f32 v154, v70, v82
v_fmac_f32 v175, v67, v84
v_mfma_f32_16x16x32_bf16 v[208:211], a[148:151], a[28:31], v[208:211]
s_add_u32 s96, s96, s97
s_lshr_b32 s100, s37, 4
s_lshl_b32 s100, s100, 14
v_mfma_f32_16x16x32_bf16 v[184:187], a[148:151], a[20:23], v[184:187]
v_fmac_f32 v134, v50, v82
v_fmac_f32 v199, v67, v86
v_mfma_f32_16x16x32_bf16 v[184:187], a[144:147], a[16:19], v[184:187]
buffer_load_dwordx4 v1, s[4:7], s44 offen offset:1024 sc1 lds
s_and_b32 s37, s37, 15
v_mfma_f32_16x16x32_bf16 v[160:163], a[144:147], a[8:11], v[160:163]
v_fmac_f32 v158, v50, v84
v_fmac_f32 v223, v67, v88
v_mfma_f32_16x16x32_bf16 v[160:163], a[148:151], a[12:15], v[160:163]
s_lshl_b32 s37, s37, 9
s_add_u32 s100, s100, s37
s_add_u32 s100, s100, 0x800000
v_mfma_f32_16x16x32_bf16 v[136:139], a[148:151], a[4:7], v[136:139]
v_fmac_f32 v182, v50, v86
v_fmac_f32 v227, v71, v88
v_mfma_f32_16x16x32_bf16 v[136:139], a[144:147], a[0:3], v[136:139]
s_waitcnt vmcnt(10) lgkmcnt(0)
s_barrier
v_mfma_f32_16x16x32_bf16 v[140:143], a[96:99], a[32:35], v[140:143]
ds_read_b128 a[128:131], v5 offset:17408
v_fmac_f32 v206, v50, v88
v_mfma_f32_16x16x32_bf16 v[140:143], a[100:103], a[36:39], v[140:143]
buffer_load_dwordx4 a[0:3], v2, s[40:43], s35 offen offset:0 sc1
s_xor_b32 s91, s91, s90
v_mfma_f32_16x16x32_bf16 v[164:167], a[100:103], a[44:47], v[164:167]
ds_read_b128 a[132:135], v5 offset:23552
v_fmac_f32 v210, v54, v88
v_mfma_f32_16x16x32_bf16 v[164:167], a[96:99], a[40:43], v[164:167]
v_fmac_f32 v203, v71, v86
v_fmac_f32 v179, v71, v84
v_mfma_f32_16x16x32_bf16 v[188:191], a[96:99], a[48:51], v[188:191]
buffer_load_dwordx4 a[4:7], v2, s[40:43], s33 offen offset:0 sc1
s_lshl_b32 s97, s81, 7
v_mfma_f32_16x16x32_bf16 v[188:191], a[100:103], a[52:55], v[188:191]
ds_read_b128 a[136:139], v5 offset:26624
v_fmac_f32 v186, v54, v86
v_mfma_f32_16x16x32_bf16 v[212:215], a[100:103], a[60:63], v[212:215]
v_fmac_f32 v162, v54, v84
v_fmac_f32 v155, v71, v82
v_mfma_f32_16x16x32_bf16 v[212:215], a[96:99], a[56:59], v[212:215]
buffer_load_dwordx4 a[8:11], v2, s[40:43], s35 offen offset:1024 sc1
s_add_u32 s97, s97, s91
v_mfma_f32_16x16x32_bf16 v[216:219], a[104:107], a[56:59], v[216:219]
ds_read_b128 a[140:143], v5 offset:32768
v_fmac_f32 v138, v54, v82
v_mfma_f32_16x16x32_bf16 v[216:219], a[108:111], a[60:63], v[216:219]
v_fmac_f32 v135, v51, v82
v_fmac_f32 v159, v51, v84
v_mfma_f32_16x16x32_bf16 v[192:195], a[108:111], a[52:55], v[192:195]
buffer_load_dwordx4 a[12:15], v2, s[40:43], s33 offen offset:1024 sc1
s_add_u32 s97, s97, s100
v_mfma_f32_16x16x32_bf16 v[192:195], a[104:107], a[48:51], v[192:195]
ds_read_b128 a[144:147], v5 offset:27648
v_fmac_f32 v183, v51, v86
v_mfma_f32_16x16x32_bf16 v[168:171], a[104:107], a[40:43], v[168:171]
v_fmac_f32 v207, v51, v88
s_bfe_u32 s37, s30, 0x10002
v_mfma_f32_16x16x32_bf16 v[168:171], a[108:111], a[44:47], v[168:171]
buffer_load_dwordx4 a[16:19], v2, s[40:43], s35 offen offset:2048 sc1
s_xor_b32 s37, s37, s51
v_mfma_f32_16x16x32_bf16 v[144:147], a[108:111], a[36:39], v[144:147]
ds_read_b128 a[148:151], v5 offset:33792
v_fmac_f32 v211, v55, v88
v_mfma_f32_16x16x32_bf16 v[144:147], a[104:107], a[32:35], v[144:147]
s_lshr_b32 s89, s29, 2
s_xor_b32 s89, s89, s37
s_lshl_b32 s88, s28, 6
v_mfma_f32_16x16x32_bf16 v[148:151], a[112:115], a[32:35], v[148:151]
buffer_load_dwordx4 a[20:23], v2, s[40:43], s33 offen offset:2048 sc1
s_add_u32 s94, s80, s88
v_mfma_f32_16x16x32_bf16 v[148:151], a[116:119], a[36:39], v[148:151]
v_fmac_f32 v187, v55, v86
s_add_u32 s94, s94, 0x80000
v_mfma_f32_16x16x32_bf16 v[172:175], a[116:119], a[44:47], v[172:175]
v_fmac_f32 v163, v55, v84
v_mul_f32 v86, 0x3fb8aa3b, v87
v_mfma_f32_16x16x32_bf16 v[172:175], a[112:115], a[40:43], v[172:175]
buffer_load_dwordx4 a[24:27], v2, s[40:43], s35 offen offset:3072 sc1
s_mul_i32 s89, s89, 0x1a00000
v_mfma_f32_16x16x32_bf16 v[196:199], a[112:115], a[48:51], v[196:199]
v_fmac_f32 v139, v55, v82
v_mul_f32 v84, 0x3fb8aa3b, v85
v_mfma_f32_16x16x32_bf16 v[196:199], a[116:119], a[52:55], v[196:199]
v_mul_f32 v82, 0x3fb8aa3b, v83
s_add_u32 s88, s88, s70
v_mfma_f32_16x16x32_bf16 v[220:223], a[116:119], a[60:63], v[220:223]
buffer_load_dwordx4 a[28:31], v2, s[40:43], s33 offen offset:3072 sc1
s_add_u32 s35, s35, 0x64000
v_mfma_f32_16x16x32_bf16 v[220:223], a[112:115], a[56:59], v[220:223]
s_add_u32 s33, s33, 0x64000
s_waitcnt lgkmcnt(0)
v_mfma_f32_16x16x32_bf16 v[224:227], a[128:131], a[56:59], v[224:227]
ds_read_b128 a[96:99], v5 offset:28672
v_mul_f32 v88, 0x3fb8aa3b, v89
v_mfma_f32_16x16x32_bf16 v[224:227], a[132:135], a[60:63], v[224:227]
buffer_load_dwordx4 v1, s[4:7], s44 offen offset:2048 sc1 lds
s_add_u32 s88, s88, s89
v_mfma_f32_16x16x32_bf16 v[200:203], a[132:135], a[52:55], v[200:203]
ds_read_b128 a[100:103], v5 offset:34816
s_add_u32 s89, s88, 0x80000
v_mfma_f32_16x16x32_bf16 v[200:203], a[128:131], a[48:51], v[200:203]
s_add_u32 s74, s71, 0x10080
s_add_u32 s72, s79, 0x2800000
s_add_u32 s73, s79, 0x2400000
v_mfma_f32_16x16x32_bf16 v[176:179], a[128:131], a[40:43], v[176:179]
s_lshr_b32 s38, s28, 1
s_and_b32 s39, s28, 1
s_mul_i32 s38, s38, 3072
v_mfma_f32_16x16x32_bf16 v[176:179], a[132:135], a[44:47], v[176:179]
ds_read_b128 a[104:107], v5 offset:29696
s_lshl_b32 s39, s39, 3
v_mfma_f32_16x16x32_bf16 v[152:155], a[132:135], a[36:39], v[152:155]
s_add_u32 s38, s38, s39
s_add_u32 s91, s83, 0x980000
v_mfma_f32_16x16x32_bf16 v[152:155], a[128:131], a[32:35], v[152:155]
v_add_u32 v233, s19, v232
v_and_b32 v248, 4, v0
s_waitcnt vmcnt(18)
v_mfma_f32_16x16x32_bf16 v[140:143], a[136:139], a[64:67], v[140:143]
ds_read_b128 a[108:111], v5 offset:35840
v_lshlrev_b32 v248, 11, v248
s_waitcnt vmcnt(17)
v_mfma_f32_16x16x32_bf16 v[140:143], a[140:143], a[68:71], v[140:143]
v_bfe_u32 v235, v0, 2, 1
v_xor_b32 v248, s90, v248
s_waitcnt vmcnt(15)
v_mfma_f32_16x16x32_bf16 v[164:167], a[140:143], a[76:79], v[164:167]
ds_read_b128 a[112:115], v5 offset:38912
v_and_b32 v249, 3, v0
v_mfma_f32_16x16x32_bf16 v[164:167], a[136:139], a[72:75], v[164:167]
v_xor_b32 v235, s37, v235
v_lshl_add_u32 v248, v249, 7, v248
s_waitcnt vmcnt(14)
v_mfma_f32_16x16x32_bf16 v[188:191], a[136:139], a[80:83], v[188:191]
v_mul_u32_u24 v235, 106496, v235
v_lshrrev_b32 v249, 4, v0
s_waitcnt vmcnt(13)
v_mfma_f32_16x16x32_bf16 v[188:191], a[140:143], a[84:87], v[188:191]
buffer_load_dwordx4 v1, s[4:7], s44 offen offset:3072 sc1 lds
s_add_u32 m0, s19, 65536
s_waitcnt vmcnt(11)
v_mfma_f32_16x16x32_bf16 v[212:215], a[140:143], a[92:95], v[212:215]
s_add_u32 s44, s84, 0xc08000
ds_read_b128 a[116:119], v5 offset:45056
v_mfma_f32_16x16x32_bf16 v[212:215], a[136:139], a[88:91], v[212:215]
v_add_lshl_u32 v235, v235, v0, 8
v_lshl_add_u32 v248, v249, 4, v248
v_mfma_f32_16x16x32_bf16 v[216:219], a[144:147], a[88:91], v[216:219]
v_add_u32 v234, s36, v8
v_cndmask_b32 v235, 2.0, v235, s[64:65]
v_mfma_f32_16x16x32_bf16 v[216:219], a[148:151], a[92:95], v[216:219]
v_mov_b32 v249, 0x3f80
v_mov_b32 v250, 1.0
v_mfma_f32_16x16x32_bf16 v[192:195], a[148:151], a[84:87], v[192:195]
v_add_u32 v252, s38, v1
v_mfma_f32_16x16x32_bf16 v[192:195], a[144:147], a[80:83], v[192:195]
v_mfma_f32_16x16x32_bf16 v[168:171], a[144:147], a[72:75], v[168:171]
v_mfma_f32_16x16x32_bf16 v[168:171], a[148:151], a[76:79], v[168:171]
v_mfma_f32_16x16x32_bf16 v[144:147], a[148:151], a[68:71], v[144:147]
v_mfma_f32_16x16x32_bf16 v[144:147], a[144:147], a[64:67], v[144:147]
s_waitcnt lgkmcnt(0)
v_mfma_f32_16x16x32_bf16 v[148:151], a[96:99], a[64:67], v[148:151]
ds_read_b128 a[128:131], v5 offset:39936
v_mfma_f32_16x16x32_bf16 v[148:151], a[100:103], a[68:71], v[148:151]
buffer_load_dwordx4 v1, s[4:7], s44 offen offset:0 sc1 lds
v_mfma_f32_16x16x32_bf16 v[172:175], a[100:103], a[76:79], v[172:175]
ds_read_b128 a[132:135], v5 offset:46080
v_mfma_f32_16x16x32_bf16 v[172:175], a[96:99], a[72:75], v[172:175]
v_mfma_f32_16x16x32_bf16 v[196:199], a[96:99], a[80:83], v[196:199]
v_mfma_f32_16x16x32_bf16 v[196:199], a[100:103], a[84:87], v[196:199]
buffer_load_dwordx4 v1, s[4:7], s44 offen offset:1024 sc1 lds
v_mfma_f32_16x16x32_bf16 v[220:223], a[100:103], a[92:95], v[220:223]
ds_read_b128 a[136:139], v5 offset:40960
v_mfma_f32_16x16x32_bf16 v[220:223], a[96:99], a[88:91], v[220:223]
v_mfma_f32_16x16x32_bf16 v[224:227], a[104:107], a[88:91], v[224:227]
ds_read_b128 a[140:143], v5 offset:47104
v_mfma_f32_16x16x32_bf16 v[224:227], a[108:111], a[92:95], v[224:227]
v_mfma_f32_16x16x32_bf16 v[200:203], a[108:111], a[84:87], v[200:203]
buffer_load_dwordx4 v1, s[4:7], s44 offen offset:2048 sc1 lds
v_mfma_f32_16x16x32_bf16 v[200:203], a[104:107], a[80:83], v[200:203]
ds_read_b128 a[144:147], v5 offset:41984
v_mfma_f32_16x16x32_bf16 v[176:179], a[104:107], a[72:75], v[176:179]
v_mfma_f32_16x16x32_bf16 v[176:179], a[108:111], a[76:79], v[176:179]
ds_read_b128 a[148:151], v5 offset:48128
v_mfma_f32_16x16x32_bf16 v[152:155], a[108:111], a[68:71], v[152:155]
v_mfma_f32_16x16x32_bf16 v[152:155], a[104:107], a[64:67], v[152:155]
buffer_load_dwordx4 v1, s[4:7], s44 offen offset:3072 sc1 lds
s_add_u32 m0, s19, 81920
s_waitcnt vmcnt(13)
v_mfma_f32_16x16x32_bf16 v[140:143], a[112:115], a[0:3], v[140:143]
s_add_u32 s44, s85, 0xc0c000
s_waitcnt vmcnt(12)
v_mfma_f32_16x16x32_bf16 v[140:143], a[116:119], a[4:7], v[140:143]
s_waitcnt vmcnt(10)
v_mfma_f32_16x16x32_bf16 v[164:167], a[116:119], a[12:15], v[164:167]
v_mfma_f32_16x16x32_bf16 v[164:167], a[112:115], a[8:11], v[164:167]
s_waitcnt vmcnt(9)
v_mfma_f32_16x16x32_bf16 v[188:191], a[112:115], a[16:19], v[188:191]
buffer_load_dwordx4 v1, s[4:7], s44 offen offset:0 sc1 lds
s_waitcnt vmcnt(9)
v_mfma_f32_16x16x32_bf16 v[188:191], a[116:119], a[20:23], v[188:191]
s_waitcnt vmcnt(7)
v_mfma_f32_16x16x32_bf16 v[212:215], a[116:119], a[28:31], v[212:215]
v_mfma_f32_16x16x32_bf16 v[212:215], a[112:115], a[24:27], v[212:215]
s_waitcnt lgkmcnt(0)
v_mfma_f32_16x16x32_bf16 v[216:219], a[128:131], a[24:27], v[216:219]
ds_read_b128 a[96:99], v5 offset:12288
v_cvt_pk_bf16_f32 v140, v140, v141
v_mfma_f32_16x16x32_bf16 v[216:219], a[132:135], a[28:31], v[216:219]
buffer_load_dwordx4 v1, s[4:7], s44 offen offset:1024 sc1 lds
v_mfma_f32_16x16x32_bf16 v[192:195], a[132:135], a[20:23], v[192:195]
ds_read_b128 a[100:103], v5 offset:18432
v_cvt_pk_bf16_f32 v141, v142, v143
v_mfma_f32_16x16x32_bf16 v[192:195], a[128:131], a[16:19], v[192:195]
v_cvt_pk_bf16_f32 v164, v164, v165
v_cvt_pk_bf16_f32 v165, v166, v167
v_mfma_f32_16x16x32_bf16 v[168:171], a[128:131], a[8:11], v[168:171]
v_cvt_pk_bf16_f32 v188, v188, v189
v_cvt_pk_bf16_f32 v189, v190, v191
v_mfma_f32_16x16x32_bf16 v[168:171], a[132:135], a[12:15], v[168:171]
buffer_load_dwordx4 v1, s[4:7], s44 offen offset:2048 sc1 lds
v_mfma_f32_16x16x32_bf16 v[144:147], a[132:135], a[4:7], v[144:147]
ds_read_b128 a[104:107], v5 offset:24576
v_cvt_pk_bf16_f32 v212, v212, v213
v_mfma_f32_16x16x32_bf16 v[144:147], a[128:131], a[0:3], v[144:147]
v_cvt_pk_bf16_f32 v213, v214, v215
v_mfma_f32_16x16x32_bf16 v[148:151], a[136:139], a[0:3], v[148:151]
ds_read_b128 a[108:111], v5 offset:30720
v_cvt_pk_bf16_f32 v214, v216, v217
v_mfma_f32_16x16x32_bf16 v[148:151], a[140:143], a[4:7], v[148:151]
v_cvt_pk_bf16_f32 v215, v218, v219
v_mfma_f32_16x16x32_bf16 v[172:175], a[140:143], a[12:15], v[172:175]
buffer_load_dwordx4 v1, s[4:7], s44 offen offset:3072 sc1 lds
s_add_u32 m0, s19, 147456
v_mfma_f32_16x16x32_bf16 v[172:175], a[136:139], a[8:11], v[172:175]
s_add_u32 s44, s87, 0xc1c000
ds_read_b128 a[112:115], v5 offset:36864
v_mfma_f32_16x16x32_bf16 v[196:199], a[136:139], a[16:19], v[196:199]
v_cvt_pk_bf16_f32 v166, v168, v169
v_cvt_pk_bf16_f32 v167, v170, v171
v_mfma_f32_16x16x32_bf16 v[196:199], a[140:143], a[20:23], v[196:199]
ds_read_b128 a[116:119], v5 offset:43008
v_cvt_pk_bf16_f32 v190, v192, v193
v_mfma_f32_16x16x32_bf16 v[220:223], a[140:143], a[28:31], v[220:223]
v_cvt_pk_bf16_f32 v142, v144, v145
v_cvt_pk_bf16_f32 v143, v146, v147
v_mfma_f32_16x16x32_bf16 v[220:223], a[136:139], a[24:27], v[220:223]
buffer_load_dwordx4 v1, s[4:7], s44 offen offset:0 sc1 lds
v_mfma_f32_16x16x32_bf16 v[224:227], a[144:147], a[24:27], v[224:227]
v_mfma_f32_16x16x32_bf16 v[92:95], a[240:243], v[140:143], 0
v_mfma_f32_16x16x32_bf16 v[224:227], a[148:151], a[28:31], v[224:227]
v_mfma_f32_16x16x32_bf16 v[96:99], a[244:247], v[140:143], 0
v_mfma_f32_16x16x32_bf16 v[200:203], a[148:151], a[20:23], v[200:203]
v_mfma_f32_16x16x32_bf16 v[100:103], a[240:243], v[164:167], 0
v_mfma_f32_16x16x32_bf16 v[200:203], a[144:147], a[16:19], v[200:203]
v_mfma_f32_16x16x32_bf16 v[104:107], a[244:247], v[164:167], 0
v_mfma_f32_16x16x32_bf16 v[176:179], a[144:147], a[8:11], v[176:179]
buffer_load_dwordx4 v1, s[4:7], s44 offen offset:1024 sc1 lds
v_mfma_f32_16x16x32_bf16 v[176:179], a[148:151], a[12:15], v[176:179]
v_max3_f32 v236, v92, v93, v94
v_max3_f32 v237, -v92, -v93, -v94
v_mfma_f32_16x16x32_bf16 v[152:155], a[148:151], a[4:7], v[152:155]
v_max3_f32 v236, v236, v95, v96
v_max3_f32 v237, v237, -v95, -v96
v_mfma_f32_16x16x32_bf16 v[152:155], a[144:147], a[0:3], v[152:155]
v_max3_f32 v236, v236, v97, v98
s_waitcnt lgkmcnt(0)
v_mfma_f32_16x16x32_bf16 v[132:135], a[96:99], a[32:35], v[132:135]
ds_read_b128 a[128:131], v5 offset:13312
v_max3_f32 v237, v237, -v97, -v98
v_mfma_f32_16x16x32_bf16 v[132:135], a[100:103], a[36:39], v[132:135]
buffer_load_dwordx4 v1, s[4:7], s44 offen offset:2048 sc1 lds
v_mfma_f32_16x16x32_bf16 v[156:159], a[100:103], a[44:47], v[156:159]
ds_read_b128 a[132:135], v5 offset:19456
v_max_f32 v236, v236, v99
v_mfma_f32_16x16x32_bf16 v[156:159], a[96:99], a[40:43], v[156:159]
v_max_f32_e64 v237, v237, -v99
v_max3_f32 v238, v100, v101, v102
v_mfma_f32_16x16x32_bf16 v[180:183], a[96:99], a[48:51], v[180:183]
v_permlane32_swap_b32 v236, v237
v_mfma_f32_16x16x32_bf16 v[180:183], a[100:103], a[52:55], v[180:183]
buffer_load_dwordx4 v1, s[4:7], s44 offen offset:3072 sc1 lds
s_add_u32 m0, s19, 98304
v_mfma_f32_16x16x32_bf16 v[204:207], a[100:103], a[60:63], v[204:207]
s_add_u32 s44, s84, 0xc10000
ds_read_b128 a[136:139], v5 offset:25600
v_mfma_f32_16x16x32_bf16 v[204:207], a[96:99], a[56:59], v[204:207]
v_max_f32 v236, v236, v237
v_mov_b32 v244, v236
v_mfma_f32_16x16x32_bf16 v[204:207], a[104:107], a[88:91], v[204:207]
ds_read_b128 a[140:143], v5 offset:31744
v_max3_f32 v239, -v100, -v101, -v102
v_mfma_f32_16x16x32_bf16 v[204:207], a[108:111], a[92:95], v[204:207]
v_permlane16_swap_b32 v236, v244
v_mfma_f32_16x16x32_bf16 v[180:183], a[108:111], a[84:87], v[180:183]
buffer_load_dwordx4 v1, s[4:7], s44 offen offset:0 sc1 lds
v_mfma_f32_16x16x32_bf16 v[180:183], a[104:107], a[80:83], v[180:183]
ds_read_b128 a[144:147], v5 offset:37888
v_max_f32 v236, v236, v244
v_mfma_f32_16x16x32_bf16 v[156:159], a[104:107], a[72:75], v[156:159]
v_mov_b32 v244, v236
v_max3_f32 v238, v238, v103, v104
v_mfma_f32_16x16x32_bf16 v[156:159], a[108:111], a[76:79], v[156:159]
ds_read_b128 a[148:151], v5 offset:44032
v_max3_f32 v239, v239, -v103, -v104
v_mfma_f32_16x16x32_bf16 v[132:135], a[108:111], a[68:71], v[132:135]
v_permlane32_swap_b32 v236, v244
v_mfma_f32_16x16x32_bf16 v[132:135], a[104:107], a[64:67], v[132:135]
buffer_load_dwordx4 v1, s[4:7], s44 offen offset:1024 sc1 lds
v_mfma_f32_16x16x32_bf16 v[132:135], a[112:115], a[0:3], v[132:135]
v_mul_f32_e64 v236, -v236, v82
v_mul_f32_e64 v237, -v244, v82
v_mfma_f32_16x16x32_bf16 v[132:135], a[116:119], a[4:7], v[132:135]
L_stub7:
s_cbranch_execz L_stub8
v_max3_f32 v238, v238, v105, v106
v_max3_f32 v239, v239, -v105, -v106
v_mfma_f32_16x16x32_bf16 v[156:159], a[116:119], a[12:15], v[156:159]
v_max_f32 v238, v238, v107
v_max_f32_e64 v239, v239, -v107
v_mfma_f32_16x16x32_bf16 v[156:159], a[112:115], a[8:11], v[156:159]
s_nop 0
v_permlane32_swap_b32 v238, v239
v_mfma_f32_16x16x32_bf16 v[180:183], a[112:115], a[16:19], v[180:183]
buffer_load_dwordx4 v1, s[4:7], s44 offen offset:2048 sc1 lds
v_mfma_f32_16x16x32_bf16 v[180:183], a[116:119], a[20:23], v[180:183]
v_max_f32 v238, v238, v239
v_mov_b32 v245, v238
v_mfma_f32_16x16x32_bf16 v[204:207], a[116:119], a[28:31], v[204:207]
s_nop 0
v_permlane16_swap_b32 v238, v245
v_mfma_f32_16x16x32_bf16 v[204:207], a[112:115], a[24:27], v[204:207]
s_waitcnt lgkmcnt(0)
s_barrier
v_mfma_f32_16x16x32_bf16 v[208:211], a[128:131], a[56:59], v[208:211]
v_max_f32 v238, v238, v245
v_mov_b32 v245, v238
v_mfma_f32_16x16x32_bf16 v[208:211], a[132:135], a[60:63], v[208:211]
buffer_load_dwordx4 v1, s[4:7], s44 offen offset:3072 sc1 lds
s_add_u32 m0, s19, 114688
v_mfma_f32_16x16x32_bf16 v[184:187], a[132:135], a[52:55], v[184:187]
s_add_u32 s44, s85, 0xc14000
v_cvt_pk_bf16_f32 v191, v194, v195
v_mfma_f32_16x16x32_bf16 v[184:187], a[128:131], a[48:51], v[184:187]
v_permlane32_swap_b32 v238, v245
v_mfma_f32_16x16x32_bf16 v[160:163], a[128:131], a[40:43], v[160:163]
v_mul_f32_e64 v238, -v238, v84
v_mul_f32_e64 v239, -v245, v84
v_mfma_f32_16x16x32_bf16 v[160:163], a[132:135], a[44:47], v[160:163]
buffer_load_dwordx4 v1, s[4:7], s44 offen offset:0 sc1 lds
v_mfma_f32_16x16x32_bf16 v[136:139], a[132:135], a[36:39], v[136:139]
v_mfma_f32_16x16x32_bf16 v[108:111], a[240:243], v[188:191], 0
v_mfma_f32_16x16x32_bf16 v[136:139], a[128:131], a[32:35], v[136:139]
v_mfma_f32_16x16x32_bf16 v[112:115], a[244:247], v[188:191], 0
v_mfma_f32_16x16x32_bf16 v[136:139], a[136:139], a[64:67], v[136:139]
v_mfma_f32_16x16x32_bf16 v[116:119], a[240:243], v[212:215], 0
v_mfma_f32_16x16x32_bf16 v[136:139], a[140:143], a[68:71], v[136:139]
v_mfma_f32_16x16x32_bf16 v[120:123], a[244:247], v[212:215], 0
v_mfma_f32_16x16x32_bf16 v[160:163], a[140:143], a[76:79], v[160:163]
buffer_load_dwordx4 v1, s[4:7], s44 offen offset:1024 sc1 lds
v_mfma_f32_16x16x32_bf16 v[160:163], a[136:139], a[72:75], v[160:163]
v_max3_f32 v240, v108, v109, v110
v_max3_f32 v241, -v108, -v109, -v110
v_mfma_f32_16x16x32_bf16 v[184:187], a[136:139], a[80:83], v[184:187]
v_max3_f32 v240, v240, v111, v112
v_max3_f32 v241, v241, -v111, -v112
v_mfma_f32_16x16x32_bf16 v[184:187], a[140:143], a[84:87], v[184:187]
v_max3_f32 v240, v240, v113, v114
v_max3_f32 v241, v241, -v113, -v114
v_mfma_f32_16x16x32_bf16 v[208:211], a[140:143], a[92:95], v[208:211]
v_max_f32 v240, v240, v115
v_max_f32_e64 v241, v241, -v115
v_mfma_f32_16x16x32_bf16 v[208:211], a[136:139], a[88:91], v[208:211]
buffer_load_dwordx4 v1, s[4:7], s44 offen offset:2048 sc1 lds
v_mfma_f32_16x16x32_bf16 v[208:211], a[144:147], a[24:27], v[208:211]
v_permlane32_swap_b32 v240, v241
v_mfma_f32_16x16x32_bf16 v[208:211], a[148:151], a[28:31], v[208:211]
v_max_f32 v240, v240, v241
v_mov_b32 v246, v240
v_mfma_f32_16x16x32_bf16 v[184:187], a[148:151], a[20:23], v[184:187]
s_nop 0
v_permlane16_swap_b32 v240, v246
v_mfma_f32_16x16x32_bf16 v[184:187], a[144:147], a[16:19], v[184:187]
v_max_f32 v240, v240, v246
v_mov_b32 v246, v240
v_mfma_f32_16x16x32_bf16 v[160:163], a[144:147], a[8:11], v[160:163]
buffer_load_dwordx4 v1, s[4:7], s44 offen offset:3072 sc1 lds
v_mfma_f32_16x16x32_bf16 v[160:163], a[148:151], a[12:15], v[160:163]
v_permlane32_swap_b32 v240, v246
v_mfma_f32_16x16x32_bf16 v[136:139], a[148:151], a[4:7], v[136:139]
v_mul_f32_e64 v240, -v240, v86
v_mul_f32_e64 v241, -v246, v86
v_mfma_f32_16x16x32_bf16 v[136:139], a[144:147], a[0:3], v[136:139]
v_max3_f32 v242, v116, v117, v118
v_max3_f32 v243, -v116, -v117, -v118
v_pk_mul_f32 v[148:149], v[148:149], v[82:83] op_sel:[0,1] op_sel_hi:[1,1]
v_pk_mul_f32 v[150:151], v[150:151], v[82:83] op_sel:[0,1] op_sel_hi:[1,1]
v_cvt_pk_bf16_f32 v148, v148, v149
v_cvt_pk_bf16_f32 v149, v150, v151
ds_write_b64 v232, v[148:149] offset:0
v_pk_mul_f32 v[152:153], v[152:153], v[82:83] op_sel:[0,1] op_sel_hi:[1,1]
v_pk_mul_f32 v[154:155], v[154:155], v[82:83] op_sel:[0,1] op_sel_hi:[1,1]
v_cvt_pk_bf16_f32 v150, v152, v153
v_cvt_pk_bf16_f32 v151, v154, v155
v_pk_mul_f32 v[172:173], v[172:173], v[84:85] op_sel:[0,1] op_sel_hi:[1,1]
v_pk_mul_f32 v[174:175], v[174:175], v[84:85] op_sel:[0,1] op_sel_hi:[1,1]
v_cvt_pk_bf16_f32 v172, v172, v173
buffer_store_dwordx4 a[248:251], v254, s[4:7], s97 offen offset:0 sc1
v_cvt_pk_bf16_f32 v173, v174, v175
ds_write_b64 v232, v[150:151] offset:512
v_pk_mul_f32 v[176:177], v[176:177], v[84:85] op_sel:[0,1] op_sel_hi:[1,1]
v_pk_mul_f32 v[178:179], v[178:179], v[84:85] op_sel:[0,1] op_sel_hi:[1,1]
v_cvt_pk_bf16_f32 v174, v176, v177
v_cvt_pk_bf16_f32 v175, v178, v179
v_pk_mul_f32 v[196:197], v[196:197], v[86:87] op_sel:[0,1] op_sel_hi:[1,1]
v_pk_mul_f32 v[198:199], v[198:199], v[86:87] op_sel:[0,1] op_sel_hi:[1,1]
v_cvt_pk_bf16_f32 v196, v196, v197
v_cvt_pk_bf16_f32 v197, v198, v199
v_pk_mul_f32 v[200:201], v[200:201], v[86:87] op_sel:[0,1] op_sel_hi:[1,1]
v_pk_mul_f32 v[202:203], v[202:203], v[86:87] op_sel:[0,1] op_sel_hi:[1,1]
v_cvt_pk_bf16_f32 v198, v200, v201
v_cvt_pk_bf16_f32 v199, v202, v203
ds_write_b64 v232, v[172:173] offset:1024
v_pk_mul_f32 v[220:221], v[220:221], v[88:89] op_sel:[0,1] op_sel_hi:[1,1]
v_pk_mul_f32 v[222:223], v[222:223], v[88:89] op_sel:[0,1] op_sel_hi:[1,1]
v_cvt_pk_bf16_f32 v220, v220, v221
v_cvt_pk_bf16_f32 v221, v222, v223
v_pk_fma_f32 v[48:49], v[92:93], v[82:83], v[236:237] op_sel:[0,0,0] op_sel_hi:[1,0,0]
v_pk_fma_f32 v[50:51], v[94:95], v[82:83], v[236:237] op_sel:[0,0,0] op_sel_hi:[1,0,0]
v_pk_fma_f32 v[52:53], v[96:97], v[82:83], v[236:237] op_sel:[0,0,0] op_sel_hi:[1,0,0]
v_pk_fma_f32 v[54:55], v[98:99], v[82:83], v[236:237] op_sel:[0,0,0] op_sel_hi:[1,0,0]
v_exp_f32 v48, v48
v_exp_f32 v49, v49
ds_write_b64 v232, v[174:175] offset:1536
buffer_store_dwordx4 a[248:251], v1, s[4:7], s96 offen offset:0 sc1
v_exp_f32 v50, v50
v_exp_f32 v51, v51
v_exp_f32 v52, v52
v_exp_f32 v53, v53
ds_write_b64 v232, v[196:197] offset:2048
v_exp_f32 v54, v54
v_exp_f32 v55, v55
v_cvt_pk_bf16_f32 v140, v48, v49
v_cvt_pk_bf16_f32 v141, v50, v51
v_cvt_pk_bf16_f32 v142, v52, v53
v_cvt_pk_bf16_f32 v143, v54, v55
v_pk_mul_f32 v[224:225], v[224:225], v[88:89] op_sel:[0,1] op_sel_hi:[1,1]
v_pk_mul_f32 v[226:227], v[226:227], v[88:89] op_sel:[0,1] op_sel_hi:[1,1]
v_cvt_pk_bf16_f32 v222, v224, v225
v_mfma_f32_16x16x32_bf16 v[148:151], v[16:19], v[140:143], 0
ds_write_b64 v232, v[198:199] offset:2560
v_cvt_pk_bf16_f32 v223, v226, v227
s_add_u32 m0, s19, 131072
v_pk_fma_f32 v[92:93], v[92:93], v[82:83], v[236:237] op_sel:[0,0,1] op_sel_hi:[1,0,1] neg_lo:[1,0,0] neg_hi:[1,0,0]
v_pk_fma_f32 v[94:95], v[94:95], v[82:83], v[236:237] op_sel:[0,0,1] op_sel_hi:[1,0,1] neg_lo:[1,0,0] neg_hi:[1,0,0]
v_pk_fma_f32 v[96:97], v[96:97], v[82:83], v[236:237] op_sel:[0,0,1] op_sel_hi:[1,0,1] neg_lo:[1,0,0] neg_hi:[1,0,0]
s_nop 1
v_rcp_f32 v148, v148
buffer_store_dwordx4 a[248:251], v3, s[4:7], s91 offen offset:0 sc1
v_pk_mul_f32 v[48:49], v[48:49], v[148:149] op_sel:[0,0] op_sel_hi:[1,0]
ds_write_b64 v232, v[220:221] offset:3072
v_pk_mul_f32 v[50:51], v[50:51], v[148:149] op_sel:[0,0] op_sel_hi:[1,0]
v_cvt_pk_bf16_f32 v140, v48, v49
v_cvt_pk_bf16_f32 v141, v50, v51
v_pk_fma_f32 v[98:99], v[98:99], v[82:83], v[236:237] op_sel:[0,0,1] op_sel_hi:[1,0,1] neg_lo:[1,0,0] neg_hi:[1,0,0]
v_exp_f32 v92, v92
v_exp_f32 v93, v93
buffer_store_dwordx4 a[248:251], v3, s[4:7], s91 offen offset:1024 sc1
ds_write_b64 v232, v[222:223] offset:3584
v_exp_f32 v94, v94
v_exp_f32 v95, v95
v_exp_f32 v96, v96
v_exp_f32 v97, v97
v_exp_f32 v98, v98
v_exp_f32 v99, v99
ds_write_b64 v233, v[140:141] offset:16384
s_add_u32 s44, s86, 0xc18000
v_cvt_pk_bf16_f32 v144, v92, v93
v_cvt_pk_bf16_f32 v145, v94, v95
v_cvt_pk_bf16_f32 v146, v96, v97
v_cvt_pk_bf16_f32 v147, v98, v99
buffer_load_dwordx4 v1, s[4:7], s44 offen offset:0 sc1 lds
v_pk_mul_f32 v[52:53], v[52:53], v[148:149] op_sel:[0,0] op_sel_hi:[1,0]
v_cvt_pk_bf16_f32 v142, v52, v53
v_pk_mul_f32 v[54:55], v[54:55], v[148:149] op_sel:[0,0] op_sel_hi:[1,0]
v_cvt_pk_bf16_f32 v143, v54, v55
v_mfma_f32_16x16x32_bf16 v[152:155], v[16:19], v[144:147], 0
ds_write_b64 v233, v[142:143] offset:16896
v_max3_f32 v242, v242, v119, v120
v_max3_f32 v243, v243, -v119, -v120
v_pk_fma_f32 v[56:57], v[100:101], v[84:85], v[238:239] op_sel:[0,0,0] op_sel_hi:[1,0,0]
v_pk_fma_f32 v[58:59], v[102:103], v[84:85], v[238:239] op_sel:[0,0,0] op_sel_hi:[1,0,0]
v_pk_fma_f32 v[60:61], v[104:105], v[84:85], v[238:239] op_sel:[0,0,0] op_sel_hi:[1,0,0]
s_nop 1
v_rcp_f32 v152, v152
v_pk_fma_f32 v[62:63], v[106:107], v[84:85], v[238:239] op_sel:[0,0,0] op_sel_hi:[1,0,0]
v_pk_mul_f32 v[92:93], v[92:93], v[152:153] op_sel:[0,0] op_sel_hi:[1,0]
v_pk_mul_f32 v[94:95], v[94:95], v[152:153] op_sel:[0,0] op_sel_hi:[1,0]
v_cvt_pk_bf16_f32 v144, v92, v93
v_cvt_pk_bf16_f32 v145, v94, v95
ds_write_b64 v233, v[144:145] offset:17408
v_exp_f32 v56, v56
v_exp_f32 v57, v57
v_exp_f32 v58, v58
v_exp_f32 v59, v59
v_exp_f32 v60, v60
v_exp_f32 v61, v61
v_exp_f32 v62, v62
v_exp_f32 v63, v63
buffer_load_dwordx4 v1, s[4:7], s44 offen offset:1024 sc1 lds
v_cvt_pk_bf16_f32 v164, v56, v57
v_cvt_pk_bf16_f32 v165, v58, v59
v_cvt_pk_bf16_f32 v166, v60, v61
v_cvt_pk_bf16_f32 v167, v62, v63
v_pk_mul_f32 v[96:97], v[96:97], v[152:153] op_sel:[0,0] op_sel_hi:[1,0]
v_pk_mul_f32 v[98:99], v[98:99], v[152:153] op_sel:[0,0] op_sel_hi:[1,0]
v_cvt_pk_bf16_f32 v146, v96, v97
v_mfma_f32_16x16x32_bf16 v[172:175], v[16:19], v[164:167], 0
v_cvt_pk_bf16_f32 v147, v98, v99
ds_write_b64 v233, v[146:147] offset:17920
v_max3_f32 v242, v242, v121, v122
v_pk_fma_f32 v[100:101], v[100:101], v[84:85], v[238:239] op_sel:[0,0,1] op_sel_hi:[1,0,1] neg_lo:[1,0,0] neg_hi:[1,0,0]
v_pk_fma_f32 v[102:103], v[102:103], v[84:85], v[238:239] op_sel:[0,0,1] op_sel_hi:[1,0,1] neg_lo:[1,0,0] neg_hi:[1,0,0]
v_pk_fma_f32 v[104:105], v[104:105], v[84:85], v[238:239] op_sel:[0,0,1] op_sel_hi:[1,0,1] neg_lo:[1,0,0] neg_hi:[1,0,0]
s_nop 1
v_rcp_f32 v172, v172
v_pk_fma_f32 v[106:107], v[106:107], v[84:85], v[238:239] op_sel:[0,0,1] op_sel_hi:[1,0,1] neg_lo:[1,0,0] neg_hi:[1,0,0]
v_pk_mul_f32 v[56:57], v[56:57], v[172:173] op_sel:[0,0] op_sel_hi:[1,0]
v_pk_mul_f32 v[58:59], v[58:59], v[172:173] op_sel:[0,0] op_sel_hi:[1,0]
v_cvt_pk_bf16_f32 v164, v56, v57
v_cvt_pk_bf16_f32 v165, v58, v59
v_exp_f32 v100, v100
ds_write_b64 v233, v[164:165] offset:18432
v_exp_f32 v101, v101
v_exp_f32 v102, v102
v_exp_f32 v103, v103
v_exp_f32 v104, v104
v_exp_f32 v105, v105
v_exp_f32 v106, v106
v_exp_f32 v107, v107
buffer_load_dwordx4 v1, s[4:7], s44 offen offset:2048 sc1 lds
v_cvt_pk_bf16_f32 v168, v100, v101
v_cvt_pk_bf16_f32 v169, v102, v103
v_cvt_pk_bf16_f32 v170, v104, v105
v_cvt_pk_bf16_f32 v171, v106, v107
v_pk_mul_f32 v[60:61], v[60:61], v[172:173] op_sel:[0,0] op_sel_hi:[1,0]
v_pk_mul_f32 v[62:63], v[62:63], v[172:173] op_sel:[0,0] op_sel_hi:[1,0]
v_cvt_pk_bf16_f32 v166, v60, v61
v_mfma_f32_16x16x32_bf16 v[176:179], v[16:19], v[168:171], 0
v_cvt_pk_bf16_f32 v167, v62, v63
ds_write_b64 v233, v[166:167] offset:18944
v_max3_f32 v243, v243, -v121, -v122
v_pk_fma_f32 v[64:65], v[108:109], v[86:87], v[240:241] op_sel:[0,0,0] op_sel_hi:[1,0,0]
v_pk_fma_f32 v[66:67], v[110:111], v[86:87], v[240:241] op_sel:[0,0,0] op_sel_hi:[1,0,0]
v_pk_fma_f32 v[68:69], v[112:113], v[86:87], v[240:241] op_sel:[0,0,0] op_sel_hi:[1,0,0]
s_nop 1
v_rcp_f32 v176, v176
v_pk_fma_f32 v[70:71], v[114:115], v[86:87], v[240:241] op_sel:[0,0,0] op_sel_hi:[1,0,0]
v_pk_mul_f32 v[100:101], v[100:101], v[176:177] op_sel:[0,0] op_sel_hi:[1,0]
v_pk_mul_f32 v[102:103], v[102:103], v[176:177] op_sel:[0,0] op_sel_hi:[1,0]
v_cvt_pk_bf16_f32 v168, v100, v101
v_cvt_pk_bf16_f32 v169, v102, v103
v_exp_f32 v64, v64
ds_write_b64 v233, v[168:169] offset:19456
buffer_load_dwordx4 v1, s[4:7], s44 offen offset:3072 sc1 lds
v_exp_f32 v65, v65
v_exp_f32 v66, v66
v_exp_f32 v67, v67
v_exp_f32 v68, v68
v_exp_f32 v69, v69
v_exp_f32 v70, v70
v_exp_f32 v71, v71
v_cvt_pk_bf16_f32 v188, v64, v65
v_cvt_pk_bf16_f32 v189, v66, v67
v_cvt_pk_bf16_f32 v190, v68, v69
v_cvt_pk_bf16_f32 v191, v70, v71
v_pk_mul_f32 v[104:105], v[104:105], v[176:177] op_sel:[0,0] op_sel_hi:[1,0]
v_pk_mul_f32 v[106:107], v[106:107], v[176:177] op_sel:[0,0] op_sel_hi:[1,0]
v_cvt_pk_bf16_f32 v170, v104, v105
v_mfma_f32_16x16x32_bf16 v[196:199], v[16:19], v[188:191], 0
v_cvt_pk_bf16_f32 v171, v106, v107
ds_write_b64 v233, v[170:171] offset:19968
buffer_store_dwordx4 a[248:251], v2, s[4:7], s72 offen offset:0 sc1
s_nop 4
v_rcp_f32 v196, v196
v_pk_fma_f32 v[108:109], v[108:109], v[86:87], v[240:241] op_sel:[0,0,1] op_sel_hi:[1,0,1] neg_lo:[1,0,0] neg_hi:[1,0,0]
v_pk_mul_f32 v[64:65], v[64:65], v[196:197] op_sel:[0,0] op_sel_hi:[1,0]
v_pk_mul_f32 v[66:67], v[66:67], v[196:197] op_sel:[0,0] op_sel_hi:[1,0]
v_cvt_pk_bf16_f32 v188, v64, v65
v_cvt_pk_bf16_f32 v189, v66, v67
v_pk_fma_f32 v[110:111], v[110:111], v[86:87], v[240:241] op_sel:[0,0,1] op_sel_hi:[1,0,1] neg_lo:[1,0,0] neg_hi:[1,0,0]
ds_write_b64 v233, v[188:189] offset:20480
v_pk_fma_f32 v[112:113], v[112:113], v[86:87], v[240:241] op_sel:[0,0,1] op_sel_hi:[1,0,1] neg_lo:[1,0,0] neg_hi:[1,0,0]
v_pk_fma_f32 v[114:115], v[114:115], v[86:87], v[240:241] op_sel:[0,0,1] op_sel_hi:[1,0,1] neg_lo:[1,0,0] neg_hi:[1,0,0]
v_exp_f32 v108, v108
v_exp_f32 v109, v109
v_exp_f32 v110, v110
v_exp_f32 v111, v111
v_exp_f32 v112, v112
v_exp_f32 v113, v113
v_exp_f32 v114, v114
v_exp_f32 v115, v115
v_max_f32 v242, v242, v123
v_max_f32_e64 v243, v243, -v123
v_cvt_pk_bf16_f32 v192, v108, v109
v_cvt_pk_bf16_f32 v193, v110, v111
v_cvt_pk_bf16_f32 v194, v112, v113
v_cvt_pk_bf16_f32 v195, v114, v115
v_pk_mul_f32 v[68:69], v[68:69], v[196:197] op_sel:[0,0] op_sel_hi:[1,0]
v_pk_mul_f32 v[70:71], v[70:71], v[196:197] op_sel:[0,0] op_sel_hi:[1,0]
v_permlane32_swap_b32 v242, v243
v_mfma_f32_16x16x32_bf16 v[200:203], v[16:19], v[192:195], 0
v_cvt_pk_bf16_f32 v190, v68, v69
v_cvt_pk_bf16_f32 v191, v70, v71
ds_write_b64 v233, v[190:191] offset:20992
v_max_f32 v242, v242, v243
v_mov_b32 v247, v242
buffer_store_dwordx4 a[248:251], v2, s[4:7], s72 offen offset:1024 sc1
s_nop 0
v_permlane16_swap_b32 v242, v247
v_rcp_f32 v200, v200
v_max_f32 v242, v242, v247
v_mov_b32 v247, v242
v_pk_mul_f32 v[108:109], v[108:109], v[200:201] op_sel:[0,0] op_sel_hi:[1,0]
v_pk_mul_f32 v[110:111], v[110:111], v[200:201] op_sel:[0,0] op_sel_hi:[1,0]
v_cvt_pk_bf16_f32 v192, v108, v109
v_cvt_pk_bf16_f32 v193, v110, v111
v_permlane32_swap_b32 v242, v247
ds_write_b64 v233, v[192:193] offset:21504
v_mul_f32_e64 v242, -v242, v88
v_mul_f32_e64 v243, -v247, v88
v_pk_fma_f32 v[124:125], v[116:117], v[88:89], v[242:243] op_sel:[0,0,0] op_sel_hi:[1,0,0]
v_pk_fma_f32 v[126:127], v[118:119], v[88:89], v[242:243] op_sel:[0,0,0] op_sel_hi:[1,0,0]
v_pk_fma_f32 v[128:129], v[120:121], v[88:89], v[242:243] op_sel:[0,0,0] op_sel_hi:[1,0,0]
v_pk_fma_f32 v[130:131], v[122:123], v[88:89], v[242:243] op_sel:[0,0,0] op_sel_hi:[1,0,0]
v_exp_f32 v124, v124
v_exp_f32 v125, v125
v_exp_f32 v126, v126
v_exp_f32 v127, v127
v_exp_f32 v128, v128
v_exp_f32 v129, v129
v_exp_f32 v130, v130
v_exp_f32 v131, v131
v_cvt_pk_bf16_f32 v212, v124, v125
v_cvt_pk_bf16_f32 v213, v126, v127
v_cvt_pk_bf16_f32 v214, v128, v129
v_cvt_pk_bf16_f32 v215, v130, v131
v_pk_mul_f32 v[112:113], v[112:113], v[200:201] op_sel:[0,0] op_sel_hi:[1,0]
v_pk_mul_f32 v[114:115], v[114:115], v[200:201] op_sel:[0,0] op_sel_hi:[1,0]
v_cvt_pk_bf16_f32 v194, v112, v113
v_mfma_f32_16x16x32_bf16 v[220:223], v[16:19], v[212:215], 0
v_cvt_pk_bf16_f32 v195, v114, v115
ds_write_b64 v233, v[194:195] offset:22016
buffer_store_dwordx4 a[248:251], v2, s[4:7], s72 offen offset:2048 sc1
s_nop 4
v_rcp_f32 v220, v220
v_pk_fma_f32 v[116:117], v[116:117], v[88:89], v[242:243] op_sel:[0,0,1] op_sel_hi:[1,0,1] neg_lo:[1,0,0] neg_hi:[1,0,0]
v_pk_mul_f32 v[124:125], v[124:125], v[220:221] op_sel:[0,0] op_sel_hi:[1,0]
v_pk_mul_f32 v[126:127], v[126:127], v[220:221] op_sel:[0,0] op_sel_hi:[1,0]
v_cvt_pk_bf16_f32 v212, v124, v125
v_cvt_pk_bf16_f32 v213, v126, v127
v_pk_fma_f32 v[118:119], v[118:119], v[88:89], v[242:243] op_sel:[0,0,1] op_sel_hi:[1,0,1] neg_lo:[1,0,0] neg_hi:[1,0,0]
ds_write_b64 v233, v[212:213] offset:22528
v_pk_fma_f32 v[120:121], v[120:121], v[88:89], v[242:243] op_sel:[0,0,1] op_sel_hi:[1,0,1] neg_lo:[1,0,0] neg_hi:[1,0,0]
v_pk_fma_f32 v[122:123], v[122:123], v[88:89], v[242:243] op_sel:[0,0,1] op_sel_hi:[1,0,1] neg_lo:[1,0,0] neg_hi:[1,0,0]
v_exp_f32 v116, v116
v_exp_f32 v117, v117
v_exp_f32 v118, v118
v_exp_f32 v119, v119
v_exp_f32 v120, v120
v_exp_f32 v121, v121
v_exp_f32 v122, v122
v_exp_f32 v123, v123
v_cvt_pk_bf16_f32 v216, v116, v117
v_cvt_pk_bf16_f32 v217, v118, v119
v_cvt_pk_bf16_f32 v218, v120, v121
v_cvt_pk_bf16_f32 v219, v122, v123
v_pk_mul_f32 v[128:129], v[128:129], v[220:221] op_sel:[0,0] op_sel_hi:[1,0]
v_pk_mul_f32 v[130:131], v[130:131], v[220:221] op_sel:[0,0] op_sel_hi:[1,0]
v_cvt_pk_bf16_f32 v214, v128, v129
v_mfma_f32_16x16x32_bf16 v[224:227], v[16:19], v[216:219], 0
v_cvt_pk_bf16_f32 v215, v130, v131
ds_write_b64 v233, v[214:215] offset:23040
buffer_store_dwordx4 a[248:251], v2, s[4:7], s72 offen offset:3072 sc1
s_nop 4
v_rcp_f32 v224, v224
s_nop 0
v_pk_mul_f32 v[116:117], v[116:117], v[224:225] op_sel:[0,0] op_sel_hi:[1,0]
v_pk_mul_f32 v[118:119], v[118:119], v[224:225] op_sel:[0,0] op_sel_hi:[1,0]
v_cvt_pk_bf16_f32 v216, v116, v117
v_cvt_pk_bf16_f32 v217, v118, v119
v_pk_mul_f32 v[120:121], v[120:121], v[224:225] op_sel:[0,0] op_sel_hi:[1,0]
ds_write_b64 v233, v[216:217] offset:23552
v_pk_mul_f32 v[122:123], v[122:123], v[224:225] op_sel:[0,0] op_sel_hi:[1,0]
v_cvt_pk_bf16_f32 v218, v120, v121
v_cvt_pk_bf16_f32 v219, v122, v123
ds_write_b64 v233, v[218:219] offset:24064
s_waitcnt vmcnt(8)
s_waitcnt lgkmcnt(0)
s_barrier
ds_read_b64_tr_b16 a[0:1], v234 offset:16384
ds_read_b64_tr_b16 a[2:3], v234 offset:18432
ds_read_b64_tr_b16 a[12:13], v234 offset:20480
ds_read_b64_tr_b16 a[14:15], v234 offset:22528
ds_read_b64_tr_b16 a[24:25], v234 offset:24576
ds_read_b64_tr_b16 a[26:27], v234 offset:26624
ds_read_b64_tr_b16 a[4:5], v8 offset:0
ds_read_b64_tr_b16 a[6:7], v8 offset:1024
ds_read_b64_tr_b16 a[8:9], v8 offset:512
ds_read_b64_tr_b16 a[10:11], v8 offset:1536
ds_read_b64_tr_b16 a[36:37], v234 offset:28672
ds_read_b64_tr_b16 a[38:39], v234 offset:30720
ds_read_b64_tr_b16 a[16:17], v8 offset:2048
ds_read_b64_tr_b16 a[18:19], v8 offset:3072
ds_read_b64_tr_b16 a[20:21], v8 offset:2560
ds_read_b64_tr_b16 a[22:23], v8 offset:3584
ds_read_b64_tr_b16 a[48:49], v234 offset:32768
ds_read_b64_tr_b16 a[50:51], v234 offset:34816
ds_read_b64_tr_b16 a[28:29], v8 offset:4096
ds_read_b64_tr_b16 a[30:31], v8 offset:5120
ds_read_b64_tr_b16 a[32:33], v8 offset:4608
ds_read_b64_tr_b16 a[34:35], v8 offset:5632
ds_read_b64_tr_b16 a[60:61], v234 offset:36864
ds_read_b64_tr_b16 a[62:63], v234 offset:38912
s_waitcnt lgkmcnt(14)
v_mfma_f32_16x16x32_bf16 v[100:103], a[0:3], v[16:19], 0
ds_read_b64_tr_b16 a[40:41], v8 offset:6144
ds_read_b64_tr_b16 a[42:43], v8 offset:7168
ds_read_b64_tr_b16 a[44:45], v8 offset:6656
ds_read_b64_tr_b16 a[46:47], v8 offset:7680
ds_read_b64_tr_b16 a[72:73], v234 offset:40960
ds_read_b64_tr_b16 a[74:75], v234 offset:43008
v_mfma_f32_16x16x32_bf16 v[100:103], a[12:15], v[16:19], v[100:103]
buffer_atomic_add v12, v235, s[4:7], s94 offen sc1
ds_read_b64_tr_b16 a[52:53], v8 offset:8192
ds_read_b64_tr_b16 a[54:55], v8 offset:9216
ds_read_b64_tr_b16 a[56:57], v8 offset:8704
ds_read_b64_tr_b16 a[58:59], v8 offset:9728
ds_read_b64_tr_b16 a[84:85], v234 offset:45056
ds_read_b64_tr_b16 a[86:87], v234 offset:47104
v_mfma_f32_16x16x32_bf16 v[100:103], a[24:27], v[16:19], v[100:103]
ds_read_b64_tr_b16 a[64:65], v8 offset:10240
ds_read_b64_tr_b16 a[66:67], v8 offset:11264
v_mfma_f32_16x16x32_bf16 v[92:95], a[0:3], a[4:7], 0
ds_read_b64_tr_b16 a[68:69], v8 offset:10752
ds_read_b64_tr_b16 a[70:71], v8 offset:11776
v_mfma_f32_16x16x32_bf16 v[96:99], a[0:3], a[8:11], 0
ds_read_b64_tr_b16 a[76:77], v8 offset:12288
s_waitcnt lgkmcnt(14)
v_mfma_f32_16x16x32_bf16 v[100:103], a[36:39], v[16:19], v[100:103]
ds_read_b64_tr_b16 a[78:79], v8 offset:13312
v_mfma_f32_16x16x32_bf16 v[92:95], a[12:15], a[16:19], v[92:95]
ds_read_b64_tr_b16 a[80:81], v8 offset:12800
ds_read_b64_tr_b16 a[82:83], v8 offset:13824
v_mfma_f32_16x16x32_bf16 v[96:99], a[12:15], a[20:23], v[96:99]
ds_read_b64_tr_b16 a[88:89], v8 offset:14336
v_mfma_f32_16x16x32_bf16 v[100:103], a[48:51], v[16:19], v[100:103]
ds_read_b64_tr_b16 a[90:91], v8 offset:15360
v_mfma_f32_16x16x32_bf16 v[92:95], a[24:27], a[28:31], v[92:95]
ds_read_b64_tr_b16 a[92:93], v8 offset:14848
ds_read_b64_tr_b16 a[94:95], v8 offset:15872
v_mfma_f32_16x16x32_bf16 v[96:99], a[24:27], a[32:35], v[96:99]
v_cvt_pk_bf16_f32 v132, v132, v133
v_cvt_pk_bf16_f32 v156, v156, v157
v_mfma_f32_16x16x32_bf16 v[100:103], a[60:63], v[16:19], v[100:103]
v_cvt_pk_bf16_f32 v180, v180, v181
v_cvt_pk_bf16_f32 v204, v204, v205
v_mfma_f32_16x16x32_bf16 v[92:95], a[36:39], a[40:43], v[92:95]
v_cvt_pk_bf16_f32 v133, v134, v135
v_cvt_pk_bf16_f32 v157, v158, v159
s_waitcnt lgkmcnt(14)
v_mfma_f32_16x16x32_bf16 v[96:99], a[36:39], a[44:47], v[96:99]
v_cvt_pk_bf16_f32 v181, v182, v183
v_cvt_pk_bf16_f32 v205, v206, v207
v_mfma_f32_16x16x32_bf16 v[100:103], a[72:75], v[16:19], v[100:103]
v_cvt_pk_bf16_f32 v134, v136, v137
v_cvt_pk_bf16_f32 v135, v138, v139
v_mfma_f32_16x16x32_bf16 v[92:95], a[48:51], a[52:55], v[92:95]
v_cvt_pk_bf16_f32 v158, v160, v161
v_cvt_pk_bf16_f32 v159, v162, v163
v_mfma_f32_16x16x32_bf16 v[96:99], a[48:51], a[56:59], v[96:99]
v_cvt_pk_bf16_f32 v182, v184, v185
v_cvt_pk_bf16_f32 v183, v186, v187
s_waitcnt lgkmcnt(12)
v_mfma_f32_16x16x32_bf16 v[100:103], a[84:87], v[16:19], v[100:103]
v_cvt_pk_bf16_f32 v206, v208, v209
v_cvt_pk_bf16_f32 v207, v210, v211
s_waitcnt lgkmcnt(10)
v_mfma_f32_16x16x32_bf16 v[92:95], a[60:63], a[64:67], v[92:95]
s_waitcnt lgkmcnt(8)
v_mfma_f32_16x16x32_bf16 v[96:99], a[60:63], a[68:71], v[96:99]
s_nop 1
v_min_u32 v100, -2, v100
v_min_u32 v101, -2, v101
s_waitcnt lgkmcnt(6)
v_mfma_f32_16x16x32_bf16 v[92:95], a[72:75], a[76:79], v[92:95]
v_min_u32 v102, -2, v102
v_min_u32 v103, -2, v103
s_waitcnt lgkmcnt(4)
v_mfma_f32_16x16x32_bf16 v[96:99], a[72:75], a[80:83], v[96:99]
buffer_store_dwordx4 v[100:103], v254, s[4:7], s97 offen sc1
s_waitcnt lgkmcnt(2)
v_mfma_f32_16x16x32_bf16 v[92:95], a[84:87], a[88:91], v[92:95]
s_waitcnt lgkmcnt(0)
v_mfma_f32_16x16x32_bf16 v[96:99], a[84:87], a[92:95], v[96:99]
s_nop 5
v_cvt_pk_bf16_f32 v92, v92, v93
v_cvt_pk_bf16_f32 v93, v94, v95
v_min_u32 v92, -2, v92
v_min_u32 v93, -2, v93
v_cvt_pk_bf16_f32 v94, v96, v97
v_cvt_pk_bf16_f32 v95, v98, v99
v_min_u32 v94, -2, v94
v_min_u32 v95, -2, v95
buffer_store_dwordx4 v[92:95], v1, s[4:7], s96 offen sc1
s_barrier
s_add_u32 m0, s19, 32768
s_add_u32 s44, s84, 0xc00000
buffer_load_dwordx4 v1, s[4:7], s44 offen offset:0 sc1 lds
v_mfma_f32_16x16x32_bf16 v[108:111], a[240:243], v[132:135], 0
v_mfma_f32_16x16x32_bf16 v[172:175], a[240:243], v[156:159], 0
v_mfma_f32_16x16x32_bf16 v[112:115], a[244:247], v[132:135], 0
s_nop 5
v_max3_f32 v236, v108, v109, v110
v_max3_f32 v237, -v108, -v109, -v110
v_mfma_f32_16x16x32_bf16 v[176:179], a[244:247], v[156:159], 0
v_max3_f32 v238, v172, v173, v174
v_max3_f32 v239, -v172, -v173, -v174
v_max3_f32 v236, v236, v111, v112
v_max3_f32 v237, v237, -v111, -v112
v_max3_f32 v236, v236, v113, v114
v_max3_f32 v237, v237, -v113, -v114
s_nop 1
v_max3_f32 v238, v238, v175, v176
v_max3_f32 v239, v239, -v175, -v176
v_max3_f32 v238, v238, v177, v178
v_max3_f32 v239, v239, -v177, -v178
v_max_f32 v236, v236, v115
buffer_load_dwordx4 v1, s[4:7], s44 offen offset:1024 sc1 lds
v_max_f32_e64 v237, v237, -v115
v_max_f32 v238, v238, v179
v_max_f32_e64 v239, v239, -v179
v_permlane32_swap_b32 v236, v237
s_nop 0
v_permlane32_swap_b32 v238, v239
v_mov_b32 v11, 0
buffer_atomic_add v11, v251, s[4:7], s89 offen sc0 sc1
v_max_f32 v236, v236, v237
v_max_f32 v238, v238, v239
v_mov_b32 v244, v236
v_mov_b32 v245, v238
s_nop 0
v_permlane16_swap_b32 v236, v244
v_permlane16_swap_b32 v238, v245
v_max_f32 v236, v236, v244
v_max_f32 v238, v238, v245
v_mov_b32 v244, v236
v_mov_b32 v245, v238
s_nop 0
v_permlane32_swap_b32 v236, v244
v_permlane32_swap_b32 v238, v245
v_mul_f32_e64 v236, -v236, v82
v_mul_f32_e64 v237, -v244, v82
buffer_load_dwordx4 v1, s[4:7], s44 offen offset:2048 sc1 lds
v_mul_f32_e64 v238, -v238, v84
v_mul_f32_e64 v239, -v245, v84
v_pk_fma_f32 v[116:117], v[108:109], v[82:83], v[236:237] op_sel:[0,0,0] op_sel_hi:[1,0,0]
v_pk_fma_f32 v[118:119], v[110:111], v[82:83], v[236:237] op_sel:[0,0,0] op_sel_hi:[1,0,0]
v_pk_fma_f32 v[120:121], v[112:113], v[82:83], v[236:237] op_sel:[0,0,0] op_sel_hi:[1,0,0]
v_pk_fma_f32 v[122:123], v[114:115], v[82:83], v[236:237] op_sel:[0,0,0] op_sel_hi:[1,0,0]
v_pk_fma_f32 v[148:149], v[172:173], v[84:85], v[238:239] op_sel:[0,0,0] op_sel_hi:[1,0,0]
v_pk_fma_f32 v[150:151], v[174:175], v[84:85], v[238:239] op_sel:[0,0,0] op_sel_hi:[1,0,0]
v_pk_fma_f32 v[152:153], v[176:177], v[84:85], v[238:239] op_sel:[0,0,0] op_sel_hi:[1,0,0]
v_pk_fma_f32 v[154:155], v[178:179], v[84:85], v[238:239] op_sel:[0,0,0] op_sel_hi:[1,0,0]
v_pk_fma_f32 v[108:109], v[108:109], v[82:83], v[236:237] op_sel:[0,0,1] op_sel_hi:[1,0,1] neg_lo:[1,0,0] neg_hi:[1,0,0]
v_pk_fma_f32 v[110:111], v[110:111], v[82:83], v[236:237] op_sel:[0,0,1] op_sel_hi:[1,0,1] neg_lo:[1,0,0] neg_hi:[1,0,0]
v_pk_fma_f32 v[112:113], v[112:113], v[82:83], v[236:237] op_sel:[0,0,1] op_sel_hi:[1,0,1] neg_lo:[1,0,0] neg_hi:[1,0,0]
v_pk_fma_f32 v[114:115], v[114:115], v[82:83], v[236:237] op_sel:[0,0,1] op_sel_hi:[1,0,1] neg_lo:[1,0,0] neg_hi:[1,0,0]
v_pk_fma_f32 v[172:173], v[172:173], v[84:85], v[238:239] op_sel:[0,0,1] op_sel_hi:[1,0,1] neg_lo:[1,0,0] neg_hi:[1,0,0]
v_pk_fma_f32 v[174:175], v[174:175], v[84:85], v[238:239] op_sel:[0,0,1] op_sel_hi:[1,0,1] neg_lo:[1,0,0] neg_hi:[1,0,0]
v_pk_fma_f32 v[176:177], v[176:177], v[84:85], v[238:239] op_sel:[0,0,1] op_sel_hi:[1,0,1] neg_lo:[1,0,0] neg_hi:[1,0,0]
v_pk_fma_f32 v[178:179], v[178:179], v[84:85], v[238:239] op_sel:[0,0,1] op_sel_hi:[1,0,1] neg_lo:[1,0,0] neg_hi:[1,0,0]
v_exp_f32 v116, v116
v_exp_f32 v108, v108
v_exp_f32 v117, v117
v_exp_f32 v109, v109
v_exp_f32 v118, v118
v_exp_f32 v110, v110
v_exp_f32 v119, v119
v_exp_f32 v111, v111
v_exp_f32 v120, v120
v_exp_f32 v112, v112
v_exp_f32 v121, v121
v_exp_f32 v113, v113
v_exp_f32 v122, v122
v_exp_f32 v114, v114
v_exp_f32 v123, v123
v_exp_f32 v115, v115
v_exp_f32 v148, v148
v_exp_f32 v172, v172
v_exp_f32 v149, v149
v_exp_f32 v173, v173
v_exp_f32 v150, v150
v_exp_f32 v174, v174
v_exp_f32 v151, v151
v_exp_f32 v175, v175
v_exp_f32 v152, v152
v_exp_f32 v176, v176
v_exp_f32 v153, v153
v_exp_f32 v177, v177
v_exp_f32 v154, v154
v_exp_f32 v178, v178
v_exp_f32 v155, v155
v_exp_f32 v179, v179
buffer_load_dwordx4 v1, s[4:7], s44 offen offset:3072 sc1 lds
v_cvt_pk_bf16_f32 v140, v116, v117
v_cvt_pk_bf16_f32 v141, v118, v119
v_cvt_pk_bf16_f32 v142, v120, v121
v_cvt_pk_bf16_f32 v143, v122, v123
v_cvt_pk_bf16_f32 v144, v108, v109
L_stub8:
s_cbranch_execz L_wret2
v_cvt_pk_bf16_f32 v145, v110, v111
v_cvt_pk_bf16_f32 v146, v112, v113
v_cvt_pk_bf16_f32 v147, v114, v115
v_cvt_pk_bf16_f32 v164, v148, v149
v_cvt_pk_bf16_f32 v165, v150, v151
v_cvt_pk_bf16_f32 v166, v152, v153
v_cvt_pk_bf16_f32 v167, v154, v155
v_cvt_pk_bf16_f32 v168, v172, v173
v_cvt_pk_bf16_f32 v169, v174, v175
v_cvt_pk_bf16_f32 v170, v176, v177
v_cvt_pk_bf16_f32 v171, v178, v179
s_waitcnt vmcnt(2)
v_readfirstlane_b32 s38, v11
s_nop 0
s_cmp_ge_u32 s38, 8
s_cbranch_scc1 Lpe_25
s_add_u32 s36, s88, 0x80000
s_mov_b32 s37, 0
Lpoll_24:
v_mov_b32 v11, 0
buffer_atomic_add v11, v251, s[4:7], s36 offen sc0 sc1
s_add_u32 s37, s37, 1
s_waitcnt vmcnt(0)
v_readfirstlane_b32 s38, v11
s_nop 0
s_cmp_ge_u32 s38, 8
s_cbranch_scc1 Lpe_25
s_cmp_lt_u32 s37, 0x100000
s_cbranch_scc1 Lpoll_24
Lpe_25:
buffer_load_dwordx4 v[48:51], v1, s[4:7], s98 offen offset:0 sc1
v_mfma_f32_16x16x32_bf16 v[108:111], a[240:243], v[180:183], 0
v_mfma_f32_16x16x32_bf16 v[220:223], a[240:243], v[204:207], 0
v_mfma_f32_16x16x32_bf16 v[112:115], a[244:247], v[180:183], 0
s_nop 5
v_max3_f32 v240, v108, v109, v110
v_max3_f32 v241, -v108, -v109, -v110
v_mfma_f32_16x16x32_bf16 v[224:227], a[244:247], v[204:207], 0
buffer_load_dwordx4 v[124:127], v248, s[4:7], s100 offen sc1
v_max3_f32 v242, v220, v221, v222
v_max3_f32 v243, -v220, -v221, -v222
v_max3_f32 v240, v240, v111, v112
v_max3_f32 v241, v241, -v111, -v112
v_max3_f32 v240, v240, v113, v114
s_nop 1
v_max3_f32 v242, v242, v223, v224
v_max3_f32 v243, v243, -v223, -v224
v_max3_f32 v241, v241, -v113, -v114
v_max3_f32 v242, v242, v225, v226
v_max3_f32 v243, v243, -v225, -v226
v_max_f32 v240, v240, v115
v_max_f32_e64 v241, v241, -v115
v_max_f32 v242, v242, v227
buffer_load_dwordx4 v[52:55], v1, s[4:7], s98 offen offset:1024 sc1
v_max_f32_e64 v243, v243, -v227
v_permlane32_swap_b32 v240, v241
s_nop 0
v_permlane32_swap_b32 v242, v243
v_max_f32 v240, v240, v241
v_max_f32 v242, v242, v243
v_mov_b32 v246, v240
v_mov_b32 v247, v242
s_nop 0
v_permlane16_swap_b32 v240, v246
v_permlane16_swap_b32 v242, v247
buffer_load_dwordx4 v[56:59], v1, s[4:7], s98 offen offset:2048 sc1
v_max_f32 v240, v240, v246
v_max_f32 v242, v242, v247
v_mov_b32 v246, v240
v_mov_b32 v247, v242
s_nop 0
v_permlane32_swap_b32 v240, v246
v_permlane32_swap_b32 v242, v247
v_mul_f32_e64 v240, -v240, v86
v_mul_f32_e64 v241, -v246, v86
v_mul_f32_e64 v242, -v242, v88
v_mul_f32_e64 v243, -v247, v88
buffer_load_dwordx4 v[60:63], v1, s[4:7], s98 offen offset:3072 sc1
v_pk_fma_f32 v[116:117], v[108:109], v[86:87], v[240:241] op_sel:[0,0,0] op_sel_hi:[1,0,0]
v_pk_fma_f32 v[118:119], v[110:111], v[86:87], v[240:241] op_sel:[0,0,0] op_sel_hi:[1,0,0]
v_pk_fma_f32 v[120:121], v[112:113], v[86:87], v[240:241] op_sel:[0,0,0] op_sel_hi:[1,0,0]
v_pk_fma_f32 v[122:123], v[114:115], v[86:87], v[240:241] op_sel:[0,0,0] op_sel_hi:[1,0,0]
v_pk_fma_f32 v[196:197], v[220:221], v[88:89], v[242:243] op_sel:[0,0,0] op_sel_hi:[1,0,0]
v_pk_fma_f32 v[198:199], v[222:223], v[88:89], v[242:243] op_sel:[0,0,0] op_sel_hi:[1,0,0]
v_pk_fma_f32 v[200:201], v[224:225], v[88:89], v[242:243] op_sel:[0,0,0] op_sel_hi:[1,0,0]
v_pk_fma_f32 v[202:203], v[226:227], v[88:89], v[242:243] op_sel:[0,0,0] op_sel_hi:[1,0,0]
v_pk_fma_f32 v[108:109], v[108:109], v[86:87], v[240:241] op_sel:[0,0,1] op_sel_hi:[1,0,1] neg_lo:[1,0,0] neg_hi:[1,0,0]
v_pk_fma_f32 v[110:111], v[110:111], v[86:87], v[240:241] op_sel:[0,0,1] op_sel_hi:[1,0,1] neg_lo:[1,0,0] neg_hi:[1,0,0]
v_pk_fma_f32 v[112:113], v[112:113], v[86:87], v[240:241] op_sel:[0,0,1] op_sel_hi:[1,0,1] neg_lo:[1,0,0] neg_hi:[1,0,0]
v_pk_fma_f32 v[114:115], v[114:115], v[86:87], v[240:241] op_sel:[0,0,1] op_sel_hi:[1,0,1] neg_lo:[1,0,0] neg_hi:[1,0,0]
v_pk_fma_f32 v[220:221], v[220:221], v[88:89], v[242:243] op_sel:[0,0,1] op_sel_hi:[1,0,1] neg_lo:[1,0,0] neg_hi:[1,0,0]
buffer_load_dwordx4 v[64:67], v1, s[4:7], s99 offen offset:0 sc1
v_pk_fma_f32 v[222:223], v[222:223], v[88:89], v[242:243] op_sel:[0,0,1] op_sel_hi:[1,0,1] neg_lo:[1,0,0] neg_hi:[1,0,0]
v_pk_fma_f32 v[224:225], v[224:225], v[88:89], v[242:243] op_sel:[0,0,1] op_sel_hi:[1,0,1] neg_lo:[1,0,0] neg_hi:[1,0,0]
v_pk_fma_f32 v[226:227], v[226:227], v[88:89], v[242:243] op_sel:[0,0,1] op_sel_hi:[1,0,1] neg_lo:[1,0,0] neg_hi:[1,0,0]
v_exp_f32 v116, v116
v_exp_f32 v108, v108
v_exp_f32 v117, v117
v_exp_f32 v109, v109
v_exp_f32 v118, v118
buffer_load_dwordx4 v[68:71], v1, s[4:7], s99 offen offset:1024 sc1
v_exp_f32 v110, v110
v_exp_f32 v119, v119
v_exp_f32 v111, v111
v_exp_f32 v120, v120
v_exp_f32 v112, v112
v_exp_f32 v121, v121
v_exp_f32 v113, v113
buffer_load_dwordx4 v[100:103], v1, s[4:7], s99 offen offset:2048 sc1
v_exp_f32 v122, v122
v_exp_f32 v114, v114
v_exp_f32 v123, v123
v_exp_f32 v115, v115
v_exp_f32 v196, v196
v_exp_f32 v220, v220
v_exp_f32 v197, v197
buffer_load_dwordx4 v[104:107], v1, s[4:7], s99 offen offset:3072 sc1
v_exp_f32 v221, v221
v_exp_f32 v198, v198
v_exp_f32 v222, v222
v_exp_f32 v199, v199
v_exp_f32 v223, v223
v_exp_f32 v200, v200
v_exp_f32 v224, v224
buffer_store_dwordx4 a[248:251], v2, s[4:7], s73 offen offset:0 sc1
v_exp_f32 v201, v201
v_exp_f32 v225, v225
v_exp_f32 v202, v202
v_exp_f32 v226, v226
v_exp_f32 v203, v203
v_exp_f32 v227, v227
v_cvt_pk_bf16_f32 v188, v116, v117
v_cvt_pk_bf16_f32 v189, v118, v119
v_cvt_pk_bf16_f32 v190, v120, v121
v_cvt_pk_bf16_f32 v191, v122, v123
v_cvt_pk_bf16_f32 v192, v108, v109
v_cvt_pk_bf16_f32 v193, v110, v111
v_cvt_pk_bf16_f32 v194, v112, v113
v_cvt_pk_bf16_f32 v195, v114, v115
v_cvt_pk_bf16_f32 v212, v196, v197
v_cvt_pk_bf16_f32 v213, v198, v199
v_cvt_pk_bf16_f32 v214, v200, v201
v_cvt_pk_bf16_f32 v215, v202, v203
v_cvt_pk_bf16_f32 v216, v220, v221
v_cvt_pk_bf16_f32 v217, v222, v223
v_cvt_pk_bf16_f32 v218, v224, v225
v_cvt_pk_bf16_f32 v219, v226, v227
buffer_store_dwordx4 a[248:251], v2, s[4:7], s73 offen offset:1024 sc1
s_waitcnt vmcnt(10)
v_lshlrev_b32 v92, 16, v48
v_and_b32 v93, 0xffff0000, v48
v_lshlrev_b32 v94, 16, v49
v_and_b32 v95, 0xffff0000, v49
v_lshlrev_b32 v96, 16, v50
v_and_b32 v97, 0xffff0000, v50
v_lshlrev_b32 v98, 16, v51
v_and_b32 v99, 0xffff0000, v51
s_waitcnt vmcnt(9)
v_add_f32_dpp v128, v124, v124 row_ror:4 row_mask:0xf bank_mask:0xf
v_add_f32_dpp v129, v125, v125 row_ror:4 row_mask:0xf bank_mask:0xf
v_add_f32_dpp v130, v126, v126 row_ror:4 row_mask:0xf bank_mask:0xf
v_add_f32_dpp v131, v127, v127 row_ror:4 row_mask:0xf bank_mask:0xf
v_add_f32_dpp v128, v128, v128 row_ror:2 row_mask:0xf bank_mask:0xf
v_add_f32_dpp v129, v129, v129 row_ror:2 row_mask:0xf bank_mask:0xf
v_add_f32_dpp v130, v130, v130 row_ror:2 row_mask:0xf bank_mask:0xf
buffer_store_dwordx4 a[248:251], v2, s[4:7], s73 offen offset:2048 sc1
v_add_f32_dpp v131, v131, v131 row_ror:2 row_mask:0xf bank_mask:0xf
v_add_f32_dpp v128, v128, v128 row_ror:1 row_mask:0xf bank_mask:0xf
v_add_f32_dpp v129, v129, v129 row_ror:1 row_mask:0xf bank_mask:0xf
v_add_f32_dpp v130, v130, v130 row_ror:1 row_mask:0xf bank_mask:0xf
v_add_f32_dpp v131, v131, v131 row_ror:1 row_mask:0xf bank_mask:0xf
s_waitcnt vmcnt(9)
v_dot2c_f32_bf16 v92, v52, v249
v_dot2c_f32_bf16 v93, v52, v250
v_dot2c_f32_bf16 v94, v53, v249
v_dot2c_f32_bf16 v95, v53, v250
v_dot2c_f32_bf16 v96, v54, v249
v_dot2c_f32_bf16 v97, v54, v250
v_dot2c_f32_bf16 v98, v55, v249
v_dot2c_f32_bf16 v99, v55, v250
v_fma_f32 v135, v129, v130, v131
s_waitcnt vmcnt(8)
v_dot2c_f32_bf16 v92, v56, v249
v_dot2c_f32_bf16 v93, v56, v250
v_dot2c_f32_bf16 v94, v57, v249
v_dot2c_f32_bf16 v95, v57, v250
v_dot2c_f32_bf16 v96, v58, v249
v_dot2c_f32_bf16 v97, v58, v250
v_dot2c_f32_bf16 v98, v59, v249
v_dot2c_f32_bf16 v99, v59, v250
buffer_store_dwordx4 a[248:251], v2, s[4:7], s73 offen offset:3072 sc1
s_waitcnt vmcnt(8)
v_dot2c_f32_bf16 v92, v60, v249
v_dot2c_f32_bf16 v93, v60, v250
v_dot2c_f32_bf16 v94, v61, v249
v_dot2c_f32_bf16 v95, v61, v250
v_dot2c_f32_bf16 v96, v62, v249
v_dot2c_f32_bf16 v97, v62, v250
v_dot2c_f32_bf16 v98, v63, v249
v_dot2c_f32_bf16 v99, v63, v250
s_waitcnt vmcnt(7)
v_dot2c_f32_bf16 v92, v64, v249
v_dot2c_f32_bf16 v93, v64, v250
v_dot2c_f32_bf16 v94, v65, v249
v_dot2c_f32_bf16 v95, v65, v250
v_dot2c_f32_bf16 v96, v66, v249
v_dot2c_f32_bf16 v97, v66, v250
v_dot2c_f32_bf16 v98, v67, v249
v_dot2c_f32_bf16 v99, v67, v250
s_waitcnt vmcnt(6)
v_dot2c_f32_bf16 v92, v68, v249
v_dot2c_f32_bf16 v93, v68, v250
v_dot2c_f32_bf16 v94, v69, v249
v_dot2c_f32_bf16 v95, v69, v250
v_dot2c_f32_bf16 v96, v70, v249
v_dot2c_f32_bf16 v97, v70, v250
v_dot2c_f32_bf16 v98, v71, v249
v_dot2c_f32_bf16 v99, v71, v250
s_waitcnt vmcnt(5)
v_dot2c_f32_bf16 v92, v100, v249
v_dot2c_f32_bf16 v93, v100, v250
v_dot2c_f32_bf16 v94, v101, v249
v_dot2c_f32_bf16 v95, v101, v250
v_dot2c_f32_bf16 v96, v102, v249
v_dot2c_f32_bf16 v97, v102, v250
v_dot2c_f32_bf16 v98, v103, v249
v_dot2c_f32_bf16 v99, v103, v250
s_waitcnt vmcnt(4)
v_dot2c_f32_bf16 v92, v104, v249
v_dot2c_f32_bf16 v93, v104, v250
v_dot2c_f32_bf16 v94, v105, v249
v_dot2c_f32_bf16 v95, v105, v250
v_dot2c_f32_bf16 v96, v106, v249
v_dot2c_f32_bf16 v97, v106, v250
v_dot2c_f32_bf16 v98, v107, v249
v_dot2c_f32_bf16 v99, v107, v250
v_fma_f32 v132, v92, v93, v94
v_fma_f32 v133, v95, v96, v97
s_nop 0
v_fma_f32 v134, v98, v99, v128
v_fma_f32 v132, v132, v133, v134
v_cmp_u_f32 vcc, v132, v135
s_cbranch_vccnz L_kvredo1
L_kvback1:
v_cvt_pk_bf16_f32 v128, v128, v129
v_cvt_pk_bf16_f32 v129, v130, v131
v_cvt_pk_bf16_f32 v92, v92, v93
v_cndmask_b32 v128, 0, v128, s[56:57]
v_cndmask_b32 v129, 0, v129, s[56:57]
v_cvt_pk_bf16_f32 v93, v94, v95
v_cvt_pk_bf16_f32 v94, v96, v97
v_cvt_pk_bf16_f32 v95, v98, v99
v_cndmask_b32 v128, v128, v16, s[58:59]
v_cndmask_b32 v129, v129, v16, s[58:59]
ds_write_b64 v252, v[92:93] offset:0
ds_write_b64 v252, v[94:95] offset:1024
ds_write_b64 v252, v[128:129] offset:2048
s_waitcnt lgkmcnt(0)
s_barrier
ds_read_b128 a[8:11], v1 offset:2048
ds_read_b128 a[20:23], v1 offset:5120
ds_read_b128 a[0:3], v1 offset:0
ds_read_b128 a[12:15], v1 offset:3072
ds_read_b128 a[4:7], v1 offset:1024
ds_read_b128 a[16:19], v1 offset:4096
s_waitcnt lgkmcnt(5)
v_mfma_f32_16x16x32_bf16 v[116:119], a[8:11], v[212:215], 0
s_waitcnt lgkmcnt(4)
v_mfma_f32_16x16x32_bf16 v[120:123], a[20:23], v[216:219], 0
s_waitcnt lgkmcnt(3)
v_mfma_f32_16x16x32_bf16 v[204:207], a[0:3], v[212:215], 0
s_nop 3
v_rcp_f32 v118, v117
s_waitcnt lgkmcnt(2)
v_mfma_f32_16x16x32_bf16 v[220:223], a[12:15], v[216:219], 0
v_rcp_f32 v119, v121
v_mul_f32 v116, v116, v118
v_fmac_f32 v116, v120, v119
v_mfma_f32_16x16x32_bf16 v[100:103], a[8:11], v[164:167], 0
v_add_f32 v116, 0x358637bd, v116
v_rcp_f32 v116, v116
s_waitcnt lgkmcnt(1)
v_mfma_f32_16x16x32_bf16 v[208:211], a[4:7], v[212:215], 0
v_mul_f32 v118, v118, v116
v_mul_f32 v119, v119, v116
v_mfma_f32_16x16x32_bf16 v[104:107], a[20:23], v[168:171], 0
v_mul_f32 v204, v204, v118
v_mul_f32 v205, v205, v118
s_waitcnt lgkmcnt(0)
v_mfma_f32_16x16x32_bf16 v[224:227], a[16:19], v[216:219], 0
v_mul_f32 v206, v206, v118
v_mul_f32 v207, v207, v118
v_fmac_f32 v204, v220, v119
v_fmac_f32 v205, v221, v119
v_rcp_f32 v102, v101
v_mul_f32 v208, v208, v118
v_mul_f32 v209, v209, v118
v_mul_f32 v210, v210, v118
v_mul_f32 v211, v211, v118
v_fmac_f32 v206, v222, v119
v_fmac_f32 v207, v223, v119
v_cvt_pk_bf16_f32 v204, v204, v205
v_rcp_f32 v103, v105
v_fmac_f32 v208, v224, v119
v_fmac_f32 v209, v225, v119
v_fmac_f32 v210, v226, v119
v_fmac_f32 v211, v227, v119
v_cvt_pk_bf16_f32 v205, v206, v207
v_cvt_pk_bf16_f32 v206, v208, v209
v_cvt_pk_bf16_f32 v207, v210, v211
v_mul_f32 v100, v100, v102
v_mfma_f32_16x16x32_bf16 v[156:159], a[0:3], v[164:167], 0
buffer_store_dwordx4 v[204:207], v2, s[4:7], s72 offen offset:3072 sc1
v_fmac_f32 v100, v104, v103
v_mfma_f32_16x16x32_bf16 v[172:175], a[12:15], v[168:171], 0
v_add_f32 v100, 0x358637bd, v100
v_rcp_f32 v100, v100
v_mfma_f32_16x16x32_bf16 v[108:111], a[8:11], v[188:191], 0
v_mul_f32 v102, v102, v100
v_mul_f32 v103, v103, v100
v_mfma_f32_16x16x32_bf16 v[160:163], a[4:7], v[164:167], 0
v_mul_f32 v156, v156, v102
v_mul_f32 v157, v157, v102
v_mfma_f32_16x16x32_bf16 v[112:115], a[20:23], v[192:195], 0
v_mul_f32 v158, v158, v102
v_mul_f32 v159, v159, v102
v_mfma_f32_16x16x32_bf16 v[176:179], a[16:19], v[168:171], 0
v_fmac_f32 v156, v172, v103
v_fmac_f32 v157, v173, v103
v_rcp_f32 v110, v109
v_mul_f32 v160, v160, v102
v_mul_f32 v161, v161, v102
v_mul_f32 v162, v162, v102
v_mul_f32 v163, v163, v102
v_fmac_f32 v158, v174, v103
v_fmac_f32 v159, v175, v103
v_cvt_pk_bf16_f32 v156, v156, v157
v_rcp_f32 v111, v113
v_fmac_f32 v160, v176, v103
v_fmac_f32 v161, v177, v103
v_fmac_f32 v162, v178, v103
v_fmac_f32 v163, v179, v103
v_cvt_pk_bf16_f32 v157, v158, v159
v_cvt_pk_bf16_f32 v158, v160, v161
v_cvt_pk_bf16_f32 v159, v162, v163
v_mul_f32 v108, v108, v110
v_mfma_f32_16x16x32_bf16 v[180:183], a[0:3], v[188:191], 0
buffer_store_dwordx4 v[156:159], v2, s[4:7], s72 offen offset:1024 sc1
v_fmac_f32 v108, v112, v111
v_mfma_f32_16x16x32_bf16 v[196:199], a[12:15], v[192:195], 0
v_add_f32 v108, 0x358637bd, v108
v_rcp_f32 v108, v108
v_mfma_f32_16x16x32_bf16 v[92:95], a[8:11], v[140:143], 0
v_mul_f32 v110, v110, v108
v_mul_f32 v111, v111, v108
v_mfma_f32_16x16x32_bf16 v[184:187], a[4:7], v[188:191], 0
v_mul_f32 v180, v180, v110
v_mul_f32 v181, v181, v110
v_mfma_f32_16x16x32_bf16 v[96:99], a[20:23], v[144:147], 0
v_mul_f32 v182, v182, v110
v_mul_f32 v183, v183, v110
v_mfma_f32_16x16x32_bf16 v[200:203], a[16:19], v[192:195], 0
v_fmac_f32 v180, v196, v111
v_fmac_f32 v181, v197, v111
v_rcp_f32 v94, v93
v_mul_f32 v184, v184, v110
v_mul_f32 v185, v185, v110
v_mul_f32 v186, v186, v110
v_mul_f32 v187, v187, v110
v_fmac_f32 v182, v198, v111
v_fmac_f32 v183, v199, v111
v_cvt_pk_bf16_f32 v180, v180, v181
v_rcp_f32 v95, v97
v_fmac_f32 v184, v200, v111
v_fmac_f32 v185, v201, v111
v_fmac_f32 v186, v202, v111
v_fmac_f32 v187, v203, v111
v_cvt_pk_bf16_f32 v181, v182, v183
v_cvt_pk_bf16_f32 v182, v184, v185
v_cvt_pk_bf16_f32 v183, v186, v187
v_mul_f32 v92, v92, v94
v_mfma_f32_16x16x32_bf16 v[132:135], a[0:3], v[140:143], 0
buffer_store_dwordx4 v[180:183], v2, s[4:7], s72 offen offset:2048 sc1
buffer_atomic_add v12, v10, s[4:7], s74 offen sc1
v_fmac_f32 v92, v96, v95
v_mfma_f32_16x16x32_bf16 v[148:151], a[12:15], v[144:147], 0
v_add_f32 v92, 0x358637bd, v92
v_rcp_f32 v92, v92
v_mfma_f32_16x16x32_bf16 v[136:139], a[4:7], v[140:143], 0
v_mul_f32 v94, v94, v92
v_mul_f32 v95, v95, v92
v_mfma_f32_16x16x32_bf16 v[152:155], a[16:19], v[144:147], 0
v_mul_f32 v132, v132, v94
v_mul_f32 v133, v133, v94
v_mul_f32 v134, v134, v94
v_mul_f32 v135, v135, v94
v_fmac_f32 v132, v148, v95
v_fmac_f32 v133, v149, v95
v_mul_f32 v136, v136, v94
v_mul_f32 v137, v137, v94
v_mul_f32 v138, v138, v94
v_mul_f32 v139, v139, v94
v_fmac_f32 v134, v150, v95
v_fmac_f32 v135, v151, v95
v_cvt_pk_bf16_f32 v132, v132, v133
v_fmac_f32 v136, v152, v95
v_fmac_f32 v137, v153, v95
v_fmac_f32 v138, v154, v95
v_fmac_f32 v139, v155, v95
v_cvt_pk_bf16_f32 v133, v134, v135
v_cvt_pk_bf16_f32 v134, v136, v137
v_cvt_pk_bf16_f32 v135, v138, v139
buffer_store_dwordx4 v[132:135], v2, s[4:7], s72 offen offset:0 sc1
s_add_u32 s92, s71, 0x10000
s_add_u32 s40, s4, 0x2800000
s_addc_u32 s41, s5, 0
v_add_u32 v5, 32768, v1
v_add_u32 v6, 98304, v1
s_mov_b32 s35, 0
v_lshlrev_b32 v132, 16, v32
v_and_b32 v133, 0xffff0000, v32
v_lshlrev_b32 v134, 16, v33
v_and_b32 v135, 0xffff0000, v33
v_lshlrev_b32 v136, 16, v34
v_and_b32 v137, 0xffff0000, v34
v_lshlrev_b32 v138, 16, v35
v_and_b32 v139, 0xffff0000, v35
v_lshlrev_b32 v140, 16, v36
v_and_b32 v141, 0xffff0000, v36
v_lshlrev_b32 v142, 16, v37
v_and_b32 v143, 0xffff0000, v37
v_lshlrev_b32 v144, 16, v38
v_and_b32 v145, 0xffff0000, v38
v_lshlrev_b32 v146, 16, v39
v_and_b32 v147, 0xffff0000, v39
v_lshlrev_b32 v148, 16, v40
v_and_b32 v149, 0xffff0000, v40
v_lshlrev_b32 v150, 16, v41
v_and_b32 v151, 0xffff0000, v41
v_lshlrev_b32 v152, 16, v42
v_and_b32 v153, 0xffff0000, v42
v_lshlrev_b32 v154, 16, v43
v_and_b32 v155, 0xffff0000, v43
v_lshlrev_b32 v156, 16, v44
v_and_b32 v157, 0xffff0000, v44
v_lshlrev_b32 v158, 16, v45
v_and_b32 v159, 0xffff0000, v45
v_lshlrev_b32 v160, 16, v46
v_and_b32 v161, 0xffff0000, v46
v_lshlrev_b32 v162, 16, v47
v_and_b32 v163, 0xffff0000, v47
s_mov_b32 s95, -1
s_mov_b64 exec, 0
s_cmp_eq_u32 s28, 3
s_cbranch_scc1 L_stub9
s_cmp_eq_u32 s28, 2
s_cbranch_scc1 L_wret3
L_wret3:
s_mov_b64 exec, -1
s_cmp_lg_u32 s28, 1
s_cbranch_scc1 Lpo_28
s_add_u32 s36, s11, 0x10080
s_mov_b32 s37, 0
v_mov_b32 v11, 0
buffer_atomic_add v11, v251, s[4:7], s36 offen sc0 sc1
s_sleep 4
Lpoll_26:
v_mov_b32 v234, 0
buffer_atomic_add v234, v251, s[4:7], s36 offen sc0 sc1
s_waitcnt vmcnt(1)
v_readfirstlane_b32 s38, v11
s_nop 0
s_cmp_ge_u32 s38, 32
s_cbranch_scc1 Lpe_27
v_mov_b32 v11, 0
buffer_atomic_add v11, v251, s[4:7], s36 offen sc0 sc1
s_waitcnt vmcnt(1)
v_readfirstlane_b32 s38, v234
s_nop 0
s_cmp_ge_u32 s38, 32
s_cbranch_scc1 Lpe_27
s_add_u32 s37, s37, 1
s_cmp_lt_u32 s37, 0x80000
s_cbranch_scc1 Lpoll_26
s_waitcnt vmcnt(0)
Lpo_28:
s_waitcnt vmcnt(0)
Lpe_27:
s_barrier
L_k2go1:
buffer_load_dwordx4 a[0:3], v4, s[40:43], s35 offen offset:0 sc1
buffer_load_dwordx4 a[4:7], v4, s[40:43], s35 offen offset:1024 sc1
s_mov_b32 s35, 4096
buffer_load_dwordx4 a[8:11], v4, s[40:43], s35 offen offset:0 sc1
buffer_load_dwordx4 a[12:15], v4, s[40:43], s35 offen offset:1024 sc1
s_mov_b32 s35, 16384
buffer_load_dwordx4 a[16:19], v4, s[40:43], s35 offen offset:0 sc1
buffer_load_dwordx4 a[20:23], v4, s[40:43], s35 offen offset:1024 sc1
s_mov_b32 s35, 20480
buffer_load_dwordx4 a[24:27], v4, s[40:43], s35 offen offset:0 sc1
buffer_load_dwordx4 a[28:31], v4, s[40:43], s35 offen offset:1024 sc1
s_mov_b32 s35, 32768
buffer_load_dwordx4 a[32:35], v4, s[40:43], s35 offen offset:0 sc1
buffer_load_dwordx4 a[36:39], v4, s[40:43], s35 offen offset:1024 sc1
s_mov_b32 s35, 36864
buffer_load_dwordx4 a[40:43], v4, s[40:43], s35 offen offset:0 sc1
buffer_load_dwordx4 a[44:47], v4, s[40:43], s35 offen offset:1024 sc1
s_mov_b32 s35, 49152
ds_read_b128 a[96:99], v5 offset:0
ds_read_b128 a[100:103], v5 offset:1024
ds_read_b128 a[104:107], v5 offset:2048
ds_read_b128 a[108:111], v5 offset:3072
ds_read_b128 a[112:115], v5 offset:4096
ds_read_b128 a[116:119], v5 offset:5120
ds_read_b128 a[120:123], v5 offset:6144
ds_read_b128 a[124:127], v5 offset:7168
s_waitcnt vmcnt(10) lgkmcnt(4)
v_mfma_f32_16x16x32_bf16 v[132:135], a[96:99], a[0:3], v[132:135]
ds_read_b128 a[128:131], v5 offset:8192
v_mfma_f32_16x16x32_bf16 v[148:151], a[96:99], a[4:7], v[148:151]
ds_read_b128 a[132:135], v5 offset:9216
v_mfma_f32_16x16x32_bf16 v[152:155], a[100:103], a[4:7], v[152:155]
buffer_load_dwordx4 a[48:51], v4, s[40:43], s35 offen offset:0 sc1
v_mfma_f32_16x16x32_bf16 v[136:139], a[100:103], a[0:3], v[136:139]
ds_read_b128 a[136:139], v5 offset:10240
v_mfma_f32_16x16x32_bf16 v[140:143], a[104:107], a[0:3], v[140:143]
ds_read_b128 a[140:143], v5 offset:11264
v_mfma_f32_16x16x32_bf16 v[156:159], a[104:107], a[4:7], v[156:159]
v_mfma_f32_16x16x32_bf16 v[160:163], a[108:111], a[4:7], v[160:163]
buffer_load_dwordx4 a[52:55], v4, s[40:43], s35 offen offset:1024 sc1
s_mov_b32 s35, 53248
v_mfma_f32_16x16x32_bf16 v[144:147], a[108:111], a[0:3], v[144:147]
s_waitcnt vmcnt(10) lgkmcnt(4)
v_mfma_f32_16x16x32_bf16 v[132:135], a[112:115], a[8:11], v[132:135]
ds_read_b128 a[96:99], v5 offset:12288
v_mfma_f32_16x16x32_bf16 v[148:151], a[112:115], a[12:15], v[148:151]
ds_read_b128 a[100:103], v5 offset:13312
v_mfma_f32_16x16x32_bf16 v[152:155], a[116:119], a[12:15], v[152:155]
buffer_load_dwordx4 a[0:3], v4, s[40:43], s35 offen offset:0 sc1
v_mfma_f32_16x16x32_bf16 v[136:139], a[116:119], a[8:11], v[136:139]
ds_read_b128 a[104:107], v5 offset:14336
v_mfma_f32_16x16x32_bf16 v[140:143], a[120:123], a[8:11], v[140:143]
ds_read_b128 a[108:111], v5 offset:15360
v_mfma_f32_16x16x32_bf16 v[156:159], a[120:123], a[12:15], v[156:159]
v_mfma_f32_16x16x32_bf16 v[160:163], a[124:127], a[12:15], v[160:163]
buffer_load_dwordx4 a[4:7], v4, s[40:43], s35 offen offset:1024 sc1
s_mov_b32 s35, 65536
v_mfma_f32_16x16x32_bf16 v[144:147], a[124:127], a[8:11], v[144:147]
s_waitcnt vmcnt(10) lgkmcnt(4)
v_mfma_f32_16x16x32_bf16 v[132:135], a[128:131], a[16:19], v[132:135]
ds_read_b128 a[112:115], v5 offset:16384
v_mfma_f32_16x16x32_bf16 v[148:151], a[128:131], a[20:23], v[148:151]
ds_read_b128 a[116:119], v5 offset:17408
v_mfma_f32_16x16x32_bf16 v[152:155], a[132:135], a[20:23], v[152:155]
buffer_load_dwordx4 a[8:11], v4, s[40:43], s35 offen offset:0 sc1
v_mfma_f32_16x16x32_bf16 v[136:139], a[132:135], a[16:19], v[136:139]
ds_read_b128 a[120:123], v5 offset:18432
v_mfma_f32_16x16x32_bf16 v[140:143], a[136:139], a[16:19], v[140:143]
ds_read_b128 a[124:127], v5 offset:19456
v_mfma_f32_16x16x32_bf16 v[156:159], a[136:139], a[20:23], v[156:159]
v_mfma_f32_16x16x32_bf16 v[160:163], a[140:143], a[20:23], v[160:163]
buffer_load_dwordx4 a[12:15], v4, s[40:43], s35 offen offset:1024 sc1
s_mov_b32 s35, 69632
v_mfma_f32_16x16x32_bf16 v[144:147], a[140:143], a[16:19], v[144:147]
s_waitcnt vmcnt(10) lgkmcnt(4)
v_mfma_f32_16x16x32_bf16 v[132:135], a[96:99], a[24:27], v[132:135]
ds_read_b128 a[128:131], v5 offset:20480
v_mfma_f32_16x16x32_bf16 v[148:151], a[96:99], a[28:31], v[148:151]
ds_read_b128 a[132:135], v5 offset:21504
v_mfma_f32_16x16x32_bf16 v[152:155], a[100:103], a[28:31], v[152:155]
buffer_load_dwordx4 a[16:19], v4, s[40:43], s35 offen offset:0 sc1
v_mfma_f32_16x16x32_bf16 v[136:139], a[100:103], a[24:27], v[136:139]
ds_read_b128 a[136:139], v5 offset:22528
v_mfma_f32_16x16x32_bf16 v[140:143], a[104:107], a[24:27], v[140:143]
ds_read_b128 a[140:143], v5 offset:23552
v_mfma_f32_16x16x32_bf16 v[156:159], a[104:107], a[28:31], v[156:159]
v_mfma_f32_16x16x32_bf16 v[160:163], a[108:111], a[28:31], v[160:163]
buffer_load_dwordx4 a[20:23], v4, s[40:43], s35 offen offset:1024 sc1
s_mov_b32 s35, 81920
v_mfma_f32_16x16x32_bf16 v[144:147], a[108:111], a[24:27], v[144:147]
s_waitcnt vmcnt(10) lgkmcnt(4)
v_mfma_f32_16x16x32_bf16 v[132:135], a[112:115], a[32:35], v[132:135]
ds_read_b128 a[96:99], v5 offset:24576
v_mfma_f32_16x16x32_bf16 v[148:151], a[112:115], a[36:39], v[148:151]
ds_read_b128 a[100:103], v5 offset:25600
v_mfma_f32_16x16x32_bf16 v[152:155], a[116:119], a[36:39], v[152:155]
buffer_load_dwordx4 a[24:27], v4, s[40:43], s35 offen offset:0 sc1
v_mfma_f32_16x16x32_bf16 v[136:139], a[116:119], a[32:35], v[136:139]
ds_read_b128 a[104:107], v5 offset:26624
v_mfma_f32_16x16x32_bf16 v[140:143], a[120:123], a[32:35], v[140:143]
ds_read_b128 a[108:111], v5 offset:27648
v_mfma_f32_16x16x32_bf16 v[156:159], a[120:123], a[36:39], v[156:159]
v_mfma_f32_16x16x32_bf16 v[160:163], a[124:127], a[36:39], v[160:163]
buffer_load_dwordx4 a[28:31], v4, s[40:43], s35 offen offset:1024 sc1
s_mov_b32 s35, 86016
v_mfma_f32_16x16x32_bf16 v[144:147], a[124:127], a[32:35], v[144:147]
s_waitcnt vmcnt(10) lgkmcnt(4)
v_mfma_f32_16x16x32_bf16 v[132:135], a[128:131], a[40:43], v[132:135]
ds_read_b128 a[112:115], v5 offset:28672
v_mfma_f32_16x16x32_bf16 v[148:151], a[128:131], a[44:47], v[148:151]
ds_read_b128 a[116:119], v5 offset:29696
v_mfma_f32_16x16x32_bf16 v[152:155], a[132:135], a[44:47], v[152:155]
buffer_load_dwordx4 a[32:35], v4, s[40:43], s35 offen offset:0 sc1
v_mfma_f32_16x16x32_bf16 v[136:139], a[132:135], a[40:43], v[136:139]
ds_read_b128 a[120:123], v5 offset:30720
v_mfma_f32_16x16x32_bf16 v[140:143], a[136:139], a[40:43], v[140:143]
ds_read_b128 a[124:127], v5 offset:31744
v_mfma_f32_16x16x32_bf16 v[156:159], a[136:139], a[44:47], v[156:159]
v_mfma_f32_16x16x32_bf16 v[160:163], a[140:143], a[44:47], v[160:163]
buffer_load_dwordx4 a[36:39], v4, s[40:43], s35 offen offset:1024 sc1
s_mov_b32 s35, 98304
v_mfma_f32_16x16x32_bf16 v[144:147], a[140:143], a[40:43], v[144:147]
s_waitcnt vmcnt(10) lgkmcnt(4)
v_mfma_f32_16x16x32_bf16 v[132:135], a[96:99], a[48:51], v[132:135]
ds_read_b128 a[128:131], v5 offset:32768
v_mfma_f32_16x16x32_bf16 v[148:151], a[96:99], a[52:55], v[148:151]
ds_read_b128 a[132:135], v5 offset:33792
v_mfma_f32_16x16x32_bf16 v[152:155], a[100:103], a[52:55], v[152:155]
buffer_load_dwordx4 a[40:43], v4, s[40:43], s35 offen offset:0 sc1
v_mfma_f32_16x16x32_bf16 v[136:139], a[100:103], a[48:51], v[136:139]
ds_read_b128 a[136:139], v5 offset:34816
v_mfma_f32_16x16x32_bf16 v[140:143], a[104:107], a[48:51], v[140:143]
ds_read_b128 a[140:143], v5 offset:35840
v_mfma_f32_16x16x32_bf16 v[156:159], a[104:107], a[52:55], v[156:159]
v_mfma_f32_16x16x32_bf16 v[160:163], a[108:111], a[52:55], v[160:163]
buffer_load_dwordx4 a[44:47], v4, s[40:43], s35 offen offset:1024 sc1
s_mov_b32 s35, 102400
v_mfma_f32_16x16x32_bf16 v[144:147], a[108:111], a[48:51], v[144:147]
s_waitcnt vmcnt(10) lgkmcnt(4)
v_mfma_f32_16x16x32_bf16 v[132:135], a[112:115], a[0:3], v[132:135]
ds_read_b128 a[96:99], v5 offset:36864
v_mfma_f32_16x16x32_bf16 v[148:151], a[112:115], a[4:7], v[148:151]
ds_read_b128 a[100:103], v5 offset:37888
v_mfma_f32_16x16x32_bf16 v[152:155], a[116:119], a[4:7], v[152:155]
buffer_load_dwordx4 a[48:51], v4, s[40:43], s35 offen offset:0 sc1
v_mfma_f32_16x16x32_bf16 v[136:139], a[116:119], a[0:3], v[136:139]
ds_read_b128 a[104:107], v5 offset:38912
v_mfma_f32_16x16x32_bf16 v[140:143], a[120:123], a[0:3], v[140:143]
ds_read_b128 a[108:111], v5 offset:39936
v_mfma_f32_16x16x32_bf16 v[156:159], a[120:123], a[4:7], v[156:159]
v_mfma_f32_16x16x32_bf16 v[160:163], a[124:127], a[4:7], v[160:163]
buffer_load_dwordx4 a[52:55], v4, s[40:43], s35 offen offset:1024 sc1
s_mov_b32 s35, 114688
v_mfma_f32_16x16x32_bf16 v[144:147], a[124:127], a[0:3], v[144:147]
s_waitcnt vmcnt(10) lgkmcnt(4)
v_mfma_f32_16x16x32_bf16 v[132:135], a[128:131], a[8:11], v[132:135]
ds_read_b128 a[112:115], v5 offset:40960
v_mfma_f32_16x16x32_bf16 v[148:151], a[128:131], a[12:15], v[148:151]
ds_read_b128 a[116:119], v5 offset:41984
v_mfma_f32_16x16x32_bf16 v[152:155], a[132:135], a[12:15], v[152:155]
buffer_load_dwordx4 a[0:3], v4, s[40:43], s35 offen offset:0 sc1
v_mfma_f32_16x16x32_bf16 v[136:139], a[132:135], a[8:11], v[136:139]
ds_read_b128 a[120:123], v5 offset:43008
v_mfma_f32_16x16x32_bf16 v[140:143], a[136:139], a[8:11], v[140:143]
ds_read_b128 a[124:127], v5 offset:44032
v_mfma_f32_16x16x32_bf16 v[156:159], a[136:139], a[12:15], v[156:159]
v_mfma_f32_16x16x32_bf16 v[160:163], a[140:143], a[12:15], v[160:163]
buffer_load_dwordx4 a[4:7], v4, s[40:43], s35 offen offset:1024 sc1
s_mov_b32 s35, 118784
v_mfma_f32_16x16x32_bf16 v[144:147], a[140:143], a[8:11], v[144:147]
s_waitcnt vmcnt(10) lgkmcnt(4)
v_mfma_f32_16x16x32_bf16 v[132:135], a[96:99], a[16:19], v[132:135]
ds_read_b128 a[128:131], v5 offset:45056
v_mfma_f32_16x16x32_bf16 v[148:151], a[96:99], a[20:23], v[148:151]
ds_read_b128 a[132:135], v5 offset:46080
v_mfma_f32_16x16x32_bf16 v[152:155], a[100:103], a[20:23], v[152:155]
buffer_load_dwordx4 a[8:11], v4, s[40:43], s35 offen offset:0 sc1
v_mfma_f32_16x16x32_bf16 v[136:139], a[100:103], a[16:19], v[136:139]
L_stub9:
s_cbranch_execz L_wret3
ds_read_b128 a[136:139], v5 offset:47104
v_mfma_f32_16x16x32_bf16 v[140:143], a[104:107], a[16:19], v[140:143]
ds_read_b128 a[140:143], v5 offset:48128
v_mfma_f32_16x16x32_bf16 v[156:159], a[104:107], a[20:23], v[156:159]
v_mfma_f32_16x16x32_bf16 v[160:163], a[108:111], a[20:23], v[160:163]
buffer_load_dwordx4 a[12:15], v4, s[40:43], s35 offen offset:1024 sc1
s_mov_b32 s35, 524288
v_mfma_f32_16x16x32_bf16 v[144:147], a[108:111], a[16:19], v[144:147]
s_waitcnt vmcnt(10) lgkmcnt(4)
v_mfma_f32_16x16x32_bf16 v[132:135], a[112:115], a[24:27], v[132:135]
ds_read_b128 a[96:99], v5 offset:49152
v_mfma_f32_16x16x32_bf16 v[148:151], a[112:115], a[28:31], v[148:151]
ds_read_b128 a[100:103], v5 offset:50176
v_mfma_f32_16x16x32_bf16 v[152:155], a[116:119], a[28:31], v[152:155]
buffer_load_dwordx4 a[16:19], v4, s[40:43], s35 offen offset:0 sc1
v_mfma_f32_16x16x32_bf16 v[136:139], a[116:119], a[24:27], v[136:139]
ds_read_b128 a[104:107], v5 offset:51200
v_mfma_f32_16x16x32_bf16 v[140:143], a[120:123], a[24:27], v[140:143]
ds_read_b128 a[108:111], v5 offset:52224
v_mfma_f32_16x16x32_bf16 v[156:159], a[120:123], a[28:31], v[156:159]
v_mfma_f32_16x16x32_bf16 v[160:163], a[124:127], a[28:31], v[160:163]
buffer_load_dwordx4 a[20:23], v4, s[40:43], s35 offen offset:1024 sc1
s_mov_b32 s35, 528384
v_mfma_f32_16x16x32_bf16 v[144:147], a[124:127], a[24:27], v[144:147]
s_waitcnt vmcnt(10) lgkmcnt(4)
v_mfma_f32_16x16x32_bf16 v[132:135], a[128:131], a[32:35], v[132:135]
ds_read_b128 a[112:115], v5 offset:53248
v_mfma_f32_16x16x32_bf16 v[148:151], a[128:131], a[36:39], v[148:151]
ds_read_b128 a[116:119], v5 offset:54272
v_mfma_f32_16x16x32_bf16 v[152:155], a[132:135], a[36:39], v[152:155]
buffer_load_dwordx4 a[24:27], v4, s[40:43], s35 offen offset:0 sc1
v_mfma_f32_16x16x32_bf16 v[136:139], a[132:135], a[32:35], v[136:139]
ds_read_b128 a[120:123], v5 offset:55296
v_mfma_f32_16x16x32_bf16 v[140:143], a[136:139], a[32:35], v[140:143]
ds_read_b128 a[124:127], v5 offset:56320
v_mfma_f32_16x16x32_bf16 v[156:159], a[136:139], a[36:39], v[156:159]
v_mfma_f32_16x16x32_bf16 v[160:163], a[140:143], a[36:39], v[160:163]
buffer_load_dwordx4 a[28:31], v4, s[40:43], s35 offen offset:1024 sc1
s_mov_b32 s35, 540672
v_mfma_f32_16x16x32_bf16 v[144:147], a[140:143], a[32:35], v[144:147]
s_waitcnt vmcnt(10) lgkmcnt(4)
v_mfma_f32_16x16x32_bf16 v[132:135], a[96:99], a[40:43], v[132:135]
ds_read_b128 a[128:131], v5 offset:57344
v_mfma_f32_16x16x32_bf16 v[148:151], a[96:99], a[44:47], v[148:151]
ds_read_b128 a[132:135], v5 offset:58368
v_mfma_f32_16x16x32_bf16 v[152:155], a[100:103], a[44:47], v[152:155]
buffer_load_dwordx4 a[32:35], v4, s[40:43], s35 offen offset:0 sc1
v_mfma_f32_16x16x32_bf16 v[136:139], a[100:103], a[40:43], v[136:139]
ds_read_b128 a[136:139], v5 offset:59392
v_mfma_f32_16x16x32_bf16 v[140:143], a[104:107], a[40:43], v[140:143]
ds_read_b128 a[140:143], v5 offset:60416
v_mfma_f32_16x16x32_bf16 v[156:159], a[104:107], a[44:47], v[156:159]
v_mfma_f32_16x16x32_bf16 v[160:163], a[108:111], a[44:47], v[160:163]
buffer_load_dwordx4 a[36:39], v4, s[40:43], s35 offen offset:1024 sc1
s_mov_b32 s35, 544768
v_mfma_f32_16x16x32_bf16 v[144:147], a[108:111], a[40:43], v[144:147]
s_waitcnt vmcnt(10) lgkmcnt(4)
v_mfma_f32_16x16x32_bf16 v[132:135], a[112:115], a[48:51], v[132:135]
ds_read_b128 a[96:99], v5 offset:61440
v_mfma_f32_16x16x32_bf16 v[148:151], a[112:115], a[52:55], v[148:151]
ds_read_b128 a[100:103], v5 offset:62464
v_mfma_f32_16x16x32_bf16 v[152:155], a[116:119], a[52:55], v[152:155]
buffer_load_dwordx4 a[40:43], v4, s[40:43], s35 offen offset:0 sc1
v_mfma_f32_16x16x32_bf16 v[136:139], a[116:119], a[48:51], v[136:139]
ds_read_b128 a[104:107], v5 offset:63488
v_mfma_f32_16x16x32_bf16 v[140:143], a[120:123], a[48:51], v[140:143]
ds_read_b128 a[108:111], v5 offset:64512
v_mfma_f32_16x16x32_bf16 v[156:159], a[120:123], a[52:55], v[156:159]
v_mfma_f32_16x16x32_bf16 v[160:163], a[124:127], a[52:55], v[160:163]
buffer_load_dwordx4 a[44:47], v4, s[40:43], s35 offen offset:1024 sc1
s_mov_b32 s35, 557056
v_mfma_f32_16x16x32_bf16 v[144:147], a[124:127], a[48:51], v[144:147]
s_waitcnt vmcnt(10) lgkmcnt(4)
v_mfma_f32_16x16x32_bf16 v[132:135], a[128:131], a[0:3], v[132:135]
ds_read_b128 a[112:115], v6 offset:0
v_mfma_f32_16x16x32_bf16 v[148:151], a[128:131], a[4:7], v[148:151]
ds_read_b128 a[116:119], v6 offset:1024
v_mfma_f32_16x16x32_bf16 v[152:155], a[132:135], a[4:7], v[152:155]
buffer_load_dwordx4 a[48:51], v4, s[40:43], s35 offen offset:0 sc1
v_mfma_f32_16x16x32_bf16 v[136:139], a[132:135], a[0:3], v[136:139]
ds_read_b128 a[120:123], v6 offset:2048
v_mfma_f32_16x16x32_bf16 v[140:143], a[136:139], a[0:3], v[140:143]
ds_read_b128 a[124:127], v6 offset:3072
v_mfma_f32_16x16x32_bf16 v[156:159], a[136:139], a[4:7], v[156:159]
v_mfma_f32_16x16x32_bf16 v[160:163], a[140:143], a[4:7], v[160:163]
buffer_load_dwordx4 a[52:55], v4, s[40:43], s35 offen offset:1024 sc1
s_mov_b32 s35, 561152
v_mfma_f32_16x16x32_bf16 v[144:147], a[140:143], a[0:3], v[144:147]
s_waitcnt vmcnt(10) lgkmcnt(4)
v_mfma_f32_16x16x32_bf16 v[132:135], a[96:99], a[8:11], v[132:135]
ds_read_b128 a[128:131], v6 offset:4096
v_mfma_f32_16x16x32_bf16 v[148:151], a[96:99], a[12:15], v[148:151]
ds_read_b128 a[132:135], v6 offset:5120
v_mfma_f32_16x16x32_bf16 v[152:155], a[100:103], a[12:15], v[152:155]
buffer_load_dwordx4 a[0:3], v4, s[40:43], s35 offen offset:0 sc1
v_mfma_f32_16x16x32_bf16 v[136:139], a[100:103], a[8:11], v[136:139]
ds_read_b128 a[136:139], v6 offset:6144
v_mfma_f32_16x16x32_bf16 v[140:143], a[104:107], a[8:11], v[140:143]
ds_read_b128 a[140:143], v6 offset:7168
v_mfma_f32_16x16x32_bf16 v[156:159], a[104:107], a[12:15], v[156:159]
v_mfma_f32_16x16x32_bf16 v[160:163], a[108:111], a[12:15], v[160:163]
buffer_load_dwordx4 a[4:7], v4, s[40:43], s35 offen offset:1024 sc1
s_mov_b32 s35, 573440
v_mfma_f32_16x16x32_bf16 v[144:147], a[108:111], a[8:11], v[144:147]
s_waitcnt vmcnt(10) lgkmcnt(4)
v_mfma_f32_16x16x32_bf16 v[132:135], a[112:115], a[16:19], v[132:135]
ds_read_b128 a[96:99], v6 offset:8192
v_mfma_f32_16x16x32_bf16 v[148:151], a[112:115], a[20:23], v[148:151]
ds_read_b128 a[100:103], v6 offset:9216
v_mfma_f32_16x16x32_bf16 v[152:155], a[116:119], a[20:23], v[152:155]
buffer_load_dwordx4 a[8:11], v4, s[40:43], s35 offen offset:0 sc1
v_mfma_f32_16x16x32_bf16 v[136:139], a[116:119], a[16:19], v[136:139]
ds_read_b128 a[104:107], v6 offset:10240
v_mfma_f32_16x16x32_bf16 v[140:143], a[120:123], a[16:19], v[140:143]
ds_read_b128 a[108:111], v6 offset:11264
v_mfma_f32_16x16x32_bf16 v[156:159], a[120:123], a[20:23], v[156:159]
v_mfma_f32_16x16x32_bf16 v[160:163], a[124:127], a[20:23], v[160:163]
buffer_load_dwordx4 a[12:15], v4, s[40:43], s35 offen offset:1024 sc1
s_mov_b32 s35, 577536
v_mfma_f32_16x16x32_bf16 v[144:147], a[124:127], a[16:19], v[144:147]
s_waitcnt vmcnt(10) lgkmcnt(4)
v_mfma_f32_16x16x32_bf16 v[132:135], a[128:131], a[24:27], v[132:135]
ds_read_b128 a[112:115], v6 offset:12288
v_mfma_f32_16x16x32_bf16 v[148:151], a[128:131], a[28:31], v[148:151]
ds_read_b128 a[116:119], v6 offset:13312
v_mfma_f32_16x16x32_bf16 v[152:155], a[132:135], a[28:31], v[152:155]
buffer_load_dwordx4 a[16:19], v4, s[40:43], s35 offen offset:0 sc1
v_mfma_f32_16x16x32_bf16 v[136:139], a[132:135], a[24:27], v[136:139]
ds_read_b128 a[120:123], v6 offset:14336
v_mfma_f32_16x16x32_bf16 v[140:143], a[136:139], a[24:27], v[140:143]
ds_read_b128 a[124:127], v6 offset:15360
v_mfma_f32_16x16x32_bf16 v[156:159], a[136:139], a[28:31], v[156:159]
v_mfma_f32_16x16x32_bf16 v[160:163], a[140:143], a[28:31], v[160:163]
buffer_load_dwordx4 a[20:23], v4, s[40:43], s35 offen offset:1024 sc1
s_mov_b32 s35, 589824
v_mfma_f32_16x16x32_bf16 v[144:147], a[140:143], a[24:27], v[144:147]
s_waitcnt vmcnt(10) lgkmcnt(4)
v_mfma_f32_16x16x32_bf16 v[132:135], a[96:99], a[32:35], v[132:135]
ds_read_b128 a[128:131], v6 offset:16384
v_mfma_f32_16x16x32_bf16 v[148:151], a[96:99], a[36:39], v[148:151]
ds_read_b128 a[132:135], v6 offset:17408
v_mfma_f32_16x16x32_bf16 v[152:155], a[100:103], a[36:39], v[152:155]
buffer_load_dwordx4 a[24:27], v4, s[40:43], s35 offen offset:0 sc1
v_mfma_f32_16x16x32_bf16 v[136:139], a[100:103], a[32:35], v[136:139]
ds_read_b128 a[136:139], v6 offset:18432
v_mfma_f32_16x16x32_bf16 v[140:143], a[104:107], a[32:35], v[140:143]
ds_read_b128 a[140:143], v6 offset:19456
v_mfma_f32_16x16x32_bf16 v[156:159], a[104:107], a[36:39], v[156:159]
v_mfma_f32_16x16x32_bf16 v[160:163], a[108:111], a[36:39], v[160:163]
buffer_load_dwordx4 a[28:31], v4, s[40:43], s35 offen offset:1024 sc1
s_mov_b32 s35, 593920
v_mfma_f32_16x16x32_bf16 v[144:147], a[108:111], a[32:35], v[144:147]
s_waitcnt vmcnt(10) lgkmcnt(4)
v_mfma_f32_16x16x32_bf16 v[132:135], a[112:115], a[40:43], v[132:135]
ds_read_b128 a[96:99], v6 offset:20480
v_mfma_f32_16x16x32_bf16 v[148:151], a[112:115], a[44:47], v[148:151]
ds_read_b128 a[100:103], v6 offset:21504
v_mfma_f32_16x16x32_bf16 v[152:155], a[116:119], a[44:47], v[152:155]
buffer_load_dwordx4 a[32:35], v4, s[40:43], s35 offen offset:0 sc1
v_mfma_f32_16x16x32_bf16 v[136:139], a[116:119], a[40:43], v[136:139]
ds_read_b128 a[104:107], v6 offset:22528
v_mfma_f32_16x16x32_bf16 v[140:143], a[120:123], a[40:43], v[140:143]
ds_read_b128 a[108:111], v6 offset:23552
v_mfma_f32_16x16x32_bf16 v[156:159], a[120:123], a[44:47], v[156:159]
v_mfma_f32_16x16x32_bf16 v[160:163], a[124:127], a[44:47], v[160:163]
buffer_load_dwordx4 a[36:39], v4, s[40:43], s35 offen offset:1024 sc1
s_mov_b32 s35, 606208
v_mfma_f32_16x16x32_bf16 v[144:147], a[124:127], a[40:43], v[144:147]
s_waitcnt vmcnt(10) lgkmcnt(4)
v_mfma_f32_16x16x32_bf16 v[132:135], a[128:131], a[48:51], v[132:135]
ds_read_b128 a[112:115], v6 offset:24576
v_mfma_f32_16x16x32_bf16 v[148:151], a[128:131], a[52:55], v[148:151]
ds_read_b128 a[116:119], v6 offset:25600
v_mfma_f32_16x16x32_bf16 v[152:155], a[132:135], a[52:55], v[152:155]
buffer_load_dwordx4 a[40:43], v4, s[40:43], s35 offen offset:0 sc1
v_mfma_f32_16x16x32_bf16 v[136:139], a[132:135], a[48:51], v[136:139]
ds_read_b128 a[120:123], v6 offset:26624
v_mfma_f32_16x16x32_bf16 v[140:143], a[136:139], a[48:51], v[140:143]
ds_read_b128 a[124:127], v6 offset:27648
v_mfma_f32_16x16x32_bf16 v[156:159], a[136:139], a[52:55], v[156:159]
v_mfma_f32_16x16x32_bf16 v[160:163], a[140:143], a[52:55], v[160:163]
buffer_load_dwordx4 a[44:47], v4, s[40:43], s35 offen offset:1024 sc1
s_mov_b32 s35, 610304
v_mfma_f32_16x16x32_bf16 v[144:147], a[140:143], a[48:51], v[144:147]
s_waitcnt vmcnt(10) lgkmcnt(4)
v_mfma_f32_16x16x32_bf16 v[132:135], a[96:99], a[0:3], v[132:135]
ds_read_b128 a[128:131], v6 offset:28672
v_mfma_f32_16x16x32_bf16 v[148:151], a[96:99], a[4:7], v[148:151]
ds_read_b128 a[132:135], v6 offset:29696
v_mfma_f32_16x16x32_bf16 v[152:155], a[100:103], a[4:7], v[152:155]
buffer_load_dwordx4 a[48:51], v4, s[40:43], s35 offen offset:0 sc1
v_mfma_f32_16x16x32_bf16 v[136:139], a[100:103], a[0:3], v[136:139]
ds_read_b128 a[136:139], v6 offset:30720
v_mfma_f32_16x16x32_bf16 v[140:143], a[104:107], a[0:3], v[140:143]
ds_read_b128 a[140:143], v6 offset:31744
v_mfma_f32_16x16x32_bf16 v[156:159], a[104:107], a[4:7], v[156:159]
v_mfma_f32_16x16x32_bf16 v[160:163], a[108:111], a[4:7], v[160:163]
buffer_load_dwordx4 a[52:55], v4, s[40:43], s35 offen offset:1024 sc1
s_mov_b32 s35, 622592
v_mfma_f32_16x16x32_bf16 v[144:147], a[108:111], a[0:3], v[144:147]
s_waitcnt vmcnt(10) lgkmcnt(4)
v_mfma_f32_16x16x32_bf16 v[132:135], a[112:115], a[8:11], v[132:135]
ds_read_b128 a[96:99], v6 offset:32768
v_mfma_f32_16x16x32_bf16 v[148:151], a[112:115], a[12:15], v[148:151]
ds_read_b128 a[100:103], v6 offset:33792
v_mfma_f32_16x16x32_bf16 v[152:155], a[116:119], a[12:15], v[152:155]
buffer_load_dwordx4 a[0:3], v4, s[40:43], s35 offen offset:0 sc1
v_mfma_f32_16x16x32_bf16 v[136:139], a[116:119], a[8:11], v[136:139]
ds_read_b128 a[104:107], v6 offset:34816
v_mfma_f32_16x16x32_bf16 v[140:143], a[120:123], a[8:11], v[140:143]
ds_read_b128 a[108:111], v6 offset:35840
v_mfma_f32_16x16x32_bf16 v[156:159], a[120:123], a[12:15], v[156:159]
v_mfma_f32_16x16x32_bf16 v[160:163], a[124:127], a[12:15], v[160:163]
buffer_load_dwordx4 a[4:7], v4, s[40:43], s35 offen offset:1024 sc1
s_mov_b32 s35, 626688
v_mfma_f32_16x16x32_bf16 v[144:147], a[124:127], a[8:11], v[144:147]
s_waitcnt vmcnt(10) lgkmcnt(4)
v_mfma_f32_16x16x32_bf16 v[132:135], a[128:131], a[16:19], v[132:135]
ds_read_b128 a[112:115], v6 offset:36864
v_mfma_f32_16x16x32_bf16 v[148:151], a[128:131], a[20:23], v[148:151]
ds_read_b128 a[116:119], v6 offset:37888
v_mfma_f32_16x16x32_bf16 v[152:155], a[132:135], a[20:23], v[152:155]
buffer_load_dwordx4 a[8:11], v4, s[40:43], s35 offen offset:0 sc1
v_mfma_f32_16x16x32_bf16 v[136:139], a[132:135], a[16:19], v[136:139]
ds_read_b128 a[120:123], v6 offset:38912
v_mfma_f32_16x16x32_bf16 v[140:143], a[136:139], a[16:19], v[140:143]
ds_read_b128 a[124:127], v6 offset:39936
v_mfma_f32_16x16x32_bf16 v[156:159], a[136:139], a[20:23], v[156:159]
v_mfma_f32_16x16x32_bf16 v[160:163], a[140:143], a[20:23], v[160:163]
buffer_load_dwordx4 a[12:15], v4, s[40:43], s35 offen offset:1024 sc1
s_mov_b32 s35, 638976
v_mfma_f32_16x16x32_bf16 v[144:147], a[140:143], a[16:19], v[144:147]
s_waitcnt vmcnt(10) lgkmcnt(4)
v_mfma_f32_16x16x32_bf16 v[132:135], a[96:99], a[24:27], v[132:135]
ds_read_b128 a[128:131], v6 offset:40960
v_mfma_f32_16x16x32_bf16 v[148:151], a[96:99], a[28:31], v[148:151]
ds_read_b128 a[132:135], v6 offset:41984
v_mfma_f32_16x16x32_bf16 v[152:155], a[100:103], a[28:31], v[152:155]
buffer_load_dwordx4 a[16:19], v4, s[40:43], s35 offen offset:0 sc1
v_mfma_f32_16x16x32_bf16 v[136:139], a[100:103], a[24:27], v[136:139]
ds_read_b128 a[136:139], v6 offset:43008
v_mfma_f32_16x16x32_bf16 v[140:143], a[104:107], a[24:27], v[140:143]
ds_read_b128 a[140:143], v6 offset:44032
v_mfma_f32_16x16x32_bf16 v[156:159], a[104:107], a[28:31], v[156:159]
v_mfma_f32_16x16x32_bf16 v[160:163], a[108:111], a[28:31], v[160:163]
buffer_load_dwordx4 a[20:23], v4, s[40:43], s35 offen offset:1024 sc1
s_mov_b32 s35, 643072
v_mfma_f32_16x16x32_bf16 v[144:147], a[108:111], a[24:27], v[144:147]
s_waitcnt vmcnt(10) lgkmcnt(4)
v_mfma_f32_16x16x32_bf16 v[132:135], a[112:115], a[32:35], v[132:135]
ds_read_b128 a[96:99], v6 offset:45056
v_mfma_f32_16x16x32_bf16 v[148:151], a[112:115], a[36:39], v[148:151]
ds_read_b128 a[100:103], v6 offset:46080
v_mfma_f32_16x16x32_bf16 v[152:155], a[116:119], a[36:39], v[152:155]
buffer_load_dwordx4 a[24:27], v4, s[40:43], s35 offen offset:0 sc1
v_mfma_f32_16x16x32_bf16 v[136:139], a[116:119], a[32:35], v[136:139]
ds_read_b128 a[104:107], v6 offset:47104
v_mfma_f32_16x16x32_bf16 v[140:143], a[120:123], a[32:35], v[140:143]
ds_read_b128 a[108:111], v6 offset:48128
v_mfma_f32_16x16x32_bf16 v[156:159], a[120:123], a[36:39], v[156:159]
v_mfma_f32_16x16x32_bf16 v[160:163], a[124:127], a[36:39], v[160:163]
buffer_load_dwordx4 a[28:31], v4, s[40:43], s35 offen offset:1024 sc1
s_mov_b32 s35, 1048576
v_mfma_f32_16x16x32_bf16 v[144:147], a[124:127], a[32:35], v[144:147]
s_waitcnt vmcnt(10) lgkmcnt(4)
v_mfma_f32_16x16x32_bf16 v[132:135], a[128:131], a[40:43], v[132:135]
s_add_u32 m0, s18, 0x0
s_add_u32 s44, s50, 0x2c00000
v_mfma_f32_16x16x32_bf16 v[148:151], a[128:131], a[44:47], v[148:151]
ds_read_b128 a[112:115], v6 offset:49152
v_mfma_f32_16x16x32_bf16 v[152:155], a[132:135], a[44:47], v[152:155]
buffer_load_dwordx4 v1, s[4:7], s44 offen offset:0 sc1 lds
v_mfma_f32_16x16x32_bf16 v[136:139], a[132:135], a[40:43], v[136:139]
ds_read_b128 a[116:119], v6 offset:50176
v_mfma_f32_16x16x32_bf16 v[140:143], a[136:139], a[40:43], v[140:143]
ds_read_b128 a[120:123], v6 offset:51200
v_mfma_f32_16x16x32_bf16 v[156:159], a[136:139], a[44:47], v[156:159]
ds_read_b128 a[124:127], v6 offset:52224
v_mfma_f32_16x16x32_bf16 v[160:163], a[140:143], a[44:47], v[160:163]
buffer_load_dwordx4 v1, s[4:7], s44 offen offset:1024 sc1 lds
s_add_u32 m0, s18, 0x2000
v_mfma_f32_16x16x32_bf16 v[144:147], a[140:143], a[40:43], v[144:147]
s_add_u32 s44, s50, 0x2c02000
s_waitcnt vmcnt(10) lgkmcnt(4)
v_mfma_f32_16x16x32_bf16 v[132:135], a[96:99], a[48:51], v[132:135]
ds_read_b128 a[128:131], v6 offset:53248
v_mfma_f32_16x16x32_bf16 v[148:151], a[96:99], a[52:55], v[148:151]
ds_read_b128 a[132:135], v6 offset:54272
v_mfma_f32_16x16x32_bf16 v[152:155], a[100:103], a[52:55], v[152:155]
buffer_load_dwordx4 v1, s[4:7], s44 offen offset:0 sc1 lds
v_mfma_f32_16x16x32_bf16 v[136:139], a[100:103], a[48:51], v[136:139]
ds_read_b128 a[136:139], v6 offset:55296
v_mfma_f32_16x16x32_bf16 v[140:143], a[104:107], a[48:51], v[140:143]
ds_read_b128 a[140:143], v6 offset:56320
v_mfma_f32_16x16x32_bf16 v[156:159], a[104:107], a[52:55], v[156:159]
v_mfma_f32_16x16x32_bf16 v[160:163], a[108:111], a[52:55], v[160:163]
buffer_load_dwordx4 v1, s[4:7], s44 offen offset:1024 sc1 lds
s_add_u32 m0, s18, 0x4000
v_mfma_f32_16x16x32_bf16 v[144:147], a[108:111], a[48:51], v[144:147]
s_add_u32 s44, s50, 0x2c04000
s_waitcnt vmcnt(10) lgkmcnt(4)
v_mfma_f32_16x16x32_bf16 v[132:135], a[112:115], a[0:3], v[132:135]
ds_read_b128 a[96:99], v6 offset:57344
v_mfma_f32_16x16x32_bf16 v[148:151], a[112:115], a[4:7], v[148:151]
ds_read_b128 a[100:103], v6 offset:58368
v_mfma_f32_16x16x32_bf16 v[152:155], a[116:119], a[4:7], v[152:155]
ds_read_b128 a[104:107], v6 offset:59392
v_mfma_f32_16x16x32_bf16 v[136:139], a[116:119], a[0:3], v[136:139]
buffer_load_dwordx4 v1, s[4:7], s44 offen offset:0 sc1 lds
v_mfma_f32_16x16x32_bf16 v[140:143], a[120:123], a[0:3], v[140:143]
ds_read_b128 a[108:111], v6 offset:60416
v_mfma_f32_16x16x32_bf16 v[156:159], a[120:123], a[4:7], v[156:159]
v_mfma_f32_16x16x32_bf16 v[160:163], a[124:127], a[4:7], v[160:163]
v_mfma_f32_16x16x32_bf16 v[144:147], a[124:127], a[0:3], v[144:147]
buffer_load_dwordx4 v1, s[4:7], s44 offen offset:1024 sc1 lds
s_waitcnt vmcnt(10) lgkmcnt(4)
v_mfma_f32_16x16x32_bf16 v[132:135], a[128:131], a[8:11], v[132:135]
s_add_u32 m0, s18, 0x6000
s_add_u32 s44, s50, 0x2c06000
v_mfma_f32_16x16x32_bf16 v[148:151], a[128:131], a[12:15], v[148:151]
ds_read_b128 a[112:115], v6 offset:61440
v_mfma_f32_16x16x32_bf16 v[152:155], a[132:135], a[12:15], v[152:155]
ds_read_b128 a[116:119], v6 offset:62464
v_mfma_f32_16x16x32_bf16 v[136:139], a[132:135], a[8:11], v[136:139]
ds_read_b128 a[120:123], v6 offset:63488
v_mfma_f32_16x16x32_bf16 v[140:143], a[136:139], a[8:11], v[140:143]
buffer_load_dwordx4 v1, s[4:7], s44 offen offset:0 sc1 lds
v_mfma_f32_16x16x32_bf16 v[156:159], a[136:139], a[12:15], v[156:159]
ds_read_b128 a[124:127], v6 offset:64512
v_mfma_f32_16x16x32_bf16 v[160:163], a[140:143], a[12:15], v[160:163]
v_mfma_f32_16x16x32_bf16 v[144:147], a[140:143], a[8:11], v[144:147]
s_waitcnt vmcnt(9) lgkmcnt(4)
v_mfma_f32_16x16x32_bf16 v[132:135], a[96:99], a[16:19], v[132:135]
v_mfma_f32_16x16x32_bf16 v[148:151], a[96:99], a[20:23], v[148:151]
buffer_load_dwordx4 v1, s[4:7], s44 offen offset:1024 sc1 lds
v_mfma_f32_16x16x32_bf16 v[152:155], a[100:103], a[20:23], v[152:155]
v_mfma_f32_16x16x32_bf16 v[136:139], a[100:103], a[16:19], v[136:139]
v_mfma_f32_16x16x32_bf16 v[140:143], a[104:107], a[16:19], v[140:143]
v_mfma_f32_16x16x32_bf16 v[156:159], a[104:107], a[20:23], v[156:159]
v_mfma_f32_16x16x32_bf16 v[160:163], a[108:111], a[20:23], v[160:163]
v_mfma_f32_16x16x32_bf16 v[144:147], a[108:111], a[16:19], v[144:147]
s_waitcnt vmcnt(8) lgkmcnt(0)
v_mfma_f32_16x16x32_bf16 v[132:135], a[112:115], a[24:27], v[132:135]
v_mfma_f32_16x16x32_bf16 v[148:151], a[112:115], a[28:31], v[148:151]
v_mfma_f32_16x16x32_bf16 v[152:155], a[116:119], a[28:31], v[152:155]
buffer_atomic_add v12, v10, s[4:7], s92 offen sc1
v_mfma_f32_16x16x32_bf16 v[136:139], a[116:119], a[24:27], v[136:139]
v_mfma_f32_16x16x32_bf16 v[140:143], a[120:123], a[24:27], v[140:143]
v_mfma_f32_16x16x32_bf16 v[156:159], a[120:123], a[28:31], v[156:159]
v_mfma_f32_16x16x32_bf16 v[160:163], a[124:127], a[28:31], v[160:163]
v_mfma_f32_16x16x32_bf16 v[144:147], a[124:127], a[24:27], v[144:147]
s_nop 0
v_cmp_u_f32 vcc, v132, v148
s_nop 0
s_and_b32 vcc_lo, vcc_lo, s95
s_cbranch_scc1 L_k2redo1
s_lshr_b32 s37, s32, 3
s_and_b32 s36, s32, 7
s_mul_i32 s37, s37, 524288
s_lshl_b32 s36, s36, 14
s_add_u32 s36, s36, s37
v_cvt_pk_bf16_f32 v32, v132, v133
v_cvt_pk_bf16_f32 v33, v134, v135
v_cvt_pk_bf16_f32 v34, v136, v137
v_cvt_pk_bf16_f32 v35, v138, v139
s_add_u32 s36, s36, 0x2000000
buffer_store_dwordx4 v[32:35], v4, s[4:7], s36 offen offset:0 sc1
v_cvt_pk_bf16_f32 v40, v148, v149
v_cvt_pk_bf16_f32 v41, v150, v151
v_cvt_pk_bf16_f32 v42, v152, v153
v_cvt_pk_bf16_f32 v43, v154, v155
v_cvt_pk_bf16_f32 v36, v140, v141
v_cvt_pk_bf16_f32 v37, v142, v143
v_cvt_pk_bf16_f32 v38, v144, v145
v_cvt_pk_bf16_f32 v39, v146, v147
s_add_u32 s37, s36, 4096
v_cvt_pk_bf16_f32 v44, v156, v157
v_cvt_pk_bf16_f32 v45, v158, v159
v_cvt_pk_bf16_f32 v46, v160, v161
buffer_store_dwordx4 v[40:43], v4, s[4:7], s36 offen offset:1024 sc1
v_cvt_pk_bf16_f32 v47, v162, v163
v_mfma_f32_16x16x32_bf16 v[96:99], v[32:35], v[32:35], 0
s_mov_b32 s38, 0x280000
s_add_u32 s92, s78, 0x50000
v_mfma_f32_16x16x32_bf16 v[92:95], v[16:19], v[32:35], 0
s_add_u32 s40, s4, 0x2000000
s_addc_u32 s41, s5, 0
v_mfma_f32_16x16x32_bf16 v[96:99], v[36:39], v[36:39], v[96:99]
buffer_store_dwordx4 v[36:39], v4, s[4:7], s37 offen offset:0 sc1
v_mfma_f32_16x16x32_bf16 v[92:95], v[16:19], v[36:39], v[92:95]
s_nop 5
v_cndmask_b32 v96, v96, v97, s[46:47]
v_cndmask_b32 v98, v98, v99, s[46:47]
v_mfma_f32_16x16x32_bf16 v[104:107], v[40:43], v[40:43], 0
v_mfma_f32_16x16x32_bf16 v[100:103], v[16:19], v[40:43], 0
v_cndmask_b32 v93, v96, v98, s[48:49]
buffer_store_dwordx4 v[44:47], v4, s[4:7], s37 offen offset:1024 sc1
v_mfma_f32_16x16x32_bf16 v[104:107], v[44:47], v[44:47], v[104:107]
v_mfma_f32_16x16x32_bf16 v[100:103], v[16:19], v[44:47], v[100:103]
s_nop 6
v_cndmask_b32 v104, v104, v105, s[46:47]
v_cndmask_b32 v106, v106, v107, s[46:47]
buffer_store_dwordx2 v[92:93], v253, s[4:7], s38 offen offset:0 sc1
v_cndmask_b32 v101, v104, v106, s[48:49]
buffer_store_dwordx2 v[100:101], v253, s[4:7], s38 offen offset:2048 sc1
s_barrier
s_add_u32 m0, s18, 0x8000
s_add_u32 s44, s50, 0x2c08000
buffer_load_dwordx4 v1, s[4:7], s44 offen offset:0 sc1 lds
buffer_load_dwordx4 v1, s[4:7], s44 offen offset:1024 sc1 lds
s_add_u32 m0, s18, 0xa000
s_add_u32 s44, s50, 0x2c0a000
buffer_load_dwordx4 v1, s[4:7], s44 offen offset:0 sc1 lds
buffer_load_dwordx4 v1, s[4:7], s44 offen offset:1024 sc1 lds
v_accvgpr_read_b32 v48, a188
v_accvgpr_read_b32 v49, a189
v_accvgpr_read_b32 v50, a190
v_accvgpr_read_b32 v51, a191
v_accvgpr_read_b32 v52, a192
v_accvgpr_read_b32 v53, a193
v_accvgpr_read_b32 v54, a194
v_accvgpr_read_b32 v55, a195
v_accvgpr_read_b32 v56, a196
v_accvgpr_read_b32 v57, a197
v_accvgpr_read_b32 v58, a198
v_accvgpr_read_b32 v59, a199
v_accvgpr_read_b32 v60, a200
v_accvgpr_read_b32 v61, a201
v_accvgpr_read_b32 v62, a202
v_accvgpr_read_b32 v63, a203
v_accvgpr_read_b32 v64, a204
v_accvgpr_read_b32 v65, a205
v_accvgpr_read_b32 v66, a206
v_accvgpr_read_b32 v67, a207
v_accvgpr_read_b32 v68, a208
v_accvgpr_read_b32 v69, a209
v_accvgpr_read_b32 v70, a210
v_accvgpr_read_b32 v71, a211
s_waitcnt vmcnt(4)
s_barrier
s_cmp_lg_u32 s28, 0
s_cbranch_scc1 Lsg_29
buffer_atomic_add v12, v10, s[4:7], s92 offen sc1
Lsg_29:
s_mov_b64 exec, 0
s_cmp_eq_u32 s28, 0
s_cbranch_scc1 L_stub10
L_wret4:
s_mov_b64 exec, -1
s_cmp_lt_u32 s28, 2
s_cbranch_scc1 Lwd_30
s_add_u32 m0, s19, 0xa000
s_add_u32 s44, s50, 0x2c0a000
s_add_u32 s44, s44, s18
buffer_load_dwordx4 v1, s[4:7], s44 offen offset:0 sc1 lds
buffer_load_dwordx4 v1, s[4:7], s44 offen offset:1024 sc1 lds
buffer_load_dwordx4 v1, s[4:7], s44 offen offset:2048 sc1 lds
buffer_load_dwordx4 v1, s[4:7], s44 offen offset:3072 sc1 lds
s_add_u32 m0, s19, 0xc000
s_add_u32 s44, s50, 0x2c0c000
s_add_u32 s44, s44, s18
buffer_load_dwordx4 v1, s[4:7], s44 offen offset:0 sc1 lds
buffer_load_dwordx4 v1, s[4:7], s44 offen offset:1024 sc1 lds
buffer_load_dwordx4 v1, s[4:7], s44 offen offset:2048 sc1 lds
buffer_load_dwordx4 v1, s[4:7], s44 offen offset:3072 sc1 lds
s_add_u32 m0, s19, 0xe000
s_add_u32 s44, s50, 0x2c0e000
s_add_u32 s44, s44, s18
buffer_load_dwordx4 v1, s[4:7], s44 offen offset:0 sc1 lds
buffer_load_dwordx4 v1, s[4:7], s44 offen offset:1024 sc1 lds
buffer_load_dwordx4 v1, s[4:7], s44 offen offset:2048 sc1 lds
buffer_load_dwordx4 v1, s[4:7], s44 offen offset:3072 sc1 lds
s_add_u32 m0, s19, 0x10000
s_add_u32 s44, s50, 0x2c10000
s_add_u32 s44, s44, s18
buffer_load_dwordx4 v1, s[4:7], s44 offen offset:0 sc1 lds
buffer_load_dwordx4 v1, s[4:7], s44 offen offset:1024 sc1 lds
buffer_load_dwordx4 v1, s[4:7], s44 offen offset:2048 sc1 lds
buffer_load_dwordx4 v1, s[4:7], s44 offen offset:3072 sc1 lds
s_add_u32 m0, s19, 0x12000
s_add_u32 s44, s50, 0x2c12000
s_add_u32 s44, s44, s18
buffer_load_dwordx4 v1, s[4:7], s44 offen offset:0 sc1 lds
buffer_load_dwordx4 v1, s[4:7], s44 offen offset:1024 sc1 lds
buffer_load_dwordx4 v1, s[4:7], s44 offen offset:2048 sc1 lds
buffer_load_dwordx4 v1, s[4:7], s44 offen offset:3072 sc1 lds
s_add_u32 m0, s19, 0x14000
s_add_u32 s44, s50, 0x2c14000
s_add_u32 s44, s44, s18
buffer_load_dwordx4 v1, s[4:7], s44 offen offset:0 sc1 lds
buffer_load_dwordx4 v1, s[4:7], s44 offen offset:1024 sc1 lds
buffer_load_dwordx4 v1, s[4:7], s44 offen offset:2048 sc1 lds
buffer_load_dwordx4 v1, s[4:7], s44 offen offset:3072 sc1 lds
s_add_u32 m0, s19, 0x16000
s_add_u32 s44, s50, 0x2c16000
s_add_u32 s44, s44, s18
buffer_load_dwordx4 v1, s[4:7], s44 offen offset:0 sc1 lds
buffer_load_dwordx4 v1, s[4:7], s44 offen offset:1024 sc1 lds
buffer_load_dwordx4 v1, s[4:7], s44 offen offset:2048 sc1 lds
buffer_load_dwordx4 v1, s[4:7], s44 offen offset:3072 sc1 lds
s_add_u32 m0, s19, 0x18000
s_add_u32 s44, s50, 0x2c18000
s_add_u32 s44, s44, s18
buffer_load_dwordx4 v1, s[4:7], s44 offen offset:0 sc1 lds
buffer_load_dwordx4 v1, s[4:7], s44 offen offset:1024 sc1 lds
buffer_load_dwordx4 v1, s[4:7], s44 offen offset:2048 sc1 lds
buffer_load_dwordx4 v1, s[4:7], s44 offen offset:3072 sc1 lds
Lwd_30:
s_cmp_lg_u32 s28, 1
s_cbranch_scc1 Lpo_33
s_add_u32 s36, s34, 0x50000
s_mov_b32 s37, 0
v_mov_b32 v11, 0
buffer_atomic_add v11, v251, s[4:7], s36 offen sc0 sc1
s_sleep 4
Lpoll_31:
v_mov_b32 v234, 0
buffer_atomic_add v234, v251, s[4:7], s36 offen sc0 sc1
s_waitcnt vmcnt(1)
v_readfirstlane_b32 s38, v11
s_nop 0
s_cmp_ge_u32 s38, 32
s_cbranch_scc1 Lpe_32
v_mov_b32 v11, 0
buffer_atomic_add v11, v251, s[4:7], s36 offen sc0 sc1
s_waitcnt vmcnt(1)
v_readfirstlane_b32 s38, v234
s_nop 0
s_cmp_ge_u32 s38, 32
s_cbranch_scc1 Lpe_32
s_add_u32 s37, s37, 1
s_cmp_lt_u32 s37, 0x80000
s_cbranch_scc1 Lpoll_31
s_waitcnt vmcnt(0)
Lpo_33:
s_waitcnt vmcnt(32) lgkmcnt(0)
s_cmp_ge_u32 s28, 2
s_cbranch_scc1 Lw_34
s_waitcnt vmcnt(0)
Lw_34:
Lpe_32:
s_barrier
s_add_u32 s94, s71, 0x20080
s_mov_b32 s35, 0
s_add_u32 s33, s35, 0x1000
buffer_load_dwordx4 a[0:3], v2, s[40:43], s35 offen offset:0 sc1
buffer_load_dwordx4 a[4:7], v2, s[40:43], s33 offen offset:0 sc1
buffer_load_dwordx4 a[8:11], v2, s[40:43], s35 offen offset:1024 sc1
buffer_load_dwordx4 a[12:15], v2, s[40:43], s33 offen offset:1024 sc1
buffer_load_dwordx4 a[16:19], v2, s[40:43], s35 offen offset:2048 sc1
buffer_load_dwordx4 a[20:23], v2, s[40:43], s33 offen offset:2048 sc1
buffer_load_dwordx4 a[24:27], v2, s[40:43], s35 offen offset:3072 sc1
buffer_load_dwordx4 a[28:31], v2, s[40:43], s33 offen offset:3072 sc1
s_add_u32 s35, s35, 0x4000
s_add_u32 s33, s33, 0x4000
buffer_load_dwordx4 a[32:35], v2, s[40:43], s35 offen offset:0 sc1
buffer_load_dwordx4 a[36:39], v2, s[40:43], s33 offen offset:0 sc1
buffer_load_dwordx4 a[40:43], v2, s[40:43], s35 offen offset:1024 sc1
buffer_load_dwordx4 a[44:47], v2, s[40:43], s33 offen offset:1024 sc1
L_stub10:
s_cbranch_execz L_stub11
buffer_load_dwordx4 a[48:51], v2, s[40:43], s35 offen offset:2048 sc1
buffer_load_dwordx4 a[52:55], v2, s[40:43], s33 offen offset:2048 sc1
buffer_load_dwordx4 a[56:59], v2, s[40:43], s35 offen offset:3072 sc1
buffer_load_dwordx4 a[60:63], v2, s[40:43], s33 offen offset:3072 sc1
s_add_u32 s35, s35, 0x4000
s_add_u32 s33, s33, 0x4000
v_add_u32 v5, 0, v1
ds_read_b128 a[96:99], v5 offset:2048
ds_read_b128 a[100:103], v5 offset:8192
ds_read_b128 a[104:107], v5 offset:3072
ds_read_b128 a[108:111], v5 offset:9216
ds_read_b128 a[112:115], v5 offset:4096
ds_read_b128 a[116:119], v5 offset:10240
s_waitcnt vmcnt(14) lgkmcnt(4)
v_mfma_f32_16x16x32_bf16 v[140:143], a[96:99], a[0:3], 0
s_add_u32 m0, s18, 0x1c000
s_add_u32 s44, s50, 0x2c1c000
v_mfma_f32_16x16x32_bf16 v[140:143], a[100:103], a[4:7], v[140:143]
buffer_load_dwordx4 a[64:67], v2, s[40:43], s35 offen offset:0 sc1
s_waitcnt vmcnt(13)
v_mfma_f32_16x16x32_bf16 v[164:167], a[100:103], a[12:15], 0
ds_read_b128 a[128:131], v5 offset:5120
v_mfma_f32_16x16x32_bf16 v[164:167], a[96:99], a[8:11], v[164:167]
ds_read_b128 a[132:135], v5 offset:11264
s_waitcnt vmcnt(12)
v_mfma_f32_16x16x32_bf16 v[188:191], a[96:99], a[16:19], 0
s_waitcnt vmcnt(11)
v_mfma_f32_16x16x32_bf16 v[188:191], a[100:103], a[20:23], v[188:191]
buffer_load_dwordx4 a[68:71], v2, s[40:43], s33 offen offset:0 sc1
s_waitcnt vmcnt(10)
v_mfma_f32_16x16x32_bf16 v[212:215], a[100:103], a[28:31], 0
ds_read_b128 a[136:139], v5 offset:0
v_mfma_f32_16x16x32_bf16 v[212:215], a[96:99], a[24:27], v[212:215]
s_waitcnt lgkmcnt(6)
v_mfma_f32_16x16x32_bf16 v[216:219], a[104:107], a[24:27], 0
ds_read_b128 a[140:143], v5 offset:6144
s_waitcnt lgkmcnt(6)
v_mfma_f32_16x16x32_bf16 v[216:219], a[108:111], a[28:31], v[216:219]
v_mfma_f32_16x16x32_bf16 v[192:195], a[108:111], a[20:23], 0
buffer_load_dwordx4 v1, s[4:7], s44 offen offset:0 sc1 lds
v_mfma_f32_16x16x32_bf16 v[192:195], a[104:107], a[16:19], v[192:195]
ds_read_b128 a[144:147], v5 offset:1024
v_mfma_f32_16x16x32_bf16 v[168:171], a[104:107], a[8:11], 0
v_mfma_f32_16x16x32_bf16 v[168:171], a[108:111], a[12:15], v[168:171]
ds_read_b128 a[148:151], v5 offset:7168
v_mfma_f32_16x16x32_bf16 v[144:147], a[108:111], a[4:7], 0
v_mfma_f32_16x16x32_bf16 v[144:147], a[104:107], a[0:3], v[144:147]
buffer_load_dwordx4 a[72:75], v2, s[40:43], s35 offen offset:1024 sc1
s_waitcnt lgkmcnt(7)
v_mfma_f32_16x16x32_bf16 v[148:151], a[112:115], a[0:3], 0
s_waitcnt lgkmcnt(6)
v_mfma_f32_16x16x32_bf16 v[148:151], a[116:119], a[4:7], v[148:151]
v_mfma_f32_16x16x32_bf16 v[172:175], a[116:119], a[12:15], 0
v_mfma_f32_16x16x32_bf16 v[172:175], a[112:115], a[8:11], v[172:175]
v_mfma_f32_16x16x32_bf16 v[196:199], a[112:115], a[16:19], 0
buffer_load_dwordx4 a[76:79], v2, s[40:43], s33 offen offset:1024 sc1
v_mfma_f32_16x16x32_bf16 v[196:199], a[116:119], a[20:23], v[196:199]
v_mfma_f32_16x16x32_bf16 v[220:223], a[116:119], a[28:31], 0
v_mfma_f32_16x16x32_bf16 v[220:223], a[112:115], a[24:27], v[220:223]
s_waitcnt lgkmcnt(0)
v_mfma_f32_16x16x32_bf16 v[224:227], a[128:131], a[24:27], 0
ds_read_b128 a[96:99], v5 offset:14336
v_mfma_f32_16x16x32_bf16 v[224:227], a[132:135], a[28:31], v[224:227]
buffer_load_dwordx4 a[80:83], v2, s[40:43], s35 offen offset:2048 sc1
v_mfma_f32_16x16x32_bf16 v[200:203], a[132:135], a[20:23], 0
ds_read_b128 a[100:103], v5 offset:20480
v_mfma_f32_16x16x32_bf16 v[200:203], a[128:131], a[16:19], v[200:203]
v_mfma_f32_16x16x32_bf16 v[176:179], a[128:131], a[8:11], 0
v_mfma_f32_16x16x32_bf16 v[176:179], a[132:135], a[12:15], v[176:179]
buffer_load_dwordx4 a[84:87], v2, s[40:43], s33 offen offset:2048 sc1
v_mfma_f32_16x16x32_bf16 v[152:155], a[132:135], a[4:7], 0
ds_read_b128 a[104:107], v5 offset:15360
v_mfma_f32_16x16x32_bf16 v[152:155], a[128:131], a[0:3], v[152:155]
v_mfma_f32_16x16x32_bf16 v[132:135], a[136:139], a[0:3], 0
ds_read_b128 a[108:111], v5 offset:21504
v_mfma_f32_16x16x32_bf16 v[132:135], a[140:143], a[4:7], v[132:135]
v_mfma_f32_16x16x32_bf16 v[156:159], a[140:143], a[12:15], 0
buffer_load_dwordx4 v1, s[4:7], s44 offen offset:1024 sc1 lds
s_add_u32 m0, s18, 0x1e000
v_mfma_f32_16x16x32_bf16 v[156:159], a[136:139], a[8:11], v[156:159]
s_add_u32 s44, s50, 0x2c1e000
ds_read_b128 a[112:115], v5 offset:16384
v_mfma_f32_16x16x32_bf16 v[180:183], a[136:139], a[16:19], 0
v_mfma_f32_16x16x32_bf16 v[180:183], a[140:143], a[20:23], v[180:183]
ds_read_b128 a[116:119], v5 offset:22528
v_mfma_f32_16x16x32_bf16 v[204:207], a[140:143], a[28:31], 0
v_mfma_f32_16x16x32_bf16 v[204:207], a[136:139], a[24:27], v[204:207]
buffer_load_dwordx4 a[88:91], v2, s[40:43], s35 offen offset:3072 sc1
v_mfma_f32_16x16x32_bf16 v[208:211], a[144:147], a[24:27], 0
v_mfma_f32_16x16x32_bf16 v[208:211], a[148:151], a[28:31], v[208:211]
v_mfma_f32_16x16x32_bf16 v[184:187], a[148:151], a[20:23], 0
v_mfma_f32_16x16x32_bf16 v[184:187], a[144:147], a[16:19], v[184:187]
v_mfma_f32_16x16x32_bf16 v[160:163], a[144:147], a[8:11], 0
buffer_load_dwordx4 a[92:95], v2, s[40:43], s33 offen offset:3072 sc1
s_add_u32 s35, s35, 0x4000
v_mfma_f32_16x16x32_bf16 v[160:163], a[148:151], a[12:15], v[160:163]
s_add_u32 s33, s33, 0x4000
v_mfma_f32_16x16x32_bf16 v[136:139], a[148:151], a[4:7], 0
v_mfma_f32_16x16x32_bf16 v[136:139], a[144:147], a[0:3], v[136:139]
s_waitcnt vmcnt(10) lgkmcnt(0)
v_mfma_f32_16x16x32_bf16 v[140:143], a[96:99], a[32:35], v[140:143]
ds_read_b128 a[128:131], v5 offset:17408
v_mfma_f32_16x16x32_bf16 v[140:143], a[100:103], a[36:39], v[140:143]
buffer_load_dwordx4 a[0:3], v2, s[40:43], s35 offen offset:0 sc1
v_mfma_f32_16x16x32_bf16 v[164:167], a[100:103], a[44:47], v[164:167]
ds_read_b128 a[132:135], v5 offset:23552
v_mfma_f32_16x16x32_bf16 v[164:167], a[96:99], a[40:43], v[164:167]
v_mfma_f32_16x16x32_bf16 v[188:191], a[96:99], a[48:51], v[188:191]
v_mfma_f32_16x16x32_bf16 v[188:191], a[100:103], a[52:55], v[188:191]
buffer_load_dwordx4 a[4:7], v2, s[40:43], s33 offen offset:0 sc1
v_mfma_f32_16x16x32_bf16 v[212:215], a[100:103], a[60:63], v[212:215]
ds_read_b128 a[136:139], v5 offset:12288
v_mfma_f32_16x16x32_bf16 v[212:215], a[96:99], a[56:59], v[212:215]
v_mfma_f32_16x16x32_bf16 v[216:219], a[104:107], a[56:59], v[216:219]
ds_read_b128 a[140:143], v5 offset:18432
v_mfma_f32_16x16x32_bf16 v[216:219], a[108:111], a[60:63], v[216:219]
v_mfma_f32_16x16x32_bf16 v[192:195], a[108:111], a[52:55], v[192:195]
buffer_load_dwordx4 v1, s[4:7], s44 offen offset:0 sc1 lds
v_mfma_f32_16x16x32_bf16 v[192:195], a[104:107], a[48:51], v[192:195]
ds_read_b128 a[144:147], v5 offset:13312
v_mfma_f32_16x16x32_bf16 v[168:171], a[104:107], a[40:43], v[168:171]
v_mfma_f32_16x16x32_bf16 v[168:171], a[108:111], a[44:47], v[168:171]
ds_read_b128 a[148:151], v5 offset:19456
v_mfma_f32_16x16x32_bf16 v[144:147], a[108:111], a[36:39], v[144:147]
v_mfma_f32_16x16x32_bf16 v[144:147], a[104:107], a[32:35], v[144:147]
buffer_load_dwordx4 a[8:11], v2, s[40:43], s35 offen offset:1024 sc1
v_mfma_f32_16x16x32_bf16 v[148:151], a[112:115], a[32:35], v[148:151]
v_mfma_f32_16x16x32_bf16 v[148:151], a[116:119], a[36:39], v[148:151]
v_mfma_f32_16x16x32_bf16 v[172:175], a[116:119], a[44:47], v[172:175]
v_mfma_f32_16x16x32_bf16 v[172:175], a[112:115], a[40:43], v[172:175]
v_mfma_f32_16x16x32_bf16 v[196:199], a[112:115], a[48:51], v[196:199]
buffer_load_dwordx4 a[12:15], v2, s[40:43], s33 offen offset:1024 sc1
v_mfma_f32_16x16x32_bf16 v[196:199], a[116:119], a[52:55], v[196:199]
v_mfma_f32_16x16x32_bf16 v[220:223], a[116:119], a[60:63], v[220:223]
v_mfma_f32_16x16x32_bf16 v[220:223], a[112:115], a[56:59], v[220:223]
s_waitcnt lgkmcnt(0)
v_mfma_f32_16x16x32_bf16 v[224:227], a[128:131], a[56:59], v[224:227]
ds_read_b128 a[96:99], v5 offset:26624
v_mfma_f32_16x16x32_bf16 v[224:227], a[132:135], a[60:63], v[224:227]
buffer_load_dwordx4 a[16:19], v2, s[40:43], s35 offen offset:2048 sc1
v_mfma_f32_16x16x32_bf16 v[200:203], a[132:135], a[52:55], v[200:203]
ds_read_b128 a[100:103], v5 offset:32768
v_mfma_f32_16x16x32_bf16 v[200:203], a[128:131], a[48:51], v[200:203]
v_mfma_f32_16x16x32_bf16 v[176:179], a[128:131], a[40:43], v[176:179]
v_mfma_f32_16x16x32_bf16 v[176:179], a[132:135], a[44:47], v[176:179]
buffer_load_dwordx4 v1, s[4:7], s44 offen offset:1024 sc1 lds
s_add_u32 m0, s18, 0x20000
v_mfma_f32_16x16x32_bf16 v[152:155], a[132:135], a[36:39], v[152:155]
s_add_u32 s44, s50, 0x2c20000
ds_read_b128 a[104:107], v5 offset:27648
v_mfma_f32_16x16x32_bf16 v[152:155], a[128:131], a[32:35], v[152:155]
v_mfma_f32_16x16x32_bf16 v[132:135], a[136:139], a[32:35], v[132:135]
ds_read_b128 a[108:111], v5 offset:33792
v_mfma_f32_16x16x32_bf16 v[132:135], a[140:143], a[36:39], v[132:135]
buffer_load_dwordx4 a[20:23], v2, s[40:43], s33 offen offset:2048 sc1
v_mfma_f32_16x16x32_bf16 v[156:159], a[140:143], a[44:47], v[156:159]
ds_read_b128 a[112:115], v5 offset:28672
v_mfma_f32_16x16x32_bf16 v[156:159], a[136:139], a[40:43], v[156:159]
v_mfma_f32_16x16x32_bf16 v[180:183], a[136:139], a[48:51], v[180:183]
v_mfma_f32_16x16x32_bf16 v[180:183], a[140:143], a[52:55], v[180:183]
buffer_load_dwordx4 a[24:27], v2, s[40:43], s35 offen offset:3072 sc1
v_mfma_f32_16x16x32_bf16 v[204:207], a[140:143], a[60:63], v[204:207]
ds_read_b128 a[116:119], v5 offset:34816
v_mfma_f32_16x16x32_bf16 v[204:207], a[136:139], a[56:59], v[204:207]
v_mfma_f32_16x16x32_bf16 v[208:211], a[144:147], a[56:59], v[208:211]
v_mfma_f32_16x16x32_bf16 v[208:211], a[148:151], a[60:63], v[208:211]
buffer_load_dwordx4 v1, s[4:7], s44 offen offset:0 sc1 lds
v_mfma_f32_16x16x32_bf16 v[184:187], a[148:151], a[52:55], v[184:187]
v_mfma_f32_16x16x32_bf16 v[184:187], a[144:147], a[48:51], v[184:187]
v_mfma_f32_16x16x32_bf16 v[160:163], a[144:147], a[40:43], v[160:163]
v_mfma_f32_16x16x32_bf16 v[160:163], a[148:151], a[44:47], v[160:163]
buffer_load_dwordx4 a[28:31], v2, s[40:43], s33 offen offset:3072 sc1
s_add_u32 s35, s35, 0x4000
v_mfma_f32_16x16x32_bf16 v[136:139], a[148:151], a[36:39], v[136:139]
s_add_u32 s33, s33, 0x4000
v_mfma_f32_16x16x32_bf16 v[136:139], a[144:147], a[32:35], v[136:139]
s_waitcnt vmcnt(11) lgkmcnt(0)
v_mfma_f32_16x16x32_bf16 v[140:143], a[96:99], a[64:67], v[140:143]
ds_read_b128 a[128:131], v5 offset:29696
v_mfma_f32_16x16x32_bf16 v[140:143], a[100:103], a[68:71], v[140:143]
buffer_load_dwordx4 a[32:35], v2, s[40:43], s35 offen offset:0 sc1
v_mfma_f32_16x16x32_bf16 v[164:167], a[100:103], a[76:79], v[164:167]
ds_read_b128 a[132:135], v5 offset:35840
v_mfma_f32_16x16x32_bf16 v[164:167], a[96:99], a[72:75], v[164:167]
v_mfma_f32_16x16x32_bf16 v[188:191], a[96:99], a[80:83], v[188:191]
v_mfma_f32_16x16x32_bf16 v[188:191], a[100:103], a[84:87], v[188:191]
buffer_load_dwordx4 a[36:39], v2, s[40:43], s33 offen offset:0 sc1
v_mfma_f32_16x16x32_bf16 v[212:215], a[100:103], a[92:95], v[212:215]
ds_read_b128 a[136:139], v5 offset:24576
v_mfma_f32_16x16x32_bf16 v[212:215], a[96:99], a[88:91], v[212:215]
v_mfma_f32_16x16x32_bf16 v[216:219], a[104:107], a[88:91], v[216:219]
ds_read_b128 a[140:143], v5 offset:30720
v_mfma_f32_16x16x32_bf16 v[216:219], a[108:111], a[92:95], v[216:219]
v_mfma_f32_16x16x32_bf16 v[192:195], a[108:111], a[84:87], v[192:195]
buffer_load_dwordx4 v1, s[4:7], s44 offen offset:1024 sc1 lds
s_add_u32 m0, s18, 0x22000
v_mfma_f32_16x16x32_bf16 v[192:195], a[104:107], a[80:83], v[192:195]
s_add_u32 s44, s50, 0x2c22000
ds_read_b128 a[144:147], v5 offset:25600
v_mfma_f32_16x16x32_bf16 v[168:171], a[104:107], a[72:75], v[168:171]
v_mfma_f32_16x16x32_bf16 v[168:171], a[108:111], a[76:79], v[168:171]
ds_read_b128 a[148:151], v5 offset:31744
v_mfma_f32_16x16x32_bf16 v[144:147], a[108:111], a[68:71], v[144:147]
v_mfma_f32_16x16x32_bf16 v[144:147], a[104:107], a[64:67], v[144:147]
buffer_load_dwordx4 a[40:43], v2, s[40:43], s35 offen offset:1024 sc1
v_mfma_f32_16x16x32_bf16 v[148:151], a[112:115], a[64:67], v[148:151]
v_mfma_f32_16x16x32_bf16 v[148:151], a[116:119], a[68:71], v[148:151]
v_mfma_f32_16x16x32_bf16 v[172:175], a[116:119], a[76:79], v[172:175]
v_mfma_f32_16x16x32_bf16 v[172:175], a[112:115], a[72:75], v[172:175]
v_mfma_f32_16x16x32_bf16 v[196:199], a[112:115], a[80:83], v[196:199]
buffer_load_dwordx4 a[44:47], v2, s[40:43], s33 offen offset:1024 sc1
v_mfma_f32_16x16x32_bf16 v[196:199], a[116:119], a[84:87], v[196:199]
v_mfma_f32_16x16x32_bf16 v[220:223], a[116:119], a[92:95], v[220:223]
v_mfma_f32_16x16x32_bf16 v[220:223], a[112:115], a[88:91], v[220:223]
s_waitcnt lgkmcnt(0)
v_mfma_f32_16x16x32_bf16 v[224:227], a[128:131], a[88:91], v[224:227]
ds_read_b128 a[96:99], v5 offset:38912
v_mfma_f32_16x16x32_bf16 v[224:227], a[132:135], a[92:95], v[224:227]
buffer_load_dwordx4 a[48:51], v2, s[40:43], s35 offen offset:2048 sc1
v_mfma_f32_16x16x32_bf16 v[200:203], a[132:135], a[84:87], v[200:203]
ds_read_b128 a[100:103], v5 offset:45056
v_mfma_f32_16x16x32_bf16 v[200:203], a[128:131], a[80:83], v[200:203]
v_mfma_f32_16x16x32_bf16 v[176:179], a[128:131], a[72:75], v[176:179]
v_mfma_f32_16x16x32_bf16 v[176:179], a[132:135], a[76:79], v[176:179]
buffer_load_dwordx4 a[52:55], v2, s[40:43], s33 offen offset:2048 sc1
v_mfma_f32_16x16x32_bf16 v[152:155], a[132:135], a[68:71], v[152:155]
ds_read_b128 a[104:107], v5 offset:39936
v_mfma_f32_16x16x32_bf16 v[152:155], a[128:131], a[64:67], v[152:155]
v_mfma_f32_16x16x32_bf16 v[132:135], a[136:139], a[64:67], v[132:135]
ds_read_b128 a[108:111], v5 offset:46080
v_mfma_f32_16x16x32_bf16 v[132:135], a[140:143], a[68:71], v[132:135]
v_mfma_f32_16x16x32_bf16 v[156:159], a[140:143], a[76:79], v[156:159]
buffer_load_dwordx4 v1, s[4:7], s44 offen offset:0 sc1 lds
v_mfma_f32_16x16x32_bf16 v[156:159], a[136:139], a[72:75], v[156:159]
ds_read_b128 a[112:115], v5 offset:40960
v_mfma_f32_16x16x32_bf16 v[180:183], a[136:139], a[80:83], v[180:183]
v_mfma_f32_16x16x32_bf16 v[180:183], a[140:143], a[84:87], v[180:183]
ds_read_b128 a[116:119], v5 offset:47104
v_mfma_f32_16x16x32_bf16 v[204:207], a[140:143], a[92:95], v[204:207]
v_mfma_f32_16x16x32_bf16 v[204:207], a[136:139], a[88:91], v[204:207]
buffer_load_dwordx4 a[56:59], v2, s[40:43], s35 offen offset:3072 sc1
v_mfma_f32_16x16x32_bf16 v[208:211], a[144:147], a[88:91], v[208:211]
v_mfma_f32_16x16x32_bf16 v[208:211], a[148:151], a[92:95], v[208:211]
v_mfma_f32_16x16x32_bf16 v[184:187], a[148:151], a[84:87], v[184:187]
v_mfma_f32_16x16x32_bf16 v[184:187], a[144:147], a[80:83], v[184:187]
v_mfma_f32_16x16x32_bf16 v[160:163], a[144:147], a[72:75], v[160:163]
buffer_load_dwordx4 a[60:63], v2, s[40:43], s33 offen offset:3072 sc1
s_add_u32 s35, s35, 0x4000
v_mfma_f32_16x16x32_bf16 v[160:163], a[148:151], a[76:79], v[160:163]
s_add_u32 s33, s33, 0x4000
v_mfma_f32_16x16x32_bf16 v[136:139], a[148:151], a[68:71], v[136:139]
v_mfma_f32_16x16x32_bf16 v[136:139], a[144:147], a[64:67], v[136:139]
s_waitcnt vmcnt(10) lgkmcnt(0)
v_mfma_f32_16x16x32_bf16 v[140:143], a[96:99], a[0:3], v[140:143]
ds_read_b128 a[128:131], v5 offset:41984
v_mfma_f32_16x16x32_bf16 v[140:143], a[100:103], a[4:7], v[140:143]
buffer_load_dwordx4 a[64:67], v2, s[40:43], s35 offen offset:0 sc1
v_mfma_f32_16x16x32_bf16 v[164:167], a[100:103], a[12:15], v[164:167]
ds_read_b128 a[132:135], v5 offset:48128
v_mfma_f32_16x16x32_bf16 v[164:167], a[96:99], a[8:11], v[164:167]
v_mfma_f32_16x16x32_bf16 v[188:191], a[96:99], a[16:19], v[188:191]
v_mfma_f32_16x16x32_bf16 v[188:191], a[100:103], a[20:23], v[188:191]
buffer_load_dwordx4 a[68:71], v2, s[40:43], s33 offen offset:0 sc1
v_mfma_f32_16x16x32_bf16 v[212:215], a[100:103], a[28:31], v[212:215]
ds_read_b128 a[136:139], v5 offset:36864
v_mfma_f32_16x16x32_bf16 v[212:215], a[96:99], a[24:27], v[212:215]
v_mfma_f32_16x16x32_bf16 v[216:219], a[104:107], a[24:27], v[216:219]
ds_read_b128 a[140:143], v5 offset:43008
v_mfma_f32_16x16x32_bf16 v[216:219], a[108:111], a[28:31], v[216:219]
v_mfma_f32_16x16x32_bf16 v[192:195], a[108:111], a[20:23], v[192:195]
buffer_load_dwordx4 v1, s[4:7], s44 offen offset:1024 sc1 lds
s_add_u32 s88, s82, 0x280000
v_mfma_f32_16x16x32_bf16 v[192:195], a[104:107], a[16:19], v[192:195]
ds_read_b128 a[144:147], v5 offset:37888
v_mfma_f32_16x16x32_bf16 v[168:171], a[104:107], a[8:11], v[168:171]
v_mfma_f32_16x16x32_bf16 v[168:171], a[108:111], a[12:15], v[168:171]
ds_read_b128 a[148:151], v5 offset:44032
v_mfma_f32_16x16x32_bf16 v[144:147], a[108:111], a[4:7], v[144:147]
v_mfma_f32_16x16x32_bf16 v[144:147], a[104:107], a[0:3], v[144:147]
buffer_load_dwordx4 a[72:75], v2, s[40:43], s35 offen offset:1024 sc1
v_mfma_f32_16x16x32_bf16 v[148:151], a[112:115], a[0:3], v[148:151]
v_mfma_f32_16x16x32_bf16 v[148:151], a[116:119], a[4:7], v[148:151]
v_mfma_f32_16x16x32_bf16 v[172:175], a[116:119], a[12:15], v[172:175]
v_mfma_f32_16x16x32_bf16 v[172:175], a[112:115], a[8:11], v[172:175]
v_mfma_f32_16x16x32_bf16 v[196:199], a[112:115], a[16:19], v[196:199]
buffer_load_dwordx4 a[76:79], v2, s[40:43], s33 offen offset:1024 sc1
v_mfma_f32_16x16x32_bf16 v[196:199], a[116:119], a[20:23], v[196:199]
v_mfma_f32_16x16x32_bf16 v[220:223], a[116:119], a[28:31], v[220:223]
v_mfma_f32_16x16x32_bf16 v[220:223], a[112:115], a[24:27], v[220:223]
s_waitcnt lgkmcnt(0)
s_barrier
v_mfma_f32_16x16x32_bf16 v[224:227], a[128:131], a[24:27], v[224:227]
v_add_u32 v5, 49152, v1
v_mfma_f32_16x16x32_bf16 v[224:227], a[132:135], a[28:31], v[224:227]
buffer_load_dwordx4 a[80:83], v2, s[40:43], s35 offen offset:2048 sc1
v_mfma_f32_16x16x32_bf16 v[200:203], a[132:135], a[20:23], v[200:203]
ds_read_b128 a[96:99], v5 offset:2048
v_mfma_f32_16x16x32_bf16 v[200:203], a[128:131], a[16:19], v[200:203]
ds_read_b128 a[100:103], v5 offset:8192
v_mfma_f32_16x16x32_bf16 v[176:179], a[128:131], a[8:11], v[176:179]
v_mfma_f32_16x16x32_bf16 v[176:179], a[132:135], a[12:15], v[176:179]
buffer_load_dwordx4 a[84:87], v2, s[40:43], s33 offen offset:2048 sc1
v_mfma_f32_16x16x32_bf16 v[152:155], a[132:135], a[4:7], v[152:155]
ds_read_b128 a[104:107], v5 offset:3072
v_mfma_f32_16x16x32_bf16 v[152:155], a[128:131], a[0:3], v[152:155]
v_mfma_f32_16x16x32_bf16 v[132:135], a[136:139], a[0:3], v[132:135]
ds_read_b128 a[108:111], v5 offset:9216
v_mfma_f32_16x16x32_bf16 v[132:135], a[140:143], a[4:7], v[132:135]
v_mfma_f32_16x16x32_bf16 v[156:159], a[140:143], a[12:15], v[156:159]
buffer_load_dwordx4 v[92:95], v1, s[4:7], s88 offen offset:0 sc1
v_mfma_f32_16x16x32_bf16 v[156:159], a[136:139], a[8:11], v[156:159]
ds_read_b128 a[112:115], v5 offset:4096
v_mfma_f32_16x16x32_bf16 v[180:183], a[136:139], a[16:19], v[180:183]
v_mfma_f32_16x16x32_bf16 v[180:183], a[140:143], a[20:23], v[180:183]
ds_read_b128 a[116:119], v5 offset:10240
v_mfma_f32_16x16x32_bf16 v[204:207], a[140:143], a[28:31], v[204:207]
v_mfma_f32_16x16x32_bf16 v[204:207], a[136:139], a[24:27], v[204:207]
buffer_load_dwordx4 a[88:91], v2, s[40:43], s35 offen offset:3072 sc1
v_mfma_f32_16x16x32_bf16 v[208:211], a[144:147], a[24:27], v[208:211]
v_mfma_f32_16x16x32_bf16 v[208:211], a[148:151], a[28:31], v[208:211]
v_mfma_f32_16x16x32_bf16 v[184:187], a[148:151], a[20:23], v[184:187]
v_mfma_f32_16x16x32_bf16 v[184:187], a[144:147], a[16:19], v[184:187]
v_mfma_f32_16x16x32_bf16 v[160:163], a[144:147], a[8:11], v[160:163]
buffer_load_dwordx4 a[92:95], v2, s[40:43], s33 offen offset:3072 sc1
s_add_u32 s35, s35, 0x4000
v_mfma_f32_16x16x32_bf16 v[160:163], a[148:151], a[12:15], v[160:163]
s_add_u32 s33, s33, 0x4000
v_mfma_f32_16x16x32_bf16 v[136:139], a[148:151], a[4:7], v[136:139]
v_mfma_f32_16x16x32_bf16 v[136:139], a[144:147], a[0:3], v[136:139]
s_waitcnt vmcnt(10) lgkmcnt(0)
v_mfma_f32_16x16x32_bf16 v[140:143], a[96:99], a[32:35], v[140:143]
ds_read_b128 a[128:131], v5 offset:5120
v_mfma_f32_16x16x32_bf16 v[140:143], a[100:103], a[36:39], v[140:143]
buffer_load_dwordx4 a[0:3], v2, s[40:43], s35 offen offset:0 sc1
v_mfma_f32_16x16x32_bf16 v[164:167], a[100:103], a[44:47], v[164:167]
ds_read_b128 a[132:135], v5 offset:11264
v_mfma_f32_16x16x32_bf16 v[164:167], a[96:99], a[40:43], v[164:167]
v_mfma_f32_16x16x32_bf16 v[188:191], a[96:99], a[48:51], v[188:191]
v_mfma_f32_16x16x32_bf16 v[188:191], a[100:103], a[52:55], v[188:191]
buffer_load_dwordx4 a[4:7], v2, s[40:43], s33 offen offset:0 sc1
v_mfma_f32_16x16x32_bf16 v[212:215], a[100:103], a[60:63], v[212:215]
ds_read_b128 a[136:139], v5 offset:0
v_mfma_f32_16x16x32_bf16 v[212:215], a[96:99], a[56:59], v[212:215]
v_mfma_f32_16x16x32_bf16 v[216:219], a[104:107], a[56:59], v[216:219]
ds_read_b128 a[140:143], v5 offset:6144
v_mfma_f32_16x16x32_bf16 v[216:219], a[108:111], a[60:63], v[216:219]
v_mfma_f32_16x16x32_bf16 v[192:195], a[108:111], a[52:55], v[192:195]
buffer_load_dwordx4 v[96:99], v1, s[4:7], s88 offen offset:1024 sc1
v_mfma_f32_16x16x32_bf16 v[192:195], a[104:107], a[48:51], v[192:195]
ds_read_b128 a[144:147], v5 offset:1024
v_mfma_f32_16x16x32_bf16 v[168:171], a[104:107], a[40:43], v[168:171]
v_mfma_f32_16x16x32_bf16 v[168:171], a[108:111], a[44:47], v[168:171]
ds_read_b128 a[148:151], v5 offset:7168
v_mfma_f32_16x16x32_bf16 v[144:147], a[108:111], a[36:39], v[144:147]
v_mfma_f32_16x16x32_bf16 v[144:147], a[104:107], a[32:35], v[144:147]
buffer_load_dwordx4 a[8:11], v2, s[40:43], s35 offen offset:1024 sc1
v_mfma_f32_16x16x32_bf16 v[148:151], a[112:115], a[32:35], v[148:151]
v_mfma_f32_16x16x32_bf16 v[148:151], a[116:119], a[36:39], v[148:151]
v_mfma_f32_16x16x32_bf16 v[172:175], a[116:119], a[44:47], v[172:175]
v_mfma_f32_16x16x32_bf16 v[172:175], a[112:115], a[40:43], v[172:175]
v_mfma_f32_16x16x32_bf16 v[196:199], a[112:115], a[48:51], v[196:199]
buffer_load_dwordx4 a[12:15], v2, s[40:43], s33 offen offset:1024 sc1
v_mfma_f32_16x16x32_bf16 v[196:199], a[116:119], a[52:55], v[196:199]
v_mfma_f32_16x16x32_bf16 v[220:223], a[116:119], a[60:63], v[220:223]
v_mfma_f32_16x16x32_bf16 v[220:223], a[112:115], a[56:59], v[220:223]
s_waitcnt lgkmcnt(0)
v_mfma_f32_16x16x32_bf16 v[224:227], a[128:131], a[56:59], v[224:227]
ds_read_b128 a[96:99], v5 offset:14336
v_mfma_f32_16x16x32_bf16 v[224:227], a[132:135], a[60:63], v[224:227]
buffer_load_dwordx4 a[16:19], v2, s[40:43], s35 offen offset:2048 sc1
v_mfma_f32_16x16x32_bf16 v[200:203], a[132:135], a[52:55], v[200:203]
ds_read_b128 a[100:103], v5 offset:20480
v_mfma_f32_16x16x32_bf16 v[200:203], a[128:131], a[48:51], v[200:203]
v_mfma_f32_16x16x32_bf16 v[176:179], a[128:131], a[40:43], v[176:179]
v_mfma_f32_16x16x32_bf16 v[176:179], a[132:135], a[44:47], v[176:179]
buffer_load_dwordx4 v[100:103], v1, s[4:7], s88 offen offset:2048 sc1
v_mfma_f32_16x16x32_bf16 v[152:155], a[132:135], a[36:39], v[152:155]
ds_read_b128 a[104:107], v5 offset:15360
v_mfma_f32_16x16x32_bf16 v[152:155], a[128:131], a[32:35], v[152:155]
v_mfma_f32_16x16x32_bf16 v[132:135], a[136:139], a[32:35], v[132:135]
ds_read_b128 a[108:111], v5 offset:21504
v_mfma_f32_16x16x32_bf16 v[132:135], a[140:143], a[36:39], v[132:135]
buffer_load_dwordx4 a[20:23], v2, s[40:43], s33 offen offset:2048 sc1
v_mfma_f32_16x16x32_bf16 v[156:159], a[140:143], a[44:47], v[156:159]
ds_read_b128 a[112:115], v5 offset:16384
v_mfma_f32_16x16x32_bf16 v[156:159], a[136:139], a[40:43], v[156:159]
v_mfma_f32_16x16x32_bf16 v[180:183], a[136:139], a[48:51], v[180:183]
v_mfma_f32_16x16x32_bf16 v[180:183], a[140:143], a[52:55], v[180:183]
buffer_load_dwordx4 a[24:27], v2, s[40:43], s35 offen offset:3072 sc1
v_mfma_f32_16x16x32_bf16 v[204:207], a[140:143], a[60:63], v[204:207]
ds_read_b128 a[116:119], v5 offset:22528
v_mfma_f32_16x16x32_bf16 v[204:207], a[136:139], a[56:59], v[204:207]
v_mfma_f32_16x16x32_bf16 v[208:211], a[144:147], a[56:59], v[208:211]
v_mfma_f32_16x16x32_bf16 v[208:211], a[148:151], a[60:63], v[208:211]
buffer_load_dwordx4 v[104:107], v1, s[4:7], s88 offen offset:3072 sc1
s_add_u32 s88, s88, 4096
v_mfma_f32_16x16x32_bf16 v[184:187], a[148:151], a[52:55], v[184:187]
v_mfma_f32_16x16x32_bf16 v[184:187], a[144:147], a[48:51], v[184:187]
v_mfma_f32_16x16x32_bf16 v[160:163], a[144:147], a[40:43], v[160:163]
v_mfma_f32_16x16x32_bf16 v[160:163], a[148:151], a[44:47], v[160:163]
buffer_load_dwordx4 a[28:31], v2, s[40:43], s33 offen offset:3072 sc1
s_add_u32 s35, s35, 0x4000
v_mfma_f32_16x16x32_bf16 v[136:139], a[148:151], a[36:39], v[136:139]
s_add_u32 s33, s33, 0x4000
v_mfma_f32_16x16x32_bf16 v[136:139], a[144:147], a[32:35], v[136:139]
s_waitcnt vmcnt(11) lgkmcnt(0)
v_mfma_f32_16x16x32_bf16 v[140:143], a[96:99], a[64:67], v[140:143]
ds_read_b128 a[128:131], v5 offset:17408
v_mfma_f32_16x16x32_bf16 v[140:143], a[100:103], a[68:71], v[140:143]
buffer_load_dwordx4 a[32:35], v2, s[40:43], s35 offen offset:0 sc1
v_mfma_f32_16x16x32_bf16 v[164:167], a[100:103], a[76:79], v[164:167]
ds_read_b128 a[132:135], v5 offset:23552
v_mfma_f32_16x16x32_bf16 v[164:167], a[96:99], a[72:75], v[164:167]
v_mfma_f32_16x16x32_bf16 v[188:191], a[96:99], a[80:83], v[188:191]
v_mfma_f32_16x16x32_bf16 v[188:191], a[100:103], a[84:87], v[188:191]
buffer_load_dwordx4 a[36:39], v2, s[40:43], s33 offen offset:0 sc1
v_mfma_f32_16x16x32_bf16 v[212:215], a[100:103], a[92:95], v[212:215]
ds_read_b128 a[136:139], v5 offset:12288
v_mfma_f32_16x16x32_bf16 v[212:215], a[96:99], a[88:91], v[212:215]
v_mfma_f32_16x16x32_bf16 v[216:219], a[104:107], a[88:91], v[216:219]
ds_read_b128 a[140:143], v5 offset:18432
v_mfma_f32_16x16x32_bf16 v[216:219], a[108:111], a[92:95], v[216:219]
v_mfma_f32_16x16x32_bf16 v[192:195], a[108:111], a[84:87], v[192:195]
buffer_load_dwordx4 v[108:111], v1, s[4:7], s88 offen offset:0 sc1
v_mfma_f32_16x16x32_bf16 v[192:195], a[104:107], a[80:83], v[192:195]
ds_read_b128 a[144:147], v5 offset:13312
v_mfma_f32_16x16x32_bf16 v[168:171], a[104:107], a[72:75], v[168:171]
v_mfma_f32_16x16x32_bf16 v[168:171], a[108:111], a[76:79], v[168:171]
ds_read_b128 a[148:151], v5 offset:19456
v_mfma_f32_16x16x32_bf16 v[144:147], a[108:111], a[68:71], v[144:147]
v_mfma_f32_16x16x32_bf16 v[144:147], a[104:107], a[64:67], v[144:147]
buffer_load_dwordx4 a[40:43], v2, s[40:43], s35 offen offset:1024 sc1
v_mfma_f32_16x16x32_bf16 v[148:151], a[112:115], a[64:67], v[148:151]
v_mfma_f32_16x16x32_bf16 v[148:151], a[116:119], a[68:71], v[148:151]
v_mfma_f32_16x16x32_bf16 v[172:175], a[116:119], a[76:79], v[172:175]
v_mfma_f32_16x16x32_bf16 v[172:175], a[112:115], a[72:75], v[172:175]
v_mfma_f32_16x16x32_bf16 v[196:199], a[112:115], a[80:83], v[196:199]
buffer_load_dwordx4 a[44:47], v2, s[40:43], s33 offen offset:1024 sc1
v_mfma_f32_16x16x32_bf16 v[196:199], a[116:119], a[84:87], v[196:199]
v_mfma_f32_16x16x32_bf16 v[220:223], a[116:119], a[92:95], v[220:223]
v_mfma_f32_16x16x32_bf16 v[220:223], a[112:115], a[88:91], v[220:223]
s_waitcnt lgkmcnt(0)
v_mfma_f32_16x16x32_bf16 v[224:227], a[128:131], a[88:91], v[224:227]
ds_read_b128 a[96:99], v5 offset:26624
v_mfma_f32_16x16x32_bf16 v[224:227], a[132:135], a[92:95], v[224:227]
buffer_load_dwordx4 a[48:51], v2, s[40:43], s35 offen offset:2048 sc1
v_mfma_f32_16x16x32_bf16 v[200:203], a[132:135], a[84:87], v[200:203]
ds_read_b128 a[100:103], v5 offset:32768
v_mfma_f32_16x16x32_bf16 v[200:203], a[128:131], a[80:83], v[200:203]
v_mfma_f32_16x16x32_bf16 v[176:179], a[128:131], a[72:75], v[176:179]
v_mfma_f32_16x16x32_bf16 v[176:179], a[132:135], a[76:79], v[176:179]
buffer_load_dwordx4 a[52:55], v2, s[40:43], s33 offen offset:2048 sc1
v_mfma_f32_16x16x32_bf16 v[152:155], a[132:135], a[68:71], v[152:155]
ds_read_b128 a[104:107], v5 offset:27648
v_mfma_f32_16x16x32_bf16 v[152:155], a[128:131], a[64:67], v[152:155]
v_mfma_f32_16x16x32_bf16 v[132:135], a[136:139], a[64:67], v[132:135]
ds_read_b128 a[108:111], v5 offset:33792
v_mfma_f32_16x16x32_bf16 v[132:135], a[140:143], a[68:71], v[132:135]
v_mfma_f32_16x16x32_bf16 v[156:159], a[140:143], a[76:79], v[156:159]
buffer_load_dwordx4 v[112:115], v1, s[4:7], s88 offen offset:1024 sc1
v_mfma_f32_16x16x32_bf16 v[156:159], a[136:139], a[72:75], v[156:159]
ds_read_b128 a[112:115], v5 offset:28672
v_mfma_f32_16x16x32_bf16 v[180:183], a[136:139], a[80:83], v[180:183]
v_mfma_f32_16x16x32_bf16 v[180:183], a[140:143], a[84:87], v[180:183]
ds_read_b128 a[116:119], v5 offset:34816
v_mfma_f32_16x16x32_bf16 v[204:207], a[140:143], a[92:95], v[204:207]
v_mfma_f32_16x16x32_bf16 v[204:207], a[136:139], a[88:91], v[204:207]
buffer_load_dwordx4 a[56:59], v2, s[40:43], s35 offen offset:3072 sc1
v_mfma_f32_16x16x32_bf16 v[208:211], a[144:147], a[88:91], v[208:211]
v_mfma_f32_16x16x32_bf16 v[208:211], a[148:151], a[92:95], v[208:211]
v_mfma_f32_16x16x32_bf16 v[184:187], a[148:151], a[84:87], v[184:187]
v_mfma_f32_16x16x32_bf16 v[184:187], a[144:147], a[80:83], v[184:187]
v_mfma_f32_16x16x32_bf16 v[160:163], a[144:147], a[72:75], v[160:163]
buffer_load_dwordx4 a[60:63], v2, s[40:43], s33 offen offset:3072 sc1
s_add_u32 s35, s35, 0x64000
v_mfma_f32_16x16x32_bf16 v[160:163], a[148:151], a[76:79], v[160:163]
s_add_u32 s33, s33, 0x64000
v_mfma_f32_16x16x32_bf16 v[136:139], a[148:151], a[68:71], v[136:139]
v_mfma_f32_16x16x32_bf16 v[136:139], a[144:147], a[64:67], v[136:139]
s_waitcnt vmcnt(10) lgkmcnt(0)
v_mfma_f32_16x16x32_bf16 v[140:143], a[96:99], a[0:3], v[140:143]
ds_read_b128 a[128:131], v5 offset:29696
v_mfma_f32_16x16x32_bf16 v[140:143], a[100:103], a[4:7], v[140:143]
buffer_load_dwordx4 a[64:67], v2, s[40:43], s35 offen offset:0 sc1
v_mfma_f32_16x16x32_bf16 v[164:167], a[100:103], a[12:15], v[164:167]
ds_read_b128 a[132:135], v5 offset:35840
v_mfma_f32_16x16x32_bf16 v[164:167], a[96:99], a[8:11], v[164:167]
v_mfma_f32_16x16x32_bf16 v[188:191], a[96:99], a[16:19], v[188:191]
v_mfma_f32_16x16x32_bf16 v[188:191], a[100:103], a[20:23], v[188:191]
buffer_load_dwordx4 a[68:71], v2, s[40:43], s33 offen offset:0 sc1
v_mfma_f32_16x16x32_bf16 v[212:215], a[100:103], a[28:31], v[212:215]
ds_read_b128 a[136:139], v5 offset:24576
v_mfma_f32_16x16x32_bf16 v[212:215], a[96:99], a[24:27], v[212:215]
v_mfma_f32_16x16x32_bf16 v[216:219], a[104:107], a[24:27], v[216:219]
ds_read_b128 a[140:143], v5 offset:30720
v_mfma_f32_16x16x32_bf16 v[216:219], a[108:111], a[28:31], v[216:219]
v_mfma_f32_16x16x32_bf16 v[192:195], a[108:111], a[20:23], v[192:195]
buffer_load_dwordx4 v[116:119], v1, s[4:7], s88 offen offset:2048 sc1
v_mfma_f32_16x16x32_bf16 v[192:195], a[104:107], a[16:19], v[192:195]
ds_read_b128 a[144:147], v5 offset:25600
v_mfma_f32_16x16x32_bf16 v[168:171], a[104:107], a[8:11], v[168:171]
v_mfma_f32_16x16x32_bf16 v[168:171], a[108:111], a[12:15], v[168:171]
ds_read_b128 a[148:151], v5 offset:31744
v_mfma_f32_16x16x32_bf16 v[144:147], a[108:111], a[4:7], v[144:147]
v_mfma_f32_16x16x32_bf16 v[144:147], a[104:107], a[0:3], v[144:147]
buffer_load_dwordx4 a[72:75], v2, s[40:43], s35 offen offset:1024 sc1
v_mfma_f32_16x16x32_bf16 v[148:151], a[112:115], a[0:3], v[148:151]
v_mfma_f32_16x16x32_bf16 v[148:151], a[116:119], a[4:7], v[148:151]
v_mfma_f32_16x16x32_bf16 v[172:175], a[116:119], a[12:15], v[172:175]
v_mfma_f32_16x16x32_bf16 v[172:175], a[112:115], a[8:11], v[172:175]
v_mfma_f32_16x16x32_bf16 v[196:199], a[112:115], a[16:19], v[196:199]
buffer_load_dwordx4 a[76:79], v2, s[40:43], s33 offen offset:1024 sc1
v_mfma_f32_16x16x32_bf16 v[196:199], a[116:119], a[20:23], v[196:199]
v_mfma_f32_16x16x32_bf16 v[220:223], a[116:119], a[28:31], v[220:223]
v_mfma_f32_16x16x32_bf16 v[220:223], a[112:115], a[24:27], v[220:223]
s_waitcnt lgkmcnt(0)
v_mfma_f32_16x16x32_bf16 v[224:227], a[128:131], a[24:27], v[224:227]
ds_read_b128 a[96:99], v5 offset:38912
v_mfma_f32_16x16x32_bf16 v[224:227], a[132:135], a[28:31], v[224:227]
buffer_load_dwordx4 a[80:83], v2, s[40:43], s35 offen offset:2048 sc1
v_mfma_f32_16x16x32_bf16 v[200:203], a[132:135], a[20:23], v[200:203]
ds_read_b128 a[100:103], v5 offset:45056
v_mfma_f32_16x16x32_bf16 v[200:203], a[128:131], a[16:19], v[200:203]
L_stub11:
s_cbranch_execz L_stub12
v_mfma_f32_16x16x32_bf16 v[176:179], a[128:131], a[8:11], v[176:179]
v_mfma_f32_16x16x32_bf16 v[176:179], a[132:135], a[12:15], v[176:179]
buffer_load_dwordx4 a[84:87], v2, s[40:43], s33 offen offset:2048 sc1
v_mfma_f32_16x16x32_bf16 v[152:155], a[132:135], a[4:7], v[152:155]
ds_read_b128 a[104:107], v5 offset:39936
v_mfma_f32_16x16x32_bf16 v[152:155], a[128:131], a[0:3], v[152:155]
v_mfma_f32_16x16x32_bf16 v[132:135], a[136:139], a[0:3], v[132:135]
ds_read_b128 a[108:111], v5 offset:46080
v_mfma_f32_16x16x32_bf16 v[132:135], a[140:143], a[4:7], v[132:135]
v_mfma_f32_16x16x32_bf16 v[156:159], a[140:143], a[12:15], v[156:159]
buffer_load_dwordx4 v[120:123], v1, s[4:7], s88 offen offset:3072 sc1
s_add_u32 m0, s18, 0x0
v_mfma_f32_16x16x32_bf16 v[156:159], a[136:139], a[8:11], v[156:159]
s_add_u32 s44, s50, 0x2c24000
ds_read_b128 a[112:115], v5 offset:40960
v_mfma_f32_16x16x32_bf16 v[180:183], a[136:139], a[16:19], v[180:183]
v_mfma_f32_16x16x32_bf16 v[180:183], a[140:143], a[20:23], v[180:183]
ds_read_b128 a[116:119], v5 offset:47104
v_mfma_f32_16x16x32_bf16 v[204:207], a[140:143], a[28:31], v[204:207]
v_mfma_f32_16x16x32_bf16 v[204:207], a[136:139], a[24:27], v[204:207]
buffer_load_dwordx4 a[88:91], v2, s[40:43], s35 offen offset:3072 sc1
v_mfma_f32_16x16x32_bf16 v[208:211], a[144:147], a[24:27], v[208:211]
v_mfma_f32_16x16x32_bf16 v[208:211], a[148:151], a[28:31], v[208:211]
v_mfma_f32_16x16x32_bf16 v[184:187], a[148:151], a[20:23], v[184:187]
v_mfma_f32_16x16x32_bf16 v[184:187], a[144:147], a[16:19], v[184:187]
v_mfma_f32_16x16x32_bf16 v[160:163], a[144:147], a[8:11], v[160:163]
buffer_load_dwordx4 a[92:95], v2, s[40:43], s33 offen offset:3072 sc1
s_add_u32 s35, s35, 0x4000
v_mfma_f32_16x16x32_bf16 v[160:163], a[148:151], a[12:15], v[160:163]
s_add_u32 s33, s33, 0x4000
v_mfma_f32_16x16x32_bf16 v[136:139], a[148:151], a[4:7], v[136:139]
v_mfma_f32_16x16x32_bf16 v[136:139], a[144:147], a[0:3], v[136:139]
s_waitcnt vmcnt(10) lgkmcnt(0)
v_mfma_f32_16x16x32_bf16 v[140:143], a[96:99], a[32:35], v[140:143]
ds_read_b128 a[128:131], v5 offset:41984
v_mfma_f32_16x16x32_bf16 v[140:143], a[100:103], a[36:39], v[140:143]
buffer_load_dwordx4 a[0:3], v2, s[40:43], s35 offen offset:0 sc1
v_mfma_f32_16x16x32_bf16 v[164:167], a[100:103], a[44:47], v[164:167]
ds_read_b128 a[132:135], v5 offset:48128
v_mfma_f32_16x16x32_bf16 v[164:167], a[96:99], a[40:43], v[164:167]
v_mfma_f32_16x16x32_bf16 v[188:191], a[96:99], a[48:51], v[188:191]
v_mfma_f32_16x16x32_bf16 v[188:191], a[100:103], a[52:55], v[188:191]
buffer_load_dwordx4 v1, s[4:7], s44 offen offset:0 sc1 lds
v_mfma_f32_16x16x32_bf16 v[212:215], a[100:103], a[60:63], v[212:215]
ds_read_b128 a[136:139], v5 offset:36864
v_mfma_f32_16x16x32_bf16 v[212:215], a[96:99], a[56:59], v[212:215]
v_mfma_f32_16x16x32_bf16 v[216:219], a[104:107], a[56:59], v[216:219]
ds_read_b128 a[140:143], v5 offset:43008
v_mfma_f32_16x16x32_bf16 v[216:219], a[108:111], a[60:63], v[216:219]
buffer_load_dwordx4 a[4:7], v2, s[40:43], s33 offen offset:0 sc1
v_mfma_f32_16x16x32_bf16 v[192:195], a[108:111], a[52:55], v[192:195]
ds_read_b128 a[144:147], v5 offset:37888
v_mfma_f32_16x16x32_bf16 v[192:195], a[104:107], a[48:51], v[192:195]
v_mfma_f32_16x16x32_bf16 v[168:171], a[104:107], a[40:43], v[168:171]
v_mfma_f32_16x16x32_bf16 v[168:171], a[108:111], a[44:47], v[168:171]
buffer_load_dwordx4 a[8:11], v2, s[40:43], s35 offen offset:1024 sc1
v_mfma_f32_16x16x32_bf16 v[144:147], a[108:111], a[36:39], v[144:147]
ds_read_b128 a[148:151], v5 offset:44032
v_mfma_f32_16x16x32_bf16 v[144:147], a[104:107], a[32:35], v[144:147]
v_mfma_f32_16x16x32_bf16 v[148:151], a[112:115], a[32:35], v[148:151]
v_mfma_f32_16x16x32_bf16 v[148:151], a[116:119], a[36:39], v[148:151]
buffer_load_dwordx4 v1, s[4:7], s44 offen offset:1024 sc1 lds
s_add_u32 m0, s18, 0x2000
v_mfma_f32_16x16x32_bf16 v[172:175], a[116:119], a[44:47], v[172:175]
s_add_u32 s44, s50, 0x2c26000
v_mfma_f32_16x16x32_bf16 v[172:175], a[112:115], a[40:43], v[172:175]
v_mfma_f32_16x16x32_bf16 v[196:199], a[112:115], a[48:51], v[196:199]
v_mfma_f32_16x16x32_bf16 v[196:199], a[116:119], a[52:55], v[196:199]
buffer_load_dwordx4 a[12:15], v2, s[40:43], s33 offen offset:1024 sc1
v_mfma_f32_16x16x32_bf16 v[220:223], a[116:119], a[60:63], v[220:223]
v_mfma_f32_16x16x32_bf16 v[220:223], a[112:115], a[56:59], v[220:223]
s_waitcnt lgkmcnt(0)
s_barrier
v_mfma_f32_16x16x32_bf16 v[224:227], a[128:131], a[56:59], v[224:227]
v_add_u32 v5, 98304, v1
v_mfma_f32_16x16x32_bf16 v[224:227], a[132:135], a[60:63], v[224:227]
buffer_load_dwordx4 a[16:19], v2, s[40:43], s35 offen offset:2048 sc1
v_mfma_f32_16x16x32_bf16 v[200:203], a[132:135], a[52:55], v[200:203]
ds_read_b128 a[96:99], v5 offset:2048
v_mfma_f32_16x16x32_bf16 v[200:203], a[128:131], a[48:51], v[200:203]
ds_read_b128 a[100:103], v5 offset:8192
v_mfma_f32_16x16x32_bf16 v[176:179], a[128:131], a[40:43], v[176:179]
v_mfma_f32_16x16x32_bf16 v[176:179], a[132:135], a[44:47], v[176:179]
buffer_load_dwordx4 a[20:23], v2, s[40:43], s33 offen offset:2048 sc1
v_mfma_f32_16x16x32_bf16 v[152:155], a[132:135], a[36:39], v[152:155]
ds_read_b128 a[104:107], v5 offset:3072
v_mfma_f32_16x16x32_bf16 v[152:155], a[128:131], a[32:35], v[152:155]
v_mfma_f32_16x16x32_bf16 v[132:135], a[136:139], a[32:35], v[132:135]
ds_read_b128 a[108:111], v5 offset:9216
v_mfma_f32_16x16x32_bf16 v[132:135], a[140:143], a[36:39], v[132:135]
v_mfma_f32_16x16x32_bf16 v[156:159], a[140:143], a[44:47], v[156:159]
buffer_load_dwordx4 v1, s[4:7], s44 offen offset:0 sc1 lds
v_mfma_f32_16x16x32_bf16 v[156:159], a[136:139], a[40:43], v[156:159]
ds_read_b128 a[112:115], v5 offset:4096
v_mfma_f32_16x16x32_bf16 v[180:183], a[136:139], a[48:51], v[180:183]
v_mfma_f32_16x16x32_bf16 v[180:183], a[140:143], a[52:55], v[180:183]
ds_read_b128 a[116:119], v5 offset:10240
v_mfma_f32_16x16x32_bf16 v[204:207], a[140:143], a[60:63], v[204:207]
v_mfma_f32_16x16x32_bf16 v[204:207], a[136:139], a[56:59], v[204:207]
buffer_load_dwordx4 a[24:27], v2, s[40:43], s35 offen offset:3072 sc1
v_mfma_f32_16x16x32_bf16 v[208:211], a[144:147], a[56:59], v[208:211]
v_mfma_f32_16x16x32_bf16 v[208:211], a[148:151], a[60:63], v[208:211]
v_mfma_f32_16x16x32_bf16 v[184:187], a[148:151], a[52:55], v[184:187]
v_mfma_f32_16x16x32_bf16 v[184:187], a[144:147], a[48:51], v[184:187]
v_mfma_f32_16x16x32_bf16 v[160:163], a[144:147], a[40:43], v[160:163]
buffer_load_dwordx4 a[28:31], v2, s[40:43], s33 offen offset:3072 sc1
s_add_u32 s35, s35, 0x4000
v_mfma_f32_16x16x32_bf16 v[160:163], a[148:151], a[44:47], v[160:163]
s_add_u32 s33, s33, 0x4000
v_mfma_f32_16x16x32_bf16 v[136:139], a[148:151], a[36:39], v[136:139]
v_mfma_f32_16x16x32_bf16 v[136:139], a[144:147], a[32:35], v[136:139]
s_waitcnt vmcnt(11) lgkmcnt(0)
v_mfma_f32_16x16x32_bf16 v[140:143], a[96:99], a[64:67], v[140:143]
ds_read_b128 a[128:131], v5 offset:5120
v_mfma_f32_16x16x32_bf16 v[140:143], a[100:103], a[68:71], v[140:143]
buffer_load_dwordx4 a[32:35], v2, s[40:43], s35 offen offset:0 sc1
v_mfma_f32_16x16x32_bf16 v[164:167], a[100:103], a[76:79], v[164:167]
ds_read_b128 a[132:135], v5 offset:11264
v_mfma_f32_16x16x32_bf16 v[164:167], a[96:99], a[72:75], v[164:167]
v_mfma_f32_16x16x32_bf16 v[188:191], a[96:99], a[80:83], v[188:191]
v_mfma_f32_16x16x32_bf16 v[188:191], a[100:103], a[84:87], v[188:191]
buffer_load_dwordx4 a[36:39], v2, s[40:43], s33 offen offset:0 sc1
v_mfma_f32_16x16x32_bf16 v[212:215], a[100:103], a[92:95], v[212:215]
ds_read_b128 a[136:139], v5 offset:0
v_mfma_f32_16x16x32_bf16 v[212:215], a[96:99], a[88:91], v[212:215]
v_mfma_f32_16x16x32_bf16 v[216:219], a[104:107], a[88:91], v[216:219]
ds_read_b128 a[140:143], v5 offset:6144
v_mfma_f32_16x16x32_bf16 v[216:219], a[108:111], a[92:95], v[216:219]
v_mfma_f32_16x16x32_bf16 v[192:195], a[108:111], a[84:87], v[192:195]
buffer_load_dwordx4 v1, s[4:7], s44 offen offset:1024 sc1 lds
s_add_u32 m0, s18, 0x4000
v_mfma_f32_16x16x32_bf16 v[192:195], a[104:107], a[80:83], v[192:195]
s_add_u32 s44, s50, 0x2c28000
ds_read_b128 a[144:147], v5 offset:1024
v_mfma_f32_16x16x32_bf16 v[168:171], a[104:107], a[72:75], v[168:171]
v_mfma_f32_16x16x32_bf16 v[168:171], a[108:111], a[76:79], v[168:171]
ds_read_b128 a[148:151], v5 offset:7168
v_mfma_f32_16x16x32_bf16 v[144:147], a[108:111], a[68:71], v[144:147]
v_mfma_f32_16x16x32_bf16 v[144:147], a[104:107], a[64:67], v[144:147]
buffer_load_dwordx4 a[40:43], v2, s[40:43], s35 offen offset:1024 sc1
v_mfma_f32_16x16x32_bf16 v[148:151], a[112:115], a[64:67], v[148:151]
v_mfma_f32_16x16x32_bf16 v[148:151], a[116:119], a[68:71], v[148:151]
v_mfma_f32_16x16x32_bf16 v[172:175], a[116:119], a[76:79], v[172:175]
v_mfma_f32_16x16x32_bf16 v[172:175], a[112:115], a[72:75], v[172:175]
v_mfma_f32_16x16x32_bf16 v[196:199], a[112:115], a[80:83], v[196:199]
buffer_load_dwordx4 a[44:47], v2, s[40:43], s33 offen offset:1024 sc1
v_mfma_f32_16x16x32_bf16 v[196:199], a[116:119], a[84:87], v[196:199]
v_mfma_f32_16x16x32_bf16 v[220:223], a[116:119], a[92:95], v[220:223]
v_mfma_f32_16x16x32_bf16 v[220:223], a[112:115], a[88:91], v[220:223]
s_waitcnt lgkmcnt(0)
v_mfma_f32_16x16x32_bf16 v[224:227], a[128:131], a[88:91], v[224:227]
ds_read_b128 a[96:99], v5 offset:14336
v_mfma_f32_16x16x32_bf16 v[224:227], a[132:135], a[92:95], v[224:227]
buffer_load_dwordx4 a[48:51], v2, s[40:43], s35 offen offset:2048 sc1
v_mfma_f32_16x16x32_bf16 v[200:203], a[132:135], a[84:87], v[200:203]
ds_read_b128 a[100:103], v5 offset:20480
v_mfma_f32_16x16x32_bf16 v[200:203], a[128:131], a[80:83], v[200:203]
v_mfma_f32_16x16x32_bf16 v[176:179], a[128:131], a[72:75], v[176:179]
v_mfma_f32_16x16x32_bf16 v[176:179], a[132:135], a[76:79], v[176:179]
buffer_load_dwordx4 a[52:55], v2, s[40:43], s33 offen offset:2048 sc1
v_mfma_f32_16x16x32_bf16 v[152:155], a[132:135], a[68:71], v[152:155]
ds_read_b128 a[104:107], v5 offset:15360
v_mfma_f32_16x16x32_bf16 v[152:155], a[128:131], a[64:67], v[152:155]
v_mfma_f32_16x16x32_bf16 v[132:135], a[136:139], a[64:67], v[132:135]
ds_read_b128 a[108:111], v5 offset:21504
v_mfma_f32_16x16x32_bf16 v[132:135], a[140:143], a[68:71], v[132:135]
v_mfma_f32_16x16x32_bf16 v[156:159], a[140:143], a[76:79], v[156:159]
buffer_load_dwordx4 v1, s[4:7], s44 offen offset:0 sc1 lds
v_mfma_f32_16x16x32_bf16 v[156:159], a[136:139], a[72:75], v[156:159]
ds_read_b128 a[112:115], v5 offset:16384
v_mfma_f32_16x16x32_bf16 v[180:183], a[136:139], a[80:83], v[180:183]
v_mfma_f32_16x16x32_bf16 v[180:183], a[140:143], a[84:87], v[180:183]
ds_read_b128 a[116:119], v5 offset:22528
v_mfma_f32_16x16x32_bf16 v[204:207], a[140:143], a[92:95], v[204:207]
v_mfma_f32_16x16x32_bf16 v[204:207], a[136:139], a[88:91], v[204:207]
buffer_load_dwordx4 a[56:59], v2, s[40:43], s35 offen offset:3072 sc1
v_mfma_f32_16x16x32_bf16 v[208:211], a[144:147], a[88:91], v[208:211]
v_mfma_f32_16x16x32_bf16 v[208:211], a[148:151], a[92:95], v[208:211]
v_mfma_f32_16x16x32_bf16 v[184:187], a[148:151], a[84:87], v[184:187]
v_mfma_f32_16x16x32_bf16 v[184:187], a[144:147], a[80:83], v[184:187]
v_mfma_f32_16x16x32_bf16 v[160:163], a[144:147], a[72:75], v[160:163]
buffer_load_dwordx4 a[60:63], v2, s[40:43], s33 offen offset:3072 sc1
s_add_u32 s35, s35, 0x4000
v_mfma_f32_16x16x32_bf16 v[160:163], a[148:151], a[76:79], v[160:163]
s_add_u32 s33, s33, 0x4000
v_mfma_f32_16x16x32_bf16 v[136:139], a[148:151], a[68:71], v[136:139]
v_mfma_f32_16x16x32_bf16 v[136:139], a[144:147], a[64:67], v[136:139]
s_waitcnt vmcnt(10) lgkmcnt(0)
v_mfma_f32_16x16x32_bf16 v[140:143], a[96:99], a[0:3], v[140:143]
ds_read_b128 a[128:131], v5 offset:17408
v_add_f32 v92, v92, v96
v_mfma_f32_16x16x32_bf16 v[140:143], a[100:103], a[4:7], v[140:143]
buffer_load_dwordx4 a[64:67], v2, s[40:43], s35 offen offset:0 sc1
v_mfma_f32_16x16x32_bf16 v[164:167], a[100:103], a[12:15], v[164:167]
ds_read_b128 a[132:135], v5 offset:23552
v_add_f32 v100, v100, v104
v_mfma_f32_16x16x32_bf16 v[164:167], a[96:99], a[8:11], v[164:167]
v_add_f32 v108, v108, v112
v_add_f32 v116, v116, v120
v_mfma_f32_16x16x32_bf16 v[188:191], a[96:99], a[16:19], v[188:191]
v_add_f32 v93, v93, v97
v_add_f32 v101, v101, v105
v_mfma_f32_16x16x32_bf16 v[188:191], a[100:103], a[20:23], v[188:191]
buffer_load_dwordx4 a[68:71], v2, s[40:43], s33 offen offset:0 sc1
v_mfma_f32_16x16x32_bf16 v[212:215], a[100:103], a[28:31], v[212:215]
ds_read_b128 a[136:139], v5 offset:12288
v_add_f32 v109, v109, v113
v_mfma_f32_16x16x32_bf16 v[212:215], a[96:99], a[24:27], v[212:215]
v_add_f32 v117, v117, v121
v_add_f32 v94, v94, v98
v_mfma_f32_16x16x32_bf16 v[216:219], a[104:107], a[24:27], v[216:219]
ds_read_b128 a[140:143], v5 offset:18432
v_add_f32 v102, v102, v106
v_mfma_f32_16x16x32_bf16 v[216:219], a[108:111], a[28:31], v[216:219]
v_add_f32 v110, v110, v114
v_mfma_f32_16x16x32_bf16 v[192:195], a[108:111], a[20:23], v[192:195]
buffer_load_dwordx4 v1, s[4:7], s44 offen offset:1024 sc1 lds
s_add_u32 m0, s18, 0x6000
v_mfma_f32_16x16x32_bf16 v[192:195], a[104:107], a[16:19], v[192:195]
s_add_u32 s44, s50, 0x2c2a000
ds_read_b128 a[144:147], v5 offset:13312
v_mfma_f32_16x16x32_bf16 v[168:171], a[104:107], a[8:11], v[168:171]
v_add_f32 v118, v118, v122
v_add_f32 v95, v95, v99
v_mfma_f32_16x16x32_bf16 v[168:171], a[108:111], a[12:15], v[168:171]
ds_read_b128 a[148:151], v5 offset:19456
v_add_f32 v103, v103, v107
v_mfma_f32_16x16x32_bf16 v[144:147], a[108:111], a[4:7], v[144:147]
v_add_f32 v111, v111, v115
v_add_f32 v119, v119, v123
v_mfma_f32_16x16x32_bf16 v[144:147], a[104:107], a[0:3], v[144:147]
buffer_load_dwordx4 a[72:75], v2, s[40:43], s35 offen offset:1024 sc1
v_mfma_f32_16x16x32_bf16 v[148:151], a[112:115], a[0:3], v[148:151]
v_add_f32_dpp v92, v92, v92 row_ror:8 row_mask:0xf bank_mask:0xf
v_add_f32_dpp v100, v100, v100 row_ror:8 row_mask:0xf bank_mask:0xf
v_mfma_f32_16x16x32_bf16 v[148:151], a[116:119], a[4:7], v[148:151]
v_add_f32_dpp v108, v108, v108 row_ror:8 row_mask:0xf bank_mask:0xf
v_mfma_f32_16x16x32_bf16 v[172:175], a[116:119], a[12:15], v[172:175]
v_add_f32_dpp v116, v116, v116 row_ror:8 row_mask:0xf bank_mask:0xf
v_mfma_f32_16x16x32_bf16 v[172:175], a[112:115], a[8:11], v[172:175]
v_add_f32_dpp v93, v93, v93 row_ror:8 row_mask:0xf bank_mask:0xf
v_mfma_f32_16x16x32_bf16 v[196:199], a[112:115], a[16:19], v[196:199]
buffer_load_dwordx4 a[76:79], v2, s[40:43], s33 offen offset:1024 sc1
v_mfma_f32_16x16x32_bf16 v[196:199], a[116:119], a[20:23], v[196:199]
v_add_f32_dpp v101, v101, v101 row_ror:8 row_mask:0xf bank_mask:0xf
v_add_f32_dpp v109, v109, v109 row_ror:8 row_mask:0xf bank_mask:0xf
v_mfma_f32_16x16x32_bf16 v[220:223], a[116:119], a[28:31], v[220:223]
v_add_f32_dpp v117, v117, v117 row_ror:8 row_mask:0xf bank_mask:0xf
v_mfma_f32_16x16x32_bf16 v[220:223], a[112:115], a[24:27], v[220:223]
v_add_f32_dpp v92, v94, v94 row_ror:8 row_mask:0xf bank_mask:0xc
s_waitcnt lgkmcnt(0)
v_mfma_f32_16x16x32_bf16 v[224:227], a[128:131], a[24:27], v[224:227]
ds_read_b128 a[96:99], v5 offset:26624
v_add_f32_dpp v100, v102, v102 row_ror:8 row_mask:0xf bank_mask:0xc
v_mfma_f32_16x16x32_bf16 v[224:227], a[132:135], a[28:31], v[224:227]
buffer_load_dwordx4 a[80:83], v2, s[40:43], s35 offen offset:2048 sc1
v_mfma_f32_16x16x32_bf16 v[200:203], a[132:135], a[20:23], v[200:203]
ds_read_b128 a[100:103], v5 offset:32768
v_add_f32_dpp v108, v110, v110 row_ror:8 row_mask:0xf bank_mask:0xc
v_mfma_f32_16x16x32_bf16 v[200:203], a[128:131], a[16:19], v[200:203]
v_add_f32_dpp v116, v118, v118 row_ror:8 row_mask:0xf bank_mask:0xc
v_add_f32_dpp v93, v95, v95 row_ror:8 row_mask:0xf bank_mask:0xc
v_mfma_f32_16x16x32_bf16 v[176:179], a[128:131], a[8:11], v[176:179]
v_add_f32_dpp v101, v103, v103 row_ror:8 row_mask:0xf bank_mask:0xc
v_add_f32_dpp v109, v111, v111 row_ror:8 row_mask:0xf bank_mask:0xc
v_mfma_f32_16x16x32_bf16 v[176:179], a[132:135], a[12:15], v[176:179]
buffer_load_dwordx4 v1, s[4:7], s44 offen offset:0 sc1 lds
v_mfma_f32_16x16x32_bf16 v[152:155], a[132:135], a[4:7], v[152:155]
ds_read_b128 a[104:107], v5 offset:27648
v_add_f32_dpp v117, v119, v119 row_ror:8 row_mask:0xf bank_mask:0xc
v_mfma_f32_16x16x32_bf16 v[152:155], a[128:131], a[0:3], v[152:155]
v_permlane32_swap_b32 v92, v93
v_mfma_f32_16x16x32_bf16 v[132:135], a[136:139], a[0:3], v[132:135]
ds_read_b128 a[108:111], v5 offset:33792
v_mfma_f32_16x16x32_bf16 v[132:135], a[140:143], a[4:7], v[132:135]
buffer_load_dwordx4 a[84:87], v2, s[40:43], s33 offen offset:2048 sc1
v_mfma_f32_16x16x32_bf16 v[156:159], a[140:143], a[12:15], v[156:159]
ds_read_b128 a[112:115], v5 offset:28672
v_mfma_f32_16x16x32_bf16 v[156:159], a[136:139], a[8:11], v[156:159]
v_permlane32_swap_b32 v100, v101
v_mfma_f32_16x16x32_bf16 v[180:183], a[136:139], a[16:19], v[180:183]
v_permlane32_swap_b32 v108, v109
v_mfma_f32_16x16x32_bf16 v[180:183], a[140:143], a[20:23], v[180:183]
buffer_load_dwordx4 a[88:91], v2, s[40:43], s35 offen offset:3072 sc1
v_mfma_f32_16x16x32_bf16 v[204:207], a[140:143], a[28:31], v[204:207]
ds_read_b128 a[116:119], v5 offset:34816
v_mfma_f32_16x16x32_bf16 v[204:207], a[136:139], a[24:27], v[204:207]
v_permlane32_swap_b32 v116, v117
v_mfma_f32_16x16x32_bf16 v[208:211], a[144:147], a[24:27], v[208:211]
v_add_f32 v92, v92, v93
v_add_f32 v100, v100, v101
v_mfma_f32_16x16x32_bf16 v[208:211], a[148:151], a[28:31], v[208:211]
buffer_load_dwordx4 v1, s[4:7], s44 offen offset:1024 sc1 lds
s_add_u32 m0, s18, 0x8000
v_mfma_f32_16x16x32_bf16 v[184:187], a[148:151], a[20:23], v[184:187]
s_add_u32 s44, s50, 0x2c2c000
v_add_f32 v108, v108, v109
v_mfma_f32_16x16x32_bf16 v[184:187], a[144:147], a[16:19], v[184:187]
v_add_f32 v116, v116, v117
v_mov_b32 v94, v92
v_mfma_f32_16x16x32_bf16 v[160:163], a[144:147], a[8:11], v[160:163]
v_mov_b32 v102, v100
v_mov_b32 v110, v108
v_mfma_f32_16x16x32_bf16 v[160:163], a[148:151], a[12:15], v[160:163]
buffer_load_dwordx4 a[92:95], v2, s[40:43], s33 offen offset:3072 sc1
s_add_u32 s35, s35, 0x4000
v_mfma_f32_16x16x32_bf16 v[136:139], a[148:151], a[4:7], v[136:139]
s_add_u32 s33, s33, 0x4000
v_mov_b32 v118, v116
v_mfma_f32_16x16x32_bf16 v[136:139], a[144:147], a[0:3], v[136:139]
s_waitcnt vmcnt(11) lgkmcnt(0)
v_mfma_f32_16x16x32_bf16 v[140:143], a[96:99], a[32:35], v[140:143]
ds_read_b128 a[128:131], v5 offset:29696
v_mfma_f32_16x16x32_bf16 v[140:143], a[100:103], a[36:39], v[140:143]
buffer_load_dwordx4 a[0:3], v2, s[40:43], s35 offen offset:0 sc1
v_mfma_f32_16x16x32_bf16 v[164:167], a[100:103], a[44:47], v[164:167]
ds_read_b128 a[132:135], v5 offset:35840
v_mfma_f32_16x16x32_bf16 v[164:167], a[96:99], a[40:43], v[164:167]
v_permlane16_swap_b32 v92, v94
v_mfma_f32_16x16x32_bf16 v[188:191], a[96:99], a[48:51], v[188:191]
v_permlane16_swap_b32 v100, v102
v_mfma_f32_16x16x32_bf16 v[188:191], a[100:103], a[52:55], v[188:191]
buffer_load_dwordx4 a[4:7], v2, s[40:43], s33 offen offset:0 sc1
v_mfma_f32_16x16x32_bf16 v[212:215], a[100:103], a[60:63], v[212:215]
ds_read_b128 a[136:139], v5 offset:24576
v_mfma_f32_16x16x32_bf16 v[212:215], a[96:99], a[56:59], v[212:215]
v_permlane16_swap_b32 v108, v110
v_mfma_f32_16x16x32_bf16 v[216:219], a[104:107], a[56:59], v[216:219]
ds_read_b128 a[140:143], v5 offset:30720
v_mfma_f32_16x16x32_bf16 v[216:219], a[108:111], a[60:63], v[216:219]
v_permlane16_swap_b32 v116, v118
v_mfma_f32_16x16x32_bf16 v[192:195], a[108:111], a[52:55], v[192:195]
buffer_load_dwordx4 v1, s[4:7], s44 offen offset:0 sc1 lds
v_mfma_f32_16x16x32_bf16 v[192:195], a[104:107], a[48:51], v[192:195]
ds_read_b128 a[144:147], v5 offset:25600
v_add_f32 v92, v92, v94
v_mfma_f32_16x16x32_bf16 v[168:171], a[104:107], a[40:43], v[168:171]
v_add_f32 v100, v100, v102
v_add_f32 v108, v108, v110
v_mfma_f32_16x16x32_bf16 v[168:171], a[108:111], a[44:47], v[168:171]
ds_read_b128 a[148:151], v5 offset:31744
v_add_f32 v116, v116, v118
v_mfma_f32_16x16x32_bf16 v[144:147], a[108:111], a[36:39], v[144:147]
v_mov_b32 v94, v92
v_mov_b32 v102, v100
v_mfma_f32_16x16x32_bf16 v[144:147], a[104:107], a[32:35], v[144:147]
buffer_load_dwordx4 a[8:11], v2, s[40:43], s35 offen offset:1024 sc1
v_mfma_f32_16x16x32_bf16 v[148:151], a[112:115], a[32:35], v[148:151]
v_mov_b32 v110, v108
v_mov_b32 v118, v116
v_mfma_f32_16x16x32_bf16 v[148:151], a[116:119], a[36:39], v[148:151]
v_permlane32_swap_b32 v92, v94
v_mfma_f32_16x16x32_bf16 v[172:175], a[116:119], a[44:47], v[172:175]
v_permlane32_swap_b32 v100, v102
v_mfma_f32_16x16x32_bf16 v[172:175], a[112:115], a[40:43], v[172:175]
v_permlane32_swap_b32 v108, v110
v_mfma_f32_16x16x32_bf16 v[196:199], a[112:115], a[48:51], v[196:199]
buffer_load_dwordx4 a[12:15], v2, s[40:43], s33 offen offset:1024 sc1
v_mfma_f32_16x16x32_bf16 v[196:199], a[116:119], a[52:55], v[196:199]
v_permlane32_swap_b32 v116, v118
v_mfma_f32_16x16x32_bf16 v[220:223], a[116:119], a[60:63], v[220:223]
v_mul_f32 v82, 0xba800000, v92
v_mul_f32 v84, 0xba800000, v100
v_mfma_f32_16x16x32_bf16 v[220:223], a[112:115], a[56:59], v[220:223]
v_mul_f32 v86, 0xba800000, v108
s_waitcnt lgkmcnt(0)
v_mfma_f32_16x16x32_bf16 v[224:227], a[128:131], a[56:59], v[224:227]
ds_read_b128 a[96:99], v5 offset:38912
v_mul_f32 v88, 0xba800000, v116
v_mfma_f32_16x16x32_bf16 v[224:227], a[132:135], a[60:63], v[224:227]
buffer_load_dwordx4 a[16:19], v2, s[40:43], s35 offen offset:2048 sc1
v_mfma_f32_16x16x32_bf16 v[200:203], a[132:135], a[52:55], v[200:203]
ds_read_b128 a[100:103], v5 offset:45056
v_mul_f32 v94, 0x3a800000, v94
v_mfma_f32_16x16x32_bf16 v[200:203], a[128:131], a[48:51], v[200:203]
v_mul_f32 v102, 0x3a800000, v102
v_mul_f32 v110, 0x3a800000, v110
v_mfma_f32_16x16x32_bf16 v[176:179], a[128:131], a[40:43], v[176:179]
v_mul_f32 v118, 0x3a800000, v118
v_fma_f32 v94, -v82, v82, v94
v_mfma_f32_16x16x32_bf16 v[176:179], a[132:135], a[44:47], v[176:179]
buffer_load_dwordx4 a[20:23], v2, s[40:43], s33 offen offset:2048 sc1
v_mfma_f32_16x16x32_bf16 v[152:155], a[132:135], a[36:39], v[152:155]
ds_read_b128 a[104:107], v5 offset:39936
v_fma_f32 v102, -v84, v84, v102
v_mfma_f32_16x16x32_bf16 v[152:155], a[128:131], a[32:35], v[152:155]
v_fma_f32 v110, -v86, v86, v110
v_fma_f32 v118, -v88, v88, v118
v_mfma_f32_16x16x32_bf16 v[132:135], a[136:139], a[32:35], v[132:135]
ds_read_b128 a[108:111], v5 offset:46080
v_max_f32 v94, 0, v94
v_mfma_f32_16x16x32_bf16 v[132:135], a[140:143], a[36:39], v[132:135]
v_max_f32 v102, 0, v102
v_mfma_f32_16x16x32_bf16 v[156:159], a[140:143], a[44:47], v[156:159]
buffer_load_dwordx4 v1, s[4:7], s44 offen offset:1024 sc1 lds
s_add_u32 m0, s18, 0xa000
v_mfma_f32_16x16x32_bf16 v[156:159], a[136:139], a[40:43], v[156:159]
s_add_u32 s44, s50, 0x2c2e000
ds_read_b128 a[112:115], v5 offset:40960
v_mfma_f32_16x16x32_bf16 v[180:183], a[136:139], a[48:51], v[180:183]
v_max_f32 v110, 0, v110
v_max_f32 v118, 0, v118
v_mfma_f32_16x16x32_bf16 v[180:183], a[140:143], a[52:55], v[180:183]
ds_read_b128 a[116:119], v5 offset:47104
v_add_f32 v94, 0x3727c5ac, v94
v_mfma_f32_16x16x32_bf16 v[204:207], a[140:143], a[60:63], v[204:207]
v_add_f32 v102, 0x3727c5ac, v102
v_add_f32 v110, 0x3727c5ac, v110
v_mfma_f32_16x16x32_bf16 v[204:207], a[136:139], a[56:59], v[204:207]
buffer_load_dwordx4 a[24:27], v2, s[40:43], s35 offen offset:3072 sc1
v_mfma_f32_16x16x32_bf16 v[208:211], a[144:147], a[56:59], v[208:211]
v_add_f32 v118, 0x3727c5ac, v118
v_mfma_f32_16x16x32_bf16 v[208:211], a[148:151], a[60:63], v[208:211]
v_rsq_f32 v83, v94
v_mfma_f32_16x16x32_bf16 v[184:187], a[148:151], a[52:55], v[184:187]
v_rsq_f32 v85, v102
v_mfma_f32_16x16x32_bf16 v[184:187], a[144:147], a[48:51], v[184:187]
v_mfma_f32_16x16x32_bf16 v[160:163], a[144:147], a[40:43], v[160:163]
buffer_load_dwordx4 a[28:31], v2, s[40:43], s33 offen offset:3072 sc1
s_add_u32 s35, s35, 0x4000
v_mfma_f32_16x16x32_bf16 v[160:163], a[148:151], a[44:47], v[160:163]
s_add_u32 s33, s33, 0x4000
v_mfma_f32_16x16x32_bf16 v[136:139], a[148:151], a[36:39], v[136:139]
v_rsq_f32 v87, v110
v_mfma_f32_16x16x32_bf16 v[136:139], a[144:147], a[32:35], v[136:139]
s_waitcnt vmcnt(10) lgkmcnt(0)
v_mfma_f32_16x16x32_bf16 v[140:143], a[96:99], a[64:67], v[140:143]
ds_read_b128 a[128:131], v5 offset:41984
v_mfma_f32_16x16x32_bf16 v[140:143], a[100:103], a[68:71], v[140:143]
buffer_load_dwordx4 a[32:35], v2, s[40:43], s35 offen offset:0 sc1
v_mfma_f32_16x16x32_bf16 v[164:167], a[100:103], a[76:79], v[164:167]
ds_read_b128 a[132:135], v5 offset:48128
v_mfma_f32_16x16x32_bf16 v[164:167], a[96:99], a[72:75], v[164:167]
v_rsq_f32 v89, v118
v_mfma_f32_16x16x32_bf16 v[188:191], a[96:99], a[80:83], v[188:191]
v_mfma_f32_16x16x32_bf16 v[188:191], a[100:103], a[84:87], v[188:191]
buffer_load_dwordx4 a[36:39], v2, s[40:43], s33 offen offset:0 sc1
v_mfma_f32_16x16x32_bf16 v[212:215], a[100:103], a[92:95], v[212:215]
ds_read_b128 a[136:139], v5 offset:36864
v_mfma_f32_16x16x32_bf16 v[212:215], a[96:99], a[88:91], v[212:215]
v_mfma_f32_16x16x32_bf16 v[216:219], a[104:107], a[88:91], v[216:219]
ds_read_b128 a[140:143], v5 offset:43008
v_mfma_f32_16x16x32_bf16 v[216:219], a[108:111], a[92:95], v[216:219]
v_mfma_f32_16x16x32_bf16 v[192:195], a[108:111], a[84:87], v[192:195]
buffer_load_dwordx4 v1, s[4:7], s44 offen offset:0 sc1 lds
v_mfma_f32_16x16x32_bf16 v[192:195], a[104:107], a[80:83], v[192:195]
ds_read_b128 a[144:147], v5 offset:37888
v_fmac_f32 v140, v56, v82
v_mfma_f32_16x16x32_bf16 v[168:171], a[104:107], a[72:75], v[168:171]
v_fmac_f32 v164, v56, v84
v_mfma_f32_16x16x32_bf16 v[168:171], a[108:111], a[76:79], v[168:171]
ds_read_b128 a[148:151], v5 offset:44032
v_mfma_f32_16x16x32_bf16 v[144:147], a[108:111], a[68:71], v[144:147]
v_fmac_f32 v188, v56, v86
v_mfma_f32_16x16x32_bf16 v[144:147], a[104:107], a[64:67], v[144:147]
buffer_load_dwordx4 a[40:43], v2, s[40:43], s35 offen offset:1024 sc1
v_mfma_f32_16x16x32_bf16 v[148:151], a[112:115], a[64:67], v[148:151]
v_fmac_f32 v212, v56, v88
v_mfma_f32_16x16x32_bf16 v[148:151], a[116:119], a[68:71], v[148:151]
v_mfma_f32_16x16x32_bf16 v[172:175], a[116:119], a[76:79], v[172:175]
v_fmac_f32 v216, v60, v88
v_mfma_f32_16x16x32_bf16 v[172:175], a[112:115], a[72:75], v[172:175]
v_mfma_f32_16x16x32_bf16 v[196:199], a[112:115], a[80:83], v[196:199]
buffer_load_dwordx4 a[44:47], v2, s[40:43], s33 offen offset:1024 sc1
v_mfma_f32_16x16x32_bf16 v[196:199], a[116:119], a[84:87], v[196:199]
v_fmac_f32 v192, v60, v86
v_mfma_f32_16x16x32_bf16 v[220:223], a[116:119], a[92:95], v[220:223]
v_fmac_f32 v168, v60, v84
v_fmac_f32 v141, v57, v82
v_mfma_f32_16x16x32_bf16 v[220:223], a[112:115], a[88:91], v[220:223]
s_waitcnt lgkmcnt(0)
s_barrier
v_mfma_f32_16x16x32_bf16 v[224:227], a[128:131], a[88:91], v[224:227]
v_add_u32 v5, 0, v1
v_fmac_f32 v144, v60, v82
v_mfma_f32_16x16x32_bf16 v[224:227], a[132:135], a[92:95], v[224:227]
buffer_load_dwordx4 a[48:51], v2, s[40:43], s35 offen offset:2048 sc1
v_mfma_f32_16x16x32_bf16 v[200:203], a[132:135], a[84:87], v[200:203]
ds_read_b128 a[96:99], v5 offset:2048
v_fmac_f32 v148, v64, v82
v_mfma_f32_16x16x32_bf16 v[200:203], a[128:131], a[80:83], v[200:203]
ds_read_b128 a[100:103], v5 offset:8192
v_fmac_f32 v165, v57, v84
v_mfma_f32_16x16x32_bf16 v[176:179], a[128:131], a[72:75], v[176:179]
v_fmac_f32 v172, v64, v84
v_fmac_f32 v189, v57, v86
v_mfma_f32_16x16x32_bf16 v[176:179], a[132:135], a[76:79], v[176:179]
buffer_load_dwordx4 a[52:55], v2, s[40:43], s33 offen offset:2048 sc1
v_mfma_f32_16x16x32_bf16 v[152:155], a[132:135], a[68:71], v[152:155]
ds_read_b128 a[104:107], v5 offset:3072
v_fmac_f32 v196, v64, v86
v_mfma_f32_16x16x32_bf16 v[152:155], a[128:131], a[64:67], v[152:155]
v_fmac_f32 v213, v57, v88
v_fmac_f32 v217, v61, v88
v_mfma_f32_16x16x32_bf16 v[132:135], a[136:139], a[64:67], v[132:135]
ds_read_b128 a[108:111], v5 offset:9216
v_fmac_f32 v220, v64, v88
v_mfma_f32_16x16x32_bf16 v[132:135], a[140:143], a[68:71], v[132:135]
v_fmac_f32 v193, v61, v86
v_mfma_f32_16x16x32_bf16 v[156:159], a[140:143], a[76:79], v[156:159]
buffer_load_dwordx4 v1, s[4:7], s44 offen offset:1024 sc1 lds
s_add_u32 m0, s19, 49152
v_mfma_f32_16x16x32_bf16 v[156:159], a[136:139], a[72:75], v[156:159]
s_add_u32 s44, s85, 0xa04000
ds_read_b128 a[112:115], v5 offset:4096
v_mfma_f32_16x16x32_bf16 v[180:183], a[136:139], a[80:83], v[180:183]
v_fmac_f32 v224, v68, v88
v_fmac_f32 v200, v68, v86
v_mfma_f32_16x16x32_bf16 v[180:183], a[140:143], a[84:87], v[180:183]
ds_read_b128 a[116:119], v5 offset:10240
v_fmac_f32 v169, v61, v84
v_mfma_f32_16x16x32_bf16 v[204:207], a[140:143], a[92:95], v[204:207]
v_fmac_f32 v176, v68, v84
v_fmac_f32 v145, v61, v82
v_mfma_f32_16x16x32_bf16 v[204:207], a[136:139], a[88:91], v[204:207]
buffer_load_dwordx4 a[56:59], v2, s[40:43], s35 offen offset:3072 sc1
v_mfma_f32_16x16x32_bf16 v[208:211], a[144:147], a[88:91], v[208:211]
v_fmac_f32 v152, v68, v82
v_fmac_f32 v149, v65, v82
v_mfma_f32_16x16x32_bf16 v[208:211], a[148:151], a[92:95], v[208:211]
v_fmac_f32 v173, v65, v84
v_mfma_f32_16x16x32_bf16 v[184:187], a[148:151], a[84:87], v[184:187]
v_fmac_f32 v132, v48, v82
v_fmac_f32 v197, v65, v86
v_mfma_f32_16x16x32_bf16 v[184:187], a[144:147], a[80:83], v[184:187]
v_mfma_f32_16x16x32_bf16 v[160:163], a[144:147], a[72:75], v[160:163]
buffer_load_dwordx4 a[60:63], v2, s[40:43], s33 offen offset:3072 sc1
s_add_u32 s35, s35, 0x4000
v_mfma_f32_16x16x32_bf16 v[160:163], a[148:151], a[76:79], v[160:163]
s_add_u32 s33, s33, 0x4000
v_fmac_f32 v156, v48, v84
v_mfma_f32_16x16x32_bf16 v[136:139], a[148:151], a[68:71], v[136:139]
v_fmac_f32 v180, v48, v86
v_fmac_f32 v221, v65, v88
v_mfma_f32_16x16x32_bf16 v[136:139], a[144:147], a[64:67], v[136:139]
v_fmac_f32 v225, v69, v88
s_waitcnt vmcnt(10) lgkmcnt(0)
v_mfma_f32_16x16x32_bf16 v[140:143], a[96:99], a[0:3], v[140:143]
ds_read_b128 a[128:131], v5 offset:5120
v_fmac_f32 v204, v48, v88
v_mfma_f32_16x16x32_bf16 v[140:143], a[100:103], a[4:7], v[140:143]
buffer_load_dwordx4 a[64:67], v2, s[40:43], s35 offen offset:0 sc1
s_lshl_b32 s37, s28, 10
v_mfma_f32_16x16x32_bf16 v[164:167], a[100:103], a[12:15], v[164:167]
ds_read_b128 a[132:135], v5 offset:11264
v_fmac_f32 v208, v52, v88
v_mfma_f32_16x16x32_bf16 v[164:167], a[96:99], a[8:11], v[164:167]
v_fmac_f32 v201, v69, v86
v_fmac_f32 v177, v69, v84
v_mfma_f32_16x16x32_bf16 v[188:191], a[96:99], a[16:19], v[188:191]
v_fmac_f32 v184, v52, v86
v_fmac_f32 v153, v69, v82
v_mfma_f32_16x16x32_bf16 v[188:191], a[100:103], a[20:23], v[188:191]
buffer_load_dwordx4 a[68:71], v2, s[40:43], s33 offen offset:0 sc1
s_add_u32 s72, s79, 0x2400000
v_mfma_f32_16x16x32_bf16 v[212:215], a[100:103], a[28:31], v[212:215]
ds_read_b128 a[136:139], v5 offset:0
v_fmac_f32 v160, v52, v84
v_mfma_f32_16x16x32_bf16 v[212:215], a[96:99], a[24:27], v[212:215]
v_fmac_f32 v133, v49, v82
s_add_u32 s63, s83, 0x980000
v_mfma_f32_16x16x32_bf16 v[216:219], a[104:107], a[24:27], v[216:219]
ds_read_b128 a[140:143], v5 offset:6144
v_fmac_f32 v136, v52, v82
v_mfma_f32_16x16x32_bf16 v[216:219], a[108:111], a[28:31], v[216:219]
buffer_load_dwordx4 a[72:75], v2, s[40:43], s35 offen offset:1024 sc1
L_stub12:
s_cbranch_execz L_stub13
s_sub_u32 s55, s63, 131072
v_mfma_f32_16x16x32_bf16 v[192:195], a[108:111], a[20:23], v[192:195]
ds_read_b128 a[144:147], v5 offset:1024
v_fmac_f32 v157, v49, v84
v_mfma_f32_16x16x32_bf16 v[192:195], a[104:107], a[16:19], v[192:195]
v_fmac_f32 v181, v49, v86
v_fmac_f32 v142, v58, v82
v_mfma_f32_16x16x32_bf16 v[168:171], a[104:107], a[8:11], v[168:171]
v_fmac_f32 v205, v49, v88
v_fmac_f32 v166, v58, v84
v_mfma_f32_16x16x32_bf16 v[168:171], a[108:111], a[12:15], v[168:171]
buffer_load_dwordx4 a[76:79], v2, s[40:43], s33 offen offset:1024 sc1
v_mfma_f32_16x16x32_bf16 v[144:147], a[108:111], a[4:7], v[144:147]
ds_read_b128 a[148:151], v5 offset:7168
v_fmac_f32 v209, v53, v88
v_mfma_f32_16x16x32_bf16 v[144:147], a[104:107], a[0:3], v[144:147]
v_fmac_f32 v190, v58, v86
v_add_u32 v233, s37, v1
v_mfma_f32_16x16x32_bf16 v[148:151], a[112:115], a[0:3], v[148:151]
v_fmac_f32 v185, v53, v86
v_fmac_f32 v214, v58, v88
v_mfma_f32_16x16x32_bf16 v[148:151], a[116:119], a[4:7], v[148:151]
buffer_load_dwordx4 a[80:83], v2, s[40:43], s35 offen offset:2048 sc1
v_mfma_f32_16x16x32_bf16 v[172:175], a[116:119], a[12:15], v[172:175]
v_fmac_f32 v161, v53, v84
v_fmac_f32 v218, v62, v88
v_mfma_f32_16x16x32_bf16 v[172:175], a[112:115], a[8:11], v[172:175]
v_add_u32 v232, s19, v7
v_add_u32 v248, s19, v8
v_mfma_f32_16x16x32_bf16 v[196:199], a[112:115], a[16:19], v[196:199]
v_fmac_f32 v137, v53, v82
v_fmac_f32 v194, v62, v86
v_mfma_f32_16x16x32_bf16 v[196:199], a[116:119], a[20:23], v[196:199]
buffer_load_dwordx4 a[84:87], v2, s[40:43], s33 offen offset:2048 sc1
v_mfma_f32_16x16x32_bf16 v[220:223], a[116:119], a[28:31], v[220:223]
v_fmac_f32 v170, v62, v84
v_fmac_f32 v143, v59, v82
v_mfma_f32_16x16x32_bf16 v[220:223], a[112:115], a[24:27], v[220:223]
s_waitcnt lgkmcnt(0)
v_mfma_f32_16x16x32_bf16 v[224:227], a[128:131], a[24:27], v[224:227]
ds_read_b128 a[96:99], v5 offset:14336
v_fmac_f32 v146, v62, v82
v_mfma_f32_16x16x32_bf16 v[224:227], a[132:135], a[28:31], v[224:227]
buffer_load_dwordx4 a[88:91], v2, s[40:43], s35 offen offset:3072 sc1
v_mfma_f32_16x16x32_bf16 v[200:203], a[132:135], a[20:23], v[200:203]
ds_read_b128 a[100:103], v5 offset:20480
v_fmac_f32 v150, v66, v82
v_mfma_f32_16x16x32_bf16 v[200:203], a[128:131], a[16:19], v[200:203]
v_fmac_f32 v167, v59, v84
v_fmac_f32 v191, v59, v86
v_mfma_f32_16x16x32_bf16 v[176:179], a[128:131], a[8:11], v[176:179]
v_fmac_f32 v174, v66, v84
v_fmac_f32 v215, v59, v88
v_mfma_f32_16x16x32_bf16 v[176:179], a[132:135], a[12:15], v[176:179]
ds_read_b128 a[104:107], v5 offset:15360
v_mfma_f32_16x16x32_bf16 v[152:155], a[132:135], a[4:7], v[152:155]
v_fmac_f32 v198, v66, v86
v_fmac_f32 v219, v63, v88
v_mfma_f32_16x16x32_bf16 v[152:155], a[128:131], a[0:3], v[152:155]
buffer_load_dwordx4 v1, s[4:7], s44 offen offset:0 sc1 lds
v_mfma_f32_16x16x32_bf16 v[132:135], a[136:139], a[0:3], v[132:135]
ds_read_b128 a[108:111], v5 offset:21504
v_fmac_f32 v222, v66, v88
v_mfma_f32_16x16x32_bf16 v[132:135], a[140:143], a[4:7], v[132:135]
v_fmac_f32 v195, v63, v86
v_mfma_f32_16x16x32_bf16 v[156:159], a[140:143], a[12:15], v[156:159]
ds_read_b128 a[112:115], v5 offset:16384
v_fmac_f32 v226, v70, v88
v_mfma_f32_16x16x32_bf16 v[156:159], a[136:139], a[8:11], v[156:159]
v_fmac_f32 v171, v63, v84
v_mfma_f32_16x16x32_bf16 v[180:183], a[136:139], a[16:19], v[180:183]
v_fmac_f32 v202, v70, v86
v_fmac_f32 v147, v63, v82
v_mfma_f32_16x16x32_bf16 v[180:183], a[140:143], a[20:23], v[180:183]
buffer_load_dwordx4 a[92:95], v2, s[40:43], s33 offen offset:3072 sc1
s_add_u32 s35, s35, 0x4000
v_mfma_f32_16x16x32_bf16 v[204:207], a[140:143], a[28:31], v[204:207]
s_add_u32 s33, s33, 0x4000
ds_read_b128 a[116:119], v5 offset:22528
v_mfma_f32_16x16x32_bf16 v[204:207], a[136:139], a[24:27], v[204:207]
v_fmac_f32 v178, v70, v84
v_fmac_f32 v151, v67, v82
v_mfma_f32_16x16x32_bf16 v[208:211], a[144:147], a[24:27], v[208:211]
v_fmac_f32 v154, v70, v82
v_fmac_f32 v175, v67, v84
v_mfma_f32_16x16x32_bf16 v[208:211], a[148:151], a[28:31], v[208:211]
v_mfma_f32_16x16x32_bf16 v[184:187], a[148:151], a[20:23], v[184:187]
v_fmac_f32 v134, v50, v82
v_fmac_f32 v199, v67, v86
v_mfma_f32_16x16x32_bf16 v[184:187], a[144:147], a[16:19], v[184:187]
buffer_load_dwordx4 v1, s[4:7], s44 offen offset:1024 sc1 lds
v_mfma_f32_16x16x32_bf16 v[160:163], a[144:147], a[8:11], v[160:163]
v_fmac_f32 v158, v50, v84
v_fmac_f32 v223, v67, v88
v_mfma_f32_16x16x32_bf16 v[160:163], a[148:151], a[12:15], v[160:163]
v_mfma_f32_16x16x32_bf16 v[136:139], a[148:151], a[4:7], v[136:139]
v_fmac_f32 v182, v50, v86
v_fmac_f32 v227, v71, v88
v_mfma_f32_16x16x32_bf16 v[136:139], a[144:147], a[0:3], v[136:139]
s_waitcnt vmcnt(10) lgkmcnt(0)
s_barrier
v_mfma_f32_16x16x32_bf16 v[140:143], a[96:99], a[32:35], v[140:143]
ds_read_b128 a[128:131], v5 offset:17408
v_fmac_f32 v206, v50, v88
v_mfma_f32_16x16x32_bf16 v[140:143], a[100:103], a[36:39], v[140:143]
buffer_load_dwordx4 a[0:3], v2, s[40:43], s35 offen offset:0 sc1
v_mfma_f32_16x16x32_bf16 v[164:167], a[100:103], a[44:47], v[164:167]
ds_read_b128 a[132:135], v5 offset:23552
v_fmac_f32 v210, v54, v88
v_mfma_f32_16x16x32_bf16 v[164:167], a[96:99], a[40:43], v[164:167]
v_fmac_f32 v203, v71, v86
v_fmac_f32 v179, v71, v84
v_mfma_f32_16x16x32_bf16 v[188:191], a[96:99], a[48:51], v[188:191]
buffer_load_dwordx4 a[4:7], v2, s[40:43], s33 offen offset:0 sc1
v_mfma_f32_16x16x32_bf16 v[188:191], a[100:103], a[52:55], v[188:191]
ds_read_b128 a[136:139], v5 offset:26624
v_fmac_f32 v186, v54, v86
v_mfma_f32_16x16x32_bf16 v[212:215], a[100:103], a[60:63], v[212:215]
v_fmac_f32 v162, v54, v84
v_fmac_f32 v155, v71, v82
v_mfma_f32_16x16x32_bf16 v[212:215], a[96:99], a[56:59], v[212:215]
buffer_load_dwordx4 a[8:11], v2, s[40:43], s35 offen offset:1024 sc1
v_mfma_f32_16x16x32_bf16 v[216:219], a[104:107], a[56:59], v[216:219]
ds_read_b128 a[140:143], v5 offset:32768
v_fmac_f32 v138, v54, v82
v_mfma_f32_16x16x32_bf16 v[216:219], a[108:111], a[60:63], v[216:219]
v_fmac_f32 v135, v51, v82
v_fmac_f32 v159, v51, v84
v_mfma_f32_16x16x32_bf16 v[192:195], a[108:111], a[52:55], v[192:195]
buffer_load_dwordx4 a[12:15], v2, s[40:43], s33 offen offset:1024 sc1
v_mfma_f32_16x16x32_bf16 v[192:195], a[104:107], a[48:51], v[192:195]
ds_read_b128 a[144:147], v5 offset:27648
v_fmac_f32 v183, v51, v86
v_mfma_f32_16x16x32_bf16 v[168:171], a[104:107], a[40:43], v[168:171]
v_fmac_f32 v207, v51, v88
v_mfma_f32_16x16x32_bf16 v[168:171], a[108:111], a[44:47], v[168:171]
buffer_load_dwordx4 a[16:19], v2, s[40:43], s35 offen offset:2048 sc1
v_mfma_f32_16x16x32_bf16 v[144:147], a[108:111], a[36:39], v[144:147]
ds_read_b128 a[148:151], v5 offset:33792
v_fmac_f32 v211, v55, v88
v_mfma_f32_16x16x32_bf16 v[144:147], a[104:107], a[32:35], v[144:147]
v_mul_f32 v88, 0x3e8293ee, v89
v_mfma_f32_16x16x32_bf16 v[148:151], a[112:115], a[32:35], v[148:151]
buffer_load_dwordx4 a[20:23], v2, s[40:43], s33 offen offset:2048 sc1
v_mfma_f32_16x16x32_bf16 v[148:151], a[116:119], a[36:39], v[148:151]
v_fmac_f32 v187, v55, v86
v_mfma_f32_16x16x32_bf16 v[172:175], a[116:119], a[44:47], v[172:175]
v_fmac_f32 v163, v55, v84
v_mul_f32 v86, 0x3e8293ee, v87
v_mfma_f32_16x16x32_bf16 v[172:175], a[112:115], a[40:43], v[172:175]
buffer_load_dwordx4 a[24:27], v2, s[40:43], s35 offen offset:3072 sc1
v_mfma_f32_16x16x32_bf16 v[196:199], a[112:115], a[48:51], v[196:199]
v_fmac_f32 v139, v55, v82
v_mul_f32 v84, 0x3e8293ee, v85
v_mfma_f32_16x16x32_bf16 v[196:199], a[116:119], a[52:55], v[196:199]
v_mul_f32 v82, 0x3e8293ee, v83
v_mfma_f32_16x16x32_bf16 v[220:223], a[116:119], a[60:63], v[220:223]
buffer_load_dwordx4 a[28:31], v2, s[40:43], s33 offen offset:3072 sc1
s_add_u32 s35, s35, 0x64000
v_mfma_f32_16x16x32_bf16 v[220:223], a[112:115], a[56:59], v[220:223]
s_add_u32 s33, s33, 0x64000
s_waitcnt lgkmcnt(0)
v_mfma_f32_16x16x32_bf16 v[224:227], a[128:131], a[56:59], v[224:227]
ds_read_b128 a[96:99], v5 offset:28672
v_mfma_f32_16x16x32_bf16 v[224:227], a[132:135], a[60:63], v[224:227]
buffer_load_dwordx4 v1, s[4:7], s44 offen offset:2048 sc1 lds
v_mfma_f32_16x16x32_bf16 v[200:203], a[132:135], a[52:55], v[200:203]
ds_read_b128 a[100:103], v5 offset:34816
v_mfma_f32_16x16x32_bf16 v[200:203], a[128:131], a[48:51], v[200:203]
v_mfma_f32_16x16x32_bf16 v[176:179], a[128:131], a[40:43], v[176:179]
v_mfma_f32_16x16x32_bf16 v[176:179], a[132:135], a[44:47], v[176:179]
ds_read_b128 a[104:107], v5 offset:29696
v_mfma_f32_16x16x32_bf16 v[152:155], a[132:135], a[36:39], v[152:155]
v_mfma_f32_16x16x32_bf16 v[152:155], a[128:131], a[32:35], v[152:155]
s_waitcnt vmcnt(18)
v_mfma_f32_16x16x32_bf16 v[140:143], a[136:139], a[64:67], v[140:143]
ds_read_b128 a[108:111], v5 offset:35840
s_waitcnt vmcnt(17)
v_mfma_f32_16x16x32_bf16 v[140:143], a[140:143], a[68:71], v[140:143]
s_waitcnt vmcnt(15)
v_mfma_f32_16x16x32_bf16 v[164:167], a[140:143], a[76:79], v[164:167]
ds_read_b128 a[112:115], v5 offset:38912
v_mfma_f32_16x16x32_bf16 v[164:167], a[136:139], a[72:75], v[164:167]
s_waitcnt vmcnt(14)
v_mfma_f32_16x16x32_bf16 v[188:191], a[136:139], a[80:83], v[188:191]
s_waitcnt vmcnt(13)
v_mfma_f32_16x16x32_bf16 v[188:191], a[140:143], a[84:87], v[188:191]
buffer_load_dwordx4 v1, s[4:7], s44 offen offset:3072 sc1 lds
s_add_u32 m0, s19, 65536
s_waitcnt vmcnt(11)
v_mfma_f32_16x16x32_bf16 v[212:215], a[140:143], a[92:95], v[212:215]
s_add_u32 s44, s84, 0xa08000
ds_read_b128 a[116:119], v5 offset:45056
v_mfma_f32_16x16x32_bf16 v[212:215], a[136:139], a[88:91], v[212:215]
v_mfma_f32_16x16x32_bf16 v[216:219], a[144:147], a[88:91], v[216:219]
v_mfma_f32_16x16x32_bf16 v[216:219], a[148:151], a[92:95], v[216:219]
v_mfma_f32_16x16x32_bf16 v[192:195], a[148:151], a[84:87], v[192:195]
v_mfma_f32_16x16x32_bf16 v[192:195], a[144:147], a[80:83], v[192:195]
v_mfma_f32_16x16x32_bf16 v[168:171], a[144:147], a[72:75], v[168:171]
v_mfma_f32_16x16x32_bf16 v[168:171], a[148:151], a[76:79], v[168:171]
v_mfma_f32_16x16x32_bf16 v[144:147], a[148:151], a[68:71], v[144:147]
v_mfma_f32_16x16x32_bf16 v[144:147], a[144:147], a[64:67], v[144:147]
s_waitcnt lgkmcnt(0)
v_mfma_f32_16x16x32_bf16 v[148:151], a[96:99], a[64:67], v[148:151]
ds_read_b128 a[128:131], v5 offset:39936
v_mfma_f32_16x16x32_bf16 v[148:151], a[100:103], a[68:71], v[148:151]
buffer_load_dwordx4 v1, s[4:7], s44 offen offset:0 sc1 lds
v_mfma_f32_16x16x32_bf16 v[172:175], a[100:103], a[76:79], v[172:175]
ds_read_b128 a[132:135], v5 offset:46080
v_mfma_f32_16x16x32_bf16 v[172:175], a[96:99], a[72:75], v[172:175]
v_mfma_f32_16x16x32_bf16 v[196:199], a[96:99], a[80:83], v[196:199]
v_mfma_f32_16x16x32_bf16 v[196:199], a[100:103], a[84:87], v[196:199]
buffer_load_dwordx4 v1, s[4:7], s44 offen offset:1024 sc1 lds
v_mfma_f32_16x16x32_bf16 v[220:223], a[100:103], a[92:95], v[220:223]
ds_read_b128 a[136:139], v5 offset:40960
v_mfma_f32_16x16x32_bf16 v[220:223], a[96:99], a[88:91], v[220:223]
v_mfma_f32_16x16x32_bf16 v[224:227], a[104:107], a[88:91], v[224:227]
ds_read_b128 a[140:143], v5 offset:47104
v_mfma_f32_16x16x32_bf16 v[224:227], a[108:111], a[92:95], v[224:227]
v_mfma_f32_16x16x32_bf16 v[200:203], a[108:111], a[84:87], v[200:203]
buffer_load_dwordx4 v1, s[4:7], s44 offen offset:2048 sc1 lds
v_mfma_f32_16x16x32_bf16 v[200:203], a[104:107], a[80:83], v[200:203]
ds_read_b128 a[144:147], v5 offset:41984
v_mfma_f32_16x16x32_bf16 v[176:179], a[104:107], a[72:75], v[176:179]
v_mfma_f32_16x16x32_bf16 v[176:179], a[108:111], a[76:79], v[176:179]
ds_read_b128 a[148:151], v5 offset:48128
v_mfma_f32_16x16x32_bf16 v[152:155], a[108:111], a[68:71], v[152:155]
v_mfma_f32_16x16x32_bf16 v[152:155], a[104:107], a[64:67], v[152:155]
buffer_load_dwordx4 v1, s[4:7], s44 offen offset:3072 sc1 lds
s_add_u32 m0, s19, 81920
s_waitcnt vmcnt(13)
v_mfma_f32_16x16x32_bf16 v[140:143], a[112:115], a[0:3], v[140:143]
s_add_u32 s44, s85, 0xa0c000
s_waitcnt vmcnt(12)
v_mfma_f32_16x16x32_bf16 v[140:143], a[116:119], a[4:7], v[140:143]
s_waitcnt vmcnt(10)
v_mfma_f32_16x16x32_bf16 v[164:167], a[116:119], a[12:15], v[164:167]
v_mfma_f32_16x16x32_bf16 v[164:167], a[112:115], a[8:11], v[164:167]
s_waitcnt vmcnt(9)
v_mfma_f32_16x16x32_bf16 v[188:191], a[112:115], a[16:19], v[188:191]
buffer_load_dwordx4 v1, s[4:7], s44 offen offset:0 sc1 lds
s_waitcnt vmcnt(9)
v_mfma_f32_16x16x32_bf16 v[188:191], a[116:119], a[20:23], v[188:191]
s_waitcnt vmcnt(7)
v_mfma_f32_16x16x32_bf16 v[212:215], a[116:119], a[28:31], v[212:215]
v_mfma_f32_16x16x32_bf16 v[212:215], a[112:115], a[24:27], v[212:215]
s_waitcnt lgkmcnt(0)
v_mfma_f32_16x16x32_bf16 v[216:219], a[128:131], a[24:27], v[216:219]
ds_read_b128 a[96:99], v5 offset:12288
v_mul_f32 v140, v140, v83
v_mfma_f32_16x16x32_bf16 v[216:219], a[132:135], a[28:31], v[216:219]
buffer_load_dwordx4 v1, s[4:7], s44 offen offset:1024 sc1 lds
v_mfma_f32_16x16x32_bf16 v[192:195], a[132:135], a[20:23], v[192:195]
ds_read_b128 a[100:103], v5 offset:18432
v_mul_f32 v141, v141, v83
v_mfma_f32_16x16x32_bf16 v[192:195], a[128:131], a[16:19], v[192:195]
v_cvt_pk_bf16_f32 v140, v140, v141
v_mul_f32 v164, v164, v85
v_mfma_f32_16x16x32_bf16 v[168:171], a[128:131], a[8:11], v[168:171]
v_mul_f32 v165, v165, v85
v_cvt_pk_bf16_f32 v164, v164, v165
v_mfma_f32_16x16x32_bf16 v[168:171], a[132:135], a[12:15], v[168:171]
buffer_load_dwordx4 v1, s[4:7], s44 offen offset:2048 sc1 lds
v_mfma_f32_16x16x32_bf16 v[144:147], a[132:135], a[4:7], v[144:147]
ds_read_b128 a[104:107], v5 offset:24576
v_mul_f32 v212, v212, v89
v_mfma_f32_16x16x32_bf16 v[144:147], a[128:131], a[0:3], v[144:147]
v_mul_f32 v213, v213, v89
v_mul_f32 v214, v214, v89
v_mfma_f32_16x16x32_bf16 v[148:151], a[136:139], a[0:3], v[148:151]
ds_read_b128 a[108:111], v5 offset:30720
v_mul_f32 v215, v215, v89
v_mfma_f32_16x16x32_bf16 v[148:151], a[140:143], a[4:7], v[148:151]
v_cvt_pk_bf16_f32 v212, v212, v213
v_mul_f32 v216, v216, v89
v_mfma_f32_16x16x32_bf16 v[172:175], a[140:143], a[12:15], v[172:175]
buffer_load_dwordx4 v1, s[4:7], s44 offen offset:3072 sc1 lds
s_add_u32 m0, s19, 147456
v_mfma_f32_16x16x32_bf16 v[172:175], a[136:139], a[8:11], v[172:175]
s_add_u32 s44, s87, 0xa1c000
ds_read_b128 a[112:115], v5 offset:36864
v_mfma_f32_16x16x32_bf16 v[196:199], a[136:139], a[16:19], v[196:199]
v_mul_f32 v217, v217, v89
v_mul_f32 v218, v218, v89
v_mfma_f32_16x16x32_bf16 v[196:199], a[140:143], a[20:23], v[196:199]
ds_read_b128 a[116:119], v5 offset:43008
v_mul_f32 v219, v219, v89
v_mfma_f32_16x16x32_bf16 v[220:223], a[140:143], a[28:31], v[220:223]
v_cvt_pk_bf16_f32 v213, v214, v215
v_cvt_pk_bf16_f32 v214, v216, v217
v_mfma_f32_16x16x32_bf16 v[220:223], a[136:139], a[24:27], v[220:223]
buffer_load_dwordx4 v1, s[4:7], s44 offen offset:0 sc1 lds
v_mfma_f32_16x16x32_bf16 v[224:227], a[144:147], a[24:27], v[224:227]
v_cvt_pk_bf16_f32 v215, v218, v219
v_min_u32 v212, -2, v212
v_mfma_f32_16x16x32_bf16 v[224:227], a[148:151], a[28:31], v[224:227]
v_min_u32 v213, -2, v213
v_min_u32 v214, -2, v214
v_mfma_f32_16x16x32_bf16 v[200:203], a[148:151], a[20:23], v[200:203]
v_min_u32 v215, -2, v215
v_mul_f32 v172, v172, v85
v_mfma_f32_16x16x32_bf16 v[200:203], a[144:147], a[16:19], v[200:203]
buffer_store_dwordx4 v[212:215], v3, s[4:7], s63 offen offset:0 sc1
v_mfma_f32_16x16x32_bf16 v[176:179], a[144:147], a[8:11], v[176:179]
buffer_load_dwordx4 v1, s[4:7], s44 offen offset:1024 sc1 lds
v_mfma_f32_16x16x32_bf16 v[176:179], a[148:151], a[12:15], v[176:179]
v_mul_f32 v173, v173, v85
v_cvt_pk_bf16_f32 v172, v172, v173
v_mfma_f32_16x16x32_bf16 v[152:155], a[148:151], a[4:7], v[152:155]
v_mul_f32 v220, v220, v89
v_mul_f32 v221, v221, v89
v_mfma_f32_16x16x32_bf16 v[152:155], a[144:147], a[0:3], v[152:155]
v_mul_f32 v222, v222, v89
s_waitcnt lgkmcnt(0)
v_mfma_f32_16x16x32_bf16 v[132:135], a[96:99], a[32:35], v[132:135]
ds_read_b128 a[128:131], v5 offset:13312
v_mul_f32 v223, v223, v89
v_mfma_f32_16x16x32_bf16 v[132:135], a[100:103], a[36:39], v[132:135]
buffer_load_dwordx4 v1, s[4:7], s44 offen offset:2048 sc1 lds
v_mfma_f32_16x16x32_bf16 v[156:159], a[100:103], a[44:47], v[156:159]
ds_read_b128 a[132:135], v5 offset:19456
v_cvt_pk_bf16_f32 v220, v220, v221
v_mfma_f32_16x16x32_bf16 v[156:159], a[96:99], a[40:43], v[156:159]
v_mul_f32 v224, v224, v89
v_mul_f32 v225, v225, v89
v_mfma_f32_16x16x32_bf16 v[180:183], a[96:99], a[48:51], v[180:183]
v_mul_f32 v226, v226, v89
v_mul_f32 v227, v227, v89
v_mfma_f32_16x16x32_bf16 v[180:183], a[100:103], a[52:55], v[180:183]
buffer_load_dwordx4 v1, s[4:7], s44 offen offset:3072 sc1 lds
s_add_u32 m0, s19, 98304
v_mfma_f32_16x16x32_bf16 v[204:207], a[100:103], a[60:63], v[204:207]
s_add_u32 s44, s84, 0xa10000
ds_read_b128 a[136:139], v5 offset:25600
v_mfma_f32_16x16x32_bf16 v[204:207], a[96:99], a[56:59], v[204:207]
v_cvt_pk_bf16_f32 v221, v222, v223
v_cvt_pk_bf16_f32 v222, v224, v225
v_mfma_f32_16x16x32_bf16 v[204:207], a[104:107], a[88:91], v[204:207]
ds_read_b128 a[140:143], v5 offset:31744
v_cvt_pk_bf16_f32 v223, v226, v227
v_mfma_f32_16x16x32_bf16 v[204:207], a[108:111], a[92:95], v[204:207]
v_min_u32 v220, -2, v220
v_min_u32 v221, -2, v221
v_mfma_f32_16x16x32_bf16 v[180:183], a[108:111], a[84:87], v[180:183]
buffer_load_dwordx4 v1, s[4:7], s44 offen offset:0 sc1 lds
v_mfma_f32_16x16x32_bf16 v[180:183], a[104:107], a[80:83], v[180:183]
ds_read_b128 a[144:147], v5 offset:37888
v_min_u32 v222, -2, v222
v_mfma_f32_16x16x32_bf16 v[156:159], a[104:107], a[72:75], v[156:159]
v_min_u32 v223, -2, v223
v_mul_f32 v196, v196, v87
v_mfma_f32_16x16x32_bf16 v[156:159], a[108:111], a[76:79], v[156:159]
ds_read_b128 a[148:151], v5 offset:44032
v_mul_f32 v197, v197, v87
v_mfma_f32_16x16x32_bf16 v[132:135], a[108:111], a[68:71], v[132:135]
buffer_store_dwordx4 v[220:223], v3, s[4:7], s63 offen offset:1024 sc1
v_mfma_f32_16x16x32_bf16 v[132:135], a[104:107], a[64:67], v[132:135]
buffer_load_dwordx4 v1, s[4:7], s44 offen offset:1024 sc1 lds
v_mfma_f32_16x16x32_bf16 v[132:135], a[112:115], a[0:3], v[132:135]
v_cvt_pk_bf16_f32 v196, v196, v197
v_mul_f32 v198, v198, v87
v_mfma_f32_16x16x32_bf16 v[132:135], a[116:119], a[4:7], v[132:135]
v_mul_f32 v199, v199, v87
v_cvt_pk_bf16_f32 v197, v198, v199
v_mfma_f32_16x16x32_bf16 v[156:159], a[116:119], a[12:15], v[156:159]
v_mul_f32 v200, v200, v87
v_mul_f32 v201, v201, v87
v_mfma_f32_16x16x32_bf16 v[156:159], a[112:115], a[8:11], v[156:159]
v_cvt_pk_bf16_f32 v198, v200, v201
v_mul_f32 v202, v202, v87
v_mfma_f32_16x16x32_bf16 v[180:183], a[112:115], a[16:19], v[180:183]
buffer_load_dwordx4 v1, s[4:7], s44 offen offset:2048 sc1 lds
v_mfma_f32_16x16x32_bf16 v[180:183], a[116:119], a[20:23], v[180:183]
v_mul_f32 v203, v203, v87
v_cvt_pk_bf16_f32 v199, v202, v203
v_mfma_f32_16x16x32_bf16 v[204:207], a[116:119], a[28:31], v[204:207]
v_mul_f32 v174, v174, v85
v_mul_f32 v175, v175, v85
v_mfma_f32_16x16x32_bf16 v[204:207], a[112:115], a[24:27], v[204:207]
s_waitcnt lgkmcnt(0)
s_barrier
v_mfma_f32_16x16x32_bf16 v[208:211], a[128:131], a[56:59], v[208:211]
ds_write_b128 v233, v[212:215] offset:21504
v_cvt_pk_bf16_f32 v173, v174, v175
v_mfma_f32_16x16x32_bf16 v[208:211], a[132:135], a[60:63], v[208:211]
buffer_load_dwordx4 v1, s[4:7], s44 offen offset:3072 sc1 lds
s_add_u32 m0, s19, 114688
v_mfma_f32_16x16x32_bf16 v[184:187], a[132:135], a[52:55], v[184:187]
s_add_u32 s44, s85, 0xa14000
ds_write_b64 v232, v[220:221] offset:4096
v_mfma_f32_16x16x32_bf16 v[184:187], a[128:131], a[48:51], v[184:187]
ds_write_b64 v232, v[222:223] offset:4608
v_cvt_pk_bf16_f32 v132, v132, v133
v_mfma_f32_16x16x32_bf16 v[160:163], a[128:131], a[40:43], v[160:163]
ds_write_b64 v232, v[196:197] offset:3072
v_cvt_pk_bf16_f32 v156, v156, v157
v_mfma_f32_16x16x32_bf16 v[160:163], a[132:135], a[44:47], v[160:163]
buffer_load_dwordx4 v1, s[4:7], s44 offen offset:0 sc1 lds
v_mfma_f32_16x16x32_bf16 v[136:139], a[132:135], a[36:39], v[136:139]
ds_write_b64 v232, v[198:199] offset:3584
v_cvt_pk_bf16_f32 v180, v180, v181
v_mfma_f32_16x16x32_bf16 v[136:139], a[128:131], a[32:35], v[136:139]
ds_write_b64 v232, v[172:173] offset:2048
v_cvt_pk_bf16_f32 v204, v204, v205
v_mfma_f32_16x16x32_bf16 v[136:139], a[136:139], a[64:67], v[136:139]
v_cvt_pk_bf16_f32 v133, v134, v135
v_cvt_pk_bf16_f32 v157, v158, v159
v_mfma_f32_16x16x32_bf16 v[136:139], a[140:143], a[68:71], v[136:139]
v_cvt_pk_bf16_f32 v181, v182, v183
v_cvt_pk_bf16_f32 v205, v206, v207
v_mfma_f32_16x16x32_bf16 v[160:163], a[140:143], a[76:79], v[160:163]
buffer_load_dwordx4 v1, s[4:7], s44 offen offset:1024 sc1 lds
v_mfma_f32_16x16x32_bf16 v[160:163], a[136:139], a[72:75], v[160:163]
v_mul_f32 v176, v176, v85
v_mul_f32 v177, v177, v85
v_mfma_f32_16x16x32_bf16 v[184:187], a[136:139], a[80:83], v[184:187]
v_cvt_pk_bf16_f32 v174, v176, v177
v_mul_f32 v178, v178, v85
v_mfma_f32_16x16x32_bf16 v[184:187], a[140:143], a[84:87], v[184:187]
v_mul_f32 v179, v179, v85
v_cvt_pk_bf16_f32 v175, v178, v179
v_mfma_f32_16x16x32_bf16 v[208:211], a[140:143], a[92:95], v[208:211]
ds_write_b64 v232, v[174:175] offset:2560
v_mul_f32 v148, v148, v83
v_mfma_f32_16x16x32_bf16 v[208:211], a[136:139], a[88:91], v[208:211]
buffer_load_dwordx4 v1, s[4:7], s44 offen offset:2048 sc1 lds
v_mfma_f32_16x16x32_bf16 v[208:211], a[144:147], a[24:27], v[208:211]
v_mul_f32 v149, v149, v83
v_cvt_pk_bf16_f32 v148, v148, v149
v_mfma_f32_16x16x32_bf16 v[208:211], a[148:151], a[28:31], v[208:211]
v_mul_f32 v150, v150, v83
v_mul_f32 v151, v151, v83
v_mfma_f32_16x16x32_bf16 v[184:187], a[148:151], a[20:23], v[184:187]
v_cvt_pk_bf16_f32 v149, v150, v151
v_mul_f32 v152, v152, v83
v_mfma_f32_16x16x32_bf16 v[184:187], a[144:147], a[16:19], v[184:187]
ds_write_b64 v232, v[148:149] offset:1024
v_mul_f32 v153, v153, v83
v_mfma_f32_16x16x32_bf16 v[160:163], a[144:147], a[8:11], v[160:163]
buffer_load_dwordx4 v1, s[4:7], s44 offen offset:3072 sc1 lds
v_mfma_f32_16x16x32_bf16 v[160:163], a[148:151], a[12:15], v[160:163]
v_cvt_pk_bf16_f32 v150, v152, v153
v_mul_f32 v154, v154, v83
v_mfma_f32_16x16x32_bf16 v[136:139], a[148:151], a[4:7], v[136:139]
v_mul_f32 v155, v155, v83
v_cvt_pk_bf16_f32 v151, v154, v155
v_mfma_f32_16x16x32_bf16 v[136:139], a[144:147], a[0:3], v[136:139]
ds_write_b64 v232, v[150:151] offset:1536
v_mul_f32 v188, v188, v87
s_add_u32 m0, s19, 32768
buffer_load_dwordx4 v[228:231], v9, s[4:7], s55 offen sc1
buffer_load_dwordx4 v[72:75], v9, s[4:7], s55 offen offset:1024 sc1
s_add_u32 s44, s84, 0xa00000
buffer_load_dwordx4 v1, s[4:7], s44 offen offset:0 sc1 lds
v_mul_f32 v189, v189, v87
v_pk_mul_f32 v[190:191], v[190:191], v[86:87] op_sel:[0,1] op_sel_hi:[1,1]
v_pk_mul_f32 v[166:167], v[166:167], v[84:85] op_sel:[0,1] op_sel_hi:[1,1]
v_pk_mul_f32 v[142:143], v[142:143], v[82:83] op_sel:[0,1] op_sel_hi:[1,1]
v_cvt_pk_bf16_f32 v188, v188, v189
v_pk_mul_f32 v[192:193], v[192:193], v[86:87] op_sel:[0,1] op_sel_hi:[1,1]
v_pk_mul_f32 v[194:195], v[194:195], v[86:87] op_sel:[0,1] op_sel_hi:[1,1]
v_pk_mul_f32 v[168:169], v[168:169], v[84:85] op_sel:[0,1] op_sel_hi:[1,1]
v_pk_mul_f32 v[170:171], v[170:171], v[84:85] op_sel:[0,1] op_sel_hi:[1,1]
v_pk_mul_f32 v[144:145], v[144:145], v[82:83] op_sel:[0,1] op_sel_hi:[1,1]
v_pk_mul_f32 v[146:147], v[146:147], v[82:83] op_sel:[0,1] op_sel_hi:[1,1]
v_cvt_pk_bf16_f32 v189, v190, v191
v_cvt_pk_bf16_f32 v165, v166, v167
v_cvt_pk_bf16_f32 v141, v142, v143
v_cvt_pk_bf16_f32 v190, v192, v193
v_cvt_pk_bf16_f32 v191, v194, v195
v_cvt_pk_bf16_f32 v166, v168, v169
v_cvt_pk_bf16_f32 v167, v170, v171
v_cvt_pk_bf16_f32 v142, v144, v145
v_cvt_pk_bf16_f32 v143, v146, v147
v_cvt_pk_bf16_f32 v134, v136, v137
v_cvt_pk_bf16_f32 v135, v138, v139
v_cvt_pk_bf16_f32 v158, v160, v161
v_cvt_pk_bf16_f32 v159, v162, v163
v_cvt_pk_bf16_f32 v182, v184, v185
v_cvt_pk_bf16_f32 v183, v186, v187
v_cvt_pk_bf16_f32 v206, v208, v209
buffer_load_dwordx4 v1, s[4:7], s44 offen offset:1024 sc1 lds
v_cvt_pk_bf16_f32 v207, v210, v211
buffer_load_dwordx4 v1, s[4:7], s44 offen offset:2048 sc1 lds
buffer_load_dwordx4 v1, s[4:7], s44 offen offset:3072 sc1 lds
s_waitcnt lgkmcnt(0)
s_barrier
s_add_u32 m0, s19, 131072
s_add_u32 s44, s86, 0xa18000
buffer_load_dwordx4 v1, s[4:7], s44 offen offset:0 sc1 lds
v_mfma_f32_16x16x32_bf16 v[208:211], v[188:191], v[204:207], v[20:23]
ds_read_b64_tr_b16 a[10:11], v248 offset:3072
v_mfma_f32_16x16x32_bf16 v[224:227], v[212:215], v[204:207], v[24:27]
ds_read_b64_tr_b16 a[12:13], v248 offset:4096
v_mfma_f32_16x16x32_bf16 v[160:163], v[140:143], v[156:159], v[20:23]
ds_read_b64_tr_b16 a[22:23], v248 offset:3584
v_mfma_f32_16x16x32_bf16 v[176:179], v[164:167], v[156:159], v[24:27]
s_nop 3
v_max_f32 v224, v224, v208
v_max_f32 v225, v225, v209
v_max_f32 v226, v226, v210
v_max_f32 v227, v227, v211
v_max3_f32 v239, v224, v225, v226
v_max_f32 v239, v239, v227
ds_read_b64_tr_b16 a[24:25], v248 offset:4608
v_max_f32 v176, v176, v160
v_max_f32 v177, v177, v161
v_max_f32 v178, v178, v162
v_max_f32 v179, v179, v163
v_max3_f32 v237, v176, v177, v178
buffer_load_dwordx4 v1, s[4:7], s44 offen offset:1024 sc1 lds
v_max_f32 v237, v237, v179
v_mfma_f32_16x16x32_bf16 v[184:187], v[164:167], v[180:183], v[20:23]
s_nop 0
v_permlane32_swap_b32 v239, v237
v_max_f32 v239, v239, v237
v_mov_b32 v242, v239
v_mfma_f32_16x16x32_bf16 v[200:203], v[188:191], v[180:183], v[24:27]
s_nop 0
v_permlane16_swap_b32 v239, v242
v_max_f32 v239, v239, v242
v_mov_b32 v242, v239
ds_read_b64_tr_b16 a[6:7], v248 offset:1024
s_nop 0
v_permlane32_swap_b32 v239, v242
v_mul_f32_e64 v89, -v239, v88
v_fma_f32 v224, v224, v88, v89
v_fma_f32 v225, v225, v88, v89
v_fma_f32 v226, v226, v88, v89
v_fma_f32 v227, v227, v88, v89
v_exp_f32 v224, v224
v_exp_f32 v225, v225
v_exp_f32 v226, v226
buffer_load_dwordx4 v1, s[4:7], s44 offen offset:2048 sc1 lds
v_exp_f32 v227, v227
v_cvt_pk_bf16_f32 v224, v224, v225
v_cvt_pk_bf16_f32 v225, v226, v227
v_and_b32 v208, v224, v28
v_and_b32 v209, v225, v29
v_and_b32 v210, v224, v30
v_and_b32 v211, v225, v31
v_max_f32 v200, v200, v184
v_max_f32 v201, v201, v185
v_mfma_f32_16x16x32_bf16 v[216:219], v[16:19], v[208:211], 0
v_max_f32 v202, v202, v186
v_max_f32 v203, v203, v187
s_waitcnt lgkmcnt(3)
v_mfma_f32_16x16x32_bf16 v[116:119], a[10:13], v[208:211], 0
v_max3_f32 v238, v200, v201, v202
ds_read_b64_tr_b16 a[18:19], v248 offset:1536
s_waitcnt lgkmcnt(2)
v_mfma_f32_16x16x32_bf16 v[120:123], a[22:25], v[208:211], 0
v_rcp_f32 v216, v216
ds_read_b64_tr_b16 a[8:9], v248 offset:2048
ds_read_b64_tr_b16 a[20:21], v248 offset:2560
buffer_load_dwordx4 v1, s[4:7], s44 offen offset:3072 sc1 lds
v_pk_mul_f32 v[116:117], v[116:117], v[216:217] op_sel:[0,0] op_sel_hi:[1,0]
v_pk_mul_f32 v[118:119], v[118:119], v[216:217] op_sel:[0,0] op_sel_hi:[1,0]
v_cvt_pk_bf16_f32 v116, v116, v117
s_nop 0
v_pk_mul_f32 v[120:121], v[120:121], v[216:217] op_sel:[0,0] op_sel_hi:[1,0]
v_pk_mul_f32 v[122:123], v[122:123], v[216:217] op_sel:[0,0] op_sel_hi:[1,0]
v_cvt_pk_bf16_f32 v117, v118, v119
v_cvt_pk_bf16_f32 v118, v120, v121
v_cvt_pk_bf16_f32 v119, v122, v123
v_max_f32 v238, v238, v203
buffer_store_dwordx4 v[116:119], v2, s[4:7], s72 offen offset:3072 sc1
s_waitcnt lgkmcnt(0)
s_cmp_lg_u32 s28, 0
s_cbranch_scc1 Lhx_35
s_waitcnt vmcnt(10)
v_max3_u32 v244, v228, v229, v230
s_waitcnt vmcnt(9)
v_max3_u32 v244, v244, v231, v72
v_max3_u32 v244, v244, v73, v74
v_max_u32 v244, v244, v75
v_cmp_eq_u32 vcc, -1, v244
s_cbranch_vccnz L_hxredo2
L_hxback2:
ds_write_b128 v233, v[228:231] offset:20480
ds_write_b64 v232, v[72:73] offset:0
ds_write_b64 v232, v[74:75] offset:512
Lhx_35:
ds_read_b128 a[0:3], v233 offset:20480
v_mfma_f32_16x16x32_bf16 v[152:155], v[140:143], v[132:135], v[24:27]
v_mul_f32_e64 v85, -v242, v84
v_fma_f32 v176, v176, v84, v85
v_fma_f32 v177, v177, v84, v85
v_fma_f32 v178, v178, v84, v85
v_fma_f32 v179, v179, v84, v85
v_exp_f32 v176, v176
v_exp_f32 v177, v177
v_exp_f32 v178, v178
v_exp_f32 v179, v179
v_cvt_pk_bf16_f32 v176, v176, v177
v_cvt_pk_bf16_f32 v177, v178, v179
v_and_b32 v160, v176, v28
v_and_b32 v161, v177, v29
v_and_b32 v162, v176, v30
v_and_b32 v163, v177, v31
ds_read_b64_tr_b16 a[4:5], v248 offset:0
s_nop 0
v_mfma_f32_16x16x32_bf16 v[168:171], v[16:19], v[160:163], 0
ds_read_b64_tr_b16 a[16:17], v248 offset:512
v_mfma_f32_16x16x32_bf16 v[100:103], a[6:9], v[160:163], 0
s_waitcnt lgkmcnt(2)
v_mfma_f32_16x16x32_bf16 v[136:139], a[0:3], v[132:135], v[76:79]
s_nop 3
v_rcp_f32 v168, v168
v_mfma_f32_16x16x32_bf16 v[104:107], a[18:21], v[160:163], 0
L_stub13:
s_cbranch_execz L_wret4
s_nop 1
v_max_f32 v152, v152, v136
v_max_f32 v153, v153, v137
v_max_f32 v154, v154, v138
v_max_f32 v155, v155, v139
v_max3_f32 v236, v152, v153, v154
v_max_f32 v236, v236, v155
v_pk_mul_f32 v[100:101], v[100:101], v[168:169] op_sel:[0,0] op_sel_hi:[1,0]
v_pk_mul_f32 v[102:103], v[102:103], v[168:169] op_sel:[0,0] op_sel_hi:[1,0]
v_permlane32_swap_b32 v238, v236
v_max_f32 v238, v238, v236
v_mov_b32 v243, v238
v_cvt_pk_bf16_f32 v100, v100, v101
v_pk_mul_f32 v[104:105], v[104:105], v[168:169] op_sel:[0,0] op_sel_hi:[1,0]
v_permlane16_swap_b32 v238, v243
v_max_f32 v238, v238, v243
v_mov_b32 v243, v238
v_pk_mul_f32 v[106:107], v[106:107], v[168:169] op_sel:[0,0] op_sel_hi:[1,0]
v_cvt_pk_bf16_f32 v101, v102, v103
v_permlane32_swap_b32 v238, v243
v_mul_f32_e64 v87, -v238, v86
v_fma_f32 v200, v200, v86, v87
v_fma_f32 v201, v201, v86, v87
v_fma_f32 v202, v202, v86, v87
v_fma_f32 v203, v203, v86, v87
v_exp_f32 v200, v200
v_exp_f32 v201, v201
v_exp_f32 v202, v202
v_exp_f32 v203, v203
v_cvt_pk_bf16_f32 v200, v200, v201
v_cvt_pk_bf16_f32 v201, v202, v203
v_and_b32 v184, v200, v28
v_and_b32 v185, v201, v29
v_and_b32 v186, v200, v30
v_and_b32 v187, v201, v31
v_cvt_pk_bf16_f32 v102, v104, v105
v_cvt_pk_bf16_f32 v103, v106, v107
v_mfma_f32_16x16x32_bf16 v[192:195], v[16:19], v[184:187], 0
buffer_store_dwordx4 v[100:103], v2, s[4:7], s72 offen offset:1024 sc1
v_mul_f32_e64 v83, -v243, v82
v_mfma_f32_16x16x32_bf16 v[108:111], a[8:11], v[184:187], 0
v_fma_f32 v152, v152, v82, v83
v_fma_f32 v153, v153, v82, v83
v_fma_f32 v154, v154, v82, v83
v_fma_f32 v155, v155, v82, v83
v_mfma_f32_16x16x32_bf16 v[112:115], a[20:23], v[184:187], 0
v_exp_f32 v152, v152
v_exp_f32 v153, v153
v_exp_f32 v154, v154
v_exp_f32 v155, v155
v_rcp_f32 v192, v192
v_cvt_pk_bf16_f32 v152, v152, v153
v_cvt_pk_bf16_f32 v153, v154, v155
v_and_b32 v136, v152, v80
v_and_b32 v137, v153, v81
v_and_b32 v138, v152, v30
v_and_b32 v139, v153, v31
buffer_atomic_add v12, v10, s[4:7], s94 offen sc1
v_pk_mul_f32 v[108:109], v[108:109], v[192:193] op_sel:[0,0] op_sel_hi:[1,0]
v_pk_mul_f32 v[110:111], v[110:111], v[192:193] op_sel:[0,0] op_sel_hi:[1,0]
v_cvt_pk_bf16_f32 v108, v108, v109
v_pk_mul_f32 v[112:113], v[112:113], v[192:193] op_sel:[0,0] op_sel_hi:[1,0]
v_cvt_pk_bf16_f32 v109, v110, v111
v_pk_mul_f32 v[114:115], v[114:115], v[192:193] op_sel:[0,0] op_sel_hi:[1,0]
v_cvt_pk_bf16_f32 v110, v112, v113
v_mfma_f32_16x16x32_bf16 v[144:147], v[16:19], v[136:139], 0
v_cvt_pk_bf16_f32 v111, v114, v115
buffer_store_dwordx4 v[108:111], v2, s[4:7], s72 offen offset:2048 sc1
s_waitcnt lgkmcnt(1)
v_mfma_f32_16x16x32_bf16 v[92:95], a[4:7], v[136:139], 0
s_nop 3
v_rcp_f32 v144, v144
s_waitcnt lgkmcnt(0)
v_mfma_f32_16x16x32_bf16 v[96:99], a[16:19], v[136:139], 0
s_nop 0
v_pk_mul_f32 v[92:93], v[92:93], v[144:145] op_sel:[0,0] op_sel_hi:[1,0]
v_pk_mul_f32 v[94:95], v[94:95], v[144:145] op_sel:[0,0] op_sel_hi:[1,0]
v_cvt_pk_bf16_f32 v92, v92, v93
v_cvt_pk_bf16_f32 v93, v94, v95
s_nop 2
v_pk_mul_f32 v[96:97], v[96:97], v[144:145] op_sel:[0,0] op_sel_hi:[1,0]
v_pk_mul_f32 v[98:99], v[98:99], v[144:145] op_sel:[0,0] op_sel_hi:[1,0]
v_cvt_pk_bf16_f32 v94, v96, v97
v_cvt_pk_bf16_f32 v95, v98, v99
buffer_store_dwordx4 v[92:95], v2, s[4:7], s72 offen offset:0 sc1
s_add_u32 s92, s71, 0x20000
s_add_u32 s40, s4, 0x2400000
s_addc_u32 s41, s5, 0
v_add_u32 v5, 32768, v1
v_add_u32 v6, 98304, v1
s_mov_b32 s35, 0
v_lshlrev_b32 v132, 16, v32
v_and_b32 v133, 0xffff0000, v32
v_lshlrev_b32 v134, 16, v33
v_and_b32 v135, 0xffff0000, v33
v_lshlrev_b32 v136, 16, v34
v_and_b32 v137, 0xffff0000, v34
v_lshlrev_b32 v138, 16, v35
v_and_b32 v139, 0xffff0000, v35
v_lshlrev_b32 v140, 16, v36
v_and_b32 v141, 0xffff0000, v36
v_lshlrev_b32 v142, 16, v37
v_and_b32 v143, 0xffff0000, v37
v_lshlrev_b32 v144, 16, v38
v_and_b32 v145, 0xffff0000, v38
v_lshlrev_b32 v146, 16, v39
v_and_b32 v147, 0xffff0000, v39
v_lshlrev_b32 v148, 16, v40
v_and_b32 v149, 0xffff0000, v40
v_lshlrev_b32 v150, 16, v41
v_and_b32 v151, 0xffff0000, v41
v_lshlrev_b32 v152, 16, v42
v_and_b32 v153, 0xffff0000, v42
v_lshlrev_b32 v154, 16, v43
v_and_b32 v155, 0xffff0000, v43
v_lshlrev_b32 v156, 16, v44
v_and_b32 v157, 0xffff0000, v44
v_lshlrev_b32 v158, 16, v45
v_and_b32 v159, 0xffff0000, v45
v_lshlrev_b32 v160, 16, v46
v_and_b32 v161, 0xffff0000, v46
v_lshlrev_b32 v162, 16, v47
v_and_b32 v163, 0xffff0000, v47
s_mov_b32 s95, -1
s_mov_b64 exec, 0
s_cmp_eq_u32 s28, 3
s_cbranch_scc1 L_stub14
s_cmp_eq_u32 s28, 2
s_cbranch_scc1 L_wret5
L_wret5:
s_mov_b64 exec, -1
s_cmp_lg_u32 s28, 1
s_cbranch_scc1 Lpo_38
s_add_u32 s36, s11, 0x20080
s_mov_b32 s37, 0
v_mov_b32 v11, 0
buffer_atomic_add v11, v251, s[4:7], s36 offen sc0 sc1
s_sleep 4
Lpoll_36:
v_mov_b32 v234, 0
buffer_atomic_add v234, v251, s[4:7], s36 offen sc0 sc1
s_waitcnt vmcnt(1)
v_readfirstlane_b32 s38, v11
s_nop 0
s_cmp_ge_u32 s38, 32
s_cbranch_scc1 Lpe_37
v_mov_b32 v11, 0
buffer_atomic_add v11, v251, s[4:7], s36 offen sc0 sc1
s_waitcnt vmcnt(1)
v_readfirstlane_b32 s38, v234
s_nop 0
s_cmp_ge_u32 s38, 32
s_cbranch_scc1 Lpe_37
s_add_u32 s37, s37, 1
s_cmp_lt_u32 s37, 0x80000
s_cbranch_scc1 Lpoll_36
s_waitcnt vmcnt(0)
Lpo_38:
s_waitcnt vmcnt(0)
Lpe_37:
s_barrier
L_k2go2:
buffer_load_dwordx4 a[0:3], v4, s[40:43], s35 offen offset:0 sc1
buffer_load_dwordx4 a[4:7], v4, s[40:43], s35 offen offset:1024 sc1
s_mov_b32 s35, 4096
buffer_load_dwordx4 a[8:11], v4, s[40:43], s35 offen offset:0 sc1
buffer_load_dwordx4 a[12:15], v4, s[40:43], s35 offen offset:1024 sc1
s_mov_b32 s35, 16384
buffer_load_dwordx4 a[16:19], v4, s[40:43], s35 offen offset:0 sc1
buffer_load_dwordx4 a[20:23], v4, s[40:43], s35 offen offset:1024 sc1
s_mov_b32 s35, 20480
buffer_load_dwordx4 a[24:27], v4, s[40:43], s35 offen offset:0 sc1
buffer_load_dwordx4 a[28:31], v4, s[40:43], s35 offen offset:1024 sc1
s_mov_b32 s35, 32768
buffer_load_dwordx4 a[32:35], v4, s[40:43], s35 offen offset:0 sc1
buffer_load_dwordx4 a[36:39], v4, s[40:43], s35 offen offset:1024 sc1
s_mov_b32 s35, 36864
buffer_load_dwordx4 a[40:43], v4, s[40:43], s35 offen offset:0 sc1
buffer_load_dwordx4 a[44:47], v4, s[40:43], s35 offen offset:1024 sc1
s_mov_b32 s35, 49152
ds_read_b128 a[96:99], v5 offset:0
ds_read_b128 a[100:103], v5 offset:1024
ds_read_b128 a[104:107], v5 offset:2048
ds_read_b128 a[108:111], v5 offset:3072
ds_read_b128 a[112:115], v5 offset:4096
ds_read_b128 a[116:119], v5 offset:5120
ds_read_b128 a[120:123], v5 offset:6144
ds_read_b128 a[124:127], v5 offset:7168
s_waitcnt vmcnt(10) lgkmcnt(4)
v_mfma_f32_16x16x32_bf16 v[132:135], a[96:99], a[0:3], v[132:135]
ds_read_b128 a[128:131], v5 offset:8192
v_mfma_f32_16x16x32_bf16 v[148:151], a[96:99], a[4:7], v[148:151]
ds_read_b128 a[132:135], v5 offset:9216
v_mfma_f32_16x16x32_bf16 v[152:155], a[100:103], a[4:7], v[152:155]
buffer_load_dwordx4 a[48:51], v4, s[40:43], s35 offen offset:0 sc1
v_mfma_f32_16x16x32_bf16 v[136:139], a[100:103], a[0:3], v[136:139]
ds_read_b128 a[136:139], v5 offset:10240
v_mfma_f32_16x16x32_bf16 v[140:143], a[104:107], a[0:3], v[140:143]
ds_read_b128 a[140:143], v5 offset:11264
v_mfma_f32_16x16x32_bf16 v[156:159], a[104:107], a[4:7], v[156:159]
v_mfma_f32_16x16x32_bf16 v[160:163], a[108:111], a[4:7], v[160:163]
buffer_load_dwordx4 a[52:55], v4, s[40:43], s35 offen offset:1024 sc1
s_mov_b32 s35, 53248
v_mfma_f32_16x16x32_bf16 v[144:147], a[108:111], a[0:3], v[144:147]
s_waitcnt vmcnt(10) lgkmcnt(4)
v_mfma_f32_16x16x32_bf16 v[132:135], a[112:115], a[8:11], v[132:135]
ds_read_b128 a[96:99], v5 offset:12288
v_mfma_f32_16x16x32_bf16 v[148:151], a[112:115], a[12:15], v[148:151]
ds_read_b128 a[100:103], v5 offset:13312
v_mfma_f32_16x16x32_bf16 v[152:155], a[116:119], a[12:15], v[152:155]
buffer_load_dwordx4 a[0:3], v4, s[40:43], s35 offen offset:0 sc1
v_mfma_f32_16x16x32_bf16 v[136:139], a[116:119], a[8:11], v[136:139]
ds_read_b128 a[104:107], v5 offset:14336
v_mfma_f32_16x16x32_bf16 v[140:143], a[120:123], a[8:11], v[140:143]
ds_read_b128 a[108:111], v5 offset:15360
v_mfma_f32_16x16x32_bf16 v[156:159], a[120:123], a[12:15], v[156:159]
v_mfma_f32_16x16x32_bf16 v[160:163], a[124:127], a[12:15], v[160:163]
buffer_load_dwordx4 a[4:7], v4, s[40:43], s35 offen offset:1024 sc1
s_mov_b32 s35, 65536
v_mfma_f32_16x16x32_bf16 v[144:147], a[124:127], a[8:11], v[144:147]
s_waitcnt vmcnt(10) lgkmcnt(4)
v_mfma_f32_16x16x32_bf16 v[132:135], a[128:131], a[16:19], v[132:135]
ds_read_b128 a[112:115], v5 offset:16384
v_mfma_f32_16x16x32_bf16 v[148:151], a[128:131], a[20:23], v[148:151]
ds_read_b128 a[116:119], v5 offset:17408
v_mfma_f32_16x16x32_bf16 v[152:155], a[132:135], a[20:23], v[152:155]
buffer_load_dwordx4 a[8:11], v4, s[40:43], s35 offen offset:0 sc1
v_mfma_f32_16x16x32_bf16 v[136:139], a[132:135], a[16:19], v[136:139]
ds_read_b128 a[120:123], v5 offset:18432
v_mfma_f32_16x16x32_bf16 v[140:143], a[136:139], a[16:19], v[140:143]
ds_read_b128 a[124:127], v5 offset:19456
v_mfma_f32_16x16x32_bf16 v[156:159], a[136:139], a[20:23], v[156:159]
v_mfma_f32_16x16x32_bf16 v[160:163], a[140:143], a[20:23], v[160:163]
buffer_load_dwordx4 a[12:15], v4, s[40:43], s35 offen offset:1024 sc1
s_mov_b32 s35, 69632
v_mfma_f32_16x16x32_bf16 v[144:147], a[140:143], a[16:19], v[144:147]
s_waitcnt vmcnt(10) lgkmcnt(4)
v_mfma_f32_16x16x32_bf16 v[132:135], a[96:99], a[24:27], v[132:135]
ds_read_b128 a[128:131], v5 offset:20480
v_mfma_f32_16x16x32_bf16 v[148:151], a[96:99], a[28:31], v[148:151]
ds_read_b128 a[132:135], v5 offset:21504
v_mfma_f32_16x16x32_bf16 v[152:155], a[100:103], a[28:31], v[152:155]
buffer_load_dwordx4 a[16:19], v4, s[40:43], s35 offen offset:0 sc1
v_mfma_f32_16x16x32_bf16 v[136:139], a[100:103], a[24:27], v[136:139]
ds_read_b128 a[136:139], v5 offset:22528
v_mfma_f32_16x16x32_bf16 v[140:143], a[104:107], a[24:27], v[140:143]
ds_read_b128 a[140:143], v5 offset:23552
v_mfma_f32_16x16x32_bf16 v[156:159], a[104:107], a[28:31], v[156:159]
v_mfma_f32_16x16x32_bf16 v[160:163], a[108:111], a[28:31], v[160:163]
buffer_load_dwordx4 a[20:23], v4, s[40:43], s35 offen offset:1024 sc1
s_mov_b32 s35, 81920
v_mfma_f32_16x16x32_bf16 v[144:147], a[108:111], a[24:27], v[144:147]
s_waitcnt vmcnt(10) lgkmcnt(4)
v_mfma_f32_16x16x32_bf16 v[132:135], a[112:115], a[32:35], v[132:135]
ds_read_b128 a[96:99], v5 offset:24576
v_mfma_f32_16x16x32_bf16 v[148:151], a[112:115], a[36:39], v[148:151]
ds_read_b128 a[100:103], v5 offset:25600
v_mfma_f32_16x16x32_bf16 v[152:155], a[116:119], a[36:39], v[152:155]
buffer_load_dwordx4 a[24:27], v4, s[40:43], s35 offen offset:0 sc1
v_mfma_f32_16x16x32_bf16 v[136:139], a[116:119], a[32:35], v[136:139]
ds_read_b128 a[104:107], v5 offset:26624
v_mfma_f32_16x16x32_bf16 v[140:143], a[120:123], a[32:35], v[140:143]
ds_read_b128 a[108:111], v5 offset:27648
v_mfma_f32_16x16x32_bf16 v[156:159], a[120:123], a[36:39], v[156:159]
v_mfma_f32_16x16x32_bf16 v[160:163], a[124:127], a[36:39], v[160:163]
buffer_load_dwordx4 a[28:31], v4, s[40:43], s35 offen offset:1024 sc1
s_mov_b32 s35, 86016
v_mfma_f32_16x16x32_bf16 v[144:147], a[124:127], a[32:35], v[144:147]
s_waitcnt vmcnt(10) lgkmcnt(4)
v_mfma_f32_16x16x32_bf16 v[132:135], a[128:131], a[40:43], v[132:135]
ds_read_b128 a[112:115], v5 offset:28672
v_mfma_f32_16x16x32_bf16 v[148:151], a[128:131], a[44:47], v[148:151]
ds_read_b128 a[116:119], v5 offset:29696
v_mfma_f32_16x16x32_bf16 v[152:155], a[132:135], a[44:47], v[152:155]
buffer_load_dwordx4 a[32:35], v4, s[40:43], s35 offen offset:0 sc1
v_mfma_f32_16x16x32_bf16 v[136:139], a[132:135], a[40:43], v[136:139]
ds_read_b128 a[120:123], v5 offset:30720
v_mfma_f32_16x16x32_bf16 v[140:143], a[136:139], a[40:43], v[140:143]
ds_read_b128 a[124:127], v5 offset:31744
v_mfma_f32_16x16x32_bf16 v[156:159], a[136:139], a[44:47], v[156:159]
v_mfma_f32_16x16x32_bf16 v[160:163], a[140:143], a[44:47], v[160:163]
buffer_load_dwordx4 a[36:39], v4, s[40:43], s35 offen offset:1024 sc1
s_mov_b32 s35, 98304
v_mfma_f32_16x16x32_bf16 v[144:147], a[140:143], a[40:43], v[144:147]
s_waitcnt vmcnt(10) lgkmcnt(4)
v_mfma_f32_16x16x32_bf16 v[132:135], a[96:99], a[48:51], v[132:135]
ds_read_b128 a[128:131], v5 offset:32768
v_mfma_f32_16x16x32_bf16 v[148:151], a[96:99], a[52:55], v[148:151]
ds_read_b128 a[132:135], v5 offset:33792
v_mfma_f32_16x16x32_bf16 v[152:155], a[100:103], a[52:55], v[152:155]
buffer_load_dwordx4 a[40:43], v4, s[40:43], s35 offen offset:0 sc1
v_mfma_f32_16x16x32_bf16 v[136:139], a[100:103], a[48:51], v[136:139]
ds_read_b128 a[136:139], v5 offset:34816
v_mfma_f32_16x16x32_bf16 v[140:143], a[104:107], a[48:51], v[140:143]
ds_read_b128 a[140:143], v5 offset:35840
v_mfma_f32_16x16x32_bf16 v[156:159], a[104:107], a[52:55], v[156:159]
v_mfma_f32_16x16x32_bf16 v[160:163], a[108:111], a[52:55], v[160:163]
buffer_load_dwordx4 a[44:47], v4, s[40:43], s35 offen offset:1024 sc1
s_mov_b32 s35, 102400
v_mfma_f32_16x16x32_bf16 v[144:147], a[108:111], a[48:51], v[144:147]
s_waitcnt vmcnt(10) lgkmcnt(4)
v_mfma_f32_16x16x32_bf16 v[132:135], a[112:115], a[0:3], v[132:135]
ds_read_b128 a[96:99], v5 offset:36864
v_mfma_f32_16x16x32_bf16 v[148:151], a[112:115], a[4:7], v[148:151]
ds_read_b128 a[100:103], v5 offset:37888
v_mfma_f32_16x16x32_bf16 v[152:155], a[116:119], a[4:7], v[152:155]
buffer_load_dwordx4 a[48:51], v4, s[40:43], s35 offen offset:0 sc1
v_mfma_f32_16x16x32_bf16 v[136:139], a[116:119], a[0:3], v[136:139]
ds_read_b128 a[104:107], v5 offset:38912
v_mfma_f32_16x16x32_bf16 v[140:143], a[120:123], a[0:3], v[140:143]
ds_read_b128 a[108:111], v5 offset:39936
v_mfma_f32_16x16x32_bf16 v[156:159], a[120:123], a[4:7], v[156:159]
v_mfma_f32_16x16x32_bf16 v[160:163], a[124:127], a[4:7], v[160:163]
buffer_load_dwordx4 a[52:55], v4, s[40:43], s35 offen offset:1024 sc1
s_mov_b32 s35, 114688
v_mfma_f32_16x16x32_bf16 v[144:147], a[124:127], a[0:3], v[144:147]
s_waitcnt vmcnt(10) lgkmcnt(4)
v_mfma_f32_16x16x32_bf16 v[132:135], a[128:131], a[8:11], v[132:135]
ds_read_b128 a[112:115], v5 offset:40960
v_mfma_f32_16x16x32_bf16 v[148:151], a[128:131], a[12:15], v[148:151]
ds_read_b128 a[116:119], v5 offset:41984
v_mfma_f32_16x16x32_bf16 v[152:155], a[132:135], a[12:15], v[152:155]
buffer_load_dwordx4 a[0:3], v4, s[40:43], s35 offen offset:0 sc1
v_mfma_f32_16x16x32_bf16 v[136:139], a[132:135], a[8:11], v[136:139]
ds_read_b128 a[120:123], v5 offset:43008
v_mfma_f32_16x16x32_bf16 v[140:143], a[136:139], a[8:11], v[140:143]
ds_read_b128 a[124:127], v5 offset:44032
v_mfma_f32_16x16x32_bf16 v[156:159], a[136:139], a[12:15], v[156:159]
v_mfma_f32_16x16x32_bf16 v[160:163], a[140:143], a[12:15], v[160:163]
buffer_load_dwordx4 a[4:7], v4, s[40:43], s35 offen offset:1024 sc1
s_mov_b32 s35, 118784
v_mfma_f32_16x16x32_bf16 v[144:147], a[140:143], a[8:11], v[144:147]
s_waitcnt vmcnt(10) lgkmcnt(4)
v_mfma_f32_16x16x32_bf16 v[132:135], a[96:99], a[16:19], v[132:135]
ds_read_b128 a[128:131], v5 offset:45056
v_mfma_f32_16x16x32_bf16 v[148:151], a[96:99], a[20:23], v[148:151]
ds_read_b128 a[132:135], v5 offset:46080
v_mfma_f32_16x16x32_bf16 v[152:155], a[100:103], a[20:23], v[152:155]
buffer_load_dwordx4 a[8:11], v4, s[40:43], s35 offen offset:0 sc1
v_mfma_f32_16x16x32_bf16 v[136:139], a[100:103], a[16:19], v[136:139]
ds_read_b128 a[136:139], v5 offset:47104
v_mfma_f32_16x16x32_bf16 v[140:143], a[104:107], a[16:19], v[140:143]
ds_read_b128 a[140:143], v5 offset:48128
v_mfma_f32_16x16x32_bf16 v[156:159], a[104:107], a[20:23], v[156:159]
v_mfma_f32_16x16x32_bf16 v[160:163], a[108:111], a[20:23], v[160:163]
buffer_load_dwordx4 a[12:15], v4, s[40:43], s35 offen offset:1024 sc1
s_mov_b32 s35, 524288
v_mfma_f32_16x16x32_bf16 v[144:147], a[108:111], a[16:19], v[144:147]
s_waitcnt vmcnt(10) lgkmcnt(4)
v_mfma_f32_16x16x32_bf16 v[132:135], a[112:115], a[24:27], v[132:135]
ds_read_b128 a[96:99], v5 offset:49152
v_mfma_f32_16x16x32_bf16 v[148:151], a[112:115], a[28:31], v[148:151]
ds_read_b128 a[100:103], v5 offset:50176
v_mfma_f32_16x16x32_bf16 v[152:155], a[116:119], a[28:31], v[152:155]
buffer_load_dwordx4 a[16:19], v4, s[40:43], s35 offen offset:0 sc1
v_mfma_f32_16x16x32_bf16 v[136:139], a[116:119], a[24:27], v[136:139]
ds_read_b128 a[104:107], v5 offset:51200
v_mfma_f32_16x16x32_bf16 v[140:143], a[120:123], a[24:27], v[140:143]
ds_read_b128 a[108:111], v5 offset:52224
v_mfma_f32_16x16x32_bf16 v[156:159], a[120:123], a[28:31], v[156:159]
v_mfma_f32_16x16x32_bf16 v[160:163], a[124:127], a[28:31], v[160:163]
buffer_load_dwordx4 a[20:23], v4, s[40:43], s35 offen offset:1024 sc1
s_mov_b32 s35, 528384
v_mfma_f32_16x16x32_bf16 v[144:147], a[124:127], a[24:27], v[144:147]
s_waitcnt vmcnt(10) lgkmcnt(4)
v_mfma_f32_16x16x32_bf16 v[132:135], a[128:131], a[32:35], v[132:135]
ds_read_b128 a[112:115], v5 offset:53248
v_mfma_f32_16x16x32_bf16 v[148:151], a[128:131], a[36:39], v[148:151]
ds_read_b128 a[116:119], v5 offset:54272
v_mfma_f32_16x16x32_bf16 v[152:155], a[132:135], a[36:39], v[152:155]
buffer_load_dwordx4 a[24:27], v4, s[40:43], s35 offen offset:0 sc1
v_mfma_f32_16x16x32_bf16 v[136:139], a[132:135], a[32:35], v[136:139]
ds_read_b128 a[120:123], v5 offset:55296
v_mfma_f32_16x16x32_bf16 v[140:143], a[136:139], a[32:35], v[140:143]
ds_read_b128 a[124:127], v5 offset:56320
v_mfma_f32_16x16x32_bf16 v[156:159], a[136:139], a[36:39], v[156:159]
v_mfma_f32_16x16x32_bf16 v[160:163], a[140:143], a[36:39], v[160:163]
buffer_load_dwordx4 a[28:31], v4, s[40:43], s35 offen offset:1024 sc1
s_mov_b32 s35, 540672
v_mfma_f32_16x16x32_bf16 v[144:147], a[140:143], a[32:35], v[144:147]
s_waitcnt vmcnt(10) lgkmcnt(4)
v_mfma_f32_16x16x32_bf16 v[132:135], a[96:99], a[40:43], v[132:135]
ds_read_b128 a[128:131], v5 offset:57344
v_mfma_f32_16x16x32_bf16 v[148:151], a[96:99], a[44:47], v[148:151]
ds_read_b128 a[132:135], v5 offset:58368
v_mfma_f32_16x16x32_bf16 v[152:155], a[100:103], a[44:47], v[152:155]
buffer_load_dwordx4 a[32:35], v4, s[40:43], s35 offen offset:0 sc1
v_mfma_f32_16x16x32_bf16 v[136:139], a[100:103], a[40:43], v[136:139]
ds_read_b128 a[136:139], v5 offset:59392
v_mfma_f32_16x16x32_bf16 v[140:143], a[104:107], a[40:43], v[140:143]
ds_read_b128 a[140:143], v5 offset:60416
v_mfma_f32_16x16x32_bf16 v[156:159], a[104:107], a[44:47], v[156:159]
v_mfma_f32_16x16x32_bf16 v[160:163], a[108:111], a[44:47], v[160:163]
buffer_load_dwordx4 a[36:39], v4, s[40:43], s35 offen offset:1024 sc1
s_mov_b32 s35, 544768
v_mfma_f32_16x16x32_bf16 v[144:147], a[108:111], a[40:43], v[144:147]
s_waitcnt vmcnt(10) lgkmcnt(4)
v_mfma_f32_16x16x32_bf16 v[132:135], a[112:115], a[48:51], v[132:135]
ds_read_b128 a[96:99], v5 offset:61440
v_mfma_f32_16x16x32_bf16 v[148:151], a[112:115], a[52:55], v[148:151]
ds_read_b128 a[100:103], v5 offset:62464
v_mfma_f32_16x16x32_bf16 v[152:155], a[116:119], a[52:55], v[152:155]
buffer_load_dwordx4 a[40:43], v4, s[40:43], s35 offen offset:0 sc1
v_mfma_f32_16x16x32_bf16 v[136:139], a[116:119], a[48:51], v[136:139]
ds_read_b128 a[104:107], v5 offset:63488
v_mfma_f32_16x16x32_bf16 v[140:143], a[120:123], a[48:51], v[140:143]
ds_read_b128 a[108:111], v5 offset:64512
v_mfma_f32_16x16x32_bf16 v[156:159], a[120:123], a[52:55], v[156:159]
v_mfma_f32_16x16x32_bf16 v[160:163], a[124:127], a[52:55], v[160:163]
buffer_load_dwordx4 a[44:47], v4, s[40:43], s35 offen offset:1024 sc1
s_mov_b32 s35, 557056
v_mfma_f32_16x16x32_bf16 v[144:147], a[124:127], a[48:51], v[144:147]
s_waitcnt vmcnt(10) lgkmcnt(4)
v_mfma_f32_16x16x32_bf16 v[132:135], a[128:131], a[0:3], v[132:135]
ds_read_b128 a[112:115], v6 offset:0
v_mfma_f32_16x16x32_bf16 v[148:151], a[128:131], a[4:7], v[148:151]
ds_read_b128 a[116:119], v6 offset:1024
v_mfma_f32_16x16x32_bf16 v[152:155], a[132:135], a[4:7], v[152:155]
buffer_load_dwordx4 a[48:51], v4, s[40:43], s35 offen offset:0 sc1
v_mfma_f32_16x16x32_bf16 v[136:139], a[132:135], a[0:3], v[136:139]
ds_read_b128 a[120:123], v6 offset:2048
v_mfma_f32_16x16x32_bf16 v[140:143], a[136:139], a[0:3], v[140:143]
ds_read_b128 a[124:127], v6 offset:3072
v_mfma_f32_16x16x32_bf16 v[156:159], a[136:139], a[4:7], v[156:159]
v_mfma_f32_16x16x32_bf16 v[160:163], a[140:143], a[4:7], v[160:163]
buffer_load_dwordx4 a[52:55], v4, s[40:43], s35 offen offset:1024 sc1
s_mov_b32 s35, 561152
v_mfma_f32_16x16x32_bf16 v[144:147], a[140:143], a[0:3], v[144:147]
s_waitcnt vmcnt(10) lgkmcnt(4)
v_mfma_f32_16x16x32_bf16 v[132:135], a[96:99], a[8:11], v[132:135]
ds_read_b128 a[128:131], v6 offset:4096
v_mfma_f32_16x16x32_bf16 v[148:151], a[96:99], a[12:15], v[148:151]
ds_read_b128 a[132:135], v6 offset:5120
v_mfma_f32_16x16x32_bf16 v[152:155], a[100:103], a[12:15], v[152:155]
buffer_load_dwordx4 a[0:3], v4, s[40:43], s35 offen offset:0 sc1
v_mfma_f32_16x16x32_bf16 v[136:139], a[100:103], a[8:11], v[136:139]
ds_read_b128 a[136:139], v6 offset:6144
v_mfma_f32_16x16x32_bf16 v[140:143], a[104:107], a[8:11], v[140:143]
ds_read_b128 a[140:143], v6 offset:7168
v_mfma_f32_16x16x32_bf16 v[156:159], a[104:107], a[12:15], v[156:159]
v_mfma_f32_16x16x32_bf16 v[160:163], a[108:111], a[12:15], v[160:163]
buffer_load_dwordx4 a[4:7], v4, s[40:43], s35 offen offset:1024 sc1
s_mov_b32 s35, 573440
v_mfma_f32_16x16x32_bf16 v[144:147], a[108:111], a[8:11], v[144:147]
s_waitcnt vmcnt(10) lgkmcnt(4)
v_mfma_f32_16x16x32_bf16 v[132:135], a[112:115], a[16:19], v[132:135]
ds_read_b128 a[96:99], v6 offset:8192
v_mfma_f32_16x16x32_bf16 v[148:151], a[112:115], a[20:23], v[148:151]
ds_read_b128 a[100:103], v6 offset:9216
v_mfma_f32_16x16x32_bf16 v[152:155], a[116:119], a[20:23], v[152:155]
buffer_load_dwordx4 a[8:11], v4, s[40:43], s35 offen offset:0 sc1
v_mfma_f32_16x16x32_bf16 v[136:139], a[116:119], a[16:19], v[136:139]
ds_read_b128 a[104:107], v6 offset:10240
v_mfma_f32_16x16x32_bf16 v[140:143], a[120:123], a[16:19], v[140:143]
ds_read_b128 a[108:111], v6 offset:11264
v_mfma_f32_16x16x32_bf16 v[156:159], a[120:123], a[20:23], v[156:159]
v_mfma_f32_16x16x32_bf16 v[160:163], a[124:127], a[20:23], v[160:163]
buffer_load_dwordx4 a[12:15], v4, s[40:43], s35 offen offset:1024 sc1
s_mov_b32 s35, 577536
v_mfma_f32_16x16x32_bf16 v[144:147], a[124:127], a[16:19], v[144:147]
s_waitcnt vmcnt(10) lgkmcnt(4)
v_mfma_f32_16x16x32_bf16 v[132:135], a[128:131], a[24:27], v[132:135]
ds_read_b128 a[112:115], v6 offset:12288
v_mfma_f32_16x16x32_bf16 v[148:151], a[128:131], a[28:31], v[148:151]
ds_read_b128 a[116:119], v6 offset:13312
v_mfma_f32_16x16x32_bf16 v[152:155], a[132:135], a[28:31], v[152:155]
buffer_load_dwordx4 a[16:19], v4, s[40:43], s35 offen offset:0 sc1
v_mfma_f32_16x16x32_bf16 v[136:139], a[132:135], a[24:27], v[136:139]
ds_read_b128 a[120:123], v6 offset:14336
v_mfma_f32_16x16x32_bf16 v[140:143], a[136:139], a[24:27], v[140:143]
ds_read_b128 a[124:127], v6 offset:15360
v_mfma_f32_16x16x32_bf16 v[156:159], a[136:139], a[28:31], v[156:159]
v_mfma_f32_16x16x32_bf16 v[160:163], a[140:143], a[28:31], v[160:163]
buffer_load_dwordx4 a[20:23], v4, s[40:43], s35 offen offset:1024 sc1
s_mov_b32 s35, 589824
v_mfma_f32_16x16x32_bf16 v[144:147], a[140:143], a[24:27], v[144:147]
s_waitcnt vmcnt(10) lgkmcnt(4)
v_mfma_f32_16x16x32_bf16 v[132:135], a[96:99], a[32:35], v[132:135]
ds_read_b128 a[128:131], v6 offset:16384
v_mfma_f32_16x16x32_bf16 v[148:151], a[96:99], a[36:39], v[148:151]
ds_read_b128 a[132:135], v6 offset:17408
v_mfma_f32_16x16x32_bf16 v[152:155], a[100:103], a[36:39], v[152:155]
buffer_load_dwordx4 a[24:27], v4, s[40:43], s35 offen offset:0 sc1
v_mfma_f32_16x16x32_bf16 v[136:139], a[100:103], a[32:35], v[136:139]
ds_read_b128 a[136:139], v6 offset:18432
v_mfma_f32_16x16x32_bf16 v[140:143], a[104:107], a[32:35], v[140:143]
ds_read_b128 a[140:143], v6 offset:19456
v_mfma_f32_16x16x32_bf16 v[156:159], a[104:107], a[36:39], v[156:159]
v_mfma_f32_16x16x32_bf16 v[160:163], a[108:111], a[36:39], v[160:163]
buffer_load_dwordx4 a[28:31], v4, s[40:43], s35 offen offset:1024 sc1
s_mov_b32 s35, 593920
v_mfma_f32_16x16x32_bf16 v[144:147], a[108:111], a[32:35], v[144:147]
s_waitcnt vmcnt(10) lgkmcnt(4)
v_mfma_f32_16x16x32_bf16 v[132:135], a[112:115], a[40:43], v[132:135]
ds_read_b128 a[96:99], v6 offset:20480
v_mfma_f32_16x16x32_bf16 v[148:151], a[112:115], a[44:47], v[148:151]
ds_read_b128 a[100:103], v6 offset:21504
v_mfma_f32_16x16x32_bf16 v[152:155], a[116:119], a[44:47], v[152:155]
buffer_load_dwordx4 a[32:35], v4, s[40:43], s35 offen offset:0 sc1
v_mfma_f32_16x16x32_bf16 v[136:139], a[116:119], a[40:43], v[136:139]
ds_read_b128 a[104:107], v6 offset:22528
v_mfma_f32_16x16x32_bf16 v[140:143], a[120:123], a[40:43], v[140:143]
ds_read_b128 a[108:111], v6 offset:23552
v_mfma_f32_16x16x32_bf16 v[156:159], a[120:123], a[44:47], v[156:159]
v_mfma_f32_16x16x32_bf16 v[160:163], a[124:127], a[44:47], v[160:163]
buffer_load_dwordx4 a[36:39], v4, s[40:43], s35 offen offset:1024 sc1
s_mov_b32 s35, 606208
v_mfma_f32_16x16x32_bf16 v[144:147], a[124:127], a[40:43], v[144:147]
s_waitcnt vmcnt(10) lgkmcnt(4)
v_mfma_f32_16x16x32_bf16 v[132:135], a[128:131], a[48:51], v[132:135]
ds_read_b128 a[112:115], v6 offset:24576
v_mfma_f32_16x16x32_bf16 v[148:151], a[128:131], a[52:55], v[148:151]
ds_read_b128 a[116:119], v6 offset:25600
v_mfma_f32_16x16x32_bf16 v[152:155], a[132:135], a[52:55], v[152:155]
buffer_load_dwordx4 a[40:43], v4, s[40:43], s35 offen offset:0 sc1
v_mfma_f32_16x16x32_bf16 v[136:139], a[132:135], a[48:51], v[136:139]
ds_read_b128 a[120:123], v6 offset:26624
v_mfma_f32_16x16x32_bf16 v[140:143], a[136:139], a[48:51], v[140:143]
ds_read_b128 a[124:127], v6 offset:27648
v_mfma_f32_16x16x32_bf16 v[156:159], a[136:139], a[52:55], v[156:159]
v_mfma_f32_16x16x32_bf16 v[160:163], a[140:143], a[52:55], v[160:163]
buffer_load_dwordx4 a[44:47], v4, s[40:43], s35 offen offset:1024 sc1
s_mov_b32 s35, 610304
v_mfma_f32_16x16x32_bf16 v[144:147], a[140:143], a[48:51], v[144:147]
s_waitcnt vmcnt(10) lgkmcnt(4)
v_mfma_f32_16x16x32_bf16 v[132:135], a[96:99], a[0:3], v[132:135]
ds_read_b128 a[128:131], v6 offset:28672
v_mfma_f32_16x16x32_bf16 v[148:151], a[96:99], a[4:7], v[148:151]
ds_read_b128 a[132:135], v6 offset:29696
v_mfma_f32_16x16x32_bf16 v[152:155], a[100:103], a[4:7], v[152:155]
buffer_load_dwordx4 a[48:51], v4, s[40:43], s35 offen offset:0 sc1
v_mfma_f32_16x16x32_bf16 v[136:139], a[100:103], a[0:3], v[136:139]
ds_read_b128 a[136:139], v6 offset:30720
v_mfma_f32_16x16x32_bf16 v[140:143], a[104:107], a[0:3], v[140:143]
ds_read_b128 a[140:143], v6 offset:31744
v_mfma_f32_16x16x32_bf16 v[156:159], a[104:107], a[4:7], v[156:159]
v_mfma_f32_16x16x32_bf16 v[160:163], a[108:111], a[4:7], v[160:163]
buffer_load_dwordx4 a[52:55], v4, s[40:43], s35 offen offset:1024 sc1
s_mov_b32 s35, 622592
v_mfma_f32_16x16x32_bf16 v[144:147], a[108:111], a[0:3], v[144:147]
s_waitcnt vmcnt(10) lgkmcnt(4)
v_mfma_f32_16x16x32_bf16 v[132:135], a[112:115], a[8:11], v[132:135]
ds_read_b128 a[96:99], v6 offset:32768
v_mfma_f32_16x16x32_bf16 v[148:151], a[112:115], a[12:15], v[148:151]
ds_read_b128 a[100:103], v6 offset:33792
v_mfma_f32_16x16x32_bf16 v[152:155], a[116:119], a[12:15], v[152:155]
buffer_load_dwordx4 a[0:3], v4, s[40:43], s35 offen offset:0 sc1
v_mfma_f32_16x16x32_bf16 v[136:139], a[116:119], a[8:11], v[136:139]
ds_read_b128 a[104:107], v6 offset:34816
v_mfma_f32_16x16x32_bf16 v[140:143], a[120:123], a[8:11], v[140:143]
ds_read_b128 a[108:111], v6 offset:35840
v_mfma_f32_16x16x32_bf16 v[156:159], a[120:123], a[12:15], v[156:159]
v_mfma_f32_16x16x32_bf16 v[160:163], a[124:127], a[12:15], v[160:163]
buffer_load_dwordx4 a[4:7], v4, s[40:43], s35 offen offset:1024 sc1
s_mov_b32 s35, 626688
v_mfma_f32_16x16x32_bf16 v[144:147], a[124:127], a[8:11], v[144:147]
s_waitcnt vmcnt(10) lgkmcnt(4)
v_mfma_f32_16x16x32_bf16 v[132:135], a[128:131], a[16:19], v[132:135]
ds_read_b128 a[112:115], v6 offset:36864
v_mfma_f32_16x16x32_bf16 v[148:151], a[128:131], a[20:23], v[148:151]
ds_read_b128 a[116:119], v6 offset:37888
v_mfma_f32_16x16x32_bf16 v[152:155], a[132:135], a[20:23], v[152:155]
buffer_load_dwordx4 a[8:11], v4, s[40:43], s35 offen offset:0 sc1
v_mfma_f32_16x16x32_bf16 v[136:139], a[132:135], a[16:19], v[136:139]
ds_read_b128 a[120:123], v6 offset:38912
v_mfma_f32_16x16x32_bf16 v[140:143], a[136:139], a[16:19], v[140:143]
ds_read_b128 a[124:127], v6 offset:39936
v_mfma_f32_16x16x32_bf16 v[156:159], a[136:139], a[20:23], v[156:159]
v_mfma_f32_16x16x32_bf16 v[160:163], a[140:143], a[20:23], v[160:163]
buffer_load_dwordx4 a[12:15], v4, s[40:43], s35 offen offset:1024 sc1
L_stub14:
s_cbranch_execz L_wret5
s_mov_b32 s35, 638976
v_mfma_f32_16x16x32_bf16 v[144:147], a[140:143], a[16:19], v[144:147]
s_waitcnt vmcnt(10) lgkmcnt(4)
v_mfma_f32_16x16x32_bf16 v[132:135], a[96:99], a[24:27], v[132:135]
ds_read_b128 a[128:131], v6 offset:40960
v_mfma_f32_16x16x32_bf16 v[148:151], a[96:99], a[28:31], v[148:151]
ds_read_b128 a[132:135], v6 offset:41984
v_mfma_f32_16x16x32_bf16 v[152:155], a[100:103], a[28:31], v[152:155]
buffer_load_dwordx4 a[16:19], v4, s[40:43], s35 offen offset:0 sc1
v_mfma_f32_16x16x32_bf16 v[136:139], a[100:103], a[24:27], v[136:139]
ds_read_b128 a[136:139], v6 offset:43008
v_mfma_f32_16x16x32_bf16 v[140:143], a[104:107], a[24:27], v[140:143]
ds_read_b128 a[140:143], v6 offset:44032
v_mfma_f32_16x16x32_bf16 v[156:159], a[104:107], a[28:31], v[156:159]
v_mfma_f32_16x16x32_bf16 v[160:163], a[108:111], a[28:31], v[160:163]
buffer_load_dwordx4 a[20:23], v4, s[40:43], s35 offen offset:1024 sc1
s_mov_b32 s35, 643072
v_mfma_f32_16x16x32_bf16 v[144:147], a[108:111], a[24:27], v[144:147]
s_waitcnt vmcnt(10) lgkmcnt(4)
v_mfma_f32_16x16x32_bf16 v[132:135], a[112:115], a[32:35], v[132:135]
ds_read_b128 a[96:99], v6 offset:45056
v_mfma_f32_16x16x32_bf16 v[148:151], a[112:115], a[36:39], v[148:151]
ds_read_b128 a[100:103], v6 offset:46080
v_mfma_f32_16x16x32_bf16 v[152:155], a[116:119], a[36:39], v[152:155]
buffer_load_dwordx4 a[24:27], v4, s[40:43], s35 offen offset:0 sc1
v_mfma_f32_16x16x32_bf16 v[136:139], a[116:119], a[32:35], v[136:139]
ds_read_b128 a[104:107], v6 offset:47104
v_mfma_f32_16x16x32_bf16 v[140:143], a[120:123], a[32:35], v[140:143]
ds_read_b128 a[108:111], v6 offset:48128
v_mfma_f32_16x16x32_bf16 v[156:159], a[120:123], a[36:39], v[156:159]
v_mfma_f32_16x16x32_bf16 v[160:163], a[124:127], a[36:39], v[160:163]
buffer_load_dwordx4 a[28:31], v4, s[40:43], s35 offen offset:1024 sc1
s_mov_b32 s35, 1048576
v_mfma_f32_16x16x32_bf16 v[144:147], a[124:127], a[32:35], v[144:147]
s_waitcnt vmcnt(10) lgkmcnt(4)
v_mfma_f32_16x16x32_bf16 v[132:135], a[128:131], a[40:43], v[132:135]
s_add_u32 m0, s18, 0x0
s_add_u32 s44, s50, 0x3400000
v_mfma_f32_16x16x32_bf16 v[148:151], a[128:131], a[44:47], v[148:151]
ds_read_b128 a[112:115], v6 offset:49152
v_mfma_f32_16x16x32_bf16 v[152:155], a[132:135], a[44:47], v[152:155]
buffer_load_dwordx4 v1, s[4:7], s44 offen offset:0 sc1 lds
v_mfma_f32_16x16x32_bf16 v[136:139], a[132:135], a[40:43], v[136:139]
ds_read_b128 a[116:119], v6 offset:50176
v_mfma_f32_16x16x32_bf16 v[140:143], a[136:139], a[40:43], v[140:143]
ds_read_b128 a[120:123], v6 offset:51200
v_mfma_f32_16x16x32_bf16 v[156:159], a[136:139], a[44:47], v[156:159]
ds_read_b128 a[124:127], v6 offset:52224
v_mfma_f32_16x16x32_bf16 v[160:163], a[140:143], a[44:47], v[160:163]
buffer_load_dwordx4 v1, s[4:7], s44 offen offset:1024 sc1 lds
s_add_u32 m0, s18, 0x2000
v_mfma_f32_16x16x32_bf16 v[144:147], a[140:143], a[40:43], v[144:147]
s_add_u32 s44, s50, 0x3402000
s_waitcnt vmcnt(10) lgkmcnt(4)
v_mfma_f32_16x16x32_bf16 v[132:135], a[96:99], a[48:51], v[132:135]
ds_read_b128 a[128:131], v6 offset:53248
v_mfma_f32_16x16x32_bf16 v[148:151], a[96:99], a[52:55], v[148:151]
ds_read_b128 a[132:135], v6 offset:54272
v_mfma_f32_16x16x32_bf16 v[152:155], a[100:103], a[52:55], v[152:155]
buffer_load_dwordx4 v1, s[4:7], s44 offen offset:0 sc1 lds
v_mfma_f32_16x16x32_bf16 v[136:139], a[100:103], a[48:51], v[136:139]
ds_read_b128 a[136:139], v6 offset:55296
v_mfma_f32_16x16x32_bf16 v[140:143], a[104:107], a[48:51], v[140:143]
ds_read_b128 a[140:143], v6 offset:56320
v_mfma_f32_16x16x32_bf16 v[156:159], a[104:107], a[52:55], v[156:159]
v_mfma_f32_16x16x32_bf16 v[160:163], a[108:111], a[52:55], v[160:163]
buffer_load_dwordx4 v1, s[4:7], s44 offen offset:1024 sc1 lds
s_add_u32 m0, s18, 0x4000
v_mfma_f32_16x16x32_bf16 v[144:147], a[108:111], a[48:51], v[144:147]
s_add_u32 s44, s50, 0x3404000
s_waitcnt vmcnt(10) lgkmcnt(4)
v_mfma_f32_16x16x32_bf16 v[132:135], a[112:115], a[0:3], v[132:135]
ds_read_b128 a[96:99], v6 offset:57344
v_mfma_f32_16x16x32_bf16 v[148:151], a[112:115], a[4:7], v[148:151]
ds_read_b128 a[100:103], v6 offset:58368
v_mfma_f32_16x16x32_bf16 v[152:155], a[116:119], a[4:7], v[152:155]
ds_read_b128 a[104:107], v6 offset:59392
v_mfma_f32_16x16x32_bf16 v[136:139], a[116:119], a[0:3], v[136:139]
buffer_load_dwordx4 v1, s[4:7], s44 offen offset:0 sc1 lds
v_mfma_f32_16x16x32_bf16 v[140:143], a[120:123], a[0:3], v[140:143]
ds_read_b128 a[108:111], v6 offset:60416
v_mfma_f32_16x16x32_bf16 v[156:159], a[120:123], a[4:7], v[156:159]
v_mfma_f32_16x16x32_bf16 v[160:163], a[124:127], a[4:7], v[160:163]
v_mfma_f32_16x16x32_bf16 v[144:147], a[124:127], a[0:3], v[144:147]
buffer_load_dwordx4 v1, s[4:7], s44 offen offset:1024 sc1 lds
s_waitcnt vmcnt(10) lgkmcnt(4)
v_mfma_f32_16x16x32_bf16 v[132:135], a[128:131], a[8:11], v[132:135]
s_add_u32 m0, s18, 0x6000
s_add_u32 s44, s50, 0x3406000
v_mfma_f32_16x16x32_bf16 v[148:151], a[128:131], a[12:15], v[148:151]
ds_read_b128 a[112:115], v6 offset:61440
v_mfma_f32_16x16x32_bf16 v[152:155], a[132:135], a[12:15], v[152:155]
ds_read_b128 a[116:119], v6 offset:62464
v_mfma_f32_16x16x32_bf16 v[136:139], a[132:135], a[8:11], v[136:139]
ds_read_b128 a[120:123], v6 offset:63488
v_mfma_f32_16x16x32_bf16 v[140:143], a[136:139], a[8:11], v[140:143]
buffer_load_dwordx4 v1, s[4:7], s44 offen offset:0 sc1 lds
v_mfma_f32_16x16x32_bf16 v[156:159], a[136:139], a[12:15], v[156:159]
ds_read_b128 a[124:127], v6 offset:64512
v_mfma_f32_16x16x32_bf16 v[160:163], a[140:143], a[12:15], v[160:163]
v_mfma_f32_16x16x32_bf16 v[144:147], a[140:143], a[8:11], v[144:147]
s_waitcnt vmcnt(9) lgkmcnt(4)
v_mfma_f32_16x16x32_bf16 v[132:135], a[96:99], a[16:19], v[132:135]
v_mfma_f32_16x16x32_bf16 v[148:151], a[96:99], a[20:23], v[148:151]
buffer_load_dwordx4 v1, s[4:7], s44 offen offset:1024 sc1 lds
v_mfma_f32_16x16x32_bf16 v[152:155], a[100:103], a[20:23], v[152:155]
v_mfma_f32_16x16x32_bf16 v[136:139], a[100:103], a[16:19], v[136:139]
v_mfma_f32_16x16x32_bf16 v[140:143], a[104:107], a[16:19], v[140:143]
v_mfma_f32_16x16x32_bf16 v[156:159], a[104:107], a[20:23], v[156:159]
v_mfma_f32_16x16x32_bf16 v[160:163], a[108:111], a[20:23], v[160:163]
v_mfma_f32_16x16x32_bf16 v[144:147], a[108:111], a[16:19], v[144:147]
s_waitcnt vmcnt(8) lgkmcnt(0)
v_mfma_f32_16x16x32_bf16 v[132:135], a[112:115], a[24:27], v[132:135]
v_mfma_f32_16x16x32_bf16 v[148:151], a[112:115], a[28:31], v[148:151]
v_mfma_f32_16x16x32_bf16 v[152:155], a[116:119], a[28:31], v[152:155]
buffer_atomic_add v12, v10, s[4:7], s92 offen sc1
v_mfma_f32_16x16x32_bf16 v[136:139], a[116:119], a[24:27], v[136:139]
v_mfma_f32_16x16x32_bf16 v[140:143], a[120:123], a[24:27], v[140:143]
v_mfma_f32_16x16x32_bf16 v[156:159], a[120:123], a[28:31], v[156:159]
v_mfma_f32_16x16x32_bf16 v[160:163], a[124:127], a[28:31], v[160:163]
v_mfma_f32_16x16x32_bf16 v[144:147], a[124:127], a[24:27], v[144:147]
s_nop 0
v_cmp_u_f32 vcc, v132, v148
s_nop 0
s_and_b32 vcc_lo, vcc_lo, s95
s_cbranch_scc1 L_k2redo2
s_lshr_b32 s37, s32, 3
s_and_b32 s36, s32, 7
s_mul_i32 s37, s37, 524288
s_lshl_b32 s36, s36, 14
s_add_u32 s36, s36, s37
v_cvt_pk_bf16_f32 v32, v132, v133
v_cvt_pk_bf16_f32 v33, v134, v135
v_cvt_pk_bf16_f32 v34, v136, v137
v_cvt_pk_bf16_f32 v35, v138, v139
s_add_u32 s36, s36, 0x1c00000
buffer_store_dwordx4 v[32:35], v4, s[4:7], s36 offen offset:0 sc1
v_cvt_pk_bf16_f32 v40, v148, v149
v_cvt_pk_bf16_f32 v41, v150, v151
v_cvt_pk_bf16_f32 v42, v152, v153
v_cvt_pk_bf16_f32 v43, v154, v155
v_cvt_pk_bf16_f32 v36, v140, v141
v_cvt_pk_bf16_f32 v37, v142, v143
v_cvt_pk_bf16_f32 v38, v144, v145
v_cvt_pk_bf16_f32 v39, v146, v147
s_add_u32 s37, s36, 4096
v_cvt_pk_bf16_f32 v44, v156, v157
v_cvt_pk_bf16_f32 v45, v158, v159
v_cvt_pk_bf16_f32 v46, v160, v161
buffer_store_dwordx4 v[40:43], v4, s[4:7], s36 offen offset:1024 sc1
v_cvt_pk_bf16_f32 v47, v162, v163
v_mfma_f32_16x16x32_bf16 v[96:99], v[32:35], v[32:35], 0
s_mov_b32 s38, 0x2c0000
s_add_u32 s92, s78, 0x60000
v_mfma_f32_16x16x32_bf16 v[92:95], v[16:19], v[32:35], 0
s_add_u32 s40, s4, 0x1c00000
s_addc_u32 s41, s5, 0
v_mfma_f32_16x16x32_bf16 v[96:99], v[36:39], v[36:39], v[96:99]
buffer_store_dwordx4 v[36:39], v4, s[4:7], s37 offen offset:0 sc1
v_mfma_f32_16x16x32_bf16 v[92:95], v[16:19], v[36:39], v[92:95]
s_nop 5
v_cndmask_b32 v96, v96, v97, s[46:47]
v_cndmask_b32 v98, v98, v99, s[46:47]
v_mfma_f32_16x16x32_bf16 v[104:107], v[40:43], v[40:43], 0
v_mfma_f32_16x16x32_bf16 v[100:103], v[16:19], v[40:43], 0
v_cndmask_b32 v93, v96, v98, s[48:49]
buffer_store_dwordx4 v[44:47], v4, s[4:7], s37 offen offset:1024 sc1
v_mfma_f32_16x16x32_bf16 v[104:107], v[44:47], v[44:47], v[104:107]
v_mfma_f32_16x16x32_bf16 v[100:103], v[16:19], v[44:47], v[100:103]
s_nop 6
v_cndmask_b32 v104, v104, v105, s[46:47]
v_cndmask_b32 v106, v106, v107, s[46:47]
buffer_store_dwordx2 v[92:93], v253, s[4:7], s38 offen offset:0 sc1
v_cndmask_b32 v101, v104, v106, s[48:49]
buffer_store_dwordx2 v[100:101], v253, s[4:7], s38 offen offset:2048 sc1
s_barrier
s_add_u32 m0, s18, 0x8000
s_add_u32 s44, s50, 0x3408000
buffer_load_dwordx4 v1, s[4:7], s44 offen offset:0 sc1 lds
buffer_load_dwordx4 v1, s[4:7], s44 offen offset:1024 sc1 lds
s_add_u32 m0, s18, 0xa000
s_add_u32 s44, s50, 0x340a000
buffer_load_dwordx4 v1, s[4:7], s44 offen offset:0 sc1 lds
buffer_load_dwordx4 v1, s[4:7], s44 offen offset:1024 sc1 lds
v_accvgpr_read_b32 v48, a216
v_accvgpr_read_b32 v49, a217
v_accvgpr_read_b32 v50, a218
v_accvgpr_read_b32 v51, a219
v_accvgpr_read_b32 v52, a220
v_accvgpr_read_b32 v53, a221
v_accvgpr_read_b32 v54, a222
v_accvgpr_read_b32 v55, a223
v_accvgpr_read_b32 v56, a224
v_accvgpr_read_b32 v57, a225
v_accvgpr_read_b32 v58, a226
v_accvgpr_read_b32 v59, a227
v_accvgpr_read_b32 v60, a228
v_accvgpr_read_b32 v61, a229
v_accvgpr_read_b32 v62, a230
v_accvgpr_read_b32 v63, a231
v_accvgpr_read_b32 v64, a232
v_accvgpr_read_b32 v65, a233
v_accvgpr_read_b32 v66, a234
v_accvgpr_read_b32 v67, a235
v_accvgpr_read_b32 v68, a236
v_accvgpr_read_b32 v69, a237
v_accvgpr_read_b32 v70, a238
v_accvgpr_read_b32 v71, a239
s_waitcnt vmcnt(4)
s_barrier
s_cmp_lg_u32 s28, 0
s_cbranch_scc1 Lsg_39
buffer_atomic_add v12, v10, s[4:7], s92 offen sc1
Lsg_39:
s_mov_b64 exec, 0
s_cmp_eq_u32 s28, 0
s_cbranch_scc1 L_stub15
L_wret6:
s_mov_b64 exec, -1
s_cmp_lt_u32 s28, 2
s_cbranch_scc1 Lwd_40
s_add_u32 m0, s19, 0xa000
s_add_u32 s44, s50, 0x340a000
s_add_u32 s44, s44, s18
buffer_load_dwordx4 v1, s[4:7], s44 offen offset:0 sc1 lds
buffer_load_dwordx4 v1, s[4:7], s44 offen offset:1024 sc1 lds
buffer_load_dwordx4 v1, s[4:7], s44 offen offset:2048 sc1 lds
buffer_load_dwordx4 v1, s[4:7], s44 offen offset:3072 sc1 lds
s_add_u32 m0, s19, 0xc000
s_add_u32 s44, s50, 0x340c000
s_add_u32 s44, s44, s18
buffer_load_dwordx4 v1, s[4:7], s44 offen offset:0 sc1 lds
buffer_load_dwordx4 v1, s[4:7], s44 offen offset:1024 sc1 lds
buffer_load_dwordx4 v1, s[4:7], s44 offen offset:2048 sc1 lds
buffer_load_dwordx4 v1, s[4:7], s44 offen offset:3072 sc1 lds
s_add_u32 m0, s19, 0xe000
s_add_u32 s44, s50, 0x340e000
s_add_u32 s44, s44, s18
buffer_load_dwordx4 v1, s[4:7], s44 offen offset:0 sc1 lds
buffer_load_dwordx4 v1, s[4:7], s44 offen offset:1024 sc1 lds
buffer_load_dwordx4 v1, s[4:7], s44 offen offset:2048 sc1 lds
buffer_load_dwordx4 v1, s[4:7], s44 offen offset:3072 sc1 lds
s_add_u32 m0, s19, 0x10000
s_add_u32 s44, s50, 0x3410000
s_add_u32 s44, s44, s18
buffer_load_dwordx4 v1, s[4:7], s44 offen offset:0 sc1 lds
buffer_load_dwordx4 v1, s[4:7], s44 offen offset:1024 sc1 lds
buffer_load_dwordx4 v1, s[4:7], s44 offen offset:2048 sc1 lds
buffer_load_dwordx4 v1, s[4:7], s44 offen offset:3072 sc1 lds
s_add_u32 m0, s19, 0x12000
s_add_u32 s44, s50, 0x3412000
s_add_u32 s44, s44, s18
buffer_load_dwordx4 v1, s[4:7], s44 offen offset:0 sc1 lds
buffer_load_dwordx4 v1, s[4:7], s44 offen offset:1024 sc1 lds
buffer_load_dwordx4 v1, s[4:7], s44 offen offset:2048 sc1 lds
buffer_load_dwordx4 v1, s[4:7], s44 offen offset:3072 sc1 lds
s_add_u32 m0, s19, 0x14000
s_add_u32 s44, s50, 0x3414000
s_add_u32 s44, s44, s18
buffer_load_dwordx4 v1, s[4:7], s44 offen offset:0 sc1 lds
buffer_load_dwordx4 v1, s[4:7], s44 offen offset:1024 sc1 lds
buffer_load_dwordx4 v1, s[4:7], s44 offen offset:2048 sc1 lds
buffer_load_dwordx4 v1, s[4:7], s44 offen offset:3072 sc1 lds
s_add_u32 m0, s19, 0x16000
s_add_u32 s44, s50, 0x3416000
s_add_u32 s44, s44, s18
buffer_load_dwordx4 v1, s[4:7], s44 offen offset:0 sc1 lds
buffer_load_dwordx4 v1, s[4:7], s44 offen offset:1024 sc1 lds
buffer_load_dwordx4 v1, s[4:7], s44 offen offset:2048 sc1 lds
buffer_load_dwordx4 v1, s[4:7], s44 offen offset:3072 sc1 lds
s_add_u32 m0, s19, 0x18000
s_add_u32 s44, s50, 0x3418000
s_add_u32 s44, s44, s18
buffer_load_dwordx4 v1, s[4:7], s44 offen offset:0 sc1 lds
buffer_load_dwordx4 v1, s[4:7], s44 offen offset:1024 sc1 lds
buffer_load_dwordx4 v1, s[4:7], s44 offen offset:2048 sc1 lds
buffer_load_dwordx4 v1, s[4:7], s44 offen offset:3072 sc1 lds
Lwd_40:
s_cmp_lg_u32 s28, 1
s_cbranch_scc1 Lpo_43
s_add_u32 s36, s34, 0x60000
s_mov_b32 s37, 0
v_mov_b32 v11, 0
buffer_atomic_add v11, v251, s[4:7], s36 offen sc0 sc1
s_sleep 4
Lpoll_41:
v_mov_b32 v234, 0
buffer_atomic_add v234, v251, s[4:7], s36 offen sc0 sc1
s_waitcnt vmcnt(1)
v_readfirstlane_b32 s38, v11
s_nop 0
s_cmp_ge_u32 s38, 32
s_cbranch_scc1 Lpe_42
v_mov_b32 v11, 0
buffer_atomic_add v11, v251, s[4:7], s36 offen sc0 sc1
s_waitcnt vmcnt(1)
v_readfirstlane_b32 s38, v234
s_nop 0
s_cmp_ge_u32 s38, 32
s_cbranch_scc1 Lpe_42
s_add_u32 s37, s37, 1
s_cmp_lt_u32 s37, 0x80000
s_cbranch_scc1 Lpoll_41
s_waitcnt vmcnt(0)
Lpo_43:
s_waitcnt vmcnt(32) lgkmcnt(0)
s_cmp_ge_u32 s28, 2
s_cbranch_scc1 Lw_44
s_waitcnt vmcnt(0)
Lw_44:
Lpe_42:
s_barrier
s_mov_b32 s35, 0
s_add_u32 s33, s35, 0x1000
buffer_load_dwordx4 a[0:3], v2, s[40:43], s35 offen offset:0 sc1
buffer_load_dwordx4 a[4:7], v2, s[40:43], s33 offen offset:0 sc1
buffer_load_dwordx4 a[8:11], v2, s[40:43], s35 offen offset:1024 sc1
buffer_load_dwordx4 a[12:15], v2, s[40:43], s33 offen offset:1024 sc1
buffer_load_dwordx4 a[16:19], v2, s[40:43], s35 offen offset:2048 sc1
buffer_load_dwordx4 a[20:23], v2, s[40:43], s33 offen offset:2048 sc1
buffer_load_dwordx4 a[24:27], v2, s[40:43], s35 offen offset:3072 sc1
buffer_load_dwordx4 a[28:31], v2, s[40:43], s33 offen offset:3072 sc1
s_add_u32 s35, s35, 0x4000
s_add_u32 s33, s33, 0x4000
buffer_load_dwordx4 a[32:35], v2, s[40:43], s35 offen offset:0 sc1
buffer_load_dwordx4 a[36:39], v2, s[40:43], s33 offen offset:0 sc1
buffer_load_dwordx4 a[40:43], v2, s[40:43], s35 offen offset:1024 sc1
buffer_load_dwordx4 a[44:47], v2, s[40:43], s33 offen offset:1024 sc1
buffer_load_dwordx4 a[48:51], v2, s[40:43], s35 offen offset:2048 sc1
buffer_load_dwordx4 a[52:55], v2, s[40:43], s33 offen offset:2048 sc1
buffer_load_dwordx4 a[56:59], v2, s[40:43], s35 offen offset:3072 sc1
buffer_load_dwordx4 a[60:63], v2, s[40:43], s33 offen offset:3072 sc1
s_add_u32 s35, s35, 0x4000
s_add_u32 s33, s33, 0x4000
v_add_u32 v5, 0, v1
ds_read_b128 a[96:99], v5 offset:2048
ds_read_b128 a[100:103], v5 offset:8192
ds_read_b128 a[104:107], v5 offset:3072
ds_read_b128 a[108:111], v5 offset:9216
ds_read_b128 a[112:115], v5 offset:4096
ds_read_b128 a[116:119], v5 offset:10240
s_waitcnt vmcnt(14) lgkmcnt(4)
v_mfma_f32_16x16x32_bf16 v[140:143], a[96:99], a[0:3], 0
s_add_u32 m0, s18, 0x1c000
s_add_u32 s44, s50, 0x341c000
v_mfma_f32_16x16x32_bf16 v[140:143], a[100:103], a[4:7], v[140:143]
buffer_load_dwordx4 a[64:67], v2, s[40:43], s35 offen offset:0 sc1
s_waitcnt vmcnt(13)
v_mfma_f32_16x16x32_bf16 v[164:167], a[100:103], a[12:15], 0
ds_read_b128 a[128:131], v5 offset:5120
v_mfma_f32_16x16x32_bf16 v[164:167], a[96:99], a[8:11], v[164:167]
ds_read_b128 a[132:135], v5 offset:11264
s_waitcnt vmcnt(12)
v_mfma_f32_16x16x32_bf16 v[188:191], a[96:99], a[16:19], 0
s_waitcnt vmcnt(11)
v_mfma_f32_16x16x32_bf16 v[188:191], a[100:103], a[20:23], v[188:191]
buffer_load_dwordx4 a[68:71], v2, s[40:43], s33 offen offset:0 sc1
s_waitcnt vmcnt(10)
v_mfma_f32_16x16x32_bf16 v[212:215], a[100:103], a[28:31], 0
ds_read_b128 a[136:139], v5 offset:0
v_mfma_f32_16x16x32_bf16 v[212:215], a[96:99], a[24:27], v[212:215]
s_waitcnt lgkmcnt(6)
v_mfma_f32_16x16x32_bf16 v[216:219], a[104:107], a[24:27], 0
ds_read_b128 a[140:143], v5 offset:6144
s_waitcnt lgkmcnt(6)
v_mfma_f32_16x16x32_bf16 v[216:219], a[108:111], a[28:31], v[216:219]
v_mfma_f32_16x16x32_bf16 v[192:195], a[108:111], a[20:23], 0
buffer_load_dwordx4 v1, s[4:7], s44 offen offset:0 sc1 lds
v_mfma_f32_16x16x32_bf16 v[192:195], a[104:107], a[16:19], v[192:195]
ds_read_b128 a[144:147], v5 offset:1024
v_mfma_f32_16x16x32_bf16 v[168:171], a[104:107], a[8:11], 0
v_mfma_f32_16x16x32_bf16 v[168:171], a[108:111], a[12:15], v[168:171]
ds_read_b128 a[148:151], v5 offset:7168
v_mfma_f32_16x16x32_bf16 v[144:147], a[108:111], a[4:7], 0
v_mfma_f32_16x16x32_bf16 v[144:147], a[104:107], a[0:3], v[144:147]
buffer_load_dwordx4 a[72:75], v2, s[40:43], s35 offen offset:1024 sc1
s_waitcnt lgkmcnt(7)
v_mfma_f32_16x16x32_bf16 v[148:151], a[112:115], a[0:3], 0
s_waitcnt lgkmcnt(6)
v_mfma_f32_16x16x32_bf16 v[148:151], a[116:119], a[4:7], v[148:151]
v_mfma_f32_16x16x32_bf16 v[172:175], a[116:119], a[12:15], 0
v_mfma_f32_16x16x32_bf16 v[172:175], a[112:115], a[8:11], v[172:175]
v_mfma_f32_16x16x32_bf16 v[196:199], a[112:115], a[16:19], 0
buffer_load_dwordx4 a[76:79], v2, s[40:43], s33 offen offset:1024 sc1
v_mfma_f32_16x16x32_bf16 v[196:199], a[116:119], a[20:23], v[196:199]
v_mfma_f32_16x16x32_bf16 v[220:223], a[116:119], a[28:31], 0
v_mfma_f32_16x16x32_bf16 v[220:223], a[112:115], a[24:27], v[220:223]
s_waitcnt lgkmcnt(0)
v_mfma_f32_16x16x32_bf16 v[224:227], a[128:131], a[24:27], 0
ds_read_b128 a[96:99], v5 offset:14336
v_mfma_f32_16x16x32_bf16 v[224:227], a[132:135], a[28:31], v[224:227]
buffer_load_dwordx4 a[80:83], v2, s[40:43], s35 offen offset:2048 sc1
v_mfma_f32_16x16x32_bf16 v[200:203], a[132:135], a[20:23], 0
ds_read_b128 a[100:103], v5 offset:20480
v_mfma_f32_16x16x32_bf16 v[200:203], a[128:131], a[16:19], v[200:203]
v_mfma_f32_16x16x32_bf16 v[176:179], a[128:131], a[8:11], 0
v_mfma_f32_16x16x32_bf16 v[176:179], a[132:135], a[12:15], v[176:179]
buffer_load_dwordx4 a[84:87], v2, s[40:43], s33 offen offset:2048 sc1
v_mfma_f32_16x16x32_bf16 v[152:155], a[132:135], a[4:7], 0
ds_read_b128 a[104:107], v5 offset:15360
v_mfma_f32_16x16x32_bf16 v[152:155], a[128:131], a[0:3], v[152:155]
v_mfma_f32_16x16x32_bf16 v[132:135], a[136:139], a[0:3], 0
ds_read_b128 a[108:111], v5 offset:21504
v_mfma_f32_16x16x32_bf16 v[132:135], a[140:143], a[4:7], v[132:135]
v_mfma_f32_16x16x32_bf16 v[156:159], a[140:143], a[12:15], 0
buffer_load_dwordx4 v1, s[4:7], s44 offen offset:1024 sc1 lds
s_add_u32 m0, s18, 0x1e000
v_mfma_f32_16x16x32_bf16 v[156:159], a[136:139], a[8:11], v[156:159]
s_add_u32 s44, s50, 0x341e000
ds_read_b128 a[112:115], v5 offset:16384
v_mfma_f32_16x16x32_bf16 v[180:183], a[136:139], a[16:19], 0
v_mfma_f32_16x16x32_bf16 v[180:183], a[140:143], a[20:23], v[180:183]
ds_read_b128 a[116:119], v5 offset:22528
v_mfma_f32_16x16x32_bf16 v[204:207], a[140:143], a[28:31], 0
v_mfma_f32_16x16x32_bf16 v[204:207], a[136:139], a[24:27], v[204:207]
buffer_load_dwordx4 a[88:91], v2, s[40:43], s35 offen offset:3072 sc1
v_mfma_f32_16x16x32_bf16 v[208:211], a[144:147], a[24:27], 0
v_mfma_f32_16x16x32_bf16 v[208:211], a[148:151], a[28:31], v[208:211]
v_mfma_f32_16x16x32_bf16 v[184:187], a[148:151], a[20:23], 0
v_mfma_f32_16x16x32_bf16 v[184:187], a[144:147], a[16:19], v[184:187]
v_mfma_f32_16x16x32_bf16 v[160:163], a[144:147], a[8:11], 0
buffer_load_dwordx4 a[92:95], v2, s[40:43], s33 offen offset:3072 sc1
s_add_u32 s35, s35, 0x4000
v_mfma_f32_16x16x32_bf16 v[160:163], a[148:151], a[12:15], v[160:163]
s_add_u32 s33, s33, 0x4000
v_mfma_f32_16x16x32_bf16 v[136:139], a[148:151], a[4:7], 0
v_mfma_f32_16x16x32_bf16 v[136:139], a[144:147], a[0:3], v[136:139]
s_waitcnt vmcnt(10) lgkmcnt(0)
v_mfma_f32_16x16x32_bf16 v[140:143], a[96:99], a[32:35], v[140:143]
ds_read_b128 a[128:131], v5 offset:17408
v_mfma_f32_16x16x32_bf16 v[140:143], a[100:103], a[36:39], v[140:143]
buffer_load_dwordx4 a[0:3], v2, s[40:43], s35 offen offset:0 sc1
v_mfma_f32_16x16x32_bf16 v[164:167], a[100:103], a[44:47], v[164:167]
ds_read_b128 a[132:135], v5 offset:23552
v_mfma_f32_16x16x32_bf16 v[164:167], a[96:99], a[40:43], v[164:167]
v_mfma_f32_16x16x32_bf16 v[188:191], a[96:99], a[48:51], v[188:191]
v_mfma_f32_16x16x32_bf16 v[188:191], a[100:103], a[52:55], v[188:191]
buffer_load_dwordx4 a[4:7], v2, s[40:43], s33 offen offset:0 sc1
v_mfma_f32_16x16x32_bf16 v[212:215], a[100:103], a[60:63], v[212:215]
ds_read_b128 a[136:139], v5 offset:12288
v_mfma_f32_16x16x32_bf16 v[212:215], a[96:99], a[56:59], v[212:215]
v_mfma_f32_16x16x32_bf16 v[216:219], a[104:107], a[56:59], v[216:219]
ds_read_b128 a[140:143], v5 offset:18432
v_mfma_f32_16x16x32_bf16 v[216:219], a[108:111], a[60:63], v[216:219]
v_mfma_f32_16x16x32_bf16 v[192:195], a[108:111], a[52:55], v[192:195]
buffer_load_dwordx4 v1, s[4:7], s44 offen offset:0 sc1 lds
v_mfma_f32_16x16x32_bf16 v[192:195], a[104:107], a[48:51], v[192:195]
ds_read_b128 a[144:147], v5 offset:13312
v_mfma_f32_16x16x32_bf16 v[168:171], a[104:107], a[40:43], v[168:171]
v_mfma_f32_16x16x32_bf16 v[168:171], a[108:111], a[44:47], v[168:171]
ds_read_b128 a[148:151], v5 offset:19456
v_mfma_f32_16x16x32_bf16 v[144:147], a[108:111], a[36:39], v[144:147]
v_mfma_f32_16x16x32_bf16 v[144:147], a[104:107], a[32:35], v[144:147]
buffer_load_dwordx4 a[8:11], v2, s[40:43], s35 offen offset:1024 sc1
v_mfma_f32_16x16x32_bf16 v[148:151], a[112:115], a[32:35], v[148:151]
v_mfma_f32_16x16x32_bf16 v[148:151], a[116:119], a[36:39], v[148:151]
v_mfma_f32_16x16x32_bf16 v[172:175], a[116:119], a[44:47], v[172:175]
v_mfma_f32_16x16x32_bf16 v[172:175], a[112:115], a[40:43], v[172:175]
v_mfma_f32_16x16x32_bf16 v[196:199], a[112:115], a[48:51], v[196:199]
buffer_load_dwordx4 a[12:15], v2, s[40:43], s33 offen offset:1024 sc1
v_mfma_f32_16x16x32_bf16 v[196:199], a[116:119], a[52:55], v[196:199]
v_mfma_f32_16x16x32_bf16 v[220:223], a[116:119], a[60:63], v[220:223]
v_mfma_f32_16x16x32_bf16 v[220:223], a[112:115], a[56:59], v[220:223]
s_waitcnt lgkmcnt(0)
v_mfma_f32_16x16x32_bf16 v[224:227], a[128:131], a[56:59], v[224:227]
ds_read_b128 a[96:99], v5 offset:26624
v_mfma_f32_16x16x32_bf16 v[224:227], a[132:135], a[60:63], v[224:227]
buffer_load_dwordx4 a[16:19], v2, s[40:43], s35 offen offset:2048 sc1
v_mfma_f32_16x16x32_bf16 v[200:203], a[132:135], a[52:55], v[200:203]
ds_read_b128 a[100:103], v5 offset:32768
v_mfma_f32_16x16x32_bf16 v[200:203], a[128:131], a[48:51], v[200:203]
v_mfma_f32_16x16x32_bf16 v[176:179], a[128:131], a[40:43], v[176:179]
v_mfma_f32_16x16x32_bf16 v[176:179], a[132:135], a[44:47], v[176:179]
buffer_load_dwordx4 v1, s[4:7], s44 offen offset:1024 sc1 lds
s_add_u32 m0, s18, 0x20000
v_mfma_f32_16x16x32_bf16 v[152:155], a[132:135], a[36:39], v[152:155]
s_add_u32 s44, s50, 0x3420000
ds_read_b128 a[104:107], v5 offset:27648
v_mfma_f32_16x16x32_bf16 v[152:155], a[128:131], a[32:35], v[152:155]
v_mfma_f32_16x16x32_bf16 v[132:135], a[136:139], a[32:35], v[132:135]
ds_read_b128 a[108:111], v5 offset:33792
v_mfma_f32_16x16x32_bf16 v[132:135], a[140:143], a[36:39], v[132:135]
buffer_load_dwordx4 a[20:23], v2, s[40:43], s33 offen offset:2048 sc1
v_mfma_f32_16x16x32_bf16 v[156:159], a[140:143], a[44:47], v[156:159]
ds_read_b128 a[112:115], v5 offset:28672
v_mfma_f32_16x16x32_bf16 v[156:159], a[136:139], a[40:43], v[156:159]
v_mfma_f32_16x16x32_bf16 v[180:183], a[136:139], a[48:51], v[180:183]
v_mfma_f32_16x16x32_bf16 v[180:183], a[140:143], a[52:55], v[180:183]
buffer_load_dwordx4 a[24:27], v2, s[40:43], s35 offen offset:3072 sc1
v_mfma_f32_16x16x32_bf16 v[204:207], a[140:143], a[60:63], v[204:207]
ds_read_b128 a[116:119], v5 offset:34816
v_mfma_f32_16x16x32_bf16 v[204:207], a[136:139], a[56:59], v[204:207]
v_mfma_f32_16x16x32_bf16 v[208:211], a[144:147], a[56:59], v[208:211]
v_mfma_f32_16x16x32_bf16 v[208:211], a[148:151], a[60:63], v[208:211]
buffer_load_dwordx4 v1, s[4:7], s44 offen offset:0 sc1 lds
v_mfma_f32_16x16x32_bf16 v[184:187], a[148:151], a[52:55], v[184:187]
v_mfma_f32_16x16x32_bf16 v[184:187], a[144:147], a[48:51], v[184:187]
v_mfma_f32_16x16x32_bf16 v[160:163], a[144:147], a[40:43], v[160:163]
v_mfma_f32_16x16x32_bf16 v[160:163], a[148:151], a[44:47], v[160:163]
buffer_load_dwordx4 a[28:31], v2, s[40:43], s33 offen offset:3072 sc1
s_add_u32 s35, s35, 0x4000
v_mfma_f32_16x16x32_bf16 v[136:139], a[148:151], a[36:39], v[136:139]
s_add_u32 s33, s33, 0x4000
v_mfma_f32_16x16x32_bf16 v[136:139], a[144:147], a[32:35], v[136:139]
s_waitcnt vmcnt(11) lgkmcnt(0)
v_mfma_f32_16x16x32_bf16 v[140:143], a[96:99], a[64:67], v[140:143]
ds_read_b128 a[128:131], v5 offset:29696
v_mfma_f32_16x16x32_bf16 v[140:143], a[100:103], a[68:71], v[140:143]
buffer_load_dwordx4 a[32:35], v2, s[40:43], s35 offen offset:0 sc1
v_mfma_f32_16x16x32_bf16 v[164:167], a[100:103], a[76:79], v[164:167]
ds_read_b128 a[132:135], v5 offset:35840
v_mfma_f32_16x16x32_bf16 v[164:167], a[96:99], a[72:75], v[164:167]
v_mfma_f32_16x16x32_bf16 v[188:191], a[96:99], a[80:83], v[188:191]
v_mfma_f32_16x16x32_bf16 v[188:191], a[100:103], a[84:87], v[188:191]
buffer_load_dwordx4 a[36:39], v2, s[40:43], s33 offen offset:0 sc1
v_mfma_f32_16x16x32_bf16 v[212:215], a[100:103], a[92:95], v[212:215]
ds_read_b128 a[136:139], v5 offset:24576
v_mfma_f32_16x16x32_bf16 v[212:215], a[96:99], a[88:91], v[212:215]
v_mfma_f32_16x16x32_bf16 v[216:219], a[104:107], a[88:91], v[216:219]
ds_read_b128 a[140:143], v5 offset:30720
v_mfma_f32_16x16x32_bf16 v[216:219], a[108:111], a[92:95], v[216:219]
v_mfma_f32_16x16x32_bf16 v[192:195], a[108:111], a[84:87], v[192:195]
buffer_load_dwordx4 v1, s[4:7], s44 offen offset:1024 sc1 lds
s_add_u32 m0, s18, 0x22000
v_mfma_f32_16x16x32_bf16 v[192:195], a[104:107], a[80:83], v[192:195]
s_add_u32 s44, s50, 0x3422000
ds_read_b128 a[144:147], v5 offset:25600
v_mfma_f32_16x16x32_bf16 v[168:171], a[104:107], a[72:75], v[168:171]
v_mfma_f32_16x16x32_bf16 v[168:171], a[108:111], a[76:79], v[168:171]
ds_read_b128 a[148:151], v5 offset:31744
v_mfma_f32_16x16x32_bf16 v[144:147], a[108:111], a[68:71], v[144:147]
v_mfma_f32_16x16x32_bf16 v[144:147], a[104:107], a[64:67], v[144:147]
buffer_load_dwordx4 a[40:43], v2, s[40:43], s35 offen offset:1024 sc1
v_mfma_f32_16x16x32_bf16 v[148:151], a[112:115], a[64:67], v[148:151]
v_mfma_f32_16x16x32_bf16 v[148:151], a[116:119], a[68:71], v[148:151]
v_mfma_f32_16x16x32_bf16 v[172:175], a[116:119], a[76:79], v[172:175]
v_mfma_f32_16x16x32_bf16 v[172:175], a[112:115], a[72:75], v[172:175]
v_mfma_f32_16x16x32_bf16 v[196:199], a[112:115], a[80:83], v[196:199]
buffer_load_dwordx4 a[44:47], v2, s[40:43], s33 offen offset:1024 sc1
v_mfma_f32_16x16x32_bf16 v[196:199], a[116:119], a[84:87], v[196:199]
v_mfma_f32_16x16x32_bf16 v[220:223], a[116:119], a[92:95], v[220:223]
v_mfma_f32_16x16x32_bf16 v[220:223], a[112:115], a[88:91], v[220:223]
s_waitcnt lgkmcnt(0)
v_mfma_f32_16x16x32_bf16 v[224:227], a[128:131], a[88:91], v[224:227]
ds_read_b128 a[96:99], v5 offset:38912
v_mfma_f32_16x16x32_bf16 v[224:227], a[132:135], a[92:95], v[224:227]
buffer_load_dwordx4 a[48:51], v2, s[40:43], s35 offen offset:2048 sc1
v_mfma_f32_16x16x32_bf16 v[200:203], a[132:135], a[84:87], v[200:203]
ds_read_b128 a[100:103], v5 offset:45056
v_mfma_f32_16x16x32_bf16 v[200:203], a[128:131], a[80:83], v[200:203]
v_mfma_f32_16x16x32_bf16 v[176:179], a[128:131], a[72:75], v[176:179]
v_mfma_f32_16x16x32_bf16 v[176:179], a[132:135], a[76:79], v[176:179]
buffer_load_dwordx4 a[52:55], v2, s[40:43], s33 offen offset:2048 sc1
v_mfma_f32_16x16x32_bf16 v[152:155], a[132:135], a[68:71], v[152:155]
ds_read_b128 a[104:107], v5 offset:39936
v_mfma_f32_16x16x32_bf16 v[152:155], a[128:131], a[64:67], v[152:155]
v_mfma_f32_16x16x32_bf16 v[132:135], a[136:139], a[64:67], v[132:135]
ds_read_b128 a[108:111], v5 offset:46080
v_mfma_f32_16x16x32_bf16 v[132:135], a[140:143], a[68:71], v[132:135]
L_stub15:
s_cbranch_execz L_stub16
v_mfma_f32_16x16x32_bf16 v[156:159], a[140:143], a[76:79], v[156:159]
buffer_load_dwordx4 v1, s[4:7], s44 offen offset:0 sc1 lds
v_mfma_f32_16x16x32_bf16 v[156:159], a[136:139], a[72:75], v[156:159]
ds_read_b128 a[112:115], v5 offset:40960
v_mfma_f32_16x16x32_bf16 v[180:183], a[136:139], a[80:83], v[180:183]
v_mfma_f32_16x16x32_bf16 v[180:183], a[140:143], a[84:87], v[180:183]
ds_read_b128 a[116:119], v5 offset:47104
v_mfma_f32_16x16x32_bf16 v[204:207], a[140:143], a[92:95], v[204:207]
v_mfma_f32_16x16x32_bf16 v[204:207], a[136:139], a[88:91], v[204:207]
buffer_load_dwordx4 a[56:59], v2, s[40:43], s35 offen offset:3072 sc1
v_mfma_f32_16x16x32_bf16 v[208:211], a[144:147], a[88:91], v[208:211]
v_mfma_f32_16x16x32_bf16 v[208:211], a[148:151], a[92:95], v[208:211]
v_mfma_f32_16x16x32_bf16 v[184:187], a[148:151], a[84:87], v[184:187]
v_mfma_f32_16x16x32_bf16 v[184:187], a[144:147], a[80:83], v[184:187]
v_mfma_f32_16x16x32_bf16 v[160:163], a[144:147], a[72:75], v[160:163]
buffer_load_dwordx4 a[60:63], v2, s[40:43], s33 offen offset:3072 sc1
s_add_u32 s35, s35, 0x4000
v_mfma_f32_16x16x32_bf16 v[160:163], a[148:151], a[76:79], v[160:163]
s_add_u32 s33, s33, 0x4000
v_mfma_f32_16x16x32_bf16 v[136:139], a[148:151], a[68:71], v[136:139]
v_mfma_f32_16x16x32_bf16 v[136:139], a[144:147], a[64:67], v[136:139]
s_waitcnt vmcnt(10) lgkmcnt(0)
v_mfma_f32_16x16x32_bf16 v[140:143], a[96:99], a[0:3], v[140:143]
ds_read_b128 a[128:131], v5 offset:41984
v_mfma_f32_16x16x32_bf16 v[140:143], a[100:103], a[4:7], v[140:143]
buffer_load_dwordx4 a[64:67], v2, s[40:43], s35 offen offset:0 sc1
v_mfma_f32_16x16x32_bf16 v[164:167], a[100:103], a[12:15], v[164:167]
ds_read_b128 a[132:135], v5 offset:48128
v_mfma_f32_16x16x32_bf16 v[164:167], a[96:99], a[8:11], v[164:167]
v_mfma_f32_16x16x32_bf16 v[188:191], a[96:99], a[16:19], v[188:191]
v_mfma_f32_16x16x32_bf16 v[188:191], a[100:103], a[20:23], v[188:191]
buffer_load_dwordx4 a[68:71], v2, s[40:43], s33 offen offset:0 sc1
v_mfma_f32_16x16x32_bf16 v[212:215], a[100:103], a[28:31], v[212:215]
ds_read_b128 a[136:139], v5 offset:36864
v_mfma_f32_16x16x32_bf16 v[212:215], a[96:99], a[24:27], v[212:215]
v_mfma_f32_16x16x32_bf16 v[216:219], a[104:107], a[24:27], v[216:219]
ds_read_b128 a[140:143], v5 offset:43008
v_mfma_f32_16x16x32_bf16 v[216:219], a[108:111], a[28:31], v[216:219]
v_mfma_f32_16x16x32_bf16 v[192:195], a[108:111], a[20:23], v[192:195]
buffer_load_dwordx4 v1, s[4:7], s44 offen offset:1024 sc1 lds
s_add_u32 s88, s82, 0x2c0000
v_mfma_f32_16x16x32_bf16 v[192:195], a[104:107], a[16:19], v[192:195]
ds_read_b128 a[144:147], v5 offset:37888
v_mfma_f32_16x16x32_bf16 v[168:171], a[104:107], a[8:11], v[168:171]
v_mfma_f32_16x16x32_bf16 v[168:171], a[108:111], a[12:15], v[168:171]
ds_read_b128 a[148:151], v5 offset:44032
v_mfma_f32_16x16x32_bf16 v[144:147], a[108:111], a[4:7], v[144:147]
v_mfma_f32_16x16x32_bf16 v[144:147], a[104:107], a[0:3], v[144:147]
buffer_load_dwordx4 a[72:75], v2, s[40:43], s35 offen offset:1024 sc1
v_mfma_f32_16x16x32_bf16 v[148:151], a[112:115], a[0:3], v[148:151]
v_mfma_f32_16x16x32_bf16 v[148:151], a[116:119], a[4:7], v[148:151]
v_mfma_f32_16x16x32_bf16 v[172:175], a[116:119], a[12:15], v[172:175]
v_mfma_f32_16x16x32_bf16 v[172:175], a[112:115], a[8:11], v[172:175]
v_mfma_f32_16x16x32_bf16 v[196:199], a[112:115], a[16:19], v[196:199]
buffer_load_dwordx4 a[76:79], v2, s[40:43], s33 offen offset:1024 sc1
v_mfma_f32_16x16x32_bf16 v[196:199], a[116:119], a[20:23], v[196:199]
v_mfma_f32_16x16x32_bf16 v[220:223], a[116:119], a[28:31], v[220:223]
v_mfma_f32_16x16x32_bf16 v[220:223], a[112:115], a[24:27], v[220:223]
s_waitcnt lgkmcnt(0)
s_barrier
v_mfma_f32_16x16x32_bf16 v[224:227], a[128:131], a[24:27], v[224:227]
v_add_u32 v5, 49152, v1
v_mfma_f32_16x16x32_bf16 v[224:227], a[132:135], a[28:31], v[224:227]
buffer_load_dwordx4 a[80:83], v2, s[40:43], s35 offen offset:2048 sc1
v_mfma_f32_16x16x32_bf16 v[200:203], a[132:135], a[20:23], v[200:203]
ds_read_b128 a[96:99], v5 offset:2048
v_mfma_f32_16x16x32_bf16 v[200:203], a[128:131], a[16:19], v[200:203]
ds_read_b128 a[100:103], v5 offset:8192
v_mfma_f32_16x16x32_bf16 v[176:179], a[128:131], a[8:11], v[176:179]
v_mfma_f32_16x16x32_bf16 v[176:179], a[132:135], a[12:15], v[176:179]
buffer_load_dwordx4 a[84:87], v2, s[40:43], s33 offen offset:2048 sc1
v_mfma_f32_16x16x32_bf16 v[152:155], a[132:135], a[4:7], v[152:155]
ds_read_b128 a[104:107], v5 offset:3072
v_mfma_f32_16x16x32_bf16 v[152:155], a[128:131], a[0:3], v[152:155]
v_mfma_f32_16x16x32_bf16 v[132:135], a[136:139], a[0:3], v[132:135]
ds_read_b128 a[108:111], v5 offset:9216
v_mfma_f32_16x16x32_bf16 v[132:135], a[140:143], a[4:7], v[132:135]
v_mfma_f32_16x16x32_bf16 v[156:159], a[140:143], a[12:15], v[156:159]
buffer_load_dwordx4 v[92:95], v1, s[4:7], s88 offen offset:0 sc1
v_mfma_f32_16x16x32_bf16 v[156:159], a[136:139], a[8:11], v[156:159]
ds_read_b128 a[112:115], v5 offset:4096
v_mfma_f32_16x16x32_bf16 v[180:183], a[136:139], a[16:19], v[180:183]
v_mfma_f32_16x16x32_bf16 v[180:183], a[140:143], a[20:23], v[180:183]
ds_read_b128 a[116:119], v5 offset:10240
v_mfma_f32_16x16x32_bf16 v[204:207], a[140:143], a[28:31], v[204:207]
v_mfma_f32_16x16x32_bf16 v[204:207], a[136:139], a[24:27], v[204:207]
buffer_load_dwordx4 a[88:91], v2, s[40:43], s35 offen offset:3072 sc1
v_mfma_f32_16x16x32_bf16 v[208:211], a[144:147], a[24:27], v[208:211]
v_mfma_f32_16x16x32_bf16 v[208:211], a[148:151], a[28:31], v[208:211]
v_mfma_f32_16x16x32_bf16 v[184:187], a[148:151], a[20:23], v[184:187]
v_mfma_f32_16x16x32_bf16 v[184:187], a[144:147], a[16:19], v[184:187]
v_mfma_f32_16x16x32_bf16 v[160:163], a[144:147], a[8:11], v[160:163]
buffer_load_dwordx4 a[92:95], v2, s[40:43], s33 offen offset:3072 sc1
s_add_u32 s35, s35, 0x4000
v_mfma_f32_16x16x32_bf16 v[160:163], a[148:151], a[12:15], v[160:163]
s_add_u32 s33, s33, 0x4000
v_mfma_f32_16x16x32_bf16 v[136:139], a[148:151], a[4:7], v[136:139]
v_mfma_f32_16x16x32_bf16 v[136:139], a[144:147], a[0:3], v[136:139]
s_waitcnt vmcnt(10) lgkmcnt(0)
v_mfma_f32_16x16x32_bf16 v[140:143], a[96:99], a[32:35], v[140:143]
ds_read_b128 a[128:131], v5 offset:5120
v_mfma_f32_16x16x32_bf16 v[140:143], a[100:103], a[36:39], v[140:143]
buffer_load_dwordx4 a[0:3], v2, s[40:43], s35 offen offset:0 sc1
v_mfma_f32_16x16x32_bf16 v[164:167], a[100:103], a[44:47], v[164:167]
ds_read_b128 a[132:135], v5 offset:11264
v_mfma_f32_16x16x32_bf16 v[164:167], a[96:99], a[40:43], v[164:167]
v_mfma_f32_16x16x32_bf16 v[188:191], a[96:99], a[48:51], v[188:191]
v_mfma_f32_16x16x32_bf16 v[188:191], a[100:103], a[52:55], v[188:191]
buffer_load_dwordx4 a[4:7], v2, s[40:43], s33 offen offset:0 sc1
v_mfma_f32_16x16x32_bf16 v[212:215], a[100:103], a[60:63], v[212:215]
ds_read_b128 a[136:139], v5 offset:0
v_mfma_f32_16x16x32_bf16 v[212:215], a[96:99], a[56:59], v[212:215]
v_mfma_f32_16x16x32_bf16 v[216:219], a[104:107], a[56:59], v[216:219]
ds_read_b128 a[140:143], v5 offset:6144
v_mfma_f32_16x16x32_bf16 v[216:219], a[108:111], a[60:63], v[216:219]
v_mfma_f32_16x16x32_bf16 v[192:195], a[108:111], a[52:55], v[192:195]
buffer_load_dwordx4 v[96:99], v1, s[4:7], s88 offen offset:1024 sc1
v_mfma_f32_16x16x32_bf16 v[192:195], a[104:107], a[48:51], v[192:195]
ds_read_b128 a[144:147], v5 offset:1024
v_mfma_f32_16x16x32_bf16 v[168:171], a[104:107], a[40:43], v[168:171]
v_mfma_f32_16x16x32_bf16 v[168:171], a[108:111], a[44:47], v[168:171]
ds_read_b128 a[148:151], v5 offset:7168
v_mfma_f32_16x16x32_bf16 v[144:147], a[108:111], a[36:39], v[144:147]
v_mfma_f32_16x16x32_bf16 v[144:147], a[104:107], a[32:35], v[144:147]
buffer_load_dwordx4 a[8:11], v2, s[40:43], s35 offen offset:1024 sc1
v_mfma_f32_16x16x32_bf16 v[148:151], a[112:115], a[32:35], v[148:151]
v_mfma_f32_16x16x32_bf16 v[148:151], a[116:119], a[36:39], v[148:151]
v_mfma_f32_16x16x32_bf16 v[172:175], a[116:119], a[44:47], v[172:175]
v_mfma_f32_16x16x32_bf16 v[172:175], a[112:115], a[40:43], v[172:175]
v_mfma_f32_16x16x32_bf16 v[196:199], a[112:115], a[48:51], v[196:199]
buffer_load_dwordx4 a[12:15], v2, s[40:43], s33 offen offset:1024 sc1
v_mfma_f32_16x16x32_bf16 v[196:199], a[116:119], a[52:55], v[196:199]
v_mfma_f32_16x16x32_bf16 v[220:223], a[116:119], a[60:63], v[220:223]
v_mfma_f32_16x16x32_bf16 v[220:223], a[112:115], a[56:59], v[220:223]
s_waitcnt lgkmcnt(0)
v_mfma_f32_16x16x32_bf16 v[224:227], a[128:131], a[56:59], v[224:227]
ds_read_b128 a[96:99], v5 offset:14336
v_mfma_f32_16x16x32_bf16 v[224:227], a[132:135], a[60:63], v[224:227]
buffer_load_dwordx4 a[16:19], v2, s[40:43], s35 offen offset:2048 sc1
v_mfma_f32_16x16x32_bf16 v[200:203], a[132:135], a[52:55], v[200:203]
ds_read_b128 a[100:103], v5 offset:20480
v_mfma_f32_16x16x32_bf16 v[200:203], a[128:131], a[48:51], v[200:203]
v_mfma_f32_16x16x32_bf16 v[176:179], a[128:131], a[40:43], v[176:179]
v_mfma_f32_16x16x32_bf16 v[176:179], a[132:135], a[44:47], v[176:179]
buffer_load_dwordx4 v[100:103], v1, s[4:7], s88 offen offset:2048 sc1
v_mfma_f32_16x16x32_bf16 v[152:155], a[132:135], a[36:39], v[152:155]
ds_read_b128 a[104:107], v5 offset:15360
v_mfma_f32_16x16x32_bf16 v[152:155], a[128:131], a[32:35], v[152:155]
v_mfma_f32_16x16x32_bf16 v[132:135], a[136:139], a[32:35], v[132:135]
ds_read_b128 a[108:111], v5 offset:21504
v_mfma_f32_16x16x32_bf16 v[132:135], a[140:143], a[36:39], v[132:135]
buffer_load_dwordx4 a[20:23], v2, s[40:43], s33 offen offset:2048 sc1
v_mfma_f32_16x16x32_bf16 v[156:159], a[140:143], a[44:47], v[156:159]
ds_read_b128 a[112:115], v5 offset:16384
v_mfma_f32_16x16x32_bf16 v[156:159], a[136:139], a[40:43], v[156:159]
v_mfma_f32_16x16x32_bf16 v[180:183], a[136:139], a[48:51], v[180:183]
v_mfma_f32_16x16x32_bf16 v[180:183], a[140:143], a[52:55], v[180:183]
buffer_load_dwordx4 a[24:27], v2, s[40:43], s35 offen offset:3072 sc1
v_mfma_f32_16x16x32_bf16 v[204:207], a[140:143], a[60:63], v[204:207]
ds_read_b128 a[116:119], v5 offset:22528
v_mfma_f32_16x16x32_bf16 v[204:207], a[136:139], a[56:59], v[204:207]
v_mfma_f32_16x16x32_bf16 v[208:211], a[144:147], a[56:59], v[208:211]
v_mfma_f32_16x16x32_bf16 v[208:211], a[148:151], a[60:63], v[208:211]
buffer_load_dwordx4 v[104:107], v1, s[4:7], s88 offen offset:3072 sc1
s_add_u32 s88, s88, 4096
v_mfma_f32_16x16x32_bf16 v[184:187], a[148:151], a[52:55], v[184:187]
v_mfma_f32_16x16x32_bf16 v[184:187], a[144:147], a[48:51], v[184:187]
v_mfma_f32_16x16x32_bf16 v[160:163], a[144:147], a[40:43], v[160:163]
v_mfma_f32_16x16x32_bf16 v[160:163], a[148:151], a[44:47], v[160:163]
buffer_load_dwordx4 a[28:31], v2, s[40:43], s33 offen offset:3072 sc1
s_add_u32 s35, s35, 0x4000
v_mfma_f32_16x16x32_bf16 v[136:139], a[148:151], a[36:39], v[136:139]
s_add_u32 s33, s33, 0x4000
v_mfma_f32_16x16x32_bf16 v[136:139], a[144:147], a[32:35], v[136:139]
s_waitcnt vmcnt(11) lgkmcnt(0)
v_mfma_f32_16x16x32_bf16 v[140:143], a[96:99], a[64:67], v[140:143]
ds_read_b128 a[128:131], v5 offset:17408
v_mfma_f32_16x16x32_bf16 v[140:143], a[100:103], a[68:71], v[140:143]
buffer_load_dwordx4 a[32:35], v2, s[40:43], s35 offen offset:0 sc1
v_mfma_f32_16x16x32_bf16 v[164:167], a[100:103], a[76:79], v[164:167]
ds_read_b128 a[132:135], v5 offset:23552
v_mfma_f32_16x16x32_bf16 v[164:167], a[96:99], a[72:75], v[164:167]
v_mfma_f32_16x16x32_bf16 v[188:191], a[96:99], a[80:83], v[188:191]
v_mfma_f32_16x16x32_bf16 v[188:191], a[100:103], a[84:87], v[188:191]
buffer_load_dwordx4 a[36:39], v2, s[40:43], s33 offen offset:0 sc1
v_mfma_f32_16x16x32_bf16 v[212:215], a[100:103], a[92:95], v[212:215]
ds_read_b128 a[136:139], v5 offset:12288
v_mfma_f32_16x16x32_bf16 v[212:215], a[96:99], a[88:91], v[212:215]
v_mfma_f32_16x16x32_bf16 v[216:219], a[104:107], a[88:91], v[216:219]
ds_read_b128 a[140:143], v5 offset:18432
v_mfma_f32_16x16x32_bf16 v[216:219], a[108:111], a[92:95], v[216:219]
v_mfma_f32_16x16x32_bf16 v[192:195], a[108:111], a[84:87], v[192:195]
buffer_load_dwordx4 v[108:111], v1, s[4:7], s88 offen offset:0 sc1
v_mfma_f32_16x16x32_bf16 v[192:195], a[104:107], a[80:83], v[192:195]
ds_read_b128 a[144:147], v5 offset:13312
v_mfma_f32_16x16x32_bf16 v[168:171], a[104:107], a[72:75], v[168:171]
v_mfma_f32_16x16x32_bf16 v[168:171], a[108:111], a[76:79], v[168:171]
ds_read_b128 a[148:151], v5 offset:19456
v_mfma_f32_16x16x32_bf16 v[144:147], a[108:111], a[68:71], v[144:147]
v_mfma_f32_16x16x32_bf16 v[144:147], a[104:107], a[64:67], v[144:147]
buffer_load_dwordx4 a[40:43], v2, s[40:43], s35 offen offset:1024 sc1
v_mfma_f32_16x16x32_bf16 v[148:151], a[112:115], a[64:67], v[148:151]
v_mfma_f32_16x16x32_bf16 v[148:151], a[116:119], a[68:71], v[148:151]
v_mfma_f32_16x16x32_bf16 v[172:175], a[116:119], a[76:79], v[172:175]
v_mfma_f32_16x16x32_bf16 v[172:175], a[112:115], a[72:75], v[172:175]
v_mfma_f32_16x16x32_bf16 v[196:199], a[112:115], a[80:83], v[196:199]
buffer_load_dwordx4 a[44:47], v2, s[40:43], s33 offen offset:1024 sc1
v_mfma_f32_16x16x32_bf16 v[196:199], a[116:119], a[84:87], v[196:199]
v_mfma_f32_16x16x32_bf16 v[220:223], a[116:119], a[92:95], v[220:223]
v_mfma_f32_16x16x32_bf16 v[220:223], a[112:115], a[88:91], v[220:223]
s_waitcnt lgkmcnt(0)
v_mfma_f32_16x16x32_bf16 v[224:227], a[128:131], a[88:91], v[224:227]
ds_read_b128 a[96:99], v5 offset:26624
v_mfma_f32_16x16x32_bf16 v[224:227], a[132:135], a[92:95], v[224:227]
buffer_load_dwordx4 a[48:51], v2, s[40:43], s35 offen offset:2048 sc1
v_mfma_f32_16x16x32_bf16 v[200:203], a[132:135], a[84:87], v[200:203]
ds_read_b128 a[100:103], v5 offset:32768
v_mfma_f32_16x16x32_bf16 v[200:203], a[128:131], a[80:83], v[200:203]
v_mfma_f32_16x16x32_bf16 v[176:179], a[128:131], a[72:75], v[176:179]
v_mfma_f32_16x16x32_bf16 v[176:179], a[132:135], a[76:79], v[176:179]
buffer_load_dwordx4 a[52:55], v2, s[40:43], s33 offen offset:2048 sc1
v_mfma_f32_16x16x32_bf16 v[152:155], a[132:135], a[68:71], v[152:155]
ds_read_b128 a[104:107], v5 offset:27648
v_mfma_f32_16x16x32_bf16 v[152:155], a[128:131], a[64:67], v[152:155]
v_mfma_f32_16x16x32_bf16 v[132:135], a[136:139], a[64:67], v[132:135]
ds_read_b128 a[108:111], v5 offset:33792
v_mfma_f32_16x16x32_bf16 v[132:135], a[140:143], a[68:71], v[132:135]
v_mfma_f32_16x16x32_bf16 v[156:159], a[140:143], a[76:79], v[156:159]
buffer_load_dwordx4 v[112:115], v1, s[4:7], s88 offen offset:1024 sc1
v_mfma_f32_16x16x32_bf16 v[156:159], a[136:139], a[72:75], v[156:159]
ds_read_b128 a[112:115], v5 offset:28672
v_mfma_f32_16x16x32_bf16 v[180:183], a[136:139], a[80:83], v[180:183]
v_mfma_f32_16x16x32_bf16 v[180:183], a[140:143], a[84:87], v[180:183]
ds_read_b128 a[116:119], v5 offset:34816
v_mfma_f32_16x16x32_bf16 v[204:207], a[140:143], a[92:95], v[204:207]
v_mfma_f32_16x16x32_bf16 v[204:207], a[136:139], a[88:91], v[204:207]
buffer_load_dwordx4 a[56:59], v2, s[40:43], s35 offen offset:3072 sc1
v_mfma_f32_16x16x32_bf16 v[208:211], a[144:147], a[88:91], v[208:211]
v_mfma_f32_16x16x32_bf16 v[208:211], a[148:151], a[92:95], v[208:211]
v_mfma_f32_16x16x32_bf16 v[184:187], a[148:151], a[84:87], v[184:187]
v_mfma_f32_16x16x32_bf16 v[184:187], a[144:147], a[80:83], v[184:187]
v_mfma_f32_16x16x32_bf16 v[160:163], a[144:147], a[72:75], v[160:163]
buffer_load_dwordx4 a[60:63], v2, s[40:43], s33 offen offset:3072 sc1
s_add_u32 s35, s35, 0x64000
v_mfma_f32_16x16x32_bf16 v[160:163], a[148:151], a[76:79], v[160:163]
s_add_u32 s33, s33, 0x64000
v_mfma_f32_16x16x32_bf16 v[136:139], a[148:151], a[68:71], v[136:139]
v_mfma_f32_16x16x32_bf16 v[136:139], a[144:147], a[64:67], v[136:139]
s_waitcnt vmcnt(10) lgkmcnt(0)
v_mfma_f32_16x16x32_bf16 v[140:143], a[96:99], a[0:3], v[140:143]
ds_read_b128 a[128:131], v5 offset:29696
v_mfma_f32_16x16x32_bf16 v[140:143], a[100:103], a[4:7], v[140:143]
buffer_load_dwordx4 a[64:67], v2, s[40:43], s35 offen offset:0 sc1
v_mfma_f32_16x16x32_bf16 v[164:167], a[100:103], a[12:15], v[164:167]
ds_read_b128 a[132:135], v5 offset:35840
v_mfma_f32_16x16x32_bf16 v[164:167], a[96:99], a[8:11], v[164:167]
v_mfma_f32_16x16x32_bf16 v[188:191], a[96:99], a[16:19], v[188:191]
v_mfma_f32_16x16x32_bf16 v[188:191], a[100:103], a[20:23], v[188:191]
buffer_load_dwordx4 a[68:71], v2, s[40:43], s33 offen offset:0 sc1
v_mfma_f32_16x16x32_bf16 v[212:215], a[100:103], a[28:31], v[212:215]
ds_read_b128 a[136:139], v5 offset:24576
v_mfma_f32_16x16x32_bf16 v[212:215], a[96:99], a[24:27], v[212:215]
v_mfma_f32_16x16x32_bf16 v[216:219], a[104:107], a[24:27], v[216:219]
ds_read_b128 a[140:143], v5 offset:30720
v_mfma_f32_16x16x32_bf16 v[216:219], a[108:111], a[28:31], v[216:219]
v_mfma_f32_16x16x32_bf16 v[192:195], a[108:111], a[20:23], v[192:195]
buffer_load_dwordx4 v[116:119], v1, s[4:7], s88 offen offset:2048 sc1
v_mfma_f32_16x16x32_bf16 v[192:195], a[104:107], a[16:19], v[192:195]
ds_read_b128 a[144:147], v5 offset:25600
v_mfma_f32_16x16x32_bf16 v[168:171], a[104:107], a[8:11], v[168:171]
v_mfma_f32_16x16x32_bf16 v[168:171], a[108:111], a[12:15], v[168:171]
ds_read_b128 a[148:151], v5 offset:31744
v_mfma_f32_16x16x32_bf16 v[144:147], a[108:111], a[4:7], v[144:147]
v_mfma_f32_16x16x32_bf16 v[144:147], a[104:107], a[0:3], v[144:147]
buffer_load_dwordx4 a[72:75], v2, s[40:43], s35 offen offset:1024 sc1
v_mfma_f32_16x16x32_bf16 v[148:151], a[112:115], a[0:3], v[148:151]
v_mfma_f32_16x16x32_bf16 v[148:151], a[116:119], a[4:7], v[148:151]
v_mfma_f32_16x16x32_bf16 v[172:175], a[116:119], a[12:15], v[172:175]
v_mfma_f32_16x16x32_bf16 v[172:175], a[112:115], a[8:11], v[172:175]
v_mfma_f32_16x16x32_bf16 v[196:199], a[112:115], a[16:19], v[196:199]
buffer_load_dwordx4 a[76:79], v2, s[40:43], s33 offen offset:1024 sc1
v_mfma_f32_16x16x32_bf16 v[196:199], a[116:119], a[20:23], v[196:199]
v_mfma_f32_16x16x32_bf16 v[220:223], a[116:119], a[28:31], v[220:223]
v_mfma_f32_16x16x32_bf16 v[220:223], a[112:115], a[24:27], v[220:223]
s_waitcnt lgkmcnt(0)
v_mfma_f32_16x16x32_bf16 v[224:227], a[128:131], a[24:27], v[224:227]
ds_read_b128 a[96:99], v5 offset:38912
v_mfma_f32_16x16x32_bf16 v[224:227], a[132:135], a[28:31], v[224:227]
buffer_load_dwordx4 a[80:83], v2, s[40:43], s35 offen offset:2048 sc1
v_mfma_f32_16x16x32_bf16 v[200:203], a[132:135], a[20:23], v[200:203]
ds_read_b128 a[100:103], v5 offset:45056
v_mfma_f32_16x16x32_bf16 v[200:203], a[128:131], a[16:19], v[200:203]
v_mfma_f32_16x16x32_bf16 v[176:179], a[128:131], a[8:11], v[176:179]
v_mfma_f32_16x16x32_bf16 v[176:179], a[132:135], a[12:15], v[176:179]
buffer_load_dwordx4 a[84:87], v2, s[40:43], s33 offen offset:2048 sc1
v_mfma_f32_16x16x32_bf16 v[152:155], a[132:135], a[4:7], v[152:155]
ds_read_b128 a[104:107], v5 offset:39936
v_mfma_f32_16x16x32_bf16 v[152:155], a[128:131], a[0:3], v[152:155]
v_mfma_f32_16x16x32_bf16 v[132:135], a[136:139], a[0:3], v[132:135]
ds_read_b128 a[108:111], v5 offset:46080
v_mfma_f32_16x16x32_bf16 v[132:135], a[140:143], a[4:7], v[132:135]
v_mfma_f32_16x16x32_bf16 v[156:159], a[140:143], a[12:15], v[156:159]
buffer_load_dwordx4 v[120:123], v1, s[4:7], s88 offen offset:3072 sc1
s_add_u32 m0, s18, 0x0
v_mfma_f32_16x16x32_bf16 v[156:159], a[136:139], a[8:11], v[156:159]
s_add_u32 s44, s50, 0x3424000
ds_read_b128 a[112:115], v5 offset:40960
v_mfma_f32_16x16x32_bf16 v[180:183], a[136:139], a[16:19], v[180:183]
v_mfma_f32_16x16x32_bf16 v[180:183], a[140:143], a[20:23], v[180:183]
ds_read_b128 a[116:119], v5 offset:47104
v_mfma_f32_16x16x32_bf16 v[204:207], a[140:143], a[28:31], v[204:207]
v_mfma_f32_16x16x32_bf16 v[204:207], a[136:139], a[24:27], v[204:207]
buffer_load_dwordx4 a[88:91], v2, s[40:43], s35 offen offset:3072 sc1
v_mfma_f32_16x16x32_bf16 v[208:211], a[144:147], a[24:27], v[208:211]
v_mfma_f32_16x16x32_bf16 v[208:211], a[148:151], a[28:31], v[208:211]
v_mfma_f32_16x16x32_bf16 v[184:187], a[148:151], a[20:23], v[184:187]
v_mfma_f32_16x16x32_bf16 v[184:187], a[144:147], a[16:19], v[184:187]
v_mfma_f32_16x16x32_bf16 v[160:163], a[144:147], a[8:11], v[160:163]
buffer_load_dwordx4 a[92:95], v2, s[40:43], s33 offen offset:3072 sc1
s_add_u32 s35, s35, 0x4000
v_mfma_f32_16x16x32_bf16 v[160:163], a[148:151], a[12:15], v[160:163]
s_add_u32 s33, s33, 0x4000
v_mfma_f32_16x16x32_bf16 v[136:139], a[148:151], a[4:7], v[136:139]
v_mfma_f32_16x16x32_bf16 v[136:139], a[144:147], a[0:3], v[136:139]
s_waitcnt vmcnt(10) lgkmcnt(0)
v_mfma_f32_16x16x32_bf16 v[140:143], a[96:99], a[32:35], v[140:143]
ds_read_b128 a[128:131], v5 offset:41984
v_mfma_f32_16x16x32_bf16 v[140:143], a[100:103], a[36:39], v[140:143]
buffer_load_dwordx4 a[0:3], v2, s[40:43], s35 offen offset:0 sc1
v_mfma_f32_16x16x32_bf16 v[164:167], a[100:103], a[44:47], v[164:167]
ds_read_b128 a[132:135], v5 offset:48128
v_mfma_f32_16x16x32_bf16 v[164:167], a[96:99], a[40:43], v[164:167]
v_mfma_f32_16x16x32_bf16 v[188:191], a[96:99], a[48:51], v[188:191]
v_mfma_f32_16x16x32_bf16 v[188:191], a[100:103], a[52:55], v[188:191]
buffer_load_dwordx4 v1, s[4:7], s44 offen offset:0 sc1 lds
v_mfma_f32_16x16x32_bf16 v[212:215], a[100:103], a[60:63], v[212:215]
ds_read_b128 a[136:139], v5 offset:36864
v_mfma_f32_16x16x32_bf16 v[212:215], a[96:99], a[56:59], v[212:215]
v_mfma_f32_16x16x32_bf16 v[216:219], a[104:107], a[56:59], v[216:219]
ds_read_b128 a[140:143], v5 offset:43008
v_mfma_f32_16x16x32_bf16 v[216:219], a[108:111], a[60:63], v[216:219]
buffer_load_dwordx4 a[4:7], v2, s[40:43], s33 offen offset:0 sc1
v_mfma_f32_16x16x32_bf16 v[192:195], a[108:111], a[52:55], v[192:195]
ds_read_b128 a[144:147], v5 offset:37888
v_mfma_f32_16x16x32_bf16 v[192:195], a[104:107], a[48:51], v[192:195]
v_mfma_f32_16x16x32_bf16 v[168:171], a[104:107], a[40:43], v[168:171]
v_mfma_f32_16x16x32_bf16 v[168:171], a[108:111], a[44:47], v[168:171]
buffer_load_dwordx4 a[8:11], v2, s[40:43], s35 offen offset:1024 sc1
v_mfma_f32_16x16x32_bf16 v[144:147], a[108:111], a[36:39], v[144:147]
ds_read_b128 a[148:151], v5 offset:44032
v_mfma_f32_16x16x32_bf16 v[144:147], a[104:107], a[32:35], v[144:147]
v_mfma_f32_16x16x32_bf16 v[148:151], a[112:115], a[32:35], v[148:151]
v_mfma_f32_16x16x32_bf16 v[148:151], a[116:119], a[36:39], v[148:151]
buffer_load_dwordx4 v1, s[4:7], s44 offen offset:1024 sc1 lds
s_add_u32 m0, s18, 0x2000
v_mfma_f32_16x16x32_bf16 v[172:175], a[116:119], a[44:47], v[172:175]
s_add_u32 s44, s50, 0x3426000
v_mfma_f32_16x16x32_bf16 v[172:175], a[112:115], a[40:43], v[172:175]
v_mfma_f32_16x16x32_bf16 v[196:199], a[112:115], a[48:51], v[196:199]
v_mfma_f32_16x16x32_bf16 v[196:199], a[116:119], a[52:55], v[196:199]
buffer_load_dwordx4 a[12:15], v2, s[40:43], s33 offen offset:1024 sc1
v_mfma_f32_16x16x32_bf16 v[220:223], a[116:119], a[60:63], v[220:223]
v_mfma_f32_16x16x32_bf16 v[220:223], a[112:115], a[56:59], v[220:223]
s_waitcnt lgkmcnt(0)
s_barrier
v_mfma_f32_16x16x32_bf16 v[224:227], a[128:131], a[56:59], v[224:227]
v_add_u32 v5, 98304, v1
v_mfma_f32_16x16x32_bf16 v[224:227], a[132:135], a[60:63], v[224:227]
buffer_load_dwordx4 a[16:19], v2, s[40:43], s35 offen offset:2048 sc1
v_mfma_f32_16x16x32_bf16 v[200:203], a[132:135], a[52:55], v[200:203]
ds_read_b128 a[96:99], v5 offset:2048
v_mfma_f32_16x16x32_bf16 v[200:203], a[128:131], a[48:51], v[200:203]
ds_read_b128 a[100:103], v5 offset:8192
v_mfma_f32_16x16x32_bf16 v[176:179], a[128:131], a[40:43], v[176:179]
v_mfma_f32_16x16x32_bf16 v[176:179], a[132:135], a[44:47], v[176:179]
buffer_load_dwordx4 a[20:23], v2, s[40:43], s33 offen offset:2048 sc1
v_mfma_f32_16x16x32_bf16 v[152:155], a[132:135], a[36:39], v[152:155]
ds_read_b128 a[104:107], v5 offset:3072
v_mfma_f32_16x16x32_bf16 v[152:155], a[128:131], a[32:35], v[152:155]
v_mfma_f32_16x16x32_bf16 v[132:135], a[136:139], a[32:35], v[132:135]
ds_read_b128 a[108:111], v5 offset:9216
v_mfma_f32_16x16x32_bf16 v[132:135], a[140:143], a[36:39], v[132:135]
v_mfma_f32_16x16x32_bf16 v[156:159], a[140:143], a[44:47], v[156:159]
buffer_load_dwordx4 v1, s[4:7], s44 offen offset:0 sc1 lds
v_mfma_f32_16x16x32_bf16 v[156:159], a[136:139], a[40:43], v[156:159]
ds_read_b128 a[112:115], v5 offset:4096
v_mfma_f32_16x16x32_bf16 v[180:183], a[136:139], a[48:51], v[180:183]
v_mfma_f32_16x16x32_bf16 v[180:183], a[140:143], a[52:55], v[180:183]
ds_read_b128 a[116:119], v5 offset:10240
v_mfma_f32_16x16x32_bf16 v[204:207], a[140:143], a[60:63], v[204:207]
v_mfma_f32_16x16x32_bf16 v[204:207], a[136:139], a[56:59], v[204:207]
buffer_load_dwordx4 a[24:27], v2, s[40:43], s35 offen offset:3072 sc1
v_mfma_f32_16x16x32_bf16 v[208:211], a[144:147], a[56:59], v[208:211]
v_mfma_f32_16x16x32_bf16 v[208:211], a[148:151], a[60:63], v[208:211]
v_mfma_f32_16x16x32_bf16 v[184:187], a[148:151], a[52:55], v[184:187]
v_mfma_f32_16x16x32_bf16 v[184:187], a[144:147], a[48:51], v[184:187]
v_mfma_f32_16x16x32_bf16 v[160:163], a[144:147], a[40:43], v[160:163]
buffer_load_dwordx4 a[28:31], v2, s[40:43], s33 offen offset:3072 sc1
s_add_u32 s35, s35, 0x4000
v_mfma_f32_16x16x32_bf16 v[160:163], a[148:151], a[44:47], v[160:163]
s_add_u32 s33, s33, 0x4000
v_mfma_f32_16x16x32_bf16 v[136:139], a[148:151], a[36:39], v[136:139]
v_mfma_f32_16x16x32_bf16 v[136:139], a[144:147], a[32:35], v[136:139]
s_waitcnt vmcnt(11) lgkmcnt(0)
v_mfma_f32_16x16x32_bf16 v[140:143], a[96:99], a[64:67], v[140:143]
ds_read_b128 a[128:131], v5 offset:5120
v_mfma_f32_16x16x32_bf16 v[140:143], a[100:103], a[68:71], v[140:143]
buffer_load_dwordx4 a[32:35], v2, s[40:43], s35 offen offset:0 sc1
v_mfma_f32_16x16x32_bf16 v[164:167], a[100:103], a[76:79], v[164:167]
ds_read_b128 a[132:135], v5 offset:11264
v_mfma_f32_16x16x32_bf16 v[164:167], a[96:99], a[72:75], v[164:167]
v_mfma_f32_16x16x32_bf16 v[188:191], a[96:99], a[80:83], v[188:191]
v_mfma_f32_16x16x32_bf16 v[188:191], a[100:103], a[84:87], v[188:191]
buffer_load_dwordx4 a[36:39], v2, s[40:43], s33 offen offset:0 sc1
v_mfma_f32_16x16x32_bf16 v[212:215], a[100:103], a[92:95], v[212:215]
ds_read_b128 a[136:139], v5 offset:0
v_mfma_f32_16x16x32_bf16 v[212:215], a[96:99], a[88:91], v[212:215]
v_mfma_f32_16x16x32_bf16 v[216:219], a[104:107], a[88:91], v[216:219]
ds_read_b128 a[140:143], v5 offset:6144
v_mfma_f32_16x16x32_bf16 v[216:219], a[108:111], a[92:95], v[216:219]
v_mfma_f32_16x16x32_bf16 v[192:195], a[108:111], a[84:87], v[192:195]
buffer_load_dwordx4 v1, s[4:7], s44 offen offset:1024 sc1 lds
s_add_u32 m0, s18, 0x4000
v_mfma_f32_16x16x32_bf16 v[192:195], a[104:107], a[80:83], v[192:195]
s_add_u32 s44, s50, 0x3428000
ds_read_b128 a[144:147], v5 offset:1024
v_mfma_f32_16x16x32_bf16 v[168:171], a[104:107], a[72:75], v[168:171]
v_mfma_f32_16x16x32_bf16 v[168:171], a[108:111], a[76:79], v[168:171]
ds_read_b128 a[148:151], v5 offset:7168
v_mfma_f32_16x16x32_bf16 v[144:147], a[108:111], a[68:71], v[144:147]
v_mfma_f32_16x16x32_bf16 v[144:147], a[104:107], a[64:67], v[144:147]
buffer_load_dwordx4 a[40:43], v2, s[40:43], s35 offen offset:1024 sc1
v_mfma_f32_16x16x32_bf16 v[148:151], a[112:115], a[64:67], v[148:151]
v_mfma_f32_16x16x32_bf16 v[148:151], a[116:119], a[68:71], v[148:151]
v_mfma_f32_16x16x32_bf16 v[172:175], a[116:119], a[76:79], v[172:175]
v_mfma_f32_16x16x32_bf16 v[172:175], a[112:115], a[72:75], v[172:175]
v_mfma_f32_16x16x32_bf16 v[196:199], a[112:115], a[80:83], v[196:199]
buffer_load_dwordx4 a[44:47], v2, s[40:43], s33 offen offset:1024 sc1
v_mfma_f32_16x16x32_bf16 v[196:199], a[116:119], a[84:87], v[196:199]
v_mfma_f32_16x16x32_bf16 v[220:223], a[116:119], a[92:95], v[220:223]
v_mfma_f32_16x16x32_bf16 v[220:223], a[112:115], a[88:91], v[220:223]
s_waitcnt lgkmcnt(0)
v_mfma_f32_16x16x32_bf16 v[224:227], a[128:131], a[88:91], v[224:227]
ds_read_b128 a[96:99], v5 offset:14336
v_mfma_f32_16x16x32_bf16 v[224:227], a[132:135], a[92:95], v[224:227]
buffer_load_dwordx4 a[48:51], v2, s[40:43], s35 offen offset:2048 sc1
v_mfma_f32_16x16x32_bf16 v[200:203], a[132:135], a[84:87], v[200:203]
ds_read_b128 a[100:103], v5 offset:20480
v_mfma_f32_16x16x32_bf16 v[200:203], a[128:131], a[80:83], v[200:203]
v_mfma_f32_16x16x32_bf16 v[176:179], a[128:131], a[72:75], v[176:179]
v_mfma_f32_16x16x32_bf16 v[176:179], a[132:135], a[76:79], v[176:179]
buffer_load_dwordx4 a[52:55], v2, s[40:43], s33 offen offset:2048 sc1
v_mfma_f32_16x16x32_bf16 v[152:155], a[132:135], a[68:71], v[152:155]
ds_read_b128 a[104:107], v5 offset:15360
v_mfma_f32_16x16x32_bf16 v[152:155], a[128:131], a[64:67], v[152:155]
v_mfma_f32_16x16x32_bf16 v[132:135], a[136:139], a[64:67], v[132:135]
ds_read_b128 a[108:111], v5 offset:21504
v_mfma_f32_16x16x32_bf16 v[132:135], a[140:143], a[68:71], v[132:135]
v_mfma_f32_16x16x32_bf16 v[156:159], a[140:143], a[76:79], v[156:159]
buffer_load_dwordx4 v1, s[4:7], s44 offen offset:0 sc1 lds
v_mfma_f32_16x16x32_bf16 v[156:159], a[136:139], a[72:75], v[156:159]
ds_read_b128 a[112:115], v5 offset:16384
v_mfma_f32_16x16x32_bf16 v[180:183], a[136:139], a[80:83], v[180:183]
v_mfma_f32_16x16x32_bf16 v[180:183], a[140:143], a[84:87], v[180:183]
ds_read_b128 a[116:119], v5 offset:22528
v_mfma_f32_16x16x32_bf16 v[204:207], a[140:143], a[92:95], v[204:207]
v_mfma_f32_16x16x32_bf16 v[204:207], a[136:139], a[88:91], v[204:207]
buffer_load_dwordx4 a[56:59], v2, s[40:43], s35 offen offset:3072 sc1
v_mfma_f32_16x16x32_bf16 v[208:211], a[144:147], a[88:91], v[208:211]
v_mfma_f32_16x16x32_bf16 v[208:211], a[148:151], a[92:95], v[208:211]
v_mfma_f32_16x16x32_bf16 v[184:187], a[148:151], a[84:87], v[184:187]
v_mfma_f32_16x16x32_bf16 v[184:187], a[144:147], a[80:83], v[184:187]
v_mfma_f32_16x16x32_bf16 v[160:163], a[144:147], a[72:75], v[160:163]
buffer_load_dwordx4 a[60:63], v2, s[40:43], s33 offen offset:3072 sc1
s_add_u32 s35, s35, 0x4000
v_mfma_f32_16x16x32_bf16 v[160:163], a[148:151], a[76:79], v[160:163]
s_add_u32 s33, s33, 0x4000
v_mfma_f32_16x16x32_bf16 v[136:139], a[148:151], a[68:71], v[136:139]
v_mfma_f32_16x16x32_bf16 v[136:139], a[144:147], a[64:67], v[136:139]
s_waitcnt vmcnt(10) lgkmcnt(0)
v_mfma_f32_16x16x32_bf16 v[140:143], a[96:99], a[0:3], v[140:143]
ds_read_b128 a[128:131], v5 offset:17408
v_add_f32 v92, v92, v96
v_mfma_f32_16x16x32_bf16 v[140:143], a[100:103], a[4:7], v[140:143]
buffer_load_dwordx4 a[64:67], v2, s[40:43], s35 offen offset:0 sc1
v_mfma_f32_16x16x32_bf16 v[164:167], a[100:103], a[12:15], v[164:167]
ds_read_b128 a[132:135], v5 offset:23552
v_add_f32 v100, v100, v104
v_mfma_f32_16x16x32_bf16 v[164:167], a[96:99], a[8:11], v[164:167]
v_add_f32 v108, v108, v112
v_add_f32 v116, v116, v120
v_mfma_f32_16x16x32_bf16 v[188:191], a[96:99], a[16:19], v[188:191]
v_add_f32 v93, v93, v97
v_add_f32 v101, v101, v105
v_mfma_f32_16x16x32_bf16 v[188:191], a[100:103], a[20:23], v[188:191]
buffer_load_dwordx4 a[68:71], v2, s[40:43], s33 offen offset:0 sc1
v_mfma_f32_16x16x32_bf16 v[212:215], a[100:103], a[28:31], v[212:215]
ds_read_b128 a[136:139], v5 offset:12288
v_add_f32 v109, v109, v113
v_mfma_f32_16x16x32_bf16 v[212:215], a[96:99], a[24:27], v[212:215]
v_add_f32 v117, v117, v121
v_add_f32 v94, v94, v98
v_mfma_f32_16x16x32_bf16 v[216:219], a[104:107], a[24:27], v[216:219]
ds_read_b128 a[140:143], v5 offset:18432
v_add_f32 v102, v102, v106
v_mfma_f32_16x16x32_bf16 v[216:219], a[108:111], a[28:31], v[216:219]
v_add_f32 v110, v110, v114
v_mfma_f32_16x16x32_bf16 v[192:195], a[108:111], a[20:23], v[192:195]
buffer_load_dwordx4 v1, s[4:7], s44 offen offset:1024 sc1 lds
s_add_u32 m0, s18, 0x6000
v_mfma_f32_16x16x32_bf16 v[192:195], a[104:107], a[16:19], v[192:195]
s_add_u32 s44, s50, 0x342a000
ds_read_b128 a[144:147], v5 offset:13312
v_mfma_f32_16x16x32_bf16 v[168:171], a[104:107], a[8:11], v[168:171]
v_add_f32 v118, v118, v122
v_add_f32 v95, v95, v99
v_mfma_f32_16x16x32_bf16 v[168:171], a[108:111], a[12:15], v[168:171]
ds_read_b128 a[148:151], v5 offset:19456
v_add_f32 v103, v103, v107
v_mfma_f32_16x16x32_bf16 v[144:147], a[108:111], a[4:7], v[144:147]
v_add_f32 v111, v111, v115
v_add_f32 v119, v119, v123
v_mfma_f32_16x16x32_bf16 v[144:147], a[104:107], a[0:3], v[144:147]
buffer_load_dwordx4 a[72:75], v2, s[40:43], s35 offen offset:1024 sc1
v_mfma_f32_16x16x32_bf16 v[148:151], a[112:115], a[0:3], v[148:151]
v_add_f32_dpp v92, v92, v92 row_ror:8 row_mask:0xf bank_mask:0xf
v_add_f32_dpp v100, v100, v100 row_ror:8 row_mask:0xf bank_mask:0xf
v_mfma_f32_16x16x32_bf16 v[148:151], a[116:119], a[4:7], v[148:151]
L_stub16:
s_cbranch_execz L_stub17
v_add_f32_dpp v108, v108, v108 row_ror:8 row_mask:0xf bank_mask:0xf
v_mfma_f32_16x16x32_bf16 v[172:175], a[116:119], a[12:15], v[172:175]
v_add_f32_dpp v116, v116, v116 row_ror:8 row_mask:0xf bank_mask:0xf
v_mfma_f32_16x16x32_bf16 v[172:175], a[112:115], a[8:11], v[172:175]
v_add_f32_dpp v93, v93, v93 row_ror:8 row_mask:0xf bank_mask:0xf
v_mfma_f32_16x16x32_bf16 v[196:199], a[112:115], a[16:19], v[196:199]
buffer_load_dwordx4 a[76:79], v2, s[40:43], s33 offen offset:1024 sc1
v_mfma_f32_16x16x32_bf16 v[196:199], a[116:119], a[20:23], v[196:199]
v_add_f32_dpp v101, v101, v101 row_ror:8 row_mask:0xf bank_mask:0xf
v_add_f32_dpp v109, v109, v109 row_ror:8 row_mask:0xf bank_mask:0xf
v_mfma_f32_16x16x32_bf16 v[220:223], a[116:119], a[28:31], v[220:223]
v_add_f32_dpp v117, v117, v117 row_ror:8 row_mask:0xf bank_mask:0xf
v_mfma_f32_16x16x32_bf16 v[220:223], a[112:115], a[24:27], v[220:223]
v_add_f32_dpp v92, v94, v94 row_ror:8 row_mask:0xf bank_mask:0xc
s_waitcnt lgkmcnt(0)
v_mfma_f32_16x16x32_bf16 v[224:227], a[128:131], a[24:27], v[224:227]
ds_read_b128 a[96:99], v5 offset:26624
v_add_f32_dpp v100, v102, v102 row_ror:8 row_mask:0xf bank_mask:0xc
v_mfma_f32_16x16x32_bf16 v[224:227], a[132:135], a[28:31], v[224:227]
buffer_load_dwordx4 a[80:83], v2, s[40:43], s35 offen offset:2048 sc1
v_mfma_f32_16x16x32_bf16 v[200:203], a[132:135], a[20:23], v[200:203]
ds_read_b128 a[100:103], v5 offset:32768
v_add_f32_dpp v108, v110, v110 row_ror:8 row_mask:0xf bank_mask:0xc
v_mfma_f32_16x16x32_bf16 v[200:203], a[128:131], a[16:19], v[200:203]
v_add_f32_dpp v116, v118, v118 row_ror:8 row_mask:0xf bank_mask:0xc
v_add_f32_dpp v93, v95, v95 row_ror:8 row_mask:0xf bank_mask:0xc
v_mfma_f32_16x16x32_bf16 v[176:179], a[128:131], a[8:11], v[176:179]
v_add_f32_dpp v101, v103, v103 row_ror:8 row_mask:0xf bank_mask:0xc
v_add_f32_dpp v109, v111, v111 row_ror:8 row_mask:0xf bank_mask:0xc
v_mfma_f32_16x16x32_bf16 v[176:179], a[132:135], a[12:15], v[176:179]
buffer_load_dwordx4 v1, s[4:7], s44 offen offset:0 sc1 lds
v_mfma_f32_16x16x32_bf16 v[152:155], a[132:135], a[4:7], v[152:155]
ds_read_b128 a[104:107], v5 offset:27648
v_add_f32_dpp v117, v119, v119 row_ror:8 row_mask:0xf bank_mask:0xc
v_mfma_f32_16x16x32_bf16 v[152:155], a[128:131], a[0:3], v[152:155]
v_permlane32_swap_b32 v92, v93
v_mfma_f32_16x16x32_bf16 v[132:135], a[136:139], a[0:3], v[132:135]
ds_read_b128 a[108:111], v5 offset:33792
v_mfma_f32_16x16x32_bf16 v[132:135], a[140:143], a[4:7], v[132:135]
buffer_load_dwordx4 a[84:87], v2, s[40:43], s33 offen offset:2048 sc1
v_mfma_f32_16x16x32_bf16 v[156:159], a[140:143], a[12:15], v[156:159]
ds_read_b128 a[112:115], v5 offset:28672
v_mfma_f32_16x16x32_bf16 v[156:159], a[136:139], a[8:11], v[156:159]
v_permlane32_swap_b32 v100, v101
v_mfma_f32_16x16x32_bf16 v[180:183], a[136:139], a[16:19], v[180:183]
v_permlane32_swap_b32 v108, v109
v_mfma_f32_16x16x32_bf16 v[180:183], a[140:143], a[20:23], v[180:183]
buffer_load_dwordx4 a[88:91], v2, s[40:43], s35 offen offset:3072 sc1
v_mfma_f32_16x16x32_bf16 v[204:207], a[140:143], a[28:31], v[204:207]
ds_read_b128 a[116:119], v5 offset:34816
v_mfma_f32_16x16x32_bf16 v[204:207], a[136:139], a[24:27], v[204:207]
v_permlane32_swap_b32 v116, v117
v_mfma_f32_16x16x32_bf16 v[208:211], a[144:147], a[24:27], v[208:211]
v_add_f32 v92, v92, v93
v_add_f32 v100, v100, v101
v_mfma_f32_16x16x32_bf16 v[208:211], a[148:151], a[28:31], v[208:211]
buffer_load_dwordx4 v1, s[4:7], s44 offen offset:1024 sc1 lds
s_add_u32 m0, s18, 0x8000
v_mfma_f32_16x16x32_bf16 v[184:187], a[148:151], a[20:23], v[184:187]
s_add_u32 s44, s50, 0x342c000
v_add_f32 v108, v108, v109
v_mfma_f32_16x16x32_bf16 v[184:187], a[144:147], a[16:19], v[184:187]
v_add_f32 v116, v116, v117
v_mov_b32 v94, v92
v_mfma_f32_16x16x32_bf16 v[160:163], a[144:147], a[8:11], v[160:163]
v_mov_b32 v102, v100
v_mov_b32 v110, v108
v_mfma_f32_16x16x32_bf16 v[160:163], a[148:151], a[12:15], v[160:163]
buffer_load_dwordx4 a[92:95], v2, s[40:43], s33 offen offset:3072 sc1
s_add_u32 s35, s35, 0x4000
v_mfma_f32_16x16x32_bf16 v[136:139], a[148:151], a[4:7], v[136:139]
s_add_u32 s33, s33, 0x4000
v_mov_b32 v118, v116
v_mfma_f32_16x16x32_bf16 v[136:139], a[144:147], a[0:3], v[136:139]
s_waitcnt vmcnt(11) lgkmcnt(0)
v_mfma_f32_16x16x32_bf16 v[140:143], a[96:99], a[32:35], v[140:143]
ds_read_b128 a[128:131], v5 offset:29696
v_mfma_f32_16x16x32_bf16 v[140:143], a[100:103], a[36:39], v[140:143]
buffer_load_dwordx4 a[0:3], v2, s[40:43], s35 offen offset:0 sc1
v_mfma_f32_16x16x32_bf16 v[164:167], a[100:103], a[44:47], v[164:167]
ds_read_b128 a[132:135], v5 offset:35840
v_mfma_f32_16x16x32_bf16 v[164:167], a[96:99], a[40:43], v[164:167]
v_permlane16_swap_b32 v92, v94
v_mfma_f32_16x16x32_bf16 v[188:191], a[96:99], a[48:51], v[188:191]
v_permlane16_swap_b32 v100, v102
v_mfma_f32_16x16x32_bf16 v[188:191], a[100:103], a[52:55], v[188:191]
buffer_load_dwordx4 a[4:7], v2, s[40:43], s33 offen offset:0 sc1
v_mfma_f32_16x16x32_bf16 v[212:215], a[100:103], a[60:63], v[212:215]
ds_read_b128 a[136:139], v5 offset:24576
v_mfma_f32_16x16x32_bf16 v[212:215], a[96:99], a[56:59], v[212:215]
v_permlane16_swap_b32 v108, v110
v_mfma_f32_16x16x32_bf16 v[216:219], a[104:107], a[56:59], v[216:219]
ds_read_b128 a[140:143], v5 offset:30720
v_mfma_f32_16x16x32_bf16 v[216:219], a[108:111], a[60:63], v[216:219]
v_permlane16_swap_b32 v116, v118
v_mfma_f32_16x16x32_bf16 v[192:195], a[108:111], a[52:55], v[192:195]
buffer_load_dwordx4 v1, s[4:7], s44 offen offset:0 sc1 lds
v_mfma_f32_16x16x32_bf16 v[192:195], a[104:107], a[48:51], v[192:195]
ds_read_b128 a[144:147], v5 offset:25600
v_add_f32 v92, v92, v94
v_mfma_f32_16x16x32_bf16 v[168:171], a[104:107], a[40:43], v[168:171]
v_add_f32 v100, v100, v102
v_add_f32 v108, v108, v110
v_mfma_f32_16x16x32_bf16 v[168:171], a[108:111], a[44:47], v[168:171]
ds_read_b128 a[148:151], v5 offset:31744
v_add_f32 v116, v116, v118
v_mfma_f32_16x16x32_bf16 v[144:147], a[108:111], a[36:39], v[144:147]
v_mov_b32 v94, v92
v_mov_b32 v102, v100
v_mfma_f32_16x16x32_bf16 v[144:147], a[104:107], a[32:35], v[144:147]
buffer_load_dwordx4 a[8:11], v2, s[40:43], s35 offen offset:1024 sc1
v_mfma_f32_16x16x32_bf16 v[148:151], a[112:115], a[32:35], v[148:151]
v_mov_b32 v110, v108
v_mov_b32 v118, v116
v_mfma_f32_16x16x32_bf16 v[148:151], a[116:119], a[36:39], v[148:151]
v_permlane32_swap_b32 v92, v94
v_mfma_f32_16x16x32_bf16 v[172:175], a[116:119], a[44:47], v[172:175]
v_permlane32_swap_b32 v100, v102
v_mfma_f32_16x16x32_bf16 v[172:175], a[112:115], a[40:43], v[172:175]
v_permlane32_swap_b32 v108, v110
v_mfma_f32_16x16x32_bf16 v[196:199], a[112:115], a[48:51], v[196:199]
buffer_load_dwordx4 a[12:15], v2, s[40:43], s33 offen offset:1024 sc1
v_mfma_f32_16x16x32_bf16 v[196:199], a[116:119], a[52:55], v[196:199]
v_permlane32_swap_b32 v116, v118
v_mfma_f32_16x16x32_bf16 v[220:223], a[116:119], a[60:63], v[220:223]
v_mul_f32 v82, 0xba800000, v92
v_mul_f32 v84, 0xba800000, v100
v_mfma_f32_16x16x32_bf16 v[220:223], a[112:115], a[56:59], v[220:223]
v_mul_f32 v86, 0xba800000, v108
s_waitcnt lgkmcnt(0)
v_mfma_f32_16x16x32_bf16 v[224:227], a[128:131], a[56:59], v[224:227]
ds_read_b128 a[96:99], v5 offset:38912
v_mul_f32 v88, 0xba800000, v116
v_mfma_f32_16x16x32_bf16 v[224:227], a[132:135], a[60:63], v[224:227]
buffer_load_dwordx4 a[16:19], v2, s[40:43], s35 offen offset:2048 sc1
v_mfma_f32_16x16x32_bf16 v[200:203], a[132:135], a[52:55], v[200:203]
ds_read_b128 a[100:103], v5 offset:45056
v_mul_f32 v94, 0x3a800000, v94
v_mfma_f32_16x16x32_bf16 v[200:203], a[128:131], a[48:51], v[200:203]
v_mul_f32 v102, 0x3a800000, v102
v_mul_f32 v110, 0x3a800000, v110
v_mfma_f32_16x16x32_bf16 v[176:179], a[128:131], a[40:43], v[176:179]
v_mul_f32 v118, 0x3a800000, v118
v_fma_f32 v94, -v82, v82, v94
v_mfma_f32_16x16x32_bf16 v[176:179], a[132:135], a[44:47], v[176:179]
buffer_load_dwordx4 a[20:23], v2, s[40:43], s33 offen offset:2048 sc1
v_mfma_f32_16x16x32_bf16 v[152:155], a[132:135], a[36:39], v[152:155]
ds_read_b128 a[104:107], v5 offset:39936
v_fma_f32 v102, -v84, v84, v102
v_mfma_f32_16x16x32_bf16 v[152:155], a[128:131], a[32:35], v[152:155]
v_fma_f32 v110, -v86, v86, v110
v_fma_f32 v118, -v88, v88, v118
v_mfma_f32_16x16x32_bf16 v[132:135], a[136:139], a[32:35], v[132:135]
ds_read_b128 a[108:111], v5 offset:46080
v_max_f32 v94, 0, v94
v_mfma_f32_16x16x32_bf16 v[132:135], a[140:143], a[36:39], v[132:135]
v_max_f32 v102, 0, v102
v_mfma_f32_16x16x32_bf16 v[156:159], a[140:143], a[44:47], v[156:159]
buffer_load_dwordx4 v1, s[4:7], s44 offen offset:1024 sc1 lds
s_add_u32 m0, s18, 0xa000
v_mfma_f32_16x16x32_bf16 v[156:159], a[136:139], a[40:43], v[156:159]
s_add_u32 s44, s50, 0x342e000
ds_read_b128 a[112:115], v5 offset:40960
v_mfma_f32_16x16x32_bf16 v[180:183], a[136:139], a[48:51], v[180:183]
v_max_f32 v110, 0, v110
v_max_f32 v118, 0, v118
v_mfma_f32_16x16x32_bf16 v[180:183], a[140:143], a[52:55], v[180:183]
ds_read_b128 a[116:119], v5 offset:47104
v_add_f32 v94, 0x3727c5ac, v94
v_mfma_f32_16x16x32_bf16 v[204:207], a[140:143], a[60:63], v[204:207]
v_add_f32 v102, 0x3727c5ac, v102
v_add_f32 v110, 0x3727c5ac, v110
v_mfma_f32_16x16x32_bf16 v[204:207], a[136:139], a[56:59], v[204:207]
buffer_load_dwordx4 a[24:27], v2, s[40:43], s35 offen offset:3072 sc1
v_mfma_f32_16x16x32_bf16 v[208:211], a[144:147], a[56:59], v[208:211]
v_add_f32 v118, 0x3727c5ac, v118
v_mfma_f32_16x16x32_bf16 v[208:211], a[148:151], a[60:63], v[208:211]
v_rsq_f32 v83, v94
v_mfma_f32_16x16x32_bf16 v[184:187], a[148:151], a[52:55], v[184:187]
v_rsq_f32 v85, v102
v_mfma_f32_16x16x32_bf16 v[184:187], a[144:147], a[48:51], v[184:187]
v_mfma_f32_16x16x32_bf16 v[160:163], a[144:147], a[40:43], v[160:163]
buffer_load_dwordx4 a[28:31], v2, s[40:43], s33 offen offset:3072 sc1
s_add_u32 s35, s35, 0x4000
v_mfma_f32_16x16x32_bf16 v[160:163], a[148:151], a[44:47], v[160:163]
s_add_u32 s33, s33, 0x4000
v_mfma_f32_16x16x32_bf16 v[136:139], a[148:151], a[36:39], v[136:139]
v_rsq_f32 v87, v110
v_mfma_f32_16x16x32_bf16 v[136:139], a[144:147], a[32:35], v[136:139]
s_waitcnt vmcnt(10) lgkmcnt(0)
v_mfma_f32_16x16x32_bf16 v[140:143], a[96:99], a[64:67], v[140:143]
ds_read_b128 a[128:131], v5 offset:41984
v_mfma_f32_16x16x32_bf16 v[140:143], a[100:103], a[68:71], v[140:143]
buffer_load_dwordx4 a[32:35], v2, s[40:43], s35 offen offset:0 sc1
v_mfma_f32_16x16x32_bf16 v[164:167], a[100:103], a[76:79], v[164:167]
ds_read_b128 a[132:135], v5 offset:48128
v_mfma_f32_16x16x32_bf16 v[164:167], a[96:99], a[72:75], v[164:167]
v_rsq_f32 v89, v118
v_mfma_f32_16x16x32_bf16 v[188:191], a[96:99], a[80:83], v[188:191]
v_mfma_f32_16x16x32_bf16 v[188:191], a[100:103], a[84:87], v[188:191]
buffer_load_dwordx4 a[36:39], v2, s[40:43], s33 offen offset:0 sc1
v_mfma_f32_16x16x32_bf16 v[212:215], a[100:103], a[92:95], v[212:215]
ds_read_b128 a[136:139], v5 offset:36864
v_mfma_f32_16x16x32_bf16 v[212:215], a[96:99], a[88:91], v[212:215]
v_mfma_f32_16x16x32_bf16 v[216:219], a[104:107], a[88:91], v[216:219]
ds_read_b128 a[140:143], v5 offset:43008
v_mfma_f32_16x16x32_bf16 v[216:219], a[108:111], a[92:95], v[216:219]
v_mfma_f32_16x16x32_bf16 v[192:195], a[108:111], a[84:87], v[192:195]
buffer_load_dwordx4 v1, s[4:7], s44 offen offset:0 sc1 lds
v_mfma_f32_16x16x32_bf16 v[192:195], a[104:107], a[80:83], v[192:195]
ds_read_b128 a[144:147], v5 offset:37888
v_fmac_f32 v140, v56, v82
v_mfma_f32_16x16x32_bf16 v[168:171], a[104:107], a[72:75], v[168:171]
v_fmac_f32 v164, v56, v84
v_mfma_f32_16x16x32_bf16 v[168:171], a[108:111], a[76:79], v[168:171]
ds_read_b128 a[148:151], v5 offset:44032
v_mfma_f32_16x16x32_bf16 v[144:147], a[108:111], a[68:71], v[144:147]
v_fmac_f32 v188, v56, v86
v_mfma_f32_16x16x32_bf16 v[144:147], a[104:107], a[64:67], v[144:147]
buffer_load_dwordx4 a[40:43], v2, s[40:43], s35 offen offset:1024 sc1
v_mfma_f32_16x16x32_bf16 v[148:151], a[112:115], a[64:67], v[148:151]
v_fmac_f32 v212, v56, v88
v_mfma_f32_16x16x32_bf16 v[148:151], a[116:119], a[68:71], v[148:151]
v_mfma_f32_16x16x32_bf16 v[172:175], a[116:119], a[76:79], v[172:175]
v_fmac_f32 v216, v60, v88
v_mfma_f32_16x16x32_bf16 v[172:175], a[112:115], a[72:75], v[172:175]
v_mfma_f32_16x16x32_bf16 v[196:199], a[112:115], a[80:83], v[196:199]
buffer_load_dwordx4 a[44:47], v2, s[40:43], s33 offen offset:1024 sc1
v_mfma_f32_16x16x32_bf16 v[196:199], a[116:119], a[84:87], v[196:199]
v_fmac_f32 v192, v60, v86
v_mfma_f32_16x16x32_bf16 v[220:223], a[116:119], a[92:95], v[220:223]
v_fmac_f32 v168, v60, v84
v_fmac_f32 v141, v57, v82
v_mfma_f32_16x16x32_bf16 v[220:223], a[112:115], a[88:91], v[220:223]
s_waitcnt lgkmcnt(0)
s_barrier
v_mfma_f32_16x16x32_bf16 v[224:227], a[128:131], a[88:91], v[224:227]
v_add_u32 v5, 0, v1
v_fmac_f32 v144, v60, v82
v_mfma_f32_16x16x32_bf16 v[224:227], a[132:135], a[92:95], v[224:227]
buffer_load_dwordx4 a[48:51], v2, s[40:43], s35 offen offset:2048 sc1
v_mfma_f32_16x16x32_bf16 v[200:203], a[132:135], a[84:87], v[200:203]
ds_read_b128 a[96:99], v5 offset:2048
v_fmac_f32 v148, v64, v82
v_mfma_f32_16x16x32_bf16 v[200:203], a[128:131], a[80:83], v[200:203]
ds_read_b128 a[100:103], v5 offset:8192
v_fmac_f32 v165, v57, v84
v_mfma_f32_16x16x32_bf16 v[176:179], a[128:131], a[72:75], v[176:179]
v_fmac_f32 v172, v64, v84
v_fmac_f32 v189, v57, v86
v_mfma_f32_16x16x32_bf16 v[176:179], a[132:135], a[76:79], v[176:179]
buffer_load_dwordx4 a[52:55], v2, s[40:43], s33 offen offset:2048 sc1
v_mfma_f32_16x16x32_bf16 v[152:155], a[132:135], a[68:71], v[152:155]
ds_read_b128 a[104:107], v5 offset:3072
v_fmac_f32 v196, v64, v86
v_mfma_f32_16x16x32_bf16 v[152:155], a[128:131], a[64:67], v[152:155]
v_fmac_f32 v213, v57, v88
v_fmac_f32 v217, v61, v88
v_mfma_f32_16x16x32_bf16 v[132:135], a[136:139], a[64:67], v[132:135]
ds_read_b128 a[108:111], v5 offset:9216
v_fmac_f32 v220, v64, v88
v_mfma_f32_16x16x32_bf16 v[132:135], a[140:143], a[68:71], v[132:135]
v_fmac_f32 v193, v61, v86
v_mfma_f32_16x16x32_bf16 v[156:159], a[140:143], a[76:79], v[156:159]
buffer_load_dwordx4 v1, s[4:7], s44 offen offset:1024 sc1 lds
s_add_u32 m0, s19, 49152
v_mfma_f32_16x16x32_bf16 v[156:159], a[136:139], a[72:75], v[156:159]
s_add_u32 s44, s85, 0xc04000
ds_read_b128 a[112:115], v5 offset:4096
v_mfma_f32_16x16x32_bf16 v[180:183], a[136:139], a[80:83], v[180:183]
v_fmac_f32 v224, v68, v88
v_fmac_f32 v200, v68, v86
v_mfma_f32_16x16x32_bf16 v[180:183], a[140:143], a[84:87], v[180:183]
ds_read_b128 a[116:119], v5 offset:10240
v_fmac_f32 v169, v61, v84
v_mfma_f32_16x16x32_bf16 v[204:207], a[140:143], a[92:95], v[204:207]
v_fmac_f32 v176, v68, v84
v_fmac_f32 v145, v61, v82
v_mfma_f32_16x16x32_bf16 v[204:207], a[136:139], a[88:91], v[204:207]
buffer_load_dwordx4 a[56:59], v2, s[40:43], s35 offen offset:3072 sc1
v_mfma_f32_16x16x32_bf16 v[208:211], a[144:147], a[88:91], v[208:211]
v_fmac_f32 v152, v68, v82
v_fmac_f32 v149, v65, v82
v_mfma_f32_16x16x32_bf16 v[208:211], a[148:151], a[92:95], v[208:211]
v_fmac_f32 v173, v65, v84
v_mfma_f32_16x16x32_bf16 v[184:187], a[148:151], a[84:87], v[184:187]
v_fmac_f32 v132, v48, v82
v_fmac_f32 v197, v65, v86
v_mfma_f32_16x16x32_bf16 v[184:187], a[144:147], a[80:83], v[184:187]
v_mfma_f32_16x16x32_bf16 v[160:163], a[144:147], a[72:75], v[160:163]
buffer_load_dwordx4 a[60:63], v2, s[40:43], s33 offen offset:3072 sc1
s_add_u32 s35, s35, 0x4000
v_mfma_f32_16x16x32_bf16 v[160:163], a[148:151], a[76:79], v[160:163]
s_add_u32 s33, s33, 0x4000
v_fmac_f32 v156, v48, v84
v_mfma_f32_16x16x32_bf16 v[136:139], a[148:151], a[68:71], v[136:139]
v_fmac_f32 v180, v48, v86
v_fmac_f32 v221, v65, v88
v_mfma_f32_16x16x32_bf16 v[136:139], a[144:147], a[64:67], v[136:139]
v_fmac_f32 v225, v69, v88
s_waitcnt vmcnt(10) lgkmcnt(0)
v_mfma_f32_16x16x32_bf16 v[140:143], a[96:99], a[0:3], v[140:143]
ds_read_b128 a[128:131], v5 offset:5120
v_fmac_f32 v204, v48, v88
v_mfma_f32_16x16x32_bf16 v[140:143], a[100:103], a[4:7], v[140:143]
buffer_load_dwordx4 a[64:67], v2, s[40:43], s35 offen offset:0 sc1
s_lshl_b32 s36, s28, 9
v_mfma_f32_16x16x32_bf16 v[164:167], a[100:103], a[12:15], v[164:167]
ds_read_b128 a[132:135], v5 offset:11264
v_fmac_f32 v208, v52, v88
v_mfma_f32_16x16x32_bf16 v[164:167], a[96:99], a[8:11], v[164:167]
v_fmac_f32 v201, v69, v86
v_fmac_f32 v177, v69, v84
v_mfma_f32_16x16x32_bf16 v[188:191], a[96:99], a[16:19], v[188:191]
v_fmac_f32 v184, v52, v86
v_fmac_f32 v153, v69, v82
v_mfma_f32_16x16x32_bf16 v[188:191], a[100:103], a[20:23], v[188:191]
buffer_load_dwordx4 a[68:71], v2, s[40:43], s33 offen offset:0 sc1
s_lshl_b32 s37, s30, 2
v_mfma_f32_16x16x32_bf16 v[212:215], a[100:103], a[28:31], v[212:215]
ds_read_b128 a[136:139], v5 offset:0
v_fmac_f32 v160, v52, v84
v_mfma_f32_16x16x32_bf16 v[212:215], a[96:99], a[24:27], v[212:215]
v_fmac_f32 v133, v49, v82
v_add_u32 v232, s19, v7
v_mfma_f32_16x16x32_bf16 v[216:219], a[104:107], a[24:27], v[216:219]
ds_read_b128 a[140:143], v5 offset:6144
v_fmac_f32 v136, v52, v82
v_mfma_f32_16x16x32_bf16 v[216:219], a[108:111], a[28:31], v[216:219]
buffer_load_dwordx4 a[72:75], v2, s[40:43], s35 offen offset:1024 sc1
s_add_u32 s37, s37, s28
v_mfma_f32_16x16x32_bf16 v[192:195], a[108:111], a[20:23], v[192:195]
ds_read_b128 a[144:147], v5 offset:1024
v_fmac_f32 v157, v49, v84
v_mfma_f32_16x16x32_bf16 v[192:195], a[104:107], a[16:19], v[192:195]
v_fmac_f32 v181, v49, v86
v_fmac_f32 v142, v58, v82
v_mfma_f32_16x16x32_bf16 v[168:171], a[104:107], a[8:11], v[168:171]
v_fmac_f32 v205, v49, v88
v_fmac_f32 v166, v58, v84
v_mfma_f32_16x16x32_bf16 v[168:171], a[108:111], a[12:15], v[168:171]
buffer_load_dwordx4 a[76:79], v2, s[40:43], s33 offen offset:1024 sc1
s_lshr_b32 s98, s37, 1
v_mfma_f32_16x16x32_bf16 v[144:147], a[108:111], a[4:7], v[144:147]
ds_read_b128 a[148:151], v5 offset:7168
v_fmac_f32 v209, v53, v88
v_mfma_f32_16x16x32_bf16 v[144:147], a[104:107], a[0:3], v[144:147]
v_fmac_f32 v190, v58, v86
s_lshl_b32 s98, s98, 14
v_mfma_f32_16x16x32_bf16 v[148:151], a[112:115], a[0:3], v[148:151]
v_fmac_f32 v185, v53, v86
v_fmac_f32 v214, v58, v88
v_mfma_f32_16x16x32_bf16 v[148:151], a[116:119], a[4:7], v[148:151]
buffer_load_dwordx4 a[80:83], v2, s[40:43], s35 offen offset:2048 sc1
s_and_b32 s99, s19, 0x1000
v_mfma_f32_16x16x32_bf16 v[172:175], a[116:119], a[12:15], v[172:175]
v_fmac_f32 v161, v53, v84
v_fmac_f32 v218, v62, v88
v_mfma_f32_16x16x32_bf16 v[172:175], a[112:115], a[8:11], v[172:175]
s_add_u32 s98, s98, s99
s_lshl_b32 s90, s51, 13
s_add_u32 s98, s98, s90
v_mfma_f32_16x16x32_bf16 v[196:199], a[112:115], a[16:19], v[196:199]
v_fmac_f32 v137, v53, v82
v_fmac_f32 v194, v62, v86
v_mfma_f32_16x16x32_bf16 v[196:199], a[116:119], a[20:23], v[196:199]
buffer_load_dwordx4 a[84:87], v2, s[40:43], s33 offen offset:2048 sc1
s_add_u32 s98, s98, 0x400000
v_mfma_f32_16x16x32_bf16 v[220:223], a[116:119], a[28:31], v[220:223]
v_fmac_f32 v170, v62, v84
v_fmac_f32 v143, v59, v82
v_mfma_f32_16x16x32_bf16 v[220:223], a[112:115], a[24:27], v[220:223]
s_xor_b32 s99, s98, 0x2000
s_waitcnt lgkmcnt(0)
v_mfma_f32_16x16x32_bf16 v[224:227], a[128:131], a[24:27], v[224:227]
ds_read_b128 a[96:99], v5 offset:14336
v_fmac_f32 v146, v62, v82
v_mfma_f32_16x16x32_bf16 v[224:227], a[132:135], a[28:31], v[224:227]
buffer_load_dwordx4 a[88:91], v2, s[40:43], s35 offen offset:3072 sc1
s_and_b32 s91, s29, 4
v_mfma_f32_16x16x32_bf16 v[200:203], a[132:135], a[20:23], v[200:203]
ds_read_b128 a[100:103], v5 offset:20480
v_fmac_f32 v150, v66, v82
v_mfma_f32_16x16x32_bf16 v[200:203], a[128:131], a[16:19], v[200:203]
v_fmac_f32 v167, v59, v84
v_fmac_f32 v191, v59, v86
v_mfma_f32_16x16x32_bf16 v[176:179], a[128:131], a[8:11], v[176:179]
v_fmac_f32 v174, v66, v84
v_fmac_f32 v215, v59, v88
v_mfma_f32_16x16x32_bf16 v[176:179], a[132:135], a[12:15], v[176:179]
ds_read_b128 a[104:107], v5 offset:15360
s_lshl_b32 s91, s91, 11
v_mfma_f32_16x16x32_bf16 v[152:155], a[132:135], a[4:7], v[152:155]
v_fmac_f32 v198, v66, v86
v_fmac_f32 v219, v63, v88
v_mfma_f32_16x16x32_bf16 v[152:155], a[128:131], a[0:3], v[152:155]
buffer_load_dwordx4 v1, s[4:7], s44 offen offset:0 sc1 lds
s_xor_b32 s96, s98, s91
v_mfma_f32_16x16x32_bf16 v[132:135], a[136:139], a[0:3], v[132:135]
ds_read_b128 a[108:111], v5 offset:21504
v_fmac_f32 v222, v66, v88
v_mfma_f32_16x16x32_bf16 v[132:135], a[140:143], a[4:7], v[132:135]
v_fmac_f32 v195, v63, v86
s_lshl_b32 s97, s81, 10
v_mfma_f32_16x16x32_bf16 v[156:159], a[140:143], a[12:15], v[156:159]
ds_read_b128 a[112:115], v5 offset:16384
v_fmac_f32 v226, v70, v88
v_mfma_f32_16x16x32_bf16 v[156:159], a[136:139], a[8:11], v[156:159]
v_fmac_f32 v171, v63, v84
s_add_u32 s96, s96, s97
v_mfma_f32_16x16x32_bf16 v[180:183], a[136:139], a[16:19], v[180:183]
v_fmac_f32 v202, v70, v86
v_fmac_f32 v147, v63, v82
v_mfma_f32_16x16x32_bf16 v[180:183], a[140:143], a[20:23], v[180:183]
buffer_load_dwordx4 a[92:95], v2, s[40:43], s33 offen offset:3072 sc1
s_add_u32 s35, s35, 0x4000
v_mfma_f32_16x16x32_bf16 v[204:207], a[140:143], a[28:31], v[204:207]
s_add_u32 s33, s33, 0x4000
ds_read_b128 a[116:119], v5 offset:22528
v_mfma_f32_16x16x32_bf16 v[204:207], a[136:139], a[24:27], v[204:207]
v_fmac_f32 v178, v70, v84
v_fmac_f32 v151, v67, v82
v_mfma_f32_16x16x32_bf16 v[208:211], a[144:147], a[24:27], v[208:211]
v_fmac_f32 v154, v70, v82
v_fmac_f32 v175, v67, v84
v_mfma_f32_16x16x32_bf16 v[208:211], a[148:151], a[28:31], v[208:211]
s_lshr_b32 s100, s37, 4
s_lshl_b32 s100, s100, 14
s_and_b32 s37, s37, 15
v_mfma_f32_16x16x32_bf16 v[184:187], a[148:151], a[20:23], v[184:187]
v_fmac_f32 v134, v50, v82
v_fmac_f32 v199, v67, v86
v_mfma_f32_16x16x32_bf16 v[184:187], a[144:147], a[16:19], v[184:187]
buffer_load_dwordx4 v1, s[4:7], s44 offen offset:1024 sc1 lds
s_lshl_b32 s37, s37, 9
v_mfma_f32_16x16x32_bf16 v[160:163], a[144:147], a[8:11], v[160:163]
v_fmac_f32 v158, v50, v84
v_fmac_f32 v223, v67, v88
v_mfma_f32_16x16x32_bf16 v[160:163], a[148:151], a[12:15], v[160:163]
s_add_u32 s100, s100, s37
s_add_u32 s100, s100, 0x820000
s_xor_b32 s91, s91, s90
v_mfma_f32_16x16x32_bf16 v[136:139], a[148:151], a[4:7], v[136:139]
v_fmac_f32 v182, v50, v86
v_fmac_f32 v227, v71, v88
v_mfma_f32_16x16x32_bf16 v[136:139], a[144:147], a[0:3], v[136:139]
s_waitcnt vmcnt(10) lgkmcnt(0)
s_barrier
v_mfma_f32_16x16x32_bf16 v[140:143], a[96:99], a[32:35], v[140:143]
ds_read_b128 a[128:131], v5 offset:17408
v_fmac_f32 v206, v50, v88
v_mfma_f32_16x16x32_bf16 v[140:143], a[100:103], a[36:39], v[140:143]
buffer_load_dwordx4 a[0:3], v2, s[40:43], s35 offen offset:0 sc1
s_lshl_b32 s97, s81, 7
v_mfma_f32_16x16x32_bf16 v[164:167], a[100:103], a[44:47], v[164:167]
ds_read_b128 a[132:135], v5 offset:23552
v_fmac_f32 v210, v54, v88
v_mfma_f32_16x16x32_bf16 v[164:167], a[96:99], a[40:43], v[164:167]
v_fmac_f32 v203, v71, v86
v_fmac_f32 v179, v71, v84
v_mfma_f32_16x16x32_bf16 v[188:191], a[96:99], a[48:51], v[188:191]
buffer_load_dwordx4 a[4:7], v2, s[40:43], s33 offen offset:0 sc1
s_add_u32 s97, s97, s91
v_mfma_f32_16x16x32_bf16 v[188:191], a[100:103], a[52:55], v[188:191]
ds_read_b128 a[136:139], v5 offset:26624
v_fmac_f32 v186, v54, v86
v_mfma_f32_16x16x32_bf16 v[212:215], a[100:103], a[60:63], v[212:215]
v_fmac_f32 v162, v54, v84
v_fmac_f32 v155, v71, v82
v_mfma_f32_16x16x32_bf16 v[212:215], a[96:99], a[56:59], v[212:215]
buffer_load_dwordx4 a[8:11], v2, s[40:43], s35 offen offset:1024 sc1
s_add_u32 s97, s97, s100
v_mfma_f32_16x16x32_bf16 v[216:219], a[104:107], a[56:59], v[216:219]
ds_read_b128 a[140:143], v5 offset:32768
v_fmac_f32 v138, v54, v82
v_mfma_f32_16x16x32_bf16 v[216:219], a[108:111], a[60:63], v[216:219]
v_fmac_f32 v135, v51, v82
v_fmac_f32 v159, v51, v84
v_mfma_f32_16x16x32_bf16 v[192:195], a[108:111], a[52:55], v[192:195]
buffer_load_dwordx4 a[12:15], v2, s[40:43], s33 offen offset:1024 sc1
s_bfe_u32 s37, s30, 0x10002
v_mfma_f32_16x16x32_bf16 v[192:195], a[104:107], a[48:51], v[192:195]
ds_read_b128 a[144:147], v5 offset:27648
v_fmac_f32 v183, v51, v86
v_mfma_f32_16x16x32_bf16 v[168:171], a[104:107], a[40:43], v[168:171]
v_fmac_f32 v207, v51, v88
s_xor_b32 s37, s37, s51
v_mfma_f32_16x16x32_bf16 v[168:171], a[108:111], a[44:47], v[168:171]
buffer_load_dwordx4 a[16:19], v2, s[40:43], s35 offen offset:2048 sc1
s_lshr_b32 s89, s29, 2
v_mfma_f32_16x16x32_bf16 v[144:147], a[108:111], a[36:39], v[144:147]
ds_read_b128 a[148:151], v5 offset:33792
v_fmac_f32 v211, v55, v88
v_mfma_f32_16x16x32_bf16 v[144:147], a[104:107], a[32:35], v[144:147]
v_mul_f32 v88, 0x3fb8aa3b, v89
s_xor_b32 s89, s89, s37
v_mfma_f32_16x16x32_bf16 v[148:151], a[112:115], a[32:35], v[148:151]
buffer_load_dwordx4 a[20:23], v2, s[40:43], s33 offen offset:2048 sc1
s_lshl_b32 s88, s28, 6
v_mfma_f32_16x16x32_bf16 v[148:151], a[116:119], a[36:39], v[148:151]
v_fmac_f32 v187, v55, v86
s_add_u32 s94, s80, s88
v_mfma_f32_16x16x32_bf16 v[172:175], a[116:119], a[44:47], v[172:175]
v_fmac_f32 v163, v55, v84
v_mul_f32 v86, 0x3fb8aa3b, v87
v_mfma_f32_16x16x32_bf16 v[172:175], a[112:115], a[40:43], v[172:175]
buffer_load_dwordx4 a[24:27], v2, s[40:43], s35 offen offset:3072 sc1
s_add_u32 s94, s94, 0x90000
v_mfma_f32_16x16x32_bf16 v[196:199], a[112:115], a[48:51], v[196:199]
v_fmac_f32 v139, v55, v82
v_mul_f32 v84, 0x3fb8aa3b, v85
v_mfma_f32_16x16x32_bf16 v[196:199], a[116:119], a[52:55], v[196:199]
v_mul_f32 v82, 0x3fb8aa3b, v83
s_mul_i32 s89, s89, 0x1a00000
v_mfma_f32_16x16x32_bf16 v[220:223], a[116:119], a[60:63], v[220:223]
buffer_load_dwordx4 a[28:31], v2, s[40:43], s33 offen offset:3072 sc1
s_add_u32 s35, s35, 0x64000
v_mfma_f32_16x16x32_bf16 v[220:223], a[112:115], a[56:59], v[220:223]
s_add_u32 s33, s33, 0x64000
s_waitcnt lgkmcnt(0)
v_mfma_f32_16x16x32_bf16 v[224:227], a[128:131], a[56:59], v[224:227]
ds_read_b128 a[96:99], v5 offset:28672
s_add_u32 s88, s88, s70
v_mfma_f32_16x16x32_bf16 v[224:227], a[132:135], a[60:63], v[224:227]
buffer_load_dwordx4 v1, s[4:7], s44 offen offset:2048 sc1 lds
s_add_u32 s88, s88, s89
v_mfma_f32_16x16x32_bf16 v[200:203], a[132:135], a[52:55], v[200:203]
ds_read_b128 a[100:103], v5 offset:34816
s_add_u32 s89, s88, 0x90000
v_mfma_f32_16x16x32_bf16 v[200:203], a[128:131], a[48:51], v[200:203]
v_add_u32 v233, s19, v232
s_add_u32 s74, s71, 0x30080
v_mfma_f32_16x16x32_bf16 v[176:179], a[128:131], a[40:43], v[176:179]
s_add_u32 s72, s79, 0x2800000
s_add_u32 s73, s79, 0x2400000
s_lshr_b32 s38, s28, 1
v_mfma_f32_16x16x32_bf16 v[176:179], a[132:135], a[44:47], v[176:179]
ds_read_b128 a[104:107], v5 offset:29696
s_and_b32 s39, s28, 1
v_mfma_f32_16x16x32_bf16 v[152:155], a[132:135], a[36:39], v[152:155]
s_mul_i32 s38, s38, 3072
s_lshl_b32 s39, s39, 3
s_add_u32 s38, s38, s39
v_mfma_f32_16x16x32_bf16 v[152:155], a[128:131], a[32:35], v[152:155]
v_and_b32 v248, 4, v0
v_lshlrev_b32 v248, 11, v248
s_waitcnt vmcnt(18)
v_mfma_f32_16x16x32_bf16 v[140:143], a[136:139], a[64:67], v[140:143]
ds_read_b128 a[108:111], v5 offset:35840
v_bfe_u32 v235, v0, 2, 1
s_waitcnt vmcnt(17)
v_mfma_f32_16x16x32_bf16 v[140:143], a[140:143], a[68:71], v[140:143]
v_xor_b32 v248, s90, v248
v_and_b32 v249, 3, v0
s_waitcnt vmcnt(15)
v_mfma_f32_16x16x32_bf16 v[164:167], a[140:143], a[76:79], v[164:167]
ds_read_b128 a[112:115], v5 offset:38912
v_xor_b32 v235, s37, v235
v_mfma_f32_16x16x32_bf16 v[164:167], a[136:139], a[72:75], v[164:167]
v_lshl_add_u32 v248, v249, 7, v248
v_mul_u32_u24 v235, 106496, v235
s_waitcnt vmcnt(14)
v_mfma_f32_16x16x32_bf16 v[188:191], a[136:139], a[80:83], v[188:191]
v_lshrrev_b32 v249, 4, v0
v_add_lshl_u32 v235, v235, v0, 8
s_waitcnt vmcnt(13)
v_mfma_f32_16x16x32_bf16 v[188:191], a[140:143], a[84:87], v[188:191]
buffer_load_dwordx4 v1, s[4:7], s44 offen offset:3072 sc1 lds
s_add_u32 m0, s19, 65536
s_waitcnt vmcnt(11)
v_mfma_f32_16x16x32_bf16 v[212:215], a[140:143], a[92:95], v[212:215]
s_add_u32 s44, s84, 0xc08000
ds_read_b128 a[116:119], v5 offset:45056
v_mfma_f32_16x16x32_bf16 v[212:215], a[136:139], a[88:91], v[212:215]
v_lshl_add_u32 v248, v249, 4, v248
v_add_u32 v234, s36, v8
v_mfma_f32_16x16x32_bf16 v[216:219], a[144:147], a[88:91], v[216:219]
v_cndmask_b32 v235, 2.0, v235, s[64:65]
v_mov_b32 v249, 0x3f80
v_mfma_f32_16x16x32_bf16 v[216:219], a[148:151], a[92:95], v[216:219]
v_mov_b32 v250, 1.0
v_add_u32 v252, s38, v1
v_mfma_f32_16x16x32_bf16 v[192:195], a[148:151], a[84:87], v[192:195]
v_mfma_f32_16x16x32_bf16 v[192:195], a[144:147], a[80:83], v[192:195]
v_mfma_f32_16x16x32_bf16 v[168:171], a[144:147], a[72:75], v[168:171]
v_mfma_f32_16x16x32_bf16 v[168:171], a[148:151], a[76:79], v[168:171]
v_mfma_f32_16x16x32_bf16 v[144:147], a[148:151], a[68:71], v[144:147]
v_mfma_f32_16x16x32_bf16 v[144:147], a[144:147], a[64:67], v[144:147]
s_waitcnt lgkmcnt(0)
v_mfma_f32_16x16x32_bf16 v[148:151], a[96:99], a[64:67], v[148:151]
ds_read_b128 a[128:131], v5 offset:39936
v_mfma_f32_16x16x32_bf16 v[148:151], a[100:103], a[68:71], v[148:151]
buffer_load_dwordx4 v1, s[4:7], s44 offen offset:0 sc1 lds
v_mfma_f32_16x16x32_bf16 v[172:175], a[100:103], a[76:79], v[172:175]
ds_read_b128 a[132:135], v5 offset:46080
v_mfma_f32_16x16x32_bf16 v[172:175], a[96:99], a[72:75], v[172:175]
v_mfma_f32_16x16x32_bf16 v[196:199], a[96:99], a[80:83], v[196:199]
v_mfma_f32_16x16x32_bf16 v[196:199], a[100:103], a[84:87], v[196:199]
buffer_load_dwordx4 v1, s[4:7], s44 offen offset:1024 sc1 lds
v_mfma_f32_16x16x32_bf16 v[220:223], a[100:103], a[92:95], v[220:223]
ds_read_b128 a[136:139], v5 offset:40960
v_mfma_f32_16x16x32_bf16 v[220:223], a[96:99], a[88:91], v[220:223]
v_mfma_f32_16x16x32_bf16 v[224:227], a[104:107], a[88:91], v[224:227]
ds_read_b128 a[140:143], v5 offset:47104
v_mfma_f32_16x16x32_bf16 v[224:227], a[108:111], a[92:95], v[224:227]
v_mfma_f32_16x16x32_bf16 v[200:203], a[108:111], a[84:87], v[200:203]
buffer_load_dwordx4 v1, s[4:7], s44 offen offset:2048 sc1 lds
v_mfma_f32_16x16x32_bf16 v[200:203], a[104:107], a[80:83], v[200:203]
ds_read_b128 a[144:147], v5 offset:41984
L_stub17:
s_cbranch_execz L_stub18
v_mfma_f32_16x16x32_bf16 v[176:179], a[104:107], a[72:75], v[176:179]
v_mfma_f32_16x16x32_bf16 v[176:179], a[108:111], a[76:79], v[176:179]
ds_read_b128 a[148:151], v5 offset:48128
v_mfma_f32_16x16x32_bf16 v[152:155], a[108:111], a[68:71], v[152:155]
v_mfma_f32_16x16x32_bf16 v[152:155], a[104:107], a[64:67], v[152:155]
buffer_load_dwordx4 v1, s[4:7], s44 offen offset:3072 sc1 lds
s_add_u32 m0, s19, 81920
s_waitcnt vmcnt(13)
v_mfma_f32_16x16x32_bf16 v[140:143], a[112:115], a[0:3], v[140:143]
s_add_u32 s44, s85, 0xc0c000
s_waitcnt vmcnt(12)
v_mfma_f32_16x16x32_bf16 v[140:143], a[116:119], a[4:7], v[140:143]
s_waitcnt vmcnt(10)
v_mfma_f32_16x16x32_bf16 v[164:167], a[116:119], a[12:15], v[164:167]
v_mfma_f32_16x16x32_bf16 v[164:167], a[112:115], a[8:11], v[164:167]
s_waitcnt vmcnt(9)
v_mfma_f32_16x16x32_bf16 v[188:191], a[112:115], a[16:19], v[188:191]
buffer_load_dwordx4 v1, s[4:7], s44 offen offset:0 sc1 lds
s_waitcnt vmcnt(9)
v_mfma_f32_16x16x32_bf16 v[188:191], a[116:119], a[20:23], v[188:191]
s_waitcnt vmcnt(7)
v_mfma_f32_16x16x32_bf16 v[212:215], a[116:119], a[28:31], v[212:215]
v_mfma_f32_16x16x32_bf16 v[212:215], a[112:115], a[24:27], v[212:215]
s_waitcnt lgkmcnt(0)
v_mfma_f32_16x16x32_bf16 v[216:219], a[128:131], a[24:27], v[216:219]
ds_read_b128 a[96:99], v5 offset:12288
v_cvt_pk_bf16_f32 v140, v140, v141
v_mfma_f32_16x16x32_bf16 v[216:219], a[132:135], a[28:31], v[216:219]
buffer_load_dwordx4 v1, s[4:7], s44 offen offset:1024 sc1 lds
v_mfma_f32_16x16x32_bf16 v[192:195], a[132:135], a[20:23], v[192:195]
ds_read_b128 a[100:103], v5 offset:18432
v_cvt_pk_bf16_f32 v141, v142, v143
v_mfma_f32_16x16x32_bf16 v[192:195], a[128:131], a[16:19], v[192:195]
v_cvt_pk_bf16_f32 v164, v164, v165
v_cvt_pk_bf16_f32 v165, v166, v167
v_mfma_f32_16x16x32_bf16 v[168:171], a[128:131], a[8:11], v[168:171]
v_cvt_pk_bf16_f32 v188, v188, v189
v_cvt_pk_bf16_f32 v189, v190, v191
v_mfma_f32_16x16x32_bf16 v[168:171], a[132:135], a[12:15], v[168:171]
buffer_load_dwordx4 v1, s[4:7], s44 offen offset:2048 sc1 lds
v_mfma_f32_16x16x32_bf16 v[144:147], a[132:135], a[4:7], v[144:147]
ds_read_b128 a[104:107], v5 offset:24576
v_cvt_pk_bf16_f32 v212, v212, v213
v_mfma_f32_16x16x32_bf16 v[144:147], a[128:131], a[0:3], v[144:147]
v_cvt_pk_bf16_f32 v213, v214, v215
v_mfma_f32_16x16x32_bf16 v[148:151], a[136:139], a[0:3], v[148:151]
ds_read_b128 a[108:111], v5 offset:30720
v_cvt_pk_bf16_f32 v214, v216, v217
v_mfma_f32_16x16x32_bf16 v[148:151], a[140:143], a[4:7], v[148:151]
v_cvt_pk_bf16_f32 v215, v218, v219
v_mfma_f32_16x16x32_bf16 v[172:175], a[140:143], a[12:15], v[172:175]
buffer_load_dwordx4 v1, s[4:7], s44 offen offset:3072 sc1 lds
s_add_u32 m0, s19, 147456
v_mfma_f32_16x16x32_bf16 v[172:175], a[136:139], a[8:11], v[172:175]
s_add_u32 s44, s87, 0xc1c000
ds_read_b128 a[112:115], v5 offset:36864
v_mfma_f32_16x16x32_bf16 v[196:199], a[136:139], a[16:19], v[196:199]
v_cvt_pk_bf16_f32 v166, v168, v169
v_cvt_pk_bf16_f32 v167, v170, v171
v_mfma_f32_16x16x32_bf16 v[196:199], a[140:143], a[20:23], v[196:199]
ds_read_b128 a[116:119], v5 offset:43008
v_cvt_pk_bf16_f32 v190, v192, v193
v_mfma_f32_16x16x32_bf16 v[220:223], a[140:143], a[28:31], v[220:223]
v_cvt_pk_bf16_f32 v142, v144, v145
v_cvt_pk_bf16_f32 v143, v146, v147
v_mfma_f32_16x16x32_bf16 v[220:223], a[136:139], a[24:27], v[220:223]
buffer_load_dwordx4 v1, s[4:7], s44 offen offset:0 sc1 lds
v_mfma_f32_16x16x32_bf16 v[224:227], a[144:147], a[24:27], v[224:227]
v_mfma_f32_16x16x32_bf16 v[92:95], a[240:243], v[140:143], 0
v_mfma_f32_16x16x32_bf16 v[224:227], a[148:151], a[28:31], v[224:227]
v_mfma_f32_16x16x32_bf16 v[96:99], a[244:247], v[140:143], 0
v_mfma_f32_16x16x32_bf16 v[200:203], a[148:151], a[20:23], v[200:203]
v_mfma_f32_16x16x32_bf16 v[100:103], a[240:243], v[164:167], 0
v_mfma_f32_16x16x32_bf16 v[200:203], a[144:147], a[16:19], v[200:203]
v_mfma_f32_16x16x32_bf16 v[104:107], a[244:247], v[164:167], 0
v_mfma_f32_16x16x32_bf16 v[176:179], a[144:147], a[8:11], v[176:179]
buffer_load_dwordx4 v1, s[4:7], s44 offen offset:1024 sc1 lds
v_mfma_f32_16x16x32_bf16 v[176:179], a[148:151], a[12:15], v[176:179]
v_max3_f32 v236, v92, v93, v94
v_max3_f32 v237, -v92, -v93, -v94
v_mfma_f32_16x16x32_bf16 v[152:155], a[148:151], a[4:7], v[152:155]
v_max3_f32 v236, v236, v95, v96
v_max3_f32 v237, v237, -v95, -v96
v_mfma_f32_16x16x32_bf16 v[152:155], a[144:147], a[0:3], v[152:155]
v_max3_f32 v236, v236, v97, v98
s_waitcnt lgkmcnt(0)
v_mfma_f32_16x16x32_bf16 v[132:135], a[96:99], a[32:35], v[132:135]
ds_read_b128 a[128:131], v5 offset:13312
v_max3_f32 v237, v237, -v97, -v98
v_mfma_f32_16x16x32_bf16 v[132:135], a[100:103], a[36:39], v[132:135]
buffer_load_dwordx4 v1, s[4:7], s44 offen offset:2048 sc1 lds
v_mfma_f32_16x16x32_bf16 v[156:159], a[100:103], a[44:47], v[156:159]
ds_read_b128 a[132:135], v5 offset:19456
v_max_f32 v236, v236, v99
v_mfma_f32_16x16x32_bf16 v[156:159], a[96:99], a[40:43], v[156:159]
v_max_f32_e64 v237, v237, -v99
v_max3_f32 v238, v100, v101, v102
v_mfma_f32_16x16x32_bf16 v[180:183], a[96:99], a[48:51], v[180:183]
v_permlane32_swap_b32 v236, v237
v_mfma_f32_16x16x32_bf16 v[180:183], a[100:103], a[52:55], v[180:183]
buffer_load_dwordx4 v1, s[4:7], s44 offen offset:3072 sc1 lds
s_add_u32 m0, s19, 98304
v_mfma_f32_16x16x32_bf16 v[204:207], a[100:103], a[60:63], v[204:207]
s_add_u32 s44, s84, 0xc10000
ds_read_b128 a[136:139], v5 offset:25600
v_mfma_f32_16x16x32_bf16 v[204:207], a[96:99], a[56:59], v[204:207]
v_max_f32 v236, v236, v237
v_mov_b32 v244, v236
v_mfma_f32_16x16x32_bf16 v[204:207], a[104:107], a[88:91], v[204:207]
ds_read_b128 a[140:143], v5 offset:31744
v_max3_f32 v239, -v100, -v101, -v102
v_mfma_f32_16x16x32_bf16 v[204:207], a[108:111], a[92:95], v[204:207]
v_permlane16_swap_b32 v236, v244
v_mfma_f32_16x16x32_bf16 v[180:183], a[108:111], a[84:87], v[180:183]
buffer_load_dwordx4 v1, s[4:7], s44 offen offset:0 sc1 lds
v_mfma_f32_16x16x32_bf16 v[180:183], a[104:107], a[80:83], v[180:183]
ds_read_b128 a[144:147], v5 offset:37888
v_max_f32 v236, v236, v244
v_mfma_f32_16x16x32_bf16 v[156:159], a[104:107], a[72:75], v[156:159]
v_mov_b32 v244, v236
v_max3_f32 v238, v238, v103, v104
v_mfma_f32_16x16x32_bf16 v[156:159], a[108:111], a[76:79], v[156:159]
ds_read_b128 a[148:151], v5 offset:44032
v_max3_f32 v239, v239, -v103, -v104
v_mfma_f32_16x16x32_bf16 v[132:135], a[108:111], a[68:71], v[132:135]
v_permlane32_swap_b32 v236, v244
v_mfma_f32_16x16x32_bf16 v[132:135], a[104:107], a[64:67], v[132:135]
buffer_load_dwordx4 v1, s[4:7], s44 offen offset:1024 sc1 lds
v_mfma_f32_16x16x32_bf16 v[132:135], a[112:115], a[0:3], v[132:135]
v_mul_f32_e64 v236, -v236, v82
v_mul_f32_e64 v237, -v244, v82
v_mfma_f32_16x16x32_bf16 v[132:135], a[116:119], a[4:7], v[132:135]
v_max3_f32 v238, v238, v105, v106
v_max3_f32 v239, v239, -v105, -v106
v_mfma_f32_16x16x32_bf16 v[156:159], a[116:119], a[12:15], v[156:159]
v_max_f32 v238, v238, v107
v_max_f32_e64 v239, v239, -v107
v_mfma_f32_16x16x32_bf16 v[156:159], a[112:115], a[8:11], v[156:159]
s_nop 0
v_permlane32_swap_b32 v238, v239
v_mfma_f32_16x16x32_bf16 v[180:183], a[112:115], a[16:19], v[180:183]
buffer_load_dwordx4 v1, s[4:7], s44 offen offset:2048 sc1 lds
v_mfma_f32_16x16x32_bf16 v[180:183], a[116:119], a[20:23], v[180:183]
v_max_f32 v238, v238, v239
v_mov_b32 v245, v238
v_mfma_f32_16x16x32_bf16 v[204:207], a[116:119], a[28:31], v[204:207]
s_nop 0
v_permlane16_swap_b32 v238, v245
v_mfma_f32_16x16x32_bf16 v[204:207], a[112:115], a[24:27], v[204:207]
s_waitcnt lgkmcnt(0)
s_barrier
v_mfma_f32_16x16x32_bf16 v[208:211], a[128:131], a[56:59], v[208:211]
v_max_f32 v238, v238, v245
v_mov_b32 v245, v238
v_mfma_f32_16x16x32_bf16 v[208:211], a[132:135], a[60:63], v[208:211]
buffer_load_dwordx4 v1, s[4:7], s44 offen offset:3072 sc1 lds
s_add_u32 m0, s19, 114688
v_mfma_f32_16x16x32_bf16 v[184:187], a[132:135], a[52:55], v[184:187]
s_add_u32 s44, s85, 0xc14000
v_cvt_pk_bf16_f32 v191, v194, v195
v_mfma_f32_16x16x32_bf16 v[184:187], a[128:131], a[48:51], v[184:187]
v_permlane32_swap_b32 v238, v245
v_mfma_f32_16x16x32_bf16 v[160:163], a[128:131], a[40:43], v[160:163]
v_mul_f32_e64 v238, -v238, v84
v_mul_f32_e64 v239, -v245, v84
v_mfma_f32_16x16x32_bf16 v[160:163], a[132:135], a[44:47], v[160:163]
buffer_load_dwordx4 v1, s[4:7], s44 offen offset:0 sc1 lds
v_mfma_f32_16x16x32_bf16 v[136:139], a[132:135], a[36:39], v[136:139]
v_mfma_f32_16x16x32_bf16 v[108:111], a[240:243], v[188:191], 0
v_mfma_f32_16x16x32_bf16 v[136:139], a[128:131], a[32:35], v[136:139]
v_mfma_f32_16x16x32_bf16 v[112:115], a[244:247], v[188:191], 0
v_mfma_f32_16x16x32_bf16 v[136:139], a[136:139], a[64:67], v[136:139]
v_mfma_f32_16x16x32_bf16 v[116:119], a[240:243], v[212:215], 0
v_mfma_f32_16x16x32_bf16 v[136:139], a[140:143], a[68:71], v[136:139]
v_mfma_f32_16x16x32_bf16 v[120:123], a[244:247], v[212:215], 0
v_mfma_f32_16x16x32_bf16 v[160:163], a[140:143], a[76:79], v[160:163]
buffer_load_dwordx4 v1, s[4:7], s44 offen offset:1024 sc1 lds
v_mfma_f32_16x16x32_bf16 v[160:163], a[136:139], a[72:75], v[160:163]
v_max3_f32 v240, v108, v109, v110
v_max3_f32 v241, -v108, -v109, -v110
v_mfma_f32_16x16x32_bf16 v[184:187], a[136:139], a[80:83], v[184:187]
v_max3_f32 v240, v240, v111, v112
v_max3_f32 v241, v241, -v111, -v112
v_mfma_f32_16x16x32_bf16 v[184:187], a[140:143], a[84:87], v[184:187]
v_max3_f32 v240, v240, v113, v114
v_max3_f32 v241, v241, -v113, -v114
v_mfma_f32_16x16x32_bf16 v[208:211], a[140:143], a[92:95], v[208:211]
v_max_f32 v240, v240, v115
v_max_f32_e64 v241, v241, -v115
v_mfma_f32_16x16x32_bf16 v[208:211], a[136:139], a[88:91], v[208:211]
buffer_load_dwordx4 v1, s[4:7], s44 offen offset:2048 sc1 lds
v_mfma_f32_16x16x32_bf16 v[208:211], a[144:147], a[24:27], v[208:211]
v_permlane32_swap_b32 v240, v241
v_mfma_f32_16x16x32_bf16 v[208:211], a[148:151], a[28:31], v[208:211]
v_max_f32 v240, v240, v241
v_mov_b32 v246, v240
v_mfma_f32_16x16x32_bf16 v[184:187], a[148:151], a[20:23], v[184:187]
s_nop 0
v_permlane16_swap_b32 v240, v246
v_mfma_f32_16x16x32_bf16 v[184:187], a[144:147], a[16:19], v[184:187]
v_max_f32 v240, v240, v246
v_mov_b32 v246, v240
v_mfma_f32_16x16x32_bf16 v[160:163], a[144:147], a[8:11], v[160:163]
buffer_load_dwordx4 v1, s[4:7], s44 offen offset:3072 sc1 lds
v_mfma_f32_16x16x32_bf16 v[160:163], a[148:151], a[12:15], v[160:163]
v_permlane32_swap_b32 v240, v246
v_mfma_f32_16x16x32_bf16 v[136:139], a[148:151], a[4:7], v[136:139]
v_mul_f32_e64 v240, -v240, v86
v_mul_f32_e64 v241, -v246, v86
v_mfma_f32_16x16x32_bf16 v[136:139], a[144:147], a[0:3], v[136:139]
v_max3_f32 v242, v116, v117, v118
v_max3_f32 v243, -v116, -v117, -v118
v_pk_mul_f32 v[148:149], v[148:149], v[82:83] op_sel:[0,1] op_sel_hi:[1,1]
v_pk_mul_f32 v[150:151], v[150:151], v[82:83] op_sel:[0,1] op_sel_hi:[1,1]
v_cvt_pk_bf16_f32 v148, v148, v149
v_cvt_pk_bf16_f32 v149, v150, v151
ds_write_b64 v232, v[148:149] offset:0
v_pk_mul_f32 v[152:153], v[152:153], v[82:83] op_sel:[0,1] op_sel_hi:[1,1]
v_pk_mul_f32 v[154:155], v[154:155], v[82:83] op_sel:[0,1] op_sel_hi:[1,1]
v_cvt_pk_bf16_f32 v150, v152, v153
v_cvt_pk_bf16_f32 v151, v154, v155
v_pk_mul_f32 v[172:173], v[172:173], v[84:85] op_sel:[0,1] op_sel_hi:[1,1]
v_pk_mul_f32 v[174:175], v[174:175], v[84:85] op_sel:[0,1] op_sel_hi:[1,1]
v_cvt_pk_bf16_f32 v172, v172, v173
v_cvt_pk_bf16_f32 v173, v174, v175
v_pk_mul_f32 v[176:177], v[176:177], v[84:85] op_sel:[0,1] op_sel_hi:[1,1]
v_pk_mul_f32 v[178:179], v[178:179], v[84:85] op_sel:[0,1] op_sel_hi:[1,1]
v_cvt_pk_bf16_f32 v174, v176, v177
v_cvt_pk_bf16_f32 v175, v178, v179
ds_write_b64 v232, v[150:151] offset:512
v_pk_mul_f32 v[196:197], v[196:197], v[86:87] op_sel:[0,1] op_sel_hi:[1,1]
v_pk_mul_f32 v[198:199], v[198:199], v[86:87] op_sel:[0,1] op_sel_hi:[1,1]
v_cvt_pk_bf16_f32 v196, v196, v197
v_cvt_pk_bf16_f32 v197, v198, v199
buffer_store_dwordx4 a[248:251], v254, s[4:7], s97 offen offset:0 sc1
v_pk_mul_f32 v[200:201], v[200:201], v[86:87] op_sel:[0,1] op_sel_hi:[1,1]
v_pk_mul_f32 v[202:203], v[202:203], v[86:87] op_sel:[0,1] op_sel_hi:[1,1]
v_cvt_pk_bf16_f32 v198, v200, v201
v_cvt_pk_bf16_f32 v199, v202, v203
ds_write_b64 v232, v[172:173] offset:1024
v_pk_mul_f32 v[220:221], v[220:221], v[88:89] op_sel:[0,1] op_sel_hi:[1,1]
v_pk_mul_f32 v[222:223], v[222:223], v[88:89] op_sel:[0,1] op_sel_hi:[1,1]
v_cvt_pk_bf16_f32 v220, v220, v221
v_cvt_pk_bf16_f32 v221, v222, v223
v_pk_fma_f32 v[48:49], v[92:93], v[82:83], v[236:237] op_sel:[0,0,0] op_sel_hi:[1,0,0]
v_pk_fma_f32 v[50:51], v[94:95], v[82:83], v[236:237] op_sel:[0,0,0] op_sel_hi:[1,0,0]
v_pk_fma_f32 v[52:53], v[96:97], v[82:83], v[236:237] op_sel:[0,0,0] op_sel_hi:[1,0,0]
v_pk_fma_f32 v[54:55], v[98:99], v[82:83], v[236:237] op_sel:[0,0,0] op_sel_hi:[1,0,0]
v_exp_f32 v48, v48
v_exp_f32 v49, v49
ds_write_b64 v232, v[174:175] offset:1536
v_exp_f32 v50, v50
v_exp_f32 v51, v51
v_exp_f32 v52, v52
v_exp_f32 v53, v53
v_exp_f32 v54, v54
v_exp_f32 v55, v55
ds_write_b64 v232, v[196:197] offset:2048
buffer_store_dwordx4 a[248:251], v1, s[4:7], s96 offen offset:0 sc1
v_cvt_pk_bf16_f32 v140, v48, v49
v_cvt_pk_bf16_f32 v141, v50, v51
v_cvt_pk_bf16_f32 v142, v52, v53
v_cvt_pk_bf16_f32 v143, v54, v55
v_pk_mul_f32 v[224:225], v[224:225], v[88:89] op_sel:[0,1] op_sel_hi:[1,1]
v_pk_mul_f32 v[226:227], v[226:227], v[88:89] op_sel:[0,1] op_sel_hi:[1,1]
v_cvt_pk_bf16_f32 v222, v224, v225
v_mfma_f32_16x16x32_bf16 v[148:151], v[16:19], v[140:143], 0
ds_write_b64 v232, v[198:199] offset:2560
v_cvt_pk_bf16_f32 v223, v226, v227
s_add_u32 m0, s19, 131072
v_pk_fma_f32 v[92:93], v[92:93], v[82:83], v[236:237] op_sel:[0,0,1] op_sel_hi:[1,0,1] neg_lo:[1,0,0] neg_hi:[1,0,0]
v_pk_fma_f32 v[94:95], v[94:95], v[82:83], v[236:237] op_sel:[0,0,1] op_sel_hi:[1,0,1] neg_lo:[1,0,0] neg_hi:[1,0,0]
v_pk_fma_f32 v[96:97], v[96:97], v[82:83], v[236:237] op_sel:[0,0,1] op_sel_hi:[1,0,1] neg_lo:[1,0,0] neg_hi:[1,0,0]
s_nop 1
v_rcp_f32 v148, v148
v_pk_fma_f32 v[98:99], v[98:99], v[82:83], v[236:237] op_sel:[0,0,1] op_sel_hi:[1,0,1] neg_lo:[1,0,0] neg_hi:[1,0,0]
v_pk_mul_f32 v[48:49], v[48:49], v[148:149] op_sel:[0,0] op_sel_hi:[1,0]
v_pk_mul_f32 v[50:51], v[50:51], v[148:149] op_sel:[0,0] op_sel_hi:[1,0]
v_cvt_pk_bf16_f32 v140, v48, v49
v_cvt_pk_bf16_f32 v141, v50, v51
ds_write_b64 v232, v[220:221] offset:3072
v_exp_f32 v92, v92
v_exp_f32 v93, v93
v_exp_f32 v94, v94
v_exp_f32 v95, v95
v_exp_f32 v96, v96
v_exp_f32 v97, v97
ds_write_b64 v232, v[222:223] offset:3584
v_exp_f32 v98, v98
v_exp_f32 v99, v99
s_add_u32 s44, s86, 0xc18000
v_cvt_pk_bf16_f32 v144, v92, v93
v_cvt_pk_bf16_f32 v145, v94, v95
v_cvt_pk_bf16_f32 v146, v96, v97
v_cvt_pk_bf16_f32 v147, v98, v99
buffer_load_dwordx4 v1, s[4:7], s44 offen offset:0 sc1 lds
v_pk_mul_f32 v[52:53], v[52:53], v[148:149] op_sel:[0,0] op_sel_hi:[1,0]
ds_write_b64 v233, v[140:141] offset:16384
v_pk_mul_f32 v[54:55], v[54:55], v[148:149] op_sel:[0,0] op_sel_hi:[1,0]
v_cvt_pk_bf16_f32 v142, v52, v53
v_mfma_f32_16x16x32_bf16 v[152:155], v[16:19], v[144:147], 0
v_cvt_pk_bf16_f32 v143, v54, v55
v_max3_f32 v242, v242, v119, v120
v_max3_f32 v243, v243, -v119, -v120
v_max3_f32 v242, v242, v121, v122
v_max3_f32 v243, v243, -v121, -v122
v_pk_fma_f32 v[56:57], v[100:101], v[84:85], v[238:239] op_sel:[0,0,0] op_sel_hi:[1,0,0]
v_pk_fma_f32 v[58:59], v[102:103], v[84:85], v[238:239] op_sel:[0,0,0] op_sel_hi:[1,0,0]
v_pk_fma_f32 v[60:61], v[104:105], v[84:85], v[238:239] op_sel:[0,0,0] op_sel_hi:[1,0,0]
ds_write_b64 v233, v[142:143] offset:16896
v_rcp_f32 v152, v152
v_pk_fma_f32 v[62:63], v[106:107], v[84:85], v[238:239] op_sel:[0,0,0] op_sel_hi:[1,0,0]
v_pk_mul_f32 v[92:93], v[92:93], v[152:153] op_sel:[0,0] op_sel_hi:[1,0]
v_pk_mul_f32 v[94:95], v[94:95], v[152:153] op_sel:[0,0] op_sel_hi:[1,0]
v_cvt_pk_bf16_f32 v144, v92, v93
v_cvt_pk_bf16_f32 v145, v94, v95
v_exp_f32 v56, v56
v_exp_f32 v57, v57
v_exp_f32 v58, v58
ds_write_b64 v233, v[144:145] offset:17408
v_exp_f32 v59, v59
v_exp_f32 v60, v60
v_exp_f32 v61, v61
v_exp_f32 v62, v62
v_exp_f32 v63, v63
buffer_load_dwordx4 v1, s[4:7], s44 offen offset:1024 sc1 lds
v_cvt_pk_bf16_f32 v164, v56, v57
v_cvt_pk_bf16_f32 v165, v58, v59
v_cvt_pk_bf16_f32 v166, v60, v61
v_cvt_pk_bf16_f32 v167, v62, v63
v_pk_mul_f32 v[96:97], v[96:97], v[152:153] op_sel:[0,0] op_sel_hi:[1,0]
v_pk_mul_f32 v[98:99], v[98:99], v[152:153] op_sel:[0,0] op_sel_hi:[1,0]
v_cvt_pk_bf16_f32 v146, v96, v97
v_mfma_f32_16x16x32_bf16 v[172:175], v[16:19], v[164:167], 0
v_cvt_pk_bf16_f32 v147, v98, v99
ds_write_b64 v233, v[146:147] offset:17920
v_max_f32 v242, v242, v123
v_pk_fma_f32 v[100:101], v[100:101], v[84:85], v[238:239] op_sel:[0,0,1] op_sel_hi:[1,0,1] neg_lo:[1,0,0] neg_hi:[1,0,0]
v_pk_fma_f32 v[102:103], v[102:103], v[84:85], v[238:239] op_sel:[0,0,1] op_sel_hi:[1,0,1] neg_lo:[1,0,0] neg_hi:[1,0,0]
v_pk_fma_f32 v[104:105], v[104:105], v[84:85], v[238:239] op_sel:[0,0,1] op_sel_hi:[1,0,1] neg_lo:[1,0,0] neg_hi:[1,0,0]
s_nop 1
v_rcp_f32 v172, v172
v_pk_fma_f32 v[106:107], v[106:107], v[84:85], v[238:239] op_sel:[0,0,1] op_sel_hi:[1,0,1] neg_lo:[1,0,0] neg_hi:[1,0,0]
v_pk_mul_f32 v[56:57], v[56:57], v[172:173] op_sel:[0,0] op_sel_hi:[1,0]
v_pk_mul_f32 v[58:59], v[58:59], v[172:173] op_sel:[0,0] op_sel_hi:[1,0]
v_cvt_pk_bf16_f32 v164, v56, v57
v_cvt_pk_bf16_f32 v165, v58, v59
v_exp_f32 v100, v100
ds_write_b64 v233, v[164:165] offset:18432
v_exp_f32 v101, v101
v_exp_f32 v102, v102
v_exp_f32 v103, v103
v_exp_f32 v104, v104
v_exp_f32 v105, v105
v_exp_f32 v106, v106
v_exp_f32 v107, v107
buffer_load_dwordx4 v1, s[4:7], s44 offen offset:2048 sc1 lds
v_cvt_pk_bf16_f32 v168, v100, v101
v_cvt_pk_bf16_f32 v169, v102, v103
v_cvt_pk_bf16_f32 v170, v104, v105
v_cvt_pk_bf16_f32 v171, v106, v107
v_pk_mul_f32 v[60:61], v[60:61], v[172:173] op_sel:[0,0] op_sel_hi:[1,0]
v_pk_mul_f32 v[62:63], v[62:63], v[172:173] op_sel:[0,0] op_sel_hi:[1,0]
v_cvt_pk_bf16_f32 v166, v60, v61
v_mfma_f32_16x16x32_bf16 v[176:179], v[16:19], v[168:171], 0
v_cvt_pk_bf16_f32 v167, v62, v63
ds_write_b64 v233, v[166:167] offset:18944
v_max_f32_e64 v243, v243, -v123
v_pk_fma_f32 v[64:65], v[108:109], v[86:87], v[240:241] op_sel:[0,0,0] op_sel_hi:[1,0,0]
v_pk_fma_f32 v[66:67], v[110:111], v[86:87], v[240:241] op_sel:[0,0,0] op_sel_hi:[1,0,0]
v_pk_fma_f32 v[68:69], v[112:113], v[86:87], v[240:241] op_sel:[0,0,0] op_sel_hi:[1,0,0]
s_nop 1
v_rcp_f32 v176, v176
v_pk_fma_f32 v[70:71], v[114:115], v[86:87], v[240:241] op_sel:[0,0,0] op_sel_hi:[1,0,0]
v_pk_mul_f32 v[100:101], v[100:101], v[176:177] op_sel:[0,0] op_sel_hi:[1,0]
v_pk_mul_f32 v[102:103], v[102:103], v[176:177] op_sel:[0,0] op_sel_hi:[1,0]
v_cvt_pk_bf16_f32 v168, v100, v101
v_cvt_pk_bf16_f32 v169, v102, v103
v_exp_f32 v64, v64
ds_write_b64 v233, v[168:169] offset:19456
buffer_load_dwordx4 v1, s[4:7], s44 offen offset:3072 sc1 lds
v_exp_f32 v65, v65
v_exp_f32 v66, v66
v_exp_f32 v67, v67
v_exp_f32 v68, v68
v_exp_f32 v69, v69
v_exp_f32 v70, v70
v_exp_f32 v71, v71
v_cvt_pk_bf16_f32 v188, v64, v65
v_cvt_pk_bf16_f32 v189, v66, v67
v_cvt_pk_bf16_f32 v190, v68, v69
v_cvt_pk_bf16_f32 v191, v70, v71
v_pk_mul_f32 v[104:105], v[104:105], v[176:177] op_sel:[0,0] op_sel_hi:[1,0]
v_pk_mul_f32 v[106:107], v[106:107], v[176:177] op_sel:[0,0] op_sel_hi:[1,0]
v_cvt_pk_bf16_f32 v170, v104, v105
v_mfma_f32_16x16x32_bf16 v[196:199], v[16:19], v[188:191], 0
v_cvt_pk_bf16_f32 v171, v106, v107
ds_write_b64 v233, v[170:171] offset:19968
buffer_store_dwordx4 a[248:251], v2, s[4:7], s72 offen offset:0 sc1
s_nop 4
v_rcp_f32 v196, v196
v_pk_fma_f32 v[108:109], v[108:109], v[86:87], v[240:241] op_sel:[0,0,1] op_sel_hi:[1,0,1] neg_lo:[1,0,0] neg_hi:[1,0,0]
v_pk_mul_f32 v[64:65], v[64:65], v[196:197] op_sel:[0,0] op_sel_hi:[1,0]
v_pk_mul_f32 v[66:67], v[66:67], v[196:197] op_sel:[0,0] op_sel_hi:[1,0]
v_cvt_pk_bf16_f32 v188, v64, v65
v_cvt_pk_bf16_f32 v189, v66, v67
v_pk_fma_f32 v[110:111], v[110:111], v[86:87], v[240:241] op_sel:[0,0,1] op_sel_hi:[1,0,1] neg_lo:[1,0,0] neg_hi:[1,0,0]
ds_write_b64 v233, v[188:189] offset:20480
v_pk_fma_f32 v[112:113], v[112:113], v[86:87], v[240:241] op_sel:[0,0,1] op_sel_hi:[1,0,1] neg_lo:[1,0,0] neg_hi:[1,0,0]
v_pk_fma_f32 v[114:115], v[114:115], v[86:87], v[240:241] op_sel:[0,0,1] op_sel_hi:[1,0,1] neg_lo:[1,0,0] neg_hi:[1,0,0]
v_exp_f32 v108, v108
v_exp_f32 v109, v109
v_exp_f32 v110, v110
v_exp_f32 v111, v111
v_exp_f32 v112, v112
v_exp_f32 v113, v113
v_exp_f32 v114, v114
v_exp_f32 v115, v115
v_cvt_pk_bf16_f32 v192, v108, v109
v_cvt_pk_bf16_f32 v193, v110, v111
v_cvt_pk_bf16_f32 v194, v112, v113
v_cvt_pk_bf16_f32 v195, v114, v115
v_pk_mul_f32 v[68:69], v[68:69], v[196:197] op_sel:[0,0] op_sel_hi:[1,0]
v_pk_mul_f32 v[70:71], v[70:71], v[196:197] op_sel:[0,0] op_sel_hi:[1,0]
v_permlane32_swap_b32 v242, v243
v_mfma_f32_16x16x32_bf16 v[200:203], v[16:19], v[192:195], 0
v_cvt_pk_bf16_f32 v190, v68, v69
v_cvt_pk_bf16_f32 v191, v70, v71
ds_write_b64 v233, v[190:191] offset:20992
v_max_f32 v242, v242, v243
v_mov_b32 v247, v242
buffer_store_dwordx4 a[248:251], v2, s[4:7], s72 offen offset:1024 sc1
s_nop 0
v_permlane16_swap_b32 v242, v247
v_rcp_f32 v200, v200
v_max_f32 v242, v242, v247
v_mov_b32 v247, v242
v_pk_mul_f32 v[108:109], v[108:109], v[200:201] op_sel:[0,0] op_sel_hi:[1,0]
v_pk_mul_f32 v[110:111], v[110:111], v[200:201] op_sel:[0,0] op_sel_hi:[1,0]
v_cvt_pk_bf16_f32 v192, v108, v109
v_cvt_pk_bf16_f32 v193, v110, v111
v_permlane32_swap_b32 v242, v247
ds_write_b64 v233, v[192:193] offset:21504
v_mul_f32_e64 v242, -v242, v88
v_mul_f32_e64 v243, -v247, v88
v_pk_fma_f32 v[124:125], v[116:117], v[88:89], v[242:243] op_sel:[0,0,0] op_sel_hi:[1,0,0]
v_pk_fma_f32 v[126:127], v[118:119], v[88:89], v[242:243] op_sel:[0,0,0] op_sel_hi:[1,0,0]
v_pk_fma_f32 v[128:129], v[120:121], v[88:89], v[242:243] op_sel:[0,0,0] op_sel_hi:[1,0,0]
v_pk_fma_f32 v[130:131], v[122:123], v[88:89], v[242:243] op_sel:[0,0,0] op_sel_hi:[1,0,0]
v_exp_f32 v124, v124
v_exp_f32 v125, v125
v_exp_f32 v126, v126
v_exp_f32 v127, v127
v_exp_f32 v128, v128
v_exp_f32 v129, v129
v_exp_f32 v130, v130
v_exp_f32 v131, v131
v_cvt_pk_bf16_f32 v212, v124, v125
v_cvt_pk_bf16_f32 v213, v126, v127
v_cvt_pk_bf16_f32 v214, v128, v129
v_cvt_pk_bf16_f32 v215, v130, v131
v_pk_mul_f32 v[112:113], v[112:113], v[200:201] op_sel:[0,0] op_sel_hi:[1,0]
v_pk_mul_f32 v[114:115], v[114:115], v[200:201] op_sel:[0,0] op_sel_hi:[1,0]
v_cvt_pk_bf16_f32 v194, v112, v113
v_mfma_f32_16x16x32_bf16 v[220:223], v[16:19], v[212:215], 0
v_cvt_pk_bf16_f32 v195, v114, v115
ds_write_b64 v233, v[194:195] offset:22016
buffer_store_dwordx4 a[248:251], v2, s[4:7], s72 offen offset:2048 sc1
s_nop 4
v_rcp_f32 v220, v220
v_pk_fma_f32 v[116:117], v[116:117], v[88:89], v[242:243] op_sel:[0,0,1] op_sel_hi:[1,0,1] neg_lo:[1,0,0] neg_hi:[1,0,0]
v_pk_mul_f32 v[124:125], v[124:125], v[220:221] op_sel:[0,0] op_sel_hi:[1,0]
v_pk_mul_f32 v[126:127], v[126:127], v[220:221] op_sel:[0,0] op_sel_hi:[1,0]
v_cvt_pk_bf16_f32 v212, v124, v125
v_cvt_pk_bf16_f32 v213, v126, v127
v_pk_fma_f32 v[118:119], v[118:119], v[88:89], v[242:243] op_sel:[0,0,1] op_sel_hi:[1,0,1] neg_lo:[1,0,0] neg_hi:[1,0,0]
ds_write_b64 v233, v[212:213] offset:22528
v_pk_fma_f32 v[120:121], v[120:121], v[88:89], v[242:243] op_sel:[0,0,1] op_sel_hi:[1,0,1] neg_lo:[1,0,0] neg_hi:[1,0,0]
v_pk_fma_f32 v[122:123], v[122:123], v[88:89], v[242:243] op_sel:[0,0,1] op_sel_hi:[1,0,1] neg_lo:[1,0,0] neg_hi:[1,0,0]
v_exp_f32 v116, v116
v_exp_f32 v117, v117
v_exp_f32 v118, v118
v_exp_f32 v119, v119
v_exp_f32 v120, v120
v_exp_f32 v121, v121
v_exp_f32 v122, v122
v_exp_f32 v123, v123
v_cvt_pk_bf16_f32 v216, v116, v117
v_cvt_pk_bf16_f32 v217, v118, v119
v_cvt_pk_bf16_f32 v218, v120, v121
v_cvt_pk_bf16_f32 v219, v122, v123
v_pk_mul_f32 v[128:129], v[128:129], v[220:221] op_sel:[0,0] op_sel_hi:[1,0]
v_pk_mul_f32 v[130:131], v[130:131], v[220:221] op_sel:[0,0] op_sel_hi:[1,0]
v_cvt_pk_bf16_f32 v214, v128, v129
v_mfma_f32_16x16x32_bf16 v[224:227], v[16:19], v[216:219], 0
v_cvt_pk_bf16_f32 v215, v130, v131
ds_write_b64 v233, v[214:215] offset:23040
buffer_store_dwordx4 a[248:251], v2, s[4:7], s72 offen offset:3072 sc1
s_nop 4
v_rcp_f32 v224, v224
s_nop 0
v_pk_mul_f32 v[116:117], v[116:117], v[224:225] op_sel:[0,0] op_sel_hi:[1,0]
v_pk_mul_f32 v[118:119], v[118:119], v[224:225] op_sel:[0,0] op_sel_hi:[1,0]
v_cvt_pk_bf16_f32 v216, v116, v117
v_cvt_pk_bf16_f32 v217, v118, v119
v_pk_mul_f32 v[120:121], v[120:121], v[224:225] op_sel:[0,0] op_sel_hi:[1,0]
ds_write_b64 v233, v[216:217] offset:23552
v_pk_mul_f32 v[122:123], v[122:123], v[224:225] op_sel:[0,0] op_sel_hi:[1,0]
v_cvt_pk_bf16_f32 v218, v120, v121
v_cvt_pk_bf16_f32 v219, v122, v123
ds_write_b64 v233, v[218:219] offset:24064
s_waitcnt vmcnt(8)
s_waitcnt lgkmcnt(0)
s_barrier
ds_read_b64_tr_b16 a[0:1], v234 offset:16384
ds_read_b64_tr_b16 a[2:3], v234 offset:18432
ds_read_b64_tr_b16 a[12:13], v234 offset:20480
ds_read_b64_tr_b16 a[14:15], v234 offset:22528
ds_read_b64_tr_b16 a[24:25], v234 offset:24576
ds_read_b64_tr_b16 a[26:27], v234 offset:26624
ds_read_b64_tr_b16 a[4:5], v8 offset:0
ds_read_b64_tr_b16 a[6:7], v8 offset:1024
ds_read_b64_tr_b16 a[8:9], v8 offset:512
ds_read_b64_tr_b16 a[10:11], v8 offset:1536
ds_read_b64_tr_b16 a[36:37], v234 offset:28672
ds_read_b64_tr_b16 a[38:39], v234 offset:30720
ds_read_b64_tr_b16 a[16:17], v8 offset:2048
ds_read_b64_tr_b16 a[18:19], v8 offset:3072
ds_read_b64_tr_b16 a[20:21], v8 offset:2560
ds_read_b64_tr_b16 a[22:23], v8 offset:3584
ds_read_b64_tr_b16 a[48:49], v234 offset:32768
ds_read_b64_tr_b16 a[50:51], v234 offset:34816
ds_read_b64_tr_b16 a[28:29], v8 offset:4096
ds_read_b64_tr_b16 a[30:31], v8 offset:5120
ds_read_b64_tr_b16 a[32:33], v8 offset:4608
ds_read_b64_tr_b16 a[34:35], v8 offset:5632
ds_read_b64_tr_b16 a[60:61], v234 offset:36864
ds_read_b64_tr_b16 a[62:63], v234 offset:38912
s_waitcnt lgkmcnt(14)
v_mfma_f32_16x16x32_bf16 v[100:103], a[0:3], v[16:19], 0
ds_read_b64_tr_b16 a[40:41], v8 offset:6144
ds_read_b64_tr_b16 a[42:43], v8 offset:7168
ds_read_b64_tr_b16 a[44:45], v8 offset:6656
ds_read_b64_tr_b16 a[46:47], v8 offset:7680
ds_read_b64_tr_b16 a[72:73], v234 offset:40960
ds_read_b64_tr_b16 a[74:75], v234 offset:43008
v_mfma_f32_16x16x32_bf16 v[100:103], a[12:15], v[16:19], v[100:103]
buffer_atomic_add v12, v235, s[4:7], s94 offen sc1
ds_read_b64_tr_b16 a[52:53], v8 offset:8192
ds_read_b64_tr_b16 a[54:55], v8 offset:9216
ds_read_b64_tr_b16 a[56:57], v8 offset:8704
ds_read_b64_tr_b16 a[58:59], v8 offset:9728
ds_read_b64_tr_b16 a[84:85], v234 offset:45056
ds_read_b64_tr_b16 a[86:87], v234 offset:47104
v_mfma_f32_16x16x32_bf16 v[100:103], a[24:27], v[16:19], v[100:103]
ds_read_b64_tr_b16 a[64:65], v8 offset:10240
ds_read_b64_tr_b16 a[66:67], v8 offset:11264
v_mfma_f32_16x16x32_bf16 v[92:95], a[0:3], a[4:7], 0
ds_read_b64_tr_b16 a[68:69], v8 offset:10752
ds_read_b64_tr_b16 a[70:71], v8 offset:11776
v_mfma_f32_16x16x32_bf16 v[96:99], a[0:3], a[8:11], 0
ds_read_b64_tr_b16 a[76:77], v8 offset:12288
s_waitcnt lgkmcnt(14)
v_mfma_f32_16x16x32_bf16 v[100:103], a[36:39], v[16:19], v[100:103]
ds_read_b64_tr_b16 a[78:79], v8 offset:13312
v_mfma_f32_16x16x32_bf16 v[92:95], a[12:15], a[16:19], v[92:95]
ds_read_b64_tr_b16 a[80:81], v8 offset:12800
ds_read_b64_tr_b16 a[82:83], v8 offset:13824
v_mfma_f32_16x16x32_bf16 v[96:99], a[12:15], a[20:23], v[96:99]
ds_read_b64_tr_b16 a[88:89], v8 offset:14336
v_mfma_f32_16x16x32_bf16 v[100:103], a[48:51], v[16:19], v[100:103]
ds_read_b64_tr_b16 a[90:91], v8 offset:15360
v_mfma_f32_16x16x32_bf16 v[92:95], a[24:27], a[28:31], v[92:95]
ds_read_b64_tr_b16 a[92:93], v8 offset:14848
ds_read_b64_tr_b16 a[94:95], v8 offset:15872
v_mfma_f32_16x16x32_bf16 v[96:99], a[24:27], a[32:35], v[96:99]
L_stub18:
s_cbranch_execz L_wret6
v_cvt_pk_bf16_f32 v132, v132, v133
v_cvt_pk_bf16_f32 v156, v156, v157
v_mfma_f32_16x16x32_bf16 v[100:103], a[60:63], v[16:19], v[100:103]
v_cvt_pk_bf16_f32 v180, v180, v181
v_cvt_pk_bf16_f32 v204, v204, v205
v_mfma_f32_16x16x32_bf16 v[92:95], a[36:39], a[40:43], v[92:95]
v_cvt_pk_bf16_f32 v133, v134, v135
v_cvt_pk_bf16_f32 v157, v158, v159
s_waitcnt lgkmcnt(14)
v_mfma_f32_16x16x32_bf16 v[96:99], a[36:39], a[44:47], v[96:99]
v_cvt_pk_bf16_f32 v181, v182, v183
v_cvt_pk_bf16_f32 v205, v206, v207
v_mfma_f32_16x16x32_bf16 v[100:103], a[72:75], v[16:19], v[100:103]
v_cvt_pk_bf16_f32 v134, v136, v137
v_cvt_pk_bf16_f32 v135, v138, v139
v_mfma_f32_16x16x32_bf16 v[92:95], a[48:51], a[52:55], v[92:95]
v_cvt_pk_bf16_f32 v158, v160, v161
v_cvt_pk_bf16_f32 v159, v162, v163
v_mfma_f32_16x16x32_bf16 v[96:99], a[48:51], a[56:59], v[96:99]
v_cvt_pk_bf16_f32 v182, v184, v185
v_cvt_pk_bf16_f32 v183, v186, v187
s_waitcnt lgkmcnt(12)
v_mfma_f32_16x16x32_bf16 v[100:103], a[84:87], v[16:19], v[100:103]
v_cvt_pk_bf16_f32 v206, v208, v209
v_cvt_pk_bf16_f32 v207, v210, v211
s_waitcnt lgkmcnt(10)
v_mfma_f32_16x16x32_bf16 v[92:95], a[60:63], a[64:67], v[92:95]
s_waitcnt lgkmcnt(8)
v_mfma_f32_16x16x32_bf16 v[96:99], a[60:63], a[68:71], v[96:99]
s_nop 1
v_min_u32 v100, -2, v100
v_min_u32 v101, -2, v101
s_waitcnt lgkmcnt(6)
v_mfma_f32_16x16x32_bf16 v[92:95], a[72:75], a[76:79], v[92:95]
v_min_u32 v102, -2, v102
v_min_u32 v103, -2, v103
s_waitcnt lgkmcnt(4)
v_mfma_f32_16x16x32_bf16 v[96:99], a[72:75], a[80:83], v[96:99]
buffer_store_dwordx4 v[100:103], v254, s[4:7], s97 offen sc1
s_waitcnt lgkmcnt(2)
v_mfma_f32_16x16x32_bf16 v[92:95], a[84:87], a[88:91], v[92:95]
s_waitcnt lgkmcnt(0)
v_mfma_f32_16x16x32_bf16 v[96:99], a[84:87], a[92:95], v[96:99]
s_nop 5
v_cvt_pk_bf16_f32 v92, v92, v93
v_cvt_pk_bf16_f32 v93, v94, v95
v_min_u32 v92, -2, v92
v_min_u32 v93, -2, v93
v_cvt_pk_bf16_f32 v94, v96, v97
v_cvt_pk_bf16_f32 v95, v98, v99
v_min_u32 v94, -2, v94
v_min_u32 v95, -2, v95
buffer_store_dwordx4 v[92:95], v1, s[4:7], s96 offen sc1
s_barrier
s_add_u32 m0, s19, 32768
s_add_u32 s44, s84, 0xc00000
buffer_load_dwordx4 v1, s[4:7], s44 offen offset:0 sc1 lds
v_mfma_f32_16x16x32_bf16 v[108:111], a[240:243], v[132:135], 0
v_mfma_f32_16x16x32_bf16 v[172:175], a[240:243], v[156:159], 0
v_mfma_f32_16x16x32_bf16 v[112:115], a[244:247], v[132:135], 0
s_nop 5
v_max3_f32 v236, v108, v109, v110
v_max3_f32 v237, -v108, -v109, -v110
v_mfma_f32_16x16x32_bf16 v[176:179], a[244:247], v[156:159], 0
v_max3_f32 v238, v172, v173, v174
v_max3_f32 v239, -v172, -v173, -v174
v_max3_f32 v236, v236, v111, v112
v_max3_f32 v237, v237, -v111, -v112
v_max3_f32 v236, v236, v113, v114
v_max3_f32 v237, v237, -v113, -v114
s_nop 1
v_max3_f32 v238, v238, v175, v176
v_max3_f32 v239, v239, -v175, -v176
v_max3_f32 v238, v238, v177, v178
v_max3_f32 v239, v239, -v177, -v178
v_max_f32 v236, v236, v115
buffer_load_dwordx4 v1, s[4:7], s44 offen offset:1024 sc1 lds
v_max_f32_e64 v237, v237, -v115
v_max_f32 v238, v238, v179
v_max_f32_e64 v239, v239, -v179
v_permlane32_swap_b32 v236, v237
s_nop 0
v_permlane32_swap_b32 v238, v239
v_mov_b32 v11, 0
buffer_atomic_add v11, v251, s[4:7], s89 offen sc0 sc1
v_max_f32 v236, v236, v237
v_max_f32 v238, v238, v239
v_mov_b32 v244, v236
v_mov_b32 v245, v238
s_nop 0
v_permlane16_swap_b32 v236, v244
v_permlane16_swap_b32 v238, v245
v_max_f32 v236, v236, v244
v_max_f32 v238, v238, v245
v_mov_b32 v244, v236
v_mov_b32 v245, v238
s_nop 0
v_permlane32_swap_b32 v236, v244
v_permlane32_swap_b32 v238, v245
v_mul_f32_e64 v236, -v236, v82
v_mul_f32_e64 v237, -v244, v82
buffer_load_dwordx4 v1, s[4:7], s44 offen offset:2048 sc1 lds
v_mul_f32_e64 v238, -v238, v84
v_mul_f32_e64 v239, -v245, v84
v_pk_fma_f32 v[116:117], v[108:109], v[82:83], v[236:237] op_sel:[0,0,0] op_sel_hi:[1,0,0]
v_pk_fma_f32 v[118:119], v[110:111], v[82:83], v[236:237] op_sel:[0,0,0] op_sel_hi:[1,0,0]
v_pk_fma_f32 v[120:121], v[112:113], v[82:83], v[236:237] op_sel:[0,0,0] op_sel_hi:[1,0,0]
v_pk_fma_f32 v[122:123], v[114:115], v[82:83], v[236:237] op_sel:[0,0,0] op_sel_hi:[1,0,0]
v_pk_fma_f32 v[148:149], v[172:173], v[84:85], v[238:239] op_sel:[0,0,0] op_sel_hi:[1,0,0]
v_pk_fma_f32 v[150:151], v[174:175], v[84:85], v[238:239] op_sel:[0,0,0] op_sel_hi:[1,0,0]
v_pk_fma_f32 v[152:153], v[176:177], v[84:85], v[238:239] op_sel:[0,0,0] op_sel_hi:[1,0,0]
v_pk_fma_f32 v[154:155], v[178:179], v[84:85], v[238:239] op_sel:[0,0,0] op_sel_hi:[1,0,0]
v_pk_fma_f32 v[108:109], v[108:109], v[82:83], v[236:237] op_sel:[0,0,1] op_sel_hi:[1,0,1] neg_lo:[1,0,0] neg_hi:[1,0,0]
v_pk_fma_f32 v[110:111], v[110:111], v[82:83], v[236:237] op_sel:[0,0,1] op_sel_hi:[1,0,1] neg_lo:[1,0,0] neg_hi:[1,0,0]
v_pk_fma_f32 v[112:113], v[112:113], v[82:83], v[236:237] op_sel:[0,0,1] op_sel_hi:[1,0,1] neg_lo:[1,0,0] neg_hi:[1,0,0]
v_pk_fma_f32 v[114:115], v[114:115], v[82:83], v[236:237] op_sel:[0,0,1] op_sel_hi:[1,0,1] neg_lo:[1,0,0] neg_hi:[1,0,0]
v_pk_fma_f32 v[172:173], v[172:173], v[84:85], v[238:239] op_sel:[0,0,1] op_sel_hi:[1,0,1] neg_lo:[1,0,0] neg_hi:[1,0,0]
v_pk_fma_f32 v[174:175], v[174:175], v[84:85], v[238:239] op_sel:[0,0,1] op_sel_hi:[1,0,1] neg_lo:[1,0,0] neg_hi:[1,0,0]
v_pk_fma_f32 v[176:177], v[176:177], v[84:85], v[238:239] op_sel:[0,0,1] op_sel_hi:[1,0,1] neg_lo:[1,0,0] neg_hi:[1,0,0]
v_pk_fma_f32 v[178:179], v[178:179], v[84:85], v[238:239] op_sel:[0,0,1] op_sel_hi:[1,0,1] neg_lo:[1,0,0] neg_hi:[1,0,0]
v_exp_f32 v116, v116
v_exp_f32 v108, v108
v_exp_f32 v117, v117
v_exp_f32 v109, v109
v_exp_f32 v118, v118
v_exp_f32 v110, v110
v_exp_f32 v119, v119
v_exp_f32 v111, v111
v_exp_f32 v120, v120
v_exp_f32 v112, v112
v_exp_f32 v121, v121
v_exp_f32 v113, v113
v_exp_f32 v122, v122
v_exp_f32 v114, v114
v_exp_f32 v123, v123
v_exp_f32 v115, v115
v_exp_f32 v148, v148
v_exp_f32 v172, v172
v_exp_f32 v149, v149
v_exp_f32 v173, v173
v_exp_f32 v150, v150
v_exp_f32 v174, v174
v_exp_f32 v151, v151
v_exp_f32 v175, v175
v_exp_f32 v152, v152
v_exp_f32 v176, v176
v_exp_f32 v153, v153
v_exp_f32 v177, v177
v_exp_f32 v154, v154
v_exp_f32 v178, v178
v_exp_f32 v155, v155
v_exp_f32 v179, v179
buffer_load_dwordx4 v1, s[4:7], s44 offen offset:3072 sc1 lds
v_cvt_pk_bf16_f32 v140, v116, v117
v_cvt_pk_bf16_f32 v141, v118, v119
v_cvt_pk_bf16_f32 v142, v120, v121
v_cvt_pk_bf16_f32 v143, v122, v123
v_cvt_pk_bf16_f32 v144, v108, v109
v_cvt_pk_bf16_f32 v145, v110, v111
v_cvt_pk_bf16_f32 v146, v112, v113
v_cvt_pk_bf16_f32 v147, v114, v115
v_cvt_pk_bf16_f32 v164, v148, v149
v_cvt_pk_bf16_f32 v165, v150, v151
v_cvt_pk_bf16_f32 v166, v152, v153
v_cvt_pk_bf16_f32 v167, v154, v155
v_cvt_pk_bf16_f32 v168, v172, v173
v_cvt_pk_bf16_f32 v169, v174, v175
v_cvt_pk_bf16_f32 v170, v176, v177
v_cvt_pk_bf16_f32 v171, v178, v179
s_waitcnt vmcnt(2)
v_readfirstlane_b32 s38, v11
s_nop 0
s_cmp_ge_u32 s38, 8
s_cbranch_scc1 Lpe_46
s_add_u32 s36, s88, 0x90000
s_mov_b32 s37, 0
Lpoll_45:
v_mov_b32 v11, 0
buffer_atomic_add v11, v251, s[4:7], s36 offen sc0 sc1
s_add_u32 s37, s37, 1
s_waitcnt vmcnt(0)
v_readfirstlane_b32 s38, v11
s_nop 0
s_cmp_ge_u32 s38, 8
s_cbranch_scc1 Lpe_46
s_cmp_lt_u32 s37, 0x100000
s_cbranch_scc1 Lpoll_45
Lpe_46:
buffer_load_dwordx4 v[48:51], v1, s[4:7], s98 offen offset:0 sc1
v_mfma_f32_16x16x32_bf16 v[108:111], a[240:243], v[180:183], 0
v_mfma_f32_16x16x32_bf16 v[220:223], a[240:243], v[204:207], 0
v_mfma_f32_16x16x32_bf16 v[112:115], a[244:247], v[180:183], 0
s_nop 5
v_max3_f32 v240, v108, v109, v110
v_max3_f32 v241, -v108, -v109, -v110
v_mfma_f32_16x16x32_bf16 v[224:227], a[244:247], v[204:207], 0
buffer_load_dwordx4 v[124:127], v248, s[4:7], s100 offen sc1
v_max3_f32 v242, v220, v221, v222
v_max3_f32 v243, -v220, -v221, -v222
v_max3_f32 v240, v240, v111, v112
v_max3_f32 v241, v241, -v111, -v112
v_max3_f32 v240, v240, v113, v114
s_nop 1
v_max3_f32 v242, v242, v223, v224
v_max3_f32 v243, v243, -v223, -v224
v_max3_f32 v241, v241, -v113, -v114
v_max3_f32 v242, v242, v225, v226
v_max3_f32 v243, v243, -v225, -v226
v_max_f32 v240, v240, v115
v_max_f32_e64 v241, v241, -v115
v_max_f32 v242, v242, v227
buffer_load_dwordx4 v[52:55], v1, s[4:7], s98 offen offset:1024 sc1
v_max_f32_e64 v243, v243, -v227
v_permlane32_swap_b32 v240, v241
s_nop 0
v_permlane32_swap_b32 v242, v243
v_max_f32 v240, v240, v241
v_max_f32 v242, v242, v243
v_mov_b32 v246, v240
v_mov_b32 v247, v242
s_nop 0
v_permlane16_swap_b32 v240, v246
v_permlane16_swap_b32 v242, v247
buffer_load_dwordx4 v[56:59], v1, s[4:7], s98 offen offset:2048 sc1
v_max_f32 v240, v240, v246
v_max_f32 v242, v242, v247
v_mov_b32 v246, v240
v_mov_b32 v247, v242
s_nop 0
v_permlane32_swap_b32 v240, v246
v_permlane32_swap_b32 v242, v247
v_mul_f32_e64 v240, -v240, v86
v_mul_f32_e64 v241, -v246, v86
v_mul_f32_e64 v242, -v242, v88
v_mul_f32_e64 v243, -v247, v88
buffer_load_dwordx4 v[60:63], v1, s[4:7], s98 offen offset:3072 sc1
v_pk_fma_f32 v[116:117], v[108:109], v[86:87], v[240:241] op_sel:[0,0,0] op_sel_hi:[1,0,0]
v_pk_fma_f32 v[118:119], v[110:111], v[86:87], v[240:241] op_sel:[0,0,0] op_sel_hi:[1,0,0]
v_pk_fma_f32 v[120:121], v[112:113], v[86:87], v[240:241] op_sel:[0,0,0] op_sel_hi:[1,0,0]
v_pk_fma_f32 v[122:123], v[114:115], v[86:87], v[240:241] op_sel:[0,0,0] op_sel_hi:[1,0,0]
v_pk_fma_f32 v[196:197], v[220:221], v[88:89], v[242:243] op_sel:[0,0,0] op_sel_hi:[1,0,0]
v_pk_fma_f32 v[198:199], v[222:223], v[88:89], v[242:243] op_sel:[0,0,0] op_sel_hi:[1,0,0]
v_pk_fma_f32 v[200:201], v[224:225], v[88:89], v[242:243] op_sel:[0,0,0] op_sel_hi:[1,0,0]
v_pk_fma_f32 v[202:203], v[226:227], v[88:89], v[242:243] op_sel:[0,0,0] op_sel_hi:[1,0,0]
v_pk_fma_f32 v[108:109], v[108:109], v[86:87], v[240:241] op_sel:[0,0,1] op_sel_hi:[1,0,1] neg_lo:[1,0,0] neg_hi:[1,0,0]
v_pk_fma_f32 v[110:111], v[110:111], v[86:87], v[240:241] op_sel:[0,0,1] op_sel_hi:[1,0,1] neg_lo:[1,0,0] neg_hi:[1,0,0]
v_pk_fma_f32 v[112:113], v[112:113], v[86:87], v[240:241] op_sel:[0,0,1] op_sel_hi:[1,0,1] neg_lo:[1,0,0] neg_hi:[1,0,0]
v_pk_fma_f32 v[114:115], v[114:115], v[86:87], v[240:241] op_sel:[0,0,1] op_sel_hi:[1,0,1] neg_lo:[1,0,0] neg_hi:[1,0,0]
v_pk_fma_f32 v[220:221], v[220:221], v[88:89], v[242:243] op_sel:[0,0,1] op_sel_hi:[1,0,1] neg_lo:[1,0,0] neg_hi:[1,0,0]
buffer_load_dwordx4 v[64:67], v1, s[4:7], s99 offen offset:0 sc1
v_pk_fma_f32 v[222:223], v[222:223], v[88:89], v[242:243] op_sel:[0,0,1] op_sel_hi:[1,0,1] neg_lo:[1,0,0] neg_hi:[1,0,0]
v_pk_fma_f32 v[224:225], v[224:225], v[88:89], v[242:243] op_sel:[0,0,1] op_sel_hi:[1,0,1] neg_lo:[1,0,0] neg_hi:[1,0,0]
v_pk_fma_f32 v[226:227], v[226:227], v[88:89], v[242:243] op_sel:[0,0,1] op_sel_hi:[1,0,1] neg_lo:[1,0,0] neg_hi:[1,0,0]
v_exp_f32 v116, v116
v_exp_f32 v108, v108
v_exp_f32 v117, v117
v_exp_f32 v109, v109
v_exp_f32 v118, v118
buffer_load_dwordx4 v[68:71], v1, s[4:7], s99 offen offset:1024 sc1
v_exp_f32 v110, v110
v_exp_f32 v119, v119
v_exp_f32 v111, v111
v_exp_f32 v120, v120
v_exp_f32 v112, v112
v_exp_f32 v121, v121
v_exp_f32 v113, v113
buffer_load_dwordx4 v[100:103], v1, s[4:7], s99 offen offset:2048 sc1
v_exp_f32 v122, v122
v_exp_f32 v114, v114
v_exp_f32 v123, v123
v_exp_f32 v115, v115
v_exp_f32 v196, v196
v_exp_f32 v220, v220
v_exp_f32 v197, v197
buffer_load_dwordx4 v[104:107], v1, s[4:7], s99 offen offset:3072 sc1
v_exp_f32 v221, v221
v_exp_f32 v198, v198
v_exp_f32 v222, v222
v_exp_f32 v199, v199
v_exp_f32 v223, v223
v_exp_f32 v200, v200
v_exp_f32 v224, v224
v_exp_f32 v201, v201
v_exp_f32 v225, v225
v_exp_f32 v202, v202
v_exp_f32 v226, v226
v_exp_f32 v203, v203
v_exp_f32 v227, v227
v_cvt_pk_bf16_f32 v188, v116, v117
v_cvt_pk_bf16_f32 v189, v118, v119
v_cvt_pk_bf16_f32 v190, v120, v121
v_cvt_pk_bf16_f32 v191, v122, v123
v_cvt_pk_bf16_f32 v192, v108, v109
v_cvt_pk_bf16_f32 v193, v110, v111
v_cvt_pk_bf16_f32 v194, v112, v113
v_cvt_pk_bf16_f32 v195, v114, v115
v_cvt_pk_bf16_f32 v212, v196, v197
v_cvt_pk_bf16_f32 v213, v198, v199
v_cvt_pk_bf16_f32 v214, v200, v201
v_cvt_pk_bf16_f32 v215, v202, v203
v_cvt_pk_bf16_f32 v216, v220, v221
v_cvt_pk_bf16_f32 v217, v222, v223
v_cvt_pk_bf16_f32 v218, v224, v225
v_cvt_pk_bf16_f32 v219, v226, v227
s_waitcnt vmcnt(8)
v_lshlrev_b32 v92, 16, v48
v_and_b32 v93, 0xffff0000, v48
v_lshlrev_b32 v94, 16, v49
v_and_b32 v95, 0xffff0000, v49
v_lshlrev_b32 v96, 16, v50
v_and_b32 v97, 0xffff0000, v50
v_lshlrev_b32 v98, 16, v51
v_and_b32 v99, 0xffff0000, v51
s_waitcnt vmcnt(7)
v_add_f32_dpp v128, v124, v124 row_ror:4 row_mask:0xf bank_mask:0xf
v_add_f32_dpp v129, v125, v125 row_ror:4 row_mask:0xf bank_mask:0xf
v_add_f32_dpp v130, v126, v126 row_ror:4 row_mask:0xf bank_mask:0xf
v_add_f32_dpp v131, v127, v127 row_ror:4 row_mask:0xf bank_mask:0xf
v_add_f32_dpp v128, v128, v128 row_ror:2 row_mask:0xf bank_mask:0xf
v_add_f32_dpp v129, v129, v129 row_ror:2 row_mask:0xf bank_mask:0xf
v_add_f32_dpp v130, v130, v130 row_ror:2 row_mask:0xf bank_mask:0xf
v_add_f32_dpp v131, v131, v131 row_ror:2 row_mask:0xf bank_mask:0xf
v_add_f32_dpp v128, v128, v128 row_ror:1 row_mask:0xf bank_mask:0xf
v_add_f32_dpp v129, v129, v129 row_ror:1 row_mask:0xf bank_mask:0xf
v_add_f32_dpp v130, v130, v130 row_ror:1 row_mask:0xf bank_mask:0xf
v_add_f32_dpp v131, v131, v131 row_ror:1 row_mask:0xf bank_mask:0xf
v_fma_f32 v135, v129, v130, v131
s_waitcnt vmcnt(6)
v_dot2c_f32_bf16 v92, v52, v249
v_dot2c_f32_bf16 v93, v52, v250
v_dot2c_f32_bf16 v94, v53, v249
v_dot2c_f32_bf16 v95, v53, v250
v_dot2c_f32_bf16 v96, v54, v249
v_dot2c_f32_bf16 v97, v54, v250
v_dot2c_f32_bf16 v98, v55, v249
v_dot2c_f32_bf16 v99, v55, v250
s_waitcnt vmcnt(5)
v_dot2c_f32_bf16 v92, v56, v249
v_dot2c_f32_bf16 v93, v56, v250
v_dot2c_f32_bf16 v94, v57, v249
v_dot2c_f32_bf16 v95, v57, v250
v_dot2c_f32_bf16 v96, v58, v249
v_dot2c_f32_bf16 v97, v58, v250
v_dot2c_f32_bf16 v98, v59, v249
v_dot2c_f32_bf16 v99, v59, v250
s_waitcnt vmcnt(4)
v_dot2c_f32_bf16 v92, v60, v249
v_dot2c_f32_bf16 v93, v60, v250
v_dot2c_f32_bf16 v94, v61, v249
v_dot2c_f32_bf16 v95, v61, v250
v_dot2c_f32_bf16 v96, v62, v249
v_dot2c_f32_bf16 v97, v62, v250
v_dot2c_f32_bf16 v98, v63, v249
v_dot2c_f32_bf16 v99, v63, v250
s_waitcnt vmcnt(3)
v_dot2c_f32_bf16 v92, v64, v249
v_dot2c_f32_bf16 v93, v64, v250
v_dot2c_f32_bf16 v94, v65, v249
v_dot2c_f32_bf16 v95, v65, v250
v_dot2c_f32_bf16 v96, v66, v249
v_dot2c_f32_bf16 v97, v66, v250
v_dot2c_f32_bf16 v98, v67, v249
v_dot2c_f32_bf16 v99, v67, v250
s_waitcnt vmcnt(2)
v_dot2c_f32_bf16 v92, v68, v249
v_dot2c_f32_bf16 v93, v68, v250
v_dot2c_f32_bf16 v94, v69, v249
v_dot2c_f32_bf16 v95, v69, v250
v_dot2c_f32_bf16 v96, v70, v249
v_dot2c_f32_bf16 v97, v70, v250
v_dot2c_f32_bf16 v98, v71, v249
v_dot2c_f32_bf16 v99, v71, v250
s_waitcnt vmcnt(1)
v_dot2c_f32_bf16 v92, v100, v249
v_dot2c_f32_bf16 v93, v100, v250
v_dot2c_f32_bf16 v94, v101, v249
v_dot2c_f32_bf16 v95, v101, v250
v_dot2c_f32_bf16 v96, v102, v249
v_dot2c_f32_bf16 v97, v102, v250
v_dot2c_f32_bf16 v98, v103, v249
v_dot2c_f32_bf16 v99, v103, v250
s_waitcnt vmcnt(0)
v_dot2c_f32_bf16 v92, v104, v249
v_dot2c_f32_bf16 v93, v104, v250
v_dot2c_f32_bf16 v94, v105, v249
v_dot2c_f32_bf16 v95, v105, v250
v_dot2c_f32_bf16 v96, v106, v249
v_dot2c_f32_bf16 v97, v106, v250
v_dot2c_f32_bf16 v98, v107, v249
v_dot2c_f32_bf16 v99, v107, v250
v_fma_f32 v132, v92, v93, v94
v_fma_f32 v133, v95, v96, v97
s_nop 0
v_fma_f32 v134, v98, v99, v128
v_fma_f32 v132, v132, v133, v134
v_cmp_u_f32 vcc, v132, v135
s_cbranch_vccnz L_kvredo3
L_kvback3:
v_cvt_pk_bf16_f32 v128, v128, v129
v_cvt_pk_bf16_f32 v129, v130, v131
v_cvt_pk_bf16_f32 v92, v92, v93
v_cndmask_b32 v128, 0, v128, s[56:57]
v_cndmask_b32 v129, 0, v129, s[56:57]
v_cvt_pk_bf16_f32 v93, v94, v95
v_cvt_pk_bf16_f32 v94, v96, v97
v_cvt_pk_bf16_f32 v95, v98, v99
v_cndmask_b32 v128, v128, v16, s[58:59]
v_cndmask_b32 v129, v129, v16, s[58:59]
ds_write_b64 v252, v[92:93] offset:0
ds_write_b64 v252, v[94:95] offset:1024
ds_write_b64 v252, v[128:129] offset:2048
s_waitcnt lgkmcnt(0)
s_barrier
ds_read_b128 a[8:11], v1 offset:2048
ds_read_b128 a[20:23], v1 offset:5120
ds_read_b128 a[0:3], v1 offset:0
ds_read_b128 a[12:15], v1 offset:3072
ds_read_b128 a[4:7], v1 offset:1024
ds_read_b128 a[16:19], v1 offset:4096
s_waitcnt lgkmcnt(5)
v_mfma_f32_16x16x32_bf16 v[116:119], a[8:11], v[212:215], 0
s_waitcnt lgkmcnt(4)
v_mfma_f32_16x16x32_bf16 v[120:123], a[20:23], v[216:219], 0
s_waitcnt lgkmcnt(3)
v_mfma_f32_16x16x32_bf16 v[204:207], a[0:3], v[212:215], 0
s_nop 3
v_rcp_f32 v118, v117
s_waitcnt lgkmcnt(2)
v_mfma_f32_16x16x32_bf16 v[220:223], a[12:15], v[216:219], 0
v_rcp_f32 v119, v121
v_mul_f32 v116, v116, v118
v_fmac_f32 v116, v120, v119
v_mfma_f32_16x16x32_bf16 v[100:103], a[8:11], v[164:167], 0
v_add_f32 v116, 0x358637bd, v116
v_rcp_f32 v116, v116
s_waitcnt lgkmcnt(1)
v_mfma_f32_16x16x32_bf16 v[208:211], a[4:7], v[212:215], 0
v_mul_f32 v118, v118, v116
v_mul_f32 v119, v119, v116
v_mfma_f32_16x16x32_bf16 v[104:107], a[20:23], v[168:171], 0
v_mul_f32 v204, v204, v118
v_mul_f32 v205, v205, v118
s_waitcnt lgkmcnt(0)
v_mfma_f32_16x16x32_bf16 v[224:227], a[16:19], v[216:219], 0
v_mul_f32 v206, v206, v118
v_mul_f32 v207, v207, v118
v_fmac_f32 v204, v220, v119
v_fmac_f32 v205, v221, v119
v_rcp_f32 v102, v101
v_mul_f32 v208, v208, v118
v_mul_f32 v209, v209, v118
v_mul_f32 v210, v210, v118
v_mul_f32 v211, v211, v118
v_fmac_f32 v206, v222, v119
v_fmac_f32 v207, v223, v119
v_cvt_pk_bf16_f32 v204, v204, v205
v_rcp_f32 v103, v105
v_fmac_f32 v208, v224, v119
v_fmac_f32 v209, v225, v119
v_fmac_f32 v210, v226, v119
v_fmac_f32 v211, v227, v119
v_cvt_pk_bf16_f32 v205, v206, v207
v_cvt_pk_bf16_f32 v206, v208, v209
v_cvt_pk_bf16_f32 v207, v210, v211
v_mul_f32 v100, v100, v102
v_mfma_f32_16x16x32_bf16 v[156:159], a[0:3], v[164:167], 0
buffer_store_dwordx4 v[204:207], v2, s[4:7], s72 offen offset:3072 sc1
v_fmac_f32 v100, v104, v103
v_mfma_f32_16x16x32_bf16 v[172:175], a[12:15], v[168:171], 0
v_add_f32 v100, 0x358637bd, v100
v_rcp_f32 v100, v100
v_mfma_f32_16x16x32_bf16 v[108:111], a[8:11], v[188:191], 0
v_mul_f32 v102, v102, v100
v_mul_f32 v103, v103, v100
v_mfma_f32_16x16x32_bf16 v[160:163], a[4:7], v[164:167], 0
v_mul_f32 v156, v156, v102
v_mul_f32 v157, v157, v102
v_mfma_f32_16x16x32_bf16 v[112:115], a[20:23], v[192:195], 0
v_mul_f32 v158, v158, v102
v_mul_f32 v159, v159, v102
v_mfma_f32_16x16x32_bf16 v[176:179], a[16:19], v[168:171], 0
v_fmac_f32 v156, v172, v103
v_fmac_f32 v157, v173, v103
v_rcp_f32 v110, v109
v_mul_f32 v160, v160, v102
v_mul_f32 v161, v161, v102
v_mul_f32 v162, v162, v102
v_mul_f32 v163, v163, v102
v_fmac_f32 v158, v174, v103
v_fmac_f32 v159, v175, v103
v_cvt_pk_bf16_f32 v156, v156, v157
v_rcp_f32 v111, v113
v_fmac_f32 v160, v176, v103
v_fmac_f32 v161, v177, v103
v_fmac_f32 v162, v178, v103
v_fmac_f32 v163, v179, v103
v_cvt_pk_bf16_f32 v157, v158, v159
v_cvt_pk_bf16_f32 v158, v160, v161
v_cvt_pk_bf16_f32 v159, v162, v163
v_mul_f32 v108, v108, v110
v_mfma_f32_16x16x32_bf16 v[180:183], a[0:3], v[188:191], 0
buffer_store_dwordx4 v[156:159], v2, s[4:7], s72 offen offset:1024 sc1
v_fmac_f32 v108, v112, v111
v_mfma_f32_16x16x32_bf16 v[196:199], a[12:15], v[192:195], 0
v_add_f32 v108, 0x358637bd, v108
v_rcp_f32 v108, v108
v_mfma_f32_16x16x32_bf16 v[92:95], a[8:11], v[140:143], 0
v_mul_f32 v110, v110, v108
v_mul_f32 v111, v111, v108
v_mfma_f32_16x16x32_bf16 v[184:187], a[4:7], v[188:191], 0
v_mul_f32 v180, v180, v110
v_mul_f32 v181, v181, v110
v_mfma_f32_16x16x32_bf16 v[96:99], a[20:23], v[144:147], 0
v_mul_f32 v182, v182, v110
v_mul_f32 v183, v183, v110
v_mfma_f32_16x16x32_bf16 v[200:203], a[16:19], v[192:195], 0
v_fmac_f32 v180, v196, v111
v_fmac_f32 v181, v197, v111
v_rcp_f32 v94, v93
v_mul_f32 v184, v184, v110
v_mul_f32 v185, v185, v110
v_mul_f32 v186, v186, v110
v_mul_f32 v187, v187, v110
v_fmac_f32 v182, v198, v111
v_fmac_f32 v183, v199, v111
v_cvt_pk_bf16_f32 v180, v180, v181
v_rcp_f32 v95, v97
v_fmac_f32 v184, v200, v111
v_fmac_f32 v185, v201, v111
v_fmac_f32 v186, v202, v111
v_fmac_f32 v187, v203, v111
v_cvt_pk_bf16_f32 v181, v182, v183
v_cvt_pk_bf16_f32 v182, v184, v185
v_cvt_pk_bf16_f32 v183, v186, v187
v_mul_f32 v92, v92, v94
v_mfma_f32_16x16x32_bf16 v[132:135], a[0:3], v[140:143], 0
buffer_store_dwordx4 v[180:183], v2, s[4:7], s72 offen offset:2048 sc1
buffer_atomic_add v12, v10, s[4:7], s74 offen sc1
v_fmac_f32 v92, v96, v95
v_mfma_f32_16x16x32_bf16 v[148:151], a[12:15], v[144:147], 0
v_add_f32 v92, 0x358637bd, v92
v_rcp_f32 v92, v92
v_mfma_f32_16x16x32_bf16 v[136:139], a[4:7], v[140:143], 0
v_mul_f32 v94, v94, v92
v_mul_f32 v95, v95, v92
v_mfma_f32_16x16x32_bf16 v[152:155], a[16:19], v[144:147], 0
v_mul_f32 v132, v132, v94
v_mul_f32 v133, v133, v94
v_mul_f32 v134, v134, v94
v_mul_f32 v135, v135, v94
v_fmac_f32 v132, v148, v95
v_fmac_f32 v133, v149, v95
v_mul_f32 v136, v136, v94
v_mul_f32 v137, v137, v94
v_mul_f32 v138, v138, v94
v_mul_f32 v139, v139, v94
v_fmac_f32 v134, v150, v95
v_fmac_f32 v135, v151, v95
v_cvt_pk_bf16_f32 v132, v132, v133
v_fmac_f32 v136, v152, v95
v_fmac_f32 v137, v153, v95
v_fmac_f32 v138, v154, v95
v_fmac_f32 v139, v155, v95
v_cvt_pk_bf16_f32 v133, v134, v135
v_cvt_pk_bf16_f32 v134, v136, v137
v_cvt_pk_bf16_f32 v135, v138, v139
buffer_store_dwordx4 v[132:135], v2, s[4:7], s72 offen offset:0 sc1
s_add_u32 s92, s71, 0x30000
s_add_u32 s40, s4, 0x2800000
s_addc_u32 s41, s5, 0
v_add_u32 v5, 32768, v1
v_add_u32 v6, 98304, v1
s_mov_b32 s35, 0
v_lshlrev_b32 v132, 16, v32
v_and_b32 v133, 0xffff0000, v32
v_lshlrev_b32 v134, 16, v33
v_and_b32 v135, 0xffff0000, v33
v_lshlrev_b32 v136, 16, v34
v_and_b32 v137, 0xffff0000, v34
v_lshlrev_b32 v138, 16, v35
v_and_b32 v139, 0xffff0000, v35
v_lshlrev_b32 v140, 16, v36
v_and_b32 v141, 0xffff0000, v36
v_lshlrev_b32 v142, 16, v37
v_and_b32 v143, 0xffff0000, v37
v_lshlrev_b32 v144, 16, v38
v_and_b32 v145, 0xffff0000, v38
v_lshlrev_b32 v146, 16, v39
v_and_b32 v147, 0xffff0000, v39
v_lshlrev_b32 v148, 16, v40
v_and_b32 v149, 0xffff0000, v40
v_lshlrev_b32 v150, 16, v41
v_and_b32 v151, 0xffff0000, v41
v_lshlrev_b32 v152, 16, v42
v_and_b32 v153, 0xffff0000, v42
v_lshlrev_b32 v154, 16, v43
v_and_b32 v155, 0xffff0000, v43
v_lshlrev_b32 v156, 16, v44
v_and_b32 v157, 0xffff0000, v44
v_lshlrev_b32 v158, 16, v45
v_and_b32 v159, 0xffff0000, v45
v_lshlrev_b32 v160, 16, v46
v_and_b32 v161, 0xffff0000, v46
v_lshlrev_b32 v162, 16, v47
v_and_b32 v163, 0xffff0000, v47
s_mov_b32 s95, -1
s_mov_b64 exec, 0
s_cmp_eq_u32 s28, 3
s_cbranch_scc1 L_stub19
s_cmp_eq_u32 s28, 2
s_cbranch_scc1 L_wret7
L_wret7:
s_mov_b64 exec, -1
s_cmp_lg_u32 s28, 1
s_cbranch_scc1 Lpo_49
s_add_u32 s36, s11, 0x30080
s_mov_b32 s37, 0
v_mov_b32 v11, 0
buffer_atomic_add v11, v251, s[4:7], s36 offen sc0 sc1
s_sleep 4
Lpoll_47:
v_mov_b32 v234, 0
buffer_atomic_add v234, v251, s[4:7], s36 offen sc0 sc1
s_waitcnt vmcnt(1)
v_readfirstlane_b32 s38, v11
s_nop 0
s_cmp_ge_u32 s38, 32
s_cbranch_scc1 Lpe_48
v_mov_b32 v11, 0
buffer_atomic_add v11, v251, s[4:7], s36 offen sc0 sc1
s_waitcnt vmcnt(1)
v_readfirstlane_b32 s38, v234
s_nop 0
s_cmp_ge_u32 s38, 32
s_cbranch_scc1 Lpe_48
s_add_u32 s37, s37, 1
s_cmp_lt_u32 s37, 0x80000
s_cbranch_scc1 Lpoll_47
s_waitcnt vmcnt(0)
Lpo_49:
s_waitcnt vmcnt(0)
Lpe_48:
s_barrier
L_k2go3:
buffer_load_dwordx4 a[0:3], v4, s[40:43], s35 offen offset:0 sc1
buffer_load_dwordx4 a[4:7], v4, s[40:43], s35 offen offset:1024 sc1
s_mov_b32 s35, 4096
buffer_load_dwordx4 a[8:11], v4, s[40:43], s35 offen offset:0 sc1
buffer_load_dwordx4 a[12:15], v4, s[40:43], s35 offen offset:1024 sc1
s_mov_b32 s35, 16384
buffer_load_dwordx4 a[16:19], v4, s[40:43], s35 offen offset:0 sc1
buffer_load_dwordx4 a[20:23], v4, s[40:43], s35 offen offset:1024 sc1
s_mov_b32 s35, 20480
buffer_load_dwordx4 a[24:27], v4, s[40:43], s35 offen offset:0 sc1
buffer_load_dwordx4 a[28:31], v4, s[40:43], s35 offen offset:1024 sc1
s_mov_b32 s35, 32768
buffer_load_dwordx4 a[32:35], v4, s[40:43], s35 offen offset:0 sc1
buffer_load_dwordx4 a[36:39], v4, s[40:43], s35 offen offset:1024 sc1
s_mov_b32 s35, 36864
buffer_load_dwordx4 a[40:43], v4, s[40:43], s35 offen offset:0 sc1
buffer_load_dwordx4 a[44:47], v4, s[40:43], s35 offen offset:1024 sc1
s_mov_b32 s35, 49152
ds_read_b128 a[96:99], v5 offset:0
ds_read_b128 a[100:103], v5 offset:1024
ds_read_b128 a[104:107], v5 offset:2048
ds_read_b128 a[108:111], v5 offset:3072
ds_read_b128 a[112:115], v5 offset:4096
ds_read_b128 a[116:119], v5 offset:5120
ds_read_b128 a[120:123], v5 offset:6144
ds_read_b128 a[124:127], v5 offset:7168
s_waitcnt vmcnt(10) lgkmcnt(4)
v_mfma_f32_16x16x32_bf16 v[132:135], a[96:99], a[0:3], v[132:135]
ds_read_b128 a[128:131], v5 offset:8192
v_mfma_f32_16x16x32_bf16 v[148:151], a[96:99], a[4:7], v[148:151]
ds_read_b128 a[132:135], v5 offset:9216
v_mfma_f32_16x16x32_bf16 v[152:155], a[100:103], a[4:7], v[152:155]
buffer_load_dwordx4 a[48:51], v4, s[40:43], s35 offen offset:0 sc1
v_mfma_f32_16x16x32_bf16 v[136:139], a[100:103], a[0:3], v[136:139]
ds_read_b128 a[136:139], v5 offset:10240
v_mfma_f32_16x16x32_bf16 v[140:143], a[104:107], a[0:3], v[140:143]
ds_read_b128 a[140:143], v5 offset:11264
v_mfma_f32_16x16x32_bf16 v[156:159], a[104:107], a[4:7], v[156:159]
v_mfma_f32_16x16x32_bf16 v[160:163], a[108:111], a[4:7], v[160:163]
buffer_load_dwordx4 a[52:55], v4, s[40:43], s35 offen offset:1024 sc1
s_mov_b32 s35, 53248
v_mfma_f32_16x16x32_bf16 v[144:147], a[108:111], a[0:3], v[144:147]
s_waitcnt vmcnt(10) lgkmcnt(4)
v_mfma_f32_16x16x32_bf16 v[132:135], a[112:115], a[8:11], v[132:135]
ds_read_b128 a[96:99], v5 offset:12288
v_mfma_f32_16x16x32_bf16 v[148:151], a[112:115], a[12:15], v[148:151]
ds_read_b128 a[100:103], v5 offset:13312
v_mfma_f32_16x16x32_bf16 v[152:155], a[116:119], a[12:15], v[152:155]
buffer_load_dwordx4 a[0:3], v4, s[40:43], s35 offen offset:0 sc1
v_mfma_f32_16x16x32_bf16 v[136:139], a[116:119], a[8:11], v[136:139]
ds_read_b128 a[104:107], v5 offset:14336
v_mfma_f32_16x16x32_bf16 v[140:143], a[120:123], a[8:11], v[140:143]
ds_read_b128 a[108:111], v5 offset:15360
v_mfma_f32_16x16x32_bf16 v[156:159], a[120:123], a[12:15], v[156:159]
v_mfma_f32_16x16x32_bf16 v[160:163], a[124:127], a[12:15], v[160:163]
buffer_load_dwordx4 a[4:7], v4, s[40:43], s35 offen offset:1024 sc1
s_mov_b32 s35, 65536
L_stub19:
s_cbranch_execz L_wret7
v_mfma_f32_16x16x32_bf16 v[144:147], a[124:127], a[8:11], v[144:147]
s_waitcnt vmcnt(10) lgkmcnt(4)
v_mfma_f32_16x16x32_bf16 v[132:135], a[128:131], a[16:19], v[132:135]
ds_read_b128 a[112:115], v5 offset:16384
v_mfma_f32_16x16x32_bf16 v[148:151], a[128:131], a[20:23], v[148:151]
ds_read_b128 a[116:119], v5 offset:17408
v_mfma_f32_16x16x32_bf16 v[152:155], a[132:135], a[20:23], v[152:155]
buffer_load_dwordx4 a[8:11], v4, s[40:43], s35 offen offset:0 sc1
v_mfma_f32_16x16x32_bf16 v[136:139], a[132:135], a[16:19], v[136:139]
ds_read_b128 a[120:123], v5 offset:18432
v_mfma_f32_16x16x32_bf16 v[140:143], a[136:139], a[16:19], v[140:143]
ds_read_b128 a[124:127], v5 offset:19456
v_mfma_f32_16x16x32_bf16 v[156:159], a[136:139], a[20:23], v[156:159]
v_mfma_f32_16x16x32_bf16 v[160:163], a[140:143], a[20:23], v[160:163]
buffer_load_dwordx4 a[12:15], v4, s[40:43], s35 offen offset:1024 sc1
s_mov_b32 s35, 69632
v_mfma_f32_16x16x32_bf16 v[144:147], a[140:143], a[16:19], v[144:147]
s_waitcnt vmcnt(10) lgkmcnt(4)
v_mfma_f32_16x16x32_bf16 v[132:135], a[96:99], a[24:27], v[132:135]
ds_read_b128 a[128:131], v5 offset:20480
v_mfma_f32_16x16x32_bf16 v[148:151], a[96:99], a[28:31], v[148:151]
ds_read_b128 a[132:135], v5 offset:21504
v_mfma_f32_16x16x32_bf16 v[152:155], a[100:103], a[28:31], v[152:155]
buffer_load_dwordx4 a[16:19], v4, s[40:43], s35 offen offset:0 sc1
v_mfma_f32_16x16x32_bf16 v[136:139], a[100:103], a[24:27], v[136:139]
ds_read_b128 a[136:139], v5 offset:22528
v_mfma_f32_16x16x32_bf16 v[140:143], a[104:107], a[24:27], v[140:143]
ds_read_b128 a[140:143], v5 offset:23552
v_mfma_f32_16x16x32_bf16 v[156:159], a[104:107], a[28:31], v[156:159]
v_mfma_f32_16x16x32_bf16 v[160:163], a[108:111], a[28:31], v[160:163]
buffer_load_dwordx4 a[20:23], v4, s[40:43], s35 offen offset:1024 sc1
s_mov_b32 s35, 81920
v_mfma_f32_16x16x32_bf16 v[144:147], a[108:111], a[24:27], v[144:147]
s_waitcnt vmcnt(10) lgkmcnt(4)
v_mfma_f32_16x16x32_bf16 v[132:135], a[112:115], a[32:35], v[132:135]
ds_read_b128 a[96:99], v5 offset:24576
v_mfma_f32_16x16x32_bf16 v[148:151], a[112:115], a[36:39], v[148:151]
ds_read_b128 a[100:103], v5 offset:25600
v_mfma_f32_16x16x32_bf16 v[152:155], a[116:119], a[36:39], v[152:155]
buffer_load_dwordx4 a[24:27], v4, s[40:43], s35 offen offset:0 sc1
v_mfma_f32_16x16x32_bf16 v[136:139], a[116:119], a[32:35], v[136:139]
ds_read_b128 a[104:107], v5 offset:26624
v_mfma_f32_16x16x32_bf16 v[140:143], a[120:123], a[32:35], v[140:143]
ds_read_b128 a[108:111], v5 offset:27648
v_mfma_f32_16x16x32_bf16 v[156:159], a[120:123], a[36:39], v[156:159]
v_mfma_f32_16x16x32_bf16 v[160:163], a[124:127], a[36:39], v[160:163]
buffer_load_dwordx4 a[28:31], v4, s[40:43], s35 offen offset:1024 sc1
s_mov_b32 s35, 86016
v_mfma_f32_16x16x32_bf16 v[144:147], a[124:127], a[32:35], v[144:147]
s_waitcnt vmcnt(10) lgkmcnt(4)
v_mfma_f32_16x16x32_bf16 v[132:135], a[128:131], a[40:43], v[132:135]
ds_read_b128 a[112:115], v5 offset:28672
v_mfma_f32_16x16x32_bf16 v[148:151], a[128:131], a[44:47], v[148:151]
ds_read_b128 a[116:119], v5 offset:29696
v_mfma_f32_16x16x32_bf16 v[152:155], a[132:135], a[44:47], v[152:155]
buffer_load_dwordx4 a[32:35], v4, s[40:43], s35 offen offset:0 sc1
v_mfma_f32_16x16x32_bf16 v[136:139], a[132:135], a[40:43], v[136:139]
ds_read_b128 a[120:123], v5 offset:30720
v_mfma_f32_16x16x32_bf16 v[140:143], a[136:139], a[40:43], v[140:143]
ds_read_b128 a[124:127], v5 offset:31744
v_mfma_f32_16x16x32_bf16 v[156:159], a[136:139], a[44:47], v[156:159]
v_mfma_f32_16x16x32_bf16 v[160:163], a[140:143], a[44:47], v[160:163]
buffer_load_dwordx4 a[36:39], v4, s[40:43], s35 offen offset:1024 sc1
s_mov_b32 s35, 98304
v_mfma_f32_16x16x32_bf16 v[144:147], a[140:143], a[40:43], v[144:147]
s_waitcnt vmcnt(10) lgkmcnt(4)
v_mfma_f32_16x16x32_bf16 v[132:135], a[96:99], a[48:51], v[132:135]
ds_read_b128 a[128:131], v5 offset:32768
v_mfma_f32_16x16x32_bf16 v[148:151], a[96:99], a[52:55], v[148:151]
ds_read_b128 a[132:135], v5 offset:33792
v_mfma_f32_16x16x32_bf16 v[152:155], a[100:103], a[52:55], v[152:155]
buffer_load_dwordx4 a[40:43], v4, s[40:43], s35 offen offset:0 sc1
v_mfma_f32_16x16x32_bf16 v[136:139], a[100:103], a[48:51], v[136:139]
ds_read_b128 a[136:139], v5 offset:34816
v_mfma_f32_16x16x32_bf16 v[140:143], a[104:107], a[48:51], v[140:143]
ds_read_b128 a[140:143], v5 offset:35840
v_mfma_f32_16x16x32_bf16 v[156:159], a[104:107], a[52:55], v[156:159]
v_mfma_f32_16x16x32_bf16 v[160:163], a[108:111], a[52:55], v[160:163]
buffer_load_dwordx4 a[44:47], v4, s[40:43], s35 offen offset:1024 sc1
s_mov_b32 s35, 102400
v_mfma_f32_16x16x32_bf16 v[144:147], a[108:111], a[48:51], v[144:147]
s_waitcnt vmcnt(10) lgkmcnt(4)
v_mfma_f32_16x16x32_bf16 v[132:135], a[112:115], a[0:3], v[132:135]
ds_read_b128 a[96:99], v5 offset:36864
v_mfma_f32_16x16x32_bf16 v[148:151], a[112:115], a[4:7], v[148:151]
ds_read_b128 a[100:103], v5 offset:37888
v_mfma_f32_16x16x32_bf16 v[152:155], a[116:119], a[4:7], v[152:155]
buffer_load_dwordx4 a[48:51], v4, s[40:43], s35 offen offset:0 sc1
v_mfma_f32_16x16x32_bf16 v[136:139], a[116:119], a[0:3], v[136:139]
ds_read_b128 a[104:107], v5 offset:38912
v_mfma_f32_16x16x32_bf16 v[140:143], a[120:123], a[0:3], v[140:143]
ds_read_b128 a[108:111], v5 offset:39936
v_mfma_f32_16x16x32_bf16 v[156:159], a[120:123], a[4:7], v[156:159]
v_mfma_f32_16x16x32_bf16 v[160:163], a[124:127], a[4:7], v[160:163]
buffer_load_dwordx4 a[52:55], v4, s[40:43], s35 offen offset:1024 sc1
s_mov_b32 s35, 114688
v_mfma_f32_16x16x32_bf16 v[144:147], a[124:127], a[0:3], v[144:147]
s_waitcnt vmcnt(10) lgkmcnt(4)
v_mfma_f32_16x16x32_bf16 v[132:135], a[128:131], a[8:11], v[132:135]
ds_read_b128 a[112:115], v5 offset:40960
v_mfma_f32_16x16x32_bf16 v[148:151], a[128:131], a[12:15], v[148:151]
ds_read_b128 a[116:119], v5 offset:41984
v_mfma_f32_16x16x32_bf16 v[152:155], a[132:135], a[12:15], v[152:155]
buffer_load_dwordx4 a[0:3], v4, s[40:43], s35 offen offset:0 sc1
v_mfma_f32_16x16x32_bf16 v[136:139], a[132:135], a[8:11], v[136:139]
ds_read_b128 a[120:123], v5 offset:43008
v_mfma_f32_16x16x32_bf16 v[140:143], a[136:139], a[8:11], v[140:143]
ds_read_b128 a[124:127], v5 offset:44032
v_mfma_f32_16x16x32_bf16 v[156:159], a[136:139], a[12:15], v[156:159]
v_mfma_f32_16x16x32_bf16 v[160:163], a[140:143], a[12:15], v[160:163]
buffer_load_dwordx4 a[4:7], v4, s[40:43], s35 offen offset:1024 sc1
s_mov_b32 s35, 118784
v_mfma_f32_16x16x32_bf16 v[144:147], a[140:143], a[8:11], v[144:147]
s_waitcnt vmcnt(10) lgkmcnt(4)
v_mfma_f32_16x16x32_bf16 v[132:135], a[96:99], a[16:19], v[132:135]
ds_read_b128 a[128:131], v5 offset:45056
v_mfma_f32_16x16x32_bf16 v[148:151], a[96:99], a[20:23], v[148:151]
ds_read_b128 a[132:135], v5 offset:46080
v_mfma_f32_16x16x32_bf16 v[152:155], a[100:103], a[20:23], v[152:155]
buffer_load_dwordx4 a[8:11], v4, s[40:43], s35 offen offset:0 sc1
v_mfma_f32_16x16x32_bf16 v[136:139], a[100:103], a[16:19], v[136:139]
ds_read_b128 a[136:139], v5 offset:47104
v_mfma_f32_16x16x32_bf16 v[140:143], a[104:107], a[16:19], v[140:143]
ds_read_b128 a[140:143], v5 offset:48128
v_mfma_f32_16x16x32_bf16 v[156:159], a[104:107], a[20:23], v[156:159]
v_mfma_f32_16x16x32_bf16 v[160:163], a[108:111], a[20:23], v[160:163]
buffer_load_dwordx4 a[12:15], v4, s[40:43], s35 offen offset:1024 sc1
s_mov_b32 s35, 524288
v_mfma_f32_16x16x32_bf16 v[144:147], a[108:111], a[16:19], v[144:147]
s_waitcnt vmcnt(10) lgkmcnt(4)
v_mfma_f32_16x16x32_bf16 v[132:135], a[112:115], a[24:27], v[132:135]
ds_read_b128 a[96:99], v5 offset:49152
v_mfma_f32_16x16x32_bf16 v[148:151], a[112:115], a[28:31], v[148:151]
ds_read_b128 a[100:103], v5 offset:50176
v_mfma_f32_16x16x32_bf16 v[152:155], a[116:119], a[28:31], v[152:155]
buffer_load_dwordx4 a[16:19], v4, s[40:43], s35 offen offset:0 sc1
v_mfma_f32_16x16x32_bf16 v[136:139], a[116:119], a[24:27], v[136:139]
ds_read_b128 a[104:107], v5 offset:51200
v_mfma_f32_16x16x32_bf16 v[140:143], a[120:123], a[24:27], v[140:143]
ds_read_b128 a[108:111], v5 offset:52224
v_mfma_f32_16x16x32_bf16 v[156:159], a[120:123], a[28:31], v[156:159]
v_mfma_f32_16x16x32_bf16 v[160:163], a[124:127], a[28:31], v[160:163]
buffer_load_dwordx4 a[20:23], v4, s[40:43], s35 offen offset:1024 sc1
s_mov_b32 s35, 528384
v_mfma_f32_16x16x32_bf16 v[144:147], a[124:127], a[24:27], v[144:147]
s_waitcnt vmcnt(10) lgkmcnt(4)
v_mfma_f32_16x16x32_bf16 v[132:135], a[128:131], a[32:35], v[132:135]
ds_read_b128 a[112:115], v5 offset:53248
v_mfma_f32_16x16x32_bf16 v[148:151], a[128:131], a[36:39], v[148:151]
ds_read_b128 a[116:119], v5 offset:54272
v_mfma_f32_16x16x32_bf16 v[152:155], a[132:135], a[36:39], v[152:155]
buffer_load_dwordx4 a[24:27], v4, s[40:43], s35 offen offset:0 sc1
v_mfma_f32_16x16x32_bf16 v[136:139], a[132:135], a[32:35], v[136:139]
ds_read_b128 a[120:123], v5 offset:55296
v_mfma_f32_16x16x32_bf16 v[140:143], a[136:139], a[32:35], v[140:143]
ds_read_b128 a[124:127], v5 offset:56320
v_mfma_f32_16x16x32_bf16 v[156:159], a[136:139], a[36:39], v[156:159]
v_mfma_f32_16x16x32_bf16 v[160:163], a[140:143], a[36:39], v[160:163]
buffer_load_dwordx4 a[28:31], v4, s[40:43], s35 offen offset:1024 sc1
s_mov_b32 s35, 540672
v_mfma_f32_16x16x32_bf16 v[144:147], a[140:143], a[32:35], v[144:147]
s_waitcnt vmcnt(10) lgkmcnt(4)
v_mfma_f32_16x16x32_bf16 v[132:135], a[96:99], a[40:43], v[132:135]
ds_read_b128 a[128:131], v5 offset:57344
v_mfma_f32_16x16x32_bf16 v[148:151], a[96:99], a[44:47], v[148:151]
ds_read_b128 a[132:135], v5 offset:58368
v_mfma_f32_16x16x32_bf16 v[152:155], a[100:103], a[44:47], v[152:155]
buffer_load_dwordx4 a[32:35], v4, s[40:43], s35 offen offset:0 sc1
v_mfma_f32_16x16x32_bf16 v[136:139], a[100:103], a[40:43], v[136:139]
ds_read_b128 a[136:139], v5 offset:59392
v_mfma_f32_16x16x32_bf16 v[140:143], a[104:107], a[40:43], v[140:143]
ds_read_b128 a[140:143], v5 offset:60416
v_mfma_f32_16x16x32_bf16 v[156:159], a[104:107], a[44:47], v[156:159]
v_mfma_f32_16x16x32_bf16 v[160:163], a[108:111], a[44:47], v[160:163]
buffer_load_dwordx4 a[36:39], v4, s[40:43], s35 offen offset:1024 sc1
s_mov_b32 s35, 544768
v_mfma_f32_16x16x32_bf16 v[144:147], a[108:111], a[40:43], v[144:147]
s_waitcnt vmcnt(10) lgkmcnt(4)
v_mfma_f32_16x16x32_bf16 v[132:135], a[112:115], a[48:51], v[132:135]
ds_read_b128 a[96:99], v5 offset:61440
v_mfma_f32_16x16x32_bf16 v[148:151], a[112:115], a[52:55], v[148:151]
ds_read_b128 a[100:103], v5 offset:62464
v_mfma_f32_16x16x32_bf16 v[152:155], a[116:119], a[52:55], v[152:155]
buffer_load_dwordx4 a[40:43], v4, s[40:43], s35 offen offset:0 sc1
v_mfma_f32_16x16x32_bf16 v[136:139], a[116:119], a[48:51], v[136:139]
ds_read_b128 a[104:107], v5 offset:63488
v_mfma_f32_16x16x32_bf16 v[140:143], a[120:123], a[48:51], v[140:143]
ds_read_b128 a[108:111], v5 offset:64512
v_mfma_f32_16x16x32_bf16 v[156:159], a[120:123], a[52:55], v[156:159]
v_mfma_f32_16x16x32_bf16 v[160:163], a[124:127], a[52:55], v[160:163]
buffer_load_dwordx4 a[44:47], v4, s[40:43], s35 offen offset:1024 sc1
s_mov_b32 s35, 557056
v_mfma_f32_16x16x32_bf16 v[144:147], a[124:127], a[48:51], v[144:147]
s_waitcnt vmcnt(10) lgkmcnt(4)
v_mfma_f32_16x16x32_bf16 v[132:135], a[128:131], a[0:3], v[132:135]
ds_read_b128 a[112:115], v6 offset:0
v_mfma_f32_16x16x32_bf16 v[148:151], a[128:131], a[4:7], v[148:151]
ds_read_b128 a[116:119], v6 offset:1024
v_mfma_f32_16x16x32_bf16 v[152:155], a[132:135], a[4:7], v[152:155]
buffer_load_dwordx4 a[48:51], v4, s[40:43], s35 offen offset:0 sc1
v_mfma_f32_16x16x32_bf16 v[136:139], a[132:135], a[0:3], v[136:139]
ds_read_b128 a[120:123], v6 offset:2048
v_mfma_f32_16x16x32_bf16 v[140:143], a[136:139], a[0:3], v[140:143]
ds_read_b128 a[124:127], v6 offset:3072
v_mfma_f32_16x16x32_bf16 v[156:159], a[136:139], a[4:7], v[156:159]
v_mfma_f32_16x16x32_bf16 v[160:163], a[140:143], a[4:7], v[160:163]
buffer_load_dwordx4 a[52:55], v4, s[40:43], s35 offen offset:1024 sc1
s_mov_b32 s35, 561152
v_mfma_f32_16x16x32_bf16 v[144:147], a[140:143], a[0:3], v[144:147]
s_waitcnt vmcnt(10) lgkmcnt(4)
v_mfma_f32_16x16x32_bf16 v[132:135], a[96:99], a[8:11], v[132:135]
ds_read_b128 a[128:131], v6 offset:4096
v_mfma_f32_16x16x32_bf16 v[148:151], a[96:99], a[12:15], v[148:151]
ds_read_b128 a[132:135], v6 offset:5120
v_mfma_f32_16x16x32_bf16 v[152:155], a[100:103], a[12:15], v[152:155]
buffer_load_dwordx4 a[0:3], v4, s[40:43], s35 offen offset:0 sc1
v_mfma_f32_16x16x32_bf16 v[136:139], a[100:103], a[8:11], v[136:139]
ds_read_b128 a[136:139], v6 offset:6144
v_mfma_f32_16x16x32_bf16 v[140:143], a[104:107], a[8:11], v[140:143]
ds_read_b128 a[140:143], v6 offset:7168
v_mfma_f32_16x16x32_bf16 v[156:159], a[104:107], a[12:15], v[156:159]
v_mfma_f32_16x16x32_bf16 v[160:163], a[108:111], a[12:15], v[160:163]
buffer_load_dwordx4 a[4:7], v4, s[40:43], s35 offen offset:1024 sc1
s_mov_b32 s35, 573440
v_mfma_f32_16x16x32_bf16 v[144:147], a[108:111], a[8:11], v[144:147]
s_waitcnt vmcnt(10) lgkmcnt(4)
v_mfma_f32_16x16x32_bf16 v[132:135], a[112:115], a[16:19], v[132:135]
ds_read_b128 a[96:99], v6 offset:8192
v_mfma_f32_16x16x32_bf16 v[148:151], a[112:115], a[20:23], v[148:151]
ds_read_b128 a[100:103], v6 offset:9216
v_mfma_f32_16x16x32_bf16 v[152:155], a[116:119], a[20:23], v[152:155]
buffer_load_dwordx4 a[8:11], v4, s[40:43], s35 offen offset:0 sc1
v_mfma_f32_16x16x32_bf16 v[136:139], a[116:119], a[16:19], v[136:139]
ds_read_b128 a[104:107], v6 offset:10240
v_mfma_f32_16x16x32_bf16 v[140:143], a[120:123], a[16:19], v[140:143]
ds_read_b128 a[108:111], v6 offset:11264
v_mfma_f32_16x16x32_bf16 v[156:159], a[120:123], a[20:23], v[156:159]
v_mfma_f32_16x16x32_bf16 v[160:163], a[124:127], a[20:23], v[160:163]
buffer_load_dwordx4 a[12:15], v4, s[40:43], s35 offen offset:1024 sc1
s_mov_b32 s35, 577536
v_mfma_f32_16x16x32_bf16 v[144:147], a[124:127], a[16:19], v[144:147]
s_waitcnt vmcnt(10) lgkmcnt(4)
v_mfma_f32_16x16x32_bf16 v[132:135], a[128:131], a[24:27], v[132:135]
ds_read_b128 a[112:115], v6 offset:12288
v_mfma_f32_16x16x32_bf16 v[148:151], a[128:131], a[28:31], v[148:151]
ds_read_b128 a[116:119], v6 offset:13312
v_mfma_f32_16x16x32_bf16 v[152:155], a[132:135], a[28:31], v[152:155]
buffer_load_dwordx4 a[16:19], v4, s[40:43], s35 offen offset:0 sc1
v_mfma_f32_16x16x32_bf16 v[136:139], a[132:135], a[24:27], v[136:139]
ds_read_b128 a[120:123], v6 offset:14336
v_mfma_f32_16x16x32_bf16 v[140:143], a[136:139], a[24:27], v[140:143]
ds_read_b128 a[124:127], v6 offset:15360
v_mfma_f32_16x16x32_bf16 v[156:159], a[136:139], a[28:31], v[156:159]
v_mfma_f32_16x16x32_bf16 v[160:163], a[140:143], a[28:31], v[160:163]
buffer_load_dwordx4 a[20:23], v4, s[40:43], s35 offen offset:1024 sc1
s_mov_b32 s35, 589824
v_mfma_f32_16x16x32_bf16 v[144:147], a[140:143], a[24:27], v[144:147]
s_waitcnt vmcnt(10) lgkmcnt(4)
v_mfma_f32_16x16x32_bf16 v[132:135], a[96:99], a[32:35], v[132:135]
ds_read_b128 a[128:131], v6 offset:16384
v_mfma_f32_16x16x32_bf16 v[148:151], a[96:99], a[36:39], v[148:151]
ds_read_b128 a[132:135], v6 offset:17408
v_mfma_f32_16x16x32_bf16 v[152:155], a[100:103], a[36:39], v[152:155]
buffer_load_dwordx4 a[24:27], v4, s[40:43], s35 offen offset:0 sc1
v_mfma_f32_16x16x32_bf16 v[136:139], a[100:103], a[32:35], v[136:139]
ds_read_b128 a[136:139], v6 offset:18432
v_mfma_f32_16x16x32_bf16 v[140:143], a[104:107], a[32:35], v[140:143]
ds_read_b128 a[140:143], v6 offset:19456
v_mfma_f32_16x16x32_bf16 v[156:159], a[104:107], a[36:39], v[156:159]
v_mfma_f32_16x16x32_bf16 v[160:163], a[108:111], a[36:39], v[160:163]
buffer_load_dwordx4 a[28:31], v4, s[40:43], s35 offen offset:1024 sc1
s_mov_b32 s35, 593920
v_mfma_f32_16x16x32_bf16 v[144:147], a[108:111], a[32:35], v[144:147]
s_waitcnt vmcnt(10) lgkmcnt(4)
v_mfma_f32_16x16x32_bf16 v[132:135], a[112:115], a[40:43], v[132:135]
ds_read_b128 a[96:99], v6 offset:20480
v_mfma_f32_16x16x32_bf16 v[148:151], a[112:115], a[44:47], v[148:151]
ds_read_b128 a[100:103], v6 offset:21504
v_mfma_f32_16x16x32_bf16 v[152:155], a[116:119], a[44:47], v[152:155]
buffer_load_dwordx4 a[32:35], v4, s[40:43], s35 offen offset:0 sc1
v_mfma_f32_16x16x32_bf16 v[136:139], a[116:119], a[40:43], v[136:139]
ds_read_b128 a[104:107], v6 offset:22528
v_mfma_f32_16x16x32_bf16 v[140:143], a[120:123], a[40:43], v[140:143]
ds_read_b128 a[108:111], v6 offset:23552
v_mfma_f32_16x16x32_bf16 v[156:159], a[120:123], a[44:47], v[156:159]
v_mfma_f32_16x16x32_bf16 v[160:163], a[124:127], a[44:47], v[160:163]
buffer_load_dwordx4 a[36:39], v4, s[40:43], s35 offen offset:1024 sc1
s_mov_b32 s35, 606208
v_mfma_f32_16x16x32_bf16 v[144:147], a[124:127], a[40:43], v[144:147]
s_waitcnt vmcnt(10) lgkmcnt(4)
v_mfma_f32_16x16x32_bf16 v[132:135], a[128:131], a[48:51], v[132:135]
ds_read_b128 a[112:115], v6 offset:24576
v_mfma_f32_16x16x32_bf16 v[148:151], a[128:131], a[52:55], v[148:151]
ds_read_b128 a[116:119], v6 offset:25600
v_mfma_f32_16x16x32_bf16 v[152:155], a[132:135], a[52:55], v[152:155]
buffer_load_dwordx4 a[40:43], v4, s[40:43], s35 offen offset:0 sc1
v_mfma_f32_16x16x32_bf16 v[136:139], a[132:135], a[48:51], v[136:139]
ds_read_b128 a[120:123], v6 offset:26624
v_mfma_f32_16x16x32_bf16 v[140:143], a[136:139], a[48:51], v[140:143]
ds_read_b128 a[124:127], v6 offset:27648
v_mfma_f32_16x16x32_bf16 v[156:159], a[136:139], a[52:55], v[156:159]
v_mfma_f32_16x16x32_bf16 v[160:163], a[140:143], a[52:55], v[160:163]
buffer_load_dwordx4 a[44:47], v4, s[40:43], s35 offen offset:1024 sc1
s_mov_b32 s35, 610304
v_mfma_f32_16x16x32_bf16 v[144:147], a[140:143], a[48:51], v[144:147]
s_waitcnt vmcnt(10) lgkmcnt(4)
v_mfma_f32_16x16x32_bf16 v[132:135], a[96:99], a[0:3], v[132:135]
ds_read_b128 a[128:131], v6 offset:28672
v_mfma_f32_16x16x32_bf16 v[148:151], a[96:99], a[4:7], v[148:151]
ds_read_b128 a[132:135], v6 offset:29696
v_mfma_f32_16x16x32_bf16 v[152:155], a[100:103], a[4:7], v[152:155]
buffer_load_dwordx4 a[48:51], v4, s[40:43], s35 offen offset:0 sc1
v_mfma_f32_16x16x32_bf16 v[136:139], a[100:103], a[0:3], v[136:139]
ds_read_b128 a[136:139], v6 offset:30720
v_mfma_f32_16x16x32_bf16 v[140:143], a[104:107], a[0:3], v[140:143]
ds_read_b128 a[140:143], v6 offset:31744
v_mfma_f32_16x16x32_bf16 v[156:159], a[104:107], a[4:7], v[156:159]
v_mfma_f32_16x16x32_bf16 v[160:163], a[108:111], a[4:7], v[160:163]
buffer_load_dwordx4 a[52:55], v4, s[40:43], s35 offen offset:1024 sc1
s_mov_b32 s35, 622592
v_mfma_f32_16x16x32_bf16 v[144:147], a[108:111], a[0:3], v[144:147]
s_waitcnt vmcnt(10) lgkmcnt(4)
v_mfma_f32_16x16x32_bf16 v[132:135], a[112:115], a[8:11], v[132:135]
ds_read_b128 a[96:99], v6 offset:32768
v_mfma_f32_16x16x32_bf16 v[148:151], a[112:115], a[12:15], v[148:151]
ds_read_b128 a[100:103], v6 offset:33792
v_mfma_f32_16x16x32_bf16 v[152:155], a[116:119], a[12:15], v[152:155]
buffer_load_dwordx4 a[0:3], v4, s[40:43], s35 offen offset:0 sc1
v_mfma_f32_16x16x32_bf16 v[136:139], a[116:119], a[8:11], v[136:139]
ds_read_b128 a[104:107], v6 offset:34816
v_mfma_f32_16x16x32_bf16 v[140:143], a[120:123], a[8:11], v[140:143]
ds_read_b128 a[108:111], v6 offset:35840
v_mfma_f32_16x16x32_bf16 v[156:159], a[120:123], a[12:15], v[156:159]
v_mfma_f32_16x16x32_bf16 v[160:163], a[124:127], a[12:15], v[160:163]
buffer_load_dwordx4 a[4:7], v4, s[40:43], s35 offen offset:1024 sc1
s_mov_b32 s35, 626688
v_mfma_f32_16x16x32_bf16 v[144:147], a[124:127], a[8:11], v[144:147]
s_waitcnt vmcnt(10) lgkmcnt(4)
v_mfma_f32_16x16x32_bf16 v[132:135], a[128:131], a[16:19], v[132:135]
ds_read_b128 a[112:115], v6 offset:36864
v_mfma_f32_16x16x32_bf16 v[148:151], a[128:131], a[20:23], v[148:151]
ds_read_b128 a[116:119], v6 offset:37888
v_mfma_f32_16x16x32_bf16 v[152:155], a[132:135], a[20:23], v[152:155]
buffer_load_dwordx4 a[8:11], v4, s[40:43], s35 offen offset:0 sc1
v_mfma_f32_16x16x32_bf16 v[136:139], a[132:135], a[16:19], v[136:139]
ds_read_b128 a[120:123], v6 offset:38912
v_mfma_f32_16x16x32_bf16 v[140:143], a[136:139], a[16:19], v[140:143]
ds_read_b128 a[124:127], v6 offset:39936
v_mfma_f32_16x16x32_bf16 v[156:159], a[136:139], a[20:23], v[156:159]
v_mfma_f32_16x16x32_bf16 v[160:163], a[140:143], a[20:23], v[160:163]
buffer_load_dwordx4 a[12:15], v4, s[40:43], s35 offen offset:1024 sc1
s_mov_b32 s35, 638976
v_mfma_f32_16x16x32_bf16 v[144:147], a[140:143], a[16:19], v[144:147]
s_waitcnt vmcnt(10) lgkmcnt(4)
v_mfma_f32_16x16x32_bf16 v[132:135], a[96:99], a[24:27], v[132:135]
ds_read_b128 a[128:131], v6 offset:40960
v_mfma_f32_16x16x32_bf16 v[148:151], a[96:99], a[28:31], v[148:151]
ds_read_b128 a[132:135], v6 offset:41984
v_mfma_f32_16x16x32_bf16 v[152:155], a[100:103], a[28:31], v[152:155]
buffer_load_dwordx4 a[16:19], v4, s[40:43], s35 offen offset:0 sc1
v_mfma_f32_16x16x32_bf16 v[136:139], a[100:103], a[24:27], v[136:139]
ds_read_b128 a[136:139], v6 offset:43008
v_mfma_f32_16x16x32_bf16 v[140:143], a[104:107], a[24:27], v[140:143]
ds_read_b128 a[140:143], v6 offset:44032
v_mfma_f32_16x16x32_bf16 v[156:159], a[104:107], a[28:31], v[156:159]
v_mfma_f32_16x16x32_bf16 v[160:163], a[108:111], a[28:31], v[160:163]
buffer_load_dwordx4 a[20:23], v4, s[40:43], s35 offen offset:1024 sc1
s_mov_b32 s35, 643072
v_mfma_f32_16x16x32_bf16 v[144:147], a[108:111], a[24:27], v[144:147]
s_waitcnt vmcnt(10) lgkmcnt(4)
v_mfma_f32_16x16x32_bf16 v[132:135], a[112:115], a[32:35], v[132:135]
ds_read_b128 a[96:99], v6 offset:45056
v_mfma_f32_16x16x32_bf16 v[148:151], a[112:115], a[36:39], v[148:151]
ds_read_b128 a[100:103], v6 offset:46080
v_mfma_f32_16x16x32_bf16 v[152:155], a[116:119], a[36:39], v[152:155]
buffer_load_dwordx4 a[24:27], v4, s[40:43], s35 offen offset:0 sc1
v_mfma_f32_16x16x32_bf16 v[136:139], a[116:119], a[32:35], v[136:139]
ds_read_b128 a[104:107], v6 offset:47104
v_mfma_f32_16x16x32_bf16 v[140:143], a[120:123], a[32:35], v[140:143]
ds_read_b128 a[108:111], v6 offset:48128
v_mfma_f32_16x16x32_bf16 v[156:159], a[120:123], a[36:39], v[156:159]
v_mfma_f32_16x16x32_bf16 v[160:163], a[124:127], a[36:39], v[160:163]
buffer_load_dwordx4 a[28:31], v4, s[40:43], s35 offen offset:1024 sc1
s_mov_b32 s35, 1048576
v_mfma_f32_16x16x32_bf16 v[144:147], a[124:127], a[32:35], v[144:147]
s_waitcnt vmcnt(10) lgkmcnt(4)
v_mfma_f32_16x16x32_bf16 v[132:135], a[128:131], a[40:43], v[132:135]
ds_read_b128 a[112:115], v6 offset:49152
v_mfma_f32_16x16x32_bf16 v[148:151], a[128:131], a[44:47], v[148:151]
ds_read_b128 a[116:119], v6 offset:50176
v_mfma_f32_16x16x32_bf16 v[152:155], a[132:135], a[44:47], v[152:155]
ds_read_b128 a[120:123], v6 offset:51200
v_mfma_f32_16x16x32_bf16 v[136:139], a[132:135], a[40:43], v[136:139]
ds_read_b128 a[124:127], v6 offset:52224
v_mfma_f32_16x16x32_bf16 v[140:143], a[136:139], a[40:43], v[140:143]
v_mfma_f32_16x16x32_bf16 v[156:159], a[136:139], a[44:47], v[156:159]
v_mfma_f32_16x16x32_bf16 v[160:163], a[140:143], a[44:47], v[160:163]
v_mfma_f32_16x16x32_bf16 v[144:147], a[140:143], a[40:43], v[144:147]
s_waitcnt vmcnt(8) lgkmcnt(4)
v_mfma_f32_16x16x32_bf16 v[132:135], a[96:99], a[48:51], v[132:135]
ds_read_b128 a[128:131], v6 offset:53248
v_mfma_f32_16x16x32_bf16 v[148:151], a[96:99], a[52:55], v[148:151]
ds_read_b128 a[132:135], v6 offset:54272
v_mfma_f32_16x16x32_bf16 v[152:155], a[100:103], a[52:55], v[152:155]
ds_read_b128 a[136:139], v6 offset:55296
v_mfma_f32_16x16x32_bf16 v[136:139], a[100:103], a[48:51], v[136:139]
ds_read_b128 a[140:143], v6 offset:56320
v_mfma_f32_16x16x32_bf16 v[140:143], a[104:107], a[48:51], v[140:143]
v_mfma_f32_16x16x32_bf16 v[156:159], a[104:107], a[52:55], v[156:159]
v_mfma_f32_16x16x32_bf16 v[160:163], a[108:111], a[52:55], v[160:163]
v_mfma_f32_16x16x32_bf16 v[144:147], a[108:111], a[48:51], v[144:147]
s_waitcnt vmcnt(6) lgkmcnt(4)
v_mfma_f32_16x16x32_bf16 v[132:135], a[112:115], a[0:3], v[132:135]
ds_read_b128 a[96:99], v6 offset:57344
v_mfma_f32_16x16x32_bf16 v[148:151], a[112:115], a[4:7], v[148:151]
ds_read_b128 a[100:103], v6 offset:58368
v_mfma_f32_16x16x32_bf16 v[152:155], a[116:119], a[4:7], v[152:155]
ds_read_b128 a[104:107], v6 offset:59392
v_mfma_f32_16x16x32_bf16 v[136:139], a[116:119], a[0:3], v[136:139]
ds_read_b128 a[108:111], v6 offset:60416
v_mfma_f32_16x16x32_bf16 v[140:143], a[120:123], a[0:3], v[140:143]
v_mfma_f32_16x16x32_bf16 v[156:159], a[120:123], a[4:7], v[156:159]
v_mfma_f32_16x16x32_bf16 v[160:163], a[124:127], a[4:7], v[160:163]
v_mfma_f32_16x16x32_bf16 v[144:147], a[124:127], a[0:3], v[144:147]
s_waitcnt vmcnt(4) lgkmcnt(4)
v_mfma_f32_16x16x32_bf16 v[132:135], a[128:131], a[8:11], v[132:135]
ds_read_b128 a[112:115], v6 offset:61440
v_mfma_f32_16x16x32_bf16 v[148:151], a[128:131], a[12:15], v[148:151]
ds_read_b128 a[116:119], v6 offset:62464
v_mfma_f32_16x16x32_bf16 v[152:155], a[132:135], a[12:15], v[152:155]
ds_read_b128 a[120:123], v6 offset:63488
v_mfma_f32_16x16x32_bf16 v[136:139], a[132:135], a[8:11], v[136:139]
ds_read_b128 a[124:127], v6 offset:64512
v_mfma_f32_16x16x32_bf16 v[140:143], a[136:139], a[8:11], v[140:143]
v_mfma_f32_16x16x32_bf16 v[156:159], a[136:139], a[12:15], v[156:159]
v_mfma_f32_16x16x32_bf16 v[160:163], a[140:143], a[12:15], v[160:163]
v_mfma_f32_16x16x32_bf16 v[144:147], a[140:143], a[8:11], v[144:147]
s_waitcnt vmcnt(2) lgkmcnt(4)
v_mfma_f32_16x16x32_bf16 v[132:135], a[96:99], a[16:19], v[132:135]
v_mfma_f32_16x16x32_bf16 v[148:151], a[96:99], a[20:23], v[148:151]
v_mfma_f32_16x16x32_bf16 v[152:155], a[100:103], a[20:23], v[152:155]
v_mfma_f32_16x16x32_bf16 v[136:139], a[100:103], a[16:19], v[136:139]
v_mfma_f32_16x16x32_bf16 v[140:143], a[104:107], a[16:19], v[140:143]
v_mfma_f32_16x16x32_bf16 v[156:159], a[104:107], a[20:23], v[156:159]
v_mfma_f32_16x16x32_bf16 v[160:163], a[108:111], a[20:23], v[160:163]
v_mfma_f32_16x16x32_bf16 v[144:147], a[108:111], a[16:19], v[144:147]
s_waitcnt vmcnt(0) lgkmcnt(0)
v_mfma_f32_16x16x32_bf16 v[132:135], a[112:115], a[24:27], v[132:135]
v_mfma_f32_16x16x32_bf16 v[148:151], a[112:115], a[28:31], v[148:151]
v_mfma_f32_16x16x32_bf16 v[152:155], a[116:119], a[28:31], v[152:155]
buffer_atomic_add v12, v10, s[4:7], s92 offen sc1
v_mfma_f32_16x16x32_bf16 v[136:139], a[116:119], a[24:27], v[136:139]
v_mfma_f32_16x16x32_bf16 v[140:143], a[120:123], a[24:27], v[140:143]
v_mfma_f32_16x16x32_bf16 v[156:159], a[120:123], a[28:31], v[156:159]
v_mfma_f32_16x16x32_bf16 v[160:163], a[124:127], a[28:31], v[160:163]
v_mfma_f32_16x16x32_bf16 v[144:147], a[124:127], a[24:27], v[144:147]
s_nop 0
v_cmp_u_f32 vcc, v132, v148
s_nop 0
s_and_b32 vcc_lo, vcc_lo, s95
s_cbranch_scc1 L_k2redo3
s_and_b32 s36, s31, 7
s_lshl_b32 s36, s36, 7
s_lshl_b32 s37, s28, 5
s_add_u32 s36, s36, s37
s_lshl_b32 s36, s36, 1
s_lshr_b32 s37, s31, 3
s_add_u32 s36, s36, s37
s_lshl_b32 s36, s36, 11
s_lshl_b32 s37, s32, 7
v_and_b32 v234, 15, v0
s_add_u32 s36, s36, s37
v_lshrrev_b32 v233, 4, v0
v_lshl_add_u32 v232, v234, 12, s36
v_cvt_pk_bf16_f32 v32, v132, v133
v_cvt_pk_bf16_f32 v33, v134, v135
v_cvt_pk_bf16_f32 v34, v136, v137
v_cvt_pk_bf16_f32 v35, v138, v139
v_lshl_add_u32 v232, v233, 4, v232
buffer_store_dwordx4 v[32:35], v232, s[12:15], 0 offen offset:0
v_cvt_pk_bf16_f32 v36, v140, v141
v_cvt_pk_bf16_f32 v37, v142, v143
v_cvt_pk_bf16_f32 v38, v144, v145
v_cvt_pk_bf16_f32 v39, v146, v147
v_cvt_pk_bf16_f32 v40, v148, v149
v_cvt_pk_bf16_f32 v41, v150, v151
v_cvt_pk_bf16_f32 v42, v152, v153
v_cvt_pk_bf16_f32 v43, v154, v155
s_mov_b32 s36, 0x10000
v_cvt_pk_bf16_f32 v44, v156, v157
v_cvt_pk_bf16_f32 v45, v158, v159
v_cvt_pk_bf16_f32 v46, v160, v161
buffer_store_dwordx4 v[36:39], v232, s[12:15], 0 offen offset:64
v_cvt_pk_bf16_f32 v47, v162, v163
buffer_store_dwordx4 v[40:43], v232, s[12:15], s36 offen offset:0
buffer_store_dwordx4 v[44:47], v232, s[12:15], s36 offen offset:64
s_or_b32 s36, s2, s28
s_cbranch_scc1 Lep_50
s_mov_b32 s36, 0xf0000
buffer_store_dword v15, off, s[4:7], s36 sc1
Lep_50:
L_end:
s_endpgm
Ltal_5:
s_mov_b32 s53, 0
Ltal_5b:
s_sleep 8
buffer_load_dword v11, v1, s[24:27], 0 offen sc1
s_add_u32 s53, s53, 1
s_waitcnt vmcnt(0)
v_readlane_b32 s51, v11, 0
v_readlane_b32 s52, v11, 8
s_nop 0
s_add_u32 s51, s51, s52
s_cmp_lt_u32 s51, 0x400000
s_cbranch_scc0 Ltab_6
s_cmp_lt_u32 s53, 0x100000
s_cbranch_scc1 Ltal_5b
s_branch Ltab_6
L_hxredo0:
s_mov_b32 s37, 0
L_hxredo0b:
s_sleep 2
buffer_load_dwordx4 v[228:231], v9, s[4:7], s55 offen sc1
buffer_load_dwordx4 v[72:75], v9, s[4:7], s55 offen offset:1024 sc1
s_waitcnt vmcnt(1)
v_max3_u32 v244, v228, v229, v230
s_waitcnt vmcnt(0)
v_max3_u32 v244, v244, v231, v72
v_max3_u32 v244, v244, v73, v74
v_max_u32 v244, v244, v75
v_cmp_eq_u32 vcc, -1, v244
s_cbranch_vccz L_hxback0
s_add_u32 s37, s37, 1
s_cmp_lt_u32 s37, 0x100000
s_cbranch_scc1 L_hxredo0b
s_branch L_hxback0
Ltr_12:
s_add_u32 s52, s67, 0xe0000
s_mov_b32 s53, 0
Ltp_13:
s_sleep 2
v_mov_b32 v11, v15
s_mov_b64 exec, 0xffff
v_mov_b32 v11, 0
buffer_atomic_add v11, v255, s[4:7], s52 offen sc0 sc1
s_mov_b64 exec, -1
s_add_u32 s53, s53, 1
s_waitcnt vmcnt(0)
v_cmp_ne_u32 vcc, v11, v15
s_cbranch_vccz Lte_14
s_cmp_lt_u32 s53, 0x100000
s_cbranch_scc1 Ltp_13
s_branch Lte_14
Ltr_15:
s_add_u32 s52, s66, 0xd0040
s_mov_b32 s53, 0
Ltp_16:
s_sleep 2
v_mov_b32 v232, v15
s_mov_b64 exec, 0xffff
v_mov_b32 v232, 0
buffer_atomic_add v232, v255, s[4:7], s52 offen sc0 sc1
s_mov_b64 exec, -1
s_add_u32 s53, s53, 1
s_waitcnt vmcnt(0)
v_cmp_ne_u32 vcc, v232, v15
s_cbranch_vccz Lte_17
s_cmp_lt_u32 s53, 0x100000
s_cbranch_scc1 Ltp_16
s_branch Lte_17
L_kvredo1:
s_mov_b32 s88, 0
L_kvredo1b:
v_max_u32 v132, v48, v49
v_max3_u32 v132, v132, v50, v51
v_max3_u32 v132, v132, v52, v53
v_max3_u32 v132, v132, v54, v55
v_max3_u32 v132, v132, v56, v57
v_max3_u32 v132, v132, v58, v59
v_max3_u32 v132, v132, v60, v61
v_max3_u32 v132, v132, v62, v63
v_max3_u32 v132, v132, v64, v65
v_max3_u32 v132, v132, v66, v67
v_max3_u32 v132, v132, v68, v69
v_max3_u32 v132, v132, v70, v71
v_max3_u32 v132, v132, v100, v101
v_max3_u32 v132, v132, v102, v103
v_max3_u32 v132, v132, v104, v105
v_max3_u32 v132, v132, v106, v107
v_max3_u32 v132, v132, v124, v125
v_max3_u32 v132, v132, v126, v127
v_cmp_eq_u32 vcc, -1, v132
s_cbranch_vccz L_kvback1
s_add_u32 s88, s88, 1
s_cmp_gt_u32 s88, 0x80000
s_cbranch_scc1 L_kvback1
s_sleep 4
buffer_load_dwordx4 v[48:51], v1, s[4:7], s98 offen offset:0 sc1
buffer_load_dwordx4 v[124:127], v248, s[4:7], s100 offen sc1
buffer_load_dwordx4 v[52:55], v1, s[4:7], s98 offen offset:1024 sc1
buffer_load_dwordx4 v[56:59], v1, s[4:7], s98 offen offset:2048 sc1
buffer_load_dwordx4 v[60:63], v1, s[4:7], s98 offen offset:3072 sc1
buffer_load_dwordx4 v[64:67], v1, s[4:7], s99 offen offset:0 sc1
buffer_load_dwordx4 v[68:71], v1, s[4:7], s99 offen offset:1024 sc1
buffer_load_dwordx4 v[100:103], v1, s[4:7], s99 offen offset:2048 sc1
buffer_load_dwordx4 v[104:107], v1, s[4:7], s99 offen offset:3072 sc1
s_waitcnt vmcnt(8)
v_lshlrev_b32 v92, 16, v48
v_and_b32 v93, 0xffff0000, v48
v_lshlrev_b32 v94, 16, v49
v_and_b32 v95, 0xffff0000, v49
v_lshlrev_b32 v96, 16, v50
v_and_b32 v97, 0xffff0000, v50
v_lshlrev_b32 v98, 16, v51
v_and_b32 v99, 0xffff0000, v51
s_waitcnt vmcnt(7)
v_add_f32_dpp v128, v124, v124 row_ror:4 row_mask:0xf bank_mask:0xf
v_add_f32_dpp v129, v125, v125 row_ror:4 row_mask:0xf bank_mask:0xf
v_add_f32_dpp v130, v126, v126 row_ror:4 row_mask:0xf bank_mask:0xf
v_add_f32_dpp v131, v127, v127 row_ror:4 row_mask:0xf bank_mask:0xf
v_add_f32_dpp v128, v128, v128 row_ror:2 row_mask:0xf bank_mask:0xf
v_add_f32_dpp v129, v129, v129 row_ror:2 row_mask:0xf bank_mask:0xf
v_add_f32_dpp v130, v130, v130 row_ror:2 row_mask:0xf bank_mask:0xf
v_add_f32_dpp v131, v131, v131 row_ror:2 row_mask:0xf bank_mask:0xf
v_add_f32_dpp v128, v128, v128 row_ror:1 row_mask:0xf bank_mask:0xf
v_add_f32_dpp v129, v129, v129 row_ror:1 row_mask:0xf bank_mask:0xf
v_add_f32_dpp v130, v130, v130 row_ror:1 row_mask:0xf bank_mask:0xf
v_add_f32_dpp v131, v131, v131 row_ror:1 row_mask:0xf bank_mask:0xf
s_waitcnt vmcnt(6)
v_dot2c_f32_bf16 v92, v52, v249
v_dot2c_f32_bf16 v93, v52, v250
v_dot2c_f32_bf16 v94, v53, v249
v_dot2c_f32_bf16 v95, v53, v250
v_dot2c_f32_bf16 v96, v54, v249
v_dot2c_f32_bf16 v97, v54, v250
v_dot2c_f32_bf16 v98, v55, v249
v_dot2c_f32_bf16 v99, v55, v250
s_waitcnt vmcnt(5)
v_dot2c_f32_bf16 v92, v56, v249
v_dot2c_f32_bf16 v93, v56, v250
v_dot2c_f32_bf16 v94, v57, v249
v_dot2c_f32_bf16 v95, v57, v250
v_dot2c_f32_bf16 v96, v58, v249
v_dot2c_f32_bf16 v97, v58, v250
v_dot2c_f32_bf16 v98, v59, v249
v_dot2c_f32_bf16 v99, v59, v250
s_waitcnt vmcnt(4)
v_dot2c_f32_bf16 v92, v60, v249
v_dot2c_f32_bf16 v93, v60, v250
v_dot2c_f32_bf16 v94, v61, v249
v_dot2c_f32_bf16 v95, v61, v250
v_dot2c_f32_bf16 v96, v62, v249
v_dot2c_f32_bf16 v97, v62, v250
v_dot2c_f32_bf16 v98, v63, v249
v_dot2c_f32_bf16 v99, v63, v250
s_waitcnt vmcnt(3)
v_dot2c_f32_bf16 v92, v64, v249
v_dot2c_f32_bf16 v93, v64, v250
v_dot2c_f32_bf16 v94, v65, v249
v_dot2c_f32_bf16 v95, v65, v250
v_dot2c_f32_bf16 v96, v66, v249
v_dot2c_f32_bf16 v97, v66, v250
v_dot2c_f32_bf16 v98, v67, v249
v_dot2c_f32_bf16 v99, v67, v250
s_waitcnt vmcnt(2)
v_dot2c_f32_bf16 v92, v68, v249
v_dot2c_f32_bf16 v93, v68, v250
v_dot2c_f32_bf16 v94, v69, v249
v_dot2c_f32_bf16 v95, v69, v250
v_dot2c_f32_bf16 v96, v70, v249
v_dot2c_f32_bf16 v97, v70, v250
v_dot2c_f32_bf16 v98, v71, v249
v_dot2c_f32_bf16 v99, v71, v250
s_waitcnt vmcnt(1)
v_dot2c_f32_bf16 v92, v100, v249
v_dot2c_f32_bf16 v93, v100, v250
v_dot2c_f32_bf16 v94, v101, v249
v_dot2c_f32_bf16 v95, v101, v250
v_dot2c_f32_bf16 v96, v102, v249
v_dot2c_f32_bf16 v97, v102, v250
v_dot2c_f32_bf16 v98, v103, v249
v_dot2c_f32_bf16 v99, v103, v250
s_waitcnt vmcnt(0)
v_dot2c_f32_bf16 v92, v104, v249
v_dot2c_f32_bf16 v93, v104, v250
v_dot2c_f32_bf16 v94, v105, v249
v_dot2c_f32_bf16 v95, v105, v250
v_dot2c_f32_bf16 v96, v106, v249
v_dot2c_f32_bf16 v97, v106, v250
v_dot2c_f32_bf16 v98, v107, v249
v_dot2c_f32_bf16 v99, v107, v250
s_nop 2
s_branch L_kvredo1b
L_k2redo1:
s_mov_b32 s95, 0
s_mov_b32 s92, 0x40000000
s_mov_b32 s93, 0x40000000
s_mov_b32 s94, 0x40000000
s_add_u32 s36, s11, 0x10000
s_mov_b32 s37, 0
Lpoll_51:
v_mov_b32 v11, 0
buffer_atomic_add v11, v251, s[4:7], s36 offen sc0 sc1
s_add_u32 s37, s37, 1
s_waitcnt vmcnt(0)
v_readfirstlane_b32 s38, v11
s_nop 0
s_cmp_ge_u32 s38, 32
s_cbranch_scc1 Lpe_52
s_cmp_lt_u32 s37, 0x100000
s_cbranch_scc1 Lpoll_51
Lpe_52:
s_nop 7
s_mov_b32 s35, 0
v_lshlrev_b32 v132, 16, v32
v_and_b32 v133, 0xffff0000, v32
v_lshlrev_b32 v134, 16, v33
v_and_b32 v135, 0xffff0000, v33
v_lshlrev_b32 v136, 16, v34
v_and_b32 v137, 0xffff0000, v34
v_lshlrev_b32 v138, 16, v35
v_and_b32 v139, 0xffff0000, v35
v_lshlrev_b32 v140, 16, v36
v_and_b32 v141, 0xffff0000, v36
v_lshlrev_b32 v142, 16, v37
v_and_b32 v143, 0xffff0000, v37
v_lshlrev_b32 v144, 16, v38
v_and_b32 v145, 0xffff0000, v38
v_lshlrev_b32 v146, 16, v39
v_and_b32 v147, 0xffff0000, v39
v_lshlrev_b32 v148, 16, v40
v_and_b32 v149, 0xffff0000, v40
v_lshlrev_b32 v150, 16, v41
v_and_b32 v151, 0xffff0000, v41
v_lshlrev_b32 v152, 16, v42
v_and_b32 v153, 0xffff0000, v42
v_lshlrev_b32 v154, 16, v43
v_and_b32 v155, 0xffff0000, v43
v_lshlrev_b32 v156, 16, v44
v_and_b32 v157, 0xffff0000, v44
v_lshlrev_b32 v158, 16, v45
v_and_b32 v159, 0xffff0000, v45
v_lshlrev_b32 v160, 16, v46
v_and_b32 v161, 0xffff0000, v46
v_lshlrev_b32 v162, 16, v47
v_and_b32 v163, 0xffff0000, v47
s_branch L_k2go1
L_hxredo2:
s_mov_b32 s37, 0
L_hxredo2b:
s_sleep 2
buffer_load_dwordx4 v[228:231], v9, s[4:7], s55 offen sc1
buffer_load_dwordx4 v[72:75], v9, s[4:7], s55 offen offset:1024 sc1
s_waitcnt vmcnt(1)
v_max3_u32 v244, v228, v229, v230
s_waitcnt vmcnt(0)
v_max3_u32 v244, v244, v231, v72
v_max3_u32 v244, v244, v73, v74
v_max_u32 v244, v244, v75
v_cmp_eq_u32 vcc, -1, v244
s_cbranch_vccz L_hxback2
s_add_u32 s37, s37, 1
s_cmp_lt_u32 s37, 0x100000
s_cbranch_scc1 L_hxredo2b
s_branch L_hxback2
L_k2redo2:
s_mov_b32 s95, 0
s_mov_b32 s92, 0x40000000
s_mov_b32 s93, 0x40000000
s_mov_b32 s94, 0x40000000
s_add_u32 s36, s11, 0x20000
s_mov_b32 s37, 0
Lpoll_53:
v_mov_b32 v11, 0
buffer_atomic_add v11, v251, s[4:7], s36 offen sc0 sc1
s_add_u32 s37, s37, 1
s_waitcnt vmcnt(0)
v_readfirstlane_b32 s38, v11
s_nop 0
s_cmp_ge_u32 s38, 32
s_cbranch_scc1 Lpe_54
s_cmp_lt_u32 s37, 0x100000
s_cbranch_scc1 Lpoll_53
Lpe_54:
s_nop 7
s_mov_b32 s35, 0
v_lshlrev_b32 v132, 16, v32
v_and_b32 v133, 0xffff0000, v32
v_lshlrev_b32 v134, 16, v33
v_and_b32 v135, 0xffff0000, v33
v_lshlrev_b32 v136, 16, v34
v_and_b32 v137, 0xffff0000, v34
v_lshlrev_b32 v138, 16, v35
v_and_b32 v139, 0xffff0000, v35
v_lshlrev_b32 v140, 16, v36
v_and_b32 v141, 0xffff0000, v36
v_lshlrev_b32 v142, 16, v37
v_and_b32 v143, 0xffff0000, v37
v_lshlrev_b32 v144, 16, v38
v_and_b32 v145, 0xffff0000, v38
v_lshlrev_b32 v146, 16, v39
v_and_b32 v147, 0xffff0000, v39
v_lshlrev_b32 v148, 16, v40
v_and_b32 v149, 0xffff0000, v40
v_lshlrev_b32 v150, 16, v41
v_and_b32 v151, 0xffff0000, v41
v_lshlrev_b32 v152, 16, v42
v_and_b32 v153, 0xffff0000, v42
v_lshlrev_b32 v154, 16, v43
v_and_b32 v155, 0xffff0000, v43
v_lshlrev_b32 v156, 16, v44
v_and_b32 v157, 0xffff0000, v44
v_lshlrev_b32 v158, 16, v45
v_and_b32 v159, 0xffff0000, v45
v_lshlrev_b32 v160, 16, v46
v_and_b32 v161, 0xffff0000, v46
v_lshlrev_b32 v162, 16, v47
v_and_b32 v163, 0xffff0000, v47
s_branch L_k2go2
L_kvredo3:
s_mov_b32 s88, 0
L_kvredo3b:
v_max_u32 v132, v48, v49
v_max3_u32 v132, v132, v50, v51
v_max3_u32 v132, v132, v52, v53
v_max3_u32 v132, v132, v54, v55
v_max3_u32 v132, v132, v56, v57
v_max3_u32 v132, v132, v58, v59
v_max3_u32 v132, v132, v60, v61
v_max3_u32 v132, v132, v62, v63
v_max3_u32 v132, v132, v64, v65
v_max3_u32 v132, v132, v66, v67
v_max3_u32 v132, v132, v68, v69
v_max3_u32 v132, v132, v70, v71
v_max3_u32 v132, v132, v100, v101
v_max3_u32 v132, v132, v102, v103
v_max3_u32 v132, v132, v104, v105
v_max3_u32 v132, v132, v106, v107
v_max3_u32 v132, v132, v124, v125
v_max3_u32 v132, v132, v126, v127
v_cmp_eq_u32 vcc, -1, v132
s_cbranch_vccz L_kvback3
s_add_u32 s88, s88, 1
s_cmp_gt_u32 s88, 0x80000
s_cbranch_scc1 L_kvback3
s_sleep 4
buffer_load_dwordx4 v[48:51], v1, s[4:7], s98 offen offset:0 sc1
buffer_load_dwordx4 v[124:127], v248, s[4:7], s100 offen sc1
buffer_load_dwordx4 v[52:55], v1, s[4:7], s98 offen offset:1024 sc1
buffer_load_dwordx4 v[56:59], v1, s[4:7], s98 offen offset:2048 sc1
buffer_load_dwordx4 v[60:63], v1, s[4:7], s98 offen offset:3072 sc1
buffer_load_dwordx4 v[64:67], v1, s[4:7], s99 offen offset:0 sc1
buffer_load_dwordx4 v[68:71], v1, s[4:7], s99 offen offset:1024 sc1
buffer_load_dwordx4 v[100:103], v1, s[4:7], s99 offen offset:2048 sc1
buffer_load_dwordx4 v[104:107], v1, s[4:7], s99 offen offset:3072 sc1
s_waitcnt vmcnt(8)
v_lshlrev_b32 v92, 16, v48
v_and_b32 v93, 0xffff0000, v48
v_lshlrev_b32 v94, 16, v49
v_and_b32 v95, 0xffff0000, v49
v_lshlrev_b32 v96, 16, v50
v_and_b32 v97, 0xffff0000, v50
v_lshlrev_b32 v98, 16, v51
v_and_b32 v99, 0xffff0000, v51
s_waitcnt vmcnt(7)
v_add_f32_dpp v128, v124, v124 row_ror:4 row_mask:0xf bank_mask:0xf
v_add_f32_dpp v129, v125, v125 row_ror:4 row_mask:0xf bank_mask:0xf
v_add_f32_dpp v130, v126, v126 row_ror:4 row_mask:0xf bank_mask:0xf
v_add_f32_dpp v131, v127, v127 row_ror:4 row_mask:0xf bank_mask:0xf
v_add_f32_dpp v128, v128, v128 row_ror:2 row_mask:0xf bank_mask:0xf
v_add_f32_dpp v129, v129, v129 row_ror:2 row_mask:0xf bank_mask:0xf
v_add_f32_dpp v130, v130, v130 row_ror:2 row_mask:0xf bank_mask:0xf
v_add_f32_dpp v131, v131, v131 row_ror:2 row_mask:0xf bank_mask:0xf
v_add_f32_dpp v128, v128, v128 row_ror:1 row_mask:0xf bank_mask:0xf
v_add_f32_dpp v129, v129, v129 row_ror:1 row_mask:0xf bank_mask:0xf
v_add_f32_dpp v130, v130, v130 row_ror:1 row_mask:0xf bank_mask:0xf
v_add_f32_dpp v131, v131, v131 row_ror:1 row_mask:0xf bank_mask:0xf
s_waitcnt vmcnt(6)
v_dot2c_f32_bf16 v92, v52, v249
v_dot2c_f32_bf16 v93, v52, v250
v_dot2c_f32_bf16 v94, v53, v249
v_dot2c_f32_bf16 v95, v53, v250
v_dot2c_f32_bf16 v96, v54, v249
v_dot2c_f32_bf16 v97, v54, v250
v_dot2c_f32_bf16 v98, v55, v249
v_dot2c_f32_bf16 v99, v55, v250
s_waitcnt vmcnt(5)
v_dot2c_f32_bf16 v92, v56, v249
v_dot2c_f32_bf16 v93, v56, v250
v_dot2c_f32_bf16 v94, v57, v249
v_dot2c_f32_bf16 v95, v57, v250
v_dot2c_f32_bf16 v96, v58, v249
v_dot2c_f32_bf16 v97, v58, v250
v_dot2c_f32_bf16 v98, v59, v249
v_dot2c_f32_bf16 v99, v59, v250
s_waitcnt vmcnt(4)
v_dot2c_f32_bf16 v92, v60, v249
v_dot2c_f32_bf16 v93, v60, v250
v_dot2c_f32_bf16 v94, v61, v249
v_dot2c_f32_bf16 v95, v61, v250
v_dot2c_f32_bf16 v96, v62, v249
v_dot2c_f32_bf16 v97, v62, v250
v_dot2c_f32_bf16 v98, v63, v249
v_dot2c_f32_bf16 v99, v63, v250
s_waitcnt vmcnt(3)
v_dot2c_f32_bf16 v92, v64, v249
v_dot2c_f32_bf16 v93, v64, v250
v_dot2c_f32_bf16 v94, v65, v249
v_dot2c_f32_bf16 v95, v65, v250
v_dot2c_f32_bf16 v96, v66, v249
v_dot2c_f32_bf16 v97, v66, v250
v_dot2c_f32_bf16 v98, v67, v249
v_dot2c_f32_bf16 v99, v67, v250
s_waitcnt vmcnt(2)
v_dot2c_f32_bf16 v92, v68, v249
v_dot2c_f32_bf16 v93, v68, v250
v_dot2c_f32_bf16 v94, v69, v249
v_dot2c_f32_bf16 v95, v69, v250
v_dot2c_f32_bf16 v96, v70, v249
v_dot2c_f32_bf16 v97, v70, v250
v_dot2c_f32_bf16 v98, v71, v249
v_dot2c_f32_bf16 v99, v71, v250
s_waitcnt vmcnt(1)
v_dot2c_f32_bf16 v92, v100, v249
v_dot2c_f32_bf16 v93, v100, v250
v_dot2c_f32_bf16 v94, v101, v249
v_dot2c_f32_bf16 v95, v101, v250
v_dot2c_f32_bf16 v96, v102, v249
v_dot2c_f32_bf16 v97, v102, v250
v_dot2c_f32_bf16 v98, v103, v249
v_dot2c_f32_bf16 v99, v103, v250
s_waitcnt vmcnt(0)
v_dot2c_f32_bf16 v92, v104, v249
v_dot2c_f32_bf16 v93, v104, v250
v_dot2c_f32_bf16 v94, v105, v249
v_dot2c_f32_bf16 v95, v105, v250
v_dot2c_f32_bf16 v96, v106, v249
v_dot2c_f32_bf16 v97, v106, v250
v_dot2c_f32_bf16 v98, v107, v249
v_dot2c_f32_bf16 v99, v107, v250
s_nop 2
s_branch L_kvredo3b
L_k2redo3:
s_mov_b32 s95, 0
s_mov_b32 s92, 0x40000000
s_mov_b32 s93, 0x40000000
s_mov_b32 s94, 0x40000000
s_add_u32 s36, s11, 0x30000
s_mov_b32 s37, 0
Lpoll_55:
v_mov_b32 v11, 0
buffer_atomic_add v11, v251, s[4:7], s36 offen sc0 sc1
s_add_u32 s37, s37, 1
s_waitcnt vmcnt(0)
v_readfirstlane_b32 s38, v11
s_nop 0
s_cmp_ge_u32 s38, 32
s_cbranch_scc1 Lpe_56
s_cmp_lt_u32 s37, 0x100000
s_cbranch_scc1 Lpoll_55
Lpe_56:
s_nop 7
s_mov_b32 s35, 0
v_lshlrev_b32 v132, 16, v32
v_and_b32 v133, 0xffff0000, v32
v_lshlrev_b32 v134, 16, v33
v_and_b32 v135, 0xffff0000, v33
v_lshlrev_b32 v136, 16, v34
v_and_b32 v137, 0xffff0000, v34
v_lshlrev_b32 v138, 16, v35
v_and_b32 v139, 0xffff0000, v35
v_lshlrev_b32 v140, 16, v36
v_and_b32 v141, 0xffff0000, v36
v_lshlrev_b32 v142, 16, v37
v_and_b32 v143, 0xffff0000, v37
v_lshlrev_b32 v144, 16, v38
v_and_b32 v145, 0xffff0000, v38
v_lshlrev_b32 v146, 16, v39
v_and_b32 v147, 0xffff0000, v39
v_lshlrev_b32 v148, 16, v40
v_and_b32 v149, 0xffff0000, v40
v_lshlrev_b32 v150, 16, v41
v_and_b32 v151, 0xffff0000, v41
v_lshlrev_b32 v152, 16, v42
v_and_b32 v153, 0xffff0000, v42
v_lshlrev_b32 v154, 16, v43
v_and_b32 v155, 0xffff0000, v43
v_lshlrev_b32 v156, 16, v44
v_and_b32 v157, 0xffff0000, v44
v_lshlrev_b32 v158, 16, v45
v_and_b32 v159, 0xffff0000, v45
v_lshlrev_b32 v160, 16, v46
v_and_b32 v161, 0xffff0000, v46
v_lshlrev_b32 v162, 16, v47
v_and_b32 v163, 0xffff0000, v47
s_branch L_k2go3
L_code_end:
.section .rodata,"a"
.p2align 6
.amdhsa_kernel interleave_layers__sliding_local_dilated__linear_kernel_hedgehog__prompt_kernel
  .amdhsa_next_free_vgpr 512
  .amdhsa_next_free_sgpr 102
  .amdhsa_accum_offset 256
  .amdhsa_group_segment_fixed_size 0
  .amdhsa_kernarg_size 80
  .amdhsa_user_sgpr_count 2
  .amdhsa_user_sgpr_kernarg_segment_ptr 1
  .amdhsa_system_sgpr_workgroup_id_x 1
.end_amdhsa_kernel
```

```asm
; @launch grid=(256,1,1) block=(256,1,1) lds=163840
.amdgcn_target "amdgcn-amd-amdhsa--gfx950"
.text
.globl interleave_layers__sliding_local_dilated__linear_kernel_hedgehog__prompt_kernel
.p2align 8
.type interleave_layers__sliding_local_dilated__linear_kernel_hedgehog__prompt_kernel,@function
interleave_layers__sliding_local_dilated__linear_kernel_hedgehog__prompt_kernel:
s_cmp_ge_u32 s2, 256
s_cbranch_scc1 L_end
s_load_dwordx16 s[64:79], s[0:1], 0
s_load_dwordx4 s[80:83], s[0:1], 64
s_getpc_b64 s[24:25]
s_mov_b32 s26, (L_end - interleave_layers__sliding_local_dilated__linear_kernel_hedgehog__prompt_kernel - 64)
s_mov_b32 s27, 0x20000
v_lshlrev_b32 v1, 5, v0
buffer_load_dword v238, v1, s[24:27], 0 offen
v_lshrrev_b32 v1, 6, v0
v_and_b32 v0, 63, v0
v_readfirstlane_b32 s28, v1
s_and_b32 s36, s2, 7
s_lshr_b32 s37, s2, 3
s_and_b32 s38, s37, 3
s_lshr_b32 s39, s37, 2
s_and_b32 s29, s36, 1
s_lshl_b32 s32, s29, 3
s_lshl_b32 s29, s29, 2
s_add_u32 s29, s29, s38
s_add_u32 s32, s32, s39
s_lshr_b32 s36, s36, 1
s_lshl_b32 s30, s36, 3
s_add_u32 s30, s30, s39
s_lshl_b32 s31, s36, 2
s_add_u32 s31, s31, s38
s_and_b32 s32, s36, 1
s_lshl_b32 s32, s32, 3
s_add_u32 s32, s32, s39
s_and_b32 s31, s2, 1
s_lshl_b32 s31, s31, 3
s_add_u32 s31, s31, s38
s_and_b32 s3, s2, 4
s_add_u32 s31, s31, s3
s_and_b32 s29, s2, 4
s_lshl_b32 s31, s29, 1
s_add_u32 s29, s29, s38
s_and_b32 s30, s2, 3
s_lshl_b32 s30, s30, 3
s_add_u32 s30, s30, s39
s_and_b32 s3, s2, 2
s_lshl_b32 s3, s3, 1
s_add_u32 s31, s31, s3
s_add_u32 s31, s31, s38
s_and_b32 s32, s2, 1
s_lshl_b32 s32, s32, 3
s_add_u32 s32, s32, s39
s_mov_b32 s3, s39
s_and_b32 s35, s2, 7
s_lshl_b32 s35, s35, 5
s_add_u32 s35, s35, s37
s_mul_i32 s33, s39, 0
s_and_b32 s33, s33, 31
v_lshlrev_b32 v1, 4, v0
v_lshrrev_b32 v233, 4, v0
v_and_b32 v234, 15, v0
s_and_b32 s88, s31, 7
s_lshl_b32 s88, s88, 7
s_lshl_b32 s37, s28, 5
s_add_u32 s88, s88, s37
s_lshl_b32 s88, s88, 1
s_lshr_b32 s37, s31, 3
s_add_u32 s88, s88, s37
s_lshl_b32 s88, s88, 11
s_lshl_b32 s37, s32, 7
s_add_u32 s88, s88, s37
v_lshrrev_b32 v235, 3, v0
v_and_b32 v236, 7, v0
v_xor_b32 v232, v236, v233
v_lshlrev_b32 v232, 4, v232
v_lshl_add_u32 v232, v235, 12, v232
v_xor_b32 v246, 64, v232
v_lshlrev_b32 v236, 4, v236
v_lshl_add_u32 v237, v235, 11, v236
v_mul_u32_u24 v235, 6144, v235
v_add_u32 v235, v235, v236
s_lshr_b32 s36, s35, 4
s_lshl_b32 s36, s36, 2
s_add_u32 s36, s36, s28
s_mul_i32 s36, s36, 98304
s_and_b32 s37, s35, 15
s_lshl_b32 s37, s37, 7
s_add_u32 s36, s36, s37
s_lshl_b32 s37, s28, 11
s_mov_b32 s39, 0x10000
s_mov_b32 s10, 0x400000
s_mov_b32 s11, 0x20000
s_mov_b32 s22, 0x600000
s_mov_b32 s23, 0x20000
s_mov_b32 s6, 0x10000000
s_mov_b32 s7, 0x20000
s_mov_b32 s44, 0xf0000
s_waitcnt lgkmcnt(0)
s_mov_b64 s[8:9], s[64:65]
s_mov_b64 s[20:21], s[66:67]
s_lshl_b32 s39, s37, 1
s_add_u32 m0, s37, 0
s_add_u32 s38, s36, 0
buffer_load_dwordx4 v235, s[20:23], s38 offen nt lds
s_add_u32 m0, s37, 1024
s_add_u32 s38, s36, 49152
buffer_load_dwordx4 v235, s[20:23], s38 offen nt lds
s_add_u32 m0, s37, 8192
s_add_u32 s38, s36, 2048
buffer_load_dwordx4 v235, s[20:23], s38 offen nt lds
s_add_u32 m0, s37, 9216
s_add_u32 s38, s36, 51200
buffer_load_dwordx4 v235, s[20:23], s38 offen nt lds
s_add_u32 m0, s37, 16384
s_add_u32 s38, s36, 4096
buffer_load_dwordx4 v235, s[20:23], s38 offen nt lds
s_add_u32 m0, s37, 17408
s_add_u32 s38, s36, 53248
buffer_load_dwordx4 v235, s[20:23], s38 offen nt lds
s_add_u32 m0, s39, 24576
s_add_u32 s38, s88, 0
buffer_load_dwordx4 v232, s[8:11], s38 offen nt lds
s_add_u32 m0, s39, 25600
s_add_u32 s38, s88, 32768
buffer_load_dwordx4 v246, s[8:11], s38 offen nt lds
s_add_u32 m0, s39, 26624
s_add_u32 s38, s88, 65536
buffer_load_dwordx4 v232, s[8:11], s38 offen nt lds
s_add_u32 m0, s39, 27648
s_add_u32 s38, s88, 98304
buffer_load_dwordx4 v246, s[8:11], s38 offen nt lds
s_mov_b32 s37, s39
v_lshrrev_b32 v232, 1, v234
v_xor_b32 v232, v232, v233
v_lshlrev_b32 v232, 4, v232
v_lshl_add_u32 v232, v234, 7, v232
v_add_u32 v232, s37, v232
s_add_u32 s4, s82, 0x0
s_addc_u32 s5, s83, 0
s_mov_b64 s[92:93], s[80:81]
s_mov_b32 s12, s78
s_mov_b32 s13, s79
s_mov_b32 s14, 0x400000
s_mov_b32 s15, 0x20000
s_mov_b32 s42, 0x400000
s_mov_b32 s43, 0x20000
v_mov_b32 v12, 1
s_mov_b64 s[40:41], s[12:13]
s_mov_b32 s64, 0xff
s_mov_b32 s65, 0
s_and_b32 s81, s29, 3
s_lshl_b32 s66, s31, 4
s_add_u32 s66, s66, s32
s_lshl_b32 s66, s66, 8
s_lshl_b32 s67, s29, 5
s_add_u32 s67, s67, s30
s_lshl_b32 s67, s67, 8
s_lshl_b32 s80, s30, 11
s_lshl_b32 s70, s29, 8
s_add_u32 s70, s70, s80
s_lshl_b32 s71, s29, 13
s_lshr_b32 s78, s31, 1
s_lshl_b32 s78, s78, 13
s_add_u32 s79, s78, 8192
s_bitcmp1_b32 s31, 0
s_cselect_b32 s79, s79, 0x40000000
s_and_b32 s36, s31, 7
s_cmp_eq_u32 s36, 7
s_cselect_b32 s79, 0x40000000, s79
v_mov_b32 v240, 0
v_mov_b32 v241, 0
v_mov_b32 v242, 0
v_mov_b32 v243, 0
v_mov_b32 v228, v235
v_mov_b32 v229, v237
s_lshr_b32 s36, s35, 4
s_lshl_b32 s36, s36, 2
s_add_u32 s36, s36, s28
s_and_b32 s37, s35, 15
s_lshl_b32 s37, s37, 7
s_lshl_b32 s16, s36, 15
s_add_u32 s16, s16, s37
s_mul_i32 s17, s36, 98304
s_add_u32 s17, s17, s37
v_mov_b32 v16, 0x3f803f80
v_mov_b32 v17, 0x3f803f80
v_mov_b32 v18, 0x3f803f80
v_mov_b32 v19, 0x3f803f80
s_mov_b32 s46, 0xaaaaaaaa
s_mov_b32 s47, 0xaaaaaaaa
s_mov_b32 s48, 0xcccccccc
s_mov_b32 s49, 0xcccccccc
s_lshl_b32 s36, s31, 1
s_lshr_b32 s37, s28, 1
s_add_u32 s36, s36, s37
s_mul_i32 s36, s36, 131072
s_and_b32 s37, s28, 1
s_lshl_b32 s37, s37, 11
s_add_u32 s36, s36, s37
v_add_u32 v4, s36, v1
s_lshl_b32 s38, s31, 2
s_add_u32 s38, s38, s28
s_lshl_b32 s38, s38, 12
s_lshl_b32 s39, s32, 7
s_add_u32 s38, s38, s39
v_lshrrev_b32 v244, 2, v234
v_cmp_eq_u32 vcc, v244, v233
v_and_b32 v244, 7, v234
v_lshl_add_u32 v244, v244, 4, s38
v_and_b32 v245, 8, v234
v_add_u32 v244, v244, v245
v_cndmask_b32 v253, 2.0, v244, vcc
v_lshlrev_b32 v244, 4, v233
v_lshl_add_u32 v244, v234, 6, v244
v_cmp_gt_u32 vcc, 2, v234
s_nop 1
v_cndmask_b32 v254, 2.0, v244, vcc
v_lshrrev_b32 v248, 4, v0
v_lshlrev_b32 v248, 10, v248
v_bfe_u32 v249, v0, 2, 2
v_lshl_add_u32 v248, v249, 7, v248
v_and_b32 v251, 3, v0
v_lshl_add_u32 v248, v251, 3, v248
s_lshr_b32 s36, s28, 1
s_lshl_b32 s36, s36, 6
s_and_b32 s37, s28, 1
s_mul_i32 s38, s37, 8224
s_add_u32 s38, s38, s36
s_mul_i32 s39, s37, 16352
s_add_u32 s39, s39, s36
v_add_u32 v249, s39, v248
v_add_u32 v248, s38, v248
s_and_b32 s38, s35, 15
s_lshl_b32 s38, s38, 1
s_lshr_b32 s36, s28, 1
s_add_u32 s38, s38, s36
s_lshr_b32 s36, s35, 4
s_mul_i32 s96, s38, 196608
s_lshr_b32 s44, s36, 3
s_mul_i32 s44, s44, 98304
s_add_u32 s96, s96, s44
s_add_u32 s96, s96, 0x2000000
s_and_b32 s44, s36, 7
s_mul_i32 s97, s44, 12288
s_mul_i32 s44, s37, 3072
s_add_u32 s97, s97, s44
s_mul_i32 s38, s38, 6
s_mul_i32 s37, s37, 3
s_add_u32 s38, s38, s37
s_lshl_b32 s38, s38, 11
s_lshl_b32 s36, s36, 7
s_add_u32 s38, s38, s36
s_add_u32 s98, s38, 0x1800000
s_add_u32 s99, s98, 4096
v_lshrrev_b32 v247, 2, v0
v_lshlrev_b32 v250, 7, v247
v_lshl_add_u32 v250, v251, 4, v250
s_lshr_b32 s36, s28, 1
s_lshl_b32 s36, s36, 12
s_and_b32 s37, s28, 1
s_lshl_b32 s37, s37, 6
s_add_u32 s36, s36, s37
s_add_u32 s36, s36, 147456
v_add_u32 v250, s36, v250
v_subrev_u32 v230, 122880, v250
s_and_b32 s36, s35, 15
s_lshl_b32 s36, s36, 17
s_lshr_b32 s37, s35, 4
s_lshl_b32 s37, s37, 13
s_add_u32 s36, s36, s37
s_lshl_b32 s37, s28, 11
s_add_u32 s36, s36, s37
s_add_u32 s100, s36, 0x1a00000
s_add_u32 s101, s36, 0x1c00000
v_lshlrev_b32 v247, 6, v247
v_lshl_add_u32 v251, v251, 3, v247
v_add_u32 v251, 155648, v251
v_xor_b32 v236, 64, v232
s_mov_b64 s[20:21], s[68:69]
s_mov_b32 s22, 0x200000
s_lshl_b32 s37, s28, 11
s_add_u32 m0, s37, 147456
s_add_u32 s36, s16, 0
buffer_load_dwordx4 v229, s[20:23], s36 offen nt lds
s_add_u32 m0, s37, 148480
s_add_u32 s36, s16, 16384
buffer_load_dwordx4 v229, s[20:23], s36 offen nt lds
s_add_u32 s36, s67, 0xc0000
s_add_u32 s37, s66, 0xd0000
s_cmp_eq_u32 s28, 2
s_cselect_b32 s36, s37, s36
s_cmp_eq_u32 s28, 1
s_cselect_b32 s37, 128, 0
s_add_u32 s36, s36, s37
s_cmp_eq_u32 s28, 3
s_cselect_b32 s37, 0x20000, 0
s_add_u32 s36, s36, s37
s_mov_b64 exec, 1
buffer_atomic_add v240, off, s[4:7], s36 sc1
s_mov_b64 exec, -1
s_lshr_b32 s36, s2, 3
s_cmp_ge_u32 s36, 11
s_cselect_b32 s37, 11, 0
s_cselect_b32 s38, 8, 0
s_sub_u32 s51, s36, s37
s_and_b32 s37, s2, 7
s_add_u32 s37, s37, s38
s_lshl_b32 s37, s37, 8
s_lshl_b32 s34, s51, 21
s_add_u32 s34, s34, s37
s_add_u32 s34, s34, 0x1e0000
s_cmp_lt_u32 s36, 22
s_cselect_b32 s36, s28, 0
s_cmp_eq_u32 s36, 2
s_cselect_b32 s34, s34, 0x40000000
v_and_b32 v239, 2, v0
v_lshlrev_b32 v239, 12, v239
v_and_b32 v244, 1, v0
v_lshl_add_u32 v239, v244, 7, v239
s_mov_b64 exec, 15
buffer_atomic_add v240, v239, s[4:7], s34 offen sc1
s_mov_b64 exec, -1
s_mov_b32 s36, 0xf0000
buffer_load_dword v11, off, s[4:7], s36 sc1
s_lshr_b32 s36, s2, 3
s_lshl_b32 s36, s36, 2
s_add_u32 s36, s36, s28
s_lshl_b32 s36, s36, 10
buffer_load_dwordx4 a[0:3], v1, s[24:27], s36 offen
s_mov_b64 s[24:25], s[92:93]
s_mov_b32 s26, 256
s_mov_b64 s[20:21], s[74:75]
s_mov_b32 s22, 0x10000
s_and_b32 s36, s28, 1
s_lshl_b32 s36, s36, 10
s_add_u32 m0, s36, 155648
s_lshl_b32 s37, s30, 11
s_add_u32 s36, s36, s37
buffer_load_dwordx4 v1, s[20:23], s36 offen lds
s_waitcnt vmcnt(7)
ds_read_b128 v[32:35], v232 offset:24576
ds_read_b128 v[36:39], v236 offset:24576
ds_read_b128 v[40:43], v232 offset:26624
ds_read_b128 v[44:47], v236 offset:26624
s_barrier
ds_read_b64_tr_b16 a[188:189], v248 offset:0
ds_read_b64_tr_b16 a[190:191], v248 offset:512
ds_read_b64_tr_b16 a[192:193], v248 offset:4096
ds_read_b64_tr_b16 a[194:195], v248 offset:4608
ds_read_b64_tr_b16 a[196:197], v249 offset:32
ds_read_b64_tr_b16 a[198:199], v249 offset:544
ds_read_b64_tr_b16 a[200:201], v249 offset:4128
ds_read_b64_tr_b16 a[202:203], v249 offset:4640
ds_read_b64_tr_b16 a[204:205], v248 offset:8192
ds_read_b64_tr_b16 a[206:207], v248 offset:8704
ds_read_b64_tr_b16 a[208:209], v248 offset:12288
ds_read_b64_tr_b16 a[210:211], v248 offset:12800
s_lshl_b32 s36, s32, 13
s_add_u32 s37, s36, 4096
s_mov_b32 s38, 0x1700000
s_waitcnt lgkmcnt(14)
v_mfma_f32_16x16x32_bf16 v[96:99], v[32:35], v[32:35], 0
v_mfma_f32_16x16x32_bf16 v[92:95], v[16:19], v[32:35], 0
buffer_store_dwordx4 v[32:35], v4, s[12:15], s36 offen offset:0 sc1
s_waitcnt lgkmcnt(13)
v_mfma_f32_16x16x32_bf16 v[104:107], v[40:43], v[40:43], 0
v_mfma_f32_16x16x32_bf16 v[100:103], v[16:19], v[40:43], 0
buffer_store_dwordx4 v[40:43], v4, s[12:15], s36 offen offset:1024 sc1
v_mfma_f32_16x16x32_bf16 v[96:99], v[36:39], v[36:39], v[96:99]
v_mfma_f32_16x16x32_bf16 v[92:95], v[16:19], v[36:39], v[92:95]
buffer_store_dwordx4 v[36:39], v4, s[12:15], s37 offen offset:0 sc1
s_waitcnt lgkmcnt(12)
v_mfma_f32_16x16x32_bf16 v[104:107], v[44:47], v[44:47], v[104:107]
v_mfma_f32_16x16x32_bf16 v[100:103], v[16:19], v[44:47], v[100:103]
buffer_store_dwordx4 v[44:47], v4, s[12:15], s37 offen offset:1024 sc1
s_nop 1
v_cndmask_b32 v96, v96, v97, s[46:47]
v_cndmask_b32 v98, v98, v99, s[46:47]
v_cndmask_b32 v93, v96, v98, s[48:49]
buffer_store_dwordx2 v[92:93], v253, s[4:7], s38 offen offset:0 sc1
v_cndmask_b32 v104, v104, v105, s[46:47]
v_cndmask_b32 v106, v106, v107, s[46:47]
v_cndmask_b32 v101, v104, v106, s[48:49]
buffer_store_dwordx2 v[100:101], v253, s[4:7], s38 offen offset:2048 sc1
s_waitcnt lgkmcnt(10)
v_mfma_f32_16x16x32_bf16 v[108:111], a[188:191], v[16:19], 0
s_waitcnt lgkmcnt(6)
v_mfma_f32_16x16x32_bf16 v[112:115], a[196:199], v[16:19], 0
s_waitcnt lgkmcnt(2)
v_mfma_f32_16x16x32_bf16 v[116:119], a[204:207], v[16:19], 0
v_mfma_f32_16x16x32_bf16 v[108:111], a[192:195], v[16:19], v[108:111]
v_mfma_f32_16x16x32_bf16 v[112:115], a[200:203], v[16:19], v[112:115]
s_waitcnt lgkmcnt(0)
v_mfma_f32_16x16x32_bf16 v[116:119], a[208:211], v[16:19], v[116:119]
s_add_u32 s36, s97, 0
s_add_u32 s36, s36, s96
buffer_store_dwordx4 a[188:191], v1, s[4:7], s36 offen sc1
s_add_u32 s36, s97, 6144
s_add_u32 s36, s36, s96
buffer_store_dwordx4 a[192:195], v1, s[4:7], s36 offen sc1
s_add_u32 s36, s97, 1024
s_add_u32 s36, s36, s96
buffer_store_dwordx4 a[196:199], v1, s[4:7], s36 offen sc1
s_add_u32 s36, s97, 7168
s_add_u32 s36, s36, s96
buffer_store_dwordx4 a[200:203], v1, s[4:7], s36 offen sc1
s_add_u32 s36, s97, 2048
s_add_u32 s36, s36, s96
buffer_store_dwordx4 a[204:207], v1, s[4:7], s36 offen sc1
s_add_u32 s36, s97, 8192
s_add_u32 s36, s36, s96
buffer_store_dwordx4 a[208:211], v1, s[4:7], s36 offen sc1
buffer_store_dwordx4 v[108:111], v254, s[4:7], s98 offen offset:0 sc1
buffer_store_dwordx4 v[112:115], v254, s[4:7], s98 offen offset:2048 sc1
buffer_store_dwordx4 v[116:119], v254, s[4:7], s99 offen offset:0 sc1
v_lshlrev_b32 v239, 16, v233
v_lshl_add_u32 v239, v234, 4, v239
s_cmp_eq_u32 s28, 0
s_cselect_b32 s36, s66, s67
s_cmp_eq_u32 s28, 2
s_cselect_b32 s36, s70, s36
s_lshl_b32 s37, s28, 18
s_add_u32 s36, s36, s37
s_cmp_eq_u32 s28, 3
s_cselect_b32 s36, 0x40000000, s36
buffer_store_dwordx4 v[240:243], v239, s[4:7], s36 offen sc1
s_add_u32 s36, s36, 0x102000
buffer_store_dwordx4 v[240:243], v239, s[4:7], s36 offen sc1
s_waitcnt vmcnt(22)
s_barrier
ds_read_b64_tr_b16 a[212:213], v250 offset:0
ds_read_b64_tr_b16 a[214:215], v250 offset:2048
ds_read_b64_tr_b16 a[216:217], v250 offset:8
ds_read_b64_tr_b16 a[218:219], v250 offset:2056
s_waitcnt lgkmcnt(2)
buffer_store_dwordx4 a[212:215], v1, s[4:7], s100 offen offset:0 sc1
s_waitcnt lgkmcnt(0)
buffer_store_dwordx4 a[216:219], v1, s[4:7], s100 offen offset:1024 sc1
s_mov_b32 s56, 0x11111111
s_mov_b32 s57, 0x11111111
s_mov_b32 s58, 0x22222222
s_mov_b32 s59, 0x22222222
s_lshl_b32 s18, s28, 11
s_lshl_b32 s19, s28, 12
s_mul_i32 s50, s30, 196608
s_add_u32 s50, s50, s18
s_lshl_b32 s36, s32, 17
s_add_u32 s36, s36, s19
s_add_u32 s37, s28, 0
s_cmp_eq_u32 s37, s3
s_cselect_b32 s37, 0, 0
s_add_u32 s84, s36, s37
s_mul_i32 s37, s37, 3
s_sub_u32 s86, s36, s37
s_add_u32 s37, s28, 4
s_cmp_eq_u32 s37, s3
s_cselect_b32 s37, 0, 0
s_add_u32 s85, s36, s37
s_mul_i32 s37, s37, 3
s_sub_u32 s87, s36, s37
s_mul_i32 s55, s28, 6144
v_accvgpr_write_b32 a248, -1
v_accvgpr_write_b32 a249, -1
v_accvgpr_write_b32 a250, -1
v_accvgpr_write_b32 a251, -1
s_lshl_b32 s36, s29, 2
s_add_u32 s36, s36, s28
s_mul_i32 s37, s36, 131072
v_add_u32 v2, s37, v1
s_lshl_b32 s82, s36, 13
s_and_b32 s38, s29, 3
s_cmp_eq_u32 s38, 0
s_cselect_b32 s38, 0, 0x1f400
s_cselect_b32 s39, 0, 2048
s_cselect_b32 s54, 32, 48
s_lshl_b32 s37, s29, 19
s_sub_u32 s37, s37, s38
v_add_u32 v3, s37, v1
v_cmp_le_u32 vcc, 8, v234
s_nop 1
v_cndmask_b32 v3, 2.0, v3, vcc
s_lshl_b32 s37, s29, 15
s_sub_u32 s83, s37, s39
s_cmp_eq_u32 s28, 0
s_cselect_b32 vcc_lo, -1, 0
s_mov_b32 vcc_hi, 0
v_lshlrev_b32 v244, 8, v0
v_cndmask_b32 v10, 2.0, v244, vcc
v_and_b32 v244, 1, v233
v_lshl_add_u32 v244, v244, 3, v234
v_and_b32 v244, 15, v244
v_lshrrev_b32 v245, 1, v233
v_lshl_add_u32 v244, v245, 4, v244
v_lshrrev_b32 v245, 3, v234
v_lshl_add_u32 v244, v245, 5, v244
v_lshlrev_b32 v7, 3, v244
v_lshrrev_b32 v246, 2, v0
v_and_b32 v247, 3, v0
v_and_b32 v244, 1, v247
v_lshl_add_u32 v244, v244, 3, v246
v_and_b32 v244, 15, v244
v_lshrrev_b32 v245, 1, v247
v_lshl_add_u32 v244, v245, 4, v244
v_lshrrev_b32 v245, 3, v246
v_lshl_add_u32 v244, v245, 5, v244
v_lshlrev_b32 v8, 3, v244
s_and_b32 s36, s28, 1
s_lshl_b32 s37, s36, 3
s_add_u32 s37, s37, 20480
s_lshl_b32 s36, s36, 9
v_add_u32 v244, s37, v1
v_add_u32 v245, s36, v7
s_cmp_lt_u32 s28, 2
s_cselect_b64 vcc, -1, 0
v_cndmask_b32 v9, v245, v244, vcc
s_cmp_eq_u32 s28, 3
s_cselect_b64 vcc, -1, 0
v_cndmask_b32 v3, 2.0, v1, vcc
s_lshl_b32 s83, s67, 3
s_cmp_eq_u32 s54, 32
s_cselect_b32 s36, 1, s28
s_cmp_eq_u32 s36, 0
s_cselect_b64 vcc, -1, 0
v_cndmask_b32 v9, 2.0, v1, vcc
v_lshlrev_b32 v239, 2, v233
v_sub_u32 v239, v239, v234
v_mov_b32 v247, 0xf149f2ca
v_add_u32 v246, 7, v239
v_cmp_gt_u32 vcc, 8, v246
v_mov_b32 v244, 0xffff
s_nop 0
v_cndmask_b32 v24, v247, 0, vcc
v_cndmask_b32 v244, 0, v244, vcc
v_mov_b32 v30, v244
v_add_u32 v246, 0, v239
v_cmp_le_i32 vcc, 9, v246
v_mov_b32 v244, 0xffff
s_nop 0
v_cndmask_b32 v20, v247, 0, vcc
v_cndmask_b32 v244, 0, v244, vcc
v_mov_b32 v28, v244
v_add_u32 v246, 8, v239
v_cmp_gt_u32 vcc, 8, v246
v_mov_b32 v244, 0xffff0000
s_nop 0
v_cndmask_b32 v25, v247, 0, vcc
v_cndmask_b32 v244, 0, v244, vcc
v_or_b32 v30, v30, v244
v_add_u32 v246, 1, v239
v_cmp_le_i32 vcc, 9, v246
v_mov_b32 v244, 0xffff0000
s_nop 0
v_cndmask_b32 v21, v247, 0, vcc
v_cndmask_b32 v244, 0, v244, vcc
v_or_b32 v28, v28, v244
v_add_u32 v246, 9, v239
v_cmp_gt_u32 vcc, 8, v246
v_mov_b32 v244, 0xffff
s_nop 0
v_cndmask_b32 v26, v247, 0, vcc
v_cndmask_b32 v244, 0, v244, vcc
v_mov_b32 v31, v244
v_add_u32 v246, 2, v239
v_cmp_le_i32 vcc, 9, v246
v_mov_b32 v244, 0xffff
s_nop 0
v_cndmask_b32 v22, v247, 0, vcc
v_cndmask_b32 v244, 0, v244, vcc
v_mov_b32 v29, v244
v_add_u32 v246, 10, v239
v_cmp_gt_u32 vcc, 8, v246
v_mov_b32 v244, 0xffff0000
s_nop 0
v_cndmask_b32 v27, v247, 0, vcc
v_cndmask_b32 v244, 0, v244, vcc
v_or_b32 v31, v31, v244
v_add_u32 v246, 3, v239
v_cmp_le_i32 vcc, 9, v246
v_mov_b32 v244, 0xffff0000
s_nop 0
v_cndmask_b32 v23, v247, 0, vcc
v_cndmask_b32 v244, 0, v244, vcc
v_or_b32 v29, v29, v244
s_and_b32 s36, s29, 3
s_or_b32 s36, s36, s28
s_cmp_eq_u32 s36, 0
s_cselect_b64 vcc, -1, 0
v_cndmask_b32 v76, v20, v247, vcc
v_cndmask_b32 v77, v21, v247, vcc
v_cndmask_b32 v78, v22, v247, vcc
v_cndmask_b32 v79, v23, v247, vcc
v_cndmask_b32 v80, v28, 0, vcc
v_cndmask_b32 v81, v29, 0, vcc
s_add_u32 s91, s83, 0x1780000
buffer_store_dwordx4 a[248:251], v3, s[4:7], s91 offen offset:0 sc1
buffer_store_dwordx4 a[248:251], v3, s[4:7], s91 offen offset:1024 sc1
s_mov_b32 s36, 0x9e3779b1
s_waitcnt vmcnt(23)
v_mul_lo_u32 v15, v11, s36
v_add_u32 v15, 0x7f4a7c15, v15
s_and_b32 s36, s31, 1
s_lshl_b32 s36, s36, 4
s_add_u32 s36, s36, s32
s_lshl_b32 s36, s36, 2
s_add_u32 s92, s78, s36
s_add_u32 s92, s92, 0xc0000
s_lshl_b32 s36, s32, 2
s_add_u32 s93, s79, s36
s_add_u32 s93, s93, 0xc0080
s_and_b32 s94, s35, 15
s_lshl_b32 s94, s94, 9
s_lshr_b32 s36, s35, 4
s_lshl_b32 s36, s36, 2
s_add_u32 s94, s94, s36
s_add_u32 s94, s94, 0xc00c0
v_lshrrev_b32 v240, 1, v0
v_lshlrev_b32 v240, 13, v240
v_and_b32 v241, 1, v0
v_lshl_add_u32 v240, v241, 8, v240
s_mov_b32 vcc_lo, 0xffff
s_mov_b32 vcc_hi, 0
v_cndmask_b32 v240, 2.0, v240, vcc
v_lshlrev_b32 v241, 2, v0
v_add_u32 v248, 0, v248
v_add_u32 v249, 0, v249
s_add_u32 s96, s96, 0x400000
s_add_u32 s98, s98, 0x80000
s_add_u32 s96, s96, 0x400000
s_add_u32 s99, s99, 0x80000
s_cmp_eq_u32 s28, 0
s_cselect_b32 vcc_lo, 0xffff, 0
v_lshlrev_b32 v252, 12, v0
v_cndmask_b32 v252, 2.0, v252, vcc
v_cndmask_b32 v14, 2.0, v240, vcc
s_and_b32 s62, s35, 15
s_lshl_b32 s62, s62, 8
s_lshr_b32 s36, s35, 4
s_lshl_b32 s36, s36, 2
s_add_u32 s62, s62, s36
s_add_u32 s62, s62, 0xd0000
s_add_u32 s8, s94, 0x1ff40
v_and_b32 v255, 15, v0
v_lshlrev_b32 v255, 2, v255
s_waitcnt vmcnt(0)
s_barrier
s_cmp_lg_u32 s28, 0
s_cbranch_scc1 Lg1s_1
buffer_atomic_swap v15, v10, s[4:7], s92 offen sc1
s_add_u32 s36, s67, 0xc2080
s_cmp_eq_u32 s81, 3
s_cselect_b32 s36, 0x40000000, s36
s_mov_b64 exec, 1
buffer_atomic_swap v15, off, s[4:7], s36 sc1
s_mov_b64 exec, -1
buffer_atomic_swap v15, v240, s[4:7], s94 offen sc1
buffer_atomic_swap v15, v252, s[4:7], s62 offen sc1
Lg1s_1:
s_branch L_aligned
.p2align 12
L_aligned:
s_mov_b64 s[20:21], s[76:77]
s_mov_b32 s22, 0x200000
s_add_u32 s89, s16, 0
buffer_load_dwordx4 a[220:223], v229, s[20:23], s89 offen nt
s_mov_b64 s[20:21], s[76:77]
s_mov_b32 s22, 0x200000
s_add_u32 s89, s16, 16384
buffer_load_dwordx4 a[224:227], v229, s[20:23], s89 offen nt
s_mov_b64 s[20:21], s[72:73]
s_mov_b32 s22, 0x600000
s_add_u32 s89, s17, 0
buffer_load_dwordx4 a[188:191], v228, s[20:23], s89 offen nt
s_mov_b64 s[20:21], s[72:73]
s_mov_b32 s22, 0x600000
s_add_u32 s89, s17, 49152
buffer_load_dwordx4 a[192:195], v228, s[20:23], s89 offen nt
s_mov_b64 s[20:21], s[72:73]
s_mov_b32 s22, 0x600000
s_add_u32 s89, s17, 2048
buffer_load_dwordx4 a[196:199], v228, s[20:23], s89 offen nt
s_mov_b64 s[20:21], s[72:73]
s_mov_b32 s22, 0x600000
s_add_u32 s89, s17, 51200
buffer_load_dwordx4 a[200:203], v228, s[20:23], s89 offen nt
s_mov_b64 s[20:21], s[72:73]
s_mov_b32 s22, 0x600000
s_add_u32 s89, s17, 4096
buffer_load_dwordx4 a[204:207], v228, s[20:23], s89 offen nt
s_mov_b64 s[20:21], s[72:73]
s_mov_b32 s22, 0x600000
s_add_u32 s89, s17, 53248
buffer_load_dwordx4 a[208:211], v228, s[20:23], s89 offen nt
s_add_u32 s89, s66, 0xd0000
ds_read_b64_tr_b16 a[240:241], v251 offset:0
ds_read_b64_tr_b16 a[242:243], v251 offset:1024
ds_read_b64_tr_b16 a[244:245], v251 offset:32
ds_read_b64_tr_b16 a[246:247], v251 offset:1056
s_lshl_b32 s36, s28, 11
v_add_u32 v231, s36, v1
s_waitcnt lgkmcnt(0)
v_add_u32 v231, 0, v231
v_cmp_eq_u32 vcc, 0, v0
s_nop 1
v_cndmask_b32 v251, 2.0, v0, vcc
s_cmp_eq_u32 s34, 0x40000000
s_cbranch_scc1 Lvote_4
s_add_u32 s36, s34, 0
s_memtime s[52:53]
s_waitcnt lgkmcnt(0)
s_load_dword s37, s[4:5], s36
s_waitcnt lgkmcnt(0)
s_memtime s[60:61]
s_waitcnt lgkmcnt(0)
s_sub_u32 s38, s60, s52
s_add_u32 s36, s34, 8192
s_memtime s[52:53]
s_waitcnt lgkmcnt(0)
s_load_dword s37, s[4:5], s36
s_waitcnt lgkmcnt(0)
s_memtime s[60:61]
s_waitcnt lgkmcnt(0)
s_sub_u32 s39, s60, s52
s_add_u32 s36, s34, 128
s_memtime s[52:53]
s_waitcnt lgkmcnt(0)
s_load_dword s37, s[4:5], s36
s_waitcnt lgkmcnt(0)
s_memtime s[60:61]
s_waitcnt lgkmcnt(0)
s_sub_u32 s37, s60, s52
s_min_u32 s38, s38, s37
s_add_u32 s36, s34, 8320
s_memtime s[52:53]
s_waitcnt lgkmcnt(0)
s_load_dword s37, s[4:5], s36
s_waitcnt lgkmcnt(0)
s_memtime s[60:61]
s_waitcnt lgkmcnt(0)
s_sub_u32 s37, s60, s52
s_min_u32 s39, s39, s37
s_cmp_lt_u32 s38, s39
s_cselect_b32 s36, 0, 1
s_lshr_b32 s37, s29, 2
s_xor_b32 s36, s36, s37
s_add_u32 s36, s36, 0x10000
v_mov_b32 v242, s36
s_and_b32 s36, s51, 1
s_lshl_b32 s36, s36, 7
s_lshr_b32 s37, s51, 1
s_lshl_b32 s37, s37, 4
s_add_u32 s36, s36, s37
buffer_atomic_add v242, v251, s[24:27], s36 offen sc1
Lvote_4:
s_mov_b64 exec, 0
s_cmp_eq_u32 s28, 3
s_cbranch_scc1 L_stub0
s_cmp_eq_u32 s28, 0
s_cbranch_scc1 L_stub1
s_cmp_eq_u32 s28, 2
s_cbranch_scc1 L_stub2
L_wret0:
s_mov_b64 exec, -1
s_cmp_lg_u32 s28, 1
s_cbranch_scc1 Lg1e_3
s_cmp_eq_u32 s54, 32
s_cselect_b32 s39, 0, 1
s_or_b32 s39, s39, 0xffff0000
s_mov_b32 s38, -1
s_add_u32 s36, s67, 0xc0000
s_mov_b32 s37, 0
Lg1p_2:
v_mov_b32 v11, 0
buffer_atomic_add v11, v241, s[4:7], s36 offen sc0 sc1
s_add_u32 s37, s37, 1
v_mov_b32 v242, v15
s_mov_b64 exec, 0xffff
v_mov_b32 v242, 0
buffer_atomic_add v242, v241, s[4:7], s89 offen sc0 sc1
s_mov_b64 exec, -1
s_waitcnt vmcnt(0)
v_cmp_ne_u32 vcc, v11, v15
v_cmp_ne_u32 s[52:53], v242, v15
s_and_b64 vcc, vcc, s[38:39]
s_or_b64 vcc, vcc, s[52:53]
s_cbranch_scc0 Lg1e_3
s_cmp_lt_u32 s37, 0x100000
s_cbranch_scc1 Lg1p_2
Lg1e_3:
s_barrier
s_add_u32 s94, s71, 0x80
s_add_u32 m0, s18, 0x0
s_add_u32 s44, s50, 0x2000000
buffer_load_dwordx4 v1, s[4:7], s44 offen offset:0 sc1 lds
buffer_load_dwordx4 v1, s[4:7], s44 offen offset:1024 sc1 lds
s_add_u32 m0, s18, 0x2000
s_add_u32 s44, s50, 0x2002000
buffer_load_dwordx4 v1, s[4:7], s44 offen offset:0 sc1 lds
buffer_load_dwordx4 v1, s[4:7], s44 offen offset:1024 sc1 lds
s_add_u32 m0, s18, 0x4000
s_add_u32 s44, s50, 0x2004000
buffer_load_dwordx4 v1, s[4:7], s44 offen offset:0 sc1 lds
buffer_load_dwordx4 v1, s[4:7], s44 offen offset:1024 sc1 lds
s_add_u32 m0, s18, 0x6000
s_add_u32 s44, s50, 0x2006000
buffer_load_dwordx4 v1, s[4:7], s44 offen offset:0 sc1 lds
buffer_load_dwordx4 v1, s[4:7], s44 offen offset:1024 sc1 lds
s_add_u32 m0, s18, 0x8000
s_add_u32 s44, s50, 0x2008000
buffer_load_dwordx4 v1, s[4:7], s44 offen offset:0 sc1 lds
buffer_load_dwordx4 v1, s[4:7], s44 offen offset:1024 sc1 lds
s_add_u32 m0, s18, 0xa000
s_add_u32 s44, s50, 0x200a000
buffer_load_dwordx4 v1, s[4:7], s44 offen offset:0 sc1 lds
buffer_load_dwordx4 v1, s[4:7], s44 offen offset:1024 sc1 lds
s_mov_b32 s35, 0
s_add_u32 s33, s35, 0x1000
buffer_load_dwordx4 a[0:3], v2, s[40:43], s35 offen offset:0 sc1
buffer_load_dwordx4 a[4:7], v2, s[40:43], s33 offen offset:0 sc1
buffer_load_dwordx4 a[8:11], v2, s[40:43], s35 offen offset:1024 sc1
buffer_load_dwordx4 a[12:15], v2, s[40:43], s33 offen offset:1024 sc1
buffer_load_dwordx4 a[16:19], v2, s[40:43], s35 offen offset:2048 sc1
buffer_load_dwordx4 a[20:23], v2, s[40:43], s33 offen offset:2048 sc1
buffer_load_dwordx4 a[24:27], v2, s[40:43], s35 offen offset:3072 sc1
buffer_load_dwordx4 a[28:31], v2, s[40:43], s33 offen offset:3072 sc1
s_add_u32 s35, s35, 0x2000
s_add_u32 s33, s33, 0x2000
buffer_load_dwordx4 a[32:35], v2, s[40:43], s35 offen offset:0 sc1
buffer_load_dwordx4 a[36:39], v2, s[40:43], s33 offen offset:0 sc1
buffer_load_dwordx4 a[40:43], v2, s[40:43], s35 offen offset:1024 sc1
buffer_load_dwordx4 a[44:47], v2, s[40:43], s33 offen offset:1024 sc1
buffer_load_dwordx4 a[48:51], v2, s[40:43], s35 offen offset:2048 sc1
buffer_load_dwordx4 a[52:55], v2, s[40:43], s33 offen offset:2048 sc1
buffer_load_dwordx4 a[56:59], v2, s[40:43], s35 offen offset:3072 sc1
buffer_load_dwordx4 a[60:63], v2, s[40:43], s33 offen offset:3072 sc1
s_add_u32 s35, s35, 0x2000
s_add_u32 s33, s33, 0x2000
s_waitcnt vmcnt(16)
s_barrier
v_add_u32 v5, 0, v1
ds_read_b128 a[96:99], v5 offset:2048
ds_read_b128 a[100:103], v5 offset:8192
ds_read_b128 a[104:107], v5 offset:3072
ds_read_b128 a[108:111], v5 offset:9216
ds_read_b128 a[112:115], v5 offset:4096
ds_read_b128 a[116:119], v5 offset:10240
s_waitcnt vmcnt(14) lgkmcnt(4)
v_mfma_f32_16x16x32_bf16 v[140:143], a[96:99], a[0:3], 0
s_add_u32 m0, s18, 0xc000
s_add_u32 s44, s50, 0x200c000
v_mfma_f32_16x16x32_bf16 v[140:143], a[100:103], a[4:7], v[140:143]
buffer_load_dwordx4 a[64:67], v2, s[40:43], s35 offen offset:0 sc1
s_waitcnt vmcnt(13)
v_mfma_f32_16x16x32_bf16 v[164:167], a[100:103], a[12:15], 0
ds_read_b128 a[128:131], v5 offset:5120
v_mfma_f32_16x16x32_bf16 v[164:167], a[96:99], a[8:11], v[164:167]
ds_read_b128 a[132:135], v5 offset:11264
s_waitcnt vmcnt(12)
v_mfma_f32_16x16x32_bf16 v[188:191], a[96:99], a[16:19], 0
s_waitcnt vmcnt(11)
v_mfma_f32_16x16x32_bf16 v[188:191], a[100:103], a[20:23], v[188:191]
buffer_load_dwordx4 v1, s[4:7], s44 offen offset:0 sc1 lds
s_waitcnt vmcnt(10)
v_mfma_f32_16x16x32_bf16 v[212:215], a[100:103], a[28:31], 0
ds_read_b128 a[136:139], v5 offset:0
v_mfma_f32_16x16x32_bf16 v[212:215], a[96:99], a[24:27], v[212:215]
s_waitcnt lgkmcnt(6)
v_mfma_f32_16x16x32_bf16 v[216:219], a[104:107], a[24:27], 0
ds_read_b128 a[140:143], v5 offset:6144
s_waitcnt lgkmcnt(6)
v_mfma_f32_16x16x32_bf16 v[216:219], a[108:111], a[28:31], v[216:219]
buffer_load_dwordx4 a[68:71], v2, s[40:43], s33 offen offset:0 sc1
v_mfma_f32_16x16x32_bf16 v[192:195], a[108:111], a[20:23], 0
ds_read_b128 a[144:147], v5 offset:1024
v_mfma_f32_16x16x32_bf16 v[192:195], a[104:107], a[16:19], v[192:195]
v_mfma_f32_16x16x32_bf16 v[168:171], a[104:107], a[8:11], 0
v_mfma_f32_16x16x32_bf16 v[168:171], a[108:111], a[12:15], v[168:171]
buffer_load_dwordx4 a[72:75], v2, s[40:43], s35 offen offset:1024 sc1
v_mfma_f32_16x16x32_bf16 v[144:147], a[108:111], a[4:7], 0
ds_read_b128 a[148:151], v5 offset:7168
v_mfma_f32_16x16x32_bf16 v[144:147], a[104:107], a[0:3], v[144:147]
s_waitcnt lgkmcnt(7)
v_mfma_f32_16x16x32_bf16 v[148:151], a[112:115], a[0:3], 0
s_waitcnt lgkmcnt(6)
v_mfma_f32_16x16x32_bf16 v[148:151], a[116:119], a[4:7], v[148:151]
buffer_load_dwordx4 v1, s[4:7], s44 offen offset:1024 sc1 lds
s_add_u32 m0, s18, 0xe000
v_mfma_f32_16x16x32_bf16 v[172:175], a[116:119], a[12:15], 0
s_add_u32 s44, s50, 0x200e000
v_mfma_f32_16x16x32_bf16 v[172:175], a[112:115], a[8:11], v[172:175]
v_mfma_f32_16x16x32_bf16 v[196:199], a[112:115], a[16:19], 0
v_mfma_f32_16x16x32_bf16 v[196:199], a[116:119], a[20:23], v[196:199]
buffer_load_dwordx4 a[76:79], v2, s[40:43], s33 offen offset:1024 sc1
v_mfma_f32_16x16x32_bf16 v[220:223], a[116:119], a[28:31], 0
v_mfma_f32_16x16x32_bf16 v[220:223], a[112:115], a[24:27], v[220:223]
s_waitcnt lgkmcnt(0)
v_mfma_f32_16x16x32_bf16 v[224:227], a[128:131], a[24:27], 0
ds_read_b128 a[96:99], v5 offset:14336
v_mfma_f32_16x16x32_bf16 v[224:227], a[132:135], a[28:31], v[224:227]
buffer_load_dwordx4 a[80:83], v2, s[40:43], s35 offen offset:2048 sc1
v_mfma_f32_16x16x32_bf16 v[200:203], a[132:135], a[20:23], 0
ds_read_b128 a[100:103], v5 offset:20480
v_mfma_f32_16x16x32_bf16 v[200:203], a[128:131], a[16:19], v[200:203]
v_mfma_f32_16x16x32_bf16 v[176:179], a[128:131], a[8:11], 0
v_mfma_f32_16x16x32_bf16 v[176:179], a[132:135], a[12:15], v[176:179]
buffer_load_dwordx4 v1, s[4:7], s44 offen offset:0 sc1 lds
v_mfma_f32_16x16x32_bf16 v[152:155], a[132:135], a[4:7], 0
ds_read_b128 a[104:107], v5 offset:15360
v_mfma_f32_16x16x32_bf16 v[152:155], a[128:131], a[0:3], v[152:155]
v_mfma_f32_16x16x32_bf16 v[132:135], a[136:139], a[0:3], 0
ds_read_b128 a[108:111], v5 offset:21504
v_mfma_f32_16x16x32_bf16 v[132:135], a[140:143], a[4:7], v[132:135]
buffer_load_dwordx4 a[84:87], v2, s[40:43], s33 offen offset:2048 sc1
v_mfma_f32_16x16x32_bf16 v[156:159], a[140:143], a[12:15], 0
ds_read_b128 a[112:115], v5 offset:16384
v_mfma_f32_16x16x32_bf16 v[156:159], a[136:139], a[8:11], v[156:159]
v_mfma_f32_16x16x32_bf16 v[180:183], a[136:139], a[16:19], 0
v_mfma_f32_16x16x32_bf16 v[180:183], a[140:143], a[20:23], v[180:183]
buffer_load_dwordx4 a[88:91], v2, s[40:43], s35 offen offset:3072 sc1
v_mfma_f32_16x16x32_bf16 v[204:207], a[140:143], a[28:31], 0
ds_read_b128 a[116:119], v5 offset:22528
v_mfma_f32_16x16x32_bf16 v[204:207], a[136:139], a[24:27], v[204:207]
v_mfma_f32_16x16x32_bf16 v[208:211], a[144:147], a[24:27], 0
v_mfma_f32_16x16x32_bf16 v[208:211], a[148:151], a[28:31], v[208:211]
buffer_load_dwordx4 v1, s[4:7], s44 offen offset:1024 sc1 lds
s_add_u32 m0, s18, 0x10000
v_mfma_f32_16x16x32_bf16 v[184:187], a[148:151], a[20:23], 0
s_add_u32 s44, s50, 0x2010000
v_mfma_f32_16x16x32_bf16 v[184:187], a[144:147], a[16:19], v[184:187]
v_mfma_f32_16x16x32_bf16 v[160:163], a[144:147], a[8:11], 0
v_mfma_f32_16x16x32_bf16 v[160:163], a[148:151], a[12:15], v[160:163]
buffer_load_dwordx4 a[92:95], v2, s[40:43], s33 offen offset:3072 sc1
s_add_u32 s35, s35, 0x2000
v_mfma_f32_16x16x32_bf16 v[136:139], a[148:151], a[4:7], 0
s_add_u32 s33, s33, 0x2000
v_mfma_f32_16x16x32_bf16 v[136:139], a[144:147], a[0:3], v[136:139]
s_waitcnt vmcnt(12) lgkmcnt(0)
v_mfma_f32_16x16x32_bf16 v[140:143], a[96:99], a[32:35], v[140:143]
ds_read_b128 a[128:131], v5 offset:17408
v_mfma_f32_16x16x32_bf16 v[140:143], a[100:103], a[36:39], v[140:143]
buffer_load_dwordx4 a[0:3], v2, s[40:43], s35 offen offset:0 sc1
v_mfma_f32_16x16x32_bf16 v[164:167], a[100:103], a[44:47], v[164:167]
ds_read_b128 a[132:135], v5 offset:23552
v_mfma_f32_16x16x32_bf16 v[164:167], a[96:99], a[40:43], v[164:167]
v_mfma_f32_16x16x32_bf16 v[188:191], a[96:99], a[48:51], v[188:191]
v_mfma_f32_16x16x32_bf16 v[188:191], a[100:103], a[52:55], v[188:191]
buffer_load_dwordx4 v1, s[4:7], s44 offen offset:0 sc1 lds
v_mfma_f32_16x16x32_bf16 v[212:215], a[100:103], a[60:63], v[212:215]
ds_read_b128 a[136:139], v5 offset:12288
v_mfma_f32_16x16x32_bf16 v[212:215], a[96:99], a[56:59], v[212:215]
v_mfma_f32_16x16x32_bf16 v[216:219], a[104:107], a[56:59], v[216:219]
ds_read_b128 a[140:143], v5 offset:18432
v_mfma_f32_16x16x32_bf16 v[216:219], a[108:111], a[60:63], v[216:219]
buffer_load_dwordx4 a[4:7], v2, s[40:43], s33 offen offset:0 sc1
v_mfma_f32_16x16x32_bf16 v[192:195], a[108:111], a[52:55], v[192:195]
ds_read_b128 a[144:147], v5 offset:13312
v_mfma_f32_16x16x32_bf16 v[192:195], a[104:107], a[48:51], v[192:195]
v_mfma_f32_16x16x32_bf16 v[168:171], a[104:107], a[40:43], v[168:171]
v_mfma_f32_16x16x32_bf16 v[168:171], a[108:111], a[44:47], v[168:171]
buffer_load_dwordx4 a[8:11], v2, s[40:43], s35 offen offset:1024 sc1
v_mfma_f32_16x16x32_bf16 v[144:147], a[108:111], a[36:39], v[144:147]
ds_read_b128 a[148:151], v5 offset:19456
v_mfma_f32_16x16x32_bf16 v[144:147], a[104:107], a[32:35], v[144:147]
v_mfma_f32_16x16x32_bf16 v[148:151], a[112:115], a[32:35], v[148:151]
v_mfma_f32_16x16x32_bf16 v[148:151], a[116:119], a[36:39], v[148:151]
buffer_load_dwordx4 v1, s[4:7], s44 offen offset:1024 sc1 lds
s_add_u32 m0, s18, 0x12000
v_mfma_f32_16x16x32_bf16 v[172:175], a[116:119], a[44:47], v[172:175]
s_add_u32 s44, s50, 0x2012000
v_mfma_f32_16x16x32_bf16 v[172:175], a[112:115], a[40:43], v[172:175]
v_mfma_f32_16x16x32_bf16 v[196:199], a[112:115], a[48:51], v[196:199]
v_mfma_f32_16x16x32_bf16 v[196:199], a[116:119], a[52:55], v[196:199]
buffer_load_dwordx4 a[12:15], v2, s[40:43], s33 offen offset:1024 sc1
v_mfma_f32_16x16x32_bf16 v[220:223], a[116:119], a[60:63], v[220:223]
v_mfma_f32_16x16x32_bf16 v[220:223], a[112:115], a[56:59], v[220:223]
s_waitcnt lgkmcnt(0)
v_mfma_f32_16x16x32_bf16 v[224:227], a[128:131], a[56:59], v[224:227]
ds_read_b128 a[96:99], v5 offset:26624
v_mfma_f32_16x16x32_bf16 v[224:227], a[132:135], a[60:63], v[224:227]
buffer_load_dwordx4 a[16:19], v2, s[40:43], s35 offen offset:2048 sc1
v_mfma_f32_16x16x32_bf16 v[200:203], a[132:135], a[52:55], v[200:203]
ds_read_b128 a[100:103], v5 offset:32768
v_mfma_f32_16x16x32_bf16 v[200:203], a[128:131], a[48:51], v[200:203]
v_mfma_f32_16x16x32_bf16 v[176:179], a[128:131], a[40:43], v[176:179]
v_mfma_f32_16x16x32_bf16 v[176:179], a[132:135], a[44:47], v[176:179]
buffer_load_dwordx4 v1, s[4:7], s44 offen offset:0 sc1 lds
v_mfma_f32_16x16x32_bf16 v[152:155], a[132:135], a[36:39], v[152:155]
ds_read_b128 a[104:107], v5 offset:27648
v_mfma_f32_16x16x32_bf16 v[152:155], a[128:131], a[32:35], v[152:155]
v_mfma_f32_16x16x32_bf16 v[132:135], a[136:139], a[32:35], v[132:135]
ds_read_b128 a[108:111], v5 offset:33792
v_mfma_f32_16x16x32_bf16 v[132:135], a[140:143], a[36:39], v[132:135]
buffer_load_dwordx4 a[20:23], v2, s[40:43], s33 offen offset:2048 sc1
v_mfma_f32_16x16x32_bf16 v[156:159], a[140:143], a[44:47], v[156:159]
ds_read_b128 a[112:115], v5 offset:28672
v_mfma_f32_16x16x32_bf16 v[156:159], a[136:139], a[40:43], v[156:159]
v_mfma_f32_16x16x32_bf16 v[180:183], a[136:139], a[48:51], v[180:183]
v_mfma_f32_16x16x32_bf16 v[180:183], a[140:143], a[52:55], v[180:183]
buffer_load_dwordx4 a[24:27], v2, s[40:43], s35 offen offset:3072 sc1
v_mfma_f32_16x16x32_bf16 v[204:207], a[140:143], a[60:63], v[204:207]
ds_read_b128 a[116:119], v5 offset:34816
v_mfma_f32_16x16x32_bf16 v[204:207], a[136:139], a[56:59], v[204:207]
v_mfma_f32_16x16x32_bf16 v[208:211], a[144:147], a[56:59], v[208:211]
v_mfma_f32_16x16x32_bf16 v[208:211], a[148:151], a[60:63], v[208:211]
buffer_load_dwordx4 v1, s[4:7], s44 offen offset:1024 sc1 lds
s_add_u32 m0, s18, 0x14000
v_mfma_f32_16x16x32_bf16 v[184:187], a[148:151], a[52:55], v[184:187]
s_add_u32 s44, s50, 0x2014000
v_mfma_f32_16x16x32_bf16 v[184:187], a[144:147], a[48:51], v[184:187]
v_mfma_f32_16x16x32_bf16 v[160:163], a[144:147], a[40:43], v[160:163]
v_mfma_f32_16x16x32_bf16 v[160:163], a[148:151], a[44:47], v[160:163]
buffer_load_dwordx4 a[28:31], v2, s[40:43], s33 offen offset:3072 sc1
s_add_u32 s35, s35, 0x2000
v_mfma_f32_16x16x32_bf16 v[136:139], a[148:151], a[36:39], v[136:139]
s_add_u32 s33, s33, 0x2000
v_mfma_f32_16x16x32_bf16 v[136:139], a[144:147], a[32:35], v[136:139]
s_waitcnt vmcnt(12) lgkmcnt(0)
v_mfma_f32_16x16x32_bf16 v[140:143], a[96:99], a[64:67], v[140:143]
ds_read_b128 a[128:131], v5 offset:29696
v_mfma_f32_16x16x32_bf16 v[140:143], a[100:103], a[68:71], v[140:143]
buffer_load_dwordx4 a[32:35], v2, s[40:43], s35 offen offset:0 sc1
v_mfma_f32_16x16x32_bf16 v[164:167], a[100:103], a[76:79], v[164:167]
ds_read_b128 a[132:135], v5 offset:35840
v_mfma_f32_16x16x32_bf16 v[164:167], a[96:99], a[72:75], v[164:167]
v_mfma_f32_16x16x32_bf16 v[188:191], a[96:99], a[80:83], v[188:191]
v_mfma_f32_16x16x32_bf16 v[188:191], a[100:103], a[84:87], v[188:191]
buffer_load_dwordx4 v1, s[4:7], s44 offen offset:0 sc1 lds
v_mfma_f32_16x16x32_bf16 v[212:215], a[100:103], a[92:95], v[212:215]
ds_read_b128 a[136:139], v5 offset:24576
v_mfma_f32_16x16x32_bf16 v[212:215], a[96:99], a[88:91], v[212:215]
v_mfma_f32_16x16x32_bf16 v[216:219], a[104:107], a[88:91], v[216:219]
ds_read_b128 a[140:143], v5 offset:30720
v_mfma_f32_16x16x32_bf16 v[216:219], a[108:111], a[92:95], v[216:219]
buffer_load_dwordx4 a[36:39], v2, s[40:43], s33 offen offset:0 sc1
v_mfma_f32_16x16x32_bf16 v[192:195], a[108:111], a[84:87], v[192:195]
ds_read_b128 a[144:147], v5 offset:25600
v_mfma_f32_16x16x32_bf16 v[192:195], a[104:107], a[80:83], v[192:195]
v_mfma_f32_16x16x32_bf16 v[168:171], a[104:107], a[72:75], v[168:171]
v_mfma_f32_16x16x32_bf16 v[168:171], a[108:111], a[76:79], v[168:171]
buffer_load_dwordx4 a[40:43], v2, s[40:43], s35 offen offset:1024 sc1
v_mfma_f32_16x16x32_bf16 v[144:147], a[108:111], a[68:71], v[144:147]
ds_read_b128 a[148:151], v5 offset:31744
v_mfma_f32_16x16x32_bf16 v[144:147], a[104:107], a[64:67], v[144:147]
v_mfma_f32_16x16x32_bf16 v[148:151], a[112:115], a[64:67], v[148:151]
v_mfma_f32_16x16x32_bf16 v[148:151], a[116:119], a[68:71], v[148:151]
buffer_load_dwordx4 v1, s[4:7], s44 offen offset:1024 sc1 lds
s_add_u32 m0, s18, 0x16000
v_mfma_f32_16x16x32_bf16 v[172:175], a[116:119], a[76:79], v[172:175]
s_add_u32 s44, s50, 0x2016000
v_mfma_f32_16x16x32_bf16 v[172:175], a[112:115], a[72:75], v[172:175]
v_mfma_f32_16x16x32_bf16 v[196:199], a[112:115], a[80:83], v[196:199]
v_mfma_f32_16x16x32_bf16 v[196:199], a[116:119], a[84:87], v[196:199]
buffer_load_dwordx4 a[44:47], v2, s[40:43], s33 offen offset:1024 sc1
v_mfma_f32_16x16x32_bf16 v[220:223], a[116:119], a[92:95], v[220:223]
v_mfma_f32_16x16x32_bf16 v[220:223], a[112:115], a[88:91], v[220:223]
s_waitcnt lgkmcnt(0)
v_mfma_f32_16x16x32_bf16 v[224:227], a[128:131], a[88:91], v[224:227]
ds_read_b128 a[96:99], v5 offset:38912
v_mfma_f32_16x16x32_bf16 v[224:227], a[132:135], a[92:95], v[224:227]
buffer_load_dwordx4 a[48:51], v2, s[40:43], s35 offen offset:2048 sc1
v_mfma_f32_16x16x32_bf16 v[200:203], a[132:135], a[84:87], v[200:203]
ds_read_b128 a[100:103], v5 offset:45056
v_mfma_f32_16x16x32_bf16 v[200:203], a[128:131], a[80:83], v[200:203]
v_mfma_f32_16x16x32_bf16 v[176:179], a[128:131], a[72:75], v[176:179]
buffer_load_dwordx4 v1, s[4:7], s44 offen offset:0 sc1 lds
v_mfma_f32_16x16x32_bf16 v[176:179], a[132:135], a[76:79], v[176:179]
ds_read_b128 a[104:107], v5 offset:39936
v_mfma_f32_16x16x32_bf16 v[152:155], a[132:135], a[68:71], v[152:155]
v_mfma_f32_16x16x32_bf16 v[152:155], a[128:131], a[64:67], v[152:155]
buffer_load_dwordx4 a[52:55], v2, s[40:43], s33 offen offset:2048 sc1
v_mfma_f32_16x16x32_bf16 v[132:135], a[136:139], a[64:67], v[132:135]
ds_read_b128 a[108:111], v5 offset:46080
v_mfma_f32_16x16x32_bf16 v[132:135], a[140:143], a[68:71], v[132:135]
v_mfma_f32_16x16x32_bf16 v[156:159], a[140:143], a[76:79], v[156:159]
ds_read_b128 a[112:115], v5 offset:40960
v_mfma_f32_16x16x32_bf16 v[156:159], a[136:139], a[72:75], v[156:159]
buffer_load_dwordx4 v1, s[4:7], s44 offen offset:1024 sc1 lds
v_mfma_f32_16x16x32_bf16 v[180:183], a[136:139], a[80:83], v[180:183]
v_and_b32 v232, 15, v0
v_lshlrev_b32 v232, 7, v232
v_mfma_f32_16x16x32_bf16 v[180:183], a[140:143], a[84:87], v[180:183]
v_lshrrev_b32 v233, 4, v0
v_lshlrev_b32 v233, 4, v233
v_mfma_f32_16x16x32_bf16 v[204:207], a[140:143], a[92:95], v[204:207]
buffer_load_dwordx4 a[56:59], v2, s[40:43], s35 offen offset:3072 sc1
v_mfma_f32_16x16x32_bf16 v[204:207], a[136:139], a[88:91], v[204:207]
v_add_u32 v232, v233, v232
s_mul_i32 s38, s30, 12288
v_mfma_f32_16x16x32_bf16 v[208:211], a[144:147], a[88:91], v[208:211]
s_add_u32 s38, s38, 0x1800000
s_add_u32 s39, s28, 4
s_min_u32 s39, s39, 5
v_mfma_f32_16x16x32_bf16 v[208:211], a[148:151], a[92:95], v[208:211]
s_lshl_b32 s36, s28, 11
s_add_u32 s36, s36, s38
s_lshl_b32 s37, s39, 11
s_add_u32 s37, s37, s38
v_mfma_f32_16x16x32_bf16 v[184:187], a[148:151], a[84:87], v[184:187]
buffer_load_dwordx4 v[48:51], v232, s[4:7], s36 offen sc1
v_mfma_f32_16x16x32_bf16 v[184:187], a[144:147], a[80:83], v[184:187]
ds_read_b128 a[116:119], v5 offset:47104
v_mfma_f32_16x16x32_bf16 v[160:163], a[144:147], a[72:75], v[160:163]
v_mfma_f32_16x16x32_bf16 v[160:163], a[148:151], a[76:79], v[160:163]
buffer_load_dwordx4 a[60:63], v2, s[40:43], s33 offen offset:3072 sc1
s_add_u32 s35, s35, 0x2000
v_mfma_f32_16x16x32_bf16 v[136:139], a[148:151], a[68:71], v[136:139]
s_add_u32 s33, s33, 0x2000
v_mfma_f32_16x16x32_bf16 v[136:139], a[144:147], a[64:67], v[136:139]
s_waitcnt vmcnt(13) lgkmcnt(0)
v_mfma_f32_16x16x32_bf16 v[140:143], a[96:99], a[0:3], v[140:143]
ds_read_b128 a[128:131], v5 offset:41984
v_mfma_f32_16x16x32_bf16 v[140:143], a[100:103], a[4:7], v[140:143]
buffer_load_dwordx4 a[64:67], v2, s[40:43], s35 offen offset:0 sc1
v_mfma_f32_16x16x32_bf16 v[164:167], a[100:103], a[12:15], v[164:167]
ds_read_b128 a[132:135], v5 offset:48128
v_mfma_f32_16x16x32_bf16 v[164:167], a[96:99], a[8:11], v[164:167]
v_mfma_f32_16x16x32_bf16 v[188:191], a[96:99], a[16:19], v[188:191]
v_mfma_f32_16x16x32_bf16 v[188:191], a[100:103], a[20:23], v[188:191]
buffer_load_dwordx4 v[52:55], v232, s[4:7], s37 offen sc1
s_add_u32 m0, s18, 0x18000
v_mfma_f32_16x16x32_bf16 v[212:215], a[100:103], a[28:31], v[212:215]
s_add_u32 s44, s50, 0x2018000
ds_read_b128 a[136:139], v5 offset:36864
v_mfma_f32_16x16x32_bf16 v[212:215], a[96:99], a[24:27], v[212:215]
v_mfma_f32_16x16x32_bf16 v[216:219], a[104:107], a[24:27], v[216:219]
ds_read_b128 a[140:143], v5 offset:43008
v_mfma_f32_16x16x32_bf16 v[216:219], a[108:111], a[28:31], v[216:219]
buffer_load_dwordx4 a[68:71], v2, s[40:43], s33 offen offset:0 sc1
v_mfma_f32_16x16x32_bf16 v[192:195], a[108:111], a[20:23], v[192:195]
ds_read_b128 a[144:147], v5 offset:37888
v_mfma_f32_16x16x32_bf16 v[192:195], a[104:107], a[16:19], v[192:195]
v_mfma_f32_16x16x32_bf16 v[168:171], a[104:107], a[8:11], v[168:171]
v_mfma_f32_16x16x32_bf16 v[168:171], a[108:111], a[12:15], v[168:171]
buffer_load_dwordx4 a[72:75], v2, s[40:43], s35 offen offset:1024 sc1
v_mfma_f32_16x16x32_bf16 v[144:147], a[108:111], a[4:7], v[144:147]
ds_read_b128 a[148:151], v5 offset:44032
v_mfma_f32_16x16x32_bf16 v[144:147], a[104:107], a[0:3], v[144:147]
v_mfma_f32_16x16x32_bf16 v[148:151], a[112:115], a[0:3], v[148:151]
v_mfma_f32_16x16x32_bf16 v[148:151], a[116:119], a[4:7], v[148:151]
buffer_load_dwordx4 v1, s[4:7], s44 offen offset:0 sc1 lds
v_mfma_f32_16x16x32_bf16 v[172:175], a[116:119], a[12:15], v[172:175]
v_mfma_f32_16x16x32_bf16 v[172:175], a[112:115], a[8:11], v[172:175]
v_mfma_f32_16x16x32_bf16 v[196:199], a[112:115], a[16:19], v[196:199]
v_mfma_f32_16x16x32_bf16 v[196:199], a[116:119], a[20:23], v[196:199]
buffer_load_dwordx4 a[76:79], v2, s[40:43], s33 offen offset:1024 sc1
v_mfma_f32_16x16x32_bf16 v[220:223], a[116:119], a[28:31], v[220:223]
v_mfma_f32_16x16x32_bf16 v[220:223], a[112:115], a[24:27], v[220:223]
s_waitcnt lgkmcnt(0)
s_barrier
v_mfma_f32_16x16x32_bf16 v[224:227], a[128:131], a[24:27], v[224:227]
v_add_u32 v5, 49152, v1
v_mfma_f32_16x16x32_bf16 v[224:227], a[132:135], a[28:31], v[224:227]
buffer_load_dwordx4 a[80:83], v2, s[40:43], s35 offen offset:2048 sc1
v_mfma_f32_16x16x32_bf16 v[200:203], a[132:135], a[20:23], v[200:203]
ds_read_b128 a[96:99], v5 offset:2048
v_mfma_f32_16x16x32_bf16 v[200:203], a[128:131], a[16:19], v[200:203]
ds_read_b128 a[100:103], v5 offset:8192
v_mfma_f32_16x16x32_bf16 v[176:179], a[128:131], a[8:11], v[176:179]
ds_write_b128 v231, a[220:223] offset:24576
v_mfma_f32_16x16x32_bf16 v[176:179], a[132:135], a[12:15], v[176:179]
buffer_load_dwordx4 v1, s[4:7], s44 offen offset:1024 sc1 lds
s_add_u32 m0, s18, 0x1a000
v_mfma_f32_16x16x32_bf16 v[152:155], a[132:135], a[4:7], v[152:155]
s_add_u32 s44, s50, 0x201a000
ds_read_b128 a[104:107], v5 offset:3072
v_mfma_f32_16x16x32_bf16 v[152:155], a[128:131], a[0:3], v[152:155]
v_mfma_f32_16x16x32_bf16 v[132:135], a[136:139], a[0:3], v[132:135]
ds_read_b128 a[108:111], v5 offset:9216
v_mfma_f32_16x16x32_bf16 v[132:135], a[140:143], a[4:7], v[132:135]
buffer_load_dwordx4 a[84:87], v2, s[40:43], s33 offen offset:2048 sc1
v_mfma_f32_16x16x32_bf16 v[156:159], a[140:143], a[12:15], v[156:159]
ds_read_b128 a[112:115], v5 offset:4096
v_mfma_f32_16x16x32_bf16 v[156:159], a[136:139], a[8:11], v[156:159]
ds_write_b128 v231, a[224:227] offset:25600
v_mfma_f32_16x16x32_bf16 v[180:183], a[136:139], a[16:19], v[180:183]
v_mfma_f32_16x16x32_bf16 v[180:183], a[140:143], a[20:23], v[180:183]
buffer_load_dwordx4 a[88:91], v2, s[40:43], s35 offen offset:3072 sc1
v_mfma_f32_16x16x32_bf16 v[204:207], a[140:143], a[28:31], v[204:207]
ds_read_b128 a[116:119], v5 offset:10240
v_mfma_f32_16x16x32_bf16 v[204:207], a[136:139], a[24:27], v[204:207]
v_mfma_f32_16x16x32_bf16 v[208:211], a[144:147], a[24:27], v[208:211]
v_mfma_f32_16x16x32_bf16 v[208:211], a[148:151], a[28:31], v[208:211]
buffer_load_dwordx4 v1, s[4:7], s44 offen offset:0 sc1 lds
v_mfma_f32_16x16x32_bf16 v[184:187], a[148:151], a[20:23], v[184:187]
v_mfma_f32_16x16x32_bf16 v[184:187], a[144:147], a[16:19], v[184:187]
v_mfma_f32_16x16x32_bf16 v[160:163], a[144:147], a[8:11], v[160:163]
v_mfma_f32_16x16x32_bf16 v[160:163], a[148:151], a[12:15], v[160:163]
buffer_load_dwordx4 a[92:95], v2, s[40:43], s33 offen offset:3072 sc1
s_add_u32 s35, s35, 0x2000
v_mfma_f32_16x16x32_bf16 v[136:139], a[148:151], a[4:7], v[136:139]
s_add_u32 s33, s33, 0x2000
ds_write_b128 v231, a[188:191] offset:0
v_mfma_f32_16x16x32_bf16 v[136:139], a[144:147], a[0:3], v[136:139]
s_waitcnt vmcnt(12) lgkmcnt(1)
v_mfma_f32_16x16x32_bf16 v[140:143], a[96:99], a[32:35], v[140:143]
ds_read_b128 a[128:131], v5 offset:5120
v_mfma_f32_16x16x32_bf16 v[140:143], a[100:103], a[36:39], v[140:143]
buffer_load_dwordx4 a[0:3], v2, s[40:43], s35 offen offset:0 sc1
v_mfma_f32_16x16x32_bf16 v[164:167], a[100:103], a[44:47], v[164:167]
ds_read_b128 a[132:135], v5 offset:11264
v_mfma_f32_16x16x32_bf16 v[164:167], a[96:99], a[40:43], v[164:167]
v_mfma_f32_16x16x32_bf16 v[188:191], a[96:99], a[48:51], v[188:191]
v_mfma_f32_16x16x32_bf16 v[188:191], a[100:103], a[52:55], v[188:191]
buffer_load_dwordx4 v1, s[4:7], s44 offen offset:1024 sc1 lds
s_add_u32 m0, s18, 0x1c000
v_mfma_f32_16x16x32_bf16 v[212:215], a[100:103], a[60:63], v[212:215]
s_add_u32 s44, s50, 0x201c000
ds_read_b128 a[136:139], v5 offset:0
v_mfma_f32_16x16x32_bf16 v[212:215], a[96:99], a[56:59], v[212:215]
ds_write_b128 v231, a[192:195] offset:1024
v_mfma_f32_16x16x32_bf16 v[216:219], a[104:107], a[56:59], v[216:219]
ds_read_b128 a[140:143], v5 offset:6144
v_mfma_f32_16x16x32_bf16 v[216:219], a[108:111], a[60:63], v[216:219]
buffer_load_dwordx4 a[4:7], v2, s[40:43], s33 offen offset:0 sc1
v_mfma_f32_16x16x32_bf16 v[192:195], a[108:111], a[52:55], v[192:195]
ds_read_b128 a[144:147], v5 offset:1024
v_mfma_f32_16x16x32_bf16 v[192:195], a[104:107], a[48:51], v[192:195]
v_mfma_f32_16x16x32_bf16 v[168:171], a[104:107], a[40:43], v[168:171]
v_mfma_f32_16x16x32_bf16 v[168:171], a[108:111], a[44:47], v[168:171]
buffer_load_dwordx4 a[8:11], v2, s[40:43], s35 offen offset:1024 sc1
v_mfma_f32_16x16x32_bf16 v[144:147], a[108:111], a[36:39], v[144:147]
ds_read_b128 a[148:151], v5 offset:7168
v_mfma_f32_16x16x32_bf16 v[144:147], a[104:107], a[32:35], v[144:147]
v_mfma_f32_16x16x32_bf16 v[148:151], a[112:115], a[32:35], v[148:151]
v_mfma_f32_16x16x32_bf16 v[148:151], a[116:119], a[36:39], v[148:151]
buffer_load_dwordx4 v1, s[4:7], s44 offen offset:0 sc1 lds
v_mfma_f32_16x16x32_bf16 v[172:175], a[116:119], a[44:47], v[172:175]
ds_write_b128 v231, a[196:199] offset:8192
v_mfma_f32_16x16x32_bf16 v[172:175], a[112:115], a[40:43], v[172:175]
v_mfma_f32_16x16x32_bf16 v[196:199], a[112:115], a[48:51], v[196:199]
v_mfma_f32_16x16x32_bf16 v[196:199], a[116:119], a[52:55], v[196:199]
L_stub0:
s_cbranch_execz L_wret0
buffer_load_dwordx4 a[12:15], v2, s[40:43], s33 offen offset:1024 sc1
v_mfma_f32_16x16x32_bf16 v[220:223], a[116:119], a[60:63], v[220:223]
v_mfma_f32_16x16x32_bf16 v[220:223], a[112:115], a[56:59], v[220:223]
s_waitcnt lgkmcnt(1)
v_mfma_f32_16x16x32_bf16 v[224:227], a[128:131], a[56:59], v[224:227]
ds_read_b128 a[96:99], v5 offset:14336
v_mfma_f32_16x16x32_bf16 v[224:227], a[132:135], a[60:63], v[224:227]
buffer_load_dwordx4 a[16:19], v2, s[40:43], s35 offen offset:2048 sc1
v_mfma_f32_16x16x32_bf16 v[200:203], a[132:135], a[52:55], v[200:203]
ds_read_b128 a[100:103], v5 offset:20480
v_mfma_f32_16x16x32_bf16 v[200:203], a[128:131], a[48:51], v[200:203]
v_mfma_f32_16x16x32_bf16 v[176:179], a[128:131], a[40:43], v[176:179]
v_mfma_f32_16x16x32_bf16 v[176:179], a[132:135], a[44:47], v[176:179]
buffer_load_dwordx4 v1, s[4:7], s44 offen offset:1024 sc1 lds
s_add_u32 s88, s82, 0x1700000
v_mfma_f32_16x16x32_bf16 v[152:155], a[132:135], a[36:39], v[152:155]
ds_read_b128 a[104:107], v5 offset:15360
v_mfma_f32_16x16x32_bf16 v[152:155], a[128:131], a[32:35], v[152:155]
ds_write_b128 v231, a[200:203] offset:9216
v_mfma_f32_16x16x32_bf16 v[132:135], a[136:139], a[32:35], v[132:135]
ds_read_b128 a[108:111], v5 offset:21504
v_mfma_f32_16x16x32_bf16 v[132:135], a[140:143], a[36:39], v[132:135]
buffer_load_dwordx4 a[20:23], v2, s[40:43], s33 offen offset:2048 sc1
v_mfma_f32_16x16x32_bf16 v[156:159], a[140:143], a[44:47], v[156:159]
ds_read_b128 a[112:115], v5 offset:16384
v_mfma_f32_16x16x32_bf16 v[156:159], a[136:139], a[40:43], v[156:159]
v_mfma_f32_16x16x32_bf16 v[180:183], a[136:139], a[48:51], v[180:183]
v_mfma_f32_16x16x32_bf16 v[180:183], a[140:143], a[52:55], v[180:183]
buffer_load_dwordx4 a[24:27], v2, s[40:43], s35 offen offset:3072 sc1
v_mfma_f32_16x16x32_bf16 v[204:207], a[140:143], a[60:63], v[204:207]
ds_read_b128 a[116:119], v5 offset:22528
v_mfma_f32_16x16x32_bf16 v[204:207], a[136:139], a[56:59], v[204:207]
ds_write_b128 v231, a[204:207] offset:16384
v_mfma_f32_16x16x32_bf16 v[208:211], a[144:147], a[56:59], v[208:211]
v_mfma_f32_16x16x32_bf16 v[208:211], a[148:151], a[60:63], v[208:211]
buffer_load_dwordx4 v[92:95], v1, s[4:7], s88 offen offset:0 sc1
v_mfma_f32_16x16x32_bf16 v[184:187], a[148:151], a[52:55], v[184:187]
v_mfma_f32_16x16x32_bf16 v[184:187], a[144:147], a[48:51], v[184:187]
v_mfma_f32_16x16x32_bf16 v[160:163], a[144:147], a[40:43], v[160:163]
v_mfma_f32_16x16x32_bf16 v[160:163], a[148:151], a[44:47], v[160:163]
buffer_load_dwordx4 a[28:31], v2, s[40:43], s33 offen offset:3072 sc1
s_add_u32 s35, s35, 0x2000
v_mfma_f32_16x16x32_bf16 v[136:139], a[148:151], a[36:39], v[136:139]
s_add_u32 s33, s33, 0x2000
v_mfma_f32_16x16x32_bf16 v[136:139], a[144:147], a[32:35], v[136:139]
s_waitcnt vmcnt(12) lgkmcnt(1)
v_mfma_f32_16x16x32_bf16 v[140:143], a[96:99], a[64:67], v[140:143]
ds_read_b128 a[128:131], v5 offset:17408
v_mfma_f32_16x16x32_bf16 v[140:143], a[100:103], a[68:71], v[140:143]
buffer_load_dwordx4 a[32:35], v2, s[40:43], s35 offen offset:0 sc1
v_mfma_f32_16x16x32_bf16 v[164:167], a[100:103], a[76:79], v[164:167]
ds_read_b128 a[132:135], v5 offset:23552
v_mfma_f32_16x16x32_bf16 v[164:167], a[96:99], a[72:75], v[164:167]
ds_write_b128 v231, a[208:211] offset:17408
v_mfma_f32_16x16x32_bf16 v[188:191], a[96:99], a[80:83], v[188:191]
v_mfma_f32_16x16x32_bf16 v[188:191], a[100:103], a[84:87], v[188:191]
buffer_load_dwordx4 v[96:99], v1, s[4:7], s88 offen offset:1024 sc1
v_mfma_f32_16x16x32_bf16 v[212:215], a[100:103], a[92:95], v[212:215]
ds_read_b128 a[136:139], v5 offset:12288
v_mfma_f32_16x16x32_bf16 v[212:215], a[96:99], a[88:91], v[212:215]
v_mfma_f32_16x16x32_bf16 v[216:219], a[104:107], a[88:91], v[216:219]
ds_read_b128 a[140:143], v5 offset:18432
v_mfma_f32_16x16x32_bf16 v[216:219], a[108:111], a[92:95], v[216:219]
buffer_load_dwordx4 a[36:39], v2, s[40:43], s33 offen offset:0 sc1
v_mfma_f32_16x16x32_bf16 v[192:195], a[108:111], a[84:87], v[192:195]
ds_read_b128 a[144:147], v5 offset:13312
v_mfma_f32_16x16x32_bf16 v[192:195], a[104:107], a[80:83], v[192:195]
v_mfma_f32_16x16x32_bf16 v[168:171], a[104:107], a[72:75], v[168:171]
v_mfma_f32_16x16x32_bf16 v[168:171], a[108:111], a[76:79], v[168:171]
buffer_load_dwordx4 a[40:43], v2, s[40:43], s35 offen offset:1024 sc1
v_mfma_f32_16x16x32_bf16 v[144:147], a[108:111], a[68:71], v[144:147]
ds_read_b128 a[148:151], v5 offset:19456
v_mfma_f32_16x16x32_bf16 v[144:147], a[104:107], a[64:67], v[144:147]
v_mfma_f32_16x16x32_bf16 v[148:151], a[112:115], a[64:67], v[148:151]
v_mfma_f32_16x16x32_bf16 v[148:151], a[116:119], a[68:71], v[148:151]
buffer_load_dwordx4 v[100:103], v1, s[4:7], s88 offen offset:2048 sc1
v_mfma_f32_16x16x32_bf16 v[172:175], a[116:119], a[76:79], v[172:175]
v_mfma_f32_16x16x32_bf16 v[172:175], a[112:115], a[72:75], v[172:175]
v_mfma_f32_16x16x32_bf16 v[196:199], a[112:115], a[80:83], v[196:199]
v_mfma_f32_16x16x32_bf16 v[196:199], a[116:119], a[84:87], v[196:199]
buffer_load_dwordx4 a[44:47], v2, s[40:43], s33 offen offset:1024 sc1
v_mfma_f32_16x16x32_bf16 v[220:223], a[116:119], a[92:95], v[220:223]
v_mfma_f32_16x16x32_bf16 v[220:223], a[112:115], a[88:91], v[220:223]
s_waitcnt lgkmcnt(0)
s_barrier
v_mfma_f32_16x16x32_bf16 v[224:227], a[128:131], a[88:91], v[224:227]
ds_read_b128 a[96:99], v5 offset:26624
v_mfma_f32_16x16x32_bf16 v[224:227], a[132:135], a[92:95], v[224:227]
buffer_load_dwordx4 a[48:51], v2, s[40:43], s35 offen offset:2048 sc1
v_mfma_f32_16x16x32_bf16 v[200:203], a[132:135], a[84:87], v[200:203]
ds_read_b128 a[100:103], v5 offset:32768
v_mfma_f32_16x16x32_bf16 v[200:203], a[128:131], a[80:83], v[200:203]
ds_read_b64_tr_b16 a[220:221], v230 offset:0
v_mfma_f32_16x16x32_bf16 v[176:179], a[128:131], a[72:75], v[176:179]
v_mfma_f32_16x16x32_bf16 v[176:179], a[132:135], a[76:79], v[176:179]
buffer_load_dwordx4 v[104:107], v1, s[4:7], s88 offen offset:3072 sc1
s_add_u32 s88, s88, 4096
v_mfma_f32_16x16x32_bf16 v[152:155], a[132:135], a[68:71], v[152:155]
ds_read_b128 a[104:107], v5 offset:27648
v_mfma_f32_16x16x32_bf16 v[152:155], a[128:131], a[64:67], v[152:155]
ds_read_b64_tr_b16 a[222:223], v230 offset:2048
v_mfma_f32_16x16x32_bf16 v[132:135], a[136:139], a[64:67], v[132:135]
ds_read_b128 a[108:111], v5 offset:33792
v_mfma_f32_16x16x32_bf16 v[132:135], a[140:143], a[68:71], v[132:135]
buffer_load_dwordx4 a[52:55], v2, s[40:43], s33 offen offset:2048 sc1
v_mfma_f32_16x16x32_bf16 v[156:159], a[140:143], a[76:79], v[156:159]
ds_read_b128 a[112:115], v5 offset:28672
v_mfma_f32_16x16x32_bf16 v[156:159], a[136:139], a[72:75], v[156:159]
ds_read_b64_tr_b16 a[224:225], v230 offset:8
v_mfma_f32_16x16x32_bf16 v[180:183], a[136:139], a[80:83], v[180:183]
v_mfma_f32_16x16x32_bf16 v[180:183], a[140:143], a[84:87], v[180:183]
buffer_load_dwordx4 a[56:59], v2, s[40:43], s35 offen offset:3072 sc1
v_mfma_f32_16x16x32_bf16 v[204:207], a[140:143], a[92:95], v[204:207]
ds_read_b128 a[116:119], v5 offset:34816
v_mfma_f32_16x16x32_bf16 v[204:207], a[136:139], a[88:91], v[204:207]
v_mfma_f32_16x16x32_bf16 v[208:211], a[144:147], a[88:91], v[208:211]
ds_read_b64_tr_b16 a[226:227], v230 offset:2056
v_mfma_f32_16x16x32_bf16 v[208:211], a[148:151], a[92:95], v[208:211]
buffer_load_dwordx4 v[108:111], v1, s[4:7], s88 offen offset:0 sc1
v_mfma_f32_16x16x32_bf16 v[184:187], a[148:151], a[84:87], v[184:187]
v_mfma_f32_16x16x32_bf16 v[184:187], a[144:147], a[80:83], v[184:187]
v_mfma_f32_16x16x32_bf16 v[160:163], a[144:147], a[72:75], v[160:163]
v_mfma_f32_16x16x32_bf16 v[160:163], a[148:151], a[76:79], v[160:163]
buffer_load_dwordx4 a[60:63], v2, s[40:43], s33 offen offset:3072 sc1
s_add_u32 s35, s35, 0x2000
v_mfma_f32_16x16x32_bf16 v[136:139], a[148:151], a[68:71], v[136:139]
s_add_u32 s33, s33, 0x2000
ds_read_b64_tr_b16 a[188:189], v248 offset:0
v_mfma_f32_16x16x32_bf16 v[136:139], a[144:147], a[64:67], v[136:139]
s_waitcnt vmcnt(12) lgkmcnt(2)
v_mfma_f32_16x16x32_bf16 v[140:143], a[96:99], a[0:3], v[140:143]
ds_read_b128 a[128:131], v5 offset:29696
v_add_f32_dpp v48, v48, v48 row_ror:8 row_mask:0xf bank_mask:0xf
v_mfma_f32_16x16x32_bf16 v[140:143], a[100:103], a[4:7], v[140:143]
buffer_load_dwordx4 a[64:67], v2, s[40:43], s35 offen offset:0 sc1
v_mfma_f32_16x16x32_bf16 v[164:167], a[100:103], a[12:15], v[164:167]
ds_read_b128 a[132:135], v5 offset:35840
v_add_f32_dpp v49, v49, v49 row_ror:8 row_mask:0xf bank_mask:0xf
v_mfma_f32_16x16x32_bf16 v[164:167], a[96:99], a[8:11], v[164:167]
ds_read_b64_tr_b16 a[190:191], v248 offset:512
v_add_f32_dpp v50, v50, v50 row_ror:8 row_mask:0xf bank_mask:0xf
v_mfma_f32_16x16x32_bf16 v[188:191], a[96:99], a[16:19], v[188:191]
v_add_f32_dpp v51, v51, v51 row_ror:8 row_mask:0xf bank_mask:0xf
v_add_f32_dpp v52, v52, v52 row_ror:8 row_mask:0xf bank_mask:0xf
v_mfma_f32_16x16x32_bf16 v[188:191], a[100:103], a[20:23], v[188:191]
buffer_load_dwordx4 v[112:115], v1, s[4:7], s88 offen offset:1024 sc1
v_mfma_f32_16x16x32_bf16 v[212:215], a[100:103], a[28:31], v[212:215]
ds_read_b128 a[136:139], v5 offset:24576
v_add_f32_dpp v53, v53, v53 row_ror:8 row_mask:0xf bank_mask:0xf
v_mfma_f32_16x16x32_bf16 v[212:215], a[96:99], a[24:27], v[212:215]
v_add_f32_dpp v54, v54, v54 row_ror:8 row_mask:0xf bank_mask:0xf
v_add_f32_dpp v55, v55, v55 row_ror:8 row_mask:0xf bank_mask:0xf
v_mfma_f32_16x16x32_bf16 v[216:219], a[104:107], a[24:27], v[216:219]
ds_read_b128 a[140:143], v5 offset:30720
v_add_f32_dpp v48, v48, v48 row_ror:4 row_mask:0xf bank_mask:0xf
v_mfma_f32_16x16x32_bf16 v[216:219], a[108:111], a[28:31], v[216:219]
buffer_load_dwordx4 a[68:71], v2, s[40:43], s33 offen offset:0 sc1
v_mfma_f32_16x16x32_bf16 v[192:195], a[108:111], a[20:23], v[192:195]
ds_read_b128 a[144:147], v5 offset:25600
v_add_f32_dpp v49, v49, v49 row_ror:4 row_mask:0xf bank_mask:0xf
v_mfma_f32_16x16x32_bf16 v[192:195], a[104:107], a[16:19], v[192:195]
ds_read_b64_tr_b16 a[192:193], v248 offset:4096
v_add_f32_dpp v50, v50, v50 row_ror:4 row_mask:0xf bank_mask:0xf
v_mfma_f32_16x16x32_bf16 v[168:171], a[104:107], a[8:11], v[168:171]
v_add_f32_dpp v51, v51, v51 row_ror:4 row_mask:0xf bank_mask:0xf
v_add_f32_dpp v52, v52, v52 row_ror:4 row_mask:0xf bank_mask:0xf
v_mfma_f32_16x16x32_bf16 v[168:171], a[108:111], a[12:15], v[168:171]
buffer_load_dwordx4 a[72:75], v2, s[40:43], s35 offen offset:1024 sc1
v_mfma_f32_16x16x32_bf16 v[144:147], a[108:111], a[4:7], v[144:147]
ds_read_b128 a[148:151], v5 offset:31744
v_add_f32_dpp v53, v53, v53 row_ror:4 row_mask:0xf bank_mask:0xf
v_mfma_f32_16x16x32_bf16 v[144:147], a[104:107], a[0:3], v[144:147]
ds_read_b64_tr_b16 a[194:195], v248 offset:4608
v_add_f32_dpp v54, v54, v54 row_ror:4 row_mask:0xf bank_mask:0xf
v_mfma_f32_16x16x32_bf16 v[148:151], a[112:115], a[0:3], v[148:151]
v_add_f32_dpp v55, v55, v55 row_ror:4 row_mask:0xf bank_mask:0xf
v_add_f32_dpp v48, v48, v48 row_ror:2 row_mask:0xf bank_mask:0xf
v_mfma_f32_16x16x32_bf16 v[148:151], a[116:119], a[4:7], v[148:151]
buffer_load_dwordx4 v[116:119], v1, s[4:7], s88 offen offset:2048 sc1
v_mfma_f32_16x16x32_bf16 v[172:175], a[116:119], a[12:15], v[172:175]
v_add_f32_dpp v49, v49, v49 row_ror:2 row_mask:0xf bank_mask:0xf
v_add_f32_dpp v50, v50, v50 row_ror:2 row_mask:0xf bank_mask:0xf
v_mfma_f32_16x16x32_bf16 v[172:175], a[112:115], a[8:11], v[172:175]
v_add_f32_dpp v51, v51, v51 row_ror:2 row_mask:0xf bank_mask:0xf
v_add_f32_dpp v52, v52, v52 row_ror:2 row_mask:0xf bank_mask:0xf
v_mfma_f32_16x16x32_bf16 v[196:199], a[112:115], a[16:19], v[196:199]
ds_read_b64_tr_b16 a[196:197], v249 offset:32
v_add_f32_dpp v53, v53, v53 row_ror:2 row_mask:0xf bank_mask:0xf
v_mfma_f32_16x16x32_bf16 v[196:199], a[116:119], a[20:23], v[196:199]
buffer_load_dwordx4 a[76:79], v2, s[40:43], s33 offen offset:1024 sc1
v_mfma_f32_16x16x32_bf16 v[220:223], a[116:119], a[28:31], v[220:223]
v_add_f32_dpp v54, v54, v54 row_ror:2 row_mask:0xf bank_mask:0xf
v_add_f32_dpp v55, v55, v55 row_ror:2 row_mask:0xf bank_mask:0xf
v_mfma_f32_16x16x32_bf16 v[220:223], a[112:115], a[24:27], v[220:223]
v_add_f32_dpp v48, v48, v48 row_ror:1 row_mask:0xf bank_mask:0xf
s_waitcnt lgkmcnt(2)
v_mfma_f32_16x16x32_bf16 v[224:227], a[128:131], a[24:27], v[224:227]
ds_read_b128 a[96:99], v5 offset:38912
v_add_f32_dpp v49, v49, v49 row_ror:1 row_mask:0xf bank_mask:0xf
v_mfma_f32_16x16x32_bf16 v[224:227], a[132:135], a[28:31], v[224:227]
buffer_load_dwordx4 a[80:83], v2, s[40:43], s35 offen offset:2048 sc1
v_mfma_f32_16x16x32_bf16 v[200:203], a[132:135], a[20:23], v[200:203]
ds_read_b128 a[100:103], v5 offset:45056
v_add_f32_dpp v50, v50, v50 row_ror:1 row_mask:0xf bank_mask:0xf
v_mfma_f32_16x16x32_bf16 v[200:203], a[128:131], a[16:19], v[200:203]
ds_read_b64_tr_b16 a[198:199], v249 offset:544
v_add_f32_dpp v51, v51, v51 row_ror:1 row_mask:0xf bank_mask:0xf
v_mfma_f32_16x16x32_bf16 v[176:179], a[128:131], a[8:11], v[176:179]
buffer_load_dwordx4 v[120:123], v1, s[4:7], s88 offen offset:3072 sc1
s_add_u32 m0, s18, 0x1e000
v_mfma_f32_16x16x32_bf16 v[176:179], a[132:135], a[12:15], v[176:179]
s_add_u32 s44, s50, 0x201e000
ds_read_b128 a[104:107], v5 offset:39936
v_mfma_f32_16x16x32_bf16 v[152:155], a[132:135], a[4:7], v[152:155]
v_add_f32_dpp v52, v52, v52 row_ror:1 row_mask:0xf bank_mask:0xf
v_add_f32_dpp v53, v53, v53 row_ror:1 row_mask:0xf bank_mask:0xf
v_mfma_f32_16x16x32_bf16 v[152:155], a[128:131], a[0:3], v[152:155]
buffer_load_dwordx4 a[84:87], v2, s[40:43], s33 offen offset:2048 sc1
v_mfma_f32_16x16x32_bf16 v[132:135], a[136:139], a[0:3], v[132:135]
ds_read_b128 a[108:111], v5 offset:46080
v_add_f32_dpp v54, v54, v54 row_ror:1 row_mask:0xf bank_mask:0xf
v_mfma_f32_16x16x32_bf16 v[132:135], a[140:143], a[4:7], v[132:135]
ds_read_b64_tr_b16 a[200:201], v249 offset:4128
v_add_f32_dpp v55, v55, v55 row_ror:1 row_mask:0xf bank_mask:0xf
v_mfma_f32_16x16x32_bf16 v[156:159], a[140:143], a[12:15], v[156:159]
ds_read_b128 a[112:115], v5 offset:40960
v_add_u32 v233, 159744, v233
v_mfma_f32_16x16x32_bf16 v[156:159], a[136:139], a[8:11], v[156:159]
buffer_load_dwordx4 v1, s[4:7], s44 offen offset:0 sc1 lds
s_lshl_b32 s36, s28, 6
v_mfma_f32_16x16x32_bf16 v[180:183], a[136:139], a[16:19], v[180:183]
ds_read_b64_tr_b16 a[202:203], v249 offset:4640
s_lshl_b32 s37, s39, 6
v_mfma_f32_16x16x32_bf16 v[180:183], a[140:143], a[20:23], v[180:183]
ds_read_b128 a[116:119], v5 offset:47104
v_add_u32 v232, s36, v233
v_mfma_f32_16x16x32_bf16 v[204:207], a[140:143], a[28:31], v[204:207]
buffer_load_dwordx4 a[88:91], v2, s[40:43], s35 offen offset:3072 sc1
v_mfma_f32_16x16x32_bf16 v[204:207], a[136:139], a[24:27], v[204:207]
v_add_u32 v235, s37, v233
v_mfma_f32_16x16x32_bf16 v[208:211], a[144:147], a[24:27], v[208:211]
v_mfma_f32_16x16x32_bf16 v[208:211], a[148:151], a[28:31], v[208:211]
v_mfma_f32_16x16x32_bf16 v[184:187], a[148:151], a[20:23], v[184:187]
buffer_load_dwordx4 v1, s[4:7], s44 offen offset:1024 sc1 lds
s_add_u32 m0, s18, 0x20000
v_mfma_f32_16x16x32_bf16 v[184:187], a[144:147], a[16:19], v[184:187]
s_add_u32 s44, s50, 0x2020000
ds_read_b64_tr_b16 a[204:205], v248 offset:8192
v_mfma_f32_16x16x32_bf16 v[160:163], a[144:147], a[8:11], v[160:163]
v_mfma_f32_16x16x32_bf16 v[160:163], a[148:151], a[12:15], v[160:163]
buffer_load_dwordx4 a[92:95], v2, s[40:43], s33 offen offset:3072 sc1
s_add_u32 s35, s35, 0x2000
v_mfma_f32_16x16x32_bf16 v[136:139], a[148:151], a[4:7], v[136:139]
s_add_u32 s33, s33, 0x2000
v_mfma_f32_16x16x32_bf16 v[136:139], a[144:147], a[0:3], v[136:139]
ds_read_b64_tr_b16 a[206:207], v248 offset:8704
s_waitcnt vmcnt(13) lgkmcnt(2)
v_mfma_f32_16x16x32_bf16 v[140:143], a[96:99], a[32:35], v[140:143]
ds_read_b128 a[128:131], v5 offset:41984
v_mfma_f32_16x16x32_bf16 v[140:143], a[100:103], a[36:39], v[140:143]
buffer_load_dwordx4 a[0:3], v2, s[40:43], s35 offen offset:0 sc1
v_mfma_f32_16x16x32_bf16 v[164:167], a[100:103], a[44:47], v[164:167]
ds_read_b128 a[132:135], v5 offset:48128
v_mfma_f32_16x16x32_bf16 v[164:167], a[96:99], a[40:43], v[164:167]
ds_write_b128 v232, v[48:51]
v_mfma_f32_16x16x32_bf16 v[188:191], a[96:99], a[48:51], v[188:191]
ds_write_b128 v235, v[52:55]
v_mfma_f32_16x16x32_bf16 v[188:191], a[100:103], a[52:55], v[188:191]
buffer_load_dwordx4 v1, s[4:7], s44 offen offset:0 sc1 lds
v_mfma_f32_16x16x32_bf16 v[212:215], a[100:103], a[60:63], v[212:215]
ds_read_b128 a[136:139], v5 offset:36864
v_mfma_f32_16x16x32_bf16 v[212:215], a[96:99], a[56:59], v[212:215]
ds_read_b64_tr_b16 a[208:209], v248 offset:12288
v_mfma_f32_16x16x32_bf16 v[216:219], a[104:107], a[56:59], v[216:219]
ds_read_b128 a[140:143], v5 offset:43008
v_mfma_f32_16x16x32_bf16 v[216:219], a[108:111], a[60:63], v[216:219]
buffer_load_dwordx4 a[4:7], v2, s[40:43], s33 offen offset:0 sc1
v_mfma_f32_16x16x32_bf16 v[192:195], a[108:111], a[52:55], v[192:195]
ds_read_b128 a[144:147], v5 offset:37888
v_mfma_f32_16x16x32_bf16 v[192:195], a[104:107], a[48:51], v[192:195]
ds_read_b64_tr_b16 a[210:211], v248 offset:12800
v_mfma_f32_16x16x32_bf16 v[168:171], a[104:107], a[40:43], v[168:171]
v_mfma_f32_16x16x32_bf16 v[168:171], a[108:111], a[44:47], v[168:171]
ds_read_b128 a[148:151], v5 offset:44032
v_mfma_f32_16x16x32_bf16 v[144:147], a[108:111], a[36:39], v[144:147]
buffer_load_dwordx4 a[8:11], v2, s[40:43], s35 offen offset:1024 sc1
v_mfma_f32_16x16x32_bf16 v[144:147], a[104:107], a[32:35], v[144:147]
v_mfma_f32_16x16x32_bf16 v[148:151], a[112:115], a[32:35], v[148:151]
v_mfma_f32_16x16x32_bf16 v[148:151], a[116:119], a[36:39], v[148:151]
v_mfma_f32_16x16x32_bf16 v[172:175], a[116:119], a[44:47], v[172:175]
buffer_load_dword v11, v1, s[24:27], 0 offen sc1
v_mfma_f32_16x16x32_bf16 v[172:175], a[112:115], a[40:43], v[172:175]
v_mfma_f32_16x16x32_bf16 v[196:199], a[112:115], a[48:51], v[196:199]
buffer_load_dwordx4 a[12:15], v2, s[40:43], s33 offen offset:1024 sc1
v_mfma_f32_16x16x32_bf16 v[196:199], a[116:119], a[52:55], v[196:199]
v_mfma_f32_16x16x32_bf16 v[220:223], a[116:119], a[60:63], v[220:223]
v_mfma_f32_16x16x32_bf16 v[220:223], a[112:115], a[56:59], v[220:223]
s_waitcnt lgkmcnt(0)
s_barrier
v_mfma_f32_16x16x32_bf16 v[224:227], a[128:131], a[56:59], v[224:227]
v_add_u32 v5, 98304, v1
v_mfma_f32_16x16x32_bf16 v[224:227], a[132:135], a[60:63], v[224:227]
buffer_load_dwordx4 a[16:19], v2, s[40:43], s35 offen offset:2048 sc1
v_mfma_f32_16x16x32_bf16 v[200:203], a[132:135], a[52:55], v[200:203]
ds_read_b128 a[96:99], v5 offset:2048
v_mfma_f32_16x16x32_bf16 v[200:203], a[128:131], a[48:51], v[200:203]
ds_read_b128 a[100:103], v5 offset:8192
v_mfma_f32_16x16x32_bf16 v[176:179], a[128:131], a[40:43], v[176:179]
ds_read_b128 v[48:51], v233 offset:0
v_mfma_f32_16x16x32_bf16 v[176:179], a[132:135], a[44:47], v[176:179]
buffer_load_dwordx4 v1, s[4:7], s44 offen offset:1024 sc1 lds
s_add_u32 m0, s18, 0x22000
v_mfma_f32_16x16x32_bf16 v[152:155], a[132:135], a[36:39], v[152:155]
s_add_u32 s44, s50, 0x2022000
ds_read_b128 a[104:107], v5 offset:3072
v_mfma_f32_16x16x32_bf16 v[152:155], a[128:131], a[32:35], v[152:155]
v_mfma_f32_16x16x32_bf16 v[132:135], a[136:139], a[32:35], v[132:135]
ds_read_b128 a[108:111], v5 offset:9216
v_mfma_f32_16x16x32_bf16 v[132:135], a[140:143], a[36:39], v[132:135]
buffer_load_dwordx4 a[20:23], v2, s[40:43], s33 offen offset:2048 sc1
v_mfma_f32_16x16x32_bf16 v[156:159], a[140:143], a[44:47], v[156:159]
ds_read_b128 a[112:115], v5 offset:4096
v_mfma_f32_16x16x32_bf16 v[156:159], a[136:139], a[40:43], v[156:159]
ds_read_b128 v[52:55], v233 offset:64
v_mfma_f32_16x16x32_bf16 v[180:183], a[136:139], a[48:51], v[180:183]
v_mfma_f32_16x16x32_bf16 v[180:183], a[140:143], a[52:55], v[180:183]
buffer_load_dwordx4 a[24:27], v2, s[40:43], s35 offen offset:3072 sc1
v_mfma_f32_16x16x32_bf16 v[204:207], a[140:143], a[60:63], v[204:207]
ds_read_b128 a[116:119], v5 offset:10240
v_mfma_f32_16x16x32_bf16 v[204:207], a[136:139], a[56:59], v[204:207]
v_mfma_f32_16x16x32_bf16 v[208:211], a[144:147], a[56:59], v[208:211]
v_mfma_f32_16x16x32_bf16 v[208:211], a[148:151], a[60:63], v[208:211]
buffer_load_dwordx4 v1, s[4:7], s44 offen offset:0 sc1 lds
v_mfma_f32_16x16x32_bf16 v[184:187], a[148:151], a[52:55], v[184:187]
v_mfma_f32_16x16x32_bf16 v[184:187], a[144:147], a[48:51], v[184:187]
v_mfma_f32_16x16x32_bf16 v[160:163], a[144:147], a[40:43], v[160:163]
v_mfma_f32_16x16x32_bf16 v[160:163], a[148:151], a[44:47], v[160:163]
buffer_load_dwordx4 a[28:31], v2, s[40:43], s33 offen offset:3072 sc1
s_add_u32 s35, s35, 0x2000
v_mfma_f32_16x16x32_bf16 v[136:139], a[148:151], a[36:39], v[136:139]
s_add_u32 s33, s33, 0x2000
ds_read_b128 v[56:59], v233 offset:128
v_mfma_f32_16x16x32_bf16 v[136:139], a[144:147], a[32:35], v[136:139]
s_waitcnt vmcnt(12) lgkmcnt(1)
v_mfma_f32_16x16x32_bf16 v[140:143], a[96:99], a[64:67], v[140:143]
ds_read_b128 a[128:131], v5 offset:5120
v_mfma_f32_16x16x32_bf16 v[140:143], a[100:103], a[68:71], v[140:143]
buffer_load_dwordx4 a[32:35], v2, s[40:43], s35 offen offset:0 sc1
v_mfma_f32_16x16x32_bf16 v[164:167], a[100:103], a[76:79], v[164:167]
ds_read_b128 a[132:135], v5 offset:11264
v_mfma_f32_16x16x32_bf16 v[164:167], a[96:99], a[72:75], v[164:167]
v_mfma_f32_16x16x32_bf16 v[236:239], a[188:191], v[16:19], 0
v_mfma_f32_16x16x32_bf16 v[188:191], a[96:99], a[80:83], v[188:191]
v_mfma_f32_16x16x32_bf16 v[240:243], a[196:199], v[16:19], 0
v_mfma_f32_16x16x32_bf16 v[188:191], a[100:103], a[84:87], v[188:191]
buffer_load_dwordx4 v1, s[4:7], s44 offen offset:1024 sc1 lds
s_add_u32 m0, s18, 0x0
v_mfma_f32_16x16x32_bf16 v[212:215], a[100:103], a[92:95], v[212:215]
s_add_u32 s44, s50, 0x2024000
ds_read_b128 a[136:139], v5 offset:0
v_mfma_f32_16x16x32_bf16 v[212:215], a[96:99], a[88:91], v[212:215]
v_mfma_f32_16x16x32_bf16 v[216:219], a[104:107], a[88:91], v[216:219]
ds_read_b128 a[140:143], v5 offset:6144
v_mfma_f32_16x16x32_bf16 v[216:219], a[108:111], a[92:95], v[216:219]
buffer_load_dwordx4 a[36:39], v2, s[40:43], s33 offen offset:0 sc1
v_mfma_f32_16x16x32_bf16 v[192:195], a[108:111], a[84:87], v[192:195]
ds_read_b128 a[144:147], v5 offset:1024
v_mfma_f32_16x16x32_bf16 v[192:195], a[104:107], a[80:83], v[192:195]
v_mfma_f32_16x16x32_bf16 v[244:247], a[204:207], v[16:19], 0
v_mfma_f32_16x16x32_bf16 v[168:171], a[104:107], a[72:75], v[168:171]
v_mfma_f32_16x16x32_bf16 v[236:239], a[192:195], v[16:19], v[236:239]
v_mfma_f32_16x16x32_bf16 v[168:171], a[108:111], a[76:79], v[168:171]
buffer_load_dwordx4 a[40:43], v2, s[40:43], s35 offen offset:1024 sc1
v_mfma_f32_16x16x32_bf16 v[144:147], a[108:111], a[68:71], v[144:147]
ds_read_b128 a[148:151], v5 offset:7168
v_mfma_f32_16x16x32_bf16 v[144:147], a[104:107], a[64:67], v[144:147]
ds_read_b128 v[60:63], v233 offset:192
v_mfma_f32_16x16x32_bf16 v[148:151], a[112:115], a[64:67], v[148:151]
v_mfma_f32_16x16x32_bf16 v[240:243], a[200:203], v[16:19], v[240:243]
v_mfma_f32_16x16x32_bf16 v[148:151], a[116:119], a[68:71], v[148:151]
buffer_load_dwordx4 v1, s[4:7], s44 offen offset:0 sc1 lds
v_mfma_f32_16x16x32_bf16 v[172:175], a[116:119], a[76:79], v[172:175]
ds_read_b128 v[64:67], v233 offset:256
v_mfma_f32_16x16x32_bf16 v[172:175], a[112:115], a[72:75], v[172:175]
v_mfma_f32_16x16x32_bf16 v[196:199], a[112:115], a[80:83], v[196:199]
v_mfma_f32_16x16x32_bf16 v[244:247], a[208:211], v[16:19], v[244:247]
v_mfma_f32_16x16x32_bf16 v[196:199], a[116:119], a[84:87], v[196:199]
buffer_load_dwordx4 a[44:47], v2, s[40:43], s33 offen offset:1024 sc1
v_mfma_f32_16x16x32_bf16 v[220:223], a[116:119], a[92:95], v[220:223]
v_mfma_f32_16x16x32_bf16 v[220:223], a[112:115], a[88:91], v[220:223]
s_waitcnt lgkmcnt(2)
v_mfma_f32_16x16x32_bf16 v[224:227], a[128:131], a[88:91], v[224:227]
ds_read_b128 a[96:99], v5 offset:14336
v_mfma_f32_16x16x32_bf16 v[224:227], a[132:135], a[92:95], v[224:227]
buffer_load_dwordx4 a[48:51], v2, s[40:43], s35 offen offset:2048 sc1
v_mfma_f32_16x16x32_bf16 v[200:203], a[132:135], a[84:87], v[200:203]
ds_read_b128 a[100:103], v5 offset:20480
v_mfma_f32_16x16x32_bf16 v[200:203], a[128:131], a[80:83], v[200:203]
v_mfma_f32_16x16x32_bf16 v[176:179], a[128:131], a[72:75], v[176:179]
buffer_load_dwordx4 v1, s[4:7], s44 offen offset:1024 sc1 lds
s_add_u32 m0, s18, 0x2000
v_mfma_f32_16x16x32_bf16 v[176:179], a[132:135], a[76:79], v[176:179]
s_add_u32 s44, s50, 0x2026000
ds_read_b128 a[104:107], v5 offset:15360
v_mfma_f32_16x16x32_bf16 v[152:155], a[132:135], a[68:71], v[152:155]
ds_read_b128 v[68:71], v233 offset:320
v_mfma_f32_16x16x32_bf16 v[152:155], a[128:131], a[64:67], v[152:155]
buffer_load_dwordx4 a[52:55], v2, s[40:43], s33 offen offset:2048 sc1
v_mfma_f32_16x16x32_bf16 v[132:135], a[136:139], a[64:67], v[132:135]
ds_read_b128 a[108:111], v5 offset:21504
v_mfma_f32_16x16x32_bf16 v[132:135], a[140:143], a[68:71], v[132:135]
v_mfma_f32_16x16x32_bf16 v[156:159], a[140:143], a[76:79], v[156:159]
ds_read_b128 a[112:115], v5 offset:16384
v_mfma_f32_16x16x32_bf16 v[156:159], a[136:139], a[72:75], v[156:159]
buffer_load_dwordx4 v1, s[4:7], s44 offen offset:0 sc1 lds
v_mfma_f32_16x16x32_bf16 v[180:183], a[136:139], a[80:83], v[180:183]
v_mfma_f32_16x16x32_bf16 v[180:183], a[140:143], a[84:87], v[180:183]
ds_read_b128 a[116:119], v5 offset:22528
v_mfma_f32_16x16x32_bf16 v[204:207], a[140:143], a[92:95], v[204:207]
buffer_load_dwordx4 a[56:59], v2, s[40:43], s35 offen offset:3072 sc1
v_mfma_f32_16x16x32_bf16 v[204:207], a[136:139], a[88:91], v[204:207]
v_mfma_f32_16x16x32_bf16 v[208:211], a[144:147], a[88:91], v[208:211]
v_mfma_f32_16x16x32_bf16 v[208:211], a[148:151], a[92:95], v[208:211]
v_mfma_f32_16x16x32_bf16 v[184:187], a[148:151], a[84:87], v[184:187]
buffer_load_dwordx4 v1, s[4:7], s44 offen offset:1024 sc1 lds
s_add_u32 m0, s18, 0x4000
v_mfma_f32_16x16x32_bf16 v[184:187], a[144:147], a[80:83], v[184:187]
s_add_u32 s44, s50, 0x2028000
v_mfma_f32_16x16x32_bf16 v[160:163], a[144:147], a[72:75], v[160:163]
v_mfma_f32_16x16x32_bf16 v[160:163], a[148:151], a[76:79], v[160:163]
buffer_load_dwordx4 a[60:63], v2, s[40:43], s33 offen offset:3072 sc1
s_add_u32 s35, s35, 0x2000
v_mfma_f32_16x16x32_bf16 v[136:139], a[148:151], a[68:71], v[136:139]
s_add_u32 s33, s33, 0x2000
v_mfma_f32_16x16x32_bf16 v[136:139], a[144:147], a[64:67], v[136:139]
s_waitcnt vmcnt(13) lgkmcnt(0)
v_mfma_f32_16x16x32_bf16 v[140:143], a[96:99], a[0:3], v[140:143]
ds_read_b128 a[128:131], v5 offset:17408
v_add_f32 v92, v92, v96
v_mfma_f32_16x16x32_bf16 v[140:143], a[100:103], a[4:7], v[140:143]
buffer_load_dwordx4 a[64:67], v2, s[40:43], s35 offen offset:0 sc1
v_mfma_f32_16x16x32_bf16 v[164:167], a[100:103], a[12:15], v[164:167]
ds_read_b128 a[132:135], v5 offset:23552
v_add_f32 v100, v100, v104
v_mfma_f32_16x16x32_bf16 v[164:167], a[96:99], a[8:11], v[164:167]
v_add_f32 v108, v108, v112
v_add_f32 v116, v116, v120
v_mfma_f32_16x16x32_bf16 v[188:191], a[96:99], a[16:19], v[188:191]
v_add_f32 v93, v93, v97
v_add_f32 v101, v101, v105
v_mfma_f32_16x16x32_bf16 v[188:191], a[100:103], a[20:23], v[188:191]
buffer_load_dwordx4 v1, s[4:7], s44 offen offset:0 sc1 lds
v_mfma_f32_16x16x32_bf16 v[212:215], a[100:103], a[28:31], v[212:215]
ds_read_b128 a[136:139], v5 offset:12288
v_add_f32 v109, v109, v113
v_mfma_f32_16x16x32_bf16 v[212:215], a[96:99], a[24:27], v[212:215]
v_add_f32 v117, v117, v121
v_add_f32 v94, v94, v98
v_mfma_f32_16x16x32_bf16 v[216:219], a[104:107], a[24:27], v[216:219]
ds_read_b128 a[140:143], v5 offset:18432
v_add_f32 v102, v102, v106
v_mfma_f32_16x16x32_bf16 v[216:219], a[108:111], a[28:31], v[216:219]
buffer_load_dwordx4 a[68:71], v2, s[40:43], s33 offen offset:0 sc1
v_mfma_f32_16x16x32_bf16 v[192:195], a[108:111], a[20:23], v[192:195]
ds_read_b128 a[144:147], v5 offset:13312
v_add_f32 v110, v110, v114
v_mfma_f32_16x16x32_bf16 v[192:195], a[104:107], a[16:19], v[192:195]
v_add_f32 v118, v118, v122
v_add_f32 v95, v95, v99
v_mfma_f32_16x16x32_bf16 v[168:171], a[104:107], a[8:11], v[168:171]
v_add_f32 v103, v103, v107
v_mfma_f32_16x16x32_bf16 v[168:171], a[108:111], a[12:15], v[168:171]
buffer_load_dwordx4 a[72:75], v2, s[40:43], s35 offen offset:1024 sc1
v_mfma_f32_16x16x32_bf16 v[144:147], a[108:111], a[4:7], v[144:147]
ds_read_b128 a[148:151], v5 offset:19456
v_add_f32 v111, v111, v115
v_mfma_f32_16x16x32_bf16 v[144:147], a[104:107], a[0:3], v[144:147]
v_add_f32 v119, v119, v123
v_add_f32_dpp v92, v92, v92 row_ror:8 row_mask:0xf bank_mask:0xf
v_mfma_f32_16x16x32_bf16 v[148:151], a[112:115], a[0:3], v[148:151]
v_add_f32_dpp v100, v100, v100 row_ror:8 row_mask:0xf bank_mask:0xf
v_mfma_f32_16x16x32_bf16 v[148:151], a[116:119], a[4:7], v[148:151]
buffer_load_dwordx4 v1, s[4:7], s44 offen offset:1024 sc1 lds
s_add_u32 m0, s18, 0x6000
v_mfma_f32_16x16x32_bf16 v[172:175], a[116:119], a[12:15], v[172:175]
s_add_u32 s44, s50, 0x202a000
v_add_f32_dpp v108, v108, v108 row_ror:8 row_mask:0xf bank_mask:0xf
v_mfma_f32_16x16x32_bf16 v[172:175], a[112:115], a[8:11], v[172:175]
v_add_f32_dpp v116, v116, v116 row_ror:8 row_mask:0xf bank_mask:0xf
v_add_f32_dpp v93, v93, v93 row_ror:8 row_mask:0xf bank_mask:0xf
v_mfma_f32_16x16x32_bf16 v[196:199], a[112:115], a[16:19], v[196:199]
v_add_f32_dpp v101, v101, v101 row_ror:8 row_mask:0xf bank_mask:0xf
v_mfma_f32_16x16x32_bf16 v[196:199], a[116:119], a[20:23], v[196:199]
buffer_load_dwordx4 a[76:79], v2, s[40:43], s33 offen offset:1024 sc1
v_mfma_f32_16x16x32_bf16 v[220:223], a[116:119], a[28:31], v[220:223]
v_add_f32_dpp v109, v109, v109 row_ror:8 row_mask:0xf bank_mask:0xf
v_add_f32_dpp v117, v117, v117 row_ror:8 row_mask:0xf bank_mask:0xf
v_mfma_f32_16x16x32_bf16 v[220:223], a[112:115], a[24:27], v[220:223]
s_waitcnt vmcnt(17) lgkmcnt(0)
s_barrier
v_mfma_f32_16x16x32_bf16 v[224:227], a[128:131], a[24:27], v[224:227]
ds_read_b128 a[96:99], v5 offset:26624
v_add_f32_dpp v92, v94, v94 row_ror:8 row_mask:0xf bank_mask:0xc
v_mfma_f32_16x16x32_bf16 v[224:227], a[132:135], a[28:31], v[224:227]
buffer_load_dwordx4 a[80:83], v2, s[40:43], s35 offen offset:2048 sc1
v_mfma_f32_16x16x32_bf16 v[200:203], a[132:135], a[20:23], v[200:203]
ds_read_b128 a[100:103], v5 offset:32768
v_add_f32_dpp v100, v102, v102 row_ror:8 row_mask:0xf bank_mask:0xc
v_mfma_f32_16x16x32_bf16 v[200:203], a[128:131], a[16:19], v[200:203]
v_add_f32_dpp v108, v110, v110 row_ror:8 row_mask:0xf bank_mask:0xc
v_add_f32_dpp v116, v118, v118 row_ror:8 row_mask:0xf bank_mask:0xc
v_mfma_f32_16x16x32_bf16 v[176:179], a[128:131], a[8:11], v[176:179]
v_add_f32_dpp v93, v95, v95 row_ror:8 row_mask:0xf bank_mask:0xc
v_add_f32_dpp v101, v103, v103 row_ror:8 row_mask:0xf bank_mask:0xc
v_mfma_f32_16x16x32_bf16 v[176:179], a[132:135], a[12:15], v[176:179]
buffer_load_dwordx4 v1, s[4:7], s44 offen offset:0 sc1 lds
v_mfma_f32_16x16x32_bf16 v[152:155], a[132:135], a[4:7], v[152:155]
ds_read_b128 a[104:107], v5 offset:27648
v_add_f32_dpp v109, v111, v111 row_ror:8 row_mask:0xf bank_mask:0xc
v_mfma_f32_16x16x32_bf16 v[152:155], a[128:131], a[0:3], v[152:155]
v_add_f32_dpp v117, v119, v119 row_ror:8 row_mask:0xf bank_mask:0xc
v_mfma_f32_16x16x32_bf16 v[132:135], a[136:139], a[0:3], v[132:135]
ds_read_b128 a[108:111], v5 offset:33792
v_mfma_f32_16x16x32_bf16 v[132:135], a[140:143], a[4:7], v[132:135]
buffer_load_dwordx4 a[84:87], v2, s[40:43], s33 offen offset:2048 sc1
v_mfma_f32_16x16x32_bf16 v[156:159], a[140:143], a[12:15], v[156:159]
ds_read_b128 a[112:115], v5 offset:28672
v_mfma_f32_16x16x32_bf16 v[156:159], a[136:139], a[8:11], v[156:159]
v_permlane32_swap_b32 v92, v93
v_mfma_f32_16x16x32_bf16 v[180:183], a[136:139], a[16:19], v[180:183]
L_stub1:
s_cbranch_execz L_wret0
v_permlane32_swap_b32 v100, v101
v_mfma_f32_16x16x32_bf16 v[180:183], a[140:143], a[20:23], v[180:183]
buffer_load_dwordx4 a[88:91], v2, s[40:43], s35 offen offset:3072 sc1
v_mfma_f32_16x16x32_bf16 v[204:207], a[140:143], a[28:31], v[204:207]
ds_read_b128 a[116:119], v5 offset:34816
v_mfma_f32_16x16x32_bf16 v[204:207], a[136:139], a[24:27], v[204:207]
v_permlane32_swap_b32 v108, v109
v_mfma_f32_16x16x32_bf16 v[208:211], a[144:147], a[24:27], v[208:211]
v_permlane32_swap_b32 v116, v117
v_mfma_f32_16x16x32_bf16 v[208:211], a[148:151], a[28:31], v[208:211]
buffer_load_dwordx4 v1, s[4:7], s44 offen offset:1024 sc1 lds
s_add_u32 m0, s18, 0x8000
v_mfma_f32_16x16x32_bf16 v[184:187], a[148:151], a[20:23], v[184:187]
s_add_u32 s44, s50, 0x202c000
v_add_f32 v92, v92, v93
v_mfma_f32_16x16x32_bf16 v[184:187], a[144:147], a[16:19], v[184:187]
v_add_f32 v100, v100, v101
v_add_f32 v108, v108, v109
v_mfma_f32_16x16x32_bf16 v[160:163], a[144:147], a[8:11], v[160:163]
v_add_f32 v116, v116, v117
v_mov_b32 v94, v92
v_mfma_f32_16x16x32_bf16 v[160:163], a[148:151], a[12:15], v[160:163]
buffer_load_dwordx4 a[92:95], v2, s[40:43], s33 offen offset:3072 sc1
s_add_u32 s35, s35, 0x2000
v_mfma_f32_16x16x32_bf16 v[136:139], a[148:151], a[4:7], v[136:139]
s_add_u32 s33, s33, 0x2000
v_mov_b32 v102, v100
v_mfma_f32_16x16x32_bf16 v[136:139], a[144:147], a[0:3], v[136:139]
v_mov_b32 v110, v108
s_waitcnt vmcnt(12) lgkmcnt(0)
v_cmp_gt_u32 vcc, 0x100000, v11
s_nop 0
s_and_b32 vcc_lo, vcc_lo, 0x1f3f
s_cbranch_scc1 Ltal_5
Ltab_6:
v_cmp_lt_u32 vcc, 0x100008, v11
s_nop 0
s_and_b32 s51, vcc_lo, 0x1f3f
v_mfma_f32_16x16x32_bf16 v[140:143], a[96:99], a[32:35], v[140:143]
ds_read_b128 a[128:131], v5 offset:29696
v_mov_b32 v118, v116
v_mfma_f32_16x16x32_bf16 v[140:143], a[100:103], a[36:39], v[140:143]
buffer_load_dwordx4 a[0:3], v2, s[40:43], s35 offen offset:0 sc1
v_mfma_f32_16x16x32_bf16 v[164:167], a[100:103], a[44:47], v[164:167]
ds_read_b128 a[132:135], v5 offset:35840
v_mfma_f32_16x16x32_bf16 v[164:167], a[96:99], a[40:43], v[164:167]
v_permlane16_swap_b32 v92, v94
v_mfma_f32_16x16x32_bf16 v[188:191], a[96:99], a[48:51], v[188:191]
v_permlane16_swap_b32 v100, v102
v_mfma_f32_16x16x32_bf16 v[188:191], a[100:103], a[52:55], v[188:191]
buffer_load_dwordx4 v1, s[4:7], s44 offen offset:0 sc1 lds
v_mfma_f32_16x16x32_bf16 v[212:215], a[100:103], a[60:63], v[212:215]
ds_read_b128 a[136:139], v5 offset:24576
v_mfma_f32_16x16x32_bf16 v[212:215], a[96:99], a[56:59], v[212:215]
v_permlane16_swap_b32 v108, v110
v_mfma_f32_16x16x32_bf16 v[216:219], a[104:107], a[56:59], v[216:219]
ds_read_b128 a[140:143], v5 offset:30720
v_mfma_f32_16x16x32_bf16 v[216:219], a[108:111], a[60:63], v[216:219]
buffer_load_dwordx4 a[4:7], v2, s[40:43], s33 offen offset:0 sc1
v_mfma_f32_16x16x32_bf16 v[192:195], a[108:111], a[52:55], v[192:195]
ds_read_b128 a[144:147], v5 offset:25600
v_mfma_f32_16x16x32_bf16 v[192:195], a[104:107], a[48:51], v[192:195]
v_permlane16_swap_b32 v116, v118
v_mfma_f32_16x16x32_bf16 v[168:171], a[104:107], a[40:43], v[168:171]
v_add_f32 v92, v92, v94
v_add_f32 v100, v100, v102
v_mfma_f32_16x16x32_bf16 v[168:171], a[108:111], a[44:47], v[168:171]
buffer_load_dwordx4 a[8:11], v2, s[40:43], s35 offen offset:1024 sc1
v_mfma_f32_16x16x32_bf16 v[144:147], a[108:111], a[36:39], v[144:147]
ds_read_b128 a[148:151], v5 offset:31744
v_add_f32 v108, v108, v110
v_mfma_f32_16x16x32_bf16 v[144:147], a[104:107], a[32:35], v[144:147]
v_add_f32 v116, v116, v118
v_mov_b32 v94, v92
v_mfma_f32_16x16x32_bf16 v[148:151], a[112:115], a[32:35], v[148:151]
v_mov_b32 v102, v100
v_mov_b32 v110, v108
v_mfma_f32_16x16x32_bf16 v[148:151], a[116:119], a[36:39], v[148:151]
buffer_load_dwordx4 v1, s[4:7], s44 offen offset:1024 sc1 lds
s_add_u32 m0, s18, 0xa000
v_mfma_f32_16x16x32_bf16 v[172:175], a[116:119], a[44:47], v[172:175]
s_add_u32 s44, s50, 0x202e000
v_mov_b32 v118, v116
v_mfma_f32_16x16x32_bf16 v[172:175], a[112:115], a[40:43], v[172:175]
v_permlane32_swap_b32 v92, v94
v_mfma_f32_16x16x32_bf16 v[196:199], a[112:115], a[48:51], v[196:199]
v_permlane32_swap_b32 v100, v102
v_mfma_f32_16x16x32_bf16 v[196:199], a[116:119], a[52:55], v[196:199]
buffer_load_dwordx4 a[12:15], v2, s[40:43], s33 offen offset:1024 sc1
v_mfma_f32_16x16x32_bf16 v[220:223], a[116:119], a[60:63], v[220:223]
v_permlane32_swap_b32 v108, v110
v_mfma_f32_16x16x32_bf16 v[220:223], a[112:115], a[56:59], v[220:223]
s_waitcnt lgkmcnt(0)
v_mfma_f32_16x16x32_bf16 v[224:227], a[128:131], a[56:59], v[224:227]
ds_read_b128 a[96:99], v5 offset:38912
v_mfma_f32_16x16x32_bf16 v[224:227], a[132:135], a[60:63], v[224:227]
buffer_load_dwordx4 a[16:19], v2, s[40:43], s35 offen offset:2048 sc1
v_mfma_f32_16x16x32_bf16 v[200:203], a[132:135], a[52:55], v[200:203]
ds_read_b128 a[100:103], v5 offset:45056
v_mfma_f32_16x16x32_bf16 v[200:203], a[128:131], a[48:51], v[200:203]
v_permlane32_swap_b32 v116, v118
v_mfma_f32_16x16x32_bf16 v[176:179], a[128:131], a[40:43], v[176:179]
v_mul_f32 v82, 0xba800000, v92
v_mul_f32 v84, 0xba800000, v100
v_mfma_f32_16x16x32_bf16 v[176:179], a[132:135], a[44:47], v[176:179]
buffer_load_dwordx4 v1, s[4:7], s44 offen offset:0 sc1 lds
v_mfma_f32_16x16x32_bf16 v[152:155], a[132:135], a[36:39], v[152:155]
ds_read_b128 a[104:107], v5 offset:39936
v_mul_f32 v86, 0xba800000, v108
v_mfma_f32_16x16x32_bf16 v[152:155], a[128:131], a[32:35], v[152:155]
v_mul_f32 v88, 0xba800000, v116
v_mul_f32 v94, 0x3a800000, v94
v_mfma_f32_16x16x32_bf16 v[132:135], a[136:139], a[32:35], v[132:135]
ds_read_b128 a[108:111], v5 offset:46080
v_mul_f32 v102, 0x3a800000, v102
v_mfma_f32_16x16x32_bf16 v[132:135], a[140:143], a[36:39], v[132:135]
buffer_load_dwordx4 a[20:23], v2, s[40:43], s33 offen offset:2048 sc1
v_mfma_f32_16x16x32_bf16 v[156:159], a[140:143], a[44:47], v[156:159]
ds_read_b128 a[112:115], v5 offset:40960
v_mul_f32 v110, 0x3a800000, v110
v_mfma_f32_16x16x32_bf16 v[156:159], a[136:139], a[40:43], v[156:159]
v_mul_f32 v118, 0x3a800000, v118
v_fma_f32 v94, -v82, v82, v94
v_mfma_f32_16x16x32_bf16 v[180:183], a[136:139], a[48:51], v[180:183]
v_fma_f32 v102, -v84, v84, v102
v_fma_f32 v110, -v86, v86, v110
v_mfma_f32_16x16x32_bf16 v[180:183], a[140:143], a[52:55], v[180:183]
buffer_load_dwordx4 a[24:27], v2, s[40:43], s35 offen offset:3072 sc1
v_mfma_f32_16x16x32_bf16 v[204:207], a[140:143], a[60:63], v[204:207]
ds_read_b128 a[116:119], v5 offset:47104
v_fma_f32 v118, -v88, v88, v118
v_mfma_f32_16x16x32_bf16 v[204:207], a[136:139], a[56:59], v[204:207]
v_max_f32 v94, 0, v94
v_max_f32 v102, 0, v102
v_mfma_f32_16x16x32_bf16 v[208:211], a[144:147], a[56:59], v[208:211]
v_max_f32 v110, 0, v110
v_max_f32 v118, 0, v118
v_mfma_f32_16x16x32_bf16 v[208:211], a[148:151], a[60:63], v[208:211]
buffer_load_dwordx4 v1, s[4:7], s44 offen offset:1024 sc1 lds
s_add_u32 m0, s19, 49152
v_mfma_f32_16x16x32_bf16 v[184:187], a[148:151], a[52:55], v[184:187]
s_add_u32 s44, s85, 0x1a04000
v_add_f32 v94, 0x3727c5ac, v94
v_mfma_f32_16x16x32_bf16 v[184:187], a[144:147], a[48:51], v[184:187]
v_add_f32 v102, 0x3727c5ac, v102
v_add_f32 v110, 0x3727c5ac, v110
v_mfma_f32_16x16x32_bf16 v[160:163], a[144:147], a[40:43], v[160:163]
v_add_f32 v118, 0x3727c5ac, v118
v_mfma_f32_16x16x32_bf16 v[160:163], a[148:151], a[44:47], v[160:163]
buffer_load_dwordx4 a[28:31], v2, s[40:43], s33 offen offset:3072 sc1
s_add_u32 s35, s35, 0x2000
v_mfma_f32_16x16x32_bf16 v[136:139], a[148:151], a[36:39], v[136:139]
s_add_u32 s33, s33, 0x2000
v_mfma_f32_16x16x32_bf16 v[136:139], a[144:147], a[32:35], v[136:139]
s_waitcnt vmcnt(12) lgkmcnt(0)
v_mfma_f32_16x16x32_bf16 v[140:143], a[96:99], a[64:67], v[140:143]
ds_read_b128 a[128:131], v5 offset:41984
v_mfma_f32_16x16x32_bf16 v[140:143], a[100:103], a[68:71], v[140:143]
buffer_load_dwordx4 a[32:35], v2, s[40:43], s35 offen offset:0 sc1
v_mfma_f32_16x16x32_bf16 v[164:167], a[100:103], a[76:79], v[164:167]
ds_read_b128 a[132:135], v5 offset:48128
v_mfma_f32_16x16x32_bf16 v[164:167], a[96:99], a[72:75], v[164:167]
v_rsq_f32 v83, v94
v_mfma_f32_16x16x32_bf16 v[188:191], a[96:99], a[80:83], v[188:191]
v_rsq_f32 v85, v102
v_mfma_f32_16x16x32_bf16 v[188:191], a[100:103], a[84:87], v[188:191]
buffer_load_dwordx4 v1, s[4:7], s44 offen offset:0 sc1 lds
v_mfma_f32_16x16x32_bf16 v[212:215], a[100:103], a[92:95], v[212:215]
ds_read_b128 a[136:139], v5 offset:36864
v_mfma_f32_16x16x32_bf16 v[212:215], a[96:99], a[88:91], v[212:215]
v_rsq_f32 v87, v110
v_rsq_f32 v89, v118
v_mfma_f32_16x16x32_bf16 v[216:219], a[104:107], a[88:91], v[216:219]
ds_read_b128 a[140:143], v5 offset:43008
v_mfma_f32_16x16x32_bf16 v[216:219], a[108:111], a[92:95], v[216:219]
buffer_load_dwordx4 a[36:39], v2, s[40:43], s33 offen offset:0 sc1
v_mfma_f32_16x16x32_bf16 v[192:195], a[108:111], a[84:87], v[192:195]
ds_read_b128 a[144:147], v5 offset:37888
v_fmac_f32 v140, v56, v82
v_mfma_f32_16x16x32_bf16 v[192:195], a[104:107], a[80:83], v[192:195]
v_mfma_f32_16x16x32_bf16 v[168:171], a[104:107], a[72:75], v[168:171]
v_fmac_f32 v164, v56, v84
v_mfma_f32_16x16x32_bf16 v[168:171], a[108:111], a[76:79], v[168:171]
buffer_load_dwordx4 a[40:43], v2, s[40:43], s35 offen offset:1024 sc1
v_mfma_f32_16x16x32_bf16 v[144:147], a[108:111], a[68:71], v[144:147]
ds_read_b128 a[148:151], v5 offset:44032
v_fmac_f32 v188, v56, v86
v_mfma_f32_16x16x32_bf16 v[144:147], a[104:107], a[64:67], v[144:147]
v_mfma_f32_16x16x32_bf16 v[148:151], a[112:115], a[64:67], v[148:151]
v_fmac_f32 v212, v56, v88
v_mfma_f32_16x16x32_bf16 v[148:151], a[116:119], a[68:71], v[148:151]
buffer_load_dwordx4 v1, s[4:7], s44 offen offset:1024 sc1 lds
v_mfma_f32_16x16x32_bf16 v[172:175], a[116:119], a[76:79], v[172:175]
v_fmac_f32 v216, v60, v88
v_mfma_f32_16x16x32_bf16 v[172:175], a[112:115], a[72:75], v[172:175]
v_mfma_f32_16x16x32_bf16 v[196:199], a[112:115], a[80:83], v[196:199]
v_fmac_f32 v192, v60, v86
v_mfma_f32_16x16x32_bf16 v[196:199], a[116:119], a[84:87], v[196:199]
buffer_load_dwordx4 a[44:47], v2, s[40:43], s33 offen offset:1024 sc1
v_mfma_f32_16x16x32_bf16 v[220:223], a[116:119], a[92:95], v[220:223]
v_fmac_f32 v168, v60, v84
v_fmac_f32 v141, v57, v82
v_mfma_f32_16x16x32_bf16 v[220:223], a[112:115], a[88:91], v[220:223]
s_waitcnt lgkmcnt(0)
s_barrier
v_mfma_f32_16x16x32_bf16 v[224:227], a[128:131], a[88:91], v[224:227]
v_add_u32 v5, 0, v1
v_fmac_f32 v144, v60, v82
v_mfma_f32_16x16x32_bf16 v[224:227], a[132:135], a[92:95], v[224:227]
buffer_load_dwordx4 a[48:51], v2, s[40:43], s35 offen offset:2048 sc1
v_mfma_f32_16x16x32_bf16 v[200:203], a[132:135], a[84:87], v[200:203]
ds_read_b128 a[96:99], v5 offset:2048
v_fmac_f32 v148, v64, v82
v_mfma_f32_16x16x32_bf16 v[200:203], a[128:131], a[80:83], v[200:203]
ds_read_b128 a[100:103], v5 offset:8192
v_fmac_f32 v165, v57, v84
v_mfma_f32_16x16x32_bf16 v[176:179], a[128:131], a[72:75], v[176:179]
v_fmac_f32 v172, v64, v84
v_fmac_f32 v189, v57, v86
v_mfma_f32_16x16x32_bf16 v[176:179], a[132:135], a[76:79], v[176:179]
buffer_load_dwordx4 v1, s[4:7], s44 offen offset:2048 sc1 lds
v_mfma_f32_16x16x32_bf16 v[152:155], a[132:135], a[68:71], v[152:155]
ds_read_b128 a[104:107], v5 offset:3072
v_fmac_f32 v196, v64, v86
v_mfma_f32_16x16x32_bf16 v[152:155], a[128:131], a[64:67], v[152:155]
v_fmac_f32 v213, v57, v88
v_fmac_f32 v217, v61, v88
v_mfma_f32_16x16x32_bf16 v[132:135], a[136:139], a[64:67], v[132:135]
ds_read_b128 a[108:111], v5 offset:9216
v_fmac_f32 v220, v64, v88
v_mfma_f32_16x16x32_bf16 v[132:135], a[140:143], a[68:71], v[132:135]
buffer_load_dwordx4 a[52:55], v2, s[40:43], s33 offen offset:2048 sc1
v_mfma_f32_16x16x32_bf16 v[156:159], a[140:143], a[76:79], v[156:159]
ds_read_b128 a[112:115], v5 offset:4096
v_fmac_f32 v224, v68, v88
v_mfma_f32_16x16x32_bf16 v[156:159], a[136:139], a[72:75], v[156:159]
v_fmac_f32 v193, v61, v86
v_fmac_f32 v169, v61, v84
v_mfma_f32_16x16x32_bf16 v[180:183], a[136:139], a[80:83], v[180:183]
v_fmac_f32 v200, v68, v86
v_fmac_f32 v145, v61, v82
v_mfma_f32_16x16x32_bf16 v[180:183], a[140:143], a[84:87], v[180:183]
buffer_load_dwordx4 a[56:59], v2, s[40:43], s35 offen offset:3072 sc1
v_mfma_f32_16x16x32_bf16 v[204:207], a[140:143], a[92:95], v[204:207]
ds_read_b128 a[116:119], v5 offset:10240
v_fmac_f32 v176, v68, v84
v_mfma_f32_16x16x32_bf16 v[204:207], a[136:139], a[88:91], v[204:207]
v_fmac_f32 v149, v65, v82
v_mfma_f32_16x16x32_bf16 v[208:211], a[144:147], a[88:91], v[208:211]
v_fmac_f32 v152, v68, v82
v_fmac_f32 v173, v65, v84
v_mfma_f32_16x16x32_bf16 v[208:211], a[148:151], a[92:95], v[208:211]
buffer_load_dwordx4 v1, s[4:7], s44 offen offset:3072 sc1 lds
s_add_u32 m0, s19, 65536
v_mfma_f32_16x16x32_bf16 v[184:187], a[148:151], a[84:87], v[184:187]
s_add_u32 s44, s84, 0x1a08000
v_fmac_f32 v132, v48, v82
v_mfma_f32_16x16x32_bf16 v[184:187], a[144:147], a[80:83], v[184:187]
v_fmac_f32 v197, v65, v86
v_mfma_f32_16x16x32_bf16 v[160:163], a[144:147], a[72:75], v[160:163]
v_fmac_f32 v156, v48, v84
v_fmac_f32 v221, v65, v88
v_mfma_f32_16x16x32_bf16 v[160:163], a[148:151], a[76:79], v[160:163]
buffer_load_dwordx4 a[60:63], v2, s[40:43], s33 offen offset:3072 sc1
s_add_u32 s35, s35, 0x2000
v_mfma_f32_16x16x32_bf16 v[136:139], a[148:151], a[68:71], v[136:139]
s_add_u32 s33, s33, 0x2000
v_fmac_f32 v180, v48, v86
v_mfma_f32_16x16x32_bf16 v[136:139], a[144:147], a[64:67], v[136:139]
v_fmac_f32 v225, v69, v88
s_waitcnt vmcnt(12) lgkmcnt(0)
v_mfma_f32_16x16x32_bf16 v[140:143], a[96:99], a[0:3], v[140:143]
ds_read_b128 a[128:131], v5 offset:5120
v_fmac_f32 v204, v48, v88
v_mfma_f32_16x16x32_bf16 v[140:143], a[100:103], a[4:7], v[140:143]
buffer_load_dwordx4 a[64:67], v2, s[40:43], s35 offen offset:0 sc1
s_lshl_b32 s37, s28, 10
v_mfma_f32_16x16x32_bf16 v[164:167], a[100:103], a[12:15], v[164:167]
ds_read_b128 a[132:135], v5 offset:11264
v_fmac_f32 v208, v52, v88
v_mfma_f32_16x16x32_bf16 v[164:167], a[96:99], a[8:11], v[164:167]
v_fmac_f32 v201, v69, v86
v_fmac_f32 v177, v69, v84
v_mfma_f32_16x16x32_bf16 v[188:191], a[96:99], a[16:19], v[188:191]
v_fmac_f32 v184, v52, v86
v_fmac_f32 v153, v69, v82
v_mfma_f32_16x16x32_bf16 v[188:191], a[100:103], a[20:23], v[188:191]
buffer_load_dwordx4 a[68:71], v2, s[40:43], s33 offen offset:0 sc1
s_lshr_b32 s79, s30, 1
v_mfma_f32_16x16x32_bf16 v[212:215], a[100:103], a[28:31], v[212:215]
ds_read_b128 a[136:139], v5 offset:0
v_fmac_f32 v160, v52, v84
v_mfma_f32_16x16x32_bf16 v[212:215], a[96:99], a[24:27], v[212:215]
v_fmac_f32 v133, v49, v82
s_lshr_b32 s36, s79, 3
v_mfma_f32_16x16x32_bf16 v[216:219], a[104:107], a[24:27], v[216:219]
ds_read_b128 a[140:143], v5 offset:6144
v_fmac_f32 v136, v52, v82
v_mfma_f32_16x16x32_bf16 v[216:219], a[108:111], a[28:31], v[216:219]
buffer_load_dwordx4 a[72:75], v2, s[40:43], s35 offen offset:1024 sc1
s_and_b32 s79, s79, 7
v_mfma_f32_16x16x32_bf16 v[192:195], a[108:111], a[20:23], v[192:195]
ds_read_b128 a[144:147], v5 offset:1024
v_fmac_f32 v157, v49, v84
v_mfma_f32_16x16x32_bf16 v[192:195], a[104:107], a[16:19], v[192:195]
v_fmac_f32 v181, v49, v86
v_fmac_f32 v142, v58, v82
v_mfma_f32_16x16x32_bf16 v[168:171], a[104:107], a[8:11], v[168:171]
v_fmac_f32 v205, v49, v88
v_fmac_f32 v166, v58, v84
v_mfma_f32_16x16x32_bf16 v[168:171], a[108:111], a[12:15], v[168:171]
buffer_load_dwordx4 a[76:79], v2, s[40:43], s33 offen offset:1024 sc1
s_mul_i32 s36, s36, 524288
v_mfma_f32_16x16x32_bf16 v[144:147], a[108:111], a[4:7], v[144:147]
ds_read_b128 a[148:151], v5 offset:7168
v_fmac_f32 v209, v53, v88
v_mfma_f32_16x16x32_bf16 v[144:147], a[104:107], a[0:3], v[144:147]
v_fmac_f32 v190, v58, v86
s_lshl_b32 s79, s79, 14
v_mfma_f32_16x16x32_bf16 v[148:151], a[112:115], a[0:3], v[148:151]
v_fmac_f32 v185, v53, v86
v_fmac_f32 v214, v58, v88
v_mfma_f32_16x16x32_bf16 v[148:151], a[116:119], a[4:7], v[148:151]
buffer_load_dwordx4 a[80:83], v2, s[40:43], s35 offen offset:2048 sc1
s_add_u32 s79, s79, s36
v_mfma_f32_16x16x32_bf16 v[172:175], a[116:119], a[12:15], v[172:175]
v_fmac_f32 v161, v53, v84
v_fmac_f32 v218, v62, v88
v_mfma_f32_16x16x32_bf16 v[172:175], a[112:115], a[8:11], v[172:175]
s_and_b32 s36, s30, 1
s_lshl_b32 s36, s36, 12
s_add_u32 s79, s79, s36
v_mfma_f32_16x16x32_bf16 v[196:199], a[112:115], a[16:19], v[196:199]
v_fmac_f32 v137, v53, v82
v_fmac_f32 v194, v62, v86
v_mfma_f32_16x16x32_bf16 v[196:199], a[116:119], a[20:23], v[196:199]
buffer_load_dwordx4 a[84:87], v2, s[40:43], s33 offen offset:2048 sc1
s_lshr_b32 s39, s29, 2
v_mfma_f32_16x16x32_bf16 v[220:223], a[116:119], a[28:31], v[220:223]
v_fmac_f32 v170, v62, v84
v_fmac_f32 v143, v59, v82
v_mfma_f32_16x16x32_bf16 v[220:223], a[112:115], a[24:27], v[220:223]
s_mul_i32 s39, s39, 0xffff
s_waitcnt lgkmcnt(0)
v_mfma_f32_16x16x32_bf16 v[224:227], a[128:131], a[24:27], v[224:227]
ds_read_b128 a[96:99], v5 offset:14336
v_fmac_f32 v146, v62, v82
v_mfma_f32_16x16x32_bf16 v[224:227], a[132:135], a[28:31], v[224:227]
buffer_load_dwordx4 a[88:91], v2, s[40:43], s35 offen offset:3072 sc1
s_xor_b32 s39, s39, s51
v_mfma_f32_16x16x32_bf16 v[200:203], a[132:135], a[20:23], v[200:203]
ds_read_b128 a[100:103], v5 offset:20480
v_fmac_f32 v150, v66, v82
v_mfma_f32_16x16x32_bf16 v[200:203], a[128:131], a[16:19], v[200:203]
v_fmac_f32 v167, v59, v84
v_fmac_f32 v191, v59, v86
v_mfma_f32_16x16x32_bf16 v[176:179], a[128:131], a[8:11], v[176:179]
buffer_load_dwordx4 v1, s[4:7], s44 offen offset:0 sc1 lds
s_and_b32 s36, s29, 2
v_mfma_f32_16x16x32_bf16 v[176:179], a[132:135], a[12:15], v[176:179]
ds_read_b128 a[104:107], v5 offset:15360
v_fmac_f32 v174, v66, v84
v_mfma_f32_16x16x32_bf16 v[152:155], a[132:135], a[4:7], v[152:155]
v_fmac_f32 v198, v66, v86
v_fmac_f32 v215, v59, v88
v_mfma_f32_16x16x32_bf16 v[152:155], a[128:131], a[0:3], v[152:155]
buffer_load_dwordx4 v1, s[4:7], s44 offen offset:1024 sc1 lds
s_lshl_b32 s36, s36, 2
v_mfma_f32_16x16x32_bf16 v[132:135], a[136:139], a[0:3], v[132:135]
ds_read_b128 a[108:111], v5 offset:21504
v_fmac_f32 v222, v66, v88
v_mfma_f32_16x16x32_bf16 v[132:135], a[140:143], a[4:7], v[132:135]
v_fmac_f32 v219, v63, v88
v_fmac_f32 v195, v63, v86
v_mfma_f32_16x16x32_bf16 v[156:159], a[140:143], a[12:15], v[156:159]
ds_read_b128 a[112:115], v5 offset:16384
v_fmac_f32 v226, v70, v88
v_mfma_f32_16x16x32_bf16 v[156:159], a[136:139], a[8:11], v[156:159]
buffer_load_dwordx4 v1, s[4:7], s44 offen offset:2048 sc1 lds
s_lshr_b32 s36, s39, s36
v_mfma_f32_16x16x32_bf16 v[180:183], a[136:139], a[16:19], v[180:183]
v_fmac_f32 v202, v70, v86
v_fmac_f32 v171, v63, v84
v_mfma_f32_16x16x32_bf16 v[180:183], a[140:143], a[20:23], v[180:183]
ds_read_b128 a[116:119], v5 offset:22528
v_fmac_f32 v147, v63, v82
v_mfma_f32_16x16x32_bf16 v[204:207], a[140:143], a[28:31], v[204:207]
buffer_load_dwordx4 a[92:95], v2, s[40:43], s33 offen offset:3072 sc1
s_add_u32 s35, s35, 0x2000
v_mfma_f32_16x16x32_bf16 v[204:207], a[136:139], a[24:27], v[204:207]
s_add_u32 s33, s33, 0x2000
v_fmac_f32 v178, v70, v84
v_mfma_f32_16x16x32_bf16 v[208:211], a[144:147], a[24:27], v[208:211]
v_fmac_f32 v154, v70, v82
v_fmac_f32 v151, v67, v82
v_mfma_f32_16x16x32_bf16 v[208:211], a[148:151], a[28:31], v[208:211]
v_fmac_f32 v175, v67, v84
s_bfe_u32 s68, s36, 0x10001
v_mfma_f32_16x16x32_bf16 v[184:187], a[148:151], a[20:23], v[184:187]
buffer_load_dwordx4 v1, s[4:7], s44 offen offset:3072 sc1 lds
s_add_u32 m0, s19, 81920
v_mfma_f32_16x16x32_bf16 v[184:187], a[144:147], a[16:19], v[184:187]
s_add_u32 s44, s85, 0x1a0c000
v_fmac_f32 v134, v50, v82
v_mfma_f32_16x16x32_bf16 v[160:163], a[144:147], a[8:11], v[160:163]
v_fmac_f32 v158, v50, v84
v_fmac_f32 v199, v67, v86
v_mfma_f32_16x16x32_bf16 v[160:163], a[148:151], a[12:15], v[160:163]
buffer_load_dwordx4 v1, s[4:7], s44 offen offset:0 sc1 lds
s_lshl_b32 s68, s68, 13
v_mfma_f32_16x16x32_bf16 v[136:139], a[148:151], a[4:7], v[136:139]
v_fmac_f32 v182, v50, v86
v_fmac_f32 v223, v67, v88
v_mfma_f32_16x16x32_bf16 v[136:139], a[144:147], a[0:3], v[136:139]
s_waitcnt vmcnt(13) lgkmcnt(0)
s_barrier
v_mfma_f32_16x16x32_bf16 v[140:143], a[96:99], a[32:35], v[140:143]
ds_read_b128 a[128:131], v5 offset:17408
v_fmac_f32 v206, v50, v88
v_mfma_f32_16x16x32_bf16 v[140:143], a[100:103], a[36:39], v[140:143]
buffer_load_dwordx4 a[0:3], v2, s[40:43], s35 offen offset:0 sc1
s_bfe_u32 s10, s36, 0x10004
v_mfma_f32_16x16x32_bf16 v[164:167], a[100:103], a[44:47], v[164:167]
ds_read_b128 a[132:135], v5 offset:23552
v_fmac_f32 v210, v54, v88
v_mfma_f32_16x16x32_bf16 v[164:167], a[96:99], a[40:43], v[164:167]
v_fmac_f32 v227, v71, v88
v_fmac_f32 v203, v71, v86
v_mfma_f32_16x16x32_bf16 v[188:191], a[96:99], a[48:51], v[188:191]
buffer_load_dwordx4 a[4:7], v2, s[40:43], s33 offen offset:0 sc1
s_lshl_b32 s10, s10, 13
v_mfma_f32_16x16x32_bf16 v[188:191], a[100:103], a[52:55], v[188:191]
ds_read_b128 a[136:139], v5 offset:26624
v_fmac_f32 v186, v54, v86
v_mfma_f32_16x16x32_bf16 v[212:215], a[100:103], a[60:63], v[212:215]
v_fmac_f32 v162, v54, v84
v_fmac_f32 v179, v71, v84
v_mfma_f32_16x16x32_bf16 v[212:215], a[96:99], a[56:59], v[212:215]
buffer_load_dwordx4 a[8:11], v2, s[40:43], s35 offen offset:1024 sc1
s_bfe_u32 s75, s36, 0x10002
v_mfma_f32_16x16x32_bf16 v[216:219], a[104:107], a[56:59], v[216:219]
ds_read_b128 a[140:143], v5 offset:32768
v_fmac_f32 v138, v54, v82
v_mfma_f32_16x16x32_bf16 v[216:219], a[108:111], a[60:63], v[216:219]
v_fmac_f32 v155, v71, v82
v_fmac_f32 v135, v51, v82
v_mfma_f32_16x16x32_bf16 v[192:195], a[108:111], a[52:55], v[192:195]
buffer_load_dwordx4 a[12:15], v2, s[40:43], s33 offen offset:1024 sc1
s_lshl_b32 s75, s75, 13
v_mfma_f32_16x16x32_bf16 v[192:195], a[104:107], a[48:51], v[192:195]
ds_read_b128 a[144:147], v5 offset:27648
v_fmac_f32 v159, v51, v84
v_mfma_f32_16x16x32_bf16 v[168:171], a[104:107], a[40:43], v[168:171]
v_fmac_f32 v183, v51, v86
v_fmac_f32 v207, v51, v88
v_mfma_f32_16x16x32_bf16 v[168:171], a[108:111], a[44:47], v[168:171]
buffer_load_dwordx4 a[16:19], v2, s[40:43], s35 offen offset:2048 sc1
s_bfe_u32 s76, s36, 0x10003
v_mfma_f32_16x16x32_bf16 v[144:147], a[108:111], a[36:39], v[144:147]
ds_read_b128 a[148:151], v5 offset:33792
v_fmac_f32 v211, v55, v88
v_mfma_f32_16x16x32_bf16 v[144:147], a[104:107], a[32:35], v[144:147]
s_lshl_b32 s76, s76, 13
s_add_u32 s75, s75, s79
s_add_u32 s76, s76, s79
v_mfma_f32_16x16x32_bf16 v[148:151], a[112:115], a[32:35], v[148:151]
buffer_load_dwordx4 a[20:23], v2, s[40:43], s33 offen offset:2048 sc1
s_and_b32 s36, s31, 4
v_mfma_f32_16x16x32_bf16 v[148:151], a[116:119], a[36:39], v[148:151]
v_fmac_f32 v187, v55, v86
s_lshl_b32 s36, s36, 1
v_mfma_f32_16x16x32_bf16 v[172:175], a[116:119], a[44:47], v[172:175]
v_fmac_f32 v163, v55, v84
s_lshr_b32 s36, s39, s36
v_mfma_f32_16x16x32_bf16 v[172:175], a[112:115], a[40:43], v[172:175]
buffer_load_dwordx4 a[24:27], v2, s[40:43], s35 offen offset:3072 sc1
s_bfe_u32 s69, s36, 0x10001
v_mfma_f32_16x16x32_bf16 v[196:199], a[112:115], a[48:51], v[196:199]
v_fmac_f32 v139, v55, v82
s_lshl_b32 s69, s69, 13
v_mfma_f32_16x16x32_bf16 v[196:199], a[116:119], a[52:55], v[196:199]
s_bfe_u32 s45, s36, 0x10004
s_lshl_b32 s45, s45, 13
s_bfe_u32 s77, s36, 0x10002
v_mfma_f32_16x16x32_bf16 v[220:223], a[116:119], a[60:63], v[220:223]
buffer_load_dwordx4 a[28:31], v2, s[40:43], s33 offen offset:3072 sc1
s_add_u32 s35, s35, 0x2000
v_mfma_f32_16x16x32_bf16 v[220:223], a[112:115], a[56:59], v[220:223]
s_add_u32 s33, s33, 0x2000
s_waitcnt lgkmcnt(0)
v_mfma_f32_16x16x32_bf16 v[224:227], a[128:131], a[56:59], v[224:227]
ds_read_b128 a[96:99], v5 offset:28672
s_lshl_b32 s77, s77, 13
v_mfma_f32_16x16x32_bf16 v[224:227], a[132:135], a[60:63], v[224:227]
buffer_load_dwordx4 v1, s[4:7], s44 offen offset:1024 sc1 lds
s_bfe_u32 s9, s36, 0x10003
v_mfma_f32_16x16x32_bf16 v[200:203], a[132:135], a[52:55], v[200:203]
ds_read_b128 a[100:103], v5 offset:34816
s_lshl_b32 s9, s9, 13
v_mfma_f32_16x16x32_bf16 v[200:203], a[128:131], a[48:51], v[200:203]
s_lshr_b32 s38, s32, 3
s_and_b32 s36, s32, 7
s_mul_i32 s38, s38, 524288
v_mfma_f32_16x16x32_bf16 v[176:179], a[128:131], a[40:43], v[176:179]
s_lshl_b32 s36, s36, 14
s_add_u32 s36, s36, s38
s_add_u32 s45, s45, s36
v_mfma_f32_16x16x32_bf16 v[176:179], a[132:135], a[44:47], v[176:179]
ds_read_b128 a[104:107], v5 offset:29696
s_add_u32 s69, s69, s36
v_mfma_f32_16x16x32_bf16 v[152:155], a[132:135], a[36:39], v[152:155]
s_bfe_u32 s79, s39, 0x10008
s_lshl_b32 s79, s79, 13
s_xor_b32 s38, s29, s39
v_mfma_f32_16x16x32_bf16 v[152:155], a[128:131], a[32:35], v[152:155]
s_and_b32 s38, s38, 1
s_mul_i32 s38, s38, 0x102000
s_add_u32 s71, s71, s38
s_waitcnt vmcnt(21)
v_mfma_f32_16x16x32_bf16 v[140:143], a[136:139], a[64:67], v[140:143]
ds_read_b128 a[108:111], v5 offset:35840
s_add_u32 s34, s67, s38
s_waitcnt vmcnt(20)
v_mfma_f32_16x16x32_bf16 v[140:143], a[140:143], a[68:71], v[140:143]
buffer_load_dwordx4 v1, s[4:7], s44 offen offset:2048 sc1 lds
s_lshr_b32 s38, s31, 1
s_waitcnt vmcnt(19)
v_mfma_f32_16x16x32_bf16 v[164:167], a[140:143], a[76:79], v[164:167]
ds_read_b128 a[112:115], v5 offset:38912
s_xor_b32 s38, s38, s39
v_mfma_f32_16x16x32_bf16 v[164:167], a[136:139], a[72:75], v[164:167]
s_and_b32 s38, s38, 1
s_mul_i32 s38, s38, 0x102000
s_add_u32 s78, s78, s38
s_waitcnt vmcnt(18)
v_mfma_f32_16x16x32_bf16 v[188:191], a[136:139], a[80:83], v[188:191]
s_add_u32 s11, s66, s38
s_lshl_b32 s38, s31, 1
s_lshr_b32 s90, s28, 1
s_waitcnt vmcnt(17)
v_mfma_f32_16x16x32_bf16 v[188:191], a[140:143], a[84:87], v[188:191]
ds_read_b128 a[116:119], v5 offset:45056
s_add_u32 s38, s38, s90
s_waitcnt vmcnt(12)
v_mfma_f32_16x16x32_bf16 v[212:215], a[140:143], a[92:95], v[212:215]
s_lshl_b32 s90, s38, 13
s_sub_u32 s91, s79, s90
s_and_b32 s38, s38, 15
v_mfma_f32_16x16x32_bf16 v[212:215], a[136:139], a[88:91], v[212:215]
s_lshl_b32 s90, s38, 14
s_add_u32 s91, s91, s90
s_and_b32 s90, s38, 12
v_mfma_f32_16x16x32_bf16 v[216:219], a[144:147], a[88:91], v[216:219]
s_add_u32 s38, s38, s90
s_lshl_b32 s38, s38, 17
s_and_b32 s90, s18, 0x800
v_mfma_f32_16x16x32_bf16 v[216:219], a[148:151], a[92:95], v[216:219]
buffer_load_dwordx4 v1, s[4:7], s44 offen offset:3072 sc1 lds
s_add_u32 s38, s38, s90
v_mfma_f32_16x16x32_bf16 v[192:195], a[148:151], a[84:87], v[192:195]
s_lshl_b32 s39, s81, 2
s_add_u32 s39, s39, s28
s_lshl_b32 s82, s39, 14
v_mfma_f32_16x16x32_bf16 v[192:195], a[144:147], a[80:83], v[192:195]
v_mul_f32 v88, 0x3e8293ee, v89
s_add_u32 s82, s82, s79
v_mfma_f32_16x16x32_bf16 v[168:171], a[144:147], a[72:75], v[168:171]
s_and_b32 s90, s39, 12
s_add_u32 s39, s39, s90
s_lshl_b32 s39, s39, 17
v_mfma_f32_16x16x32_bf16 v[168:171], a[148:151], a[76:79], v[168:171]
s_add_u32 s72, s75, 0x800000
s_add_u32 s63, s83, 0x1780000
s_sub_u32 s55, s63, 65536
v_mfma_f32_16x16x32_bf16 v[144:147], a[148:151], a[68:71], v[144:147]
s_bfe_u32 s36, s83, 0x5000d
s_lshl_b32 s36, s36, 14
s_and_b32 s83, s83, 0x1800
v_mfma_f32_16x16x32_bf16 v[144:147], a[144:147], a[64:67], v[144:147]
s_add_u32 s83, s83, s36
s_waitcnt lgkmcnt(0)
v_mfma_f32_16x16x32_bf16 v[148:151], a[96:99], a[64:67], v[148:151]
ds_read_b128 a[128:131], v5 offset:39936
s_add_u32 s83, s83, s79
v_mfma_f32_16x16x32_bf16 v[148:151], a[100:103], a[68:71], v[148:151]
buffer_store_dwordx4 a[220:223], v1, s[4:7], s101 offen offset:0 sc1
v_mfma_f32_16x16x32_bf16 v[172:175], a[100:103], a[76:79], v[172:175]
ds_read_b128 a[132:135], v5 offset:46080
v_add_u32 v233, s37, v1
v_mfma_f32_16x16x32_bf16 v[172:175], a[96:99], a[72:75], v[172:175]
v_add_u32 v232, s19, v7
v_mul_f32 v86, 0x3e8293ee, v87
v_mfma_f32_16x16x32_bf16 v[196:199], a[96:99], a[80:83], v[196:199]
v_mul_f32 v84, 0x3e8293ee, v85
v_mul_f32 v82, 0x3e8293ee, v83
v_mfma_f32_16x16x32_bf16 v[196:199], a[100:103], a[84:87], v[196:199]
ds_read_b128 a[136:139], v5 offset:40960
v_add_u32 v248, s19, v8
v_mfma_f32_16x16x32_bf16 v[220:223], a[100:103], a[92:95], v[220:223]
v_add_u32 v253, s91, v253
v_add_u32 v4, s38, v1
v_mfma_f32_16x16x32_bf16 v[220:223], a[96:99], a[88:91], v[220:223]
v_add_u32 v2, s39, v1
v_mfma_f32_16x16x32_bf16 v[224:227], a[104:107], a[88:91], v[224:227]
ds_read_b128 a[140:143], v5 offset:47104
v_mfma_f32_16x16x32_bf16 v[224:227], a[108:111], a[92:95], v[224:227]
buffer_store_dwordx4 a[224:227], v1, s[4:7], s101 offen offset:1024 sc1
s_add_u32 s16, s97, 0
v_mfma_f32_16x16x32_bf16 v[200:203], a[108:111], a[84:87], v[200:203]
s_add_u32 s16, s16, s96
ds_read_b128 a[144:147], v5 offset:41984
v_mfma_f32_16x16x32_bf16 v[200:203], a[104:107], a[80:83], v[200:203]
v_mfma_f32_16x16x32_bf16 v[176:179], a[104:107], a[72:75], v[176:179]
v_mfma_f32_16x16x32_bf16 v[176:179], a[108:111], a[76:79], v[176:179]
ds_read_b128 a[148:151], v5 offset:48128
v_mfma_f32_16x16x32_bf16 v[152:155], a[108:111], a[68:71], v[152:155]
v_mfma_f32_16x16x32_bf16 v[152:155], a[104:107], a[64:67], v[152:155]
s_waitcnt vmcnt(12)
v_mfma_f32_16x16x32_bf16 v[140:143], a[112:115], a[0:3], v[140:143]
s_waitcnt vmcnt(11)
v_mfma_f32_16x16x32_bf16 v[140:143], a[116:119], a[4:7], v[140:143]
buffer_store_dwordx4 a[188:191], v1, s[4:7], s16 offen sc1
s_add_u32 s16, s97, 6144
s_waitcnt vmcnt(10)
v_mfma_f32_16x16x32_bf16 v[164:167], a[116:119], a[12:15], v[164:167]
s_add_u32 s16, s16, s96
v_mfma_f32_16x16x32_bf16 v[164:167], a[112:115], a[8:11], v[164:167]
L_stub2:
s_cbranch_execz L_wret0
s_waitcnt vmcnt(9)
v_mfma_f32_16x16x32_bf16 v[188:191], a[112:115], a[16:19], v[188:191]
s_waitcnt vmcnt(8)
v_mfma_f32_16x16x32_bf16 v[188:191], a[116:119], a[20:23], v[188:191]
s_waitcnt vmcnt(6)
v_mfma_f32_16x16x32_bf16 v[212:215], a[116:119], a[28:31], v[212:215]
v_mfma_f32_16x16x32_bf16 v[212:215], a[112:115], a[24:27], v[212:215]
s_waitcnt lgkmcnt(0)
v_mfma_f32_16x16x32_bf16 v[216:219], a[128:131], a[24:27], v[216:219]
ds_read_b128 a[96:99], v5 offset:12288
v_mul_f32 v140, v140, v83
v_mfma_f32_16x16x32_bf16 v[216:219], a[132:135], a[28:31], v[216:219]
buffer_store_dwordx4 a[192:195], v1, s[4:7], s16 offen sc1
s_add_u32 s16, s97, 1024
v_mfma_f32_16x16x32_bf16 v[192:195], a[132:135], a[20:23], v[192:195]
s_add_u32 s16, s16, s96
ds_read_b128 a[100:103], v5 offset:18432
v_mfma_f32_16x16x32_bf16 v[192:195], a[128:131], a[16:19], v[192:195]
v_mul_f32 v141, v141, v83
v_cvt_pk_bf16_f32 v140, v140, v141
v_mfma_f32_16x16x32_bf16 v[168:171], a[128:131], a[8:11], v[168:171]
v_mul_f32 v188, v188, v87
v_mul_f32 v189, v189, v87
v_mfma_f32_16x16x32_bf16 v[168:171], a[132:135], a[12:15], v[168:171]
ds_read_b128 a[104:107], v5 offset:24576
v_cvt_pk_bf16_f32 v188, v188, v189
v_mfma_f32_16x16x32_bf16 v[144:147], a[132:135], a[4:7], v[144:147]
v_mul_f32 v212, v212, v89
v_mul_f32 v213, v213, v89
v_mfma_f32_16x16x32_bf16 v[144:147], a[128:131], a[0:3], v[144:147]
v_mul_f32 v214, v214, v89
v_mul_f32 v215, v215, v89
v_mfma_f32_16x16x32_bf16 v[148:151], a[136:139], a[0:3], v[148:151]
ds_read_b128 a[108:111], v5 offset:30720
v_cvt_pk_bf16_f32 v212, v212, v213
v_mfma_f32_16x16x32_bf16 v[148:151], a[140:143], a[4:7], v[148:151]
buffer_store_dwordx4 a[196:199], v1, s[4:7], s16 offen sc1
s_add_u32 s16, s97, 7168
v_mfma_f32_16x16x32_bf16 v[172:175], a[140:143], a[12:15], v[172:175]
s_add_u32 s16, s16, s96
ds_read_b128 a[112:115], v5 offset:36864
v_mfma_f32_16x16x32_bf16 v[172:175], a[136:139], a[8:11], v[172:175]
v_mul_f32 v216, v216, v89
v_mul_f32 v217, v217, v89
v_mfma_f32_16x16x32_bf16 v[196:199], a[136:139], a[16:19], v[196:199]
v_mul_f32 v218, v218, v89
v_mul_f32 v219, v219, v89
v_mfma_f32_16x16x32_bf16 v[196:199], a[140:143], a[20:23], v[196:199]
ds_read_b128 a[116:119], v5 offset:43008
v_cvt_pk_bf16_f32 v213, v214, v215
v_mfma_f32_16x16x32_bf16 v[220:223], a[140:143], a[28:31], v[220:223]
v_cvt_pk_bf16_f32 v214, v216, v217
v_cvt_pk_bf16_f32 v215, v218, v219
v_mfma_f32_16x16x32_bf16 v[220:223], a[136:139], a[24:27], v[220:223]
v_min_u32 v212, -2, v212
v_min_u32 v213, -2, v213
v_mfma_f32_16x16x32_bf16 v[224:227], a[144:147], a[24:27], v[224:227]
v_min_u32 v214, -2, v214
v_min_u32 v215, -2, v215
v_mfma_f32_16x16x32_bf16 v[224:227], a[148:151], a[28:31], v[224:227]
buffer_store_dwordx4 a[200:203], v1, s[4:7], s16 offen sc1
s_add_u32 s16, s97, 2048
v_mfma_f32_16x16x32_bf16 v[200:203], a[148:151], a[20:23], v[200:203]
s_add_u32 s16, s16, s96
buffer_store_dwordx4 v[212:215], v3, s[4:7], s63 offen offset:0 sc1
v_mfma_f32_16x16x32_bf16 v[200:203], a[144:147], a[16:19], v[200:203]
v_mul_f32 v172, v172, v85
v_mul_f32 v173, v173, v85
v_mfma_f32_16x16x32_bf16 v[176:179], a[144:147], a[8:11], v[176:179]
v_cvt_pk_bf16_f32 v172, v172, v173
v_mul_f32 v196, v196, v87
v_mfma_f32_16x16x32_bf16 v[176:179], a[148:151], a[12:15], v[176:179]
v_mul_f32 v197, v197, v87
v_cvt_pk_bf16_f32 v196, v196, v197
v_mfma_f32_16x16x32_bf16 v[152:155], a[148:151], a[4:7], v[152:155]
v_mul_f32 v220, v220, v89
v_mul_f32 v221, v221, v89
v_mfma_f32_16x16x32_bf16 v[152:155], a[144:147], a[0:3], v[152:155]
v_mul_f32 v222, v222, v89
s_waitcnt lgkmcnt(0)
v_mfma_f32_16x16x32_bf16 v[132:135], a[96:99], a[32:35], v[132:135]
ds_read_b128 a[128:131], v5 offset:13312
v_mul_f32 v223, v223, v89
v_mfma_f32_16x16x32_bf16 v[132:135], a[100:103], a[36:39], v[132:135]
buffer_store_dwordx4 a[204:207], v1, s[4:7], s16 offen sc1
s_add_u32 s16, s97, 8192
v_mfma_f32_16x16x32_bf16 v[156:159], a[100:103], a[44:47], v[156:159]
s_add_u32 s16, s16, s96
ds_read_b128 a[132:135], v5 offset:19456
v_mfma_f32_16x16x32_bf16 v[156:159], a[96:99], a[40:43], v[156:159]
v_cvt_pk_bf16_f32 v220, v220, v221
v_mul_f32 v224, v224, v89
v_mfma_f32_16x16x32_bf16 v[180:183], a[96:99], a[48:51], v[180:183]
v_mul_f32 v225, v225, v89
v_mul_f32 v226, v226, v89
v_mfma_f32_16x16x32_bf16 v[180:183], a[100:103], a[52:55], v[180:183]
ds_read_b128 a[136:139], v5 offset:25600
v_mul_f32 v227, v227, v89
v_mfma_f32_16x16x32_bf16 v[204:207], a[100:103], a[60:63], v[204:207]
v_cvt_pk_bf16_f32 v221, v222, v223
v_cvt_pk_bf16_f32 v222, v224, v225
v_mfma_f32_16x16x32_bf16 v[204:207], a[96:99], a[56:59], v[204:207]
v_cvt_pk_bf16_f32 v223, v226, v227
v_min_u32 v220, -2, v220
v_mfma_f32_16x16x32_bf16 v[204:207], a[104:107], a[88:91], v[204:207]
ds_read_b128 a[140:143], v5 offset:31744
v_min_u32 v221, -2, v221
v_mfma_f32_16x16x32_bf16 v[204:207], a[108:111], a[92:95], v[204:207]
buffer_store_dwordx4 a[208:211], v1, s[4:7], s16 offen sc1
v_mfma_f32_16x16x32_bf16 v[180:183], a[108:111], a[84:87], v[180:183]
ds_read_b128 a[144:147], v5 offset:37888
v_min_u32 v222, -2, v222
v_mfma_f32_16x16x32_bf16 v[180:183], a[104:107], a[80:83], v[180:183]
v_min_u32 v223, -2, v223
v_mul_f32 v198, v198, v87
v_mfma_f32_16x16x32_bf16 v[156:159], a[104:107], a[72:75], v[156:159]
buffer_store_dwordx4 v[220:223], v3, s[4:7], s63 offen offset:1024 sc1
v_mfma_f32_16x16x32_bf16 v[156:159], a[108:111], a[76:79], v[156:159]
ds_read_b128 a[148:151], v5 offset:44032
v_mul_f32 v199, v199, v87
v_mfma_f32_16x16x32_bf16 v[132:135], a[108:111], a[68:71], v[132:135]
v_cvt_pk_bf16_f32 v197, v198, v199
v_mul_f32 v200, v200, v87
v_mfma_f32_16x16x32_bf16 v[132:135], a[104:107], a[64:67], v[132:135]
v_mul_f32 v201, v201, v87
v_cvt_pk_bf16_f32 v198, v200, v201
v_mfma_f32_16x16x32_bf16 v[132:135], a[112:115], a[0:3], v[132:135]
v_mul_f32 v202, v202, v87
v_mul_f32 v203, v203, v87
v_mfma_f32_16x16x32_bf16 v[132:135], a[116:119], a[4:7], v[132:135]
buffer_store_dwordx4 v[236:239], v254, s[4:7], s98 offen offset:0 sc1
v_mfma_f32_16x16x32_bf16 v[156:159], a[116:119], a[12:15], v[156:159]
v_cvt_pk_bf16_f32 v199, v202, v203
v_mul_f32 v174, v174, v85
v_mfma_f32_16x16x32_bf16 v[156:159], a[112:115], a[8:11], v[156:159]
v_mul_f32 v175, v175, v85
v_cvt_pk_bf16_f32 v173, v174, v175
v_mfma_f32_16x16x32_bf16 v[180:183], a[112:115], a[16:19], v[180:183]
v_mul_f32 v176, v176, v85
v_mul_f32 v177, v177, v85
v_mfma_f32_16x16x32_bf16 v[180:183], a[116:119], a[20:23], v[180:183]
v_cvt_pk_bf16_f32 v174, v176, v177
v_mul_f32 v178, v178, v85
v_mfma_f32_16x16x32_bf16 v[204:207], a[116:119], a[28:31], v[204:207]
v_mul_f32 v179, v179, v85
v_cvt_pk_bf16_f32 v175, v178, v179
v_mfma_f32_16x16x32_bf16 v[204:207], a[112:115], a[24:27], v[204:207]
s_waitcnt lgkmcnt(0)
s_barrier
v_mfma_f32_16x16x32_bf16 v[208:211], a[128:131], a[56:59], v[208:211]
ds_write_b128 v233, v[212:215] offset:21504
v_cvt_pk_bf16_f32 v132, v132, v133
v_mfma_f32_16x16x32_bf16 v[208:211], a[132:135], a[60:63], v[208:211]
buffer_store_dwordx4 v[240:243], v254, s[4:7], s98 offen offset:2048 sc1
v_mfma_f32_16x16x32_bf16 v[184:187], a[132:135], a[52:55], v[184:187]
ds_write_b64 v232, v[220:221] offset:4096
v_cvt_pk_bf16_f32 v156, v156, v157
v_mfma_f32_16x16x32_bf16 v[184:187], a[128:131], a[48:51], v[184:187]
ds_write_b64 v232, v[222:223] offset:4608
v_cvt_pk_bf16_f32 v133, v134, v135
v_mfma_f32_16x16x32_bf16 v[160:163], a[128:131], a[40:43], v[160:163]
ds_write_b64 v232, v[196:197] offset:3072
v_cvt_pk_bf16_f32 v180, v180, v181
v_mfma_f32_16x16x32_bf16 v[160:163], a[132:135], a[44:47], v[160:163]
ds_write_b64 v232, v[198:199] offset:3584
v_cvt_pk_bf16_f32 v157, v158, v159
v_mfma_f32_16x16x32_bf16 v[136:139], a[132:135], a[36:39], v[136:139]
ds_write_b64 v232, v[172:173] offset:2048
v_cvt_pk_bf16_f32 v204, v204, v205
v_mfma_f32_16x16x32_bf16 v[136:139], a[128:131], a[32:35], v[136:139]
ds_write_b64 v232, v[174:175] offset:2560
v_cvt_pk_bf16_f32 v181, v182, v183
v_mfma_f32_16x16x32_bf16 v[136:139], a[136:139], a[64:67], v[136:139]
v_cvt_pk_bf16_f32 v205, v206, v207
v_mul_f32 v148, v148, v83
v_mfma_f32_16x16x32_bf16 v[136:139], a[140:143], a[68:71], v[136:139]
v_mul_f32 v149, v149, v83
v_cvt_pk_bf16_f32 v148, v148, v149
v_mfma_f32_16x16x32_bf16 v[160:163], a[140:143], a[76:79], v[160:163]
v_mul_f32 v150, v150, v83
v_mul_f32 v151, v151, v83
v_mfma_f32_16x16x32_bf16 v[160:163], a[136:139], a[72:75], v[160:163]
v_cvt_pk_bf16_f32 v149, v150, v151
v_mul_f32 v152, v152, v83
v_mfma_f32_16x16x32_bf16 v[184:187], a[136:139], a[80:83], v[184:187]
ds_write_b64 v232, v[148:149] offset:1024
v_mul_f32 v153, v153, v83
v_mfma_f32_16x16x32_bf16 v[184:187], a[140:143], a[84:87], v[184:187]
buffer_store_dwordx4 v[244:247], v254, s[4:7], s99 offen offset:0 sc1
v_mfma_f32_16x16x32_bf16 v[208:211], a[140:143], a[92:95], v[208:211]
v_cvt_pk_bf16_f32 v150, v152, v153
v_mul_f32 v154, v154, v83
v_mfma_f32_16x16x32_bf16 v[208:211], a[136:139], a[88:91], v[208:211]
v_mul_f32 v155, v155, v83
v_cvt_pk_bf16_f32 v151, v154, v155
v_mfma_f32_16x16x32_bf16 v[208:211], a[144:147], a[24:27], v[208:211]
ds_write_b64 v232, v[150:151] offset:1536
v_mul_f32 v164, v164, v85
v_mfma_f32_16x16x32_bf16 v[208:211], a[148:151], a[28:31], v[208:211]
v_mul_f32 v165, v165, v85
v_cvt_pk_bf16_f32 v164, v164, v165
v_mfma_f32_16x16x32_bf16 v[184:187], a[148:151], a[20:23], v[184:187]
v_mul_f32 v190, v190, v87
v_mul_f32 v191, v191, v87
v_mfma_f32_16x16x32_bf16 v[184:187], a[144:147], a[16:19], v[184:187]
v_cvt_pk_bf16_f32 v189, v190, v191
v_mul_f32 v166, v166, v85
v_mfma_f32_16x16x32_bf16 v[160:163], a[144:147], a[8:11], v[160:163]
v_mul_f32 v167, v167, v85
v_cvt_pk_bf16_f32 v165, v166, v167
v_mfma_f32_16x16x32_bf16 v[160:163], a[148:151], a[12:15], v[160:163]
v_mul_f32 v142, v142, v83
v_mul_f32 v143, v143, v83
v_mfma_f32_16x16x32_bf16 v[136:139], a[148:151], a[4:7], v[136:139]
v_cvt_pk_bf16_f32 v141, v142, v143
v_mul_f32 v192, v192, v87
v_mfma_f32_16x16x32_bf16 v[136:139], a[144:147], a[0:3], v[136:139]
v_mul_f32 v193, v193, v87
v_cvt_pk_bf16_f32 v190, v192, v193
s_add_u32 m0, s19, 32768
s_add_u32 s44, s84, 0x1a00000
buffer_load_dwordx4 v1, s[4:7], s44 offen offset:0 sc1 lds
v_pk_mul_f32 v[194:195], v[194:195], v[86:87] op_sel:[0,1] op_sel_hi:[1,1]
v_pk_mul_f32 v[168:169], v[168:169], v[84:85] op_sel:[0,1] op_sel_hi:[1,1]
v_pk_mul_f32 v[170:171], v[170:171], v[84:85] op_sel:[0,1] op_sel_hi:[1,1]
v_pk_mul_f32 v[144:145], v[144:145], v[82:83] op_sel:[0,1] op_sel_hi:[1,1]
v_pk_mul_f32 v[146:147], v[146:147], v[82:83] op_sel:[0,1] op_sel_hi:[1,1]
v_cvt_pk_bf16_f32 v191, v194, v195
v_cvt_pk_bf16_f32 v166, v168, v169
v_cvt_pk_bf16_f32 v167, v170, v171
v_cvt_pk_bf16_f32 v142, v144, v145
v_cvt_pk_bf16_f32 v143, v146, v147
v_cvt_pk_bf16_f32 v134, v136, v137
v_cvt_pk_bf16_f32 v135, v138, v139
v_cvt_pk_bf16_f32 v158, v160, v161
v_cvt_pk_bf16_f32 v159, v162, v163
v_cvt_pk_bf16_f32 v182, v184, v185
v_cvt_pk_bf16_f32 v183, v186, v187
v_cvt_pk_bf16_f32 v206, v208, v209
v_cvt_pk_bf16_f32 v207, v210, v211
buffer_load_dwordx4 v1, s[4:7], s44 offen offset:1024 sc1 lds
buffer_load_dwordx4 v1, s[4:7], s44 offen offset:2048 sc1 lds
buffer_load_dwordx4 v1, s[4:7], s44 offen offset:3072 sc1 lds
s_add_u32 m0, s19, 98304
s_add_u32 s44, s84, 0x1a10000
buffer_load_dwordx4 v1, s[4:7], s44 offen offset:0 sc1 lds
buffer_load_dwordx4 v1, s[4:7], s44 offen offset:1024 sc1 lds
buffer_load_dwordx4 v1, s[4:7], s44 offen offset:2048 sc1 lds
buffer_load_dwordx4 v1, s[4:7], s44 offen offset:3072 sc1 lds
s_waitcnt lgkmcnt(0)
s_barrier
s_add_u32 m0, s19, 114688
s_add_u32 s44, s85, 0x1a14000
buffer_load_dwordx4 v1, s[4:7], s44 offen offset:0 sc1 lds
v_mfma_f32_16x16x32_bf16 v[208:211], v[188:191], v[204:207], v[20:23]
ds_read_b64_tr_b16 a[10:11], v248 offset:3072
v_mfma_f32_16x16x32_bf16 v[224:227], v[212:215], v[204:207], v[24:27]
ds_read_b64_tr_b16 a[12:13], v248 offset:4096
v_mfma_f32_16x16x32_bf16 v[160:163], v[140:143], v[156:159], v[20:23]
ds_read_b64_tr_b16 a[22:23], v248 offset:3584
v_mfma_f32_16x16x32_bf16 v[176:179], v[164:167], v[156:159], v[24:27]
s_nop 3
v_max_f32 v224, v224, v208
v_max_f32 v225, v225, v209
v_max_f32 v226, v226, v210
v_max_f32 v227, v227, v211
v_max3_f32 v239, v224, v225, v226
v_max_f32 v239, v239, v227
ds_read_b64_tr_b16 a[24:25], v248 offset:4608
v_max_f32 v176, v176, v160
v_max_f32 v177, v177, v161
v_max_f32 v178, v178, v162
v_max_f32 v179, v179, v163
v_max3_f32 v237, v176, v177, v178
buffer_load_dwordx4 v1, s[4:7], s44 offen offset:1024 sc1 lds
v_max_f32 v237, v237, v179
ds_read_b64_tr_b16 a[6:7], v248 offset:1024
s_nop 0
v_permlane32_swap_b32 v239, v237
v_max_f32 v239, v239, v237
v_mov_b32 v242, v239
ds_read_b64_tr_b16 a[8:9], v248 offset:2048
s_nop 0
v_permlane16_swap_b32 v239, v242
v_max_f32 v239, v239, v242
v_mov_b32 v242, v239
ds_read_b64_tr_b16 a[18:19], v248 offset:1536
s_nop 0
v_permlane32_swap_b32 v239, v242
v_mul_f32_e64 v89, -v239, v88
v_fma_f32 v224, v224, v88, v89
v_fma_f32 v225, v225, v88, v89
v_fma_f32 v226, v226, v88, v89
v_fma_f32 v227, v227, v88, v89
buffer_load_dwordx4 v[228:231], v9, s[4:7], s55 offen sc1
buffer_load_dwordx4 v[72:75], v9, s[4:7], s55 offen offset:1024 sc1
v_exp_f32 v224, v224
v_exp_f32 v225, v225
v_exp_f32 v226, v226
buffer_load_dwordx4 v1, s[4:7], s44 offen offset:2048 sc1 lds
v_exp_f32 v227, v227
v_cvt_pk_bf16_f32 v224, v224, v225
v_cvt_pk_bf16_f32 v225, v226, v227
ds_read_b64_tr_b16 a[20:21], v248 offset:2560
v_and_b32 v208, v224, v28
v_and_b32 v209, v225, v29
v_and_b32 v210, v224, v30
v_and_b32 v211, v225, v31
v_mul_f32_e64 v85, -v242, v84
v_fma_f32 v176, v176, v84, v85
v_mfma_f32_16x16x32_bf16 v[216:219], v[16:19], v[208:211], 0
v_fma_f32 v177, v177, v84, v85
v_fma_f32 v178, v178, v84, v85
s_waitcnt lgkmcnt(6)
v_mfma_f32_16x16x32_bf16 v[116:119], a[10:13], v[208:211], 0
v_fma_f32 v179, v179, v84, v85
v_exp_f32 v176, v176
s_waitcnt lgkmcnt(4)
v_mfma_f32_16x16x32_bf16 v[120:123], a[22:25], v[208:211], 0
v_exp_f32 v177, v177
v_exp_f32 v178, v178
buffer_load_dwordx4 v1, s[4:7], s44 offen offset:3072 sc1 lds
v_exp_f32 v179, v179
v_rcp_f32 v216, v216
v_cvt_pk_bf16_f32 v176, v176, v177
v_cvt_pk_bf16_f32 v177, v178, v179
v_and_b32 v160, v176, v28
v_and_b32 v161, v177, v29
v_and_b32 v162, v176, v30
v_and_b32 v163, v177, v31
v_pk_mul_f32 v[116:117], v[116:117], v[216:217] op_sel:[0,0] op_sel_hi:[1,0]
v_cvt_pk_bf16_f32 v116, v116, v117
v_pk_mul_f32 v[118:119], v[118:119], v[216:217] op_sel:[0,0] op_sel_hi:[1,0]
v_cvt_pk_bf16_f32 v117, v118, v119
v_pk_mul_f32 v[120:121], v[120:121], v[216:217] op_sel:[0,0] op_sel_hi:[1,0]
v_cvt_pk_bf16_f32 v118, v120, v121
v_pk_mul_f32 v[122:123], v[122:123], v[216:217] op_sel:[0,0] op_sel_hi:[1,0]
v_cvt_pk_bf16_f32 v119, v122, v123
v_mfma_f32_16x16x32_bf16 v[168:171], v[16:19], v[160:163], 0
s_waitcnt lgkmcnt(2)
v_mfma_f32_16x16x32_bf16 v[100:103], a[6:9], v[160:163], 0
s_waitcnt lgkmcnt(0)
v_mfma_f32_16x16x32_bf16 v[104:107], a[18:21], v[160:163], 0
buffer_store_dwordx4 v[116:119], v2, s[4:7], s72 offen offset:3072 sc1
v_mfma_f32_16x16x32_bf16 v[184:187], v[164:167], v[180:183], v[20:23]
s_nop 1
v_rcp_f32 v168, v168
v_mfma_f32_16x16x32_bf16 v[200:203], v[188:191], v[180:183], v[24:27]
v_pk_mul_f32 v[100:101], v[100:101], v[168:169] op_sel:[0,0] op_sel_hi:[1,0]
v_pk_mul_f32 v[102:103], v[102:103], v[168:169] op_sel:[0,0] op_sel_hi:[1,0]
v_cvt_pk_bf16_f32 v100, v100, v101
v_pk_mul_f32 v[104:105], v[104:105], v[168:169] op_sel:[0,0] op_sel_hi:[1,0]
v_pk_mul_f32 v[106:107], v[106:107], v[168:169] op_sel:[0,0] op_sel_hi:[1,0]
v_cvt_pk_bf16_f32 v101, v102, v103
v_cvt_pk_bf16_f32 v102, v104, v105
v_cvt_pk_bf16_f32 v103, v106, v107
v_max_f32 v200, v200, v184
v_max_f32 v201, v201, v185
v_max_f32 v202, v202, v186
buffer_store_dwordx4 v[100:103], v2, s[4:7], s72 offen offset:1024 sc1
v_max_f32 v203, v203, v187
v_max3_f32 v238, v200, v201, v202
v_max_f32 v238, v238, v203
s_cmp_lg_u32 s28, 0
s_cbranch_scc1 Lhx_7
s_waitcnt vmcnt(5)
v_max3_u32 v244, v228, v229, v230
s_waitcnt vmcnt(4)
v_max3_u32 v244, v244, v231, v72
v_max3_u32 v244, v244, v73, v74
v_max_u32 v244, v244, v75
v_cmp_eq_u32 vcc, -1, v244
s_cbranch_vccnz L_hxredo0
L_hxback0:
ds_write_b128 v233, v[228:231] offset:20480
ds_write_b64 v232, v[72:73] offset:0
ds_write_b64 v232, v[74:75] offset:512
Lhx_7:
ds_read_b128 a[0:3], v233 offset:20480
v_mfma_f32_16x16x32_bf16 v[152:155], v[140:143], v[132:135], v[24:27]
ds_read_b64_tr_b16 a[4:5], v248 offset:0
ds_read_b64_tr_b16 a[16:17], v248 offset:512
s_waitcnt lgkmcnt(2)
v_mfma_f32_16x16x32_bf16 v[136:139], a[0:3], v[132:135], v[76:79]
s_nop 7
v_max_f32 v152, v152, v136
v_max_f32 v153, v153, v137
v_max_f32 v154, v154, v138
v_max_f32 v155, v155, v139
v_max3_f32 v236, v152, v153, v154
v_max_f32 v236, v236, v155
s_nop 1
v_permlane32_swap_b32 v238, v236
v_max_f32 v238, v238, v236
v_mov_b32 v243, v238
s_nop 1
v_permlane16_swap_b32 v238, v243
v_max_f32 v238, v238, v243
v_mov_b32 v243, v238
s_nop 1
v_permlane32_swap_b32 v238, v243
v_mul_f32_e64 v87, -v238, v86
v_fma_f32 v200, v200, v86, v87
v_fma_f32 v201, v201, v86, v87
v_fma_f32 v202, v202, v86, v87
v_fma_f32 v203, v203, v86, v87
v_exp_f32 v200, v200
v_exp_f32 v201, v201
v_exp_f32 v202, v202
v_exp_f32 v203, v203
v_cvt_pk_bf16_f32 v200, v200, v201
v_cvt_pk_bf16_f32 v201, v202, v203
v_and_b32 v184, v200, v28
v_and_b32 v185, v201, v29
v_and_b32 v186, v200, v30
v_and_b32 v187, v201, v31
v_mul_f32_e64 v83, -v243, v82
v_fma_f32 v152, v152, v82, v83
v_mfma_f32_16x16x32_bf16 v[192:195], v[16:19], v[184:187], 0
v_fma_f32 v153, v153, v82, v83
v_fma_f32 v154, v154, v82, v83
v_mfma_f32_16x16x32_bf16 v[108:111], a[8:11], v[184:187], 0
v_fma_f32 v155, v155, v82, v83
v_exp_f32 v152, v152
v_mfma_f32_16x16x32_bf16 v[112:115], a[20:23], v[184:187], 0
v_exp_f32 v153, v153
v_exp_f32 v154, v154
v_exp_f32 v155, v155
v_rcp_f32 v192, v192
v_cvt_pk_bf16_f32 v152, v152, v153
v_cvt_pk_bf16_f32 v153, v154, v155
v_and_b32 v136, v152, v80
v_and_b32 v137, v153, v81
v_and_b32 v138, v152, v30
v_and_b32 v139, v153, v31
v_pk_mul_f32 v[108:109], v[108:109], v[192:193] op_sel:[0,0] op_sel_hi:[1,0]
v_pk_mul_f32 v[110:111], v[110:111], v[192:193] op_sel:[0,0] op_sel_hi:[1,0]
v_cvt_pk_bf16_f32 v108, v108, v109
v_pk_mul_f32 v[112:113], v[112:113], v[192:193] op_sel:[0,0] op_sel_hi:[1,0]
v_cvt_pk_bf16_f32 v109, v110, v111
v_pk_mul_f32 v[114:115], v[114:115], v[192:193] op_sel:[0,0] op_sel_hi:[1,0]
v_cvt_pk_bf16_f32 v110, v112, v113
v_mfma_f32_16x16x32_bf16 v[144:147], v[16:19], v[136:139], 0
v_cvt_pk_bf16_f32 v111, v114, v115
buffer_store_dwordx4 v[108:111], v2, s[4:7], s72 offen offset:2048 sc1
s_waitcnt lgkmcnt(1)
v_mfma_f32_16x16x32_bf16 v[92:95], a[4:7], v[136:139], 0
s_nop 3
v_rcp_f32 v144, v144
s_waitcnt lgkmcnt(0)
v_mfma_f32_16x16x32_bf16 v[96:99], a[16:19], v[136:139], 0
s_nop 0
v_pk_mul_f32 v[92:93], v[92:93], v[144:145] op_sel:[0,0] op_sel_hi:[1,0]
v_pk_mul_f32 v[94:95], v[94:95], v[144:145] op_sel:[0,0] op_sel_hi:[1,0]
v_cvt_pk_bf16_f32 v92, v92, v93
v_cvt_pk_bf16_f32 v93, v94, v95
s_nop 2
v_pk_mul_f32 v[96:97], v[96:97], v[144:145] op_sel:[0,0] op_sel_hi:[1,0]
v_pk_mul_f32 v[98:99], v[98:99], v[144:145] op_sel:[0,0] op_sel_hi:[1,0]
v_cvt_pk_bf16_f32 v94, v96, v97
v_cvt_pk_bf16_f32 v95, v98, v99
buffer_store_dwordx4 v[92:95], v2, s[4:7], s72 offen offset:0 sc1
s_add_u32 s92, s71, 0x0
v_accvgpr_write_b32 a188, v48
v_accvgpr_write_b32 a189, v49
v_accvgpr_write_b32 a190, v50
v_accvgpr_write_b32 a191, v51
v_accvgpr_write_b32 a192, v52
v_accvgpr_write_b32 a193, v53
v_accvgpr_write_b32 a194, v54
v_accvgpr_write_b32 a195, v55
v_accvgpr_write_b32 a196, v56
v_accvgpr_write_b32 a197, v57
v_accvgpr_write_b32 a198, v58
v_accvgpr_write_b32 a199, v59
v_accvgpr_write_b32 a200, v60
v_accvgpr_write_b32 a201, v61
v_accvgpr_write_b32 a202, v62
v_accvgpr_write_b32 a203, v63
v_accvgpr_write_b32 a204, v64
v_accvgpr_write_b32 a205, v65
v_accvgpr_write_b32 a206, v66
v_accvgpr_write_b32 a207, v67
v_accvgpr_write_b32 a208, v68
v_accvgpr_write_b32 a209, v69
v_accvgpr_write_b32 a210, v70
v_accvgpr_write_b32 a211, v71
s_add_u32 s40, s4, 0x800000
s_addc_u32 s41, s5, 0
v_add_u32 v5, 32768, v1
v_add_u32 v6, 98304, v1
s_mov_b32 s35, s77
v_lshlrev_b32 v132, 16, v32
v_and_b32 v133, 0xffff0000, v32
v_lshlrev_b32 v134, 16, v33
v_and_b32 v135, 0xffff0000, v33
v_lshlrev_b32 v136, 16, v34
v_and_b32 v137, 0xffff0000, v34
v_lshlrev_b32 v138, 16, v35
v_and_b32 v139, 0xffff0000, v35
v_lshlrev_b32 v140, 16, v36
v_and_b32 v141, 0xffff0000, v36
v_lshlrev_b32 v142, 16, v37
v_and_b32 v143, 0xffff0000, v37
v_lshlrev_b32 v144, 16, v38
v_and_b32 v145, 0xffff0000, v38
v_lshlrev_b32 v146, 16, v39
v_and_b32 v147, 0xffff0000, v39
v_lshlrev_b32 v148, 16, v40
v_and_b32 v149, 0xffff0000, v40
v_lshlrev_b32 v150, 16, v41
v_and_b32 v151, 0xffff0000, v41
v_lshlrev_b32 v152, 16, v42
v_and_b32 v153, 0xffff0000, v42
v_lshlrev_b32 v154, 16, v43
v_and_b32 v155, 0xffff0000, v43
v_lshlrev_b32 v156, 16, v44
v_and_b32 v157, 0xffff0000, v44
v_lshlrev_b32 v158, 16, v45
v_and_b32 v159, 0xffff0000, v45
v_lshlrev_b32 v160, 16, v46
v_and_b32 v161, 0xffff0000, v46
v_lshlrev_b32 v162, 16, v47
v_and_b32 v163, 0xffff0000, v47
s_waitcnt vmcnt(0)
s_barrier
s_cmp_lg_u32 s28, 0
s_cbranch_scc1 Lsg_8
buffer_atomic_add v12, v10, s[4:7], s92 offen sc1
buffer_atomic_swap v15, v14, s[4:7], s8 offen sc1
buffer_atomic_swap v15, v252, s[4:7], s62 offen offset:64 sc1
Lsg_8:
s_add_u32 m0, s19, 131072
s_add_u32 s44, s86, 0x1a18000
buffer_load_dwordx4 v1, s[4:7], s44 offen offset:0 sc1 lds
buffer_load_dwordx4 v1, s[4:7], s44 offen offset:1024 sc1 lds
buffer_load_dwordx4 v1, s[4:7], s44 offen offset:2048 sc1 lds
buffer_load_dwordx4 v1, s[4:7], s44 offen offset:3072 sc1 lds
s_add_u32 m0, s19, 147456
s_add_u32 s44, s87, 0x1a1c000
buffer_load_dwordx4 v1, s[4:7], s44 offen offset:0 sc1 lds
buffer_load_dwordx4 v1, s[4:7], s44 offen offset:1024 sc1 lds
buffer_load_dwordx4 v1, s[4:7], s44 offen offset:2048 sc1 lds
buffer_load_dwordx4 v1, s[4:7], s44 offen offset:3072 sc1 lds
s_mov_b64 exec, 0
s_cmp_eq_u32 s28, 3
s_cbranch_scc1 L_stub3
s_cmp_eq_u32 s28, 2
s_cbranch_scc1 L_stub4
s_cmp_eq_u32 s28, 0
s_cbranch_scc1 L_stub8
L_wret1:
s_mov_b64 exec, -1
s_cmp_lg_u32 s28, 1
s_cbranch_scc1 Lpo_11
s_add_u32 s36, s11, 0x0
s_mov_b32 s37, 0
v_mov_b32 v11, 0
buffer_atomic_add v11, v251, s[4:7], s36 offen sc0 sc1
s_sleep 4
Lpoll_9:
v_mov_b32 v234, 0
buffer_atomic_add v234, v251, s[4:7], s36 offen sc0 sc1
s_waitcnt vmcnt(1)
v_readfirstlane_b32 s38, v11
s_nop 0
s_cmp_ge_u32 s38, 32
s_cbranch_scc1 Lpe_10
v_mov_b32 v11, 0
buffer_atomic_add v11, v251, s[4:7], s36 offen sc0 sc1
s_waitcnt vmcnt(1)
v_readfirstlane_b32 s38, v234
s_nop 0
s_cmp_ge_u32 s38, 32
s_cbranch_scc1 Lpe_10
s_add_u32 s37, s37, 1
s_cmp_lt_u32 s37, 0x80000
s_cbranch_scc1 Lpoll_9
s_waitcnt vmcnt(0)
Lpo_11:
s_waitcnt vmcnt(0)
Lpe_10:
s_barrier
L_k2go0:
buffer_load_dwordx4 a[0:3], v4, s[40:43], s35 offen offset:0 sc1
buffer_load_dwordx4 a[4:7], v4, s[40:43], s35 offen offset:1024 sc1
s_add_u32 s35, s77, 4096
buffer_load_dwordx4 a[8:11], v4, s[40:43], s35 offen offset:0 sc1
buffer_load_dwordx4 a[12:15], v4, s[40:43], s35 offen offset:1024 sc1
s_add_u32 s35, s77, 16384
buffer_load_dwordx4 a[16:19], v4, s[40:43], s35 offen offset:0 sc1
buffer_load_dwordx4 a[20:23], v4, s[40:43], s35 offen offset:1024 sc1
s_add_u32 s35, s77, 20480
buffer_load_dwordx4 a[24:27], v4, s[40:43], s35 offen offset:0 sc1
buffer_load_dwordx4 a[28:31], v4, s[40:43], s35 offen offset:1024 sc1
s_add_u32 s35, s77, 32768
buffer_load_dwordx4 a[32:35], v4, s[40:43], s35 offen offset:0 sc1
buffer_load_dwordx4 a[36:39], v4, s[40:43], s35 offen offset:1024 sc1
s_add_u32 s35, s77, 36864
buffer_load_dwordx4 a[40:43], v4, s[40:43], s35 offen offset:0 sc1
buffer_load_dwordx4 a[44:47], v4, s[40:43], s35 offen offset:1024 sc1
s_add_u32 s35, s77, 49152
ds_read_b128 a[96:99], v5 offset:0
ds_read_b128 a[100:103], v5 offset:1024
ds_read_b128 a[104:107], v5 offset:2048
ds_read_b128 a[108:111], v5 offset:3072
ds_read_b128 a[112:115], v5 offset:4096
ds_read_b128 a[116:119], v5 offset:5120
ds_read_b128 a[120:123], v5 offset:6144
ds_read_b128 a[124:127], v5 offset:7168
s_waitcnt vmcnt(10) lgkmcnt(4)
v_mfma_f32_16x16x32_bf16 v[132:135], a[96:99], a[0:3], v[132:135]
ds_read_b128 a[128:131], v5 offset:8192
v_mfma_f32_16x16x32_bf16 v[148:151], a[96:99], a[4:7], v[148:151]
ds_read_b128 a[132:135], v5 offset:9216
v_mfma_f32_16x16x32_bf16 v[152:155], a[100:103], a[4:7], v[152:155]
buffer_load_dwordx4 a[48:51], v4, s[40:43], s35 offen offset:0 sc1
v_mfma_f32_16x16x32_bf16 v[136:139], a[100:103], a[0:3], v[136:139]
ds_read_b128 a[136:139], v5 offset:10240
v_mfma_f32_16x16x32_bf16 v[140:143], a[104:107], a[0:3], v[140:143]
ds_read_b128 a[140:143], v5 offset:11264
v_mfma_f32_16x16x32_bf16 v[156:159], a[104:107], a[4:7], v[156:159]
v_mfma_f32_16x16x32_bf16 v[160:163], a[108:111], a[4:7], v[160:163]
buffer_load_dwordx4 a[52:55], v4, s[40:43], s35 offen offset:1024 sc1
s_add_u32 s35, s77, 53248
v_mfma_f32_16x16x32_bf16 v[144:147], a[108:111], a[0:3], v[144:147]
s_waitcnt vmcnt(10) lgkmcnt(4)
v_mfma_f32_16x16x32_bf16 v[132:135], a[112:115], a[8:11], v[132:135]
ds_read_b128 a[96:99], v5 offset:12288
v_mfma_f32_16x16x32_bf16 v[148:151], a[112:115], a[12:15], v[148:151]
ds_read_b128 a[100:103], v5 offset:13312
v_mfma_f32_16x16x32_bf16 v[152:155], a[116:119], a[12:15], v[152:155]
buffer_load_dwordx4 a[0:3], v4, s[40:43], s35 offen offset:0 sc1
L_stub3:
s_cbranch_execz L_wret1
v_mfma_f32_16x16x32_bf16 v[136:139], a[116:119], a[8:11], v[136:139]
ds_read_b128 a[104:107], v5 offset:14336
v_mfma_f32_16x16x32_bf16 v[140:143], a[120:123], a[8:11], v[140:143]
ds_read_b128 a[108:111], v5 offset:15360
v_mfma_f32_16x16x32_bf16 v[156:159], a[120:123], a[12:15], v[156:159]
v_mfma_f32_16x16x32_bf16 v[160:163], a[124:127], a[12:15], v[160:163]
buffer_load_dwordx4 a[4:7], v4, s[40:43], s35 offen offset:1024 sc1
s_add_u32 s35, s77, 65536
v_mfma_f32_16x16x32_bf16 v[144:147], a[124:127], a[8:11], v[144:147]
s_waitcnt vmcnt(10) lgkmcnt(4)
v_mfma_f32_16x16x32_bf16 v[132:135], a[128:131], a[16:19], v[132:135]
ds_read_b128 a[112:115], v5 offset:16384
v_mfma_f32_16x16x32_bf16 v[148:151], a[128:131], a[20:23], v[148:151]
ds_read_b128 a[116:119], v5 offset:17408
v_mfma_f32_16x16x32_bf16 v[152:155], a[132:135], a[20:23], v[152:155]
buffer_load_dwordx4 a[8:11], v4, s[40:43], s35 offen offset:0 sc1
v_mfma_f32_16x16x32_bf16 v[136:139], a[132:135], a[16:19], v[136:139]
ds_read_b128 a[120:123], v5 offset:18432
v_mfma_f32_16x16x32_bf16 v[140:143], a[136:139], a[16:19], v[140:143]
ds_read_b128 a[124:127], v5 offset:19456
v_mfma_f32_16x16x32_bf16 v[156:159], a[136:139], a[20:23], v[156:159]
v_mfma_f32_16x16x32_bf16 v[160:163], a[140:143], a[20:23], v[160:163]
buffer_load_dwordx4 a[12:15], v4, s[40:43], s35 offen offset:1024 sc1
s_add_u32 s35, s77, 69632
v_mfma_f32_16x16x32_bf16 v[144:147], a[140:143], a[16:19], v[144:147]
s_waitcnt vmcnt(10) lgkmcnt(4)
v_mfma_f32_16x16x32_bf16 v[132:135], a[96:99], a[24:27], v[132:135]
ds_read_b128 a[128:131], v5 offset:20480
v_mfma_f32_16x16x32_bf16 v[148:151], a[96:99], a[28:31], v[148:151]
ds_read_b128 a[132:135], v5 offset:21504
v_mfma_f32_16x16x32_bf16 v[152:155], a[100:103], a[28:31], v[152:155]
buffer_load_dwordx4 a[16:19], v4, s[40:43], s35 offen offset:0 sc1
v_mfma_f32_16x16x32_bf16 v[136:139], a[100:103], a[24:27], v[136:139]
ds_read_b128 a[136:139], v5 offset:22528
v_mfma_f32_16x16x32_bf16 v[140:143], a[104:107], a[24:27], v[140:143]
ds_read_b128 a[140:143], v5 offset:23552
v_mfma_f32_16x16x32_bf16 v[156:159], a[104:107], a[28:31], v[156:159]
v_mfma_f32_16x16x32_bf16 v[160:163], a[108:111], a[28:31], v[160:163]
buffer_load_dwordx4 a[20:23], v4, s[40:43], s35 offen offset:1024 sc1
s_add_u32 s35, s77, 81920
v_mfma_f32_16x16x32_bf16 v[144:147], a[108:111], a[24:27], v[144:147]
s_waitcnt vmcnt(10) lgkmcnt(4)
v_mfma_f32_16x16x32_bf16 v[132:135], a[112:115], a[32:35], v[132:135]
ds_read_b128 a[96:99], v5 offset:24576
v_mfma_f32_16x16x32_bf16 v[148:151], a[112:115], a[36:39], v[148:151]
ds_read_b128 a[100:103], v5 offset:25600
v_mfma_f32_16x16x32_bf16 v[152:155], a[116:119], a[36:39], v[152:155]
buffer_load_dwordx4 a[24:27], v4, s[40:43], s35 offen offset:0 sc1
v_mfma_f32_16x16x32_bf16 v[136:139], a[116:119], a[32:35], v[136:139]
ds_read_b128 a[104:107], v5 offset:26624
v_mfma_f32_16x16x32_bf16 v[140:143], a[120:123], a[32:35], v[140:143]
ds_read_b128 a[108:111], v5 offset:27648
v_mfma_f32_16x16x32_bf16 v[156:159], a[120:123], a[36:39], v[156:159]
v_mfma_f32_16x16x32_bf16 v[160:163], a[124:127], a[36:39], v[160:163]
buffer_load_dwordx4 a[28:31], v4, s[40:43], s35 offen offset:1024 sc1
s_add_u32 s35, s77, 86016
v_mfma_f32_16x16x32_bf16 v[144:147], a[124:127], a[32:35], v[144:147]
s_waitcnt vmcnt(10) lgkmcnt(4)
v_mfma_f32_16x16x32_bf16 v[132:135], a[128:131], a[40:43], v[132:135]
ds_read_b128 a[112:115], v5 offset:28672
v_mfma_f32_16x16x32_bf16 v[148:151], a[128:131], a[44:47], v[148:151]
ds_read_b128 a[116:119], v5 offset:29696
v_mfma_f32_16x16x32_bf16 v[152:155], a[132:135], a[44:47], v[152:155]
buffer_load_dwordx4 a[32:35], v4, s[40:43], s35 offen offset:0 sc1
v_mfma_f32_16x16x32_bf16 v[136:139], a[132:135], a[40:43], v[136:139]
ds_read_b128 a[120:123], v5 offset:30720
v_mfma_f32_16x16x32_bf16 v[140:143], a[136:139], a[40:43], v[140:143]
ds_read_b128 a[124:127], v5 offset:31744
v_mfma_f32_16x16x32_bf16 v[156:159], a[136:139], a[44:47], v[156:159]
v_mfma_f32_16x16x32_bf16 v[160:163], a[140:143], a[44:47], v[160:163]
buffer_load_dwordx4 a[36:39], v4, s[40:43], s35 offen offset:1024 sc1
s_add_u32 s35, s77, 98304
v_mfma_f32_16x16x32_bf16 v[144:147], a[140:143], a[40:43], v[144:147]
s_waitcnt vmcnt(10) lgkmcnt(4)
v_mfma_f32_16x16x32_bf16 v[132:135], a[96:99], a[48:51], v[132:135]
ds_read_b128 a[128:131], v5 offset:32768
v_mfma_f32_16x16x32_bf16 v[148:151], a[96:99], a[52:55], v[148:151]
ds_read_b128 a[132:135], v5 offset:33792
v_mfma_f32_16x16x32_bf16 v[152:155], a[100:103], a[52:55], v[152:155]
buffer_load_dwordx4 a[40:43], v4, s[40:43], s35 offen offset:0 sc1
v_mfma_f32_16x16x32_bf16 v[136:139], a[100:103], a[48:51], v[136:139]
ds_read_b128 a[136:139], v5 offset:34816
v_mfma_f32_16x16x32_bf16 v[140:143], a[104:107], a[48:51], v[140:143]
ds_read_b128 a[140:143], v5 offset:35840
v_mfma_f32_16x16x32_bf16 v[156:159], a[104:107], a[52:55], v[156:159]
v_mfma_f32_16x16x32_bf16 v[160:163], a[108:111], a[52:55], v[160:163]
buffer_load_dwordx4 a[44:47], v4, s[40:43], s35 offen offset:1024 sc1
s_add_u32 s35, s77, 102400
v_mfma_f32_16x16x32_bf16 v[144:147], a[108:111], a[48:51], v[144:147]
s_waitcnt vmcnt(10) lgkmcnt(4)
v_mfma_f32_16x16x32_bf16 v[132:135], a[112:115], a[0:3], v[132:135]
ds_read_b128 a[96:99], v5 offset:36864
v_mfma_f32_16x16x32_bf16 v[148:151], a[112:115], a[4:7], v[148:151]
ds_read_b128 a[100:103], v5 offset:37888
v_mfma_f32_16x16x32_bf16 v[152:155], a[116:119], a[4:7], v[152:155]
buffer_load_dwordx4 a[48:51], v4, s[40:43], s35 offen offset:0 sc1
v_mfma_f32_16x16x32_bf16 v[136:139], a[116:119], a[0:3], v[136:139]
ds_read_b128 a[104:107], v5 offset:38912
v_mfma_f32_16x16x32_bf16 v[140:143], a[120:123], a[0:3], v[140:143]
ds_read_b128 a[108:111], v5 offset:39936
v_mfma_f32_16x16x32_bf16 v[156:159], a[120:123], a[4:7], v[156:159]
v_mfma_f32_16x16x32_bf16 v[160:163], a[124:127], a[4:7], v[160:163]
buffer_load_dwordx4 a[52:55], v4, s[40:43], s35 offen offset:1024 sc1
s_add_u32 s35, s77, 114688
v_mfma_f32_16x16x32_bf16 v[144:147], a[124:127], a[0:3], v[144:147]
s_waitcnt vmcnt(10) lgkmcnt(4)
v_mfma_f32_16x16x32_bf16 v[132:135], a[128:131], a[8:11], v[132:135]
ds_read_b128 a[112:115], v5 offset:40960
v_mfma_f32_16x16x32_bf16 v[148:151], a[128:131], a[12:15], v[148:151]
ds_read_b128 a[116:119], v5 offset:41984
v_mfma_f32_16x16x32_bf16 v[152:155], a[132:135], a[12:15], v[152:155]
buffer_load_dwordx4 a[0:3], v4, s[40:43], s35 offen offset:0 sc1
v_mfma_f32_16x16x32_bf16 v[136:139], a[132:135], a[8:11], v[136:139]
ds_read_b128 a[120:123], v5 offset:43008
v_mfma_f32_16x16x32_bf16 v[140:143], a[136:139], a[8:11], v[140:143]
ds_read_b128 a[124:127], v5 offset:44032
v_mfma_f32_16x16x32_bf16 v[156:159], a[136:139], a[12:15], v[156:159]
v_mfma_f32_16x16x32_bf16 v[160:163], a[140:143], a[12:15], v[160:163]
buffer_load_dwordx4 a[4:7], v4, s[40:43], s35 offen offset:1024 sc1
s_add_u32 s35, s77, 118784
v_mfma_f32_16x16x32_bf16 v[144:147], a[140:143], a[8:11], v[144:147]
s_waitcnt vmcnt(10) lgkmcnt(4)
v_mfma_f32_16x16x32_bf16 v[132:135], a[96:99], a[16:19], v[132:135]
ds_read_b128 a[128:131], v5 offset:45056
v_mfma_f32_16x16x32_bf16 v[148:151], a[96:99], a[20:23], v[148:151]
ds_read_b128 a[132:135], v5 offset:46080
v_mfma_f32_16x16x32_bf16 v[152:155], a[100:103], a[20:23], v[152:155]
buffer_load_dwordx4 a[8:11], v4, s[40:43], s35 offen offset:0 sc1
v_mfma_f32_16x16x32_bf16 v[136:139], a[100:103], a[16:19], v[136:139]
ds_read_b128 a[136:139], v5 offset:47104
v_mfma_f32_16x16x32_bf16 v[140:143], a[104:107], a[16:19], v[140:143]
ds_read_b128 a[140:143], v5 offset:48128
v_mfma_f32_16x16x32_bf16 v[156:159], a[104:107], a[20:23], v[156:159]
v_mfma_f32_16x16x32_bf16 v[160:163], a[108:111], a[20:23], v[160:163]
buffer_load_dwordx4 a[12:15], v4, s[40:43], s35 offen offset:1024 sc1
s_add_u32 s35, s77, 524288
v_mfma_f32_16x16x32_bf16 v[144:147], a[108:111], a[16:19], v[144:147]
s_waitcnt vmcnt(10) lgkmcnt(4)
v_mfma_f32_16x16x32_bf16 v[132:135], a[112:115], a[24:27], v[132:135]
ds_read_b128 a[96:99], v5 offset:49152
v_mfma_f32_16x16x32_bf16 v[148:151], a[112:115], a[28:31], v[148:151]
ds_read_b128 a[100:103], v5 offset:50176
v_mfma_f32_16x16x32_bf16 v[152:155], a[116:119], a[28:31], v[152:155]
buffer_load_dwordx4 a[16:19], v4, s[40:43], s35 offen offset:0 sc1
v_mfma_f32_16x16x32_bf16 v[136:139], a[116:119], a[24:27], v[136:139]
ds_read_b128 a[104:107], v5 offset:51200
v_mfma_f32_16x16x32_bf16 v[140:143], a[120:123], a[24:27], v[140:143]
ds_read_b128 a[108:111], v5 offset:52224
v_mfma_f32_16x16x32_bf16 v[156:159], a[120:123], a[28:31], v[156:159]
v_mfma_f32_16x16x32_bf16 v[160:163], a[124:127], a[28:31], v[160:163]
buffer_load_dwordx4 a[20:23], v4, s[40:43], s35 offen offset:1024 sc1
s_add_u32 s35, s77, 528384
v_mfma_f32_16x16x32_bf16 v[144:147], a[124:127], a[24:27], v[144:147]
s_waitcnt vmcnt(10) lgkmcnt(4)
v_mfma_f32_16x16x32_bf16 v[132:135], a[128:131], a[32:35], v[132:135]
ds_read_b128 a[112:115], v5 offset:53248
v_mfma_f32_16x16x32_bf16 v[148:151], a[128:131], a[36:39], v[148:151]
ds_read_b128 a[116:119], v5 offset:54272
v_mfma_f32_16x16x32_bf16 v[152:155], a[132:135], a[36:39], v[152:155]
buffer_load_dwordx4 a[24:27], v4, s[40:43], s35 offen offset:0 sc1
v_mfma_f32_16x16x32_bf16 v[136:139], a[132:135], a[32:35], v[136:139]
ds_read_b128 a[120:123], v5 offset:55296
v_mfma_f32_16x16x32_bf16 v[140:143], a[136:139], a[32:35], v[140:143]
ds_read_b128 a[124:127], v5 offset:56320
v_mfma_f32_16x16x32_bf16 v[156:159], a[136:139], a[36:39], v[156:159]
v_mfma_f32_16x16x32_bf16 v[160:163], a[140:143], a[36:39], v[160:163]
buffer_load_dwordx4 a[28:31], v4, s[40:43], s35 offen offset:1024 sc1
s_add_u32 s35, s77, 540672
v_mfma_f32_16x16x32_bf16 v[144:147], a[140:143], a[32:35], v[144:147]
s_waitcnt vmcnt(10) lgkmcnt(4)
v_mfma_f32_16x16x32_bf16 v[132:135], a[96:99], a[40:43], v[132:135]
ds_read_b128 a[128:131], v5 offset:57344
v_mfma_f32_16x16x32_bf16 v[148:151], a[96:99], a[44:47], v[148:151]
ds_read_b128 a[132:135], v5 offset:58368
v_mfma_f32_16x16x32_bf16 v[152:155], a[100:103], a[44:47], v[152:155]
buffer_load_dwordx4 a[32:35], v4, s[40:43], s35 offen offset:0 sc1
v_mfma_f32_16x16x32_bf16 v[136:139], a[100:103], a[40:43], v[136:139]
ds_read_b128 a[136:139], v5 offset:59392
v_mfma_f32_16x16x32_bf16 v[140:143], a[104:107], a[40:43], v[140:143]
ds_read_b128 a[140:143], v5 offset:60416
v_mfma_f32_16x16x32_bf16 v[156:159], a[104:107], a[44:47], v[156:159]
v_mfma_f32_16x16x32_bf16 v[160:163], a[108:111], a[44:47], v[160:163]
buffer_load_dwordx4 a[36:39], v4, s[40:43], s35 offen offset:1024 sc1
s_add_u32 s35, s77, 544768
v_mfma_f32_16x16x32_bf16 v[144:147], a[108:111], a[40:43], v[144:147]
s_waitcnt vmcnt(10) lgkmcnt(4)
v_mfma_f32_16x16x32_bf16 v[132:135], a[112:115], a[48:51], v[132:135]
ds_read_b128 a[96:99], v5 offset:61440
v_mfma_f32_16x16x32_bf16 v[148:151], a[112:115], a[52:55], v[148:151]
ds_read_b128 a[100:103], v5 offset:62464
v_mfma_f32_16x16x32_bf16 v[152:155], a[116:119], a[52:55], v[152:155]
buffer_load_dwordx4 a[40:43], v4, s[40:43], s35 offen offset:0 sc1
v_mfma_f32_16x16x32_bf16 v[136:139], a[116:119], a[48:51], v[136:139]
ds_read_b128 a[104:107], v5 offset:63488
v_mfma_f32_16x16x32_bf16 v[140:143], a[120:123], a[48:51], v[140:143]
ds_read_b128 a[108:111], v5 offset:64512
v_mfma_f32_16x16x32_bf16 v[156:159], a[120:123], a[52:55], v[156:159]
v_mfma_f32_16x16x32_bf16 v[160:163], a[124:127], a[52:55], v[160:163]
buffer_load_dwordx4 a[44:47], v4, s[40:43], s35 offen offset:1024 sc1
s_add_u32 s35, s77, 557056
v_mfma_f32_16x16x32_bf16 v[144:147], a[124:127], a[48:51], v[144:147]
s_waitcnt vmcnt(10) lgkmcnt(4)
v_mfma_f32_16x16x32_bf16 v[132:135], a[128:131], a[0:3], v[132:135]
ds_read_b128 a[112:115], v6 offset:0
v_mfma_f32_16x16x32_bf16 v[148:151], a[128:131], a[4:7], v[148:151]
ds_read_b128 a[116:119], v6 offset:1024
v_mfma_f32_16x16x32_bf16 v[152:155], a[132:135], a[4:7], v[152:155]
buffer_load_dwordx4 a[48:51], v4, s[40:43], s35 offen offset:0 sc1
v_mfma_f32_16x16x32_bf16 v[136:139], a[132:135], a[0:3], v[136:139]
ds_read_b128 a[120:123], v6 offset:2048
v_mfma_f32_16x16x32_bf16 v[140:143], a[136:139], a[0:3], v[140:143]
ds_read_b128 a[124:127], v6 offset:3072
v_mfma_f32_16x16x32_bf16 v[156:159], a[136:139], a[4:7], v[156:159]
v_mfma_f32_16x16x32_bf16 v[160:163], a[140:143], a[4:7], v[160:163]
buffer_load_dwordx4 a[52:55], v4, s[40:43], s35 offen offset:1024 sc1
s_add_u32 s35, s77, 561152
v_mfma_f32_16x16x32_bf16 v[144:147], a[140:143], a[0:3], v[144:147]
s_waitcnt vmcnt(10) lgkmcnt(4)
v_mfma_f32_16x16x32_bf16 v[132:135], a[96:99], a[8:11], v[132:135]
ds_read_b128 a[128:131], v6 offset:4096
v_mfma_f32_16x16x32_bf16 v[148:151], a[96:99], a[12:15], v[148:151]
ds_read_b128 a[132:135], v6 offset:5120
v_mfma_f32_16x16x32_bf16 v[152:155], a[100:103], a[12:15], v[152:155]
buffer_load_dwordx4 a[0:3], v4, s[40:43], s35 offen offset:0 sc1
v_mfma_f32_16x16x32_bf16 v[136:139], a[100:103], a[8:11], v[136:139]
ds_read_b128 a[136:139], v6 offset:6144
v_mfma_f32_16x16x32_bf16 v[140:143], a[104:107], a[8:11], v[140:143]
ds_read_b128 a[140:143], v6 offset:7168
v_mfma_f32_16x16x32_bf16 v[156:159], a[104:107], a[12:15], v[156:159]
v_mfma_f32_16x16x32_bf16 v[160:163], a[108:111], a[12:15], v[160:163]
buffer_load_dwordx4 a[4:7], v4, s[40:43], s35 offen offset:1024 sc1
s_add_u32 s35, s77, 573440
v_mfma_f32_16x16x32_bf16 v[144:147], a[108:111], a[8:11], v[144:147]
s_waitcnt vmcnt(10) lgkmcnt(4)
v_mfma_f32_16x16x32_bf16 v[132:135], a[112:115], a[16:19], v[132:135]
ds_read_b128 a[96:99], v6 offset:8192
v_mfma_f32_16x16x32_bf16 v[148:151], a[112:115], a[20:23], v[148:151]
ds_read_b128 a[100:103], v6 offset:9216
v_mfma_f32_16x16x32_bf16 v[152:155], a[116:119], a[20:23], v[152:155]
buffer_load_dwordx4 a[8:11], v4, s[40:43], s35 offen offset:0 sc1
v_mfma_f32_16x16x32_bf16 v[136:139], a[116:119], a[16:19], v[136:139]
ds_read_b128 a[104:107], v6 offset:10240
v_mfma_f32_16x16x32_bf16 v[140:143], a[120:123], a[16:19], v[140:143]
ds_read_b128 a[108:111], v6 offset:11264
v_mfma_f32_16x16x32_bf16 v[156:159], a[120:123], a[20:23], v[156:159]
v_mfma_f32_16x16x32_bf16 v[160:163], a[124:127], a[20:23], v[160:163]
buffer_load_dwordx4 a[12:15], v4, s[40:43], s35 offen offset:1024 sc1
s_add_u32 s35, s77, 577536
v_mfma_f32_16x16x32_bf16 v[144:147], a[124:127], a[16:19], v[144:147]
s_waitcnt vmcnt(10) lgkmcnt(4)
v_mfma_f32_16x16x32_bf16 v[132:135], a[128:131], a[24:27], v[132:135]
ds_read_b128 a[112:115], v6 offset:12288
v_mfma_f32_16x16x32_bf16 v[148:151], a[128:131], a[28:31], v[148:151]
ds_read_b128 a[116:119], v6 offset:13312
v_mfma_f32_16x16x32_bf16 v[152:155], a[132:135], a[28:31], v[152:155]
buffer_load_dwordx4 a[16:19], v4, s[40:43], s35 offen offset:0 sc1
v_mfma_f32_16x16x32_bf16 v[136:139], a[132:135], a[24:27], v[136:139]
ds_read_b128 a[120:123], v6 offset:14336
v_mfma_f32_16x16x32_bf16 v[140:143], a[136:139], a[24:27], v[140:143]
ds_read_b128 a[124:127], v6 offset:15360
v_mfma_f32_16x16x32_bf16 v[156:159], a[136:139], a[28:31], v[156:159]
v_mfma_f32_16x16x32_bf16 v[160:163], a[140:143], a[28:31], v[160:163]
buffer_load_dwordx4 a[20:23], v4, s[40:43], s35 offen offset:1024 sc1
s_add_u32 s35, s77, 589824
v_mfma_f32_16x16x32_bf16 v[144:147], a[140:143], a[24:27], v[144:147]
s_waitcnt vmcnt(10) lgkmcnt(4)
v_mfma_f32_16x16x32_bf16 v[132:135], a[96:99], a[32:35], v[132:135]
ds_read_b128 a[128:131], v6 offset:16384
v_mfma_f32_16x16x32_bf16 v[148:151], a[96:99], a[36:39], v[148:151]
ds_read_b128 a[132:135], v6 offset:17408
v_mfma_f32_16x16x32_bf16 v[152:155], a[100:103], a[36:39], v[152:155]
buffer_load_dwordx4 a[24:27], v4, s[40:43], s35 offen offset:0 sc1
v_mfma_f32_16x16x32_bf16 v[136:139], a[100:103], a[32:35], v[136:139]
ds_read_b128 a[136:139], v6 offset:18432
v_mfma_f32_16x16x32_bf16 v[140:143], a[104:107], a[32:35], v[140:143]
ds_read_b128 a[140:143], v6 offset:19456
v_mfma_f32_16x16x32_bf16 v[156:159], a[104:107], a[36:39], v[156:159]
v_mfma_f32_16x16x32_bf16 v[160:163], a[108:111], a[36:39], v[160:163]
buffer_load_dwordx4 a[28:31], v4, s[40:43], s35 offen offset:1024 sc1
s_add_u32 s35, s77, 593920
v_mfma_f32_16x16x32_bf16 v[144:147], a[108:111], a[32:35], v[144:147]
s_waitcnt vmcnt(10) lgkmcnt(4)
v_mfma_f32_16x16x32_bf16 v[132:135], a[112:115], a[40:43], v[132:135]
ds_read_b128 a[96:99], v6 offset:20480
v_mfma_f32_16x16x32_bf16 v[148:151], a[112:115], a[44:47], v[148:151]
ds_read_b128 a[100:103], v6 offset:21504
v_mfma_f32_16x16x32_bf16 v[152:155], a[116:119], a[44:47], v[152:155]
buffer_load_dwordx4 a[32:35], v4, s[40:43], s35 offen offset:0 sc1
v_mfma_f32_16x16x32_bf16 v[136:139], a[116:119], a[40:43], v[136:139]
ds_read_b128 a[104:107], v6 offset:22528
v_mfma_f32_16x16x32_bf16 v[140:143], a[120:123], a[40:43], v[140:143]
ds_read_b128 a[108:111], v6 offset:23552
v_mfma_f32_16x16x32_bf16 v[156:159], a[120:123], a[44:47], v[156:159]
v_mfma_f32_16x16x32_bf16 v[160:163], a[124:127], a[44:47], v[160:163]
buffer_load_dwordx4 a[36:39], v4, s[40:43], s35 offen offset:1024 sc1
s_add_u32 s35, s77, 606208
v_mfma_f32_16x16x32_bf16 v[144:147], a[124:127], a[40:43], v[144:147]
s_waitcnt vmcnt(10) lgkmcnt(4)
v_mfma_f32_16x16x32_bf16 v[132:135], a[128:131], a[48:51], v[132:135]
ds_read_b128 a[112:115], v6 offset:24576
v_mfma_f32_16x16x32_bf16 v[148:151], a[128:131], a[52:55], v[148:151]
ds_read_b128 a[116:119], v6 offset:25600
v_mfma_f32_16x16x32_bf16 v[152:155], a[132:135], a[52:55], v[152:155]
buffer_load_dwordx4 a[40:43], v4, s[40:43], s35 offen offset:0 sc1
v_mfma_f32_16x16x32_bf16 v[136:139], a[132:135], a[48:51], v[136:139]
ds_read_b128 a[120:123], v6 offset:26624
v_mfma_f32_16x16x32_bf16 v[140:143], a[136:139], a[48:51], v[140:143]
s_add_u32 s88, s67, 0xe0000
s_add_u32 s89, s66, 0xd0000
v_mfma_f32_16x16x32_bf16 v[156:159], a[136:139], a[52:55], v[156:159]
buffer_load_dword v11, v255, s[4:7], s88 offen sc1
v_mfma_f32_16x16x32_bf16 v[160:163], a[140:143], a[52:55], v[160:163]
buffer_load_dwordx4 a[44:47], v4, s[40:43], s35 offen offset:1024 sc1
s_add_u32 s35, s77, 610304
v_mfma_f32_16x16x32_bf16 v[144:147], a[140:143], a[48:51], v[144:147]
ds_read_b128 a[124:127], v6 offset:27648
s_waitcnt vmcnt(11) lgkmcnt(4)
v_mfma_f32_16x16x32_bf16 v[132:135], a[96:99], a[0:3], v[132:135]
buffer_load_dword v232, v255, s[4:7], s89 offen offset:64 sc1
v_mfma_f32_16x16x32_bf16 v[148:151], a[96:99], a[4:7], v[148:151]
ds_read_b128 a[128:131], v6 offset:28672
v_mfma_f32_16x16x32_bf16 v[152:155], a[100:103], a[4:7], v[152:155]
buffer_load_dwordx4 a[48:51], v4, s[40:43], s35 offen offset:0 sc1
v_mfma_f32_16x16x32_bf16 v[136:139], a[100:103], a[0:3], v[136:139]
ds_read_b128 a[132:135], v6 offset:29696
v_mfma_f32_16x16x32_bf16 v[140:143], a[104:107], a[0:3], v[140:143]
ds_read_b128 a[136:139], v6 offset:30720
v_mfma_f32_16x16x32_bf16 v[156:159], a[104:107], a[4:7], v[156:159]
ds_read_b128 a[140:143], v6 offset:31744
v_mfma_f32_16x16x32_bf16 v[160:163], a[108:111], a[4:7], v[160:163]
buffer_load_dwordx4 a[52:55], v4, s[40:43], s35 offen offset:1024 sc1
s_add_u32 s35, s77, 622592
v_mfma_f32_16x16x32_bf16 v[144:147], a[108:111], a[0:3], v[144:147]
s_waitcnt vmcnt(12) lgkmcnt(4)
v_mfma_f32_16x16x32_bf16 v[132:135], a[112:115], a[8:11], v[132:135]
ds_read_b128 a[96:99], v6 offset:32768
v_mfma_f32_16x16x32_bf16 v[148:151], a[112:115], a[12:15], v[148:151]
ds_read_b128 a[100:103], v6 offset:33792
v_mfma_f32_16x16x32_bf16 v[152:155], a[116:119], a[12:15], v[152:155]
buffer_load_dwordx4 a[0:3], v4, s[40:43], s35 offen offset:0 sc1
v_mfma_f32_16x16x32_bf16 v[136:139], a[116:119], a[8:11], v[136:139]
ds_read_b128 a[104:107], v6 offset:34816
v_mfma_f32_16x16x32_bf16 v[140:143], a[120:123], a[8:11], v[140:143]
ds_read_b128 a[108:111], v6 offset:35840
v_mfma_f32_16x16x32_bf16 v[156:159], a[120:123], a[12:15], v[156:159]
v_mfma_f32_16x16x32_bf16 v[160:163], a[124:127], a[12:15], v[160:163]
buffer_load_dwordx4 a[4:7], v4, s[40:43], s35 offen offset:1024 sc1
s_add_u32 s35, s77, 626688
v_mfma_f32_16x16x32_bf16 v[144:147], a[124:127], a[8:11], v[144:147]
s_waitcnt vmcnt(12) lgkmcnt(4)
v_mfma_f32_16x16x32_bf16 v[132:135], a[128:131], a[16:19], v[132:135]
ds_read_b128 a[112:115], v6 offset:36864
v_mfma_f32_16x16x32_bf16 v[148:151], a[128:131], a[20:23], v[148:151]
ds_read_b128 a[116:119], v6 offset:37888
v_mfma_f32_16x16x32_bf16 v[152:155], a[132:135], a[20:23], v[152:155]
buffer_load_dwordx4 a[8:11], v4, s[40:43], s35 offen offset:0 sc1
v_mfma_f32_16x16x32_bf16 v[136:139], a[132:135], a[16:19], v[136:139]
ds_read_b128 a[120:123], v6 offset:38912
v_mfma_f32_16x16x32_bf16 v[140:143], a[136:139], a[16:19], v[140:143]
ds_read_b128 a[124:127], v6 offset:39936
v_mfma_f32_16x16x32_bf16 v[156:159], a[136:139], a[20:23], v[156:159]
v_mfma_f32_16x16x32_bf16 v[160:163], a[140:143], a[20:23], v[160:163]
buffer_load_dwordx4 a[12:15], v4, s[40:43], s35 offen offset:1024 sc1
s_add_u32 s35, s77, 638976
v_mfma_f32_16x16x32_bf16 v[144:147], a[140:143], a[16:19], v[144:147]
s_waitcnt vmcnt(12) lgkmcnt(4)
v_mfma_f32_16x16x32_bf16 v[132:135], a[96:99], a[24:27], v[132:135]
ds_read_b128 a[128:131], v6 offset:40960
v_mfma_f32_16x16x32_bf16 v[148:151], a[96:99], a[28:31], v[148:151]
ds_read_b128 a[132:135], v6 offset:41984
v_mfma_f32_16x16x32_bf16 v[152:155], a[100:103], a[28:31], v[152:155]
buffer_load_dwordx4 a[16:19], v4, s[40:43], s35 offen offset:0 sc1
v_mfma_f32_16x16x32_bf16 v[136:139], a[100:103], a[24:27], v[136:139]
ds_read_b128 a[136:139], v6 offset:43008
v_mfma_f32_16x16x32_bf16 v[140:143], a[104:107], a[24:27], v[140:143]
ds_read_b128 a[140:143], v6 offset:44032
v_mfma_f32_16x16x32_bf16 v[156:159], a[104:107], a[28:31], v[156:159]
v_mfma_f32_16x16x32_bf16 v[160:163], a[108:111], a[28:31], v[160:163]
buffer_load_dwordx4 a[20:23], v4, s[40:43], s35 offen offset:1024 sc1
s_add_u32 s35, s77, 643072
v_mfma_f32_16x16x32_bf16 v[144:147], a[108:111], a[24:27], v[144:147]
s_waitcnt vmcnt(12) lgkmcnt(4)
v_mfma_f32_16x16x32_bf16 v[132:135], a[112:115], a[32:35], v[132:135]
ds_read_b128 a[96:99], v6 offset:45056
v_mfma_f32_16x16x32_bf16 v[148:151], a[112:115], a[36:39], v[148:151]
ds_read_b128 a[100:103], v6 offset:46080
v_mfma_f32_16x16x32_bf16 v[152:155], a[116:119], a[36:39], v[152:155]
buffer_load_dwordx4 a[24:27], v4, s[40:43], s35 offen offset:0 sc1
v_mfma_f32_16x16x32_bf16 v[136:139], a[116:119], a[32:35], v[136:139]
ds_read_b128 a[104:107], v6 offset:47104
v_mfma_f32_16x16x32_bf16 v[140:143], a[120:123], a[32:35], v[140:143]
ds_read_b128 a[108:111], v6 offset:48128
v_mfma_f32_16x16x32_bf16 v[156:159], a[120:123], a[36:39], v[156:159]
v_mfma_f32_16x16x32_bf16 v[160:163], a[124:127], a[36:39], v[160:163]
buffer_load_dwordx4 a[28:31], v4, s[40:43], s35 offen offset:1024 sc1
s_add_u32 s35, s77, 1048576
v_mfma_f32_16x16x32_bf16 v[144:147], a[124:127], a[32:35], v[144:147]
s_waitcnt vmcnt(11) lgkmcnt(4)
v_cmp_ne_u32 vcc, v11, v15
s_cbranch_vccnz Ltr_12
Lte_14:
v_mfma_f32_16x16x32_bf16 v[132:135], a[128:131], a[40:43], v[132:135]
s_add_u32 m0, s18, 0x0
s_add_u32 s44, s50, 0x2800000
v_mfma_f32_16x16x32_bf16 v[148:151], a[128:131], a[44:47], v[148:151]
ds_read_b128 a[112:115], v6 offset:49152
v_mfma_f32_16x16x32_bf16 v[152:155], a[132:135], a[44:47], v[152:155]
buffer_load_dwordx4 v1, s[4:7], s44 offen offset:0 sc1 lds
v_mfma_f32_16x16x32_bf16 v[136:139], a[132:135], a[40:43], v[136:139]
ds_read_b128 a[116:119], v6 offset:50176
v_mfma_f32_16x16x32_bf16 v[140:143], a[136:139], a[40:43], v[140:143]
ds_read_b128 a[120:123], v6 offset:51200
v_mfma_f32_16x16x32_bf16 v[156:159], a[136:139], a[44:47], v[156:159]
ds_read_b128 a[124:127], v6 offset:52224
v_mfma_f32_16x16x32_bf16 v[160:163], a[140:143], a[44:47], v[160:163]
buffer_load_dwordx4 v1, s[4:7], s44 offen offset:1024 sc1 lds
s_add_u32 m0, s18, 0x2000
v_mfma_f32_16x16x32_bf16 v[144:147], a[140:143], a[40:43], v[144:147]
s_add_u32 s44, s50, 0x2802000
s_waitcnt vmcnt(10) lgkmcnt(4)
v_mfma_f32_16x16x32_bf16 v[132:135], a[96:99], a[48:51], v[132:135]
ds_read_b128 a[128:131], v6 offset:53248
v_mfma_f32_16x16x32_bf16 v[148:151], a[96:99], a[52:55], v[148:151]
ds_read_b128 a[132:135], v6 offset:54272
v_mfma_f32_16x16x32_bf16 v[152:155], a[100:103], a[52:55], v[152:155]
buffer_load_dwordx4 v1, s[4:7], s44 offen offset:0 sc1 lds
v_mfma_f32_16x16x32_bf16 v[136:139], a[100:103], a[48:51], v[136:139]
ds_read_b128 a[136:139], v6 offset:55296
v_mfma_f32_16x16x32_bf16 v[140:143], a[104:107], a[48:51], v[140:143]
ds_read_b128 a[140:143], v6 offset:56320
v_mfma_f32_16x16x32_bf16 v[156:159], a[104:107], a[52:55], v[156:159]
v_mfma_f32_16x16x32_bf16 v[160:163], a[108:111], a[52:55], v[160:163]
buffer_load_dwordx4 v1, s[4:7], s44 offen offset:1024 sc1 lds
s_add_u32 m0, s18, 0x4000
v_mfma_f32_16x16x32_bf16 v[144:147], a[108:111], a[48:51], v[144:147]
s_add_u32 s44, s50, 0x2804000
s_waitcnt vmcnt(10) lgkmcnt(4)
v_mfma_f32_16x16x32_bf16 v[132:135], a[112:115], a[0:3], v[132:135]
ds_read_b128 a[96:99], v6 offset:57344
v_mfma_f32_16x16x32_bf16 v[148:151], a[112:115], a[4:7], v[148:151]
ds_read_b128 a[100:103], v6 offset:58368
v_mfma_f32_16x16x32_bf16 v[152:155], a[116:119], a[4:7], v[152:155]
ds_read_b128 a[104:107], v6 offset:59392
v_mfma_f32_16x16x32_bf16 v[136:139], a[116:119], a[0:3], v[136:139]
buffer_load_dwordx4 v1, s[4:7], s44 offen offset:0 sc1 lds
v_mfma_f32_16x16x32_bf16 v[140:143], a[120:123], a[0:3], v[140:143]
ds_read_b128 a[108:111], v6 offset:60416
v_mfma_f32_16x16x32_bf16 v[156:159], a[120:123], a[4:7], v[156:159]
v_mfma_f32_16x16x32_bf16 v[160:163], a[124:127], a[4:7], v[160:163]
v_mfma_f32_16x16x32_bf16 v[144:147], a[124:127], a[0:3], v[144:147]
buffer_load_dwordx4 v1, s[4:7], s44 offen offset:1024 sc1 lds
s_waitcnt vmcnt(10) lgkmcnt(4)
v_mfma_f32_16x16x32_bf16 v[132:135], a[128:131], a[8:11], v[132:135]
s_add_u32 m0, s18, 0x6000
s_add_u32 s44, s50, 0x2806000
v_mfma_f32_16x16x32_bf16 v[148:151], a[128:131], a[12:15], v[148:151]
ds_read_b128 a[112:115], v6 offset:61440
v_mfma_f32_16x16x32_bf16 v[152:155], a[132:135], a[12:15], v[152:155]
ds_read_b128 a[116:119], v6 offset:62464
v_mfma_f32_16x16x32_bf16 v[136:139], a[132:135], a[8:11], v[136:139]
ds_read_b128 a[120:123], v6 offset:63488
v_mfma_f32_16x16x32_bf16 v[140:143], a[136:139], a[8:11], v[140:143]
buffer_load_dwordx4 v1, s[4:7], s44 offen offset:0 sc1 lds
v_mfma_f32_16x16x32_bf16 v[156:159], a[136:139], a[12:15], v[156:159]
ds_read_b128 a[124:127], v6 offset:64512
v_mfma_f32_16x16x32_bf16 v[160:163], a[140:143], a[12:15], v[160:163]
v_mfma_f32_16x16x32_bf16 v[144:147], a[140:143], a[8:11], v[144:147]
s_waitcnt vmcnt(9) lgkmcnt(4)
v_mfma_f32_16x16x32_bf16 v[132:135], a[96:99], a[16:19], v[132:135]
v_mfma_f32_16x16x32_bf16 v[148:151], a[96:99], a[20:23], v[148:151]
buffer_load_dwordx4 v1, s[4:7], s44 offen offset:1024 sc1 lds
v_mfma_f32_16x16x32_bf16 v[152:155], a[100:103], a[20:23], v[152:155]
v_mfma_f32_16x16x32_bf16 v[136:139], a[100:103], a[16:19], v[136:139]
v_mfma_f32_16x16x32_bf16 v[140:143], a[104:107], a[16:19], v[140:143]
v_mfma_f32_16x16x32_bf16 v[156:159], a[104:107], a[20:23], v[156:159]
v_mfma_f32_16x16x32_bf16 v[160:163], a[108:111], a[20:23], v[160:163]
v_mfma_f32_16x16x32_bf16 v[144:147], a[108:111], a[16:19], v[144:147]
s_waitcnt vmcnt(8) lgkmcnt(0)
v_mfma_f32_16x16x32_bf16 v[132:135], a[112:115], a[24:27], v[132:135]
v_mfma_f32_16x16x32_bf16 v[148:151], a[112:115], a[28:31], v[148:151]
v_mfma_f32_16x16x32_bf16 v[152:155], a[116:119], a[28:31], v[152:155]
v_mfma_f32_16x16x32_bf16 v[136:139], a[116:119], a[24:27], v[136:139]
v_mfma_f32_16x16x32_bf16 v[140:143], a[120:123], a[24:27], v[140:143]
v_mfma_f32_16x16x32_bf16 v[156:159], a[120:123], a[28:31], v[156:159]
v_mfma_f32_16x16x32_bf16 v[160:163], a[124:127], a[28:31], v[160:163]
v_mfma_f32_16x16x32_bf16 v[144:147], a[124:127], a[24:27], v[144:147]
s_nop 0
v_cvt_pk_bf16_f32 v32, v132, v133
v_cvt_pk_bf16_f32 v33, v134, v135
s_nop 0
v_cvt_pk_bf16_f32 v34, v136, v137
v_cvt_pk_bf16_f32 v35, v138, v139
s_add_u32 s36, s69, 0x400000
buffer_store_dwordx4 v[32:35], v4, s[4:7], s36 offen offset:0 sc1
v_cvt_pk_bf16_f32 v40, v148, v149
v_cvt_pk_bf16_f32 v41, v150, v151
v_cvt_pk_bf16_f32 v42, v152, v153
v_cvt_pk_bf16_f32 v43, v154, v155
v_cvt_pk_bf16_f32 v36, v140, v141
v_cvt_pk_bf16_f32 v37, v142, v143
v_cvt_pk_bf16_f32 v38, v144, v145
v_cvt_pk_bf16_f32 v39, v146, v147
s_add_u32 s37, s36, 4096
v_cvt_pk_bf16_f32 v44, v156, v157
v_cvt_pk_bf16_f32 v45, v158, v159
v_cvt_pk_bf16_f32 v46, v160, v161
buffer_store_dwordx4 v[40:43], v4, s[4:7], s36 offen offset:1024 sc1
v_cvt_pk_bf16_f32 v47, v162, v163
v_mfma_f32_16x16x32_bf16 v[96:99], v[32:35], v[32:35], 0
s_mov_b32 s38, 0x300000
s_add_u32 s92, s78, 0x40000
v_mfma_f32_16x16x32_bf16 v[92:95], v[16:19], v[32:35], 0
s_add_u32 s40, s4, 0x400000
s_addc_u32 s41, s5, 0
v_mfma_f32_16x16x32_bf16 v[96:99], v[36:39], v[36:39], v[96:99]
buffer_store_dwordx4 v[36:39], v4, s[4:7], s37 offen offset:0 sc1
v_mfma_f32_16x16x32_bf16 v[92:95], v[16:19], v[36:39], v[92:95]
s_nop 5
v_cndmask_b32 v96, v96, v97, s[46:47]
v_cndmask_b32 v98, v98, v99, s[46:47]
v_mfma_f32_16x16x32_bf16 v[104:107], v[40:43], v[40:43], 0
v_mfma_f32_16x16x32_bf16 v[100:103], v[16:19], v[40:43], 0
v_cndmask_b32 v93, v96, v98, s[48:49]
buffer_store_dwordx4 v[44:47], v4, s[4:7], s37 offen offset:1024 sc1
v_mfma_f32_16x16x32_bf16 v[104:107], v[44:47], v[44:47], v[104:107]
v_mfma_f32_16x16x32_bf16 v[100:103], v[16:19], v[44:47], v[100:103]
s_nop 6
v_cndmask_b32 v104, v104, v105, s[46:47]
v_cndmask_b32 v106, v106, v107, s[46:47]
buffer_store_dwordx2 v[92:93], v253, s[4:7], s38 offen offset:0 sc1
v_cndmask_b32 v101, v104, v106, s[48:49]
L_stub4:
s_cbranch_execz L_wret1
buffer_store_dwordx2 v[100:101], v253, s[4:7], s38 offen offset:2048 sc1
v_cmp_ne_u32 vcc, v232, v15
s_cbranch_vccnz Ltr_15
Lte_17:
s_barrier
s_add_u32 m0, s18, 0x8000
s_add_u32 s44, s50, 0x2808000
buffer_load_dwordx4 v1, s[4:7], s44 offen offset:0 sc1 lds
buffer_load_dwordx4 v1, s[4:7], s44 offen offset:1024 sc1 lds
s_add_u32 m0, s18, 0xa000
s_add_u32 s44, s50, 0x280a000
buffer_load_dwordx4 v1, s[4:7], s44 offen offset:0 sc1 lds
buffer_load_dwordx4 v1, s[4:7], s44 offen offset:1024 sc1 lds
s_waitcnt vmcnt(4)
s_barrier
s_cmp_lg_u32 s28, 0
s_cbranch_scc1 Lsg_18
buffer_atomic_add v12, v10, s[4:7], s92 offen sc1
Lsg_18:
s_mov_b64 exec, 0
s_cmp_eq_u32 s28, 0
s_cbranch_scc1 L_stub5
L_wret2:
s_mov_b64 exec, -1
s_cmp_lt_u32 s28, 2
s_cbranch_scc1 Lwd_19
s_add_u32 m0, s19, 0xa000
s_add_u32 s44, s50, 0x280a000
s_add_u32 s44, s44, s18
buffer_load_dwordx4 v1, s[4:7], s44 offen offset:0 sc1 lds
buffer_load_dwordx4 v1, s[4:7], s44 offen offset:1024 sc1 lds
buffer_load_dwordx4 v1, s[4:7], s44 offen offset:2048 sc1 lds
buffer_load_dwordx4 v1, s[4:7], s44 offen offset:3072 sc1 lds
s_add_u32 m0, s19, 0xc000
s_add_u32 s44, s50, 0x280c000
s_add_u32 s44, s44, s18
buffer_load_dwordx4 v1, s[4:7], s44 offen offset:0 sc1 lds
buffer_load_dwordx4 v1, s[4:7], s44 offen offset:1024 sc1 lds
buffer_load_dwordx4 v1, s[4:7], s44 offen offset:2048 sc1 lds
buffer_load_dwordx4 v1, s[4:7], s44 offen offset:3072 sc1 lds
s_add_u32 m0, s19, 0xe000
s_add_u32 s44, s50, 0x280e000
s_add_u32 s44, s44, s18
buffer_load_dwordx4 v1, s[4:7], s44 offen offset:0 sc1 lds
buffer_load_dwordx4 v1, s[4:7], s44 offen offset:1024 sc1 lds
buffer_load_dwordx4 v1, s[4:7], s44 offen offset:2048 sc1 lds
buffer_load_dwordx4 v1, s[4:7], s44 offen offset:3072 sc1 lds
s_add_u32 m0, s19, 0x10000
s_add_u32 s44, s50, 0x2810000
s_add_u32 s44, s44, s18
buffer_load_dwordx4 v1, s[4:7], s44 offen offset:0 sc1 lds
buffer_load_dwordx4 v1, s[4:7], s44 offen offset:1024 sc1 lds
buffer_load_dwordx4 v1, s[4:7], s44 offen offset:2048 sc1 lds
buffer_load_dwordx4 v1, s[4:7], s44 offen offset:3072 sc1 lds
s_add_u32 m0, s19, 0x12000
s_add_u32 s44, s50, 0x2812000
s_add_u32 s44, s44, s18
buffer_load_dwordx4 v1, s[4:7], s44 offen offset:0 sc1 lds
buffer_load_dwordx4 v1, s[4:7], s44 offen offset:1024 sc1 lds
buffer_load_dwordx4 v1, s[4:7], s44 offen offset:2048 sc1 lds
buffer_load_dwordx4 v1, s[4:7], s44 offen offset:3072 sc1 lds
s_add_u32 m0, s19, 0x14000
s_add_u32 s44, s50, 0x2814000
s_add_u32 s44, s44, s18
buffer_load_dwordx4 v1, s[4:7], s44 offen offset:0 sc1 lds
buffer_load_dwordx4 v1, s[4:7], s44 offen offset:1024 sc1 lds
buffer_load_dwordx4 v1, s[4:7], s44 offen offset:2048 sc1 lds
buffer_load_dwordx4 v1, s[4:7], s44 offen offset:3072 sc1 lds
s_add_u32 m0, s19, 0x16000
s_add_u32 s44, s50, 0x2816000
s_add_u32 s44, s44, s18
buffer_load_dwordx4 v1, s[4:7], s44 offen offset:0 sc1 lds
buffer_load_dwordx4 v1, s[4:7], s44 offen offset:1024 sc1 lds
buffer_load_dwordx4 v1, s[4:7], s44 offen offset:2048 sc1 lds
buffer_load_dwordx4 v1, s[4:7], s44 offen offset:3072 sc1 lds
s_add_u32 m0, s19, 0x18000
s_add_u32 s44, s50, 0x2818000
s_add_u32 s44, s44, s18
buffer_load_dwordx4 v1, s[4:7], s44 offen offset:0 sc1 lds
buffer_load_dwordx4 v1, s[4:7], s44 offen offset:1024 sc1 lds
buffer_load_dwordx4 v1, s[4:7], s44 offen offset:2048 sc1 lds
buffer_load_dwordx4 v1, s[4:7], s44 offen offset:3072 sc1 lds
Lwd_19:
s_cmp_lg_u32 s28, 1
s_cbranch_scc1 Lpo_22
s_add_u32 s36, s34, 0x40000
s_mov_b32 s37, 0
v_mov_b32 v11, 0
buffer_atomic_add v11, v251, s[4:7], s36 offen sc0 sc1
s_sleep 4
Lpoll_20:
v_mov_b32 v234, 0
buffer_atomic_add v234, v251, s[4:7], s36 offen sc0 sc1
s_waitcnt vmcnt(1)
v_readfirstlane_b32 s38, v11
s_nop 0
s_cmp_ge_u32 s38, 32
s_cbranch_scc1 Lpe_21
v_mov_b32 v11, 0
buffer_atomic_add v11, v251, s[4:7], s36 offen sc0 sc1
s_waitcnt vmcnt(1)
v_readfirstlane_b32 s38, v234
s_nop 0
s_cmp_ge_u32 s38, 32
s_cbranch_scc1 Lpe_21
s_add_u32 s37, s37, 1
s_cmp_lt_u32 s37, 0x80000
s_cbranch_scc1 Lpoll_20
s_waitcnt vmcnt(0)
Lpo_22:
s_waitcnt vmcnt(32) lgkmcnt(0)
s_cmp_ge_u32 s28, 2
s_cbranch_scc1 Lw_23
s_waitcnt vmcnt(0)
Lw_23:
Lpe_21:
s_barrier
s_mov_b32 s35, s68
s_add_u32 s33, s35, 0x1000
buffer_load_dwordx4 a[0:3], v2, s[40:43], s35 offen offset:0 sc1
buffer_load_dwordx4 a[4:7], v2, s[40:43], s33 offen offset:0 sc1
buffer_load_dwordx4 a[8:11], v2, s[40:43], s35 offen offset:1024 sc1
buffer_load_dwordx4 a[12:15], v2, s[40:43], s33 offen offset:1024 sc1
buffer_load_dwordx4 a[16:19], v2, s[40:43], s35 offen offset:2048 sc1
buffer_load_dwordx4 a[20:23], v2, s[40:43], s33 offen offset:2048 sc1
buffer_load_dwordx4 a[24:27], v2, s[40:43], s35 offen offset:3072 sc1
buffer_load_dwordx4 a[28:31], v2, s[40:43], s33 offen offset:3072 sc1
s_add_u32 s35, s35, 0x4000
s_add_u32 s33, s33, 0x4000
buffer_load_dwordx4 a[32:35], v2, s[40:43], s35 offen offset:0 sc1
buffer_load_dwordx4 a[36:39], v2, s[40:43], s33 offen offset:0 sc1
buffer_load_dwordx4 a[40:43], v2, s[40:43], s35 offen offset:1024 sc1
buffer_load_dwordx4 a[44:47], v2, s[40:43], s33 offen offset:1024 sc1
buffer_load_dwordx4 a[48:51], v2, s[40:43], s35 offen offset:2048 sc1
buffer_load_dwordx4 a[52:55], v2, s[40:43], s33 offen offset:2048 sc1
buffer_load_dwordx4 a[56:59], v2, s[40:43], s35 offen offset:3072 sc1
buffer_load_dwordx4 a[60:63], v2, s[40:43], s33 offen offset:3072 sc1
s_add_u32 s35, s35, 0x4000
s_add_u32 s33, s33, 0x4000
v_add_u32 v5, 0, v1
ds_read_b128 a[96:99], v5 offset:2048
ds_read_b128 a[100:103], v5 offset:8192
ds_read_b128 a[104:107], v5 offset:3072
ds_read_b128 a[108:111], v5 offset:9216
ds_read_b128 a[112:115], v5 offset:4096
ds_read_b128 a[116:119], v5 offset:10240
s_waitcnt vmcnt(14) lgkmcnt(4)
v_mfma_f32_16x16x32_bf16 v[140:143], a[96:99], a[0:3], 0
v_and_b32 v232, 15, v0
v_lshlrev_b32 v232, 7, v232
v_mfma_f32_16x16x32_bf16 v[140:143], a[100:103], a[4:7], v[140:143]
buffer_load_dwordx4 a[64:67], v2, s[40:43], s35 offen offset:0 sc1
s_waitcnt vmcnt(13)
v_mfma_f32_16x16x32_bf16 v[164:167], a[100:103], a[12:15], 0
v_lshrrev_b32 v233, 4, v0
v_lshlrev_b32 v233, 4, v233
v_mfma_f32_16x16x32_bf16 v[164:167], a[96:99], a[8:11], v[164:167]
v_add_u32 v232, v233, v232
s_mul_i32 s38, s30, 12288
s_waitcnt vmcnt(12)
v_mfma_f32_16x16x32_bf16 v[188:191], a[96:99], a[16:19], 0
s_add_u32 s38, s38, 0x1880000
s_add_u32 s39, s28, 4
s_min_u32 s39, s39, 5
s_waitcnt vmcnt(11)
v_mfma_f32_16x16x32_bf16 v[188:191], a[100:103], a[20:23], v[188:191]
buffer_load_dwordx4 a[68:71], v2, s[40:43], s33 offen offset:0 sc1
s_lshl_b32 s36, s28, 11
s_waitcnt vmcnt(10)
v_mfma_f32_16x16x32_bf16 v[212:215], a[100:103], a[28:31], 0
s_add_u32 s36, s36, s38
s_lshl_b32 s37, s39, 11
s_add_u32 s37, s37, s38
v_mfma_f32_16x16x32_bf16 v[212:215], a[96:99], a[24:27], v[212:215]
ds_read_b128 a[128:131], v5 offset:5120
s_waitcnt lgkmcnt(4)
v_mfma_f32_16x16x32_bf16 v[216:219], a[104:107], a[24:27], 0
ds_read_b128 a[132:135], v5 offset:11264
s_waitcnt lgkmcnt(4)
v_mfma_f32_16x16x32_bf16 v[216:219], a[108:111], a[28:31], v[216:219]
ds_read_b128 a[136:139], v5 offset:0
v_mfma_f32_16x16x32_bf16 v[192:195], a[108:111], a[20:23], 0
buffer_load_dwordx4 v[48:51], v232, s[4:7], s36 offen sc1
v_mfma_f32_16x16x32_bf16 v[192:195], a[104:107], a[16:19], v[192:195]
ds_read_b128 a[140:143], v5 offset:6144
v_mfma_f32_16x16x32_bf16 v[168:171], a[104:107], a[8:11], 0
ds_read_b128 a[144:147], v5 offset:1024
v_mfma_f32_16x16x32_bf16 v[168:171], a[108:111], a[12:15], v[168:171]
ds_read_b128 a[148:151], v5 offset:7168
v_mfma_f32_16x16x32_bf16 v[144:147], a[108:111], a[4:7], 0
v_mfma_f32_16x16x32_bf16 v[144:147], a[104:107], a[0:3], v[144:147]
buffer_load_dwordx4 a[72:75], v2, s[40:43], s35 offen offset:1024 sc1
s_waitcnt lgkmcnt(7)
v_mfma_f32_16x16x32_bf16 v[148:151], a[112:115], a[0:3], 0
s_waitcnt lgkmcnt(6)
v_mfma_f32_16x16x32_bf16 v[148:151], a[116:119], a[4:7], v[148:151]
v_mfma_f32_16x16x32_bf16 v[172:175], a[116:119], a[12:15], 0
v_mfma_f32_16x16x32_bf16 v[172:175], a[112:115], a[8:11], v[172:175]
v_mfma_f32_16x16x32_bf16 v[196:199], a[112:115], a[16:19], 0
buffer_load_dwordx4 a[76:79], v2, s[40:43], s33 offen offset:1024 sc1
v_mfma_f32_16x16x32_bf16 v[196:199], a[116:119], a[20:23], v[196:199]
v_mfma_f32_16x16x32_bf16 v[220:223], a[116:119], a[28:31], 0
v_mfma_f32_16x16x32_bf16 v[220:223], a[112:115], a[24:27], v[220:223]
s_waitcnt lgkmcnt(0)
v_mfma_f32_16x16x32_bf16 v[224:227], a[128:131], a[24:27], 0
ds_read_b128 a[96:99], v5 offset:14336
v_mfma_f32_16x16x32_bf16 v[224:227], a[132:135], a[28:31], v[224:227]
buffer_load_dwordx4 a[80:83], v2, s[40:43], s35 offen offset:2048 sc1
v_mfma_f32_16x16x32_bf16 v[200:203], a[132:135], a[20:23], 0
ds_read_b128 a[100:103], v5 offset:20480
v_mfma_f32_16x16x32_bf16 v[200:203], a[128:131], a[16:19], v[200:203]
v_mfma_f32_16x16x32_bf16 v[176:179], a[128:131], a[8:11], 0
v_mfma_f32_16x16x32_bf16 v[176:179], a[132:135], a[12:15], v[176:179]
buffer_load_dwordx4 a[84:87], v2, s[40:43], s33 offen offset:2048 sc1
v_mfma_f32_16x16x32_bf16 v[152:155], a[132:135], a[4:7], 0
ds_read_b128 a[104:107], v5 offset:15360
v_mfma_f32_16x16x32_bf16 v[152:155], a[128:131], a[0:3], v[152:155]
v_mfma_f32_16x16x32_bf16 v[132:135], a[136:139], a[0:3], 0
ds_read_b128 a[108:111], v5 offset:21504
v_mfma_f32_16x16x32_bf16 v[132:135], a[140:143], a[4:7], v[132:135]
v_mfma_f32_16x16x32_bf16 v[156:159], a[140:143], a[12:15], 0
buffer_load_dwordx4 v[52:55], v232, s[4:7], s37 offen sc1
s_add_u32 m0, s18, 0x1c000
v_mfma_f32_16x16x32_bf16 v[156:159], a[136:139], a[8:11], v[156:159]
s_add_u32 s44, s50, 0x281c000
ds_read_b128 a[112:115], v5 offset:16384
v_mfma_f32_16x16x32_bf16 v[180:183], a[136:139], a[16:19], 0
v_mfma_f32_16x16x32_bf16 v[180:183], a[140:143], a[20:23], v[180:183]
ds_read_b128 a[116:119], v5 offset:22528
v_mfma_f32_16x16x32_bf16 v[204:207], a[140:143], a[28:31], 0
v_mfma_f32_16x16x32_bf16 v[204:207], a[136:139], a[24:27], v[204:207]
buffer_load_dwordx4 a[88:91], v2, s[40:43], s35 offen offset:3072 sc1
v_mfma_f32_16x16x32_bf16 v[208:211], a[144:147], a[24:27], 0
v_mfma_f32_16x16x32_bf16 v[208:211], a[148:151], a[28:31], v[208:211]
v_mfma_f32_16x16x32_bf16 v[184:187], a[148:151], a[20:23], 0
v_mfma_f32_16x16x32_bf16 v[184:187], a[144:147], a[16:19], v[184:187]
v_mfma_f32_16x16x32_bf16 v[160:163], a[144:147], a[8:11], 0
buffer_load_dwordx4 a[92:95], v2, s[40:43], s33 offen offset:3072 sc1
s_add_u32 s35, s35, 0x4000
v_mfma_f32_16x16x32_bf16 v[160:163], a[148:151], a[12:15], v[160:163]
s_add_u32 s33, s33, 0x4000
v_mfma_f32_16x16x32_bf16 v[136:139], a[148:151], a[4:7], 0
v_mfma_f32_16x16x32_bf16 v[136:139], a[144:147], a[0:3], v[136:139]
s_waitcnt vmcnt(10) lgkmcnt(0)
v_mfma_f32_16x16x32_bf16 v[140:143], a[96:99], a[32:35], v[140:143]
ds_read_b128 a[128:131], v5 offset:17408
v_mfma_f32_16x16x32_bf16 v[140:143], a[100:103], a[36:39], v[140:143]
buffer_load_dwordx4 a[0:3], v2, s[40:43], s35 offen offset:0 sc1
v_mfma_f32_16x16x32_bf16 v[164:167], a[100:103], a[44:47], v[164:167]
ds_read_b128 a[132:135], v5 offset:23552
v_mfma_f32_16x16x32_bf16 v[164:167], a[96:99], a[40:43], v[164:167]
v_mfma_f32_16x16x32_bf16 v[188:191], a[96:99], a[48:51], v[188:191]
v_mfma_f32_16x16x32_bf16 v[188:191], a[100:103], a[52:55], v[188:191]
buffer_load_dwordx4 v1, s[4:7], s44 offen offset:0 sc1 lds
v_mfma_f32_16x16x32_bf16 v[212:215], a[100:103], a[60:63], v[212:215]
ds_read_b128 a[136:139], v5 offset:12288
v_mfma_f32_16x16x32_bf16 v[212:215], a[96:99], a[56:59], v[212:215]
v_mfma_f32_16x16x32_bf16 v[216:219], a[104:107], a[56:59], v[216:219]
ds_read_b128 a[140:143], v5 offset:18432
v_mfma_f32_16x16x32_bf16 v[216:219], a[108:111], a[60:63], v[216:219]
buffer_load_dwordx4 a[4:7], v2, s[40:43], s33 offen offset:0 sc1
v_mfma_f32_16x16x32_bf16 v[192:195], a[108:111], a[52:55], v[192:195]
ds_read_b128 a[144:147], v5 offset:13312
v_mfma_f32_16x16x32_bf16 v[192:195], a[104:107], a[48:51], v[192:195]
v_mfma_f32_16x16x32_bf16 v[168:171], a[104:107], a[40:43], v[168:171]
v_mfma_f32_16x16x32_bf16 v[168:171], a[108:111], a[44:47], v[168:171]
buffer_load_dwordx4 a[8:11], v2, s[40:43], s35 offen offset:1024 sc1
v_mfma_f32_16x16x32_bf16 v[144:147], a[108:111], a[36:39], v[144:147]
ds_read_b128 a[148:151], v5 offset:19456
v_mfma_f32_16x16x32_bf16 v[144:147], a[104:107], a[32:35], v[144:147]
v_mfma_f32_16x16x32_bf16 v[148:151], a[112:115], a[32:35], v[148:151]
v_mfma_f32_16x16x32_bf16 v[148:151], a[116:119], a[36:39], v[148:151]
buffer_load_dwordx4 v1, s[4:7], s44 offen offset:1024 sc1 lds
s_add_u32 m0, s18, 0x1e000
v_mfma_f32_16x16x32_bf16 v[172:175], a[116:119], a[44:47], v[172:175]
s_add_u32 s44, s50, 0x281e000
v_mfma_f32_16x16x32_bf16 v[172:175], a[112:115], a[40:43], v[172:175]
v_mfma_f32_16x16x32_bf16 v[196:199], a[112:115], a[48:51], v[196:199]
v_mfma_f32_16x16x32_bf16 v[196:199], a[116:119], a[52:55], v[196:199]
buffer_load_dwordx4 a[12:15], v2, s[40:43], s33 offen offset:1024 sc1
v_mfma_f32_16x16x32_bf16 v[220:223], a[116:119], a[60:63], v[220:223]
v_mfma_f32_16x16x32_bf16 v[220:223], a[112:115], a[56:59], v[220:223]
s_waitcnt lgkmcnt(0)
v_mfma_f32_16x16x32_bf16 v[224:227], a[128:131], a[56:59], v[224:227]
ds_read_b128 a[96:99], v5 offset:26624
v_mfma_f32_16x16x32_bf16 v[224:227], a[132:135], a[60:63], v[224:227]
buffer_load_dwordx4 a[16:19], v2, s[40:43], s35 offen offset:2048 sc1
v_mfma_f32_16x16x32_bf16 v[200:203], a[132:135], a[52:55], v[200:203]
ds_read_b128 a[100:103], v5 offset:32768
v_mfma_f32_16x16x32_bf16 v[200:203], a[128:131], a[48:51], v[200:203]
v_mfma_f32_16x16x32_bf16 v[176:179], a[128:131], a[40:43], v[176:179]
v_mfma_f32_16x16x32_bf16 v[176:179], a[132:135], a[44:47], v[176:179]
buffer_load_dwordx4 a[20:23], v2, s[40:43], s33 offen offset:2048 sc1
v_mfma_f32_16x16x32_bf16 v[152:155], a[132:135], a[36:39], v[152:155]
ds_read_b128 a[104:107], v5 offset:27648
v_mfma_f32_16x16x32_bf16 v[152:155], a[128:131], a[32:35], v[152:155]
v_mfma_f32_16x16x32_bf16 v[132:135], a[136:139], a[32:35], v[132:135]
ds_read_b128 a[108:111], v5 offset:33792
v_mfma_f32_16x16x32_bf16 v[132:135], a[140:143], a[36:39], v[132:135]
v_mfma_f32_16x16x32_bf16 v[156:159], a[140:143], a[44:47], v[156:159]
buffer_load_dwordx4 v1, s[4:7], s44 offen offset:0 sc1 lds
v_mfma_f32_16x16x32_bf16 v[156:159], a[136:139], a[40:43], v[156:159]
ds_read_b128 a[112:115], v5 offset:28672
v_mfma_f32_16x16x32_bf16 v[180:183], a[136:139], a[48:51], v[180:183]
v_mfma_f32_16x16x32_bf16 v[180:183], a[140:143], a[52:55], v[180:183]
ds_read_b128 a[116:119], v5 offset:34816
v_mfma_f32_16x16x32_bf16 v[204:207], a[140:143], a[60:63], v[204:207]
v_mfma_f32_16x16x32_bf16 v[204:207], a[136:139], a[56:59], v[204:207]
buffer_load_dwordx4 a[24:27], v2, s[40:43], s35 offen offset:3072 sc1
v_mfma_f32_16x16x32_bf16 v[208:211], a[144:147], a[56:59], v[208:211]
v_mfma_f32_16x16x32_bf16 v[208:211], a[148:151], a[60:63], v[208:211]
v_mfma_f32_16x16x32_bf16 v[184:187], a[148:151], a[52:55], v[184:187]
v_mfma_f32_16x16x32_bf16 v[184:187], a[144:147], a[48:51], v[184:187]
v_mfma_f32_16x16x32_bf16 v[160:163], a[144:147], a[40:43], v[160:163]
buffer_load_dwordx4 a[28:31], v2, s[40:43], s33 offen offset:3072 sc1
s_add_u32 s35, s35, 0x4000
v_mfma_f32_16x16x32_bf16 v[160:163], a[148:151], a[44:47], v[160:163]
s_add_u32 s33, s33, 0x4000
v_mfma_f32_16x16x32_bf16 v[136:139], a[148:151], a[36:39], v[136:139]
v_mfma_f32_16x16x32_bf16 v[136:139], a[144:147], a[32:35], v[136:139]
s_waitcnt vmcnt(11) lgkmcnt(0)
v_mfma_f32_16x16x32_bf16 v[140:143], a[96:99], a[64:67], v[140:143]
ds_read_b128 a[128:131], v5 offset:29696
v_mfma_f32_16x16x32_bf16 v[140:143], a[100:103], a[68:71], v[140:143]
buffer_load_dwordx4 a[32:35], v2, s[40:43], s35 offen offset:0 sc1
v_mfma_f32_16x16x32_bf16 v[164:167], a[100:103], a[76:79], v[164:167]
ds_read_b128 a[132:135], v5 offset:35840
v_mfma_f32_16x16x32_bf16 v[164:167], a[96:99], a[72:75], v[164:167]
v_mfma_f32_16x16x32_bf16 v[188:191], a[96:99], a[80:83], v[188:191]
v_mfma_f32_16x16x32_bf16 v[188:191], a[100:103], a[84:87], v[188:191]
buffer_load_dwordx4 a[36:39], v2, s[40:43], s33 offen offset:0 sc1
v_mfma_f32_16x16x32_bf16 v[212:215], a[100:103], a[92:95], v[212:215]
ds_read_b128 a[136:139], v5 offset:24576
v_mfma_f32_16x16x32_bf16 v[212:215], a[96:99], a[88:91], v[212:215]
v_mfma_f32_16x16x32_bf16 v[216:219], a[104:107], a[88:91], v[216:219]
ds_read_b128 a[140:143], v5 offset:30720
v_mfma_f32_16x16x32_bf16 v[216:219], a[108:111], a[92:95], v[216:219]
v_mfma_f32_16x16x32_bf16 v[192:195], a[108:111], a[84:87], v[192:195]
buffer_load_dwordx4 v1, s[4:7], s44 offen offset:1024 sc1 lds
s_add_u32 m0, s18, 0x20000
v_mfma_f32_16x16x32_bf16 v[192:195], a[104:107], a[80:83], v[192:195]
s_add_u32 s44, s50, 0x2820000
ds_read_b128 a[144:147], v5 offset:25600
v_mfma_f32_16x16x32_bf16 v[168:171], a[104:107], a[72:75], v[168:171]
v_mfma_f32_16x16x32_bf16 v[168:171], a[108:111], a[76:79], v[168:171]
ds_read_b128 a[148:151], v5 offset:31744
v_mfma_f32_16x16x32_bf16 v[144:147], a[108:111], a[68:71], v[144:147]
v_mfma_f32_16x16x32_bf16 v[144:147], a[104:107], a[64:67], v[144:147]
buffer_load_dwordx4 a[40:43], v2, s[40:43], s35 offen offset:1024 sc1
v_mfma_f32_16x16x32_bf16 v[148:151], a[112:115], a[64:67], v[148:151]
v_mfma_f32_16x16x32_bf16 v[148:151], a[116:119], a[68:71], v[148:151]
v_mfma_f32_16x16x32_bf16 v[172:175], a[116:119], a[76:79], v[172:175]
v_mfma_f32_16x16x32_bf16 v[172:175], a[112:115], a[72:75], v[172:175]
v_mfma_f32_16x16x32_bf16 v[196:199], a[112:115], a[80:83], v[196:199]
buffer_load_dwordx4 a[44:47], v2, s[40:43], s33 offen offset:1024 sc1
v_mfma_f32_16x16x32_bf16 v[196:199], a[116:119], a[84:87], v[196:199]
v_mfma_f32_16x16x32_bf16 v[220:223], a[116:119], a[92:95], v[220:223]
v_mfma_f32_16x16x32_bf16 v[220:223], a[112:115], a[88:91], v[220:223]
s_waitcnt lgkmcnt(0)
v_mfma_f32_16x16x32_bf16 v[224:227], a[128:131], a[88:91], v[224:227]
ds_read_b128 a[96:99], v5 offset:38912
v_mfma_f32_16x16x32_bf16 v[224:227], a[132:135], a[92:95], v[224:227]
buffer_load_dwordx4 a[48:51], v2, s[40:43], s35 offen offset:2048 sc1
v_mfma_f32_16x16x32_bf16 v[200:203], a[132:135], a[84:87], v[200:203]
ds_read_b128 a[100:103], v5 offset:45056
v_mfma_f32_16x16x32_bf16 v[200:203], a[128:131], a[80:83], v[200:203]
v_mfma_f32_16x16x32_bf16 v[176:179], a[128:131], a[72:75], v[176:179]
v_mfma_f32_16x16x32_bf16 v[176:179], a[132:135], a[76:79], v[176:179]
buffer_load_dwordx4 a[52:55], v2, s[40:43], s33 offen offset:2048 sc1
v_mfma_f32_16x16x32_bf16 v[152:155], a[132:135], a[68:71], v[152:155]
ds_read_b128 a[104:107], v5 offset:39936
v_mfma_f32_16x16x32_bf16 v[152:155], a[128:131], a[64:67], v[152:155]
v_mfma_f32_16x16x32_bf16 v[132:135], a[136:139], a[64:67], v[132:135]
ds_read_b128 a[108:111], v5 offset:46080
v_mfma_f32_16x16x32_bf16 v[132:135], a[140:143], a[68:71], v[132:135]
v_mfma_f32_16x16x32_bf16 v[156:159], a[140:143], a[76:79], v[156:159]
buffer_load_dwordx4 v1, s[4:7], s44 offen offset:0 sc1 lds
v_mfma_f32_16x16x32_bf16 v[156:159], a[136:139], a[72:75], v[156:159]
ds_read_b128 a[112:115], v5 offset:40960
v_mfma_f32_16x16x32_bf16 v[180:183], a[136:139], a[80:83], v[180:183]
v_mfma_f32_16x16x32_bf16 v[180:183], a[140:143], a[84:87], v[180:183]
ds_read_b128 a[116:119], v5 offset:47104
v_mfma_f32_16x16x32_bf16 v[204:207], a[140:143], a[92:95], v[204:207]
v_mfma_f32_16x16x32_bf16 v[204:207], a[136:139], a[88:91], v[204:207]
buffer_load_dwordx4 a[56:59], v2, s[40:43], s35 offen offset:3072 sc1
v_mfma_f32_16x16x32_bf16 v[208:211], a[144:147], a[88:91], v[208:211]
v_mfma_f32_16x16x32_bf16 v[208:211], a[148:151], a[92:95], v[208:211]
v_mfma_f32_16x16x32_bf16 v[184:187], a[148:151], a[84:87], v[184:187]
v_mfma_f32_16x16x32_bf16 v[184:187], a[144:147], a[80:83], v[184:187]
v_mfma_f32_16x16x32_bf16 v[160:163], a[144:147], a[72:75], v[160:163]
buffer_load_dwordx4 a[60:63], v2, s[40:43], s33 offen offset:3072 sc1
s_add_u32 s35, s35, 0x4000
v_mfma_f32_16x16x32_bf16 v[160:163], a[148:151], a[76:79], v[160:163]
s_add_u32 s33, s33, 0x4000
v_mfma_f32_16x16x32_bf16 v[136:139], a[148:151], a[68:71], v[136:139]
v_mfma_f32_16x16x32_bf16 v[136:139], a[144:147], a[64:67], v[136:139]
s_waitcnt vmcnt(10) lgkmcnt(0)
v_mfma_f32_16x16x32_bf16 v[140:143], a[96:99], a[0:3], v[140:143]
ds_read_b128 a[128:131], v5 offset:41984
v_mfma_f32_16x16x32_bf16 v[140:143], a[100:103], a[4:7], v[140:143]
buffer_load_dwordx4 a[64:67], v2, s[40:43], s35 offen offset:0 sc1
v_mfma_f32_16x16x32_bf16 v[164:167], a[100:103], a[12:15], v[164:167]
ds_read_b128 a[132:135], v5 offset:48128
v_mfma_f32_16x16x32_bf16 v[164:167], a[96:99], a[8:11], v[164:167]
v_mfma_f32_16x16x32_bf16 v[188:191], a[96:99], a[16:19], v[188:191]
v_mfma_f32_16x16x32_bf16 v[188:191], a[100:103], a[20:23], v[188:191]
buffer_load_dwordx4 v1, s[4:7], s44 offen offset:1024 sc1 lds
s_add_u32 m0, s18, 0x22000
v_mfma_f32_16x16x32_bf16 v[212:215], a[100:103], a[28:31], v[212:215]
s_add_u32 s44, s50, 0x2822000
ds_read_b128 a[136:139], v5 offset:36864
v_mfma_f32_16x16x32_bf16 v[212:215], a[96:99], a[24:27], v[212:215]
v_mfma_f32_16x16x32_bf16 v[216:219], a[104:107], a[24:27], v[216:219]
ds_read_b128 a[140:143], v5 offset:43008
v_mfma_f32_16x16x32_bf16 v[216:219], a[108:111], a[28:31], v[216:219]
buffer_load_dwordx4 a[68:71], v2, s[40:43], s33 offen offset:0 sc1
v_mfma_f32_16x16x32_bf16 v[192:195], a[108:111], a[20:23], v[192:195]
ds_read_b128 a[144:147], v5 offset:37888
v_mfma_f32_16x16x32_bf16 v[192:195], a[104:107], a[16:19], v[192:195]
v_mfma_f32_16x16x32_bf16 v[168:171], a[104:107], a[8:11], v[168:171]
v_mfma_f32_16x16x32_bf16 v[168:171], a[108:111], a[12:15], v[168:171]
buffer_load_dwordx4 a[72:75], v2, s[40:43], s35 offen offset:1024 sc1
v_mfma_f32_16x16x32_bf16 v[144:147], a[108:111], a[4:7], v[144:147]
ds_read_b128 a[148:151], v5 offset:44032
v_mfma_f32_16x16x32_bf16 v[144:147], a[104:107], a[0:3], v[144:147]
v_mfma_f32_16x16x32_bf16 v[148:151], a[112:115], a[0:3], v[148:151]
v_mfma_f32_16x16x32_bf16 v[148:151], a[116:119], a[4:7], v[148:151]
buffer_load_dwordx4 v1, s[4:7], s44 offen offset:0 sc1 lds
v_mfma_f32_16x16x32_bf16 v[172:175], a[116:119], a[12:15], v[172:175]
v_mfma_f32_16x16x32_bf16 v[172:175], a[112:115], a[8:11], v[172:175]
v_mfma_f32_16x16x32_bf16 v[196:199], a[112:115], a[16:19], v[196:199]
v_mfma_f32_16x16x32_bf16 v[196:199], a[116:119], a[20:23], v[196:199]
buffer_load_dwordx4 a[76:79], v2, s[40:43], s33 offen offset:1024 sc1
v_mfma_f32_16x16x32_bf16 v[220:223], a[116:119], a[28:31], v[220:223]
v_mfma_f32_16x16x32_bf16 v[220:223], a[112:115], a[24:27], v[220:223]
s_waitcnt lgkmcnt(0)
s_barrier
v_mfma_f32_16x16x32_bf16 v[224:227], a[128:131], a[24:27], v[224:227]
v_add_u32 v5, 49152, v1
v_mfma_f32_16x16x32_bf16 v[224:227], a[132:135], a[28:31], v[224:227]
buffer_load_dwordx4 a[80:83], v2, s[40:43], s35 offen offset:2048 sc1
v_mfma_f32_16x16x32_bf16 v[200:203], a[132:135], a[20:23], v[200:203]
ds_read_b128 a[96:99], v5 offset:2048
v_mfma_f32_16x16x32_bf16 v[200:203], a[128:131], a[16:19], v[200:203]
ds_read_b128 a[100:103], v5 offset:8192
v_mfma_f32_16x16x32_bf16 v[176:179], a[128:131], a[8:11], v[176:179]
v_mfma_f32_16x16x32_bf16 v[176:179], a[132:135], a[12:15], v[176:179]
buffer_load_dwordx4 a[84:87], v2, s[40:43], s33 offen offset:2048 sc1
v_mfma_f32_16x16x32_bf16 v[152:155], a[132:135], a[4:7], v[152:155]
ds_read_b128 a[104:107], v5 offset:3072
v_mfma_f32_16x16x32_bf16 v[152:155], a[128:131], a[0:3], v[152:155]
v_mfma_f32_16x16x32_bf16 v[132:135], a[136:139], a[0:3], v[132:135]
ds_read_b128 a[108:111], v5 offset:9216
v_mfma_f32_16x16x32_bf16 v[132:135], a[140:143], a[4:7], v[132:135]
v_mfma_f32_16x16x32_bf16 v[156:159], a[140:143], a[12:15], v[156:159]
buffer_load_dwordx4 v1, s[4:7], s44 offen offset:1024 sc1 lds
s_add_u32 s88, s82, 0x300000
v_mfma_f32_16x16x32_bf16 v[156:159], a[136:139], a[8:11], v[156:159]
ds_read_b128 a[112:115], v5 offset:4096
v_mfma_f32_16x16x32_bf16 v[180:183], a[136:139], a[16:19], v[180:183]
v_mfma_f32_16x16x32_bf16 v[180:183], a[140:143], a[20:23], v[180:183]
ds_read_b128 a[116:119], v5 offset:10240
v_mfma_f32_16x16x32_bf16 v[204:207], a[140:143], a[28:31], v[204:207]
v_mfma_f32_16x16x32_bf16 v[204:207], a[136:139], a[24:27], v[204:207]
buffer_load_dwordx4 a[88:91], v2, s[40:43], s35 offen offset:3072 sc1
v_mfma_f32_16x16x32_bf16 v[208:211], a[144:147], a[24:27], v[208:211]
v_mfma_f32_16x16x32_bf16 v[208:211], a[148:151], a[28:31], v[208:211]
v_mfma_f32_16x16x32_bf16 v[184:187], a[148:151], a[20:23], v[184:187]
v_mfma_f32_16x16x32_bf16 v[184:187], a[144:147], a[16:19], v[184:187]
v_mfma_f32_16x16x32_bf16 v[160:163], a[144:147], a[8:11], v[160:163]
buffer_load_dwordx4 a[92:95], v2, s[40:43], s33 offen offset:3072 sc1
s_add_u32 s35, s35, 0x4000
v_mfma_f32_16x16x32_bf16 v[160:163], a[148:151], a[12:15], v[160:163]
s_add_u32 s33, s33, 0x4000
v_mfma_f32_16x16x32_bf16 v[136:139], a[148:151], a[4:7], v[136:139]
v_mfma_f32_16x16x32_bf16 v[136:139], a[144:147], a[0:3], v[136:139]
s_waitcnt vmcnt(11) lgkmcnt(0)
v_mfma_f32_16x16x32_bf16 v[140:143], a[96:99], a[32:35], v[140:143]
ds_read_b128 a[128:131], v5 offset:5120
v_mfma_f32_16x16x32_bf16 v[140:143], a[100:103], a[36:39], v[140:143]
buffer_load_dwordx4 a[0:3], v2, s[40:43], s35 offen offset:0 sc1
v_mfma_f32_16x16x32_bf16 v[164:167], a[100:103], a[44:47], v[164:167]
ds_read_b128 a[132:135], v5 offset:11264
v_mfma_f32_16x16x32_bf16 v[164:167], a[96:99], a[40:43], v[164:167]
v_mfma_f32_16x16x32_bf16 v[188:191], a[96:99], a[48:51], v[188:191]
v_mfma_f32_16x16x32_bf16 v[188:191], a[100:103], a[52:55], v[188:191]
buffer_load_dwordx4 a[4:7], v2, s[40:43], s33 offen offset:0 sc1
v_mfma_f32_16x16x32_bf16 v[212:215], a[100:103], a[60:63], v[212:215]
ds_read_b128 a[136:139], v5 offset:0
v_mfma_f32_16x16x32_bf16 v[212:215], a[96:99], a[56:59], v[212:215]
v_mfma_f32_16x16x32_bf16 v[216:219], a[104:107], a[56:59], v[216:219]
ds_read_b128 a[140:143], v5 offset:6144
v_mfma_f32_16x16x32_bf16 v[216:219], a[108:111], a[60:63], v[216:219]
v_mfma_f32_16x16x32_bf16 v[192:195], a[108:111], a[52:55], v[192:195]
buffer_load_dwordx4 v[92:95], v1, s[4:7], s88 offen offset:0 sc1
v_mfma_f32_16x16x32_bf16 v[192:195], a[104:107], a[48:51], v[192:195]
ds_read_b128 a[144:147], v5 offset:1024
v_mfma_f32_16x16x32_bf16 v[168:171], a[104:107], a[40:43], v[168:171]
v_mfma_f32_16x16x32_bf16 v[168:171], a[108:111], a[44:47], v[168:171]
ds_read_b128 a[148:151], v5 offset:7168
v_mfma_f32_16x16x32_bf16 v[144:147], a[108:111], a[36:39], v[144:147]
v_mfma_f32_16x16x32_bf16 v[144:147], a[104:107], a[32:35], v[144:147]
buffer_load_dwordx4 a[8:11], v2, s[40:43], s35 offen offset:1024 sc1
v_mfma_f32_16x16x32_bf16 v[148:151], a[112:115], a[32:35], v[148:151]
v_mfma_f32_16x16x32_bf16 v[148:151], a[116:119], a[36:39], v[148:151]
v_mfma_f32_16x16x32_bf16 v[172:175], a[116:119], a[44:47], v[172:175]
v_mfma_f32_16x16x32_bf16 v[172:175], a[112:115], a[40:43], v[172:175]
v_mfma_f32_16x16x32_bf16 v[196:199], a[112:115], a[48:51], v[196:199]
buffer_load_dwordx4 a[12:15], v2, s[40:43], s33 offen offset:1024 sc1
v_mfma_f32_16x16x32_bf16 v[196:199], a[116:119], a[52:55], v[196:199]
v_mfma_f32_16x16x32_bf16 v[220:223], a[116:119], a[60:63], v[220:223]
v_mfma_f32_16x16x32_bf16 v[220:223], a[112:115], a[56:59], v[220:223]
s_waitcnt lgkmcnt(0)
v_mfma_f32_16x16x32_bf16 v[224:227], a[128:131], a[56:59], v[224:227]
ds_read_b128 a[96:99], v5 offset:14336
v_mfma_f32_16x16x32_bf16 v[224:227], a[132:135], a[60:63], v[224:227]
buffer_load_dwordx4 a[16:19], v2, s[40:43], s35 offen offset:2048 sc1
v_mfma_f32_16x16x32_bf16 v[200:203], a[132:135], a[52:55], v[200:203]
ds_read_b128 a[100:103], v5 offset:20480
v_mfma_f32_16x16x32_bf16 v[200:203], a[128:131], a[48:51], v[200:203]
v_mfma_f32_16x16x32_bf16 v[176:179], a[128:131], a[40:43], v[176:179]
v_mfma_f32_16x16x32_bf16 v[176:179], a[132:135], a[44:47], v[176:179]
buffer_load_dwordx4 a[20:23], v2, s[40:43], s33 offen offset:2048 sc1
v_mfma_f32_16x16x32_bf16 v[152:155], a[132:135], a[36:39], v[152:155]
ds_read_b128 a[104:107], v5 offset:15360
v_mfma_f32_16x16x32_bf16 v[152:155], a[128:131], a[32:35], v[152:155]
v_mfma_f32_16x16x32_bf16 v[132:135], a[136:139], a[32:35], v[132:135]
ds_read_b128 a[108:111], v5 offset:21504
v_mfma_f32_16x16x32_bf16 v[132:135], a[140:143], a[36:39], v[132:135]
v_mfma_f32_16x16x32_bf16 v[156:159], a[140:143], a[44:47], v[156:159]
buffer_load_dwordx4 v[96:99], v1, s[4:7], s88 offen offset:1024 sc1
v_mfma_f32_16x16x32_bf16 v[156:159], a[136:139], a[40:43], v[156:159]
ds_read_b128 a[112:115], v5 offset:16384
v_mfma_f32_16x16x32_bf16 v[180:183], a[136:139], a[48:51], v[180:183]
v_mfma_f32_16x16x32_bf16 v[180:183], a[140:143], a[52:55], v[180:183]
ds_read_b128 a[116:119], v5 offset:22528
v_mfma_f32_16x16x32_bf16 v[204:207], a[140:143], a[60:63], v[204:207]
v_mfma_f32_16x16x32_bf16 v[204:207], a[136:139], a[56:59], v[204:207]
buffer_load_dwordx4 a[24:27], v2, s[40:43], s35 offen offset:3072 sc1
v_mfma_f32_16x16x32_bf16 v[208:211], a[144:147], a[56:59], v[208:211]
v_mfma_f32_16x16x32_bf16 v[208:211], a[148:151], a[60:63], v[208:211]
v_mfma_f32_16x16x32_bf16 v[184:187], a[148:151], a[52:55], v[184:187]
v_mfma_f32_16x16x32_bf16 v[184:187], a[144:147], a[48:51], v[184:187]
v_mfma_f32_16x16x32_bf16 v[160:163], a[144:147], a[40:43], v[160:163]
buffer_load_dwordx4 a[28:31], v2, s[40:43], s33 offen offset:3072 sc1
s_add_u32 s35, s35, 0x4000
v_mfma_f32_16x16x32_bf16 v[160:163], a[148:151], a[44:47], v[160:163]
s_add_u32 s33, s33, 0x4000
v_mfma_f32_16x16x32_bf16 v[136:139], a[148:151], a[36:39], v[136:139]
v_mfma_f32_16x16x32_bf16 v[136:139], a[144:147], a[32:35], v[136:139]
s_waitcnt vmcnt(10) lgkmcnt(0)
v_mfma_f32_16x16x32_bf16 v[140:143], a[96:99], a[64:67], v[140:143]
ds_read_b128 a[128:131], v5 offset:17408
v_mfma_f32_16x16x32_bf16 v[140:143], a[100:103], a[68:71], v[140:143]
buffer_load_dwordx4 a[32:35], v2, s[40:43], s35 offen offset:0 sc1
v_mfma_f32_16x16x32_bf16 v[164:167], a[100:103], a[76:79], v[164:167]
ds_read_b128 a[132:135], v5 offset:23552
v_mfma_f32_16x16x32_bf16 v[164:167], a[96:99], a[72:75], v[164:167]
v_mfma_f32_16x16x32_bf16 v[188:191], a[96:99], a[80:83], v[188:191]
L_stub5:
s_cbranch_execz L_stub6
v_mfma_f32_16x16x32_bf16 v[188:191], a[100:103], a[84:87], v[188:191]
buffer_load_dwordx4 v[100:103], v1, s[4:7], s88 offen offset:2048 sc1
v_mfma_f32_16x16x32_bf16 v[212:215], a[100:103], a[92:95], v[212:215]
ds_read_b128 a[136:139], v5 offset:12288
v_mfma_f32_16x16x32_bf16 v[212:215], a[96:99], a[88:91], v[212:215]
v_mfma_f32_16x16x32_bf16 v[216:219], a[104:107], a[88:91], v[216:219]
ds_read_b128 a[140:143], v5 offset:18432
v_mfma_f32_16x16x32_bf16 v[216:219], a[108:111], a[92:95], v[216:219]
buffer_load_dwordx4 a[36:39], v2, s[40:43], s33 offen offset:0 sc1
v_mfma_f32_16x16x32_bf16 v[192:195], a[108:111], a[84:87], v[192:195]
ds_read_b128 a[144:147], v5 offset:13312
v_mfma_f32_16x16x32_bf16 v[192:195], a[104:107], a[80:83], v[192:195]
v_mfma_f32_16x16x32_bf16 v[168:171], a[104:107], a[72:75], v[168:171]
v_mfma_f32_16x16x32_bf16 v[168:171], a[108:111], a[76:79], v[168:171]
buffer_load_dwordx4 a[40:43], v2, s[40:43], s35 offen offset:1024 sc1
v_mfma_f32_16x16x32_bf16 v[144:147], a[108:111], a[68:71], v[144:147]
ds_read_b128 a[148:151], v5 offset:19456
v_mfma_f32_16x16x32_bf16 v[144:147], a[104:107], a[64:67], v[144:147]
v_mfma_f32_16x16x32_bf16 v[148:151], a[112:115], a[64:67], v[148:151]
v_mfma_f32_16x16x32_bf16 v[148:151], a[116:119], a[68:71], v[148:151]
buffer_load_dwordx4 v[104:107], v1, s[4:7], s88 offen offset:3072 sc1
s_add_u32 s88, s88, 4096
v_mfma_f32_16x16x32_bf16 v[172:175], a[116:119], a[76:79], v[172:175]
v_mfma_f32_16x16x32_bf16 v[172:175], a[112:115], a[72:75], v[172:175]
v_mfma_f32_16x16x32_bf16 v[196:199], a[112:115], a[80:83], v[196:199]
v_mfma_f32_16x16x32_bf16 v[196:199], a[116:119], a[84:87], v[196:199]
buffer_load_dwordx4 a[44:47], v2, s[40:43], s33 offen offset:1024 sc1
v_mfma_f32_16x16x32_bf16 v[220:223], a[116:119], a[92:95], v[220:223]
v_mfma_f32_16x16x32_bf16 v[220:223], a[112:115], a[88:91], v[220:223]
s_waitcnt lgkmcnt(0)
v_mfma_f32_16x16x32_bf16 v[224:227], a[128:131], a[88:91], v[224:227]
ds_read_b128 a[96:99], v5 offset:26624
v_mfma_f32_16x16x32_bf16 v[224:227], a[132:135], a[92:95], v[224:227]
buffer_load_dwordx4 a[48:51], v2, s[40:43], s35 offen offset:2048 sc1
v_mfma_f32_16x16x32_bf16 v[200:203], a[132:135], a[84:87], v[200:203]
ds_read_b128 a[100:103], v5 offset:32768
v_mfma_f32_16x16x32_bf16 v[200:203], a[128:131], a[80:83], v[200:203]
v_mfma_f32_16x16x32_bf16 v[176:179], a[128:131], a[72:75], v[176:179]
v_mfma_f32_16x16x32_bf16 v[176:179], a[132:135], a[76:79], v[176:179]
buffer_load_dwordx4 a[52:55], v2, s[40:43], s33 offen offset:2048 sc1
v_mfma_f32_16x16x32_bf16 v[152:155], a[132:135], a[68:71], v[152:155]
ds_read_b128 a[104:107], v5 offset:27648
v_mfma_f32_16x16x32_bf16 v[152:155], a[128:131], a[64:67], v[152:155]
v_mfma_f32_16x16x32_bf16 v[132:135], a[136:139], a[64:67], v[132:135]
ds_read_b128 a[108:111], v5 offset:33792
v_mfma_f32_16x16x32_bf16 v[132:135], a[140:143], a[68:71], v[132:135]
v_mfma_f32_16x16x32_bf16 v[156:159], a[140:143], a[76:79], v[156:159]
buffer_load_dwordx4 v[108:111], v1, s[4:7], s88 offen offset:0 sc1
v_mfma_f32_16x16x32_bf16 v[156:159], a[136:139], a[72:75], v[156:159]
ds_read_b128 a[112:115], v5 offset:28672
v_mfma_f32_16x16x32_bf16 v[180:183], a[136:139], a[80:83], v[180:183]
v_mfma_f32_16x16x32_bf16 v[180:183], a[140:143], a[84:87], v[180:183]
ds_read_b128 a[116:119], v5 offset:34816
v_mfma_f32_16x16x32_bf16 v[204:207], a[140:143], a[92:95], v[204:207]
v_mfma_f32_16x16x32_bf16 v[204:207], a[136:139], a[88:91], v[204:207]
buffer_load_dwordx4 a[56:59], v2, s[40:43], s35 offen offset:3072 sc1
v_mfma_f32_16x16x32_bf16 v[208:211], a[144:147], a[88:91], v[208:211]
v_mfma_f32_16x16x32_bf16 v[208:211], a[148:151], a[92:95], v[208:211]
v_mfma_f32_16x16x32_bf16 v[184:187], a[148:151], a[84:87], v[184:187]
v_mfma_f32_16x16x32_bf16 v[184:187], a[144:147], a[80:83], v[184:187]
v_mfma_f32_16x16x32_bf16 v[160:163], a[144:147], a[72:75], v[160:163]
buffer_load_dwordx4 a[60:63], v2, s[40:43], s33 offen offset:3072 sc1
s_add_u32 s35, s35, 0x64000
v_mfma_f32_16x16x32_bf16 v[160:163], a[148:151], a[76:79], v[160:163]
s_add_u32 s33, s33, 0x64000
v_mfma_f32_16x16x32_bf16 v[136:139], a[148:151], a[68:71], v[136:139]
v_mfma_f32_16x16x32_bf16 v[136:139], a[144:147], a[64:67], v[136:139]
s_waitcnt vmcnt(11) lgkmcnt(0)
v_mfma_f32_16x16x32_bf16 v[140:143], a[96:99], a[0:3], v[140:143]
ds_read_b128 a[128:131], v5 offset:29696
v_add_f32_dpp v48, v48, v48 row_ror:8 row_mask:0xf bank_mask:0xf
v_mfma_f32_16x16x32_bf16 v[140:143], a[100:103], a[4:7], v[140:143]
buffer_load_dwordx4 a[64:67], v2, s[40:43], s35 offen offset:0 sc1
v_mfma_f32_16x16x32_bf16 v[164:167], a[100:103], a[12:15], v[164:167]
ds_read_b128 a[132:135], v5 offset:35840
v_add_f32_dpp v49, v49, v49 row_ror:8 row_mask:0xf bank_mask:0xf
v_mfma_f32_16x16x32_bf16 v[164:167], a[96:99], a[8:11], v[164:167]
v_add_f32_dpp v50, v50, v50 row_ror:8 row_mask:0xf bank_mask:0xf
v_add_f32_dpp v51, v51, v51 row_ror:8 row_mask:0xf bank_mask:0xf
v_mfma_f32_16x16x32_bf16 v[188:191], a[96:99], a[16:19], v[188:191]
v_add_f32_dpp v52, v52, v52 row_ror:8 row_mask:0xf bank_mask:0xf
v_add_f32_dpp v53, v53, v53 row_ror:8 row_mask:0xf bank_mask:0xf
v_mfma_f32_16x16x32_bf16 v[188:191], a[100:103], a[20:23], v[188:191]
buffer_load_dwordx4 a[68:71], v2, s[40:43], s33 offen offset:0 sc1
v_mfma_f32_16x16x32_bf16 v[212:215], a[100:103], a[28:31], v[212:215]
ds_read_b128 a[136:139], v5 offset:24576
v_add_f32_dpp v54, v54, v54 row_ror:8 row_mask:0xf bank_mask:0xf
v_mfma_f32_16x16x32_bf16 v[212:215], a[96:99], a[24:27], v[212:215]
v_add_f32_dpp v55, v55, v55 row_ror:8 row_mask:0xf bank_mask:0xf
v_add_f32_dpp v48, v48, v48 row_ror:4 row_mask:0xf bank_mask:0xf
v_mfma_f32_16x16x32_bf16 v[216:219], a[104:107], a[24:27], v[216:219]
ds_read_b128 a[140:143], v5 offset:30720
v_add_f32_dpp v49, v49, v49 row_ror:4 row_mask:0xf bank_mask:0xf
v_mfma_f32_16x16x32_bf16 v[216:219], a[108:111], a[28:31], v[216:219]
v_add_f32_dpp v50, v50, v50 row_ror:4 row_mask:0xf bank_mask:0xf
v_mfma_f32_16x16x32_bf16 v[192:195], a[108:111], a[20:23], v[192:195]
buffer_load_dwordx4 v[112:115], v1, s[4:7], s88 offen offset:1024 sc1
v_mfma_f32_16x16x32_bf16 v[192:195], a[104:107], a[16:19], v[192:195]
ds_read_b128 a[144:147], v5 offset:25600
v_add_f32_dpp v51, v51, v51 row_ror:4 row_mask:0xf bank_mask:0xf
v_mfma_f32_16x16x32_bf16 v[168:171], a[104:107], a[8:11], v[168:171]
v_add_f32_dpp v52, v52, v52 row_ror:4 row_mask:0xf bank_mask:0xf
v_add_f32_dpp v53, v53, v53 row_ror:4 row_mask:0xf bank_mask:0xf
v_mfma_f32_16x16x32_bf16 v[168:171], a[108:111], a[12:15], v[168:171]
ds_read_b128 a[148:151], v5 offset:31744
v_add_f32_dpp v54, v54, v54 row_ror:4 row_mask:0xf bank_mask:0xf
v_mfma_f32_16x16x32_bf16 v[144:147], a[108:111], a[4:7], v[144:147]
v_add_f32_dpp v55, v55, v55 row_ror:4 row_mask:0xf bank_mask:0xf
v_mfma_f32_16x16x32_bf16 v[144:147], a[104:107], a[0:3], v[144:147]
buffer_load_dwordx4 a[72:75], v2, s[40:43], s35 offen offset:1024 sc1
v_mfma_f32_16x16x32_bf16 v[148:151], a[112:115], a[0:3], v[148:151]
v_add_f32_dpp v48, v48, v48 row_ror:2 row_mask:0xf bank_mask:0xf
v_add_f32_dpp v49, v49, v49 row_ror:2 row_mask:0xf bank_mask:0xf
v_mfma_f32_16x16x32_bf16 v[148:151], a[116:119], a[4:7], v[148:151]
v_add_f32_dpp v50, v50, v50 row_ror:2 row_mask:0xf bank_mask:0xf
v_mfma_f32_16x16x32_bf16 v[172:175], a[116:119], a[12:15], v[172:175]
v_add_f32_dpp v51, v51, v51 row_ror:2 row_mask:0xf bank_mask:0xf
v_mfma_f32_16x16x32_bf16 v[172:175], a[112:115], a[8:11], v[172:175]
v_add_f32_dpp v52, v52, v52 row_ror:2 row_mask:0xf bank_mask:0xf
v_mfma_f32_16x16x32_bf16 v[196:199], a[112:115], a[16:19], v[196:199]
buffer_load_dwordx4 a[76:79], v2, s[40:43], s33 offen offset:1024 sc1
v_mfma_f32_16x16x32_bf16 v[196:199], a[116:119], a[20:23], v[196:199]
v_add_f32_dpp v53, v53, v53 row_ror:2 row_mask:0xf bank_mask:0xf
v_add_f32_dpp v54, v54, v54 row_ror:2 row_mask:0xf bank_mask:0xf
v_mfma_f32_16x16x32_bf16 v[220:223], a[116:119], a[28:31], v[220:223]
v_add_f32_dpp v55, v55, v55 row_ror:2 row_mask:0xf bank_mask:0xf
v_mfma_f32_16x16x32_bf16 v[220:223], a[112:115], a[24:27], v[220:223]
v_add_f32_dpp v48, v48, v48 row_ror:1 row_mask:0xf bank_mask:0xf
s_waitcnt lgkmcnt(0)
v_mfma_f32_16x16x32_bf16 v[224:227], a[128:131], a[24:27], v[224:227]
ds_read_b128 a[96:99], v5 offset:38912
v_add_f32_dpp v49, v49, v49 row_ror:1 row_mask:0xf bank_mask:0xf
v_mfma_f32_16x16x32_bf16 v[224:227], a[132:135], a[28:31], v[224:227]
buffer_load_dwordx4 a[80:83], v2, s[40:43], s35 offen offset:2048 sc1
v_mfma_f32_16x16x32_bf16 v[200:203], a[132:135], a[20:23], v[200:203]
ds_read_b128 a[100:103], v5 offset:45056
v_add_f32_dpp v50, v50, v50 row_ror:1 row_mask:0xf bank_mask:0xf
v_mfma_f32_16x16x32_bf16 v[200:203], a[128:131], a[16:19], v[200:203]
v_add_f32_dpp v51, v51, v51 row_ror:1 row_mask:0xf bank_mask:0xf
v_add_f32_dpp v52, v52, v52 row_ror:1 row_mask:0xf bank_mask:0xf
v_mfma_f32_16x16x32_bf16 v[176:179], a[128:131], a[8:11], v[176:179]
v_add_f32_dpp v53, v53, v53 row_ror:1 row_mask:0xf bank_mask:0xf
v_add_f32_dpp v54, v54, v54 row_ror:1 row_mask:0xf bank_mask:0xf
v_mfma_f32_16x16x32_bf16 v[176:179], a[132:135], a[12:15], v[176:179]
buffer_load_dwordx4 a[84:87], v2, s[40:43], s33 offen offset:2048 sc1
v_mfma_f32_16x16x32_bf16 v[152:155], a[132:135], a[4:7], v[152:155]
ds_read_b128 a[104:107], v5 offset:39936
v_add_f32_dpp v55, v55, v55 row_ror:1 row_mask:0xf bank_mask:0xf
v_mfma_f32_16x16x32_bf16 v[152:155], a[128:131], a[0:3], v[152:155]
v_add_u32 v233, 159744, v233
s_lshl_b32 s36, s28, 6
v_mfma_f32_16x16x32_bf16 v[132:135], a[136:139], a[0:3], v[132:135]
ds_read_b128 a[108:111], v5 offset:46080
s_lshl_b32 s37, s39, 6
v_mfma_f32_16x16x32_bf16 v[132:135], a[140:143], a[4:7], v[132:135]
v_add_u32 v232, s36, v233
v_mfma_f32_16x16x32_bf16 v[156:159], a[140:143], a[12:15], v[156:159]
buffer_load_dwordx4 v[116:119], v1, s[4:7], s88 offen offset:2048 sc1
v_mfma_f32_16x16x32_bf16 v[156:159], a[136:139], a[8:11], v[156:159]
ds_read_b128 a[112:115], v5 offset:40960
v_add_u32 v235, s37, v233
v_mfma_f32_16x16x32_bf16 v[180:183], a[136:139], a[16:19], v[180:183]
v_mfma_f32_16x16x32_bf16 v[180:183], a[140:143], a[20:23], v[180:183]
ds_read_b128 a[116:119], v5 offset:47104
v_mfma_f32_16x16x32_bf16 v[204:207], a[140:143], a[28:31], v[204:207]
v_mfma_f32_16x16x32_bf16 v[204:207], a[136:139], a[24:27], v[204:207]
buffer_load_dwordx4 a[88:91], v2, s[40:43], s35 offen offset:3072 sc1
v_mfma_f32_16x16x32_bf16 v[208:211], a[144:147], a[24:27], v[208:211]
v_mfma_f32_16x16x32_bf16 v[208:211], a[148:151], a[28:31], v[208:211]
v_mfma_f32_16x16x32_bf16 v[184:187], a[148:151], a[20:23], v[184:187]
v_mfma_f32_16x16x32_bf16 v[184:187], a[144:147], a[16:19], v[184:187]
v_mfma_f32_16x16x32_bf16 v[160:163], a[144:147], a[8:11], v[160:163]
buffer_load_dwordx4 a[92:95], v2, s[40:43], s33 offen offset:3072 sc1
s_add_u32 s35, s35, 0x4000
v_mfma_f32_16x16x32_bf16 v[160:163], a[148:151], a[12:15], v[160:163]
s_add_u32 s33, s33, 0x4000
v_mfma_f32_16x16x32_bf16 v[136:139], a[148:151], a[4:7], v[136:139]
v_mfma_f32_16x16x32_bf16 v[136:139], a[144:147], a[0:3], v[136:139]
s_waitcnt vmcnt(10) lgkmcnt(0)
v_mfma_f32_16x16x32_bf16 v[140:143], a[96:99], a[32:35], v[140:143]
ds_read_b128 a[128:131], v5 offset:41984
v_mfma_f32_16x16x32_bf16 v[140:143], a[100:103], a[36:39], v[140:143]
buffer_load_dwordx4 a[0:3], v2, s[40:43], s35 offen offset:0 sc1
v_mfma_f32_16x16x32_bf16 v[164:167], a[100:103], a[44:47], v[164:167]
ds_read_b128 a[132:135], v5 offset:48128
v_mfma_f32_16x16x32_bf16 v[164:167], a[96:99], a[40:43], v[164:167]
ds_write_b128 v232, v[48:51]
v_mfma_f32_16x16x32_bf16 v[188:191], a[96:99], a[48:51], v[188:191]
ds_write_b128 v235, v[52:55]
v_mfma_f32_16x16x32_bf16 v[188:191], a[100:103], a[52:55], v[188:191]
buffer_load_dwordx4 v[120:123], v1, s[4:7], s88 offen offset:3072 sc1
s_add_u32 m0, s18, 0x0
v_mfma_f32_16x16x32_bf16 v[212:215], a[100:103], a[60:63], v[212:215]
s_add_u32 s44, s50, 0x2824000
ds_read_b128 a[136:139], v5 offset:36864
v_mfma_f32_16x16x32_bf16 v[212:215], a[96:99], a[56:59], v[212:215]
v_mfma_f32_16x16x32_bf16 v[216:219], a[104:107], a[56:59], v[216:219]
ds_read_b128 a[140:143], v5 offset:43008
v_mfma_f32_16x16x32_bf16 v[216:219], a[108:111], a[60:63], v[216:219]
buffer_load_dwordx4 a[4:7], v2, s[40:43], s33 offen offset:0 sc1
v_mfma_f32_16x16x32_bf16 v[192:195], a[108:111], a[52:55], v[192:195]
ds_read_b128 a[144:147], v5 offset:37888
v_mfma_f32_16x16x32_bf16 v[192:195], a[104:107], a[48:51], v[192:195]
v_mfma_f32_16x16x32_bf16 v[168:171], a[104:107], a[40:43], v[168:171]
v_mfma_f32_16x16x32_bf16 v[168:171], a[108:111], a[44:47], v[168:171]
buffer_load_dwordx4 a[8:11], v2, s[40:43], s35 offen offset:1024 sc1
v_mfma_f32_16x16x32_bf16 v[144:147], a[108:111], a[36:39], v[144:147]
ds_read_b128 a[148:151], v5 offset:44032
v_mfma_f32_16x16x32_bf16 v[144:147], a[104:107], a[32:35], v[144:147]
v_mfma_f32_16x16x32_bf16 v[148:151], a[112:115], a[32:35], v[148:151]
v_mfma_f32_16x16x32_bf16 v[148:151], a[116:119], a[36:39], v[148:151]
buffer_load_dwordx4 v1, s[4:7], s44 offen offset:0 sc1 lds
v_mfma_f32_16x16x32_bf16 v[172:175], a[116:119], a[44:47], v[172:175]
v_mfma_f32_16x16x32_bf16 v[172:175], a[112:115], a[40:43], v[172:175]
v_mfma_f32_16x16x32_bf16 v[196:199], a[112:115], a[48:51], v[196:199]
v_mfma_f32_16x16x32_bf16 v[196:199], a[116:119], a[52:55], v[196:199]
buffer_load_dwordx4 a[12:15], v2, s[40:43], s33 offen offset:1024 sc1
v_mfma_f32_16x16x32_bf16 v[220:223], a[116:119], a[60:63], v[220:223]
v_mfma_f32_16x16x32_bf16 v[220:223], a[112:115], a[56:59], v[220:223]
s_waitcnt lgkmcnt(0)
s_barrier
v_mfma_f32_16x16x32_bf16 v[224:227], a[128:131], a[56:59], v[224:227]
v_add_u32 v5, 98304, v1
v_mfma_f32_16x16x32_bf16 v[224:227], a[132:135], a[60:63], v[224:227]
buffer_load_dwordx4 a[16:19], v2, s[40:43], s35 offen offset:2048 sc1
v_mfma_f32_16x16x32_bf16 v[200:203], a[132:135], a[52:55], v[200:203]
ds_read_b128 a[96:99], v5 offset:2048
v_mfma_f32_16x16x32_bf16 v[200:203], a[128:131], a[48:51], v[200:203]
ds_read_b128 a[100:103], v5 offset:8192
v_mfma_f32_16x16x32_bf16 v[176:179], a[128:131], a[40:43], v[176:179]
ds_read_b128 v[48:51], v233 offset:0
v_mfma_f32_16x16x32_bf16 v[176:179], a[132:135], a[44:47], v[176:179]
buffer_load_dwordx4 a[20:23], v2, s[40:43], s33 offen offset:2048 sc1
v_mfma_f32_16x16x32_bf16 v[152:155], a[132:135], a[36:39], v[152:155]
ds_read_b128 a[104:107], v5 offset:3072
v_mfma_f32_16x16x32_bf16 v[152:155], a[128:131], a[32:35], v[152:155]
v_mfma_f32_16x16x32_bf16 v[132:135], a[136:139], a[32:35], v[132:135]
ds_read_b128 a[108:111], v5 offset:9216
v_mfma_f32_16x16x32_bf16 v[132:135], a[140:143], a[36:39], v[132:135]
v_mfma_f32_16x16x32_bf16 v[156:159], a[140:143], a[44:47], v[156:159]
buffer_load_dwordx4 v1, s[4:7], s44 offen offset:1024 sc1 lds
s_add_u32 m0, s18, 0x2000
v_mfma_f32_16x16x32_bf16 v[156:159], a[136:139], a[40:43], v[156:159]
s_add_u32 s44, s50, 0x2826000
ds_read_b128 a[112:115], v5 offset:4096
v_mfma_f32_16x16x32_bf16 v[180:183], a[136:139], a[48:51], v[180:183]
ds_read_b128 v[52:55], v233 offset:64
v_mfma_f32_16x16x32_bf16 v[180:183], a[140:143], a[52:55], v[180:183]
ds_read_b128 a[116:119], v5 offset:10240
v_mfma_f32_16x16x32_bf16 v[204:207], a[140:143], a[60:63], v[204:207]
v_mfma_f32_16x16x32_bf16 v[204:207], a[136:139], a[56:59], v[204:207]
buffer_load_dwordx4 a[24:27], v2, s[40:43], s35 offen offset:3072 sc1
v_mfma_f32_16x16x32_bf16 v[208:211], a[144:147], a[56:59], v[208:211]
v_mfma_f32_16x16x32_bf16 v[208:211], a[148:151], a[60:63], v[208:211]
v_mfma_f32_16x16x32_bf16 v[184:187], a[148:151], a[52:55], v[184:187]
v_mfma_f32_16x16x32_bf16 v[184:187], a[144:147], a[48:51], v[184:187]
v_mfma_f32_16x16x32_bf16 v[160:163], a[144:147], a[40:43], v[160:163]
buffer_load_dwordx4 a[28:31], v2, s[40:43], s33 offen offset:3072 sc1
s_add_u32 s35, s35, 0x4000
v_mfma_f32_16x16x32_bf16 v[160:163], a[148:151], a[44:47], v[160:163]
s_add_u32 s33, s33, 0x4000
ds_read_b128 v[56:59], v233 offset:128
v_mfma_f32_16x16x32_bf16 v[136:139], a[148:151], a[36:39], v[136:139]
v_mfma_f32_16x16x32_bf16 v[136:139], a[144:147], a[32:35], v[136:139]
s_waitcnt vmcnt(11) lgkmcnt(1)
v_mfma_f32_16x16x32_bf16 v[140:143], a[96:99], a[64:67], v[140:143]
ds_read_b128 a[128:131], v5 offset:5120
v_mfma_f32_16x16x32_bf16 v[140:143], a[100:103], a[68:71], v[140:143]
buffer_load_dwordx4 a[32:35], v2, s[40:43], s35 offen offset:0 sc1
v_mfma_f32_16x16x32_bf16 v[164:167], a[100:103], a[76:79], v[164:167]
ds_read_b128 a[132:135], v5 offset:11264
v_mfma_f32_16x16x32_bf16 v[164:167], a[96:99], a[72:75], v[164:167]
v_mfma_f32_16x16x32_bf16 v[188:191], a[96:99], a[80:83], v[188:191]
v_mfma_f32_16x16x32_bf16 v[188:191], a[100:103], a[84:87], v[188:191]
buffer_load_dwordx4 a[36:39], v2, s[40:43], s33 offen offset:0 sc1
v_mfma_f32_16x16x32_bf16 v[212:215], a[100:103], a[92:95], v[212:215]
ds_read_b128 a[136:139], v5 offset:0
v_mfma_f32_16x16x32_bf16 v[212:215], a[96:99], a[88:91], v[212:215]
v_mfma_f32_16x16x32_bf16 v[216:219], a[104:107], a[88:91], v[216:219]
ds_read_b128 a[140:143], v5 offset:6144
v_mfma_f32_16x16x32_bf16 v[216:219], a[108:111], a[92:95], v[216:219]
ds_read_b128 v[60:63], v233 offset:192
v_mfma_f32_16x16x32_bf16 v[192:195], a[108:111], a[84:87], v[192:195]
buffer_load_dwordx4 v1, s[4:7], s44 offen offset:0 sc1 lds
v_mfma_f32_16x16x32_bf16 v[192:195], a[104:107], a[80:83], v[192:195]
ds_read_b128 a[144:147], v5 offset:1024
v_mfma_f32_16x16x32_bf16 v[168:171], a[104:107], a[72:75], v[168:171]
v_mfma_f32_16x16x32_bf16 v[168:171], a[108:111], a[76:79], v[168:171]
ds_read_b128 a[148:151], v5 offset:7168
v_mfma_f32_16x16x32_bf16 v[144:147], a[108:111], a[68:71], v[144:147]
v_mfma_f32_16x16x32_bf16 v[144:147], a[104:107], a[64:67], v[144:147]
buffer_load_dwordx4 a[40:43], v2, s[40:43], s35 offen offset:1024 sc1
v_mfma_f32_16x16x32_bf16 v[148:151], a[112:115], a[64:67], v[148:151]
v_mfma_f32_16x16x32_bf16 v[148:151], a[116:119], a[68:71], v[148:151]
v_mfma_f32_16x16x32_bf16 v[172:175], a[116:119], a[76:79], v[172:175]
ds_read_b128 v[64:67], v233 offset:256
v_mfma_f32_16x16x32_bf16 v[172:175], a[112:115], a[72:75], v[172:175]
v_mfma_f32_16x16x32_bf16 v[196:199], a[112:115], a[80:83], v[196:199]
buffer_load_dwordx4 a[44:47], v2, s[40:43], s33 offen offset:1024 sc1
v_mfma_f32_16x16x32_bf16 v[196:199], a[116:119], a[84:87], v[196:199]
v_mfma_f32_16x16x32_bf16 v[220:223], a[116:119], a[92:95], v[220:223]
v_mfma_f32_16x16x32_bf16 v[220:223], a[112:115], a[88:91], v[220:223]
s_waitcnt lgkmcnt(1)
v_mfma_f32_16x16x32_bf16 v[224:227], a[128:131], a[88:91], v[224:227]
ds_read_b128 a[96:99], v5 offset:14336
v_mfma_f32_16x16x32_bf16 v[224:227], a[132:135], a[92:95], v[224:227]
buffer_load_dwordx4 a[48:51], v2, s[40:43], s35 offen offset:2048 sc1
v_mfma_f32_16x16x32_bf16 v[200:203], a[132:135], a[84:87], v[200:203]
ds_read_b128 a[100:103], v5 offset:20480
v_mfma_f32_16x16x32_bf16 v[200:203], a[128:131], a[80:83], v[200:203]
v_mfma_f32_16x16x32_bf16 v[176:179], a[128:131], a[72:75], v[176:179]
v_mfma_f32_16x16x32_bf16 v[176:179], a[132:135], a[76:79], v[176:179]
buffer_load_dwordx4 a[52:55], v2, s[40:43], s33 offen offset:2048 sc1
v_mfma_f32_16x16x32_bf16 v[152:155], a[132:135], a[68:71], v[152:155]
ds_read_b128 a[104:107], v5 offset:15360
v_mfma_f32_16x16x32_bf16 v[152:155], a[128:131], a[64:67], v[152:155]
ds_read_b128 v[68:71], v233 offset:320
v_mfma_f32_16x16x32_bf16 v[132:135], a[136:139], a[64:67], v[132:135]
ds_read_b128 a[108:111], v5 offset:21504
v_mfma_f32_16x16x32_bf16 v[132:135], a[140:143], a[68:71], v[132:135]
v_mfma_f32_16x16x32_bf16 v[156:159], a[140:143], a[76:79], v[156:159]
buffer_load_dwordx4 v1, s[4:7], s44 offen offset:1024 sc1 lds
s_add_u32 m0, s18, 0x4000
v_mfma_f32_16x16x32_bf16 v[156:159], a[136:139], a[72:75], v[156:159]
s_add_u32 s44, s50, 0x2828000
ds_read_b128 a[112:115], v5 offset:16384
v_mfma_f32_16x16x32_bf16 v[180:183], a[136:139], a[80:83], v[180:183]
v_mfma_f32_16x16x32_bf16 v[180:183], a[140:143], a[84:87], v[180:183]
ds_read_b128 a[116:119], v5 offset:22528
v_mfma_f32_16x16x32_bf16 v[204:207], a[140:143], a[92:95], v[204:207]
v_mfma_f32_16x16x32_bf16 v[204:207], a[136:139], a[88:91], v[204:207]
buffer_load_dwordx4 a[56:59], v2, s[40:43], s35 offen offset:3072 sc1
v_mfma_f32_16x16x32_bf16 v[208:211], a[144:147], a[88:91], v[208:211]
v_mfma_f32_16x16x32_bf16 v[208:211], a[148:151], a[92:95], v[208:211]
v_mfma_f32_16x16x32_bf16 v[184:187], a[148:151], a[84:87], v[184:187]
v_mfma_f32_16x16x32_bf16 v[184:187], a[144:147], a[80:83], v[184:187]
v_mfma_f32_16x16x32_bf16 v[160:163], a[144:147], a[72:75], v[160:163]
buffer_load_dwordx4 a[60:63], v2, s[40:43], s33 offen offset:3072 sc1
s_add_u32 s35, s35, 0x4000
v_mfma_f32_16x16x32_bf16 v[160:163], a[148:151], a[76:79], v[160:163]
s_add_u32 s33, s33, 0x4000
v_mfma_f32_16x16x32_bf16 v[136:139], a[148:151], a[68:71], v[136:139]
v_mfma_f32_16x16x32_bf16 v[136:139], a[144:147], a[64:67], v[136:139]
s_waitcnt vmcnt(10) lgkmcnt(0)
v_mfma_f32_16x16x32_bf16 v[140:143], a[96:99], a[0:3], v[140:143]
ds_read_b128 a[128:131], v5 offset:17408
v_add_f32 v92, v92, v96
v_mfma_f32_16x16x32_bf16 v[140:143], a[100:103], a[4:7], v[140:143]
buffer_load_dwordx4 a[64:67], v2, s[40:43], s35 offen offset:0 sc1
v_mfma_f32_16x16x32_bf16 v[164:167], a[100:103], a[12:15], v[164:167]
ds_read_b128 a[132:135], v5 offset:23552
v_add_f32 v100, v100, v104
v_mfma_f32_16x16x32_bf16 v[164:167], a[96:99], a[8:11], v[164:167]
v_add_f32 v108, v108, v112
v_add_f32 v116, v116, v120
v_mfma_f32_16x16x32_bf16 v[188:191], a[96:99], a[16:19], v[188:191]
v_add_f32 v93, v93, v97
v_add_f32 v101, v101, v105
v_mfma_f32_16x16x32_bf16 v[188:191], a[100:103], a[20:23], v[188:191]
buffer_load_dwordx4 v1, s[4:7], s44 offen offset:0 sc1 lds
v_mfma_f32_16x16x32_bf16 v[212:215], a[100:103], a[28:31], v[212:215]
ds_read_b128 a[136:139], v5 offset:12288
v_add_f32 v109, v109, v113
v_mfma_f32_16x16x32_bf16 v[212:215], a[96:99], a[24:27], v[212:215]
v_add_f32 v117, v117, v121
v_add_f32 v94, v94, v98
v_mfma_f32_16x16x32_bf16 v[216:219], a[104:107], a[24:27], v[216:219]
ds_read_b128 a[140:143], v5 offset:18432
v_add_f32 v102, v102, v106
v_mfma_f32_16x16x32_bf16 v[216:219], a[108:111], a[28:31], v[216:219]
buffer_load_dwordx4 a[68:71], v2, s[40:43], s33 offen offset:0 sc1
v_mfma_f32_16x16x32_bf16 v[192:195], a[108:111], a[20:23], v[192:195]
ds_read_b128 a[144:147], v5 offset:13312
v_add_f32 v110, v110, v114
v_mfma_f32_16x16x32_bf16 v[192:195], a[104:107], a[16:19], v[192:195]
v_add_f32 v118, v118, v122
v_add_f32 v95, v95, v99
v_mfma_f32_16x16x32_bf16 v[168:171], a[104:107], a[8:11], v[168:171]
v_add_f32 v103, v103, v107
v_mfma_f32_16x16x32_bf16 v[168:171], a[108:111], a[12:15], v[168:171]
buffer_load_dwordx4 a[72:75], v2, s[40:43], s35 offen offset:1024 sc1
v_mfma_f32_16x16x32_bf16 v[144:147], a[108:111], a[4:7], v[144:147]
ds_read_b128 a[148:151], v5 offset:19456
v_add_f32 v111, v111, v115
v_mfma_f32_16x16x32_bf16 v[144:147], a[104:107], a[0:3], v[144:147]
v_add_f32 v119, v119, v123
v_add_f32_dpp v92, v92, v92 row_ror:8 row_mask:0xf bank_mask:0xf
v_mfma_f32_16x16x32_bf16 v[148:151], a[112:115], a[0:3], v[148:151]
v_add_f32_dpp v100, v100, v100 row_ror:8 row_mask:0xf bank_mask:0xf
v_mfma_f32_16x16x32_bf16 v[148:151], a[116:119], a[4:7], v[148:151]
buffer_load_dwordx4 v1, s[4:7], s44 offen offset:1024 sc1 lds
s_add_u32 m0, s18, 0x6000
v_mfma_f32_16x16x32_bf16 v[172:175], a[116:119], a[12:15], v[172:175]
s_add_u32 s44, s50, 0x282a000
v_add_f32_dpp v108, v108, v108 row_ror:8 row_mask:0xf bank_mask:0xf
v_mfma_f32_16x16x32_bf16 v[172:175], a[112:115], a[8:11], v[172:175]
v_add_f32_dpp v116, v116, v116 row_ror:8 row_mask:0xf bank_mask:0xf
v_add_f32_dpp v93, v93, v93 row_ror:8 row_mask:0xf bank_mask:0xf
v_mfma_f32_16x16x32_bf16 v[196:199], a[112:115], a[16:19], v[196:199]
v_add_f32_dpp v101, v101, v101 row_ror:8 row_mask:0xf bank_mask:0xf
v_mfma_f32_16x16x32_bf16 v[196:199], a[116:119], a[20:23], v[196:199]
buffer_load_dwordx4 a[76:79], v2, s[40:43], s33 offen offset:1024 sc1
v_mfma_f32_16x16x32_bf16 v[220:223], a[116:119], a[28:31], v[220:223]
v_add_f32_dpp v109, v109, v109 row_ror:8 row_mask:0xf bank_mask:0xf
v_add_f32_dpp v117, v117, v117 row_ror:8 row_mask:0xf bank_mask:0xf
v_mfma_f32_16x16x32_bf16 v[220:223], a[112:115], a[24:27], v[220:223]
v_add_f32_dpp v92, v94, v94 row_ror:8 row_mask:0xf bank_mask:0xc
s_waitcnt lgkmcnt(0)
v_mfma_f32_16x16x32_bf16 v[224:227], a[128:131], a[24:27], v[224:227]
ds_read_b128 a[96:99], v5 offset:26624
v_accvgpr_write_b32 a216, v48
v_mfma_f32_16x16x32_bf16 v[224:227], a[132:135], a[28:31], v[224:227]
buffer_load_dwordx4 a[80:83], v2, s[40:43], s35 offen offset:2048 sc1
v_mfma_f32_16x16x32_bf16 v[200:203], a[132:135], a[20:23], v[200:203]
ds_read_b128 a[100:103], v5 offset:32768
v_add_f32_dpp v100, v102, v102 row_ror:8 row_mask:0xf bank_mask:0xc
v_mfma_f32_16x16x32_bf16 v[200:203], a[128:131], a[16:19], v[200:203]
v_accvgpr_write_b32 a217, v49
v_add_f32_dpp v108, v110, v110 row_ror:8 row_mask:0xf bank_mask:0xc
v_mfma_f32_16x16x32_bf16 v[176:179], a[128:131], a[8:11], v[176:179]
v_add_f32_dpp v116, v118, v118 row_ror:8 row_mask:0xf bank_mask:0xc
v_add_f32_dpp v93, v95, v95 row_ror:8 row_mask:0xf bank_mask:0xc
v_mfma_f32_16x16x32_bf16 v[176:179], a[132:135], a[12:15], v[176:179]
buffer_load_dwordx4 a[84:87], v2, s[40:43], s33 offen offset:2048 sc1
v_mfma_f32_16x16x32_bf16 v[152:155], a[132:135], a[4:7], v[152:155]
ds_read_b128 a[104:107], v5 offset:27648
v_accvgpr_write_b32 a218, v50
v_mfma_f32_16x16x32_bf16 v[152:155], a[128:131], a[0:3], v[152:155]
v_add_f32_dpp v101, v103, v103 row_ror:8 row_mask:0xf bank_mask:0xc
v_add_f32_dpp v109, v111, v111 row_ror:8 row_mask:0xf bank_mask:0xc
v_mfma_f32_16x16x32_bf16 v[132:135], a[136:139], a[0:3], v[132:135]
ds_read_b128 a[108:111], v5 offset:33792
v_add_f32_dpp v117, v119, v119 row_ror:8 row_mask:0xf bank_mask:0xc
v_mfma_f32_16x16x32_bf16 v[132:135], a[140:143], a[4:7], v[132:135]
v_accvgpr_write_b32 a219, v51
v_mfma_f32_16x16x32_bf16 v[156:159], a[140:143], a[12:15], v[156:159]
buffer_load_dwordx4 v1, s[4:7], s44 offen offset:0 sc1 lds
v_mfma_f32_16x16x32_bf16 v[156:159], a[136:139], a[8:11], v[156:159]
ds_read_b128 a[112:115], v5 offset:28672
v_mfma_f32_16x16x32_bf16 v[180:183], a[136:139], a[16:19], v[180:183]
v_accvgpr_write_b32 a220, v52
v_mfma_f32_16x16x32_bf16 v[180:183], a[140:143], a[20:23], v[180:183]
ds_read_b128 a[116:119], v5 offset:34816
v_mfma_f32_16x16x32_bf16 v[204:207], a[140:143], a[28:31], v[204:207]
v_permlane32_swap_b32 v92, v93
v_mfma_f32_16x16x32_bf16 v[204:207], a[136:139], a[24:27], v[204:207]
buffer_load_dwordx4 a[88:91], v2, s[40:43], s35 offen offset:3072 sc1
v_mfma_f32_16x16x32_bf16 v[208:211], a[144:147], a[24:27], v[208:211]
v_accvgpr_write_b32 a221, v53
v_mfma_f32_16x16x32_bf16 v[208:211], a[148:151], a[28:31], v[208:211]
v_permlane32_swap_b32 v100, v101
v_mfma_f32_16x16x32_bf16 v[184:187], a[148:151], a[20:23], v[184:187]
v_accvgpr_write_b32 a222, v54
v_mfma_f32_16x16x32_bf16 v[184:187], a[144:147], a[16:19], v[184:187]
v_permlane32_swap_b32 v108, v109
v_mfma_f32_16x16x32_bf16 v[160:163], a[144:147], a[8:11], v[160:163]
buffer_load_dwordx4 a[92:95], v2, s[40:43], s33 offen offset:3072 sc1
s_add_u32 s35, s35, 0x4000
v_mfma_f32_16x16x32_bf16 v[160:163], a[148:151], a[12:15], v[160:163]
s_add_u32 s33, s33, 0x4000
v_accvgpr_write_b32 a223, v55
v_mfma_f32_16x16x32_bf16 v[136:139], a[148:151], a[4:7], v[136:139]
v_permlane32_swap_b32 v116, v117
v_mfma_f32_16x16x32_bf16 v[136:139], a[144:147], a[0:3], v[136:139]
v_add_f32 v92, v92, v93
s_waitcnt vmcnt(11) lgkmcnt(0)
v_mfma_f32_16x16x32_bf16 v[140:143], a[96:99], a[32:35], v[140:143]
ds_read_b128 a[128:131], v5 offset:29696
v_accvgpr_write_b32 a224, v56
v_mfma_f32_16x16x32_bf16 v[140:143], a[100:103], a[36:39], v[140:143]
buffer_load_dwordx4 a[0:3], v2, s[40:43], s35 offen offset:0 sc1
v_mfma_f32_16x16x32_bf16 v[164:167], a[100:103], a[44:47], v[164:167]
ds_read_b128 a[132:135], v5 offset:35840
v_add_f32 v100, v100, v101
v_mfma_f32_16x16x32_bf16 v[164:167], a[96:99], a[40:43], v[164:167]
v_accvgpr_write_b32 a225, v57
v_add_f32 v108, v108, v109
v_mfma_f32_16x16x32_bf16 v[188:191], a[96:99], a[48:51], v[188:191]
v_add_f32 v116, v116, v117
v_mov_b32 v94, v92
v_mfma_f32_16x16x32_bf16 v[188:191], a[100:103], a[52:55], v[188:191]
buffer_load_dwordx4 a[4:7], v2, s[40:43], s33 offen offset:0 sc1
v_mfma_f32_16x16x32_bf16 v[212:215], a[100:103], a[60:63], v[212:215]
ds_read_b128 a[136:139], v5 offset:24576
v_accvgpr_write_b32 a226, v58
v_mfma_f32_16x16x32_bf16 v[212:215], a[96:99], a[56:59], v[212:215]
v_mov_b32 v102, v100
v_mov_b32 v110, v108
v_mfma_f32_16x16x32_bf16 v[216:219], a[104:107], a[56:59], v[216:219]
ds_read_b128 a[140:143], v5 offset:30720
v_mov_b32 v118, v116
v_mfma_f32_16x16x32_bf16 v[216:219], a[108:111], a[60:63], v[216:219]
v_accvgpr_write_b32 a227, v59
v_mfma_f32_16x16x32_bf16 v[192:195], a[108:111], a[52:55], v[192:195]
buffer_load_dwordx4 v1, s[4:7], s44 offen offset:1024 sc1 lds
s_add_u32 m0, s18, 0x8000
v_mfma_f32_16x16x32_bf16 v[192:195], a[104:107], a[48:51], v[192:195]
s_add_u32 s44, s50, 0x282c000
ds_read_b128 a[144:147], v5 offset:25600
v_mfma_f32_16x16x32_bf16 v[168:171], a[104:107], a[40:43], v[168:171]
v_accvgpr_write_b32 a228, v60
v_mfma_f32_16x16x32_bf16 v[168:171], a[108:111], a[44:47], v[168:171]
ds_read_b128 a[148:151], v5 offset:31744
v_mfma_f32_16x16x32_bf16 v[144:147], a[108:111], a[36:39], v[144:147]
v_permlane16_swap_b32 v92, v94
v_mfma_f32_16x16x32_bf16 v[144:147], a[104:107], a[32:35], v[144:147]
buffer_load_dwordx4 a[8:11], v2, s[40:43], s35 offen offset:1024 sc1
v_mfma_f32_16x16x32_bf16 v[148:151], a[112:115], a[32:35], v[148:151]
v_accvgpr_write_b32 a229, v61
v_mfma_f32_16x16x32_bf16 v[148:151], a[116:119], a[36:39], v[148:151]
v_permlane16_swap_b32 v100, v102
v_mfma_f32_16x16x32_bf16 v[172:175], a[116:119], a[44:47], v[172:175]
v_accvgpr_write_b32 a230, v62
v_mfma_f32_16x16x32_bf16 v[172:175], a[112:115], a[40:43], v[172:175]
v_permlane16_swap_b32 v108, v110
v_mfma_f32_16x16x32_bf16 v[196:199], a[112:115], a[48:51], v[196:199]
buffer_load_dwordx4 a[12:15], v2, s[40:43], s33 offen offset:1024 sc1
v_mfma_f32_16x16x32_bf16 v[196:199], a[116:119], a[52:55], v[196:199]
v_accvgpr_write_b32 a231, v63
v_mfma_f32_16x16x32_bf16 v[220:223], a[116:119], a[60:63], v[220:223]
v_permlane16_swap_b32 v116, v118
v_mfma_f32_16x16x32_bf16 v[220:223], a[112:115], a[56:59], v[220:223]
v_add_f32 v92, v92, v94
s_waitcnt lgkmcnt(0)
v_mfma_f32_16x16x32_bf16 v[224:227], a[128:131], a[56:59], v[224:227]
ds_read_b128 a[96:99], v5 offset:38912
v_accvgpr_write_b32 a232, v64
v_mfma_f32_16x16x32_bf16 v[224:227], a[132:135], a[60:63], v[224:227]
buffer_load_dwordx4 a[16:19], v2, s[40:43], s35 offen offset:2048 sc1
v_mfma_f32_16x16x32_bf16 v[200:203], a[132:135], a[52:55], v[200:203]
ds_read_b128 a[100:103], v5 offset:45056
v_add_f32 v100, v100, v102
v_mfma_f32_16x16x32_bf16 v[200:203], a[128:131], a[48:51], v[200:203]
v_accvgpr_write_b32 a233, v65
v_add_f32 v108, v108, v110
v_mfma_f32_16x16x32_bf16 v[176:179], a[128:131], a[40:43], v[176:179]
v_add_f32 v116, v116, v118
v_mov_b32 v94, v92
v_mfma_f32_16x16x32_bf16 v[176:179], a[132:135], a[44:47], v[176:179]
L_stub6:
s_cbranch_execz L_stub7
buffer_load_dwordx4 a[20:23], v2, s[40:43], s33 offen offset:2048 sc1
v_mfma_f32_16x16x32_bf16 v[152:155], a[132:135], a[36:39], v[152:155]
ds_read_b128 a[104:107], v5 offset:39936
v_accvgpr_write_b32 a234, v66
v_mfma_f32_16x16x32_bf16 v[152:155], a[128:131], a[32:35], v[152:155]
v_mov_b32 v102, v100
v_mov_b32 v110, v108
v_mfma_f32_16x16x32_bf16 v[132:135], a[136:139], a[32:35], v[132:135]
ds_read_b128 a[108:111], v5 offset:46080
v_mov_b32 v118, v116
v_mfma_f32_16x16x32_bf16 v[132:135], a[140:143], a[36:39], v[132:135]
v_accvgpr_write_b32 a235, v67
v_mfma_f32_16x16x32_bf16 v[156:159], a[140:143], a[44:47], v[156:159]
buffer_load_dwordx4 v1, s[4:7], s44 offen offset:0 sc1 lds
v_mfma_f32_16x16x32_bf16 v[156:159], a[136:139], a[40:43], v[156:159]
ds_read_b128 a[112:115], v5 offset:40960
v_mfma_f32_16x16x32_bf16 v[180:183], a[136:139], a[48:51], v[180:183]
v_accvgpr_write_b32 a236, v68
v_mfma_f32_16x16x32_bf16 v[180:183], a[140:143], a[52:55], v[180:183]
ds_read_b128 a[116:119], v5 offset:47104
v_mfma_f32_16x16x32_bf16 v[204:207], a[140:143], a[60:63], v[204:207]
v_permlane32_swap_b32 v92, v94
v_mfma_f32_16x16x32_bf16 v[204:207], a[136:139], a[56:59], v[204:207]
buffer_load_dwordx4 a[24:27], v2, s[40:43], s35 offen offset:3072 sc1
v_mfma_f32_16x16x32_bf16 v[208:211], a[144:147], a[56:59], v[208:211]
v_accvgpr_write_b32 a237, v69
v_mfma_f32_16x16x32_bf16 v[208:211], a[148:151], a[60:63], v[208:211]
v_permlane32_swap_b32 v100, v102
v_mfma_f32_16x16x32_bf16 v[184:187], a[148:151], a[52:55], v[184:187]
v_accvgpr_write_b32 a238, v70
v_mfma_f32_16x16x32_bf16 v[184:187], a[144:147], a[48:51], v[184:187]
v_permlane32_swap_b32 v108, v110
v_mfma_f32_16x16x32_bf16 v[160:163], a[144:147], a[40:43], v[160:163]
buffer_load_dwordx4 a[28:31], v2, s[40:43], s33 offen offset:3072 sc1
s_add_u32 s35, s35, 0x4000
v_mfma_f32_16x16x32_bf16 v[160:163], a[148:151], a[44:47], v[160:163]
s_add_u32 s33, s33, 0x4000
v_accvgpr_write_b32 a239, v71
v_mfma_f32_16x16x32_bf16 v[136:139], a[148:151], a[36:39], v[136:139]
v_permlane32_swap_b32 v116, v118
v_mfma_f32_16x16x32_bf16 v[136:139], a[144:147], a[32:35], v[136:139]
v_mul_f32 v82, 0xba800000, v92
s_waitcnt vmcnt(10) lgkmcnt(0)
v_mfma_f32_16x16x32_bf16 v[140:143], a[96:99], a[64:67], v[140:143]
ds_read_b128 a[128:131], v5 offset:41984
v_mul_f32 v84, 0xba800000, v100
v_mfma_f32_16x16x32_bf16 v[140:143], a[100:103], a[68:71], v[140:143]
buffer_load_dwordx4 a[32:35], v2, s[40:43], s35 offen offset:0 sc1
v_mfma_f32_16x16x32_bf16 v[164:167], a[100:103], a[76:79], v[164:167]
ds_read_b128 a[132:135], v5 offset:48128
v_mul_f32 v86, 0xba800000, v108
v_mfma_f32_16x16x32_bf16 v[164:167], a[96:99], a[72:75], v[164:167]
v_mul_f32 v88, 0xba800000, v116
v_mul_f32 v94, 0x3a800000, v94
v_mfma_f32_16x16x32_bf16 v[188:191], a[96:99], a[80:83], v[188:191]
v_mul_f32 v102, 0x3a800000, v102
v_mul_f32 v110, 0x3a800000, v110
v_mfma_f32_16x16x32_bf16 v[188:191], a[100:103], a[84:87], v[188:191]
buffer_load_dwordx4 v1, s[4:7], s44 offen offset:1024 sc1 lds
s_add_u32 m0, s18, 0xa000
v_mfma_f32_16x16x32_bf16 v[212:215], a[100:103], a[92:95], v[212:215]
s_add_u32 s44, s50, 0x282e000
ds_read_b128 a[136:139], v5 offset:36864
v_mfma_f32_16x16x32_bf16 v[212:215], a[96:99], a[88:91], v[212:215]
v_mul_f32 v118, 0x3a800000, v118
v_fma_f32 v94, -v82, v82, v94
v_fma_f32 v102, -v84, v84, v102
v_fma_f32 v110, -v86, v86, v110
v_fma_f32 v118, -v88, v88, v118
v_max_f32 v94, 0, v94
v_max_f32 v102, 0, v102
v_max_f32 v110, 0, v110
v_max_f32 v118, 0, v118
v_add_f32 v94, 0x3727c5ac, v94
v_add_f32 v102, 0x3727c5ac, v102
v_add_f32 v110, 0x3727c5ac, v110
v_add_f32 v118, 0x3727c5ac, v118
v_rsq_f32 v83, v94
v_rsq_f32 v85, v102
v_rsq_f32 v87, v110
v_rsq_f32 v89, v118
v_mfma_f32_16x16x32_bf16 v[216:219], a[104:107], a[88:91], v[216:219]
ds_read_b128 a[140:143], v5 offset:43008
v_mfma_f32_16x16x32_bf16 v[216:219], a[108:111], a[92:95], v[216:219]
buffer_load_dwordx4 a[36:39], v2, s[40:43], s33 offen offset:0 sc1
v_mfma_f32_16x16x32_bf16 v[192:195], a[108:111], a[84:87], v[192:195]
ds_read_b128 a[144:147], v5 offset:37888
v_fmac_f32 v140, v56, v82
v_mfma_f32_16x16x32_bf16 v[192:195], a[104:107], a[80:83], v[192:195]
v_mfma_f32_16x16x32_bf16 v[168:171], a[104:107], a[72:75], v[168:171]
v_fmac_f32 v164, v56, v84
v_mfma_f32_16x16x32_bf16 v[168:171], a[108:111], a[76:79], v[168:171]
buffer_load_dwordx4 a[40:43], v2, s[40:43], s35 offen offset:1024 sc1
v_mfma_f32_16x16x32_bf16 v[144:147], a[108:111], a[68:71], v[144:147]
ds_read_b128 a[148:151], v5 offset:44032
v_fmac_f32 v188, v56, v86
v_mfma_f32_16x16x32_bf16 v[144:147], a[104:107], a[64:67], v[144:147]
v_mfma_f32_16x16x32_bf16 v[148:151], a[112:115], a[64:67], v[148:151]
v_fmac_f32 v212, v56, v88
v_mfma_f32_16x16x32_bf16 v[148:151], a[116:119], a[68:71], v[148:151]
buffer_load_dwordx4 v1, s[4:7], s44 offen offset:0 sc1 lds
v_mfma_f32_16x16x32_bf16 v[172:175], a[116:119], a[76:79], v[172:175]
v_fmac_f32 v216, v60, v88
v_mfma_f32_16x16x32_bf16 v[172:175], a[112:115], a[72:75], v[172:175]
v_mfma_f32_16x16x32_bf16 v[196:199], a[112:115], a[80:83], v[196:199]
v_fmac_f32 v192, v60, v86
v_mfma_f32_16x16x32_bf16 v[196:199], a[116:119], a[84:87], v[196:199]
buffer_load_dwordx4 a[44:47], v2, s[40:43], s33 offen offset:1024 sc1
v_mfma_f32_16x16x32_bf16 v[220:223], a[116:119], a[92:95], v[220:223]
v_fmac_f32 v168, v60, v84
v_fmac_f32 v141, v57, v82
v_mfma_f32_16x16x32_bf16 v[220:223], a[112:115], a[88:91], v[220:223]
s_waitcnt lgkmcnt(0)
s_barrier
v_mfma_f32_16x16x32_bf16 v[224:227], a[128:131], a[88:91], v[224:227]
v_add_u32 v5, 0, v1
v_fmac_f32 v144, v60, v82
v_mfma_f32_16x16x32_bf16 v[224:227], a[132:135], a[92:95], v[224:227]
buffer_load_dwordx4 a[48:51], v2, s[40:43], s35 offen offset:2048 sc1
v_mfma_f32_16x16x32_bf16 v[200:203], a[132:135], a[84:87], v[200:203]
ds_read_b128 a[96:99], v5 offset:2048
v_fmac_f32 v148, v64, v82
v_mfma_f32_16x16x32_bf16 v[200:203], a[128:131], a[80:83], v[200:203]
ds_read_b128 a[100:103], v5 offset:8192
v_fmac_f32 v165, v57, v84
v_mfma_f32_16x16x32_bf16 v[176:179], a[128:131], a[72:75], v[176:179]
v_fmac_f32 v172, v64, v84
v_fmac_f32 v189, v57, v86
v_mfma_f32_16x16x32_bf16 v[176:179], a[132:135], a[76:79], v[176:179]
buffer_load_dwordx4 a[52:55], v2, s[40:43], s33 offen offset:2048 sc1
v_mfma_f32_16x16x32_bf16 v[152:155], a[132:135], a[68:71], v[152:155]
ds_read_b128 a[104:107], v5 offset:3072
v_fmac_f32 v196, v64, v86
v_mfma_f32_16x16x32_bf16 v[152:155], a[128:131], a[64:67], v[152:155]
v_fmac_f32 v213, v57, v88
v_fmac_f32 v217, v61, v88
v_mfma_f32_16x16x32_bf16 v[132:135], a[136:139], a[64:67], v[132:135]
ds_read_b128 a[108:111], v5 offset:9216
v_fmac_f32 v220, v64, v88
v_mfma_f32_16x16x32_bf16 v[132:135], a[140:143], a[68:71], v[132:135]
v_fmac_f32 v193, v61, v86
v_mfma_f32_16x16x32_bf16 v[156:159], a[140:143], a[76:79], v[156:159]
buffer_load_dwordx4 v1, s[4:7], s44 offen offset:1024 sc1 lds
s_add_u32 m0, s19, 49152
v_mfma_f32_16x16x32_bf16 v[156:159], a[136:139], a[72:75], v[156:159]
s_add_u32 s44, s85, 0x1c04000
ds_read_b128 a[112:115], v5 offset:4096
v_mfma_f32_16x16x32_bf16 v[180:183], a[136:139], a[80:83], v[180:183]
v_fmac_f32 v224, v68, v88
v_fmac_f32 v200, v68, v86
v_mfma_f32_16x16x32_bf16 v[180:183], a[140:143], a[84:87], v[180:183]
ds_read_b128 a[116:119], v5 offset:10240
v_fmac_f32 v169, v61, v84
v_mfma_f32_16x16x32_bf16 v[204:207], a[140:143], a[92:95], v[204:207]
v_fmac_f32 v176, v68, v84
v_fmac_f32 v145, v61, v82
v_mfma_f32_16x16x32_bf16 v[204:207], a[136:139], a[88:91], v[204:207]
buffer_load_dwordx4 a[56:59], v2, s[40:43], s35 offen offset:3072 sc1
v_mfma_f32_16x16x32_bf16 v[208:211], a[144:147], a[88:91], v[208:211]
v_fmac_f32 v152, v68, v82
v_fmac_f32 v149, v65, v82
v_mfma_f32_16x16x32_bf16 v[208:211], a[148:151], a[92:95], v[208:211]
v_fmac_f32 v173, v65, v84
v_mfma_f32_16x16x32_bf16 v[184:187], a[148:151], a[84:87], v[184:187]
v_fmac_f32 v132, v48, v82
v_fmac_f32 v197, v65, v86
v_mfma_f32_16x16x32_bf16 v[184:187], a[144:147], a[80:83], v[184:187]
v_mfma_f32_16x16x32_bf16 v[160:163], a[144:147], a[72:75], v[160:163]
buffer_load_dwordx4 a[60:63], v2, s[40:43], s33 offen offset:3072 sc1
s_add_u32 s35, s35, 0x4000
v_mfma_f32_16x16x32_bf16 v[160:163], a[148:151], a[76:79], v[160:163]
s_add_u32 s33, s33, 0x4000
v_fmac_f32 v156, v48, v84
v_mfma_f32_16x16x32_bf16 v[136:139], a[148:151], a[68:71], v[136:139]
v_fmac_f32 v180, v48, v86
v_fmac_f32 v221, v65, v88
v_mfma_f32_16x16x32_bf16 v[136:139], a[144:147], a[64:67], v[136:139]
v_fmac_f32 v225, v69, v88
s_waitcnt vmcnt(11) lgkmcnt(0)
v_mfma_f32_16x16x32_bf16 v[140:143], a[96:99], a[0:3], v[140:143]
ds_read_b128 a[128:131], v5 offset:5120
v_fmac_f32 v204, v48, v88
v_mfma_f32_16x16x32_bf16 v[140:143], a[100:103], a[4:7], v[140:143]
buffer_load_dwordx4 a[64:67], v2, s[40:43], s35 offen offset:0 sc1
s_lshl_b32 s36, s28, 9
v_mfma_f32_16x16x32_bf16 v[164:167], a[100:103], a[12:15], v[164:167]
ds_read_b128 a[132:135], v5 offset:11264
v_fmac_f32 v208, v52, v88
v_mfma_f32_16x16x32_bf16 v[164:167], a[96:99], a[8:11], v[164:167]
v_fmac_f32 v201, v69, v86
v_fmac_f32 v177, v69, v84
v_mfma_f32_16x16x32_bf16 v[188:191], a[96:99], a[16:19], v[188:191]
v_fmac_f32 v184, v52, v86
v_fmac_f32 v153, v69, v82
v_mfma_f32_16x16x32_bf16 v[188:191], a[100:103], a[20:23], v[188:191]
buffer_load_dwordx4 a[68:71], v2, s[40:43], s33 offen offset:0 sc1
s_lshl_b32 s37, s30, 2
v_mfma_f32_16x16x32_bf16 v[212:215], a[100:103], a[28:31], v[212:215]
ds_read_b128 a[136:139], v5 offset:0
v_fmac_f32 v160, v52, v84
v_mfma_f32_16x16x32_bf16 v[212:215], a[96:99], a[24:27], v[212:215]
v_fmac_f32 v133, v49, v82
s_add_u32 s37, s37, s28
v_mfma_f32_16x16x32_bf16 v[216:219], a[104:107], a[24:27], v[216:219]
ds_read_b128 a[140:143], v5 offset:6144
v_fmac_f32 v136, v52, v82
v_mfma_f32_16x16x32_bf16 v[216:219], a[108:111], a[28:31], v[216:219]
buffer_load_dwordx4 a[72:75], v2, s[40:43], s35 offen offset:1024 sc1
s_lshr_b32 s98, s37, 1
v_mfma_f32_16x16x32_bf16 v[192:195], a[108:111], a[20:23], v[192:195]
ds_read_b128 a[144:147], v5 offset:1024
v_fmac_f32 v157, v49, v84
v_mfma_f32_16x16x32_bf16 v[192:195], a[104:107], a[16:19], v[192:195]
v_fmac_f32 v181, v49, v86
v_fmac_f32 v142, v58, v82
v_mfma_f32_16x16x32_bf16 v[168:171], a[104:107], a[8:11], v[168:171]
v_fmac_f32 v205, v49, v88
v_fmac_f32 v166, v58, v84
v_mfma_f32_16x16x32_bf16 v[168:171], a[108:111], a[12:15], v[168:171]
buffer_load_dwordx4 a[76:79], v2, s[40:43], s33 offen offset:1024 sc1
s_lshl_b32 s98, s98, 14
v_mfma_f32_16x16x32_bf16 v[144:147], a[108:111], a[4:7], v[144:147]
ds_read_b128 a[148:151], v5 offset:7168
v_fmac_f32 v209, v53, v88
v_mfma_f32_16x16x32_bf16 v[144:147], a[104:107], a[0:3], v[144:147]
v_fmac_f32 v190, v58, v86
s_and_b32 s99, s19, 0x1000
v_mfma_f32_16x16x32_bf16 v[148:151], a[112:115], a[0:3], v[148:151]
v_fmac_f32 v185, v53, v86
v_fmac_f32 v214, v58, v88
v_mfma_f32_16x16x32_bf16 v[148:151], a[116:119], a[4:7], v[148:151]
buffer_load_dwordx4 a[80:83], v2, s[40:43], s35 offen offset:2048 sc1
s_add_u32 s98, s98, s99
v_mfma_f32_16x16x32_bf16 v[172:175], a[116:119], a[12:15], v[172:175]
v_fmac_f32 v161, v53, v84
v_fmac_f32 v218, v62, v88
v_mfma_f32_16x16x32_bf16 v[172:175], a[112:115], a[8:11], v[172:175]
v_add_u32 v232, s19, v7
s_bfe_u32 s90, s51, 0x10005
v_mfma_f32_16x16x32_bf16 v[196:199], a[112:115], a[16:19], v[196:199]
v_fmac_f32 v137, v53, v82
v_fmac_f32 v194, v62, v86
v_mfma_f32_16x16x32_bf16 v[196:199], a[116:119], a[20:23], v[196:199]
buffer_load_dwordx4 a[84:87], v2, s[40:43], s33 offen offset:2048 sc1
s_lshl_b32 s90, s90, 13
v_mfma_f32_16x16x32_bf16 v[220:223], a[116:119], a[28:31], v[220:223]
v_fmac_f32 v170, v62, v84
v_fmac_f32 v143, v59, v82
v_mfma_f32_16x16x32_bf16 v[220:223], a[112:115], a[24:27], v[220:223]
s_add_u32 s98, s98, s90
s_waitcnt lgkmcnt(0)
v_mfma_f32_16x16x32_bf16 v[224:227], a[128:131], a[24:27], v[224:227]
ds_read_b128 a[96:99], v5 offset:14336
v_fmac_f32 v146, v62, v82
v_mfma_f32_16x16x32_bf16 v[224:227], a[132:135], a[28:31], v[224:227]
buffer_load_dwordx4 a[88:91], v2, s[40:43], s35 offen offset:3072 sc1
s_add_u32 s98, s98, 0x1400000
v_mfma_f32_16x16x32_bf16 v[200:203], a[132:135], a[20:23], v[200:203]
ds_read_b128 a[100:103], v5 offset:20480
v_fmac_f32 v150, v66, v82
v_mfma_f32_16x16x32_bf16 v[200:203], a[128:131], a[16:19], v[200:203]
v_fmac_f32 v167, v59, v84
v_fmac_f32 v191, v59, v86
v_mfma_f32_16x16x32_bf16 v[176:179], a[128:131], a[8:11], v[176:179]
v_fmac_f32 v174, v66, v84
v_fmac_f32 v215, v59, v88
v_mfma_f32_16x16x32_bf16 v[176:179], a[132:135], a[12:15], v[176:179]
ds_read_b128 a[104:107], v5 offset:15360
s_xor_b32 s99, s98, 0x2000
v_mfma_f32_16x16x32_bf16 v[152:155], a[132:135], a[4:7], v[152:155]
v_fmac_f32 v198, v66, v86
v_fmac_f32 v219, v63, v88
v_mfma_f32_16x16x32_bf16 v[152:155], a[128:131], a[0:3], v[152:155]
buffer_load_dwordx4 v1, s[4:7], s44 offen offset:0 sc1 lds
s_and_b32 s91, s29, 4
v_mfma_f32_16x16x32_bf16 v[132:135], a[136:139], a[0:3], v[132:135]
ds_read_b128 a[108:111], v5 offset:21504
v_fmac_f32 v222, v66, v88
v_mfma_f32_16x16x32_bf16 v[132:135], a[140:143], a[4:7], v[132:135]
v_fmac_f32 v195, v63, v86
s_lshl_b32 s91, s91, 11
v_mfma_f32_16x16x32_bf16 v[156:159], a[140:143], a[12:15], v[156:159]
ds_read_b128 a[112:115], v5 offset:16384
v_fmac_f32 v226, v70, v88
v_mfma_f32_16x16x32_bf16 v[156:159], a[136:139], a[8:11], v[156:159]
v_fmac_f32 v171, v63, v84
s_xor_b32 s96, s98, s91
v_mfma_f32_16x16x32_bf16 v[180:183], a[136:139], a[16:19], v[180:183]
v_fmac_f32 v202, v70, v86
v_fmac_f32 v147, v63, v82
v_mfma_f32_16x16x32_bf16 v[180:183], a[140:143], a[20:23], v[180:183]
buffer_load_dwordx4 a[92:95], v2, s[40:43], s33 offen offset:3072 sc1
s_add_u32 s35, s35, 0x4000
v_mfma_f32_16x16x32_bf16 v[204:207], a[140:143], a[28:31], v[204:207]
s_add_u32 s33, s33, 0x4000
ds_read_b128 a[116:119], v5 offset:22528
v_mfma_f32_16x16x32_bf16 v[204:207], a[136:139], a[24:27], v[204:207]
v_fmac_f32 v178, v70, v84
v_fmac_f32 v151, v67, v82
v_mfma_f32_16x16x32_bf16 v[208:211], a[144:147], a[24:27], v[208:211]
v_fmac_f32 v154, v70, v82
v_fmac_f32 v175, v67, v84
v_mfma_f32_16x16x32_bf16 v[208:211], a[148:151], a[28:31], v[208:211]
s_lshl_b32 s97, s81, 10
s_add_u32 s96, s96, s97
s_lshr_b32 s100, s37, 4
v_mfma_f32_16x16x32_bf16 v[184:187], a[148:151], a[20:23], v[184:187]
v_fmac_f32 v134, v50, v82
v_fmac_f32 v199, v67, v86
v_mfma_f32_16x16x32_bf16 v[184:187], a[144:147], a[16:19], v[184:187]
buffer_load_dwordx4 v1, s[4:7], s44 offen offset:1024 sc1 lds
s_lshl_b32 s100, s100, 14
v_mfma_f32_16x16x32_bf16 v[160:163], a[144:147], a[8:11], v[160:163]
v_fmac_f32 v158, v50, v84
v_fmac_f32 v223, v67, v88
v_mfma_f32_16x16x32_bf16 v[160:163], a[148:151], a[12:15], v[160:163]
s_and_b32 s37, s37, 15
s_lshl_b32 s37, s37, 9
s_add_u32 s100, s100, s37
v_mfma_f32_16x16x32_bf16 v[136:139], a[148:151], a[4:7], v[136:139]
v_fmac_f32 v182, v50, v86
v_fmac_f32 v227, v71, v88
v_mfma_f32_16x16x32_bf16 v[136:139], a[144:147], a[0:3], v[136:139]
s_waitcnt vmcnt(10) lgkmcnt(0)
s_barrier
v_mfma_f32_16x16x32_bf16 v[140:143], a[96:99], a[32:35], v[140:143]
ds_read_b128 a[128:131], v5 offset:17408
v_fmac_f32 v206, v50, v88
v_mfma_f32_16x16x32_bf16 v[140:143], a[100:103], a[36:39], v[140:143]
buffer_load_dwordx4 a[0:3], v2, s[40:43], s35 offen offset:0 sc1
s_add_u32 s100, s100, 0x240000
v_mfma_f32_16x16x32_bf16 v[164:167], a[100:103], a[44:47], v[164:167]
ds_read_b128 a[132:135], v5 offset:23552
v_fmac_f32 v210, v54, v88
v_mfma_f32_16x16x32_bf16 v[164:167], a[96:99], a[40:43], v[164:167]
v_fmac_f32 v203, v71, v86
v_fmac_f32 v179, v71, v84
v_mfma_f32_16x16x32_bf16 v[188:191], a[96:99], a[48:51], v[188:191]
buffer_load_dwordx4 a[4:7], v2, s[40:43], s33 offen offset:0 sc1
s_xor_b32 s90, s91, s79
v_mfma_f32_16x16x32_bf16 v[188:191], a[100:103], a[52:55], v[188:191]
ds_read_b128 a[136:139], v5 offset:26624
v_fmac_f32 v186, v54, v86
v_mfma_f32_16x16x32_bf16 v[212:215], a[100:103], a[60:63], v[212:215]
v_fmac_f32 v162, v54, v84
v_fmac_f32 v155, v71, v82
v_mfma_f32_16x16x32_bf16 v[212:215], a[96:99], a[56:59], v[212:215]
buffer_load_dwordx4 a[8:11], v2, s[40:43], s35 offen offset:1024 sc1
s_lshl_b32 s97, s81, 7
v_mfma_f32_16x16x32_bf16 v[216:219], a[104:107], a[56:59], v[216:219]
ds_read_b128 a[140:143], v5 offset:32768
v_fmac_f32 v138, v54, v82
v_mfma_f32_16x16x32_bf16 v[216:219], a[108:111], a[60:63], v[216:219]
v_fmac_f32 v135, v51, v82
v_fmac_f32 v159, v51, v84
v_mfma_f32_16x16x32_bf16 v[192:195], a[108:111], a[52:55], v[192:195]
buffer_load_dwordx4 a[12:15], v2, s[40:43], s33 offen offset:1024 sc1
s_add_u32 s97, s97, s79
v_mfma_f32_16x16x32_bf16 v[192:195], a[104:107], a[48:51], v[192:195]
ds_read_b128 a[144:147], v5 offset:27648
v_fmac_f32 v183, v51, v86
v_mfma_f32_16x16x32_bf16 v[168:171], a[104:107], a[40:43], v[168:171]
v_fmac_f32 v207, v51, v88
s_add_u32 s97, s97, s100
v_mfma_f32_16x16x32_bf16 v[168:171], a[108:111], a[44:47], v[168:171]
buffer_load_dwordx4 a[16:19], v2, s[40:43], s35 offen offset:2048 sc1
s_lshr_b32 s37, s30, 2
v_mfma_f32_16x16x32_bf16 v[144:147], a[108:111], a[36:39], v[144:147]
ds_read_b128 a[148:151], v5 offset:33792
v_fmac_f32 v211, v55, v88
v_mfma_f32_16x16x32_bf16 v[144:147], a[104:107], a[32:35], v[144:147]
s_xor_b32 s37, s37, s51
s_and_b32 s37, s37, 1
s_lshr_b32 s89, s29, 2
v_mfma_f32_16x16x32_bf16 v[148:151], a[112:115], a[32:35], v[148:151]
buffer_load_dwordx4 a[20:23], v2, s[40:43], s33 offen offset:2048 sc1
s_xor_b32 s89, s89, s37
v_mfma_f32_16x16x32_bf16 v[148:151], a[116:119], a[36:39], v[148:151]
v_fmac_f32 v187, v55, v86
s_lshl_b32 s88, s28, 6
v_mfma_f32_16x16x32_bf16 v[172:175], a[116:119], a[44:47], v[172:175]
v_fmac_f32 v163, v55, v84
v_mul_f32 v86, 0x3fb8aa3b, v87
v_mfma_f32_16x16x32_bf16 v[172:175], a[112:115], a[40:43], v[172:175]
buffer_load_dwordx4 a[24:27], v2, s[40:43], s35 offen offset:3072 sc1
s_add_u32 s94, s80, s88
v_mfma_f32_16x16x32_bf16 v[196:199], a[112:115], a[48:51], v[196:199]
v_fmac_f32 v139, v55, v82
v_mul_f32 v84, 0x3fb8aa3b, v85
v_mfma_f32_16x16x32_bf16 v[196:199], a[116:119], a[52:55], v[196:199]
v_mul_f32 v82, 0x3fb8aa3b, v83
s_add_u32 s94, s94, 0x80000
v_mfma_f32_16x16x32_bf16 v[220:223], a[116:119], a[60:63], v[220:223]
buffer_load_dwordx4 a[28:31], v2, s[40:43], s33 offen offset:3072 sc1
s_add_u32 s35, s35, 0x64000
v_mfma_f32_16x16x32_bf16 v[220:223], a[112:115], a[56:59], v[220:223]
s_add_u32 s33, s33, 0x64000
s_waitcnt lgkmcnt(0)
v_mfma_f32_16x16x32_bf16 v[224:227], a[128:131], a[56:59], v[224:227]
ds_read_b128 a[96:99], v5 offset:28672
s_mul_i32 s89, s89, 0x102000
v_mfma_f32_16x16x32_bf16 v[224:227], a[132:135], a[60:63], v[224:227]
buffer_load_dwordx4 v1, s[4:7], s44 offen offset:2048 sc1 lds
s_add_u32 s88, s88, s70
v_mfma_f32_16x16x32_bf16 v[200:203], a[132:135], a[52:55], v[200:203]
ds_read_b128 a[100:103], v5 offset:34816
v_mul_f32 v88, 0x3fb8aa3b, v89
v_mfma_f32_16x16x32_bf16 v[200:203], a[128:131], a[48:51], v[200:203]
s_add_u32 s88, s88, s89
s_add_u32 s89, s88, 0x80000
s_add_u32 s74, s71, 0x10080
v_mfma_f32_16x16x32_bf16 v[176:179], a[128:131], a[40:43], v[176:179]
s_add_u32 s72, s76, 0xc00000
s_add_u32 s73, s75, 0x800000
s_lshr_b32 s38, s28, 1
v_mfma_f32_16x16x32_bf16 v[176:179], a[132:135], a[44:47], v[176:179]
ds_read_b128 a[104:107], v5 offset:29696
s_and_b32 s39, s28, 1
v_mfma_f32_16x16x32_bf16 v[152:155], a[132:135], a[36:39], v[152:155]
s_mul_i32 s38, s38, 3072
s_lshl_b32 s39, s39, 3
s_add_u32 s38, s38, s39
v_mfma_f32_16x16x32_bf16 v[152:155], a[128:131], a[32:35], v[152:155]
s_add_u32 s91, s83, 0x280000
v_add_u32 v233, s19, v232
s_waitcnt vmcnt(18)
v_mfma_f32_16x16x32_bf16 v[140:143], a[136:139], a[64:67], v[140:143]
ds_read_b128 a[108:111], v5 offset:35840
v_and_b32 v248, 4, v0
s_waitcnt vmcnt(17)
v_mfma_f32_16x16x32_bf16 v[140:143], a[140:143], a[68:71], v[140:143]
v_lshlrev_b32 v248, 11, v248
v_bfe_u32 v235, v0, 2, 1
s_waitcnt vmcnt(15)
v_mfma_f32_16x16x32_bf16 v[164:167], a[140:143], a[76:79], v[164:167]
ds_read_b128 a[112:115], v5 offset:38912
v_xor_b32 v248, s90, v248
v_mfma_f32_16x16x32_bf16 v[164:167], a[136:139], a[72:75], v[164:167]
v_and_b32 v249, 3, v0
v_xor_b32 v235, s37, v235
s_waitcnt vmcnt(14)
v_mfma_f32_16x16x32_bf16 v[188:191], a[136:139], a[80:83], v[188:191]
v_lshl_add_u32 v248, v249, 7, v248
v_mul_u32_u24 v235, 4128, v235
s_waitcnt vmcnt(13)
v_mfma_f32_16x16x32_bf16 v[188:191], a[140:143], a[84:87], v[188:191]
buffer_load_dwordx4 v1, s[4:7], s44 offen offset:3072 sc1 lds
s_add_u32 m0, s19, 65536
s_waitcnt vmcnt(11)
v_mfma_f32_16x16x32_bf16 v[212:215], a[140:143], a[92:95], v[212:215]
s_add_u32 s44, s84, 0x1c08000
ds_read_b128 a[116:119], v5 offset:45056
v_mfma_f32_16x16x32_bf16 v[212:215], a[136:139], a[88:91], v[212:215]
v_lshrrev_b32 v249, 4, v0
v_add_lshl_u32 v235, v235, v0, 8
v_mfma_f32_16x16x32_bf16 v[216:219], a[144:147], a[88:91], v[216:219]
v_lshl_add_u32 v248, v249, 4, v248
v_add_u32 v234, s36, v8
v_mfma_f32_16x16x32_bf16 v[216:219], a[148:151], a[92:95], v[216:219]
v_cndmask_b32 v235, 2.0, v235, s[64:65]
v_mov_b32 v249, 0x3f80
v_mfma_f32_16x16x32_bf16 v[192:195], a[148:151], a[84:87], v[192:195]
v_mov_b32 v250, 1.0
v_add_u32 v252, s38, v1
v_mfma_f32_16x16x32_bf16 v[192:195], a[144:147], a[80:83], v[192:195]
v_mfma_f32_16x16x32_bf16 v[168:171], a[144:147], a[72:75], v[168:171]
v_mfma_f32_16x16x32_bf16 v[168:171], a[148:151], a[76:79], v[168:171]
v_mfma_f32_16x16x32_bf16 v[144:147], a[148:151], a[68:71], v[144:147]
v_mfma_f32_16x16x32_bf16 v[144:147], a[144:147], a[64:67], v[144:147]
s_waitcnt lgkmcnt(0)
v_mfma_f32_16x16x32_bf16 v[148:151], a[96:99], a[64:67], v[148:151]
ds_read_b128 a[128:131], v5 offset:39936
v_mfma_f32_16x16x32_bf16 v[148:151], a[100:103], a[68:71], v[148:151]
buffer_load_dwordx4 v1, s[4:7], s44 offen offset:0 sc1 lds
v_mfma_f32_16x16x32_bf16 v[172:175], a[100:103], a[76:79], v[172:175]
ds_read_b128 a[132:135], v5 offset:46080
v_mfma_f32_16x16x32_bf16 v[172:175], a[96:99], a[72:75], v[172:175]
v_mfma_f32_16x16x32_bf16 v[196:199], a[96:99], a[80:83], v[196:199]
v_mfma_f32_16x16x32_bf16 v[196:199], a[100:103], a[84:87], v[196:199]
buffer_load_dwordx4 v1, s[4:7], s44 offen offset:1024 sc1 lds
v_mfma_f32_16x16x32_bf16 v[220:223], a[100:103], a[92:95], v[220:223]
ds_read_b128 a[136:139], v5 offset:40960
v_mfma_f32_16x16x32_bf16 v[220:223], a[96:99], a[88:91], v[220:223]
v_mfma_f32_16x16x32_bf16 v[224:227], a[104:107], a[88:91], v[224:227]
ds_read_b128 a[140:143], v5 offset:47104
v_mfma_f32_16x16x32_bf16 v[224:227], a[108:111], a[92:95], v[224:227]
v_mfma_f32_16x16x32_bf16 v[200:203], a[108:111], a[84:87], v[200:203]
buffer_load_dwordx4 v1, s[4:7], s44 offen offset:2048 sc1 lds
v_mfma_f32_16x16x32_bf16 v[200:203], a[104:107], a[80:83], v[200:203]
ds_read_b128 a[144:147], v5 offset:41984
v_mfma_f32_16x16x32_bf16 v[176:179], a[104:107], a[72:75], v[176:179]
v_mfma_f32_16x16x32_bf16 v[176:179], a[108:111], a[76:79], v[176:179]
ds_read_b128 a[148:151], v5 offset:48128
v_mfma_f32_16x16x32_bf16 v[152:155], a[108:111], a[68:71], v[152:155]
v_mfma_f32_16x16x32_bf16 v[152:155], a[104:107], a[64:67], v[152:155]
buffer_load_dwordx4 v1, s[4:7], s44 offen offset:3072 sc1 lds
s_add_u32 m0, s19, 81920
s_waitcnt vmcnt(13)
v_mfma_f32_16x16x32_bf16 v[140:143], a[112:115], a[0:3], v[140:143]
s_add_u32 s44, s85, 0x1c0c000
s_waitcnt vmcnt(12)
v_mfma_f32_16x16x32_bf16 v[140:143], a[116:119], a[4:7], v[140:143]
s_waitcnt vmcnt(10)
v_mfma_f32_16x16x32_bf16 v[164:167], a[116:119], a[12:15], v[164:167]
v_mfma_f32_16x16x32_bf16 v[164:167], a[112:115], a[8:11], v[164:167]
s_waitcnt vmcnt(9)
v_mfma_f32_16x16x32_bf16 v[188:191], a[112:115], a[16:19], v[188:191]
buffer_load_dwordx4 v1, s[4:7], s44 offen offset:0 sc1 lds
s_waitcnt vmcnt(9)
v_mfma_f32_16x16x32_bf16 v[188:191], a[116:119], a[20:23], v[188:191]
s_waitcnt vmcnt(7)
v_mfma_f32_16x16x32_bf16 v[212:215], a[116:119], a[28:31], v[212:215]
v_mfma_f32_16x16x32_bf16 v[212:215], a[112:115], a[24:27], v[212:215]
s_waitcnt lgkmcnt(0)
v_mfma_f32_16x16x32_bf16 v[216:219], a[128:131], a[24:27], v[216:219]
ds_read_b128 a[96:99], v5 offset:12288
v_cvt_pk_bf16_f32 v140, v140, v141
v_mfma_f32_16x16x32_bf16 v[216:219], a[132:135], a[28:31], v[216:219]
buffer_load_dwordx4 v1, s[4:7], s44 offen offset:1024 sc1 lds
v_mfma_f32_16x16x32_bf16 v[192:195], a[132:135], a[20:23], v[192:195]
ds_read_b128 a[100:103], v5 offset:18432
v_cvt_pk_bf16_f32 v141, v142, v143
v_mfma_f32_16x16x32_bf16 v[192:195], a[128:131], a[16:19], v[192:195]
v_cvt_pk_bf16_f32 v164, v164, v165
v_cvt_pk_bf16_f32 v165, v166, v167
v_mfma_f32_16x16x32_bf16 v[168:171], a[128:131], a[8:11], v[168:171]
v_cvt_pk_bf16_f32 v188, v188, v189
v_cvt_pk_bf16_f32 v189, v190, v191
v_mfma_f32_16x16x32_bf16 v[168:171], a[132:135], a[12:15], v[168:171]
buffer_load_dwordx4 v1, s[4:7], s44 offen offset:2048 sc1 lds
v_mfma_f32_16x16x32_bf16 v[144:147], a[132:135], a[4:7], v[144:147]
ds_read_b128 a[104:107], v5 offset:24576
v_cvt_pk_bf16_f32 v212, v212, v213
v_mfma_f32_16x16x32_bf16 v[144:147], a[128:131], a[0:3], v[144:147]
v_cvt_pk_bf16_f32 v213, v214, v215
v_mfma_f32_16x16x32_bf16 v[148:151], a[136:139], a[0:3], v[148:151]
ds_read_b128 a[108:111], v5 offset:30720
v_cvt_pk_bf16_f32 v214, v216, v217
v_mfma_f32_16x16x32_bf16 v[148:151], a[140:143], a[4:7], v[148:151]
v_cvt_pk_bf16_f32 v215, v218, v219
v_mfma_f32_16x16x32_bf16 v[172:175], a[140:143], a[12:15], v[172:175]
buffer_load_dwordx4 v1, s[4:7], s44 offen offset:3072 sc1 lds
s_add_u32 m0, s19, 147456
v_mfma_f32_16x16x32_bf16 v[172:175], a[136:139], a[8:11], v[172:175]
s_add_u32 s44, s87, 0x1c1c000
ds_read_b128 a[112:115], v5 offset:36864
v_mfma_f32_16x16x32_bf16 v[196:199], a[136:139], a[16:19], v[196:199]
v_cvt_pk_bf16_f32 v166, v168, v169
v_cvt_pk_bf16_f32 v167, v170, v171
v_mfma_f32_16x16x32_bf16 v[196:199], a[140:143], a[20:23], v[196:199]
ds_read_b128 a[116:119], v5 offset:43008
v_cvt_pk_bf16_f32 v190, v192, v193
v_mfma_f32_16x16x32_bf16 v[220:223], a[140:143], a[28:31], v[220:223]
v_cvt_pk_bf16_f32 v142, v144, v145
v_cvt_pk_bf16_f32 v143, v146, v147
v_mfma_f32_16x16x32_bf16 v[220:223], a[136:139], a[24:27], v[220:223]
buffer_load_dwordx4 v1, s[4:7], s44 offen offset:0 sc1 lds
v_mfma_f32_16x16x32_bf16 v[224:227], a[144:147], a[24:27], v[224:227]
v_mfma_f32_16x16x32_bf16 v[92:95], a[240:243], v[140:143], 0
v_mfma_f32_16x16x32_bf16 v[224:227], a[148:151], a[28:31], v[224:227]
v_mfma_f32_16x16x32_bf16 v[96:99], a[244:247], v[140:143], 0
v_mfma_f32_16x16x32_bf16 v[200:203], a[148:151], a[20:23], v[200:203]
v_mfma_f32_16x16x32_bf16 v[100:103], a[240:243], v[164:167], 0
v_mfma_f32_16x16x32_bf16 v[200:203], a[144:147], a[16:19], v[200:203]
v_mfma_f32_16x16x32_bf16 v[104:107], a[244:247], v[164:167], 0
v_mfma_f32_16x16x32_bf16 v[176:179], a[144:147], a[8:11], v[176:179]
buffer_load_dwordx4 v1, s[4:7], s44 offen offset:1024 sc1 lds
v_mfma_f32_16x16x32_bf16 v[176:179], a[148:151], a[12:15], v[176:179]
v_max3_f32 v236, v92, v93, v94
v_max3_f32 v237, -v92, -v93, -v94
v_mfma_f32_16x16x32_bf16 v[152:155], a[148:151], a[4:7], v[152:155]
v_max3_f32 v236, v236, v95, v96
v_max3_f32 v237, v237, -v95, -v96
v_mfma_f32_16x16x32_bf16 v[152:155], a[144:147], a[0:3], v[152:155]
v_max3_f32 v236, v236, v97, v98
s_waitcnt lgkmcnt(0)
v_mfma_f32_16x16x32_bf16 v[132:135], a[96:99], a[32:35], v[132:135]
ds_read_b128 a[128:131], v5 offset:13312
v_max3_f32 v237, v237, -v97, -v98
v_mfma_f32_16x16x32_bf16 v[132:135], a[100:103], a[36:39], v[132:135]
buffer_load_dwordx4 v1, s[4:7], s44 offen offset:2048 sc1 lds
v_mfma_f32_16x16x32_bf16 v[156:159], a[100:103], a[44:47], v[156:159]
ds_read_b128 a[132:135], v5 offset:19456
v_max_f32 v236, v236, v99
v_mfma_f32_16x16x32_bf16 v[156:159], a[96:99], a[40:43], v[156:159]
v_max_f32_e64 v237, v237, -v99
v_max3_f32 v238, v100, v101, v102
v_mfma_f32_16x16x32_bf16 v[180:183], a[96:99], a[48:51], v[180:183]
v_permlane32_swap_b32 v236, v237
v_mfma_f32_16x16x32_bf16 v[180:183], a[100:103], a[52:55], v[180:183]
buffer_load_dwordx4 v1, s[4:7], s44 offen offset:3072 sc1 lds
s_add_u32 m0, s19, 98304
v_mfma_f32_16x16x32_bf16 v[204:207], a[100:103], a[60:63], v[204:207]
s_add_u32 s44, s84, 0x1c10000
ds_read_b128 a[136:139], v5 offset:25600
v_mfma_f32_16x16x32_bf16 v[204:207], a[96:99], a[56:59], v[204:207]
v_max_f32 v236, v236, v237
v_mov_b32 v244, v236
v_mfma_f32_16x16x32_bf16 v[204:207], a[104:107], a[88:91], v[204:207]
ds_read_b128 a[140:143], v5 offset:31744
v_max3_f32 v239, -v100, -v101, -v102
v_mfma_f32_16x16x32_bf16 v[204:207], a[108:111], a[92:95], v[204:207]
v_permlane16_swap_b32 v236, v244
v_mfma_f32_16x16x32_bf16 v[180:183], a[108:111], a[84:87], v[180:183]
L_stub7:
s_cbranch_execz L_wret2
buffer_load_dwordx4 v1, s[4:7], s44 offen offset:0 sc1 lds
v_mfma_f32_16x16x32_bf16 v[180:183], a[104:107], a[80:83], v[180:183]
ds_read_b128 a[144:147], v5 offset:37888
v_max_f32 v236, v236, v244
v_mfma_f32_16x16x32_bf16 v[156:159], a[104:107], a[72:75], v[156:159]
v_mov_b32 v244, v236
v_max3_f32 v238, v238, v103, v104
v_mfma_f32_16x16x32_bf16 v[156:159], a[108:111], a[76:79], v[156:159]
ds_read_b128 a[148:151], v5 offset:44032
v_max3_f32 v239, v239, -v103, -v104
v_mfma_f32_16x16x32_bf16 v[132:135], a[108:111], a[68:71], v[132:135]
v_permlane32_swap_b32 v236, v244
v_mfma_f32_16x16x32_bf16 v[132:135], a[104:107], a[64:67], v[132:135]
buffer_load_dwordx4 v1, s[4:7], s44 offen offset:1024 sc1 lds
v_mfma_f32_16x16x32_bf16 v[132:135], a[112:115], a[0:3], v[132:135]
v_mul_f32_e64 v236, -v236, v82
v_mul_f32_e64 v237, -v244, v82
v_mfma_f32_16x16x32_bf16 v[132:135], a[116:119], a[4:7], v[132:135]
v_max3_f32 v238, v238, v105, v106
v_max3_f32 v239, v239, -v105, -v106
v_mfma_f32_16x16x32_bf16 v[156:159], a[116:119], a[12:15], v[156:159]
v_max_f32 v238, v238, v107
v_max_f32_e64 v239, v239, -v107
v_mfma_f32_16x16x32_bf16 v[156:159], a[112:115], a[8:11], v[156:159]
s_nop 0
v_permlane32_swap_b32 v238, v239
v_mfma_f32_16x16x32_bf16 v[180:183], a[112:115], a[16:19], v[180:183]
buffer_load_dwordx4 v1, s[4:7], s44 offen offset:2048 sc1 lds
v_mfma_f32_16x16x32_bf16 v[180:183], a[116:119], a[20:23], v[180:183]
v_max_f32 v238, v238, v239
v_mov_b32 v245, v238
v_mfma_f32_16x16x32_bf16 v[204:207], a[116:119], a[28:31], v[204:207]
s_nop 0
v_permlane16_swap_b32 v238, v245
v_mfma_f32_16x16x32_bf16 v[204:207], a[112:115], a[24:27], v[204:207]
s_waitcnt lgkmcnt(0)
s_barrier
v_mfma_f32_16x16x32_bf16 v[208:211], a[128:131], a[56:59], v[208:211]
v_max_f32 v238, v238, v245
v_mov_b32 v245, v238
v_mfma_f32_16x16x32_bf16 v[208:211], a[132:135], a[60:63], v[208:211]
buffer_load_dwordx4 v1, s[4:7], s44 offen offset:3072 sc1 lds
s_add_u32 m0, s19, 114688
v_mfma_f32_16x16x32_bf16 v[184:187], a[132:135], a[52:55], v[184:187]
s_add_u32 s44, s85, 0x1c14000
v_cvt_pk_bf16_f32 v191, v194, v195
v_mfma_f32_16x16x32_bf16 v[184:187], a[128:131], a[48:51], v[184:187]
v_permlane32_swap_b32 v238, v245
v_mfma_f32_16x16x32_bf16 v[160:163], a[128:131], a[40:43], v[160:163]
v_mul_f32_e64 v238, -v238, v84
v_mul_f32_e64 v239, -v245, v84
v_mfma_f32_16x16x32_bf16 v[160:163], a[132:135], a[44:47], v[160:163]
buffer_load_dwordx4 v1, s[4:7], s44 offen offset:0 sc1 lds
v_mfma_f32_16x16x32_bf16 v[136:139], a[132:135], a[36:39], v[136:139]
v_mfma_f32_16x16x32_bf16 v[108:111], a[240:243], v[188:191], 0
v_mfma_f32_16x16x32_bf16 v[136:139], a[128:131], a[32:35], v[136:139]
v_mfma_f32_16x16x32_bf16 v[112:115], a[244:247], v[188:191], 0
v_mfma_f32_16x16x32_bf16 v[136:139], a[136:139], a[64:67], v[136:139]
v_mfma_f32_16x16x32_bf16 v[116:119], a[240:243], v[212:215], 0
v_mfma_f32_16x16x32_bf16 v[136:139], a[140:143], a[68:71], v[136:139]
v_mfma_f32_16x16x32_bf16 v[120:123], a[244:247], v[212:215], 0
v_mfma_f32_16x16x32_bf16 v[160:163], a[140:143], a[76:79], v[160:163]
buffer_load_dwordx4 v1, s[4:7], s44 offen offset:1024 sc1 lds
v_mfma_f32_16x16x32_bf16 v[160:163], a[136:139], a[72:75], v[160:163]
v_max3_f32 v240, v108, v109, v110
v_max3_f32 v241, -v108, -v109, -v110
v_mfma_f32_16x16x32_bf16 v[184:187], a[136:139], a[80:83], v[184:187]
v_max3_f32 v240, v240, v111, v112
v_max3_f32 v241, v241, -v111, -v112
v_mfma_f32_16x16x32_bf16 v[184:187], a[140:143], a[84:87], v[184:187]
v_max3_f32 v240, v240, v113, v114
v_max3_f32 v241, v241, -v113, -v114
v_mfma_f32_16x16x32_bf16 v[208:211], a[140:143], a[92:95], v[208:211]
v_max_f32 v240, v240, v115
v_max_f32_e64 v241, v241, -v115
v_mfma_f32_16x16x32_bf16 v[208:211], a[136:139], a[88:91], v[208:211]
buffer_load_dwordx4 v1, s[4:7], s44 offen offset:2048 sc1 lds
v_mfma_f32_16x16x32_bf16 v[208:211], a[144:147], a[24:27], v[208:211]
v_permlane32_swap_b32 v240, v241
v_mfma_f32_16x16x32_bf16 v[208:211], a[148:151], a[28:31], v[208:211]
v_max_f32 v240, v240, v241
v_mov_b32 v246, v240
v_mfma_f32_16x16x32_bf16 v[184:187], a[148:151], a[20:23], v[184:187]
s_nop 0
v_permlane16_swap_b32 v240, v246
v_mfma_f32_16x16x32_bf16 v[184:187], a[144:147], a[16:19], v[184:187]
v_max_f32 v240, v240, v246
v_mov_b32 v246, v240
v_mfma_f32_16x16x32_bf16 v[160:163], a[144:147], a[8:11], v[160:163]
buffer_load_dwordx4 v1, s[4:7], s44 offen offset:3072 sc1 lds
v_mfma_f32_16x16x32_bf16 v[160:163], a[148:151], a[12:15], v[160:163]
v_permlane32_swap_b32 v240, v246
v_mfma_f32_16x16x32_bf16 v[136:139], a[148:151], a[4:7], v[136:139]
v_mul_f32_e64 v240, -v240, v86
v_mul_f32_e64 v241, -v246, v86
v_mfma_f32_16x16x32_bf16 v[136:139], a[144:147], a[0:3], v[136:139]
v_max3_f32 v242, v116, v117, v118
v_max3_f32 v243, -v116, -v117, -v118
v_pk_mul_f32 v[148:149], v[148:149], v[82:83] op_sel:[0,1] op_sel_hi:[1,1]
v_pk_mul_f32 v[150:151], v[150:151], v[82:83] op_sel:[0,1] op_sel_hi:[1,1]
v_cvt_pk_bf16_f32 v148, v148, v149
v_cvt_pk_bf16_f32 v149, v150, v151
ds_write_b64 v232, v[148:149] offset:0
v_pk_mul_f32 v[152:153], v[152:153], v[82:83] op_sel:[0,1] op_sel_hi:[1,1]
v_pk_mul_f32 v[154:155], v[154:155], v[82:83] op_sel:[0,1] op_sel_hi:[1,1]
v_cvt_pk_bf16_f32 v150, v152, v153
v_cvt_pk_bf16_f32 v151, v154, v155
v_pk_mul_f32 v[172:173], v[172:173], v[84:85] op_sel:[0,1] op_sel_hi:[1,1]
v_pk_mul_f32 v[174:175], v[174:175], v[84:85] op_sel:[0,1] op_sel_hi:[1,1]
v_cvt_pk_bf16_f32 v172, v172, v173
buffer_store_dwordx4 a[248:251], v254, s[4:7], s97 offen offset:0 sc1
v_cvt_pk_bf16_f32 v173, v174, v175
ds_write_b64 v232, v[150:151] offset:512
v_pk_mul_f32 v[176:177], v[176:177], v[84:85] op_sel:[0,1] op_sel_hi:[1,1]
v_pk_mul_f32 v[178:179], v[178:179], v[84:85] op_sel:[0,1] op_sel_hi:[1,1]
v_cvt_pk_bf16_f32 v174, v176, v177
v_cvt_pk_bf16_f32 v175, v178, v179
v_pk_mul_f32 v[196:197], v[196:197], v[86:87] op_sel:[0,1] op_sel_hi:[1,1]
v_pk_mul_f32 v[198:199], v[198:199], v[86:87] op_sel:[0,1] op_sel_hi:[1,1]
v_cvt_pk_bf16_f32 v196, v196, v197
v_cvt_pk_bf16_f32 v197, v198, v199
v_pk_mul_f32 v[200:201], v[200:201], v[86:87] op_sel:[0,1] op_sel_hi:[1,1]
v_pk_mul_f32 v[202:203], v[202:203], v[86:87] op_sel:[0,1] op_sel_hi:[1,1]
v_cvt_pk_bf16_f32 v198, v200, v201
v_cvt_pk_bf16_f32 v199, v202, v203
ds_write_b64 v232, v[172:173] offset:1024
v_pk_mul_f32 v[220:221], v[220:221], v[88:89] op_sel:[0,1] op_sel_hi:[1,1]
v_pk_mul_f32 v[222:223], v[222:223], v[88:89] op_sel:[0,1] op_sel_hi:[1,1]
v_cvt_pk_bf16_f32 v220, v220, v221
v_cvt_pk_bf16_f32 v221, v222, v223
v_pk_fma_f32 v[48:49], v[92:93], v[82:83], v[236:237] op_sel:[0,0,0] op_sel_hi:[1,0,0]
v_pk_fma_f32 v[50:51], v[94:95], v[82:83], v[236:237] op_sel:[0,0,0] op_sel_hi:[1,0,0]
v_pk_fma_f32 v[52:53], v[96:97], v[82:83], v[236:237] op_sel:[0,0,0] op_sel_hi:[1,0,0]
v_pk_fma_f32 v[54:55], v[98:99], v[82:83], v[236:237] op_sel:[0,0,0] op_sel_hi:[1,0,0]
v_exp_f32 v48, v48
v_exp_f32 v49, v49
ds_write_b64 v232, v[174:175] offset:1536
buffer_store_dwordx4 a[248:251], v1, s[4:7], s96 offen offset:0 sc1
v_exp_f32 v50, v50
v_exp_f32 v51, v51
v_exp_f32 v52, v52
v_exp_f32 v53, v53
ds_write_b64 v232, v[196:197] offset:2048
v_exp_f32 v54, v54
v_exp_f32 v55, v55
v_cvt_pk_bf16_f32 v140, v48, v49
v_cvt_pk_bf16_f32 v141, v50, v51
v_cvt_pk_bf16_f32 v142, v52, v53
v_cvt_pk_bf16_f32 v143, v54, v55
v_pk_mul_f32 v[224:225], v[224:225], v[88:89] op_sel:[0,1] op_sel_hi:[1,1]
v_pk_mul_f32 v[226:227], v[226:227], v[88:89] op_sel:[0,1] op_sel_hi:[1,1]
v_cvt_pk_bf16_f32 v222, v224, v225
v_mfma_f32_16x16x32_bf16 v[148:151], v[16:19], v[140:143], 0
ds_write_b64 v232, v[198:199] offset:2560
v_cvt_pk_bf16_f32 v223, v226, v227
s_add_u32 m0, s19, 131072
v_pk_fma_f32 v[92:93], v[92:93], v[82:83], v[236:237] op_sel:[0,0,1] op_sel_hi:[1,0,1] neg_lo:[1,0,0] neg_hi:[1,0,0]
v_pk_fma_f32 v[94:95], v[94:95], v[82:83], v[236:237] op_sel:[0,0,1] op_sel_hi:[1,0,1] neg_lo:[1,0,0] neg_hi:[1,0,0]
v_pk_fma_f32 v[96:97], v[96:97], v[82:83], v[236:237] op_sel:[0,0,1] op_sel_hi:[1,0,1] neg_lo:[1,0,0] neg_hi:[1,0,0]
s_nop 1
v_rcp_f32 v148, v148
buffer_store_dwordx4 a[248:251], v3, s[4:7], s91 offen offset:0 sc1
v_pk_mul_f32 v[48:49], v[48:49], v[148:149] op_sel:[0,0] op_sel_hi:[1,0]
ds_write_b64 v232, v[220:221] offset:3072
v_pk_mul_f32 v[50:51], v[50:51], v[148:149] op_sel:[0,0] op_sel_hi:[1,0]
v_cvt_pk_bf16_f32 v140, v48, v49
v_cvt_pk_bf16_f32 v141, v50, v51
v_pk_fma_f32 v[98:99], v[98:99], v[82:83], v[236:237] op_sel:[0,0,1] op_sel_hi:[1,0,1] neg_lo:[1,0,0] neg_hi:[1,0,0]
v_exp_f32 v92, v92
v_exp_f32 v93, v93
buffer_store_dwordx4 a[248:251], v3, s[4:7], s91 offen offset:1024 sc1
ds_write_b64 v232, v[222:223] offset:3584
v_exp_f32 v94, v94
v_exp_f32 v95, v95
v_exp_f32 v96, v96
v_exp_f32 v97, v97
v_exp_f32 v98, v98
v_exp_f32 v99, v99
ds_write_b64 v233, v[140:141] offset:16384
s_add_u32 s44, s86, 0x1c18000
v_cvt_pk_bf16_f32 v144, v92, v93
v_cvt_pk_bf16_f32 v145, v94, v95
v_cvt_pk_bf16_f32 v146, v96, v97
v_cvt_pk_bf16_f32 v147, v98, v99
buffer_load_dwordx4 v1, s[4:7], s44 offen offset:0 sc1 lds
v_pk_mul_f32 v[52:53], v[52:53], v[148:149] op_sel:[0,0] op_sel_hi:[1,0]
v_cvt_pk_bf16_f32 v142, v52, v53
v_pk_mul_f32 v[54:55], v[54:55], v[148:149] op_sel:[0,0] op_sel_hi:[1,0]
v_cvt_pk_bf16_f32 v143, v54, v55
v_mfma_f32_16x16x32_bf16 v[152:155], v[16:19], v[144:147], 0
ds_write_b64 v233, v[142:143] offset:16896
v_max3_f32 v242, v242, v119, v120
v_max3_f32 v243, v243, -v119, -v120
v_pk_fma_f32 v[56:57], v[100:101], v[84:85], v[238:239] op_sel:[0,0,0] op_sel_hi:[1,0,0]
v_pk_fma_f32 v[58:59], v[102:103], v[84:85], v[238:239] op_sel:[0,0,0] op_sel_hi:[1,0,0]
v_pk_fma_f32 v[60:61], v[104:105], v[84:85], v[238:239] op_sel:[0,0,0] op_sel_hi:[1,0,0]
s_nop 1
v_rcp_f32 v152, v152
v_pk_fma_f32 v[62:63], v[106:107], v[84:85], v[238:239] op_sel:[0,0,0] op_sel_hi:[1,0,0]
v_pk_mul_f32 v[92:93], v[92:93], v[152:153] op_sel:[0,0] op_sel_hi:[1,0]
v_pk_mul_f32 v[94:95], v[94:95], v[152:153] op_sel:[0,0] op_sel_hi:[1,0]
v_cvt_pk_bf16_f32 v144, v92, v93
v_cvt_pk_bf16_f32 v145, v94, v95
ds_write_b64 v233, v[144:145] offset:17408
v_exp_f32 v56, v56
v_exp_f32 v57, v57
v_exp_f32 v58, v58
v_exp_f32 v59, v59
v_exp_f32 v60, v60
v_exp_f32 v61, v61
v_exp_f32 v62, v62
v_exp_f32 v63, v63
buffer_load_dwordx4 v1, s[4:7], s44 offen offset:1024 sc1 lds
v_cvt_pk_bf16_f32 v164, v56, v57
v_cvt_pk_bf16_f32 v165, v58, v59
v_cvt_pk_bf16_f32 v166, v60, v61
v_cvt_pk_bf16_f32 v167, v62, v63
v_pk_mul_f32 v[96:97], v[96:97], v[152:153] op_sel:[0,0] op_sel_hi:[1,0]
v_pk_mul_f32 v[98:99], v[98:99], v[152:153] op_sel:[0,0] op_sel_hi:[1,0]
v_cvt_pk_bf16_f32 v146, v96, v97
v_mfma_f32_16x16x32_bf16 v[172:175], v[16:19], v[164:167], 0
v_cvt_pk_bf16_f32 v147, v98, v99
ds_write_b64 v233, v[146:147] offset:17920
v_max3_f32 v242, v242, v121, v122
v_pk_fma_f32 v[100:101], v[100:101], v[84:85], v[238:239] op_sel:[0,0,1] op_sel_hi:[1,0,1] neg_lo:[1,0,0] neg_hi:[1,0,0]
v_pk_fma_f32 v[102:103], v[102:103], v[84:85], v[238:239] op_sel:[0,0,1] op_sel_hi:[1,0,1] neg_lo:[1,0,0] neg_hi:[1,0,0]
v_pk_fma_f32 v[104:105], v[104:105], v[84:85], v[238:239] op_sel:[0,0,1] op_sel_hi:[1,0,1] neg_lo:[1,0,0] neg_hi:[1,0,0]
s_nop 1
v_rcp_f32 v172, v172
v_pk_fma_f32 v[106:107], v[106:107], v[84:85], v[238:239] op_sel:[0,0,1] op_sel_hi:[1,0,1] neg_lo:[1,0,0] neg_hi:[1,0,0]
v_pk_mul_f32 v[56:57], v[56:57], v[172:173] op_sel:[0,0] op_sel_hi:[1,0]
v_pk_mul_f32 v[58:59], v[58:59], v[172:173] op_sel:[0,0] op_sel_hi:[1,0]
v_cvt_pk_bf16_f32 v164, v56, v57
v_cvt_pk_bf16_f32 v165, v58, v59
v_exp_f32 v100, v100
ds_write_b64 v233, v[164:165] offset:18432
v_exp_f32 v101, v101
v_exp_f32 v102, v102
v_exp_f32 v103, v103
v_exp_f32 v104, v104
v_exp_f32 v105, v105
v_exp_f32 v106, v106
v_exp_f32 v107, v107
buffer_load_dwordx4 v1, s[4:7], s44 offen offset:2048 sc1 lds
v_cvt_pk_bf16_f32 v168, v100, v101
v_cvt_pk_bf16_f32 v169, v102, v103
v_cvt_pk_bf16_f32 v170, v104, v105
v_cvt_pk_bf16_f32 v171, v106, v107
v_pk_mul_f32 v[60:61], v[60:61], v[172:173] op_sel:[0,0] op_sel_hi:[1,0]
v_pk_mul_f32 v[62:63], v[62:63], v[172:173] op_sel:[0,0] op_sel_hi:[1,0]
v_cvt_pk_bf16_f32 v166, v60, v61
v_mfma_f32_16x16x32_bf16 v[176:179], v[16:19], v[168:171], 0
v_cvt_pk_bf16_f32 v167, v62, v63
ds_write_b64 v233, v[166:167] offset:18944
v_max3_f32 v243, v243, -v121, -v122
v_pk_fma_f32 v[64:65], v[108:109], v[86:87], v[240:241] op_sel:[0,0,0] op_sel_hi:[1,0,0]
v_pk_fma_f32 v[66:67], v[110:111], v[86:87], v[240:241] op_sel:[0,0,0] op_sel_hi:[1,0,0]
v_pk_fma_f32 v[68:69], v[112:113], v[86:87], v[240:241] op_sel:[0,0,0] op_sel_hi:[1,0,0]
s_nop 1
v_rcp_f32 v176, v176
v_pk_fma_f32 v[70:71], v[114:115], v[86:87], v[240:241] op_sel:[0,0,0] op_sel_hi:[1,0,0]
v_pk_mul_f32 v[100:101], v[100:101], v[176:177] op_sel:[0,0] op_sel_hi:[1,0]
v_pk_mul_f32 v[102:103], v[102:103], v[176:177] op_sel:[0,0] op_sel_hi:[1,0]
v_cvt_pk_bf16_f32 v168, v100, v101
v_cvt_pk_bf16_f32 v169, v102, v103
v_exp_f32 v64, v64
ds_write_b64 v233, v[168:169] offset:19456
buffer_load_dwordx4 v1, s[4:7], s44 offen offset:3072 sc1 lds
v_exp_f32 v65, v65
v_exp_f32 v66, v66
v_exp_f32 v67, v67
v_exp_f32 v68, v68
v_exp_f32 v69, v69
v_exp_f32 v70, v70
v_exp_f32 v71, v71
v_cvt_pk_bf16_f32 v188, v64, v65
v_cvt_pk_bf16_f32 v189, v66, v67
v_cvt_pk_bf16_f32 v190, v68, v69
v_cvt_pk_bf16_f32 v191, v70, v71
v_pk_mul_f32 v[104:105], v[104:105], v[176:177] op_sel:[0,0] op_sel_hi:[1,0]
v_pk_mul_f32 v[106:107], v[106:107], v[176:177] op_sel:[0,0] op_sel_hi:[1,0]
v_cvt_pk_bf16_f32 v170, v104, v105
v_mfma_f32_16x16x32_bf16 v[196:199], v[16:19], v[188:191], 0
v_cvt_pk_bf16_f32 v171, v106, v107
ds_write_b64 v233, v[170:171] offset:19968
buffer_store_dwordx4 a[248:251], v2, s[4:7], s72 offen offset:0 sc1
s_nop 4
v_rcp_f32 v196, v196
v_pk_fma_f32 v[108:109], v[108:109], v[86:87], v[240:241] op_sel:[0,0,1] op_sel_hi:[1,0,1] neg_lo:[1,0,0] neg_hi:[1,0,0]
v_pk_mul_f32 v[64:65], v[64:65], v[196:197] op_sel:[0,0] op_sel_hi:[1,0]
v_pk_mul_f32 v[66:67], v[66:67], v[196:197] op_sel:[0,0] op_sel_hi:[1,0]
v_cvt_pk_bf16_f32 v188, v64, v65
v_cvt_pk_bf16_f32 v189, v66, v67
v_pk_fma_f32 v[110:111], v[110:111], v[86:87], v[240:241] op_sel:[0,0,1] op_sel_hi:[1,0,1] neg_lo:[1,0,0] neg_hi:[1,0,0]
ds_write_b64 v233, v[188:189] offset:20480
v_pk_fma_f32 v[112:113], v[112:113], v[86:87], v[240:241] op_sel:[0,0,1] op_sel_hi:[1,0,1] neg_lo:[1,0,0] neg_hi:[1,0,0]
v_pk_fma_f32 v[114:115], v[114:115], v[86:87], v[240:241] op_sel:[0,0,1] op_sel_hi:[1,0,1] neg_lo:[1,0,0] neg_hi:[1,0,0]
v_exp_f32 v108, v108
v_exp_f32 v109, v109
v_exp_f32 v110, v110
v_exp_f32 v111, v111
v_exp_f32 v112, v112
v_exp_f32 v113, v113
v_exp_f32 v114, v114
v_exp_f32 v115, v115
v_max_f32 v242, v242, v123
v_max_f32_e64 v243, v243, -v123
v_cvt_pk_bf16_f32 v192, v108, v109
v_cvt_pk_bf16_f32 v193, v110, v111
v_cvt_pk_bf16_f32 v194, v112, v113
v_cvt_pk_bf16_f32 v195, v114, v115
v_pk_mul_f32 v[68:69], v[68:69], v[196:197] op_sel:[0,0] op_sel_hi:[1,0]
v_pk_mul_f32 v[70:71], v[70:71], v[196:197] op_sel:[0,0] op_sel_hi:[1,0]
v_permlane32_swap_b32 v242, v243
v_mfma_f32_16x16x32_bf16 v[200:203], v[16:19], v[192:195], 0
v_cvt_pk_bf16_f32 v190, v68, v69
v_cvt_pk_bf16_f32 v191, v70, v71
ds_write_b64 v233, v[190:191] offset:20992
v_max_f32 v242, v242, v243
v_mov_b32 v247, v242
buffer_store_dwordx4 a[248:251], v2, s[4:7], s72 offen offset:1024 sc1
s_nop 0
v_permlane16_swap_b32 v242, v247
v_rcp_f32 v200, v200
v_max_f32 v242, v242, v247
v_mov_b32 v247, v242
v_pk_mul_f32 v[108:109], v[108:109], v[200:201] op_sel:[0,0] op_sel_hi:[1,0]
v_pk_mul_f32 v[110:111], v[110:111], v[200:201] op_sel:[0,0] op_sel_hi:[1,0]
v_cvt_pk_bf16_f32 v192, v108, v109
v_cvt_pk_bf16_f32 v193, v110, v111
v_permlane32_swap_b32 v242, v247
ds_write_b64 v233, v[192:193] offset:21504
v_mul_f32_e64 v242, -v242, v88
v_mul_f32_e64 v243, -v247, v88
v_pk_fma_f32 v[124:125], v[116:117], v[88:89], v[242:243] op_sel:[0,0,0] op_sel_hi:[1,0,0]
v_pk_fma_f32 v[126:127], v[118:119], v[88:89], v[242:243] op_sel:[0,0,0] op_sel_hi:[1,0,0]
v_pk_fma_f32 v[128:129], v[120:121], v[88:89], v[242:243] op_sel:[0,0,0] op_sel_hi:[1,0,0]
v_pk_fma_f32 v[130:131], v[122:123], v[88:89], v[242:243] op_sel:[0,0,0] op_sel_hi:[1,0,0]
v_exp_f32 v124, v124
v_exp_f32 v125, v125
v_exp_f32 v126, v126
v_exp_f32 v127, v127
v_exp_f32 v128, v128
v_exp_f32 v129, v129
v_exp_f32 v130, v130
v_exp_f32 v131, v131
v_cvt_pk_bf16_f32 v212, v124, v125
v_cvt_pk_bf16_f32 v213, v126, v127
v_cvt_pk_bf16_f32 v214, v128, v129
v_cvt_pk_bf16_f32 v215, v130, v131
v_pk_mul_f32 v[112:113], v[112:113], v[200:201] op_sel:[0,0] op_sel_hi:[1,0]
v_pk_mul_f32 v[114:115], v[114:115], v[200:201] op_sel:[0,0] op_sel_hi:[1,0]
v_cvt_pk_bf16_f32 v194, v112, v113
v_mfma_f32_16x16x32_bf16 v[220:223], v[16:19], v[212:215], 0
v_cvt_pk_bf16_f32 v195, v114, v115
ds_write_b64 v233, v[194:195] offset:22016
buffer_store_dwordx4 a[248:251], v2, s[4:7], s72 offen offset:2048 sc1
s_nop 4
v_rcp_f32 v220, v220
v_pk_fma_f32 v[116:117], v[116:117], v[88:89], v[242:243] op_sel:[0,0,1] op_sel_hi:[1,0,1] neg_lo:[1,0,0] neg_hi:[1,0,0]
v_pk_mul_f32 v[124:125], v[124:125], v[220:221] op_sel:[0,0] op_sel_hi:[1,0]
v_pk_mul_f32 v[126:127], v[126:127], v[220:221] op_sel:[0,0] op_sel_hi:[1,0]
v_cvt_pk_bf16_f32 v212, v124, v125
v_cvt_pk_bf16_f32 v213, v126, v127
v_pk_fma_f32 v[118:119], v[118:119], v[88:89], v[242:243] op_sel:[0,0,1] op_sel_hi:[1,0,1] neg_lo:[1,0,0] neg_hi:[1,0,0]
ds_write_b64 v233, v[212:213] offset:22528
v_pk_fma_f32 v[120:121], v[120:121], v[88:89], v[242:243] op_sel:[0,0,1] op_sel_hi:[1,0,1] neg_lo:[1,0,0] neg_hi:[1,0,0]
v_pk_fma_f32 v[122:123], v[122:123], v[88:89], v[242:243] op_sel:[0,0,1] op_sel_hi:[1,0,1] neg_lo:[1,0,0] neg_hi:[1,0,0]
v_exp_f32 v116, v116
v_exp_f32 v117, v117
v_exp_f32 v118, v118
v_exp_f32 v119, v119
v_exp_f32 v120, v120
v_exp_f32 v121, v121
v_exp_f32 v122, v122
v_exp_f32 v123, v123
v_cvt_pk_bf16_f32 v216, v116, v117
v_cvt_pk_bf16_f32 v217, v118, v119
v_cvt_pk_bf16_f32 v218, v120, v121
v_cvt_pk_bf16_f32 v219, v122, v123
v_pk_mul_f32 v[128:129], v[128:129], v[220:221] op_sel:[0,0] op_sel_hi:[1,0]
v_pk_mul_f32 v[130:131], v[130:131], v[220:221] op_sel:[0,0] op_sel_hi:[1,0]
v_cvt_pk_bf16_f32 v214, v128, v129
v_mfma_f32_16x16x32_bf16 v[224:227], v[16:19], v[216:219], 0
v_cvt_pk_bf16_f32 v215, v130, v131
ds_write_b64 v233, v[214:215] offset:23040
buffer_store_dwordx4 a[248:251], v2, s[4:7], s72 offen offset:3072 sc1
s_nop 4
v_rcp_f32 v224, v224
s_nop 0
v_pk_mul_f32 v[116:117], v[116:117], v[224:225] op_sel:[0,0] op_sel_hi:[1,0]
v_pk_mul_f32 v[118:119], v[118:119], v[224:225] op_sel:[0,0] op_sel_hi:[1,0]
v_cvt_pk_bf16_f32 v216, v116, v117
v_cvt_pk_bf16_f32 v217, v118, v119
v_pk_mul_f32 v[120:121], v[120:121], v[224:225] op_sel:[0,0] op_sel_hi:[1,0]
ds_write_b64 v233, v[216:217] offset:23552
v_pk_mul_f32 v[122:123], v[122:123], v[224:225] op_sel:[0,0] op_sel_hi:[1,0]
v_cvt_pk_bf16_f32 v218, v120, v121
v_cvt_pk_bf16_f32 v219, v122, v123
ds_write_b64 v233, v[218:219] offset:24064
s_waitcnt vmcnt(8)
s_waitcnt lgkmcnt(0)
s_barrier
ds_read_b64_tr_b16 a[0:1], v234 offset:16384
ds_read_b64_tr_b16 a[2:3], v234 offset:18432
ds_read_b64_tr_b16 a[12:13], v234 offset:20480
ds_read_b64_tr_b16 a[14:15], v234 offset:22528
ds_read_b64_tr_b16 a[24:25], v234 offset:24576
ds_read_b64_tr_b16 a[26:27], v234 offset:26624
ds_read_b64_tr_b16 a[4:5], v8 offset:0
ds_read_b64_tr_b16 a[6:7], v8 offset:1024
ds_read_b64_tr_b16 a[8:9], v8 offset:512
ds_read_b64_tr_b16 a[10:11], v8 offset:1536
ds_read_b64_tr_b16 a[36:37], v234 offset:28672
ds_read_b64_tr_b16 a[38:39], v234 offset:30720
ds_read_b64_tr_b16 a[16:17], v8 offset:2048
ds_read_b64_tr_b16 a[18:19], v8 offset:3072
ds_read_b64_tr_b16 a[20:21], v8 offset:2560
ds_read_b64_tr_b16 a[22:23], v8 offset:3584
ds_read_b64_tr_b16 a[48:49], v234 offset:32768
ds_read_b64_tr_b16 a[50:51], v234 offset:34816
ds_read_b64_tr_b16 a[28:29], v8 offset:4096
ds_read_b64_tr_b16 a[30:31], v8 offset:5120
ds_read_b64_tr_b16 a[32:33], v8 offset:4608
ds_read_b64_tr_b16 a[34:35], v8 offset:5632
ds_read_b64_tr_b16 a[60:61], v234 offset:36864
ds_read_b64_tr_b16 a[62:63], v234 offset:38912
s_waitcnt lgkmcnt(14)
v_mfma_f32_16x16x32_bf16 v[100:103], a[0:3], v[16:19], 0
ds_read_b64_tr_b16 a[40:41], v8 offset:6144
ds_read_b64_tr_b16 a[42:43], v8 offset:7168
ds_read_b64_tr_b16 a[44:45], v8 offset:6656
ds_read_b64_tr_b16 a[46:47], v8 offset:7680
ds_read_b64_tr_b16 a[72:73], v234 offset:40960
ds_read_b64_tr_b16 a[74:75], v234 offset:43008
v_mfma_f32_16x16x32_bf16 v[100:103], a[12:15], v[16:19], v[100:103]
buffer_atomic_add v12, v235, s[4:7], s94 offen sc1
ds_read_b64_tr_b16 a[52:53], v8 offset:8192
ds_read_b64_tr_b16 a[54:55], v8 offset:9216
ds_read_b64_tr_b16 a[56:57], v8 offset:8704
ds_read_b64_tr_b16 a[58:59], v8 offset:9728
ds_read_b64_tr_b16 a[84:85], v234 offset:45056
ds_read_b64_tr_b16 a[86:87], v234 offset:47104
v_mfma_f32_16x16x32_bf16 v[100:103], a[24:27], v[16:19], v[100:103]
ds_read_b64_tr_b16 a[64:65], v8 offset:10240
ds_read_b64_tr_b16 a[66:67], v8 offset:11264
v_mfma_f32_16x16x32_bf16 v[92:95], a[0:3], a[4:7], 0
ds_read_b64_tr_b16 a[68:69], v8 offset:10752
ds_read_b64_tr_b16 a[70:71], v8 offset:11776
v_mfma_f32_16x16x32_bf16 v[96:99], a[0:3], a[8:11], 0
ds_read_b64_tr_b16 a[76:77], v8 offset:12288
s_waitcnt lgkmcnt(14)
v_mfma_f32_16x16x32_bf16 v[100:103], a[36:39], v[16:19], v[100:103]
ds_read_b64_tr_b16 a[78:79], v8 offset:13312
v_mfma_f32_16x16x32_bf16 v[92:95], a[12:15], a[16:19], v[92:95]
ds_read_b64_tr_b16 a[80:81], v8 offset:12800
ds_read_b64_tr_b16 a[82:83], v8 offset:13824
v_mfma_f32_16x16x32_bf16 v[96:99], a[12:15], a[20:23], v[96:99]
ds_read_b64_tr_b16 a[88:89], v8 offset:14336
v_mfma_f32_16x16x32_bf16 v[100:103], a[48:51], v[16:19], v[100:103]
ds_read_b64_tr_b16 a[90:91], v8 offset:15360
v_mfma_f32_16x16x32_bf16 v[92:95], a[24:27], a[28:31], v[92:95]
ds_read_b64_tr_b16 a[92:93], v8 offset:14848
ds_read_b64_tr_b16 a[94:95], v8 offset:15872
v_mfma_f32_16x16x32_bf16 v[96:99], a[24:27], a[32:35], v[96:99]
v_cvt_pk_bf16_f32 v132, v132, v133
v_cvt_pk_bf16_f32 v156, v156, v157
v_mfma_f32_16x16x32_bf16 v[100:103], a[60:63], v[16:19], v[100:103]
v_cvt_pk_bf16_f32 v180, v180, v181
v_cvt_pk_bf16_f32 v204, v204, v205
v_mfma_f32_16x16x32_bf16 v[92:95], a[36:39], a[40:43], v[92:95]
v_cvt_pk_bf16_f32 v133, v134, v135
v_cvt_pk_bf16_f32 v157, v158, v159
s_waitcnt lgkmcnt(14)
v_mfma_f32_16x16x32_bf16 v[96:99], a[36:39], a[44:47], v[96:99]
v_cvt_pk_bf16_f32 v181, v182, v183
v_cvt_pk_bf16_f32 v205, v206, v207
v_mfma_f32_16x16x32_bf16 v[100:103], a[72:75], v[16:19], v[100:103]
v_cvt_pk_bf16_f32 v134, v136, v137
v_cvt_pk_bf16_f32 v135, v138, v139
v_mfma_f32_16x16x32_bf16 v[92:95], a[48:51], a[52:55], v[92:95]
v_cvt_pk_bf16_f32 v158, v160, v161
v_cvt_pk_bf16_f32 v159, v162, v163
v_mfma_f32_16x16x32_bf16 v[96:99], a[48:51], a[56:59], v[96:99]
v_cvt_pk_bf16_f32 v182, v184, v185
v_cvt_pk_bf16_f32 v183, v186, v187
s_waitcnt lgkmcnt(12)
v_mfma_f32_16x16x32_bf16 v[100:103], a[84:87], v[16:19], v[100:103]
v_cvt_pk_bf16_f32 v206, v208, v209
v_cvt_pk_bf16_f32 v207, v210, v211
s_waitcnt lgkmcnt(10)
v_mfma_f32_16x16x32_bf16 v[92:95], a[60:63], a[64:67], v[92:95]
s_waitcnt lgkmcnt(8)
v_mfma_f32_16x16x32_bf16 v[96:99], a[60:63], a[68:71], v[96:99]
s_nop 1
v_min_u32 v100, -2, v100
v_min_u32 v101, -2, v101
s_waitcnt lgkmcnt(6)
v_mfma_f32_16x16x32_bf16 v[92:95], a[72:75], a[76:79], v[92:95]
v_min_u32 v102, -2, v102
v_min_u32 v103, -2, v103
s_waitcnt lgkmcnt(4)
v_mfma_f32_16x16x32_bf16 v[96:99], a[72:75], a[80:83], v[96:99]
buffer_store_dwordx4 v[100:103], v254, s[4:7], s97 offen sc1
s_waitcnt lgkmcnt(2)
v_mfma_f32_16x16x32_bf16 v[92:95], a[84:87], a[88:91], v[92:95]
s_waitcnt lgkmcnt(0)
v_mfma_f32_16x16x32_bf16 v[96:99], a[84:87], a[92:95], v[96:99]
s_nop 5
v_cvt_pk_bf16_f32 v92, v92, v93
v_cvt_pk_bf16_f32 v93, v94, v95
v_min_u32 v92, -2, v92
v_min_u32 v93, -2, v93
v_cvt_pk_bf16_f32 v94, v96, v97
v_cvt_pk_bf16_f32 v95, v98, v99
v_min_u32 v94, -2, v94
v_min_u32 v95, -2, v95
buffer_store_dwordx4 v[92:95], v1, s[4:7], s96 offen sc1
s_barrier
s_add_u32 m0, s19, 32768
s_add_u32 s44, s84, 0x1c00000
buffer_load_dwordx4 v1, s[4:7], s44 offen offset:0 sc1 lds
v_mfma_f32_16x16x32_bf16 v[108:111], a[240:243], v[132:135], 0
v_mfma_f32_16x16x32_bf16 v[172:175], a[240:243], v[156:159], 0
v_mfma_f32_16x16x32_bf16 v[112:115], a[244:247], v[132:135], 0
s_nop 5
v_max3_f32 v236, v108, v109, v110
v_max3_f32 v237, -v108, -v109, -v110
v_mfma_f32_16x16x32_bf16 v[176:179], a[244:247], v[156:159], 0
v_max3_f32 v238, v172, v173, v174
v_max3_f32 v239, -v172, -v173, -v174
v_max3_f32 v236, v236, v111, v112
v_max3_f32 v237, v237, -v111, -v112
v_max3_f32 v236, v236, v113, v114
v_max3_f32 v237, v237, -v113, -v114
s_nop 1
v_max3_f32 v238, v238, v175, v176
v_max3_f32 v239, v239, -v175, -v176
v_max3_f32 v238, v238, v177, v178
v_max3_f32 v239, v239, -v177, -v178
v_max_f32 v236, v236, v115
buffer_load_dwordx4 v1, s[4:7], s44 offen offset:1024 sc1 lds
v_max_f32_e64 v237, v237, -v115
v_max_f32 v238, v238, v179
v_max_f32_e64 v239, v239, -v179
v_permlane32_swap_b32 v236, v237
s_nop 0
v_permlane32_swap_b32 v238, v239
v_mov_b32 v11, 0
buffer_atomic_add v11, v251, s[4:7], s89 offen sc0 sc1
v_max_f32 v236, v236, v237
v_max_f32 v238, v238, v239
v_mov_b32 v244, v236
v_mov_b32 v245, v238
s_nop 0
v_permlane16_swap_b32 v236, v244
v_permlane16_swap_b32 v238, v245
v_max_f32 v236, v236, v244
v_max_f32 v238, v238, v245
v_mov_b32 v244, v236
v_mov_b32 v245, v238
s_nop 0
v_permlane32_swap_b32 v236, v244
v_permlane32_swap_b32 v238, v245
v_mul_f32_e64 v236, -v236, v82
v_mul_f32_e64 v237, -v244, v82
buffer_load_dwordx4 v1, s[4:7], s44 offen offset:2048 sc1 lds
v_mul_f32_e64 v238, -v238, v84
v_mul_f32_e64 v239, -v245, v84
v_pk_fma_f32 v[116:117], v[108:109], v[82:83], v[236:237] op_sel:[0,0,0] op_sel_hi:[1,0,0]
v_pk_fma_f32 v[118:119], v[110:111], v[82:83], v[236:237] op_sel:[0,0,0] op_sel_hi:[1,0,0]
v_pk_fma_f32 v[120:121], v[112:113], v[82:83], v[236:237] op_sel:[0,0,0] op_sel_hi:[1,0,0]
v_pk_fma_f32 v[122:123], v[114:115], v[82:83], v[236:237] op_sel:[0,0,0] op_sel_hi:[1,0,0]
v_pk_fma_f32 v[148:149], v[172:173], v[84:85], v[238:239] op_sel:[0,0,0] op_sel_hi:[1,0,0]
v_pk_fma_f32 v[150:151], v[174:175], v[84:85], v[238:239] op_sel:[0,0,0] op_sel_hi:[1,0,0]
v_pk_fma_f32 v[152:153], v[176:177], v[84:85], v[238:239] op_sel:[0,0,0] op_sel_hi:[1,0,0]
v_pk_fma_f32 v[154:155], v[178:179], v[84:85], v[238:239] op_sel:[0,0,0] op_sel_hi:[1,0,0]
v_pk_fma_f32 v[108:109], v[108:109], v[82:83], v[236:237] op_sel:[0,0,1] op_sel_hi:[1,0,1] neg_lo:[1,0,0] neg_hi:[1,0,0]
v_pk_fma_f32 v[110:111], v[110:111], v[82:83], v[236:237] op_sel:[0,0,1] op_sel_hi:[1,0,1] neg_lo:[1,0,0] neg_hi:[1,0,0]
v_pk_fma_f32 v[112:113], v[112:113], v[82:83], v[236:237] op_sel:[0,0,1] op_sel_hi:[1,0,1] neg_lo:[1,0,0] neg_hi:[1,0,0]
v_pk_fma_f32 v[114:115], v[114:115], v[82:83], v[236:237] op_sel:[0,0,1] op_sel_hi:[1,0,1] neg_lo:[1,0,0] neg_hi:[1,0,0]
v_pk_fma_f32 v[172:173], v[172:173], v[84:85], v[238:239] op_sel:[0,0,1] op_sel_hi:[1,0,1] neg_lo:[1,0,0] neg_hi:[1,0,0]
v_pk_fma_f32 v[174:175], v[174:175], v[84:85], v[238:239] op_sel:[0,0,1] op_sel_hi:[1,0,1] neg_lo:[1,0,0] neg_hi:[1,0,0]
v_pk_fma_f32 v[176:177], v[176:177], v[84:85], v[238:239] op_sel:[0,0,1] op_sel_hi:[1,0,1] neg_lo:[1,0,0] neg_hi:[1,0,0]
v_pk_fma_f32 v[178:179], v[178:179], v[84:85], v[238:239] op_sel:[0,0,1] op_sel_hi:[1,0,1] neg_lo:[1,0,0] neg_hi:[1,0,0]
v_exp_f32 v116, v116
v_exp_f32 v108, v108
v_exp_f32 v117, v117
v_exp_f32 v109, v109
v_exp_f32 v118, v118
v_exp_f32 v110, v110
v_exp_f32 v119, v119
v_exp_f32 v111, v111
v_exp_f32 v120, v120
v_exp_f32 v112, v112
v_exp_f32 v121, v121
v_exp_f32 v113, v113
L_stub8:
s_cbranch_execz L_wret1
v_exp_f32 v122, v122
v_exp_f32 v114, v114
v_exp_f32 v123, v123
v_exp_f32 v115, v115
v_exp_f32 v148, v148
v_exp_f32 v172, v172
v_exp_f32 v149, v149
v_exp_f32 v173, v173
v_exp_f32 v150, v150
v_exp_f32 v174, v174
v_exp_f32 v151, v151
v_exp_f32 v175, v175
v_exp_f32 v152, v152
v_exp_f32 v176, v176
v_exp_f32 v153, v153
v_exp_f32 v177, v177
v_exp_f32 v154, v154
v_exp_f32 v178, v178
v_exp_f32 v155, v155
v_exp_f32 v179, v179
buffer_load_dwordx4 v1, s[4:7], s44 offen offset:3072 sc1 lds
v_cvt_pk_bf16_f32 v140, v116, v117
v_cvt_pk_bf16_f32 v141, v118, v119
v_cvt_pk_bf16_f32 v142, v120, v121
v_cvt_pk_bf16_f32 v143, v122, v123
v_cvt_pk_bf16_f32 v144, v108, v109
v_cvt_pk_bf16_f32 v145, v110, v111
v_cvt_pk_bf16_f32 v146, v112, v113
v_cvt_pk_bf16_f32 v147, v114, v115
v_cvt_pk_bf16_f32 v164, v148, v149
v_cvt_pk_bf16_f32 v165, v150, v151
v_cvt_pk_bf16_f32 v166, v152, v153
v_cvt_pk_bf16_f32 v167, v154, v155
v_cvt_pk_bf16_f32 v168, v172, v173
v_cvt_pk_bf16_f32 v169, v174, v175
v_cvt_pk_bf16_f32 v170, v176, v177
v_cvt_pk_bf16_f32 v171, v178, v179
s_waitcnt vmcnt(2)
v_readfirstlane_b32 s38, v11
s_nop 0
s_cmp_ge_u32 s38, 8
s_cbranch_scc1 Lpe_25
s_add_u32 s36, s88, 0x80000
s_mov_b32 s37, 0
Lpoll_24:
v_mov_b32 v11, 0
buffer_atomic_add v11, v251, s[4:7], s36 offen sc0 sc1
s_add_u32 s37, s37, 1
s_waitcnt vmcnt(0)
v_readfirstlane_b32 s38, v11
s_nop 0
s_cmp_ge_u32 s38, 8
s_cbranch_scc1 Lpe_25
s_cmp_lt_u32 s37, 0x100000
s_cbranch_scc1 Lpoll_24
Lpe_25:
buffer_load_dwordx4 v[48:51], v1, s[4:7], s98 offen offset:0 sc1
v_mfma_f32_16x16x32_bf16 v[108:111], a[240:243], v[180:183], 0
v_mfma_f32_16x16x32_bf16 v[220:223], a[240:243], v[204:207], 0
v_mfma_f32_16x16x32_bf16 v[112:115], a[244:247], v[180:183], 0
s_nop 5
v_max3_f32 v240, v108, v109, v110
v_max3_f32 v241, -v108, -v109, -v110
v_mfma_f32_16x16x32_bf16 v[224:227], a[244:247], v[204:207], 0
buffer_load_dwordx4 v[124:127], v248, s[4:7], s100 offen sc1
v_max3_f32 v242, v220, v221, v222
v_max3_f32 v243, -v220, -v221, -v222
v_max3_f32 v240, v240, v111, v112
v_max3_f32 v241, v241, -v111, -v112
v_max3_f32 v240, v240, v113, v114
s_nop 1
v_max3_f32 v242, v242, v223, v224
v_max3_f32 v243, v243, -v223, -v224
v_max3_f32 v241, v241, -v113, -v114
v_max3_f32 v242, v242, v225, v226
v_max3_f32 v243, v243, -v225, -v226
v_max_f32 v240, v240, v115
v_max_f32_e64 v241, v241, -v115
v_max_f32 v242, v242, v227
buffer_load_dwordx4 v[52:55], v1, s[4:7], s98 offen offset:1024 sc1
v_max_f32_e64 v243, v243, -v227
v_permlane32_swap_b32 v240, v241
s_nop 0
v_permlane32_swap_b32 v242, v243
v_max_f32 v240, v240, v241
v_max_f32 v242, v242, v243
v_mov_b32 v246, v240
v_mov_b32 v247, v242
s_nop 0
v_permlane16_swap_b32 v240, v246
v_permlane16_swap_b32 v242, v247
buffer_load_dwordx4 v[56:59], v1, s[4:7], s98 offen offset:2048 sc1
v_max_f32 v240, v240, v246
v_max_f32 v242, v242, v247
v_mov_b32 v246, v240
v_mov_b32 v247, v242
s_nop 0
v_permlane32_swap_b32 v240, v246
v_permlane32_swap_b32 v242, v247
v_mul_f32_e64 v240, -v240, v86
v_mul_f32_e64 v241, -v246, v86
v_mul_f32_e64 v242, -v242, v88
v_mul_f32_e64 v243, -v247, v88
buffer_load_dwordx4 v[60:63], v1, s[4:7], s98 offen offset:3072 sc1
v_pk_fma_f32 v[116:117], v[108:109], v[86:87], v[240:241] op_sel:[0,0,0] op_sel_hi:[1,0,0]
v_pk_fma_f32 v[118:119], v[110:111], v[86:87], v[240:241] op_sel:[0,0,0] op_sel_hi:[1,0,0]
v_pk_fma_f32 v[120:121], v[112:113], v[86:87], v[240:241] op_sel:[0,0,0] op_sel_hi:[1,0,0]
v_pk_fma_f32 v[122:123], v[114:115], v[86:87], v[240:241] op_sel:[0,0,0] op_sel_hi:[1,0,0]
v_pk_fma_f32 v[196:197], v[220:221], v[88:89], v[242:243] op_sel:[0,0,0] op_sel_hi:[1,0,0]
v_pk_fma_f32 v[198:199], v[222:223], v[88:89], v[242:243] op_sel:[0,0,0] op_sel_hi:[1,0,0]
v_pk_fma_f32 v[200:201], v[224:225], v[88:89], v[242:243] op_sel:[0,0,0] op_sel_hi:[1,0,0]
v_pk_fma_f32 v[202:203], v[226:227], v[88:89], v[242:243] op_sel:[0,0,0] op_sel_hi:[1,0,0]
v_pk_fma_f32 v[108:109], v[108:109], v[86:87], v[240:241] op_sel:[0,0,1] op_sel_hi:[1,0,1] neg_lo:[1,0,0] neg_hi:[1,0,0]
v_pk_fma_f32 v[110:111], v[110:111], v[86:87], v[240:241] op_sel:[0,0,1] op_sel_hi:[1,0,1] neg_lo:[1,0,0] neg_hi:[1,0,0]
v_pk_fma_f32 v[112:113], v[112:113], v[86:87], v[240:241] op_sel:[0,0,1] op_sel_hi:[1,0,1] neg_lo:[1,0,0] neg_hi:[1,0,0]
v_pk_fma_f32 v[114:115], v[114:115], v[86:87], v[240:241] op_sel:[0,0,1] op_sel_hi:[1,0,1] neg_lo:[1,0,0] neg_hi:[1,0,0]
v_pk_fma_f32 v[220:221], v[220:221], v[88:89], v[242:243] op_sel:[0,0,1] op_sel_hi:[1,0,1] neg_lo:[1,0,0] neg_hi:[1,0,0]
buffer_load_dwordx4 v[64:67], v1, s[4:7], s99 offen offset:0 sc1
v_pk_fma_f32 v[222:223], v[222:223], v[88:89], v[242:243] op_sel:[0,0,1] op_sel_hi:[1,0,1] neg_lo:[1,0,0] neg_hi:[1,0,0]
v_pk_fma_f32 v[224:225], v[224:225], v[88:89], v[242:243] op_sel:[0,0,1] op_sel_hi:[1,0,1] neg_lo:[1,0,0] neg_hi:[1,0,0]
v_pk_fma_f32 v[226:227], v[226:227], v[88:89], v[242:243] op_sel:[0,0,1] op_sel_hi:[1,0,1] neg_lo:[1,0,0] neg_hi:[1,0,0]
v_exp_f32 v116, v116
v_exp_f32 v108, v108
v_exp_f32 v117, v117
v_exp_f32 v109, v109
v_exp_f32 v118, v118
buffer_load_dwordx4 v[68:71], v1, s[4:7], s99 offen offset:1024 sc1
v_exp_f32 v110, v110
v_exp_f32 v119, v119
v_exp_f32 v111, v111
v_exp_f32 v120, v120
v_exp_f32 v112, v112
v_exp_f32 v121, v121
v_exp_f32 v113, v113
buffer_load_dwordx4 v[100:103], v1, s[4:7], s99 offen offset:2048 sc1
v_exp_f32 v122, v122
v_exp_f32 v114, v114
v_exp_f32 v123, v123
v_exp_f32 v115, v115
v_exp_f32 v196, v196
v_exp_f32 v220, v220
v_exp_f32 v197, v197
buffer_load_dwordx4 v[104:107], v1, s[4:7], s99 offen offset:3072 sc1
v_exp_f32 v221, v221
v_exp_f32 v198, v198
v_exp_f32 v222, v222
v_exp_f32 v199, v199
v_exp_f32 v223, v223
v_exp_f32 v200, v200
v_exp_f32 v224, v224
buffer_store_dwordx4 a[248:251], v2, s[4:7], s73 offen offset:0 sc1
v_exp_f32 v201, v201
v_exp_f32 v225, v225
v_exp_f32 v202, v202
v_exp_f32 v226, v226
v_exp_f32 v203, v203
v_exp_f32 v227, v227
v_cvt_pk_bf16_f32 v188, v116, v117
v_cvt_pk_bf16_f32 v189, v118, v119
v_cvt_pk_bf16_f32 v190, v120, v121
v_cvt_pk_bf16_f32 v191, v122, v123
v_cvt_pk_bf16_f32 v192, v108, v109
v_cvt_pk_bf16_f32 v193, v110, v111
v_cvt_pk_bf16_f32 v194, v112, v113
v_cvt_pk_bf16_f32 v195, v114, v115
v_cvt_pk_bf16_f32 v212, v196, v197
v_cvt_pk_bf16_f32 v213, v198, v199
v_cvt_pk_bf16_f32 v214, v200, v201
v_cvt_pk_bf16_f32 v215, v202, v203
v_cvt_pk_bf16_f32 v216, v220, v221
v_cvt_pk_bf16_f32 v217, v222, v223
v_cvt_pk_bf16_f32 v218, v224, v225
v_cvt_pk_bf16_f32 v219, v226, v227
buffer_store_dwordx4 a[248:251], v2, s[4:7], s73 offen offset:1024 sc1
s_waitcnt vmcnt(10)
v_lshlrev_b32 v92, 16, v48
v_and_b32 v93, 0xffff0000, v48
v_lshlrev_b32 v94, 16, v49
v_and_b32 v95, 0xffff0000, v49
v_lshlrev_b32 v96, 16, v50
v_and_b32 v97, 0xffff0000, v50
v_lshlrev_b32 v98, 16, v51
v_and_b32 v99, 0xffff0000, v51
s_waitcnt vmcnt(9)
v_add_f32_dpp v128, v124, v124 row_ror:4 row_mask:0xf bank_mask:0xf
v_add_f32_dpp v129, v125, v125 row_ror:4 row_mask:0xf bank_mask:0xf
v_add_f32_dpp v130, v126, v126 row_ror:4 row_mask:0xf bank_mask:0xf
v_add_f32_dpp v131, v127, v127 row_ror:4 row_mask:0xf bank_mask:0xf
v_add_f32_dpp v128, v128, v128 row_ror:2 row_mask:0xf bank_mask:0xf
v_add_f32_dpp v129, v129, v129 row_ror:2 row_mask:0xf bank_mask:0xf
v_add_f32_dpp v130, v130, v130 row_ror:2 row_mask:0xf bank_mask:0xf
buffer_store_dwordx4 a[248:251], v2, s[4:7], s73 offen offset:2048 sc1
v_add_f32_dpp v131, v131, v131 row_ror:2 row_mask:0xf bank_mask:0xf
v_add_f32_dpp v128, v128, v128 row_ror:1 row_mask:0xf bank_mask:0xf
v_add_f32_dpp v129, v129, v129 row_ror:1 row_mask:0xf bank_mask:0xf
v_add_f32_dpp v130, v130, v130 row_ror:1 row_mask:0xf bank_mask:0xf
v_add_f32_dpp v131, v131, v131 row_ror:1 row_mask:0xf bank_mask:0xf
s_waitcnt vmcnt(9)
v_dot2c_f32_bf16 v92, v52, v249
v_dot2c_f32_bf16 v93, v52, v250
v_dot2c_f32_bf16 v94, v53, v249
v_dot2c_f32_bf16 v95, v53, v250
v_dot2c_f32_bf16 v96, v54, v249
v_dot2c_f32_bf16 v97, v54, v250
v_dot2c_f32_bf16 v98, v55, v249
v_dot2c_f32_bf16 v99, v55, v250
v_fma_f32 v135, v129, v130, v131
s_waitcnt vmcnt(8)
v_dot2c_f32_bf16 v92, v56, v249
v_dot2c_f32_bf16 v93, v56, v250
v_dot2c_f32_bf16 v94, v57, v249
v_dot2c_f32_bf16 v95, v57, v250
v_dot2c_f32_bf16 v96, v58, v249
v_dot2c_f32_bf16 v97, v58, v250
v_dot2c_f32_bf16 v98, v59, v249
v_dot2c_f32_bf16 v99, v59, v250
buffer_store_dwordx4 a[248:251], v2, s[4:7], s73 offen offset:3072 sc1
s_waitcnt vmcnt(8)
v_dot2c_f32_bf16 v92, v60, v249
v_dot2c_f32_bf16 v93, v60, v250
v_dot2c_f32_bf16 v94, v61, v249
v_dot2c_f32_bf16 v95, v61, v250
v_dot2c_f32_bf16 v96, v62, v249
v_dot2c_f32_bf16 v97, v62, v250
v_dot2c_f32_bf16 v98, v63, v249
v_dot2c_f32_bf16 v99, v63, v250
s_waitcnt vmcnt(7)
v_dot2c_f32_bf16 v92, v64, v249
v_dot2c_f32_bf16 v93, v64, v250
v_dot2c_f32_bf16 v94, v65, v249
v_dot2c_f32_bf16 v95, v65, v250
v_dot2c_f32_bf16 v96, v66, v249
v_dot2c_f32_bf16 v97, v66, v250
v_dot2c_f32_bf16 v98, v67, v249
v_dot2c_f32_bf16 v99, v67, v250
s_waitcnt vmcnt(6)
v_dot2c_f32_bf16 v92, v68, v249
v_dot2c_f32_bf16 v93, v68, v250
v_dot2c_f32_bf16 v94, v69, v249
v_dot2c_f32_bf16 v95, v69, v250
v_dot2c_f32_bf16 v96, v70, v249
v_dot2c_f32_bf16 v97, v70, v250
v_dot2c_f32_bf16 v98, v71, v249
v_dot2c_f32_bf16 v99, v71, v250
s_waitcnt vmcnt(5)
v_dot2c_f32_bf16 v92, v100, v249
v_dot2c_f32_bf16 v93, v100, v250
v_dot2c_f32_bf16 v94, v101, v249
v_dot2c_f32_bf16 v95, v101, v250
v_dot2c_f32_bf16 v96, v102, v249
v_dot2c_f32_bf16 v97, v102, v250
v_dot2c_f32_bf16 v98, v103, v249
v_dot2c_f32_bf16 v99, v103, v250
s_waitcnt vmcnt(4)
v_dot2c_f32_bf16 v92, v104, v249
v_dot2c_f32_bf16 v93, v104, v250
v_dot2c_f32_bf16 v94, v105, v249
v_dot2c_f32_bf16 v95, v105, v250
v_dot2c_f32_bf16 v96, v106, v249
v_dot2c_f32_bf16 v97, v106, v250
v_dot2c_f32_bf16 v98, v107, v249
v_dot2c_f32_bf16 v99, v107, v250
v_fma_f32 v132, v92, v93, v94
v_fma_f32 v133, v95, v96, v97
s_nop 0
v_fma_f32 v134, v98, v99, v128
v_fma_f32 v132, v132, v133, v134
v_cmp_u_f32 vcc, v132, v135
s_cbranch_vccnz L_kvredo1
L_kvback1:
v_cvt_pk_bf16_f32 v128, v128, v129
v_cvt_pk_bf16_f32 v129, v130, v131
v_cvt_pk_bf16_f32 v92, v92, v93
v_cndmask_b32 v128, 0, v128, s[56:57]
v_cndmask_b32 v129, 0, v129, s[56:57]
v_cvt_pk_bf16_f32 v93, v94, v95
v_cvt_pk_bf16_f32 v94, v96, v97
v_cvt_pk_bf16_f32 v95, v98, v99
v_cndmask_b32 v128, v128, v16, s[58:59]
v_cndmask_b32 v129, v129, v16, s[58:59]
ds_write_b64 v252, v[92:93] offset:0
ds_write_b64 v252, v[94:95] offset:1024
ds_write_b64 v252, v[128:129] offset:2048
s_waitcnt lgkmcnt(0)
s_barrier
ds_read_b128 a[8:11], v1 offset:2048
ds_read_b128 a[20:23], v1 offset:5120
ds_read_b128 a[0:3], v1 offset:0
ds_read_b128 a[12:15], v1 offset:3072
ds_read_b128 a[4:7], v1 offset:1024
ds_read_b128 a[16:19], v1 offset:4096
s_waitcnt lgkmcnt(5)
v_mfma_f32_16x16x32_bf16 v[116:119], a[8:11], v[212:215], 0
s_waitcnt lgkmcnt(4)
v_mfma_f32_16x16x32_bf16 v[120:123], a[20:23], v[216:219], 0
s_waitcnt lgkmcnt(3)
v_mfma_f32_16x16x32_bf16 v[204:207], a[0:3], v[212:215], 0
s_nop 3
v_rcp_f32 v118, v117
s_waitcnt lgkmcnt(2)
v_mfma_f32_16x16x32_bf16 v[220:223], a[12:15], v[216:219], 0
v_rcp_f32 v119, v121
v_mul_f32 v116, v116, v118
buffer_atomic_add v12, v10, s[4:7], s74 offen sc1
v_fmac_f32 v116, v120, v119
v_mfma_f32_16x16x32_bf16 v[100:103], a[8:11], v[164:167], 0
v_add_f32 v116, 0x358637bd, v116
v_rcp_f32 v116, v116
s_waitcnt lgkmcnt(1)
v_mfma_f32_16x16x32_bf16 v[208:211], a[4:7], v[212:215], 0
v_mul_f32 v118, v118, v116
v_mul_f32 v119, v119, v116
v_mfma_f32_16x16x32_bf16 v[104:107], a[20:23], v[168:171], 0
v_mul_f32 v204, v204, v118
v_mul_f32 v205, v205, v118
s_waitcnt lgkmcnt(0)
v_mfma_f32_16x16x32_bf16 v[224:227], a[16:19], v[216:219], 0
v_mul_f32 v206, v206, v118
v_mul_f32 v207, v207, v118
v_fmac_f32 v204, v220, v119
v_fmac_f32 v205, v221, v119
v_rcp_f32 v102, v101
v_mul_f32 v208, v208, v118
v_mul_f32 v209, v209, v118
v_mul_f32 v210, v210, v118
v_mul_f32 v211, v211, v118
v_fmac_f32 v206, v222, v119
v_fmac_f32 v207, v223, v119
v_cvt_pk_bf16_f32 v204, v204, v205
v_rcp_f32 v103, v105
v_fmac_f32 v208, v224, v119
v_fmac_f32 v209, v225, v119
v_fmac_f32 v210, v226, v119
v_fmac_f32 v211, v227, v119
v_cvt_pk_bf16_f32 v205, v206, v207
v_cvt_pk_bf16_f32 v206, v208, v209
v_cvt_pk_bf16_f32 v207, v210, v211
v_mul_f32 v100, v100, v102
v_mfma_f32_16x16x32_bf16 v[156:159], a[0:3], v[164:167], 0
buffer_store_dwordx4 v[204:207], v2, s[4:7], s72 offen offset:3072 sc1
v_fmac_f32 v100, v104, v103
v_mfma_f32_16x16x32_bf16 v[172:175], a[12:15], v[168:171], 0
v_add_f32 v100, 0x358637bd, v100
v_rcp_f32 v100, v100
v_mfma_f32_16x16x32_bf16 v[108:111], a[8:11], v[188:191], 0
v_mul_f32 v102, v102, v100
v_mul_f32 v103, v103, v100
v_mfma_f32_16x16x32_bf16 v[160:163], a[4:7], v[164:167], 0
v_mul_f32 v156, v156, v102
v_mul_f32 v157, v157, v102
v_mfma_f32_16x16x32_bf16 v[112:115], a[20:23], v[192:195], 0
v_mul_f32 v158, v158, v102
v_mul_f32 v159, v159, v102
v_mfma_f32_16x16x32_bf16 v[176:179], a[16:19], v[168:171], 0
v_fmac_f32 v156, v172, v103
v_fmac_f32 v157, v173, v103
v_rcp_f32 v110, v109
v_mul_f32 v160, v160, v102
v_mul_f32 v161, v161, v102
v_mul_f32 v162, v162, v102
v_mul_f32 v163, v163, v102
v_fmac_f32 v158, v174, v103
v_fmac_f32 v159, v175, v103
v_cvt_pk_bf16_f32 v156, v156, v157
v_rcp_f32 v111, v113
v_fmac_f32 v160, v176, v103
v_fmac_f32 v161, v177, v103
v_fmac_f32 v162, v178, v103
v_fmac_f32 v163, v179, v103
v_cvt_pk_bf16_f32 v157, v158, v159
v_cvt_pk_bf16_f32 v158, v160, v161
v_cvt_pk_bf16_f32 v159, v162, v163
v_mul_f32 v108, v108, v110
v_mfma_f32_16x16x32_bf16 v[180:183], a[0:3], v[188:191], 0
buffer_store_dwordx4 v[156:159], v2, s[4:7], s72 offen offset:1024 sc1
v_fmac_f32 v108, v112, v111
v_mfma_f32_16x16x32_bf16 v[196:199], a[12:15], v[192:195], 0
v_add_f32 v108, 0x358637bd, v108
v_rcp_f32 v108, v108
v_mfma_f32_16x16x32_bf16 v[92:95], a[8:11], v[140:143], 0
v_mul_f32 v110, v110, v108
v_mul_f32 v111, v111, v108
v_mfma_f32_16x16x32_bf16 v[184:187], a[4:7], v[188:191], 0
v_mul_f32 v180, v180, v110
v_mul_f32 v181, v181, v110
v_mfma_f32_16x16x32_bf16 v[96:99], a[20:23], v[144:147], 0
v_mul_f32 v182, v182, v110
v_mul_f32 v183, v183, v110
v_mfma_f32_16x16x32_bf16 v[200:203], a[16:19], v[192:195], 0
v_fmac_f32 v180, v196, v111
v_fmac_f32 v181, v197, v111
v_rcp_f32 v94, v93
v_mul_f32 v184, v184, v110
v_mul_f32 v185, v185, v110
v_mul_f32 v186, v186, v110
v_mul_f32 v187, v187, v110
v_fmac_f32 v182, v198, v111
v_fmac_f32 v183, v199, v111
v_cvt_pk_bf16_f32 v180, v180, v181
v_rcp_f32 v95, v97
v_fmac_f32 v184, v200, v111
v_fmac_f32 v185, v201, v111
v_fmac_f32 v186, v202, v111
v_fmac_f32 v187, v203, v111
v_cvt_pk_bf16_f32 v181, v182, v183
v_cvt_pk_bf16_f32 v182, v184, v185
v_cvt_pk_bf16_f32 v183, v186, v187
v_mul_f32 v92, v92, v94
v_mfma_f32_16x16x32_bf16 v[132:135], a[0:3], v[140:143], 0
buffer_store_dwordx4 v[180:183], v2, s[4:7], s72 offen offset:2048 sc1
v_fmac_f32 v92, v96, v95
v_mfma_f32_16x16x32_bf16 v[148:151], a[12:15], v[144:147], 0
v_add_f32 v92, 0x358637bd, v92
v_rcp_f32 v92, v92
v_mfma_f32_16x16x32_bf16 v[136:139], a[4:7], v[140:143], 0
v_mul_f32 v94, v94, v92
v_mul_f32 v95, v95, v92
v_mfma_f32_16x16x32_bf16 v[152:155], a[16:19], v[144:147], 0
v_mul_f32 v132, v132, v94
v_mul_f32 v133, v133, v94
v_mul_f32 v134, v134, v94
v_mul_f32 v135, v135, v94
v_fmac_f32 v132, v148, v95
v_fmac_f32 v133, v149, v95
v_mul_f32 v136, v136, v94
v_mul_f32 v137, v137, v94
v_mul_f32 v138, v138, v94
v_mul_f32 v139, v139, v94
v_fmac_f32 v134, v150, v95
v_fmac_f32 v135, v151, v95
v_cvt_pk_bf16_f32 v132, v132, v133
v_fmac_f32 v136, v152, v95
v_fmac_f32 v137, v153, v95
v_fmac_f32 v138, v154, v95
v_fmac_f32 v139, v155, v95
v_cvt_pk_bf16_f32 v133, v134, v135
v_cvt_pk_bf16_f32 v134, v136, v137
v_cvt_pk_bf16_f32 v135, v138, v139
buffer_store_dwordx4 v[132:135], v2, s[4:7], s72 offen offset:0 sc1
s_add_u32 s92, s71, 0x10000
s_add_u32 s40, s4, 0xc00000
s_addc_u32 s41, s5, 0
v_add_u32 v5, 32768, v1
v_add_u32 v6, 98304, v1
s_mov_b32 s35, s9
v_lshlrev_b32 v132, 16, v32
v_and_b32 v133, 0xffff0000, v32
v_lshlrev_b32 v134, 16, v33
v_and_b32 v135, 0xffff0000, v33
v_lshlrev_b32 v136, 16, v34
v_and_b32 v137, 0xffff0000, v34
v_lshlrev_b32 v138, 16, v35
v_and_b32 v139, 0xffff0000, v35
v_lshlrev_b32 v140, 16, v36
v_and_b32 v141, 0xffff0000, v36
v_lshlrev_b32 v142, 16, v37
v_and_b32 v143, 0xffff0000, v37
v_lshlrev_b32 v144, 16, v38
v_and_b32 v145, 0xffff0000, v38
v_lshlrev_b32 v146, 16, v39
v_and_b32 v147, 0xffff0000, v39
v_lshlrev_b32 v148, 16, v40
v_and_b32 v149, 0xffff0000, v40
v_lshlrev_b32 v150, 16, v41
v_and_b32 v151, 0xffff0000, v41
v_lshlrev_b32 v152, 16, v42
v_and_b32 v153, 0xffff0000, v42
v_lshlrev_b32 v154, 16, v43
v_and_b32 v155, 0xffff0000, v43
v_lshlrev_b32 v156, 16, v44
v_and_b32 v157, 0xffff0000, v44
v_lshlrev_b32 v158, 16, v45
v_and_b32 v159, 0xffff0000, v45
v_lshlrev_b32 v160, 16, v46
v_and_b32 v161, 0xffff0000, v46
v_lshlrev_b32 v162, 16, v47
v_and_b32 v163, 0xffff0000, v47
s_mov_b32 s95, -1
s_mov_b64 exec, 0
s_cmp_eq_u32 s28, 3
s_cbranch_scc1 L_stub9
s_cmp_eq_u32 s28, 2
s_cbranch_scc1 L_stub12
s_cmp_eq_u32 s28, 0
s_cbranch_scc1 L_stub13
L_wret3:
s_mov_b64 exec, -1
s_cmp_lg_u32 s28, 1
s_cbranch_scc1 Lpo_28
s_add_u32 s36, s11, 0x10080
s_mov_b32 s37, 0
v_mov_b32 v11, 0
buffer_atomic_add v11, v251, s[4:7], s36 offen sc0 sc1
s_sleep 4
Lpoll_26:
v_mov_b32 v234, 0
buffer_atomic_add v234, v251, s[4:7], s36 offen sc0 sc1
s_waitcnt vmcnt(1)
v_readfirstlane_b32 s38, v11
s_nop 0
s_cmp_ge_u32 s38, 32
s_cbranch_scc1 Lpe_27
v_mov_b32 v11, 0
buffer_atomic_add v11, v251, s[4:7], s36 offen sc0 sc1
s_waitcnt vmcnt(1)
v_readfirstlane_b32 s38, v234
s_nop 0
s_cmp_ge_u32 s38, 32
s_cbranch_scc1 Lpe_27
s_add_u32 s37, s37, 1
s_cmp_lt_u32 s37, 0x80000
s_cbranch_scc1 Lpoll_26
s_waitcnt vmcnt(0)
Lpo_28:
s_waitcnt vmcnt(0)
Lpe_27:
s_barrier
L_k2go1:
buffer_load_dwordx4 a[0:3], v4, s[40:43], s35 offen offset:0 sc1
buffer_load_dwordx4 a[4:7], v4, s[40:43], s35 offen offset:1024 sc1
s_add_u32 s35, s9, 4096
buffer_load_dwordx4 a[8:11], v4, s[40:43], s35 offen offset:0 sc1
buffer_load_dwordx4 a[12:15], v4, s[40:43], s35 offen offset:1024 sc1
s_add_u32 s35, s9, 16384
buffer_load_dwordx4 a[16:19], v4, s[40:43], s35 offen offset:0 sc1
buffer_load_dwordx4 a[20:23], v4, s[40:43], s35 offen offset:1024 sc1
s_add_u32 s35, s9, 20480
buffer_load_dwordx4 a[24:27], v4, s[40:43], s35 offen offset:0 sc1
buffer_load_dwordx4 a[28:31], v4, s[40:43], s35 offen offset:1024 sc1
s_add_u32 s35, s9, 32768
buffer_load_dwordx4 a[32:35], v4, s[40:43], s35 offen offset:0 sc1
buffer_load_dwordx4 a[36:39], v4, s[40:43], s35 offen offset:1024 sc1
s_add_u32 s35, s9, 36864
buffer_load_dwordx4 a[40:43], v4, s[40:43], s35 offen offset:0 sc1
buffer_load_dwordx4 a[44:47], v4, s[40:43], s35 offen offset:1024 sc1
s_add_u32 s35, s9, 49152
ds_read_b128 a[96:99], v5 offset:0
ds_read_b128 a[100:103], v5 offset:1024
ds_read_b128 a[104:107], v5 offset:2048
ds_read_b128 a[108:111], v5 offset:3072
ds_read_b128 a[112:115], v5 offset:4096
ds_read_b128 a[116:119], v5 offset:5120
ds_read_b128 a[120:123], v5 offset:6144
ds_read_b128 a[124:127], v5 offset:7168
s_waitcnt vmcnt(10) lgkmcnt(4)
v_mfma_f32_16x16x32_bf16 v[132:135], a[96:99], a[0:3], v[132:135]
ds_read_b128 a[128:131], v5 offset:8192
v_mfma_f32_16x16x32_bf16 v[148:151], a[96:99], a[4:7], v[148:151]
ds_read_b128 a[132:135], v5 offset:9216
v_mfma_f32_16x16x32_bf16 v[152:155], a[100:103], a[4:7], v[152:155]
buffer_load_dwordx4 a[48:51], v4, s[40:43], s35 offen offset:0 sc1
v_mfma_f32_16x16x32_bf16 v[136:139], a[100:103], a[0:3], v[136:139]
ds_read_b128 a[136:139], v5 offset:10240
v_mfma_f32_16x16x32_bf16 v[140:143], a[104:107], a[0:3], v[140:143]
ds_read_b128 a[140:143], v5 offset:11264
v_mfma_f32_16x16x32_bf16 v[156:159], a[104:107], a[4:7], v[156:159]
v_mfma_f32_16x16x32_bf16 v[160:163], a[108:111], a[4:7], v[160:163]
buffer_load_dwordx4 a[52:55], v4, s[40:43], s35 offen offset:1024 sc1
s_add_u32 s35, s9, 53248
v_mfma_f32_16x16x32_bf16 v[144:147], a[108:111], a[0:3], v[144:147]
s_waitcnt vmcnt(10) lgkmcnt(4)
v_mfma_f32_16x16x32_bf16 v[132:135], a[112:115], a[8:11], v[132:135]
ds_read_b128 a[96:99], v5 offset:12288
v_mfma_f32_16x16x32_bf16 v[148:151], a[112:115], a[12:15], v[148:151]
ds_read_b128 a[100:103], v5 offset:13312
v_mfma_f32_16x16x32_bf16 v[152:155], a[116:119], a[12:15], v[152:155]
buffer_load_dwordx4 a[0:3], v4, s[40:43], s35 offen offset:0 sc1
v_mfma_f32_16x16x32_bf16 v[136:139], a[116:119], a[8:11], v[136:139]
ds_read_b128 a[104:107], v5 offset:14336
v_mfma_f32_16x16x32_bf16 v[140:143], a[120:123], a[8:11], v[140:143]
ds_read_b128 a[108:111], v5 offset:15360
v_mfma_f32_16x16x32_bf16 v[156:159], a[120:123], a[12:15], v[156:159]
v_mfma_f32_16x16x32_bf16 v[160:163], a[124:127], a[12:15], v[160:163]
buffer_load_dwordx4 a[4:7], v4, s[40:43], s35 offen offset:1024 sc1
s_add_u32 s35, s9, 65536
v_mfma_f32_16x16x32_bf16 v[144:147], a[124:127], a[8:11], v[144:147]
s_waitcnt vmcnt(10) lgkmcnt(4)
v_mfma_f32_16x16x32_bf16 v[132:135], a[128:131], a[16:19], v[132:135]
ds_read_b128 a[112:115], v5 offset:16384
v_mfma_f32_16x16x32_bf16 v[148:151], a[128:131], a[20:23], v[148:151]
ds_read_b128 a[116:119], v5 offset:17408
v_mfma_f32_16x16x32_bf16 v[152:155], a[132:135], a[20:23], v[152:155]
buffer_load_dwordx4 a[8:11], v4, s[40:43], s35 offen offset:0 sc1
v_mfma_f32_16x16x32_bf16 v[136:139], a[132:135], a[16:19], v[136:139]
ds_read_b128 a[120:123], v5 offset:18432
v_mfma_f32_16x16x32_bf16 v[140:143], a[136:139], a[16:19], v[140:143]
ds_read_b128 a[124:127], v5 offset:19456
v_mfma_f32_16x16x32_bf16 v[156:159], a[136:139], a[20:23], v[156:159]
v_mfma_f32_16x16x32_bf16 v[160:163], a[140:143], a[20:23], v[160:163]
buffer_load_dwordx4 a[12:15], v4, s[40:43], s35 offen offset:1024 sc1
s_add_u32 s35, s9, 69632
v_mfma_f32_16x16x32_bf16 v[144:147], a[140:143], a[16:19], v[144:147]
s_waitcnt vmcnt(10) lgkmcnt(4)
v_mfma_f32_16x16x32_bf16 v[132:135], a[96:99], a[24:27], v[132:135]
ds_read_b128 a[128:131], v5 offset:20480
v_mfma_f32_16x16x32_bf16 v[148:151], a[96:99], a[28:31], v[148:151]
ds_read_b128 a[132:135], v5 offset:21504
v_mfma_f32_16x16x32_bf16 v[152:155], a[100:103], a[28:31], v[152:155]
buffer_load_dwordx4 a[16:19], v4, s[40:43], s35 offen offset:0 sc1
v_mfma_f32_16x16x32_bf16 v[136:139], a[100:103], a[24:27], v[136:139]
ds_read_b128 a[136:139], v5 offset:22528
v_mfma_f32_16x16x32_bf16 v[140:143], a[104:107], a[24:27], v[140:143]
ds_read_b128 a[140:143], v5 offset:23552
v_mfma_f32_16x16x32_bf16 v[156:159], a[104:107], a[28:31], v[156:159]
v_mfma_f32_16x16x32_bf16 v[160:163], a[108:111], a[28:31], v[160:163]
buffer_load_dwordx4 a[20:23], v4, s[40:43], s35 offen offset:1024 sc1
s_add_u32 s35, s9, 81920
v_mfma_f32_16x16x32_bf16 v[144:147], a[108:111], a[24:27], v[144:147]
s_waitcnt vmcnt(10) lgkmcnt(4)
v_mfma_f32_16x16x32_bf16 v[132:135], a[112:115], a[32:35], v[132:135]
ds_read_b128 a[96:99], v5 offset:24576
v_mfma_f32_16x16x32_bf16 v[148:151], a[112:115], a[36:39], v[148:151]
ds_read_b128 a[100:103], v5 offset:25600
v_mfma_f32_16x16x32_bf16 v[152:155], a[116:119], a[36:39], v[152:155]
buffer_load_dwordx4 a[24:27], v4, s[40:43], s35 offen offset:0 sc1
v_mfma_f32_16x16x32_bf16 v[136:139], a[116:119], a[32:35], v[136:139]
ds_read_b128 a[104:107], v5 offset:26624
v_mfma_f32_16x16x32_bf16 v[140:143], a[120:123], a[32:35], v[140:143]
ds_read_b128 a[108:111], v5 offset:27648
v_mfma_f32_16x16x32_bf16 v[156:159], a[120:123], a[36:39], v[156:159]
v_mfma_f32_16x16x32_bf16 v[160:163], a[124:127], a[36:39], v[160:163]
buffer_load_dwordx4 a[28:31], v4, s[40:43], s35 offen offset:1024 sc1
s_add_u32 s35, s9, 86016
v_mfma_f32_16x16x32_bf16 v[144:147], a[124:127], a[32:35], v[144:147]
s_waitcnt vmcnt(10) lgkmcnt(4)
v_mfma_f32_16x16x32_bf16 v[132:135], a[128:131], a[40:43], v[132:135]
ds_read_b128 a[112:115], v5 offset:28672
v_mfma_f32_16x16x32_bf16 v[148:151], a[128:131], a[44:47], v[148:151]
ds_read_b128 a[116:119], v5 offset:29696
v_mfma_f32_16x16x32_bf16 v[152:155], a[132:135], a[44:47], v[152:155]
buffer_load_dwordx4 a[32:35], v4, s[40:43], s35 offen offset:0 sc1
v_mfma_f32_16x16x32_bf16 v[136:139], a[132:135], a[40:43], v[136:139]
ds_read_b128 a[120:123], v5 offset:30720
v_mfma_f32_16x16x32_bf16 v[140:143], a[136:139], a[40:43], v[140:143]
ds_read_b128 a[124:127], v5 offset:31744
v_mfma_f32_16x16x32_bf16 v[156:159], a[136:139], a[44:47], v[156:159]
v_mfma_f32_16x16x32_bf16 v[160:163], a[140:143], a[44:47], v[160:163]
buffer_load_dwordx4 a[36:39], v4, s[40:43], s35 offen offset:1024 sc1
s_add_u32 s35, s9, 98304
v_mfma_f32_16x16x32_bf16 v[144:147], a[140:143], a[40:43], v[144:147]
s_waitcnt vmcnt(10) lgkmcnt(4)
v_mfma_f32_16x16x32_bf16 v[132:135], a[96:99], a[48:51], v[132:135]
ds_read_b128 a[128:131], v5 offset:32768
v_mfma_f32_16x16x32_bf16 v[148:151], a[96:99], a[52:55], v[148:151]
ds_read_b128 a[132:135], v5 offset:33792
v_mfma_f32_16x16x32_bf16 v[152:155], a[100:103], a[52:55], v[152:155]
buffer_load_dwordx4 a[40:43], v4, s[40:43], s35 offen offset:0 sc1
v_mfma_f32_16x16x32_bf16 v[136:139], a[100:103], a[48:51], v[136:139]
ds_read_b128 a[136:139], v5 offset:34816
v_mfma_f32_16x16x32_bf16 v[140:143], a[104:107], a[48:51], v[140:143]
ds_read_b128 a[140:143], v5 offset:35840
v_mfma_f32_16x16x32_bf16 v[156:159], a[104:107], a[52:55], v[156:159]
v_mfma_f32_16x16x32_bf16 v[160:163], a[108:111], a[52:55], v[160:163]
buffer_load_dwordx4 a[44:47], v4, s[40:43], s35 offen offset:1024 sc1
s_add_u32 s35, s9, 102400
v_mfma_f32_16x16x32_bf16 v[144:147], a[108:111], a[48:51], v[144:147]
s_waitcnt vmcnt(10) lgkmcnt(4)
v_mfma_f32_16x16x32_bf16 v[132:135], a[112:115], a[0:3], v[132:135]
ds_read_b128 a[96:99], v5 offset:36864
v_mfma_f32_16x16x32_bf16 v[148:151], a[112:115], a[4:7], v[148:151]
ds_read_b128 a[100:103], v5 offset:37888
v_mfma_f32_16x16x32_bf16 v[152:155], a[116:119], a[4:7], v[152:155]
buffer_load_dwordx4 a[48:51], v4, s[40:43], s35 offen offset:0 sc1
v_mfma_f32_16x16x32_bf16 v[136:139], a[116:119], a[0:3], v[136:139]
ds_read_b128 a[104:107], v5 offset:38912
v_mfma_f32_16x16x32_bf16 v[140:143], a[120:123], a[0:3], v[140:143]
ds_read_b128 a[108:111], v5 offset:39936
v_mfma_f32_16x16x32_bf16 v[156:159], a[120:123], a[4:7], v[156:159]
v_mfma_f32_16x16x32_bf16 v[160:163], a[124:127], a[4:7], v[160:163]
buffer_load_dwordx4 a[52:55], v4, s[40:43], s35 offen offset:1024 sc1
s_add_u32 s35, s9, 114688
v_mfma_f32_16x16x32_bf16 v[144:147], a[124:127], a[0:3], v[144:147]
s_waitcnt vmcnt(10) lgkmcnt(4)
v_mfma_f32_16x16x32_bf16 v[132:135], a[128:131], a[8:11], v[132:135]
ds_read_b128 a[112:115], v5 offset:40960
v_mfma_f32_16x16x32_bf16 v[148:151], a[128:131], a[12:15], v[148:151]
ds_read_b128 a[116:119], v5 offset:41984
v_mfma_f32_16x16x32_bf16 v[152:155], a[132:135], a[12:15], v[152:155]
buffer_load_dwordx4 a[0:3], v4, s[40:43], s35 offen offset:0 sc1
L_stub9:
s_cbranch_execz L_wret3
v_mfma_f32_16x16x32_bf16 v[136:139], a[132:135], a[8:11], v[136:139]
ds_read_b128 a[120:123], v5 offset:43008
v_mfma_f32_16x16x32_bf16 v[140:143], a[136:139], a[8:11], v[140:143]
ds_read_b128 a[124:127], v5 offset:44032
v_mfma_f32_16x16x32_bf16 v[156:159], a[136:139], a[12:15], v[156:159]
v_mfma_f32_16x16x32_bf16 v[160:163], a[140:143], a[12:15], v[160:163]
buffer_load_dwordx4 a[4:7], v4, s[40:43], s35 offen offset:1024 sc1
s_add_u32 s35, s9, 118784
v_mfma_f32_16x16x32_bf16 v[144:147], a[140:143], a[8:11], v[144:147]
s_waitcnt vmcnt(10) lgkmcnt(4)
v_mfma_f32_16x16x32_bf16 v[132:135], a[96:99], a[16:19], v[132:135]
ds_read_b128 a[128:131], v5 offset:45056
v_mfma_f32_16x16x32_bf16 v[148:151], a[96:99], a[20:23], v[148:151]
ds_read_b128 a[132:135], v5 offset:46080
v_mfma_f32_16x16x32_bf16 v[152:155], a[100:103], a[20:23], v[152:155]
buffer_load_dwordx4 a[8:11], v4, s[40:43], s35 offen offset:0 sc1
v_mfma_f32_16x16x32_bf16 v[136:139], a[100:103], a[16:19], v[136:139]
ds_read_b128 a[136:139], v5 offset:47104
v_mfma_f32_16x16x32_bf16 v[140:143], a[104:107], a[16:19], v[140:143]
ds_read_b128 a[140:143], v5 offset:48128
v_mfma_f32_16x16x32_bf16 v[156:159], a[104:107], a[20:23], v[156:159]
v_mfma_f32_16x16x32_bf16 v[160:163], a[108:111], a[20:23], v[160:163]
buffer_load_dwordx4 a[12:15], v4, s[40:43], s35 offen offset:1024 sc1
s_add_u32 s35, s9, 524288
v_mfma_f32_16x16x32_bf16 v[144:147], a[108:111], a[16:19], v[144:147]
s_waitcnt vmcnt(10) lgkmcnt(4)
v_mfma_f32_16x16x32_bf16 v[132:135], a[112:115], a[24:27], v[132:135]
ds_read_b128 a[96:99], v5 offset:49152
v_mfma_f32_16x16x32_bf16 v[148:151], a[112:115], a[28:31], v[148:151]
ds_read_b128 a[100:103], v5 offset:50176
v_mfma_f32_16x16x32_bf16 v[152:155], a[116:119], a[28:31], v[152:155]
buffer_load_dwordx4 a[16:19], v4, s[40:43], s35 offen offset:0 sc1
v_mfma_f32_16x16x32_bf16 v[136:139], a[116:119], a[24:27], v[136:139]
ds_read_b128 a[104:107], v5 offset:51200
v_mfma_f32_16x16x32_bf16 v[140:143], a[120:123], a[24:27], v[140:143]
ds_read_b128 a[108:111], v5 offset:52224
v_mfma_f32_16x16x32_bf16 v[156:159], a[120:123], a[28:31], v[156:159]
v_mfma_f32_16x16x32_bf16 v[160:163], a[124:127], a[28:31], v[160:163]
buffer_load_dwordx4 a[20:23], v4, s[40:43], s35 offen offset:1024 sc1
s_add_u32 s35, s9, 528384
v_mfma_f32_16x16x32_bf16 v[144:147], a[124:127], a[24:27], v[144:147]
s_waitcnt vmcnt(10) lgkmcnt(4)
v_mfma_f32_16x16x32_bf16 v[132:135], a[128:131], a[32:35], v[132:135]
ds_read_b128 a[112:115], v5 offset:53248
v_mfma_f32_16x16x32_bf16 v[148:151], a[128:131], a[36:39], v[148:151]
ds_read_b128 a[116:119], v5 offset:54272
v_mfma_f32_16x16x32_bf16 v[152:155], a[132:135], a[36:39], v[152:155]
buffer_load_dwordx4 a[24:27], v4, s[40:43], s35 offen offset:0 sc1
v_mfma_f32_16x16x32_bf16 v[136:139], a[132:135], a[32:35], v[136:139]
ds_read_b128 a[120:123], v5 offset:55296
v_mfma_f32_16x16x32_bf16 v[140:143], a[136:139], a[32:35], v[140:143]
ds_read_b128 a[124:127], v5 offset:56320
v_mfma_f32_16x16x32_bf16 v[156:159], a[136:139], a[36:39], v[156:159]
v_mfma_f32_16x16x32_bf16 v[160:163], a[140:143], a[36:39], v[160:163]
buffer_load_dwordx4 a[28:31], v4, s[40:43], s35 offen offset:1024 sc1
s_add_u32 s35, s9, 540672
v_mfma_f32_16x16x32_bf16 v[144:147], a[140:143], a[32:35], v[144:147]
s_waitcnt vmcnt(10) lgkmcnt(4)
v_mfma_f32_16x16x32_bf16 v[132:135], a[96:99], a[40:43], v[132:135]
ds_read_b128 a[128:131], v5 offset:57344
v_mfma_f32_16x16x32_bf16 v[148:151], a[96:99], a[44:47], v[148:151]
ds_read_b128 a[132:135], v5 offset:58368
v_mfma_f32_16x16x32_bf16 v[152:155], a[100:103], a[44:47], v[152:155]
buffer_load_dwordx4 a[32:35], v4, s[40:43], s35 offen offset:0 sc1
v_mfma_f32_16x16x32_bf16 v[136:139], a[100:103], a[40:43], v[136:139]
ds_read_b128 a[136:139], v5 offset:59392
v_mfma_f32_16x16x32_bf16 v[140:143], a[104:107], a[40:43], v[140:143]
ds_read_b128 a[140:143], v5 offset:60416
v_mfma_f32_16x16x32_bf16 v[156:159], a[104:107], a[44:47], v[156:159]
v_mfma_f32_16x16x32_bf16 v[160:163], a[108:111], a[44:47], v[160:163]
buffer_load_dwordx4 a[36:39], v4, s[40:43], s35 offen offset:1024 sc1
s_add_u32 s35, s9, 544768
v_mfma_f32_16x16x32_bf16 v[144:147], a[108:111], a[40:43], v[144:147]
s_waitcnt vmcnt(10) lgkmcnt(4)
v_mfma_f32_16x16x32_bf16 v[132:135], a[112:115], a[48:51], v[132:135]
ds_read_b128 a[96:99], v5 offset:61440
v_mfma_f32_16x16x32_bf16 v[148:151], a[112:115], a[52:55], v[148:151]
ds_read_b128 a[100:103], v5 offset:62464
v_mfma_f32_16x16x32_bf16 v[152:155], a[116:119], a[52:55], v[152:155]
buffer_load_dwordx4 a[40:43], v4, s[40:43], s35 offen offset:0 sc1
v_mfma_f32_16x16x32_bf16 v[136:139], a[116:119], a[48:51], v[136:139]
ds_read_b128 a[104:107], v5 offset:63488
v_mfma_f32_16x16x32_bf16 v[140:143], a[120:123], a[48:51], v[140:143]
ds_read_b128 a[108:111], v5 offset:64512
v_mfma_f32_16x16x32_bf16 v[156:159], a[120:123], a[52:55], v[156:159]
v_mfma_f32_16x16x32_bf16 v[160:163], a[124:127], a[52:55], v[160:163]
buffer_load_dwordx4 a[44:47], v4, s[40:43], s35 offen offset:1024 sc1
s_add_u32 s35, s9, 557056
v_mfma_f32_16x16x32_bf16 v[144:147], a[124:127], a[48:51], v[144:147]
s_waitcnt vmcnt(10) lgkmcnt(4)
v_mfma_f32_16x16x32_bf16 v[132:135], a[128:131], a[0:3], v[132:135]
ds_read_b128 a[112:115], v6 offset:0
v_mfma_f32_16x16x32_bf16 v[148:151], a[128:131], a[4:7], v[148:151]
ds_read_b128 a[116:119], v6 offset:1024
v_mfma_f32_16x16x32_bf16 v[152:155], a[132:135], a[4:7], v[152:155]
buffer_load_dwordx4 a[48:51], v4, s[40:43], s35 offen offset:0 sc1
v_mfma_f32_16x16x32_bf16 v[136:139], a[132:135], a[0:3], v[136:139]
ds_read_b128 a[120:123], v6 offset:2048
v_mfma_f32_16x16x32_bf16 v[140:143], a[136:139], a[0:3], v[140:143]
ds_read_b128 a[124:127], v6 offset:3072
v_mfma_f32_16x16x32_bf16 v[156:159], a[136:139], a[4:7], v[156:159]
v_mfma_f32_16x16x32_bf16 v[160:163], a[140:143], a[4:7], v[160:163]
buffer_load_dwordx4 a[52:55], v4, s[40:43], s35 offen offset:1024 sc1
s_add_u32 s35, s9, 561152
v_mfma_f32_16x16x32_bf16 v[144:147], a[140:143], a[0:3], v[144:147]
s_waitcnt vmcnt(10) lgkmcnt(4)
v_mfma_f32_16x16x32_bf16 v[132:135], a[96:99], a[8:11], v[132:135]
ds_read_b128 a[128:131], v6 offset:4096
v_mfma_f32_16x16x32_bf16 v[148:151], a[96:99], a[12:15], v[148:151]
ds_read_b128 a[132:135], v6 offset:5120
v_mfma_f32_16x16x32_bf16 v[152:155], a[100:103], a[12:15], v[152:155]
buffer_load_dwordx4 a[0:3], v4, s[40:43], s35 offen offset:0 sc1
v_mfma_f32_16x16x32_bf16 v[136:139], a[100:103], a[8:11], v[136:139]
ds_read_b128 a[136:139], v6 offset:6144
v_mfma_f32_16x16x32_bf16 v[140:143], a[104:107], a[8:11], v[140:143]
ds_read_b128 a[140:143], v6 offset:7168
v_mfma_f32_16x16x32_bf16 v[156:159], a[104:107], a[12:15], v[156:159]
v_mfma_f32_16x16x32_bf16 v[160:163], a[108:111], a[12:15], v[160:163]
buffer_load_dwordx4 a[4:7], v4, s[40:43], s35 offen offset:1024 sc1
s_add_u32 s35, s9, 573440
v_mfma_f32_16x16x32_bf16 v[144:147], a[108:111], a[8:11], v[144:147]
s_waitcnt vmcnt(10) lgkmcnt(4)
v_mfma_f32_16x16x32_bf16 v[132:135], a[112:115], a[16:19], v[132:135]
ds_read_b128 a[96:99], v6 offset:8192
v_mfma_f32_16x16x32_bf16 v[148:151], a[112:115], a[20:23], v[148:151]
ds_read_b128 a[100:103], v6 offset:9216
v_mfma_f32_16x16x32_bf16 v[152:155], a[116:119], a[20:23], v[152:155]
buffer_load_dwordx4 a[8:11], v4, s[40:43], s35 offen offset:0 sc1
v_mfma_f32_16x16x32_bf16 v[136:139], a[116:119], a[16:19], v[136:139]
ds_read_b128 a[104:107], v6 offset:10240
v_mfma_f32_16x16x32_bf16 v[140:143], a[120:123], a[16:19], v[140:143]
ds_read_b128 a[108:111], v6 offset:11264
v_mfma_f32_16x16x32_bf16 v[156:159], a[120:123], a[20:23], v[156:159]
v_mfma_f32_16x16x32_bf16 v[160:163], a[124:127], a[20:23], v[160:163]
buffer_load_dwordx4 a[12:15], v4, s[40:43], s35 offen offset:1024 sc1
s_add_u32 s35, s9, 577536
v_mfma_f32_16x16x32_bf16 v[144:147], a[124:127], a[16:19], v[144:147]
s_waitcnt vmcnt(10) lgkmcnt(4)
v_mfma_f32_16x16x32_bf16 v[132:135], a[128:131], a[24:27], v[132:135]
ds_read_b128 a[112:115], v6 offset:12288
v_mfma_f32_16x16x32_bf16 v[148:151], a[128:131], a[28:31], v[148:151]
ds_read_b128 a[116:119], v6 offset:13312
v_mfma_f32_16x16x32_bf16 v[152:155], a[132:135], a[28:31], v[152:155]
buffer_load_dwordx4 a[16:19], v4, s[40:43], s35 offen offset:0 sc1
v_mfma_f32_16x16x32_bf16 v[136:139], a[132:135], a[24:27], v[136:139]
ds_read_b128 a[120:123], v6 offset:14336
v_mfma_f32_16x16x32_bf16 v[140:143], a[136:139], a[24:27], v[140:143]
ds_read_b128 a[124:127], v6 offset:15360
v_mfma_f32_16x16x32_bf16 v[156:159], a[136:139], a[28:31], v[156:159]
v_mfma_f32_16x16x32_bf16 v[160:163], a[140:143], a[28:31], v[160:163]
buffer_load_dwordx4 a[20:23], v4, s[40:43], s35 offen offset:1024 sc1
s_add_u32 s35, s9, 589824
v_mfma_f32_16x16x32_bf16 v[144:147], a[140:143], a[24:27], v[144:147]
s_waitcnt vmcnt(10) lgkmcnt(4)
v_mfma_f32_16x16x32_bf16 v[132:135], a[96:99], a[32:35], v[132:135]
ds_read_b128 a[128:131], v6 offset:16384
v_mfma_f32_16x16x32_bf16 v[148:151], a[96:99], a[36:39], v[148:151]
ds_read_b128 a[132:135], v6 offset:17408
v_mfma_f32_16x16x32_bf16 v[152:155], a[100:103], a[36:39], v[152:155]
buffer_load_dwordx4 a[24:27], v4, s[40:43], s35 offen offset:0 sc1
v_mfma_f32_16x16x32_bf16 v[136:139], a[100:103], a[32:35], v[136:139]
ds_read_b128 a[136:139], v6 offset:18432
v_mfma_f32_16x16x32_bf16 v[140:143], a[104:107], a[32:35], v[140:143]
ds_read_b128 a[140:143], v6 offset:19456
v_mfma_f32_16x16x32_bf16 v[156:159], a[104:107], a[36:39], v[156:159]
v_mfma_f32_16x16x32_bf16 v[160:163], a[108:111], a[36:39], v[160:163]
buffer_load_dwordx4 a[28:31], v4, s[40:43], s35 offen offset:1024 sc1
s_add_u32 s35, s9, 593920
v_mfma_f32_16x16x32_bf16 v[144:147], a[108:111], a[32:35], v[144:147]
s_waitcnt vmcnt(10) lgkmcnt(4)
v_mfma_f32_16x16x32_bf16 v[132:135], a[112:115], a[40:43], v[132:135]
ds_read_b128 a[96:99], v6 offset:20480
v_mfma_f32_16x16x32_bf16 v[148:151], a[112:115], a[44:47], v[148:151]
ds_read_b128 a[100:103], v6 offset:21504
v_mfma_f32_16x16x32_bf16 v[152:155], a[116:119], a[44:47], v[152:155]
buffer_load_dwordx4 a[32:35], v4, s[40:43], s35 offen offset:0 sc1
v_mfma_f32_16x16x32_bf16 v[136:139], a[116:119], a[40:43], v[136:139]
ds_read_b128 a[104:107], v6 offset:22528
v_mfma_f32_16x16x32_bf16 v[140:143], a[120:123], a[40:43], v[140:143]
ds_read_b128 a[108:111], v6 offset:23552
v_mfma_f32_16x16x32_bf16 v[156:159], a[120:123], a[44:47], v[156:159]
v_mfma_f32_16x16x32_bf16 v[160:163], a[124:127], a[44:47], v[160:163]
buffer_load_dwordx4 a[36:39], v4, s[40:43], s35 offen offset:1024 sc1
s_add_u32 s35, s9, 606208
v_mfma_f32_16x16x32_bf16 v[144:147], a[124:127], a[40:43], v[144:147]
s_waitcnt vmcnt(10) lgkmcnt(4)
v_mfma_f32_16x16x32_bf16 v[132:135], a[128:131], a[48:51], v[132:135]
ds_read_b128 a[112:115], v6 offset:24576
v_mfma_f32_16x16x32_bf16 v[148:151], a[128:131], a[52:55], v[148:151]
ds_read_b128 a[116:119], v6 offset:25600
v_mfma_f32_16x16x32_bf16 v[152:155], a[132:135], a[52:55], v[152:155]
buffer_load_dwordx4 a[40:43], v4, s[40:43], s35 offen offset:0 sc1
v_mfma_f32_16x16x32_bf16 v[136:139], a[132:135], a[48:51], v[136:139]
ds_read_b128 a[120:123], v6 offset:26624
v_mfma_f32_16x16x32_bf16 v[140:143], a[136:139], a[48:51], v[140:143]
ds_read_b128 a[124:127], v6 offset:27648
v_mfma_f32_16x16x32_bf16 v[156:159], a[136:139], a[52:55], v[156:159]
v_mfma_f32_16x16x32_bf16 v[160:163], a[140:143], a[52:55], v[160:163]
buffer_load_dwordx4 a[44:47], v4, s[40:43], s35 offen offset:1024 sc1
s_add_u32 s35, s9, 610304
v_mfma_f32_16x16x32_bf16 v[144:147], a[140:143], a[48:51], v[144:147]
s_waitcnt vmcnt(10) lgkmcnt(4)
v_mfma_f32_16x16x32_bf16 v[132:135], a[96:99], a[0:3], v[132:135]
ds_read_b128 a[128:131], v6 offset:28672
v_mfma_f32_16x16x32_bf16 v[148:151], a[96:99], a[4:7], v[148:151]
ds_read_b128 a[132:135], v6 offset:29696
v_mfma_f32_16x16x32_bf16 v[152:155], a[100:103], a[4:7], v[152:155]
buffer_load_dwordx4 a[48:51], v4, s[40:43], s35 offen offset:0 sc1
v_mfma_f32_16x16x32_bf16 v[136:139], a[100:103], a[0:3], v[136:139]
ds_read_b128 a[136:139], v6 offset:30720
v_mfma_f32_16x16x32_bf16 v[140:143], a[104:107], a[0:3], v[140:143]
ds_read_b128 a[140:143], v6 offset:31744
v_mfma_f32_16x16x32_bf16 v[156:159], a[104:107], a[4:7], v[156:159]
v_mfma_f32_16x16x32_bf16 v[160:163], a[108:111], a[4:7], v[160:163]
buffer_load_dwordx4 a[52:55], v4, s[40:43], s35 offen offset:1024 sc1
s_add_u32 s35, s9, 622592
v_mfma_f32_16x16x32_bf16 v[144:147], a[108:111], a[0:3], v[144:147]
s_waitcnt vmcnt(10) lgkmcnt(4)
v_mfma_f32_16x16x32_bf16 v[132:135], a[112:115], a[8:11], v[132:135]
ds_read_b128 a[96:99], v6 offset:32768
v_mfma_f32_16x16x32_bf16 v[148:151], a[112:115], a[12:15], v[148:151]
ds_read_b128 a[100:103], v6 offset:33792
v_mfma_f32_16x16x32_bf16 v[152:155], a[116:119], a[12:15], v[152:155]
buffer_load_dwordx4 a[0:3], v4, s[40:43], s35 offen offset:0 sc1
v_mfma_f32_16x16x32_bf16 v[136:139], a[116:119], a[8:11], v[136:139]
ds_read_b128 a[104:107], v6 offset:34816
v_mfma_f32_16x16x32_bf16 v[140:143], a[120:123], a[8:11], v[140:143]
ds_read_b128 a[108:111], v6 offset:35840
v_mfma_f32_16x16x32_bf16 v[156:159], a[120:123], a[12:15], v[156:159]
v_mfma_f32_16x16x32_bf16 v[160:163], a[124:127], a[12:15], v[160:163]
buffer_load_dwordx4 a[4:7], v4, s[40:43], s35 offen offset:1024 sc1
s_add_u32 s35, s9, 626688
v_mfma_f32_16x16x32_bf16 v[144:147], a[124:127], a[8:11], v[144:147]
s_waitcnt vmcnt(10) lgkmcnt(4)
v_mfma_f32_16x16x32_bf16 v[132:135], a[128:131], a[16:19], v[132:135]
ds_read_b128 a[112:115], v6 offset:36864
v_mfma_f32_16x16x32_bf16 v[148:151], a[128:131], a[20:23], v[148:151]
ds_read_b128 a[116:119], v6 offset:37888
v_mfma_f32_16x16x32_bf16 v[152:155], a[132:135], a[20:23], v[152:155]
buffer_load_dwordx4 a[8:11], v4, s[40:43], s35 offen offset:0 sc1
v_mfma_f32_16x16x32_bf16 v[136:139], a[132:135], a[16:19], v[136:139]
ds_read_b128 a[120:123], v6 offset:38912
v_mfma_f32_16x16x32_bf16 v[140:143], a[136:139], a[16:19], v[140:143]
ds_read_b128 a[124:127], v6 offset:39936
v_mfma_f32_16x16x32_bf16 v[156:159], a[136:139], a[20:23], v[156:159]
v_mfma_f32_16x16x32_bf16 v[160:163], a[140:143], a[20:23], v[160:163]
buffer_load_dwordx4 a[12:15], v4, s[40:43], s35 offen offset:1024 sc1
s_add_u32 s35, s9, 638976
v_mfma_f32_16x16x32_bf16 v[144:147], a[140:143], a[16:19], v[144:147]
s_waitcnt vmcnt(10) lgkmcnt(4)
v_mfma_f32_16x16x32_bf16 v[132:135], a[96:99], a[24:27], v[132:135]
ds_read_b128 a[128:131], v6 offset:40960
v_mfma_f32_16x16x32_bf16 v[148:151], a[96:99], a[28:31], v[148:151]
ds_read_b128 a[132:135], v6 offset:41984
v_mfma_f32_16x16x32_bf16 v[152:155], a[100:103], a[28:31], v[152:155]
buffer_load_dwordx4 a[16:19], v4, s[40:43], s35 offen offset:0 sc1
v_mfma_f32_16x16x32_bf16 v[136:139], a[100:103], a[24:27], v[136:139]
ds_read_b128 a[136:139], v6 offset:43008
v_mfma_f32_16x16x32_bf16 v[140:143], a[104:107], a[24:27], v[140:143]
ds_read_b128 a[140:143], v6 offset:44032
v_mfma_f32_16x16x32_bf16 v[156:159], a[104:107], a[28:31], v[156:159]
v_mfma_f32_16x16x32_bf16 v[160:163], a[108:111], a[28:31], v[160:163]
buffer_load_dwordx4 a[20:23], v4, s[40:43], s35 offen offset:1024 sc1
s_add_u32 s35, s9, 643072
v_mfma_f32_16x16x32_bf16 v[144:147], a[108:111], a[24:27], v[144:147]
s_waitcnt vmcnt(10) lgkmcnt(4)
v_mfma_f32_16x16x32_bf16 v[132:135], a[112:115], a[32:35], v[132:135]
ds_read_b128 a[96:99], v6 offset:45056
v_mfma_f32_16x16x32_bf16 v[148:151], a[112:115], a[36:39], v[148:151]
ds_read_b128 a[100:103], v6 offset:46080
v_mfma_f32_16x16x32_bf16 v[152:155], a[116:119], a[36:39], v[152:155]
buffer_load_dwordx4 a[24:27], v4, s[40:43], s35 offen offset:0 sc1
v_mfma_f32_16x16x32_bf16 v[136:139], a[116:119], a[32:35], v[136:139]
ds_read_b128 a[104:107], v6 offset:47104
v_mfma_f32_16x16x32_bf16 v[140:143], a[120:123], a[32:35], v[140:143]
ds_read_b128 a[108:111], v6 offset:48128
v_mfma_f32_16x16x32_bf16 v[156:159], a[120:123], a[36:39], v[156:159]
v_mfma_f32_16x16x32_bf16 v[160:163], a[124:127], a[36:39], v[160:163]
buffer_load_dwordx4 a[28:31], v4, s[40:43], s35 offen offset:1024 sc1
s_add_u32 s35, s9, 1048576
v_mfma_f32_16x16x32_bf16 v[144:147], a[124:127], a[32:35], v[144:147]
s_waitcnt vmcnt(10) lgkmcnt(4)
v_mfma_f32_16x16x32_bf16 v[132:135], a[128:131], a[40:43], v[132:135]
s_add_u32 m0, s18, 0x0
s_add_u32 s44, s50, 0x2000000
v_mfma_f32_16x16x32_bf16 v[148:151], a[128:131], a[44:47], v[148:151]
ds_read_b128 a[112:115], v6 offset:49152
v_mfma_f32_16x16x32_bf16 v[152:155], a[132:135], a[44:47], v[152:155]
buffer_load_dwordx4 v1, s[4:7], s44 offen offset:0 sc1 lds
v_mfma_f32_16x16x32_bf16 v[136:139], a[132:135], a[40:43], v[136:139]
ds_read_b128 a[116:119], v6 offset:50176
v_mfma_f32_16x16x32_bf16 v[140:143], a[136:139], a[40:43], v[140:143]
ds_read_b128 a[120:123], v6 offset:51200
v_mfma_f32_16x16x32_bf16 v[156:159], a[136:139], a[44:47], v[156:159]
ds_read_b128 a[124:127], v6 offset:52224
v_mfma_f32_16x16x32_bf16 v[160:163], a[140:143], a[44:47], v[160:163]
buffer_load_dwordx4 v1, s[4:7], s44 offen offset:1024 sc1 lds
s_add_u32 m0, s18, 0x2000
v_mfma_f32_16x16x32_bf16 v[144:147], a[140:143], a[40:43], v[144:147]
s_add_u32 s44, s50, 0x2002000
s_waitcnt vmcnt(10) lgkmcnt(4)
v_mfma_f32_16x16x32_bf16 v[132:135], a[96:99], a[48:51], v[132:135]
ds_read_b128 a[128:131], v6 offset:53248
v_mfma_f32_16x16x32_bf16 v[148:151], a[96:99], a[52:55], v[148:151]
ds_read_b128 a[132:135], v6 offset:54272
v_mfma_f32_16x16x32_bf16 v[152:155], a[100:103], a[52:55], v[152:155]
buffer_load_dwordx4 v1, s[4:7], s44 offen offset:0 sc1 lds
v_mfma_f32_16x16x32_bf16 v[136:139], a[100:103], a[48:51], v[136:139]
ds_read_b128 a[136:139], v6 offset:55296
v_mfma_f32_16x16x32_bf16 v[140:143], a[104:107], a[48:51], v[140:143]
ds_read_b128 a[140:143], v6 offset:56320
v_mfma_f32_16x16x32_bf16 v[156:159], a[104:107], a[52:55], v[156:159]
v_mfma_f32_16x16x32_bf16 v[160:163], a[108:111], a[52:55], v[160:163]
buffer_load_dwordx4 v1, s[4:7], s44 offen offset:1024 sc1 lds
s_add_u32 m0, s18, 0x4000
v_mfma_f32_16x16x32_bf16 v[144:147], a[108:111], a[48:51], v[144:147]
s_add_u32 s44, s50, 0x2004000
s_waitcnt vmcnt(10) lgkmcnt(4)
v_mfma_f32_16x16x32_bf16 v[132:135], a[112:115], a[0:3], v[132:135]
ds_read_b128 a[96:99], v6 offset:57344
v_mfma_f32_16x16x32_bf16 v[148:151], a[112:115], a[4:7], v[148:151]
ds_read_b128 a[100:103], v6 offset:58368
v_mfma_f32_16x16x32_bf16 v[152:155], a[116:119], a[4:7], v[152:155]
ds_read_b128 a[104:107], v6 offset:59392
v_mfma_f32_16x16x32_bf16 v[136:139], a[116:119], a[0:3], v[136:139]
buffer_load_dwordx4 v1, s[4:7], s44 offen offset:0 sc1 lds
v_mfma_f32_16x16x32_bf16 v[140:143], a[120:123], a[0:3], v[140:143]
ds_read_b128 a[108:111], v6 offset:60416
v_mfma_f32_16x16x32_bf16 v[156:159], a[120:123], a[4:7], v[156:159]
v_mfma_f32_16x16x32_bf16 v[160:163], a[124:127], a[4:7], v[160:163]
v_mfma_f32_16x16x32_bf16 v[144:147], a[124:127], a[0:3], v[144:147]
buffer_load_dwordx4 v1, s[4:7], s44 offen offset:1024 sc1 lds
s_waitcnt vmcnt(10) lgkmcnt(4)
v_mfma_f32_16x16x32_bf16 v[132:135], a[128:131], a[8:11], v[132:135]
s_add_u32 m0, s18, 0x6000
s_add_u32 s44, s50, 0x2006000
v_mfma_f32_16x16x32_bf16 v[148:151], a[128:131], a[12:15], v[148:151]
ds_read_b128 a[112:115], v6 offset:61440
v_mfma_f32_16x16x32_bf16 v[152:155], a[132:135], a[12:15], v[152:155]
ds_read_b128 a[116:119], v6 offset:62464
v_mfma_f32_16x16x32_bf16 v[136:139], a[132:135], a[8:11], v[136:139]
ds_read_b128 a[120:123], v6 offset:63488
v_mfma_f32_16x16x32_bf16 v[140:143], a[136:139], a[8:11], v[140:143]
buffer_load_dwordx4 v1, s[4:7], s44 offen offset:0 sc1 lds
v_mfma_f32_16x16x32_bf16 v[156:159], a[136:139], a[12:15], v[156:159]
ds_read_b128 a[124:127], v6 offset:64512
v_mfma_f32_16x16x32_bf16 v[160:163], a[140:143], a[12:15], v[160:163]
v_mfma_f32_16x16x32_bf16 v[144:147], a[140:143], a[8:11], v[144:147]
s_waitcnt vmcnt(9) lgkmcnt(4)
v_mfma_f32_16x16x32_bf16 v[132:135], a[96:99], a[16:19], v[132:135]
v_mfma_f32_16x16x32_bf16 v[148:151], a[96:99], a[20:23], v[148:151]
buffer_load_dwordx4 v1, s[4:7], s44 offen offset:1024 sc1 lds
v_mfma_f32_16x16x32_bf16 v[152:155], a[100:103], a[20:23], v[152:155]
v_mfma_f32_16x16x32_bf16 v[136:139], a[100:103], a[16:19], v[136:139]
v_mfma_f32_16x16x32_bf16 v[140:143], a[104:107], a[16:19], v[140:143]
v_mfma_f32_16x16x32_bf16 v[156:159], a[104:107], a[20:23], v[156:159]
v_mfma_f32_16x16x32_bf16 v[160:163], a[108:111], a[20:23], v[160:163]
v_mfma_f32_16x16x32_bf16 v[144:147], a[108:111], a[16:19], v[144:147]
s_waitcnt vmcnt(8) lgkmcnt(0)
v_mfma_f32_16x16x32_bf16 v[132:135], a[112:115], a[24:27], v[132:135]
v_mfma_f32_16x16x32_bf16 v[148:151], a[112:115], a[28:31], v[148:151]
v_mfma_f32_16x16x32_bf16 v[152:155], a[116:119], a[28:31], v[152:155]
v_mfma_f32_16x16x32_bf16 v[136:139], a[116:119], a[24:27], v[136:139]
v_mfma_f32_16x16x32_bf16 v[140:143], a[120:123], a[24:27], v[140:143]
v_mfma_f32_16x16x32_bf16 v[156:159], a[120:123], a[28:31], v[156:159]
v_mfma_f32_16x16x32_bf16 v[160:163], a[124:127], a[28:31], v[160:163]
v_mfma_f32_16x16x32_bf16 v[144:147], a[124:127], a[24:27], v[144:147]
s_nop 1
v_cmp_u_f32 vcc, v132, v148
s_nop 0
s_and_b32 vcc_lo, vcc_lo, s95
s_cbranch_scc1 L_k2redo1
v_cvt_pk_bf16_f32 v32, v132, v133
v_cvt_pk_bf16_f32 v33, v134, v135
v_cvt_pk_bf16_f32 v34, v136, v137
v_cvt_pk_bf16_f32 v35, v138, v139
s_add_u32 s36, s45, 0x1000000
buffer_store_dwordx4 v[32:35], v4, s[4:7], s36 offen offset:0 sc1
v_cvt_pk_bf16_f32 v40, v148, v149
v_cvt_pk_bf16_f32 v41, v150, v151
v_cvt_pk_bf16_f32 v42, v152, v153
v_cvt_pk_bf16_f32 v43, v154, v155
v_cvt_pk_bf16_f32 v36, v140, v141
v_cvt_pk_bf16_f32 v37, v142, v143
v_cvt_pk_bf16_f32 v38, v144, v145
v_cvt_pk_bf16_f32 v39, v146, v147
s_add_u32 s37, s36, 4096
v_cvt_pk_bf16_f32 v44, v156, v157
v_cvt_pk_bf16_f32 v45, v158, v159
v_cvt_pk_bf16_f32 v46, v160, v161
buffer_store_dwordx4 v[40:43], v4, s[4:7], s36 offen offset:1024 sc1
v_cvt_pk_bf16_f32 v47, v162, v163
v_mfma_f32_16x16x32_bf16 v[96:99], v[32:35], v[32:35], 0
s_mov_b32 s38, 0x340000
s_add_u32 s92, s78, 0x50000
v_mfma_f32_16x16x32_bf16 v[92:95], v[16:19], v[32:35], 0
s_add_u32 s40, s4, 0x1000000
s_addc_u32 s41, s5, 0
v_mfma_f32_16x16x32_bf16 v[96:99], v[36:39], v[36:39], v[96:99]
buffer_store_dwordx4 v[36:39], v4, s[4:7], s37 offen offset:0 sc1
v_mfma_f32_16x16x32_bf16 v[92:95], v[16:19], v[36:39], v[92:95]
s_nop 5
v_cndmask_b32 v96, v96, v97, s[46:47]
v_cndmask_b32 v98, v98, v99, s[46:47]
v_mfma_f32_16x16x32_bf16 v[104:107], v[40:43], v[40:43], 0
v_mfma_f32_16x16x32_bf16 v[100:103], v[16:19], v[40:43], 0
v_cndmask_b32 v93, v96, v98, s[48:49]
buffer_store_dwordx4 v[44:47], v4, s[4:7], s37 offen offset:1024 sc1
v_mfma_f32_16x16x32_bf16 v[104:107], v[44:47], v[44:47], v[104:107]
v_mfma_f32_16x16x32_bf16 v[100:103], v[16:19], v[44:47], v[100:103]
s_nop 6
v_cndmask_b32 v104, v104, v105, s[46:47]
v_cndmask_b32 v106, v106, v107, s[46:47]
buffer_store_dwordx2 v[92:93], v253, s[4:7], s38 offen offset:0 sc1
v_cndmask_b32 v101, v104, v106, s[48:49]
buffer_store_dwordx2 v[100:101], v253, s[4:7], s38 offen offset:2048 sc1
s_barrier
s_add_u32 m0, s18, 0x8000
s_add_u32 s44, s50, 0x2008000
buffer_load_dwordx4 v1, s[4:7], s44 offen offset:0 sc1 lds
buffer_load_dwordx4 v1, s[4:7], s44 offen offset:1024 sc1 lds
s_add_u32 m0, s18, 0xa000
s_add_u32 s44, s50, 0x200a000
buffer_load_dwordx4 v1, s[4:7], s44 offen offset:0 sc1 lds
buffer_load_dwordx4 v1, s[4:7], s44 offen offset:1024 sc1 lds
v_accvgpr_read_b32 v48, a188
v_accvgpr_read_b32 v49, a189
v_accvgpr_read_b32 v50, a190
v_accvgpr_read_b32 v51, a191
v_accvgpr_read_b32 v52, a192
v_accvgpr_read_b32 v53, a193
v_accvgpr_read_b32 v54, a194
v_accvgpr_read_b32 v55, a195
v_accvgpr_read_b32 v56, a196
v_accvgpr_read_b32 v57, a197
v_accvgpr_read_b32 v58, a198
v_accvgpr_read_b32 v59, a199
v_accvgpr_read_b32 v60, a200
v_accvgpr_read_b32 v61, a201
v_accvgpr_read_b32 v62, a202
v_accvgpr_read_b32 v63, a203
v_accvgpr_read_b32 v64, a204
v_accvgpr_read_b32 v65, a205
v_accvgpr_read_b32 v66, a206
v_accvgpr_read_b32 v67, a207
v_accvgpr_read_b32 v68, a208
v_accvgpr_read_b32 v69, a209
v_accvgpr_read_b32 v70, a210
v_accvgpr_read_b32 v71, a211
s_waitcnt vmcnt(4)
s_barrier
s_cmp_lg_u32 s28, 0
s_cbranch_scc1 Lsg_29
buffer_atomic_add v12, v10, s[4:7], s92 offen sc1
Lsg_29:
s_mov_b64 exec, 0
s_cmp_eq_u32 s28, 0
s_cbranch_scc1 L_stub10
L_wret4:
s_mov_b64 exec, -1
s_cmp_lt_u32 s28, 2
s_cbranch_scc1 Lwd_30
s_add_u32 m0, s19, 0xa000
s_add_u32 s44, s50, 0x200a000
s_add_u32 s44, s44, s18
buffer_load_dwordx4 v1, s[4:7], s44 offen offset:0 sc1 lds
buffer_load_dwordx4 v1, s[4:7], s44 offen offset:1024 sc1 lds
buffer_load_dwordx4 v1, s[4:7], s44 offen offset:2048 sc1 lds
buffer_load_dwordx4 v1, s[4:7], s44 offen offset:3072 sc1 lds
s_add_u32 m0, s19, 0xc000
s_add_u32 s44, s50, 0x200c000
s_add_u32 s44, s44, s18
buffer_load_dwordx4 v1, s[4:7], s44 offen offset:0 sc1 lds
buffer_load_dwordx4 v1, s[4:7], s44 offen offset:1024 sc1 lds
buffer_load_dwordx4 v1, s[4:7], s44 offen offset:2048 sc1 lds
buffer_load_dwordx4 v1, s[4:7], s44 offen offset:3072 sc1 lds
s_add_u32 m0, s19, 0xe000
s_add_u32 s44, s50, 0x200e000
s_add_u32 s44, s44, s18
buffer_load_dwordx4 v1, s[4:7], s44 offen offset:0 sc1 lds
buffer_load_dwordx4 v1, s[4:7], s44 offen offset:1024 sc1 lds
buffer_load_dwordx4 v1, s[4:7], s44 offen offset:2048 sc1 lds
buffer_load_dwordx4 v1, s[4:7], s44 offen offset:3072 sc1 lds
s_add_u32 m0, s19, 0x10000
s_add_u32 s44, s50, 0x2010000
s_add_u32 s44, s44, s18
buffer_load_dwordx4 v1, s[4:7], s44 offen offset:0 sc1 lds
buffer_load_dwordx4 v1, s[4:7], s44 offen offset:1024 sc1 lds
buffer_load_dwordx4 v1, s[4:7], s44 offen offset:2048 sc1 lds
buffer_load_dwordx4 v1, s[4:7], s44 offen offset:3072 sc1 lds
s_add_u32 m0, s19, 0x12000
s_add_u32 s44, s50, 0x2012000
s_add_u32 s44, s44, s18
buffer_load_dwordx4 v1, s[4:7], s44 offen offset:0 sc1 lds
buffer_load_dwordx4 v1, s[4:7], s44 offen offset:1024 sc1 lds
buffer_load_dwordx4 v1, s[4:7], s44 offen offset:2048 sc1 lds
buffer_load_dwordx4 v1, s[4:7], s44 offen offset:3072 sc1 lds
s_add_u32 m0, s19, 0x14000
s_add_u32 s44, s50, 0x2014000
s_add_u32 s44, s44, s18
buffer_load_dwordx4 v1, s[4:7], s44 offen offset:0 sc1 lds
buffer_load_dwordx4 v1, s[4:7], s44 offen offset:1024 sc1 lds
buffer_load_dwordx4 v1, s[4:7], s44 offen offset:2048 sc1 lds
buffer_load_dwordx4 v1, s[4:7], s44 offen offset:3072 sc1 lds
s_add_u32 m0, s19, 0x16000
s_add_u32 s44, s50, 0x2016000
s_add_u32 s44, s44, s18
buffer_load_dwordx4 v1, s[4:7], s44 offen offset:0 sc1 lds
buffer_load_dwordx4 v1, s[4:7], s44 offen offset:1024 sc1 lds
buffer_load_dwordx4 v1, s[4:7], s44 offen offset:2048 sc1 lds
buffer_load_dwordx4 v1, s[4:7], s44 offen offset:3072 sc1 lds
s_add_u32 m0, s19, 0x18000
s_add_u32 s44, s50, 0x2018000
s_add_u32 s44, s44, s18
buffer_load_dwordx4 v1, s[4:7], s44 offen offset:0 sc1 lds
buffer_load_dwordx4 v1, s[4:7], s44 offen offset:1024 sc1 lds
buffer_load_dwordx4 v1, s[4:7], s44 offen offset:2048 sc1 lds
buffer_load_dwordx4 v1, s[4:7], s44 offen offset:3072 sc1 lds
Lwd_30:
s_cmp_lg_u32 s28, 1
s_cbranch_scc1 Lpo_33
s_add_u32 s36, s34, 0x50000
s_mov_b32 s37, 0
v_mov_b32 v11, 0
buffer_atomic_add v11, v251, s[4:7], s36 offen sc0 sc1
s_sleep 4
Lpoll_31:
v_mov_b32 v234, 0
buffer_atomic_add v234, v251, s[4:7], s36 offen sc0 sc1
s_waitcnt vmcnt(1)
v_readfirstlane_b32 s38, v11
s_nop 0
s_cmp_ge_u32 s38, 32
s_cbranch_scc1 Lpe_32
v_mov_b32 v11, 0
buffer_atomic_add v11, v251, s[4:7], s36 offen sc0 sc1
s_waitcnt vmcnt(1)
v_readfirstlane_b32 s38, v234
s_nop 0
s_cmp_ge_u32 s38, 32
s_cbranch_scc1 Lpe_32
s_add_u32 s37, s37, 1
s_cmp_lt_u32 s37, 0x80000
s_cbranch_scc1 Lpoll_31
s_waitcnt vmcnt(0)
Lpo_33:
s_waitcnt vmcnt(32) lgkmcnt(0)
s_cmp_ge_u32 s28, 2
s_cbranch_scc1 Lw_34
s_waitcnt vmcnt(0)
Lw_34:
Lpe_32:
s_barrier
s_add_u32 s94, s71, 0x20080
s_mov_b32 s35, s10
s_add_u32 s33, s35, 0x1000
buffer_load_dwordx4 a[0:3], v2, s[40:43], s35 offen offset:0 sc1
L_stub10:
s_cbranch_execz L_stub11
buffer_load_dwordx4 a[4:7], v2, s[40:43], s33 offen offset:0 sc1
buffer_load_dwordx4 a[8:11], v2, s[40:43], s35 offen offset:1024 sc1
buffer_load_dwordx4 a[12:15], v2, s[40:43], s33 offen offset:1024 sc1
buffer_load_dwordx4 a[16:19], v2, s[40:43], s35 offen offset:2048 sc1
buffer_load_dwordx4 a[20:23], v2, s[40:43], s33 offen offset:2048 sc1
buffer_load_dwordx4 a[24:27], v2, s[40:43], s35 offen offset:3072 sc1
buffer_load_dwordx4 a[28:31], v2, s[40:43], s33 offen offset:3072 sc1
s_add_u32 s35, s35, 0x4000
s_add_u32 s33, s33, 0x4000
buffer_load_dwordx4 a[32:35], v2, s[40:43], s35 offen offset:0 sc1
buffer_load_dwordx4 a[36:39], v2, s[40:43], s33 offen offset:0 sc1
buffer_load_dwordx4 a[40:43], v2, s[40:43], s35 offen offset:1024 sc1
buffer_load_dwordx4 a[44:47], v2, s[40:43], s33 offen offset:1024 sc1
buffer_load_dwordx4 a[48:51], v2, s[40:43], s35 offen offset:2048 sc1
buffer_load_dwordx4 a[52:55], v2, s[40:43], s33 offen offset:2048 sc1
buffer_load_dwordx4 a[56:59], v2, s[40:43], s35 offen offset:3072 sc1
buffer_load_dwordx4 a[60:63], v2, s[40:43], s33 offen offset:3072 sc1
s_add_u32 s35, s35, 0x4000
s_add_u32 s33, s33, 0x4000
v_add_u32 v5, 0, v1
ds_read_b128 a[96:99], v5 offset:2048
ds_read_b128 a[100:103], v5 offset:8192
ds_read_b128 a[104:107], v5 offset:3072
ds_read_b128 a[108:111], v5 offset:9216
ds_read_b128 a[112:115], v5 offset:4096
ds_read_b128 a[116:119], v5 offset:10240
s_waitcnt vmcnt(14) lgkmcnt(4)
v_mfma_f32_16x16x32_bf16 v[140:143], a[96:99], a[0:3], 0
s_add_u32 m0, s18, 0x1c000
s_add_u32 s44, s50, 0x201c000
v_mfma_f32_16x16x32_bf16 v[140:143], a[100:103], a[4:7], v[140:143]
buffer_load_dwordx4 a[64:67], v2, s[40:43], s35 offen offset:0 sc1
s_waitcnt vmcnt(13)
v_mfma_f32_16x16x32_bf16 v[164:167], a[100:103], a[12:15], 0
ds_read_b128 a[128:131], v5 offset:5120
v_mfma_f32_16x16x32_bf16 v[164:167], a[96:99], a[8:11], v[164:167]
ds_read_b128 a[132:135], v5 offset:11264
s_waitcnt vmcnt(12)
v_mfma_f32_16x16x32_bf16 v[188:191], a[96:99], a[16:19], 0
s_waitcnt vmcnt(11)
v_mfma_f32_16x16x32_bf16 v[188:191], a[100:103], a[20:23], v[188:191]
buffer_load_dwordx4 a[68:71], v2, s[40:43], s33 offen offset:0 sc1
s_waitcnt vmcnt(10)
v_mfma_f32_16x16x32_bf16 v[212:215], a[100:103], a[28:31], 0
ds_read_b128 a[136:139], v5 offset:0
v_mfma_f32_16x16x32_bf16 v[212:215], a[96:99], a[24:27], v[212:215]
s_waitcnt lgkmcnt(6)
v_mfma_f32_16x16x32_bf16 v[216:219], a[104:107], a[24:27], 0
ds_read_b128 a[140:143], v5 offset:6144
s_waitcnt lgkmcnt(6)
v_mfma_f32_16x16x32_bf16 v[216:219], a[108:111], a[28:31], v[216:219]
v_mfma_f32_16x16x32_bf16 v[192:195], a[108:111], a[20:23], 0
buffer_load_dwordx4 v1, s[4:7], s44 offen offset:0 sc1 lds
v_mfma_f32_16x16x32_bf16 v[192:195], a[104:107], a[16:19], v[192:195]
ds_read_b128 a[144:147], v5 offset:1024
v_mfma_f32_16x16x32_bf16 v[168:171], a[104:107], a[8:11], 0
v_mfma_f32_16x16x32_bf16 v[168:171], a[108:111], a[12:15], v[168:171]
ds_read_b128 a[148:151], v5 offset:7168
v_mfma_f32_16x16x32_bf16 v[144:147], a[108:111], a[4:7], 0
v_mfma_f32_16x16x32_bf16 v[144:147], a[104:107], a[0:3], v[144:147]
buffer_load_dwordx4 a[72:75], v2, s[40:43], s35 offen offset:1024 sc1
s_waitcnt lgkmcnt(7)
v_mfma_f32_16x16x32_bf16 v[148:151], a[112:115], a[0:3], 0
s_waitcnt lgkmcnt(6)
v_mfma_f32_16x16x32_bf16 v[148:151], a[116:119], a[4:7], v[148:151]
v_mfma_f32_16x16x32_bf16 v[172:175], a[116:119], a[12:15], 0
v_mfma_f32_16x16x32_bf16 v[172:175], a[112:115], a[8:11], v[172:175]
v_mfma_f32_16x16x32_bf16 v[196:199], a[112:115], a[16:19], 0
buffer_load_dwordx4 a[76:79], v2, s[40:43], s33 offen offset:1024 sc1
v_mfma_f32_16x16x32_bf16 v[196:199], a[116:119], a[20:23], v[196:199]
v_mfma_f32_16x16x32_bf16 v[220:223], a[116:119], a[28:31], 0
v_mfma_f32_16x16x32_bf16 v[220:223], a[112:115], a[24:27], v[220:223]
s_waitcnt lgkmcnt(0)
v_mfma_f32_16x16x32_bf16 v[224:227], a[128:131], a[24:27], 0
ds_read_b128 a[96:99], v5 offset:14336
v_mfma_f32_16x16x32_bf16 v[224:227], a[132:135], a[28:31], v[224:227]
buffer_load_dwordx4 a[80:83], v2, s[40:43], s35 offen offset:2048 sc1
v_mfma_f32_16x16x32_bf16 v[200:203], a[132:135], a[20:23], 0
ds_read_b128 a[100:103], v5 offset:20480
v_mfma_f32_16x16x32_bf16 v[200:203], a[128:131], a[16:19], v[200:203]
v_mfma_f32_16x16x32_bf16 v[176:179], a[128:131], a[8:11], 0
v_mfma_f32_16x16x32_bf16 v[176:179], a[132:135], a[12:15], v[176:179]
buffer_load_dwordx4 a[84:87], v2, s[40:43], s33 offen offset:2048 sc1
v_mfma_f32_16x16x32_bf16 v[152:155], a[132:135], a[4:7], 0
ds_read_b128 a[104:107], v5 offset:15360
v_mfma_f32_16x16x32_bf16 v[152:155], a[128:131], a[0:3], v[152:155]
v_mfma_f32_16x16x32_bf16 v[132:135], a[136:139], a[0:3], 0
ds_read_b128 a[108:111], v5 offset:21504
v_mfma_f32_16x16x32_bf16 v[132:135], a[140:143], a[4:7], v[132:135]
v_mfma_f32_16x16x32_bf16 v[156:159], a[140:143], a[12:15], 0
buffer_load_dwordx4 v1, s[4:7], s44 offen offset:1024 sc1 lds
s_add_u32 m0, s18, 0x1e000
v_mfma_f32_16x16x32_bf16 v[156:159], a[136:139], a[8:11], v[156:159]
s_add_u32 s44, s50, 0x201e000
ds_read_b128 a[112:115], v5 offset:16384
v_mfma_f32_16x16x32_bf16 v[180:183], a[136:139], a[16:19], 0
v_mfma_f32_16x16x32_bf16 v[180:183], a[140:143], a[20:23], v[180:183]
ds_read_b128 a[116:119], v5 offset:22528
v_mfma_f32_16x16x32_bf16 v[204:207], a[140:143], a[28:31], 0
v_mfma_f32_16x16x32_bf16 v[204:207], a[136:139], a[24:27], v[204:207]
buffer_load_dwordx4 a[88:91], v2, s[40:43], s35 offen offset:3072 sc1
v_mfma_f32_16x16x32_bf16 v[208:211], a[144:147], a[24:27], 0
v_mfma_f32_16x16x32_bf16 v[208:211], a[148:151], a[28:31], v[208:211]
v_mfma_f32_16x16x32_bf16 v[184:187], a[148:151], a[20:23], 0
v_mfma_f32_16x16x32_bf16 v[184:187], a[144:147], a[16:19], v[184:187]
v_mfma_f32_16x16x32_bf16 v[160:163], a[144:147], a[8:11], 0
buffer_load_dwordx4 a[92:95], v2, s[40:43], s33 offen offset:3072 sc1
s_add_u32 s35, s35, 0x4000
v_mfma_f32_16x16x32_bf16 v[160:163], a[148:151], a[12:15], v[160:163]
s_add_u32 s33, s33, 0x4000
v_mfma_f32_16x16x32_bf16 v[136:139], a[148:151], a[4:7], 0
v_mfma_f32_16x16x32_bf16 v[136:139], a[144:147], a[0:3], v[136:139]
s_waitcnt vmcnt(10) lgkmcnt(0)
v_mfma_f32_16x16x32_bf16 v[140:143], a[96:99], a[32:35], v[140:143]
ds_read_b128 a[128:131], v5 offset:17408
v_mfma_f32_16x16x32_bf16 v[140:143], a[100:103], a[36:39], v[140:143]
buffer_load_dwordx4 a[0:3], v2, s[40:43], s35 offen offset:0 sc1
v_mfma_f32_16x16x32_bf16 v[164:167], a[100:103], a[44:47], v[164:167]
ds_read_b128 a[132:135], v5 offset:23552
v_mfma_f32_16x16x32_bf16 v[164:167], a[96:99], a[40:43], v[164:167]
v_mfma_f32_16x16x32_bf16 v[188:191], a[96:99], a[48:51], v[188:191]
v_mfma_f32_16x16x32_bf16 v[188:191], a[100:103], a[52:55], v[188:191]
buffer_load_dwordx4 a[4:7], v2, s[40:43], s33 offen offset:0 sc1
v_mfma_f32_16x16x32_bf16 v[212:215], a[100:103], a[60:63], v[212:215]
ds_read_b128 a[136:139], v5 offset:12288
v_mfma_f32_16x16x32_bf16 v[212:215], a[96:99], a[56:59], v[212:215]
v_mfma_f32_16x16x32_bf16 v[216:219], a[104:107], a[56:59], v[216:219]
ds_read_b128 a[140:143], v5 offset:18432
v_mfma_f32_16x16x32_bf16 v[216:219], a[108:111], a[60:63], v[216:219]
v_mfma_f32_16x16x32_bf16 v[192:195], a[108:111], a[52:55], v[192:195]
buffer_load_dwordx4 v1, s[4:7], s44 offen offset:0 sc1 lds
v_mfma_f32_16x16x32_bf16 v[192:195], a[104:107], a[48:51], v[192:195]
ds_read_b128 a[144:147], v5 offset:13312
v_mfma_f32_16x16x32_bf16 v[168:171], a[104:107], a[40:43], v[168:171]
v_mfma_f32_16x16x32_bf16 v[168:171], a[108:111], a[44:47], v[168:171]
ds_read_b128 a[148:151], v5 offset:19456
v_mfma_f32_16x16x32_bf16 v[144:147], a[108:111], a[36:39], v[144:147]
v_mfma_f32_16x16x32_bf16 v[144:147], a[104:107], a[32:35], v[144:147]
buffer_load_dwordx4 a[8:11], v2, s[40:43], s35 offen offset:1024 sc1
v_mfma_f32_16x16x32_bf16 v[148:151], a[112:115], a[32:35], v[148:151]
v_mfma_f32_16x16x32_bf16 v[148:151], a[116:119], a[36:39], v[148:151]
v_mfma_f32_16x16x32_bf16 v[172:175], a[116:119], a[44:47], v[172:175]
v_mfma_f32_16x16x32_bf16 v[172:175], a[112:115], a[40:43], v[172:175]
v_mfma_f32_16x16x32_bf16 v[196:199], a[112:115], a[48:51], v[196:199]
buffer_load_dwordx4 a[12:15], v2, s[40:43], s33 offen offset:1024 sc1
v_mfma_f32_16x16x32_bf16 v[196:199], a[116:119], a[52:55], v[196:199]
v_mfma_f32_16x16x32_bf16 v[220:223], a[116:119], a[60:63], v[220:223]
v_mfma_f32_16x16x32_bf16 v[220:223], a[112:115], a[56:59], v[220:223]
s_waitcnt lgkmcnt(0)
v_mfma_f32_16x16x32_bf16 v[224:227], a[128:131], a[56:59], v[224:227]
ds_read_b128 a[96:99], v5 offset:26624
v_mfma_f32_16x16x32_bf16 v[224:227], a[132:135], a[60:63], v[224:227]
buffer_load_dwordx4 a[16:19], v2, s[40:43], s35 offen offset:2048 sc1
v_mfma_f32_16x16x32_bf16 v[200:203], a[132:135], a[52:55], v[200:203]
ds_read_b128 a[100:103], v5 offset:32768
v_mfma_f32_16x16x32_bf16 v[200:203], a[128:131], a[48:51], v[200:203]
v_mfma_f32_16x16x32_bf16 v[176:179], a[128:131], a[40:43], v[176:179]
v_mfma_f32_16x16x32_bf16 v[176:179], a[132:135], a[44:47], v[176:179]
buffer_load_dwordx4 v1, s[4:7], s44 offen offset:1024 sc1 lds
s_add_u32 m0, s18, 0x20000
v_mfma_f32_16x16x32_bf16 v[152:155], a[132:135], a[36:39], v[152:155]
s_add_u32 s44, s50, 0x2020000
ds_read_b128 a[104:107], v5 offset:27648
v_mfma_f32_16x16x32_bf16 v[152:155], a[128:131], a[32:35], v[152:155]
v_mfma_f32_16x16x32_bf16 v[132:135], a[136:139], a[32:35], v[132:135]
ds_read_b128 a[108:111], v5 offset:33792
v_mfma_f32_16x16x32_bf16 v[132:135], a[140:143], a[36:39], v[132:135]
buffer_load_dwordx4 a[20:23], v2, s[40:43], s33 offen offset:2048 sc1
v_mfma_f32_16x16x32_bf16 v[156:159], a[140:143], a[44:47], v[156:159]
ds_read_b128 a[112:115], v5 offset:28672
v_mfma_f32_16x16x32_bf16 v[156:159], a[136:139], a[40:43], v[156:159]
v_mfma_f32_16x16x32_bf16 v[180:183], a[136:139], a[48:51], v[180:183]
v_mfma_f32_16x16x32_bf16 v[180:183], a[140:143], a[52:55], v[180:183]
buffer_load_dwordx4 a[24:27], v2, s[40:43], s35 offen offset:3072 sc1
v_mfma_f32_16x16x32_bf16 v[204:207], a[140:143], a[60:63], v[204:207]
ds_read_b128 a[116:119], v5 offset:34816
v_mfma_f32_16x16x32_bf16 v[204:207], a[136:139], a[56:59], v[204:207]
v_mfma_f32_16x16x32_bf16 v[208:211], a[144:147], a[56:59], v[208:211]
v_mfma_f32_16x16x32_bf16 v[208:211], a[148:151], a[60:63], v[208:211]
buffer_load_dwordx4 v1, s[4:7], s44 offen offset:0 sc1 lds
v_mfma_f32_16x16x32_bf16 v[184:187], a[148:151], a[52:55], v[184:187]
v_mfma_f32_16x16x32_bf16 v[184:187], a[144:147], a[48:51], v[184:187]
v_mfma_f32_16x16x32_bf16 v[160:163], a[144:147], a[40:43], v[160:163]
v_mfma_f32_16x16x32_bf16 v[160:163], a[148:151], a[44:47], v[160:163]
buffer_load_dwordx4 a[28:31], v2, s[40:43], s33 offen offset:3072 sc1
s_add_u32 s35, s35, 0x4000
v_mfma_f32_16x16x32_bf16 v[136:139], a[148:151], a[36:39], v[136:139]
s_add_u32 s33, s33, 0x4000
v_mfma_f32_16x16x32_bf16 v[136:139], a[144:147], a[32:35], v[136:139]
s_waitcnt vmcnt(11) lgkmcnt(0)
v_mfma_f32_16x16x32_bf16 v[140:143], a[96:99], a[64:67], v[140:143]
ds_read_b128 a[128:131], v5 offset:29696
v_mfma_f32_16x16x32_bf16 v[140:143], a[100:103], a[68:71], v[140:143]
buffer_load_dwordx4 a[32:35], v2, s[40:43], s35 offen offset:0 sc1
v_mfma_f32_16x16x32_bf16 v[164:167], a[100:103], a[76:79], v[164:167]
ds_read_b128 a[132:135], v5 offset:35840
v_mfma_f32_16x16x32_bf16 v[164:167], a[96:99], a[72:75], v[164:167]
v_mfma_f32_16x16x32_bf16 v[188:191], a[96:99], a[80:83], v[188:191]
v_mfma_f32_16x16x32_bf16 v[188:191], a[100:103], a[84:87], v[188:191]
buffer_load_dwordx4 a[36:39], v2, s[40:43], s33 offen offset:0 sc1
v_mfma_f32_16x16x32_bf16 v[212:215], a[100:103], a[92:95], v[212:215]
ds_read_b128 a[136:139], v5 offset:24576
v_mfma_f32_16x16x32_bf16 v[212:215], a[96:99], a[88:91], v[212:215]
v_mfma_f32_16x16x32_bf16 v[216:219], a[104:107], a[88:91], v[216:219]
ds_read_b128 a[140:143], v5 offset:30720
v_mfma_f32_16x16x32_bf16 v[216:219], a[108:111], a[92:95], v[216:219]
v_mfma_f32_16x16x32_bf16 v[192:195], a[108:111], a[84:87], v[192:195]
buffer_load_dwordx4 v1, s[4:7], s44 offen offset:1024 sc1 lds
s_add_u32 m0, s18, 0x22000
v_mfma_f32_16x16x32_bf16 v[192:195], a[104:107], a[80:83], v[192:195]
s_add_u32 s44, s50, 0x2022000
ds_read_b128 a[144:147], v5 offset:25600
v_mfma_f32_16x16x32_bf16 v[168:171], a[104:107], a[72:75], v[168:171]
v_mfma_f32_16x16x32_bf16 v[168:171], a[108:111], a[76:79], v[168:171]
ds_read_b128 a[148:151], v5 offset:31744
v_mfma_f32_16x16x32_bf16 v[144:147], a[108:111], a[68:71], v[144:147]
v_mfma_f32_16x16x32_bf16 v[144:147], a[104:107], a[64:67], v[144:147]
buffer_load_dwordx4 a[40:43], v2, s[40:43], s35 offen offset:1024 sc1
v_mfma_f32_16x16x32_bf16 v[148:151], a[112:115], a[64:67], v[148:151]
v_mfma_f32_16x16x32_bf16 v[148:151], a[116:119], a[68:71], v[148:151]
v_mfma_f32_16x16x32_bf16 v[172:175], a[116:119], a[76:79], v[172:175]
v_mfma_f32_16x16x32_bf16 v[172:175], a[112:115], a[72:75], v[172:175]
v_mfma_f32_16x16x32_bf16 v[196:199], a[112:115], a[80:83], v[196:199]
buffer_load_dwordx4 a[44:47], v2, s[40:43], s33 offen offset:1024 sc1
v_mfma_f32_16x16x32_bf16 v[196:199], a[116:119], a[84:87], v[196:199]
v_mfma_f32_16x16x32_bf16 v[220:223], a[116:119], a[92:95], v[220:223]
v_mfma_f32_16x16x32_bf16 v[220:223], a[112:115], a[88:91], v[220:223]
s_waitcnt lgkmcnt(0)
v_mfma_f32_16x16x32_bf16 v[224:227], a[128:131], a[88:91], v[224:227]
ds_read_b128 a[96:99], v5 offset:38912
v_mfma_f32_16x16x32_bf16 v[224:227], a[132:135], a[92:95], v[224:227]
buffer_load_dwordx4 a[48:51], v2, s[40:43], s35 offen offset:2048 sc1
v_mfma_f32_16x16x32_bf16 v[200:203], a[132:135], a[84:87], v[200:203]
ds_read_b128 a[100:103], v5 offset:45056
v_mfma_f32_16x16x32_bf16 v[200:203], a[128:131], a[80:83], v[200:203]
v_mfma_f32_16x16x32_bf16 v[176:179], a[128:131], a[72:75], v[176:179]
v_mfma_f32_16x16x32_bf16 v[176:179], a[132:135], a[76:79], v[176:179]
buffer_load_dwordx4 a[52:55], v2, s[40:43], s33 offen offset:2048 sc1
v_mfma_f32_16x16x32_bf16 v[152:155], a[132:135], a[68:71], v[152:155]
ds_read_b128 a[104:107], v5 offset:39936
v_mfma_f32_16x16x32_bf16 v[152:155], a[128:131], a[64:67], v[152:155]
v_mfma_f32_16x16x32_bf16 v[132:135], a[136:139], a[64:67], v[132:135]
ds_read_b128 a[108:111], v5 offset:46080
v_mfma_f32_16x16x32_bf16 v[132:135], a[140:143], a[68:71], v[132:135]
v_mfma_f32_16x16x32_bf16 v[156:159], a[140:143], a[76:79], v[156:159]
buffer_load_dwordx4 v1, s[4:7], s44 offen offset:0 sc1 lds
v_mfma_f32_16x16x32_bf16 v[156:159], a[136:139], a[72:75], v[156:159]
ds_read_b128 a[112:115], v5 offset:40960
v_mfma_f32_16x16x32_bf16 v[180:183], a[136:139], a[80:83], v[180:183]
v_mfma_f32_16x16x32_bf16 v[180:183], a[140:143], a[84:87], v[180:183]
ds_read_b128 a[116:119], v5 offset:47104
v_mfma_f32_16x16x32_bf16 v[204:207], a[140:143], a[92:95], v[204:207]
v_mfma_f32_16x16x32_bf16 v[204:207], a[136:139], a[88:91], v[204:207]
buffer_load_dwordx4 a[56:59], v2, s[40:43], s35 offen offset:3072 sc1
v_mfma_f32_16x16x32_bf16 v[208:211], a[144:147], a[88:91], v[208:211]
v_mfma_f32_16x16x32_bf16 v[208:211], a[148:151], a[92:95], v[208:211]
v_mfma_f32_16x16x32_bf16 v[184:187], a[148:151], a[84:87], v[184:187]
v_mfma_f32_16x16x32_bf16 v[184:187], a[144:147], a[80:83], v[184:187]
v_mfma_f32_16x16x32_bf16 v[160:163], a[144:147], a[72:75], v[160:163]
buffer_load_dwordx4 a[60:63], v2, s[40:43], s33 offen offset:3072 sc1
s_add_u32 s35, s35, 0x4000
v_mfma_f32_16x16x32_bf16 v[160:163], a[148:151], a[76:79], v[160:163]
s_add_u32 s33, s33, 0x4000
v_mfma_f32_16x16x32_bf16 v[136:139], a[148:151], a[68:71], v[136:139]
v_mfma_f32_16x16x32_bf16 v[136:139], a[144:147], a[64:67], v[136:139]
s_waitcnt vmcnt(10) lgkmcnt(0)
v_mfma_f32_16x16x32_bf16 v[140:143], a[96:99], a[0:3], v[140:143]
ds_read_b128 a[128:131], v5 offset:41984
v_mfma_f32_16x16x32_bf16 v[140:143], a[100:103], a[4:7], v[140:143]
buffer_load_dwordx4 a[64:67], v2, s[40:43], s35 offen offset:0 sc1
v_mfma_f32_16x16x32_bf16 v[164:167], a[100:103], a[12:15], v[164:167]
ds_read_b128 a[132:135], v5 offset:48128
v_mfma_f32_16x16x32_bf16 v[164:167], a[96:99], a[8:11], v[164:167]
v_mfma_f32_16x16x32_bf16 v[188:191], a[96:99], a[16:19], v[188:191]
v_mfma_f32_16x16x32_bf16 v[188:191], a[100:103], a[20:23], v[188:191]
buffer_load_dwordx4 a[68:71], v2, s[40:43], s33 offen offset:0 sc1
v_mfma_f32_16x16x32_bf16 v[212:215], a[100:103], a[28:31], v[212:215]
ds_read_b128 a[136:139], v5 offset:36864
v_mfma_f32_16x16x32_bf16 v[212:215], a[96:99], a[24:27], v[212:215]
v_mfma_f32_16x16x32_bf16 v[216:219], a[104:107], a[24:27], v[216:219]
ds_read_b128 a[140:143], v5 offset:43008
v_mfma_f32_16x16x32_bf16 v[216:219], a[108:111], a[28:31], v[216:219]
v_mfma_f32_16x16x32_bf16 v[192:195], a[108:111], a[20:23], v[192:195]
buffer_load_dwordx4 v1, s[4:7], s44 offen offset:1024 sc1 lds
s_add_u32 s88, s82, 0x340000
v_mfma_f32_16x16x32_bf16 v[192:195], a[104:107], a[16:19], v[192:195]
ds_read_b128 a[144:147], v5 offset:37888
v_mfma_f32_16x16x32_bf16 v[168:171], a[104:107], a[8:11], v[168:171]
v_mfma_f32_16x16x32_bf16 v[168:171], a[108:111], a[12:15], v[168:171]
ds_read_b128 a[148:151], v5 offset:44032
v_mfma_f32_16x16x32_bf16 v[144:147], a[108:111], a[4:7], v[144:147]
v_mfma_f32_16x16x32_bf16 v[144:147], a[104:107], a[0:3], v[144:147]
buffer_load_dwordx4 a[72:75], v2, s[40:43], s35 offen offset:1024 sc1
v_mfma_f32_16x16x32_bf16 v[148:151], a[112:115], a[0:3], v[148:151]
v_mfma_f32_16x16x32_bf16 v[148:151], a[116:119], a[4:7], v[148:151]
v_mfma_f32_16x16x32_bf16 v[172:175], a[116:119], a[12:15], v[172:175]
v_mfma_f32_16x16x32_bf16 v[172:175], a[112:115], a[8:11], v[172:175]
v_mfma_f32_16x16x32_bf16 v[196:199], a[112:115], a[16:19], v[196:199]
buffer_load_dwordx4 a[76:79], v2, s[40:43], s33 offen offset:1024 sc1
v_mfma_f32_16x16x32_bf16 v[196:199], a[116:119], a[20:23], v[196:199]
v_mfma_f32_16x16x32_bf16 v[220:223], a[116:119], a[28:31], v[220:223]
v_mfma_f32_16x16x32_bf16 v[220:223], a[112:115], a[24:27], v[220:223]
s_waitcnt lgkmcnt(0)
s_barrier
v_mfma_f32_16x16x32_bf16 v[224:227], a[128:131], a[24:27], v[224:227]
v_add_u32 v5, 49152, v1
v_mfma_f32_16x16x32_bf16 v[224:227], a[132:135], a[28:31], v[224:227]
buffer_load_dwordx4 a[80:83], v2, s[40:43], s35 offen offset:2048 sc1
v_mfma_f32_16x16x32_bf16 v[200:203], a[132:135], a[20:23], v[200:203]
ds_read_b128 a[96:99], v5 offset:2048
v_mfma_f32_16x16x32_bf16 v[200:203], a[128:131], a[16:19], v[200:203]
ds_read_b128 a[100:103], v5 offset:8192
v_mfma_f32_16x16x32_bf16 v[176:179], a[128:131], a[8:11], v[176:179]
v_mfma_f32_16x16x32_bf16 v[176:179], a[132:135], a[12:15], v[176:179]
buffer_load_dwordx4 a[84:87], v2, s[40:43], s33 offen offset:2048 sc1
v_mfma_f32_16x16x32_bf16 v[152:155], a[132:135], a[4:7], v[152:155]
ds_read_b128 a[104:107], v5 offset:3072
v_mfma_f32_16x16x32_bf16 v[152:155], a[128:131], a[0:3], v[152:155]
v_mfma_f32_16x16x32_bf16 v[132:135], a[136:139], a[0:3], v[132:135]
ds_read_b128 a[108:111], v5 offset:9216
v_mfma_f32_16x16x32_bf16 v[132:135], a[140:143], a[4:7], v[132:135]
v_mfma_f32_16x16x32_bf16 v[156:159], a[140:143], a[12:15], v[156:159]
buffer_load_dwordx4 v[92:95], v1, s[4:7], s88 offen offset:0 sc1
v_mfma_f32_16x16x32_bf16 v[156:159], a[136:139], a[8:11], v[156:159]
ds_read_b128 a[112:115], v5 offset:4096
v_mfma_f32_16x16x32_bf16 v[180:183], a[136:139], a[16:19], v[180:183]
v_mfma_f32_16x16x32_bf16 v[180:183], a[140:143], a[20:23], v[180:183]
ds_read_b128 a[116:119], v5 offset:10240
v_mfma_f32_16x16x32_bf16 v[204:207], a[140:143], a[28:31], v[204:207]
v_mfma_f32_16x16x32_bf16 v[204:207], a[136:139], a[24:27], v[204:207]
buffer_load_dwordx4 a[88:91], v2, s[40:43], s35 offen offset:3072 sc1
v_mfma_f32_16x16x32_bf16 v[208:211], a[144:147], a[24:27], v[208:211]
v_mfma_f32_16x16x32_bf16 v[208:211], a[148:151], a[28:31], v[208:211]
v_mfma_f32_16x16x32_bf16 v[184:187], a[148:151], a[20:23], v[184:187]
v_mfma_f32_16x16x32_bf16 v[184:187], a[144:147], a[16:19], v[184:187]
v_mfma_f32_16x16x32_bf16 v[160:163], a[144:147], a[8:11], v[160:163]
buffer_load_dwordx4 a[92:95], v2, s[40:43], s33 offen offset:3072 sc1
s_add_u32 s35, s35, 0x4000
v_mfma_f32_16x16x32_bf16 v[160:163], a[148:151], a[12:15], v[160:163]
s_add_u32 s33, s33, 0x4000
v_mfma_f32_16x16x32_bf16 v[136:139], a[148:151], a[4:7], v[136:139]
v_mfma_f32_16x16x32_bf16 v[136:139], a[144:147], a[0:3], v[136:139]
s_waitcnt vmcnt(10) lgkmcnt(0)
v_mfma_f32_16x16x32_bf16 v[140:143], a[96:99], a[32:35], v[140:143]
ds_read_b128 a[128:131], v5 offset:5120
v_mfma_f32_16x16x32_bf16 v[140:143], a[100:103], a[36:39], v[140:143]
buffer_load_dwordx4 a[0:3], v2, s[40:43], s35 offen offset:0 sc1
v_mfma_f32_16x16x32_bf16 v[164:167], a[100:103], a[44:47], v[164:167]
ds_read_b128 a[132:135], v5 offset:11264
v_mfma_f32_16x16x32_bf16 v[164:167], a[96:99], a[40:43], v[164:167]
v_mfma_f32_16x16x32_bf16 v[188:191], a[96:99], a[48:51], v[188:191]
v_mfma_f32_16x16x32_bf16 v[188:191], a[100:103], a[52:55], v[188:191]
buffer_load_dwordx4 a[4:7], v2, s[40:43], s33 offen offset:0 sc1
v_mfma_f32_16x16x32_bf16 v[212:215], a[100:103], a[60:63], v[212:215]
ds_read_b128 a[136:139], v5 offset:0
v_mfma_f32_16x16x32_bf16 v[212:215], a[96:99], a[56:59], v[212:215]
v_mfma_f32_16x16x32_bf16 v[216:219], a[104:107], a[56:59], v[216:219]
ds_read_b128 a[140:143], v5 offset:6144
v_mfma_f32_16x16x32_bf16 v[216:219], a[108:111], a[60:63], v[216:219]
v_mfma_f32_16x16x32_bf16 v[192:195], a[108:111], a[52:55], v[192:195]
buffer_load_dwordx4 v[96:99], v1, s[4:7], s88 offen offset:1024 sc1
v_mfma_f32_16x16x32_bf16 v[192:195], a[104:107], a[48:51], v[192:195]
ds_read_b128 a[144:147], v5 offset:1024
v_mfma_f32_16x16x32_bf16 v[168:171], a[104:107], a[40:43], v[168:171]
v_mfma_f32_16x16x32_bf16 v[168:171], a[108:111], a[44:47], v[168:171]
ds_read_b128 a[148:151], v5 offset:7168
v_mfma_f32_16x16x32_bf16 v[144:147], a[108:111], a[36:39], v[144:147]
v_mfma_f32_16x16x32_bf16 v[144:147], a[104:107], a[32:35], v[144:147]
buffer_load_dwordx4 a[8:11], v2, s[40:43], s35 offen offset:1024 sc1
v_mfma_f32_16x16x32_bf16 v[148:151], a[112:115], a[32:35], v[148:151]
v_mfma_f32_16x16x32_bf16 v[148:151], a[116:119], a[36:39], v[148:151]
v_mfma_f32_16x16x32_bf16 v[172:175], a[116:119], a[44:47], v[172:175]
v_mfma_f32_16x16x32_bf16 v[172:175], a[112:115], a[40:43], v[172:175]
v_mfma_f32_16x16x32_bf16 v[196:199], a[112:115], a[48:51], v[196:199]
buffer_load_dwordx4 a[12:15], v2, s[40:43], s33 offen offset:1024 sc1
v_mfma_f32_16x16x32_bf16 v[196:199], a[116:119], a[52:55], v[196:199]
v_mfma_f32_16x16x32_bf16 v[220:223], a[116:119], a[60:63], v[220:223]
v_mfma_f32_16x16x32_bf16 v[220:223], a[112:115], a[56:59], v[220:223]
s_waitcnt lgkmcnt(0)
v_mfma_f32_16x16x32_bf16 v[224:227], a[128:131], a[56:59], v[224:227]
ds_read_b128 a[96:99], v5 offset:14336
v_mfma_f32_16x16x32_bf16 v[224:227], a[132:135], a[60:63], v[224:227]
buffer_load_dwordx4 a[16:19], v2, s[40:43], s35 offen offset:2048 sc1
v_mfma_f32_16x16x32_bf16 v[200:203], a[132:135], a[52:55], v[200:203]
ds_read_b128 a[100:103], v5 offset:20480
v_mfma_f32_16x16x32_bf16 v[200:203], a[128:131], a[48:51], v[200:203]
v_mfma_f32_16x16x32_bf16 v[176:179], a[128:131], a[40:43], v[176:179]
v_mfma_f32_16x16x32_bf16 v[176:179], a[132:135], a[44:47], v[176:179]
buffer_load_dwordx4 v[100:103], v1, s[4:7], s88 offen offset:2048 sc1
v_mfma_f32_16x16x32_bf16 v[152:155], a[132:135], a[36:39], v[152:155]
ds_read_b128 a[104:107], v5 offset:15360
v_mfma_f32_16x16x32_bf16 v[152:155], a[128:131], a[32:35], v[152:155]
v_mfma_f32_16x16x32_bf16 v[132:135], a[136:139], a[32:35], v[132:135]
ds_read_b128 a[108:111], v5 offset:21504
v_mfma_f32_16x16x32_bf16 v[132:135], a[140:143], a[36:39], v[132:135]
buffer_load_dwordx4 a[20:23], v2, s[40:43], s33 offen offset:2048 sc1
v_mfma_f32_16x16x32_bf16 v[156:159], a[140:143], a[44:47], v[156:159]
ds_read_b128 a[112:115], v5 offset:16384
v_mfma_f32_16x16x32_bf16 v[156:159], a[136:139], a[40:43], v[156:159]
v_mfma_f32_16x16x32_bf16 v[180:183], a[136:139], a[48:51], v[180:183]
v_mfma_f32_16x16x32_bf16 v[180:183], a[140:143], a[52:55], v[180:183]
buffer_load_dwordx4 a[24:27], v2, s[40:43], s35 offen offset:3072 sc1
v_mfma_f32_16x16x32_bf16 v[204:207], a[140:143], a[60:63], v[204:207]
ds_read_b128 a[116:119], v5 offset:22528
v_mfma_f32_16x16x32_bf16 v[204:207], a[136:139], a[56:59], v[204:207]
v_mfma_f32_16x16x32_bf16 v[208:211], a[144:147], a[56:59], v[208:211]
v_mfma_f32_16x16x32_bf16 v[208:211], a[148:151], a[60:63], v[208:211]
buffer_load_dwordx4 v[104:107], v1, s[4:7], s88 offen offset:3072 sc1
s_add_u32 s88, s88, 4096
v_mfma_f32_16x16x32_bf16 v[184:187], a[148:151], a[52:55], v[184:187]
v_mfma_f32_16x16x32_bf16 v[184:187], a[144:147], a[48:51], v[184:187]
v_mfma_f32_16x16x32_bf16 v[160:163], a[144:147], a[40:43], v[160:163]
v_mfma_f32_16x16x32_bf16 v[160:163], a[148:151], a[44:47], v[160:163]
buffer_load_dwordx4 a[28:31], v2, s[40:43], s33 offen offset:3072 sc1
s_add_u32 s35, s35, 0x4000
v_mfma_f32_16x16x32_bf16 v[136:139], a[148:151], a[36:39], v[136:139]
s_add_u32 s33, s33, 0x4000
v_mfma_f32_16x16x32_bf16 v[136:139], a[144:147], a[32:35], v[136:139]
s_waitcnt vmcnt(11) lgkmcnt(0)
v_mfma_f32_16x16x32_bf16 v[140:143], a[96:99], a[64:67], v[140:143]
ds_read_b128 a[128:131], v5 offset:17408
v_mfma_f32_16x16x32_bf16 v[140:143], a[100:103], a[68:71], v[140:143]
buffer_load_dwordx4 a[32:35], v2, s[40:43], s35 offen offset:0 sc1
v_mfma_f32_16x16x32_bf16 v[164:167], a[100:103], a[76:79], v[164:167]
ds_read_b128 a[132:135], v5 offset:23552
v_mfma_f32_16x16x32_bf16 v[164:167], a[96:99], a[72:75], v[164:167]
v_mfma_f32_16x16x32_bf16 v[188:191], a[96:99], a[80:83], v[188:191]
v_mfma_f32_16x16x32_bf16 v[188:191], a[100:103], a[84:87], v[188:191]
buffer_load_dwordx4 a[36:39], v2, s[40:43], s33 offen offset:0 sc1
v_mfma_f32_16x16x32_bf16 v[212:215], a[100:103], a[92:95], v[212:215]
ds_read_b128 a[136:139], v5 offset:12288
v_mfma_f32_16x16x32_bf16 v[212:215], a[96:99], a[88:91], v[212:215]
v_mfma_f32_16x16x32_bf16 v[216:219], a[104:107], a[88:91], v[216:219]
ds_read_b128 a[140:143], v5 offset:18432
v_mfma_f32_16x16x32_bf16 v[216:219], a[108:111], a[92:95], v[216:219]
v_mfma_f32_16x16x32_bf16 v[192:195], a[108:111], a[84:87], v[192:195]
buffer_load_dwordx4 v[108:111], v1, s[4:7], s88 offen offset:0 sc1
v_mfma_f32_16x16x32_bf16 v[192:195], a[104:107], a[80:83], v[192:195]
ds_read_b128 a[144:147], v5 offset:13312
v_mfma_f32_16x16x32_bf16 v[168:171], a[104:107], a[72:75], v[168:171]
v_mfma_f32_16x16x32_bf16 v[168:171], a[108:111], a[76:79], v[168:171]
ds_read_b128 a[148:151], v5 offset:19456
v_mfma_f32_16x16x32_bf16 v[144:147], a[108:111], a[68:71], v[144:147]
v_mfma_f32_16x16x32_bf16 v[144:147], a[104:107], a[64:67], v[144:147]
buffer_load_dwordx4 a[40:43], v2, s[40:43], s35 offen offset:1024 sc1
v_mfma_f32_16x16x32_bf16 v[148:151], a[112:115], a[64:67], v[148:151]
v_mfma_f32_16x16x32_bf16 v[148:151], a[116:119], a[68:71], v[148:151]
v_mfma_f32_16x16x32_bf16 v[172:175], a[116:119], a[76:79], v[172:175]
v_mfma_f32_16x16x32_bf16 v[172:175], a[112:115], a[72:75], v[172:175]
v_mfma_f32_16x16x32_bf16 v[196:199], a[112:115], a[80:83], v[196:199]
buffer_load_dwordx4 a[44:47], v2, s[40:43], s33 offen offset:1024 sc1
v_mfma_f32_16x16x32_bf16 v[196:199], a[116:119], a[84:87], v[196:199]
v_mfma_f32_16x16x32_bf16 v[220:223], a[116:119], a[92:95], v[220:223]
v_mfma_f32_16x16x32_bf16 v[220:223], a[112:115], a[88:91], v[220:223]
s_waitcnt lgkmcnt(0)
v_mfma_f32_16x16x32_bf16 v[224:227], a[128:131], a[88:91], v[224:227]
ds_read_b128 a[96:99], v5 offset:26624
v_mfma_f32_16x16x32_bf16 v[224:227], a[132:135], a[92:95], v[224:227]
buffer_load_dwordx4 a[48:51], v2, s[40:43], s35 offen offset:2048 sc1
v_mfma_f32_16x16x32_bf16 v[200:203], a[132:135], a[84:87], v[200:203]
ds_read_b128 a[100:103], v5 offset:32768
v_mfma_f32_16x16x32_bf16 v[200:203], a[128:131], a[80:83], v[200:203]
v_mfma_f32_16x16x32_bf16 v[176:179], a[128:131], a[72:75], v[176:179]
v_mfma_f32_16x16x32_bf16 v[176:179], a[132:135], a[76:79], v[176:179]
buffer_load_dwordx4 a[52:55], v2, s[40:43], s33 offen offset:2048 sc1
v_mfma_f32_16x16x32_bf16 v[152:155], a[132:135], a[68:71], v[152:155]
ds_read_b128 a[104:107], v5 offset:27648
v_mfma_f32_16x16x32_bf16 v[152:155], a[128:131], a[64:67], v[152:155]
v_mfma_f32_16x16x32_bf16 v[132:135], a[136:139], a[64:67], v[132:135]
ds_read_b128 a[108:111], v5 offset:33792
v_mfma_f32_16x16x32_bf16 v[132:135], a[140:143], a[68:71], v[132:135]
v_mfma_f32_16x16x32_bf16 v[156:159], a[140:143], a[76:79], v[156:159]
buffer_load_dwordx4 v[112:115], v1, s[4:7], s88 offen offset:1024 sc1
v_mfma_f32_16x16x32_bf16 v[156:159], a[136:139], a[72:75], v[156:159]
ds_read_b128 a[112:115], v5 offset:28672
v_mfma_f32_16x16x32_bf16 v[180:183], a[136:139], a[80:83], v[180:183]
v_mfma_f32_16x16x32_bf16 v[180:183], a[140:143], a[84:87], v[180:183]
ds_read_b128 a[116:119], v5 offset:34816
v_mfma_f32_16x16x32_bf16 v[204:207], a[140:143], a[92:95], v[204:207]
v_mfma_f32_16x16x32_bf16 v[204:207], a[136:139], a[88:91], v[204:207]
buffer_load_dwordx4 a[56:59], v2, s[40:43], s35 offen offset:3072 sc1
v_mfma_f32_16x16x32_bf16 v[208:211], a[144:147], a[88:91], v[208:211]
v_mfma_f32_16x16x32_bf16 v[208:211], a[148:151], a[92:95], v[208:211]
v_mfma_f32_16x16x32_bf16 v[184:187], a[148:151], a[84:87], v[184:187]
v_mfma_f32_16x16x32_bf16 v[184:187], a[144:147], a[80:83], v[184:187]
v_mfma_f32_16x16x32_bf16 v[160:163], a[144:147], a[72:75], v[160:163]
buffer_load_dwordx4 a[60:63], v2, s[40:43], s33 offen offset:3072 sc1
s_add_u32 s35, s35, 0x64000
v_mfma_f32_16x16x32_bf16 v[160:163], a[148:151], a[76:79], v[160:163]
s_add_u32 s33, s33, 0x64000
v_mfma_f32_16x16x32_bf16 v[136:139], a[148:151], a[68:71], v[136:139]
v_mfma_f32_16x16x32_bf16 v[136:139], a[144:147], a[64:67], v[136:139]
s_waitcnt vmcnt(10) lgkmcnt(0)
v_mfma_f32_16x16x32_bf16 v[140:143], a[96:99], a[0:3], v[140:143]
ds_read_b128 a[128:131], v5 offset:29696
v_mfma_f32_16x16x32_bf16 v[140:143], a[100:103], a[4:7], v[140:143]
buffer_load_dwordx4 a[64:67], v2, s[40:43], s35 offen offset:0 sc1
v_mfma_f32_16x16x32_bf16 v[164:167], a[100:103], a[12:15], v[164:167]
ds_read_b128 a[132:135], v5 offset:35840
v_mfma_f32_16x16x32_bf16 v[164:167], a[96:99], a[8:11], v[164:167]
v_mfma_f32_16x16x32_bf16 v[188:191], a[96:99], a[16:19], v[188:191]
v_mfma_f32_16x16x32_bf16 v[188:191], a[100:103], a[20:23], v[188:191]
buffer_load_dwordx4 a[68:71], v2, s[40:43], s33 offen offset:0 sc1
v_mfma_f32_16x16x32_bf16 v[212:215], a[100:103], a[28:31], v[212:215]
ds_read_b128 a[136:139], v5 offset:24576
v_mfma_f32_16x16x32_bf16 v[212:215], a[96:99], a[24:27], v[212:215]
v_mfma_f32_16x16x32_bf16 v[216:219], a[104:107], a[24:27], v[216:219]
ds_read_b128 a[140:143], v5 offset:30720
v_mfma_f32_16x16x32_bf16 v[216:219], a[108:111], a[28:31], v[216:219]
v_mfma_f32_16x16x32_bf16 v[192:195], a[108:111], a[20:23], v[192:195]
buffer_load_dwordx4 v[116:119], v1, s[4:7], s88 offen offset:2048 sc1
v_mfma_f32_16x16x32_bf16 v[192:195], a[104:107], a[16:19], v[192:195]
ds_read_b128 a[144:147], v5 offset:25600
v_mfma_f32_16x16x32_bf16 v[168:171], a[104:107], a[8:11], v[168:171]
v_mfma_f32_16x16x32_bf16 v[168:171], a[108:111], a[12:15], v[168:171]
ds_read_b128 a[148:151], v5 offset:31744
v_mfma_f32_16x16x32_bf16 v[144:147], a[108:111], a[4:7], v[144:147]
v_mfma_f32_16x16x32_bf16 v[144:147], a[104:107], a[0:3], v[144:147]
buffer_load_dwordx4 a[72:75], v2, s[40:43], s35 offen offset:1024 sc1
v_mfma_f32_16x16x32_bf16 v[148:151], a[112:115], a[0:3], v[148:151]
v_mfma_f32_16x16x32_bf16 v[148:151], a[116:119], a[4:7], v[148:151]
v_mfma_f32_16x16x32_bf16 v[172:175], a[116:119], a[12:15], v[172:175]
v_mfma_f32_16x16x32_bf16 v[172:175], a[112:115], a[8:11], v[172:175]
L_stub11:
s_cbranch_execz L_wret4
v_mfma_f32_16x16x32_bf16 v[196:199], a[112:115], a[16:19], v[196:199]
buffer_load_dwordx4 a[76:79], v2, s[40:43], s33 offen offset:1024 sc1
v_mfma_f32_16x16x32_bf16 v[196:199], a[116:119], a[20:23], v[196:199]
v_mfma_f32_16x16x32_bf16 v[220:223], a[116:119], a[28:31], v[220:223]
v_mfma_f32_16x16x32_bf16 v[220:223], a[112:115], a[24:27], v[220:223]
s_waitcnt lgkmcnt(0)
v_mfma_f32_16x16x32_bf16 v[224:227], a[128:131], a[24:27], v[224:227]
ds_read_b128 a[96:99], v5 offset:38912
v_mfma_f32_16x16x32_bf16 v[224:227], a[132:135], a[28:31], v[224:227]
buffer_load_dwordx4 a[80:83], v2, s[40:43], s35 offen offset:2048 sc1
v_mfma_f32_16x16x32_bf16 v[200:203], a[132:135], a[20:23], v[200:203]
ds_read_b128 a[100:103], v5 offset:45056
v_mfma_f32_16x16x32_bf16 v[200:203], a[128:131], a[16:19], v[200:203]
v_mfma_f32_16x16x32_bf16 v[176:179], a[128:131], a[8:11], v[176:179]
v_mfma_f32_16x16x32_bf16 v[176:179], a[132:135], a[12:15], v[176:179]
buffer_load_dwordx4 a[84:87], v2, s[40:43], s33 offen offset:2048 sc1
v_mfma_f32_16x16x32_bf16 v[152:155], a[132:135], a[4:7], v[152:155]
ds_read_b128 a[104:107], v5 offset:39936
v_mfma_f32_16x16x32_bf16 v[152:155], a[128:131], a[0:3], v[152:155]
v_mfma_f32_16x16x32_bf16 v[132:135], a[136:139], a[0:3], v[132:135]
ds_read_b128 a[108:111], v5 offset:46080
v_mfma_f32_16x16x32_bf16 v[132:135], a[140:143], a[4:7], v[132:135]
v_mfma_f32_16x16x32_bf16 v[156:159], a[140:143], a[12:15], v[156:159]
buffer_load_dwordx4 v[120:123], v1, s[4:7], s88 offen offset:3072 sc1
s_add_u32 m0, s18, 0x0
v_mfma_f32_16x16x32_bf16 v[156:159], a[136:139], a[8:11], v[156:159]
s_add_u32 s44, s50, 0x2024000
ds_read_b128 a[112:115], v5 offset:40960
v_mfma_f32_16x16x32_bf16 v[180:183], a[136:139], a[16:19], v[180:183]
v_mfma_f32_16x16x32_bf16 v[180:183], a[140:143], a[20:23], v[180:183]
ds_read_b128 a[116:119], v5 offset:47104
v_mfma_f32_16x16x32_bf16 v[204:207], a[140:143], a[28:31], v[204:207]
v_mfma_f32_16x16x32_bf16 v[204:207], a[136:139], a[24:27], v[204:207]
buffer_load_dwordx4 a[88:91], v2, s[40:43], s35 offen offset:3072 sc1
v_mfma_f32_16x16x32_bf16 v[208:211], a[144:147], a[24:27], v[208:211]
v_mfma_f32_16x16x32_bf16 v[208:211], a[148:151], a[28:31], v[208:211]
v_mfma_f32_16x16x32_bf16 v[184:187], a[148:151], a[20:23], v[184:187]
v_mfma_f32_16x16x32_bf16 v[184:187], a[144:147], a[16:19], v[184:187]
v_mfma_f32_16x16x32_bf16 v[160:163], a[144:147], a[8:11], v[160:163]
buffer_load_dwordx4 a[92:95], v2, s[40:43], s33 offen offset:3072 sc1
s_add_u32 s35, s35, 0x4000
v_mfma_f32_16x16x32_bf16 v[160:163], a[148:151], a[12:15], v[160:163]
s_add_u32 s33, s33, 0x4000
v_mfma_f32_16x16x32_bf16 v[136:139], a[148:151], a[4:7], v[136:139]
v_mfma_f32_16x16x32_bf16 v[136:139], a[144:147], a[0:3], v[136:139]
s_waitcnt vmcnt(10) lgkmcnt(0)
v_mfma_f32_16x16x32_bf16 v[140:143], a[96:99], a[32:35], v[140:143]
ds_read_b128 a[128:131], v5 offset:41984
v_mfma_f32_16x16x32_bf16 v[140:143], a[100:103], a[36:39], v[140:143]
buffer_load_dwordx4 a[0:3], v2, s[40:43], s35 offen offset:0 sc1
v_mfma_f32_16x16x32_bf16 v[164:167], a[100:103], a[44:47], v[164:167]
ds_read_b128 a[132:135], v5 offset:48128
v_mfma_f32_16x16x32_bf16 v[164:167], a[96:99], a[40:43], v[164:167]
v_mfma_f32_16x16x32_bf16 v[188:191], a[96:99], a[48:51], v[188:191]
v_mfma_f32_16x16x32_bf16 v[188:191], a[100:103], a[52:55], v[188:191]
buffer_load_dwordx4 v1, s[4:7], s44 offen offset:0 sc1 lds
v_mfma_f32_16x16x32_bf16 v[212:215], a[100:103], a[60:63], v[212:215]
ds_read_b128 a[136:139], v5 offset:36864
v_mfma_f32_16x16x32_bf16 v[212:215], a[96:99], a[56:59], v[212:215]
v_mfma_f32_16x16x32_bf16 v[216:219], a[104:107], a[56:59], v[216:219]
ds_read_b128 a[140:143], v5 offset:43008
v_mfma_f32_16x16x32_bf16 v[216:219], a[108:111], a[60:63], v[216:219]
buffer_load_dwordx4 a[4:7], v2, s[40:43], s33 offen offset:0 sc1
v_mfma_f32_16x16x32_bf16 v[192:195], a[108:111], a[52:55], v[192:195]
ds_read_b128 a[144:147], v5 offset:37888
v_mfma_f32_16x16x32_bf16 v[192:195], a[104:107], a[48:51], v[192:195]
v_mfma_f32_16x16x32_bf16 v[168:171], a[104:107], a[40:43], v[168:171]
v_mfma_f32_16x16x32_bf16 v[168:171], a[108:111], a[44:47], v[168:171]
buffer_load_dwordx4 a[8:11], v2, s[40:43], s35 offen offset:1024 sc1
v_mfma_f32_16x16x32_bf16 v[144:147], a[108:111], a[36:39], v[144:147]
ds_read_b128 a[148:151], v5 offset:44032
v_mfma_f32_16x16x32_bf16 v[144:147], a[104:107], a[32:35], v[144:147]
v_mfma_f32_16x16x32_bf16 v[148:151], a[112:115], a[32:35], v[148:151]
v_mfma_f32_16x16x32_bf16 v[148:151], a[116:119], a[36:39], v[148:151]
buffer_load_dwordx4 v1, s[4:7], s44 offen offset:1024 sc1 lds
s_add_u32 m0, s18, 0x2000
v_mfma_f32_16x16x32_bf16 v[172:175], a[116:119], a[44:47], v[172:175]
s_add_u32 s44, s50, 0x2026000
v_mfma_f32_16x16x32_bf16 v[172:175], a[112:115], a[40:43], v[172:175]
v_mfma_f32_16x16x32_bf16 v[196:199], a[112:115], a[48:51], v[196:199]
v_mfma_f32_16x16x32_bf16 v[196:199], a[116:119], a[52:55], v[196:199]
buffer_load_dwordx4 a[12:15], v2, s[40:43], s33 offen offset:1024 sc1
v_mfma_f32_16x16x32_bf16 v[220:223], a[116:119], a[60:63], v[220:223]
v_mfma_f32_16x16x32_bf16 v[220:223], a[112:115], a[56:59], v[220:223]
s_waitcnt lgkmcnt(0)
s_barrier
v_mfma_f32_16x16x32_bf16 v[224:227], a[128:131], a[56:59], v[224:227]
v_add_u32 v5, 98304, v1
v_mfma_f32_16x16x32_bf16 v[224:227], a[132:135], a[60:63], v[224:227]
buffer_load_dwordx4 a[16:19], v2, s[40:43], s35 offen offset:2048 sc1
v_mfma_f32_16x16x32_bf16 v[200:203], a[132:135], a[52:55], v[200:203]
ds_read_b128 a[96:99], v5 offset:2048
v_mfma_f32_16x16x32_bf16 v[200:203], a[128:131], a[48:51], v[200:203]
ds_read_b128 a[100:103], v5 offset:8192
v_mfma_f32_16x16x32_bf16 v[176:179], a[128:131], a[40:43], v[176:179]
v_mfma_f32_16x16x32_bf16 v[176:179], a[132:135], a[44:47], v[176:179]
buffer_load_dwordx4 a[20:23], v2, s[40:43], s33 offen offset:2048 sc1
v_mfma_f32_16x16x32_bf16 v[152:155], a[132:135], a[36:39], v[152:155]
ds_read_b128 a[104:107], v5 offset:3072
v_mfma_f32_16x16x32_bf16 v[152:155], a[128:131], a[32:35], v[152:155]
v_mfma_f32_16x16x32_bf16 v[132:135], a[136:139], a[32:35], v[132:135]
ds_read_b128 a[108:111], v5 offset:9216
v_mfma_f32_16x16x32_bf16 v[132:135], a[140:143], a[36:39], v[132:135]
v_mfma_f32_16x16x32_bf16 v[156:159], a[140:143], a[44:47], v[156:159]
buffer_load_dwordx4 v1, s[4:7], s44 offen offset:0 sc1 lds
v_mfma_f32_16x16x32_bf16 v[156:159], a[136:139], a[40:43], v[156:159]
ds_read_b128 a[112:115], v5 offset:4096
v_mfma_f32_16x16x32_bf16 v[180:183], a[136:139], a[48:51], v[180:183]
v_mfma_f32_16x16x32_bf16 v[180:183], a[140:143], a[52:55], v[180:183]
ds_read_b128 a[116:119], v5 offset:10240
v_mfma_f32_16x16x32_bf16 v[204:207], a[140:143], a[60:63], v[204:207]
v_mfma_f32_16x16x32_bf16 v[204:207], a[136:139], a[56:59], v[204:207]
buffer_load_dwordx4 a[24:27], v2, s[40:43], s35 offen offset:3072 sc1
v_mfma_f32_16x16x32_bf16 v[208:211], a[144:147], a[56:59], v[208:211]
v_mfma_f32_16x16x32_bf16 v[208:211], a[148:151], a[60:63], v[208:211]
v_mfma_f32_16x16x32_bf16 v[184:187], a[148:151], a[52:55], v[184:187]
v_mfma_f32_16x16x32_bf16 v[184:187], a[144:147], a[48:51], v[184:187]
v_mfma_f32_16x16x32_bf16 v[160:163], a[144:147], a[40:43], v[160:163]
buffer_load_dwordx4 a[28:31], v2, s[40:43], s33 offen offset:3072 sc1
s_add_u32 s35, s35, 0x4000
v_mfma_f32_16x16x32_bf16 v[160:163], a[148:151], a[44:47], v[160:163]
s_add_u32 s33, s33, 0x4000
v_mfma_f32_16x16x32_bf16 v[136:139], a[148:151], a[36:39], v[136:139]
v_mfma_f32_16x16x32_bf16 v[136:139], a[144:147], a[32:35], v[136:139]
s_waitcnt vmcnt(11) lgkmcnt(0)
v_mfma_f32_16x16x32_bf16 v[140:143], a[96:99], a[64:67], v[140:143]
ds_read_b128 a[128:131], v5 offset:5120
v_mfma_f32_16x16x32_bf16 v[140:143], a[100:103], a[68:71], v[140:143]
buffer_load_dwordx4 a[32:35], v2, s[40:43], s35 offen offset:0 sc1
v_mfma_f32_16x16x32_bf16 v[164:167], a[100:103], a[76:79], v[164:167]
ds_read_b128 a[132:135], v5 offset:11264
v_mfma_f32_16x16x32_bf16 v[164:167], a[96:99], a[72:75], v[164:167]
v_mfma_f32_16x16x32_bf16 v[188:191], a[96:99], a[80:83], v[188:191]
v_mfma_f32_16x16x32_bf16 v[188:191], a[100:103], a[84:87], v[188:191]
buffer_load_dwordx4 a[36:39], v2, s[40:43], s33 offen offset:0 sc1
v_mfma_f32_16x16x32_bf16 v[212:215], a[100:103], a[92:95], v[212:215]
ds_read_b128 a[136:139], v5 offset:0
v_mfma_f32_16x16x32_bf16 v[212:215], a[96:99], a[88:91], v[212:215]
v_mfma_f32_16x16x32_bf16 v[216:219], a[104:107], a[88:91], v[216:219]
ds_read_b128 a[140:143], v5 offset:6144
v_mfma_f32_16x16x32_bf16 v[216:219], a[108:111], a[92:95], v[216:219]
v_mfma_f32_16x16x32_bf16 v[192:195], a[108:111], a[84:87], v[192:195]
buffer_load_dwordx4 v1, s[4:7], s44 offen offset:1024 sc1 lds
s_add_u32 m0, s18, 0x4000
v_mfma_f32_16x16x32_bf16 v[192:195], a[104:107], a[80:83], v[192:195]
s_add_u32 s44, s50, 0x2028000
ds_read_b128 a[144:147], v5 offset:1024
v_mfma_f32_16x16x32_bf16 v[168:171], a[104:107], a[72:75], v[168:171]
v_mfma_f32_16x16x32_bf16 v[168:171], a[108:111], a[76:79], v[168:171]
ds_read_b128 a[148:151], v5 offset:7168
v_mfma_f32_16x16x32_bf16 v[144:147], a[108:111], a[68:71], v[144:147]
v_mfma_f32_16x16x32_bf16 v[144:147], a[104:107], a[64:67], v[144:147]
buffer_load_dwordx4 a[40:43], v2, s[40:43], s35 offen offset:1024 sc1
v_mfma_f32_16x16x32_bf16 v[148:151], a[112:115], a[64:67], v[148:151]
v_mfma_f32_16x16x32_bf16 v[148:151], a[116:119], a[68:71], v[148:151]
v_mfma_f32_16x16x32_bf16 v[172:175], a[116:119], a[76:79], v[172:175]
v_mfma_f32_16x16x32_bf16 v[172:175], a[112:115], a[72:75], v[172:175]
v_mfma_f32_16x16x32_bf16 v[196:199], a[112:115], a[80:83], v[196:199]
buffer_load_dwordx4 a[44:47], v2, s[40:43], s33 offen offset:1024 sc1
v_mfma_f32_16x16x32_bf16 v[196:199], a[116:119], a[84:87], v[196:199]
v_mfma_f32_16x16x32_bf16 v[220:223], a[116:119], a[92:95], v[220:223]
v_mfma_f32_16x16x32_bf16 v[220:223], a[112:115], a[88:91], v[220:223]
s_waitcnt lgkmcnt(0)
v_mfma_f32_16x16x32_bf16 v[224:227], a[128:131], a[88:91], v[224:227]
ds_read_b128 a[96:99], v5 offset:14336
v_mfma_f32_16x16x32_bf16 v[224:227], a[132:135], a[92:95], v[224:227]
buffer_load_dwordx4 a[48:51], v2, s[40:43], s35 offen offset:2048 sc1
v_mfma_f32_16x16x32_bf16 v[200:203], a[132:135], a[84:87], v[200:203]
ds_read_b128 a[100:103], v5 offset:20480
v_mfma_f32_16x16x32_bf16 v[200:203], a[128:131], a[80:83], v[200:203]
v_mfma_f32_16x16x32_bf16 v[176:179], a[128:131], a[72:75], v[176:179]
v_mfma_f32_16x16x32_bf16 v[176:179], a[132:135], a[76:79], v[176:179]
buffer_load_dwordx4 a[52:55], v2, s[40:43], s33 offen offset:2048 sc1
v_mfma_f32_16x16x32_bf16 v[152:155], a[132:135], a[68:71], v[152:155]
ds_read_b128 a[104:107], v5 offset:15360
v_mfma_f32_16x16x32_bf16 v[152:155], a[128:131], a[64:67], v[152:155]
v_mfma_f32_16x16x32_bf16 v[132:135], a[136:139], a[64:67], v[132:135]
ds_read_b128 a[108:111], v5 offset:21504
v_mfma_f32_16x16x32_bf16 v[132:135], a[140:143], a[68:71], v[132:135]
v_mfma_f32_16x16x32_bf16 v[156:159], a[140:143], a[76:79], v[156:159]
buffer_load_dwordx4 v1, s[4:7], s44 offen offset:0 sc1 lds
v_mfma_f32_16x16x32_bf16 v[156:159], a[136:139], a[72:75], v[156:159]
ds_read_b128 a[112:115], v5 offset:16384
v_mfma_f32_16x16x32_bf16 v[180:183], a[136:139], a[80:83], v[180:183]
v_mfma_f32_16x16x32_bf16 v[180:183], a[140:143], a[84:87], v[180:183]
ds_read_b128 a[116:119], v5 offset:22528
v_mfma_f32_16x16x32_bf16 v[204:207], a[140:143], a[92:95], v[204:207]
v_mfma_f32_16x16x32_bf16 v[204:207], a[136:139], a[88:91], v[204:207]
buffer_load_dwordx4 a[56:59], v2, s[40:43], s35 offen offset:3072 sc1
v_mfma_f32_16x16x32_bf16 v[208:211], a[144:147], a[88:91], v[208:211]
v_mfma_f32_16x16x32_bf16 v[208:211], a[148:151], a[92:95], v[208:211]
v_mfma_f32_16x16x32_bf16 v[184:187], a[148:151], a[84:87], v[184:187]
v_mfma_f32_16x16x32_bf16 v[184:187], a[144:147], a[80:83], v[184:187]
v_mfma_f32_16x16x32_bf16 v[160:163], a[144:147], a[72:75], v[160:163]
buffer_load_dwordx4 a[60:63], v2, s[40:43], s33 offen offset:3072 sc1
s_add_u32 s35, s35, 0x4000
v_mfma_f32_16x16x32_bf16 v[160:163], a[148:151], a[76:79], v[160:163]
s_add_u32 s33, s33, 0x4000
v_mfma_f32_16x16x32_bf16 v[136:139], a[148:151], a[68:71], v[136:139]
v_mfma_f32_16x16x32_bf16 v[136:139], a[144:147], a[64:67], v[136:139]
s_waitcnt vmcnt(10) lgkmcnt(0)
v_mfma_f32_16x16x32_bf16 v[140:143], a[96:99], a[0:3], v[140:143]
ds_read_b128 a[128:131], v5 offset:17408
v_add_f32 v92, v92, v96
v_mfma_f32_16x16x32_bf16 v[140:143], a[100:103], a[4:7], v[140:143]
buffer_load_dwordx4 a[64:67], v2, s[40:43], s35 offen offset:0 sc1
v_mfma_f32_16x16x32_bf16 v[164:167], a[100:103], a[12:15], v[164:167]
ds_read_b128 a[132:135], v5 offset:23552
v_add_f32 v100, v100, v104
v_mfma_f32_16x16x32_bf16 v[164:167], a[96:99], a[8:11], v[164:167]
v_add_f32 v108, v108, v112
v_add_f32 v116, v116, v120
v_mfma_f32_16x16x32_bf16 v[188:191], a[96:99], a[16:19], v[188:191]
v_add_f32 v93, v93, v97
v_add_f32 v101, v101, v105
v_mfma_f32_16x16x32_bf16 v[188:191], a[100:103], a[20:23], v[188:191]
buffer_load_dwordx4 a[68:71], v2, s[40:43], s33 offen offset:0 sc1
v_mfma_f32_16x16x32_bf16 v[212:215], a[100:103], a[28:31], v[212:215]
ds_read_b128 a[136:139], v5 offset:12288
v_add_f32 v109, v109, v113
v_mfma_f32_16x16x32_bf16 v[212:215], a[96:99], a[24:27], v[212:215]
v_add_f32 v117, v117, v121
v_add_f32 v94, v94, v98
v_mfma_f32_16x16x32_bf16 v[216:219], a[104:107], a[24:27], v[216:219]
ds_read_b128 a[140:143], v5 offset:18432
v_add_f32 v102, v102, v106
v_mfma_f32_16x16x32_bf16 v[216:219], a[108:111], a[28:31], v[216:219]
v_add_f32 v110, v110, v114
v_mfma_f32_16x16x32_bf16 v[192:195], a[108:111], a[20:23], v[192:195]
buffer_load_dwordx4 v1, s[4:7], s44 offen offset:1024 sc1 lds
s_add_u32 m0, s18, 0x6000
v_mfma_f32_16x16x32_bf16 v[192:195], a[104:107], a[16:19], v[192:195]
s_add_u32 s44, s50, 0x202a000
ds_read_b128 a[144:147], v5 offset:13312
v_mfma_f32_16x16x32_bf16 v[168:171], a[104:107], a[8:11], v[168:171]
v_add_f32 v118, v118, v122
v_add_f32 v95, v95, v99
v_mfma_f32_16x16x32_bf16 v[168:171], a[108:111], a[12:15], v[168:171]
ds_read_b128 a[148:151], v5 offset:19456
v_add_f32 v103, v103, v107
v_mfma_f32_16x16x32_bf16 v[144:147], a[108:111], a[4:7], v[144:147]
v_add_f32 v111, v111, v115
v_add_f32 v119, v119, v123
v_mfma_f32_16x16x32_bf16 v[144:147], a[104:107], a[0:3], v[144:147]
buffer_load_dwordx4 a[72:75], v2, s[40:43], s35 offen offset:1024 sc1
v_mfma_f32_16x16x32_bf16 v[148:151], a[112:115], a[0:3], v[148:151]
v_add_f32_dpp v92, v92, v92 row_ror:8 row_mask:0xf bank_mask:0xf
v_add_f32_dpp v100, v100, v100 row_ror:8 row_mask:0xf bank_mask:0xf
v_mfma_f32_16x16x32_bf16 v[148:151], a[116:119], a[4:7], v[148:151]
v_add_f32_dpp v108, v108, v108 row_ror:8 row_mask:0xf bank_mask:0xf
v_mfma_f32_16x16x32_bf16 v[172:175], a[116:119], a[12:15], v[172:175]
v_add_f32_dpp v116, v116, v116 row_ror:8 row_mask:0xf bank_mask:0xf
v_mfma_f32_16x16x32_bf16 v[172:175], a[112:115], a[8:11], v[172:175]
v_add_f32_dpp v93, v93, v93 row_ror:8 row_mask:0xf bank_mask:0xf
v_mfma_f32_16x16x32_bf16 v[196:199], a[112:115], a[16:19], v[196:199]
buffer_load_dwordx4 a[76:79], v2, s[40:43], s33 offen offset:1024 sc1
v_mfma_f32_16x16x32_bf16 v[196:199], a[116:119], a[20:23], v[196:199]
v_add_f32_dpp v101, v101, v101 row_ror:8 row_mask:0xf bank_mask:0xf
v_add_f32_dpp v109, v109, v109 row_ror:8 row_mask:0xf bank_mask:0xf
v_mfma_f32_16x16x32_bf16 v[220:223], a[116:119], a[28:31], v[220:223]
v_add_f32_dpp v117, v117, v117 row_ror:8 row_mask:0xf bank_mask:0xf
v_mfma_f32_16x16x32_bf16 v[220:223], a[112:115], a[24:27], v[220:223]
v_add_f32_dpp v92, v94, v94 row_ror:8 row_mask:0xf bank_mask:0xc
s_waitcnt lgkmcnt(0)
v_mfma_f32_16x16x32_bf16 v[224:227], a[128:131], a[24:27], v[224:227]
ds_read_b128 a[96:99], v5 offset:26624
v_add_f32_dpp v100, v102, v102 row_ror:8 row_mask:0xf bank_mask:0xc
v_mfma_f32_16x16x32_bf16 v[224:227], a[132:135], a[28:31], v[224:227]
buffer_load_dwordx4 a[80:83], v2, s[40:43], s35 offen offset:2048 sc1
v_mfma_f32_16x16x32_bf16 v[200:203], a[132:135], a[20:23], v[200:203]
ds_read_b128 a[100:103], v5 offset:32768
v_add_f32_dpp v108, v110, v110 row_ror:8 row_mask:0xf bank_mask:0xc
v_mfma_f32_16x16x32_bf16 v[200:203], a[128:131], a[16:19], v[200:203]
v_add_f32_dpp v116, v118, v118 row_ror:8 row_mask:0xf bank_mask:0xc
v_add_f32_dpp v93, v95, v95 row_ror:8 row_mask:0xf bank_mask:0xc
v_mfma_f32_16x16x32_bf16 v[176:179], a[128:131], a[8:11], v[176:179]
v_add_f32_dpp v101, v103, v103 row_ror:8 row_mask:0xf bank_mask:0xc
v_add_f32_dpp v109, v111, v111 row_ror:8 row_mask:0xf bank_mask:0xc
v_mfma_f32_16x16x32_bf16 v[176:179], a[132:135], a[12:15], v[176:179]
buffer_load_dwordx4 v1, s[4:7], s44 offen offset:0 sc1 lds
v_mfma_f32_16x16x32_bf16 v[152:155], a[132:135], a[4:7], v[152:155]
ds_read_b128 a[104:107], v5 offset:27648
v_add_f32_dpp v117, v119, v119 row_ror:8 row_mask:0xf bank_mask:0xc
v_mfma_f32_16x16x32_bf16 v[152:155], a[128:131], a[0:3], v[152:155]
v_permlane32_swap_b32 v92, v93
v_mfma_f32_16x16x32_bf16 v[132:135], a[136:139], a[0:3], v[132:135]
ds_read_b128 a[108:111], v5 offset:33792
v_mfma_f32_16x16x32_bf16 v[132:135], a[140:143], a[4:7], v[132:135]
buffer_load_dwordx4 a[84:87], v2, s[40:43], s33 offen offset:2048 sc1
v_mfma_f32_16x16x32_bf16 v[156:159], a[140:143], a[12:15], v[156:159]
ds_read_b128 a[112:115], v5 offset:28672
v_mfma_f32_16x16x32_bf16 v[156:159], a[136:139], a[8:11], v[156:159]
v_permlane32_swap_b32 v100, v101
v_mfma_f32_16x16x32_bf16 v[180:183], a[136:139], a[16:19], v[180:183]
v_permlane32_swap_b32 v108, v109
v_mfma_f32_16x16x32_bf16 v[180:183], a[140:143], a[20:23], v[180:183]
buffer_load_dwordx4 a[88:91], v2, s[40:43], s35 offen offset:3072 sc1
v_mfma_f32_16x16x32_bf16 v[204:207], a[140:143], a[28:31], v[204:207]
ds_read_b128 a[116:119], v5 offset:34816
v_mfma_f32_16x16x32_bf16 v[204:207], a[136:139], a[24:27], v[204:207]
v_permlane32_swap_b32 v116, v117
v_mfma_f32_16x16x32_bf16 v[208:211], a[144:147], a[24:27], v[208:211]
v_add_f32 v92, v92, v93
v_add_f32 v100, v100, v101
v_mfma_f32_16x16x32_bf16 v[208:211], a[148:151], a[28:31], v[208:211]
buffer_load_dwordx4 v1, s[4:7], s44 offen offset:1024 sc1 lds
s_add_u32 m0, s18, 0x8000
v_mfma_f32_16x16x32_bf16 v[184:187], a[148:151], a[20:23], v[184:187]
s_add_u32 s44, s50, 0x202c000
v_add_f32 v108, v108, v109
v_mfma_f32_16x16x32_bf16 v[184:187], a[144:147], a[16:19], v[184:187]
v_add_f32 v116, v116, v117
v_mov_b32 v94, v92
v_mfma_f32_16x16x32_bf16 v[160:163], a[144:147], a[8:11], v[160:163]
v_mov_b32 v102, v100
v_mov_b32 v110, v108
v_mfma_f32_16x16x32_bf16 v[160:163], a[148:151], a[12:15], v[160:163]
buffer_load_dwordx4 a[92:95], v2, s[40:43], s33 offen offset:3072 sc1
s_add_u32 s35, s35, 0x4000
v_mfma_f32_16x16x32_bf16 v[136:139], a[148:151], a[4:7], v[136:139]
s_add_u32 s33, s33, 0x4000
v_mov_b32 v118, v116
v_mfma_f32_16x16x32_bf16 v[136:139], a[144:147], a[0:3], v[136:139]
s_waitcnt vmcnt(11) lgkmcnt(0)
v_mfma_f32_16x16x32_bf16 v[140:143], a[96:99], a[32:35], v[140:143]
ds_read_b128 a[128:131], v5 offset:29696
v_mfma_f32_16x16x32_bf16 v[140:143], a[100:103], a[36:39], v[140:143]
buffer_load_dwordx4 a[0:3], v2, s[40:43], s35 offen offset:0 sc1
v_mfma_f32_16x16x32_bf16 v[164:167], a[100:103], a[44:47], v[164:167]
ds_read_b128 a[132:135], v5 offset:35840
v_mfma_f32_16x16x32_bf16 v[164:167], a[96:99], a[40:43], v[164:167]
v_permlane16_swap_b32 v92, v94
v_mfma_f32_16x16x32_bf16 v[188:191], a[96:99], a[48:51], v[188:191]
v_permlane16_swap_b32 v100, v102
v_mfma_f32_16x16x32_bf16 v[188:191], a[100:103], a[52:55], v[188:191]
buffer_load_dwordx4 a[4:7], v2, s[40:43], s33 offen offset:0 sc1
v_mfma_f32_16x16x32_bf16 v[212:215], a[100:103], a[60:63], v[212:215]
ds_read_b128 a[136:139], v5 offset:24576
v_mfma_f32_16x16x32_bf16 v[212:215], a[96:99], a[56:59], v[212:215]
v_permlane16_swap_b32 v108, v110
v_mfma_f32_16x16x32_bf16 v[216:219], a[104:107], a[56:59], v[216:219]
ds_read_b128 a[140:143], v5 offset:30720
v_mfma_f32_16x16x32_bf16 v[216:219], a[108:111], a[60:63], v[216:219]
v_permlane16_swap_b32 v116, v118
v_mfma_f32_16x16x32_bf16 v[192:195], a[108:111], a[52:55], v[192:195]
buffer_load_dwordx4 v1, s[4:7], s44 offen offset:0 sc1 lds
v_mfma_f32_16x16x32_bf16 v[192:195], a[104:107], a[48:51], v[192:195]
ds_read_b128 a[144:147], v5 offset:25600
v_add_f32 v92, v92, v94
v_mfma_f32_16x16x32_bf16 v[168:171], a[104:107], a[40:43], v[168:171]
v_add_f32 v100, v100, v102
v_add_f32 v108, v108, v110
v_mfma_f32_16x16x32_bf16 v[168:171], a[108:111], a[44:47], v[168:171]
ds_read_b128 a[148:151], v5 offset:31744
v_add_f32 v116, v116, v118
v_mfma_f32_16x16x32_bf16 v[144:147], a[108:111], a[36:39], v[144:147]
v_mov_b32 v94, v92
v_mov_b32 v102, v100
v_mfma_f32_16x16x32_bf16 v[144:147], a[104:107], a[32:35], v[144:147]
buffer_load_dwordx4 a[8:11], v2, s[40:43], s35 offen offset:1024 sc1
v_mfma_f32_16x16x32_bf16 v[148:151], a[112:115], a[32:35], v[148:151]
v_mov_b32 v110, v108
v_mov_b32 v118, v116
v_mfma_f32_16x16x32_bf16 v[148:151], a[116:119], a[36:39], v[148:151]
v_permlane32_swap_b32 v92, v94
v_mfma_f32_16x16x32_bf16 v[172:175], a[116:119], a[44:47], v[172:175]
v_permlane32_swap_b32 v100, v102
v_mfma_f32_16x16x32_bf16 v[172:175], a[112:115], a[40:43], v[172:175]
v_permlane32_swap_b32 v108, v110
v_mfma_f32_16x16x32_bf16 v[196:199], a[112:115], a[48:51], v[196:199]
buffer_load_dwordx4 a[12:15], v2, s[40:43], s33 offen offset:1024 sc1
v_mfma_f32_16x16x32_bf16 v[196:199], a[116:119], a[52:55], v[196:199]
v_permlane32_swap_b32 v116, v118
v_mfma_f32_16x16x32_bf16 v[220:223], a[116:119], a[60:63], v[220:223]
v_mul_f32 v82, 0xba800000, v92
v_mul_f32 v84, 0xba800000, v100
v_mfma_f32_16x16x32_bf16 v[220:223], a[112:115], a[56:59], v[220:223]
v_mul_f32 v86, 0xba800000, v108
s_waitcnt lgkmcnt(0)
v_mfma_f32_16x16x32_bf16 v[224:227], a[128:131], a[56:59], v[224:227]
ds_read_b128 a[96:99], v5 offset:38912
v_mul_f32 v88, 0xba800000, v116
v_mfma_f32_16x16x32_bf16 v[224:227], a[132:135], a[60:63], v[224:227]
buffer_load_dwordx4 a[16:19], v2, s[40:43], s35 offen offset:2048 sc1
v_mfma_f32_16x16x32_bf16 v[200:203], a[132:135], a[52:55], v[200:203]
ds_read_b128 a[100:103], v5 offset:45056
v_mul_f32 v94, 0x3a800000, v94
v_mfma_f32_16x16x32_bf16 v[200:203], a[128:131], a[48:51], v[200:203]
v_mul_f32 v102, 0x3a800000, v102
v_mul_f32 v110, 0x3a800000, v110
v_mfma_f32_16x16x32_bf16 v[176:179], a[128:131], a[40:43], v[176:179]
v_mul_f32 v118, 0x3a800000, v118
v_fma_f32 v94, -v82, v82, v94
v_mfma_f32_16x16x32_bf16 v[176:179], a[132:135], a[44:47], v[176:179]
buffer_load_dwordx4 a[20:23], v2, s[40:43], s33 offen offset:2048 sc1
v_mfma_f32_16x16x32_bf16 v[152:155], a[132:135], a[36:39], v[152:155]
ds_read_b128 a[104:107], v5 offset:39936
v_fma_f32 v102, -v84, v84, v102
v_mfma_f32_16x16x32_bf16 v[152:155], a[128:131], a[32:35], v[152:155]
v_fma_f32 v110, -v86, v86, v110
v_fma_f32 v118, -v88, v88, v118
v_mfma_f32_16x16x32_bf16 v[132:135], a[136:139], a[32:35], v[132:135]
ds_read_b128 a[108:111], v5 offset:46080
v_max_f32 v94, 0, v94
v_mfma_f32_16x16x32_bf16 v[132:135], a[140:143], a[36:39], v[132:135]
v_max_f32 v102, 0, v102
v_mfma_f32_16x16x32_bf16 v[156:159], a[140:143], a[44:47], v[156:159]
buffer_load_dwordx4 v1, s[4:7], s44 offen offset:1024 sc1 lds
s_add_u32 m0, s18, 0xa000
v_mfma_f32_16x16x32_bf16 v[156:159], a[136:139], a[40:43], v[156:159]
s_add_u32 s44, s50, 0x202e000
ds_read_b128 a[112:115], v5 offset:40960
v_mfma_f32_16x16x32_bf16 v[180:183], a[136:139], a[48:51], v[180:183]
v_max_f32 v110, 0, v110
v_max_f32 v118, 0, v118
v_mfma_f32_16x16x32_bf16 v[180:183], a[140:143], a[52:55], v[180:183]
ds_read_b128 a[116:119], v5 offset:47104
v_add_f32 v94, 0x3727c5ac, v94
v_mfma_f32_16x16x32_bf16 v[204:207], a[140:143], a[60:63], v[204:207]
v_add_f32 v102, 0x3727c5ac, v102
v_add_f32 v110, 0x3727c5ac, v110
v_mfma_f32_16x16x32_bf16 v[204:207], a[136:139], a[56:59], v[204:207]
buffer_load_dwordx4 a[24:27], v2, s[40:43], s35 offen offset:3072 sc1
v_mfma_f32_16x16x32_bf16 v[208:211], a[144:147], a[56:59], v[208:211]
v_add_f32 v118, 0x3727c5ac, v118
v_mfma_f32_16x16x32_bf16 v[208:211], a[148:151], a[60:63], v[208:211]
v_rsq_f32 v83, v94
v_mfma_f32_16x16x32_bf16 v[184:187], a[148:151], a[52:55], v[184:187]
v_rsq_f32 v85, v102
v_mfma_f32_16x16x32_bf16 v[184:187], a[144:147], a[48:51], v[184:187]
v_mfma_f32_16x16x32_bf16 v[160:163], a[144:147], a[40:43], v[160:163]
buffer_load_dwordx4 a[28:31], v2, s[40:43], s33 offen offset:3072 sc1
s_add_u32 s35, s35, 0x4000
v_mfma_f32_16x16x32_bf16 v[160:163], a[148:151], a[44:47], v[160:163]
s_add_u32 s33, s33, 0x4000
v_mfma_f32_16x16x32_bf16 v[136:139], a[148:151], a[36:39], v[136:139]
v_rsq_f32 v87, v110
v_mfma_f32_16x16x32_bf16 v[136:139], a[144:147], a[32:35], v[136:139]
s_waitcnt vmcnt(10) lgkmcnt(0)
v_mfma_f32_16x16x32_bf16 v[140:143], a[96:99], a[64:67], v[140:143]
ds_read_b128 a[128:131], v5 offset:41984
v_mfma_f32_16x16x32_bf16 v[140:143], a[100:103], a[68:71], v[140:143]
buffer_load_dwordx4 a[32:35], v2, s[40:43], s35 offen offset:0 sc1
v_mfma_f32_16x16x32_bf16 v[164:167], a[100:103], a[76:79], v[164:167]
ds_read_b128 a[132:135], v5 offset:48128
v_mfma_f32_16x16x32_bf16 v[164:167], a[96:99], a[72:75], v[164:167]
v_rsq_f32 v89, v118
v_mfma_f32_16x16x32_bf16 v[188:191], a[96:99], a[80:83], v[188:191]
v_mfma_f32_16x16x32_bf16 v[188:191], a[100:103], a[84:87], v[188:191]
buffer_load_dwordx4 a[36:39], v2, s[40:43], s33 offen offset:0 sc1
v_mfma_f32_16x16x32_bf16 v[212:215], a[100:103], a[92:95], v[212:215]
ds_read_b128 a[136:139], v5 offset:36864
v_mfma_f32_16x16x32_bf16 v[212:215], a[96:99], a[88:91], v[212:215]
v_mfma_f32_16x16x32_bf16 v[216:219], a[104:107], a[88:91], v[216:219]
ds_read_b128 a[140:143], v5 offset:43008
v_mfma_f32_16x16x32_bf16 v[216:219], a[108:111], a[92:95], v[216:219]
v_mfma_f32_16x16x32_bf16 v[192:195], a[108:111], a[84:87], v[192:195]
buffer_load_dwordx4 v1, s[4:7], s44 offen offset:0 sc1 lds
v_mfma_f32_16x16x32_bf16 v[192:195], a[104:107], a[80:83], v[192:195]
ds_read_b128 a[144:147], v5 offset:37888
v_fmac_f32 v140, v56, v82
v_mfma_f32_16x16x32_bf16 v[168:171], a[104:107], a[72:75], v[168:171]
v_fmac_f32 v164, v56, v84
v_mfma_f32_16x16x32_bf16 v[168:171], a[108:111], a[76:79], v[168:171]
ds_read_b128 a[148:151], v5 offset:44032
v_mfma_f32_16x16x32_bf16 v[144:147], a[108:111], a[68:71], v[144:147]
v_fmac_f32 v188, v56, v86
v_mfma_f32_16x16x32_bf16 v[144:147], a[104:107], a[64:67], v[144:147]
buffer_load_dwordx4 a[40:43], v2, s[40:43], s35 offen offset:1024 sc1
v_mfma_f32_16x16x32_bf16 v[148:151], a[112:115], a[64:67], v[148:151]
v_fmac_f32 v212, v56, v88
v_mfma_f32_16x16x32_bf16 v[148:151], a[116:119], a[68:71], v[148:151]
v_mfma_f32_16x16x32_bf16 v[172:175], a[116:119], a[76:79], v[172:175]
v_fmac_f32 v216, v60, v88
v_mfma_f32_16x16x32_bf16 v[172:175], a[112:115], a[72:75], v[172:175]
v_mfma_f32_16x16x32_bf16 v[196:199], a[112:115], a[80:83], v[196:199]
buffer_load_dwordx4 a[44:47], v2, s[40:43], s33 offen offset:1024 sc1
v_mfma_f32_16x16x32_bf16 v[196:199], a[116:119], a[84:87], v[196:199]
v_fmac_f32 v192, v60, v86
v_mfma_f32_16x16x32_bf16 v[220:223], a[116:119], a[92:95], v[220:223]
v_fmac_f32 v168, v60, v84
v_fmac_f32 v141, v57, v82
v_mfma_f32_16x16x32_bf16 v[220:223], a[112:115], a[88:91], v[220:223]
s_waitcnt lgkmcnt(0)
s_barrier
v_mfma_f32_16x16x32_bf16 v[224:227], a[128:131], a[88:91], v[224:227]
v_add_u32 v5, 0, v1
v_fmac_f32 v144, v60, v82
v_mfma_f32_16x16x32_bf16 v[224:227], a[132:135], a[92:95], v[224:227]
buffer_load_dwordx4 a[48:51], v2, s[40:43], s35 offen offset:2048 sc1
v_mfma_f32_16x16x32_bf16 v[200:203], a[132:135], a[84:87], v[200:203]
ds_read_b128 a[96:99], v5 offset:2048
v_fmac_f32 v148, v64, v82
v_mfma_f32_16x16x32_bf16 v[200:203], a[128:131], a[80:83], v[200:203]
ds_read_b128 a[100:103], v5 offset:8192
v_fmac_f32 v165, v57, v84
v_mfma_f32_16x16x32_bf16 v[176:179], a[128:131], a[72:75], v[176:179]
v_fmac_f32 v172, v64, v84
v_fmac_f32 v189, v57, v86
v_mfma_f32_16x16x32_bf16 v[176:179], a[132:135], a[76:79], v[176:179]
buffer_load_dwordx4 a[52:55], v2, s[40:43], s33 offen offset:2048 sc1
v_mfma_f32_16x16x32_bf16 v[152:155], a[132:135], a[68:71], v[152:155]
ds_read_b128 a[104:107], v5 offset:3072
v_fmac_f32 v196, v64, v86
v_mfma_f32_16x16x32_bf16 v[152:155], a[128:131], a[64:67], v[152:155]
v_fmac_f32 v213, v57, v88
v_fmac_f32 v217, v61, v88
v_mfma_f32_16x16x32_bf16 v[132:135], a[136:139], a[64:67], v[132:135]
ds_read_b128 a[108:111], v5 offset:9216
v_fmac_f32 v220, v64, v88
v_mfma_f32_16x16x32_bf16 v[132:135], a[140:143], a[68:71], v[132:135]
v_fmac_f32 v193, v61, v86
v_mfma_f32_16x16x32_bf16 v[156:159], a[140:143], a[76:79], v[156:159]
buffer_load_dwordx4 v1, s[4:7], s44 offen offset:1024 sc1 lds
s_add_u32 m0, s19, 49152
v_mfma_f32_16x16x32_bf16 v[156:159], a[136:139], a[72:75], v[156:159]
s_add_u32 s44, s85, 0x1a04000
ds_read_b128 a[112:115], v5 offset:4096
v_mfma_f32_16x16x32_bf16 v[180:183], a[136:139], a[80:83], v[180:183]
v_fmac_f32 v224, v68, v88
v_fmac_f32 v200, v68, v86
v_mfma_f32_16x16x32_bf16 v[180:183], a[140:143], a[84:87], v[180:183]
ds_read_b128 a[116:119], v5 offset:10240
v_fmac_f32 v169, v61, v84
v_mfma_f32_16x16x32_bf16 v[204:207], a[140:143], a[92:95], v[204:207]
v_fmac_f32 v176, v68, v84
v_fmac_f32 v145, v61, v82
v_mfma_f32_16x16x32_bf16 v[204:207], a[136:139], a[88:91], v[204:207]
buffer_load_dwordx4 a[56:59], v2, s[40:43], s35 offen offset:3072 sc1
v_mfma_f32_16x16x32_bf16 v[208:211], a[144:147], a[88:91], v[208:211]
v_fmac_f32 v152, v68, v82
v_fmac_f32 v149, v65, v82
v_mfma_f32_16x16x32_bf16 v[208:211], a[148:151], a[92:95], v[208:211]
v_fmac_f32 v173, v65, v84
v_mfma_f32_16x16x32_bf16 v[184:187], a[148:151], a[84:87], v[184:187]
v_fmac_f32 v132, v48, v82
v_fmac_f32 v197, v65, v86
v_mfma_f32_16x16x32_bf16 v[184:187], a[144:147], a[80:83], v[184:187]
v_mfma_f32_16x16x32_bf16 v[160:163], a[144:147], a[72:75], v[160:163]
buffer_load_dwordx4 a[60:63], v2, s[40:43], s33 offen offset:3072 sc1
s_add_u32 s35, s35, 0x4000
v_mfma_f32_16x16x32_bf16 v[160:163], a[148:151], a[76:79], v[160:163]
s_add_u32 s33, s33, 0x4000
v_fmac_f32 v156, v48, v84
v_mfma_f32_16x16x32_bf16 v[136:139], a[148:151], a[68:71], v[136:139]
v_fmac_f32 v180, v48, v86
v_fmac_f32 v221, v65, v88
v_mfma_f32_16x16x32_bf16 v[136:139], a[144:147], a[64:67], v[136:139]
v_fmac_f32 v225, v69, v88
s_waitcnt vmcnt(10) lgkmcnt(0)
v_mfma_f32_16x16x32_bf16 v[140:143], a[96:99], a[0:3], v[140:143]
ds_read_b128 a[128:131], v5 offset:5120
v_fmac_f32 v204, v48, v88
v_mfma_f32_16x16x32_bf16 v[140:143], a[100:103], a[4:7], v[140:143]
buffer_load_dwordx4 a[64:67], v2, s[40:43], s35 offen offset:0 sc1
s_lshl_b32 s37, s28, 10
v_mfma_f32_16x16x32_bf16 v[164:167], a[100:103], a[12:15], v[164:167]
ds_read_b128 a[132:135], v5 offset:11264
v_fmac_f32 v208, v52, v88
v_mfma_f32_16x16x32_bf16 v[164:167], a[96:99], a[8:11], v[164:167]
v_fmac_f32 v201, v69, v86
v_fmac_f32 v177, v69, v84
v_mfma_f32_16x16x32_bf16 v[188:191], a[96:99], a[16:19], v[188:191]
v_fmac_f32 v184, v52, v86
L_stub12:
s_cbranch_execz L_wret3
v_fmac_f32 v153, v69, v82
v_mfma_f32_16x16x32_bf16 v[188:191], a[100:103], a[20:23], v[188:191]
buffer_load_dwordx4 a[68:71], v2, s[40:43], s33 offen offset:0 sc1
s_add_u32 s72, s75, 0x800000
v_mfma_f32_16x16x32_bf16 v[212:215], a[100:103], a[28:31], v[212:215]
ds_read_b128 a[136:139], v5 offset:0
v_fmac_f32 v160, v52, v84
v_mfma_f32_16x16x32_bf16 v[212:215], a[96:99], a[24:27], v[212:215]
v_fmac_f32 v133, v49, v82
s_add_u32 s63, s83, 0x280000
v_mfma_f32_16x16x32_bf16 v[216:219], a[104:107], a[24:27], v[216:219]
ds_read_b128 a[140:143], v5 offset:6144
v_fmac_f32 v136, v52, v82
v_mfma_f32_16x16x32_bf16 v[216:219], a[108:111], a[28:31], v[216:219]
buffer_load_dwordx4 a[72:75], v2, s[40:43], s35 offen offset:1024 sc1
s_sub_u32 s55, s63, 131072
v_mfma_f32_16x16x32_bf16 v[192:195], a[108:111], a[20:23], v[192:195]
ds_read_b128 a[144:147], v5 offset:1024
v_fmac_f32 v157, v49, v84
v_mfma_f32_16x16x32_bf16 v[192:195], a[104:107], a[16:19], v[192:195]
v_fmac_f32 v181, v49, v86
v_fmac_f32 v142, v58, v82
v_mfma_f32_16x16x32_bf16 v[168:171], a[104:107], a[8:11], v[168:171]
v_fmac_f32 v205, v49, v88
v_fmac_f32 v166, v58, v84
v_mfma_f32_16x16x32_bf16 v[168:171], a[108:111], a[12:15], v[168:171]
buffer_load_dwordx4 a[76:79], v2, s[40:43], s33 offen offset:1024 sc1
v_mfma_f32_16x16x32_bf16 v[144:147], a[108:111], a[4:7], v[144:147]
ds_read_b128 a[148:151], v5 offset:7168
v_fmac_f32 v209, v53, v88
v_mfma_f32_16x16x32_bf16 v[144:147], a[104:107], a[0:3], v[144:147]
v_fmac_f32 v190, v58, v86
v_add_u32 v233, s37, v1
v_mfma_f32_16x16x32_bf16 v[148:151], a[112:115], a[0:3], v[148:151]
v_fmac_f32 v185, v53, v86
v_fmac_f32 v214, v58, v88
v_mfma_f32_16x16x32_bf16 v[148:151], a[116:119], a[4:7], v[148:151]
buffer_load_dwordx4 a[80:83], v2, s[40:43], s35 offen offset:2048 sc1
v_mfma_f32_16x16x32_bf16 v[172:175], a[116:119], a[12:15], v[172:175]
v_fmac_f32 v161, v53, v84
v_fmac_f32 v218, v62, v88
v_mfma_f32_16x16x32_bf16 v[172:175], a[112:115], a[8:11], v[172:175]
v_add_u32 v232, s19, v7
v_add_u32 v248, s19, v8
v_mfma_f32_16x16x32_bf16 v[196:199], a[112:115], a[16:19], v[196:199]
v_fmac_f32 v137, v53, v82
v_fmac_f32 v194, v62, v86
v_mfma_f32_16x16x32_bf16 v[196:199], a[116:119], a[20:23], v[196:199]
buffer_load_dwordx4 a[84:87], v2, s[40:43], s33 offen offset:2048 sc1
v_mfma_f32_16x16x32_bf16 v[220:223], a[116:119], a[28:31], v[220:223]
v_fmac_f32 v170, v62, v84
v_fmac_f32 v143, v59, v82
v_mfma_f32_16x16x32_bf16 v[220:223], a[112:115], a[24:27], v[220:223]
s_waitcnt lgkmcnt(0)
v_mfma_f32_16x16x32_bf16 v[224:227], a[128:131], a[24:27], v[224:227]
ds_read_b128 a[96:99], v5 offset:14336
v_fmac_f32 v146, v62, v82
v_mfma_f32_16x16x32_bf16 v[224:227], a[132:135], a[28:31], v[224:227]
buffer_load_dwordx4 a[88:91], v2, s[40:43], s35 offen offset:3072 sc1
v_mfma_f32_16x16x32_bf16 v[200:203], a[132:135], a[20:23], v[200:203]
ds_read_b128 a[100:103], v5 offset:20480
v_fmac_f32 v150, v66, v82
v_mfma_f32_16x16x32_bf16 v[200:203], a[128:131], a[16:19], v[200:203]
v_fmac_f32 v167, v59, v84
v_fmac_f32 v191, v59, v86
v_mfma_f32_16x16x32_bf16 v[176:179], a[128:131], a[8:11], v[176:179]
v_fmac_f32 v174, v66, v84
v_fmac_f32 v215, v59, v88
v_mfma_f32_16x16x32_bf16 v[176:179], a[132:135], a[12:15], v[176:179]
ds_read_b128 a[104:107], v5 offset:15360
v_mfma_f32_16x16x32_bf16 v[152:155], a[132:135], a[4:7], v[152:155]
v_fmac_f32 v198, v66, v86
v_fmac_f32 v219, v63, v88
v_mfma_f32_16x16x32_bf16 v[152:155], a[128:131], a[0:3], v[152:155]
buffer_load_dwordx4 v1, s[4:7], s44 offen offset:0 sc1 lds
v_mfma_f32_16x16x32_bf16 v[132:135], a[136:139], a[0:3], v[132:135]
ds_read_b128 a[108:111], v5 offset:21504
v_fmac_f32 v222, v66, v88
v_mfma_f32_16x16x32_bf16 v[132:135], a[140:143], a[4:7], v[132:135]
v_fmac_f32 v195, v63, v86
v_mfma_f32_16x16x32_bf16 v[156:159], a[140:143], a[12:15], v[156:159]
ds_read_b128 a[112:115], v5 offset:16384
v_fmac_f32 v226, v70, v88
v_mfma_f32_16x16x32_bf16 v[156:159], a[136:139], a[8:11], v[156:159]
v_fmac_f32 v171, v63, v84
v_mfma_f32_16x16x32_bf16 v[180:183], a[136:139], a[16:19], v[180:183]
v_fmac_f32 v202, v70, v86
v_fmac_f32 v147, v63, v82
v_mfma_f32_16x16x32_bf16 v[180:183], a[140:143], a[20:23], v[180:183]
buffer_load_dwordx4 a[92:95], v2, s[40:43], s33 offen offset:3072 sc1
s_add_u32 s35, s35, 0x4000
v_mfma_f32_16x16x32_bf16 v[204:207], a[140:143], a[28:31], v[204:207]
s_add_u32 s33, s33, 0x4000
ds_read_b128 a[116:119], v5 offset:22528
v_mfma_f32_16x16x32_bf16 v[204:207], a[136:139], a[24:27], v[204:207]
v_fmac_f32 v178, v70, v84
v_fmac_f32 v151, v67, v82
v_mfma_f32_16x16x32_bf16 v[208:211], a[144:147], a[24:27], v[208:211]
v_fmac_f32 v154, v70, v82
v_fmac_f32 v175, v67, v84
v_mfma_f32_16x16x32_bf16 v[208:211], a[148:151], a[28:31], v[208:211]
v_mfma_f32_16x16x32_bf16 v[184:187], a[148:151], a[20:23], v[184:187]
v_fmac_f32 v134, v50, v82
v_fmac_f32 v199, v67, v86
v_mfma_f32_16x16x32_bf16 v[184:187], a[144:147], a[16:19], v[184:187]
buffer_load_dwordx4 v1, s[4:7], s44 offen offset:1024 sc1 lds
v_mfma_f32_16x16x32_bf16 v[160:163], a[144:147], a[8:11], v[160:163]
v_fmac_f32 v158, v50, v84
v_fmac_f32 v223, v67, v88
v_mfma_f32_16x16x32_bf16 v[160:163], a[148:151], a[12:15], v[160:163]
v_mfma_f32_16x16x32_bf16 v[136:139], a[148:151], a[4:7], v[136:139]
v_fmac_f32 v182, v50, v86
v_fmac_f32 v227, v71, v88
v_mfma_f32_16x16x32_bf16 v[136:139], a[144:147], a[0:3], v[136:139]
s_waitcnt vmcnt(10) lgkmcnt(0)
s_barrier
v_mfma_f32_16x16x32_bf16 v[140:143], a[96:99], a[32:35], v[140:143]
ds_read_b128 a[128:131], v5 offset:17408
v_fmac_f32 v206, v50, v88
v_mfma_f32_16x16x32_bf16 v[140:143], a[100:103], a[36:39], v[140:143]
buffer_load_dwordx4 a[0:3], v2, s[40:43], s35 offen offset:0 sc1
v_mfma_f32_16x16x32_bf16 v[164:167], a[100:103], a[44:47], v[164:167]
ds_read_b128 a[132:135], v5 offset:23552
v_fmac_f32 v210, v54, v88
v_mfma_f32_16x16x32_bf16 v[164:167], a[96:99], a[40:43], v[164:167]
v_fmac_f32 v203, v71, v86
v_fmac_f32 v179, v71, v84
v_mfma_f32_16x16x32_bf16 v[188:191], a[96:99], a[48:51], v[188:191]
buffer_load_dwordx4 a[4:7], v2, s[40:43], s33 offen offset:0 sc1
v_mfma_f32_16x16x32_bf16 v[188:191], a[100:103], a[52:55], v[188:191]
ds_read_b128 a[136:139], v5 offset:26624
v_fmac_f32 v186, v54, v86
v_mfma_f32_16x16x32_bf16 v[212:215], a[100:103], a[60:63], v[212:215]
v_fmac_f32 v162, v54, v84
v_fmac_f32 v155, v71, v82
v_mfma_f32_16x16x32_bf16 v[212:215], a[96:99], a[56:59], v[212:215]
buffer_load_dwordx4 a[8:11], v2, s[40:43], s35 offen offset:1024 sc1
v_mfma_f32_16x16x32_bf16 v[216:219], a[104:107], a[56:59], v[216:219]
ds_read_b128 a[140:143], v5 offset:32768
v_fmac_f32 v138, v54, v82
v_mfma_f32_16x16x32_bf16 v[216:219], a[108:111], a[60:63], v[216:219]
v_fmac_f32 v135, v51, v82
v_fmac_f32 v159, v51, v84
v_mfma_f32_16x16x32_bf16 v[192:195], a[108:111], a[52:55], v[192:195]
buffer_load_dwordx4 a[12:15], v2, s[40:43], s33 offen offset:1024 sc1
v_mfma_f32_16x16x32_bf16 v[192:195], a[104:107], a[48:51], v[192:195]
ds_read_b128 a[144:147], v5 offset:27648
v_fmac_f32 v183, v51, v86
v_mfma_f32_16x16x32_bf16 v[168:171], a[104:107], a[40:43], v[168:171]
v_fmac_f32 v207, v51, v88
v_mfma_f32_16x16x32_bf16 v[168:171], a[108:111], a[44:47], v[168:171]
buffer_load_dwordx4 a[16:19], v2, s[40:43], s35 offen offset:2048 sc1
v_mfma_f32_16x16x32_bf16 v[144:147], a[108:111], a[36:39], v[144:147]
ds_read_b128 a[148:151], v5 offset:33792
v_fmac_f32 v211, v55, v88
v_mfma_f32_16x16x32_bf16 v[144:147], a[104:107], a[32:35], v[144:147]
v_mul_f32 v88, 0x3e8293ee, v89
v_mfma_f32_16x16x32_bf16 v[148:151], a[112:115], a[32:35], v[148:151]
buffer_load_dwordx4 a[20:23], v2, s[40:43], s33 offen offset:2048 sc1
v_mfma_f32_16x16x32_bf16 v[148:151], a[116:119], a[36:39], v[148:151]
v_fmac_f32 v187, v55, v86
v_mfma_f32_16x16x32_bf16 v[172:175], a[116:119], a[44:47], v[172:175]
v_fmac_f32 v163, v55, v84
v_mul_f32 v86, 0x3e8293ee, v87
v_mfma_f32_16x16x32_bf16 v[172:175], a[112:115], a[40:43], v[172:175]
buffer_load_dwordx4 a[24:27], v2, s[40:43], s35 offen offset:3072 sc1
v_mfma_f32_16x16x32_bf16 v[196:199], a[112:115], a[48:51], v[196:199]
v_fmac_f32 v139, v55, v82
v_mul_f32 v84, 0x3e8293ee, v85
v_mfma_f32_16x16x32_bf16 v[196:199], a[116:119], a[52:55], v[196:199]
v_mul_f32 v82, 0x3e8293ee, v83
v_mfma_f32_16x16x32_bf16 v[220:223], a[116:119], a[60:63], v[220:223]
buffer_load_dwordx4 a[28:31], v2, s[40:43], s33 offen offset:3072 sc1
s_add_u32 s35, s35, 0x64000
v_mfma_f32_16x16x32_bf16 v[220:223], a[112:115], a[56:59], v[220:223]
s_add_u32 s33, s33, 0x64000
s_waitcnt lgkmcnt(0)
v_mfma_f32_16x16x32_bf16 v[224:227], a[128:131], a[56:59], v[224:227]
ds_read_b128 a[96:99], v5 offset:28672
v_mfma_f32_16x16x32_bf16 v[224:227], a[132:135], a[60:63], v[224:227]
buffer_load_dwordx4 v1, s[4:7], s44 offen offset:2048 sc1 lds
v_mfma_f32_16x16x32_bf16 v[200:203], a[132:135], a[52:55], v[200:203]
ds_read_b128 a[100:103], v5 offset:34816
v_mfma_f32_16x16x32_bf16 v[200:203], a[128:131], a[48:51], v[200:203]
v_mfma_f32_16x16x32_bf16 v[176:179], a[128:131], a[40:43], v[176:179]
v_mfma_f32_16x16x32_bf16 v[176:179], a[132:135], a[44:47], v[176:179]
ds_read_b128 a[104:107], v5 offset:29696
v_mfma_f32_16x16x32_bf16 v[152:155], a[132:135], a[36:39], v[152:155]
v_mfma_f32_16x16x32_bf16 v[152:155], a[128:131], a[32:35], v[152:155]
s_waitcnt vmcnt(18)
v_mfma_f32_16x16x32_bf16 v[140:143], a[136:139], a[64:67], v[140:143]
ds_read_b128 a[108:111], v5 offset:35840
s_waitcnt vmcnt(17)
v_mfma_f32_16x16x32_bf16 v[140:143], a[140:143], a[68:71], v[140:143]
s_waitcnt vmcnt(15)
v_mfma_f32_16x16x32_bf16 v[164:167], a[140:143], a[76:79], v[164:167]
ds_read_b128 a[112:115], v5 offset:38912
v_mfma_f32_16x16x32_bf16 v[164:167], a[136:139], a[72:75], v[164:167]
s_waitcnt vmcnt(14)
v_mfma_f32_16x16x32_bf16 v[188:191], a[136:139], a[80:83], v[188:191]
s_waitcnt vmcnt(13)
v_mfma_f32_16x16x32_bf16 v[188:191], a[140:143], a[84:87], v[188:191]
buffer_load_dwordx4 v1, s[4:7], s44 offen offset:3072 sc1 lds
s_add_u32 m0, s19, 65536
s_waitcnt vmcnt(11)
v_mfma_f32_16x16x32_bf16 v[212:215], a[140:143], a[92:95], v[212:215]
s_add_u32 s44, s84, 0x1a08000
ds_read_b128 a[116:119], v5 offset:45056
v_mfma_f32_16x16x32_bf16 v[212:215], a[136:139], a[88:91], v[212:215]
v_mfma_f32_16x16x32_bf16 v[216:219], a[144:147], a[88:91], v[216:219]
v_mfma_f32_16x16x32_bf16 v[216:219], a[148:151], a[92:95], v[216:219]
v_mfma_f32_16x16x32_bf16 v[192:195], a[148:151], a[84:87], v[192:195]
v_mfma_f32_16x16x32_bf16 v[192:195], a[144:147], a[80:83], v[192:195]
v_mfma_f32_16x16x32_bf16 v[168:171], a[144:147], a[72:75], v[168:171]
v_mfma_f32_16x16x32_bf16 v[168:171], a[148:151], a[76:79], v[168:171]
v_mfma_f32_16x16x32_bf16 v[144:147], a[148:151], a[68:71], v[144:147]
v_mfma_f32_16x16x32_bf16 v[144:147], a[144:147], a[64:67], v[144:147]
s_waitcnt lgkmcnt(0)
v_mfma_f32_16x16x32_bf16 v[148:151], a[96:99], a[64:67], v[148:151]
ds_read_b128 a[128:131], v5 offset:39936
v_mfma_f32_16x16x32_bf16 v[148:151], a[100:103], a[68:71], v[148:151]
buffer_load_dwordx4 v1, s[4:7], s44 offen offset:0 sc1 lds
v_mfma_f32_16x16x32_bf16 v[172:175], a[100:103], a[76:79], v[172:175]
ds_read_b128 a[132:135], v5 offset:46080
v_mfma_f32_16x16x32_bf16 v[172:175], a[96:99], a[72:75], v[172:175]
v_mfma_f32_16x16x32_bf16 v[196:199], a[96:99], a[80:83], v[196:199]
v_mfma_f32_16x16x32_bf16 v[196:199], a[100:103], a[84:87], v[196:199]
buffer_load_dwordx4 v1, s[4:7], s44 offen offset:1024 sc1 lds
v_mfma_f32_16x16x32_bf16 v[220:223], a[100:103], a[92:95], v[220:223]
ds_read_b128 a[136:139], v5 offset:40960
v_mfma_f32_16x16x32_bf16 v[220:223], a[96:99], a[88:91], v[220:223]
v_mfma_f32_16x16x32_bf16 v[224:227], a[104:107], a[88:91], v[224:227]
ds_read_b128 a[140:143], v5 offset:47104
v_mfma_f32_16x16x32_bf16 v[224:227], a[108:111], a[92:95], v[224:227]
v_mfma_f32_16x16x32_bf16 v[200:203], a[108:111], a[84:87], v[200:203]
buffer_load_dwordx4 v1, s[4:7], s44 offen offset:2048 sc1 lds
v_mfma_f32_16x16x32_bf16 v[200:203], a[104:107], a[80:83], v[200:203]
ds_read_b128 a[144:147], v5 offset:41984
v_mfma_f32_16x16x32_bf16 v[176:179], a[104:107], a[72:75], v[176:179]
v_mfma_f32_16x16x32_bf16 v[176:179], a[108:111], a[76:79], v[176:179]
ds_read_b128 a[148:151], v5 offset:48128
v_mfma_f32_16x16x32_bf16 v[152:155], a[108:111], a[68:71], v[152:155]
v_mfma_f32_16x16x32_bf16 v[152:155], a[104:107], a[64:67], v[152:155]
buffer_load_dwordx4 v1, s[4:7], s44 offen offset:3072 sc1 lds
s_add_u32 m0, s19, 81920
s_waitcnt vmcnt(13)
v_mfma_f32_16x16x32_bf16 v[140:143], a[112:115], a[0:3], v[140:143]
s_add_u32 s44, s85, 0x1a0c000
s_waitcnt vmcnt(12)
v_mfma_f32_16x16x32_bf16 v[140:143], a[116:119], a[4:7], v[140:143]
s_waitcnt vmcnt(10)
v_mfma_f32_16x16x32_bf16 v[164:167], a[116:119], a[12:15], v[164:167]
v_mfma_f32_16x16x32_bf16 v[164:167], a[112:115], a[8:11], v[164:167]
s_waitcnt vmcnt(9)
v_mfma_f32_16x16x32_bf16 v[188:191], a[112:115], a[16:19], v[188:191]
buffer_load_dwordx4 v1, s[4:7], s44 offen offset:0 sc1 lds
s_waitcnt vmcnt(9)
v_mfma_f32_16x16x32_bf16 v[188:191], a[116:119], a[20:23], v[188:191]
s_waitcnt vmcnt(7)
v_mfma_f32_16x16x32_bf16 v[212:215], a[116:119], a[28:31], v[212:215]
v_mfma_f32_16x16x32_bf16 v[212:215], a[112:115], a[24:27], v[212:215]
s_waitcnt lgkmcnt(0)
v_mfma_f32_16x16x32_bf16 v[216:219], a[128:131], a[24:27], v[216:219]
ds_read_b128 a[96:99], v5 offset:12288
v_mul_f32 v140, v140, v83
v_mfma_f32_16x16x32_bf16 v[216:219], a[132:135], a[28:31], v[216:219]
buffer_load_dwordx4 v1, s[4:7], s44 offen offset:1024 sc1 lds
v_mfma_f32_16x16x32_bf16 v[192:195], a[132:135], a[20:23], v[192:195]
ds_read_b128 a[100:103], v5 offset:18432
v_mul_f32 v141, v141, v83
v_mfma_f32_16x16x32_bf16 v[192:195], a[128:131], a[16:19], v[192:195]
v_cvt_pk_bf16_f32 v140, v140, v141
v_mul_f32 v164, v164, v85
v_mfma_f32_16x16x32_bf16 v[168:171], a[128:131], a[8:11], v[168:171]
v_mul_f32 v165, v165, v85
v_cvt_pk_bf16_f32 v164, v164, v165
v_mfma_f32_16x16x32_bf16 v[168:171], a[132:135], a[12:15], v[168:171]
buffer_load_dwordx4 v1, s[4:7], s44 offen offset:2048 sc1 lds
v_mfma_f32_16x16x32_bf16 v[144:147], a[132:135], a[4:7], v[144:147]
ds_read_b128 a[104:107], v5 offset:24576
v_mul_f32 v212, v212, v89
v_mfma_f32_16x16x32_bf16 v[144:147], a[128:131], a[0:3], v[144:147]
v_mul_f32 v213, v213, v89
v_mul_f32 v214, v214, v89
v_mfma_f32_16x16x32_bf16 v[148:151], a[136:139], a[0:3], v[148:151]
ds_read_b128 a[108:111], v5 offset:30720
v_mul_f32 v215, v215, v89
v_mfma_f32_16x16x32_bf16 v[148:151], a[140:143], a[4:7], v[148:151]
v_cvt_pk_bf16_f32 v212, v212, v213
v_mul_f32 v216, v216, v89
v_mfma_f32_16x16x32_bf16 v[172:175], a[140:143], a[12:15], v[172:175]
buffer_load_dwordx4 v1, s[4:7], s44 offen offset:3072 sc1 lds
s_add_u32 m0, s19, 147456
v_mfma_f32_16x16x32_bf16 v[172:175], a[136:139], a[8:11], v[172:175]
s_add_u32 s44, s87, 0x1a1c000
ds_read_b128 a[112:115], v5 offset:36864
v_mfma_f32_16x16x32_bf16 v[196:199], a[136:139], a[16:19], v[196:199]
v_mul_f32 v217, v217, v89
v_mul_f32 v218, v218, v89
v_mfma_f32_16x16x32_bf16 v[196:199], a[140:143], a[20:23], v[196:199]
ds_read_b128 a[116:119], v5 offset:43008
v_mul_f32 v219, v219, v89
v_mfma_f32_16x16x32_bf16 v[220:223], a[140:143], a[28:31], v[220:223]
v_cvt_pk_bf16_f32 v213, v214, v215
v_cvt_pk_bf16_f32 v214, v216, v217
v_mfma_f32_16x16x32_bf16 v[220:223], a[136:139], a[24:27], v[220:223]
buffer_load_dwordx4 v1, s[4:7], s44 offen offset:0 sc1 lds
v_mfma_f32_16x16x32_bf16 v[224:227], a[144:147], a[24:27], v[224:227]
v_cvt_pk_bf16_f32 v215, v218, v219
v_min_u32 v212, -2, v212
v_mfma_f32_16x16x32_bf16 v[224:227], a[148:151], a[28:31], v[224:227]
v_min_u32 v213, -2, v213
v_min_u32 v214, -2, v214
v_mfma_f32_16x16x32_bf16 v[200:203], a[148:151], a[20:23], v[200:203]
v_min_u32 v215, -2, v215
v_mul_f32 v172, v172, v85
v_mfma_f32_16x16x32_bf16 v[200:203], a[144:147], a[16:19], v[200:203]
buffer_store_dwordx4 v[212:215], v3, s[4:7], s63 offen offset:0 sc1
v_mfma_f32_16x16x32_bf16 v[176:179], a[144:147], a[8:11], v[176:179]
buffer_load_dwordx4 v1, s[4:7], s44 offen offset:1024 sc1 lds
v_mfma_f32_16x16x32_bf16 v[176:179], a[148:151], a[12:15], v[176:179]
v_mul_f32 v173, v173, v85
v_cvt_pk_bf16_f32 v172, v172, v173
v_mfma_f32_16x16x32_bf16 v[152:155], a[148:151], a[4:7], v[152:155]
v_mul_f32 v220, v220, v89
v_mul_f32 v221, v221, v89
v_mfma_f32_16x16x32_bf16 v[152:155], a[144:147], a[0:3], v[152:155]
v_mul_f32 v222, v222, v89
s_waitcnt lgkmcnt(0)
v_mfma_f32_16x16x32_bf16 v[132:135], a[96:99], a[32:35], v[132:135]
ds_read_b128 a[128:131], v5 offset:13312
v_mul_f32 v223, v223, v89
v_mfma_f32_16x16x32_bf16 v[132:135], a[100:103], a[36:39], v[132:135]
buffer_load_dwordx4 v1, s[4:7], s44 offen offset:2048 sc1 lds
v_mfma_f32_16x16x32_bf16 v[156:159], a[100:103], a[44:47], v[156:159]
ds_read_b128 a[132:135], v5 offset:19456
v_cvt_pk_bf16_f32 v220, v220, v221
v_mfma_f32_16x16x32_bf16 v[156:159], a[96:99], a[40:43], v[156:159]
v_mul_f32 v224, v224, v89
v_mul_f32 v225, v225, v89
v_mfma_f32_16x16x32_bf16 v[180:183], a[96:99], a[48:51], v[180:183]
v_mul_f32 v226, v226, v89
v_mul_f32 v227, v227, v89
v_mfma_f32_16x16x32_bf16 v[180:183], a[100:103], a[52:55], v[180:183]
buffer_load_dwordx4 v1, s[4:7], s44 offen offset:3072 sc1 lds
s_add_u32 m0, s19, 98304
v_mfma_f32_16x16x32_bf16 v[204:207], a[100:103], a[60:63], v[204:207]
s_add_u32 s44, s84, 0x1a10000
ds_read_b128 a[136:139], v5 offset:25600
v_mfma_f32_16x16x32_bf16 v[204:207], a[96:99], a[56:59], v[204:207]
v_cvt_pk_bf16_f32 v221, v222, v223
v_cvt_pk_bf16_f32 v222, v224, v225
v_mfma_f32_16x16x32_bf16 v[204:207], a[104:107], a[88:91], v[204:207]
ds_read_b128 a[140:143], v5 offset:31744
v_cvt_pk_bf16_f32 v223, v226, v227
v_mfma_f32_16x16x32_bf16 v[204:207], a[108:111], a[92:95], v[204:207]
v_min_u32 v220, -2, v220
v_min_u32 v221, -2, v221
v_mfma_f32_16x16x32_bf16 v[180:183], a[108:111], a[84:87], v[180:183]
buffer_load_dwordx4 v1, s[4:7], s44 offen offset:0 sc1 lds
v_mfma_f32_16x16x32_bf16 v[180:183], a[104:107], a[80:83], v[180:183]
ds_read_b128 a[144:147], v5 offset:37888
v_min_u32 v222, -2, v222
v_mfma_f32_16x16x32_bf16 v[156:159], a[104:107], a[72:75], v[156:159]
v_min_u32 v223, -2, v223
v_mul_f32 v196, v196, v87
v_mfma_f32_16x16x32_bf16 v[156:159], a[108:111], a[76:79], v[156:159]
ds_read_b128 a[148:151], v5 offset:44032
v_mul_f32 v197, v197, v87
v_mfma_f32_16x16x32_bf16 v[132:135], a[108:111], a[68:71], v[132:135]
buffer_store_dwordx4 v[220:223], v3, s[4:7], s63 offen offset:1024 sc1
v_mfma_f32_16x16x32_bf16 v[132:135], a[104:107], a[64:67], v[132:135]
buffer_load_dwordx4 v1, s[4:7], s44 offen offset:1024 sc1 lds
v_mfma_f32_16x16x32_bf16 v[132:135], a[112:115], a[0:3], v[132:135]
v_cvt_pk_bf16_f32 v196, v196, v197
v_mul_f32 v198, v198, v87
v_mfma_f32_16x16x32_bf16 v[132:135], a[116:119], a[4:7], v[132:135]
v_mul_f32 v199, v199, v87
v_cvt_pk_bf16_f32 v197, v198, v199
v_mfma_f32_16x16x32_bf16 v[156:159], a[116:119], a[12:15], v[156:159]
v_mul_f32 v200, v200, v87
v_mul_f32 v201, v201, v87
v_mfma_f32_16x16x32_bf16 v[156:159], a[112:115], a[8:11], v[156:159]
v_cvt_pk_bf16_f32 v198, v200, v201
v_mul_f32 v202, v202, v87
v_mfma_f32_16x16x32_bf16 v[180:183], a[112:115], a[16:19], v[180:183]
buffer_load_dwordx4 v1, s[4:7], s44 offen offset:2048 sc1 lds
v_mfma_f32_16x16x32_bf16 v[180:183], a[116:119], a[20:23], v[180:183]
v_mul_f32 v203, v203, v87
v_cvt_pk_bf16_f32 v199, v202, v203
v_mfma_f32_16x16x32_bf16 v[204:207], a[116:119], a[28:31], v[204:207]
v_mul_f32 v174, v174, v85
v_mul_f32 v175, v175, v85
v_mfma_f32_16x16x32_bf16 v[204:207], a[112:115], a[24:27], v[204:207]
s_waitcnt lgkmcnt(0)
s_barrier
v_mfma_f32_16x16x32_bf16 v[208:211], a[128:131], a[56:59], v[208:211]
ds_write_b128 v233, v[212:215] offset:21504
v_cvt_pk_bf16_f32 v173, v174, v175
v_mfma_f32_16x16x32_bf16 v[208:211], a[132:135], a[60:63], v[208:211]
buffer_load_dwordx4 v1, s[4:7], s44 offen offset:3072 sc1 lds
s_add_u32 m0, s19, 114688
v_mfma_f32_16x16x32_bf16 v[184:187], a[132:135], a[52:55], v[184:187]
s_add_u32 s44, s85, 0x1a14000
ds_write_b64 v232, v[220:221] offset:4096
v_mfma_f32_16x16x32_bf16 v[184:187], a[128:131], a[48:51], v[184:187]
ds_write_b64 v232, v[222:223] offset:4608
v_cvt_pk_bf16_f32 v132, v132, v133
v_mfma_f32_16x16x32_bf16 v[160:163], a[128:131], a[40:43], v[160:163]
ds_write_b64 v232, v[196:197] offset:3072
v_cvt_pk_bf16_f32 v156, v156, v157
v_mfma_f32_16x16x32_bf16 v[160:163], a[132:135], a[44:47], v[160:163]
buffer_load_dwordx4 v1, s[4:7], s44 offen offset:0 sc1 lds
v_mfma_f32_16x16x32_bf16 v[136:139], a[132:135], a[36:39], v[136:139]
ds_write_b64 v232, v[198:199] offset:3584
v_cvt_pk_bf16_f32 v180, v180, v181
v_mfma_f32_16x16x32_bf16 v[136:139], a[128:131], a[32:35], v[136:139]
ds_write_b64 v232, v[172:173] offset:2048
v_cvt_pk_bf16_f32 v204, v204, v205
v_mfma_f32_16x16x32_bf16 v[136:139], a[136:139], a[64:67], v[136:139]
v_cvt_pk_bf16_f32 v133, v134, v135
v_cvt_pk_bf16_f32 v157, v158, v159
v_mfma_f32_16x16x32_bf16 v[136:139], a[140:143], a[68:71], v[136:139]
v_cvt_pk_bf16_f32 v181, v182, v183
v_cvt_pk_bf16_f32 v205, v206, v207
v_mfma_f32_16x16x32_bf16 v[160:163], a[140:143], a[76:79], v[160:163]
buffer_load_dwordx4 v1, s[4:7], s44 offen offset:1024 sc1 lds
v_mfma_f32_16x16x32_bf16 v[160:163], a[136:139], a[72:75], v[160:163]
v_mul_f32 v176, v176, v85
v_mul_f32 v177, v177, v85
v_mfma_f32_16x16x32_bf16 v[184:187], a[136:139], a[80:83], v[184:187]
v_cvt_pk_bf16_f32 v174, v176, v177
v_mul_f32 v178, v178, v85
v_mfma_f32_16x16x32_bf16 v[184:187], a[140:143], a[84:87], v[184:187]
v_mul_f32 v179, v179, v85
v_cvt_pk_bf16_f32 v175, v178, v179
v_mfma_f32_16x16x32_bf16 v[208:211], a[140:143], a[92:95], v[208:211]
ds_write_b64 v232, v[174:175] offset:2560
v_mul_f32 v148, v148, v83
v_mfma_f32_16x16x32_bf16 v[208:211], a[136:139], a[88:91], v[208:211]
buffer_load_dwordx4 v1, s[4:7], s44 offen offset:2048 sc1 lds
v_mfma_f32_16x16x32_bf16 v[208:211], a[144:147], a[24:27], v[208:211]
v_mul_f32 v149, v149, v83
v_cvt_pk_bf16_f32 v148, v148, v149
v_mfma_f32_16x16x32_bf16 v[208:211], a[148:151], a[28:31], v[208:211]
v_mul_f32 v150, v150, v83
v_mul_f32 v151, v151, v83
v_mfma_f32_16x16x32_bf16 v[184:187], a[148:151], a[20:23], v[184:187]
v_cvt_pk_bf16_f32 v149, v150, v151
v_mul_f32 v152, v152, v83
v_mfma_f32_16x16x32_bf16 v[184:187], a[144:147], a[16:19], v[184:187]
ds_write_b64 v232, v[148:149] offset:1024
v_mul_f32 v153, v153, v83
v_mfma_f32_16x16x32_bf16 v[160:163], a[144:147], a[8:11], v[160:163]
buffer_load_dwordx4 v1, s[4:7], s44 offen offset:3072 sc1 lds
v_mfma_f32_16x16x32_bf16 v[160:163], a[148:151], a[12:15], v[160:163]
v_cvt_pk_bf16_f32 v150, v152, v153
v_mul_f32 v154, v154, v83
v_mfma_f32_16x16x32_bf16 v[136:139], a[148:151], a[4:7], v[136:139]
v_mul_f32 v155, v155, v83
v_cvt_pk_bf16_f32 v151, v154, v155
v_mfma_f32_16x16x32_bf16 v[136:139], a[144:147], a[0:3], v[136:139]
ds_write_b64 v232, v[150:151] offset:1536
v_mul_f32 v188, v188, v87
s_add_u32 m0, s19, 32768
buffer_load_dwordx4 v[228:231], v9, s[4:7], s55 offen sc1
buffer_load_dwordx4 v[72:75], v9, s[4:7], s55 offen offset:1024 sc1
s_add_u32 s44, s84, 0x1a00000
buffer_load_dwordx4 v1, s[4:7], s44 offen offset:0 sc1 lds
v_mul_f32 v189, v189, v87
v_pk_mul_f32 v[190:191], v[190:191], v[86:87] op_sel:[0,1] op_sel_hi:[1,1]
v_pk_mul_f32 v[166:167], v[166:167], v[84:85] op_sel:[0,1] op_sel_hi:[1,1]
v_pk_mul_f32 v[142:143], v[142:143], v[82:83] op_sel:[0,1] op_sel_hi:[1,1]
v_cvt_pk_bf16_f32 v188, v188, v189
v_pk_mul_f32 v[192:193], v[192:193], v[86:87] op_sel:[0,1] op_sel_hi:[1,1]
v_pk_mul_f32 v[194:195], v[194:195], v[86:87] op_sel:[0,1] op_sel_hi:[1,1]
v_pk_mul_f32 v[168:169], v[168:169], v[84:85] op_sel:[0,1] op_sel_hi:[1,1]
v_pk_mul_f32 v[170:171], v[170:171], v[84:85] op_sel:[0,1] op_sel_hi:[1,1]
v_pk_mul_f32 v[144:145], v[144:145], v[82:83] op_sel:[0,1] op_sel_hi:[1,1]
v_pk_mul_f32 v[146:147], v[146:147], v[82:83] op_sel:[0,1] op_sel_hi:[1,1]
v_cvt_pk_bf16_f32 v189, v190, v191
v_cvt_pk_bf16_f32 v165, v166, v167
v_cvt_pk_bf16_f32 v141, v142, v143
v_cvt_pk_bf16_f32 v190, v192, v193
v_cvt_pk_bf16_f32 v191, v194, v195
v_cvt_pk_bf16_f32 v166, v168, v169
v_cvt_pk_bf16_f32 v167, v170, v171
v_cvt_pk_bf16_f32 v142, v144, v145
v_cvt_pk_bf16_f32 v143, v146, v147
v_cvt_pk_bf16_f32 v134, v136, v137
v_cvt_pk_bf16_f32 v135, v138, v139
v_cvt_pk_bf16_f32 v158, v160, v161
v_cvt_pk_bf16_f32 v159, v162, v163
v_cvt_pk_bf16_f32 v182, v184, v185
v_cvt_pk_bf16_f32 v183, v186, v187
v_cvt_pk_bf16_f32 v206, v208, v209
buffer_load_dwordx4 v1, s[4:7], s44 offen offset:1024 sc1 lds
v_cvt_pk_bf16_f32 v207, v210, v211
buffer_load_dwordx4 v1, s[4:7], s44 offen offset:2048 sc1 lds
buffer_load_dwordx4 v1, s[4:7], s44 offen offset:3072 sc1 lds
s_waitcnt lgkmcnt(0)
s_barrier
s_add_u32 m0, s19, 131072
s_add_u32 s44, s86, 0x1a18000
buffer_load_dwordx4 v1, s[4:7], s44 offen offset:0 sc1 lds
v_mfma_f32_16x16x32_bf16 v[208:211], v[188:191], v[204:207], v[20:23]
ds_read_b64_tr_b16 a[10:11], v248 offset:3072
v_mfma_f32_16x16x32_bf16 v[224:227], v[212:215], v[204:207], v[24:27]
ds_read_b64_tr_b16 a[12:13], v248 offset:4096
v_mfma_f32_16x16x32_bf16 v[160:163], v[140:143], v[156:159], v[20:23]
ds_read_b64_tr_b16 a[22:23], v248 offset:3584
v_mfma_f32_16x16x32_bf16 v[176:179], v[164:167], v[156:159], v[24:27]
s_nop 3
v_max_f32 v224, v224, v208
v_max_f32 v225, v225, v209
v_max_f32 v226, v226, v210
v_max_f32 v227, v227, v211
v_max3_f32 v239, v224, v225, v226
v_max_f32 v239, v239, v227
ds_read_b64_tr_b16 a[24:25], v248 offset:4608
v_max_f32 v176, v176, v160
v_max_f32 v177, v177, v161
v_max_f32 v178, v178, v162
v_max_f32 v179, v179, v163
v_max3_f32 v237, v176, v177, v178
buffer_load_dwordx4 v1, s[4:7], s44 offen offset:1024 sc1 lds
v_max_f32 v237, v237, v179
v_mfma_f32_16x16x32_bf16 v[184:187], v[164:167], v[180:183], v[20:23]
s_nop 0
v_permlane32_swap_b32 v239, v237
v_max_f32 v239, v239, v237
v_mov_b32 v242, v239
v_mfma_f32_16x16x32_bf16 v[200:203], v[188:191], v[180:183], v[24:27]
s_nop 0
v_permlane16_swap_b32 v239, v242
v_max_f32 v239, v239, v242
v_mov_b32 v242, v239
ds_read_b64_tr_b16 a[6:7], v248 offset:1024
s_nop 0
v_permlane32_swap_b32 v239, v242
v_mul_f32_e64 v89, -v239, v88
v_fma_f32 v224, v224, v88, v89
v_fma_f32 v225, v225, v88, v89
v_fma_f32 v226, v226, v88, v89
v_fma_f32 v227, v227, v88, v89
v_exp_f32 v224, v224
v_exp_f32 v225, v225
v_exp_f32 v226, v226
buffer_load_dwordx4 v1, s[4:7], s44 offen offset:2048 sc1 lds
v_exp_f32 v227, v227
v_cvt_pk_bf16_f32 v224, v224, v225
v_cvt_pk_bf16_f32 v225, v226, v227
v_and_b32 v208, v224, v28
v_and_b32 v209, v225, v29
v_and_b32 v210, v224, v30
v_and_b32 v211, v225, v31
v_max_f32 v200, v200, v184
v_max_f32 v201, v201, v185
v_mfma_f32_16x16x32_bf16 v[216:219], v[16:19], v[208:211], 0
v_max_f32 v202, v202, v186
v_max_f32 v203, v203, v187
s_waitcnt lgkmcnt(3)
v_mfma_f32_16x16x32_bf16 v[116:119], a[10:13], v[208:211], 0
v_max3_f32 v238, v200, v201, v202
ds_read_b64_tr_b16 a[18:19], v248 offset:1536
s_waitcnt lgkmcnt(2)
v_mfma_f32_16x16x32_bf16 v[120:123], a[22:25], v[208:211], 0
v_rcp_f32 v216, v216
ds_read_b64_tr_b16 a[8:9], v248 offset:2048
ds_read_b64_tr_b16 a[20:21], v248 offset:2560
buffer_load_dwordx4 v1, s[4:7], s44 offen offset:3072 sc1 lds
v_pk_mul_f32 v[116:117], v[116:117], v[216:217] op_sel:[0,0] op_sel_hi:[1,0]
v_pk_mul_f32 v[118:119], v[118:119], v[216:217] op_sel:[0,0] op_sel_hi:[1,0]
v_cvt_pk_bf16_f32 v116, v116, v117
s_nop 0
v_pk_mul_f32 v[120:121], v[120:121], v[216:217] op_sel:[0,0] op_sel_hi:[1,0]
v_pk_mul_f32 v[122:123], v[122:123], v[216:217] op_sel:[0,0] op_sel_hi:[1,0]
v_cvt_pk_bf16_f32 v117, v118, v119
v_cvt_pk_bf16_f32 v118, v120, v121
v_cvt_pk_bf16_f32 v119, v122, v123
v_max_f32 v238, v238, v203
buffer_store_dwordx4 v[116:119], v2, s[4:7], s72 offen offset:3072 sc1
s_waitcnt lgkmcnt(0)
s_cmp_lg_u32 s28, 0
s_cbranch_scc1 Lhx_35
s_waitcnt vmcnt(10)
v_max3_u32 v244, v228, v229, v230
s_waitcnt vmcnt(9)
v_max3_u32 v244, v244, v231, v72
v_max3_u32 v244, v244, v73, v74
v_max_u32 v244, v244, v75
v_cmp_eq_u32 vcc, -1, v244
s_cbranch_vccnz L_hxredo2
L_hxback2:
ds_write_b128 v233, v[228:231] offset:20480
ds_write_b64 v232, v[72:73] offset:0
ds_write_b64 v232, v[74:75] offset:512
Lhx_35:
ds_read_b128 a[0:3], v233 offset:20480
v_mfma_f32_16x16x32_bf16 v[152:155], v[140:143], v[132:135], v[24:27]
v_mul_f32_e64 v85, -v242, v84
buffer_atomic_add v12, v10, s[4:7], s94 offen sc1
v_fma_f32 v176, v176, v84, v85
v_fma_f32 v177, v177, v84, v85
v_fma_f32 v178, v178, v84, v85
v_fma_f32 v179, v179, v84, v85
L_stub13:
s_cbranch_execz L_wret3
v_exp_f32 v176, v176
v_exp_f32 v177, v177
v_exp_f32 v178, v178
v_exp_f32 v179, v179
v_cvt_pk_bf16_f32 v176, v176, v177
v_cvt_pk_bf16_f32 v177, v178, v179
v_and_b32 v160, v176, v28
v_and_b32 v161, v177, v29
v_and_b32 v162, v176, v30
v_and_b32 v163, v177, v31
ds_read_b64_tr_b16 a[4:5], v248 offset:0
s_nop 0
v_mfma_f32_16x16x32_bf16 v[168:171], v[16:19], v[160:163], 0
ds_read_b64_tr_b16 a[16:17], v248 offset:512
v_mfma_f32_16x16x32_bf16 v[100:103], a[6:9], v[160:163], 0
s_waitcnt lgkmcnt(2)
v_mfma_f32_16x16x32_bf16 v[136:139], a[0:3], v[132:135], v[76:79]
s_nop 3
v_rcp_f32 v168, v168
v_mfma_f32_16x16x32_bf16 v[104:107], a[18:21], v[160:163], 0
s_nop 1
v_max_f32 v152, v152, v136
v_max_f32 v153, v153, v137
v_max_f32 v154, v154, v138
v_max_f32 v155, v155, v139
v_max3_f32 v236, v152, v153, v154
v_max_f32 v236, v236, v155
v_pk_mul_f32 v[100:101], v[100:101], v[168:169] op_sel:[0,0] op_sel_hi:[1,0]
v_pk_mul_f32 v[102:103], v[102:103], v[168:169] op_sel:[0,0] op_sel_hi:[1,0]
v_permlane32_swap_b32 v238, v236
v_max_f32 v238, v238, v236
v_mov_b32 v243, v238
v_cvt_pk_bf16_f32 v100, v100, v101
v_pk_mul_f32 v[104:105], v[104:105], v[168:169] op_sel:[0,0] op_sel_hi:[1,0]
v_permlane16_swap_b32 v238, v243
v_max_f32 v238, v238, v243
v_mov_b32 v243, v238
v_pk_mul_f32 v[106:107], v[106:107], v[168:169] op_sel:[0,0] op_sel_hi:[1,0]
v_cvt_pk_bf16_f32 v101, v102, v103
v_permlane32_swap_b32 v238, v243
v_mul_f32_e64 v87, -v238, v86
v_fma_f32 v200, v200, v86, v87
v_fma_f32 v201, v201, v86, v87
v_fma_f32 v202, v202, v86, v87
v_fma_f32 v203, v203, v86, v87
v_exp_f32 v200, v200
v_exp_f32 v201, v201
v_exp_f32 v202, v202
v_exp_f32 v203, v203
v_cvt_pk_bf16_f32 v200, v200, v201
v_cvt_pk_bf16_f32 v201, v202, v203
v_and_b32 v184, v200, v28
v_and_b32 v185, v201, v29
v_and_b32 v186, v200, v30
v_and_b32 v187, v201, v31
v_cvt_pk_bf16_f32 v102, v104, v105
v_cvt_pk_bf16_f32 v103, v106, v107
v_mfma_f32_16x16x32_bf16 v[192:195], v[16:19], v[184:187], 0
buffer_store_dwordx4 v[100:103], v2, s[4:7], s72 offen offset:1024 sc1
v_mul_f32_e64 v83, -v243, v82
v_mfma_f32_16x16x32_bf16 v[108:111], a[8:11], v[184:187], 0
v_fma_f32 v152, v152, v82, v83
v_fma_f32 v153, v153, v82, v83
v_fma_f32 v154, v154, v82, v83
v_fma_f32 v155, v155, v82, v83
v_mfma_f32_16x16x32_bf16 v[112:115], a[20:23], v[184:187], 0
v_exp_f32 v152, v152
v_exp_f32 v153, v153
v_exp_f32 v154, v154
v_exp_f32 v155, v155
v_rcp_f32 v192, v192
v_cvt_pk_bf16_f32 v152, v152, v153
v_cvt_pk_bf16_f32 v153, v154, v155
v_and_b32 v136, v152, v80
v_and_b32 v137, v153, v81
v_and_b32 v138, v152, v30
v_and_b32 v139, v153, v31
v_pk_mul_f32 v[108:109], v[108:109], v[192:193] op_sel:[0,0] op_sel_hi:[1,0]
v_pk_mul_f32 v[110:111], v[110:111], v[192:193] op_sel:[0,0] op_sel_hi:[1,0]
v_cvt_pk_bf16_f32 v108, v108, v109
v_pk_mul_f32 v[112:113], v[112:113], v[192:193] op_sel:[0,0] op_sel_hi:[1,0]
v_cvt_pk_bf16_f32 v109, v110, v111
v_pk_mul_f32 v[114:115], v[114:115], v[192:193] op_sel:[0,0] op_sel_hi:[1,0]
v_cvt_pk_bf16_f32 v110, v112, v113
v_mfma_f32_16x16x32_bf16 v[144:147], v[16:19], v[136:139], 0
v_cvt_pk_bf16_f32 v111, v114, v115
buffer_store_dwordx4 v[108:111], v2, s[4:7], s72 offen offset:2048 sc1
s_waitcnt lgkmcnt(1)
v_mfma_f32_16x16x32_bf16 v[92:95], a[4:7], v[136:139], 0
s_nop 3
v_rcp_f32 v144, v144
s_waitcnt lgkmcnt(0)
v_mfma_f32_16x16x32_bf16 v[96:99], a[16:19], v[136:139], 0
s_nop 0
v_pk_mul_f32 v[92:93], v[92:93], v[144:145] op_sel:[0,0] op_sel_hi:[1,0]
v_pk_mul_f32 v[94:95], v[94:95], v[144:145] op_sel:[0,0] op_sel_hi:[1,0]
v_cvt_pk_bf16_f32 v92, v92, v93
v_cvt_pk_bf16_f32 v93, v94, v95
s_nop 2
v_pk_mul_f32 v[96:97], v[96:97], v[144:145] op_sel:[0,0] op_sel_hi:[1,0]
v_pk_mul_f32 v[98:99], v[98:99], v[144:145] op_sel:[0,0] op_sel_hi:[1,0]
v_cvt_pk_bf16_f32 v94, v96, v97
v_cvt_pk_bf16_f32 v95, v98, v99
buffer_store_dwordx4 v[92:95], v2, s[4:7], s72 offen offset:0 sc1
s_add_u32 s92, s71, 0x20000
s_add_u32 s40, s4, 0x800000
s_addc_u32 s41, s5, 0
v_add_u32 v5, 32768, v1
v_add_u32 v6, 98304, v1
s_mov_b32 s35, s77
v_lshlrev_b32 v132, 16, v32
v_and_b32 v133, 0xffff0000, v32
v_lshlrev_b32 v134, 16, v33
v_and_b32 v135, 0xffff0000, v33
v_lshlrev_b32 v136, 16, v34
v_and_b32 v137, 0xffff0000, v34
v_lshlrev_b32 v138, 16, v35
v_and_b32 v139, 0xffff0000, v35
v_lshlrev_b32 v140, 16, v36
v_and_b32 v141, 0xffff0000, v36
v_lshlrev_b32 v142, 16, v37
v_and_b32 v143, 0xffff0000, v37
v_lshlrev_b32 v144, 16, v38
v_and_b32 v145, 0xffff0000, v38
v_lshlrev_b32 v146, 16, v39
v_and_b32 v147, 0xffff0000, v39
v_lshlrev_b32 v148, 16, v40
v_and_b32 v149, 0xffff0000, v40
v_lshlrev_b32 v150, 16, v41
v_and_b32 v151, 0xffff0000, v41
v_lshlrev_b32 v152, 16, v42
v_and_b32 v153, 0xffff0000, v42
v_lshlrev_b32 v154, 16, v43
v_and_b32 v155, 0xffff0000, v43
v_lshlrev_b32 v156, 16, v44
v_and_b32 v157, 0xffff0000, v44
v_lshlrev_b32 v158, 16, v45
v_and_b32 v159, 0xffff0000, v45
v_lshlrev_b32 v160, 16, v46
v_and_b32 v161, 0xffff0000, v46
v_lshlrev_b32 v162, 16, v47
v_and_b32 v163, 0xffff0000, v47
s_mov_b32 s95, -1
s_mov_b64 exec, 0
s_cmp_eq_u32 s28, 3
s_cbranch_scc1 L_stub14
s_cmp_eq_u32 s28, 2
s_cbranch_scc1 L_stub17
s_cmp_eq_u32 s28, 0
s_cbranch_scc1 L_stub18
L_wret5:
s_mov_b64 exec, -1
s_cmp_lg_u32 s28, 1
s_cbranch_scc1 Lpo_38
s_add_u32 s36, s11, 0x20080
s_mov_b32 s37, 0
v_mov_b32 v11, 0
buffer_atomic_add v11, v251, s[4:7], s36 offen sc0 sc1
s_sleep 4
Lpoll_36:
v_mov_b32 v234, 0
buffer_atomic_add v234, v251, s[4:7], s36 offen sc0 sc1
s_waitcnt vmcnt(1)
v_readfirstlane_b32 s38, v11
s_nop 0
s_cmp_ge_u32 s38, 32
s_cbranch_scc1 Lpe_37
v_mov_b32 v11, 0
buffer_atomic_add v11, v251, s[4:7], s36 offen sc0 sc1
s_waitcnt vmcnt(1)
v_readfirstlane_b32 s38, v234
s_nop 0
s_cmp_ge_u32 s38, 32
s_cbranch_scc1 Lpe_37
s_add_u32 s37, s37, 1
s_cmp_lt_u32 s37, 0x80000
s_cbranch_scc1 Lpoll_36
s_waitcnt vmcnt(0)
Lpo_38:
s_waitcnt vmcnt(0)
Lpe_37:
s_barrier
L_k2go2:
buffer_load_dwordx4 a[0:3], v4, s[40:43], s35 offen offset:0 sc1
buffer_load_dwordx4 a[4:7], v4, s[40:43], s35 offen offset:1024 sc1
s_add_u32 s35, s77, 4096
buffer_load_dwordx4 a[8:11], v4, s[40:43], s35 offen offset:0 sc1
buffer_load_dwordx4 a[12:15], v4, s[40:43], s35 offen offset:1024 sc1
s_add_u32 s35, s77, 16384
buffer_load_dwordx4 a[16:19], v4, s[40:43], s35 offen offset:0 sc1
buffer_load_dwordx4 a[20:23], v4, s[40:43], s35 offen offset:1024 sc1
s_add_u32 s35, s77, 20480
buffer_load_dwordx4 a[24:27], v4, s[40:43], s35 offen offset:0 sc1
buffer_load_dwordx4 a[28:31], v4, s[40:43], s35 offen offset:1024 sc1
s_add_u32 s35, s77, 32768
buffer_load_dwordx4 a[32:35], v4, s[40:43], s35 offen offset:0 sc1
buffer_load_dwordx4 a[36:39], v4, s[40:43], s35 offen offset:1024 sc1
s_add_u32 s35, s77, 36864
buffer_load_dwordx4 a[40:43], v4, s[40:43], s35 offen offset:0 sc1
buffer_load_dwordx4 a[44:47], v4, s[40:43], s35 offen offset:1024 sc1
s_add_u32 s35, s77, 49152
ds_read_b128 a[96:99], v5 offset:0
ds_read_b128 a[100:103], v5 offset:1024
ds_read_b128 a[104:107], v5 offset:2048
ds_read_b128 a[108:111], v5 offset:3072
ds_read_b128 a[112:115], v5 offset:4096
ds_read_b128 a[116:119], v5 offset:5120
ds_read_b128 a[120:123], v5 offset:6144
ds_read_b128 a[124:127], v5 offset:7168
s_waitcnt vmcnt(10) lgkmcnt(4)
v_mfma_f32_16x16x32_bf16 v[132:135], a[96:99], a[0:3], v[132:135]
ds_read_b128 a[128:131], v5 offset:8192
v_mfma_f32_16x16x32_bf16 v[148:151], a[96:99], a[4:7], v[148:151]
ds_read_b128 a[132:135], v5 offset:9216
v_mfma_f32_16x16x32_bf16 v[152:155], a[100:103], a[4:7], v[152:155]
buffer_load_dwordx4 a[48:51], v4, s[40:43], s35 offen offset:0 sc1
v_mfma_f32_16x16x32_bf16 v[136:139], a[100:103], a[0:3], v[136:139]
ds_read_b128 a[136:139], v5 offset:10240
v_mfma_f32_16x16x32_bf16 v[140:143], a[104:107], a[0:3], v[140:143]
ds_read_b128 a[140:143], v5 offset:11264
v_mfma_f32_16x16x32_bf16 v[156:159], a[104:107], a[4:7], v[156:159]
v_mfma_f32_16x16x32_bf16 v[160:163], a[108:111], a[4:7], v[160:163]
buffer_load_dwordx4 a[52:55], v4, s[40:43], s35 offen offset:1024 sc1
s_add_u32 s35, s77, 53248
v_mfma_f32_16x16x32_bf16 v[144:147], a[108:111], a[0:3], v[144:147]
s_waitcnt vmcnt(10) lgkmcnt(4)
v_mfma_f32_16x16x32_bf16 v[132:135], a[112:115], a[8:11], v[132:135]
ds_read_b128 a[96:99], v5 offset:12288
v_mfma_f32_16x16x32_bf16 v[148:151], a[112:115], a[12:15], v[148:151]
ds_read_b128 a[100:103], v5 offset:13312
v_mfma_f32_16x16x32_bf16 v[152:155], a[116:119], a[12:15], v[152:155]
buffer_load_dwordx4 a[0:3], v4, s[40:43], s35 offen offset:0 sc1
v_mfma_f32_16x16x32_bf16 v[136:139], a[116:119], a[8:11], v[136:139]
ds_read_b128 a[104:107], v5 offset:14336
v_mfma_f32_16x16x32_bf16 v[140:143], a[120:123], a[8:11], v[140:143]
ds_read_b128 a[108:111], v5 offset:15360
v_mfma_f32_16x16x32_bf16 v[156:159], a[120:123], a[12:15], v[156:159]
v_mfma_f32_16x16x32_bf16 v[160:163], a[124:127], a[12:15], v[160:163]
buffer_load_dwordx4 a[4:7], v4, s[40:43], s35 offen offset:1024 sc1
s_add_u32 s35, s77, 65536
v_mfma_f32_16x16x32_bf16 v[144:147], a[124:127], a[8:11], v[144:147]
s_waitcnt vmcnt(10) lgkmcnt(4)
v_mfma_f32_16x16x32_bf16 v[132:135], a[128:131], a[16:19], v[132:135]
ds_read_b128 a[112:115], v5 offset:16384
v_mfma_f32_16x16x32_bf16 v[148:151], a[128:131], a[20:23], v[148:151]
ds_read_b128 a[116:119], v5 offset:17408
v_mfma_f32_16x16x32_bf16 v[152:155], a[132:135], a[20:23], v[152:155]
buffer_load_dwordx4 a[8:11], v4, s[40:43], s35 offen offset:0 sc1
v_mfma_f32_16x16x32_bf16 v[136:139], a[132:135], a[16:19], v[136:139]
ds_read_b128 a[120:123], v5 offset:18432
v_mfma_f32_16x16x32_bf16 v[140:143], a[136:139], a[16:19], v[140:143]
ds_read_b128 a[124:127], v5 offset:19456
v_mfma_f32_16x16x32_bf16 v[156:159], a[136:139], a[20:23], v[156:159]
v_mfma_f32_16x16x32_bf16 v[160:163], a[140:143], a[20:23], v[160:163]
buffer_load_dwordx4 a[12:15], v4, s[40:43], s35 offen offset:1024 sc1
s_add_u32 s35, s77, 69632
v_mfma_f32_16x16x32_bf16 v[144:147], a[140:143], a[16:19], v[144:147]
s_waitcnt vmcnt(10) lgkmcnt(4)
v_mfma_f32_16x16x32_bf16 v[132:135], a[96:99], a[24:27], v[132:135]
ds_read_b128 a[128:131], v5 offset:20480
v_mfma_f32_16x16x32_bf16 v[148:151], a[96:99], a[28:31], v[148:151]
ds_read_b128 a[132:135], v5 offset:21504
v_mfma_f32_16x16x32_bf16 v[152:155], a[100:103], a[28:31], v[152:155]
buffer_load_dwordx4 a[16:19], v4, s[40:43], s35 offen offset:0 sc1
v_mfma_f32_16x16x32_bf16 v[136:139], a[100:103], a[24:27], v[136:139]
ds_read_b128 a[136:139], v5 offset:22528
v_mfma_f32_16x16x32_bf16 v[140:143], a[104:107], a[24:27], v[140:143]
ds_read_b128 a[140:143], v5 offset:23552
v_mfma_f32_16x16x32_bf16 v[156:159], a[104:107], a[28:31], v[156:159]
v_mfma_f32_16x16x32_bf16 v[160:163], a[108:111], a[28:31], v[160:163]
buffer_load_dwordx4 a[20:23], v4, s[40:43], s35 offen offset:1024 sc1
s_add_u32 s35, s77, 81920
v_mfma_f32_16x16x32_bf16 v[144:147], a[108:111], a[24:27], v[144:147]
s_waitcnt vmcnt(10) lgkmcnt(4)
v_mfma_f32_16x16x32_bf16 v[132:135], a[112:115], a[32:35], v[132:135]
ds_read_b128 a[96:99], v5 offset:24576
v_mfma_f32_16x16x32_bf16 v[148:151], a[112:115], a[36:39], v[148:151]
ds_read_b128 a[100:103], v5 offset:25600
v_mfma_f32_16x16x32_bf16 v[152:155], a[116:119], a[36:39], v[152:155]
buffer_load_dwordx4 a[24:27], v4, s[40:43], s35 offen offset:0 sc1
v_mfma_f32_16x16x32_bf16 v[136:139], a[116:119], a[32:35], v[136:139]
ds_read_b128 a[104:107], v5 offset:26624
v_mfma_f32_16x16x32_bf16 v[140:143], a[120:123], a[32:35], v[140:143]
ds_read_b128 a[108:111], v5 offset:27648
v_mfma_f32_16x16x32_bf16 v[156:159], a[120:123], a[36:39], v[156:159]
v_mfma_f32_16x16x32_bf16 v[160:163], a[124:127], a[36:39], v[160:163]
buffer_load_dwordx4 a[28:31], v4, s[40:43], s35 offen offset:1024 sc1
s_add_u32 s35, s77, 86016
v_mfma_f32_16x16x32_bf16 v[144:147], a[124:127], a[32:35], v[144:147]
s_waitcnt vmcnt(10) lgkmcnt(4)
v_mfma_f32_16x16x32_bf16 v[132:135], a[128:131], a[40:43], v[132:135]
ds_read_b128 a[112:115], v5 offset:28672
v_mfma_f32_16x16x32_bf16 v[148:151], a[128:131], a[44:47], v[148:151]
ds_read_b128 a[116:119], v5 offset:29696
v_mfma_f32_16x16x32_bf16 v[152:155], a[132:135], a[44:47], v[152:155]
buffer_load_dwordx4 a[32:35], v4, s[40:43], s35 offen offset:0 sc1
v_mfma_f32_16x16x32_bf16 v[136:139], a[132:135], a[40:43], v[136:139]
ds_read_b128 a[120:123], v5 offset:30720
v_mfma_f32_16x16x32_bf16 v[140:143], a[136:139], a[40:43], v[140:143]
ds_read_b128 a[124:127], v5 offset:31744
v_mfma_f32_16x16x32_bf16 v[156:159], a[136:139], a[44:47], v[156:159]
v_mfma_f32_16x16x32_bf16 v[160:163], a[140:143], a[44:47], v[160:163]
buffer_load_dwordx4 a[36:39], v4, s[40:43], s35 offen offset:1024 sc1
s_add_u32 s35, s77, 98304
v_mfma_f32_16x16x32_bf16 v[144:147], a[140:143], a[40:43], v[144:147]
s_waitcnt vmcnt(10) lgkmcnt(4)
v_mfma_f32_16x16x32_bf16 v[132:135], a[96:99], a[48:51], v[132:135]
ds_read_b128 a[128:131], v5 offset:32768
v_mfma_f32_16x16x32_bf16 v[148:151], a[96:99], a[52:55], v[148:151]
ds_read_b128 a[132:135], v5 offset:33792
v_mfma_f32_16x16x32_bf16 v[152:155], a[100:103], a[52:55], v[152:155]
buffer_load_dwordx4 a[40:43], v4, s[40:43], s35 offen offset:0 sc1
v_mfma_f32_16x16x32_bf16 v[136:139], a[100:103], a[48:51], v[136:139]
ds_read_b128 a[136:139], v5 offset:34816
v_mfma_f32_16x16x32_bf16 v[140:143], a[104:107], a[48:51], v[140:143]
ds_read_b128 a[140:143], v5 offset:35840
v_mfma_f32_16x16x32_bf16 v[156:159], a[104:107], a[52:55], v[156:159]
v_mfma_f32_16x16x32_bf16 v[160:163], a[108:111], a[52:55], v[160:163]
buffer_load_dwordx4 a[44:47], v4, s[40:43], s35 offen offset:1024 sc1
s_add_u32 s35, s77, 102400
v_mfma_f32_16x16x32_bf16 v[144:147], a[108:111], a[48:51], v[144:147]
s_waitcnt vmcnt(10) lgkmcnt(4)
v_mfma_f32_16x16x32_bf16 v[132:135], a[112:115], a[0:3], v[132:135]
ds_read_b128 a[96:99], v5 offset:36864
v_mfma_f32_16x16x32_bf16 v[148:151], a[112:115], a[4:7], v[148:151]
ds_read_b128 a[100:103], v5 offset:37888
v_mfma_f32_16x16x32_bf16 v[152:155], a[116:119], a[4:7], v[152:155]
buffer_load_dwordx4 a[48:51], v4, s[40:43], s35 offen offset:0 sc1
v_mfma_f32_16x16x32_bf16 v[136:139], a[116:119], a[0:3], v[136:139]
ds_read_b128 a[104:107], v5 offset:38912
v_mfma_f32_16x16x32_bf16 v[140:143], a[120:123], a[0:3], v[140:143]
ds_read_b128 a[108:111], v5 offset:39936
v_mfma_f32_16x16x32_bf16 v[156:159], a[120:123], a[4:7], v[156:159]
v_mfma_f32_16x16x32_bf16 v[160:163], a[124:127], a[4:7], v[160:163]
buffer_load_dwordx4 a[52:55], v4, s[40:43], s35 offen offset:1024 sc1
s_add_u32 s35, s77, 114688
v_mfma_f32_16x16x32_bf16 v[144:147], a[124:127], a[0:3], v[144:147]
s_waitcnt vmcnt(10) lgkmcnt(4)
v_mfma_f32_16x16x32_bf16 v[132:135], a[128:131], a[8:11], v[132:135]
ds_read_b128 a[112:115], v5 offset:40960
v_mfma_f32_16x16x32_bf16 v[148:151], a[128:131], a[12:15], v[148:151]
ds_read_b128 a[116:119], v5 offset:41984
v_mfma_f32_16x16x32_bf16 v[152:155], a[132:135], a[12:15], v[152:155]
buffer_load_dwordx4 a[0:3], v4, s[40:43], s35 offen offset:0 sc1
v_mfma_f32_16x16x32_bf16 v[136:139], a[132:135], a[8:11], v[136:139]
ds_read_b128 a[120:123], v5 offset:43008
v_mfma_f32_16x16x32_bf16 v[140:143], a[136:139], a[8:11], v[140:143]
ds_read_b128 a[124:127], v5 offset:44032
v_mfma_f32_16x16x32_bf16 v[156:159], a[136:139], a[12:15], v[156:159]
v_mfma_f32_16x16x32_bf16 v[160:163], a[140:143], a[12:15], v[160:163]
buffer_load_dwordx4 a[4:7], v4, s[40:43], s35 offen offset:1024 sc1
s_add_u32 s35, s77, 118784
v_mfma_f32_16x16x32_bf16 v[144:147], a[140:143], a[8:11], v[144:147]
s_waitcnt vmcnt(10) lgkmcnt(4)
v_mfma_f32_16x16x32_bf16 v[132:135], a[96:99], a[16:19], v[132:135]
ds_read_b128 a[128:131], v5 offset:45056
v_mfma_f32_16x16x32_bf16 v[148:151], a[96:99], a[20:23], v[148:151]
ds_read_b128 a[132:135], v5 offset:46080
v_mfma_f32_16x16x32_bf16 v[152:155], a[100:103], a[20:23], v[152:155]
buffer_load_dwordx4 a[8:11], v4, s[40:43], s35 offen offset:0 sc1
v_mfma_f32_16x16x32_bf16 v[136:139], a[100:103], a[16:19], v[136:139]
ds_read_b128 a[136:139], v5 offset:47104
v_mfma_f32_16x16x32_bf16 v[140:143], a[104:107], a[16:19], v[140:143]
ds_read_b128 a[140:143], v5 offset:48128
v_mfma_f32_16x16x32_bf16 v[156:159], a[104:107], a[20:23], v[156:159]
v_mfma_f32_16x16x32_bf16 v[160:163], a[108:111], a[20:23], v[160:163]
buffer_load_dwordx4 a[12:15], v4, s[40:43], s35 offen offset:1024 sc1
s_add_u32 s35, s77, 524288
v_mfma_f32_16x16x32_bf16 v[144:147], a[108:111], a[16:19], v[144:147]
s_waitcnt vmcnt(10) lgkmcnt(4)
v_mfma_f32_16x16x32_bf16 v[132:135], a[112:115], a[24:27], v[132:135]
ds_read_b128 a[96:99], v5 offset:49152
v_mfma_f32_16x16x32_bf16 v[148:151], a[112:115], a[28:31], v[148:151]
ds_read_b128 a[100:103], v5 offset:50176
v_mfma_f32_16x16x32_bf16 v[152:155], a[116:119], a[28:31], v[152:155]
buffer_load_dwordx4 a[16:19], v4, s[40:43], s35 offen offset:0 sc1
v_mfma_f32_16x16x32_bf16 v[136:139], a[116:119], a[24:27], v[136:139]
ds_read_b128 a[104:107], v5 offset:51200
v_mfma_f32_16x16x32_bf16 v[140:143], a[120:123], a[24:27], v[140:143]
ds_read_b128 a[108:111], v5 offset:52224
v_mfma_f32_16x16x32_bf16 v[156:159], a[120:123], a[28:31], v[156:159]
v_mfma_f32_16x16x32_bf16 v[160:163], a[124:127], a[28:31], v[160:163]
buffer_load_dwordx4 a[20:23], v4, s[40:43], s35 offen offset:1024 sc1
s_add_u32 s35, s77, 528384
v_mfma_f32_16x16x32_bf16 v[144:147], a[124:127], a[24:27], v[144:147]
s_waitcnt vmcnt(10) lgkmcnt(4)
v_mfma_f32_16x16x32_bf16 v[132:135], a[128:131], a[32:35], v[132:135]
ds_read_b128 a[112:115], v5 offset:53248
v_mfma_f32_16x16x32_bf16 v[148:151], a[128:131], a[36:39], v[148:151]
ds_read_b128 a[116:119], v5 offset:54272
v_mfma_f32_16x16x32_bf16 v[152:155], a[132:135], a[36:39], v[152:155]
buffer_load_dwordx4 a[24:27], v4, s[40:43], s35 offen offset:0 sc1
v_mfma_f32_16x16x32_bf16 v[136:139], a[132:135], a[32:35], v[136:139]
ds_read_b128 a[120:123], v5 offset:55296
v_mfma_f32_16x16x32_bf16 v[140:143], a[136:139], a[32:35], v[140:143]
ds_read_b128 a[124:127], v5 offset:56320
v_mfma_f32_16x16x32_bf16 v[156:159], a[136:139], a[36:39], v[156:159]
v_mfma_f32_16x16x32_bf16 v[160:163], a[140:143], a[36:39], v[160:163]
buffer_load_dwordx4 a[28:31], v4, s[40:43], s35 offen offset:1024 sc1
s_add_u32 s35, s77, 540672
v_mfma_f32_16x16x32_bf16 v[144:147], a[140:143], a[32:35], v[144:147]
s_waitcnt vmcnt(10) lgkmcnt(4)
v_mfma_f32_16x16x32_bf16 v[132:135], a[96:99], a[40:43], v[132:135]
ds_read_b128 a[128:131], v5 offset:57344
v_mfma_f32_16x16x32_bf16 v[148:151], a[96:99], a[44:47], v[148:151]
ds_read_b128 a[132:135], v5 offset:58368
v_mfma_f32_16x16x32_bf16 v[152:155], a[100:103], a[44:47], v[152:155]
buffer_load_dwordx4 a[32:35], v4, s[40:43], s35 offen offset:0 sc1
v_mfma_f32_16x16x32_bf16 v[136:139], a[100:103], a[40:43], v[136:139]
ds_read_b128 a[136:139], v5 offset:59392
v_mfma_f32_16x16x32_bf16 v[140:143], a[104:107], a[40:43], v[140:143]
ds_read_b128 a[140:143], v5 offset:60416
v_mfma_f32_16x16x32_bf16 v[156:159], a[104:107], a[44:47], v[156:159]
v_mfma_f32_16x16x32_bf16 v[160:163], a[108:111], a[44:47], v[160:163]
buffer_load_dwordx4 a[36:39], v4, s[40:43], s35 offen offset:1024 sc1
s_add_u32 s35, s77, 544768
v_mfma_f32_16x16x32_bf16 v[144:147], a[108:111], a[40:43], v[144:147]
s_waitcnt vmcnt(10) lgkmcnt(4)
v_mfma_f32_16x16x32_bf16 v[132:135], a[112:115], a[48:51], v[132:135]
ds_read_b128 a[96:99], v5 offset:61440
v_mfma_f32_16x16x32_bf16 v[148:151], a[112:115], a[52:55], v[148:151]
ds_read_b128 a[100:103], v5 offset:62464
v_mfma_f32_16x16x32_bf16 v[152:155], a[116:119], a[52:55], v[152:155]
buffer_load_dwordx4 a[40:43], v4, s[40:43], s35 offen offset:0 sc1
v_mfma_f32_16x16x32_bf16 v[136:139], a[116:119], a[48:51], v[136:139]
ds_read_b128 a[104:107], v5 offset:63488
v_mfma_f32_16x16x32_bf16 v[140:143], a[120:123], a[48:51], v[140:143]
ds_read_b128 a[108:111], v5 offset:64512
v_mfma_f32_16x16x32_bf16 v[156:159], a[120:123], a[52:55], v[156:159]
v_mfma_f32_16x16x32_bf16 v[160:163], a[124:127], a[52:55], v[160:163]
buffer_load_dwordx4 a[44:47], v4, s[40:43], s35 offen offset:1024 sc1
s_add_u32 s35, s77, 557056
v_mfma_f32_16x16x32_bf16 v[144:147], a[124:127], a[48:51], v[144:147]
s_waitcnt vmcnt(10) lgkmcnt(4)
v_mfma_f32_16x16x32_bf16 v[132:135], a[128:131], a[0:3], v[132:135]
ds_read_b128 a[112:115], v6 offset:0
v_mfma_f32_16x16x32_bf16 v[148:151], a[128:131], a[4:7], v[148:151]
ds_read_b128 a[116:119], v6 offset:1024
v_mfma_f32_16x16x32_bf16 v[152:155], a[132:135], a[4:7], v[152:155]
buffer_load_dwordx4 a[48:51], v4, s[40:43], s35 offen offset:0 sc1
v_mfma_f32_16x16x32_bf16 v[136:139], a[132:135], a[0:3], v[136:139]
ds_read_b128 a[120:123], v6 offset:2048
v_mfma_f32_16x16x32_bf16 v[140:143], a[136:139], a[0:3], v[140:143]
ds_read_b128 a[124:127], v6 offset:3072
v_mfma_f32_16x16x32_bf16 v[156:159], a[136:139], a[4:7], v[156:159]
v_mfma_f32_16x16x32_bf16 v[160:163], a[140:143], a[4:7], v[160:163]
buffer_load_dwordx4 a[52:55], v4, s[40:43], s35 offen offset:1024 sc1
s_add_u32 s35, s77, 561152
v_mfma_f32_16x16x32_bf16 v[144:147], a[140:143], a[0:3], v[144:147]
s_waitcnt vmcnt(10) lgkmcnt(4)
v_mfma_f32_16x16x32_bf16 v[132:135], a[96:99], a[8:11], v[132:135]
ds_read_b128 a[128:131], v6 offset:4096
v_mfma_f32_16x16x32_bf16 v[148:151], a[96:99], a[12:15], v[148:151]
ds_read_b128 a[132:135], v6 offset:5120
v_mfma_f32_16x16x32_bf16 v[152:155], a[100:103], a[12:15], v[152:155]
buffer_load_dwordx4 a[0:3], v4, s[40:43], s35 offen offset:0 sc1
v_mfma_f32_16x16x32_bf16 v[136:139], a[100:103], a[8:11], v[136:139]
ds_read_b128 a[136:139], v6 offset:6144
v_mfma_f32_16x16x32_bf16 v[140:143], a[104:107], a[8:11], v[140:143]
ds_read_b128 a[140:143], v6 offset:7168
v_mfma_f32_16x16x32_bf16 v[156:159], a[104:107], a[12:15], v[156:159]
v_mfma_f32_16x16x32_bf16 v[160:163], a[108:111], a[12:15], v[160:163]
buffer_load_dwordx4 a[4:7], v4, s[40:43], s35 offen offset:1024 sc1
s_add_u32 s35, s77, 573440
v_mfma_f32_16x16x32_bf16 v[144:147], a[108:111], a[8:11], v[144:147]
s_waitcnt vmcnt(10) lgkmcnt(4)
v_mfma_f32_16x16x32_bf16 v[132:135], a[112:115], a[16:19], v[132:135]
ds_read_b128 a[96:99], v6 offset:8192
v_mfma_f32_16x16x32_bf16 v[148:151], a[112:115], a[20:23], v[148:151]
ds_read_b128 a[100:103], v6 offset:9216
v_mfma_f32_16x16x32_bf16 v[152:155], a[116:119], a[20:23], v[152:155]
buffer_load_dwordx4 a[8:11], v4, s[40:43], s35 offen offset:0 sc1
v_mfma_f32_16x16x32_bf16 v[136:139], a[116:119], a[16:19], v[136:139]
ds_read_b128 a[104:107], v6 offset:10240
v_mfma_f32_16x16x32_bf16 v[140:143], a[120:123], a[16:19], v[140:143]
ds_read_b128 a[108:111], v6 offset:11264
v_mfma_f32_16x16x32_bf16 v[156:159], a[120:123], a[20:23], v[156:159]
v_mfma_f32_16x16x32_bf16 v[160:163], a[124:127], a[20:23], v[160:163]
buffer_load_dwordx4 a[12:15], v4, s[40:43], s35 offen offset:1024 sc1
s_add_u32 s35, s77, 577536
v_mfma_f32_16x16x32_bf16 v[144:147], a[124:127], a[16:19], v[144:147]
s_waitcnt vmcnt(10) lgkmcnt(4)
v_mfma_f32_16x16x32_bf16 v[132:135], a[128:131], a[24:27], v[132:135]
ds_read_b128 a[112:115], v6 offset:12288
v_mfma_f32_16x16x32_bf16 v[148:151], a[128:131], a[28:31], v[148:151]
ds_read_b128 a[116:119], v6 offset:13312
v_mfma_f32_16x16x32_bf16 v[152:155], a[132:135], a[28:31], v[152:155]
buffer_load_dwordx4 a[16:19], v4, s[40:43], s35 offen offset:0 sc1
v_mfma_f32_16x16x32_bf16 v[136:139], a[132:135], a[24:27], v[136:139]
ds_read_b128 a[120:123], v6 offset:14336
v_mfma_f32_16x16x32_bf16 v[140:143], a[136:139], a[24:27], v[140:143]
ds_read_b128 a[124:127], v6 offset:15360
v_mfma_f32_16x16x32_bf16 v[156:159], a[136:139], a[28:31], v[156:159]
v_mfma_f32_16x16x32_bf16 v[160:163], a[140:143], a[28:31], v[160:163]
buffer_load_dwordx4 a[20:23], v4, s[40:43], s35 offen offset:1024 sc1
s_add_u32 s35, s77, 589824
v_mfma_f32_16x16x32_bf16 v[144:147], a[140:143], a[24:27], v[144:147]
s_waitcnt vmcnt(10) lgkmcnt(4)
v_mfma_f32_16x16x32_bf16 v[132:135], a[96:99], a[32:35], v[132:135]
ds_read_b128 a[128:131], v6 offset:16384
v_mfma_f32_16x16x32_bf16 v[148:151], a[96:99], a[36:39], v[148:151]
ds_read_b128 a[132:135], v6 offset:17408
v_mfma_f32_16x16x32_bf16 v[152:155], a[100:103], a[36:39], v[152:155]
buffer_load_dwordx4 a[24:27], v4, s[40:43], s35 offen offset:0 sc1
v_mfma_f32_16x16x32_bf16 v[136:139], a[100:103], a[32:35], v[136:139]
ds_read_b128 a[136:139], v6 offset:18432
v_mfma_f32_16x16x32_bf16 v[140:143], a[104:107], a[32:35], v[140:143]
ds_read_b128 a[140:143], v6 offset:19456
v_mfma_f32_16x16x32_bf16 v[156:159], a[104:107], a[36:39], v[156:159]
v_mfma_f32_16x16x32_bf16 v[160:163], a[108:111], a[36:39], v[160:163]
buffer_load_dwordx4 a[28:31], v4, s[40:43], s35 offen offset:1024 sc1
s_add_u32 s35, s77, 593920
v_mfma_f32_16x16x32_bf16 v[144:147], a[108:111], a[32:35], v[144:147]
s_waitcnt vmcnt(10) lgkmcnt(4)
v_mfma_f32_16x16x32_bf16 v[132:135], a[112:115], a[40:43], v[132:135]
ds_read_b128 a[96:99], v6 offset:20480
v_mfma_f32_16x16x32_bf16 v[148:151], a[112:115], a[44:47], v[148:151]
ds_read_b128 a[100:103], v6 offset:21504
v_mfma_f32_16x16x32_bf16 v[152:155], a[116:119], a[44:47], v[152:155]
buffer_load_dwordx4 a[32:35], v4, s[40:43], s35 offen offset:0 sc1
v_mfma_f32_16x16x32_bf16 v[136:139], a[116:119], a[40:43], v[136:139]
ds_read_b128 a[104:107], v6 offset:22528
v_mfma_f32_16x16x32_bf16 v[140:143], a[120:123], a[40:43], v[140:143]
ds_read_b128 a[108:111], v6 offset:23552
v_mfma_f32_16x16x32_bf16 v[156:159], a[120:123], a[44:47], v[156:159]
v_mfma_f32_16x16x32_bf16 v[160:163], a[124:127], a[44:47], v[160:163]
buffer_load_dwordx4 a[36:39], v4, s[40:43], s35 offen offset:1024 sc1
s_add_u32 s35, s77, 606208
v_mfma_f32_16x16x32_bf16 v[144:147], a[124:127], a[40:43], v[144:147]
s_waitcnt vmcnt(10) lgkmcnt(4)
v_mfma_f32_16x16x32_bf16 v[132:135], a[128:131], a[48:51], v[132:135]
ds_read_b128 a[112:115], v6 offset:24576
v_mfma_f32_16x16x32_bf16 v[148:151], a[128:131], a[52:55], v[148:151]
ds_read_b128 a[116:119], v6 offset:25600
v_mfma_f32_16x16x32_bf16 v[152:155], a[132:135], a[52:55], v[152:155]
buffer_load_dwordx4 a[40:43], v4, s[40:43], s35 offen offset:0 sc1
v_mfma_f32_16x16x32_bf16 v[136:139], a[132:135], a[48:51], v[136:139]
ds_read_b128 a[120:123], v6 offset:26624
v_mfma_f32_16x16x32_bf16 v[140:143], a[136:139], a[48:51], v[140:143]
ds_read_b128 a[124:127], v6 offset:27648
v_mfma_f32_16x16x32_bf16 v[156:159], a[136:139], a[52:55], v[156:159]
v_mfma_f32_16x16x32_bf16 v[160:163], a[140:143], a[52:55], v[160:163]
buffer_load_dwordx4 a[44:47], v4, s[40:43], s35 offen offset:1024 sc1
s_add_u32 s35, s77, 610304
v_mfma_f32_16x16x32_bf16 v[144:147], a[140:143], a[48:51], v[144:147]
s_waitcnt vmcnt(10) lgkmcnt(4)
v_mfma_f32_16x16x32_bf16 v[132:135], a[96:99], a[0:3], v[132:135]
ds_read_b128 a[128:131], v6 offset:28672
v_mfma_f32_16x16x32_bf16 v[148:151], a[96:99], a[4:7], v[148:151]
ds_read_b128 a[132:135], v6 offset:29696
v_mfma_f32_16x16x32_bf16 v[152:155], a[100:103], a[4:7], v[152:155]
buffer_load_dwordx4 a[48:51], v4, s[40:43], s35 offen offset:0 sc1
v_mfma_f32_16x16x32_bf16 v[136:139], a[100:103], a[0:3], v[136:139]
ds_read_b128 a[136:139], v6 offset:30720
v_mfma_f32_16x16x32_bf16 v[140:143], a[104:107], a[0:3], v[140:143]
ds_read_b128 a[140:143], v6 offset:31744
v_mfma_f32_16x16x32_bf16 v[156:159], a[104:107], a[4:7], v[156:159]
v_mfma_f32_16x16x32_bf16 v[160:163], a[108:111], a[4:7], v[160:163]
buffer_load_dwordx4 a[52:55], v4, s[40:43], s35 offen offset:1024 sc1
s_add_u32 s35, s77, 622592
v_mfma_f32_16x16x32_bf16 v[144:147], a[108:111], a[0:3], v[144:147]
s_waitcnt vmcnt(10) lgkmcnt(4)
v_mfma_f32_16x16x32_bf16 v[132:135], a[112:115], a[8:11], v[132:135]
ds_read_b128 a[96:99], v6 offset:32768
v_mfma_f32_16x16x32_bf16 v[148:151], a[112:115], a[12:15], v[148:151]
ds_read_b128 a[100:103], v6 offset:33792
v_mfma_f32_16x16x32_bf16 v[152:155], a[116:119], a[12:15], v[152:155]
buffer_load_dwordx4 a[0:3], v4, s[40:43], s35 offen offset:0 sc1
v_mfma_f32_16x16x32_bf16 v[136:139], a[116:119], a[8:11], v[136:139]
ds_read_b128 a[104:107], v6 offset:34816
v_mfma_f32_16x16x32_bf16 v[140:143], a[120:123], a[8:11], v[140:143]
ds_read_b128 a[108:111], v6 offset:35840
v_mfma_f32_16x16x32_bf16 v[156:159], a[120:123], a[12:15], v[156:159]
v_mfma_f32_16x16x32_bf16 v[160:163], a[124:127], a[12:15], v[160:163]
buffer_load_dwordx4 a[4:7], v4, s[40:43], s35 offen offset:1024 sc1
s_add_u32 s35, s77, 626688
v_mfma_f32_16x16x32_bf16 v[144:147], a[124:127], a[8:11], v[144:147]
L_stub14:
s_cbranch_execz L_wret5
s_waitcnt vmcnt(10) lgkmcnt(4)
v_mfma_f32_16x16x32_bf16 v[132:135], a[128:131], a[16:19], v[132:135]
ds_read_b128 a[112:115], v6 offset:36864
v_mfma_f32_16x16x32_bf16 v[148:151], a[128:131], a[20:23], v[148:151]
ds_read_b128 a[116:119], v6 offset:37888
v_mfma_f32_16x16x32_bf16 v[152:155], a[132:135], a[20:23], v[152:155]
buffer_load_dwordx4 a[8:11], v4, s[40:43], s35 offen offset:0 sc1
v_mfma_f32_16x16x32_bf16 v[136:139], a[132:135], a[16:19], v[136:139]
ds_read_b128 a[120:123], v6 offset:38912
v_mfma_f32_16x16x32_bf16 v[140:143], a[136:139], a[16:19], v[140:143]
ds_read_b128 a[124:127], v6 offset:39936
v_mfma_f32_16x16x32_bf16 v[156:159], a[136:139], a[20:23], v[156:159]
v_mfma_f32_16x16x32_bf16 v[160:163], a[140:143], a[20:23], v[160:163]
buffer_load_dwordx4 a[12:15], v4, s[40:43], s35 offen offset:1024 sc1
s_add_u32 s35, s77, 638976
v_mfma_f32_16x16x32_bf16 v[144:147], a[140:143], a[16:19], v[144:147]
s_waitcnt vmcnt(10) lgkmcnt(4)
v_mfma_f32_16x16x32_bf16 v[132:135], a[96:99], a[24:27], v[132:135]
ds_read_b128 a[128:131], v6 offset:40960
v_mfma_f32_16x16x32_bf16 v[148:151], a[96:99], a[28:31], v[148:151]
ds_read_b128 a[132:135], v6 offset:41984
v_mfma_f32_16x16x32_bf16 v[152:155], a[100:103], a[28:31], v[152:155]
buffer_load_dwordx4 a[16:19], v4, s[40:43], s35 offen offset:0 sc1
v_mfma_f32_16x16x32_bf16 v[136:139], a[100:103], a[24:27], v[136:139]
ds_read_b128 a[136:139], v6 offset:43008
v_mfma_f32_16x16x32_bf16 v[140:143], a[104:107], a[24:27], v[140:143]
ds_read_b128 a[140:143], v6 offset:44032
v_mfma_f32_16x16x32_bf16 v[156:159], a[104:107], a[28:31], v[156:159]
v_mfma_f32_16x16x32_bf16 v[160:163], a[108:111], a[28:31], v[160:163]
buffer_load_dwordx4 a[20:23], v4, s[40:43], s35 offen offset:1024 sc1
s_add_u32 s35, s77, 643072
v_mfma_f32_16x16x32_bf16 v[144:147], a[108:111], a[24:27], v[144:147]
s_waitcnt vmcnt(10) lgkmcnt(4)
v_mfma_f32_16x16x32_bf16 v[132:135], a[112:115], a[32:35], v[132:135]
ds_read_b128 a[96:99], v6 offset:45056
v_mfma_f32_16x16x32_bf16 v[148:151], a[112:115], a[36:39], v[148:151]
ds_read_b128 a[100:103], v6 offset:46080
v_mfma_f32_16x16x32_bf16 v[152:155], a[116:119], a[36:39], v[152:155]
buffer_load_dwordx4 a[24:27], v4, s[40:43], s35 offen offset:0 sc1
v_mfma_f32_16x16x32_bf16 v[136:139], a[116:119], a[32:35], v[136:139]
ds_read_b128 a[104:107], v6 offset:47104
v_mfma_f32_16x16x32_bf16 v[140:143], a[120:123], a[32:35], v[140:143]
ds_read_b128 a[108:111], v6 offset:48128
v_mfma_f32_16x16x32_bf16 v[156:159], a[120:123], a[36:39], v[156:159]
v_mfma_f32_16x16x32_bf16 v[160:163], a[124:127], a[36:39], v[160:163]
buffer_load_dwordx4 a[28:31], v4, s[40:43], s35 offen offset:1024 sc1
s_add_u32 s35, s77, 1048576
v_mfma_f32_16x16x32_bf16 v[144:147], a[124:127], a[32:35], v[144:147]
s_waitcnt vmcnt(10) lgkmcnt(4)
v_mfma_f32_16x16x32_bf16 v[132:135], a[128:131], a[40:43], v[132:135]
s_add_u32 m0, s18, 0x0
s_add_u32 s44, s50, 0x2800000
v_mfma_f32_16x16x32_bf16 v[148:151], a[128:131], a[44:47], v[148:151]
ds_read_b128 a[112:115], v6 offset:49152
v_mfma_f32_16x16x32_bf16 v[152:155], a[132:135], a[44:47], v[152:155]
buffer_load_dwordx4 v1, s[4:7], s44 offen offset:0 sc1 lds
v_mfma_f32_16x16x32_bf16 v[136:139], a[132:135], a[40:43], v[136:139]
ds_read_b128 a[116:119], v6 offset:50176
v_mfma_f32_16x16x32_bf16 v[140:143], a[136:139], a[40:43], v[140:143]
ds_read_b128 a[120:123], v6 offset:51200
v_mfma_f32_16x16x32_bf16 v[156:159], a[136:139], a[44:47], v[156:159]
ds_read_b128 a[124:127], v6 offset:52224
v_mfma_f32_16x16x32_bf16 v[160:163], a[140:143], a[44:47], v[160:163]
buffer_load_dwordx4 v1, s[4:7], s44 offen offset:1024 sc1 lds
s_add_u32 m0, s18, 0x2000
v_mfma_f32_16x16x32_bf16 v[144:147], a[140:143], a[40:43], v[144:147]
s_add_u32 s44, s50, 0x2802000
s_waitcnt vmcnt(10) lgkmcnt(4)
v_mfma_f32_16x16x32_bf16 v[132:135], a[96:99], a[48:51], v[132:135]
ds_read_b128 a[128:131], v6 offset:53248
v_mfma_f32_16x16x32_bf16 v[148:151], a[96:99], a[52:55], v[148:151]
ds_read_b128 a[132:135], v6 offset:54272
v_mfma_f32_16x16x32_bf16 v[152:155], a[100:103], a[52:55], v[152:155]
buffer_load_dwordx4 v1, s[4:7], s44 offen offset:0 sc1 lds
v_mfma_f32_16x16x32_bf16 v[136:139], a[100:103], a[48:51], v[136:139]
ds_read_b128 a[136:139], v6 offset:55296
v_mfma_f32_16x16x32_bf16 v[140:143], a[104:107], a[48:51], v[140:143]
ds_read_b128 a[140:143], v6 offset:56320
v_mfma_f32_16x16x32_bf16 v[156:159], a[104:107], a[52:55], v[156:159]
v_mfma_f32_16x16x32_bf16 v[160:163], a[108:111], a[52:55], v[160:163]
buffer_load_dwordx4 v1, s[4:7], s44 offen offset:1024 sc1 lds
s_add_u32 m0, s18, 0x4000
v_mfma_f32_16x16x32_bf16 v[144:147], a[108:111], a[48:51], v[144:147]
s_add_u32 s44, s50, 0x2804000
s_waitcnt vmcnt(10) lgkmcnt(4)
v_mfma_f32_16x16x32_bf16 v[132:135], a[112:115], a[0:3], v[132:135]
ds_read_b128 a[96:99], v6 offset:57344
v_mfma_f32_16x16x32_bf16 v[148:151], a[112:115], a[4:7], v[148:151]
ds_read_b128 a[100:103], v6 offset:58368
v_mfma_f32_16x16x32_bf16 v[152:155], a[116:119], a[4:7], v[152:155]
ds_read_b128 a[104:107], v6 offset:59392
v_mfma_f32_16x16x32_bf16 v[136:139], a[116:119], a[0:3], v[136:139]
buffer_load_dwordx4 v1, s[4:7], s44 offen offset:0 sc1 lds
v_mfma_f32_16x16x32_bf16 v[140:143], a[120:123], a[0:3], v[140:143]
ds_read_b128 a[108:111], v6 offset:60416
v_mfma_f32_16x16x32_bf16 v[156:159], a[120:123], a[4:7], v[156:159]
v_mfma_f32_16x16x32_bf16 v[160:163], a[124:127], a[4:7], v[160:163]
v_mfma_f32_16x16x32_bf16 v[144:147], a[124:127], a[0:3], v[144:147]
buffer_load_dwordx4 v1, s[4:7], s44 offen offset:1024 sc1 lds
s_waitcnt vmcnt(10) lgkmcnt(4)
v_mfma_f32_16x16x32_bf16 v[132:135], a[128:131], a[8:11], v[132:135]
s_add_u32 m0, s18, 0x6000
s_add_u32 s44, s50, 0x2806000
v_mfma_f32_16x16x32_bf16 v[148:151], a[128:131], a[12:15], v[148:151]
ds_read_b128 a[112:115], v6 offset:61440
v_mfma_f32_16x16x32_bf16 v[152:155], a[132:135], a[12:15], v[152:155]
ds_read_b128 a[116:119], v6 offset:62464
v_mfma_f32_16x16x32_bf16 v[136:139], a[132:135], a[8:11], v[136:139]
ds_read_b128 a[120:123], v6 offset:63488
v_mfma_f32_16x16x32_bf16 v[140:143], a[136:139], a[8:11], v[140:143]
buffer_load_dwordx4 v1, s[4:7], s44 offen offset:0 sc1 lds
v_mfma_f32_16x16x32_bf16 v[156:159], a[136:139], a[12:15], v[156:159]
ds_read_b128 a[124:127], v6 offset:64512
v_mfma_f32_16x16x32_bf16 v[160:163], a[140:143], a[12:15], v[160:163]
v_mfma_f32_16x16x32_bf16 v[144:147], a[140:143], a[8:11], v[144:147]
s_waitcnt vmcnt(9) lgkmcnt(4)
v_mfma_f32_16x16x32_bf16 v[132:135], a[96:99], a[16:19], v[132:135]
v_mfma_f32_16x16x32_bf16 v[148:151], a[96:99], a[20:23], v[148:151]
buffer_load_dwordx4 v1, s[4:7], s44 offen offset:1024 sc1 lds
v_mfma_f32_16x16x32_bf16 v[152:155], a[100:103], a[20:23], v[152:155]
v_mfma_f32_16x16x32_bf16 v[136:139], a[100:103], a[16:19], v[136:139]
v_mfma_f32_16x16x32_bf16 v[140:143], a[104:107], a[16:19], v[140:143]
v_mfma_f32_16x16x32_bf16 v[156:159], a[104:107], a[20:23], v[156:159]
v_mfma_f32_16x16x32_bf16 v[160:163], a[108:111], a[20:23], v[160:163]
v_mfma_f32_16x16x32_bf16 v[144:147], a[108:111], a[16:19], v[144:147]
s_waitcnt vmcnt(8) lgkmcnt(0)
v_mfma_f32_16x16x32_bf16 v[132:135], a[112:115], a[24:27], v[132:135]
v_mfma_f32_16x16x32_bf16 v[148:151], a[112:115], a[28:31], v[148:151]
v_mfma_f32_16x16x32_bf16 v[152:155], a[116:119], a[28:31], v[152:155]
v_mfma_f32_16x16x32_bf16 v[136:139], a[116:119], a[24:27], v[136:139]
v_mfma_f32_16x16x32_bf16 v[140:143], a[120:123], a[24:27], v[140:143]
v_mfma_f32_16x16x32_bf16 v[156:159], a[120:123], a[28:31], v[156:159]
v_mfma_f32_16x16x32_bf16 v[160:163], a[124:127], a[28:31], v[160:163]
v_mfma_f32_16x16x32_bf16 v[144:147], a[124:127], a[24:27], v[144:147]
s_nop 1
v_cmp_u_f32 vcc, v132, v148
s_nop 0
s_and_b32 vcc_lo, vcc_lo, s95
s_cbranch_scc1 L_k2redo2
v_cvt_pk_bf16_f32 v32, v132, v133
v_cvt_pk_bf16_f32 v33, v134, v135
v_cvt_pk_bf16_f32 v34, v136, v137
v_cvt_pk_bf16_f32 v35, v138, v139
s_add_u32 s36, s69, 0x400000
buffer_store_dwordx4 v[32:35], v4, s[4:7], s36 offen offset:0 sc1
v_cvt_pk_bf16_f32 v40, v148, v149
v_cvt_pk_bf16_f32 v41, v150, v151
v_cvt_pk_bf16_f32 v42, v152, v153
v_cvt_pk_bf16_f32 v43, v154, v155
v_cvt_pk_bf16_f32 v36, v140, v141
v_cvt_pk_bf16_f32 v37, v142, v143
v_cvt_pk_bf16_f32 v38, v144, v145
v_cvt_pk_bf16_f32 v39, v146, v147
s_add_u32 s37, s36, 4096
v_cvt_pk_bf16_f32 v44, v156, v157
v_cvt_pk_bf16_f32 v45, v158, v159
v_cvt_pk_bf16_f32 v46, v160, v161
buffer_store_dwordx4 v[40:43], v4, s[4:7], s36 offen offset:1024 sc1
v_cvt_pk_bf16_f32 v47, v162, v163
v_mfma_f32_16x16x32_bf16 v[96:99], v[32:35], v[32:35], 0
s_mov_b32 s38, 0x380000
s_add_u32 s92, s78, 0x60000
v_mfma_f32_16x16x32_bf16 v[92:95], v[16:19], v[32:35], 0
s_add_u32 s40, s4, 0x400000
s_addc_u32 s41, s5, 0
v_mfma_f32_16x16x32_bf16 v[96:99], v[36:39], v[36:39], v[96:99]
buffer_store_dwordx4 v[36:39], v4, s[4:7], s37 offen offset:0 sc1
v_mfma_f32_16x16x32_bf16 v[92:95], v[16:19], v[36:39], v[92:95]
s_nop 5
v_cndmask_b32 v96, v96, v97, s[46:47]
v_cndmask_b32 v98, v98, v99, s[46:47]
v_mfma_f32_16x16x32_bf16 v[104:107], v[40:43], v[40:43], 0
v_mfma_f32_16x16x32_bf16 v[100:103], v[16:19], v[40:43], 0
v_cndmask_b32 v93, v96, v98, s[48:49]
buffer_store_dwordx4 v[44:47], v4, s[4:7], s37 offen offset:1024 sc1
v_mfma_f32_16x16x32_bf16 v[104:107], v[44:47], v[44:47], v[104:107]
v_mfma_f32_16x16x32_bf16 v[100:103], v[16:19], v[44:47], v[100:103]
s_nop 6
v_cndmask_b32 v104, v104, v105, s[46:47]
v_cndmask_b32 v106, v106, v107, s[46:47]
buffer_store_dwordx2 v[92:93], v253, s[4:7], s38 offen offset:0 sc1
v_cndmask_b32 v101, v104, v106, s[48:49]
buffer_store_dwordx2 v[100:101], v253, s[4:7], s38 offen offset:2048 sc1
s_barrier
s_add_u32 m0, s18, 0x8000
s_add_u32 s44, s50, 0x2808000
buffer_load_dwordx4 v1, s[4:7], s44 offen offset:0 sc1 lds
buffer_load_dwordx4 v1, s[4:7], s44 offen offset:1024 sc1 lds
s_add_u32 m0, s18, 0xa000
s_add_u32 s44, s50, 0x280a000
buffer_load_dwordx4 v1, s[4:7], s44 offen offset:0 sc1 lds
buffer_load_dwordx4 v1, s[4:7], s44 offen offset:1024 sc1 lds
v_accvgpr_read_b32 v48, a216
v_accvgpr_read_b32 v49, a217
v_accvgpr_read_b32 v50, a218
v_accvgpr_read_b32 v51, a219
v_accvgpr_read_b32 v52, a220
v_accvgpr_read_b32 v53, a221
v_accvgpr_read_b32 v54, a222
v_accvgpr_read_b32 v55, a223
v_accvgpr_read_b32 v56, a224
v_accvgpr_read_b32 v57, a225
v_accvgpr_read_b32 v58, a226
v_accvgpr_read_b32 v59, a227
v_accvgpr_read_b32 v60, a228
v_accvgpr_read_b32 v61, a229
v_accvgpr_read_b32 v62, a230
v_accvgpr_read_b32 v63, a231
v_accvgpr_read_b32 v64, a232
v_accvgpr_read_b32 v65, a233
v_accvgpr_read_b32 v66, a234
v_accvgpr_read_b32 v67, a235
v_accvgpr_read_b32 v68, a236
v_accvgpr_read_b32 v69, a237
v_accvgpr_read_b32 v70, a238
v_accvgpr_read_b32 v71, a239
s_waitcnt vmcnt(4)
s_barrier
s_cmp_lg_u32 s28, 0
s_cbranch_scc1 Lsg_39
buffer_atomic_add v12, v10, s[4:7], s92 offen sc1
Lsg_39:
s_mov_b64 exec, 0
s_cmp_eq_u32 s28, 0
s_cbranch_scc1 L_stub15
L_wret6:
s_mov_b64 exec, -1
s_cmp_lt_u32 s28, 2
s_cbranch_scc1 Lwd_40
s_add_u32 m0, s19, 0xa000
s_add_u32 s44, s50, 0x280a000
s_add_u32 s44, s44, s18
buffer_load_dwordx4 v1, s[4:7], s44 offen offset:0 sc1 lds
buffer_load_dwordx4 v1, s[4:7], s44 offen offset:1024 sc1 lds
buffer_load_dwordx4 v1, s[4:7], s44 offen offset:2048 sc1 lds
buffer_load_dwordx4 v1, s[4:7], s44 offen offset:3072 sc1 lds
s_add_u32 m0, s19, 0xc000
s_add_u32 s44, s50, 0x280c000
s_add_u32 s44, s44, s18
buffer_load_dwordx4 v1, s[4:7], s44 offen offset:0 sc1 lds
buffer_load_dwordx4 v1, s[4:7], s44 offen offset:1024 sc1 lds
buffer_load_dwordx4 v1, s[4:7], s44 offen offset:2048 sc1 lds
buffer_load_dwordx4 v1, s[4:7], s44 offen offset:3072 sc1 lds
s_add_u32 m0, s19, 0xe000
s_add_u32 s44, s50, 0x280e000
s_add_u32 s44, s44, s18
buffer_load_dwordx4 v1, s[4:7], s44 offen offset:0 sc1 lds
buffer_load_dwordx4 v1, s[4:7], s44 offen offset:1024 sc1 lds
buffer_load_dwordx4 v1, s[4:7], s44 offen offset:2048 sc1 lds
buffer_load_dwordx4 v1, s[4:7], s44 offen offset:3072 sc1 lds
s_add_u32 m0, s19, 0x10000
s_add_u32 s44, s50, 0x2810000
s_add_u32 s44, s44, s18
buffer_load_dwordx4 v1, s[4:7], s44 offen offset:0 sc1 lds
buffer_load_dwordx4 v1, s[4:7], s44 offen offset:1024 sc1 lds
buffer_load_dwordx4 v1, s[4:7], s44 offen offset:2048 sc1 lds
buffer_load_dwordx4 v1, s[4:7], s44 offen offset:3072 sc1 lds
s_add_u32 m0, s19, 0x12000
s_add_u32 s44, s50, 0x2812000
s_add_u32 s44, s44, s18
buffer_load_dwordx4 v1, s[4:7], s44 offen offset:0 sc1 lds
buffer_load_dwordx4 v1, s[4:7], s44 offen offset:1024 sc1 lds
buffer_load_dwordx4 v1, s[4:7], s44 offen offset:2048 sc1 lds
buffer_load_dwordx4 v1, s[4:7], s44 offen offset:3072 sc1 lds
s_add_u32 m0, s19, 0x14000
s_add_u32 s44, s50, 0x2814000
s_add_u32 s44, s44, s18
buffer_load_dwordx4 v1, s[4:7], s44 offen offset:0 sc1 lds
buffer_load_dwordx4 v1, s[4:7], s44 offen offset:1024 sc1 lds
buffer_load_dwordx4 v1, s[4:7], s44 offen offset:2048 sc1 lds
buffer_load_dwordx4 v1, s[4:7], s44 offen offset:3072 sc1 lds
s_add_u32 m0, s19, 0x16000
s_add_u32 s44, s50, 0x2816000
s_add_u32 s44, s44, s18
buffer_load_dwordx4 v1, s[4:7], s44 offen offset:0 sc1 lds
buffer_load_dwordx4 v1, s[4:7], s44 offen offset:1024 sc1 lds
buffer_load_dwordx4 v1, s[4:7], s44 offen offset:2048 sc1 lds
buffer_load_dwordx4 v1, s[4:7], s44 offen offset:3072 sc1 lds
s_add_u32 m0, s19, 0x18000
s_add_u32 s44, s50, 0x2818000
s_add_u32 s44, s44, s18
buffer_load_dwordx4 v1, s[4:7], s44 offen offset:0 sc1 lds
buffer_load_dwordx4 v1, s[4:7], s44 offen offset:1024 sc1 lds
buffer_load_dwordx4 v1, s[4:7], s44 offen offset:2048 sc1 lds
buffer_load_dwordx4 v1, s[4:7], s44 offen offset:3072 sc1 lds
Lwd_40:
s_cmp_lg_u32 s28, 1
s_cbranch_scc1 Lpo_43
s_add_u32 s36, s34, 0x60000
s_mov_b32 s37, 0
v_mov_b32 v11, 0
buffer_atomic_add v11, v251, s[4:7], s36 offen sc0 sc1
s_sleep 4
Lpoll_41:
v_mov_b32 v234, 0
buffer_atomic_add v234, v251, s[4:7], s36 offen sc0 sc1
s_waitcnt vmcnt(1)
v_readfirstlane_b32 s38, v11
s_nop 0
s_cmp_ge_u32 s38, 32
s_cbranch_scc1 Lpe_42
v_mov_b32 v11, 0
buffer_atomic_add v11, v251, s[4:7], s36 offen sc0 sc1
s_waitcnt vmcnt(1)
v_readfirstlane_b32 s38, v234
s_nop 0
s_cmp_ge_u32 s38, 32
s_cbranch_scc1 Lpe_42
s_add_u32 s37, s37, 1
s_cmp_lt_u32 s37, 0x80000
s_cbranch_scc1 Lpoll_41
s_waitcnt vmcnt(0)
Lpo_43:
s_waitcnt vmcnt(32) lgkmcnt(0)
s_cmp_ge_u32 s28, 2
s_cbranch_scc1 Lw_44
s_waitcnt vmcnt(0)
Lw_44:
Lpe_42:
s_barrier
s_mov_b32 s35, s68
s_add_u32 s33, s35, 0x1000
buffer_load_dwordx4 a[0:3], v2, s[40:43], s35 offen offset:0 sc1
buffer_load_dwordx4 a[4:7], v2, s[40:43], s33 offen offset:0 sc1
buffer_load_dwordx4 a[8:11], v2, s[40:43], s35 offen offset:1024 sc1
buffer_load_dwordx4 a[12:15], v2, s[40:43], s33 offen offset:1024 sc1
buffer_load_dwordx4 a[16:19], v2, s[40:43], s35 offen offset:2048 sc1
buffer_load_dwordx4 a[20:23], v2, s[40:43], s33 offen offset:2048 sc1
buffer_load_dwordx4 a[24:27], v2, s[40:43], s35 offen offset:3072 sc1
buffer_load_dwordx4 a[28:31], v2, s[40:43], s33 offen offset:3072 sc1
s_add_u32 s35, s35, 0x4000
s_add_u32 s33, s33, 0x4000
buffer_load_dwordx4 a[32:35], v2, s[40:43], s35 offen offset:0 sc1
buffer_load_dwordx4 a[36:39], v2, s[40:43], s33 offen offset:0 sc1
buffer_load_dwordx4 a[40:43], v2, s[40:43], s35 offen offset:1024 sc1
buffer_load_dwordx4 a[44:47], v2, s[40:43], s33 offen offset:1024 sc1
buffer_load_dwordx4 a[48:51], v2, s[40:43], s35 offen offset:2048 sc1
buffer_load_dwordx4 a[52:55], v2, s[40:43], s33 offen offset:2048 sc1
buffer_load_dwordx4 a[56:59], v2, s[40:43], s35 offen offset:3072 sc1
buffer_load_dwordx4 a[60:63], v2, s[40:43], s33 offen offset:3072 sc1
s_add_u32 s35, s35, 0x4000
s_add_u32 s33, s33, 0x4000
v_add_u32 v5, 0, v1
ds_read_b128 a[96:99], v5 offset:2048
ds_read_b128 a[100:103], v5 offset:8192
ds_read_b128 a[104:107], v5 offset:3072
ds_read_b128 a[108:111], v5 offset:9216
ds_read_b128 a[112:115], v5 offset:4096
ds_read_b128 a[116:119], v5 offset:10240
s_waitcnt vmcnt(14) lgkmcnt(4)
v_mfma_f32_16x16x32_bf16 v[140:143], a[96:99], a[0:3], 0
s_add_u32 m0, s18, 0x1c000
s_add_u32 s44, s50, 0x281c000
v_mfma_f32_16x16x32_bf16 v[140:143], a[100:103], a[4:7], v[140:143]
buffer_load_dwordx4 a[64:67], v2, s[40:43], s35 offen offset:0 sc1
s_waitcnt vmcnt(13)
v_mfma_f32_16x16x32_bf16 v[164:167], a[100:103], a[12:15], 0
ds_read_b128 a[128:131], v5 offset:5120
v_mfma_f32_16x16x32_bf16 v[164:167], a[96:99], a[8:11], v[164:167]
ds_read_b128 a[132:135], v5 offset:11264
s_waitcnt vmcnt(12)
v_mfma_f32_16x16x32_bf16 v[188:191], a[96:99], a[16:19], 0
s_waitcnt vmcnt(11)
v_mfma_f32_16x16x32_bf16 v[188:191], a[100:103], a[20:23], v[188:191]
buffer_load_dwordx4 a[68:71], v2, s[40:43], s33 offen offset:0 sc1
s_waitcnt vmcnt(10)
v_mfma_f32_16x16x32_bf16 v[212:215], a[100:103], a[28:31], 0
ds_read_b128 a[136:139], v5 offset:0
v_mfma_f32_16x16x32_bf16 v[212:215], a[96:99], a[24:27], v[212:215]
s_waitcnt lgkmcnt(6)
v_mfma_f32_16x16x32_bf16 v[216:219], a[104:107], a[24:27], 0
ds_read_b128 a[140:143], v5 offset:6144
s_waitcnt lgkmcnt(6)
v_mfma_f32_16x16x32_bf16 v[216:219], a[108:111], a[28:31], v[216:219]
v_mfma_f32_16x16x32_bf16 v[192:195], a[108:111], a[20:23], 0
buffer_load_dwordx4 v1, s[4:7], s44 offen offset:0 sc1 lds
v_mfma_f32_16x16x32_bf16 v[192:195], a[104:107], a[16:19], v[192:195]
ds_read_b128 a[144:147], v5 offset:1024
v_mfma_f32_16x16x32_bf16 v[168:171], a[104:107], a[8:11], 0
v_mfma_f32_16x16x32_bf16 v[168:171], a[108:111], a[12:15], v[168:171]
ds_read_b128 a[148:151], v5 offset:7168
v_mfma_f32_16x16x32_bf16 v[144:147], a[108:111], a[4:7], 0
v_mfma_f32_16x16x32_bf16 v[144:147], a[104:107], a[0:3], v[144:147]
buffer_load_dwordx4 a[72:75], v2, s[40:43], s35 offen offset:1024 sc1
s_waitcnt lgkmcnt(7)
v_mfma_f32_16x16x32_bf16 v[148:151], a[112:115], a[0:3], 0
s_waitcnt lgkmcnt(6)
v_mfma_f32_16x16x32_bf16 v[148:151], a[116:119], a[4:7], v[148:151]
v_mfma_f32_16x16x32_bf16 v[172:175], a[116:119], a[12:15], 0
v_mfma_f32_16x16x32_bf16 v[172:175], a[112:115], a[8:11], v[172:175]
v_mfma_f32_16x16x32_bf16 v[196:199], a[112:115], a[16:19], 0
buffer_load_dwordx4 a[76:79], v2, s[40:43], s33 offen offset:1024 sc1
v_mfma_f32_16x16x32_bf16 v[196:199], a[116:119], a[20:23], v[196:199]
v_mfma_f32_16x16x32_bf16 v[220:223], a[116:119], a[28:31], 0
v_mfma_f32_16x16x32_bf16 v[220:223], a[112:115], a[24:27], v[220:223]
s_waitcnt lgkmcnt(0)
v_mfma_f32_16x16x32_bf16 v[224:227], a[128:131], a[24:27], 0
ds_read_b128 a[96:99], v5 offset:14336
v_mfma_f32_16x16x32_bf16 v[224:227], a[132:135], a[28:31], v[224:227]
buffer_load_dwordx4 a[80:83], v2, s[40:43], s35 offen offset:2048 sc1
v_mfma_f32_16x16x32_bf16 v[200:203], a[132:135], a[20:23], 0
ds_read_b128 a[100:103], v5 offset:20480
v_mfma_f32_16x16x32_bf16 v[200:203], a[128:131], a[16:19], v[200:203]
v_mfma_f32_16x16x32_bf16 v[176:179], a[128:131], a[8:11], 0
v_mfma_f32_16x16x32_bf16 v[176:179], a[132:135], a[12:15], v[176:179]
buffer_load_dwordx4 a[84:87], v2, s[40:43], s33 offen offset:2048 sc1
v_mfma_f32_16x16x32_bf16 v[152:155], a[132:135], a[4:7], 0
ds_read_b128 a[104:107], v5 offset:15360
v_mfma_f32_16x16x32_bf16 v[152:155], a[128:131], a[0:3], v[152:155]
v_mfma_f32_16x16x32_bf16 v[132:135], a[136:139], a[0:3], 0
ds_read_b128 a[108:111], v5 offset:21504
v_mfma_f32_16x16x32_bf16 v[132:135], a[140:143], a[4:7], v[132:135]
v_mfma_f32_16x16x32_bf16 v[156:159], a[140:143], a[12:15], 0
buffer_load_dwordx4 v1, s[4:7], s44 offen offset:1024 sc1 lds
s_add_u32 m0, s18, 0x1e000
v_mfma_f32_16x16x32_bf16 v[156:159], a[136:139], a[8:11], v[156:159]
s_add_u32 s44, s50, 0x281e000
ds_read_b128 a[112:115], v5 offset:16384
v_mfma_f32_16x16x32_bf16 v[180:183], a[136:139], a[16:19], 0
v_mfma_f32_16x16x32_bf16 v[180:183], a[140:143], a[20:23], v[180:183]
ds_read_b128 a[116:119], v5 offset:22528
v_mfma_f32_16x16x32_bf16 v[204:207], a[140:143], a[28:31], 0
v_mfma_f32_16x16x32_bf16 v[204:207], a[136:139], a[24:27], v[204:207]
buffer_load_dwordx4 a[88:91], v2, s[40:43], s35 offen offset:3072 sc1
v_mfma_f32_16x16x32_bf16 v[208:211], a[144:147], a[24:27], 0
v_mfma_f32_16x16x32_bf16 v[208:211], a[148:151], a[28:31], v[208:211]
v_mfma_f32_16x16x32_bf16 v[184:187], a[148:151], a[20:23], 0
v_mfma_f32_16x16x32_bf16 v[184:187], a[144:147], a[16:19], v[184:187]
v_mfma_f32_16x16x32_bf16 v[160:163], a[144:147], a[8:11], 0
buffer_load_dwordx4 a[92:95], v2, s[40:43], s33 offen offset:3072 sc1
s_add_u32 s35, s35, 0x4000
v_mfma_f32_16x16x32_bf16 v[160:163], a[148:151], a[12:15], v[160:163]
s_add_u32 s33, s33, 0x4000
v_mfma_f32_16x16x32_bf16 v[136:139], a[148:151], a[4:7], 0
v_mfma_f32_16x16x32_bf16 v[136:139], a[144:147], a[0:3], v[136:139]
s_waitcnt vmcnt(10) lgkmcnt(0)
v_mfma_f32_16x16x32_bf16 v[140:143], a[96:99], a[32:35], v[140:143]
ds_read_b128 a[128:131], v5 offset:17408
v_mfma_f32_16x16x32_bf16 v[140:143], a[100:103], a[36:39], v[140:143]
buffer_load_dwordx4 a[0:3], v2, s[40:43], s35 offen offset:0 sc1
v_mfma_f32_16x16x32_bf16 v[164:167], a[100:103], a[44:47], v[164:167]
ds_read_b128 a[132:135], v5 offset:23552
v_mfma_f32_16x16x32_bf16 v[164:167], a[96:99], a[40:43], v[164:167]
v_mfma_f32_16x16x32_bf16 v[188:191], a[96:99], a[48:51], v[188:191]
v_mfma_f32_16x16x32_bf16 v[188:191], a[100:103], a[52:55], v[188:191]
buffer_load_dwordx4 a[4:7], v2, s[40:43], s33 offen offset:0 sc1
v_mfma_f32_16x16x32_bf16 v[212:215], a[100:103], a[60:63], v[212:215]
ds_read_b128 a[136:139], v5 offset:12288
v_mfma_f32_16x16x32_bf16 v[212:215], a[96:99], a[56:59], v[212:215]
v_mfma_f32_16x16x32_bf16 v[216:219], a[104:107], a[56:59], v[216:219]
ds_read_b128 a[140:143], v5 offset:18432
v_mfma_f32_16x16x32_bf16 v[216:219], a[108:111], a[60:63], v[216:219]
v_mfma_f32_16x16x32_bf16 v[192:195], a[108:111], a[52:55], v[192:195]
buffer_load_dwordx4 v1, s[4:7], s44 offen offset:0 sc1 lds
v_mfma_f32_16x16x32_bf16 v[192:195], a[104:107], a[48:51], v[192:195]
ds_read_b128 a[144:147], v5 offset:13312
v_mfma_f32_16x16x32_bf16 v[168:171], a[104:107], a[40:43], v[168:171]
v_mfma_f32_16x16x32_bf16 v[168:171], a[108:111], a[44:47], v[168:171]
ds_read_b128 a[148:151], v5 offset:19456
v_mfma_f32_16x16x32_bf16 v[144:147], a[108:111], a[36:39], v[144:147]
v_mfma_f32_16x16x32_bf16 v[144:147], a[104:107], a[32:35], v[144:147]
buffer_load_dwordx4 a[8:11], v2, s[40:43], s35 offen offset:1024 sc1
v_mfma_f32_16x16x32_bf16 v[148:151], a[112:115], a[32:35], v[148:151]
v_mfma_f32_16x16x32_bf16 v[148:151], a[116:119], a[36:39], v[148:151]
v_mfma_f32_16x16x32_bf16 v[172:175], a[116:119], a[44:47], v[172:175]
v_mfma_f32_16x16x32_bf16 v[172:175], a[112:115], a[40:43], v[172:175]
v_mfma_f32_16x16x32_bf16 v[196:199], a[112:115], a[48:51], v[196:199]
buffer_load_dwordx4 a[12:15], v2, s[40:43], s33 offen offset:1024 sc1
v_mfma_f32_16x16x32_bf16 v[196:199], a[116:119], a[52:55], v[196:199]
v_mfma_f32_16x16x32_bf16 v[220:223], a[116:119], a[60:63], v[220:223]
v_mfma_f32_16x16x32_bf16 v[220:223], a[112:115], a[56:59], v[220:223]
s_waitcnt lgkmcnt(0)
v_mfma_f32_16x16x32_bf16 v[224:227], a[128:131], a[56:59], v[224:227]
ds_read_b128 a[96:99], v5 offset:26624
v_mfma_f32_16x16x32_bf16 v[224:227], a[132:135], a[60:63], v[224:227]
buffer_load_dwordx4 a[16:19], v2, s[40:43], s35 offen offset:2048 sc1
v_mfma_f32_16x16x32_bf16 v[200:203], a[132:135], a[52:55], v[200:203]
ds_read_b128 a[100:103], v5 offset:32768
v_mfma_f32_16x16x32_bf16 v[200:203], a[128:131], a[48:51], v[200:203]
v_mfma_f32_16x16x32_bf16 v[176:179], a[128:131], a[40:43], v[176:179]
v_mfma_f32_16x16x32_bf16 v[176:179], a[132:135], a[44:47], v[176:179]
buffer_load_dwordx4 v1, s[4:7], s44 offen offset:1024 sc1 lds
s_add_u32 m0, s18, 0x20000
v_mfma_f32_16x16x32_bf16 v[152:155], a[132:135], a[36:39], v[152:155]
s_add_u32 s44, s50, 0x2820000
ds_read_b128 a[104:107], v5 offset:27648
v_mfma_f32_16x16x32_bf16 v[152:155], a[128:131], a[32:35], v[152:155]
v_mfma_f32_16x16x32_bf16 v[132:135], a[136:139], a[32:35], v[132:135]
ds_read_b128 a[108:111], v5 offset:33792
v_mfma_f32_16x16x32_bf16 v[132:135], a[140:143], a[36:39], v[132:135]
buffer_load_dwordx4 a[20:23], v2, s[40:43], s33 offen offset:2048 sc1
v_mfma_f32_16x16x32_bf16 v[156:159], a[140:143], a[44:47], v[156:159]
ds_read_b128 a[112:115], v5 offset:28672
v_mfma_f32_16x16x32_bf16 v[156:159], a[136:139], a[40:43], v[156:159]
v_mfma_f32_16x16x32_bf16 v[180:183], a[136:139], a[48:51], v[180:183]
v_mfma_f32_16x16x32_bf16 v[180:183], a[140:143], a[52:55], v[180:183]
buffer_load_dwordx4 a[24:27], v2, s[40:43], s35 offen offset:3072 sc1
v_mfma_f32_16x16x32_bf16 v[204:207], a[140:143], a[60:63], v[204:207]
ds_read_b128 a[116:119], v5 offset:34816
v_mfma_f32_16x16x32_bf16 v[204:207], a[136:139], a[56:59], v[204:207]
v_mfma_f32_16x16x32_bf16 v[208:211], a[144:147], a[56:59], v[208:211]
v_mfma_f32_16x16x32_bf16 v[208:211], a[148:151], a[60:63], v[208:211]
buffer_load_dwordx4 v1, s[4:7], s44 offen offset:0 sc1 lds
v_mfma_f32_16x16x32_bf16 v[184:187], a[148:151], a[52:55], v[184:187]
v_mfma_f32_16x16x32_bf16 v[184:187], a[144:147], a[48:51], v[184:187]
v_mfma_f32_16x16x32_bf16 v[160:163], a[144:147], a[40:43], v[160:163]
v_mfma_f32_16x16x32_bf16 v[160:163], a[148:151], a[44:47], v[160:163]
buffer_load_dwordx4 a[28:31], v2, s[40:43], s33 offen offset:3072 sc1
s_add_u32 s35, s35, 0x4000
v_mfma_f32_16x16x32_bf16 v[136:139], a[148:151], a[36:39], v[136:139]
s_add_u32 s33, s33, 0x4000
v_mfma_f32_16x16x32_bf16 v[136:139], a[144:147], a[32:35], v[136:139]
s_waitcnt vmcnt(11) lgkmcnt(0)
v_mfma_f32_16x16x32_bf16 v[140:143], a[96:99], a[64:67], v[140:143]
ds_read_b128 a[128:131], v5 offset:29696
v_mfma_f32_16x16x32_bf16 v[140:143], a[100:103], a[68:71], v[140:143]
buffer_load_dwordx4 a[32:35], v2, s[40:43], s35 offen offset:0 sc1
v_mfma_f32_16x16x32_bf16 v[164:167], a[100:103], a[76:79], v[164:167]
ds_read_b128 a[132:135], v5 offset:35840
v_mfma_f32_16x16x32_bf16 v[164:167], a[96:99], a[72:75], v[164:167]
v_mfma_f32_16x16x32_bf16 v[188:191], a[96:99], a[80:83], v[188:191]
v_mfma_f32_16x16x32_bf16 v[188:191], a[100:103], a[84:87], v[188:191]
buffer_load_dwordx4 a[36:39], v2, s[40:43], s33 offen offset:0 sc1
v_mfma_f32_16x16x32_bf16 v[212:215], a[100:103], a[92:95], v[212:215]
ds_read_b128 a[136:139], v5 offset:24576
v_mfma_f32_16x16x32_bf16 v[212:215], a[96:99], a[88:91], v[212:215]
v_mfma_f32_16x16x32_bf16 v[216:219], a[104:107], a[88:91], v[216:219]
ds_read_b128 a[140:143], v5 offset:30720
v_mfma_f32_16x16x32_bf16 v[216:219], a[108:111], a[92:95], v[216:219]
v_mfma_f32_16x16x32_bf16 v[192:195], a[108:111], a[84:87], v[192:195]
buffer_load_dwordx4 v1, s[4:7], s44 offen offset:1024 sc1 lds
s_add_u32 m0, s18, 0x22000
v_mfma_f32_16x16x32_bf16 v[192:195], a[104:107], a[80:83], v[192:195]
s_add_u32 s44, s50, 0x2822000
ds_read_b128 a[144:147], v5 offset:25600
v_mfma_f32_16x16x32_bf16 v[168:171], a[104:107], a[72:75], v[168:171]
v_mfma_f32_16x16x32_bf16 v[168:171], a[108:111], a[76:79], v[168:171]
ds_read_b128 a[148:151], v5 offset:31744
v_mfma_f32_16x16x32_bf16 v[144:147], a[108:111], a[68:71], v[144:147]
v_mfma_f32_16x16x32_bf16 v[144:147], a[104:107], a[64:67], v[144:147]
buffer_load_dwordx4 a[40:43], v2, s[40:43], s35 offen offset:1024 sc1
v_mfma_f32_16x16x32_bf16 v[148:151], a[112:115], a[64:67], v[148:151]
v_mfma_f32_16x16x32_bf16 v[148:151], a[116:119], a[68:71], v[148:151]
v_mfma_f32_16x16x32_bf16 v[172:175], a[116:119], a[76:79], v[172:175]
v_mfma_f32_16x16x32_bf16 v[172:175], a[112:115], a[72:75], v[172:175]
v_mfma_f32_16x16x32_bf16 v[196:199], a[112:115], a[80:83], v[196:199]
buffer_load_dwordx4 a[44:47], v2, s[40:43], s33 offen offset:1024 sc1
v_mfma_f32_16x16x32_bf16 v[196:199], a[116:119], a[84:87], v[196:199]
v_mfma_f32_16x16x32_bf16 v[220:223], a[116:119], a[92:95], v[220:223]
v_mfma_f32_16x16x32_bf16 v[220:223], a[112:115], a[88:91], v[220:223]
s_waitcnt lgkmcnt(0)
v_mfma_f32_16x16x32_bf16 v[224:227], a[128:131], a[88:91], v[224:227]
ds_read_b128 a[96:99], v5 offset:38912
v_mfma_f32_16x16x32_bf16 v[224:227], a[132:135], a[92:95], v[224:227]
buffer_load_dwordx4 a[48:51], v2, s[40:43], s35 offen offset:2048 sc1
v_mfma_f32_16x16x32_bf16 v[200:203], a[132:135], a[84:87], v[200:203]
ds_read_b128 a[100:103], v5 offset:45056
L_stub15:
s_cbranch_execz L_stub16
v_mfma_f32_16x16x32_bf16 v[200:203], a[128:131], a[80:83], v[200:203]
v_mfma_f32_16x16x32_bf16 v[176:179], a[128:131], a[72:75], v[176:179]
v_mfma_f32_16x16x32_bf16 v[176:179], a[132:135], a[76:79], v[176:179]
buffer_load_dwordx4 a[52:55], v2, s[40:43], s33 offen offset:2048 sc1
v_mfma_f32_16x16x32_bf16 v[152:155], a[132:135], a[68:71], v[152:155]
ds_read_b128 a[104:107], v5 offset:39936
v_mfma_f32_16x16x32_bf16 v[152:155], a[128:131], a[64:67], v[152:155]
v_mfma_f32_16x16x32_bf16 v[132:135], a[136:139], a[64:67], v[132:135]
ds_read_b128 a[108:111], v5 offset:46080
v_mfma_f32_16x16x32_bf16 v[132:135], a[140:143], a[68:71], v[132:135]
v_mfma_f32_16x16x32_bf16 v[156:159], a[140:143], a[76:79], v[156:159]
buffer_load_dwordx4 v1, s[4:7], s44 offen offset:0 sc1 lds
v_mfma_f32_16x16x32_bf16 v[156:159], a[136:139], a[72:75], v[156:159]
ds_read_b128 a[112:115], v5 offset:40960
v_mfma_f32_16x16x32_bf16 v[180:183], a[136:139], a[80:83], v[180:183]
v_mfma_f32_16x16x32_bf16 v[180:183], a[140:143], a[84:87], v[180:183]
ds_read_b128 a[116:119], v5 offset:47104
v_mfma_f32_16x16x32_bf16 v[204:207], a[140:143], a[92:95], v[204:207]
v_mfma_f32_16x16x32_bf16 v[204:207], a[136:139], a[88:91], v[204:207]
buffer_load_dwordx4 a[56:59], v2, s[40:43], s35 offen offset:3072 sc1
v_mfma_f32_16x16x32_bf16 v[208:211], a[144:147], a[88:91], v[208:211]
v_mfma_f32_16x16x32_bf16 v[208:211], a[148:151], a[92:95], v[208:211]
v_mfma_f32_16x16x32_bf16 v[184:187], a[148:151], a[84:87], v[184:187]
v_mfma_f32_16x16x32_bf16 v[184:187], a[144:147], a[80:83], v[184:187]
v_mfma_f32_16x16x32_bf16 v[160:163], a[144:147], a[72:75], v[160:163]
buffer_load_dwordx4 a[60:63], v2, s[40:43], s33 offen offset:3072 sc1
s_add_u32 s35, s35, 0x4000
v_mfma_f32_16x16x32_bf16 v[160:163], a[148:151], a[76:79], v[160:163]
s_add_u32 s33, s33, 0x4000
v_mfma_f32_16x16x32_bf16 v[136:139], a[148:151], a[68:71], v[136:139]
v_mfma_f32_16x16x32_bf16 v[136:139], a[144:147], a[64:67], v[136:139]
s_waitcnt vmcnt(10) lgkmcnt(0)
v_mfma_f32_16x16x32_bf16 v[140:143], a[96:99], a[0:3], v[140:143]
ds_read_b128 a[128:131], v5 offset:41984
v_mfma_f32_16x16x32_bf16 v[140:143], a[100:103], a[4:7], v[140:143]
buffer_load_dwordx4 a[64:67], v2, s[40:43], s35 offen offset:0 sc1
v_mfma_f32_16x16x32_bf16 v[164:167], a[100:103], a[12:15], v[164:167]
ds_read_b128 a[132:135], v5 offset:48128
v_mfma_f32_16x16x32_bf16 v[164:167], a[96:99], a[8:11], v[164:167]
v_mfma_f32_16x16x32_bf16 v[188:191], a[96:99], a[16:19], v[188:191]
v_mfma_f32_16x16x32_bf16 v[188:191], a[100:103], a[20:23], v[188:191]
buffer_load_dwordx4 a[68:71], v2, s[40:43], s33 offen offset:0 sc1
v_mfma_f32_16x16x32_bf16 v[212:215], a[100:103], a[28:31], v[212:215]
ds_read_b128 a[136:139], v5 offset:36864
v_mfma_f32_16x16x32_bf16 v[212:215], a[96:99], a[24:27], v[212:215]
v_mfma_f32_16x16x32_bf16 v[216:219], a[104:107], a[24:27], v[216:219]
ds_read_b128 a[140:143], v5 offset:43008
v_mfma_f32_16x16x32_bf16 v[216:219], a[108:111], a[28:31], v[216:219]
v_mfma_f32_16x16x32_bf16 v[192:195], a[108:111], a[20:23], v[192:195]
buffer_load_dwordx4 v1, s[4:7], s44 offen offset:1024 sc1 lds
s_add_u32 s88, s82, 0x380000
v_mfma_f32_16x16x32_bf16 v[192:195], a[104:107], a[16:19], v[192:195]
ds_read_b128 a[144:147], v5 offset:37888
v_mfma_f32_16x16x32_bf16 v[168:171], a[104:107], a[8:11], v[168:171]
v_mfma_f32_16x16x32_bf16 v[168:171], a[108:111], a[12:15], v[168:171]
ds_read_b128 a[148:151], v5 offset:44032
v_mfma_f32_16x16x32_bf16 v[144:147], a[108:111], a[4:7], v[144:147]
v_mfma_f32_16x16x32_bf16 v[144:147], a[104:107], a[0:3], v[144:147]
buffer_load_dwordx4 a[72:75], v2, s[40:43], s35 offen offset:1024 sc1
v_mfma_f32_16x16x32_bf16 v[148:151], a[112:115], a[0:3], v[148:151]
v_mfma_f32_16x16x32_bf16 v[148:151], a[116:119], a[4:7], v[148:151]
v_mfma_f32_16x16x32_bf16 v[172:175], a[116:119], a[12:15], v[172:175]
v_mfma_f32_16x16x32_bf16 v[172:175], a[112:115], a[8:11], v[172:175]
v_mfma_f32_16x16x32_bf16 v[196:199], a[112:115], a[16:19], v[196:199]
buffer_load_dwordx4 a[76:79], v2, s[40:43], s33 offen offset:1024 sc1
v_mfma_f32_16x16x32_bf16 v[196:199], a[116:119], a[20:23], v[196:199]
v_mfma_f32_16x16x32_bf16 v[220:223], a[116:119], a[28:31], v[220:223]
v_mfma_f32_16x16x32_bf16 v[220:223], a[112:115], a[24:27], v[220:223]
s_waitcnt lgkmcnt(0)
s_barrier
v_mfma_f32_16x16x32_bf16 v[224:227], a[128:131], a[24:27], v[224:227]
v_add_u32 v5, 49152, v1
v_mfma_f32_16x16x32_bf16 v[224:227], a[132:135], a[28:31], v[224:227]
buffer_load_dwordx4 a[80:83], v2, s[40:43], s35 offen offset:2048 sc1
v_mfma_f32_16x16x32_bf16 v[200:203], a[132:135], a[20:23], v[200:203]
ds_read_b128 a[96:99], v5 offset:2048
v_mfma_f32_16x16x32_bf16 v[200:203], a[128:131], a[16:19], v[200:203]
ds_read_b128 a[100:103], v5 offset:8192
v_mfma_f32_16x16x32_bf16 v[176:179], a[128:131], a[8:11], v[176:179]
v_mfma_f32_16x16x32_bf16 v[176:179], a[132:135], a[12:15], v[176:179]
buffer_load_dwordx4 a[84:87], v2, s[40:43], s33 offen offset:2048 sc1
v_mfma_f32_16x16x32_bf16 v[152:155], a[132:135], a[4:7], v[152:155]
ds_read_b128 a[104:107], v5 offset:3072
v_mfma_f32_16x16x32_bf16 v[152:155], a[128:131], a[0:3], v[152:155]
v_mfma_f32_16x16x32_bf16 v[132:135], a[136:139], a[0:3], v[132:135]
ds_read_b128 a[108:111], v5 offset:9216
v_mfma_f32_16x16x32_bf16 v[132:135], a[140:143], a[4:7], v[132:135]
v_mfma_f32_16x16x32_bf16 v[156:159], a[140:143], a[12:15], v[156:159]
buffer_load_dwordx4 v[92:95], v1, s[4:7], s88 offen offset:0 sc1
v_mfma_f32_16x16x32_bf16 v[156:159], a[136:139], a[8:11], v[156:159]
ds_read_b128 a[112:115], v5 offset:4096
v_mfma_f32_16x16x32_bf16 v[180:183], a[136:139], a[16:19], v[180:183]
v_mfma_f32_16x16x32_bf16 v[180:183], a[140:143], a[20:23], v[180:183]
ds_read_b128 a[116:119], v5 offset:10240
v_mfma_f32_16x16x32_bf16 v[204:207], a[140:143], a[28:31], v[204:207]
v_mfma_f32_16x16x32_bf16 v[204:207], a[136:139], a[24:27], v[204:207]
buffer_load_dwordx4 a[88:91], v2, s[40:43], s35 offen offset:3072 sc1
v_mfma_f32_16x16x32_bf16 v[208:211], a[144:147], a[24:27], v[208:211]
v_mfma_f32_16x16x32_bf16 v[208:211], a[148:151], a[28:31], v[208:211]
v_mfma_f32_16x16x32_bf16 v[184:187], a[148:151], a[20:23], v[184:187]
v_mfma_f32_16x16x32_bf16 v[184:187], a[144:147], a[16:19], v[184:187]
v_mfma_f32_16x16x32_bf16 v[160:163], a[144:147], a[8:11], v[160:163]
buffer_load_dwordx4 a[92:95], v2, s[40:43], s33 offen offset:3072 sc1
s_add_u32 s35, s35, 0x4000
v_mfma_f32_16x16x32_bf16 v[160:163], a[148:151], a[12:15], v[160:163]
s_add_u32 s33, s33, 0x4000
v_mfma_f32_16x16x32_bf16 v[136:139], a[148:151], a[4:7], v[136:139]
v_mfma_f32_16x16x32_bf16 v[136:139], a[144:147], a[0:3], v[136:139]
s_waitcnt vmcnt(10) lgkmcnt(0)
v_mfma_f32_16x16x32_bf16 v[140:143], a[96:99], a[32:35], v[140:143]
ds_read_b128 a[128:131], v5 offset:5120
v_mfma_f32_16x16x32_bf16 v[140:143], a[100:103], a[36:39], v[140:143]
buffer_load_dwordx4 a[0:3], v2, s[40:43], s35 offen offset:0 sc1
v_mfma_f32_16x16x32_bf16 v[164:167], a[100:103], a[44:47], v[164:167]
ds_read_b128 a[132:135], v5 offset:11264
v_mfma_f32_16x16x32_bf16 v[164:167], a[96:99], a[40:43], v[164:167]
v_mfma_f32_16x16x32_bf16 v[188:191], a[96:99], a[48:51], v[188:191]
v_mfma_f32_16x16x32_bf16 v[188:191], a[100:103], a[52:55], v[188:191]
buffer_load_dwordx4 a[4:7], v2, s[40:43], s33 offen offset:0 sc1
v_mfma_f32_16x16x32_bf16 v[212:215], a[100:103], a[60:63], v[212:215]
ds_read_b128 a[136:139], v5 offset:0
v_mfma_f32_16x16x32_bf16 v[212:215], a[96:99], a[56:59], v[212:215]
v_mfma_f32_16x16x32_bf16 v[216:219], a[104:107], a[56:59], v[216:219]
ds_read_b128 a[140:143], v5 offset:6144
v_mfma_f32_16x16x32_bf16 v[216:219], a[108:111], a[60:63], v[216:219]
v_mfma_f32_16x16x32_bf16 v[192:195], a[108:111], a[52:55], v[192:195]
buffer_load_dwordx4 v[96:99], v1, s[4:7], s88 offen offset:1024 sc1
v_mfma_f32_16x16x32_bf16 v[192:195], a[104:107], a[48:51], v[192:195]
ds_read_b128 a[144:147], v5 offset:1024
v_mfma_f32_16x16x32_bf16 v[168:171], a[104:107], a[40:43], v[168:171]
v_mfma_f32_16x16x32_bf16 v[168:171], a[108:111], a[44:47], v[168:171]
ds_read_b128 a[148:151], v5 offset:7168
v_mfma_f32_16x16x32_bf16 v[144:147], a[108:111], a[36:39], v[144:147]
v_mfma_f32_16x16x32_bf16 v[144:147], a[104:107], a[32:35], v[144:147]
buffer_load_dwordx4 a[8:11], v2, s[40:43], s35 offen offset:1024 sc1
v_mfma_f32_16x16x32_bf16 v[148:151], a[112:115], a[32:35], v[148:151]
v_mfma_f32_16x16x32_bf16 v[148:151], a[116:119], a[36:39], v[148:151]
v_mfma_f32_16x16x32_bf16 v[172:175], a[116:119], a[44:47], v[172:175]
v_mfma_f32_16x16x32_bf16 v[172:175], a[112:115], a[40:43], v[172:175]
v_mfma_f32_16x16x32_bf16 v[196:199], a[112:115], a[48:51], v[196:199]
buffer_load_dwordx4 a[12:15], v2, s[40:43], s33 offen offset:1024 sc1
v_mfma_f32_16x16x32_bf16 v[196:199], a[116:119], a[52:55], v[196:199]
v_mfma_f32_16x16x32_bf16 v[220:223], a[116:119], a[60:63], v[220:223]
v_mfma_f32_16x16x32_bf16 v[220:223], a[112:115], a[56:59], v[220:223]
s_waitcnt lgkmcnt(0)
v_mfma_f32_16x16x32_bf16 v[224:227], a[128:131], a[56:59], v[224:227]
ds_read_b128 a[96:99], v5 offset:14336
v_mfma_f32_16x16x32_bf16 v[224:227], a[132:135], a[60:63], v[224:227]
buffer_load_dwordx4 a[16:19], v2, s[40:43], s35 offen offset:2048 sc1
v_mfma_f32_16x16x32_bf16 v[200:203], a[132:135], a[52:55], v[200:203]
ds_read_b128 a[100:103], v5 offset:20480
v_mfma_f32_16x16x32_bf16 v[200:203], a[128:131], a[48:51], v[200:203]
v_mfma_f32_16x16x32_bf16 v[176:179], a[128:131], a[40:43], v[176:179]
v_mfma_f32_16x16x32_bf16 v[176:179], a[132:135], a[44:47], v[176:179]
buffer_load_dwordx4 v[100:103], v1, s[4:7], s88 offen offset:2048 sc1
v_mfma_f32_16x16x32_bf16 v[152:155], a[132:135], a[36:39], v[152:155]
ds_read_b128 a[104:107], v5 offset:15360
v_mfma_f32_16x16x32_bf16 v[152:155], a[128:131], a[32:35], v[152:155]
v_mfma_f32_16x16x32_bf16 v[132:135], a[136:139], a[32:35], v[132:135]
ds_read_b128 a[108:111], v5 offset:21504
v_mfma_f32_16x16x32_bf16 v[132:135], a[140:143], a[36:39], v[132:135]
buffer_load_dwordx4 a[20:23], v2, s[40:43], s33 offen offset:2048 sc1
v_mfma_f32_16x16x32_bf16 v[156:159], a[140:143], a[44:47], v[156:159]
ds_read_b128 a[112:115], v5 offset:16384
v_mfma_f32_16x16x32_bf16 v[156:159], a[136:139], a[40:43], v[156:159]
v_mfma_f32_16x16x32_bf16 v[180:183], a[136:139], a[48:51], v[180:183]
v_mfma_f32_16x16x32_bf16 v[180:183], a[140:143], a[52:55], v[180:183]
buffer_load_dwordx4 a[24:27], v2, s[40:43], s35 offen offset:3072 sc1
v_mfma_f32_16x16x32_bf16 v[204:207], a[140:143], a[60:63], v[204:207]
ds_read_b128 a[116:119], v5 offset:22528
v_mfma_f32_16x16x32_bf16 v[204:207], a[136:139], a[56:59], v[204:207]
v_mfma_f32_16x16x32_bf16 v[208:211], a[144:147], a[56:59], v[208:211]
v_mfma_f32_16x16x32_bf16 v[208:211], a[148:151], a[60:63], v[208:211]
buffer_load_dwordx4 v[104:107], v1, s[4:7], s88 offen offset:3072 sc1
s_add_u32 s88, s88, 4096
v_mfma_f32_16x16x32_bf16 v[184:187], a[148:151], a[52:55], v[184:187]
v_mfma_f32_16x16x32_bf16 v[184:187], a[144:147], a[48:51], v[184:187]
v_mfma_f32_16x16x32_bf16 v[160:163], a[144:147], a[40:43], v[160:163]
v_mfma_f32_16x16x32_bf16 v[160:163], a[148:151], a[44:47], v[160:163]
buffer_load_dwordx4 a[28:31], v2, s[40:43], s33 offen offset:3072 sc1
s_add_u32 s35, s35, 0x4000
v_mfma_f32_16x16x32_bf16 v[136:139], a[148:151], a[36:39], v[136:139]
s_add_u32 s33, s33, 0x4000
v_mfma_f32_16x16x32_bf16 v[136:139], a[144:147], a[32:35], v[136:139]
s_waitcnt vmcnt(11) lgkmcnt(0)
v_mfma_f32_16x16x32_bf16 v[140:143], a[96:99], a[64:67], v[140:143]
ds_read_b128 a[128:131], v5 offset:17408
v_mfma_f32_16x16x32_bf16 v[140:143], a[100:103], a[68:71], v[140:143]
buffer_load_dwordx4 a[32:35], v2, s[40:43], s35 offen offset:0 sc1
v_mfma_f32_16x16x32_bf16 v[164:167], a[100:103], a[76:79], v[164:167]
ds_read_b128 a[132:135], v5 offset:23552
v_mfma_f32_16x16x32_bf16 v[164:167], a[96:99], a[72:75], v[164:167]
v_mfma_f32_16x16x32_bf16 v[188:191], a[96:99], a[80:83], v[188:191]
v_mfma_f32_16x16x32_bf16 v[188:191], a[100:103], a[84:87], v[188:191]
buffer_load_dwordx4 a[36:39], v2, s[40:43], s33 offen offset:0 sc1
v_mfma_f32_16x16x32_bf16 v[212:215], a[100:103], a[92:95], v[212:215]
ds_read_b128 a[136:139], v5 offset:12288
v_mfma_f32_16x16x32_bf16 v[212:215], a[96:99], a[88:91], v[212:215]
v_mfma_f32_16x16x32_bf16 v[216:219], a[104:107], a[88:91], v[216:219]
ds_read_b128 a[140:143], v5 offset:18432
v_mfma_f32_16x16x32_bf16 v[216:219], a[108:111], a[92:95], v[216:219]
v_mfma_f32_16x16x32_bf16 v[192:195], a[108:111], a[84:87], v[192:195]
buffer_load_dwordx4 v[108:111], v1, s[4:7], s88 offen offset:0 sc1
v_mfma_f32_16x16x32_bf16 v[192:195], a[104:107], a[80:83], v[192:195]
ds_read_b128 a[144:147], v5 offset:13312
v_mfma_f32_16x16x32_bf16 v[168:171], a[104:107], a[72:75], v[168:171]
v_mfma_f32_16x16x32_bf16 v[168:171], a[108:111], a[76:79], v[168:171]
ds_read_b128 a[148:151], v5 offset:19456
v_mfma_f32_16x16x32_bf16 v[144:147], a[108:111], a[68:71], v[144:147]
v_mfma_f32_16x16x32_bf16 v[144:147], a[104:107], a[64:67], v[144:147]
buffer_load_dwordx4 a[40:43], v2, s[40:43], s35 offen offset:1024 sc1
v_mfma_f32_16x16x32_bf16 v[148:151], a[112:115], a[64:67], v[148:151]
v_mfma_f32_16x16x32_bf16 v[148:151], a[116:119], a[68:71], v[148:151]
v_mfma_f32_16x16x32_bf16 v[172:175], a[116:119], a[76:79], v[172:175]
v_mfma_f32_16x16x32_bf16 v[172:175], a[112:115], a[72:75], v[172:175]
v_mfma_f32_16x16x32_bf16 v[196:199], a[112:115], a[80:83], v[196:199]
buffer_load_dwordx4 a[44:47], v2, s[40:43], s33 offen offset:1024 sc1
v_mfma_f32_16x16x32_bf16 v[196:199], a[116:119], a[84:87], v[196:199]
v_mfma_f32_16x16x32_bf16 v[220:223], a[116:119], a[92:95], v[220:223]
v_mfma_f32_16x16x32_bf16 v[220:223], a[112:115], a[88:91], v[220:223]
s_waitcnt lgkmcnt(0)
v_mfma_f32_16x16x32_bf16 v[224:227], a[128:131], a[88:91], v[224:227]
ds_read_b128 a[96:99], v5 offset:26624
v_mfma_f32_16x16x32_bf16 v[224:227], a[132:135], a[92:95], v[224:227]
buffer_load_dwordx4 a[48:51], v2, s[40:43], s35 offen offset:2048 sc1
v_mfma_f32_16x16x32_bf16 v[200:203], a[132:135], a[84:87], v[200:203]
ds_read_b128 a[100:103], v5 offset:32768
v_mfma_f32_16x16x32_bf16 v[200:203], a[128:131], a[80:83], v[200:203]
v_mfma_f32_16x16x32_bf16 v[176:179], a[128:131], a[72:75], v[176:179]
v_mfma_f32_16x16x32_bf16 v[176:179], a[132:135], a[76:79], v[176:179]
buffer_load_dwordx4 a[52:55], v2, s[40:43], s33 offen offset:2048 sc1
v_mfma_f32_16x16x32_bf16 v[152:155], a[132:135], a[68:71], v[152:155]
ds_read_b128 a[104:107], v5 offset:27648
v_mfma_f32_16x16x32_bf16 v[152:155], a[128:131], a[64:67], v[152:155]
v_mfma_f32_16x16x32_bf16 v[132:135], a[136:139], a[64:67], v[132:135]
ds_read_b128 a[108:111], v5 offset:33792
v_mfma_f32_16x16x32_bf16 v[132:135], a[140:143], a[68:71], v[132:135]
v_mfma_f32_16x16x32_bf16 v[156:159], a[140:143], a[76:79], v[156:159]
buffer_load_dwordx4 v[112:115], v1, s[4:7], s88 offen offset:1024 sc1
v_mfma_f32_16x16x32_bf16 v[156:159], a[136:139], a[72:75], v[156:159]
ds_read_b128 a[112:115], v5 offset:28672
v_mfma_f32_16x16x32_bf16 v[180:183], a[136:139], a[80:83], v[180:183]
v_mfma_f32_16x16x32_bf16 v[180:183], a[140:143], a[84:87], v[180:183]
ds_read_b128 a[116:119], v5 offset:34816
v_mfma_f32_16x16x32_bf16 v[204:207], a[140:143], a[92:95], v[204:207]
v_mfma_f32_16x16x32_bf16 v[204:207], a[136:139], a[88:91], v[204:207]
buffer_load_dwordx4 a[56:59], v2, s[40:43], s35 offen offset:3072 sc1
v_mfma_f32_16x16x32_bf16 v[208:211], a[144:147], a[88:91], v[208:211]
v_mfma_f32_16x16x32_bf16 v[208:211], a[148:151], a[92:95], v[208:211]
v_mfma_f32_16x16x32_bf16 v[184:187], a[148:151], a[84:87], v[184:187]
v_mfma_f32_16x16x32_bf16 v[184:187], a[144:147], a[80:83], v[184:187]
v_mfma_f32_16x16x32_bf16 v[160:163], a[144:147], a[72:75], v[160:163]
buffer_load_dwordx4 a[60:63], v2, s[40:43], s33 offen offset:3072 sc1
s_add_u32 s35, s35, 0x64000
v_mfma_f32_16x16x32_bf16 v[160:163], a[148:151], a[76:79], v[160:163]
s_add_u32 s33, s33, 0x64000
v_mfma_f32_16x16x32_bf16 v[136:139], a[148:151], a[68:71], v[136:139]
v_mfma_f32_16x16x32_bf16 v[136:139], a[144:147], a[64:67], v[136:139]
s_waitcnt vmcnt(10) lgkmcnt(0)
v_mfma_f32_16x16x32_bf16 v[140:143], a[96:99], a[0:3], v[140:143]
ds_read_b128 a[128:131], v5 offset:29696
v_mfma_f32_16x16x32_bf16 v[140:143], a[100:103], a[4:7], v[140:143]
buffer_load_dwordx4 a[64:67], v2, s[40:43], s35 offen offset:0 sc1
v_mfma_f32_16x16x32_bf16 v[164:167], a[100:103], a[12:15], v[164:167]
ds_read_b128 a[132:135], v5 offset:35840
v_mfma_f32_16x16x32_bf16 v[164:167], a[96:99], a[8:11], v[164:167]
v_mfma_f32_16x16x32_bf16 v[188:191], a[96:99], a[16:19], v[188:191]
v_mfma_f32_16x16x32_bf16 v[188:191], a[100:103], a[20:23], v[188:191]
buffer_load_dwordx4 a[68:71], v2, s[40:43], s33 offen offset:0 sc1
v_mfma_f32_16x16x32_bf16 v[212:215], a[100:103], a[28:31], v[212:215]
ds_read_b128 a[136:139], v5 offset:24576
v_mfma_f32_16x16x32_bf16 v[212:215], a[96:99], a[24:27], v[212:215]
v_mfma_f32_16x16x32_bf16 v[216:219], a[104:107], a[24:27], v[216:219]
ds_read_b128 a[140:143], v5 offset:30720
v_mfma_f32_16x16x32_bf16 v[216:219], a[108:111], a[28:31], v[216:219]
v_mfma_f32_16x16x32_bf16 v[192:195], a[108:111], a[20:23], v[192:195]
buffer_load_dwordx4 v[116:119], v1, s[4:7], s88 offen offset:2048 sc1
v_mfma_f32_16x16x32_bf16 v[192:195], a[104:107], a[16:19], v[192:195]
ds_read_b128 a[144:147], v5 offset:25600
v_mfma_f32_16x16x32_bf16 v[168:171], a[104:107], a[8:11], v[168:171]
v_mfma_f32_16x16x32_bf16 v[168:171], a[108:111], a[12:15], v[168:171]
ds_read_b128 a[148:151], v5 offset:31744
v_mfma_f32_16x16x32_bf16 v[144:147], a[108:111], a[4:7], v[144:147]
v_mfma_f32_16x16x32_bf16 v[144:147], a[104:107], a[0:3], v[144:147]
buffer_load_dwordx4 a[72:75], v2, s[40:43], s35 offen offset:1024 sc1
v_mfma_f32_16x16x32_bf16 v[148:151], a[112:115], a[0:3], v[148:151]
v_mfma_f32_16x16x32_bf16 v[148:151], a[116:119], a[4:7], v[148:151]
v_mfma_f32_16x16x32_bf16 v[172:175], a[116:119], a[12:15], v[172:175]
v_mfma_f32_16x16x32_bf16 v[172:175], a[112:115], a[8:11], v[172:175]
v_mfma_f32_16x16x32_bf16 v[196:199], a[112:115], a[16:19], v[196:199]
buffer_load_dwordx4 a[76:79], v2, s[40:43], s33 offen offset:1024 sc1
v_mfma_f32_16x16x32_bf16 v[196:199], a[116:119], a[20:23], v[196:199]
v_mfma_f32_16x16x32_bf16 v[220:223], a[116:119], a[28:31], v[220:223]
v_mfma_f32_16x16x32_bf16 v[220:223], a[112:115], a[24:27], v[220:223]
s_waitcnt lgkmcnt(0)
v_mfma_f32_16x16x32_bf16 v[224:227], a[128:131], a[24:27], v[224:227]
ds_read_b128 a[96:99], v5 offset:38912
v_mfma_f32_16x16x32_bf16 v[224:227], a[132:135], a[28:31], v[224:227]
buffer_load_dwordx4 a[80:83], v2, s[40:43], s35 offen offset:2048 sc1
v_mfma_f32_16x16x32_bf16 v[200:203], a[132:135], a[20:23], v[200:203]
ds_read_b128 a[100:103], v5 offset:45056
v_mfma_f32_16x16x32_bf16 v[200:203], a[128:131], a[16:19], v[200:203]
v_mfma_f32_16x16x32_bf16 v[176:179], a[128:131], a[8:11], v[176:179]
v_mfma_f32_16x16x32_bf16 v[176:179], a[132:135], a[12:15], v[176:179]
buffer_load_dwordx4 a[84:87], v2, s[40:43], s33 offen offset:2048 sc1
v_mfma_f32_16x16x32_bf16 v[152:155], a[132:135], a[4:7], v[152:155]
ds_read_b128 a[104:107], v5 offset:39936
v_mfma_f32_16x16x32_bf16 v[152:155], a[128:131], a[0:3], v[152:155]
v_mfma_f32_16x16x32_bf16 v[132:135], a[136:139], a[0:3], v[132:135]
ds_read_b128 a[108:111], v5 offset:46080
v_mfma_f32_16x16x32_bf16 v[132:135], a[140:143], a[4:7], v[132:135]
v_mfma_f32_16x16x32_bf16 v[156:159], a[140:143], a[12:15], v[156:159]
buffer_load_dwordx4 v[120:123], v1, s[4:7], s88 offen offset:3072 sc1
s_add_u32 m0, s18, 0x0
v_mfma_f32_16x16x32_bf16 v[156:159], a[136:139], a[8:11], v[156:159]
s_add_u32 s44, s50, 0x2824000
ds_read_b128 a[112:115], v5 offset:40960
v_mfma_f32_16x16x32_bf16 v[180:183], a[136:139], a[16:19], v[180:183]
v_mfma_f32_16x16x32_bf16 v[180:183], a[140:143], a[20:23], v[180:183]
ds_read_b128 a[116:119], v5 offset:47104
v_mfma_f32_16x16x32_bf16 v[204:207], a[140:143], a[28:31], v[204:207]
v_mfma_f32_16x16x32_bf16 v[204:207], a[136:139], a[24:27], v[204:207]
buffer_load_dwordx4 a[88:91], v2, s[40:43], s35 offen offset:3072 sc1
v_mfma_f32_16x16x32_bf16 v[208:211], a[144:147], a[24:27], v[208:211]
v_mfma_f32_16x16x32_bf16 v[208:211], a[148:151], a[28:31], v[208:211]
v_mfma_f32_16x16x32_bf16 v[184:187], a[148:151], a[20:23], v[184:187]
v_mfma_f32_16x16x32_bf16 v[184:187], a[144:147], a[16:19], v[184:187]
v_mfma_f32_16x16x32_bf16 v[160:163], a[144:147], a[8:11], v[160:163]
buffer_load_dwordx4 a[92:95], v2, s[40:43], s33 offen offset:3072 sc1
s_add_u32 s35, s35, 0x4000
v_mfma_f32_16x16x32_bf16 v[160:163], a[148:151], a[12:15], v[160:163]
s_add_u32 s33, s33, 0x4000
v_mfma_f32_16x16x32_bf16 v[136:139], a[148:151], a[4:7], v[136:139]
v_mfma_f32_16x16x32_bf16 v[136:139], a[144:147], a[0:3], v[136:139]
s_waitcnt vmcnt(10) lgkmcnt(0)
v_mfma_f32_16x16x32_bf16 v[140:143], a[96:99], a[32:35], v[140:143]
ds_read_b128 a[128:131], v5 offset:41984
v_mfma_f32_16x16x32_bf16 v[140:143], a[100:103], a[36:39], v[140:143]
buffer_load_dwordx4 a[0:3], v2, s[40:43], s35 offen offset:0 sc1
v_mfma_f32_16x16x32_bf16 v[164:167], a[100:103], a[44:47], v[164:167]
ds_read_b128 a[132:135], v5 offset:48128
v_mfma_f32_16x16x32_bf16 v[164:167], a[96:99], a[40:43], v[164:167]
v_mfma_f32_16x16x32_bf16 v[188:191], a[96:99], a[48:51], v[188:191]
v_mfma_f32_16x16x32_bf16 v[188:191], a[100:103], a[52:55], v[188:191]
buffer_load_dwordx4 v1, s[4:7], s44 offen offset:0 sc1 lds
v_mfma_f32_16x16x32_bf16 v[212:215], a[100:103], a[60:63], v[212:215]
ds_read_b128 a[136:139], v5 offset:36864
v_mfma_f32_16x16x32_bf16 v[212:215], a[96:99], a[56:59], v[212:215]
v_mfma_f32_16x16x32_bf16 v[216:219], a[104:107], a[56:59], v[216:219]
ds_read_b128 a[140:143], v5 offset:43008
v_mfma_f32_16x16x32_bf16 v[216:219], a[108:111], a[60:63], v[216:219]
buffer_load_dwordx4 a[4:7], v2, s[40:43], s33 offen offset:0 sc1
v_mfma_f32_16x16x32_bf16 v[192:195], a[108:111], a[52:55], v[192:195]
ds_read_b128 a[144:147], v5 offset:37888
v_mfma_f32_16x16x32_bf16 v[192:195], a[104:107], a[48:51], v[192:195]
v_mfma_f32_16x16x32_bf16 v[168:171], a[104:107], a[40:43], v[168:171]
v_mfma_f32_16x16x32_bf16 v[168:171], a[108:111], a[44:47], v[168:171]
buffer_load_dwordx4 a[8:11], v2, s[40:43], s35 offen offset:1024 sc1
v_mfma_f32_16x16x32_bf16 v[144:147], a[108:111], a[36:39], v[144:147]
ds_read_b128 a[148:151], v5 offset:44032
v_mfma_f32_16x16x32_bf16 v[144:147], a[104:107], a[32:35], v[144:147]
v_mfma_f32_16x16x32_bf16 v[148:151], a[112:115], a[32:35], v[148:151]
v_mfma_f32_16x16x32_bf16 v[148:151], a[116:119], a[36:39], v[148:151]
buffer_load_dwordx4 v1, s[4:7], s44 offen offset:1024 sc1 lds
s_add_u32 m0, s18, 0x2000
v_mfma_f32_16x16x32_bf16 v[172:175], a[116:119], a[44:47], v[172:175]
s_add_u32 s44, s50, 0x2826000
v_mfma_f32_16x16x32_bf16 v[172:175], a[112:115], a[40:43], v[172:175]
v_mfma_f32_16x16x32_bf16 v[196:199], a[112:115], a[48:51], v[196:199]
v_mfma_f32_16x16x32_bf16 v[196:199], a[116:119], a[52:55], v[196:199]
buffer_load_dwordx4 a[12:15], v2, s[40:43], s33 offen offset:1024 sc1
v_mfma_f32_16x16x32_bf16 v[220:223], a[116:119], a[60:63], v[220:223]
v_mfma_f32_16x16x32_bf16 v[220:223], a[112:115], a[56:59], v[220:223]
s_waitcnt lgkmcnt(0)
s_barrier
v_mfma_f32_16x16x32_bf16 v[224:227], a[128:131], a[56:59], v[224:227]
v_add_u32 v5, 98304, v1
v_mfma_f32_16x16x32_bf16 v[224:227], a[132:135], a[60:63], v[224:227]
buffer_load_dwordx4 a[16:19], v2, s[40:43], s35 offen offset:2048 sc1
v_mfma_f32_16x16x32_bf16 v[200:203], a[132:135], a[52:55], v[200:203]
ds_read_b128 a[96:99], v5 offset:2048
v_mfma_f32_16x16x32_bf16 v[200:203], a[128:131], a[48:51], v[200:203]
ds_read_b128 a[100:103], v5 offset:8192
v_mfma_f32_16x16x32_bf16 v[176:179], a[128:131], a[40:43], v[176:179]
v_mfma_f32_16x16x32_bf16 v[176:179], a[132:135], a[44:47], v[176:179]
buffer_load_dwordx4 a[20:23], v2, s[40:43], s33 offen offset:2048 sc1
v_mfma_f32_16x16x32_bf16 v[152:155], a[132:135], a[36:39], v[152:155]
ds_read_b128 a[104:107], v5 offset:3072
v_mfma_f32_16x16x32_bf16 v[152:155], a[128:131], a[32:35], v[152:155]
v_mfma_f32_16x16x32_bf16 v[132:135], a[136:139], a[32:35], v[132:135]
ds_read_b128 a[108:111], v5 offset:9216
v_mfma_f32_16x16x32_bf16 v[132:135], a[140:143], a[36:39], v[132:135]
v_mfma_f32_16x16x32_bf16 v[156:159], a[140:143], a[44:47], v[156:159]
buffer_load_dwordx4 v1, s[4:7], s44 offen offset:0 sc1 lds
v_mfma_f32_16x16x32_bf16 v[156:159], a[136:139], a[40:43], v[156:159]
ds_read_b128 a[112:115], v5 offset:4096
v_mfma_f32_16x16x32_bf16 v[180:183], a[136:139], a[48:51], v[180:183]
v_mfma_f32_16x16x32_bf16 v[180:183], a[140:143], a[52:55], v[180:183]
ds_read_b128 a[116:119], v5 offset:10240
v_mfma_f32_16x16x32_bf16 v[204:207], a[140:143], a[60:63], v[204:207]
v_mfma_f32_16x16x32_bf16 v[204:207], a[136:139], a[56:59], v[204:207]
buffer_load_dwordx4 a[24:27], v2, s[40:43], s35 offen offset:3072 sc1
v_mfma_f32_16x16x32_bf16 v[208:211], a[144:147], a[56:59], v[208:211]
v_mfma_f32_16x16x32_bf16 v[208:211], a[148:151], a[60:63], v[208:211]
v_mfma_f32_16x16x32_bf16 v[184:187], a[148:151], a[52:55], v[184:187]
v_mfma_f32_16x16x32_bf16 v[184:187], a[144:147], a[48:51], v[184:187]
v_mfma_f32_16x16x32_bf16 v[160:163], a[144:147], a[40:43], v[160:163]
buffer_load_dwordx4 a[28:31], v2, s[40:43], s33 offen offset:3072 sc1
s_add_u32 s35, s35, 0x4000
v_mfma_f32_16x16x32_bf16 v[160:163], a[148:151], a[44:47], v[160:163]
s_add_u32 s33, s33, 0x4000
v_mfma_f32_16x16x32_bf16 v[136:139], a[148:151], a[36:39], v[136:139]
v_mfma_f32_16x16x32_bf16 v[136:139], a[144:147], a[32:35], v[136:139]
s_waitcnt vmcnt(11) lgkmcnt(0)
v_mfma_f32_16x16x32_bf16 v[140:143], a[96:99], a[64:67], v[140:143]
ds_read_b128 a[128:131], v5 offset:5120
v_mfma_f32_16x16x32_bf16 v[140:143], a[100:103], a[68:71], v[140:143]
buffer_load_dwordx4 a[32:35], v2, s[40:43], s35 offen offset:0 sc1
v_mfma_f32_16x16x32_bf16 v[164:167], a[100:103], a[76:79], v[164:167]
ds_read_b128 a[132:135], v5 offset:11264
v_mfma_f32_16x16x32_bf16 v[164:167], a[96:99], a[72:75], v[164:167]
v_mfma_f32_16x16x32_bf16 v[188:191], a[96:99], a[80:83], v[188:191]
v_mfma_f32_16x16x32_bf16 v[188:191], a[100:103], a[84:87], v[188:191]
buffer_load_dwordx4 a[36:39], v2, s[40:43], s33 offen offset:0 sc1
v_mfma_f32_16x16x32_bf16 v[212:215], a[100:103], a[92:95], v[212:215]
ds_read_b128 a[136:139], v5 offset:0
v_mfma_f32_16x16x32_bf16 v[212:215], a[96:99], a[88:91], v[212:215]
v_mfma_f32_16x16x32_bf16 v[216:219], a[104:107], a[88:91], v[216:219]
ds_read_b128 a[140:143], v5 offset:6144
v_mfma_f32_16x16x32_bf16 v[216:219], a[108:111], a[92:95], v[216:219]
v_mfma_f32_16x16x32_bf16 v[192:195], a[108:111], a[84:87], v[192:195]
buffer_load_dwordx4 v1, s[4:7], s44 offen offset:1024 sc1 lds
s_add_u32 m0, s18, 0x4000
v_mfma_f32_16x16x32_bf16 v[192:195], a[104:107], a[80:83], v[192:195]
s_add_u32 s44, s50, 0x2828000
ds_read_b128 a[144:147], v5 offset:1024
v_mfma_f32_16x16x32_bf16 v[168:171], a[104:107], a[72:75], v[168:171]
v_mfma_f32_16x16x32_bf16 v[168:171], a[108:111], a[76:79], v[168:171]
ds_read_b128 a[148:151], v5 offset:7168
v_mfma_f32_16x16x32_bf16 v[144:147], a[108:111], a[68:71], v[144:147]
v_mfma_f32_16x16x32_bf16 v[144:147], a[104:107], a[64:67], v[144:147]
buffer_load_dwordx4 a[40:43], v2, s[40:43], s35 offen offset:1024 sc1
v_mfma_f32_16x16x32_bf16 v[148:151], a[112:115], a[64:67], v[148:151]
v_mfma_f32_16x16x32_bf16 v[148:151], a[116:119], a[68:71], v[148:151]
v_mfma_f32_16x16x32_bf16 v[172:175], a[116:119], a[76:79], v[172:175]
v_mfma_f32_16x16x32_bf16 v[172:175], a[112:115], a[72:75], v[172:175]
v_mfma_f32_16x16x32_bf16 v[196:199], a[112:115], a[80:83], v[196:199]
buffer_load_dwordx4 a[44:47], v2, s[40:43], s33 offen offset:1024 sc1
v_mfma_f32_16x16x32_bf16 v[196:199], a[116:119], a[84:87], v[196:199]
v_mfma_f32_16x16x32_bf16 v[220:223], a[116:119], a[92:95], v[220:223]
v_mfma_f32_16x16x32_bf16 v[220:223], a[112:115], a[88:91], v[220:223]
s_waitcnt lgkmcnt(0)
v_mfma_f32_16x16x32_bf16 v[224:227], a[128:131], a[88:91], v[224:227]
ds_read_b128 a[96:99], v5 offset:14336
v_mfma_f32_16x16x32_bf16 v[224:227], a[132:135], a[92:95], v[224:227]
buffer_load_dwordx4 a[48:51], v2, s[40:43], s35 offen offset:2048 sc1
v_mfma_f32_16x16x32_bf16 v[200:203], a[132:135], a[84:87], v[200:203]
ds_read_b128 a[100:103], v5 offset:20480
v_mfma_f32_16x16x32_bf16 v[200:203], a[128:131], a[80:83], v[200:203]
v_mfma_f32_16x16x32_bf16 v[176:179], a[128:131], a[72:75], v[176:179]
v_mfma_f32_16x16x32_bf16 v[176:179], a[132:135], a[76:79], v[176:179]
buffer_load_dwordx4 a[52:55], v2, s[40:43], s33 offen offset:2048 sc1
v_mfma_f32_16x16x32_bf16 v[152:155], a[132:135], a[68:71], v[152:155]
ds_read_b128 a[104:107], v5 offset:15360
v_mfma_f32_16x16x32_bf16 v[152:155], a[128:131], a[64:67], v[152:155]
v_mfma_f32_16x16x32_bf16 v[132:135], a[136:139], a[64:67], v[132:135]
ds_read_b128 a[108:111], v5 offset:21504
v_mfma_f32_16x16x32_bf16 v[132:135], a[140:143], a[68:71], v[132:135]
v_mfma_f32_16x16x32_bf16 v[156:159], a[140:143], a[76:79], v[156:159]
buffer_load_dwordx4 v1, s[4:7], s44 offen offset:0 sc1 lds
v_mfma_f32_16x16x32_bf16 v[156:159], a[136:139], a[72:75], v[156:159]
ds_read_b128 a[112:115], v5 offset:16384
v_mfma_f32_16x16x32_bf16 v[180:183], a[136:139], a[80:83], v[180:183]
v_mfma_f32_16x16x32_bf16 v[180:183], a[140:143], a[84:87], v[180:183]
ds_read_b128 a[116:119], v5 offset:22528
v_mfma_f32_16x16x32_bf16 v[204:207], a[140:143], a[92:95], v[204:207]
v_mfma_f32_16x16x32_bf16 v[204:207], a[136:139], a[88:91], v[204:207]
buffer_load_dwordx4 a[56:59], v2, s[40:43], s35 offen offset:3072 sc1
v_mfma_f32_16x16x32_bf16 v[208:211], a[144:147], a[88:91], v[208:211]
v_mfma_f32_16x16x32_bf16 v[208:211], a[148:151], a[92:95], v[208:211]
v_mfma_f32_16x16x32_bf16 v[184:187], a[148:151], a[84:87], v[184:187]
v_mfma_f32_16x16x32_bf16 v[184:187], a[144:147], a[80:83], v[184:187]
v_mfma_f32_16x16x32_bf16 v[160:163], a[144:147], a[72:75], v[160:163]
buffer_load_dwordx4 a[60:63], v2, s[40:43], s33 offen offset:3072 sc1
s_add_u32 s35, s35, 0x4000
v_mfma_f32_16x16x32_bf16 v[160:163], a[148:151], a[76:79], v[160:163]
s_add_u32 s33, s33, 0x4000
v_mfma_f32_16x16x32_bf16 v[136:139], a[148:151], a[68:71], v[136:139]
v_mfma_f32_16x16x32_bf16 v[136:139], a[144:147], a[64:67], v[136:139]
s_waitcnt vmcnt(10) lgkmcnt(0)
v_mfma_f32_16x16x32_bf16 v[140:143], a[96:99], a[0:3], v[140:143]
ds_read_b128 a[128:131], v5 offset:17408
v_add_f32 v92, v92, v96
v_mfma_f32_16x16x32_bf16 v[140:143], a[100:103], a[4:7], v[140:143]
buffer_load_dwordx4 a[64:67], v2, s[40:43], s35 offen offset:0 sc1
v_mfma_f32_16x16x32_bf16 v[164:167], a[100:103], a[12:15], v[164:167]
ds_read_b128 a[132:135], v5 offset:23552
v_add_f32 v100, v100, v104
v_mfma_f32_16x16x32_bf16 v[164:167], a[96:99], a[8:11], v[164:167]
v_add_f32 v108, v108, v112
v_add_f32 v116, v116, v120
v_mfma_f32_16x16x32_bf16 v[188:191], a[96:99], a[16:19], v[188:191]
v_add_f32 v93, v93, v97
v_add_f32 v101, v101, v105
v_mfma_f32_16x16x32_bf16 v[188:191], a[100:103], a[20:23], v[188:191]
buffer_load_dwordx4 a[68:71], v2, s[40:43], s33 offen offset:0 sc1
v_mfma_f32_16x16x32_bf16 v[212:215], a[100:103], a[28:31], v[212:215]
ds_read_b128 a[136:139], v5 offset:12288
v_add_f32 v109, v109, v113
v_mfma_f32_16x16x32_bf16 v[212:215], a[96:99], a[24:27], v[212:215]
v_add_f32 v117, v117, v121
v_add_f32 v94, v94, v98
v_mfma_f32_16x16x32_bf16 v[216:219], a[104:107], a[24:27], v[216:219]
ds_read_b128 a[140:143], v5 offset:18432
v_add_f32 v102, v102, v106
v_mfma_f32_16x16x32_bf16 v[216:219], a[108:111], a[28:31], v[216:219]
v_add_f32 v110, v110, v114
v_mfma_f32_16x16x32_bf16 v[192:195], a[108:111], a[20:23], v[192:195]
buffer_load_dwordx4 v1, s[4:7], s44 offen offset:1024 sc1 lds
s_add_u32 m0, s18, 0x6000
v_mfma_f32_16x16x32_bf16 v[192:195], a[104:107], a[16:19], v[192:195]
s_add_u32 s44, s50, 0x282a000
ds_read_b128 a[144:147], v5 offset:13312
v_mfma_f32_16x16x32_bf16 v[168:171], a[104:107], a[8:11], v[168:171]
v_add_f32 v118, v118, v122
v_add_f32 v95, v95, v99
L_stub16:
s_cbranch_execz L_wret6
v_mfma_f32_16x16x32_bf16 v[168:171], a[108:111], a[12:15], v[168:171]
ds_read_b128 a[148:151], v5 offset:19456
v_add_f32 v103, v103, v107
v_mfma_f32_16x16x32_bf16 v[144:147], a[108:111], a[4:7], v[144:147]
v_add_f32 v111, v111, v115
v_add_f32 v119, v119, v123
v_mfma_f32_16x16x32_bf16 v[144:147], a[104:107], a[0:3], v[144:147]
buffer_load_dwordx4 a[72:75], v2, s[40:43], s35 offen offset:1024 sc1
v_mfma_f32_16x16x32_bf16 v[148:151], a[112:115], a[0:3], v[148:151]
v_add_f32_dpp v92, v92, v92 row_ror:8 row_mask:0xf bank_mask:0xf
v_add_f32_dpp v100, v100, v100 row_ror:8 row_mask:0xf bank_mask:0xf
v_mfma_f32_16x16x32_bf16 v[148:151], a[116:119], a[4:7], v[148:151]
v_add_f32_dpp v108, v108, v108 row_ror:8 row_mask:0xf bank_mask:0xf
v_mfma_f32_16x16x32_bf16 v[172:175], a[116:119], a[12:15], v[172:175]
v_add_f32_dpp v116, v116, v116 row_ror:8 row_mask:0xf bank_mask:0xf
v_mfma_f32_16x16x32_bf16 v[172:175], a[112:115], a[8:11], v[172:175]
v_add_f32_dpp v93, v93, v93 row_ror:8 row_mask:0xf bank_mask:0xf
v_mfma_f32_16x16x32_bf16 v[196:199], a[112:115], a[16:19], v[196:199]
buffer_load_dwordx4 a[76:79], v2, s[40:43], s33 offen offset:1024 sc1
v_mfma_f32_16x16x32_bf16 v[196:199], a[116:119], a[20:23], v[196:199]
v_add_f32_dpp v101, v101, v101 row_ror:8 row_mask:0xf bank_mask:0xf
v_add_f32_dpp v109, v109, v109 row_ror:8 row_mask:0xf bank_mask:0xf
v_mfma_f32_16x16x32_bf16 v[220:223], a[116:119], a[28:31], v[220:223]
v_add_f32_dpp v117, v117, v117 row_ror:8 row_mask:0xf bank_mask:0xf
v_mfma_f32_16x16x32_bf16 v[220:223], a[112:115], a[24:27], v[220:223]
v_add_f32_dpp v92, v94, v94 row_ror:8 row_mask:0xf bank_mask:0xc
s_waitcnt lgkmcnt(0)
v_mfma_f32_16x16x32_bf16 v[224:227], a[128:131], a[24:27], v[224:227]
ds_read_b128 a[96:99], v5 offset:26624
v_add_f32_dpp v100, v102, v102 row_ror:8 row_mask:0xf bank_mask:0xc
v_mfma_f32_16x16x32_bf16 v[224:227], a[132:135], a[28:31], v[224:227]
buffer_load_dwordx4 a[80:83], v2, s[40:43], s35 offen offset:2048 sc1
v_mfma_f32_16x16x32_bf16 v[200:203], a[132:135], a[20:23], v[200:203]
ds_read_b128 a[100:103], v5 offset:32768
v_add_f32_dpp v108, v110, v110 row_ror:8 row_mask:0xf bank_mask:0xc
v_mfma_f32_16x16x32_bf16 v[200:203], a[128:131], a[16:19], v[200:203]
v_add_f32_dpp v116, v118, v118 row_ror:8 row_mask:0xf bank_mask:0xc
v_add_f32_dpp v93, v95, v95 row_ror:8 row_mask:0xf bank_mask:0xc
v_mfma_f32_16x16x32_bf16 v[176:179], a[128:131], a[8:11], v[176:179]
v_add_f32_dpp v101, v103, v103 row_ror:8 row_mask:0xf bank_mask:0xc
v_add_f32_dpp v109, v111, v111 row_ror:8 row_mask:0xf bank_mask:0xc
v_mfma_f32_16x16x32_bf16 v[176:179], a[132:135], a[12:15], v[176:179]
buffer_load_dwordx4 v1, s[4:7], s44 offen offset:0 sc1 lds
v_mfma_f32_16x16x32_bf16 v[152:155], a[132:135], a[4:7], v[152:155]
ds_read_b128 a[104:107], v5 offset:27648
v_add_f32_dpp v117, v119, v119 row_ror:8 row_mask:0xf bank_mask:0xc
v_mfma_f32_16x16x32_bf16 v[152:155], a[128:131], a[0:3], v[152:155]
v_permlane32_swap_b32 v92, v93
v_mfma_f32_16x16x32_bf16 v[132:135], a[136:139], a[0:3], v[132:135]
ds_read_b128 a[108:111], v5 offset:33792
v_mfma_f32_16x16x32_bf16 v[132:135], a[140:143], a[4:7], v[132:135]
buffer_load_dwordx4 a[84:87], v2, s[40:43], s33 offen offset:2048 sc1
v_mfma_f32_16x16x32_bf16 v[156:159], a[140:143], a[12:15], v[156:159]
ds_read_b128 a[112:115], v5 offset:28672
v_mfma_f32_16x16x32_bf16 v[156:159], a[136:139], a[8:11], v[156:159]
v_permlane32_swap_b32 v100, v101
v_mfma_f32_16x16x32_bf16 v[180:183], a[136:139], a[16:19], v[180:183]
v_permlane32_swap_b32 v108, v109
v_mfma_f32_16x16x32_bf16 v[180:183], a[140:143], a[20:23], v[180:183]
buffer_load_dwordx4 a[88:91], v2, s[40:43], s35 offen offset:3072 sc1
v_mfma_f32_16x16x32_bf16 v[204:207], a[140:143], a[28:31], v[204:207]
ds_read_b128 a[116:119], v5 offset:34816
v_mfma_f32_16x16x32_bf16 v[204:207], a[136:139], a[24:27], v[204:207]
v_permlane32_swap_b32 v116, v117
v_mfma_f32_16x16x32_bf16 v[208:211], a[144:147], a[24:27], v[208:211]
v_add_f32 v92, v92, v93
v_add_f32 v100, v100, v101
v_mfma_f32_16x16x32_bf16 v[208:211], a[148:151], a[28:31], v[208:211]
buffer_load_dwordx4 v1, s[4:7], s44 offen offset:1024 sc1 lds
s_add_u32 m0, s18, 0x8000
v_mfma_f32_16x16x32_bf16 v[184:187], a[148:151], a[20:23], v[184:187]
s_add_u32 s44, s50, 0x282c000
v_add_f32 v108, v108, v109
v_mfma_f32_16x16x32_bf16 v[184:187], a[144:147], a[16:19], v[184:187]
v_add_f32 v116, v116, v117
v_mov_b32 v94, v92
v_mfma_f32_16x16x32_bf16 v[160:163], a[144:147], a[8:11], v[160:163]
v_mov_b32 v102, v100
v_mov_b32 v110, v108
v_mfma_f32_16x16x32_bf16 v[160:163], a[148:151], a[12:15], v[160:163]
buffer_load_dwordx4 a[92:95], v2, s[40:43], s33 offen offset:3072 sc1
s_add_u32 s35, s35, 0x4000
v_mfma_f32_16x16x32_bf16 v[136:139], a[148:151], a[4:7], v[136:139]
s_add_u32 s33, s33, 0x4000
v_mov_b32 v118, v116
v_mfma_f32_16x16x32_bf16 v[136:139], a[144:147], a[0:3], v[136:139]
s_waitcnt vmcnt(11) lgkmcnt(0)
v_mfma_f32_16x16x32_bf16 v[140:143], a[96:99], a[32:35], v[140:143]
ds_read_b128 a[128:131], v5 offset:29696
v_mfma_f32_16x16x32_bf16 v[140:143], a[100:103], a[36:39], v[140:143]
buffer_load_dwordx4 a[0:3], v2, s[40:43], s35 offen offset:0 sc1
v_mfma_f32_16x16x32_bf16 v[164:167], a[100:103], a[44:47], v[164:167]
ds_read_b128 a[132:135], v5 offset:35840
v_mfma_f32_16x16x32_bf16 v[164:167], a[96:99], a[40:43], v[164:167]
v_permlane16_swap_b32 v92, v94
v_mfma_f32_16x16x32_bf16 v[188:191], a[96:99], a[48:51], v[188:191]
v_permlane16_swap_b32 v100, v102
v_mfma_f32_16x16x32_bf16 v[188:191], a[100:103], a[52:55], v[188:191]
buffer_load_dwordx4 a[4:7], v2, s[40:43], s33 offen offset:0 sc1
v_mfma_f32_16x16x32_bf16 v[212:215], a[100:103], a[60:63], v[212:215]
ds_read_b128 a[136:139], v5 offset:24576
v_mfma_f32_16x16x32_bf16 v[212:215], a[96:99], a[56:59], v[212:215]
v_permlane16_swap_b32 v108, v110
v_mfma_f32_16x16x32_bf16 v[216:219], a[104:107], a[56:59], v[216:219]
ds_read_b128 a[140:143], v5 offset:30720
v_mfma_f32_16x16x32_bf16 v[216:219], a[108:111], a[60:63], v[216:219]
v_permlane16_swap_b32 v116, v118
v_mfma_f32_16x16x32_bf16 v[192:195], a[108:111], a[52:55], v[192:195]
buffer_load_dwordx4 v1, s[4:7], s44 offen offset:0 sc1 lds
v_mfma_f32_16x16x32_bf16 v[192:195], a[104:107], a[48:51], v[192:195]
ds_read_b128 a[144:147], v5 offset:25600
v_add_f32 v92, v92, v94
v_mfma_f32_16x16x32_bf16 v[168:171], a[104:107], a[40:43], v[168:171]
v_add_f32 v100, v100, v102
v_add_f32 v108, v108, v110
v_mfma_f32_16x16x32_bf16 v[168:171], a[108:111], a[44:47], v[168:171]
ds_read_b128 a[148:151], v5 offset:31744
v_add_f32 v116, v116, v118
v_mfma_f32_16x16x32_bf16 v[144:147], a[108:111], a[36:39], v[144:147]
v_mov_b32 v94, v92
v_mov_b32 v102, v100
v_mfma_f32_16x16x32_bf16 v[144:147], a[104:107], a[32:35], v[144:147]
buffer_load_dwordx4 a[8:11], v2, s[40:43], s35 offen offset:1024 sc1
v_mfma_f32_16x16x32_bf16 v[148:151], a[112:115], a[32:35], v[148:151]
v_mov_b32 v110, v108
v_mov_b32 v118, v116
v_mfma_f32_16x16x32_bf16 v[148:151], a[116:119], a[36:39], v[148:151]
v_permlane32_swap_b32 v92, v94
v_mfma_f32_16x16x32_bf16 v[172:175], a[116:119], a[44:47], v[172:175]
v_permlane32_swap_b32 v100, v102
v_mfma_f32_16x16x32_bf16 v[172:175], a[112:115], a[40:43], v[172:175]
v_permlane32_swap_b32 v108, v110
v_mfma_f32_16x16x32_bf16 v[196:199], a[112:115], a[48:51], v[196:199]
buffer_load_dwordx4 a[12:15], v2, s[40:43], s33 offen offset:1024 sc1
v_mfma_f32_16x16x32_bf16 v[196:199], a[116:119], a[52:55], v[196:199]
v_permlane32_swap_b32 v116, v118
v_mfma_f32_16x16x32_bf16 v[220:223], a[116:119], a[60:63], v[220:223]
v_mul_f32 v82, 0xba800000, v92
v_mul_f32 v84, 0xba800000, v100
v_mfma_f32_16x16x32_bf16 v[220:223], a[112:115], a[56:59], v[220:223]
v_mul_f32 v86, 0xba800000, v108
s_waitcnt lgkmcnt(0)
v_mfma_f32_16x16x32_bf16 v[224:227], a[128:131], a[56:59], v[224:227]
ds_read_b128 a[96:99], v5 offset:38912
v_mul_f32 v88, 0xba800000, v116
v_mfma_f32_16x16x32_bf16 v[224:227], a[132:135], a[60:63], v[224:227]
buffer_load_dwordx4 a[16:19], v2, s[40:43], s35 offen offset:2048 sc1
v_mfma_f32_16x16x32_bf16 v[200:203], a[132:135], a[52:55], v[200:203]
ds_read_b128 a[100:103], v5 offset:45056
v_mul_f32 v94, 0x3a800000, v94
v_mfma_f32_16x16x32_bf16 v[200:203], a[128:131], a[48:51], v[200:203]
v_mul_f32 v102, 0x3a800000, v102
v_mul_f32 v110, 0x3a800000, v110
v_mfma_f32_16x16x32_bf16 v[176:179], a[128:131], a[40:43], v[176:179]
v_mul_f32 v118, 0x3a800000, v118
v_fma_f32 v94, -v82, v82, v94
v_mfma_f32_16x16x32_bf16 v[176:179], a[132:135], a[44:47], v[176:179]
buffer_load_dwordx4 a[20:23], v2, s[40:43], s33 offen offset:2048 sc1
v_mfma_f32_16x16x32_bf16 v[152:155], a[132:135], a[36:39], v[152:155]
ds_read_b128 a[104:107], v5 offset:39936
v_fma_f32 v102, -v84, v84, v102
v_mfma_f32_16x16x32_bf16 v[152:155], a[128:131], a[32:35], v[152:155]
v_fma_f32 v110, -v86, v86, v110
v_fma_f32 v118, -v88, v88, v118
v_mfma_f32_16x16x32_bf16 v[132:135], a[136:139], a[32:35], v[132:135]
ds_read_b128 a[108:111], v5 offset:46080
v_max_f32 v94, 0, v94
v_mfma_f32_16x16x32_bf16 v[132:135], a[140:143], a[36:39], v[132:135]
v_max_f32 v102, 0, v102
v_mfma_f32_16x16x32_bf16 v[156:159], a[140:143], a[44:47], v[156:159]
buffer_load_dwordx4 v1, s[4:7], s44 offen offset:1024 sc1 lds
s_add_u32 m0, s18, 0xa000
v_mfma_f32_16x16x32_bf16 v[156:159], a[136:139], a[40:43], v[156:159]
s_add_u32 s44, s50, 0x282e000
ds_read_b128 a[112:115], v5 offset:40960
v_mfma_f32_16x16x32_bf16 v[180:183], a[136:139], a[48:51], v[180:183]
v_max_f32 v110, 0, v110
v_max_f32 v118, 0, v118
v_mfma_f32_16x16x32_bf16 v[180:183], a[140:143], a[52:55], v[180:183]
ds_read_b128 a[116:119], v5 offset:47104
v_add_f32 v94, 0x3727c5ac, v94
v_mfma_f32_16x16x32_bf16 v[204:207], a[140:143], a[60:63], v[204:207]
v_add_f32 v102, 0x3727c5ac, v102
v_add_f32 v110, 0x3727c5ac, v110
v_mfma_f32_16x16x32_bf16 v[204:207], a[136:139], a[56:59], v[204:207]
buffer_load_dwordx4 a[24:27], v2, s[40:43], s35 offen offset:3072 sc1
v_mfma_f32_16x16x32_bf16 v[208:211], a[144:147], a[56:59], v[208:211]
v_add_f32 v118, 0x3727c5ac, v118
v_mfma_f32_16x16x32_bf16 v[208:211], a[148:151], a[60:63], v[208:211]
v_rsq_f32 v83, v94
v_mfma_f32_16x16x32_bf16 v[184:187], a[148:151], a[52:55], v[184:187]
v_rsq_f32 v85, v102
v_mfma_f32_16x16x32_bf16 v[184:187], a[144:147], a[48:51], v[184:187]
v_mfma_f32_16x16x32_bf16 v[160:163], a[144:147], a[40:43], v[160:163]
buffer_load_dwordx4 a[28:31], v2, s[40:43], s33 offen offset:3072 sc1
s_add_u32 s35, s35, 0x4000
v_mfma_f32_16x16x32_bf16 v[160:163], a[148:151], a[44:47], v[160:163]
s_add_u32 s33, s33, 0x4000
v_mfma_f32_16x16x32_bf16 v[136:139], a[148:151], a[36:39], v[136:139]
v_rsq_f32 v87, v110
v_mfma_f32_16x16x32_bf16 v[136:139], a[144:147], a[32:35], v[136:139]
s_waitcnt vmcnt(10) lgkmcnt(0)
v_mfma_f32_16x16x32_bf16 v[140:143], a[96:99], a[64:67], v[140:143]
ds_read_b128 a[128:131], v5 offset:41984
v_mfma_f32_16x16x32_bf16 v[140:143], a[100:103], a[68:71], v[140:143]
buffer_load_dwordx4 a[32:35], v2, s[40:43], s35 offen offset:0 sc1
v_mfma_f32_16x16x32_bf16 v[164:167], a[100:103], a[76:79], v[164:167]
ds_read_b128 a[132:135], v5 offset:48128
v_mfma_f32_16x16x32_bf16 v[164:167], a[96:99], a[72:75], v[164:167]
v_rsq_f32 v89, v118
v_mfma_f32_16x16x32_bf16 v[188:191], a[96:99], a[80:83], v[188:191]
v_mfma_f32_16x16x32_bf16 v[188:191], a[100:103], a[84:87], v[188:191]
buffer_load_dwordx4 a[36:39], v2, s[40:43], s33 offen offset:0 sc1
v_mfma_f32_16x16x32_bf16 v[212:215], a[100:103], a[92:95], v[212:215]
ds_read_b128 a[136:139], v5 offset:36864
v_mfma_f32_16x16x32_bf16 v[212:215], a[96:99], a[88:91], v[212:215]
v_mfma_f32_16x16x32_bf16 v[216:219], a[104:107], a[88:91], v[216:219]
ds_read_b128 a[140:143], v5 offset:43008
v_mfma_f32_16x16x32_bf16 v[216:219], a[108:111], a[92:95], v[216:219]
v_mfma_f32_16x16x32_bf16 v[192:195], a[108:111], a[84:87], v[192:195]
buffer_load_dwordx4 v1, s[4:7], s44 offen offset:0 sc1 lds
v_mfma_f32_16x16x32_bf16 v[192:195], a[104:107], a[80:83], v[192:195]
ds_read_b128 a[144:147], v5 offset:37888
v_fmac_f32 v140, v56, v82
v_mfma_f32_16x16x32_bf16 v[168:171], a[104:107], a[72:75], v[168:171]
v_fmac_f32 v164, v56, v84
v_mfma_f32_16x16x32_bf16 v[168:171], a[108:111], a[76:79], v[168:171]
ds_read_b128 a[148:151], v5 offset:44032
v_mfma_f32_16x16x32_bf16 v[144:147], a[108:111], a[68:71], v[144:147]
v_fmac_f32 v188, v56, v86
v_mfma_f32_16x16x32_bf16 v[144:147], a[104:107], a[64:67], v[144:147]
buffer_load_dwordx4 a[40:43], v2, s[40:43], s35 offen offset:1024 sc1
v_mfma_f32_16x16x32_bf16 v[148:151], a[112:115], a[64:67], v[148:151]
v_fmac_f32 v212, v56, v88
v_mfma_f32_16x16x32_bf16 v[148:151], a[116:119], a[68:71], v[148:151]
v_mfma_f32_16x16x32_bf16 v[172:175], a[116:119], a[76:79], v[172:175]
v_fmac_f32 v216, v60, v88
v_mfma_f32_16x16x32_bf16 v[172:175], a[112:115], a[72:75], v[172:175]
v_mfma_f32_16x16x32_bf16 v[196:199], a[112:115], a[80:83], v[196:199]
buffer_load_dwordx4 a[44:47], v2, s[40:43], s33 offen offset:1024 sc1
v_mfma_f32_16x16x32_bf16 v[196:199], a[116:119], a[84:87], v[196:199]
v_fmac_f32 v192, v60, v86
v_mfma_f32_16x16x32_bf16 v[220:223], a[116:119], a[92:95], v[220:223]
v_fmac_f32 v168, v60, v84
v_fmac_f32 v141, v57, v82
v_mfma_f32_16x16x32_bf16 v[220:223], a[112:115], a[88:91], v[220:223]
s_waitcnt lgkmcnt(0)
s_barrier
v_mfma_f32_16x16x32_bf16 v[224:227], a[128:131], a[88:91], v[224:227]
v_add_u32 v5, 0, v1
v_fmac_f32 v144, v60, v82
v_mfma_f32_16x16x32_bf16 v[224:227], a[132:135], a[92:95], v[224:227]
buffer_load_dwordx4 a[48:51], v2, s[40:43], s35 offen offset:2048 sc1
v_mfma_f32_16x16x32_bf16 v[200:203], a[132:135], a[84:87], v[200:203]
ds_read_b128 a[96:99], v5 offset:2048
v_fmac_f32 v148, v64, v82
v_mfma_f32_16x16x32_bf16 v[200:203], a[128:131], a[80:83], v[200:203]
ds_read_b128 a[100:103], v5 offset:8192
v_fmac_f32 v165, v57, v84
v_mfma_f32_16x16x32_bf16 v[176:179], a[128:131], a[72:75], v[176:179]
v_fmac_f32 v172, v64, v84
v_fmac_f32 v189, v57, v86
v_mfma_f32_16x16x32_bf16 v[176:179], a[132:135], a[76:79], v[176:179]
buffer_load_dwordx4 a[52:55], v2, s[40:43], s33 offen offset:2048 sc1
v_mfma_f32_16x16x32_bf16 v[152:155], a[132:135], a[68:71], v[152:155]
ds_read_b128 a[104:107], v5 offset:3072
v_fmac_f32 v196, v64, v86
v_mfma_f32_16x16x32_bf16 v[152:155], a[128:131], a[64:67], v[152:155]
v_fmac_f32 v213, v57, v88
v_fmac_f32 v217, v61, v88
v_mfma_f32_16x16x32_bf16 v[132:135], a[136:139], a[64:67], v[132:135]
ds_read_b128 a[108:111], v5 offset:9216
v_fmac_f32 v220, v64, v88
v_mfma_f32_16x16x32_bf16 v[132:135], a[140:143], a[68:71], v[132:135]
v_fmac_f32 v193, v61, v86
v_mfma_f32_16x16x32_bf16 v[156:159], a[140:143], a[76:79], v[156:159]
buffer_load_dwordx4 v1, s[4:7], s44 offen offset:1024 sc1 lds
s_add_u32 m0, s19, 49152
v_mfma_f32_16x16x32_bf16 v[156:159], a[136:139], a[72:75], v[156:159]
s_add_u32 s44, s85, 0x1c04000
ds_read_b128 a[112:115], v5 offset:4096
v_mfma_f32_16x16x32_bf16 v[180:183], a[136:139], a[80:83], v[180:183]
v_fmac_f32 v224, v68, v88
v_fmac_f32 v200, v68, v86
v_mfma_f32_16x16x32_bf16 v[180:183], a[140:143], a[84:87], v[180:183]
ds_read_b128 a[116:119], v5 offset:10240
v_fmac_f32 v169, v61, v84
v_mfma_f32_16x16x32_bf16 v[204:207], a[140:143], a[92:95], v[204:207]
v_fmac_f32 v176, v68, v84
v_fmac_f32 v145, v61, v82
v_mfma_f32_16x16x32_bf16 v[204:207], a[136:139], a[88:91], v[204:207]
buffer_load_dwordx4 a[56:59], v2, s[40:43], s35 offen offset:3072 sc1
v_mfma_f32_16x16x32_bf16 v[208:211], a[144:147], a[88:91], v[208:211]
v_fmac_f32 v152, v68, v82
v_fmac_f32 v149, v65, v82
v_mfma_f32_16x16x32_bf16 v[208:211], a[148:151], a[92:95], v[208:211]
v_fmac_f32 v173, v65, v84
v_mfma_f32_16x16x32_bf16 v[184:187], a[148:151], a[84:87], v[184:187]
v_fmac_f32 v132, v48, v82
v_fmac_f32 v197, v65, v86
v_mfma_f32_16x16x32_bf16 v[184:187], a[144:147], a[80:83], v[184:187]
v_mfma_f32_16x16x32_bf16 v[160:163], a[144:147], a[72:75], v[160:163]
buffer_load_dwordx4 a[60:63], v2, s[40:43], s33 offen offset:3072 sc1
s_add_u32 s35, s35, 0x4000
v_mfma_f32_16x16x32_bf16 v[160:163], a[148:151], a[76:79], v[160:163]
s_add_u32 s33, s33, 0x4000
v_fmac_f32 v156, v48, v84
v_mfma_f32_16x16x32_bf16 v[136:139], a[148:151], a[68:71], v[136:139]
v_fmac_f32 v180, v48, v86
v_fmac_f32 v221, v65, v88
v_mfma_f32_16x16x32_bf16 v[136:139], a[144:147], a[64:67], v[136:139]
v_fmac_f32 v225, v69, v88
s_waitcnt vmcnt(10) lgkmcnt(0)
v_mfma_f32_16x16x32_bf16 v[140:143], a[96:99], a[0:3], v[140:143]
ds_read_b128 a[128:131], v5 offset:5120
v_fmac_f32 v204, v48, v88
v_mfma_f32_16x16x32_bf16 v[140:143], a[100:103], a[4:7], v[140:143]
buffer_load_dwordx4 a[64:67], v2, s[40:43], s35 offen offset:0 sc1
s_lshl_b32 s36, s28, 9
v_mfma_f32_16x16x32_bf16 v[164:167], a[100:103], a[12:15], v[164:167]
ds_read_b128 a[132:135], v5 offset:11264
v_fmac_f32 v208, v52, v88
v_mfma_f32_16x16x32_bf16 v[164:167], a[96:99], a[8:11], v[164:167]
v_fmac_f32 v201, v69, v86
v_fmac_f32 v177, v69, v84
v_mfma_f32_16x16x32_bf16 v[188:191], a[96:99], a[16:19], v[188:191]
v_fmac_f32 v184, v52, v86
v_fmac_f32 v153, v69, v82
v_mfma_f32_16x16x32_bf16 v[188:191], a[100:103], a[20:23], v[188:191]
buffer_load_dwordx4 a[68:71], v2, s[40:43], s33 offen offset:0 sc1
s_lshl_b32 s37, s30, 2
v_mfma_f32_16x16x32_bf16 v[212:215], a[100:103], a[28:31], v[212:215]
ds_read_b128 a[136:139], v5 offset:0
v_fmac_f32 v160, v52, v84
v_mfma_f32_16x16x32_bf16 v[212:215], a[96:99], a[24:27], v[212:215]
v_fmac_f32 v133, v49, v82
v_add_u32 v232, s19, v7
v_mfma_f32_16x16x32_bf16 v[216:219], a[104:107], a[24:27], v[216:219]
ds_read_b128 a[140:143], v5 offset:6144
v_fmac_f32 v136, v52, v82
v_mfma_f32_16x16x32_bf16 v[216:219], a[108:111], a[28:31], v[216:219]
buffer_load_dwordx4 a[72:75], v2, s[40:43], s35 offen offset:1024 sc1
s_add_u32 s37, s37, s28
v_mfma_f32_16x16x32_bf16 v[192:195], a[108:111], a[20:23], v[192:195]
ds_read_b128 a[144:147], v5 offset:1024
v_fmac_f32 v157, v49, v84
v_mfma_f32_16x16x32_bf16 v[192:195], a[104:107], a[16:19], v[192:195]
v_fmac_f32 v181, v49, v86
v_fmac_f32 v142, v58, v82
v_mfma_f32_16x16x32_bf16 v[168:171], a[104:107], a[8:11], v[168:171]
v_fmac_f32 v205, v49, v88
v_fmac_f32 v166, v58, v84
v_mfma_f32_16x16x32_bf16 v[168:171], a[108:111], a[12:15], v[168:171]
buffer_load_dwordx4 a[76:79], v2, s[40:43], s33 offen offset:1024 sc1
s_lshr_b32 s98, s37, 1
v_mfma_f32_16x16x32_bf16 v[144:147], a[108:111], a[4:7], v[144:147]
ds_read_b128 a[148:151], v5 offset:7168
v_fmac_f32 v209, v53, v88
v_mfma_f32_16x16x32_bf16 v[144:147], a[104:107], a[0:3], v[144:147]
v_fmac_f32 v190, v58, v86
s_lshl_b32 s98, s98, 14
v_mfma_f32_16x16x32_bf16 v[148:151], a[112:115], a[0:3], v[148:151]
v_fmac_f32 v185, v53, v86
v_fmac_f32 v214, v58, v88
v_mfma_f32_16x16x32_bf16 v[148:151], a[116:119], a[4:7], v[148:151]
buffer_load_dwordx4 a[80:83], v2, s[40:43], s35 offen offset:2048 sc1
s_and_b32 s99, s19, 0x1000
v_mfma_f32_16x16x32_bf16 v[172:175], a[116:119], a[12:15], v[172:175]
v_fmac_f32 v161, v53, v84
v_fmac_f32 v218, v62, v88
v_mfma_f32_16x16x32_bf16 v[172:175], a[112:115], a[8:11], v[172:175]
s_add_u32 s98, s98, s99
s_bfe_u32 s90, s51, 0x10005
s_lshl_b32 s90, s90, 13
v_mfma_f32_16x16x32_bf16 v[196:199], a[112:115], a[16:19], v[196:199]
v_fmac_f32 v137, v53, v82
v_fmac_f32 v194, v62, v86
v_mfma_f32_16x16x32_bf16 v[196:199], a[116:119], a[20:23], v[196:199]
buffer_load_dwordx4 a[84:87], v2, s[40:43], s33 offen offset:2048 sc1
s_add_u32 s98, s98, s90
v_mfma_f32_16x16x32_bf16 v[220:223], a[116:119], a[28:31], v[220:223]
v_fmac_f32 v170, v62, v84
v_fmac_f32 v143, v59, v82
v_mfma_f32_16x16x32_bf16 v[220:223], a[112:115], a[24:27], v[220:223]
s_add_u32 s98, s98, 0x1500000
s_waitcnt lgkmcnt(0)
v_mfma_f32_16x16x32_bf16 v[224:227], a[128:131], a[24:27], v[224:227]
ds_read_b128 a[96:99], v5 offset:14336
v_fmac_f32 v146, v62, v82
v_mfma_f32_16x16x32_bf16 v[224:227], a[132:135], a[28:31], v[224:227]
buffer_load_dwordx4 a[88:91], v2, s[40:43], s35 offen offset:3072 sc1
s_xor_b32 s99, s98, 0x2000
v_mfma_f32_16x16x32_bf16 v[200:203], a[132:135], a[20:23], v[200:203]
ds_read_b128 a[100:103], v5 offset:20480
v_fmac_f32 v150, v66, v82
v_mfma_f32_16x16x32_bf16 v[200:203], a[128:131], a[16:19], v[200:203]
v_fmac_f32 v167, v59, v84
v_fmac_f32 v191, v59, v86
v_mfma_f32_16x16x32_bf16 v[176:179], a[128:131], a[8:11], v[176:179]
v_fmac_f32 v174, v66, v84
v_fmac_f32 v215, v59, v88
v_mfma_f32_16x16x32_bf16 v[176:179], a[132:135], a[12:15], v[176:179]
ds_read_b128 a[104:107], v5 offset:15360
s_and_b32 s91, s29, 4
v_mfma_f32_16x16x32_bf16 v[152:155], a[132:135], a[4:7], v[152:155]
v_fmac_f32 v198, v66, v86
v_fmac_f32 v219, v63, v88
v_mfma_f32_16x16x32_bf16 v[152:155], a[128:131], a[0:3], v[152:155]
buffer_load_dwordx4 v1, s[4:7], s44 offen offset:0 sc1 lds
s_lshl_b32 s91, s91, 11
v_mfma_f32_16x16x32_bf16 v[132:135], a[136:139], a[0:3], v[132:135]
ds_read_b128 a[108:111], v5 offset:21504
v_fmac_f32 v222, v66, v88
v_mfma_f32_16x16x32_bf16 v[132:135], a[140:143], a[4:7], v[132:135]
v_fmac_f32 v195, v63, v86
s_xor_b32 s96, s98, s91
v_mfma_f32_16x16x32_bf16 v[156:159], a[140:143], a[12:15], v[156:159]
ds_read_b128 a[112:115], v5 offset:16384
v_fmac_f32 v226, v70, v88
v_mfma_f32_16x16x32_bf16 v[156:159], a[136:139], a[8:11], v[156:159]
v_fmac_f32 v171, v63, v84
s_lshl_b32 s97, s81, 10
v_mfma_f32_16x16x32_bf16 v[180:183], a[136:139], a[16:19], v[180:183]
v_fmac_f32 v202, v70, v86
v_fmac_f32 v147, v63, v82
v_mfma_f32_16x16x32_bf16 v[180:183], a[140:143], a[20:23], v[180:183]
buffer_load_dwordx4 a[92:95], v2, s[40:43], s33 offen offset:3072 sc1
s_add_u32 s35, s35, 0x4000
v_mfma_f32_16x16x32_bf16 v[204:207], a[140:143], a[28:31], v[204:207]
s_add_u32 s33, s33, 0x4000
ds_read_b128 a[116:119], v5 offset:22528
v_mfma_f32_16x16x32_bf16 v[204:207], a[136:139], a[24:27], v[204:207]
v_fmac_f32 v178, v70, v84
v_fmac_f32 v151, v67, v82
v_mfma_f32_16x16x32_bf16 v[208:211], a[144:147], a[24:27], v[208:211]
v_fmac_f32 v154, v70, v82
v_fmac_f32 v175, v67, v84
v_mfma_f32_16x16x32_bf16 v[208:211], a[148:151], a[28:31], v[208:211]
s_add_u32 s96, s96, s97
s_lshr_b32 s100, s37, 4
s_lshl_b32 s100, s100, 14
v_mfma_f32_16x16x32_bf16 v[184:187], a[148:151], a[20:23], v[184:187]
v_fmac_f32 v134, v50, v82
v_fmac_f32 v199, v67, v86
v_mfma_f32_16x16x32_bf16 v[184:187], a[144:147], a[16:19], v[184:187]
buffer_load_dwordx4 v1, s[4:7], s44 offen offset:1024 sc1 lds
s_and_b32 s37, s37, 15
v_mfma_f32_16x16x32_bf16 v[160:163], a[144:147], a[8:11], v[160:163]
v_fmac_f32 v158, v50, v84
v_fmac_f32 v223, v67, v88
v_mfma_f32_16x16x32_bf16 v[160:163], a[148:151], a[12:15], v[160:163]
s_lshl_b32 s37, s37, 9
s_add_u32 s100, s100, s37
s_add_u32 s100, s100, 0x260000
v_mfma_f32_16x16x32_bf16 v[136:139], a[148:151], a[4:7], v[136:139]
v_fmac_f32 v182, v50, v86
v_fmac_f32 v227, v71, v88
v_mfma_f32_16x16x32_bf16 v[136:139], a[144:147], a[0:3], v[136:139]
s_waitcnt vmcnt(10) lgkmcnt(0)
s_barrier
v_mfma_f32_16x16x32_bf16 v[140:143], a[96:99], a[32:35], v[140:143]
ds_read_b128 a[128:131], v5 offset:17408
v_fmac_f32 v206, v50, v88
v_mfma_f32_16x16x32_bf16 v[140:143], a[100:103], a[36:39], v[140:143]
buffer_load_dwordx4 a[0:3], v2, s[40:43], s35 offen offset:0 sc1
s_xor_b32 s90, s91, s79
v_mfma_f32_16x16x32_bf16 v[164:167], a[100:103], a[44:47], v[164:167]
ds_read_b128 a[132:135], v5 offset:23552
v_fmac_f32 v210, v54, v88
v_mfma_f32_16x16x32_bf16 v[164:167], a[96:99], a[40:43], v[164:167]
v_fmac_f32 v203, v71, v86
v_fmac_f32 v179, v71, v84
v_mfma_f32_16x16x32_bf16 v[188:191], a[96:99], a[48:51], v[188:191]
buffer_load_dwordx4 a[4:7], v2, s[40:43], s33 offen offset:0 sc1
s_lshl_b32 s97, s81, 7
v_mfma_f32_16x16x32_bf16 v[188:191], a[100:103], a[52:55], v[188:191]
ds_read_b128 a[136:139], v5 offset:26624
v_fmac_f32 v186, v54, v86
v_mfma_f32_16x16x32_bf16 v[212:215], a[100:103], a[60:63], v[212:215]
v_fmac_f32 v162, v54, v84
v_fmac_f32 v155, v71, v82
v_mfma_f32_16x16x32_bf16 v[212:215], a[96:99], a[56:59], v[212:215]
buffer_load_dwordx4 a[8:11], v2, s[40:43], s35 offen offset:1024 sc1
s_add_u32 s97, s97, s79
v_mfma_f32_16x16x32_bf16 v[216:219], a[104:107], a[56:59], v[216:219]
ds_read_b128 a[140:143], v5 offset:32768
v_fmac_f32 v138, v54, v82
v_mfma_f32_16x16x32_bf16 v[216:219], a[108:111], a[60:63], v[216:219]
v_fmac_f32 v135, v51, v82
v_fmac_f32 v159, v51, v84
v_mfma_f32_16x16x32_bf16 v[192:195], a[108:111], a[52:55], v[192:195]
buffer_load_dwordx4 a[12:15], v2, s[40:43], s33 offen offset:1024 sc1
s_add_u32 s97, s97, s100
v_mfma_f32_16x16x32_bf16 v[192:195], a[104:107], a[48:51], v[192:195]
ds_read_b128 a[144:147], v5 offset:27648
v_fmac_f32 v183, v51, v86
v_mfma_f32_16x16x32_bf16 v[168:171], a[104:107], a[40:43], v[168:171]
v_fmac_f32 v207, v51, v88
s_lshr_b32 s37, s30, 2
v_mfma_f32_16x16x32_bf16 v[168:171], a[108:111], a[44:47], v[168:171]
buffer_load_dwordx4 a[16:19], v2, s[40:43], s35 offen offset:2048 sc1
s_xor_b32 s37, s37, s51
v_mfma_f32_16x16x32_bf16 v[144:147], a[108:111], a[36:39], v[144:147]
ds_read_b128 a[148:151], v5 offset:33792
v_fmac_f32 v211, v55, v88
v_mfma_f32_16x16x32_bf16 v[144:147], a[104:107], a[32:35], v[144:147]
v_mul_f32 v88, 0x3fb8aa3b, v89
s_and_b32 s37, s37, 1
v_mfma_f32_16x16x32_bf16 v[148:151], a[112:115], a[32:35], v[148:151]
buffer_load_dwordx4 a[20:23], v2, s[40:43], s33 offen offset:2048 sc1
s_lshr_b32 s89, s29, 2
v_mfma_f32_16x16x32_bf16 v[148:151], a[116:119], a[36:39], v[148:151]
v_fmac_f32 v187, v55, v86
s_xor_b32 s89, s89, s37
v_mfma_f32_16x16x32_bf16 v[172:175], a[116:119], a[44:47], v[172:175]
v_fmac_f32 v163, v55, v84
v_mul_f32 v86, 0x3fb8aa3b, v87
v_mfma_f32_16x16x32_bf16 v[172:175], a[112:115], a[40:43], v[172:175]
buffer_load_dwordx4 a[24:27], v2, s[40:43], s35 offen offset:3072 sc1
s_lshl_b32 s88, s28, 6
v_mfma_f32_16x16x32_bf16 v[196:199], a[112:115], a[48:51], v[196:199]
v_fmac_f32 v139, v55, v82
v_mul_f32 v84, 0x3fb8aa3b, v85
v_mfma_f32_16x16x32_bf16 v[196:199], a[116:119], a[52:55], v[196:199]
v_mul_f32 v82, 0x3fb8aa3b, v83
s_add_u32 s94, s80, s88
v_mfma_f32_16x16x32_bf16 v[220:223], a[116:119], a[60:63], v[220:223]
buffer_load_dwordx4 a[28:31], v2, s[40:43], s33 offen offset:3072 sc1
s_add_u32 s35, s35, 0x64000
v_mfma_f32_16x16x32_bf16 v[220:223], a[112:115], a[56:59], v[220:223]
s_add_u32 s33, s33, 0x64000
s_waitcnt lgkmcnt(0)
v_mfma_f32_16x16x32_bf16 v[224:227], a[128:131], a[56:59], v[224:227]
ds_read_b128 a[96:99], v5 offset:28672
s_add_u32 s94, s94, 0x90000
v_mfma_f32_16x16x32_bf16 v[224:227], a[132:135], a[60:63], v[224:227]
buffer_load_dwordx4 v1, s[4:7], s44 offen offset:2048 sc1 lds
s_mul_i32 s89, s89, 0x102000
v_mfma_f32_16x16x32_bf16 v[200:203], a[132:135], a[52:55], v[200:203]
ds_read_b128 a[100:103], v5 offset:34816
s_add_u32 s88, s88, s70
v_mfma_f32_16x16x32_bf16 v[200:203], a[128:131], a[48:51], v[200:203]
s_add_u32 s88, s88, s89
s_add_u32 s89, s88, 0x90000
s_add_u32 s74, s71, 0x30080
v_mfma_f32_16x16x32_bf16 v[176:179], a[128:131], a[40:43], v[176:179]
v_add_u32 v233, s19, v232
s_add_u32 s72, s76, 0xc00000
v_mfma_f32_16x16x32_bf16 v[176:179], a[132:135], a[44:47], v[176:179]
ds_read_b128 a[104:107], v5 offset:29696
s_add_u32 s73, s75, 0x800000
v_mfma_f32_16x16x32_bf16 v[152:155], a[132:135], a[36:39], v[152:155]
s_lshr_b32 s38, s28, 1
s_and_b32 s39, s28, 1
s_mul_i32 s38, s38, 3072
v_mfma_f32_16x16x32_bf16 v[152:155], a[128:131], a[32:35], v[152:155]
s_lshl_b32 s39, s39, 3
s_add_u32 s38, s38, s39
s_waitcnt vmcnt(18)
v_mfma_f32_16x16x32_bf16 v[140:143], a[136:139], a[64:67], v[140:143]
ds_read_b128 a[108:111], v5 offset:35840
v_and_b32 v248, 4, v0
s_waitcnt vmcnt(17)
v_mfma_f32_16x16x32_bf16 v[140:143], a[140:143], a[68:71], v[140:143]
v_lshlrev_b32 v248, 11, v248
v_bfe_u32 v235, v0, 2, 1
s_waitcnt vmcnt(15)
v_mfma_f32_16x16x32_bf16 v[164:167], a[140:143], a[76:79], v[164:167]
ds_read_b128 a[112:115], v5 offset:38912
v_xor_b32 v248, s90, v248
v_mfma_f32_16x16x32_bf16 v[164:167], a[136:139], a[72:75], v[164:167]
v_and_b32 v249, 3, v0
v_xor_b32 v235, s37, v235
s_waitcnt vmcnt(14)
v_mfma_f32_16x16x32_bf16 v[188:191], a[136:139], a[80:83], v[188:191]
v_lshl_add_u32 v248, v249, 7, v248
v_mul_u32_u24 v235, 4128, v235
s_waitcnt vmcnt(13)
v_mfma_f32_16x16x32_bf16 v[188:191], a[140:143], a[84:87], v[188:191]
buffer_load_dwordx4 v1, s[4:7], s44 offen offset:3072 sc1 lds
s_add_u32 m0, s19, 65536
s_waitcnt vmcnt(11)
v_mfma_f32_16x16x32_bf16 v[212:215], a[140:143], a[92:95], v[212:215]
s_add_u32 s44, s84, 0x1c08000
ds_read_b128 a[116:119], v5 offset:45056
v_mfma_f32_16x16x32_bf16 v[212:215], a[136:139], a[88:91], v[212:215]
v_lshrrev_b32 v249, 4, v0
v_add_lshl_u32 v235, v235, v0, 8
v_mfma_f32_16x16x32_bf16 v[216:219], a[144:147], a[88:91], v[216:219]
v_lshl_add_u32 v248, v249, 4, v248
v_add_u32 v234, s36, v8
v_mfma_f32_16x16x32_bf16 v[216:219], a[148:151], a[92:95], v[216:219]
v_cndmask_b32 v235, 2.0, v235, s[64:65]
v_mov_b32 v249, 0x3f80
v_mfma_f32_16x16x32_bf16 v[192:195], a[148:151], a[84:87], v[192:195]
v_mov_b32 v250, 1.0
v_add_u32 v252, s38, v1
v_mfma_f32_16x16x32_bf16 v[192:195], a[144:147], a[80:83], v[192:195]
v_mfma_f32_16x16x32_bf16 v[168:171], a[144:147], a[72:75], v[168:171]
v_mfma_f32_16x16x32_bf16 v[168:171], a[148:151], a[76:79], v[168:171]
v_mfma_f32_16x16x32_bf16 v[144:147], a[148:151], a[68:71], v[144:147]
v_mfma_f32_16x16x32_bf16 v[144:147], a[144:147], a[64:67], v[144:147]
s_waitcnt lgkmcnt(0)
v_mfma_f32_16x16x32_bf16 v[148:151], a[96:99], a[64:67], v[148:151]
ds_read_b128 a[128:131], v5 offset:39936
v_mfma_f32_16x16x32_bf16 v[148:151], a[100:103], a[68:71], v[148:151]
buffer_load_dwordx4 v1, s[4:7], s44 offen offset:0 sc1 lds
v_mfma_f32_16x16x32_bf16 v[172:175], a[100:103], a[76:79], v[172:175]
ds_read_b128 a[132:135], v5 offset:46080
v_mfma_f32_16x16x32_bf16 v[172:175], a[96:99], a[72:75], v[172:175]
v_mfma_f32_16x16x32_bf16 v[196:199], a[96:99], a[80:83], v[196:199]
v_mfma_f32_16x16x32_bf16 v[196:199], a[100:103], a[84:87], v[196:199]
L_stub17:
s_cbranch_execz L_wret5
buffer_load_dwordx4 v1, s[4:7], s44 offen offset:1024 sc1 lds
v_mfma_f32_16x16x32_bf16 v[220:223], a[100:103], a[92:95], v[220:223]
ds_read_b128 a[136:139], v5 offset:40960
v_mfma_f32_16x16x32_bf16 v[220:223], a[96:99], a[88:91], v[220:223]
v_mfma_f32_16x16x32_bf16 v[224:227], a[104:107], a[88:91], v[224:227]
ds_read_b128 a[140:143], v5 offset:47104
v_mfma_f32_16x16x32_bf16 v[224:227], a[108:111], a[92:95], v[224:227]
v_mfma_f32_16x16x32_bf16 v[200:203], a[108:111], a[84:87], v[200:203]
buffer_load_dwordx4 v1, s[4:7], s44 offen offset:2048 sc1 lds
v_mfma_f32_16x16x32_bf16 v[200:203], a[104:107], a[80:83], v[200:203]
ds_read_b128 a[144:147], v5 offset:41984
v_mfma_f32_16x16x32_bf16 v[176:179], a[104:107], a[72:75], v[176:179]
v_mfma_f32_16x16x32_bf16 v[176:179], a[108:111], a[76:79], v[176:179]
ds_read_b128 a[148:151], v5 offset:48128
v_mfma_f32_16x16x32_bf16 v[152:155], a[108:111], a[68:71], v[152:155]
v_mfma_f32_16x16x32_bf16 v[152:155], a[104:107], a[64:67], v[152:155]
buffer_load_dwordx4 v1, s[4:7], s44 offen offset:3072 sc1 lds
s_add_u32 m0, s19, 81920
s_waitcnt vmcnt(13)
v_mfma_f32_16x16x32_bf16 v[140:143], a[112:115], a[0:3], v[140:143]
s_add_u32 s44, s85, 0x1c0c000
s_waitcnt vmcnt(12)
v_mfma_f32_16x16x32_bf16 v[140:143], a[116:119], a[4:7], v[140:143]
s_waitcnt vmcnt(10)
v_mfma_f32_16x16x32_bf16 v[164:167], a[116:119], a[12:15], v[164:167]
v_mfma_f32_16x16x32_bf16 v[164:167], a[112:115], a[8:11], v[164:167]
s_waitcnt vmcnt(9)
v_mfma_f32_16x16x32_bf16 v[188:191], a[112:115], a[16:19], v[188:191]
buffer_load_dwordx4 v1, s[4:7], s44 offen offset:0 sc1 lds
s_waitcnt vmcnt(9)
v_mfma_f32_16x16x32_bf16 v[188:191], a[116:119], a[20:23], v[188:191]
s_waitcnt vmcnt(7)
v_mfma_f32_16x16x32_bf16 v[212:215], a[116:119], a[28:31], v[212:215]
v_mfma_f32_16x16x32_bf16 v[212:215], a[112:115], a[24:27], v[212:215]
s_waitcnt lgkmcnt(0)
v_mfma_f32_16x16x32_bf16 v[216:219], a[128:131], a[24:27], v[216:219]
ds_read_b128 a[96:99], v5 offset:12288
v_cvt_pk_bf16_f32 v140, v140, v141
v_mfma_f32_16x16x32_bf16 v[216:219], a[132:135], a[28:31], v[216:219]
buffer_load_dwordx4 v1, s[4:7], s44 offen offset:1024 sc1 lds
v_mfma_f32_16x16x32_bf16 v[192:195], a[132:135], a[20:23], v[192:195]
ds_read_b128 a[100:103], v5 offset:18432
v_cvt_pk_bf16_f32 v141, v142, v143
v_mfma_f32_16x16x32_bf16 v[192:195], a[128:131], a[16:19], v[192:195]
v_cvt_pk_bf16_f32 v164, v164, v165
v_cvt_pk_bf16_f32 v165, v166, v167
v_mfma_f32_16x16x32_bf16 v[168:171], a[128:131], a[8:11], v[168:171]
v_cvt_pk_bf16_f32 v188, v188, v189
v_cvt_pk_bf16_f32 v189, v190, v191
v_mfma_f32_16x16x32_bf16 v[168:171], a[132:135], a[12:15], v[168:171]
buffer_load_dwordx4 v1, s[4:7], s44 offen offset:2048 sc1 lds
v_mfma_f32_16x16x32_bf16 v[144:147], a[132:135], a[4:7], v[144:147]
ds_read_b128 a[104:107], v5 offset:24576
v_cvt_pk_bf16_f32 v212, v212, v213
v_mfma_f32_16x16x32_bf16 v[144:147], a[128:131], a[0:3], v[144:147]
v_cvt_pk_bf16_f32 v213, v214, v215
v_mfma_f32_16x16x32_bf16 v[148:151], a[136:139], a[0:3], v[148:151]
ds_read_b128 a[108:111], v5 offset:30720
v_cvt_pk_bf16_f32 v214, v216, v217
v_mfma_f32_16x16x32_bf16 v[148:151], a[140:143], a[4:7], v[148:151]
v_cvt_pk_bf16_f32 v215, v218, v219
v_mfma_f32_16x16x32_bf16 v[172:175], a[140:143], a[12:15], v[172:175]
buffer_load_dwordx4 v1, s[4:7], s44 offen offset:3072 sc1 lds
s_add_u32 m0, s19, 147456
v_mfma_f32_16x16x32_bf16 v[172:175], a[136:139], a[8:11], v[172:175]
s_add_u32 s44, s87, 0x1c1c000
ds_read_b128 a[112:115], v5 offset:36864
v_mfma_f32_16x16x32_bf16 v[196:199], a[136:139], a[16:19], v[196:199]
v_cvt_pk_bf16_f32 v166, v168, v169
v_cvt_pk_bf16_f32 v167, v170, v171
v_mfma_f32_16x16x32_bf16 v[196:199], a[140:143], a[20:23], v[196:199]
ds_read_b128 a[116:119], v5 offset:43008
v_cvt_pk_bf16_f32 v190, v192, v193
v_mfma_f32_16x16x32_bf16 v[220:223], a[140:143], a[28:31], v[220:223]
v_cvt_pk_bf16_f32 v142, v144, v145
v_cvt_pk_bf16_f32 v143, v146, v147
v_mfma_f32_16x16x32_bf16 v[220:223], a[136:139], a[24:27], v[220:223]
buffer_load_dwordx4 v1, s[4:7], s44 offen offset:0 sc1 lds
v_mfma_f32_16x16x32_bf16 v[224:227], a[144:147], a[24:27], v[224:227]
v_mfma_f32_16x16x32_bf16 v[92:95], a[240:243], v[140:143], 0
v_mfma_f32_16x16x32_bf16 v[224:227], a[148:151], a[28:31], v[224:227]
v_mfma_f32_16x16x32_bf16 v[96:99], a[244:247], v[140:143], 0
v_mfma_f32_16x16x32_bf16 v[200:203], a[148:151], a[20:23], v[200:203]
v_mfma_f32_16x16x32_bf16 v[100:103], a[240:243], v[164:167], 0
v_mfma_f32_16x16x32_bf16 v[200:203], a[144:147], a[16:19], v[200:203]
v_mfma_f32_16x16x32_bf16 v[104:107], a[244:247], v[164:167], 0
v_mfma_f32_16x16x32_bf16 v[176:179], a[144:147], a[8:11], v[176:179]
buffer_load_dwordx4 v1, s[4:7], s44 offen offset:1024 sc1 lds
v_mfma_f32_16x16x32_bf16 v[176:179], a[148:151], a[12:15], v[176:179]
v_max3_f32 v236, v92, v93, v94
v_max3_f32 v237, -v92, -v93, -v94
v_mfma_f32_16x16x32_bf16 v[152:155], a[148:151], a[4:7], v[152:155]
v_max3_f32 v236, v236, v95, v96
v_max3_f32 v237, v237, -v95, -v96
v_mfma_f32_16x16x32_bf16 v[152:155], a[144:147], a[0:3], v[152:155]
v_max3_f32 v236, v236, v97, v98
s_waitcnt lgkmcnt(0)
v_mfma_f32_16x16x32_bf16 v[132:135], a[96:99], a[32:35], v[132:135]
ds_read_b128 a[128:131], v5 offset:13312
v_max3_f32 v237, v237, -v97, -v98
v_mfma_f32_16x16x32_bf16 v[132:135], a[100:103], a[36:39], v[132:135]
buffer_load_dwordx4 v1, s[4:7], s44 offen offset:2048 sc1 lds
v_mfma_f32_16x16x32_bf16 v[156:159], a[100:103], a[44:47], v[156:159]
ds_read_b128 a[132:135], v5 offset:19456
v_max_f32 v236, v236, v99
v_mfma_f32_16x16x32_bf16 v[156:159], a[96:99], a[40:43], v[156:159]
v_max_f32_e64 v237, v237, -v99
v_max3_f32 v238, v100, v101, v102
v_mfma_f32_16x16x32_bf16 v[180:183], a[96:99], a[48:51], v[180:183]
v_permlane32_swap_b32 v236, v237
v_mfma_f32_16x16x32_bf16 v[180:183], a[100:103], a[52:55], v[180:183]
buffer_load_dwordx4 v1, s[4:7], s44 offen offset:3072 sc1 lds
s_add_u32 m0, s19, 98304
v_mfma_f32_16x16x32_bf16 v[204:207], a[100:103], a[60:63], v[204:207]
s_add_u32 s44, s84, 0x1c10000
ds_read_b128 a[136:139], v5 offset:25600
v_mfma_f32_16x16x32_bf16 v[204:207], a[96:99], a[56:59], v[204:207]
v_max_f32 v236, v236, v237
v_mov_b32 v244, v236
v_mfma_f32_16x16x32_bf16 v[204:207], a[104:107], a[88:91], v[204:207]
ds_read_b128 a[140:143], v5 offset:31744
v_max3_f32 v239, -v100, -v101, -v102
v_mfma_f32_16x16x32_bf16 v[204:207], a[108:111], a[92:95], v[204:207]
v_permlane16_swap_b32 v236, v244
v_mfma_f32_16x16x32_bf16 v[180:183], a[108:111], a[84:87], v[180:183]
buffer_load_dwordx4 v1, s[4:7], s44 offen offset:0 sc1 lds
v_mfma_f32_16x16x32_bf16 v[180:183], a[104:107], a[80:83], v[180:183]
ds_read_b128 a[144:147], v5 offset:37888
v_max_f32 v236, v236, v244
v_mfma_f32_16x16x32_bf16 v[156:159], a[104:107], a[72:75], v[156:159]
v_mov_b32 v244, v236
v_max3_f32 v238, v238, v103, v104
v_mfma_f32_16x16x32_bf16 v[156:159], a[108:111], a[76:79], v[156:159]
ds_read_b128 a[148:151], v5 offset:44032
v_max3_f32 v239, v239, -v103, -v104
v_mfma_f32_16x16x32_bf16 v[132:135], a[108:111], a[68:71], v[132:135]
v_permlane32_swap_b32 v236, v244
v_mfma_f32_16x16x32_bf16 v[132:135], a[104:107], a[64:67], v[132:135]
buffer_load_dwordx4 v1, s[4:7], s44 offen offset:1024 sc1 lds
v_mfma_f32_16x16x32_bf16 v[132:135], a[112:115], a[0:3], v[132:135]
v_mul_f32_e64 v236, -v236, v82
v_mul_f32_e64 v237, -v244, v82
v_mfma_f32_16x16x32_bf16 v[132:135], a[116:119], a[4:7], v[132:135]
v_max3_f32 v238, v238, v105, v106
v_max3_f32 v239, v239, -v105, -v106
v_mfma_f32_16x16x32_bf16 v[156:159], a[116:119], a[12:15], v[156:159]
v_max_f32 v238, v238, v107
v_max_f32_e64 v239, v239, -v107
v_mfma_f32_16x16x32_bf16 v[156:159], a[112:115], a[8:11], v[156:159]
s_nop 0
v_permlane32_swap_b32 v238, v239
v_mfma_f32_16x16x32_bf16 v[180:183], a[112:115], a[16:19], v[180:183]
buffer_load_dwordx4 v1, s[4:7], s44 offen offset:2048 sc1 lds
v_mfma_f32_16x16x32_bf16 v[180:183], a[116:119], a[20:23], v[180:183]
v_max_f32 v238, v238, v239
v_mov_b32 v245, v238
v_mfma_f32_16x16x32_bf16 v[204:207], a[116:119], a[28:31], v[204:207]
s_nop 0
v_permlane16_swap_b32 v238, v245
v_mfma_f32_16x16x32_bf16 v[204:207], a[112:115], a[24:27], v[204:207]
s_waitcnt lgkmcnt(0)
s_barrier
v_mfma_f32_16x16x32_bf16 v[208:211], a[128:131], a[56:59], v[208:211]
v_max_f32 v238, v238, v245
v_mov_b32 v245, v238
v_mfma_f32_16x16x32_bf16 v[208:211], a[132:135], a[60:63], v[208:211]
buffer_load_dwordx4 v1, s[4:7], s44 offen offset:3072 sc1 lds
s_add_u32 m0, s19, 114688
v_mfma_f32_16x16x32_bf16 v[184:187], a[132:135], a[52:55], v[184:187]
s_add_u32 s44, s85, 0x1c14000
v_cvt_pk_bf16_f32 v191, v194, v195
v_mfma_f32_16x16x32_bf16 v[184:187], a[128:131], a[48:51], v[184:187]
v_permlane32_swap_b32 v238, v245
v_mfma_f32_16x16x32_bf16 v[160:163], a[128:131], a[40:43], v[160:163]
v_mul_f32_e64 v238, -v238, v84
v_mul_f32_e64 v239, -v245, v84
v_mfma_f32_16x16x32_bf16 v[160:163], a[132:135], a[44:47], v[160:163]
buffer_load_dwordx4 v1, s[4:7], s44 offen offset:0 sc1 lds
v_mfma_f32_16x16x32_bf16 v[136:139], a[132:135], a[36:39], v[136:139]
v_mfma_f32_16x16x32_bf16 v[108:111], a[240:243], v[188:191], 0
v_mfma_f32_16x16x32_bf16 v[136:139], a[128:131], a[32:35], v[136:139]
v_mfma_f32_16x16x32_bf16 v[112:115], a[244:247], v[188:191], 0
v_mfma_f32_16x16x32_bf16 v[136:139], a[136:139], a[64:67], v[136:139]
v_mfma_f32_16x16x32_bf16 v[116:119], a[240:243], v[212:215], 0
v_mfma_f32_16x16x32_bf16 v[136:139], a[140:143], a[68:71], v[136:139]
v_mfma_f32_16x16x32_bf16 v[120:123], a[244:247], v[212:215], 0
v_mfma_f32_16x16x32_bf16 v[160:163], a[140:143], a[76:79], v[160:163]
buffer_load_dwordx4 v1, s[4:7], s44 offen offset:1024 sc1 lds
v_mfma_f32_16x16x32_bf16 v[160:163], a[136:139], a[72:75], v[160:163]
v_max3_f32 v240, v108, v109, v110
v_max3_f32 v241, -v108, -v109, -v110
v_mfma_f32_16x16x32_bf16 v[184:187], a[136:139], a[80:83], v[184:187]
v_max3_f32 v240, v240, v111, v112
v_max3_f32 v241, v241, -v111, -v112
v_mfma_f32_16x16x32_bf16 v[184:187], a[140:143], a[84:87], v[184:187]
v_max3_f32 v240, v240, v113, v114
v_max3_f32 v241, v241, -v113, -v114
v_mfma_f32_16x16x32_bf16 v[208:211], a[140:143], a[92:95], v[208:211]
v_max_f32 v240, v240, v115
v_max_f32_e64 v241, v241, -v115
v_mfma_f32_16x16x32_bf16 v[208:211], a[136:139], a[88:91], v[208:211]
buffer_load_dwordx4 v1, s[4:7], s44 offen offset:2048 sc1 lds
v_mfma_f32_16x16x32_bf16 v[208:211], a[144:147], a[24:27], v[208:211]
v_permlane32_swap_b32 v240, v241
v_mfma_f32_16x16x32_bf16 v[208:211], a[148:151], a[28:31], v[208:211]
v_max_f32 v240, v240, v241
v_mov_b32 v246, v240
v_mfma_f32_16x16x32_bf16 v[184:187], a[148:151], a[20:23], v[184:187]
s_nop 0
v_permlane16_swap_b32 v240, v246
v_mfma_f32_16x16x32_bf16 v[184:187], a[144:147], a[16:19], v[184:187]
v_max_f32 v240, v240, v246
v_mov_b32 v246, v240
v_mfma_f32_16x16x32_bf16 v[160:163], a[144:147], a[8:11], v[160:163]
buffer_load_dwordx4 v1, s[4:7], s44 offen offset:3072 sc1 lds
v_mfma_f32_16x16x32_bf16 v[160:163], a[148:151], a[12:15], v[160:163]
v_permlane32_swap_b32 v240, v246
v_mfma_f32_16x16x32_bf16 v[136:139], a[148:151], a[4:7], v[136:139]
v_mul_f32_e64 v240, -v240, v86
v_mul_f32_e64 v241, -v246, v86
v_mfma_f32_16x16x32_bf16 v[136:139], a[144:147], a[0:3], v[136:139]
v_max3_f32 v242, v116, v117, v118
v_max3_f32 v243, -v116, -v117, -v118
v_pk_mul_f32 v[148:149], v[148:149], v[82:83] op_sel:[0,1] op_sel_hi:[1,1]
v_pk_mul_f32 v[150:151], v[150:151], v[82:83] op_sel:[0,1] op_sel_hi:[1,1]
v_cvt_pk_bf16_f32 v148, v148, v149
v_cvt_pk_bf16_f32 v149, v150, v151
ds_write_b64 v232, v[148:149] offset:0
v_pk_mul_f32 v[152:153], v[152:153], v[82:83] op_sel:[0,1] op_sel_hi:[1,1]
v_pk_mul_f32 v[154:155], v[154:155], v[82:83] op_sel:[0,1] op_sel_hi:[1,1]
v_cvt_pk_bf16_f32 v150, v152, v153
v_cvt_pk_bf16_f32 v151, v154, v155
v_pk_mul_f32 v[172:173], v[172:173], v[84:85] op_sel:[0,1] op_sel_hi:[1,1]
v_pk_mul_f32 v[174:175], v[174:175], v[84:85] op_sel:[0,1] op_sel_hi:[1,1]
v_cvt_pk_bf16_f32 v172, v172, v173
v_cvt_pk_bf16_f32 v173, v174, v175
v_pk_mul_f32 v[176:177], v[176:177], v[84:85] op_sel:[0,1] op_sel_hi:[1,1]
v_pk_mul_f32 v[178:179], v[178:179], v[84:85] op_sel:[0,1] op_sel_hi:[1,1]
v_cvt_pk_bf16_f32 v174, v176, v177
v_cvt_pk_bf16_f32 v175, v178, v179
ds_write_b64 v232, v[150:151] offset:512
v_pk_mul_f32 v[196:197], v[196:197], v[86:87] op_sel:[0,1] op_sel_hi:[1,1]
v_pk_mul_f32 v[198:199], v[198:199], v[86:87] op_sel:[0,1] op_sel_hi:[1,1]
v_cvt_pk_bf16_f32 v196, v196, v197
v_cvt_pk_bf16_f32 v197, v198, v199
buffer_store_dwordx4 a[248:251], v254, s[4:7], s97 offen offset:0 sc1
v_pk_mul_f32 v[200:201], v[200:201], v[86:87] op_sel:[0,1] op_sel_hi:[1,1]
v_pk_mul_f32 v[202:203], v[202:203], v[86:87] op_sel:[0,1] op_sel_hi:[1,1]
v_cvt_pk_bf16_f32 v198, v200, v201
v_cvt_pk_bf16_f32 v199, v202, v203
ds_write_b64 v232, v[172:173] offset:1024
v_pk_mul_f32 v[220:221], v[220:221], v[88:89] op_sel:[0,1] op_sel_hi:[1,1]
v_pk_mul_f32 v[222:223], v[222:223], v[88:89] op_sel:[0,1] op_sel_hi:[1,1]
v_cvt_pk_bf16_f32 v220, v220, v221
v_cvt_pk_bf16_f32 v221, v222, v223
v_pk_fma_f32 v[48:49], v[92:93], v[82:83], v[236:237] op_sel:[0,0,0] op_sel_hi:[1,0,0]
v_pk_fma_f32 v[50:51], v[94:95], v[82:83], v[236:237] op_sel:[0,0,0] op_sel_hi:[1,0,0]
v_pk_fma_f32 v[52:53], v[96:97], v[82:83], v[236:237] op_sel:[0,0,0] op_sel_hi:[1,0,0]
v_pk_fma_f32 v[54:55], v[98:99], v[82:83], v[236:237] op_sel:[0,0,0] op_sel_hi:[1,0,0]
v_exp_f32 v48, v48
v_exp_f32 v49, v49
ds_write_b64 v232, v[174:175] offset:1536
v_exp_f32 v50, v50
v_exp_f32 v51, v51
v_exp_f32 v52, v52
v_exp_f32 v53, v53
v_exp_f32 v54, v54
v_exp_f32 v55, v55
ds_write_b64 v232, v[196:197] offset:2048
buffer_store_dwordx4 a[248:251], v1, s[4:7], s96 offen offset:0 sc1
v_cvt_pk_bf16_f32 v140, v48, v49
v_cvt_pk_bf16_f32 v141, v50, v51
v_cvt_pk_bf16_f32 v142, v52, v53
v_cvt_pk_bf16_f32 v143, v54, v55
v_pk_mul_f32 v[224:225], v[224:225], v[88:89] op_sel:[0,1] op_sel_hi:[1,1]
v_pk_mul_f32 v[226:227], v[226:227], v[88:89] op_sel:[0,1] op_sel_hi:[1,1]
v_cvt_pk_bf16_f32 v222, v224, v225
v_mfma_f32_16x16x32_bf16 v[148:151], v[16:19], v[140:143], 0
ds_write_b64 v232, v[198:199] offset:2560
v_cvt_pk_bf16_f32 v223, v226, v227
s_add_u32 m0, s19, 131072
v_pk_fma_f32 v[92:93], v[92:93], v[82:83], v[236:237] op_sel:[0,0,1] op_sel_hi:[1,0,1] neg_lo:[1,0,0] neg_hi:[1,0,0]
v_pk_fma_f32 v[94:95], v[94:95], v[82:83], v[236:237] op_sel:[0,0,1] op_sel_hi:[1,0,1] neg_lo:[1,0,0] neg_hi:[1,0,0]
v_pk_fma_f32 v[96:97], v[96:97], v[82:83], v[236:237] op_sel:[0,0,1] op_sel_hi:[1,0,1] neg_lo:[1,0,0] neg_hi:[1,0,0]
s_nop 1
v_rcp_f32 v148, v148
v_pk_fma_f32 v[98:99], v[98:99], v[82:83], v[236:237] op_sel:[0,0,1] op_sel_hi:[1,0,1] neg_lo:[1,0,0] neg_hi:[1,0,0]
v_pk_mul_f32 v[48:49], v[48:49], v[148:149] op_sel:[0,0] op_sel_hi:[1,0]
v_pk_mul_f32 v[50:51], v[50:51], v[148:149] op_sel:[0,0] op_sel_hi:[1,0]
v_cvt_pk_bf16_f32 v140, v48, v49
v_cvt_pk_bf16_f32 v141, v50, v51
ds_write_b64 v232, v[220:221] offset:3072
v_exp_f32 v92, v92
v_exp_f32 v93, v93
v_exp_f32 v94, v94
v_exp_f32 v95, v95
v_exp_f32 v96, v96
v_exp_f32 v97, v97
ds_write_b64 v232, v[222:223] offset:3584
v_exp_f32 v98, v98
v_exp_f32 v99, v99
s_add_u32 s44, s86, 0x1c18000
v_cvt_pk_bf16_f32 v144, v92, v93
v_cvt_pk_bf16_f32 v145, v94, v95
v_cvt_pk_bf16_f32 v146, v96, v97
v_cvt_pk_bf16_f32 v147, v98, v99
buffer_load_dwordx4 v1, s[4:7], s44 offen offset:0 sc1 lds
v_pk_mul_f32 v[52:53], v[52:53], v[148:149] op_sel:[0,0] op_sel_hi:[1,0]
ds_write_b64 v233, v[140:141] offset:16384
v_pk_mul_f32 v[54:55], v[54:55], v[148:149] op_sel:[0,0] op_sel_hi:[1,0]
v_cvt_pk_bf16_f32 v142, v52, v53
v_mfma_f32_16x16x32_bf16 v[152:155], v[16:19], v[144:147], 0
v_cvt_pk_bf16_f32 v143, v54, v55
v_max3_f32 v242, v242, v119, v120
v_max3_f32 v243, v243, -v119, -v120
v_max3_f32 v242, v242, v121, v122
v_max3_f32 v243, v243, -v121, -v122
v_pk_fma_f32 v[56:57], v[100:101], v[84:85], v[238:239] op_sel:[0,0,0] op_sel_hi:[1,0,0]
v_pk_fma_f32 v[58:59], v[102:103], v[84:85], v[238:239] op_sel:[0,0,0] op_sel_hi:[1,0,0]
v_pk_fma_f32 v[60:61], v[104:105], v[84:85], v[238:239] op_sel:[0,0,0] op_sel_hi:[1,0,0]
ds_write_b64 v233, v[142:143] offset:16896
v_rcp_f32 v152, v152
v_pk_fma_f32 v[62:63], v[106:107], v[84:85], v[238:239] op_sel:[0,0,0] op_sel_hi:[1,0,0]
v_pk_mul_f32 v[92:93], v[92:93], v[152:153] op_sel:[0,0] op_sel_hi:[1,0]
v_pk_mul_f32 v[94:95], v[94:95], v[152:153] op_sel:[0,0] op_sel_hi:[1,0]
v_cvt_pk_bf16_f32 v144, v92, v93
v_cvt_pk_bf16_f32 v145, v94, v95
v_exp_f32 v56, v56
v_exp_f32 v57, v57
v_exp_f32 v58, v58
ds_write_b64 v233, v[144:145] offset:17408
v_exp_f32 v59, v59
v_exp_f32 v60, v60
v_exp_f32 v61, v61
v_exp_f32 v62, v62
v_exp_f32 v63, v63
buffer_load_dwordx4 v1, s[4:7], s44 offen offset:1024 sc1 lds
v_cvt_pk_bf16_f32 v164, v56, v57
v_cvt_pk_bf16_f32 v165, v58, v59
v_cvt_pk_bf16_f32 v166, v60, v61
v_cvt_pk_bf16_f32 v167, v62, v63
v_pk_mul_f32 v[96:97], v[96:97], v[152:153] op_sel:[0,0] op_sel_hi:[1,0]
v_pk_mul_f32 v[98:99], v[98:99], v[152:153] op_sel:[0,0] op_sel_hi:[1,0]
v_cvt_pk_bf16_f32 v146, v96, v97
v_mfma_f32_16x16x32_bf16 v[172:175], v[16:19], v[164:167], 0
v_cvt_pk_bf16_f32 v147, v98, v99
ds_write_b64 v233, v[146:147] offset:17920
v_max_f32 v242, v242, v123
v_pk_fma_f32 v[100:101], v[100:101], v[84:85], v[238:239] op_sel:[0,0,1] op_sel_hi:[1,0,1] neg_lo:[1,0,0] neg_hi:[1,0,0]
v_pk_fma_f32 v[102:103], v[102:103], v[84:85], v[238:239] op_sel:[0,0,1] op_sel_hi:[1,0,1] neg_lo:[1,0,0] neg_hi:[1,0,0]
v_pk_fma_f32 v[104:105], v[104:105], v[84:85], v[238:239] op_sel:[0,0,1] op_sel_hi:[1,0,1] neg_lo:[1,0,0] neg_hi:[1,0,0]
s_nop 1
v_rcp_f32 v172, v172
v_pk_fma_f32 v[106:107], v[106:107], v[84:85], v[238:239] op_sel:[0,0,1] op_sel_hi:[1,0,1] neg_lo:[1,0,0] neg_hi:[1,0,0]
v_pk_mul_f32 v[56:57], v[56:57], v[172:173] op_sel:[0,0] op_sel_hi:[1,0]
v_pk_mul_f32 v[58:59], v[58:59], v[172:173] op_sel:[0,0] op_sel_hi:[1,0]
v_cvt_pk_bf16_f32 v164, v56, v57
v_cvt_pk_bf16_f32 v165, v58, v59
v_exp_f32 v100, v100
ds_write_b64 v233, v[164:165] offset:18432
v_exp_f32 v101, v101
v_exp_f32 v102, v102
v_exp_f32 v103, v103
v_exp_f32 v104, v104
v_exp_f32 v105, v105
v_exp_f32 v106, v106
v_exp_f32 v107, v107
buffer_load_dwordx4 v1, s[4:7], s44 offen offset:2048 sc1 lds
v_cvt_pk_bf16_f32 v168, v100, v101
v_cvt_pk_bf16_f32 v169, v102, v103
v_cvt_pk_bf16_f32 v170, v104, v105
v_cvt_pk_bf16_f32 v171, v106, v107
v_pk_mul_f32 v[60:61], v[60:61], v[172:173] op_sel:[0,0] op_sel_hi:[1,0]
v_pk_mul_f32 v[62:63], v[62:63], v[172:173] op_sel:[0,0] op_sel_hi:[1,0]
v_cvt_pk_bf16_f32 v166, v60, v61
v_mfma_f32_16x16x32_bf16 v[176:179], v[16:19], v[168:171], 0
v_cvt_pk_bf16_f32 v167, v62, v63
ds_write_b64 v233, v[166:167] offset:18944
v_max_f32_e64 v243, v243, -v123
v_pk_fma_f32 v[64:65], v[108:109], v[86:87], v[240:241] op_sel:[0,0,0] op_sel_hi:[1,0,0]
v_pk_fma_f32 v[66:67], v[110:111], v[86:87], v[240:241] op_sel:[0,0,0] op_sel_hi:[1,0,0]
v_pk_fma_f32 v[68:69], v[112:113], v[86:87], v[240:241] op_sel:[0,0,0] op_sel_hi:[1,0,0]
s_nop 1
v_rcp_f32 v176, v176
v_pk_fma_f32 v[70:71], v[114:115], v[86:87], v[240:241] op_sel:[0,0,0] op_sel_hi:[1,0,0]
v_pk_mul_f32 v[100:101], v[100:101], v[176:177] op_sel:[0,0] op_sel_hi:[1,0]
v_pk_mul_f32 v[102:103], v[102:103], v[176:177] op_sel:[0,0] op_sel_hi:[1,0]
v_cvt_pk_bf16_f32 v168, v100, v101
v_cvt_pk_bf16_f32 v169, v102, v103
v_exp_f32 v64, v64
ds_write_b64 v233, v[168:169] offset:19456
buffer_load_dwordx4 v1, s[4:7], s44 offen offset:3072 sc1 lds
v_exp_f32 v65, v65
v_exp_f32 v66, v66
v_exp_f32 v67, v67
v_exp_f32 v68, v68
v_exp_f32 v69, v69
v_exp_f32 v70, v70
v_exp_f32 v71, v71
v_cvt_pk_bf16_f32 v188, v64, v65
v_cvt_pk_bf16_f32 v189, v66, v67
v_cvt_pk_bf16_f32 v190, v68, v69
v_cvt_pk_bf16_f32 v191, v70, v71
v_pk_mul_f32 v[104:105], v[104:105], v[176:177] op_sel:[0,0] op_sel_hi:[1,0]
v_pk_mul_f32 v[106:107], v[106:107], v[176:177] op_sel:[0,0] op_sel_hi:[1,0]
v_cvt_pk_bf16_f32 v170, v104, v105
v_mfma_f32_16x16x32_bf16 v[196:199], v[16:19], v[188:191], 0
v_cvt_pk_bf16_f32 v171, v106, v107
ds_write_b64 v233, v[170:171] offset:19968
buffer_store_dwordx4 a[248:251], v2, s[4:7], s72 offen offset:0 sc1
s_nop 4
v_rcp_f32 v196, v196
v_pk_fma_f32 v[108:109], v[108:109], v[86:87], v[240:241] op_sel:[0,0,1] op_sel_hi:[1,0,1] neg_lo:[1,0,0] neg_hi:[1,0,0]
v_pk_mul_f32 v[64:65], v[64:65], v[196:197] op_sel:[0,0] op_sel_hi:[1,0]
v_pk_mul_f32 v[66:67], v[66:67], v[196:197] op_sel:[0,0] op_sel_hi:[1,0]
v_cvt_pk_bf16_f32 v188, v64, v65
v_cvt_pk_bf16_f32 v189, v66, v67
v_pk_fma_f32 v[110:111], v[110:111], v[86:87], v[240:241] op_sel:[0,0,1] op_sel_hi:[1,0,1] neg_lo:[1,0,0] neg_hi:[1,0,0]
ds_write_b64 v233, v[188:189] offset:20480
v_pk_fma_f32 v[112:113], v[112:113], v[86:87], v[240:241] op_sel:[0,0,1] op_sel_hi:[1,0,1] neg_lo:[1,0,0] neg_hi:[1,0,0]
v_pk_fma_f32 v[114:115], v[114:115], v[86:87], v[240:241] op_sel:[0,0,1] op_sel_hi:[1,0,1] neg_lo:[1,0,0] neg_hi:[1,0,0]
v_exp_f32 v108, v108
v_exp_f32 v109, v109
v_exp_f32 v110, v110
v_exp_f32 v111, v111
v_exp_f32 v112, v112
v_exp_f32 v113, v113
v_exp_f32 v114, v114
v_exp_f32 v115, v115
v_cvt_pk_bf16_f32 v192, v108, v109
v_cvt_pk_bf16_f32 v193, v110, v111
v_cvt_pk_bf16_f32 v194, v112, v113
v_cvt_pk_bf16_f32 v195, v114, v115
v_pk_mul_f32 v[68:69], v[68:69], v[196:197] op_sel:[0,0] op_sel_hi:[1,0]
v_pk_mul_f32 v[70:71], v[70:71], v[196:197] op_sel:[0,0] op_sel_hi:[1,0]
v_permlane32_swap_b32 v242, v243
v_mfma_f32_16x16x32_bf16 v[200:203], v[16:19], v[192:195], 0
v_cvt_pk_bf16_f32 v190, v68, v69
v_cvt_pk_bf16_f32 v191, v70, v71
ds_write_b64 v233, v[190:191] offset:20992
v_max_f32 v242, v242, v243
v_mov_b32 v247, v242
buffer_store_dwordx4 a[248:251], v2, s[4:7], s72 offen offset:1024 sc1
s_nop 0
v_permlane16_swap_b32 v242, v247
v_rcp_f32 v200, v200
v_max_f32 v242, v242, v247
v_mov_b32 v247, v242
v_pk_mul_f32 v[108:109], v[108:109], v[200:201] op_sel:[0,0] op_sel_hi:[1,0]
v_pk_mul_f32 v[110:111], v[110:111], v[200:201] op_sel:[0,0] op_sel_hi:[1,0]
v_cvt_pk_bf16_f32 v192, v108, v109
v_cvt_pk_bf16_f32 v193, v110, v111
v_permlane32_swap_b32 v242, v247
ds_write_b64 v233, v[192:193] offset:21504
v_mul_f32_e64 v242, -v242, v88
v_mul_f32_e64 v243, -v247, v88
v_pk_fma_f32 v[124:125], v[116:117], v[88:89], v[242:243] op_sel:[0,0,0] op_sel_hi:[1,0,0]
v_pk_fma_f32 v[126:127], v[118:119], v[88:89], v[242:243] op_sel:[0,0,0] op_sel_hi:[1,0,0]
v_pk_fma_f32 v[128:129], v[120:121], v[88:89], v[242:243] op_sel:[0,0,0] op_sel_hi:[1,0,0]
v_pk_fma_f32 v[130:131], v[122:123], v[88:89], v[242:243] op_sel:[0,0,0] op_sel_hi:[1,0,0]
v_exp_f32 v124, v124
v_exp_f32 v125, v125
v_exp_f32 v126, v126
v_exp_f32 v127, v127
v_exp_f32 v128, v128
v_exp_f32 v129, v129
v_exp_f32 v130, v130
v_exp_f32 v131, v131
v_cvt_pk_bf16_f32 v212, v124, v125
v_cvt_pk_bf16_f32 v213, v126, v127
v_cvt_pk_bf16_f32 v214, v128, v129
v_cvt_pk_bf16_f32 v215, v130, v131
v_pk_mul_f32 v[112:113], v[112:113], v[200:201] op_sel:[0,0] op_sel_hi:[1,0]
v_pk_mul_f32 v[114:115], v[114:115], v[200:201] op_sel:[0,0] op_sel_hi:[1,0]
v_cvt_pk_bf16_f32 v194, v112, v113
v_mfma_f32_16x16x32_bf16 v[220:223], v[16:19], v[212:215], 0
v_cvt_pk_bf16_f32 v195, v114, v115
ds_write_b64 v233, v[194:195] offset:22016
buffer_store_dwordx4 a[248:251], v2, s[4:7], s72 offen offset:2048 sc1
s_nop 4
v_rcp_f32 v220, v220
v_pk_fma_f32 v[116:117], v[116:117], v[88:89], v[242:243] op_sel:[0,0,1] op_sel_hi:[1,0,1] neg_lo:[1,0,0] neg_hi:[1,0,0]
v_pk_mul_f32 v[124:125], v[124:125], v[220:221] op_sel:[0,0] op_sel_hi:[1,0]
v_pk_mul_f32 v[126:127], v[126:127], v[220:221] op_sel:[0,0] op_sel_hi:[1,0]
v_cvt_pk_bf16_f32 v212, v124, v125
v_cvt_pk_bf16_f32 v213, v126, v127
v_pk_fma_f32 v[118:119], v[118:119], v[88:89], v[242:243] op_sel:[0,0,1] op_sel_hi:[1,0,1] neg_lo:[1,0,0] neg_hi:[1,0,0]
ds_write_b64 v233, v[212:213] offset:22528
v_pk_fma_f32 v[120:121], v[120:121], v[88:89], v[242:243] op_sel:[0,0,1] op_sel_hi:[1,0,1] neg_lo:[1,0,0] neg_hi:[1,0,0]
v_pk_fma_f32 v[122:123], v[122:123], v[88:89], v[242:243] op_sel:[0,0,1] op_sel_hi:[1,0,1] neg_lo:[1,0,0] neg_hi:[1,0,0]
v_exp_f32 v116, v116
v_exp_f32 v117, v117
v_exp_f32 v118, v118
v_exp_f32 v119, v119
v_exp_f32 v120, v120
v_exp_f32 v121, v121
v_exp_f32 v122, v122
v_exp_f32 v123, v123
v_cvt_pk_bf16_f32 v216, v116, v117
v_cvt_pk_bf16_f32 v217, v118, v119
v_cvt_pk_bf16_f32 v218, v120, v121
v_cvt_pk_bf16_f32 v219, v122, v123
v_pk_mul_f32 v[128:129], v[128:129], v[220:221] op_sel:[0,0] op_sel_hi:[1,0]
v_pk_mul_f32 v[130:131], v[130:131], v[220:221] op_sel:[0,0] op_sel_hi:[1,0]
v_cvt_pk_bf16_f32 v214, v128, v129
v_mfma_f32_16x16x32_bf16 v[224:227], v[16:19], v[216:219], 0
v_cvt_pk_bf16_f32 v215, v130, v131
ds_write_b64 v233, v[214:215] offset:23040
buffer_store_dwordx4 a[248:251], v2, s[4:7], s72 offen offset:3072 sc1
s_nop 4
v_rcp_f32 v224, v224
s_nop 0
v_pk_mul_f32 v[116:117], v[116:117], v[224:225] op_sel:[0,0] op_sel_hi:[1,0]
v_pk_mul_f32 v[118:119], v[118:119], v[224:225] op_sel:[0,0] op_sel_hi:[1,0]
v_cvt_pk_bf16_f32 v216, v116, v117
v_cvt_pk_bf16_f32 v217, v118, v119
v_pk_mul_f32 v[120:121], v[120:121], v[224:225] op_sel:[0,0] op_sel_hi:[1,0]
ds_write_b64 v233, v[216:217] offset:23552
v_pk_mul_f32 v[122:123], v[122:123], v[224:225] op_sel:[0,0] op_sel_hi:[1,0]
v_cvt_pk_bf16_f32 v218, v120, v121
v_cvt_pk_bf16_f32 v219, v122, v123
ds_write_b64 v233, v[218:219] offset:24064
s_waitcnt vmcnt(8)
s_waitcnt lgkmcnt(0)
s_barrier
ds_read_b64_tr_b16 a[0:1], v234 offset:16384
ds_read_b64_tr_b16 a[2:3], v234 offset:18432
ds_read_b64_tr_b16 a[12:13], v234 offset:20480
ds_read_b64_tr_b16 a[14:15], v234 offset:22528
ds_read_b64_tr_b16 a[24:25], v234 offset:24576
ds_read_b64_tr_b16 a[26:27], v234 offset:26624
ds_read_b64_tr_b16 a[4:5], v8 offset:0
ds_read_b64_tr_b16 a[6:7], v8 offset:1024
ds_read_b64_tr_b16 a[8:9], v8 offset:512
ds_read_b64_tr_b16 a[10:11], v8 offset:1536
ds_read_b64_tr_b16 a[36:37], v234 offset:28672
ds_read_b64_tr_b16 a[38:39], v234 offset:30720
ds_read_b64_tr_b16 a[16:17], v8 offset:2048
ds_read_b64_tr_b16 a[18:19], v8 offset:3072
ds_read_b64_tr_b16 a[20:21], v8 offset:2560
ds_read_b64_tr_b16 a[22:23], v8 offset:3584
ds_read_b64_tr_b16 a[48:49], v234 offset:32768
ds_read_b64_tr_b16 a[50:51], v234 offset:34816
ds_read_b64_tr_b16 a[28:29], v8 offset:4096
ds_read_b64_tr_b16 a[30:31], v8 offset:5120
ds_read_b64_tr_b16 a[32:33], v8 offset:4608
ds_read_b64_tr_b16 a[34:35], v8 offset:5632
ds_read_b64_tr_b16 a[60:61], v234 offset:36864
ds_read_b64_tr_b16 a[62:63], v234 offset:38912
s_waitcnt lgkmcnt(14)
v_mfma_f32_16x16x32_bf16 v[100:103], a[0:3], v[16:19], 0
ds_read_b64_tr_b16 a[40:41], v8 offset:6144
ds_read_b64_tr_b16 a[42:43], v8 offset:7168
ds_read_b64_tr_b16 a[44:45], v8 offset:6656
ds_read_b64_tr_b16 a[46:47], v8 offset:7680
ds_read_b64_tr_b16 a[72:73], v234 offset:40960
ds_read_b64_tr_b16 a[74:75], v234 offset:43008
v_mfma_f32_16x16x32_bf16 v[100:103], a[12:15], v[16:19], v[100:103]
buffer_atomic_add v12, v235, s[4:7], s94 offen sc1
ds_read_b64_tr_b16 a[52:53], v8 offset:8192
ds_read_b64_tr_b16 a[54:55], v8 offset:9216
ds_read_b64_tr_b16 a[56:57], v8 offset:8704
ds_read_b64_tr_b16 a[58:59], v8 offset:9728
ds_read_b64_tr_b16 a[84:85], v234 offset:45056
ds_read_b64_tr_b16 a[86:87], v234 offset:47104
v_mfma_f32_16x16x32_bf16 v[100:103], a[24:27], v[16:19], v[100:103]
ds_read_b64_tr_b16 a[64:65], v8 offset:10240
ds_read_b64_tr_b16 a[66:67], v8 offset:11264
v_mfma_f32_16x16x32_bf16 v[92:95], a[0:3], a[4:7], 0
ds_read_b64_tr_b16 a[68:69], v8 offset:10752
ds_read_b64_tr_b16 a[70:71], v8 offset:11776
v_mfma_f32_16x16x32_bf16 v[96:99], a[0:3], a[8:11], 0
ds_read_b64_tr_b16 a[76:77], v8 offset:12288
s_waitcnt lgkmcnt(14)
v_mfma_f32_16x16x32_bf16 v[100:103], a[36:39], v[16:19], v[100:103]
ds_read_b64_tr_b16 a[78:79], v8 offset:13312
L_stub18:
s_cbranch_execz L_wret5
v_mfma_f32_16x16x32_bf16 v[92:95], a[12:15], a[16:19], v[92:95]
ds_read_b64_tr_b16 a[80:81], v8 offset:12800
ds_read_b64_tr_b16 a[82:83], v8 offset:13824
v_mfma_f32_16x16x32_bf16 v[96:99], a[12:15], a[20:23], v[96:99]
ds_read_b64_tr_b16 a[88:89], v8 offset:14336
v_mfma_f32_16x16x32_bf16 v[100:103], a[48:51], v[16:19], v[100:103]
ds_read_b64_tr_b16 a[90:91], v8 offset:15360
v_mfma_f32_16x16x32_bf16 v[92:95], a[24:27], a[28:31], v[92:95]
ds_read_b64_tr_b16 a[92:93], v8 offset:14848
ds_read_b64_tr_b16 a[94:95], v8 offset:15872
v_mfma_f32_16x16x32_bf16 v[96:99], a[24:27], a[32:35], v[96:99]
v_cvt_pk_bf16_f32 v132, v132, v133
v_cvt_pk_bf16_f32 v156, v156, v157
v_mfma_f32_16x16x32_bf16 v[100:103], a[60:63], v[16:19], v[100:103]
v_cvt_pk_bf16_f32 v180, v180, v181
v_cvt_pk_bf16_f32 v204, v204, v205
v_mfma_f32_16x16x32_bf16 v[92:95], a[36:39], a[40:43], v[92:95]
v_cvt_pk_bf16_f32 v133, v134, v135
v_cvt_pk_bf16_f32 v157, v158, v159
s_waitcnt lgkmcnt(14)
v_mfma_f32_16x16x32_bf16 v[96:99], a[36:39], a[44:47], v[96:99]
v_cvt_pk_bf16_f32 v181, v182, v183
v_cvt_pk_bf16_f32 v205, v206, v207
v_mfma_f32_16x16x32_bf16 v[100:103], a[72:75], v[16:19], v[100:103]
v_cvt_pk_bf16_f32 v134, v136, v137
v_cvt_pk_bf16_f32 v135, v138, v139
v_mfma_f32_16x16x32_bf16 v[92:95], a[48:51], a[52:55], v[92:95]
v_cvt_pk_bf16_f32 v158, v160, v161
v_cvt_pk_bf16_f32 v159, v162, v163
v_mfma_f32_16x16x32_bf16 v[96:99], a[48:51], a[56:59], v[96:99]
v_cvt_pk_bf16_f32 v182, v184, v185
v_cvt_pk_bf16_f32 v183, v186, v187
s_waitcnt lgkmcnt(12)
v_mfma_f32_16x16x32_bf16 v[100:103], a[84:87], v[16:19], v[100:103]
v_cvt_pk_bf16_f32 v206, v208, v209
v_cvt_pk_bf16_f32 v207, v210, v211
s_waitcnt lgkmcnt(10)
v_mfma_f32_16x16x32_bf16 v[92:95], a[60:63], a[64:67], v[92:95]
s_waitcnt lgkmcnt(8)
v_mfma_f32_16x16x32_bf16 v[96:99], a[60:63], a[68:71], v[96:99]
s_nop 1
v_min_u32 v100, -2, v100
v_min_u32 v101, -2, v101
s_waitcnt lgkmcnt(6)
v_mfma_f32_16x16x32_bf16 v[92:95], a[72:75], a[76:79], v[92:95]
v_min_u32 v102, -2, v102
v_min_u32 v103, -2, v103
s_waitcnt lgkmcnt(4)
v_mfma_f32_16x16x32_bf16 v[96:99], a[72:75], a[80:83], v[96:99]
buffer_store_dwordx4 v[100:103], v254, s[4:7], s97 offen sc1
s_waitcnt lgkmcnt(2)
v_mfma_f32_16x16x32_bf16 v[92:95], a[84:87], a[88:91], v[92:95]
s_waitcnt lgkmcnt(0)
v_mfma_f32_16x16x32_bf16 v[96:99], a[84:87], a[92:95], v[96:99]
s_nop 5
v_cvt_pk_bf16_f32 v92, v92, v93
v_cvt_pk_bf16_f32 v93, v94, v95
v_min_u32 v92, -2, v92
v_min_u32 v93, -2, v93
v_cvt_pk_bf16_f32 v94, v96, v97
v_cvt_pk_bf16_f32 v95, v98, v99
v_min_u32 v94, -2, v94
v_min_u32 v95, -2, v95
buffer_store_dwordx4 v[92:95], v1, s[4:7], s96 offen sc1
s_barrier
s_add_u32 m0, s19, 32768
s_add_u32 s44, s84, 0x1c00000
buffer_load_dwordx4 v1, s[4:7], s44 offen offset:0 sc1 lds
v_mfma_f32_16x16x32_bf16 v[108:111], a[240:243], v[132:135], 0
v_mfma_f32_16x16x32_bf16 v[172:175], a[240:243], v[156:159], 0
v_mfma_f32_16x16x32_bf16 v[112:115], a[244:247], v[132:135], 0
s_nop 5
v_max3_f32 v236, v108, v109, v110
v_max3_f32 v237, -v108, -v109, -v110
v_mfma_f32_16x16x32_bf16 v[176:179], a[244:247], v[156:159], 0
v_max3_f32 v238, v172, v173, v174
v_max3_f32 v239, -v172, -v173, -v174
v_max3_f32 v236, v236, v111, v112
v_max3_f32 v237, v237, -v111, -v112
v_max3_f32 v236, v236, v113, v114
v_max3_f32 v237, v237, -v113, -v114
s_nop 1
v_max3_f32 v238, v238, v175, v176
v_max3_f32 v239, v239, -v175, -v176
v_max3_f32 v238, v238, v177, v178
v_max3_f32 v239, v239, -v177, -v178
v_max_f32 v236, v236, v115
buffer_load_dwordx4 v1, s[4:7], s44 offen offset:1024 sc1 lds
v_max_f32_e64 v237, v237, -v115
v_max_f32 v238, v238, v179
v_max_f32_e64 v239, v239, -v179
v_permlane32_swap_b32 v236, v237
s_nop 0
v_permlane32_swap_b32 v238, v239
v_mov_b32 v11, 0
buffer_atomic_add v11, v251, s[4:7], s89 offen sc0 sc1
v_max_f32 v236, v236, v237
v_max_f32 v238, v238, v239
v_mov_b32 v244, v236
v_mov_b32 v245, v238
s_nop 0
v_permlane16_swap_b32 v236, v244
v_permlane16_swap_b32 v238, v245
v_max_f32 v236, v236, v244
v_max_f32 v238, v238, v245
v_mov_b32 v244, v236
v_mov_b32 v245, v238
s_nop 0
v_permlane32_swap_b32 v236, v244
v_permlane32_swap_b32 v238, v245
v_mul_f32_e64 v236, -v236, v82
v_mul_f32_e64 v237, -v244, v82
buffer_load_dwordx4 v1, s[4:7], s44 offen offset:2048 sc1 lds
v_mul_f32_e64 v238, -v238, v84
v_mul_f32_e64 v239, -v245, v84
v_pk_fma_f32 v[116:117], v[108:109], v[82:83], v[236:237] op_sel:[0,0,0] op_sel_hi:[1,0,0]
v_pk_fma_f32 v[118:119], v[110:111], v[82:83], v[236:237] op_sel:[0,0,0] op_sel_hi:[1,0,0]
v_pk_fma_f32 v[120:121], v[112:113], v[82:83], v[236:237] op_sel:[0,0,0] op_sel_hi:[1,0,0]
v_pk_fma_f32 v[122:123], v[114:115], v[82:83], v[236:237] op_sel:[0,0,0] op_sel_hi:[1,0,0]
v_pk_fma_f32 v[148:149], v[172:173], v[84:85], v[238:239] op_sel:[0,0,0] op_sel_hi:[1,0,0]
v_pk_fma_f32 v[150:151], v[174:175], v[84:85], v[238:239] op_sel:[0,0,0] op_sel_hi:[1,0,0]
v_pk_fma_f32 v[152:153], v[176:177], v[84:85], v[238:239] op_sel:[0,0,0] op_sel_hi:[1,0,0]
v_pk_fma_f32 v[154:155], v[178:179], v[84:85], v[238:239] op_sel:[0,0,0] op_sel_hi:[1,0,0]
v_pk_fma_f32 v[108:109], v[108:109], v[82:83], v[236:237] op_sel:[0,0,1] op_sel_hi:[1,0,1] neg_lo:[1,0,0] neg_hi:[1,0,0]
v_pk_fma_f32 v[110:111], v[110:111], v[82:83], v[236:237] op_sel:[0,0,1] op_sel_hi:[1,0,1] neg_lo:[1,0,0] neg_hi:[1,0,0]
v_pk_fma_f32 v[112:113], v[112:113], v[82:83], v[236:237] op_sel:[0,0,1] op_sel_hi:[1,0,1] neg_lo:[1,0,0] neg_hi:[1,0,0]
v_pk_fma_f32 v[114:115], v[114:115], v[82:83], v[236:237] op_sel:[0,0,1] op_sel_hi:[1,0,1] neg_lo:[1,0,0] neg_hi:[1,0,0]
v_pk_fma_f32 v[172:173], v[172:173], v[84:85], v[238:239] op_sel:[0,0,1] op_sel_hi:[1,0,1] neg_lo:[1,0,0] neg_hi:[1,0,0]
v_pk_fma_f32 v[174:175], v[174:175], v[84:85], v[238:239] op_sel:[0,0,1] op_sel_hi:[1,0,1] neg_lo:[1,0,0] neg_hi:[1,0,0]
v_pk_fma_f32 v[176:177], v[176:177], v[84:85], v[238:239] op_sel:[0,0,1] op_sel_hi:[1,0,1] neg_lo:[1,0,0] neg_hi:[1,0,0]
v_pk_fma_f32 v[178:179], v[178:179], v[84:85], v[238:239] op_sel:[0,0,1] op_sel_hi:[1,0,1] neg_lo:[1,0,0] neg_hi:[1,0,0]
v_exp_f32 v116, v116
v_exp_f32 v108, v108
v_exp_f32 v117, v117
v_exp_f32 v109, v109
v_exp_f32 v118, v118
v_exp_f32 v110, v110
v_exp_f32 v119, v119
v_exp_f32 v111, v111
v_exp_f32 v120, v120
v_exp_f32 v112, v112
v_exp_f32 v121, v121
v_exp_f32 v113, v113
v_exp_f32 v122, v122
v_exp_f32 v114, v114
v_exp_f32 v123, v123
v_exp_f32 v115, v115
v_exp_f32 v148, v148
v_exp_f32 v172, v172
v_exp_f32 v149, v149
v_exp_f32 v173, v173
v_exp_f32 v150, v150
v_exp_f32 v174, v174
v_exp_f32 v151, v151
v_exp_f32 v175, v175
v_exp_f32 v152, v152
v_exp_f32 v176, v176
v_exp_f32 v153, v153
v_exp_f32 v177, v177
v_exp_f32 v154, v154
v_exp_f32 v178, v178
v_exp_f32 v155, v155
v_exp_f32 v179, v179
buffer_load_dwordx4 v1, s[4:7], s44 offen offset:3072 sc1 lds
v_cvt_pk_bf16_f32 v140, v116, v117
v_cvt_pk_bf16_f32 v141, v118, v119
v_cvt_pk_bf16_f32 v142, v120, v121
v_cvt_pk_bf16_f32 v143, v122, v123
v_cvt_pk_bf16_f32 v144, v108, v109
v_cvt_pk_bf16_f32 v145, v110, v111
v_cvt_pk_bf16_f32 v146, v112, v113
v_cvt_pk_bf16_f32 v147, v114, v115
v_cvt_pk_bf16_f32 v164, v148, v149
v_cvt_pk_bf16_f32 v165, v150, v151
v_cvt_pk_bf16_f32 v166, v152, v153
v_cvt_pk_bf16_f32 v167, v154, v155
v_cvt_pk_bf16_f32 v168, v172, v173
v_cvt_pk_bf16_f32 v169, v174, v175
v_cvt_pk_bf16_f32 v170, v176, v177
v_cvt_pk_bf16_f32 v171, v178, v179
s_waitcnt vmcnt(2)
v_readfirstlane_b32 s38, v11
s_nop 0
s_cmp_ge_u32 s38, 8
s_cbranch_scc1 Lpe_46
s_add_u32 s36, s88, 0x90000
s_mov_b32 s37, 0
Lpoll_45:
v_mov_b32 v11, 0
buffer_atomic_add v11, v251, s[4:7], s36 offen sc0 sc1
s_add_u32 s37, s37, 1
s_waitcnt vmcnt(0)
v_readfirstlane_b32 s38, v11
s_nop 0
s_cmp_ge_u32 s38, 8
s_cbranch_scc1 Lpe_46
s_cmp_lt_u32 s37, 0x100000
s_cbranch_scc1 Lpoll_45
Lpe_46:
buffer_load_dwordx4 v[48:51], v1, s[4:7], s98 offen offset:0 sc1
v_mfma_f32_16x16x32_bf16 v[108:111], a[240:243], v[180:183], 0
v_mfma_f32_16x16x32_bf16 v[220:223], a[240:243], v[204:207], 0
v_mfma_f32_16x16x32_bf16 v[112:115], a[244:247], v[180:183], 0
s_nop 5
v_max3_f32 v240, v108, v109, v110
v_max3_f32 v241, -v108, -v109, -v110
v_mfma_f32_16x16x32_bf16 v[224:227], a[244:247], v[204:207], 0
buffer_load_dwordx4 v[124:127], v248, s[4:7], s100 offen sc1
v_max3_f32 v242, v220, v221, v222
v_max3_f32 v243, -v220, -v221, -v222
v_max3_f32 v240, v240, v111, v112
v_max3_f32 v241, v241, -v111, -v112
v_max3_f32 v240, v240, v113, v114
s_nop 1
v_max3_f32 v242, v242, v223, v224
v_max3_f32 v243, v243, -v223, -v224
v_max3_f32 v241, v241, -v113, -v114
v_max3_f32 v242, v242, v225, v226
v_max3_f32 v243, v243, -v225, -v226
v_max_f32 v240, v240, v115
v_max_f32_e64 v241, v241, -v115
v_max_f32 v242, v242, v227
buffer_load_dwordx4 v[52:55], v1, s[4:7], s98 offen offset:1024 sc1
v_max_f32_e64 v243, v243, -v227
v_permlane32_swap_b32 v240, v241
s_nop 0
v_permlane32_swap_b32 v242, v243
v_max_f32 v240, v240, v241
v_max_f32 v242, v242, v243
v_mov_b32 v246, v240
v_mov_b32 v247, v242
s_nop 0
v_permlane16_swap_b32 v240, v246
v_permlane16_swap_b32 v242, v247
buffer_load_dwordx4 v[56:59], v1, s[4:7], s98 offen offset:2048 sc1
v_max_f32 v240, v240, v246
v_max_f32 v242, v242, v247
v_mov_b32 v246, v240
v_mov_b32 v247, v242
s_nop 0
v_permlane32_swap_b32 v240, v246
v_permlane32_swap_b32 v242, v247
v_mul_f32_e64 v240, -v240, v86
v_mul_f32_e64 v241, -v246, v86
v_mul_f32_e64 v242, -v242, v88
v_mul_f32_e64 v243, -v247, v88
buffer_load_dwordx4 v[60:63], v1, s[4:7], s98 offen offset:3072 sc1
v_pk_fma_f32 v[116:117], v[108:109], v[86:87], v[240:241] op_sel:[0,0,0] op_sel_hi:[1,0,0]
v_pk_fma_f32 v[118:119], v[110:111], v[86:87], v[240:241] op_sel:[0,0,0] op_sel_hi:[1,0,0]
v_pk_fma_f32 v[120:121], v[112:113], v[86:87], v[240:241] op_sel:[0,0,0] op_sel_hi:[1,0,0]
v_pk_fma_f32 v[122:123], v[114:115], v[86:87], v[240:241] op_sel:[0,0,0] op_sel_hi:[1,0,0]
v_pk_fma_f32 v[196:197], v[220:221], v[88:89], v[242:243] op_sel:[0,0,0] op_sel_hi:[1,0,0]
v_pk_fma_f32 v[198:199], v[222:223], v[88:89], v[242:243] op_sel:[0,0,0] op_sel_hi:[1,0,0]
v_pk_fma_f32 v[200:201], v[224:225], v[88:89], v[242:243] op_sel:[0,0,0] op_sel_hi:[1,0,0]
v_pk_fma_f32 v[202:203], v[226:227], v[88:89], v[242:243] op_sel:[0,0,0] op_sel_hi:[1,0,0]
v_pk_fma_f32 v[108:109], v[108:109], v[86:87], v[240:241] op_sel:[0,0,1] op_sel_hi:[1,0,1] neg_lo:[1,0,0] neg_hi:[1,0,0]
v_pk_fma_f32 v[110:111], v[110:111], v[86:87], v[240:241] op_sel:[0,0,1] op_sel_hi:[1,0,1] neg_lo:[1,0,0] neg_hi:[1,0,0]
v_pk_fma_f32 v[112:113], v[112:113], v[86:87], v[240:241] op_sel:[0,0,1] op_sel_hi:[1,0,1] neg_lo:[1,0,0] neg_hi:[1,0,0]
v_pk_fma_f32 v[114:115], v[114:115], v[86:87], v[240:241] op_sel:[0,0,1] op_sel_hi:[1,0,1] neg_lo:[1,0,0] neg_hi:[1,0,0]
v_pk_fma_f32 v[220:221], v[220:221], v[88:89], v[242:243] op_sel:[0,0,1] op_sel_hi:[1,0,1] neg_lo:[1,0,0] neg_hi:[1,0,0]
buffer_load_dwordx4 v[64:67], v1, s[4:7], s99 offen offset:0 sc1
v_pk_fma_f32 v[222:223], v[222:223], v[88:89], v[242:243] op_sel:[0,0,1] op_sel_hi:[1,0,1] neg_lo:[1,0,0] neg_hi:[1,0,0]
v_pk_fma_f32 v[224:225], v[224:225], v[88:89], v[242:243] op_sel:[0,0,1] op_sel_hi:[1,0,1] neg_lo:[1,0,0] neg_hi:[1,0,0]
v_pk_fma_f32 v[226:227], v[226:227], v[88:89], v[242:243] op_sel:[0,0,1] op_sel_hi:[1,0,1] neg_lo:[1,0,0] neg_hi:[1,0,0]
v_exp_f32 v116, v116
v_exp_f32 v108, v108
v_exp_f32 v117, v117
v_exp_f32 v109, v109
v_exp_f32 v118, v118
buffer_load_dwordx4 v[68:71], v1, s[4:7], s99 offen offset:1024 sc1
v_exp_f32 v110, v110
v_exp_f32 v119, v119
v_exp_f32 v111, v111
v_exp_f32 v120, v120
v_exp_f32 v112, v112
v_exp_f32 v121, v121
v_exp_f32 v113, v113
buffer_load_dwordx4 v[100:103], v1, s[4:7], s99 offen offset:2048 sc1
v_exp_f32 v122, v122
v_exp_f32 v114, v114
v_exp_f32 v123, v123
v_exp_f32 v115, v115
v_exp_f32 v196, v196
v_exp_f32 v220, v220
v_exp_f32 v197, v197
buffer_load_dwordx4 v[104:107], v1, s[4:7], s99 offen offset:3072 sc1
v_exp_f32 v221, v221
v_exp_f32 v198, v198
v_exp_f32 v222, v222
v_exp_f32 v199, v199
v_exp_f32 v223, v223
v_exp_f32 v200, v200
v_exp_f32 v224, v224
v_exp_f32 v201, v201
v_exp_f32 v225, v225
v_exp_f32 v202, v202
v_exp_f32 v226, v226
v_exp_f32 v203, v203
v_exp_f32 v227, v227
v_cvt_pk_bf16_f32 v188, v116, v117
v_cvt_pk_bf16_f32 v189, v118, v119
v_cvt_pk_bf16_f32 v190, v120, v121
v_cvt_pk_bf16_f32 v191, v122, v123
v_cvt_pk_bf16_f32 v192, v108, v109
v_cvt_pk_bf16_f32 v193, v110, v111
v_cvt_pk_bf16_f32 v194, v112, v113
v_cvt_pk_bf16_f32 v195, v114, v115
v_cvt_pk_bf16_f32 v212, v196, v197
v_cvt_pk_bf16_f32 v213, v198, v199
v_cvt_pk_bf16_f32 v214, v200, v201
v_cvt_pk_bf16_f32 v215, v202, v203
v_cvt_pk_bf16_f32 v216, v220, v221
v_cvt_pk_bf16_f32 v217, v222, v223
v_cvt_pk_bf16_f32 v218, v224, v225
v_cvt_pk_bf16_f32 v219, v226, v227
s_waitcnt vmcnt(8)
v_lshlrev_b32 v92, 16, v48
v_and_b32 v93, 0xffff0000, v48
v_lshlrev_b32 v94, 16, v49
v_and_b32 v95, 0xffff0000, v49
v_lshlrev_b32 v96, 16, v50
v_and_b32 v97, 0xffff0000, v50
v_lshlrev_b32 v98, 16, v51
v_and_b32 v99, 0xffff0000, v51
s_waitcnt vmcnt(7)
v_add_f32_dpp v128, v124, v124 row_ror:4 row_mask:0xf bank_mask:0xf
v_add_f32_dpp v129, v125, v125 row_ror:4 row_mask:0xf bank_mask:0xf
v_add_f32_dpp v130, v126, v126 row_ror:4 row_mask:0xf bank_mask:0xf
v_add_f32_dpp v131, v127, v127 row_ror:4 row_mask:0xf bank_mask:0xf
v_add_f32_dpp v128, v128, v128 row_ror:2 row_mask:0xf bank_mask:0xf
v_add_f32_dpp v129, v129, v129 row_ror:2 row_mask:0xf bank_mask:0xf
v_add_f32_dpp v130, v130, v130 row_ror:2 row_mask:0xf bank_mask:0xf
v_add_f32_dpp v131, v131, v131 row_ror:2 row_mask:0xf bank_mask:0xf
v_add_f32_dpp v128, v128, v128 row_ror:1 row_mask:0xf bank_mask:0xf
v_add_f32_dpp v129, v129, v129 row_ror:1 row_mask:0xf bank_mask:0xf
v_add_f32_dpp v130, v130, v130 row_ror:1 row_mask:0xf bank_mask:0xf
v_add_f32_dpp v131, v131, v131 row_ror:1 row_mask:0xf bank_mask:0xf
v_fma_f32 v135, v129, v130, v131
s_waitcnt vmcnt(6)
v_dot2c_f32_bf16 v92, v52, v249
v_dot2c_f32_bf16 v93, v52, v250
v_dot2c_f32_bf16 v94, v53, v249
v_dot2c_f32_bf16 v95, v53, v250
v_dot2c_f32_bf16 v96, v54, v249
v_dot2c_f32_bf16 v97, v54, v250
v_dot2c_f32_bf16 v98, v55, v249
v_dot2c_f32_bf16 v99, v55, v250
s_waitcnt vmcnt(5)
v_dot2c_f32_bf16 v92, v56, v249
v_dot2c_f32_bf16 v93, v56, v250
v_dot2c_f32_bf16 v94, v57, v249
v_dot2c_f32_bf16 v95, v57, v250
v_dot2c_f32_bf16 v96, v58, v249
v_dot2c_f32_bf16 v97, v58, v250
v_dot2c_f32_bf16 v98, v59, v249
v_dot2c_f32_bf16 v99, v59, v250
s_waitcnt vmcnt(4)
v_dot2c_f32_bf16 v92, v60, v249
v_dot2c_f32_bf16 v93, v60, v250
v_dot2c_f32_bf16 v94, v61, v249
v_dot2c_f32_bf16 v95, v61, v250
v_dot2c_f32_bf16 v96, v62, v249
v_dot2c_f32_bf16 v97, v62, v250
v_dot2c_f32_bf16 v98, v63, v249
v_dot2c_f32_bf16 v99, v63, v250
s_waitcnt vmcnt(3)
v_dot2c_f32_bf16 v92, v64, v249
v_dot2c_f32_bf16 v93, v64, v250
v_dot2c_f32_bf16 v94, v65, v249
v_dot2c_f32_bf16 v95, v65, v250
v_dot2c_f32_bf16 v96, v66, v249
v_dot2c_f32_bf16 v97, v66, v250
v_dot2c_f32_bf16 v98, v67, v249
v_dot2c_f32_bf16 v99, v67, v250
s_waitcnt vmcnt(2)
v_dot2c_f32_bf16 v92, v68, v249
v_dot2c_f32_bf16 v93, v68, v250
v_dot2c_f32_bf16 v94, v69, v249
v_dot2c_f32_bf16 v95, v69, v250
v_dot2c_f32_bf16 v96, v70, v249
v_dot2c_f32_bf16 v97, v70, v250
v_dot2c_f32_bf16 v98, v71, v249
v_dot2c_f32_bf16 v99, v71, v250
s_waitcnt vmcnt(1)
v_dot2c_f32_bf16 v92, v100, v249
v_dot2c_f32_bf16 v93, v100, v250
v_dot2c_f32_bf16 v94, v101, v249
v_dot2c_f32_bf16 v95, v101, v250
v_dot2c_f32_bf16 v96, v102, v249
v_dot2c_f32_bf16 v97, v102, v250
v_dot2c_f32_bf16 v98, v103, v249
v_dot2c_f32_bf16 v99, v103, v250
s_waitcnt vmcnt(0)
v_dot2c_f32_bf16 v92, v104, v249
v_dot2c_f32_bf16 v93, v104, v250
v_dot2c_f32_bf16 v94, v105, v249
v_dot2c_f32_bf16 v95, v105, v250
v_dot2c_f32_bf16 v96, v106, v249
v_dot2c_f32_bf16 v97, v106, v250
v_dot2c_f32_bf16 v98, v107, v249
v_dot2c_f32_bf16 v99, v107, v250
v_fma_f32 v132, v92, v93, v94
v_fma_f32 v133, v95, v96, v97
s_nop 0
v_fma_f32 v134, v98, v99, v128
v_fma_f32 v132, v132, v133, v134
v_cmp_u_f32 vcc, v132, v135
s_cbranch_vccnz L_kvredo3
L_kvback3:
v_cvt_pk_bf16_f32 v128, v128, v129
v_cvt_pk_bf16_f32 v129, v130, v131
v_cvt_pk_bf16_f32 v92, v92, v93
v_cndmask_b32 v128, 0, v128, s[56:57]
v_cndmask_b32 v129, 0, v129, s[56:57]
v_cvt_pk_bf16_f32 v93, v94, v95
v_cvt_pk_bf16_f32 v94, v96, v97
v_cvt_pk_bf16_f32 v95, v98, v99
v_cndmask_b32 v128, v128, v16, s[58:59]
v_cndmask_b32 v129, v129, v16, s[58:59]
ds_write_b64 v252, v[92:93] offset:0
ds_write_b64 v252, v[94:95] offset:1024
ds_write_b64 v252, v[128:129] offset:2048
s_waitcnt lgkmcnt(0)
s_barrier
ds_read_b128 a[8:11], v1 offset:2048
ds_read_b128 a[20:23], v1 offset:5120
ds_read_b128 a[0:3], v1 offset:0
ds_read_b128 a[12:15], v1 offset:3072
ds_read_b128 a[4:7], v1 offset:1024
ds_read_b128 a[16:19], v1 offset:4096
s_waitcnt lgkmcnt(5)
v_mfma_f32_16x16x32_bf16 v[116:119], a[8:11], v[212:215], 0
s_waitcnt lgkmcnt(4)
v_mfma_f32_16x16x32_bf16 v[120:123], a[20:23], v[216:219], 0
s_waitcnt lgkmcnt(3)
v_mfma_f32_16x16x32_bf16 v[204:207], a[0:3], v[212:215], 0
s_nop 3
v_rcp_f32 v118, v117
s_waitcnt lgkmcnt(2)
v_mfma_f32_16x16x32_bf16 v[220:223], a[12:15], v[216:219], 0
v_rcp_f32 v119, v121
v_mul_f32 v116, v116, v118
buffer_atomic_add v12, v10, s[4:7], s74 offen sc1
v_fmac_f32 v116, v120, v119
v_mfma_f32_16x16x32_bf16 v[100:103], a[8:11], v[164:167], 0
v_add_f32 v116, 0x358637bd, v116
v_rcp_f32 v116, v116
s_waitcnt lgkmcnt(1)
v_mfma_f32_16x16x32_bf16 v[208:211], a[4:7], v[212:215], 0
v_mul_f32 v118, v118, v116
v_mul_f32 v119, v119, v116
v_mfma_f32_16x16x32_bf16 v[104:107], a[20:23], v[168:171], 0
v_mul_f32 v204, v204, v118
v_mul_f32 v205, v205, v118
s_waitcnt lgkmcnt(0)
v_mfma_f32_16x16x32_bf16 v[224:227], a[16:19], v[216:219], 0
v_mul_f32 v206, v206, v118
v_mul_f32 v207, v207, v118
v_fmac_f32 v204, v220, v119
v_fmac_f32 v205, v221, v119
v_rcp_f32 v102, v101
v_mul_f32 v208, v208, v118
v_mul_f32 v209, v209, v118
v_mul_f32 v210, v210, v118
v_mul_f32 v211, v211, v118
v_fmac_f32 v206, v222, v119
v_fmac_f32 v207, v223, v119
v_cvt_pk_bf16_f32 v204, v204, v205
v_rcp_f32 v103, v105
v_fmac_f32 v208, v224, v119
v_fmac_f32 v209, v225, v119
v_fmac_f32 v210, v226, v119
v_fmac_f32 v211, v227, v119
v_cvt_pk_bf16_f32 v205, v206, v207
v_cvt_pk_bf16_f32 v206, v208, v209
v_cvt_pk_bf16_f32 v207, v210, v211
v_mul_f32 v100, v100, v102
v_mfma_f32_16x16x32_bf16 v[156:159], a[0:3], v[164:167], 0
buffer_store_dwordx4 v[204:207], v2, s[4:7], s72 offen offset:3072 sc1
v_fmac_f32 v100, v104, v103
v_mfma_f32_16x16x32_bf16 v[172:175], a[12:15], v[168:171], 0
v_add_f32 v100, 0x358637bd, v100
v_rcp_f32 v100, v100
v_mfma_f32_16x16x32_bf16 v[108:111], a[8:11], v[188:191], 0
v_mul_f32 v102, v102, v100
v_mul_f32 v103, v103, v100
v_mfma_f32_16x16x32_bf16 v[160:163], a[4:7], v[164:167], 0
v_mul_f32 v156, v156, v102
v_mul_f32 v157, v157, v102
v_mfma_f32_16x16x32_bf16 v[112:115], a[20:23], v[192:195], 0
v_mul_f32 v158, v158, v102
v_mul_f32 v159, v159, v102
v_mfma_f32_16x16x32_bf16 v[176:179], a[16:19], v[168:171], 0
v_fmac_f32 v156, v172, v103
v_fmac_f32 v157, v173, v103
v_rcp_f32 v110, v109
v_mul_f32 v160, v160, v102
v_mul_f32 v161, v161, v102
v_mul_f32 v162, v162, v102
v_mul_f32 v163, v163, v102
v_fmac_f32 v158, v174, v103
v_fmac_f32 v159, v175, v103
v_cvt_pk_bf16_f32 v156, v156, v157
v_rcp_f32 v111, v113
v_fmac_f32 v160, v176, v103
v_fmac_f32 v161, v177, v103
v_fmac_f32 v162, v178, v103
v_fmac_f32 v163, v179, v103
v_cvt_pk_bf16_f32 v157, v158, v159
v_cvt_pk_bf16_f32 v158, v160, v161
v_cvt_pk_bf16_f32 v159, v162, v163
v_mul_f32 v108, v108, v110
v_mfma_f32_16x16x32_bf16 v[180:183], a[0:3], v[188:191], 0
buffer_store_dwordx4 v[156:159], v2, s[4:7], s72 offen offset:1024 sc1
v_fmac_f32 v108, v112, v111
v_mfma_f32_16x16x32_bf16 v[196:199], a[12:15], v[192:195], 0
v_add_f32 v108, 0x358637bd, v108
v_rcp_f32 v108, v108
v_mfma_f32_16x16x32_bf16 v[92:95], a[8:11], v[140:143], 0
v_mul_f32 v110, v110, v108
v_mul_f32 v111, v111, v108
v_mfma_f32_16x16x32_bf16 v[184:187], a[4:7], v[188:191], 0
v_mul_f32 v180, v180, v110
v_mul_f32 v181, v181, v110
v_mfma_f32_16x16x32_bf16 v[96:99], a[20:23], v[144:147], 0
v_mul_f32 v182, v182, v110
v_mul_f32 v183, v183, v110
v_mfma_f32_16x16x32_bf16 v[200:203], a[16:19], v[192:195], 0
v_fmac_f32 v180, v196, v111
v_fmac_f32 v181, v197, v111
v_rcp_f32 v94, v93
v_mul_f32 v184, v184, v110
v_mul_f32 v185, v185, v110
v_mul_f32 v186, v186, v110
v_mul_f32 v187, v187, v110
v_fmac_f32 v182, v198, v111
v_fmac_f32 v183, v199, v111
v_cvt_pk_bf16_f32 v180, v180, v181
v_rcp_f32 v95, v97
v_fmac_f32 v184, v200, v111
v_fmac_f32 v185, v201, v111
v_fmac_f32 v186, v202, v111
v_fmac_f32 v187, v203, v111
v_cvt_pk_bf16_f32 v181, v182, v183
v_cvt_pk_bf16_f32 v182, v184, v185
v_cvt_pk_bf16_f32 v183, v186, v187
v_mul_f32 v92, v92, v94
v_mfma_f32_16x16x32_bf16 v[132:135], a[0:3], v[140:143], 0
buffer_store_dwordx4 v[180:183], v2, s[4:7], s72 offen offset:2048 sc1
v_fmac_f32 v92, v96, v95
v_mfma_f32_16x16x32_bf16 v[148:151], a[12:15], v[144:147], 0
v_add_f32 v92, 0x358637bd, v92
v_rcp_f32 v92, v92
v_mfma_f32_16x16x32_bf16 v[136:139], a[4:7], v[140:143], 0
v_mul_f32 v94, v94, v92
v_mul_f32 v95, v95, v92
v_mfma_f32_16x16x32_bf16 v[152:155], a[16:19], v[144:147], 0
v_mul_f32 v132, v132, v94
v_mul_f32 v133, v133, v94
v_mul_f32 v134, v134, v94
v_mul_f32 v135, v135, v94
v_fmac_f32 v132, v148, v95
v_fmac_f32 v133, v149, v95
v_mul_f32 v136, v136, v94
v_mul_f32 v137, v137, v94
v_mul_f32 v138, v138, v94
v_mul_f32 v139, v139, v94
v_fmac_f32 v134, v150, v95
v_fmac_f32 v135, v151, v95
v_cvt_pk_bf16_f32 v132, v132, v133
v_fmac_f32 v136, v152, v95
v_fmac_f32 v137, v153, v95
v_fmac_f32 v138, v154, v95
v_fmac_f32 v139, v155, v95
v_cvt_pk_bf16_f32 v133, v134, v135
v_cvt_pk_bf16_f32 v134, v136, v137
v_cvt_pk_bf16_f32 v135, v138, v139
buffer_store_dwordx4 v[132:135], v2, s[4:7], s72 offen offset:0 sc1
s_add_u32 s92, s71, 0x30000
s_add_u32 s40, s4, 0xc00000
s_addc_u32 s41, s5, 0
v_add_u32 v5, 32768, v1
v_add_u32 v6, 98304, v1
s_mov_b32 s35, s9
v_lshlrev_b32 v132, 16, v32
v_and_b32 v133, 0xffff0000, v32
v_lshlrev_b32 v134, 16, v33
v_and_b32 v135, 0xffff0000, v33
v_lshlrev_b32 v136, 16, v34
v_and_b32 v137, 0xffff0000, v34
v_lshlrev_b32 v138, 16, v35
v_and_b32 v139, 0xffff0000, v35
v_lshlrev_b32 v140, 16, v36
v_and_b32 v141, 0xffff0000, v36
v_lshlrev_b32 v142, 16, v37
v_and_b32 v143, 0xffff0000, v37
v_lshlrev_b32 v144, 16, v38
v_and_b32 v145, 0xffff0000, v38
v_lshlrev_b32 v146, 16, v39
v_and_b32 v147, 0xffff0000, v39
v_lshlrev_b32 v148, 16, v40
v_and_b32 v149, 0xffff0000, v40
v_lshlrev_b32 v150, 16, v41
v_and_b32 v151, 0xffff0000, v41
v_lshlrev_b32 v152, 16, v42
v_and_b32 v153, 0xffff0000, v42
v_lshlrev_b32 v154, 16, v43
v_and_b32 v155, 0xffff0000, v43
v_lshlrev_b32 v156, 16, v44
v_and_b32 v157, 0xffff0000, v44
v_lshlrev_b32 v158, 16, v45
v_and_b32 v159, 0xffff0000, v45
v_lshlrev_b32 v160, 16, v46
v_and_b32 v161, 0xffff0000, v46
v_lshlrev_b32 v162, 16, v47
v_and_b32 v163, 0xffff0000, v47
s_mov_b32 s95, -1
s_mov_b64 exec, 0
s_cmp_eq_u32 s28, 3
s_cbranch_scc1 L_stub19
s_cmp_eq_u32 s28, 2
s_cbranch_scc1 L_wret7
s_cmp_eq_u32 s28, 0
s_cbranch_scc1 L_wret7
L_wret7:
s_mov_b64 exec, -1
s_cmp_lg_u32 s28, 1
s_cbranch_scc1 Lpo_49
s_add_u32 s36, s11, 0x30080
s_mov_b32 s37, 0
v_mov_b32 v11, 0
buffer_atomic_add v11, v251, s[4:7], s36 offen sc0 sc1
s_sleep 4
Lpoll_47:
v_mov_b32 v234, 0
buffer_atomic_add v234, v251, s[4:7], s36 offen sc0 sc1
s_waitcnt vmcnt(1)
v_readfirstlane_b32 s38, v11
s_nop 0
s_cmp_ge_u32 s38, 32
s_cbranch_scc1 Lpe_48
v_mov_b32 v11, 0
buffer_atomic_add v11, v251, s[4:7], s36 offen sc0 sc1
s_waitcnt vmcnt(1)
v_readfirstlane_b32 s38, v234
s_nop 0
s_cmp_ge_u32 s38, 32
s_cbranch_scc1 Lpe_48
s_add_u32 s37, s37, 1
s_cmp_lt_u32 s37, 0x80000
s_cbranch_scc1 Lpoll_47
s_waitcnt vmcnt(0)
Lpo_49:
s_waitcnt vmcnt(0)
Lpe_48:
s_barrier
L_k2go3:
buffer_load_dwordx4 a[0:3], v4, s[40:43], s35 offen offset:0 sc1
buffer_load_dwordx4 a[4:7], v4, s[40:43], s35 offen offset:1024 sc1
s_add_u32 s35, s9, 4096
buffer_load_dwordx4 a[8:11], v4, s[40:43], s35 offen offset:0 sc1
buffer_load_dwordx4 a[12:15], v4, s[40:43], s35 offen offset:1024 sc1
s_add_u32 s35, s9, 16384
buffer_load_dwordx4 a[16:19], v4, s[40:43], s35 offen offset:0 sc1
buffer_load_dwordx4 a[20:23], v4, s[40:43], s35 offen offset:1024 sc1
s_add_u32 s35, s9, 20480
buffer_load_dwordx4 a[24:27], v4, s[40:43], s35 offen offset:0 sc1
buffer_load_dwordx4 a[28:31], v4, s[40:43], s35 offen offset:1024 sc1
s_add_u32 s35, s9, 32768
buffer_load_dwordx4 a[32:35], v4, s[40:43], s35 offen offset:0 sc1
buffer_load_dwordx4 a[36:39], v4, s[40:43], s35 offen offset:1024 sc1
s_add_u32 s35, s9, 36864
buffer_load_dwordx4 a[40:43], v4, s[40:43], s35 offen offset:0 sc1
buffer_load_dwordx4 a[44:47], v4, s[40:43], s35 offen offset:1024 sc1
s_add_u32 s35, s9, 49152
ds_read_b128 a[96:99], v5 offset:0
ds_read_b128 a[100:103], v5 offset:1024
ds_read_b128 a[104:107], v5 offset:2048
ds_read_b128 a[108:111], v5 offset:3072
ds_read_b128 a[112:115], v5 offset:4096
ds_read_b128 a[116:119], v5 offset:5120
ds_read_b128 a[120:123], v5 offset:6144
ds_read_b128 a[124:127], v5 offset:7168
s_waitcnt vmcnt(10) lgkmcnt(4)
v_mfma_f32_16x16x32_bf16 v[132:135], a[96:99], a[0:3], v[132:135]
ds_read_b128 a[128:131], v5 offset:8192
v_mfma_f32_16x16x32_bf16 v[148:151], a[96:99], a[4:7], v[148:151]
ds_read_b128 a[132:135], v5 offset:9216
v_mfma_f32_16x16x32_bf16 v[152:155], a[100:103], a[4:7], v[152:155]
buffer_load_dwordx4 a[48:51], v4, s[40:43], s35 offen offset:0 sc1
v_mfma_f32_16x16x32_bf16 v[136:139], a[100:103], a[0:3], v[136:139]
ds_read_b128 a[136:139], v5 offset:10240
v_mfma_f32_16x16x32_bf16 v[140:143], a[104:107], a[0:3], v[140:143]
ds_read_b128 a[140:143], v5 offset:11264
v_mfma_f32_16x16x32_bf16 v[156:159], a[104:107], a[4:7], v[156:159]
v_mfma_f32_16x16x32_bf16 v[160:163], a[108:111], a[4:7], v[160:163]
buffer_load_dwordx4 a[52:55], v4, s[40:43], s35 offen offset:1024 sc1
s_add_u32 s35, s9, 53248
v_mfma_f32_16x16x32_bf16 v[144:147], a[108:111], a[0:3], v[144:147]
s_waitcnt vmcnt(10) lgkmcnt(4)
v_mfma_f32_16x16x32_bf16 v[132:135], a[112:115], a[8:11], v[132:135]
ds_read_b128 a[96:99], v5 offset:12288
L_stub19:
s_cbranch_execz L_wret7
v_mfma_f32_16x16x32_bf16 v[148:151], a[112:115], a[12:15], v[148:151]
ds_read_b128 a[100:103], v5 offset:13312
v_mfma_f32_16x16x32_bf16 v[152:155], a[116:119], a[12:15], v[152:155]
buffer_load_dwordx4 a[0:3], v4, s[40:43], s35 offen offset:0 sc1
v_mfma_f32_16x16x32_bf16 v[136:139], a[116:119], a[8:11], v[136:139]
ds_read_b128 a[104:107], v5 offset:14336
v_mfma_f32_16x16x32_bf16 v[140:143], a[120:123], a[8:11], v[140:143]
ds_read_b128 a[108:111], v5 offset:15360
v_mfma_f32_16x16x32_bf16 v[156:159], a[120:123], a[12:15], v[156:159]
v_mfma_f32_16x16x32_bf16 v[160:163], a[124:127], a[12:15], v[160:163]
buffer_load_dwordx4 a[4:7], v4, s[40:43], s35 offen offset:1024 sc1
s_add_u32 s35, s9, 65536
v_mfma_f32_16x16x32_bf16 v[144:147], a[124:127], a[8:11], v[144:147]
s_waitcnt vmcnt(10) lgkmcnt(4)
v_mfma_f32_16x16x32_bf16 v[132:135], a[128:131], a[16:19], v[132:135]
ds_read_b128 a[112:115], v5 offset:16384
v_mfma_f32_16x16x32_bf16 v[148:151], a[128:131], a[20:23], v[148:151]
ds_read_b128 a[116:119], v5 offset:17408
v_mfma_f32_16x16x32_bf16 v[152:155], a[132:135], a[20:23], v[152:155]
buffer_load_dwordx4 a[8:11], v4, s[40:43], s35 offen offset:0 sc1
v_mfma_f32_16x16x32_bf16 v[136:139], a[132:135], a[16:19], v[136:139]
ds_read_b128 a[120:123], v5 offset:18432
v_mfma_f32_16x16x32_bf16 v[140:143], a[136:139], a[16:19], v[140:143]
ds_read_b128 a[124:127], v5 offset:19456
v_mfma_f32_16x16x32_bf16 v[156:159], a[136:139], a[20:23], v[156:159]
v_mfma_f32_16x16x32_bf16 v[160:163], a[140:143], a[20:23], v[160:163]
buffer_load_dwordx4 a[12:15], v4, s[40:43], s35 offen offset:1024 sc1
s_add_u32 s35, s9, 69632
v_mfma_f32_16x16x32_bf16 v[144:147], a[140:143], a[16:19], v[144:147]
s_waitcnt vmcnt(10) lgkmcnt(4)
v_mfma_f32_16x16x32_bf16 v[132:135], a[96:99], a[24:27], v[132:135]
ds_read_b128 a[128:131], v5 offset:20480
v_mfma_f32_16x16x32_bf16 v[148:151], a[96:99], a[28:31], v[148:151]
ds_read_b128 a[132:135], v5 offset:21504
v_mfma_f32_16x16x32_bf16 v[152:155], a[100:103], a[28:31], v[152:155]
buffer_load_dwordx4 a[16:19], v4, s[40:43], s35 offen offset:0 sc1
v_mfma_f32_16x16x32_bf16 v[136:139], a[100:103], a[24:27], v[136:139]
ds_read_b128 a[136:139], v5 offset:22528
v_mfma_f32_16x16x32_bf16 v[140:143], a[104:107], a[24:27], v[140:143]
ds_read_b128 a[140:143], v5 offset:23552
v_mfma_f32_16x16x32_bf16 v[156:159], a[104:107], a[28:31], v[156:159]
v_mfma_f32_16x16x32_bf16 v[160:163], a[108:111], a[28:31], v[160:163]
buffer_load_dwordx4 a[20:23], v4, s[40:43], s35 offen offset:1024 sc1
s_add_u32 s35, s9, 81920
v_mfma_f32_16x16x32_bf16 v[144:147], a[108:111], a[24:27], v[144:147]
s_waitcnt vmcnt(10) lgkmcnt(4)
v_mfma_f32_16x16x32_bf16 v[132:135], a[112:115], a[32:35], v[132:135]
ds_read_b128 a[96:99], v5 offset:24576
v_mfma_f32_16x16x32_bf16 v[148:151], a[112:115], a[36:39], v[148:151]
ds_read_b128 a[100:103], v5 offset:25600
v_mfma_f32_16x16x32_bf16 v[152:155], a[116:119], a[36:39], v[152:155]
buffer_load_dwordx4 a[24:27], v4, s[40:43], s35 offen offset:0 sc1
v_mfma_f32_16x16x32_bf16 v[136:139], a[116:119], a[32:35], v[136:139]
ds_read_b128 a[104:107], v5 offset:26624
v_mfma_f32_16x16x32_bf16 v[140:143], a[120:123], a[32:35], v[140:143]
ds_read_b128 a[108:111], v5 offset:27648
v_mfma_f32_16x16x32_bf16 v[156:159], a[120:123], a[36:39], v[156:159]
v_mfma_f32_16x16x32_bf16 v[160:163], a[124:127], a[36:39], v[160:163]
buffer_load_dwordx4 a[28:31], v4, s[40:43], s35 offen offset:1024 sc1
s_add_u32 s35, s9, 86016
v_mfma_f32_16x16x32_bf16 v[144:147], a[124:127], a[32:35], v[144:147]
s_waitcnt vmcnt(10) lgkmcnt(4)
v_mfma_f32_16x16x32_bf16 v[132:135], a[128:131], a[40:43], v[132:135]
ds_read_b128 a[112:115], v5 offset:28672
v_mfma_f32_16x16x32_bf16 v[148:151], a[128:131], a[44:47], v[148:151]
ds_read_b128 a[116:119], v5 offset:29696
v_mfma_f32_16x16x32_bf16 v[152:155], a[132:135], a[44:47], v[152:155]
buffer_load_dwordx4 a[32:35], v4, s[40:43], s35 offen offset:0 sc1
v_mfma_f32_16x16x32_bf16 v[136:139], a[132:135], a[40:43], v[136:139]
ds_read_b128 a[120:123], v5 offset:30720
v_mfma_f32_16x16x32_bf16 v[140:143], a[136:139], a[40:43], v[140:143]
ds_read_b128 a[124:127], v5 offset:31744
v_mfma_f32_16x16x32_bf16 v[156:159], a[136:139], a[44:47], v[156:159]
v_mfma_f32_16x16x32_bf16 v[160:163], a[140:143], a[44:47], v[160:163]
buffer_load_dwordx4 a[36:39], v4, s[40:43], s35 offen offset:1024 sc1
s_add_u32 s35, s9, 98304
v_mfma_f32_16x16x32_bf16 v[144:147], a[140:143], a[40:43], v[144:147]
s_waitcnt vmcnt(10) lgkmcnt(4)
v_mfma_f32_16x16x32_bf16 v[132:135], a[96:99], a[48:51], v[132:135]
ds_read_b128 a[128:131], v5 offset:32768
v_mfma_f32_16x16x32_bf16 v[148:151], a[96:99], a[52:55], v[148:151]
ds_read_b128 a[132:135], v5 offset:33792
v_mfma_f32_16x16x32_bf16 v[152:155], a[100:103], a[52:55], v[152:155]
buffer_load_dwordx4 a[40:43], v4, s[40:43], s35 offen offset:0 sc1
v_mfma_f32_16x16x32_bf16 v[136:139], a[100:103], a[48:51], v[136:139]
ds_read_b128 a[136:139], v5 offset:34816
v_mfma_f32_16x16x32_bf16 v[140:143], a[104:107], a[48:51], v[140:143]
ds_read_b128 a[140:143], v5 offset:35840
v_mfma_f32_16x16x32_bf16 v[156:159], a[104:107], a[52:55], v[156:159]
v_mfma_f32_16x16x32_bf16 v[160:163], a[108:111], a[52:55], v[160:163]
buffer_load_dwordx4 a[44:47], v4, s[40:43], s35 offen offset:1024 sc1
s_add_u32 s35, s9, 102400
v_mfma_f32_16x16x32_bf16 v[144:147], a[108:111], a[48:51], v[144:147]
s_waitcnt vmcnt(10) lgkmcnt(4)
v_mfma_f32_16x16x32_bf16 v[132:135], a[112:115], a[0:3], v[132:135]
ds_read_b128 a[96:99], v5 offset:36864
v_mfma_f32_16x16x32_bf16 v[148:151], a[112:115], a[4:7], v[148:151]
ds_read_b128 a[100:103], v5 offset:37888
v_mfma_f32_16x16x32_bf16 v[152:155], a[116:119], a[4:7], v[152:155]
buffer_load_dwordx4 a[48:51], v4, s[40:43], s35 offen offset:0 sc1
v_mfma_f32_16x16x32_bf16 v[136:139], a[116:119], a[0:3], v[136:139]
ds_read_b128 a[104:107], v5 offset:38912
v_mfma_f32_16x16x32_bf16 v[140:143], a[120:123], a[0:3], v[140:143]
ds_read_b128 a[108:111], v5 offset:39936
v_mfma_f32_16x16x32_bf16 v[156:159], a[120:123], a[4:7], v[156:159]
v_mfma_f32_16x16x32_bf16 v[160:163], a[124:127], a[4:7], v[160:163]
buffer_load_dwordx4 a[52:55], v4, s[40:43], s35 offen offset:1024 sc1
s_add_u32 s35, s9, 114688
v_mfma_f32_16x16x32_bf16 v[144:147], a[124:127], a[0:3], v[144:147]
s_waitcnt vmcnt(10) lgkmcnt(4)
v_mfma_f32_16x16x32_bf16 v[132:135], a[128:131], a[8:11], v[132:135]
ds_read_b128 a[112:115], v5 offset:40960
v_mfma_f32_16x16x32_bf16 v[148:151], a[128:131], a[12:15], v[148:151]
ds_read_b128 a[116:119], v5 offset:41984
v_mfma_f32_16x16x32_bf16 v[152:155], a[132:135], a[12:15], v[152:155]
buffer_load_dwordx4 a[0:3], v4, s[40:43], s35 offen offset:0 sc1
v_mfma_f32_16x16x32_bf16 v[136:139], a[132:135], a[8:11], v[136:139]
ds_read_b128 a[120:123], v5 offset:43008
v_mfma_f32_16x16x32_bf16 v[140:143], a[136:139], a[8:11], v[140:143]
ds_read_b128 a[124:127], v5 offset:44032
v_mfma_f32_16x16x32_bf16 v[156:159], a[136:139], a[12:15], v[156:159]
v_mfma_f32_16x16x32_bf16 v[160:163], a[140:143], a[12:15], v[160:163]
buffer_load_dwordx4 a[4:7], v4, s[40:43], s35 offen offset:1024 sc1
s_add_u32 s35, s9, 118784
v_mfma_f32_16x16x32_bf16 v[144:147], a[140:143], a[8:11], v[144:147]
s_waitcnt vmcnt(10) lgkmcnt(4)
v_mfma_f32_16x16x32_bf16 v[132:135], a[96:99], a[16:19], v[132:135]
ds_read_b128 a[128:131], v5 offset:45056
v_mfma_f32_16x16x32_bf16 v[148:151], a[96:99], a[20:23], v[148:151]
ds_read_b128 a[132:135], v5 offset:46080
v_mfma_f32_16x16x32_bf16 v[152:155], a[100:103], a[20:23], v[152:155]
buffer_load_dwordx4 a[8:11], v4, s[40:43], s35 offen offset:0 sc1
v_mfma_f32_16x16x32_bf16 v[136:139], a[100:103], a[16:19], v[136:139]
ds_read_b128 a[136:139], v5 offset:47104
v_mfma_f32_16x16x32_bf16 v[140:143], a[104:107], a[16:19], v[140:143]
ds_read_b128 a[140:143], v5 offset:48128
v_mfma_f32_16x16x32_bf16 v[156:159], a[104:107], a[20:23], v[156:159]
v_mfma_f32_16x16x32_bf16 v[160:163], a[108:111], a[20:23], v[160:163]
buffer_load_dwordx4 a[12:15], v4, s[40:43], s35 offen offset:1024 sc1
s_add_u32 s35, s9, 524288
v_mfma_f32_16x16x32_bf16 v[144:147], a[108:111], a[16:19], v[144:147]
s_waitcnt vmcnt(10) lgkmcnt(4)
v_mfma_f32_16x16x32_bf16 v[132:135], a[112:115], a[24:27], v[132:135]
ds_read_b128 a[96:99], v5 offset:49152
v_mfma_f32_16x16x32_bf16 v[148:151], a[112:115], a[28:31], v[148:151]
ds_read_b128 a[100:103], v5 offset:50176
v_mfma_f32_16x16x32_bf16 v[152:155], a[116:119], a[28:31], v[152:155]
buffer_load_dwordx4 a[16:19], v4, s[40:43], s35 offen offset:0 sc1
v_mfma_f32_16x16x32_bf16 v[136:139], a[116:119], a[24:27], v[136:139]
ds_read_b128 a[104:107], v5 offset:51200
v_mfma_f32_16x16x32_bf16 v[140:143], a[120:123], a[24:27], v[140:143]
ds_read_b128 a[108:111], v5 offset:52224
v_mfma_f32_16x16x32_bf16 v[156:159], a[120:123], a[28:31], v[156:159]
v_mfma_f32_16x16x32_bf16 v[160:163], a[124:127], a[28:31], v[160:163]
buffer_load_dwordx4 a[20:23], v4, s[40:43], s35 offen offset:1024 sc1
s_add_u32 s35, s9, 528384
v_mfma_f32_16x16x32_bf16 v[144:147], a[124:127], a[24:27], v[144:147]
s_waitcnt vmcnt(10) lgkmcnt(4)
v_mfma_f32_16x16x32_bf16 v[132:135], a[128:131], a[32:35], v[132:135]
ds_read_b128 a[112:115], v5 offset:53248
v_mfma_f32_16x16x32_bf16 v[148:151], a[128:131], a[36:39], v[148:151]
ds_read_b128 a[116:119], v5 offset:54272
v_mfma_f32_16x16x32_bf16 v[152:155], a[132:135], a[36:39], v[152:155]
buffer_load_dwordx4 a[24:27], v4, s[40:43], s35 offen offset:0 sc1
v_mfma_f32_16x16x32_bf16 v[136:139], a[132:135], a[32:35], v[136:139]
ds_read_b128 a[120:123], v5 offset:55296
v_mfma_f32_16x16x32_bf16 v[140:143], a[136:139], a[32:35], v[140:143]
ds_read_b128 a[124:127], v5 offset:56320
v_mfma_f32_16x16x32_bf16 v[156:159], a[136:139], a[36:39], v[156:159]
v_mfma_f32_16x16x32_bf16 v[160:163], a[140:143], a[36:39], v[160:163]
buffer_load_dwordx4 a[28:31], v4, s[40:43], s35 offen offset:1024 sc1
s_add_u32 s35, s9, 540672
v_mfma_f32_16x16x32_bf16 v[144:147], a[140:143], a[32:35], v[144:147]
s_waitcnt vmcnt(10) lgkmcnt(4)
v_mfma_f32_16x16x32_bf16 v[132:135], a[96:99], a[40:43], v[132:135]
ds_read_b128 a[128:131], v5 offset:57344
v_mfma_f32_16x16x32_bf16 v[148:151], a[96:99], a[44:47], v[148:151]
ds_read_b128 a[132:135], v5 offset:58368
v_mfma_f32_16x16x32_bf16 v[152:155], a[100:103], a[44:47], v[152:155]
buffer_load_dwordx4 a[32:35], v4, s[40:43], s35 offen offset:0 sc1
v_mfma_f32_16x16x32_bf16 v[136:139], a[100:103], a[40:43], v[136:139]
ds_read_b128 a[136:139], v5 offset:59392
v_mfma_f32_16x16x32_bf16 v[140:143], a[104:107], a[40:43], v[140:143]
ds_read_b128 a[140:143], v5 offset:60416
v_mfma_f32_16x16x32_bf16 v[156:159], a[104:107], a[44:47], v[156:159]
v_mfma_f32_16x16x32_bf16 v[160:163], a[108:111], a[44:47], v[160:163]
buffer_load_dwordx4 a[36:39], v4, s[40:43], s35 offen offset:1024 sc1
s_add_u32 s35, s9, 544768
v_mfma_f32_16x16x32_bf16 v[144:147], a[108:111], a[40:43], v[144:147]
s_waitcnt vmcnt(10) lgkmcnt(4)
v_mfma_f32_16x16x32_bf16 v[132:135], a[112:115], a[48:51], v[132:135]
ds_read_b128 a[96:99], v5 offset:61440
v_mfma_f32_16x16x32_bf16 v[148:151], a[112:115], a[52:55], v[148:151]
ds_read_b128 a[100:103], v5 offset:62464
v_mfma_f32_16x16x32_bf16 v[152:155], a[116:119], a[52:55], v[152:155]
buffer_load_dwordx4 a[40:43], v4, s[40:43], s35 offen offset:0 sc1
v_mfma_f32_16x16x32_bf16 v[136:139], a[116:119], a[48:51], v[136:139]
ds_read_b128 a[104:107], v5 offset:63488
v_mfma_f32_16x16x32_bf16 v[140:143], a[120:123], a[48:51], v[140:143]
ds_read_b128 a[108:111], v5 offset:64512
v_mfma_f32_16x16x32_bf16 v[156:159], a[120:123], a[52:55], v[156:159]
v_mfma_f32_16x16x32_bf16 v[160:163], a[124:127], a[52:55], v[160:163]
buffer_load_dwordx4 a[44:47], v4, s[40:43], s35 offen offset:1024 sc1
s_add_u32 s35, s9, 557056
v_mfma_f32_16x16x32_bf16 v[144:147], a[124:127], a[48:51], v[144:147]
s_waitcnt vmcnt(10) lgkmcnt(4)
v_mfma_f32_16x16x32_bf16 v[132:135], a[128:131], a[0:3], v[132:135]
ds_read_b128 a[112:115], v6 offset:0
v_mfma_f32_16x16x32_bf16 v[148:151], a[128:131], a[4:7], v[148:151]
ds_read_b128 a[116:119], v6 offset:1024
v_mfma_f32_16x16x32_bf16 v[152:155], a[132:135], a[4:7], v[152:155]
buffer_load_dwordx4 a[48:51], v4, s[40:43], s35 offen offset:0 sc1
v_mfma_f32_16x16x32_bf16 v[136:139], a[132:135], a[0:3], v[136:139]
ds_read_b128 a[120:123], v6 offset:2048
v_mfma_f32_16x16x32_bf16 v[140:143], a[136:139], a[0:3], v[140:143]
ds_read_b128 a[124:127], v6 offset:3072
v_mfma_f32_16x16x32_bf16 v[156:159], a[136:139], a[4:7], v[156:159]
v_mfma_f32_16x16x32_bf16 v[160:163], a[140:143], a[4:7], v[160:163]
buffer_load_dwordx4 a[52:55], v4, s[40:43], s35 offen offset:1024 sc1
s_add_u32 s35, s9, 561152
v_mfma_f32_16x16x32_bf16 v[144:147], a[140:143], a[0:3], v[144:147]
s_waitcnt vmcnt(10) lgkmcnt(4)
v_mfma_f32_16x16x32_bf16 v[132:135], a[96:99], a[8:11], v[132:135]
ds_read_b128 a[128:131], v6 offset:4096
v_mfma_f32_16x16x32_bf16 v[148:151], a[96:99], a[12:15], v[148:151]
ds_read_b128 a[132:135], v6 offset:5120
v_mfma_f32_16x16x32_bf16 v[152:155], a[100:103], a[12:15], v[152:155]
buffer_load_dwordx4 a[0:3], v4, s[40:43], s35 offen offset:0 sc1
v_mfma_f32_16x16x32_bf16 v[136:139], a[100:103], a[8:11], v[136:139]
ds_read_b128 a[136:139], v6 offset:6144
v_mfma_f32_16x16x32_bf16 v[140:143], a[104:107], a[8:11], v[140:143]
ds_read_b128 a[140:143], v6 offset:7168
v_mfma_f32_16x16x32_bf16 v[156:159], a[104:107], a[12:15], v[156:159]
v_mfma_f32_16x16x32_bf16 v[160:163], a[108:111], a[12:15], v[160:163]
buffer_load_dwordx4 a[4:7], v4, s[40:43], s35 offen offset:1024 sc1
s_add_u32 s35, s9, 573440
v_mfma_f32_16x16x32_bf16 v[144:147], a[108:111], a[8:11], v[144:147]
s_waitcnt vmcnt(10) lgkmcnt(4)
v_mfma_f32_16x16x32_bf16 v[132:135], a[112:115], a[16:19], v[132:135]
ds_read_b128 a[96:99], v6 offset:8192
v_mfma_f32_16x16x32_bf16 v[148:151], a[112:115], a[20:23], v[148:151]
ds_read_b128 a[100:103], v6 offset:9216
v_mfma_f32_16x16x32_bf16 v[152:155], a[116:119], a[20:23], v[152:155]
buffer_load_dwordx4 a[8:11], v4, s[40:43], s35 offen offset:0 sc1
v_mfma_f32_16x16x32_bf16 v[136:139], a[116:119], a[16:19], v[136:139]
ds_read_b128 a[104:107], v6 offset:10240
v_mfma_f32_16x16x32_bf16 v[140:143], a[120:123], a[16:19], v[140:143]
ds_read_b128 a[108:111], v6 offset:11264
v_mfma_f32_16x16x32_bf16 v[156:159], a[120:123], a[20:23], v[156:159]
v_mfma_f32_16x16x32_bf16 v[160:163], a[124:127], a[20:23], v[160:163]
buffer_load_dwordx4 a[12:15], v4, s[40:43], s35 offen offset:1024 sc1
s_add_u32 s35, s9, 577536
v_mfma_f32_16x16x32_bf16 v[144:147], a[124:127], a[16:19], v[144:147]
s_waitcnt vmcnt(10) lgkmcnt(4)
v_mfma_f32_16x16x32_bf16 v[132:135], a[128:131], a[24:27], v[132:135]
ds_read_b128 a[112:115], v6 offset:12288
v_mfma_f32_16x16x32_bf16 v[148:151], a[128:131], a[28:31], v[148:151]
ds_read_b128 a[116:119], v6 offset:13312
v_mfma_f32_16x16x32_bf16 v[152:155], a[132:135], a[28:31], v[152:155]
buffer_load_dwordx4 a[16:19], v4, s[40:43], s35 offen offset:0 sc1
v_mfma_f32_16x16x32_bf16 v[136:139], a[132:135], a[24:27], v[136:139]
ds_read_b128 a[120:123], v6 offset:14336
v_mfma_f32_16x16x32_bf16 v[140:143], a[136:139], a[24:27], v[140:143]
ds_read_b128 a[124:127], v6 offset:15360
v_mfma_f32_16x16x32_bf16 v[156:159], a[136:139], a[28:31], v[156:159]
v_mfma_f32_16x16x32_bf16 v[160:163], a[140:143], a[28:31], v[160:163]
buffer_load_dwordx4 a[20:23], v4, s[40:43], s35 offen offset:1024 sc1
s_add_u32 s35, s9, 589824
v_mfma_f32_16x16x32_bf16 v[144:147], a[140:143], a[24:27], v[144:147]
s_waitcnt vmcnt(10) lgkmcnt(4)
v_mfma_f32_16x16x32_bf16 v[132:135], a[96:99], a[32:35], v[132:135]
ds_read_b128 a[128:131], v6 offset:16384
v_mfma_f32_16x16x32_bf16 v[148:151], a[96:99], a[36:39], v[148:151]
ds_read_b128 a[132:135], v6 offset:17408
v_mfma_f32_16x16x32_bf16 v[152:155], a[100:103], a[36:39], v[152:155]
buffer_load_dwordx4 a[24:27], v4, s[40:43], s35 offen offset:0 sc1
v_mfma_f32_16x16x32_bf16 v[136:139], a[100:103], a[32:35], v[136:139]
ds_read_b128 a[136:139], v6 offset:18432
v_mfma_f32_16x16x32_bf16 v[140:143], a[104:107], a[32:35], v[140:143]
ds_read_b128 a[140:143], v6 offset:19456
v_mfma_f32_16x16x32_bf16 v[156:159], a[104:107], a[36:39], v[156:159]
v_mfma_f32_16x16x32_bf16 v[160:163], a[108:111], a[36:39], v[160:163]
buffer_load_dwordx4 a[28:31], v4, s[40:43], s35 offen offset:1024 sc1
s_add_u32 s35, s9, 593920
v_mfma_f32_16x16x32_bf16 v[144:147], a[108:111], a[32:35], v[144:147]
s_waitcnt vmcnt(10) lgkmcnt(4)
v_mfma_f32_16x16x32_bf16 v[132:135], a[112:115], a[40:43], v[132:135]
ds_read_b128 a[96:99], v6 offset:20480
v_mfma_f32_16x16x32_bf16 v[148:151], a[112:115], a[44:47], v[148:151]
ds_read_b128 a[100:103], v6 offset:21504
v_mfma_f32_16x16x32_bf16 v[152:155], a[116:119], a[44:47], v[152:155]
buffer_load_dwordx4 a[32:35], v4, s[40:43], s35 offen offset:0 sc1
v_mfma_f32_16x16x32_bf16 v[136:139], a[116:119], a[40:43], v[136:139]
ds_read_b128 a[104:107], v6 offset:22528
v_mfma_f32_16x16x32_bf16 v[140:143], a[120:123], a[40:43], v[140:143]
ds_read_b128 a[108:111], v6 offset:23552
v_mfma_f32_16x16x32_bf16 v[156:159], a[120:123], a[44:47], v[156:159]
v_mfma_f32_16x16x32_bf16 v[160:163], a[124:127], a[44:47], v[160:163]
buffer_load_dwordx4 a[36:39], v4, s[40:43], s35 offen offset:1024 sc1
s_add_u32 s35, s9, 606208
v_mfma_f32_16x16x32_bf16 v[144:147], a[124:127], a[40:43], v[144:147]
s_waitcnt vmcnt(10) lgkmcnt(4)
v_mfma_f32_16x16x32_bf16 v[132:135], a[128:131], a[48:51], v[132:135]
ds_read_b128 a[112:115], v6 offset:24576
v_mfma_f32_16x16x32_bf16 v[148:151], a[128:131], a[52:55], v[148:151]
ds_read_b128 a[116:119], v6 offset:25600
v_mfma_f32_16x16x32_bf16 v[152:155], a[132:135], a[52:55], v[152:155]
buffer_load_dwordx4 a[40:43], v4, s[40:43], s35 offen offset:0 sc1
v_mfma_f32_16x16x32_bf16 v[136:139], a[132:135], a[48:51], v[136:139]
ds_read_b128 a[120:123], v6 offset:26624
v_mfma_f32_16x16x32_bf16 v[140:143], a[136:139], a[48:51], v[140:143]
ds_read_b128 a[124:127], v6 offset:27648
v_mfma_f32_16x16x32_bf16 v[156:159], a[136:139], a[52:55], v[156:159]
v_mfma_f32_16x16x32_bf16 v[160:163], a[140:143], a[52:55], v[160:163]
buffer_load_dwordx4 a[44:47], v4, s[40:43], s35 offen offset:1024 sc1
s_add_u32 s35, s9, 610304
v_mfma_f32_16x16x32_bf16 v[144:147], a[140:143], a[48:51], v[144:147]
s_waitcnt vmcnt(10) lgkmcnt(4)
v_mfma_f32_16x16x32_bf16 v[132:135], a[96:99], a[0:3], v[132:135]
ds_read_b128 a[128:131], v6 offset:28672
v_mfma_f32_16x16x32_bf16 v[148:151], a[96:99], a[4:7], v[148:151]
ds_read_b128 a[132:135], v6 offset:29696
v_mfma_f32_16x16x32_bf16 v[152:155], a[100:103], a[4:7], v[152:155]
buffer_load_dwordx4 a[48:51], v4, s[40:43], s35 offen offset:0 sc1
v_mfma_f32_16x16x32_bf16 v[136:139], a[100:103], a[0:3], v[136:139]
ds_read_b128 a[136:139], v6 offset:30720
v_mfma_f32_16x16x32_bf16 v[140:143], a[104:107], a[0:3], v[140:143]
ds_read_b128 a[140:143], v6 offset:31744
v_mfma_f32_16x16x32_bf16 v[156:159], a[104:107], a[4:7], v[156:159]
v_mfma_f32_16x16x32_bf16 v[160:163], a[108:111], a[4:7], v[160:163]
buffer_load_dwordx4 a[52:55], v4, s[40:43], s35 offen offset:1024 sc1
s_add_u32 s35, s9, 622592
v_mfma_f32_16x16x32_bf16 v[144:147], a[108:111], a[0:3], v[144:147]
s_waitcnt vmcnt(10) lgkmcnt(4)
v_mfma_f32_16x16x32_bf16 v[132:135], a[112:115], a[8:11], v[132:135]
ds_read_b128 a[96:99], v6 offset:32768
v_mfma_f32_16x16x32_bf16 v[148:151], a[112:115], a[12:15], v[148:151]
ds_read_b128 a[100:103], v6 offset:33792
v_mfma_f32_16x16x32_bf16 v[152:155], a[116:119], a[12:15], v[152:155]
buffer_load_dwordx4 a[0:3], v4, s[40:43], s35 offen offset:0 sc1
v_mfma_f32_16x16x32_bf16 v[136:139], a[116:119], a[8:11], v[136:139]
ds_read_b128 a[104:107], v6 offset:34816
v_mfma_f32_16x16x32_bf16 v[140:143], a[120:123], a[8:11], v[140:143]
ds_read_b128 a[108:111], v6 offset:35840
v_mfma_f32_16x16x32_bf16 v[156:159], a[120:123], a[12:15], v[156:159]
v_mfma_f32_16x16x32_bf16 v[160:163], a[124:127], a[12:15], v[160:163]
buffer_load_dwordx4 a[4:7], v4, s[40:43], s35 offen offset:1024 sc1
s_add_u32 s35, s9, 626688
v_mfma_f32_16x16x32_bf16 v[144:147], a[124:127], a[8:11], v[144:147]
s_waitcnt vmcnt(10) lgkmcnt(4)
v_mfma_f32_16x16x32_bf16 v[132:135], a[128:131], a[16:19], v[132:135]
ds_read_b128 a[112:115], v6 offset:36864
v_mfma_f32_16x16x32_bf16 v[148:151], a[128:131], a[20:23], v[148:151]
ds_read_b128 a[116:119], v6 offset:37888
v_mfma_f32_16x16x32_bf16 v[152:155], a[132:135], a[20:23], v[152:155]
buffer_load_dwordx4 a[8:11], v4, s[40:43], s35 offen offset:0 sc1
v_mfma_f32_16x16x32_bf16 v[136:139], a[132:135], a[16:19], v[136:139]
ds_read_b128 a[120:123], v6 offset:38912
v_mfma_f32_16x16x32_bf16 v[140:143], a[136:139], a[16:19], v[140:143]
ds_read_b128 a[124:127], v6 offset:39936
v_mfma_f32_16x16x32_bf16 v[156:159], a[136:139], a[20:23], v[156:159]
v_mfma_f32_16x16x32_bf16 v[160:163], a[140:143], a[20:23], v[160:163]
buffer_load_dwordx4 a[12:15], v4, s[40:43], s35 offen offset:1024 sc1
s_add_u32 s35, s9, 638976
v_mfma_f32_16x16x32_bf16 v[144:147], a[140:143], a[16:19], v[144:147]
s_waitcnt vmcnt(10) lgkmcnt(4)
v_mfma_f32_16x16x32_bf16 v[132:135], a[96:99], a[24:27], v[132:135]
ds_read_b128 a[128:131], v6 offset:40960
v_mfma_f32_16x16x32_bf16 v[148:151], a[96:99], a[28:31], v[148:151]
ds_read_b128 a[132:135], v6 offset:41984
v_mfma_f32_16x16x32_bf16 v[152:155], a[100:103], a[28:31], v[152:155]
buffer_load_dwordx4 a[16:19], v4, s[40:43], s35 offen offset:0 sc1
v_mfma_f32_16x16x32_bf16 v[136:139], a[100:103], a[24:27], v[136:139]
ds_read_b128 a[136:139], v6 offset:43008
v_mfma_f32_16x16x32_bf16 v[140:143], a[104:107], a[24:27], v[140:143]
ds_read_b128 a[140:143], v6 offset:44032
v_mfma_f32_16x16x32_bf16 v[156:159], a[104:107], a[28:31], v[156:159]
v_mfma_f32_16x16x32_bf16 v[160:163], a[108:111], a[28:31], v[160:163]
buffer_load_dwordx4 a[20:23], v4, s[40:43], s35 offen offset:1024 sc1
s_add_u32 s35, s9, 643072
v_mfma_f32_16x16x32_bf16 v[144:147], a[108:111], a[24:27], v[144:147]
s_waitcnt vmcnt(10) lgkmcnt(4)
v_mfma_f32_16x16x32_bf16 v[132:135], a[112:115], a[32:35], v[132:135]
ds_read_b128 a[96:99], v6 offset:45056
v_mfma_f32_16x16x32_bf16 v[148:151], a[112:115], a[36:39], v[148:151]
ds_read_b128 a[100:103], v6 offset:46080
v_mfma_f32_16x16x32_bf16 v[152:155], a[116:119], a[36:39], v[152:155]
buffer_load_dwordx4 a[24:27], v4, s[40:43], s35 offen offset:0 sc1
v_mfma_f32_16x16x32_bf16 v[136:139], a[116:119], a[32:35], v[136:139]
ds_read_b128 a[104:107], v6 offset:47104
v_mfma_f32_16x16x32_bf16 v[140:143], a[120:123], a[32:35], v[140:143]
ds_read_b128 a[108:111], v6 offset:48128
v_mfma_f32_16x16x32_bf16 v[156:159], a[120:123], a[36:39], v[156:159]
v_mfma_f32_16x16x32_bf16 v[160:163], a[124:127], a[36:39], v[160:163]
buffer_load_dwordx4 a[28:31], v4, s[40:43], s35 offen offset:1024 sc1
s_add_u32 s35, s9, 1048576
v_mfma_f32_16x16x32_bf16 v[144:147], a[124:127], a[32:35], v[144:147]
s_waitcnt vmcnt(10) lgkmcnt(4)
v_mfma_f32_16x16x32_bf16 v[132:135], a[128:131], a[40:43], v[132:135]
ds_read_b128 a[112:115], v6 offset:49152
v_mfma_f32_16x16x32_bf16 v[148:151], a[128:131], a[44:47], v[148:151]
ds_read_b128 a[116:119], v6 offset:50176
v_mfma_f32_16x16x32_bf16 v[152:155], a[132:135], a[44:47], v[152:155]
ds_read_b128 a[120:123], v6 offset:51200
v_mfma_f32_16x16x32_bf16 v[136:139], a[132:135], a[40:43], v[136:139]
ds_read_b128 a[124:127], v6 offset:52224
v_mfma_f32_16x16x32_bf16 v[140:143], a[136:139], a[40:43], v[140:143]
v_mfma_f32_16x16x32_bf16 v[156:159], a[136:139], a[44:47], v[156:159]
v_mfma_f32_16x16x32_bf16 v[160:163], a[140:143], a[44:47], v[160:163]
v_mfma_f32_16x16x32_bf16 v[144:147], a[140:143], a[40:43], v[144:147]
s_waitcnt vmcnt(8) lgkmcnt(4)
v_mfma_f32_16x16x32_bf16 v[132:135], a[96:99], a[48:51], v[132:135]
ds_read_b128 a[128:131], v6 offset:53248
v_mfma_f32_16x16x32_bf16 v[148:151], a[96:99], a[52:55], v[148:151]
ds_read_b128 a[132:135], v6 offset:54272
v_mfma_f32_16x16x32_bf16 v[152:155], a[100:103], a[52:55], v[152:155]
ds_read_b128 a[136:139], v6 offset:55296
v_mfma_f32_16x16x32_bf16 v[136:139], a[100:103], a[48:51], v[136:139]
ds_read_b128 a[140:143], v6 offset:56320
v_mfma_f32_16x16x32_bf16 v[140:143], a[104:107], a[48:51], v[140:143]
v_mfma_f32_16x16x32_bf16 v[156:159], a[104:107], a[52:55], v[156:159]
v_mfma_f32_16x16x32_bf16 v[160:163], a[108:111], a[52:55], v[160:163]
v_mfma_f32_16x16x32_bf16 v[144:147], a[108:111], a[48:51], v[144:147]
s_waitcnt vmcnt(6) lgkmcnt(4)
v_mfma_f32_16x16x32_bf16 v[132:135], a[112:115], a[0:3], v[132:135]
ds_read_b128 a[96:99], v6 offset:57344
v_mfma_f32_16x16x32_bf16 v[148:151], a[112:115], a[4:7], v[148:151]
ds_read_b128 a[100:103], v6 offset:58368
v_mfma_f32_16x16x32_bf16 v[152:155], a[116:119], a[4:7], v[152:155]
ds_read_b128 a[104:107], v6 offset:59392
v_mfma_f32_16x16x32_bf16 v[136:139], a[116:119], a[0:3], v[136:139]
ds_read_b128 a[108:111], v6 offset:60416
v_mfma_f32_16x16x32_bf16 v[140:143], a[120:123], a[0:3], v[140:143]
v_mfma_f32_16x16x32_bf16 v[156:159], a[120:123], a[4:7], v[156:159]
v_mfma_f32_16x16x32_bf16 v[160:163], a[124:127], a[4:7], v[160:163]
v_mfma_f32_16x16x32_bf16 v[144:147], a[124:127], a[0:3], v[144:147]
s_waitcnt vmcnt(4) lgkmcnt(4)
v_mfma_f32_16x16x32_bf16 v[132:135], a[128:131], a[8:11], v[132:135]
ds_read_b128 a[112:115], v6 offset:61440
v_mfma_f32_16x16x32_bf16 v[148:151], a[128:131], a[12:15], v[148:151]
ds_read_b128 a[116:119], v6 offset:62464
v_mfma_f32_16x16x32_bf16 v[152:155], a[132:135], a[12:15], v[152:155]
ds_read_b128 a[120:123], v6 offset:63488
v_mfma_f32_16x16x32_bf16 v[136:139], a[132:135], a[8:11], v[136:139]
ds_read_b128 a[124:127], v6 offset:64512
v_mfma_f32_16x16x32_bf16 v[140:143], a[136:139], a[8:11], v[140:143]
v_mfma_f32_16x16x32_bf16 v[156:159], a[136:139], a[12:15], v[156:159]
v_mfma_f32_16x16x32_bf16 v[160:163], a[140:143], a[12:15], v[160:163]
v_mfma_f32_16x16x32_bf16 v[144:147], a[140:143], a[8:11], v[144:147]
s_waitcnt vmcnt(2) lgkmcnt(4)
v_mfma_f32_16x16x32_bf16 v[132:135], a[96:99], a[16:19], v[132:135]
v_mfma_f32_16x16x32_bf16 v[148:151], a[96:99], a[20:23], v[148:151]
v_mfma_f32_16x16x32_bf16 v[152:155], a[100:103], a[20:23], v[152:155]
v_mfma_f32_16x16x32_bf16 v[136:139], a[100:103], a[16:19], v[136:139]
v_mfma_f32_16x16x32_bf16 v[140:143], a[104:107], a[16:19], v[140:143]
v_mfma_f32_16x16x32_bf16 v[156:159], a[104:107], a[20:23], v[156:159]
v_mfma_f32_16x16x32_bf16 v[160:163], a[108:111], a[20:23], v[160:163]
v_mfma_f32_16x16x32_bf16 v[144:147], a[108:111], a[16:19], v[144:147]
s_waitcnt vmcnt(0) lgkmcnt(0)
v_mfma_f32_16x16x32_bf16 v[132:135], a[112:115], a[24:27], v[132:135]
v_mfma_f32_16x16x32_bf16 v[148:151], a[112:115], a[28:31], v[148:151]
v_mfma_f32_16x16x32_bf16 v[152:155], a[116:119], a[28:31], v[152:155]
v_mfma_f32_16x16x32_bf16 v[136:139], a[116:119], a[24:27], v[136:139]
v_mfma_f32_16x16x32_bf16 v[140:143], a[120:123], a[24:27], v[140:143]
v_mfma_f32_16x16x32_bf16 v[156:159], a[120:123], a[28:31], v[156:159]
v_mfma_f32_16x16x32_bf16 v[160:163], a[124:127], a[28:31], v[160:163]
v_mfma_f32_16x16x32_bf16 v[144:147], a[124:127], a[24:27], v[144:147]
s_nop 1
v_cmp_u_f32 vcc, v132, v148
s_nop 0
s_and_b32 vcc_lo, vcc_lo, s95
s_cbranch_scc1 L_k2redo3
s_and_b32 s36, s31, 7
s_lshl_b32 s36, s36, 7
s_lshl_b32 s37, s28, 5
s_add_u32 s36, s36, s37
s_lshl_b32 s36, s36, 1
s_lshr_b32 s37, s31, 3
s_add_u32 s36, s36, s37
s_lshl_b32 s36, s36, 11
s_lshl_b32 s37, s32, 7
v_and_b32 v234, 15, v0
s_add_u32 s36, s36, s37
v_lshrrev_b32 v233, 4, v0
v_lshl_add_u32 v232, v234, 12, s36
v_cvt_pk_bf16_f32 v32, v132, v133
v_cvt_pk_bf16_f32 v33, v134, v135
v_cvt_pk_bf16_f32 v34, v136, v137
v_cvt_pk_bf16_f32 v35, v138, v139
v_lshl_add_u32 v232, v233, 4, v232
buffer_store_dwordx4 v[32:35], v232, s[12:15], 0 offen offset:0
v_cvt_pk_bf16_f32 v36, v140, v141
v_cvt_pk_bf16_f32 v37, v142, v143
v_cvt_pk_bf16_f32 v38, v144, v145
v_cvt_pk_bf16_f32 v39, v146, v147
v_cvt_pk_bf16_f32 v40, v148, v149
v_cvt_pk_bf16_f32 v41, v150, v151
v_cvt_pk_bf16_f32 v42, v152, v153
v_cvt_pk_bf16_f32 v43, v154, v155
s_mov_b32 s36, 0x10000
v_cvt_pk_bf16_f32 v44, v156, v157
v_cvt_pk_bf16_f32 v45, v158, v159
v_cvt_pk_bf16_f32 v46, v160, v161
buffer_store_dwordx4 v[36:39], v232, s[12:15], 0 offen offset:64
v_cvt_pk_bf16_f32 v47, v162, v163
buffer_store_dwordx4 v[40:43], v232, s[12:15], s36 offen offset:0
buffer_store_dwordx4 v[44:47], v232, s[12:15], s36 offen offset:64
s_or_b32 s36, s2, s28
s_cbranch_scc1 Lep_50
s_mov_b32 s36, 0xf0000
buffer_store_dword v15, off, s[4:7], s36 sc1
Lep_50:
L_end:
s_endpgm
Ltal_5:
s_mov_b32 s53, 0
Ltal_5b:
s_sleep 8
buffer_load_dword v11, v1, s[24:27], 0 offen sc1
s_add_u32 s53, s53, 1
s_waitcnt vmcnt(0)
v_cmp_gt_u32 vcc, 0x100000, v11
s_nop 0
s_and_b32 vcc_lo, vcc_lo, 0x1f3f
s_cbranch_scc0 Ltab_6
s_cmp_lt_u32 s53, 0x100000
s_cbranch_scc1 Ltal_5b
s_branch Ltab_6
L_hxredo0:
s_mov_b32 s37, 0
L_hxredo0b:
s_sleep 2
buffer_load_dwordx4 v[228:231], v9, s[4:7], s55 offen sc1
buffer_load_dwordx4 v[72:75], v9, s[4:7], s55 offen offset:1024 sc1
s_waitcnt vmcnt(1)
v_max3_u32 v244, v228, v229, v230
s_waitcnt vmcnt(0)
v_max3_u32 v244, v244, v231, v72
v_max3_u32 v244, v244, v73, v74
v_max_u32 v244, v244, v75
v_cmp_eq_u32 vcc, -1, v244
s_cbranch_vccz L_hxback0
s_add_u32 s37, s37, 1
s_cmp_lt_u32 s37, 0x100000
s_cbranch_scc1 L_hxredo0b
s_branch L_hxback0
Ltr_12:
s_add_u32 s52, s67, 0xe0000
s_mov_b32 s53, 0
Ltp_13:
s_sleep 2
v_mov_b32 v11, v15
s_mov_b64 exec, 0xffff
v_mov_b32 v11, 0
buffer_atomic_add v11, v255, s[4:7], s52 offen sc0 sc1
s_mov_b64 exec, -1
s_add_u32 s53, s53, 1
s_waitcnt vmcnt(0)
v_cmp_ne_u32 vcc, v11, v15
s_cbranch_vccz Lte_14
s_cmp_lt_u32 s53, 0x100000
s_cbranch_scc1 Ltp_13
s_branch Lte_14
Ltr_15:
s_add_u32 s52, s66, 0xd0040
s_mov_b32 s53, 0
Ltp_16:
s_sleep 2
v_mov_b32 v232, v15
s_mov_b64 exec, 0xffff
v_mov_b32 v232, 0
buffer_atomic_add v232, v255, s[4:7], s52 offen sc0 sc1
s_mov_b64 exec, -1
s_add_u32 s53, s53, 1
s_waitcnt vmcnt(0)
v_cmp_ne_u32 vcc, v232, v15
s_cbranch_vccz Lte_17
s_cmp_lt_u32 s53, 0x100000
s_cbranch_scc1 Ltp_16
s_branch Lte_17
L_kvredo1:
s_mov_b32 s88, 0
L_kvredo1b:
v_max_u32 v132, v48, v49
v_max3_u32 v132, v132, v50, v51
v_max3_u32 v132, v132, v52, v53
v_max3_u32 v132, v132, v54, v55
v_max3_u32 v132, v132, v56, v57
v_max3_u32 v132, v132, v58, v59
v_max3_u32 v132, v132, v60, v61
v_max3_u32 v132, v132, v62, v63
v_max3_u32 v132, v132, v64, v65
v_max3_u32 v132, v132, v66, v67
v_max3_u32 v132, v132, v68, v69
v_max3_u32 v132, v132, v70, v71
v_max3_u32 v132, v132, v100, v101
v_max3_u32 v132, v132, v102, v103
v_max3_u32 v132, v132, v104, v105
v_max3_u32 v132, v132, v106, v107
v_max3_u32 v132, v132, v124, v125
v_max3_u32 v132, v132, v126, v127
v_cmp_eq_u32 vcc, -1, v132
s_cbranch_vccz L_kvback1
s_add_u32 s88, s88, 1
s_cmp_gt_u32 s88, 0x80000
s_cbranch_scc1 L_kvback1
s_sleep 4
buffer_load_dwordx4 v[48:51], v1, s[4:7], s98 offen offset:0 sc1
buffer_load_dwordx4 v[124:127], v248, s[4:7], s100 offen sc1
buffer_load_dwordx4 v[52:55], v1, s[4:7], s98 offen offset:1024 sc1
buffer_load_dwordx4 v[56:59], v1, s[4:7], s98 offen offset:2048 sc1
buffer_load_dwordx4 v[60:63], v1, s[4:7], s98 offen offset:3072 sc1
buffer_load_dwordx4 v[64:67], v1, s[4:7], s99 offen offset:0 sc1
buffer_load_dwordx4 v[68:71], v1, s[4:7], s99 offen offset:1024 sc1
buffer_load_dwordx4 v[100:103], v1, s[4:7], s99 offen offset:2048 sc1
buffer_load_dwordx4 v[104:107], v1, s[4:7], s99 offen offset:3072 sc1
s_waitcnt vmcnt(8)
v_lshlrev_b32 v92, 16, v48
v_and_b32 v93, 0xffff0000, v48
v_lshlrev_b32 v94, 16, v49
v_and_b32 v95, 0xffff0000, v49
v_lshlrev_b32 v96, 16, v50
v_and_b32 v97, 0xffff0000, v50
v_lshlrev_b32 v98, 16, v51
v_and_b32 v99, 0xffff0000, v51
s_waitcnt vmcnt(7)
v_add_f32_dpp v128, v124, v124 row_ror:4 row_mask:0xf bank_mask:0xf
v_add_f32_dpp v129, v125, v125 row_ror:4 row_mask:0xf bank_mask:0xf
v_add_f32_dpp v130, v126, v126 row_ror:4 row_mask:0xf bank_mask:0xf
v_add_f32_dpp v131, v127, v127 row_ror:4 row_mask:0xf bank_mask:0xf
v_add_f32_dpp v128, v128, v128 row_ror:2 row_mask:0xf bank_mask:0xf
v_add_f32_dpp v129, v129, v129 row_ror:2 row_mask:0xf bank_mask:0xf
v_add_f32_dpp v130, v130, v130 row_ror:2 row_mask:0xf bank_mask:0xf
v_add_f32_dpp v131, v131, v131 row_ror:2 row_mask:0xf bank_mask:0xf
v_add_f32_dpp v128, v128, v128 row_ror:1 row_mask:0xf bank_mask:0xf
v_add_f32_dpp v129, v129, v129 row_ror:1 row_mask:0xf bank_mask:0xf
v_add_f32_dpp v130, v130, v130 row_ror:1 row_mask:0xf bank_mask:0xf
v_add_f32_dpp v131, v131, v131 row_ror:1 row_mask:0xf bank_mask:0xf
s_waitcnt vmcnt(6)
v_dot2c_f32_bf16 v92, v52, v249
v_dot2c_f32_bf16 v93, v52, v250
v_dot2c_f32_bf16 v94, v53, v249
v_dot2c_f32_bf16 v95, v53, v250
v_dot2c_f32_bf16 v96, v54, v249
v_dot2c_f32_bf16 v97, v54, v250
v_dot2c_f32_bf16 v98, v55, v249
v_dot2c_f32_bf16 v99, v55, v250
s_waitcnt vmcnt(5)
v_dot2c_f32_bf16 v92, v56, v249
v_dot2c_f32_bf16 v93, v56, v250
v_dot2c_f32_bf16 v94, v57, v249
v_dot2c_f32_bf16 v95, v57, v250
v_dot2c_f32_bf16 v96, v58, v249
v_dot2c_f32_bf16 v97, v58, v250
v_dot2c_f32_bf16 v98, v59, v249
v_dot2c_f32_bf16 v99, v59, v250
s_waitcnt vmcnt(4)
v_dot2c_f32_bf16 v92, v60, v249
v_dot2c_f32_bf16 v93, v60, v250
v_dot2c_f32_bf16 v94, v61, v249
v_dot2c_f32_bf16 v95, v61, v250
v_dot2c_f32_bf16 v96, v62, v249
v_dot2c_f32_bf16 v97, v62, v250
v_dot2c_f32_bf16 v98, v63, v249
v_dot2c_f32_bf16 v99, v63, v250
s_waitcnt vmcnt(3)
v_dot2c_f32_bf16 v92, v64, v249
v_dot2c_f32_bf16 v93, v64, v250
v_dot2c_f32_bf16 v94, v65, v249
v_dot2c_f32_bf16 v95, v65, v250
v_dot2c_f32_bf16 v96, v66, v249
v_dot2c_f32_bf16 v97, v66, v250
v_dot2c_f32_bf16 v98, v67, v249
v_dot2c_f32_bf16 v99, v67, v250
s_waitcnt vmcnt(2)
v_dot2c_f32_bf16 v92, v68, v249
v_dot2c_f32_bf16 v93, v68, v250
v_dot2c_f32_bf16 v94, v69, v249
v_dot2c_f32_bf16 v95, v69, v250
v_dot2c_f32_bf16 v96, v70, v249
v_dot2c_f32_bf16 v97, v70, v250
v_dot2c_f32_bf16 v98, v71, v249
v_dot2c_f32_bf16 v99, v71, v250
s_waitcnt vmcnt(1)
v_dot2c_f32_bf16 v92, v100, v249
v_dot2c_f32_bf16 v93, v100, v250
v_dot2c_f32_bf16 v94, v101, v249
v_dot2c_f32_bf16 v95, v101, v250
v_dot2c_f32_bf16 v96, v102, v249
v_dot2c_f32_bf16 v97, v102, v250
v_dot2c_f32_bf16 v98, v103, v249
v_dot2c_f32_bf16 v99, v103, v250
s_waitcnt vmcnt(0)
v_dot2c_f32_bf16 v92, v104, v249
v_dot2c_f32_bf16 v93, v104, v250
v_dot2c_f32_bf16 v94, v105, v249
v_dot2c_f32_bf16 v95, v105, v250
v_dot2c_f32_bf16 v96, v106, v249
v_dot2c_f32_bf16 v97, v106, v250
v_dot2c_f32_bf16 v98, v107, v249
v_dot2c_f32_bf16 v99, v107, v250
s_nop 2
s_branch L_kvredo1b
L_k2redo1:
s_mov_b32 s95, 0
s_mov_b32 s92, 0x40000000
s_mov_b32 s93, 0x40000000
s_mov_b32 s94, 0x40000000
s_mov_b32 s37, 0
L_k2redo1a:
s_sleep 4
v_mov_b32 v108, 0
s_mov_b32 s36, 0
L_k2redo1b:
s_lshr_b32 s39, s36, 3
s_mul_i32 s39, s39, 524288
s_and_b32 s38, s36, 7
s_lshl_b32 s38, s38, 14
s_add_u32 s38, s38, s39
s_add_u32 s38, s38, s9
s_add_u32 s39, s38, 4096
buffer_load_dwordx4 v[92:95], v4, s[40:43], s38 offen offset:0 sc1
buffer_load_dwordx4 v[96:99], v4, s[40:43], s38 offen offset:1024 sc1
buffer_load_dwordx4 v[100:103], v4, s[40:43], s39 offen offset:0 sc1
buffer_load_dwordx4 v[104:107], v4, s[40:43], s39 offen offset:1024 sc1
s_waitcnt vmcnt(3)
v_max3_u32 v108, v108, v92, v93
v_max3_u32 v108, v108, v94, v95
s_waitcnt vmcnt(2)
v_max3_u32 v108, v108, v96, v97
v_max3_u32 v108, v108, v98, v99
s_waitcnt vmcnt(1)
v_max3_u32 v108, v108, v100, v101
v_max3_u32 v108, v108, v102, v103
s_waitcnt vmcnt(0)
v_max3_u32 v108, v108, v104, v105
v_max3_u32 v108, v108, v106, v107
s_add_u32 s36, s36, 1
s_cmp_lt_u32 s36, 16
s_cbranch_scc1 L_k2redo1b
v_cmp_eq_u32 vcc, -1, v108
s_cbranch_vccz L_k2redo1c
s_add_u32 s37, s37, 1
s_cmp_lt_u32 s37, 0x8000
s_cbranch_scc1 L_k2redo1a
L_k2redo1c:
s_nop 7
s_mov_b32 s35, s9
v_lshlrev_b32 v132, 16, v32
v_and_b32 v133, 0xffff0000, v32
v_lshlrev_b32 v134, 16, v33
v_and_b32 v135, 0xffff0000, v33
v_lshlrev_b32 v136, 16, v34
v_and_b32 v137, 0xffff0000, v34
v_lshlrev_b32 v138, 16, v35
v_and_b32 v139, 0xffff0000, v35
v_lshlrev_b32 v140, 16, v36
v_and_b32 v141, 0xffff0000, v36
v_lshlrev_b32 v142, 16, v37
v_and_b32 v143, 0xffff0000, v37
v_lshlrev_b32 v144, 16, v38
v_and_b32 v145, 0xffff0000, v38
v_lshlrev_b32 v146, 16, v39
v_and_b32 v147, 0xffff0000, v39
v_lshlrev_b32 v148, 16, v40
v_and_b32 v149, 0xffff0000, v40
v_lshlrev_b32 v150, 16, v41
v_and_b32 v151, 0xffff0000, v41
v_lshlrev_b32 v152, 16, v42
v_and_b32 v153, 0xffff0000, v42
v_lshlrev_b32 v154, 16, v43
v_and_b32 v155, 0xffff0000, v43
v_lshlrev_b32 v156, 16, v44
v_and_b32 v157, 0xffff0000, v44
v_lshlrev_b32 v158, 16, v45
v_and_b32 v159, 0xffff0000, v45
v_lshlrev_b32 v160, 16, v46
v_and_b32 v161, 0xffff0000, v46
v_lshlrev_b32 v162, 16, v47
v_and_b32 v163, 0xffff0000, v47
s_branch L_k2go1
L_hxredo2:
s_mov_b32 s37, 0
L_hxredo2b:
s_sleep 2
buffer_load_dwordx4 v[228:231], v9, s[4:7], s55 offen sc1
buffer_load_dwordx4 v[72:75], v9, s[4:7], s55 offen offset:1024 sc1
s_waitcnt vmcnt(1)
v_max3_u32 v244, v228, v229, v230
s_waitcnt vmcnt(0)
v_max3_u32 v244, v244, v231, v72
v_max3_u32 v244, v244, v73, v74
v_max_u32 v244, v244, v75
v_cmp_eq_u32 vcc, -1, v244
s_cbranch_vccz L_hxback2
s_add_u32 s37, s37, 1
s_cmp_lt_u32 s37, 0x100000
s_cbranch_scc1 L_hxredo2b
s_branch L_hxback2
L_k2redo2:
s_mov_b32 s95, 0
s_mov_b32 s92, 0x40000000
s_mov_b32 s93, 0x40000000
s_mov_b32 s94, 0x40000000
s_mov_b32 s37, 0
L_k2redo2a:
s_sleep 4
v_mov_b32 v108, 0
s_mov_b32 s36, 0
L_k2redo2b:
s_lshr_b32 s39, s36, 3
s_mul_i32 s39, s39, 524288
s_and_b32 s38, s36, 7
s_lshl_b32 s38, s38, 14
s_add_u32 s38, s38, s39
s_add_u32 s38, s38, s77
s_add_u32 s39, s38, 4096
buffer_load_dwordx4 v[92:95], v4, s[40:43], s38 offen offset:0 sc1
buffer_load_dwordx4 v[96:99], v4, s[40:43], s38 offen offset:1024 sc1
buffer_load_dwordx4 v[100:103], v4, s[40:43], s39 offen offset:0 sc1
buffer_load_dwordx4 v[104:107], v4, s[40:43], s39 offen offset:1024 sc1
s_waitcnt vmcnt(3)
v_max3_u32 v108, v108, v92, v93
v_max3_u32 v108, v108, v94, v95
s_waitcnt vmcnt(2)
v_max3_u32 v108, v108, v96, v97
v_max3_u32 v108, v108, v98, v99
s_waitcnt vmcnt(1)
v_max3_u32 v108, v108, v100, v101
v_max3_u32 v108, v108, v102, v103
s_waitcnt vmcnt(0)
v_max3_u32 v108, v108, v104, v105
v_max3_u32 v108, v108, v106, v107
s_add_u32 s36, s36, 1
s_cmp_lt_u32 s36, 16
s_cbranch_scc1 L_k2redo2b
v_cmp_eq_u32 vcc, -1, v108
s_cbranch_vccz L_k2redo2c
s_add_u32 s37, s37, 1
s_cmp_lt_u32 s37, 0x8000
s_cbranch_scc1 L_k2redo2a
L_k2redo2c:
s_nop 7
s_mov_b32 s35, s77
v_lshlrev_b32 v132, 16, v32
v_and_b32 v133, 0xffff0000, v32
v_lshlrev_b32 v134, 16, v33
v_and_b32 v135, 0xffff0000, v33
v_lshlrev_b32 v136, 16, v34
v_and_b32 v137, 0xffff0000, v34
v_lshlrev_b32 v138, 16, v35
v_and_b32 v139, 0xffff0000, v35
v_lshlrev_b32 v140, 16, v36
v_and_b32 v141, 0xffff0000, v36
v_lshlrev_b32 v142, 16, v37
v_and_b32 v143, 0xffff0000, v37
v_lshlrev_b32 v144, 16, v38
v_and_b32 v145, 0xffff0000, v38
v_lshlrev_b32 v146, 16, v39
v_and_b32 v147, 0xffff0000, v39
v_lshlrev_b32 v148, 16, v40
v_and_b32 v149, 0xffff0000, v40
v_lshlrev_b32 v150, 16, v41
v_and_b32 v151, 0xffff0000, v41
v_lshlrev_b32 v152, 16, v42
v_and_b32 v153, 0xffff0000, v42
v_lshlrev_b32 v154, 16, v43
v_and_b32 v155, 0xffff0000, v43
v_lshlrev_b32 v156, 16, v44
v_and_b32 v157, 0xffff0000, v44
v_lshlrev_b32 v158, 16, v45
v_and_b32 v159, 0xffff0000, v45
v_lshlrev_b32 v160, 16, v46
v_and_b32 v161, 0xffff0000, v46
v_lshlrev_b32 v162, 16, v47
v_and_b32 v163, 0xffff0000, v47
s_branch L_k2go2
L_kvredo3:
s_mov_b32 s88, 0
L_kvredo3b:
v_max_u32 v132, v48, v49
v_max3_u32 v132, v132, v50, v51
v_max3_u32 v132, v132, v52, v53
v_max3_u32 v132, v132, v54, v55
v_max3_u32 v132, v132, v56, v57
v_max3_u32 v132, v132, v58, v59
v_max3_u32 v132, v132, v60, v61
v_max3_u32 v132, v132, v62, v63
v_max3_u32 v132, v132, v64, v65
v_max3_u32 v132, v132, v66, v67
v_max3_u32 v132, v132, v68, v69
v_max3_u32 v132, v132, v70, v71
v_max3_u32 v132, v132, v100, v101
v_max3_u32 v132, v132, v102, v103
v_max3_u32 v132, v132, v104, v105
v_max3_u32 v132, v132, v106, v107
v_max3_u32 v132, v132, v124, v125
v_max3_u32 v132, v132, v126, v127
v_cmp_eq_u32 vcc, -1, v132
s_cbranch_vccz L_kvback3
s_add_u32 s88, s88, 1
s_cmp_gt_u32 s88, 0x80000
s_cbranch_scc1 L_kvback3
s_sleep 4
buffer_load_dwordx4 v[48:51], v1, s[4:7], s98 offen offset:0 sc1
buffer_load_dwordx4 v[124:127], v248, s[4:7], s100 offen sc1
buffer_load_dwordx4 v[52:55], v1, s[4:7], s98 offen offset:1024 sc1
buffer_load_dwordx4 v[56:59], v1, s[4:7], s98 offen offset:2048 sc1
buffer_load_dwordx4 v[60:63], v1, s[4:7], s98 offen offset:3072 sc1
buffer_load_dwordx4 v[64:67], v1, s[4:7], s99 offen offset:0 sc1
buffer_load_dwordx4 v[68:71], v1, s[4:7], s99 offen offset:1024 sc1
buffer_load_dwordx4 v[100:103], v1, s[4:7], s99 offen offset:2048 sc1
buffer_load_dwordx4 v[104:107], v1, s[4:7], s99 offen offset:3072 sc1
s_waitcnt vmcnt(8)
v_lshlrev_b32 v92, 16, v48
v_and_b32 v93, 0xffff0000, v48
v_lshlrev_b32 v94, 16, v49
v_and_b32 v95, 0xffff0000, v49
v_lshlrev_b32 v96, 16, v50
v_and_b32 v97, 0xffff0000, v50
v_lshlrev_b32 v98, 16, v51
v_and_b32 v99, 0xffff0000, v51
s_waitcnt vmcnt(7)
v_add_f32_dpp v128, v124, v124 row_ror:4 row_mask:0xf bank_mask:0xf
v_add_f32_dpp v129, v125, v125 row_ror:4 row_mask:0xf bank_mask:0xf
v_add_f32_dpp v130, v126, v126 row_ror:4 row_mask:0xf bank_mask:0xf
v_add_f32_dpp v131, v127, v127 row_ror:4 row_mask:0xf bank_mask:0xf
v_add_f32_dpp v128, v128, v128 row_ror:2 row_mask:0xf bank_mask:0xf
v_add_f32_dpp v129, v129, v129 row_ror:2 row_mask:0xf bank_mask:0xf
v_add_f32_dpp v130, v130, v130 row_ror:2 row_mask:0xf bank_mask:0xf
v_add_f32_dpp v131, v131, v131 row_ror:2 row_mask:0xf bank_mask:0xf
v_add_f32_dpp v128, v128, v128 row_ror:1 row_mask:0xf bank_mask:0xf
v_add_f32_dpp v129, v129, v129 row_ror:1 row_mask:0xf bank_mask:0xf
v_add_f32_dpp v130, v130, v130 row_ror:1 row_mask:0xf bank_mask:0xf
v_add_f32_dpp v131, v131, v131 row_ror:1 row_mask:0xf bank_mask:0xf
s_waitcnt vmcnt(6)
v_dot2c_f32_bf16 v92, v52, v249
v_dot2c_f32_bf16 v93, v52, v250
v_dot2c_f32_bf16 v94, v53, v249
v_dot2c_f32_bf16 v95, v53, v250
v_dot2c_f32_bf16 v96, v54, v249
v_dot2c_f32_bf16 v97, v54, v250
v_dot2c_f32_bf16 v98, v55, v249
v_dot2c_f32_bf16 v99, v55, v250
s_waitcnt vmcnt(5)
v_dot2c_f32_bf16 v92, v56, v249
v_dot2c_f32_bf16 v93, v56, v250
v_dot2c_f32_bf16 v94, v57, v249
v_dot2c_f32_bf16 v95, v57, v250
v_dot2c_f32_bf16 v96, v58, v249
v_dot2c_f32_bf16 v97, v58, v250
v_dot2c_f32_bf16 v98, v59, v249
v_dot2c_f32_bf16 v99, v59, v250
s_waitcnt vmcnt(4)
v_dot2c_f32_bf16 v92, v60, v249
v_dot2c_f32_bf16 v93, v60, v250
v_dot2c_f32_bf16 v94, v61, v249
v_dot2c_f32_bf16 v95, v61, v250
v_dot2c_f32_bf16 v96, v62, v249
v_dot2c_f32_bf16 v97, v62, v250
v_dot2c_f32_bf16 v98, v63, v249
v_dot2c_f32_bf16 v99, v63, v250
s_waitcnt vmcnt(3)
v_dot2c_f32_bf16 v92, v64, v249
v_dot2c_f32_bf16 v93, v64, v250
v_dot2c_f32_bf16 v94, v65, v249
v_dot2c_f32_bf16 v95, v65, v250
v_dot2c_f32_bf16 v96, v66, v249
v_dot2c_f32_bf16 v97, v66, v250
v_dot2c_f32_bf16 v98, v67, v249
v_dot2c_f32_bf16 v99, v67, v250
s_waitcnt vmcnt(2)
v_dot2c_f32_bf16 v92, v68, v249
v_dot2c_f32_bf16 v93, v68, v250
v_dot2c_f32_bf16 v94, v69, v249
v_dot2c_f32_bf16 v95, v69, v250
v_dot2c_f32_bf16 v96, v70, v249
v_dot2c_f32_bf16 v97, v70, v250
v_dot2c_f32_bf16 v98, v71, v249
v_dot2c_f32_bf16 v99, v71, v250
s_waitcnt vmcnt(1)
v_dot2c_f32_bf16 v92, v100, v249
v_dot2c_f32_bf16 v93, v100, v250
v_dot2c_f32_bf16 v94, v101, v249
v_dot2c_f32_bf16 v95, v101, v250
v_dot2c_f32_bf16 v96, v102, v249
v_dot2c_f32_bf16 v97, v102, v250
v_dot2c_f32_bf16 v98, v103, v249
v_dot2c_f32_bf16 v99, v103, v250
s_waitcnt vmcnt(0)
v_dot2c_f32_bf16 v92, v104, v249
v_dot2c_f32_bf16 v93, v104, v250
v_dot2c_f32_bf16 v94, v105, v249
v_dot2c_f32_bf16 v95, v105, v250
v_dot2c_f32_bf16 v96, v106, v249
v_dot2c_f32_bf16 v97, v106, v250
v_dot2c_f32_bf16 v98, v107, v249
v_dot2c_f32_bf16 v99, v107, v250
s_nop 2
s_branch L_kvredo3b
L_k2redo3:
s_mov_b32 s95, 0
s_mov_b32 s92, 0x40000000
s_mov_b32 s93, 0x40000000
s_mov_b32 s94, 0x40000000
s_mov_b32 s37, 0
L_k2redo3a:
s_sleep 4
v_mov_b32 v108, 0
s_mov_b32 s36, 0
L_k2redo3b:
s_lshr_b32 s39, s36, 3
s_mul_i32 s39, s39, 524288
s_and_b32 s38, s36, 7
s_lshl_b32 s38, s38, 14
s_add_u32 s38, s38, s39
s_add_u32 s38, s38, s9
s_add_u32 s39, s38, 4096
buffer_load_dwordx4 v[92:95], v4, s[40:43], s38 offen offset:0 sc1
buffer_load_dwordx4 v[96:99], v4, s[40:43], s38 offen offset:1024 sc1
buffer_load_dwordx4 v[100:103], v4, s[40:43], s39 offen offset:0 sc1
buffer_load_dwordx4 v[104:107], v4, s[40:43], s39 offen offset:1024 sc1
s_waitcnt vmcnt(3)
v_max3_u32 v108, v108, v92, v93
v_max3_u32 v108, v108, v94, v95
s_waitcnt vmcnt(2)
v_max3_u32 v108, v108, v96, v97
v_max3_u32 v108, v108, v98, v99
s_waitcnt vmcnt(1)
v_max3_u32 v108, v108, v100, v101
v_max3_u32 v108, v108, v102, v103
s_waitcnt vmcnt(0)
v_max3_u32 v108, v108, v104, v105
v_max3_u32 v108, v108, v106, v107
s_add_u32 s36, s36, 1
s_cmp_lt_u32 s36, 16
s_cbranch_scc1 L_k2redo3b
v_cmp_eq_u32 vcc, -1, v108
s_cbranch_vccz L_k2redo3c
s_add_u32 s37, s37, 1
s_cmp_lt_u32 s37, 0x8000
s_cbranch_scc1 L_k2redo3a
L_k2redo3c:
s_nop 7
s_mov_b32 s35, s9
v_lshlrev_b32 v132, 16, v32
v_and_b32 v133, 0xffff0000, v32
v_lshlrev_b32 v134, 16, v33
v_and_b32 v135, 0xffff0000, v33
v_lshlrev_b32 v136, 16, v34
v_and_b32 v137, 0xffff0000, v34
v_lshlrev_b32 v138, 16, v35
v_and_b32 v139, 0xffff0000, v35
v_lshlrev_b32 v140, 16, v36
v_and_b32 v141, 0xffff0000, v36
v_lshlrev_b32 v142, 16, v37
v_and_b32 v143, 0xffff0000, v37
v_lshlrev_b32 v144, 16, v38
v_and_b32 v145, 0xffff0000, v38
v_lshlrev_b32 v146, 16, v39
v_and_b32 v147, 0xffff0000, v39
v_lshlrev_b32 v148, 16, v40
v_and_b32 v149, 0xffff0000, v40
v_lshlrev_b32 v150, 16, v41
v_and_b32 v151, 0xffff0000, v41
v_lshlrev_b32 v152, 16, v42
v_and_b32 v153, 0xffff0000, v42
v_lshlrev_b32 v154, 16, v43
v_and_b32 v155, 0xffff0000, v43
v_lshlrev_b32 v156, 16, v44
v_and_b32 v157, 0xffff0000, v44
v_lshlrev_b32 v158, 16, v45
v_and_b32 v159, 0xffff0000, v45
v_lshlrev_b32 v160, 16, v46
v_and_b32 v161, 0xffff0000, v46
v_lshlrev_b32 v162, 16, v47
v_and_b32 v163, 0xffff0000, v47
s_branch L_k2go3
L_code_end:
.section .rodata,"a"
.p2align 6
.amdhsa_kernel interleave_layers__sliding_local_dilated__linear_kernel_hedgehog__prompt_kernel
  .amdhsa_next_free_vgpr 512
  .amdhsa_next_free_sgpr 102
  .amdhsa_accum_offset 256
  .amdhsa_group_segment_fixed_size 0
  .amdhsa_kernarg_size 80
  .amdhsa_user_sgpr_count 2
  .amdhsa_user_sgpr_kernarg_segment_ptr 1
  .amdhsa_system_sgpr_workgroup_id_x 1
.end_amdhsa_kernel
```

```asm
; @launch grid=(256,1,1) block=(256,1,1) lds=163840
.amdgcn_target "amdgcn-amd-amdhsa--gfx950"
.text
.globl interleave_layers__sliding_local_dilated__linear_kernel_hedgehog__prompt_kernel
.p2align 8
.type interleave_layers__sliding_local_dilated__linear_kernel_hedgehog__prompt_kernel,@function
interleave_layers__sliding_local_dilated__linear_kernel_hedgehog__prompt_kernel:
s_cmp_ge_u32 s2, 256
s_cbranch_scc1 L_end
s_load_dwordx16 s[64:79], s[0:1], 0
s_load_dwordx4 s[80:83], s[0:1], 64
s_getpc_b64 s[24:25]
s_mov_b32 s26, (L_end - interleave_layers__sliding_local_dilated__linear_kernel_hedgehog__prompt_kernel - 64)
s_mov_b32 s27, 0x20000
v_lshlrev_b32 v1, 5, v0
buffer_load_dword v238, v1, s[24:27], 0 offen
v_lshrrev_b32 v1, 6, v0
v_and_b32 v0, 63, v0
v_readfirstlane_b32 s28, v1
s_and_b32 s36, s2, 7
s_lshr_b32 s37, s2, 3
s_and_b32 s38, s37, 3
s_lshr_b32 s39, s37, 2
s_and_b32 s29, s36, 1
s_lshl_b32 s32, s29, 3
s_lshl_b32 s29, s29, 2
s_add_u32 s29, s29, s38
s_add_u32 s32, s32, s39
s_lshr_b32 s36, s36, 1
s_lshl_b32 s30, s36, 3
s_add_u32 s30, s30, s39
s_lshl_b32 s31, s36, 2
s_add_u32 s31, s31, s38
s_and_b32 s32, s36, 1
s_lshl_b32 s32, s32, 3
s_add_u32 s32, s32, s39
s_and_b32 s31, s2, 1
s_lshl_b32 s31, s31, 3
s_add_u32 s31, s31, s38
s_and_b32 s3, s2, 4
s_add_u32 s31, s31, s3
s_and_b32 s29, s2, 4
s_lshl_b32 s31, s29, 1
s_add_u32 s29, s29, s38
s_and_b32 s30, s2, 3
s_lshl_b32 s30, s30, 3
s_add_u32 s30, s30, s39
s_and_b32 s3, s2, 2
s_lshl_b32 s3, s3, 1
s_add_u32 s31, s31, s3
s_add_u32 s31, s31, s38
s_and_b32 s32, s2, 1
s_lshl_b32 s32, s32, 3
s_add_u32 s32, s32, s39
s_mov_b32 s3, s39
s_and_b32 s35, s2, 7
s_lshl_b32 s35, s35, 5
s_add_u32 s35, s35, s37
s_mul_i32 s33, s39, 0
s_and_b32 s33, s33, 31
v_lshlrev_b32 v1, 4, v0
v_lshrrev_b32 v233, 4, v0
v_and_b32 v234, 15, v0
s_and_b32 s88, s31, 7
s_lshl_b32 s88, s88, 7
s_lshl_b32 s37, s28, 5
s_add_u32 s88, s88, s37
s_lshl_b32 s88, s88, 1
s_lshr_b32 s37, s31, 3
s_add_u32 s88, s88, s37
s_lshl_b32 s88, s88, 11
s_lshl_b32 s37, s32, 7
s_add_u32 s88, s88, s37
v_lshrrev_b32 v235, 3, v0
v_and_b32 v236, 7, v0
v_xor_b32 v232, v236, v233
v_lshlrev_b32 v232, 4, v232
v_lshl_add_u32 v232, v235, 12, v232
v_xor_b32 v246, 64, v232
v_lshlrev_b32 v236, 4, v236
v_lshl_add_u32 v237, v235, 11, v236
v_mul_u32_u24 v235, 6144, v235
v_add_u32 v235, v235, v236
s_lshr_b32 s36, s35, 4
s_lshl_b32 s36, s36, 2
s_add_u32 s36, s36, s28
s_mul_i32 s36, s36, 98304
s_and_b32 s37, s35, 15
s_lshl_b32 s37, s37, 7
s_add_u32 s36, s36, s37
s_lshl_b32 s37, s28, 11
s_mov_b32 s39, 0x10000
s_mov_b32 s10, 0x400000
s_mov_b32 s11, 0x20000
s_mov_b32 s22, 0x600000
s_mov_b32 s23, 0x20000
s_mov_b32 s6, 0x10000000
s_mov_b32 s7, 0x20000
s_mov_b32 s44, 0xf0000
s_waitcnt lgkmcnt(0)
s_mov_b64 s[8:9], s[64:65]
s_mov_b64 s[20:21], s[66:67]
s_lshl_b32 s39, s37, 1
s_add_u32 m0, s37, 0
s_add_u32 s38, s36, 0
buffer_load_dwordx4 v235, s[20:23], s38 offen nt lds
s_add_u32 m0, s37, 1024
s_add_u32 s38, s36, 49152
buffer_load_dwordx4 v235, s[20:23], s38 offen nt lds
s_add_u32 m0, s37, 8192
s_add_u32 s38, s36, 2048
buffer_load_dwordx4 v235, s[20:23], s38 offen nt lds
s_add_u32 m0, s37, 9216
s_add_u32 s38, s36, 51200
buffer_load_dwordx4 v235, s[20:23], s38 offen nt lds
s_add_u32 m0, s37, 16384
s_add_u32 s38, s36, 4096
buffer_load_dwordx4 v235, s[20:23], s38 offen nt lds
s_add_u32 m0, s37, 17408
s_add_u32 s38, s36, 53248
buffer_load_dwordx4 v235, s[20:23], s38 offen nt lds
s_add_u32 m0, s39, 24576
s_add_u32 s38, s88, 0
buffer_load_dwordx4 v232, s[8:11], s38 offen nt lds
s_add_u32 m0, s39, 25600
s_add_u32 s38, s88, 32768
buffer_load_dwordx4 v246, s[8:11], s38 offen nt lds
s_add_u32 m0, s39, 26624
s_add_u32 s38, s88, 65536
buffer_load_dwordx4 v232, s[8:11], s38 offen nt lds
s_add_u32 m0, s39, 27648
s_add_u32 s38, s88, 98304
buffer_load_dwordx4 v246, s[8:11], s38 offen nt lds
s_mov_b32 s37, s39
v_lshrrev_b32 v232, 1, v234
v_xor_b32 v232, v232, v233
v_lshlrev_b32 v232, 4, v232
v_lshl_add_u32 v232, v234, 7, v232
v_add_u32 v232, s37, v232
s_add_u32 s4, s82, 0x0
s_addc_u32 s5, s83, 0
s_mov_b64 s[92:93], s[80:81]
s_mov_b32 s12, s78
s_mov_b32 s13, s79
s_mov_b32 s14, 0x400000
s_mov_b32 s15, 0x20000
s_mov_b32 s42, 0x400000
s_mov_b32 s43, 0x20000
v_mov_b32 v12, 1
s_mov_b64 s[40:41], s[12:13]
s_mov_b32 s64, 0xff
s_mov_b32 s65, 0
s_and_b32 s81, s29, 3
s_lshl_b32 s66, s31, 4
s_add_u32 s66, s66, s32
s_lshl_b32 s66, s66, 8
s_lshl_b32 s67, s29, 5
s_add_u32 s67, s67, s30
s_lshl_b32 s67, s67, 8
s_lshl_b32 s80, s30, 11
s_lshl_b32 s70, s29, 8
s_add_u32 s70, s70, s80
s_lshl_b32 s71, s29, 13
s_lshr_b32 s78, s31, 1
s_lshl_b32 s78, s78, 13
s_add_u32 s79, s78, 8192
s_bitcmp1_b32 s31, 0
s_cselect_b32 s79, s79, 0x40000000
s_and_b32 s36, s31, 7
s_cmp_eq_u32 s36, 7
s_cselect_b32 s79, 0x40000000, s79
v_mov_b32 v240, 0
v_mov_b32 v241, 0
v_mov_b32 v242, 0
v_mov_b32 v243, 0
v_mov_b32 v228, v235
v_mov_b32 v229, v237
s_lshr_b32 s36, s35, 4
s_lshl_b32 s36, s36, 2
s_add_u32 s36, s36, s28
s_and_b32 s37, s35, 15
s_lshl_b32 s37, s37, 7
s_lshl_b32 s16, s36, 15
s_add_u32 s16, s16, s37
s_mul_i32 s17, s36, 98304
s_add_u32 s17, s17, s37
v_mov_b32 v16, 0x3f803f80
v_mov_b32 v17, 0x3f803f80
v_mov_b32 v18, 0x3f803f80
v_mov_b32 v19, 0x3f803f80
s_mov_b32 s46, 0xaaaaaaaa
s_mov_b32 s47, 0xaaaaaaaa
s_mov_b32 s48, 0xcccccccc
s_mov_b32 s49, 0xcccccccc
s_lshl_b32 s36, s31, 1
s_lshr_b32 s37, s28, 1
s_add_u32 s36, s36, s37
s_mul_i32 s36, s36, 131072
s_and_b32 s37, s28, 1
s_lshl_b32 s37, s37, 11
s_add_u32 s36, s36, s37
v_add_u32 v4, s36, v1
s_lshl_b32 s38, s31, 2
s_add_u32 s38, s38, s28
s_lshl_b32 s38, s38, 12
s_lshl_b32 s39, s32, 7
s_add_u32 s38, s38, s39
v_lshrrev_b32 v244, 2, v234
v_cmp_eq_u32 vcc, v244, v233
v_and_b32 v244, 7, v234
v_lshl_add_u32 v244, v244, 4, s38
v_and_b32 v245, 8, v234
v_add_u32 v244, v244, v245
v_cndmask_b32 v253, 2.0, v244, vcc
v_lshlrev_b32 v244, 4, v233
v_lshl_add_u32 v244, v234, 6, v244
v_cmp_gt_u32 vcc, 2, v234
s_nop 1
v_cndmask_b32 v254, 2.0, v244, vcc
v_lshrrev_b32 v248, 4, v0
v_lshlrev_b32 v248, 10, v248
v_bfe_u32 v249, v0, 2, 2
v_lshl_add_u32 v248, v249, 7, v248
v_and_b32 v251, 3, v0
v_lshl_add_u32 v248, v251, 3, v248
s_lshr_b32 s36, s28, 1
s_lshl_b32 s36, s36, 6
s_and_b32 s37, s28, 1
s_mul_i32 s38, s37, 8224
s_add_u32 s38, s38, s36
s_mul_i32 s39, s37, 16352
s_add_u32 s39, s39, s36
v_add_u32 v249, s39, v248
v_add_u32 v248, s38, v248
s_and_b32 s38, s35, 15
s_lshl_b32 s38, s38, 1
s_lshr_b32 s36, s28, 1
s_add_u32 s38, s38, s36
s_lshr_b32 s36, s35, 4
s_mul_i32 s96, s38, 196608
s_lshr_b32 s44, s36, 3
s_mul_i32 s44, s44, 98304
s_add_u32 s96, s96, s44
s_add_u32 s96, s96, 0x2000000
s_and_b32 s44, s36, 7
s_mul_i32 s97, s44, 12288
s_mul_i32 s44, s37, 3072
s_add_u32 s97, s97, s44
s_mul_i32 s38, s38, 6
s_mul_i32 s37, s37, 3
s_add_u32 s38, s38, s37
s_lshl_b32 s38, s38, 11
s_lshl_b32 s36, s36, 7
s_add_u32 s38, s38, s36
s_add_u32 s98, s38, 0x1800000
s_add_u32 s99, s98, 4096
v_lshrrev_b32 v247, 2, v0
v_lshlrev_b32 v250, 7, v247
v_lshl_add_u32 v250, v251, 4, v250
s_lshr_b32 s36, s28, 1
s_lshl_b32 s36, s36, 12
s_and_b32 s37, s28, 1
s_lshl_b32 s37, s37, 6
s_add_u32 s36, s36, s37
s_add_u32 s36, s36, 147456
v_add_u32 v250, s36, v250
v_subrev_u32 v230, 122880, v250
s_and_b32 s36, s35, 15
s_lshl_b32 s36, s36, 17
s_lshr_b32 s37, s35, 4
s_lshl_b32 s37, s37, 13
s_add_u32 s36, s36, s37
s_lshl_b32 s37, s28, 11
s_add_u32 s36, s36, s37
s_add_u32 s100, s36, 0x1a00000
s_add_u32 s101, s36, 0x1c00000
v_lshlrev_b32 v247, 6, v247
v_lshl_add_u32 v251, v251, 3, v247
v_add_u32 v251, 155648, v251
v_xor_b32 v236, 64, v232
s_mov_b64 s[20:21], s[68:69]
s_mov_b32 s22, 0x200000
s_lshl_b32 s37, s28, 11
s_add_u32 m0, s37, 147456
s_add_u32 s36, s16, 0
buffer_load_dwordx4 v229, s[20:23], s36 offen nt lds
s_add_u32 m0, s37, 148480
s_add_u32 s36, s16, 16384
buffer_load_dwordx4 v229, s[20:23], s36 offen nt lds
s_add_u32 s36, s67, 0xc0000
s_add_u32 s37, s66, 0xd0000
s_cmp_eq_u32 s28, 2
s_cselect_b32 s36, s37, s36
s_cmp_eq_u32 s28, 1
s_cselect_b32 s37, 128, 0
s_add_u32 s36, s36, s37
s_cmp_eq_u32 s28, 3
s_cselect_b32 s37, 0x20000, 0
s_add_u32 s36, s36, s37
s_mov_b64 exec, 1
buffer_atomic_add v240, off, s[4:7], s36 sc1
s_mov_b64 exec, -1
s_lshr_b32 s36, s2, 3
s_cmp_ge_u32 s36, 11
s_cselect_b32 s37, 11, 0
s_cselect_b32 s38, 8, 0
s_sub_u32 s51, s36, s37
s_and_b32 s37, s2, 7
s_add_u32 s37, s37, s38
s_lshl_b32 s37, s37, 8
s_lshl_b32 s34, s51, 21
s_add_u32 s34, s34, s37
s_add_u32 s34, s34, 0x1e0000
s_cmp_lt_u32 s36, 22
s_cselect_b32 s36, s28, 0
s_cmp_eq_u32 s36, 2
s_cselect_b32 s34, s34, 0x40000000
v_and_b32 v239, 2, v0
v_lshlrev_b32 v239, 12, v239
v_and_b32 v244, 1, v0
v_lshl_add_u32 v239, v244, 7, v239
s_mov_b64 exec, 15
buffer_atomic_add v240, v239, s[4:7], s34 offen sc1
s_mov_b64 exec, -1
s_mov_b32 s36, 0xf0000
buffer_load_dword v11, off, s[4:7], s36 sc1
s_lshr_b32 s36, s2, 3
s_lshl_b32 s36, s36, 2
s_add_u32 s36, s36, s28
s_lshl_b32 s36, s36, 10
buffer_load_dwordx4 a[0:3], v1, s[24:27], s36 offen
s_mov_b64 s[24:25], s[92:93]
s_mov_b32 s26, 256
s_mov_b64 s[20:21], s[74:75]
s_mov_b32 s22, 0x10000
s_and_b32 s36, s28, 1
s_lshl_b32 s36, s36, 10
s_add_u32 m0, s36, 155648
s_lshl_b32 s37, s30, 11
s_add_u32 s36, s36, s37
buffer_load_dwordx4 v1, s[20:23], s36 offen lds
s_waitcnt vmcnt(7)
ds_read_b128 v[32:35], v232 offset:24576
ds_read_b128 v[36:39], v236 offset:24576
ds_read_b128 v[40:43], v232 offset:26624
ds_read_b128 v[44:47], v236 offset:26624
s_barrier
ds_read_b64_tr_b16 a[188:189], v248 offset:0
ds_read_b64_tr_b16 a[190:191], v248 offset:512
ds_read_b64_tr_b16 a[192:193], v248 offset:4096
ds_read_b64_tr_b16 a[194:195], v248 offset:4608
ds_read_b64_tr_b16 a[196:197], v249 offset:32
ds_read_b64_tr_b16 a[198:199], v249 offset:544
ds_read_b64_tr_b16 a[200:201], v249 offset:4128
ds_read_b64_tr_b16 a[202:203], v249 offset:4640
ds_read_b64_tr_b16 a[204:205], v248 offset:8192
ds_read_b64_tr_b16 a[206:207], v248 offset:8704
ds_read_b64_tr_b16 a[208:209], v248 offset:12288
ds_read_b64_tr_b16 a[210:211], v248 offset:12800
s_lshl_b32 s36, s32, 13
s_add_u32 s37, s36, 4096
s_mov_b32 s38, 0x1700000
s_waitcnt lgkmcnt(14)
v_mfma_f32_16x16x32_bf16 v[96:99], v[32:35], v[32:35], 0
v_mfma_f32_16x16x32_bf16 v[92:95], v[16:19], v[32:35], 0
buffer_store_dwordx4 v[32:35], v4, s[12:15], s36 offen offset:0 sc1
s_waitcnt lgkmcnt(13)
v_mfma_f32_16x16x32_bf16 v[104:107], v[40:43], v[40:43], 0
v_mfma_f32_16x16x32_bf16 v[100:103], v[16:19], v[40:43], 0
buffer_store_dwordx4 v[40:43], v4, s[12:15], s36 offen offset:1024 sc1
v_mfma_f32_16x16x32_bf16 v[96:99], v[36:39], v[36:39], v[96:99]
v_mfma_f32_16x16x32_bf16 v[92:95], v[16:19], v[36:39], v[92:95]
buffer_store_dwordx4 v[36:39], v4, s[12:15], s37 offen offset:0 sc1
s_waitcnt lgkmcnt(12)
v_mfma_f32_16x16x32_bf16 v[104:107], v[44:47], v[44:47], v[104:107]
v_mfma_f32_16x16x32_bf16 v[100:103], v[16:19], v[44:47], v[100:103]
buffer_store_dwordx4 v[44:47], v4, s[12:15], s37 offen offset:1024 sc1
s_nop 1
v_cndmask_b32 v96, v96, v97, s[46:47]
v_cndmask_b32 v98, v98, v99, s[46:47]
v_cndmask_b32 v93, v96, v98, s[48:49]
buffer_store_dwordx2 v[92:93], v253, s[4:7], s38 offen offset:0 sc1
v_cndmask_b32 v104, v104, v105, s[46:47]
v_cndmask_b32 v106, v106, v107, s[46:47]
v_cndmask_b32 v101, v104, v106, s[48:49]
buffer_store_dwordx2 v[100:101], v253, s[4:7], s38 offen offset:2048 sc1
s_waitcnt lgkmcnt(10)
v_mfma_f32_16x16x32_bf16 v[108:111], a[188:191], v[16:19], 0
s_waitcnt lgkmcnt(6)
v_mfma_f32_16x16x32_bf16 v[112:115], a[196:199], v[16:19], 0
s_waitcnt lgkmcnt(2)
v_mfma_f32_16x16x32_bf16 v[116:119], a[204:207], v[16:19], 0
v_mfma_f32_16x16x32_bf16 v[108:111], a[192:195], v[16:19], v[108:111]
v_mfma_f32_16x16x32_bf16 v[112:115], a[200:203], v[16:19], v[112:115]
s_waitcnt lgkmcnt(0)
v_mfma_f32_16x16x32_bf16 v[116:119], a[208:211], v[16:19], v[116:119]
s_add_u32 s36, s97, 0
s_add_u32 s36, s36, s96
buffer_store_dwordx4 a[188:191], v1, s[4:7], s36 offen sc1
s_add_u32 s36, s97, 6144
s_add_u32 s36, s36, s96
buffer_store_dwordx4 a[192:195], v1, s[4:7], s36 offen sc1
s_add_u32 s36, s97, 1024
s_add_u32 s36, s36, s96
buffer_store_dwordx4 a[196:199], v1, s[4:7], s36 offen sc1
s_add_u32 s36, s97, 7168
s_add_u32 s36, s36, s96
buffer_store_dwordx4 a[200:203], v1, s[4:7], s36 offen sc1
s_add_u32 s36, s97, 2048
s_add_u32 s36, s36, s96
buffer_store_dwordx4 a[204:207], v1, s[4:7], s36 offen sc1
s_add_u32 s36, s97, 8192
s_add_u32 s36, s36, s96
buffer_store_dwordx4 a[208:211], v1, s[4:7], s36 offen sc1
buffer_store_dwordx4 v[108:111], v254, s[4:7], s98 offen offset:0 sc1
buffer_store_dwordx4 v[112:115], v254, s[4:7], s98 offen offset:2048 sc1
buffer_store_dwordx4 v[116:119], v254, s[4:7], s99 offen offset:0 sc1
v_lshlrev_b32 v239, 16, v233
v_lshl_add_u32 v239, v234, 4, v239
s_cmp_eq_u32 s28, 0
s_cselect_b32 s36, s66, s67
s_cmp_eq_u32 s28, 2
s_cselect_b32 s36, s70, s36
s_lshl_b32 s37, s28, 18
s_add_u32 s36, s36, s37
s_cmp_eq_u32 s28, 3
s_cselect_b32 s36, 0x40000000, s36
buffer_store_dwordx4 v[240:243], v239, s[4:7], s36 offen sc1
s_add_u32 s36, s36, 0x102000
buffer_store_dwordx4 v[240:243], v239, s[4:7], s36 offen sc1
s_waitcnt vmcnt(22)
s_barrier
ds_read_b64_tr_b16 a[212:213], v250 offset:0
ds_read_b64_tr_b16 a[214:215], v250 offset:2048
ds_read_b64_tr_b16 a[216:217], v250 offset:8
ds_read_b64_tr_b16 a[218:219], v250 offset:2056
s_waitcnt lgkmcnt(2)
buffer_store_dwordx4 a[212:215], v1, s[4:7], s100 offen offset:0 sc1
s_waitcnt lgkmcnt(0)
buffer_store_dwordx4 a[216:219], v1, s[4:7], s100 offen offset:1024 sc1
s_mov_b32 s56, 0x11111111
s_mov_b32 s57, 0x11111111
s_mov_b32 s58, 0x22222222
s_mov_b32 s59, 0x22222222
s_lshl_b32 s18, s28, 11
s_lshl_b32 s19, s28, 12
s_mul_i32 s50, s30, 196608
s_add_u32 s50, s50, s18
s_lshl_b32 s36, s32, 17
s_add_u32 s36, s36, s19
s_lshr_b32 s37, s30, 3
s_lshl_b32 s37, s37, 15
s_add_u32 s36, s36, s37
s_add_u32 s84, s36, 0x1a00000
s_add_u32 s85, s36, 0x1c00000
s_mul_i32 s55, s28, 6144
v_accvgpr_write_b32 a248, -1
v_accvgpr_write_b32 a249, -1
v_accvgpr_write_b32 a250, -1
v_accvgpr_write_b32 a251, -1
s_lshl_b32 s36, s29, 2
s_add_u32 s36, s36, s28
s_mul_i32 s37, s36, 131072
v_add_u32 v2, s37, v1
s_lshl_b32 s82, s36, 13
s_and_b32 s38, s29, 3
s_cmp_eq_u32 s38, 0
s_cselect_b32 s38, 0, 0x1f400
s_cselect_b32 s39, 0, 2048
s_cselect_b32 s54, 32, 48
s_lshl_b32 s37, s29, 19
s_sub_u32 s37, s37, s38
v_add_u32 v3, s37, v1
v_cmp_le_u32 vcc, 8, v234
s_nop 1
v_cndmask_b32 v3, 2.0, v3, vcc
s_lshl_b32 s37, s29, 15
s_sub_u32 s83, s37, s39
s_cmp_eq_u32 s28, 0
s_cselect_b32 vcc_lo, -1, 0
s_mov_b32 vcc_hi, 0
v_lshlrev_b32 v244, 8, v0
v_cndmask_b32 v10, 2.0, v244, vcc
v_and_b32 v244, 1, v233
v_lshl_add_u32 v244, v244, 3, v234
v_and_b32 v244, 15, v244
v_lshrrev_b32 v245, 1, v233
v_lshl_add_u32 v244, v245, 4, v244
v_lshrrev_b32 v245, 3, v234
v_lshl_add_u32 v244, v245, 5, v244
v_lshlrev_b32 v7, 3, v244
v_lshrrev_b32 v246, 2, v0
v_and_b32 v247, 3, v0
v_and_b32 v244, 1, v247
v_lshl_add_u32 v244, v244, 3, v246
v_and_b32 v244, 15, v244
v_lshrrev_b32 v245, 1, v247
v_lshl_add_u32 v244, v245, 4, v244
v_lshrrev_b32 v245, 3, v246
v_lshl_add_u32 v244, v245, 5, v244
v_lshlrev_b32 v8, 3, v244
s_and_b32 s36, s28, 1
s_lshl_b32 s37, s36, 3
s_add_u32 s37, s37, 20480
s_lshl_b32 s36, s36, 9
v_add_u32 v244, s37, v1
v_add_u32 v245, s36, v7
s_cmp_lt_u32 s28, 2
s_cselect_b64 vcc, -1, 0
v_cndmask_b32 v9, v245, v244, vcc
s_cmp_eq_u32 s28, 3
s_cselect_b64 vcc, -1, 0
v_cndmask_b32 v3, 2.0, v1, vcc
s_lshl_b32 s83, s67, 3
s_cmp_eq_u32 s54, 32
s_cselect_b32 s36, 1, s28
s_cmp_eq_u32 s36, 0
s_cselect_b64 vcc, -1, 0
v_cndmask_b32 v9, 2.0, v1, vcc
v_lshlrev_b32 v239, 2, v233
v_sub_u32 v239, v239, v234
v_mov_b32 v247, 0xf149f2ca
v_add_u32 v246, 7, v239
v_cmp_gt_u32 vcc, 8, v246
v_mov_b32 v244, 0xffff
s_nop 0
v_cndmask_b32 v24, v247, 0, vcc
v_cndmask_b32 v244, 0, v244, vcc
v_mov_b32 v30, v244
v_add_u32 v246, 0, v239
v_cmp_le_i32 vcc, 9, v246
v_mov_b32 v244, 0xffff
s_nop 0
v_cndmask_b32 v20, v247, 0, vcc
v_cndmask_b32 v244, 0, v244, vcc
v_mov_b32 v28, v244
v_add_u32 v246, 8, v239
v_cmp_gt_u32 vcc, 8, v246
v_mov_b32 v244, 0xffff0000
s_nop 0
v_cndmask_b32 v25, v247, 0, vcc
v_cndmask_b32 v244, 0, v244, vcc
v_or_b32 v30, v30, v244
v_add_u32 v246, 1, v239
v_cmp_le_i32 vcc, 9, v246
v_mov_b32 v244, 0xffff0000
s_nop 0
v_cndmask_b32 v21, v247, 0, vcc
v_cndmask_b32 v244, 0, v244, vcc
v_or_b32 v28, v28, v244
v_add_u32 v246, 9, v239
v_cmp_gt_u32 vcc, 8, v246
v_mov_b32 v244, 0xffff
s_nop 0
v_cndmask_b32 v26, v247, 0, vcc
v_cndmask_b32 v244, 0, v244, vcc
v_mov_b32 v31, v244
v_add_u32 v246, 2, v239
v_cmp_le_i32 vcc, 9, v246
v_mov_b32 v244, 0xffff
s_nop 0
v_cndmask_b32 v22, v247, 0, vcc
v_cndmask_b32 v244, 0, v244, vcc
v_mov_b32 v29, v244
v_add_u32 v246, 10, v239
v_cmp_gt_u32 vcc, 8, v246
v_mov_b32 v244, 0xffff0000
s_nop 0
v_cndmask_b32 v27, v247, 0, vcc
v_cndmask_b32 v244, 0, v244, vcc
v_or_b32 v31, v31, v244
v_add_u32 v246, 3, v239
v_cmp_le_i32 vcc, 9, v246
v_mov_b32 v244, 0xffff0000
s_nop 0
v_cndmask_b32 v23, v247, 0, vcc
v_cndmask_b32 v244, 0, v244, vcc
v_or_b32 v29, v29, v244
s_and_b32 s36, s29, 3
s_or_b32 s36, s36, s28
s_cmp_eq_u32 s36, 0
s_cselect_b64 vcc, -1, 0
v_cndmask_b32 v76, v20, v247, vcc
v_cndmask_b32 v77, v21, v247, vcc
v_cndmask_b32 v78, v22, v247, vcc
v_cndmask_b32 v79, v23, v247, vcc
v_cndmask_b32 v80, v28, 0, vcc
v_cndmask_b32 v81, v29, 0, vcc
s_add_u32 s91, s83, 0x1780000
buffer_store_dwordx4 a[248:251], v3, s[4:7], s91 offen offset:0 sc1
buffer_store_dwordx4 a[248:251], v3, s[4:7], s91 offen offset:1024 sc1
s_mov_b32 s36, 0x9e3779b1
s_waitcnt vmcnt(23)
v_mul_lo_u32 v15, v11, s36
v_add_u32 v15, 0x7f4a7c15, v15
s_and_b32 s36, s31, 1
s_lshl_b32 s36, s36, 4
s_add_u32 s36, s36, s32
s_lshl_b32 s36, s36, 2
s_add_u32 s92, s78, s36
s_add_u32 s92, s92, 0xc0000
s_lshl_b32 s36, s32, 2
s_add_u32 s93, s79, s36
s_add_u32 s93, s93, 0xc0080
s_and_b32 s94, s35, 15
s_lshl_b32 s94, s94, 9
s_lshr_b32 s36, s35, 4
s_lshl_b32 s36, s36, 2
s_add_u32 s94, s94, s36
s_add_u32 s94, s94, 0xc00c0
v_lshrrev_b32 v240, 1, v0
v_lshlrev_b32 v240, 13, v240
v_and_b32 v241, 1, v0
v_lshl_add_u32 v240, v241, 8, v240
s_mov_b32 vcc_lo, 0xffff
s_mov_b32 vcc_hi, 0
v_cndmask_b32 v240, 2.0, v240, vcc
v_lshlrev_b32 v241, 2, v0
v_add_u32 v248, 0, v248
v_add_u32 v249, 0, v249
s_add_u32 s96, s96, 0x400000
s_add_u32 s98, s98, 0x80000
s_add_u32 s96, s96, 0x400000
s_add_u32 s99, s99, 0x80000
s_cmp_eq_u32 s28, 0
s_cselect_b32 vcc_lo, 0xffff, 0
v_lshlrev_b32 v252, 12, v0
v_cndmask_b32 v252, 2.0, v252, vcc
v_cndmask_b32 v14, 2.0, v240, vcc
s_and_b32 s62, s35, 15
s_lshl_b32 s62, s62, 8
s_lshr_b32 s36, s35, 4
s_lshl_b32 s36, s36, 2
s_add_u32 s62, s62, s36
s_add_u32 s62, s62, 0xd0000
s_add_u32 s8, s94, 0x1ff40
v_and_b32 v255, 15, v0
v_lshlrev_b32 v255, 2, v255
s_waitcnt vmcnt(0)
s_barrier
s_cmp_lg_u32 s28, 0
s_cbranch_scc1 Lg1s_1
buffer_atomic_swap v15, v10, s[4:7], s92 offen sc1
s_add_u32 s36, s67, 0xc2080
s_cmp_eq_u32 s81, 3
s_cselect_b32 s36, 0x40000000, s36
s_mov_b64 exec, 1
buffer_atomic_swap v15, off, s[4:7], s36 sc1
s_mov_b64 exec, -1
buffer_atomic_swap v15, v240, s[4:7], s94 offen sc1
buffer_atomic_swap v15, v252, s[4:7], s62 offen sc1
Lg1s_1:
s_branch L_aligned
.p2align 12
L_aligned:
s_mov_b64 s[20:21], s[76:77]
s_mov_b32 s22, 0x200000
s_add_u32 s89, s16, 0
buffer_load_dwordx4 a[220:223], v229, s[20:23], s89 offen nt
s_mov_b64 s[20:21], s[76:77]
s_mov_b32 s22, 0x200000
s_add_u32 s89, s16, 16384
buffer_load_dwordx4 a[224:227], v229, s[20:23], s89 offen nt
s_mov_b64 s[20:21], s[72:73]
s_mov_b32 s22, 0x600000
s_add_u32 s89, s17, 0
buffer_load_dwordx4 a[188:191], v228, s[20:23], s89 offen nt
s_mov_b64 s[20:21], s[72:73]
s_mov_b32 s22, 0x600000
s_add_u32 s89, s17, 49152
buffer_load_dwordx4 a[192:195], v228, s[20:23], s89 offen nt
s_mov_b64 s[20:21], s[72:73]
s_mov_b32 s22, 0x600000
s_add_u32 s89, s17, 2048
buffer_load_dwordx4 a[196:199], v228, s[20:23], s89 offen nt
s_mov_b64 s[20:21], s[72:73]
s_mov_b32 s22, 0x600000
s_add_u32 s89, s17, 51200
buffer_load_dwordx4 a[200:203], v228, s[20:23], s89 offen nt
s_mov_b64 s[20:21], s[72:73]
s_mov_b32 s22, 0x600000
s_add_u32 s89, s17, 4096
buffer_load_dwordx4 a[204:207], v228, s[20:23], s89 offen nt
s_mov_b64 s[20:21], s[72:73]
s_mov_b32 s22, 0x600000
s_add_u32 s89, s17, 53248
buffer_load_dwordx4 a[208:211], v228, s[20:23], s89 offen nt
s_add_u32 s89, s66, 0xd0000
ds_read_b64_tr_b16 a[240:241], v251 offset:0
ds_read_b64_tr_b16 a[242:243], v251 offset:1024
ds_read_b64_tr_b16 a[244:245], v251 offset:32
ds_read_b64_tr_b16 a[246:247], v251 offset:1056
s_lshl_b32 s36, s28, 11
v_add_u32 v231, s36, v1
s_waitcnt lgkmcnt(0)
v_add_u32 v231, 0, v231
v_cmp_eq_u32 vcc, 0, v0
s_nop 1
v_cndmask_b32 v251, 2.0, v0, vcc
s_cmp_eq_u32 s34, 0x40000000
s_cbranch_scc1 Lvote_4
s_add_u32 s36, s34, 0
s_memtime s[52:53]
s_waitcnt lgkmcnt(0)
s_load_dword s37, s[4:5], s36
s_waitcnt lgkmcnt(0)
s_memtime s[60:61]
s_waitcnt lgkmcnt(0)
s_sub_u32 s38, s60, s52
s_add_u32 s36, s34, 8192
s_memtime s[52:53]
s_waitcnt lgkmcnt(0)
s_load_dword s37, s[4:5], s36
s_waitcnt lgkmcnt(0)
s_memtime s[60:61]
s_waitcnt lgkmcnt(0)
s_sub_u32 s39, s60, s52
s_add_u32 s36, s34, 128
s_memtime s[52:53]
s_waitcnt lgkmcnt(0)
s_load_dword s37, s[4:5], s36
s_waitcnt lgkmcnt(0)
s_memtime s[60:61]
s_waitcnt lgkmcnt(0)
s_sub_u32 s37, s60, s52
s_min_u32 s38, s38, s37
s_add_u32 s36, s34, 8320
s_memtime s[52:53]
s_waitcnt lgkmcnt(0)
s_load_dword s37, s[4:5], s36
s_waitcnt lgkmcnt(0)
s_memtime s[60:61]
s_waitcnt lgkmcnt(0)
s_sub_u32 s37, s60, s52
s_min_u32 s39, s39, s37
s_cmp_lt_u32 s38, s39
s_cselect_b32 s36, 0, 1
s_lshr_b32 s37, s29, 2
s_xor_b32 s36, s36, s37
s_add_u32 s36, s36, 0x10000
v_mov_b32 v242, s36
s_and_b32 s36, s51, 1
s_lshl_b32 s36, s36, 7
s_lshr_b32 s37, s51, 1
s_lshl_b32 s37, s37, 4
s_add_u32 s36, s36, s37
buffer_atomic_add v242, v251, s[24:27], s36 offen sc1
Lvote_4:
s_mov_b64 exec, 0
s_cmp_eq_u32 s28, 3
s_cbranch_scc1 L_stub0
s_cmp_eq_u32 s28, 0
s_cbranch_scc1 L_stub1
s_cmp_eq_u32 s28, 2
s_cbranch_scc1 L_stub2
L_wret0:
s_mov_b64 exec, -1
s_cmp_lg_u32 s28, 1
s_cbranch_scc1 Lg1e_3
s_cmp_eq_u32 s54, 32
s_cselect_b32 s39, 0, 1
s_or_b32 s39, s39, 0xffff0000
s_mov_b32 s38, -1
s_add_u32 s36, s67, 0xc0000
s_mov_b32 s37, 0
Lg1p_2:
v_mov_b32 v11, 0
buffer_atomic_add v11, v241, s[4:7], s36 offen sc0 sc1
s_add_u32 s37, s37, 1
v_mov_b32 v242, v15
s_mov_b64 exec, 0xffff
v_mov_b32 v242, 0
buffer_atomic_add v242, v241, s[4:7], s89 offen sc0 sc1
s_mov_b64 exec, -1
s_waitcnt vmcnt(0)
v_cmp_ne_u32 vcc, v11, v15
v_cmp_ne_u32 s[52:53], v242, v15
s_and_b64 vcc, vcc, s[38:39]
s_or_b64 vcc, vcc, s[52:53]
s_cbranch_scc0 Lg1e_3
s_cmp_lt_u32 s37, 0x100000
s_cbranch_scc1 Lg1p_2
Lg1e_3:
s_barrier
s_add_u32 s94, s71, 0x80
s_add_u32 m0, s18, 0x0
s_add_u32 s44, s50, 0x2000000
buffer_load_dwordx4 v1, s[4:7], s44 offen offset:0 sc1 lds
buffer_load_dwordx4 v1, s[4:7], s44 offen offset:1024 sc1 lds
s_add_u32 m0, s18, 0x2000
s_add_u32 s44, s50, 0x2002000
buffer_load_dwordx4 v1, s[4:7], s44 offen offset:0 sc1 lds
buffer_load_dwordx4 v1, s[4:7], s44 offen offset:1024 sc1 lds
s_add_u32 m0, s18, 0x4000
s_add_u32 s44, s50, 0x2004000
buffer_load_dwordx4 v1, s[4:7], s44 offen offset:0 sc1 lds
buffer_load_dwordx4 v1, s[4:7], s44 offen offset:1024 sc1 lds
s_add_u32 m0, s18, 0x6000
s_add_u32 s44, s50, 0x2006000
buffer_load_dwordx4 v1, s[4:7], s44 offen offset:0 sc1 lds
buffer_load_dwordx4 v1, s[4:7], s44 offen offset:1024 sc1 lds
s_add_u32 m0, s18, 0x8000
s_add_u32 s44, s50, 0x2008000
buffer_load_dwordx4 v1, s[4:7], s44 offen offset:0 sc1 lds
buffer_load_dwordx4 v1, s[4:7], s44 offen offset:1024 sc1 lds
s_add_u32 m0, s18, 0xa000
s_add_u32 s44, s50, 0x200a000
buffer_load_dwordx4 v1, s[4:7], s44 offen offset:0 sc1 lds
buffer_load_dwordx4 v1, s[4:7], s44 offen offset:1024 sc1 lds
s_mov_b32 s35, 0
s_add_u32 s33, s35, 0x1000
buffer_load_dwordx4 a[0:3], v2, s[40:43], s35 offen offset:0 sc1
buffer_load_dwordx4 a[4:7], v2, s[40:43], s33 offen offset:0 sc1
buffer_load_dwordx4 a[8:11], v2, s[40:43], s35 offen offset:1024 sc1
buffer_load_dwordx4 a[12:15], v2, s[40:43], s33 offen offset:1024 sc1
buffer_load_dwordx4 a[16:19], v2, s[40:43], s35 offen offset:2048 sc1
buffer_load_dwordx4 a[20:23], v2, s[40:43], s33 offen offset:2048 sc1
buffer_load_dwordx4 a[24:27], v2, s[40:43], s35 offen offset:3072 sc1
buffer_load_dwordx4 a[28:31], v2, s[40:43], s33 offen offset:3072 sc1
s_add_u32 s35, s35, 0x2000
s_add_u32 s33, s33, 0x2000
buffer_load_dwordx4 a[32:35], v2, s[40:43], s35 offen offset:0 sc1
buffer_load_dwordx4 a[36:39], v2, s[40:43], s33 offen offset:0 sc1
buffer_load_dwordx4 a[40:43], v2, s[40:43], s35 offen offset:1024 sc1
buffer_load_dwordx4 a[44:47], v2, s[40:43], s33 offen offset:1024 sc1
buffer_load_dwordx4 a[48:51], v2, s[40:43], s35 offen offset:2048 sc1
buffer_load_dwordx4 a[52:55], v2, s[40:43], s33 offen offset:2048 sc1
buffer_load_dwordx4 a[56:59], v2, s[40:43], s35 offen offset:3072 sc1
buffer_load_dwordx4 a[60:63], v2, s[40:43], s33 offen offset:3072 sc1
s_add_u32 s35, s35, 0x2000
s_add_u32 s33, s33, 0x2000
s_waitcnt vmcnt(16)
s_barrier
v_add_u32 v5, 0, v1
ds_read_b128 a[96:99], v5 offset:2048
ds_read_b128 a[100:103], v5 offset:8192
ds_read_b128 a[104:107], v5 offset:3072
ds_read_b128 a[108:111], v5 offset:9216
ds_read_b128 a[112:115], v5 offset:4096
ds_read_b128 a[116:119], v5 offset:10240
s_waitcnt vmcnt(14) lgkmcnt(4)
v_mfma_f32_16x16x32_bf16 v[140:143], a[96:99], a[0:3], 0
s_add_u32 m0, s18, 0xc000
s_add_u32 s44, s50, 0x200c000
v_mfma_f32_16x16x32_bf16 v[140:143], a[100:103], a[4:7], v[140:143]
buffer_load_dwordx4 a[64:67], v2, s[40:43], s35 offen offset:0 sc1
s_waitcnt vmcnt(13)
v_mfma_f32_16x16x32_bf16 v[164:167], a[100:103], a[12:15], 0
ds_read_b128 a[128:131], v5 offset:5120
v_mfma_f32_16x16x32_bf16 v[164:167], a[96:99], a[8:11], v[164:167]
ds_read_b128 a[132:135], v5 offset:11264
s_waitcnt vmcnt(12)
v_mfma_f32_16x16x32_bf16 v[188:191], a[96:99], a[16:19], 0
s_waitcnt vmcnt(11)
v_mfma_f32_16x16x32_bf16 v[188:191], a[100:103], a[20:23], v[188:191]
buffer_load_dwordx4 v1, s[4:7], s44 offen offset:0 sc1 lds
s_waitcnt vmcnt(10)
v_mfma_f32_16x16x32_bf16 v[212:215], a[100:103], a[28:31], 0
ds_read_b128 a[136:139], v5 offset:0
v_mfma_f32_16x16x32_bf16 v[212:215], a[96:99], a[24:27], v[212:215]
s_waitcnt lgkmcnt(6)
v_mfma_f32_16x16x32_bf16 v[216:219], a[104:107], a[24:27], 0
ds_read_b128 a[140:143], v5 offset:6144
s_waitcnt lgkmcnt(6)
v_mfma_f32_16x16x32_bf16 v[216:219], a[108:111], a[28:31], v[216:219]
buffer_load_dwordx4 a[68:71], v2, s[40:43], s33 offen offset:0 sc1
v_mfma_f32_16x16x32_bf16 v[192:195], a[108:111], a[20:23], 0
ds_read_b128 a[144:147], v5 offset:1024
v_mfma_f32_16x16x32_bf16 v[192:195], a[104:107], a[16:19], v[192:195]
v_mfma_f32_16x16x32_bf16 v[168:171], a[104:107], a[8:11], 0
v_mfma_f32_16x16x32_bf16 v[168:171], a[108:111], a[12:15], v[168:171]
buffer_load_dwordx4 a[72:75], v2, s[40:43], s35 offen offset:1024 sc1
v_mfma_f32_16x16x32_bf16 v[144:147], a[108:111], a[4:7], 0
ds_read_b128 a[148:151], v5 offset:7168
v_mfma_f32_16x16x32_bf16 v[144:147], a[104:107], a[0:3], v[144:147]
s_waitcnt lgkmcnt(7)
v_mfma_f32_16x16x32_bf16 v[148:151], a[112:115], a[0:3], 0
s_waitcnt lgkmcnt(6)
v_mfma_f32_16x16x32_bf16 v[148:151], a[116:119], a[4:7], v[148:151]
buffer_load_dwordx4 v1, s[4:7], s44 offen offset:1024 sc1 lds
s_add_u32 m0, s18, 0xe000
v_mfma_f32_16x16x32_bf16 v[172:175], a[116:119], a[12:15], 0
s_add_u32 s44, s50, 0x200e000
v_mfma_f32_16x16x32_bf16 v[172:175], a[112:115], a[8:11], v[172:175]
v_mfma_f32_16x16x32_bf16 v[196:199], a[112:115], a[16:19], 0
v_mfma_f32_16x16x32_bf16 v[196:199], a[116:119], a[20:23], v[196:199]
buffer_load_dwordx4 a[76:79], v2, s[40:43], s33 offen offset:1024 sc1
v_mfma_f32_16x16x32_bf16 v[220:223], a[116:119], a[28:31], 0
v_mfma_f32_16x16x32_bf16 v[220:223], a[112:115], a[24:27], v[220:223]
s_waitcnt lgkmcnt(0)
v_mfma_f32_16x16x32_bf16 v[224:227], a[128:131], a[24:27], 0
ds_read_b128 a[96:99], v5 offset:14336
v_mfma_f32_16x16x32_bf16 v[224:227], a[132:135], a[28:31], v[224:227]
buffer_load_dwordx4 a[80:83], v2, s[40:43], s35 offen offset:2048 sc1
v_mfma_f32_16x16x32_bf16 v[200:203], a[132:135], a[20:23], 0
ds_read_b128 a[100:103], v5 offset:20480
v_mfma_f32_16x16x32_bf16 v[200:203], a[128:131], a[16:19], v[200:203]
v_mfma_f32_16x16x32_bf16 v[176:179], a[128:131], a[8:11], 0
v_mfma_f32_16x16x32_bf16 v[176:179], a[132:135], a[12:15], v[176:179]
buffer_load_dwordx4 v1, s[4:7], s44 offen offset:0 sc1 lds
v_mfma_f32_16x16x32_bf16 v[152:155], a[132:135], a[4:7], 0
ds_read_b128 a[104:107], v5 offset:15360
v_mfma_f32_16x16x32_bf16 v[152:155], a[128:131], a[0:3], v[152:155]
v_mfma_f32_16x16x32_bf16 v[132:135], a[136:139], a[0:3], 0
ds_read_b128 a[108:111], v5 offset:21504
v_mfma_f32_16x16x32_bf16 v[132:135], a[140:143], a[4:7], v[132:135]
buffer_load_dwordx4 a[84:87], v2, s[40:43], s33 offen offset:2048 sc1
v_mfma_f32_16x16x32_bf16 v[156:159], a[140:143], a[12:15], 0
ds_read_b128 a[112:115], v5 offset:16384
v_mfma_f32_16x16x32_bf16 v[156:159], a[136:139], a[8:11], v[156:159]
v_mfma_f32_16x16x32_bf16 v[180:183], a[136:139], a[16:19], 0
v_mfma_f32_16x16x32_bf16 v[180:183], a[140:143], a[20:23], v[180:183]
buffer_load_dwordx4 a[88:91], v2, s[40:43], s35 offen offset:3072 sc1
v_mfma_f32_16x16x32_bf16 v[204:207], a[140:143], a[28:31], 0
ds_read_b128 a[116:119], v5 offset:22528
v_mfma_f32_16x16x32_bf16 v[204:207], a[136:139], a[24:27], v[204:207]
v_mfma_f32_16x16x32_bf16 v[208:211], a[144:147], a[24:27], 0
v_mfma_f32_16x16x32_bf16 v[208:211], a[148:151], a[28:31], v[208:211]
buffer_load_dwordx4 v1, s[4:7], s44 offen offset:1024 sc1 lds
s_add_u32 m0, s18, 0x10000
v_mfma_f32_16x16x32_bf16 v[184:187], a[148:151], a[20:23], 0
s_add_u32 s44, s50, 0x2010000
v_mfma_f32_16x16x32_bf16 v[184:187], a[144:147], a[16:19], v[184:187]
v_mfma_f32_16x16x32_bf16 v[160:163], a[144:147], a[8:11], 0
v_mfma_f32_16x16x32_bf16 v[160:163], a[148:151], a[12:15], v[160:163]
buffer_load_dwordx4 a[92:95], v2, s[40:43], s33 offen offset:3072 sc1
s_add_u32 s35, s35, 0x2000
v_mfma_f32_16x16x32_bf16 v[136:139], a[148:151], a[4:7], 0
s_add_u32 s33, s33, 0x2000
v_mfma_f32_16x16x32_bf16 v[136:139], a[144:147], a[0:3], v[136:139]
s_waitcnt vmcnt(12) lgkmcnt(0)
v_mfma_f32_16x16x32_bf16 v[140:143], a[96:99], a[32:35], v[140:143]
ds_read_b128 a[128:131], v5 offset:17408
v_mfma_f32_16x16x32_bf16 v[140:143], a[100:103], a[36:39], v[140:143]
buffer_load_dwordx4 a[0:3], v2, s[40:43], s35 offen offset:0 sc1
v_mfma_f32_16x16x32_bf16 v[164:167], a[100:103], a[44:47], v[164:167]
ds_read_b128 a[132:135], v5 offset:23552
v_mfma_f32_16x16x32_bf16 v[164:167], a[96:99], a[40:43], v[164:167]
v_mfma_f32_16x16x32_bf16 v[188:191], a[96:99], a[48:51], v[188:191]
v_mfma_f32_16x16x32_bf16 v[188:191], a[100:103], a[52:55], v[188:191]
buffer_load_dwordx4 v1, s[4:7], s44 offen offset:0 sc1 lds
v_mfma_f32_16x16x32_bf16 v[212:215], a[100:103], a[60:63], v[212:215]
ds_read_b128 a[136:139], v5 offset:12288
v_mfma_f32_16x16x32_bf16 v[212:215], a[96:99], a[56:59], v[212:215]
v_mfma_f32_16x16x32_bf16 v[216:219], a[104:107], a[56:59], v[216:219]
ds_read_b128 a[140:143], v5 offset:18432
v_mfma_f32_16x16x32_bf16 v[216:219], a[108:111], a[60:63], v[216:219]
buffer_load_dwordx4 a[4:7], v2, s[40:43], s33 offen offset:0 sc1
v_mfma_f32_16x16x32_bf16 v[192:195], a[108:111], a[52:55], v[192:195]
ds_read_b128 a[144:147], v5 offset:13312
v_mfma_f32_16x16x32_bf16 v[192:195], a[104:107], a[48:51], v[192:195]
v_mfma_f32_16x16x32_bf16 v[168:171], a[104:107], a[40:43], v[168:171]
v_mfma_f32_16x16x32_bf16 v[168:171], a[108:111], a[44:47], v[168:171]
buffer_load_dwordx4 a[8:11], v2, s[40:43], s35 offen offset:1024 sc1
v_mfma_f32_16x16x32_bf16 v[144:147], a[108:111], a[36:39], v[144:147]
ds_read_b128 a[148:151], v5 offset:19456
v_mfma_f32_16x16x32_bf16 v[144:147], a[104:107], a[32:35], v[144:147]
v_mfma_f32_16x16x32_bf16 v[148:151], a[112:115], a[32:35], v[148:151]
v_mfma_f32_16x16x32_bf16 v[148:151], a[116:119], a[36:39], v[148:151]
buffer_load_dwordx4 v1, s[4:7], s44 offen offset:1024 sc1 lds
s_add_u32 m0, s18, 0x12000
v_mfma_f32_16x16x32_bf16 v[172:175], a[116:119], a[44:47], v[172:175]
s_add_u32 s44, s50, 0x2012000
v_mfma_f32_16x16x32_bf16 v[172:175], a[112:115], a[40:43], v[172:175]
v_mfma_f32_16x16x32_bf16 v[196:199], a[112:115], a[48:51], v[196:199]
v_mfma_f32_16x16x32_bf16 v[196:199], a[116:119], a[52:55], v[196:199]
buffer_load_dwordx4 a[12:15], v2, s[40:43], s33 offen offset:1024 sc1
v_mfma_f32_16x16x32_bf16 v[220:223], a[116:119], a[60:63], v[220:223]
v_mfma_f32_16x16x32_bf16 v[220:223], a[112:115], a[56:59], v[220:223]
s_waitcnt lgkmcnt(0)
v_mfma_f32_16x16x32_bf16 v[224:227], a[128:131], a[56:59], v[224:227]
ds_read_b128 a[96:99], v5 offset:26624
v_mfma_f32_16x16x32_bf16 v[224:227], a[132:135], a[60:63], v[224:227]
buffer_load_dwordx4 a[16:19], v2, s[40:43], s35 offen offset:2048 sc1
v_mfma_f32_16x16x32_bf16 v[200:203], a[132:135], a[52:55], v[200:203]
ds_read_b128 a[100:103], v5 offset:32768
v_mfma_f32_16x16x32_bf16 v[200:203], a[128:131], a[48:51], v[200:203]
v_mfma_f32_16x16x32_bf16 v[176:179], a[128:131], a[40:43], v[176:179]
v_mfma_f32_16x16x32_bf16 v[176:179], a[132:135], a[44:47], v[176:179]
buffer_load_dwordx4 v1, s[4:7], s44 offen offset:0 sc1 lds
v_mfma_f32_16x16x32_bf16 v[152:155], a[132:135], a[36:39], v[152:155]
ds_read_b128 a[104:107], v5 offset:27648
v_mfma_f32_16x16x32_bf16 v[152:155], a[128:131], a[32:35], v[152:155]
v_mfma_f32_16x16x32_bf16 v[132:135], a[136:139], a[32:35], v[132:135]
ds_read_b128 a[108:111], v5 offset:33792
v_mfma_f32_16x16x32_bf16 v[132:135], a[140:143], a[36:39], v[132:135]
buffer_load_dwordx4 a[20:23], v2, s[40:43], s33 offen offset:2048 sc1
v_mfma_f32_16x16x32_bf16 v[156:159], a[140:143], a[44:47], v[156:159]
ds_read_b128 a[112:115], v5 offset:28672
v_mfma_f32_16x16x32_bf16 v[156:159], a[136:139], a[40:43], v[156:159]
v_mfma_f32_16x16x32_bf16 v[180:183], a[136:139], a[48:51], v[180:183]
v_mfma_f32_16x16x32_bf16 v[180:183], a[140:143], a[52:55], v[180:183]
buffer_load_dwordx4 a[24:27], v2, s[40:43], s35 offen offset:3072 sc1
v_mfma_f32_16x16x32_bf16 v[204:207], a[140:143], a[60:63], v[204:207]
ds_read_b128 a[116:119], v5 offset:34816
v_mfma_f32_16x16x32_bf16 v[204:207], a[136:139], a[56:59], v[204:207]
v_mfma_f32_16x16x32_bf16 v[208:211], a[144:147], a[56:59], v[208:211]
v_mfma_f32_16x16x32_bf16 v[208:211], a[148:151], a[60:63], v[208:211]
buffer_load_dwordx4 v1, s[4:7], s44 offen offset:1024 sc1 lds
s_add_u32 m0, s18, 0x14000
v_mfma_f32_16x16x32_bf16 v[184:187], a[148:151], a[52:55], v[184:187]
s_add_u32 s44, s50, 0x2014000
v_mfma_f32_16x16x32_bf16 v[184:187], a[144:147], a[48:51], v[184:187]
v_mfma_f32_16x16x32_bf16 v[160:163], a[144:147], a[40:43], v[160:163]
v_mfma_f32_16x16x32_bf16 v[160:163], a[148:151], a[44:47], v[160:163]
buffer_load_dwordx4 a[28:31], v2, s[40:43], s33 offen offset:3072 sc1
s_add_u32 s35, s35, 0x2000
v_mfma_f32_16x16x32_bf16 v[136:139], a[148:151], a[36:39], v[136:139]
s_add_u32 s33, s33, 0x2000
v_mfma_f32_16x16x32_bf16 v[136:139], a[144:147], a[32:35], v[136:139]
s_waitcnt vmcnt(12) lgkmcnt(0)
v_mfma_f32_16x16x32_bf16 v[140:143], a[96:99], a[64:67], v[140:143]
ds_read_b128 a[128:131], v5 offset:29696
v_mfma_f32_16x16x32_bf16 v[140:143], a[100:103], a[68:71], v[140:143]
buffer_load_dwordx4 a[32:35], v2, s[40:43], s35 offen offset:0 sc1
v_mfma_f32_16x16x32_bf16 v[164:167], a[100:103], a[76:79], v[164:167]
ds_read_b128 a[132:135], v5 offset:35840
v_mfma_f32_16x16x32_bf16 v[164:167], a[96:99], a[72:75], v[164:167]
v_mfma_f32_16x16x32_bf16 v[188:191], a[96:99], a[80:83], v[188:191]
v_mfma_f32_16x16x32_bf16 v[188:191], a[100:103], a[84:87], v[188:191]
buffer_load_dwordx4 v1, s[4:7], s44 offen offset:0 sc1 lds
v_mfma_f32_16x16x32_bf16 v[212:215], a[100:103], a[92:95], v[212:215]
ds_read_b128 a[136:139], v5 offset:24576
v_mfma_f32_16x16x32_bf16 v[212:215], a[96:99], a[88:91], v[212:215]
v_mfma_f32_16x16x32_bf16 v[216:219], a[104:107], a[88:91], v[216:219]
ds_read_b128 a[140:143], v5 offset:30720
v_mfma_f32_16x16x32_bf16 v[216:219], a[108:111], a[92:95], v[216:219]
buffer_load_dwordx4 a[36:39], v2, s[40:43], s33 offen offset:0 sc1
v_mfma_f32_16x16x32_bf16 v[192:195], a[108:111], a[84:87], v[192:195]
ds_read_b128 a[144:147], v5 offset:25600
v_mfma_f32_16x16x32_bf16 v[192:195], a[104:107], a[80:83], v[192:195]
v_mfma_f32_16x16x32_bf16 v[168:171], a[104:107], a[72:75], v[168:171]
v_mfma_f32_16x16x32_bf16 v[168:171], a[108:111], a[76:79], v[168:171]
buffer_load_dwordx4 a[40:43], v2, s[40:43], s35 offen offset:1024 sc1
v_mfma_f32_16x16x32_bf16 v[144:147], a[108:111], a[68:71], v[144:147]
ds_read_b128 a[148:151], v5 offset:31744
v_mfma_f32_16x16x32_bf16 v[144:147], a[104:107], a[64:67], v[144:147]
v_mfma_f32_16x16x32_bf16 v[148:151], a[112:115], a[64:67], v[148:151]
v_mfma_f32_16x16x32_bf16 v[148:151], a[116:119], a[68:71], v[148:151]
buffer_load_dwordx4 v1, s[4:7], s44 offen offset:1024 sc1 lds
s_add_u32 m0, s18, 0x16000
v_mfma_f32_16x16x32_bf16 v[172:175], a[116:119], a[76:79], v[172:175]
s_add_u32 s44, s50, 0x2016000
v_mfma_f32_16x16x32_bf16 v[172:175], a[112:115], a[72:75], v[172:175]
v_mfma_f32_16x16x32_bf16 v[196:199], a[112:115], a[80:83], v[196:199]
v_mfma_f32_16x16x32_bf16 v[196:199], a[116:119], a[84:87], v[196:199]
buffer_load_dwordx4 a[44:47], v2, s[40:43], s33 offen offset:1024 sc1
v_mfma_f32_16x16x32_bf16 v[220:223], a[116:119], a[92:95], v[220:223]
v_mfma_f32_16x16x32_bf16 v[220:223], a[112:115], a[88:91], v[220:223]
s_waitcnt lgkmcnt(0)
v_mfma_f32_16x16x32_bf16 v[224:227], a[128:131], a[88:91], v[224:227]
ds_read_b128 a[96:99], v5 offset:38912
v_mfma_f32_16x16x32_bf16 v[224:227], a[132:135], a[92:95], v[224:227]
buffer_load_dwordx4 a[48:51], v2, s[40:43], s35 offen offset:2048 sc1
v_mfma_f32_16x16x32_bf16 v[200:203], a[132:135], a[84:87], v[200:203]
ds_read_b128 a[100:103], v5 offset:45056
v_mfma_f32_16x16x32_bf16 v[200:203], a[128:131], a[80:83], v[200:203]
v_mfma_f32_16x16x32_bf16 v[176:179], a[128:131], a[72:75], v[176:179]
buffer_load_dwordx4 v1, s[4:7], s44 offen offset:0 sc1 lds
v_mfma_f32_16x16x32_bf16 v[176:179], a[132:135], a[76:79], v[176:179]
ds_read_b128 a[104:107], v5 offset:39936
v_mfma_f32_16x16x32_bf16 v[152:155], a[132:135], a[68:71], v[152:155]
v_mfma_f32_16x16x32_bf16 v[152:155], a[128:131], a[64:67], v[152:155]
buffer_load_dwordx4 a[52:55], v2, s[40:43], s33 offen offset:2048 sc1
v_mfma_f32_16x16x32_bf16 v[132:135], a[136:139], a[64:67], v[132:135]
ds_read_b128 a[108:111], v5 offset:46080
v_mfma_f32_16x16x32_bf16 v[132:135], a[140:143], a[68:71], v[132:135]
v_mfma_f32_16x16x32_bf16 v[156:159], a[140:143], a[76:79], v[156:159]
ds_read_b128 a[112:115], v5 offset:40960
v_mfma_f32_16x16x32_bf16 v[156:159], a[136:139], a[72:75], v[156:159]
buffer_load_dwordx4 v1, s[4:7], s44 offen offset:1024 sc1 lds
v_mfma_f32_16x16x32_bf16 v[180:183], a[136:139], a[80:83], v[180:183]
v_and_b32 v232, 15, v0
v_lshlrev_b32 v232, 7, v232
v_mfma_f32_16x16x32_bf16 v[180:183], a[140:143], a[84:87], v[180:183]
v_lshrrev_b32 v233, 4, v0
v_lshlrev_b32 v233, 4, v233
v_mfma_f32_16x16x32_bf16 v[204:207], a[140:143], a[92:95], v[204:207]
buffer_load_dwordx4 a[56:59], v2, s[40:43], s35 offen offset:3072 sc1
v_mfma_f32_16x16x32_bf16 v[204:207], a[136:139], a[88:91], v[204:207]
v_add_u32 v232, v233, v232
s_mul_i32 s38, s30, 12288
v_mfma_f32_16x16x32_bf16 v[208:211], a[144:147], a[88:91], v[208:211]
s_add_u32 s38, s38, 0x1800000
s_add_u32 s39, s28, 4
s_min_u32 s39, s39, 5
v_mfma_f32_16x16x32_bf16 v[208:211], a[148:151], a[92:95], v[208:211]
s_lshl_b32 s36, s28, 11
s_add_u32 s36, s36, s38
s_lshl_b32 s37, s39, 11
s_add_u32 s37, s37, s38
v_mfma_f32_16x16x32_bf16 v[184:187], a[148:151], a[84:87], v[184:187]
buffer_load_dwordx4 v[48:51], v232, s[4:7], s36 offen sc1
v_mfma_f32_16x16x32_bf16 v[184:187], a[144:147], a[80:83], v[184:187]
ds_read_b128 a[116:119], v5 offset:47104
v_mfma_f32_16x16x32_bf16 v[160:163], a[144:147], a[72:75], v[160:163]
v_mfma_f32_16x16x32_bf16 v[160:163], a[148:151], a[76:79], v[160:163]
buffer_load_dwordx4 a[60:63], v2, s[40:43], s33 offen offset:3072 sc1
s_add_u32 s35, s35, 0x2000
v_mfma_f32_16x16x32_bf16 v[136:139], a[148:151], a[68:71], v[136:139]
s_add_u32 s33, s33, 0x2000
v_mfma_f32_16x16x32_bf16 v[136:139], a[144:147], a[64:67], v[136:139]
s_waitcnt vmcnt(13) lgkmcnt(0)
v_mfma_f32_16x16x32_bf16 v[140:143], a[96:99], a[0:3], v[140:143]
ds_read_b128 a[128:131], v5 offset:41984
v_mfma_f32_16x16x32_bf16 v[140:143], a[100:103], a[4:7], v[140:143]
buffer_load_dwordx4 a[64:67], v2, s[40:43], s35 offen offset:0 sc1
v_mfma_f32_16x16x32_bf16 v[164:167], a[100:103], a[12:15], v[164:167]
ds_read_b128 a[132:135], v5 offset:48128
v_mfma_f32_16x16x32_bf16 v[164:167], a[96:99], a[8:11], v[164:167]
v_mfma_f32_16x16x32_bf16 v[188:191], a[96:99], a[16:19], v[188:191]
v_mfma_f32_16x16x32_bf16 v[188:191], a[100:103], a[20:23], v[188:191]
buffer_load_dwordx4 v[52:55], v232, s[4:7], s37 offen sc1
s_add_u32 m0, s18, 0x18000
v_mfma_f32_16x16x32_bf16 v[212:215], a[100:103], a[28:31], v[212:215]
s_add_u32 s44, s50, 0x2018000
ds_read_b128 a[136:139], v5 offset:36864
v_mfma_f32_16x16x32_bf16 v[212:215], a[96:99], a[24:27], v[212:215]
v_mfma_f32_16x16x32_bf16 v[216:219], a[104:107], a[24:27], v[216:219]
ds_read_b128 a[140:143], v5 offset:43008
v_mfma_f32_16x16x32_bf16 v[216:219], a[108:111], a[28:31], v[216:219]
buffer_load_dwordx4 a[68:71], v2, s[40:43], s33 offen offset:0 sc1
v_mfma_f32_16x16x32_bf16 v[192:195], a[108:111], a[20:23], v[192:195]
ds_read_b128 a[144:147], v5 offset:37888
v_mfma_f32_16x16x32_bf16 v[192:195], a[104:107], a[16:19], v[192:195]
v_mfma_f32_16x16x32_bf16 v[168:171], a[104:107], a[8:11], v[168:171]
v_mfma_f32_16x16x32_bf16 v[168:171], a[108:111], a[12:15], v[168:171]
buffer_load_dwordx4 a[72:75], v2, s[40:43], s35 offen offset:1024 sc1
v_mfma_f32_16x16x32_bf16 v[144:147], a[108:111], a[4:7], v[144:147]
ds_read_b128 a[148:151], v5 offset:44032
v_mfma_f32_16x16x32_bf16 v[144:147], a[104:107], a[0:3], v[144:147]
v_mfma_f32_16x16x32_bf16 v[148:151], a[112:115], a[0:3], v[148:151]
v_mfma_f32_16x16x32_bf16 v[148:151], a[116:119], a[4:7], v[148:151]
buffer_load_dwordx4 v1, s[4:7], s44 offen offset:0 sc1 lds
v_mfma_f32_16x16x32_bf16 v[172:175], a[116:119], a[12:15], v[172:175]
v_mfma_f32_16x16x32_bf16 v[172:175], a[112:115], a[8:11], v[172:175]
v_mfma_f32_16x16x32_bf16 v[196:199], a[112:115], a[16:19], v[196:199]
v_mfma_f32_16x16x32_bf16 v[196:199], a[116:119], a[20:23], v[196:199]
buffer_load_dwordx4 a[76:79], v2, s[40:43], s33 offen offset:1024 sc1
v_mfma_f32_16x16x32_bf16 v[220:223], a[116:119], a[28:31], v[220:223]
v_mfma_f32_16x16x32_bf16 v[220:223], a[112:115], a[24:27], v[220:223]
s_waitcnt lgkmcnt(0)
s_barrier
v_mfma_f32_16x16x32_bf16 v[224:227], a[128:131], a[24:27], v[224:227]
v_add_u32 v5, 49152, v1
v_mfma_f32_16x16x32_bf16 v[224:227], a[132:135], a[28:31], v[224:227]
buffer_load_dwordx4 a[80:83], v2, s[40:43], s35 offen offset:2048 sc1
v_mfma_f32_16x16x32_bf16 v[200:203], a[132:135], a[20:23], v[200:203]
ds_read_b128 a[96:99], v5 offset:2048
v_mfma_f32_16x16x32_bf16 v[200:203], a[128:131], a[16:19], v[200:203]
ds_read_b128 a[100:103], v5 offset:8192
v_mfma_f32_16x16x32_bf16 v[176:179], a[128:131], a[8:11], v[176:179]
ds_write_b128 v231, a[220:223] offset:24576
v_mfma_f32_16x16x32_bf16 v[176:179], a[132:135], a[12:15], v[176:179]
buffer_load_dwordx4 v1, s[4:7], s44 offen offset:1024 sc1 lds
s_add_u32 m0, s18, 0x1a000
v_mfma_f32_16x16x32_bf16 v[152:155], a[132:135], a[4:7], v[152:155]
s_add_u32 s44, s50, 0x201a000
ds_read_b128 a[104:107], v5 offset:3072
v_mfma_f32_16x16x32_bf16 v[152:155], a[128:131], a[0:3], v[152:155]
v_mfma_f32_16x16x32_bf16 v[132:135], a[136:139], a[0:3], v[132:135]
ds_read_b128 a[108:111], v5 offset:9216
v_mfma_f32_16x16x32_bf16 v[132:135], a[140:143], a[4:7], v[132:135]
buffer_load_dwordx4 a[84:87], v2, s[40:43], s33 offen offset:2048 sc1
v_mfma_f32_16x16x32_bf16 v[156:159], a[140:143], a[12:15], v[156:159]
ds_read_b128 a[112:115], v5 offset:4096
v_mfma_f32_16x16x32_bf16 v[156:159], a[136:139], a[8:11], v[156:159]
ds_write_b128 v231, a[224:227] offset:25600
v_mfma_f32_16x16x32_bf16 v[180:183], a[136:139], a[16:19], v[180:183]
v_mfma_f32_16x16x32_bf16 v[180:183], a[140:143], a[20:23], v[180:183]
buffer_load_dwordx4 a[88:91], v2, s[40:43], s35 offen offset:3072 sc1
v_mfma_f32_16x16x32_bf16 v[204:207], a[140:143], a[28:31], v[204:207]
ds_read_b128 a[116:119], v5 offset:10240
v_mfma_f32_16x16x32_bf16 v[204:207], a[136:139], a[24:27], v[204:207]
v_mfma_f32_16x16x32_bf16 v[208:211], a[144:147], a[24:27], v[208:211]
v_mfma_f32_16x16x32_bf16 v[208:211], a[148:151], a[28:31], v[208:211]
buffer_load_dwordx4 v1, s[4:7], s44 offen offset:0 sc1 lds
v_mfma_f32_16x16x32_bf16 v[184:187], a[148:151], a[20:23], v[184:187]
v_mfma_f32_16x16x32_bf16 v[184:187], a[144:147], a[16:19], v[184:187]
v_mfma_f32_16x16x32_bf16 v[160:163], a[144:147], a[8:11], v[160:163]
v_mfma_f32_16x16x32_bf16 v[160:163], a[148:151], a[12:15], v[160:163]
buffer_load_dwordx4 a[92:95], v2, s[40:43], s33 offen offset:3072 sc1
s_add_u32 s35, s35, 0x2000
v_mfma_f32_16x16x32_bf16 v[136:139], a[148:151], a[4:7], v[136:139]
s_add_u32 s33, s33, 0x2000
ds_write_b128 v231, a[188:191] offset:0
v_mfma_f32_16x16x32_bf16 v[136:139], a[144:147], a[0:3], v[136:139]
s_waitcnt vmcnt(12) lgkmcnt(1)
v_mfma_f32_16x16x32_bf16 v[140:143], a[96:99], a[32:35], v[140:143]
ds_read_b128 a[128:131], v5 offset:5120
v_mfma_f32_16x16x32_bf16 v[140:143], a[100:103], a[36:39], v[140:143]
buffer_load_dwordx4 a[0:3], v2, s[40:43], s35 offen offset:0 sc1
v_mfma_f32_16x16x32_bf16 v[164:167], a[100:103], a[44:47], v[164:167]
ds_read_b128 a[132:135], v5 offset:11264
v_mfma_f32_16x16x32_bf16 v[164:167], a[96:99], a[40:43], v[164:167]
v_mfma_f32_16x16x32_bf16 v[188:191], a[96:99], a[48:51], v[188:191]
v_mfma_f32_16x16x32_bf16 v[188:191], a[100:103], a[52:55], v[188:191]
buffer_load_dwordx4 v1, s[4:7], s44 offen offset:1024 sc1 lds
s_add_u32 m0, s18, 0x1c000
v_mfma_f32_16x16x32_bf16 v[212:215], a[100:103], a[60:63], v[212:215]
s_add_u32 s44, s50, 0x201c000
ds_read_b128 a[136:139], v5 offset:0
v_mfma_f32_16x16x32_bf16 v[212:215], a[96:99], a[56:59], v[212:215]
ds_write_b128 v231, a[192:195] offset:1024
v_mfma_f32_16x16x32_bf16 v[216:219], a[104:107], a[56:59], v[216:219]
ds_read_b128 a[140:143], v5 offset:6144
v_mfma_f32_16x16x32_bf16 v[216:219], a[108:111], a[60:63], v[216:219]
buffer_load_dwordx4 a[4:7], v2, s[40:43], s33 offen offset:0 sc1
v_mfma_f32_16x16x32_bf16 v[192:195], a[108:111], a[52:55], v[192:195]
ds_read_b128 a[144:147], v5 offset:1024
v_mfma_f32_16x16x32_bf16 v[192:195], a[104:107], a[48:51], v[192:195]
v_mfma_f32_16x16x32_bf16 v[168:171], a[104:107], a[40:43], v[168:171]
v_mfma_f32_16x16x32_bf16 v[168:171], a[108:111], a[44:47], v[168:171]
buffer_load_dwordx4 a[8:11], v2, s[40:43], s35 offen offset:1024 sc1
v_mfma_f32_16x16x32_bf16 v[144:147], a[108:111], a[36:39], v[144:147]
ds_read_b128 a[148:151], v5 offset:7168
v_mfma_f32_16x16x32_bf16 v[144:147], a[104:107], a[32:35], v[144:147]
v_mfma_f32_16x16x32_bf16 v[148:151], a[112:115], a[32:35], v[148:151]
v_mfma_f32_16x16x32_bf16 v[148:151], a[116:119], a[36:39], v[148:151]
buffer_load_dwordx4 v1, s[4:7], s44 offen offset:0 sc1 lds
v_mfma_f32_16x16x32_bf16 v[172:175], a[116:119], a[44:47], v[172:175]
ds_write_b128 v231, a[196:199] offset:8192
v_mfma_f32_16x16x32_bf16 v[172:175], a[112:115], a[40:43], v[172:175]
v_mfma_f32_16x16x32_bf16 v[196:199], a[112:115], a[48:51], v[196:199]
v_mfma_f32_16x16x32_bf16 v[196:199], a[116:119], a[52:55], v[196:199]
L_stub0:
s_cbranch_execz L_wret0
buffer_load_dwordx4 a[12:15], v2, s[40:43], s33 offen offset:1024 sc1
v_mfma_f32_16x16x32_bf16 v[220:223], a[116:119], a[60:63], v[220:223]
v_mfma_f32_16x16x32_bf16 v[220:223], a[112:115], a[56:59], v[220:223]
s_waitcnt lgkmcnt(1)
v_mfma_f32_16x16x32_bf16 v[224:227], a[128:131], a[56:59], v[224:227]
ds_read_b128 a[96:99], v5 offset:14336
v_mfma_f32_16x16x32_bf16 v[224:227], a[132:135], a[60:63], v[224:227]
buffer_load_dwordx4 a[16:19], v2, s[40:43], s35 offen offset:2048 sc1
v_mfma_f32_16x16x32_bf16 v[200:203], a[132:135], a[52:55], v[200:203]
ds_read_b128 a[100:103], v5 offset:20480
v_mfma_f32_16x16x32_bf16 v[200:203], a[128:131], a[48:51], v[200:203]
v_mfma_f32_16x16x32_bf16 v[176:179], a[128:131], a[40:43], v[176:179]
v_mfma_f32_16x16x32_bf16 v[176:179], a[132:135], a[44:47], v[176:179]
buffer_load_dwordx4 v1, s[4:7], s44 offen offset:1024 sc1 lds
s_add_u32 s88, s82, 0x1700000
v_mfma_f32_16x16x32_bf16 v[152:155], a[132:135], a[36:39], v[152:155]
ds_read_b128 a[104:107], v5 offset:15360
v_mfma_f32_16x16x32_bf16 v[152:155], a[128:131], a[32:35], v[152:155]
ds_write_b128 v231, a[200:203] offset:9216
v_mfma_f32_16x16x32_bf16 v[132:135], a[136:139], a[32:35], v[132:135]
ds_read_b128 a[108:111], v5 offset:21504
v_mfma_f32_16x16x32_bf16 v[132:135], a[140:143], a[36:39], v[132:135]
buffer_load_dwordx4 a[20:23], v2, s[40:43], s33 offen offset:2048 sc1
v_mfma_f32_16x16x32_bf16 v[156:159], a[140:143], a[44:47], v[156:159]
ds_read_b128 a[112:115], v5 offset:16384
v_mfma_f32_16x16x32_bf16 v[156:159], a[136:139], a[40:43], v[156:159]
v_mfma_f32_16x16x32_bf16 v[180:183], a[136:139], a[48:51], v[180:183]
v_mfma_f32_16x16x32_bf16 v[180:183], a[140:143], a[52:55], v[180:183]
buffer_load_dwordx4 a[24:27], v2, s[40:43], s35 offen offset:3072 sc1
v_mfma_f32_16x16x32_bf16 v[204:207], a[140:143], a[60:63], v[204:207]
ds_read_b128 a[116:119], v5 offset:22528
v_mfma_f32_16x16x32_bf16 v[204:207], a[136:139], a[56:59], v[204:207]
ds_write_b128 v231, a[204:207] offset:16384
v_mfma_f32_16x16x32_bf16 v[208:211], a[144:147], a[56:59], v[208:211]
v_mfma_f32_16x16x32_bf16 v[208:211], a[148:151], a[60:63], v[208:211]
buffer_load_dwordx4 v[92:95], v1, s[4:7], s88 offen offset:0 sc1
v_mfma_f32_16x16x32_bf16 v[184:187], a[148:151], a[52:55], v[184:187]
v_mfma_f32_16x16x32_bf16 v[184:187], a[144:147], a[48:51], v[184:187]
v_mfma_f32_16x16x32_bf16 v[160:163], a[144:147], a[40:43], v[160:163]
v_mfma_f32_16x16x32_bf16 v[160:163], a[148:151], a[44:47], v[160:163]
buffer_load_dwordx4 a[28:31], v2, s[40:43], s33 offen offset:3072 sc1
s_add_u32 s35, s35, 0x2000
v_mfma_f32_16x16x32_bf16 v[136:139], a[148:151], a[36:39], v[136:139]
s_add_u32 s33, s33, 0x2000
v_mfma_f32_16x16x32_bf16 v[136:139], a[144:147], a[32:35], v[136:139]
s_waitcnt vmcnt(12) lgkmcnt(1)
v_mfma_f32_16x16x32_bf16 v[140:143], a[96:99], a[64:67], v[140:143]
ds_read_b128 a[128:131], v5 offset:17408
v_mfma_f32_16x16x32_bf16 v[140:143], a[100:103], a[68:71], v[140:143]
buffer_load_dwordx4 a[32:35], v2, s[40:43], s35 offen offset:0 sc1
v_mfma_f32_16x16x32_bf16 v[164:167], a[100:103], a[76:79], v[164:167]
ds_read_b128 a[132:135], v5 offset:23552
v_mfma_f32_16x16x32_bf16 v[164:167], a[96:99], a[72:75], v[164:167]
ds_write_b128 v231, a[208:211] offset:17408
v_mfma_f32_16x16x32_bf16 v[188:191], a[96:99], a[80:83], v[188:191]
v_mfma_f32_16x16x32_bf16 v[188:191], a[100:103], a[84:87], v[188:191]
buffer_load_dwordx4 v[96:99], v1, s[4:7], s88 offen offset:1024 sc1
v_mfma_f32_16x16x32_bf16 v[212:215], a[100:103], a[92:95], v[212:215]
ds_read_b128 a[136:139], v5 offset:12288
v_mfma_f32_16x16x32_bf16 v[212:215], a[96:99], a[88:91], v[212:215]
v_mfma_f32_16x16x32_bf16 v[216:219], a[104:107], a[88:91], v[216:219]
ds_read_b128 a[140:143], v5 offset:18432
v_mfma_f32_16x16x32_bf16 v[216:219], a[108:111], a[92:95], v[216:219]
buffer_load_dwordx4 a[36:39], v2, s[40:43], s33 offen offset:0 sc1
v_mfma_f32_16x16x32_bf16 v[192:195], a[108:111], a[84:87], v[192:195]
ds_read_b128 a[144:147], v5 offset:13312
v_mfma_f32_16x16x32_bf16 v[192:195], a[104:107], a[80:83], v[192:195]
v_mfma_f32_16x16x32_bf16 v[168:171], a[104:107], a[72:75], v[168:171]
v_mfma_f32_16x16x32_bf16 v[168:171], a[108:111], a[76:79], v[168:171]
buffer_load_dwordx4 a[40:43], v2, s[40:43], s35 offen offset:1024 sc1
v_mfma_f32_16x16x32_bf16 v[144:147], a[108:111], a[68:71], v[144:147]
ds_read_b128 a[148:151], v5 offset:19456
v_mfma_f32_16x16x32_bf16 v[144:147], a[104:107], a[64:67], v[144:147]
v_mfma_f32_16x16x32_bf16 v[148:151], a[112:115], a[64:67], v[148:151]
v_mfma_f32_16x16x32_bf16 v[148:151], a[116:119], a[68:71], v[148:151]
buffer_load_dwordx4 v[100:103], v1, s[4:7], s88 offen offset:2048 sc1
v_mfma_f32_16x16x32_bf16 v[172:175], a[116:119], a[76:79], v[172:175]
v_mfma_f32_16x16x32_bf16 v[172:175], a[112:115], a[72:75], v[172:175]
v_mfma_f32_16x16x32_bf16 v[196:199], a[112:115], a[80:83], v[196:199]
v_mfma_f32_16x16x32_bf16 v[196:199], a[116:119], a[84:87], v[196:199]
buffer_load_dwordx4 a[44:47], v2, s[40:43], s33 offen offset:1024 sc1
v_mfma_f32_16x16x32_bf16 v[220:223], a[116:119], a[92:95], v[220:223]
v_mfma_f32_16x16x32_bf16 v[220:223], a[112:115], a[88:91], v[220:223]
s_waitcnt lgkmcnt(0)
s_barrier
v_mfma_f32_16x16x32_bf16 v[224:227], a[128:131], a[88:91], v[224:227]
ds_read_b128 a[96:99], v5 offset:26624
v_mfma_f32_16x16x32_bf16 v[224:227], a[132:135], a[92:95], v[224:227]
buffer_load_dwordx4 a[48:51], v2, s[40:43], s35 offen offset:2048 sc1
v_mfma_f32_16x16x32_bf16 v[200:203], a[132:135], a[84:87], v[200:203]
ds_read_b128 a[100:103], v5 offset:32768
v_mfma_f32_16x16x32_bf16 v[200:203], a[128:131], a[80:83], v[200:203]
ds_read_b64_tr_b16 a[220:221], v230 offset:0
v_mfma_f32_16x16x32_bf16 v[176:179], a[128:131], a[72:75], v[176:179]
v_mfma_f32_16x16x32_bf16 v[176:179], a[132:135], a[76:79], v[176:179]
buffer_load_dwordx4 v[104:107], v1, s[4:7], s88 offen offset:3072 sc1
s_add_u32 s88, s88, 4096
v_mfma_f32_16x16x32_bf16 v[152:155], a[132:135], a[68:71], v[152:155]
ds_read_b128 a[104:107], v5 offset:27648
v_mfma_f32_16x16x32_bf16 v[152:155], a[128:131], a[64:67], v[152:155]
ds_read_b64_tr_b16 a[222:223], v230 offset:2048
v_mfma_f32_16x16x32_bf16 v[132:135], a[136:139], a[64:67], v[132:135]
ds_read_b128 a[108:111], v5 offset:33792
v_mfma_f32_16x16x32_bf16 v[132:135], a[140:143], a[68:71], v[132:135]
buffer_load_dwordx4 a[52:55], v2, s[40:43], s33 offen offset:2048 sc1
v_mfma_f32_16x16x32_bf16 v[156:159], a[140:143], a[76:79], v[156:159]
ds_read_b128 a[112:115], v5 offset:28672
v_mfma_f32_16x16x32_bf16 v[156:159], a[136:139], a[72:75], v[156:159]
ds_read_b64_tr_b16 a[224:225], v230 offset:8
v_mfma_f32_16x16x32_bf16 v[180:183], a[136:139], a[80:83], v[180:183]
v_mfma_f32_16x16x32_bf16 v[180:183], a[140:143], a[84:87], v[180:183]
buffer_load_dwordx4 a[56:59], v2, s[40:43], s35 offen offset:3072 sc1
v_mfma_f32_16x16x32_bf16 v[204:207], a[140:143], a[92:95], v[204:207]
ds_read_b128 a[116:119], v5 offset:34816
v_mfma_f32_16x16x32_bf16 v[204:207], a[136:139], a[88:91], v[204:207]
v_mfma_f32_16x16x32_bf16 v[208:211], a[144:147], a[88:91], v[208:211]
ds_read_b64_tr_b16 a[226:227], v230 offset:2056
v_mfma_f32_16x16x32_bf16 v[208:211], a[148:151], a[92:95], v[208:211]
buffer_load_dwordx4 v[108:111], v1, s[4:7], s88 offen offset:0 sc1
v_mfma_f32_16x16x32_bf16 v[184:187], a[148:151], a[84:87], v[184:187]
v_mfma_f32_16x16x32_bf16 v[184:187], a[144:147], a[80:83], v[184:187]
v_mfma_f32_16x16x32_bf16 v[160:163], a[144:147], a[72:75], v[160:163]
v_mfma_f32_16x16x32_bf16 v[160:163], a[148:151], a[76:79], v[160:163]
buffer_load_dwordx4 a[60:63], v2, s[40:43], s33 offen offset:3072 sc1
s_add_u32 s35, s35, 0x2000
v_mfma_f32_16x16x32_bf16 v[136:139], a[148:151], a[68:71], v[136:139]
s_add_u32 s33, s33, 0x2000
ds_read_b64_tr_b16 a[188:189], v248 offset:0
v_mfma_f32_16x16x32_bf16 v[136:139], a[144:147], a[64:67], v[136:139]
s_waitcnt vmcnt(12) lgkmcnt(2)
v_mfma_f32_16x16x32_bf16 v[140:143], a[96:99], a[0:3], v[140:143]
ds_read_b128 a[128:131], v5 offset:29696
v_add_f32_dpp v48, v48, v48 row_ror:8 row_mask:0xf bank_mask:0xf
v_mfma_f32_16x16x32_bf16 v[140:143], a[100:103], a[4:7], v[140:143]
buffer_load_dwordx4 a[64:67], v2, s[40:43], s35 offen offset:0 sc1
v_mfma_f32_16x16x32_bf16 v[164:167], a[100:103], a[12:15], v[164:167]
ds_read_b128 a[132:135], v5 offset:35840
v_add_f32_dpp v49, v49, v49 row_ror:8 row_mask:0xf bank_mask:0xf
v_mfma_f32_16x16x32_bf16 v[164:167], a[96:99], a[8:11], v[164:167]
ds_read_b64_tr_b16 a[190:191], v248 offset:512
v_add_f32_dpp v50, v50, v50 row_ror:8 row_mask:0xf bank_mask:0xf
v_mfma_f32_16x16x32_bf16 v[188:191], a[96:99], a[16:19], v[188:191]
v_add_f32_dpp v51, v51, v51 row_ror:8 row_mask:0xf bank_mask:0xf
v_add_f32_dpp v52, v52, v52 row_ror:8 row_mask:0xf bank_mask:0xf
v_mfma_f32_16x16x32_bf16 v[188:191], a[100:103], a[20:23], v[188:191]
buffer_load_dwordx4 v[112:115], v1, s[4:7], s88 offen offset:1024 sc1
v_mfma_f32_16x16x32_bf16 v[212:215], a[100:103], a[28:31], v[212:215]
ds_read_b128 a[136:139], v5 offset:24576
v_add_f32_dpp v53, v53, v53 row_ror:8 row_mask:0xf bank_mask:0xf
v_mfma_f32_16x16x32_bf16 v[212:215], a[96:99], a[24:27], v[212:215]
v_add_f32_dpp v54, v54, v54 row_ror:8 row_mask:0xf bank_mask:0xf
v_add_f32_dpp v55, v55, v55 row_ror:8 row_mask:0xf bank_mask:0xf
v_mfma_f32_16x16x32_bf16 v[216:219], a[104:107], a[24:27], v[216:219]
ds_read_b128 a[140:143], v5 offset:30720
v_add_f32_dpp v48, v48, v48 row_ror:4 row_mask:0xf bank_mask:0xf
v_mfma_f32_16x16x32_bf16 v[216:219], a[108:111], a[28:31], v[216:219]
buffer_load_dwordx4 a[68:71], v2, s[40:43], s33 offen offset:0 sc1
v_mfma_f32_16x16x32_bf16 v[192:195], a[108:111], a[20:23], v[192:195]
ds_read_b128 a[144:147], v5 offset:25600
v_add_f32_dpp v49, v49, v49 row_ror:4 row_mask:0xf bank_mask:0xf
v_mfma_f32_16x16x32_bf16 v[192:195], a[104:107], a[16:19], v[192:195]
ds_read_b64_tr_b16 a[192:193], v248 offset:4096
v_add_f32_dpp v50, v50, v50 row_ror:4 row_mask:0xf bank_mask:0xf
v_mfma_f32_16x16x32_bf16 v[168:171], a[104:107], a[8:11], v[168:171]
v_add_f32_dpp v51, v51, v51 row_ror:4 row_mask:0xf bank_mask:0xf
v_add_f32_dpp v52, v52, v52 row_ror:4 row_mask:0xf bank_mask:0xf
v_mfma_f32_16x16x32_bf16 v[168:171], a[108:111], a[12:15], v[168:171]
buffer_load_dwordx4 a[72:75], v2, s[40:43], s35 offen offset:1024 sc1
v_mfma_f32_16x16x32_bf16 v[144:147], a[108:111], a[4:7], v[144:147]
ds_read_b128 a[148:151], v5 offset:31744
v_add_f32_dpp v53, v53, v53 row_ror:4 row_mask:0xf bank_mask:0xf
v_mfma_f32_16x16x32_bf16 v[144:147], a[104:107], a[0:3], v[144:147]
ds_read_b64_tr_b16 a[194:195], v248 offset:4608
v_add_f32_dpp v54, v54, v54 row_ror:4 row_mask:0xf bank_mask:0xf
v_mfma_f32_16x16x32_bf16 v[148:151], a[112:115], a[0:3], v[148:151]
v_add_f32_dpp v55, v55, v55 row_ror:4 row_mask:0xf bank_mask:0xf
v_add_f32_dpp v48, v48, v48 row_ror:2 row_mask:0xf bank_mask:0xf
v_mfma_f32_16x16x32_bf16 v[148:151], a[116:119], a[4:7], v[148:151]
buffer_load_dwordx4 v[116:119], v1, s[4:7], s88 offen offset:2048 sc1
v_mfma_f32_16x16x32_bf16 v[172:175], a[116:119], a[12:15], v[172:175]
v_add_f32_dpp v49, v49, v49 row_ror:2 row_mask:0xf bank_mask:0xf
v_add_f32_dpp v50, v50, v50 row_ror:2 row_mask:0xf bank_mask:0xf
v_mfma_f32_16x16x32_bf16 v[172:175], a[112:115], a[8:11], v[172:175]
v_add_f32_dpp v51, v51, v51 row_ror:2 row_mask:0xf bank_mask:0xf
v_add_f32_dpp v52, v52, v52 row_ror:2 row_mask:0xf bank_mask:0xf
v_mfma_f32_16x16x32_bf16 v[196:199], a[112:115], a[16:19], v[196:199]
ds_read_b64_tr_b16 a[196:197], v249 offset:32
v_add_f32_dpp v53, v53, v53 row_ror:2 row_mask:0xf bank_mask:0xf
v_mfma_f32_16x16x32_bf16 v[196:199], a[116:119], a[20:23], v[196:199]
buffer_load_dwordx4 a[76:79], v2, s[40:43], s33 offen offset:1024 sc1
v_mfma_f32_16x16x32_bf16 v[220:223], a[116:119], a[28:31], v[220:223]
v_add_f32_dpp v54, v54, v54 row_ror:2 row_mask:0xf bank_mask:0xf
v_add_f32_dpp v55, v55, v55 row_ror:2 row_mask:0xf bank_mask:0xf
v_mfma_f32_16x16x32_bf16 v[220:223], a[112:115], a[24:27], v[220:223]
v_add_f32_dpp v48, v48, v48 row_ror:1 row_mask:0xf bank_mask:0xf
s_waitcnt lgkmcnt(2)
v_mfma_f32_16x16x32_bf16 v[224:227], a[128:131], a[24:27], v[224:227]
ds_read_b128 a[96:99], v5 offset:38912
v_add_f32_dpp v49, v49, v49 row_ror:1 row_mask:0xf bank_mask:0xf
v_mfma_f32_16x16x32_bf16 v[224:227], a[132:135], a[28:31], v[224:227]
buffer_load_dwordx4 a[80:83], v2, s[40:43], s35 offen offset:2048 sc1
v_mfma_f32_16x16x32_bf16 v[200:203], a[132:135], a[20:23], v[200:203]
ds_read_b128 a[100:103], v5 offset:45056
v_add_f32_dpp v50, v50, v50 row_ror:1 row_mask:0xf bank_mask:0xf
v_mfma_f32_16x16x32_bf16 v[200:203], a[128:131], a[16:19], v[200:203]
ds_read_b64_tr_b16 a[198:199], v249 offset:544
v_add_f32_dpp v51, v51, v51 row_ror:1 row_mask:0xf bank_mask:0xf
v_mfma_f32_16x16x32_bf16 v[176:179], a[128:131], a[8:11], v[176:179]
buffer_load_dwordx4 v[120:123], v1, s[4:7], s88 offen offset:3072 sc1
s_add_u32 m0, s18, 0x1e000
v_mfma_f32_16x16x32_bf16 v[176:179], a[132:135], a[12:15], v[176:179]
s_add_u32 s44, s50, 0x201e000
ds_read_b128 a[104:107], v5 offset:39936
v_mfma_f32_16x16x32_bf16 v[152:155], a[132:135], a[4:7], v[152:155]
v_add_f32_dpp v52, v52, v52 row_ror:1 row_mask:0xf bank_mask:0xf
v_add_f32_dpp v53, v53, v53 row_ror:1 row_mask:0xf bank_mask:0xf
v_mfma_f32_16x16x32_bf16 v[152:155], a[128:131], a[0:3], v[152:155]
buffer_load_dwordx4 a[84:87], v2, s[40:43], s33 offen offset:2048 sc1
v_mfma_f32_16x16x32_bf16 v[132:135], a[136:139], a[0:3], v[132:135]
ds_read_b128 a[108:111], v5 offset:46080
v_add_f32_dpp v54, v54, v54 row_ror:1 row_mask:0xf bank_mask:0xf
v_mfma_f32_16x16x32_bf16 v[132:135], a[140:143], a[4:7], v[132:135]
ds_read_b64_tr_b16 a[200:201], v249 offset:4128
v_add_f32_dpp v55, v55, v55 row_ror:1 row_mask:0xf bank_mask:0xf
v_mfma_f32_16x16x32_bf16 v[156:159], a[140:143], a[12:15], v[156:159]
ds_read_b128 a[112:115], v5 offset:40960
v_add_u32 v233, 159744, v233
v_mfma_f32_16x16x32_bf16 v[156:159], a[136:139], a[8:11], v[156:159]
buffer_load_dwordx4 v1, s[4:7], s44 offen offset:0 sc1 lds
s_lshl_b32 s36, s28, 6
v_mfma_f32_16x16x32_bf16 v[180:183], a[136:139], a[16:19], v[180:183]
ds_read_b64_tr_b16 a[202:203], v249 offset:4640
s_lshl_b32 s37, s39, 6
v_mfma_f32_16x16x32_bf16 v[180:183], a[140:143], a[20:23], v[180:183]
ds_read_b128 a[116:119], v5 offset:47104
v_add_u32 v232, s36, v233
v_mfma_f32_16x16x32_bf16 v[204:207], a[140:143], a[28:31], v[204:207]
buffer_load_dwordx4 a[88:91], v2, s[40:43], s35 offen offset:3072 sc1
v_mfma_f32_16x16x32_bf16 v[204:207], a[136:139], a[24:27], v[204:207]
v_add_u32 v235, s37, v233
v_mfma_f32_16x16x32_bf16 v[208:211], a[144:147], a[24:27], v[208:211]
v_mfma_f32_16x16x32_bf16 v[208:211], a[148:151], a[28:31], v[208:211]
v_mfma_f32_16x16x32_bf16 v[184:187], a[148:151], a[20:23], v[184:187]
buffer_load_dwordx4 v1, s[4:7], s44 offen offset:1024 sc1 lds
s_add_u32 m0, s18, 0x20000
v_mfma_f32_16x16x32_bf16 v[184:187], a[144:147], a[16:19], v[184:187]
s_add_u32 s44, s50, 0x2020000
ds_read_b64_tr_b16 a[204:205], v248 offset:8192
v_mfma_f32_16x16x32_bf16 v[160:163], a[144:147], a[8:11], v[160:163]
v_mfma_f32_16x16x32_bf16 v[160:163], a[148:151], a[12:15], v[160:163]
buffer_load_dwordx4 a[92:95], v2, s[40:43], s33 offen offset:3072 sc1
s_add_u32 s35, s35, 0x2000
v_mfma_f32_16x16x32_bf16 v[136:139], a[148:151], a[4:7], v[136:139]
s_add_u32 s33, s33, 0x2000
v_mfma_f32_16x16x32_bf16 v[136:139], a[144:147], a[0:3], v[136:139]
ds_read_b64_tr_b16 a[206:207], v248 offset:8704
s_waitcnt vmcnt(13) lgkmcnt(2)
v_mfma_f32_16x16x32_bf16 v[140:143], a[96:99], a[32:35], v[140:143]
ds_read_b128 a[128:131], v5 offset:41984
v_mfma_f32_16x16x32_bf16 v[140:143], a[100:103], a[36:39], v[140:143]
buffer_load_dwordx4 a[0:3], v2, s[40:43], s35 offen offset:0 sc1
v_mfma_f32_16x16x32_bf16 v[164:167], a[100:103], a[44:47], v[164:167]
ds_read_b128 a[132:135], v5 offset:48128
v_mfma_f32_16x16x32_bf16 v[164:167], a[96:99], a[40:43], v[164:167]
ds_write_b128 v232, v[48:51]
v_mfma_f32_16x16x32_bf16 v[188:191], a[96:99], a[48:51], v[188:191]
ds_write_b128 v235, v[52:55]
v_mfma_f32_16x16x32_bf16 v[188:191], a[100:103], a[52:55], v[188:191]
buffer_load_dwordx4 v1, s[4:7], s44 offen offset:0 sc1 lds
v_mfma_f32_16x16x32_bf16 v[212:215], a[100:103], a[60:63], v[212:215]
ds_read_b128 a[136:139], v5 offset:36864
v_mfma_f32_16x16x32_bf16 v[212:215], a[96:99], a[56:59], v[212:215]
ds_read_b64_tr_b16 a[208:209], v248 offset:12288
v_mfma_f32_16x16x32_bf16 v[216:219], a[104:107], a[56:59], v[216:219]
ds_read_b128 a[140:143], v5 offset:43008
v_mfma_f32_16x16x32_bf16 v[216:219], a[108:111], a[60:63], v[216:219]
buffer_load_dwordx4 a[4:7], v2, s[40:43], s33 offen offset:0 sc1
v_mfma_f32_16x16x32_bf16 v[192:195], a[108:111], a[52:55], v[192:195]
ds_read_b128 a[144:147], v5 offset:37888
v_mfma_f32_16x16x32_bf16 v[192:195], a[104:107], a[48:51], v[192:195]
ds_read_b64_tr_b16 a[210:211], v248 offset:12800
v_mfma_f32_16x16x32_bf16 v[168:171], a[104:107], a[40:43], v[168:171]
v_mfma_f32_16x16x32_bf16 v[168:171], a[108:111], a[44:47], v[168:171]
ds_read_b128 a[148:151], v5 offset:44032
v_mfma_f32_16x16x32_bf16 v[144:147], a[108:111], a[36:39], v[144:147]
buffer_load_dwordx4 a[8:11], v2, s[40:43], s35 offen offset:1024 sc1
v_mfma_f32_16x16x32_bf16 v[144:147], a[104:107], a[32:35], v[144:147]
v_mfma_f32_16x16x32_bf16 v[148:151], a[112:115], a[32:35], v[148:151]
v_mfma_f32_16x16x32_bf16 v[148:151], a[116:119], a[36:39], v[148:151]
v_mfma_f32_16x16x32_bf16 v[172:175], a[116:119], a[44:47], v[172:175]
buffer_load_dword v11, v1, s[24:27], 0 offen sc1
v_mfma_f32_16x16x32_bf16 v[172:175], a[112:115], a[40:43], v[172:175]
v_mfma_f32_16x16x32_bf16 v[196:199], a[112:115], a[48:51], v[196:199]
buffer_load_dwordx4 a[12:15], v2, s[40:43], s33 offen offset:1024 sc1
v_mfma_f32_16x16x32_bf16 v[196:199], a[116:119], a[52:55], v[196:199]
v_mfma_f32_16x16x32_bf16 v[220:223], a[116:119], a[60:63], v[220:223]
v_mfma_f32_16x16x32_bf16 v[220:223], a[112:115], a[56:59], v[220:223]
s_waitcnt lgkmcnt(0)
s_barrier
v_mfma_f32_16x16x32_bf16 v[224:227], a[128:131], a[56:59], v[224:227]
v_add_u32 v5, 98304, v1
v_mfma_f32_16x16x32_bf16 v[224:227], a[132:135], a[60:63], v[224:227]
buffer_load_dwordx4 a[16:19], v2, s[40:43], s35 offen offset:2048 sc1
v_mfma_f32_16x16x32_bf16 v[200:203], a[132:135], a[52:55], v[200:203]
ds_read_b128 a[96:99], v5 offset:2048
v_mfma_f32_16x16x32_bf16 v[200:203], a[128:131], a[48:51], v[200:203]
ds_read_b128 a[100:103], v5 offset:8192
v_mfma_f32_16x16x32_bf16 v[176:179], a[128:131], a[40:43], v[176:179]
ds_read_b128 v[48:51], v233 offset:0
v_mfma_f32_16x16x32_bf16 v[176:179], a[132:135], a[44:47], v[176:179]
buffer_load_dwordx4 v1, s[4:7], s44 offen offset:1024 sc1 lds
s_add_u32 m0, s18, 0x22000
v_mfma_f32_16x16x32_bf16 v[152:155], a[132:135], a[36:39], v[152:155]
s_add_u32 s44, s50, 0x2022000
ds_read_b128 a[104:107], v5 offset:3072
v_mfma_f32_16x16x32_bf16 v[152:155], a[128:131], a[32:35], v[152:155]
v_mfma_f32_16x16x32_bf16 v[132:135], a[136:139], a[32:35], v[132:135]
ds_read_b128 a[108:111], v5 offset:9216
v_mfma_f32_16x16x32_bf16 v[132:135], a[140:143], a[36:39], v[132:135]
buffer_load_dwordx4 a[20:23], v2, s[40:43], s33 offen offset:2048 sc1
v_mfma_f32_16x16x32_bf16 v[156:159], a[140:143], a[44:47], v[156:159]
ds_read_b128 a[112:115], v5 offset:4096
v_mfma_f32_16x16x32_bf16 v[156:159], a[136:139], a[40:43], v[156:159]
ds_read_b128 v[52:55], v233 offset:64
v_mfma_f32_16x16x32_bf16 v[180:183], a[136:139], a[48:51], v[180:183]
v_mfma_f32_16x16x32_bf16 v[180:183], a[140:143], a[52:55], v[180:183]
buffer_load_dwordx4 a[24:27], v2, s[40:43], s35 offen offset:3072 sc1
v_mfma_f32_16x16x32_bf16 v[204:207], a[140:143], a[60:63], v[204:207]
ds_read_b128 a[116:119], v5 offset:10240
v_mfma_f32_16x16x32_bf16 v[204:207], a[136:139], a[56:59], v[204:207]
v_mfma_f32_16x16x32_bf16 v[208:211], a[144:147], a[56:59], v[208:211]
v_mfma_f32_16x16x32_bf16 v[208:211], a[148:151], a[60:63], v[208:211]
buffer_load_dwordx4 v1, s[4:7], s44 offen offset:0 sc1 lds
v_mfma_f32_16x16x32_bf16 v[184:187], a[148:151], a[52:55], v[184:187]
v_mfma_f32_16x16x32_bf16 v[184:187], a[144:147], a[48:51], v[184:187]
v_mfma_f32_16x16x32_bf16 v[160:163], a[144:147], a[40:43], v[160:163]
v_mfma_f32_16x16x32_bf16 v[160:163], a[148:151], a[44:47], v[160:163]
buffer_load_dwordx4 a[28:31], v2, s[40:43], s33 offen offset:3072 sc1
s_add_u32 s35, s35, 0x2000
v_mfma_f32_16x16x32_bf16 v[136:139], a[148:151], a[36:39], v[136:139]
s_add_u32 s33, s33, 0x2000
ds_read_b128 v[56:59], v233 offset:128
v_mfma_f32_16x16x32_bf16 v[136:139], a[144:147], a[32:35], v[136:139]
s_waitcnt vmcnt(12) lgkmcnt(1)
v_mfma_f32_16x16x32_bf16 v[140:143], a[96:99], a[64:67], v[140:143]
ds_read_b128 a[128:131], v5 offset:5120
v_mfma_f32_16x16x32_bf16 v[140:143], a[100:103], a[68:71], v[140:143]
buffer_load_dwordx4 a[32:35], v2, s[40:43], s35 offen offset:0 sc1
v_mfma_f32_16x16x32_bf16 v[164:167], a[100:103], a[76:79], v[164:167]
ds_read_b128 a[132:135], v5 offset:11264
v_mfma_f32_16x16x32_bf16 v[164:167], a[96:99], a[72:75], v[164:167]
v_mfma_f32_16x16x32_bf16 v[236:239], a[188:191], v[16:19], 0
v_mfma_f32_16x16x32_bf16 v[188:191], a[96:99], a[80:83], v[188:191]
v_mfma_f32_16x16x32_bf16 v[240:243], a[196:199], v[16:19], 0
v_mfma_f32_16x16x32_bf16 v[188:191], a[100:103], a[84:87], v[188:191]
buffer_load_dwordx4 v1, s[4:7], s44 offen offset:1024 sc1 lds
s_add_u32 m0, s18, 0x0
v_mfma_f32_16x16x32_bf16 v[212:215], a[100:103], a[92:95], v[212:215]
s_add_u32 s44, s50, 0x2024000
ds_read_b128 a[136:139], v5 offset:0
v_mfma_f32_16x16x32_bf16 v[212:215], a[96:99], a[88:91], v[212:215]
v_mfma_f32_16x16x32_bf16 v[216:219], a[104:107], a[88:91], v[216:219]
ds_read_b128 a[140:143], v5 offset:6144
v_mfma_f32_16x16x32_bf16 v[216:219], a[108:111], a[92:95], v[216:219]
buffer_load_dwordx4 a[36:39], v2, s[40:43], s33 offen offset:0 sc1
v_mfma_f32_16x16x32_bf16 v[192:195], a[108:111], a[84:87], v[192:195]
ds_read_b128 a[144:147], v5 offset:1024
v_mfma_f32_16x16x32_bf16 v[192:195], a[104:107], a[80:83], v[192:195]
v_mfma_f32_16x16x32_bf16 v[244:247], a[204:207], v[16:19], 0
v_mfma_f32_16x16x32_bf16 v[168:171], a[104:107], a[72:75], v[168:171]
v_mfma_f32_16x16x32_bf16 v[236:239], a[192:195], v[16:19], v[236:239]
v_mfma_f32_16x16x32_bf16 v[168:171], a[108:111], a[76:79], v[168:171]
buffer_load_dwordx4 a[40:43], v2, s[40:43], s35 offen offset:1024 sc1
v_mfma_f32_16x16x32_bf16 v[144:147], a[108:111], a[68:71], v[144:147]
ds_read_b128 a[148:151], v5 offset:7168
v_mfma_f32_16x16x32_bf16 v[144:147], a[104:107], a[64:67], v[144:147]
ds_read_b128 v[60:63], v233 offset:192
v_mfma_f32_16x16x32_bf16 v[148:151], a[112:115], a[64:67], v[148:151]
v_mfma_f32_16x16x32_bf16 v[240:243], a[200:203], v[16:19], v[240:243]
v_mfma_f32_16x16x32_bf16 v[148:151], a[116:119], a[68:71], v[148:151]
buffer_load_dwordx4 v1, s[4:7], s44 offen offset:0 sc1 lds
v_mfma_f32_16x16x32_bf16 v[172:175], a[116:119], a[76:79], v[172:175]
ds_read_b128 v[64:67], v233 offset:256
v_mfma_f32_16x16x32_bf16 v[172:175], a[112:115], a[72:75], v[172:175]
v_mfma_f32_16x16x32_bf16 v[196:199], a[112:115], a[80:83], v[196:199]
v_mfma_f32_16x16x32_bf16 v[244:247], a[208:211], v[16:19], v[244:247]
v_mfma_f32_16x16x32_bf16 v[196:199], a[116:119], a[84:87], v[196:199]
buffer_load_dwordx4 a[44:47], v2, s[40:43], s33 offen offset:1024 sc1
v_mfma_f32_16x16x32_bf16 v[220:223], a[116:119], a[92:95], v[220:223]
v_mfma_f32_16x16x32_bf16 v[220:223], a[112:115], a[88:91], v[220:223]
s_waitcnt lgkmcnt(2)
v_mfma_f32_16x16x32_bf16 v[224:227], a[128:131], a[88:91], v[224:227]
ds_read_b128 a[96:99], v5 offset:14336
v_mfma_f32_16x16x32_bf16 v[224:227], a[132:135], a[92:95], v[224:227]
buffer_load_dwordx4 a[48:51], v2, s[40:43], s35 offen offset:2048 sc1
v_mfma_f32_16x16x32_bf16 v[200:203], a[132:135], a[84:87], v[200:203]
ds_read_b128 a[100:103], v5 offset:20480
v_mfma_f32_16x16x32_bf16 v[200:203], a[128:131], a[80:83], v[200:203]
v_mfma_f32_16x16x32_bf16 v[176:179], a[128:131], a[72:75], v[176:179]
buffer_load_dwordx4 v1, s[4:7], s44 offen offset:1024 sc1 lds
s_add_u32 m0, s18, 0x2000
v_mfma_f32_16x16x32_bf16 v[176:179], a[132:135], a[76:79], v[176:179]
s_add_u32 s44, s50, 0x2026000
ds_read_b128 a[104:107], v5 offset:15360
v_mfma_f32_16x16x32_bf16 v[152:155], a[132:135], a[68:71], v[152:155]
ds_read_b128 v[68:71], v233 offset:320
v_mfma_f32_16x16x32_bf16 v[152:155], a[128:131], a[64:67], v[152:155]
buffer_load_dwordx4 a[52:55], v2, s[40:43], s33 offen offset:2048 sc1
v_mfma_f32_16x16x32_bf16 v[132:135], a[136:139], a[64:67], v[132:135]
ds_read_b128 a[108:111], v5 offset:21504
v_mfma_f32_16x16x32_bf16 v[132:135], a[140:143], a[68:71], v[132:135]
v_mfma_f32_16x16x32_bf16 v[156:159], a[140:143], a[76:79], v[156:159]
ds_read_b128 a[112:115], v5 offset:16384
v_mfma_f32_16x16x32_bf16 v[156:159], a[136:139], a[72:75], v[156:159]
buffer_load_dwordx4 v1, s[4:7], s44 offen offset:0 sc1 lds
v_mfma_f32_16x16x32_bf16 v[180:183], a[136:139], a[80:83], v[180:183]
v_mfma_f32_16x16x32_bf16 v[180:183], a[140:143], a[84:87], v[180:183]
ds_read_b128 a[116:119], v5 offset:22528
v_mfma_f32_16x16x32_bf16 v[204:207], a[140:143], a[92:95], v[204:207]
buffer_load_dwordx4 a[56:59], v2, s[40:43], s35 offen offset:3072 sc1
v_mfma_f32_16x16x32_bf16 v[204:207], a[136:139], a[88:91], v[204:207]
v_mfma_f32_16x16x32_bf16 v[208:211], a[144:147], a[88:91], v[208:211]
v_mfma_f32_16x16x32_bf16 v[208:211], a[148:151], a[92:95], v[208:211]
v_mfma_f32_16x16x32_bf16 v[184:187], a[148:151], a[84:87], v[184:187]
buffer_load_dwordx4 v1, s[4:7], s44 offen offset:1024 sc1 lds
s_add_u32 m0, s18, 0x4000
v_mfma_f32_16x16x32_bf16 v[184:187], a[144:147], a[80:83], v[184:187]
s_add_u32 s44, s50, 0x2028000
v_mfma_f32_16x16x32_bf16 v[160:163], a[144:147], a[72:75], v[160:163]
v_mfma_f32_16x16x32_bf16 v[160:163], a[148:151], a[76:79], v[160:163]
buffer_load_dwordx4 a[60:63], v2, s[40:43], s33 offen offset:3072 sc1
s_add_u32 s35, s35, 0x2000
v_mfma_f32_16x16x32_bf16 v[136:139], a[148:151], a[68:71], v[136:139]
s_add_u32 s33, s33, 0x2000
v_mfma_f32_16x16x32_bf16 v[136:139], a[144:147], a[64:67], v[136:139]
s_waitcnt vmcnt(13) lgkmcnt(0)
v_mfma_f32_16x16x32_bf16 v[140:143], a[96:99], a[0:3], v[140:143]
ds_read_b128 a[128:131], v5 offset:17408
v_add_f32 v92, v92, v96
v_mfma_f32_16x16x32_bf16 v[140:143], a[100:103], a[4:7], v[140:143]
buffer_load_dwordx4 a[64:67], v2, s[40:43], s35 offen offset:0 sc1
v_mfma_f32_16x16x32_bf16 v[164:167], a[100:103], a[12:15], v[164:167]
ds_read_b128 a[132:135], v5 offset:23552
v_add_f32 v100, v100, v104
v_mfma_f32_16x16x32_bf16 v[164:167], a[96:99], a[8:11], v[164:167]
v_add_f32 v108, v108, v112
v_add_f32 v116, v116, v120
v_mfma_f32_16x16x32_bf16 v[188:191], a[96:99], a[16:19], v[188:191]
v_add_f32 v93, v93, v97
v_add_f32 v101, v101, v105
v_mfma_f32_16x16x32_bf16 v[188:191], a[100:103], a[20:23], v[188:191]
buffer_load_dwordx4 v1, s[4:7], s44 offen offset:0 sc1 lds
v_mfma_f32_16x16x32_bf16 v[212:215], a[100:103], a[28:31], v[212:215]
ds_read_b128 a[136:139], v5 offset:12288
v_add_f32 v109, v109, v113
v_mfma_f32_16x16x32_bf16 v[212:215], a[96:99], a[24:27], v[212:215]
v_add_f32 v117, v117, v121
v_add_f32 v94, v94, v98
v_mfma_f32_16x16x32_bf16 v[216:219], a[104:107], a[24:27], v[216:219]
ds_read_b128 a[140:143], v5 offset:18432
v_add_f32 v102, v102, v106
v_mfma_f32_16x16x32_bf16 v[216:219], a[108:111], a[28:31], v[216:219]
buffer_load_dwordx4 a[68:71], v2, s[40:43], s33 offen offset:0 sc1
v_mfma_f32_16x16x32_bf16 v[192:195], a[108:111], a[20:23], v[192:195]
ds_read_b128 a[144:147], v5 offset:13312
v_add_f32 v110, v110, v114
v_mfma_f32_16x16x32_bf16 v[192:195], a[104:107], a[16:19], v[192:195]
v_add_f32 v118, v118, v122
v_add_f32 v95, v95, v99
v_mfma_f32_16x16x32_bf16 v[168:171], a[104:107], a[8:11], v[168:171]
v_add_f32 v103, v103, v107
v_mfma_f32_16x16x32_bf16 v[168:171], a[108:111], a[12:15], v[168:171]
buffer_load_dwordx4 a[72:75], v2, s[40:43], s35 offen offset:1024 sc1
v_mfma_f32_16x16x32_bf16 v[144:147], a[108:111], a[4:7], v[144:147]
ds_read_b128 a[148:151], v5 offset:19456
v_add_f32 v111, v111, v115
v_mfma_f32_16x16x32_bf16 v[144:147], a[104:107], a[0:3], v[144:147]
v_add_f32 v119, v119, v123
v_add_f32_dpp v92, v92, v92 row_ror:8 row_mask:0xf bank_mask:0xf
v_mfma_f32_16x16x32_bf16 v[148:151], a[112:115], a[0:3], v[148:151]
v_add_f32_dpp v100, v100, v100 row_ror:8 row_mask:0xf bank_mask:0xf
v_mfma_f32_16x16x32_bf16 v[148:151], a[116:119], a[4:7], v[148:151]
buffer_load_dwordx4 v1, s[4:7], s44 offen offset:1024 sc1 lds
s_add_u32 m0, s18, 0x6000
v_mfma_f32_16x16x32_bf16 v[172:175], a[116:119], a[12:15], v[172:175]
s_add_u32 s44, s50, 0x202a000
v_add_f32_dpp v108, v108, v108 row_ror:8 row_mask:0xf bank_mask:0xf
v_mfma_f32_16x16x32_bf16 v[172:175], a[112:115], a[8:11], v[172:175]
v_add_f32_dpp v116, v116, v116 row_ror:8 row_mask:0xf bank_mask:0xf
v_add_f32_dpp v93, v93, v93 row_ror:8 row_mask:0xf bank_mask:0xf
v_mfma_f32_16x16x32_bf16 v[196:199], a[112:115], a[16:19], v[196:199]
v_add_f32_dpp v101, v101, v101 row_ror:8 row_mask:0xf bank_mask:0xf
v_mfma_f32_16x16x32_bf16 v[196:199], a[116:119], a[20:23], v[196:199]
buffer_load_dwordx4 a[76:79], v2, s[40:43], s33 offen offset:1024 sc1
v_mfma_f32_16x16x32_bf16 v[220:223], a[116:119], a[28:31], v[220:223]
v_add_f32_dpp v109, v109, v109 row_ror:8 row_mask:0xf bank_mask:0xf
v_add_f32_dpp v117, v117, v117 row_ror:8 row_mask:0xf bank_mask:0xf
v_mfma_f32_16x16x32_bf16 v[220:223], a[112:115], a[24:27], v[220:223]
s_waitcnt vmcnt(17) lgkmcnt(0)
s_barrier
v_mfma_f32_16x16x32_bf16 v[224:227], a[128:131], a[24:27], v[224:227]
ds_read_b128 a[96:99], v5 offset:26624
v_add_f32_dpp v92, v94, v94 row_ror:8 row_mask:0xf bank_mask:0xc
v_mfma_f32_16x16x32_bf16 v[224:227], a[132:135], a[28:31], v[224:227]
buffer_load_dwordx4 a[80:83], v2, s[40:43], s35 offen offset:2048 sc1
v_mfma_f32_16x16x32_bf16 v[200:203], a[132:135], a[20:23], v[200:203]
ds_read_b128 a[100:103], v5 offset:32768
v_add_f32_dpp v100, v102, v102 row_ror:8 row_mask:0xf bank_mask:0xc
v_mfma_f32_16x16x32_bf16 v[200:203], a[128:131], a[16:19], v[200:203]
v_add_f32_dpp v108, v110, v110 row_ror:8 row_mask:0xf bank_mask:0xc
v_add_f32_dpp v116, v118, v118 row_ror:8 row_mask:0xf bank_mask:0xc
v_mfma_f32_16x16x32_bf16 v[176:179], a[128:131], a[8:11], v[176:179]
v_add_f32_dpp v93, v95, v95 row_ror:8 row_mask:0xf bank_mask:0xc
v_add_f32_dpp v101, v103, v103 row_ror:8 row_mask:0xf bank_mask:0xc
v_mfma_f32_16x16x32_bf16 v[176:179], a[132:135], a[12:15], v[176:179]
buffer_load_dwordx4 v1, s[4:7], s44 offen offset:0 sc1 lds
v_mfma_f32_16x16x32_bf16 v[152:155], a[132:135], a[4:7], v[152:155]
ds_read_b128 a[104:107], v5 offset:27648
v_add_f32_dpp v109, v111, v111 row_ror:8 row_mask:0xf bank_mask:0xc
v_mfma_f32_16x16x32_bf16 v[152:155], a[128:131], a[0:3], v[152:155]
v_add_f32_dpp v117, v119, v119 row_ror:8 row_mask:0xf bank_mask:0xc
v_mfma_f32_16x16x32_bf16 v[132:135], a[136:139], a[0:3], v[132:135]
ds_read_b128 a[108:111], v5 offset:33792
v_mfma_f32_16x16x32_bf16 v[132:135], a[140:143], a[4:7], v[132:135]
buffer_load_dwordx4 a[84:87], v2, s[40:43], s33 offen offset:2048 sc1
v_mfma_f32_16x16x32_bf16 v[156:159], a[140:143], a[12:15], v[156:159]
ds_read_b128 a[112:115], v5 offset:28672
v_mfma_f32_16x16x32_bf16 v[156:159], a[136:139], a[8:11], v[156:159]
v_permlane32_swap_b32 v92, v93
v_mfma_f32_16x16x32_bf16 v[180:183], a[136:139], a[16:19], v[180:183]
L_stub1:
s_cbranch_execz L_wret0
v_permlane32_swap_b32 v100, v101
v_mfma_f32_16x16x32_bf16 v[180:183], a[140:143], a[20:23], v[180:183]
buffer_load_dwordx4 a[88:91], v2, s[40:43], s35 offen offset:3072 sc1
v_mfma_f32_16x16x32_bf16 v[204:207], a[140:143], a[28:31], v[204:207]
ds_read_b128 a[116:119], v5 offset:34816
v_mfma_f32_16x16x32_bf16 v[204:207], a[136:139], a[24:27], v[204:207]
v_permlane32_swap_b32 v108, v109
v_mfma_f32_16x16x32_bf16 v[208:211], a[144:147], a[24:27], v[208:211]
v_permlane32_swap_b32 v116, v117
v_mfma_f32_16x16x32_bf16 v[208:211], a[148:151], a[28:31], v[208:211]
buffer_load_dwordx4 v1, s[4:7], s44 offen offset:1024 sc1 lds
s_add_u32 m0, s18, 0x8000
v_mfma_f32_16x16x32_bf16 v[184:187], a[148:151], a[20:23], v[184:187]
s_add_u32 s44, s50, 0x202c000
v_add_f32 v92, v92, v93
v_mfma_f32_16x16x32_bf16 v[184:187], a[144:147], a[16:19], v[184:187]
v_add_f32 v100, v100, v101
v_add_f32 v108, v108, v109
v_mfma_f32_16x16x32_bf16 v[160:163], a[144:147], a[8:11], v[160:163]
v_add_f32 v116, v116, v117
v_mov_b32 v94, v92
v_mfma_f32_16x16x32_bf16 v[160:163], a[148:151], a[12:15], v[160:163]
buffer_load_dwordx4 a[92:95], v2, s[40:43], s33 offen offset:3072 sc1
s_add_u32 s35, s35, 0x2000
v_mfma_f32_16x16x32_bf16 v[136:139], a[148:151], a[4:7], v[136:139]
s_add_u32 s33, s33, 0x2000
v_mov_b32 v102, v100
v_mfma_f32_16x16x32_bf16 v[136:139], a[144:147], a[0:3], v[136:139]
v_mov_b32 v110, v108
s_waitcnt vmcnt(12) lgkmcnt(0)
v_cmp_gt_u32 vcc, 0x100000, v11
s_nop 0
s_and_b32 vcc_lo, vcc_lo, 0x1f3f
s_cbranch_scc1 Ltal_5
Ltab_6:
v_cmp_lt_u32 vcc, 0x100008, v11
s_nop 0
s_and_b32 s51, vcc_lo, 0x1f3f
v_mfma_f32_16x16x32_bf16 v[140:143], a[96:99], a[32:35], v[140:143]
ds_read_b128 a[128:131], v5 offset:29696
v_mov_b32 v118, v116
v_mfma_f32_16x16x32_bf16 v[140:143], a[100:103], a[36:39], v[140:143]
buffer_load_dwordx4 a[0:3], v2, s[40:43], s35 offen offset:0 sc1
v_mfma_f32_16x16x32_bf16 v[164:167], a[100:103], a[44:47], v[164:167]
ds_read_b128 a[132:135], v5 offset:35840
v_mfma_f32_16x16x32_bf16 v[164:167], a[96:99], a[40:43], v[164:167]
v_permlane16_swap_b32 v92, v94
v_mfma_f32_16x16x32_bf16 v[188:191], a[96:99], a[48:51], v[188:191]
v_permlane16_swap_b32 v100, v102
v_mfma_f32_16x16x32_bf16 v[188:191], a[100:103], a[52:55], v[188:191]
buffer_load_dwordx4 v1, s[4:7], s44 offen offset:0 sc1 lds
v_mfma_f32_16x16x32_bf16 v[212:215], a[100:103], a[60:63], v[212:215]
ds_read_b128 a[136:139], v5 offset:24576
v_mfma_f32_16x16x32_bf16 v[212:215], a[96:99], a[56:59], v[212:215]
v_permlane16_swap_b32 v108, v110
v_mfma_f32_16x16x32_bf16 v[216:219], a[104:107], a[56:59], v[216:219]
ds_read_b128 a[140:143], v5 offset:30720
v_mfma_f32_16x16x32_bf16 v[216:219], a[108:111], a[60:63], v[216:219]
buffer_load_dwordx4 a[4:7], v2, s[40:43], s33 offen offset:0 sc1
v_mfma_f32_16x16x32_bf16 v[192:195], a[108:111], a[52:55], v[192:195]
ds_read_b128 a[144:147], v5 offset:25600
v_mfma_f32_16x16x32_bf16 v[192:195], a[104:107], a[48:51], v[192:195]
v_permlane16_swap_b32 v116, v118
v_mfma_f32_16x16x32_bf16 v[168:171], a[104:107], a[40:43], v[168:171]
v_add_f32 v92, v92, v94
v_add_f32 v100, v100, v102
v_mfma_f32_16x16x32_bf16 v[168:171], a[108:111], a[44:47], v[168:171]
buffer_load_dwordx4 a[8:11], v2, s[40:43], s35 offen offset:1024 sc1
v_mfma_f32_16x16x32_bf16 v[144:147], a[108:111], a[36:39], v[144:147]
ds_read_b128 a[148:151], v5 offset:31744
v_add_f32 v108, v108, v110
v_mfma_f32_16x16x32_bf16 v[144:147], a[104:107], a[32:35], v[144:147]
v_add_f32 v116, v116, v118
v_mov_b32 v94, v92
v_mfma_f32_16x16x32_bf16 v[148:151], a[112:115], a[32:35], v[148:151]
v_mov_b32 v102, v100
v_mov_b32 v110, v108
v_mfma_f32_16x16x32_bf16 v[148:151], a[116:119], a[36:39], v[148:151]
buffer_load_dwordx4 v1, s[4:7], s44 offen offset:1024 sc1 lds
s_add_u32 m0, s18, 0xa000
v_mfma_f32_16x16x32_bf16 v[172:175], a[116:119], a[44:47], v[172:175]
s_add_u32 s44, s50, 0x202e000
v_mov_b32 v118, v116
v_mfma_f32_16x16x32_bf16 v[172:175], a[112:115], a[40:43], v[172:175]
v_permlane32_swap_b32 v92, v94
v_mfma_f32_16x16x32_bf16 v[196:199], a[112:115], a[48:51], v[196:199]
v_permlane32_swap_b32 v100, v102
v_mfma_f32_16x16x32_bf16 v[196:199], a[116:119], a[52:55], v[196:199]
buffer_load_dwordx4 a[12:15], v2, s[40:43], s33 offen offset:1024 sc1
v_mfma_f32_16x16x32_bf16 v[220:223], a[116:119], a[60:63], v[220:223]
v_permlane32_swap_b32 v108, v110
v_mfma_f32_16x16x32_bf16 v[220:223], a[112:115], a[56:59], v[220:223]
s_waitcnt lgkmcnt(0)
v_mfma_f32_16x16x32_bf16 v[224:227], a[128:131], a[56:59], v[224:227]
ds_read_b128 a[96:99], v5 offset:38912
v_mfma_f32_16x16x32_bf16 v[224:227], a[132:135], a[60:63], v[224:227]
buffer_load_dwordx4 a[16:19], v2, s[40:43], s35 offen offset:2048 sc1
v_mfma_f32_16x16x32_bf16 v[200:203], a[132:135], a[52:55], v[200:203]
ds_read_b128 a[100:103], v5 offset:45056
v_mfma_f32_16x16x32_bf16 v[200:203], a[128:131], a[48:51], v[200:203]
v_permlane32_swap_b32 v116, v118
v_mfma_f32_16x16x32_bf16 v[176:179], a[128:131], a[40:43], v[176:179]
v_mul_f32 v82, 0xba800000, v92
v_mul_f32 v84, 0xba800000, v100
v_mfma_f32_16x16x32_bf16 v[176:179], a[132:135], a[44:47], v[176:179]
buffer_load_dwordx4 v1, s[4:7], s44 offen offset:0 sc1 lds
v_mfma_f32_16x16x32_bf16 v[152:155], a[132:135], a[36:39], v[152:155]
ds_read_b128 a[104:107], v5 offset:39936
v_mul_f32 v86, 0xba800000, v108
v_mfma_f32_16x16x32_bf16 v[152:155], a[128:131], a[32:35], v[152:155]
v_mul_f32 v88, 0xba800000, v116
v_mul_f32 v94, 0x3a800000, v94
v_mfma_f32_16x16x32_bf16 v[132:135], a[136:139], a[32:35], v[132:135]
ds_read_b128 a[108:111], v5 offset:46080
v_mul_f32 v102, 0x3a800000, v102
v_mfma_f32_16x16x32_bf16 v[132:135], a[140:143], a[36:39], v[132:135]
buffer_load_dwordx4 a[20:23], v2, s[40:43], s33 offen offset:2048 sc1
v_mfma_f32_16x16x32_bf16 v[156:159], a[140:143], a[44:47], v[156:159]
ds_read_b128 a[112:115], v5 offset:40960
v_mul_f32 v110, 0x3a800000, v110
v_mfma_f32_16x16x32_bf16 v[156:159], a[136:139], a[40:43], v[156:159]
v_mul_f32 v118, 0x3a800000, v118
v_fma_f32 v94, -v82, v82, v94
v_mfma_f32_16x16x32_bf16 v[180:183], a[136:139], a[48:51], v[180:183]
v_fma_f32 v102, -v84, v84, v102
v_fma_f32 v110, -v86, v86, v110
v_mfma_f32_16x16x32_bf16 v[180:183], a[140:143], a[52:55], v[180:183]
buffer_load_dwordx4 a[24:27], v2, s[40:43], s35 offen offset:3072 sc1
v_mfma_f32_16x16x32_bf16 v[204:207], a[140:143], a[60:63], v[204:207]
ds_read_b128 a[116:119], v5 offset:47104
v_fma_f32 v118, -v88, v88, v118
v_mfma_f32_16x16x32_bf16 v[204:207], a[136:139], a[56:59], v[204:207]
v_max_f32 v94, 0, v94
v_max_f32 v102, 0, v102
v_mfma_f32_16x16x32_bf16 v[208:211], a[144:147], a[56:59], v[208:211]
v_max_f32 v110, 0, v110
v_max_f32 v118, 0, v118
v_mfma_f32_16x16x32_bf16 v[208:211], a[148:151], a[60:63], v[208:211]
buffer_load_dwordx4 v1, s[4:7], s44 offen offset:1024 sc1 lds
s_add_u32 m0, s19, 49152
v_mfma_f32_16x16x32_bf16 v[184:187], a[148:151], a[52:55], v[184:187]
s_xor_b32 s44, s84, 16384
v_add_f32 v94, 0x3727c5ac, v94
v_mfma_f32_16x16x32_bf16 v[184:187], a[144:147], a[48:51], v[184:187]
v_add_f32 v102, 0x3727c5ac, v102
v_add_f32 v110, 0x3727c5ac, v110
v_mfma_f32_16x16x32_bf16 v[160:163], a[144:147], a[40:43], v[160:163]
v_add_f32 v118, 0x3727c5ac, v118
v_mfma_f32_16x16x32_bf16 v[160:163], a[148:151], a[44:47], v[160:163]
buffer_load_dwordx4 a[28:31], v2, s[40:43], s33 offen offset:3072 sc1
s_add_u32 s35, s35, 0x2000
v_mfma_f32_16x16x32_bf16 v[136:139], a[148:151], a[36:39], v[136:139]
s_add_u32 s33, s33, 0x2000
v_mfma_f32_16x16x32_bf16 v[136:139], a[144:147], a[32:35], v[136:139]
s_waitcnt vmcnt(12) lgkmcnt(0)
v_mfma_f32_16x16x32_bf16 v[140:143], a[96:99], a[64:67], v[140:143]
ds_read_b128 a[128:131], v5 offset:41984
v_mfma_f32_16x16x32_bf16 v[140:143], a[100:103], a[68:71], v[140:143]
buffer_load_dwordx4 a[32:35], v2, s[40:43], s35 offen offset:0 sc1
v_mfma_f32_16x16x32_bf16 v[164:167], a[100:103], a[76:79], v[164:167]
ds_read_b128 a[132:135], v5 offset:48128
v_mfma_f32_16x16x32_bf16 v[164:167], a[96:99], a[72:75], v[164:167]
v_rsq_f32 v83, v94
v_mfma_f32_16x16x32_bf16 v[188:191], a[96:99], a[80:83], v[188:191]
v_rsq_f32 v85, v102
v_mfma_f32_16x16x32_bf16 v[188:191], a[100:103], a[84:87], v[188:191]
buffer_load_dwordx4 v1, s[4:7], s44 offen offset:0 sc1 lds
v_mfma_f32_16x16x32_bf16 v[212:215], a[100:103], a[92:95], v[212:215]
ds_read_b128 a[136:139], v5 offset:36864
v_mfma_f32_16x16x32_bf16 v[212:215], a[96:99], a[88:91], v[212:215]
v_rsq_f32 v87, v110
v_rsq_f32 v89, v118
v_mfma_f32_16x16x32_bf16 v[216:219], a[104:107], a[88:91], v[216:219]
ds_read_b128 a[140:143], v5 offset:43008
v_mfma_f32_16x16x32_bf16 v[216:219], a[108:111], a[92:95], v[216:219]
buffer_load_dwordx4 a[36:39], v2, s[40:43], s33 offen offset:0 sc1
v_mfma_f32_16x16x32_bf16 v[192:195], a[108:111], a[84:87], v[192:195]
ds_read_b128 a[144:147], v5 offset:37888
v_fmac_f32 v140, v56, v82
v_mfma_f32_16x16x32_bf16 v[192:195], a[104:107], a[80:83], v[192:195]
v_mfma_f32_16x16x32_bf16 v[168:171], a[104:107], a[72:75], v[168:171]
v_fmac_f32 v164, v56, v84
v_mfma_f32_16x16x32_bf16 v[168:171], a[108:111], a[76:79], v[168:171]
buffer_load_dwordx4 a[40:43], v2, s[40:43], s35 offen offset:1024 sc1
v_mfma_f32_16x16x32_bf16 v[144:147], a[108:111], a[68:71], v[144:147]
ds_read_b128 a[148:151], v5 offset:44032
v_fmac_f32 v188, v56, v86
v_mfma_f32_16x16x32_bf16 v[144:147], a[104:107], a[64:67], v[144:147]
v_mfma_f32_16x16x32_bf16 v[148:151], a[112:115], a[64:67], v[148:151]
v_fmac_f32 v212, v56, v88
v_mfma_f32_16x16x32_bf16 v[148:151], a[116:119], a[68:71], v[148:151]
buffer_load_dwordx4 v1, s[4:7], s44 offen offset:1024 sc1 lds
v_mfma_f32_16x16x32_bf16 v[172:175], a[116:119], a[76:79], v[172:175]
v_fmac_f32 v216, v60, v88
v_mfma_f32_16x16x32_bf16 v[172:175], a[112:115], a[72:75], v[172:175]
v_mfma_f32_16x16x32_bf16 v[196:199], a[112:115], a[80:83], v[196:199]
v_fmac_f32 v192, v60, v86
v_mfma_f32_16x16x32_bf16 v[196:199], a[116:119], a[84:87], v[196:199]
buffer_load_dwordx4 a[44:47], v2, s[40:43], s33 offen offset:1024 sc1
v_mfma_f32_16x16x32_bf16 v[220:223], a[116:119], a[92:95], v[220:223]
v_fmac_f32 v168, v60, v84
v_fmac_f32 v141, v57, v82
v_mfma_f32_16x16x32_bf16 v[220:223], a[112:115], a[88:91], v[220:223]
s_waitcnt lgkmcnt(0)
s_barrier
v_mfma_f32_16x16x32_bf16 v[224:227], a[128:131], a[88:91], v[224:227]
v_add_u32 v5, 0, v1
v_fmac_f32 v144, v60, v82
v_mfma_f32_16x16x32_bf16 v[224:227], a[132:135], a[92:95], v[224:227]
buffer_load_dwordx4 a[48:51], v2, s[40:43], s35 offen offset:2048 sc1
v_mfma_f32_16x16x32_bf16 v[200:203], a[132:135], a[84:87], v[200:203]
ds_read_b128 a[96:99], v5 offset:2048
v_fmac_f32 v148, v64, v82
v_mfma_f32_16x16x32_bf16 v[200:203], a[128:131], a[80:83], v[200:203]
ds_read_b128 a[100:103], v5 offset:8192
v_fmac_f32 v165, v57, v84
v_mfma_f32_16x16x32_bf16 v[176:179], a[128:131], a[72:75], v[176:179]
v_fmac_f32 v172, v64, v84
v_fmac_f32 v189, v57, v86
v_mfma_f32_16x16x32_bf16 v[176:179], a[132:135], a[76:79], v[176:179]
buffer_load_dwordx4 v1, s[4:7], s44 offen offset:2048 sc1 lds
v_mfma_f32_16x16x32_bf16 v[152:155], a[132:135], a[68:71], v[152:155]
ds_read_b128 a[104:107], v5 offset:3072
v_fmac_f32 v196, v64, v86
v_mfma_f32_16x16x32_bf16 v[152:155], a[128:131], a[64:67], v[152:155]
v_fmac_f32 v213, v57, v88
v_fmac_f32 v217, v61, v88
v_mfma_f32_16x16x32_bf16 v[132:135], a[136:139], a[64:67], v[132:135]
ds_read_b128 a[108:111], v5 offset:9216
v_fmac_f32 v220, v64, v88
v_mfma_f32_16x16x32_bf16 v[132:135], a[140:143], a[68:71], v[132:135]
buffer_load_dwordx4 a[52:55], v2, s[40:43], s33 offen offset:2048 sc1
v_mfma_f32_16x16x32_bf16 v[156:159], a[140:143], a[76:79], v[156:159]
ds_read_b128 a[112:115], v5 offset:4096
v_fmac_f32 v224, v68, v88
v_mfma_f32_16x16x32_bf16 v[156:159], a[136:139], a[72:75], v[156:159]
v_fmac_f32 v193, v61, v86
v_fmac_f32 v169, v61, v84
v_mfma_f32_16x16x32_bf16 v[180:183], a[136:139], a[80:83], v[180:183]
v_fmac_f32 v200, v68, v86
v_fmac_f32 v145, v61, v82
v_mfma_f32_16x16x32_bf16 v[180:183], a[140:143], a[84:87], v[180:183]
buffer_load_dwordx4 a[56:59], v2, s[40:43], s35 offen offset:3072 sc1
v_mfma_f32_16x16x32_bf16 v[204:207], a[140:143], a[92:95], v[204:207]
ds_read_b128 a[116:119], v5 offset:10240
v_fmac_f32 v176, v68, v84
v_mfma_f32_16x16x32_bf16 v[204:207], a[136:139], a[88:91], v[204:207]
v_fmac_f32 v149, v65, v82
v_mfma_f32_16x16x32_bf16 v[208:211], a[144:147], a[88:91], v[208:211]
v_fmac_f32 v152, v68, v82
v_fmac_f32 v173, v65, v84
v_mfma_f32_16x16x32_bf16 v[208:211], a[148:151], a[92:95], v[208:211]
buffer_load_dwordx4 v1, s[4:7], s44 offen offset:3072 sc1 lds
s_add_u32 m0, s19, 65536
v_mfma_f32_16x16x32_bf16 v[184:187], a[148:151], a[84:87], v[184:187]
s_xor_b32 s44, s84, 32768
v_fmac_f32 v132, v48, v82
v_mfma_f32_16x16x32_bf16 v[184:187], a[144:147], a[80:83], v[184:187]
v_fmac_f32 v197, v65, v86
v_mfma_f32_16x16x32_bf16 v[160:163], a[144:147], a[72:75], v[160:163]
v_fmac_f32 v156, v48, v84
v_fmac_f32 v221, v65, v88
v_mfma_f32_16x16x32_bf16 v[160:163], a[148:151], a[76:79], v[160:163]
buffer_load_dwordx4 a[60:63], v2, s[40:43], s33 offen offset:3072 sc1
s_add_u32 s35, s35, 0x2000
v_mfma_f32_16x16x32_bf16 v[136:139], a[148:151], a[68:71], v[136:139]
s_add_u32 s33, s33, 0x2000
v_fmac_f32 v180, v48, v86
v_mfma_f32_16x16x32_bf16 v[136:139], a[144:147], a[64:67], v[136:139]
v_fmac_f32 v225, v69, v88
s_waitcnt vmcnt(12) lgkmcnt(0)
v_mfma_f32_16x16x32_bf16 v[140:143], a[96:99], a[0:3], v[140:143]
ds_read_b128 a[128:131], v5 offset:5120
v_fmac_f32 v204, v48, v88
v_mfma_f32_16x16x32_bf16 v[140:143], a[100:103], a[4:7], v[140:143]
buffer_load_dwordx4 a[64:67], v2, s[40:43], s35 offen offset:0 sc1
s_lshl_b32 s37, s28, 10
v_mfma_f32_16x16x32_bf16 v[164:167], a[100:103], a[12:15], v[164:167]
ds_read_b128 a[132:135], v5 offset:11264
v_fmac_f32 v208, v52, v88
v_mfma_f32_16x16x32_bf16 v[164:167], a[96:99], a[8:11], v[164:167]
v_fmac_f32 v201, v69, v86
v_fmac_f32 v177, v69, v84
v_mfma_f32_16x16x32_bf16 v[188:191], a[96:99], a[16:19], v[188:191]
v_fmac_f32 v184, v52, v86
v_fmac_f32 v153, v69, v82
v_mfma_f32_16x16x32_bf16 v[188:191], a[100:103], a[20:23], v[188:191]
buffer_load_dwordx4 a[68:71], v2, s[40:43], s33 offen offset:0 sc1
s_lshr_b32 s79, s30, 1
v_mfma_f32_16x16x32_bf16 v[212:215], a[100:103], a[28:31], v[212:215]
ds_read_b128 a[136:139], v5 offset:0
v_fmac_f32 v160, v52, v84
v_mfma_f32_16x16x32_bf16 v[212:215], a[96:99], a[24:27], v[212:215]
v_fmac_f32 v133, v49, v82
s_lshr_b32 s36, s79, 3
v_mfma_f32_16x16x32_bf16 v[216:219], a[104:107], a[24:27], v[216:219]
ds_read_b128 a[140:143], v5 offset:6144
v_fmac_f32 v136, v52, v82
v_mfma_f32_16x16x32_bf16 v[216:219], a[108:111], a[28:31], v[216:219]
buffer_load_dwordx4 a[72:75], v2, s[40:43], s35 offen offset:1024 sc1
s_and_b32 s79, s79, 7
v_mfma_f32_16x16x32_bf16 v[192:195], a[108:111], a[20:23], v[192:195]
ds_read_b128 a[144:147], v5 offset:1024
v_fmac_f32 v157, v49, v84
v_mfma_f32_16x16x32_bf16 v[192:195], a[104:107], a[16:19], v[192:195]
v_fmac_f32 v181, v49, v86
v_fmac_f32 v142, v58, v82
v_mfma_f32_16x16x32_bf16 v[168:171], a[104:107], a[8:11], v[168:171]
v_fmac_f32 v205, v49, v88
v_fmac_f32 v166, v58, v84
v_mfma_f32_16x16x32_bf16 v[168:171], a[108:111], a[12:15], v[168:171]
buffer_load_dwordx4 a[76:79], v2, s[40:43], s33 offen offset:1024 sc1
s_mul_i32 s36, s36, 524288
v_mfma_f32_16x16x32_bf16 v[144:147], a[108:111], a[4:7], v[144:147]
ds_read_b128 a[148:151], v5 offset:7168
v_fmac_f32 v209, v53, v88
v_mfma_f32_16x16x32_bf16 v[144:147], a[104:107], a[0:3], v[144:147]
v_fmac_f32 v190, v58, v86
s_lshl_b32 s79, s79, 14
v_mfma_f32_16x16x32_bf16 v[148:151], a[112:115], a[0:3], v[148:151]
v_fmac_f32 v185, v53, v86
v_fmac_f32 v214, v58, v88
v_mfma_f32_16x16x32_bf16 v[148:151], a[116:119], a[4:7], v[148:151]
buffer_load_dwordx4 a[80:83], v2, s[40:43], s35 offen offset:2048 sc1
s_add_u32 s79, s79, s36
v_mfma_f32_16x16x32_bf16 v[172:175], a[116:119], a[12:15], v[172:175]
v_fmac_f32 v161, v53, v84
v_fmac_f32 v218, v62, v88
v_mfma_f32_16x16x32_bf16 v[172:175], a[112:115], a[8:11], v[172:175]
s_and_b32 s36, s30, 1
s_lshl_b32 s36, s36, 12
s_add_u32 s79, s79, s36
v_mfma_f32_16x16x32_bf16 v[196:199], a[112:115], a[16:19], v[196:199]
v_fmac_f32 v137, v53, v82
v_fmac_f32 v194, v62, v86
v_mfma_f32_16x16x32_bf16 v[196:199], a[116:119], a[20:23], v[196:199]
buffer_load_dwordx4 a[84:87], v2, s[40:43], s33 offen offset:2048 sc1
s_lshr_b32 s39, s29, 2
v_mfma_f32_16x16x32_bf16 v[220:223], a[116:119], a[28:31], v[220:223]
v_fmac_f32 v170, v62, v84
v_fmac_f32 v143, v59, v82
v_mfma_f32_16x16x32_bf16 v[220:223], a[112:115], a[24:27], v[220:223]
s_mul_i32 s39, s39, 0xffff
s_waitcnt lgkmcnt(0)
v_mfma_f32_16x16x32_bf16 v[224:227], a[128:131], a[24:27], v[224:227]
ds_read_b128 a[96:99], v5 offset:14336
v_fmac_f32 v146, v62, v82
v_mfma_f32_16x16x32_bf16 v[224:227], a[132:135], a[28:31], v[224:227]
buffer_load_dwordx4 a[88:91], v2, s[40:43], s35 offen offset:3072 sc1
s_xor_b32 s39, s39, s51
v_mfma_f32_16x16x32_bf16 v[200:203], a[132:135], a[20:23], v[200:203]
ds_read_b128 a[100:103], v5 offset:20480
v_fmac_f32 v150, v66, v82
v_mfma_f32_16x16x32_bf16 v[200:203], a[128:131], a[16:19], v[200:203]
v_fmac_f32 v167, v59, v84
v_fmac_f32 v191, v59, v86
v_mfma_f32_16x16x32_bf16 v[176:179], a[128:131], a[8:11], v[176:179]
buffer_load_dwordx4 v1, s[4:7], s44 offen offset:0 sc1 lds
s_and_b32 s36, s29, 2
v_mfma_f32_16x16x32_bf16 v[176:179], a[132:135], a[12:15], v[176:179]
ds_read_b128 a[104:107], v5 offset:15360
v_fmac_f32 v174, v66, v84
v_mfma_f32_16x16x32_bf16 v[152:155], a[132:135], a[4:7], v[152:155]
v_fmac_f32 v198, v66, v86
v_fmac_f32 v215, v59, v88
v_mfma_f32_16x16x32_bf16 v[152:155], a[128:131], a[0:3], v[152:155]
buffer_load_dwordx4 v1, s[4:7], s44 offen offset:1024 sc1 lds
s_lshl_b32 s36, s36, 2
v_mfma_f32_16x16x32_bf16 v[132:135], a[136:139], a[0:3], v[132:135]
ds_read_b128 a[108:111], v5 offset:21504
v_fmac_f32 v222, v66, v88
v_mfma_f32_16x16x32_bf16 v[132:135], a[140:143], a[4:7], v[132:135]
v_fmac_f32 v219, v63, v88
v_fmac_f32 v195, v63, v86
v_mfma_f32_16x16x32_bf16 v[156:159], a[140:143], a[12:15], v[156:159]
ds_read_b128 a[112:115], v5 offset:16384
v_fmac_f32 v226, v70, v88
v_mfma_f32_16x16x32_bf16 v[156:159], a[136:139], a[8:11], v[156:159]
buffer_load_dwordx4 v1, s[4:7], s44 offen offset:2048 sc1 lds
s_lshr_b32 s36, s39, s36
v_mfma_f32_16x16x32_bf16 v[180:183], a[136:139], a[16:19], v[180:183]
v_fmac_f32 v202, v70, v86
v_fmac_f32 v171, v63, v84
v_mfma_f32_16x16x32_bf16 v[180:183], a[140:143], a[20:23], v[180:183]
ds_read_b128 a[116:119], v5 offset:22528
v_fmac_f32 v147, v63, v82
v_mfma_f32_16x16x32_bf16 v[204:207], a[140:143], a[28:31], v[204:207]
buffer_load_dwordx4 a[92:95], v2, s[40:43], s33 offen offset:3072 sc1
s_add_u32 s35, s35, 0x2000
v_mfma_f32_16x16x32_bf16 v[204:207], a[136:139], a[24:27], v[204:207]
s_add_u32 s33, s33, 0x2000
v_fmac_f32 v178, v70, v84
v_mfma_f32_16x16x32_bf16 v[208:211], a[144:147], a[24:27], v[208:211]
v_fmac_f32 v154, v70, v82
v_fmac_f32 v151, v67, v82
v_mfma_f32_16x16x32_bf16 v[208:211], a[148:151], a[28:31], v[208:211]
v_fmac_f32 v175, v67, v84
s_bfe_u32 s68, s36, 0x10001
v_mfma_f32_16x16x32_bf16 v[184:187], a[148:151], a[20:23], v[184:187]
buffer_load_dwordx4 v1, s[4:7], s44 offen offset:3072 sc1 lds
s_add_u32 m0, s19, 81920
v_mfma_f32_16x16x32_bf16 v[184:187], a[144:147], a[16:19], v[184:187]
s_xor_b32 s44, s84, 49152
v_fmac_f32 v134, v50, v82
v_mfma_f32_16x16x32_bf16 v[160:163], a[144:147], a[8:11], v[160:163]
v_fmac_f32 v158, v50, v84
v_fmac_f32 v199, v67, v86
v_mfma_f32_16x16x32_bf16 v[160:163], a[148:151], a[12:15], v[160:163]
buffer_load_dwordx4 v1, s[4:7], s44 offen offset:0 sc1 lds
s_lshl_b32 s68, s68, 13
v_mfma_f32_16x16x32_bf16 v[136:139], a[148:151], a[4:7], v[136:139]
v_fmac_f32 v182, v50, v86
v_fmac_f32 v223, v67, v88
v_mfma_f32_16x16x32_bf16 v[136:139], a[144:147], a[0:3], v[136:139]
s_waitcnt vmcnt(13) lgkmcnt(0)
s_barrier
v_mfma_f32_16x16x32_bf16 v[140:143], a[96:99], a[32:35], v[140:143]
ds_read_b128 a[128:131], v5 offset:17408
v_fmac_f32 v206, v50, v88
v_mfma_f32_16x16x32_bf16 v[140:143], a[100:103], a[36:39], v[140:143]
buffer_load_dwordx4 a[0:3], v2, s[40:43], s35 offen offset:0 sc1
s_bfe_u32 s10, s36, 0x10004
v_mfma_f32_16x16x32_bf16 v[164:167], a[100:103], a[44:47], v[164:167]
ds_read_b128 a[132:135], v5 offset:23552
v_fmac_f32 v210, v54, v88
v_mfma_f32_16x16x32_bf16 v[164:167], a[96:99], a[40:43], v[164:167]
v_fmac_f32 v227, v71, v88
v_fmac_f32 v203, v71, v86
v_mfma_f32_16x16x32_bf16 v[188:191], a[96:99], a[48:51], v[188:191]
buffer_load_dwordx4 a[4:7], v2, s[40:43], s33 offen offset:0 sc1
s_lshl_b32 s10, s10, 13
v_mfma_f32_16x16x32_bf16 v[188:191], a[100:103], a[52:55], v[188:191]
ds_read_b128 a[136:139], v5 offset:26624
v_fmac_f32 v186, v54, v86
v_mfma_f32_16x16x32_bf16 v[212:215], a[100:103], a[60:63], v[212:215]
v_fmac_f32 v162, v54, v84
v_fmac_f32 v179, v71, v84
v_mfma_f32_16x16x32_bf16 v[212:215], a[96:99], a[56:59], v[212:215]
buffer_load_dwordx4 a[8:11], v2, s[40:43], s35 offen offset:1024 sc1
s_bfe_u32 s75, s36, 0x10002
v_mfma_f32_16x16x32_bf16 v[216:219], a[104:107], a[56:59], v[216:219]
ds_read_b128 a[140:143], v5 offset:32768
v_fmac_f32 v138, v54, v82
v_mfma_f32_16x16x32_bf16 v[216:219], a[108:111], a[60:63], v[216:219]
v_fmac_f32 v155, v71, v82
v_fmac_f32 v135, v51, v82
v_mfma_f32_16x16x32_bf16 v[192:195], a[108:111], a[52:55], v[192:195]
buffer_load_dwordx4 a[12:15], v2, s[40:43], s33 offen offset:1024 sc1
s_lshl_b32 s75, s75, 13
v_mfma_f32_16x16x32_bf16 v[192:195], a[104:107], a[48:51], v[192:195]
ds_read_b128 a[144:147], v5 offset:27648
v_fmac_f32 v159, v51, v84
v_mfma_f32_16x16x32_bf16 v[168:171], a[104:107], a[40:43], v[168:171]
v_fmac_f32 v183, v51, v86
v_fmac_f32 v207, v51, v88
v_mfma_f32_16x16x32_bf16 v[168:171], a[108:111], a[44:47], v[168:171]
buffer_load_dwordx4 a[16:19], v2, s[40:43], s35 offen offset:2048 sc1
s_bfe_u32 s76, s36, 0x10003
v_mfma_f32_16x16x32_bf16 v[144:147], a[108:111], a[36:39], v[144:147]
ds_read_b128 a[148:151], v5 offset:33792
v_fmac_f32 v211, v55, v88
v_mfma_f32_16x16x32_bf16 v[144:147], a[104:107], a[32:35], v[144:147]
s_lshl_b32 s76, s76, 13
s_add_u32 s75, s75, s79
s_add_u32 s76, s76, s79
v_mfma_f32_16x16x32_bf16 v[148:151], a[112:115], a[32:35], v[148:151]
buffer_load_dwordx4 a[20:23], v2, s[40:43], s33 offen offset:2048 sc1
s_and_b32 s36, s31, 4
v_mfma_f32_16x16x32_bf16 v[148:151], a[116:119], a[36:39], v[148:151]
v_fmac_f32 v187, v55, v86
s_lshl_b32 s36, s36, 1
v_mfma_f32_16x16x32_bf16 v[172:175], a[116:119], a[44:47], v[172:175]
v_fmac_f32 v163, v55, v84
s_lshr_b32 s36, s39, s36
v_mfma_f32_16x16x32_bf16 v[172:175], a[112:115], a[40:43], v[172:175]
buffer_load_dwordx4 a[24:27], v2, s[40:43], s35 offen offset:3072 sc1
s_bfe_u32 s69, s36, 0x10001
v_mfma_f32_16x16x32_bf16 v[196:199], a[112:115], a[48:51], v[196:199]
v_fmac_f32 v139, v55, v82
s_lshl_b32 s69, s69, 13
v_mfma_f32_16x16x32_bf16 v[196:199], a[116:119], a[52:55], v[196:199]
s_bfe_u32 s45, s36, 0x10004
s_lshl_b32 s45, s45, 13
s_bfe_u32 s77, s36, 0x10002
v_mfma_f32_16x16x32_bf16 v[220:223], a[116:119], a[60:63], v[220:223]
buffer_load_dwordx4 a[28:31], v2, s[40:43], s33 offen offset:3072 sc1
s_add_u32 s35, s35, 0x2000
v_mfma_f32_16x16x32_bf16 v[220:223], a[112:115], a[56:59], v[220:223]
s_add_u32 s33, s33, 0x2000
s_waitcnt lgkmcnt(0)
v_mfma_f32_16x16x32_bf16 v[224:227], a[128:131], a[56:59], v[224:227]
ds_read_b128 a[96:99], v5 offset:28672
s_lshl_b32 s77, s77, 13
v_mfma_f32_16x16x32_bf16 v[224:227], a[132:135], a[60:63], v[224:227]
buffer_load_dwordx4 v1, s[4:7], s44 offen offset:1024 sc1 lds
s_bfe_u32 s9, s36, 0x10003
v_mfma_f32_16x16x32_bf16 v[200:203], a[132:135], a[52:55], v[200:203]
ds_read_b128 a[100:103], v5 offset:34816
s_lshl_b32 s9, s9, 13
v_mfma_f32_16x16x32_bf16 v[200:203], a[128:131], a[48:51], v[200:203]
s_lshr_b32 s38, s32, 3
s_and_b32 s36, s32, 7
s_mul_i32 s38, s38, 524288
v_mfma_f32_16x16x32_bf16 v[176:179], a[128:131], a[40:43], v[176:179]
s_lshl_b32 s36, s36, 14
s_add_u32 s36, s36, s38
s_add_u32 s45, s45, s36
v_mfma_f32_16x16x32_bf16 v[176:179], a[132:135], a[44:47], v[176:179]
ds_read_b128 a[104:107], v5 offset:29696
s_add_u32 s69, s69, s36
v_mfma_f32_16x16x32_bf16 v[152:155], a[132:135], a[36:39], v[152:155]
s_bfe_u32 s79, s39, 0x10008
s_lshl_b32 s79, s79, 13
s_xor_b32 s38, s29, s39
v_mfma_f32_16x16x32_bf16 v[152:155], a[128:131], a[32:35], v[152:155]
s_and_b32 s38, s38, 1
s_mul_i32 s38, s38, 0x102000
s_add_u32 s71, s71, s38
s_waitcnt vmcnt(21)
v_mfma_f32_16x16x32_bf16 v[140:143], a[136:139], a[64:67], v[140:143]
ds_read_b128 a[108:111], v5 offset:35840
s_add_u32 s34, s67, s38
s_waitcnt vmcnt(20)
v_mfma_f32_16x16x32_bf16 v[140:143], a[140:143], a[68:71], v[140:143]
buffer_load_dwordx4 v1, s[4:7], s44 offen offset:2048 sc1 lds
s_lshr_b32 s38, s31, 1
s_waitcnt vmcnt(19)
v_mfma_f32_16x16x32_bf16 v[164:167], a[140:143], a[76:79], v[164:167]
ds_read_b128 a[112:115], v5 offset:38912
s_xor_b32 s38, s38, s39
v_mfma_f32_16x16x32_bf16 v[164:167], a[136:139], a[72:75], v[164:167]
s_and_b32 s38, s38, 1
s_mul_i32 s38, s38, 0x102000
s_add_u32 s78, s78, s38
s_waitcnt vmcnt(18)
v_mfma_f32_16x16x32_bf16 v[188:191], a[136:139], a[80:83], v[188:191]
s_add_u32 s11, s66, s38
s_and_b32 s38, s30, 8
s_lshl_b32 s38, s38, 13
s_waitcnt vmcnt(17)
v_mfma_f32_16x16x32_bf16 v[188:191], a[140:143], a[84:87], v[188:191]
ds_read_b128 a[116:119], v5 offset:45056
s_and_b32 s36, s30, 16
s_waitcnt vmcnt(12)
v_mfma_f32_16x16x32_bf16 v[212:215], a[140:143], a[92:95], v[212:215]
s_lshl_b32 s36, s36, 15
s_add_u32 s38, s38, s36
s_add_u32 s77, s77, s38
v_mfma_f32_16x16x32_bf16 v[212:215], a[136:139], a[88:91], v[212:215]
s_add_u32 s9, s9, s38
s_lshl_b32 s38, s31, 1
s_lshr_b32 s90, s28, 1
v_mfma_f32_16x16x32_bf16 v[216:219], a[144:147], a[88:91], v[216:219]
s_add_u32 s38, s38, s90
s_lshl_b32 s90, s38, 13
s_sub_u32 s91, s79, s90
v_mfma_f32_16x16x32_bf16 v[216:219], a[148:151], a[92:95], v[216:219]
buffer_load_dwordx4 v1, s[4:7], s44 offen offset:3072 sc1 lds
s_and_b32 s38, s38, 15
v_mfma_f32_16x16x32_bf16 v[192:195], a[148:151], a[84:87], v[192:195]
s_lshl_b32 s90, s38, 14
s_add_u32 s91, s91, s90
s_and_b32 s90, s38, 12
v_mfma_f32_16x16x32_bf16 v[192:195], a[144:147], a[80:83], v[192:195]
s_add_u32 s38, s38, s90
s_lshl_b32 s38, s38, 17
s_and_b32 s90, s18, 0x800
v_mfma_f32_16x16x32_bf16 v[168:171], a[144:147], a[72:75], v[168:171]
s_add_u32 s38, s38, s90
s_lshl_b32 s39, s81, 2
s_add_u32 s39, s39, s28
v_mfma_f32_16x16x32_bf16 v[168:171], a[148:151], a[76:79], v[168:171]
s_lshl_b32 s82, s39, 14
v_mul_f32 v88, 0x3e8293ee, v89
v_mfma_f32_16x16x32_bf16 v[144:147], a[148:151], a[68:71], v[144:147]
s_add_u32 s82, s82, s79
s_and_b32 s90, s39, 12
s_add_u32 s39, s39, s90
v_mfma_f32_16x16x32_bf16 v[144:147], a[144:147], a[64:67], v[144:147]
s_lshl_b32 s39, s39, 17
s_waitcnt lgkmcnt(0)
v_mfma_f32_16x16x32_bf16 v[148:151], a[96:99], a[64:67], v[148:151]
ds_read_b128 a[128:131], v5 offset:39936
s_add_u32 s72, s75, 0x800000
v_mfma_f32_16x16x32_bf16 v[148:151], a[100:103], a[68:71], v[148:151]
buffer_store_dwordx4 a[220:223], v1, s[4:7], s101 offen offset:0 sc1
s_add_u32 s63, s83, 0x1780000
v_mfma_f32_16x16x32_bf16 v[172:175], a[100:103], a[76:79], v[172:175]
ds_read_b128 a[132:135], v5 offset:46080
s_sub_u32 s55, s63, 65536
v_mfma_f32_16x16x32_bf16 v[172:175], a[96:99], a[72:75], v[172:175]
s_bfe_u32 s36, s83, 0x5000d
s_lshl_b32 s36, s36, 14
s_and_b32 s83, s83, 0x1800
v_mfma_f32_16x16x32_bf16 v[196:199], a[96:99], a[80:83], v[196:199]
s_add_u32 s83, s83, s36
s_add_u32 s83, s83, s79
v_mfma_f32_16x16x32_bf16 v[196:199], a[100:103], a[84:87], v[196:199]
ds_read_b128 a[136:139], v5 offset:40960
v_add_u32 v233, s37, v1
v_mfma_f32_16x16x32_bf16 v[220:223], a[100:103], a[92:95], v[220:223]
v_add_u32 v232, s19, v7
v_mul_f32 v86, 0x3e8293ee, v87
v_mfma_f32_16x16x32_bf16 v[220:223], a[96:99], a[88:91], v[220:223]
v_mul_f32 v84, 0x3e8293ee, v85
v_mul_f32 v82, 0x3e8293ee, v83
v_mfma_f32_16x16x32_bf16 v[224:227], a[104:107], a[88:91], v[224:227]
ds_read_b128 a[140:143], v5 offset:47104
v_add_u32 v248, s19, v8
v_mfma_f32_16x16x32_bf16 v[224:227], a[108:111], a[92:95], v[224:227]
buffer_store_dwordx4 a[224:227], v1, s[4:7], s101 offen offset:1024 sc1
s_add_u32 s16, s97, 0
v_mfma_f32_16x16x32_bf16 v[200:203], a[108:111], a[84:87], v[200:203]
s_add_u32 s16, s16, s96
ds_read_b128 a[144:147], v5 offset:41984
v_mfma_f32_16x16x32_bf16 v[200:203], a[104:107], a[80:83], v[200:203]
v_add_u32 v253, s91, v253
v_add_u32 v4, s38, v1
v_mfma_f32_16x16x32_bf16 v[176:179], a[104:107], a[72:75], v[176:179]
v_add_u32 v2, s39, v1
v_mfma_f32_16x16x32_bf16 v[176:179], a[108:111], a[76:79], v[176:179]
ds_read_b128 a[148:151], v5 offset:48128
v_mfma_f32_16x16x32_bf16 v[152:155], a[108:111], a[68:71], v[152:155]
v_mfma_f32_16x16x32_bf16 v[152:155], a[104:107], a[64:67], v[152:155]
s_waitcnt vmcnt(12)
v_mfma_f32_16x16x32_bf16 v[140:143], a[112:115], a[0:3], v[140:143]
s_waitcnt vmcnt(11)
v_mfma_f32_16x16x32_bf16 v[140:143], a[116:119], a[4:7], v[140:143]
buffer_store_dwordx4 a[188:191], v1, s[4:7], s16 offen sc1
L_stub2:
s_cbranch_execz L_wret0
s_add_u32 s16, s97, 6144
s_waitcnt vmcnt(10)
v_mfma_f32_16x16x32_bf16 v[164:167], a[116:119], a[12:15], v[164:167]
s_add_u32 s16, s16, s96
v_mfma_f32_16x16x32_bf16 v[164:167], a[112:115], a[8:11], v[164:167]
s_waitcnt vmcnt(9)
v_mfma_f32_16x16x32_bf16 v[188:191], a[112:115], a[16:19], v[188:191]
s_waitcnt vmcnt(8)
v_mfma_f32_16x16x32_bf16 v[188:191], a[116:119], a[20:23], v[188:191]
s_waitcnt vmcnt(6)
v_mfma_f32_16x16x32_bf16 v[212:215], a[116:119], a[28:31], v[212:215]
v_mfma_f32_16x16x32_bf16 v[212:215], a[112:115], a[24:27], v[212:215]
s_waitcnt lgkmcnt(0)
v_mfma_f32_16x16x32_bf16 v[216:219], a[128:131], a[24:27], v[216:219]
ds_read_b128 a[96:99], v5 offset:12288
v_mul_f32 v140, v140, v83
v_mfma_f32_16x16x32_bf16 v[216:219], a[132:135], a[28:31], v[216:219]
buffer_store_dwordx4 a[192:195], v1, s[4:7], s16 offen sc1
s_add_u32 s16, s97, 1024
v_mfma_f32_16x16x32_bf16 v[192:195], a[132:135], a[20:23], v[192:195]
s_add_u32 s16, s16, s96
ds_read_b128 a[100:103], v5 offset:18432
v_mfma_f32_16x16x32_bf16 v[192:195], a[128:131], a[16:19], v[192:195]
v_mul_f32 v141, v141, v83
v_cvt_pk_bf16_f32 v140, v140, v141
v_mfma_f32_16x16x32_bf16 v[168:171], a[128:131], a[8:11], v[168:171]
v_mul_f32 v188, v188, v87
v_mul_f32 v189, v189, v87
v_mfma_f32_16x16x32_bf16 v[168:171], a[132:135], a[12:15], v[168:171]
ds_read_b128 a[104:107], v5 offset:24576
v_cvt_pk_bf16_f32 v188, v188, v189
v_mfma_f32_16x16x32_bf16 v[144:147], a[132:135], a[4:7], v[144:147]
v_mul_f32 v212, v212, v89
v_mul_f32 v213, v213, v89
v_mfma_f32_16x16x32_bf16 v[144:147], a[128:131], a[0:3], v[144:147]
v_mul_f32 v214, v214, v89
v_mul_f32 v215, v215, v89
v_mfma_f32_16x16x32_bf16 v[148:151], a[136:139], a[0:3], v[148:151]
ds_read_b128 a[108:111], v5 offset:30720
v_cvt_pk_bf16_f32 v212, v212, v213
v_mfma_f32_16x16x32_bf16 v[148:151], a[140:143], a[4:7], v[148:151]
buffer_store_dwordx4 a[196:199], v1, s[4:7], s16 offen sc1
s_add_u32 s16, s97, 7168
v_mfma_f32_16x16x32_bf16 v[172:175], a[140:143], a[12:15], v[172:175]
s_add_u32 s16, s16, s96
ds_read_b128 a[112:115], v5 offset:36864
v_mfma_f32_16x16x32_bf16 v[172:175], a[136:139], a[8:11], v[172:175]
v_mul_f32 v216, v216, v89
v_mul_f32 v217, v217, v89
v_mfma_f32_16x16x32_bf16 v[196:199], a[136:139], a[16:19], v[196:199]
v_mul_f32 v218, v218, v89
v_mul_f32 v219, v219, v89
v_mfma_f32_16x16x32_bf16 v[196:199], a[140:143], a[20:23], v[196:199]
ds_read_b128 a[116:119], v5 offset:43008
v_cvt_pk_bf16_f32 v213, v214, v215
v_mfma_f32_16x16x32_bf16 v[220:223], a[140:143], a[28:31], v[220:223]
v_cvt_pk_bf16_f32 v214, v216, v217
v_cvt_pk_bf16_f32 v215, v218, v219
v_mfma_f32_16x16x32_bf16 v[220:223], a[136:139], a[24:27], v[220:223]
v_min_u32 v212, -2, v212
v_min_u32 v213, -2, v213
v_mfma_f32_16x16x32_bf16 v[224:227], a[144:147], a[24:27], v[224:227]
v_min_u32 v214, -2, v214
v_min_u32 v215, -2, v215
v_mfma_f32_16x16x32_bf16 v[224:227], a[148:151], a[28:31], v[224:227]
buffer_store_dwordx4 a[200:203], v1, s[4:7], s16 offen sc1
s_add_u32 s16, s97, 2048
v_mfma_f32_16x16x32_bf16 v[200:203], a[148:151], a[20:23], v[200:203]
s_add_u32 s16, s16, s96
buffer_store_dwordx4 v[212:215], v3, s[4:7], s63 offen offset:0 sc1
v_mfma_f32_16x16x32_bf16 v[200:203], a[144:147], a[16:19], v[200:203]
v_mul_f32 v172, v172, v85
v_mul_f32 v173, v173, v85
v_mfma_f32_16x16x32_bf16 v[176:179], a[144:147], a[8:11], v[176:179]
v_cvt_pk_bf16_f32 v172, v172, v173
v_mul_f32 v196, v196, v87
v_mfma_f32_16x16x32_bf16 v[176:179], a[148:151], a[12:15], v[176:179]
v_mul_f32 v197, v197, v87
v_cvt_pk_bf16_f32 v196, v196, v197
v_mfma_f32_16x16x32_bf16 v[152:155], a[148:151], a[4:7], v[152:155]
v_mul_f32 v220, v220, v89
v_mul_f32 v221, v221, v89
v_mfma_f32_16x16x32_bf16 v[152:155], a[144:147], a[0:3], v[152:155]
v_mul_f32 v222, v222, v89
s_waitcnt lgkmcnt(0)
v_mfma_f32_16x16x32_bf16 v[132:135], a[96:99], a[32:35], v[132:135]
ds_read_b128 a[128:131], v5 offset:13312
v_mul_f32 v223, v223, v89
v_mfma_f32_16x16x32_bf16 v[132:135], a[100:103], a[36:39], v[132:135]
buffer_store_dwordx4 a[204:207], v1, s[4:7], s16 offen sc1
s_add_u32 s16, s97, 8192
v_mfma_f32_16x16x32_bf16 v[156:159], a[100:103], a[44:47], v[156:159]
s_add_u32 s16, s16, s96
ds_read_b128 a[132:135], v5 offset:19456
v_mfma_f32_16x16x32_bf16 v[156:159], a[96:99], a[40:43], v[156:159]
v_cvt_pk_bf16_f32 v220, v220, v221
v_mul_f32 v224, v224, v89
v_mfma_f32_16x16x32_bf16 v[180:183], a[96:99], a[48:51], v[180:183]
v_mul_f32 v225, v225, v89
v_mul_f32 v226, v226, v89
v_mfma_f32_16x16x32_bf16 v[180:183], a[100:103], a[52:55], v[180:183]
ds_read_b128 a[136:139], v5 offset:25600
v_mul_f32 v227, v227, v89
v_mfma_f32_16x16x32_bf16 v[204:207], a[100:103], a[60:63], v[204:207]
v_cvt_pk_bf16_f32 v221, v222, v223
v_cvt_pk_bf16_f32 v222, v224, v225
v_mfma_f32_16x16x32_bf16 v[204:207], a[96:99], a[56:59], v[204:207]
v_cvt_pk_bf16_f32 v223, v226, v227
v_min_u32 v220, -2, v220
v_mfma_f32_16x16x32_bf16 v[204:207], a[104:107], a[88:91], v[204:207]
ds_read_b128 a[140:143], v5 offset:31744
v_min_u32 v221, -2, v221
v_mfma_f32_16x16x32_bf16 v[204:207], a[108:111], a[92:95], v[204:207]
buffer_store_dwordx4 a[208:211], v1, s[4:7], s16 offen sc1
v_mfma_f32_16x16x32_bf16 v[180:183], a[108:111], a[84:87], v[180:183]
ds_read_b128 a[144:147], v5 offset:37888
v_min_u32 v222, -2, v222
v_mfma_f32_16x16x32_bf16 v[180:183], a[104:107], a[80:83], v[180:183]
v_min_u32 v223, -2, v223
v_mul_f32 v198, v198, v87
v_mfma_f32_16x16x32_bf16 v[156:159], a[104:107], a[72:75], v[156:159]
buffer_store_dwordx4 v[220:223], v3, s[4:7], s63 offen offset:1024 sc1
v_mfma_f32_16x16x32_bf16 v[156:159], a[108:111], a[76:79], v[156:159]
ds_read_b128 a[148:151], v5 offset:44032
v_mul_f32 v199, v199, v87
v_mfma_f32_16x16x32_bf16 v[132:135], a[108:111], a[68:71], v[132:135]
v_cvt_pk_bf16_f32 v197, v198, v199
v_mul_f32 v200, v200, v87
v_mfma_f32_16x16x32_bf16 v[132:135], a[104:107], a[64:67], v[132:135]
v_mul_f32 v201, v201, v87
v_cvt_pk_bf16_f32 v198, v200, v201
v_mfma_f32_16x16x32_bf16 v[132:135], a[112:115], a[0:3], v[132:135]
v_mul_f32 v202, v202, v87
v_mul_f32 v203, v203, v87
v_mfma_f32_16x16x32_bf16 v[132:135], a[116:119], a[4:7], v[132:135]
buffer_store_dwordx4 v[236:239], v254, s[4:7], s98 offen offset:0 sc1
v_mfma_f32_16x16x32_bf16 v[156:159], a[116:119], a[12:15], v[156:159]
v_cvt_pk_bf16_f32 v199, v202, v203
v_mul_f32 v174, v174, v85
v_mfma_f32_16x16x32_bf16 v[156:159], a[112:115], a[8:11], v[156:159]
v_mul_f32 v175, v175, v85
v_cvt_pk_bf16_f32 v173, v174, v175
v_mfma_f32_16x16x32_bf16 v[180:183], a[112:115], a[16:19], v[180:183]
v_mul_f32 v176, v176, v85
v_mul_f32 v177, v177, v85
v_mfma_f32_16x16x32_bf16 v[180:183], a[116:119], a[20:23], v[180:183]
v_cvt_pk_bf16_f32 v174, v176, v177
v_mul_f32 v178, v178, v85
v_mfma_f32_16x16x32_bf16 v[204:207], a[116:119], a[28:31], v[204:207]
v_mul_f32 v179, v179, v85
v_cvt_pk_bf16_f32 v175, v178, v179
v_mfma_f32_16x16x32_bf16 v[204:207], a[112:115], a[24:27], v[204:207]
s_waitcnt lgkmcnt(0)
s_barrier
v_mfma_f32_16x16x32_bf16 v[208:211], a[128:131], a[56:59], v[208:211]
ds_write_b128 v233, v[212:215] offset:21504
v_cvt_pk_bf16_f32 v132, v132, v133
v_mfma_f32_16x16x32_bf16 v[208:211], a[132:135], a[60:63], v[208:211]
buffer_store_dwordx4 v[240:243], v254, s[4:7], s98 offen offset:2048 sc1
v_mfma_f32_16x16x32_bf16 v[184:187], a[132:135], a[52:55], v[184:187]
ds_write_b64 v232, v[220:221] offset:4096
v_cvt_pk_bf16_f32 v156, v156, v157
v_mfma_f32_16x16x32_bf16 v[184:187], a[128:131], a[48:51], v[184:187]
ds_write_b64 v232, v[222:223] offset:4608
v_cvt_pk_bf16_f32 v133, v134, v135
v_mfma_f32_16x16x32_bf16 v[160:163], a[128:131], a[40:43], v[160:163]
ds_write_b64 v232, v[196:197] offset:3072
v_cvt_pk_bf16_f32 v180, v180, v181
v_mfma_f32_16x16x32_bf16 v[160:163], a[132:135], a[44:47], v[160:163]
ds_write_b64 v232, v[198:199] offset:3584
v_cvt_pk_bf16_f32 v157, v158, v159
v_mfma_f32_16x16x32_bf16 v[136:139], a[132:135], a[36:39], v[136:139]
ds_write_b64 v232, v[172:173] offset:2048
v_cvt_pk_bf16_f32 v204, v204, v205
v_mfma_f32_16x16x32_bf16 v[136:139], a[128:131], a[32:35], v[136:139]
ds_write_b64 v232, v[174:175] offset:2560
v_cvt_pk_bf16_f32 v181, v182, v183
v_mfma_f32_16x16x32_bf16 v[136:139], a[136:139], a[64:67], v[136:139]
v_cvt_pk_bf16_f32 v205, v206, v207
v_mul_f32 v148, v148, v83
v_mfma_f32_16x16x32_bf16 v[136:139], a[140:143], a[68:71], v[136:139]
v_mul_f32 v149, v149, v83
v_cvt_pk_bf16_f32 v148, v148, v149
v_mfma_f32_16x16x32_bf16 v[160:163], a[140:143], a[76:79], v[160:163]
v_mul_f32 v150, v150, v83
v_mul_f32 v151, v151, v83
v_mfma_f32_16x16x32_bf16 v[160:163], a[136:139], a[72:75], v[160:163]
v_cvt_pk_bf16_f32 v149, v150, v151
v_mul_f32 v152, v152, v83
v_mfma_f32_16x16x32_bf16 v[184:187], a[136:139], a[80:83], v[184:187]
ds_write_b64 v232, v[148:149] offset:1024
v_mul_f32 v153, v153, v83
v_mfma_f32_16x16x32_bf16 v[184:187], a[140:143], a[84:87], v[184:187]
buffer_store_dwordx4 v[244:247], v254, s[4:7], s99 offen offset:0 sc1
v_mfma_f32_16x16x32_bf16 v[208:211], a[140:143], a[92:95], v[208:211]
v_cvt_pk_bf16_f32 v150, v152, v153
v_mul_f32 v154, v154, v83
v_mfma_f32_16x16x32_bf16 v[208:211], a[136:139], a[88:91], v[208:211]
v_mul_f32 v155, v155, v83
v_cvt_pk_bf16_f32 v151, v154, v155
v_mfma_f32_16x16x32_bf16 v[208:211], a[144:147], a[24:27], v[208:211]
ds_write_b64 v232, v[150:151] offset:1536
v_mul_f32 v164, v164, v85
v_mfma_f32_16x16x32_bf16 v[208:211], a[148:151], a[28:31], v[208:211]
v_mul_f32 v165, v165, v85
v_cvt_pk_bf16_f32 v164, v164, v165
v_mfma_f32_16x16x32_bf16 v[184:187], a[148:151], a[20:23], v[184:187]
v_mul_f32 v190, v190, v87
v_mul_f32 v191, v191, v87
v_mfma_f32_16x16x32_bf16 v[184:187], a[144:147], a[16:19], v[184:187]
v_cvt_pk_bf16_f32 v189, v190, v191
v_mul_f32 v166, v166, v85
v_mfma_f32_16x16x32_bf16 v[160:163], a[144:147], a[8:11], v[160:163]
v_mul_f32 v167, v167, v85
v_cvt_pk_bf16_f32 v165, v166, v167
v_mfma_f32_16x16x32_bf16 v[160:163], a[148:151], a[12:15], v[160:163]
v_mul_f32 v142, v142, v83
v_mul_f32 v143, v143, v83
v_mfma_f32_16x16x32_bf16 v[136:139], a[148:151], a[4:7], v[136:139]
v_cvt_pk_bf16_f32 v141, v142, v143
v_mul_f32 v192, v192, v87
v_mfma_f32_16x16x32_bf16 v[136:139], a[144:147], a[0:3], v[136:139]
v_mul_f32 v193, v193, v87
v_cvt_pk_bf16_f32 v190, v192, v193
s_add_u32 m0, s19, 32768
s_xor_b32 s44, s84, 0
buffer_load_dwordx4 v1, s[4:7], s44 offen offset:0 sc1 lds
v_pk_mul_f32 v[194:195], v[194:195], v[86:87] op_sel:[0,1] op_sel_hi:[1,1]
v_pk_mul_f32 v[168:169], v[168:169], v[84:85] op_sel:[0,1] op_sel_hi:[1,1]
v_pk_mul_f32 v[170:171], v[170:171], v[84:85] op_sel:[0,1] op_sel_hi:[1,1]
v_pk_mul_f32 v[144:145], v[144:145], v[82:83] op_sel:[0,1] op_sel_hi:[1,1]
v_pk_mul_f32 v[146:147], v[146:147], v[82:83] op_sel:[0,1] op_sel_hi:[1,1]
v_cvt_pk_bf16_f32 v191, v194, v195
v_cvt_pk_bf16_f32 v166, v168, v169
v_cvt_pk_bf16_f32 v167, v170, v171
v_cvt_pk_bf16_f32 v142, v144, v145
v_cvt_pk_bf16_f32 v143, v146, v147
v_cvt_pk_bf16_f32 v134, v136, v137
v_cvt_pk_bf16_f32 v135, v138, v139
v_cvt_pk_bf16_f32 v158, v160, v161
v_cvt_pk_bf16_f32 v159, v162, v163
v_cvt_pk_bf16_f32 v182, v184, v185
v_cvt_pk_bf16_f32 v183, v186, v187
v_cvt_pk_bf16_f32 v206, v208, v209
v_cvt_pk_bf16_f32 v207, v210, v211
buffer_load_dwordx4 v1, s[4:7], s44 offen offset:1024 sc1 lds
buffer_load_dwordx4 v1, s[4:7], s44 offen offset:2048 sc1 lds
buffer_load_dwordx4 v1, s[4:7], s44 offen offset:3072 sc1 lds
s_add_u32 m0, s19, 98304
s_xor_b32 s44, s84, 65536
buffer_load_dwordx4 v1, s[4:7], s44 offen offset:0 sc1 lds
buffer_load_dwordx4 v1, s[4:7], s44 offen offset:1024 sc1 lds
buffer_load_dwordx4 v1, s[4:7], s44 offen offset:2048 sc1 lds
buffer_load_dwordx4 v1, s[4:7], s44 offen offset:3072 sc1 lds
s_waitcnt lgkmcnt(0)
s_barrier
s_add_u32 m0, s19, 114688
s_xor_b32 s44, s84, 81920
buffer_load_dwordx4 v1, s[4:7], s44 offen offset:0 sc1 lds
v_mfma_f32_16x16x32_bf16 v[208:211], v[188:191], v[204:207], v[20:23]
ds_read_b64_tr_b16 a[10:11], v248 offset:3072
v_mfma_f32_16x16x32_bf16 v[224:227], v[212:215], v[204:207], v[24:27]
ds_read_b64_tr_b16 a[12:13], v248 offset:4096
v_mfma_f32_16x16x32_bf16 v[160:163], v[140:143], v[156:159], v[20:23]
ds_read_b64_tr_b16 a[22:23], v248 offset:3584
v_mfma_f32_16x16x32_bf16 v[176:179], v[164:167], v[156:159], v[24:27]
s_nop 3
v_max_f32 v224, v224, v208
v_max_f32 v225, v225, v209
v_max_f32 v226, v226, v210
v_max_f32 v227, v227, v211
v_max3_f32 v239, v224, v225, v226
v_max_f32 v239, v239, v227
ds_read_b64_tr_b16 a[24:25], v248 offset:4608
v_max_f32 v176, v176, v160
v_max_f32 v177, v177, v161
v_max_f32 v178, v178, v162
v_max_f32 v179, v179, v163
v_max3_f32 v237, v176, v177, v178
buffer_load_dwordx4 v1, s[4:7], s44 offen offset:1024 sc1 lds
v_max_f32 v237, v237, v179
ds_read_b64_tr_b16 a[6:7], v248 offset:1024
s_nop 0
v_permlane32_swap_b32 v239, v237
v_max_f32 v239, v239, v237
v_mov_b32 v242, v239
ds_read_b64_tr_b16 a[8:9], v248 offset:2048
s_nop 0
v_permlane16_swap_b32 v239, v242
v_max_f32 v239, v239, v242
v_mov_b32 v242, v239
ds_read_b64_tr_b16 a[18:19], v248 offset:1536
s_nop 0
v_permlane32_swap_b32 v239, v242
v_mul_f32_e64 v89, -v239, v88
v_fma_f32 v224, v224, v88, v89
v_fma_f32 v225, v225, v88, v89
v_fma_f32 v226, v226, v88, v89
v_fma_f32 v227, v227, v88, v89
buffer_load_dwordx4 v[228:231], v9, s[4:7], s55 offen sc1
buffer_load_dwordx4 v[72:75], v9, s[4:7], s55 offen offset:1024 sc1
v_exp_f32 v224, v224
v_exp_f32 v225, v225
v_exp_f32 v226, v226
buffer_load_dwordx4 v1, s[4:7], s44 offen offset:2048 sc1 lds
v_exp_f32 v227, v227
v_cvt_pk_bf16_f32 v224, v224, v225
v_cvt_pk_bf16_f32 v225, v226, v227
ds_read_b64_tr_b16 a[20:21], v248 offset:2560
v_and_b32 v208, v224, v28
v_and_b32 v209, v225, v29
v_and_b32 v210, v224, v30
v_and_b32 v211, v225, v31
v_mul_f32_e64 v85, -v242, v84
v_fma_f32 v176, v176, v84, v85
v_mfma_f32_16x16x32_bf16 v[216:219], v[16:19], v[208:211], 0
v_fma_f32 v177, v177, v84, v85
v_fma_f32 v178, v178, v84, v85
s_waitcnt lgkmcnt(6)
v_mfma_f32_16x16x32_bf16 v[116:119], a[10:13], v[208:211], 0
v_fma_f32 v179, v179, v84, v85
v_exp_f32 v176, v176
s_waitcnt lgkmcnt(4)
v_mfma_f32_16x16x32_bf16 v[120:123], a[22:25], v[208:211], 0
v_exp_f32 v177, v177
v_exp_f32 v178, v178
buffer_load_dwordx4 v1, s[4:7], s44 offen offset:3072 sc1 lds
v_exp_f32 v179, v179
v_rcp_f32 v216, v216
v_cvt_pk_bf16_f32 v176, v176, v177
v_cvt_pk_bf16_f32 v177, v178, v179
v_and_b32 v160, v176, v28
v_and_b32 v161, v177, v29
v_and_b32 v162, v176, v30
v_and_b32 v163, v177, v31
v_pk_mul_f32 v[116:117], v[116:117], v[216:217] op_sel:[0,0] op_sel_hi:[1,0]
v_cvt_pk_bf16_f32 v116, v116, v117
v_pk_mul_f32 v[118:119], v[118:119], v[216:217] op_sel:[0,0] op_sel_hi:[1,0]
v_cvt_pk_bf16_f32 v117, v118, v119
v_pk_mul_f32 v[120:121], v[120:121], v[216:217] op_sel:[0,0] op_sel_hi:[1,0]
v_cvt_pk_bf16_f32 v118, v120, v121
v_pk_mul_f32 v[122:123], v[122:123], v[216:217] op_sel:[0,0] op_sel_hi:[1,0]
v_cvt_pk_bf16_f32 v119, v122, v123
v_mfma_f32_16x16x32_bf16 v[168:171], v[16:19], v[160:163], 0
s_waitcnt lgkmcnt(2)
v_mfma_f32_16x16x32_bf16 v[100:103], a[6:9], v[160:163], 0
s_waitcnt lgkmcnt(0)
v_mfma_f32_16x16x32_bf16 v[104:107], a[18:21], v[160:163], 0
buffer_store_dwordx4 v[116:119], v2, s[4:7], s72 offen offset:3072 sc1
v_mfma_f32_16x16x32_bf16 v[184:187], v[164:167], v[180:183], v[20:23]
s_nop 1
v_rcp_f32 v168, v168
v_mfma_f32_16x16x32_bf16 v[200:203], v[188:191], v[180:183], v[24:27]
v_pk_mul_f32 v[100:101], v[100:101], v[168:169] op_sel:[0,0] op_sel_hi:[1,0]
v_pk_mul_f32 v[102:103], v[102:103], v[168:169] op_sel:[0,0] op_sel_hi:[1,0]
v_cvt_pk_bf16_f32 v100, v100, v101
v_pk_mul_f32 v[104:105], v[104:105], v[168:169] op_sel:[0,0] op_sel_hi:[1,0]
v_pk_mul_f32 v[106:107], v[106:107], v[168:169] op_sel:[0,0] op_sel_hi:[1,0]
v_cvt_pk_bf16_f32 v101, v102, v103
v_cvt_pk_bf16_f32 v102, v104, v105
v_cvt_pk_bf16_f32 v103, v106, v107
v_max_f32 v200, v200, v184
v_max_f32 v201, v201, v185
v_max_f32 v202, v202, v186
buffer_store_dwordx4 v[100:103], v2, s[4:7], s72 offen offset:1024 sc1
v_max_f32 v203, v203, v187
v_max3_f32 v238, v200, v201, v202
v_max_f32 v238, v238, v203
s_cmp_lg_u32 s28, 0
s_cbranch_scc1 Lhx_7
s_waitcnt vmcnt(5)
v_max3_u32 v244, v228, v229, v230
s_waitcnt vmcnt(4)
v_max3_u32 v244, v244, v231, v72
v_max3_u32 v244, v244, v73, v74
v_max_u32 v244, v244, v75
v_cmp_eq_u32 vcc, -1, v244
s_cbranch_vccnz L_hxredo0
L_hxback0:
ds_write_b128 v233, v[228:231] offset:20480
ds_write_b64 v232, v[72:73] offset:0
ds_write_b64 v232, v[74:75] offset:512
Lhx_7:
ds_read_b128 a[0:3], v233 offset:20480
v_mfma_f32_16x16x32_bf16 v[152:155], v[140:143], v[132:135], v[24:27]
ds_read_b64_tr_b16 a[4:5], v248 offset:0
ds_read_b64_tr_b16 a[16:17], v248 offset:512
s_waitcnt lgkmcnt(2)
v_mfma_f32_16x16x32_bf16 v[136:139], a[0:3], v[132:135], v[76:79]
s_nop 7
v_max_f32 v152, v152, v136
v_max_f32 v153, v153, v137
v_max_f32 v154, v154, v138
v_max_f32 v155, v155, v139
v_max3_f32 v236, v152, v153, v154
v_max_f32 v236, v236, v155
s_nop 1
v_permlane32_swap_b32 v238, v236
v_max_f32 v238, v238, v236
v_mov_b32 v243, v238
s_nop 1
v_permlane16_swap_b32 v238, v243
v_max_f32 v238, v238, v243
v_mov_b32 v243, v238
s_nop 1
v_permlane32_swap_b32 v238, v243
v_mul_f32_e64 v87, -v238, v86
v_fma_f32 v200, v200, v86, v87
v_fma_f32 v201, v201, v86, v87
v_fma_f32 v202, v202, v86, v87
v_fma_f32 v203, v203, v86, v87
v_exp_f32 v200, v200
v_exp_f32 v201, v201
v_exp_f32 v202, v202
v_exp_f32 v203, v203
v_cvt_pk_bf16_f32 v200, v200, v201
v_cvt_pk_bf16_f32 v201, v202, v203
v_and_b32 v184, v200, v28
v_and_b32 v185, v201, v29
v_and_b32 v186, v200, v30
v_and_b32 v187, v201, v31
v_mul_f32_e64 v83, -v243, v82
v_fma_f32 v152, v152, v82, v83
v_mfma_f32_16x16x32_bf16 v[192:195], v[16:19], v[184:187], 0
v_fma_f32 v153, v153, v82, v83
v_fma_f32 v154, v154, v82, v83
v_mfma_f32_16x16x32_bf16 v[108:111], a[8:11], v[184:187], 0
v_fma_f32 v155, v155, v82, v83
v_exp_f32 v152, v152
v_mfma_f32_16x16x32_bf16 v[112:115], a[20:23], v[184:187], 0
v_exp_f32 v153, v153
v_exp_f32 v154, v154
v_exp_f32 v155, v155
v_rcp_f32 v192, v192
v_cvt_pk_bf16_f32 v152, v152, v153
v_cvt_pk_bf16_f32 v153, v154, v155
v_and_b32 v136, v152, v80
v_and_b32 v137, v153, v81
v_and_b32 v138, v152, v30
v_and_b32 v139, v153, v31
v_pk_mul_f32 v[108:109], v[108:109], v[192:193] op_sel:[0,0] op_sel_hi:[1,0]
v_pk_mul_f32 v[110:111], v[110:111], v[192:193] op_sel:[0,0] op_sel_hi:[1,0]
v_cvt_pk_bf16_f32 v108, v108, v109
v_pk_mul_f32 v[112:113], v[112:113], v[192:193] op_sel:[0,0] op_sel_hi:[1,0]
v_cvt_pk_bf16_f32 v109, v110, v111
v_pk_mul_f32 v[114:115], v[114:115], v[192:193] op_sel:[0,0] op_sel_hi:[1,0]
v_cvt_pk_bf16_f32 v110, v112, v113
v_mfma_f32_16x16x32_bf16 v[144:147], v[16:19], v[136:139], 0
v_cvt_pk_bf16_f32 v111, v114, v115
buffer_store_dwordx4 v[108:111], v2, s[4:7], s72 offen offset:2048 sc1
s_waitcnt lgkmcnt(1)
v_mfma_f32_16x16x32_bf16 v[92:95], a[4:7], v[136:139], 0
s_nop 3
v_rcp_f32 v144, v144
s_waitcnt lgkmcnt(0)
v_mfma_f32_16x16x32_bf16 v[96:99], a[16:19], v[136:139], 0
s_nop 0
v_pk_mul_f32 v[92:93], v[92:93], v[144:145] op_sel:[0,0] op_sel_hi:[1,0]
v_pk_mul_f32 v[94:95], v[94:95], v[144:145] op_sel:[0,0] op_sel_hi:[1,0]
v_cvt_pk_bf16_f32 v92, v92, v93
v_cvt_pk_bf16_f32 v93, v94, v95
s_nop 2
v_pk_mul_f32 v[96:97], v[96:97], v[144:145] op_sel:[0,0] op_sel_hi:[1,0]
v_pk_mul_f32 v[98:99], v[98:99], v[144:145] op_sel:[0,0] op_sel_hi:[1,0]
v_cvt_pk_bf16_f32 v94, v96, v97
v_cvt_pk_bf16_f32 v95, v98, v99
buffer_store_dwordx4 v[92:95], v2, s[4:7], s72 offen offset:0 sc1
s_add_u32 s92, s71, 0x0
v_accvgpr_write_b32 a188, v48
v_accvgpr_write_b32 a189, v49
v_accvgpr_write_b32 a190, v50
v_accvgpr_write_b32 a191, v51
v_accvgpr_write_b32 a192, v52
v_accvgpr_write_b32 a193, v53
v_accvgpr_write_b32 a194, v54
v_accvgpr_write_b32 a195, v55
v_accvgpr_write_b32 a196, v56
v_accvgpr_write_b32 a197, v57
v_accvgpr_write_b32 a198, v58
v_accvgpr_write_b32 a199, v59
v_accvgpr_write_b32 a200, v60
v_accvgpr_write_b32 a201, v61
v_accvgpr_write_b32 a202, v62
v_accvgpr_write_b32 a203, v63
v_accvgpr_write_b32 a204, v64
v_accvgpr_write_b32 a205, v65
v_accvgpr_write_b32 a206, v66
v_accvgpr_write_b32 a207, v67
v_accvgpr_write_b32 a208, v68
v_accvgpr_write_b32 a209, v69
v_accvgpr_write_b32 a210, v70
v_accvgpr_write_b32 a211, v71
s_add_u32 s40, s4, 0x800000
s_addc_u32 s41, s5, 0
v_add_u32 v5, 32768, v1
v_add_u32 v6, 98304, v1
s_mov_b32 s35, s77
v_lshlrev_b32 v132, 16, v32
v_and_b32 v133, 0xffff0000, v32
v_lshlrev_b32 v134, 16, v33
v_and_b32 v135, 0xffff0000, v33
v_lshlrev_b32 v136, 16, v34
v_and_b32 v137, 0xffff0000, v34
v_lshlrev_b32 v138, 16, v35
v_and_b32 v139, 0xffff0000, v35
v_lshlrev_b32 v140, 16, v36
v_and_b32 v141, 0xffff0000, v36
v_lshlrev_b32 v142, 16, v37
v_and_b32 v143, 0xffff0000, v37
v_lshlrev_b32 v144, 16, v38
v_and_b32 v145, 0xffff0000, v38
v_lshlrev_b32 v146, 16, v39
v_and_b32 v147, 0xffff0000, v39
v_lshlrev_b32 v148, 16, v40
v_and_b32 v149, 0xffff0000, v40
v_lshlrev_b32 v150, 16, v41
v_and_b32 v151, 0xffff0000, v41
v_lshlrev_b32 v152, 16, v42
v_and_b32 v153, 0xffff0000, v42
v_lshlrev_b32 v154, 16, v43
v_and_b32 v155, 0xffff0000, v43
v_lshlrev_b32 v156, 16, v44
v_and_b32 v157, 0xffff0000, v44
v_lshlrev_b32 v158, 16, v45
v_and_b32 v159, 0xffff0000, v45
v_lshlrev_b32 v160, 16, v46
v_and_b32 v161, 0xffff0000, v46
v_lshlrev_b32 v162, 16, v47
v_and_b32 v163, 0xffff0000, v47
s_waitcnt vmcnt(0)
s_barrier
s_cmp_lg_u32 s28, 0
s_cbranch_scc1 Lsg_8
buffer_atomic_add v12, v10, s[4:7], s92 offen sc1
buffer_atomic_swap v15, v14, s[4:7], s8 offen sc1
buffer_atomic_swap v15, v252, s[4:7], s62 offen offset:64 sc1
Lsg_8:
s_add_u32 m0, s19, 131072
s_xor_b32 s44, s84, 98304
buffer_load_dwordx4 v1, s[4:7], s44 offen offset:0 sc1 lds
buffer_load_dwordx4 v1, s[4:7], s44 offen offset:1024 sc1 lds
buffer_load_dwordx4 v1, s[4:7], s44 offen offset:2048 sc1 lds
buffer_load_dwordx4 v1, s[4:7], s44 offen offset:3072 sc1 lds
s_add_u32 m0, s19, 147456
s_xor_b32 s44, s84, 114688
buffer_load_dwordx4 v1, s[4:7], s44 offen offset:0 sc1 lds
buffer_load_dwordx4 v1, s[4:7], s44 offen offset:1024 sc1 lds
buffer_load_dwordx4 v1, s[4:7], s44 offen offset:2048 sc1 lds
buffer_load_dwordx4 v1, s[4:7], s44 offen offset:3072 sc1 lds
s_mov_b64 exec, 0
s_cmp_eq_u32 s28, 3
s_cbranch_scc1 L_stub3
s_cmp_eq_u32 s28, 2
s_cbranch_scc1 L_stub4
s_cmp_eq_u32 s28, 0
s_cbranch_scc1 L_stub8
L_wret1:
s_mov_b64 exec, -1
s_cmp_lg_u32 s28, 1
s_cbranch_scc1 Lpo_11
s_add_u32 s36, s11, 0x0
s_mov_b32 s37, 0
v_mov_b32 v11, 0
buffer_atomic_add v11, v251, s[4:7], s36 offen sc0 sc1
s_sleep 4
Lpoll_9:
v_mov_b32 v234, 0
buffer_atomic_add v234, v251, s[4:7], s36 offen sc0 sc1
s_waitcnt vmcnt(1)
v_readfirstlane_b32 s38, v11
s_nop 0
s_cmp_ge_u32 s38, 32
s_cbranch_scc1 Lpe_10
v_mov_b32 v11, 0
buffer_atomic_add v11, v251, s[4:7], s36 offen sc0 sc1
s_waitcnt vmcnt(1)
v_readfirstlane_b32 s38, v234
s_nop 0
s_cmp_ge_u32 s38, 32
s_cbranch_scc1 Lpe_10
s_add_u32 s37, s37, 1
s_cmp_lt_u32 s37, 0x80000
s_cbranch_scc1 Lpoll_9
s_waitcnt vmcnt(0)
Lpo_11:
s_waitcnt vmcnt(0)
Lpe_10:
s_barrier
L_k2go0:
buffer_load_dwordx4 a[0:3], v4, s[40:43], s35 offen offset:0 sc1
buffer_load_dwordx4 a[4:7], v4, s[40:43], s35 offen offset:1024 sc1
s_xor_b32 s35, s77, 4096
buffer_load_dwordx4 a[8:11], v4, s[40:43], s35 offen offset:0 sc1
buffer_load_dwordx4 a[12:15], v4, s[40:43], s35 offen offset:1024 sc1
s_xor_b32 s35, s77, 16384
buffer_load_dwordx4 a[16:19], v4, s[40:43], s35 offen offset:0 sc1
buffer_load_dwordx4 a[20:23], v4, s[40:43], s35 offen offset:1024 sc1
s_xor_b32 s35, s77, 20480
buffer_load_dwordx4 a[24:27], v4, s[40:43], s35 offen offset:0 sc1
buffer_load_dwordx4 a[28:31], v4, s[40:43], s35 offen offset:1024 sc1
s_xor_b32 s35, s77, 32768
buffer_load_dwordx4 a[32:35], v4, s[40:43], s35 offen offset:0 sc1
buffer_load_dwordx4 a[36:39], v4, s[40:43], s35 offen offset:1024 sc1
s_xor_b32 s35, s77, 36864
buffer_load_dwordx4 a[40:43], v4, s[40:43], s35 offen offset:0 sc1
buffer_load_dwordx4 a[44:47], v4, s[40:43], s35 offen offset:1024 sc1
s_xor_b32 s35, s77, 49152
ds_read_b128 a[96:99], v5 offset:0
ds_read_b128 a[100:103], v5 offset:1024
ds_read_b128 a[104:107], v5 offset:2048
ds_read_b128 a[108:111], v5 offset:3072
ds_read_b128 a[112:115], v5 offset:4096
ds_read_b128 a[116:119], v5 offset:5120
ds_read_b128 a[120:123], v5 offset:6144
ds_read_b128 a[124:127], v5 offset:7168
s_waitcnt vmcnt(10) lgkmcnt(4)
v_mfma_f32_16x16x32_bf16 v[132:135], a[96:99], a[0:3], v[132:135]
ds_read_b128 a[128:131], v5 offset:8192
v_mfma_f32_16x16x32_bf16 v[148:151], a[96:99], a[4:7], v[148:151]
ds_read_b128 a[132:135], v5 offset:9216
v_mfma_f32_16x16x32_bf16 v[152:155], a[100:103], a[4:7], v[152:155]
buffer_load_dwordx4 a[48:51], v4, s[40:43], s35 offen offset:0 sc1
v_mfma_f32_16x16x32_bf16 v[136:139], a[100:103], a[0:3], v[136:139]
ds_read_b128 a[136:139], v5 offset:10240
v_mfma_f32_16x16x32_bf16 v[140:143], a[104:107], a[0:3], v[140:143]
ds_read_b128 a[140:143], v5 offset:11264
v_mfma_f32_16x16x32_bf16 v[156:159], a[104:107], a[4:7], v[156:159]
v_mfma_f32_16x16x32_bf16 v[160:163], a[108:111], a[4:7], v[160:163]
buffer_load_dwordx4 a[52:55], v4, s[40:43], s35 offen offset:1024 sc1
s_xor_b32 s35, s77, 53248
v_mfma_f32_16x16x32_bf16 v[144:147], a[108:111], a[0:3], v[144:147]
s_waitcnt vmcnt(10) lgkmcnt(4)
v_mfma_f32_16x16x32_bf16 v[132:135], a[112:115], a[8:11], v[132:135]
ds_read_b128 a[96:99], v5 offset:12288
v_mfma_f32_16x16x32_bf16 v[148:151], a[112:115], a[12:15], v[148:151]
L_stub3:
s_cbranch_execz L_wret1
ds_read_b128 a[100:103], v5 offset:13312
v_mfma_f32_16x16x32_bf16 v[152:155], a[116:119], a[12:15], v[152:155]
buffer_load_dwordx4 a[0:3], v4, s[40:43], s35 offen offset:0 sc1
v_mfma_f32_16x16x32_bf16 v[136:139], a[116:119], a[8:11], v[136:139]
ds_read_b128 a[104:107], v5 offset:14336
v_mfma_f32_16x16x32_bf16 v[140:143], a[120:123], a[8:11], v[140:143]
ds_read_b128 a[108:111], v5 offset:15360
v_mfma_f32_16x16x32_bf16 v[156:159], a[120:123], a[12:15], v[156:159]
v_mfma_f32_16x16x32_bf16 v[160:163], a[124:127], a[12:15], v[160:163]
buffer_load_dwordx4 a[4:7], v4, s[40:43], s35 offen offset:1024 sc1
s_xor_b32 s35, s77, 65536
v_mfma_f32_16x16x32_bf16 v[144:147], a[124:127], a[8:11], v[144:147]
s_waitcnt vmcnt(10) lgkmcnt(4)
v_mfma_f32_16x16x32_bf16 v[132:135], a[128:131], a[16:19], v[132:135]
ds_read_b128 a[112:115], v5 offset:16384
v_mfma_f32_16x16x32_bf16 v[148:151], a[128:131], a[20:23], v[148:151]
ds_read_b128 a[116:119], v5 offset:17408
v_mfma_f32_16x16x32_bf16 v[152:155], a[132:135], a[20:23], v[152:155]
buffer_load_dwordx4 a[8:11], v4, s[40:43], s35 offen offset:0 sc1
v_mfma_f32_16x16x32_bf16 v[136:139], a[132:135], a[16:19], v[136:139]
ds_read_b128 a[120:123], v5 offset:18432
v_mfma_f32_16x16x32_bf16 v[140:143], a[136:139], a[16:19], v[140:143]
ds_read_b128 a[124:127], v5 offset:19456
v_mfma_f32_16x16x32_bf16 v[156:159], a[136:139], a[20:23], v[156:159]
v_mfma_f32_16x16x32_bf16 v[160:163], a[140:143], a[20:23], v[160:163]
buffer_load_dwordx4 a[12:15], v4, s[40:43], s35 offen offset:1024 sc1
s_xor_b32 s35, s77, 69632
v_mfma_f32_16x16x32_bf16 v[144:147], a[140:143], a[16:19], v[144:147]
s_waitcnt vmcnt(10) lgkmcnt(4)
v_mfma_f32_16x16x32_bf16 v[132:135], a[96:99], a[24:27], v[132:135]
ds_read_b128 a[128:131], v5 offset:20480
v_mfma_f32_16x16x32_bf16 v[148:151], a[96:99], a[28:31], v[148:151]
ds_read_b128 a[132:135], v5 offset:21504
v_mfma_f32_16x16x32_bf16 v[152:155], a[100:103], a[28:31], v[152:155]
buffer_load_dwordx4 a[16:19], v4, s[40:43], s35 offen offset:0 sc1
v_mfma_f32_16x16x32_bf16 v[136:139], a[100:103], a[24:27], v[136:139]
ds_read_b128 a[136:139], v5 offset:22528
v_mfma_f32_16x16x32_bf16 v[140:143], a[104:107], a[24:27], v[140:143]
ds_read_b128 a[140:143], v5 offset:23552
v_mfma_f32_16x16x32_bf16 v[156:159], a[104:107], a[28:31], v[156:159]
v_mfma_f32_16x16x32_bf16 v[160:163], a[108:111], a[28:31], v[160:163]
buffer_load_dwordx4 a[20:23], v4, s[40:43], s35 offen offset:1024 sc1
s_xor_b32 s35, s77, 81920
v_mfma_f32_16x16x32_bf16 v[144:147], a[108:111], a[24:27], v[144:147]
s_waitcnt vmcnt(10) lgkmcnt(4)
v_mfma_f32_16x16x32_bf16 v[132:135], a[112:115], a[32:35], v[132:135]
ds_read_b128 a[96:99], v5 offset:24576
v_mfma_f32_16x16x32_bf16 v[148:151], a[112:115], a[36:39], v[148:151]
ds_read_b128 a[100:103], v5 offset:25600
v_mfma_f32_16x16x32_bf16 v[152:155], a[116:119], a[36:39], v[152:155]
buffer_load_dwordx4 a[24:27], v4, s[40:43], s35 offen offset:0 sc1
v_mfma_f32_16x16x32_bf16 v[136:139], a[116:119], a[32:35], v[136:139]
ds_read_b128 a[104:107], v5 offset:26624
v_mfma_f32_16x16x32_bf16 v[140:143], a[120:123], a[32:35], v[140:143]
ds_read_b128 a[108:111], v5 offset:27648
v_mfma_f32_16x16x32_bf16 v[156:159], a[120:123], a[36:39], v[156:159]
v_mfma_f32_16x16x32_bf16 v[160:163], a[124:127], a[36:39], v[160:163]
buffer_load_dwordx4 a[28:31], v4, s[40:43], s35 offen offset:1024 sc1
s_xor_b32 s35, s77, 86016
v_mfma_f32_16x16x32_bf16 v[144:147], a[124:127], a[32:35], v[144:147]
s_waitcnt vmcnt(10) lgkmcnt(4)
v_mfma_f32_16x16x32_bf16 v[132:135], a[128:131], a[40:43], v[132:135]
ds_read_b128 a[112:115], v5 offset:28672
v_mfma_f32_16x16x32_bf16 v[148:151], a[128:131], a[44:47], v[148:151]
ds_read_b128 a[116:119], v5 offset:29696
v_mfma_f32_16x16x32_bf16 v[152:155], a[132:135], a[44:47], v[152:155]
buffer_load_dwordx4 a[32:35], v4, s[40:43], s35 offen offset:0 sc1
v_mfma_f32_16x16x32_bf16 v[136:139], a[132:135], a[40:43], v[136:139]
ds_read_b128 a[120:123], v5 offset:30720
v_mfma_f32_16x16x32_bf16 v[140:143], a[136:139], a[40:43], v[140:143]
ds_read_b128 a[124:127], v5 offset:31744
v_mfma_f32_16x16x32_bf16 v[156:159], a[136:139], a[44:47], v[156:159]
v_mfma_f32_16x16x32_bf16 v[160:163], a[140:143], a[44:47], v[160:163]
buffer_load_dwordx4 a[36:39], v4, s[40:43], s35 offen offset:1024 sc1
s_xor_b32 s35, s77, 98304
v_mfma_f32_16x16x32_bf16 v[144:147], a[140:143], a[40:43], v[144:147]
s_waitcnt vmcnt(10) lgkmcnt(4)
v_mfma_f32_16x16x32_bf16 v[132:135], a[96:99], a[48:51], v[132:135]
ds_read_b128 a[128:131], v5 offset:32768
v_mfma_f32_16x16x32_bf16 v[148:151], a[96:99], a[52:55], v[148:151]
ds_read_b128 a[132:135], v5 offset:33792
v_mfma_f32_16x16x32_bf16 v[152:155], a[100:103], a[52:55], v[152:155]
buffer_load_dwordx4 a[40:43], v4, s[40:43], s35 offen offset:0 sc1
v_mfma_f32_16x16x32_bf16 v[136:139], a[100:103], a[48:51], v[136:139]
ds_read_b128 a[136:139], v5 offset:34816
v_mfma_f32_16x16x32_bf16 v[140:143], a[104:107], a[48:51], v[140:143]
ds_read_b128 a[140:143], v5 offset:35840
v_mfma_f32_16x16x32_bf16 v[156:159], a[104:107], a[52:55], v[156:159]
v_mfma_f32_16x16x32_bf16 v[160:163], a[108:111], a[52:55], v[160:163]
buffer_load_dwordx4 a[44:47], v4, s[40:43], s35 offen offset:1024 sc1
s_xor_b32 s35, s77, 102400
v_mfma_f32_16x16x32_bf16 v[144:147], a[108:111], a[48:51], v[144:147]
s_waitcnt vmcnt(10) lgkmcnt(4)
v_mfma_f32_16x16x32_bf16 v[132:135], a[112:115], a[0:3], v[132:135]
ds_read_b128 a[96:99], v5 offset:36864
v_mfma_f32_16x16x32_bf16 v[148:151], a[112:115], a[4:7], v[148:151]
ds_read_b128 a[100:103], v5 offset:37888
v_mfma_f32_16x16x32_bf16 v[152:155], a[116:119], a[4:7], v[152:155]
buffer_load_dwordx4 a[48:51], v4, s[40:43], s35 offen offset:0 sc1
v_mfma_f32_16x16x32_bf16 v[136:139], a[116:119], a[0:3], v[136:139]
ds_read_b128 a[104:107], v5 offset:38912
v_mfma_f32_16x16x32_bf16 v[140:143], a[120:123], a[0:3], v[140:143]
ds_read_b128 a[108:111], v5 offset:39936
v_mfma_f32_16x16x32_bf16 v[156:159], a[120:123], a[4:7], v[156:159]
v_mfma_f32_16x16x32_bf16 v[160:163], a[124:127], a[4:7], v[160:163]
buffer_load_dwordx4 a[52:55], v4, s[40:43], s35 offen offset:1024 sc1
s_xor_b32 s35, s77, 114688
v_mfma_f32_16x16x32_bf16 v[144:147], a[124:127], a[0:3], v[144:147]
s_waitcnt vmcnt(10) lgkmcnt(4)
v_mfma_f32_16x16x32_bf16 v[132:135], a[128:131], a[8:11], v[132:135]
ds_read_b128 a[112:115], v5 offset:40960
v_mfma_f32_16x16x32_bf16 v[148:151], a[128:131], a[12:15], v[148:151]
ds_read_b128 a[116:119], v5 offset:41984
v_mfma_f32_16x16x32_bf16 v[152:155], a[132:135], a[12:15], v[152:155]
buffer_load_dwordx4 a[0:3], v4, s[40:43], s35 offen offset:0 sc1
v_mfma_f32_16x16x32_bf16 v[136:139], a[132:135], a[8:11], v[136:139]
ds_read_b128 a[120:123], v5 offset:43008
v_mfma_f32_16x16x32_bf16 v[140:143], a[136:139], a[8:11], v[140:143]
ds_read_b128 a[124:127], v5 offset:44032
v_mfma_f32_16x16x32_bf16 v[156:159], a[136:139], a[12:15], v[156:159]
v_mfma_f32_16x16x32_bf16 v[160:163], a[140:143], a[12:15], v[160:163]
buffer_load_dwordx4 a[4:7], v4, s[40:43], s35 offen offset:1024 sc1
s_xor_b32 s35, s77, 118784
v_mfma_f32_16x16x32_bf16 v[144:147], a[140:143], a[8:11], v[144:147]
s_waitcnt vmcnt(10) lgkmcnt(4)
v_mfma_f32_16x16x32_bf16 v[132:135], a[96:99], a[16:19], v[132:135]
ds_read_b128 a[128:131], v5 offset:45056
v_mfma_f32_16x16x32_bf16 v[148:151], a[96:99], a[20:23], v[148:151]
ds_read_b128 a[132:135], v5 offset:46080
v_mfma_f32_16x16x32_bf16 v[152:155], a[100:103], a[20:23], v[152:155]
buffer_load_dwordx4 a[8:11], v4, s[40:43], s35 offen offset:0 sc1
v_mfma_f32_16x16x32_bf16 v[136:139], a[100:103], a[16:19], v[136:139]
ds_read_b128 a[136:139], v5 offset:47104
v_mfma_f32_16x16x32_bf16 v[140:143], a[104:107], a[16:19], v[140:143]
ds_read_b128 a[140:143], v5 offset:48128
v_mfma_f32_16x16x32_bf16 v[156:159], a[104:107], a[20:23], v[156:159]
v_mfma_f32_16x16x32_bf16 v[160:163], a[108:111], a[20:23], v[160:163]
buffer_load_dwordx4 a[12:15], v4, s[40:43], s35 offen offset:1024 sc1
s_xor_b32 s35, s77, 524288
v_mfma_f32_16x16x32_bf16 v[144:147], a[108:111], a[16:19], v[144:147]
s_waitcnt vmcnt(10) lgkmcnt(4)
v_mfma_f32_16x16x32_bf16 v[132:135], a[112:115], a[24:27], v[132:135]
ds_read_b128 a[96:99], v5 offset:49152
v_mfma_f32_16x16x32_bf16 v[148:151], a[112:115], a[28:31], v[148:151]
ds_read_b128 a[100:103], v5 offset:50176
v_mfma_f32_16x16x32_bf16 v[152:155], a[116:119], a[28:31], v[152:155]
buffer_load_dwordx4 a[16:19], v4, s[40:43], s35 offen offset:0 sc1
v_mfma_f32_16x16x32_bf16 v[136:139], a[116:119], a[24:27], v[136:139]
ds_read_b128 a[104:107], v5 offset:51200
v_mfma_f32_16x16x32_bf16 v[140:143], a[120:123], a[24:27], v[140:143]
ds_read_b128 a[108:111], v5 offset:52224
v_mfma_f32_16x16x32_bf16 v[156:159], a[120:123], a[28:31], v[156:159]
v_mfma_f32_16x16x32_bf16 v[160:163], a[124:127], a[28:31], v[160:163]
buffer_load_dwordx4 a[20:23], v4, s[40:43], s35 offen offset:1024 sc1
s_xor_b32 s35, s77, 528384
v_mfma_f32_16x16x32_bf16 v[144:147], a[124:127], a[24:27], v[144:147]
s_waitcnt vmcnt(10) lgkmcnt(4)
v_mfma_f32_16x16x32_bf16 v[132:135], a[128:131], a[32:35], v[132:135]
ds_read_b128 a[112:115], v5 offset:53248
v_mfma_f32_16x16x32_bf16 v[148:151], a[128:131], a[36:39], v[148:151]
ds_read_b128 a[116:119], v5 offset:54272
v_mfma_f32_16x16x32_bf16 v[152:155], a[132:135], a[36:39], v[152:155]
buffer_load_dwordx4 a[24:27], v4, s[40:43], s35 offen offset:0 sc1
v_mfma_f32_16x16x32_bf16 v[136:139], a[132:135], a[32:35], v[136:139]
ds_read_b128 a[120:123], v5 offset:55296
v_mfma_f32_16x16x32_bf16 v[140:143], a[136:139], a[32:35], v[140:143]
ds_read_b128 a[124:127], v5 offset:56320
v_mfma_f32_16x16x32_bf16 v[156:159], a[136:139], a[36:39], v[156:159]
v_mfma_f32_16x16x32_bf16 v[160:163], a[140:143], a[36:39], v[160:163]
buffer_load_dwordx4 a[28:31], v4, s[40:43], s35 offen offset:1024 sc1
s_xor_b32 s35, s77, 540672
v_mfma_f32_16x16x32_bf16 v[144:147], a[140:143], a[32:35], v[144:147]
s_waitcnt vmcnt(10) lgkmcnt(4)
v_mfma_f32_16x16x32_bf16 v[132:135], a[96:99], a[40:43], v[132:135]
ds_read_b128 a[128:131], v5 offset:57344
v_mfma_f32_16x16x32_bf16 v[148:151], a[96:99], a[44:47], v[148:151]
ds_read_b128 a[132:135], v5 offset:58368
v_mfma_f32_16x16x32_bf16 v[152:155], a[100:103], a[44:47], v[152:155]
buffer_load_dwordx4 a[32:35], v4, s[40:43], s35 offen offset:0 sc1
v_mfma_f32_16x16x32_bf16 v[136:139], a[100:103], a[40:43], v[136:139]
ds_read_b128 a[136:139], v5 offset:59392
v_mfma_f32_16x16x32_bf16 v[140:143], a[104:107], a[40:43], v[140:143]
ds_read_b128 a[140:143], v5 offset:60416
v_mfma_f32_16x16x32_bf16 v[156:159], a[104:107], a[44:47], v[156:159]
v_mfma_f32_16x16x32_bf16 v[160:163], a[108:111], a[44:47], v[160:163]
buffer_load_dwordx4 a[36:39], v4, s[40:43], s35 offen offset:1024 sc1
s_xor_b32 s35, s77, 544768
v_mfma_f32_16x16x32_bf16 v[144:147], a[108:111], a[40:43], v[144:147]
s_waitcnt vmcnt(10) lgkmcnt(4)
v_mfma_f32_16x16x32_bf16 v[132:135], a[112:115], a[48:51], v[132:135]
ds_read_b128 a[96:99], v5 offset:61440
v_mfma_f32_16x16x32_bf16 v[148:151], a[112:115], a[52:55], v[148:151]
ds_read_b128 a[100:103], v5 offset:62464
v_mfma_f32_16x16x32_bf16 v[152:155], a[116:119], a[52:55], v[152:155]
buffer_load_dwordx4 a[40:43], v4, s[40:43], s35 offen offset:0 sc1
v_mfma_f32_16x16x32_bf16 v[136:139], a[116:119], a[48:51], v[136:139]
ds_read_b128 a[104:107], v5 offset:63488
v_mfma_f32_16x16x32_bf16 v[140:143], a[120:123], a[48:51], v[140:143]
ds_read_b128 a[108:111], v5 offset:64512
v_mfma_f32_16x16x32_bf16 v[156:159], a[120:123], a[52:55], v[156:159]
v_mfma_f32_16x16x32_bf16 v[160:163], a[124:127], a[52:55], v[160:163]
buffer_load_dwordx4 a[44:47], v4, s[40:43], s35 offen offset:1024 sc1
s_xor_b32 s35, s77, 557056
v_mfma_f32_16x16x32_bf16 v[144:147], a[124:127], a[48:51], v[144:147]
s_waitcnt vmcnt(10) lgkmcnt(4)
v_mfma_f32_16x16x32_bf16 v[132:135], a[128:131], a[0:3], v[132:135]
ds_read_b128 a[112:115], v6 offset:0
v_mfma_f32_16x16x32_bf16 v[148:151], a[128:131], a[4:7], v[148:151]
ds_read_b128 a[116:119], v6 offset:1024
v_mfma_f32_16x16x32_bf16 v[152:155], a[132:135], a[4:7], v[152:155]
buffer_load_dwordx4 a[48:51], v4, s[40:43], s35 offen offset:0 sc1
v_mfma_f32_16x16x32_bf16 v[136:139], a[132:135], a[0:3], v[136:139]
ds_read_b128 a[120:123], v6 offset:2048
v_mfma_f32_16x16x32_bf16 v[140:143], a[136:139], a[0:3], v[140:143]
ds_read_b128 a[124:127], v6 offset:3072
v_mfma_f32_16x16x32_bf16 v[156:159], a[136:139], a[4:7], v[156:159]
v_mfma_f32_16x16x32_bf16 v[160:163], a[140:143], a[4:7], v[160:163]
buffer_load_dwordx4 a[52:55], v4, s[40:43], s35 offen offset:1024 sc1
s_xor_b32 s35, s77, 561152
v_mfma_f32_16x16x32_bf16 v[144:147], a[140:143], a[0:3], v[144:147]
s_waitcnt vmcnt(10) lgkmcnt(4)
v_mfma_f32_16x16x32_bf16 v[132:135], a[96:99], a[8:11], v[132:135]
ds_read_b128 a[128:131], v6 offset:4096
v_mfma_f32_16x16x32_bf16 v[148:151], a[96:99], a[12:15], v[148:151]
ds_read_b128 a[132:135], v6 offset:5120
v_mfma_f32_16x16x32_bf16 v[152:155], a[100:103], a[12:15], v[152:155]
buffer_load_dwordx4 a[0:3], v4, s[40:43], s35 offen offset:0 sc1
v_mfma_f32_16x16x32_bf16 v[136:139], a[100:103], a[8:11], v[136:139]
ds_read_b128 a[136:139], v6 offset:6144
v_mfma_f32_16x16x32_bf16 v[140:143], a[104:107], a[8:11], v[140:143]
ds_read_b128 a[140:143], v6 offset:7168
v_mfma_f32_16x16x32_bf16 v[156:159], a[104:107], a[12:15], v[156:159]
v_mfma_f32_16x16x32_bf16 v[160:163], a[108:111], a[12:15], v[160:163]
buffer_load_dwordx4 a[4:7], v4, s[40:43], s35 offen offset:1024 sc1
s_xor_b32 s35, s77, 573440
v_mfma_f32_16x16x32_bf16 v[144:147], a[108:111], a[8:11], v[144:147]
s_waitcnt vmcnt(10) lgkmcnt(4)
v_mfma_f32_16x16x32_bf16 v[132:135], a[112:115], a[16:19], v[132:135]
ds_read_b128 a[96:99], v6 offset:8192
v_mfma_f32_16x16x32_bf16 v[148:151], a[112:115], a[20:23], v[148:151]
ds_read_b128 a[100:103], v6 offset:9216
v_mfma_f32_16x16x32_bf16 v[152:155], a[116:119], a[20:23], v[152:155]
buffer_load_dwordx4 a[8:11], v4, s[40:43], s35 offen offset:0 sc1
v_mfma_f32_16x16x32_bf16 v[136:139], a[116:119], a[16:19], v[136:139]
ds_read_b128 a[104:107], v6 offset:10240
v_mfma_f32_16x16x32_bf16 v[140:143], a[120:123], a[16:19], v[140:143]
ds_read_b128 a[108:111], v6 offset:11264
v_mfma_f32_16x16x32_bf16 v[156:159], a[120:123], a[20:23], v[156:159]
v_mfma_f32_16x16x32_bf16 v[160:163], a[124:127], a[20:23], v[160:163]
buffer_load_dwordx4 a[12:15], v4, s[40:43], s35 offen offset:1024 sc1
s_xor_b32 s35, s77, 577536
v_mfma_f32_16x16x32_bf16 v[144:147], a[124:127], a[16:19], v[144:147]
s_waitcnt vmcnt(10) lgkmcnt(4)
v_mfma_f32_16x16x32_bf16 v[132:135], a[128:131], a[24:27], v[132:135]
ds_read_b128 a[112:115], v6 offset:12288
v_mfma_f32_16x16x32_bf16 v[148:151], a[128:131], a[28:31], v[148:151]
ds_read_b128 a[116:119], v6 offset:13312
v_mfma_f32_16x16x32_bf16 v[152:155], a[132:135], a[28:31], v[152:155]
buffer_load_dwordx4 a[16:19], v4, s[40:43], s35 offen offset:0 sc1
v_mfma_f32_16x16x32_bf16 v[136:139], a[132:135], a[24:27], v[136:139]
ds_read_b128 a[120:123], v6 offset:14336
v_mfma_f32_16x16x32_bf16 v[140:143], a[136:139], a[24:27], v[140:143]
ds_read_b128 a[124:127], v6 offset:15360
v_mfma_f32_16x16x32_bf16 v[156:159], a[136:139], a[28:31], v[156:159]
v_mfma_f32_16x16x32_bf16 v[160:163], a[140:143], a[28:31], v[160:163]
buffer_load_dwordx4 a[20:23], v4, s[40:43], s35 offen offset:1024 sc1
s_xor_b32 s35, s77, 589824
v_mfma_f32_16x16x32_bf16 v[144:147], a[140:143], a[24:27], v[144:147]
s_waitcnt vmcnt(10) lgkmcnt(4)
v_mfma_f32_16x16x32_bf16 v[132:135], a[96:99], a[32:35], v[132:135]
ds_read_b128 a[128:131], v6 offset:16384
v_mfma_f32_16x16x32_bf16 v[148:151], a[96:99], a[36:39], v[148:151]
ds_read_b128 a[132:135], v6 offset:17408
v_mfma_f32_16x16x32_bf16 v[152:155], a[100:103], a[36:39], v[152:155]
buffer_load_dwordx4 a[24:27], v4, s[40:43], s35 offen offset:0 sc1
v_mfma_f32_16x16x32_bf16 v[136:139], a[100:103], a[32:35], v[136:139]
ds_read_b128 a[136:139], v6 offset:18432
v_mfma_f32_16x16x32_bf16 v[140:143], a[104:107], a[32:35], v[140:143]
ds_read_b128 a[140:143], v6 offset:19456
v_mfma_f32_16x16x32_bf16 v[156:159], a[104:107], a[36:39], v[156:159]
v_mfma_f32_16x16x32_bf16 v[160:163], a[108:111], a[36:39], v[160:163]
buffer_load_dwordx4 a[28:31], v4, s[40:43], s35 offen offset:1024 sc1
s_xor_b32 s35, s77, 593920
v_mfma_f32_16x16x32_bf16 v[144:147], a[108:111], a[32:35], v[144:147]
s_waitcnt vmcnt(10) lgkmcnt(4)
v_mfma_f32_16x16x32_bf16 v[132:135], a[112:115], a[40:43], v[132:135]
ds_read_b128 a[96:99], v6 offset:20480
v_mfma_f32_16x16x32_bf16 v[148:151], a[112:115], a[44:47], v[148:151]
ds_read_b128 a[100:103], v6 offset:21504
v_mfma_f32_16x16x32_bf16 v[152:155], a[116:119], a[44:47], v[152:155]
buffer_load_dwordx4 a[32:35], v4, s[40:43], s35 offen offset:0 sc1
v_mfma_f32_16x16x32_bf16 v[136:139], a[116:119], a[40:43], v[136:139]
ds_read_b128 a[104:107], v6 offset:22528
v_mfma_f32_16x16x32_bf16 v[140:143], a[120:123], a[40:43], v[140:143]
ds_read_b128 a[108:111], v6 offset:23552
v_mfma_f32_16x16x32_bf16 v[156:159], a[120:123], a[44:47], v[156:159]
v_mfma_f32_16x16x32_bf16 v[160:163], a[124:127], a[44:47], v[160:163]
buffer_load_dwordx4 a[36:39], v4, s[40:43], s35 offen offset:1024 sc1
s_xor_b32 s35, s77, 606208
v_mfma_f32_16x16x32_bf16 v[144:147], a[124:127], a[40:43], v[144:147]
s_waitcnt vmcnt(10) lgkmcnt(4)
v_mfma_f32_16x16x32_bf16 v[132:135], a[128:131], a[48:51], v[132:135]
ds_read_b128 a[112:115], v6 offset:24576
v_mfma_f32_16x16x32_bf16 v[148:151], a[128:131], a[52:55], v[148:151]
ds_read_b128 a[116:119], v6 offset:25600
v_mfma_f32_16x16x32_bf16 v[152:155], a[132:135], a[52:55], v[152:155]
buffer_load_dwordx4 a[40:43], v4, s[40:43], s35 offen offset:0 sc1
v_mfma_f32_16x16x32_bf16 v[136:139], a[132:135], a[48:51], v[136:139]
ds_read_b128 a[120:123], v6 offset:26624
v_mfma_f32_16x16x32_bf16 v[140:143], a[136:139], a[48:51], v[140:143]
s_add_u32 s88, s67, 0xe0000
s_add_u32 s89, s66, 0xd0000
v_mfma_f32_16x16x32_bf16 v[156:159], a[136:139], a[52:55], v[156:159]
buffer_load_dword v11, v255, s[4:7], s88 offen sc1
v_mfma_f32_16x16x32_bf16 v[160:163], a[140:143], a[52:55], v[160:163]
buffer_load_dwordx4 a[44:47], v4, s[40:43], s35 offen offset:1024 sc1
s_xor_b32 s35, s77, 610304
v_mfma_f32_16x16x32_bf16 v[144:147], a[140:143], a[48:51], v[144:147]
ds_read_b128 a[124:127], v6 offset:27648
s_waitcnt vmcnt(11) lgkmcnt(4)
v_mfma_f32_16x16x32_bf16 v[132:135], a[96:99], a[0:3], v[132:135]
buffer_load_dword v232, v255, s[4:7], s89 offen offset:64 sc1
v_mfma_f32_16x16x32_bf16 v[148:151], a[96:99], a[4:7], v[148:151]
ds_read_b128 a[128:131], v6 offset:28672
v_mfma_f32_16x16x32_bf16 v[152:155], a[100:103], a[4:7], v[152:155]
buffer_load_dwordx4 a[48:51], v4, s[40:43], s35 offen offset:0 sc1
v_mfma_f32_16x16x32_bf16 v[136:139], a[100:103], a[0:3], v[136:139]
ds_read_b128 a[132:135], v6 offset:29696
v_mfma_f32_16x16x32_bf16 v[140:143], a[104:107], a[0:3], v[140:143]
ds_read_b128 a[136:139], v6 offset:30720
v_mfma_f32_16x16x32_bf16 v[156:159], a[104:107], a[4:7], v[156:159]
ds_read_b128 a[140:143], v6 offset:31744
v_mfma_f32_16x16x32_bf16 v[160:163], a[108:111], a[4:7], v[160:163]
buffer_load_dwordx4 a[52:55], v4, s[40:43], s35 offen offset:1024 sc1
s_xor_b32 s35, s77, 622592
v_mfma_f32_16x16x32_bf16 v[144:147], a[108:111], a[0:3], v[144:147]
s_waitcnt vmcnt(12) lgkmcnt(4)
v_mfma_f32_16x16x32_bf16 v[132:135], a[112:115], a[8:11], v[132:135]
ds_read_b128 a[96:99], v6 offset:32768
v_mfma_f32_16x16x32_bf16 v[148:151], a[112:115], a[12:15], v[148:151]
ds_read_b128 a[100:103], v6 offset:33792
v_mfma_f32_16x16x32_bf16 v[152:155], a[116:119], a[12:15], v[152:155]
buffer_load_dwordx4 a[0:3], v4, s[40:43], s35 offen offset:0 sc1
v_mfma_f32_16x16x32_bf16 v[136:139], a[116:119], a[8:11], v[136:139]
ds_read_b128 a[104:107], v6 offset:34816
v_mfma_f32_16x16x32_bf16 v[140:143], a[120:123], a[8:11], v[140:143]
ds_read_b128 a[108:111], v6 offset:35840
v_mfma_f32_16x16x32_bf16 v[156:159], a[120:123], a[12:15], v[156:159]
v_mfma_f32_16x16x32_bf16 v[160:163], a[124:127], a[12:15], v[160:163]
buffer_load_dwordx4 a[4:7], v4, s[40:43], s35 offen offset:1024 sc1
s_xor_b32 s35, s77, 626688
v_mfma_f32_16x16x32_bf16 v[144:147], a[124:127], a[8:11], v[144:147]
s_waitcnt vmcnt(12) lgkmcnt(4)
v_mfma_f32_16x16x32_bf16 v[132:135], a[128:131], a[16:19], v[132:135]
ds_read_b128 a[112:115], v6 offset:36864
v_mfma_f32_16x16x32_bf16 v[148:151], a[128:131], a[20:23], v[148:151]
ds_read_b128 a[116:119], v6 offset:37888
v_mfma_f32_16x16x32_bf16 v[152:155], a[132:135], a[20:23], v[152:155]
buffer_load_dwordx4 a[8:11], v4, s[40:43], s35 offen offset:0 sc1
v_mfma_f32_16x16x32_bf16 v[136:139], a[132:135], a[16:19], v[136:139]
ds_read_b128 a[120:123], v6 offset:38912
v_mfma_f32_16x16x32_bf16 v[140:143], a[136:139], a[16:19], v[140:143]
ds_read_b128 a[124:127], v6 offset:39936
v_mfma_f32_16x16x32_bf16 v[156:159], a[136:139], a[20:23], v[156:159]
v_mfma_f32_16x16x32_bf16 v[160:163], a[140:143], a[20:23], v[160:163]
buffer_load_dwordx4 a[12:15], v4, s[40:43], s35 offen offset:1024 sc1
s_xor_b32 s35, s77, 638976
v_mfma_f32_16x16x32_bf16 v[144:147], a[140:143], a[16:19], v[144:147]
s_waitcnt vmcnt(12) lgkmcnt(4)
v_mfma_f32_16x16x32_bf16 v[132:135], a[96:99], a[24:27], v[132:135]
ds_read_b128 a[128:131], v6 offset:40960
v_mfma_f32_16x16x32_bf16 v[148:151], a[96:99], a[28:31], v[148:151]
ds_read_b128 a[132:135], v6 offset:41984
v_mfma_f32_16x16x32_bf16 v[152:155], a[100:103], a[28:31], v[152:155]
buffer_load_dwordx4 a[16:19], v4, s[40:43], s35 offen offset:0 sc1
v_mfma_f32_16x16x32_bf16 v[136:139], a[100:103], a[24:27], v[136:139]
ds_read_b128 a[136:139], v6 offset:43008
v_mfma_f32_16x16x32_bf16 v[140:143], a[104:107], a[24:27], v[140:143]
ds_read_b128 a[140:143], v6 offset:44032
v_mfma_f32_16x16x32_bf16 v[156:159], a[104:107], a[28:31], v[156:159]
v_mfma_f32_16x16x32_bf16 v[160:163], a[108:111], a[28:31], v[160:163]
buffer_load_dwordx4 a[20:23], v4, s[40:43], s35 offen offset:1024 sc1
s_xor_b32 s35, s77, 643072
v_mfma_f32_16x16x32_bf16 v[144:147], a[108:111], a[24:27], v[144:147]
s_waitcnt vmcnt(12) lgkmcnt(4)
v_mfma_f32_16x16x32_bf16 v[132:135], a[112:115], a[32:35], v[132:135]
ds_read_b128 a[96:99], v6 offset:45056
v_mfma_f32_16x16x32_bf16 v[148:151], a[112:115], a[36:39], v[148:151]
ds_read_b128 a[100:103], v6 offset:46080
v_mfma_f32_16x16x32_bf16 v[152:155], a[116:119], a[36:39], v[152:155]
buffer_load_dwordx4 a[24:27], v4, s[40:43], s35 offen offset:0 sc1
v_mfma_f32_16x16x32_bf16 v[136:139], a[116:119], a[32:35], v[136:139]
ds_read_b128 a[104:107], v6 offset:47104
v_mfma_f32_16x16x32_bf16 v[140:143], a[120:123], a[32:35], v[140:143]
ds_read_b128 a[108:111], v6 offset:48128
v_mfma_f32_16x16x32_bf16 v[156:159], a[120:123], a[36:39], v[156:159]
v_mfma_f32_16x16x32_bf16 v[160:163], a[124:127], a[36:39], v[160:163]
buffer_load_dwordx4 a[28:31], v4, s[40:43], s35 offen offset:1024 sc1
s_xor_b32 s35, s77, 0
v_mfma_f32_16x16x32_bf16 v[144:147], a[124:127], a[32:35], v[144:147]
s_waitcnt vmcnt(11) lgkmcnt(4)
v_cmp_ne_u32 vcc, v11, v15
s_cbranch_vccnz Ltr_12
Lte_14:
v_mfma_f32_16x16x32_bf16 v[132:135], a[128:131], a[40:43], v[132:135]
s_add_u32 m0, s18, 0x0
s_add_u32 s44, s50, 0x2800000
v_mfma_f32_16x16x32_bf16 v[148:151], a[128:131], a[44:47], v[148:151]
ds_read_b128 a[112:115], v6 offset:49152
v_mfma_f32_16x16x32_bf16 v[152:155], a[132:135], a[44:47], v[152:155]
buffer_load_dwordx4 v1, s[4:7], s44 offen offset:0 sc1 lds
v_mfma_f32_16x16x32_bf16 v[136:139], a[132:135], a[40:43], v[136:139]
ds_read_b128 a[116:119], v6 offset:50176
v_mfma_f32_16x16x32_bf16 v[140:143], a[136:139], a[40:43], v[140:143]
ds_read_b128 a[120:123], v6 offset:51200
v_mfma_f32_16x16x32_bf16 v[156:159], a[136:139], a[44:47], v[156:159]
ds_read_b128 a[124:127], v6 offset:52224
v_mfma_f32_16x16x32_bf16 v[160:163], a[140:143], a[44:47], v[160:163]
buffer_load_dwordx4 v1, s[4:7], s44 offen offset:1024 sc1 lds
s_add_u32 m0, s18, 0x2000
v_mfma_f32_16x16x32_bf16 v[144:147], a[140:143], a[40:43], v[144:147]
s_add_u32 s44, s50, 0x2802000
s_waitcnt vmcnt(10) lgkmcnt(4)
v_mfma_f32_16x16x32_bf16 v[132:135], a[96:99], a[48:51], v[132:135]
ds_read_b128 a[128:131], v6 offset:53248
v_mfma_f32_16x16x32_bf16 v[148:151], a[96:99], a[52:55], v[148:151]
ds_read_b128 a[132:135], v6 offset:54272
v_mfma_f32_16x16x32_bf16 v[152:155], a[100:103], a[52:55], v[152:155]
buffer_load_dwordx4 v1, s[4:7], s44 offen offset:0 sc1 lds
v_mfma_f32_16x16x32_bf16 v[136:139], a[100:103], a[48:51], v[136:139]
ds_read_b128 a[136:139], v6 offset:55296
v_mfma_f32_16x16x32_bf16 v[140:143], a[104:107], a[48:51], v[140:143]
ds_read_b128 a[140:143], v6 offset:56320
v_mfma_f32_16x16x32_bf16 v[156:159], a[104:107], a[52:55], v[156:159]
v_mfma_f32_16x16x32_bf16 v[160:163], a[108:111], a[52:55], v[160:163]
buffer_load_dwordx4 v1, s[4:7], s44 offen offset:1024 sc1 lds
s_add_u32 m0, s18, 0x4000
v_mfma_f32_16x16x32_bf16 v[144:147], a[108:111], a[48:51], v[144:147]
s_add_u32 s44, s50, 0x2804000
s_waitcnt vmcnt(10) lgkmcnt(4)
v_mfma_f32_16x16x32_bf16 v[132:135], a[112:115], a[0:3], v[132:135]
ds_read_b128 a[96:99], v6 offset:57344
v_mfma_f32_16x16x32_bf16 v[148:151], a[112:115], a[4:7], v[148:151]
ds_read_b128 a[100:103], v6 offset:58368
v_mfma_f32_16x16x32_bf16 v[152:155], a[116:119], a[4:7], v[152:155]
ds_read_b128 a[104:107], v6 offset:59392
v_mfma_f32_16x16x32_bf16 v[136:139], a[116:119], a[0:3], v[136:139]
buffer_load_dwordx4 v1, s[4:7], s44 offen offset:0 sc1 lds
v_mfma_f32_16x16x32_bf16 v[140:143], a[120:123], a[0:3], v[140:143]
ds_read_b128 a[108:111], v6 offset:60416
v_mfma_f32_16x16x32_bf16 v[156:159], a[120:123], a[4:7], v[156:159]
v_mfma_f32_16x16x32_bf16 v[160:163], a[124:127], a[4:7], v[160:163]
v_mfma_f32_16x16x32_bf16 v[144:147], a[124:127], a[0:3], v[144:147]
buffer_load_dwordx4 v1, s[4:7], s44 offen offset:1024 sc1 lds
s_waitcnt vmcnt(10) lgkmcnt(4)
v_mfma_f32_16x16x32_bf16 v[132:135], a[128:131], a[8:11], v[132:135]
s_add_u32 m0, s18, 0x6000
s_add_u32 s44, s50, 0x2806000
v_mfma_f32_16x16x32_bf16 v[148:151], a[128:131], a[12:15], v[148:151]
ds_read_b128 a[112:115], v6 offset:61440
v_mfma_f32_16x16x32_bf16 v[152:155], a[132:135], a[12:15], v[152:155]
ds_read_b128 a[116:119], v6 offset:62464
v_mfma_f32_16x16x32_bf16 v[136:139], a[132:135], a[8:11], v[136:139]
ds_read_b128 a[120:123], v6 offset:63488
v_mfma_f32_16x16x32_bf16 v[140:143], a[136:139], a[8:11], v[140:143]
buffer_load_dwordx4 v1, s[4:7], s44 offen offset:0 sc1 lds
v_mfma_f32_16x16x32_bf16 v[156:159], a[136:139], a[12:15], v[156:159]
ds_read_b128 a[124:127], v6 offset:64512
v_mfma_f32_16x16x32_bf16 v[160:163], a[140:143], a[12:15], v[160:163]
v_mfma_f32_16x16x32_bf16 v[144:147], a[140:143], a[8:11], v[144:147]
s_waitcnt vmcnt(9) lgkmcnt(4)
v_mfma_f32_16x16x32_bf16 v[132:135], a[96:99], a[16:19], v[132:135]
v_mfma_f32_16x16x32_bf16 v[148:151], a[96:99], a[20:23], v[148:151]
buffer_load_dwordx4 v1, s[4:7], s44 offen offset:1024 sc1 lds
v_mfma_f32_16x16x32_bf16 v[152:155], a[100:103], a[20:23], v[152:155]
v_mfma_f32_16x16x32_bf16 v[136:139], a[100:103], a[16:19], v[136:139]
v_mfma_f32_16x16x32_bf16 v[140:143], a[104:107], a[16:19], v[140:143]
v_mfma_f32_16x16x32_bf16 v[156:159], a[104:107], a[20:23], v[156:159]
v_mfma_f32_16x16x32_bf16 v[160:163], a[108:111], a[20:23], v[160:163]
v_mfma_f32_16x16x32_bf16 v[144:147], a[108:111], a[16:19], v[144:147]
s_waitcnt vmcnt(8) lgkmcnt(0)
v_mfma_f32_16x16x32_bf16 v[132:135], a[112:115], a[24:27], v[132:135]
v_mfma_f32_16x16x32_bf16 v[148:151], a[112:115], a[28:31], v[148:151]
v_mfma_f32_16x16x32_bf16 v[152:155], a[116:119], a[28:31], v[152:155]
v_mfma_f32_16x16x32_bf16 v[136:139], a[116:119], a[24:27], v[136:139]
v_mfma_f32_16x16x32_bf16 v[140:143], a[120:123], a[24:27], v[140:143]
v_mfma_f32_16x16x32_bf16 v[156:159], a[120:123], a[28:31], v[156:159]
v_mfma_f32_16x16x32_bf16 v[160:163], a[124:127], a[28:31], v[160:163]
v_mfma_f32_16x16x32_bf16 v[144:147], a[124:127], a[24:27], v[144:147]
s_nop 0
v_cvt_pk_bf16_f32 v32, v132, v133
v_cvt_pk_bf16_f32 v33, v134, v135
s_nop 0
v_cvt_pk_bf16_f32 v34, v136, v137
v_cvt_pk_bf16_f32 v35, v138, v139
s_add_u32 s36, s69, 0x400000
buffer_store_dwordx4 v[32:35], v4, s[4:7], s36 offen offset:0 sc1
v_cvt_pk_bf16_f32 v40, v148, v149
v_cvt_pk_bf16_f32 v41, v150, v151
v_cvt_pk_bf16_f32 v42, v152, v153
v_cvt_pk_bf16_f32 v43, v154, v155
v_cvt_pk_bf16_f32 v36, v140, v141
v_cvt_pk_bf16_f32 v37, v142, v143
v_cvt_pk_bf16_f32 v38, v144, v145
v_cvt_pk_bf16_f32 v39, v146, v147
s_add_u32 s37, s36, 4096
v_cvt_pk_bf16_f32 v44, v156, v157
v_cvt_pk_bf16_f32 v45, v158, v159
v_cvt_pk_bf16_f32 v46, v160, v161
buffer_store_dwordx4 v[40:43], v4, s[4:7], s36 offen offset:1024 sc1
v_cvt_pk_bf16_f32 v47, v162, v163
v_mfma_f32_16x16x32_bf16 v[96:99], v[32:35], v[32:35], 0
s_mov_b32 s38, 0x300000
s_add_u32 s92, s78, 0x40000
v_mfma_f32_16x16x32_bf16 v[92:95], v[16:19], v[32:35], 0
s_add_u32 s40, s4, 0x400000
s_addc_u32 s41, s5, 0
v_mfma_f32_16x16x32_bf16 v[96:99], v[36:39], v[36:39], v[96:99]
buffer_store_dwordx4 v[36:39], v4, s[4:7], s37 offen offset:0 sc1
v_mfma_f32_16x16x32_bf16 v[92:95], v[16:19], v[36:39], v[92:95]
s_nop 5
v_cndmask_b32 v96, v96, v97, s[46:47]
v_cndmask_b32 v98, v98, v99, s[46:47]
v_mfma_f32_16x16x32_bf16 v[104:107], v[40:43], v[40:43], 0
v_mfma_f32_16x16x32_bf16 v[100:103], v[16:19], v[40:43], 0
v_cndmask_b32 v93, v96, v98, s[48:49]
buffer_store_dwordx4 v[44:47], v4, s[4:7], s37 offen offset:1024 sc1
v_mfma_f32_16x16x32_bf16 v[104:107], v[44:47], v[44:47], v[104:107]
v_mfma_f32_16x16x32_bf16 v[100:103], v[16:19], v[44:47], v[100:103]
s_nop 6
v_cndmask_b32 v104, v104, v105, s[46:47]
v_cndmask_b32 v106, v106, v107, s[46:47]
L_stub4:
s_cbranch_execz L_wret1
buffer_store_dwordx2 v[92:93], v253, s[4:7], s38 offen offset:0 sc1
v_cndmask_b32 v101, v104, v106, s[48:49]
buffer_store_dwordx2 v[100:101], v253, s[4:7], s38 offen offset:2048 sc1
v_cmp_ne_u32 vcc, v232, v15
s_cbranch_vccnz Ltr_15
Lte_17:
s_barrier
s_add_u32 m0, s18, 0x8000
s_add_u32 s44, s50, 0x2808000
buffer_load_dwordx4 v1, s[4:7], s44 offen offset:0 sc1 lds
buffer_load_dwordx4 v1, s[4:7], s44 offen offset:1024 sc1 lds
s_add_u32 m0, s18, 0xa000
s_add_u32 s44, s50, 0x280a000
buffer_load_dwordx4 v1, s[4:7], s44 offen offset:0 sc1 lds
buffer_load_dwordx4 v1, s[4:7], s44 offen offset:1024 sc1 lds
s_waitcnt vmcnt(4)
s_barrier
s_cmp_lg_u32 s28, 0
s_cbranch_scc1 Lsg_18
buffer_atomic_add v12, v10, s[4:7], s92 offen sc1
Lsg_18:
s_mov_b64 exec, 0
s_cmp_eq_u32 s28, 0
s_cbranch_scc1 L_stub5
L_wret2:
s_mov_b64 exec, -1
s_cmp_lt_u32 s28, 2
s_cbranch_scc1 Lwd_19
s_add_u32 m0, s19, 0xa000
s_add_u32 s44, s50, 0x280a000
s_add_u32 s44, s44, s18
buffer_load_dwordx4 v1, s[4:7], s44 offen offset:0 sc1 lds
buffer_load_dwordx4 v1, s[4:7], s44 offen offset:1024 sc1 lds
buffer_load_dwordx4 v1, s[4:7], s44 offen offset:2048 sc1 lds
buffer_load_dwordx4 v1, s[4:7], s44 offen offset:3072 sc1 lds
s_add_u32 m0, s19, 0xc000
s_add_u32 s44, s50, 0x280c000
s_add_u32 s44, s44, s18
buffer_load_dwordx4 v1, s[4:7], s44 offen offset:0 sc1 lds
buffer_load_dwordx4 v1, s[4:7], s44 offen offset:1024 sc1 lds
buffer_load_dwordx4 v1, s[4:7], s44 offen offset:2048 sc1 lds
buffer_load_dwordx4 v1, s[4:7], s44 offen offset:3072 sc1 lds
s_add_u32 m0, s19, 0xe000
s_add_u32 s44, s50, 0x280e000
s_add_u32 s44, s44, s18
buffer_load_dwordx4 v1, s[4:7], s44 offen offset:0 sc1 lds
buffer_load_dwordx4 v1, s[4:7], s44 offen offset:1024 sc1 lds
buffer_load_dwordx4 v1, s[4:7], s44 offen offset:2048 sc1 lds
buffer_load_dwordx4 v1, s[4:7], s44 offen offset:3072 sc1 lds
s_add_u32 m0, s19, 0x10000
s_add_u32 s44, s50, 0x2810000
s_add_u32 s44, s44, s18
buffer_load_dwordx4 v1, s[4:7], s44 offen offset:0 sc1 lds
buffer_load_dwordx4 v1, s[4:7], s44 offen offset:1024 sc1 lds
buffer_load_dwordx4 v1, s[4:7], s44 offen offset:2048 sc1 lds
buffer_load_dwordx4 v1, s[4:7], s44 offen offset:3072 sc1 lds
s_add_u32 m0, s19, 0x12000
s_add_u32 s44, s50, 0x2812000
s_add_u32 s44, s44, s18
buffer_load_dwordx4 v1, s[4:7], s44 offen offset:0 sc1 lds
buffer_load_dwordx4 v1, s[4:7], s44 offen offset:1024 sc1 lds
buffer_load_dwordx4 v1, s[4:7], s44 offen offset:2048 sc1 lds
buffer_load_dwordx4 v1, s[4:7], s44 offen offset:3072 sc1 lds
s_add_u32 m0, s19, 0x14000
s_add_u32 s44, s50, 0x2814000
s_add_u32 s44, s44, s18
buffer_load_dwordx4 v1, s[4:7], s44 offen offset:0 sc1 lds
buffer_load_dwordx4 v1, s[4:7], s44 offen offset:1024 sc1 lds
buffer_load_dwordx4 v1, s[4:7], s44 offen offset:2048 sc1 lds
buffer_load_dwordx4 v1, s[4:7], s44 offen offset:3072 sc1 lds
s_add_u32 m0, s19, 0x16000
s_add_u32 s44, s50, 0x2816000
s_add_u32 s44, s44, s18
buffer_load_dwordx4 v1, s[4:7], s44 offen offset:0 sc1 lds
buffer_load_dwordx4 v1, s[4:7], s44 offen offset:1024 sc1 lds
buffer_load_dwordx4 v1, s[4:7], s44 offen offset:2048 sc1 lds
buffer_load_dwordx4 v1, s[4:7], s44 offen offset:3072 sc1 lds
s_add_u32 m0, s19, 0x18000
s_add_u32 s44, s50, 0x2818000
s_add_u32 s44, s44, s18
buffer_load_dwordx4 v1, s[4:7], s44 offen offset:0 sc1 lds
buffer_load_dwordx4 v1, s[4:7], s44 offen offset:1024 sc1 lds
buffer_load_dwordx4 v1, s[4:7], s44 offen offset:2048 sc1 lds
buffer_load_dwordx4 v1, s[4:7], s44 offen offset:3072 sc1 lds
Lwd_19:
s_cmp_lg_u32 s28, 1
s_cbranch_scc1 Lpo_22
s_add_u32 s36, s34, 0x40000
s_mov_b32 s37, 0
v_mov_b32 v11, 0
buffer_atomic_add v11, v251, s[4:7], s36 offen sc0 sc1
s_sleep 4
Lpoll_20:
v_mov_b32 v234, 0
buffer_atomic_add v234, v251, s[4:7], s36 offen sc0 sc1
s_waitcnt vmcnt(1)
v_readfirstlane_b32 s38, v11
s_nop 0
s_cmp_ge_u32 s38, 32
s_cbranch_scc1 Lpe_21
v_mov_b32 v11, 0
buffer_atomic_add v11, v251, s[4:7], s36 offen sc0 sc1
s_waitcnt vmcnt(1)
v_readfirstlane_b32 s38, v234
s_nop 0
s_cmp_ge_u32 s38, 32
s_cbranch_scc1 Lpe_21
s_add_u32 s37, s37, 1
s_cmp_lt_u32 s37, 0x80000
s_cbranch_scc1 Lpoll_20
s_waitcnt vmcnt(0)
Lpo_22:
s_waitcnt vmcnt(32) lgkmcnt(0)
s_cmp_ge_u32 s28, 2
s_cbranch_scc1 Lw_23
s_waitcnt vmcnt(0)
Lw_23:
Lpe_21:
s_barrier
s_mov_b32 s35, s68
s_add_u32 s33, s35, 0x1000
buffer_load_dwordx4 a[0:3], v2, s[40:43], s35 offen offset:0 sc1
buffer_load_dwordx4 a[4:7], v2, s[40:43], s33 offen offset:0 sc1
buffer_load_dwordx4 a[8:11], v2, s[40:43], s35 offen offset:1024 sc1
buffer_load_dwordx4 a[12:15], v2, s[40:43], s33 offen offset:1024 sc1
buffer_load_dwordx4 a[16:19], v2, s[40:43], s35 offen offset:2048 sc1
buffer_load_dwordx4 a[20:23], v2, s[40:43], s33 offen offset:2048 sc1
buffer_load_dwordx4 a[24:27], v2, s[40:43], s35 offen offset:3072 sc1
buffer_load_dwordx4 a[28:31], v2, s[40:43], s33 offen offset:3072 sc1
s_add_u32 s35, s35, 0x4000
s_add_u32 s33, s33, 0x4000
buffer_load_dwordx4 a[32:35], v2, s[40:43], s35 offen offset:0 sc1
buffer_load_dwordx4 a[36:39], v2, s[40:43], s33 offen offset:0 sc1
buffer_load_dwordx4 a[40:43], v2, s[40:43], s35 offen offset:1024 sc1
buffer_load_dwordx4 a[44:47], v2, s[40:43], s33 offen offset:1024 sc1
buffer_load_dwordx4 a[48:51], v2, s[40:43], s35 offen offset:2048 sc1
buffer_load_dwordx4 a[52:55], v2, s[40:43], s33 offen offset:2048 sc1
buffer_load_dwordx4 a[56:59], v2, s[40:43], s35 offen offset:3072 sc1
buffer_load_dwordx4 a[60:63], v2, s[40:43], s33 offen offset:3072 sc1
s_add_u32 s35, s35, 0x4000
s_add_u32 s33, s33, 0x4000
v_add_u32 v5, 0, v1
ds_read_b128 a[96:99], v5 offset:2048
ds_read_b128 a[100:103], v5 offset:8192
ds_read_b128 a[104:107], v5 offset:3072
ds_read_b128 a[108:111], v5 offset:9216
ds_read_b128 a[112:115], v5 offset:4096
ds_read_b128 a[116:119], v5 offset:10240
s_waitcnt vmcnt(14) lgkmcnt(4)
v_mfma_f32_16x16x32_bf16 v[140:143], a[96:99], a[0:3], 0
v_and_b32 v232, 15, v0
v_lshlrev_b32 v232, 7, v232
v_mfma_f32_16x16x32_bf16 v[140:143], a[100:103], a[4:7], v[140:143]
buffer_load_dwordx4 a[64:67], v2, s[40:43], s35 offen offset:0 sc1
s_waitcnt vmcnt(13)
v_mfma_f32_16x16x32_bf16 v[164:167], a[100:103], a[12:15], 0
v_lshrrev_b32 v233, 4, v0
v_lshlrev_b32 v233, 4, v233
v_mfma_f32_16x16x32_bf16 v[164:167], a[96:99], a[8:11], v[164:167]
v_add_u32 v232, v233, v232
s_mul_i32 s38, s30, 12288
s_waitcnt vmcnt(12)
v_mfma_f32_16x16x32_bf16 v[188:191], a[96:99], a[16:19], 0
s_add_u32 s38, s38, 0x1880000
s_add_u32 s39, s28, 4
s_min_u32 s39, s39, 5
s_waitcnt vmcnt(11)
v_mfma_f32_16x16x32_bf16 v[188:191], a[100:103], a[20:23], v[188:191]
buffer_load_dwordx4 a[68:71], v2, s[40:43], s33 offen offset:0 sc1
s_lshl_b32 s36, s28, 11
s_waitcnt vmcnt(10)
v_mfma_f32_16x16x32_bf16 v[212:215], a[100:103], a[28:31], 0
s_add_u32 s36, s36, s38
s_lshl_b32 s37, s39, 11
s_add_u32 s37, s37, s38
v_mfma_f32_16x16x32_bf16 v[212:215], a[96:99], a[24:27], v[212:215]
ds_read_b128 a[128:131], v5 offset:5120
s_waitcnt lgkmcnt(4)
v_mfma_f32_16x16x32_bf16 v[216:219], a[104:107], a[24:27], 0
ds_read_b128 a[132:135], v5 offset:11264
s_waitcnt lgkmcnt(4)
v_mfma_f32_16x16x32_bf16 v[216:219], a[108:111], a[28:31], v[216:219]
ds_read_b128 a[136:139], v5 offset:0
v_mfma_f32_16x16x32_bf16 v[192:195], a[108:111], a[20:23], 0
buffer_load_dwordx4 v[48:51], v232, s[4:7], s36 offen sc1
v_mfma_f32_16x16x32_bf16 v[192:195], a[104:107], a[16:19], v[192:195]
ds_read_b128 a[140:143], v5 offset:6144
v_mfma_f32_16x16x32_bf16 v[168:171], a[104:107], a[8:11], 0
ds_read_b128 a[144:147], v5 offset:1024
v_mfma_f32_16x16x32_bf16 v[168:171], a[108:111], a[12:15], v[168:171]
ds_read_b128 a[148:151], v5 offset:7168
v_mfma_f32_16x16x32_bf16 v[144:147], a[108:111], a[4:7], 0
v_mfma_f32_16x16x32_bf16 v[144:147], a[104:107], a[0:3], v[144:147]
buffer_load_dwordx4 a[72:75], v2, s[40:43], s35 offen offset:1024 sc1
s_waitcnt lgkmcnt(7)
v_mfma_f32_16x16x32_bf16 v[148:151], a[112:115], a[0:3], 0
s_waitcnt lgkmcnt(6)
v_mfma_f32_16x16x32_bf16 v[148:151], a[116:119], a[4:7], v[148:151]
v_mfma_f32_16x16x32_bf16 v[172:175], a[116:119], a[12:15], 0
v_mfma_f32_16x16x32_bf16 v[172:175], a[112:115], a[8:11], v[172:175]
v_mfma_f32_16x16x32_bf16 v[196:199], a[112:115], a[16:19], 0
buffer_load_dwordx4 a[76:79], v2, s[40:43], s33 offen offset:1024 sc1
v_mfma_f32_16x16x32_bf16 v[196:199], a[116:119], a[20:23], v[196:199]
v_mfma_f32_16x16x32_bf16 v[220:223], a[116:119], a[28:31], 0
v_mfma_f32_16x16x32_bf16 v[220:223], a[112:115], a[24:27], v[220:223]
s_waitcnt lgkmcnt(0)
v_mfma_f32_16x16x32_bf16 v[224:227], a[128:131], a[24:27], 0
ds_read_b128 a[96:99], v5 offset:14336
v_mfma_f32_16x16x32_bf16 v[224:227], a[132:135], a[28:31], v[224:227]
buffer_load_dwordx4 a[80:83], v2, s[40:43], s35 offen offset:2048 sc1
v_mfma_f32_16x16x32_bf16 v[200:203], a[132:135], a[20:23], 0
ds_read_b128 a[100:103], v5 offset:20480
v_mfma_f32_16x16x32_bf16 v[200:203], a[128:131], a[16:19], v[200:203]
v_mfma_f32_16x16x32_bf16 v[176:179], a[128:131], a[8:11], 0
v_mfma_f32_16x16x32_bf16 v[176:179], a[132:135], a[12:15], v[176:179]
buffer_load_dwordx4 a[84:87], v2, s[40:43], s33 offen offset:2048 sc1
v_mfma_f32_16x16x32_bf16 v[152:155], a[132:135], a[4:7], 0
ds_read_b128 a[104:107], v5 offset:15360
v_mfma_f32_16x16x32_bf16 v[152:155], a[128:131], a[0:3], v[152:155]
v_mfma_f32_16x16x32_bf16 v[132:135], a[136:139], a[0:3], 0
ds_read_b128 a[108:111], v5 offset:21504
v_mfma_f32_16x16x32_bf16 v[132:135], a[140:143], a[4:7], v[132:135]
v_mfma_f32_16x16x32_bf16 v[156:159], a[140:143], a[12:15], 0
buffer_load_dwordx4 v[52:55], v232, s[4:7], s37 offen sc1
s_add_u32 m0, s18, 0x1c000
v_mfma_f32_16x16x32_bf16 v[156:159], a[136:139], a[8:11], v[156:159]
s_add_u32 s44, s50, 0x281c000
ds_read_b128 a[112:115], v5 offset:16384
v_mfma_f32_16x16x32_bf16 v[180:183], a[136:139], a[16:19], 0
v_mfma_f32_16x16x32_bf16 v[180:183], a[140:143], a[20:23], v[180:183]
ds_read_b128 a[116:119], v5 offset:22528
v_mfma_f32_16x16x32_bf16 v[204:207], a[140:143], a[28:31], 0
v_mfma_f32_16x16x32_bf16 v[204:207], a[136:139], a[24:27], v[204:207]
buffer_load_dwordx4 a[88:91], v2, s[40:43], s35 offen offset:3072 sc1
v_mfma_f32_16x16x32_bf16 v[208:211], a[144:147], a[24:27], 0
v_mfma_f32_16x16x32_bf16 v[208:211], a[148:151], a[28:31], v[208:211]
v_mfma_f32_16x16x32_bf16 v[184:187], a[148:151], a[20:23], 0
v_mfma_f32_16x16x32_bf16 v[184:187], a[144:147], a[16:19], v[184:187]
v_mfma_f32_16x16x32_bf16 v[160:163], a[144:147], a[8:11], 0
buffer_load_dwordx4 a[92:95], v2, s[40:43], s33 offen offset:3072 sc1
s_add_u32 s35, s35, 0x4000
v_mfma_f32_16x16x32_bf16 v[160:163], a[148:151], a[12:15], v[160:163]
s_add_u32 s33, s33, 0x4000
v_mfma_f32_16x16x32_bf16 v[136:139], a[148:151], a[4:7], 0
v_mfma_f32_16x16x32_bf16 v[136:139], a[144:147], a[0:3], v[136:139]
s_waitcnt vmcnt(10) lgkmcnt(0)
v_mfma_f32_16x16x32_bf16 v[140:143], a[96:99], a[32:35], v[140:143]
ds_read_b128 a[128:131], v5 offset:17408
v_mfma_f32_16x16x32_bf16 v[140:143], a[100:103], a[36:39], v[140:143]
buffer_load_dwordx4 a[0:3], v2, s[40:43], s35 offen offset:0 sc1
v_mfma_f32_16x16x32_bf16 v[164:167], a[100:103], a[44:47], v[164:167]
ds_read_b128 a[132:135], v5 offset:23552
v_mfma_f32_16x16x32_bf16 v[164:167], a[96:99], a[40:43], v[164:167]
v_mfma_f32_16x16x32_bf16 v[188:191], a[96:99], a[48:51], v[188:191]
v_mfma_f32_16x16x32_bf16 v[188:191], a[100:103], a[52:55], v[188:191]
buffer_load_dwordx4 v1, s[4:7], s44 offen offset:0 sc1 lds
v_mfma_f32_16x16x32_bf16 v[212:215], a[100:103], a[60:63], v[212:215]
ds_read_b128 a[136:139], v5 offset:12288
v_mfma_f32_16x16x32_bf16 v[212:215], a[96:99], a[56:59], v[212:215]
v_mfma_f32_16x16x32_bf16 v[216:219], a[104:107], a[56:59], v[216:219]
ds_read_b128 a[140:143], v5 offset:18432
v_mfma_f32_16x16x32_bf16 v[216:219], a[108:111], a[60:63], v[216:219]
buffer_load_dwordx4 a[4:7], v2, s[40:43], s33 offen offset:0 sc1
v_mfma_f32_16x16x32_bf16 v[192:195], a[108:111], a[52:55], v[192:195]
ds_read_b128 a[144:147], v5 offset:13312
v_mfma_f32_16x16x32_bf16 v[192:195], a[104:107], a[48:51], v[192:195]
v_mfma_f32_16x16x32_bf16 v[168:171], a[104:107], a[40:43], v[168:171]
v_mfma_f32_16x16x32_bf16 v[168:171], a[108:111], a[44:47], v[168:171]
buffer_load_dwordx4 a[8:11], v2, s[40:43], s35 offen offset:1024 sc1
v_mfma_f32_16x16x32_bf16 v[144:147], a[108:111], a[36:39], v[144:147]
ds_read_b128 a[148:151], v5 offset:19456
v_mfma_f32_16x16x32_bf16 v[144:147], a[104:107], a[32:35], v[144:147]
v_mfma_f32_16x16x32_bf16 v[148:151], a[112:115], a[32:35], v[148:151]
v_mfma_f32_16x16x32_bf16 v[148:151], a[116:119], a[36:39], v[148:151]
buffer_load_dwordx4 v1, s[4:7], s44 offen offset:1024 sc1 lds
s_add_u32 m0, s18, 0x1e000
v_mfma_f32_16x16x32_bf16 v[172:175], a[116:119], a[44:47], v[172:175]
s_add_u32 s44, s50, 0x281e000
v_mfma_f32_16x16x32_bf16 v[172:175], a[112:115], a[40:43], v[172:175]
v_mfma_f32_16x16x32_bf16 v[196:199], a[112:115], a[48:51], v[196:199]
v_mfma_f32_16x16x32_bf16 v[196:199], a[116:119], a[52:55], v[196:199]
buffer_load_dwordx4 a[12:15], v2, s[40:43], s33 offen offset:1024 sc1
v_mfma_f32_16x16x32_bf16 v[220:223], a[116:119], a[60:63], v[220:223]
v_mfma_f32_16x16x32_bf16 v[220:223], a[112:115], a[56:59], v[220:223]
s_waitcnt lgkmcnt(0)
v_mfma_f32_16x16x32_bf16 v[224:227], a[128:131], a[56:59], v[224:227]
ds_read_b128 a[96:99], v5 offset:26624
v_mfma_f32_16x16x32_bf16 v[224:227], a[132:135], a[60:63], v[224:227]
buffer_load_dwordx4 a[16:19], v2, s[40:43], s35 offen offset:2048 sc1
v_mfma_f32_16x16x32_bf16 v[200:203], a[132:135], a[52:55], v[200:203]
ds_read_b128 a[100:103], v5 offset:32768
v_mfma_f32_16x16x32_bf16 v[200:203], a[128:131], a[48:51], v[200:203]
v_mfma_f32_16x16x32_bf16 v[176:179], a[128:131], a[40:43], v[176:179]
v_mfma_f32_16x16x32_bf16 v[176:179], a[132:135], a[44:47], v[176:179]
buffer_load_dwordx4 a[20:23], v2, s[40:43], s33 offen offset:2048 sc1
v_mfma_f32_16x16x32_bf16 v[152:155], a[132:135], a[36:39], v[152:155]
ds_read_b128 a[104:107], v5 offset:27648
v_mfma_f32_16x16x32_bf16 v[152:155], a[128:131], a[32:35], v[152:155]
v_mfma_f32_16x16x32_bf16 v[132:135], a[136:139], a[32:35], v[132:135]
ds_read_b128 a[108:111], v5 offset:33792
v_mfma_f32_16x16x32_bf16 v[132:135], a[140:143], a[36:39], v[132:135]
v_mfma_f32_16x16x32_bf16 v[156:159], a[140:143], a[44:47], v[156:159]
buffer_load_dwordx4 v1, s[4:7], s44 offen offset:0 sc1 lds
v_mfma_f32_16x16x32_bf16 v[156:159], a[136:139], a[40:43], v[156:159]
ds_read_b128 a[112:115], v5 offset:28672
v_mfma_f32_16x16x32_bf16 v[180:183], a[136:139], a[48:51], v[180:183]
v_mfma_f32_16x16x32_bf16 v[180:183], a[140:143], a[52:55], v[180:183]
ds_read_b128 a[116:119], v5 offset:34816
v_mfma_f32_16x16x32_bf16 v[204:207], a[140:143], a[60:63], v[204:207]
v_mfma_f32_16x16x32_bf16 v[204:207], a[136:139], a[56:59], v[204:207]
buffer_load_dwordx4 a[24:27], v2, s[40:43], s35 offen offset:3072 sc1
v_mfma_f32_16x16x32_bf16 v[208:211], a[144:147], a[56:59], v[208:211]
v_mfma_f32_16x16x32_bf16 v[208:211], a[148:151], a[60:63], v[208:211]
v_mfma_f32_16x16x32_bf16 v[184:187], a[148:151], a[52:55], v[184:187]
v_mfma_f32_16x16x32_bf16 v[184:187], a[144:147], a[48:51], v[184:187]
v_mfma_f32_16x16x32_bf16 v[160:163], a[144:147], a[40:43], v[160:163]
buffer_load_dwordx4 a[28:31], v2, s[40:43], s33 offen offset:3072 sc1
s_add_u32 s35, s35, 0x4000
v_mfma_f32_16x16x32_bf16 v[160:163], a[148:151], a[44:47], v[160:163]
s_add_u32 s33, s33, 0x4000
v_mfma_f32_16x16x32_bf16 v[136:139], a[148:151], a[36:39], v[136:139]
v_mfma_f32_16x16x32_bf16 v[136:139], a[144:147], a[32:35], v[136:139]
s_waitcnt vmcnt(11) lgkmcnt(0)
v_mfma_f32_16x16x32_bf16 v[140:143], a[96:99], a[64:67], v[140:143]
ds_read_b128 a[128:131], v5 offset:29696
v_mfma_f32_16x16x32_bf16 v[140:143], a[100:103], a[68:71], v[140:143]
buffer_load_dwordx4 a[32:35], v2, s[40:43], s35 offen offset:0 sc1
v_mfma_f32_16x16x32_bf16 v[164:167], a[100:103], a[76:79], v[164:167]
ds_read_b128 a[132:135], v5 offset:35840
v_mfma_f32_16x16x32_bf16 v[164:167], a[96:99], a[72:75], v[164:167]
v_mfma_f32_16x16x32_bf16 v[188:191], a[96:99], a[80:83], v[188:191]
v_mfma_f32_16x16x32_bf16 v[188:191], a[100:103], a[84:87], v[188:191]
buffer_load_dwordx4 a[36:39], v2, s[40:43], s33 offen offset:0 sc1
v_mfma_f32_16x16x32_bf16 v[212:215], a[100:103], a[92:95], v[212:215]
ds_read_b128 a[136:139], v5 offset:24576
v_mfma_f32_16x16x32_bf16 v[212:215], a[96:99], a[88:91], v[212:215]
v_mfma_f32_16x16x32_bf16 v[216:219], a[104:107], a[88:91], v[216:219]
ds_read_b128 a[140:143], v5 offset:30720
v_mfma_f32_16x16x32_bf16 v[216:219], a[108:111], a[92:95], v[216:219]
v_mfma_f32_16x16x32_bf16 v[192:195], a[108:111], a[84:87], v[192:195]
buffer_load_dwordx4 v1, s[4:7], s44 offen offset:1024 sc1 lds
s_add_u32 m0, s18, 0x20000
v_mfma_f32_16x16x32_bf16 v[192:195], a[104:107], a[80:83], v[192:195]
s_add_u32 s44, s50, 0x2820000
ds_read_b128 a[144:147], v5 offset:25600
v_mfma_f32_16x16x32_bf16 v[168:171], a[104:107], a[72:75], v[168:171]
v_mfma_f32_16x16x32_bf16 v[168:171], a[108:111], a[76:79], v[168:171]
ds_read_b128 a[148:151], v5 offset:31744
v_mfma_f32_16x16x32_bf16 v[144:147], a[108:111], a[68:71], v[144:147]
v_mfma_f32_16x16x32_bf16 v[144:147], a[104:107], a[64:67], v[144:147]
buffer_load_dwordx4 a[40:43], v2, s[40:43], s35 offen offset:1024 sc1
v_mfma_f32_16x16x32_bf16 v[148:151], a[112:115], a[64:67], v[148:151]
v_mfma_f32_16x16x32_bf16 v[148:151], a[116:119], a[68:71], v[148:151]
v_mfma_f32_16x16x32_bf16 v[172:175], a[116:119], a[76:79], v[172:175]
v_mfma_f32_16x16x32_bf16 v[172:175], a[112:115], a[72:75], v[172:175]
v_mfma_f32_16x16x32_bf16 v[196:199], a[112:115], a[80:83], v[196:199]
buffer_load_dwordx4 a[44:47], v2, s[40:43], s33 offen offset:1024 sc1
v_mfma_f32_16x16x32_bf16 v[196:199], a[116:119], a[84:87], v[196:199]
v_mfma_f32_16x16x32_bf16 v[220:223], a[116:119], a[92:95], v[220:223]
v_mfma_f32_16x16x32_bf16 v[220:223], a[112:115], a[88:91], v[220:223]
s_waitcnt lgkmcnt(0)
v_mfma_f32_16x16x32_bf16 v[224:227], a[128:131], a[88:91], v[224:227]
ds_read_b128 a[96:99], v5 offset:38912
v_mfma_f32_16x16x32_bf16 v[224:227], a[132:135], a[92:95], v[224:227]
buffer_load_dwordx4 a[48:51], v2, s[40:43], s35 offen offset:2048 sc1
v_mfma_f32_16x16x32_bf16 v[200:203], a[132:135], a[84:87], v[200:203]
ds_read_b128 a[100:103], v5 offset:45056
v_mfma_f32_16x16x32_bf16 v[200:203], a[128:131], a[80:83], v[200:203]
v_mfma_f32_16x16x32_bf16 v[176:179], a[128:131], a[72:75], v[176:179]
v_mfma_f32_16x16x32_bf16 v[176:179], a[132:135], a[76:79], v[176:179]
buffer_load_dwordx4 a[52:55], v2, s[40:43], s33 offen offset:2048 sc1
v_mfma_f32_16x16x32_bf16 v[152:155], a[132:135], a[68:71], v[152:155]
ds_read_b128 a[104:107], v5 offset:39936
v_mfma_f32_16x16x32_bf16 v[152:155], a[128:131], a[64:67], v[152:155]
v_mfma_f32_16x16x32_bf16 v[132:135], a[136:139], a[64:67], v[132:135]
ds_read_b128 a[108:111], v5 offset:46080
v_mfma_f32_16x16x32_bf16 v[132:135], a[140:143], a[68:71], v[132:135]
v_mfma_f32_16x16x32_bf16 v[156:159], a[140:143], a[76:79], v[156:159]
buffer_load_dwordx4 v1, s[4:7], s44 offen offset:0 sc1 lds
v_mfma_f32_16x16x32_bf16 v[156:159], a[136:139], a[72:75], v[156:159]
ds_read_b128 a[112:115], v5 offset:40960
v_mfma_f32_16x16x32_bf16 v[180:183], a[136:139], a[80:83], v[180:183]
v_mfma_f32_16x16x32_bf16 v[180:183], a[140:143], a[84:87], v[180:183]
ds_read_b128 a[116:119], v5 offset:47104
v_mfma_f32_16x16x32_bf16 v[204:207], a[140:143], a[92:95], v[204:207]
v_mfma_f32_16x16x32_bf16 v[204:207], a[136:139], a[88:91], v[204:207]
buffer_load_dwordx4 a[56:59], v2, s[40:43], s35 offen offset:3072 sc1
v_mfma_f32_16x16x32_bf16 v[208:211], a[144:147], a[88:91], v[208:211]
v_mfma_f32_16x16x32_bf16 v[208:211], a[148:151], a[92:95], v[208:211]
v_mfma_f32_16x16x32_bf16 v[184:187], a[148:151], a[84:87], v[184:187]
v_mfma_f32_16x16x32_bf16 v[184:187], a[144:147], a[80:83], v[184:187]
v_mfma_f32_16x16x32_bf16 v[160:163], a[144:147], a[72:75], v[160:163]
buffer_load_dwordx4 a[60:63], v2, s[40:43], s33 offen offset:3072 sc1
s_add_u32 s35, s35, 0x4000
v_mfma_f32_16x16x32_bf16 v[160:163], a[148:151], a[76:79], v[160:163]
s_add_u32 s33, s33, 0x4000
v_mfma_f32_16x16x32_bf16 v[136:139], a[148:151], a[68:71], v[136:139]
v_mfma_f32_16x16x32_bf16 v[136:139], a[144:147], a[64:67], v[136:139]
s_waitcnt vmcnt(10) lgkmcnt(0)
v_mfma_f32_16x16x32_bf16 v[140:143], a[96:99], a[0:3], v[140:143]
ds_read_b128 a[128:131], v5 offset:41984
v_mfma_f32_16x16x32_bf16 v[140:143], a[100:103], a[4:7], v[140:143]
buffer_load_dwordx4 a[64:67], v2, s[40:43], s35 offen offset:0 sc1
v_mfma_f32_16x16x32_bf16 v[164:167], a[100:103], a[12:15], v[164:167]
ds_read_b128 a[132:135], v5 offset:48128
v_mfma_f32_16x16x32_bf16 v[164:167], a[96:99], a[8:11], v[164:167]
v_mfma_f32_16x16x32_bf16 v[188:191], a[96:99], a[16:19], v[188:191]
v_mfma_f32_16x16x32_bf16 v[188:191], a[100:103], a[20:23], v[188:191]
buffer_load_dwordx4 v1, s[4:7], s44 offen offset:1024 sc1 lds
s_add_u32 m0, s18, 0x22000
v_mfma_f32_16x16x32_bf16 v[212:215], a[100:103], a[28:31], v[212:215]
s_add_u32 s44, s50, 0x2822000
ds_read_b128 a[136:139], v5 offset:36864
v_mfma_f32_16x16x32_bf16 v[212:215], a[96:99], a[24:27], v[212:215]
v_mfma_f32_16x16x32_bf16 v[216:219], a[104:107], a[24:27], v[216:219]
ds_read_b128 a[140:143], v5 offset:43008
v_mfma_f32_16x16x32_bf16 v[216:219], a[108:111], a[28:31], v[216:219]
buffer_load_dwordx4 a[68:71], v2, s[40:43], s33 offen offset:0 sc1
v_mfma_f32_16x16x32_bf16 v[192:195], a[108:111], a[20:23], v[192:195]
ds_read_b128 a[144:147], v5 offset:37888
v_mfma_f32_16x16x32_bf16 v[192:195], a[104:107], a[16:19], v[192:195]
v_mfma_f32_16x16x32_bf16 v[168:171], a[104:107], a[8:11], v[168:171]
v_mfma_f32_16x16x32_bf16 v[168:171], a[108:111], a[12:15], v[168:171]
buffer_load_dwordx4 a[72:75], v2, s[40:43], s35 offen offset:1024 sc1
v_mfma_f32_16x16x32_bf16 v[144:147], a[108:111], a[4:7], v[144:147]
ds_read_b128 a[148:151], v5 offset:44032
v_mfma_f32_16x16x32_bf16 v[144:147], a[104:107], a[0:3], v[144:147]
v_mfma_f32_16x16x32_bf16 v[148:151], a[112:115], a[0:3], v[148:151]
v_mfma_f32_16x16x32_bf16 v[148:151], a[116:119], a[4:7], v[148:151]
buffer_load_dwordx4 v1, s[4:7], s44 offen offset:0 sc1 lds
v_mfma_f32_16x16x32_bf16 v[172:175], a[116:119], a[12:15], v[172:175]
v_mfma_f32_16x16x32_bf16 v[172:175], a[112:115], a[8:11], v[172:175]
v_mfma_f32_16x16x32_bf16 v[196:199], a[112:115], a[16:19], v[196:199]
v_mfma_f32_16x16x32_bf16 v[196:199], a[116:119], a[20:23], v[196:199]
buffer_load_dwordx4 a[76:79], v2, s[40:43], s33 offen offset:1024 sc1
v_mfma_f32_16x16x32_bf16 v[220:223], a[116:119], a[28:31], v[220:223]
v_mfma_f32_16x16x32_bf16 v[220:223], a[112:115], a[24:27], v[220:223]
s_waitcnt lgkmcnt(0)
s_barrier
v_mfma_f32_16x16x32_bf16 v[224:227], a[128:131], a[24:27], v[224:227]
v_add_u32 v5, 49152, v1
v_mfma_f32_16x16x32_bf16 v[224:227], a[132:135], a[28:31], v[224:227]
buffer_load_dwordx4 a[80:83], v2, s[40:43], s35 offen offset:2048 sc1
v_mfma_f32_16x16x32_bf16 v[200:203], a[132:135], a[20:23], v[200:203]
ds_read_b128 a[96:99], v5 offset:2048
v_mfma_f32_16x16x32_bf16 v[200:203], a[128:131], a[16:19], v[200:203]
ds_read_b128 a[100:103], v5 offset:8192
v_mfma_f32_16x16x32_bf16 v[176:179], a[128:131], a[8:11], v[176:179]
v_mfma_f32_16x16x32_bf16 v[176:179], a[132:135], a[12:15], v[176:179]
buffer_load_dwordx4 a[84:87], v2, s[40:43], s33 offen offset:2048 sc1
v_mfma_f32_16x16x32_bf16 v[152:155], a[132:135], a[4:7], v[152:155]
ds_read_b128 a[104:107], v5 offset:3072
v_mfma_f32_16x16x32_bf16 v[152:155], a[128:131], a[0:3], v[152:155]
v_mfma_f32_16x16x32_bf16 v[132:135], a[136:139], a[0:3], v[132:135]
ds_read_b128 a[108:111], v5 offset:9216
v_mfma_f32_16x16x32_bf16 v[132:135], a[140:143], a[4:7], v[132:135]
v_mfma_f32_16x16x32_bf16 v[156:159], a[140:143], a[12:15], v[156:159]
buffer_load_dwordx4 v1, s[4:7], s44 offen offset:1024 sc1 lds
s_add_u32 s88, s82, 0x300000
v_mfma_f32_16x16x32_bf16 v[156:159], a[136:139], a[8:11], v[156:159]
ds_read_b128 a[112:115], v5 offset:4096
v_mfma_f32_16x16x32_bf16 v[180:183], a[136:139], a[16:19], v[180:183]
v_mfma_f32_16x16x32_bf16 v[180:183], a[140:143], a[20:23], v[180:183]
ds_read_b128 a[116:119], v5 offset:10240
v_mfma_f32_16x16x32_bf16 v[204:207], a[140:143], a[28:31], v[204:207]
v_mfma_f32_16x16x32_bf16 v[204:207], a[136:139], a[24:27], v[204:207]
buffer_load_dwordx4 a[88:91], v2, s[40:43], s35 offen offset:3072 sc1
v_mfma_f32_16x16x32_bf16 v[208:211], a[144:147], a[24:27], v[208:211]
v_mfma_f32_16x16x32_bf16 v[208:211], a[148:151], a[28:31], v[208:211]
v_mfma_f32_16x16x32_bf16 v[184:187], a[148:151], a[20:23], v[184:187]
v_mfma_f32_16x16x32_bf16 v[184:187], a[144:147], a[16:19], v[184:187]
v_mfma_f32_16x16x32_bf16 v[160:163], a[144:147], a[8:11], v[160:163]
buffer_load_dwordx4 a[92:95], v2, s[40:43], s33 offen offset:3072 sc1
s_add_u32 s35, s35, 0x4000
v_mfma_f32_16x16x32_bf16 v[160:163], a[148:151], a[12:15], v[160:163]
s_add_u32 s33, s33, 0x4000
v_mfma_f32_16x16x32_bf16 v[136:139], a[148:151], a[4:7], v[136:139]
v_mfma_f32_16x16x32_bf16 v[136:139], a[144:147], a[0:3], v[136:139]
s_waitcnt vmcnt(11) lgkmcnt(0)
v_mfma_f32_16x16x32_bf16 v[140:143], a[96:99], a[32:35], v[140:143]
ds_read_b128 a[128:131], v5 offset:5120
v_mfma_f32_16x16x32_bf16 v[140:143], a[100:103], a[36:39], v[140:143]
buffer_load_dwordx4 a[0:3], v2, s[40:43], s35 offen offset:0 sc1
v_mfma_f32_16x16x32_bf16 v[164:167], a[100:103], a[44:47], v[164:167]
ds_read_b128 a[132:135], v5 offset:11264
v_mfma_f32_16x16x32_bf16 v[164:167], a[96:99], a[40:43], v[164:167]
v_mfma_f32_16x16x32_bf16 v[188:191], a[96:99], a[48:51], v[188:191]
v_mfma_f32_16x16x32_bf16 v[188:191], a[100:103], a[52:55], v[188:191]
buffer_load_dwordx4 a[4:7], v2, s[40:43], s33 offen offset:0 sc1
v_mfma_f32_16x16x32_bf16 v[212:215], a[100:103], a[60:63], v[212:215]
ds_read_b128 a[136:139], v5 offset:0
v_mfma_f32_16x16x32_bf16 v[212:215], a[96:99], a[56:59], v[212:215]
v_mfma_f32_16x16x32_bf16 v[216:219], a[104:107], a[56:59], v[216:219]
ds_read_b128 a[140:143], v5 offset:6144
v_mfma_f32_16x16x32_bf16 v[216:219], a[108:111], a[60:63], v[216:219]
v_mfma_f32_16x16x32_bf16 v[192:195], a[108:111], a[52:55], v[192:195]
buffer_load_dwordx4 v[92:95], v1, s[4:7], s88 offen offset:0 sc1
v_mfma_f32_16x16x32_bf16 v[192:195], a[104:107], a[48:51], v[192:195]
ds_read_b128 a[144:147], v5 offset:1024
v_mfma_f32_16x16x32_bf16 v[168:171], a[104:107], a[40:43], v[168:171]
v_mfma_f32_16x16x32_bf16 v[168:171], a[108:111], a[44:47], v[168:171]
ds_read_b128 a[148:151], v5 offset:7168
v_mfma_f32_16x16x32_bf16 v[144:147], a[108:111], a[36:39], v[144:147]
v_mfma_f32_16x16x32_bf16 v[144:147], a[104:107], a[32:35], v[144:147]
buffer_load_dwordx4 a[8:11], v2, s[40:43], s35 offen offset:1024 sc1
v_mfma_f32_16x16x32_bf16 v[148:151], a[112:115], a[32:35], v[148:151]
v_mfma_f32_16x16x32_bf16 v[148:151], a[116:119], a[36:39], v[148:151]
v_mfma_f32_16x16x32_bf16 v[172:175], a[116:119], a[44:47], v[172:175]
v_mfma_f32_16x16x32_bf16 v[172:175], a[112:115], a[40:43], v[172:175]
v_mfma_f32_16x16x32_bf16 v[196:199], a[112:115], a[48:51], v[196:199]
buffer_load_dwordx4 a[12:15], v2, s[40:43], s33 offen offset:1024 sc1
v_mfma_f32_16x16x32_bf16 v[196:199], a[116:119], a[52:55], v[196:199]
v_mfma_f32_16x16x32_bf16 v[220:223], a[116:119], a[60:63], v[220:223]
v_mfma_f32_16x16x32_bf16 v[220:223], a[112:115], a[56:59], v[220:223]
s_waitcnt lgkmcnt(0)
v_mfma_f32_16x16x32_bf16 v[224:227], a[128:131], a[56:59], v[224:227]
ds_read_b128 a[96:99], v5 offset:14336
v_mfma_f32_16x16x32_bf16 v[224:227], a[132:135], a[60:63], v[224:227]
buffer_load_dwordx4 a[16:19], v2, s[40:43], s35 offen offset:2048 sc1
v_mfma_f32_16x16x32_bf16 v[200:203], a[132:135], a[52:55], v[200:203]
ds_read_b128 a[100:103], v5 offset:20480
v_mfma_f32_16x16x32_bf16 v[200:203], a[128:131], a[48:51], v[200:203]
v_mfma_f32_16x16x32_bf16 v[176:179], a[128:131], a[40:43], v[176:179]
v_mfma_f32_16x16x32_bf16 v[176:179], a[132:135], a[44:47], v[176:179]
buffer_load_dwordx4 a[20:23], v2, s[40:43], s33 offen offset:2048 sc1
v_mfma_f32_16x16x32_bf16 v[152:155], a[132:135], a[36:39], v[152:155]
ds_read_b128 a[104:107], v5 offset:15360
v_mfma_f32_16x16x32_bf16 v[152:155], a[128:131], a[32:35], v[152:155]
v_mfma_f32_16x16x32_bf16 v[132:135], a[136:139], a[32:35], v[132:135]
ds_read_b128 a[108:111], v5 offset:21504
v_mfma_f32_16x16x32_bf16 v[132:135], a[140:143], a[36:39], v[132:135]
v_mfma_f32_16x16x32_bf16 v[156:159], a[140:143], a[44:47], v[156:159]
buffer_load_dwordx4 v[96:99], v1, s[4:7], s88 offen offset:1024 sc1
v_mfma_f32_16x16x32_bf16 v[156:159], a[136:139], a[40:43], v[156:159]
ds_read_b128 a[112:115], v5 offset:16384
v_mfma_f32_16x16x32_bf16 v[180:183], a[136:139], a[48:51], v[180:183]
v_mfma_f32_16x16x32_bf16 v[180:183], a[140:143], a[52:55], v[180:183]
ds_read_b128 a[116:119], v5 offset:22528
v_mfma_f32_16x16x32_bf16 v[204:207], a[140:143], a[60:63], v[204:207]
v_mfma_f32_16x16x32_bf16 v[204:207], a[136:139], a[56:59], v[204:207]
buffer_load_dwordx4 a[24:27], v2, s[40:43], s35 offen offset:3072 sc1
v_mfma_f32_16x16x32_bf16 v[208:211], a[144:147], a[56:59], v[208:211]
v_mfma_f32_16x16x32_bf16 v[208:211], a[148:151], a[60:63], v[208:211]
v_mfma_f32_16x16x32_bf16 v[184:187], a[148:151], a[52:55], v[184:187]
v_mfma_f32_16x16x32_bf16 v[184:187], a[144:147], a[48:51], v[184:187]
v_mfma_f32_16x16x32_bf16 v[160:163], a[144:147], a[40:43], v[160:163]
buffer_load_dwordx4 a[28:31], v2, s[40:43], s33 offen offset:3072 sc1
s_add_u32 s35, s35, 0x4000
v_mfma_f32_16x16x32_bf16 v[160:163], a[148:151], a[44:47], v[160:163]
s_add_u32 s33, s33, 0x4000
v_mfma_f32_16x16x32_bf16 v[136:139], a[148:151], a[36:39], v[136:139]
v_mfma_f32_16x16x32_bf16 v[136:139], a[144:147], a[32:35], v[136:139]
s_waitcnt vmcnt(10) lgkmcnt(0)
v_mfma_f32_16x16x32_bf16 v[140:143], a[96:99], a[64:67], v[140:143]
ds_read_b128 a[128:131], v5 offset:17408
v_mfma_f32_16x16x32_bf16 v[140:143], a[100:103], a[68:71], v[140:143]
buffer_load_dwordx4 a[32:35], v2, s[40:43], s35 offen offset:0 sc1
v_mfma_f32_16x16x32_bf16 v[164:167], a[100:103], a[76:79], v[164:167]
ds_read_b128 a[132:135], v5 offset:23552
L_stub5:
s_cbranch_execz L_stub6
v_mfma_f32_16x16x32_bf16 v[164:167], a[96:99], a[72:75], v[164:167]
v_mfma_f32_16x16x32_bf16 v[188:191], a[96:99], a[80:83], v[188:191]
v_mfma_f32_16x16x32_bf16 v[188:191], a[100:103], a[84:87], v[188:191]
buffer_load_dwordx4 v[100:103], v1, s[4:7], s88 offen offset:2048 sc1
v_mfma_f32_16x16x32_bf16 v[212:215], a[100:103], a[92:95], v[212:215]
ds_read_b128 a[136:139], v5 offset:12288
v_mfma_f32_16x16x32_bf16 v[212:215], a[96:99], a[88:91], v[212:215]
v_mfma_f32_16x16x32_bf16 v[216:219], a[104:107], a[88:91], v[216:219]
ds_read_b128 a[140:143], v5 offset:18432
v_mfma_f32_16x16x32_bf16 v[216:219], a[108:111], a[92:95], v[216:219]
buffer_load_dwordx4 a[36:39], v2, s[40:43], s33 offen offset:0 sc1
v_mfma_f32_16x16x32_bf16 v[192:195], a[108:111], a[84:87], v[192:195]
ds_read_b128 a[144:147], v5 offset:13312
v_mfma_f32_16x16x32_bf16 v[192:195], a[104:107], a[80:83], v[192:195]
v_mfma_f32_16x16x32_bf16 v[168:171], a[104:107], a[72:75], v[168:171]
v_mfma_f32_16x16x32_bf16 v[168:171], a[108:111], a[76:79], v[168:171]
buffer_load_dwordx4 a[40:43], v2, s[40:43], s35 offen offset:1024 sc1
v_mfma_f32_16x16x32_bf16 v[144:147], a[108:111], a[68:71], v[144:147]
ds_read_b128 a[148:151], v5 offset:19456
v_mfma_f32_16x16x32_bf16 v[144:147], a[104:107], a[64:67], v[144:147]
v_mfma_f32_16x16x32_bf16 v[148:151], a[112:115], a[64:67], v[148:151]
v_mfma_f32_16x16x32_bf16 v[148:151], a[116:119], a[68:71], v[148:151]
buffer_load_dwordx4 v[104:107], v1, s[4:7], s88 offen offset:3072 sc1
s_add_u32 s88, s88, 4096
v_mfma_f32_16x16x32_bf16 v[172:175], a[116:119], a[76:79], v[172:175]
v_mfma_f32_16x16x32_bf16 v[172:175], a[112:115], a[72:75], v[172:175]
v_mfma_f32_16x16x32_bf16 v[196:199], a[112:115], a[80:83], v[196:199]
v_mfma_f32_16x16x32_bf16 v[196:199], a[116:119], a[84:87], v[196:199]
buffer_load_dwordx4 a[44:47], v2, s[40:43], s33 offen offset:1024 sc1
v_mfma_f32_16x16x32_bf16 v[220:223], a[116:119], a[92:95], v[220:223]
v_mfma_f32_16x16x32_bf16 v[220:223], a[112:115], a[88:91], v[220:223]
s_waitcnt lgkmcnt(0)
v_mfma_f32_16x16x32_bf16 v[224:227], a[128:131], a[88:91], v[224:227]
ds_read_b128 a[96:99], v5 offset:26624
v_mfma_f32_16x16x32_bf16 v[224:227], a[132:135], a[92:95], v[224:227]
buffer_load_dwordx4 a[48:51], v2, s[40:43], s35 offen offset:2048 sc1
v_mfma_f32_16x16x32_bf16 v[200:203], a[132:135], a[84:87], v[200:203]
ds_read_b128 a[100:103], v5 offset:32768
v_mfma_f32_16x16x32_bf16 v[200:203], a[128:131], a[80:83], v[200:203]
v_mfma_f32_16x16x32_bf16 v[176:179], a[128:131], a[72:75], v[176:179]
v_mfma_f32_16x16x32_bf16 v[176:179], a[132:135], a[76:79], v[176:179]
buffer_load_dwordx4 a[52:55], v2, s[40:43], s33 offen offset:2048 sc1
v_mfma_f32_16x16x32_bf16 v[152:155], a[132:135], a[68:71], v[152:155]
ds_read_b128 a[104:107], v5 offset:27648
v_mfma_f32_16x16x32_bf16 v[152:155], a[128:131], a[64:67], v[152:155]
v_mfma_f32_16x16x32_bf16 v[132:135], a[136:139], a[64:67], v[132:135]
ds_read_b128 a[108:111], v5 offset:33792
v_mfma_f32_16x16x32_bf16 v[132:135], a[140:143], a[68:71], v[132:135]
v_mfma_f32_16x16x32_bf16 v[156:159], a[140:143], a[76:79], v[156:159]
buffer_load_dwordx4 v[108:111], v1, s[4:7], s88 offen offset:0 sc1
v_mfma_f32_16x16x32_bf16 v[156:159], a[136:139], a[72:75], v[156:159]
ds_read_b128 a[112:115], v5 offset:28672
v_mfma_f32_16x16x32_bf16 v[180:183], a[136:139], a[80:83], v[180:183]
v_mfma_f32_16x16x32_bf16 v[180:183], a[140:143], a[84:87], v[180:183]
ds_read_b128 a[116:119], v5 offset:34816
v_mfma_f32_16x16x32_bf16 v[204:207], a[140:143], a[92:95], v[204:207]
v_mfma_f32_16x16x32_bf16 v[204:207], a[136:139], a[88:91], v[204:207]
buffer_load_dwordx4 a[56:59], v2, s[40:43], s35 offen offset:3072 sc1
v_mfma_f32_16x16x32_bf16 v[208:211], a[144:147], a[88:91], v[208:211]
v_mfma_f32_16x16x32_bf16 v[208:211], a[148:151], a[92:95], v[208:211]
v_mfma_f32_16x16x32_bf16 v[184:187], a[148:151], a[84:87], v[184:187]
v_mfma_f32_16x16x32_bf16 v[184:187], a[144:147], a[80:83], v[184:187]
v_mfma_f32_16x16x32_bf16 v[160:163], a[144:147], a[72:75], v[160:163]
buffer_load_dwordx4 a[60:63], v2, s[40:43], s33 offen offset:3072 sc1
s_add_u32 s35, s35, 0x64000
v_mfma_f32_16x16x32_bf16 v[160:163], a[148:151], a[76:79], v[160:163]
s_add_u32 s33, s33, 0x64000
v_mfma_f32_16x16x32_bf16 v[136:139], a[148:151], a[68:71], v[136:139]
v_mfma_f32_16x16x32_bf16 v[136:139], a[144:147], a[64:67], v[136:139]
s_waitcnt vmcnt(11) lgkmcnt(0)
v_mfma_f32_16x16x32_bf16 v[140:143], a[96:99], a[0:3], v[140:143]
ds_read_b128 a[128:131], v5 offset:29696
v_add_f32_dpp v48, v48, v48 row_ror:8 row_mask:0xf bank_mask:0xf
v_mfma_f32_16x16x32_bf16 v[140:143], a[100:103], a[4:7], v[140:143]
buffer_load_dwordx4 a[64:67], v2, s[40:43], s35 offen offset:0 sc1
v_mfma_f32_16x16x32_bf16 v[164:167], a[100:103], a[12:15], v[164:167]
ds_read_b128 a[132:135], v5 offset:35840
v_add_f32_dpp v49, v49, v49 row_ror:8 row_mask:0xf bank_mask:0xf
v_mfma_f32_16x16x32_bf16 v[164:167], a[96:99], a[8:11], v[164:167]
v_add_f32_dpp v50, v50, v50 row_ror:8 row_mask:0xf bank_mask:0xf
v_add_f32_dpp v51, v51, v51 row_ror:8 row_mask:0xf bank_mask:0xf
v_mfma_f32_16x16x32_bf16 v[188:191], a[96:99], a[16:19], v[188:191]
v_add_f32_dpp v52, v52, v52 row_ror:8 row_mask:0xf bank_mask:0xf
v_add_f32_dpp v53, v53, v53 row_ror:8 row_mask:0xf bank_mask:0xf
v_mfma_f32_16x16x32_bf16 v[188:191], a[100:103], a[20:23], v[188:191]
buffer_load_dwordx4 a[68:71], v2, s[40:43], s33 offen offset:0 sc1
v_mfma_f32_16x16x32_bf16 v[212:215], a[100:103], a[28:31], v[212:215]
ds_read_b128 a[136:139], v5 offset:24576
v_add_f32_dpp v54, v54, v54 row_ror:8 row_mask:0xf bank_mask:0xf
v_mfma_f32_16x16x32_bf16 v[212:215], a[96:99], a[24:27], v[212:215]
v_add_f32_dpp v55, v55, v55 row_ror:8 row_mask:0xf bank_mask:0xf
v_add_f32_dpp v48, v48, v48 row_ror:4 row_mask:0xf bank_mask:0xf
v_mfma_f32_16x16x32_bf16 v[216:219], a[104:107], a[24:27], v[216:219]
ds_read_b128 a[140:143], v5 offset:30720
v_add_f32_dpp v49, v49, v49 row_ror:4 row_mask:0xf bank_mask:0xf
v_mfma_f32_16x16x32_bf16 v[216:219], a[108:111], a[28:31], v[216:219]
v_add_f32_dpp v50, v50, v50 row_ror:4 row_mask:0xf bank_mask:0xf
v_mfma_f32_16x16x32_bf16 v[192:195], a[108:111], a[20:23], v[192:195]
buffer_load_dwordx4 v[112:115], v1, s[4:7], s88 offen offset:1024 sc1
v_mfma_f32_16x16x32_bf16 v[192:195], a[104:107], a[16:19], v[192:195]
ds_read_b128 a[144:147], v5 offset:25600
v_add_f32_dpp v51, v51, v51 row_ror:4 row_mask:0xf bank_mask:0xf
v_mfma_f32_16x16x32_bf16 v[168:171], a[104:107], a[8:11], v[168:171]
v_add_f32_dpp v52, v52, v52 row_ror:4 row_mask:0xf bank_mask:0xf
v_add_f32_dpp v53, v53, v53 row_ror:4 row_mask:0xf bank_mask:0xf
v_mfma_f32_16x16x32_bf16 v[168:171], a[108:111], a[12:15], v[168:171]
ds_read_b128 a[148:151], v5 offset:31744
v_add_f32_dpp v54, v54, v54 row_ror:4 row_mask:0xf bank_mask:0xf
v_mfma_f32_16x16x32_bf16 v[144:147], a[108:111], a[4:7], v[144:147]
v_add_f32_dpp v55, v55, v55 row_ror:4 row_mask:0xf bank_mask:0xf
v_mfma_f32_16x16x32_bf16 v[144:147], a[104:107], a[0:3], v[144:147]
buffer_load_dwordx4 a[72:75], v2, s[40:43], s35 offen offset:1024 sc1
v_mfma_f32_16x16x32_bf16 v[148:151], a[112:115], a[0:3], v[148:151]
v_add_f32_dpp v48, v48, v48 row_ror:2 row_mask:0xf bank_mask:0xf
v_add_f32_dpp v49, v49, v49 row_ror:2 row_mask:0xf bank_mask:0xf
v_mfma_f32_16x16x32_bf16 v[148:151], a[116:119], a[4:7], v[148:151]
v_add_f32_dpp v50, v50, v50 row_ror:2 row_mask:0xf bank_mask:0xf
v_mfma_f32_16x16x32_bf16 v[172:175], a[116:119], a[12:15], v[172:175]
v_add_f32_dpp v51, v51, v51 row_ror:2 row_mask:0xf bank_mask:0xf
v_mfma_f32_16x16x32_bf16 v[172:175], a[112:115], a[8:11], v[172:175]
v_add_f32_dpp v52, v52, v52 row_ror:2 row_mask:0xf bank_mask:0xf
v_mfma_f32_16x16x32_bf16 v[196:199], a[112:115], a[16:19], v[196:199]
buffer_load_dwordx4 a[76:79], v2, s[40:43], s33 offen offset:1024 sc1
v_mfma_f32_16x16x32_bf16 v[196:199], a[116:119], a[20:23], v[196:199]
v_add_f32_dpp v53, v53, v53 row_ror:2 row_mask:0xf bank_mask:0xf
v_add_f32_dpp v54, v54, v54 row_ror:2 row_mask:0xf bank_mask:0xf
v_mfma_f32_16x16x32_bf16 v[220:223], a[116:119], a[28:31], v[220:223]
v_add_f32_dpp v55, v55, v55 row_ror:2 row_mask:0xf bank_mask:0xf
v_mfma_f32_16x16x32_bf16 v[220:223], a[112:115], a[24:27], v[220:223]
v_add_f32_dpp v48, v48, v48 row_ror:1 row_mask:0xf bank_mask:0xf
s_waitcnt lgkmcnt(0)
v_mfma_f32_16x16x32_bf16 v[224:227], a[128:131], a[24:27], v[224:227]
ds_read_b128 a[96:99], v5 offset:38912
v_add_f32_dpp v49, v49, v49 row_ror:1 row_mask:0xf bank_mask:0xf
v_mfma_f32_16x16x32_bf16 v[224:227], a[132:135], a[28:31], v[224:227]
buffer_load_dwordx4 a[80:83], v2, s[40:43], s35 offen offset:2048 sc1
v_mfma_f32_16x16x32_bf16 v[200:203], a[132:135], a[20:23], v[200:203]
ds_read_b128 a[100:103], v5 offset:45056
v_add_f32_dpp v50, v50, v50 row_ror:1 row_mask:0xf bank_mask:0xf
v_mfma_f32_16x16x32_bf16 v[200:203], a[128:131], a[16:19], v[200:203]
v_add_f32_dpp v51, v51, v51 row_ror:1 row_mask:0xf bank_mask:0xf
v_add_f32_dpp v52, v52, v52 row_ror:1 row_mask:0xf bank_mask:0xf
v_mfma_f32_16x16x32_bf16 v[176:179], a[128:131], a[8:11], v[176:179]
v_add_f32_dpp v53, v53, v53 row_ror:1 row_mask:0xf bank_mask:0xf
v_add_f32_dpp v54, v54, v54 row_ror:1 row_mask:0xf bank_mask:0xf
v_mfma_f32_16x16x32_bf16 v[176:179], a[132:135], a[12:15], v[176:179]
buffer_load_dwordx4 a[84:87], v2, s[40:43], s33 offen offset:2048 sc1
v_mfma_f32_16x16x32_bf16 v[152:155], a[132:135], a[4:7], v[152:155]
ds_read_b128 a[104:107], v5 offset:39936
v_add_f32_dpp v55, v55, v55 row_ror:1 row_mask:0xf bank_mask:0xf
v_mfma_f32_16x16x32_bf16 v[152:155], a[128:131], a[0:3], v[152:155]
v_add_u32 v233, 159744, v233
s_lshl_b32 s36, s28, 6
v_mfma_f32_16x16x32_bf16 v[132:135], a[136:139], a[0:3], v[132:135]
ds_read_b128 a[108:111], v5 offset:46080
s_lshl_b32 s37, s39, 6
v_mfma_f32_16x16x32_bf16 v[132:135], a[140:143], a[4:7], v[132:135]
v_add_u32 v232, s36, v233
v_mfma_f32_16x16x32_bf16 v[156:159], a[140:143], a[12:15], v[156:159]
buffer_load_dwordx4 v[116:119], v1, s[4:7], s88 offen offset:2048 sc1
v_mfma_f32_16x16x32_bf16 v[156:159], a[136:139], a[8:11], v[156:159]
ds_read_b128 a[112:115], v5 offset:40960
v_add_u32 v235, s37, v233
v_mfma_f32_16x16x32_bf16 v[180:183], a[136:139], a[16:19], v[180:183]
v_mfma_f32_16x16x32_bf16 v[180:183], a[140:143], a[20:23], v[180:183]
ds_read_b128 a[116:119], v5 offset:47104
v_mfma_f32_16x16x32_bf16 v[204:207], a[140:143], a[28:31], v[204:207]
v_mfma_f32_16x16x32_bf16 v[204:207], a[136:139], a[24:27], v[204:207]
buffer_load_dwordx4 a[88:91], v2, s[40:43], s35 offen offset:3072 sc1
v_mfma_f32_16x16x32_bf16 v[208:211], a[144:147], a[24:27], v[208:211]
v_mfma_f32_16x16x32_bf16 v[208:211], a[148:151], a[28:31], v[208:211]
v_mfma_f32_16x16x32_bf16 v[184:187], a[148:151], a[20:23], v[184:187]
v_mfma_f32_16x16x32_bf16 v[184:187], a[144:147], a[16:19], v[184:187]
v_mfma_f32_16x16x32_bf16 v[160:163], a[144:147], a[8:11], v[160:163]
buffer_load_dwordx4 a[92:95], v2, s[40:43], s33 offen offset:3072 sc1
s_add_u32 s35, s35, 0x4000
v_mfma_f32_16x16x32_bf16 v[160:163], a[148:151], a[12:15], v[160:163]
s_add_u32 s33, s33, 0x4000
v_mfma_f32_16x16x32_bf16 v[136:139], a[148:151], a[4:7], v[136:139]
v_mfma_f32_16x16x32_bf16 v[136:139], a[144:147], a[0:3], v[136:139]
s_waitcnt vmcnt(10) lgkmcnt(0)
v_mfma_f32_16x16x32_bf16 v[140:143], a[96:99], a[32:35], v[140:143]
ds_read_b128 a[128:131], v5 offset:41984
v_mfma_f32_16x16x32_bf16 v[140:143], a[100:103], a[36:39], v[140:143]
buffer_load_dwordx4 a[0:3], v2, s[40:43], s35 offen offset:0 sc1
v_mfma_f32_16x16x32_bf16 v[164:167], a[100:103], a[44:47], v[164:167]
ds_read_b128 a[132:135], v5 offset:48128
v_mfma_f32_16x16x32_bf16 v[164:167], a[96:99], a[40:43], v[164:167]
ds_write_b128 v232, v[48:51]
v_mfma_f32_16x16x32_bf16 v[188:191], a[96:99], a[48:51], v[188:191]
ds_write_b128 v235, v[52:55]
v_mfma_f32_16x16x32_bf16 v[188:191], a[100:103], a[52:55], v[188:191]
buffer_load_dwordx4 v[120:123], v1, s[4:7], s88 offen offset:3072 sc1
s_add_u32 m0, s18, 0x0
v_mfma_f32_16x16x32_bf16 v[212:215], a[100:103], a[60:63], v[212:215]
s_add_u32 s44, s50, 0x2824000
ds_read_b128 a[136:139], v5 offset:36864
v_mfma_f32_16x16x32_bf16 v[212:215], a[96:99], a[56:59], v[212:215]
v_mfma_f32_16x16x32_bf16 v[216:219], a[104:107], a[56:59], v[216:219]
ds_read_b128 a[140:143], v5 offset:43008
v_mfma_f32_16x16x32_bf16 v[216:219], a[108:111], a[60:63], v[216:219]
buffer_load_dwordx4 a[4:7], v2, s[40:43], s33 offen offset:0 sc1
v_mfma_f32_16x16x32_bf16 v[192:195], a[108:111], a[52:55], v[192:195]
ds_read_b128 a[144:147], v5 offset:37888
v_mfma_f32_16x16x32_bf16 v[192:195], a[104:107], a[48:51], v[192:195]
v_mfma_f32_16x16x32_bf16 v[168:171], a[104:107], a[40:43], v[168:171]
v_mfma_f32_16x16x32_bf16 v[168:171], a[108:111], a[44:47], v[168:171]
buffer_load_dwordx4 a[8:11], v2, s[40:43], s35 offen offset:1024 sc1
v_mfma_f32_16x16x32_bf16 v[144:147], a[108:111], a[36:39], v[144:147]
ds_read_b128 a[148:151], v5 offset:44032
v_mfma_f32_16x16x32_bf16 v[144:147], a[104:107], a[32:35], v[144:147]
v_mfma_f32_16x16x32_bf16 v[148:151], a[112:115], a[32:35], v[148:151]
v_mfma_f32_16x16x32_bf16 v[148:151], a[116:119], a[36:39], v[148:151]
buffer_load_dwordx4 v1, s[4:7], s44 offen offset:0 sc1 lds
v_mfma_f32_16x16x32_bf16 v[172:175], a[116:119], a[44:47], v[172:175]
v_mfma_f32_16x16x32_bf16 v[172:175], a[112:115], a[40:43], v[172:175]
v_mfma_f32_16x16x32_bf16 v[196:199], a[112:115], a[48:51], v[196:199]
v_mfma_f32_16x16x32_bf16 v[196:199], a[116:119], a[52:55], v[196:199]
buffer_load_dwordx4 a[12:15], v2, s[40:43], s33 offen offset:1024 sc1
v_mfma_f32_16x16x32_bf16 v[220:223], a[116:119], a[60:63], v[220:223]
v_mfma_f32_16x16x32_bf16 v[220:223], a[112:115], a[56:59], v[220:223]
s_waitcnt lgkmcnt(0)
s_barrier
v_mfma_f32_16x16x32_bf16 v[224:227], a[128:131], a[56:59], v[224:227]
v_add_u32 v5, 98304, v1
v_mfma_f32_16x16x32_bf16 v[224:227], a[132:135], a[60:63], v[224:227]
buffer_load_dwordx4 a[16:19], v2, s[40:43], s35 offen offset:2048 sc1
v_mfma_f32_16x16x32_bf16 v[200:203], a[132:135], a[52:55], v[200:203]
ds_read_b128 a[96:99], v5 offset:2048
v_mfma_f32_16x16x32_bf16 v[200:203], a[128:131], a[48:51], v[200:203]
ds_read_b128 a[100:103], v5 offset:8192
v_mfma_f32_16x16x32_bf16 v[176:179], a[128:131], a[40:43], v[176:179]
ds_read_b128 v[48:51], v233 offset:0
v_mfma_f32_16x16x32_bf16 v[176:179], a[132:135], a[44:47], v[176:179]
buffer_load_dwordx4 a[20:23], v2, s[40:43], s33 offen offset:2048 sc1
v_mfma_f32_16x16x32_bf16 v[152:155], a[132:135], a[36:39], v[152:155]
ds_read_b128 a[104:107], v5 offset:3072
v_mfma_f32_16x16x32_bf16 v[152:155], a[128:131], a[32:35], v[152:155]
v_mfma_f32_16x16x32_bf16 v[132:135], a[136:139], a[32:35], v[132:135]
ds_read_b128 a[108:111], v5 offset:9216
v_mfma_f32_16x16x32_bf16 v[132:135], a[140:143], a[36:39], v[132:135]
v_mfma_f32_16x16x32_bf16 v[156:159], a[140:143], a[44:47], v[156:159]
buffer_load_dwordx4 v1, s[4:7], s44 offen offset:1024 sc1 lds
s_add_u32 m0, s18, 0x2000
v_mfma_f32_16x16x32_bf16 v[156:159], a[136:139], a[40:43], v[156:159]
s_add_u32 s44, s50, 0x2826000
ds_read_b128 a[112:115], v5 offset:4096
v_mfma_f32_16x16x32_bf16 v[180:183], a[136:139], a[48:51], v[180:183]
ds_read_b128 v[52:55], v233 offset:64
v_mfma_f32_16x16x32_bf16 v[180:183], a[140:143], a[52:55], v[180:183]
ds_read_b128 a[116:119], v5 offset:10240
v_mfma_f32_16x16x32_bf16 v[204:207], a[140:143], a[60:63], v[204:207]
v_mfma_f32_16x16x32_bf16 v[204:207], a[136:139], a[56:59], v[204:207]
buffer_load_dwordx4 a[24:27], v2, s[40:43], s35 offen offset:3072 sc1
v_mfma_f32_16x16x32_bf16 v[208:211], a[144:147], a[56:59], v[208:211]
v_mfma_f32_16x16x32_bf16 v[208:211], a[148:151], a[60:63], v[208:211]
v_mfma_f32_16x16x32_bf16 v[184:187], a[148:151], a[52:55], v[184:187]
v_mfma_f32_16x16x32_bf16 v[184:187], a[144:147], a[48:51], v[184:187]
v_mfma_f32_16x16x32_bf16 v[160:163], a[144:147], a[40:43], v[160:163]
buffer_load_dwordx4 a[28:31], v2, s[40:43], s33 offen offset:3072 sc1
s_add_u32 s35, s35, 0x4000
v_mfma_f32_16x16x32_bf16 v[160:163], a[148:151], a[44:47], v[160:163]
s_add_u32 s33, s33, 0x4000
ds_read_b128 v[56:59], v233 offset:128
v_mfma_f32_16x16x32_bf16 v[136:139], a[148:151], a[36:39], v[136:139]
v_mfma_f32_16x16x32_bf16 v[136:139], a[144:147], a[32:35], v[136:139]
s_waitcnt vmcnt(11) lgkmcnt(1)
v_mfma_f32_16x16x32_bf16 v[140:143], a[96:99], a[64:67], v[140:143]
ds_read_b128 a[128:131], v5 offset:5120
v_mfma_f32_16x16x32_bf16 v[140:143], a[100:103], a[68:71], v[140:143]
buffer_load_dwordx4 a[32:35], v2, s[40:43], s35 offen offset:0 sc1
v_mfma_f32_16x16x32_bf16 v[164:167], a[100:103], a[76:79], v[164:167]
ds_read_b128 a[132:135], v5 offset:11264
v_mfma_f32_16x16x32_bf16 v[164:167], a[96:99], a[72:75], v[164:167]
v_mfma_f32_16x16x32_bf16 v[188:191], a[96:99], a[80:83], v[188:191]
v_mfma_f32_16x16x32_bf16 v[188:191], a[100:103], a[84:87], v[188:191]
buffer_load_dwordx4 a[36:39], v2, s[40:43], s33 offen offset:0 sc1
v_mfma_f32_16x16x32_bf16 v[212:215], a[100:103], a[92:95], v[212:215]
ds_read_b128 a[136:139], v5 offset:0
v_mfma_f32_16x16x32_bf16 v[212:215], a[96:99], a[88:91], v[212:215]
v_mfma_f32_16x16x32_bf16 v[216:219], a[104:107], a[88:91], v[216:219]
ds_read_b128 a[140:143], v5 offset:6144
v_mfma_f32_16x16x32_bf16 v[216:219], a[108:111], a[92:95], v[216:219]
ds_read_b128 v[60:63], v233 offset:192
v_mfma_f32_16x16x32_bf16 v[192:195], a[108:111], a[84:87], v[192:195]
buffer_load_dwordx4 v1, s[4:7], s44 offen offset:0 sc1 lds
v_mfma_f32_16x16x32_bf16 v[192:195], a[104:107], a[80:83], v[192:195]
ds_read_b128 a[144:147], v5 offset:1024
v_mfma_f32_16x16x32_bf16 v[168:171], a[104:107], a[72:75], v[168:171]
v_mfma_f32_16x16x32_bf16 v[168:171], a[108:111], a[76:79], v[168:171]
ds_read_b128 a[148:151], v5 offset:7168
v_mfma_f32_16x16x32_bf16 v[144:147], a[108:111], a[68:71], v[144:147]
v_mfma_f32_16x16x32_bf16 v[144:147], a[104:107], a[64:67], v[144:147]
buffer_load_dwordx4 a[40:43], v2, s[40:43], s35 offen offset:1024 sc1
v_mfma_f32_16x16x32_bf16 v[148:151], a[112:115], a[64:67], v[148:151]
v_mfma_f32_16x16x32_bf16 v[148:151], a[116:119], a[68:71], v[148:151]
v_mfma_f32_16x16x32_bf16 v[172:175], a[116:119], a[76:79], v[172:175]
ds_read_b128 v[64:67], v233 offset:256
v_mfma_f32_16x16x32_bf16 v[172:175], a[112:115], a[72:75], v[172:175]
v_mfma_f32_16x16x32_bf16 v[196:199], a[112:115], a[80:83], v[196:199]
buffer_load_dwordx4 a[44:47], v2, s[40:43], s33 offen offset:1024 sc1
v_mfma_f32_16x16x32_bf16 v[196:199], a[116:119], a[84:87], v[196:199]
v_mfma_f32_16x16x32_bf16 v[220:223], a[116:119], a[92:95], v[220:223]
v_mfma_f32_16x16x32_bf16 v[220:223], a[112:115], a[88:91], v[220:223]
s_waitcnt lgkmcnt(1)
v_mfma_f32_16x16x32_bf16 v[224:227], a[128:131], a[88:91], v[224:227]
ds_read_b128 a[96:99], v5 offset:14336
v_mfma_f32_16x16x32_bf16 v[224:227], a[132:135], a[92:95], v[224:227]
buffer_load_dwordx4 a[48:51], v2, s[40:43], s35 offen offset:2048 sc1
v_mfma_f32_16x16x32_bf16 v[200:203], a[132:135], a[84:87], v[200:203]
ds_read_b128 a[100:103], v5 offset:20480
v_mfma_f32_16x16x32_bf16 v[200:203], a[128:131], a[80:83], v[200:203]
v_mfma_f32_16x16x32_bf16 v[176:179], a[128:131], a[72:75], v[176:179]
v_mfma_f32_16x16x32_bf16 v[176:179], a[132:135], a[76:79], v[176:179]
buffer_load_dwordx4 a[52:55], v2, s[40:43], s33 offen offset:2048 sc1
v_mfma_f32_16x16x32_bf16 v[152:155], a[132:135], a[68:71], v[152:155]
ds_read_b128 a[104:107], v5 offset:15360
v_mfma_f32_16x16x32_bf16 v[152:155], a[128:131], a[64:67], v[152:155]
ds_read_b128 v[68:71], v233 offset:320
v_mfma_f32_16x16x32_bf16 v[132:135], a[136:139], a[64:67], v[132:135]
ds_read_b128 a[108:111], v5 offset:21504
v_mfma_f32_16x16x32_bf16 v[132:135], a[140:143], a[68:71], v[132:135]
v_mfma_f32_16x16x32_bf16 v[156:159], a[140:143], a[76:79], v[156:159]
buffer_load_dwordx4 v1, s[4:7], s44 offen offset:1024 sc1 lds
s_add_u32 m0, s18, 0x4000
v_mfma_f32_16x16x32_bf16 v[156:159], a[136:139], a[72:75], v[156:159]
s_add_u32 s44, s50, 0x2828000
ds_read_b128 a[112:115], v5 offset:16384
v_mfma_f32_16x16x32_bf16 v[180:183], a[136:139], a[80:83], v[180:183]
v_mfma_f32_16x16x32_bf16 v[180:183], a[140:143], a[84:87], v[180:183]
ds_read_b128 a[116:119], v5 offset:22528
v_mfma_f32_16x16x32_bf16 v[204:207], a[140:143], a[92:95], v[204:207]
v_mfma_f32_16x16x32_bf16 v[204:207], a[136:139], a[88:91], v[204:207]
buffer_load_dwordx4 a[56:59], v2, s[40:43], s35 offen offset:3072 sc1
v_mfma_f32_16x16x32_bf16 v[208:211], a[144:147], a[88:91], v[208:211]
v_mfma_f32_16x16x32_bf16 v[208:211], a[148:151], a[92:95], v[208:211]
v_mfma_f32_16x16x32_bf16 v[184:187], a[148:151], a[84:87], v[184:187]
v_mfma_f32_16x16x32_bf16 v[184:187], a[144:147], a[80:83], v[184:187]
v_mfma_f32_16x16x32_bf16 v[160:163], a[144:147], a[72:75], v[160:163]
buffer_load_dwordx4 a[60:63], v2, s[40:43], s33 offen offset:3072 sc1
s_add_u32 s35, s35, 0x4000
v_mfma_f32_16x16x32_bf16 v[160:163], a[148:151], a[76:79], v[160:163]
s_add_u32 s33, s33, 0x4000
v_mfma_f32_16x16x32_bf16 v[136:139], a[148:151], a[68:71], v[136:139]
v_mfma_f32_16x16x32_bf16 v[136:139], a[144:147], a[64:67], v[136:139]
s_waitcnt vmcnt(10) lgkmcnt(0)
v_mfma_f32_16x16x32_bf16 v[140:143], a[96:99], a[0:3], v[140:143]
ds_read_b128 a[128:131], v5 offset:17408
v_add_f32 v92, v92, v96
v_mfma_f32_16x16x32_bf16 v[140:143], a[100:103], a[4:7], v[140:143]
buffer_load_dwordx4 a[64:67], v2, s[40:43], s35 offen offset:0 sc1
v_mfma_f32_16x16x32_bf16 v[164:167], a[100:103], a[12:15], v[164:167]
ds_read_b128 a[132:135], v5 offset:23552
v_add_f32 v100, v100, v104
v_mfma_f32_16x16x32_bf16 v[164:167], a[96:99], a[8:11], v[164:167]
v_add_f32 v108, v108, v112
v_add_f32 v116, v116, v120
v_mfma_f32_16x16x32_bf16 v[188:191], a[96:99], a[16:19], v[188:191]
v_add_f32 v93, v93, v97
v_add_f32 v101, v101, v105
v_mfma_f32_16x16x32_bf16 v[188:191], a[100:103], a[20:23], v[188:191]
buffer_load_dwordx4 v1, s[4:7], s44 offen offset:0 sc1 lds
v_mfma_f32_16x16x32_bf16 v[212:215], a[100:103], a[28:31], v[212:215]
ds_read_b128 a[136:139], v5 offset:12288
v_add_f32 v109, v109, v113
v_mfma_f32_16x16x32_bf16 v[212:215], a[96:99], a[24:27], v[212:215]
v_add_f32 v117, v117, v121
v_add_f32 v94, v94, v98
v_mfma_f32_16x16x32_bf16 v[216:219], a[104:107], a[24:27], v[216:219]
ds_read_b128 a[140:143], v5 offset:18432
v_add_f32 v102, v102, v106
v_mfma_f32_16x16x32_bf16 v[216:219], a[108:111], a[28:31], v[216:219]
buffer_load_dwordx4 a[68:71], v2, s[40:43], s33 offen offset:0 sc1
v_mfma_f32_16x16x32_bf16 v[192:195], a[108:111], a[20:23], v[192:195]
ds_read_b128 a[144:147], v5 offset:13312
v_add_f32 v110, v110, v114
v_mfma_f32_16x16x32_bf16 v[192:195], a[104:107], a[16:19], v[192:195]
v_add_f32 v118, v118, v122
v_add_f32 v95, v95, v99
v_mfma_f32_16x16x32_bf16 v[168:171], a[104:107], a[8:11], v[168:171]
v_add_f32 v103, v103, v107
v_mfma_f32_16x16x32_bf16 v[168:171], a[108:111], a[12:15], v[168:171]
buffer_load_dwordx4 a[72:75], v2, s[40:43], s35 offen offset:1024 sc1
v_mfma_f32_16x16x32_bf16 v[144:147], a[108:111], a[4:7], v[144:147]
ds_read_b128 a[148:151], v5 offset:19456
v_add_f32 v111, v111, v115
v_mfma_f32_16x16x32_bf16 v[144:147], a[104:107], a[0:3], v[144:147]
v_add_f32 v119, v119, v123
v_add_f32_dpp v92, v92, v92 row_ror:8 row_mask:0xf bank_mask:0xf
v_mfma_f32_16x16x32_bf16 v[148:151], a[112:115], a[0:3], v[148:151]
v_add_f32_dpp v100, v100, v100 row_ror:8 row_mask:0xf bank_mask:0xf
v_mfma_f32_16x16x32_bf16 v[148:151], a[116:119], a[4:7], v[148:151]
buffer_load_dwordx4 v1, s[4:7], s44 offen offset:1024 sc1 lds
s_add_u32 m0, s18, 0x6000
v_mfma_f32_16x16x32_bf16 v[172:175], a[116:119], a[12:15], v[172:175]
s_add_u32 s44, s50, 0x282a000
v_add_f32_dpp v108, v108, v108 row_ror:8 row_mask:0xf bank_mask:0xf
v_mfma_f32_16x16x32_bf16 v[172:175], a[112:115], a[8:11], v[172:175]
v_add_f32_dpp v116, v116, v116 row_ror:8 row_mask:0xf bank_mask:0xf
v_add_f32_dpp v93, v93, v93 row_ror:8 row_mask:0xf bank_mask:0xf
v_mfma_f32_16x16x32_bf16 v[196:199], a[112:115], a[16:19], v[196:199]
v_add_f32_dpp v101, v101, v101 row_ror:8 row_mask:0xf bank_mask:0xf
v_mfma_f32_16x16x32_bf16 v[196:199], a[116:119], a[20:23], v[196:199]
buffer_load_dwordx4 a[76:79], v2, s[40:43], s33 offen offset:1024 sc1
v_mfma_f32_16x16x32_bf16 v[220:223], a[116:119], a[28:31], v[220:223]
v_add_f32_dpp v109, v109, v109 row_ror:8 row_mask:0xf bank_mask:0xf
v_add_f32_dpp v117, v117, v117 row_ror:8 row_mask:0xf bank_mask:0xf
v_mfma_f32_16x16x32_bf16 v[220:223], a[112:115], a[24:27], v[220:223]
v_add_f32_dpp v92, v94, v94 row_ror:8 row_mask:0xf bank_mask:0xc
s_waitcnt lgkmcnt(0)
v_mfma_f32_16x16x32_bf16 v[224:227], a[128:131], a[24:27], v[224:227]
ds_read_b128 a[96:99], v5 offset:26624
v_accvgpr_write_b32 a216, v48
v_mfma_f32_16x16x32_bf16 v[224:227], a[132:135], a[28:31], v[224:227]
buffer_load_dwordx4 a[80:83], v2, s[40:43], s35 offen offset:2048 sc1
v_mfma_f32_16x16x32_bf16 v[200:203], a[132:135], a[20:23], v[200:203]
ds_read_b128 a[100:103], v5 offset:32768
v_add_f32_dpp v100, v102, v102 row_ror:8 row_mask:0xf bank_mask:0xc
v_mfma_f32_16x16x32_bf16 v[200:203], a[128:131], a[16:19], v[200:203]
v_accvgpr_write_b32 a217, v49
v_add_f32_dpp v108, v110, v110 row_ror:8 row_mask:0xf bank_mask:0xc
v_mfma_f32_16x16x32_bf16 v[176:179], a[128:131], a[8:11], v[176:179]
v_add_f32_dpp v116, v118, v118 row_ror:8 row_mask:0xf bank_mask:0xc
v_add_f32_dpp v93, v95, v95 row_ror:8 row_mask:0xf bank_mask:0xc
v_mfma_f32_16x16x32_bf16 v[176:179], a[132:135], a[12:15], v[176:179]
buffer_load_dwordx4 a[84:87], v2, s[40:43], s33 offen offset:2048 sc1
v_mfma_f32_16x16x32_bf16 v[152:155], a[132:135], a[4:7], v[152:155]
ds_read_b128 a[104:107], v5 offset:27648
v_accvgpr_write_b32 a218, v50
v_mfma_f32_16x16x32_bf16 v[152:155], a[128:131], a[0:3], v[152:155]
v_add_f32_dpp v101, v103, v103 row_ror:8 row_mask:0xf bank_mask:0xc
v_add_f32_dpp v109, v111, v111 row_ror:8 row_mask:0xf bank_mask:0xc
v_mfma_f32_16x16x32_bf16 v[132:135], a[136:139], a[0:3], v[132:135]
ds_read_b128 a[108:111], v5 offset:33792
v_add_f32_dpp v117, v119, v119 row_ror:8 row_mask:0xf bank_mask:0xc
v_mfma_f32_16x16x32_bf16 v[132:135], a[140:143], a[4:7], v[132:135]
v_accvgpr_write_b32 a219, v51
v_mfma_f32_16x16x32_bf16 v[156:159], a[140:143], a[12:15], v[156:159]
buffer_load_dwordx4 v1, s[4:7], s44 offen offset:0 sc1 lds
v_mfma_f32_16x16x32_bf16 v[156:159], a[136:139], a[8:11], v[156:159]
ds_read_b128 a[112:115], v5 offset:28672
v_mfma_f32_16x16x32_bf16 v[180:183], a[136:139], a[16:19], v[180:183]
v_accvgpr_write_b32 a220, v52
v_mfma_f32_16x16x32_bf16 v[180:183], a[140:143], a[20:23], v[180:183]
ds_read_b128 a[116:119], v5 offset:34816
v_mfma_f32_16x16x32_bf16 v[204:207], a[140:143], a[28:31], v[204:207]
v_permlane32_swap_b32 v92, v93
v_mfma_f32_16x16x32_bf16 v[204:207], a[136:139], a[24:27], v[204:207]
buffer_load_dwordx4 a[88:91], v2, s[40:43], s35 offen offset:3072 sc1
v_mfma_f32_16x16x32_bf16 v[208:211], a[144:147], a[24:27], v[208:211]
v_accvgpr_write_b32 a221, v53
v_mfma_f32_16x16x32_bf16 v[208:211], a[148:151], a[28:31], v[208:211]
v_permlane32_swap_b32 v100, v101
v_mfma_f32_16x16x32_bf16 v[184:187], a[148:151], a[20:23], v[184:187]
v_accvgpr_write_b32 a222, v54
v_mfma_f32_16x16x32_bf16 v[184:187], a[144:147], a[16:19], v[184:187]
v_permlane32_swap_b32 v108, v109
v_mfma_f32_16x16x32_bf16 v[160:163], a[144:147], a[8:11], v[160:163]
buffer_load_dwordx4 a[92:95], v2, s[40:43], s33 offen offset:3072 sc1
s_add_u32 s35, s35, 0x4000
v_mfma_f32_16x16x32_bf16 v[160:163], a[148:151], a[12:15], v[160:163]
s_add_u32 s33, s33, 0x4000
v_accvgpr_write_b32 a223, v55
v_mfma_f32_16x16x32_bf16 v[136:139], a[148:151], a[4:7], v[136:139]
v_permlane32_swap_b32 v116, v117
v_mfma_f32_16x16x32_bf16 v[136:139], a[144:147], a[0:3], v[136:139]
v_add_f32 v92, v92, v93
s_waitcnt vmcnt(11) lgkmcnt(0)
v_mfma_f32_16x16x32_bf16 v[140:143], a[96:99], a[32:35], v[140:143]
ds_read_b128 a[128:131], v5 offset:29696
v_accvgpr_write_b32 a224, v56
v_mfma_f32_16x16x32_bf16 v[140:143], a[100:103], a[36:39], v[140:143]
buffer_load_dwordx4 a[0:3], v2, s[40:43], s35 offen offset:0 sc1
v_mfma_f32_16x16x32_bf16 v[164:167], a[100:103], a[44:47], v[164:167]
ds_read_b128 a[132:135], v5 offset:35840
v_add_f32 v100, v100, v101
v_mfma_f32_16x16x32_bf16 v[164:167], a[96:99], a[40:43], v[164:167]
v_accvgpr_write_b32 a225, v57
v_add_f32 v108, v108, v109
v_mfma_f32_16x16x32_bf16 v[188:191], a[96:99], a[48:51], v[188:191]
v_add_f32 v116, v116, v117
v_mov_b32 v94, v92
v_mfma_f32_16x16x32_bf16 v[188:191], a[100:103], a[52:55], v[188:191]
buffer_load_dwordx4 a[4:7], v2, s[40:43], s33 offen offset:0 sc1
v_mfma_f32_16x16x32_bf16 v[212:215], a[100:103], a[60:63], v[212:215]
ds_read_b128 a[136:139], v5 offset:24576
v_accvgpr_write_b32 a226, v58
v_mfma_f32_16x16x32_bf16 v[212:215], a[96:99], a[56:59], v[212:215]
v_mov_b32 v102, v100
v_mov_b32 v110, v108
v_mfma_f32_16x16x32_bf16 v[216:219], a[104:107], a[56:59], v[216:219]
ds_read_b128 a[140:143], v5 offset:30720
v_mov_b32 v118, v116
v_mfma_f32_16x16x32_bf16 v[216:219], a[108:111], a[60:63], v[216:219]
v_accvgpr_write_b32 a227, v59
v_mfma_f32_16x16x32_bf16 v[192:195], a[108:111], a[52:55], v[192:195]
buffer_load_dwordx4 v1, s[4:7], s44 offen offset:1024 sc1 lds
s_add_u32 m0, s18, 0x8000
v_mfma_f32_16x16x32_bf16 v[192:195], a[104:107], a[48:51], v[192:195]
s_add_u32 s44, s50, 0x282c000
ds_read_b128 a[144:147], v5 offset:25600
v_mfma_f32_16x16x32_bf16 v[168:171], a[104:107], a[40:43], v[168:171]
v_accvgpr_write_b32 a228, v60
v_mfma_f32_16x16x32_bf16 v[168:171], a[108:111], a[44:47], v[168:171]
ds_read_b128 a[148:151], v5 offset:31744
v_mfma_f32_16x16x32_bf16 v[144:147], a[108:111], a[36:39], v[144:147]
v_permlane16_swap_b32 v92, v94
v_mfma_f32_16x16x32_bf16 v[144:147], a[104:107], a[32:35], v[144:147]
buffer_load_dwordx4 a[8:11], v2, s[40:43], s35 offen offset:1024 sc1
v_mfma_f32_16x16x32_bf16 v[148:151], a[112:115], a[32:35], v[148:151]
v_accvgpr_write_b32 a229, v61
v_mfma_f32_16x16x32_bf16 v[148:151], a[116:119], a[36:39], v[148:151]
v_permlane16_swap_b32 v100, v102
v_mfma_f32_16x16x32_bf16 v[172:175], a[116:119], a[44:47], v[172:175]
v_accvgpr_write_b32 a230, v62
v_mfma_f32_16x16x32_bf16 v[172:175], a[112:115], a[40:43], v[172:175]
v_permlane16_swap_b32 v108, v110
v_mfma_f32_16x16x32_bf16 v[196:199], a[112:115], a[48:51], v[196:199]
buffer_load_dwordx4 a[12:15], v2, s[40:43], s33 offen offset:1024 sc1
v_mfma_f32_16x16x32_bf16 v[196:199], a[116:119], a[52:55], v[196:199]
v_accvgpr_write_b32 a231, v63
v_mfma_f32_16x16x32_bf16 v[220:223], a[116:119], a[60:63], v[220:223]
v_permlane16_swap_b32 v116, v118
v_mfma_f32_16x16x32_bf16 v[220:223], a[112:115], a[56:59], v[220:223]
v_add_f32 v92, v92, v94
s_waitcnt lgkmcnt(0)
v_mfma_f32_16x16x32_bf16 v[224:227], a[128:131], a[56:59], v[224:227]
ds_read_b128 a[96:99], v5 offset:38912
v_accvgpr_write_b32 a232, v64
v_mfma_f32_16x16x32_bf16 v[224:227], a[132:135], a[60:63], v[224:227]
buffer_load_dwordx4 a[16:19], v2, s[40:43], s35 offen offset:2048 sc1
v_mfma_f32_16x16x32_bf16 v[200:203], a[132:135], a[52:55], v[200:203]
ds_read_b128 a[100:103], v5 offset:45056
v_add_f32 v100, v100, v102
v_mfma_f32_16x16x32_bf16 v[200:203], a[128:131], a[48:51], v[200:203]
v_accvgpr_write_b32 a233, v65
v_add_f32 v108, v108, v110
L_stub6:
s_cbranch_execz L_stub7
v_mfma_f32_16x16x32_bf16 v[176:179], a[128:131], a[40:43], v[176:179]
v_add_f32 v116, v116, v118
v_mov_b32 v94, v92
v_mfma_f32_16x16x32_bf16 v[176:179], a[132:135], a[44:47], v[176:179]
buffer_load_dwordx4 a[20:23], v2, s[40:43], s33 offen offset:2048 sc1
v_mfma_f32_16x16x32_bf16 v[152:155], a[132:135], a[36:39], v[152:155]
ds_read_b128 a[104:107], v5 offset:39936
v_accvgpr_write_b32 a234, v66
v_mfma_f32_16x16x32_bf16 v[152:155], a[128:131], a[32:35], v[152:155]
v_mov_b32 v102, v100
v_mov_b32 v110, v108
v_mfma_f32_16x16x32_bf16 v[132:135], a[136:139], a[32:35], v[132:135]
ds_read_b128 a[108:111], v5 offset:46080
v_mov_b32 v118, v116
v_mfma_f32_16x16x32_bf16 v[132:135], a[140:143], a[36:39], v[132:135]
v_accvgpr_write_b32 a235, v67
v_mfma_f32_16x16x32_bf16 v[156:159], a[140:143], a[44:47], v[156:159]
buffer_load_dwordx4 v1, s[4:7], s44 offen offset:0 sc1 lds
v_mfma_f32_16x16x32_bf16 v[156:159], a[136:139], a[40:43], v[156:159]
ds_read_b128 a[112:115], v5 offset:40960
v_mfma_f32_16x16x32_bf16 v[180:183], a[136:139], a[48:51], v[180:183]
v_accvgpr_write_b32 a236, v68
v_mfma_f32_16x16x32_bf16 v[180:183], a[140:143], a[52:55], v[180:183]
ds_read_b128 a[116:119], v5 offset:47104
v_mfma_f32_16x16x32_bf16 v[204:207], a[140:143], a[60:63], v[204:207]
v_permlane32_swap_b32 v92, v94
v_mfma_f32_16x16x32_bf16 v[204:207], a[136:139], a[56:59], v[204:207]
buffer_load_dwordx4 a[24:27], v2, s[40:43], s35 offen offset:3072 sc1
v_mfma_f32_16x16x32_bf16 v[208:211], a[144:147], a[56:59], v[208:211]
v_accvgpr_write_b32 a237, v69
v_mfma_f32_16x16x32_bf16 v[208:211], a[148:151], a[60:63], v[208:211]
v_permlane32_swap_b32 v100, v102
v_mfma_f32_16x16x32_bf16 v[184:187], a[148:151], a[52:55], v[184:187]
v_accvgpr_write_b32 a238, v70
v_mfma_f32_16x16x32_bf16 v[184:187], a[144:147], a[48:51], v[184:187]
v_permlane32_swap_b32 v108, v110
v_mfma_f32_16x16x32_bf16 v[160:163], a[144:147], a[40:43], v[160:163]
buffer_load_dwordx4 a[28:31], v2, s[40:43], s33 offen offset:3072 sc1
s_add_u32 s35, s35, 0x4000
v_mfma_f32_16x16x32_bf16 v[160:163], a[148:151], a[44:47], v[160:163]
s_add_u32 s33, s33, 0x4000
v_accvgpr_write_b32 a239, v71
v_mfma_f32_16x16x32_bf16 v[136:139], a[148:151], a[36:39], v[136:139]
v_permlane32_swap_b32 v116, v118
v_mfma_f32_16x16x32_bf16 v[136:139], a[144:147], a[32:35], v[136:139]
v_mul_f32 v82, 0xba800000, v92
s_waitcnt vmcnt(10) lgkmcnt(0)
v_mfma_f32_16x16x32_bf16 v[140:143], a[96:99], a[64:67], v[140:143]
ds_read_b128 a[128:131], v5 offset:41984
v_mul_f32 v84, 0xba800000, v100
v_mfma_f32_16x16x32_bf16 v[140:143], a[100:103], a[68:71], v[140:143]
buffer_load_dwordx4 a[32:35], v2, s[40:43], s35 offen offset:0 sc1
v_mfma_f32_16x16x32_bf16 v[164:167], a[100:103], a[76:79], v[164:167]
ds_read_b128 a[132:135], v5 offset:48128
v_mul_f32 v86, 0xba800000, v108
v_mfma_f32_16x16x32_bf16 v[164:167], a[96:99], a[72:75], v[164:167]
v_mul_f32 v88, 0xba800000, v116
v_mul_f32 v94, 0x3a800000, v94
v_mfma_f32_16x16x32_bf16 v[188:191], a[96:99], a[80:83], v[188:191]
v_mul_f32 v102, 0x3a800000, v102
v_mul_f32 v110, 0x3a800000, v110
v_mfma_f32_16x16x32_bf16 v[188:191], a[100:103], a[84:87], v[188:191]
buffer_load_dwordx4 v1, s[4:7], s44 offen offset:1024 sc1 lds
s_add_u32 m0, s18, 0xa000
v_mfma_f32_16x16x32_bf16 v[212:215], a[100:103], a[92:95], v[212:215]
s_add_u32 s44, s50, 0x282e000
ds_read_b128 a[136:139], v5 offset:36864
v_mfma_f32_16x16x32_bf16 v[212:215], a[96:99], a[88:91], v[212:215]
v_mul_f32 v118, 0x3a800000, v118
v_fma_f32 v94, -v82, v82, v94
v_fma_f32 v102, -v84, v84, v102
v_fma_f32 v110, -v86, v86, v110
v_fma_f32 v118, -v88, v88, v118
v_max_f32 v94, 0, v94
v_max_f32 v102, 0, v102
v_max_f32 v110, 0, v110
v_max_f32 v118, 0, v118
v_add_f32 v94, 0x3727c5ac, v94
v_add_f32 v102, 0x3727c5ac, v102
v_add_f32 v110, 0x3727c5ac, v110
v_add_f32 v118, 0x3727c5ac, v118
v_rsq_f32 v83, v94
v_rsq_f32 v85, v102
v_rsq_f32 v87, v110
v_rsq_f32 v89, v118
v_mfma_f32_16x16x32_bf16 v[216:219], a[104:107], a[88:91], v[216:219]
ds_read_b128 a[140:143], v5 offset:43008
v_mfma_f32_16x16x32_bf16 v[216:219], a[108:111], a[92:95], v[216:219]
buffer_load_dwordx4 a[36:39], v2, s[40:43], s33 offen offset:0 sc1
v_mfma_f32_16x16x32_bf16 v[192:195], a[108:111], a[84:87], v[192:195]
ds_read_b128 a[144:147], v5 offset:37888
v_fmac_f32 v140, v56, v82
v_mfma_f32_16x16x32_bf16 v[192:195], a[104:107], a[80:83], v[192:195]
v_mfma_f32_16x16x32_bf16 v[168:171], a[104:107], a[72:75], v[168:171]
v_fmac_f32 v164, v56, v84
v_mfma_f32_16x16x32_bf16 v[168:171], a[108:111], a[76:79], v[168:171]
buffer_load_dwordx4 a[40:43], v2, s[40:43], s35 offen offset:1024 sc1
v_mfma_f32_16x16x32_bf16 v[144:147], a[108:111], a[68:71], v[144:147]
ds_read_b128 a[148:151], v5 offset:44032
v_fmac_f32 v188, v56, v86
v_mfma_f32_16x16x32_bf16 v[144:147], a[104:107], a[64:67], v[144:147]
v_mfma_f32_16x16x32_bf16 v[148:151], a[112:115], a[64:67], v[148:151]
v_fmac_f32 v212, v56, v88
v_mfma_f32_16x16x32_bf16 v[148:151], a[116:119], a[68:71], v[148:151]
buffer_load_dwordx4 v1, s[4:7], s44 offen offset:0 sc1 lds
v_mfma_f32_16x16x32_bf16 v[172:175], a[116:119], a[76:79], v[172:175]
v_fmac_f32 v216, v60, v88
v_mfma_f32_16x16x32_bf16 v[172:175], a[112:115], a[72:75], v[172:175]
v_mfma_f32_16x16x32_bf16 v[196:199], a[112:115], a[80:83], v[196:199]
v_fmac_f32 v192, v60, v86
v_mfma_f32_16x16x32_bf16 v[196:199], a[116:119], a[84:87], v[196:199]
buffer_load_dwordx4 a[44:47], v2, s[40:43], s33 offen offset:1024 sc1
v_mfma_f32_16x16x32_bf16 v[220:223], a[116:119], a[92:95], v[220:223]
v_fmac_f32 v168, v60, v84
v_fmac_f32 v141, v57, v82
v_mfma_f32_16x16x32_bf16 v[220:223], a[112:115], a[88:91], v[220:223]
s_waitcnt lgkmcnt(0)
s_barrier
v_mfma_f32_16x16x32_bf16 v[224:227], a[128:131], a[88:91], v[224:227]
v_add_u32 v5, 0, v1
v_fmac_f32 v144, v60, v82
v_mfma_f32_16x16x32_bf16 v[224:227], a[132:135], a[92:95], v[224:227]
buffer_load_dwordx4 a[48:51], v2, s[40:43], s35 offen offset:2048 sc1
v_mfma_f32_16x16x32_bf16 v[200:203], a[132:135], a[84:87], v[200:203]
ds_read_b128 a[96:99], v5 offset:2048
v_fmac_f32 v148, v64, v82
v_mfma_f32_16x16x32_bf16 v[200:203], a[128:131], a[80:83], v[200:203]
ds_read_b128 a[100:103], v5 offset:8192
v_fmac_f32 v165, v57, v84
v_mfma_f32_16x16x32_bf16 v[176:179], a[128:131], a[72:75], v[176:179]
v_fmac_f32 v172, v64, v84
v_fmac_f32 v189, v57, v86
v_mfma_f32_16x16x32_bf16 v[176:179], a[132:135], a[76:79], v[176:179]
buffer_load_dwordx4 a[52:55], v2, s[40:43], s33 offen offset:2048 sc1
v_mfma_f32_16x16x32_bf16 v[152:155], a[132:135], a[68:71], v[152:155]
ds_read_b128 a[104:107], v5 offset:3072
v_fmac_f32 v196, v64, v86
v_mfma_f32_16x16x32_bf16 v[152:155], a[128:131], a[64:67], v[152:155]
v_fmac_f32 v213, v57, v88
v_fmac_f32 v217, v61, v88
v_mfma_f32_16x16x32_bf16 v[132:135], a[136:139], a[64:67], v[132:135]
ds_read_b128 a[108:111], v5 offset:9216
v_fmac_f32 v220, v64, v88
v_mfma_f32_16x16x32_bf16 v[132:135], a[140:143], a[68:71], v[132:135]
v_fmac_f32 v193, v61, v86
v_mfma_f32_16x16x32_bf16 v[156:159], a[140:143], a[76:79], v[156:159]
buffer_load_dwordx4 v1, s[4:7], s44 offen offset:1024 sc1 lds
s_add_u32 m0, s19, 49152
v_mfma_f32_16x16x32_bf16 v[156:159], a[136:139], a[72:75], v[156:159]
s_xor_b32 s44, s85, 16384
ds_read_b128 a[112:115], v5 offset:4096
v_mfma_f32_16x16x32_bf16 v[180:183], a[136:139], a[80:83], v[180:183]
v_fmac_f32 v224, v68, v88
v_fmac_f32 v200, v68, v86
v_mfma_f32_16x16x32_bf16 v[180:183], a[140:143], a[84:87], v[180:183]
ds_read_b128 a[116:119], v5 offset:10240
v_fmac_f32 v169, v61, v84
v_mfma_f32_16x16x32_bf16 v[204:207], a[140:143], a[92:95], v[204:207]
v_fmac_f32 v176, v68, v84
v_fmac_f32 v145, v61, v82
v_mfma_f32_16x16x32_bf16 v[204:207], a[136:139], a[88:91], v[204:207]
buffer_load_dwordx4 a[56:59], v2, s[40:43], s35 offen offset:3072 sc1
v_mfma_f32_16x16x32_bf16 v[208:211], a[144:147], a[88:91], v[208:211]
v_fmac_f32 v152, v68, v82
v_fmac_f32 v149, v65, v82
v_mfma_f32_16x16x32_bf16 v[208:211], a[148:151], a[92:95], v[208:211]
v_fmac_f32 v173, v65, v84
v_mfma_f32_16x16x32_bf16 v[184:187], a[148:151], a[84:87], v[184:187]
v_fmac_f32 v132, v48, v82
v_fmac_f32 v197, v65, v86
v_mfma_f32_16x16x32_bf16 v[184:187], a[144:147], a[80:83], v[184:187]
v_mfma_f32_16x16x32_bf16 v[160:163], a[144:147], a[72:75], v[160:163]
buffer_load_dwordx4 a[60:63], v2, s[40:43], s33 offen offset:3072 sc1
s_add_u32 s35, s35, 0x4000
v_mfma_f32_16x16x32_bf16 v[160:163], a[148:151], a[76:79], v[160:163]
s_add_u32 s33, s33, 0x4000
v_fmac_f32 v156, v48, v84
v_mfma_f32_16x16x32_bf16 v[136:139], a[148:151], a[68:71], v[136:139]
v_fmac_f32 v180, v48, v86
v_fmac_f32 v221, v65, v88
v_mfma_f32_16x16x32_bf16 v[136:139], a[144:147], a[64:67], v[136:139]
v_fmac_f32 v225, v69, v88
s_waitcnt vmcnt(11) lgkmcnt(0)
v_mfma_f32_16x16x32_bf16 v[140:143], a[96:99], a[0:3], v[140:143]
ds_read_b128 a[128:131], v5 offset:5120
v_fmac_f32 v204, v48, v88
v_mfma_f32_16x16x32_bf16 v[140:143], a[100:103], a[4:7], v[140:143]
buffer_load_dwordx4 a[64:67], v2, s[40:43], s35 offen offset:0 sc1
s_lshl_b32 s36, s28, 9
v_mfma_f32_16x16x32_bf16 v[164:167], a[100:103], a[12:15], v[164:167]
ds_read_b128 a[132:135], v5 offset:11264
v_fmac_f32 v208, v52, v88
v_mfma_f32_16x16x32_bf16 v[164:167], a[96:99], a[8:11], v[164:167]
v_fmac_f32 v201, v69, v86
v_fmac_f32 v177, v69, v84
v_mfma_f32_16x16x32_bf16 v[188:191], a[96:99], a[16:19], v[188:191]
v_fmac_f32 v184, v52, v86
v_fmac_f32 v153, v69, v82
v_mfma_f32_16x16x32_bf16 v[188:191], a[100:103], a[20:23], v[188:191]
buffer_load_dwordx4 a[68:71], v2, s[40:43], s33 offen offset:0 sc1
s_lshl_b32 s37, s30, 2
v_mfma_f32_16x16x32_bf16 v[212:215], a[100:103], a[28:31], v[212:215]
ds_read_b128 a[136:139], v5 offset:0
v_fmac_f32 v160, v52, v84
v_mfma_f32_16x16x32_bf16 v[212:215], a[96:99], a[24:27], v[212:215]
v_fmac_f32 v133, v49, v82
s_add_u32 s37, s37, s28
v_mfma_f32_16x16x32_bf16 v[216:219], a[104:107], a[24:27], v[216:219]
ds_read_b128 a[140:143], v5 offset:6144
v_fmac_f32 v136, v52, v82
v_mfma_f32_16x16x32_bf16 v[216:219], a[108:111], a[28:31], v[216:219]
buffer_load_dwordx4 a[72:75], v2, s[40:43], s35 offen offset:1024 sc1
s_lshr_b32 s98, s37, 1
v_mfma_f32_16x16x32_bf16 v[192:195], a[108:111], a[20:23], v[192:195]
ds_read_b128 a[144:147], v5 offset:1024
v_fmac_f32 v157, v49, v84
v_mfma_f32_16x16x32_bf16 v[192:195], a[104:107], a[16:19], v[192:195]
v_fmac_f32 v181, v49, v86
v_fmac_f32 v142, v58, v82
v_mfma_f32_16x16x32_bf16 v[168:171], a[104:107], a[8:11], v[168:171]
v_fmac_f32 v205, v49, v88
v_fmac_f32 v166, v58, v84
v_mfma_f32_16x16x32_bf16 v[168:171], a[108:111], a[12:15], v[168:171]
buffer_load_dwordx4 a[76:79], v2, s[40:43], s33 offen offset:1024 sc1
s_lshl_b32 s98, s98, 14
v_mfma_f32_16x16x32_bf16 v[144:147], a[108:111], a[4:7], v[144:147]
ds_read_b128 a[148:151], v5 offset:7168
v_fmac_f32 v209, v53, v88
v_mfma_f32_16x16x32_bf16 v[144:147], a[104:107], a[0:3], v[144:147]
v_fmac_f32 v190, v58, v86
s_and_b32 s99, s19, 0x1000
v_mfma_f32_16x16x32_bf16 v[148:151], a[112:115], a[0:3], v[148:151]
v_fmac_f32 v185, v53, v86
v_fmac_f32 v214, v58, v88
v_mfma_f32_16x16x32_bf16 v[148:151], a[116:119], a[4:7], v[148:151]
buffer_load_dwordx4 a[80:83], v2, s[40:43], s35 offen offset:2048 sc1
s_add_u32 s98, s98, s99
v_mfma_f32_16x16x32_bf16 v[172:175], a[116:119], a[12:15], v[172:175]
v_fmac_f32 v161, v53, v84
v_fmac_f32 v218, v62, v88
v_mfma_f32_16x16x32_bf16 v[172:175], a[112:115], a[8:11], v[172:175]
v_add_u32 v232, s19, v7
s_bfe_u32 s90, s51, 0x10005
v_mfma_f32_16x16x32_bf16 v[196:199], a[112:115], a[16:19], v[196:199]
v_fmac_f32 v137, v53, v82
v_fmac_f32 v194, v62, v86
v_mfma_f32_16x16x32_bf16 v[196:199], a[116:119], a[20:23], v[196:199]
buffer_load_dwordx4 a[84:87], v2, s[40:43], s33 offen offset:2048 sc1
s_lshl_b32 s90, s90, 13
v_mfma_f32_16x16x32_bf16 v[220:223], a[116:119], a[28:31], v[220:223]
v_fmac_f32 v170, v62, v84
v_fmac_f32 v143, v59, v82
v_mfma_f32_16x16x32_bf16 v[220:223], a[112:115], a[24:27], v[220:223]
s_add_u32 s98, s98, s90
s_waitcnt lgkmcnt(0)
v_mfma_f32_16x16x32_bf16 v[224:227], a[128:131], a[24:27], v[224:227]
ds_read_b128 a[96:99], v5 offset:14336
v_fmac_f32 v146, v62, v82
v_mfma_f32_16x16x32_bf16 v[224:227], a[132:135], a[28:31], v[224:227]
buffer_load_dwordx4 a[88:91], v2, s[40:43], s35 offen offset:3072 sc1
s_add_u32 s98, s98, 0x1400000
v_mfma_f32_16x16x32_bf16 v[200:203], a[132:135], a[20:23], v[200:203]
ds_read_b128 a[100:103], v5 offset:20480
v_fmac_f32 v150, v66, v82
v_mfma_f32_16x16x32_bf16 v[200:203], a[128:131], a[16:19], v[200:203]
v_fmac_f32 v167, v59, v84
v_fmac_f32 v191, v59, v86
v_mfma_f32_16x16x32_bf16 v[176:179], a[128:131], a[8:11], v[176:179]
v_fmac_f32 v174, v66, v84
v_fmac_f32 v215, v59, v88
v_mfma_f32_16x16x32_bf16 v[176:179], a[132:135], a[12:15], v[176:179]
ds_read_b128 a[104:107], v5 offset:15360
s_xor_b32 s99, s98, 0x2000
v_mfma_f32_16x16x32_bf16 v[152:155], a[132:135], a[4:7], v[152:155]
v_fmac_f32 v198, v66, v86
v_fmac_f32 v219, v63, v88
v_mfma_f32_16x16x32_bf16 v[152:155], a[128:131], a[0:3], v[152:155]
buffer_load_dwordx4 v1, s[4:7], s44 offen offset:0 sc1 lds
s_and_b32 s91, s29, 4
v_mfma_f32_16x16x32_bf16 v[132:135], a[136:139], a[0:3], v[132:135]
ds_read_b128 a[108:111], v5 offset:21504
v_fmac_f32 v222, v66, v88
v_mfma_f32_16x16x32_bf16 v[132:135], a[140:143], a[4:7], v[132:135]
v_fmac_f32 v195, v63, v86
s_lshl_b32 s91, s91, 11
v_mfma_f32_16x16x32_bf16 v[156:159], a[140:143], a[12:15], v[156:159]
ds_read_b128 a[112:115], v5 offset:16384
v_fmac_f32 v226, v70, v88
v_mfma_f32_16x16x32_bf16 v[156:159], a[136:139], a[8:11], v[156:159]
v_fmac_f32 v171, v63, v84
s_xor_b32 s96, s98, s91
v_mfma_f32_16x16x32_bf16 v[180:183], a[136:139], a[16:19], v[180:183]
v_fmac_f32 v202, v70, v86
v_fmac_f32 v147, v63, v82
v_mfma_f32_16x16x32_bf16 v[180:183], a[140:143], a[20:23], v[180:183]
buffer_load_dwordx4 a[92:95], v2, s[40:43], s33 offen offset:3072 sc1
s_add_u32 s35, s35, 0x4000
v_mfma_f32_16x16x32_bf16 v[204:207], a[140:143], a[28:31], v[204:207]
s_add_u32 s33, s33, 0x4000
ds_read_b128 a[116:119], v5 offset:22528
v_mfma_f32_16x16x32_bf16 v[204:207], a[136:139], a[24:27], v[204:207]
v_fmac_f32 v178, v70, v84
v_fmac_f32 v151, v67, v82
v_mfma_f32_16x16x32_bf16 v[208:211], a[144:147], a[24:27], v[208:211]
v_fmac_f32 v154, v70, v82
v_fmac_f32 v175, v67, v84
v_mfma_f32_16x16x32_bf16 v[208:211], a[148:151], a[28:31], v[208:211]
s_lshl_b32 s97, s81, 10
s_add_u32 s96, s96, s97
s_lshr_b32 s100, s37, 4
v_mfma_f32_16x16x32_bf16 v[184:187], a[148:151], a[20:23], v[184:187]
v_fmac_f32 v134, v50, v82
v_fmac_f32 v199, v67, v86
v_mfma_f32_16x16x32_bf16 v[184:187], a[144:147], a[16:19], v[184:187]
buffer_load_dwordx4 v1, s[4:7], s44 offen offset:1024 sc1 lds
s_lshl_b32 s100, s100, 14
v_mfma_f32_16x16x32_bf16 v[160:163], a[144:147], a[8:11], v[160:163]
v_fmac_f32 v158, v50, v84
v_fmac_f32 v223, v67, v88
v_mfma_f32_16x16x32_bf16 v[160:163], a[148:151], a[12:15], v[160:163]
s_and_b32 s37, s37, 15
s_lshl_b32 s37, s37, 9
s_add_u32 s100, s100, s37
v_mfma_f32_16x16x32_bf16 v[136:139], a[148:151], a[4:7], v[136:139]
v_fmac_f32 v182, v50, v86
v_fmac_f32 v227, v71, v88
v_mfma_f32_16x16x32_bf16 v[136:139], a[144:147], a[0:3], v[136:139]
s_waitcnt vmcnt(10) lgkmcnt(0)
s_barrier
v_mfma_f32_16x16x32_bf16 v[140:143], a[96:99], a[32:35], v[140:143]
ds_read_b128 a[128:131], v5 offset:17408
v_fmac_f32 v206, v50, v88
v_mfma_f32_16x16x32_bf16 v[140:143], a[100:103], a[36:39], v[140:143]
buffer_load_dwordx4 a[0:3], v2, s[40:43], s35 offen offset:0 sc1
s_add_u32 s100, s100, 0x240000
v_mfma_f32_16x16x32_bf16 v[164:167], a[100:103], a[44:47], v[164:167]
ds_read_b128 a[132:135], v5 offset:23552
v_fmac_f32 v210, v54, v88
v_mfma_f32_16x16x32_bf16 v[164:167], a[96:99], a[40:43], v[164:167]
v_fmac_f32 v203, v71, v86
v_fmac_f32 v179, v71, v84
v_mfma_f32_16x16x32_bf16 v[188:191], a[96:99], a[48:51], v[188:191]
buffer_load_dwordx4 a[4:7], v2, s[40:43], s33 offen offset:0 sc1
s_xor_b32 s90, s91, s79
v_mfma_f32_16x16x32_bf16 v[188:191], a[100:103], a[52:55], v[188:191]
ds_read_b128 a[136:139], v5 offset:26624
v_fmac_f32 v186, v54, v86
v_mfma_f32_16x16x32_bf16 v[212:215], a[100:103], a[60:63], v[212:215]
v_fmac_f32 v162, v54, v84
v_fmac_f32 v155, v71, v82
v_mfma_f32_16x16x32_bf16 v[212:215], a[96:99], a[56:59], v[212:215]
buffer_load_dwordx4 a[8:11], v2, s[40:43], s35 offen offset:1024 sc1
s_lshl_b32 s97, s81, 7
v_mfma_f32_16x16x32_bf16 v[216:219], a[104:107], a[56:59], v[216:219]
ds_read_b128 a[140:143], v5 offset:32768
v_fmac_f32 v138, v54, v82
v_mfma_f32_16x16x32_bf16 v[216:219], a[108:111], a[60:63], v[216:219]
v_fmac_f32 v135, v51, v82
v_fmac_f32 v159, v51, v84
v_mfma_f32_16x16x32_bf16 v[192:195], a[108:111], a[52:55], v[192:195]
buffer_load_dwordx4 a[12:15], v2, s[40:43], s33 offen offset:1024 sc1
s_add_u32 s97, s97, s79
v_mfma_f32_16x16x32_bf16 v[192:195], a[104:107], a[48:51], v[192:195]
ds_read_b128 a[144:147], v5 offset:27648
v_fmac_f32 v183, v51, v86
v_mfma_f32_16x16x32_bf16 v[168:171], a[104:107], a[40:43], v[168:171]
v_fmac_f32 v207, v51, v88
s_add_u32 s97, s97, s100
v_mfma_f32_16x16x32_bf16 v[168:171], a[108:111], a[44:47], v[168:171]
buffer_load_dwordx4 a[16:19], v2, s[40:43], s35 offen offset:2048 sc1
s_lshr_b32 s37, s30, 2
v_mfma_f32_16x16x32_bf16 v[144:147], a[108:111], a[36:39], v[144:147]
ds_read_b128 a[148:151], v5 offset:33792
v_fmac_f32 v211, v55, v88
v_mfma_f32_16x16x32_bf16 v[144:147], a[104:107], a[32:35], v[144:147]
s_xor_b32 s37, s37, s51
s_and_b32 s37, s37, 1
s_lshr_b32 s89, s29, 2
v_mfma_f32_16x16x32_bf16 v[148:151], a[112:115], a[32:35], v[148:151]
buffer_load_dwordx4 a[20:23], v2, s[40:43], s33 offen offset:2048 sc1
s_xor_b32 s89, s89, s37
v_mfma_f32_16x16x32_bf16 v[148:151], a[116:119], a[36:39], v[148:151]
v_fmac_f32 v187, v55, v86
s_lshl_b32 s88, s28, 6
v_mfma_f32_16x16x32_bf16 v[172:175], a[116:119], a[44:47], v[172:175]
v_fmac_f32 v163, v55, v84
v_mul_f32 v86, 0x3fb8aa3b, v87
v_mfma_f32_16x16x32_bf16 v[172:175], a[112:115], a[40:43], v[172:175]
buffer_load_dwordx4 a[24:27], v2, s[40:43], s35 offen offset:3072 sc1
s_add_u32 s94, s80, s88
v_mfma_f32_16x16x32_bf16 v[196:199], a[112:115], a[48:51], v[196:199]
v_fmac_f32 v139, v55, v82
v_mul_f32 v84, 0x3fb8aa3b, v85
v_mfma_f32_16x16x32_bf16 v[196:199], a[116:119], a[52:55], v[196:199]
v_mul_f32 v82, 0x3fb8aa3b, v83
s_add_u32 s94, s94, 0x80000
v_mfma_f32_16x16x32_bf16 v[220:223], a[116:119], a[60:63], v[220:223]
buffer_load_dwordx4 a[28:31], v2, s[40:43], s33 offen offset:3072 sc1
s_add_u32 s35, s35, 0x64000
v_mfma_f32_16x16x32_bf16 v[220:223], a[112:115], a[56:59], v[220:223]
s_add_u32 s33, s33, 0x64000
s_waitcnt lgkmcnt(0)
v_mfma_f32_16x16x32_bf16 v[224:227], a[128:131], a[56:59], v[224:227]
ds_read_b128 a[96:99], v5 offset:28672
s_mul_i32 s89, s89, 0x102000
v_mfma_f32_16x16x32_bf16 v[224:227], a[132:135], a[60:63], v[224:227]
buffer_load_dwordx4 v1, s[4:7], s44 offen offset:2048 sc1 lds
s_add_u32 s88, s88, s70
v_mfma_f32_16x16x32_bf16 v[200:203], a[132:135], a[52:55], v[200:203]
ds_read_b128 a[100:103], v5 offset:34816
v_mul_f32 v88, 0x3fb8aa3b, v89
v_mfma_f32_16x16x32_bf16 v[200:203], a[128:131], a[48:51], v[200:203]
s_add_u32 s88, s88, s89
s_add_u32 s89, s88, 0x80000
s_add_u32 s74, s71, 0x10080
v_mfma_f32_16x16x32_bf16 v[176:179], a[128:131], a[40:43], v[176:179]
s_add_u32 s72, s76, 0xc00000
s_add_u32 s73, s75, 0x800000
s_lshr_b32 s38, s28, 1
v_mfma_f32_16x16x32_bf16 v[176:179], a[132:135], a[44:47], v[176:179]
ds_read_b128 a[104:107], v5 offset:29696
s_and_b32 s39, s28, 1
v_mfma_f32_16x16x32_bf16 v[152:155], a[132:135], a[36:39], v[152:155]
s_mul_i32 s38, s38, 3072
s_lshl_b32 s39, s39, 3
s_add_u32 s38, s38, s39
v_mfma_f32_16x16x32_bf16 v[152:155], a[128:131], a[32:35], v[152:155]
s_add_u32 s91, s83, 0x280000
v_add_u32 v233, s19, v232
s_waitcnt vmcnt(18)
v_mfma_f32_16x16x32_bf16 v[140:143], a[136:139], a[64:67], v[140:143]
ds_read_b128 a[108:111], v5 offset:35840
v_and_b32 v248, 4, v0
s_waitcnt vmcnt(17)
v_mfma_f32_16x16x32_bf16 v[140:143], a[140:143], a[68:71], v[140:143]
v_lshlrev_b32 v248, 11, v248
v_bfe_u32 v235, v0, 2, 1
s_waitcnt vmcnt(15)
v_mfma_f32_16x16x32_bf16 v[164:167], a[140:143], a[76:79], v[164:167]
ds_read_b128 a[112:115], v5 offset:38912
v_xor_b32 v248, s90, v248
v_mfma_f32_16x16x32_bf16 v[164:167], a[136:139], a[72:75], v[164:167]
v_and_b32 v249, 3, v0
v_xor_b32 v235, s37, v235
s_waitcnt vmcnt(14)
v_mfma_f32_16x16x32_bf16 v[188:191], a[136:139], a[80:83], v[188:191]
v_lshl_add_u32 v248, v249, 7, v248
v_mul_u32_u24 v235, 4128, v235
s_waitcnt vmcnt(13)
v_mfma_f32_16x16x32_bf16 v[188:191], a[140:143], a[84:87], v[188:191]
buffer_load_dwordx4 v1, s[4:7], s44 offen offset:3072 sc1 lds
s_add_u32 m0, s19, 65536
s_waitcnt vmcnt(11)
v_mfma_f32_16x16x32_bf16 v[212:215], a[140:143], a[92:95], v[212:215]
s_xor_b32 s44, s85, 32768
ds_read_b128 a[116:119], v5 offset:45056
v_mfma_f32_16x16x32_bf16 v[212:215], a[136:139], a[88:91], v[212:215]
v_lshrrev_b32 v249, 4, v0
v_add_lshl_u32 v235, v235, v0, 8
v_mfma_f32_16x16x32_bf16 v[216:219], a[144:147], a[88:91], v[216:219]
v_lshl_add_u32 v248, v249, 4, v248
v_add_u32 v234, s36, v8
v_mfma_f32_16x16x32_bf16 v[216:219], a[148:151], a[92:95], v[216:219]
v_cndmask_b32 v235, 2.0, v235, s[64:65]
v_mov_b32 v249, 0x3f80
v_mfma_f32_16x16x32_bf16 v[192:195], a[148:151], a[84:87], v[192:195]
v_mov_b32 v250, 1.0
v_add_u32 v252, s38, v1
v_mfma_f32_16x16x32_bf16 v[192:195], a[144:147], a[80:83], v[192:195]
v_mfma_f32_16x16x32_bf16 v[168:171], a[144:147], a[72:75], v[168:171]
v_mfma_f32_16x16x32_bf16 v[168:171], a[148:151], a[76:79], v[168:171]
v_mfma_f32_16x16x32_bf16 v[144:147], a[148:151], a[68:71], v[144:147]
v_mfma_f32_16x16x32_bf16 v[144:147], a[144:147], a[64:67], v[144:147]
s_waitcnt lgkmcnt(0)
v_mfma_f32_16x16x32_bf16 v[148:151], a[96:99], a[64:67], v[148:151]
ds_read_b128 a[128:131], v5 offset:39936
v_mfma_f32_16x16x32_bf16 v[148:151], a[100:103], a[68:71], v[148:151]
buffer_load_dwordx4 v1, s[4:7], s44 offen offset:0 sc1 lds
v_mfma_f32_16x16x32_bf16 v[172:175], a[100:103], a[76:79], v[172:175]
ds_read_b128 a[132:135], v5 offset:46080
v_mfma_f32_16x16x32_bf16 v[172:175], a[96:99], a[72:75], v[172:175]
v_mfma_f32_16x16x32_bf16 v[196:199], a[96:99], a[80:83], v[196:199]
v_mfma_f32_16x16x32_bf16 v[196:199], a[100:103], a[84:87], v[196:199]
buffer_load_dwordx4 v1, s[4:7], s44 offen offset:1024 sc1 lds
v_mfma_f32_16x16x32_bf16 v[220:223], a[100:103], a[92:95], v[220:223]
ds_read_b128 a[136:139], v5 offset:40960
v_mfma_f32_16x16x32_bf16 v[220:223], a[96:99], a[88:91], v[220:223]
v_mfma_f32_16x16x32_bf16 v[224:227], a[104:107], a[88:91], v[224:227]
ds_read_b128 a[140:143], v5 offset:47104
v_mfma_f32_16x16x32_bf16 v[224:227], a[108:111], a[92:95], v[224:227]
v_mfma_f32_16x16x32_bf16 v[200:203], a[108:111], a[84:87], v[200:203]
buffer_load_dwordx4 v1, s[4:7], s44 offen offset:2048 sc1 lds
v_mfma_f32_16x16x32_bf16 v[200:203], a[104:107], a[80:83], v[200:203]
ds_read_b128 a[144:147], v5 offset:41984
v_mfma_f32_16x16x32_bf16 v[176:179], a[104:107], a[72:75], v[176:179]
v_mfma_f32_16x16x32_bf16 v[176:179], a[108:111], a[76:79], v[176:179]
ds_read_b128 a[148:151], v5 offset:48128
v_mfma_f32_16x16x32_bf16 v[152:155], a[108:111], a[68:71], v[152:155]
v_mfma_f32_16x16x32_bf16 v[152:155], a[104:107], a[64:67], v[152:155]
buffer_load_dwordx4 v1, s[4:7], s44 offen offset:3072 sc1 lds
s_add_u32 m0, s19, 81920
s_waitcnt vmcnt(13)
v_mfma_f32_16x16x32_bf16 v[140:143], a[112:115], a[0:3], v[140:143]
s_xor_b32 s44, s85, 49152
s_waitcnt vmcnt(12)
v_mfma_f32_16x16x32_bf16 v[140:143], a[116:119], a[4:7], v[140:143]
s_waitcnt vmcnt(10)
v_mfma_f32_16x16x32_bf16 v[164:167], a[116:119], a[12:15], v[164:167]
v_mfma_f32_16x16x32_bf16 v[164:167], a[112:115], a[8:11], v[164:167]
s_waitcnt vmcnt(9)
v_mfma_f32_16x16x32_bf16 v[188:191], a[112:115], a[16:19], v[188:191]
buffer_load_dwordx4 v1, s[4:7], s44 offen offset:0 sc1 lds
s_waitcnt vmcnt(9)
v_mfma_f32_16x16x32_bf16 v[188:191], a[116:119], a[20:23], v[188:191]
s_waitcnt vmcnt(7)
v_mfma_f32_16x16x32_bf16 v[212:215], a[116:119], a[28:31], v[212:215]
v_mfma_f32_16x16x32_bf16 v[212:215], a[112:115], a[24:27], v[212:215]
s_waitcnt lgkmcnt(0)
v_mfma_f32_16x16x32_bf16 v[216:219], a[128:131], a[24:27], v[216:219]
ds_read_b128 a[96:99], v5 offset:12288
v_cvt_pk_bf16_f32 v140, v140, v141
v_mfma_f32_16x16x32_bf16 v[216:219], a[132:135], a[28:31], v[216:219]
buffer_load_dwordx4 v1, s[4:7], s44 offen offset:1024 sc1 lds
v_mfma_f32_16x16x32_bf16 v[192:195], a[132:135], a[20:23], v[192:195]
ds_read_b128 a[100:103], v5 offset:18432
v_cvt_pk_bf16_f32 v141, v142, v143
v_mfma_f32_16x16x32_bf16 v[192:195], a[128:131], a[16:19], v[192:195]
v_cvt_pk_bf16_f32 v164, v164, v165
v_cvt_pk_bf16_f32 v165, v166, v167
v_mfma_f32_16x16x32_bf16 v[168:171], a[128:131], a[8:11], v[168:171]
v_cvt_pk_bf16_f32 v188, v188, v189
v_cvt_pk_bf16_f32 v189, v190, v191
v_mfma_f32_16x16x32_bf16 v[168:171], a[132:135], a[12:15], v[168:171]
buffer_load_dwordx4 v1, s[4:7], s44 offen offset:2048 sc1 lds
v_mfma_f32_16x16x32_bf16 v[144:147], a[132:135], a[4:7], v[144:147]
ds_read_b128 a[104:107], v5 offset:24576
v_cvt_pk_bf16_f32 v212, v212, v213
v_mfma_f32_16x16x32_bf16 v[144:147], a[128:131], a[0:3], v[144:147]
v_cvt_pk_bf16_f32 v213, v214, v215
v_mfma_f32_16x16x32_bf16 v[148:151], a[136:139], a[0:3], v[148:151]
ds_read_b128 a[108:111], v5 offset:30720
v_cvt_pk_bf16_f32 v214, v216, v217
v_mfma_f32_16x16x32_bf16 v[148:151], a[140:143], a[4:7], v[148:151]
v_cvt_pk_bf16_f32 v215, v218, v219
v_mfma_f32_16x16x32_bf16 v[172:175], a[140:143], a[12:15], v[172:175]
buffer_load_dwordx4 v1, s[4:7], s44 offen offset:3072 sc1 lds
s_add_u32 m0, s19, 147456
v_mfma_f32_16x16x32_bf16 v[172:175], a[136:139], a[8:11], v[172:175]
s_xor_b32 s44, s85, 114688
ds_read_b128 a[112:115], v5 offset:36864
v_mfma_f32_16x16x32_bf16 v[196:199], a[136:139], a[16:19], v[196:199]
v_cvt_pk_bf16_f32 v166, v168, v169
v_cvt_pk_bf16_f32 v167, v170, v171
v_mfma_f32_16x16x32_bf16 v[196:199], a[140:143], a[20:23], v[196:199]
ds_read_b128 a[116:119], v5 offset:43008
v_cvt_pk_bf16_f32 v190, v192, v193
v_mfma_f32_16x16x32_bf16 v[220:223], a[140:143], a[28:31], v[220:223]
v_cvt_pk_bf16_f32 v142, v144, v145
v_cvt_pk_bf16_f32 v143, v146, v147
v_mfma_f32_16x16x32_bf16 v[220:223], a[136:139], a[24:27], v[220:223]
buffer_load_dwordx4 v1, s[4:7], s44 offen offset:0 sc1 lds
v_mfma_f32_16x16x32_bf16 v[224:227], a[144:147], a[24:27], v[224:227]
v_mfma_f32_16x16x32_bf16 v[92:95], a[240:243], v[140:143], 0
v_mfma_f32_16x16x32_bf16 v[224:227], a[148:151], a[28:31], v[224:227]
v_mfma_f32_16x16x32_bf16 v[96:99], a[244:247], v[140:143], 0
v_mfma_f32_16x16x32_bf16 v[200:203], a[148:151], a[20:23], v[200:203]
v_mfma_f32_16x16x32_bf16 v[100:103], a[240:243], v[164:167], 0
v_mfma_f32_16x16x32_bf16 v[200:203], a[144:147], a[16:19], v[200:203]
v_mfma_f32_16x16x32_bf16 v[104:107], a[244:247], v[164:167], 0
v_mfma_f32_16x16x32_bf16 v[176:179], a[144:147], a[8:11], v[176:179]
buffer_load_dwordx4 v1, s[4:7], s44 offen offset:1024 sc1 lds
v_mfma_f32_16x16x32_bf16 v[176:179], a[148:151], a[12:15], v[176:179]
v_max3_f32 v236, v92, v93, v94
v_max3_f32 v237, -v92, -v93, -v94
v_mfma_f32_16x16x32_bf16 v[152:155], a[148:151], a[4:7], v[152:155]
v_max3_f32 v236, v236, v95, v96
v_max3_f32 v237, v237, -v95, -v96
v_mfma_f32_16x16x32_bf16 v[152:155], a[144:147], a[0:3], v[152:155]
v_max3_f32 v236, v236, v97, v98
s_waitcnt lgkmcnt(0)
v_mfma_f32_16x16x32_bf16 v[132:135], a[96:99], a[32:35], v[132:135]
ds_read_b128 a[128:131], v5 offset:13312
v_max3_f32 v237, v237, -v97, -v98
v_mfma_f32_16x16x32_bf16 v[132:135], a[100:103], a[36:39], v[132:135]
buffer_load_dwordx4 v1, s[4:7], s44 offen offset:2048 sc1 lds
v_mfma_f32_16x16x32_bf16 v[156:159], a[100:103], a[44:47], v[156:159]
ds_read_b128 a[132:135], v5 offset:19456
v_max_f32 v236, v236, v99
v_mfma_f32_16x16x32_bf16 v[156:159], a[96:99], a[40:43], v[156:159]
v_max_f32_e64 v237, v237, -v99
v_max3_f32 v238, v100, v101, v102
v_mfma_f32_16x16x32_bf16 v[180:183], a[96:99], a[48:51], v[180:183]
v_permlane32_swap_b32 v236, v237
v_mfma_f32_16x16x32_bf16 v[180:183], a[100:103], a[52:55], v[180:183]
buffer_load_dwordx4 v1, s[4:7], s44 offen offset:3072 sc1 lds
s_add_u32 m0, s19, 98304
v_mfma_f32_16x16x32_bf16 v[204:207], a[100:103], a[60:63], v[204:207]
s_xor_b32 s44, s85, 65536
ds_read_b128 a[136:139], v5 offset:25600
v_mfma_f32_16x16x32_bf16 v[204:207], a[96:99], a[56:59], v[204:207]
v_max_f32 v236, v236, v237
v_mov_b32 v244, v236
v_mfma_f32_16x16x32_bf16 v[204:207], a[104:107], a[88:91], v[204:207]
ds_read_b128 a[140:143], v5 offset:31744
v_max3_f32 v239, -v100, -v101, -v102
L_stub7:
s_cbranch_execz L_wret2
v_mfma_f32_16x16x32_bf16 v[204:207], a[108:111], a[92:95], v[204:207]
v_permlane16_swap_b32 v236, v244
v_mfma_f32_16x16x32_bf16 v[180:183], a[108:111], a[84:87], v[180:183]
buffer_load_dwordx4 v1, s[4:7], s44 offen offset:0 sc1 lds
v_mfma_f32_16x16x32_bf16 v[180:183], a[104:107], a[80:83], v[180:183]
ds_read_b128 a[144:147], v5 offset:37888
v_max_f32 v236, v236, v244
v_mfma_f32_16x16x32_bf16 v[156:159], a[104:107], a[72:75], v[156:159]
v_mov_b32 v244, v236
v_max3_f32 v238, v238, v103, v104
v_mfma_f32_16x16x32_bf16 v[156:159], a[108:111], a[76:79], v[156:159]
ds_read_b128 a[148:151], v5 offset:44032
v_max3_f32 v239, v239, -v103, -v104
v_mfma_f32_16x16x32_bf16 v[132:135], a[108:111], a[68:71], v[132:135]
v_permlane32_swap_b32 v236, v244
v_mfma_f32_16x16x32_bf16 v[132:135], a[104:107], a[64:67], v[132:135]
buffer_load_dwordx4 v1, s[4:7], s44 offen offset:1024 sc1 lds
v_mfma_f32_16x16x32_bf16 v[132:135], a[112:115], a[0:3], v[132:135]
v_mul_f32_e64 v236, -v236, v82
v_mul_f32_e64 v237, -v244, v82
v_mfma_f32_16x16x32_bf16 v[132:135], a[116:119], a[4:7], v[132:135]
v_max3_f32 v238, v238, v105, v106
v_max3_f32 v239, v239, -v105, -v106
v_mfma_f32_16x16x32_bf16 v[156:159], a[116:119], a[12:15], v[156:159]
v_max_f32 v238, v238, v107
v_max_f32_e64 v239, v239, -v107
v_mfma_f32_16x16x32_bf16 v[156:159], a[112:115], a[8:11], v[156:159]
s_nop 0
v_permlane32_swap_b32 v238, v239
v_mfma_f32_16x16x32_bf16 v[180:183], a[112:115], a[16:19], v[180:183]
buffer_load_dwordx4 v1, s[4:7], s44 offen offset:2048 sc1 lds
v_mfma_f32_16x16x32_bf16 v[180:183], a[116:119], a[20:23], v[180:183]
v_max_f32 v238, v238, v239
v_mov_b32 v245, v238
v_mfma_f32_16x16x32_bf16 v[204:207], a[116:119], a[28:31], v[204:207]
s_nop 0
v_permlane16_swap_b32 v238, v245
v_mfma_f32_16x16x32_bf16 v[204:207], a[112:115], a[24:27], v[204:207]
s_waitcnt lgkmcnt(0)
s_barrier
v_mfma_f32_16x16x32_bf16 v[208:211], a[128:131], a[56:59], v[208:211]
v_max_f32 v238, v238, v245
v_mov_b32 v245, v238
v_mfma_f32_16x16x32_bf16 v[208:211], a[132:135], a[60:63], v[208:211]
buffer_load_dwordx4 v1, s[4:7], s44 offen offset:3072 sc1 lds
s_add_u32 m0, s19, 114688
v_mfma_f32_16x16x32_bf16 v[184:187], a[132:135], a[52:55], v[184:187]
s_xor_b32 s44, s85, 81920
v_cvt_pk_bf16_f32 v191, v194, v195
v_mfma_f32_16x16x32_bf16 v[184:187], a[128:131], a[48:51], v[184:187]
v_permlane32_swap_b32 v238, v245
v_mfma_f32_16x16x32_bf16 v[160:163], a[128:131], a[40:43], v[160:163]
v_mul_f32_e64 v238, -v238, v84
v_mul_f32_e64 v239, -v245, v84
v_mfma_f32_16x16x32_bf16 v[160:163], a[132:135], a[44:47], v[160:163]
buffer_load_dwordx4 v1, s[4:7], s44 offen offset:0 sc1 lds
v_mfma_f32_16x16x32_bf16 v[136:139], a[132:135], a[36:39], v[136:139]
v_mfma_f32_16x16x32_bf16 v[108:111], a[240:243], v[188:191], 0
v_mfma_f32_16x16x32_bf16 v[136:139], a[128:131], a[32:35], v[136:139]
v_mfma_f32_16x16x32_bf16 v[112:115], a[244:247], v[188:191], 0
v_mfma_f32_16x16x32_bf16 v[136:139], a[136:139], a[64:67], v[136:139]
v_mfma_f32_16x16x32_bf16 v[116:119], a[240:243], v[212:215], 0
v_mfma_f32_16x16x32_bf16 v[136:139], a[140:143], a[68:71], v[136:139]
v_mfma_f32_16x16x32_bf16 v[120:123], a[244:247], v[212:215], 0
v_mfma_f32_16x16x32_bf16 v[160:163], a[140:143], a[76:79], v[160:163]
buffer_load_dwordx4 v1, s[4:7], s44 offen offset:1024 sc1 lds
v_mfma_f32_16x16x32_bf16 v[160:163], a[136:139], a[72:75], v[160:163]
v_max3_f32 v240, v108, v109, v110
v_max3_f32 v241, -v108, -v109, -v110
v_mfma_f32_16x16x32_bf16 v[184:187], a[136:139], a[80:83], v[184:187]
v_max3_f32 v240, v240, v111, v112
v_max3_f32 v241, v241, -v111, -v112
v_mfma_f32_16x16x32_bf16 v[184:187], a[140:143], a[84:87], v[184:187]
v_max3_f32 v240, v240, v113, v114
v_max3_f32 v241, v241, -v113, -v114
v_mfma_f32_16x16x32_bf16 v[208:211], a[140:143], a[92:95], v[208:211]
v_max_f32 v240, v240, v115
v_max_f32_e64 v241, v241, -v115
v_mfma_f32_16x16x32_bf16 v[208:211], a[136:139], a[88:91], v[208:211]
buffer_load_dwordx4 v1, s[4:7], s44 offen offset:2048 sc1 lds
v_mfma_f32_16x16x32_bf16 v[208:211], a[144:147], a[24:27], v[208:211]
v_permlane32_swap_b32 v240, v241
v_mfma_f32_16x16x32_bf16 v[208:211], a[148:151], a[28:31], v[208:211]
v_max_f32 v240, v240, v241
v_mov_b32 v246, v240
v_mfma_f32_16x16x32_bf16 v[184:187], a[148:151], a[20:23], v[184:187]
s_nop 0
v_permlane16_swap_b32 v240, v246
v_mfma_f32_16x16x32_bf16 v[184:187], a[144:147], a[16:19], v[184:187]
v_max_f32 v240, v240, v246
v_mov_b32 v246, v240
v_mfma_f32_16x16x32_bf16 v[160:163], a[144:147], a[8:11], v[160:163]
buffer_load_dwordx4 v1, s[4:7], s44 offen offset:3072 sc1 lds
v_mfma_f32_16x16x32_bf16 v[160:163], a[148:151], a[12:15], v[160:163]
v_permlane32_swap_b32 v240, v246
v_mfma_f32_16x16x32_bf16 v[136:139], a[148:151], a[4:7], v[136:139]
v_mul_f32_e64 v240, -v240, v86
v_mul_f32_e64 v241, -v246, v86
v_mfma_f32_16x16x32_bf16 v[136:139], a[144:147], a[0:3], v[136:139]
v_max3_f32 v242, v116, v117, v118
v_max3_f32 v243, -v116, -v117, -v118
v_pk_mul_f32 v[148:149], v[148:149], v[82:83] op_sel:[0,1] op_sel_hi:[1,1]
v_pk_mul_f32 v[150:151], v[150:151], v[82:83] op_sel:[0,1] op_sel_hi:[1,1]
v_cvt_pk_bf16_f32 v148, v148, v149
v_cvt_pk_bf16_f32 v149, v150, v151
ds_write_b64 v232, v[148:149] offset:0
v_pk_mul_f32 v[152:153], v[152:153], v[82:83] op_sel:[0,1] op_sel_hi:[1,1]
v_pk_mul_f32 v[154:155], v[154:155], v[82:83] op_sel:[0,1] op_sel_hi:[1,1]
v_cvt_pk_bf16_f32 v150, v152, v153
v_cvt_pk_bf16_f32 v151, v154, v155
v_pk_mul_f32 v[172:173], v[172:173], v[84:85] op_sel:[0,1] op_sel_hi:[1,1]
v_pk_mul_f32 v[174:175], v[174:175], v[84:85] op_sel:[0,1] op_sel_hi:[1,1]
v_cvt_pk_bf16_f32 v172, v172, v173
buffer_store_dwordx4 a[248:251], v254, s[4:7], s97 offen offset:0 sc1
v_cvt_pk_bf16_f32 v173, v174, v175
ds_write_b64 v232, v[150:151] offset:512
v_pk_mul_f32 v[176:177], v[176:177], v[84:85] op_sel:[0,1] op_sel_hi:[1,1]
v_pk_mul_f32 v[178:179], v[178:179], v[84:85] op_sel:[0,1] op_sel_hi:[1,1]
v_cvt_pk_bf16_f32 v174, v176, v177
v_cvt_pk_bf16_f32 v175, v178, v179
v_pk_mul_f32 v[196:197], v[196:197], v[86:87] op_sel:[0,1] op_sel_hi:[1,1]
v_pk_mul_f32 v[198:199], v[198:199], v[86:87] op_sel:[0,1] op_sel_hi:[1,1]
v_cvt_pk_bf16_f32 v196, v196, v197
v_cvt_pk_bf16_f32 v197, v198, v199
v_pk_mul_f32 v[200:201], v[200:201], v[86:87] op_sel:[0,1] op_sel_hi:[1,1]
v_pk_mul_f32 v[202:203], v[202:203], v[86:87] op_sel:[0,1] op_sel_hi:[1,1]
v_cvt_pk_bf16_f32 v198, v200, v201
v_cvt_pk_bf16_f32 v199, v202, v203
ds_write_b64 v232, v[172:173] offset:1024
v_pk_mul_f32 v[220:221], v[220:221], v[88:89] op_sel:[0,1] op_sel_hi:[1,1]
v_pk_mul_f32 v[222:223], v[222:223], v[88:89] op_sel:[0,1] op_sel_hi:[1,1]
v_cvt_pk_bf16_f32 v220, v220, v221
v_cvt_pk_bf16_f32 v221, v222, v223
v_pk_fma_f32 v[48:49], v[92:93], v[82:83], v[236:237] op_sel:[0,0,0] op_sel_hi:[1,0,0]
v_pk_fma_f32 v[50:51], v[94:95], v[82:83], v[236:237] op_sel:[0,0,0] op_sel_hi:[1,0,0]
v_pk_fma_f32 v[52:53], v[96:97], v[82:83], v[236:237] op_sel:[0,0,0] op_sel_hi:[1,0,0]
v_pk_fma_f32 v[54:55], v[98:99], v[82:83], v[236:237] op_sel:[0,0,0] op_sel_hi:[1,0,0]
v_exp_f32 v48, v48
v_exp_f32 v49, v49
ds_write_b64 v232, v[174:175] offset:1536
buffer_store_dwordx4 a[248:251], v1, s[4:7], s96 offen offset:0 sc1
v_exp_f32 v50, v50
v_exp_f32 v51, v51
v_exp_f32 v52, v52
v_exp_f32 v53, v53
ds_write_b64 v232, v[196:197] offset:2048
v_exp_f32 v54, v54
v_exp_f32 v55, v55
v_cvt_pk_bf16_f32 v140, v48, v49
v_cvt_pk_bf16_f32 v141, v50, v51
v_cvt_pk_bf16_f32 v142, v52, v53
v_cvt_pk_bf16_f32 v143, v54, v55
v_pk_mul_f32 v[224:225], v[224:225], v[88:89] op_sel:[0,1] op_sel_hi:[1,1]
v_pk_mul_f32 v[226:227], v[226:227], v[88:89] op_sel:[0,1] op_sel_hi:[1,1]
v_cvt_pk_bf16_f32 v222, v224, v225
v_mfma_f32_16x16x32_bf16 v[148:151], v[16:19], v[140:143], 0
ds_write_b64 v232, v[198:199] offset:2560
v_cvt_pk_bf16_f32 v223, v226, v227
s_add_u32 m0, s19, 131072
v_pk_fma_f32 v[92:93], v[92:93], v[82:83], v[236:237] op_sel:[0,0,1] op_sel_hi:[1,0,1] neg_lo:[1,0,0] neg_hi:[1,0,0]
v_pk_fma_f32 v[94:95], v[94:95], v[82:83], v[236:237] op_sel:[0,0,1] op_sel_hi:[1,0,1] neg_lo:[1,0,0] neg_hi:[1,0,0]
v_pk_fma_f32 v[96:97], v[96:97], v[82:83], v[236:237] op_sel:[0,0,1] op_sel_hi:[1,0,1] neg_lo:[1,0,0] neg_hi:[1,0,0]
s_nop 1
v_rcp_f32 v148, v148
buffer_store_dwordx4 a[248:251], v3, s[4:7], s91 offen offset:0 sc1
v_pk_mul_f32 v[48:49], v[48:49], v[148:149] op_sel:[0,0] op_sel_hi:[1,0]
ds_write_b64 v232, v[220:221] offset:3072
v_pk_mul_f32 v[50:51], v[50:51], v[148:149] op_sel:[0,0] op_sel_hi:[1,0]
v_cvt_pk_bf16_f32 v140, v48, v49
v_cvt_pk_bf16_f32 v141, v50, v51
v_pk_fma_f32 v[98:99], v[98:99], v[82:83], v[236:237] op_sel:[0,0,1] op_sel_hi:[1,0,1] neg_lo:[1,0,0] neg_hi:[1,0,0]
v_exp_f32 v92, v92
v_exp_f32 v93, v93
buffer_store_dwordx4 a[248:251], v3, s[4:7], s91 offen offset:1024 sc1
ds_write_b64 v232, v[222:223] offset:3584
v_exp_f32 v94, v94
v_exp_f32 v95, v95
v_exp_f32 v96, v96
v_exp_f32 v97, v97
v_exp_f32 v98, v98
v_exp_f32 v99, v99
ds_write_b64 v233, v[140:141] offset:16384
s_xor_b32 s44, s85, 98304
v_cvt_pk_bf16_f32 v144, v92, v93
v_cvt_pk_bf16_f32 v145, v94, v95
v_cvt_pk_bf16_f32 v146, v96, v97
v_cvt_pk_bf16_f32 v147, v98, v99
buffer_load_dwordx4 v1, s[4:7], s44 offen offset:0 sc1 lds
v_pk_mul_f32 v[52:53], v[52:53], v[148:149] op_sel:[0,0] op_sel_hi:[1,0]
v_cvt_pk_bf16_f32 v142, v52, v53
v_pk_mul_f32 v[54:55], v[54:55], v[148:149] op_sel:[0,0] op_sel_hi:[1,0]
v_cvt_pk_bf16_f32 v143, v54, v55
v_mfma_f32_16x16x32_bf16 v[152:155], v[16:19], v[144:147], 0
ds_write_b64 v233, v[142:143] offset:16896
v_max3_f32 v242, v242, v119, v120
v_max3_f32 v243, v243, -v119, -v120
v_pk_fma_f32 v[56:57], v[100:101], v[84:85], v[238:239] op_sel:[0,0,0] op_sel_hi:[1,0,0]
v_pk_fma_f32 v[58:59], v[102:103], v[84:85], v[238:239] op_sel:[0,0,0] op_sel_hi:[1,0,0]
v_pk_fma_f32 v[60:61], v[104:105], v[84:85], v[238:239] op_sel:[0,0,0] op_sel_hi:[1,0,0]
s_nop 1
v_rcp_f32 v152, v152
v_pk_fma_f32 v[62:63], v[106:107], v[84:85], v[238:239] op_sel:[0,0,0] op_sel_hi:[1,0,0]
v_pk_mul_f32 v[92:93], v[92:93], v[152:153] op_sel:[0,0] op_sel_hi:[1,0]
v_pk_mul_f32 v[94:95], v[94:95], v[152:153] op_sel:[0,0] op_sel_hi:[1,0]
v_cvt_pk_bf16_f32 v144, v92, v93
v_cvt_pk_bf16_f32 v145, v94, v95
ds_write_b64 v233, v[144:145] offset:17408
v_exp_f32 v56, v56
v_exp_f32 v57, v57
v_exp_f32 v58, v58
v_exp_f32 v59, v59
v_exp_f32 v60, v60
v_exp_f32 v61, v61
v_exp_f32 v62, v62
v_exp_f32 v63, v63
buffer_load_dwordx4 v1, s[4:7], s44 offen offset:1024 sc1 lds
v_cvt_pk_bf16_f32 v164, v56, v57
v_cvt_pk_bf16_f32 v165, v58, v59
v_cvt_pk_bf16_f32 v166, v60, v61
v_cvt_pk_bf16_f32 v167, v62, v63
v_pk_mul_f32 v[96:97], v[96:97], v[152:153] op_sel:[0,0] op_sel_hi:[1,0]
v_pk_mul_f32 v[98:99], v[98:99], v[152:153] op_sel:[0,0] op_sel_hi:[1,0]
v_cvt_pk_bf16_f32 v146, v96, v97
v_mfma_f32_16x16x32_bf16 v[172:175], v[16:19], v[164:167], 0
v_cvt_pk_bf16_f32 v147, v98, v99
ds_write_b64 v233, v[146:147] offset:17920
v_max3_f32 v242, v242, v121, v122
v_pk_fma_f32 v[100:101], v[100:101], v[84:85], v[238:239] op_sel:[0,0,1] op_sel_hi:[1,0,1] neg_lo:[1,0,0] neg_hi:[1,0,0]
v_pk_fma_f32 v[102:103], v[102:103], v[84:85], v[238:239] op_sel:[0,0,1] op_sel_hi:[1,0,1] neg_lo:[1,0,0] neg_hi:[1,0,0]
v_pk_fma_f32 v[104:105], v[104:105], v[84:85], v[238:239] op_sel:[0,0,1] op_sel_hi:[1,0,1] neg_lo:[1,0,0] neg_hi:[1,0,0]
s_nop 1
v_rcp_f32 v172, v172
v_pk_fma_f32 v[106:107], v[106:107], v[84:85], v[238:239] op_sel:[0,0,1] op_sel_hi:[1,0,1] neg_lo:[1,0,0] neg_hi:[1,0,0]
v_pk_mul_f32 v[56:57], v[56:57], v[172:173] op_sel:[0,0] op_sel_hi:[1,0]
v_pk_mul_f32 v[58:59], v[58:59], v[172:173] op_sel:[0,0] op_sel_hi:[1,0]
v_cvt_pk_bf16_f32 v164, v56, v57
v_cvt_pk_bf16_f32 v165, v58, v59
v_exp_f32 v100, v100
ds_write_b64 v233, v[164:165] offset:18432
v_exp_f32 v101, v101
v_exp_f32 v102, v102
v_exp_f32 v103, v103
v_exp_f32 v104, v104
v_exp_f32 v105, v105
v_exp_f32 v106, v106
v_exp_f32 v107, v107
buffer_load_dwordx4 v1, s[4:7], s44 offen offset:2048 sc1 lds
v_cvt_pk_bf16_f32 v168, v100, v101
v_cvt_pk_bf16_f32 v169, v102, v103
v_cvt_pk_bf16_f32 v170, v104, v105
v_cvt_pk_bf16_f32 v171, v106, v107
v_pk_mul_f32 v[60:61], v[60:61], v[172:173] op_sel:[0,0] op_sel_hi:[1,0]
v_pk_mul_f32 v[62:63], v[62:63], v[172:173] op_sel:[0,0] op_sel_hi:[1,0]
v_cvt_pk_bf16_f32 v166, v60, v61
v_mfma_f32_16x16x32_bf16 v[176:179], v[16:19], v[168:171], 0
v_cvt_pk_bf16_f32 v167, v62, v63
ds_write_b64 v233, v[166:167] offset:18944
v_max3_f32 v243, v243, -v121, -v122
v_pk_fma_f32 v[64:65], v[108:109], v[86:87], v[240:241] op_sel:[0,0,0] op_sel_hi:[1,0,0]
v_pk_fma_f32 v[66:67], v[110:111], v[86:87], v[240:241] op_sel:[0,0,0] op_sel_hi:[1,0,0]
v_pk_fma_f32 v[68:69], v[112:113], v[86:87], v[240:241] op_sel:[0,0,0] op_sel_hi:[1,0,0]
s_nop 1
v_rcp_f32 v176, v176
v_pk_fma_f32 v[70:71], v[114:115], v[86:87], v[240:241] op_sel:[0,0,0] op_sel_hi:[1,0,0]
v_pk_mul_f32 v[100:101], v[100:101], v[176:177] op_sel:[0,0] op_sel_hi:[1,0]
v_pk_mul_f32 v[102:103], v[102:103], v[176:177] op_sel:[0,0] op_sel_hi:[1,0]
v_cvt_pk_bf16_f32 v168, v100, v101
v_cvt_pk_bf16_f32 v169, v102, v103
v_exp_f32 v64, v64
ds_write_b64 v233, v[168:169] offset:19456
buffer_load_dwordx4 v1, s[4:7], s44 offen offset:3072 sc1 lds
v_exp_f32 v65, v65
v_exp_f32 v66, v66
v_exp_f32 v67, v67
v_exp_f32 v68, v68
v_exp_f32 v69, v69
v_exp_f32 v70, v70
v_exp_f32 v71, v71
v_cvt_pk_bf16_f32 v188, v64, v65
v_cvt_pk_bf16_f32 v189, v66, v67
v_cvt_pk_bf16_f32 v190, v68, v69
v_cvt_pk_bf16_f32 v191, v70, v71
v_pk_mul_f32 v[104:105], v[104:105], v[176:177] op_sel:[0,0] op_sel_hi:[1,0]
v_pk_mul_f32 v[106:107], v[106:107], v[176:177] op_sel:[0,0] op_sel_hi:[1,0]
v_cvt_pk_bf16_f32 v170, v104, v105
v_mfma_f32_16x16x32_bf16 v[196:199], v[16:19], v[188:191], 0
v_cvt_pk_bf16_f32 v171, v106, v107
ds_write_b64 v233, v[170:171] offset:19968
buffer_store_dwordx4 a[248:251], v2, s[4:7], s72 offen offset:0 sc1
s_nop 4
v_rcp_f32 v196, v196
v_pk_fma_f32 v[108:109], v[108:109], v[86:87], v[240:241] op_sel:[0,0,1] op_sel_hi:[1,0,1] neg_lo:[1,0,0] neg_hi:[1,0,0]
v_pk_mul_f32 v[64:65], v[64:65], v[196:197] op_sel:[0,0] op_sel_hi:[1,0]
v_pk_mul_f32 v[66:67], v[66:67], v[196:197] op_sel:[0,0] op_sel_hi:[1,0]
v_cvt_pk_bf16_f32 v188, v64, v65
v_cvt_pk_bf16_f32 v189, v66, v67
v_pk_fma_f32 v[110:111], v[110:111], v[86:87], v[240:241] op_sel:[0,0,1] op_sel_hi:[1,0,1] neg_lo:[1,0,0] neg_hi:[1,0,0]
ds_write_b64 v233, v[188:189] offset:20480
v_pk_fma_f32 v[112:113], v[112:113], v[86:87], v[240:241] op_sel:[0,0,1] op_sel_hi:[1,0,1] neg_lo:[1,0,0] neg_hi:[1,0,0]
v_pk_fma_f32 v[114:115], v[114:115], v[86:87], v[240:241] op_sel:[0,0,1] op_sel_hi:[1,0,1] neg_lo:[1,0,0] neg_hi:[1,0,0]
v_exp_f32 v108, v108
v_exp_f32 v109, v109
v_exp_f32 v110, v110
v_exp_f32 v111, v111
v_exp_f32 v112, v112
v_exp_f32 v113, v113
v_exp_f32 v114, v114
v_exp_f32 v115, v115
v_max_f32 v242, v242, v123
v_max_f32_e64 v243, v243, -v123
v_cvt_pk_bf16_f32 v192, v108, v109
v_cvt_pk_bf16_f32 v193, v110, v111
v_cvt_pk_bf16_f32 v194, v112, v113
v_cvt_pk_bf16_f32 v195, v114, v115
v_pk_mul_f32 v[68:69], v[68:69], v[196:197] op_sel:[0,0] op_sel_hi:[1,0]
v_pk_mul_f32 v[70:71], v[70:71], v[196:197] op_sel:[0,0] op_sel_hi:[1,0]
v_permlane32_swap_b32 v242, v243
v_mfma_f32_16x16x32_bf16 v[200:203], v[16:19], v[192:195], 0
v_cvt_pk_bf16_f32 v190, v68, v69
v_cvt_pk_bf16_f32 v191, v70, v71
ds_write_b64 v233, v[190:191] offset:20992
v_max_f32 v242, v242, v243
v_mov_b32 v247, v242
buffer_store_dwordx4 a[248:251], v2, s[4:7], s72 offen offset:1024 sc1
s_nop 0
v_permlane16_swap_b32 v242, v247
v_rcp_f32 v200, v200
v_max_f32 v242, v242, v247
v_mov_b32 v247, v242
v_pk_mul_f32 v[108:109], v[108:109], v[200:201] op_sel:[0,0] op_sel_hi:[1,0]
v_pk_mul_f32 v[110:111], v[110:111], v[200:201] op_sel:[0,0] op_sel_hi:[1,0]
v_cvt_pk_bf16_f32 v192, v108, v109
v_cvt_pk_bf16_f32 v193, v110, v111
v_permlane32_swap_b32 v242, v247
ds_write_b64 v233, v[192:193] offset:21504
v_mul_f32_e64 v242, -v242, v88
v_mul_f32_e64 v243, -v247, v88
v_pk_fma_f32 v[124:125], v[116:117], v[88:89], v[242:243] op_sel:[0,0,0] op_sel_hi:[1,0,0]
v_pk_fma_f32 v[126:127], v[118:119], v[88:89], v[242:243] op_sel:[0,0,0] op_sel_hi:[1,0,0]
v_pk_fma_f32 v[128:129], v[120:121], v[88:89], v[242:243] op_sel:[0,0,0] op_sel_hi:[1,0,0]
v_pk_fma_f32 v[130:131], v[122:123], v[88:89], v[242:243] op_sel:[0,0,0] op_sel_hi:[1,0,0]
v_exp_f32 v124, v124
v_exp_f32 v125, v125
v_exp_f32 v126, v126
v_exp_f32 v127, v127
v_exp_f32 v128, v128
v_exp_f32 v129, v129
v_exp_f32 v130, v130
v_exp_f32 v131, v131
v_cvt_pk_bf16_f32 v212, v124, v125
v_cvt_pk_bf16_f32 v213, v126, v127
v_cvt_pk_bf16_f32 v214, v128, v129
v_cvt_pk_bf16_f32 v215, v130, v131
v_pk_mul_f32 v[112:113], v[112:113], v[200:201] op_sel:[0,0] op_sel_hi:[1,0]
v_pk_mul_f32 v[114:115], v[114:115], v[200:201] op_sel:[0,0] op_sel_hi:[1,0]
v_cvt_pk_bf16_f32 v194, v112, v113
v_mfma_f32_16x16x32_bf16 v[220:223], v[16:19], v[212:215], 0
v_cvt_pk_bf16_f32 v195, v114, v115
ds_write_b64 v233, v[194:195] offset:22016
buffer_store_dwordx4 a[248:251], v2, s[4:7], s72 offen offset:2048 sc1
s_nop 4
v_rcp_f32 v220, v220
v_pk_fma_f32 v[116:117], v[116:117], v[88:89], v[242:243] op_sel:[0,0,1] op_sel_hi:[1,0,1] neg_lo:[1,0,0] neg_hi:[1,0,0]
v_pk_mul_f32 v[124:125], v[124:125], v[220:221] op_sel:[0,0] op_sel_hi:[1,0]
v_pk_mul_f32 v[126:127], v[126:127], v[220:221] op_sel:[0,0] op_sel_hi:[1,0]
v_cvt_pk_bf16_f32 v212, v124, v125
v_cvt_pk_bf16_f32 v213, v126, v127
v_pk_fma_f32 v[118:119], v[118:119], v[88:89], v[242:243] op_sel:[0,0,1] op_sel_hi:[1,0,1] neg_lo:[1,0,0] neg_hi:[1,0,0]
ds_write_b64 v233, v[212:213] offset:22528
v_pk_fma_f32 v[120:121], v[120:121], v[88:89], v[242:243] op_sel:[0,0,1] op_sel_hi:[1,0,1] neg_lo:[1,0,0] neg_hi:[1,0,0]
v_pk_fma_f32 v[122:123], v[122:123], v[88:89], v[242:243] op_sel:[0,0,1] op_sel_hi:[1,0,1] neg_lo:[1,0,0] neg_hi:[1,0,0]
v_exp_f32 v116, v116
v_exp_f32 v117, v117
v_exp_f32 v118, v118
v_exp_f32 v119, v119
v_exp_f32 v120, v120
v_exp_f32 v121, v121
v_exp_f32 v122, v122
v_exp_f32 v123, v123
v_cvt_pk_bf16_f32 v216, v116, v117
v_cvt_pk_bf16_f32 v217, v118, v119
v_cvt_pk_bf16_f32 v218, v120, v121
v_cvt_pk_bf16_f32 v219, v122, v123
v_pk_mul_f32 v[128:129], v[128:129], v[220:221] op_sel:[0,0] op_sel_hi:[1,0]
v_pk_mul_f32 v[130:131], v[130:131], v[220:221] op_sel:[0,0] op_sel_hi:[1,0]
v_cvt_pk_bf16_f32 v214, v128, v129
v_mfma_f32_16x16x32_bf16 v[224:227], v[16:19], v[216:219], 0
v_cvt_pk_bf16_f32 v215, v130, v131
ds_write_b64 v233, v[214:215] offset:23040
buffer_store_dwordx4 a[248:251], v2, s[4:7], s72 offen offset:3072 sc1
s_nop 4
v_rcp_f32 v224, v224
s_nop 0
v_pk_mul_f32 v[116:117], v[116:117], v[224:225] op_sel:[0,0] op_sel_hi:[1,0]
v_pk_mul_f32 v[118:119], v[118:119], v[224:225] op_sel:[0,0] op_sel_hi:[1,0]
v_cvt_pk_bf16_f32 v216, v116, v117
v_cvt_pk_bf16_f32 v217, v118, v119
v_pk_mul_f32 v[120:121], v[120:121], v[224:225] op_sel:[0,0] op_sel_hi:[1,0]
ds_write_b64 v233, v[216:217] offset:23552
v_pk_mul_f32 v[122:123], v[122:123], v[224:225] op_sel:[0,0] op_sel_hi:[1,0]
v_cvt_pk_bf16_f32 v218, v120, v121
v_cvt_pk_bf16_f32 v219, v122, v123
ds_write_b64 v233, v[218:219] offset:24064
s_waitcnt vmcnt(8)
s_waitcnt lgkmcnt(0)
s_barrier
ds_read_b64_tr_b16 a[0:1], v234 offset:16384
ds_read_b64_tr_b16 a[2:3], v234 offset:18432
ds_read_b64_tr_b16 a[12:13], v234 offset:20480
ds_read_b64_tr_b16 a[14:15], v234 offset:22528
ds_read_b64_tr_b16 a[24:25], v234 offset:24576
ds_read_b64_tr_b16 a[26:27], v234 offset:26624
ds_read_b64_tr_b16 a[4:5], v8 offset:0
ds_read_b64_tr_b16 a[6:7], v8 offset:1024
ds_read_b64_tr_b16 a[8:9], v8 offset:512
ds_read_b64_tr_b16 a[10:11], v8 offset:1536
ds_read_b64_tr_b16 a[36:37], v234 offset:28672
ds_read_b64_tr_b16 a[38:39], v234 offset:30720
ds_read_b64_tr_b16 a[16:17], v8 offset:2048
ds_read_b64_tr_b16 a[18:19], v8 offset:3072
ds_read_b64_tr_b16 a[20:21], v8 offset:2560
ds_read_b64_tr_b16 a[22:23], v8 offset:3584
ds_read_b64_tr_b16 a[48:49], v234 offset:32768
ds_read_b64_tr_b16 a[50:51], v234 offset:34816
ds_read_b64_tr_b16 a[28:29], v8 offset:4096
ds_read_b64_tr_b16 a[30:31], v8 offset:5120
ds_read_b64_tr_b16 a[32:33], v8 offset:4608
ds_read_b64_tr_b16 a[34:35], v8 offset:5632
ds_read_b64_tr_b16 a[60:61], v234 offset:36864
ds_read_b64_tr_b16 a[62:63], v234 offset:38912
s_waitcnt lgkmcnt(14)
v_mfma_f32_16x16x32_bf16 v[100:103], a[0:3], v[16:19], 0
ds_read_b64_tr_b16 a[40:41], v8 offset:6144
ds_read_b64_tr_b16 a[42:43], v8 offset:7168
ds_read_b64_tr_b16 a[44:45], v8 offset:6656
ds_read_b64_tr_b16 a[46:47], v8 offset:7680
ds_read_b64_tr_b16 a[72:73], v234 offset:40960
ds_read_b64_tr_b16 a[74:75], v234 offset:43008
v_mfma_f32_16x16x32_bf16 v[100:103], a[12:15], v[16:19], v[100:103]
buffer_atomic_add v12, v235, s[4:7], s94 offen sc1
ds_read_b64_tr_b16 a[52:53], v8 offset:8192
ds_read_b64_tr_b16 a[54:55], v8 offset:9216
ds_read_b64_tr_b16 a[56:57], v8 offset:8704
ds_read_b64_tr_b16 a[58:59], v8 offset:9728
ds_read_b64_tr_b16 a[84:85], v234 offset:45056
ds_read_b64_tr_b16 a[86:87], v234 offset:47104
v_mfma_f32_16x16x32_bf16 v[100:103], a[24:27], v[16:19], v[100:103]
ds_read_b64_tr_b16 a[64:65], v8 offset:10240
ds_read_b64_tr_b16 a[66:67], v8 offset:11264
v_mfma_f32_16x16x32_bf16 v[92:95], a[0:3], a[4:7], 0
ds_read_b64_tr_b16 a[68:69], v8 offset:10752
ds_read_b64_tr_b16 a[70:71], v8 offset:11776
v_mfma_f32_16x16x32_bf16 v[96:99], a[0:3], a[8:11], 0
ds_read_b64_tr_b16 a[76:77], v8 offset:12288
s_waitcnt lgkmcnt(14)
v_mfma_f32_16x16x32_bf16 v[100:103], a[36:39], v[16:19], v[100:103]
ds_read_b64_tr_b16 a[78:79], v8 offset:13312
v_mfma_f32_16x16x32_bf16 v[92:95], a[12:15], a[16:19], v[92:95]
ds_read_b64_tr_b16 a[80:81], v8 offset:12800
ds_read_b64_tr_b16 a[82:83], v8 offset:13824
v_mfma_f32_16x16x32_bf16 v[96:99], a[12:15], a[20:23], v[96:99]
ds_read_b64_tr_b16 a[88:89], v8 offset:14336
v_mfma_f32_16x16x32_bf16 v[100:103], a[48:51], v[16:19], v[100:103]
ds_read_b64_tr_b16 a[90:91], v8 offset:15360
v_mfma_f32_16x16x32_bf16 v[92:95], a[24:27], a[28:31], v[92:95]
ds_read_b64_tr_b16 a[92:93], v8 offset:14848
ds_read_b64_tr_b16 a[94:95], v8 offset:15872
v_mfma_f32_16x16x32_bf16 v[96:99], a[24:27], a[32:35], v[96:99]
v_cvt_pk_bf16_f32 v132, v132, v133
v_cvt_pk_bf16_f32 v156, v156, v157
v_mfma_f32_16x16x32_bf16 v[100:103], a[60:63], v[16:19], v[100:103]
v_cvt_pk_bf16_f32 v180, v180, v181
v_cvt_pk_bf16_f32 v204, v204, v205
v_mfma_f32_16x16x32_bf16 v[92:95], a[36:39], a[40:43], v[92:95]
v_cvt_pk_bf16_f32 v133, v134, v135
v_cvt_pk_bf16_f32 v157, v158, v159
s_waitcnt lgkmcnt(14)
v_mfma_f32_16x16x32_bf16 v[96:99], a[36:39], a[44:47], v[96:99]
v_cvt_pk_bf16_f32 v181, v182, v183
v_cvt_pk_bf16_f32 v205, v206, v207
v_mfma_f32_16x16x32_bf16 v[100:103], a[72:75], v[16:19], v[100:103]
v_cvt_pk_bf16_f32 v134, v136, v137
v_cvt_pk_bf16_f32 v135, v138, v139
v_mfma_f32_16x16x32_bf16 v[92:95], a[48:51], a[52:55], v[92:95]
v_cvt_pk_bf16_f32 v158, v160, v161
v_cvt_pk_bf16_f32 v159, v162, v163
v_mfma_f32_16x16x32_bf16 v[96:99], a[48:51], a[56:59], v[96:99]
v_cvt_pk_bf16_f32 v182, v184, v185
v_cvt_pk_bf16_f32 v183, v186, v187
s_waitcnt lgkmcnt(12)
v_mfma_f32_16x16x32_bf16 v[100:103], a[84:87], v[16:19], v[100:103]
v_cvt_pk_bf16_f32 v206, v208, v209
v_cvt_pk_bf16_f32 v207, v210, v211
s_waitcnt lgkmcnt(10)
v_mfma_f32_16x16x32_bf16 v[92:95], a[60:63], a[64:67], v[92:95]
s_waitcnt lgkmcnt(8)
v_mfma_f32_16x16x32_bf16 v[96:99], a[60:63], a[68:71], v[96:99]
s_nop 1
v_min_u32 v100, -2, v100
v_min_u32 v101, -2, v101
s_waitcnt lgkmcnt(6)
v_mfma_f32_16x16x32_bf16 v[92:95], a[72:75], a[76:79], v[92:95]
v_min_u32 v102, -2, v102
v_min_u32 v103, -2, v103
s_waitcnt lgkmcnt(4)
v_mfma_f32_16x16x32_bf16 v[96:99], a[72:75], a[80:83], v[96:99]
buffer_store_dwordx4 v[100:103], v254, s[4:7], s97 offen sc1
s_waitcnt lgkmcnt(2)
v_mfma_f32_16x16x32_bf16 v[92:95], a[84:87], a[88:91], v[92:95]
s_waitcnt lgkmcnt(0)
v_mfma_f32_16x16x32_bf16 v[96:99], a[84:87], a[92:95], v[96:99]
s_nop 5
v_cvt_pk_bf16_f32 v92, v92, v93
v_cvt_pk_bf16_f32 v93, v94, v95
v_min_u32 v92, -2, v92
v_min_u32 v93, -2, v93
v_cvt_pk_bf16_f32 v94, v96, v97
v_cvt_pk_bf16_f32 v95, v98, v99
v_min_u32 v94, -2, v94
v_min_u32 v95, -2, v95
buffer_store_dwordx4 v[92:95], v1, s[4:7], s96 offen sc1
s_barrier
s_add_u32 m0, s19, 32768
s_xor_b32 s44, s85, 0
buffer_load_dwordx4 v1, s[4:7], s44 offen offset:0 sc1 lds
v_mfma_f32_16x16x32_bf16 v[108:111], a[240:243], v[132:135], 0
v_mfma_f32_16x16x32_bf16 v[172:175], a[240:243], v[156:159], 0
v_mfma_f32_16x16x32_bf16 v[112:115], a[244:247], v[132:135], 0
s_nop 5
v_max3_f32 v236, v108, v109, v110
v_max3_f32 v237, -v108, -v109, -v110
v_mfma_f32_16x16x32_bf16 v[176:179], a[244:247], v[156:159], 0
v_max3_f32 v238, v172, v173, v174
v_max3_f32 v239, -v172, -v173, -v174
v_max3_f32 v236, v236, v111, v112
v_max3_f32 v237, v237, -v111, -v112
v_max3_f32 v236, v236, v113, v114
v_max3_f32 v237, v237, -v113, -v114
s_nop 1
v_max3_f32 v238, v238, v175, v176
v_max3_f32 v239, v239, -v175, -v176
v_max3_f32 v238, v238, v177, v178
v_max3_f32 v239, v239, -v177, -v178
v_max_f32 v236, v236, v115
buffer_load_dwordx4 v1, s[4:7], s44 offen offset:1024 sc1 lds
v_max_f32_e64 v237, v237, -v115
v_max_f32 v238, v238, v179
v_max_f32_e64 v239, v239, -v179
v_permlane32_swap_b32 v236, v237
s_nop 0
v_permlane32_swap_b32 v238, v239
v_mov_b32 v11, 0
buffer_atomic_add v11, v251, s[4:7], s89 offen sc0 sc1
v_max_f32 v236, v236, v237
v_max_f32 v238, v238, v239
v_mov_b32 v244, v236
v_mov_b32 v245, v238
s_nop 0
v_permlane16_swap_b32 v236, v244
v_permlane16_swap_b32 v238, v245
v_max_f32 v236, v236, v244
v_max_f32 v238, v238, v245
v_mov_b32 v244, v236
v_mov_b32 v245, v238
s_nop 0
v_permlane32_swap_b32 v236, v244
v_permlane32_swap_b32 v238, v245
v_mul_f32_e64 v236, -v236, v82
v_mul_f32_e64 v237, -v244, v82
buffer_load_dwordx4 v1, s[4:7], s44 offen offset:2048 sc1 lds
v_mul_f32_e64 v238, -v238, v84
v_mul_f32_e64 v239, -v245, v84
v_pk_fma_f32 v[116:117], v[108:109], v[82:83], v[236:237] op_sel:[0,0,0] op_sel_hi:[1,0,0]
v_pk_fma_f32 v[118:119], v[110:111], v[82:83], v[236:237] op_sel:[0,0,0] op_sel_hi:[1,0,0]
v_pk_fma_f32 v[120:121], v[112:113], v[82:83], v[236:237] op_sel:[0,0,0] op_sel_hi:[1,0,0]
v_pk_fma_f32 v[122:123], v[114:115], v[82:83], v[236:237] op_sel:[0,0,0] op_sel_hi:[1,0,0]
v_pk_fma_f32 v[148:149], v[172:173], v[84:85], v[238:239] op_sel:[0,0,0] op_sel_hi:[1,0,0]
v_pk_fma_f32 v[150:151], v[174:175], v[84:85], v[238:239] op_sel:[0,0,0] op_sel_hi:[1,0,0]
v_pk_fma_f32 v[152:153], v[176:177], v[84:85], v[238:239] op_sel:[0,0,0] op_sel_hi:[1,0,0]
v_pk_fma_f32 v[154:155], v[178:179], v[84:85], v[238:239] op_sel:[0,0,0] op_sel_hi:[1,0,0]
v_pk_fma_f32 v[108:109], v[108:109], v[82:83], v[236:237] op_sel:[0,0,1] op_sel_hi:[1,0,1] neg_lo:[1,0,0] neg_hi:[1,0,0]
v_pk_fma_f32 v[110:111], v[110:111], v[82:83], v[236:237] op_sel:[0,0,1] op_sel_hi:[1,0,1] neg_lo:[1,0,0] neg_hi:[1,0,0]
v_pk_fma_f32 v[112:113], v[112:113], v[82:83], v[236:237] op_sel:[0,0,1] op_sel_hi:[1,0,1] neg_lo:[1,0,0] neg_hi:[1,0,0]
v_pk_fma_f32 v[114:115], v[114:115], v[82:83], v[236:237] op_sel:[0,0,1] op_sel_hi:[1,0,1] neg_lo:[1,0,0] neg_hi:[1,0,0]
v_pk_fma_f32 v[172:173], v[172:173], v[84:85], v[238:239] op_sel:[0,0,1] op_sel_hi:[1,0,1] neg_lo:[1,0,0] neg_hi:[1,0,0]
v_pk_fma_f32 v[174:175], v[174:175], v[84:85], v[238:239] op_sel:[0,0,1] op_sel_hi:[1,0,1] neg_lo:[1,0,0] neg_hi:[1,0,0]
v_pk_fma_f32 v[176:177], v[176:177], v[84:85], v[238:239] op_sel:[0,0,1] op_sel_hi:[1,0,1] neg_lo:[1,0,0] neg_hi:[1,0,0]
v_pk_fma_f32 v[178:179], v[178:179], v[84:85], v[238:239] op_sel:[0,0,1] op_sel_hi:[1,0,1] neg_lo:[1,0,0] neg_hi:[1,0,0]
v_exp_f32 v116, v116
v_exp_f32 v108, v108
v_exp_f32 v117, v117
v_exp_f32 v109, v109
v_exp_f32 v118, v118
v_exp_f32 v110, v110
v_exp_f32 v119, v119
v_exp_f32 v111, v111
L_stub8:
s_cbranch_execz L_wret1
v_exp_f32 v120, v120
v_exp_f32 v112, v112
v_exp_f32 v121, v121
v_exp_f32 v113, v113
v_exp_f32 v122, v122
v_exp_f32 v114, v114
v_exp_f32 v123, v123
v_exp_f32 v115, v115
v_exp_f32 v148, v148
v_exp_f32 v172, v172
v_exp_f32 v149, v149
v_exp_f32 v173, v173
v_exp_f32 v150, v150
v_exp_f32 v174, v174
v_exp_f32 v151, v151
v_exp_f32 v175, v175
v_exp_f32 v152, v152
v_exp_f32 v176, v176
v_exp_f32 v153, v153
v_exp_f32 v177, v177
v_exp_f32 v154, v154
v_exp_f32 v178, v178
v_exp_f32 v155, v155
v_exp_f32 v179, v179
buffer_load_dwordx4 v1, s[4:7], s44 offen offset:3072 sc1 lds
v_cvt_pk_bf16_f32 v140, v116, v117
v_cvt_pk_bf16_f32 v141, v118, v119
v_cvt_pk_bf16_f32 v142, v120, v121
v_cvt_pk_bf16_f32 v143, v122, v123
v_cvt_pk_bf16_f32 v144, v108, v109
v_cvt_pk_bf16_f32 v145, v110, v111
v_cvt_pk_bf16_f32 v146, v112, v113
v_cvt_pk_bf16_f32 v147, v114, v115
v_cvt_pk_bf16_f32 v164, v148, v149
v_cvt_pk_bf16_f32 v165, v150, v151
v_cvt_pk_bf16_f32 v166, v152, v153
v_cvt_pk_bf16_f32 v167, v154, v155
v_cvt_pk_bf16_f32 v168, v172, v173
v_cvt_pk_bf16_f32 v169, v174, v175
v_cvt_pk_bf16_f32 v170, v176, v177
v_cvt_pk_bf16_f32 v171, v178, v179
s_waitcnt vmcnt(2)
v_readfirstlane_b32 s38, v11
s_nop 0
s_cmp_ge_u32 s38, 8
s_cbranch_scc1 Lpe_25
s_add_u32 s36, s88, 0x80000
s_mov_b32 s37, 0
Lpoll_24:
v_mov_b32 v11, 0
buffer_atomic_add v11, v251, s[4:7], s36 offen sc0 sc1
s_add_u32 s37, s37, 1
s_waitcnt vmcnt(0)
v_readfirstlane_b32 s38, v11
s_nop 0
s_cmp_ge_u32 s38, 8
s_cbranch_scc1 Lpe_25
s_cmp_lt_u32 s37, 0x100000
s_cbranch_scc1 Lpoll_24
Lpe_25:
buffer_load_dwordx4 v[48:51], v1, s[4:7], s98 offen offset:0 sc1
v_mfma_f32_16x16x32_bf16 v[108:111], a[240:243], v[180:183], 0
v_mfma_f32_16x16x32_bf16 v[220:223], a[240:243], v[204:207], 0
v_mfma_f32_16x16x32_bf16 v[112:115], a[244:247], v[180:183], 0
s_nop 5
v_max3_f32 v240, v108, v109, v110
v_max3_f32 v241, -v108, -v109, -v110
v_mfma_f32_16x16x32_bf16 v[224:227], a[244:247], v[204:207], 0
buffer_load_dwordx4 v[124:127], v248, s[4:7], s100 offen sc1
v_max3_f32 v242, v220, v221, v222
v_max3_f32 v243, -v220, -v221, -v222
v_max3_f32 v240, v240, v111, v112
v_max3_f32 v241, v241, -v111, -v112
v_max3_f32 v240, v240, v113, v114
s_nop 1
v_max3_f32 v242, v242, v223, v224
v_max3_f32 v243, v243, -v223, -v224
v_max3_f32 v241, v241, -v113, -v114
v_max3_f32 v242, v242, v225, v226
v_max3_f32 v243, v243, -v225, -v226
v_max_f32 v240, v240, v115
v_max_f32_e64 v241, v241, -v115
v_max_f32 v242, v242, v227
buffer_load_dwordx4 v[52:55], v1, s[4:7], s98 offen offset:1024 sc1
v_max_f32_e64 v243, v243, -v227
v_permlane32_swap_b32 v240, v241
s_nop 0
v_permlane32_swap_b32 v242, v243
v_max_f32 v240, v240, v241
v_max_f32 v242, v242, v243
v_mov_b32 v246, v240
v_mov_b32 v247, v242
s_nop 0
v_permlane16_swap_b32 v240, v246
v_permlane16_swap_b32 v242, v247
buffer_load_dwordx4 v[56:59], v1, s[4:7], s98 offen offset:2048 sc1
v_max_f32 v240, v240, v246
v_max_f32 v242, v242, v247
v_mov_b32 v246, v240
v_mov_b32 v247, v242
s_nop 0
v_permlane32_swap_b32 v240, v246
v_permlane32_swap_b32 v242, v247
v_mul_f32_e64 v240, -v240, v86
v_mul_f32_e64 v241, -v246, v86
v_mul_f32_e64 v242, -v242, v88
v_mul_f32_e64 v243, -v247, v88
buffer_load_dwordx4 v[60:63], v1, s[4:7], s98 offen offset:3072 sc1
v_pk_fma_f32 v[116:117], v[108:109], v[86:87], v[240:241] op_sel:[0,0,0] op_sel_hi:[1,0,0]
v_pk_fma_f32 v[118:119], v[110:111], v[86:87], v[240:241] op_sel:[0,0,0] op_sel_hi:[1,0,0]
v_pk_fma_f32 v[120:121], v[112:113], v[86:87], v[240:241] op_sel:[0,0,0] op_sel_hi:[1,0,0]
v_pk_fma_f32 v[122:123], v[114:115], v[86:87], v[240:241] op_sel:[0,0,0] op_sel_hi:[1,0,0]
v_pk_fma_f32 v[196:197], v[220:221], v[88:89], v[242:243] op_sel:[0,0,0] op_sel_hi:[1,0,0]
v_pk_fma_f32 v[198:199], v[222:223], v[88:89], v[242:243] op_sel:[0,0,0] op_sel_hi:[1,0,0]
v_pk_fma_f32 v[200:201], v[224:225], v[88:89], v[242:243] op_sel:[0,0,0] op_sel_hi:[1,0,0]
v_pk_fma_f32 v[202:203], v[226:227], v[88:89], v[242:243] op_sel:[0,0,0] op_sel_hi:[1,0,0]
v_pk_fma_f32 v[108:109], v[108:109], v[86:87], v[240:241] op_sel:[0,0,1] op_sel_hi:[1,0,1] neg_lo:[1,0,0] neg_hi:[1,0,0]
v_pk_fma_f32 v[110:111], v[110:111], v[86:87], v[240:241] op_sel:[0,0,1] op_sel_hi:[1,0,1] neg_lo:[1,0,0] neg_hi:[1,0,0]
v_pk_fma_f32 v[112:113], v[112:113], v[86:87], v[240:241] op_sel:[0,0,1] op_sel_hi:[1,0,1] neg_lo:[1,0,0] neg_hi:[1,0,0]
v_pk_fma_f32 v[114:115], v[114:115], v[86:87], v[240:241] op_sel:[0,0,1] op_sel_hi:[1,0,1] neg_lo:[1,0,0] neg_hi:[1,0,0]
v_pk_fma_f32 v[220:221], v[220:221], v[88:89], v[242:243] op_sel:[0,0,1] op_sel_hi:[1,0,1] neg_lo:[1,0,0] neg_hi:[1,0,0]
buffer_load_dwordx4 v[64:67], v1, s[4:7], s99 offen offset:0 sc1
v_pk_fma_f32 v[222:223], v[222:223], v[88:89], v[242:243] op_sel:[0,0,1] op_sel_hi:[1,0,1] neg_lo:[1,0,0] neg_hi:[1,0,0]
v_pk_fma_f32 v[224:225], v[224:225], v[88:89], v[242:243] op_sel:[0,0,1] op_sel_hi:[1,0,1] neg_lo:[1,0,0] neg_hi:[1,0,0]
v_pk_fma_f32 v[226:227], v[226:227], v[88:89], v[242:243] op_sel:[0,0,1] op_sel_hi:[1,0,1] neg_lo:[1,0,0] neg_hi:[1,0,0]
v_exp_f32 v116, v116
v_exp_f32 v108, v108
v_exp_f32 v117, v117
v_exp_f32 v109, v109
v_exp_f32 v118, v118
buffer_load_dwordx4 v[68:71], v1, s[4:7], s99 offen offset:1024 sc1
v_exp_f32 v110, v110
v_exp_f32 v119, v119
v_exp_f32 v111, v111
v_exp_f32 v120, v120
v_exp_f32 v112, v112
v_exp_f32 v121, v121
v_exp_f32 v113, v113
buffer_load_dwordx4 v[100:103], v1, s[4:7], s99 offen offset:2048 sc1
v_exp_f32 v122, v122
v_exp_f32 v114, v114
v_exp_f32 v123, v123
v_exp_f32 v115, v115
v_exp_f32 v196, v196
v_exp_f32 v220, v220
v_exp_f32 v197, v197
buffer_load_dwordx4 v[104:107], v1, s[4:7], s99 offen offset:3072 sc1
v_exp_f32 v221, v221
v_exp_f32 v198, v198
v_exp_f32 v222, v222
v_exp_f32 v199, v199
v_exp_f32 v223, v223
v_exp_f32 v200, v200
v_exp_f32 v224, v224
buffer_store_dwordx4 a[248:251], v2, s[4:7], s73 offen offset:0 sc1
v_exp_f32 v201, v201
v_exp_f32 v225, v225
v_exp_f32 v202, v202
v_exp_f32 v226, v226
v_exp_f32 v203, v203
v_exp_f32 v227, v227
v_cvt_pk_bf16_f32 v188, v116, v117
v_cvt_pk_bf16_f32 v189, v118, v119
v_cvt_pk_bf16_f32 v190, v120, v121
v_cvt_pk_bf16_f32 v191, v122, v123
v_cvt_pk_bf16_f32 v192, v108, v109
v_cvt_pk_bf16_f32 v193, v110, v111
v_cvt_pk_bf16_f32 v194, v112, v113
v_cvt_pk_bf16_f32 v195, v114, v115
v_cvt_pk_bf16_f32 v212, v196, v197
v_cvt_pk_bf16_f32 v213, v198, v199
v_cvt_pk_bf16_f32 v214, v200, v201
v_cvt_pk_bf16_f32 v215, v202, v203
v_cvt_pk_bf16_f32 v216, v220, v221
v_cvt_pk_bf16_f32 v217, v222, v223
v_cvt_pk_bf16_f32 v218, v224, v225
v_cvt_pk_bf16_f32 v219, v226, v227
buffer_store_dwordx4 a[248:251], v2, s[4:7], s73 offen offset:1024 sc1
s_waitcnt vmcnt(10)
v_lshlrev_b32 v92, 16, v48
v_and_b32 v93, 0xffff0000, v48
v_lshlrev_b32 v94, 16, v49
v_and_b32 v95, 0xffff0000, v49
v_lshlrev_b32 v96, 16, v50
v_and_b32 v97, 0xffff0000, v50
v_lshlrev_b32 v98, 16, v51
v_and_b32 v99, 0xffff0000, v51
s_waitcnt vmcnt(9)
v_add_f32_dpp v128, v124, v124 row_ror:4 row_mask:0xf bank_mask:0xf
v_add_f32_dpp v129, v125, v125 row_ror:4 row_mask:0xf bank_mask:0xf
v_add_f32_dpp v130, v126, v126 row_ror:4 row_mask:0xf bank_mask:0xf
v_add_f32_dpp v131, v127, v127 row_ror:4 row_mask:0xf bank_mask:0xf
v_add_f32_dpp v128, v128, v128 row_ror:2 row_mask:0xf bank_mask:0xf
v_add_f32_dpp v129, v129, v129 row_ror:2 row_mask:0xf bank_mask:0xf
v_add_f32_dpp v130, v130, v130 row_ror:2 row_mask:0xf bank_mask:0xf
buffer_store_dwordx4 a[248:251], v2, s[4:7], s73 offen offset:2048 sc1
v_add_f32_dpp v131, v131, v131 row_ror:2 row_mask:0xf bank_mask:0xf
v_add_f32_dpp v128, v128, v128 row_ror:1 row_mask:0xf bank_mask:0xf
v_add_f32_dpp v129, v129, v129 row_ror:1 row_mask:0xf bank_mask:0xf
v_add_f32_dpp v130, v130, v130 row_ror:1 row_mask:0xf bank_mask:0xf
v_add_f32_dpp v131, v131, v131 row_ror:1 row_mask:0xf bank_mask:0xf
s_waitcnt vmcnt(9)
v_dot2c_f32_bf16 v92, v52, v249
v_dot2c_f32_bf16 v93, v52, v250
v_dot2c_f32_bf16 v94, v53, v249
v_dot2c_f32_bf16 v95, v53, v250
v_dot2c_f32_bf16 v96, v54, v249
v_dot2c_f32_bf16 v97, v54, v250
v_dot2c_f32_bf16 v98, v55, v249
v_dot2c_f32_bf16 v99, v55, v250
v_fma_f32 v135, v129, v130, v131
s_waitcnt vmcnt(8)
v_dot2c_f32_bf16 v92, v56, v249
v_dot2c_f32_bf16 v93, v56, v250
v_dot2c_f32_bf16 v94, v57, v249
v_dot2c_f32_bf16 v95, v57, v250
v_dot2c_f32_bf16 v96, v58, v249
v_dot2c_f32_bf16 v97, v58, v250
v_dot2c_f32_bf16 v98, v59, v249
v_dot2c_f32_bf16 v99, v59, v250
buffer_store_dwordx4 a[248:251], v2, s[4:7], s73 offen offset:3072 sc1
s_waitcnt vmcnt(8)
v_dot2c_f32_bf16 v92, v60, v249
v_dot2c_f32_bf16 v93, v60, v250
v_dot2c_f32_bf16 v94, v61, v249
v_dot2c_f32_bf16 v95, v61, v250
v_dot2c_f32_bf16 v96, v62, v249
v_dot2c_f32_bf16 v97, v62, v250
v_dot2c_f32_bf16 v98, v63, v249
v_dot2c_f32_bf16 v99, v63, v250
s_waitcnt vmcnt(7)
v_dot2c_f32_bf16 v92, v64, v249
v_dot2c_f32_bf16 v93, v64, v250
v_dot2c_f32_bf16 v94, v65, v249
v_dot2c_f32_bf16 v95, v65, v250
v_dot2c_f32_bf16 v96, v66, v249
v_dot2c_f32_bf16 v97, v66, v250
v_dot2c_f32_bf16 v98, v67, v249
v_dot2c_f32_bf16 v99, v67, v250
s_waitcnt vmcnt(6)
v_dot2c_f32_bf16 v92, v68, v249
v_dot2c_f32_bf16 v93, v68, v250
v_dot2c_f32_bf16 v94, v69, v249
v_dot2c_f32_bf16 v95, v69, v250
v_dot2c_f32_bf16 v96, v70, v249
v_dot2c_f32_bf16 v97, v70, v250
v_dot2c_f32_bf16 v98, v71, v249
v_dot2c_f32_bf16 v99, v71, v250
s_waitcnt vmcnt(5)
v_dot2c_f32_bf16 v92, v100, v249
v_dot2c_f32_bf16 v93, v100, v250
v_dot2c_f32_bf16 v94, v101, v249
v_dot2c_f32_bf16 v95, v101, v250
v_dot2c_f32_bf16 v96, v102, v249
v_dot2c_f32_bf16 v97, v102, v250
v_dot2c_f32_bf16 v98, v103, v249
v_dot2c_f32_bf16 v99, v103, v250
s_waitcnt vmcnt(4)
v_dot2c_f32_bf16 v92, v104, v249
v_dot2c_f32_bf16 v93, v104, v250
v_dot2c_f32_bf16 v94, v105, v249
v_dot2c_f32_bf16 v95, v105, v250
v_dot2c_f32_bf16 v96, v106, v249
v_dot2c_f32_bf16 v97, v106, v250
v_dot2c_f32_bf16 v98, v107, v249
v_dot2c_f32_bf16 v99, v107, v250
v_fma_f32 v132, v92, v93, v94
v_fma_f32 v133, v95, v96, v97
s_nop 0
v_fma_f32 v134, v98, v99, v128
v_fma_f32 v132, v132, v133, v134
v_cmp_u_f32 vcc, v132, v135
s_cbranch_vccnz L_kvredo1
L_kvback1:
v_cvt_pk_bf16_f32 v128, v128, v129
v_cvt_pk_bf16_f32 v129, v130, v131
v_cvt_pk_bf16_f32 v92, v92, v93
v_cndmask_b32 v128, 0, v128, s[56:57]
v_cndmask_b32 v129, 0, v129, s[56:57]
v_cvt_pk_bf16_f32 v93, v94, v95
v_cvt_pk_bf16_f32 v94, v96, v97
v_cvt_pk_bf16_f32 v95, v98, v99
v_cndmask_b32 v128, v128, v16, s[58:59]
v_cndmask_b32 v129, v129, v16, s[58:59]
ds_write_b64 v252, v[92:93] offset:0
ds_write_b64 v252, v[94:95] offset:1024
ds_write_b64 v252, v[128:129] offset:2048
s_waitcnt lgkmcnt(0)
s_barrier
ds_read_b128 a[8:11], v1 offset:2048
ds_read_b128 a[20:23], v1 offset:5120
ds_read_b128 a[0:3], v1 offset:0
ds_read_b128 a[12:15], v1 offset:3072
ds_read_b128 a[4:7], v1 offset:1024
ds_read_b128 a[16:19], v1 offset:4096
s_waitcnt lgkmcnt(5)
v_mfma_f32_16x16x32_bf16 v[116:119], a[8:11], v[212:215], 0
s_waitcnt lgkmcnt(4)
v_mfma_f32_16x16x32_bf16 v[120:123], a[20:23], v[216:219], 0
s_waitcnt lgkmcnt(3)
v_mfma_f32_16x16x32_bf16 v[204:207], a[0:3], v[212:215], 0
s_nop 3
v_rcp_f32 v118, v117
s_waitcnt lgkmcnt(2)
v_mfma_f32_16x16x32_bf16 v[220:223], a[12:15], v[216:219], 0
v_rcp_f32 v119, v121
v_mul_f32 v116, v116, v118
v_fmac_f32 v116, v120, v119
v_mfma_f32_16x16x32_bf16 v[100:103], a[8:11], v[164:167], 0
v_add_f32 v116, 0x358637bd, v116
v_rcp_f32 v116, v116
s_waitcnt lgkmcnt(1)
v_mfma_f32_16x16x32_bf16 v[208:211], a[4:7], v[212:215], 0
v_mul_f32 v118, v118, v116
v_mul_f32 v119, v119, v116
v_mfma_f32_16x16x32_bf16 v[104:107], a[20:23], v[168:171], 0
v_mul_f32 v204, v204, v118
v_mul_f32 v205, v205, v118
s_waitcnt lgkmcnt(0)
v_mfma_f32_16x16x32_bf16 v[224:227], a[16:19], v[216:219], 0
v_mul_f32 v206, v206, v118
v_mul_f32 v207, v207, v118
v_fmac_f32 v204, v220, v119
v_fmac_f32 v205, v221, v119
v_rcp_f32 v102, v101
v_mul_f32 v208, v208, v118
v_mul_f32 v209, v209, v118
v_mul_f32 v210, v210, v118
buffer_atomic_add v12, v10, s[4:7], s74 offen sc1
v_mul_f32 v211, v211, v118
v_fmac_f32 v206, v222, v119
v_fmac_f32 v207, v223, v119
v_cvt_pk_bf16_f32 v204, v204, v205
v_rcp_f32 v103, v105
v_fmac_f32 v208, v224, v119
v_fmac_f32 v209, v225, v119
v_fmac_f32 v210, v226, v119
v_fmac_f32 v211, v227, v119
v_cvt_pk_bf16_f32 v205, v206, v207
v_cvt_pk_bf16_f32 v206, v208, v209
v_cvt_pk_bf16_f32 v207, v210, v211
v_mul_f32 v100, v100, v102
v_mfma_f32_16x16x32_bf16 v[156:159], a[0:3], v[164:167], 0
buffer_store_dwordx4 v[204:207], v2, s[4:7], s72 offen offset:3072 sc1
v_fmac_f32 v100, v104, v103
v_mfma_f32_16x16x32_bf16 v[172:175], a[12:15], v[168:171], 0
v_add_f32 v100, 0x358637bd, v100
v_rcp_f32 v100, v100
v_mfma_f32_16x16x32_bf16 v[108:111], a[8:11], v[188:191], 0
v_mul_f32 v102, v102, v100
v_mul_f32 v103, v103, v100
v_mfma_f32_16x16x32_bf16 v[160:163], a[4:7], v[164:167], 0
v_mul_f32 v156, v156, v102
v_mul_f32 v157, v157, v102
v_mfma_f32_16x16x32_bf16 v[112:115], a[20:23], v[192:195], 0
v_mul_f32 v158, v158, v102
v_mul_f32 v159, v159, v102
v_mfma_f32_16x16x32_bf16 v[176:179], a[16:19], v[168:171], 0
v_fmac_f32 v156, v172, v103
v_fmac_f32 v157, v173, v103
v_rcp_f32 v110, v109
v_mul_f32 v160, v160, v102
v_mul_f32 v161, v161, v102
v_mul_f32 v162, v162, v102
v_mul_f32 v163, v163, v102
v_fmac_f32 v158, v174, v103
v_fmac_f32 v159, v175, v103
v_cvt_pk_bf16_f32 v156, v156, v157
v_rcp_f32 v111, v113
v_fmac_f32 v160, v176, v103
v_fmac_f32 v161, v177, v103
v_fmac_f32 v162, v178, v103
v_fmac_f32 v163, v179, v103
v_cvt_pk_bf16_f32 v157, v158, v159
v_cvt_pk_bf16_f32 v158, v160, v161
v_cvt_pk_bf16_f32 v159, v162, v163
v_mul_f32 v108, v108, v110
v_mfma_f32_16x16x32_bf16 v[180:183], a[0:3], v[188:191], 0
buffer_store_dwordx4 v[156:159], v2, s[4:7], s72 offen offset:1024 sc1
v_fmac_f32 v108, v112, v111
v_mfma_f32_16x16x32_bf16 v[196:199], a[12:15], v[192:195], 0
v_add_f32 v108, 0x358637bd, v108
v_rcp_f32 v108, v108
v_mfma_f32_16x16x32_bf16 v[92:95], a[8:11], v[140:143], 0
v_mul_f32 v110, v110, v108
v_mul_f32 v111, v111, v108
v_mfma_f32_16x16x32_bf16 v[184:187], a[4:7], v[188:191], 0
v_mul_f32 v180, v180, v110
v_mul_f32 v181, v181, v110
v_mfma_f32_16x16x32_bf16 v[96:99], a[20:23], v[144:147], 0
v_mul_f32 v182, v182, v110
v_mul_f32 v183, v183, v110
v_mfma_f32_16x16x32_bf16 v[200:203], a[16:19], v[192:195], 0
v_fmac_f32 v180, v196, v111
v_fmac_f32 v181, v197, v111
v_rcp_f32 v94, v93
v_mul_f32 v184, v184, v110
v_mul_f32 v185, v185, v110
v_mul_f32 v186, v186, v110
v_mul_f32 v187, v187, v110
v_fmac_f32 v182, v198, v111
v_fmac_f32 v183, v199, v111
v_cvt_pk_bf16_f32 v180, v180, v181
v_rcp_f32 v95, v97
v_fmac_f32 v184, v200, v111
v_fmac_f32 v185, v201, v111
v_fmac_f32 v186, v202, v111
v_fmac_f32 v187, v203, v111
v_cvt_pk_bf16_f32 v181, v182, v183
v_cvt_pk_bf16_f32 v182, v184, v185
v_cvt_pk_bf16_f32 v183, v186, v187
v_mul_f32 v92, v92, v94
v_mfma_f32_16x16x32_bf16 v[132:135], a[0:3], v[140:143], 0
buffer_store_dwordx4 v[180:183], v2, s[4:7], s72 offen offset:2048 sc1
v_fmac_f32 v92, v96, v95
v_mfma_f32_16x16x32_bf16 v[148:151], a[12:15], v[144:147], 0
v_add_f32 v92, 0x358637bd, v92
v_rcp_f32 v92, v92
v_mfma_f32_16x16x32_bf16 v[136:139], a[4:7], v[140:143], 0
v_mul_f32 v94, v94, v92
v_mul_f32 v95, v95, v92
v_mfma_f32_16x16x32_bf16 v[152:155], a[16:19], v[144:147], 0
v_mul_f32 v132, v132, v94
v_mul_f32 v133, v133, v94
v_mul_f32 v134, v134, v94
v_mul_f32 v135, v135, v94
v_fmac_f32 v132, v148, v95
v_fmac_f32 v133, v149, v95
v_mul_f32 v136, v136, v94
v_mul_f32 v137, v137, v94
v_mul_f32 v138, v138, v94
v_mul_f32 v139, v139, v94
v_fmac_f32 v134, v150, v95
v_fmac_f32 v135, v151, v95
v_cvt_pk_bf16_f32 v132, v132, v133
v_fmac_f32 v136, v152, v95
v_fmac_f32 v137, v153, v95
v_fmac_f32 v138, v154, v95
v_fmac_f32 v139, v155, v95
v_cvt_pk_bf16_f32 v133, v134, v135
v_cvt_pk_bf16_f32 v134, v136, v137
v_cvt_pk_bf16_f32 v135, v138, v139
buffer_store_dwordx4 v[132:135], v2, s[4:7], s72 offen offset:0 sc1
s_add_u32 s92, s71, 0x10000
s_add_u32 s40, s4, 0xc00000
s_addc_u32 s41, s5, 0
v_add_u32 v5, 32768, v1
v_add_u32 v6, 98304, v1
s_mov_b32 s35, s9
v_lshlrev_b32 v132, 16, v32
v_and_b32 v133, 0xffff0000, v32
v_lshlrev_b32 v134, 16, v33
v_and_b32 v135, 0xffff0000, v33
v_lshlrev_b32 v136, 16, v34
v_and_b32 v137, 0xffff0000, v34
v_lshlrev_b32 v138, 16, v35
v_and_b32 v139, 0xffff0000, v35
v_lshlrev_b32 v140, 16, v36
v_and_b32 v141, 0xffff0000, v36
v_lshlrev_b32 v142, 16, v37
v_and_b32 v143, 0xffff0000, v37
v_lshlrev_b32 v144, 16, v38
v_and_b32 v145, 0xffff0000, v38
v_lshlrev_b32 v146, 16, v39
v_and_b32 v147, 0xffff0000, v39
v_lshlrev_b32 v148, 16, v40
v_and_b32 v149, 0xffff0000, v40
v_lshlrev_b32 v150, 16, v41
v_and_b32 v151, 0xffff0000, v41
v_lshlrev_b32 v152, 16, v42
v_and_b32 v153, 0xffff0000, v42
v_lshlrev_b32 v154, 16, v43
v_and_b32 v155, 0xffff0000, v43
v_lshlrev_b32 v156, 16, v44
v_and_b32 v157, 0xffff0000, v44
v_lshlrev_b32 v158, 16, v45
v_and_b32 v159, 0xffff0000, v45
v_lshlrev_b32 v160, 16, v46
v_and_b32 v161, 0xffff0000, v46
v_lshlrev_b32 v162, 16, v47
v_and_b32 v163, 0xffff0000, v47
s_mov_b32 s95, -1
s_mov_b64 exec, 0
s_cmp_eq_u32 s28, 3
s_cbranch_scc1 L_stub9
s_cmp_eq_u32 s28, 2
s_cbranch_scc1 L_stub12
s_cmp_eq_u32 s28, 0
s_cbranch_scc1 L_stub13
L_wret3:
s_mov_b64 exec, -1
s_cmp_lg_u32 s28, 1
s_cbranch_scc1 Lpo_28
s_add_u32 s36, s11, 0x10080
s_mov_b32 s37, 0
v_mov_b32 v11, 0
buffer_atomic_add v11, v251, s[4:7], s36 offen sc0 sc1
s_sleep 4
Lpoll_26:
v_mov_b32 v234, 0
buffer_atomic_add v234, v251, s[4:7], s36 offen sc0 sc1
s_waitcnt vmcnt(1)
v_readfirstlane_b32 s38, v11
s_nop 0
s_cmp_ge_u32 s38, 32
s_cbranch_scc1 Lpe_27
v_mov_b32 v11, 0
buffer_atomic_add v11, v251, s[4:7], s36 offen sc0 sc1
s_waitcnt vmcnt(1)
v_readfirstlane_b32 s38, v234
s_nop 0
s_cmp_ge_u32 s38, 32
s_cbranch_scc1 Lpe_27
s_add_u32 s37, s37, 1
s_cmp_lt_u32 s37, 0x80000
s_cbranch_scc1 Lpoll_26
s_waitcnt vmcnt(0)
Lpo_28:
s_waitcnt vmcnt(0)
Lpe_27:
s_barrier
L_k2go1:
buffer_load_dwordx4 a[0:3], v4, s[40:43], s35 offen offset:0 sc1
buffer_load_dwordx4 a[4:7], v4, s[40:43], s35 offen offset:1024 sc1
s_xor_b32 s35, s9, 4096
buffer_load_dwordx4 a[8:11], v4, s[40:43], s35 offen offset:0 sc1
buffer_load_dwordx4 a[12:15], v4, s[40:43], s35 offen offset:1024 sc1
s_xor_b32 s35, s9, 16384
buffer_load_dwordx4 a[16:19], v4, s[40:43], s35 offen offset:0 sc1
buffer_load_dwordx4 a[20:23], v4, s[40:43], s35 offen offset:1024 sc1
s_xor_b32 s35, s9, 20480
buffer_load_dwordx4 a[24:27], v4, s[40:43], s35 offen offset:0 sc1
buffer_load_dwordx4 a[28:31], v4, s[40:43], s35 offen offset:1024 sc1
s_xor_b32 s35, s9, 32768
buffer_load_dwordx4 a[32:35], v4, s[40:43], s35 offen offset:0 sc1
buffer_load_dwordx4 a[36:39], v4, s[40:43], s35 offen offset:1024 sc1
s_xor_b32 s35, s9, 36864
buffer_load_dwordx4 a[40:43], v4, s[40:43], s35 offen offset:0 sc1
buffer_load_dwordx4 a[44:47], v4, s[40:43], s35 offen offset:1024 sc1
s_xor_b32 s35, s9, 49152
ds_read_b128 a[96:99], v5 offset:0
ds_read_b128 a[100:103], v5 offset:1024
ds_read_b128 a[104:107], v5 offset:2048
ds_read_b128 a[108:111], v5 offset:3072
ds_read_b128 a[112:115], v5 offset:4096
ds_read_b128 a[116:119], v5 offset:5120
ds_read_b128 a[120:123], v5 offset:6144
ds_read_b128 a[124:127], v5 offset:7168
s_waitcnt vmcnt(10) lgkmcnt(4)
v_mfma_f32_16x16x32_bf16 v[132:135], a[96:99], a[0:3], v[132:135]
ds_read_b128 a[128:131], v5 offset:8192
v_mfma_f32_16x16x32_bf16 v[148:151], a[96:99], a[4:7], v[148:151]
ds_read_b128 a[132:135], v5 offset:9216
v_mfma_f32_16x16x32_bf16 v[152:155], a[100:103], a[4:7], v[152:155]
buffer_load_dwordx4 a[48:51], v4, s[40:43], s35 offen offset:0 sc1
v_mfma_f32_16x16x32_bf16 v[136:139], a[100:103], a[0:3], v[136:139]
ds_read_b128 a[136:139], v5 offset:10240
v_mfma_f32_16x16x32_bf16 v[140:143], a[104:107], a[0:3], v[140:143]
ds_read_b128 a[140:143], v5 offset:11264
v_mfma_f32_16x16x32_bf16 v[156:159], a[104:107], a[4:7], v[156:159]
v_mfma_f32_16x16x32_bf16 v[160:163], a[108:111], a[4:7], v[160:163]
buffer_load_dwordx4 a[52:55], v4, s[40:43], s35 offen offset:1024 sc1
s_xor_b32 s35, s9, 53248
v_mfma_f32_16x16x32_bf16 v[144:147], a[108:111], a[0:3], v[144:147]
s_waitcnt vmcnt(10) lgkmcnt(4)
v_mfma_f32_16x16x32_bf16 v[132:135], a[112:115], a[8:11], v[132:135]
ds_read_b128 a[96:99], v5 offset:12288
v_mfma_f32_16x16x32_bf16 v[148:151], a[112:115], a[12:15], v[148:151]
ds_read_b128 a[100:103], v5 offset:13312
v_mfma_f32_16x16x32_bf16 v[152:155], a[116:119], a[12:15], v[152:155]
buffer_load_dwordx4 a[0:3], v4, s[40:43], s35 offen offset:0 sc1
v_mfma_f32_16x16x32_bf16 v[136:139], a[116:119], a[8:11], v[136:139]
ds_read_b128 a[104:107], v5 offset:14336
v_mfma_f32_16x16x32_bf16 v[140:143], a[120:123], a[8:11], v[140:143]
ds_read_b128 a[108:111], v5 offset:15360
v_mfma_f32_16x16x32_bf16 v[156:159], a[120:123], a[12:15], v[156:159]
v_mfma_f32_16x16x32_bf16 v[160:163], a[124:127], a[12:15], v[160:163]
buffer_load_dwordx4 a[4:7], v4, s[40:43], s35 offen offset:1024 sc1
s_xor_b32 s35, s9, 65536
v_mfma_f32_16x16x32_bf16 v[144:147], a[124:127], a[8:11], v[144:147]
s_waitcnt vmcnt(10) lgkmcnt(4)
v_mfma_f32_16x16x32_bf16 v[132:135], a[128:131], a[16:19], v[132:135]
ds_read_b128 a[112:115], v5 offset:16384
v_mfma_f32_16x16x32_bf16 v[148:151], a[128:131], a[20:23], v[148:151]
ds_read_b128 a[116:119], v5 offset:17408
v_mfma_f32_16x16x32_bf16 v[152:155], a[132:135], a[20:23], v[152:155]
buffer_load_dwordx4 a[8:11], v4, s[40:43], s35 offen offset:0 sc1
v_mfma_f32_16x16x32_bf16 v[136:139], a[132:135], a[16:19], v[136:139]
ds_read_b128 a[120:123], v5 offset:18432
v_mfma_f32_16x16x32_bf16 v[140:143], a[136:139], a[16:19], v[140:143]
ds_read_b128 a[124:127], v5 offset:19456
v_mfma_f32_16x16x32_bf16 v[156:159], a[136:139], a[20:23], v[156:159]
v_mfma_f32_16x16x32_bf16 v[160:163], a[140:143], a[20:23], v[160:163]
buffer_load_dwordx4 a[12:15], v4, s[40:43], s35 offen offset:1024 sc1
s_xor_b32 s35, s9, 69632
v_mfma_f32_16x16x32_bf16 v[144:147], a[140:143], a[16:19], v[144:147]
s_waitcnt vmcnt(10) lgkmcnt(4)
v_mfma_f32_16x16x32_bf16 v[132:135], a[96:99], a[24:27], v[132:135]
ds_read_b128 a[128:131], v5 offset:20480
v_mfma_f32_16x16x32_bf16 v[148:151], a[96:99], a[28:31], v[148:151]
ds_read_b128 a[132:135], v5 offset:21504
v_mfma_f32_16x16x32_bf16 v[152:155], a[100:103], a[28:31], v[152:155]
buffer_load_dwordx4 a[16:19], v4, s[40:43], s35 offen offset:0 sc1
v_mfma_f32_16x16x32_bf16 v[136:139], a[100:103], a[24:27], v[136:139]
ds_read_b128 a[136:139], v5 offset:22528
v_mfma_f32_16x16x32_bf16 v[140:143], a[104:107], a[24:27], v[140:143]
ds_read_b128 a[140:143], v5 offset:23552
v_mfma_f32_16x16x32_bf16 v[156:159], a[104:107], a[28:31], v[156:159]
v_mfma_f32_16x16x32_bf16 v[160:163], a[108:111], a[28:31], v[160:163]
buffer_load_dwordx4 a[20:23], v4, s[40:43], s35 offen offset:1024 sc1
s_xor_b32 s35, s9, 81920
v_mfma_f32_16x16x32_bf16 v[144:147], a[108:111], a[24:27], v[144:147]
s_waitcnt vmcnt(10) lgkmcnt(4)
v_mfma_f32_16x16x32_bf16 v[132:135], a[112:115], a[32:35], v[132:135]
ds_read_b128 a[96:99], v5 offset:24576
v_mfma_f32_16x16x32_bf16 v[148:151], a[112:115], a[36:39], v[148:151]
ds_read_b128 a[100:103], v5 offset:25600
v_mfma_f32_16x16x32_bf16 v[152:155], a[116:119], a[36:39], v[152:155]
buffer_load_dwordx4 a[24:27], v4, s[40:43], s35 offen offset:0 sc1
v_mfma_f32_16x16x32_bf16 v[136:139], a[116:119], a[32:35], v[136:139]
ds_read_b128 a[104:107], v5 offset:26624
v_mfma_f32_16x16x32_bf16 v[140:143], a[120:123], a[32:35], v[140:143]
ds_read_b128 a[108:111], v5 offset:27648
v_mfma_f32_16x16x32_bf16 v[156:159], a[120:123], a[36:39], v[156:159]
v_mfma_f32_16x16x32_bf16 v[160:163], a[124:127], a[36:39], v[160:163]
buffer_load_dwordx4 a[28:31], v4, s[40:43], s35 offen offset:1024 sc1
s_xor_b32 s35, s9, 86016
v_mfma_f32_16x16x32_bf16 v[144:147], a[124:127], a[32:35], v[144:147]
s_waitcnt vmcnt(10) lgkmcnt(4)
v_mfma_f32_16x16x32_bf16 v[132:135], a[128:131], a[40:43], v[132:135]
ds_read_b128 a[112:115], v5 offset:28672
v_mfma_f32_16x16x32_bf16 v[148:151], a[128:131], a[44:47], v[148:151]
ds_read_b128 a[116:119], v5 offset:29696
v_mfma_f32_16x16x32_bf16 v[152:155], a[132:135], a[44:47], v[152:155]
buffer_load_dwordx4 a[32:35], v4, s[40:43], s35 offen offset:0 sc1
v_mfma_f32_16x16x32_bf16 v[136:139], a[132:135], a[40:43], v[136:139]
ds_read_b128 a[120:123], v5 offset:30720
v_mfma_f32_16x16x32_bf16 v[140:143], a[136:139], a[40:43], v[140:143]
ds_read_b128 a[124:127], v5 offset:31744
v_mfma_f32_16x16x32_bf16 v[156:159], a[136:139], a[44:47], v[156:159]
v_mfma_f32_16x16x32_bf16 v[160:163], a[140:143], a[44:47], v[160:163]
buffer_load_dwordx4 a[36:39], v4, s[40:43], s35 offen offset:1024 sc1
s_xor_b32 s35, s9, 98304
v_mfma_f32_16x16x32_bf16 v[144:147], a[140:143], a[40:43], v[144:147]
s_waitcnt vmcnt(10) lgkmcnt(4)
v_mfma_f32_16x16x32_bf16 v[132:135], a[96:99], a[48:51], v[132:135]
ds_read_b128 a[128:131], v5 offset:32768
v_mfma_f32_16x16x32_bf16 v[148:151], a[96:99], a[52:55], v[148:151]
ds_read_b128 a[132:135], v5 offset:33792
v_mfma_f32_16x16x32_bf16 v[152:155], a[100:103], a[52:55], v[152:155]
buffer_load_dwordx4 a[40:43], v4, s[40:43], s35 offen offset:0 sc1
v_mfma_f32_16x16x32_bf16 v[136:139], a[100:103], a[48:51], v[136:139]
ds_read_b128 a[136:139], v5 offset:34816
v_mfma_f32_16x16x32_bf16 v[140:143], a[104:107], a[48:51], v[140:143]
ds_read_b128 a[140:143], v5 offset:35840
v_mfma_f32_16x16x32_bf16 v[156:159], a[104:107], a[52:55], v[156:159]
v_mfma_f32_16x16x32_bf16 v[160:163], a[108:111], a[52:55], v[160:163]
buffer_load_dwordx4 a[44:47], v4, s[40:43], s35 offen offset:1024 sc1
s_xor_b32 s35, s9, 102400
v_mfma_f32_16x16x32_bf16 v[144:147], a[108:111], a[48:51], v[144:147]
s_waitcnt vmcnt(10) lgkmcnt(4)
v_mfma_f32_16x16x32_bf16 v[132:135], a[112:115], a[0:3], v[132:135]
ds_read_b128 a[96:99], v5 offset:36864
v_mfma_f32_16x16x32_bf16 v[148:151], a[112:115], a[4:7], v[148:151]
ds_read_b128 a[100:103], v5 offset:37888
v_mfma_f32_16x16x32_bf16 v[152:155], a[116:119], a[4:7], v[152:155]
buffer_load_dwordx4 a[48:51], v4, s[40:43], s35 offen offset:0 sc1
v_mfma_f32_16x16x32_bf16 v[136:139], a[116:119], a[0:3], v[136:139]
ds_read_b128 a[104:107], v5 offset:38912
v_mfma_f32_16x16x32_bf16 v[140:143], a[120:123], a[0:3], v[140:143]
ds_read_b128 a[108:111], v5 offset:39936
v_mfma_f32_16x16x32_bf16 v[156:159], a[120:123], a[4:7], v[156:159]
v_mfma_f32_16x16x32_bf16 v[160:163], a[124:127], a[4:7], v[160:163]
buffer_load_dwordx4 a[52:55], v4, s[40:43], s35 offen offset:1024 sc1
s_xor_b32 s35, s9, 114688
v_mfma_f32_16x16x32_bf16 v[144:147], a[124:127], a[0:3], v[144:147]
s_waitcnt vmcnt(10) lgkmcnt(4)
v_mfma_f32_16x16x32_bf16 v[132:135], a[128:131], a[8:11], v[132:135]
ds_read_b128 a[112:115], v5 offset:40960
v_mfma_f32_16x16x32_bf16 v[148:151], a[128:131], a[12:15], v[148:151]
ds_read_b128 a[116:119], v5 offset:41984
L_stub9:
s_cbranch_execz L_wret3
v_mfma_f32_16x16x32_bf16 v[152:155], a[132:135], a[12:15], v[152:155]
buffer_load_dwordx4 a[0:3], v4, s[40:43], s35 offen offset:0 sc1
v_mfma_f32_16x16x32_bf16 v[136:139], a[132:135], a[8:11], v[136:139]
ds_read_b128 a[120:123], v5 offset:43008
v_mfma_f32_16x16x32_bf16 v[140:143], a[136:139], a[8:11], v[140:143]
ds_read_b128 a[124:127], v5 offset:44032
v_mfma_f32_16x16x32_bf16 v[156:159], a[136:139], a[12:15], v[156:159]
v_mfma_f32_16x16x32_bf16 v[160:163], a[140:143], a[12:15], v[160:163]
buffer_load_dwordx4 a[4:7], v4, s[40:43], s35 offen offset:1024 sc1
s_xor_b32 s35, s9, 118784
v_mfma_f32_16x16x32_bf16 v[144:147], a[140:143], a[8:11], v[144:147]
s_waitcnt vmcnt(10) lgkmcnt(4)
v_mfma_f32_16x16x32_bf16 v[132:135], a[96:99], a[16:19], v[132:135]
ds_read_b128 a[128:131], v5 offset:45056
v_mfma_f32_16x16x32_bf16 v[148:151], a[96:99], a[20:23], v[148:151]
ds_read_b128 a[132:135], v5 offset:46080
v_mfma_f32_16x16x32_bf16 v[152:155], a[100:103], a[20:23], v[152:155]
buffer_load_dwordx4 a[8:11], v4, s[40:43], s35 offen offset:0 sc1
v_mfma_f32_16x16x32_bf16 v[136:139], a[100:103], a[16:19], v[136:139]
ds_read_b128 a[136:139], v5 offset:47104
v_mfma_f32_16x16x32_bf16 v[140:143], a[104:107], a[16:19], v[140:143]
ds_read_b128 a[140:143], v5 offset:48128
v_mfma_f32_16x16x32_bf16 v[156:159], a[104:107], a[20:23], v[156:159]
v_mfma_f32_16x16x32_bf16 v[160:163], a[108:111], a[20:23], v[160:163]
buffer_load_dwordx4 a[12:15], v4, s[40:43], s35 offen offset:1024 sc1
s_xor_b32 s35, s9, 524288
v_mfma_f32_16x16x32_bf16 v[144:147], a[108:111], a[16:19], v[144:147]
s_waitcnt vmcnt(10) lgkmcnt(4)
v_mfma_f32_16x16x32_bf16 v[132:135], a[112:115], a[24:27], v[132:135]
ds_read_b128 a[96:99], v5 offset:49152
v_mfma_f32_16x16x32_bf16 v[148:151], a[112:115], a[28:31], v[148:151]
ds_read_b128 a[100:103], v5 offset:50176
v_mfma_f32_16x16x32_bf16 v[152:155], a[116:119], a[28:31], v[152:155]
buffer_load_dwordx4 a[16:19], v4, s[40:43], s35 offen offset:0 sc1
v_mfma_f32_16x16x32_bf16 v[136:139], a[116:119], a[24:27], v[136:139]
ds_read_b128 a[104:107], v5 offset:51200
v_mfma_f32_16x16x32_bf16 v[140:143], a[120:123], a[24:27], v[140:143]
ds_read_b128 a[108:111], v5 offset:52224
v_mfma_f32_16x16x32_bf16 v[156:159], a[120:123], a[28:31], v[156:159]
v_mfma_f32_16x16x32_bf16 v[160:163], a[124:127], a[28:31], v[160:163]
buffer_load_dwordx4 a[20:23], v4, s[40:43], s35 offen offset:1024 sc1
s_xor_b32 s35, s9, 528384
v_mfma_f32_16x16x32_bf16 v[144:147], a[124:127], a[24:27], v[144:147]
s_waitcnt vmcnt(10) lgkmcnt(4)
v_mfma_f32_16x16x32_bf16 v[132:135], a[128:131], a[32:35], v[132:135]
ds_read_b128 a[112:115], v5 offset:53248
v_mfma_f32_16x16x32_bf16 v[148:151], a[128:131], a[36:39], v[148:151]
ds_read_b128 a[116:119], v5 offset:54272
v_mfma_f32_16x16x32_bf16 v[152:155], a[132:135], a[36:39], v[152:155]
buffer_load_dwordx4 a[24:27], v4, s[40:43], s35 offen offset:0 sc1
v_mfma_f32_16x16x32_bf16 v[136:139], a[132:135], a[32:35], v[136:139]
ds_read_b128 a[120:123], v5 offset:55296
v_mfma_f32_16x16x32_bf16 v[140:143], a[136:139], a[32:35], v[140:143]
ds_read_b128 a[124:127], v5 offset:56320
v_mfma_f32_16x16x32_bf16 v[156:159], a[136:139], a[36:39], v[156:159]
v_mfma_f32_16x16x32_bf16 v[160:163], a[140:143], a[36:39], v[160:163]
buffer_load_dwordx4 a[28:31], v4, s[40:43], s35 offen offset:1024 sc1
s_xor_b32 s35, s9, 540672
v_mfma_f32_16x16x32_bf16 v[144:147], a[140:143], a[32:35], v[144:147]
s_waitcnt vmcnt(10) lgkmcnt(4)
v_mfma_f32_16x16x32_bf16 v[132:135], a[96:99], a[40:43], v[132:135]
ds_read_b128 a[128:131], v5 offset:57344
v_mfma_f32_16x16x32_bf16 v[148:151], a[96:99], a[44:47], v[148:151]
ds_read_b128 a[132:135], v5 offset:58368
v_mfma_f32_16x16x32_bf16 v[152:155], a[100:103], a[44:47], v[152:155]
buffer_load_dwordx4 a[32:35], v4, s[40:43], s35 offen offset:0 sc1
v_mfma_f32_16x16x32_bf16 v[136:139], a[100:103], a[40:43], v[136:139]
ds_read_b128 a[136:139], v5 offset:59392
v_mfma_f32_16x16x32_bf16 v[140:143], a[104:107], a[40:43], v[140:143]
ds_read_b128 a[140:143], v5 offset:60416
v_mfma_f32_16x16x32_bf16 v[156:159], a[104:107], a[44:47], v[156:159]
v_mfma_f32_16x16x32_bf16 v[160:163], a[108:111], a[44:47], v[160:163]
buffer_load_dwordx4 a[36:39], v4, s[40:43], s35 offen offset:1024 sc1
s_xor_b32 s35, s9, 544768
v_mfma_f32_16x16x32_bf16 v[144:147], a[108:111], a[40:43], v[144:147]
s_waitcnt vmcnt(10) lgkmcnt(4)
v_mfma_f32_16x16x32_bf16 v[132:135], a[112:115], a[48:51], v[132:135]
ds_read_b128 a[96:99], v5 offset:61440
v_mfma_f32_16x16x32_bf16 v[148:151], a[112:115], a[52:55], v[148:151]
ds_read_b128 a[100:103], v5 offset:62464
v_mfma_f32_16x16x32_bf16 v[152:155], a[116:119], a[52:55], v[152:155]
buffer_load_dwordx4 a[40:43], v4, s[40:43], s35 offen offset:0 sc1
v_mfma_f32_16x16x32_bf16 v[136:139], a[116:119], a[48:51], v[136:139]
ds_read_b128 a[104:107], v5 offset:63488
v_mfma_f32_16x16x32_bf16 v[140:143], a[120:123], a[48:51], v[140:143]
ds_read_b128 a[108:111], v5 offset:64512
v_mfma_f32_16x16x32_bf16 v[156:159], a[120:123], a[52:55], v[156:159]
v_mfma_f32_16x16x32_bf16 v[160:163], a[124:127], a[52:55], v[160:163]
buffer_load_dwordx4 a[44:47], v4, s[40:43], s35 offen offset:1024 sc1
s_xor_b32 s35, s9, 557056
v_mfma_f32_16x16x32_bf16 v[144:147], a[124:127], a[48:51], v[144:147]
s_waitcnt vmcnt(10) lgkmcnt(4)
v_mfma_f32_16x16x32_bf16 v[132:135], a[128:131], a[0:3], v[132:135]
ds_read_b128 a[112:115], v6 offset:0
v_mfma_f32_16x16x32_bf16 v[148:151], a[128:131], a[4:7], v[148:151]
ds_read_b128 a[116:119], v6 offset:1024
v_mfma_f32_16x16x32_bf16 v[152:155], a[132:135], a[4:7], v[152:155]
buffer_load_dwordx4 a[48:51], v4, s[40:43], s35 offen offset:0 sc1
v_mfma_f32_16x16x32_bf16 v[136:139], a[132:135], a[0:3], v[136:139]
ds_read_b128 a[120:123], v6 offset:2048
v_mfma_f32_16x16x32_bf16 v[140:143], a[136:139], a[0:3], v[140:143]
ds_read_b128 a[124:127], v6 offset:3072
v_mfma_f32_16x16x32_bf16 v[156:159], a[136:139], a[4:7], v[156:159]
v_mfma_f32_16x16x32_bf16 v[160:163], a[140:143], a[4:7], v[160:163]
buffer_load_dwordx4 a[52:55], v4, s[40:43], s35 offen offset:1024 sc1
s_xor_b32 s35, s9, 561152
v_mfma_f32_16x16x32_bf16 v[144:147], a[140:143], a[0:3], v[144:147]
s_waitcnt vmcnt(10) lgkmcnt(4)
v_mfma_f32_16x16x32_bf16 v[132:135], a[96:99], a[8:11], v[132:135]
ds_read_b128 a[128:131], v6 offset:4096
v_mfma_f32_16x16x32_bf16 v[148:151], a[96:99], a[12:15], v[148:151]
ds_read_b128 a[132:135], v6 offset:5120
v_mfma_f32_16x16x32_bf16 v[152:155], a[100:103], a[12:15], v[152:155]
buffer_load_dwordx4 a[0:3], v4, s[40:43], s35 offen offset:0 sc1
v_mfma_f32_16x16x32_bf16 v[136:139], a[100:103], a[8:11], v[136:139]
ds_read_b128 a[136:139], v6 offset:6144
v_mfma_f32_16x16x32_bf16 v[140:143], a[104:107], a[8:11], v[140:143]
ds_read_b128 a[140:143], v6 offset:7168
v_mfma_f32_16x16x32_bf16 v[156:159], a[104:107], a[12:15], v[156:159]
v_mfma_f32_16x16x32_bf16 v[160:163], a[108:111], a[12:15], v[160:163]
buffer_load_dwordx4 a[4:7], v4, s[40:43], s35 offen offset:1024 sc1
s_xor_b32 s35, s9, 573440
v_mfma_f32_16x16x32_bf16 v[144:147], a[108:111], a[8:11], v[144:147]
s_waitcnt vmcnt(10) lgkmcnt(4)
v_mfma_f32_16x16x32_bf16 v[132:135], a[112:115], a[16:19], v[132:135]
ds_read_b128 a[96:99], v6 offset:8192
v_mfma_f32_16x16x32_bf16 v[148:151], a[112:115], a[20:23], v[148:151]
ds_read_b128 a[100:103], v6 offset:9216
v_mfma_f32_16x16x32_bf16 v[152:155], a[116:119], a[20:23], v[152:155]
buffer_load_dwordx4 a[8:11], v4, s[40:43], s35 offen offset:0 sc1
v_mfma_f32_16x16x32_bf16 v[136:139], a[116:119], a[16:19], v[136:139]
ds_read_b128 a[104:107], v6 offset:10240
v_mfma_f32_16x16x32_bf16 v[140:143], a[120:123], a[16:19], v[140:143]
ds_read_b128 a[108:111], v6 offset:11264
v_mfma_f32_16x16x32_bf16 v[156:159], a[120:123], a[20:23], v[156:159]
v_mfma_f32_16x16x32_bf16 v[160:163], a[124:127], a[20:23], v[160:163]
buffer_load_dwordx4 a[12:15], v4, s[40:43], s35 offen offset:1024 sc1
s_xor_b32 s35, s9, 577536
v_mfma_f32_16x16x32_bf16 v[144:147], a[124:127], a[16:19], v[144:147]
s_waitcnt vmcnt(10) lgkmcnt(4)
v_mfma_f32_16x16x32_bf16 v[132:135], a[128:131], a[24:27], v[132:135]
ds_read_b128 a[112:115], v6 offset:12288
v_mfma_f32_16x16x32_bf16 v[148:151], a[128:131], a[28:31], v[148:151]
ds_read_b128 a[116:119], v6 offset:13312
v_mfma_f32_16x16x32_bf16 v[152:155], a[132:135], a[28:31], v[152:155]
buffer_load_dwordx4 a[16:19], v4, s[40:43], s35 offen offset:0 sc1
v_mfma_f32_16x16x32_bf16 v[136:139], a[132:135], a[24:27], v[136:139]
ds_read_b128 a[120:123], v6 offset:14336
v_mfma_f32_16x16x32_bf16 v[140:143], a[136:139], a[24:27], v[140:143]
ds_read_b128 a[124:127], v6 offset:15360
v_mfma_f32_16x16x32_bf16 v[156:159], a[136:139], a[28:31], v[156:159]
v_mfma_f32_16x16x32_bf16 v[160:163], a[140:143], a[28:31], v[160:163]
buffer_load_dwordx4 a[20:23], v4, s[40:43], s35 offen offset:1024 sc1
s_xor_b32 s35, s9, 589824
v_mfma_f32_16x16x32_bf16 v[144:147], a[140:143], a[24:27], v[144:147]
s_waitcnt vmcnt(10) lgkmcnt(4)
v_mfma_f32_16x16x32_bf16 v[132:135], a[96:99], a[32:35], v[132:135]
ds_read_b128 a[128:131], v6 offset:16384
v_mfma_f32_16x16x32_bf16 v[148:151], a[96:99], a[36:39], v[148:151]
ds_read_b128 a[132:135], v6 offset:17408
v_mfma_f32_16x16x32_bf16 v[152:155], a[100:103], a[36:39], v[152:155]
buffer_load_dwordx4 a[24:27], v4, s[40:43], s35 offen offset:0 sc1
v_mfma_f32_16x16x32_bf16 v[136:139], a[100:103], a[32:35], v[136:139]
ds_read_b128 a[136:139], v6 offset:18432
v_mfma_f32_16x16x32_bf16 v[140:143], a[104:107], a[32:35], v[140:143]
ds_read_b128 a[140:143], v6 offset:19456
v_mfma_f32_16x16x32_bf16 v[156:159], a[104:107], a[36:39], v[156:159]
v_mfma_f32_16x16x32_bf16 v[160:163], a[108:111], a[36:39], v[160:163]
buffer_load_dwordx4 a[28:31], v4, s[40:43], s35 offen offset:1024 sc1
s_xor_b32 s35, s9, 593920
v_mfma_f32_16x16x32_bf16 v[144:147], a[108:111], a[32:35], v[144:147]
s_waitcnt vmcnt(10) lgkmcnt(4)
v_mfma_f32_16x16x32_bf16 v[132:135], a[112:115], a[40:43], v[132:135]
ds_read_b128 a[96:99], v6 offset:20480
v_mfma_f32_16x16x32_bf16 v[148:151], a[112:115], a[44:47], v[148:151]
ds_read_b128 a[100:103], v6 offset:21504
v_mfma_f32_16x16x32_bf16 v[152:155], a[116:119], a[44:47], v[152:155]
buffer_load_dwordx4 a[32:35], v4, s[40:43], s35 offen offset:0 sc1
v_mfma_f32_16x16x32_bf16 v[136:139], a[116:119], a[40:43], v[136:139]
ds_read_b128 a[104:107], v6 offset:22528
v_mfma_f32_16x16x32_bf16 v[140:143], a[120:123], a[40:43], v[140:143]
ds_read_b128 a[108:111], v6 offset:23552
v_mfma_f32_16x16x32_bf16 v[156:159], a[120:123], a[44:47], v[156:159]
v_mfma_f32_16x16x32_bf16 v[160:163], a[124:127], a[44:47], v[160:163]
buffer_load_dwordx4 a[36:39], v4, s[40:43], s35 offen offset:1024 sc1
s_xor_b32 s35, s9, 606208
v_mfma_f32_16x16x32_bf16 v[144:147], a[124:127], a[40:43], v[144:147]
s_waitcnt vmcnt(10) lgkmcnt(4)
v_mfma_f32_16x16x32_bf16 v[132:135], a[128:131], a[48:51], v[132:135]
ds_read_b128 a[112:115], v6 offset:24576
v_mfma_f32_16x16x32_bf16 v[148:151], a[128:131], a[52:55], v[148:151]
ds_read_b128 a[116:119], v6 offset:25600
v_mfma_f32_16x16x32_bf16 v[152:155], a[132:135], a[52:55], v[152:155]
buffer_load_dwordx4 a[40:43], v4, s[40:43], s35 offen offset:0 sc1
v_mfma_f32_16x16x32_bf16 v[136:139], a[132:135], a[48:51], v[136:139]
ds_read_b128 a[120:123], v6 offset:26624
v_mfma_f32_16x16x32_bf16 v[140:143], a[136:139], a[48:51], v[140:143]
ds_read_b128 a[124:127], v6 offset:27648
v_mfma_f32_16x16x32_bf16 v[156:159], a[136:139], a[52:55], v[156:159]
v_mfma_f32_16x16x32_bf16 v[160:163], a[140:143], a[52:55], v[160:163]
buffer_load_dwordx4 a[44:47], v4, s[40:43], s35 offen offset:1024 sc1
s_xor_b32 s35, s9, 610304
v_mfma_f32_16x16x32_bf16 v[144:147], a[140:143], a[48:51], v[144:147]
s_waitcnt vmcnt(10) lgkmcnt(4)
v_mfma_f32_16x16x32_bf16 v[132:135], a[96:99], a[0:3], v[132:135]
ds_read_b128 a[128:131], v6 offset:28672
v_mfma_f32_16x16x32_bf16 v[148:151], a[96:99], a[4:7], v[148:151]
ds_read_b128 a[132:135], v6 offset:29696
v_mfma_f32_16x16x32_bf16 v[152:155], a[100:103], a[4:7], v[152:155]
buffer_load_dwordx4 a[48:51], v4, s[40:43], s35 offen offset:0 sc1
v_mfma_f32_16x16x32_bf16 v[136:139], a[100:103], a[0:3], v[136:139]
ds_read_b128 a[136:139], v6 offset:30720
v_mfma_f32_16x16x32_bf16 v[140:143], a[104:107], a[0:3], v[140:143]
ds_read_b128 a[140:143], v6 offset:31744
v_mfma_f32_16x16x32_bf16 v[156:159], a[104:107], a[4:7], v[156:159]
v_mfma_f32_16x16x32_bf16 v[160:163], a[108:111], a[4:7], v[160:163]
buffer_load_dwordx4 a[52:55], v4, s[40:43], s35 offen offset:1024 sc1
s_xor_b32 s35, s9, 622592
v_mfma_f32_16x16x32_bf16 v[144:147], a[108:111], a[0:3], v[144:147]
s_waitcnt vmcnt(10) lgkmcnt(4)
v_mfma_f32_16x16x32_bf16 v[132:135], a[112:115], a[8:11], v[132:135]
ds_read_b128 a[96:99], v6 offset:32768
v_mfma_f32_16x16x32_bf16 v[148:151], a[112:115], a[12:15], v[148:151]
ds_read_b128 a[100:103], v6 offset:33792
v_mfma_f32_16x16x32_bf16 v[152:155], a[116:119], a[12:15], v[152:155]
buffer_load_dwordx4 a[0:3], v4, s[40:43], s35 offen offset:0 sc1
v_mfma_f32_16x16x32_bf16 v[136:139], a[116:119], a[8:11], v[136:139]
ds_read_b128 a[104:107], v6 offset:34816
v_mfma_f32_16x16x32_bf16 v[140:143], a[120:123], a[8:11], v[140:143]
ds_read_b128 a[108:111], v6 offset:35840
v_mfma_f32_16x16x32_bf16 v[156:159], a[120:123], a[12:15], v[156:159]
v_mfma_f32_16x16x32_bf16 v[160:163], a[124:127], a[12:15], v[160:163]
buffer_load_dwordx4 a[4:7], v4, s[40:43], s35 offen offset:1024 sc1
s_xor_b32 s35, s9, 626688
v_mfma_f32_16x16x32_bf16 v[144:147], a[124:127], a[8:11], v[144:147]
s_waitcnt vmcnt(10) lgkmcnt(4)
v_mfma_f32_16x16x32_bf16 v[132:135], a[128:131], a[16:19], v[132:135]
ds_read_b128 a[112:115], v6 offset:36864
v_mfma_f32_16x16x32_bf16 v[148:151], a[128:131], a[20:23], v[148:151]
ds_read_b128 a[116:119], v6 offset:37888
v_mfma_f32_16x16x32_bf16 v[152:155], a[132:135], a[20:23], v[152:155]
buffer_load_dwordx4 a[8:11], v4, s[40:43], s35 offen offset:0 sc1
v_mfma_f32_16x16x32_bf16 v[136:139], a[132:135], a[16:19], v[136:139]
ds_read_b128 a[120:123], v6 offset:38912
v_mfma_f32_16x16x32_bf16 v[140:143], a[136:139], a[16:19], v[140:143]
ds_read_b128 a[124:127], v6 offset:39936
v_mfma_f32_16x16x32_bf16 v[156:159], a[136:139], a[20:23], v[156:159]
v_mfma_f32_16x16x32_bf16 v[160:163], a[140:143], a[20:23], v[160:163]
buffer_load_dwordx4 a[12:15], v4, s[40:43], s35 offen offset:1024 sc1
s_xor_b32 s35, s9, 638976
v_mfma_f32_16x16x32_bf16 v[144:147], a[140:143], a[16:19], v[144:147]
s_waitcnt vmcnt(10) lgkmcnt(4)
v_mfma_f32_16x16x32_bf16 v[132:135], a[96:99], a[24:27], v[132:135]
ds_read_b128 a[128:131], v6 offset:40960
v_mfma_f32_16x16x32_bf16 v[148:151], a[96:99], a[28:31], v[148:151]
ds_read_b128 a[132:135], v6 offset:41984
v_mfma_f32_16x16x32_bf16 v[152:155], a[100:103], a[28:31], v[152:155]
buffer_load_dwordx4 a[16:19], v4, s[40:43], s35 offen offset:0 sc1
v_mfma_f32_16x16x32_bf16 v[136:139], a[100:103], a[24:27], v[136:139]
ds_read_b128 a[136:139], v6 offset:43008
v_mfma_f32_16x16x32_bf16 v[140:143], a[104:107], a[24:27], v[140:143]
ds_read_b128 a[140:143], v6 offset:44032
v_mfma_f32_16x16x32_bf16 v[156:159], a[104:107], a[28:31], v[156:159]
v_mfma_f32_16x16x32_bf16 v[160:163], a[108:111], a[28:31], v[160:163]
buffer_load_dwordx4 a[20:23], v4, s[40:43], s35 offen offset:1024 sc1
s_xor_b32 s35, s9, 643072
v_mfma_f32_16x16x32_bf16 v[144:147], a[108:111], a[24:27], v[144:147]
s_waitcnt vmcnt(10) lgkmcnt(4)
v_mfma_f32_16x16x32_bf16 v[132:135], a[112:115], a[32:35], v[132:135]
ds_read_b128 a[96:99], v6 offset:45056
v_mfma_f32_16x16x32_bf16 v[148:151], a[112:115], a[36:39], v[148:151]
ds_read_b128 a[100:103], v6 offset:46080
v_mfma_f32_16x16x32_bf16 v[152:155], a[116:119], a[36:39], v[152:155]
buffer_load_dwordx4 a[24:27], v4, s[40:43], s35 offen offset:0 sc1
v_mfma_f32_16x16x32_bf16 v[136:139], a[116:119], a[32:35], v[136:139]
ds_read_b128 a[104:107], v6 offset:47104
v_mfma_f32_16x16x32_bf16 v[140:143], a[120:123], a[32:35], v[140:143]
ds_read_b128 a[108:111], v6 offset:48128
v_mfma_f32_16x16x32_bf16 v[156:159], a[120:123], a[36:39], v[156:159]
v_mfma_f32_16x16x32_bf16 v[160:163], a[124:127], a[36:39], v[160:163]
buffer_load_dwordx4 a[28:31], v4, s[40:43], s35 offen offset:1024 sc1
s_xor_b32 s35, s9, 0
v_mfma_f32_16x16x32_bf16 v[144:147], a[124:127], a[32:35], v[144:147]
s_waitcnt vmcnt(10) lgkmcnt(4)
v_mfma_f32_16x16x32_bf16 v[132:135], a[128:131], a[40:43], v[132:135]
s_add_u32 m0, s18, 0x0
s_add_u32 s44, s50, 0x2000000
v_mfma_f32_16x16x32_bf16 v[148:151], a[128:131], a[44:47], v[148:151]
ds_read_b128 a[112:115], v6 offset:49152
v_mfma_f32_16x16x32_bf16 v[152:155], a[132:135], a[44:47], v[152:155]
buffer_load_dwordx4 v1, s[4:7], s44 offen offset:0 sc1 lds
v_mfma_f32_16x16x32_bf16 v[136:139], a[132:135], a[40:43], v[136:139]
ds_read_b128 a[116:119], v6 offset:50176
v_mfma_f32_16x16x32_bf16 v[140:143], a[136:139], a[40:43], v[140:143]
ds_read_b128 a[120:123], v6 offset:51200
v_mfma_f32_16x16x32_bf16 v[156:159], a[136:139], a[44:47], v[156:159]
ds_read_b128 a[124:127], v6 offset:52224
v_mfma_f32_16x16x32_bf16 v[160:163], a[140:143], a[44:47], v[160:163]
buffer_load_dwordx4 v1, s[4:7], s44 offen offset:1024 sc1 lds
s_add_u32 m0, s18, 0x2000
v_mfma_f32_16x16x32_bf16 v[144:147], a[140:143], a[40:43], v[144:147]
s_add_u32 s44, s50, 0x2002000
s_waitcnt vmcnt(10) lgkmcnt(4)
v_mfma_f32_16x16x32_bf16 v[132:135], a[96:99], a[48:51], v[132:135]
ds_read_b128 a[128:131], v6 offset:53248
v_mfma_f32_16x16x32_bf16 v[148:151], a[96:99], a[52:55], v[148:151]
ds_read_b128 a[132:135], v6 offset:54272
v_mfma_f32_16x16x32_bf16 v[152:155], a[100:103], a[52:55], v[152:155]
buffer_load_dwordx4 v1, s[4:7], s44 offen offset:0 sc1 lds
v_mfma_f32_16x16x32_bf16 v[136:139], a[100:103], a[48:51], v[136:139]
ds_read_b128 a[136:139], v6 offset:55296
v_mfma_f32_16x16x32_bf16 v[140:143], a[104:107], a[48:51], v[140:143]
ds_read_b128 a[140:143], v6 offset:56320
v_mfma_f32_16x16x32_bf16 v[156:159], a[104:107], a[52:55], v[156:159]
v_mfma_f32_16x16x32_bf16 v[160:163], a[108:111], a[52:55], v[160:163]
buffer_load_dwordx4 v1, s[4:7], s44 offen offset:1024 sc1 lds
s_add_u32 m0, s18, 0x4000
v_mfma_f32_16x16x32_bf16 v[144:147], a[108:111], a[48:51], v[144:147]
s_add_u32 s44, s50, 0x2004000
s_waitcnt vmcnt(10) lgkmcnt(4)
v_mfma_f32_16x16x32_bf16 v[132:135], a[112:115], a[0:3], v[132:135]
ds_read_b128 a[96:99], v6 offset:57344
v_mfma_f32_16x16x32_bf16 v[148:151], a[112:115], a[4:7], v[148:151]
ds_read_b128 a[100:103], v6 offset:58368
v_mfma_f32_16x16x32_bf16 v[152:155], a[116:119], a[4:7], v[152:155]
ds_read_b128 a[104:107], v6 offset:59392
v_mfma_f32_16x16x32_bf16 v[136:139], a[116:119], a[0:3], v[136:139]
buffer_load_dwordx4 v1, s[4:7], s44 offen offset:0 sc1 lds
v_mfma_f32_16x16x32_bf16 v[140:143], a[120:123], a[0:3], v[140:143]
ds_read_b128 a[108:111], v6 offset:60416
v_mfma_f32_16x16x32_bf16 v[156:159], a[120:123], a[4:7], v[156:159]
v_mfma_f32_16x16x32_bf16 v[160:163], a[124:127], a[4:7], v[160:163]
v_mfma_f32_16x16x32_bf16 v[144:147], a[124:127], a[0:3], v[144:147]
buffer_load_dwordx4 v1, s[4:7], s44 offen offset:1024 sc1 lds
s_waitcnt vmcnt(10) lgkmcnt(4)
v_mfma_f32_16x16x32_bf16 v[132:135], a[128:131], a[8:11], v[132:135]
s_add_u32 m0, s18, 0x6000
s_add_u32 s44, s50, 0x2006000
v_mfma_f32_16x16x32_bf16 v[148:151], a[128:131], a[12:15], v[148:151]
ds_read_b128 a[112:115], v6 offset:61440
v_mfma_f32_16x16x32_bf16 v[152:155], a[132:135], a[12:15], v[152:155]
ds_read_b128 a[116:119], v6 offset:62464
v_mfma_f32_16x16x32_bf16 v[136:139], a[132:135], a[8:11], v[136:139]
ds_read_b128 a[120:123], v6 offset:63488
v_mfma_f32_16x16x32_bf16 v[140:143], a[136:139], a[8:11], v[140:143]
buffer_load_dwordx4 v1, s[4:7], s44 offen offset:0 sc1 lds
v_mfma_f32_16x16x32_bf16 v[156:159], a[136:139], a[12:15], v[156:159]
ds_read_b128 a[124:127], v6 offset:64512
v_mfma_f32_16x16x32_bf16 v[160:163], a[140:143], a[12:15], v[160:163]
v_mfma_f32_16x16x32_bf16 v[144:147], a[140:143], a[8:11], v[144:147]
s_waitcnt vmcnt(9) lgkmcnt(4)
v_mfma_f32_16x16x32_bf16 v[132:135], a[96:99], a[16:19], v[132:135]
v_mfma_f32_16x16x32_bf16 v[148:151], a[96:99], a[20:23], v[148:151]
buffer_load_dwordx4 v1, s[4:7], s44 offen offset:1024 sc1 lds
v_mfma_f32_16x16x32_bf16 v[152:155], a[100:103], a[20:23], v[152:155]
v_mfma_f32_16x16x32_bf16 v[136:139], a[100:103], a[16:19], v[136:139]
v_mfma_f32_16x16x32_bf16 v[140:143], a[104:107], a[16:19], v[140:143]
v_mfma_f32_16x16x32_bf16 v[156:159], a[104:107], a[20:23], v[156:159]
v_mfma_f32_16x16x32_bf16 v[160:163], a[108:111], a[20:23], v[160:163]
v_mfma_f32_16x16x32_bf16 v[144:147], a[108:111], a[16:19], v[144:147]
s_waitcnt vmcnt(8) lgkmcnt(0)
v_mfma_f32_16x16x32_bf16 v[132:135], a[112:115], a[24:27], v[132:135]
v_mfma_f32_16x16x32_bf16 v[148:151], a[112:115], a[28:31], v[148:151]
v_mfma_f32_16x16x32_bf16 v[152:155], a[116:119], a[28:31], v[152:155]
v_mfma_f32_16x16x32_bf16 v[136:139], a[116:119], a[24:27], v[136:139]
v_mfma_f32_16x16x32_bf16 v[140:143], a[120:123], a[24:27], v[140:143]
v_mfma_f32_16x16x32_bf16 v[156:159], a[120:123], a[28:31], v[156:159]
v_mfma_f32_16x16x32_bf16 v[160:163], a[124:127], a[28:31], v[160:163]
v_mfma_f32_16x16x32_bf16 v[144:147], a[124:127], a[24:27], v[144:147]
s_nop 1
v_cmp_u_f32 vcc, v132, v148
s_nop 0
s_and_b32 vcc_lo, vcc_lo, s95
s_cbranch_scc1 L_k2redo1
v_cvt_pk_bf16_f32 v32, v132, v133
v_cvt_pk_bf16_f32 v33, v134, v135
v_cvt_pk_bf16_f32 v34, v136, v137
v_cvt_pk_bf16_f32 v35, v138, v139
s_add_u32 s36, s45, 0x1000000
buffer_store_dwordx4 v[32:35], v4, s[4:7], s36 offen offset:0 sc1
v_cvt_pk_bf16_f32 v40, v148, v149
v_cvt_pk_bf16_f32 v41, v150, v151
v_cvt_pk_bf16_f32 v42, v152, v153
v_cvt_pk_bf16_f32 v43, v154, v155
v_cvt_pk_bf16_f32 v36, v140, v141
v_cvt_pk_bf16_f32 v37, v142, v143
v_cvt_pk_bf16_f32 v38, v144, v145
v_cvt_pk_bf16_f32 v39, v146, v147
s_add_u32 s37, s36, 4096
v_cvt_pk_bf16_f32 v44, v156, v157
v_cvt_pk_bf16_f32 v45, v158, v159
v_cvt_pk_bf16_f32 v46, v160, v161
buffer_store_dwordx4 v[40:43], v4, s[4:7], s36 offen offset:1024 sc1
v_cvt_pk_bf16_f32 v47, v162, v163
v_mfma_f32_16x16x32_bf16 v[96:99], v[32:35], v[32:35], 0
s_mov_b32 s38, 0x340000
s_add_u32 s92, s78, 0x50000
v_mfma_f32_16x16x32_bf16 v[92:95], v[16:19], v[32:35], 0
s_add_u32 s40, s4, 0x1000000
s_addc_u32 s41, s5, 0
v_mfma_f32_16x16x32_bf16 v[96:99], v[36:39], v[36:39], v[96:99]
buffer_store_dwordx4 v[36:39], v4, s[4:7], s37 offen offset:0 sc1
v_mfma_f32_16x16x32_bf16 v[92:95], v[16:19], v[36:39], v[92:95]
s_nop 5
v_cndmask_b32 v96, v96, v97, s[46:47]
v_cndmask_b32 v98, v98, v99, s[46:47]
v_mfma_f32_16x16x32_bf16 v[104:107], v[40:43], v[40:43], 0
v_mfma_f32_16x16x32_bf16 v[100:103], v[16:19], v[40:43], 0
v_cndmask_b32 v93, v96, v98, s[48:49]
buffer_store_dwordx4 v[44:47], v4, s[4:7], s37 offen offset:1024 sc1
v_mfma_f32_16x16x32_bf16 v[104:107], v[44:47], v[44:47], v[104:107]
v_mfma_f32_16x16x32_bf16 v[100:103], v[16:19], v[44:47], v[100:103]
s_nop 6
v_cndmask_b32 v104, v104, v105, s[46:47]
v_cndmask_b32 v106, v106, v107, s[46:47]
buffer_store_dwordx2 v[92:93], v253, s[4:7], s38 offen offset:0 sc1
v_cndmask_b32 v101, v104, v106, s[48:49]
buffer_store_dwordx2 v[100:101], v253, s[4:7], s38 offen offset:2048 sc1
s_barrier
s_add_u32 m0, s18, 0x8000
s_add_u32 s44, s50, 0x2008000
buffer_load_dwordx4 v1, s[4:7], s44 offen offset:0 sc1 lds
buffer_load_dwordx4 v1, s[4:7], s44 offen offset:1024 sc1 lds
s_add_u32 m0, s18, 0xa000
s_add_u32 s44, s50, 0x200a000
buffer_load_dwordx4 v1, s[4:7], s44 offen offset:0 sc1 lds
buffer_load_dwordx4 v1, s[4:7], s44 offen offset:1024 sc1 lds
v_accvgpr_read_b32 v48, a188
v_accvgpr_read_b32 v49, a189
v_accvgpr_read_b32 v50, a190
v_accvgpr_read_b32 v51, a191
v_accvgpr_read_b32 v52, a192
v_accvgpr_read_b32 v53, a193
v_accvgpr_read_b32 v54, a194
v_accvgpr_read_b32 v55, a195
v_accvgpr_read_b32 v56, a196
v_accvgpr_read_b32 v57, a197
v_accvgpr_read_b32 v58, a198
v_accvgpr_read_b32 v59, a199
v_accvgpr_read_b32 v60, a200
v_accvgpr_read_b32 v61, a201
v_accvgpr_read_b32 v62, a202
v_accvgpr_read_b32 v63, a203
v_accvgpr_read_b32 v64, a204
v_accvgpr_read_b32 v65, a205
v_accvgpr_read_b32 v66, a206
v_accvgpr_read_b32 v67, a207
v_accvgpr_read_b32 v68, a208
v_accvgpr_read_b32 v69, a209
v_accvgpr_read_b32 v70, a210
v_accvgpr_read_b32 v71, a211
s_waitcnt vmcnt(4)
s_barrier
s_cmp_lg_u32 s28, 0
s_cbranch_scc1 Lsg_29
buffer_atomic_add v12, v10, s[4:7], s92 offen sc1
Lsg_29:
s_mov_b64 exec, 0
s_cmp_eq_u32 s28, 0
s_cbranch_scc1 L_stub10
L_wret4:
s_mov_b64 exec, -1
s_cmp_lt_u32 s28, 2
s_cbranch_scc1 Lwd_30
s_add_u32 m0, s19, 0xa000
s_add_u32 s44, s50, 0x200a000
s_add_u32 s44, s44, s18
buffer_load_dwordx4 v1, s[4:7], s44 offen offset:0 sc1 lds
buffer_load_dwordx4 v1, s[4:7], s44 offen offset:1024 sc1 lds
buffer_load_dwordx4 v1, s[4:7], s44 offen offset:2048 sc1 lds
buffer_load_dwordx4 v1, s[4:7], s44 offen offset:3072 sc1 lds
s_add_u32 m0, s19, 0xc000
s_add_u32 s44, s50, 0x200c000
s_add_u32 s44, s44, s18
buffer_load_dwordx4 v1, s[4:7], s44 offen offset:0 sc1 lds
buffer_load_dwordx4 v1, s[4:7], s44 offen offset:1024 sc1 lds
buffer_load_dwordx4 v1, s[4:7], s44 offen offset:2048 sc1 lds
buffer_load_dwordx4 v1, s[4:7], s44 offen offset:3072 sc1 lds
s_add_u32 m0, s19, 0xe000
s_add_u32 s44, s50, 0x200e000
s_add_u32 s44, s44, s18
buffer_load_dwordx4 v1, s[4:7], s44 offen offset:0 sc1 lds
buffer_load_dwordx4 v1, s[4:7], s44 offen offset:1024 sc1 lds
buffer_load_dwordx4 v1, s[4:7], s44 offen offset:2048 sc1 lds
buffer_load_dwordx4 v1, s[4:7], s44 offen offset:3072 sc1 lds
s_add_u32 m0, s19, 0x10000
s_add_u32 s44, s50, 0x2010000
s_add_u32 s44, s44, s18
buffer_load_dwordx4 v1, s[4:7], s44 offen offset:0 sc1 lds
buffer_load_dwordx4 v1, s[4:7], s44 offen offset:1024 sc1 lds
buffer_load_dwordx4 v1, s[4:7], s44 offen offset:2048 sc1 lds
buffer_load_dwordx4 v1, s[4:7], s44 offen offset:3072 sc1 lds
s_add_u32 m0, s19, 0x12000
s_add_u32 s44, s50, 0x2012000
s_add_u32 s44, s44, s18
buffer_load_dwordx4 v1, s[4:7], s44 offen offset:0 sc1 lds
buffer_load_dwordx4 v1, s[4:7], s44 offen offset:1024 sc1 lds
buffer_load_dwordx4 v1, s[4:7], s44 offen offset:2048 sc1 lds
buffer_load_dwordx4 v1, s[4:7], s44 offen offset:3072 sc1 lds
s_add_u32 m0, s19, 0x14000
s_add_u32 s44, s50, 0x2014000
s_add_u32 s44, s44, s18
buffer_load_dwordx4 v1, s[4:7], s44 offen offset:0 sc1 lds
buffer_load_dwordx4 v1, s[4:7], s44 offen offset:1024 sc1 lds
buffer_load_dwordx4 v1, s[4:7], s44 offen offset:2048 sc1 lds
buffer_load_dwordx4 v1, s[4:7], s44 offen offset:3072 sc1 lds
s_add_u32 m0, s19, 0x16000
s_add_u32 s44, s50, 0x2016000
s_add_u32 s44, s44, s18
buffer_load_dwordx4 v1, s[4:7], s44 offen offset:0 sc1 lds
buffer_load_dwordx4 v1, s[4:7], s44 offen offset:1024 sc1 lds
buffer_load_dwordx4 v1, s[4:7], s44 offen offset:2048 sc1 lds
buffer_load_dwordx4 v1, s[4:7], s44 offen offset:3072 sc1 lds
s_add_u32 m0, s19, 0x18000
s_add_u32 s44, s50, 0x2018000
s_add_u32 s44, s44, s18
buffer_load_dwordx4 v1, s[4:7], s44 offen offset:0 sc1 lds
buffer_load_dwordx4 v1, s[4:7], s44 offen offset:1024 sc1 lds
buffer_load_dwordx4 v1, s[4:7], s44 offen offset:2048 sc1 lds
buffer_load_dwordx4 v1, s[4:7], s44 offen offset:3072 sc1 lds
Lwd_30:
s_cmp_lg_u32 s28, 1
s_cbranch_scc1 Lpo_33
s_add_u32 s36, s34, 0x50000
s_mov_b32 s37, 0
v_mov_b32 v11, 0
buffer_atomic_add v11, v251, s[4:7], s36 offen sc0 sc1
s_sleep 4
Lpoll_31:
v_mov_b32 v234, 0
buffer_atomic_add v234, v251, s[4:7], s36 offen sc0 sc1
s_waitcnt vmcnt(1)
v_readfirstlane_b32 s38, v11
s_nop 0
s_cmp_ge_u32 s38, 32
s_cbranch_scc1 Lpe_32
v_mov_b32 v11, 0
buffer_atomic_add v11, v251, s[4:7], s36 offen sc0 sc1
s_waitcnt vmcnt(1)
v_readfirstlane_b32 s38, v234
s_nop 0
s_cmp_ge_u32 s38, 32
s_cbranch_scc1 Lpe_32
s_add_u32 s37, s37, 1
s_cmp_lt_u32 s37, 0x80000
s_cbranch_scc1 Lpoll_31
s_waitcnt vmcnt(0)
Lpo_33:
s_waitcnt vmcnt(32) lgkmcnt(0)
s_cmp_ge_u32 s28, 2
s_cbranch_scc1 Lw_34
s_waitcnt vmcnt(0)
Lw_34:
Lpe_32:
s_barrier
s_add_u32 s94, s71, 0x20080
s_mov_b32 s35, s10
L_stub10:
s_cbranch_execz L_stub11
s_add_u32 s33, s35, 0x1000
buffer_load_dwordx4 a[0:3], v2, s[40:43], s35 offen offset:0 sc1
buffer_load_dwordx4 a[4:7], v2, s[40:43], s33 offen offset:0 sc1
buffer_load_dwordx4 a[8:11], v2, s[40:43], s35 offen offset:1024 sc1
buffer_load_dwordx4 a[12:15], v2, s[40:43], s33 offen offset:1024 sc1
buffer_load_dwordx4 a[16:19], v2, s[40:43], s35 offen offset:2048 sc1
buffer_load_dwordx4 a[20:23], v2, s[40:43], s33 offen offset:2048 sc1
buffer_load_dwordx4 a[24:27], v2, s[40:43], s35 offen offset:3072 sc1
buffer_load_dwordx4 a[28:31], v2, s[40:43], s33 offen offset:3072 sc1
s_add_u32 s35, s35, 0x4000
s_add_u32 s33, s33, 0x4000
buffer_load_dwordx4 a[32:35], v2, s[40:43], s35 offen offset:0 sc1
buffer_load_dwordx4 a[36:39], v2, s[40:43], s33 offen offset:0 sc1
buffer_load_dwordx4 a[40:43], v2, s[40:43], s35 offen offset:1024 sc1
buffer_load_dwordx4 a[44:47], v2, s[40:43], s33 offen offset:1024 sc1
buffer_load_dwordx4 a[48:51], v2, s[40:43], s35 offen offset:2048 sc1
buffer_load_dwordx4 a[52:55], v2, s[40:43], s33 offen offset:2048 sc1
buffer_load_dwordx4 a[56:59], v2, s[40:43], s35 offen offset:3072 sc1
buffer_load_dwordx4 a[60:63], v2, s[40:43], s33 offen offset:3072 sc1
s_add_u32 s35, s35, 0x4000
s_add_u32 s33, s33, 0x4000
v_add_u32 v5, 0, v1
ds_read_b128 a[96:99], v5 offset:2048
ds_read_b128 a[100:103], v5 offset:8192
ds_read_b128 a[104:107], v5 offset:3072
ds_read_b128 a[108:111], v5 offset:9216
ds_read_b128 a[112:115], v5 offset:4096
ds_read_b128 a[116:119], v5 offset:10240
s_waitcnt vmcnt(14) lgkmcnt(4)
v_mfma_f32_16x16x32_bf16 v[140:143], a[96:99], a[0:3], 0
s_add_u32 m0, s18, 0x1c000
s_add_u32 s44, s50, 0x201c000
v_mfma_f32_16x16x32_bf16 v[140:143], a[100:103], a[4:7], v[140:143]
buffer_load_dwordx4 a[64:67], v2, s[40:43], s35 offen offset:0 sc1
s_waitcnt vmcnt(13)
v_mfma_f32_16x16x32_bf16 v[164:167], a[100:103], a[12:15], 0
ds_read_b128 a[128:131], v5 offset:5120
v_mfma_f32_16x16x32_bf16 v[164:167], a[96:99], a[8:11], v[164:167]
ds_read_b128 a[132:135], v5 offset:11264
s_waitcnt vmcnt(12)
v_mfma_f32_16x16x32_bf16 v[188:191], a[96:99], a[16:19], 0
s_waitcnt vmcnt(11)
v_mfma_f32_16x16x32_bf16 v[188:191], a[100:103], a[20:23], v[188:191]
buffer_load_dwordx4 a[68:71], v2, s[40:43], s33 offen offset:0 sc1
s_waitcnt vmcnt(10)
v_mfma_f32_16x16x32_bf16 v[212:215], a[100:103], a[28:31], 0
ds_read_b128 a[136:139], v5 offset:0
v_mfma_f32_16x16x32_bf16 v[212:215], a[96:99], a[24:27], v[212:215]
s_waitcnt lgkmcnt(6)
v_mfma_f32_16x16x32_bf16 v[216:219], a[104:107], a[24:27], 0
ds_read_b128 a[140:143], v5 offset:6144
s_waitcnt lgkmcnt(6)
v_mfma_f32_16x16x32_bf16 v[216:219], a[108:111], a[28:31], v[216:219]
v_mfma_f32_16x16x32_bf16 v[192:195], a[108:111], a[20:23], 0
buffer_load_dwordx4 v1, s[4:7], s44 offen offset:0 sc1 lds
v_mfma_f32_16x16x32_bf16 v[192:195], a[104:107], a[16:19], v[192:195]
ds_read_b128 a[144:147], v5 offset:1024
v_mfma_f32_16x16x32_bf16 v[168:171], a[104:107], a[8:11], 0
v_mfma_f32_16x16x32_bf16 v[168:171], a[108:111], a[12:15], v[168:171]
ds_read_b128 a[148:151], v5 offset:7168
v_mfma_f32_16x16x32_bf16 v[144:147], a[108:111], a[4:7], 0
v_mfma_f32_16x16x32_bf16 v[144:147], a[104:107], a[0:3], v[144:147]
buffer_load_dwordx4 a[72:75], v2, s[40:43], s35 offen offset:1024 sc1
s_waitcnt lgkmcnt(7)
v_mfma_f32_16x16x32_bf16 v[148:151], a[112:115], a[0:3], 0
s_waitcnt lgkmcnt(6)
v_mfma_f32_16x16x32_bf16 v[148:151], a[116:119], a[4:7], v[148:151]
v_mfma_f32_16x16x32_bf16 v[172:175], a[116:119], a[12:15], 0
v_mfma_f32_16x16x32_bf16 v[172:175], a[112:115], a[8:11], v[172:175]
v_mfma_f32_16x16x32_bf16 v[196:199], a[112:115], a[16:19], 0
buffer_load_dwordx4 a[76:79], v2, s[40:43], s33 offen offset:1024 sc1
v_mfma_f32_16x16x32_bf16 v[196:199], a[116:119], a[20:23], v[196:199]
v_mfma_f32_16x16x32_bf16 v[220:223], a[116:119], a[28:31], 0
v_mfma_f32_16x16x32_bf16 v[220:223], a[112:115], a[24:27], v[220:223]
s_waitcnt lgkmcnt(0)
v_mfma_f32_16x16x32_bf16 v[224:227], a[128:131], a[24:27], 0
ds_read_b128 a[96:99], v5 offset:14336
v_mfma_f32_16x16x32_bf16 v[224:227], a[132:135], a[28:31], v[224:227]
buffer_load_dwordx4 a[80:83], v2, s[40:43], s35 offen offset:2048 sc1
v_mfma_f32_16x16x32_bf16 v[200:203], a[132:135], a[20:23], 0
ds_read_b128 a[100:103], v5 offset:20480
v_mfma_f32_16x16x32_bf16 v[200:203], a[128:131], a[16:19], v[200:203]
v_mfma_f32_16x16x32_bf16 v[176:179], a[128:131], a[8:11], 0
v_mfma_f32_16x16x32_bf16 v[176:179], a[132:135], a[12:15], v[176:179]
buffer_load_dwordx4 a[84:87], v2, s[40:43], s33 offen offset:2048 sc1
v_mfma_f32_16x16x32_bf16 v[152:155], a[132:135], a[4:7], 0
ds_read_b128 a[104:107], v5 offset:15360
v_mfma_f32_16x16x32_bf16 v[152:155], a[128:131], a[0:3], v[152:155]
v_mfma_f32_16x16x32_bf16 v[132:135], a[136:139], a[0:3], 0
ds_read_b128 a[108:111], v5 offset:21504
v_mfma_f32_16x16x32_bf16 v[132:135], a[140:143], a[4:7], v[132:135]
v_mfma_f32_16x16x32_bf16 v[156:159], a[140:143], a[12:15], 0
buffer_load_dwordx4 v1, s[4:7], s44 offen offset:1024 sc1 lds
s_add_u32 m0, s18, 0x1e000
v_mfma_f32_16x16x32_bf16 v[156:159], a[136:139], a[8:11], v[156:159]
s_add_u32 s44, s50, 0x201e000
ds_read_b128 a[112:115], v5 offset:16384
v_mfma_f32_16x16x32_bf16 v[180:183], a[136:139], a[16:19], 0
v_mfma_f32_16x16x32_bf16 v[180:183], a[140:143], a[20:23], v[180:183]
ds_read_b128 a[116:119], v5 offset:22528
v_mfma_f32_16x16x32_bf16 v[204:207], a[140:143], a[28:31], 0
v_mfma_f32_16x16x32_bf16 v[204:207], a[136:139], a[24:27], v[204:207]
buffer_load_dwordx4 a[88:91], v2, s[40:43], s35 offen offset:3072 sc1
v_mfma_f32_16x16x32_bf16 v[208:211], a[144:147], a[24:27], 0
v_mfma_f32_16x16x32_bf16 v[208:211], a[148:151], a[28:31], v[208:211]
v_mfma_f32_16x16x32_bf16 v[184:187], a[148:151], a[20:23], 0
v_mfma_f32_16x16x32_bf16 v[184:187], a[144:147], a[16:19], v[184:187]
v_mfma_f32_16x16x32_bf16 v[160:163], a[144:147], a[8:11], 0
buffer_load_dwordx4 a[92:95], v2, s[40:43], s33 offen offset:3072 sc1
s_add_u32 s35, s35, 0x4000
v_mfma_f32_16x16x32_bf16 v[160:163], a[148:151], a[12:15], v[160:163]
s_add_u32 s33, s33, 0x4000
v_mfma_f32_16x16x32_bf16 v[136:139], a[148:151], a[4:7], 0
v_mfma_f32_16x16x32_bf16 v[136:139], a[144:147], a[0:3], v[136:139]
s_waitcnt vmcnt(10) lgkmcnt(0)
v_mfma_f32_16x16x32_bf16 v[140:143], a[96:99], a[32:35], v[140:143]
ds_read_b128 a[128:131], v5 offset:17408
v_mfma_f32_16x16x32_bf16 v[140:143], a[100:103], a[36:39], v[140:143]
buffer_load_dwordx4 a[0:3], v2, s[40:43], s35 offen offset:0 sc1
v_mfma_f32_16x16x32_bf16 v[164:167], a[100:103], a[44:47], v[164:167]
ds_read_b128 a[132:135], v5 offset:23552
v_mfma_f32_16x16x32_bf16 v[164:167], a[96:99], a[40:43], v[164:167]
v_mfma_f32_16x16x32_bf16 v[188:191], a[96:99], a[48:51], v[188:191]
v_mfma_f32_16x16x32_bf16 v[188:191], a[100:103], a[52:55], v[188:191]
buffer_load_dwordx4 a[4:7], v2, s[40:43], s33 offen offset:0 sc1
v_mfma_f32_16x16x32_bf16 v[212:215], a[100:103], a[60:63], v[212:215]
ds_read_b128 a[136:139], v5 offset:12288
v_mfma_f32_16x16x32_bf16 v[212:215], a[96:99], a[56:59], v[212:215]
v_mfma_f32_16x16x32_bf16 v[216:219], a[104:107], a[56:59], v[216:219]
ds_read_b128 a[140:143], v5 offset:18432
v_mfma_f32_16x16x32_bf16 v[216:219], a[108:111], a[60:63], v[216:219]
v_mfma_f32_16x16x32_bf16 v[192:195], a[108:111], a[52:55], v[192:195]
buffer_load_dwordx4 v1, s[4:7], s44 offen offset:0 sc1 lds
v_mfma_f32_16x16x32_bf16 v[192:195], a[104:107], a[48:51], v[192:195]
ds_read_b128 a[144:147], v5 offset:13312
v_mfma_f32_16x16x32_bf16 v[168:171], a[104:107], a[40:43], v[168:171]
v_mfma_f32_16x16x32_bf16 v[168:171], a[108:111], a[44:47], v[168:171]
ds_read_b128 a[148:151], v5 offset:19456
v_mfma_f32_16x16x32_bf16 v[144:147], a[108:111], a[36:39], v[144:147]
v_mfma_f32_16x16x32_bf16 v[144:147], a[104:107], a[32:35], v[144:147]
buffer_load_dwordx4 a[8:11], v2, s[40:43], s35 offen offset:1024 sc1
v_mfma_f32_16x16x32_bf16 v[148:151], a[112:115], a[32:35], v[148:151]
v_mfma_f32_16x16x32_bf16 v[148:151], a[116:119], a[36:39], v[148:151]
v_mfma_f32_16x16x32_bf16 v[172:175], a[116:119], a[44:47], v[172:175]
v_mfma_f32_16x16x32_bf16 v[172:175], a[112:115], a[40:43], v[172:175]
v_mfma_f32_16x16x32_bf16 v[196:199], a[112:115], a[48:51], v[196:199]
buffer_load_dwordx4 a[12:15], v2, s[40:43], s33 offen offset:1024 sc1
v_mfma_f32_16x16x32_bf16 v[196:199], a[116:119], a[52:55], v[196:199]
v_mfma_f32_16x16x32_bf16 v[220:223], a[116:119], a[60:63], v[220:223]
v_mfma_f32_16x16x32_bf16 v[220:223], a[112:115], a[56:59], v[220:223]
s_waitcnt lgkmcnt(0)
v_mfma_f32_16x16x32_bf16 v[224:227], a[128:131], a[56:59], v[224:227]
ds_read_b128 a[96:99], v5 offset:26624
v_mfma_f32_16x16x32_bf16 v[224:227], a[132:135], a[60:63], v[224:227]
buffer_load_dwordx4 a[16:19], v2, s[40:43], s35 offen offset:2048 sc1
v_mfma_f32_16x16x32_bf16 v[200:203], a[132:135], a[52:55], v[200:203]
ds_read_b128 a[100:103], v5 offset:32768
v_mfma_f32_16x16x32_bf16 v[200:203], a[128:131], a[48:51], v[200:203]
v_mfma_f32_16x16x32_bf16 v[176:179], a[128:131], a[40:43], v[176:179]
v_mfma_f32_16x16x32_bf16 v[176:179], a[132:135], a[44:47], v[176:179]
buffer_load_dwordx4 v1, s[4:7], s44 offen offset:1024 sc1 lds
s_add_u32 m0, s18, 0x20000
v_mfma_f32_16x16x32_bf16 v[152:155], a[132:135], a[36:39], v[152:155]
s_add_u32 s44, s50, 0x2020000
ds_read_b128 a[104:107], v5 offset:27648
v_mfma_f32_16x16x32_bf16 v[152:155], a[128:131], a[32:35], v[152:155]
v_mfma_f32_16x16x32_bf16 v[132:135], a[136:139], a[32:35], v[132:135]
ds_read_b128 a[108:111], v5 offset:33792
v_mfma_f32_16x16x32_bf16 v[132:135], a[140:143], a[36:39], v[132:135]
buffer_load_dwordx4 a[20:23], v2, s[40:43], s33 offen offset:2048 sc1
v_mfma_f32_16x16x32_bf16 v[156:159], a[140:143], a[44:47], v[156:159]
ds_read_b128 a[112:115], v5 offset:28672
v_mfma_f32_16x16x32_bf16 v[156:159], a[136:139], a[40:43], v[156:159]
v_mfma_f32_16x16x32_bf16 v[180:183], a[136:139], a[48:51], v[180:183]
v_mfma_f32_16x16x32_bf16 v[180:183], a[140:143], a[52:55], v[180:183]
buffer_load_dwordx4 a[24:27], v2, s[40:43], s35 offen offset:3072 sc1
v_mfma_f32_16x16x32_bf16 v[204:207], a[140:143], a[60:63], v[204:207]
ds_read_b128 a[116:119], v5 offset:34816
v_mfma_f32_16x16x32_bf16 v[204:207], a[136:139], a[56:59], v[204:207]
v_mfma_f32_16x16x32_bf16 v[208:211], a[144:147], a[56:59], v[208:211]
v_mfma_f32_16x16x32_bf16 v[208:211], a[148:151], a[60:63], v[208:211]
buffer_load_dwordx4 v1, s[4:7], s44 offen offset:0 sc1 lds
v_mfma_f32_16x16x32_bf16 v[184:187], a[148:151], a[52:55], v[184:187]
v_mfma_f32_16x16x32_bf16 v[184:187], a[144:147], a[48:51], v[184:187]
v_mfma_f32_16x16x32_bf16 v[160:163], a[144:147], a[40:43], v[160:163]
v_mfma_f32_16x16x32_bf16 v[160:163], a[148:151], a[44:47], v[160:163]
buffer_load_dwordx4 a[28:31], v2, s[40:43], s33 offen offset:3072 sc1
s_add_u32 s35, s35, 0x4000
v_mfma_f32_16x16x32_bf16 v[136:139], a[148:151], a[36:39], v[136:139]
s_add_u32 s33, s33, 0x4000
v_mfma_f32_16x16x32_bf16 v[136:139], a[144:147], a[32:35], v[136:139]
s_waitcnt vmcnt(11) lgkmcnt(0)
v_mfma_f32_16x16x32_bf16 v[140:143], a[96:99], a[64:67], v[140:143]
ds_read_b128 a[128:131], v5 offset:29696
v_mfma_f32_16x16x32_bf16 v[140:143], a[100:103], a[68:71], v[140:143]
buffer_load_dwordx4 a[32:35], v2, s[40:43], s35 offen offset:0 sc1
v_mfma_f32_16x16x32_bf16 v[164:167], a[100:103], a[76:79], v[164:167]
ds_read_b128 a[132:135], v5 offset:35840
v_mfma_f32_16x16x32_bf16 v[164:167], a[96:99], a[72:75], v[164:167]
v_mfma_f32_16x16x32_bf16 v[188:191], a[96:99], a[80:83], v[188:191]
v_mfma_f32_16x16x32_bf16 v[188:191], a[100:103], a[84:87], v[188:191]
buffer_load_dwordx4 a[36:39], v2, s[40:43], s33 offen offset:0 sc1
v_mfma_f32_16x16x32_bf16 v[212:215], a[100:103], a[92:95], v[212:215]
ds_read_b128 a[136:139], v5 offset:24576
v_mfma_f32_16x16x32_bf16 v[212:215], a[96:99], a[88:91], v[212:215]
v_mfma_f32_16x16x32_bf16 v[216:219], a[104:107], a[88:91], v[216:219]
ds_read_b128 a[140:143], v5 offset:30720
v_mfma_f32_16x16x32_bf16 v[216:219], a[108:111], a[92:95], v[216:219]
v_mfma_f32_16x16x32_bf16 v[192:195], a[108:111], a[84:87], v[192:195]
buffer_load_dwordx4 v1, s[4:7], s44 offen offset:1024 sc1 lds
s_add_u32 m0, s18, 0x22000
v_mfma_f32_16x16x32_bf16 v[192:195], a[104:107], a[80:83], v[192:195]
s_add_u32 s44, s50, 0x2022000
ds_read_b128 a[144:147], v5 offset:25600
v_mfma_f32_16x16x32_bf16 v[168:171], a[104:107], a[72:75], v[168:171]
v_mfma_f32_16x16x32_bf16 v[168:171], a[108:111], a[76:79], v[168:171]
ds_read_b128 a[148:151], v5 offset:31744
v_mfma_f32_16x16x32_bf16 v[144:147], a[108:111], a[68:71], v[144:147]
v_mfma_f32_16x16x32_bf16 v[144:147], a[104:107], a[64:67], v[144:147]
buffer_load_dwordx4 a[40:43], v2, s[40:43], s35 offen offset:1024 sc1
v_mfma_f32_16x16x32_bf16 v[148:151], a[112:115], a[64:67], v[148:151]
v_mfma_f32_16x16x32_bf16 v[148:151], a[116:119], a[68:71], v[148:151]
v_mfma_f32_16x16x32_bf16 v[172:175], a[116:119], a[76:79], v[172:175]
v_mfma_f32_16x16x32_bf16 v[172:175], a[112:115], a[72:75], v[172:175]
v_mfma_f32_16x16x32_bf16 v[196:199], a[112:115], a[80:83], v[196:199]
buffer_load_dwordx4 a[44:47], v2, s[40:43], s33 offen offset:1024 sc1
v_mfma_f32_16x16x32_bf16 v[196:199], a[116:119], a[84:87], v[196:199]
v_mfma_f32_16x16x32_bf16 v[220:223], a[116:119], a[92:95], v[220:223]
v_mfma_f32_16x16x32_bf16 v[220:223], a[112:115], a[88:91], v[220:223]
s_waitcnt lgkmcnt(0)
v_mfma_f32_16x16x32_bf16 v[224:227], a[128:131], a[88:91], v[224:227]
ds_read_b128 a[96:99], v5 offset:38912
v_mfma_f32_16x16x32_bf16 v[224:227], a[132:135], a[92:95], v[224:227]
buffer_load_dwordx4 a[48:51], v2, s[40:43], s35 offen offset:2048 sc1
v_mfma_f32_16x16x32_bf16 v[200:203], a[132:135], a[84:87], v[200:203]
ds_read_b128 a[100:103], v5 offset:45056
v_mfma_f32_16x16x32_bf16 v[200:203], a[128:131], a[80:83], v[200:203]
v_mfma_f32_16x16x32_bf16 v[176:179], a[128:131], a[72:75], v[176:179]
v_mfma_f32_16x16x32_bf16 v[176:179], a[132:135], a[76:79], v[176:179]
buffer_load_dwordx4 a[52:55], v2, s[40:43], s33 offen offset:2048 sc1
v_mfma_f32_16x16x32_bf16 v[152:155], a[132:135], a[68:71], v[152:155]
ds_read_b128 a[104:107], v5 offset:39936
v_mfma_f32_16x16x32_bf16 v[152:155], a[128:131], a[64:67], v[152:155]
v_mfma_f32_16x16x32_bf16 v[132:135], a[136:139], a[64:67], v[132:135]
ds_read_b128 a[108:111], v5 offset:46080
v_mfma_f32_16x16x32_bf16 v[132:135], a[140:143], a[68:71], v[132:135]
v_mfma_f32_16x16x32_bf16 v[156:159], a[140:143], a[76:79], v[156:159]
buffer_load_dwordx4 v1, s[4:7], s44 offen offset:0 sc1 lds
v_mfma_f32_16x16x32_bf16 v[156:159], a[136:139], a[72:75], v[156:159]
ds_read_b128 a[112:115], v5 offset:40960
v_mfma_f32_16x16x32_bf16 v[180:183], a[136:139], a[80:83], v[180:183]
v_mfma_f32_16x16x32_bf16 v[180:183], a[140:143], a[84:87], v[180:183]
ds_read_b128 a[116:119], v5 offset:47104
v_mfma_f32_16x16x32_bf16 v[204:207], a[140:143], a[92:95], v[204:207]
v_mfma_f32_16x16x32_bf16 v[204:207], a[136:139], a[88:91], v[204:207]
buffer_load_dwordx4 a[56:59], v2, s[40:43], s35 offen offset:3072 sc1
v_mfma_f32_16x16x32_bf16 v[208:211], a[144:147], a[88:91], v[208:211]
v_mfma_f32_16x16x32_bf16 v[208:211], a[148:151], a[92:95], v[208:211]
v_mfma_f32_16x16x32_bf16 v[184:187], a[148:151], a[84:87], v[184:187]
v_mfma_f32_16x16x32_bf16 v[184:187], a[144:147], a[80:83], v[184:187]
v_mfma_f32_16x16x32_bf16 v[160:163], a[144:147], a[72:75], v[160:163]
buffer_load_dwordx4 a[60:63], v2, s[40:43], s33 offen offset:3072 sc1
s_add_u32 s35, s35, 0x4000
v_mfma_f32_16x16x32_bf16 v[160:163], a[148:151], a[76:79], v[160:163]
s_add_u32 s33, s33, 0x4000
v_mfma_f32_16x16x32_bf16 v[136:139], a[148:151], a[68:71], v[136:139]
v_mfma_f32_16x16x32_bf16 v[136:139], a[144:147], a[64:67], v[136:139]
s_waitcnt vmcnt(10) lgkmcnt(0)
v_mfma_f32_16x16x32_bf16 v[140:143], a[96:99], a[0:3], v[140:143]
ds_read_b128 a[128:131], v5 offset:41984
v_mfma_f32_16x16x32_bf16 v[140:143], a[100:103], a[4:7], v[140:143]
buffer_load_dwordx4 a[64:67], v2, s[40:43], s35 offen offset:0 sc1
v_mfma_f32_16x16x32_bf16 v[164:167], a[100:103], a[12:15], v[164:167]
ds_read_b128 a[132:135], v5 offset:48128
v_mfma_f32_16x16x32_bf16 v[164:167], a[96:99], a[8:11], v[164:167]
v_mfma_f32_16x16x32_bf16 v[188:191], a[96:99], a[16:19], v[188:191]
v_mfma_f32_16x16x32_bf16 v[188:191], a[100:103], a[20:23], v[188:191]
buffer_load_dwordx4 a[68:71], v2, s[40:43], s33 offen offset:0 sc1
v_mfma_f32_16x16x32_bf16 v[212:215], a[100:103], a[28:31], v[212:215]
ds_read_b128 a[136:139], v5 offset:36864
v_mfma_f32_16x16x32_bf16 v[212:215], a[96:99], a[24:27], v[212:215]
v_mfma_f32_16x16x32_bf16 v[216:219], a[104:107], a[24:27], v[216:219]
ds_read_b128 a[140:143], v5 offset:43008
v_mfma_f32_16x16x32_bf16 v[216:219], a[108:111], a[28:31], v[216:219]
v_mfma_f32_16x16x32_bf16 v[192:195], a[108:111], a[20:23], v[192:195]
buffer_load_dwordx4 v1, s[4:7], s44 offen offset:1024 sc1 lds
s_add_u32 s88, s82, 0x340000
v_mfma_f32_16x16x32_bf16 v[192:195], a[104:107], a[16:19], v[192:195]
ds_read_b128 a[144:147], v5 offset:37888
v_mfma_f32_16x16x32_bf16 v[168:171], a[104:107], a[8:11], v[168:171]
v_mfma_f32_16x16x32_bf16 v[168:171], a[108:111], a[12:15], v[168:171]
ds_read_b128 a[148:151], v5 offset:44032
v_mfma_f32_16x16x32_bf16 v[144:147], a[108:111], a[4:7], v[144:147]
v_mfma_f32_16x16x32_bf16 v[144:147], a[104:107], a[0:3], v[144:147]
buffer_load_dwordx4 a[72:75], v2, s[40:43], s35 offen offset:1024 sc1
v_mfma_f32_16x16x32_bf16 v[148:151], a[112:115], a[0:3], v[148:151]
v_mfma_f32_16x16x32_bf16 v[148:151], a[116:119], a[4:7], v[148:151]
v_mfma_f32_16x16x32_bf16 v[172:175], a[116:119], a[12:15], v[172:175]
v_mfma_f32_16x16x32_bf16 v[172:175], a[112:115], a[8:11], v[172:175]
v_mfma_f32_16x16x32_bf16 v[196:199], a[112:115], a[16:19], v[196:199]
buffer_load_dwordx4 a[76:79], v2, s[40:43], s33 offen offset:1024 sc1
v_mfma_f32_16x16x32_bf16 v[196:199], a[116:119], a[20:23], v[196:199]
v_mfma_f32_16x16x32_bf16 v[220:223], a[116:119], a[28:31], v[220:223]
v_mfma_f32_16x16x32_bf16 v[220:223], a[112:115], a[24:27], v[220:223]
s_waitcnt lgkmcnt(0)
s_barrier
v_mfma_f32_16x16x32_bf16 v[224:227], a[128:131], a[24:27], v[224:227]
v_add_u32 v5, 49152, v1
v_mfma_f32_16x16x32_bf16 v[224:227], a[132:135], a[28:31], v[224:227]
buffer_load_dwordx4 a[80:83], v2, s[40:43], s35 offen offset:2048 sc1
v_mfma_f32_16x16x32_bf16 v[200:203], a[132:135], a[20:23], v[200:203]
ds_read_b128 a[96:99], v5 offset:2048
v_mfma_f32_16x16x32_bf16 v[200:203], a[128:131], a[16:19], v[200:203]
ds_read_b128 a[100:103], v5 offset:8192
v_mfma_f32_16x16x32_bf16 v[176:179], a[128:131], a[8:11], v[176:179]
v_mfma_f32_16x16x32_bf16 v[176:179], a[132:135], a[12:15], v[176:179]
buffer_load_dwordx4 a[84:87], v2, s[40:43], s33 offen offset:2048 sc1
v_mfma_f32_16x16x32_bf16 v[152:155], a[132:135], a[4:7], v[152:155]
ds_read_b128 a[104:107], v5 offset:3072
v_mfma_f32_16x16x32_bf16 v[152:155], a[128:131], a[0:3], v[152:155]
v_mfma_f32_16x16x32_bf16 v[132:135], a[136:139], a[0:3], v[132:135]
ds_read_b128 a[108:111], v5 offset:9216
v_mfma_f32_16x16x32_bf16 v[132:135], a[140:143], a[4:7], v[132:135]
v_mfma_f32_16x16x32_bf16 v[156:159], a[140:143], a[12:15], v[156:159]
buffer_load_dwordx4 v[92:95], v1, s[4:7], s88 offen offset:0 sc1
v_mfma_f32_16x16x32_bf16 v[156:159], a[136:139], a[8:11], v[156:159]
ds_read_b128 a[112:115], v5 offset:4096
v_mfma_f32_16x16x32_bf16 v[180:183], a[136:139], a[16:19], v[180:183]
v_mfma_f32_16x16x32_bf16 v[180:183], a[140:143], a[20:23], v[180:183]
ds_read_b128 a[116:119], v5 offset:10240
v_mfma_f32_16x16x32_bf16 v[204:207], a[140:143], a[28:31], v[204:207]
v_mfma_f32_16x16x32_bf16 v[204:207], a[136:139], a[24:27], v[204:207]
buffer_load_dwordx4 a[88:91], v2, s[40:43], s35 offen offset:3072 sc1
v_mfma_f32_16x16x32_bf16 v[208:211], a[144:147], a[24:27], v[208:211]
v_mfma_f32_16x16x32_bf16 v[208:211], a[148:151], a[28:31], v[208:211]
v_mfma_f32_16x16x32_bf16 v[184:187], a[148:151], a[20:23], v[184:187]
v_mfma_f32_16x16x32_bf16 v[184:187], a[144:147], a[16:19], v[184:187]
v_mfma_f32_16x16x32_bf16 v[160:163], a[144:147], a[8:11], v[160:163]
buffer_load_dwordx4 a[92:95], v2, s[40:43], s33 offen offset:3072 sc1
s_add_u32 s35, s35, 0x4000
v_mfma_f32_16x16x32_bf16 v[160:163], a[148:151], a[12:15], v[160:163]
s_add_u32 s33, s33, 0x4000
v_mfma_f32_16x16x32_bf16 v[136:139], a[148:151], a[4:7], v[136:139]
v_mfma_f32_16x16x32_bf16 v[136:139], a[144:147], a[0:3], v[136:139]
s_waitcnt vmcnt(10) lgkmcnt(0)
v_mfma_f32_16x16x32_bf16 v[140:143], a[96:99], a[32:35], v[140:143]
ds_read_b128 a[128:131], v5 offset:5120
v_mfma_f32_16x16x32_bf16 v[140:143], a[100:103], a[36:39], v[140:143]
buffer_load_dwordx4 a[0:3], v2, s[40:43], s35 offen offset:0 sc1
v_mfma_f32_16x16x32_bf16 v[164:167], a[100:103], a[44:47], v[164:167]
ds_read_b128 a[132:135], v5 offset:11264
v_mfma_f32_16x16x32_bf16 v[164:167], a[96:99], a[40:43], v[164:167]
v_mfma_f32_16x16x32_bf16 v[188:191], a[96:99], a[48:51], v[188:191]
v_mfma_f32_16x16x32_bf16 v[188:191], a[100:103], a[52:55], v[188:191]
buffer_load_dwordx4 a[4:7], v2, s[40:43], s33 offen offset:0 sc1
v_mfma_f32_16x16x32_bf16 v[212:215], a[100:103], a[60:63], v[212:215]
ds_read_b128 a[136:139], v5 offset:0
v_mfma_f32_16x16x32_bf16 v[212:215], a[96:99], a[56:59], v[212:215]
v_mfma_f32_16x16x32_bf16 v[216:219], a[104:107], a[56:59], v[216:219]
ds_read_b128 a[140:143], v5 offset:6144
v_mfma_f32_16x16x32_bf16 v[216:219], a[108:111], a[60:63], v[216:219]
v_mfma_f32_16x16x32_bf16 v[192:195], a[108:111], a[52:55], v[192:195]
buffer_load_dwordx4 v[96:99], v1, s[4:7], s88 offen offset:1024 sc1
v_mfma_f32_16x16x32_bf16 v[192:195], a[104:107], a[48:51], v[192:195]
ds_read_b128 a[144:147], v5 offset:1024
v_mfma_f32_16x16x32_bf16 v[168:171], a[104:107], a[40:43], v[168:171]
v_mfma_f32_16x16x32_bf16 v[168:171], a[108:111], a[44:47], v[168:171]
ds_read_b128 a[148:151], v5 offset:7168
v_mfma_f32_16x16x32_bf16 v[144:147], a[108:111], a[36:39], v[144:147]
v_mfma_f32_16x16x32_bf16 v[144:147], a[104:107], a[32:35], v[144:147]
buffer_load_dwordx4 a[8:11], v2, s[40:43], s35 offen offset:1024 sc1
v_mfma_f32_16x16x32_bf16 v[148:151], a[112:115], a[32:35], v[148:151]
v_mfma_f32_16x16x32_bf16 v[148:151], a[116:119], a[36:39], v[148:151]
v_mfma_f32_16x16x32_bf16 v[172:175], a[116:119], a[44:47], v[172:175]
v_mfma_f32_16x16x32_bf16 v[172:175], a[112:115], a[40:43], v[172:175]
v_mfma_f32_16x16x32_bf16 v[196:199], a[112:115], a[48:51], v[196:199]
buffer_load_dwordx4 a[12:15], v2, s[40:43], s33 offen offset:1024 sc1
v_mfma_f32_16x16x32_bf16 v[196:199], a[116:119], a[52:55], v[196:199]
v_mfma_f32_16x16x32_bf16 v[220:223], a[116:119], a[60:63], v[220:223]
v_mfma_f32_16x16x32_bf16 v[220:223], a[112:115], a[56:59], v[220:223]
s_waitcnt lgkmcnt(0)
v_mfma_f32_16x16x32_bf16 v[224:227], a[128:131], a[56:59], v[224:227]
ds_read_b128 a[96:99], v5 offset:14336
v_mfma_f32_16x16x32_bf16 v[224:227], a[132:135], a[60:63], v[224:227]
buffer_load_dwordx4 a[16:19], v2, s[40:43], s35 offen offset:2048 sc1
v_mfma_f32_16x16x32_bf16 v[200:203], a[132:135], a[52:55], v[200:203]
ds_read_b128 a[100:103], v5 offset:20480
v_mfma_f32_16x16x32_bf16 v[200:203], a[128:131], a[48:51], v[200:203]
v_mfma_f32_16x16x32_bf16 v[176:179], a[128:131], a[40:43], v[176:179]
v_mfma_f32_16x16x32_bf16 v[176:179], a[132:135], a[44:47], v[176:179]
buffer_load_dwordx4 v[100:103], v1, s[4:7], s88 offen offset:2048 sc1
v_mfma_f32_16x16x32_bf16 v[152:155], a[132:135], a[36:39], v[152:155]
ds_read_b128 a[104:107], v5 offset:15360
v_mfma_f32_16x16x32_bf16 v[152:155], a[128:131], a[32:35], v[152:155]
v_mfma_f32_16x16x32_bf16 v[132:135], a[136:139], a[32:35], v[132:135]
ds_read_b128 a[108:111], v5 offset:21504
v_mfma_f32_16x16x32_bf16 v[132:135], a[140:143], a[36:39], v[132:135]
buffer_load_dwordx4 a[20:23], v2, s[40:43], s33 offen offset:2048 sc1
v_mfma_f32_16x16x32_bf16 v[156:159], a[140:143], a[44:47], v[156:159]
ds_read_b128 a[112:115], v5 offset:16384
v_mfma_f32_16x16x32_bf16 v[156:159], a[136:139], a[40:43], v[156:159]
v_mfma_f32_16x16x32_bf16 v[180:183], a[136:139], a[48:51], v[180:183]
v_mfma_f32_16x16x32_bf16 v[180:183], a[140:143], a[52:55], v[180:183]
buffer_load_dwordx4 a[24:27], v2, s[40:43], s35 offen offset:3072 sc1
v_mfma_f32_16x16x32_bf16 v[204:207], a[140:143], a[60:63], v[204:207]
ds_read_b128 a[116:119], v5 offset:22528
v_mfma_f32_16x16x32_bf16 v[204:207], a[136:139], a[56:59], v[204:207]
v_mfma_f32_16x16x32_bf16 v[208:211], a[144:147], a[56:59], v[208:211]
v_mfma_f32_16x16x32_bf16 v[208:211], a[148:151], a[60:63], v[208:211]
buffer_load_dwordx4 v[104:107], v1, s[4:7], s88 offen offset:3072 sc1
s_add_u32 s88, s88, 4096
v_mfma_f32_16x16x32_bf16 v[184:187], a[148:151], a[52:55], v[184:187]
v_mfma_f32_16x16x32_bf16 v[184:187], a[144:147], a[48:51], v[184:187]
v_mfma_f32_16x16x32_bf16 v[160:163], a[144:147], a[40:43], v[160:163]
v_mfma_f32_16x16x32_bf16 v[160:163], a[148:151], a[44:47], v[160:163]
buffer_load_dwordx4 a[28:31], v2, s[40:43], s33 offen offset:3072 sc1
s_add_u32 s35, s35, 0x4000
v_mfma_f32_16x16x32_bf16 v[136:139], a[148:151], a[36:39], v[136:139]
s_add_u32 s33, s33, 0x4000
v_mfma_f32_16x16x32_bf16 v[136:139], a[144:147], a[32:35], v[136:139]
s_waitcnt vmcnt(11) lgkmcnt(0)
v_mfma_f32_16x16x32_bf16 v[140:143], a[96:99], a[64:67], v[140:143]
ds_read_b128 a[128:131], v5 offset:17408
v_mfma_f32_16x16x32_bf16 v[140:143], a[100:103], a[68:71], v[140:143]
buffer_load_dwordx4 a[32:35], v2, s[40:43], s35 offen offset:0 sc1
v_mfma_f32_16x16x32_bf16 v[164:167], a[100:103], a[76:79], v[164:167]
ds_read_b128 a[132:135], v5 offset:23552
v_mfma_f32_16x16x32_bf16 v[164:167], a[96:99], a[72:75], v[164:167]
v_mfma_f32_16x16x32_bf16 v[188:191], a[96:99], a[80:83], v[188:191]
v_mfma_f32_16x16x32_bf16 v[188:191], a[100:103], a[84:87], v[188:191]
buffer_load_dwordx4 a[36:39], v2, s[40:43], s33 offen offset:0 sc1
v_mfma_f32_16x16x32_bf16 v[212:215], a[100:103], a[92:95], v[212:215]
ds_read_b128 a[136:139], v5 offset:12288
v_mfma_f32_16x16x32_bf16 v[212:215], a[96:99], a[88:91], v[212:215]
v_mfma_f32_16x16x32_bf16 v[216:219], a[104:107], a[88:91], v[216:219]
ds_read_b128 a[140:143], v5 offset:18432
v_mfma_f32_16x16x32_bf16 v[216:219], a[108:111], a[92:95], v[216:219]
v_mfma_f32_16x16x32_bf16 v[192:195], a[108:111], a[84:87], v[192:195]
buffer_load_dwordx4 v[108:111], v1, s[4:7], s88 offen offset:0 sc1
v_mfma_f32_16x16x32_bf16 v[192:195], a[104:107], a[80:83], v[192:195]
ds_read_b128 a[144:147], v5 offset:13312
v_mfma_f32_16x16x32_bf16 v[168:171], a[104:107], a[72:75], v[168:171]
v_mfma_f32_16x16x32_bf16 v[168:171], a[108:111], a[76:79], v[168:171]
ds_read_b128 a[148:151], v5 offset:19456
v_mfma_f32_16x16x32_bf16 v[144:147], a[108:111], a[68:71], v[144:147]
v_mfma_f32_16x16x32_bf16 v[144:147], a[104:107], a[64:67], v[144:147]
buffer_load_dwordx4 a[40:43], v2, s[40:43], s35 offen offset:1024 sc1
v_mfma_f32_16x16x32_bf16 v[148:151], a[112:115], a[64:67], v[148:151]
v_mfma_f32_16x16x32_bf16 v[148:151], a[116:119], a[68:71], v[148:151]
v_mfma_f32_16x16x32_bf16 v[172:175], a[116:119], a[76:79], v[172:175]
v_mfma_f32_16x16x32_bf16 v[172:175], a[112:115], a[72:75], v[172:175]
v_mfma_f32_16x16x32_bf16 v[196:199], a[112:115], a[80:83], v[196:199]
buffer_load_dwordx4 a[44:47], v2, s[40:43], s33 offen offset:1024 sc1
v_mfma_f32_16x16x32_bf16 v[196:199], a[116:119], a[84:87], v[196:199]
v_mfma_f32_16x16x32_bf16 v[220:223], a[116:119], a[92:95], v[220:223]
v_mfma_f32_16x16x32_bf16 v[220:223], a[112:115], a[88:91], v[220:223]
s_waitcnt lgkmcnt(0)
v_mfma_f32_16x16x32_bf16 v[224:227], a[128:131], a[88:91], v[224:227]
ds_read_b128 a[96:99], v5 offset:26624
v_mfma_f32_16x16x32_bf16 v[224:227], a[132:135], a[92:95], v[224:227]
buffer_load_dwordx4 a[48:51], v2, s[40:43], s35 offen offset:2048 sc1
v_mfma_f32_16x16x32_bf16 v[200:203], a[132:135], a[84:87], v[200:203]
ds_read_b128 a[100:103], v5 offset:32768
v_mfma_f32_16x16x32_bf16 v[200:203], a[128:131], a[80:83], v[200:203]
v_mfma_f32_16x16x32_bf16 v[176:179], a[128:131], a[72:75], v[176:179]
v_mfma_f32_16x16x32_bf16 v[176:179], a[132:135], a[76:79], v[176:179]
buffer_load_dwordx4 a[52:55], v2, s[40:43], s33 offen offset:2048 sc1
v_mfma_f32_16x16x32_bf16 v[152:155], a[132:135], a[68:71], v[152:155]
ds_read_b128 a[104:107], v5 offset:27648
v_mfma_f32_16x16x32_bf16 v[152:155], a[128:131], a[64:67], v[152:155]
v_mfma_f32_16x16x32_bf16 v[132:135], a[136:139], a[64:67], v[132:135]
ds_read_b128 a[108:111], v5 offset:33792
v_mfma_f32_16x16x32_bf16 v[132:135], a[140:143], a[68:71], v[132:135]
v_mfma_f32_16x16x32_bf16 v[156:159], a[140:143], a[76:79], v[156:159]
buffer_load_dwordx4 v[112:115], v1, s[4:7], s88 offen offset:1024 sc1
v_mfma_f32_16x16x32_bf16 v[156:159], a[136:139], a[72:75], v[156:159]
ds_read_b128 a[112:115], v5 offset:28672
v_mfma_f32_16x16x32_bf16 v[180:183], a[136:139], a[80:83], v[180:183]
v_mfma_f32_16x16x32_bf16 v[180:183], a[140:143], a[84:87], v[180:183]
ds_read_b128 a[116:119], v5 offset:34816
v_mfma_f32_16x16x32_bf16 v[204:207], a[140:143], a[92:95], v[204:207]
v_mfma_f32_16x16x32_bf16 v[204:207], a[136:139], a[88:91], v[204:207]
buffer_load_dwordx4 a[56:59], v2, s[40:43], s35 offen offset:3072 sc1
v_mfma_f32_16x16x32_bf16 v[208:211], a[144:147], a[88:91], v[208:211]
v_mfma_f32_16x16x32_bf16 v[208:211], a[148:151], a[92:95], v[208:211]
v_mfma_f32_16x16x32_bf16 v[184:187], a[148:151], a[84:87], v[184:187]
v_mfma_f32_16x16x32_bf16 v[184:187], a[144:147], a[80:83], v[184:187]
v_mfma_f32_16x16x32_bf16 v[160:163], a[144:147], a[72:75], v[160:163]
buffer_load_dwordx4 a[60:63], v2, s[40:43], s33 offen offset:3072 sc1
s_add_u32 s35, s35, 0x64000
v_mfma_f32_16x16x32_bf16 v[160:163], a[148:151], a[76:79], v[160:163]
s_add_u32 s33, s33, 0x64000
v_mfma_f32_16x16x32_bf16 v[136:139], a[148:151], a[68:71], v[136:139]
v_mfma_f32_16x16x32_bf16 v[136:139], a[144:147], a[64:67], v[136:139]
s_waitcnt vmcnt(10) lgkmcnt(0)
v_mfma_f32_16x16x32_bf16 v[140:143], a[96:99], a[0:3], v[140:143]
ds_read_b128 a[128:131], v5 offset:29696
v_mfma_f32_16x16x32_bf16 v[140:143], a[100:103], a[4:7], v[140:143]
buffer_load_dwordx4 a[64:67], v2, s[40:43], s35 offen offset:0 sc1
v_mfma_f32_16x16x32_bf16 v[164:167], a[100:103], a[12:15], v[164:167]
ds_read_b128 a[132:135], v5 offset:35840
v_mfma_f32_16x16x32_bf16 v[164:167], a[96:99], a[8:11], v[164:167]
v_mfma_f32_16x16x32_bf16 v[188:191], a[96:99], a[16:19], v[188:191]
v_mfma_f32_16x16x32_bf16 v[188:191], a[100:103], a[20:23], v[188:191]
buffer_load_dwordx4 a[68:71], v2, s[40:43], s33 offen offset:0 sc1
v_mfma_f32_16x16x32_bf16 v[212:215], a[100:103], a[28:31], v[212:215]
ds_read_b128 a[136:139], v5 offset:24576
v_mfma_f32_16x16x32_bf16 v[212:215], a[96:99], a[24:27], v[212:215]
v_mfma_f32_16x16x32_bf16 v[216:219], a[104:107], a[24:27], v[216:219]
ds_read_b128 a[140:143], v5 offset:30720
v_mfma_f32_16x16x32_bf16 v[216:219], a[108:111], a[28:31], v[216:219]
v_mfma_f32_16x16x32_bf16 v[192:195], a[108:111], a[20:23], v[192:195]
buffer_load_dwordx4 v[116:119], v1, s[4:7], s88 offen offset:2048 sc1
v_mfma_f32_16x16x32_bf16 v[192:195], a[104:107], a[16:19], v[192:195]
ds_read_b128 a[144:147], v5 offset:25600
v_mfma_f32_16x16x32_bf16 v[168:171], a[104:107], a[8:11], v[168:171]
v_mfma_f32_16x16x32_bf16 v[168:171], a[108:111], a[12:15], v[168:171]
ds_read_b128 a[148:151], v5 offset:31744
v_mfma_f32_16x16x32_bf16 v[144:147], a[108:111], a[4:7], v[144:147]
v_mfma_f32_16x16x32_bf16 v[144:147], a[104:107], a[0:3], v[144:147]
buffer_load_dwordx4 a[72:75], v2, s[40:43], s35 offen offset:1024 sc1
v_mfma_f32_16x16x32_bf16 v[148:151], a[112:115], a[0:3], v[148:151]
v_mfma_f32_16x16x32_bf16 v[148:151], a[116:119], a[4:7], v[148:151]
L_stub11:
s_cbranch_execz L_wret4
v_mfma_f32_16x16x32_bf16 v[172:175], a[116:119], a[12:15], v[172:175]
v_mfma_f32_16x16x32_bf16 v[172:175], a[112:115], a[8:11], v[172:175]
v_mfma_f32_16x16x32_bf16 v[196:199], a[112:115], a[16:19], v[196:199]
buffer_load_dwordx4 a[76:79], v2, s[40:43], s33 offen offset:1024 sc1
v_mfma_f32_16x16x32_bf16 v[196:199], a[116:119], a[20:23], v[196:199]
v_mfma_f32_16x16x32_bf16 v[220:223], a[116:119], a[28:31], v[220:223]
v_mfma_f32_16x16x32_bf16 v[220:223], a[112:115], a[24:27], v[220:223]
s_waitcnt lgkmcnt(0)
v_mfma_f32_16x16x32_bf16 v[224:227], a[128:131], a[24:27], v[224:227]
ds_read_b128 a[96:99], v5 offset:38912
v_mfma_f32_16x16x32_bf16 v[224:227], a[132:135], a[28:31], v[224:227]
buffer_load_dwordx4 a[80:83], v2, s[40:43], s35 offen offset:2048 sc1
v_mfma_f32_16x16x32_bf16 v[200:203], a[132:135], a[20:23], v[200:203]
ds_read_b128 a[100:103], v5 offset:45056
v_mfma_f32_16x16x32_bf16 v[200:203], a[128:131], a[16:19], v[200:203]
v_mfma_f32_16x16x32_bf16 v[176:179], a[128:131], a[8:11], v[176:179]
v_mfma_f32_16x16x32_bf16 v[176:179], a[132:135], a[12:15], v[176:179]
buffer_load_dwordx4 a[84:87], v2, s[40:43], s33 offen offset:2048 sc1
v_mfma_f32_16x16x32_bf16 v[152:155], a[132:135], a[4:7], v[152:155]
ds_read_b128 a[104:107], v5 offset:39936
v_mfma_f32_16x16x32_bf16 v[152:155], a[128:131], a[0:3], v[152:155]
v_mfma_f32_16x16x32_bf16 v[132:135], a[136:139], a[0:3], v[132:135]
ds_read_b128 a[108:111], v5 offset:46080
v_mfma_f32_16x16x32_bf16 v[132:135], a[140:143], a[4:7], v[132:135]
v_mfma_f32_16x16x32_bf16 v[156:159], a[140:143], a[12:15], v[156:159]
buffer_load_dwordx4 v[120:123], v1, s[4:7], s88 offen offset:3072 sc1
s_add_u32 m0, s18, 0x0
v_mfma_f32_16x16x32_bf16 v[156:159], a[136:139], a[8:11], v[156:159]
s_add_u32 s44, s50, 0x2024000
ds_read_b128 a[112:115], v5 offset:40960
v_mfma_f32_16x16x32_bf16 v[180:183], a[136:139], a[16:19], v[180:183]
v_mfma_f32_16x16x32_bf16 v[180:183], a[140:143], a[20:23], v[180:183]
ds_read_b128 a[116:119], v5 offset:47104
v_mfma_f32_16x16x32_bf16 v[204:207], a[140:143], a[28:31], v[204:207]
v_mfma_f32_16x16x32_bf16 v[204:207], a[136:139], a[24:27], v[204:207]
buffer_load_dwordx4 a[88:91], v2, s[40:43], s35 offen offset:3072 sc1
v_mfma_f32_16x16x32_bf16 v[208:211], a[144:147], a[24:27], v[208:211]
v_mfma_f32_16x16x32_bf16 v[208:211], a[148:151], a[28:31], v[208:211]
v_mfma_f32_16x16x32_bf16 v[184:187], a[148:151], a[20:23], v[184:187]
v_mfma_f32_16x16x32_bf16 v[184:187], a[144:147], a[16:19], v[184:187]
v_mfma_f32_16x16x32_bf16 v[160:163], a[144:147], a[8:11], v[160:163]
buffer_load_dwordx4 a[92:95], v2, s[40:43], s33 offen offset:3072 sc1
s_add_u32 s35, s35, 0x4000
v_mfma_f32_16x16x32_bf16 v[160:163], a[148:151], a[12:15], v[160:163]
s_add_u32 s33, s33, 0x4000
v_mfma_f32_16x16x32_bf16 v[136:139], a[148:151], a[4:7], v[136:139]
v_mfma_f32_16x16x32_bf16 v[136:139], a[144:147], a[0:3], v[136:139]
s_waitcnt vmcnt(10) lgkmcnt(0)
v_mfma_f32_16x16x32_bf16 v[140:143], a[96:99], a[32:35], v[140:143]
ds_read_b128 a[128:131], v5 offset:41984
v_mfma_f32_16x16x32_bf16 v[140:143], a[100:103], a[36:39], v[140:143]
buffer_load_dwordx4 a[0:3], v2, s[40:43], s35 offen offset:0 sc1
v_mfma_f32_16x16x32_bf16 v[164:167], a[100:103], a[44:47], v[164:167]
ds_read_b128 a[132:135], v5 offset:48128
v_mfma_f32_16x16x32_bf16 v[164:167], a[96:99], a[40:43], v[164:167]
v_mfma_f32_16x16x32_bf16 v[188:191], a[96:99], a[48:51], v[188:191]
v_mfma_f32_16x16x32_bf16 v[188:191], a[100:103], a[52:55], v[188:191]
buffer_load_dwordx4 v1, s[4:7], s44 offen offset:0 sc1 lds
v_mfma_f32_16x16x32_bf16 v[212:215], a[100:103], a[60:63], v[212:215]
ds_read_b128 a[136:139], v5 offset:36864
v_mfma_f32_16x16x32_bf16 v[212:215], a[96:99], a[56:59], v[212:215]
v_mfma_f32_16x16x32_bf16 v[216:219], a[104:107], a[56:59], v[216:219]
ds_read_b128 a[140:143], v5 offset:43008
v_mfma_f32_16x16x32_bf16 v[216:219], a[108:111], a[60:63], v[216:219]
buffer_load_dwordx4 a[4:7], v2, s[40:43], s33 offen offset:0 sc1
v_mfma_f32_16x16x32_bf16 v[192:195], a[108:111], a[52:55], v[192:195]
ds_read_b128 a[144:147], v5 offset:37888
v_mfma_f32_16x16x32_bf16 v[192:195], a[104:107], a[48:51], v[192:195]
v_mfma_f32_16x16x32_bf16 v[168:171], a[104:107], a[40:43], v[168:171]
v_mfma_f32_16x16x32_bf16 v[168:171], a[108:111], a[44:47], v[168:171]
buffer_load_dwordx4 a[8:11], v2, s[40:43], s35 offen offset:1024 sc1
v_mfma_f32_16x16x32_bf16 v[144:147], a[108:111], a[36:39], v[144:147]
ds_read_b128 a[148:151], v5 offset:44032
v_mfma_f32_16x16x32_bf16 v[144:147], a[104:107], a[32:35], v[144:147]
v_mfma_f32_16x16x32_bf16 v[148:151], a[112:115], a[32:35], v[148:151]
v_mfma_f32_16x16x32_bf16 v[148:151], a[116:119], a[36:39], v[148:151]
buffer_load_dwordx4 v1, s[4:7], s44 offen offset:1024 sc1 lds
s_add_u32 m0, s18, 0x2000
v_mfma_f32_16x16x32_bf16 v[172:175], a[116:119], a[44:47], v[172:175]
s_add_u32 s44, s50, 0x2026000
v_mfma_f32_16x16x32_bf16 v[172:175], a[112:115], a[40:43], v[172:175]
v_mfma_f32_16x16x32_bf16 v[196:199], a[112:115], a[48:51], v[196:199]
v_mfma_f32_16x16x32_bf16 v[196:199], a[116:119], a[52:55], v[196:199]
buffer_load_dwordx4 a[12:15], v2, s[40:43], s33 offen offset:1024 sc1
v_mfma_f32_16x16x32_bf16 v[220:223], a[116:119], a[60:63], v[220:223]
v_mfma_f32_16x16x32_bf16 v[220:223], a[112:115], a[56:59], v[220:223]
s_waitcnt lgkmcnt(0)
s_barrier
v_mfma_f32_16x16x32_bf16 v[224:227], a[128:131], a[56:59], v[224:227]
v_add_u32 v5, 98304, v1
v_mfma_f32_16x16x32_bf16 v[224:227], a[132:135], a[60:63], v[224:227]
buffer_load_dwordx4 a[16:19], v2, s[40:43], s35 offen offset:2048 sc1
v_mfma_f32_16x16x32_bf16 v[200:203], a[132:135], a[52:55], v[200:203]
ds_read_b128 a[96:99], v5 offset:2048
v_mfma_f32_16x16x32_bf16 v[200:203], a[128:131], a[48:51], v[200:203]
ds_read_b128 a[100:103], v5 offset:8192
v_mfma_f32_16x16x32_bf16 v[176:179], a[128:131], a[40:43], v[176:179]
v_mfma_f32_16x16x32_bf16 v[176:179], a[132:135], a[44:47], v[176:179]
buffer_load_dwordx4 a[20:23], v2, s[40:43], s33 offen offset:2048 sc1
v_mfma_f32_16x16x32_bf16 v[152:155], a[132:135], a[36:39], v[152:155]
ds_read_b128 a[104:107], v5 offset:3072
v_mfma_f32_16x16x32_bf16 v[152:155], a[128:131], a[32:35], v[152:155]
v_mfma_f32_16x16x32_bf16 v[132:135], a[136:139], a[32:35], v[132:135]
ds_read_b128 a[108:111], v5 offset:9216
v_mfma_f32_16x16x32_bf16 v[132:135], a[140:143], a[36:39], v[132:135]
v_mfma_f32_16x16x32_bf16 v[156:159], a[140:143], a[44:47], v[156:159]
buffer_load_dwordx4 v1, s[4:7], s44 offen offset:0 sc1 lds
v_mfma_f32_16x16x32_bf16 v[156:159], a[136:139], a[40:43], v[156:159]
ds_read_b128 a[112:115], v5 offset:4096
v_mfma_f32_16x16x32_bf16 v[180:183], a[136:139], a[48:51], v[180:183]
v_mfma_f32_16x16x32_bf16 v[180:183], a[140:143], a[52:55], v[180:183]
ds_read_b128 a[116:119], v5 offset:10240
v_mfma_f32_16x16x32_bf16 v[204:207], a[140:143], a[60:63], v[204:207]
v_mfma_f32_16x16x32_bf16 v[204:207], a[136:139], a[56:59], v[204:207]
buffer_load_dwordx4 a[24:27], v2, s[40:43], s35 offen offset:3072 sc1
v_mfma_f32_16x16x32_bf16 v[208:211], a[144:147], a[56:59], v[208:211]
v_mfma_f32_16x16x32_bf16 v[208:211], a[148:151], a[60:63], v[208:211]
v_mfma_f32_16x16x32_bf16 v[184:187], a[148:151], a[52:55], v[184:187]
v_mfma_f32_16x16x32_bf16 v[184:187], a[144:147], a[48:51], v[184:187]
v_mfma_f32_16x16x32_bf16 v[160:163], a[144:147], a[40:43], v[160:163]
buffer_load_dwordx4 a[28:31], v2, s[40:43], s33 offen offset:3072 sc1
s_add_u32 s35, s35, 0x4000
v_mfma_f32_16x16x32_bf16 v[160:163], a[148:151], a[44:47], v[160:163]
s_add_u32 s33, s33, 0x4000
v_mfma_f32_16x16x32_bf16 v[136:139], a[148:151], a[36:39], v[136:139]
v_mfma_f32_16x16x32_bf16 v[136:139], a[144:147], a[32:35], v[136:139]
s_waitcnt vmcnt(11) lgkmcnt(0)
v_mfma_f32_16x16x32_bf16 v[140:143], a[96:99], a[64:67], v[140:143]
ds_read_b128 a[128:131], v5 offset:5120
v_mfma_f32_16x16x32_bf16 v[140:143], a[100:103], a[68:71], v[140:143]
buffer_load_dwordx4 a[32:35], v2, s[40:43], s35 offen offset:0 sc1
v_mfma_f32_16x16x32_bf16 v[164:167], a[100:103], a[76:79], v[164:167]
ds_read_b128 a[132:135], v5 offset:11264
v_mfma_f32_16x16x32_bf16 v[164:167], a[96:99], a[72:75], v[164:167]
v_mfma_f32_16x16x32_bf16 v[188:191], a[96:99], a[80:83], v[188:191]
v_mfma_f32_16x16x32_bf16 v[188:191], a[100:103], a[84:87], v[188:191]
buffer_load_dwordx4 a[36:39], v2, s[40:43], s33 offen offset:0 sc1
v_mfma_f32_16x16x32_bf16 v[212:215], a[100:103], a[92:95], v[212:215]
ds_read_b128 a[136:139], v5 offset:0
v_mfma_f32_16x16x32_bf16 v[212:215], a[96:99], a[88:91], v[212:215]
v_mfma_f32_16x16x32_bf16 v[216:219], a[104:107], a[88:91], v[216:219]
ds_read_b128 a[140:143], v5 offset:6144
v_mfma_f32_16x16x32_bf16 v[216:219], a[108:111], a[92:95], v[216:219]
v_mfma_f32_16x16x32_bf16 v[192:195], a[108:111], a[84:87], v[192:195]
buffer_load_dwordx4 v1, s[4:7], s44 offen offset:1024 sc1 lds
s_add_u32 m0, s18, 0x4000
v_mfma_f32_16x16x32_bf16 v[192:195], a[104:107], a[80:83], v[192:195]
s_add_u32 s44, s50, 0x2028000
ds_read_b128 a[144:147], v5 offset:1024
v_mfma_f32_16x16x32_bf16 v[168:171], a[104:107], a[72:75], v[168:171]
v_mfma_f32_16x16x32_bf16 v[168:171], a[108:111], a[76:79], v[168:171]
ds_read_b128 a[148:151], v5 offset:7168
v_mfma_f32_16x16x32_bf16 v[144:147], a[108:111], a[68:71], v[144:147]
v_mfma_f32_16x16x32_bf16 v[144:147], a[104:107], a[64:67], v[144:147]
buffer_load_dwordx4 a[40:43], v2, s[40:43], s35 offen offset:1024 sc1
v_mfma_f32_16x16x32_bf16 v[148:151], a[112:115], a[64:67], v[148:151]
v_mfma_f32_16x16x32_bf16 v[148:151], a[116:119], a[68:71], v[148:151]
v_mfma_f32_16x16x32_bf16 v[172:175], a[116:119], a[76:79], v[172:175]
v_mfma_f32_16x16x32_bf16 v[172:175], a[112:115], a[72:75], v[172:175]
v_mfma_f32_16x16x32_bf16 v[196:199], a[112:115], a[80:83], v[196:199]
buffer_load_dwordx4 a[44:47], v2, s[40:43], s33 offen offset:1024 sc1
v_mfma_f32_16x16x32_bf16 v[196:199], a[116:119], a[84:87], v[196:199]
v_mfma_f32_16x16x32_bf16 v[220:223], a[116:119], a[92:95], v[220:223]
v_mfma_f32_16x16x32_bf16 v[220:223], a[112:115], a[88:91], v[220:223]
s_waitcnt lgkmcnt(0)
v_mfma_f32_16x16x32_bf16 v[224:227], a[128:131], a[88:91], v[224:227]
ds_read_b128 a[96:99], v5 offset:14336
v_mfma_f32_16x16x32_bf16 v[224:227], a[132:135], a[92:95], v[224:227]
buffer_load_dwordx4 a[48:51], v2, s[40:43], s35 offen offset:2048 sc1
v_mfma_f32_16x16x32_bf16 v[200:203], a[132:135], a[84:87], v[200:203]
ds_read_b128 a[100:103], v5 offset:20480
v_mfma_f32_16x16x32_bf16 v[200:203], a[128:131], a[80:83], v[200:203]
v_mfma_f32_16x16x32_bf16 v[176:179], a[128:131], a[72:75], v[176:179]
v_mfma_f32_16x16x32_bf16 v[176:179], a[132:135], a[76:79], v[176:179]
buffer_load_dwordx4 a[52:55], v2, s[40:43], s33 offen offset:2048 sc1
v_mfma_f32_16x16x32_bf16 v[152:155], a[132:135], a[68:71], v[152:155]
ds_read_b128 a[104:107], v5 offset:15360
v_mfma_f32_16x16x32_bf16 v[152:155], a[128:131], a[64:67], v[152:155]
v_mfma_f32_16x16x32_bf16 v[132:135], a[136:139], a[64:67], v[132:135]
ds_read_b128 a[108:111], v5 offset:21504
v_mfma_f32_16x16x32_bf16 v[132:135], a[140:143], a[68:71], v[132:135]
v_mfma_f32_16x16x32_bf16 v[156:159], a[140:143], a[76:79], v[156:159]
buffer_load_dwordx4 v1, s[4:7], s44 offen offset:0 sc1 lds
v_mfma_f32_16x16x32_bf16 v[156:159], a[136:139], a[72:75], v[156:159]
ds_read_b128 a[112:115], v5 offset:16384
v_mfma_f32_16x16x32_bf16 v[180:183], a[136:139], a[80:83], v[180:183]
v_mfma_f32_16x16x32_bf16 v[180:183], a[140:143], a[84:87], v[180:183]
ds_read_b128 a[116:119], v5 offset:22528
v_mfma_f32_16x16x32_bf16 v[204:207], a[140:143], a[92:95], v[204:207]
v_mfma_f32_16x16x32_bf16 v[204:207], a[136:139], a[88:91], v[204:207]
buffer_load_dwordx4 a[56:59], v2, s[40:43], s35 offen offset:3072 sc1
v_mfma_f32_16x16x32_bf16 v[208:211], a[144:147], a[88:91], v[208:211]
v_mfma_f32_16x16x32_bf16 v[208:211], a[148:151], a[92:95], v[208:211]
v_mfma_f32_16x16x32_bf16 v[184:187], a[148:151], a[84:87], v[184:187]
v_mfma_f32_16x16x32_bf16 v[184:187], a[144:147], a[80:83], v[184:187]
v_mfma_f32_16x16x32_bf16 v[160:163], a[144:147], a[72:75], v[160:163]
buffer_load_dwordx4 a[60:63], v2, s[40:43], s33 offen offset:3072 sc1
s_add_u32 s35, s35, 0x4000
v_mfma_f32_16x16x32_bf16 v[160:163], a[148:151], a[76:79], v[160:163]
s_add_u32 s33, s33, 0x4000
v_mfma_f32_16x16x32_bf16 v[136:139], a[148:151], a[68:71], v[136:139]
v_mfma_f32_16x16x32_bf16 v[136:139], a[144:147], a[64:67], v[136:139]
s_waitcnt vmcnt(10) lgkmcnt(0)
v_mfma_f32_16x16x32_bf16 v[140:143], a[96:99], a[0:3], v[140:143]
ds_read_b128 a[128:131], v5 offset:17408
v_add_f32 v92, v92, v96
v_mfma_f32_16x16x32_bf16 v[140:143], a[100:103], a[4:7], v[140:143]
buffer_load_dwordx4 a[64:67], v2, s[40:43], s35 offen offset:0 sc1
v_mfma_f32_16x16x32_bf16 v[164:167], a[100:103], a[12:15], v[164:167]
ds_read_b128 a[132:135], v5 offset:23552
v_add_f32 v100, v100, v104
v_mfma_f32_16x16x32_bf16 v[164:167], a[96:99], a[8:11], v[164:167]
v_add_f32 v108, v108, v112
v_add_f32 v116, v116, v120
v_mfma_f32_16x16x32_bf16 v[188:191], a[96:99], a[16:19], v[188:191]
v_add_f32 v93, v93, v97
v_add_f32 v101, v101, v105
v_mfma_f32_16x16x32_bf16 v[188:191], a[100:103], a[20:23], v[188:191]
buffer_load_dwordx4 a[68:71], v2, s[40:43], s33 offen offset:0 sc1
v_mfma_f32_16x16x32_bf16 v[212:215], a[100:103], a[28:31], v[212:215]
ds_read_b128 a[136:139], v5 offset:12288
v_add_f32 v109, v109, v113
v_mfma_f32_16x16x32_bf16 v[212:215], a[96:99], a[24:27], v[212:215]
v_add_f32 v117, v117, v121
v_add_f32 v94, v94, v98
v_mfma_f32_16x16x32_bf16 v[216:219], a[104:107], a[24:27], v[216:219]
ds_read_b128 a[140:143], v5 offset:18432
v_add_f32 v102, v102, v106
v_mfma_f32_16x16x32_bf16 v[216:219], a[108:111], a[28:31], v[216:219]
v_add_f32 v110, v110, v114
v_mfma_f32_16x16x32_bf16 v[192:195], a[108:111], a[20:23], v[192:195]
buffer_load_dwordx4 v1, s[4:7], s44 offen offset:1024 sc1 lds
s_add_u32 m0, s18, 0x6000
v_mfma_f32_16x16x32_bf16 v[192:195], a[104:107], a[16:19], v[192:195]
s_add_u32 s44, s50, 0x202a000
ds_read_b128 a[144:147], v5 offset:13312
v_mfma_f32_16x16x32_bf16 v[168:171], a[104:107], a[8:11], v[168:171]
v_add_f32 v118, v118, v122
v_add_f32 v95, v95, v99
v_mfma_f32_16x16x32_bf16 v[168:171], a[108:111], a[12:15], v[168:171]
ds_read_b128 a[148:151], v5 offset:19456
v_add_f32 v103, v103, v107
v_mfma_f32_16x16x32_bf16 v[144:147], a[108:111], a[4:7], v[144:147]
v_add_f32 v111, v111, v115
v_add_f32 v119, v119, v123
v_mfma_f32_16x16x32_bf16 v[144:147], a[104:107], a[0:3], v[144:147]
buffer_load_dwordx4 a[72:75], v2, s[40:43], s35 offen offset:1024 sc1
v_mfma_f32_16x16x32_bf16 v[148:151], a[112:115], a[0:3], v[148:151]
v_add_f32_dpp v92, v92, v92 row_ror:8 row_mask:0xf bank_mask:0xf
v_add_f32_dpp v100, v100, v100 row_ror:8 row_mask:0xf bank_mask:0xf
v_mfma_f32_16x16x32_bf16 v[148:151], a[116:119], a[4:7], v[148:151]
v_add_f32_dpp v108, v108, v108 row_ror:8 row_mask:0xf bank_mask:0xf
v_mfma_f32_16x16x32_bf16 v[172:175], a[116:119], a[12:15], v[172:175]
v_add_f32_dpp v116, v116, v116 row_ror:8 row_mask:0xf bank_mask:0xf
v_mfma_f32_16x16x32_bf16 v[172:175], a[112:115], a[8:11], v[172:175]
v_add_f32_dpp v93, v93, v93 row_ror:8 row_mask:0xf bank_mask:0xf
v_mfma_f32_16x16x32_bf16 v[196:199], a[112:115], a[16:19], v[196:199]
buffer_load_dwordx4 a[76:79], v2, s[40:43], s33 offen offset:1024 sc1
v_mfma_f32_16x16x32_bf16 v[196:199], a[116:119], a[20:23], v[196:199]
v_add_f32_dpp v101, v101, v101 row_ror:8 row_mask:0xf bank_mask:0xf
v_add_f32_dpp v109, v109, v109 row_ror:8 row_mask:0xf bank_mask:0xf
v_mfma_f32_16x16x32_bf16 v[220:223], a[116:119], a[28:31], v[220:223]
v_add_f32_dpp v117, v117, v117 row_ror:8 row_mask:0xf bank_mask:0xf
v_mfma_f32_16x16x32_bf16 v[220:223], a[112:115], a[24:27], v[220:223]
v_add_f32_dpp v92, v94, v94 row_ror:8 row_mask:0xf bank_mask:0xc
s_waitcnt lgkmcnt(0)
v_mfma_f32_16x16x32_bf16 v[224:227], a[128:131], a[24:27], v[224:227]
ds_read_b128 a[96:99], v5 offset:26624
v_add_f32_dpp v100, v102, v102 row_ror:8 row_mask:0xf bank_mask:0xc
v_mfma_f32_16x16x32_bf16 v[224:227], a[132:135], a[28:31], v[224:227]
buffer_load_dwordx4 a[80:83], v2, s[40:43], s35 offen offset:2048 sc1
v_mfma_f32_16x16x32_bf16 v[200:203], a[132:135], a[20:23], v[200:203]
ds_read_b128 a[100:103], v5 offset:32768
v_add_f32_dpp v108, v110, v110 row_ror:8 row_mask:0xf bank_mask:0xc
v_mfma_f32_16x16x32_bf16 v[200:203], a[128:131], a[16:19], v[200:203]
v_add_f32_dpp v116, v118, v118 row_ror:8 row_mask:0xf bank_mask:0xc
v_add_f32_dpp v93, v95, v95 row_ror:8 row_mask:0xf bank_mask:0xc
v_mfma_f32_16x16x32_bf16 v[176:179], a[128:131], a[8:11], v[176:179]
v_add_f32_dpp v101, v103, v103 row_ror:8 row_mask:0xf bank_mask:0xc
v_add_f32_dpp v109, v111, v111 row_ror:8 row_mask:0xf bank_mask:0xc
v_mfma_f32_16x16x32_bf16 v[176:179], a[132:135], a[12:15], v[176:179]
buffer_load_dwordx4 v1, s[4:7], s44 offen offset:0 sc1 lds
v_mfma_f32_16x16x32_bf16 v[152:155], a[132:135], a[4:7], v[152:155]
ds_read_b128 a[104:107], v5 offset:27648
v_add_f32_dpp v117, v119, v119 row_ror:8 row_mask:0xf bank_mask:0xc
v_mfma_f32_16x16x32_bf16 v[152:155], a[128:131], a[0:3], v[152:155]
v_permlane32_swap_b32 v92, v93
v_mfma_f32_16x16x32_bf16 v[132:135], a[136:139], a[0:3], v[132:135]
ds_read_b128 a[108:111], v5 offset:33792
v_mfma_f32_16x16x32_bf16 v[132:135], a[140:143], a[4:7], v[132:135]
buffer_load_dwordx4 a[84:87], v2, s[40:43], s33 offen offset:2048 sc1
v_mfma_f32_16x16x32_bf16 v[156:159], a[140:143], a[12:15], v[156:159]
ds_read_b128 a[112:115], v5 offset:28672
v_mfma_f32_16x16x32_bf16 v[156:159], a[136:139], a[8:11], v[156:159]
v_permlane32_swap_b32 v100, v101
v_mfma_f32_16x16x32_bf16 v[180:183], a[136:139], a[16:19], v[180:183]
v_permlane32_swap_b32 v108, v109
v_mfma_f32_16x16x32_bf16 v[180:183], a[140:143], a[20:23], v[180:183]
buffer_load_dwordx4 a[88:91], v2, s[40:43], s35 offen offset:3072 sc1
v_mfma_f32_16x16x32_bf16 v[204:207], a[140:143], a[28:31], v[204:207]
ds_read_b128 a[116:119], v5 offset:34816
v_mfma_f32_16x16x32_bf16 v[204:207], a[136:139], a[24:27], v[204:207]
v_permlane32_swap_b32 v116, v117
v_mfma_f32_16x16x32_bf16 v[208:211], a[144:147], a[24:27], v[208:211]
v_add_f32 v92, v92, v93
v_add_f32 v100, v100, v101
v_mfma_f32_16x16x32_bf16 v[208:211], a[148:151], a[28:31], v[208:211]
buffer_load_dwordx4 v1, s[4:7], s44 offen offset:1024 sc1 lds
s_add_u32 m0, s18, 0x8000
v_mfma_f32_16x16x32_bf16 v[184:187], a[148:151], a[20:23], v[184:187]
s_add_u32 s44, s50, 0x202c000
v_add_f32 v108, v108, v109
v_mfma_f32_16x16x32_bf16 v[184:187], a[144:147], a[16:19], v[184:187]
v_add_f32 v116, v116, v117
v_mov_b32 v94, v92
v_mfma_f32_16x16x32_bf16 v[160:163], a[144:147], a[8:11], v[160:163]
v_mov_b32 v102, v100
v_mov_b32 v110, v108
v_mfma_f32_16x16x32_bf16 v[160:163], a[148:151], a[12:15], v[160:163]
buffer_load_dwordx4 a[92:95], v2, s[40:43], s33 offen offset:3072 sc1
s_add_u32 s35, s35, 0x4000
v_mfma_f32_16x16x32_bf16 v[136:139], a[148:151], a[4:7], v[136:139]
s_add_u32 s33, s33, 0x4000
v_mov_b32 v118, v116
v_mfma_f32_16x16x32_bf16 v[136:139], a[144:147], a[0:3], v[136:139]
s_waitcnt vmcnt(11) lgkmcnt(0)
v_mfma_f32_16x16x32_bf16 v[140:143], a[96:99], a[32:35], v[140:143]
ds_read_b128 a[128:131], v5 offset:29696
v_mfma_f32_16x16x32_bf16 v[140:143], a[100:103], a[36:39], v[140:143]
buffer_load_dwordx4 a[0:3], v2, s[40:43], s35 offen offset:0 sc1
v_mfma_f32_16x16x32_bf16 v[164:167], a[100:103], a[44:47], v[164:167]
ds_read_b128 a[132:135], v5 offset:35840
v_mfma_f32_16x16x32_bf16 v[164:167], a[96:99], a[40:43], v[164:167]
v_permlane16_swap_b32 v92, v94
v_mfma_f32_16x16x32_bf16 v[188:191], a[96:99], a[48:51], v[188:191]
v_permlane16_swap_b32 v100, v102
v_mfma_f32_16x16x32_bf16 v[188:191], a[100:103], a[52:55], v[188:191]
buffer_load_dwordx4 a[4:7], v2, s[40:43], s33 offen offset:0 sc1
v_mfma_f32_16x16x32_bf16 v[212:215], a[100:103], a[60:63], v[212:215]
ds_read_b128 a[136:139], v5 offset:24576
v_mfma_f32_16x16x32_bf16 v[212:215], a[96:99], a[56:59], v[212:215]
v_permlane16_swap_b32 v108, v110
v_mfma_f32_16x16x32_bf16 v[216:219], a[104:107], a[56:59], v[216:219]
ds_read_b128 a[140:143], v5 offset:30720
v_mfma_f32_16x16x32_bf16 v[216:219], a[108:111], a[60:63], v[216:219]
v_permlane16_swap_b32 v116, v118
v_mfma_f32_16x16x32_bf16 v[192:195], a[108:111], a[52:55], v[192:195]
buffer_load_dwordx4 v1, s[4:7], s44 offen offset:0 sc1 lds
v_mfma_f32_16x16x32_bf16 v[192:195], a[104:107], a[48:51], v[192:195]
ds_read_b128 a[144:147], v5 offset:25600
v_add_f32 v92, v92, v94
v_mfma_f32_16x16x32_bf16 v[168:171], a[104:107], a[40:43], v[168:171]
v_add_f32 v100, v100, v102
v_add_f32 v108, v108, v110
v_mfma_f32_16x16x32_bf16 v[168:171], a[108:111], a[44:47], v[168:171]
ds_read_b128 a[148:151], v5 offset:31744
v_add_f32 v116, v116, v118
v_mfma_f32_16x16x32_bf16 v[144:147], a[108:111], a[36:39], v[144:147]
v_mov_b32 v94, v92
v_mov_b32 v102, v100
v_mfma_f32_16x16x32_bf16 v[144:147], a[104:107], a[32:35], v[144:147]
buffer_load_dwordx4 a[8:11], v2, s[40:43], s35 offen offset:1024 sc1
v_mfma_f32_16x16x32_bf16 v[148:151], a[112:115], a[32:35], v[148:151]
v_mov_b32 v110, v108
v_mov_b32 v118, v116
v_mfma_f32_16x16x32_bf16 v[148:151], a[116:119], a[36:39], v[148:151]
v_permlane32_swap_b32 v92, v94
v_mfma_f32_16x16x32_bf16 v[172:175], a[116:119], a[44:47], v[172:175]
v_permlane32_swap_b32 v100, v102
v_mfma_f32_16x16x32_bf16 v[172:175], a[112:115], a[40:43], v[172:175]
v_permlane32_swap_b32 v108, v110
v_mfma_f32_16x16x32_bf16 v[196:199], a[112:115], a[48:51], v[196:199]
buffer_load_dwordx4 a[12:15], v2, s[40:43], s33 offen offset:1024 sc1
v_mfma_f32_16x16x32_bf16 v[196:199], a[116:119], a[52:55], v[196:199]
v_permlane32_swap_b32 v116, v118
v_mfma_f32_16x16x32_bf16 v[220:223], a[116:119], a[60:63], v[220:223]
v_mul_f32 v82, 0xba800000, v92
v_mul_f32 v84, 0xba800000, v100
v_mfma_f32_16x16x32_bf16 v[220:223], a[112:115], a[56:59], v[220:223]
v_mul_f32 v86, 0xba800000, v108
s_waitcnt lgkmcnt(0)
v_mfma_f32_16x16x32_bf16 v[224:227], a[128:131], a[56:59], v[224:227]
ds_read_b128 a[96:99], v5 offset:38912
v_mul_f32 v88, 0xba800000, v116
v_mfma_f32_16x16x32_bf16 v[224:227], a[132:135], a[60:63], v[224:227]
buffer_load_dwordx4 a[16:19], v2, s[40:43], s35 offen offset:2048 sc1
v_mfma_f32_16x16x32_bf16 v[200:203], a[132:135], a[52:55], v[200:203]
ds_read_b128 a[100:103], v5 offset:45056
v_mul_f32 v94, 0x3a800000, v94
v_mfma_f32_16x16x32_bf16 v[200:203], a[128:131], a[48:51], v[200:203]
v_mul_f32 v102, 0x3a800000, v102
v_mul_f32 v110, 0x3a800000, v110
v_mfma_f32_16x16x32_bf16 v[176:179], a[128:131], a[40:43], v[176:179]
v_mul_f32 v118, 0x3a800000, v118
v_fma_f32 v94, -v82, v82, v94
v_mfma_f32_16x16x32_bf16 v[176:179], a[132:135], a[44:47], v[176:179]
buffer_load_dwordx4 a[20:23], v2, s[40:43], s33 offen offset:2048 sc1
v_mfma_f32_16x16x32_bf16 v[152:155], a[132:135], a[36:39], v[152:155]
ds_read_b128 a[104:107], v5 offset:39936
v_fma_f32 v102, -v84, v84, v102
v_mfma_f32_16x16x32_bf16 v[152:155], a[128:131], a[32:35], v[152:155]
v_fma_f32 v110, -v86, v86, v110
v_fma_f32 v118, -v88, v88, v118
v_mfma_f32_16x16x32_bf16 v[132:135], a[136:139], a[32:35], v[132:135]
ds_read_b128 a[108:111], v5 offset:46080
v_max_f32 v94, 0, v94
v_mfma_f32_16x16x32_bf16 v[132:135], a[140:143], a[36:39], v[132:135]
v_max_f32 v102, 0, v102
v_mfma_f32_16x16x32_bf16 v[156:159], a[140:143], a[44:47], v[156:159]
buffer_load_dwordx4 v1, s[4:7], s44 offen offset:1024 sc1 lds
s_add_u32 m0, s18, 0xa000
v_mfma_f32_16x16x32_bf16 v[156:159], a[136:139], a[40:43], v[156:159]
s_add_u32 s44, s50, 0x202e000
ds_read_b128 a[112:115], v5 offset:40960
v_mfma_f32_16x16x32_bf16 v[180:183], a[136:139], a[48:51], v[180:183]
v_max_f32 v110, 0, v110
v_max_f32 v118, 0, v118
v_mfma_f32_16x16x32_bf16 v[180:183], a[140:143], a[52:55], v[180:183]
ds_read_b128 a[116:119], v5 offset:47104
v_add_f32 v94, 0x3727c5ac, v94
v_mfma_f32_16x16x32_bf16 v[204:207], a[140:143], a[60:63], v[204:207]
v_add_f32 v102, 0x3727c5ac, v102
v_add_f32 v110, 0x3727c5ac, v110
v_mfma_f32_16x16x32_bf16 v[204:207], a[136:139], a[56:59], v[204:207]
buffer_load_dwordx4 a[24:27], v2, s[40:43], s35 offen offset:3072 sc1
v_mfma_f32_16x16x32_bf16 v[208:211], a[144:147], a[56:59], v[208:211]
v_add_f32 v118, 0x3727c5ac, v118
v_mfma_f32_16x16x32_bf16 v[208:211], a[148:151], a[60:63], v[208:211]
v_rsq_f32 v83, v94
v_mfma_f32_16x16x32_bf16 v[184:187], a[148:151], a[52:55], v[184:187]
v_rsq_f32 v85, v102
v_mfma_f32_16x16x32_bf16 v[184:187], a[144:147], a[48:51], v[184:187]
v_mfma_f32_16x16x32_bf16 v[160:163], a[144:147], a[40:43], v[160:163]
buffer_load_dwordx4 a[28:31], v2, s[40:43], s33 offen offset:3072 sc1
s_add_u32 s35, s35, 0x4000
v_mfma_f32_16x16x32_bf16 v[160:163], a[148:151], a[44:47], v[160:163]
s_add_u32 s33, s33, 0x4000
v_mfma_f32_16x16x32_bf16 v[136:139], a[148:151], a[36:39], v[136:139]
v_rsq_f32 v87, v110
v_mfma_f32_16x16x32_bf16 v[136:139], a[144:147], a[32:35], v[136:139]
s_waitcnt vmcnt(10) lgkmcnt(0)
v_mfma_f32_16x16x32_bf16 v[140:143], a[96:99], a[64:67], v[140:143]
ds_read_b128 a[128:131], v5 offset:41984
v_mfma_f32_16x16x32_bf16 v[140:143], a[100:103], a[68:71], v[140:143]
buffer_load_dwordx4 a[32:35], v2, s[40:43], s35 offen offset:0 sc1
v_mfma_f32_16x16x32_bf16 v[164:167], a[100:103], a[76:79], v[164:167]
ds_read_b128 a[132:135], v5 offset:48128
v_mfma_f32_16x16x32_bf16 v[164:167], a[96:99], a[72:75], v[164:167]
v_rsq_f32 v89, v118
v_mfma_f32_16x16x32_bf16 v[188:191], a[96:99], a[80:83], v[188:191]
v_mfma_f32_16x16x32_bf16 v[188:191], a[100:103], a[84:87], v[188:191]
buffer_load_dwordx4 a[36:39], v2, s[40:43], s33 offen offset:0 sc1
v_mfma_f32_16x16x32_bf16 v[212:215], a[100:103], a[92:95], v[212:215]
ds_read_b128 a[136:139], v5 offset:36864
v_mfma_f32_16x16x32_bf16 v[212:215], a[96:99], a[88:91], v[212:215]
v_mfma_f32_16x16x32_bf16 v[216:219], a[104:107], a[88:91], v[216:219]
ds_read_b128 a[140:143], v5 offset:43008
v_mfma_f32_16x16x32_bf16 v[216:219], a[108:111], a[92:95], v[216:219]
v_mfma_f32_16x16x32_bf16 v[192:195], a[108:111], a[84:87], v[192:195]
buffer_load_dwordx4 v1, s[4:7], s44 offen offset:0 sc1 lds
v_mfma_f32_16x16x32_bf16 v[192:195], a[104:107], a[80:83], v[192:195]
ds_read_b128 a[144:147], v5 offset:37888
v_fmac_f32 v140, v56, v82
v_mfma_f32_16x16x32_bf16 v[168:171], a[104:107], a[72:75], v[168:171]
v_fmac_f32 v164, v56, v84
v_mfma_f32_16x16x32_bf16 v[168:171], a[108:111], a[76:79], v[168:171]
ds_read_b128 a[148:151], v5 offset:44032
v_mfma_f32_16x16x32_bf16 v[144:147], a[108:111], a[68:71], v[144:147]
v_fmac_f32 v188, v56, v86
v_mfma_f32_16x16x32_bf16 v[144:147], a[104:107], a[64:67], v[144:147]
buffer_load_dwordx4 a[40:43], v2, s[40:43], s35 offen offset:1024 sc1
v_mfma_f32_16x16x32_bf16 v[148:151], a[112:115], a[64:67], v[148:151]
v_fmac_f32 v212, v56, v88
v_mfma_f32_16x16x32_bf16 v[148:151], a[116:119], a[68:71], v[148:151]
v_mfma_f32_16x16x32_bf16 v[172:175], a[116:119], a[76:79], v[172:175]
v_fmac_f32 v216, v60, v88
v_mfma_f32_16x16x32_bf16 v[172:175], a[112:115], a[72:75], v[172:175]
v_mfma_f32_16x16x32_bf16 v[196:199], a[112:115], a[80:83], v[196:199]
buffer_load_dwordx4 a[44:47], v2, s[40:43], s33 offen offset:1024 sc1
v_mfma_f32_16x16x32_bf16 v[196:199], a[116:119], a[84:87], v[196:199]
v_fmac_f32 v192, v60, v86
v_mfma_f32_16x16x32_bf16 v[220:223], a[116:119], a[92:95], v[220:223]
v_fmac_f32 v168, v60, v84
v_fmac_f32 v141, v57, v82
v_mfma_f32_16x16x32_bf16 v[220:223], a[112:115], a[88:91], v[220:223]
s_waitcnt lgkmcnt(0)
s_barrier
v_mfma_f32_16x16x32_bf16 v[224:227], a[128:131], a[88:91], v[224:227]
v_add_u32 v5, 0, v1
v_fmac_f32 v144, v60, v82
v_mfma_f32_16x16x32_bf16 v[224:227], a[132:135], a[92:95], v[224:227]
buffer_load_dwordx4 a[48:51], v2, s[40:43], s35 offen offset:2048 sc1
v_mfma_f32_16x16x32_bf16 v[200:203], a[132:135], a[84:87], v[200:203]
ds_read_b128 a[96:99], v5 offset:2048
v_fmac_f32 v148, v64, v82
v_mfma_f32_16x16x32_bf16 v[200:203], a[128:131], a[80:83], v[200:203]
ds_read_b128 a[100:103], v5 offset:8192
v_fmac_f32 v165, v57, v84
v_mfma_f32_16x16x32_bf16 v[176:179], a[128:131], a[72:75], v[176:179]
v_fmac_f32 v172, v64, v84
v_fmac_f32 v189, v57, v86
v_mfma_f32_16x16x32_bf16 v[176:179], a[132:135], a[76:79], v[176:179]
buffer_load_dwordx4 a[52:55], v2, s[40:43], s33 offen offset:2048 sc1
v_mfma_f32_16x16x32_bf16 v[152:155], a[132:135], a[68:71], v[152:155]
ds_read_b128 a[104:107], v5 offset:3072
v_fmac_f32 v196, v64, v86
v_mfma_f32_16x16x32_bf16 v[152:155], a[128:131], a[64:67], v[152:155]
v_fmac_f32 v213, v57, v88
v_fmac_f32 v217, v61, v88
v_mfma_f32_16x16x32_bf16 v[132:135], a[136:139], a[64:67], v[132:135]
ds_read_b128 a[108:111], v5 offset:9216
v_fmac_f32 v220, v64, v88
v_mfma_f32_16x16x32_bf16 v[132:135], a[140:143], a[68:71], v[132:135]
v_fmac_f32 v193, v61, v86
v_mfma_f32_16x16x32_bf16 v[156:159], a[140:143], a[76:79], v[156:159]
buffer_load_dwordx4 v1, s[4:7], s44 offen offset:1024 sc1 lds
s_add_u32 m0, s19, 49152
v_mfma_f32_16x16x32_bf16 v[156:159], a[136:139], a[72:75], v[156:159]
s_xor_b32 s44, s84, 16384
ds_read_b128 a[112:115], v5 offset:4096
v_mfma_f32_16x16x32_bf16 v[180:183], a[136:139], a[80:83], v[180:183]
v_fmac_f32 v224, v68, v88
v_fmac_f32 v200, v68, v86
v_mfma_f32_16x16x32_bf16 v[180:183], a[140:143], a[84:87], v[180:183]
ds_read_b128 a[116:119], v5 offset:10240
v_fmac_f32 v169, v61, v84
v_mfma_f32_16x16x32_bf16 v[204:207], a[140:143], a[92:95], v[204:207]
v_fmac_f32 v176, v68, v84
v_fmac_f32 v145, v61, v82
v_mfma_f32_16x16x32_bf16 v[204:207], a[136:139], a[88:91], v[204:207]
buffer_load_dwordx4 a[56:59], v2, s[40:43], s35 offen offset:3072 sc1
v_mfma_f32_16x16x32_bf16 v[208:211], a[144:147], a[88:91], v[208:211]
v_fmac_f32 v152, v68, v82
v_fmac_f32 v149, v65, v82
v_mfma_f32_16x16x32_bf16 v[208:211], a[148:151], a[92:95], v[208:211]
v_fmac_f32 v173, v65, v84
v_mfma_f32_16x16x32_bf16 v[184:187], a[148:151], a[84:87], v[184:187]
v_fmac_f32 v132, v48, v82
v_fmac_f32 v197, v65, v86
v_mfma_f32_16x16x32_bf16 v[184:187], a[144:147], a[80:83], v[184:187]
v_mfma_f32_16x16x32_bf16 v[160:163], a[144:147], a[72:75], v[160:163]
buffer_load_dwordx4 a[60:63], v2, s[40:43], s33 offen offset:3072 sc1
s_add_u32 s35, s35, 0x4000
v_mfma_f32_16x16x32_bf16 v[160:163], a[148:151], a[76:79], v[160:163]
s_add_u32 s33, s33, 0x4000
v_fmac_f32 v156, v48, v84
v_mfma_f32_16x16x32_bf16 v[136:139], a[148:151], a[68:71], v[136:139]
v_fmac_f32 v180, v48, v86
v_fmac_f32 v221, v65, v88
v_mfma_f32_16x16x32_bf16 v[136:139], a[144:147], a[64:67], v[136:139]
v_fmac_f32 v225, v69, v88
s_waitcnt vmcnt(10) lgkmcnt(0)
v_mfma_f32_16x16x32_bf16 v[140:143], a[96:99], a[0:3], v[140:143]
ds_read_b128 a[128:131], v5 offset:5120
v_fmac_f32 v204, v48, v88
v_mfma_f32_16x16x32_bf16 v[140:143], a[100:103], a[4:7], v[140:143]
buffer_load_dwordx4 a[64:67], v2, s[40:43], s35 offen offset:0 sc1
s_lshl_b32 s37, s28, 10
v_mfma_f32_16x16x32_bf16 v[164:167], a[100:103], a[12:15], v[164:167]
ds_read_b128 a[132:135], v5 offset:11264
v_fmac_f32 v208, v52, v88
v_mfma_f32_16x16x32_bf16 v[164:167], a[96:99], a[8:11], v[164:167]
v_fmac_f32 v201, v69, v86
v_fmac_f32 v177, v69, v84
L_stub12:
s_cbranch_execz L_wret3
v_mfma_f32_16x16x32_bf16 v[188:191], a[96:99], a[16:19], v[188:191]
v_fmac_f32 v184, v52, v86
v_fmac_f32 v153, v69, v82
v_mfma_f32_16x16x32_bf16 v[188:191], a[100:103], a[20:23], v[188:191]
buffer_load_dwordx4 a[68:71], v2, s[40:43], s33 offen offset:0 sc1
s_add_u32 s72, s75, 0x800000
v_mfma_f32_16x16x32_bf16 v[212:215], a[100:103], a[28:31], v[212:215]
ds_read_b128 a[136:139], v5 offset:0
v_fmac_f32 v160, v52, v84
v_mfma_f32_16x16x32_bf16 v[212:215], a[96:99], a[24:27], v[212:215]
v_fmac_f32 v133, v49, v82
s_add_u32 s63, s83, 0x280000
v_mfma_f32_16x16x32_bf16 v[216:219], a[104:107], a[24:27], v[216:219]
ds_read_b128 a[140:143], v5 offset:6144
v_fmac_f32 v136, v52, v82
v_mfma_f32_16x16x32_bf16 v[216:219], a[108:111], a[28:31], v[216:219]
buffer_load_dwordx4 a[72:75], v2, s[40:43], s35 offen offset:1024 sc1
s_sub_u32 s55, s63, 131072
v_mfma_f32_16x16x32_bf16 v[192:195], a[108:111], a[20:23], v[192:195]
ds_read_b128 a[144:147], v5 offset:1024
v_fmac_f32 v157, v49, v84
v_mfma_f32_16x16x32_bf16 v[192:195], a[104:107], a[16:19], v[192:195]
v_fmac_f32 v181, v49, v86
v_fmac_f32 v142, v58, v82
v_mfma_f32_16x16x32_bf16 v[168:171], a[104:107], a[8:11], v[168:171]
v_fmac_f32 v205, v49, v88
v_fmac_f32 v166, v58, v84
v_mfma_f32_16x16x32_bf16 v[168:171], a[108:111], a[12:15], v[168:171]
buffer_load_dwordx4 a[76:79], v2, s[40:43], s33 offen offset:1024 sc1
v_mfma_f32_16x16x32_bf16 v[144:147], a[108:111], a[4:7], v[144:147]
ds_read_b128 a[148:151], v5 offset:7168
v_fmac_f32 v209, v53, v88
v_mfma_f32_16x16x32_bf16 v[144:147], a[104:107], a[0:3], v[144:147]
v_fmac_f32 v190, v58, v86
v_add_u32 v233, s37, v1
v_mfma_f32_16x16x32_bf16 v[148:151], a[112:115], a[0:3], v[148:151]
v_fmac_f32 v185, v53, v86
v_fmac_f32 v214, v58, v88
v_mfma_f32_16x16x32_bf16 v[148:151], a[116:119], a[4:7], v[148:151]
buffer_load_dwordx4 a[80:83], v2, s[40:43], s35 offen offset:2048 sc1
v_mfma_f32_16x16x32_bf16 v[172:175], a[116:119], a[12:15], v[172:175]
v_fmac_f32 v161, v53, v84
v_fmac_f32 v218, v62, v88
v_mfma_f32_16x16x32_bf16 v[172:175], a[112:115], a[8:11], v[172:175]
v_add_u32 v232, s19, v7
v_add_u32 v248, s19, v8
v_mfma_f32_16x16x32_bf16 v[196:199], a[112:115], a[16:19], v[196:199]
v_fmac_f32 v137, v53, v82
v_fmac_f32 v194, v62, v86
v_mfma_f32_16x16x32_bf16 v[196:199], a[116:119], a[20:23], v[196:199]
buffer_load_dwordx4 a[84:87], v2, s[40:43], s33 offen offset:2048 sc1
v_mfma_f32_16x16x32_bf16 v[220:223], a[116:119], a[28:31], v[220:223]
v_fmac_f32 v170, v62, v84
v_fmac_f32 v143, v59, v82
v_mfma_f32_16x16x32_bf16 v[220:223], a[112:115], a[24:27], v[220:223]
s_waitcnt lgkmcnt(0)
v_mfma_f32_16x16x32_bf16 v[224:227], a[128:131], a[24:27], v[224:227]
ds_read_b128 a[96:99], v5 offset:14336
v_fmac_f32 v146, v62, v82
v_mfma_f32_16x16x32_bf16 v[224:227], a[132:135], a[28:31], v[224:227]
buffer_load_dwordx4 a[88:91], v2, s[40:43], s35 offen offset:3072 sc1
v_mfma_f32_16x16x32_bf16 v[200:203], a[132:135], a[20:23], v[200:203]
ds_read_b128 a[100:103], v5 offset:20480
v_fmac_f32 v150, v66, v82
v_mfma_f32_16x16x32_bf16 v[200:203], a[128:131], a[16:19], v[200:203]
v_fmac_f32 v167, v59, v84
v_fmac_f32 v191, v59, v86
v_mfma_f32_16x16x32_bf16 v[176:179], a[128:131], a[8:11], v[176:179]
v_fmac_f32 v174, v66, v84
v_fmac_f32 v215, v59, v88
v_mfma_f32_16x16x32_bf16 v[176:179], a[132:135], a[12:15], v[176:179]
ds_read_b128 a[104:107], v5 offset:15360
v_mfma_f32_16x16x32_bf16 v[152:155], a[132:135], a[4:7], v[152:155]
v_fmac_f32 v198, v66, v86
v_fmac_f32 v219, v63, v88
v_mfma_f32_16x16x32_bf16 v[152:155], a[128:131], a[0:3], v[152:155]
buffer_load_dwordx4 v1, s[4:7], s44 offen offset:0 sc1 lds
v_mfma_f32_16x16x32_bf16 v[132:135], a[136:139], a[0:3], v[132:135]
ds_read_b128 a[108:111], v5 offset:21504
v_fmac_f32 v222, v66, v88
v_mfma_f32_16x16x32_bf16 v[132:135], a[140:143], a[4:7], v[132:135]
v_fmac_f32 v195, v63, v86
v_mfma_f32_16x16x32_bf16 v[156:159], a[140:143], a[12:15], v[156:159]
ds_read_b128 a[112:115], v5 offset:16384
v_fmac_f32 v226, v70, v88
v_mfma_f32_16x16x32_bf16 v[156:159], a[136:139], a[8:11], v[156:159]
v_fmac_f32 v171, v63, v84
v_mfma_f32_16x16x32_bf16 v[180:183], a[136:139], a[16:19], v[180:183]
v_fmac_f32 v202, v70, v86
v_fmac_f32 v147, v63, v82
v_mfma_f32_16x16x32_bf16 v[180:183], a[140:143], a[20:23], v[180:183]
buffer_load_dwordx4 a[92:95], v2, s[40:43], s33 offen offset:3072 sc1
s_add_u32 s35, s35, 0x4000
v_mfma_f32_16x16x32_bf16 v[204:207], a[140:143], a[28:31], v[204:207]
s_add_u32 s33, s33, 0x4000
ds_read_b128 a[116:119], v5 offset:22528
v_mfma_f32_16x16x32_bf16 v[204:207], a[136:139], a[24:27], v[204:207]
v_fmac_f32 v178, v70, v84
v_fmac_f32 v151, v67, v82
v_mfma_f32_16x16x32_bf16 v[208:211], a[144:147], a[24:27], v[208:211]
v_fmac_f32 v154, v70, v82
v_fmac_f32 v175, v67, v84
v_mfma_f32_16x16x32_bf16 v[208:211], a[148:151], a[28:31], v[208:211]
v_mfma_f32_16x16x32_bf16 v[184:187], a[148:151], a[20:23], v[184:187]
v_fmac_f32 v134, v50, v82
v_fmac_f32 v199, v67, v86
v_mfma_f32_16x16x32_bf16 v[184:187], a[144:147], a[16:19], v[184:187]
buffer_load_dwordx4 v1, s[4:7], s44 offen offset:1024 sc1 lds
v_mfma_f32_16x16x32_bf16 v[160:163], a[144:147], a[8:11], v[160:163]
v_fmac_f32 v158, v50, v84
v_fmac_f32 v223, v67, v88
v_mfma_f32_16x16x32_bf16 v[160:163], a[148:151], a[12:15], v[160:163]
v_mfma_f32_16x16x32_bf16 v[136:139], a[148:151], a[4:7], v[136:139]
v_fmac_f32 v182, v50, v86
v_fmac_f32 v227, v71, v88
v_mfma_f32_16x16x32_bf16 v[136:139], a[144:147], a[0:3], v[136:139]
s_waitcnt vmcnt(10) lgkmcnt(0)
s_barrier
v_mfma_f32_16x16x32_bf16 v[140:143], a[96:99], a[32:35], v[140:143]
ds_read_b128 a[128:131], v5 offset:17408
v_fmac_f32 v206, v50, v88
v_mfma_f32_16x16x32_bf16 v[140:143], a[100:103], a[36:39], v[140:143]
buffer_load_dwordx4 a[0:3], v2, s[40:43], s35 offen offset:0 sc1
v_mfma_f32_16x16x32_bf16 v[164:167], a[100:103], a[44:47], v[164:167]
ds_read_b128 a[132:135], v5 offset:23552
v_fmac_f32 v210, v54, v88
v_mfma_f32_16x16x32_bf16 v[164:167], a[96:99], a[40:43], v[164:167]
v_fmac_f32 v203, v71, v86
v_fmac_f32 v179, v71, v84
v_mfma_f32_16x16x32_bf16 v[188:191], a[96:99], a[48:51], v[188:191]
buffer_load_dwordx4 a[4:7], v2, s[40:43], s33 offen offset:0 sc1
v_mfma_f32_16x16x32_bf16 v[188:191], a[100:103], a[52:55], v[188:191]
ds_read_b128 a[136:139], v5 offset:26624
v_fmac_f32 v186, v54, v86
v_mfma_f32_16x16x32_bf16 v[212:215], a[100:103], a[60:63], v[212:215]
v_fmac_f32 v162, v54, v84
v_fmac_f32 v155, v71, v82
v_mfma_f32_16x16x32_bf16 v[212:215], a[96:99], a[56:59], v[212:215]
buffer_load_dwordx4 a[8:11], v2, s[40:43], s35 offen offset:1024 sc1
v_mfma_f32_16x16x32_bf16 v[216:219], a[104:107], a[56:59], v[216:219]
ds_read_b128 a[140:143], v5 offset:32768
v_fmac_f32 v138, v54, v82
v_mfma_f32_16x16x32_bf16 v[216:219], a[108:111], a[60:63], v[216:219]
v_fmac_f32 v135, v51, v82
v_fmac_f32 v159, v51, v84
v_mfma_f32_16x16x32_bf16 v[192:195], a[108:111], a[52:55], v[192:195]
buffer_load_dwordx4 a[12:15], v2, s[40:43], s33 offen offset:1024 sc1
v_mfma_f32_16x16x32_bf16 v[192:195], a[104:107], a[48:51], v[192:195]
ds_read_b128 a[144:147], v5 offset:27648
v_fmac_f32 v183, v51, v86
v_mfma_f32_16x16x32_bf16 v[168:171], a[104:107], a[40:43], v[168:171]
v_fmac_f32 v207, v51, v88
v_mfma_f32_16x16x32_bf16 v[168:171], a[108:111], a[44:47], v[168:171]
buffer_load_dwordx4 a[16:19], v2, s[40:43], s35 offen offset:2048 sc1
v_mfma_f32_16x16x32_bf16 v[144:147], a[108:111], a[36:39], v[144:147]
ds_read_b128 a[148:151], v5 offset:33792
v_fmac_f32 v211, v55, v88
v_mfma_f32_16x16x32_bf16 v[144:147], a[104:107], a[32:35], v[144:147]
v_mul_f32 v88, 0x3e8293ee, v89
v_mfma_f32_16x16x32_bf16 v[148:151], a[112:115], a[32:35], v[148:151]
buffer_load_dwordx4 a[20:23], v2, s[40:43], s33 offen offset:2048 sc1
v_mfma_f32_16x16x32_bf16 v[148:151], a[116:119], a[36:39], v[148:151]
v_fmac_f32 v187, v55, v86
v_mfma_f32_16x16x32_bf16 v[172:175], a[116:119], a[44:47], v[172:175]
v_fmac_f32 v163, v55, v84
v_mul_f32 v86, 0x3e8293ee, v87
v_mfma_f32_16x16x32_bf16 v[172:175], a[112:115], a[40:43], v[172:175]
buffer_load_dwordx4 a[24:27], v2, s[40:43], s35 offen offset:3072 sc1
v_mfma_f32_16x16x32_bf16 v[196:199], a[112:115], a[48:51], v[196:199]
v_fmac_f32 v139, v55, v82
v_mul_f32 v84, 0x3e8293ee, v85
v_mfma_f32_16x16x32_bf16 v[196:199], a[116:119], a[52:55], v[196:199]
v_mul_f32 v82, 0x3e8293ee, v83
v_mfma_f32_16x16x32_bf16 v[220:223], a[116:119], a[60:63], v[220:223]
buffer_load_dwordx4 a[28:31], v2, s[40:43], s33 offen offset:3072 sc1
s_add_u32 s35, s35, 0x64000
v_mfma_f32_16x16x32_bf16 v[220:223], a[112:115], a[56:59], v[220:223]
s_add_u32 s33, s33, 0x64000
s_waitcnt lgkmcnt(0)
v_mfma_f32_16x16x32_bf16 v[224:227], a[128:131], a[56:59], v[224:227]
ds_read_b128 a[96:99], v5 offset:28672
v_mfma_f32_16x16x32_bf16 v[224:227], a[132:135], a[60:63], v[224:227]
buffer_load_dwordx4 v1, s[4:7], s44 offen offset:2048 sc1 lds
v_mfma_f32_16x16x32_bf16 v[200:203], a[132:135], a[52:55], v[200:203]
ds_read_b128 a[100:103], v5 offset:34816
v_mfma_f32_16x16x32_bf16 v[200:203], a[128:131], a[48:51], v[200:203]
v_mfma_f32_16x16x32_bf16 v[176:179], a[128:131], a[40:43], v[176:179]
v_mfma_f32_16x16x32_bf16 v[176:179], a[132:135], a[44:47], v[176:179]
ds_read_b128 a[104:107], v5 offset:29696
v_mfma_f32_16x16x32_bf16 v[152:155], a[132:135], a[36:39], v[152:155]
v_mfma_f32_16x16x32_bf16 v[152:155], a[128:131], a[32:35], v[152:155]
s_waitcnt vmcnt(18)
v_mfma_f32_16x16x32_bf16 v[140:143], a[136:139], a[64:67], v[140:143]
ds_read_b128 a[108:111], v5 offset:35840
s_waitcnt vmcnt(17)
v_mfma_f32_16x16x32_bf16 v[140:143], a[140:143], a[68:71], v[140:143]
s_waitcnt vmcnt(15)
v_mfma_f32_16x16x32_bf16 v[164:167], a[140:143], a[76:79], v[164:167]
ds_read_b128 a[112:115], v5 offset:38912
v_mfma_f32_16x16x32_bf16 v[164:167], a[136:139], a[72:75], v[164:167]
s_waitcnt vmcnt(14)
v_mfma_f32_16x16x32_bf16 v[188:191], a[136:139], a[80:83], v[188:191]
s_waitcnt vmcnt(13)
v_mfma_f32_16x16x32_bf16 v[188:191], a[140:143], a[84:87], v[188:191]
buffer_load_dwordx4 v1, s[4:7], s44 offen offset:3072 sc1 lds
s_add_u32 m0, s19, 65536
s_waitcnt vmcnt(11)
v_mfma_f32_16x16x32_bf16 v[212:215], a[140:143], a[92:95], v[212:215]
s_xor_b32 s44, s84, 32768
ds_read_b128 a[116:119], v5 offset:45056
v_mfma_f32_16x16x32_bf16 v[212:215], a[136:139], a[88:91], v[212:215]
v_mfma_f32_16x16x32_bf16 v[216:219], a[144:147], a[88:91], v[216:219]
v_mfma_f32_16x16x32_bf16 v[216:219], a[148:151], a[92:95], v[216:219]
v_mfma_f32_16x16x32_bf16 v[192:195], a[148:151], a[84:87], v[192:195]
v_mfma_f32_16x16x32_bf16 v[192:195], a[144:147], a[80:83], v[192:195]
v_mfma_f32_16x16x32_bf16 v[168:171], a[144:147], a[72:75], v[168:171]
v_mfma_f32_16x16x32_bf16 v[168:171], a[148:151], a[76:79], v[168:171]
v_mfma_f32_16x16x32_bf16 v[144:147], a[148:151], a[68:71], v[144:147]
v_mfma_f32_16x16x32_bf16 v[144:147], a[144:147], a[64:67], v[144:147]
s_waitcnt lgkmcnt(0)
v_mfma_f32_16x16x32_bf16 v[148:151], a[96:99], a[64:67], v[148:151]
ds_read_b128 a[128:131], v5 offset:39936
v_mfma_f32_16x16x32_bf16 v[148:151], a[100:103], a[68:71], v[148:151]
buffer_load_dwordx4 v1, s[4:7], s44 offen offset:0 sc1 lds
v_mfma_f32_16x16x32_bf16 v[172:175], a[100:103], a[76:79], v[172:175]
ds_read_b128 a[132:135], v5 offset:46080
v_mfma_f32_16x16x32_bf16 v[172:175], a[96:99], a[72:75], v[172:175]
v_mfma_f32_16x16x32_bf16 v[196:199], a[96:99], a[80:83], v[196:199]
v_mfma_f32_16x16x32_bf16 v[196:199], a[100:103], a[84:87], v[196:199]
buffer_load_dwordx4 v1, s[4:7], s44 offen offset:1024 sc1 lds
v_mfma_f32_16x16x32_bf16 v[220:223], a[100:103], a[92:95], v[220:223]
ds_read_b128 a[136:139], v5 offset:40960
v_mfma_f32_16x16x32_bf16 v[220:223], a[96:99], a[88:91], v[220:223]
v_mfma_f32_16x16x32_bf16 v[224:227], a[104:107], a[88:91], v[224:227]
ds_read_b128 a[140:143], v5 offset:47104
v_mfma_f32_16x16x32_bf16 v[224:227], a[108:111], a[92:95], v[224:227]
v_mfma_f32_16x16x32_bf16 v[200:203], a[108:111], a[84:87], v[200:203]
buffer_load_dwordx4 v1, s[4:7], s44 offen offset:2048 sc1 lds
v_mfma_f32_16x16x32_bf16 v[200:203], a[104:107], a[80:83], v[200:203]
ds_read_b128 a[144:147], v5 offset:41984
v_mfma_f32_16x16x32_bf16 v[176:179], a[104:107], a[72:75], v[176:179]
v_mfma_f32_16x16x32_bf16 v[176:179], a[108:111], a[76:79], v[176:179]
ds_read_b128 a[148:151], v5 offset:48128
v_mfma_f32_16x16x32_bf16 v[152:155], a[108:111], a[68:71], v[152:155]
v_mfma_f32_16x16x32_bf16 v[152:155], a[104:107], a[64:67], v[152:155]
buffer_load_dwordx4 v1, s[4:7], s44 offen offset:3072 sc1 lds
s_add_u32 m0, s19, 81920
s_waitcnt vmcnt(13)
v_mfma_f32_16x16x32_bf16 v[140:143], a[112:115], a[0:3], v[140:143]
s_xor_b32 s44, s84, 49152
s_waitcnt vmcnt(12)
v_mfma_f32_16x16x32_bf16 v[140:143], a[116:119], a[4:7], v[140:143]
s_waitcnt vmcnt(10)
v_mfma_f32_16x16x32_bf16 v[164:167], a[116:119], a[12:15], v[164:167]
v_mfma_f32_16x16x32_bf16 v[164:167], a[112:115], a[8:11], v[164:167]
s_waitcnt vmcnt(9)
v_mfma_f32_16x16x32_bf16 v[188:191], a[112:115], a[16:19], v[188:191]
buffer_load_dwordx4 v1, s[4:7], s44 offen offset:0 sc1 lds
s_waitcnt vmcnt(9)
v_mfma_f32_16x16x32_bf16 v[188:191], a[116:119], a[20:23], v[188:191]
s_waitcnt vmcnt(7)
v_mfma_f32_16x16x32_bf16 v[212:215], a[116:119], a[28:31], v[212:215]
v_mfma_f32_16x16x32_bf16 v[212:215], a[112:115], a[24:27], v[212:215]
s_waitcnt lgkmcnt(0)
v_mfma_f32_16x16x32_bf16 v[216:219], a[128:131], a[24:27], v[216:219]
ds_read_b128 a[96:99], v5 offset:12288
v_mul_f32 v140, v140, v83
v_mfma_f32_16x16x32_bf16 v[216:219], a[132:135], a[28:31], v[216:219]
buffer_load_dwordx4 v1, s[4:7], s44 offen offset:1024 sc1 lds
v_mfma_f32_16x16x32_bf16 v[192:195], a[132:135], a[20:23], v[192:195]
ds_read_b128 a[100:103], v5 offset:18432
v_mul_f32 v141, v141, v83
v_mfma_f32_16x16x32_bf16 v[192:195], a[128:131], a[16:19], v[192:195]
v_cvt_pk_bf16_f32 v140, v140, v141
v_mul_f32 v164, v164, v85
v_mfma_f32_16x16x32_bf16 v[168:171], a[128:131], a[8:11], v[168:171]
v_mul_f32 v165, v165, v85
v_cvt_pk_bf16_f32 v164, v164, v165
v_mfma_f32_16x16x32_bf16 v[168:171], a[132:135], a[12:15], v[168:171]
buffer_load_dwordx4 v1, s[4:7], s44 offen offset:2048 sc1 lds
v_mfma_f32_16x16x32_bf16 v[144:147], a[132:135], a[4:7], v[144:147]
ds_read_b128 a[104:107], v5 offset:24576
v_mul_f32 v212, v212, v89
v_mfma_f32_16x16x32_bf16 v[144:147], a[128:131], a[0:3], v[144:147]
v_mul_f32 v213, v213, v89
v_mul_f32 v214, v214, v89
v_mfma_f32_16x16x32_bf16 v[148:151], a[136:139], a[0:3], v[148:151]
ds_read_b128 a[108:111], v5 offset:30720
v_mul_f32 v215, v215, v89
v_mfma_f32_16x16x32_bf16 v[148:151], a[140:143], a[4:7], v[148:151]
v_cvt_pk_bf16_f32 v212, v212, v213
v_mul_f32 v216, v216, v89
v_mfma_f32_16x16x32_bf16 v[172:175], a[140:143], a[12:15], v[172:175]
buffer_load_dwordx4 v1, s[4:7], s44 offen offset:3072 sc1 lds
s_add_u32 m0, s19, 147456
v_mfma_f32_16x16x32_bf16 v[172:175], a[136:139], a[8:11], v[172:175]
s_xor_b32 s44, s84, 114688
ds_read_b128 a[112:115], v5 offset:36864
v_mfma_f32_16x16x32_bf16 v[196:199], a[136:139], a[16:19], v[196:199]
v_mul_f32 v217, v217, v89
v_mul_f32 v218, v218, v89
v_mfma_f32_16x16x32_bf16 v[196:199], a[140:143], a[20:23], v[196:199]
ds_read_b128 a[116:119], v5 offset:43008
v_mul_f32 v219, v219, v89
v_mfma_f32_16x16x32_bf16 v[220:223], a[140:143], a[28:31], v[220:223]
v_cvt_pk_bf16_f32 v213, v214, v215
v_cvt_pk_bf16_f32 v214, v216, v217
v_mfma_f32_16x16x32_bf16 v[220:223], a[136:139], a[24:27], v[220:223]
buffer_load_dwordx4 v1, s[4:7], s44 offen offset:0 sc1 lds
v_mfma_f32_16x16x32_bf16 v[224:227], a[144:147], a[24:27], v[224:227]
v_cvt_pk_bf16_f32 v215, v218, v219
v_min_u32 v212, -2, v212
v_mfma_f32_16x16x32_bf16 v[224:227], a[148:151], a[28:31], v[224:227]
v_min_u32 v213, -2, v213
v_min_u32 v214, -2, v214
v_mfma_f32_16x16x32_bf16 v[200:203], a[148:151], a[20:23], v[200:203]
v_min_u32 v215, -2, v215
v_mul_f32 v172, v172, v85
v_mfma_f32_16x16x32_bf16 v[200:203], a[144:147], a[16:19], v[200:203]
buffer_store_dwordx4 v[212:215], v3, s[4:7], s63 offen offset:0 sc1
v_mfma_f32_16x16x32_bf16 v[176:179], a[144:147], a[8:11], v[176:179]
buffer_load_dwordx4 v1, s[4:7], s44 offen offset:1024 sc1 lds
v_mfma_f32_16x16x32_bf16 v[176:179], a[148:151], a[12:15], v[176:179]
v_mul_f32 v173, v173, v85
v_cvt_pk_bf16_f32 v172, v172, v173
v_mfma_f32_16x16x32_bf16 v[152:155], a[148:151], a[4:7], v[152:155]
v_mul_f32 v220, v220, v89
v_mul_f32 v221, v221, v89
v_mfma_f32_16x16x32_bf16 v[152:155], a[144:147], a[0:3], v[152:155]
v_mul_f32 v222, v222, v89
s_waitcnt lgkmcnt(0)
v_mfma_f32_16x16x32_bf16 v[132:135], a[96:99], a[32:35], v[132:135]
ds_read_b128 a[128:131], v5 offset:13312
v_mul_f32 v223, v223, v89
v_mfma_f32_16x16x32_bf16 v[132:135], a[100:103], a[36:39], v[132:135]
buffer_load_dwordx4 v1, s[4:7], s44 offen offset:2048 sc1 lds
v_mfma_f32_16x16x32_bf16 v[156:159], a[100:103], a[44:47], v[156:159]
ds_read_b128 a[132:135], v5 offset:19456
v_cvt_pk_bf16_f32 v220, v220, v221
v_mfma_f32_16x16x32_bf16 v[156:159], a[96:99], a[40:43], v[156:159]
v_mul_f32 v224, v224, v89
v_mul_f32 v225, v225, v89
v_mfma_f32_16x16x32_bf16 v[180:183], a[96:99], a[48:51], v[180:183]
v_mul_f32 v226, v226, v89
v_mul_f32 v227, v227, v89
v_mfma_f32_16x16x32_bf16 v[180:183], a[100:103], a[52:55], v[180:183]
buffer_load_dwordx4 v1, s[4:7], s44 offen offset:3072 sc1 lds
s_add_u32 m0, s19, 98304
v_mfma_f32_16x16x32_bf16 v[204:207], a[100:103], a[60:63], v[204:207]
s_xor_b32 s44, s84, 65536
ds_read_b128 a[136:139], v5 offset:25600
v_mfma_f32_16x16x32_bf16 v[204:207], a[96:99], a[56:59], v[204:207]
v_cvt_pk_bf16_f32 v221, v222, v223
v_cvt_pk_bf16_f32 v222, v224, v225
v_mfma_f32_16x16x32_bf16 v[204:207], a[104:107], a[88:91], v[204:207]
ds_read_b128 a[140:143], v5 offset:31744
v_cvt_pk_bf16_f32 v223, v226, v227
v_mfma_f32_16x16x32_bf16 v[204:207], a[108:111], a[92:95], v[204:207]
v_min_u32 v220, -2, v220
v_min_u32 v221, -2, v221
v_mfma_f32_16x16x32_bf16 v[180:183], a[108:111], a[84:87], v[180:183]
buffer_load_dwordx4 v1, s[4:7], s44 offen offset:0 sc1 lds
v_mfma_f32_16x16x32_bf16 v[180:183], a[104:107], a[80:83], v[180:183]
ds_read_b128 a[144:147], v5 offset:37888
v_min_u32 v222, -2, v222
v_mfma_f32_16x16x32_bf16 v[156:159], a[104:107], a[72:75], v[156:159]
v_min_u32 v223, -2, v223
v_mul_f32 v196, v196, v87
v_mfma_f32_16x16x32_bf16 v[156:159], a[108:111], a[76:79], v[156:159]
ds_read_b128 a[148:151], v5 offset:44032
v_mul_f32 v197, v197, v87
v_mfma_f32_16x16x32_bf16 v[132:135], a[108:111], a[68:71], v[132:135]
buffer_store_dwordx4 v[220:223], v3, s[4:7], s63 offen offset:1024 sc1
v_mfma_f32_16x16x32_bf16 v[132:135], a[104:107], a[64:67], v[132:135]
buffer_load_dwordx4 v1, s[4:7], s44 offen offset:1024 sc1 lds
v_mfma_f32_16x16x32_bf16 v[132:135], a[112:115], a[0:3], v[132:135]
v_cvt_pk_bf16_f32 v196, v196, v197
v_mul_f32 v198, v198, v87
v_mfma_f32_16x16x32_bf16 v[132:135], a[116:119], a[4:7], v[132:135]
v_mul_f32 v199, v199, v87
v_cvt_pk_bf16_f32 v197, v198, v199
v_mfma_f32_16x16x32_bf16 v[156:159], a[116:119], a[12:15], v[156:159]
v_mul_f32 v200, v200, v87
v_mul_f32 v201, v201, v87
v_mfma_f32_16x16x32_bf16 v[156:159], a[112:115], a[8:11], v[156:159]
v_cvt_pk_bf16_f32 v198, v200, v201
v_mul_f32 v202, v202, v87
v_mfma_f32_16x16x32_bf16 v[180:183], a[112:115], a[16:19], v[180:183]
buffer_load_dwordx4 v1, s[4:7], s44 offen offset:2048 sc1 lds
v_mfma_f32_16x16x32_bf16 v[180:183], a[116:119], a[20:23], v[180:183]
v_mul_f32 v203, v203, v87
v_cvt_pk_bf16_f32 v199, v202, v203
v_mfma_f32_16x16x32_bf16 v[204:207], a[116:119], a[28:31], v[204:207]
v_mul_f32 v174, v174, v85
v_mul_f32 v175, v175, v85
v_mfma_f32_16x16x32_bf16 v[204:207], a[112:115], a[24:27], v[204:207]
s_waitcnt lgkmcnt(0)
s_barrier
v_mfma_f32_16x16x32_bf16 v[208:211], a[128:131], a[56:59], v[208:211]
ds_write_b128 v233, v[212:215] offset:21504
v_cvt_pk_bf16_f32 v173, v174, v175
v_mfma_f32_16x16x32_bf16 v[208:211], a[132:135], a[60:63], v[208:211]
buffer_load_dwordx4 v1, s[4:7], s44 offen offset:3072 sc1 lds
s_add_u32 m0, s19, 114688
v_mfma_f32_16x16x32_bf16 v[184:187], a[132:135], a[52:55], v[184:187]
s_xor_b32 s44, s84, 81920
ds_write_b64 v232, v[220:221] offset:4096
v_mfma_f32_16x16x32_bf16 v[184:187], a[128:131], a[48:51], v[184:187]
ds_write_b64 v232, v[222:223] offset:4608
v_cvt_pk_bf16_f32 v132, v132, v133
v_mfma_f32_16x16x32_bf16 v[160:163], a[128:131], a[40:43], v[160:163]
ds_write_b64 v232, v[196:197] offset:3072
v_cvt_pk_bf16_f32 v156, v156, v157
v_mfma_f32_16x16x32_bf16 v[160:163], a[132:135], a[44:47], v[160:163]
buffer_load_dwordx4 v1, s[4:7], s44 offen offset:0 sc1 lds
v_mfma_f32_16x16x32_bf16 v[136:139], a[132:135], a[36:39], v[136:139]
ds_write_b64 v232, v[198:199] offset:3584
v_cvt_pk_bf16_f32 v180, v180, v181
v_mfma_f32_16x16x32_bf16 v[136:139], a[128:131], a[32:35], v[136:139]
ds_write_b64 v232, v[172:173] offset:2048
v_cvt_pk_bf16_f32 v204, v204, v205
v_mfma_f32_16x16x32_bf16 v[136:139], a[136:139], a[64:67], v[136:139]
v_cvt_pk_bf16_f32 v133, v134, v135
v_cvt_pk_bf16_f32 v157, v158, v159
v_mfma_f32_16x16x32_bf16 v[136:139], a[140:143], a[68:71], v[136:139]
v_cvt_pk_bf16_f32 v181, v182, v183
v_cvt_pk_bf16_f32 v205, v206, v207
v_mfma_f32_16x16x32_bf16 v[160:163], a[140:143], a[76:79], v[160:163]
buffer_load_dwordx4 v1, s[4:7], s44 offen offset:1024 sc1 lds
v_mfma_f32_16x16x32_bf16 v[160:163], a[136:139], a[72:75], v[160:163]
v_mul_f32 v176, v176, v85
v_mul_f32 v177, v177, v85
v_mfma_f32_16x16x32_bf16 v[184:187], a[136:139], a[80:83], v[184:187]
v_cvt_pk_bf16_f32 v174, v176, v177
v_mul_f32 v178, v178, v85
v_mfma_f32_16x16x32_bf16 v[184:187], a[140:143], a[84:87], v[184:187]
v_mul_f32 v179, v179, v85
v_cvt_pk_bf16_f32 v175, v178, v179
v_mfma_f32_16x16x32_bf16 v[208:211], a[140:143], a[92:95], v[208:211]
ds_write_b64 v232, v[174:175] offset:2560
v_mul_f32 v148, v148, v83
v_mfma_f32_16x16x32_bf16 v[208:211], a[136:139], a[88:91], v[208:211]
buffer_load_dwordx4 v1, s[4:7], s44 offen offset:2048 sc1 lds
v_mfma_f32_16x16x32_bf16 v[208:211], a[144:147], a[24:27], v[208:211]
v_mul_f32 v149, v149, v83
v_cvt_pk_bf16_f32 v148, v148, v149
v_mfma_f32_16x16x32_bf16 v[208:211], a[148:151], a[28:31], v[208:211]
v_mul_f32 v150, v150, v83
v_mul_f32 v151, v151, v83
v_mfma_f32_16x16x32_bf16 v[184:187], a[148:151], a[20:23], v[184:187]
v_cvt_pk_bf16_f32 v149, v150, v151
v_mul_f32 v152, v152, v83
v_mfma_f32_16x16x32_bf16 v[184:187], a[144:147], a[16:19], v[184:187]
ds_write_b64 v232, v[148:149] offset:1024
v_mul_f32 v153, v153, v83
v_mfma_f32_16x16x32_bf16 v[160:163], a[144:147], a[8:11], v[160:163]
buffer_load_dwordx4 v1, s[4:7], s44 offen offset:3072 sc1 lds
v_mfma_f32_16x16x32_bf16 v[160:163], a[148:151], a[12:15], v[160:163]
v_cvt_pk_bf16_f32 v150, v152, v153
v_mul_f32 v154, v154, v83
v_mfma_f32_16x16x32_bf16 v[136:139], a[148:151], a[4:7], v[136:139]
v_mul_f32 v155, v155, v83
v_cvt_pk_bf16_f32 v151, v154, v155
v_mfma_f32_16x16x32_bf16 v[136:139], a[144:147], a[0:3], v[136:139]
ds_write_b64 v232, v[150:151] offset:1536
v_mul_f32 v188, v188, v87
s_add_u32 m0, s19, 32768
buffer_load_dwordx4 v[228:231], v9, s[4:7], s55 offen sc1
buffer_load_dwordx4 v[72:75], v9, s[4:7], s55 offen offset:1024 sc1
s_xor_b32 s44, s84, 0
buffer_load_dwordx4 v1, s[4:7], s44 offen offset:0 sc1 lds
v_mul_f32 v189, v189, v87
v_pk_mul_f32 v[190:191], v[190:191], v[86:87] op_sel:[0,1] op_sel_hi:[1,1]
v_pk_mul_f32 v[166:167], v[166:167], v[84:85] op_sel:[0,1] op_sel_hi:[1,1]
v_pk_mul_f32 v[142:143], v[142:143], v[82:83] op_sel:[0,1] op_sel_hi:[1,1]
v_cvt_pk_bf16_f32 v188, v188, v189
v_pk_mul_f32 v[192:193], v[192:193], v[86:87] op_sel:[0,1] op_sel_hi:[1,1]
v_pk_mul_f32 v[194:195], v[194:195], v[86:87] op_sel:[0,1] op_sel_hi:[1,1]
v_pk_mul_f32 v[168:169], v[168:169], v[84:85] op_sel:[0,1] op_sel_hi:[1,1]
v_pk_mul_f32 v[170:171], v[170:171], v[84:85] op_sel:[0,1] op_sel_hi:[1,1]
v_pk_mul_f32 v[144:145], v[144:145], v[82:83] op_sel:[0,1] op_sel_hi:[1,1]
v_pk_mul_f32 v[146:147], v[146:147], v[82:83] op_sel:[0,1] op_sel_hi:[1,1]
v_cvt_pk_bf16_f32 v189, v190, v191
v_cvt_pk_bf16_f32 v165, v166, v167
v_cvt_pk_bf16_f32 v141, v142, v143
v_cvt_pk_bf16_f32 v190, v192, v193
v_cvt_pk_bf16_f32 v191, v194, v195
v_cvt_pk_bf16_f32 v166, v168, v169
v_cvt_pk_bf16_f32 v167, v170, v171
v_cvt_pk_bf16_f32 v142, v144, v145
v_cvt_pk_bf16_f32 v143, v146, v147
v_cvt_pk_bf16_f32 v134, v136, v137
v_cvt_pk_bf16_f32 v135, v138, v139
v_cvt_pk_bf16_f32 v158, v160, v161
v_cvt_pk_bf16_f32 v159, v162, v163
v_cvt_pk_bf16_f32 v182, v184, v185
v_cvt_pk_bf16_f32 v183, v186, v187
v_cvt_pk_bf16_f32 v206, v208, v209
buffer_load_dwordx4 v1, s[4:7], s44 offen offset:1024 sc1 lds
v_cvt_pk_bf16_f32 v207, v210, v211
buffer_load_dwordx4 v1, s[4:7], s44 offen offset:2048 sc1 lds
buffer_load_dwordx4 v1, s[4:7], s44 offen offset:3072 sc1 lds
s_waitcnt lgkmcnt(0)
s_barrier
s_add_u32 m0, s19, 131072
s_xor_b32 s44, s84, 98304
buffer_load_dwordx4 v1, s[4:7], s44 offen offset:0 sc1 lds
v_mfma_f32_16x16x32_bf16 v[208:211], v[188:191], v[204:207], v[20:23]
ds_read_b64_tr_b16 a[10:11], v248 offset:3072
v_mfma_f32_16x16x32_bf16 v[224:227], v[212:215], v[204:207], v[24:27]
ds_read_b64_tr_b16 a[12:13], v248 offset:4096
v_mfma_f32_16x16x32_bf16 v[160:163], v[140:143], v[156:159], v[20:23]
ds_read_b64_tr_b16 a[22:23], v248 offset:3584
v_mfma_f32_16x16x32_bf16 v[176:179], v[164:167], v[156:159], v[24:27]
s_nop 3
v_max_f32 v224, v224, v208
v_max_f32 v225, v225, v209
v_max_f32 v226, v226, v210
v_max_f32 v227, v227, v211
v_max3_f32 v239, v224, v225, v226
v_max_f32 v239, v239, v227
ds_read_b64_tr_b16 a[24:25], v248 offset:4608
v_max_f32 v176, v176, v160
v_max_f32 v177, v177, v161
v_max_f32 v178, v178, v162
v_max_f32 v179, v179, v163
v_max3_f32 v237, v176, v177, v178
buffer_load_dwordx4 v1, s[4:7], s44 offen offset:1024 sc1 lds
v_max_f32 v237, v237, v179
v_mfma_f32_16x16x32_bf16 v[184:187], v[164:167], v[180:183], v[20:23]
s_nop 0
v_permlane32_swap_b32 v239, v237
v_max_f32 v239, v239, v237
v_mov_b32 v242, v239
v_mfma_f32_16x16x32_bf16 v[200:203], v[188:191], v[180:183], v[24:27]
s_nop 0
v_permlane16_swap_b32 v239, v242
v_max_f32 v239, v239, v242
v_mov_b32 v242, v239
ds_read_b64_tr_b16 a[6:7], v248 offset:1024
s_nop 0
v_permlane32_swap_b32 v239, v242
v_mul_f32_e64 v89, -v239, v88
v_fma_f32 v224, v224, v88, v89
v_fma_f32 v225, v225, v88, v89
v_fma_f32 v226, v226, v88, v89
v_fma_f32 v227, v227, v88, v89
v_exp_f32 v224, v224
v_exp_f32 v225, v225
v_exp_f32 v226, v226
buffer_load_dwordx4 v1, s[4:7], s44 offen offset:2048 sc1 lds
v_exp_f32 v227, v227
v_cvt_pk_bf16_f32 v224, v224, v225
v_cvt_pk_bf16_f32 v225, v226, v227
v_and_b32 v208, v224, v28
v_and_b32 v209, v225, v29
v_and_b32 v210, v224, v30
v_and_b32 v211, v225, v31
v_max_f32 v200, v200, v184
v_max_f32 v201, v201, v185
v_mfma_f32_16x16x32_bf16 v[216:219], v[16:19], v[208:211], 0
v_max_f32 v202, v202, v186
v_max_f32 v203, v203, v187
s_waitcnt lgkmcnt(3)
v_mfma_f32_16x16x32_bf16 v[116:119], a[10:13], v[208:211], 0
v_max3_f32 v238, v200, v201, v202
ds_read_b64_tr_b16 a[18:19], v248 offset:1536
s_waitcnt lgkmcnt(2)
v_mfma_f32_16x16x32_bf16 v[120:123], a[22:25], v[208:211], 0
v_rcp_f32 v216, v216
ds_read_b64_tr_b16 a[8:9], v248 offset:2048
ds_read_b64_tr_b16 a[20:21], v248 offset:2560
buffer_load_dwordx4 v1, s[4:7], s44 offen offset:3072 sc1 lds
v_pk_mul_f32 v[116:117], v[116:117], v[216:217] op_sel:[0,0] op_sel_hi:[1,0]
v_pk_mul_f32 v[118:119], v[118:119], v[216:217] op_sel:[0,0] op_sel_hi:[1,0]
v_cvt_pk_bf16_f32 v116, v116, v117
s_nop 0
v_pk_mul_f32 v[120:121], v[120:121], v[216:217] op_sel:[0,0] op_sel_hi:[1,0]
v_pk_mul_f32 v[122:123], v[122:123], v[216:217] op_sel:[0,0] op_sel_hi:[1,0]
v_cvt_pk_bf16_f32 v117, v118, v119
v_cvt_pk_bf16_f32 v118, v120, v121
v_cvt_pk_bf16_f32 v119, v122, v123
v_max_f32 v238, v238, v203
buffer_store_dwordx4 v[116:119], v2, s[4:7], s72 offen offset:3072 sc1
s_waitcnt lgkmcnt(0)
s_cmp_lg_u32 s28, 0
s_cbranch_scc1 Lhx_35
s_waitcnt vmcnt(10)
v_max3_u32 v244, v228, v229, v230
s_waitcnt vmcnt(9)
v_max3_u32 v244, v244, v231, v72
v_max3_u32 v244, v244, v73, v74
v_max_u32 v244, v244, v75
v_cmp_eq_u32 vcc, -1, v244
s_cbranch_vccnz L_hxredo2
L_hxback2:
ds_write_b128 v233, v[228:231] offset:20480
ds_write_b64 v232, v[72:73] offset:0
ds_write_b64 v232, v[74:75] offset:512
Lhx_35:
ds_read_b128 a[0:3], v233 offset:20480
v_mfma_f32_16x16x32_bf16 v[152:155], v[140:143], v[132:135], v[24:27]
v_mul_f32_e64 v85, -v242, v84
v_fma_f32 v176, v176, v84, v85
v_fma_f32 v177, v177, v84, v85
v_fma_f32 v178, v178, v84, v85
v_fma_f32 v179, v179, v84, v85
L_stub13:
s_cbranch_execz L_wret3
v_exp_f32 v176, v176
v_exp_f32 v177, v177
v_exp_f32 v178, v178
v_exp_f32 v179, v179
v_cvt_pk_bf16_f32 v176, v176, v177
v_cvt_pk_bf16_f32 v177, v178, v179
v_and_b32 v160, v176, v28
v_and_b32 v161, v177, v29
v_and_b32 v162, v176, v30
v_and_b32 v163, v177, v31
ds_read_b64_tr_b16 a[4:5], v248 offset:0
s_nop 0
v_mfma_f32_16x16x32_bf16 v[168:171], v[16:19], v[160:163], 0
ds_read_b64_tr_b16 a[16:17], v248 offset:512
v_mfma_f32_16x16x32_bf16 v[100:103], a[6:9], v[160:163], 0
buffer_atomic_add v12, v10, s[4:7], s94 offen sc1
s_waitcnt lgkmcnt(2)
v_mfma_f32_16x16x32_bf16 v[136:139], a[0:3], v[132:135], v[76:79]
s_nop 2
v_rcp_f32 v168, v168
v_mfma_f32_16x16x32_bf16 v[104:107], a[18:21], v[160:163], 0
s_nop 2
v_max_f32 v152, v152, v136
v_max_f32 v153, v153, v137
v_max_f32 v154, v154, v138
v_max_f32 v155, v155, v139
v_max3_f32 v236, v152, v153, v154
v_max_f32 v236, v236, v155
v_pk_mul_f32 v[100:101], v[100:101], v[168:169] op_sel:[0,0] op_sel_hi:[1,0]
v_pk_mul_f32 v[102:103], v[102:103], v[168:169] op_sel:[0,0] op_sel_hi:[1,0]
v_permlane32_swap_b32 v238, v236
v_max_f32 v238, v238, v236
v_mov_b32 v243, v238
v_cvt_pk_bf16_f32 v100, v100, v101
v_pk_mul_f32 v[104:105], v[104:105], v[168:169] op_sel:[0,0] op_sel_hi:[1,0]
v_permlane16_swap_b32 v238, v243
v_max_f32 v238, v238, v243
v_mov_b32 v243, v238
v_pk_mul_f32 v[106:107], v[106:107], v[168:169] op_sel:[0,0] op_sel_hi:[1,0]
v_cvt_pk_bf16_f32 v101, v102, v103
v_permlane32_swap_b32 v238, v243
v_mul_f32_e64 v87, -v238, v86
v_fma_f32 v200, v200, v86, v87
v_fma_f32 v201, v201, v86, v87
v_fma_f32 v202, v202, v86, v87
v_fma_f32 v203, v203, v86, v87
v_exp_f32 v200, v200
v_exp_f32 v201, v201
v_exp_f32 v202, v202
v_exp_f32 v203, v203
v_cvt_pk_bf16_f32 v200, v200, v201
v_cvt_pk_bf16_f32 v201, v202, v203
v_and_b32 v184, v200, v28
v_and_b32 v185, v201, v29
v_and_b32 v186, v200, v30
v_and_b32 v187, v201, v31
v_cvt_pk_bf16_f32 v102, v104, v105
v_cvt_pk_bf16_f32 v103, v106, v107
v_mfma_f32_16x16x32_bf16 v[192:195], v[16:19], v[184:187], 0
buffer_store_dwordx4 v[100:103], v2, s[4:7], s72 offen offset:1024 sc1
v_mul_f32_e64 v83, -v243, v82
v_mfma_f32_16x16x32_bf16 v[108:111], a[8:11], v[184:187], 0
v_fma_f32 v152, v152, v82, v83
v_fma_f32 v153, v153, v82, v83
v_fma_f32 v154, v154, v82, v83
v_fma_f32 v155, v155, v82, v83
v_mfma_f32_16x16x32_bf16 v[112:115], a[20:23], v[184:187], 0
v_exp_f32 v152, v152
v_exp_f32 v153, v153
v_exp_f32 v154, v154
v_exp_f32 v155, v155
v_rcp_f32 v192, v192
v_cvt_pk_bf16_f32 v152, v152, v153
v_cvt_pk_bf16_f32 v153, v154, v155
v_and_b32 v136, v152, v80
v_and_b32 v137, v153, v81
v_and_b32 v138, v152, v30
v_and_b32 v139, v153, v31
v_pk_mul_f32 v[108:109], v[108:109], v[192:193] op_sel:[0,0] op_sel_hi:[1,0]
v_pk_mul_f32 v[110:111], v[110:111], v[192:193] op_sel:[0,0] op_sel_hi:[1,0]
v_cvt_pk_bf16_f32 v108, v108, v109
v_pk_mul_f32 v[112:113], v[112:113], v[192:193] op_sel:[0,0] op_sel_hi:[1,0]
v_cvt_pk_bf16_f32 v109, v110, v111
v_pk_mul_f32 v[114:115], v[114:115], v[192:193] op_sel:[0,0] op_sel_hi:[1,0]
v_cvt_pk_bf16_f32 v110, v112, v113
v_mfma_f32_16x16x32_bf16 v[144:147], v[16:19], v[136:139], 0
v_cvt_pk_bf16_f32 v111, v114, v115
buffer_store_dwordx4 v[108:111], v2, s[4:7], s72 offen offset:2048 sc1
s_waitcnt lgkmcnt(1)
v_mfma_f32_16x16x32_bf16 v[92:95], a[4:7], v[136:139], 0
s_nop 3
v_rcp_f32 v144, v144
s_waitcnt lgkmcnt(0)
v_mfma_f32_16x16x32_bf16 v[96:99], a[16:19], v[136:139], 0
s_nop 0
v_pk_mul_f32 v[92:93], v[92:93], v[144:145] op_sel:[0,0] op_sel_hi:[1,0]
v_pk_mul_f32 v[94:95], v[94:95], v[144:145] op_sel:[0,0] op_sel_hi:[1,0]
v_cvt_pk_bf16_f32 v92, v92, v93
v_cvt_pk_bf16_f32 v93, v94, v95
s_nop 2
v_pk_mul_f32 v[96:97], v[96:97], v[144:145] op_sel:[0,0] op_sel_hi:[1,0]
v_pk_mul_f32 v[98:99], v[98:99], v[144:145] op_sel:[0,0] op_sel_hi:[1,0]
v_cvt_pk_bf16_f32 v94, v96, v97
v_cvt_pk_bf16_f32 v95, v98, v99
buffer_store_dwordx4 v[92:95], v2, s[4:7], s72 offen offset:0 sc1
s_add_u32 s92, s71, 0x20000
s_add_u32 s40, s4, 0x800000
s_addc_u32 s41, s5, 0
v_add_u32 v5, 32768, v1
v_add_u32 v6, 98304, v1
s_mov_b32 s35, s77
v_lshlrev_b32 v132, 16, v32
v_and_b32 v133, 0xffff0000, v32
v_lshlrev_b32 v134, 16, v33
v_and_b32 v135, 0xffff0000, v33
v_lshlrev_b32 v136, 16, v34
v_and_b32 v137, 0xffff0000, v34
v_lshlrev_b32 v138, 16, v35
v_and_b32 v139, 0xffff0000, v35
v_lshlrev_b32 v140, 16, v36
v_and_b32 v141, 0xffff0000, v36
v_lshlrev_b32 v142, 16, v37
v_and_b32 v143, 0xffff0000, v37
v_lshlrev_b32 v144, 16, v38
v_and_b32 v145, 0xffff0000, v38
v_lshlrev_b32 v146, 16, v39
v_and_b32 v147, 0xffff0000, v39
v_lshlrev_b32 v148, 16, v40
v_and_b32 v149, 0xffff0000, v40
v_lshlrev_b32 v150, 16, v41
v_and_b32 v151, 0xffff0000, v41
v_lshlrev_b32 v152, 16, v42
v_and_b32 v153, 0xffff0000, v42
v_lshlrev_b32 v154, 16, v43
v_and_b32 v155, 0xffff0000, v43
v_lshlrev_b32 v156, 16, v44
v_and_b32 v157, 0xffff0000, v44
v_lshlrev_b32 v158, 16, v45
v_and_b32 v159, 0xffff0000, v45
v_lshlrev_b32 v160, 16, v46
v_and_b32 v161, 0xffff0000, v46
v_lshlrev_b32 v162, 16, v47
v_and_b32 v163, 0xffff0000, v47
s_mov_b32 s95, -1
s_mov_b64 exec, 0
s_cmp_eq_u32 s28, 3
s_cbranch_scc1 L_stub14
s_cmp_eq_u32 s28, 2
s_cbranch_scc1 L_stub17
s_cmp_eq_u32 s28, 0
s_cbranch_scc1 L_stub18
L_wret5:
s_mov_b64 exec, -1
s_cmp_lg_u32 s28, 1
s_cbranch_scc1 Lpo_38
s_add_u32 s36, s11, 0x20080
s_mov_b32 s37, 0
v_mov_b32 v11, 0
buffer_atomic_add v11, v251, s[4:7], s36 offen sc0 sc1
s_sleep 4
Lpoll_36:
v_mov_b32 v234, 0
buffer_atomic_add v234, v251, s[4:7], s36 offen sc0 sc1
s_waitcnt vmcnt(1)
v_readfirstlane_b32 s38, v11
s_nop 0
s_cmp_ge_u32 s38, 32
s_cbranch_scc1 Lpe_37
v_mov_b32 v11, 0
buffer_atomic_add v11, v251, s[4:7], s36 offen sc0 sc1
s_waitcnt vmcnt(1)
v_readfirstlane_b32 s38, v234
s_nop 0
s_cmp_ge_u32 s38, 32
s_cbranch_scc1 Lpe_37
s_add_u32 s37, s37, 1
s_cmp_lt_u32 s37, 0x80000
s_cbranch_scc1 Lpoll_36
s_waitcnt vmcnt(0)
Lpo_38:
s_waitcnt vmcnt(0)
Lpe_37:
s_barrier
L_k2go2:
buffer_load_dwordx4 a[0:3], v4, s[40:43], s35 offen offset:0 sc1
buffer_load_dwordx4 a[4:7], v4, s[40:43], s35 offen offset:1024 sc1
s_xor_b32 s35, s77, 4096
buffer_load_dwordx4 a[8:11], v4, s[40:43], s35 offen offset:0 sc1
buffer_load_dwordx4 a[12:15], v4, s[40:43], s35 offen offset:1024 sc1
s_xor_b32 s35, s77, 16384
buffer_load_dwordx4 a[16:19], v4, s[40:43], s35 offen offset:0 sc1
buffer_load_dwordx4 a[20:23], v4, s[40:43], s35 offen offset:1024 sc1
s_xor_b32 s35, s77, 20480
buffer_load_dwordx4 a[24:27], v4, s[40:43], s35 offen offset:0 sc1
buffer_load_dwordx4 a[28:31], v4, s[40:43], s35 offen offset:1024 sc1
s_xor_b32 s35, s77, 32768
buffer_load_dwordx4 a[32:35], v4, s[40:43], s35 offen offset:0 sc1
buffer_load_dwordx4 a[36:39], v4, s[40:43], s35 offen offset:1024 sc1
s_xor_b32 s35, s77, 36864
buffer_load_dwordx4 a[40:43], v4, s[40:43], s35 offen offset:0 sc1
buffer_load_dwordx4 a[44:47], v4, s[40:43], s35 offen offset:1024 sc1
s_xor_b32 s35, s77, 49152
ds_read_b128 a[96:99], v5 offset:0
ds_read_b128 a[100:103], v5 offset:1024
ds_read_b128 a[104:107], v5 offset:2048
ds_read_b128 a[108:111], v5 offset:3072
ds_read_b128 a[112:115], v5 offset:4096
ds_read_b128 a[116:119], v5 offset:5120
ds_read_b128 a[120:123], v5 offset:6144
ds_read_b128 a[124:127], v5 offset:7168
s_waitcnt vmcnt(10) lgkmcnt(4)
v_mfma_f32_16x16x32_bf16 v[132:135], a[96:99], a[0:3], v[132:135]
ds_read_b128 a[128:131], v5 offset:8192
v_mfma_f32_16x16x32_bf16 v[148:151], a[96:99], a[4:7], v[148:151]
ds_read_b128 a[132:135], v5 offset:9216
v_mfma_f32_16x16x32_bf16 v[152:155], a[100:103], a[4:7], v[152:155]
buffer_load_dwordx4 a[48:51], v4, s[40:43], s35 offen offset:0 sc1
v_mfma_f32_16x16x32_bf16 v[136:139], a[100:103], a[0:3], v[136:139]
ds_read_b128 a[136:139], v5 offset:10240
v_mfma_f32_16x16x32_bf16 v[140:143], a[104:107], a[0:3], v[140:143]
ds_read_b128 a[140:143], v5 offset:11264
v_mfma_f32_16x16x32_bf16 v[156:159], a[104:107], a[4:7], v[156:159]
v_mfma_f32_16x16x32_bf16 v[160:163], a[108:111], a[4:7], v[160:163]
buffer_load_dwordx4 a[52:55], v4, s[40:43], s35 offen offset:1024 sc1
s_xor_b32 s35, s77, 53248
v_mfma_f32_16x16x32_bf16 v[144:147], a[108:111], a[0:3], v[144:147]
s_waitcnt vmcnt(10) lgkmcnt(4)
v_mfma_f32_16x16x32_bf16 v[132:135], a[112:115], a[8:11], v[132:135]
ds_read_b128 a[96:99], v5 offset:12288
v_mfma_f32_16x16x32_bf16 v[148:151], a[112:115], a[12:15], v[148:151]
ds_read_b128 a[100:103], v5 offset:13312
v_mfma_f32_16x16x32_bf16 v[152:155], a[116:119], a[12:15], v[152:155]
buffer_load_dwordx4 a[0:3], v4, s[40:43], s35 offen offset:0 sc1
v_mfma_f32_16x16x32_bf16 v[136:139], a[116:119], a[8:11], v[136:139]
ds_read_b128 a[104:107], v5 offset:14336
v_mfma_f32_16x16x32_bf16 v[140:143], a[120:123], a[8:11], v[140:143]
ds_read_b128 a[108:111], v5 offset:15360
v_mfma_f32_16x16x32_bf16 v[156:159], a[120:123], a[12:15], v[156:159]
v_mfma_f32_16x16x32_bf16 v[160:163], a[124:127], a[12:15], v[160:163]
buffer_load_dwordx4 a[4:7], v4, s[40:43], s35 offen offset:1024 sc1
s_xor_b32 s35, s77, 65536
v_mfma_f32_16x16x32_bf16 v[144:147], a[124:127], a[8:11], v[144:147]
s_waitcnt vmcnt(10) lgkmcnt(4)
v_mfma_f32_16x16x32_bf16 v[132:135], a[128:131], a[16:19], v[132:135]
ds_read_b128 a[112:115], v5 offset:16384
v_mfma_f32_16x16x32_bf16 v[148:151], a[128:131], a[20:23], v[148:151]
ds_read_b128 a[116:119], v5 offset:17408
v_mfma_f32_16x16x32_bf16 v[152:155], a[132:135], a[20:23], v[152:155]
buffer_load_dwordx4 a[8:11], v4, s[40:43], s35 offen offset:0 sc1
v_mfma_f32_16x16x32_bf16 v[136:139], a[132:135], a[16:19], v[136:139]
ds_read_b128 a[120:123], v5 offset:18432
v_mfma_f32_16x16x32_bf16 v[140:143], a[136:139], a[16:19], v[140:143]
ds_read_b128 a[124:127], v5 offset:19456
v_mfma_f32_16x16x32_bf16 v[156:159], a[136:139], a[20:23], v[156:159]
v_mfma_f32_16x16x32_bf16 v[160:163], a[140:143], a[20:23], v[160:163]
buffer_load_dwordx4 a[12:15], v4, s[40:43], s35 offen offset:1024 sc1
s_xor_b32 s35, s77, 69632
v_mfma_f32_16x16x32_bf16 v[144:147], a[140:143], a[16:19], v[144:147]
s_waitcnt vmcnt(10) lgkmcnt(4)
v_mfma_f32_16x16x32_bf16 v[132:135], a[96:99], a[24:27], v[132:135]
ds_read_b128 a[128:131], v5 offset:20480
v_mfma_f32_16x16x32_bf16 v[148:151], a[96:99], a[28:31], v[148:151]
ds_read_b128 a[132:135], v5 offset:21504
v_mfma_f32_16x16x32_bf16 v[152:155], a[100:103], a[28:31], v[152:155]
buffer_load_dwordx4 a[16:19], v4, s[40:43], s35 offen offset:0 sc1
v_mfma_f32_16x16x32_bf16 v[136:139], a[100:103], a[24:27], v[136:139]
ds_read_b128 a[136:139], v5 offset:22528
v_mfma_f32_16x16x32_bf16 v[140:143], a[104:107], a[24:27], v[140:143]
ds_read_b128 a[140:143], v5 offset:23552
v_mfma_f32_16x16x32_bf16 v[156:159], a[104:107], a[28:31], v[156:159]
v_mfma_f32_16x16x32_bf16 v[160:163], a[108:111], a[28:31], v[160:163]
buffer_load_dwordx4 a[20:23], v4, s[40:43], s35 offen offset:1024 sc1
s_xor_b32 s35, s77, 81920
v_mfma_f32_16x16x32_bf16 v[144:147], a[108:111], a[24:27], v[144:147]
s_waitcnt vmcnt(10) lgkmcnt(4)
v_mfma_f32_16x16x32_bf16 v[132:135], a[112:115], a[32:35], v[132:135]
ds_read_b128 a[96:99], v5 offset:24576
v_mfma_f32_16x16x32_bf16 v[148:151], a[112:115], a[36:39], v[148:151]
ds_read_b128 a[100:103], v5 offset:25600
v_mfma_f32_16x16x32_bf16 v[152:155], a[116:119], a[36:39], v[152:155]
buffer_load_dwordx4 a[24:27], v4, s[40:43], s35 offen offset:0 sc1
v_mfma_f32_16x16x32_bf16 v[136:139], a[116:119], a[32:35], v[136:139]
ds_read_b128 a[104:107], v5 offset:26624
v_mfma_f32_16x16x32_bf16 v[140:143], a[120:123], a[32:35], v[140:143]
ds_read_b128 a[108:111], v5 offset:27648
v_mfma_f32_16x16x32_bf16 v[156:159], a[120:123], a[36:39], v[156:159]
v_mfma_f32_16x16x32_bf16 v[160:163], a[124:127], a[36:39], v[160:163]
buffer_load_dwordx4 a[28:31], v4, s[40:43], s35 offen offset:1024 sc1
s_xor_b32 s35, s77, 86016
v_mfma_f32_16x16x32_bf16 v[144:147], a[124:127], a[32:35], v[144:147]
s_waitcnt vmcnt(10) lgkmcnt(4)
v_mfma_f32_16x16x32_bf16 v[132:135], a[128:131], a[40:43], v[132:135]
ds_read_b128 a[112:115], v5 offset:28672
v_mfma_f32_16x16x32_bf16 v[148:151], a[128:131], a[44:47], v[148:151]
ds_read_b128 a[116:119], v5 offset:29696
v_mfma_f32_16x16x32_bf16 v[152:155], a[132:135], a[44:47], v[152:155]
buffer_load_dwordx4 a[32:35], v4, s[40:43], s35 offen offset:0 sc1
v_mfma_f32_16x16x32_bf16 v[136:139], a[132:135], a[40:43], v[136:139]
ds_read_b128 a[120:123], v5 offset:30720
v_mfma_f32_16x16x32_bf16 v[140:143], a[136:139], a[40:43], v[140:143]
ds_read_b128 a[124:127], v5 offset:31744
v_mfma_f32_16x16x32_bf16 v[156:159], a[136:139], a[44:47], v[156:159]
v_mfma_f32_16x16x32_bf16 v[160:163], a[140:143], a[44:47], v[160:163]
buffer_load_dwordx4 a[36:39], v4, s[40:43], s35 offen offset:1024 sc1
s_xor_b32 s35, s77, 98304
v_mfma_f32_16x16x32_bf16 v[144:147], a[140:143], a[40:43], v[144:147]
s_waitcnt vmcnt(10) lgkmcnt(4)
v_mfma_f32_16x16x32_bf16 v[132:135], a[96:99], a[48:51], v[132:135]
ds_read_b128 a[128:131], v5 offset:32768
v_mfma_f32_16x16x32_bf16 v[148:151], a[96:99], a[52:55], v[148:151]
ds_read_b128 a[132:135], v5 offset:33792
v_mfma_f32_16x16x32_bf16 v[152:155], a[100:103], a[52:55], v[152:155]
buffer_load_dwordx4 a[40:43], v4, s[40:43], s35 offen offset:0 sc1
v_mfma_f32_16x16x32_bf16 v[136:139], a[100:103], a[48:51], v[136:139]
ds_read_b128 a[136:139], v5 offset:34816
v_mfma_f32_16x16x32_bf16 v[140:143], a[104:107], a[48:51], v[140:143]
ds_read_b128 a[140:143], v5 offset:35840
v_mfma_f32_16x16x32_bf16 v[156:159], a[104:107], a[52:55], v[156:159]
v_mfma_f32_16x16x32_bf16 v[160:163], a[108:111], a[52:55], v[160:163]
buffer_load_dwordx4 a[44:47], v4, s[40:43], s35 offen offset:1024 sc1
s_xor_b32 s35, s77, 102400
v_mfma_f32_16x16x32_bf16 v[144:147], a[108:111], a[48:51], v[144:147]
s_waitcnt vmcnt(10) lgkmcnt(4)
v_mfma_f32_16x16x32_bf16 v[132:135], a[112:115], a[0:3], v[132:135]
ds_read_b128 a[96:99], v5 offset:36864
v_mfma_f32_16x16x32_bf16 v[148:151], a[112:115], a[4:7], v[148:151]
ds_read_b128 a[100:103], v5 offset:37888
v_mfma_f32_16x16x32_bf16 v[152:155], a[116:119], a[4:7], v[152:155]
buffer_load_dwordx4 a[48:51], v4, s[40:43], s35 offen offset:0 sc1
v_mfma_f32_16x16x32_bf16 v[136:139], a[116:119], a[0:3], v[136:139]
ds_read_b128 a[104:107], v5 offset:38912
v_mfma_f32_16x16x32_bf16 v[140:143], a[120:123], a[0:3], v[140:143]
ds_read_b128 a[108:111], v5 offset:39936
v_mfma_f32_16x16x32_bf16 v[156:159], a[120:123], a[4:7], v[156:159]
v_mfma_f32_16x16x32_bf16 v[160:163], a[124:127], a[4:7], v[160:163]
buffer_load_dwordx4 a[52:55], v4, s[40:43], s35 offen offset:1024 sc1
s_xor_b32 s35, s77, 114688
v_mfma_f32_16x16x32_bf16 v[144:147], a[124:127], a[0:3], v[144:147]
s_waitcnt vmcnt(10) lgkmcnt(4)
v_mfma_f32_16x16x32_bf16 v[132:135], a[128:131], a[8:11], v[132:135]
ds_read_b128 a[112:115], v5 offset:40960
v_mfma_f32_16x16x32_bf16 v[148:151], a[128:131], a[12:15], v[148:151]
ds_read_b128 a[116:119], v5 offset:41984
v_mfma_f32_16x16x32_bf16 v[152:155], a[132:135], a[12:15], v[152:155]
buffer_load_dwordx4 a[0:3], v4, s[40:43], s35 offen offset:0 sc1
v_mfma_f32_16x16x32_bf16 v[136:139], a[132:135], a[8:11], v[136:139]
ds_read_b128 a[120:123], v5 offset:43008
v_mfma_f32_16x16x32_bf16 v[140:143], a[136:139], a[8:11], v[140:143]
ds_read_b128 a[124:127], v5 offset:44032
v_mfma_f32_16x16x32_bf16 v[156:159], a[136:139], a[12:15], v[156:159]
v_mfma_f32_16x16x32_bf16 v[160:163], a[140:143], a[12:15], v[160:163]
buffer_load_dwordx4 a[4:7], v4, s[40:43], s35 offen offset:1024 sc1
s_xor_b32 s35, s77, 118784
v_mfma_f32_16x16x32_bf16 v[144:147], a[140:143], a[8:11], v[144:147]
s_waitcnt vmcnt(10) lgkmcnt(4)
v_mfma_f32_16x16x32_bf16 v[132:135], a[96:99], a[16:19], v[132:135]
ds_read_b128 a[128:131], v5 offset:45056
v_mfma_f32_16x16x32_bf16 v[148:151], a[96:99], a[20:23], v[148:151]
ds_read_b128 a[132:135], v5 offset:46080
v_mfma_f32_16x16x32_bf16 v[152:155], a[100:103], a[20:23], v[152:155]
buffer_load_dwordx4 a[8:11], v4, s[40:43], s35 offen offset:0 sc1
v_mfma_f32_16x16x32_bf16 v[136:139], a[100:103], a[16:19], v[136:139]
ds_read_b128 a[136:139], v5 offset:47104
v_mfma_f32_16x16x32_bf16 v[140:143], a[104:107], a[16:19], v[140:143]
ds_read_b128 a[140:143], v5 offset:48128
v_mfma_f32_16x16x32_bf16 v[156:159], a[104:107], a[20:23], v[156:159]
v_mfma_f32_16x16x32_bf16 v[160:163], a[108:111], a[20:23], v[160:163]
buffer_load_dwordx4 a[12:15], v4, s[40:43], s35 offen offset:1024 sc1
s_xor_b32 s35, s77, 524288
v_mfma_f32_16x16x32_bf16 v[144:147], a[108:111], a[16:19], v[144:147]
s_waitcnt vmcnt(10) lgkmcnt(4)
v_mfma_f32_16x16x32_bf16 v[132:135], a[112:115], a[24:27], v[132:135]
ds_read_b128 a[96:99], v5 offset:49152
v_mfma_f32_16x16x32_bf16 v[148:151], a[112:115], a[28:31], v[148:151]
ds_read_b128 a[100:103], v5 offset:50176
v_mfma_f32_16x16x32_bf16 v[152:155], a[116:119], a[28:31], v[152:155]
buffer_load_dwordx4 a[16:19], v4, s[40:43], s35 offen offset:0 sc1
v_mfma_f32_16x16x32_bf16 v[136:139], a[116:119], a[24:27], v[136:139]
ds_read_b128 a[104:107], v5 offset:51200
v_mfma_f32_16x16x32_bf16 v[140:143], a[120:123], a[24:27], v[140:143]
ds_read_b128 a[108:111], v5 offset:52224
v_mfma_f32_16x16x32_bf16 v[156:159], a[120:123], a[28:31], v[156:159]
v_mfma_f32_16x16x32_bf16 v[160:163], a[124:127], a[28:31], v[160:163]
buffer_load_dwordx4 a[20:23], v4, s[40:43], s35 offen offset:1024 sc1
s_xor_b32 s35, s77, 528384
v_mfma_f32_16x16x32_bf16 v[144:147], a[124:127], a[24:27], v[144:147]
s_waitcnt vmcnt(10) lgkmcnt(4)
v_mfma_f32_16x16x32_bf16 v[132:135], a[128:131], a[32:35], v[132:135]
ds_read_b128 a[112:115], v5 offset:53248
v_mfma_f32_16x16x32_bf16 v[148:151], a[128:131], a[36:39], v[148:151]
ds_read_b128 a[116:119], v5 offset:54272
v_mfma_f32_16x16x32_bf16 v[152:155], a[132:135], a[36:39], v[152:155]
buffer_load_dwordx4 a[24:27], v4, s[40:43], s35 offen offset:0 sc1
v_mfma_f32_16x16x32_bf16 v[136:139], a[132:135], a[32:35], v[136:139]
ds_read_b128 a[120:123], v5 offset:55296
v_mfma_f32_16x16x32_bf16 v[140:143], a[136:139], a[32:35], v[140:143]
ds_read_b128 a[124:127], v5 offset:56320
v_mfma_f32_16x16x32_bf16 v[156:159], a[136:139], a[36:39], v[156:159]
v_mfma_f32_16x16x32_bf16 v[160:163], a[140:143], a[36:39], v[160:163]
buffer_load_dwordx4 a[28:31], v4, s[40:43], s35 offen offset:1024 sc1
s_xor_b32 s35, s77, 540672
v_mfma_f32_16x16x32_bf16 v[144:147], a[140:143], a[32:35], v[144:147]
s_waitcnt vmcnt(10) lgkmcnt(4)
v_mfma_f32_16x16x32_bf16 v[132:135], a[96:99], a[40:43], v[132:135]
ds_read_b128 a[128:131], v5 offset:57344
v_mfma_f32_16x16x32_bf16 v[148:151], a[96:99], a[44:47], v[148:151]
ds_read_b128 a[132:135], v5 offset:58368
v_mfma_f32_16x16x32_bf16 v[152:155], a[100:103], a[44:47], v[152:155]
buffer_load_dwordx4 a[32:35], v4, s[40:43], s35 offen offset:0 sc1
v_mfma_f32_16x16x32_bf16 v[136:139], a[100:103], a[40:43], v[136:139]
ds_read_b128 a[136:139], v5 offset:59392
v_mfma_f32_16x16x32_bf16 v[140:143], a[104:107], a[40:43], v[140:143]
ds_read_b128 a[140:143], v5 offset:60416
v_mfma_f32_16x16x32_bf16 v[156:159], a[104:107], a[44:47], v[156:159]
v_mfma_f32_16x16x32_bf16 v[160:163], a[108:111], a[44:47], v[160:163]
buffer_load_dwordx4 a[36:39], v4, s[40:43], s35 offen offset:1024 sc1
s_xor_b32 s35, s77, 544768
v_mfma_f32_16x16x32_bf16 v[144:147], a[108:111], a[40:43], v[144:147]
s_waitcnt vmcnt(10) lgkmcnt(4)
v_mfma_f32_16x16x32_bf16 v[132:135], a[112:115], a[48:51], v[132:135]
ds_read_b128 a[96:99], v5 offset:61440
v_mfma_f32_16x16x32_bf16 v[148:151], a[112:115], a[52:55], v[148:151]
ds_read_b128 a[100:103], v5 offset:62464
v_mfma_f32_16x16x32_bf16 v[152:155], a[116:119], a[52:55], v[152:155]
buffer_load_dwordx4 a[40:43], v4, s[40:43], s35 offen offset:0 sc1
v_mfma_f32_16x16x32_bf16 v[136:139], a[116:119], a[48:51], v[136:139]
ds_read_b128 a[104:107], v5 offset:63488
v_mfma_f32_16x16x32_bf16 v[140:143], a[120:123], a[48:51], v[140:143]
ds_read_b128 a[108:111], v5 offset:64512
v_mfma_f32_16x16x32_bf16 v[156:159], a[120:123], a[52:55], v[156:159]
v_mfma_f32_16x16x32_bf16 v[160:163], a[124:127], a[52:55], v[160:163]
buffer_load_dwordx4 a[44:47], v4, s[40:43], s35 offen offset:1024 sc1
s_xor_b32 s35, s77, 557056
v_mfma_f32_16x16x32_bf16 v[144:147], a[124:127], a[48:51], v[144:147]
s_waitcnt vmcnt(10) lgkmcnt(4)
v_mfma_f32_16x16x32_bf16 v[132:135], a[128:131], a[0:3], v[132:135]
ds_read_b128 a[112:115], v6 offset:0
v_mfma_f32_16x16x32_bf16 v[148:151], a[128:131], a[4:7], v[148:151]
ds_read_b128 a[116:119], v6 offset:1024
v_mfma_f32_16x16x32_bf16 v[152:155], a[132:135], a[4:7], v[152:155]
buffer_load_dwordx4 a[48:51], v4, s[40:43], s35 offen offset:0 sc1
v_mfma_f32_16x16x32_bf16 v[136:139], a[132:135], a[0:3], v[136:139]
ds_read_b128 a[120:123], v6 offset:2048
v_mfma_f32_16x16x32_bf16 v[140:143], a[136:139], a[0:3], v[140:143]
ds_read_b128 a[124:127], v6 offset:3072
v_mfma_f32_16x16x32_bf16 v[156:159], a[136:139], a[4:7], v[156:159]
v_mfma_f32_16x16x32_bf16 v[160:163], a[140:143], a[4:7], v[160:163]
buffer_load_dwordx4 a[52:55], v4, s[40:43], s35 offen offset:1024 sc1
s_xor_b32 s35, s77, 561152
v_mfma_f32_16x16x32_bf16 v[144:147], a[140:143], a[0:3], v[144:147]
s_waitcnt vmcnt(10) lgkmcnt(4)
v_mfma_f32_16x16x32_bf16 v[132:135], a[96:99], a[8:11], v[132:135]
ds_read_b128 a[128:131], v6 offset:4096
v_mfma_f32_16x16x32_bf16 v[148:151], a[96:99], a[12:15], v[148:151]
ds_read_b128 a[132:135], v6 offset:5120
v_mfma_f32_16x16x32_bf16 v[152:155], a[100:103], a[12:15], v[152:155]
buffer_load_dwordx4 a[0:3], v4, s[40:43], s35 offen offset:0 sc1
v_mfma_f32_16x16x32_bf16 v[136:139], a[100:103], a[8:11], v[136:139]
ds_read_b128 a[136:139], v6 offset:6144
v_mfma_f32_16x16x32_bf16 v[140:143], a[104:107], a[8:11], v[140:143]
ds_read_b128 a[140:143], v6 offset:7168
v_mfma_f32_16x16x32_bf16 v[156:159], a[104:107], a[12:15], v[156:159]
v_mfma_f32_16x16x32_bf16 v[160:163], a[108:111], a[12:15], v[160:163]
buffer_load_dwordx4 a[4:7], v4, s[40:43], s35 offen offset:1024 sc1
s_xor_b32 s35, s77, 573440
v_mfma_f32_16x16x32_bf16 v[144:147], a[108:111], a[8:11], v[144:147]
s_waitcnt vmcnt(10) lgkmcnt(4)
v_mfma_f32_16x16x32_bf16 v[132:135], a[112:115], a[16:19], v[132:135]
ds_read_b128 a[96:99], v6 offset:8192
v_mfma_f32_16x16x32_bf16 v[148:151], a[112:115], a[20:23], v[148:151]
ds_read_b128 a[100:103], v6 offset:9216
v_mfma_f32_16x16x32_bf16 v[152:155], a[116:119], a[20:23], v[152:155]
buffer_load_dwordx4 a[8:11], v4, s[40:43], s35 offen offset:0 sc1
v_mfma_f32_16x16x32_bf16 v[136:139], a[116:119], a[16:19], v[136:139]
ds_read_b128 a[104:107], v6 offset:10240
v_mfma_f32_16x16x32_bf16 v[140:143], a[120:123], a[16:19], v[140:143]
ds_read_b128 a[108:111], v6 offset:11264
v_mfma_f32_16x16x32_bf16 v[156:159], a[120:123], a[20:23], v[156:159]
v_mfma_f32_16x16x32_bf16 v[160:163], a[124:127], a[20:23], v[160:163]
buffer_load_dwordx4 a[12:15], v4, s[40:43], s35 offen offset:1024 sc1
s_xor_b32 s35, s77, 577536
v_mfma_f32_16x16x32_bf16 v[144:147], a[124:127], a[16:19], v[144:147]
s_waitcnt vmcnt(10) lgkmcnt(4)
v_mfma_f32_16x16x32_bf16 v[132:135], a[128:131], a[24:27], v[132:135]
ds_read_b128 a[112:115], v6 offset:12288
v_mfma_f32_16x16x32_bf16 v[148:151], a[128:131], a[28:31], v[148:151]
ds_read_b128 a[116:119], v6 offset:13312
v_mfma_f32_16x16x32_bf16 v[152:155], a[132:135], a[28:31], v[152:155]
buffer_load_dwordx4 a[16:19], v4, s[40:43], s35 offen offset:0 sc1
v_mfma_f32_16x16x32_bf16 v[136:139], a[132:135], a[24:27], v[136:139]
ds_read_b128 a[120:123], v6 offset:14336
v_mfma_f32_16x16x32_bf16 v[140:143], a[136:139], a[24:27], v[140:143]
ds_read_b128 a[124:127], v6 offset:15360
v_mfma_f32_16x16x32_bf16 v[156:159], a[136:139], a[28:31], v[156:159]
v_mfma_f32_16x16x32_bf16 v[160:163], a[140:143], a[28:31], v[160:163]
buffer_load_dwordx4 a[20:23], v4, s[40:43], s35 offen offset:1024 sc1
s_xor_b32 s35, s77, 589824
v_mfma_f32_16x16x32_bf16 v[144:147], a[140:143], a[24:27], v[144:147]
s_waitcnt vmcnt(10) lgkmcnt(4)
v_mfma_f32_16x16x32_bf16 v[132:135], a[96:99], a[32:35], v[132:135]
ds_read_b128 a[128:131], v6 offset:16384
v_mfma_f32_16x16x32_bf16 v[148:151], a[96:99], a[36:39], v[148:151]
ds_read_b128 a[132:135], v6 offset:17408
v_mfma_f32_16x16x32_bf16 v[152:155], a[100:103], a[36:39], v[152:155]
buffer_load_dwordx4 a[24:27], v4, s[40:43], s35 offen offset:0 sc1
v_mfma_f32_16x16x32_bf16 v[136:139], a[100:103], a[32:35], v[136:139]
ds_read_b128 a[136:139], v6 offset:18432
v_mfma_f32_16x16x32_bf16 v[140:143], a[104:107], a[32:35], v[140:143]
ds_read_b128 a[140:143], v6 offset:19456
v_mfma_f32_16x16x32_bf16 v[156:159], a[104:107], a[36:39], v[156:159]
v_mfma_f32_16x16x32_bf16 v[160:163], a[108:111], a[36:39], v[160:163]
buffer_load_dwordx4 a[28:31], v4, s[40:43], s35 offen offset:1024 sc1
s_xor_b32 s35, s77, 593920
v_mfma_f32_16x16x32_bf16 v[144:147], a[108:111], a[32:35], v[144:147]
s_waitcnt vmcnt(10) lgkmcnt(4)
v_mfma_f32_16x16x32_bf16 v[132:135], a[112:115], a[40:43], v[132:135]
ds_read_b128 a[96:99], v6 offset:20480
v_mfma_f32_16x16x32_bf16 v[148:151], a[112:115], a[44:47], v[148:151]
ds_read_b128 a[100:103], v6 offset:21504
v_mfma_f32_16x16x32_bf16 v[152:155], a[116:119], a[44:47], v[152:155]
buffer_load_dwordx4 a[32:35], v4, s[40:43], s35 offen offset:0 sc1
v_mfma_f32_16x16x32_bf16 v[136:139], a[116:119], a[40:43], v[136:139]
ds_read_b128 a[104:107], v6 offset:22528
v_mfma_f32_16x16x32_bf16 v[140:143], a[120:123], a[40:43], v[140:143]
ds_read_b128 a[108:111], v6 offset:23552
v_mfma_f32_16x16x32_bf16 v[156:159], a[120:123], a[44:47], v[156:159]
v_mfma_f32_16x16x32_bf16 v[160:163], a[124:127], a[44:47], v[160:163]
buffer_load_dwordx4 a[36:39], v4, s[40:43], s35 offen offset:1024 sc1
s_xor_b32 s35, s77, 606208
v_mfma_f32_16x16x32_bf16 v[144:147], a[124:127], a[40:43], v[144:147]
s_waitcnt vmcnt(10) lgkmcnt(4)
v_mfma_f32_16x16x32_bf16 v[132:135], a[128:131], a[48:51], v[132:135]
ds_read_b128 a[112:115], v6 offset:24576
v_mfma_f32_16x16x32_bf16 v[148:151], a[128:131], a[52:55], v[148:151]
ds_read_b128 a[116:119], v6 offset:25600
v_mfma_f32_16x16x32_bf16 v[152:155], a[132:135], a[52:55], v[152:155]
buffer_load_dwordx4 a[40:43], v4, s[40:43], s35 offen offset:0 sc1
v_mfma_f32_16x16x32_bf16 v[136:139], a[132:135], a[48:51], v[136:139]
ds_read_b128 a[120:123], v6 offset:26624
v_mfma_f32_16x16x32_bf16 v[140:143], a[136:139], a[48:51], v[140:143]
ds_read_b128 a[124:127], v6 offset:27648
v_mfma_f32_16x16x32_bf16 v[156:159], a[136:139], a[52:55], v[156:159]
v_mfma_f32_16x16x32_bf16 v[160:163], a[140:143], a[52:55], v[160:163]
buffer_load_dwordx4 a[44:47], v4, s[40:43], s35 offen offset:1024 sc1
s_xor_b32 s35, s77, 610304
v_mfma_f32_16x16x32_bf16 v[144:147], a[140:143], a[48:51], v[144:147]
s_waitcnt vmcnt(10) lgkmcnt(4)
v_mfma_f32_16x16x32_bf16 v[132:135], a[96:99], a[0:3], v[132:135]
ds_read_b128 a[128:131], v6 offset:28672
v_mfma_f32_16x16x32_bf16 v[148:151], a[96:99], a[4:7], v[148:151]
ds_read_b128 a[132:135], v6 offset:29696
v_mfma_f32_16x16x32_bf16 v[152:155], a[100:103], a[4:7], v[152:155]
buffer_load_dwordx4 a[48:51], v4, s[40:43], s35 offen offset:0 sc1
v_mfma_f32_16x16x32_bf16 v[136:139], a[100:103], a[0:3], v[136:139]
ds_read_b128 a[136:139], v6 offset:30720
v_mfma_f32_16x16x32_bf16 v[140:143], a[104:107], a[0:3], v[140:143]
ds_read_b128 a[140:143], v6 offset:31744
v_mfma_f32_16x16x32_bf16 v[156:159], a[104:107], a[4:7], v[156:159]
v_mfma_f32_16x16x32_bf16 v[160:163], a[108:111], a[4:7], v[160:163]
buffer_load_dwordx4 a[52:55], v4, s[40:43], s35 offen offset:1024 sc1
s_xor_b32 s35, s77, 622592
v_mfma_f32_16x16x32_bf16 v[144:147], a[108:111], a[0:3], v[144:147]
s_waitcnt vmcnt(10) lgkmcnt(4)
v_mfma_f32_16x16x32_bf16 v[132:135], a[112:115], a[8:11], v[132:135]
ds_read_b128 a[96:99], v6 offset:32768
v_mfma_f32_16x16x32_bf16 v[148:151], a[112:115], a[12:15], v[148:151]
ds_read_b128 a[100:103], v6 offset:33792
v_mfma_f32_16x16x32_bf16 v[152:155], a[116:119], a[12:15], v[152:155]
buffer_load_dwordx4 a[0:3], v4, s[40:43], s35 offen offset:0 sc1
v_mfma_f32_16x16x32_bf16 v[136:139], a[116:119], a[8:11], v[136:139]
ds_read_b128 a[104:107], v6 offset:34816
v_mfma_f32_16x16x32_bf16 v[140:143], a[120:123], a[8:11], v[140:143]
ds_read_b128 a[108:111], v6 offset:35840
v_mfma_f32_16x16x32_bf16 v[156:159], a[120:123], a[12:15], v[156:159]
v_mfma_f32_16x16x32_bf16 v[160:163], a[124:127], a[12:15], v[160:163]
buffer_load_dwordx4 a[4:7], v4, s[40:43], s35 offen offset:1024 sc1
s_xor_b32 s35, s77, 626688
L_stub14:
s_cbranch_execz L_wret5
v_mfma_f32_16x16x32_bf16 v[144:147], a[124:127], a[8:11], v[144:147]
s_waitcnt vmcnt(10) lgkmcnt(4)
v_mfma_f32_16x16x32_bf16 v[132:135], a[128:131], a[16:19], v[132:135]
ds_read_b128 a[112:115], v6 offset:36864
v_mfma_f32_16x16x32_bf16 v[148:151], a[128:131], a[20:23], v[148:151]
ds_read_b128 a[116:119], v6 offset:37888
v_mfma_f32_16x16x32_bf16 v[152:155], a[132:135], a[20:23], v[152:155]
buffer_load_dwordx4 a[8:11], v4, s[40:43], s35 offen offset:0 sc1
v_mfma_f32_16x16x32_bf16 v[136:139], a[132:135], a[16:19], v[136:139]
ds_read_b128 a[120:123], v6 offset:38912
v_mfma_f32_16x16x32_bf16 v[140:143], a[136:139], a[16:19], v[140:143]
ds_read_b128 a[124:127], v6 offset:39936
v_mfma_f32_16x16x32_bf16 v[156:159], a[136:139], a[20:23], v[156:159]
v_mfma_f32_16x16x32_bf16 v[160:163], a[140:143], a[20:23], v[160:163]
buffer_load_dwordx4 a[12:15], v4, s[40:43], s35 offen offset:1024 sc1
s_xor_b32 s35, s77, 638976
v_mfma_f32_16x16x32_bf16 v[144:147], a[140:143], a[16:19], v[144:147]
s_waitcnt vmcnt(10) lgkmcnt(4)
v_mfma_f32_16x16x32_bf16 v[132:135], a[96:99], a[24:27], v[132:135]
ds_read_b128 a[128:131], v6 offset:40960
v_mfma_f32_16x16x32_bf16 v[148:151], a[96:99], a[28:31], v[148:151]
ds_read_b128 a[132:135], v6 offset:41984
v_mfma_f32_16x16x32_bf16 v[152:155], a[100:103], a[28:31], v[152:155]
buffer_load_dwordx4 a[16:19], v4, s[40:43], s35 offen offset:0 sc1
v_mfma_f32_16x16x32_bf16 v[136:139], a[100:103], a[24:27], v[136:139]
ds_read_b128 a[136:139], v6 offset:43008
v_mfma_f32_16x16x32_bf16 v[140:143], a[104:107], a[24:27], v[140:143]
ds_read_b128 a[140:143], v6 offset:44032
v_mfma_f32_16x16x32_bf16 v[156:159], a[104:107], a[28:31], v[156:159]
v_mfma_f32_16x16x32_bf16 v[160:163], a[108:111], a[28:31], v[160:163]
buffer_load_dwordx4 a[20:23], v4, s[40:43], s35 offen offset:1024 sc1
s_xor_b32 s35, s77, 643072
v_mfma_f32_16x16x32_bf16 v[144:147], a[108:111], a[24:27], v[144:147]
s_waitcnt vmcnt(10) lgkmcnt(4)
v_mfma_f32_16x16x32_bf16 v[132:135], a[112:115], a[32:35], v[132:135]
ds_read_b128 a[96:99], v6 offset:45056
v_mfma_f32_16x16x32_bf16 v[148:151], a[112:115], a[36:39], v[148:151]
ds_read_b128 a[100:103], v6 offset:46080
v_mfma_f32_16x16x32_bf16 v[152:155], a[116:119], a[36:39], v[152:155]
buffer_load_dwordx4 a[24:27], v4, s[40:43], s35 offen offset:0 sc1
v_mfma_f32_16x16x32_bf16 v[136:139], a[116:119], a[32:35], v[136:139]
ds_read_b128 a[104:107], v6 offset:47104
v_mfma_f32_16x16x32_bf16 v[140:143], a[120:123], a[32:35], v[140:143]
ds_read_b128 a[108:111], v6 offset:48128
v_mfma_f32_16x16x32_bf16 v[156:159], a[120:123], a[36:39], v[156:159]
v_mfma_f32_16x16x32_bf16 v[160:163], a[124:127], a[36:39], v[160:163]
buffer_load_dwordx4 a[28:31], v4, s[40:43], s35 offen offset:1024 sc1
s_xor_b32 s35, s77, 0
v_mfma_f32_16x16x32_bf16 v[144:147], a[124:127], a[32:35], v[144:147]
s_waitcnt vmcnt(10) lgkmcnt(4)
v_mfma_f32_16x16x32_bf16 v[132:135], a[128:131], a[40:43], v[132:135]
s_add_u32 m0, s18, 0x0
s_add_u32 s44, s50, 0x2800000
v_mfma_f32_16x16x32_bf16 v[148:151], a[128:131], a[44:47], v[148:151]
ds_read_b128 a[112:115], v6 offset:49152
v_mfma_f32_16x16x32_bf16 v[152:155], a[132:135], a[44:47], v[152:155]
buffer_load_dwordx4 v1, s[4:7], s44 offen offset:0 sc1 lds
v_mfma_f32_16x16x32_bf16 v[136:139], a[132:135], a[40:43], v[136:139]
ds_read_b128 a[116:119], v6 offset:50176
v_mfma_f32_16x16x32_bf16 v[140:143], a[136:139], a[40:43], v[140:143]
ds_read_b128 a[120:123], v6 offset:51200
v_mfma_f32_16x16x32_bf16 v[156:159], a[136:139], a[44:47], v[156:159]
ds_read_b128 a[124:127], v6 offset:52224
v_mfma_f32_16x16x32_bf16 v[160:163], a[140:143], a[44:47], v[160:163]
buffer_load_dwordx4 v1, s[4:7], s44 offen offset:1024 sc1 lds
s_add_u32 m0, s18, 0x2000
v_mfma_f32_16x16x32_bf16 v[144:147], a[140:143], a[40:43], v[144:147]
s_add_u32 s44, s50, 0x2802000
s_waitcnt vmcnt(10) lgkmcnt(4)
v_mfma_f32_16x16x32_bf16 v[132:135], a[96:99], a[48:51], v[132:135]
ds_read_b128 a[128:131], v6 offset:53248
v_mfma_f32_16x16x32_bf16 v[148:151], a[96:99], a[52:55], v[148:151]
ds_read_b128 a[132:135], v6 offset:54272
v_mfma_f32_16x16x32_bf16 v[152:155], a[100:103], a[52:55], v[152:155]
buffer_load_dwordx4 v1, s[4:7], s44 offen offset:0 sc1 lds
v_mfma_f32_16x16x32_bf16 v[136:139], a[100:103], a[48:51], v[136:139]
ds_read_b128 a[136:139], v6 offset:55296
v_mfma_f32_16x16x32_bf16 v[140:143], a[104:107], a[48:51], v[140:143]
ds_read_b128 a[140:143], v6 offset:56320
v_mfma_f32_16x16x32_bf16 v[156:159], a[104:107], a[52:55], v[156:159]
v_mfma_f32_16x16x32_bf16 v[160:163], a[108:111], a[52:55], v[160:163]
buffer_load_dwordx4 v1, s[4:7], s44 offen offset:1024 sc1 lds
s_add_u32 m0, s18, 0x4000
v_mfma_f32_16x16x32_bf16 v[144:147], a[108:111], a[48:51], v[144:147]
s_add_u32 s44, s50, 0x2804000
s_waitcnt vmcnt(10) lgkmcnt(4)
v_mfma_f32_16x16x32_bf16 v[132:135], a[112:115], a[0:3], v[132:135]
ds_read_b128 a[96:99], v6 offset:57344
v_mfma_f32_16x16x32_bf16 v[148:151], a[112:115], a[4:7], v[148:151]
ds_read_b128 a[100:103], v6 offset:58368
v_mfma_f32_16x16x32_bf16 v[152:155], a[116:119], a[4:7], v[152:155]
ds_read_b128 a[104:107], v6 offset:59392
v_mfma_f32_16x16x32_bf16 v[136:139], a[116:119], a[0:3], v[136:139]
buffer_load_dwordx4 v1, s[4:7], s44 offen offset:0 sc1 lds
v_mfma_f32_16x16x32_bf16 v[140:143], a[120:123], a[0:3], v[140:143]
ds_read_b128 a[108:111], v6 offset:60416
v_mfma_f32_16x16x32_bf16 v[156:159], a[120:123], a[4:7], v[156:159]
v_mfma_f32_16x16x32_bf16 v[160:163], a[124:127], a[4:7], v[160:163]
v_mfma_f32_16x16x32_bf16 v[144:147], a[124:127], a[0:3], v[144:147]
buffer_load_dwordx4 v1, s[4:7], s44 offen offset:1024 sc1 lds
s_waitcnt vmcnt(10) lgkmcnt(4)
v_mfma_f32_16x16x32_bf16 v[132:135], a[128:131], a[8:11], v[132:135]
s_add_u32 m0, s18, 0x6000
s_add_u32 s44, s50, 0x2806000
v_mfma_f32_16x16x32_bf16 v[148:151], a[128:131], a[12:15], v[148:151]
ds_read_b128 a[112:115], v6 offset:61440
v_mfma_f32_16x16x32_bf16 v[152:155], a[132:135], a[12:15], v[152:155]
ds_read_b128 a[116:119], v6 offset:62464
v_mfma_f32_16x16x32_bf16 v[136:139], a[132:135], a[8:11], v[136:139]
ds_read_b128 a[120:123], v6 offset:63488
v_mfma_f32_16x16x32_bf16 v[140:143], a[136:139], a[8:11], v[140:143]
buffer_load_dwordx4 v1, s[4:7], s44 offen offset:0 sc1 lds
v_mfma_f32_16x16x32_bf16 v[156:159], a[136:139], a[12:15], v[156:159]
ds_read_b128 a[124:127], v6 offset:64512
v_mfma_f32_16x16x32_bf16 v[160:163], a[140:143], a[12:15], v[160:163]
v_mfma_f32_16x16x32_bf16 v[144:147], a[140:143], a[8:11], v[144:147]
s_waitcnt vmcnt(9) lgkmcnt(4)
v_mfma_f32_16x16x32_bf16 v[132:135], a[96:99], a[16:19], v[132:135]
v_mfma_f32_16x16x32_bf16 v[148:151], a[96:99], a[20:23], v[148:151]
buffer_load_dwordx4 v1, s[4:7], s44 offen offset:1024 sc1 lds
v_mfma_f32_16x16x32_bf16 v[152:155], a[100:103], a[20:23], v[152:155]
v_mfma_f32_16x16x32_bf16 v[136:139], a[100:103], a[16:19], v[136:139]
v_mfma_f32_16x16x32_bf16 v[140:143], a[104:107], a[16:19], v[140:143]
v_mfma_f32_16x16x32_bf16 v[156:159], a[104:107], a[20:23], v[156:159]
v_mfma_f32_16x16x32_bf16 v[160:163], a[108:111], a[20:23], v[160:163]
v_mfma_f32_16x16x32_bf16 v[144:147], a[108:111], a[16:19], v[144:147]
s_waitcnt vmcnt(8) lgkmcnt(0)
v_mfma_f32_16x16x32_bf16 v[132:135], a[112:115], a[24:27], v[132:135]
v_mfma_f32_16x16x32_bf16 v[148:151], a[112:115], a[28:31], v[148:151]
v_mfma_f32_16x16x32_bf16 v[152:155], a[116:119], a[28:31], v[152:155]
v_mfma_f32_16x16x32_bf16 v[136:139], a[116:119], a[24:27], v[136:139]
v_mfma_f32_16x16x32_bf16 v[140:143], a[120:123], a[24:27], v[140:143]
v_mfma_f32_16x16x32_bf16 v[156:159], a[120:123], a[28:31], v[156:159]
v_mfma_f32_16x16x32_bf16 v[160:163], a[124:127], a[28:31], v[160:163]
v_mfma_f32_16x16x32_bf16 v[144:147], a[124:127], a[24:27], v[144:147]
s_nop 1
v_cmp_u_f32 vcc, v132, v148
s_nop 0
s_and_b32 vcc_lo, vcc_lo, s95
s_cbranch_scc1 L_k2redo2
v_cvt_pk_bf16_f32 v32, v132, v133
v_cvt_pk_bf16_f32 v33, v134, v135
v_cvt_pk_bf16_f32 v34, v136, v137
v_cvt_pk_bf16_f32 v35, v138, v139
s_add_u32 s36, s69, 0x400000
buffer_store_dwordx4 v[32:35], v4, s[4:7], s36 offen offset:0 sc1
v_cvt_pk_bf16_f32 v40, v148, v149
v_cvt_pk_bf16_f32 v41, v150, v151
v_cvt_pk_bf16_f32 v42, v152, v153
v_cvt_pk_bf16_f32 v43, v154, v155
v_cvt_pk_bf16_f32 v36, v140, v141
v_cvt_pk_bf16_f32 v37, v142, v143
v_cvt_pk_bf16_f32 v38, v144, v145
v_cvt_pk_bf16_f32 v39, v146, v147
s_add_u32 s37, s36, 4096
v_cvt_pk_bf16_f32 v44, v156, v157
v_cvt_pk_bf16_f32 v45, v158, v159
v_cvt_pk_bf16_f32 v46, v160, v161
buffer_store_dwordx4 v[40:43], v4, s[4:7], s36 offen offset:1024 sc1
v_cvt_pk_bf16_f32 v47, v162, v163
v_mfma_f32_16x16x32_bf16 v[96:99], v[32:35], v[32:35], 0
s_mov_b32 s38, 0x380000
s_add_u32 s92, s78, 0x60000
v_mfma_f32_16x16x32_bf16 v[92:95], v[16:19], v[32:35], 0
s_add_u32 s40, s4, 0x400000
s_addc_u32 s41, s5, 0
v_mfma_f32_16x16x32_bf16 v[96:99], v[36:39], v[36:39], v[96:99]
buffer_store_dwordx4 v[36:39], v4, s[4:7], s37 offen offset:0 sc1
v_mfma_f32_16x16x32_bf16 v[92:95], v[16:19], v[36:39], v[92:95]
s_nop 5
v_cndmask_b32 v96, v96, v97, s[46:47]
v_cndmask_b32 v98, v98, v99, s[46:47]
v_mfma_f32_16x16x32_bf16 v[104:107], v[40:43], v[40:43], 0
v_mfma_f32_16x16x32_bf16 v[100:103], v[16:19], v[40:43], 0
v_cndmask_b32 v93, v96, v98, s[48:49]
buffer_store_dwordx4 v[44:47], v4, s[4:7], s37 offen offset:1024 sc1
v_mfma_f32_16x16x32_bf16 v[104:107], v[44:47], v[44:47], v[104:107]
v_mfma_f32_16x16x32_bf16 v[100:103], v[16:19], v[44:47], v[100:103]
s_nop 6
v_cndmask_b32 v104, v104, v105, s[46:47]
v_cndmask_b32 v106, v106, v107, s[46:47]
buffer_store_dwordx2 v[92:93], v253, s[4:7], s38 offen offset:0 sc1
v_cndmask_b32 v101, v104, v106, s[48:49]
buffer_store_dwordx2 v[100:101], v253, s[4:7], s38 offen offset:2048 sc1
s_barrier
s_add_u32 m0, s18, 0x8000
s_add_u32 s44, s50, 0x2808000
buffer_load_dwordx4 v1, s[4:7], s44 offen offset:0 sc1 lds
buffer_load_dwordx4 v1, s[4:7], s44 offen offset:1024 sc1 lds
s_add_u32 m0, s18, 0xa000
s_add_u32 s44, s50, 0x280a000
buffer_load_dwordx4 v1, s[4:7], s44 offen offset:0 sc1 lds
buffer_load_dwordx4 v1, s[4:7], s44 offen offset:1024 sc1 lds
v_accvgpr_read_b32 v48, a216
v_accvgpr_read_b32 v49, a217
v_accvgpr_read_b32 v50, a218
v_accvgpr_read_b32 v51, a219
v_accvgpr_read_b32 v52, a220
v_accvgpr_read_b32 v53, a221
v_accvgpr_read_b32 v54, a222
v_accvgpr_read_b32 v55, a223
v_accvgpr_read_b32 v56, a224
v_accvgpr_read_b32 v57, a225
v_accvgpr_read_b32 v58, a226
v_accvgpr_read_b32 v59, a227
v_accvgpr_read_b32 v60, a228
v_accvgpr_read_b32 v61, a229
v_accvgpr_read_b32 v62, a230
v_accvgpr_read_b32 v63, a231
v_accvgpr_read_b32 v64, a232
v_accvgpr_read_b32 v65, a233
v_accvgpr_read_b32 v66, a234
v_accvgpr_read_b32 v67, a235
v_accvgpr_read_b32 v68, a236
v_accvgpr_read_b32 v69, a237
v_accvgpr_read_b32 v70, a238
v_accvgpr_read_b32 v71, a239
s_waitcnt vmcnt(4)
s_barrier
s_cmp_lg_u32 s28, 0
s_cbranch_scc1 Lsg_39
buffer_atomic_add v12, v10, s[4:7], s92 offen sc1
Lsg_39:
s_mov_b64 exec, 0
s_cmp_eq_u32 s28, 0
s_cbranch_scc1 L_stub15
L_wret6:
s_mov_b64 exec, -1
s_cmp_lt_u32 s28, 2
s_cbranch_scc1 Lwd_40
s_add_u32 m0, s19, 0xa000
s_add_u32 s44, s50, 0x280a000
s_add_u32 s44, s44, s18
buffer_load_dwordx4 v1, s[4:7], s44 offen offset:0 sc1 lds
buffer_load_dwordx4 v1, s[4:7], s44 offen offset:1024 sc1 lds
buffer_load_dwordx4 v1, s[4:7], s44 offen offset:2048 sc1 lds
buffer_load_dwordx4 v1, s[4:7], s44 offen offset:3072 sc1 lds
s_add_u32 m0, s19, 0xc000
s_add_u32 s44, s50, 0x280c000
s_add_u32 s44, s44, s18
buffer_load_dwordx4 v1, s[4:7], s44 offen offset:0 sc1 lds
buffer_load_dwordx4 v1, s[4:7], s44 offen offset:1024 sc1 lds
buffer_load_dwordx4 v1, s[4:7], s44 offen offset:2048 sc1 lds
buffer_load_dwordx4 v1, s[4:7], s44 offen offset:3072 sc1 lds
s_add_u32 m0, s19, 0xe000
s_add_u32 s44, s50, 0x280e000
s_add_u32 s44, s44, s18
buffer_load_dwordx4 v1, s[4:7], s44 offen offset:0 sc1 lds
buffer_load_dwordx4 v1, s[4:7], s44 offen offset:1024 sc1 lds
buffer_load_dwordx4 v1, s[4:7], s44 offen offset:2048 sc1 lds
buffer_load_dwordx4 v1, s[4:7], s44 offen offset:3072 sc1 lds
s_add_u32 m0, s19, 0x10000
s_add_u32 s44, s50, 0x2810000
s_add_u32 s44, s44, s18
buffer_load_dwordx4 v1, s[4:7], s44 offen offset:0 sc1 lds
buffer_load_dwordx4 v1, s[4:7], s44 offen offset:1024 sc1 lds
buffer_load_dwordx4 v1, s[4:7], s44 offen offset:2048 sc1 lds
buffer_load_dwordx4 v1, s[4:7], s44 offen offset:3072 sc1 lds
s_add_u32 m0, s19, 0x12000
s_add_u32 s44, s50, 0x2812000
s_add_u32 s44, s44, s18
buffer_load_dwordx4 v1, s[4:7], s44 offen offset:0 sc1 lds
buffer_load_dwordx4 v1, s[4:7], s44 offen offset:1024 sc1 lds
buffer_load_dwordx4 v1, s[4:7], s44 offen offset:2048 sc1 lds
buffer_load_dwordx4 v1, s[4:7], s44 offen offset:3072 sc1 lds
s_add_u32 m0, s19, 0x14000
s_add_u32 s44, s50, 0x2814000
s_add_u32 s44, s44, s18
buffer_load_dwordx4 v1, s[4:7], s44 offen offset:0 sc1 lds
buffer_load_dwordx4 v1, s[4:7], s44 offen offset:1024 sc1 lds
buffer_load_dwordx4 v1, s[4:7], s44 offen offset:2048 sc1 lds
buffer_load_dwordx4 v1, s[4:7], s44 offen offset:3072 sc1 lds
s_add_u32 m0, s19, 0x16000
s_add_u32 s44, s50, 0x2816000
s_add_u32 s44, s44, s18
buffer_load_dwordx4 v1, s[4:7], s44 offen offset:0 sc1 lds
buffer_load_dwordx4 v1, s[4:7], s44 offen offset:1024 sc1 lds
buffer_load_dwordx4 v1, s[4:7], s44 offen offset:2048 sc1 lds
buffer_load_dwordx4 v1, s[4:7], s44 offen offset:3072 sc1 lds
s_add_u32 m0, s19, 0x18000
s_add_u32 s44, s50, 0x2818000
s_add_u32 s44, s44, s18
buffer_load_dwordx4 v1, s[4:7], s44 offen offset:0 sc1 lds
buffer_load_dwordx4 v1, s[4:7], s44 offen offset:1024 sc1 lds
buffer_load_dwordx4 v1, s[4:7], s44 offen offset:2048 sc1 lds
buffer_load_dwordx4 v1, s[4:7], s44 offen offset:3072 sc1 lds
Lwd_40:
s_cmp_lg_u32 s28, 1
s_cbranch_scc1 Lpo_43
s_add_u32 s36, s34, 0x60000
s_mov_b32 s37, 0
v_mov_b32 v11, 0
buffer_atomic_add v11, v251, s[4:7], s36 offen sc0 sc1
s_sleep 4
Lpoll_41:
v_mov_b32 v234, 0
buffer_atomic_add v234, v251, s[4:7], s36 offen sc0 sc1
s_waitcnt vmcnt(1)
v_readfirstlane_b32 s38, v11
s_nop 0
s_cmp_ge_u32 s38, 32
s_cbranch_scc1 Lpe_42
v_mov_b32 v11, 0
buffer_atomic_add v11, v251, s[4:7], s36 offen sc0 sc1
s_waitcnt vmcnt(1)
v_readfirstlane_b32 s38, v234
s_nop 0
s_cmp_ge_u32 s38, 32
s_cbranch_scc1 Lpe_42
s_add_u32 s37, s37, 1
s_cmp_lt_u32 s37, 0x80000
s_cbranch_scc1 Lpoll_41
s_waitcnt vmcnt(0)
Lpo_43:
s_waitcnt vmcnt(32) lgkmcnt(0)
s_cmp_ge_u32 s28, 2
s_cbranch_scc1 Lw_44
s_waitcnt vmcnt(0)
Lw_44:
Lpe_42:
s_barrier
s_mov_b32 s35, s68
s_add_u32 s33, s35, 0x1000
buffer_load_dwordx4 a[0:3], v2, s[40:43], s35 offen offset:0 sc1
buffer_load_dwordx4 a[4:7], v2, s[40:43], s33 offen offset:0 sc1
buffer_load_dwordx4 a[8:11], v2, s[40:43], s35 offen offset:1024 sc1
buffer_load_dwordx4 a[12:15], v2, s[40:43], s33 offen offset:1024 sc1
buffer_load_dwordx4 a[16:19], v2, s[40:43], s35 offen offset:2048 sc1
buffer_load_dwordx4 a[20:23], v2, s[40:43], s33 offen offset:2048 sc1
buffer_load_dwordx4 a[24:27], v2, s[40:43], s35 offen offset:3072 sc1
buffer_load_dwordx4 a[28:31], v2, s[40:43], s33 offen offset:3072 sc1
s_add_u32 s35, s35, 0x4000
s_add_u32 s33, s33, 0x4000
buffer_load_dwordx4 a[32:35], v2, s[40:43], s35 offen offset:0 sc1
buffer_load_dwordx4 a[36:39], v2, s[40:43], s33 offen offset:0 sc1
buffer_load_dwordx4 a[40:43], v2, s[40:43], s35 offen offset:1024 sc1
buffer_load_dwordx4 a[44:47], v2, s[40:43], s33 offen offset:1024 sc1
buffer_load_dwordx4 a[48:51], v2, s[40:43], s35 offen offset:2048 sc1
buffer_load_dwordx4 a[52:55], v2, s[40:43], s33 offen offset:2048 sc1
buffer_load_dwordx4 a[56:59], v2, s[40:43], s35 offen offset:3072 sc1
buffer_load_dwordx4 a[60:63], v2, s[40:43], s33 offen offset:3072 sc1
s_add_u32 s35, s35, 0x4000
s_add_u32 s33, s33, 0x4000
v_add_u32 v5, 0, v1
ds_read_b128 a[96:99], v5 offset:2048
ds_read_b128 a[100:103], v5 offset:8192
ds_read_b128 a[104:107], v5 offset:3072
ds_read_b128 a[108:111], v5 offset:9216
ds_read_b128 a[112:115], v5 offset:4096
ds_read_b128 a[116:119], v5 offset:10240
s_waitcnt vmcnt(14) lgkmcnt(4)
v_mfma_f32_16x16x32_bf16 v[140:143], a[96:99], a[0:3], 0
s_add_u32 m0, s18, 0x1c000
s_add_u32 s44, s50, 0x281c000
v_mfma_f32_16x16x32_bf16 v[140:143], a[100:103], a[4:7], v[140:143]
buffer_load_dwordx4 a[64:67], v2, s[40:43], s35 offen offset:0 sc1
s_waitcnt vmcnt(13)
v_mfma_f32_16x16x32_bf16 v[164:167], a[100:103], a[12:15], 0
ds_read_b128 a[128:131], v5 offset:5120
v_mfma_f32_16x16x32_bf16 v[164:167], a[96:99], a[8:11], v[164:167]
ds_read_b128 a[132:135], v5 offset:11264
s_waitcnt vmcnt(12)
v_mfma_f32_16x16x32_bf16 v[188:191], a[96:99], a[16:19], 0
s_waitcnt vmcnt(11)
v_mfma_f32_16x16x32_bf16 v[188:191], a[100:103], a[20:23], v[188:191]
buffer_load_dwordx4 a[68:71], v2, s[40:43], s33 offen offset:0 sc1
s_waitcnt vmcnt(10)
v_mfma_f32_16x16x32_bf16 v[212:215], a[100:103], a[28:31], 0
ds_read_b128 a[136:139], v5 offset:0
v_mfma_f32_16x16x32_bf16 v[212:215], a[96:99], a[24:27], v[212:215]
s_waitcnt lgkmcnt(6)
v_mfma_f32_16x16x32_bf16 v[216:219], a[104:107], a[24:27], 0
ds_read_b128 a[140:143], v5 offset:6144
s_waitcnt lgkmcnt(6)
v_mfma_f32_16x16x32_bf16 v[216:219], a[108:111], a[28:31], v[216:219]
v_mfma_f32_16x16x32_bf16 v[192:195], a[108:111], a[20:23], 0
buffer_load_dwordx4 v1, s[4:7], s44 offen offset:0 sc1 lds
v_mfma_f32_16x16x32_bf16 v[192:195], a[104:107], a[16:19], v[192:195]
ds_read_b128 a[144:147], v5 offset:1024
v_mfma_f32_16x16x32_bf16 v[168:171], a[104:107], a[8:11], 0
v_mfma_f32_16x16x32_bf16 v[168:171], a[108:111], a[12:15], v[168:171]
ds_read_b128 a[148:151], v5 offset:7168
v_mfma_f32_16x16x32_bf16 v[144:147], a[108:111], a[4:7], 0
v_mfma_f32_16x16x32_bf16 v[144:147], a[104:107], a[0:3], v[144:147]
buffer_load_dwordx4 a[72:75], v2, s[40:43], s35 offen offset:1024 sc1
s_waitcnt lgkmcnt(7)
v_mfma_f32_16x16x32_bf16 v[148:151], a[112:115], a[0:3], 0
s_waitcnt lgkmcnt(6)
v_mfma_f32_16x16x32_bf16 v[148:151], a[116:119], a[4:7], v[148:151]
v_mfma_f32_16x16x32_bf16 v[172:175], a[116:119], a[12:15], 0
v_mfma_f32_16x16x32_bf16 v[172:175], a[112:115], a[8:11], v[172:175]
v_mfma_f32_16x16x32_bf16 v[196:199], a[112:115], a[16:19], 0
buffer_load_dwordx4 a[76:79], v2, s[40:43], s33 offen offset:1024 sc1
v_mfma_f32_16x16x32_bf16 v[196:199], a[116:119], a[20:23], v[196:199]
v_mfma_f32_16x16x32_bf16 v[220:223], a[116:119], a[28:31], 0
v_mfma_f32_16x16x32_bf16 v[220:223], a[112:115], a[24:27], v[220:223]
s_waitcnt lgkmcnt(0)
v_mfma_f32_16x16x32_bf16 v[224:227], a[128:131], a[24:27], 0
ds_read_b128 a[96:99], v5 offset:14336
v_mfma_f32_16x16x32_bf16 v[224:227], a[132:135], a[28:31], v[224:227]
buffer_load_dwordx4 a[80:83], v2, s[40:43], s35 offen offset:2048 sc1
v_mfma_f32_16x16x32_bf16 v[200:203], a[132:135], a[20:23], 0
ds_read_b128 a[100:103], v5 offset:20480
v_mfma_f32_16x16x32_bf16 v[200:203], a[128:131], a[16:19], v[200:203]
v_mfma_f32_16x16x32_bf16 v[176:179], a[128:131], a[8:11], 0
v_mfma_f32_16x16x32_bf16 v[176:179], a[132:135], a[12:15], v[176:179]
buffer_load_dwordx4 a[84:87], v2, s[40:43], s33 offen offset:2048 sc1
v_mfma_f32_16x16x32_bf16 v[152:155], a[132:135], a[4:7], 0
ds_read_b128 a[104:107], v5 offset:15360
v_mfma_f32_16x16x32_bf16 v[152:155], a[128:131], a[0:3], v[152:155]
v_mfma_f32_16x16x32_bf16 v[132:135], a[136:139], a[0:3], 0
ds_read_b128 a[108:111], v5 offset:21504
v_mfma_f32_16x16x32_bf16 v[132:135], a[140:143], a[4:7], v[132:135]
v_mfma_f32_16x16x32_bf16 v[156:159], a[140:143], a[12:15], 0
buffer_load_dwordx4 v1, s[4:7], s44 offen offset:1024 sc1 lds
s_add_u32 m0, s18, 0x1e000
v_mfma_f32_16x16x32_bf16 v[156:159], a[136:139], a[8:11], v[156:159]
s_add_u32 s44, s50, 0x281e000
ds_read_b128 a[112:115], v5 offset:16384
v_mfma_f32_16x16x32_bf16 v[180:183], a[136:139], a[16:19], 0
v_mfma_f32_16x16x32_bf16 v[180:183], a[140:143], a[20:23], v[180:183]
ds_read_b128 a[116:119], v5 offset:22528
v_mfma_f32_16x16x32_bf16 v[204:207], a[140:143], a[28:31], 0
v_mfma_f32_16x16x32_bf16 v[204:207], a[136:139], a[24:27], v[204:207]
buffer_load_dwordx4 a[88:91], v2, s[40:43], s35 offen offset:3072 sc1
v_mfma_f32_16x16x32_bf16 v[208:211], a[144:147], a[24:27], 0
v_mfma_f32_16x16x32_bf16 v[208:211], a[148:151], a[28:31], v[208:211]
v_mfma_f32_16x16x32_bf16 v[184:187], a[148:151], a[20:23], 0
v_mfma_f32_16x16x32_bf16 v[184:187], a[144:147], a[16:19], v[184:187]
v_mfma_f32_16x16x32_bf16 v[160:163], a[144:147], a[8:11], 0
buffer_load_dwordx4 a[92:95], v2, s[40:43], s33 offen offset:3072 sc1
s_add_u32 s35, s35, 0x4000
v_mfma_f32_16x16x32_bf16 v[160:163], a[148:151], a[12:15], v[160:163]
s_add_u32 s33, s33, 0x4000
v_mfma_f32_16x16x32_bf16 v[136:139], a[148:151], a[4:7], 0
v_mfma_f32_16x16x32_bf16 v[136:139], a[144:147], a[0:3], v[136:139]
s_waitcnt vmcnt(10) lgkmcnt(0)
v_mfma_f32_16x16x32_bf16 v[140:143], a[96:99], a[32:35], v[140:143]
ds_read_b128 a[128:131], v5 offset:17408
v_mfma_f32_16x16x32_bf16 v[140:143], a[100:103], a[36:39], v[140:143]
buffer_load_dwordx4 a[0:3], v2, s[40:43], s35 offen offset:0 sc1
v_mfma_f32_16x16x32_bf16 v[164:167], a[100:103], a[44:47], v[164:167]
ds_read_b128 a[132:135], v5 offset:23552
v_mfma_f32_16x16x32_bf16 v[164:167], a[96:99], a[40:43], v[164:167]
v_mfma_f32_16x16x32_bf16 v[188:191], a[96:99], a[48:51], v[188:191]
v_mfma_f32_16x16x32_bf16 v[188:191], a[100:103], a[52:55], v[188:191]
buffer_load_dwordx4 a[4:7], v2, s[40:43], s33 offen offset:0 sc1
v_mfma_f32_16x16x32_bf16 v[212:215], a[100:103], a[60:63], v[212:215]
ds_read_b128 a[136:139], v5 offset:12288
v_mfma_f32_16x16x32_bf16 v[212:215], a[96:99], a[56:59], v[212:215]
v_mfma_f32_16x16x32_bf16 v[216:219], a[104:107], a[56:59], v[216:219]
ds_read_b128 a[140:143], v5 offset:18432
v_mfma_f32_16x16x32_bf16 v[216:219], a[108:111], a[60:63], v[216:219]
v_mfma_f32_16x16x32_bf16 v[192:195], a[108:111], a[52:55], v[192:195]
buffer_load_dwordx4 v1, s[4:7], s44 offen offset:0 sc1 lds
v_mfma_f32_16x16x32_bf16 v[192:195], a[104:107], a[48:51], v[192:195]
ds_read_b128 a[144:147], v5 offset:13312
v_mfma_f32_16x16x32_bf16 v[168:171], a[104:107], a[40:43], v[168:171]
v_mfma_f32_16x16x32_bf16 v[168:171], a[108:111], a[44:47], v[168:171]
ds_read_b128 a[148:151], v5 offset:19456
v_mfma_f32_16x16x32_bf16 v[144:147], a[108:111], a[36:39], v[144:147]
v_mfma_f32_16x16x32_bf16 v[144:147], a[104:107], a[32:35], v[144:147]
buffer_load_dwordx4 a[8:11], v2, s[40:43], s35 offen offset:1024 sc1
v_mfma_f32_16x16x32_bf16 v[148:151], a[112:115], a[32:35], v[148:151]
v_mfma_f32_16x16x32_bf16 v[148:151], a[116:119], a[36:39], v[148:151]
v_mfma_f32_16x16x32_bf16 v[172:175], a[116:119], a[44:47], v[172:175]
v_mfma_f32_16x16x32_bf16 v[172:175], a[112:115], a[40:43], v[172:175]
v_mfma_f32_16x16x32_bf16 v[196:199], a[112:115], a[48:51], v[196:199]
buffer_load_dwordx4 a[12:15], v2, s[40:43], s33 offen offset:1024 sc1
v_mfma_f32_16x16x32_bf16 v[196:199], a[116:119], a[52:55], v[196:199]
v_mfma_f32_16x16x32_bf16 v[220:223], a[116:119], a[60:63], v[220:223]
v_mfma_f32_16x16x32_bf16 v[220:223], a[112:115], a[56:59], v[220:223]
s_waitcnt lgkmcnt(0)
v_mfma_f32_16x16x32_bf16 v[224:227], a[128:131], a[56:59], v[224:227]
ds_read_b128 a[96:99], v5 offset:26624
v_mfma_f32_16x16x32_bf16 v[224:227], a[132:135], a[60:63], v[224:227]
buffer_load_dwordx4 a[16:19], v2, s[40:43], s35 offen offset:2048 sc1
v_mfma_f32_16x16x32_bf16 v[200:203], a[132:135], a[52:55], v[200:203]
ds_read_b128 a[100:103], v5 offset:32768
v_mfma_f32_16x16x32_bf16 v[200:203], a[128:131], a[48:51], v[200:203]
v_mfma_f32_16x16x32_bf16 v[176:179], a[128:131], a[40:43], v[176:179]
v_mfma_f32_16x16x32_bf16 v[176:179], a[132:135], a[44:47], v[176:179]
buffer_load_dwordx4 v1, s[4:7], s44 offen offset:1024 sc1 lds
s_add_u32 m0, s18, 0x20000
v_mfma_f32_16x16x32_bf16 v[152:155], a[132:135], a[36:39], v[152:155]
s_add_u32 s44, s50, 0x2820000
ds_read_b128 a[104:107], v5 offset:27648
v_mfma_f32_16x16x32_bf16 v[152:155], a[128:131], a[32:35], v[152:155]
v_mfma_f32_16x16x32_bf16 v[132:135], a[136:139], a[32:35], v[132:135]
ds_read_b128 a[108:111], v5 offset:33792
v_mfma_f32_16x16x32_bf16 v[132:135], a[140:143], a[36:39], v[132:135]
buffer_load_dwordx4 a[20:23], v2, s[40:43], s33 offen offset:2048 sc1
v_mfma_f32_16x16x32_bf16 v[156:159], a[140:143], a[44:47], v[156:159]
ds_read_b128 a[112:115], v5 offset:28672
v_mfma_f32_16x16x32_bf16 v[156:159], a[136:139], a[40:43], v[156:159]
v_mfma_f32_16x16x32_bf16 v[180:183], a[136:139], a[48:51], v[180:183]
v_mfma_f32_16x16x32_bf16 v[180:183], a[140:143], a[52:55], v[180:183]
buffer_load_dwordx4 a[24:27], v2, s[40:43], s35 offen offset:3072 sc1
v_mfma_f32_16x16x32_bf16 v[204:207], a[140:143], a[60:63], v[204:207]
ds_read_b128 a[116:119], v5 offset:34816
v_mfma_f32_16x16x32_bf16 v[204:207], a[136:139], a[56:59], v[204:207]
v_mfma_f32_16x16x32_bf16 v[208:211], a[144:147], a[56:59], v[208:211]
v_mfma_f32_16x16x32_bf16 v[208:211], a[148:151], a[60:63], v[208:211]
buffer_load_dwordx4 v1, s[4:7], s44 offen offset:0 sc1 lds
v_mfma_f32_16x16x32_bf16 v[184:187], a[148:151], a[52:55], v[184:187]
v_mfma_f32_16x16x32_bf16 v[184:187], a[144:147], a[48:51], v[184:187]
v_mfma_f32_16x16x32_bf16 v[160:163], a[144:147], a[40:43], v[160:163]
v_mfma_f32_16x16x32_bf16 v[160:163], a[148:151], a[44:47], v[160:163]
buffer_load_dwordx4 a[28:31], v2, s[40:43], s33 offen offset:3072 sc1
s_add_u32 s35, s35, 0x4000
v_mfma_f32_16x16x32_bf16 v[136:139], a[148:151], a[36:39], v[136:139]
s_add_u32 s33, s33, 0x4000
v_mfma_f32_16x16x32_bf16 v[136:139], a[144:147], a[32:35], v[136:139]
s_waitcnt vmcnt(11) lgkmcnt(0)
v_mfma_f32_16x16x32_bf16 v[140:143], a[96:99], a[64:67], v[140:143]
ds_read_b128 a[128:131], v5 offset:29696
v_mfma_f32_16x16x32_bf16 v[140:143], a[100:103], a[68:71], v[140:143]
buffer_load_dwordx4 a[32:35], v2, s[40:43], s35 offen offset:0 sc1
v_mfma_f32_16x16x32_bf16 v[164:167], a[100:103], a[76:79], v[164:167]
ds_read_b128 a[132:135], v5 offset:35840
v_mfma_f32_16x16x32_bf16 v[164:167], a[96:99], a[72:75], v[164:167]
v_mfma_f32_16x16x32_bf16 v[188:191], a[96:99], a[80:83], v[188:191]
v_mfma_f32_16x16x32_bf16 v[188:191], a[100:103], a[84:87], v[188:191]
buffer_load_dwordx4 a[36:39], v2, s[40:43], s33 offen offset:0 sc1
v_mfma_f32_16x16x32_bf16 v[212:215], a[100:103], a[92:95], v[212:215]
ds_read_b128 a[136:139], v5 offset:24576
v_mfma_f32_16x16x32_bf16 v[212:215], a[96:99], a[88:91], v[212:215]
v_mfma_f32_16x16x32_bf16 v[216:219], a[104:107], a[88:91], v[216:219]
ds_read_b128 a[140:143], v5 offset:30720
v_mfma_f32_16x16x32_bf16 v[216:219], a[108:111], a[92:95], v[216:219]
v_mfma_f32_16x16x32_bf16 v[192:195], a[108:111], a[84:87], v[192:195]
buffer_load_dwordx4 v1, s[4:7], s44 offen offset:1024 sc1 lds
s_add_u32 m0, s18, 0x22000
v_mfma_f32_16x16x32_bf16 v[192:195], a[104:107], a[80:83], v[192:195]
s_add_u32 s44, s50, 0x2822000
ds_read_b128 a[144:147], v5 offset:25600
v_mfma_f32_16x16x32_bf16 v[168:171], a[104:107], a[72:75], v[168:171]
v_mfma_f32_16x16x32_bf16 v[168:171], a[108:111], a[76:79], v[168:171]
ds_read_b128 a[148:151], v5 offset:31744
v_mfma_f32_16x16x32_bf16 v[144:147], a[108:111], a[68:71], v[144:147]
v_mfma_f32_16x16x32_bf16 v[144:147], a[104:107], a[64:67], v[144:147]
buffer_load_dwordx4 a[40:43], v2, s[40:43], s35 offen offset:1024 sc1
v_mfma_f32_16x16x32_bf16 v[148:151], a[112:115], a[64:67], v[148:151]
v_mfma_f32_16x16x32_bf16 v[148:151], a[116:119], a[68:71], v[148:151]
v_mfma_f32_16x16x32_bf16 v[172:175], a[116:119], a[76:79], v[172:175]
v_mfma_f32_16x16x32_bf16 v[172:175], a[112:115], a[72:75], v[172:175]
v_mfma_f32_16x16x32_bf16 v[196:199], a[112:115], a[80:83], v[196:199]
buffer_load_dwordx4 a[44:47], v2, s[40:43], s33 offen offset:1024 sc1
v_mfma_f32_16x16x32_bf16 v[196:199], a[116:119], a[84:87], v[196:199]
v_mfma_f32_16x16x32_bf16 v[220:223], a[116:119], a[92:95], v[220:223]
v_mfma_f32_16x16x32_bf16 v[220:223], a[112:115], a[88:91], v[220:223]
s_waitcnt lgkmcnt(0)
v_mfma_f32_16x16x32_bf16 v[224:227], a[128:131], a[88:91], v[224:227]
ds_read_b128 a[96:99], v5 offset:38912
v_mfma_f32_16x16x32_bf16 v[224:227], a[132:135], a[92:95], v[224:227]
buffer_load_dwordx4 a[48:51], v2, s[40:43], s35 offen offset:2048 sc1
v_mfma_f32_16x16x32_bf16 v[200:203], a[132:135], a[84:87], v[200:203]
ds_read_b128 a[100:103], v5 offset:45056
L_stub15:
s_cbranch_execz L_stub16
v_mfma_f32_16x16x32_bf16 v[200:203], a[128:131], a[80:83], v[200:203]
v_mfma_f32_16x16x32_bf16 v[176:179], a[128:131], a[72:75], v[176:179]
v_mfma_f32_16x16x32_bf16 v[176:179], a[132:135], a[76:79], v[176:179]
buffer_load_dwordx4 a[52:55], v2, s[40:43], s33 offen offset:2048 sc1
v_mfma_f32_16x16x32_bf16 v[152:155], a[132:135], a[68:71], v[152:155]
ds_read_b128 a[104:107], v5 offset:39936
v_mfma_f32_16x16x32_bf16 v[152:155], a[128:131], a[64:67], v[152:155]
v_mfma_f32_16x16x32_bf16 v[132:135], a[136:139], a[64:67], v[132:135]
ds_read_b128 a[108:111], v5 offset:46080
v_mfma_f32_16x16x32_bf16 v[132:135], a[140:143], a[68:71], v[132:135]
v_mfma_f32_16x16x32_bf16 v[156:159], a[140:143], a[76:79], v[156:159]
buffer_load_dwordx4 v1, s[4:7], s44 offen offset:0 sc1 lds
v_mfma_f32_16x16x32_bf16 v[156:159], a[136:139], a[72:75], v[156:159]
ds_read_b128 a[112:115], v5 offset:40960
v_mfma_f32_16x16x32_bf16 v[180:183], a[136:139], a[80:83], v[180:183]
v_mfma_f32_16x16x32_bf16 v[180:183], a[140:143], a[84:87], v[180:183]
ds_read_b128 a[116:119], v5 offset:47104
v_mfma_f32_16x16x32_bf16 v[204:207], a[140:143], a[92:95], v[204:207]
v_mfma_f32_16x16x32_bf16 v[204:207], a[136:139], a[88:91], v[204:207]
buffer_load_dwordx4 a[56:59], v2, s[40:43], s35 offen offset:3072 sc1
v_mfma_f32_16x16x32_bf16 v[208:211], a[144:147], a[88:91], v[208:211]
v_mfma_f32_16x16x32_bf16 v[208:211], a[148:151], a[92:95], v[208:211]
v_mfma_f32_16x16x32_bf16 v[184:187], a[148:151], a[84:87], v[184:187]
v_mfma_f32_16x16x32_bf16 v[184:187], a[144:147], a[80:83], v[184:187]
v_mfma_f32_16x16x32_bf16 v[160:163], a[144:147], a[72:75], v[160:163]
buffer_load_dwordx4 a[60:63], v2, s[40:43], s33 offen offset:3072 sc1
s_add_u32 s35, s35, 0x4000
v_mfma_f32_16x16x32_bf16 v[160:163], a[148:151], a[76:79], v[160:163]
s_add_u32 s33, s33, 0x4000
v_mfma_f32_16x16x32_bf16 v[136:139], a[148:151], a[68:71], v[136:139]
v_mfma_f32_16x16x32_bf16 v[136:139], a[144:147], a[64:67], v[136:139]
s_waitcnt vmcnt(10) lgkmcnt(0)
v_mfma_f32_16x16x32_bf16 v[140:143], a[96:99], a[0:3], v[140:143]
ds_read_b128 a[128:131], v5 offset:41984
v_mfma_f32_16x16x32_bf16 v[140:143], a[100:103], a[4:7], v[140:143]
buffer_load_dwordx4 a[64:67], v2, s[40:43], s35 offen offset:0 sc1
v_mfma_f32_16x16x32_bf16 v[164:167], a[100:103], a[12:15], v[164:167]
ds_read_b128 a[132:135], v5 offset:48128
v_mfma_f32_16x16x32_bf16 v[164:167], a[96:99], a[8:11], v[164:167]
v_mfma_f32_16x16x32_bf16 v[188:191], a[96:99], a[16:19], v[188:191]
v_mfma_f32_16x16x32_bf16 v[188:191], a[100:103], a[20:23], v[188:191]
buffer_load_dwordx4 a[68:71], v2, s[40:43], s33 offen offset:0 sc1
v_mfma_f32_16x16x32_bf16 v[212:215], a[100:103], a[28:31], v[212:215]
ds_read_b128 a[136:139], v5 offset:36864
v_mfma_f32_16x16x32_bf16 v[212:215], a[96:99], a[24:27], v[212:215]
v_mfma_f32_16x16x32_bf16 v[216:219], a[104:107], a[24:27], v[216:219]
ds_read_b128 a[140:143], v5 offset:43008
v_mfma_f32_16x16x32_bf16 v[216:219], a[108:111], a[28:31], v[216:219]
v_mfma_f32_16x16x32_bf16 v[192:195], a[108:111], a[20:23], v[192:195]
buffer_load_dwordx4 v1, s[4:7], s44 offen offset:1024 sc1 lds
s_add_u32 s88, s82, 0x380000
v_mfma_f32_16x16x32_bf16 v[192:195], a[104:107], a[16:19], v[192:195]
ds_read_b128 a[144:147], v5 offset:37888
v_mfma_f32_16x16x32_bf16 v[168:171], a[104:107], a[8:11], v[168:171]
v_mfma_f32_16x16x32_bf16 v[168:171], a[108:111], a[12:15], v[168:171]
ds_read_b128 a[148:151], v5 offset:44032
v_mfma_f32_16x16x32_bf16 v[144:147], a[108:111], a[4:7], v[144:147]
v_mfma_f32_16x16x32_bf16 v[144:147], a[104:107], a[0:3], v[144:147]
buffer_load_dwordx4 a[72:75], v2, s[40:43], s35 offen offset:1024 sc1
v_mfma_f32_16x16x32_bf16 v[148:151], a[112:115], a[0:3], v[148:151]
v_mfma_f32_16x16x32_bf16 v[148:151], a[116:119], a[4:7], v[148:151]
v_mfma_f32_16x16x32_bf16 v[172:175], a[116:119], a[12:15], v[172:175]
v_mfma_f32_16x16x32_bf16 v[172:175], a[112:115], a[8:11], v[172:175]
v_mfma_f32_16x16x32_bf16 v[196:199], a[112:115], a[16:19], v[196:199]
buffer_load_dwordx4 a[76:79], v2, s[40:43], s33 offen offset:1024 sc1
v_mfma_f32_16x16x32_bf16 v[196:199], a[116:119], a[20:23], v[196:199]
v_mfma_f32_16x16x32_bf16 v[220:223], a[116:119], a[28:31], v[220:223]
v_mfma_f32_16x16x32_bf16 v[220:223], a[112:115], a[24:27], v[220:223]
s_waitcnt lgkmcnt(0)
s_barrier
v_mfma_f32_16x16x32_bf16 v[224:227], a[128:131], a[24:27], v[224:227]
v_add_u32 v5, 49152, v1
v_mfma_f32_16x16x32_bf16 v[224:227], a[132:135], a[28:31], v[224:227]
buffer_load_dwordx4 a[80:83], v2, s[40:43], s35 offen offset:2048 sc1
v_mfma_f32_16x16x32_bf16 v[200:203], a[132:135], a[20:23], v[200:203]
ds_read_b128 a[96:99], v5 offset:2048
v_mfma_f32_16x16x32_bf16 v[200:203], a[128:131], a[16:19], v[200:203]
ds_read_b128 a[100:103], v5 offset:8192
v_mfma_f32_16x16x32_bf16 v[176:179], a[128:131], a[8:11], v[176:179]
v_mfma_f32_16x16x32_bf16 v[176:179], a[132:135], a[12:15], v[176:179]
buffer_load_dwordx4 a[84:87], v2, s[40:43], s33 offen offset:2048 sc1
v_mfma_f32_16x16x32_bf16 v[152:155], a[132:135], a[4:7], v[152:155]
ds_read_b128 a[104:107], v5 offset:3072
v_mfma_f32_16x16x32_bf16 v[152:155], a[128:131], a[0:3], v[152:155]
v_mfma_f32_16x16x32_bf16 v[132:135], a[136:139], a[0:3], v[132:135]
ds_read_b128 a[108:111], v5 offset:9216
v_mfma_f32_16x16x32_bf16 v[132:135], a[140:143], a[4:7], v[132:135]
v_mfma_f32_16x16x32_bf16 v[156:159], a[140:143], a[12:15], v[156:159]
buffer_load_dwordx4 v[92:95], v1, s[4:7], s88 offen offset:0 sc1
v_mfma_f32_16x16x32_bf16 v[156:159], a[136:139], a[8:11], v[156:159]
ds_read_b128 a[112:115], v5 offset:4096
v_mfma_f32_16x16x32_bf16 v[180:183], a[136:139], a[16:19], v[180:183]
v_mfma_f32_16x16x32_bf16 v[180:183], a[140:143], a[20:23], v[180:183]
ds_read_b128 a[116:119], v5 offset:10240
v_mfma_f32_16x16x32_bf16 v[204:207], a[140:143], a[28:31], v[204:207]
v_mfma_f32_16x16x32_bf16 v[204:207], a[136:139], a[24:27], v[204:207]
buffer_load_dwordx4 a[88:91], v2, s[40:43], s35 offen offset:3072 sc1
v_mfma_f32_16x16x32_bf16 v[208:211], a[144:147], a[24:27], v[208:211]
v_mfma_f32_16x16x32_bf16 v[208:211], a[148:151], a[28:31], v[208:211]
v_mfma_f32_16x16x32_bf16 v[184:187], a[148:151], a[20:23], v[184:187]
v_mfma_f32_16x16x32_bf16 v[184:187], a[144:147], a[16:19], v[184:187]
v_mfma_f32_16x16x32_bf16 v[160:163], a[144:147], a[8:11], v[160:163]
buffer_load_dwordx4 a[92:95], v2, s[40:43], s33 offen offset:3072 sc1
s_add_u32 s35, s35, 0x4000
v_mfma_f32_16x16x32_bf16 v[160:163], a[148:151], a[12:15], v[160:163]
s_add_u32 s33, s33, 0x4000
v_mfma_f32_16x16x32_bf16 v[136:139], a[148:151], a[4:7], v[136:139]
v_mfma_f32_16x16x32_bf16 v[136:139], a[144:147], a[0:3], v[136:139]
s_waitcnt vmcnt(10) lgkmcnt(0)
v_mfma_f32_16x16x32_bf16 v[140:143], a[96:99], a[32:35], v[140:143]
ds_read_b128 a[128:131], v5 offset:5120
v_mfma_f32_16x16x32_bf16 v[140:143], a[100:103], a[36:39], v[140:143]
buffer_load_dwordx4 a[0:3], v2, s[40:43], s35 offen offset:0 sc1
v_mfma_f32_16x16x32_bf16 v[164:167], a[100:103], a[44:47], v[164:167]
ds_read_b128 a[132:135], v5 offset:11264
v_mfma_f32_16x16x32_bf16 v[164:167], a[96:99], a[40:43], v[164:167]
v_mfma_f32_16x16x32_bf16 v[188:191], a[96:99], a[48:51], v[188:191]
v_mfma_f32_16x16x32_bf16 v[188:191], a[100:103], a[52:55], v[188:191]
buffer_load_dwordx4 a[4:7], v2, s[40:43], s33 offen offset:0 sc1
v_mfma_f32_16x16x32_bf16 v[212:215], a[100:103], a[60:63], v[212:215]
ds_read_b128 a[136:139], v5 offset:0
v_mfma_f32_16x16x32_bf16 v[212:215], a[96:99], a[56:59], v[212:215]
v_mfma_f32_16x16x32_bf16 v[216:219], a[104:107], a[56:59], v[216:219]
ds_read_b128 a[140:143], v5 offset:6144
v_mfma_f32_16x16x32_bf16 v[216:219], a[108:111], a[60:63], v[216:219]
v_mfma_f32_16x16x32_bf16 v[192:195], a[108:111], a[52:55], v[192:195]
buffer_load_dwordx4 v[96:99], v1, s[4:7], s88 offen offset:1024 sc1
v_mfma_f32_16x16x32_bf16 v[192:195], a[104:107], a[48:51], v[192:195]
ds_read_b128 a[144:147], v5 offset:1024
v_mfma_f32_16x16x32_bf16 v[168:171], a[104:107], a[40:43], v[168:171]
v_mfma_f32_16x16x32_bf16 v[168:171], a[108:111], a[44:47], v[168:171]
ds_read_b128 a[148:151], v5 offset:7168
v_mfma_f32_16x16x32_bf16 v[144:147], a[108:111], a[36:39], v[144:147]
v_mfma_f32_16x16x32_bf16 v[144:147], a[104:107], a[32:35], v[144:147]
buffer_load_dwordx4 a[8:11], v2, s[40:43], s35 offen offset:1024 sc1
v_mfma_f32_16x16x32_bf16 v[148:151], a[112:115], a[32:35], v[148:151]
v_mfma_f32_16x16x32_bf16 v[148:151], a[116:119], a[36:39], v[148:151]
v_mfma_f32_16x16x32_bf16 v[172:175], a[116:119], a[44:47], v[172:175]
v_mfma_f32_16x16x32_bf16 v[172:175], a[112:115], a[40:43], v[172:175]
v_mfma_f32_16x16x32_bf16 v[196:199], a[112:115], a[48:51], v[196:199]
buffer_load_dwordx4 a[12:15], v2, s[40:43], s33 offen offset:1024 sc1
v_mfma_f32_16x16x32_bf16 v[196:199], a[116:119], a[52:55], v[196:199]
v_mfma_f32_16x16x32_bf16 v[220:223], a[116:119], a[60:63], v[220:223]
v_mfma_f32_16x16x32_bf16 v[220:223], a[112:115], a[56:59], v[220:223]
s_waitcnt lgkmcnt(0)
v_mfma_f32_16x16x32_bf16 v[224:227], a[128:131], a[56:59], v[224:227]
ds_read_b128 a[96:99], v5 offset:14336
v_mfma_f32_16x16x32_bf16 v[224:227], a[132:135], a[60:63], v[224:227]
buffer_load_dwordx4 a[16:19], v2, s[40:43], s35 offen offset:2048 sc1
v_mfma_f32_16x16x32_bf16 v[200:203], a[132:135], a[52:55], v[200:203]
ds_read_b128 a[100:103], v5 offset:20480
v_mfma_f32_16x16x32_bf16 v[200:203], a[128:131], a[48:51], v[200:203]
v_mfma_f32_16x16x32_bf16 v[176:179], a[128:131], a[40:43], v[176:179]
v_mfma_f32_16x16x32_bf16 v[176:179], a[132:135], a[44:47], v[176:179]
buffer_load_dwordx4 v[100:103], v1, s[4:7], s88 offen offset:2048 sc1
v_mfma_f32_16x16x32_bf16 v[152:155], a[132:135], a[36:39], v[152:155]
ds_read_b128 a[104:107], v5 offset:15360
v_mfma_f32_16x16x32_bf16 v[152:155], a[128:131], a[32:35], v[152:155]
v_mfma_f32_16x16x32_bf16 v[132:135], a[136:139], a[32:35], v[132:135]
ds_read_b128 a[108:111], v5 offset:21504
v_mfma_f32_16x16x32_bf16 v[132:135], a[140:143], a[36:39], v[132:135]
buffer_load_dwordx4 a[20:23], v2, s[40:43], s33 offen offset:2048 sc1
v_mfma_f32_16x16x32_bf16 v[156:159], a[140:143], a[44:47], v[156:159]
ds_read_b128 a[112:115], v5 offset:16384
v_mfma_f32_16x16x32_bf16 v[156:159], a[136:139], a[40:43], v[156:159]
v_mfma_f32_16x16x32_bf16 v[180:183], a[136:139], a[48:51], v[180:183]
v_mfma_f32_16x16x32_bf16 v[180:183], a[140:143], a[52:55], v[180:183]
buffer_load_dwordx4 a[24:27], v2, s[40:43], s35 offen offset:3072 sc1
v_mfma_f32_16x16x32_bf16 v[204:207], a[140:143], a[60:63], v[204:207]
ds_read_b128 a[116:119], v5 offset:22528
v_mfma_f32_16x16x32_bf16 v[204:207], a[136:139], a[56:59], v[204:207]
v_mfma_f32_16x16x32_bf16 v[208:211], a[144:147], a[56:59], v[208:211]
v_mfma_f32_16x16x32_bf16 v[208:211], a[148:151], a[60:63], v[208:211]
buffer_load_dwordx4 v[104:107], v1, s[4:7], s88 offen offset:3072 sc1
s_add_u32 s88, s88, 4096
v_mfma_f32_16x16x32_bf16 v[184:187], a[148:151], a[52:55], v[184:187]
v_mfma_f32_16x16x32_bf16 v[184:187], a[144:147], a[48:51], v[184:187]
v_mfma_f32_16x16x32_bf16 v[160:163], a[144:147], a[40:43], v[160:163]
v_mfma_f32_16x16x32_bf16 v[160:163], a[148:151], a[44:47], v[160:163]
buffer_load_dwordx4 a[28:31], v2, s[40:43], s33 offen offset:3072 sc1
s_add_u32 s35, s35, 0x4000
v_mfma_f32_16x16x32_bf16 v[136:139], a[148:151], a[36:39], v[136:139]
s_add_u32 s33, s33, 0x4000
v_mfma_f32_16x16x32_bf16 v[136:139], a[144:147], a[32:35], v[136:139]
s_waitcnt vmcnt(11) lgkmcnt(0)
v_mfma_f32_16x16x32_bf16 v[140:143], a[96:99], a[64:67], v[140:143]
ds_read_b128 a[128:131], v5 offset:17408
v_mfma_f32_16x16x32_bf16 v[140:143], a[100:103], a[68:71], v[140:143]
buffer_load_dwordx4 a[32:35], v2, s[40:43], s35 offen offset:0 sc1
v_mfma_f32_16x16x32_bf16 v[164:167], a[100:103], a[76:79], v[164:167]
ds_read_b128 a[132:135], v5 offset:23552
v_mfma_f32_16x16x32_bf16 v[164:167], a[96:99], a[72:75], v[164:167]
v_mfma_f32_16x16x32_bf16 v[188:191], a[96:99], a[80:83], v[188:191]
v_mfma_f32_16x16x32_bf16 v[188:191], a[100:103], a[84:87], v[188:191]
buffer_load_dwordx4 a[36:39], v2, s[40:43], s33 offen offset:0 sc1
v_mfma_f32_16x16x32_bf16 v[212:215], a[100:103], a[92:95], v[212:215]
ds_read_b128 a[136:139], v5 offset:12288
v_mfma_f32_16x16x32_bf16 v[212:215], a[96:99], a[88:91], v[212:215]
v_mfma_f32_16x16x32_bf16 v[216:219], a[104:107], a[88:91], v[216:219]
ds_read_b128 a[140:143], v5 offset:18432
v_mfma_f32_16x16x32_bf16 v[216:219], a[108:111], a[92:95], v[216:219]
v_mfma_f32_16x16x32_bf16 v[192:195], a[108:111], a[84:87], v[192:195]
buffer_load_dwordx4 v[108:111], v1, s[4:7], s88 offen offset:0 sc1
v_mfma_f32_16x16x32_bf16 v[192:195], a[104:107], a[80:83], v[192:195]
ds_read_b128 a[144:147], v5 offset:13312
v_mfma_f32_16x16x32_bf16 v[168:171], a[104:107], a[72:75], v[168:171]
v_mfma_f32_16x16x32_bf16 v[168:171], a[108:111], a[76:79], v[168:171]
ds_read_b128 a[148:151], v5 offset:19456
v_mfma_f32_16x16x32_bf16 v[144:147], a[108:111], a[68:71], v[144:147]
v_mfma_f32_16x16x32_bf16 v[144:147], a[104:107], a[64:67], v[144:147]
buffer_load_dwordx4 a[40:43], v2, s[40:43], s35 offen offset:1024 sc1
v_mfma_f32_16x16x32_bf16 v[148:151], a[112:115], a[64:67], v[148:151]
v_mfma_f32_16x16x32_bf16 v[148:151], a[116:119], a[68:71], v[148:151]
v_mfma_f32_16x16x32_bf16 v[172:175], a[116:119], a[76:79], v[172:175]
v_mfma_f32_16x16x32_bf16 v[172:175], a[112:115], a[72:75], v[172:175]
v_mfma_f32_16x16x32_bf16 v[196:199], a[112:115], a[80:83], v[196:199]
buffer_load_dwordx4 a[44:47], v2, s[40:43], s33 offen offset:1024 sc1
v_mfma_f32_16x16x32_bf16 v[196:199], a[116:119], a[84:87], v[196:199]
v_mfma_f32_16x16x32_bf16 v[220:223], a[116:119], a[92:95], v[220:223]
v_mfma_f32_16x16x32_bf16 v[220:223], a[112:115], a[88:91], v[220:223]
s_waitcnt lgkmcnt(0)
v_mfma_f32_16x16x32_bf16 v[224:227], a[128:131], a[88:91], v[224:227]
ds_read_b128 a[96:99], v5 offset:26624
v_mfma_f32_16x16x32_bf16 v[224:227], a[132:135], a[92:95], v[224:227]
buffer_load_dwordx4 a[48:51], v2, s[40:43], s35 offen offset:2048 sc1
v_mfma_f32_16x16x32_bf16 v[200:203], a[132:135], a[84:87], v[200:203]
ds_read_b128 a[100:103], v5 offset:32768
v_mfma_f32_16x16x32_bf16 v[200:203], a[128:131], a[80:83], v[200:203]
v_mfma_f32_16x16x32_bf16 v[176:179], a[128:131], a[72:75], v[176:179]
v_mfma_f32_16x16x32_bf16 v[176:179], a[132:135], a[76:79], v[176:179]
buffer_load_dwordx4 a[52:55], v2, s[40:43], s33 offen offset:2048 sc1
v_mfma_f32_16x16x32_bf16 v[152:155], a[132:135], a[68:71], v[152:155]
ds_read_b128 a[104:107], v5 offset:27648
v_mfma_f32_16x16x32_bf16 v[152:155], a[128:131], a[64:67], v[152:155]
v_mfma_f32_16x16x32_bf16 v[132:135], a[136:139], a[64:67], v[132:135]
ds_read_b128 a[108:111], v5 offset:33792
v_mfma_f32_16x16x32_bf16 v[132:135], a[140:143], a[68:71], v[132:135]
v_mfma_f32_16x16x32_bf16 v[156:159], a[140:143], a[76:79], v[156:159]
buffer_load_dwordx4 v[112:115], v1, s[4:7], s88 offen offset:1024 sc1
v_mfma_f32_16x16x32_bf16 v[156:159], a[136:139], a[72:75], v[156:159]
ds_read_b128 a[112:115], v5 offset:28672
v_mfma_f32_16x16x32_bf16 v[180:183], a[136:139], a[80:83], v[180:183]
v_mfma_f32_16x16x32_bf16 v[180:183], a[140:143], a[84:87], v[180:183]
ds_read_b128 a[116:119], v5 offset:34816
v_mfma_f32_16x16x32_bf16 v[204:207], a[140:143], a[92:95], v[204:207]
v_mfma_f32_16x16x32_bf16 v[204:207], a[136:139], a[88:91], v[204:207]
buffer_load_dwordx4 a[56:59], v2, s[40:43], s35 offen offset:3072 sc1
v_mfma_f32_16x16x32_bf16 v[208:211], a[144:147], a[88:91], v[208:211]
v_mfma_f32_16x16x32_bf16 v[208:211], a[148:151], a[92:95], v[208:211]
v_mfma_f32_16x16x32_bf16 v[184:187], a[148:151], a[84:87], v[184:187]
v_mfma_f32_16x16x32_bf16 v[184:187], a[144:147], a[80:83], v[184:187]
v_mfma_f32_16x16x32_bf16 v[160:163], a[144:147], a[72:75], v[160:163]
buffer_load_dwordx4 a[60:63], v2, s[40:43], s33 offen offset:3072 sc1
s_add_u32 s35, s35, 0x64000
v_mfma_f32_16x16x32_bf16 v[160:163], a[148:151], a[76:79], v[160:163]
s_add_u32 s33, s33, 0x64000
v_mfma_f32_16x16x32_bf16 v[136:139], a[148:151], a[68:71], v[136:139]
v_mfma_f32_16x16x32_bf16 v[136:139], a[144:147], a[64:67], v[136:139]
s_waitcnt vmcnt(10) lgkmcnt(0)
v_mfma_f32_16x16x32_bf16 v[140:143], a[96:99], a[0:3], v[140:143]
ds_read_b128 a[128:131], v5 offset:29696
v_mfma_f32_16x16x32_bf16 v[140:143], a[100:103], a[4:7], v[140:143]
buffer_load_dwordx4 a[64:67], v2, s[40:43], s35 offen offset:0 sc1
v_mfma_f32_16x16x32_bf16 v[164:167], a[100:103], a[12:15], v[164:167]
ds_read_b128 a[132:135], v5 offset:35840
v_mfma_f32_16x16x32_bf16 v[164:167], a[96:99], a[8:11], v[164:167]
v_mfma_f32_16x16x32_bf16 v[188:191], a[96:99], a[16:19], v[188:191]
v_mfma_f32_16x16x32_bf16 v[188:191], a[100:103], a[20:23], v[188:191]
buffer_load_dwordx4 a[68:71], v2, s[40:43], s33 offen offset:0 sc1
v_mfma_f32_16x16x32_bf16 v[212:215], a[100:103], a[28:31], v[212:215]
ds_read_b128 a[136:139], v5 offset:24576
v_mfma_f32_16x16x32_bf16 v[212:215], a[96:99], a[24:27], v[212:215]
v_mfma_f32_16x16x32_bf16 v[216:219], a[104:107], a[24:27], v[216:219]
ds_read_b128 a[140:143], v5 offset:30720
v_mfma_f32_16x16x32_bf16 v[216:219], a[108:111], a[28:31], v[216:219]
v_mfma_f32_16x16x32_bf16 v[192:195], a[108:111], a[20:23], v[192:195]
buffer_load_dwordx4 v[116:119], v1, s[4:7], s88 offen offset:2048 sc1
v_mfma_f32_16x16x32_bf16 v[192:195], a[104:107], a[16:19], v[192:195]
ds_read_b128 a[144:147], v5 offset:25600
v_mfma_f32_16x16x32_bf16 v[168:171], a[104:107], a[8:11], v[168:171]
v_mfma_f32_16x16x32_bf16 v[168:171], a[108:111], a[12:15], v[168:171]
ds_read_b128 a[148:151], v5 offset:31744
v_mfma_f32_16x16x32_bf16 v[144:147], a[108:111], a[4:7], v[144:147]
v_mfma_f32_16x16x32_bf16 v[144:147], a[104:107], a[0:3], v[144:147]
buffer_load_dwordx4 a[72:75], v2, s[40:43], s35 offen offset:1024 sc1
v_mfma_f32_16x16x32_bf16 v[148:151], a[112:115], a[0:3], v[148:151]
v_mfma_f32_16x16x32_bf16 v[148:151], a[116:119], a[4:7], v[148:151]
v_mfma_f32_16x16x32_bf16 v[172:175], a[116:119], a[12:15], v[172:175]
v_mfma_f32_16x16x32_bf16 v[172:175], a[112:115], a[8:11], v[172:175]
v_mfma_f32_16x16x32_bf16 v[196:199], a[112:115], a[16:19], v[196:199]
buffer_load_dwordx4 a[76:79], v2, s[40:43], s33 offen offset:1024 sc1
v_mfma_f32_16x16x32_bf16 v[196:199], a[116:119], a[20:23], v[196:199]
v_mfma_f32_16x16x32_bf16 v[220:223], a[116:119], a[28:31], v[220:223]
v_mfma_f32_16x16x32_bf16 v[220:223], a[112:115], a[24:27], v[220:223]
s_waitcnt lgkmcnt(0)
v_mfma_f32_16x16x32_bf16 v[224:227], a[128:131], a[24:27], v[224:227]
ds_read_b128 a[96:99], v5 offset:38912
v_mfma_f32_16x16x32_bf16 v[224:227], a[132:135], a[28:31], v[224:227]
buffer_load_dwordx4 a[80:83], v2, s[40:43], s35 offen offset:2048 sc1
v_mfma_f32_16x16x32_bf16 v[200:203], a[132:135], a[20:23], v[200:203]
ds_read_b128 a[100:103], v5 offset:45056
v_mfma_f32_16x16x32_bf16 v[200:203], a[128:131], a[16:19], v[200:203]
v_mfma_f32_16x16x32_bf16 v[176:179], a[128:131], a[8:11], v[176:179]
v_mfma_f32_16x16x32_bf16 v[176:179], a[132:135], a[12:15], v[176:179]
buffer_load_dwordx4 a[84:87], v2, s[40:43], s33 offen offset:2048 sc1
v_mfma_f32_16x16x32_bf16 v[152:155], a[132:135], a[4:7], v[152:155]
ds_read_b128 a[104:107], v5 offset:39936
v_mfma_f32_16x16x32_bf16 v[152:155], a[128:131], a[0:3], v[152:155]
v_mfma_f32_16x16x32_bf16 v[132:135], a[136:139], a[0:3], v[132:135]
ds_read_b128 a[108:111], v5 offset:46080
v_mfma_f32_16x16x32_bf16 v[132:135], a[140:143], a[4:7], v[132:135]
v_mfma_f32_16x16x32_bf16 v[156:159], a[140:143], a[12:15], v[156:159]
buffer_load_dwordx4 v[120:123], v1, s[4:7], s88 offen offset:3072 sc1
s_add_u32 m0, s18, 0x0
v_mfma_f32_16x16x32_bf16 v[156:159], a[136:139], a[8:11], v[156:159]
s_add_u32 s44, s50, 0x2824000
ds_read_b128 a[112:115], v5 offset:40960
v_mfma_f32_16x16x32_bf16 v[180:183], a[136:139], a[16:19], v[180:183]
v_mfma_f32_16x16x32_bf16 v[180:183], a[140:143], a[20:23], v[180:183]
ds_read_b128 a[116:119], v5 offset:47104
v_mfma_f32_16x16x32_bf16 v[204:207], a[140:143], a[28:31], v[204:207]
v_mfma_f32_16x16x32_bf16 v[204:207], a[136:139], a[24:27], v[204:207]
buffer_load_dwordx4 a[88:91], v2, s[40:43], s35 offen offset:3072 sc1
v_mfma_f32_16x16x32_bf16 v[208:211], a[144:147], a[24:27], v[208:211]
v_mfma_f32_16x16x32_bf16 v[208:211], a[148:151], a[28:31], v[208:211]
v_mfma_f32_16x16x32_bf16 v[184:187], a[148:151], a[20:23], v[184:187]
v_mfma_f32_16x16x32_bf16 v[184:187], a[144:147], a[16:19], v[184:187]
v_mfma_f32_16x16x32_bf16 v[160:163], a[144:147], a[8:11], v[160:163]
buffer_load_dwordx4 a[92:95], v2, s[40:43], s33 offen offset:3072 sc1
s_add_u32 s35, s35, 0x4000
v_mfma_f32_16x16x32_bf16 v[160:163], a[148:151], a[12:15], v[160:163]
s_add_u32 s33, s33, 0x4000
v_mfma_f32_16x16x32_bf16 v[136:139], a[148:151], a[4:7], v[136:139]
v_mfma_f32_16x16x32_bf16 v[136:139], a[144:147], a[0:3], v[136:139]
s_waitcnt vmcnt(10) lgkmcnt(0)
v_mfma_f32_16x16x32_bf16 v[140:143], a[96:99], a[32:35], v[140:143]
ds_read_b128 a[128:131], v5 offset:41984
v_mfma_f32_16x16x32_bf16 v[140:143], a[100:103], a[36:39], v[140:143]
buffer_load_dwordx4 a[0:3], v2, s[40:43], s35 offen offset:0 sc1
v_mfma_f32_16x16x32_bf16 v[164:167], a[100:103], a[44:47], v[164:167]
ds_read_b128 a[132:135], v5 offset:48128
v_mfma_f32_16x16x32_bf16 v[164:167], a[96:99], a[40:43], v[164:167]
v_mfma_f32_16x16x32_bf16 v[188:191], a[96:99], a[48:51], v[188:191]
v_mfma_f32_16x16x32_bf16 v[188:191], a[100:103], a[52:55], v[188:191]
buffer_load_dwordx4 v1, s[4:7], s44 offen offset:0 sc1 lds
v_mfma_f32_16x16x32_bf16 v[212:215], a[100:103], a[60:63], v[212:215]
ds_read_b128 a[136:139], v5 offset:36864
v_mfma_f32_16x16x32_bf16 v[212:215], a[96:99], a[56:59], v[212:215]
v_mfma_f32_16x16x32_bf16 v[216:219], a[104:107], a[56:59], v[216:219]
ds_read_b128 a[140:143], v5 offset:43008
v_mfma_f32_16x16x32_bf16 v[216:219], a[108:111], a[60:63], v[216:219]
buffer_load_dwordx4 a[4:7], v2, s[40:43], s33 offen offset:0 sc1
v_mfma_f32_16x16x32_bf16 v[192:195], a[108:111], a[52:55], v[192:195]
ds_read_b128 a[144:147], v5 offset:37888
v_mfma_f32_16x16x32_bf16 v[192:195], a[104:107], a[48:51], v[192:195]
v_mfma_f32_16x16x32_bf16 v[168:171], a[104:107], a[40:43], v[168:171]
v_mfma_f32_16x16x32_bf16 v[168:171], a[108:111], a[44:47], v[168:171]
buffer_load_dwordx4 a[8:11], v2, s[40:43], s35 offen offset:1024 sc1
v_mfma_f32_16x16x32_bf16 v[144:147], a[108:111], a[36:39], v[144:147]
ds_read_b128 a[148:151], v5 offset:44032
v_mfma_f32_16x16x32_bf16 v[144:147], a[104:107], a[32:35], v[144:147]
v_mfma_f32_16x16x32_bf16 v[148:151], a[112:115], a[32:35], v[148:151]
v_mfma_f32_16x16x32_bf16 v[148:151], a[116:119], a[36:39], v[148:151]
buffer_load_dwordx4 v1, s[4:7], s44 offen offset:1024 sc1 lds
s_add_u32 m0, s18, 0x2000
v_mfma_f32_16x16x32_bf16 v[172:175], a[116:119], a[44:47], v[172:175]
s_add_u32 s44, s50, 0x2826000
v_mfma_f32_16x16x32_bf16 v[172:175], a[112:115], a[40:43], v[172:175]
v_mfma_f32_16x16x32_bf16 v[196:199], a[112:115], a[48:51], v[196:199]
v_mfma_f32_16x16x32_bf16 v[196:199], a[116:119], a[52:55], v[196:199]
buffer_load_dwordx4 a[12:15], v2, s[40:43], s33 offen offset:1024 sc1
v_mfma_f32_16x16x32_bf16 v[220:223], a[116:119], a[60:63], v[220:223]
v_mfma_f32_16x16x32_bf16 v[220:223], a[112:115], a[56:59], v[220:223]
s_waitcnt lgkmcnt(0)
s_barrier
v_mfma_f32_16x16x32_bf16 v[224:227], a[128:131], a[56:59], v[224:227]
v_add_u32 v5, 98304, v1
v_mfma_f32_16x16x32_bf16 v[224:227], a[132:135], a[60:63], v[224:227]
buffer_load_dwordx4 a[16:19], v2, s[40:43], s35 offen offset:2048 sc1
v_mfma_f32_16x16x32_bf16 v[200:203], a[132:135], a[52:55], v[200:203]
ds_read_b128 a[96:99], v5 offset:2048
v_mfma_f32_16x16x32_bf16 v[200:203], a[128:131], a[48:51], v[200:203]
ds_read_b128 a[100:103], v5 offset:8192
v_mfma_f32_16x16x32_bf16 v[176:179], a[128:131], a[40:43], v[176:179]
v_mfma_f32_16x16x32_bf16 v[176:179], a[132:135], a[44:47], v[176:179]
buffer_load_dwordx4 a[20:23], v2, s[40:43], s33 offen offset:2048 sc1
v_mfma_f32_16x16x32_bf16 v[152:155], a[132:135], a[36:39], v[152:155]
ds_read_b128 a[104:107], v5 offset:3072
v_mfma_f32_16x16x32_bf16 v[152:155], a[128:131], a[32:35], v[152:155]
v_mfma_f32_16x16x32_bf16 v[132:135], a[136:139], a[32:35], v[132:135]
ds_read_b128 a[108:111], v5 offset:9216
v_mfma_f32_16x16x32_bf16 v[132:135], a[140:143], a[36:39], v[132:135]
v_mfma_f32_16x16x32_bf16 v[156:159], a[140:143], a[44:47], v[156:159]
buffer_load_dwordx4 v1, s[4:7], s44 offen offset:0 sc1 lds
v_mfma_f32_16x16x32_bf16 v[156:159], a[136:139], a[40:43], v[156:159]
ds_read_b128 a[112:115], v5 offset:4096
v_mfma_f32_16x16x32_bf16 v[180:183], a[136:139], a[48:51], v[180:183]
v_mfma_f32_16x16x32_bf16 v[180:183], a[140:143], a[52:55], v[180:183]
ds_read_b128 a[116:119], v5 offset:10240
v_mfma_f32_16x16x32_bf16 v[204:207], a[140:143], a[60:63], v[204:207]
v_mfma_f32_16x16x32_bf16 v[204:207], a[136:139], a[56:59], v[204:207]
buffer_load_dwordx4 a[24:27], v2, s[40:43], s35 offen offset:3072 sc1
v_mfma_f32_16x16x32_bf16 v[208:211], a[144:147], a[56:59], v[208:211]
v_mfma_f32_16x16x32_bf16 v[208:211], a[148:151], a[60:63], v[208:211]
v_mfma_f32_16x16x32_bf16 v[184:187], a[148:151], a[52:55], v[184:187]
v_mfma_f32_16x16x32_bf16 v[184:187], a[144:147], a[48:51], v[184:187]
v_mfma_f32_16x16x32_bf16 v[160:163], a[144:147], a[40:43], v[160:163]
buffer_load_dwordx4 a[28:31], v2, s[40:43], s33 offen offset:3072 sc1
s_add_u32 s35, s35, 0x4000
v_mfma_f32_16x16x32_bf16 v[160:163], a[148:151], a[44:47], v[160:163]
s_add_u32 s33, s33, 0x4000
v_mfma_f32_16x16x32_bf16 v[136:139], a[148:151], a[36:39], v[136:139]
v_mfma_f32_16x16x32_bf16 v[136:139], a[144:147], a[32:35], v[136:139]
s_waitcnt vmcnt(11) lgkmcnt(0)
v_mfma_f32_16x16x32_bf16 v[140:143], a[96:99], a[64:67], v[140:143]
ds_read_b128 a[128:131], v5 offset:5120
v_mfma_f32_16x16x32_bf16 v[140:143], a[100:103], a[68:71], v[140:143]
buffer_load_dwordx4 a[32:35], v2, s[40:43], s35 offen offset:0 sc1
v_mfma_f32_16x16x32_bf16 v[164:167], a[100:103], a[76:79], v[164:167]
ds_read_b128 a[132:135], v5 offset:11264
v_mfma_f32_16x16x32_bf16 v[164:167], a[96:99], a[72:75], v[164:167]
v_mfma_f32_16x16x32_bf16 v[188:191], a[96:99], a[80:83], v[188:191]
v_mfma_f32_16x16x32_bf16 v[188:191], a[100:103], a[84:87], v[188:191]
buffer_load_dwordx4 a[36:39], v2, s[40:43], s33 offen offset:0 sc1
v_mfma_f32_16x16x32_bf16 v[212:215], a[100:103], a[92:95], v[212:215]
ds_read_b128 a[136:139], v5 offset:0
v_mfma_f32_16x16x32_bf16 v[212:215], a[96:99], a[88:91], v[212:215]
v_mfma_f32_16x16x32_bf16 v[216:219], a[104:107], a[88:91], v[216:219]
ds_read_b128 a[140:143], v5 offset:6144
v_mfma_f32_16x16x32_bf16 v[216:219], a[108:111], a[92:95], v[216:219]
v_mfma_f32_16x16x32_bf16 v[192:195], a[108:111], a[84:87], v[192:195]
buffer_load_dwordx4 v1, s[4:7], s44 offen offset:1024 sc1 lds
s_add_u32 m0, s18, 0x4000
v_mfma_f32_16x16x32_bf16 v[192:195], a[104:107], a[80:83], v[192:195]
s_add_u32 s44, s50, 0x2828000
ds_read_b128 a[144:147], v5 offset:1024
v_mfma_f32_16x16x32_bf16 v[168:171], a[104:107], a[72:75], v[168:171]
v_mfma_f32_16x16x32_bf16 v[168:171], a[108:111], a[76:79], v[168:171]
ds_read_b128 a[148:151], v5 offset:7168
v_mfma_f32_16x16x32_bf16 v[144:147], a[108:111], a[68:71], v[144:147]
v_mfma_f32_16x16x32_bf16 v[144:147], a[104:107], a[64:67], v[144:147]
buffer_load_dwordx4 a[40:43], v2, s[40:43], s35 offen offset:1024 sc1
v_mfma_f32_16x16x32_bf16 v[148:151], a[112:115], a[64:67], v[148:151]
v_mfma_f32_16x16x32_bf16 v[148:151], a[116:119], a[68:71], v[148:151]
v_mfma_f32_16x16x32_bf16 v[172:175], a[116:119], a[76:79], v[172:175]
v_mfma_f32_16x16x32_bf16 v[172:175], a[112:115], a[72:75], v[172:175]
v_mfma_f32_16x16x32_bf16 v[196:199], a[112:115], a[80:83], v[196:199]
buffer_load_dwordx4 a[44:47], v2, s[40:43], s33 offen offset:1024 sc1
v_mfma_f32_16x16x32_bf16 v[196:199], a[116:119], a[84:87], v[196:199]
v_mfma_f32_16x16x32_bf16 v[220:223], a[116:119], a[92:95], v[220:223]
v_mfma_f32_16x16x32_bf16 v[220:223], a[112:115], a[88:91], v[220:223]
s_waitcnt lgkmcnt(0)
v_mfma_f32_16x16x32_bf16 v[224:227], a[128:131], a[88:91], v[224:227]
ds_read_b128 a[96:99], v5 offset:14336
v_mfma_f32_16x16x32_bf16 v[224:227], a[132:135], a[92:95], v[224:227]
buffer_load_dwordx4 a[48:51], v2, s[40:43], s35 offen offset:2048 sc1
v_mfma_f32_16x16x32_bf16 v[200:203], a[132:135], a[84:87], v[200:203]
ds_read_b128 a[100:103], v5 offset:20480
v_mfma_f32_16x16x32_bf16 v[200:203], a[128:131], a[80:83], v[200:203]
v_mfma_f32_16x16x32_bf16 v[176:179], a[128:131], a[72:75], v[176:179]
v_mfma_f32_16x16x32_bf16 v[176:179], a[132:135], a[76:79], v[176:179]
buffer_load_dwordx4 a[52:55], v2, s[40:43], s33 offen offset:2048 sc1
v_mfma_f32_16x16x32_bf16 v[152:155], a[132:135], a[68:71], v[152:155]
ds_read_b128 a[104:107], v5 offset:15360
v_mfma_f32_16x16x32_bf16 v[152:155], a[128:131], a[64:67], v[152:155]
v_mfma_f32_16x16x32_bf16 v[132:135], a[136:139], a[64:67], v[132:135]
ds_read_b128 a[108:111], v5 offset:21504
v_mfma_f32_16x16x32_bf16 v[132:135], a[140:143], a[68:71], v[132:135]
v_mfma_f32_16x16x32_bf16 v[156:159], a[140:143], a[76:79], v[156:159]
buffer_load_dwordx4 v1, s[4:7], s44 offen offset:0 sc1 lds
v_mfma_f32_16x16x32_bf16 v[156:159], a[136:139], a[72:75], v[156:159]
ds_read_b128 a[112:115], v5 offset:16384
v_mfma_f32_16x16x32_bf16 v[180:183], a[136:139], a[80:83], v[180:183]
v_mfma_f32_16x16x32_bf16 v[180:183], a[140:143], a[84:87], v[180:183]
ds_read_b128 a[116:119], v5 offset:22528
v_mfma_f32_16x16x32_bf16 v[204:207], a[140:143], a[92:95], v[204:207]
v_mfma_f32_16x16x32_bf16 v[204:207], a[136:139], a[88:91], v[204:207]
buffer_load_dwordx4 a[56:59], v2, s[40:43], s35 offen offset:3072 sc1
v_mfma_f32_16x16x32_bf16 v[208:211], a[144:147], a[88:91], v[208:211]
v_mfma_f32_16x16x32_bf16 v[208:211], a[148:151], a[92:95], v[208:211]
v_mfma_f32_16x16x32_bf16 v[184:187], a[148:151], a[84:87], v[184:187]
v_mfma_f32_16x16x32_bf16 v[184:187], a[144:147], a[80:83], v[184:187]
v_mfma_f32_16x16x32_bf16 v[160:163], a[144:147], a[72:75], v[160:163]
buffer_load_dwordx4 a[60:63], v2, s[40:43], s33 offen offset:3072 sc1
s_add_u32 s35, s35, 0x4000
v_mfma_f32_16x16x32_bf16 v[160:163], a[148:151], a[76:79], v[160:163]
s_add_u32 s33, s33, 0x4000
v_mfma_f32_16x16x32_bf16 v[136:139], a[148:151], a[68:71], v[136:139]
v_mfma_f32_16x16x32_bf16 v[136:139], a[144:147], a[64:67], v[136:139]
s_waitcnt vmcnt(10) lgkmcnt(0)
v_mfma_f32_16x16x32_bf16 v[140:143], a[96:99], a[0:3], v[140:143]
ds_read_b128 a[128:131], v5 offset:17408
v_add_f32 v92, v92, v96
v_mfma_f32_16x16x32_bf16 v[140:143], a[100:103], a[4:7], v[140:143]
buffer_load_dwordx4 a[64:67], v2, s[40:43], s35 offen offset:0 sc1
v_mfma_f32_16x16x32_bf16 v[164:167], a[100:103], a[12:15], v[164:167]
ds_read_b128 a[132:135], v5 offset:23552
v_add_f32 v100, v100, v104
v_mfma_f32_16x16x32_bf16 v[164:167], a[96:99], a[8:11], v[164:167]
v_add_f32 v108, v108, v112
v_add_f32 v116, v116, v120
v_mfma_f32_16x16x32_bf16 v[188:191], a[96:99], a[16:19], v[188:191]
v_add_f32 v93, v93, v97
v_add_f32 v101, v101, v105
v_mfma_f32_16x16x32_bf16 v[188:191], a[100:103], a[20:23], v[188:191]
buffer_load_dwordx4 a[68:71], v2, s[40:43], s33 offen offset:0 sc1
v_mfma_f32_16x16x32_bf16 v[212:215], a[100:103], a[28:31], v[212:215]
ds_read_b128 a[136:139], v5 offset:12288
v_add_f32 v109, v109, v113
v_mfma_f32_16x16x32_bf16 v[212:215], a[96:99], a[24:27], v[212:215]
v_add_f32 v117, v117, v121
v_add_f32 v94, v94, v98
v_mfma_f32_16x16x32_bf16 v[216:219], a[104:107], a[24:27], v[216:219]
ds_read_b128 a[140:143], v5 offset:18432
v_add_f32 v102, v102, v106
v_mfma_f32_16x16x32_bf16 v[216:219], a[108:111], a[28:31], v[216:219]
v_add_f32 v110, v110, v114
v_mfma_f32_16x16x32_bf16 v[192:195], a[108:111], a[20:23], v[192:195]
buffer_load_dwordx4 v1, s[4:7], s44 offen offset:1024 sc1 lds
s_add_u32 m0, s18, 0x6000
v_mfma_f32_16x16x32_bf16 v[192:195], a[104:107], a[16:19], v[192:195]
s_add_u32 s44, s50, 0x282a000
ds_read_b128 a[144:147], v5 offset:13312
v_mfma_f32_16x16x32_bf16 v[168:171], a[104:107], a[8:11], v[168:171]
v_add_f32 v118, v118, v122
L_stub16:
s_cbranch_execz L_wret6
v_add_f32 v95, v95, v99
v_mfma_f32_16x16x32_bf16 v[168:171], a[108:111], a[12:15], v[168:171]
ds_read_b128 a[148:151], v5 offset:19456
v_add_f32 v103, v103, v107
v_mfma_f32_16x16x32_bf16 v[144:147], a[108:111], a[4:7], v[144:147]
v_add_f32 v111, v111, v115
v_add_f32 v119, v119, v123
v_mfma_f32_16x16x32_bf16 v[144:147], a[104:107], a[0:3], v[144:147]
buffer_load_dwordx4 a[72:75], v2, s[40:43], s35 offen offset:1024 sc1
v_mfma_f32_16x16x32_bf16 v[148:151], a[112:115], a[0:3], v[148:151]
v_add_f32_dpp v92, v92, v92 row_ror:8 row_mask:0xf bank_mask:0xf
v_add_f32_dpp v100, v100, v100 row_ror:8 row_mask:0xf bank_mask:0xf
v_mfma_f32_16x16x32_bf16 v[148:151], a[116:119], a[4:7], v[148:151]
v_add_f32_dpp v108, v108, v108 row_ror:8 row_mask:0xf bank_mask:0xf
v_mfma_f32_16x16x32_bf16 v[172:175], a[116:119], a[12:15], v[172:175]
v_add_f32_dpp v116, v116, v116 row_ror:8 row_mask:0xf bank_mask:0xf
v_mfma_f32_16x16x32_bf16 v[172:175], a[112:115], a[8:11], v[172:175]
v_add_f32_dpp v93, v93, v93 row_ror:8 row_mask:0xf bank_mask:0xf
v_mfma_f32_16x16x32_bf16 v[196:199], a[112:115], a[16:19], v[196:199]
buffer_load_dwordx4 a[76:79], v2, s[40:43], s33 offen offset:1024 sc1
v_mfma_f32_16x16x32_bf16 v[196:199], a[116:119], a[20:23], v[196:199]
v_add_f32_dpp v101, v101, v101 row_ror:8 row_mask:0xf bank_mask:0xf
v_add_f32_dpp v109, v109, v109 row_ror:8 row_mask:0xf bank_mask:0xf
v_mfma_f32_16x16x32_bf16 v[220:223], a[116:119], a[28:31], v[220:223]
v_add_f32_dpp v117, v117, v117 row_ror:8 row_mask:0xf bank_mask:0xf
v_mfma_f32_16x16x32_bf16 v[220:223], a[112:115], a[24:27], v[220:223]
v_add_f32_dpp v92, v94, v94 row_ror:8 row_mask:0xf bank_mask:0xc
s_waitcnt lgkmcnt(0)
v_mfma_f32_16x16x32_bf16 v[224:227], a[128:131], a[24:27], v[224:227]
ds_read_b128 a[96:99], v5 offset:26624
v_add_f32_dpp v100, v102, v102 row_ror:8 row_mask:0xf bank_mask:0xc
v_mfma_f32_16x16x32_bf16 v[224:227], a[132:135], a[28:31], v[224:227]
buffer_load_dwordx4 a[80:83], v2, s[40:43], s35 offen offset:2048 sc1
v_mfma_f32_16x16x32_bf16 v[200:203], a[132:135], a[20:23], v[200:203]
ds_read_b128 a[100:103], v5 offset:32768
v_add_f32_dpp v108, v110, v110 row_ror:8 row_mask:0xf bank_mask:0xc
v_mfma_f32_16x16x32_bf16 v[200:203], a[128:131], a[16:19], v[200:203]
v_add_f32_dpp v116, v118, v118 row_ror:8 row_mask:0xf bank_mask:0xc
v_add_f32_dpp v93, v95, v95 row_ror:8 row_mask:0xf bank_mask:0xc
v_mfma_f32_16x16x32_bf16 v[176:179], a[128:131], a[8:11], v[176:179]
v_add_f32_dpp v101, v103, v103 row_ror:8 row_mask:0xf bank_mask:0xc
v_add_f32_dpp v109, v111, v111 row_ror:8 row_mask:0xf bank_mask:0xc
v_mfma_f32_16x16x32_bf16 v[176:179], a[132:135], a[12:15], v[176:179]
buffer_load_dwordx4 v1, s[4:7], s44 offen offset:0 sc1 lds
v_mfma_f32_16x16x32_bf16 v[152:155], a[132:135], a[4:7], v[152:155]
ds_read_b128 a[104:107], v5 offset:27648
v_add_f32_dpp v117, v119, v119 row_ror:8 row_mask:0xf bank_mask:0xc
v_mfma_f32_16x16x32_bf16 v[152:155], a[128:131], a[0:3], v[152:155]
v_permlane32_swap_b32 v92, v93
v_mfma_f32_16x16x32_bf16 v[132:135], a[136:139], a[0:3], v[132:135]
ds_read_b128 a[108:111], v5 offset:33792
v_mfma_f32_16x16x32_bf16 v[132:135], a[140:143], a[4:7], v[132:135]
buffer_load_dwordx4 a[84:87], v2, s[40:43], s33 offen offset:2048 sc1
v_mfma_f32_16x16x32_bf16 v[156:159], a[140:143], a[12:15], v[156:159]
ds_read_b128 a[112:115], v5 offset:28672
v_mfma_f32_16x16x32_bf16 v[156:159], a[136:139], a[8:11], v[156:159]
v_permlane32_swap_b32 v100, v101
v_mfma_f32_16x16x32_bf16 v[180:183], a[136:139], a[16:19], v[180:183]
v_permlane32_swap_b32 v108, v109
v_mfma_f32_16x16x32_bf16 v[180:183], a[140:143], a[20:23], v[180:183]
buffer_load_dwordx4 a[88:91], v2, s[40:43], s35 offen offset:3072 sc1
v_mfma_f32_16x16x32_bf16 v[204:207], a[140:143], a[28:31], v[204:207]
ds_read_b128 a[116:119], v5 offset:34816
v_mfma_f32_16x16x32_bf16 v[204:207], a[136:139], a[24:27], v[204:207]
v_permlane32_swap_b32 v116, v117
v_mfma_f32_16x16x32_bf16 v[208:211], a[144:147], a[24:27], v[208:211]
v_add_f32 v92, v92, v93
v_add_f32 v100, v100, v101
v_mfma_f32_16x16x32_bf16 v[208:211], a[148:151], a[28:31], v[208:211]
buffer_load_dwordx4 v1, s[4:7], s44 offen offset:1024 sc1 lds
s_add_u32 m0, s18, 0x8000
v_mfma_f32_16x16x32_bf16 v[184:187], a[148:151], a[20:23], v[184:187]
s_add_u32 s44, s50, 0x282c000
v_add_f32 v108, v108, v109
v_mfma_f32_16x16x32_bf16 v[184:187], a[144:147], a[16:19], v[184:187]
v_add_f32 v116, v116, v117
v_mov_b32 v94, v92
v_mfma_f32_16x16x32_bf16 v[160:163], a[144:147], a[8:11], v[160:163]
v_mov_b32 v102, v100
v_mov_b32 v110, v108
v_mfma_f32_16x16x32_bf16 v[160:163], a[148:151], a[12:15], v[160:163]
buffer_load_dwordx4 a[92:95], v2, s[40:43], s33 offen offset:3072 sc1
s_add_u32 s35, s35, 0x4000
v_mfma_f32_16x16x32_bf16 v[136:139], a[148:151], a[4:7], v[136:139]
s_add_u32 s33, s33, 0x4000
v_mov_b32 v118, v116
v_mfma_f32_16x16x32_bf16 v[136:139], a[144:147], a[0:3], v[136:139]
s_waitcnt vmcnt(11) lgkmcnt(0)
v_mfma_f32_16x16x32_bf16 v[140:143], a[96:99], a[32:35], v[140:143]
ds_read_b128 a[128:131], v5 offset:29696
v_mfma_f32_16x16x32_bf16 v[140:143], a[100:103], a[36:39], v[140:143]
buffer_load_dwordx4 a[0:3], v2, s[40:43], s35 offen offset:0 sc1
v_mfma_f32_16x16x32_bf16 v[164:167], a[100:103], a[44:47], v[164:167]
ds_read_b128 a[132:135], v5 offset:35840
v_mfma_f32_16x16x32_bf16 v[164:167], a[96:99], a[40:43], v[164:167]
v_permlane16_swap_b32 v92, v94
v_mfma_f32_16x16x32_bf16 v[188:191], a[96:99], a[48:51], v[188:191]
v_permlane16_swap_b32 v100, v102
v_mfma_f32_16x16x32_bf16 v[188:191], a[100:103], a[52:55], v[188:191]
buffer_load_dwordx4 a[4:7], v2, s[40:43], s33 offen offset:0 sc1
v_mfma_f32_16x16x32_bf16 v[212:215], a[100:103], a[60:63], v[212:215]
ds_read_b128 a[136:139], v5 offset:24576
v_mfma_f32_16x16x32_bf16 v[212:215], a[96:99], a[56:59], v[212:215]
v_permlane16_swap_b32 v108, v110
v_mfma_f32_16x16x32_bf16 v[216:219], a[104:107], a[56:59], v[216:219]
ds_read_b128 a[140:143], v5 offset:30720
v_mfma_f32_16x16x32_bf16 v[216:219], a[108:111], a[60:63], v[216:219]
v_permlane16_swap_b32 v116, v118
v_mfma_f32_16x16x32_bf16 v[192:195], a[108:111], a[52:55], v[192:195]
buffer_load_dwordx4 v1, s[4:7], s44 offen offset:0 sc1 lds
v_mfma_f32_16x16x32_bf16 v[192:195], a[104:107], a[48:51], v[192:195]
ds_read_b128 a[144:147], v5 offset:25600
v_add_f32 v92, v92, v94
v_mfma_f32_16x16x32_bf16 v[168:171], a[104:107], a[40:43], v[168:171]
v_add_f32 v100, v100, v102
v_add_f32 v108, v108, v110
v_mfma_f32_16x16x32_bf16 v[168:171], a[108:111], a[44:47], v[168:171]
ds_read_b128 a[148:151], v5 offset:31744
v_add_f32 v116, v116, v118
v_mfma_f32_16x16x32_bf16 v[144:147], a[108:111], a[36:39], v[144:147]
v_mov_b32 v94, v92
v_mov_b32 v102, v100
v_mfma_f32_16x16x32_bf16 v[144:147], a[104:107], a[32:35], v[144:147]
buffer_load_dwordx4 a[8:11], v2, s[40:43], s35 offen offset:1024 sc1
v_mfma_f32_16x16x32_bf16 v[148:151], a[112:115], a[32:35], v[148:151]
v_mov_b32 v110, v108
v_mov_b32 v118, v116
v_mfma_f32_16x16x32_bf16 v[148:151], a[116:119], a[36:39], v[148:151]
v_permlane32_swap_b32 v92, v94
v_mfma_f32_16x16x32_bf16 v[172:175], a[116:119], a[44:47], v[172:175]
v_permlane32_swap_b32 v100, v102
v_mfma_f32_16x16x32_bf16 v[172:175], a[112:115], a[40:43], v[172:175]
v_permlane32_swap_b32 v108, v110
v_mfma_f32_16x16x32_bf16 v[196:199], a[112:115], a[48:51], v[196:199]
buffer_load_dwordx4 a[12:15], v2, s[40:43], s33 offen offset:1024 sc1
v_mfma_f32_16x16x32_bf16 v[196:199], a[116:119], a[52:55], v[196:199]
v_permlane32_swap_b32 v116, v118
v_mfma_f32_16x16x32_bf16 v[220:223], a[116:119], a[60:63], v[220:223]
v_mul_f32 v82, 0xba800000, v92
v_mul_f32 v84, 0xba800000, v100
v_mfma_f32_16x16x32_bf16 v[220:223], a[112:115], a[56:59], v[220:223]
v_mul_f32 v86, 0xba800000, v108
s_waitcnt lgkmcnt(0)
v_mfma_f32_16x16x32_bf16 v[224:227], a[128:131], a[56:59], v[224:227]
ds_read_b128 a[96:99], v5 offset:38912
v_mul_f32 v88, 0xba800000, v116
v_mfma_f32_16x16x32_bf16 v[224:227], a[132:135], a[60:63], v[224:227]
buffer_load_dwordx4 a[16:19], v2, s[40:43], s35 offen offset:2048 sc1
v_mfma_f32_16x16x32_bf16 v[200:203], a[132:135], a[52:55], v[200:203]
ds_read_b128 a[100:103], v5 offset:45056
v_mul_f32 v94, 0x3a800000, v94
v_mfma_f32_16x16x32_bf16 v[200:203], a[128:131], a[48:51], v[200:203]
v_mul_f32 v102, 0x3a800000, v102
v_mul_f32 v110, 0x3a800000, v110
v_mfma_f32_16x16x32_bf16 v[176:179], a[128:131], a[40:43], v[176:179]
v_mul_f32 v118, 0x3a800000, v118
v_fma_f32 v94, -v82, v82, v94
v_mfma_f32_16x16x32_bf16 v[176:179], a[132:135], a[44:47], v[176:179]
buffer_load_dwordx4 a[20:23], v2, s[40:43], s33 offen offset:2048 sc1
v_mfma_f32_16x16x32_bf16 v[152:155], a[132:135], a[36:39], v[152:155]
ds_read_b128 a[104:107], v5 offset:39936
v_fma_f32 v102, -v84, v84, v102
v_mfma_f32_16x16x32_bf16 v[152:155], a[128:131], a[32:35], v[152:155]
v_fma_f32 v110, -v86, v86, v110
v_fma_f32 v118, -v88, v88, v118
v_mfma_f32_16x16x32_bf16 v[132:135], a[136:139], a[32:35], v[132:135]
ds_read_b128 a[108:111], v5 offset:46080
v_max_f32 v94, 0, v94
v_mfma_f32_16x16x32_bf16 v[132:135], a[140:143], a[36:39], v[132:135]
v_max_f32 v102, 0, v102
v_mfma_f32_16x16x32_bf16 v[156:159], a[140:143], a[44:47], v[156:159]
buffer_load_dwordx4 v1, s[4:7], s44 offen offset:1024 sc1 lds
s_add_u32 m0, s18, 0xa000
v_mfma_f32_16x16x32_bf16 v[156:159], a[136:139], a[40:43], v[156:159]
s_add_u32 s44, s50, 0x282e000
ds_read_b128 a[112:115], v5 offset:40960
v_mfma_f32_16x16x32_bf16 v[180:183], a[136:139], a[48:51], v[180:183]
v_max_f32 v110, 0, v110
v_max_f32 v118, 0, v118
v_mfma_f32_16x16x32_bf16 v[180:183], a[140:143], a[52:55], v[180:183]
ds_read_b128 a[116:119], v5 offset:47104
v_add_f32 v94, 0x3727c5ac, v94
v_mfma_f32_16x16x32_bf16 v[204:207], a[140:143], a[60:63], v[204:207]
v_add_f32 v102, 0x3727c5ac, v102
v_add_f32 v110, 0x3727c5ac, v110
v_mfma_f32_16x16x32_bf16 v[204:207], a[136:139], a[56:59], v[204:207]
buffer_load_dwordx4 a[24:27], v2, s[40:43], s35 offen offset:3072 sc1
v_mfma_f32_16x16x32_bf16 v[208:211], a[144:147], a[56:59], v[208:211]
v_add_f32 v118, 0x3727c5ac, v118
v_mfma_f32_16x16x32_bf16 v[208:211], a[148:151], a[60:63], v[208:211]
v_rsq_f32 v83, v94
v_mfma_f32_16x16x32_bf16 v[184:187], a[148:151], a[52:55], v[184:187]
v_rsq_f32 v85, v102
v_mfma_f32_16x16x32_bf16 v[184:187], a[144:147], a[48:51], v[184:187]
v_mfma_f32_16x16x32_bf16 v[160:163], a[144:147], a[40:43], v[160:163]
buffer_load_dwordx4 a[28:31], v2, s[40:43], s33 offen offset:3072 sc1
s_add_u32 s35, s35, 0x4000
v_mfma_f32_16x16x32_bf16 v[160:163], a[148:151], a[44:47], v[160:163]
s_add_u32 s33, s33, 0x4000
v_mfma_f32_16x16x32_bf16 v[136:139], a[148:151], a[36:39], v[136:139]
v_rsq_f32 v87, v110
v_mfma_f32_16x16x32_bf16 v[136:139], a[144:147], a[32:35], v[136:139]
s_waitcnt vmcnt(10) lgkmcnt(0)
v_mfma_f32_16x16x32_bf16 v[140:143], a[96:99], a[64:67], v[140:143]
ds_read_b128 a[128:131], v5 offset:41984
v_mfma_f32_16x16x32_bf16 v[140:143], a[100:103], a[68:71], v[140:143]
buffer_load_dwordx4 a[32:35], v2, s[40:43], s35 offen offset:0 sc1
v_mfma_f32_16x16x32_bf16 v[164:167], a[100:103], a[76:79], v[164:167]
ds_read_b128 a[132:135], v5 offset:48128
v_mfma_f32_16x16x32_bf16 v[164:167], a[96:99], a[72:75], v[164:167]
v_rsq_f32 v89, v118
v_mfma_f32_16x16x32_bf16 v[188:191], a[96:99], a[80:83], v[188:191]
v_mfma_f32_16x16x32_bf16 v[188:191], a[100:103], a[84:87], v[188:191]
buffer_load_dwordx4 a[36:39], v2, s[40:43], s33 offen offset:0 sc1
v_mfma_f32_16x16x32_bf16 v[212:215], a[100:103], a[92:95], v[212:215]
ds_read_b128 a[136:139], v5 offset:36864
v_mfma_f32_16x16x32_bf16 v[212:215], a[96:99], a[88:91], v[212:215]
v_mfma_f32_16x16x32_bf16 v[216:219], a[104:107], a[88:91], v[216:219]
ds_read_b128 a[140:143], v5 offset:43008
v_mfma_f32_16x16x32_bf16 v[216:219], a[108:111], a[92:95], v[216:219]
v_mfma_f32_16x16x32_bf16 v[192:195], a[108:111], a[84:87], v[192:195]
buffer_load_dwordx4 v1, s[4:7], s44 offen offset:0 sc1 lds
v_mfma_f32_16x16x32_bf16 v[192:195], a[104:107], a[80:83], v[192:195]
ds_read_b128 a[144:147], v5 offset:37888
v_fmac_f32 v140, v56, v82
v_mfma_f32_16x16x32_bf16 v[168:171], a[104:107], a[72:75], v[168:171]
v_fmac_f32 v164, v56, v84
v_mfma_f32_16x16x32_bf16 v[168:171], a[108:111], a[76:79], v[168:171]
ds_read_b128 a[148:151], v5 offset:44032
v_mfma_f32_16x16x32_bf16 v[144:147], a[108:111], a[68:71], v[144:147]
v_fmac_f32 v188, v56, v86
v_mfma_f32_16x16x32_bf16 v[144:147], a[104:107], a[64:67], v[144:147]
buffer_load_dwordx4 a[40:43], v2, s[40:43], s35 offen offset:1024 sc1
v_mfma_f32_16x16x32_bf16 v[148:151], a[112:115], a[64:67], v[148:151]
v_fmac_f32 v212, v56, v88
v_mfma_f32_16x16x32_bf16 v[148:151], a[116:119], a[68:71], v[148:151]
v_mfma_f32_16x16x32_bf16 v[172:175], a[116:119], a[76:79], v[172:175]
v_fmac_f32 v216, v60, v88
v_mfma_f32_16x16x32_bf16 v[172:175], a[112:115], a[72:75], v[172:175]
v_mfma_f32_16x16x32_bf16 v[196:199], a[112:115], a[80:83], v[196:199]
buffer_load_dwordx4 a[44:47], v2, s[40:43], s33 offen offset:1024 sc1
v_mfma_f32_16x16x32_bf16 v[196:199], a[116:119], a[84:87], v[196:199]
v_fmac_f32 v192, v60, v86
v_mfma_f32_16x16x32_bf16 v[220:223], a[116:119], a[92:95], v[220:223]
v_fmac_f32 v168, v60, v84
v_fmac_f32 v141, v57, v82
v_mfma_f32_16x16x32_bf16 v[220:223], a[112:115], a[88:91], v[220:223]
s_waitcnt lgkmcnt(0)
s_barrier
v_mfma_f32_16x16x32_bf16 v[224:227], a[128:131], a[88:91], v[224:227]
v_add_u32 v5, 0, v1
v_fmac_f32 v144, v60, v82
v_mfma_f32_16x16x32_bf16 v[224:227], a[132:135], a[92:95], v[224:227]
buffer_load_dwordx4 a[48:51], v2, s[40:43], s35 offen offset:2048 sc1
v_mfma_f32_16x16x32_bf16 v[200:203], a[132:135], a[84:87], v[200:203]
ds_read_b128 a[96:99], v5 offset:2048
v_fmac_f32 v148, v64, v82
v_mfma_f32_16x16x32_bf16 v[200:203], a[128:131], a[80:83], v[200:203]
ds_read_b128 a[100:103], v5 offset:8192
v_fmac_f32 v165, v57, v84
v_mfma_f32_16x16x32_bf16 v[176:179], a[128:131], a[72:75], v[176:179]
v_fmac_f32 v172, v64, v84
v_fmac_f32 v189, v57, v86
v_mfma_f32_16x16x32_bf16 v[176:179], a[132:135], a[76:79], v[176:179]
buffer_load_dwordx4 a[52:55], v2, s[40:43], s33 offen offset:2048 sc1
v_mfma_f32_16x16x32_bf16 v[152:155], a[132:135], a[68:71], v[152:155]
ds_read_b128 a[104:107], v5 offset:3072
v_fmac_f32 v196, v64, v86
v_mfma_f32_16x16x32_bf16 v[152:155], a[128:131], a[64:67], v[152:155]
v_fmac_f32 v213, v57, v88
v_fmac_f32 v217, v61, v88
v_mfma_f32_16x16x32_bf16 v[132:135], a[136:139], a[64:67], v[132:135]
ds_read_b128 a[108:111], v5 offset:9216
v_fmac_f32 v220, v64, v88
v_mfma_f32_16x16x32_bf16 v[132:135], a[140:143], a[68:71], v[132:135]
v_fmac_f32 v193, v61, v86
v_mfma_f32_16x16x32_bf16 v[156:159], a[140:143], a[76:79], v[156:159]
buffer_load_dwordx4 v1, s[4:7], s44 offen offset:1024 sc1 lds
s_add_u32 m0, s19, 49152
v_mfma_f32_16x16x32_bf16 v[156:159], a[136:139], a[72:75], v[156:159]
s_xor_b32 s44, s85, 16384
ds_read_b128 a[112:115], v5 offset:4096
v_mfma_f32_16x16x32_bf16 v[180:183], a[136:139], a[80:83], v[180:183]
v_fmac_f32 v224, v68, v88
v_fmac_f32 v200, v68, v86
v_mfma_f32_16x16x32_bf16 v[180:183], a[140:143], a[84:87], v[180:183]
ds_read_b128 a[116:119], v5 offset:10240
v_fmac_f32 v169, v61, v84
v_mfma_f32_16x16x32_bf16 v[204:207], a[140:143], a[92:95], v[204:207]
v_fmac_f32 v176, v68, v84
v_fmac_f32 v145, v61, v82
v_mfma_f32_16x16x32_bf16 v[204:207], a[136:139], a[88:91], v[204:207]
buffer_load_dwordx4 a[56:59], v2, s[40:43], s35 offen offset:3072 sc1
v_mfma_f32_16x16x32_bf16 v[208:211], a[144:147], a[88:91], v[208:211]
v_fmac_f32 v152, v68, v82
v_fmac_f32 v149, v65, v82
v_mfma_f32_16x16x32_bf16 v[208:211], a[148:151], a[92:95], v[208:211]
v_fmac_f32 v173, v65, v84
v_mfma_f32_16x16x32_bf16 v[184:187], a[148:151], a[84:87], v[184:187]
v_fmac_f32 v132, v48, v82
v_fmac_f32 v197, v65, v86
v_mfma_f32_16x16x32_bf16 v[184:187], a[144:147], a[80:83], v[184:187]
v_mfma_f32_16x16x32_bf16 v[160:163], a[144:147], a[72:75], v[160:163]
buffer_load_dwordx4 a[60:63], v2, s[40:43], s33 offen offset:3072 sc1
s_add_u32 s35, s35, 0x4000
v_mfma_f32_16x16x32_bf16 v[160:163], a[148:151], a[76:79], v[160:163]
s_add_u32 s33, s33, 0x4000
v_fmac_f32 v156, v48, v84
v_mfma_f32_16x16x32_bf16 v[136:139], a[148:151], a[68:71], v[136:139]
v_fmac_f32 v180, v48, v86
v_fmac_f32 v221, v65, v88
v_mfma_f32_16x16x32_bf16 v[136:139], a[144:147], a[64:67], v[136:139]
v_fmac_f32 v225, v69, v88
s_waitcnt vmcnt(10) lgkmcnt(0)
v_mfma_f32_16x16x32_bf16 v[140:143], a[96:99], a[0:3], v[140:143]
ds_read_b128 a[128:131], v5 offset:5120
v_fmac_f32 v204, v48, v88
v_mfma_f32_16x16x32_bf16 v[140:143], a[100:103], a[4:7], v[140:143]
buffer_load_dwordx4 a[64:67], v2, s[40:43], s35 offen offset:0 sc1
s_lshl_b32 s36, s28, 9
v_mfma_f32_16x16x32_bf16 v[164:167], a[100:103], a[12:15], v[164:167]
ds_read_b128 a[132:135], v5 offset:11264
v_fmac_f32 v208, v52, v88
v_mfma_f32_16x16x32_bf16 v[164:167], a[96:99], a[8:11], v[164:167]
v_fmac_f32 v201, v69, v86
v_fmac_f32 v177, v69, v84
v_mfma_f32_16x16x32_bf16 v[188:191], a[96:99], a[16:19], v[188:191]
v_fmac_f32 v184, v52, v86
v_fmac_f32 v153, v69, v82
v_mfma_f32_16x16x32_bf16 v[188:191], a[100:103], a[20:23], v[188:191]
buffer_load_dwordx4 a[68:71], v2, s[40:43], s33 offen offset:0 sc1
s_lshl_b32 s37, s30, 2
v_mfma_f32_16x16x32_bf16 v[212:215], a[100:103], a[28:31], v[212:215]
ds_read_b128 a[136:139], v5 offset:0
v_fmac_f32 v160, v52, v84
v_mfma_f32_16x16x32_bf16 v[212:215], a[96:99], a[24:27], v[212:215]
v_fmac_f32 v133, v49, v82
v_add_u32 v232, s19, v7
v_mfma_f32_16x16x32_bf16 v[216:219], a[104:107], a[24:27], v[216:219]
ds_read_b128 a[140:143], v5 offset:6144
v_fmac_f32 v136, v52, v82
v_mfma_f32_16x16x32_bf16 v[216:219], a[108:111], a[28:31], v[216:219]
buffer_load_dwordx4 a[72:75], v2, s[40:43], s35 offen offset:1024 sc1
s_add_u32 s37, s37, s28
v_mfma_f32_16x16x32_bf16 v[192:195], a[108:111], a[20:23], v[192:195]
ds_read_b128 a[144:147], v5 offset:1024
v_fmac_f32 v157, v49, v84
v_mfma_f32_16x16x32_bf16 v[192:195], a[104:107], a[16:19], v[192:195]
v_fmac_f32 v181, v49, v86
v_fmac_f32 v142, v58, v82
v_mfma_f32_16x16x32_bf16 v[168:171], a[104:107], a[8:11], v[168:171]
v_fmac_f32 v205, v49, v88
v_fmac_f32 v166, v58, v84
v_mfma_f32_16x16x32_bf16 v[168:171], a[108:111], a[12:15], v[168:171]
buffer_load_dwordx4 a[76:79], v2, s[40:43], s33 offen offset:1024 sc1
s_lshr_b32 s98, s37, 1
v_mfma_f32_16x16x32_bf16 v[144:147], a[108:111], a[4:7], v[144:147]
ds_read_b128 a[148:151], v5 offset:7168
v_fmac_f32 v209, v53, v88
v_mfma_f32_16x16x32_bf16 v[144:147], a[104:107], a[0:3], v[144:147]
v_fmac_f32 v190, v58, v86
s_lshl_b32 s98, s98, 14
v_mfma_f32_16x16x32_bf16 v[148:151], a[112:115], a[0:3], v[148:151]
v_fmac_f32 v185, v53, v86
v_fmac_f32 v214, v58, v88
v_mfma_f32_16x16x32_bf16 v[148:151], a[116:119], a[4:7], v[148:151]
buffer_load_dwordx4 a[80:83], v2, s[40:43], s35 offen offset:2048 sc1
s_and_b32 s99, s19, 0x1000
v_mfma_f32_16x16x32_bf16 v[172:175], a[116:119], a[12:15], v[172:175]
v_fmac_f32 v161, v53, v84
v_fmac_f32 v218, v62, v88
v_mfma_f32_16x16x32_bf16 v[172:175], a[112:115], a[8:11], v[172:175]
s_add_u32 s98, s98, s99
s_bfe_u32 s90, s51, 0x10005
s_lshl_b32 s90, s90, 13
v_mfma_f32_16x16x32_bf16 v[196:199], a[112:115], a[16:19], v[196:199]
v_fmac_f32 v137, v53, v82
v_fmac_f32 v194, v62, v86
v_mfma_f32_16x16x32_bf16 v[196:199], a[116:119], a[20:23], v[196:199]
buffer_load_dwordx4 a[84:87], v2, s[40:43], s33 offen offset:2048 sc1
s_add_u32 s98, s98, s90
v_mfma_f32_16x16x32_bf16 v[220:223], a[116:119], a[28:31], v[220:223]
v_fmac_f32 v170, v62, v84
v_fmac_f32 v143, v59, v82
v_mfma_f32_16x16x32_bf16 v[220:223], a[112:115], a[24:27], v[220:223]
s_add_u32 s98, s98, 0x1500000
s_waitcnt lgkmcnt(0)
v_mfma_f32_16x16x32_bf16 v[224:227], a[128:131], a[24:27], v[224:227]
ds_read_b128 a[96:99], v5 offset:14336
v_fmac_f32 v146, v62, v82
v_mfma_f32_16x16x32_bf16 v[224:227], a[132:135], a[28:31], v[224:227]
buffer_load_dwordx4 a[88:91], v2, s[40:43], s35 offen offset:3072 sc1
s_xor_b32 s99, s98, 0x2000
v_mfma_f32_16x16x32_bf16 v[200:203], a[132:135], a[20:23], v[200:203]
ds_read_b128 a[100:103], v5 offset:20480
v_fmac_f32 v150, v66, v82
v_mfma_f32_16x16x32_bf16 v[200:203], a[128:131], a[16:19], v[200:203]
v_fmac_f32 v167, v59, v84
v_fmac_f32 v191, v59, v86
v_mfma_f32_16x16x32_bf16 v[176:179], a[128:131], a[8:11], v[176:179]
v_fmac_f32 v174, v66, v84
v_fmac_f32 v215, v59, v88
v_mfma_f32_16x16x32_bf16 v[176:179], a[132:135], a[12:15], v[176:179]
ds_read_b128 a[104:107], v5 offset:15360
s_and_b32 s91, s29, 4
v_mfma_f32_16x16x32_bf16 v[152:155], a[132:135], a[4:7], v[152:155]
v_fmac_f32 v198, v66, v86
v_fmac_f32 v219, v63, v88
v_mfma_f32_16x16x32_bf16 v[152:155], a[128:131], a[0:3], v[152:155]
buffer_load_dwordx4 v1, s[4:7], s44 offen offset:0 sc1 lds
s_lshl_b32 s91, s91, 11
v_mfma_f32_16x16x32_bf16 v[132:135], a[136:139], a[0:3], v[132:135]
ds_read_b128 a[108:111], v5 offset:21504
v_fmac_f32 v222, v66, v88
v_mfma_f32_16x16x32_bf16 v[132:135], a[140:143], a[4:7], v[132:135]
v_fmac_f32 v195, v63, v86
s_xor_b32 s96, s98, s91
v_mfma_f32_16x16x32_bf16 v[156:159], a[140:143], a[12:15], v[156:159]
ds_read_b128 a[112:115], v5 offset:16384
v_fmac_f32 v226, v70, v88
v_mfma_f32_16x16x32_bf16 v[156:159], a[136:139], a[8:11], v[156:159]
v_fmac_f32 v171, v63, v84
s_lshl_b32 s97, s81, 10
v_mfma_f32_16x16x32_bf16 v[180:183], a[136:139], a[16:19], v[180:183]
v_fmac_f32 v202, v70, v86
v_fmac_f32 v147, v63, v82
v_mfma_f32_16x16x32_bf16 v[180:183], a[140:143], a[20:23], v[180:183]
buffer_load_dwordx4 a[92:95], v2, s[40:43], s33 offen offset:3072 sc1
s_add_u32 s35, s35, 0x4000
v_mfma_f32_16x16x32_bf16 v[204:207], a[140:143], a[28:31], v[204:207]
s_add_u32 s33, s33, 0x4000
ds_read_b128 a[116:119], v5 offset:22528
v_mfma_f32_16x16x32_bf16 v[204:207], a[136:139], a[24:27], v[204:207]
v_fmac_f32 v178, v70, v84
v_fmac_f32 v151, v67, v82
v_mfma_f32_16x16x32_bf16 v[208:211], a[144:147], a[24:27], v[208:211]
v_fmac_f32 v154, v70, v82
v_fmac_f32 v175, v67, v84
v_mfma_f32_16x16x32_bf16 v[208:211], a[148:151], a[28:31], v[208:211]
s_add_u32 s96, s96, s97
s_lshr_b32 s100, s37, 4
s_lshl_b32 s100, s100, 14
v_mfma_f32_16x16x32_bf16 v[184:187], a[148:151], a[20:23], v[184:187]
v_fmac_f32 v134, v50, v82
v_fmac_f32 v199, v67, v86
v_mfma_f32_16x16x32_bf16 v[184:187], a[144:147], a[16:19], v[184:187]
buffer_load_dwordx4 v1, s[4:7], s44 offen offset:1024 sc1 lds
s_and_b32 s37, s37, 15
v_mfma_f32_16x16x32_bf16 v[160:163], a[144:147], a[8:11], v[160:163]
v_fmac_f32 v158, v50, v84
v_fmac_f32 v223, v67, v88
v_mfma_f32_16x16x32_bf16 v[160:163], a[148:151], a[12:15], v[160:163]
s_lshl_b32 s37, s37, 9
s_add_u32 s100, s100, s37
s_add_u32 s100, s100, 0x260000
v_mfma_f32_16x16x32_bf16 v[136:139], a[148:151], a[4:7], v[136:139]
v_fmac_f32 v182, v50, v86
v_fmac_f32 v227, v71, v88
v_mfma_f32_16x16x32_bf16 v[136:139], a[144:147], a[0:3], v[136:139]
s_waitcnt vmcnt(10) lgkmcnt(0)
s_barrier
v_mfma_f32_16x16x32_bf16 v[140:143], a[96:99], a[32:35], v[140:143]
ds_read_b128 a[128:131], v5 offset:17408
v_fmac_f32 v206, v50, v88
v_mfma_f32_16x16x32_bf16 v[140:143], a[100:103], a[36:39], v[140:143]
buffer_load_dwordx4 a[0:3], v2, s[40:43], s35 offen offset:0 sc1
s_xor_b32 s90, s91, s79
v_mfma_f32_16x16x32_bf16 v[164:167], a[100:103], a[44:47], v[164:167]
ds_read_b128 a[132:135], v5 offset:23552
v_fmac_f32 v210, v54, v88
v_mfma_f32_16x16x32_bf16 v[164:167], a[96:99], a[40:43], v[164:167]
v_fmac_f32 v203, v71, v86
v_fmac_f32 v179, v71, v84
v_mfma_f32_16x16x32_bf16 v[188:191], a[96:99], a[48:51], v[188:191]
buffer_load_dwordx4 a[4:7], v2, s[40:43], s33 offen offset:0 sc1
s_lshl_b32 s97, s81, 7
v_mfma_f32_16x16x32_bf16 v[188:191], a[100:103], a[52:55], v[188:191]
ds_read_b128 a[136:139], v5 offset:26624
v_fmac_f32 v186, v54, v86
v_mfma_f32_16x16x32_bf16 v[212:215], a[100:103], a[60:63], v[212:215]
v_fmac_f32 v162, v54, v84
v_fmac_f32 v155, v71, v82
v_mfma_f32_16x16x32_bf16 v[212:215], a[96:99], a[56:59], v[212:215]
buffer_load_dwordx4 a[8:11], v2, s[40:43], s35 offen offset:1024 sc1
s_add_u32 s97, s97, s79
v_mfma_f32_16x16x32_bf16 v[216:219], a[104:107], a[56:59], v[216:219]
ds_read_b128 a[140:143], v5 offset:32768
v_fmac_f32 v138, v54, v82
v_mfma_f32_16x16x32_bf16 v[216:219], a[108:111], a[60:63], v[216:219]
v_fmac_f32 v135, v51, v82
v_fmac_f32 v159, v51, v84
v_mfma_f32_16x16x32_bf16 v[192:195], a[108:111], a[52:55], v[192:195]
buffer_load_dwordx4 a[12:15], v2, s[40:43], s33 offen offset:1024 sc1
s_add_u32 s97, s97, s100
v_mfma_f32_16x16x32_bf16 v[192:195], a[104:107], a[48:51], v[192:195]
ds_read_b128 a[144:147], v5 offset:27648
v_fmac_f32 v183, v51, v86
v_mfma_f32_16x16x32_bf16 v[168:171], a[104:107], a[40:43], v[168:171]
v_fmac_f32 v207, v51, v88
s_lshr_b32 s37, s30, 2
v_mfma_f32_16x16x32_bf16 v[168:171], a[108:111], a[44:47], v[168:171]
buffer_load_dwordx4 a[16:19], v2, s[40:43], s35 offen offset:2048 sc1
s_xor_b32 s37, s37, s51
v_mfma_f32_16x16x32_bf16 v[144:147], a[108:111], a[36:39], v[144:147]
ds_read_b128 a[148:151], v5 offset:33792
v_fmac_f32 v211, v55, v88
v_mfma_f32_16x16x32_bf16 v[144:147], a[104:107], a[32:35], v[144:147]
v_mul_f32 v88, 0x3fb8aa3b, v89
s_and_b32 s37, s37, 1
v_mfma_f32_16x16x32_bf16 v[148:151], a[112:115], a[32:35], v[148:151]
buffer_load_dwordx4 a[20:23], v2, s[40:43], s33 offen offset:2048 sc1
s_lshr_b32 s89, s29, 2
v_mfma_f32_16x16x32_bf16 v[148:151], a[116:119], a[36:39], v[148:151]
v_fmac_f32 v187, v55, v86
s_xor_b32 s89, s89, s37
v_mfma_f32_16x16x32_bf16 v[172:175], a[116:119], a[44:47], v[172:175]
v_fmac_f32 v163, v55, v84
v_mul_f32 v86, 0x3fb8aa3b, v87
v_mfma_f32_16x16x32_bf16 v[172:175], a[112:115], a[40:43], v[172:175]
buffer_load_dwordx4 a[24:27], v2, s[40:43], s35 offen offset:3072 sc1
s_lshl_b32 s88, s28, 6
v_mfma_f32_16x16x32_bf16 v[196:199], a[112:115], a[48:51], v[196:199]
v_fmac_f32 v139, v55, v82
v_mul_f32 v84, 0x3fb8aa3b, v85
v_mfma_f32_16x16x32_bf16 v[196:199], a[116:119], a[52:55], v[196:199]
v_mul_f32 v82, 0x3fb8aa3b, v83
s_add_u32 s94, s80, s88
v_mfma_f32_16x16x32_bf16 v[220:223], a[116:119], a[60:63], v[220:223]
buffer_load_dwordx4 a[28:31], v2, s[40:43], s33 offen offset:3072 sc1
s_add_u32 s35, s35, 0x64000
v_mfma_f32_16x16x32_bf16 v[220:223], a[112:115], a[56:59], v[220:223]
s_add_u32 s33, s33, 0x64000
s_waitcnt lgkmcnt(0)
v_mfma_f32_16x16x32_bf16 v[224:227], a[128:131], a[56:59], v[224:227]
ds_read_b128 a[96:99], v5 offset:28672
s_add_u32 s94, s94, 0x90000
v_mfma_f32_16x16x32_bf16 v[224:227], a[132:135], a[60:63], v[224:227]
buffer_load_dwordx4 v1, s[4:7], s44 offen offset:2048 sc1 lds
s_mul_i32 s89, s89, 0x102000
v_mfma_f32_16x16x32_bf16 v[200:203], a[132:135], a[52:55], v[200:203]
ds_read_b128 a[100:103], v5 offset:34816
s_add_u32 s88, s88, s70
v_mfma_f32_16x16x32_bf16 v[200:203], a[128:131], a[48:51], v[200:203]
s_add_u32 s88, s88, s89
s_add_u32 s89, s88, 0x90000
s_add_u32 s74, s71, 0x30080
v_mfma_f32_16x16x32_bf16 v[176:179], a[128:131], a[40:43], v[176:179]
v_add_u32 v233, s19, v232
s_add_u32 s72, s76, 0xc00000
v_mfma_f32_16x16x32_bf16 v[176:179], a[132:135], a[44:47], v[176:179]
ds_read_b128 a[104:107], v5 offset:29696
s_add_u32 s73, s75, 0x800000
v_mfma_f32_16x16x32_bf16 v[152:155], a[132:135], a[36:39], v[152:155]
s_lshr_b32 s38, s28, 1
s_and_b32 s39, s28, 1
s_mul_i32 s38, s38, 3072
v_mfma_f32_16x16x32_bf16 v[152:155], a[128:131], a[32:35], v[152:155]
s_lshl_b32 s39, s39, 3
s_add_u32 s38, s38, s39
s_waitcnt vmcnt(18)
v_mfma_f32_16x16x32_bf16 v[140:143], a[136:139], a[64:67], v[140:143]
ds_read_b128 a[108:111], v5 offset:35840
v_and_b32 v248, 4, v0
s_waitcnt vmcnt(17)
v_mfma_f32_16x16x32_bf16 v[140:143], a[140:143], a[68:71], v[140:143]
v_lshlrev_b32 v248, 11, v248
v_bfe_u32 v235, v0, 2, 1
s_waitcnt vmcnt(15)
v_mfma_f32_16x16x32_bf16 v[164:167], a[140:143], a[76:79], v[164:167]
ds_read_b128 a[112:115], v5 offset:38912
v_xor_b32 v248, s90, v248
v_mfma_f32_16x16x32_bf16 v[164:167], a[136:139], a[72:75], v[164:167]
v_and_b32 v249, 3, v0
v_xor_b32 v235, s37, v235
s_waitcnt vmcnt(14)
v_mfma_f32_16x16x32_bf16 v[188:191], a[136:139], a[80:83], v[188:191]
v_lshl_add_u32 v248, v249, 7, v248
v_mul_u32_u24 v235, 4128, v235
s_waitcnt vmcnt(13)
v_mfma_f32_16x16x32_bf16 v[188:191], a[140:143], a[84:87], v[188:191]
buffer_load_dwordx4 v1, s[4:7], s44 offen offset:3072 sc1 lds
s_add_u32 m0, s19, 65536
s_waitcnt vmcnt(11)
v_mfma_f32_16x16x32_bf16 v[212:215], a[140:143], a[92:95], v[212:215]
s_xor_b32 s44, s85, 32768
ds_read_b128 a[116:119], v5 offset:45056
v_mfma_f32_16x16x32_bf16 v[212:215], a[136:139], a[88:91], v[212:215]
v_lshrrev_b32 v249, 4, v0
v_add_lshl_u32 v235, v235, v0, 8
v_mfma_f32_16x16x32_bf16 v[216:219], a[144:147], a[88:91], v[216:219]
v_lshl_add_u32 v248, v249, 4, v248
v_add_u32 v234, s36, v8
v_mfma_f32_16x16x32_bf16 v[216:219], a[148:151], a[92:95], v[216:219]
v_cndmask_b32 v235, 2.0, v235, s[64:65]
v_mov_b32 v249, 0x3f80
v_mfma_f32_16x16x32_bf16 v[192:195], a[148:151], a[84:87], v[192:195]
v_mov_b32 v250, 1.0
v_add_u32 v252, s38, v1
v_mfma_f32_16x16x32_bf16 v[192:195], a[144:147], a[80:83], v[192:195]
v_mfma_f32_16x16x32_bf16 v[168:171], a[144:147], a[72:75], v[168:171]
v_mfma_f32_16x16x32_bf16 v[168:171], a[148:151], a[76:79], v[168:171]
v_mfma_f32_16x16x32_bf16 v[144:147], a[148:151], a[68:71], v[144:147]
v_mfma_f32_16x16x32_bf16 v[144:147], a[144:147], a[64:67], v[144:147]
s_waitcnt lgkmcnt(0)
v_mfma_f32_16x16x32_bf16 v[148:151], a[96:99], a[64:67], v[148:151]
ds_read_b128 a[128:131], v5 offset:39936
v_mfma_f32_16x16x32_bf16 v[148:151], a[100:103], a[68:71], v[148:151]
buffer_load_dwordx4 v1, s[4:7], s44 offen offset:0 sc1 lds
v_mfma_f32_16x16x32_bf16 v[172:175], a[100:103], a[76:79], v[172:175]
ds_read_b128 a[132:135], v5 offset:46080
v_mfma_f32_16x16x32_bf16 v[172:175], a[96:99], a[72:75], v[172:175]
v_mfma_f32_16x16x32_bf16 v[196:199], a[96:99], a[80:83], v[196:199]
L_stub17:
s_cbranch_execz L_wret5
v_mfma_f32_16x16x32_bf16 v[196:199], a[100:103], a[84:87], v[196:199]
buffer_load_dwordx4 v1, s[4:7], s44 offen offset:1024 sc1 lds
v_mfma_f32_16x16x32_bf16 v[220:223], a[100:103], a[92:95], v[220:223]
ds_read_b128 a[136:139], v5 offset:40960
v_mfma_f32_16x16x32_bf16 v[220:223], a[96:99], a[88:91], v[220:223]
v_mfma_f32_16x16x32_bf16 v[224:227], a[104:107], a[88:91], v[224:227]
ds_read_b128 a[140:143], v5 offset:47104
v_mfma_f32_16x16x32_bf16 v[224:227], a[108:111], a[92:95], v[224:227]
v_mfma_f32_16x16x32_bf16 v[200:203], a[108:111], a[84:87], v[200:203]
buffer_load_dwordx4 v1, s[4:7], s44 offen offset:2048 sc1 lds
v_mfma_f32_16x16x32_bf16 v[200:203], a[104:107], a[80:83], v[200:203]
ds_read_b128 a[144:147], v5 offset:41984
v_mfma_f32_16x16x32_bf16 v[176:179], a[104:107], a[72:75], v[176:179]
v_mfma_f32_16x16x32_bf16 v[176:179], a[108:111], a[76:79], v[176:179]
ds_read_b128 a[148:151], v5 offset:48128
v_mfma_f32_16x16x32_bf16 v[152:155], a[108:111], a[68:71], v[152:155]
v_mfma_f32_16x16x32_bf16 v[152:155], a[104:107], a[64:67], v[152:155]
buffer_load_dwordx4 v1, s[4:7], s44 offen offset:3072 sc1 lds
s_add_u32 m0, s19, 81920
s_waitcnt vmcnt(13)
v_mfma_f32_16x16x32_bf16 v[140:143], a[112:115], a[0:3], v[140:143]
s_xor_b32 s44, s85, 49152
s_waitcnt vmcnt(12)
v_mfma_f32_16x16x32_bf16 v[140:143], a[116:119], a[4:7], v[140:143]
s_waitcnt vmcnt(10)
v_mfma_f32_16x16x32_bf16 v[164:167], a[116:119], a[12:15], v[164:167]
v_mfma_f32_16x16x32_bf16 v[164:167], a[112:115], a[8:11], v[164:167]
s_waitcnt vmcnt(9)
v_mfma_f32_16x16x32_bf16 v[188:191], a[112:115], a[16:19], v[188:191]
buffer_load_dwordx4 v1, s[4:7], s44 offen offset:0 sc1 lds
s_waitcnt vmcnt(9)
v_mfma_f32_16x16x32_bf16 v[188:191], a[116:119], a[20:23], v[188:191]
s_waitcnt vmcnt(7)
v_mfma_f32_16x16x32_bf16 v[212:215], a[116:119], a[28:31], v[212:215]
v_mfma_f32_16x16x32_bf16 v[212:215], a[112:115], a[24:27], v[212:215]
s_waitcnt lgkmcnt(0)
v_mfma_f32_16x16x32_bf16 v[216:219], a[128:131], a[24:27], v[216:219]
ds_read_b128 a[96:99], v5 offset:12288
v_cvt_pk_bf16_f32 v140, v140, v141
v_mfma_f32_16x16x32_bf16 v[216:219], a[132:135], a[28:31], v[216:219]
buffer_load_dwordx4 v1, s[4:7], s44 offen offset:1024 sc1 lds
v_mfma_f32_16x16x32_bf16 v[192:195], a[132:135], a[20:23], v[192:195]
ds_read_b128 a[100:103], v5 offset:18432
v_cvt_pk_bf16_f32 v141, v142, v143
v_mfma_f32_16x16x32_bf16 v[192:195], a[128:131], a[16:19], v[192:195]
v_cvt_pk_bf16_f32 v164, v164, v165
v_cvt_pk_bf16_f32 v165, v166, v167
v_mfma_f32_16x16x32_bf16 v[168:171], a[128:131], a[8:11], v[168:171]
v_cvt_pk_bf16_f32 v188, v188, v189
v_cvt_pk_bf16_f32 v189, v190, v191
v_mfma_f32_16x16x32_bf16 v[168:171], a[132:135], a[12:15], v[168:171]
buffer_load_dwordx4 v1, s[4:7], s44 offen offset:2048 sc1 lds
v_mfma_f32_16x16x32_bf16 v[144:147], a[132:135], a[4:7], v[144:147]
ds_read_b128 a[104:107], v5 offset:24576
v_cvt_pk_bf16_f32 v212, v212, v213
v_mfma_f32_16x16x32_bf16 v[144:147], a[128:131], a[0:3], v[144:147]
v_cvt_pk_bf16_f32 v213, v214, v215
v_mfma_f32_16x16x32_bf16 v[148:151], a[136:139], a[0:3], v[148:151]
ds_read_b128 a[108:111], v5 offset:30720
v_cvt_pk_bf16_f32 v214, v216, v217
v_mfma_f32_16x16x32_bf16 v[148:151], a[140:143], a[4:7], v[148:151]
v_cvt_pk_bf16_f32 v215, v218, v219
v_mfma_f32_16x16x32_bf16 v[172:175], a[140:143], a[12:15], v[172:175]
buffer_load_dwordx4 v1, s[4:7], s44 offen offset:3072 sc1 lds
s_add_u32 m0, s19, 147456
v_mfma_f32_16x16x32_bf16 v[172:175], a[136:139], a[8:11], v[172:175]
s_xor_b32 s44, s85, 114688
ds_read_b128 a[112:115], v5 offset:36864
v_mfma_f32_16x16x32_bf16 v[196:199], a[136:139], a[16:19], v[196:199]
v_cvt_pk_bf16_f32 v166, v168, v169
v_cvt_pk_bf16_f32 v167, v170, v171
v_mfma_f32_16x16x32_bf16 v[196:199], a[140:143], a[20:23], v[196:199]
ds_read_b128 a[116:119], v5 offset:43008
v_cvt_pk_bf16_f32 v190, v192, v193
v_mfma_f32_16x16x32_bf16 v[220:223], a[140:143], a[28:31], v[220:223]
v_cvt_pk_bf16_f32 v142, v144, v145
v_cvt_pk_bf16_f32 v143, v146, v147
v_mfma_f32_16x16x32_bf16 v[220:223], a[136:139], a[24:27], v[220:223]
buffer_load_dwordx4 v1, s[4:7], s44 offen offset:0 sc1 lds
v_mfma_f32_16x16x32_bf16 v[224:227], a[144:147], a[24:27], v[224:227]
v_mfma_f32_16x16x32_bf16 v[92:95], a[240:243], v[140:143], 0
v_mfma_f32_16x16x32_bf16 v[224:227], a[148:151], a[28:31], v[224:227]
v_mfma_f32_16x16x32_bf16 v[96:99], a[244:247], v[140:143], 0
v_mfma_f32_16x16x32_bf16 v[200:203], a[148:151], a[20:23], v[200:203]
v_mfma_f32_16x16x32_bf16 v[100:103], a[240:243], v[164:167], 0
v_mfma_f32_16x16x32_bf16 v[200:203], a[144:147], a[16:19], v[200:203]
v_mfma_f32_16x16x32_bf16 v[104:107], a[244:247], v[164:167], 0
v_mfma_f32_16x16x32_bf16 v[176:179], a[144:147], a[8:11], v[176:179]
buffer_load_dwordx4 v1, s[4:7], s44 offen offset:1024 sc1 lds
v_mfma_f32_16x16x32_bf16 v[176:179], a[148:151], a[12:15], v[176:179]
v_max3_f32 v236, v92, v93, v94
v_max3_f32 v237, -v92, -v93, -v94
v_mfma_f32_16x16x32_bf16 v[152:155], a[148:151], a[4:7], v[152:155]
v_max3_f32 v236, v236, v95, v96
v_max3_f32 v237, v237, -v95, -v96
v_mfma_f32_16x16x32_bf16 v[152:155], a[144:147], a[0:3], v[152:155]
v_max3_f32 v236, v236, v97, v98
s_waitcnt lgkmcnt(0)
v_mfma_f32_16x16x32_bf16 v[132:135], a[96:99], a[32:35], v[132:135]
ds_read_b128 a[128:131], v5 offset:13312
v_max3_f32 v237, v237, -v97, -v98
v_mfma_f32_16x16x32_bf16 v[132:135], a[100:103], a[36:39], v[132:135]
buffer_load_dwordx4 v1, s[4:7], s44 offen offset:2048 sc1 lds
v_mfma_f32_16x16x32_bf16 v[156:159], a[100:103], a[44:47], v[156:159]
ds_read_b128 a[132:135], v5 offset:19456
v_max_f32 v236, v236, v99
v_mfma_f32_16x16x32_bf16 v[156:159], a[96:99], a[40:43], v[156:159]
v_max_f32_e64 v237, v237, -v99
v_max3_f32 v238, v100, v101, v102
v_mfma_f32_16x16x32_bf16 v[180:183], a[96:99], a[48:51], v[180:183]
v_permlane32_swap_b32 v236, v237
v_mfma_f32_16x16x32_bf16 v[180:183], a[100:103], a[52:55], v[180:183]
buffer_load_dwordx4 v1, s[4:7], s44 offen offset:3072 sc1 lds
s_add_u32 m0, s19, 98304
v_mfma_f32_16x16x32_bf16 v[204:207], a[100:103], a[60:63], v[204:207]
s_xor_b32 s44, s85, 65536
ds_read_b128 a[136:139], v5 offset:25600
v_mfma_f32_16x16x32_bf16 v[204:207], a[96:99], a[56:59], v[204:207]
v_max_f32 v236, v236, v237
v_mov_b32 v244, v236
v_mfma_f32_16x16x32_bf16 v[204:207], a[104:107], a[88:91], v[204:207]
ds_read_b128 a[140:143], v5 offset:31744
v_max3_f32 v239, -v100, -v101, -v102
v_mfma_f32_16x16x32_bf16 v[204:207], a[108:111], a[92:95], v[204:207]
v_permlane16_swap_b32 v236, v244
v_mfma_f32_16x16x32_bf16 v[180:183], a[108:111], a[84:87], v[180:183]
buffer_load_dwordx4 v1, s[4:7], s44 offen offset:0 sc1 lds
v_mfma_f32_16x16x32_bf16 v[180:183], a[104:107], a[80:83], v[180:183]
ds_read_b128 a[144:147], v5 offset:37888
v_max_f32 v236, v236, v244
v_mfma_f32_16x16x32_bf16 v[156:159], a[104:107], a[72:75], v[156:159]
v_mov_b32 v244, v236
v_max3_f32 v238, v238, v103, v104
v_mfma_f32_16x16x32_bf16 v[156:159], a[108:111], a[76:79], v[156:159]
ds_read_b128 a[148:151], v5 offset:44032
v_max3_f32 v239, v239, -v103, -v104
v_mfma_f32_16x16x32_bf16 v[132:135], a[108:111], a[68:71], v[132:135]
v_permlane32_swap_b32 v236, v244
v_mfma_f32_16x16x32_bf16 v[132:135], a[104:107], a[64:67], v[132:135]
buffer_load_dwordx4 v1, s[4:7], s44 offen offset:1024 sc1 lds
v_mfma_f32_16x16x32_bf16 v[132:135], a[112:115], a[0:3], v[132:135]
v_mul_f32_e64 v236, -v236, v82
v_mul_f32_e64 v237, -v244, v82
v_mfma_f32_16x16x32_bf16 v[132:135], a[116:119], a[4:7], v[132:135]
v_max3_f32 v238, v238, v105, v106
v_max3_f32 v239, v239, -v105, -v106
v_mfma_f32_16x16x32_bf16 v[156:159], a[116:119], a[12:15], v[156:159]
v_max_f32 v238, v238, v107
v_max_f32_e64 v239, v239, -v107
v_mfma_f32_16x16x32_bf16 v[156:159], a[112:115], a[8:11], v[156:159]
s_nop 0
v_permlane32_swap_b32 v238, v239
v_mfma_f32_16x16x32_bf16 v[180:183], a[112:115], a[16:19], v[180:183]
buffer_load_dwordx4 v1, s[4:7], s44 offen offset:2048 sc1 lds
v_mfma_f32_16x16x32_bf16 v[180:183], a[116:119], a[20:23], v[180:183]
v_max_f32 v238, v238, v239
v_mov_b32 v245, v238
v_mfma_f32_16x16x32_bf16 v[204:207], a[116:119], a[28:31], v[204:207]
s_nop 0
v_permlane16_swap_b32 v238, v245
v_mfma_f32_16x16x32_bf16 v[204:207], a[112:115], a[24:27], v[204:207]
s_waitcnt lgkmcnt(0)
s_barrier
v_mfma_f32_16x16x32_bf16 v[208:211], a[128:131], a[56:59], v[208:211]
v_max_f32 v238, v238, v245
v_mov_b32 v245, v238
v_mfma_f32_16x16x32_bf16 v[208:211], a[132:135], a[60:63], v[208:211]
buffer_load_dwordx4 v1, s[4:7], s44 offen offset:3072 sc1 lds
s_add_u32 m0, s19, 114688
v_mfma_f32_16x16x32_bf16 v[184:187], a[132:135], a[52:55], v[184:187]
s_xor_b32 s44, s85, 81920
v_cvt_pk_bf16_f32 v191, v194, v195
v_mfma_f32_16x16x32_bf16 v[184:187], a[128:131], a[48:51], v[184:187]
v_permlane32_swap_b32 v238, v245
v_mfma_f32_16x16x32_bf16 v[160:163], a[128:131], a[40:43], v[160:163]
v_mul_f32_e64 v238, -v238, v84
v_mul_f32_e64 v239, -v245, v84
v_mfma_f32_16x16x32_bf16 v[160:163], a[132:135], a[44:47], v[160:163]
buffer_load_dwordx4 v1, s[4:7], s44 offen offset:0 sc1 lds
v_mfma_f32_16x16x32_bf16 v[136:139], a[132:135], a[36:39], v[136:139]
v_mfma_f32_16x16x32_bf16 v[108:111], a[240:243], v[188:191], 0
v_mfma_f32_16x16x32_bf16 v[136:139], a[128:131], a[32:35], v[136:139]
v_mfma_f32_16x16x32_bf16 v[112:115], a[244:247], v[188:191], 0
v_mfma_f32_16x16x32_bf16 v[136:139], a[136:139], a[64:67], v[136:139]
v_mfma_f32_16x16x32_bf16 v[116:119], a[240:243], v[212:215], 0
v_mfma_f32_16x16x32_bf16 v[136:139], a[140:143], a[68:71], v[136:139]
v_mfma_f32_16x16x32_bf16 v[120:123], a[244:247], v[212:215], 0
v_mfma_f32_16x16x32_bf16 v[160:163], a[140:143], a[76:79], v[160:163]
buffer_load_dwordx4 v1, s[4:7], s44 offen offset:1024 sc1 lds
v_mfma_f32_16x16x32_bf16 v[160:163], a[136:139], a[72:75], v[160:163]
v_max3_f32 v240, v108, v109, v110
v_max3_f32 v241, -v108, -v109, -v110
v_mfma_f32_16x16x32_bf16 v[184:187], a[136:139], a[80:83], v[184:187]
v_max3_f32 v240, v240, v111, v112
v_max3_f32 v241, v241, -v111, -v112
v_mfma_f32_16x16x32_bf16 v[184:187], a[140:143], a[84:87], v[184:187]
v_max3_f32 v240, v240, v113, v114
v_max3_f32 v241, v241, -v113, -v114
v_mfma_f32_16x16x32_bf16 v[208:211], a[140:143], a[92:95], v[208:211]
v_max_f32 v240, v240, v115
v_max_f32_e64 v241, v241, -v115
v_mfma_f32_16x16x32_bf16 v[208:211], a[136:139], a[88:91], v[208:211]
buffer_load_dwordx4 v1, s[4:7], s44 offen offset:2048 sc1 lds
v_mfma_f32_16x16x32_bf16 v[208:211], a[144:147], a[24:27], v[208:211]
v_permlane32_swap_b32 v240, v241
v_mfma_f32_16x16x32_bf16 v[208:211], a[148:151], a[28:31], v[208:211]
v_max_f32 v240, v240, v241
v_mov_b32 v246, v240
v_mfma_f32_16x16x32_bf16 v[184:187], a[148:151], a[20:23], v[184:187]
s_nop 0
v_permlane16_swap_b32 v240, v246
v_mfma_f32_16x16x32_bf16 v[184:187], a[144:147], a[16:19], v[184:187]
v_max_f32 v240, v240, v246
v_mov_b32 v246, v240
v_mfma_f32_16x16x32_bf16 v[160:163], a[144:147], a[8:11], v[160:163]
buffer_load_dwordx4 v1, s[4:7], s44 offen offset:3072 sc1 lds
v_mfma_f32_16x16x32_bf16 v[160:163], a[148:151], a[12:15], v[160:163]
v_permlane32_swap_b32 v240, v246
v_mfma_f32_16x16x32_bf16 v[136:139], a[148:151], a[4:7], v[136:139]
v_mul_f32_e64 v240, -v240, v86
v_mul_f32_e64 v241, -v246, v86
v_mfma_f32_16x16x32_bf16 v[136:139], a[144:147], a[0:3], v[136:139]
v_max3_f32 v242, v116, v117, v118
v_max3_f32 v243, -v116, -v117, -v118
v_pk_mul_f32 v[148:149], v[148:149], v[82:83] op_sel:[0,1] op_sel_hi:[1,1]
v_pk_mul_f32 v[150:151], v[150:151], v[82:83] op_sel:[0,1] op_sel_hi:[1,1]
v_cvt_pk_bf16_f32 v148, v148, v149
v_cvt_pk_bf16_f32 v149, v150, v151
ds_write_b64 v232, v[148:149] offset:0
v_pk_mul_f32 v[152:153], v[152:153], v[82:83] op_sel:[0,1] op_sel_hi:[1,1]
v_pk_mul_f32 v[154:155], v[154:155], v[82:83] op_sel:[0,1] op_sel_hi:[1,1]
v_cvt_pk_bf16_f32 v150, v152, v153
v_cvt_pk_bf16_f32 v151, v154, v155
v_pk_mul_f32 v[172:173], v[172:173], v[84:85] op_sel:[0,1] op_sel_hi:[1,1]
v_pk_mul_f32 v[174:175], v[174:175], v[84:85] op_sel:[0,1] op_sel_hi:[1,1]
v_cvt_pk_bf16_f32 v172, v172, v173
v_cvt_pk_bf16_f32 v173, v174, v175
v_pk_mul_f32 v[176:177], v[176:177], v[84:85] op_sel:[0,1] op_sel_hi:[1,1]
v_pk_mul_f32 v[178:179], v[178:179], v[84:85] op_sel:[0,1] op_sel_hi:[1,1]
v_cvt_pk_bf16_f32 v174, v176, v177
v_cvt_pk_bf16_f32 v175, v178, v179
ds_write_b64 v232, v[150:151] offset:512
v_pk_mul_f32 v[196:197], v[196:197], v[86:87] op_sel:[0,1] op_sel_hi:[1,1]
v_pk_mul_f32 v[198:199], v[198:199], v[86:87] op_sel:[0,1] op_sel_hi:[1,1]
v_cvt_pk_bf16_f32 v196, v196, v197
v_cvt_pk_bf16_f32 v197, v198, v199
buffer_store_dwordx4 a[248:251], v254, s[4:7], s97 offen offset:0 sc1
v_pk_mul_f32 v[200:201], v[200:201], v[86:87] op_sel:[0,1] op_sel_hi:[1,1]
v_pk_mul_f32 v[202:203], v[202:203], v[86:87] op_sel:[0,1] op_sel_hi:[1,1]
v_cvt_pk_bf16_f32 v198, v200, v201
v_cvt_pk_bf16_f32 v199, v202, v203
ds_write_b64 v232, v[172:173] offset:1024
v_pk_mul_f32 v[220:221], v[220:221], v[88:89] op_sel:[0,1] op_sel_hi:[1,1]
v_pk_mul_f32 v[222:223], v[222:223], v[88:89] op_sel:[0,1] op_sel_hi:[1,1]
v_cvt_pk_bf16_f32 v220, v220, v221
v_cvt_pk_bf16_f32 v221, v222, v223
v_pk_fma_f32 v[48:49], v[92:93], v[82:83], v[236:237] op_sel:[0,0,0] op_sel_hi:[1,0,0]
v_pk_fma_f32 v[50:51], v[94:95], v[82:83], v[236:237] op_sel:[0,0,0] op_sel_hi:[1,0,0]
v_pk_fma_f32 v[52:53], v[96:97], v[82:83], v[236:237] op_sel:[0,0,0] op_sel_hi:[1,0,0]
v_pk_fma_f32 v[54:55], v[98:99], v[82:83], v[236:237] op_sel:[0,0,0] op_sel_hi:[1,0,0]
v_exp_f32 v48, v48
v_exp_f32 v49, v49
ds_write_b64 v232, v[174:175] offset:1536
v_exp_f32 v50, v50
v_exp_f32 v51, v51
v_exp_f32 v52, v52
v_exp_f32 v53, v53
v_exp_f32 v54, v54
v_exp_f32 v55, v55
ds_write_b64 v232, v[196:197] offset:2048
buffer_store_dwordx4 a[248:251], v1, s[4:7], s96 offen offset:0 sc1
v_cvt_pk_bf16_f32 v140, v48, v49
v_cvt_pk_bf16_f32 v141, v50, v51
v_cvt_pk_bf16_f32 v142, v52, v53
v_cvt_pk_bf16_f32 v143, v54, v55
v_pk_mul_f32 v[224:225], v[224:225], v[88:89] op_sel:[0,1] op_sel_hi:[1,1]
v_pk_mul_f32 v[226:227], v[226:227], v[88:89] op_sel:[0,1] op_sel_hi:[1,1]
v_cvt_pk_bf16_f32 v222, v224, v225
v_mfma_f32_16x16x32_bf16 v[148:151], v[16:19], v[140:143], 0
ds_write_b64 v232, v[198:199] offset:2560
v_cvt_pk_bf16_f32 v223, v226, v227
s_add_u32 m0, s19, 131072
v_pk_fma_f32 v[92:93], v[92:93], v[82:83], v[236:237] op_sel:[0,0,1] op_sel_hi:[1,0,1] neg_lo:[1,0,0] neg_hi:[1,0,0]
v_pk_fma_f32 v[94:95], v[94:95], v[82:83], v[236:237] op_sel:[0,0,1] op_sel_hi:[1,0,1] neg_lo:[1,0,0] neg_hi:[1,0,0]
v_pk_fma_f32 v[96:97], v[96:97], v[82:83], v[236:237] op_sel:[0,0,1] op_sel_hi:[1,0,1] neg_lo:[1,0,0] neg_hi:[1,0,0]
s_nop 1
v_rcp_f32 v148, v148
v_pk_fma_f32 v[98:99], v[98:99], v[82:83], v[236:237] op_sel:[0,0,1] op_sel_hi:[1,0,1] neg_lo:[1,0,0] neg_hi:[1,0,0]
v_pk_mul_f32 v[48:49], v[48:49], v[148:149] op_sel:[0,0] op_sel_hi:[1,0]
v_pk_mul_f32 v[50:51], v[50:51], v[148:149] op_sel:[0,0] op_sel_hi:[1,0]
v_cvt_pk_bf16_f32 v140, v48, v49
v_cvt_pk_bf16_f32 v141, v50, v51
ds_write_b64 v232, v[220:221] offset:3072
v_exp_f32 v92, v92
v_exp_f32 v93, v93
v_exp_f32 v94, v94
v_exp_f32 v95, v95
v_exp_f32 v96, v96
v_exp_f32 v97, v97
ds_write_b64 v232, v[222:223] offset:3584
v_exp_f32 v98, v98
v_exp_f32 v99, v99
s_xor_b32 s44, s85, 98304
v_cvt_pk_bf16_f32 v144, v92, v93
v_cvt_pk_bf16_f32 v145, v94, v95
v_cvt_pk_bf16_f32 v146, v96, v97
v_cvt_pk_bf16_f32 v147, v98, v99
buffer_load_dwordx4 v1, s[4:7], s44 offen offset:0 sc1 lds
v_pk_mul_f32 v[52:53], v[52:53], v[148:149] op_sel:[0,0] op_sel_hi:[1,0]
ds_write_b64 v233, v[140:141] offset:16384
v_pk_mul_f32 v[54:55], v[54:55], v[148:149] op_sel:[0,0] op_sel_hi:[1,0]
v_cvt_pk_bf16_f32 v142, v52, v53
v_mfma_f32_16x16x32_bf16 v[152:155], v[16:19], v[144:147], 0
v_cvt_pk_bf16_f32 v143, v54, v55
v_max3_f32 v242, v242, v119, v120
v_max3_f32 v243, v243, -v119, -v120
v_max3_f32 v242, v242, v121, v122
v_max3_f32 v243, v243, -v121, -v122
v_pk_fma_f32 v[56:57], v[100:101], v[84:85], v[238:239] op_sel:[0,0,0] op_sel_hi:[1,0,0]
v_pk_fma_f32 v[58:59], v[102:103], v[84:85], v[238:239] op_sel:[0,0,0] op_sel_hi:[1,0,0]
v_pk_fma_f32 v[60:61], v[104:105], v[84:85], v[238:239] op_sel:[0,0,0] op_sel_hi:[1,0,0]
ds_write_b64 v233, v[142:143] offset:16896
v_rcp_f32 v152, v152
v_pk_fma_f32 v[62:63], v[106:107], v[84:85], v[238:239] op_sel:[0,0,0] op_sel_hi:[1,0,0]
v_pk_mul_f32 v[92:93], v[92:93], v[152:153] op_sel:[0,0] op_sel_hi:[1,0]
v_pk_mul_f32 v[94:95], v[94:95], v[152:153] op_sel:[0,0] op_sel_hi:[1,0]
v_cvt_pk_bf16_f32 v144, v92, v93
v_cvt_pk_bf16_f32 v145, v94, v95
v_exp_f32 v56, v56
v_exp_f32 v57, v57
v_exp_f32 v58, v58
ds_write_b64 v233, v[144:145] offset:17408
v_exp_f32 v59, v59
v_exp_f32 v60, v60
v_exp_f32 v61, v61
v_exp_f32 v62, v62
v_exp_f32 v63, v63
buffer_load_dwordx4 v1, s[4:7], s44 offen offset:1024 sc1 lds
v_cvt_pk_bf16_f32 v164, v56, v57
v_cvt_pk_bf16_f32 v165, v58, v59
v_cvt_pk_bf16_f32 v166, v60, v61
v_cvt_pk_bf16_f32 v167, v62, v63
v_pk_mul_f32 v[96:97], v[96:97], v[152:153] op_sel:[0,0] op_sel_hi:[1,0]
v_pk_mul_f32 v[98:99], v[98:99], v[152:153] op_sel:[0,0] op_sel_hi:[1,0]
v_cvt_pk_bf16_f32 v146, v96, v97
v_mfma_f32_16x16x32_bf16 v[172:175], v[16:19], v[164:167], 0
v_cvt_pk_bf16_f32 v147, v98, v99
ds_write_b64 v233, v[146:147] offset:17920
v_max_f32 v242, v242, v123
v_pk_fma_f32 v[100:101], v[100:101], v[84:85], v[238:239] op_sel:[0,0,1] op_sel_hi:[1,0,1] neg_lo:[1,0,0] neg_hi:[1,0,0]
v_pk_fma_f32 v[102:103], v[102:103], v[84:85], v[238:239] op_sel:[0,0,1] op_sel_hi:[1,0,1] neg_lo:[1,0,0] neg_hi:[1,0,0]
v_pk_fma_f32 v[104:105], v[104:105], v[84:85], v[238:239] op_sel:[0,0,1] op_sel_hi:[1,0,1] neg_lo:[1,0,0] neg_hi:[1,0,0]
s_nop 1
v_rcp_f32 v172, v172
v_pk_fma_f32 v[106:107], v[106:107], v[84:85], v[238:239] op_sel:[0,0,1] op_sel_hi:[1,0,1] neg_lo:[1,0,0] neg_hi:[1,0,0]
v_pk_mul_f32 v[56:57], v[56:57], v[172:173] op_sel:[0,0] op_sel_hi:[1,0]
v_pk_mul_f32 v[58:59], v[58:59], v[172:173] op_sel:[0,0] op_sel_hi:[1,0]
v_cvt_pk_bf16_f32 v164, v56, v57
v_cvt_pk_bf16_f32 v165, v58, v59
v_exp_f32 v100, v100
ds_write_b64 v233, v[164:165] offset:18432
v_exp_f32 v101, v101
v_exp_f32 v102, v102
v_exp_f32 v103, v103
v_exp_f32 v104, v104
v_exp_f32 v105, v105
v_exp_f32 v106, v106
v_exp_f32 v107, v107
buffer_load_dwordx4 v1, s[4:7], s44 offen offset:2048 sc1 lds
v_cvt_pk_bf16_f32 v168, v100, v101
v_cvt_pk_bf16_f32 v169, v102, v103
v_cvt_pk_bf16_f32 v170, v104, v105
v_cvt_pk_bf16_f32 v171, v106, v107
v_pk_mul_f32 v[60:61], v[60:61], v[172:173] op_sel:[0,0] op_sel_hi:[1,0]
v_pk_mul_f32 v[62:63], v[62:63], v[172:173] op_sel:[0,0] op_sel_hi:[1,0]
v_cvt_pk_bf16_f32 v166, v60, v61
v_mfma_f32_16x16x32_bf16 v[176:179], v[16:19], v[168:171], 0
v_cvt_pk_bf16_f32 v167, v62, v63
ds_write_b64 v233, v[166:167] offset:18944
v_max_f32_e64 v243, v243, -v123
v_pk_fma_f32 v[64:65], v[108:109], v[86:87], v[240:241] op_sel:[0,0,0] op_sel_hi:[1,0,0]
v_pk_fma_f32 v[66:67], v[110:111], v[86:87], v[240:241] op_sel:[0,0,0] op_sel_hi:[1,0,0]
v_pk_fma_f32 v[68:69], v[112:113], v[86:87], v[240:241] op_sel:[0,0,0] op_sel_hi:[1,0,0]
s_nop 1
v_rcp_f32 v176, v176
v_pk_fma_f32 v[70:71], v[114:115], v[86:87], v[240:241] op_sel:[0,0,0] op_sel_hi:[1,0,0]
v_pk_mul_f32 v[100:101], v[100:101], v[176:177] op_sel:[0,0] op_sel_hi:[1,0]
v_pk_mul_f32 v[102:103], v[102:103], v[176:177] op_sel:[0,0] op_sel_hi:[1,0]
v_cvt_pk_bf16_f32 v168, v100, v101
v_cvt_pk_bf16_f32 v169, v102, v103
v_exp_f32 v64, v64
ds_write_b64 v233, v[168:169] offset:19456
buffer_load_dwordx4 v1, s[4:7], s44 offen offset:3072 sc1 lds
v_exp_f32 v65, v65
v_exp_f32 v66, v66
v_exp_f32 v67, v67
v_exp_f32 v68, v68
v_exp_f32 v69, v69
v_exp_f32 v70, v70
v_exp_f32 v71, v71
v_cvt_pk_bf16_f32 v188, v64, v65
v_cvt_pk_bf16_f32 v189, v66, v67
v_cvt_pk_bf16_f32 v190, v68, v69
v_cvt_pk_bf16_f32 v191, v70, v71
v_pk_mul_f32 v[104:105], v[104:105], v[176:177] op_sel:[0,0] op_sel_hi:[1,0]
v_pk_mul_f32 v[106:107], v[106:107], v[176:177] op_sel:[0,0] op_sel_hi:[1,0]
v_cvt_pk_bf16_f32 v170, v104, v105
v_mfma_f32_16x16x32_bf16 v[196:199], v[16:19], v[188:191], 0
v_cvt_pk_bf16_f32 v171, v106, v107
ds_write_b64 v233, v[170:171] offset:19968
buffer_store_dwordx4 a[248:251], v2, s[4:7], s72 offen offset:0 sc1
s_nop 4
v_rcp_f32 v196, v196
v_pk_fma_f32 v[108:109], v[108:109], v[86:87], v[240:241] op_sel:[0,0,1] op_sel_hi:[1,0,1] neg_lo:[1,0,0] neg_hi:[1,0,0]
v_pk_mul_f32 v[64:65], v[64:65], v[196:197] op_sel:[0,0] op_sel_hi:[1,0]
v_pk_mul_f32 v[66:67], v[66:67], v[196:197] op_sel:[0,0] op_sel_hi:[1,0]
v_cvt_pk_bf16_f32 v188, v64, v65
v_cvt_pk_bf16_f32 v189, v66, v67
v_pk_fma_f32 v[110:111], v[110:111], v[86:87], v[240:241] op_sel:[0,0,1] op_sel_hi:[1,0,1] neg_lo:[1,0,0] neg_hi:[1,0,0]
ds_write_b64 v233, v[188:189] offset:20480
v_pk_fma_f32 v[112:113], v[112:113], v[86:87], v[240:241] op_sel:[0,0,1] op_sel_hi:[1,0,1] neg_lo:[1,0,0] neg_hi:[1,0,0]
v_pk_fma_f32 v[114:115], v[114:115], v[86:87], v[240:241] op_sel:[0,0,1] op_sel_hi:[1,0,1] neg_lo:[1,0,0] neg_hi:[1,0,0]
v_exp_f32 v108, v108
v_exp_f32 v109, v109
v_exp_f32 v110, v110
v_exp_f32 v111, v111
v_exp_f32 v112, v112
v_exp_f32 v113, v113
v_exp_f32 v114, v114
v_exp_f32 v115, v115
v_cvt_pk_bf16_f32 v192, v108, v109
v_cvt_pk_bf16_f32 v193, v110, v111
v_cvt_pk_bf16_f32 v194, v112, v113
v_cvt_pk_bf16_f32 v195, v114, v115
v_pk_mul_f32 v[68:69], v[68:69], v[196:197] op_sel:[0,0] op_sel_hi:[1,0]
v_pk_mul_f32 v[70:71], v[70:71], v[196:197] op_sel:[0,0] op_sel_hi:[1,0]
v_permlane32_swap_b32 v242, v243
v_mfma_f32_16x16x32_bf16 v[200:203], v[16:19], v[192:195], 0
v_cvt_pk_bf16_f32 v190, v68, v69
v_cvt_pk_bf16_f32 v191, v70, v71
ds_write_b64 v233, v[190:191] offset:20992
v_max_f32 v242, v242, v243
v_mov_b32 v247, v242
buffer_store_dwordx4 a[248:251], v2, s[4:7], s72 offen offset:1024 sc1
s_nop 0
v_permlane16_swap_b32 v242, v247
v_rcp_f32 v200, v200
v_max_f32 v242, v242, v247
v_mov_b32 v247, v242
v_pk_mul_f32 v[108:109], v[108:109], v[200:201] op_sel:[0,0] op_sel_hi:[1,0]
v_pk_mul_f32 v[110:111], v[110:111], v[200:201] op_sel:[0,0] op_sel_hi:[1,0]
v_cvt_pk_bf16_f32 v192, v108, v109
v_cvt_pk_bf16_f32 v193, v110, v111
v_permlane32_swap_b32 v242, v247
ds_write_b64 v233, v[192:193] offset:21504
v_mul_f32_e64 v242, -v242, v88
v_mul_f32_e64 v243, -v247, v88
v_pk_fma_f32 v[124:125], v[116:117], v[88:89], v[242:243] op_sel:[0,0,0] op_sel_hi:[1,0,0]
v_pk_fma_f32 v[126:127], v[118:119], v[88:89], v[242:243] op_sel:[0,0,0] op_sel_hi:[1,0,0]
v_pk_fma_f32 v[128:129], v[120:121], v[88:89], v[242:243] op_sel:[0,0,0] op_sel_hi:[1,0,0]
v_pk_fma_f32 v[130:131], v[122:123], v[88:89], v[242:243] op_sel:[0,0,0] op_sel_hi:[1,0,0]
v_exp_f32 v124, v124
v_exp_f32 v125, v125
v_exp_f32 v126, v126
v_exp_f32 v127, v127
v_exp_f32 v128, v128
v_exp_f32 v129, v129
v_exp_f32 v130, v130
v_exp_f32 v131, v131
v_cvt_pk_bf16_f32 v212, v124, v125
v_cvt_pk_bf16_f32 v213, v126, v127
v_cvt_pk_bf16_f32 v214, v128, v129
v_cvt_pk_bf16_f32 v215, v130, v131
v_pk_mul_f32 v[112:113], v[112:113], v[200:201] op_sel:[0,0] op_sel_hi:[1,0]
v_pk_mul_f32 v[114:115], v[114:115], v[200:201] op_sel:[0,0] op_sel_hi:[1,0]
v_cvt_pk_bf16_f32 v194, v112, v113
v_mfma_f32_16x16x32_bf16 v[220:223], v[16:19], v[212:215], 0
v_cvt_pk_bf16_f32 v195, v114, v115
ds_write_b64 v233, v[194:195] offset:22016
buffer_store_dwordx4 a[248:251], v2, s[4:7], s72 offen offset:2048 sc1
s_nop 4
v_rcp_f32 v220, v220
v_pk_fma_f32 v[116:117], v[116:117], v[88:89], v[242:243] op_sel:[0,0,1] op_sel_hi:[1,0,1] neg_lo:[1,0,0] neg_hi:[1,0,0]
v_pk_mul_f32 v[124:125], v[124:125], v[220:221] op_sel:[0,0] op_sel_hi:[1,0]
v_pk_mul_f32 v[126:127], v[126:127], v[220:221] op_sel:[0,0] op_sel_hi:[1,0]
v_cvt_pk_bf16_f32 v212, v124, v125
v_cvt_pk_bf16_f32 v213, v126, v127
v_pk_fma_f32 v[118:119], v[118:119], v[88:89], v[242:243] op_sel:[0,0,1] op_sel_hi:[1,0,1] neg_lo:[1,0,0] neg_hi:[1,0,0]
ds_write_b64 v233, v[212:213] offset:22528
v_pk_fma_f32 v[120:121], v[120:121], v[88:89], v[242:243] op_sel:[0,0,1] op_sel_hi:[1,0,1] neg_lo:[1,0,0] neg_hi:[1,0,0]
v_pk_fma_f32 v[122:123], v[122:123], v[88:89], v[242:243] op_sel:[0,0,1] op_sel_hi:[1,0,1] neg_lo:[1,0,0] neg_hi:[1,0,0]
v_exp_f32 v116, v116
v_exp_f32 v117, v117
v_exp_f32 v118, v118
v_exp_f32 v119, v119
v_exp_f32 v120, v120
v_exp_f32 v121, v121
v_exp_f32 v122, v122
v_exp_f32 v123, v123
v_cvt_pk_bf16_f32 v216, v116, v117
v_cvt_pk_bf16_f32 v217, v118, v119
v_cvt_pk_bf16_f32 v218, v120, v121
v_cvt_pk_bf16_f32 v219, v122, v123
v_pk_mul_f32 v[128:129], v[128:129], v[220:221] op_sel:[0,0] op_sel_hi:[1,0]
v_pk_mul_f32 v[130:131], v[130:131], v[220:221] op_sel:[0,0] op_sel_hi:[1,0]
v_cvt_pk_bf16_f32 v214, v128, v129
v_mfma_f32_16x16x32_bf16 v[224:227], v[16:19], v[216:219], 0
v_cvt_pk_bf16_f32 v215, v130, v131
ds_write_b64 v233, v[214:215] offset:23040
buffer_store_dwordx4 a[248:251], v2, s[4:7], s72 offen offset:3072 sc1
s_nop 4
v_rcp_f32 v224, v224
s_nop 0
v_pk_mul_f32 v[116:117], v[116:117], v[224:225] op_sel:[0,0] op_sel_hi:[1,0]
v_pk_mul_f32 v[118:119], v[118:119], v[224:225] op_sel:[0,0] op_sel_hi:[1,0]
v_cvt_pk_bf16_f32 v216, v116, v117
v_cvt_pk_bf16_f32 v217, v118, v119
v_pk_mul_f32 v[120:121], v[120:121], v[224:225] op_sel:[0,0] op_sel_hi:[1,0]
ds_write_b64 v233, v[216:217] offset:23552
v_pk_mul_f32 v[122:123], v[122:123], v[224:225] op_sel:[0,0] op_sel_hi:[1,0]
v_cvt_pk_bf16_f32 v218, v120, v121
v_cvt_pk_bf16_f32 v219, v122, v123
ds_write_b64 v233, v[218:219] offset:24064
s_waitcnt vmcnt(8)
s_waitcnt lgkmcnt(0)
s_barrier
ds_read_b64_tr_b16 a[0:1], v234 offset:16384
ds_read_b64_tr_b16 a[2:3], v234 offset:18432
ds_read_b64_tr_b16 a[12:13], v234 offset:20480
ds_read_b64_tr_b16 a[14:15], v234 offset:22528
ds_read_b64_tr_b16 a[24:25], v234 offset:24576
ds_read_b64_tr_b16 a[26:27], v234 offset:26624
ds_read_b64_tr_b16 a[4:5], v8 offset:0
ds_read_b64_tr_b16 a[6:7], v8 offset:1024
ds_read_b64_tr_b16 a[8:9], v8 offset:512
ds_read_b64_tr_b16 a[10:11], v8 offset:1536
ds_read_b64_tr_b16 a[36:37], v234 offset:28672
ds_read_b64_tr_b16 a[38:39], v234 offset:30720
ds_read_b64_tr_b16 a[16:17], v8 offset:2048
ds_read_b64_tr_b16 a[18:19], v8 offset:3072
ds_read_b64_tr_b16 a[20:21], v8 offset:2560
ds_read_b64_tr_b16 a[22:23], v8 offset:3584
ds_read_b64_tr_b16 a[48:49], v234 offset:32768
ds_read_b64_tr_b16 a[50:51], v234 offset:34816
ds_read_b64_tr_b16 a[28:29], v8 offset:4096
ds_read_b64_tr_b16 a[30:31], v8 offset:5120
ds_read_b64_tr_b16 a[32:33], v8 offset:4608
ds_read_b64_tr_b16 a[34:35], v8 offset:5632
ds_read_b64_tr_b16 a[60:61], v234 offset:36864
ds_read_b64_tr_b16 a[62:63], v234 offset:38912
s_waitcnt lgkmcnt(14)
v_mfma_f32_16x16x32_bf16 v[100:103], a[0:3], v[16:19], 0
ds_read_b64_tr_b16 a[40:41], v8 offset:6144
ds_read_b64_tr_b16 a[42:43], v8 offset:7168
ds_read_b64_tr_b16 a[44:45], v8 offset:6656
ds_read_b64_tr_b16 a[46:47], v8 offset:7680
ds_read_b64_tr_b16 a[72:73], v234 offset:40960
ds_read_b64_tr_b16 a[74:75], v234 offset:43008
v_mfma_f32_16x16x32_bf16 v[100:103], a[12:15], v[16:19], v[100:103]
buffer_atomic_add v12, v235, s[4:7], s94 offen sc1
ds_read_b64_tr_b16 a[52:53], v8 offset:8192
ds_read_b64_tr_b16 a[54:55], v8 offset:9216
ds_read_b64_tr_b16 a[56:57], v8 offset:8704
ds_read_b64_tr_b16 a[58:59], v8 offset:9728
ds_read_b64_tr_b16 a[84:85], v234 offset:45056
ds_read_b64_tr_b16 a[86:87], v234 offset:47104
v_mfma_f32_16x16x32_bf16 v[100:103], a[24:27], v[16:19], v[100:103]
ds_read_b64_tr_b16 a[64:65], v8 offset:10240
ds_read_b64_tr_b16 a[66:67], v8 offset:11264
v_mfma_f32_16x16x32_bf16 v[92:95], a[0:3], a[4:7], 0
ds_read_b64_tr_b16 a[68:69], v8 offset:10752
ds_read_b64_tr_b16 a[70:71], v8 offset:11776
v_mfma_f32_16x16x32_bf16 v[96:99], a[0:3], a[8:11], 0
ds_read_b64_tr_b16 a[76:77], v8 offset:12288
s_waitcnt lgkmcnt(14)
v_mfma_f32_16x16x32_bf16 v[100:103], a[36:39], v[16:19], v[100:103]
ds_read_b64_tr_b16 a[78:79], v8 offset:13312
L_stub18:
s_cbranch_execz L_wret5
v_mfma_f32_16x16x32_bf16 v[92:95], a[12:15], a[16:19], v[92:95]
ds_read_b64_tr_b16 a[80:81], v8 offset:12800
ds_read_b64_tr_b16 a[82:83], v8 offset:13824
v_mfma_f32_16x16x32_bf16 v[96:99], a[12:15], a[20:23], v[96:99]
ds_read_b64_tr_b16 a[88:89], v8 offset:14336
v_mfma_f32_16x16x32_bf16 v[100:103], a[48:51], v[16:19], v[100:103]
ds_read_b64_tr_b16 a[90:91], v8 offset:15360
v_mfma_f32_16x16x32_bf16 v[92:95], a[24:27], a[28:31], v[92:95]
ds_read_b64_tr_b16 a[92:93], v8 offset:14848
ds_read_b64_tr_b16 a[94:95], v8 offset:15872
v_mfma_f32_16x16x32_bf16 v[96:99], a[24:27], a[32:35], v[96:99]
v_cvt_pk_bf16_f32 v132, v132, v133
v_cvt_pk_bf16_f32 v156, v156, v157
v_mfma_f32_16x16x32_bf16 v[100:103], a[60:63], v[16:19], v[100:103]
v_cvt_pk_bf16_f32 v180, v180, v181
v_cvt_pk_bf16_f32 v204, v204, v205
v_mfma_f32_16x16x32_bf16 v[92:95], a[36:39], a[40:43], v[92:95]
v_cvt_pk_bf16_f32 v133, v134, v135
v_cvt_pk_bf16_f32 v157, v158, v159
s_waitcnt lgkmcnt(14)
v_mfma_f32_16x16x32_bf16 v[96:99], a[36:39], a[44:47], v[96:99]
v_cvt_pk_bf16_f32 v181, v182, v183
v_cvt_pk_bf16_f32 v205, v206, v207
v_mfma_f32_16x16x32_bf16 v[100:103], a[72:75], v[16:19], v[100:103]
v_cvt_pk_bf16_f32 v134, v136, v137
v_cvt_pk_bf16_f32 v135, v138, v139
v_mfma_f32_16x16x32_bf16 v[92:95], a[48:51], a[52:55], v[92:95]
v_cvt_pk_bf16_f32 v158, v160, v161
v_cvt_pk_bf16_f32 v159, v162, v163
v_mfma_f32_16x16x32_bf16 v[96:99], a[48:51], a[56:59], v[96:99]
v_cvt_pk_bf16_f32 v182, v184, v185
v_cvt_pk_bf16_f32 v183, v186, v187
s_waitcnt lgkmcnt(12)
v_mfma_f32_16x16x32_bf16 v[100:103], a[84:87], v[16:19], v[100:103]
v_cvt_pk_bf16_f32 v206, v208, v209
v_cvt_pk_bf16_f32 v207, v210, v211
s_waitcnt lgkmcnt(10)
v_mfma_f32_16x16x32_bf16 v[92:95], a[60:63], a[64:67], v[92:95]
s_waitcnt lgkmcnt(8)
v_mfma_f32_16x16x32_bf16 v[96:99], a[60:63], a[68:71], v[96:99]
s_nop 1
v_min_u32 v100, -2, v100
v_min_u32 v101, -2, v101
s_waitcnt lgkmcnt(6)
v_mfma_f32_16x16x32_bf16 v[92:95], a[72:75], a[76:79], v[92:95]
v_min_u32 v102, -2, v102
v_min_u32 v103, -2, v103
s_waitcnt lgkmcnt(4)
v_mfma_f32_16x16x32_bf16 v[96:99], a[72:75], a[80:83], v[96:99]
buffer_store_dwordx4 v[100:103], v254, s[4:7], s97 offen sc1
s_waitcnt lgkmcnt(2)
v_mfma_f32_16x16x32_bf16 v[92:95], a[84:87], a[88:91], v[92:95]
s_waitcnt lgkmcnt(0)
v_mfma_f32_16x16x32_bf16 v[96:99], a[84:87], a[92:95], v[96:99]
s_nop 5
v_cvt_pk_bf16_f32 v92, v92, v93
v_cvt_pk_bf16_f32 v93, v94, v95
v_min_u32 v92, -2, v92
v_min_u32 v93, -2, v93
v_cvt_pk_bf16_f32 v94, v96, v97
v_cvt_pk_bf16_f32 v95, v98, v99
v_min_u32 v94, -2, v94
v_min_u32 v95, -2, v95
buffer_store_dwordx4 v[92:95], v1, s[4:7], s96 offen sc1
s_barrier
s_add_u32 m0, s19, 32768
s_xor_b32 s44, s85, 0
buffer_load_dwordx4 v1, s[4:7], s44 offen offset:0 sc1 lds
v_mfma_f32_16x16x32_bf16 v[108:111], a[240:243], v[132:135], 0
v_mfma_f32_16x16x32_bf16 v[172:175], a[240:243], v[156:159], 0
v_mfma_f32_16x16x32_bf16 v[112:115], a[244:247], v[132:135], 0
s_nop 5
v_max3_f32 v236, v108, v109, v110
v_max3_f32 v237, -v108, -v109, -v110
v_mfma_f32_16x16x32_bf16 v[176:179], a[244:247], v[156:159], 0
v_max3_f32 v238, v172, v173, v174
v_max3_f32 v239, -v172, -v173, -v174
v_max3_f32 v236, v236, v111, v112
v_max3_f32 v237, v237, -v111, -v112
v_max3_f32 v236, v236, v113, v114
v_max3_f32 v237, v237, -v113, -v114
s_nop 1
v_max3_f32 v238, v238, v175, v176
v_max3_f32 v239, v239, -v175, -v176
v_max3_f32 v238, v238, v177, v178
v_max3_f32 v239, v239, -v177, -v178
v_max_f32 v236, v236, v115
buffer_load_dwordx4 v1, s[4:7], s44 offen offset:1024 sc1 lds
v_max_f32_e64 v237, v237, -v115
v_max_f32 v238, v238, v179
v_max_f32_e64 v239, v239, -v179
v_permlane32_swap_b32 v236, v237
s_nop 0
v_permlane32_swap_b32 v238, v239
v_mov_b32 v11, 0
buffer_atomic_add v11, v251, s[4:7], s89 offen sc0 sc1
v_max_f32 v236, v236, v237
v_max_f32 v238, v238, v239
v_mov_b32 v244, v236
v_mov_b32 v245, v238
s_nop 0
v_permlane16_swap_b32 v236, v244
v_permlane16_swap_b32 v238, v245
v_max_f32 v236, v236, v244
v_max_f32 v238, v238, v245
v_mov_b32 v244, v236
v_mov_b32 v245, v238
s_nop 0
v_permlane32_swap_b32 v236, v244
v_permlane32_swap_b32 v238, v245
v_mul_f32_e64 v236, -v236, v82
v_mul_f32_e64 v237, -v244, v82
buffer_load_dwordx4 v1, s[4:7], s44 offen offset:2048 sc1 lds
v_mul_f32_e64 v238, -v238, v84
v_mul_f32_e64 v239, -v245, v84
v_pk_fma_f32 v[116:117], v[108:109], v[82:83], v[236:237] op_sel:[0,0,0] op_sel_hi:[1,0,0]
v_pk_fma_f32 v[118:119], v[110:111], v[82:83], v[236:237] op_sel:[0,0,0] op_sel_hi:[1,0,0]
v_pk_fma_f32 v[120:121], v[112:113], v[82:83], v[236:237] op_sel:[0,0,0] op_sel_hi:[1,0,0]
v_pk_fma_f32 v[122:123], v[114:115], v[82:83], v[236:237] op_sel:[0,0,0] op_sel_hi:[1,0,0]
v_pk_fma_f32 v[148:149], v[172:173], v[84:85], v[238:239] op_sel:[0,0,0] op_sel_hi:[1,0,0]
v_pk_fma_f32 v[150:151], v[174:175], v[84:85], v[238:239] op_sel:[0,0,0] op_sel_hi:[1,0,0]
v_pk_fma_f32 v[152:153], v[176:177], v[84:85], v[238:239] op_sel:[0,0,0] op_sel_hi:[1,0,0]
v_pk_fma_f32 v[154:155], v[178:179], v[84:85], v[238:239] op_sel:[0,0,0] op_sel_hi:[1,0,0]
v_pk_fma_f32 v[108:109], v[108:109], v[82:83], v[236:237] op_sel:[0,0,1] op_sel_hi:[1,0,1] neg_lo:[1,0,0] neg_hi:[1,0,0]
v_pk_fma_f32 v[110:111], v[110:111], v[82:83], v[236:237] op_sel:[0,0,1] op_sel_hi:[1,0,1] neg_lo:[1,0,0] neg_hi:[1,0,0]
v_pk_fma_f32 v[112:113], v[112:113], v[82:83], v[236:237] op_sel:[0,0,1] op_sel_hi:[1,0,1] neg_lo:[1,0,0] neg_hi:[1,0,0]
v_pk_fma_f32 v[114:115], v[114:115], v[82:83], v[236:237] op_sel:[0,0,1] op_sel_hi:[1,0,1] neg_lo:[1,0,0] neg_hi:[1,0,0]
v_pk_fma_f32 v[172:173], v[172:173], v[84:85], v[238:239] op_sel:[0,0,1] op_sel_hi:[1,0,1] neg_lo:[1,0,0] neg_hi:[1,0,0]
v_pk_fma_f32 v[174:175], v[174:175], v[84:85], v[238:239] op_sel:[0,0,1] op_sel_hi:[1,0,1] neg_lo:[1,0,0] neg_hi:[1,0,0]
v_pk_fma_f32 v[176:177], v[176:177], v[84:85], v[238:239] op_sel:[0,0,1] op_sel_hi:[1,0,1] neg_lo:[1,0,0] neg_hi:[1,0,0]
v_pk_fma_f32 v[178:179], v[178:179], v[84:85], v[238:239] op_sel:[0,0,1] op_sel_hi:[1,0,1] neg_lo:[1,0,0] neg_hi:[1,0,0]
v_exp_f32 v116, v116
v_exp_f32 v108, v108
v_exp_f32 v117, v117
v_exp_f32 v109, v109
v_exp_f32 v118, v118
v_exp_f32 v110, v110
v_exp_f32 v119, v119
v_exp_f32 v111, v111
v_exp_f32 v120, v120
v_exp_f32 v112, v112
v_exp_f32 v121, v121
v_exp_f32 v113, v113
v_exp_f32 v122, v122
v_exp_f32 v114, v114
v_exp_f32 v123, v123
v_exp_f32 v115, v115
v_exp_f32 v148, v148
v_exp_f32 v172, v172
v_exp_f32 v149, v149
v_exp_f32 v173, v173
v_exp_f32 v150, v150
v_exp_f32 v174, v174
v_exp_f32 v151, v151
v_exp_f32 v175, v175
v_exp_f32 v152, v152
v_exp_f32 v176, v176
v_exp_f32 v153, v153
v_exp_f32 v177, v177
v_exp_f32 v154, v154
v_exp_f32 v178, v178
v_exp_f32 v155, v155
v_exp_f32 v179, v179
buffer_load_dwordx4 v1, s[4:7], s44 offen offset:3072 sc1 lds
v_cvt_pk_bf16_f32 v140, v116, v117
v_cvt_pk_bf16_f32 v141, v118, v119
v_cvt_pk_bf16_f32 v142, v120, v121
v_cvt_pk_bf16_f32 v143, v122, v123
v_cvt_pk_bf16_f32 v144, v108, v109
v_cvt_pk_bf16_f32 v145, v110, v111
v_cvt_pk_bf16_f32 v146, v112, v113
v_cvt_pk_bf16_f32 v147, v114, v115
v_cvt_pk_bf16_f32 v164, v148, v149
v_cvt_pk_bf16_f32 v165, v150, v151
v_cvt_pk_bf16_f32 v166, v152, v153
v_cvt_pk_bf16_f32 v167, v154, v155
v_cvt_pk_bf16_f32 v168, v172, v173
v_cvt_pk_bf16_f32 v169, v174, v175
v_cvt_pk_bf16_f32 v170, v176, v177
v_cvt_pk_bf16_f32 v171, v178, v179
s_waitcnt vmcnt(2)
v_readfirstlane_b32 s38, v11
s_nop 0
s_cmp_ge_u32 s38, 8
s_cbranch_scc1 Lpe_46
s_add_u32 s36, s88, 0x90000
s_mov_b32 s37, 0
Lpoll_45:
v_mov_b32 v11, 0
buffer_atomic_add v11, v251, s[4:7], s36 offen sc0 sc1
s_add_u32 s37, s37, 1
s_waitcnt vmcnt(0)
v_readfirstlane_b32 s38, v11
s_nop 0
s_cmp_ge_u32 s38, 8
s_cbranch_scc1 Lpe_46
s_cmp_lt_u32 s37, 0x100000
s_cbranch_scc1 Lpoll_45
Lpe_46:
buffer_load_dwordx4 v[48:51], v1, s[4:7], s98 offen offset:0 sc1
v_mfma_f32_16x16x32_bf16 v[108:111], a[240:243], v[180:183], 0
v_mfma_f32_16x16x32_bf16 v[220:223], a[240:243], v[204:207], 0
v_mfma_f32_16x16x32_bf16 v[112:115], a[244:247], v[180:183], 0
s_nop 5
v_max3_f32 v240, v108, v109, v110
v_max3_f32 v241, -v108, -v109, -v110
v_mfma_f32_16x16x32_bf16 v[224:227], a[244:247], v[204:207], 0
buffer_load_dwordx4 v[124:127], v248, s[4:7], s100 offen sc1
v_max3_f32 v242, v220, v221, v222
v_max3_f32 v243, -v220, -v221, -v222
v_max3_f32 v240, v240, v111, v112
v_max3_f32 v241, v241, -v111, -v112
v_max3_f32 v240, v240, v113, v114
s_nop 1
v_max3_f32 v242, v242, v223, v224
v_max3_f32 v243, v243, -v223, -v224
v_max3_f32 v241, v241, -v113, -v114
v_max3_f32 v242, v242, v225, v226
v_max3_f32 v243, v243, -v225, -v226
v_max_f32 v240, v240, v115
v_max_f32_e64 v241, v241, -v115
v_max_f32 v242, v242, v227
buffer_load_dwordx4 v[52:55], v1, s[4:7], s98 offen offset:1024 sc1
v_max_f32_e64 v243, v243, -v227
v_permlane32_swap_b32 v240, v241
s_nop 0
v_permlane32_swap_b32 v242, v243
v_max_f32 v240, v240, v241
v_max_f32 v242, v242, v243
v_mov_b32 v246, v240
v_mov_b32 v247, v242
s_nop 0
v_permlane16_swap_b32 v240, v246
v_permlane16_swap_b32 v242, v247
buffer_load_dwordx4 v[56:59], v1, s[4:7], s98 offen offset:2048 sc1
v_max_f32 v240, v240, v246
v_max_f32 v242, v242, v247
v_mov_b32 v246, v240
v_mov_b32 v247, v242
s_nop 0
v_permlane32_swap_b32 v240, v246
v_permlane32_swap_b32 v242, v247
v_mul_f32_e64 v240, -v240, v86
v_mul_f32_e64 v241, -v246, v86
v_mul_f32_e64 v242, -v242, v88
v_mul_f32_e64 v243, -v247, v88
buffer_load_dwordx4 v[60:63], v1, s[4:7], s98 offen offset:3072 sc1
v_pk_fma_f32 v[116:117], v[108:109], v[86:87], v[240:241] op_sel:[0,0,0] op_sel_hi:[1,0,0]
v_pk_fma_f32 v[118:119], v[110:111], v[86:87], v[240:241] op_sel:[0,0,0] op_sel_hi:[1,0,0]
v_pk_fma_f32 v[120:121], v[112:113], v[86:87], v[240:241] op_sel:[0,0,0] op_sel_hi:[1,0,0]
v_pk_fma_f32 v[122:123], v[114:115], v[86:87], v[240:241] op_sel:[0,0,0] op_sel_hi:[1,0,0]
v_pk_fma_f32 v[196:197], v[220:221], v[88:89], v[242:243] op_sel:[0,0,0] op_sel_hi:[1,0,0]
v_pk_fma_f32 v[198:199], v[222:223], v[88:89], v[242:243] op_sel:[0,0,0] op_sel_hi:[1,0,0]
v_pk_fma_f32 v[200:201], v[224:225], v[88:89], v[242:243] op_sel:[0,0,0] op_sel_hi:[1,0,0]
v_pk_fma_f32 v[202:203], v[226:227], v[88:89], v[242:243] op_sel:[0,0,0] op_sel_hi:[1,0,0]
v_pk_fma_f32 v[108:109], v[108:109], v[86:87], v[240:241] op_sel:[0,0,1] op_sel_hi:[1,0,1] neg_lo:[1,0,0] neg_hi:[1,0,0]
v_pk_fma_f32 v[110:111], v[110:111], v[86:87], v[240:241] op_sel:[0,0,1] op_sel_hi:[1,0,1] neg_lo:[1,0,0] neg_hi:[1,0,0]
v_pk_fma_f32 v[112:113], v[112:113], v[86:87], v[240:241] op_sel:[0,0,1] op_sel_hi:[1,0,1] neg_lo:[1,0,0] neg_hi:[1,0,0]
v_pk_fma_f32 v[114:115], v[114:115], v[86:87], v[240:241] op_sel:[0,0,1] op_sel_hi:[1,0,1] neg_lo:[1,0,0] neg_hi:[1,0,0]
v_pk_fma_f32 v[220:221], v[220:221], v[88:89], v[242:243] op_sel:[0,0,1] op_sel_hi:[1,0,1] neg_lo:[1,0,0] neg_hi:[1,0,0]
buffer_load_dwordx4 v[64:67], v1, s[4:7], s99 offen offset:0 sc1
v_pk_fma_f32 v[222:223], v[222:223], v[88:89], v[242:243] op_sel:[0,0,1] op_sel_hi:[1,0,1] neg_lo:[1,0,0] neg_hi:[1,0,0]
v_pk_fma_f32 v[224:225], v[224:225], v[88:89], v[242:243] op_sel:[0,0,1] op_sel_hi:[1,0,1] neg_lo:[1,0,0] neg_hi:[1,0,0]
v_pk_fma_f32 v[226:227], v[226:227], v[88:89], v[242:243] op_sel:[0,0,1] op_sel_hi:[1,0,1] neg_lo:[1,0,0] neg_hi:[1,0,0]
v_exp_f32 v116, v116
v_exp_f32 v108, v108
v_exp_f32 v117, v117
v_exp_f32 v109, v109
v_exp_f32 v118, v118
buffer_load_dwordx4 v[68:71], v1, s[4:7], s99 offen offset:1024 sc1
v_exp_f32 v110, v110
v_exp_f32 v119, v119
v_exp_f32 v111, v111
v_exp_f32 v120, v120
v_exp_f32 v112, v112
v_exp_f32 v121, v121
v_exp_f32 v113, v113
buffer_load_dwordx4 v[100:103], v1, s[4:7], s99 offen offset:2048 sc1
v_exp_f32 v122, v122
v_exp_f32 v114, v114
v_exp_f32 v123, v123
v_exp_f32 v115, v115
v_exp_f32 v196, v196
v_exp_f32 v220, v220
v_exp_f32 v197, v197
buffer_load_dwordx4 v[104:107], v1, s[4:7], s99 offen offset:3072 sc1
v_exp_f32 v221, v221
v_exp_f32 v198, v198
v_exp_f32 v222, v222
v_exp_f32 v199, v199
v_exp_f32 v223, v223
v_exp_f32 v200, v200
v_exp_f32 v224, v224
v_exp_f32 v201, v201
v_exp_f32 v225, v225
v_exp_f32 v202, v202
v_exp_f32 v226, v226
v_exp_f32 v203, v203
v_exp_f32 v227, v227
v_cvt_pk_bf16_f32 v188, v116, v117
v_cvt_pk_bf16_f32 v189, v118, v119
v_cvt_pk_bf16_f32 v190, v120, v121
v_cvt_pk_bf16_f32 v191, v122, v123
v_cvt_pk_bf16_f32 v192, v108, v109
v_cvt_pk_bf16_f32 v193, v110, v111
v_cvt_pk_bf16_f32 v194, v112, v113
v_cvt_pk_bf16_f32 v195, v114, v115
v_cvt_pk_bf16_f32 v212, v196, v197
v_cvt_pk_bf16_f32 v213, v198, v199
v_cvt_pk_bf16_f32 v214, v200, v201
v_cvt_pk_bf16_f32 v215, v202, v203
v_cvt_pk_bf16_f32 v216, v220, v221
v_cvt_pk_bf16_f32 v217, v222, v223
v_cvt_pk_bf16_f32 v218, v224, v225
v_cvt_pk_bf16_f32 v219, v226, v227
s_waitcnt vmcnt(8)
v_lshlrev_b32 v92, 16, v48
v_and_b32 v93, 0xffff0000, v48
v_lshlrev_b32 v94, 16, v49
v_and_b32 v95, 0xffff0000, v49
v_lshlrev_b32 v96, 16, v50
v_and_b32 v97, 0xffff0000, v50
v_lshlrev_b32 v98, 16, v51
v_and_b32 v99, 0xffff0000, v51
s_waitcnt vmcnt(7)
v_add_f32_dpp v128, v124, v124 row_ror:4 row_mask:0xf bank_mask:0xf
v_add_f32_dpp v129, v125, v125 row_ror:4 row_mask:0xf bank_mask:0xf
v_add_f32_dpp v130, v126, v126 row_ror:4 row_mask:0xf bank_mask:0xf
v_add_f32_dpp v131, v127, v127 row_ror:4 row_mask:0xf bank_mask:0xf
v_add_f32_dpp v128, v128, v128 row_ror:2 row_mask:0xf bank_mask:0xf
v_add_f32_dpp v129, v129, v129 row_ror:2 row_mask:0xf bank_mask:0xf
v_add_f32_dpp v130, v130, v130 row_ror:2 row_mask:0xf bank_mask:0xf
v_add_f32_dpp v131, v131, v131 row_ror:2 row_mask:0xf bank_mask:0xf
v_add_f32_dpp v128, v128, v128 row_ror:1 row_mask:0xf bank_mask:0xf
v_add_f32_dpp v129, v129, v129 row_ror:1 row_mask:0xf bank_mask:0xf
v_add_f32_dpp v130, v130, v130 row_ror:1 row_mask:0xf bank_mask:0xf
v_add_f32_dpp v131, v131, v131 row_ror:1 row_mask:0xf bank_mask:0xf
v_fma_f32 v135, v129, v130, v131
s_waitcnt vmcnt(6)
v_dot2c_f32_bf16 v92, v52, v249
v_dot2c_f32_bf16 v93, v52, v250
v_dot2c_f32_bf16 v94, v53, v249
v_dot2c_f32_bf16 v95, v53, v250
v_dot2c_f32_bf16 v96, v54, v249
v_dot2c_f32_bf16 v97, v54, v250
v_dot2c_f32_bf16 v98, v55, v249
v_dot2c_f32_bf16 v99, v55, v250
s_waitcnt vmcnt(5)
v_dot2c_f32_bf16 v92, v56, v249
v_dot2c_f32_bf16 v93, v56, v250
v_dot2c_f32_bf16 v94, v57, v249
v_dot2c_f32_bf16 v95, v57, v250
v_dot2c_f32_bf16 v96, v58, v249
v_dot2c_f32_bf16 v97, v58, v250
v_dot2c_f32_bf16 v98, v59, v249
v_dot2c_f32_bf16 v99, v59, v250
s_waitcnt vmcnt(4)
v_dot2c_f32_bf16 v92, v60, v249
v_dot2c_f32_bf16 v93, v60, v250
v_dot2c_f32_bf16 v94, v61, v249
v_dot2c_f32_bf16 v95, v61, v250
v_dot2c_f32_bf16 v96, v62, v249
v_dot2c_f32_bf16 v97, v62, v250
v_dot2c_f32_bf16 v98, v63, v249
v_dot2c_f32_bf16 v99, v63, v250
s_waitcnt vmcnt(3)
v_dot2c_f32_bf16 v92, v64, v249
v_dot2c_f32_bf16 v93, v64, v250
v_dot2c_f32_bf16 v94, v65, v249
v_dot2c_f32_bf16 v95, v65, v250
v_dot2c_f32_bf16 v96, v66, v249
v_dot2c_f32_bf16 v97, v66, v250
v_dot2c_f32_bf16 v98, v67, v249
v_dot2c_f32_bf16 v99, v67, v250
s_waitcnt vmcnt(2)
v_dot2c_f32_bf16 v92, v68, v249
v_dot2c_f32_bf16 v93, v68, v250
v_dot2c_f32_bf16 v94, v69, v249
v_dot2c_f32_bf16 v95, v69, v250
v_dot2c_f32_bf16 v96, v70, v249
v_dot2c_f32_bf16 v97, v70, v250
v_dot2c_f32_bf16 v98, v71, v249
v_dot2c_f32_bf16 v99, v71, v250
s_waitcnt vmcnt(1)
v_dot2c_f32_bf16 v92, v100, v249
v_dot2c_f32_bf16 v93, v100, v250
v_dot2c_f32_bf16 v94, v101, v249
v_dot2c_f32_bf16 v95, v101, v250
v_dot2c_f32_bf16 v96, v102, v249
v_dot2c_f32_bf16 v97, v102, v250
v_dot2c_f32_bf16 v98, v103, v249
v_dot2c_f32_bf16 v99, v103, v250
s_waitcnt vmcnt(0)
v_dot2c_f32_bf16 v92, v104, v249
v_dot2c_f32_bf16 v93, v104, v250
v_dot2c_f32_bf16 v94, v105, v249
v_dot2c_f32_bf16 v95, v105, v250
v_dot2c_f32_bf16 v96, v106, v249
v_dot2c_f32_bf16 v97, v106, v250
v_dot2c_f32_bf16 v98, v107, v249
v_dot2c_f32_bf16 v99, v107, v250
v_fma_f32 v132, v92, v93, v94
v_fma_f32 v133, v95, v96, v97
s_nop 0
v_fma_f32 v134, v98, v99, v128
v_fma_f32 v132, v132, v133, v134
v_cmp_u_f32 vcc, v132, v135
s_cbranch_vccnz L_kvredo3
L_kvback3:
v_cvt_pk_bf16_f32 v128, v128, v129
v_cvt_pk_bf16_f32 v129, v130, v131
v_cvt_pk_bf16_f32 v92, v92, v93
v_cndmask_b32 v128, 0, v128, s[56:57]
v_cndmask_b32 v129, 0, v129, s[56:57]
v_cvt_pk_bf16_f32 v93, v94, v95
v_cvt_pk_bf16_f32 v94, v96, v97
v_cvt_pk_bf16_f32 v95, v98, v99
v_cndmask_b32 v128, v128, v16, s[58:59]
v_cndmask_b32 v129, v129, v16, s[58:59]
ds_write_b64 v252, v[92:93] offset:0
ds_write_b64 v252, v[94:95] offset:1024
ds_write_b64 v252, v[128:129] offset:2048
s_waitcnt lgkmcnt(0)
s_barrier
ds_read_b128 a[8:11], v1 offset:2048
ds_read_b128 a[20:23], v1 offset:5120
ds_read_b128 a[0:3], v1 offset:0
ds_read_b128 a[12:15], v1 offset:3072
ds_read_b128 a[4:7], v1 offset:1024
ds_read_b128 a[16:19], v1 offset:4096
s_waitcnt lgkmcnt(5)
v_mfma_f32_16x16x32_bf16 v[116:119], a[8:11], v[212:215], 0
s_waitcnt lgkmcnt(4)
v_mfma_f32_16x16x32_bf16 v[120:123], a[20:23], v[216:219], 0
s_waitcnt lgkmcnt(3)
v_mfma_f32_16x16x32_bf16 v[204:207], a[0:3], v[212:215], 0
s_nop 3
v_rcp_f32 v118, v117
s_waitcnt lgkmcnt(2)
v_mfma_f32_16x16x32_bf16 v[220:223], a[12:15], v[216:219], 0
v_rcp_f32 v119, v121
v_mul_f32 v116, v116, v118
v_fmac_f32 v116, v120, v119
v_mfma_f32_16x16x32_bf16 v[100:103], a[8:11], v[164:167], 0
v_add_f32 v116, 0x358637bd, v116
v_rcp_f32 v116, v116
s_waitcnt lgkmcnt(1)
v_mfma_f32_16x16x32_bf16 v[208:211], a[4:7], v[212:215], 0
v_mul_f32 v118, v118, v116
v_mul_f32 v119, v119, v116
v_mfma_f32_16x16x32_bf16 v[104:107], a[20:23], v[168:171], 0
v_mul_f32 v204, v204, v118
v_mul_f32 v205, v205, v118
s_waitcnt lgkmcnt(0)
v_mfma_f32_16x16x32_bf16 v[224:227], a[16:19], v[216:219], 0
v_mul_f32 v206, v206, v118
v_mul_f32 v207, v207, v118
v_fmac_f32 v204, v220, v119
v_fmac_f32 v205, v221, v119
v_rcp_f32 v102, v101
v_mul_f32 v208, v208, v118
v_mul_f32 v209, v209, v118
v_mul_f32 v210, v210, v118
buffer_atomic_add v12, v10, s[4:7], s74 offen sc1
v_mul_f32 v211, v211, v118
v_fmac_f32 v206, v222, v119
v_fmac_f32 v207, v223, v119
v_cvt_pk_bf16_f32 v204, v204, v205
v_rcp_f32 v103, v105
v_fmac_f32 v208, v224, v119
v_fmac_f32 v209, v225, v119
v_fmac_f32 v210, v226, v119
v_fmac_f32 v211, v227, v119
v_cvt_pk_bf16_f32 v205, v206, v207
v_cvt_pk_bf16_f32 v206, v208, v209
v_cvt_pk_bf16_f32 v207, v210, v211
v_mul_f32 v100, v100, v102
v_mfma_f32_16x16x32_bf16 v[156:159], a[0:3], v[164:167], 0
buffer_store_dwordx4 v[204:207], v2, s[4:7], s72 offen offset:3072 sc1
v_fmac_f32 v100, v104, v103
v_mfma_f32_16x16x32_bf16 v[172:175], a[12:15], v[168:171], 0
v_add_f32 v100, 0x358637bd, v100
v_rcp_f32 v100, v100
v_mfma_f32_16x16x32_bf16 v[108:111], a[8:11], v[188:191], 0
v_mul_f32 v102, v102, v100
v_mul_f32 v103, v103, v100
v_mfma_f32_16x16x32_bf16 v[160:163], a[4:7], v[164:167], 0
v_mul_f32 v156, v156, v102
v_mul_f32 v157, v157, v102
v_mfma_f32_16x16x32_bf16 v[112:115], a[20:23], v[192:195], 0
v_mul_f32 v158, v158, v102
v_mul_f32 v159, v159, v102
v_mfma_f32_16x16x32_bf16 v[176:179], a[16:19], v[168:171], 0
v_fmac_f32 v156, v172, v103
v_fmac_f32 v157, v173, v103
v_rcp_f32 v110, v109
v_mul_f32 v160, v160, v102
v_mul_f32 v161, v161, v102
v_mul_f32 v162, v162, v102
v_mul_f32 v163, v163, v102
v_fmac_f32 v158, v174, v103
v_fmac_f32 v159, v175, v103
v_cvt_pk_bf16_f32 v156, v156, v157
v_rcp_f32 v111, v113
v_fmac_f32 v160, v176, v103
v_fmac_f32 v161, v177, v103
v_fmac_f32 v162, v178, v103
v_fmac_f32 v163, v179, v103
v_cvt_pk_bf16_f32 v157, v158, v159
v_cvt_pk_bf16_f32 v158, v160, v161
v_cvt_pk_bf16_f32 v159, v162, v163
v_mul_f32 v108, v108, v110
v_mfma_f32_16x16x32_bf16 v[180:183], a[0:3], v[188:191], 0
buffer_store_dwordx4 v[156:159], v2, s[4:7], s72 offen offset:1024 sc1
v_fmac_f32 v108, v112, v111
v_mfma_f32_16x16x32_bf16 v[196:199], a[12:15], v[192:195], 0
v_add_f32 v108, 0x358637bd, v108
v_rcp_f32 v108, v108
v_mfma_f32_16x16x32_bf16 v[92:95], a[8:11], v[140:143], 0
v_mul_f32 v110, v110, v108
v_mul_f32 v111, v111, v108
v_mfma_f32_16x16x32_bf16 v[184:187], a[4:7], v[188:191], 0
v_mul_f32 v180, v180, v110
v_mul_f32 v181, v181, v110
v_mfma_f32_16x16x32_bf16 v[96:99], a[20:23], v[144:147], 0
v_mul_f32 v182, v182, v110
v_mul_f32 v183, v183, v110
v_mfma_f32_16x16x32_bf16 v[200:203], a[16:19], v[192:195], 0
v_fmac_f32 v180, v196, v111
v_fmac_f32 v181, v197, v111
v_rcp_f32 v94, v93
v_mul_f32 v184, v184, v110
v_mul_f32 v185, v185, v110
v_mul_f32 v186, v186, v110
v_mul_f32 v187, v187, v110
v_fmac_f32 v182, v198, v111
v_fmac_f32 v183, v199, v111
v_cvt_pk_bf16_f32 v180, v180, v181
v_rcp_f32 v95, v97
v_fmac_f32 v184, v200, v111
v_fmac_f32 v185, v201, v111
v_fmac_f32 v186, v202, v111
v_fmac_f32 v187, v203, v111
v_cvt_pk_bf16_f32 v181, v182, v183
v_cvt_pk_bf16_f32 v182, v184, v185
v_cvt_pk_bf16_f32 v183, v186, v187
v_mul_f32 v92, v92, v94
v_mfma_f32_16x16x32_bf16 v[132:135], a[0:3], v[140:143], 0
buffer_store_dwordx4 v[180:183], v2, s[4:7], s72 offen offset:2048 sc1
v_fmac_f32 v92, v96, v95
v_mfma_f32_16x16x32_bf16 v[148:151], a[12:15], v[144:147], 0
v_add_f32 v92, 0x358637bd, v92
v_rcp_f32 v92, v92
v_mfma_f32_16x16x32_bf16 v[136:139], a[4:7], v[140:143], 0
v_mul_f32 v94, v94, v92
v_mul_f32 v95, v95, v92
v_mfma_f32_16x16x32_bf16 v[152:155], a[16:19], v[144:147], 0
v_mul_f32 v132, v132, v94
v_mul_f32 v133, v133, v94
v_mul_f32 v134, v134, v94
v_mul_f32 v135, v135, v94
v_fmac_f32 v132, v148, v95
v_fmac_f32 v133, v149, v95
v_mul_f32 v136, v136, v94
v_mul_f32 v137, v137, v94
v_mul_f32 v138, v138, v94
v_mul_f32 v139, v139, v94
v_fmac_f32 v134, v150, v95
v_fmac_f32 v135, v151, v95
v_cvt_pk_bf16_f32 v132, v132, v133
v_fmac_f32 v136, v152, v95
v_fmac_f32 v137, v153, v95
v_fmac_f32 v138, v154, v95
v_fmac_f32 v139, v155, v95
v_cvt_pk_bf16_f32 v133, v134, v135
v_cvt_pk_bf16_f32 v134, v136, v137
v_cvt_pk_bf16_f32 v135, v138, v139
buffer_store_dwordx4 v[132:135], v2, s[4:7], s72 offen offset:0 sc1
s_add_u32 s92, s71, 0x30000
s_add_u32 s40, s4, 0xc00000
s_addc_u32 s41, s5, 0
v_add_u32 v5, 32768, v1
v_add_u32 v6, 98304, v1
s_mov_b32 s35, s9
v_lshlrev_b32 v132, 16, v32
v_and_b32 v133, 0xffff0000, v32
v_lshlrev_b32 v134, 16, v33
v_and_b32 v135, 0xffff0000, v33
v_lshlrev_b32 v136, 16, v34
v_and_b32 v137, 0xffff0000, v34
v_lshlrev_b32 v138, 16, v35
v_and_b32 v139, 0xffff0000, v35
v_lshlrev_b32 v140, 16, v36
v_and_b32 v141, 0xffff0000, v36
v_lshlrev_b32 v142, 16, v37
v_and_b32 v143, 0xffff0000, v37
v_lshlrev_b32 v144, 16, v38
v_and_b32 v145, 0xffff0000, v38
v_lshlrev_b32 v146, 16, v39
v_and_b32 v147, 0xffff0000, v39
v_lshlrev_b32 v148, 16, v40
v_and_b32 v149, 0xffff0000, v40
v_lshlrev_b32 v150, 16, v41
v_and_b32 v151, 0xffff0000, v41
v_lshlrev_b32 v152, 16, v42
v_and_b32 v153, 0xffff0000, v42
v_lshlrev_b32 v154, 16, v43
v_and_b32 v155, 0xffff0000, v43
v_lshlrev_b32 v156, 16, v44
v_and_b32 v157, 0xffff0000, v44
v_lshlrev_b32 v158, 16, v45
v_and_b32 v159, 0xffff0000, v45
v_lshlrev_b32 v160, 16, v46
v_and_b32 v161, 0xffff0000, v46
v_lshlrev_b32 v162, 16, v47
v_and_b32 v163, 0xffff0000, v47
s_mov_b32 s95, -1
s_mov_b64 exec, 0
s_cmp_eq_u32 s28, 3
s_cbranch_scc1 L_stub19
s_cmp_eq_u32 s28, 2
s_cbranch_scc1 L_wret7
s_cmp_eq_u32 s28, 0
s_cbranch_scc1 L_wret7
L_wret7:
s_mov_b64 exec, -1
s_cmp_lg_u32 s28, 1
s_cbranch_scc1 Lpo_49
s_add_u32 s36, s11, 0x30080
s_mov_b32 s37, 0
v_mov_b32 v11, 0
buffer_atomic_add v11, v251, s[4:7], s36 offen sc0 sc1
s_sleep 4
Lpoll_47:
v_mov_b32 v234, 0
buffer_atomic_add v234, v251, s[4:7], s36 offen sc0 sc1
s_waitcnt vmcnt(1)
v_readfirstlane_b32 s38, v11
s_nop 0
s_cmp_ge_u32 s38, 32
s_cbranch_scc1 Lpe_48
v_mov_b32 v11, 0
buffer_atomic_add v11, v251, s[4:7], s36 offen sc0 sc1
s_waitcnt vmcnt(1)
v_readfirstlane_b32 s38, v234
s_nop 0
s_cmp_ge_u32 s38, 32
s_cbranch_scc1 Lpe_48
s_add_u32 s37, s37, 1
s_cmp_lt_u32 s37, 0x80000
s_cbranch_scc1 Lpoll_47
s_waitcnt vmcnt(0)
Lpo_49:
s_waitcnt vmcnt(0)
Lpe_48:
s_barrier
L_k2go3:
buffer_load_dwordx4 a[0:3], v4, s[40:43], s35 offen offset:0 sc1
buffer_load_dwordx4 a[4:7], v4, s[40:43], s35 offen offset:1024 sc1
s_xor_b32 s35, s9, 4096
buffer_load_dwordx4 a[8:11], v4, s[40:43], s35 offen offset:0 sc1
buffer_load_dwordx4 a[12:15], v4, s[40:43], s35 offen offset:1024 sc1
s_xor_b32 s35, s9, 16384
buffer_load_dwordx4 a[16:19], v4, s[40:43], s35 offen offset:0 sc1
buffer_load_dwordx4 a[20:23], v4, s[40:43], s35 offen offset:1024 sc1
s_xor_b32 s35, s9, 20480
buffer_load_dwordx4 a[24:27], v4, s[40:43], s35 offen offset:0 sc1
buffer_load_dwordx4 a[28:31], v4, s[40:43], s35 offen offset:1024 sc1
s_xor_b32 s35, s9, 32768
buffer_load_dwordx4 a[32:35], v4, s[40:43], s35 offen offset:0 sc1
buffer_load_dwordx4 a[36:39], v4, s[40:43], s35 offen offset:1024 sc1
s_xor_b32 s35, s9, 36864
buffer_load_dwordx4 a[40:43], v4, s[40:43], s35 offen offset:0 sc1
buffer_load_dwordx4 a[44:47], v4, s[40:43], s35 offen offset:1024 sc1
s_xor_b32 s35, s9, 49152
ds_read_b128 a[96:99], v5 offset:0
ds_read_b128 a[100:103], v5 offset:1024
ds_read_b128 a[104:107], v5 offset:2048
ds_read_b128 a[108:111], v5 offset:3072
ds_read_b128 a[112:115], v5 offset:4096
ds_read_b128 a[116:119], v5 offset:5120
ds_read_b128 a[120:123], v5 offset:6144
ds_read_b128 a[124:127], v5 offset:7168
s_waitcnt vmcnt(10) lgkmcnt(4)
v_mfma_f32_16x16x32_bf16 v[132:135], a[96:99], a[0:3], v[132:135]
ds_read_b128 a[128:131], v5 offset:8192
v_mfma_f32_16x16x32_bf16 v[148:151], a[96:99], a[4:7], v[148:151]
ds_read_b128 a[132:135], v5 offset:9216
v_mfma_f32_16x16x32_bf16 v[152:155], a[100:103], a[4:7], v[152:155]
buffer_load_dwordx4 a[48:51], v4, s[40:43], s35 offen offset:0 sc1
v_mfma_f32_16x16x32_bf16 v[136:139], a[100:103], a[0:3], v[136:139]
ds_read_b128 a[136:139], v5 offset:10240
v_mfma_f32_16x16x32_bf16 v[140:143], a[104:107], a[0:3], v[140:143]
ds_read_b128 a[140:143], v5 offset:11264
v_mfma_f32_16x16x32_bf16 v[156:159], a[104:107], a[4:7], v[156:159]
v_mfma_f32_16x16x32_bf16 v[160:163], a[108:111], a[4:7], v[160:163]
buffer_load_dwordx4 a[52:55], v4, s[40:43], s35 offen offset:1024 sc1
s_xor_b32 s35, s9, 53248
v_mfma_f32_16x16x32_bf16 v[144:147], a[108:111], a[0:3], v[144:147]
s_waitcnt vmcnt(10) lgkmcnt(4)
v_mfma_f32_16x16x32_bf16 v[132:135], a[112:115], a[8:11], v[132:135]
ds_read_b128 a[96:99], v5 offset:12288
L_stub19:
s_cbranch_execz L_wret7
v_mfma_f32_16x16x32_bf16 v[148:151], a[112:115], a[12:15], v[148:151]
ds_read_b128 a[100:103], v5 offset:13312
v_mfma_f32_16x16x32_bf16 v[152:155], a[116:119], a[12:15], v[152:155]
buffer_load_dwordx4 a[0:3], v4, s[40:43], s35 offen offset:0 sc1
v_mfma_f32_16x16x32_bf16 v[136:139], a[116:119], a[8:11], v[136:139]
ds_read_b128 a[104:107], v5 offset:14336
v_mfma_f32_16x16x32_bf16 v[140:143], a[120:123], a[8:11], v[140:143]
ds_read_b128 a[108:111], v5 offset:15360
v_mfma_f32_16x16x32_bf16 v[156:159], a[120:123], a[12:15], v[156:159]
v_mfma_f32_16x16x32_bf16 v[160:163], a[124:127], a[12:15], v[160:163]
buffer_load_dwordx4 a[4:7], v4, s[40:43], s35 offen offset:1024 sc1
s_xor_b32 s35, s9, 65536
v_mfma_f32_16x16x32_bf16 v[144:147], a[124:127], a[8:11], v[144:147]
s_waitcnt vmcnt(10) lgkmcnt(4)
v_mfma_f32_16x16x32_bf16 v[132:135], a[128:131], a[16:19], v[132:135]
ds_read_b128 a[112:115], v5 offset:16384
v_mfma_f32_16x16x32_bf16 v[148:151], a[128:131], a[20:23], v[148:151]
ds_read_b128 a[116:119], v5 offset:17408
v_mfma_f32_16x16x32_bf16 v[152:155], a[132:135], a[20:23], v[152:155]
buffer_load_dwordx4 a[8:11], v4, s[40:43], s35 offen offset:0 sc1
v_mfma_f32_16x16x32_bf16 v[136:139], a[132:135], a[16:19], v[136:139]
ds_read_b128 a[120:123], v5 offset:18432
v_mfma_f32_16x16x32_bf16 v[140:143], a[136:139], a[16:19], v[140:143]
ds_read_b128 a[124:127], v5 offset:19456
v_mfma_f32_16x16x32_bf16 v[156:159], a[136:139], a[20:23], v[156:159]
v_mfma_f32_16x16x32_bf16 v[160:163], a[140:143], a[20:23], v[160:163]
buffer_load_dwordx4 a[12:15], v4, s[40:43], s35 offen offset:1024 sc1
s_xor_b32 s35, s9, 69632
v_mfma_f32_16x16x32_bf16 v[144:147], a[140:143], a[16:19], v[144:147]
s_waitcnt vmcnt(10) lgkmcnt(4)
v_mfma_f32_16x16x32_bf16 v[132:135], a[96:99], a[24:27], v[132:135]
ds_read_b128 a[128:131], v5 offset:20480
v_mfma_f32_16x16x32_bf16 v[148:151], a[96:99], a[28:31], v[148:151]
ds_read_b128 a[132:135], v5 offset:21504
v_mfma_f32_16x16x32_bf16 v[152:155], a[100:103], a[28:31], v[152:155]
buffer_load_dwordx4 a[16:19], v4, s[40:43], s35 offen offset:0 sc1
v_mfma_f32_16x16x32_bf16 v[136:139], a[100:103], a[24:27], v[136:139]
ds_read_b128 a[136:139], v5 offset:22528
v_mfma_f32_16x16x32_bf16 v[140:143], a[104:107], a[24:27], v[140:143]
ds_read_b128 a[140:143], v5 offset:23552
v_mfma_f32_16x16x32_bf16 v[156:159], a[104:107], a[28:31], v[156:159]
v_mfma_f32_16x16x32_bf16 v[160:163], a[108:111], a[28:31], v[160:163]
buffer_load_dwordx4 a[20:23], v4, s[40:43], s35 offen offset:1024 sc1
s_xor_b32 s35, s9, 81920
v_mfma_f32_16x16x32_bf16 v[144:147], a[108:111], a[24:27], v[144:147]
s_waitcnt vmcnt(10) lgkmcnt(4)
v_mfma_f32_16x16x32_bf16 v[132:135], a[112:115], a[32:35], v[132:135]
ds_read_b128 a[96:99], v5 offset:24576
v_mfma_f32_16x16x32_bf16 v[148:151], a[112:115], a[36:39], v[148:151]
ds_read_b128 a[100:103], v5 offset:25600
v_mfma_f32_16x16x32_bf16 v[152:155], a[116:119], a[36:39], v[152:155]
buffer_load_dwordx4 a[24:27], v4, s[40:43], s35 offen offset:0 sc1
v_mfma_f32_16x16x32_bf16 v[136:139], a[116:119], a[32:35], v[136:139]
ds_read_b128 a[104:107], v5 offset:26624
v_mfma_f32_16x16x32_bf16 v[140:143], a[120:123], a[32:35], v[140:143]
ds_read_b128 a[108:111], v5 offset:27648
v_mfma_f32_16x16x32_bf16 v[156:159], a[120:123], a[36:39], v[156:159]
v_mfma_f32_16x16x32_bf16 v[160:163], a[124:127], a[36:39], v[160:163]
buffer_load_dwordx4 a[28:31], v4, s[40:43], s35 offen offset:1024 sc1
s_xor_b32 s35, s9, 86016
v_mfma_f32_16x16x32_bf16 v[144:147], a[124:127], a[32:35], v[144:147]
s_waitcnt vmcnt(10) lgkmcnt(4)
v_mfma_f32_16x16x32_bf16 v[132:135], a[128:131], a[40:43], v[132:135]
ds_read_b128 a[112:115], v5 offset:28672
v_mfma_f32_16x16x32_bf16 v[148:151], a[128:131], a[44:47], v[148:151]
ds_read_b128 a[116:119], v5 offset:29696
v_mfma_f32_16x16x32_bf16 v[152:155], a[132:135], a[44:47], v[152:155]
buffer_load_dwordx4 a[32:35], v4, s[40:43], s35 offen offset:0 sc1
v_mfma_f32_16x16x32_bf16 v[136:139], a[132:135], a[40:43], v[136:139]
ds_read_b128 a[120:123], v5 offset:30720
v_mfma_f32_16x16x32_bf16 v[140:143], a[136:139], a[40:43], v[140:143]
ds_read_b128 a[124:127], v5 offset:31744
v_mfma_f32_16x16x32_bf16 v[156:159], a[136:139], a[44:47], v[156:159]
v_mfma_f32_16x16x32_bf16 v[160:163], a[140:143], a[44:47], v[160:163]
buffer_load_dwordx4 a[36:39], v4, s[40:43], s35 offen offset:1024 sc1
s_xor_b32 s35, s9, 98304
v_mfma_f32_16x16x32_bf16 v[144:147], a[140:143], a[40:43], v[144:147]
s_waitcnt vmcnt(10) lgkmcnt(4)
v_mfma_f32_16x16x32_bf16 v[132:135], a[96:99], a[48:51], v[132:135]
ds_read_b128 a[128:131], v5 offset:32768
v_mfma_f32_16x16x32_bf16 v[148:151], a[96:99], a[52:55], v[148:151]
ds_read_b128 a[132:135], v5 offset:33792
v_mfma_f32_16x16x32_bf16 v[152:155], a[100:103], a[52:55], v[152:155]
buffer_load_dwordx4 a[40:43], v4, s[40:43], s35 offen offset:0 sc1
v_mfma_f32_16x16x32_bf16 v[136:139], a[100:103], a[48:51], v[136:139]
ds_read_b128 a[136:139], v5 offset:34816
v_mfma_f32_16x16x32_bf16 v[140:143], a[104:107], a[48:51], v[140:143]
ds_read_b128 a[140:143], v5 offset:35840
v_mfma_f32_16x16x32_bf16 v[156:159], a[104:107], a[52:55], v[156:159]
v_mfma_f32_16x16x32_bf16 v[160:163], a[108:111], a[52:55], v[160:163]
buffer_load_dwordx4 a[44:47], v4, s[40:43], s35 offen offset:1024 sc1
s_xor_b32 s35, s9, 102400
v_mfma_f32_16x16x32_bf16 v[144:147], a[108:111], a[48:51], v[144:147]
s_waitcnt vmcnt(10) lgkmcnt(4)
v_mfma_f32_16x16x32_bf16 v[132:135], a[112:115], a[0:3], v[132:135]
ds_read_b128 a[96:99], v5 offset:36864
v_mfma_f32_16x16x32_bf16 v[148:151], a[112:115], a[4:7], v[148:151]
ds_read_b128 a[100:103], v5 offset:37888
v_mfma_f32_16x16x32_bf16 v[152:155], a[116:119], a[4:7], v[152:155]
buffer_load_dwordx4 a[48:51], v4, s[40:43], s35 offen offset:0 sc1
v_mfma_f32_16x16x32_bf16 v[136:139], a[116:119], a[0:3], v[136:139]
ds_read_b128 a[104:107], v5 offset:38912
v_mfma_f32_16x16x32_bf16 v[140:143], a[120:123], a[0:3], v[140:143]
ds_read_b128 a[108:111], v5 offset:39936
v_mfma_f32_16x16x32_bf16 v[156:159], a[120:123], a[4:7], v[156:159]
v_mfma_f32_16x16x32_bf16 v[160:163], a[124:127], a[4:7], v[160:163]
buffer_load_dwordx4 a[52:55], v4, s[40:43], s35 offen offset:1024 sc1
s_xor_b32 s35, s9, 114688
v_mfma_f32_16x16x32_bf16 v[144:147], a[124:127], a[0:3], v[144:147]
s_waitcnt vmcnt(10) lgkmcnt(4)
v_mfma_f32_16x16x32_bf16 v[132:135], a[128:131], a[8:11], v[132:135]
ds_read_b128 a[112:115], v5 offset:40960
v_mfma_f32_16x16x32_bf16 v[148:151], a[128:131], a[12:15], v[148:151]
ds_read_b128 a[116:119], v5 offset:41984
v_mfma_f32_16x16x32_bf16 v[152:155], a[132:135], a[12:15], v[152:155]
buffer_load_dwordx4 a[0:3], v4, s[40:43], s35 offen offset:0 sc1
v_mfma_f32_16x16x32_bf16 v[136:139], a[132:135], a[8:11], v[136:139]
ds_read_b128 a[120:123], v5 offset:43008
v_mfma_f32_16x16x32_bf16 v[140:143], a[136:139], a[8:11], v[140:143]
ds_read_b128 a[124:127], v5 offset:44032
v_mfma_f32_16x16x32_bf16 v[156:159], a[136:139], a[12:15], v[156:159]
v_mfma_f32_16x16x32_bf16 v[160:163], a[140:143], a[12:15], v[160:163]
buffer_load_dwordx4 a[4:7], v4, s[40:43], s35 offen offset:1024 sc1
s_xor_b32 s35, s9, 118784
v_mfma_f32_16x16x32_bf16 v[144:147], a[140:143], a[8:11], v[144:147]
s_waitcnt vmcnt(10) lgkmcnt(4)
v_mfma_f32_16x16x32_bf16 v[132:135], a[96:99], a[16:19], v[132:135]
ds_read_b128 a[128:131], v5 offset:45056
v_mfma_f32_16x16x32_bf16 v[148:151], a[96:99], a[20:23], v[148:151]
ds_read_b128 a[132:135], v5 offset:46080
v_mfma_f32_16x16x32_bf16 v[152:155], a[100:103], a[20:23], v[152:155]
buffer_load_dwordx4 a[8:11], v4, s[40:43], s35 offen offset:0 sc1
v_mfma_f32_16x16x32_bf16 v[136:139], a[100:103], a[16:19], v[136:139]
ds_read_b128 a[136:139], v5 offset:47104
v_mfma_f32_16x16x32_bf16 v[140:143], a[104:107], a[16:19], v[140:143]
ds_read_b128 a[140:143], v5 offset:48128
v_mfma_f32_16x16x32_bf16 v[156:159], a[104:107], a[20:23], v[156:159]
v_mfma_f32_16x16x32_bf16 v[160:163], a[108:111], a[20:23], v[160:163]
buffer_load_dwordx4 a[12:15], v4, s[40:43], s35 offen offset:1024 sc1
s_xor_b32 s35, s9, 524288
v_mfma_f32_16x16x32_bf16 v[144:147], a[108:111], a[16:19], v[144:147]
s_waitcnt vmcnt(10) lgkmcnt(4)
v_mfma_f32_16x16x32_bf16 v[132:135], a[112:115], a[24:27], v[132:135]
ds_read_b128 a[96:99], v5 offset:49152
v_mfma_f32_16x16x32_bf16 v[148:151], a[112:115], a[28:31], v[148:151]
ds_read_b128 a[100:103], v5 offset:50176
v_mfma_f32_16x16x32_bf16 v[152:155], a[116:119], a[28:31], v[152:155]
buffer_load_dwordx4 a[16:19], v4, s[40:43], s35 offen offset:0 sc1
v_mfma_f32_16x16x32_bf16 v[136:139], a[116:119], a[24:27], v[136:139]
ds_read_b128 a[104:107], v5 offset:51200
v_mfma_f32_16x16x32_bf16 v[140:143], a[120:123], a[24:27], v[140:143]
ds_read_b128 a[108:111], v5 offset:52224
v_mfma_f32_16x16x32_bf16 v[156:159], a[120:123], a[28:31], v[156:159]
v_mfma_f32_16x16x32_bf16 v[160:163], a[124:127], a[28:31], v[160:163]
buffer_load_dwordx4 a[20:23], v4, s[40:43], s35 offen offset:1024 sc1
s_xor_b32 s35, s9, 528384
v_mfma_f32_16x16x32_bf16 v[144:147], a[124:127], a[24:27], v[144:147]
s_waitcnt vmcnt(10) lgkmcnt(4)
v_mfma_f32_16x16x32_bf16 v[132:135], a[128:131], a[32:35], v[132:135]
ds_read_b128 a[112:115], v5 offset:53248
v_mfma_f32_16x16x32_bf16 v[148:151], a[128:131], a[36:39], v[148:151]
ds_read_b128 a[116:119], v5 offset:54272
v_mfma_f32_16x16x32_bf16 v[152:155], a[132:135], a[36:39], v[152:155]
buffer_load_dwordx4 a[24:27], v4, s[40:43], s35 offen offset:0 sc1
v_mfma_f32_16x16x32_bf16 v[136:139], a[132:135], a[32:35], v[136:139]
ds_read_b128 a[120:123], v5 offset:55296
v_mfma_f32_16x16x32_bf16 v[140:143], a[136:139], a[32:35], v[140:143]
ds_read_b128 a[124:127], v5 offset:56320
v_mfma_f32_16x16x32_bf16 v[156:159], a[136:139], a[36:39], v[156:159]
v_mfma_f32_16x16x32_bf16 v[160:163], a[140:143], a[36:39], v[160:163]
buffer_load_dwordx4 a[28:31], v4, s[40:43], s35 offen offset:1024 sc1
s_xor_b32 s35, s9, 540672
v_mfma_f32_16x16x32_bf16 v[144:147], a[140:143], a[32:35], v[144:147]
s_waitcnt vmcnt(10) lgkmcnt(4)
v_mfma_f32_16x16x32_bf16 v[132:135], a[96:99], a[40:43], v[132:135]
ds_read_b128 a[128:131], v5 offset:57344
v_mfma_f32_16x16x32_bf16 v[148:151], a[96:99], a[44:47], v[148:151]
ds_read_b128 a[132:135], v5 offset:58368
v_mfma_f32_16x16x32_bf16 v[152:155], a[100:103], a[44:47], v[152:155]
buffer_load_dwordx4 a[32:35], v4, s[40:43], s35 offen offset:0 sc1
v_mfma_f32_16x16x32_bf16 v[136:139], a[100:103], a[40:43], v[136:139]
ds_read_b128 a[136:139], v5 offset:59392
v_mfma_f32_16x16x32_bf16 v[140:143], a[104:107], a[40:43], v[140:143]
ds_read_b128 a[140:143], v5 offset:60416
v_mfma_f32_16x16x32_bf16 v[156:159], a[104:107], a[44:47], v[156:159]
v_mfma_f32_16x16x32_bf16 v[160:163], a[108:111], a[44:47], v[160:163]
buffer_load_dwordx4 a[36:39], v4, s[40:43], s35 offen offset:1024 sc1
s_xor_b32 s35, s9, 544768
v_mfma_f32_16x16x32_bf16 v[144:147], a[108:111], a[40:43], v[144:147]
s_waitcnt vmcnt(10) lgkmcnt(4)
v_mfma_f32_16x16x32_bf16 v[132:135], a[112:115], a[48:51], v[132:135]
ds_read_b128 a[96:99], v5 offset:61440
v_mfma_f32_16x16x32_bf16 v[148:151], a[112:115], a[52:55], v[148:151]
ds_read_b128 a[100:103], v5 offset:62464
v_mfma_f32_16x16x32_bf16 v[152:155], a[116:119], a[52:55], v[152:155]
buffer_load_dwordx4 a[40:43], v4, s[40:43], s35 offen offset:0 sc1
v_mfma_f32_16x16x32_bf16 v[136:139], a[116:119], a[48:51], v[136:139]
ds_read_b128 a[104:107], v5 offset:63488
v_mfma_f32_16x16x32_bf16 v[140:143], a[120:123], a[48:51], v[140:143]
ds_read_b128 a[108:111], v5 offset:64512
v_mfma_f32_16x16x32_bf16 v[156:159], a[120:123], a[52:55], v[156:159]
v_mfma_f32_16x16x32_bf16 v[160:163], a[124:127], a[52:55], v[160:163]
buffer_load_dwordx4 a[44:47], v4, s[40:43], s35 offen offset:1024 sc1
s_xor_b32 s35, s9, 557056
v_mfma_f32_16x16x32_bf16 v[144:147], a[124:127], a[48:51], v[144:147]
s_waitcnt vmcnt(10) lgkmcnt(4)
v_mfma_f32_16x16x32_bf16 v[132:135], a[128:131], a[0:3], v[132:135]
ds_read_b128 a[112:115], v6 offset:0
v_mfma_f32_16x16x32_bf16 v[148:151], a[128:131], a[4:7], v[148:151]
ds_read_b128 a[116:119], v6 offset:1024
v_mfma_f32_16x16x32_bf16 v[152:155], a[132:135], a[4:7], v[152:155]
buffer_load_dwordx4 a[48:51], v4, s[40:43], s35 offen offset:0 sc1
v_mfma_f32_16x16x32_bf16 v[136:139], a[132:135], a[0:3], v[136:139]
ds_read_b128 a[120:123], v6 offset:2048
v_mfma_f32_16x16x32_bf16 v[140:143], a[136:139], a[0:3], v[140:143]
ds_read_b128 a[124:127], v6 offset:3072
v_mfma_f32_16x16x32_bf16 v[156:159], a[136:139], a[4:7], v[156:159]
v_mfma_f32_16x16x32_bf16 v[160:163], a[140:143], a[4:7], v[160:163]
buffer_load_dwordx4 a[52:55], v4, s[40:43], s35 offen offset:1024 sc1
s_xor_b32 s35, s9, 561152
v_mfma_f32_16x16x32_bf16 v[144:147], a[140:143], a[0:3], v[144:147]
s_waitcnt vmcnt(10) lgkmcnt(4)
v_mfma_f32_16x16x32_bf16 v[132:135], a[96:99], a[8:11], v[132:135]
ds_read_b128 a[128:131], v6 offset:4096
v_mfma_f32_16x16x32_bf16 v[148:151], a[96:99], a[12:15], v[148:151]
ds_read_b128 a[132:135], v6 offset:5120
v_mfma_f32_16x16x32_bf16 v[152:155], a[100:103], a[12:15], v[152:155]
buffer_load_dwordx4 a[0:3], v4, s[40:43], s35 offen offset:0 sc1
v_mfma_f32_16x16x32_bf16 v[136:139], a[100:103], a[8:11], v[136:139]
ds_read_b128 a[136:139], v6 offset:6144
v_mfma_f32_16x16x32_bf16 v[140:143], a[104:107], a[8:11], v[140:143]
ds_read_b128 a[140:143], v6 offset:7168
v_mfma_f32_16x16x32_bf16 v[156:159], a[104:107], a[12:15], v[156:159]
v_mfma_f32_16x16x32_bf16 v[160:163], a[108:111], a[12:15], v[160:163]
buffer_load_dwordx4 a[4:7], v4, s[40:43], s35 offen offset:1024 sc1
s_xor_b32 s35, s9, 573440
v_mfma_f32_16x16x32_bf16 v[144:147], a[108:111], a[8:11], v[144:147]
s_waitcnt vmcnt(10) lgkmcnt(4)
v_mfma_f32_16x16x32_bf16 v[132:135], a[112:115], a[16:19], v[132:135]
ds_read_b128 a[96:99], v6 offset:8192
v_mfma_f32_16x16x32_bf16 v[148:151], a[112:115], a[20:23], v[148:151]
ds_read_b128 a[100:103], v6 offset:9216
v_mfma_f32_16x16x32_bf16 v[152:155], a[116:119], a[20:23], v[152:155]
buffer_load_dwordx4 a[8:11], v4, s[40:43], s35 offen offset:0 sc1
v_mfma_f32_16x16x32_bf16 v[136:139], a[116:119], a[16:19], v[136:139]
ds_read_b128 a[104:107], v6 offset:10240
v_mfma_f32_16x16x32_bf16 v[140:143], a[120:123], a[16:19], v[140:143]
ds_read_b128 a[108:111], v6 offset:11264
v_mfma_f32_16x16x32_bf16 v[156:159], a[120:123], a[20:23], v[156:159]
v_mfma_f32_16x16x32_bf16 v[160:163], a[124:127], a[20:23], v[160:163]
buffer_load_dwordx4 a[12:15], v4, s[40:43], s35 offen offset:1024 sc1
s_xor_b32 s35, s9, 577536
v_mfma_f32_16x16x32_bf16 v[144:147], a[124:127], a[16:19], v[144:147]
s_waitcnt vmcnt(10) lgkmcnt(4)
v_mfma_f32_16x16x32_bf16 v[132:135], a[128:131], a[24:27], v[132:135]
ds_read_b128 a[112:115], v6 offset:12288
v_mfma_f32_16x16x32_bf16 v[148:151], a[128:131], a[28:31], v[148:151]
ds_read_b128 a[116:119], v6 offset:13312
v_mfma_f32_16x16x32_bf16 v[152:155], a[132:135], a[28:31], v[152:155]
buffer_load_dwordx4 a[16:19], v4, s[40:43], s35 offen offset:0 sc1
v_mfma_f32_16x16x32_bf16 v[136:139], a[132:135], a[24:27], v[136:139]
ds_read_b128 a[120:123], v6 offset:14336
v_mfma_f32_16x16x32_bf16 v[140:143], a[136:139], a[24:27], v[140:143]
ds_read_b128 a[124:127], v6 offset:15360
v_mfma_f32_16x16x32_bf16 v[156:159], a[136:139], a[28:31], v[156:159]
v_mfma_f32_16x16x32_bf16 v[160:163], a[140:143], a[28:31], v[160:163]
buffer_load_dwordx4 a[20:23], v4, s[40:43], s35 offen offset:1024 sc1
s_xor_b32 s35, s9, 589824
v_mfma_f32_16x16x32_bf16 v[144:147], a[140:143], a[24:27], v[144:147]
s_waitcnt vmcnt(10) lgkmcnt(4)
v_mfma_f32_16x16x32_bf16 v[132:135], a[96:99], a[32:35], v[132:135]
ds_read_b128 a[128:131], v6 offset:16384
v_mfma_f32_16x16x32_bf16 v[148:151], a[96:99], a[36:39], v[148:151]
ds_read_b128 a[132:135], v6 offset:17408
v_mfma_f32_16x16x32_bf16 v[152:155], a[100:103], a[36:39], v[152:155]
buffer_load_dwordx4 a[24:27], v4, s[40:43], s35 offen offset:0 sc1
v_mfma_f32_16x16x32_bf16 v[136:139], a[100:103], a[32:35], v[136:139]
ds_read_b128 a[136:139], v6 offset:18432
v_mfma_f32_16x16x32_bf16 v[140:143], a[104:107], a[32:35], v[140:143]
ds_read_b128 a[140:143], v6 offset:19456
v_mfma_f32_16x16x32_bf16 v[156:159], a[104:107], a[36:39], v[156:159]
v_mfma_f32_16x16x32_bf16 v[160:163], a[108:111], a[36:39], v[160:163]
buffer_load_dwordx4 a[28:31], v4, s[40:43], s35 offen offset:1024 sc1
s_xor_b32 s35, s9, 593920
v_mfma_f32_16x16x32_bf16 v[144:147], a[108:111], a[32:35], v[144:147]
s_waitcnt vmcnt(10) lgkmcnt(4)
v_mfma_f32_16x16x32_bf16 v[132:135], a[112:115], a[40:43], v[132:135]
ds_read_b128 a[96:99], v6 offset:20480
v_mfma_f32_16x16x32_bf16 v[148:151], a[112:115], a[44:47], v[148:151]
ds_read_b128 a[100:103], v6 offset:21504
v_mfma_f32_16x16x32_bf16 v[152:155], a[116:119], a[44:47], v[152:155]
buffer_load_dwordx4 a[32:35], v4, s[40:43], s35 offen offset:0 sc1
v_mfma_f32_16x16x32_bf16 v[136:139], a[116:119], a[40:43], v[136:139]
ds_read_b128 a[104:107], v6 offset:22528
v_mfma_f32_16x16x32_bf16 v[140:143], a[120:123], a[40:43], v[140:143]
ds_read_b128 a[108:111], v6 offset:23552
v_mfma_f32_16x16x32_bf16 v[156:159], a[120:123], a[44:47], v[156:159]
v_mfma_f32_16x16x32_bf16 v[160:163], a[124:127], a[44:47], v[160:163]
buffer_load_dwordx4 a[36:39], v4, s[40:43], s35 offen offset:1024 sc1
s_xor_b32 s35, s9, 606208
v_mfma_f32_16x16x32_bf16 v[144:147], a[124:127], a[40:43], v[144:147]
s_waitcnt vmcnt(10) lgkmcnt(4)
v_mfma_f32_16x16x32_bf16 v[132:135], a[128:131], a[48:51], v[132:135]
ds_read_b128 a[112:115], v6 offset:24576
v_mfma_f32_16x16x32_bf16 v[148:151], a[128:131], a[52:55], v[148:151]
ds_read_b128 a[116:119], v6 offset:25600
v_mfma_f32_16x16x32_bf16 v[152:155], a[132:135], a[52:55], v[152:155]
buffer_load_dwordx4 a[40:43], v4, s[40:43], s35 offen offset:0 sc1
v_mfma_f32_16x16x32_bf16 v[136:139], a[132:135], a[48:51], v[136:139]
ds_read_b128 a[120:123], v6 offset:26624
v_mfma_f32_16x16x32_bf16 v[140:143], a[136:139], a[48:51], v[140:143]
ds_read_b128 a[124:127], v6 offset:27648
v_mfma_f32_16x16x32_bf16 v[156:159], a[136:139], a[52:55], v[156:159]
v_mfma_f32_16x16x32_bf16 v[160:163], a[140:143], a[52:55], v[160:163]
buffer_load_dwordx4 a[44:47], v4, s[40:43], s35 offen offset:1024 sc1
s_xor_b32 s35, s9, 610304
v_mfma_f32_16x16x32_bf16 v[144:147], a[140:143], a[48:51], v[144:147]
s_waitcnt vmcnt(10) lgkmcnt(4)
v_mfma_f32_16x16x32_bf16 v[132:135], a[96:99], a[0:3], v[132:135]
ds_read_b128 a[128:131], v6 offset:28672
v_mfma_f32_16x16x32_bf16 v[148:151], a[96:99], a[4:7], v[148:151]
ds_read_b128 a[132:135], v6 offset:29696
v_mfma_f32_16x16x32_bf16 v[152:155], a[100:103], a[4:7], v[152:155]
buffer_load_dwordx4 a[48:51], v4, s[40:43], s35 offen offset:0 sc1
v_mfma_f32_16x16x32_bf16 v[136:139], a[100:103], a[0:3], v[136:139]
ds_read_b128 a[136:139], v6 offset:30720
v_mfma_f32_16x16x32_bf16 v[140:143], a[104:107], a[0:3], v[140:143]
ds_read_b128 a[140:143], v6 offset:31744
v_mfma_f32_16x16x32_bf16 v[156:159], a[104:107], a[4:7], v[156:159]
v_mfma_f32_16x16x32_bf16 v[160:163], a[108:111], a[4:7], v[160:163]
buffer_load_dwordx4 a[52:55], v4, s[40:43], s35 offen offset:1024 sc1
s_xor_b32 s35, s9, 622592
v_mfma_f32_16x16x32_bf16 v[144:147], a[108:111], a[0:3], v[144:147]
s_waitcnt vmcnt(10) lgkmcnt(4)
v_mfma_f32_16x16x32_bf16 v[132:135], a[112:115], a[8:11], v[132:135]
ds_read_b128 a[96:99], v6 offset:32768
v_mfma_f32_16x16x32_bf16 v[148:151], a[112:115], a[12:15], v[148:151]
ds_read_b128 a[100:103], v6 offset:33792
v_mfma_f32_16x16x32_bf16 v[152:155], a[116:119], a[12:15], v[152:155]
buffer_load_dwordx4 a[0:3], v4, s[40:43], s35 offen offset:0 sc1
v_mfma_f32_16x16x32_bf16 v[136:139], a[116:119], a[8:11], v[136:139]
ds_read_b128 a[104:107], v6 offset:34816
v_mfma_f32_16x16x32_bf16 v[140:143], a[120:123], a[8:11], v[140:143]
ds_read_b128 a[108:111], v6 offset:35840
v_mfma_f32_16x16x32_bf16 v[156:159], a[120:123], a[12:15], v[156:159]
v_mfma_f32_16x16x32_bf16 v[160:163], a[124:127], a[12:15], v[160:163]
buffer_load_dwordx4 a[4:7], v4, s[40:43], s35 offen offset:1024 sc1
s_xor_b32 s35, s9, 626688
v_mfma_f32_16x16x32_bf16 v[144:147], a[124:127], a[8:11], v[144:147]
s_waitcnt vmcnt(10) lgkmcnt(4)
v_mfma_f32_16x16x32_bf16 v[132:135], a[128:131], a[16:19], v[132:135]
ds_read_b128 a[112:115], v6 offset:36864
v_mfma_f32_16x16x32_bf16 v[148:151], a[128:131], a[20:23], v[148:151]
ds_read_b128 a[116:119], v6 offset:37888
v_mfma_f32_16x16x32_bf16 v[152:155], a[132:135], a[20:23], v[152:155]
buffer_load_dwordx4 a[8:11], v4, s[40:43], s35 offen offset:0 sc1
v_mfma_f32_16x16x32_bf16 v[136:139], a[132:135], a[16:19], v[136:139]
ds_read_b128 a[120:123], v6 offset:38912
v_mfma_f32_16x16x32_bf16 v[140:143], a[136:139], a[16:19], v[140:143]
ds_read_b128 a[124:127], v6 offset:39936
v_mfma_f32_16x16x32_bf16 v[156:159], a[136:139], a[20:23], v[156:159]
v_mfma_f32_16x16x32_bf16 v[160:163], a[140:143], a[20:23], v[160:163]
buffer_load_dwordx4 a[12:15], v4, s[40:43], s35 offen offset:1024 sc1
s_xor_b32 s35, s9, 638976
v_mfma_f32_16x16x32_bf16 v[144:147], a[140:143], a[16:19], v[144:147]
s_waitcnt vmcnt(10) lgkmcnt(4)
v_mfma_f32_16x16x32_bf16 v[132:135], a[96:99], a[24:27], v[132:135]
ds_read_b128 a[128:131], v6 offset:40960
v_mfma_f32_16x16x32_bf16 v[148:151], a[96:99], a[28:31], v[148:151]
ds_read_b128 a[132:135], v6 offset:41984
v_mfma_f32_16x16x32_bf16 v[152:155], a[100:103], a[28:31], v[152:155]
buffer_load_dwordx4 a[16:19], v4, s[40:43], s35 offen offset:0 sc1
v_mfma_f32_16x16x32_bf16 v[136:139], a[100:103], a[24:27], v[136:139]
ds_read_b128 a[136:139], v6 offset:43008
v_mfma_f32_16x16x32_bf16 v[140:143], a[104:107], a[24:27], v[140:143]
ds_read_b128 a[140:143], v6 offset:44032
v_mfma_f32_16x16x32_bf16 v[156:159], a[104:107], a[28:31], v[156:159]
v_mfma_f32_16x16x32_bf16 v[160:163], a[108:111], a[28:31], v[160:163]
buffer_load_dwordx4 a[20:23], v4, s[40:43], s35 offen offset:1024 sc1
s_xor_b32 s35, s9, 643072
v_mfma_f32_16x16x32_bf16 v[144:147], a[108:111], a[24:27], v[144:147]
s_waitcnt vmcnt(10) lgkmcnt(4)
v_mfma_f32_16x16x32_bf16 v[132:135], a[112:115], a[32:35], v[132:135]
ds_read_b128 a[96:99], v6 offset:45056
v_mfma_f32_16x16x32_bf16 v[148:151], a[112:115], a[36:39], v[148:151]
ds_read_b128 a[100:103], v6 offset:46080
v_mfma_f32_16x16x32_bf16 v[152:155], a[116:119], a[36:39], v[152:155]
buffer_load_dwordx4 a[24:27], v4, s[40:43], s35 offen offset:0 sc1
v_mfma_f32_16x16x32_bf16 v[136:139], a[116:119], a[32:35], v[136:139]
ds_read_b128 a[104:107], v6 offset:47104
v_mfma_f32_16x16x32_bf16 v[140:143], a[120:123], a[32:35], v[140:143]
ds_read_b128 a[108:111], v6 offset:48128
v_mfma_f32_16x16x32_bf16 v[156:159], a[120:123], a[36:39], v[156:159]
v_mfma_f32_16x16x32_bf16 v[160:163], a[124:127], a[36:39], v[160:163]
buffer_load_dwordx4 a[28:31], v4, s[40:43], s35 offen offset:1024 sc1
s_xor_b32 s35, s9, 0
v_mfma_f32_16x16x32_bf16 v[144:147], a[124:127], a[32:35], v[144:147]
s_waitcnt vmcnt(10) lgkmcnt(4)
v_mfma_f32_16x16x32_bf16 v[132:135], a[128:131], a[40:43], v[132:135]
ds_read_b128 a[112:115], v6 offset:49152
v_mfma_f32_16x16x32_bf16 v[148:151], a[128:131], a[44:47], v[148:151]
ds_read_b128 a[116:119], v6 offset:50176
v_mfma_f32_16x16x32_bf16 v[152:155], a[132:135], a[44:47], v[152:155]
ds_read_b128 a[120:123], v6 offset:51200
v_mfma_f32_16x16x32_bf16 v[136:139], a[132:135], a[40:43], v[136:139]
ds_read_b128 a[124:127], v6 offset:52224
v_mfma_f32_16x16x32_bf16 v[140:143], a[136:139], a[40:43], v[140:143]
v_mfma_f32_16x16x32_bf16 v[156:159], a[136:139], a[44:47], v[156:159]
v_mfma_f32_16x16x32_bf16 v[160:163], a[140:143], a[44:47], v[160:163]
v_mfma_f32_16x16x32_bf16 v[144:147], a[140:143], a[40:43], v[144:147]
s_waitcnt vmcnt(8) lgkmcnt(4)
v_mfma_f32_16x16x32_bf16 v[132:135], a[96:99], a[48:51], v[132:135]
ds_read_b128 a[128:131], v6 offset:53248
v_mfma_f32_16x16x32_bf16 v[148:151], a[96:99], a[52:55], v[148:151]
ds_read_b128 a[132:135], v6 offset:54272
v_mfma_f32_16x16x32_bf16 v[152:155], a[100:103], a[52:55], v[152:155]
ds_read_b128 a[136:139], v6 offset:55296
v_mfma_f32_16x16x32_bf16 v[136:139], a[100:103], a[48:51], v[136:139]
ds_read_b128 a[140:143], v6 offset:56320
v_mfma_f32_16x16x32_bf16 v[140:143], a[104:107], a[48:51], v[140:143]
v_mfma_f32_16x16x32_bf16 v[156:159], a[104:107], a[52:55], v[156:159]
v_mfma_f32_16x16x32_bf16 v[160:163], a[108:111], a[52:55], v[160:163]
v_mfma_f32_16x16x32_bf16 v[144:147], a[108:111], a[48:51], v[144:147]
s_waitcnt vmcnt(6) lgkmcnt(4)
v_mfma_f32_16x16x32_bf16 v[132:135], a[112:115], a[0:3], v[132:135]
ds_read_b128 a[96:99], v6 offset:57344
v_mfma_f32_16x16x32_bf16 v[148:151], a[112:115], a[4:7], v[148:151]
ds_read_b128 a[100:103], v6 offset:58368
v_mfma_f32_16x16x32_bf16 v[152:155], a[116:119], a[4:7], v[152:155]
ds_read_b128 a[104:107], v6 offset:59392
v_mfma_f32_16x16x32_bf16 v[136:139], a[116:119], a[0:3], v[136:139]
ds_read_b128 a[108:111], v6 offset:60416
v_mfma_f32_16x16x32_bf16 v[140:143], a[120:123], a[0:3], v[140:143]
v_mfma_f32_16x16x32_bf16 v[156:159], a[120:123], a[4:7], v[156:159]
v_mfma_f32_16x16x32_bf16 v[160:163], a[124:127], a[4:7], v[160:163]
v_mfma_f32_16x16x32_bf16 v[144:147], a[124:127], a[0:3], v[144:147]
s_waitcnt vmcnt(4) lgkmcnt(4)
v_mfma_f32_16x16x32_bf16 v[132:135], a[128:131], a[8:11], v[132:135]
ds_read_b128 a[112:115], v6 offset:61440
v_mfma_f32_16x16x32_bf16 v[148:151], a[128:131], a[12:15], v[148:151]
ds_read_b128 a[116:119], v6 offset:62464
v_mfma_f32_16x16x32_bf16 v[152:155], a[132:135], a[12:15], v[152:155]
ds_read_b128 a[120:123], v6 offset:63488
v_mfma_f32_16x16x32_bf16 v[136:139], a[132:135], a[8:11], v[136:139]
ds_read_b128 a[124:127], v6 offset:64512
v_mfma_f32_16x16x32_bf16 v[140:143], a[136:139], a[8:11], v[140:143]
v_mfma_f32_16x16x32_bf16 v[156:159], a[136:139], a[12:15], v[156:159]
v_mfma_f32_16x16x32_bf16 v[160:163], a[140:143], a[12:15], v[160:163]
v_mfma_f32_16x16x32_bf16 v[144:147], a[140:143], a[8:11], v[144:147]
s_waitcnt vmcnt(2) lgkmcnt(4)
v_mfma_f32_16x16x32_bf16 v[132:135], a[96:99], a[16:19], v[132:135]
v_mfma_f32_16x16x32_bf16 v[148:151], a[96:99], a[20:23], v[148:151]
v_mfma_f32_16x16x32_bf16 v[152:155], a[100:103], a[20:23], v[152:155]
v_mfma_f32_16x16x32_bf16 v[136:139], a[100:103], a[16:19], v[136:139]
v_mfma_f32_16x16x32_bf16 v[140:143], a[104:107], a[16:19], v[140:143]
v_mfma_f32_16x16x32_bf16 v[156:159], a[104:107], a[20:23], v[156:159]
v_mfma_f32_16x16x32_bf16 v[160:163], a[108:111], a[20:23], v[160:163]
v_mfma_f32_16x16x32_bf16 v[144:147], a[108:111], a[16:19], v[144:147]
s_waitcnt vmcnt(0) lgkmcnt(0)
v_mfma_f32_16x16x32_bf16 v[132:135], a[112:115], a[24:27], v[132:135]
v_mfma_f32_16x16x32_bf16 v[148:151], a[112:115], a[28:31], v[148:151]
v_mfma_f32_16x16x32_bf16 v[152:155], a[116:119], a[28:31], v[152:155]
v_mfma_f32_16x16x32_bf16 v[136:139], a[116:119], a[24:27], v[136:139]
v_mfma_f32_16x16x32_bf16 v[140:143], a[120:123], a[24:27], v[140:143]
v_mfma_f32_16x16x32_bf16 v[156:159], a[120:123], a[28:31], v[156:159]
v_mfma_f32_16x16x32_bf16 v[160:163], a[124:127], a[28:31], v[160:163]
v_mfma_f32_16x16x32_bf16 v[144:147], a[124:127], a[24:27], v[144:147]
s_nop 1
v_cmp_u_f32 vcc, v132, v148
s_nop 0
s_and_b32 vcc_lo, vcc_lo, s95
s_cbranch_scc1 L_k2redo3
s_and_b32 s36, s31, 7
s_lshl_b32 s36, s36, 7
s_lshl_b32 s37, s28, 5
s_add_u32 s36, s36, s37
s_lshl_b32 s36, s36, 1
s_lshr_b32 s37, s31, 3
s_add_u32 s36, s36, s37
s_lshl_b32 s36, s36, 11
s_lshl_b32 s37, s32, 7
v_and_b32 v234, 15, v0
s_add_u32 s36, s36, s37
v_lshrrev_b32 v233, 4, v0
v_lshl_add_u32 v232, v234, 12, s36
v_cvt_pk_bf16_f32 v32, v132, v133
v_cvt_pk_bf16_f32 v33, v134, v135
v_cvt_pk_bf16_f32 v34, v136, v137
v_cvt_pk_bf16_f32 v35, v138, v139
v_lshl_add_u32 v232, v233, 4, v232
buffer_store_dwordx4 v[32:35], v232, s[12:15], 0 offen offset:0
v_cvt_pk_bf16_f32 v36, v140, v141
v_cvt_pk_bf16_f32 v37, v142, v143
v_cvt_pk_bf16_f32 v38, v144, v145
v_cvt_pk_bf16_f32 v39, v146, v147
v_cvt_pk_bf16_f32 v40, v148, v149
v_cvt_pk_bf16_f32 v41, v150, v151
v_cvt_pk_bf16_f32 v42, v152, v153
v_cvt_pk_bf16_f32 v43, v154, v155
s_mov_b32 s36, 0x10000
v_cvt_pk_bf16_f32 v44, v156, v157
v_cvt_pk_bf16_f32 v45, v158, v159
v_cvt_pk_bf16_f32 v46, v160, v161
buffer_store_dwordx4 v[36:39], v232, s[12:15], 0 offen offset:64
v_cvt_pk_bf16_f32 v47, v162, v163
buffer_store_dwordx4 v[40:43], v232, s[12:15], s36 offen offset:0
buffer_store_dwordx4 v[44:47], v232, s[12:15], s36 offen offset:64
s_or_b32 s36, s2, s28
s_cbranch_scc1 Lep_50
s_mov_b32 s36, 0xf0000
buffer_store_dword v15, off, s[4:7], s36 sc1
Lep_50:
L_end:
s_endpgm
Ltal_5:
s_mov_b32 s53, 0
Ltal_5b:
s_sleep 8
buffer_load_dword v11, v1, s[24:27], 0 offen sc1
s_add_u32 s53, s53, 1
s_waitcnt vmcnt(0)
v_cmp_gt_u32 vcc, 0x100000, v11
s_nop 0
s_and_b32 vcc_lo, vcc_lo, 0x1f3f
s_cbranch_scc0 Ltab_6
s_cmp_lt_u32 s53, 0x100000
s_cbranch_scc1 Ltal_5b
s_branch Ltab_6
L_hxredo0:
s_mov_b32 s37, 0
L_hxredo0b:
s_sleep 2
buffer_load_dwordx4 v[228:231], v9, s[4:7], s55 offen sc1
buffer_load_dwordx4 v[72:75], v9, s[4:7], s55 offen offset:1024 sc1
s_waitcnt vmcnt(1)
v_max3_u32 v244, v228, v229, v230
s_waitcnt vmcnt(0)
v_max3_u32 v244, v244, v231, v72
v_max3_u32 v244, v244, v73, v74
v_max_u32 v244, v244, v75
v_cmp_eq_u32 vcc, -1, v244
s_cbranch_vccz L_hxback0
s_add_u32 s37, s37, 1
s_cmp_lt_u32 s37, 0x100000
s_cbranch_scc1 L_hxredo0b
s_branch L_hxback0
Ltr_12:
s_add_u32 s52, s67, 0xe0000
s_mov_b32 s53, 0
Ltp_13:
s_sleep 2
v_mov_b32 v11, v15
s_mov_b64 exec, 0xffff
v_mov_b32 v11, 0
buffer_atomic_add v11, v255, s[4:7], s52 offen sc0 sc1
s_mov_b64 exec, -1
s_add_u32 s53, s53, 1
s_waitcnt vmcnt(0)
v_cmp_ne_u32 vcc, v11, v15
s_cbranch_vccz Lte_14
s_cmp_lt_u32 s53, 0x100000
s_cbranch_scc1 Ltp_13
s_branch Lte_14
Ltr_15:
s_add_u32 s52, s66, 0xd0040
s_mov_b32 s53, 0
Ltp_16:
s_sleep 2
v_mov_b32 v232, v15
s_mov_b64 exec, 0xffff
v_mov_b32 v232, 0
buffer_atomic_add v232, v255, s[4:7], s52 offen sc0 sc1
s_mov_b64 exec, -1
s_add_u32 s53, s53, 1
s_waitcnt vmcnt(0)
v_cmp_ne_u32 vcc, v232, v15
s_cbranch_vccz Lte_17
s_cmp_lt_u32 s53, 0x100000
s_cbranch_scc1 Ltp_16
s_branch Lte_17
L_kvredo1:
s_mov_b32 s88, 0
L_kvredo1b:
v_max_u32 v132, v48, v49
v_max3_u32 v132, v132, v50, v51
v_max3_u32 v132, v132, v52, v53
v_max3_u32 v132, v132, v54, v55
v_max3_u32 v132, v132, v56, v57
v_max3_u32 v132, v132, v58, v59
v_max3_u32 v132, v132, v60, v61
v_max3_u32 v132, v132, v62, v63
v_max3_u32 v132, v132, v64, v65
v_max3_u32 v132, v132, v66, v67
v_max3_u32 v132, v132, v68, v69
v_max3_u32 v132, v132, v70, v71
v_max3_u32 v132, v132, v100, v101
v_max3_u32 v132, v132, v102, v103
v_max3_u32 v132, v132, v104, v105
v_max3_u32 v132, v132, v106, v107
v_max3_u32 v132, v132, v124, v125
v_max3_u32 v132, v132, v126, v127
v_cmp_eq_u32 vcc, -1, v132
s_cbranch_vccz L_kvback1
s_add_u32 s88, s88, 1
s_cmp_gt_u32 s88, 0x80000
s_cbranch_scc1 L_kvback1
s_sleep 4
buffer_load_dwordx4 v[48:51], v1, s[4:7], s98 offen offset:0 sc1
buffer_load_dwordx4 v[124:127], v248, s[4:7], s100 offen sc1
buffer_load_dwordx4 v[52:55], v1, s[4:7], s98 offen offset:1024 sc1
buffer_load_dwordx4 v[56:59], v1, s[4:7], s98 offen offset:2048 sc1
buffer_load_dwordx4 v[60:63], v1, s[4:7], s98 offen offset:3072 sc1
buffer_load_dwordx4 v[64:67], v1, s[4:7], s99 offen offset:0 sc1
buffer_load_dwordx4 v[68:71], v1, s[4:7], s99 offen offset:1024 sc1
buffer_load_dwordx4 v[100:103], v1, s[4:7], s99 offen offset:2048 sc1
buffer_load_dwordx4 v[104:107], v1, s[4:7], s99 offen offset:3072 sc1
s_waitcnt vmcnt(8)
v_lshlrev_b32 v92, 16, v48
v_and_b32 v93, 0xffff0000, v48
v_lshlrev_b32 v94, 16, v49
v_and_b32 v95, 0xffff0000, v49
v_lshlrev_b32 v96, 16, v50
v_and_b32 v97, 0xffff0000, v50
v_lshlrev_b32 v98, 16, v51
v_and_b32 v99, 0xffff0000, v51
s_waitcnt vmcnt(7)
v_add_f32_dpp v128, v124, v124 row_ror:4 row_mask:0xf bank_mask:0xf
v_add_f32_dpp v129, v125, v125 row_ror:4 row_mask:0xf bank_mask:0xf
v_add_f32_dpp v130, v126, v126 row_ror:4 row_mask:0xf bank_mask:0xf
v_add_f32_dpp v131, v127, v127 row_ror:4 row_mask:0xf bank_mask:0xf
v_add_f32_dpp v128, v128, v128 row_ror:2 row_mask:0xf bank_mask:0xf
v_add_f32_dpp v129, v129, v129 row_ror:2 row_mask:0xf bank_mask:0xf
v_add_f32_dpp v130, v130, v130 row_ror:2 row_mask:0xf bank_mask:0xf
v_add_f32_dpp v131, v131, v131 row_ror:2 row_mask:0xf bank_mask:0xf
v_add_f32_dpp v128, v128, v128 row_ror:1 row_mask:0xf bank_mask:0xf
v_add_f32_dpp v129, v129, v129 row_ror:1 row_mask:0xf bank_mask:0xf
v_add_f32_dpp v130, v130, v130 row_ror:1 row_mask:0xf bank_mask:0xf
v_add_f32_dpp v131, v131, v131 row_ror:1 row_mask:0xf bank_mask:0xf
s_waitcnt vmcnt(6)
v_dot2c_f32_bf16 v92, v52, v249
v_dot2c_f32_bf16 v93, v52, v250
v_dot2c_f32_bf16 v94, v53, v249
v_dot2c_f32_bf16 v95, v53, v250
v_dot2c_f32_bf16 v96, v54, v249
v_dot2c_f32_bf16 v97, v54, v250
v_dot2c_f32_bf16 v98, v55, v249
v_dot2c_f32_bf16 v99, v55, v250
s_waitcnt vmcnt(5)
v_dot2c_f32_bf16 v92, v56, v249
v_dot2c_f32_bf16 v93, v56, v250
v_dot2c_f32_bf16 v94, v57, v249
v_dot2c_f32_bf16 v95, v57, v250
v_dot2c_f32_bf16 v96, v58, v249
v_dot2c_f32_bf16 v97, v58, v250
v_dot2c_f32_bf16 v98, v59, v249
v_dot2c_f32_bf16 v99, v59, v250
s_waitcnt vmcnt(4)
v_dot2c_f32_bf16 v92, v60, v249
v_dot2c_f32_bf16 v93, v60, v250
v_dot2c_f32_bf16 v94, v61, v249
v_dot2c_f32_bf16 v95, v61, v250
v_dot2c_f32_bf16 v96, v62, v249
v_dot2c_f32_bf16 v97, v62, v250
v_dot2c_f32_bf16 v98, v63, v249
v_dot2c_f32_bf16 v99, v63, v250
s_waitcnt vmcnt(3)
v_dot2c_f32_bf16 v92, v64, v249
v_dot2c_f32_bf16 v93, v64, v250
v_dot2c_f32_bf16 v94, v65, v249
v_dot2c_f32_bf16 v95, v65, v250
v_dot2c_f32_bf16 v96, v66, v249
v_dot2c_f32_bf16 v97, v66, v250
v_dot2c_f32_bf16 v98, v67, v249
v_dot2c_f32_bf16 v99, v67, v250
s_waitcnt vmcnt(2)
v_dot2c_f32_bf16 v92, v68, v249
v_dot2c_f32_bf16 v93, v68, v250
v_dot2c_f32_bf16 v94, v69, v249
v_dot2c_f32_bf16 v95, v69, v250
v_dot2c_f32_bf16 v96, v70, v249
v_dot2c_f32_bf16 v97, v70, v250
v_dot2c_f32_bf16 v98, v71, v249
v_dot2c_f32_bf16 v99, v71, v250
s_waitcnt vmcnt(1)
v_dot2c_f32_bf16 v92, v100, v249
v_dot2c_f32_bf16 v93, v100, v250
v_dot2c_f32_bf16 v94, v101, v249
v_dot2c_f32_bf16 v95, v101, v250
v_dot2c_f32_bf16 v96, v102, v249
v_dot2c_f32_bf16 v97, v102, v250
v_dot2c_f32_bf16 v98, v103, v249
v_dot2c_f32_bf16 v99, v103, v250
s_waitcnt vmcnt(0)
v_dot2c_f32_bf16 v92, v104, v249
v_dot2c_f32_bf16 v93, v104, v250
v_dot2c_f32_bf16 v94, v105, v249
v_dot2c_f32_bf16 v95, v105, v250
v_dot2c_f32_bf16 v96, v106, v249
v_dot2c_f32_bf16 v97, v106, v250
v_dot2c_f32_bf16 v98, v107, v249
v_dot2c_f32_bf16 v99, v107, v250
s_nop 2
s_branch L_kvredo1b
L_k2redo1:
s_mov_b32 s95, 0
s_mov_b32 s92, 0x40000000
s_mov_b32 s93, 0x40000000
s_mov_b32 s94, 0x40000000
s_mov_b32 s37, 0
L_k2redo1a:
s_sleep 4
v_mov_b32 v108, 0
s_mov_b32 s36, 0
L_k2redo1b:
s_lshr_b32 s39, s36, 3
s_mul_i32 s39, s39, 524288
s_and_b32 s38, s36, 7
s_lshl_b32 s38, s38, 14
s_add_u32 s38, s38, s39
s_xor_b32 s38, s38, s9
s_add_u32 s39, s38, 4096
buffer_load_dwordx4 v[92:95], v4, s[40:43], s38 offen offset:0 sc1
buffer_load_dwordx4 v[96:99], v4, s[40:43], s38 offen offset:1024 sc1
buffer_load_dwordx4 v[100:103], v4, s[40:43], s39 offen offset:0 sc1
buffer_load_dwordx4 v[104:107], v4, s[40:43], s39 offen offset:1024 sc1
s_waitcnt vmcnt(3)
v_max3_u32 v108, v108, v92, v93
v_max3_u32 v108, v108, v94, v95
s_waitcnt vmcnt(2)
v_max3_u32 v108, v108, v96, v97
v_max3_u32 v108, v108, v98, v99
s_waitcnt vmcnt(1)
v_max3_u32 v108, v108, v100, v101
v_max3_u32 v108, v108, v102, v103
s_waitcnt vmcnt(0)
v_max3_u32 v108, v108, v104, v105
v_max3_u32 v108, v108, v106, v107
s_add_u32 s36, s36, 1
s_cmp_lt_u32 s36, 16
s_cbranch_scc1 L_k2redo1b
v_cmp_eq_u32 vcc, -1, v108
s_cbranch_vccz L_k2redo1c
s_add_u32 s37, s37, 1
s_cmp_lt_u32 s37, 0x8000
s_cbranch_scc1 L_k2redo1a
L_k2redo1c:
s_nop 7
s_mov_b32 s35, s9
v_lshlrev_b32 v132, 16, v32
v_and_b32 v133, 0xffff0000, v32
v_lshlrev_b32 v134, 16, v33
v_and_b32 v135, 0xffff0000, v33
v_lshlrev_b32 v136, 16, v34
v_and_b32 v137, 0xffff0000, v34
v_lshlrev_b32 v138, 16, v35
v_and_b32 v139, 0xffff0000, v35
v_lshlrev_b32 v140, 16, v36
v_and_b32 v141, 0xffff0000, v36
v_lshlrev_b32 v142, 16, v37
v_and_b32 v143, 0xffff0000, v37
v_lshlrev_b32 v144, 16, v38
v_and_b32 v145, 0xffff0000, v38
v_lshlrev_b32 v146, 16, v39
v_and_b32 v147, 0xffff0000, v39
v_lshlrev_b32 v148, 16, v40
v_and_b32 v149, 0xffff0000, v40
v_lshlrev_b32 v150, 16, v41
v_and_b32 v151, 0xffff0000, v41
v_lshlrev_b32 v152, 16, v42
v_and_b32 v153, 0xffff0000, v42
v_lshlrev_b32 v154, 16, v43
v_and_b32 v155, 0xffff0000, v43
v_lshlrev_b32 v156, 16, v44
v_and_b32 v157, 0xffff0000, v44
v_lshlrev_b32 v158, 16, v45
v_and_b32 v159, 0xffff0000, v45
v_lshlrev_b32 v160, 16, v46
v_and_b32 v161, 0xffff0000, v46
v_lshlrev_b32 v162, 16, v47
v_and_b32 v163, 0xffff0000, v47
s_branch L_k2go1
L_hxredo2:
s_mov_b32 s37, 0
L_hxredo2b:
s_sleep 2
buffer_load_dwordx4 v[228:231], v9, s[4:7], s55 offen sc1
buffer_load_dwordx4 v[72:75], v9, s[4:7], s55 offen offset:1024 sc1
s_waitcnt vmcnt(1)
v_max3_u32 v244, v228, v229, v230
s_waitcnt vmcnt(0)
v_max3_u32 v244, v244, v231, v72
v_max3_u32 v244, v244, v73, v74
v_max_u32 v244, v244, v75
v_cmp_eq_u32 vcc, -1, v244
s_cbranch_vccz L_hxback2
s_add_u32 s37, s37, 1
s_cmp_lt_u32 s37, 0x100000
s_cbranch_scc1 L_hxredo2b
s_branch L_hxback2
L_k2redo2:
s_mov_b32 s95, 0
s_mov_b32 s92, 0x40000000
s_mov_b32 s93, 0x40000000
s_mov_b32 s94, 0x40000000
s_mov_b32 s37, 0
L_k2redo2a:
s_sleep 4
v_mov_b32 v108, 0
s_mov_b32 s36, 0
L_k2redo2b:
s_lshr_b32 s39, s36, 3
s_mul_i32 s39, s39, 524288
s_and_b32 s38, s36, 7
s_lshl_b32 s38, s38, 14
s_add_u32 s38, s38, s39
s_xor_b32 s38, s38, s77
s_add_u32 s39, s38, 4096
buffer_load_dwordx4 v[92:95], v4, s[40:43], s38 offen offset:0 sc1
buffer_load_dwordx4 v[96:99], v4, s[40:43], s38 offen offset:1024 sc1
buffer_load_dwordx4 v[100:103], v4, s[40:43], s39 offen offset:0 sc1
buffer_load_dwordx4 v[104:107], v4, s[40:43], s39 offen offset:1024 sc1
s_waitcnt vmcnt(3)
v_max3_u32 v108, v108, v92, v93
v_max3_u32 v108, v108, v94, v95
s_waitcnt vmcnt(2)
v_max3_u32 v108, v108, v96, v97
v_max3_u32 v108, v108, v98, v99
s_waitcnt vmcnt(1)
v_max3_u32 v108, v108, v100, v101
v_max3_u32 v108, v108, v102, v103
s_waitcnt vmcnt(0)
v_max3_u32 v108, v108, v104, v105
v_max3_u32 v108, v108, v106, v107
s_add_u32 s36, s36, 1
s_cmp_lt_u32 s36, 16
s_cbranch_scc1 L_k2redo2b
v_cmp_eq_u32 vcc, -1, v108
s_cbranch_vccz L_k2redo2c
s_add_u32 s37, s37, 1
s_cmp_lt_u32 s37, 0x8000
s_cbranch_scc1 L_k2redo2a
L_k2redo2c:
s_nop 7
s_mov_b32 s35, s77
v_lshlrev_b32 v132, 16, v32
v_and_b32 v133, 0xffff0000, v32
v_lshlrev_b32 v134, 16, v33
v_and_b32 v135, 0xffff0000, v33
v_lshlrev_b32 v136, 16, v34
v_and_b32 v137, 0xffff0000, v34
v_lshlrev_b32 v138, 16, v35
v_and_b32 v139, 0xffff0000, v35
v_lshlrev_b32 v140, 16, v36
v_and_b32 v141, 0xffff0000, v36
v_lshlrev_b32 v142, 16, v37
v_and_b32 v143, 0xffff0000, v37
v_lshlrev_b32 v144, 16, v38
v_and_b32 v145, 0xffff0000, v38
v_lshlrev_b32 v146, 16, v39
v_and_b32 v147, 0xffff0000, v39
v_lshlrev_b32 v148, 16, v40
v_and_b32 v149, 0xffff0000, v40
v_lshlrev_b32 v150, 16, v41
v_and_b32 v151, 0xffff0000, v41
v_lshlrev_b32 v152, 16, v42
v_and_b32 v153, 0xffff0000, v42
v_lshlrev_b32 v154, 16, v43
v_and_b32 v155, 0xffff0000, v43
v_lshlrev_b32 v156, 16, v44
v_and_b32 v157, 0xffff0000, v44
v_lshlrev_b32 v158, 16, v45
v_and_b32 v159, 0xffff0000, v45
v_lshlrev_b32 v160, 16, v46
v_and_b32 v161, 0xffff0000, v46
v_lshlrev_b32 v162, 16, v47
v_and_b32 v163, 0xffff0000, v47
s_branch L_k2go2
L_kvredo3:
s_mov_b32 s88, 0
L_kvredo3b:
v_max_u32 v132, v48, v49
v_max3_u32 v132, v132, v50, v51
v_max3_u32 v132, v132, v52, v53
v_max3_u32 v132, v132, v54, v55
v_max3_u32 v132, v132, v56, v57
v_max3_u32 v132, v132, v58, v59
v_max3_u32 v132, v132, v60, v61
v_max3_u32 v132, v132, v62, v63
v_max3_u32 v132, v132, v64, v65
v_max3_u32 v132, v132, v66, v67
v_max3_u32 v132, v132, v68, v69
v_max3_u32 v132, v132, v70, v71
v_max3_u32 v132, v132, v100, v101
v_max3_u32 v132, v132, v102, v103
v_max3_u32 v132, v132, v104, v105
v_max3_u32 v132, v132, v106, v107
v_max3_u32 v132, v132, v124, v125
v_max3_u32 v132, v132, v126, v127
v_cmp_eq_u32 vcc, -1, v132
s_cbranch_vccz L_kvback3
s_add_u32 s88, s88, 1
s_cmp_gt_u32 s88, 0x80000
s_cbranch_scc1 L_kvback3
s_sleep 4
buffer_load_dwordx4 v[48:51], v1, s[4:7], s98 offen offset:0 sc1
buffer_load_dwordx4 v[124:127], v248, s[4:7], s100 offen sc1
buffer_load_dwordx4 v[52:55], v1, s[4:7], s98 offen offset:1024 sc1
buffer_load_dwordx4 v[56:59], v1, s[4:7], s98 offen offset:2048 sc1
buffer_load_dwordx4 v[60:63], v1, s[4:7], s98 offen offset:3072 sc1
buffer_load_dwordx4 v[64:67], v1, s[4:7], s99 offen offset:0 sc1
buffer_load_dwordx4 v[68:71], v1, s[4:7], s99 offen offset:1024 sc1
buffer_load_dwordx4 v[100:103], v1, s[4:7], s99 offen offset:2048 sc1
buffer_load_dwordx4 v[104:107], v1, s[4:7], s99 offen offset:3072 sc1
s_waitcnt vmcnt(8)
v_lshlrev_b32 v92, 16, v48
v_and_b32 v93, 0xffff0000, v48
v_lshlrev_b32 v94, 16, v49
v_and_b32 v95, 0xffff0000, v49
v_lshlrev_b32 v96, 16, v50
v_and_b32 v97, 0xffff0000, v50
v_lshlrev_b32 v98, 16, v51
v_and_b32 v99, 0xffff0000, v51
s_waitcnt vmcnt(7)
v_add_f32_dpp v128, v124, v124 row_ror:4 row_mask:0xf bank_mask:0xf
v_add_f32_dpp v129, v125, v125 row_ror:4 row_mask:0xf bank_mask:0xf
v_add_f32_dpp v130, v126, v126 row_ror:4 row_mask:0xf bank_mask:0xf
v_add_f32_dpp v131, v127, v127 row_ror:4 row_mask:0xf bank_mask:0xf
v_add_f32_dpp v128, v128, v128 row_ror:2 row_mask:0xf bank_mask:0xf
v_add_f32_dpp v129, v129, v129 row_ror:2 row_mask:0xf bank_mask:0xf
v_add_f32_dpp v130, v130, v130 row_ror:2 row_mask:0xf bank_mask:0xf
v_add_f32_dpp v131, v131, v131 row_ror:2 row_mask:0xf bank_mask:0xf
v_add_f32_dpp v128, v128, v128 row_ror:1 row_mask:0xf bank_mask:0xf
v_add_f32_dpp v129, v129, v129 row_ror:1 row_mask:0xf bank_mask:0xf
v_add_f32_dpp v130, v130, v130 row_ror:1 row_mask:0xf bank_mask:0xf
v_add_f32_dpp v131, v131, v131 row_ror:1 row_mask:0xf bank_mask:0xf
s_waitcnt vmcnt(6)
v_dot2c_f32_bf16 v92, v52, v249
v_dot2c_f32_bf16 v93, v52, v250
v_dot2c_f32_bf16 v94, v53, v249
v_dot2c_f32_bf16 v95, v53, v250
v_dot2c_f32_bf16 v96, v54, v249
v_dot2c_f32_bf16 v97, v54, v250
v_dot2c_f32_bf16 v98, v55, v249
v_dot2c_f32_bf16 v99, v55, v250
s_waitcnt vmcnt(5)
v_dot2c_f32_bf16 v92, v56, v249
v_dot2c_f32_bf16 v93, v56, v250
v_dot2c_f32_bf16 v94, v57, v249
v_dot2c_f32_bf16 v95, v57, v250
v_dot2c_f32_bf16 v96, v58, v249
v_dot2c_f32_bf16 v97, v58, v250
v_dot2c_f32_bf16 v98, v59, v249
v_dot2c_f32_bf16 v99, v59, v250
s_waitcnt vmcnt(4)
v_dot2c_f32_bf16 v92, v60, v249
v_dot2c_f32_bf16 v93, v60, v250
v_dot2c_f32_bf16 v94, v61, v249
v_dot2c_f32_bf16 v95, v61, v250
v_dot2c_f32_bf16 v96, v62, v249
v_dot2c_f32_bf16 v97, v62, v250
v_dot2c_f32_bf16 v98, v63, v249
v_dot2c_f32_bf16 v99, v63, v250
s_waitcnt vmcnt(3)
v_dot2c_f32_bf16 v92, v64, v249
v_dot2c_f32_bf16 v93, v64, v250
v_dot2c_f32_bf16 v94, v65, v249
v_dot2c_f32_bf16 v95, v65, v250
v_dot2c_f32_bf16 v96, v66, v249
v_dot2c_f32_bf16 v97, v66, v250
v_dot2c_f32_bf16 v98, v67, v249
v_dot2c_f32_bf16 v99, v67, v250
s_waitcnt vmcnt(2)
v_dot2c_f32_bf16 v92, v68, v249
v_dot2c_f32_bf16 v93, v68, v250
v_dot2c_f32_bf16 v94, v69, v249
v_dot2c_f32_bf16 v95, v69, v250
v_dot2c_f32_bf16 v96, v70, v249
v_dot2c_f32_bf16 v97, v70, v250
v_dot2c_f32_bf16 v98, v71, v249
v_dot2c_f32_bf16 v99, v71, v250
s_waitcnt vmcnt(1)
v_dot2c_f32_bf16 v92, v100, v249
v_dot2c_f32_bf16 v93, v100, v250
v_dot2c_f32_bf16 v94, v101, v249
v_dot2c_f32_bf16 v95, v101, v250
v_dot2c_f32_bf16 v96, v102, v249
v_dot2c_f32_bf16 v97, v102, v250
v_dot2c_f32_bf16 v98, v103, v249
v_dot2c_f32_bf16 v99, v103, v250
s_waitcnt vmcnt(0)
v_dot2c_f32_bf16 v92, v104, v249
v_dot2c_f32_bf16 v93, v104, v250
v_dot2c_f32_bf16 v94, v105, v249
v_dot2c_f32_bf16 v95, v105, v250
v_dot2c_f32_bf16 v96, v106, v249
v_dot2c_f32_bf16 v97, v106, v250
v_dot2c_f32_bf16 v98, v107, v249
v_dot2c_f32_bf16 v99, v107, v250
s_nop 2
s_branch L_kvredo3b
L_k2redo3:
s_mov_b32 s95, 0
s_mov_b32 s92, 0x40000000
s_mov_b32 s93, 0x40000000
s_mov_b32 s94, 0x40000000
s_mov_b32 s37, 0
L_k2redo3a:
s_sleep 4
v_mov_b32 v108, 0
s_mov_b32 s36, 0
L_k2redo3b:
s_lshr_b32 s39, s36, 3
s_mul_i32 s39, s39, 524288
s_and_b32 s38, s36, 7
s_lshl_b32 s38, s38, 14
s_add_u32 s38, s38, s39
s_xor_b32 s38, s38, s9
s_add_u32 s39, s38, 4096
buffer_load_dwordx4 v[92:95], v4, s[40:43], s38 offen offset:0 sc1
buffer_load_dwordx4 v[96:99], v4, s[40:43], s38 offen offset:1024 sc1
buffer_load_dwordx4 v[100:103], v4, s[40:43], s39 offen offset:0 sc1
buffer_load_dwordx4 v[104:107], v4, s[40:43], s39 offen offset:1024 sc1
s_waitcnt vmcnt(3)
v_max3_u32 v108, v108, v92, v93
v_max3_u32 v108, v108, v94, v95
s_waitcnt vmcnt(2)
v_max3_u32 v108, v108, v96, v97
v_max3_u32 v108, v108, v98, v99
s_waitcnt vmcnt(1)
v_max3_u32 v108, v108, v100, v101
v_max3_u32 v108, v108, v102, v103
s_waitcnt vmcnt(0)
v_max3_u32 v108, v108, v104, v105
v_max3_u32 v108, v108, v106, v107
s_add_u32 s36, s36, 1
s_cmp_lt_u32 s36, 16
s_cbranch_scc1 L_k2redo3b
v_cmp_eq_u32 vcc, -1, v108
s_cbranch_vccz L_k2redo3c
s_add_u32 s37, s37, 1
s_cmp_lt_u32 s37, 0x8000
s_cbranch_scc1 L_k2redo3a
L_k2redo3c:
s_nop 7
s_mov_b32 s35, s9
v_lshlrev_b32 v132, 16, v32
v_and_b32 v133, 0xffff0000, v32
v_lshlrev_b32 v134, 16, v33
v_and_b32 v135, 0xffff0000, v33
v_lshlrev_b32 v136, 16, v34
v_and_b32 v137, 0xffff0000, v34
v_lshlrev_b32 v138, 16, v35
v_and_b32 v139, 0xffff0000, v35
v_lshlrev_b32 v140, 16, v36
v_and_b32 v141, 0xffff0000, v36
v_lshlrev_b32 v142, 16, v37
v_and_b32 v143, 0xffff0000, v37
v_lshlrev_b32 v144, 16, v38
v_and_b32 v145, 0xffff0000, v38
v_lshlrev_b32 v146, 16, v39
v_and_b32 v147, 0xffff0000, v39
v_lshlrev_b32 v148, 16, v40
v_and_b32 v149, 0xffff0000, v40
v_lshlrev_b32 v150, 16, v41
v_and_b32 v151, 0xffff0000, v41
v_lshlrev_b32 v152, 16, v42
v_and_b32 v153, 0xffff0000, v42
v_lshlrev_b32 v154, 16, v43
v_and_b32 v155, 0xffff0000, v43
v_lshlrev_b32 v156, 16, v44
v_and_b32 v157, 0xffff0000, v44
v_lshlrev_b32 v158, 16, v45
v_and_b32 v159, 0xffff0000, v45
v_lshlrev_b32 v160, 16, v46
v_and_b32 v161, 0xffff0000, v46
v_lshlrev_b32 v162, 16, v47
v_and_b32 v163, 0xffff0000, v47
s_branch L_k2go3
L_code_end:
.section .rodata,"a"
.p2align 6
.amdhsa_kernel interleave_layers__sliding_local_dilated__linear_kernel_hedgehog__prompt_kernel
  .amdhsa_next_free_vgpr 512
  .amdhsa_next_free_sgpr 102
  .amdhsa_accum_offset 256
  .amdhsa_group_segment_fixed_size 0
  .amdhsa_kernarg_size 80
  .amdhsa_user_sgpr_count 2
  .amdhsa_user_sgpr_kernarg_segment_ptr 1
  .amdhsa_system_sgpr_workgroup_id_x 1
.end_amdhsa_kernel
```

```asm
; @launch grid=(256,1,1) block=(256,1,1) lds=163840
.amdgcn_target "amdgcn-amd-amdhsa--gfx950"
.text
.globl interleave_layers__sliding_local_dilated__linear_kernel_hedgehog__prompt_kernel
.p2align 8
.type interleave_layers__sliding_local_dilated__linear_kernel_hedgehog__prompt_kernel,@function
interleave_layers__sliding_local_dilated__linear_kernel_hedgehog__prompt_kernel:
s_cmp_ge_u32 s2, 256
s_cbranch_scc1 L_end
s_load_dwordx16 s[64:79], s[0:1], 0
s_load_dwordx4 s[80:83], s[0:1], 64
s_getpc_b64 s[24:25]
s_mov_b32 s26, (L_end - interleave_layers__sliding_local_dilated__linear_kernel_hedgehog__prompt_kernel - 64)
s_mov_b32 s27, 0x20000
v_lshlrev_b32 v1, 5, v0
buffer_load_dword v238, v1, s[24:27], 0 offen
v_lshrrev_b32 v1, 6, v0
v_and_b32 v0, 63, v0
v_readfirstlane_b32 s28, v1
s_getreg_b32 s3, hwreg(HW_REG_XCC_ID, 0, 4)
s_sub_u32 s3, s3, s2
s_and_b32 s3, s3, 7
s_or_b32 s3, s3, 0x100
L_roles:
s_add_u32 s36, s2, s3
s_lshr_b32 s37, s2, 3
s_and_b32 s38, s37, 3
s_lshr_b32 s39, s37, 2
s_and_b32 s29, s36, 4
s_lshl_b32 s31, s29, 1
s_add_u32 s29, s29, s38
s_and_b32 s30, s36, 3
s_lshl_b32 s30, s30, 3
s_add_u32 s30, s30, s39
s_and_b32 s32, s36, 2
s_lshl_b32 s32, s32, 1
s_add_u32 s31, s31, s32
s_add_u32 s31, s31, s38
s_and_b32 s32, s36, 1
s_lshl_b32 s32, s32, 3
s_add_u32 s32, s32, s39
s_and_b32 s35, s2, 7
s_lshl_b32 s35, s35, 5
s_add_u32 s35, s35, s37
v_lshlrev_b32 v1, 4, v0
v_lshrrev_b32 v233, 4, v0
v_and_b32 v234, 15, v0
s_and_b32 s88, s31, 7
s_lshl_b32 s88, s88, 7
s_lshl_b32 s37, s28, 5
s_add_u32 s88, s88, s37
s_lshl_b32 s88, s88, 1
s_lshr_b32 s37, s31, 3
s_add_u32 s88, s88, s37
s_lshl_b32 s88, s88, 11
s_lshl_b32 s37, s32, 7
s_add_u32 s88, s88, s37
v_lshrrev_b32 v235, 3, v0
v_and_b32 v236, 7, v0
v_xor_b32 v232, v236, v233
v_lshlrev_b32 v232, 4, v232
v_lshl_add_u32 v232, v235, 12, v232
v_xor_b32 v246, 64, v232
v_lshlrev_b32 v236, 4, v236
v_lshl_add_u32 v237, v235, 11, v236
v_mul_u32_u24 v235, 6144, v235
v_add_u32 v235, v235, v236
s_lshr_b32 s36, s35, 4
s_lshl_b32 s36, s36, 2
s_add_u32 s36, s36, s28
s_mul_i32 s36, s36, 98304
s_and_b32 s37, s35, 15
s_lshl_b32 s37, s37, 7
s_add_u32 s36, s36, s37
s_lshl_b32 s37, s28, 11
s_mov_b32 s39, 0x10000
s_mov_b32 s10, 0x400000
s_mov_b32 s11, 0x20000
s_mov_b32 s22, 0x600000
s_mov_b32 s23, 0x20000
s_mov_b32 s6, 0x10000000
s_mov_b32 s7, 0x20000
s_mov_b32 s44, 0xf0000
s_waitcnt lgkmcnt(0)
s_lshr_b32 s38, s2, 3
s_or_b32 s38, s38, s28
s_cbranch_scc1 Lrp_1
s_mov_b32 s40, s80
s_mov_b32 s41, s81
s_mov_b32 s42, 0x100
s_mov_b32 s43, 0x20000
v_mov_b32 v240, s3
v_mov_b32 v241, 0
s_mov_b64 exec, 1
buffer_atomic_cmpswap v[240:241], off, s[40:43], 0 offset:252 sc1
s_mov_b64 exec, -1
Lrp_1:
s_mov_b64 s[8:9], s[64:65]
s_mov_b64 s[20:21], s[66:67]
s_lshl_b32 s39, s37, 1
s_add_u32 m0, s37, 0
s_add_u32 s38, s36, 0
buffer_load_dwordx4 v235, s[20:23], s38 offen nt lds
s_add_u32 m0, s37, 1024
s_add_u32 s38, s36, 49152
buffer_load_dwordx4 v235, s[20:23], s38 offen nt lds
s_add_u32 m0, s37, 8192
s_add_u32 s38, s36, 2048
buffer_load_dwordx4 v235, s[20:23], s38 offen nt lds
s_add_u32 m0, s37, 9216
s_add_u32 s38, s36, 51200
buffer_load_dwordx4 v235, s[20:23], s38 offen nt lds
s_add_u32 m0, s37, 16384
s_add_u32 s38, s36, 4096
buffer_load_dwordx4 v235, s[20:23], s38 offen nt lds
s_add_u32 m0, s37, 17408
s_add_u32 s38, s36, 53248
buffer_load_dwordx4 v235, s[20:23], s38 offen nt lds
s_add_u32 m0, s39, 24576
s_add_u32 s38, s88, 0
buffer_load_dwordx4 v232, s[8:11], s38 offen nt lds
s_add_u32 m0, s39, 25600
s_add_u32 s38, s88, 32768
buffer_load_dwordx4 v246, s[8:11], s38 offen nt lds
s_add_u32 m0, s39, 26624
s_add_u32 s38, s88, 65536
buffer_load_dwordx4 v232, s[8:11], s38 offen nt lds
s_add_u32 m0, s39, 27648
s_add_u32 s38, s88, 98304
buffer_load_dwordx4 v246, s[8:11], s38 offen nt lds
s_mov_b32 s37, s39
v_lshrrev_b32 v232, 1, v234
v_xor_b32 v232, v232, v233
v_lshlrev_b32 v232, 4, v232
v_lshl_add_u32 v232, v234, 7, v232
v_add_u32 v232, s37, v232
s_add_u32 s4, s82, 0x0
s_addc_u32 s5, s83, 0
s_mov_b64 s[92:93], s[80:81]
s_mov_b32 s12, s78
s_mov_b32 s13, s79
s_mov_b32 s14, 0x400000
s_mov_b32 s15, 0x20000
s_mov_b32 s42, 0x400000
s_mov_b32 s43, 0x20000
v_mov_b32 v12, 1
s_mov_b64 s[40:41], s[12:13]
s_mov_b32 s64, 0xff
s_mov_b32 s65, 0
s_and_b32 s81, s29, 3
s_lshl_b32 s66, s31, 4
s_add_u32 s66, s66, s32
s_lshl_b32 s66, s66, 8
s_lshl_b32 s67, s29, 5
s_add_u32 s67, s67, s30
s_lshl_b32 s67, s67, 8
s_lshl_b32 s80, s30, 11
s_lshl_b32 s70, s29, 8
s_add_u32 s70, s70, s80
s_lshl_b32 s71, s29, 13
s_lshr_b32 s78, s31, 1
s_lshl_b32 s78, s78, 13
s_add_u32 s79, s78, 8192
s_bitcmp1_b32 s31, 0
s_cselect_b32 s79, s79, 0x40000000
s_and_b32 s36, s31, 7
s_cmp_eq_u32 s36, 7
s_cselect_b32 s79, 0x40000000, s79
v_mov_b32 v240, 0
v_mov_b32 v241, 0
v_mov_b32 v242, 0
v_mov_b32 v243, 0
v_mov_b32 v228, v235
v_mov_b32 v229, v237
s_lshr_b32 s36, s35, 4
s_lshl_b32 s36, s36, 2
s_add_u32 s36, s36, s28
s_and_b32 s37, s35, 15
s_lshl_b32 s37, s37, 7
s_lshl_b32 s16, s36, 15
s_add_u32 s16, s16, s37
s_mul_i32 s17, s36, 98304
s_add_u32 s17, s17, s37
v_mov_b32 v16, 0x3f803f80
v_mov_b32 v17, 0x3f803f80
v_mov_b32 v18, 0x3f803f80
v_mov_b32 v19, 0x3f803f80
s_mov_b32 s46, 0xaaaaaaaa
s_mov_b32 s47, 0xaaaaaaaa
s_mov_b32 s48, 0xcccccccc
s_mov_b32 s49, 0xcccccccc
s_lshl_b32 s36, s31, 1
s_lshr_b32 s37, s28, 1
s_add_u32 s36, s36, s37
s_mul_i32 s36, s36, 131072
s_and_b32 s37, s28, 1
s_lshl_b32 s37, s37, 11
s_add_u32 s36, s36, s37
v_add_u32 v4, s36, v1
s_lshl_b32 s38, s31, 2
s_add_u32 s38, s38, s28
s_lshl_b32 s38, s38, 12
s_lshl_b32 s39, s32, 7
s_add_u32 s38, s38, s39
v_lshrrev_b32 v244, 2, v234
v_cmp_eq_u32 vcc, v244, v233
v_and_b32 v244, 7, v234
v_lshl_add_u32 v244, v244, 4, s38
v_and_b32 v245, 8, v234
v_add_u32 v244, v244, v245
v_cndmask_b32 v253, 2.0, v244, vcc
v_lshlrev_b32 v244, 4, v233
v_lshl_add_u32 v244, v234, 6, v244
v_cmp_gt_u32 vcc, 2, v234
s_nop 1
v_cndmask_b32 v254, 2.0, v244, vcc
v_lshrrev_b32 v248, 4, v0
v_lshlrev_b32 v248, 10, v248
v_bfe_u32 v249, v0, 2, 2
v_lshl_add_u32 v248, v249, 7, v248
v_and_b32 v251, 3, v0
v_lshl_add_u32 v248, v251, 3, v248
s_lshr_b32 s36, s28, 1
s_lshl_b32 s36, s36, 6
s_and_b32 s37, s28, 1
s_mul_i32 s38, s37, 8224
s_add_u32 s38, s38, s36
s_mul_i32 s39, s37, 16352
s_add_u32 s39, s39, s36
v_add_u32 v249, s39, v248
v_add_u32 v248, s38, v248
s_and_b32 s38, s35, 15
s_lshl_b32 s38, s38, 1
s_lshr_b32 s36, s28, 1
s_add_u32 s38, s38, s36
s_lshr_b32 s36, s35, 4
s_mul_i32 s96, s38, 196608
s_lshr_b32 s44, s36, 3
s_mul_i32 s44, s44, 98304
s_add_u32 s96, s96, s44
s_add_u32 s96, s96, 0x2000000
s_and_b32 s44, s36, 7
s_mul_i32 s97, s44, 12288
s_mul_i32 s44, s37, 3072
s_add_u32 s97, s97, s44
s_mul_i32 s38, s38, 6
s_mul_i32 s37, s37, 3
s_add_u32 s38, s38, s37
s_lshl_b32 s38, s38, 11
s_lshl_b32 s36, s36, 7
s_add_u32 s38, s38, s36
s_add_u32 s98, s38, 0x1800000
s_add_u32 s99, s98, 4096
v_lshrrev_b32 v247, 2, v0
v_lshlrev_b32 v250, 7, v247
v_lshl_add_u32 v250, v251, 4, v250
s_lshr_b32 s36, s28, 1
s_lshl_b32 s36, s36, 12
s_and_b32 s37, s28, 1
s_lshl_b32 s37, s37, 6
s_add_u32 s36, s36, s37
s_add_u32 s36, s36, 147456
v_add_u32 v250, s36, v250
v_subrev_u32 v230, 122880, v250
s_and_b32 s36, s35, 15
s_lshl_b32 s36, s36, 17
s_lshr_b32 s37, s35, 4
s_lshl_b32 s37, s37, 13
s_add_u32 s36, s36, s37
s_lshl_b32 s37, s28, 11
s_add_u32 s36, s36, s37
s_add_u32 s100, s36, 0x1a00000
s_add_u32 s101, s36, 0x1c00000
v_lshlrev_b32 v247, 6, v247
v_lshl_add_u32 v251, v251, 3, v247
v_add_u32 v251, 155648, v251
v_xor_b32 v236, 64, v232
s_mov_b32 s94, 256
s_mov_b32 s95, 0x20000
buffer_load_dword v245, off, s[92:95], 0 offset:252 sc1
s_mov_b64 s[20:21], s[68:69]
s_mov_b32 s22, 0x200000
s_lshl_b32 s37, s28, 11
s_add_u32 m0, s37, 147456
s_add_u32 s36, s16, 0
buffer_load_dwordx4 v229, s[20:23], s36 offen nt lds
s_add_u32 m0, s37, 148480
s_add_u32 s36, s16, 16384
buffer_load_dwordx4 v229, s[20:23], s36 offen nt lds
s_add_u32 s36, s67, 0xc0000
s_add_u32 s37, s66, 0xd0000
s_cmp_eq_u32 s28, 2
s_cselect_b32 s36, s37, s36
s_cmp_eq_u32 s28, 1
s_cselect_b32 s37, 128, 0
s_add_u32 s36, s36, s37
s_cmp_eq_u32 s28, 3
s_cselect_b32 s37, 0x20000, 0
s_add_u32 s36, s36, s37
s_mov_b64 exec, 1
buffer_atomic_add v240, off, s[4:7], s36 sc1
s_mov_b64 exec, -1
s_lshr_b32 s36, s2, 3
s_cmp_ge_u32 s36, 11
s_cselect_b32 s37, 11, 0
s_cselect_b32 s38, 8, 0
s_sub_u32 s51, s36, s37
s_and_b32 s37, s2, 7
s_add_u32 s37, s37, s38
s_lshl_b32 s37, s37, 8
s_lshl_b32 s34, s51, 21
s_add_u32 s34, s34, s37
s_add_u32 s34, s34, 0x1e0000
s_cmp_lt_u32 s36, 22
s_cselect_b32 s36, s28, 0
s_cmp_eq_u32 s36, 2
s_cselect_b32 s34, s34, 0x40000000
v_and_b32 v239, 2, v0
v_lshlrev_b32 v239, 12, v239
v_and_b32 v244, 1, v0
v_lshl_add_u32 v239, v244, 7, v239
s_mov_b64 exec, 15
buffer_atomic_add v240, v239, s[4:7], s34 offen sc1
s_mov_b64 exec, -1
s_mov_b32 s36, 0xf0000
buffer_load_dword v11, off, s[4:7], s36 sc1
s_lshr_b32 s36, s2, 3
s_lshl_b32 s36, s36, 2
s_add_u32 s36, s36, s28
s_lshl_b32 s36, s36, 10
buffer_load_dwordx4 a[0:3], v1, s[24:27], s36 offen
s_mov_b64 s[24:25], s[92:93]
s_mov_b32 s26, 256
s_mov_b64 s[20:21], s[74:75]
s_mov_b32 s22, 0x10000
s_and_b32 s36, s28, 1
s_lshl_b32 s36, s36, 10
s_add_u32 m0, s36, 155648
s_lshl_b32 s37, s30, 11
s_add_u32 s36, s36, s37
buffer_load_dwordx4 v1, s[20:23], s36 offen lds
s_waitcnt vmcnt(8)
s_waitcnt vmcnt(7)
v_readfirstlane_b32 s36, v245
s_nop 0
s_cmp_lg_u32 s36, s3
s_cbranch_scc1 L_rfix
L_rok:
ds_read_b128 v[32:35], v232 offset:24576
ds_read_b128 v[36:39], v236 offset:24576
ds_read_b128 v[40:43], v232 offset:26624
ds_read_b128 v[44:47], v236 offset:26624
s_barrier
ds_read_b64_tr_b16 a[188:189], v248 offset:0
ds_read_b64_tr_b16 a[190:191], v248 offset:512
ds_read_b64_tr_b16 a[192:193], v248 offset:4096
ds_read_b64_tr_b16 a[194:195], v248 offset:4608
ds_read_b64_tr_b16 a[196:197], v249 offset:32
ds_read_b64_tr_b16 a[198:199], v249 offset:544
ds_read_b64_tr_b16 a[200:201], v249 offset:4128
ds_read_b64_tr_b16 a[202:203], v249 offset:4640
ds_read_b64_tr_b16 a[204:205], v248 offset:8192
ds_read_b64_tr_b16 a[206:207], v248 offset:8704
ds_read_b64_tr_b16 a[208:209], v248 offset:12288
ds_read_b64_tr_b16 a[210:211], v248 offset:12800
s_lshl_b32 s36, s32, 13
s_add_u32 s37, s36, 4096
s_mov_b32 s38, 0x1700000
s_waitcnt lgkmcnt(14)
v_mfma_f32_16x16x32_bf16 v[96:99], v[32:35], v[32:35], 0
v_mfma_f32_16x16x32_bf16 v[92:95], v[16:19], v[32:35], 0
buffer_store_dwordx4 v[32:35], v4, s[12:15], s36 offen offset:0 sc1
s_waitcnt lgkmcnt(13)
v_mfma_f32_16x16x32_bf16 v[104:107], v[40:43], v[40:43], 0
v_mfma_f32_16x16x32_bf16 v[100:103], v[16:19], v[40:43], 0
buffer_store_dwordx4 v[40:43], v4, s[12:15], s36 offen offset:1024 sc1
v_mfma_f32_16x16x32_bf16 v[96:99], v[36:39], v[36:39], v[96:99]
v_mfma_f32_16x16x32_bf16 v[92:95], v[16:19], v[36:39], v[92:95]
buffer_store_dwordx4 v[36:39], v4, s[12:15], s37 offen offset:0 sc1
s_waitcnt lgkmcnt(12)
v_mfma_f32_16x16x32_bf16 v[104:107], v[44:47], v[44:47], v[104:107]
v_mfma_f32_16x16x32_bf16 v[100:103], v[16:19], v[44:47], v[100:103]
buffer_store_dwordx4 v[44:47], v4, s[12:15], s37 offen offset:1024 sc1
s_nop 1
v_cndmask_b32 v96, v96, v97, s[46:47]
v_cndmask_b32 v98, v98, v99, s[46:47]
v_cndmask_b32 v93, v96, v98, s[48:49]
buffer_store_dwordx2 v[92:93], v253, s[4:7], s38 offen offset:0 sc1
v_cndmask_b32 v104, v104, v105, s[46:47]
v_cndmask_b32 v106, v106, v107, s[46:47]
v_cndmask_b32 v101, v104, v106, s[48:49]
buffer_store_dwordx2 v[100:101], v253, s[4:7], s38 offen offset:2048 sc1
s_waitcnt lgkmcnt(10)
v_mfma_f32_16x16x32_bf16 v[108:111], a[188:191], v[16:19], 0
s_waitcnt lgkmcnt(6)
v_mfma_f32_16x16x32_bf16 v[112:115], a[196:199], v[16:19], 0
s_waitcnt lgkmcnt(2)
v_mfma_f32_16x16x32_bf16 v[116:119], a[204:207], v[16:19], 0
v_mfma_f32_16x16x32_bf16 v[108:111], a[192:195], v[16:19], v[108:111]
v_mfma_f32_16x16x32_bf16 v[112:115], a[200:203], v[16:19], v[112:115]
s_waitcnt lgkmcnt(0)
v_mfma_f32_16x16x32_bf16 v[116:119], a[208:211], v[16:19], v[116:119]
s_add_u32 s36, s97, 0
s_add_u32 s36, s36, s96
buffer_store_dwordx4 a[188:191], v1, s[4:7], s36 offen sc1
s_add_u32 s36, s97, 6144
s_add_u32 s36, s36, s96
buffer_store_dwordx4 a[192:195], v1, s[4:7], s36 offen sc1
s_add_u32 s36, s97, 1024
s_add_u32 s36, s36, s96
buffer_store_dwordx4 a[196:199], v1, s[4:7], s36 offen sc1
s_add_u32 s36, s97, 7168
s_add_u32 s36, s36, s96
buffer_store_dwordx4 a[200:203], v1, s[4:7], s36 offen sc1
s_add_u32 s36, s97, 2048
s_add_u32 s36, s36, s96
buffer_store_dwordx4 a[204:207], v1, s[4:7], s36 offen sc1
s_add_u32 s36, s97, 8192
s_add_u32 s36, s36, s96
buffer_store_dwordx4 a[208:211], v1, s[4:7], s36 offen sc1
buffer_store_dwordx4 v[108:111], v254, s[4:7], s98 offen offset:0 sc1
buffer_store_dwordx4 v[112:115], v254, s[4:7], s98 offen offset:2048 sc1
buffer_store_dwordx4 v[116:119], v254, s[4:7], s99 offen offset:0 sc1
v_lshlrev_b32 v239, 16, v233
v_lshl_add_u32 v239, v234, 4, v239
s_cmp_eq_u32 s28, 0
s_cselect_b32 s36, s66, s67
s_cmp_eq_u32 s28, 2
s_cselect_b32 s36, s70, s36
s_lshl_b32 s37, s28, 18
s_add_u32 s36, s36, s37
s_cmp_eq_u32 s28, 3
s_cselect_b32 s36, 0x40000000, s36
buffer_store_dwordx4 v[240:243], v239, s[4:7], s36 offen sc1
s_add_u32 s36, s36, 0x102000
buffer_store_dwordx4 v[240:243], v239, s[4:7], s36 offen sc1
s_waitcnt vmcnt(22)
s_barrier
ds_read_b64_tr_b16 a[212:213], v250 offset:0
ds_read_b64_tr_b16 a[214:215], v250 offset:2048
ds_read_b64_tr_b16 a[216:217], v250 offset:8
ds_read_b64_tr_b16 a[218:219], v250 offset:2056
s_waitcnt lgkmcnt(2)
buffer_store_dwordx4 a[212:215], v1, s[4:7], s100 offen offset:0 sc1
s_waitcnt lgkmcnt(0)
buffer_store_dwordx4 a[216:219], v1, s[4:7], s100 offen offset:1024 sc1
s_mov_b32 s56, 0x11111111
s_mov_b32 s57, 0x11111111
s_mov_b32 s58, 0x22222222
s_mov_b32 s59, 0x22222222
s_lshl_b32 s18, s28, 11
s_lshl_b32 s19, s28, 12
s_mul_i32 s50, s30, 196608
s_add_u32 s50, s50, s18
s_lshl_b32 s36, s32, 17
s_add_u32 s36, s36, s19
s_lshr_b32 s37, s30, 3
s_lshl_b32 s37, s37, 15
s_add_u32 s36, s36, s37
s_add_u32 s84, s36, 0x1a00000
s_add_u32 s85, s36, 0x1c00000
s_mul_i32 s55, s28, 6144
v_accvgpr_write_b32 a248, -1
v_accvgpr_write_b32 a249, -1
v_accvgpr_write_b32 a250, -1
v_accvgpr_write_b32 a251, -1
s_lshl_b32 s36, s29, 2
s_add_u32 s36, s36, s28
s_mul_i32 s37, s36, 131072
v_add_u32 v2, s37, v1
s_lshl_b32 s82, s36, 13
s_and_b32 s38, s29, 3
s_cmp_eq_u32 s38, 0
s_cselect_b32 s38, 0, 0x1f400
s_cselect_b32 s39, 0, 2048
s_cselect_b32 s54, 32, 48
s_lshl_b32 s37, s29, 19
s_sub_u32 s37, s37, s38
v_add_u32 v3, s37, v1
v_cmp_le_u32 vcc, 8, v234
s_nop 1
v_cndmask_b32 v3, 2.0, v3, vcc
s_lshl_b32 s37, s29, 15
s_sub_u32 s83, s37, s39
s_cmp_eq_u32 s28, 0
s_cselect_b32 vcc_lo, -1, 0
s_mov_b32 vcc_hi, 0
v_lshlrev_b32 v244, 8, v0
v_cndmask_b32 v10, 2.0, v244, vcc
v_and_b32 v244, 1, v233
v_lshl_add_u32 v244, v244, 3, v234
v_and_b32 v244, 15, v244
v_lshrrev_b32 v245, 1, v233
v_lshl_add_u32 v244, v245, 4, v244
v_lshrrev_b32 v245, 3, v234
v_lshl_add_u32 v244, v245, 5, v244
v_lshlrev_b32 v7, 3, v244
v_lshrrev_b32 v246, 2, v0
v_and_b32 v247, 3, v0
v_and_b32 v244, 1, v247
v_lshl_add_u32 v244, v244, 3, v246
v_and_b32 v244, 15, v244
v_lshrrev_b32 v245, 1, v247
v_lshl_add_u32 v244, v245, 4, v244
v_lshrrev_b32 v245, 3, v246
v_lshl_add_u32 v244, v245, 5, v244
v_lshlrev_b32 v8, 3, v244
s_and_b32 s36, s28, 1
s_lshl_b32 s37, s36, 3
s_add_u32 s37, s37, 20480
s_lshl_b32 s36, s36, 9
v_add_u32 v244, s37, v1
v_add_u32 v245, s36, v7
s_cmp_lt_u32 s28, 2
s_cselect_b64 vcc, -1, 0
v_cndmask_b32 v9, v245, v244, vcc
s_cmp_eq_u32 s28, 3
s_cselect_b64 vcc, -1, 0
v_cndmask_b32 v3, 2.0, v1, vcc
s_lshl_b32 s83, s67, 3
s_cmp_eq_u32 s54, 32
s_cselect_b32 s36, 1, s28
s_cmp_eq_u32 s36, 0
s_cselect_b64 vcc, -1, 0
v_cndmask_b32 v9, 2.0, v1, vcc
v_lshlrev_b32 v239, 2, v233
v_sub_u32 v239, v239, v234
v_mov_b32 v247, 0xf149f2ca
v_add_u32 v246, 7, v239
v_cmp_gt_u32 vcc, 8, v246
v_mov_b32 v244, 0xffff
s_nop 0
v_cndmask_b32 v24, v247, 0, vcc
v_cndmask_b32 v244, 0, v244, vcc
v_mov_b32 v30, v244
v_add_u32 v246, 0, v239
v_cmp_le_i32 vcc, 9, v246
v_mov_b32 v244, 0xffff
s_nop 0
v_cndmask_b32 v20, v247, 0, vcc
v_cndmask_b32 v244, 0, v244, vcc
v_mov_b32 v28, v244
v_add_u32 v246, 8, v239
v_cmp_gt_u32 vcc, 8, v246
v_mov_b32 v244, 0xffff0000
s_nop 0
v_cndmask_b32 v25, v247, 0, vcc
v_cndmask_b32 v244, 0, v244, vcc
v_or_b32 v30, v30, v244
v_add_u32 v246, 1, v239
v_cmp_le_i32 vcc, 9, v246
v_mov_b32 v244, 0xffff0000
s_nop 0
v_cndmask_b32 v21, v247, 0, vcc
v_cndmask_b32 v244, 0, v244, vcc
v_or_b32 v28, v28, v244
v_add_u32 v246, 9, v239
v_cmp_gt_u32 vcc, 8, v246
v_mov_b32 v244, 0xffff
s_nop 0
v_cndmask_b32 v26, v247, 0, vcc
v_cndmask_b32 v244, 0, v244, vcc
v_mov_b32 v31, v244
v_add_u32 v246, 2, v239
v_cmp_le_i32 vcc, 9, v246
v_mov_b32 v244, 0xffff
s_nop 0
v_cndmask_b32 v22, v247, 0, vcc
v_cndmask_b32 v244, 0, v244, vcc
v_mov_b32 v29, v244
v_add_u32 v246, 10, v239
v_cmp_gt_u32 vcc, 8, v246
v_mov_b32 v244, 0xffff0000
s_nop 0
v_cndmask_b32 v27, v247, 0, vcc
v_cndmask_b32 v244, 0, v244, vcc
v_or_b32 v31, v31, v244
v_add_u32 v246, 3, v239
v_cmp_le_i32 vcc, 9, v246
v_mov_b32 v244, 0xffff0000
s_nop 0
v_cndmask_b32 v23, v247, 0, vcc
v_cndmask_b32 v244, 0, v244, vcc
v_or_b32 v29, v29, v244
s_and_b32 s36, s29, 3
s_or_b32 s36, s36, s28
s_cmp_eq_u32 s36, 0
s_cselect_b64 vcc, -1, 0
v_cndmask_b32 v76, v20, v247, vcc
v_cndmask_b32 v77, v21, v247, vcc
v_cndmask_b32 v78, v22, v247, vcc
v_cndmask_b32 v79, v23, v247, vcc
v_cndmask_b32 v80, v28, 0, vcc
v_cndmask_b32 v81, v29, 0, vcc
s_add_u32 s91, s83, 0x1780000
buffer_store_dwordx4 a[248:251], v3, s[4:7], s91 offen offset:0 sc1
buffer_store_dwordx4 a[248:251], v3, s[4:7], s91 offen offset:1024 sc1
s_mov_b32 s36, 0x9e3779b1
s_waitcnt vmcnt(23)
v_mul_lo_u32 v15, v11, s36
v_add_u32 v15, 0x7f4a7c15, v15
s_and_b32 s36, s31, 1
s_lshl_b32 s36, s36, 4
s_add_u32 s36, s36, s32
s_lshl_b32 s36, s36, 2
s_add_u32 s92, s78, s36
s_add_u32 s92, s92, 0xc0000
s_lshl_b32 s36, s32, 2
s_add_u32 s93, s79, s36
s_add_u32 s93, s93, 0xc0080
s_and_b32 s94, s35, 15
s_lshl_b32 s94, s94, 9
s_lshr_b32 s36, s35, 4
s_lshl_b32 s36, s36, 2
s_add_u32 s94, s94, s36
s_add_u32 s94, s94, 0xc00c0
v_lshrrev_b32 v240, 1, v0
v_lshlrev_b32 v240, 13, v240
v_and_b32 v241, 1, v0
v_lshl_add_u32 v240, v241, 8, v240
s_mov_b32 vcc_lo, 0xffff
s_mov_b32 vcc_hi, 0
v_cndmask_b32 v240, 2.0, v240, vcc
v_lshlrev_b32 v241, 2, v0
v_add_u32 v248, 0, v248
v_add_u32 v249, 0, v249
s_add_u32 s96, s96, 0x400000
s_add_u32 s98, s98, 0x80000
s_add_u32 s96, s96, 0x400000
s_add_u32 s99, s99, 0x80000
s_cmp_eq_u32 s28, 0
s_cselect_b32 vcc_lo, 0xffff, 0
v_lshlrev_b32 v252, 12, v0
v_cndmask_b32 v252, 2.0, v252, vcc
v_cndmask_b32 v14, 2.0, v240, vcc
s_and_b32 s62, s35, 15
s_lshl_b32 s62, s62, 8
s_lshr_b32 s36, s35, 4
s_lshl_b32 s36, s36, 2
s_add_u32 s62, s62, s36
s_add_u32 s62, s62, 0xd0000
s_add_u32 s8, s94, 0x1ff40
v_and_b32 v255, 15, v0
v_lshlrev_b32 v255, 2, v255
s_waitcnt vmcnt(0)
s_barrier
s_cmp_lg_u32 s28, 0
s_cbranch_scc1 Lg1s_2
buffer_atomic_swap v15, v10, s[4:7], s92 offen sc1
s_add_u32 s36, s67, 0xc2080
s_cmp_eq_u32 s81, 3
s_cselect_b32 s36, 0x40000000, s36
s_mov_b64 exec, 1
buffer_atomic_swap v15, off, s[4:7], s36 sc1
s_mov_b64 exec, -1
buffer_atomic_swap v15, v240, s[4:7], s94 offen sc1
buffer_atomic_swap v15, v252, s[4:7], s62 offen sc1
Lg1s_2:
s_branch L_aligned
.p2align 12
L_aligned:
s_mov_b64 s[20:21], s[76:77]
s_mov_b32 s22, 0x200000
s_add_u32 s89, s16, 0
buffer_load_dwordx4 a[220:223], v229, s[20:23], s89 offen nt
s_mov_b64 s[20:21], s[76:77]
s_mov_b32 s22, 0x200000
s_add_u32 s89, s16, 16384
buffer_load_dwordx4 a[224:227], v229, s[20:23], s89 offen nt
s_mov_b64 s[20:21], s[72:73]
s_mov_b32 s22, 0x600000
s_add_u32 s89, s17, 0
buffer_load_dwordx4 a[188:191], v228, s[20:23], s89 offen nt
s_mov_b64 s[20:21], s[72:73]
s_mov_b32 s22, 0x600000
s_add_u32 s89, s17, 49152
buffer_load_dwordx4 a[192:195], v228, s[20:23], s89 offen nt
s_mov_b64 s[20:21], s[72:73]
s_mov_b32 s22, 0x600000
s_add_u32 s89, s17, 2048
buffer_load_dwordx4 a[196:199], v228, s[20:23], s89 offen nt
s_mov_b64 s[20:21], s[72:73]
s_mov_b32 s22, 0x600000
s_add_u32 s89, s17, 51200
buffer_load_dwordx4 a[200:203], v228, s[20:23], s89 offen nt
s_mov_b64 s[20:21], s[72:73]
s_mov_b32 s22, 0x600000
s_add_u32 s89, s17, 4096
buffer_load_dwordx4 a[204:207], v228, s[20:23], s89 offen nt
s_mov_b64 s[20:21], s[72:73]
s_mov_b32 s22, 0x600000
s_add_u32 s89, s17, 53248
buffer_load_dwordx4 a[208:211], v228, s[20:23], s89 offen nt
s_add_u32 s89, s66, 0xd0000
ds_read_b64_tr_b16 a[240:241], v251 offset:0
ds_read_b64_tr_b16 a[242:243], v251 offset:1024
ds_read_b64_tr_b16 a[244:245], v251 offset:32
ds_read_b64_tr_b16 a[246:247], v251 offset:1056
s_lshl_b32 s36, s28, 11
v_add_u32 v231, s36, v1
s_waitcnt lgkmcnt(0)
v_add_u32 v231, 0, v231
v_cmp_eq_u32 vcc, 0, v0
s_nop 1
v_cndmask_b32 v251, 2.0, v0, vcc
s_cmp_eq_u32 s34, 0x40000000
s_cbranch_scc1 Lvote_5
s_add_u32 s36, s34, 0
s_memtime s[52:53]
s_waitcnt lgkmcnt(0)
s_load_dword s37, s[4:5], s36
s_waitcnt lgkmcnt(0)
s_memtime s[60:61]
s_waitcnt lgkmcnt(0)
s_sub_u32 s38, s60, s52
s_add_u32 s36, s34, 8192
s_memtime s[52:53]
s_waitcnt lgkmcnt(0)
s_load_dword s37, s[4:5], s36
s_waitcnt lgkmcnt(0)
s_memtime s[60:61]
s_waitcnt lgkmcnt(0)
s_sub_u32 s39, s60, s52
s_add_u32 s36, s34, 128
s_memtime s[52:53]
s_waitcnt lgkmcnt(0)
s_load_dword s37, s[4:5], s36
s_waitcnt lgkmcnt(0)
s_memtime s[60:61]
s_waitcnt lgkmcnt(0)
s_sub_u32 s37, s60, s52
s_min_u32 s38, s38, s37
s_add_u32 s36, s34, 8320
s_memtime s[52:53]
s_waitcnt lgkmcnt(0)
s_load_dword s37, s[4:5], s36
s_waitcnt lgkmcnt(0)
s_memtime s[60:61]
s_waitcnt lgkmcnt(0)
s_sub_u32 s37, s60, s52
s_min_u32 s39, s39, s37
s_cmp_lt_u32 s38, s39
s_cselect_b32 s36, 0, 1
s_lshr_b32 s37, s29, 2
s_xor_b32 s36, s36, s37
s_add_u32 s36, s36, 0x10000
v_mov_b32 v242, s36
s_and_b32 s36, s51, 1
s_lshl_b32 s36, s36, 7
s_lshr_b32 s37, s51, 1
s_lshl_b32 s37, s37, 4
s_add_u32 s36, s36, s37
buffer_atomic_add v242, v251, s[24:27], s36 offen sc1
Lvote_5:
s_mov_b64 exec, 0
s_cmp_eq_u32 s28, 3
s_cbranch_scc1 L_stub0
s_cmp_eq_u32 s28, 0
s_cbranch_scc1 L_stub1
s_cmp_eq_u32 s28, 2
s_cbranch_scc1 L_stub2
L_wret0:
s_mov_b64 exec, -1
s_cmp_lg_u32 s28, 1
s_cbranch_scc1 Lg1e_4
s_cmp_eq_u32 s54, 32
s_cselect_b32 s39, 0, 1
s_or_b32 s39, s39, 0xffff0000
s_mov_b32 s38, -1
s_add_u32 s36, s67, 0xc0000
s_mov_b32 s37, 0
Lg1p_3:
v_mov_b32 v11, 0
buffer_atomic_add v11, v241, s[4:7], s36 offen sc0 sc1
s_add_u32 s37, s37, 1
v_mov_b32 v242, v15
s_mov_b64 exec, 0xffff
v_mov_b32 v242, 0
buffer_atomic_add v242, v241, s[4:7], s89 offen sc0 sc1
s_mov_b64 exec, -1
s_waitcnt vmcnt(0)
v_cmp_ne_u32 vcc, v11, v15
v_cmp_ne_u32 s[52:53], v242, v15
s_and_b64 vcc, vcc, s[38:39]
s_or_b64 vcc, vcc, s[52:53]
s_cbranch_scc0 Lg1e_4
s_cmp_lt_u32 s37, 0x100000
s_cbranch_scc1 Lg1p_3
Lg1e_4:
s_barrier
s_add_u32 s94, s71, 0x80
s_add_u32 m0, s18, 0x0
s_add_u32 s44, s50, 0x2000000
buffer_load_dwordx4 v1, s[4:7], s44 offen offset:0 sc1 lds
buffer_load_dwordx4 v1, s[4:7], s44 offen offset:1024 sc1 lds
s_add_u32 m0, s18, 0x2000
s_add_u32 s44, s50, 0x2002000
buffer_load_dwordx4 v1, s[4:7], s44 offen offset:0 sc1 lds
buffer_load_dwordx4 v1, s[4:7], s44 offen offset:1024 sc1 lds
s_add_u32 m0, s18, 0x4000
s_add_u32 s44, s50, 0x2004000
buffer_load_dwordx4 v1, s[4:7], s44 offen offset:0 sc1 lds
buffer_load_dwordx4 v1, s[4:7], s44 offen offset:1024 sc1 lds
s_add_u32 m0, s18, 0x6000
s_add_u32 s44, s50, 0x2006000
buffer_load_dwordx4 v1, s[4:7], s44 offen offset:0 sc1 lds
buffer_load_dwordx4 v1, s[4:7], s44 offen offset:1024 sc1 lds
s_add_u32 m0, s18, 0x8000
s_add_u32 s44, s50, 0x2008000
buffer_load_dwordx4 v1, s[4:7], s44 offen offset:0 sc1 lds
buffer_load_dwordx4 v1, s[4:7], s44 offen offset:1024 sc1 lds
s_add_u32 m0, s18, 0xa000
s_add_u32 s44, s50, 0x200a000
buffer_load_dwordx4 v1, s[4:7], s44 offen offset:0 sc1 lds
buffer_load_dwordx4 v1, s[4:7], s44 offen offset:1024 sc1 lds
s_mov_b32 s35, 0
s_add_u32 s33, s35, 0x1000
buffer_load_dwordx4 a[0:3], v2, s[40:43], s35 offen offset:0 sc1
buffer_load_dwordx4 a[4:7], v2, s[40:43], s33 offen offset:0 sc1
buffer_load_dwordx4 a[8:11], v2, s[40:43], s35 offen offset:1024 sc1
buffer_load_dwordx4 a[12:15], v2, s[40:43], s33 offen offset:1024 sc1
buffer_load_dwordx4 a[16:19], v2, s[40:43], s35 offen offset:2048 sc1
buffer_load_dwordx4 a[20:23], v2, s[40:43], s33 offen offset:2048 sc1
buffer_load_dwordx4 a[24:27], v2, s[40:43], s35 offen offset:3072 sc1
buffer_load_dwordx4 a[28:31], v2, s[40:43], s33 offen offset:3072 sc1
s_add_u32 s35, s35, 0x2000
s_add_u32 s33, s33, 0x2000
buffer_load_dwordx4 a[32:35], v2, s[40:43], s35 offen offset:0 sc1
buffer_load_dwordx4 a[36:39], v2, s[40:43], s33 offen offset:0 sc1
buffer_load_dwordx4 a[40:43], v2, s[40:43], s35 offen offset:1024 sc1
buffer_load_dwordx4 a[44:47], v2, s[40:43], s33 offen offset:1024 sc1
buffer_load_dwordx4 a[48:51], v2, s[40:43], s35 offen offset:2048 sc1
buffer_load_dwordx4 a[52:55], v2, s[40:43], s33 offen offset:2048 sc1
buffer_load_dwordx4 a[56:59], v2, s[40:43], s35 offen offset:3072 sc1
buffer_load_dwordx4 a[60:63], v2, s[40:43], s33 offen offset:3072 sc1
s_add_u32 s35, s35, 0x2000
s_add_u32 s33, s33, 0x2000
s_waitcnt vmcnt(16)
s_barrier
v_add_u32 v5, 0, v1
ds_read_b128 a[96:99], v5 offset:2048
ds_read_b128 a[100:103], v5 offset:8192
ds_read_b128 a[104:107], v5 offset:3072
ds_read_b128 a[108:111], v5 offset:9216
ds_read_b128 a[112:115], v5 offset:4096
ds_read_b128 a[116:119], v5 offset:10240
s_waitcnt vmcnt(14) lgkmcnt(4)
v_mfma_f32_16x16x32_bf16 v[140:143], a[96:99], a[0:3], 0
s_add_u32 m0, s18, 0xc000
s_add_u32 s44, s50, 0x200c000
v_mfma_f32_16x16x32_bf16 v[140:143], a[100:103], a[4:7], v[140:143]
buffer_load_dwordx4 a[64:67], v2, s[40:43], s35 offen offset:0 sc1
s_waitcnt vmcnt(13)
v_mfma_f32_16x16x32_bf16 v[164:167], a[100:103], a[12:15], 0
ds_read_b128 a[128:131], v5 offset:5120
v_mfma_f32_16x16x32_bf16 v[164:167], a[96:99], a[8:11], v[164:167]
ds_read_b128 a[132:135], v5 offset:11264
s_waitcnt vmcnt(12)
v_mfma_f32_16x16x32_bf16 v[188:191], a[96:99], a[16:19], 0
s_waitcnt vmcnt(11)
v_mfma_f32_16x16x32_bf16 v[188:191], a[100:103], a[20:23], v[188:191]
buffer_load_dwordx4 v1, s[4:7], s44 offen offset:0 sc1 lds
s_waitcnt vmcnt(10)
v_mfma_f32_16x16x32_bf16 v[212:215], a[100:103], a[28:31], 0
ds_read_b128 a[136:139], v5 offset:0
v_mfma_f32_16x16x32_bf16 v[212:215], a[96:99], a[24:27], v[212:215]
s_waitcnt lgkmcnt(6)
v_mfma_f32_16x16x32_bf16 v[216:219], a[104:107], a[24:27], 0
ds_read_b128 a[140:143], v5 offset:6144
s_waitcnt lgkmcnt(6)
v_mfma_f32_16x16x32_bf16 v[216:219], a[108:111], a[28:31], v[216:219]
buffer_load_dwordx4 a[68:71], v2, s[40:43], s33 offen offset:0 sc1
v_mfma_f32_16x16x32_bf16 v[192:195], a[108:111], a[20:23], 0
ds_read_b128 a[144:147], v5 offset:1024
v_mfma_f32_16x16x32_bf16 v[192:195], a[104:107], a[16:19], v[192:195]
v_mfma_f32_16x16x32_bf16 v[168:171], a[104:107], a[8:11], 0
v_mfma_f32_16x16x32_bf16 v[168:171], a[108:111], a[12:15], v[168:171]
buffer_load_dwordx4 a[72:75], v2, s[40:43], s35 offen offset:1024 sc1
v_mfma_f32_16x16x32_bf16 v[144:147], a[108:111], a[4:7], 0
ds_read_b128 a[148:151], v5 offset:7168
v_mfma_f32_16x16x32_bf16 v[144:147], a[104:107], a[0:3], v[144:147]
s_waitcnt lgkmcnt(7)
v_mfma_f32_16x16x32_bf16 v[148:151], a[112:115], a[0:3], 0
s_waitcnt lgkmcnt(6)
v_mfma_f32_16x16x32_bf16 v[148:151], a[116:119], a[4:7], v[148:151]
buffer_load_dwordx4 v1, s[4:7], s44 offen offset:1024 sc1 lds
s_add_u32 m0, s18, 0xe000
v_mfma_f32_16x16x32_bf16 v[172:175], a[116:119], a[12:15], 0
s_add_u32 s44, s50, 0x200e000
v_mfma_f32_16x16x32_bf16 v[172:175], a[112:115], a[8:11], v[172:175]
v_mfma_f32_16x16x32_bf16 v[196:199], a[112:115], a[16:19], 0
v_mfma_f32_16x16x32_bf16 v[196:199], a[116:119], a[20:23], v[196:199]
buffer_load_dwordx4 a[76:79], v2, s[40:43], s33 offen offset:1024 sc1
v_mfma_f32_16x16x32_bf16 v[220:223], a[116:119], a[28:31], 0
v_mfma_f32_16x16x32_bf16 v[220:223], a[112:115], a[24:27], v[220:223]
s_waitcnt lgkmcnt(0)
v_mfma_f32_16x16x32_bf16 v[224:227], a[128:131], a[24:27], 0
ds_read_b128 a[96:99], v5 offset:14336
v_mfma_f32_16x16x32_bf16 v[224:227], a[132:135], a[28:31], v[224:227]
buffer_load_dwordx4 a[80:83], v2, s[40:43], s35 offen offset:2048 sc1
v_mfma_f32_16x16x32_bf16 v[200:203], a[132:135], a[20:23], 0
ds_read_b128 a[100:103], v5 offset:20480
v_mfma_f32_16x16x32_bf16 v[200:203], a[128:131], a[16:19], v[200:203]
v_mfma_f32_16x16x32_bf16 v[176:179], a[128:131], a[8:11], 0
v_mfma_f32_16x16x32_bf16 v[176:179], a[132:135], a[12:15], v[176:179]
buffer_load_dwordx4 v1, s[4:7], s44 offen offset:0 sc1 lds
v_mfma_f32_16x16x32_bf16 v[152:155], a[132:135], a[4:7], 0
ds_read_b128 a[104:107], v5 offset:15360
v_mfma_f32_16x16x32_bf16 v[152:155], a[128:131], a[0:3], v[152:155]
v_mfma_f32_16x16x32_bf16 v[132:135], a[136:139], a[0:3], 0
ds_read_b128 a[108:111], v5 offset:21504
v_mfma_f32_16x16x32_bf16 v[132:135], a[140:143], a[4:7], v[132:135]
buffer_load_dwordx4 a[84:87], v2, s[40:43], s33 offen offset:2048 sc1
v_mfma_f32_16x16x32_bf16 v[156:159], a[140:143], a[12:15], 0
ds_read_b128 a[112:115], v5 offset:16384
v_mfma_f32_16x16x32_bf16 v[156:159], a[136:139], a[8:11], v[156:159]
v_mfma_f32_16x16x32_bf16 v[180:183], a[136:139], a[16:19], 0
v_mfma_f32_16x16x32_bf16 v[180:183], a[140:143], a[20:23], v[180:183]
buffer_load_dwordx4 a[88:91], v2, s[40:43], s35 offen offset:3072 sc1
v_mfma_f32_16x16x32_bf16 v[204:207], a[140:143], a[28:31], 0
ds_read_b128 a[116:119], v5 offset:22528
v_mfma_f32_16x16x32_bf16 v[204:207], a[136:139], a[24:27], v[204:207]
v_mfma_f32_16x16x32_bf16 v[208:211], a[144:147], a[24:27], 0
v_mfma_f32_16x16x32_bf16 v[208:211], a[148:151], a[28:31], v[208:211]
buffer_load_dwordx4 v1, s[4:7], s44 offen offset:1024 sc1 lds
s_add_u32 m0, s18, 0x10000
v_mfma_f32_16x16x32_bf16 v[184:187], a[148:151], a[20:23], 0
s_add_u32 s44, s50, 0x2010000
v_mfma_f32_16x16x32_bf16 v[184:187], a[144:147], a[16:19], v[184:187]
v_mfma_f32_16x16x32_bf16 v[160:163], a[144:147], a[8:11], 0
v_mfma_f32_16x16x32_bf16 v[160:163], a[148:151], a[12:15], v[160:163]
buffer_load_dwordx4 a[92:95], v2, s[40:43], s33 offen offset:3072 sc1
s_add_u32 s35, s35, 0x2000
v_mfma_f32_16x16x32_bf16 v[136:139], a[148:151], a[4:7], 0
s_add_u32 s33, s33, 0x2000
v_mfma_f32_16x16x32_bf16 v[136:139], a[144:147], a[0:3], v[136:139]
s_waitcnt vmcnt(12) lgkmcnt(0)
v_mfma_f32_16x16x32_bf16 v[140:143], a[96:99], a[32:35], v[140:143]
ds_read_b128 a[128:131], v5 offset:17408
v_mfma_f32_16x16x32_bf16 v[140:143], a[100:103], a[36:39], v[140:143]
buffer_load_dwordx4 a[0:3], v2, s[40:43], s35 offen offset:0 sc1
v_mfma_f32_16x16x32_bf16 v[164:167], a[100:103], a[44:47], v[164:167]
ds_read_b128 a[132:135], v5 offset:23552
v_mfma_f32_16x16x32_bf16 v[164:167], a[96:99], a[40:43], v[164:167]
v_mfma_f32_16x16x32_bf16 v[188:191], a[96:99], a[48:51], v[188:191]
v_mfma_f32_16x16x32_bf16 v[188:191], a[100:103], a[52:55], v[188:191]
buffer_load_dwordx4 v1, s[4:7], s44 offen offset:0 sc1 lds
v_mfma_f32_16x16x32_bf16 v[212:215], a[100:103], a[60:63], v[212:215]
ds_read_b128 a[136:139], v5 offset:12288
v_mfma_f32_16x16x32_bf16 v[212:215], a[96:99], a[56:59], v[212:215]
v_mfma_f32_16x16x32_bf16 v[216:219], a[104:107], a[56:59], v[216:219]
ds_read_b128 a[140:143], v5 offset:18432
v_mfma_f32_16x16x32_bf16 v[216:219], a[108:111], a[60:63], v[216:219]
buffer_load_dwordx4 a[4:7], v2, s[40:43], s33 offen offset:0 sc1
v_mfma_f32_16x16x32_bf16 v[192:195], a[108:111], a[52:55], v[192:195]
ds_read_b128 a[144:147], v5 offset:13312
v_mfma_f32_16x16x32_bf16 v[192:195], a[104:107], a[48:51], v[192:195]
v_mfma_f32_16x16x32_bf16 v[168:171], a[104:107], a[40:43], v[168:171]
v_mfma_f32_16x16x32_bf16 v[168:171], a[108:111], a[44:47], v[168:171]
buffer_load_dwordx4 a[8:11], v2, s[40:43], s35 offen offset:1024 sc1
v_mfma_f32_16x16x32_bf16 v[144:147], a[108:111], a[36:39], v[144:147]
ds_read_b128 a[148:151], v5 offset:19456
v_mfma_f32_16x16x32_bf16 v[144:147], a[104:107], a[32:35], v[144:147]
v_mfma_f32_16x16x32_bf16 v[148:151], a[112:115], a[32:35], v[148:151]
v_mfma_f32_16x16x32_bf16 v[148:151], a[116:119], a[36:39], v[148:151]
buffer_load_dwordx4 v1, s[4:7], s44 offen offset:1024 sc1 lds
s_add_u32 m0, s18, 0x12000
v_mfma_f32_16x16x32_bf16 v[172:175], a[116:119], a[44:47], v[172:175]
s_add_u32 s44, s50, 0x2012000
v_mfma_f32_16x16x32_bf16 v[172:175], a[112:115], a[40:43], v[172:175]
v_mfma_f32_16x16x32_bf16 v[196:199], a[112:115], a[48:51], v[196:199]
v_mfma_f32_16x16x32_bf16 v[196:199], a[116:119], a[52:55], v[196:199]
buffer_load_dwordx4 a[12:15], v2, s[40:43], s33 offen offset:1024 sc1
v_mfma_f32_16x16x32_bf16 v[220:223], a[116:119], a[60:63], v[220:223]
v_mfma_f32_16x16x32_bf16 v[220:223], a[112:115], a[56:59], v[220:223]
s_waitcnt lgkmcnt(0)
v_mfma_f32_16x16x32_bf16 v[224:227], a[128:131], a[56:59], v[224:227]
ds_read_b128 a[96:99], v5 offset:26624
v_mfma_f32_16x16x32_bf16 v[224:227], a[132:135], a[60:63], v[224:227]
buffer_load_dwordx4 a[16:19], v2, s[40:43], s35 offen offset:2048 sc1
v_mfma_f32_16x16x32_bf16 v[200:203], a[132:135], a[52:55], v[200:203]
ds_read_b128 a[100:103], v5 offset:32768
v_mfma_f32_16x16x32_bf16 v[200:203], a[128:131], a[48:51], v[200:203]
v_mfma_f32_16x16x32_bf16 v[176:179], a[128:131], a[40:43], v[176:179]
v_mfma_f32_16x16x32_bf16 v[176:179], a[132:135], a[44:47], v[176:179]
buffer_load_dwordx4 v1, s[4:7], s44 offen offset:0 sc1 lds
v_mfma_f32_16x16x32_bf16 v[152:155], a[132:135], a[36:39], v[152:155]
ds_read_b128 a[104:107], v5 offset:27648
v_mfma_f32_16x16x32_bf16 v[152:155], a[128:131], a[32:35], v[152:155]
v_mfma_f32_16x16x32_bf16 v[132:135], a[136:139], a[32:35], v[132:135]
ds_read_b128 a[108:111], v5 offset:33792
v_mfma_f32_16x16x32_bf16 v[132:135], a[140:143], a[36:39], v[132:135]
buffer_load_dwordx4 a[20:23], v2, s[40:43], s33 offen offset:2048 sc1
v_mfma_f32_16x16x32_bf16 v[156:159], a[140:143], a[44:47], v[156:159]
ds_read_b128 a[112:115], v5 offset:28672
v_mfma_f32_16x16x32_bf16 v[156:159], a[136:139], a[40:43], v[156:159]
v_mfma_f32_16x16x32_bf16 v[180:183], a[136:139], a[48:51], v[180:183]
v_mfma_f32_16x16x32_bf16 v[180:183], a[140:143], a[52:55], v[180:183]
buffer_load_dwordx4 a[24:27], v2, s[40:43], s35 offen offset:3072 sc1
v_mfma_f32_16x16x32_bf16 v[204:207], a[140:143], a[60:63], v[204:207]
ds_read_b128 a[116:119], v5 offset:34816
v_mfma_f32_16x16x32_bf16 v[204:207], a[136:139], a[56:59], v[204:207]
v_mfma_f32_16x16x32_bf16 v[208:211], a[144:147], a[56:59], v[208:211]
v_mfma_f32_16x16x32_bf16 v[208:211], a[148:151], a[60:63], v[208:211]
buffer_load_dwordx4 v1, s[4:7], s44 offen offset:1024 sc1 lds
s_add_u32 m0, s18, 0x14000
v_mfma_f32_16x16x32_bf16 v[184:187], a[148:151], a[52:55], v[184:187]
s_add_u32 s44, s50, 0x2014000
v_mfma_f32_16x16x32_bf16 v[184:187], a[144:147], a[48:51], v[184:187]
v_mfma_f32_16x16x32_bf16 v[160:163], a[144:147], a[40:43], v[160:163]
v_mfma_f32_16x16x32_bf16 v[160:163], a[148:151], a[44:47], v[160:163]
buffer_load_dwordx4 a[28:31], v2, s[40:43], s33 offen offset:3072 sc1
s_add_u32 s35, s35, 0x2000
v_mfma_f32_16x16x32_bf16 v[136:139], a[148:151], a[36:39], v[136:139]
s_add_u32 s33, s33, 0x2000
v_mfma_f32_16x16x32_bf16 v[136:139], a[144:147], a[32:35], v[136:139]
s_waitcnt vmcnt(12) lgkmcnt(0)
v_mfma_f32_16x16x32_bf16 v[140:143], a[96:99], a[64:67], v[140:143]
ds_read_b128 a[128:131], v5 offset:29696
v_mfma_f32_16x16x32_bf16 v[140:143], a[100:103], a[68:71], v[140:143]
buffer_load_dwordx4 a[32:35], v2, s[40:43], s35 offen offset:0 sc1
v_mfma_f32_16x16x32_bf16 v[164:167], a[100:103], a[76:79], v[164:167]
ds_read_b128 a[132:135], v5 offset:35840
v_mfma_f32_16x16x32_bf16 v[164:167], a[96:99], a[72:75], v[164:167]
v_mfma_f32_16x16x32_bf16 v[188:191], a[96:99], a[80:83], v[188:191]
v_mfma_f32_16x16x32_bf16 v[188:191], a[100:103], a[84:87], v[188:191]
buffer_load_dwordx4 v1, s[4:7], s44 offen offset:0 sc1 lds
v_mfma_f32_16x16x32_bf16 v[212:215], a[100:103], a[92:95], v[212:215]
ds_read_b128 a[136:139], v5 offset:24576
v_mfma_f32_16x16x32_bf16 v[212:215], a[96:99], a[88:91], v[212:215]
v_mfma_f32_16x16x32_bf16 v[216:219], a[104:107], a[88:91], v[216:219]
ds_read_b128 a[140:143], v5 offset:30720
v_mfma_f32_16x16x32_bf16 v[216:219], a[108:111], a[92:95], v[216:219]
buffer_load_dwordx4 a[36:39], v2, s[40:43], s33 offen offset:0 sc1
v_mfma_f32_16x16x32_bf16 v[192:195], a[108:111], a[84:87], v[192:195]
ds_read_b128 a[144:147], v5 offset:25600
v_mfma_f32_16x16x32_bf16 v[192:195], a[104:107], a[80:83], v[192:195]
v_mfma_f32_16x16x32_bf16 v[168:171], a[104:107], a[72:75], v[168:171]
v_mfma_f32_16x16x32_bf16 v[168:171], a[108:111], a[76:79], v[168:171]
buffer_load_dwordx4 a[40:43], v2, s[40:43], s35 offen offset:1024 sc1
v_mfma_f32_16x16x32_bf16 v[144:147], a[108:111], a[68:71], v[144:147]
ds_read_b128 a[148:151], v5 offset:31744
v_mfma_f32_16x16x32_bf16 v[144:147], a[104:107], a[64:67], v[144:147]
v_mfma_f32_16x16x32_bf16 v[148:151], a[112:115], a[64:67], v[148:151]
v_mfma_f32_16x16x32_bf16 v[148:151], a[116:119], a[68:71], v[148:151]
buffer_load_dwordx4 v1, s[4:7], s44 offen offset:1024 sc1 lds
s_add_u32 m0, s18, 0x16000
v_mfma_f32_16x16x32_bf16 v[172:175], a[116:119], a[76:79], v[172:175]
s_add_u32 s44, s50, 0x2016000
v_mfma_f32_16x16x32_bf16 v[172:175], a[112:115], a[72:75], v[172:175]
v_mfma_f32_16x16x32_bf16 v[196:199], a[112:115], a[80:83], v[196:199]
v_mfma_f32_16x16x32_bf16 v[196:199], a[116:119], a[84:87], v[196:199]
buffer_load_dwordx4 a[44:47], v2, s[40:43], s33 offen offset:1024 sc1
v_mfma_f32_16x16x32_bf16 v[220:223], a[116:119], a[92:95], v[220:223]
v_mfma_f32_16x16x32_bf16 v[220:223], a[112:115], a[88:91], v[220:223]
s_waitcnt lgkmcnt(0)
v_mfma_f32_16x16x32_bf16 v[224:227], a[128:131], a[88:91], v[224:227]
ds_read_b128 a[96:99], v5 offset:38912
v_mfma_f32_16x16x32_bf16 v[224:227], a[132:135], a[92:95], v[224:227]
buffer_load_dwordx4 a[48:51], v2, s[40:43], s35 offen offset:2048 sc1
v_mfma_f32_16x16x32_bf16 v[200:203], a[132:135], a[84:87], v[200:203]
ds_read_b128 a[100:103], v5 offset:45056
v_mfma_f32_16x16x32_bf16 v[200:203], a[128:131], a[80:83], v[200:203]
v_mfma_f32_16x16x32_bf16 v[176:179], a[128:131], a[72:75], v[176:179]
buffer_load_dwordx4 v1, s[4:7], s44 offen offset:0 sc1 lds
v_mfma_f32_16x16x32_bf16 v[176:179], a[132:135], a[76:79], v[176:179]
ds_read_b128 a[104:107], v5 offset:39936
v_mfma_f32_16x16x32_bf16 v[152:155], a[132:135], a[68:71], v[152:155]
v_mfma_f32_16x16x32_bf16 v[152:155], a[128:131], a[64:67], v[152:155]
buffer_load_dwordx4 a[52:55], v2, s[40:43], s33 offen offset:2048 sc1
v_mfma_f32_16x16x32_bf16 v[132:135], a[136:139], a[64:67], v[132:135]
ds_read_b128 a[108:111], v5 offset:46080
v_mfma_f32_16x16x32_bf16 v[132:135], a[140:143], a[68:71], v[132:135]
v_mfma_f32_16x16x32_bf16 v[156:159], a[140:143], a[76:79], v[156:159]
ds_read_b128 a[112:115], v5 offset:40960
v_mfma_f32_16x16x32_bf16 v[156:159], a[136:139], a[72:75], v[156:159]
buffer_load_dwordx4 v1, s[4:7], s44 offen offset:1024 sc1 lds
v_mfma_f32_16x16x32_bf16 v[180:183], a[136:139], a[80:83], v[180:183]
v_and_b32 v232, 15, v0
v_lshlrev_b32 v232, 7, v232
v_mfma_f32_16x16x32_bf16 v[180:183], a[140:143], a[84:87], v[180:183]
v_lshrrev_b32 v233, 4, v0
v_lshlrev_b32 v233, 4, v233
v_mfma_f32_16x16x32_bf16 v[204:207], a[140:143], a[92:95], v[204:207]
buffer_load_dwordx4 a[56:59], v2, s[40:43], s35 offen offset:3072 sc1
v_mfma_f32_16x16x32_bf16 v[204:207], a[136:139], a[88:91], v[204:207]
v_add_u32 v232, v233, v232
s_mul_i32 s38, s30, 12288
v_mfma_f32_16x16x32_bf16 v[208:211], a[144:147], a[88:91], v[208:211]
s_add_u32 s38, s38, 0x1800000
s_add_u32 s39, s28, 4
s_min_u32 s39, s39, 5
v_mfma_f32_16x16x32_bf16 v[208:211], a[148:151], a[92:95], v[208:211]
s_lshl_b32 s36, s28, 11
s_add_u32 s36, s36, s38
s_lshl_b32 s37, s39, 11
s_add_u32 s37, s37, s38
v_mfma_f32_16x16x32_bf16 v[184:187], a[148:151], a[84:87], v[184:187]
buffer_load_dwordx4 v[48:51], v232, s[4:7], s36 offen sc1
v_mfma_f32_16x16x32_bf16 v[184:187], a[144:147], a[80:83], v[184:187]
ds_read_b128 a[116:119], v5 offset:47104
v_mfma_f32_16x16x32_bf16 v[160:163], a[144:147], a[72:75], v[160:163]
v_mfma_f32_16x16x32_bf16 v[160:163], a[148:151], a[76:79], v[160:163]
buffer_load_dwordx4 a[60:63], v2, s[40:43], s33 offen offset:3072 sc1
s_add_u32 s35, s35, 0x2000
v_mfma_f32_16x16x32_bf16 v[136:139], a[148:151], a[68:71], v[136:139]
s_add_u32 s33, s33, 0x2000
v_mfma_f32_16x16x32_bf16 v[136:139], a[144:147], a[64:67], v[136:139]
s_waitcnt vmcnt(13) lgkmcnt(0)
v_mfma_f32_16x16x32_bf16 v[140:143], a[96:99], a[0:3], v[140:143]
ds_read_b128 a[128:131], v5 offset:41984
v_mfma_f32_16x16x32_bf16 v[140:143], a[100:103], a[4:7], v[140:143]
buffer_load_dwordx4 a[64:67], v2, s[40:43], s35 offen offset:0 sc1
v_mfma_f32_16x16x32_bf16 v[164:167], a[100:103], a[12:15], v[164:167]
ds_read_b128 a[132:135], v5 offset:48128
v_mfma_f32_16x16x32_bf16 v[164:167], a[96:99], a[8:11], v[164:167]
v_mfma_f32_16x16x32_bf16 v[188:191], a[96:99], a[16:19], v[188:191]
v_mfma_f32_16x16x32_bf16 v[188:191], a[100:103], a[20:23], v[188:191]
buffer_load_dwordx4 v[52:55], v232, s[4:7], s37 offen sc1
s_add_u32 m0, s18, 0x18000
v_mfma_f32_16x16x32_bf16 v[212:215], a[100:103], a[28:31], v[212:215]
s_add_u32 s44, s50, 0x2018000
ds_read_b128 a[136:139], v5 offset:36864
v_mfma_f32_16x16x32_bf16 v[212:215], a[96:99], a[24:27], v[212:215]
v_mfma_f32_16x16x32_bf16 v[216:219], a[104:107], a[24:27], v[216:219]
ds_read_b128 a[140:143], v5 offset:43008
v_mfma_f32_16x16x32_bf16 v[216:219], a[108:111], a[28:31], v[216:219]
buffer_load_dwordx4 a[68:71], v2, s[40:43], s33 offen offset:0 sc1
v_mfma_f32_16x16x32_bf16 v[192:195], a[108:111], a[20:23], v[192:195]
ds_read_b128 a[144:147], v5 offset:37888
v_mfma_f32_16x16x32_bf16 v[192:195], a[104:107], a[16:19], v[192:195]
v_mfma_f32_16x16x32_bf16 v[168:171], a[104:107], a[8:11], v[168:171]
v_mfma_f32_16x16x32_bf16 v[168:171], a[108:111], a[12:15], v[168:171]
buffer_load_dwordx4 a[72:75], v2, s[40:43], s35 offen offset:1024 sc1
v_mfma_f32_16x16x32_bf16 v[144:147], a[108:111], a[4:7], v[144:147]
ds_read_b128 a[148:151], v5 offset:44032
v_mfma_f32_16x16x32_bf16 v[144:147], a[104:107], a[0:3], v[144:147]
v_mfma_f32_16x16x32_bf16 v[148:151], a[112:115], a[0:3], v[148:151]
v_mfma_f32_16x16x32_bf16 v[148:151], a[116:119], a[4:7], v[148:151]
buffer_load_dwordx4 v1, s[4:7], s44 offen offset:0 sc1 lds
v_mfma_f32_16x16x32_bf16 v[172:175], a[116:119], a[12:15], v[172:175]
v_mfma_f32_16x16x32_bf16 v[172:175], a[112:115], a[8:11], v[172:175]
v_mfma_f32_16x16x32_bf16 v[196:199], a[112:115], a[16:19], v[196:199]
v_mfma_f32_16x16x32_bf16 v[196:199], a[116:119], a[20:23], v[196:199]
buffer_load_dwordx4 a[76:79], v2, s[40:43], s33 offen offset:1024 sc1
v_mfma_f32_16x16x32_bf16 v[220:223], a[116:119], a[28:31], v[220:223]
v_mfma_f32_16x16x32_bf16 v[220:223], a[112:115], a[24:27], v[220:223]
s_waitcnt lgkmcnt(0)
s_barrier
v_mfma_f32_16x16x32_bf16 v[224:227], a[128:131], a[24:27], v[224:227]
v_add_u32 v5, 49152, v1
v_mfma_f32_16x16x32_bf16 v[224:227], a[132:135], a[28:31], v[224:227]
buffer_load_dwordx4 a[80:83], v2, s[40:43], s35 offen offset:2048 sc1
v_mfma_f32_16x16x32_bf16 v[200:203], a[132:135], a[20:23], v[200:203]
ds_read_b128 a[96:99], v5 offset:2048
v_mfma_f32_16x16x32_bf16 v[200:203], a[128:131], a[16:19], v[200:203]
ds_read_b128 a[100:103], v5 offset:8192
v_mfma_f32_16x16x32_bf16 v[176:179], a[128:131], a[8:11], v[176:179]
ds_write_b128 v231, a[220:223] offset:24576
v_mfma_f32_16x16x32_bf16 v[176:179], a[132:135], a[12:15], v[176:179]
buffer_load_dwordx4 v1, s[4:7], s44 offen offset:1024 sc1 lds
s_add_u32 m0, s18, 0x1a000
v_mfma_f32_16x16x32_bf16 v[152:155], a[132:135], a[4:7], v[152:155]
s_add_u32 s44, s50, 0x201a000
ds_read_b128 a[104:107], v5 offset:3072
v_mfma_f32_16x16x32_bf16 v[152:155], a[128:131], a[0:3], v[152:155]
v_mfma_f32_16x16x32_bf16 v[132:135], a[136:139], a[0:3], v[132:135]
ds_read_b128 a[108:111], v5 offset:9216
v_mfma_f32_16x16x32_bf16 v[132:135], a[140:143], a[4:7], v[132:135]
buffer_load_dwordx4 a[84:87], v2, s[40:43], s33 offen offset:2048 sc1
v_mfma_f32_16x16x32_bf16 v[156:159], a[140:143], a[12:15], v[156:159]
ds_read_b128 a[112:115], v5 offset:4096
v_mfma_f32_16x16x32_bf16 v[156:159], a[136:139], a[8:11], v[156:159]
ds_write_b128 v231, a[224:227] offset:25600
v_mfma_f32_16x16x32_bf16 v[180:183], a[136:139], a[16:19], v[180:183]
v_mfma_f32_16x16x32_bf16 v[180:183], a[140:143], a[20:23], v[180:183]
buffer_load_dwordx4 a[88:91], v2, s[40:43], s35 offen offset:3072 sc1
v_mfma_f32_16x16x32_bf16 v[204:207], a[140:143], a[28:31], v[204:207]
ds_read_b128 a[116:119], v5 offset:10240
v_mfma_f32_16x16x32_bf16 v[204:207], a[136:139], a[24:27], v[204:207]
v_mfma_f32_16x16x32_bf16 v[208:211], a[144:147], a[24:27], v[208:211]
v_mfma_f32_16x16x32_bf16 v[208:211], a[148:151], a[28:31], v[208:211]
buffer_load_dwordx4 v1, s[4:7], s44 offen offset:0 sc1 lds
v_mfma_f32_16x16x32_bf16 v[184:187], a[148:151], a[20:23], v[184:187]
v_mfma_f32_16x16x32_bf16 v[184:187], a[144:147], a[16:19], v[184:187]
v_mfma_f32_16x16x32_bf16 v[160:163], a[144:147], a[8:11], v[160:163]
v_mfma_f32_16x16x32_bf16 v[160:163], a[148:151], a[12:15], v[160:163]
buffer_load_dwordx4 a[92:95], v2, s[40:43], s33 offen offset:3072 sc1
s_add_u32 s35, s35, 0x2000
v_mfma_f32_16x16x32_bf16 v[136:139], a[148:151], a[4:7], v[136:139]
s_add_u32 s33, s33, 0x2000
ds_write_b128 v231, a[188:191] offset:0
v_mfma_f32_16x16x32_bf16 v[136:139], a[144:147], a[0:3], v[136:139]
s_waitcnt vmcnt(12) lgkmcnt(1)
v_mfma_f32_16x16x32_bf16 v[140:143], a[96:99], a[32:35], v[140:143]
ds_read_b128 a[128:131], v5 offset:5120
v_mfma_f32_16x16x32_bf16 v[140:143], a[100:103], a[36:39], v[140:143]
buffer_load_dwordx4 a[0:3], v2, s[40:43], s35 offen offset:0 sc1
v_mfma_f32_16x16x32_bf16 v[164:167], a[100:103], a[44:47], v[164:167]
ds_read_b128 a[132:135], v5 offset:11264
v_mfma_f32_16x16x32_bf16 v[164:167], a[96:99], a[40:43], v[164:167]
v_mfma_f32_16x16x32_bf16 v[188:191], a[96:99], a[48:51], v[188:191]
v_mfma_f32_16x16x32_bf16 v[188:191], a[100:103], a[52:55], v[188:191]
buffer_load_dwordx4 v1, s[4:7], s44 offen offset:1024 sc1 lds
s_add_u32 m0, s18, 0x1c000
v_mfma_f32_16x16x32_bf16 v[212:215], a[100:103], a[60:63], v[212:215]
s_add_u32 s44, s50, 0x201c000
ds_read_b128 a[136:139], v5 offset:0
v_mfma_f32_16x16x32_bf16 v[212:215], a[96:99], a[56:59], v[212:215]
ds_write_b128 v231, a[192:195] offset:1024
v_mfma_f32_16x16x32_bf16 v[216:219], a[104:107], a[56:59], v[216:219]
ds_read_b128 a[140:143], v5 offset:6144
v_mfma_f32_16x16x32_bf16 v[216:219], a[108:111], a[60:63], v[216:219]
buffer_load_dwordx4 a[4:7], v2, s[40:43], s33 offen offset:0 sc1
v_mfma_f32_16x16x32_bf16 v[192:195], a[108:111], a[52:55], v[192:195]
ds_read_b128 a[144:147], v5 offset:1024
v_mfma_f32_16x16x32_bf16 v[192:195], a[104:107], a[48:51], v[192:195]
v_mfma_f32_16x16x32_bf16 v[168:171], a[104:107], a[40:43], v[168:171]
v_mfma_f32_16x16x32_bf16 v[168:171], a[108:111], a[44:47], v[168:171]
buffer_load_dwordx4 a[8:11], v2, s[40:43], s35 offen offset:1024 sc1
v_mfma_f32_16x16x32_bf16 v[144:147], a[108:111], a[36:39], v[144:147]
ds_read_b128 a[148:151], v5 offset:7168
v_mfma_f32_16x16x32_bf16 v[144:147], a[104:107], a[32:35], v[144:147]
v_mfma_f32_16x16x32_bf16 v[148:151], a[112:115], a[32:35], v[148:151]
v_mfma_f32_16x16x32_bf16 v[148:151], a[116:119], a[36:39], v[148:151]
buffer_load_dwordx4 v1, s[4:7], s44 offen offset:0 sc1 lds
v_mfma_f32_16x16x32_bf16 v[172:175], a[116:119], a[44:47], v[172:175]
ds_write_b128 v231, a[196:199] offset:8192
v_mfma_f32_16x16x32_bf16 v[172:175], a[112:115], a[40:43], v[172:175]
v_mfma_f32_16x16x32_bf16 v[196:199], a[112:115], a[48:51], v[196:199]
v_mfma_f32_16x16x32_bf16 v[196:199], a[116:119], a[52:55], v[196:199]
L_stub0:
s_cbranch_execz L_wret0
buffer_load_dwordx4 a[12:15], v2, s[40:43], s33 offen offset:1024 sc1
v_mfma_f32_16x16x32_bf16 v[220:223], a[116:119], a[60:63], v[220:223]
v_mfma_f32_16x16x32_bf16 v[220:223], a[112:115], a[56:59], v[220:223]
s_waitcnt lgkmcnt(1)
v_mfma_f32_16x16x32_bf16 v[224:227], a[128:131], a[56:59], v[224:227]
ds_read_b128 a[96:99], v5 offset:14336
v_mfma_f32_16x16x32_bf16 v[224:227], a[132:135], a[60:63], v[224:227]
buffer_load_dwordx4 a[16:19], v2, s[40:43], s35 offen offset:2048 sc1
v_mfma_f32_16x16x32_bf16 v[200:203], a[132:135], a[52:55], v[200:203]
ds_read_b128 a[100:103], v5 offset:20480
v_mfma_f32_16x16x32_bf16 v[200:203], a[128:131], a[48:51], v[200:203]
v_mfma_f32_16x16x32_bf16 v[176:179], a[128:131], a[40:43], v[176:179]
v_mfma_f32_16x16x32_bf16 v[176:179], a[132:135], a[44:47], v[176:179]
buffer_load_dwordx4 v1, s[4:7], s44 offen offset:1024 sc1 lds
s_add_u32 s88, s82, 0x1700000
v_mfma_f32_16x16x32_bf16 v[152:155], a[132:135], a[36:39], v[152:155]
ds_read_b128 a[104:107], v5 offset:15360
v_mfma_f32_16x16x32_bf16 v[152:155], a[128:131], a[32:35], v[152:155]
ds_write_b128 v231, a[200:203] offset:9216
v_mfma_f32_16x16x32_bf16 v[132:135], a[136:139], a[32:35], v[132:135]
ds_read_b128 a[108:111], v5 offset:21504
v_mfma_f32_16x16x32_bf16 v[132:135], a[140:143], a[36:39], v[132:135]
buffer_load_dwordx4 a[20:23], v2, s[40:43], s33 offen offset:2048 sc1
v_mfma_f32_16x16x32_bf16 v[156:159], a[140:143], a[44:47], v[156:159]
ds_read_b128 a[112:115], v5 offset:16384
v_mfma_f32_16x16x32_bf16 v[156:159], a[136:139], a[40:43], v[156:159]
v_mfma_f32_16x16x32_bf16 v[180:183], a[136:139], a[48:51], v[180:183]
v_mfma_f32_16x16x32_bf16 v[180:183], a[140:143], a[52:55], v[180:183]
buffer_load_dwordx4 a[24:27], v2, s[40:43], s35 offen offset:3072 sc1
v_mfma_f32_16x16x32_bf16 v[204:207], a[140:143], a[60:63], v[204:207]
ds_read_b128 a[116:119], v5 offset:22528
v_mfma_f32_16x16x32_bf16 v[204:207], a[136:139], a[56:59], v[204:207]
ds_write_b128 v231, a[204:207] offset:16384
v_mfma_f32_16x16x32_bf16 v[208:211], a[144:147], a[56:59], v[208:211]
v_mfma_f32_16x16x32_bf16 v[208:211], a[148:151], a[60:63], v[208:211]
buffer_load_dwordx4 v[92:95], v1, s[4:7], s88 offen offset:0 sc1
v_mfma_f32_16x16x32_bf16 v[184:187], a[148:151], a[52:55], v[184:187]
v_mfma_f32_16x16x32_bf16 v[184:187], a[144:147], a[48:51], v[184:187]
v_mfma_f32_16x16x32_bf16 v[160:163], a[144:147], a[40:43], v[160:163]
v_mfma_f32_16x16x32_bf16 v[160:163], a[148:151], a[44:47], v[160:163]
buffer_load_dwordx4 a[28:31], v2, s[40:43], s33 offen offset:3072 sc1
s_add_u32 s35, s35, 0x2000
v_mfma_f32_16x16x32_bf16 v[136:139], a[148:151], a[36:39], v[136:139]
s_add_u32 s33, s33, 0x2000
v_mfma_f32_16x16x32_bf16 v[136:139], a[144:147], a[32:35], v[136:139]
s_waitcnt vmcnt(12) lgkmcnt(1)
v_mfma_f32_16x16x32_bf16 v[140:143], a[96:99], a[64:67], v[140:143]
ds_read_b128 a[128:131], v5 offset:17408
v_mfma_f32_16x16x32_bf16 v[140:143], a[100:103], a[68:71], v[140:143]
buffer_load_dwordx4 a[32:35], v2, s[40:43], s35 offen offset:0 sc1
v_mfma_f32_16x16x32_bf16 v[164:167], a[100:103], a[76:79], v[164:167]
ds_read_b128 a[132:135], v5 offset:23552
v_mfma_f32_16x16x32_bf16 v[164:167], a[96:99], a[72:75], v[164:167]
ds_write_b128 v231, a[208:211] offset:17408
v_mfma_f32_16x16x32_bf16 v[188:191], a[96:99], a[80:83], v[188:191]
v_mfma_f32_16x16x32_bf16 v[188:191], a[100:103], a[84:87], v[188:191]
buffer_load_dwordx4 v[96:99], v1, s[4:7], s88 offen offset:1024 sc1
v_mfma_f32_16x16x32_bf16 v[212:215], a[100:103], a[92:95], v[212:215]
ds_read_b128 a[136:139], v5 offset:12288
v_mfma_f32_16x16x32_bf16 v[212:215], a[96:99], a[88:91], v[212:215]
v_mfma_f32_16x16x32_bf16 v[216:219], a[104:107], a[88:91], v[216:219]
ds_read_b128 a[140:143], v5 offset:18432
v_mfma_f32_16x16x32_bf16 v[216:219], a[108:111], a[92:95], v[216:219]
buffer_load_dwordx4 a[36:39], v2, s[40:43], s33 offen offset:0 sc1
v_mfma_f32_16x16x32_bf16 v[192:195], a[108:111], a[84:87], v[192:195]
ds_read_b128 a[144:147], v5 offset:13312
v_mfma_f32_16x16x32_bf16 v[192:195], a[104:107], a[80:83], v[192:195]
v_mfma_f32_16x16x32_bf16 v[168:171], a[104:107], a[72:75], v[168:171]
v_mfma_f32_16x16x32_bf16 v[168:171], a[108:111], a[76:79], v[168:171]
buffer_load_dwordx4 a[40:43], v2, s[40:43], s35 offen offset:1024 sc1
v_mfma_f32_16x16x32_bf16 v[144:147], a[108:111], a[68:71], v[144:147]
ds_read_b128 a[148:151], v5 offset:19456
v_mfma_f32_16x16x32_bf16 v[144:147], a[104:107], a[64:67], v[144:147]
v_mfma_f32_16x16x32_bf16 v[148:151], a[112:115], a[64:67], v[148:151]
v_mfma_f32_16x16x32_bf16 v[148:151], a[116:119], a[68:71], v[148:151]
buffer_load_dwordx4 v[100:103], v1, s[4:7], s88 offen offset:2048 sc1
v_mfma_f32_16x16x32_bf16 v[172:175], a[116:119], a[76:79], v[172:175]
v_mfma_f32_16x16x32_bf16 v[172:175], a[112:115], a[72:75], v[172:175]
v_mfma_f32_16x16x32_bf16 v[196:199], a[112:115], a[80:83], v[196:199]
v_mfma_f32_16x16x32_bf16 v[196:199], a[116:119], a[84:87], v[196:199]
buffer_load_dwordx4 a[44:47], v2, s[40:43], s33 offen offset:1024 sc1
v_mfma_f32_16x16x32_bf16 v[220:223], a[116:119], a[92:95], v[220:223]
v_mfma_f32_16x16x32_bf16 v[220:223], a[112:115], a[88:91], v[220:223]
s_waitcnt lgkmcnt(0)
s_barrier
v_mfma_f32_16x16x32_bf16 v[224:227], a[128:131], a[88:91], v[224:227]
ds_read_b128 a[96:99], v5 offset:26624
v_mfma_f32_16x16x32_bf16 v[224:227], a[132:135], a[92:95], v[224:227]
buffer_load_dwordx4 a[48:51], v2, s[40:43], s35 offen offset:2048 sc1
v_mfma_f32_16x16x32_bf16 v[200:203], a[132:135], a[84:87], v[200:203]
ds_read_b128 a[100:103], v5 offset:32768
v_mfma_f32_16x16x32_bf16 v[200:203], a[128:131], a[80:83], v[200:203]
ds_read_b64_tr_b16 a[220:221], v230 offset:0
v_mfma_f32_16x16x32_bf16 v[176:179], a[128:131], a[72:75], v[176:179]
v_mfma_f32_16x16x32_bf16 v[176:179], a[132:135], a[76:79], v[176:179]
buffer_load_dwordx4 v[104:107], v1, s[4:7], s88 offen offset:3072 sc1
s_add_u32 s88, s88, 4096
v_mfma_f32_16x16x32_bf16 v[152:155], a[132:135], a[68:71], v[152:155]
ds_read_b128 a[104:107], v5 offset:27648
v_mfma_f32_16x16x32_bf16 v[152:155], a[128:131], a[64:67], v[152:155]
ds_read_b64_tr_b16 a[222:223], v230 offset:2048
v_mfma_f32_16x16x32_bf16 v[132:135], a[136:139], a[64:67], v[132:135]
ds_read_b128 a[108:111], v5 offset:33792
v_mfma_f32_16x16x32_bf16 v[132:135], a[140:143], a[68:71], v[132:135]
buffer_load_dwordx4 a[52:55], v2, s[40:43], s33 offen offset:2048 sc1
v_mfma_f32_16x16x32_bf16 v[156:159], a[140:143], a[76:79], v[156:159]
ds_read_b128 a[112:115], v5 offset:28672
v_mfma_f32_16x16x32_bf16 v[156:159], a[136:139], a[72:75], v[156:159]
ds_read_b64_tr_b16 a[224:225], v230 offset:8
v_mfma_f32_16x16x32_bf16 v[180:183], a[136:139], a[80:83], v[180:183]
v_mfma_f32_16x16x32_bf16 v[180:183], a[140:143], a[84:87], v[180:183]
buffer_load_dwordx4 a[56:59], v2, s[40:43], s35 offen offset:3072 sc1
v_mfma_f32_16x16x32_bf16 v[204:207], a[140:143], a[92:95], v[204:207]
ds_read_b128 a[116:119], v5 offset:34816
v_mfma_f32_16x16x32_bf16 v[204:207], a[136:139], a[88:91], v[204:207]
v_mfma_f32_16x16x32_bf16 v[208:211], a[144:147], a[88:91], v[208:211]
ds_read_b64_tr_b16 a[226:227], v230 offset:2056
v_mfma_f32_16x16x32_bf16 v[208:211], a[148:151], a[92:95], v[208:211]
buffer_load_dwordx4 v[108:111], v1, s[4:7], s88 offen offset:0 sc1
v_mfma_f32_16x16x32_bf16 v[184:187], a[148:151], a[84:87], v[184:187]
v_mfma_f32_16x16x32_bf16 v[184:187], a[144:147], a[80:83], v[184:187]
v_mfma_f32_16x16x32_bf16 v[160:163], a[144:147], a[72:75], v[160:163]
v_mfma_f32_16x16x32_bf16 v[160:163], a[148:151], a[76:79], v[160:163]
buffer_load_dwordx4 a[60:63], v2, s[40:43], s33 offen offset:3072 sc1
s_add_u32 s35, s35, 0x2000
v_mfma_f32_16x16x32_bf16 v[136:139], a[148:151], a[68:71], v[136:139]
s_add_u32 s33, s33, 0x2000
ds_read_b64_tr_b16 a[188:189], v248 offset:0
v_mfma_f32_16x16x32_bf16 v[136:139], a[144:147], a[64:67], v[136:139]
s_waitcnt vmcnt(12) lgkmcnt(2)
v_mfma_f32_16x16x32_bf16 v[140:143], a[96:99], a[0:3], v[140:143]
ds_read_b128 a[128:131], v5 offset:29696
v_add_f32_dpp v48, v48, v48 row_ror:8 row_mask:0xf bank_mask:0xf
v_mfma_f32_16x16x32_bf16 v[140:143], a[100:103], a[4:7], v[140:143]
buffer_load_dwordx4 a[64:67], v2, s[40:43], s35 offen offset:0 sc1
v_mfma_f32_16x16x32_bf16 v[164:167], a[100:103], a[12:15], v[164:167]
ds_read_b128 a[132:135], v5 offset:35840
v_add_f32_dpp v49, v49, v49 row_ror:8 row_mask:0xf bank_mask:0xf
v_mfma_f32_16x16x32_bf16 v[164:167], a[96:99], a[8:11], v[164:167]
ds_read_b64_tr_b16 a[190:191], v248 offset:512
v_add_f32_dpp v50, v50, v50 row_ror:8 row_mask:0xf bank_mask:0xf
v_mfma_f32_16x16x32_bf16 v[188:191], a[96:99], a[16:19], v[188:191]
v_add_f32_dpp v51, v51, v51 row_ror:8 row_mask:0xf bank_mask:0xf
v_add_f32_dpp v52, v52, v52 row_ror:8 row_mask:0xf bank_mask:0xf
v_mfma_f32_16x16x32_bf16 v[188:191], a[100:103], a[20:23], v[188:191]
buffer_load_dwordx4 v[112:115], v1, s[4:7], s88 offen offset:1024 sc1
v_mfma_f32_16x16x32_bf16 v[212:215], a[100:103], a[28:31], v[212:215]
ds_read_b128 a[136:139], v5 offset:24576
v_add_f32_dpp v53, v53, v53 row_ror:8 row_mask:0xf bank_mask:0xf
v_mfma_f32_16x16x32_bf16 v[212:215], a[96:99], a[24:27], v[212:215]
v_add_f32_dpp v54, v54, v54 row_ror:8 row_mask:0xf bank_mask:0xf
v_add_f32_dpp v55, v55, v55 row_ror:8 row_mask:0xf bank_mask:0xf
v_mfma_f32_16x16x32_bf16 v[216:219], a[104:107], a[24:27], v[216:219]
ds_read_b128 a[140:143], v5 offset:30720
v_add_f32_dpp v48, v48, v48 row_ror:4 row_mask:0xf bank_mask:0xf
v_mfma_f32_16x16x32_bf16 v[216:219], a[108:111], a[28:31], v[216:219]
buffer_load_dwordx4 a[68:71], v2, s[40:43], s33 offen offset:0 sc1
v_mfma_f32_16x16x32_bf16 v[192:195], a[108:111], a[20:23], v[192:195]
ds_read_b128 a[144:147], v5 offset:25600
v_add_f32_dpp v49, v49, v49 row_ror:4 row_mask:0xf bank_mask:0xf
v_mfma_f32_16x16x32_bf16 v[192:195], a[104:107], a[16:19], v[192:195]
ds_read_b64_tr_b16 a[192:193], v248 offset:4096
v_add_f32_dpp v50, v50, v50 row_ror:4 row_mask:0xf bank_mask:0xf
v_mfma_f32_16x16x32_bf16 v[168:171], a[104:107], a[8:11], v[168:171]
v_add_f32_dpp v51, v51, v51 row_ror:4 row_mask:0xf bank_mask:0xf
v_add_f32_dpp v52, v52, v52 row_ror:4 row_mask:0xf bank_mask:0xf
v_mfma_f32_16x16x32_bf16 v[168:171], a[108:111], a[12:15], v[168:171]
buffer_load_dwordx4 a[72:75], v2, s[40:43], s35 offen offset:1024 sc1
v_mfma_f32_16x16x32_bf16 v[144:147], a[108:111], a[4:7], v[144:147]
ds_read_b128 a[148:151], v5 offset:31744
v_add_f32_dpp v53, v53, v53 row_ror:4 row_mask:0xf bank_mask:0xf
v_mfma_f32_16x16x32_bf16 v[144:147], a[104:107], a[0:3], v[144:147]
ds_read_b64_tr_b16 a[194:195], v248 offset:4608
v_add_f32_dpp v54, v54, v54 row_ror:4 row_mask:0xf bank_mask:0xf
v_mfma_f32_16x16x32_bf16 v[148:151], a[112:115], a[0:3], v[148:151]
v_add_f32_dpp v55, v55, v55 row_ror:4 row_mask:0xf bank_mask:0xf
v_add_f32_dpp v48, v48, v48 row_ror:2 row_mask:0xf bank_mask:0xf
v_mfma_f32_16x16x32_bf16 v[148:151], a[116:119], a[4:7], v[148:151]
buffer_load_dwordx4 v[116:119], v1, s[4:7], s88 offen offset:2048 sc1
v_mfma_f32_16x16x32_bf16 v[172:175], a[116:119], a[12:15], v[172:175]
v_add_f32_dpp v49, v49, v49 row_ror:2 row_mask:0xf bank_mask:0xf
v_add_f32_dpp v50, v50, v50 row_ror:2 row_mask:0xf bank_mask:0xf
v_mfma_f32_16x16x32_bf16 v[172:175], a[112:115], a[8:11], v[172:175]
v_add_f32_dpp v51, v51, v51 row_ror:2 row_mask:0xf bank_mask:0xf
v_add_f32_dpp v52, v52, v52 row_ror:2 row_mask:0xf bank_mask:0xf
v_mfma_f32_16x16x32_bf16 v[196:199], a[112:115], a[16:19], v[196:199]
ds_read_b64_tr_b16 a[196:197], v249 offset:32
v_add_f32_dpp v53, v53, v53 row_ror:2 row_mask:0xf bank_mask:0xf
v_mfma_f32_16x16x32_bf16 v[196:199], a[116:119], a[20:23], v[196:199]
buffer_load_dwordx4 a[76:79], v2, s[40:43], s33 offen offset:1024 sc1
v_mfma_f32_16x16x32_bf16 v[220:223], a[116:119], a[28:31], v[220:223]
v_add_f32_dpp v54, v54, v54 row_ror:2 row_mask:0xf bank_mask:0xf
v_add_f32_dpp v55, v55, v55 row_ror:2 row_mask:0xf bank_mask:0xf
v_mfma_f32_16x16x32_bf16 v[220:223], a[112:115], a[24:27], v[220:223]
v_add_f32_dpp v48, v48, v48 row_ror:1 row_mask:0xf bank_mask:0xf
s_waitcnt lgkmcnt(2)
v_mfma_f32_16x16x32_bf16 v[224:227], a[128:131], a[24:27], v[224:227]
ds_read_b128 a[96:99], v5 offset:38912
v_add_f32_dpp v49, v49, v49 row_ror:1 row_mask:0xf bank_mask:0xf
v_mfma_f32_16x16x32_bf16 v[224:227], a[132:135], a[28:31], v[224:227]
buffer_load_dwordx4 a[80:83], v2, s[40:43], s35 offen offset:2048 sc1
v_mfma_f32_16x16x32_bf16 v[200:203], a[132:135], a[20:23], v[200:203]
ds_read_b128 a[100:103], v5 offset:45056
v_add_f32_dpp v50, v50, v50 row_ror:1 row_mask:0xf bank_mask:0xf
v_mfma_f32_16x16x32_bf16 v[200:203], a[128:131], a[16:19], v[200:203]
ds_read_b64_tr_b16 a[198:199], v249 offset:544
v_add_f32_dpp v51, v51, v51 row_ror:1 row_mask:0xf bank_mask:0xf
v_mfma_f32_16x16x32_bf16 v[176:179], a[128:131], a[8:11], v[176:179]
buffer_load_dwordx4 v[120:123], v1, s[4:7], s88 offen offset:3072 sc1
s_add_u32 m0, s18, 0x1e000
v_mfma_f32_16x16x32_bf16 v[176:179], a[132:135], a[12:15], v[176:179]
s_add_u32 s44, s50, 0x201e000
ds_read_b128 a[104:107], v5 offset:39936
v_mfma_f32_16x16x32_bf16 v[152:155], a[132:135], a[4:7], v[152:155]
v_add_f32_dpp v52, v52, v52 row_ror:1 row_mask:0xf bank_mask:0xf
v_add_f32_dpp v53, v53, v53 row_ror:1 row_mask:0xf bank_mask:0xf
v_mfma_f32_16x16x32_bf16 v[152:155], a[128:131], a[0:3], v[152:155]
buffer_load_dwordx4 a[84:87], v2, s[40:43], s33 offen offset:2048 sc1
v_mfma_f32_16x16x32_bf16 v[132:135], a[136:139], a[0:3], v[132:135]
ds_read_b128 a[108:111], v5 offset:46080
v_add_f32_dpp v54, v54, v54 row_ror:1 row_mask:0xf bank_mask:0xf
v_mfma_f32_16x16x32_bf16 v[132:135], a[140:143], a[4:7], v[132:135]
ds_read_b64_tr_b16 a[200:201], v249 offset:4128
v_add_f32_dpp v55, v55, v55 row_ror:1 row_mask:0xf bank_mask:0xf
v_mfma_f32_16x16x32_bf16 v[156:159], a[140:143], a[12:15], v[156:159]
ds_read_b128 a[112:115], v5 offset:40960
v_add_u32 v233, 159744, v233
v_mfma_f32_16x16x32_bf16 v[156:159], a[136:139], a[8:11], v[156:159]
buffer_load_dwordx4 v1, s[4:7], s44 offen offset:0 sc1 lds
s_lshl_b32 s36, s28, 6
v_mfma_f32_16x16x32_bf16 v[180:183], a[136:139], a[16:19], v[180:183]
ds_read_b64_tr_b16 a[202:203], v249 offset:4640
s_lshl_b32 s37, s39, 6
v_mfma_f32_16x16x32_bf16 v[180:183], a[140:143], a[20:23], v[180:183]
ds_read_b128 a[116:119], v5 offset:47104
v_add_u32 v232, s36, v233
v_mfma_f32_16x16x32_bf16 v[204:207], a[140:143], a[28:31], v[204:207]
buffer_load_dwordx4 a[88:91], v2, s[40:43], s35 offen offset:3072 sc1
v_mfma_f32_16x16x32_bf16 v[204:207], a[136:139], a[24:27], v[204:207]
v_add_u32 v235, s37, v233
v_mfma_f32_16x16x32_bf16 v[208:211], a[144:147], a[24:27], v[208:211]
v_mfma_f32_16x16x32_bf16 v[208:211], a[148:151], a[28:31], v[208:211]
v_mfma_f32_16x16x32_bf16 v[184:187], a[148:151], a[20:23], v[184:187]
buffer_load_dwordx4 v1, s[4:7], s44 offen offset:1024 sc1 lds
s_add_u32 m0, s18, 0x20000
v_mfma_f32_16x16x32_bf16 v[184:187], a[144:147], a[16:19], v[184:187]
s_add_u32 s44, s50, 0x2020000
ds_read_b64_tr_b16 a[204:205], v248 offset:8192
v_mfma_f32_16x16x32_bf16 v[160:163], a[144:147], a[8:11], v[160:163]
v_mfma_f32_16x16x32_bf16 v[160:163], a[148:151], a[12:15], v[160:163]
buffer_load_dwordx4 a[92:95], v2, s[40:43], s33 offen offset:3072 sc1
s_add_u32 s35, s35, 0x2000
v_mfma_f32_16x16x32_bf16 v[136:139], a[148:151], a[4:7], v[136:139]
s_add_u32 s33, s33, 0x2000
v_mfma_f32_16x16x32_bf16 v[136:139], a[144:147], a[0:3], v[136:139]
ds_read_b64_tr_b16 a[206:207], v248 offset:8704
s_waitcnt vmcnt(13) lgkmcnt(2)
v_mfma_f32_16x16x32_bf16 v[140:143], a[96:99], a[32:35], v[140:143]
ds_read_b128 a[128:131], v5 offset:41984
v_mfma_f32_16x16x32_bf16 v[140:143], a[100:103], a[36:39], v[140:143]
buffer_load_dwordx4 a[0:3], v2, s[40:43], s35 offen offset:0 sc1
v_mfma_f32_16x16x32_bf16 v[164:167], a[100:103], a[44:47], v[164:167]
ds_read_b128 a[132:135], v5 offset:48128
v_mfma_f32_16x16x32_bf16 v[164:167], a[96:99], a[40:43], v[164:167]
ds_write_b128 v232, v[48:51]
v_mfma_f32_16x16x32_bf16 v[188:191], a[96:99], a[48:51], v[188:191]
ds_write_b128 v235, v[52:55]
v_mfma_f32_16x16x32_bf16 v[188:191], a[100:103], a[52:55], v[188:191]
buffer_load_dwordx4 v1, s[4:7], s44 offen offset:0 sc1 lds
v_mfma_f32_16x16x32_bf16 v[212:215], a[100:103], a[60:63], v[212:215]
ds_read_b128 a[136:139], v5 offset:36864
v_mfma_f32_16x16x32_bf16 v[212:215], a[96:99], a[56:59], v[212:215]
ds_read_b64_tr_b16 a[208:209], v248 offset:12288
v_mfma_f32_16x16x32_bf16 v[216:219], a[104:107], a[56:59], v[216:219]
ds_read_b128 a[140:143], v5 offset:43008
v_mfma_f32_16x16x32_bf16 v[216:219], a[108:111], a[60:63], v[216:219]
buffer_load_dwordx4 a[4:7], v2, s[40:43], s33 offen offset:0 sc1
v_mfma_f32_16x16x32_bf16 v[192:195], a[108:111], a[52:55], v[192:195]
ds_read_b128 a[144:147], v5 offset:37888
v_mfma_f32_16x16x32_bf16 v[192:195], a[104:107], a[48:51], v[192:195]
ds_read_b64_tr_b16 a[210:211], v248 offset:12800
v_mfma_f32_16x16x32_bf16 v[168:171], a[104:107], a[40:43], v[168:171]
v_mfma_f32_16x16x32_bf16 v[168:171], a[108:111], a[44:47], v[168:171]
ds_read_b128 a[148:151], v5 offset:44032
v_mfma_f32_16x16x32_bf16 v[144:147], a[108:111], a[36:39], v[144:147]
buffer_load_dwordx4 a[8:11], v2, s[40:43], s35 offen offset:1024 sc1
v_mfma_f32_16x16x32_bf16 v[144:147], a[104:107], a[32:35], v[144:147]
v_mfma_f32_16x16x32_bf16 v[148:151], a[112:115], a[32:35], v[148:151]
v_mfma_f32_16x16x32_bf16 v[148:151], a[116:119], a[36:39], v[148:151]
v_mfma_f32_16x16x32_bf16 v[172:175], a[116:119], a[44:47], v[172:175]
buffer_load_dword v11, v1, s[24:27], 0 offen sc1
v_mfma_f32_16x16x32_bf16 v[172:175], a[112:115], a[40:43], v[172:175]
v_mfma_f32_16x16x32_bf16 v[196:199], a[112:115], a[48:51], v[196:199]
buffer_load_dwordx4 a[12:15], v2, s[40:43], s33 offen offset:1024 sc1
v_mfma_f32_16x16x32_bf16 v[196:199], a[116:119], a[52:55], v[196:199]
v_mfma_f32_16x16x32_bf16 v[220:223], a[116:119], a[60:63], v[220:223]
v_mfma_f32_16x16x32_bf16 v[220:223], a[112:115], a[56:59], v[220:223]
s_waitcnt lgkmcnt(0)
s_barrier
v_mfma_f32_16x16x32_bf16 v[224:227], a[128:131], a[56:59], v[224:227]
v_add_u32 v5, 98304, v1
v_mfma_f32_16x16x32_bf16 v[224:227], a[132:135], a[60:63], v[224:227]
buffer_load_dwordx4 a[16:19], v2, s[40:43], s35 offen offset:2048 sc1
v_mfma_f32_16x16x32_bf16 v[200:203], a[132:135], a[52:55], v[200:203]
ds_read_b128 a[96:99], v5 offset:2048
v_mfma_f32_16x16x32_bf16 v[200:203], a[128:131], a[48:51], v[200:203]
ds_read_b128 a[100:103], v5 offset:8192
v_mfma_f32_16x16x32_bf16 v[176:179], a[128:131], a[40:43], v[176:179]
ds_read_b128 v[48:51], v233 offset:0
v_mfma_f32_16x16x32_bf16 v[176:179], a[132:135], a[44:47], v[176:179]
buffer_load_dwordx4 v1, s[4:7], s44 offen offset:1024 sc1 lds
s_add_u32 m0, s18, 0x22000
v_mfma_f32_16x16x32_bf16 v[152:155], a[132:135], a[36:39], v[152:155]
s_add_u32 s44, s50, 0x2022000
ds_read_b128 a[104:107], v5 offset:3072
v_mfma_f32_16x16x32_bf16 v[152:155], a[128:131], a[32:35], v[152:155]
v_mfma_f32_16x16x32_bf16 v[132:135], a[136:139], a[32:35], v[132:135]
ds_read_b128 a[108:111], v5 offset:9216
v_mfma_f32_16x16x32_bf16 v[132:135], a[140:143], a[36:39], v[132:135]
buffer_load_dwordx4 a[20:23], v2, s[40:43], s33 offen offset:2048 sc1
v_mfma_f32_16x16x32_bf16 v[156:159], a[140:143], a[44:47], v[156:159]
ds_read_b128 a[112:115], v5 offset:4096
v_mfma_f32_16x16x32_bf16 v[156:159], a[136:139], a[40:43], v[156:159]
ds_read_b128 v[52:55], v233 offset:64
v_mfma_f32_16x16x32_bf16 v[180:183], a[136:139], a[48:51], v[180:183]
v_mfma_f32_16x16x32_bf16 v[180:183], a[140:143], a[52:55], v[180:183]
buffer_load_dwordx4 a[24:27], v2, s[40:43], s35 offen offset:3072 sc1
v_mfma_f32_16x16x32_bf16 v[204:207], a[140:143], a[60:63], v[204:207]
ds_read_b128 a[116:119], v5 offset:10240
v_mfma_f32_16x16x32_bf16 v[204:207], a[136:139], a[56:59], v[204:207]
v_mfma_f32_16x16x32_bf16 v[208:211], a[144:147], a[56:59], v[208:211]
v_mfma_f32_16x16x32_bf16 v[208:211], a[148:151], a[60:63], v[208:211]
buffer_load_dwordx4 v1, s[4:7], s44 offen offset:0 sc1 lds
v_mfma_f32_16x16x32_bf16 v[184:187], a[148:151], a[52:55], v[184:187]
v_mfma_f32_16x16x32_bf16 v[184:187], a[144:147], a[48:51], v[184:187]
v_mfma_f32_16x16x32_bf16 v[160:163], a[144:147], a[40:43], v[160:163]
v_mfma_f32_16x16x32_bf16 v[160:163], a[148:151], a[44:47], v[160:163]
buffer_load_dwordx4 a[28:31], v2, s[40:43], s33 offen offset:3072 sc1
s_add_u32 s35, s35, 0x2000
v_mfma_f32_16x16x32_bf16 v[136:139], a[148:151], a[36:39], v[136:139]
s_add_u32 s33, s33, 0x2000
ds_read_b128 v[56:59], v233 offset:128
v_mfma_f32_16x16x32_bf16 v[136:139], a[144:147], a[32:35], v[136:139]
s_waitcnt vmcnt(12) lgkmcnt(1)
v_mfma_f32_16x16x32_bf16 v[140:143], a[96:99], a[64:67], v[140:143]
ds_read_b128 a[128:131], v5 offset:5120
v_mfma_f32_16x16x32_bf16 v[140:143], a[100:103], a[68:71], v[140:143]
buffer_load_dwordx4 a[32:35], v2, s[40:43], s35 offen offset:0 sc1
v_mfma_f32_16x16x32_bf16 v[164:167], a[100:103], a[76:79], v[164:167]
ds_read_b128 a[132:135], v5 offset:11264
v_mfma_f32_16x16x32_bf16 v[164:167], a[96:99], a[72:75], v[164:167]
v_mfma_f32_16x16x32_bf16 v[236:239], a[188:191], v[16:19], 0
v_mfma_f32_16x16x32_bf16 v[188:191], a[96:99], a[80:83], v[188:191]
v_mfma_f32_16x16x32_bf16 v[240:243], a[196:199], v[16:19], 0
v_mfma_f32_16x16x32_bf16 v[188:191], a[100:103], a[84:87], v[188:191]
buffer_load_dwordx4 v1, s[4:7], s44 offen offset:1024 sc1 lds
s_add_u32 m0, s18, 0x0
v_mfma_f32_16x16x32_bf16 v[212:215], a[100:103], a[92:95], v[212:215]
s_add_u32 s44, s50, 0x2024000
ds_read_b128 a[136:139], v5 offset:0
v_mfma_f32_16x16x32_bf16 v[212:215], a[96:99], a[88:91], v[212:215]
v_mfma_f32_16x16x32_bf16 v[216:219], a[104:107], a[88:91], v[216:219]
ds_read_b128 a[140:143], v5 offset:6144
v_mfma_f32_16x16x32_bf16 v[216:219], a[108:111], a[92:95], v[216:219]
buffer_load_dwordx4 a[36:39], v2, s[40:43], s33 offen offset:0 sc1
v_mfma_f32_16x16x32_bf16 v[192:195], a[108:111], a[84:87], v[192:195]
ds_read_b128 a[144:147], v5 offset:1024
v_mfma_f32_16x16x32_bf16 v[192:195], a[104:107], a[80:83], v[192:195]
v_mfma_f32_16x16x32_bf16 v[244:247], a[204:207], v[16:19], 0
v_mfma_f32_16x16x32_bf16 v[168:171], a[104:107], a[72:75], v[168:171]
v_mfma_f32_16x16x32_bf16 v[236:239], a[192:195], v[16:19], v[236:239]
v_mfma_f32_16x16x32_bf16 v[168:171], a[108:111], a[76:79], v[168:171]
buffer_load_dwordx4 a[40:43], v2, s[40:43], s35 offen offset:1024 sc1
v_mfma_f32_16x16x32_bf16 v[144:147], a[108:111], a[68:71], v[144:147]
ds_read_b128 a[148:151], v5 offset:7168
v_mfma_f32_16x16x32_bf16 v[144:147], a[104:107], a[64:67], v[144:147]
ds_read_b128 v[60:63], v233 offset:192
v_mfma_f32_16x16x32_bf16 v[148:151], a[112:115], a[64:67], v[148:151]
v_mfma_f32_16x16x32_bf16 v[240:243], a[200:203], v[16:19], v[240:243]
v_mfma_f32_16x16x32_bf16 v[148:151], a[116:119], a[68:71], v[148:151]
buffer_load_dwordx4 v1, s[4:7], s44 offen offset:0 sc1 lds
v_mfma_f32_16x16x32_bf16 v[172:175], a[116:119], a[76:79], v[172:175]
ds_read_b128 v[64:67], v233 offset:256
v_mfma_f32_16x16x32_bf16 v[172:175], a[112:115], a[72:75], v[172:175]
v_mfma_f32_16x16x32_bf16 v[196:199], a[112:115], a[80:83], v[196:199]
v_mfma_f32_16x16x32_bf16 v[244:247], a[208:211], v[16:19], v[244:247]
v_mfma_f32_16x16x32_bf16 v[196:199], a[116:119], a[84:87], v[196:199]
buffer_load_dwordx4 a[44:47], v2, s[40:43], s33 offen offset:1024 sc1
v_mfma_f32_16x16x32_bf16 v[220:223], a[116:119], a[92:95], v[220:223]
v_mfma_f32_16x16x32_bf16 v[220:223], a[112:115], a[88:91], v[220:223]
s_waitcnt lgkmcnt(2)
v_mfma_f32_16x16x32_bf16 v[224:227], a[128:131], a[88:91], v[224:227]
ds_read_b128 a[96:99], v5 offset:14336
v_mfma_f32_16x16x32_bf16 v[224:227], a[132:135], a[92:95], v[224:227]
buffer_load_dwordx4 a[48:51], v2, s[40:43], s35 offen offset:2048 sc1
v_mfma_f32_16x16x32_bf16 v[200:203], a[132:135], a[84:87], v[200:203]
ds_read_b128 a[100:103], v5 offset:20480
v_mfma_f32_16x16x32_bf16 v[200:203], a[128:131], a[80:83], v[200:203]
v_mfma_f32_16x16x32_bf16 v[176:179], a[128:131], a[72:75], v[176:179]
buffer_load_dwordx4 v1, s[4:7], s44 offen offset:1024 sc1 lds
s_add_u32 m0, s18, 0x2000
v_mfma_f32_16x16x32_bf16 v[176:179], a[132:135], a[76:79], v[176:179]
s_add_u32 s44, s50, 0x2026000
ds_read_b128 a[104:107], v5 offset:15360
v_mfma_f32_16x16x32_bf16 v[152:155], a[132:135], a[68:71], v[152:155]
ds_read_b128 v[68:71], v233 offset:320
v_mfma_f32_16x16x32_bf16 v[152:155], a[128:131], a[64:67], v[152:155]
buffer_load_dwordx4 a[52:55], v2, s[40:43], s33 offen offset:2048 sc1
v_mfma_f32_16x16x32_bf16 v[132:135], a[136:139], a[64:67], v[132:135]
ds_read_b128 a[108:111], v5 offset:21504
v_mfma_f32_16x16x32_bf16 v[132:135], a[140:143], a[68:71], v[132:135]
v_mfma_f32_16x16x32_bf16 v[156:159], a[140:143], a[76:79], v[156:159]
ds_read_b128 a[112:115], v5 offset:16384
v_mfma_f32_16x16x32_bf16 v[156:159], a[136:139], a[72:75], v[156:159]
buffer_load_dwordx4 v1, s[4:7], s44 offen offset:0 sc1 lds
v_mfma_f32_16x16x32_bf16 v[180:183], a[136:139], a[80:83], v[180:183]
v_mfma_f32_16x16x32_bf16 v[180:183], a[140:143], a[84:87], v[180:183]
ds_read_b128 a[116:119], v5 offset:22528
v_mfma_f32_16x16x32_bf16 v[204:207], a[140:143], a[92:95], v[204:207]
buffer_load_dwordx4 a[56:59], v2, s[40:43], s35 offen offset:3072 sc1
v_mfma_f32_16x16x32_bf16 v[204:207], a[136:139], a[88:91], v[204:207]
v_mfma_f32_16x16x32_bf16 v[208:211], a[144:147], a[88:91], v[208:211]
v_mfma_f32_16x16x32_bf16 v[208:211], a[148:151], a[92:95], v[208:211]
v_mfma_f32_16x16x32_bf16 v[184:187], a[148:151], a[84:87], v[184:187]
buffer_load_dwordx4 v1, s[4:7], s44 offen offset:1024 sc1 lds
s_add_u32 m0, s18, 0x4000
v_mfma_f32_16x16x32_bf16 v[184:187], a[144:147], a[80:83], v[184:187]
s_add_u32 s44, s50, 0x2028000
v_mfma_f32_16x16x32_bf16 v[160:163], a[144:147], a[72:75], v[160:163]
v_mfma_f32_16x16x32_bf16 v[160:163], a[148:151], a[76:79], v[160:163]
buffer_load_dwordx4 a[60:63], v2, s[40:43], s33 offen offset:3072 sc1
s_add_u32 s35, s35, 0x2000
v_mfma_f32_16x16x32_bf16 v[136:139], a[148:151], a[68:71], v[136:139]
s_add_u32 s33, s33, 0x2000
v_mfma_f32_16x16x32_bf16 v[136:139], a[144:147], a[64:67], v[136:139]
s_waitcnt vmcnt(13) lgkmcnt(0)
v_mfma_f32_16x16x32_bf16 v[140:143], a[96:99], a[0:3], v[140:143]
ds_read_b128 a[128:131], v5 offset:17408
v_add_f32 v92, v92, v96
v_mfma_f32_16x16x32_bf16 v[140:143], a[100:103], a[4:7], v[140:143]
buffer_load_dwordx4 a[64:67], v2, s[40:43], s35 offen offset:0 sc1
v_mfma_f32_16x16x32_bf16 v[164:167], a[100:103], a[12:15], v[164:167]
ds_read_b128 a[132:135], v5 offset:23552
v_add_f32 v100, v100, v104
v_mfma_f32_16x16x32_bf16 v[164:167], a[96:99], a[8:11], v[164:167]
v_add_f32 v108, v108, v112
v_add_f32 v116, v116, v120
v_mfma_f32_16x16x32_bf16 v[188:191], a[96:99], a[16:19], v[188:191]
v_add_f32 v93, v93, v97
v_add_f32 v101, v101, v105
v_mfma_f32_16x16x32_bf16 v[188:191], a[100:103], a[20:23], v[188:191]
buffer_load_dwordx4 v1, s[4:7], s44 offen offset:0 sc1 lds
v_mfma_f32_16x16x32_bf16 v[212:215], a[100:103], a[28:31], v[212:215]
ds_read_b128 a[136:139], v5 offset:12288
v_add_f32 v109, v109, v113
v_mfma_f32_16x16x32_bf16 v[212:215], a[96:99], a[24:27], v[212:215]
v_add_f32 v117, v117, v121
v_add_f32 v94, v94, v98
v_mfma_f32_16x16x32_bf16 v[216:219], a[104:107], a[24:27], v[216:219]
ds_read_b128 a[140:143], v5 offset:18432
v_add_f32 v102, v102, v106
v_mfma_f32_16x16x32_bf16 v[216:219], a[108:111], a[28:31], v[216:219]
buffer_load_dwordx4 a[68:71], v2, s[40:43], s33 offen offset:0 sc1
v_mfma_f32_16x16x32_bf16 v[192:195], a[108:111], a[20:23], v[192:195]
ds_read_b128 a[144:147], v5 offset:13312
v_add_f32 v110, v110, v114
v_mfma_f32_16x16x32_bf16 v[192:195], a[104:107], a[16:19], v[192:195]
v_add_f32 v118, v118, v122
v_add_f32 v95, v95, v99
v_mfma_f32_16x16x32_bf16 v[168:171], a[104:107], a[8:11], v[168:171]
v_add_f32 v103, v103, v107
v_mfma_f32_16x16x32_bf16 v[168:171], a[108:111], a[12:15], v[168:171]
buffer_load_dwordx4 a[72:75], v2, s[40:43], s35 offen offset:1024 sc1
v_mfma_f32_16x16x32_bf16 v[144:147], a[108:111], a[4:7], v[144:147]
ds_read_b128 a[148:151], v5 offset:19456
v_add_f32 v111, v111, v115
v_mfma_f32_16x16x32_bf16 v[144:147], a[104:107], a[0:3], v[144:147]
v_add_f32 v119, v119, v123
v_add_f32_dpp v92, v92, v92 row_ror:8 row_mask:0xf bank_mask:0xf
v_mfma_f32_16x16x32_bf16 v[148:151], a[112:115], a[0:3], v[148:151]
v_add_f32_dpp v100, v100, v100 row_ror:8 row_mask:0xf bank_mask:0xf
v_mfma_f32_16x16x32_bf16 v[148:151], a[116:119], a[4:7], v[148:151]
buffer_load_dwordx4 v1, s[4:7], s44 offen offset:1024 sc1 lds
s_add_u32 m0, s18, 0x6000
v_mfma_f32_16x16x32_bf16 v[172:175], a[116:119], a[12:15], v[172:175]
s_add_u32 s44, s50, 0x202a000
v_add_f32_dpp v108, v108, v108 row_ror:8 row_mask:0xf bank_mask:0xf
v_mfma_f32_16x16x32_bf16 v[172:175], a[112:115], a[8:11], v[172:175]
v_add_f32_dpp v116, v116, v116 row_ror:8 row_mask:0xf bank_mask:0xf
v_add_f32_dpp v93, v93, v93 row_ror:8 row_mask:0xf bank_mask:0xf
v_mfma_f32_16x16x32_bf16 v[196:199], a[112:115], a[16:19], v[196:199]
v_add_f32_dpp v101, v101, v101 row_ror:8 row_mask:0xf bank_mask:0xf
v_mfma_f32_16x16x32_bf16 v[196:199], a[116:119], a[20:23], v[196:199]
buffer_load_dwordx4 a[76:79], v2, s[40:43], s33 offen offset:1024 sc1
v_mfma_f32_16x16x32_bf16 v[220:223], a[116:119], a[28:31], v[220:223]
v_add_f32_dpp v109, v109, v109 row_ror:8 row_mask:0xf bank_mask:0xf
v_add_f32_dpp v117, v117, v117 row_ror:8 row_mask:0xf bank_mask:0xf
v_mfma_f32_16x16x32_bf16 v[220:223], a[112:115], a[24:27], v[220:223]
s_waitcnt vmcnt(17) lgkmcnt(0)
s_barrier
v_mfma_f32_16x16x32_bf16 v[224:227], a[128:131], a[24:27], v[224:227]
ds_read_b128 a[96:99], v5 offset:26624
v_add_f32_dpp v92, v94, v94 row_ror:8 row_mask:0xf bank_mask:0xc
v_mfma_f32_16x16x32_bf16 v[224:227], a[132:135], a[28:31], v[224:227]
buffer_load_dwordx4 a[80:83], v2, s[40:43], s35 offen offset:2048 sc1
v_mfma_f32_16x16x32_bf16 v[200:203], a[132:135], a[20:23], v[200:203]
ds_read_b128 a[100:103], v5 offset:32768
v_add_f32_dpp v100, v102, v102 row_ror:8 row_mask:0xf bank_mask:0xc
v_mfma_f32_16x16x32_bf16 v[200:203], a[128:131], a[16:19], v[200:203]
v_add_f32_dpp v108, v110, v110 row_ror:8 row_mask:0xf bank_mask:0xc
v_add_f32_dpp v116, v118, v118 row_ror:8 row_mask:0xf bank_mask:0xc
v_mfma_f32_16x16x32_bf16 v[176:179], a[128:131], a[8:11], v[176:179]
v_add_f32_dpp v93, v95, v95 row_ror:8 row_mask:0xf bank_mask:0xc
v_add_f32_dpp v101, v103, v103 row_ror:8 row_mask:0xf bank_mask:0xc
v_mfma_f32_16x16x32_bf16 v[176:179], a[132:135], a[12:15], v[176:179]
buffer_load_dwordx4 v1, s[4:7], s44 offen offset:0 sc1 lds
v_mfma_f32_16x16x32_bf16 v[152:155], a[132:135], a[4:7], v[152:155]
ds_read_b128 a[104:107], v5 offset:27648
v_add_f32_dpp v109, v111, v111 row_ror:8 row_mask:0xf bank_mask:0xc
v_mfma_f32_16x16x32_bf16 v[152:155], a[128:131], a[0:3], v[152:155]
v_add_f32_dpp v117, v119, v119 row_ror:8 row_mask:0xf bank_mask:0xc
v_mfma_f32_16x16x32_bf16 v[132:135], a[136:139], a[0:3], v[132:135]
ds_read_b128 a[108:111], v5 offset:33792
v_mfma_f32_16x16x32_bf16 v[132:135], a[140:143], a[4:7], v[132:135]
buffer_load_dwordx4 a[84:87], v2, s[40:43], s33 offen offset:2048 sc1
v_mfma_f32_16x16x32_bf16 v[156:159], a[140:143], a[12:15], v[156:159]
ds_read_b128 a[112:115], v5 offset:28672
v_mfma_f32_16x16x32_bf16 v[156:159], a[136:139], a[8:11], v[156:159]
v_permlane32_swap_b32 v92, v93
v_mfma_f32_16x16x32_bf16 v[180:183], a[136:139], a[16:19], v[180:183]
L_stub1:
s_cbranch_execz L_wret0
v_permlane32_swap_b32 v100, v101
v_mfma_f32_16x16x32_bf16 v[180:183], a[140:143], a[20:23], v[180:183]
buffer_load_dwordx4 a[88:91], v2, s[40:43], s35 offen offset:3072 sc1
v_mfma_f32_16x16x32_bf16 v[204:207], a[140:143], a[28:31], v[204:207]
ds_read_b128 a[116:119], v5 offset:34816
v_mfma_f32_16x16x32_bf16 v[204:207], a[136:139], a[24:27], v[204:207]
v_permlane32_swap_b32 v108, v109
v_mfma_f32_16x16x32_bf16 v[208:211], a[144:147], a[24:27], v[208:211]
v_permlane32_swap_b32 v116, v117
v_mfma_f32_16x16x32_bf16 v[208:211], a[148:151], a[28:31], v[208:211]
buffer_load_dwordx4 v1, s[4:7], s44 offen offset:1024 sc1 lds
s_add_u32 m0, s18, 0x8000
v_mfma_f32_16x16x32_bf16 v[184:187], a[148:151], a[20:23], v[184:187]
s_add_u32 s44, s50, 0x202c000
v_add_f32 v92, v92, v93
v_mfma_f32_16x16x32_bf16 v[184:187], a[144:147], a[16:19], v[184:187]
v_add_f32 v100, v100, v101
v_add_f32 v108, v108, v109
v_mfma_f32_16x16x32_bf16 v[160:163], a[144:147], a[8:11], v[160:163]
v_add_f32 v116, v116, v117
v_mov_b32 v94, v92
v_mfma_f32_16x16x32_bf16 v[160:163], a[148:151], a[12:15], v[160:163]
buffer_load_dwordx4 a[92:95], v2, s[40:43], s33 offen offset:3072 sc1
s_add_u32 s35, s35, 0x2000
v_mfma_f32_16x16x32_bf16 v[136:139], a[148:151], a[4:7], v[136:139]
s_add_u32 s33, s33, 0x2000
v_mov_b32 v102, v100
v_mfma_f32_16x16x32_bf16 v[136:139], a[144:147], a[0:3], v[136:139]
v_mov_b32 v110, v108
s_waitcnt vmcnt(12) lgkmcnt(0)
v_cmp_gt_u32 vcc, 0x100000, v11
s_nop 0
s_and_b32 vcc_lo, vcc_lo, 0x1f3f
s_cbranch_scc1 Ltal_6
Ltab_7:
v_cmp_lt_u32 vcc, 0x100008, v11
s_nop 0
s_and_b32 s51, vcc_lo, 0x1f3f
v_mfma_f32_16x16x32_bf16 v[140:143], a[96:99], a[32:35], v[140:143]
ds_read_b128 a[128:131], v5 offset:29696
v_mov_b32 v118, v116
v_mfma_f32_16x16x32_bf16 v[140:143], a[100:103], a[36:39], v[140:143]
buffer_load_dwordx4 a[0:3], v2, s[40:43], s35 offen offset:0 sc1
v_mfma_f32_16x16x32_bf16 v[164:167], a[100:103], a[44:47], v[164:167]
ds_read_b128 a[132:135], v5 offset:35840
v_mfma_f32_16x16x32_bf16 v[164:167], a[96:99], a[40:43], v[164:167]
v_permlane16_swap_b32 v92, v94
v_mfma_f32_16x16x32_bf16 v[188:191], a[96:99], a[48:51], v[188:191]
v_permlane16_swap_b32 v100, v102
v_mfma_f32_16x16x32_bf16 v[188:191], a[100:103], a[52:55], v[188:191]
buffer_load_dwordx4 v1, s[4:7], s44 offen offset:0 sc1 lds
v_mfma_f32_16x16x32_bf16 v[212:215], a[100:103], a[60:63], v[212:215]
ds_read_b128 a[136:139], v5 offset:24576
v_mfma_f32_16x16x32_bf16 v[212:215], a[96:99], a[56:59], v[212:215]
v_permlane16_swap_b32 v108, v110
v_mfma_f32_16x16x32_bf16 v[216:219], a[104:107], a[56:59], v[216:219]
ds_read_b128 a[140:143], v5 offset:30720
v_mfma_f32_16x16x32_bf16 v[216:219], a[108:111], a[60:63], v[216:219]
buffer_load_dwordx4 a[4:7], v2, s[40:43], s33 offen offset:0 sc1
v_mfma_f32_16x16x32_bf16 v[192:195], a[108:111], a[52:55], v[192:195]
ds_read_b128 a[144:147], v5 offset:25600
v_mfma_f32_16x16x32_bf16 v[192:195], a[104:107], a[48:51], v[192:195]
v_permlane16_swap_b32 v116, v118
v_mfma_f32_16x16x32_bf16 v[168:171], a[104:107], a[40:43], v[168:171]
v_add_f32 v92, v92, v94
v_add_f32 v100, v100, v102
v_mfma_f32_16x16x32_bf16 v[168:171], a[108:111], a[44:47], v[168:171]
buffer_load_dwordx4 a[8:11], v2, s[40:43], s35 offen offset:1024 sc1
v_mfma_f32_16x16x32_bf16 v[144:147], a[108:111], a[36:39], v[144:147]
ds_read_b128 a[148:151], v5 offset:31744
v_add_f32 v108, v108, v110
v_mfma_f32_16x16x32_bf16 v[144:147], a[104:107], a[32:35], v[144:147]
v_add_f32 v116, v116, v118
v_mov_b32 v94, v92
v_mfma_f32_16x16x32_bf16 v[148:151], a[112:115], a[32:35], v[148:151]
v_mov_b32 v102, v100
v_mov_b32 v110, v108
v_mfma_f32_16x16x32_bf16 v[148:151], a[116:119], a[36:39], v[148:151]
buffer_load_dwordx4 v1, s[4:7], s44 offen offset:1024 sc1 lds
s_add_u32 m0, s18, 0xa000
v_mfma_f32_16x16x32_bf16 v[172:175], a[116:119], a[44:47], v[172:175]
s_add_u32 s44, s50, 0x202e000
v_mov_b32 v118, v116
v_mfma_f32_16x16x32_bf16 v[172:175], a[112:115], a[40:43], v[172:175]
v_permlane32_swap_b32 v92, v94
v_mfma_f32_16x16x32_bf16 v[196:199], a[112:115], a[48:51], v[196:199]
v_permlane32_swap_b32 v100, v102
v_mfma_f32_16x16x32_bf16 v[196:199], a[116:119], a[52:55], v[196:199]
buffer_load_dwordx4 a[12:15], v2, s[40:43], s33 offen offset:1024 sc1
v_mfma_f32_16x16x32_bf16 v[220:223], a[116:119], a[60:63], v[220:223]
v_permlane32_swap_b32 v108, v110
v_mfma_f32_16x16x32_bf16 v[220:223], a[112:115], a[56:59], v[220:223]
s_waitcnt lgkmcnt(0)
v_mfma_f32_16x16x32_bf16 v[224:227], a[128:131], a[56:59], v[224:227]
ds_read_b128 a[96:99], v5 offset:38912
v_mfma_f32_16x16x32_bf16 v[224:227], a[132:135], a[60:63], v[224:227]
buffer_load_dwordx4 a[16:19], v2, s[40:43], s35 offen offset:2048 sc1
v_mfma_f32_16x16x32_bf16 v[200:203], a[132:135], a[52:55], v[200:203]
ds_read_b128 a[100:103], v5 offset:45056
v_mfma_f32_16x16x32_bf16 v[200:203], a[128:131], a[48:51], v[200:203]
v_permlane32_swap_b32 v116, v118
v_mfma_f32_16x16x32_bf16 v[176:179], a[128:131], a[40:43], v[176:179]
v_mul_f32 v82, 0xba800000, v92
v_mul_f32 v84, 0xba800000, v100
v_mfma_f32_16x16x32_bf16 v[176:179], a[132:135], a[44:47], v[176:179]
buffer_load_dwordx4 v1, s[4:7], s44 offen offset:0 sc1 lds
v_mfma_f32_16x16x32_bf16 v[152:155], a[132:135], a[36:39], v[152:155]
ds_read_b128 a[104:107], v5 offset:39936
v_mul_f32 v86, 0xba800000, v108
v_mfma_f32_16x16x32_bf16 v[152:155], a[128:131], a[32:35], v[152:155]
v_mul_f32 v88, 0xba800000, v116
v_mul_f32 v94, 0x3a800000, v94
v_mfma_f32_16x16x32_bf16 v[132:135], a[136:139], a[32:35], v[132:135]
ds_read_b128 a[108:111], v5 offset:46080
v_mul_f32 v102, 0x3a800000, v102
v_mfma_f32_16x16x32_bf16 v[132:135], a[140:143], a[36:39], v[132:135]
buffer_load_dwordx4 a[20:23], v2, s[40:43], s33 offen offset:2048 sc1
v_mfma_f32_16x16x32_bf16 v[156:159], a[140:143], a[44:47], v[156:159]
ds_read_b128 a[112:115], v5 offset:40960
v_mul_f32 v110, 0x3a800000, v110
v_mfma_f32_16x16x32_bf16 v[156:159], a[136:139], a[40:43], v[156:159]
v_mul_f32 v118, 0x3a800000, v118
v_fma_f32 v94, -v82, v82, v94
v_mfma_f32_16x16x32_bf16 v[180:183], a[136:139], a[48:51], v[180:183]
v_fma_f32 v102, -v84, v84, v102
v_fma_f32 v110, -v86, v86, v110
v_mfma_f32_16x16x32_bf16 v[180:183], a[140:143], a[52:55], v[180:183]
buffer_load_dwordx4 a[24:27], v2, s[40:43], s35 offen offset:3072 sc1
v_mfma_f32_16x16x32_bf16 v[204:207], a[140:143], a[60:63], v[204:207]
ds_read_b128 a[116:119], v5 offset:47104
v_fma_f32 v118, -v88, v88, v118
v_mfma_f32_16x16x32_bf16 v[204:207], a[136:139], a[56:59], v[204:207]
v_max_f32 v94, 0, v94
v_max_f32 v102, 0, v102
v_mfma_f32_16x16x32_bf16 v[208:211], a[144:147], a[56:59], v[208:211]
v_max_f32 v110, 0, v110
v_max_f32 v118, 0, v118
v_mfma_f32_16x16x32_bf16 v[208:211], a[148:151], a[60:63], v[208:211]
buffer_load_dwordx4 v1, s[4:7], s44 offen offset:1024 sc1 lds
s_add_u32 m0, s19, 49152
v_mfma_f32_16x16x32_bf16 v[184:187], a[148:151], a[52:55], v[184:187]
s_xor_b32 s44, s84, 16384
v_add_f32 v94, 0x3727c5ac, v94
v_mfma_f32_16x16x32_bf16 v[184:187], a[144:147], a[48:51], v[184:187]
v_add_f32 v102, 0x3727c5ac, v102
v_add_f32 v110, 0x3727c5ac, v110
v_mfma_f32_16x16x32_bf16 v[160:163], a[144:147], a[40:43], v[160:163]
v_add_f32 v118, 0x3727c5ac, v118
v_mfma_f32_16x16x32_bf16 v[160:163], a[148:151], a[44:47], v[160:163]
buffer_load_dwordx4 a[28:31], v2, s[40:43], s33 offen offset:3072 sc1
s_add_u32 s35, s35, 0x2000
v_mfma_f32_16x16x32_bf16 v[136:139], a[148:151], a[36:39], v[136:139]
s_add_u32 s33, s33, 0x2000
v_mfma_f32_16x16x32_bf16 v[136:139], a[144:147], a[32:35], v[136:139]
s_waitcnt vmcnt(12) lgkmcnt(0)
v_mfma_f32_16x16x32_bf16 v[140:143], a[96:99], a[64:67], v[140:143]
ds_read_b128 a[128:131], v5 offset:41984
v_mfma_f32_16x16x32_bf16 v[140:143], a[100:103], a[68:71], v[140:143]
buffer_load_dwordx4 a[32:35], v2, s[40:43], s35 offen offset:0 sc1
v_mfma_f32_16x16x32_bf16 v[164:167], a[100:103], a[76:79], v[164:167]
ds_read_b128 a[132:135], v5 offset:48128
v_mfma_f32_16x16x32_bf16 v[164:167], a[96:99], a[72:75], v[164:167]
v_rsq_f32 v83, v94
v_mfma_f32_16x16x32_bf16 v[188:191], a[96:99], a[80:83], v[188:191]
v_rsq_f32 v85, v102
v_mfma_f32_16x16x32_bf16 v[188:191], a[100:103], a[84:87], v[188:191]
buffer_load_dwordx4 v1, s[4:7], s44 offen offset:0 sc1 lds
v_mfma_f32_16x16x32_bf16 v[212:215], a[100:103], a[92:95], v[212:215]
ds_read_b128 a[136:139], v5 offset:36864
v_mfma_f32_16x16x32_bf16 v[212:215], a[96:99], a[88:91], v[212:215]
v_rsq_f32 v87, v110
v_rsq_f32 v89, v118
v_mfma_f32_16x16x32_bf16 v[216:219], a[104:107], a[88:91], v[216:219]
ds_read_b128 a[140:143], v5 offset:43008
v_mfma_f32_16x16x32_bf16 v[216:219], a[108:111], a[92:95], v[216:219]
buffer_load_dwordx4 a[36:39], v2, s[40:43], s33 offen offset:0 sc1
v_mfma_f32_16x16x32_bf16 v[192:195], a[108:111], a[84:87], v[192:195]
ds_read_b128 a[144:147], v5 offset:37888
v_fmac_f32 v140, v56, v82
v_mfma_f32_16x16x32_bf16 v[192:195], a[104:107], a[80:83], v[192:195]
v_mfma_f32_16x16x32_bf16 v[168:171], a[104:107], a[72:75], v[168:171]
v_fmac_f32 v164, v56, v84
v_mfma_f32_16x16x32_bf16 v[168:171], a[108:111], a[76:79], v[168:171]
buffer_load_dwordx4 a[40:43], v2, s[40:43], s35 offen offset:1024 sc1
v_mfma_f32_16x16x32_bf16 v[144:147], a[108:111], a[68:71], v[144:147]
ds_read_b128 a[148:151], v5 offset:44032
v_fmac_f32 v188, v56, v86
v_mfma_f32_16x16x32_bf16 v[144:147], a[104:107], a[64:67], v[144:147]
v_mfma_f32_16x16x32_bf16 v[148:151], a[112:115], a[64:67], v[148:151]
v_fmac_f32 v212, v56, v88
v_mfma_f32_16x16x32_bf16 v[148:151], a[116:119], a[68:71], v[148:151]
buffer_load_dwordx4 v1, s[4:7], s44 offen offset:1024 sc1 lds
v_mfma_f32_16x16x32_bf16 v[172:175], a[116:119], a[76:79], v[172:175]
v_fmac_f32 v216, v60, v88
v_mfma_f32_16x16x32_bf16 v[172:175], a[112:115], a[72:75], v[172:175]
v_mfma_f32_16x16x32_bf16 v[196:199], a[112:115], a[80:83], v[196:199]
v_fmac_f32 v192, v60, v86
v_mfma_f32_16x16x32_bf16 v[196:199], a[116:119], a[84:87], v[196:199]
buffer_load_dwordx4 a[44:47], v2, s[40:43], s33 offen offset:1024 sc1
v_mfma_f32_16x16x32_bf16 v[220:223], a[116:119], a[92:95], v[220:223]
v_fmac_f32 v168, v60, v84
v_fmac_f32 v141, v57, v82
v_mfma_f32_16x16x32_bf16 v[220:223], a[112:115], a[88:91], v[220:223]
s_waitcnt lgkmcnt(0)
s_barrier
v_mfma_f32_16x16x32_bf16 v[224:227], a[128:131], a[88:91], v[224:227]
v_add_u32 v5, 0, v1
v_fmac_f32 v144, v60, v82
v_mfma_f32_16x16x32_bf16 v[224:227], a[132:135], a[92:95], v[224:227]
buffer_load_dwordx4 a[48:51], v2, s[40:43], s35 offen offset:2048 sc1
v_mfma_f32_16x16x32_bf16 v[200:203], a[132:135], a[84:87], v[200:203]
ds_read_b128 a[96:99], v5 offset:2048
v_fmac_f32 v148, v64, v82
v_mfma_f32_16x16x32_bf16 v[200:203], a[128:131], a[80:83], v[200:203]
ds_read_b128 a[100:103], v5 offset:8192
v_fmac_f32 v165, v57, v84
v_mfma_f32_16x16x32_bf16 v[176:179], a[128:131], a[72:75], v[176:179]
v_fmac_f32 v172, v64, v84
v_fmac_f32 v189, v57, v86
v_mfma_f32_16x16x32_bf16 v[176:179], a[132:135], a[76:79], v[176:179]
buffer_load_dwordx4 v1, s[4:7], s44 offen offset:2048 sc1 lds
v_mfma_f32_16x16x32_bf16 v[152:155], a[132:135], a[68:71], v[152:155]
ds_read_b128 a[104:107], v5 offset:3072
v_fmac_f32 v196, v64, v86
v_mfma_f32_16x16x32_bf16 v[152:155], a[128:131], a[64:67], v[152:155]
v_fmac_f32 v213, v57, v88
v_fmac_f32 v217, v61, v88
v_mfma_f32_16x16x32_bf16 v[132:135], a[136:139], a[64:67], v[132:135]
ds_read_b128 a[108:111], v5 offset:9216
v_fmac_f32 v220, v64, v88
v_mfma_f32_16x16x32_bf16 v[132:135], a[140:143], a[68:71], v[132:135]
buffer_load_dwordx4 a[52:55], v2, s[40:43], s33 offen offset:2048 sc1
v_mfma_f32_16x16x32_bf16 v[156:159], a[140:143], a[76:79], v[156:159]
ds_read_b128 a[112:115], v5 offset:4096
v_fmac_f32 v224, v68, v88
v_mfma_f32_16x16x32_bf16 v[156:159], a[136:139], a[72:75], v[156:159]
v_fmac_f32 v193, v61, v86
v_fmac_f32 v169, v61, v84
v_mfma_f32_16x16x32_bf16 v[180:183], a[136:139], a[80:83], v[180:183]
v_fmac_f32 v200, v68, v86
v_fmac_f32 v145, v61, v82
v_mfma_f32_16x16x32_bf16 v[180:183], a[140:143], a[84:87], v[180:183]
buffer_load_dwordx4 a[56:59], v2, s[40:43], s35 offen offset:3072 sc1
v_mfma_f32_16x16x32_bf16 v[204:207], a[140:143], a[92:95], v[204:207]
ds_read_b128 a[116:119], v5 offset:10240
v_fmac_f32 v176, v68, v84
v_mfma_f32_16x16x32_bf16 v[204:207], a[136:139], a[88:91], v[204:207]
v_fmac_f32 v149, v65, v82
v_mfma_f32_16x16x32_bf16 v[208:211], a[144:147], a[88:91], v[208:211]
v_fmac_f32 v152, v68, v82
v_fmac_f32 v173, v65, v84
v_mfma_f32_16x16x32_bf16 v[208:211], a[148:151], a[92:95], v[208:211]
buffer_load_dwordx4 v1, s[4:7], s44 offen offset:3072 sc1 lds
s_add_u32 m0, s19, 65536
v_mfma_f32_16x16x32_bf16 v[184:187], a[148:151], a[84:87], v[184:187]
s_xor_b32 s44, s84, 32768
v_fmac_f32 v132, v48, v82
v_mfma_f32_16x16x32_bf16 v[184:187], a[144:147], a[80:83], v[184:187]
v_fmac_f32 v197, v65, v86
v_mfma_f32_16x16x32_bf16 v[160:163], a[144:147], a[72:75], v[160:163]
v_fmac_f32 v156, v48, v84
v_fmac_f32 v221, v65, v88
v_mfma_f32_16x16x32_bf16 v[160:163], a[148:151], a[76:79], v[160:163]
buffer_load_dwordx4 a[60:63], v2, s[40:43], s33 offen offset:3072 sc1
s_add_u32 s35, s35, 0x2000
v_mfma_f32_16x16x32_bf16 v[136:139], a[148:151], a[68:71], v[136:139]
s_add_u32 s33, s33, 0x2000
v_fmac_f32 v180, v48, v86
v_mfma_f32_16x16x32_bf16 v[136:139], a[144:147], a[64:67], v[136:139]
v_fmac_f32 v225, v69, v88
s_waitcnt vmcnt(12) lgkmcnt(0)
v_mfma_f32_16x16x32_bf16 v[140:143], a[96:99], a[0:3], v[140:143]
ds_read_b128 a[128:131], v5 offset:5120
v_fmac_f32 v204, v48, v88
v_mfma_f32_16x16x32_bf16 v[140:143], a[100:103], a[4:7], v[140:143]
buffer_load_dwordx4 a[64:67], v2, s[40:43], s35 offen offset:0 sc1
s_lshl_b32 s37, s28, 10
v_mfma_f32_16x16x32_bf16 v[164:167], a[100:103], a[12:15], v[164:167]
ds_read_b128 a[132:135], v5 offset:11264
v_fmac_f32 v208, v52, v88
v_mfma_f32_16x16x32_bf16 v[164:167], a[96:99], a[8:11], v[164:167]
v_fmac_f32 v201, v69, v86
v_fmac_f32 v177, v69, v84
v_mfma_f32_16x16x32_bf16 v[188:191], a[96:99], a[16:19], v[188:191]
v_fmac_f32 v184, v52, v86
v_fmac_f32 v153, v69, v82
v_mfma_f32_16x16x32_bf16 v[188:191], a[100:103], a[20:23], v[188:191]
buffer_load_dwordx4 a[68:71], v2, s[40:43], s33 offen offset:0 sc1
s_lshr_b32 s79, s30, 1
v_mfma_f32_16x16x32_bf16 v[212:215], a[100:103], a[28:31], v[212:215]
ds_read_b128 a[136:139], v5 offset:0
v_fmac_f32 v160, v52, v84
v_mfma_f32_16x16x32_bf16 v[212:215], a[96:99], a[24:27], v[212:215]
v_fmac_f32 v133, v49, v82
s_lshr_b32 s36, s79, 3
v_mfma_f32_16x16x32_bf16 v[216:219], a[104:107], a[24:27], v[216:219]
ds_read_b128 a[140:143], v5 offset:6144
v_fmac_f32 v136, v52, v82
v_mfma_f32_16x16x32_bf16 v[216:219], a[108:111], a[28:31], v[216:219]
buffer_load_dwordx4 a[72:75], v2, s[40:43], s35 offen offset:1024 sc1
s_and_b32 s79, s79, 7
v_mfma_f32_16x16x32_bf16 v[192:195], a[108:111], a[20:23], v[192:195]
ds_read_b128 a[144:147], v5 offset:1024
v_fmac_f32 v157, v49, v84
v_mfma_f32_16x16x32_bf16 v[192:195], a[104:107], a[16:19], v[192:195]
v_fmac_f32 v181, v49, v86
v_fmac_f32 v142, v58, v82
v_mfma_f32_16x16x32_bf16 v[168:171], a[104:107], a[8:11], v[168:171]
v_fmac_f32 v205, v49, v88
v_fmac_f32 v166, v58, v84
v_mfma_f32_16x16x32_bf16 v[168:171], a[108:111], a[12:15], v[168:171]
buffer_load_dwordx4 a[76:79], v2, s[40:43], s33 offen offset:1024 sc1
s_mul_i32 s36, s36, 524288
v_mfma_f32_16x16x32_bf16 v[144:147], a[108:111], a[4:7], v[144:147]
ds_read_b128 a[148:151], v5 offset:7168
v_fmac_f32 v209, v53, v88
v_mfma_f32_16x16x32_bf16 v[144:147], a[104:107], a[0:3], v[144:147]
v_fmac_f32 v190, v58, v86
s_lshl_b32 s79, s79, 14
v_mfma_f32_16x16x32_bf16 v[148:151], a[112:115], a[0:3], v[148:151]
v_fmac_f32 v185, v53, v86
v_fmac_f32 v214, v58, v88
v_mfma_f32_16x16x32_bf16 v[148:151], a[116:119], a[4:7], v[148:151]
buffer_load_dwordx4 a[80:83], v2, s[40:43], s35 offen offset:2048 sc1
s_add_u32 s79, s79, s36
v_mfma_f32_16x16x32_bf16 v[172:175], a[116:119], a[12:15], v[172:175]
v_fmac_f32 v161, v53, v84
v_fmac_f32 v218, v62, v88
v_mfma_f32_16x16x32_bf16 v[172:175], a[112:115], a[8:11], v[172:175]
s_and_b32 s36, s30, 1
s_lshl_b32 s36, s36, 12
s_add_u32 s79, s79, s36
v_mfma_f32_16x16x32_bf16 v[196:199], a[112:115], a[16:19], v[196:199]
v_fmac_f32 v137, v53, v82
v_fmac_f32 v194, v62, v86
v_mfma_f32_16x16x32_bf16 v[196:199], a[116:119], a[20:23], v[196:199]
buffer_load_dwordx4 a[84:87], v2, s[40:43], s33 offen offset:2048 sc1
s_lshr_b32 s39, s29, 2
v_mfma_f32_16x16x32_bf16 v[220:223], a[116:119], a[28:31], v[220:223]
v_fmac_f32 v170, v62, v84
v_fmac_f32 v143, v59, v82
v_mfma_f32_16x16x32_bf16 v[220:223], a[112:115], a[24:27], v[220:223]
s_mul_i32 s39, s39, 0xffff
s_waitcnt lgkmcnt(0)
v_mfma_f32_16x16x32_bf16 v[224:227], a[128:131], a[24:27], v[224:227]
ds_read_b128 a[96:99], v5 offset:14336
v_fmac_f32 v146, v62, v82
v_mfma_f32_16x16x32_bf16 v[224:227], a[132:135], a[28:31], v[224:227]
buffer_load_dwordx4 a[88:91], v2, s[40:43], s35 offen offset:3072 sc1
s_xor_b32 s39, s39, s51
v_mfma_f32_16x16x32_bf16 v[200:203], a[132:135], a[20:23], v[200:203]
ds_read_b128 a[100:103], v5 offset:20480
v_fmac_f32 v150, v66, v82
v_mfma_f32_16x16x32_bf16 v[200:203], a[128:131], a[16:19], v[200:203]
v_fmac_f32 v167, v59, v84
v_fmac_f32 v191, v59, v86
v_mfma_f32_16x16x32_bf16 v[176:179], a[128:131], a[8:11], v[176:179]
buffer_load_dwordx4 v1, s[4:7], s44 offen offset:0 sc1 lds
s_and_b32 s36, s29, 2
v_mfma_f32_16x16x32_bf16 v[176:179], a[132:135], a[12:15], v[176:179]
ds_read_b128 a[104:107], v5 offset:15360
v_fmac_f32 v174, v66, v84
v_mfma_f32_16x16x32_bf16 v[152:155], a[132:135], a[4:7], v[152:155]
v_fmac_f32 v198, v66, v86
v_fmac_f32 v215, v59, v88
v_mfma_f32_16x16x32_bf16 v[152:155], a[128:131], a[0:3], v[152:155]
buffer_load_dwordx4 v1, s[4:7], s44 offen offset:1024 sc1 lds
s_lshl_b32 s36, s36, 2
v_mfma_f32_16x16x32_bf16 v[132:135], a[136:139], a[0:3], v[132:135]
ds_read_b128 a[108:111], v5 offset:21504
v_fmac_f32 v222, v66, v88
v_mfma_f32_16x16x32_bf16 v[132:135], a[140:143], a[4:7], v[132:135]
v_fmac_f32 v219, v63, v88
v_fmac_f32 v195, v63, v86
v_mfma_f32_16x16x32_bf16 v[156:159], a[140:143], a[12:15], v[156:159]
ds_read_b128 a[112:115], v5 offset:16384
v_fmac_f32 v226, v70, v88
v_mfma_f32_16x16x32_bf16 v[156:159], a[136:139], a[8:11], v[156:159]
buffer_load_dwordx4 v1, s[4:7], s44 offen offset:2048 sc1 lds
s_lshr_b32 s36, s39, s36
v_mfma_f32_16x16x32_bf16 v[180:183], a[136:139], a[16:19], v[180:183]
v_fmac_f32 v202, v70, v86
v_fmac_f32 v171, v63, v84
v_mfma_f32_16x16x32_bf16 v[180:183], a[140:143], a[20:23], v[180:183]
ds_read_b128 a[116:119], v5 offset:22528
v_fmac_f32 v147, v63, v82
v_mfma_f32_16x16x32_bf16 v[204:207], a[140:143], a[28:31], v[204:207]
buffer_load_dwordx4 a[92:95], v2, s[40:43], s33 offen offset:3072 sc1
s_add_u32 s35, s35, 0x2000
v_mfma_f32_16x16x32_bf16 v[204:207], a[136:139], a[24:27], v[204:207]
s_add_u32 s33, s33, 0x2000
v_fmac_f32 v178, v70, v84
v_mfma_f32_16x16x32_bf16 v[208:211], a[144:147], a[24:27], v[208:211]
v_fmac_f32 v154, v70, v82
v_fmac_f32 v151, v67, v82
v_mfma_f32_16x16x32_bf16 v[208:211], a[148:151], a[28:31], v[208:211]
v_fmac_f32 v175, v67, v84
s_bfe_u32 s68, s36, 0x10001
v_mfma_f32_16x16x32_bf16 v[184:187], a[148:151], a[20:23], v[184:187]
buffer_load_dwordx4 v1, s[4:7], s44 offen offset:3072 sc1 lds
s_add_u32 m0, s19, 81920
v_mfma_f32_16x16x32_bf16 v[184:187], a[144:147], a[16:19], v[184:187]
s_xor_b32 s44, s84, 49152
v_fmac_f32 v134, v50, v82
v_mfma_f32_16x16x32_bf16 v[160:163], a[144:147], a[8:11], v[160:163]
v_fmac_f32 v158, v50, v84
v_fmac_f32 v199, v67, v86
v_mfma_f32_16x16x32_bf16 v[160:163], a[148:151], a[12:15], v[160:163]
buffer_load_dwordx4 v1, s[4:7], s44 offen offset:0 sc1 lds
s_lshl_b32 s68, s68, 13
v_mfma_f32_16x16x32_bf16 v[136:139], a[148:151], a[4:7], v[136:139]
v_fmac_f32 v182, v50, v86
v_fmac_f32 v223, v67, v88
v_mfma_f32_16x16x32_bf16 v[136:139], a[144:147], a[0:3], v[136:139]
s_waitcnt vmcnt(13) lgkmcnt(0)
s_barrier
v_mfma_f32_16x16x32_bf16 v[140:143], a[96:99], a[32:35], v[140:143]
ds_read_b128 a[128:131], v5 offset:17408
v_fmac_f32 v206, v50, v88
v_mfma_f32_16x16x32_bf16 v[140:143], a[100:103], a[36:39], v[140:143]
buffer_load_dwordx4 a[0:3], v2, s[40:43], s35 offen offset:0 sc1
s_bfe_u32 s10, s36, 0x10004
v_mfma_f32_16x16x32_bf16 v[164:167], a[100:103], a[44:47], v[164:167]
ds_read_b128 a[132:135], v5 offset:23552
v_fmac_f32 v210, v54, v88
v_mfma_f32_16x16x32_bf16 v[164:167], a[96:99], a[40:43], v[164:167]
v_fmac_f32 v227, v71, v88
v_fmac_f32 v203, v71, v86
v_mfma_f32_16x16x32_bf16 v[188:191], a[96:99], a[48:51], v[188:191]
buffer_load_dwordx4 a[4:7], v2, s[40:43], s33 offen offset:0 sc1
s_lshl_b32 s10, s10, 13
v_mfma_f32_16x16x32_bf16 v[188:191], a[100:103], a[52:55], v[188:191]
ds_read_b128 a[136:139], v5 offset:26624
v_fmac_f32 v186, v54, v86
v_mfma_f32_16x16x32_bf16 v[212:215], a[100:103], a[60:63], v[212:215]
v_fmac_f32 v162, v54, v84
v_fmac_f32 v179, v71, v84
v_mfma_f32_16x16x32_bf16 v[212:215], a[96:99], a[56:59], v[212:215]
buffer_load_dwordx4 a[8:11], v2, s[40:43], s35 offen offset:1024 sc1
s_bfe_u32 s75, s36, 0x10002
v_mfma_f32_16x16x32_bf16 v[216:219], a[104:107], a[56:59], v[216:219]
ds_read_b128 a[140:143], v5 offset:32768
v_fmac_f32 v138, v54, v82
v_mfma_f32_16x16x32_bf16 v[216:219], a[108:111], a[60:63], v[216:219]
v_fmac_f32 v155, v71, v82
v_fmac_f32 v135, v51, v82
v_mfma_f32_16x16x32_bf16 v[192:195], a[108:111], a[52:55], v[192:195]
buffer_load_dwordx4 a[12:15], v2, s[40:43], s33 offen offset:1024 sc1
s_lshl_b32 s75, s75, 13
v_mfma_f32_16x16x32_bf16 v[192:195], a[104:107], a[48:51], v[192:195]
ds_read_b128 a[144:147], v5 offset:27648
v_fmac_f32 v159, v51, v84
v_mfma_f32_16x16x32_bf16 v[168:171], a[104:107], a[40:43], v[168:171]
v_fmac_f32 v183, v51, v86
v_fmac_f32 v207, v51, v88
v_mfma_f32_16x16x32_bf16 v[168:171], a[108:111], a[44:47], v[168:171]
buffer_load_dwordx4 a[16:19], v2, s[40:43], s35 offen offset:2048 sc1
s_bfe_u32 s76, s36, 0x10003
v_mfma_f32_16x16x32_bf16 v[144:147], a[108:111], a[36:39], v[144:147]
ds_read_b128 a[148:151], v5 offset:33792
v_fmac_f32 v211, v55, v88
v_mfma_f32_16x16x32_bf16 v[144:147], a[104:107], a[32:35], v[144:147]
s_lshl_b32 s76, s76, 13
s_add_u32 s75, s75, s79
s_add_u32 s76, s76, s79
v_mfma_f32_16x16x32_bf16 v[148:151], a[112:115], a[32:35], v[148:151]
buffer_load_dwordx4 a[20:23], v2, s[40:43], s33 offen offset:2048 sc1
s_and_b32 s36, s31, 4
v_mfma_f32_16x16x32_bf16 v[148:151], a[116:119], a[36:39], v[148:151]
v_fmac_f32 v187, v55, v86
s_lshl_b32 s36, s36, 1
v_mfma_f32_16x16x32_bf16 v[172:175], a[116:119], a[44:47], v[172:175]
v_fmac_f32 v163, v55, v84
s_lshr_b32 s36, s39, s36
v_mfma_f32_16x16x32_bf16 v[172:175], a[112:115], a[40:43], v[172:175]
buffer_load_dwordx4 a[24:27], v2, s[40:43], s35 offen offset:3072 sc1
s_bfe_u32 s69, s36, 0x10001
v_mfma_f32_16x16x32_bf16 v[196:199], a[112:115], a[48:51], v[196:199]
v_fmac_f32 v139, v55, v82
s_lshl_b32 s69, s69, 13
v_mfma_f32_16x16x32_bf16 v[196:199], a[116:119], a[52:55], v[196:199]
s_bfe_u32 s45, s36, 0x10004
s_lshl_b32 s45, s45, 13
s_bfe_u32 s77, s36, 0x10002
v_mfma_f32_16x16x32_bf16 v[220:223], a[116:119], a[60:63], v[220:223]
buffer_load_dwordx4 a[28:31], v2, s[40:43], s33 offen offset:3072 sc1
s_add_u32 s35, s35, 0x2000
v_mfma_f32_16x16x32_bf16 v[220:223], a[112:115], a[56:59], v[220:223]
s_add_u32 s33, s33, 0x2000
s_waitcnt lgkmcnt(0)
v_mfma_f32_16x16x32_bf16 v[224:227], a[128:131], a[56:59], v[224:227]
ds_read_b128 a[96:99], v5 offset:28672
s_lshl_b32 s77, s77, 13
v_mfma_f32_16x16x32_bf16 v[224:227], a[132:135], a[60:63], v[224:227]
buffer_load_dwordx4 v1, s[4:7], s44 offen offset:1024 sc1 lds
s_bfe_u32 s9, s36, 0x10003
v_mfma_f32_16x16x32_bf16 v[200:203], a[132:135], a[52:55], v[200:203]
ds_read_b128 a[100:103], v5 offset:34816
s_lshl_b32 s9, s9, 13
v_mfma_f32_16x16x32_bf16 v[200:203], a[128:131], a[48:51], v[200:203]
s_lshr_b32 s38, s32, 3
s_and_b32 s36, s32, 7
s_mul_i32 s38, s38, 524288
v_mfma_f32_16x16x32_bf16 v[176:179], a[128:131], a[40:43], v[176:179]
s_lshl_b32 s36, s36, 14
s_add_u32 s36, s36, s38
s_add_u32 s45, s45, s36
v_mfma_f32_16x16x32_bf16 v[176:179], a[132:135], a[44:47], v[176:179]
ds_read_b128 a[104:107], v5 offset:29696
s_add_u32 s69, s69, s36
v_mfma_f32_16x16x32_bf16 v[152:155], a[132:135], a[36:39], v[152:155]
s_bfe_u32 s79, s39, 0x10008
s_lshl_b32 s79, s79, 13
s_xor_b32 s38, s29, s39
v_mfma_f32_16x16x32_bf16 v[152:155], a[128:131], a[32:35], v[152:155]
s_and_b32 s38, s38, 1
s_mul_i32 s38, s38, 0x102000
s_add_u32 s71, s71, s38
s_waitcnt vmcnt(21)
v_mfma_f32_16x16x32_bf16 v[140:143], a[136:139], a[64:67], v[140:143]
ds_read_b128 a[108:111], v5 offset:35840
s_add_u32 s34, s67, s38
s_waitcnt vmcnt(20)
v_mfma_f32_16x16x32_bf16 v[140:143], a[140:143], a[68:71], v[140:143]
buffer_load_dwordx4 v1, s[4:7], s44 offen offset:2048 sc1 lds
s_lshr_b32 s38, s31, 1
s_waitcnt vmcnt(19)
v_mfma_f32_16x16x32_bf16 v[164:167], a[140:143], a[76:79], v[164:167]
ds_read_b128 a[112:115], v5 offset:38912
s_xor_b32 s38, s38, s39
v_mfma_f32_16x16x32_bf16 v[164:167], a[136:139], a[72:75], v[164:167]
s_and_b32 s38, s38, 1
s_mul_i32 s38, s38, 0x102000
s_add_u32 s78, s78, s38
s_waitcnt vmcnt(18)
v_mfma_f32_16x16x32_bf16 v[188:191], a[136:139], a[80:83], v[188:191]
s_add_u32 s11, s66, s38
s_and_b32 s38, s30, 8
s_lshl_b32 s38, s38, 13
s_waitcnt vmcnt(17)
v_mfma_f32_16x16x32_bf16 v[188:191], a[140:143], a[84:87], v[188:191]
ds_read_b128 a[116:119], v5 offset:45056
s_and_b32 s36, s30, 16
s_waitcnt vmcnt(12)
v_mfma_f32_16x16x32_bf16 v[212:215], a[140:143], a[92:95], v[212:215]
s_lshl_b32 s36, s36, 15
s_add_u32 s38, s38, s36
s_add_u32 s77, s77, s38
v_mfma_f32_16x16x32_bf16 v[212:215], a[136:139], a[88:91], v[212:215]
s_add_u32 s9, s9, s38
s_lshl_b32 s38, s31, 1
s_lshr_b32 s90, s28, 1
v_mfma_f32_16x16x32_bf16 v[216:219], a[144:147], a[88:91], v[216:219]
s_add_u32 s38, s38, s90
s_lshl_b32 s90, s38, 13
s_sub_u32 s91, s79, s90
v_mfma_f32_16x16x32_bf16 v[216:219], a[148:151], a[92:95], v[216:219]
buffer_load_dwordx4 v1, s[4:7], s44 offen offset:3072 sc1 lds
s_and_b32 s38, s38, 15
v_mfma_f32_16x16x32_bf16 v[192:195], a[148:151], a[84:87], v[192:195]
s_lshl_b32 s90, s38, 14
s_add_u32 s91, s91, s90
s_and_b32 s90, s38, 12
v_mfma_f32_16x16x32_bf16 v[192:195], a[144:147], a[80:83], v[192:195]
s_add_u32 s38, s38, s90
s_lshl_b32 s38, s38, 17
s_and_b32 s90, s18, 0x800
v_mfma_f32_16x16x32_bf16 v[168:171], a[144:147], a[72:75], v[168:171]
s_add_u32 s38, s38, s90
s_lshl_b32 s39, s81, 2
s_add_u32 s39, s39, s28
v_mfma_f32_16x16x32_bf16 v[168:171], a[148:151], a[76:79], v[168:171]
s_lshl_b32 s82, s39, 14
v_mul_f32 v88, 0x3e8293ee, v89
v_mfma_f32_16x16x32_bf16 v[144:147], a[148:151], a[68:71], v[144:147]
s_add_u32 s82, s82, s79
s_and_b32 s90, s39, 12
s_add_u32 s39, s39, s90
v_mfma_f32_16x16x32_bf16 v[144:147], a[144:147], a[64:67], v[144:147]
s_lshl_b32 s39, s39, 17
s_waitcnt lgkmcnt(0)
v_mfma_f32_16x16x32_bf16 v[148:151], a[96:99], a[64:67], v[148:151]
ds_read_b128 a[128:131], v5 offset:39936
s_add_u32 s72, s75, 0x800000
v_mfma_f32_16x16x32_bf16 v[148:151], a[100:103], a[68:71], v[148:151]
buffer_store_dwordx4 a[220:223], v1, s[4:7], s101 offen offset:0 sc1
s_add_u32 s63, s83, 0x1780000
v_mfma_f32_16x16x32_bf16 v[172:175], a[100:103], a[76:79], v[172:175]
ds_read_b128 a[132:135], v5 offset:46080
s_sub_u32 s55, s63, 65536
v_mfma_f32_16x16x32_bf16 v[172:175], a[96:99], a[72:75], v[172:175]
s_bfe_u32 s36, s83, 0x5000d
s_lshl_b32 s36, s36, 14
s_and_b32 s83, s83, 0x1800
v_mfma_f32_16x16x32_bf16 v[196:199], a[96:99], a[80:83], v[196:199]
s_add_u32 s83, s83, s36
s_add_u32 s83, s83, s79
v_mfma_f32_16x16x32_bf16 v[196:199], a[100:103], a[84:87], v[196:199]
ds_read_b128 a[136:139], v5 offset:40960
v_add_u32 v233, s37, v1
v_mfma_f32_16x16x32_bf16 v[220:223], a[100:103], a[92:95], v[220:223]
v_add_u32 v232, s19, v7
v_mul_f32 v86, 0x3e8293ee, v87
v_mfma_f32_16x16x32_bf16 v[220:223], a[96:99], a[88:91], v[220:223]
v_mul_f32 v84, 0x3e8293ee, v85
v_mul_f32 v82, 0x3e8293ee, v83
v_mfma_f32_16x16x32_bf16 v[224:227], a[104:107], a[88:91], v[224:227]
ds_read_b128 a[140:143], v5 offset:47104
v_add_u32 v248, s19, v8
v_mfma_f32_16x16x32_bf16 v[224:227], a[108:111], a[92:95], v[224:227]
buffer_store_dwordx4 a[224:227], v1, s[4:7], s101 offen offset:1024 sc1
s_add_u32 s16, s97, 0
v_mfma_f32_16x16x32_bf16 v[200:203], a[108:111], a[84:87], v[200:203]
s_add_u32 s16, s16, s96
ds_read_b128 a[144:147], v5 offset:41984
v_mfma_f32_16x16x32_bf16 v[200:203], a[104:107], a[80:83], v[200:203]
v_add_u32 v253, s91, v253
v_add_u32 v4, s38, v1
v_mfma_f32_16x16x32_bf16 v[176:179], a[104:107], a[72:75], v[176:179]
v_add_u32 v2, s39, v1
v_mfma_f32_16x16x32_bf16 v[176:179], a[108:111], a[76:79], v[176:179]
ds_read_b128 a[148:151], v5 offset:48128
v_mfma_f32_16x16x32_bf16 v[152:155], a[108:111], a[68:71], v[152:155]
v_mfma_f32_16x16x32_bf16 v[152:155], a[104:107], a[64:67], v[152:155]
s_waitcnt vmcnt(12)
v_mfma_f32_16x16x32_bf16 v[140:143], a[112:115], a[0:3], v[140:143]
s_waitcnt vmcnt(11)
v_mfma_f32_16x16x32_bf16 v[140:143], a[116:119], a[4:7], v[140:143]
buffer_store_dwordx4 a[188:191], v1, s[4:7], s16 offen sc1
L_stub2:
s_cbranch_execz L_wret0
s_add_u32 s16, s97, 6144
s_waitcnt vmcnt(10)
v_mfma_f32_16x16x32_bf16 v[164:167], a[116:119], a[12:15], v[164:167]
s_add_u32 s16, s16, s96
v_mfma_f32_16x16x32_bf16 v[164:167], a[112:115], a[8:11], v[164:167]
s_waitcnt vmcnt(9)
v_mfma_f32_16x16x32_bf16 v[188:191], a[112:115], a[16:19], v[188:191]
s_waitcnt vmcnt(8)
v_mfma_f32_16x16x32_bf16 v[188:191], a[116:119], a[20:23], v[188:191]
s_waitcnt vmcnt(6)
v_mfma_f32_16x16x32_bf16 v[212:215], a[116:119], a[28:31], v[212:215]
v_mfma_f32_16x16x32_bf16 v[212:215], a[112:115], a[24:27], v[212:215]
s_waitcnt lgkmcnt(0)
v_mfma_f32_16x16x32_bf16 v[216:219], a[128:131], a[24:27], v[216:219]
ds_read_b128 a[96:99], v5 offset:12288
v_mul_f32 v140, v140, v83
v_mfma_f32_16x16x32_bf16 v[216:219], a[132:135], a[28:31], v[216:219]
buffer_store_dwordx4 a[192:195], v1, s[4:7], s16 offen sc1
s_add_u32 s16, s97, 1024
v_mfma_f32_16x16x32_bf16 v[192:195], a[132:135], a[20:23], v[192:195]
s_add_u32 s16, s16, s96
ds_read_b128 a[100:103], v5 offset:18432
v_mfma_f32_16x16x32_bf16 v[192:195], a[128:131], a[16:19], v[192:195]
v_mul_f32 v141, v141, v83
v_cvt_pk_bf16_f32 v140, v140, v141
v_mfma_f32_16x16x32_bf16 v[168:171], a[128:131], a[8:11], v[168:171]
v_mul_f32 v188, v188, v87
v_mul_f32 v189, v189, v87
v_mfma_f32_16x16x32_bf16 v[168:171], a[132:135], a[12:15], v[168:171]
ds_read_b128 a[104:107], v5 offset:24576
v_cvt_pk_bf16_f32 v188, v188, v189
v_mfma_f32_16x16x32_bf16 v[144:147], a[132:135], a[4:7], v[144:147]
v_mul_f32 v212, v212, v89
v_mul_f32 v213, v213, v89
v_mfma_f32_16x16x32_bf16 v[144:147], a[128:131], a[0:3], v[144:147]
v_mul_f32 v214, v214, v89
v_mul_f32 v215, v215, v89
v_mfma_f32_16x16x32_bf16 v[148:151], a[136:139], a[0:3], v[148:151]
ds_read_b128 a[108:111], v5 offset:30720
v_cvt_pk_bf16_f32 v212, v212, v213
v_mfma_f32_16x16x32_bf16 v[148:151], a[140:143], a[4:7], v[148:151]
buffer_store_dwordx4 a[196:199], v1, s[4:7], s16 offen sc1
s_add_u32 s16, s97, 7168
v_mfma_f32_16x16x32_bf16 v[172:175], a[140:143], a[12:15], v[172:175]
s_add_u32 s16, s16, s96
ds_read_b128 a[112:115], v5 offset:36864
v_mfma_f32_16x16x32_bf16 v[172:175], a[136:139], a[8:11], v[172:175]
v_mul_f32 v216, v216, v89
v_mul_f32 v217, v217, v89
v_mfma_f32_16x16x32_bf16 v[196:199], a[136:139], a[16:19], v[196:199]
v_mul_f32 v218, v218, v89
v_mul_f32 v219, v219, v89
v_mfma_f32_16x16x32_bf16 v[196:199], a[140:143], a[20:23], v[196:199]
ds_read_b128 a[116:119], v5 offset:43008
v_cvt_pk_bf16_f32 v213, v214, v215
v_mfma_f32_16x16x32_bf16 v[220:223], a[140:143], a[28:31], v[220:223]
v_cvt_pk_bf16_f32 v214, v216, v217
v_cvt_pk_bf16_f32 v215, v218, v219
v_mfma_f32_16x16x32_bf16 v[220:223], a[136:139], a[24:27], v[220:223]
v_min_u32 v212, -2, v212
v_min_u32 v213, -2, v213
v_mfma_f32_16x16x32_bf16 v[224:227], a[144:147], a[24:27], v[224:227]
v_min_u32 v214, -2, v214
v_min_u32 v215, -2, v215
v_mfma_f32_16x16x32_bf16 v[224:227], a[148:151], a[28:31], v[224:227]
buffer_store_dwordx4 a[200:203], v1, s[4:7], s16 offen sc1
s_add_u32 s16, s97, 2048
v_mfma_f32_16x16x32_bf16 v[200:203], a[148:151], a[20:23], v[200:203]
s_add_u32 s16, s16, s96
buffer_store_dwordx4 v[212:215], v3, s[4:7], s63 offen offset:0 sc1
v_mfma_f32_16x16x32_bf16 v[200:203], a[144:147], a[16:19], v[200:203]
v_mul_f32 v172, v172, v85
v_mul_f32 v173, v173, v85
v_mfma_f32_16x16x32_bf16 v[176:179], a[144:147], a[8:11], v[176:179]
v_cvt_pk_bf16_f32 v172, v172, v173
v_mul_f32 v196, v196, v87
v_mfma_f32_16x16x32_bf16 v[176:179], a[148:151], a[12:15], v[176:179]
v_mul_f32 v197, v197, v87
v_cvt_pk_bf16_f32 v196, v196, v197
v_mfma_f32_16x16x32_bf16 v[152:155], a[148:151], a[4:7], v[152:155]
v_mul_f32 v220, v220, v89
v_mul_f32 v221, v221, v89
v_mfma_f32_16x16x32_bf16 v[152:155], a[144:147], a[0:3], v[152:155]
v_mul_f32 v222, v222, v89
s_waitcnt lgkmcnt(0)
v_mfma_f32_16x16x32_bf16 v[132:135], a[96:99], a[32:35], v[132:135]
ds_read_b128 a[128:131], v5 offset:13312
v_mul_f32 v223, v223, v89
v_mfma_f32_16x16x32_bf16 v[132:135], a[100:103], a[36:39], v[132:135]
buffer_store_dwordx4 a[204:207], v1, s[4:7], s16 offen sc1
s_add_u32 s16, s97, 8192
v_mfma_f32_16x16x32_bf16 v[156:159], a[100:103], a[44:47], v[156:159]
s_add_u32 s16, s16, s96
ds_read_b128 a[132:135], v5 offset:19456
v_mfma_f32_16x16x32_bf16 v[156:159], a[96:99], a[40:43], v[156:159]
v_cvt_pk_bf16_f32 v220, v220, v221
v_mul_f32 v224, v224, v89
v_mfma_f32_16x16x32_bf16 v[180:183], a[96:99], a[48:51], v[180:183]
v_mul_f32 v225, v225, v89
v_mul_f32 v226, v226, v89
v_mfma_f32_16x16x32_bf16 v[180:183], a[100:103], a[52:55], v[180:183]
ds_read_b128 a[136:139], v5 offset:25600
v_mul_f32 v227, v227, v89
v_mfma_f32_16x16x32_bf16 v[204:207], a[100:103], a[60:63], v[204:207]
v_cvt_pk_bf16_f32 v221, v222, v223
v_cvt_pk_bf16_f32 v222, v224, v225
v_mfma_f32_16x16x32_bf16 v[204:207], a[96:99], a[56:59], v[204:207]
v_cvt_pk_bf16_f32 v223, v226, v227
v_min_u32 v220, -2, v220
v_mfma_f32_16x16x32_bf16 v[204:207], a[104:107], a[88:91], v[204:207]
ds_read_b128 a[140:143], v5 offset:31744
v_min_u32 v221, -2, v221
v_mfma_f32_16x16x32_bf16 v[204:207], a[108:111], a[92:95], v[204:207]
buffer_store_dwordx4 a[208:211], v1, s[4:7], s16 offen sc1
v_mfma_f32_16x16x32_bf16 v[180:183], a[108:111], a[84:87], v[180:183]
ds_read_b128 a[144:147], v5 offset:37888
v_min_u32 v222, -2, v222
v_mfma_f32_16x16x32_bf16 v[180:183], a[104:107], a[80:83], v[180:183]
v_min_u32 v223, -2, v223
v_mul_f32 v198, v198, v87
v_mfma_f32_16x16x32_bf16 v[156:159], a[104:107], a[72:75], v[156:159]
buffer_store_dwordx4 v[220:223], v3, s[4:7], s63 offen offset:1024 sc1
v_mfma_f32_16x16x32_bf16 v[156:159], a[108:111], a[76:79], v[156:159]
ds_read_b128 a[148:151], v5 offset:44032
v_mul_f32 v199, v199, v87
v_mfma_f32_16x16x32_bf16 v[132:135], a[108:111], a[68:71], v[132:135]
v_cvt_pk_bf16_f32 v197, v198, v199
v_mul_f32 v200, v200, v87
v_mfma_f32_16x16x32_bf16 v[132:135], a[104:107], a[64:67], v[132:135]
v_mul_f32 v201, v201, v87
v_cvt_pk_bf16_f32 v198, v200, v201
v_mfma_f32_16x16x32_bf16 v[132:135], a[112:115], a[0:3], v[132:135]
v_mul_f32 v202, v202, v87
v_mul_f32 v203, v203, v87
v_mfma_f32_16x16x32_bf16 v[132:135], a[116:119], a[4:7], v[132:135]
buffer_store_dwordx4 v[236:239], v254, s[4:7], s98 offen offset:0 sc1
v_mfma_f32_16x16x32_bf16 v[156:159], a[116:119], a[12:15], v[156:159]
v_cvt_pk_bf16_f32 v199, v202, v203
v_mul_f32 v174, v174, v85
v_mfma_f32_16x16x32_bf16 v[156:159], a[112:115], a[8:11], v[156:159]
v_mul_f32 v175, v175, v85
v_cvt_pk_bf16_f32 v173, v174, v175
v_mfma_f32_16x16x32_bf16 v[180:183], a[112:115], a[16:19], v[180:183]
v_mul_f32 v176, v176, v85
v_mul_f32 v177, v177, v85
v_mfma_f32_16x16x32_bf16 v[180:183], a[116:119], a[20:23], v[180:183]
v_cvt_pk_bf16_f32 v174, v176, v177
v_mul_f32 v178, v178, v85
v_mfma_f32_16x16x32_bf16 v[204:207], a[116:119], a[28:31], v[204:207]
v_mul_f32 v179, v179, v85
v_cvt_pk_bf16_f32 v175, v178, v179
v_mfma_f32_16x16x32_bf16 v[204:207], a[112:115], a[24:27], v[204:207]
s_waitcnt lgkmcnt(0)
s_barrier
v_mfma_f32_16x16x32_bf16 v[208:211], a[128:131], a[56:59], v[208:211]
ds_write_b128 v233, v[212:215] offset:21504
v_cvt_pk_bf16_f32 v132, v132, v133
v_mfma_f32_16x16x32_bf16 v[208:211], a[132:135], a[60:63], v[208:211]
buffer_store_dwordx4 v[240:243], v254, s[4:7], s98 offen offset:2048 sc1
v_mfma_f32_16x16x32_bf16 v[184:187], a[132:135], a[52:55], v[184:187]
ds_write_b64 v232, v[220:221] offset:4096
v_cvt_pk_bf16_f32 v156, v156, v157
v_mfma_f32_16x16x32_bf16 v[184:187], a[128:131], a[48:51], v[184:187]
ds_write_b64 v232, v[222:223] offset:4608
v_cvt_pk_bf16_f32 v133, v134, v135
v_mfma_f32_16x16x32_bf16 v[160:163], a[128:131], a[40:43], v[160:163]
ds_write_b64 v232, v[196:197] offset:3072
v_cvt_pk_bf16_f32 v180, v180, v181
v_mfma_f32_16x16x32_bf16 v[160:163], a[132:135], a[44:47], v[160:163]
ds_write_b64 v232, v[198:199] offset:3584
v_cvt_pk_bf16_f32 v157, v158, v159
v_mfma_f32_16x16x32_bf16 v[136:139], a[132:135], a[36:39], v[136:139]
ds_write_b64 v232, v[172:173] offset:2048
v_cvt_pk_bf16_f32 v204, v204, v205
v_mfma_f32_16x16x32_bf16 v[136:139], a[128:131], a[32:35], v[136:139]
ds_write_b64 v232, v[174:175] offset:2560
v_cvt_pk_bf16_f32 v181, v182, v183
v_mfma_f32_16x16x32_bf16 v[136:139], a[136:139], a[64:67], v[136:139]
v_cvt_pk_bf16_f32 v205, v206, v207
v_mul_f32 v148, v148, v83
v_mfma_f32_16x16x32_bf16 v[136:139], a[140:143], a[68:71], v[136:139]
v_mul_f32 v149, v149, v83
v_cvt_pk_bf16_f32 v148, v148, v149
v_mfma_f32_16x16x32_bf16 v[160:163], a[140:143], a[76:79], v[160:163]
v_mul_f32 v150, v150, v83
v_mul_f32 v151, v151, v83
v_mfma_f32_16x16x32_bf16 v[160:163], a[136:139], a[72:75], v[160:163]
v_cvt_pk_bf16_f32 v149, v150, v151
v_mul_f32 v152, v152, v83
v_mfma_f32_16x16x32_bf16 v[184:187], a[136:139], a[80:83], v[184:187]
ds_write_b64 v232, v[148:149] offset:1024
v_mul_f32 v153, v153, v83
v_mfma_f32_16x16x32_bf16 v[184:187], a[140:143], a[84:87], v[184:187]
buffer_store_dwordx4 v[244:247], v254, s[4:7], s99 offen offset:0 sc1
v_mfma_f32_16x16x32_bf16 v[208:211], a[140:143], a[92:95], v[208:211]
v_cvt_pk_bf16_f32 v150, v152, v153
v_mul_f32 v154, v154, v83
v_mfma_f32_16x16x32_bf16 v[208:211], a[136:139], a[88:91], v[208:211]
v_mul_f32 v155, v155, v83
v_cvt_pk_bf16_f32 v151, v154, v155
v_mfma_f32_16x16x32_bf16 v[208:211], a[144:147], a[24:27], v[208:211]
ds_write_b64 v232, v[150:151] offset:1536
v_mul_f32 v164, v164, v85
v_mfma_f32_16x16x32_bf16 v[208:211], a[148:151], a[28:31], v[208:211]
v_mul_f32 v165, v165, v85
v_cvt_pk_bf16_f32 v164, v164, v165
v_mfma_f32_16x16x32_bf16 v[184:187], a[148:151], a[20:23], v[184:187]
v_mul_f32 v190, v190, v87
v_mul_f32 v191, v191, v87
v_mfma_f32_16x16x32_bf16 v[184:187], a[144:147], a[16:19], v[184:187]
v_cvt_pk_bf16_f32 v189, v190, v191
v_mul_f32 v166, v166, v85
v_mfma_f32_16x16x32_bf16 v[160:163], a[144:147], a[8:11], v[160:163]
v_mul_f32 v167, v167, v85
v_cvt_pk_bf16_f32 v165, v166, v167
v_mfma_f32_16x16x32_bf16 v[160:163], a[148:151], a[12:15], v[160:163]
v_mul_f32 v142, v142, v83
v_mul_f32 v143, v143, v83
v_mfma_f32_16x16x32_bf16 v[136:139], a[148:151], a[4:7], v[136:139]
v_cvt_pk_bf16_f32 v141, v142, v143
v_mul_f32 v192, v192, v87
v_mfma_f32_16x16x32_bf16 v[136:139], a[144:147], a[0:3], v[136:139]
v_mul_f32 v193, v193, v87
v_cvt_pk_bf16_f32 v190, v192, v193
s_add_u32 m0, s19, 32768
s_xor_b32 s44, s84, 0
buffer_load_dwordx4 v1, s[4:7], s44 offen offset:0 sc1 lds
v_pk_mul_f32 v[194:195], v[194:195], v[86:87] op_sel:[0,1] op_sel_hi:[1,1]
v_pk_mul_f32 v[168:169], v[168:169], v[84:85] op_sel:[0,1] op_sel_hi:[1,1]
v_pk_mul_f32 v[170:171], v[170:171], v[84:85] op_sel:[0,1] op_sel_hi:[1,1]
v_pk_mul_f32 v[144:145], v[144:145], v[82:83] op_sel:[0,1] op_sel_hi:[1,1]
v_pk_mul_f32 v[146:147], v[146:147], v[82:83] op_sel:[0,1] op_sel_hi:[1,1]
v_cvt_pk_bf16_f32 v191, v194, v195
v_cvt_pk_bf16_f32 v166, v168, v169
v_cvt_pk_bf16_f32 v167, v170, v171
v_cvt_pk_bf16_f32 v142, v144, v145
v_cvt_pk_bf16_f32 v143, v146, v147
v_cvt_pk_bf16_f32 v134, v136, v137
v_cvt_pk_bf16_f32 v135, v138, v139
v_cvt_pk_bf16_f32 v158, v160, v161
v_cvt_pk_bf16_f32 v159, v162, v163
v_cvt_pk_bf16_f32 v182, v184, v185
v_cvt_pk_bf16_f32 v183, v186, v187
v_cvt_pk_bf16_f32 v206, v208, v209
v_cvt_pk_bf16_f32 v207, v210, v211
buffer_load_dwordx4 v1, s[4:7], s44 offen offset:1024 sc1 lds
buffer_load_dwordx4 v1, s[4:7], s44 offen offset:2048 sc1 lds
buffer_load_dwordx4 v1, s[4:7], s44 offen offset:3072 sc1 lds
s_add_u32 m0, s19, 98304
s_xor_b32 s44, s84, 65536
buffer_load_dwordx4 v1, s[4:7], s44 offen offset:0 sc1 lds
buffer_load_dwordx4 v1, s[4:7], s44 offen offset:1024 sc1 lds
buffer_load_dwordx4 v1, s[4:7], s44 offen offset:2048 sc1 lds
buffer_load_dwordx4 v1, s[4:7], s44 offen offset:3072 sc1 lds
s_waitcnt lgkmcnt(0)
s_barrier
s_add_u32 m0, s19, 114688
s_xor_b32 s44, s84, 81920
buffer_load_dwordx4 v1, s[4:7], s44 offen offset:0 sc1 lds
v_mfma_f32_16x16x32_bf16 v[208:211], v[188:191], v[204:207], v[20:23]
ds_read_b64_tr_b16 a[10:11], v248 offset:3072
v_mfma_f32_16x16x32_bf16 v[224:227], v[212:215], v[204:207], v[24:27]
ds_read_b64_tr_b16 a[12:13], v248 offset:4096
v_mfma_f32_16x16x32_bf16 v[160:163], v[140:143], v[156:159], v[20:23]
ds_read_b64_tr_b16 a[22:23], v248 offset:3584
v_mfma_f32_16x16x32_bf16 v[176:179], v[164:167], v[156:159], v[24:27]
s_nop 3
v_max_f32 v224, v224, v208
v_max_f32 v225, v225, v209
v_max_f32 v226, v226, v210
v_max_f32 v227, v227, v211
v_max3_f32 v239, v224, v225, v226
v_max_f32 v239, v239, v227
ds_read_b64_tr_b16 a[24:25], v248 offset:4608
v_max_f32 v176, v176, v160
v_max_f32 v177, v177, v161
v_max_f32 v178, v178, v162
v_max_f32 v179, v179, v163
v_max3_f32 v237, v176, v177, v178
buffer_load_dwordx4 v1, s[4:7], s44 offen offset:1024 sc1 lds
v_max_f32 v237, v237, v179
ds_read_b64_tr_b16 a[6:7], v248 offset:1024
s_nop 0
v_permlane32_swap_b32 v239, v237
v_max_f32 v239, v239, v237
v_mov_b32 v242, v239
ds_read_b64_tr_b16 a[8:9], v248 offset:2048
s_nop 0
v_permlane16_swap_b32 v239, v242
v_max_f32 v239, v239, v242
v_mov_b32 v242, v239
ds_read_b64_tr_b16 a[18:19], v248 offset:1536
s_nop 0
v_permlane32_swap_b32 v239, v242
v_mul_f32_e64 v89, -v239, v88
v_fma_f32 v224, v224, v88, v89
v_fma_f32 v225, v225, v88, v89
v_fma_f32 v226, v226, v88, v89
v_fma_f32 v227, v227, v88, v89
buffer_load_dwordx4 v[228:231], v9, s[4:7], s55 offen sc1
buffer_load_dwordx4 v[72:75], v9, s[4:7], s55 offen offset:1024 sc1
v_exp_f32 v224, v224
v_exp_f32 v225, v225
v_exp_f32 v226, v226
buffer_load_dwordx4 v1, s[4:7], s44 offen offset:2048 sc1 lds
v_exp_f32 v227, v227
v_cvt_pk_bf16_f32 v224, v224, v225
v_cvt_pk_bf16_f32 v225, v226, v227
ds_read_b64_tr_b16 a[20:21], v248 offset:2560
v_and_b32 v208, v224, v28
v_and_b32 v209, v225, v29
v_and_b32 v210, v224, v30
v_and_b32 v211, v225, v31
v_mul_f32_e64 v85, -v242, v84
v_fma_f32 v176, v176, v84, v85
v_mfma_f32_16x16x32_bf16 v[216:219], v[16:19], v[208:211], 0
v_fma_f32 v177, v177, v84, v85
v_fma_f32 v178, v178, v84, v85
s_waitcnt lgkmcnt(6)
v_mfma_f32_16x16x32_bf16 v[116:119], a[10:13], v[208:211], 0
v_fma_f32 v179, v179, v84, v85
v_exp_f32 v176, v176
s_waitcnt lgkmcnt(4)
v_mfma_f32_16x16x32_bf16 v[120:123], a[22:25], v[208:211], 0
v_exp_f32 v177, v177
v_exp_f32 v178, v178
buffer_load_dwordx4 v1, s[4:7], s44 offen offset:3072 sc1 lds
v_exp_f32 v179, v179
v_rcp_f32 v216, v216
v_cvt_pk_bf16_f32 v176, v176, v177
v_cvt_pk_bf16_f32 v177, v178, v179
v_and_b32 v160, v176, v28
v_and_b32 v161, v177, v29
v_and_b32 v162, v176, v30
v_and_b32 v163, v177, v31
v_pk_mul_f32 v[116:117], v[116:117], v[216:217] op_sel:[0,0] op_sel_hi:[1,0]
v_cvt_pk_bf16_f32 v116, v116, v117
v_pk_mul_f32 v[118:119], v[118:119], v[216:217] op_sel:[0,0] op_sel_hi:[1,0]
v_cvt_pk_bf16_f32 v117, v118, v119
v_pk_mul_f32 v[120:121], v[120:121], v[216:217] op_sel:[0,0] op_sel_hi:[1,0]
v_cvt_pk_bf16_f32 v118, v120, v121
v_pk_mul_f32 v[122:123], v[122:123], v[216:217] op_sel:[0,0] op_sel_hi:[1,0]
v_cvt_pk_bf16_f32 v119, v122, v123
v_mfma_f32_16x16x32_bf16 v[168:171], v[16:19], v[160:163], 0
s_waitcnt lgkmcnt(2)
v_mfma_f32_16x16x32_bf16 v[100:103], a[6:9], v[160:163], 0
s_waitcnt lgkmcnt(0)
v_mfma_f32_16x16x32_bf16 v[104:107], a[18:21], v[160:163], 0
buffer_store_dwordx4 v[116:119], v2, s[4:7], s72 offen offset:3072 sc1
v_mfma_f32_16x16x32_bf16 v[184:187], v[164:167], v[180:183], v[20:23]
s_nop 1
v_rcp_f32 v168, v168
v_mfma_f32_16x16x32_bf16 v[200:203], v[188:191], v[180:183], v[24:27]
v_pk_mul_f32 v[100:101], v[100:101], v[168:169] op_sel:[0,0] op_sel_hi:[1,0]
v_pk_mul_f32 v[102:103], v[102:103], v[168:169] op_sel:[0,0] op_sel_hi:[1,0]
v_cvt_pk_bf16_f32 v100, v100, v101
v_pk_mul_f32 v[104:105], v[104:105], v[168:169] op_sel:[0,0] op_sel_hi:[1,0]
v_pk_mul_f32 v[106:107], v[106:107], v[168:169] op_sel:[0,0] op_sel_hi:[1,0]
v_cvt_pk_bf16_f32 v101, v102, v103
v_cvt_pk_bf16_f32 v102, v104, v105
v_cvt_pk_bf16_f32 v103, v106, v107
v_max_f32 v200, v200, v184
v_max_f32 v201, v201, v185
v_max_f32 v202, v202, v186
buffer_store_dwordx4 v[100:103], v2, s[4:7], s72 offen offset:1024 sc1
v_max_f32 v203, v203, v187
v_max3_f32 v238, v200, v201, v202
v_max_f32 v238, v238, v203
s_cmp_lg_u32 s28, 0
s_cbranch_scc1 Lhx_8
s_waitcnt vmcnt(5)
v_max3_u32 v244, v228, v229, v230
s_waitcnt vmcnt(4)
v_max3_u32 v244, v244, v231, v72
v_max3_u32 v244, v244, v73, v74
v_max_u32 v244, v244, v75
v_cmp_eq_u32 vcc, -1, v244
s_cbranch_vccnz L_hxredo0
L_hxback0:
ds_write_b128 v233, v[228:231] offset:20480
ds_write_b64 v232, v[72:73] offset:0
ds_write_b64 v232, v[74:75] offset:512
Lhx_8:
ds_read_b128 a[0:3], v233 offset:20480
v_mfma_f32_16x16x32_bf16 v[152:155], v[140:143], v[132:135], v[24:27]
ds_read_b64_tr_b16 a[4:5], v248 offset:0
ds_read_b64_tr_b16 a[16:17], v248 offset:512
s_waitcnt lgkmcnt(2)
v_mfma_f32_16x16x32_bf16 v[136:139], a[0:3], v[132:135], v[76:79]
s_nop 7
v_max_f32 v152, v152, v136
v_max_f32 v153, v153, v137
v_max_f32 v154, v154, v138
v_max_f32 v155, v155, v139
v_max3_f32 v236, v152, v153, v154
v_max_f32 v236, v236, v155
s_nop 1
v_permlane32_swap_b32 v238, v236
v_max_f32 v238, v238, v236
v_mov_b32 v243, v238
s_nop 1
v_permlane16_swap_b32 v238, v243
v_max_f32 v238, v238, v243
v_mov_b32 v243, v238
s_nop 1
v_permlane32_swap_b32 v238, v243
v_mul_f32_e64 v87, -v238, v86
v_fma_f32 v200, v200, v86, v87
v_fma_f32 v201, v201, v86, v87
v_fma_f32 v202, v202, v86, v87
v_fma_f32 v203, v203, v86, v87
v_exp_f32 v200, v200
v_exp_f32 v201, v201
v_exp_f32 v202, v202
v_exp_f32 v203, v203
v_cvt_pk_bf16_f32 v200, v200, v201
v_cvt_pk_bf16_f32 v201, v202, v203
v_and_b32 v184, v200, v28
v_and_b32 v185, v201, v29
v_and_b32 v186, v200, v30
v_and_b32 v187, v201, v31
v_mul_f32_e64 v83, -v243, v82
v_fma_f32 v152, v152, v82, v83
v_mfma_f32_16x16x32_bf16 v[192:195], v[16:19], v[184:187], 0
v_fma_f32 v153, v153, v82, v83
v_fma_f32 v154, v154, v82, v83
v_mfma_f32_16x16x32_bf16 v[108:111], a[8:11], v[184:187], 0
v_fma_f32 v155, v155, v82, v83
v_exp_f32 v152, v152
v_mfma_f32_16x16x32_bf16 v[112:115], a[20:23], v[184:187], 0
v_exp_f32 v153, v153
v_exp_f32 v154, v154
v_exp_f32 v155, v155
v_rcp_f32 v192, v192
v_cvt_pk_bf16_f32 v152, v152, v153
v_cvt_pk_bf16_f32 v153, v154, v155
v_and_b32 v136, v152, v80
v_and_b32 v137, v153, v81
v_and_b32 v138, v152, v30
v_and_b32 v139, v153, v31
v_pk_mul_f32 v[108:109], v[108:109], v[192:193] op_sel:[0,0] op_sel_hi:[1,0]
v_pk_mul_f32 v[110:111], v[110:111], v[192:193] op_sel:[0,0] op_sel_hi:[1,0]
v_cvt_pk_bf16_f32 v108, v108, v109
v_pk_mul_f32 v[112:113], v[112:113], v[192:193] op_sel:[0,0] op_sel_hi:[1,0]
v_cvt_pk_bf16_f32 v109, v110, v111
v_pk_mul_f32 v[114:115], v[114:115], v[192:193] op_sel:[0,0] op_sel_hi:[1,0]
v_cvt_pk_bf16_f32 v110, v112, v113
v_mfma_f32_16x16x32_bf16 v[144:147], v[16:19], v[136:139], 0
v_cvt_pk_bf16_f32 v111, v114, v115
buffer_store_dwordx4 v[108:111], v2, s[4:7], s72 offen offset:2048 sc1
s_waitcnt lgkmcnt(1)
v_mfma_f32_16x16x32_bf16 v[92:95], a[4:7], v[136:139], 0
s_nop 3
v_rcp_f32 v144, v144
s_waitcnt lgkmcnt(0)
v_mfma_f32_16x16x32_bf16 v[96:99], a[16:19], v[136:139], 0
s_nop 0
v_pk_mul_f32 v[92:93], v[92:93], v[144:145] op_sel:[0,0] op_sel_hi:[1,0]
v_pk_mul_f32 v[94:95], v[94:95], v[144:145] op_sel:[0,0] op_sel_hi:[1,0]
v_cvt_pk_bf16_f32 v92, v92, v93
v_cvt_pk_bf16_f32 v93, v94, v95
s_nop 2
v_pk_mul_f32 v[96:97], v[96:97], v[144:145] op_sel:[0,0] op_sel_hi:[1,0]
v_pk_mul_f32 v[98:99], v[98:99], v[144:145] op_sel:[0,0] op_sel_hi:[1,0]
v_cvt_pk_bf16_f32 v94, v96, v97
v_cvt_pk_bf16_f32 v95, v98, v99
buffer_store_dwordx4 v[92:95], v2, s[4:7], s72 offen offset:0 sc1
s_add_u32 s92, s71, 0x0
v_accvgpr_write_b32 a188, v48
v_accvgpr_write_b32 a189, v49
v_accvgpr_write_b32 a190, v50
v_accvgpr_write_b32 a191, v51
v_accvgpr_write_b32 a192, v52
v_accvgpr_write_b32 a193, v53
v_accvgpr_write_b32 a194, v54
v_accvgpr_write_b32 a195, v55
v_accvgpr_write_b32 a196, v56
v_accvgpr_write_b32 a197, v57
v_accvgpr_write_b32 a198, v58
v_accvgpr_write_b32 a199, v59
v_accvgpr_write_b32 a200, v60
v_accvgpr_write_b32 a201, v61
v_accvgpr_write_b32 a202, v62
v_accvgpr_write_b32 a203, v63
v_accvgpr_write_b32 a204, v64
v_accvgpr_write_b32 a205, v65
v_accvgpr_write_b32 a206, v66
v_accvgpr_write_b32 a207, v67
v_accvgpr_write_b32 a208, v68
v_accvgpr_write_b32 a209, v69
v_accvgpr_write_b32 a210, v70
v_accvgpr_write_b32 a211, v71
s_add_u32 s40, s4, 0x800000
s_addc_u32 s41, s5, 0
v_add_u32 v5, 32768, v1
v_add_u32 v6, 98304, v1
s_mov_b32 s35, s77
v_lshlrev_b32 v132, 16, v32
v_and_b32 v133, 0xffff0000, v32
v_lshlrev_b32 v134, 16, v33
v_and_b32 v135, 0xffff0000, v33
v_lshlrev_b32 v136, 16, v34
v_and_b32 v137, 0xffff0000, v34
v_lshlrev_b32 v138, 16, v35
v_and_b32 v139, 0xffff0000, v35
v_lshlrev_b32 v140, 16, v36
v_and_b32 v141, 0xffff0000, v36
v_lshlrev_b32 v142, 16, v37
v_and_b32 v143, 0xffff0000, v37
v_lshlrev_b32 v144, 16, v38
v_and_b32 v145, 0xffff0000, v38
v_lshlrev_b32 v146, 16, v39
v_and_b32 v147, 0xffff0000, v39
v_lshlrev_b32 v148, 16, v40
v_and_b32 v149, 0xffff0000, v40
v_lshlrev_b32 v150, 16, v41
v_and_b32 v151, 0xffff0000, v41
v_lshlrev_b32 v152, 16, v42
v_and_b32 v153, 0xffff0000, v42
v_lshlrev_b32 v154, 16, v43
v_and_b32 v155, 0xffff0000, v43
v_lshlrev_b32 v156, 16, v44
v_and_b32 v157, 0xffff0000, v44
v_lshlrev_b32 v158, 16, v45
v_and_b32 v159, 0xffff0000, v45
v_lshlrev_b32 v160, 16, v46
v_and_b32 v161, 0xffff0000, v46
v_lshlrev_b32 v162, 16, v47
v_and_b32 v163, 0xffff0000, v47
s_waitcnt vmcnt(0)
s_barrier
s_cmp_lg_u32 s28, 0
s_cbranch_scc1 Lsg_9
buffer_atomic_add v12, v10, s[4:7], s92 offen sc1
buffer_atomic_swap v15, v14, s[4:7], s8 offen sc1
buffer_atomic_swap v15, v252, s[4:7], s62 offen offset:64 sc1
Lsg_9:
s_add_u32 m0, s19, 131072
s_xor_b32 s44, s84, 98304
buffer_load_dwordx4 v1, s[4:7], s44 offen offset:0 sc1 lds
buffer_load_dwordx4 v1, s[4:7], s44 offen offset:1024 sc1 lds
buffer_load_dwordx4 v1, s[4:7], s44 offen offset:2048 sc1 lds
buffer_load_dwordx4 v1, s[4:7], s44 offen offset:3072 sc1 lds
s_add_u32 m0, s19, 147456
s_xor_b32 s44, s84, 114688
buffer_load_dwordx4 v1, s[4:7], s44 offen offset:0 sc1 lds
buffer_load_dwordx4 v1, s[4:7], s44 offen offset:1024 sc1 lds
buffer_load_dwordx4 v1, s[4:7], s44 offen offset:2048 sc1 lds
buffer_load_dwordx4 v1, s[4:7], s44 offen offset:3072 sc1 lds
s_mov_b64 exec, 0
s_cmp_eq_u32 s28, 3
s_cbranch_scc1 L_stub3
s_cmp_eq_u32 s28, 2
s_cbranch_scc1 L_stub4
s_cmp_eq_u32 s28, 0
s_cbranch_scc1 L_stub8
L_wret1:
s_mov_b64 exec, -1
s_cmp_lg_u32 s28, 1
s_cbranch_scc1 Lpo_12
s_add_u32 s36, s11, 0x0
s_mov_b32 s37, 0
v_mov_b32 v11, 0
buffer_atomic_add v11, v251, s[4:7], s36 offen sc0 sc1
s_sleep 4
Lpoll_10:
v_mov_b32 v234, 0
buffer_atomic_add v234, v251, s[4:7], s36 offen sc0 sc1
s_waitcnt vmcnt(1)
v_readfirstlane_b32 s38, v11
s_nop 0
s_cmp_ge_u32 s38, 32
s_cbranch_scc1 Lpe_11
v_mov_b32 v11, 0
buffer_atomic_add v11, v251, s[4:7], s36 offen sc0 sc1
s_waitcnt vmcnt(1)
v_readfirstlane_b32 s38, v234
s_nop 0
s_cmp_ge_u32 s38, 32
s_cbranch_scc1 Lpe_11
s_add_u32 s37, s37, 1
s_cmp_lt_u32 s37, 0x80000
s_cbranch_scc1 Lpoll_10
s_waitcnt vmcnt(0)
Lpo_12:
s_waitcnt vmcnt(0)
Lpe_11:
s_barrier
L_k2go0:
buffer_load_dwordx4 a[0:3], v4, s[40:43], s35 offen offset:0 sc1
buffer_load_dwordx4 a[4:7], v4, s[40:43], s35 offen offset:1024 sc1
s_xor_b32 s35, s77, 4096
buffer_load_dwordx4 a[8:11], v4, s[40:43], s35 offen offset:0 sc1
buffer_load_dwordx4 a[12:15], v4, s[40:43], s35 offen offset:1024 sc1
s_xor_b32 s35, s77, 16384
buffer_load_dwordx4 a[16:19], v4, s[40:43], s35 offen offset:0 sc1
buffer_load_dwordx4 a[20:23], v4, s[40:43], s35 offen offset:1024 sc1
s_xor_b32 s35, s77, 20480
buffer_load_dwordx4 a[24:27], v4, s[40:43], s35 offen offset:0 sc1
buffer_load_dwordx4 a[28:31], v4, s[40:43], s35 offen offset:1024 sc1
s_xor_b32 s35, s77, 32768
buffer_load_dwordx4 a[32:35], v4, s[40:43], s35 offen offset:0 sc1
buffer_load_dwordx4 a[36:39], v4, s[40:43], s35 offen offset:1024 sc1
s_xor_b32 s35, s77, 36864
buffer_load_dwordx4 a[40:43], v4, s[40:43], s35 offen offset:0 sc1
buffer_load_dwordx4 a[44:47], v4, s[40:43], s35 offen offset:1024 sc1
s_xor_b32 s35, s77, 49152
ds_read_b128 a[96:99], v5 offset:0
ds_read_b128 a[100:103], v5 offset:1024
ds_read_b128 a[104:107], v5 offset:2048
ds_read_b128 a[108:111], v5 offset:3072
ds_read_b128 a[112:115], v5 offset:4096
ds_read_b128 a[116:119], v5 offset:5120
ds_read_b128 a[120:123], v5 offset:6144
ds_read_b128 a[124:127], v5 offset:7168
s_waitcnt vmcnt(10) lgkmcnt(4)
v_mfma_f32_16x16x32_bf16 v[132:135], a[96:99], a[0:3], v[132:135]
ds_read_b128 a[128:131], v5 offset:8192
v_mfma_f32_16x16x32_bf16 v[148:151], a[96:99], a[4:7], v[148:151]
ds_read_b128 a[132:135], v5 offset:9216
v_mfma_f32_16x16x32_bf16 v[152:155], a[100:103], a[4:7], v[152:155]
buffer_load_dwordx4 a[48:51], v4, s[40:43], s35 offen offset:0 sc1
v_mfma_f32_16x16x32_bf16 v[136:139], a[100:103], a[0:3], v[136:139]
ds_read_b128 a[136:139], v5 offset:10240
v_mfma_f32_16x16x32_bf16 v[140:143], a[104:107], a[0:3], v[140:143]
ds_read_b128 a[140:143], v5 offset:11264
v_mfma_f32_16x16x32_bf16 v[156:159], a[104:107], a[4:7], v[156:159]
v_mfma_f32_16x16x32_bf16 v[160:163], a[108:111], a[4:7], v[160:163]
buffer_load_dwordx4 a[52:55], v4, s[40:43], s35 offen offset:1024 sc1
s_xor_b32 s35, s77, 53248
v_mfma_f32_16x16x32_bf16 v[144:147], a[108:111], a[0:3], v[144:147]
s_waitcnt vmcnt(10) lgkmcnt(4)
v_mfma_f32_16x16x32_bf16 v[132:135], a[112:115], a[8:11], v[132:135]
ds_read_b128 a[96:99], v5 offset:12288
v_mfma_f32_16x16x32_bf16 v[148:151], a[112:115], a[12:15], v[148:151]
L_stub3:
s_cbranch_execz L_wret1
ds_read_b128 a[100:103], v5 offset:13312
v_mfma_f32_16x16x32_bf16 v[152:155], a[116:119], a[12:15], v[152:155]
buffer_load_dwordx4 a[0:3], v4, s[40:43], s35 offen offset:0 sc1
v_mfma_f32_16x16x32_bf16 v[136:139], a[116:119], a[8:11], v[136:139]
ds_read_b128 a[104:107], v5 offset:14336
v_mfma_f32_16x16x32_bf16 v[140:143], a[120:123], a[8:11], v[140:143]
ds_read_b128 a[108:111], v5 offset:15360
v_mfma_f32_16x16x32_bf16 v[156:159], a[120:123], a[12:15], v[156:159]
v_mfma_f32_16x16x32_bf16 v[160:163], a[124:127], a[12:15], v[160:163]
buffer_load_dwordx4 a[4:7], v4, s[40:43], s35 offen offset:1024 sc1
s_xor_b32 s35, s77, 65536
v_mfma_f32_16x16x32_bf16 v[144:147], a[124:127], a[8:11], v[144:147]
s_waitcnt vmcnt(10) lgkmcnt(4)
v_mfma_f32_16x16x32_bf16 v[132:135], a[128:131], a[16:19], v[132:135]
ds_read_b128 a[112:115], v5 offset:16384
v_mfma_f32_16x16x32_bf16 v[148:151], a[128:131], a[20:23], v[148:151]
ds_read_b128 a[116:119], v5 offset:17408
v_mfma_f32_16x16x32_bf16 v[152:155], a[132:135], a[20:23], v[152:155]
buffer_load_dwordx4 a[8:11], v4, s[40:43], s35 offen offset:0 sc1
v_mfma_f32_16x16x32_bf16 v[136:139], a[132:135], a[16:19], v[136:139]
ds_read_b128 a[120:123], v5 offset:18432
v_mfma_f32_16x16x32_bf16 v[140:143], a[136:139], a[16:19], v[140:143]
ds_read_b128 a[124:127], v5 offset:19456
v_mfma_f32_16x16x32_bf16 v[156:159], a[136:139], a[20:23], v[156:159]
v_mfma_f32_16x16x32_bf16 v[160:163], a[140:143], a[20:23], v[160:163]
buffer_load_dwordx4 a[12:15], v4, s[40:43], s35 offen offset:1024 sc1
s_xor_b32 s35, s77, 69632
v_mfma_f32_16x16x32_bf16 v[144:147], a[140:143], a[16:19], v[144:147]
s_waitcnt vmcnt(10) lgkmcnt(4)
v_mfma_f32_16x16x32_bf16 v[132:135], a[96:99], a[24:27], v[132:135]
ds_read_b128 a[128:131], v5 offset:20480
v_mfma_f32_16x16x32_bf16 v[148:151], a[96:99], a[28:31], v[148:151]
ds_read_b128 a[132:135], v5 offset:21504
v_mfma_f32_16x16x32_bf16 v[152:155], a[100:103], a[28:31], v[152:155]
buffer_load_dwordx4 a[16:19], v4, s[40:43], s35 offen offset:0 sc1
v_mfma_f32_16x16x32_bf16 v[136:139], a[100:103], a[24:27], v[136:139]
ds_read_b128 a[136:139], v5 offset:22528
v_mfma_f32_16x16x32_bf16 v[140:143], a[104:107], a[24:27], v[140:143]
ds_read_b128 a[140:143], v5 offset:23552
v_mfma_f32_16x16x32_bf16 v[156:159], a[104:107], a[28:31], v[156:159]
v_mfma_f32_16x16x32_bf16 v[160:163], a[108:111], a[28:31], v[160:163]
buffer_load_dwordx4 a[20:23], v4, s[40:43], s35 offen offset:1024 sc1
s_xor_b32 s35, s77, 81920
v_mfma_f32_16x16x32_bf16 v[144:147], a[108:111], a[24:27], v[144:147]
s_waitcnt vmcnt(10) lgkmcnt(4)
v_mfma_f32_16x16x32_bf16 v[132:135], a[112:115], a[32:35], v[132:135]
ds_read_b128 a[96:99], v5 offset:24576
v_mfma_f32_16x16x32_bf16 v[148:151], a[112:115], a[36:39], v[148:151]
ds_read_b128 a[100:103], v5 offset:25600
v_mfma_f32_16x16x32_bf16 v[152:155], a[116:119], a[36:39], v[152:155]
buffer_load_dwordx4 a[24:27], v4, s[40:43], s35 offen offset:0 sc1
v_mfma_f32_16x16x32_bf16 v[136:139], a[116:119], a[32:35], v[136:139]
ds_read_b128 a[104:107], v5 offset:26624
v_mfma_f32_16x16x32_bf16 v[140:143], a[120:123], a[32:35], v[140:143]
ds_read_b128 a[108:111], v5 offset:27648
v_mfma_f32_16x16x32_bf16 v[156:159], a[120:123], a[36:39], v[156:159]
v_mfma_f32_16x16x32_bf16 v[160:163], a[124:127], a[36:39], v[160:163]
buffer_load_dwordx4 a[28:31], v4, s[40:43], s35 offen offset:1024 sc1
s_xor_b32 s35, s77, 86016
v_mfma_f32_16x16x32_bf16 v[144:147], a[124:127], a[32:35], v[144:147]
s_waitcnt vmcnt(10) lgkmcnt(4)
v_mfma_f32_16x16x32_bf16 v[132:135], a[128:131], a[40:43], v[132:135]
ds_read_b128 a[112:115], v5 offset:28672
v_mfma_f32_16x16x32_bf16 v[148:151], a[128:131], a[44:47], v[148:151]
ds_read_b128 a[116:119], v5 offset:29696
v_mfma_f32_16x16x32_bf16 v[152:155], a[132:135], a[44:47], v[152:155]
buffer_load_dwordx4 a[32:35], v4, s[40:43], s35 offen offset:0 sc1
v_mfma_f32_16x16x32_bf16 v[136:139], a[132:135], a[40:43], v[136:139]
ds_read_b128 a[120:123], v5 offset:30720
v_mfma_f32_16x16x32_bf16 v[140:143], a[136:139], a[40:43], v[140:143]
ds_read_b128 a[124:127], v5 offset:31744
v_mfma_f32_16x16x32_bf16 v[156:159], a[136:139], a[44:47], v[156:159]
v_mfma_f32_16x16x32_bf16 v[160:163], a[140:143], a[44:47], v[160:163]
buffer_load_dwordx4 a[36:39], v4, s[40:43], s35 offen offset:1024 sc1
s_xor_b32 s35, s77, 98304
v_mfma_f32_16x16x32_bf16 v[144:147], a[140:143], a[40:43], v[144:147]
s_waitcnt vmcnt(10) lgkmcnt(4)
v_mfma_f32_16x16x32_bf16 v[132:135], a[96:99], a[48:51], v[132:135]
ds_read_b128 a[128:131], v5 offset:32768
v_mfma_f32_16x16x32_bf16 v[148:151], a[96:99], a[52:55], v[148:151]
ds_read_b128 a[132:135], v5 offset:33792
v_mfma_f32_16x16x32_bf16 v[152:155], a[100:103], a[52:55], v[152:155]
buffer_load_dwordx4 a[40:43], v4, s[40:43], s35 offen offset:0 sc1
v_mfma_f32_16x16x32_bf16 v[136:139], a[100:103], a[48:51], v[136:139]
ds_read_b128 a[136:139], v5 offset:34816
v_mfma_f32_16x16x32_bf16 v[140:143], a[104:107], a[48:51], v[140:143]
ds_read_b128 a[140:143], v5 offset:35840
v_mfma_f32_16x16x32_bf16 v[156:159], a[104:107], a[52:55], v[156:159]
v_mfma_f32_16x16x32_bf16 v[160:163], a[108:111], a[52:55], v[160:163]
buffer_load_dwordx4 a[44:47], v4, s[40:43], s35 offen offset:1024 sc1
s_xor_b32 s35, s77, 102400
v_mfma_f32_16x16x32_bf16 v[144:147], a[108:111], a[48:51], v[144:147]
s_waitcnt vmcnt(10) lgkmcnt(4)
v_mfma_f32_16x16x32_bf16 v[132:135], a[112:115], a[0:3], v[132:135]
ds_read_b128 a[96:99], v5 offset:36864
v_mfma_f32_16x16x32_bf16 v[148:151], a[112:115], a[4:7], v[148:151]
ds_read_b128 a[100:103], v5 offset:37888
v_mfma_f32_16x16x32_bf16 v[152:155], a[116:119], a[4:7], v[152:155]
buffer_load_dwordx4 a[48:51], v4, s[40:43], s35 offen offset:0 sc1
v_mfma_f32_16x16x32_bf16 v[136:139], a[116:119], a[0:3], v[136:139]
ds_read_b128 a[104:107], v5 offset:38912
v_mfma_f32_16x16x32_bf16 v[140:143], a[120:123], a[0:3], v[140:143]
ds_read_b128 a[108:111], v5 offset:39936
v_mfma_f32_16x16x32_bf16 v[156:159], a[120:123], a[4:7], v[156:159]
v_mfma_f32_16x16x32_bf16 v[160:163], a[124:127], a[4:7], v[160:163]
buffer_load_dwordx4 a[52:55], v4, s[40:43], s35 offen offset:1024 sc1
s_xor_b32 s35, s77, 114688
v_mfma_f32_16x16x32_bf16 v[144:147], a[124:127], a[0:3], v[144:147]
s_waitcnt vmcnt(10) lgkmcnt(4)
v_mfma_f32_16x16x32_bf16 v[132:135], a[128:131], a[8:11], v[132:135]
ds_read_b128 a[112:115], v5 offset:40960
v_mfma_f32_16x16x32_bf16 v[148:151], a[128:131], a[12:15], v[148:151]
ds_read_b128 a[116:119], v5 offset:41984
v_mfma_f32_16x16x32_bf16 v[152:155], a[132:135], a[12:15], v[152:155]
buffer_load_dwordx4 a[0:3], v4, s[40:43], s35 offen offset:0 sc1
v_mfma_f32_16x16x32_bf16 v[136:139], a[132:135], a[8:11], v[136:139]
ds_read_b128 a[120:123], v5 offset:43008
v_mfma_f32_16x16x32_bf16 v[140:143], a[136:139], a[8:11], v[140:143]
ds_read_b128 a[124:127], v5 offset:44032
v_mfma_f32_16x16x32_bf16 v[156:159], a[136:139], a[12:15], v[156:159]
v_mfma_f32_16x16x32_bf16 v[160:163], a[140:143], a[12:15], v[160:163]
buffer_load_dwordx4 a[4:7], v4, s[40:43], s35 offen offset:1024 sc1
s_xor_b32 s35, s77, 118784
v_mfma_f32_16x16x32_bf16 v[144:147], a[140:143], a[8:11], v[144:147]
s_waitcnt vmcnt(10) lgkmcnt(4)
v_mfma_f32_16x16x32_bf16 v[132:135], a[96:99], a[16:19], v[132:135]
ds_read_b128 a[128:131], v5 offset:45056
v_mfma_f32_16x16x32_bf16 v[148:151], a[96:99], a[20:23], v[148:151]
ds_read_b128 a[132:135], v5 offset:46080
v_mfma_f32_16x16x32_bf16 v[152:155], a[100:103], a[20:23], v[152:155]
buffer_load_dwordx4 a[8:11], v4, s[40:43], s35 offen offset:0 sc1
v_mfma_f32_16x16x32_bf16 v[136:139], a[100:103], a[16:19], v[136:139]
ds_read_b128 a[136:139], v5 offset:47104
v_mfma_f32_16x16x32_bf16 v[140:143], a[104:107], a[16:19], v[140:143]
ds_read_b128 a[140:143], v5 offset:48128
v_mfma_f32_16x16x32_bf16 v[156:159], a[104:107], a[20:23], v[156:159]
v_mfma_f32_16x16x32_bf16 v[160:163], a[108:111], a[20:23], v[160:163]
buffer_load_dwordx4 a[12:15], v4, s[40:43], s35 offen offset:1024 sc1
s_xor_b32 s35, s77, 524288
v_mfma_f32_16x16x32_bf16 v[144:147], a[108:111], a[16:19], v[144:147]
s_waitcnt vmcnt(10) lgkmcnt(4)
v_mfma_f32_16x16x32_bf16 v[132:135], a[112:115], a[24:27], v[132:135]
ds_read_b128 a[96:99], v5 offset:49152
v_mfma_f32_16x16x32_bf16 v[148:151], a[112:115], a[28:31], v[148:151]
ds_read_b128 a[100:103], v5 offset:50176
v_mfma_f32_16x16x32_bf16 v[152:155], a[116:119], a[28:31], v[152:155]
buffer_load_dwordx4 a[16:19], v4, s[40:43], s35 offen offset:0 sc1
v_mfma_f32_16x16x32_bf16 v[136:139], a[116:119], a[24:27], v[136:139]
ds_read_b128 a[104:107], v5 offset:51200
v_mfma_f32_16x16x32_bf16 v[140:143], a[120:123], a[24:27], v[140:143]
ds_read_b128 a[108:111], v5 offset:52224
v_mfma_f32_16x16x32_bf16 v[156:159], a[120:123], a[28:31], v[156:159]
v_mfma_f32_16x16x32_bf16 v[160:163], a[124:127], a[28:31], v[160:163]
buffer_load_dwordx4 a[20:23], v4, s[40:43], s35 offen offset:1024 sc1
s_xor_b32 s35, s77, 528384
v_mfma_f32_16x16x32_bf16 v[144:147], a[124:127], a[24:27], v[144:147]
s_waitcnt vmcnt(10) lgkmcnt(4)
v_mfma_f32_16x16x32_bf16 v[132:135], a[128:131], a[32:35], v[132:135]
ds_read_b128 a[112:115], v5 offset:53248
v_mfma_f32_16x16x32_bf16 v[148:151], a[128:131], a[36:39], v[148:151]
ds_read_b128 a[116:119], v5 offset:54272
v_mfma_f32_16x16x32_bf16 v[152:155], a[132:135], a[36:39], v[152:155]
buffer_load_dwordx4 a[24:27], v4, s[40:43], s35 offen offset:0 sc1
v_mfma_f32_16x16x32_bf16 v[136:139], a[132:135], a[32:35], v[136:139]
ds_read_b128 a[120:123], v5 offset:55296
v_mfma_f32_16x16x32_bf16 v[140:143], a[136:139], a[32:35], v[140:143]
ds_read_b128 a[124:127], v5 offset:56320
v_mfma_f32_16x16x32_bf16 v[156:159], a[136:139], a[36:39], v[156:159]
v_mfma_f32_16x16x32_bf16 v[160:163], a[140:143], a[36:39], v[160:163]
buffer_load_dwordx4 a[28:31], v4, s[40:43], s35 offen offset:1024 sc1
s_xor_b32 s35, s77, 540672
v_mfma_f32_16x16x32_bf16 v[144:147], a[140:143], a[32:35], v[144:147]
s_waitcnt vmcnt(10) lgkmcnt(4)
v_mfma_f32_16x16x32_bf16 v[132:135], a[96:99], a[40:43], v[132:135]
ds_read_b128 a[128:131], v5 offset:57344
v_mfma_f32_16x16x32_bf16 v[148:151], a[96:99], a[44:47], v[148:151]
ds_read_b128 a[132:135], v5 offset:58368
v_mfma_f32_16x16x32_bf16 v[152:155], a[100:103], a[44:47], v[152:155]
buffer_load_dwordx4 a[32:35], v4, s[40:43], s35 offen offset:0 sc1
v_mfma_f32_16x16x32_bf16 v[136:139], a[100:103], a[40:43], v[136:139]
ds_read_b128 a[136:139], v5 offset:59392
v_mfma_f32_16x16x32_bf16 v[140:143], a[104:107], a[40:43], v[140:143]
ds_read_b128 a[140:143], v5 offset:60416
v_mfma_f32_16x16x32_bf16 v[156:159], a[104:107], a[44:47], v[156:159]
v_mfma_f32_16x16x32_bf16 v[160:163], a[108:111], a[44:47], v[160:163]
buffer_load_dwordx4 a[36:39], v4, s[40:43], s35 offen offset:1024 sc1
s_xor_b32 s35, s77, 544768
v_mfma_f32_16x16x32_bf16 v[144:147], a[108:111], a[40:43], v[144:147]
s_waitcnt vmcnt(10) lgkmcnt(4)
v_mfma_f32_16x16x32_bf16 v[132:135], a[112:115], a[48:51], v[132:135]
ds_read_b128 a[96:99], v5 offset:61440
v_mfma_f32_16x16x32_bf16 v[148:151], a[112:115], a[52:55], v[148:151]
ds_read_b128 a[100:103], v5 offset:62464
v_mfma_f32_16x16x32_bf16 v[152:155], a[116:119], a[52:55], v[152:155]
buffer_load_dwordx4 a[40:43], v4, s[40:43], s35 offen offset:0 sc1
v_mfma_f32_16x16x32_bf16 v[136:139], a[116:119], a[48:51], v[136:139]
ds_read_b128 a[104:107], v5 offset:63488
v_mfma_f32_16x16x32_bf16 v[140:143], a[120:123], a[48:51], v[140:143]
ds_read_b128 a[108:111], v5 offset:64512
v_mfma_f32_16x16x32_bf16 v[156:159], a[120:123], a[52:55], v[156:159]
v_mfma_f32_16x16x32_bf16 v[160:163], a[124:127], a[52:55], v[160:163]
buffer_load_dwordx4 a[44:47], v4, s[40:43], s35 offen offset:1024 sc1
s_xor_b32 s35, s77, 557056
v_mfma_f32_16x16x32_bf16 v[144:147], a[124:127], a[48:51], v[144:147]
s_waitcnt vmcnt(10) lgkmcnt(4)
v_mfma_f32_16x16x32_bf16 v[132:135], a[128:131], a[0:3], v[132:135]
ds_read_b128 a[112:115], v6 offset:0
v_mfma_f32_16x16x32_bf16 v[148:151], a[128:131], a[4:7], v[148:151]
ds_read_b128 a[116:119], v6 offset:1024
v_mfma_f32_16x16x32_bf16 v[152:155], a[132:135], a[4:7], v[152:155]
buffer_load_dwordx4 a[48:51], v4, s[40:43], s35 offen offset:0 sc1
v_mfma_f32_16x16x32_bf16 v[136:139], a[132:135], a[0:3], v[136:139]
ds_read_b128 a[120:123], v6 offset:2048
v_mfma_f32_16x16x32_bf16 v[140:143], a[136:139], a[0:3], v[140:143]
ds_read_b128 a[124:127], v6 offset:3072
v_mfma_f32_16x16x32_bf16 v[156:159], a[136:139], a[4:7], v[156:159]
v_mfma_f32_16x16x32_bf16 v[160:163], a[140:143], a[4:7], v[160:163]
buffer_load_dwordx4 a[52:55], v4, s[40:43], s35 offen offset:1024 sc1
s_xor_b32 s35, s77, 561152
v_mfma_f32_16x16x32_bf16 v[144:147], a[140:143], a[0:3], v[144:147]
s_waitcnt vmcnt(10) lgkmcnt(4)
v_mfma_f32_16x16x32_bf16 v[132:135], a[96:99], a[8:11], v[132:135]
ds_read_b128 a[128:131], v6 offset:4096
v_mfma_f32_16x16x32_bf16 v[148:151], a[96:99], a[12:15], v[148:151]
ds_read_b128 a[132:135], v6 offset:5120
v_mfma_f32_16x16x32_bf16 v[152:155], a[100:103], a[12:15], v[152:155]
buffer_load_dwordx4 a[0:3], v4, s[40:43], s35 offen offset:0 sc1
v_mfma_f32_16x16x32_bf16 v[136:139], a[100:103], a[8:11], v[136:139]
ds_read_b128 a[136:139], v6 offset:6144
v_mfma_f32_16x16x32_bf16 v[140:143], a[104:107], a[8:11], v[140:143]
ds_read_b128 a[140:143], v6 offset:7168
v_mfma_f32_16x16x32_bf16 v[156:159], a[104:107], a[12:15], v[156:159]
v_mfma_f32_16x16x32_bf16 v[160:163], a[108:111], a[12:15], v[160:163]
buffer_load_dwordx4 a[4:7], v4, s[40:43], s35 offen offset:1024 sc1
s_xor_b32 s35, s77, 573440
v_mfma_f32_16x16x32_bf16 v[144:147], a[108:111], a[8:11], v[144:147]
s_waitcnt vmcnt(10) lgkmcnt(4)
v_mfma_f32_16x16x32_bf16 v[132:135], a[112:115], a[16:19], v[132:135]
ds_read_b128 a[96:99], v6 offset:8192
v_mfma_f32_16x16x32_bf16 v[148:151], a[112:115], a[20:23], v[148:151]
ds_read_b128 a[100:103], v6 offset:9216
v_mfma_f32_16x16x32_bf16 v[152:155], a[116:119], a[20:23], v[152:155]
buffer_load_dwordx4 a[8:11], v4, s[40:43], s35 offen offset:0 sc1
v_mfma_f32_16x16x32_bf16 v[136:139], a[116:119], a[16:19], v[136:139]
ds_read_b128 a[104:107], v6 offset:10240
v_mfma_f32_16x16x32_bf16 v[140:143], a[120:123], a[16:19], v[140:143]
ds_read_b128 a[108:111], v6 offset:11264
v_mfma_f32_16x16x32_bf16 v[156:159], a[120:123], a[20:23], v[156:159]
v_mfma_f32_16x16x32_bf16 v[160:163], a[124:127], a[20:23], v[160:163]
buffer_load_dwordx4 a[12:15], v4, s[40:43], s35 offen offset:1024 sc1
s_xor_b32 s35, s77, 577536
v_mfma_f32_16x16x32_bf16 v[144:147], a[124:127], a[16:19], v[144:147]
s_waitcnt vmcnt(10) lgkmcnt(4)
v_mfma_f32_16x16x32_bf16 v[132:135], a[128:131], a[24:27], v[132:135]
ds_read_b128 a[112:115], v6 offset:12288
v_mfma_f32_16x16x32_bf16 v[148:151], a[128:131], a[28:31], v[148:151]
ds_read_b128 a[116:119], v6 offset:13312
v_mfma_f32_16x16x32_bf16 v[152:155], a[132:135], a[28:31], v[152:155]
buffer_load_dwordx4 a[16:19], v4, s[40:43], s35 offen offset:0 sc1
v_mfma_f32_16x16x32_bf16 v[136:139], a[132:135], a[24:27], v[136:139]
ds_read_b128 a[120:123], v6 offset:14336
v_mfma_f32_16x16x32_bf16 v[140:143], a[136:139], a[24:27], v[140:143]
ds_read_b128 a[124:127], v6 offset:15360
v_mfma_f32_16x16x32_bf16 v[156:159], a[136:139], a[28:31], v[156:159]
v_mfma_f32_16x16x32_bf16 v[160:163], a[140:143], a[28:31], v[160:163]
buffer_load_dwordx4 a[20:23], v4, s[40:43], s35 offen offset:1024 sc1
s_xor_b32 s35, s77, 589824
v_mfma_f32_16x16x32_bf16 v[144:147], a[140:143], a[24:27], v[144:147]
s_waitcnt vmcnt(10) lgkmcnt(4)
v_mfma_f32_16x16x32_bf16 v[132:135], a[96:99], a[32:35], v[132:135]
ds_read_b128 a[128:131], v6 offset:16384
v_mfma_f32_16x16x32_bf16 v[148:151], a[96:99], a[36:39], v[148:151]
ds_read_b128 a[132:135], v6 offset:17408
v_mfma_f32_16x16x32_bf16 v[152:155], a[100:103], a[36:39], v[152:155]
buffer_load_dwordx4 a[24:27], v4, s[40:43], s35 offen offset:0 sc1
v_mfma_f32_16x16x32_bf16 v[136:139], a[100:103], a[32:35], v[136:139]
ds_read_b128 a[136:139], v6 offset:18432
v_mfma_f32_16x16x32_bf16 v[140:143], a[104:107], a[32:35], v[140:143]
ds_read_b128 a[140:143], v6 offset:19456
v_mfma_f32_16x16x32_bf16 v[156:159], a[104:107], a[36:39], v[156:159]
v_mfma_f32_16x16x32_bf16 v[160:163], a[108:111], a[36:39], v[160:163]
buffer_load_dwordx4 a[28:31], v4, s[40:43], s35 offen offset:1024 sc1
s_xor_b32 s35, s77, 593920
v_mfma_f32_16x16x32_bf16 v[144:147], a[108:111], a[32:35], v[144:147]
s_waitcnt vmcnt(10) lgkmcnt(4)
v_mfma_f32_16x16x32_bf16 v[132:135], a[112:115], a[40:43], v[132:135]
ds_read_b128 a[96:99], v6 offset:20480
v_mfma_f32_16x16x32_bf16 v[148:151], a[112:115], a[44:47], v[148:151]
ds_read_b128 a[100:103], v6 offset:21504
v_mfma_f32_16x16x32_bf16 v[152:155], a[116:119], a[44:47], v[152:155]
buffer_load_dwordx4 a[32:35], v4, s[40:43], s35 offen offset:0 sc1
v_mfma_f32_16x16x32_bf16 v[136:139], a[116:119], a[40:43], v[136:139]
ds_read_b128 a[104:107], v6 offset:22528
v_mfma_f32_16x16x32_bf16 v[140:143], a[120:123], a[40:43], v[140:143]
ds_read_b128 a[108:111], v6 offset:23552
v_mfma_f32_16x16x32_bf16 v[156:159], a[120:123], a[44:47], v[156:159]
v_mfma_f32_16x16x32_bf16 v[160:163], a[124:127], a[44:47], v[160:163]
buffer_load_dwordx4 a[36:39], v4, s[40:43], s35 offen offset:1024 sc1
s_xor_b32 s35, s77, 606208
v_mfma_f32_16x16x32_bf16 v[144:147], a[124:127], a[40:43], v[144:147]
s_waitcnt vmcnt(10) lgkmcnt(4)
v_mfma_f32_16x16x32_bf16 v[132:135], a[128:131], a[48:51], v[132:135]
ds_read_b128 a[112:115], v6 offset:24576
v_mfma_f32_16x16x32_bf16 v[148:151], a[128:131], a[52:55], v[148:151]
ds_read_b128 a[116:119], v6 offset:25600
v_mfma_f32_16x16x32_bf16 v[152:155], a[132:135], a[52:55], v[152:155]
buffer_load_dwordx4 a[40:43], v4, s[40:43], s35 offen offset:0 sc1
v_mfma_f32_16x16x32_bf16 v[136:139], a[132:135], a[48:51], v[136:139]
ds_read_b128 a[120:123], v6 offset:26624
v_mfma_f32_16x16x32_bf16 v[140:143], a[136:139], a[48:51], v[140:143]
s_add_u32 s88, s67, 0xe0000
s_add_u32 s89, s66, 0xd0000
v_mfma_f32_16x16x32_bf16 v[156:159], a[136:139], a[52:55], v[156:159]
buffer_load_dword v11, v255, s[4:7], s88 offen sc1
v_mfma_f32_16x16x32_bf16 v[160:163], a[140:143], a[52:55], v[160:163]
buffer_load_dwordx4 a[44:47], v4, s[40:43], s35 offen offset:1024 sc1
s_xor_b32 s35, s77, 610304
v_mfma_f32_16x16x32_bf16 v[144:147], a[140:143], a[48:51], v[144:147]
ds_read_b128 a[124:127], v6 offset:27648
s_waitcnt vmcnt(11) lgkmcnt(4)
v_mfma_f32_16x16x32_bf16 v[132:135], a[96:99], a[0:3], v[132:135]
buffer_load_dword v232, v255, s[4:7], s89 offen offset:64 sc1
v_mfma_f32_16x16x32_bf16 v[148:151], a[96:99], a[4:7], v[148:151]
ds_read_b128 a[128:131], v6 offset:28672
v_mfma_f32_16x16x32_bf16 v[152:155], a[100:103], a[4:7], v[152:155]
buffer_load_dwordx4 a[48:51], v4, s[40:43], s35 offen offset:0 sc1
v_mfma_f32_16x16x32_bf16 v[136:139], a[100:103], a[0:3], v[136:139]
ds_read_b128 a[132:135], v6 offset:29696
v_mfma_f32_16x16x32_bf16 v[140:143], a[104:107], a[0:3], v[140:143]
ds_read_b128 a[136:139], v6 offset:30720
v_mfma_f32_16x16x32_bf16 v[156:159], a[104:107], a[4:7], v[156:159]
ds_read_b128 a[140:143], v6 offset:31744
v_mfma_f32_16x16x32_bf16 v[160:163], a[108:111], a[4:7], v[160:163]
buffer_load_dwordx4 a[52:55], v4, s[40:43], s35 offen offset:1024 sc1
s_xor_b32 s35, s77, 622592
v_mfma_f32_16x16x32_bf16 v[144:147], a[108:111], a[0:3], v[144:147]
s_waitcnt vmcnt(12) lgkmcnt(4)
v_mfma_f32_16x16x32_bf16 v[132:135], a[112:115], a[8:11], v[132:135]
ds_read_b128 a[96:99], v6 offset:32768
v_mfma_f32_16x16x32_bf16 v[148:151], a[112:115], a[12:15], v[148:151]
ds_read_b128 a[100:103], v6 offset:33792
v_mfma_f32_16x16x32_bf16 v[152:155], a[116:119], a[12:15], v[152:155]
buffer_load_dwordx4 a[0:3], v4, s[40:43], s35 offen offset:0 sc1
v_mfma_f32_16x16x32_bf16 v[136:139], a[116:119], a[8:11], v[136:139]
ds_read_b128 a[104:107], v6 offset:34816
v_mfma_f32_16x16x32_bf16 v[140:143], a[120:123], a[8:11], v[140:143]
ds_read_b128 a[108:111], v6 offset:35840
v_mfma_f32_16x16x32_bf16 v[156:159], a[120:123], a[12:15], v[156:159]
v_mfma_f32_16x16x32_bf16 v[160:163], a[124:127], a[12:15], v[160:163]
buffer_load_dwordx4 a[4:7], v4, s[40:43], s35 offen offset:1024 sc1
s_xor_b32 s35, s77, 626688
v_mfma_f32_16x16x32_bf16 v[144:147], a[124:127], a[8:11], v[144:147]
s_waitcnt vmcnt(12) lgkmcnt(4)
v_mfma_f32_16x16x32_bf16 v[132:135], a[128:131], a[16:19], v[132:135]
ds_read_b128 a[112:115], v6 offset:36864
v_mfma_f32_16x16x32_bf16 v[148:151], a[128:131], a[20:23], v[148:151]
ds_read_b128 a[116:119], v6 offset:37888
v_mfma_f32_16x16x32_bf16 v[152:155], a[132:135], a[20:23], v[152:155]
buffer_load_dwordx4 a[8:11], v4, s[40:43], s35 offen offset:0 sc1
v_mfma_f32_16x16x32_bf16 v[136:139], a[132:135], a[16:19], v[136:139]
ds_read_b128 a[120:123], v6 offset:38912
v_mfma_f32_16x16x32_bf16 v[140:143], a[136:139], a[16:19], v[140:143]
ds_read_b128 a[124:127], v6 offset:39936
v_mfma_f32_16x16x32_bf16 v[156:159], a[136:139], a[20:23], v[156:159]
v_mfma_f32_16x16x32_bf16 v[160:163], a[140:143], a[20:23], v[160:163]
buffer_load_dwordx4 a[12:15], v4, s[40:43], s35 offen offset:1024 sc1
s_xor_b32 s35, s77, 638976
v_mfma_f32_16x16x32_bf16 v[144:147], a[140:143], a[16:19], v[144:147]
s_waitcnt vmcnt(12) lgkmcnt(4)
v_mfma_f32_16x16x32_bf16 v[132:135], a[96:99], a[24:27], v[132:135]
ds_read_b128 a[128:131], v6 offset:40960
v_mfma_f32_16x16x32_bf16 v[148:151], a[96:99], a[28:31], v[148:151]
ds_read_b128 a[132:135], v6 offset:41984
v_mfma_f32_16x16x32_bf16 v[152:155], a[100:103], a[28:31], v[152:155]
buffer_load_dwordx4 a[16:19], v4, s[40:43], s35 offen offset:0 sc1
v_mfma_f32_16x16x32_bf16 v[136:139], a[100:103], a[24:27], v[136:139]
ds_read_b128 a[136:139], v6 offset:43008
v_mfma_f32_16x16x32_bf16 v[140:143], a[104:107], a[24:27], v[140:143]
ds_read_b128 a[140:143], v6 offset:44032
v_mfma_f32_16x16x32_bf16 v[156:159], a[104:107], a[28:31], v[156:159]
v_mfma_f32_16x16x32_bf16 v[160:163], a[108:111], a[28:31], v[160:163]
buffer_load_dwordx4 a[20:23], v4, s[40:43], s35 offen offset:1024 sc1
s_xor_b32 s35, s77, 643072
v_mfma_f32_16x16x32_bf16 v[144:147], a[108:111], a[24:27], v[144:147]
s_waitcnt vmcnt(12) lgkmcnt(4)
v_mfma_f32_16x16x32_bf16 v[132:135], a[112:115], a[32:35], v[132:135]
ds_read_b128 a[96:99], v6 offset:45056
v_mfma_f32_16x16x32_bf16 v[148:151], a[112:115], a[36:39], v[148:151]
ds_read_b128 a[100:103], v6 offset:46080
v_mfma_f32_16x16x32_bf16 v[152:155], a[116:119], a[36:39], v[152:155]
buffer_load_dwordx4 a[24:27], v4, s[40:43], s35 offen offset:0 sc1
v_mfma_f32_16x16x32_bf16 v[136:139], a[116:119], a[32:35], v[136:139]
ds_read_b128 a[104:107], v6 offset:47104
v_mfma_f32_16x16x32_bf16 v[140:143], a[120:123], a[32:35], v[140:143]
ds_read_b128 a[108:111], v6 offset:48128
v_mfma_f32_16x16x32_bf16 v[156:159], a[120:123], a[36:39], v[156:159]
v_mfma_f32_16x16x32_bf16 v[160:163], a[124:127], a[36:39], v[160:163]
buffer_load_dwordx4 a[28:31], v4, s[40:43], s35 offen offset:1024 sc1
s_xor_b32 s35, s77, 0
v_mfma_f32_16x16x32_bf16 v[144:147], a[124:127], a[32:35], v[144:147]
s_waitcnt vmcnt(11) lgkmcnt(4)
v_cmp_ne_u32 vcc, v11, v15
s_cbranch_vccnz Ltr_13
Lte_15:
v_mfma_f32_16x16x32_bf16 v[132:135], a[128:131], a[40:43], v[132:135]
s_add_u32 m0, s18, 0x0
s_add_u32 s44, s50, 0x2800000
v_mfma_f32_16x16x32_bf16 v[148:151], a[128:131], a[44:47], v[148:151]
ds_read_b128 a[112:115], v6 offset:49152
v_mfma_f32_16x16x32_bf16 v[152:155], a[132:135], a[44:47], v[152:155]
buffer_load_dwordx4 v1, s[4:7], s44 offen offset:0 sc1 lds
v_mfma_f32_16x16x32_bf16 v[136:139], a[132:135], a[40:43], v[136:139]
ds_read_b128 a[116:119], v6 offset:50176
v_mfma_f32_16x16x32_bf16 v[140:143], a[136:139], a[40:43], v[140:143]
ds_read_b128 a[120:123], v6 offset:51200
v_mfma_f32_16x16x32_bf16 v[156:159], a[136:139], a[44:47], v[156:159]
ds_read_b128 a[124:127], v6 offset:52224
v_mfma_f32_16x16x32_bf16 v[160:163], a[140:143], a[44:47], v[160:163]
buffer_load_dwordx4 v1, s[4:7], s44 offen offset:1024 sc1 lds
s_add_u32 m0, s18, 0x2000
v_mfma_f32_16x16x32_bf16 v[144:147], a[140:143], a[40:43], v[144:147]
s_add_u32 s44, s50, 0x2802000
s_waitcnt vmcnt(10) lgkmcnt(4)
v_mfma_f32_16x16x32_bf16 v[132:135], a[96:99], a[48:51], v[132:135]
ds_read_b128 a[128:131], v6 offset:53248
v_mfma_f32_16x16x32_bf16 v[148:151], a[96:99], a[52:55], v[148:151]
ds_read_b128 a[132:135], v6 offset:54272
v_mfma_f32_16x16x32_bf16 v[152:155], a[100:103], a[52:55], v[152:155]
buffer_load_dwordx4 v1, s[4:7], s44 offen offset:0 sc1 lds
v_mfma_f32_16x16x32_bf16 v[136:139], a[100:103], a[48:51], v[136:139]
ds_read_b128 a[136:139], v6 offset:55296
v_mfma_f32_16x16x32_bf16 v[140:143], a[104:107], a[48:51], v[140:143]
ds_read_b128 a[140:143], v6 offset:56320
v_mfma_f32_16x16x32_bf16 v[156:159], a[104:107], a[52:55], v[156:159]
v_mfma_f32_16x16x32_bf16 v[160:163], a[108:111], a[52:55], v[160:163]
buffer_load_dwordx4 v1, s[4:7], s44 offen offset:1024 sc1 lds
s_add_u32 m0, s18, 0x4000
v_mfma_f32_16x16x32_bf16 v[144:147], a[108:111], a[48:51], v[144:147]
s_add_u32 s44, s50, 0x2804000
s_waitcnt vmcnt(10) lgkmcnt(4)
v_mfma_f32_16x16x32_bf16 v[132:135], a[112:115], a[0:3], v[132:135]
ds_read_b128 a[96:99], v6 offset:57344
v_mfma_f32_16x16x32_bf16 v[148:151], a[112:115], a[4:7], v[148:151]
ds_read_b128 a[100:103], v6 offset:58368
v_mfma_f32_16x16x32_bf16 v[152:155], a[116:119], a[4:7], v[152:155]
ds_read_b128 a[104:107], v6 offset:59392
v_mfma_f32_16x16x32_bf16 v[136:139], a[116:119], a[0:3], v[136:139]
buffer_load_dwordx4 v1, s[4:7], s44 offen offset:0 sc1 lds
v_mfma_f32_16x16x32_bf16 v[140:143], a[120:123], a[0:3], v[140:143]
ds_read_b128 a[108:111], v6 offset:60416
v_mfma_f32_16x16x32_bf16 v[156:159], a[120:123], a[4:7], v[156:159]
v_mfma_f32_16x16x32_bf16 v[160:163], a[124:127], a[4:7], v[160:163]
v_mfma_f32_16x16x32_bf16 v[144:147], a[124:127], a[0:3], v[144:147]
buffer_load_dwordx4 v1, s[4:7], s44 offen offset:1024 sc1 lds
s_waitcnt vmcnt(10) lgkmcnt(4)
v_mfma_f32_16x16x32_bf16 v[132:135], a[128:131], a[8:11], v[132:135]
s_add_u32 m0, s18, 0x6000
s_add_u32 s44, s50, 0x2806000
v_mfma_f32_16x16x32_bf16 v[148:151], a[128:131], a[12:15], v[148:151]
ds_read_b128 a[112:115], v6 offset:61440
v_mfma_f32_16x16x32_bf16 v[152:155], a[132:135], a[12:15], v[152:155]
ds_read_b128 a[116:119], v6 offset:62464
v_mfma_f32_16x16x32_bf16 v[136:139], a[132:135], a[8:11], v[136:139]
ds_read_b128 a[120:123], v6 offset:63488
v_mfma_f32_16x16x32_bf16 v[140:143], a[136:139], a[8:11], v[140:143]
buffer_load_dwordx4 v1, s[4:7], s44 offen offset:0 sc1 lds
v_mfma_f32_16x16x32_bf16 v[156:159], a[136:139], a[12:15], v[156:159]
ds_read_b128 a[124:127], v6 offset:64512
v_mfma_f32_16x16x32_bf16 v[160:163], a[140:143], a[12:15], v[160:163]
v_mfma_f32_16x16x32_bf16 v[144:147], a[140:143], a[8:11], v[144:147]
s_waitcnt vmcnt(9) lgkmcnt(4)
v_mfma_f32_16x16x32_bf16 v[132:135], a[96:99], a[16:19], v[132:135]
v_mfma_f32_16x16x32_bf16 v[148:151], a[96:99], a[20:23], v[148:151]
buffer_load_dwordx4 v1, s[4:7], s44 offen offset:1024 sc1 lds
v_mfma_f32_16x16x32_bf16 v[152:155], a[100:103], a[20:23], v[152:155]
v_mfma_f32_16x16x32_bf16 v[136:139], a[100:103], a[16:19], v[136:139]
v_mfma_f32_16x16x32_bf16 v[140:143], a[104:107], a[16:19], v[140:143]
v_mfma_f32_16x16x32_bf16 v[156:159], a[104:107], a[20:23], v[156:159]
v_mfma_f32_16x16x32_bf16 v[160:163], a[108:111], a[20:23], v[160:163]
v_mfma_f32_16x16x32_bf16 v[144:147], a[108:111], a[16:19], v[144:147]
s_waitcnt vmcnt(8) lgkmcnt(0)
v_mfma_f32_16x16x32_bf16 v[132:135], a[112:115], a[24:27], v[132:135]
v_mfma_f32_16x16x32_bf16 v[148:151], a[112:115], a[28:31], v[148:151]
v_mfma_f32_16x16x32_bf16 v[152:155], a[116:119], a[28:31], v[152:155]
v_mfma_f32_16x16x32_bf16 v[136:139], a[116:119], a[24:27], v[136:139]
v_mfma_f32_16x16x32_bf16 v[140:143], a[120:123], a[24:27], v[140:143]
v_mfma_f32_16x16x32_bf16 v[156:159], a[120:123], a[28:31], v[156:159]
v_mfma_f32_16x16x32_bf16 v[160:163], a[124:127], a[28:31], v[160:163]
v_mfma_f32_16x16x32_bf16 v[144:147], a[124:127], a[24:27], v[144:147]
s_nop 0
v_cvt_pk_bf16_f32 v32, v132, v133
v_cvt_pk_bf16_f32 v33, v134, v135
s_nop 0
v_cvt_pk_bf16_f32 v34, v136, v137
v_cvt_pk_bf16_f32 v35, v138, v139
s_add_u32 s36, s69, 0x400000
buffer_store_dwordx4 v[32:35], v4, s[4:7], s36 offen offset:0 sc1
v_cvt_pk_bf16_f32 v40, v148, v149
v_cvt_pk_bf16_f32 v41, v150, v151
v_cvt_pk_bf16_f32 v42, v152, v153
v_cvt_pk_bf16_f32 v43, v154, v155
v_cvt_pk_bf16_f32 v36, v140, v141
v_cvt_pk_bf16_f32 v37, v142, v143
v_cvt_pk_bf16_f32 v38, v144, v145
v_cvt_pk_bf16_f32 v39, v146, v147
s_add_u32 s37, s36, 4096
v_cvt_pk_bf16_f32 v44, v156, v157
v_cvt_pk_bf16_f32 v45, v158, v159
v_cvt_pk_bf16_f32 v46, v160, v161
buffer_store_dwordx4 v[40:43], v4, s[4:7], s36 offen offset:1024 sc1
v_cvt_pk_bf16_f32 v47, v162, v163
v_mfma_f32_16x16x32_bf16 v[96:99], v[32:35], v[32:35], 0
s_mov_b32 s38, 0x300000
s_add_u32 s92, s78, 0x40000
v_mfma_f32_16x16x32_bf16 v[92:95], v[16:19], v[32:35], 0
s_add_u32 s40, s4, 0x400000
s_addc_u32 s41, s5, 0
v_mfma_f32_16x16x32_bf16 v[96:99], v[36:39], v[36:39], v[96:99]
buffer_store_dwordx4 v[36:39], v4, s[4:7], s37 offen offset:0 sc1
v_mfma_f32_16x16x32_bf16 v[92:95], v[16:19], v[36:39], v[92:95]
s_nop 5
v_cndmask_b32 v96, v96, v97, s[46:47]
v_cndmask_b32 v98, v98, v99, s[46:47]
v_mfma_f32_16x16x32_bf16 v[104:107], v[40:43], v[40:43], 0
v_mfma_f32_16x16x32_bf16 v[100:103], v[16:19], v[40:43], 0
v_cndmask_b32 v93, v96, v98, s[48:49]
buffer_store_dwordx4 v[44:47], v4, s[4:7], s37 offen offset:1024 sc1
v_mfma_f32_16x16x32_bf16 v[104:107], v[44:47], v[44:47], v[104:107]
v_mfma_f32_16x16x32_bf16 v[100:103], v[16:19], v[44:47], v[100:103]
s_nop 6
v_cndmask_b32 v104, v104, v105, s[46:47]
v_cndmask_b32 v106, v106, v107, s[46:47]
L_stub4:
s_cbranch_execz L_wret1
buffer_store_dwordx2 v[92:93], v253, s[4:7], s38 offen offset:0 sc1
v_cndmask_b32 v101, v104, v106, s[48:49]
buffer_store_dwordx2 v[100:101], v253, s[4:7], s38 offen offset:2048 sc1
v_cmp_ne_u32 vcc, v232, v15
s_cbranch_vccnz Ltr_16
Lte_18:
s_barrier
s_add_u32 m0, s18, 0x8000
s_add_u32 s44, s50, 0x2808000
buffer_load_dwordx4 v1, s[4:7], s44 offen offset:0 sc1 lds
buffer_load_dwordx4 v1, s[4:7], s44 offen offset:1024 sc1 lds
s_add_u32 m0, s18, 0xa000
s_add_u32 s44, s50, 0x280a000
buffer_load_dwordx4 v1, s[4:7], s44 offen offset:0 sc1 lds
buffer_load_dwordx4 v1, s[4:7], s44 offen offset:1024 sc1 lds
s_waitcnt vmcnt(4)
s_barrier
s_cmp_lg_u32 s28, 0
s_cbranch_scc1 Lsg_19
buffer_atomic_add v12, v10, s[4:7], s92 offen sc1
Lsg_19:
s_mov_b64 exec, 0
s_cmp_eq_u32 s28, 0
s_cbranch_scc1 L_stub5
L_wret2:
s_mov_b64 exec, -1
s_cmp_lt_u32 s28, 2
s_cbranch_scc1 Lwd_20
s_add_u32 m0, s19, 0xa000
s_add_u32 s44, s50, 0x280a000
s_add_u32 s44, s44, s18
buffer_load_dwordx4 v1, s[4:7], s44 offen offset:0 sc1 lds
buffer_load_dwordx4 v1, s[4:7], s44 offen offset:1024 sc1 lds
buffer_load_dwordx4 v1, s[4:7], s44 offen offset:2048 sc1 lds
buffer_load_dwordx4 v1, s[4:7], s44 offen offset:3072 sc1 lds
s_add_u32 m0, s19, 0xc000
s_add_u32 s44, s50, 0x280c000
s_add_u32 s44, s44, s18
buffer_load_dwordx4 v1, s[4:7], s44 offen offset:0 sc1 lds
buffer_load_dwordx4 v1, s[4:7], s44 offen offset:1024 sc1 lds
buffer_load_dwordx4 v1, s[4:7], s44 offen offset:2048 sc1 lds
buffer_load_dwordx4 v1, s[4:7], s44 offen offset:3072 sc1 lds
s_add_u32 m0, s19, 0xe000
s_add_u32 s44, s50, 0x280e000
s_add_u32 s44, s44, s18
buffer_load_dwordx4 v1, s[4:7], s44 offen offset:0 sc1 lds
buffer_load_dwordx4 v1, s[4:7], s44 offen offset:1024 sc1 lds
buffer_load_dwordx4 v1, s[4:7], s44 offen offset:2048 sc1 lds
buffer_load_dwordx4 v1, s[4:7], s44 offen offset:3072 sc1 lds
s_add_u32 m0, s19, 0x10000
s_add_u32 s44, s50, 0x2810000
s_add_u32 s44, s44, s18
buffer_load_dwordx4 v1, s[4:7], s44 offen offset:0 sc1 lds
buffer_load_dwordx4 v1, s[4:7], s44 offen offset:1024 sc1 lds
buffer_load_dwordx4 v1, s[4:7], s44 offen offset:2048 sc1 lds
buffer_load_dwordx4 v1, s[4:7], s44 offen offset:3072 sc1 lds
s_add_u32 m0, s19, 0x12000
s_add_u32 s44, s50, 0x2812000
s_add_u32 s44, s44, s18
buffer_load_dwordx4 v1, s[4:7], s44 offen offset:0 sc1 lds
buffer_load_dwordx4 v1, s[4:7], s44 offen offset:1024 sc1 lds
buffer_load_dwordx4 v1, s[4:7], s44 offen offset:2048 sc1 lds
buffer_load_dwordx4 v1, s[4:7], s44 offen offset:3072 sc1 lds
s_add_u32 m0, s19, 0x14000
s_add_u32 s44, s50, 0x2814000
s_add_u32 s44, s44, s18
buffer_load_dwordx4 v1, s[4:7], s44 offen offset:0 sc1 lds
buffer_load_dwordx4 v1, s[4:7], s44 offen offset:1024 sc1 lds
buffer_load_dwordx4 v1, s[4:7], s44 offen offset:2048 sc1 lds
buffer_load_dwordx4 v1, s[4:7], s44 offen offset:3072 sc1 lds
s_add_u32 m0, s19, 0x16000
s_add_u32 s44, s50, 0x2816000
s_add_u32 s44, s44, s18
buffer_load_dwordx4 v1, s[4:7], s44 offen offset:0 sc1 lds
buffer_load_dwordx4 v1, s[4:7], s44 offen offset:1024 sc1 lds
buffer_load_dwordx4 v1, s[4:7], s44 offen offset:2048 sc1 lds
buffer_load_dwordx4 v1, s[4:7], s44 offen offset:3072 sc1 lds
s_add_u32 m0, s19, 0x18000
s_add_u32 s44, s50, 0x2818000
s_add_u32 s44, s44, s18
buffer_load_dwordx4 v1, s[4:7], s44 offen offset:0 sc1 lds
buffer_load_dwordx4 v1, s[4:7], s44 offen offset:1024 sc1 lds
buffer_load_dwordx4 v1, s[4:7], s44 offen offset:2048 sc1 lds
buffer_load_dwordx4 v1, s[4:7], s44 offen offset:3072 sc1 lds
Lwd_20:
s_cmp_lg_u32 s28, 1
s_cbranch_scc1 Lpo_23
s_add_u32 s36, s34, 0x40000
s_mov_b32 s37, 0
v_mov_b32 v11, 0
buffer_atomic_add v11, v251, s[4:7], s36 offen sc0 sc1
s_sleep 4
Lpoll_21:
v_mov_b32 v234, 0
buffer_atomic_add v234, v251, s[4:7], s36 offen sc0 sc1
s_waitcnt vmcnt(1)
v_readfirstlane_b32 s38, v11
s_nop 0
s_cmp_ge_u32 s38, 32
s_cbranch_scc1 Lpe_22
v_mov_b32 v11, 0
buffer_atomic_add v11, v251, s[4:7], s36 offen sc0 sc1
s_waitcnt vmcnt(1)
v_readfirstlane_b32 s38, v234
s_nop 0
s_cmp_ge_u32 s38, 32
s_cbranch_scc1 Lpe_22
s_add_u32 s37, s37, 1
s_cmp_lt_u32 s37, 0x80000
s_cbranch_scc1 Lpoll_21
s_waitcnt vmcnt(0)
Lpo_23:
s_waitcnt vmcnt(32) lgkmcnt(0)
s_cmp_ge_u32 s28, 2
s_cbranch_scc1 Lw_24
s_waitcnt vmcnt(0)
Lw_24:
Lpe_22:
s_barrier
s_mov_b32 s35, s68
s_add_u32 s33, s35, 0x1000
buffer_load_dwordx4 a[0:3], v2, s[40:43], s35 offen offset:0 sc1
buffer_load_dwordx4 a[4:7], v2, s[40:43], s33 offen offset:0 sc1
buffer_load_dwordx4 a[8:11], v2, s[40:43], s35 offen offset:1024 sc1
buffer_load_dwordx4 a[12:15], v2, s[40:43], s33 offen offset:1024 sc1
buffer_load_dwordx4 a[16:19], v2, s[40:43], s35 offen offset:2048 sc1
buffer_load_dwordx4 a[20:23], v2, s[40:43], s33 offen offset:2048 sc1
buffer_load_dwordx4 a[24:27], v2, s[40:43], s35 offen offset:3072 sc1
buffer_load_dwordx4 a[28:31], v2, s[40:43], s33 offen offset:3072 sc1
s_add_u32 s35, s35, 0x4000
s_add_u32 s33, s33, 0x4000
buffer_load_dwordx4 a[32:35], v2, s[40:43], s35 offen offset:0 sc1
buffer_load_dwordx4 a[36:39], v2, s[40:43], s33 offen offset:0 sc1
buffer_load_dwordx4 a[40:43], v2, s[40:43], s35 offen offset:1024 sc1
buffer_load_dwordx4 a[44:47], v2, s[40:43], s33 offen offset:1024 sc1
buffer_load_dwordx4 a[48:51], v2, s[40:43], s35 offen offset:2048 sc1
buffer_load_dwordx4 a[52:55], v2, s[40:43], s33 offen offset:2048 sc1
buffer_load_dwordx4 a[56:59], v2, s[40:43], s35 offen offset:3072 sc1
buffer_load_dwordx4 a[60:63], v2, s[40:43], s33 offen offset:3072 sc1
s_add_u32 s35, s35, 0x4000
s_add_u32 s33, s33, 0x4000
v_add_u32 v5, 0, v1
ds_read_b128 a[96:99], v5 offset:2048
ds_read_b128 a[100:103], v5 offset:8192
ds_read_b128 a[104:107], v5 offset:3072
ds_read_b128 a[108:111], v5 offset:9216
ds_read_b128 a[112:115], v5 offset:4096
ds_read_b128 a[116:119], v5 offset:10240
s_waitcnt vmcnt(14) lgkmcnt(4)
v_mfma_f32_16x16x32_bf16 v[140:143], a[96:99], a[0:3], 0
v_and_b32 v232, 15, v0
v_lshlrev_b32 v232, 7, v232
v_mfma_f32_16x16x32_bf16 v[140:143], a[100:103], a[4:7], v[140:143]
buffer_load_dwordx4 a[64:67], v2, s[40:43], s35 offen offset:0 sc1
s_waitcnt vmcnt(13)
v_mfma_f32_16x16x32_bf16 v[164:167], a[100:103], a[12:15], 0
v_lshrrev_b32 v233, 4, v0
v_lshlrev_b32 v233, 4, v233
v_mfma_f32_16x16x32_bf16 v[164:167], a[96:99], a[8:11], v[164:167]
v_add_u32 v232, v233, v232
s_mul_i32 s38, s30, 12288
s_waitcnt vmcnt(12)
v_mfma_f32_16x16x32_bf16 v[188:191], a[96:99], a[16:19], 0
s_add_u32 s38, s38, 0x1880000
s_add_u32 s39, s28, 4
s_min_u32 s39, s39, 5
s_waitcnt vmcnt(11)
v_mfma_f32_16x16x32_bf16 v[188:191], a[100:103], a[20:23], v[188:191]
buffer_load_dwordx4 a[68:71], v2, s[40:43], s33 offen offset:0 sc1
s_lshl_b32 s36, s28, 11
s_waitcnt vmcnt(10)
v_mfma_f32_16x16x32_bf16 v[212:215], a[100:103], a[28:31], 0
s_add_u32 s36, s36, s38
s_lshl_b32 s37, s39, 11
s_add_u32 s37, s37, s38
v_mfma_f32_16x16x32_bf16 v[212:215], a[96:99], a[24:27], v[212:215]
ds_read_b128 a[128:131], v5 offset:5120
s_waitcnt lgkmcnt(4)
v_mfma_f32_16x16x32_bf16 v[216:219], a[104:107], a[24:27], 0
ds_read_b128 a[132:135], v5 offset:11264
s_waitcnt lgkmcnt(4)
v_mfma_f32_16x16x32_bf16 v[216:219], a[108:111], a[28:31], v[216:219]
ds_read_b128 a[136:139], v5 offset:0
v_mfma_f32_16x16x32_bf16 v[192:195], a[108:111], a[20:23], 0
buffer_load_dwordx4 v[48:51], v232, s[4:7], s36 offen sc1
v_mfma_f32_16x16x32_bf16 v[192:195], a[104:107], a[16:19], v[192:195]
ds_read_b128 a[140:143], v5 offset:6144
v_mfma_f32_16x16x32_bf16 v[168:171], a[104:107], a[8:11], 0
ds_read_b128 a[144:147], v5 offset:1024
v_mfma_f32_16x16x32_bf16 v[168:171], a[108:111], a[12:15], v[168:171]
ds_read_b128 a[148:151], v5 offset:7168
v_mfma_f32_16x16x32_bf16 v[144:147], a[108:111], a[4:7], 0
v_mfma_f32_16x16x32_bf16 v[144:147], a[104:107], a[0:3], v[144:147]
buffer_load_dwordx4 a[72:75], v2, s[40:43], s35 offen offset:1024 sc1
s_waitcnt lgkmcnt(7)
v_mfma_f32_16x16x32_bf16 v[148:151], a[112:115], a[0:3], 0
s_waitcnt lgkmcnt(6)
v_mfma_f32_16x16x32_bf16 v[148:151], a[116:119], a[4:7], v[148:151]
v_mfma_f32_16x16x32_bf16 v[172:175], a[116:119], a[12:15], 0
v_mfma_f32_16x16x32_bf16 v[172:175], a[112:115], a[8:11], v[172:175]
v_mfma_f32_16x16x32_bf16 v[196:199], a[112:115], a[16:19], 0
buffer_load_dwordx4 a[76:79], v2, s[40:43], s33 offen offset:1024 sc1
v_mfma_f32_16x16x32_bf16 v[196:199], a[116:119], a[20:23], v[196:199]
v_mfma_f32_16x16x32_bf16 v[220:223], a[116:119], a[28:31], 0
v_mfma_f32_16x16x32_bf16 v[220:223], a[112:115], a[24:27], v[220:223]
s_waitcnt lgkmcnt(0)
v_mfma_f32_16x16x32_bf16 v[224:227], a[128:131], a[24:27], 0
ds_read_b128 a[96:99], v5 offset:14336
v_mfma_f32_16x16x32_bf16 v[224:227], a[132:135], a[28:31], v[224:227]
buffer_load_dwordx4 a[80:83], v2, s[40:43], s35 offen offset:2048 sc1
v_mfma_f32_16x16x32_bf16 v[200:203], a[132:135], a[20:23], 0
ds_read_b128 a[100:103], v5 offset:20480
v_mfma_f32_16x16x32_bf16 v[200:203], a[128:131], a[16:19], v[200:203]
v_mfma_f32_16x16x32_bf16 v[176:179], a[128:131], a[8:11], 0
v_mfma_f32_16x16x32_bf16 v[176:179], a[132:135], a[12:15], v[176:179]
buffer_load_dwordx4 a[84:87], v2, s[40:43], s33 offen offset:2048 sc1
v_mfma_f32_16x16x32_bf16 v[152:155], a[132:135], a[4:7], 0
ds_read_b128 a[104:107], v5 offset:15360
v_mfma_f32_16x16x32_bf16 v[152:155], a[128:131], a[0:3], v[152:155]
v_mfma_f32_16x16x32_bf16 v[132:135], a[136:139], a[0:3], 0
ds_read_b128 a[108:111], v5 offset:21504
v_mfma_f32_16x16x32_bf16 v[132:135], a[140:143], a[4:7], v[132:135]
v_mfma_f32_16x16x32_bf16 v[156:159], a[140:143], a[12:15], 0
buffer_load_dwordx4 v[52:55], v232, s[4:7], s37 offen sc1
s_add_u32 m0, s18, 0x1c000
v_mfma_f32_16x16x32_bf16 v[156:159], a[136:139], a[8:11], v[156:159]
s_add_u32 s44, s50, 0x281c000
ds_read_b128 a[112:115], v5 offset:16384
v_mfma_f32_16x16x32_bf16 v[180:183], a[136:139], a[16:19], 0
v_mfma_f32_16x16x32_bf16 v[180:183], a[140:143], a[20:23], v[180:183]
ds_read_b128 a[116:119], v5 offset:22528
v_mfma_f32_16x16x32_bf16 v[204:207], a[140:143], a[28:31], 0
v_mfma_f32_16x16x32_bf16 v[204:207], a[136:139], a[24:27], v[204:207]
buffer_load_dwordx4 a[88:91], v2, s[40:43], s35 offen offset:3072 sc1
v_mfma_f32_16x16x32_bf16 v[208:211], a[144:147], a[24:27], 0
v_mfma_f32_16x16x32_bf16 v[208:211], a[148:151], a[28:31], v[208:211]
v_mfma_f32_16x16x32_bf16 v[184:187], a[148:151], a[20:23], 0
v_mfma_f32_16x16x32_bf16 v[184:187], a[144:147], a[16:19], v[184:187]
v_mfma_f32_16x16x32_bf16 v[160:163], a[144:147], a[8:11], 0
buffer_load_dwordx4 a[92:95], v2, s[40:43], s33 offen offset:3072 sc1
s_add_u32 s35, s35, 0x4000
v_mfma_f32_16x16x32_bf16 v[160:163], a[148:151], a[12:15], v[160:163]
s_add_u32 s33, s33, 0x4000
v_mfma_f32_16x16x32_bf16 v[136:139], a[148:151], a[4:7], 0
v_mfma_f32_16x16x32_bf16 v[136:139], a[144:147], a[0:3], v[136:139]
s_waitcnt vmcnt(10) lgkmcnt(0)
v_mfma_f32_16x16x32_bf16 v[140:143], a[96:99], a[32:35], v[140:143]
ds_read_b128 a[128:131], v5 offset:17408
v_mfma_f32_16x16x32_bf16 v[140:143], a[100:103], a[36:39], v[140:143]
buffer_load_dwordx4 a[0:3], v2, s[40:43], s35 offen offset:0 sc1
v_mfma_f32_16x16x32_bf16 v[164:167], a[100:103], a[44:47], v[164:167]
ds_read_b128 a[132:135], v5 offset:23552
v_mfma_f32_16x16x32_bf16 v[164:167], a[96:99], a[40:43], v[164:167]
v_mfma_f32_16x16x32_bf16 v[188:191], a[96:99], a[48:51], v[188:191]
v_mfma_f32_16x16x32_bf16 v[188:191], a[100:103], a[52:55], v[188:191]
buffer_load_dwordx4 v1, s[4:7], s44 offen offset:0 sc1 lds
v_mfma_f32_16x16x32_bf16 v[212:215], a[100:103], a[60:63], v[212:215]
ds_read_b128 a[136:139], v5 offset:12288
v_mfma_f32_16x16x32_bf16 v[212:215], a[96:99], a[56:59], v[212:215]
v_mfma_f32_16x16x32_bf16 v[216:219], a[104:107], a[56:59], v[216:219]
ds_read_b128 a[140:143], v5 offset:18432
v_mfma_f32_16x16x32_bf16 v[216:219], a[108:111], a[60:63], v[216:219]
buffer_load_dwordx4 a[4:7], v2, s[40:43], s33 offen offset:0 sc1
v_mfma_f32_16x16x32_bf16 v[192:195], a[108:111], a[52:55], v[192:195]
ds_read_b128 a[144:147], v5 offset:13312
v_mfma_f32_16x16x32_bf16 v[192:195], a[104:107], a[48:51], v[192:195]
v_mfma_f32_16x16x32_bf16 v[168:171], a[104:107], a[40:43], v[168:171]
v_mfma_f32_16x16x32_bf16 v[168:171], a[108:111], a[44:47], v[168:171]
buffer_load_dwordx4 a[8:11], v2, s[40:43], s35 offen offset:1024 sc1
v_mfma_f32_16x16x32_bf16 v[144:147], a[108:111], a[36:39], v[144:147]
ds_read_b128 a[148:151], v5 offset:19456
v_mfma_f32_16x16x32_bf16 v[144:147], a[104:107], a[32:35], v[144:147]
v_mfma_f32_16x16x32_bf16 v[148:151], a[112:115], a[32:35], v[148:151]
v_mfma_f32_16x16x32_bf16 v[148:151], a[116:119], a[36:39], v[148:151]
buffer_load_dwordx4 v1, s[4:7], s44 offen offset:1024 sc1 lds
s_add_u32 m0, s18, 0x1e000
v_mfma_f32_16x16x32_bf16 v[172:175], a[116:119], a[44:47], v[172:175]
s_add_u32 s44, s50, 0x281e000
v_mfma_f32_16x16x32_bf16 v[172:175], a[112:115], a[40:43], v[172:175]
v_mfma_f32_16x16x32_bf16 v[196:199], a[112:115], a[48:51], v[196:199]
v_mfma_f32_16x16x32_bf16 v[196:199], a[116:119], a[52:55], v[196:199]
buffer_load_dwordx4 a[12:15], v2, s[40:43], s33 offen offset:1024 sc1
v_mfma_f32_16x16x32_bf16 v[220:223], a[116:119], a[60:63], v[220:223]
v_mfma_f32_16x16x32_bf16 v[220:223], a[112:115], a[56:59], v[220:223]
s_waitcnt lgkmcnt(0)
v_mfma_f32_16x16x32_bf16 v[224:227], a[128:131], a[56:59], v[224:227]
ds_read_b128 a[96:99], v5 offset:26624
v_mfma_f32_16x16x32_bf16 v[224:227], a[132:135], a[60:63], v[224:227]
buffer_load_dwordx4 a[16:19], v2, s[40:43], s35 offen offset:2048 sc1
v_mfma_f32_16x16x32_bf16 v[200:203], a[132:135], a[52:55], v[200:203]
ds_read_b128 a[100:103], v5 offset:32768
v_mfma_f32_16x16x32_bf16 v[200:203], a[128:131], a[48:51], v[200:203]
v_mfma_f32_16x16x32_bf16 v[176:179], a[128:131], a[40:43], v[176:179]
v_mfma_f32_16x16x32_bf16 v[176:179], a[132:135], a[44:47], v[176:179]
buffer_load_dwordx4 a[20:23], v2, s[40:43], s33 offen offset:2048 sc1
v_mfma_f32_16x16x32_bf16 v[152:155], a[132:135], a[36:39], v[152:155]
ds_read_b128 a[104:107], v5 offset:27648
v_mfma_f32_16x16x32_bf16 v[152:155], a[128:131], a[32:35], v[152:155]
v_mfma_f32_16x16x32_bf16 v[132:135], a[136:139], a[32:35], v[132:135]
ds_read_b128 a[108:111], v5 offset:33792
v_mfma_f32_16x16x32_bf16 v[132:135], a[140:143], a[36:39], v[132:135]
v_mfma_f32_16x16x32_bf16 v[156:159], a[140:143], a[44:47], v[156:159]
buffer_load_dwordx4 v1, s[4:7], s44 offen offset:0 sc1 lds
v_mfma_f32_16x16x32_bf16 v[156:159], a[136:139], a[40:43], v[156:159]
ds_read_b128 a[112:115], v5 offset:28672
v_mfma_f32_16x16x32_bf16 v[180:183], a[136:139], a[48:51], v[180:183]
v_mfma_f32_16x16x32_bf16 v[180:183], a[140:143], a[52:55], v[180:183]
ds_read_b128 a[116:119], v5 offset:34816
v_mfma_f32_16x16x32_bf16 v[204:207], a[140:143], a[60:63], v[204:207]
v_mfma_f32_16x16x32_bf16 v[204:207], a[136:139], a[56:59], v[204:207]
buffer_load_dwordx4 a[24:27], v2, s[40:43], s35 offen offset:3072 sc1
v_mfma_f32_16x16x32_bf16 v[208:211], a[144:147], a[56:59], v[208:211]
v_mfma_f32_16x16x32_bf16 v[208:211], a[148:151], a[60:63], v[208:211]
v_mfma_f32_16x16x32_bf16 v[184:187], a[148:151], a[52:55], v[184:187]
v_mfma_f32_16x16x32_bf16 v[184:187], a[144:147], a[48:51], v[184:187]
v_mfma_f32_16x16x32_bf16 v[160:163], a[144:147], a[40:43], v[160:163]
buffer_load_dwordx4 a[28:31], v2, s[40:43], s33 offen offset:3072 sc1
s_add_u32 s35, s35, 0x4000
v_mfma_f32_16x16x32_bf16 v[160:163], a[148:151], a[44:47], v[160:163]
s_add_u32 s33, s33, 0x4000
v_mfma_f32_16x16x32_bf16 v[136:139], a[148:151], a[36:39], v[136:139]
v_mfma_f32_16x16x32_bf16 v[136:139], a[144:147], a[32:35], v[136:139]
s_waitcnt vmcnt(11) lgkmcnt(0)
v_mfma_f32_16x16x32_bf16 v[140:143], a[96:99], a[64:67], v[140:143]
ds_read_b128 a[128:131], v5 offset:29696
v_mfma_f32_16x16x32_bf16 v[140:143], a[100:103], a[68:71], v[140:143]
buffer_load_dwordx4 a[32:35], v2, s[40:43], s35 offen offset:0 sc1
v_mfma_f32_16x16x32_bf16 v[164:167], a[100:103], a[76:79], v[164:167]
ds_read_b128 a[132:135], v5 offset:35840
v_mfma_f32_16x16x32_bf16 v[164:167], a[96:99], a[72:75], v[164:167]
v_mfma_f32_16x16x32_bf16 v[188:191], a[96:99], a[80:83], v[188:191]
v_mfma_f32_16x16x32_bf16 v[188:191], a[100:103], a[84:87], v[188:191]
buffer_load_dwordx4 a[36:39], v2, s[40:43], s33 offen offset:0 sc1
v_mfma_f32_16x16x32_bf16 v[212:215], a[100:103], a[92:95], v[212:215]
ds_read_b128 a[136:139], v5 offset:24576
v_mfma_f32_16x16x32_bf16 v[212:215], a[96:99], a[88:91], v[212:215]
v_mfma_f32_16x16x32_bf16 v[216:219], a[104:107], a[88:91], v[216:219]
ds_read_b128 a[140:143], v5 offset:30720
v_mfma_f32_16x16x32_bf16 v[216:219], a[108:111], a[92:95], v[216:219]
v_mfma_f32_16x16x32_bf16 v[192:195], a[108:111], a[84:87], v[192:195]
buffer_load_dwordx4 v1, s[4:7], s44 offen offset:1024 sc1 lds
s_add_u32 m0, s18, 0x20000
v_mfma_f32_16x16x32_bf16 v[192:195], a[104:107], a[80:83], v[192:195]
s_add_u32 s44, s50, 0x2820000
ds_read_b128 a[144:147], v5 offset:25600
v_mfma_f32_16x16x32_bf16 v[168:171], a[104:107], a[72:75], v[168:171]
v_mfma_f32_16x16x32_bf16 v[168:171], a[108:111], a[76:79], v[168:171]
ds_read_b128 a[148:151], v5 offset:31744
v_mfma_f32_16x16x32_bf16 v[144:147], a[108:111], a[68:71], v[144:147]
v_mfma_f32_16x16x32_bf16 v[144:147], a[104:107], a[64:67], v[144:147]
buffer_load_dwordx4 a[40:43], v2, s[40:43], s35 offen offset:1024 sc1
v_mfma_f32_16x16x32_bf16 v[148:151], a[112:115], a[64:67], v[148:151]
v_mfma_f32_16x16x32_bf16 v[148:151], a[116:119], a[68:71], v[148:151]
v_mfma_f32_16x16x32_bf16 v[172:175], a[116:119], a[76:79], v[172:175]
v_mfma_f32_16x16x32_bf16 v[172:175], a[112:115], a[72:75], v[172:175]
v_mfma_f32_16x16x32_bf16 v[196:199], a[112:115], a[80:83], v[196:199]
buffer_load_dwordx4 a[44:47], v2, s[40:43], s33 offen offset:1024 sc1
v_mfma_f32_16x16x32_bf16 v[196:199], a[116:119], a[84:87], v[196:199]
v_mfma_f32_16x16x32_bf16 v[220:223], a[116:119], a[92:95], v[220:223]
v_mfma_f32_16x16x32_bf16 v[220:223], a[112:115], a[88:91], v[220:223]
s_waitcnt lgkmcnt(0)
v_mfma_f32_16x16x32_bf16 v[224:227], a[128:131], a[88:91], v[224:227]
ds_read_b128 a[96:99], v5 offset:38912
v_mfma_f32_16x16x32_bf16 v[224:227], a[132:135], a[92:95], v[224:227]
buffer_load_dwordx4 a[48:51], v2, s[40:43], s35 offen offset:2048 sc1
v_mfma_f32_16x16x32_bf16 v[200:203], a[132:135], a[84:87], v[200:203]
ds_read_b128 a[100:103], v5 offset:45056
v_mfma_f32_16x16x32_bf16 v[200:203], a[128:131], a[80:83], v[200:203]
v_mfma_f32_16x16x32_bf16 v[176:179], a[128:131], a[72:75], v[176:179]
v_mfma_f32_16x16x32_bf16 v[176:179], a[132:135], a[76:79], v[176:179]
buffer_load_dwordx4 a[52:55], v2, s[40:43], s33 offen offset:2048 sc1
v_mfma_f32_16x16x32_bf16 v[152:155], a[132:135], a[68:71], v[152:155]
ds_read_b128 a[104:107], v5 offset:39936
v_mfma_f32_16x16x32_bf16 v[152:155], a[128:131], a[64:67], v[152:155]
v_mfma_f32_16x16x32_bf16 v[132:135], a[136:139], a[64:67], v[132:135]
ds_read_b128 a[108:111], v5 offset:46080
v_mfma_f32_16x16x32_bf16 v[132:135], a[140:143], a[68:71], v[132:135]
v_mfma_f32_16x16x32_bf16 v[156:159], a[140:143], a[76:79], v[156:159]
buffer_load_dwordx4 v1, s[4:7], s44 offen offset:0 sc1 lds
v_mfma_f32_16x16x32_bf16 v[156:159], a[136:139], a[72:75], v[156:159]
ds_read_b128 a[112:115], v5 offset:40960
v_mfma_f32_16x16x32_bf16 v[180:183], a[136:139], a[80:83], v[180:183]
v_mfma_f32_16x16x32_bf16 v[180:183], a[140:143], a[84:87], v[180:183]
ds_read_b128 a[116:119], v5 offset:47104
v_mfma_f32_16x16x32_bf16 v[204:207], a[140:143], a[92:95], v[204:207]
v_mfma_f32_16x16x32_bf16 v[204:207], a[136:139], a[88:91], v[204:207]
buffer_load_dwordx4 a[56:59], v2, s[40:43], s35 offen offset:3072 sc1
v_mfma_f32_16x16x32_bf16 v[208:211], a[144:147], a[88:91], v[208:211]
v_mfma_f32_16x16x32_bf16 v[208:211], a[148:151], a[92:95], v[208:211]
v_mfma_f32_16x16x32_bf16 v[184:187], a[148:151], a[84:87], v[184:187]
v_mfma_f32_16x16x32_bf16 v[184:187], a[144:147], a[80:83], v[184:187]
v_mfma_f32_16x16x32_bf16 v[160:163], a[144:147], a[72:75], v[160:163]
buffer_load_dwordx4 a[60:63], v2, s[40:43], s33 offen offset:3072 sc1
s_add_u32 s35, s35, 0x4000
v_mfma_f32_16x16x32_bf16 v[160:163], a[148:151], a[76:79], v[160:163]
s_add_u32 s33, s33, 0x4000
v_mfma_f32_16x16x32_bf16 v[136:139], a[148:151], a[68:71], v[136:139]
v_mfma_f32_16x16x32_bf16 v[136:139], a[144:147], a[64:67], v[136:139]
s_waitcnt vmcnt(10) lgkmcnt(0)
v_mfma_f32_16x16x32_bf16 v[140:143], a[96:99], a[0:3], v[140:143]
ds_read_b128 a[128:131], v5 offset:41984
v_mfma_f32_16x16x32_bf16 v[140:143], a[100:103], a[4:7], v[140:143]
buffer_load_dwordx4 a[64:67], v2, s[40:43], s35 offen offset:0 sc1
v_mfma_f32_16x16x32_bf16 v[164:167], a[100:103], a[12:15], v[164:167]
ds_read_b128 a[132:135], v5 offset:48128
v_mfma_f32_16x16x32_bf16 v[164:167], a[96:99], a[8:11], v[164:167]
v_mfma_f32_16x16x32_bf16 v[188:191], a[96:99], a[16:19], v[188:191]
v_mfma_f32_16x16x32_bf16 v[188:191], a[100:103], a[20:23], v[188:191]
buffer_load_dwordx4 v1, s[4:7], s44 offen offset:1024 sc1 lds
s_add_u32 m0, s18, 0x22000
v_mfma_f32_16x16x32_bf16 v[212:215], a[100:103], a[28:31], v[212:215]
s_add_u32 s44, s50, 0x2822000
ds_read_b128 a[136:139], v5 offset:36864
v_mfma_f32_16x16x32_bf16 v[212:215], a[96:99], a[24:27], v[212:215]
v_mfma_f32_16x16x32_bf16 v[216:219], a[104:107], a[24:27], v[216:219]
ds_read_b128 a[140:143], v5 offset:43008
v_mfma_f32_16x16x32_bf16 v[216:219], a[108:111], a[28:31], v[216:219]
buffer_load_dwordx4 a[68:71], v2, s[40:43], s33 offen offset:0 sc1
v_mfma_f32_16x16x32_bf16 v[192:195], a[108:111], a[20:23], v[192:195]
ds_read_b128 a[144:147], v5 offset:37888
v_mfma_f32_16x16x32_bf16 v[192:195], a[104:107], a[16:19], v[192:195]
v_mfma_f32_16x16x32_bf16 v[168:171], a[104:107], a[8:11], v[168:171]
v_mfma_f32_16x16x32_bf16 v[168:171], a[108:111], a[12:15], v[168:171]
buffer_load_dwordx4 a[72:75], v2, s[40:43], s35 offen offset:1024 sc1
v_mfma_f32_16x16x32_bf16 v[144:147], a[108:111], a[4:7], v[144:147]
ds_read_b128 a[148:151], v5 offset:44032
v_mfma_f32_16x16x32_bf16 v[144:147], a[104:107], a[0:3], v[144:147]
v_mfma_f32_16x16x32_bf16 v[148:151], a[112:115], a[0:3], v[148:151]
v_mfma_f32_16x16x32_bf16 v[148:151], a[116:119], a[4:7], v[148:151]
buffer_load_dwordx4 v1, s[4:7], s44 offen offset:0 sc1 lds
v_mfma_f32_16x16x32_bf16 v[172:175], a[116:119], a[12:15], v[172:175]
v_mfma_f32_16x16x32_bf16 v[172:175], a[112:115], a[8:11], v[172:175]
v_mfma_f32_16x16x32_bf16 v[196:199], a[112:115], a[16:19], v[196:199]
v_mfma_f32_16x16x32_bf16 v[196:199], a[116:119], a[20:23], v[196:199]
buffer_load_dwordx4 a[76:79], v2, s[40:43], s33 offen offset:1024 sc1
v_mfma_f32_16x16x32_bf16 v[220:223], a[116:119], a[28:31], v[220:223]
v_mfma_f32_16x16x32_bf16 v[220:223], a[112:115], a[24:27], v[220:223]
s_waitcnt lgkmcnt(0)
s_barrier
v_mfma_f32_16x16x32_bf16 v[224:227], a[128:131], a[24:27], v[224:227]
v_add_u32 v5, 49152, v1
v_mfma_f32_16x16x32_bf16 v[224:227], a[132:135], a[28:31], v[224:227]
buffer_load_dwordx4 a[80:83], v2, s[40:43], s35 offen offset:2048 sc1
v_mfma_f32_16x16x32_bf16 v[200:203], a[132:135], a[20:23], v[200:203]
ds_read_b128 a[96:99], v5 offset:2048
v_mfma_f32_16x16x32_bf16 v[200:203], a[128:131], a[16:19], v[200:203]
ds_read_b128 a[100:103], v5 offset:8192
v_mfma_f32_16x16x32_bf16 v[176:179], a[128:131], a[8:11], v[176:179]
v_mfma_f32_16x16x32_bf16 v[176:179], a[132:135], a[12:15], v[176:179]
buffer_load_dwordx4 a[84:87], v2, s[40:43], s33 offen offset:2048 sc1
v_mfma_f32_16x16x32_bf16 v[152:155], a[132:135], a[4:7], v[152:155]
ds_read_b128 a[104:107], v5 offset:3072
v_mfma_f32_16x16x32_bf16 v[152:155], a[128:131], a[0:3], v[152:155]
v_mfma_f32_16x16x32_bf16 v[132:135], a[136:139], a[0:3], v[132:135]
ds_read_b128 a[108:111], v5 offset:9216
v_mfma_f32_16x16x32_bf16 v[132:135], a[140:143], a[4:7], v[132:135]
v_mfma_f32_16x16x32_bf16 v[156:159], a[140:143], a[12:15], v[156:159]
buffer_load_dwordx4 v1, s[4:7], s44 offen offset:1024 sc1 lds
s_add_u32 s88, s82, 0x300000
v_mfma_f32_16x16x32_bf16 v[156:159], a[136:139], a[8:11], v[156:159]
ds_read_b128 a[112:115], v5 offset:4096
v_mfma_f32_16x16x32_bf16 v[180:183], a[136:139], a[16:19], v[180:183]
v_mfma_f32_16x16x32_bf16 v[180:183], a[140:143], a[20:23], v[180:183]
ds_read_b128 a[116:119], v5 offset:10240
v_mfma_f32_16x16x32_bf16 v[204:207], a[140:143], a[28:31], v[204:207]
v_mfma_f32_16x16x32_bf16 v[204:207], a[136:139], a[24:27], v[204:207]
buffer_load_dwordx4 a[88:91], v2, s[40:43], s35 offen offset:3072 sc1
v_mfma_f32_16x16x32_bf16 v[208:211], a[144:147], a[24:27], v[208:211]
v_mfma_f32_16x16x32_bf16 v[208:211], a[148:151], a[28:31], v[208:211]
v_mfma_f32_16x16x32_bf16 v[184:187], a[148:151], a[20:23], v[184:187]
v_mfma_f32_16x16x32_bf16 v[184:187], a[144:147], a[16:19], v[184:187]
v_mfma_f32_16x16x32_bf16 v[160:163], a[144:147], a[8:11], v[160:163]
buffer_load_dwordx4 a[92:95], v2, s[40:43], s33 offen offset:3072 sc1
s_add_u32 s35, s35, 0x4000
v_mfma_f32_16x16x32_bf16 v[160:163], a[148:151], a[12:15], v[160:163]
s_add_u32 s33, s33, 0x4000
v_mfma_f32_16x16x32_bf16 v[136:139], a[148:151], a[4:7], v[136:139]
v_mfma_f32_16x16x32_bf16 v[136:139], a[144:147], a[0:3], v[136:139]
s_waitcnt vmcnt(11) lgkmcnt(0)
v_mfma_f32_16x16x32_bf16 v[140:143], a[96:99], a[32:35], v[140:143]
ds_read_b128 a[128:131], v5 offset:5120
v_mfma_f32_16x16x32_bf16 v[140:143], a[100:103], a[36:39], v[140:143]
buffer_load_dwordx4 a[0:3], v2, s[40:43], s35 offen offset:0 sc1
v_mfma_f32_16x16x32_bf16 v[164:167], a[100:103], a[44:47], v[164:167]
ds_read_b128 a[132:135], v5 offset:11264
v_mfma_f32_16x16x32_bf16 v[164:167], a[96:99], a[40:43], v[164:167]
v_mfma_f32_16x16x32_bf16 v[188:191], a[96:99], a[48:51], v[188:191]
v_mfma_f32_16x16x32_bf16 v[188:191], a[100:103], a[52:55], v[188:191]
buffer_load_dwordx4 a[4:7], v2, s[40:43], s33 offen offset:0 sc1
v_mfma_f32_16x16x32_bf16 v[212:215], a[100:103], a[60:63], v[212:215]
ds_read_b128 a[136:139], v5 offset:0
v_mfma_f32_16x16x32_bf16 v[212:215], a[96:99], a[56:59], v[212:215]
v_mfma_f32_16x16x32_bf16 v[216:219], a[104:107], a[56:59], v[216:219]
ds_read_b128 a[140:143], v5 offset:6144
v_mfma_f32_16x16x32_bf16 v[216:219], a[108:111], a[60:63], v[216:219]
v_mfma_f32_16x16x32_bf16 v[192:195], a[108:111], a[52:55], v[192:195]
buffer_load_dwordx4 v[92:95], v1, s[4:7], s88 offen offset:0 sc1
v_mfma_f32_16x16x32_bf16 v[192:195], a[104:107], a[48:51], v[192:195]
ds_read_b128 a[144:147], v5 offset:1024
v_mfma_f32_16x16x32_bf16 v[168:171], a[104:107], a[40:43], v[168:171]
v_mfma_f32_16x16x32_bf16 v[168:171], a[108:111], a[44:47], v[168:171]
ds_read_b128 a[148:151], v5 offset:7168
v_mfma_f32_16x16x32_bf16 v[144:147], a[108:111], a[36:39], v[144:147]
v_mfma_f32_16x16x32_bf16 v[144:147], a[104:107], a[32:35], v[144:147]
buffer_load_dwordx4 a[8:11], v2, s[40:43], s35 offen offset:1024 sc1
v_mfma_f32_16x16x32_bf16 v[148:151], a[112:115], a[32:35], v[148:151]
v_mfma_f32_16x16x32_bf16 v[148:151], a[116:119], a[36:39], v[148:151]
v_mfma_f32_16x16x32_bf16 v[172:175], a[116:119], a[44:47], v[172:175]
v_mfma_f32_16x16x32_bf16 v[172:175], a[112:115], a[40:43], v[172:175]
v_mfma_f32_16x16x32_bf16 v[196:199], a[112:115], a[48:51], v[196:199]
buffer_load_dwordx4 a[12:15], v2, s[40:43], s33 offen offset:1024 sc1
v_mfma_f32_16x16x32_bf16 v[196:199], a[116:119], a[52:55], v[196:199]
v_mfma_f32_16x16x32_bf16 v[220:223], a[116:119], a[60:63], v[220:223]
v_mfma_f32_16x16x32_bf16 v[220:223], a[112:115], a[56:59], v[220:223]
s_waitcnt lgkmcnt(0)
v_mfma_f32_16x16x32_bf16 v[224:227], a[128:131], a[56:59], v[224:227]
ds_read_b128 a[96:99], v5 offset:14336
v_mfma_f32_16x16x32_bf16 v[224:227], a[132:135], a[60:63], v[224:227]
buffer_load_dwordx4 a[16:19], v2, s[40:43], s35 offen offset:2048 sc1
v_mfma_f32_16x16x32_bf16 v[200:203], a[132:135], a[52:55], v[200:203]
ds_read_b128 a[100:103], v5 offset:20480
v_mfma_f32_16x16x32_bf16 v[200:203], a[128:131], a[48:51], v[200:203]
v_mfma_f32_16x16x32_bf16 v[176:179], a[128:131], a[40:43], v[176:179]
v_mfma_f32_16x16x32_bf16 v[176:179], a[132:135], a[44:47], v[176:179]
buffer_load_dwordx4 a[20:23], v2, s[40:43], s33 offen offset:2048 sc1
v_mfma_f32_16x16x32_bf16 v[152:155], a[132:135], a[36:39], v[152:155]
ds_read_b128 a[104:107], v5 offset:15360
v_mfma_f32_16x16x32_bf16 v[152:155], a[128:131], a[32:35], v[152:155]
v_mfma_f32_16x16x32_bf16 v[132:135], a[136:139], a[32:35], v[132:135]
ds_read_b128 a[108:111], v5 offset:21504
v_mfma_f32_16x16x32_bf16 v[132:135], a[140:143], a[36:39], v[132:135]
v_mfma_f32_16x16x32_bf16 v[156:159], a[140:143], a[44:47], v[156:159]
buffer_load_dwordx4 v[96:99], v1, s[4:7], s88 offen offset:1024 sc1
v_mfma_f32_16x16x32_bf16 v[156:159], a[136:139], a[40:43], v[156:159]
ds_read_b128 a[112:115], v5 offset:16384
v_mfma_f32_16x16x32_bf16 v[180:183], a[136:139], a[48:51], v[180:183]
v_mfma_f32_16x16x32_bf16 v[180:183], a[140:143], a[52:55], v[180:183]
ds_read_b128 a[116:119], v5 offset:22528
v_mfma_f32_16x16x32_bf16 v[204:207], a[140:143], a[60:63], v[204:207]
v_mfma_f32_16x16x32_bf16 v[204:207], a[136:139], a[56:59], v[204:207]
buffer_load_dwordx4 a[24:27], v2, s[40:43], s35 offen offset:3072 sc1
v_mfma_f32_16x16x32_bf16 v[208:211], a[144:147], a[56:59], v[208:211]
v_mfma_f32_16x16x32_bf16 v[208:211], a[148:151], a[60:63], v[208:211]
v_mfma_f32_16x16x32_bf16 v[184:187], a[148:151], a[52:55], v[184:187]
v_mfma_f32_16x16x32_bf16 v[184:187], a[144:147], a[48:51], v[184:187]
v_mfma_f32_16x16x32_bf16 v[160:163], a[144:147], a[40:43], v[160:163]
buffer_load_dwordx4 a[28:31], v2, s[40:43], s33 offen offset:3072 sc1
s_add_u32 s35, s35, 0x4000
v_mfma_f32_16x16x32_bf16 v[160:163], a[148:151], a[44:47], v[160:163]
s_add_u32 s33, s33, 0x4000
v_mfma_f32_16x16x32_bf16 v[136:139], a[148:151], a[36:39], v[136:139]
v_mfma_f32_16x16x32_bf16 v[136:139], a[144:147], a[32:35], v[136:139]
s_waitcnt vmcnt(10) lgkmcnt(0)
v_mfma_f32_16x16x32_bf16 v[140:143], a[96:99], a[64:67], v[140:143]
ds_read_b128 a[128:131], v5 offset:17408
v_mfma_f32_16x16x32_bf16 v[140:143], a[100:103], a[68:71], v[140:143]
buffer_load_dwordx4 a[32:35], v2, s[40:43], s35 offen offset:0 sc1
v_mfma_f32_16x16x32_bf16 v[164:167], a[100:103], a[76:79], v[164:167]
ds_read_b128 a[132:135], v5 offset:23552
L_stub5:
s_cbranch_execz L_stub6
v_mfma_f32_16x16x32_bf16 v[164:167], a[96:99], a[72:75], v[164:167]
v_mfma_f32_16x16x32_bf16 v[188:191], a[96:99], a[80:83], v[188:191]
v_mfma_f32_16x16x32_bf16 v[188:191], a[100:103], a[84:87], v[188:191]
buffer_load_dwordx4 v[100:103], v1, s[4:7], s88 offen offset:2048 sc1
v_mfma_f32_16x16x32_bf16 v[212:215], a[100:103], a[92:95], v[212:215]
ds_read_b128 a[136:139], v5 offset:12288
v_mfma_f32_16x16x32_bf16 v[212:215], a[96:99], a[88:91], v[212:215]
v_mfma_f32_16x16x32_bf16 v[216:219], a[104:107], a[88:91], v[216:219]
ds_read_b128 a[140:143], v5 offset:18432
v_mfma_f32_16x16x32_bf16 v[216:219], a[108:111], a[92:95], v[216:219]
buffer_load_dwordx4 a[36:39], v2, s[40:43], s33 offen offset:0 sc1
v_mfma_f32_16x16x32_bf16 v[192:195], a[108:111], a[84:87], v[192:195]
ds_read_b128 a[144:147], v5 offset:13312
v_mfma_f32_16x16x32_bf16 v[192:195], a[104:107], a[80:83], v[192:195]
v_mfma_f32_16x16x32_bf16 v[168:171], a[104:107], a[72:75], v[168:171]
v_mfma_f32_16x16x32_bf16 v[168:171], a[108:111], a[76:79], v[168:171]
buffer_load_dwordx4 a[40:43], v2, s[40:43], s35 offen offset:1024 sc1
v_mfma_f32_16x16x32_bf16 v[144:147], a[108:111], a[68:71], v[144:147]
ds_read_b128 a[148:151], v5 offset:19456
v_mfma_f32_16x16x32_bf16 v[144:147], a[104:107], a[64:67], v[144:147]
v_mfma_f32_16x16x32_bf16 v[148:151], a[112:115], a[64:67], v[148:151]
v_mfma_f32_16x16x32_bf16 v[148:151], a[116:119], a[68:71], v[148:151]
buffer_load_dwordx4 v[104:107], v1, s[4:7], s88 offen offset:3072 sc1
s_add_u32 s88, s88, 4096
v_mfma_f32_16x16x32_bf16 v[172:175], a[116:119], a[76:79], v[172:175]
v_mfma_f32_16x16x32_bf16 v[172:175], a[112:115], a[72:75], v[172:175]
v_mfma_f32_16x16x32_bf16 v[196:199], a[112:115], a[80:83], v[196:199]
v_mfma_f32_16x16x32_bf16 v[196:199], a[116:119], a[84:87], v[196:199]
buffer_load_dwordx4 a[44:47], v2, s[40:43], s33 offen offset:1024 sc1
v_mfma_f32_16x16x32_bf16 v[220:223], a[116:119], a[92:95], v[220:223]
v_mfma_f32_16x16x32_bf16 v[220:223], a[112:115], a[88:91], v[220:223]
s_waitcnt lgkmcnt(0)
v_mfma_f32_16x16x32_bf16 v[224:227], a[128:131], a[88:91], v[224:227]
ds_read_b128 a[96:99], v5 offset:26624
v_mfma_f32_16x16x32_bf16 v[224:227], a[132:135], a[92:95], v[224:227]
buffer_load_dwordx4 a[48:51], v2, s[40:43], s35 offen offset:2048 sc1
v_mfma_f32_16x16x32_bf16 v[200:203], a[132:135], a[84:87], v[200:203]
ds_read_b128 a[100:103], v5 offset:32768
v_mfma_f32_16x16x32_bf16 v[200:203], a[128:131], a[80:83], v[200:203]
v_mfma_f32_16x16x32_bf16 v[176:179], a[128:131], a[72:75], v[176:179]
v_mfma_f32_16x16x32_bf16 v[176:179], a[132:135], a[76:79], v[176:179]
buffer_load_dwordx4 a[52:55], v2, s[40:43], s33 offen offset:2048 sc1
v_mfma_f32_16x16x32_bf16 v[152:155], a[132:135], a[68:71], v[152:155]
ds_read_b128 a[104:107], v5 offset:27648
v_mfma_f32_16x16x32_bf16 v[152:155], a[128:131], a[64:67], v[152:155]
v_mfma_f32_16x16x32_bf16 v[132:135], a[136:139], a[64:67], v[132:135]
ds_read_b128 a[108:111], v5 offset:33792
v_mfma_f32_16x16x32_bf16 v[132:135], a[140:143], a[68:71], v[132:135]
v_mfma_f32_16x16x32_bf16 v[156:159], a[140:143], a[76:79], v[156:159]
buffer_load_dwordx4 v[108:111], v1, s[4:7], s88 offen offset:0 sc1
v_mfma_f32_16x16x32_bf16 v[156:159], a[136:139], a[72:75], v[156:159]
ds_read_b128 a[112:115], v5 offset:28672
v_mfma_f32_16x16x32_bf16 v[180:183], a[136:139], a[80:83], v[180:183]
v_mfma_f32_16x16x32_bf16 v[180:183], a[140:143], a[84:87], v[180:183]
ds_read_b128 a[116:119], v5 offset:34816
v_mfma_f32_16x16x32_bf16 v[204:207], a[140:143], a[92:95], v[204:207]
v_mfma_f32_16x16x32_bf16 v[204:207], a[136:139], a[88:91], v[204:207]
buffer_load_dwordx4 a[56:59], v2, s[40:43], s35 offen offset:3072 sc1
v_mfma_f32_16x16x32_bf16 v[208:211], a[144:147], a[88:91], v[208:211]
v_mfma_f32_16x16x32_bf16 v[208:211], a[148:151], a[92:95], v[208:211]
v_mfma_f32_16x16x32_bf16 v[184:187], a[148:151], a[84:87], v[184:187]
v_mfma_f32_16x16x32_bf16 v[184:187], a[144:147], a[80:83], v[184:187]
v_mfma_f32_16x16x32_bf16 v[160:163], a[144:147], a[72:75], v[160:163]
buffer_load_dwordx4 a[60:63], v2, s[40:43], s33 offen offset:3072 sc1
s_add_u32 s35, s35, 0x64000
v_mfma_f32_16x16x32_bf16 v[160:163], a[148:151], a[76:79], v[160:163]
s_add_u32 s33, s33, 0x64000
v_mfma_f32_16x16x32_bf16 v[136:139], a[148:151], a[68:71], v[136:139]
v_mfma_f32_16x16x32_bf16 v[136:139], a[144:147], a[64:67], v[136:139]
s_waitcnt vmcnt(11) lgkmcnt(0)
v_mfma_f32_16x16x32_bf16 v[140:143], a[96:99], a[0:3], v[140:143]
ds_read_b128 a[128:131], v5 offset:29696
v_add_f32_dpp v48, v48, v48 row_ror:8 row_mask:0xf bank_mask:0xf
v_mfma_f32_16x16x32_bf16 v[140:143], a[100:103], a[4:7], v[140:143]
buffer_load_dwordx4 a[64:67], v2, s[40:43], s35 offen offset:0 sc1
v_mfma_f32_16x16x32_bf16 v[164:167], a[100:103], a[12:15], v[164:167]
ds_read_b128 a[132:135], v5 offset:35840
v_add_f32_dpp v49, v49, v49 row_ror:8 row_mask:0xf bank_mask:0xf
v_mfma_f32_16x16x32_bf16 v[164:167], a[96:99], a[8:11], v[164:167]
v_add_f32_dpp v50, v50, v50 row_ror:8 row_mask:0xf bank_mask:0xf
v_add_f32_dpp v51, v51, v51 row_ror:8 row_mask:0xf bank_mask:0xf
v_mfma_f32_16x16x32_bf16 v[188:191], a[96:99], a[16:19], v[188:191]
v_add_f32_dpp v52, v52, v52 row_ror:8 row_mask:0xf bank_mask:0xf
v_add_f32_dpp v53, v53, v53 row_ror:8 row_mask:0xf bank_mask:0xf
v_mfma_f32_16x16x32_bf16 v[188:191], a[100:103], a[20:23], v[188:191]
buffer_load_dwordx4 a[68:71], v2, s[40:43], s33 offen offset:0 sc1
v_mfma_f32_16x16x32_bf16 v[212:215], a[100:103], a[28:31], v[212:215]
ds_read_b128 a[136:139], v5 offset:24576
v_add_f32_dpp v54, v54, v54 row_ror:8 row_mask:0xf bank_mask:0xf
v_mfma_f32_16x16x32_bf16 v[212:215], a[96:99], a[24:27], v[212:215]
v_add_f32_dpp v55, v55, v55 row_ror:8 row_mask:0xf bank_mask:0xf
v_add_f32_dpp v48, v48, v48 row_ror:4 row_mask:0xf bank_mask:0xf
v_mfma_f32_16x16x32_bf16 v[216:219], a[104:107], a[24:27], v[216:219]
ds_read_b128 a[140:143], v5 offset:30720
v_add_f32_dpp v49, v49, v49 row_ror:4 row_mask:0xf bank_mask:0xf
v_mfma_f32_16x16x32_bf16 v[216:219], a[108:111], a[28:31], v[216:219]
v_add_f32_dpp v50, v50, v50 row_ror:4 row_mask:0xf bank_mask:0xf
v_mfma_f32_16x16x32_bf16 v[192:195], a[108:111], a[20:23], v[192:195]
buffer_load_dwordx4 v[112:115], v1, s[4:7], s88 offen offset:1024 sc1
v_mfma_f32_16x16x32_bf16 v[192:195], a[104:107], a[16:19], v[192:195]
ds_read_b128 a[144:147], v5 offset:25600
v_add_f32_dpp v51, v51, v51 row_ror:4 row_mask:0xf bank_mask:0xf
v_mfma_f32_16x16x32_bf16 v[168:171], a[104:107], a[8:11], v[168:171]
v_add_f32_dpp v52, v52, v52 row_ror:4 row_mask:0xf bank_mask:0xf
v_add_f32_dpp v53, v53, v53 row_ror:4 row_mask:0xf bank_mask:0xf
v_mfma_f32_16x16x32_bf16 v[168:171], a[108:111], a[12:15], v[168:171]
ds_read_b128 a[148:151], v5 offset:31744
v_add_f32_dpp v54, v54, v54 row_ror:4 row_mask:0xf bank_mask:0xf
v_mfma_f32_16x16x32_bf16 v[144:147], a[108:111], a[4:7], v[144:147]
v_add_f32_dpp v55, v55, v55 row_ror:4 row_mask:0xf bank_mask:0xf
v_mfma_f32_16x16x32_bf16 v[144:147], a[104:107], a[0:3], v[144:147]
buffer_load_dwordx4 a[72:75], v2, s[40:43], s35 offen offset:1024 sc1
v_mfma_f32_16x16x32_bf16 v[148:151], a[112:115], a[0:3], v[148:151]
v_add_f32_dpp v48, v48, v48 row_ror:2 row_mask:0xf bank_mask:0xf
v_add_f32_dpp v49, v49, v49 row_ror:2 row_mask:0xf bank_mask:0xf
v_mfma_f32_16x16x32_bf16 v[148:151], a[116:119], a[4:7], v[148:151]
v_add_f32_dpp v50, v50, v50 row_ror:2 row_mask:0xf bank_mask:0xf
v_mfma_f32_16x16x32_bf16 v[172:175], a[116:119], a[12:15], v[172:175]
v_add_f32_dpp v51, v51, v51 row_ror:2 row_mask:0xf bank_mask:0xf
v_mfma_f32_16x16x32_bf16 v[172:175], a[112:115], a[8:11], v[172:175]
v_add_f32_dpp v52, v52, v52 row_ror:2 row_mask:0xf bank_mask:0xf
v_mfma_f32_16x16x32_bf16 v[196:199], a[112:115], a[16:19], v[196:199]
buffer_load_dwordx4 a[76:79], v2, s[40:43], s33 offen offset:1024 sc1
v_mfma_f32_16x16x32_bf16 v[196:199], a[116:119], a[20:23], v[196:199]
v_add_f32_dpp v53, v53, v53 row_ror:2 row_mask:0xf bank_mask:0xf
v_add_f32_dpp v54, v54, v54 row_ror:2 row_mask:0xf bank_mask:0xf
v_mfma_f32_16x16x32_bf16 v[220:223], a[116:119], a[28:31], v[220:223]
v_add_f32_dpp v55, v55, v55 row_ror:2 row_mask:0xf bank_mask:0xf
v_mfma_f32_16x16x32_bf16 v[220:223], a[112:115], a[24:27], v[220:223]
v_add_f32_dpp v48, v48, v48 row_ror:1 row_mask:0xf bank_mask:0xf
s_waitcnt lgkmcnt(0)
v_mfma_f32_16x16x32_bf16 v[224:227], a[128:131], a[24:27], v[224:227]
ds_read_b128 a[96:99], v5 offset:38912
v_add_f32_dpp v49, v49, v49 row_ror:1 row_mask:0xf bank_mask:0xf
v_mfma_f32_16x16x32_bf16 v[224:227], a[132:135], a[28:31], v[224:227]
buffer_load_dwordx4 a[80:83], v2, s[40:43], s35 offen offset:2048 sc1
v_mfma_f32_16x16x32_bf16 v[200:203], a[132:135], a[20:23], v[200:203]
ds_read_b128 a[100:103], v5 offset:45056
v_add_f32_dpp v50, v50, v50 row_ror:1 row_mask:0xf bank_mask:0xf
v_mfma_f32_16x16x32_bf16 v[200:203], a[128:131], a[16:19], v[200:203]
v_add_f32_dpp v51, v51, v51 row_ror:1 row_mask:0xf bank_mask:0xf
v_add_f32_dpp v52, v52, v52 row_ror:1 row_mask:0xf bank_mask:0xf
v_mfma_f32_16x16x32_bf16 v[176:179], a[128:131], a[8:11], v[176:179]
v_add_f32_dpp v53, v53, v53 row_ror:1 row_mask:0xf bank_mask:0xf
v_add_f32_dpp v54, v54, v54 row_ror:1 row_mask:0xf bank_mask:0xf
v_mfma_f32_16x16x32_bf16 v[176:179], a[132:135], a[12:15], v[176:179]
buffer_load_dwordx4 a[84:87], v2, s[40:43], s33 offen offset:2048 sc1
v_mfma_f32_16x16x32_bf16 v[152:155], a[132:135], a[4:7], v[152:155]
ds_read_b128 a[104:107], v5 offset:39936
v_add_f32_dpp v55, v55, v55 row_ror:1 row_mask:0xf bank_mask:0xf
v_mfma_f32_16x16x32_bf16 v[152:155], a[128:131], a[0:3], v[152:155]
v_add_u32 v233, 159744, v233
s_lshl_b32 s36, s28, 6
v_mfma_f32_16x16x32_bf16 v[132:135], a[136:139], a[0:3], v[132:135]
ds_read_b128 a[108:111], v5 offset:46080
s_lshl_b32 s37, s39, 6
v_mfma_f32_16x16x32_bf16 v[132:135], a[140:143], a[4:7], v[132:135]
v_add_u32 v232, s36, v233
v_mfma_f32_16x16x32_bf16 v[156:159], a[140:143], a[12:15], v[156:159]
buffer_load_dwordx4 v[116:119], v1, s[4:7], s88 offen offset:2048 sc1
v_mfma_f32_16x16x32_bf16 v[156:159], a[136:139], a[8:11], v[156:159]
ds_read_b128 a[112:115], v5 offset:40960
v_add_u32 v235, s37, v233
v_mfma_f32_16x16x32_bf16 v[180:183], a[136:139], a[16:19], v[180:183]
v_mfma_f32_16x16x32_bf16 v[180:183], a[140:143], a[20:23], v[180:183]
ds_read_b128 a[116:119], v5 offset:47104
v_mfma_f32_16x16x32_bf16 v[204:207], a[140:143], a[28:31], v[204:207]
v_mfma_f32_16x16x32_bf16 v[204:207], a[136:139], a[24:27], v[204:207]
buffer_load_dwordx4 a[88:91], v2, s[40:43], s35 offen offset:3072 sc1
v_mfma_f32_16x16x32_bf16 v[208:211], a[144:147], a[24:27], v[208:211]
v_mfma_f32_16x16x32_bf16 v[208:211], a[148:151], a[28:31], v[208:211]
v_mfma_f32_16x16x32_bf16 v[184:187], a[148:151], a[20:23], v[184:187]
v_mfma_f32_16x16x32_bf16 v[184:187], a[144:147], a[16:19], v[184:187]
v_mfma_f32_16x16x32_bf16 v[160:163], a[144:147], a[8:11], v[160:163]
buffer_load_dwordx4 a[92:95], v2, s[40:43], s33 offen offset:3072 sc1
s_add_u32 s35, s35, 0x4000
v_mfma_f32_16x16x32_bf16 v[160:163], a[148:151], a[12:15], v[160:163]
s_add_u32 s33, s33, 0x4000
v_mfma_f32_16x16x32_bf16 v[136:139], a[148:151], a[4:7], v[136:139]
v_mfma_f32_16x16x32_bf16 v[136:139], a[144:147], a[0:3], v[136:139]
s_waitcnt vmcnt(10) lgkmcnt(0)
v_mfma_f32_16x16x32_bf16 v[140:143], a[96:99], a[32:35], v[140:143]
ds_read_b128 a[128:131], v5 offset:41984
v_mfma_f32_16x16x32_bf16 v[140:143], a[100:103], a[36:39], v[140:143]
buffer_load_dwordx4 a[0:3], v2, s[40:43], s35 offen offset:0 sc1
v_mfma_f32_16x16x32_bf16 v[164:167], a[100:103], a[44:47], v[164:167]
ds_read_b128 a[132:135], v5 offset:48128
v_mfma_f32_16x16x32_bf16 v[164:167], a[96:99], a[40:43], v[164:167]
ds_write_b128 v232, v[48:51]
v_mfma_f32_16x16x32_bf16 v[188:191], a[96:99], a[48:51], v[188:191]
ds_write_b128 v235, v[52:55]
v_mfma_f32_16x16x32_bf16 v[188:191], a[100:103], a[52:55], v[188:191]
buffer_load_dwordx4 v[120:123], v1, s[4:7], s88 offen offset:3072 sc1
s_add_u32 m0, s18, 0x0
v_mfma_f32_16x16x32_bf16 v[212:215], a[100:103], a[60:63], v[212:215]
s_add_u32 s44, s50, 0x2824000
ds_read_b128 a[136:139], v5 offset:36864
v_mfma_f32_16x16x32_bf16 v[212:215], a[96:99], a[56:59], v[212:215]
v_mfma_f32_16x16x32_bf16 v[216:219], a[104:107], a[56:59], v[216:219]
ds_read_b128 a[140:143], v5 offset:43008
v_mfma_f32_16x16x32_bf16 v[216:219], a[108:111], a[60:63], v[216:219]
buffer_load_dwordx4 a[4:7], v2, s[40:43], s33 offen offset:0 sc1
v_mfma_f32_16x16x32_bf16 v[192:195], a[108:111], a[52:55], v[192:195]
ds_read_b128 a[144:147], v5 offset:37888
v_mfma_f32_16x16x32_bf16 v[192:195], a[104:107], a[48:51], v[192:195]
v_mfma_f32_16x16x32_bf16 v[168:171], a[104:107], a[40:43], v[168:171]
v_mfma_f32_16x16x32_bf16 v[168:171], a[108:111], a[44:47], v[168:171]
buffer_load_dwordx4 a[8:11], v2, s[40:43], s35 offen offset:1024 sc1
v_mfma_f32_16x16x32_bf16 v[144:147], a[108:111], a[36:39], v[144:147]
ds_read_b128 a[148:151], v5 offset:44032
v_mfma_f32_16x16x32_bf16 v[144:147], a[104:107], a[32:35], v[144:147]
v_mfma_f32_16x16x32_bf16 v[148:151], a[112:115], a[32:35], v[148:151]
v_mfma_f32_16x16x32_bf16 v[148:151], a[116:119], a[36:39], v[148:151]
buffer_load_dwordx4 v1, s[4:7], s44 offen offset:0 sc1 lds
v_mfma_f32_16x16x32_bf16 v[172:175], a[116:119], a[44:47], v[172:175]
v_mfma_f32_16x16x32_bf16 v[172:175], a[112:115], a[40:43], v[172:175]
v_mfma_f32_16x16x32_bf16 v[196:199], a[112:115], a[48:51], v[196:199]
v_mfma_f32_16x16x32_bf16 v[196:199], a[116:119], a[52:55], v[196:199]
buffer_load_dwordx4 a[12:15], v2, s[40:43], s33 offen offset:1024 sc1
v_mfma_f32_16x16x32_bf16 v[220:223], a[116:119], a[60:63], v[220:223]
v_mfma_f32_16x16x32_bf16 v[220:223], a[112:115], a[56:59], v[220:223]
s_waitcnt lgkmcnt(0)
s_barrier
v_mfma_f32_16x16x32_bf16 v[224:227], a[128:131], a[56:59], v[224:227]
v_add_u32 v5, 98304, v1
v_mfma_f32_16x16x32_bf16 v[224:227], a[132:135], a[60:63], v[224:227]
buffer_load_dwordx4 a[16:19], v2, s[40:43], s35 offen offset:2048 sc1
v_mfma_f32_16x16x32_bf16 v[200:203], a[132:135], a[52:55], v[200:203]
ds_read_b128 a[96:99], v5 offset:2048
v_mfma_f32_16x16x32_bf16 v[200:203], a[128:131], a[48:51], v[200:203]
ds_read_b128 a[100:103], v5 offset:8192
v_mfma_f32_16x16x32_bf16 v[176:179], a[128:131], a[40:43], v[176:179]
ds_read_b128 v[48:51], v233 offset:0
v_mfma_f32_16x16x32_bf16 v[176:179], a[132:135], a[44:47], v[176:179]
buffer_load_dwordx4 a[20:23], v2, s[40:43], s33 offen offset:2048 sc1
v_mfma_f32_16x16x32_bf16 v[152:155], a[132:135], a[36:39], v[152:155]
ds_read_b128 a[104:107], v5 offset:3072
v_mfma_f32_16x16x32_bf16 v[152:155], a[128:131], a[32:35], v[152:155]
v_mfma_f32_16x16x32_bf16 v[132:135], a[136:139], a[32:35], v[132:135]
ds_read_b128 a[108:111], v5 offset:9216
v_mfma_f32_16x16x32_bf16 v[132:135], a[140:143], a[36:39], v[132:135]
v_mfma_f32_16x16x32_bf16 v[156:159], a[140:143], a[44:47], v[156:159]
buffer_load_dwordx4 v1, s[4:7], s44 offen offset:1024 sc1 lds
s_add_u32 m0, s18, 0x2000
v_mfma_f32_16x16x32_bf16 v[156:159], a[136:139], a[40:43], v[156:159]
s_add_u32 s44, s50, 0x2826000
ds_read_b128 a[112:115], v5 offset:4096
v_mfma_f32_16x16x32_bf16 v[180:183], a[136:139], a[48:51], v[180:183]
ds_read_b128 v[52:55], v233 offset:64
v_mfma_f32_16x16x32_bf16 v[180:183], a[140:143], a[52:55], v[180:183]
ds_read_b128 a[116:119], v5 offset:10240
v_mfma_f32_16x16x32_bf16 v[204:207], a[140:143], a[60:63], v[204:207]
v_mfma_f32_16x16x32_bf16 v[204:207], a[136:139], a[56:59], v[204:207]
buffer_load_dwordx4 a[24:27], v2, s[40:43], s35 offen offset:3072 sc1
v_mfma_f32_16x16x32_bf16 v[208:211], a[144:147], a[56:59], v[208:211]
v_mfma_f32_16x16x32_bf16 v[208:211], a[148:151], a[60:63], v[208:211]
v_mfma_f32_16x16x32_bf16 v[184:187], a[148:151], a[52:55], v[184:187]
v_mfma_f32_16x16x32_bf16 v[184:187], a[144:147], a[48:51], v[184:187]
v_mfma_f32_16x16x32_bf16 v[160:163], a[144:147], a[40:43], v[160:163]
buffer_load_dwordx4 a[28:31], v2, s[40:43], s33 offen offset:3072 sc1
s_add_u32 s35, s35, 0x4000
v_mfma_f32_16x16x32_bf16 v[160:163], a[148:151], a[44:47], v[160:163]
s_add_u32 s33, s33, 0x4000
ds_read_b128 v[56:59], v233 offset:128
v_mfma_f32_16x16x32_bf16 v[136:139], a[148:151], a[36:39], v[136:139]
v_mfma_f32_16x16x32_bf16 v[136:139], a[144:147], a[32:35], v[136:139]
s_waitcnt vmcnt(11) lgkmcnt(1)
v_mfma_f32_16x16x32_bf16 v[140:143], a[96:99], a[64:67], v[140:143]
ds_read_b128 a[128:131], v5 offset:5120
v_mfma_f32_16x16x32_bf16 v[140:143], a[100:103], a[68:71], v[140:143]
buffer_load_dwordx4 a[32:35], v2, s[40:43], s35 offen offset:0 sc1
v_mfma_f32_16x16x32_bf16 v[164:167], a[100:103], a[76:79], v[164:167]
ds_read_b128 a[132:135], v5 offset:11264
v_mfma_f32_16x16x32_bf16 v[164:167], a[96:99], a[72:75], v[164:167]
v_mfma_f32_16x16x32_bf16 v[188:191], a[96:99], a[80:83], v[188:191]
v_mfma_f32_16x16x32_bf16 v[188:191], a[100:103], a[84:87], v[188:191]
buffer_load_dwordx4 a[36:39], v2, s[40:43], s33 offen offset:0 sc1
v_mfma_f32_16x16x32_bf16 v[212:215], a[100:103], a[92:95], v[212:215]
ds_read_b128 a[136:139], v5 offset:0
v_mfma_f32_16x16x32_bf16 v[212:215], a[96:99], a[88:91], v[212:215]
v_mfma_f32_16x16x32_bf16 v[216:219], a[104:107], a[88:91], v[216:219]
ds_read_b128 a[140:143], v5 offset:6144
v_mfma_f32_16x16x32_bf16 v[216:219], a[108:111], a[92:95], v[216:219]
ds_read_b128 v[60:63], v233 offset:192
v_mfma_f32_16x16x32_bf16 v[192:195], a[108:111], a[84:87], v[192:195]
buffer_load_dwordx4 v1, s[4:7], s44 offen offset:0 sc1 lds
v_mfma_f32_16x16x32_bf16 v[192:195], a[104:107], a[80:83], v[192:195]
ds_read_b128 a[144:147], v5 offset:1024
v_mfma_f32_16x16x32_bf16 v[168:171], a[104:107], a[72:75], v[168:171]
v_mfma_f32_16x16x32_bf16 v[168:171], a[108:111], a[76:79], v[168:171]
ds_read_b128 a[148:151], v5 offset:7168
v_mfma_f32_16x16x32_bf16 v[144:147], a[108:111], a[68:71], v[144:147]
v_mfma_f32_16x16x32_bf16 v[144:147], a[104:107], a[64:67], v[144:147]
buffer_load_dwordx4 a[40:43], v2, s[40:43], s35 offen offset:1024 sc1
v_mfma_f32_16x16x32_bf16 v[148:151], a[112:115], a[64:67], v[148:151]
v_mfma_f32_16x16x32_bf16 v[148:151], a[116:119], a[68:71], v[148:151]
v_mfma_f32_16x16x32_bf16 v[172:175], a[116:119], a[76:79], v[172:175]
ds_read_b128 v[64:67], v233 offset:256
v_mfma_f32_16x16x32_bf16 v[172:175], a[112:115], a[72:75], v[172:175]
v_mfma_f32_16x16x32_bf16 v[196:199], a[112:115], a[80:83], v[196:199]
buffer_load_dwordx4 a[44:47], v2, s[40:43], s33 offen offset:1024 sc1
v_mfma_f32_16x16x32_bf16 v[196:199], a[116:119], a[84:87], v[196:199]
v_mfma_f32_16x16x32_bf16 v[220:223], a[116:119], a[92:95], v[220:223]
v_mfma_f32_16x16x32_bf16 v[220:223], a[112:115], a[88:91], v[220:223]
s_waitcnt lgkmcnt(1)
v_mfma_f32_16x16x32_bf16 v[224:227], a[128:131], a[88:91], v[224:227]
ds_read_b128 a[96:99], v5 offset:14336
v_mfma_f32_16x16x32_bf16 v[224:227], a[132:135], a[92:95], v[224:227]
buffer_load_dwordx4 a[48:51], v2, s[40:43], s35 offen offset:2048 sc1
v_mfma_f32_16x16x32_bf16 v[200:203], a[132:135], a[84:87], v[200:203]
ds_read_b128 a[100:103], v5 offset:20480
v_mfma_f32_16x16x32_bf16 v[200:203], a[128:131], a[80:83], v[200:203]
v_mfma_f32_16x16x32_bf16 v[176:179], a[128:131], a[72:75], v[176:179]
v_mfma_f32_16x16x32_bf16 v[176:179], a[132:135], a[76:79], v[176:179]
buffer_load_dwordx4 a[52:55], v2, s[40:43], s33 offen offset:2048 sc1
v_mfma_f32_16x16x32_bf16 v[152:155], a[132:135], a[68:71], v[152:155]
ds_read_b128 a[104:107], v5 offset:15360
v_mfma_f32_16x16x32_bf16 v[152:155], a[128:131], a[64:67], v[152:155]
ds_read_b128 v[68:71], v233 offset:320
v_mfma_f32_16x16x32_bf16 v[132:135], a[136:139], a[64:67], v[132:135]
ds_read_b128 a[108:111], v5 offset:21504
v_mfma_f32_16x16x32_bf16 v[132:135], a[140:143], a[68:71], v[132:135]
v_mfma_f32_16x16x32_bf16 v[156:159], a[140:143], a[76:79], v[156:159]
buffer_load_dwordx4 v1, s[4:7], s44 offen offset:1024 sc1 lds
s_add_u32 m0, s18, 0x4000
v_mfma_f32_16x16x32_bf16 v[156:159], a[136:139], a[72:75], v[156:159]
s_add_u32 s44, s50, 0x2828000
ds_read_b128 a[112:115], v5 offset:16384
v_mfma_f32_16x16x32_bf16 v[180:183], a[136:139], a[80:83], v[180:183]
v_mfma_f32_16x16x32_bf16 v[180:183], a[140:143], a[84:87], v[180:183]
ds_read_b128 a[116:119], v5 offset:22528
v_mfma_f32_16x16x32_bf16 v[204:207], a[140:143], a[92:95], v[204:207]
v_mfma_f32_16x16x32_bf16 v[204:207], a[136:139], a[88:91], v[204:207]
buffer_load_dwordx4 a[56:59], v2, s[40:43], s35 offen offset:3072 sc1
v_mfma_f32_16x16x32_bf16 v[208:211], a[144:147], a[88:91], v[208:211]
v_mfma_f32_16x16x32_bf16 v[208:211], a[148:151], a[92:95], v[208:211]
v_mfma_f32_16x16x32_bf16 v[184:187], a[148:151], a[84:87], v[184:187]
v_mfma_f32_16x16x32_bf16 v[184:187], a[144:147], a[80:83], v[184:187]
v_mfma_f32_16x16x32_bf16 v[160:163], a[144:147], a[72:75], v[160:163]
buffer_load_dwordx4 a[60:63], v2, s[40:43], s33 offen offset:3072 sc1
s_add_u32 s35, s35, 0x4000
v_mfma_f32_16x16x32_bf16 v[160:163], a[148:151], a[76:79], v[160:163]
s_add_u32 s33, s33, 0x4000
v_mfma_f32_16x16x32_bf16 v[136:139], a[148:151], a[68:71], v[136:139]
v_mfma_f32_16x16x32_bf16 v[136:139], a[144:147], a[64:67], v[136:139]
s_waitcnt vmcnt(10) lgkmcnt(0)
v_mfma_f32_16x16x32_bf16 v[140:143], a[96:99], a[0:3], v[140:143]
ds_read_b128 a[128:131], v5 offset:17408
v_add_f32 v92, v92, v96
v_mfma_f32_16x16x32_bf16 v[140:143], a[100:103], a[4:7], v[140:143]
buffer_load_dwordx4 a[64:67], v2, s[40:43], s35 offen offset:0 sc1
v_mfma_f32_16x16x32_bf16 v[164:167], a[100:103], a[12:15], v[164:167]
ds_read_b128 a[132:135], v5 offset:23552
v_add_f32 v100, v100, v104
v_mfma_f32_16x16x32_bf16 v[164:167], a[96:99], a[8:11], v[164:167]
v_add_f32 v108, v108, v112
v_add_f32 v116, v116, v120
v_mfma_f32_16x16x32_bf16 v[188:191], a[96:99], a[16:19], v[188:191]
v_add_f32 v93, v93, v97
v_add_f32 v101, v101, v105
v_mfma_f32_16x16x32_bf16 v[188:191], a[100:103], a[20:23], v[188:191]
buffer_load_dwordx4 v1, s[4:7], s44 offen offset:0 sc1 lds
v_mfma_f32_16x16x32_bf16 v[212:215], a[100:103], a[28:31], v[212:215]
ds_read_b128 a[136:139], v5 offset:12288
v_add_f32 v109, v109, v113
v_mfma_f32_16x16x32_bf16 v[212:215], a[96:99], a[24:27], v[212:215]
v_add_f32 v117, v117, v121
v_add_f32 v94, v94, v98
v_mfma_f32_16x16x32_bf16 v[216:219], a[104:107], a[24:27], v[216:219]
ds_read_b128 a[140:143], v5 offset:18432
v_add_f32 v102, v102, v106
v_mfma_f32_16x16x32_bf16 v[216:219], a[108:111], a[28:31], v[216:219]
buffer_load_dwordx4 a[68:71], v2, s[40:43], s33 offen offset:0 sc1
v_mfma_f32_16x16x32_bf16 v[192:195], a[108:111], a[20:23], v[192:195]
ds_read_b128 a[144:147], v5 offset:13312
v_add_f32 v110, v110, v114
v_mfma_f32_16x16x32_bf16 v[192:195], a[104:107], a[16:19], v[192:195]
v_add_f32 v118, v118, v122
v_add_f32 v95, v95, v99
v_mfma_f32_16x16x32_bf16 v[168:171], a[104:107], a[8:11], v[168:171]
v_add_f32 v103, v103, v107
v_mfma_f32_16x16x32_bf16 v[168:171], a[108:111], a[12:15], v[168:171]
buffer_load_dwordx4 a[72:75], v2, s[40:43], s35 offen offset:1024 sc1
v_mfma_f32_16x16x32_bf16 v[144:147], a[108:111], a[4:7], v[144:147]
ds_read_b128 a[148:151], v5 offset:19456
v_add_f32 v111, v111, v115
v_mfma_f32_16x16x32_bf16 v[144:147], a[104:107], a[0:3], v[144:147]
v_add_f32 v119, v119, v123
v_add_f32_dpp v92, v92, v92 row_ror:8 row_mask:0xf bank_mask:0xf
v_mfma_f32_16x16x32_bf16 v[148:151], a[112:115], a[0:3], v[148:151]
v_add_f32_dpp v100, v100, v100 row_ror:8 row_mask:0xf bank_mask:0xf
v_mfma_f32_16x16x32_bf16 v[148:151], a[116:119], a[4:7], v[148:151]
buffer_load_dwordx4 v1, s[4:7], s44 offen offset:1024 sc1 lds
s_add_u32 m0, s18, 0x6000
v_mfma_f32_16x16x32_bf16 v[172:175], a[116:119], a[12:15], v[172:175]
s_add_u32 s44, s50, 0x282a000
v_add_f32_dpp v108, v108, v108 row_ror:8 row_mask:0xf bank_mask:0xf
v_mfma_f32_16x16x32_bf16 v[172:175], a[112:115], a[8:11], v[172:175]
v_add_f32_dpp v116, v116, v116 row_ror:8 row_mask:0xf bank_mask:0xf
v_add_f32_dpp v93, v93, v93 row_ror:8 row_mask:0xf bank_mask:0xf
v_mfma_f32_16x16x32_bf16 v[196:199], a[112:115], a[16:19], v[196:199]
v_add_f32_dpp v101, v101, v101 row_ror:8 row_mask:0xf bank_mask:0xf
v_mfma_f32_16x16x32_bf16 v[196:199], a[116:119], a[20:23], v[196:199]
buffer_load_dwordx4 a[76:79], v2, s[40:43], s33 offen offset:1024 sc1
v_mfma_f32_16x16x32_bf16 v[220:223], a[116:119], a[28:31], v[220:223]
v_add_f32_dpp v109, v109, v109 row_ror:8 row_mask:0xf bank_mask:0xf
v_add_f32_dpp v117, v117, v117 row_ror:8 row_mask:0xf bank_mask:0xf
v_mfma_f32_16x16x32_bf16 v[220:223], a[112:115], a[24:27], v[220:223]
v_add_f32_dpp v92, v94, v94 row_ror:8 row_mask:0xf bank_mask:0xc
s_waitcnt lgkmcnt(0)
v_mfma_f32_16x16x32_bf16 v[224:227], a[128:131], a[24:27], v[224:227]
ds_read_b128 a[96:99], v5 offset:26624
v_accvgpr_write_b32 a216, v48
v_mfma_f32_16x16x32_bf16 v[224:227], a[132:135], a[28:31], v[224:227]
buffer_load_dwordx4 a[80:83], v2, s[40:43], s35 offen offset:2048 sc1
v_mfma_f32_16x16x32_bf16 v[200:203], a[132:135], a[20:23], v[200:203]
ds_read_b128 a[100:103], v5 offset:32768
v_add_f32_dpp v100, v102, v102 row_ror:8 row_mask:0xf bank_mask:0xc
v_mfma_f32_16x16x32_bf16 v[200:203], a[128:131], a[16:19], v[200:203]
v_accvgpr_write_b32 a217, v49
v_add_f32_dpp v108, v110, v110 row_ror:8 row_mask:0xf bank_mask:0xc
v_mfma_f32_16x16x32_bf16 v[176:179], a[128:131], a[8:11], v[176:179]
v_add_f32_dpp v116, v118, v118 row_ror:8 row_mask:0xf bank_mask:0xc
v_add_f32_dpp v93, v95, v95 row_ror:8 row_mask:0xf bank_mask:0xc
v_mfma_f32_16x16x32_bf16 v[176:179], a[132:135], a[12:15], v[176:179]
buffer_load_dwordx4 a[84:87], v2, s[40:43], s33 offen offset:2048 sc1
v_mfma_f32_16x16x32_bf16 v[152:155], a[132:135], a[4:7], v[152:155]
ds_read_b128 a[104:107], v5 offset:27648
v_accvgpr_write_b32 a218, v50
v_mfma_f32_16x16x32_bf16 v[152:155], a[128:131], a[0:3], v[152:155]
v_add_f32_dpp v101, v103, v103 row_ror:8 row_mask:0xf bank_mask:0xc
v_add_f32_dpp v109, v111, v111 row_ror:8 row_mask:0xf bank_mask:0xc
v_mfma_f32_16x16x32_bf16 v[132:135], a[136:139], a[0:3], v[132:135]
ds_read_b128 a[108:111], v5 offset:33792
v_add_f32_dpp v117, v119, v119 row_ror:8 row_mask:0xf bank_mask:0xc
v_mfma_f32_16x16x32_bf16 v[132:135], a[140:143], a[4:7], v[132:135]
v_accvgpr_write_b32 a219, v51
v_mfma_f32_16x16x32_bf16 v[156:159], a[140:143], a[12:15], v[156:159]
buffer_load_dwordx4 v1, s[4:7], s44 offen offset:0 sc1 lds
v_mfma_f32_16x16x32_bf16 v[156:159], a[136:139], a[8:11], v[156:159]
ds_read_b128 a[112:115], v5 offset:28672
v_mfma_f32_16x16x32_bf16 v[180:183], a[136:139], a[16:19], v[180:183]
v_accvgpr_write_b32 a220, v52
v_mfma_f32_16x16x32_bf16 v[180:183], a[140:143], a[20:23], v[180:183]
ds_read_b128 a[116:119], v5 offset:34816
v_mfma_f32_16x16x32_bf16 v[204:207], a[140:143], a[28:31], v[204:207]
v_permlane32_swap_b32 v92, v93
v_mfma_f32_16x16x32_bf16 v[204:207], a[136:139], a[24:27], v[204:207]
buffer_load_dwordx4 a[88:91], v2, s[40:43], s35 offen offset:3072 sc1
v_mfma_f32_16x16x32_bf16 v[208:211], a[144:147], a[24:27], v[208:211]
v_accvgpr_write_b32 a221, v53
v_mfma_f32_16x16x32_bf16 v[208:211], a[148:151], a[28:31], v[208:211]
v_permlane32_swap_b32 v100, v101
v_mfma_f32_16x16x32_bf16 v[184:187], a[148:151], a[20:23], v[184:187]
v_accvgpr_write_b32 a222, v54
v_mfma_f32_16x16x32_bf16 v[184:187], a[144:147], a[16:19], v[184:187]
v_permlane32_swap_b32 v108, v109
v_mfma_f32_16x16x32_bf16 v[160:163], a[144:147], a[8:11], v[160:163]
buffer_load_dwordx4 a[92:95], v2, s[40:43], s33 offen offset:3072 sc1
s_add_u32 s35, s35, 0x4000
v_mfma_f32_16x16x32_bf16 v[160:163], a[148:151], a[12:15], v[160:163]
s_add_u32 s33, s33, 0x4000
v_accvgpr_write_b32 a223, v55
v_mfma_f32_16x16x32_bf16 v[136:139], a[148:151], a[4:7], v[136:139]
v_permlane32_swap_b32 v116, v117
v_mfma_f32_16x16x32_bf16 v[136:139], a[144:147], a[0:3], v[136:139]
v_add_f32 v92, v92, v93
s_waitcnt vmcnt(11) lgkmcnt(0)
v_mfma_f32_16x16x32_bf16 v[140:143], a[96:99], a[32:35], v[140:143]
ds_read_b128 a[128:131], v5 offset:29696
v_accvgpr_write_b32 a224, v56
v_mfma_f32_16x16x32_bf16 v[140:143], a[100:103], a[36:39], v[140:143]
buffer_load_dwordx4 a[0:3], v2, s[40:43], s35 offen offset:0 sc1
v_mfma_f32_16x16x32_bf16 v[164:167], a[100:103], a[44:47], v[164:167]
ds_read_b128 a[132:135], v5 offset:35840
v_add_f32 v100, v100, v101
v_mfma_f32_16x16x32_bf16 v[164:167], a[96:99], a[40:43], v[164:167]
v_accvgpr_write_b32 a225, v57
v_add_f32 v108, v108, v109
v_mfma_f32_16x16x32_bf16 v[188:191], a[96:99], a[48:51], v[188:191]
v_add_f32 v116, v116, v117
v_mov_b32 v94, v92
v_mfma_f32_16x16x32_bf16 v[188:191], a[100:103], a[52:55], v[188:191]
buffer_load_dwordx4 a[4:7], v2, s[40:43], s33 offen offset:0 sc1
v_mfma_f32_16x16x32_bf16 v[212:215], a[100:103], a[60:63], v[212:215]
ds_read_b128 a[136:139], v5 offset:24576
v_accvgpr_write_b32 a226, v58
v_mfma_f32_16x16x32_bf16 v[212:215], a[96:99], a[56:59], v[212:215]
v_mov_b32 v102, v100
v_mov_b32 v110, v108
v_mfma_f32_16x16x32_bf16 v[216:219], a[104:107], a[56:59], v[216:219]
ds_read_b128 a[140:143], v5 offset:30720
v_mov_b32 v118, v116
v_mfma_f32_16x16x32_bf16 v[216:219], a[108:111], a[60:63], v[216:219]
v_accvgpr_write_b32 a227, v59
v_mfma_f32_16x16x32_bf16 v[192:195], a[108:111], a[52:55], v[192:195]
buffer_load_dwordx4 v1, s[4:7], s44 offen offset:1024 sc1 lds
s_add_u32 m0, s18, 0x8000
v_mfma_f32_16x16x32_bf16 v[192:195], a[104:107], a[48:51], v[192:195]
s_add_u32 s44, s50, 0x282c000
ds_read_b128 a[144:147], v5 offset:25600
v_mfma_f32_16x16x32_bf16 v[168:171], a[104:107], a[40:43], v[168:171]
v_accvgpr_write_b32 a228, v60
v_mfma_f32_16x16x32_bf16 v[168:171], a[108:111], a[44:47], v[168:171]
ds_read_b128 a[148:151], v5 offset:31744
v_mfma_f32_16x16x32_bf16 v[144:147], a[108:111], a[36:39], v[144:147]
v_permlane16_swap_b32 v92, v94
v_mfma_f32_16x16x32_bf16 v[144:147], a[104:107], a[32:35], v[144:147]
buffer_load_dwordx4 a[8:11], v2, s[40:43], s35 offen offset:1024 sc1
v_mfma_f32_16x16x32_bf16 v[148:151], a[112:115], a[32:35], v[148:151]
v_accvgpr_write_b32 a229, v61
v_mfma_f32_16x16x32_bf16 v[148:151], a[116:119], a[36:39], v[148:151]
v_permlane16_swap_b32 v100, v102
v_mfma_f32_16x16x32_bf16 v[172:175], a[116:119], a[44:47], v[172:175]
v_accvgpr_write_b32 a230, v62
v_mfma_f32_16x16x32_bf16 v[172:175], a[112:115], a[40:43], v[172:175]
v_permlane16_swap_b32 v108, v110
v_mfma_f32_16x16x32_bf16 v[196:199], a[112:115], a[48:51], v[196:199]
buffer_load_dwordx4 a[12:15], v2, s[40:43], s33 offen offset:1024 sc1
v_mfma_f32_16x16x32_bf16 v[196:199], a[116:119], a[52:55], v[196:199]
v_accvgpr_write_b32 a231, v63
v_mfma_f32_16x16x32_bf16 v[220:223], a[116:119], a[60:63], v[220:223]
v_permlane16_swap_b32 v116, v118
v_mfma_f32_16x16x32_bf16 v[220:223], a[112:115], a[56:59], v[220:223]
v_add_f32 v92, v92, v94
s_waitcnt lgkmcnt(0)
v_mfma_f32_16x16x32_bf16 v[224:227], a[128:131], a[56:59], v[224:227]
ds_read_b128 a[96:99], v5 offset:38912
v_accvgpr_write_b32 a232, v64
v_mfma_f32_16x16x32_bf16 v[224:227], a[132:135], a[60:63], v[224:227]
buffer_load_dwordx4 a[16:19], v2, s[40:43], s35 offen offset:2048 sc1
v_mfma_f32_16x16x32_bf16 v[200:203], a[132:135], a[52:55], v[200:203]
ds_read_b128 a[100:103], v5 offset:45056
v_add_f32 v100, v100, v102
v_mfma_f32_16x16x32_bf16 v[200:203], a[128:131], a[48:51], v[200:203]
v_accvgpr_write_b32 a233, v65
v_add_f32 v108, v108, v110
L_stub6:
s_cbranch_execz L_stub7
v_mfma_f32_16x16x32_bf16 v[176:179], a[128:131], a[40:43], v[176:179]
v_add_f32 v116, v116, v118
v_mov_b32 v94, v92
v_mfma_f32_16x16x32_bf16 v[176:179], a[132:135], a[44:47], v[176:179]
buffer_load_dwordx4 a[20:23], v2, s[40:43], s33 offen offset:2048 sc1
v_mfma_f32_16x16x32_bf16 v[152:155], a[132:135], a[36:39], v[152:155]
ds_read_b128 a[104:107], v5 offset:39936
v_accvgpr_write_b32 a234, v66
v_mfma_f32_16x16x32_bf16 v[152:155], a[128:131], a[32:35], v[152:155]
v_mov_b32 v102, v100
v_mov_b32 v110, v108
v_mfma_f32_16x16x32_bf16 v[132:135], a[136:139], a[32:35], v[132:135]
ds_read_b128 a[108:111], v5 offset:46080
v_mov_b32 v118, v116
v_mfma_f32_16x16x32_bf16 v[132:135], a[140:143], a[36:39], v[132:135]
v_accvgpr_write_b32 a235, v67
v_mfma_f32_16x16x32_bf16 v[156:159], a[140:143], a[44:47], v[156:159]
buffer_load_dwordx4 v1, s[4:7], s44 offen offset:0 sc1 lds
v_mfma_f32_16x16x32_bf16 v[156:159], a[136:139], a[40:43], v[156:159]
ds_read_b128 a[112:115], v5 offset:40960
v_mfma_f32_16x16x32_bf16 v[180:183], a[136:139], a[48:51], v[180:183]
v_accvgpr_write_b32 a236, v68
v_mfma_f32_16x16x32_bf16 v[180:183], a[140:143], a[52:55], v[180:183]
ds_read_b128 a[116:119], v5 offset:47104
v_mfma_f32_16x16x32_bf16 v[204:207], a[140:143], a[60:63], v[204:207]
v_permlane32_swap_b32 v92, v94
v_mfma_f32_16x16x32_bf16 v[204:207], a[136:139], a[56:59], v[204:207]
buffer_load_dwordx4 a[24:27], v2, s[40:43], s35 offen offset:3072 sc1
v_mfma_f32_16x16x32_bf16 v[208:211], a[144:147], a[56:59], v[208:211]
v_accvgpr_write_b32 a237, v69
v_mfma_f32_16x16x32_bf16 v[208:211], a[148:151], a[60:63], v[208:211]
v_permlane32_swap_b32 v100, v102
v_mfma_f32_16x16x32_bf16 v[184:187], a[148:151], a[52:55], v[184:187]
v_accvgpr_write_b32 a238, v70
v_mfma_f32_16x16x32_bf16 v[184:187], a[144:147], a[48:51], v[184:187]
v_permlane32_swap_b32 v108, v110
v_mfma_f32_16x16x32_bf16 v[160:163], a[144:147], a[40:43], v[160:163]
buffer_load_dwordx4 a[28:31], v2, s[40:43], s33 offen offset:3072 sc1
s_add_u32 s35, s35, 0x4000
v_mfma_f32_16x16x32_bf16 v[160:163], a[148:151], a[44:47], v[160:163]
s_add_u32 s33, s33, 0x4000
v_accvgpr_write_b32 a239, v71
v_mfma_f32_16x16x32_bf16 v[136:139], a[148:151], a[36:39], v[136:139]
v_permlane32_swap_b32 v116, v118
v_mfma_f32_16x16x32_bf16 v[136:139], a[144:147], a[32:35], v[136:139]
v_mul_f32 v82, 0xba800000, v92
s_waitcnt vmcnt(10) lgkmcnt(0)
v_mfma_f32_16x16x32_bf16 v[140:143], a[96:99], a[64:67], v[140:143]
ds_read_b128 a[128:131], v5 offset:41984
v_mul_f32 v84, 0xba800000, v100
v_mfma_f32_16x16x32_bf16 v[140:143], a[100:103], a[68:71], v[140:143]
buffer_load_dwordx4 a[32:35], v2, s[40:43], s35 offen offset:0 sc1
v_mfma_f32_16x16x32_bf16 v[164:167], a[100:103], a[76:79], v[164:167]
ds_read_b128 a[132:135], v5 offset:48128
v_mul_f32 v86, 0xba800000, v108
v_mfma_f32_16x16x32_bf16 v[164:167], a[96:99], a[72:75], v[164:167]
v_mul_f32 v88, 0xba800000, v116
v_mul_f32 v94, 0x3a800000, v94
v_mfma_f32_16x16x32_bf16 v[188:191], a[96:99], a[80:83], v[188:191]
v_mul_f32 v102, 0x3a800000, v102
v_mul_f32 v110, 0x3a800000, v110
v_mfma_f32_16x16x32_bf16 v[188:191], a[100:103], a[84:87], v[188:191]
buffer_load_dwordx4 v1, s[4:7], s44 offen offset:1024 sc1 lds
s_add_u32 m0, s18, 0xa000
v_mfma_f32_16x16x32_bf16 v[212:215], a[100:103], a[92:95], v[212:215]
s_add_u32 s44, s50, 0x282e000
ds_read_b128 a[136:139], v5 offset:36864
v_mfma_f32_16x16x32_bf16 v[212:215], a[96:99], a[88:91], v[212:215]
v_mul_f32 v118, 0x3a800000, v118
v_fma_f32 v94, -v82, v82, v94
v_fma_f32 v102, -v84, v84, v102
v_fma_f32 v110, -v86, v86, v110
v_fma_f32 v118, -v88, v88, v118
v_max_f32 v94, 0, v94
v_max_f32 v102, 0, v102
v_max_f32 v110, 0, v110
v_max_f32 v118, 0, v118
v_add_f32 v94, 0x3727c5ac, v94
v_add_f32 v102, 0x3727c5ac, v102
v_add_f32 v110, 0x3727c5ac, v110
v_add_f32 v118, 0x3727c5ac, v118
v_rsq_f32 v83, v94
v_rsq_f32 v85, v102
v_rsq_f32 v87, v110
v_rsq_f32 v89, v118
v_mfma_f32_16x16x32_bf16 v[216:219], a[104:107], a[88:91], v[216:219]
ds_read_b128 a[140:143], v5 offset:43008
v_mfma_f32_16x16x32_bf16 v[216:219], a[108:111], a[92:95], v[216:219]
buffer_load_dwordx4 a[36:39], v2, s[40:43], s33 offen offset:0 sc1
v_mfma_f32_16x16x32_bf16 v[192:195], a[108:111], a[84:87], v[192:195]
ds_read_b128 a[144:147], v5 offset:37888
v_fmac_f32 v140, v56, v82
v_mfma_f32_16x16x32_bf16 v[192:195], a[104:107], a[80:83], v[192:195]
v_mfma_f32_16x16x32_bf16 v[168:171], a[104:107], a[72:75], v[168:171]
v_fmac_f32 v164, v56, v84
v_mfma_f32_16x16x32_bf16 v[168:171], a[108:111], a[76:79], v[168:171]
buffer_load_dwordx4 a[40:43], v2, s[40:43], s35 offen offset:1024 sc1
v_mfma_f32_16x16x32_bf16 v[144:147], a[108:111], a[68:71], v[144:147]
ds_read_b128 a[148:151], v5 offset:44032
v_fmac_f32 v188, v56, v86
v_mfma_f32_16x16x32_bf16 v[144:147], a[104:107], a[64:67], v[144:147]
v_mfma_f32_16x16x32_bf16 v[148:151], a[112:115], a[64:67], v[148:151]
v_fmac_f32 v212, v56, v88
v_mfma_f32_16x16x32_bf16 v[148:151], a[116:119], a[68:71], v[148:151]
buffer_load_dwordx4 v1, s[4:7], s44 offen offset:0 sc1 lds
v_mfma_f32_16x16x32_bf16 v[172:175], a[116:119], a[76:79], v[172:175]
v_fmac_f32 v216, v60, v88
v_mfma_f32_16x16x32_bf16 v[172:175], a[112:115], a[72:75], v[172:175]
v_mfma_f32_16x16x32_bf16 v[196:199], a[112:115], a[80:83], v[196:199]
v_fmac_f32 v192, v60, v86
v_mfma_f32_16x16x32_bf16 v[196:199], a[116:119], a[84:87], v[196:199]
buffer_load_dwordx4 a[44:47], v2, s[40:43], s33 offen offset:1024 sc1
v_mfma_f32_16x16x32_bf16 v[220:223], a[116:119], a[92:95], v[220:223]
v_fmac_f32 v168, v60, v84
v_fmac_f32 v141, v57, v82
v_mfma_f32_16x16x32_bf16 v[220:223], a[112:115], a[88:91], v[220:223]
s_waitcnt lgkmcnt(0)
s_barrier
v_mfma_f32_16x16x32_bf16 v[224:227], a[128:131], a[88:91], v[224:227]
v_add_u32 v5, 0, v1
v_fmac_f32 v144, v60, v82
v_mfma_f32_16x16x32_bf16 v[224:227], a[132:135], a[92:95], v[224:227]
buffer_load_dwordx4 a[48:51], v2, s[40:43], s35 offen offset:2048 sc1
v_mfma_f32_16x16x32_bf16 v[200:203], a[132:135], a[84:87], v[200:203]
ds_read_b128 a[96:99], v5 offset:2048
v_fmac_f32 v148, v64, v82
v_mfma_f32_16x16x32_bf16 v[200:203], a[128:131], a[80:83], v[200:203]
ds_read_b128 a[100:103], v5 offset:8192
v_fmac_f32 v165, v57, v84
v_mfma_f32_16x16x32_bf16 v[176:179], a[128:131], a[72:75], v[176:179]
v_fmac_f32 v172, v64, v84
v_fmac_f32 v189, v57, v86
v_mfma_f32_16x16x32_bf16 v[176:179], a[132:135], a[76:79], v[176:179]
buffer_load_dwordx4 a[52:55], v2, s[40:43], s33 offen offset:2048 sc1
v_mfma_f32_16x16x32_bf16 v[152:155], a[132:135], a[68:71], v[152:155]
ds_read_b128 a[104:107], v5 offset:3072
v_fmac_f32 v196, v64, v86
v_mfma_f32_16x16x32_bf16 v[152:155], a[128:131], a[64:67], v[152:155]
v_fmac_f32 v213, v57, v88
v_fmac_f32 v217, v61, v88
v_mfma_f32_16x16x32_bf16 v[132:135], a[136:139], a[64:67], v[132:135]
ds_read_b128 a[108:111], v5 offset:9216
v_fmac_f32 v220, v64, v88
v_mfma_f32_16x16x32_bf16 v[132:135], a[140:143], a[68:71], v[132:135]
v_fmac_f32 v193, v61, v86
v_mfma_f32_16x16x32_bf16 v[156:159], a[140:143], a[76:79], v[156:159]
buffer_load_dwordx4 v1, s[4:7], s44 offen offset:1024 sc1 lds
s_add_u32 m0, s19, 49152
v_mfma_f32_16x16x32_bf16 v[156:159], a[136:139], a[72:75], v[156:159]
s_xor_b32 s44, s85, 16384
ds_read_b128 a[112:115], v5 offset:4096
v_mfma_f32_16x16x32_bf16 v[180:183], a[136:139], a[80:83], v[180:183]
v_fmac_f32 v224, v68, v88
v_fmac_f32 v200, v68, v86
v_mfma_f32_16x16x32_bf16 v[180:183], a[140:143], a[84:87], v[180:183]
ds_read_b128 a[116:119], v5 offset:10240
v_fmac_f32 v169, v61, v84
v_mfma_f32_16x16x32_bf16 v[204:207], a[140:143], a[92:95], v[204:207]
v_fmac_f32 v176, v68, v84
v_fmac_f32 v145, v61, v82
v_mfma_f32_16x16x32_bf16 v[204:207], a[136:139], a[88:91], v[204:207]
buffer_load_dwordx4 a[56:59], v2, s[40:43], s35 offen offset:3072 sc1
v_mfma_f32_16x16x32_bf16 v[208:211], a[144:147], a[88:91], v[208:211]
v_fmac_f32 v152, v68, v82
v_fmac_f32 v149, v65, v82
v_mfma_f32_16x16x32_bf16 v[208:211], a[148:151], a[92:95], v[208:211]
v_fmac_f32 v173, v65, v84
v_mfma_f32_16x16x32_bf16 v[184:187], a[148:151], a[84:87], v[184:187]
v_fmac_f32 v132, v48, v82
v_fmac_f32 v197, v65, v86
v_mfma_f32_16x16x32_bf16 v[184:187], a[144:147], a[80:83], v[184:187]
v_mfma_f32_16x16x32_bf16 v[160:163], a[144:147], a[72:75], v[160:163]
buffer_load_dwordx4 a[60:63], v2, s[40:43], s33 offen offset:3072 sc1
s_add_u32 s35, s35, 0x4000
v_mfma_f32_16x16x32_bf16 v[160:163], a[148:151], a[76:79], v[160:163]
s_add_u32 s33, s33, 0x4000
v_fmac_f32 v156, v48, v84
v_mfma_f32_16x16x32_bf16 v[136:139], a[148:151], a[68:71], v[136:139]
v_fmac_f32 v180, v48, v86
v_fmac_f32 v221, v65, v88
v_mfma_f32_16x16x32_bf16 v[136:139], a[144:147], a[64:67], v[136:139]
v_fmac_f32 v225, v69, v88
s_waitcnt vmcnt(11) lgkmcnt(0)
v_mfma_f32_16x16x32_bf16 v[140:143], a[96:99], a[0:3], v[140:143]
ds_read_b128 a[128:131], v5 offset:5120
v_fmac_f32 v204, v48, v88
v_mfma_f32_16x16x32_bf16 v[140:143], a[100:103], a[4:7], v[140:143]
buffer_load_dwordx4 a[64:67], v2, s[40:43], s35 offen offset:0 sc1
s_lshl_b32 s36, s28, 9
v_mfma_f32_16x16x32_bf16 v[164:167], a[100:103], a[12:15], v[164:167]
ds_read_b128 a[132:135], v5 offset:11264
v_fmac_f32 v208, v52, v88
v_mfma_f32_16x16x32_bf16 v[164:167], a[96:99], a[8:11], v[164:167]
v_fmac_f32 v201, v69, v86
v_fmac_f32 v177, v69, v84
v_mfma_f32_16x16x32_bf16 v[188:191], a[96:99], a[16:19], v[188:191]
v_fmac_f32 v184, v52, v86
v_fmac_f32 v153, v69, v82
v_mfma_f32_16x16x32_bf16 v[188:191], a[100:103], a[20:23], v[188:191]
buffer_load_dwordx4 a[68:71], v2, s[40:43], s33 offen offset:0 sc1
s_lshl_b32 s37, s30, 2
v_mfma_f32_16x16x32_bf16 v[212:215], a[100:103], a[28:31], v[212:215]
ds_read_b128 a[136:139], v5 offset:0
v_fmac_f32 v160, v52, v84
v_mfma_f32_16x16x32_bf16 v[212:215], a[96:99], a[24:27], v[212:215]
v_fmac_f32 v133, v49, v82
s_add_u32 s37, s37, s28
v_mfma_f32_16x16x32_bf16 v[216:219], a[104:107], a[24:27], v[216:219]
ds_read_b128 a[140:143], v5 offset:6144
v_fmac_f32 v136, v52, v82
v_mfma_f32_16x16x32_bf16 v[216:219], a[108:111], a[28:31], v[216:219]
buffer_load_dwordx4 a[72:75], v2, s[40:43], s35 offen offset:1024 sc1
s_lshr_b32 s98, s37, 1
v_mfma_f32_16x16x32_bf16 v[192:195], a[108:111], a[20:23], v[192:195]
ds_read_b128 a[144:147], v5 offset:1024
v_fmac_f32 v157, v49, v84
v_mfma_f32_16x16x32_bf16 v[192:195], a[104:107], a[16:19], v[192:195]
v_fmac_f32 v181, v49, v86
v_fmac_f32 v142, v58, v82
v_mfma_f32_16x16x32_bf16 v[168:171], a[104:107], a[8:11], v[168:171]
v_fmac_f32 v205, v49, v88
v_fmac_f32 v166, v58, v84
v_mfma_f32_16x16x32_bf16 v[168:171], a[108:111], a[12:15], v[168:171]
buffer_load_dwordx4 a[76:79], v2, s[40:43], s33 offen offset:1024 sc1
s_lshl_b32 s98, s98, 14
v_mfma_f32_16x16x32_bf16 v[144:147], a[108:111], a[4:7], v[144:147]
ds_read_b128 a[148:151], v5 offset:7168
v_fmac_f32 v209, v53, v88
v_mfma_f32_16x16x32_bf16 v[144:147], a[104:107], a[0:3], v[144:147]
v_fmac_f32 v190, v58, v86
s_and_b32 s99, s19, 0x1000
v_mfma_f32_16x16x32_bf16 v[148:151], a[112:115], a[0:3], v[148:151]
v_fmac_f32 v185, v53, v86
v_fmac_f32 v214, v58, v88
v_mfma_f32_16x16x32_bf16 v[148:151], a[116:119], a[4:7], v[148:151]
buffer_load_dwordx4 a[80:83], v2, s[40:43], s35 offen offset:2048 sc1
s_add_u32 s98, s98, s99
v_mfma_f32_16x16x32_bf16 v[172:175], a[116:119], a[12:15], v[172:175]
v_fmac_f32 v161, v53, v84
v_fmac_f32 v218, v62, v88
v_mfma_f32_16x16x32_bf16 v[172:175], a[112:115], a[8:11], v[172:175]
v_add_u32 v232, s19, v7
s_bfe_u32 s90, s51, 0x10005
v_mfma_f32_16x16x32_bf16 v[196:199], a[112:115], a[16:19], v[196:199]
v_fmac_f32 v137, v53, v82
v_fmac_f32 v194, v62, v86
v_mfma_f32_16x16x32_bf16 v[196:199], a[116:119], a[20:23], v[196:199]
buffer_load_dwordx4 a[84:87], v2, s[40:43], s33 offen offset:2048 sc1
s_lshl_b32 s90, s90, 13
v_mfma_f32_16x16x32_bf16 v[220:223], a[116:119], a[28:31], v[220:223]
v_fmac_f32 v170, v62, v84
v_fmac_f32 v143, v59, v82
v_mfma_f32_16x16x32_bf16 v[220:223], a[112:115], a[24:27], v[220:223]
s_add_u32 s98, s98, s90
s_waitcnt lgkmcnt(0)
v_mfma_f32_16x16x32_bf16 v[224:227], a[128:131], a[24:27], v[224:227]
ds_read_b128 a[96:99], v5 offset:14336
v_fmac_f32 v146, v62, v82
v_mfma_f32_16x16x32_bf16 v[224:227], a[132:135], a[28:31], v[224:227]
buffer_load_dwordx4 a[88:91], v2, s[40:43], s35 offen offset:3072 sc1
s_add_u32 s98, s98, 0x1400000
v_mfma_f32_16x16x32_bf16 v[200:203], a[132:135], a[20:23], v[200:203]
ds_read_b128 a[100:103], v5 offset:20480
v_fmac_f32 v150, v66, v82
v_mfma_f32_16x16x32_bf16 v[200:203], a[128:131], a[16:19], v[200:203]
v_fmac_f32 v167, v59, v84
v_fmac_f32 v191, v59, v86
v_mfma_f32_16x16x32_bf16 v[176:179], a[128:131], a[8:11], v[176:179]
v_fmac_f32 v174, v66, v84
v_fmac_f32 v215, v59, v88
v_mfma_f32_16x16x32_bf16 v[176:179], a[132:135], a[12:15], v[176:179]
ds_read_b128 a[104:107], v5 offset:15360
s_xor_b32 s99, s98, 0x2000
v_mfma_f32_16x16x32_bf16 v[152:155], a[132:135], a[4:7], v[152:155]
v_fmac_f32 v198, v66, v86
v_fmac_f32 v219, v63, v88
v_mfma_f32_16x16x32_bf16 v[152:155], a[128:131], a[0:3], v[152:155]
buffer_load_dwordx4 v1, s[4:7], s44 offen offset:0 sc1 lds
s_and_b32 s91, s29, 4
v_mfma_f32_16x16x32_bf16 v[132:135], a[136:139], a[0:3], v[132:135]
ds_read_b128 a[108:111], v5 offset:21504
v_fmac_f32 v222, v66, v88
v_mfma_f32_16x16x32_bf16 v[132:135], a[140:143], a[4:7], v[132:135]
v_fmac_f32 v195, v63, v86
s_lshl_b32 s91, s91, 11
v_mfma_f32_16x16x32_bf16 v[156:159], a[140:143], a[12:15], v[156:159]
ds_read_b128 a[112:115], v5 offset:16384
v_fmac_f32 v226, v70, v88
v_mfma_f32_16x16x32_bf16 v[156:159], a[136:139], a[8:11], v[156:159]
v_fmac_f32 v171, v63, v84
s_xor_b32 s96, s98, s91
v_mfma_f32_16x16x32_bf16 v[180:183], a[136:139], a[16:19], v[180:183]
v_fmac_f32 v202, v70, v86
v_fmac_f32 v147, v63, v82
v_mfma_f32_16x16x32_bf16 v[180:183], a[140:143], a[20:23], v[180:183]
buffer_load_dwordx4 a[92:95], v2, s[40:43], s33 offen offset:3072 sc1
s_add_u32 s35, s35, 0x4000
v_mfma_f32_16x16x32_bf16 v[204:207], a[140:143], a[28:31], v[204:207]
s_add_u32 s33, s33, 0x4000
ds_read_b128 a[116:119], v5 offset:22528
v_mfma_f32_16x16x32_bf16 v[204:207], a[136:139], a[24:27], v[204:207]
v_fmac_f32 v178, v70, v84
v_fmac_f32 v151, v67, v82
v_mfma_f32_16x16x32_bf16 v[208:211], a[144:147], a[24:27], v[208:211]
v_fmac_f32 v154, v70, v82
v_fmac_f32 v175, v67, v84
v_mfma_f32_16x16x32_bf16 v[208:211], a[148:151], a[28:31], v[208:211]
s_lshl_b32 s97, s81, 10
s_add_u32 s96, s96, s97
s_lshr_b32 s100, s37, 4
v_mfma_f32_16x16x32_bf16 v[184:187], a[148:151], a[20:23], v[184:187]
v_fmac_f32 v134, v50, v82
v_fmac_f32 v199, v67, v86
v_mfma_f32_16x16x32_bf16 v[184:187], a[144:147], a[16:19], v[184:187]
buffer_load_dwordx4 v1, s[4:7], s44 offen offset:1024 sc1 lds
s_lshl_b32 s100, s100, 14
v_mfma_f32_16x16x32_bf16 v[160:163], a[144:147], a[8:11], v[160:163]
v_fmac_f32 v158, v50, v84
v_fmac_f32 v223, v67, v88
v_mfma_f32_16x16x32_bf16 v[160:163], a[148:151], a[12:15], v[160:163]
s_and_b32 s37, s37, 15
s_lshl_b32 s37, s37, 9
s_add_u32 s100, s100, s37
v_mfma_f32_16x16x32_bf16 v[136:139], a[148:151], a[4:7], v[136:139]
v_fmac_f32 v182, v50, v86
v_fmac_f32 v227, v71, v88
v_mfma_f32_16x16x32_bf16 v[136:139], a[144:147], a[0:3], v[136:139]
s_waitcnt vmcnt(10) lgkmcnt(0)
s_barrier
v_mfma_f32_16x16x32_bf16 v[140:143], a[96:99], a[32:35], v[140:143]
ds_read_b128 a[128:131], v5 offset:17408
v_fmac_f32 v206, v50, v88
v_mfma_f32_16x16x32_bf16 v[140:143], a[100:103], a[36:39], v[140:143]
buffer_load_dwordx4 a[0:3], v2, s[40:43], s35 offen offset:0 sc1
s_add_u32 s100, s100, 0x240000
v_mfma_f32_16x16x32_bf16 v[164:167], a[100:103], a[44:47], v[164:167]
ds_read_b128 a[132:135], v5 offset:23552
v_fmac_f32 v210, v54, v88
v_mfma_f32_16x16x32_bf16 v[164:167], a[96:99], a[40:43], v[164:167]
v_fmac_f32 v203, v71, v86
v_fmac_f32 v179, v71, v84
v_mfma_f32_16x16x32_bf16 v[188:191], a[96:99], a[48:51], v[188:191]
buffer_load_dwordx4 a[4:7], v2, s[40:43], s33 offen offset:0 sc1
s_xor_b32 s90, s91, s79
v_mfma_f32_16x16x32_bf16 v[188:191], a[100:103], a[52:55], v[188:191]
ds_read_b128 a[136:139], v5 offset:26624
v_fmac_f32 v186, v54, v86
v_mfma_f32_16x16x32_bf16 v[212:215], a[100:103], a[60:63], v[212:215]
v_fmac_f32 v162, v54, v84
v_fmac_f32 v155, v71, v82
v_mfma_f32_16x16x32_bf16 v[212:215], a[96:99], a[56:59], v[212:215]
buffer_load_dwordx4 a[8:11], v2, s[40:43], s35 offen offset:1024 sc1
s_lshl_b32 s97, s81, 7
v_mfma_f32_16x16x32_bf16 v[216:219], a[104:107], a[56:59], v[216:219]
ds_read_b128 a[140:143], v5 offset:32768
v_fmac_f32 v138, v54, v82
v_mfma_f32_16x16x32_bf16 v[216:219], a[108:111], a[60:63], v[216:219]
v_fmac_f32 v135, v51, v82
v_fmac_f32 v159, v51, v84
v_mfma_f32_16x16x32_bf16 v[192:195], a[108:111], a[52:55], v[192:195]
buffer_load_dwordx4 a[12:15], v2, s[40:43], s33 offen offset:1024 sc1
s_add_u32 s97, s97, s79
v_mfma_f32_16x16x32_bf16 v[192:195], a[104:107], a[48:51], v[192:195]
ds_read_b128 a[144:147], v5 offset:27648
v_fmac_f32 v183, v51, v86
v_mfma_f32_16x16x32_bf16 v[168:171], a[104:107], a[40:43], v[168:171]
v_fmac_f32 v207, v51, v88
s_add_u32 s97, s97, s100
v_mfma_f32_16x16x32_bf16 v[168:171], a[108:111], a[44:47], v[168:171]
buffer_load_dwordx4 a[16:19], v2, s[40:43], s35 offen offset:2048 sc1
s_lshr_b32 s37, s30, 2
v_mfma_f32_16x16x32_bf16 v[144:147], a[108:111], a[36:39], v[144:147]
ds_read_b128 a[148:151], v5 offset:33792
v_fmac_f32 v211, v55, v88
v_mfma_f32_16x16x32_bf16 v[144:147], a[104:107], a[32:35], v[144:147]
s_xor_b32 s37, s37, s51
s_and_b32 s37, s37, 1
s_lshr_b32 s89, s29, 2
v_mfma_f32_16x16x32_bf16 v[148:151], a[112:115], a[32:35], v[148:151]
buffer_load_dwordx4 a[20:23], v2, s[40:43], s33 offen offset:2048 sc1
s_xor_b32 s89, s89, s37
v_mfma_f32_16x16x32_bf16 v[148:151], a[116:119], a[36:39], v[148:151]
v_fmac_f32 v187, v55, v86
s_lshl_b32 s88, s28, 6
v_mfma_f32_16x16x32_bf16 v[172:175], a[116:119], a[44:47], v[172:175]
v_fmac_f32 v163, v55, v84
v_mul_f32 v86, 0x3fb8aa3b, v87
v_mfma_f32_16x16x32_bf16 v[172:175], a[112:115], a[40:43], v[172:175]
buffer_load_dwordx4 a[24:27], v2, s[40:43], s35 offen offset:3072 sc1
s_add_u32 s94, s80, s88
v_mfma_f32_16x16x32_bf16 v[196:199], a[112:115], a[48:51], v[196:199]
v_fmac_f32 v139, v55, v82
v_mul_f32 v84, 0x3fb8aa3b, v85
v_mfma_f32_16x16x32_bf16 v[196:199], a[116:119], a[52:55], v[196:199]
v_mul_f32 v82, 0x3fb8aa3b, v83
s_add_u32 s94, s94, 0x80000
v_mfma_f32_16x16x32_bf16 v[220:223], a[116:119], a[60:63], v[220:223]
buffer_load_dwordx4 a[28:31], v2, s[40:43], s33 offen offset:3072 sc1
s_add_u32 s35, s35, 0x64000
v_mfma_f32_16x16x32_bf16 v[220:223], a[112:115], a[56:59], v[220:223]
s_add_u32 s33, s33, 0x64000
s_waitcnt lgkmcnt(0)
v_mfma_f32_16x16x32_bf16 v[224:227], a[128:131], a[56:59], v[224:227]
ds_read_b128 a[96:99], v5 offset:28672
s_mul_i32 s89, s89, 0x102000
v_mfma_f32_16x16x32_bf16 v[224:227], a[132:135], a[60:63], v[224:227]
buffer_load_dwordx4 v1, s[4:7], s44 offen offset:2048 sc1 lds
s_add_u32 s88, s88, s70
v_mfma_f32_16x16x32_bf16 v[200:203], a[132:135], a[52:55], v[200:203]
ds_read_b128 a[100:103], v5 offset:34816
v_mul_f32 v88, 0x3fb8aa3b, v89
v_mfma_f32_16x16x32_bf16 v[200:203], a[128:131], a[48:51], v[200:203]
s_add_u32 s88, s88, s89
s_add_u32 s89, s88, 0x80000
s_add_u32 s74, s71, 0x10080
v_mfma_f32_16x16x32_bf16 v[176:179], a[128:131], a[40:43], v[176:179]
s_add_u32 s72, s76, 0xc00000
s_add_u32 s73, s75, 0x800000
s_lshr_b32 s38, s28, 1
v_mfma_f32_16x16x32_bf16 v[176:179], a[132:135], a[44:47], v[176:179]
ds_read_b128 a[104:107], v5 offset:29696
s_and_b32 s39, s28, 1
v_mfma_f32_16x16x32_bf16 v[152:155], a[132:135], a[36:39], v[152:155]
s_mul_i32 s38, s38, 3072
s_lshl_b32 s39, s39, 3
s_add_u32 s38, s38, s39
v_mfma_f32_16x16x32_bf16 v[152:155], a[128:131], a[32:35], v[152:155]
s_add_u32 s91, s83, 0x280000
v_add_u32 v233, s19, v232
s_waitcnt vmcnt(18)
v_mfma_f32_16x16x32_bf16 v[140:143], a[136:139], a[64:67], v[140:143]
ds_read_b128 a[108:111], v5 offset:35840
v_and_b32 v248, 4, v0
s_waitcnt vmcnt(17)
v_mfma_f32_16x16x32_bf16 v[140:143], a[140:143], a[68:71], v[140:143]
v_lshlrev_b32 v248, 11, v248
v_bfe_u32 v235, v0, 2, 1
s_waitcnt vmcnt(15)
v_mfma_f32_16x16x32_bf16 v[164:167], a[140:143], a[76:79], v[164:167]
ds_read_b128 a[112:115], v5 offset:38912
v_xor_b32 v248, s90, v248
v_mfma_f32_16x16x32_bf16 v[164:167], a[136:139], a[72:75], v[164:167]
v_and_b32 v249, 3, v0
v_xor_b32 v235, s37, v235
s_waitcnt vmcnt(14)
v_mfma_f32_16x16x32_bf16 v[188:191], a[136:139], a[80:83], v[188:191]
v_lshl_add_u32 v248, v249, 7, v248
v_mul_u32_u24 v235, 4128, v235
s_waitcnt vmcnt(13)
v_mfma_f32_16x16x32_bf16 v[188:191], a[140:143], a[84:87], v[188:191]
buffer_load_dwordx4 v1, s[4:7], s44 offen offset:3072 sc1 lds
s_add_u32 m0, s19, 65536
s_waitcnt vmcnt(11)
v_mfma_f32_16x16x32_bf16 v[212:215], a[140:143], a[92:95], v[212:215]
s_xor_b32 s44, s85, 32768
ds_read_b128 a[116:119], v5 offset:45056
v_mfma_f32_16x16x32_bf16 v[212:215], a[136:139], a[88:91], v[212:215]
v_lshrrev_b32 v249, 4, v0
v_add_lshl_u32 v235, v235, v0, 8
v_mfma_f32_16x16x32_bf16 v[216:219], a[144:147], a[88:91], v[216:219]
v_lshl_add_u32 v248, v249, 4, v248
v_add_u32 v234, s36, v8
v_mfma_f32_16x16x32_bf16 v[216:219], a[148:151], a[92:95], v[216:219]
v_cndmask_b32 v235, 2.0, v235, s[64:65]
v_mov_b32 v249, 0x3f80
v_mfma_f32_16x16x32_bf16 v[192:195], a[148:151], a[84:87], v[192:195]
v_mov_b32 v250, 1.0
v_add_u32 v252, s38, v1
v_mfma_f32_16x16x32_bf16 v[192:195], a[144:147], a[80:83], v[192:195]
v_mfma_f32_16x16x32_bf16 v[168:171], a[144:147], a[72:75], v[168:171]
v_mfma_f32_16x16x32_bf16 v[168:171], a[148:151], a[76:79], v[168:171]
v_mfma_f32_16x16x32_bf16 v[144:147], a[148:151], a[68:71], v[144:147]
v_mfma_f32_16x16x32_bf16 v[144:147], a[144:147], a[64:67], v[144:147]
s_waitcnt lgkmcnt(0)
v_mfma_f32_16x16x32_bf16 v[148:151], a[96:99], a[64:67], v[148:151]
ds_read_b128 a[128:131], v5 offset:39936
v_mfma_f32_16x16x32_bf16 v[148:151], a[100:103], a[68:71], v[148:151]
buffer_load_dwordx4 v1, s[4:7], s44 offen offset:0 sc1 lds
v_mfma_f32_16x16x32_bf16 v[172:175], a[100:103], a[76:79], v[172:175]
ds_read_b128 a[132:135], v5 offset:46080
v_mfma_f32_16x16x32_bf16 v[172:175], a[96:99], a[72:75], v[172:175]
v_mfma_f32_16x16x32_bf16 v[196:199], a[96:99], a[80:83], v[196:199]
v_mfma_f32_16x16x32_bf16 v[196:199], a[100:103], a[84:87], v[196:199]
buffer_load_dwordx4 v1, s[4:7], s44 offen offset:1024 sc1 lds
v_mfma_f32_16x16x32_bf16 v[220:223], a[100:103], a[92:95], v[220:223]
ds_read_b128 a[136:139], v5 offset:40960
v_mfma_f32_16x16x32_bf16 v[220:223], a[96:99], a[88:91], v[220:223]
v_mfma_f32_16x16x32_bf16 v[224:227], a[104:107], a[88:91], v[224:227]
ds_read_b128 a[140:143], v5 offset:47104
v_mfma_f32_16x16x32_bf16 v[224:227], a[108:111], a[92:95], v[224:227]
v_mfma_f32_16x16x32_bf16 v[200:203], a[108:111], a[84:87], v[200:203]
buffer_load_dwordx4 v1, s[4:7], s44 offen offset:2048 sc1 lds
v_mfma_f32_16x16x32_bf16 v[200:203], a[104:107], a[80:83], v[200:203]
ds_read_b128 a[144:147], v5 offset:41984
v_mfma_f32_16x16x32_bf16 v[176:179], a[104:107], a[72:75], v[176:179]
v_mfma_f32_16x16x32_bf16 v[176:179], a[108:111], a[76:79], v[176:179]
ds_read_b128 a[148:151], v5 offset:48128
v_mfma_f32_16x16x32_bf16 v[152:155], a[108:111], a[68:71], v[152:155]
v_mfma_f32_16x16x32_bf16 v[152:155], a[104:107], a[64:67], v[152:155]
buffer_load_dwordx4 v1, s[4:7], s44 offen offset:3072 sc1 lds
s_add_u32 m0, s19, 81920
s_waitcnt vmcnt(13)
v_mfma_f32_16x16x32_bf16 v[140:143], a[112:115], a[0:3], v[140:143]
s_xor_b32 s44, s85, 49152
s_waitcnt vmcnt(12)
v_mfma_f32_16x16x32_bf16 v[140:143], a[116:119], a[4:7], v[140:143]
s_waitcnt vmcnt(10)
v_mfma_f32_16x16x32_bf16 v[164:167], a[116:119], a[12:15], v[164:167]
v_mfma_f32_16x16x32_bf16 v[164:167], a[112:115], a[8:11], v[164:167]
s_waitcnt vmcnt(9)
v_mfma_f32_16x16x32_bf16 v[188:191], a[112:115], a[16:19], v[188:191]
buffer_load_dwordx4 v1, s[4:7], s44 offen offset:0 sc1 lds
s_waitcnt vmcnt(9)
v_mfma_f32_16x16x32_bf16 v[188:191], a[116:119], a[20:23], v[188:191]
s_waitcnt vmcnt(7)
v_mfma_f32_16x16x32_bf16 v[212:215], a[116:119], a[28:31], v[212:215]
v_mfma_f32_16x16x32_bf16 v[212:215], a[112:115], a[24:27], v[212:215]
s_waitcnt lgkmcnt(0)
v_mfma_f32_16x16x32_bf16 v[216:219], a[128:131], a[24:27], v[216:219]
ds_read_b128 a[96:99], v5 offset:12288
v_cvt_pk_bf16_f32 v140, v140, v141
v_mfma_f32_16x16x32_bf16 v[216:219], a[132:135], a[28:31], v[216:219]
buffer_load_dwordx4 v1, s[4:7], s44 offen offset:1024 sc1 lds
v_mfma_f32_16x16x32_bf16 v[192:195], a[132:135], a[20:23], v[192:195]
ds_read_b128 a[100:103], v5 offset:18432
v_cvt_pk_bf16_f32 v141, v142, v143
v_mfma_f32_16x16x32_bf16 v[192:195], a[128:131], a[16:19], v[192:195]
v_cvt_pk_bf16_f32 v164, v164, v165
v_cvt_pk_bf16_f32 v165, v166, v167
v_mfma_f32_16x16x32_bf16 v[168:171], a[128:131], a[8:11], v[168:171]
v_cvt_pk_bf16_f32 v188, v188, v189
v_cvt_pk_bf16_f32 v189, v190, v191
v_mfma_f32_16x16x32_bf16 v[168:171], a[132:135], a[12:15], v[168:171]
buffer_load_dwordx4 v1, s[4:7], s44 offen offset:2048 sc1 lds
v_mfma_f32_16x16x32_bf16 v[144:147], a[132:135], a[4:7], v[144:147]
ds_read_b128 a[104:107], v5 offset:24576
v_cvt_pk_bf16_f32 v212, v212, v213
v_mfma_f32_16x16x32_bf16 v[144:147], a[128:131], a[0:3], v[144:147]
v_cvt_pk_bf16_f32 v213, v214, v215
v_mfma_f32_16x16x32_bf16 v[148:151], a[136:139], a[0:3], v[148:151]
ds_read_b128 a[108:111], v5 offset:30720
v_cvt_pk_bf16_f32 v214, v216, v217
v_mfma_f32_16x16x32_bf16 v[148:151], a[140:143], a[4:7], v[148:151]
v_cvt_pk_bf16_f32 v215, v218, v219
v_mfma_f32_16x16x32_bf16 v[172:175], a[140:143], a[12:15], v[172:175]
buffer_load_dwordx4 v1, s[4:7], s44 offen offset:3072 sc1 lds
s_add_u32 m0, s19, 147456
v_mfma_f32_16x16x32_bf16 v[172:175], a[136:139], a[8:11], v[172:175]
s_xor_b32 s44, s85, 114688
ds_read_b128 a[112:115], v5 offset:36864
v_mfma_f32_16x16x32_bf16 v[196:199], a[136:139], a[16:19], v[196:199]
v_cvt_pk_bf16_f32 v166, v168, v169
v_cvt_pk_bf16_f32 v167, v170, v171
v_mfma_f32_16x16x32_bf16 v[196:199], a[140:143], a[20:23], v[196:199]
ds_read_b128 a[116:119], v5 offset:43008
v_cvt_pk_bf16_f32 v190, v192, v193
v_mfma_f32_16x16x32_bf16 v[220:223], a[140:143], a[28:31], v[220:223]
v_cvt_pk_bf16_f32 v142, v144, v145
v_cvt_pk_bf16_f32 v143, v146, v147
v_mfma_f32_16x16x32_bf16 v[220:223], a[136:139], a[24:27], v[220:223]
buffer_load_dwordx4 v1, s[4:7], s44 offen offset:0 sc1 lds
v_mfma_f32_16x16x32_bf16 v[224:227], a[144:147], a[24:27], v[224:227]
v_mfma_f32_16x16x32_bf16 v[92:95], a[240:243], v[140:143], 0
v_mfma_f32_16x16x32_bf16 v[224:227], a[148:151], a[28:31], v[224:227]
v_mfma_f32_16x16x32_bf16 v[96:99], a[244:247], v[140:143], 0
v_mfma_f32_16x16x32_bf16 v[200:203], a[148:151], a[20:23], v[200:203]
v_mfma_f32_16x16x32_bf16 v[100:103], a[240:243], v[164:167], 0
v_mfma_f32_16x16x32_bf16 v[200:203], a[144:147], a[16:19], v[200:203]
v_mfma_f32_16x16x32_bf16 v[104:107], a[244:247], v[164:167], 0
v_mfma_f32_16x16x32_bf16 v[176:179], a[144:147], a[8:11], v[176:179]
buffer_load_dwordx4 v1, s[4:7], s44 offen offset:1024 sc1 lds
v_mfma_f32_16x16x32_bf16 v[176:179], a[148:151], a[12:15], v[176:179]
v_max3_f32 v236, v92, v93, v94
v_max3_f32 v237, -v92, -v93, -v94
v_mfma_f32_16x16x32_bf16 v[152:155], a[148:151], a[4:7], v[152:155]
v_max3_f32 v236, v236, v95, v96
v_max3_f32 v237, v237, -v95, -v96
v_mfma_f32_16x16x32_bf16 v[152:155], a[144:147], a[0:3], v[152:155]
v_max3_f32 v236, v236, v97, v98
s_waitcnt lgkmcnt(0)
v_mfma_f32_16x16x32_bf16 v[132:135], a[96:99], a[32:35], v[132:135]
ds_read_b128 a[128:131], v5 offset:13312
v_max3_f32 v237, v237, -v97, -v98
v_mfma_f32_16x16x32_bf16 v[132:135], a[100:103], a[36:39], v[132:135]
buffer_load_dwordx4 v1, s[4:7], s44 offen offset:2048 sc1 lds
v_mfma_f32_16x16x32_bf16 v[156:159], a[100:103], a[44:47], v[156:159]
ds_read_b128 a[132:135], v5 offset:19456
v_max_f32 v236, v236, v99
v_mfma_f32_16x16x32_bf16 v[156:159], a[96:99], a[40:43], v[156:159]
v_max_f32_e64 v237, v237, -v99
v_max3_f32 v238, v100, v101, v102
v_mfma_f32_16x16x32_bf16 v[180:183], a[96:99], a[48:51], v[180:183]
v_permlane32_swap_b32 v236, v237
v_mfma_f32_16x16x32_bf16 v[180:183], a[100:103], a[52:55], v[180:183]
buffer_load_dwordx4 v1, s[4:7], s44 offen offset:3072 sc1 lds
s_add_u32 m0, s19, 98304
v_mfma_f32_16x16x32_bf16 v[204:207], a[100:103], a[60:63], v[204:207]
s_xor_b32 s44, s85, 65536
ds_read_b128 a[136:139], v5 offset:25600
v_mfma_f32_16x16x32_bf16 v[204:207], a[96:99], a[56:59], v[204:207]
v_max_f32 v236, v236, v237
v_mov_b32 v244, v236
v_mfma_f32_16x16x32_bf16 v[204:207], a[104:107], a[88:91], v[204:207]
ds_read_b128 a[140:143], v5 offset:31744
v_max3_f32 v239, -v100, -v101, -v102
L_stub7:
s_cbranch_execz L_wret2
v_mfma_f32_16x16x32_bf16 v[204:207], a[108:111], a[92:95], v[204:207]
v_permlane16_swap_b32 v236, v244
v_mfma_f32_16x16x32_bf16 v[180:183], a[108:111], a[84:87], v[180:183]
buffer_load_dwordx4 v1, s[4:7], s44 offen offset:0 sc1 lds
v_mfma_f32_16x16x32_bf16 v[180:183], a[104:107], a[80:83], v[180:183]
ds_read_b128 a[144:147], v5 offset:37888
v_max_f32 v236, v236, v244
v_mfma_f32_16x16x32_bf16 v[156:159], a[104:107], a[72:75], v[156:159]
v_mov_b32 v244, v236
v_max3_f32 v238, v238, v103, v104
v_mfma_f32_16x16x32_bf16 v[156:159], a[108:111], a[76:79], v[156:159]
ds_read_b128 a[148:151], v5 offset:44032
v_max3_f32 v239, v239, -v103, -v104
v_mfma_f32_16x16x32_bf16 v[132:135], a[108:111], a[68:71], v[132:135]
v_permlane32_swap_b32 v236, v244
v_mfma_f32_16x16x32_bf16 v[132:135], a[104:107], a[64:67], v[132:135]
buffer_load_dwordx4 v1, s[4:7], s44 offen offset:1024 sc1 lds
v_mfma_f32_16x16x32_bf16 v[132:135], a[112:115], a[0:3], v[132:135]
v_mul_f32_e64 v236, -v236, v82
v_mul_f32_e64 v237, -v244, v82
v_mfma_f32_16x16x32_bf16 v[132:135], a[116:119], a[4:7], v[132:135]
v_max3_f32 v238, v238, v105, v106
v_max3_f32 v239, v239, -v105, -v106
v_mfma_f32_16x16x32_bf16 v[156:159], a[116:119], a[12:15], v[156:159]
v_max_f32 v238, v238, v107
v_max_f32_e64 v239, v239, -v107
v_mfma_f32_16x16x32_bf16 v[156:159], a[112:115], a[8:11], v[156:159]
s_nop 0
v_permlane32_swap_b32 v238, v239
v_mfma_f32_16x16x32_bf16 v[180:183], a[112:115], a[16:19], v[180:183]
buffer_load_dwordx4 v1, s[4:7], s44 offen offset:2048 sc1 lds
v_mfma_f32_16x16x32_bf16 v[180:183], a[116:119], a[20:23], v[180:183]
v_max_f32 v238, v238, v239
v_mov_b32 v245, v238
v_mfma_f32_16x16x32_bf16 v[204:207], a[116:119], a[28:31], v[204:207]
s_nop 0
v_permlane16_swap_b32 v238, v245
v_mfma_f32_16x16x32_bf16 v[204:207], a[112:115], a[24:27], v[204:207]
s_waitcnt lgkmcnt(0)
s_barrier
v_mfma_f32_16x16x32_bf16 v[208:211], a[128:131], a[56:59], v[208:211]
v_max_f32 v238, v238, v245
v_mov_b32 v245, v238
v_mfma_f32_16x16x32_bf16 v[208:211], a[132:135], a[60:63], v[208:211]
buffer_load_dwordx4 v1, s[4:7], s44 offen offset:3072 sc1 lds
s_add_u32 m0, s19, 114688
v_mfma_f32_16x16x32_bf16 v[184:187], a[132:135], a[52:55], v[184:187]
s_xor_b32 s44, s85, 81920
v_cvt_pk_bf16_f32 v191, v194, v195
v_mfma_f32_16x16x32_bf16 v[184:187], a[128:131], a[48:51], v[184:187]
v_permlane32_swap_b32 v238, v245
v_mfma_f32_16x16x32_bf16 v[160:163], a[128:131], a[40:43], v[160:163]
v_mul_f32_e64 v238, -v238, v84
v_mul_f32_e64 v239, -v245, v84
v_mfma_f32_16x16x32_bf16 v[160:163], a[132:135], a[44:47], v[160:163]
buffer_load_dwordx4 v1, s[4:7], s44 offen offset:0 sc1 lds
v_mfma_f32_16x16x32_bf16 v[136:139], a[132:135], a[36:39], v[136:139]
v_mfma_f32_16x16x32_bf16 v[108:111], a[240:243], v[188:191], 0
v_mfma_f32_16x16x32_bf16 v[136:139], a[128:131], a[32:35], v[136:139]
v_mfma_f32_16x16x32_bf16 v[112:115], a[244:247], v[188:191], 0
v_mfma_f32_16x16x32_bf16 v[136:139], a[136:139], a[64:67], v[136:139]
v_mfma_f32_16x16x32_bf16 v[116:119], a[240:243], v[212:215], 0
v_mfma_f32_16x16x32_bf16 v[136:139], a[140:143], a[68:71], v[136:139]
v_mfma_f32_16x16x32_bf16 v[120:123], a[244:247], v[212:215], 0
v_mfma_f32_16x16x32_bf16 v[160:163], a[140:143], a[76:79], v[160:163]
buffer_load_dwordx4 v1, s[4:7], s44 offen offset:1024 sc1 lds
v_mfma_f32_16x16x32_bf16 v[160:163], a[136:139], a[72:75], v[160:163]
v_max3_f32 v240, v108, v109, v110
v_max3_f32 v241, -v108, -v109, -v110
v_mfma_f32_16x16x32_bf16 v[184:187], a[136:139], a[80:83], v[184:187]
v_max3_f32 v240, v240, v111, v112
v_max3_f32 v241, v241, -v111, -v112
v_mfma_f32_16x16x32_bf16 v[184:187], a[140:143], a[84:87], v[184:187]
v_max3_f32 v240, v240, v113, v114
v_max3_f32 v241, v241, -v113, -v114
v_mfma_f32_16x16x32_bf16 v[208:211], a[140:143], a[92:95], v[208:211]
v_max_f32 v240, v240, v115
v_max_f32_e64 v241, v241, -v115
v_mfma_f32_16x16x32_bf16 v[208:211], a[136:139], a[88:91], v[208:211]
buffer_load_dwordx4 v1, s[4:7], s44 offen offset:2048 sc1 lds
v_mfma_f32_16x16x32_bf16 v[208:211], a[144:147], a[24:27], v[208:211]
v_permlane32_swap_b32 v240, v241
v_mfma_f32_16x16x32_bf16 v[208:211], a[148:151], a[28:31], v[208:211]
v_max_f32 v240, v240, v241
v_mov_b32 v246, v240
v_mfma_f32_16x16x32_bf16 v[184:187], a[148:151], a[20:23], v[184:187]
s_nop 0
v_permlane16_swap_b32 v240, v246
v_mfma_f32_16x16x32_bf16 v[184:187], a[144:147], a[16:19], v[184:187]
v_max_f32 v240, v240, v246
v_mov_b32 v246, v240
v_mfma_f32_16x16x32_bf16 v[160:163], a[144:147], a[8:11], v[160:163]
buffer_load_dwordx4 v1, s[4:7], s44 offen offset:3072 sc1 lds
v_mfma_f32_16x16x32_bf16 v[160:163], a[148:151], a[12:15], v[160:163]
v_permlane32_swap_b32 v240, v246
v_mfma_f32_16x16x32_bf16 v[136:139], a[148:151], a[4:7], v[136:139]
v_mul_f32_e64 v240, -v240, v86
v_mul_f32_e64 v241, -v246, v86
v_mfma_f32_16x16x32_bf16 v[136:139], a[144:147], a[0:3], v[136:139]
v_max3_f32 v242, v116, v117, v118
v_max3_f32 v243, -v116, -v117, -v118
v_pk_mul_f32 v[148:149], v[148:149], v[82:83] op_sel:[0,1] op_sel_hi:[1,1]
v_pk_mul_f32 v[150:151], v[150:151], v[82:83] op_sel:[0,1] op_sel_hi:[1,1]
v_cvt_pk_bf16_f32 v148, v148, v149
v_cvt_pk_bf16_f32 v149, v150, v151
ds_write_b64 v232, v[148:149] offset:0
v_pk_mul_f32 v[152:153], v[152:153], v[82:83] op_sel:[0,1] op_sel_hi:[1,1]
v_pk_mul_f32 v[154:155], v[154:155], v[82:83] op_sel:[0,1] op_sel_hi:[1,1]
v_cvt_pk_bf16_f32 v150, v152, v153
v_cvt_pk_bf16_f32 v151, v154, v155
v_pk_mul_f32 v[172:173], v[172:173], v[84:85] op_sel:[0,1] op_sel_hi:[1,1]
v_pk_mul_f32 v[174:175], v[174:175], v[84:85] op_sel:[0,1] op_sel_hi:[1,1]
v_cvt_pk_bf16_f32 v172, v172, v173
buffer_store_dwordx4 a[248:251], v254, s[4:7], s97 offen offset:0 sc1
v_cvt_pk_bf16_f32 v173, v174, v175
ds_write_b64 v232, v[150:151] offset:512
v_pk_mul_f32 v[176:177], v[176:177], v[84:85] op_sel:[0,1] op_sel_hi:[1,1]
v_pk_mul_f32 v[178:179], v[178:179], v[84:85] op_sel:[0,1] op_sel_hi:[1,1]
v_cvt_pk_bf16_f32 v174, v176, v177
v_cvt_pk_bf16_f32 v175, v178, v179
v_pk_mul_f32 v[196:197], v[196:197], v[86:87] op_sel:[0,1] op_sel_hi:[1,1]
v_pk_mul_f32 v[198:199], v[198:199], v[86:87] op_sel:[0,1] op_sel_hi:[1,1]
v_cvt_pk_bf16_f32 v196, v196, v197
v_cvt_pk_bf16_f32 v197, v198, v199
v_pk_mul_f32 v[200:201], v[200:201], v[86:87] op_sel:[0,1] op_sel_hi:[1,1]
v_pk_mul_f32 v[202:203], v[202:203], v[86:87] op_sel:[0,1] op_sel_hi:[1,1]
v_cvt_pk_bf16_f32 v198, v200, v201
v_cvt_pk_bf16_f32 v199, v202, v203
ds_write_b64 v232, v[172:173] offset:1024
v_pk_mul_f32 v[220:221], v[220:221], v[88:89] op_sel:[0,1] op_sel_hi:[1,1]
v_pk_mul_f32 v[222:223], v[222:223], v[88:89] op_sel:[0,1] op_sel_hi:[1,1]
v_cvt_pk_bf16_f32 v220, v220, v221
v_cvt_pk_bf16_f32 v221, v222, v223
v_pk_fma_f32 v[48:49], v[92:93], v[82:83], v[236:237] op_sel:[0,0,0] op_sel_hi:[1,0,0]
v_pk_fma_f32 v[50:51], v[94:95], v[82:83], v[236:237] op_sel:[0,0,0] op_sel_hi:[1,0,0]
v_pk_fma_f32 v[52:53], v[96:97], v[82:83], v[236:237] op_sel:[0,0,0] op_sel_hi:[1,0,0]
v_pk_fma_f32 v[54:55], v[98:99], v[82:83], v[236:237] op_sel:[0,0,0] op_sel_hi:[1,0,0]
v_exp_f32 v48, v48
v_exp_f32 v49, v49
ds_write_b64 v232, v[174:175] offset:1536
buffer_store_dwordx4 a[248:251], v1, s[4:7], s96 offen offset:0 sc1
v_exp_f32 v50, v50
v_exp_f32 v51, v51
v_exp_f32 v52, v52
v_exp_f32 v53, v53
ds_write_b64 v232, v[196:197] offset:2048
v_exp_f32 v54, v54
v_exp_f32 v55, v55
v_cvt_pk_bf16_f32 v140, v48, v49
v_cvt_pk_bf16_f32 v141, v50, v51
v_cvt_pk_bf16_f32 v142, v52, v53
v_cvt_pk_bf16_f32 v143, v54, v55
v_pk_mul_f32 v[224:225], v[224:225], v[88:89] op_sel:[0,1] op_sel_hi:[1,1]
v_pk_mul_f32 v[226:227], v[226:227], v[88:89] op_sel:[0,1] op_sel_hi:[1,1]
v_cvt_pk_bf16_f32 v222, v224, v225
v_mfma_f32_16x16x32_bf16 v[148:151], v[16:19], v[140:143], 0
ds_write_b64 v232, v[198:199] offset:2560
v_cvt_pk_bf16_f32 v223, v226, v227
s_add_u32 m0, s19, 131072
v_pk_fma_f32 v[92:93], v[92:93], v[82:83], v[236:237] op_sel:[0,0,1] op_sel_hi:[1,0,1] neg_lo:[1,0,0] neg_hi:[1,0,0]
v_pk_fma_f32 v[94:95], v[94:95], v[82:83], v[236:237] op_sel:[0,0,1] op_sel_hi:[1,0,1] neg_lo:[1,0,0] neg_hi:[1,0,0]
v_pk_fma_f32 v[96:97], v[96:97], v[82:83], v[236:237] op_sel:[0,0,1] op_sel_hi:[1,0,1] neg_lo:[1,0,0] neg_hi:[1,0,0]
s_nop 1
v_rcp_f32 v148, v148
buffer_store_dwordx4 a[248:251], v3, s[4:7], s91 offen offset:0 sc1
v_pk_mul_f32 v[48:49], v[48:49], v[148:149] op_sel:[0,0] op_sel_hi:[1,0]
ds_write_b64 v232, v[220:221] offset:3072
v_pk_mul_f32 v[50:51], v[50:51], v[148:149] op_sel:[0,0] op_sel_hi:[1,0]
v_cvt_pk_bf16_f32 v140, v48, v49
v_cvt_pk_bf16_f32 v141, v50, v51
v_pk_fma_f32 v[98:99], v[98:99], v[82:83], v[236:237] op_sel:[0,0,1] op_sel_hi:[1,0,1] neg_lo:[1,0,0] neg_hi:[1,0,0]
v_exp_f32 v92, v92
v_exp_f32 v93, v93
buffer_store_dwordx4 a[248:251], v3, s[4:7], s91 offen offset:1024 sc1
ds_write_b64 v232, v[222:223] offset:3584
v_exp_f32 v94, v94
v_exp_f32 v95, v95
v_exp_f32 v96, v96
v_exp_f32 v97, v97
v_exp_f32 v98, v98
v_exp_f32 v99, v99
ds_write_b64 v233, v[140:141] offset:16384
s_xor_b32 s44, s85, 98304
v_cvt_pk_bf16_f32 v144, v92, v93
v_cvt_pk_bf16_f32 v145, v94, v95
v_cvt_pk_bf16_f32 v146, v96, v97
v_cvt_pk_bf16_f32 v147, v98, v99
buffer_load_dwordx4 v1, s[4:7], s44 offen offset:0 sc1 lds
v_pk_mul_f32 v[52:53], v[52:53], v[148:149] op_sel:[0,0] op_sel_hi:[1,0]
v_cvt_pk_bf16_f32 v142, v52, v53
v_pk_mul_f32 v[54:55], v[54:55], v[148:149] op_sel:[0,0] op_sel_hi:[1,0]
v_cvt_pk_bf16_f32 v143, v54, v55
v_mfma_f32_16x16x32_bf16 v[152:155], v[16:19], v[144:147], 0
ds_write_b64 v233, v[142:143] offset:16896
v_max3_f32 v242, v242, v119, v120
v_max3_f32 v243, v243, -v119, -v120
v_pk_fma_f32 v[56:57], v[100:101], v[84:85], v[238:239] op_sel:[0,0,0] op_sel_hi:[1,0,0]
v_pk_fma_f32 v[58:59], v[102:103], v[84:85], v[238:239] op_sel:[0,0,0] op_sel_hi:[1,0,0]
v_pk_fma_f32 v[60:61], v[104:105], v[84:85], v[238:239] op_sel:[0,0,0] op_sel_hi:[1,0,0]
s_nop 1
v_rcp_f32 v152, v152
v_pk_fma_f32 v[62:63], v[106:107], v[84:85], v[238:239] op_sel:[0,0,0] op_sel_hi:[1,0,0]
v_pk_mul_f32 v[92:93], v[92:93], v[152:153] op_sel:[0,0] op_sel_hi:[1,0]
v_pk_mul_f32 v[94:95], v[94:95], v[152:153] op_sel:[0,0] op_sel_hi:[1,0]
v_cvt_pk_bf16_f32 v144, v92, v93
v_cvt_pk_bf16_f32 v145, v94, v95
ds_write_b64 v233, v[144:145] offset:17408
v_exp_f32 v56, v56
v_exp_f32 v57, v57
v_exp_f32 v58, v58
v_exp_f32 v59, v59
v_exp_f32 v60, v60
v_exp_f32 v61, v61
v_exp_f32 v62, v62
v_exp_f32 v63, v63
buffer_load_dwordx4 v1, s[4:7], s44 offen offset:1024 sc1 lds
v_cvt_pk_bf16_f32 v164, v56, v57
v_cvt_pk_bf16_f32 v165, v58, v59
v_cvt_pk_bf16_f32 v166, v60, v61
v_cvt_pk_bf16_f32 v167, v62, v63
v_pk_mul_f32 v[96:97], v[96:97], v[152:153] op_sel:[0,0] op_sel_hi:[1,0]
v_pk_mul_f32 v[98:99], v[98:99], v[152:153] op_sel:[0,0] op_sel_hi:[1,0]
v_cvt_pk_bf16_f32 v146, v96, v97
v_mfma_f32_16x16x32_bf16 v[172:175], v[16:19], v[164:167], 0
v_cvt_pk_bf16_f32 v147, v98, v99
ds_write_b64 v233, v[146:147] offset:17920
v_max3_f32 v242, v242, v121, v122
v_pk_fma_f32 v[100:101], v[100:101], v[84:85], v[238:239] op_sel:[0,0,1] op_sel_hi:[1,0,1] neg_lo:[1,0,0] neg_hi:[1,0,0]
v_pk_fma_f32 v[102:103], v[102:103], v[84:85], v[238:239] op_sel:[0,0,1] op_sel_hi:[1,0,1] neg_lo:[1,0,0] neg_hi:[1,0,0]
v_pk_fma_f32 v[104:105], v[104:105], v[84:85], v[238:239] op_sel:[0,0,1] op_sel_hi:[1,0,1] neg_lo:[1,0,0] neg_hi:[1,0,0]
s_nop 1
v_rcp_f32 v172, v172
v_pk_fma_f32 v[106:107], v[106:107], v[84:85], v[238:239] op_sel:[0,0,1] op_sel_hi:[1,0,1] neg_lo:[1,0,0] neg_hi:[1,0,0]
v_pk_mul_f32 v[56:57], v[56:57], v[172:173] op_sel:[0,0] op_sel_hi:[1,0]
v_pk_mul_f32 v[58:59], v[58:59], v[172:173] op_sel:[0,0] op_sel_hi:[1,0]
v_cvt_pk_bf16_f32 v164, v56, v57
v_cvt_pk_bf16_f32 v165, v58, v59
v_exp_f32 v100, v100
ds_write_b64 v233, v[164:165] offset:18432
v_exp_f32 v101, v101
v_exp_f32 v102, v102
v_exp_f32 v103, v103
v_exp_f32 v104, v104
v_exp_f32 v105, v105
v_exp_f32 v106, v106
v_exp_f32 v107, v107
buffer_load_dwordx4 v1, s[4:7], s44 offen offset:2048 sc1 lds
v_cvt_pk_bf16_f32 v168, v100, v101
v_cvt_pk_bf16_f32 v169, v102, v103
v_cvt_pk_bf16_f32 v170, v104, v105
v_cvt_pk_bf16_f32 v171, v106, v107
v_pk_mul_f32 v[60:61], v[60:61], v[172:173] op_sel:[0,0] op_sel_hi:[1,0]
v_pk_mul_f32 v[62:63], v[62:63], v[172:173] op_sel:[0,0] op_sel_hi:[1,0]
v_cvt_pk_bf16_f32 v166, v60, v61
v_mfma_f32_16x16x32_bf16 v[176:179], v[16:19], v[168:171], 0
v_cvt_pk_bf16_f32 v167, v62, v63
ds_write_b64 v233, v[166:167] offset:18944
v_max3_f32 v243, v243, -v121, -v122
v_pk_fma_f32 v[64:65], v[108:109], v[86:87], v[240:241] op_sel:[0,0,0] op_sel_hi:[1,0,0]
v_pk_fma_f32 v[66:67], v[110:111], v[86:87], v[240:241] op_sel:[0,0,0] op_sel_hi:[1,0,0]
v_pk_fma_f32 v[68:69], v[112:113], v[86:87], v[240:241] op_sel:[0,0,0] op_sel_hi:[1,0,0]
s_nop 1
v_rcp_f32 v176, v176
v_pk_fma_f32 v[70:71], v[114:115], v[86:87], v[240:241] op_sel:[0,0,0] op_sel_hi:[1,0,0]
v_pk_mul_f32 v[100:101], v[100:101], v[176:177] op_sel:[0,0] op_sel_hi:[1,0]
v_pk_mul_f32 v[102:103], v[102:103], v[176:177] op_sel:[0,0] op_sel_hi:[1,0]
v_cvt_pk_bf16_f32 v168, v100, v101
v_cvt_pk_bf16_f32 v169, v102, v103
v_exp_f32 v64, v64
ds_write_b64 v233, v[168:169] offset:19456
buffer_load_dwordx4 v1, s[4:7], s44 offen offset:3072 sc1 lds
v_exp_f32 v65, v65
v_exp_f32 v66, v66
v_exp_f32 v67, v67
v_exp_f32 v68, v68
v_exp_f32 v69, v69
v_exp_f32 v70, v70
v_exp_f32 v71, v71
v_cvt_pk_bf16_f32 v188, v64, v65
v_cvt_pk_bf16_f32 v189, v66, v67
v_cvt_pk_bf16_f32 v190, v68, v69
v_cvt_pk_bf16_f32 v191, v70, v71
v_pk_mul_f32 v[104:105], v[104:105], v[176:177] op_sel:[0,0] op_sel_hi:[1,0]
v_pk_mul_f32 v[106:107], v[106:107], v[176:177] op_sel:[0,0] op_sel_hi:[1,0]
v_cvt_pk_bf16_f32 v170, v104, v105
v_mfma_f32_16x16x32_bf16 v[196:199], v[16:19], v[188:191], 0
v_cvt_pk_bf16_f32 v171, v106, v107
ds_write_b64 v233, v[170:171] offset:19968
buffer_store_dwordx4 a[248:251], v2, s[4:7], s72 offen offset:0 sc1
s_nop 4
v_rcp_f32 v196, v196
v_pk_fma_f32 v[108:109], v[108:109], v[86:87], v[240:241] op_sel:[0,0,1] op_sel_hi:[1,0,1] neg_lo:[1,0,0] neg_hi:[1,0,0]
v_pk_mul_f32 v[64:65], v[64:65], v[196:197] op_sel:[0,0] op_sel_hi:[1,0]
v_pk_mul_f32 v[66:67], v[66:67], v[196:197] op_sel:[0,0] op_sel_hi:[1,0]
v_cvt_pk_bf16_f32 v188, v64, v65
v_cvt_pk_bf16_f32 v189, v66, v67
v_pk_fma_f32 v[110:111], v[110:111], v[86:87], v[240:241] op_sel:[0,0,1] op_sel_hi:[1,0,1] neg_lo:[1,0,0] neg_hi:[1,0,0]
ds_write_b64 v233, v[188:189] offset:20480
v_pk_fma_f32 v[112:113], v[112:113], v[86:87], v[240:241] op_sel:[0,0,1] op_sel_hi:[1,0,1] neg_lo:[1,0,0] neg_hi:[1,0,0]
v_pk_fma_f32 v[114:115], v[114:115], v[86:87], v[240:241] op_sel:[0,0,1] op_sel_hi:[1,0,1] neg_lo:[1,0,0] neg_hi:[1,0,0]
v_exp_f32 v108, v108
v_exp_f32 v109, v109
v_exp_f32 v110, v110
v_exp_f32 v111, v111
v_exp_f32 v112, v112
v_exp_f32 v113, v113
v_exp_f32 v114, v114
v_exp_f32 v115, v115
v_max_f32 v242, v242, v123
v_max_f32_e64 v243, v243, -v123
v_cvt_pk_bf16_f32 v192, v108, v109
v_cvt_pk_bf16_f32 v193, v110, v111
v_cvt_pk_bf16_f32 v194, v112, v113
v_cvt_pk_bf16_f32 v195, v114, v115
v_pk_mul_f32 v[68:69], v[68:69], v[196:197] op_sel:[0,0] op_sel_hi:[1,0]
v_pk_mul_f32 v[70:71], v[70:71], v[196:197] op_sel:[0,0] op_sel_hi:[1,0]
v_permlane32_swap_b32 v242, v243
v_mfma_f32_16x16x32_bf16 v[200:203], v[16:19], v[192:195], 0
v_cvt_pk_bf16_f32 v190, v68, v69
v_cvt_pk_bf16_f32 v191, v70, v71
ds_write_b64 v233, v[190:191] offset:20992
v_max_f32 v242, v242, v243
v_mov_b32 v247, v242
buffer_store_dwordx4 a[248:251], v2, s[4:7], s72 offen offset:1024 sc1
s_nop 0
v_permlane16_swap_b32 v242, v247
v_rcp_f32 v200, v200
v_max_f32 v242, v242, v247
v_mov_b32 v247, v242
v_pk_mul_f32 v[108:109], v[108:109], v[200:201] op_sel:[0,0] op_sel_hi:[1,0]
v_pk_mul_f32 v[110:111], v[110:111], v[200:201] op_sel:[0,0] op_sel_hi:[1,0]
v_cvt_pk_bf16_f32 v192, v108, v109
v_cvt_pk_bf16_f32 v193, v110, v111
v_permlane32_swap_b32 v242, v247
ds_write_b64 v233, v[192:193] offset:21504
v_mul_f32_e64 v242, -v242, v88
v_mul_f32_e64 v243, -v247, v88
v_pk_fma_f32 v[124:125], v[116:117], v[88:89], v[242:243] op_sel:[0,0,0] op_sel_hi:[1,0,0]
v_pk_fma_f32 v[126:127], v[118:119], v[88:89], v[242:243] op_sel:[0,0,0] op_sel_hi:[1,0,0]
v_pk_fma_f32 v[128:129], v[120:121], v[88:89], v[242:243] op_sel:[0,0,0] op_sel_hi:[1,0,0]
v_pk_fma_f32 v[130:131], v[122:123], v[88:89], v[242:243] op_sel:[0,0,0] op_sel_hi:[1,0,0]
v_exp_f32 v124, v124
v_exp_f32 v125, v125
v_exp_f32 v126, v126
v_exp_f32 v127, v127
v_exp_f32 v128, v128
v_exp_f32 v129, v129
v_exp_f32 v130, v130
v_exp_f32 v131, v131
v_cvt_pk_bf16_f32 v212, v124, v125
v_cvt_pk_bf16_f32 v213, v126, v127
v_cvt_pk_bf16_f32 v214, v128, v129
v_cvt_pk_bf16_f32 v215, v130, v131
v_pk_mul_f32 v[112:113], v[112:113], v[200:201] op_sel:[0,0] op_sel_hi:[1,0]
v_pk_mul_f32 v[114:115], v[114:115], v[200:201] op_sel:[0,0] op_sel_hi:[1,0]
v_cvt_pk_bf16_f32 v194, v112, v113
v_mfma_f32_16x16x32_bf16 v[220:223], v[16:19], v[212:215], 0
v_cvt_pk_bf16_f32 v195, v114, v115
ds_write_b64 v233, v[194:195] offset:22016
buffer_store_dwordx4 a[248:251], v2, s[4:7], s72 offen offset:2048 sc1
s_nop 4
v_rcp_f32 v220, v220
v_pk_fma_f32 v[116:117], v[116:117], v[88:89], v[242:243] op_sel:[0,0,1] op_sel_hi:[1,0,1] neg_lo:[1,0,0] neg_hi:[1,0,0]
v_pk_mul_f32 v[124:125], v[124:125], v[220:221] op_sel:[0,0] op_sel_hi:[1,0]
v_pk_mul_f32 v[126:127], v[126:127], v[220:221] op_sel:[0,0] op_sel_hi:[1,0]
v_cvt_pk_bf16_f32 v212, v124, v125
v_cvt_pk_bf16_f32 v213, v126, v127
v_pk_fma_f32 v[118:119], v[118:119], v[88:89], v[242:243] op_sel:[0,0,1] op_sel_hi:[1,0,1] neg_lo:[1,0,0] neg_hi:[1,0,0]
ds_write_b64 v233, v[212:213] offset:22528
v_pk_fma_f32 v[120:121], v[120:121], v[88:89], v[242:243] op_sel:[0,0,1] op_sel_hi:[1,0,1] neg_lo:[1,0,0] neg_hi:[1,0,0]
v_pk_fma_f32 v[122:123], v[122:123], v[88:89], v[242:243] op_sel:[0,0,1] op_sel_hi:[1,0,1] neg_lo:[1,0,0] neg_hi:[1,0,0]
v_exp_f32 v116, v116
v_exp_f32 v117, v117
v_exp_f32 v118, v118
v_exp_f32 v119, v119
v_exp_f32 v120, v120
v_exp_f32 v121, v121
v_exp_f32 v122, v122
v_exp_f32 v123, v123
v_cvt_pk_bf16_f32 v216, v116, v117
v_cvt_pk_bf16_f32 v217, v118, v119
v_cvt_pk_bf16_f32 v218, v120, v121
v_cvt_pk_bf16_f32 v219, v122, v123
v_pk_mul_f32 v[128:129], v[128:129], v[220:221] op_sel:[0,0] op_sel_hi:[1,0]
v_pk_mul_f32 v[130:131], v[130:131], v[220:221] op_sel:[0,0] op_sel_hi:[1,0]
v_cvt_pk_bf16_f32 v214, v128, v129
v_mfma_f32_16x16x32_bf16 v[224:227], v[16:19], v[216:219], 0
v_cvt_pk_bf16_f32 v215, v130, v131
ds_write_b64 v233, v[214:215] offset:23040
buffer_store_dwordx4 a[248:251], v2, s[4:7], s72 offen offset:3072 sc1
s_nop 4
v_rcp_f32 v224, v224
s_nop 0
v_pk_mul_f32 v[116:117], v[116:117], v[224:225] op_sel:[0,0] op_sel_hi:[1,0]
v_pk_mul_f32 v[118:119], v[118:119], v[224:225] op_sel:[0,0] op_sel_hi:[1,0]
v_cvt_pk_bf16_f32 v216, v116, v117
v_cvt_pk_bf16_f32 v217, v118, v119
v_pk_mul_f32 v[120:121], v[120:121], v[224:225] op_sel:[0,0] op_sel_hi:[1,0]
ds_write_b64 v233, v[216:217] offset:23552
v_pk_mul_f32 v[122:123], v[122:123], v[224:225] op_sel:[0,0] op_sel_hi:[1,0]
v_cvt_pk_bf16_f32 v218, v120, v121
v_cvt_pk_bf16_f32 v219, v122, v123
ds_write_b64 v233, v[218:219] offset:24064
s_waitcnt vmcnt(8)
s_waitcnt lgkmcnt(0)
s_barrier
ds_read_b64_tr_b16 a[0:1], v234 offset:16384
ds_read_b64_tr_b16 a[2:3], v234 offset:18432
ds_read_b64_tr_b16 a[12:13], v234 offset:20480
ds_read_b64_tr_b16 a[14:15], v234 offset:22528
ds_read_b64_tr_b16 a[24:25], v234 offset:24576
ds_read_b64_tr_b16 a[26:27], v234 offset:26624
ds_read_b64_tr_b16 a[4:5], v8 offset:0
ds_read_b64_tr_b16 a[6:7], v8 offset:1024
ds_read_b64_tr_b16 a[8:9], v8 offset:512
ds_read_b64_tr_b16 a[10:11], v8 offset:1536
ds_read_b64_tr_b16 a[36:37], v234 offset:28672
ds_read_b64_tr_b16 a[38:39], v234 offset:30720
ds_read_b64_tr_b16 a[16:17], v8 offset:2048
ds_read_b64_tr_b16 a[18:19], v8 offset:3072
ds_read_b64_tr_b16 a[20:21], v8 offset:2560
ds_read_b64_tr_b16 a[22:23], v8 offset:3584
ds_read_b64_tr_b16 a[48:49], v234 offset:32768
ds_read_b64_tr_b16 a[50:51], v234 offset:34816
ds_read_b64_tr_b16 a[28:29], v8 offset:4096
ds_read_b64_tr_b16 a[30:31], v8 offset:5120
ds_read_b64_tr_b16 a[32:33], v8 offset:4608
ds_read_b64_tr_b16 a[34:35], v8 offset:5632
ds_read_b64_tr_b16 a[60:61], v234 offset:36864
ds_read_b64_tr_b16 a[62:63], v234 offset:38912
s_waitcnt lgkmcnt(14)
v_mfma_f32_16x16x32_bf16 v[100:103], a[0:3], v[16:19], 0
ds_read_b64_tr_b16 a[40:41], v8 offset:6144
ds_read_b64_tr_b16 a[42:43], v8 offset:7168
ds_read_b64_tr_b16 a[44:45], v8 offset:6656
ds_read_b64_tr_b16 a[46:47], v8 offset:7680
ds_read_b64_tr_b16 a[72:73], v234 offset:40960
ds_read_b64_tr_b16 a[74:75], v234 offset:43008
v_mfma_f32_16x16x32_bf16 v[100:103], a[12:15], v[16:19], v[100:103]
buffer_atomic_add v12, v235, s[4:7], s94 offen sc1
ds_read_b64_tr_b16 a[52:53], v8 offset:8192
ds_read_b64_tr_b16 a[54:55], v8 offset:9216
ds_read_b64_tr_b16 a[56:57], v8 offset:8704
ds_read_b64_tr_b16 a[58:59], v8 offset:9728
ds_read_b64_tr_b16 a[84:85], v234 offset:45056
ds_read_b64_tr_b16 a[86:87], v234 offset:47104
v_mfma_f32_16x16x32_bf16 v[100:103], a[24:27], v[16:19], v[100:103]
ds_read_b64_tr_b16 a[64:65], v8 offset:10240
ds_read_b64_tr_b16 a[66:67], v8 offset:11264
v_mfma_f32_16x16x32_bf16 v[92:95], a[0:3], a[4:7], 0
ds_read_b64_tr_b16 a[68:69], v8 offset:10752
ds_read_b64_tr_b16 a[70:71], v8 offset:11776
v_mfma_f32_16x16x32_bf16 v[96:99], a[0:3], a[8:11], 0
ds_read_b64_tr_b16 a[76:77], v8 offset:12288
s_waitcnt lgkmcnt(14)
v_mfma_f32_16x16x32_bf16 v[100:103], a[36:39], v[16:19], v[100:103]
ds_read_b64_tr_b16 a[78:79], v8 offset:13312
v_mfma_f32_16x16x32_bf16 v[92:95], a[12:15], a[16:19], v[92:95]
ds_read_b64_tr_b16 a[80:81], v8 offset:12800
ds_read_b64_tr_b16 a[82:83], v8 offset:13824
v_mfma_f32_16x16x32_bf16 v[96:99], a[12:15], a[20:23], v[96:99]
ds_read_b64_tr_b16 a[88:89], v8 offset:14336
v_mfma_f32_16x16x32_bf16 v[100:103], a[48:51], v[16:19], v[100:103]
ds_read_b64_tr_b16 a[90:91], v8 offset:15360
v_mfma_f32_16x16x32_bf16 v[92:95], a[24:27], a[28:31], v[92:95]
ds_read_b64_tr_b16 a[92:93], v8 offset:14848
ds_read_b64_tr_b16 a[94:95], v8 offset:15872
v_mfma_f32_16x16x32_bf16 v[96:99], a[24:27], a[32:35], v[96:99]
v_cvt_pk_bf16_f32 v132, v132, v133
v_cvt_pk_bf16_f32 v156, v156, v157
v_mfma_f32_16x16x32_bf16 v[100:103], a[60:63], v[16:19], v[100:103]
v_cvt_pk_bf16_f32 v180, v180, v181
v_cvt_pk_bf16_f32 v204, v204, v205
v_mfma_f32_16x16x32_bf16 v[92:95], a[36:39], a[40:43], v[92:95]
v_cvt_pk_bf16_f32 v133, v134, v135
v_cvt_pk_bf16_f32 v157, v158, v159
s_waitcnt lgkmcnt(14)
v_mfma_f32_16x16x32_bf16 v[96:99], a[36:39], a[44:47], v[96:99]
v_cvt_pk_bf16_f32 v181, v182, v183
v_cvt_pk_bf16_f32 v205, v206, v207
v_mfma_f32_16x16x32_bf16 v[100:103], a[72:75], v[16:19], v[100:103]
v_cvt_pk_bf16_f32 v134, v136, v137
v_cvt_pk_bf16_f32 v135, v138, v139
v_mfma_f32_16x16x32_bf16 v[92:95], a[48:51], a[52:55], v[92:95]
v_cvt_pk_bf16_f32 v158, v160, v161
v_cvt_pk_bf16_f32 v159, v162, v163
v_mfma_f32_16x16x32_bf16 v[96:99], a[48:51], a[56:59], v[96:99]
v_cvt_pk_bf16_f32 v182, v184, v185
v_cvt_pk_bf16_f32 v183, v186, v187
s_waitcnt lgkmcnt(12)
v_mfma_f32_16x16x32_bf16 v[100:103], a[84:87], v[16:19], v[100:103]
v_cvt_pk_bf16_f32 v206, v208, v209
v_cvt_pk_bf16_f32 v207, v210, v211
s_waitcnt lgkmcnt(10)
v_mfma_f32_16x16x32_bf16 v[92:95], a[60:63], a[64:67], v[92:95]
s_waitcnt lgkmcnt(8)
v_mfma_f32_16x16x32_bf16 v[96:99], a[60:63], a[68:71], v[96:99]
s_nop 1
v_min_u32 v100, -2, v100
v_min_u32 v101, -2, v101
s_waitcnt lgkmcnt(6)
v_mfma_f32_16x16x32_bf16 v[92:95], a[72:75], a[76:79], v[92:95]
v_min_u32 v102, -2, v102
v_min_u32 v103, -2, v103
s_waitcnt lgkmcnt(4)
v_mfma_f32_16x16x32_bf16 v[96:99], a[72:75], a[80:83], v[96:99]
buffer_store_dwordx4 v[100:103], v254, s[4:7], s97 offen sc1
s_waitcnt lgkmcnt(2)
v_mfma_f32_16x16x32_bf16 v[92:95], a[84:87], a[88:91], v[92:95]
s_waitcnt lgkmcnt(0)
v_mfma_f32_16x16x32_bf16 v[96:99], a[84:87], a[92:95], v[96:99]
s_nop 5
v_cvt_pk_bf16_f32 v92, v92, v93
v_cvt_pk_bf16_f32 v93, v94, v95
v_min_u32 v92, -2, v92
v_min_u32 v93, -2, v93
v_cvt_pk_bf16_f32 v94, v96, v97
v_cvt_pk_bf16_f32 v95, v98, v99
v_min_u32 v94, -2, v94
v_min_u32 v95, -2, v95
buffer_store_dwordx4 v[92:95], v1, s[4:7], s96 offen sc1
s_barrier
s_add_u32 m0, s19, 32768
s_xor_b32 s44, s85, 0
buffer_load_dwordx4 v1, s[4:7], s44 offen offset:0 sc1 lds
v_mfma_f32_16x16x32_bf16 v[108:111], a[240:243], v[132:135], 0
v_mfma_f32_16x16x32_bf16 v[172:175], a[240:243], v[156:159], 0
v_mfma_f32_16x16x32_bf16 v[112:115], a[244:247], v[132:135], 0
s_nop 5
v_max3_f32 v236, v108, v109, v110
v_max3_f32 v237, -v108, -v109, -v110
v_mfma_f32_16x16x32_bf16 v[176:179], a[244:247], v[156:159], 0
v_max3_f32 v238, v172, v173, v174
v_max3_f32 v239, -v172, -v173, -v174
v_max3_f32 v236, v236, v111, v112
v_max3_f32 v237, v237, -v111, -v112
v_max3_f32 v236, v236, v113, v114
v_max3_f32 v237, v237, -v113, -v114
s_nop 1
v_max3_f32 v238, v238, v175, v176
v_max3_f32 v239, v239, -v175, -v176
v_max3_f32 v238, v238, v177, v178
v_max3_f32 v239, v239, -v177, -v178
v_max_f32 v236, v236, v115
buffer_load_dwordx4 v1, s[4:7], s44 offen offset:1024 sc1 lds
v_max_f32_e64 v237, v237, -v115
v_max_f32 v238, v238, v179
v_max_f32_e64 v239, v239, -v179
v_permlane32_swap_b32 v236, v237
s_nop 0
v_permlane32_swap_b32 v238, v239
v_mov_b32 v11, 0
buffer_atomic_add v11, v251, s[4:7], s89 offen sc0 sc1
v_max_f32 v236, v236, v237
v_max_f32 v238, v238, v239
v_mov_b32 v244, v236
v_mov_b32 v245, v238
s_nop 0
v_permlane16_swap_b32 v236, v244
v_permlane16_swap_b32 v238, v245
v_max_f32 v236, v236, v244
v_max_f32 v238, v238, v245
v_mov_b32 v244, v236
v_mov_b32 v245, v238
s_nop 0
v_permlane32_swap_b32 v236, v244
v_permlane32_swap_b32 v238, v245
v_mul_f32_e64 v236, -v236, v82
v_mul_f32_e64 v237, -v244, v82
buffer_load_dwordx4 v1, s[4:7], s44 offen offset:2048 sc1 lds
v_mul_f32_e64 v238, -v238, v84
v_mul_f32_e64 v239, -v245, v84
v_pk_fma_f32 v[116:117], v[108:109], v[82:83], v[236:237] op_sel:[0,0,0] op_sel_hi:[1,0,0]
v_pk_fma_f32 v[118:119], v[110:111], v[82:83], v[236:237] op_sel:[0,0,0] op_sel_hi:[1,0,0]
v_pk_fma_f32 v[120:121], v[112:113], v[82:83], v[236:237] op_sel:[0,0,0] op_sel_hi:[1,0,0]
v_pk_fma_f32 v[122:123], v[114:115], v[82:83], v[236:237] op_sel:[0,0,0] op_sel_hi:[1,0,0]
v_pk_fma_f32 v[148:149], v[172:173], v[84:85], v[238:239] op_sel:[0,0,0] op_sel_hi:[1,0,0]
v_pk_fma_f32 v[150:151], v[174:175], v[84:85], v[238:239] op_sel:[0,0,0] op_sel_hi:[1,0,0]
v_pk_fma_f32 v[152:153], v[176:177], v[84:85], v[238:239] op_sel:[0,0,0] op_sel_hi:[1,0,0]
v_pk_fma_f32 v[154:155], v[178:179], v[84:85], v[238:239] op_sel:[0,0,0] op_sel_hi:[1,0,0]
v_pk_fma_f32 v[108:109], v[108:109], v[82:83], v[236:237] op_sel:[0,0,1] op_sel_hi:[1,0,1] neg_lo:[1,0,0] neg_hi:[1,0,0]
v_pk_fma_f32 v[110:111], v[110:111], v[82:83], v[236:237] op_sel:[0,0,1] op_sel_hi:[1,0,1] neg_lo:[1,0,0] neg_hi:[1,0,0]
v_pk_fma_f32 v[112:113], v[112:113], v[82:83], v[236:237] op_sel:[0,0,1] op_sel_hi:[1,0,1] neg_lo:[1,0,0] neg_hi:[1,0,0]
v_pk_fma_f32 v[114:115], v[114:115], v[82:83], v[236:237] op_sel:[0,0,1] op_sel_hi:[1,0,1] neg_lo:[1,0,0] neg_hi:[1,0,0]
v_pk_fma_f32 v[172:173], v[172:173], v[84:85], v[238:239] op_sel:[0,0,1] op_sel_hi:[1,0,1] neg_lo:[1,0,0] neg_hi:[1,0,0]
v_pk_fma_f32 v[174:175], v[174:175], v[84:85], v[238:239] op_sel:[0,0,1] op_sel_hi:[1,0,1] neg_lo:[1,0,0] neg_hi:[1,0,0]
v_pk_fma_f32 v[176:177], v[176:177], v[84:85], v[238:239] op_sel:[0,0,1] op_sel_hi:[1,0,1] neg_lo:[1,0,0] neg_hi:[1,0,0]
v_pk_fma_f32 v[178:179], v[178:179], v[84:85], v[238:239] op_sel:[0,0,1] op_sel_hi:[1,0,1] neg_lo:[1,0,0] neg_hi:[1,0,0]
v_exp_f32 v116, v116
v_exp_f32 v108, v108
v_exp_f32 v117, v117
v_exp_f32 v109, v109
v_exp_f32 v118, v118
v_exp_f32 v110, v110
v_exp_f32 v119, v119
v_exp_f32 v111, v111
L_stub8:
s_cbranch_execz L_wret1
v_exp_f32 v120, v120
v_exp_f32 v112, v112
v_exp_f32 v121, v121
v_exp_f32 v113, v113
v_exp_f32 v122, v122
v_exp_f32 v114, v114
v_exp_f32 v123, v123
v_exp_f32 v115, v115
v_exp_f32 v148, v148
v_exp_f32 v172, v172
v_exp_f32 v149, v149
v_exp_f32 v173, v173
v_exp_f32 v150, v150
v_exp_f32 v174, v174
v_exp_f32 v151, v151
v_exp_f32 v175, v175
v_exp_f32 v152, v152
v_exp_f32 v176, v176
v_exp_f32 v153, v153
v_exp_f32 v177, v177
v_exp_f32 v154, v154
v_exp_f32 v178, v178
v_exp_f32 v155, v155
v_exp_f32 v179, v179
buffer_load_dwordx4 v1, s[4:7], s44 offen offset:3072 sc1 lds
v_cvt_pk_bf16_f32 v140, v116, v117
v_cvt_pk_bf16_f32 v141, v118, v119
v_cvt_pk_bf16_f32 v142, v120, v121
v_cvt_pk_bf16_f32 v143, v122, v123
v_cvt_pk_bf16_f32 v144, v108, v109
v_cvt_pk_bf16_f32 v145, v110, v111
v_cvt_pk_bf16_f32 v146, v112, v113
v_cvt_pk_bf16_f32 v147, v114, v115
v_cvt_pk_bf16_f32 v164, v148, v149
v_cvt_pk_bf16_f32 v165, v150, v151
v_cvt_pk_bf16_f32 v166, v152, v153
v_cvt_pk_bf16_f32 v167, v154, v155
v_cvt_pk_bf16_f32 v168, v172, v173
v_cvt_pk_bf16_f32 v169, v174, v175
v_cvt_pk_bf16_f32 v170, v176, v177
v_cvt_pk_bf16_f32 v171, v178, v179
s_waitcnt vmcnt(2)
v_readfirstlane_b32 s38, v11
s_nop 0
s_cmp_ge_u32 s38, 8
s_cbranch_scc1 Lpe_26
s_add_u32 s36, s88, 0x80000
s_mov_b32 s37, 0
Lpoll_25:
v_mov_b32 v11, 0
buffer_atomic_add v11, v251, s[4:7], s36 offen sc0 sc1
s_add_u32 s37, s37, 1
s_waitcnt vmcnt(0)
v_readfirstlane_b32 s38, v11
s_nop 0
s_cmp_ge_u32 s38, 8
s_cbranch_scc1 Lpe_26
s_cmp_lt_u32 s37, 0x100000
s_cbranch_scc1 Lpoll_25
Lpe_26:
buffer_load_dwordx4 v[48:51], v1, s[4:7], s98 offen offset:0 sc1
v_mfma_f32_16x16x32_bf16 v[108:111], a[240:243], v[180:183], 0
v_mfma_f32_16x16x32_bf16 v[220:223], a[240:243], v[204:207], 0
v_mfma_f32_16x16x32_bf16 v[112:115], a[244:247], v[180:183], 0
s_nop 5
v_max3_f32 v240, v108, v109, v110
v_max3_f32 v241, -v108, -v109, -v110
v_mfma_f32_16x16x32_bf16 v[224:227], a[244:247], v[204:207], 0
buffer_load_dwordx4 v[124:127], v248, s[4:7], s100 offen sc1
v_max3_f32 v242, v220, v221, v222
v_max3_f32 v243, -v220, -v221, -v222
v_max3_f32 v240, v240, v111, v112
v_max3_f32 v241, v241, -v111, -v112
v_max3_f32 v240, v240, v113, v114
s_nop 1
v_max3_f32 v242, v242, v223, v224
v_max3_f32 v243, v243, -v223, -v224
v_max3_f32 v241, v241, -v113, -v114
v_max3_f32 v242, v242, v225, v226
v_max3_f32 v243, v243, -v225, -v226
v_max_f32 v240, v240, v115
v_max_f32_e64 v241, v241, -v115
v_max_f32 v242, v242, v227
buffer_load_dwordx4 v[52:55], v1, s[4:7], s98 offen offset:1024 sc1
v_max_f32_e64 v243, v243, -v227
v_permlane32_swap_b32 v240, v241
s_nop 0
v_permlane32_swap_b32 v242, v243
v_max_f32 v240, v240, v241
v_max_f32 v242, v242, v243
v_mov_b32 v246, v240
v_mov_b32 v247, v242
s_nop 0
v_permlane16_swap_b32 v240, v246
v_permlane16_swap_b32 v242, v247
buffer_load_dwordx4 v[56:59], v1, s[4:7], s98 offen offset:2048 sc1
v_max_f32 v240, v240, v246
v_max_f32 v242, v242, v247
v_mov_b32 v246, v240
v_mov_b32 v247, v242
s_nop 0
v_permlane32_swap_b32 v240, v246
v_permlane32_swap_b32 v242, v247
v_mul_f32_e64 v240, -v240, v86
v_mul_f32_e64 v241, -v246, v86
v_mul_f32_e64 v242, -v242, v88
v_mul_f32_e64 v243, -v247, v88
buffer_load_dwordx4 v[60:63], v1, s[4:7], s98 offen offset:3072 sc1
v_pk_fma_f32 v[116:117], v[108:109], v[86:87], v[240:241] op_sel:[0,0,0] op_sel_hi:[1,0,0]
v_pk_fma_f32 v[118:119], v[110:111], v[86:87], v[240:241] op_sel:[0,0,0] op_sel_hi:[1,0,0]
v_pk_fma_f32 v[120:121], v[112:113], v[86:87], v[240:241] op_sel:[0,0,0] op_sel_hi:[1,0,0]
v_pk_fma_f32 v[122:123], v[114:115], v[86:87], v[240:241] op_sel:[0,0,0] op_sel_hi:[1,0,0]
v_pk_fma_f32 v[196:197], v[220:221], v[88:89], v[242:243] op_sel:[0,0,0] op_sel_hi:[1,0,0]
v_pk_fma_f32 v[198:199], v[222:223], v[88:89], v[242:243] op_sel:[0,0,0] op_sel_hi:[1,0,0]
v_pk_fma_f32 v[200:201], v[224:225], v[88:89], v[242:243] op_sel:[0,0,0] op_sel_hi:[1,0,0]
v_pk_fma_f32 v[202:203], v[226:227], v[88:89], v[242:243] op_sel:[0,0,0] op_sel_hi:[1,0,0]
v_pk_fma_f32 v[108:109], v[108:109], v[86:87], v[240:241] op_sel:[0,0,1] op_sel_hi:[1,0,1] neg_lo:[1,0,0] neg_hi:[1,0,0]
v_pk_fma_f32 v[110:111], v[110:111], v[86:87], v[240:241] op_sel:[0,0,1] op_sel_hi:[1,0,1] neg_lo:[1,0,0] neg_hi:[1,0,0]
v_pk_fma_f32 v[112:113], v[112:113], v[86:87], v[240:241] op_sel:[0,0,1] op_sel_hi:[1,0,1] neg_lo:[1,0,0] neg_hi:[1,0,0]
v_pk_fma_f32 v[114:115], v[114:115], v[86:87], v[240:241] op_sel:[0,0,1] op_sel_hi:[1,0,1] neg_lo:[1,0,0] neg_hi:[1,0,0]
v_pk_fma_f32 v[220:221], v[220:221], v[88:89], v[242:243] op_sel:[0,0,1] op_sel_hi:[1,0,1] neg_lo:[1,0,0] neg_hi:[1,0,0]
buffer_load_dwordx4 v[64:67], v1, s[4:7], s99 offen offset:0 sc1
v_pk_fma_f32 v[222:223], v[222:223], v[88:89], v[242:243] op_sel:[0,0,1] op_sel_hi:[1,0,1] neg_lo:[1,0,0] neg_hi:[1,0,0]
v_pk_fma_f32 v[224:225], v[224:225], v[88:89], v[242:243] op_sel:[0,0,1] op_sel_hi:[1,0,1] neg_lo:[1,0,0] neg_hi:[1,0,0]
v_pk_fma_f32 v[226:227], v[226:227], v[88:89], v[242:243] op_sel:[0,0,1] op_sel_hi:[1,0,1] neg_lo:[1,0,0] neg_hi:[1,0,0]
v_exp_f32 v116, v116
v_exp_f32 v108, v108
v_exp_f32 v117, v117
v_exp_f32 v109, v109
v_exp_f32 v118, v118
buffer_load_dwordx4 v[68:71], v1, s[4:7], s99 offen offset:1024 sc1
v_exp_f32 v110, v110
v_exp_f32 v119, v119
v_exp_f32 v111, v111
v_exp_f32 v120, v120
v_exp_f32 v112, v112
v_exp_f32 v121, v121
v_exp_f32 v113, v113
buffer_load_dwordx4 v[100:103], v1, s[4:7], s99 offen offset:2048 sc1
v_exp_f32 v122, v122
v_exp_f32 v114, v114
v_exp_f32 v123, v123
v_exp_f32 v115, v115
v_exp_f32 v196, v196
v_exp_f32 v220, v220
v_exp_f32 v197, v197
buffer_load_dwordx4 v[104:107], v1, s[4:7], s99 offen offset:3072 sc1
v_exp_f32 v221, v221
v_exp_f32 v198, v198
v_exp_f32 v222, v222
v_exp_f32 v199, v199
v_exp_f32 v223, v223
v_exp_f32 v200, v200
v_exp_f32 v224, v224
buffer_store_dwordx4 a[248:251], v2, s[4:7], s73 offen offset:0 sc1
v_exp_f32 v201, v201
v_exp_f32 v225, v225
v_exp_f32 v202, v202
v_exp_f32 v226, v226
v_exp_f32 v203, v203
v_exp_f32 v227, v227
v_cvt_pk_bf16_f32 v188, v116, v117
v_cvt_pk_bf16_f32 v189, v118, v119
v_cvt_pk_bf16_f32 v190, v120, v121
v_cvt_pk_bf16_f32 v191, v122, v123
v_cvt_pk_bf16_f32 v192, v108, v109
v_cvt_pk_bf16_f32 v193, v110, v111
v_cvt_pk_bf16_f32 v194, v112, v113
v_cvt_pk_bf16_f32 v195, v114, v115
v_cvt_pk_bf16_f32 v212, v196, v197
v_cvt_pk_bf16_f32 v213, v198, v199
v_cvt_pk_bf16_f32 v214, v200, v201
v_cvt_pk_bf16_f32 v215, v202, v203
v_cvt_pk_bf16_f32 v216, v220, v221
v_cvt_pk_bf16_f32 v217, v222, v223
v_cvt_pk_bf16_f32 v218, v224, v225
v_cvt_pk_bf16_f32 v219, v226, v227
buffer_store_dwordx4 a[248:251], v2, s[4:7], s73 offen offset:1024 sc1
s_waitcnt vmcnt(10)
v_lshlrev_b32 v92, 16, v48
v_and_b32 v93, 0xffff0000, v48
v_lshlrev_b32 v94, 16, v49
v_and_b32 v95, 0xffff0000, v49
v_lshlrev_b32 v96, 16, v50
v_and_b32 v97, 0xffff0000, v50
v_lshlrev_b32 v98, 16, v51
v_and_b32 v99, 0xffff0000, v51
s_waitcnt vmcnt(9)
v_add_f32_dpp v128, v124, v124 row_ror:4 row_mask:0xf bank_mask:0xf
v_add_f32_dpp v129, v125, v125 row_ror:4 row_mask:0xf bank_mask:0xf
v_add_f32_dpp v130, v126, v126 row_ror:4 row_mask:0xf bank_mask:0xf
v_add_f32_dpp v131, v127, v127 row_ror:4 row_mask:0xf bank_mask:0xf
v_add_f32_dpp v128, v128, v128 row_ror:2 row_mask:0xf bank_mask:0xf
v_add_f32_dpp v129, v129, v129 row_ror:2 row_mask:0xf bank_mask:0xf
v_add_f32_dpp v130, v130, v130 row_ror:2 row_mask:0xf bank_mask:0xf
buffer_store_dwordx4 a[248:251], v2, s[4:7], s73 offen offset:2048 sc1
v_add_f32_dpp v131, v131, v131 row_ror:2 row_mask:0xf bank_mask:0xf
v_add_f32_dpp v128, v128, v128 row_ror:1 row_mask:0xf bank_mask:0xf
v_add_f32_dpp v129, v129, v129 row_ror:1 row_mask:0xf bank_mask:0xf
v_add_f32_dpp v130, v130, v130 row_ror:1 row_mask:0xf bank_mask:0xf
v_add_f32_dpp v131, v131, v131 row_ror:1 row_mask:0xf bank_mask:0xf
s_waitcnt vmcnt(9)
v_dot2c_f32_bf16 v92, v52, v249
v_dot2c_f32_bf16 v93, v52, v250
v_dot2c_f32_bf16 v94, v53, v249
v_dot2c_f32_bf16 v95, v53, v250
v_dot2c_f32_bf16 v96, v54, v249
v_dot2c_f32_bf16 v97, v54, v250
v_dot2c_f32_bf16 v98, v55, v249
v_dot2c_f32_bf16 v99, v55, v250
v_fma_f32 v135, v129, v130, v131
s_waitcnt vmcnt(8)
v_dot2c_f32_bf16 v92, v56, v249
v_dot2c_f32_bf16 v93, v56, v250
v_dot2c_f32_bf16 v94, v57, v249
v_dot2c_f32_bf16 v95, v57, v250
v_dot2c_f32_bf16 v96, v58, v249
v_dot2c_f32_bf16 v97, v58, v250
v_dot2c_f32_bf16 v98, v59, v249
v_dot2c_f32_bf16 v99, v59, v250
buffer_store_dwordx4 a[248:251], v2, s[4:7], s73 offen offset:3072 sc1
s_waitcnt vmcnt(8)
v_dot2c_f32_bf16 v92, v60, v249
v_dot2c_f32_bf16 v93, v60, v250
v_dot2c_f32_bf16 v94, v61, v249
v_dot2c_f32_bf16 v95, v61, v250
v_dot2c_f32_bf16 v96, v62, v249
v_dot2c_f32_bf16 v97, v62, v250
v_dot2c_f32_bf16 v98, v63, v249
v_dot2c_f32_bf16 v99, v63, v250
s_waitcnt vmcnt(7)
v_dot2c_f32_bf16 v92, v64, v249
v_dot2c_f32_bf16 v93, v64, v250
v_dot2c_f32_bf16 v94, v65, v249
v_dot2c_f32_bf16 v95, v65, v250
v_dot2c_f32_bf16 v96, v66, v249
v_dot2c_f32_bf16 v97, v66, v250
v_dot2c_f32_bf16 v98, v67, v249
v_dot2c_f32_bf16 v99, v67, v250
s_waitcnt vmcnt(6)
v_dot2c_f32_bf16 v92, v68, v249
v_dot2c_f32_bf16 v93, v68, v250
v_dot2c_f32_bf16 v94, v69, v249
v_dot2c_f32_bf16 v95, v69, v250
v_dot2c_f32_bf16 v96, v70, v249
v_dot2c_f32_bf16 v97, v70, v250
v_dot2c_f32_bf16 v98, v71, v249
v_dot2c_f32_bf16 v99, v71, v250
s_waitcnt vmcnt(5)
v_dot2c_f32_bf16 v92, v100, v249
v_dot2c_f32_bf16 v93, v100, v250
v_dot2c_f32_bf16 v94, v101, v249
v_dot2c_f32_bf16 v95, v101, v250
v_dot2c_f32_bf16 v96, v102, v249
v_dot2c_f32_bf16 v97, v102, v250
v_dot2c_f32_bf16 v98, v103, v249
v_dot2c_f32_bf16 v99, v103, v250
s_waitcnt vmcnt(4)
v_dot2c_f32_bf16 v92, v104, v249
v_dot2c_f32_bf16 v93, v104, v250
v_dot2c_f32_bf16 v94, v105, v249
v_dot2c_f32_bf16 v95, v105, v250
v_dot2c_f32_bf16 v96, v106, v249
v_dot2c_f32_bf16 v97, v106, v250
v_dot2c_f32_bf16 v98, v107, v249
v_dot2c_f32_bf16 v99, v107, v250
v_fma_f32 v132, v92, v93, v94
v_fma_f32 v133, v95, v96, v97
s_nop 0
v_fma_f32 v134, v98, v99, v128
v_fma_f32 v132, v132, v133, v134
v_cmp_u_f32 vcc, v132, v135
s_cbranch_vccnz L_kvredo1
L_kvback1:
v_cvt_pk_bf16_f32 v128, v128, v129
v_cvt_pk_bf16_f32 v129, v130, v131
v_cvt_pk_bf16_f32 v92, v92, v93
v_cndmask_b32 v128, 0, v128, s[56:57]
v_cndmask_b32 v129, 0, v129, s[56:57]
v_cvt_pk_bf16_f32 v93, v94, v95
v_cvt_pk_bf16_f32 v94, v96, v97
v_cvt_pk_bf16_f32 v95, v98, v99
v_cndmask_b32 v128, v128, v16, s[58:59]
v_cndmask_b32 v129, v129, v16, s[58:59]
ds_write_b64 v252, v[92:93] offset:0
ds_write_b64 v252, v[94:95] offset:1024
ds_write_b64 v252, v[128:129] offset:2048
s_waitcnt lgkmcnt(0)
s_barrier
ds_read_b128 a[8:11], v1 offset:2048
ds_read_b128 a[20:23], v1 offset:5120
ds_read_b128 a[0:3], v1 offset:0
ds_read_b128 a[12:15], v1 offset:3072
ds_read_b128 a[4:7], v1 offset:1024
ds_read_b128 a[16:19], v1 offset:4096
s_waitcnt lgkmcnt(5)
v_mfma_f32_16x16x32_bf16 v[116:119], a[8:11], v[212:215], 0
s_waitcnt lgkmcnt(4)
v_mfma_f32_16x16x32_bf16 v[120:123], a[20:23], v[216:219], 0
s_waitcnt lgkmcnt(3)
v_mfma_f32_16x16x32_bf16 v[204:207], a[0:3], v[212:215], 0
s_nop 3
v_rcp_f32 v118, v117
s_waitcnt lgkmcnt(2)
v_mfma_f32_16x16x32_bf16 v[220:223], a[12:15], v[216:219], 0
v_rcp_f32 v119, v121
v_mul_f32 v116, v116, v118
v_fmac_f32 v116, v120, v119
v_mfma_f32_16x16x32_bf16 v[100:103], a[8:11], v[164:167], 0
v_add_f32 v116, 0x358637bd, v116
v_rcp_f32 v116, v116
s_waitcnt lgkmcnt(1)
v_mfma_f32_16x16x32_bf16 v[208:211], a[4:7], v[212:215], 0
v_mul_f32 v118, v118, v116
v_mul_f32 v119, v119, v116
v_mfma_f32_16x16x32_bf16 v[104:107], a[20:23], v[168:171], 0
v_mul_f32 v204, v204, v118
v_mul_f32 v205, v205, v118
s_waitcnt lgkmcnt(0)
v_mfma_f32_16x16x32_bf16 v[224:227], a[16:19], v[216:219], 0
v_mul_f32 v206, v206, v118
v_mul_f32 v207, v207, v118
v_fmac_f32 v204, v220, v119
v_fmac_f32 v205, v221, v119
v_rcp_f32 v102, v101
v_mul_f32 v208, v208, v118
v_mul_f32 v209, v209, v118
v_mul_f32 v210, v210, v118
buffer_atomic_add v12, v10, s[4:7], s74 offen sc1
v_mul_f32 v211, v211, v118
v_fmac_f32 v206, v222, v119
v_fmac_f32 v207, v223, v119
v_cvt_pk_bf16_f32 v204, v204, v205
v_rcp_f32 v103, v105
v_fmac_f32 v208, v224, v119
v_fmac_f32 v209, v225, v119
v_fmac_f32 v210, v226, v119
v_fmac_f32 v211, v227, v119
v_cvt_pk_bf16_f32 v205, v206, v207
v_cvt_pk_bf16_f32 v206, v208, v209
v_cvt_pk_bf16_f32 v207, v210, v211
v_mul_f32 v100, v100, v102
v_mfma_f32_16x16x32_bf16 v[156:159], a[0:3], v[164:167], 0
buffer_store_dwordx4 v[204:207], v2, s[4:7], s72 offen offset:3072 sc1
v_fmac_f32 v100, v104, v103
v_mfma_f32_16x16x32_bf16 v[172:175], a[12:15], v[168:171], 0
v_add_f32 v100, 0x358637bd, v100
v_rcp_f32 v100, v100
v_mfma_f32_16x16x32_bf16 v[108:111], a[8:11], v[188:191], 0
v_mul_f32 v102, v102, v100
v_mul_f32 v103, v103, v100
v_mfma_f32_16x16x32_bf16 v[160:163], a[4:7], v[164:167], 0
v_mul_f32 v156, v156, v102
v_mul_f32 v157, v157, v102
v_mfma_f32_16x16x32_bf16 v[112:115], a[20:23], v[192:195], 0
v_mul_f32 v158, v158, v102
v_mul_f32 v159, v159, v102
v_mfma_f32_16x16x32_bf16 v[176:179], a[16:19], v[168:171], 0
v_fmac_f32 v156, v172, v103
v_fmac_f32 v157, v173, v103
v_rcp_f32 v110, v109
v_mul_f32 v160, v160, v102
v_mul_f32 v161, v161, v102
v_mul_f32 v162, v162, v102
v_mul_f32 v163, v163, v102
v_fmac_f32 v158, v174, v103
v_fmac_f32 v159, v175, v103
v_cvt_pk_bf16_f32 v156, v156, v157
v_rcp_f32 v111, v113
v_fmac_f32 v160, v176, v103
v_fmac_f32 v161, v177, v103
v_fmac_f32 v162, v178, v103
v_fmac_f32 v163, v179, v103
v_cvt_pk_bf16_f32 v157, v158, v159
v_cvt_pk_bf16_f32 v158, v160, v161
v_cvt_pk_bf16_f32 v159, v162, v163
v_mul_f32 v108, v108, v110
v_mfma_f32_16x16x32_bf16 v[180:183], a[0:3], v[188:191], 0
buffer_store_dwordx4 v[156:159], v2, s[4:7], s72 offen offset:1024 sc1
v_fmac_f32 v108, v112, v111
v_mfma_f32_16x16x32_bf16 v[196:199], a[12:15], v[192:195], 0
v_add_f32 v108, 0x358637bd, v108
v_rcp_f32 v108, v108
v_mfma_f32_16x16x32_bf16 v[92:95], a[8:11], v[140:143], 0
v_mul_f32 v110, v110, v108
v_mul_f32 v111, v111, v108
v_mfma_f32_16x16x32_bf16 v[184:187], a[4:7], v[188:191], 0
v_mul_f32 v180, v180, v110
v_mul_f32 v181, v181, v110
v_mfma_f32_16x16x32_bf16 v[96:99], a[20:23], v[144:147], 0
v_mul_f32 v182, v182, v110
v_mul_f32 v183, v183, v110
v_mfma_f32_16x16x32_bf16 v[200:203], a[16:19], v[192:195], 0
v_fmac_f32 v180, v196, v111
v_fmac_f32 v181, v197, v111
v_rcp_f32 v94, v93
v_mul_f32 v184, v184, v110
v_mul_f32 v185, v185, v110
v_mul_f32 v186, v186, v110
v_mul_f32 v187, v187, v110
v_fmac_f32 v182, v198, v111
v_fmac_f32 v183, v199, v111
v_cvt_pk_bf16_f32 v180, v180, v181
v_rcp_f32 v95, v97
v_fmac_f32 v184, v200, v111
v_fmac_f32 v185, v201, v111
v_fmac_f32 v186, v202, v111
v_fmac_f32 v187, v203, v111
v_cvt_pk_bf16_f32 v181, v182, v183
v_cvt_pk_bf16_f32 v182, v184, v185
v_cvt_pk_bf16_f32 v183, v186, v187
v_mul_f32 v92, v92, v94
v_mfma_f32_16x16x32_bf16 v[132:135], a[0:3], v[140:143], 0
buffer_store_dwordx4 v[180:183], v2, s[4:7], s72 offen offset:2048 sc1
v_fmac_f32 v92, v96, v95
v_mfma_f32_16x16x32_bf16 v[148:151], a[12:15], v[144:147], 0
v_add_f32 v92, 0x358637bd, v92
v_rcp_f32 v92, v92
v_mfma_f32_16x16x32_bf16 v[136:139], a[4:7], v[140:143], 0
v_mul_f32 v94, v94, v92
v_mul_f32 v95, v95, v92
v_mfma_f32_16x16x32_bf16 v[152:155], a[16:19], v[144:147], 0
v_mul_f32 v132, v132, v94
v_mul_f32 v133, v133, v94
v_mul_f32 v134, v134, v94
v_mul_f32 v135, v135, v94
v_fmac_f32 v132, v148, v95
v_fmac_f32 v133, v149, v95
v_mul_f32 v136, v136, v94
v_mul_f32 v137, v137, v94
v_mul_f32 v138, v138, v94
v_mul_f32 v139, v139, v94
v_fmac_f32 v134, v150, v95
v_fmac_f32 v135, v151, v95
v_cvt_pk_bf16_f32 v132, v132, v133
v_fmac_f32 v136, v152, v95
v_fmac_f32 v137, v153, v95
v_fmac_f32 v138, v154, v95
v_fmac_f32 v139, v155, v95
v_cvt_pk_bf16_f32 v133, v134, v135
v_cvt_pk_bf16_f32 v134, v136, v137
v_cvt_pk_bf16_f32 v135, v138, v139
buffer_store_dwordx4 v[132:135], v2, s[4:7], s72 offen offset:0 sc1
s_add_u32 s92, s71, 0x10000
s_add_u32 s40, s4, 0xc00000
s_addc_u32 s41, s5, 0
v_add_u32 v5, 32768, v1
v_add_u32 v6, 98304, v1
s_mov_b32 s35, s9
v_lshlrev_b32 v132, 16, v32
v_and_b32 v133, 0xffff0000, v32
v_lshlrev_b32 v134, 16, v33
v_and_b32 v135, 0xffff0000, v33
v_lshlrev_b32 v136, 16, v34
v_and_b32 v137, 0xffff0000, v34
v_lshlrev_b32 v138, 16, v35
v_and_b32 v139, 0xffff0000, v35
v_lshlrev_b32 v140, 16, v36
v_and_b32 v141, 0xffff0000, v36
v_lshlrev_b32 v142, 16, v37
v_and_b32 v143, 0xffff0000, v37
v_lshlrev_b32 v144, 16, v38
v_and_b32 v145, 0xffff0000, v38
v_lshlrev_b32 v146, 16, v39
v_and_b32 v147, 0xffff0000, v39
v_lshlrev_b32 v148, 16, v40
v_and_b32 v149, 0xffff0000, v40
v_lshlrev_b32 v150, 16, v41
v_and_b32 v151, 0xffff0000, v41
v_lshlrev_b32 v152, 16, v42
v_and_b32 v153, 0xffff0000, v42
v_lshlrev_b32 v154, 16, v43
v_and_b32 v155, 0xffff0000, v43
v_lshlrev_b32 v156, 16, v44
v_and_b32 v157, 0xffff0000, v44
v_lshlrev_b32 v158, 16, v45
v_and_b32 v159, 0xffff0000, v45
v_lshlrev_b32 v160, 16, v46
v_and_b32 v161, 0xffff0000, v46
v_lshlrev_b32 v162, 16, v47
v_and_b32 v163, 0xffff0000, v47
s_mov_b32 s95, -1
s_mov_b64 exec, 0
s_cmp_eq_u32 s28, 3
s_cbranch_scc1 L_stub9
s_cmp_eq_u32 s28, 2
s_cbranch_scc1 L_stub12
s_cmp_eq_u32 s28, 0
s_cbranch_scc1 L_stub13
L_wret3:
s_mov_b64 exec, -1
s_cmp_lg_u32 s28, 1
s_cbranch_scc1 Lpo_29
s_add_u32 s36, s11, 0x10080
s_mov_b32 s37, 0
v_mov_b32 v11, 0
buffer_atomic_add v11, v251, s[4:7], s36 offen sc0 sc1
s_sleep 4
Lpoll_27:
v_mov_b32 v234, 0
buffer_atomic_add v234, v251, s[4:7], s36 offen sc0 sc1
s_waitcnt vmcnt(1)
v_readfirstlane_b32 s38, v11
s_nop 0
s_cmp_ge_u32 s38, 32
s_cbranch_scc1 Lpe_28
v_mov_b32 v11, 0
buffer_atomic_add v11, v251, s[4:7], s36 offen sc0 sc1
s_waitcnt vmcnt(1)
v_readfirstlane_b32 s38, v234
s_nop 0
s_cmp_ge_u32 s38, 32
s_cbranch_scc1 Lpe_28
s_add_u32 s37, s37, 1
s_cmp_lt_u32 s37, 0x80000
s_cbranch_scc1 Lpoll_27
s_waitcnt vmcnt(0)
Lpo_29:
s_waitcnt vmcnt(0)
Lpe_28:
s_barrier
L_k2go1:
buffer_load_dwordx4 a[0:3], v4, s[40:43], s35 offen offset:0 sc1
buffer_load_dwordx4 a[4:7], v4, s[40:43], s35 offen offset:1024 sc1
s_xor_b32 s35, s9, 4096
buffer_load_dwordx4 a[8:11], v4, s[40:43], s35 offen offset:0 sc1
buffer_load_dwordx4 a[12:15], v4, s[40:43], s35 offen offset:1024 sc1
s_xor_b32 s35, s9, 16384
buffer_load_dwordx4 a[16:19], v4, s[40:43], s35 offen offset:0 sc1
buffer_load_dwordx4 a[20:23], v4, s[40:43], s35 offen offset:1024 sc1
s_xor_b32 s35, s9, 20480
buffer_load_dwordx4 a[24:27], v4, s[40:43], s35 offen offset:0 sc1
buffer_load_dwordx4 a[28:31], v4, s[40:43], s35 offen offset:1024 sc1
s_xor_b32 s35, s9, 32768
buffer_load_dwordx4 a[32:35], v4, s[40:43], s35 offen offset:0 sc1
buffer_load_dwordx4 a[36:39], v4, s[40:43], s35 offen offset:1024 sc1
s_xor_b32 s35, s9, 36864
buffer_load_dwordx4 a[40:43], v4, s[40:43], s35 offen offset:0 sc1
buffer_load_dwordx4 a[44:47], v4, s[40:43], s35 offen offset:1024 sc1
s_xor_b32 s35, s9, 49152
ds_read_b128 a[96:99], v5 offset:0
ds_read_b128 a[100:103], v5 offset:1024
ds_read_b128 a[104:107], v5 offset:2048
ds_read_b128 a[108:111], v5 offset:3072
ds_read_b128 a[112:115], v5 offset:4096
ds_read_b128 a[116:119], v5 offset:5120
ds_read_b128 a[120:123], v5 offset:6144
ds_read_b128 a[124:127], v5 offset:7168
s_waitcnt vmcnt(10) lgkmcnt(4)
v_mfma_f32_16x16x32_bf16 v[132:135], a[96:99], a[0:3], v[132:135]
ds_read_b128 a[128:131], v5 offset:8192
v_mfma_f32_16x16x32_bf16 v[148:151], a[96:99], a[4:7], v[148:151]
ds_read_b128 a[132:135], v5 offset:9216
v_mfma_f32_16x16x32_bf16 v[152:155], a[100:103], a[4:7], v[152:155]
buffer_load_dwordx4 a[48:51], v4, s[40:43], s35 offen offset:0 sc1
v_mfma_f32_16x16x32_bf16 v[136:139], a[100:103], a[0:3], v[136:139]
ds_read_b128 a[136:139], v5 offset:10240
v_mfma_f32_16x16x32_bf16 v[140:143], a[104:107], a[0:3], v[140:143]
ds_read_b128 a[140:143], v5 offset:11264
v_mfma_f32_16x16x32_bf16 v[156:159], a[104:107], a[4:7], v[156:159]
v_mfma_f32_16x16x32_bf16 v[160:163], a[108:111], a[4:7], v[160:163]
buffer_load_dwordx4 a[52:55], v4, s[40:43], s35 offen offset:1024 sc1
s_xor_b32 s35, s9, 53248
v_mfma_f32_16x16x32_bf16 v[144:147], a[108:111], a[0:3], v[144:147]
s_waitcnt vmcnt(10) lgkmcnt(4)
v_mfma_f32_16x16x32_bf16 v[132:135], a[112:115], a[8:11], v[132:135]
ds_read_b128 a[96:99], v5 offset:12288
v_mfma_f32_16x16x32_bf16 v[148:151], a[112:115], a[12:15], v[148:151]
ds_read_b128 a[100:103], v5 offset:13312
v_mfma_f32_16x16x32_bf16 v[152:155], a[116:119], a[12:15], v[152:155]
buffer_load_dwordx4 a[0:3], v4, s[40:43], s35 offen offset:0 sc1
v_mfma_f32_16x16x32_bf16 v[136:139], a[116:119], a[8:11], v[136:139]
ds_read_b128 a[104:107], v5 offset:14336
v_mfma_f32_16x16x32_bf16 v[140:143], a[120:123], a[8:11], v[140:143]
ds_read_b128 a[108:111], v5 offset:15360
v_mfma_f32_16x16x32_bf16 v[156:159], a[120:123], a[12:15], v[156:159]
v_mfma_f32_16x16x32_bf16 v[160:163], a[124:127], a[12:15], v[160:163]
buffer_load_dwordx4 a[4:7], v4, s[40:43], s35 offen offset:1024 sc1
s_xor_b32 s35, s9, 65536
v_mfma_f32_16x16x32_bf16 v[144:147], a[124:127], a[8:11], v[144:147]
s_waitcnt vmcnt(10) lgkmcnt(4)
v_mfma_f32_16x16x32_bf16 v[132:135], a[128:131], a[16:19], v[132:135]
ds_read_b128 a[112:115], v5 offset:16384
v_mfma_f32_16x16x32_bf16 v[148:151], a[128:131], a[20:23], v[148:151]
ds_read_b128 a[116:119], v5 offset:17408
v_mfma_f32_16x16x32_bf16 v[152:155], a[132:135], a[20:23], v[152:155]
buffer_load_dwordx4 a[8:11], v4, s[40:43], s35 offen offset:0 sc1
v_mfma_f32_16x16x32_bf16 v[136:139], a[132:135], a[16:19], v[136:139]
ds_read_b128 a[120:123], v5 offset:18432
v_mfma_f32_16x16x32_bf16 v[140:143], a[136:139], a[16:19], v[140:143]
ds_read_b128 a[124:127], v5 offset:19456
v_mfma_f32_16x16x32_bf16 v[156:159], a[136:139], a[20:23], v[156:159]
v_mfma_f32_16x16x32_bf16 v[160:163], a[140:143], a[20:23], v[160:163]
buffer_load_dwordx4 a[12:15], v4, s[40:43], s35 offen offset:1024 sc1
s_xor_b32 s35, s9, 69632
v_mfma_f32_16x16x32_bf16 v[144:147], a[140:143], a[16:19], v[144:147]
s_waitcnt vmcnt(10) lgkmcnt(4)
v_mfma_f32_16x16x32_bf16 v[132:135], a[96:99], a[24:27], v[132:135]
ds_read_b128 a[128:131], v5 offset:20480
v_mfma_f32_16x16x32_bf16 v[148:151], a[96:99], a[28:31], v[148:151]
ds_read_b128 a[132:135], v5 offset:21504
v_mfma_f32_16x16x32_bf16 v[152:155], a[100:103], a[28:31], v[152:155]
buffer_load_dwordx4 a[16:19], v4, s[40:43], s35 offen offset:0 sc1
v_mfma_f32_16x16x32_bf16 v[136:139], a[100:103], a[24:27], v[136:139]
ds_read_b128 a[136:139], v5 offset:22528
v_mfma_f32_16x16x32_bf16 v[140:143], a[104:107], a[24:27], v[140:143]
ds_read_b128 a[140:143], v5 offset:23552
v_mfma_f32_16x16x32_bf16 v[156:159], a[104:107], a[28:31], v[156:159]
v_mfma_f32_16x16x32_bf16 v[160:163], a[108:111], a[28:31], v[160:163]
buffer_load_dwordx4 a[20:23], v4, s[40:43], s35 offen offset:1024 sc1
s_xor_b32 s35, s9, 81920
v_mfma_f32_16x16x32_bf16 v[144:147], a[108:111], a[24:27], v[144:147]
s_waitcnt vmcnt(10) lgkmcnt(4)
v_mfma_f32_16x16x32_bf16 v[132:135], a[112:115], a[32:35], v[132:135]
ds_read_b128 a[96:99], v5 offset:24576
v_mfma_f32_16x16x32_bf16 v[148:151], a[112:115], a[36:39], v[148:151]
ds_read_b128 a[100:103], v5 offset:25600
v_mfma_f32_16x16x32_bf16 v[152:155], a[116:119], a[36:39], v[152:155]
buffer_load_dwordx4 a[24:27], v4, s[40:43], s35 offen offset:0 sc1
v_mfma_f32_16x16x32_bf16 v[136:139], a[116:119], a[32:35], v[136:139]
ds_read_b128 a[104:107], v5 offset:26624
v_mfma_f32_16x16x32_bf16 v[140:143], a[120:123], a[32:35], v[140:143]
ds_read_b128 a[108:111], v5 offset:27648
v_mfma_f32_16x16x32_bf16 v[156:159], a[120:123], a[36:39], v[156:159]
v_mfma_f32_16x16x32_bf16 v[160:163], a[124:127], a[36:39], v[160:163]
buffer_load_dwordx4 a[28:31], v4, s[40:43], s35 offen offset:1024 sc1
s_xor_b32 s35, s9, 86016
v_mfma_f32_16x16x32_bf16 v[144:147], a[124:127], a[32:35], v[144:147]
s_waitcnt vmcnt(10) lgkmcnt(4)
v_mfma_f32_16x16x32_bf16 v[132:135], a[128:131], a[40:43], v[132:135]
ds_read_b128 a[112:115], v5 offset:28672
v_mfma_f32_16x16x32_bf16 v[148:151], a[128:131], a[44:47], v[148:151]
ds_read_b128 a[116:119], v5 offset:29696
v_mfma_f32_16x16x32_bf16 v[152:155], a[132:135], a[44:47], v[152:155]
buffer_load_dwordx4 a[32:35], v4, s[40:43], s35 offen offset:0 sc1
v_mfma_f32_16x16x32_bf16 v[136:139], a[132:135], a[40:43], v[136:139]
ds_read_b128 a[120:123], v5 offset:30720
v_mfma_f32_16x16x32_bf16 v[140:143], a[136:139], a[40:43], v[140:143]
ds_read_b128 a[124:127], v5 offset:31744
v_mfma_f32_16x16x32_bf16 v[156:159], a[136:139], a[44:47], v[156:159]
v_mfma_f32_16x16x32_bf16 v[160:163], a[140:143], a[44:47], v[160:163]
buffer_load_dwordx4 a[36:39], v4, s[40:43], s35 offen offset:1024 sc1
s_xor_b32 s35, s9, 98304
v_mfma_f32_16x16x32_bf16 v[144:147], a[140:143], a[40:43], v[144:147]
s_waitcnt vmcnt(10) lgkmcnt(4)
v_mfma_f32_16x16x32_bf16 v[132:135], a[96:99], a[48:51], v[132:135]
ds_read_b128 a[128:131], v5 offset:32768
v_mfma_f32_16x16x32_bf16 v[148:151], a[96:99], a[52:55], v[148:151]
ds_read_b128 a[132:135], v5 offset:33792
v_mfma_f32_16x16x32_bf16 v[152:155], a[100:103], a[52:55], v[152:155]
buffer_load_dwordx4 a[40:43], v4, s[40:43], s35 offen offset:0 sc1
v_mfma_f32_16x16x32_bf16 v[136:139], a[100:103], a[48:51], v[136:139]
ds_read_b128 a[136:139], v5 offset:34816
v_mfma_f32_16x16x32_bf16 v[140:143], a[104:107], a[48:51], v[140:143]
ds_read_b128 a[140:143], v5 offset:35840
v_mfma_f32_16x16x32_bf16 v[156:159], a[104:107], a[52:55], v[156:159]
v_mfma_f32_16x16x32_bf16 v[160:163], a[108:111], a[52:55], v[160:163]
buffer_load_dwordx4 a[44:47], v4, s[40:43], s35 offen offset:1024 sc1
s_xor_b32 s35, s9, 102400
v_mfma_f32_16x16x32_bf16 v[144:147], a[108:111], a[48:51], v[144:147]
s_waitcnt vmcnt(10) lgkmcnt(4)
v_mfma_f32_16x16x32_bf16 v[132:135], a[112:115], a[0:3], v[132:135]
ds_read_b128 a[96:99], v5 offset:36864
v_mfma_f32_16x16x32_bf16 v[148:151], a[112:115], a[4:7], v[148:151]
ds_read_b128 a[100:103], v5 offset:37888
v_mfma_f32_16x16x32_bf16 v[152:155], a[116:119], a[4:7], v[152:155]
buffer_load_dwordx4 a[48:51], v4, s[40:43], s35 offen offset:0 sc1
v_mfma_f32_16x16x32_bf16 v[136:139], a[116:119], a[0:3], v[136:139]
ds_read_b128 a[104:107], v5 offset:38912
v_mfma_f32_16x16x32_bf16 v[140:143], a[120:123], a[0:3], v[140:143]
ds_read_b128 a[108:111], v5 offset:39936
v_mfma_f32_16x16x32_bf16 v[156:159], a[120:123], a[4:7], v[156:159]
v_mfma_f32_16x16x32_bf16 v[160:163], a[124:127], a[4:7], v[160:163]
buffer_load_dwordx4 a[52:55], v4, s[40:43], s35 offen offset:1024 sc1
s_xor_b32 s35, s9, 114688
v_mfma_f32_16x16x32_bf16 v[144:147], a[124:127], a[0:3], v[144:147]
s_waitcnt vmcnt(10) lgkmcnt(4)
v_mfma_f32_16x16x32_bf16 v[132:135], a[128:131], a[8:11], v[132:135]
ds_read_b128 a[112:115], v5 offset:40960
v_mfma_f32_16x16x32_bf16 v[148:151], a[128:131], a[12:15], v[148:151]
ds_read_b128 a[116:119], v5 offset:41984
L_stub9:
s_cbranch_execz L_wret3
v_mfma_f32_16x16x32_bf16 v[152:155], a[132:135], a[12:15], v[152:155]
buffer_load_dwordx4 a[0:3], v4, s[40:43], s35 offen offset:0 sc1
v_mfma_f32_16x16x32_bf16 v[136:139], a[132:135], a[8:11], v[136:139]
ds_read_b128 a[120:123], v5 offset:43008
v_mfma_f32_16x16x32_bf16 v[140:143], a[136:139], a[8:11], v[140:143]
ds_read_b128 a[124:127], v5 offset:44032
v_mfma_f32_16x16x32_bf16 v[156:159], a[136:139], a[12:15], v[156:159]
v_mfma_f32_16x16x32_bf16 v[160:163], a[140:143], a[12:15], v[160:163]
buffer_load_dwordx4 a[4:7], v4, s[40:43], s35 offen offset:1024 sc1
s_xor_b32 s35, s9, 118784
v_mfma_f32_16x16x32_bf16 v[144:147], a[140:143], a[8:11], v[144:147]
s_waitcnt vmcnt(10) lgkmcnt(4)
v_mfma_f32_16x16x32_bf16 v[132:135], a[96:99], a[16:19], v[132:135]
ds_read_b128 a[128:131], v5 offset:45056
v_mfma_f32_16x16x32_bf16 v[148:151], a[96:99], a[20:23], v[148:151]
ds_read_b128 a[132:135], v5 offset:46080
v_mfma_f32_16x16x32_bf16 v[152:155], a[100:103], a[20:23], v[152:155]
buffer_load_dwordx4 a[8:11], v4, s[40:43], s35 offen offset:0 sc1
v_mfma_f32_16x16x32_bf16 v[136:139], a[100:103], a[16:19], v[136:139]
ds_read_b128 a[136:139], v5 offset:47104
v_mfma_f32_16x16x32_bf16 v[140:143], a[104:107], a[16:19], v[140:143]
ds_read_b128 a[140:143], v5 offset:48128
v_mfma_f32_16x16x32_bf16 v[156:159], a[104:107], a[20:23], v[156:159]
v_mfma_f32_16x16x32_bf16 v[160:163], a[108:111], a[20:23], v[160:163]
buffer_load_dwordx4 a[12:15], v4, s[40:43], s35 offen offset:1024 sc1
s_xor_b32 s35, s9, 524288
v_mfma_f32_16x16x32_bf16 v[144:147], a[108:111], a[16:19], v[144:147]
s_waitcnt vmcnt(10) lgkmcnt(4)
v_mfma_f32_16x16x32_bf16 v[132:135], a[112:115], a[24:27], v[132:135]
ds_read_b128 a[96:99], v5 offset:49152
v_mfma_f32_16x16x32_bf16 v[148:151], a[112:115], a[28:31], v[148:151]
ds_read_b128 a[100:103], v5 offset:50176
v_mfma_f32_16x16x32_bf16 v[152:155], a[116:119], a[28:31], v[152:155]
buffer_load_dwordx4 a[16:19], v4, s[40:43], s35 offen offset:0 sc1
v_mfma_f32_16x16x32_bf16 v[136:139], a[116:119], a[24:27], v[136:139]
ds_read_b128 a[104:107], v5 offset:51200
v_mfma_f32_16x16x32_bf16 v[140:143], a[120:123], a[24:27], v[140:143]
ds_read_b128 a[108:111], v5 offset:52224
v_mfma_f32_16x16x32_bf16 v[156:159], a[120:123], a[28:31], v[156:159]
v_mfma_f32_16x16x32_bf16 v[160:163], a[124:127], a[28:31], v[160:163]
buffer_load_dwordx4 a[20:23], v4, s[40:43], s35 offen offset:1024 sc1
s_xor_b32 s35, s9, 528384
v_mfma_f32_16x16x32_bf16 v[144:147], a[124:127], a[24:27], v[144:147]
s_waitcnt vmcnt(10) lgkmcnt(4)
v_mfma_f32_16x16x32_bf16 v[132:135], a[128:131], a[32:35], v[132:135]
ds_read_b128 a[112:115], v5 offset:53248
v_mfma_f32_16x16x32_bf16 v[148:151], a[128:131], a[36:39], v[148:151]
ds_read_b128 a[116:119], v5 offset:54272
v_mfma_f32_16x16x32_bf16 v[152:155], a[132:135], a[36:39], v[152:155]
buffer_load_dwordx4 a[24:27], v4, s[40:43], s35 offen offset:0 sc1
v_mfma_f32_16x16x32_bf16 v[136:139], a[132:135], a[32:35], v[136:139]
ds_read_b128 a[120:123], v5 offset:55296
v_mfma_f32_16x16x32_bf16 v[140:143], a[136:139], a[32:35], v[140:143]
ds_read_b128 a[124:127], v5 offset:56320
v_mfma_f32_16x16x32_bf16 v[156:159], a[136:139], a[36:39], v[156:159]
v_mfma_f32_16x16x32_bf16 v[160:163], a[140:143], a[36:39], v[160:163]
buffer_load_dwordx4 a[28:31], v4, s[40:43], s35 offen offset:1024 sc1
s_xor_b32 s35, s9, 540672
v_mfma_f32_16x16x32_bf16 v[144:147], a[140:143], a[32:35], v[144:147]
s_waitcnt vmcnt(10) lgkmcnt(4)
v_mfma_f32_16x16x32_bf16 v[132:135], a[96:99], a[40:43], v[132:135]
ds_read_b128 a[128:131], v5 offset:57344
v_mfma_f32_16x16x32_bf16 v[148:151], a[96:99], a[44:47], v[148:151]
ds_read_b128 a[132:135], v5 offset:58368
v_mfma_f32_16x16x32_bf16 v[152:155], a[100:103], a[44:47], v[152:155]
buffer_load_dwordx4 a[32:35], v4, s[40:43], s35 offen offset:0 sc1
v_mfma_f32_16x16x32_bf16 v[136:139], a[100:103], a[40:43], v[136:139]
ds_read_b128 a[136:139], v5 offset:59392
v_mfma_f32_16x16x32_bf16 v[140:143], a[104:107], a[40:43], v[140:143]
ds_read_b128 a[140:143], v5 offset:60416
v_mfma_f32_16x16x32_bf16 v[156:159], a[104:107], a[44:47], v[156:159]
v_mfma_f32_16x16x32_bf16 v[160:163], a[108:111], a[44:47], v[160:163]
buffer_load_dwordx4 a[36:39], v4, s[40:43], s35 offen offset:1024 sc1
s_xor_b32 s35, s9, 544768
v_mfma_f32_16x16x32_bf16 v[144:147], a[108:111], a[40:43], v[144:147]
s_waitcnt vmcnt(10) lgkmcnt(4)
v_mfma_f32_16x16x32_bf16 v[132:135], a[112:115], a[48:51], v[132:135]
ds_read_b128 a[96:99], v5 offset:61440
v_mfma_f32_16x16x32_bf16 v[148:151], a[112:115], a[52:55], v[148:151]
ds_read_b128 a[100:103], v5 offset:62464
v_mfma_f32_16x16x32_bf16 v[152:155], a[116:119], a[52:55], v[152:155]
buffer_load_dwordx4 a[40:43], v4, s[40:43], s35 offen offset:0 sc1
v_mfma_f32_16x16x32_bf16 v[136:139], a[116:119], a[48:51], v[136:139]
ds_read_b128 a[104:107], v5 offset:63488
v_mfma_f32_16x16x32_bf16 v[140:143], a[120:123], a[48:51], v[140:143]
ds_read_b128 a[108:111], v5 offset:64512
v_mfma_f32_16x16x32_bf16 v[156:159], a[120:123], a[52:55], v[156:159]
v_mfma_f32_16x16x32_bf16 v[160:163], a[124:127], a[52:55], v[160:163]
buffer_load_dwordx4 a[44:47], v4, s[40:43], s35 offen offset:1024 sc1
s_xor_b32 s35, s9, 557056
v_mfma_f32_16x16x32_bf16 v[144:147], a[124:127], a[48:51], v[144:147]
s_waitcnt vmcnt(10) lgkmcnt(4)
v_mfma_f32_16x16x32_bf16 v[132:135], a[128:131], a[0:3], v[132:135]
ds_read_b128 a[112:115], v6 offset:0
v_mfma_f32_16x16x32_bf16 v[148:151], a[128:131], a[4:7], v[148:151]
ds_read_b128 a[116:119], v6 offset:1024
v_mfma_f32_16x16x32_bf16 v[152:155], a[132:135], a[4:7], v[152:155]
buffer_load_dwordx4 a[48:51], v4, s[40:43], s35 offen offset:0 sc1
v_mfma_f32_16x16x32_bf16 v[136:139], a[132:135], a[0:3], v[136:139]
ds_read_b128 a[120:123], v6 offset:2048
v_mfma_f32_16x16x32_bf16 v[140:143], a[136:139], a[0:3], v[140:143]
ds_read_b128 a[124:127], v6 offset:3072
v_mfma_f32_16x16x32_bf16 v[156:159], a[136:139], a[4:7], v[156:159]
v_mfma_f32_16x16x32_bf16 v[160:163], a[140:143], a[4:7], v[160:163]
buffer_load_dwordx4 a[52:55], v4, s[40:43], s35 offen offset:1024 sc1
s_xor_b32 s35, s9, 561152
v_mfma_f32_16x16x32_bf16 v[144:147], a[140:143], a[0:3], v[144:147]
s_waitcnt vmcnt(10) lgkmcnt(4)
v_mfma_f32_16x16x32_bf16 v[132:135], a[96:99], a[8:11], v[132:135]
ds_read_b128 a[128:131], v6 offset:4096
v_mfma_f32_16x16x32_bf16 v[148:151], a[96:99], a[12:15], v[148:151]
ds_read_b128 a[132:135], v6 offset:5120
v_mfma_f32_16x16x32_bf16 v[152:155], a[100:103], a[12:15], v[152:155]
buffer_load_dwordx4 a[0:3], v4, s[40:43], s35 offen offset:0 sc1
v_mfma_f32_16x16x32_bf16 v[136:139], a[100:103], a[8:11], v[136:139]
ds_read_b128 a[136:139], v6 offset:6144
v_mfma_f32_16x16x32_bf16 v[140:143], a[104:107], a[8:11], v[140:143]
ds_read_b128 a[140:143], v6 offset:7168
v_mfma_f32_16x16x32_bf16 v[156:159], a[104:107], a[12:15], v[156:159]
v_mfma_f32_16x16x32_bf16 v[160:163], a[108:111], a[12:15], v[160:163]
buffer_load_dwordx4 a[4:7], v4, s[40:43], s35 offen offset:1024 sc1
s_xor_b32 s35, s9, 573440
v_mfma_f32_16x16x32_bf16 v[144:147], a[108:111], a[8:11], v[144:147]
s_waitcnt vmcnt(10) lgkmcnt(4)
v_mfma_f32_16x16x32_bf16 v[132:135], a[112:115], a[16:19], v[132:135]
ds_read_b128 a[96:99], v6 offset:8192
v_mfma_f32_16x16x32_bf16 v[148:151], a[112:115], a[20:23], v[148:151]
ds_read_b128 a[100:103], v6 offset:9216
v_mfma_f32_16x16x32_bf16 v[152:155], a[116:119], a[20:23], v[152:155]
buffer_load_dwordx4 a[8:11], v4, s[40:43], s35 offen offset:0 sc1
v_mfma_f32_16x16x32_bf16 v[136:139], a[116:119], a[16:19], v[136:139]
ds_read_b128 a[104:107], v6 offset:10240
v_mfma_f32_16x16x32_bf16 v[140:143], a[120:123], a[16:19], v[140:143]
ds_read_b128 a[108:111], v6 offset:11264
v_mfma_f32_16x16x32_bf16 v[156:159], a[120:123], a[20:23], v[156:159]
v_mfma_f32_16x16x32_bf16 v[160:163], a[124:127], a[20:23], v[160:163]
buffer_load_dwordx4 a[12:15], v4, s[40:43], s35 offen offset:1024 sc1
s_xor_b32 s35, s9, 577536
v_mfma_f32_16x16x32_bf16 v[144:147], a[124:127], a[16:19], v[144:147]
s_waitcnt vmcnt(10) lgkmcnt(4)
v_mfma_f32_16x16x32_bf16 v[132:135], a[128:131], a[24:27], v[132:135]
ds_read_b128 a[112:115], v6 offset:12288
v_mfma_f32_16x16x32_bf16 v[148:151], a[128:131], a[28:31], v[148:151]
ds_read_b128 a[116:119], v6 offset:13312
v_mfma_f32_16x16x32_bf16 v[152:155], a[132:135], a[28:31], v[152:155]
buffer_load_dwordx4 a[16:19], v4, s[40:43], s35 offen offset:0 sc1
v_mfma_f32_16x16x32_bf16 v[136:139], a[132:135], a[24:27], v[136:139]
ds_read_b128 a[120:123], v6 offset:14336
v_mfma_f32_16x16x32_bf16 v[140:143], a[136:139], a[24:27], v[140:143]
ds_read_b128 a[124:127], v6 offset:15360
v_mfma_f32_16x16x32_bf16 v[156:159], a[136:139], a[28:31], v[156:159]
v_mfma_f32_16x16x32_bf16 v[160:163], a[140:143], a[28:31], v[160:163]
buffer_load_dwordx4 a[20:23], v4, s[40:43], s35 offen offset:1024 sc1
s_xor_b32 s35, s9, 589824
v_mfma_f32_16x16x32_bf16 v[144:147], a[140:143], a[24:27], v[144:147]
s_waitcnt vmcnt(10) lgkmcnt(4)
v_mfma_f32_16x16x32_bf16 v[132:135], a[96:99], a[32:35], v[132:135]
ds_read_b128 a[128:131], v6 offset:16384
v_mfma_f32_16x16x32_bf16 v[148:151], a[96:99], a[36:39], v[148:151]
ds_read_b128 a[132:135], v6 offset:17408
v_mfma_f32_16x16x32_bf16 v[152:155], a[100:103], a[36:39], v[152:155]
buffer_load_dwordx4 a[24:27], v4, s[40:43], s35 offen offset:0 sc1
v_mfma_f32_16x16x32_bf16 v[136:139], a[100:103], a[32:35], v[136:139]
ds_read_b128 a[136:139], v6 offset:18432
v_mfma_f32_16x16x32_bf16 v[140:143], a[104:107], a[32:35], v[140:143]
ds_read_b128 a[140:143], v6 offset:19456
v_mfma_f32_16x16x32_bf16 v[156:159], a[104:107], a[36:39], v[156:159]
v_mfma_f32_16x16x32_bf16 v[160:163], a[108:111], a[36:39], v[160:163]
buffer_load_dwordx4 a[28:31], v4, s[40:43], s35 offen offset:1024 sc1
s_xor_b32 s35, s9, 593920
v_mfma_f32_16x16x32_bf16 v[144:147], a[108:111], a[32:35], v[144:147]
s_waitcnt vmcnt(10) lgkmcnt(4)
v_mfma_f32_16x16x32_bf16 v[132:135], a[112:115], a[40:43], v[132:135]
ds_read_b128 a[96:99], v6 offset:20480
v_mfma_f32_16x16x32_bf16 v[148:151], a[112:115], a[44:47], v[148:151]
ds_read_b128 a[100:103], v6 offset:21504
v_mfma_f32_16x16x32_bf16 v[152:155], a[116:119], a[44:47], v[152:155]
buffer_load_dwordx4 a[32:35], v4, s[40:43], s35 offen offset:0 sc1
v_mfma_f32_16x16x32_bf16 v[136:139], a[116:119], a[40:43], v[136:139]
ds_read_b128 a[104:107], v6 offset:22528
v_mfma_f32_16x16x32_bf16 v[140:143], a[120:123], a[40:43], v[140:143]
ds_read_b128 a[108:111], v6 offset:23552
v_mfma_f32_16x16x32_bf16 v[156:159], a[120:123], a[44:47], v[156:159]
v_mfma_f32_16x16x32_bf16 v[160:163], a[124:127], a[44:47], v[160:163]
buffer_load_dwordx4 a[36:39], v4, s[40:43], s35 offen offset:1024 sc1
s_xor_b32 s35, s9, 606208
v_mfma_f32_16x16x32_bf16 v[144:147], a[124:127], a[40:43], v[144:147]
s_waitcnt vmcnt(10) lgkmcnt(4)
v_mfma_f32_16x16x32_bf16 v[132:135], a[128:131], a[48:51], v[132:135]
ds_read_b128 a[112:115], v6 offset:24576
v_mfma_f32_16x16x32_bf16 v[148:151], a[128:131], a[52:55], v[148:151]
ds_read_b128 a[116:119], v6 offset:25600
v_mfma_f32_16x16x32_bf16 v[152:155], a[132:135], a[52:55], v[152:155]
buffer_load_dwordx4 a[40:43], v4, s[40:43], s35 offen offset:0 sc1
v_mfma_f32_16x16x32_bf16 v[136:139], a[132:135], a[48:51], v[136:139]
ds_read_b128 a[120:123], v6 offset:26624
v_mfma_f32_16x16x32_bf16 v[140:143], a[136:139], a[48:51], v[140:143]
ds_read_b128 a[124:127], v6 offset:27648
v_mfma_f32_16x16x32_bf16 v[156:159], a[136:139], a[52:55], v[156:159]
v_mfma_f32_16x16x32_bf16 v[160:163], a[140:143], a[52:55], v[160:163]
buffer_load_dwordx4 a[44:47], v4, s[40:43], s35 offen offset:1024 sc1
s_xor_b32 s35, s9, 610304
v_mfma_f32_16x16x32_bf16 v[144:147], a[140:143], a[48:51], v[144:147]
s_waitcnt vmcnt(10) lgkmcnt(4)
v_mfma_f32_16x16x32_bf16 v[132:135], a[96:99], a[0:3], v[132:135]
ds_read_b128 a[128:131], v6 offset:28672
v_mfma_f32_16x16x32_bf16 v[148:151], a[96:99], a[4:7], v[148:151]
ds_read_b128 a[132:135], v6 offset:29696
v_mfma_f32_16x16x32_bf16 v[152:155], a[100:103], a[4:7], v[152:155]
buffer_load_dwordx4 a[48:51], v4, s[40:43], s35 offen offset:0 sc1
v_mfma_f32_16x16x32_bf16 v[136:139], a[100:103], a[0:3], v[136:139]
ds_read_b128 a[136:139], v6 offset:30720
v_mfma_f32_16x16x32_bf16 v[140:143], a[104:107], a[0:3], v[140:143]
ds_read_b128 a[140:143], v6 offset:31744
v_mfma_f32_16x16x32_bf16 v[156:159], a[104:107], a[4:7], v[156:159]
v_mfma_f32_16x16x32_bf16 v[160:163], a[108:111], a[4:7], v[160:163]
buffer_load_dwordx4 a[52:55], v4, s[40:43], s35 offen offset:1024 sc1
s_xor_b32 s35, s9, 622592
v_mfma_f32_16x16x32_bf16 v[144:147], a[108:111], a[0:3], v[144:147]
s_waitcnt vmcnt(10) lgkmcnt(4)
v_mfma_f32_16x16x32_bf16 v[132:135], a[112:115], a[8:11], v[132:135]
ds_read_b128 a[96:99], v6 offset:32768
v_mfma_f32_16x16x32_bf16 v[148:151], a[112:115], a[12:15], v[148:151]
ds_read_b128 a[100:103], v6 offset:33792
v_mfma_f32_16x16x32_bf16 v[152:155], a[116:119], a[12:15], v[152:155]
buffer_load_dwordx4 a[0:3], v4, s[40:43], s35 offen offset:0 sc1
v_mfma_f32_16x16x32_bf16 v[136:139], a[116:119], a[8:11], v[136:139]
ds_read_b128 a[104:107], v6 offset:34816
v_mfma_f32_16x16x32_bf16 v[140:143], a[120:123], a[8:11], v[140:143]
ds_read_b128 a[108:111], v6 offset:35840
v_mfma_f32_16x16x32_bf16 v[156:159], a[120:123], a[12:15], v[156:159]
v_mfma_f32_16x16x32_bf16 v[160:163], a[124:127], a[12:15], v[160:163]
buffer_load_dwordx4 a[4:7], v4, s[40:43], s35 offen offset:1024 sc1
s_xor_b32 s35, s9, 626688
v_mfma_f32_16x16x32_bf16 v[144:147], a[124:127], a[8:11], v[144:147]
s_waitcnt vmcnt(10) lgkmcnt(4)
v_mfma_f32_16x16x32_bf16 v[132:135], a[128:131], a[16:19], v[132:135]
ds_read_b128 a[112:115], v6 offset:36864
v_mfma_f32_16x16x32_bf16 v[148:151], a[128:131], a[20:23], v[148:151]
ds_read_b128 a[116:119], v6 offset:37888
v_mfma_f32_16x16x32_bf16 v[152:155], a[132:135], a[20:23], v[152:155]
buffer_load_dwordx4 a[8:11], v4, s[40:43], s35 offen offset:0 sc1
v_mfma_f32_16x16x32_bf16 v[136:139], a[132:135], a[16:19], v[136:139]
ds_read_b128 a[120:123], v6 offset:38912
v_mfma_f32_16x16x32_bf16 v[140:143], a[136:139], a[16:19], v[140:143]
ds_read_b128 a[124:127], v6 offset:39936
v_mfma_f32_16x16x32_bf16 v[156:159], a[136:139], a[20:23], v[156:159]
v_mfma_f32_16x16x32_bf16 v[160:163], a[140:143], a[20:23], v[160:163]
buffer_load_dwordx4 a[12:15], v4, s[40:43], s35 offen offset:1024 sc1
s_xor_b32 s35, s9, 638976
v_mfma_f32_16x16x32_bf16 v[144:147], a[140:143], a[16:19], v[144:147]
s_waitcnt vmcnt(10) lgkmcnt(4)
v_mfma_f32_16x16x32_bf16 v[132:135], a[96:99], a[24:27], v[132:135]
ds_read_b128 a[128:131], v6 offset:40960
v_mfma_f32_16x16x32_bf16 v[148:151], a[96:99], a[28:31], v[148:151]
ds_read_b128 a[132:135], v6 offset:41984
v_mfma_f32_16x16x32_bf16 v[152:155], a[100:103], a[28:31], v[152:155]
buffer_load_dwordx4 a[16:19], v4, s[40:43], s35 offen offset:0 sc1
v_mfma_f32_16x16x32_bf16 v[136:139], a[100:103], a[24:27], v[136:139]
ds_read_b128 a[136:139], v6 offset:43008
v_mfma_f32_16x16x32_bf16 v[140:143], a[104:107], a[24:27], v[140:143]
ds_read_b128 a[140:143], v6 offset:44032
v_mfma_f32_16x16x32_bf16 v[156:159], a[104:107], a[28:31], v[156:159]
v_mfma_f32_16x16x32_bf16 v[160:163], a[108:111], a[28:31], v[160:163]
buffer_load_dwordx4 a[20:23], v4, s[40:43], s35 offen offset:1024 sc1
s_xor_b32 s35, s9, 643072
v_mfma_f32_16x16x32_bf16 v[144:147], a[108:111], a[24:27], v[144:147]
s_waitcnt vmcnt(10) lgkmcnt(4)
v_mfma_f32_16x16x32_bf16 v[132:135], a[112:115], a[32:35], v[132:135]
ds_read_b128 a[96:99], v6 offset:45056
v_mfma_f32_16x16x32_bf16 v[148:151], a[112:115], a[36:39], v[148:151]
ds_read_b128 a[100:103], v6 offset:46080
v_mfma_f32_16x16x32_bf16 v[152:155], a[116:119], a[36:39], v[152:155]
buffer_load_dwordx4 a[24:27], v4, s[40:43], s35 offen offset:0 sc1
v_mfma_f32_16x16x32_bf16 v[136:139], a[116:119], a[32:35], v[136:139]
ds_read_b128 a[104:107], v6 offset:47104
v_mfma_f32_16x16x32_bf16 v[140:143], a[120:123], a[32:35], v[140:143]
ds_read_b128 a[108:111], v6 offset:48128
v_mfma_f32_16x16x32_bf16 v[156:159], a[120:123], a[36:39], v[156:159]
v_mfma_f32_16x16x32_bf16 v[160:163], a[124:127], a[36:39], v[160:163]
buffer_load_dwordx4 a[28:31], v4, s[40:43], s35 offen offset:1024 sc1
s_xor_b32 s35, s9, 0
v_mfma_f32_16x16x32_bf16 v[144:147], a[124:127], a[32:35], v[144:147]
s_waitcnt vmcnt(10) lgkmcnt(4)
v_mfma_f32_16x16x32_bf16 v[132:135], a[128:131], a[40:43], v[132:135]
s_add_u32 m0, s18, 0x0
s_add_u32 s44, s50, 0x2000000
v_mfma_f32_16x16x32_bf16 v[148:151], a[128:131], a[44:47], v[148:151]
ds_read_b128 a[112:115], v6 offset:49152
v_mfma_f32_16x16x32_bf16 v[152:155], a[132:135], a[44:47], v[152:155]
buffer_load_dwordx4 v1, s[4:7], s44 offen offset:0 sc1 lds
v_mfma_f32_16x16x32_bf16 v[136:139], a[132:135], a[40:43], v[136:139]
ds_read_b128 a[116:119], v6 offset:50176
v_mfma_f32_16x16x32_bf16 v[140:143], a[136:139], a[40:43], v[140:143]
ds_read_b128 a[120:123], v6 offset:51200
v_mfma_f32_16x16x32_bf16 v[156:159], a[136:139], a[44:47], v[156:159]
ds_read_b128 a[124:127], v6 offset:52224
v_mfma_f32_16x16x32_bf16 v[160:163], a[140:143], a[44:47], v[160:163]
buffer_load_dwordx4 v1, s[4:7], s44 offen offset:1024 sc1 lds
s_add_u32 m0, s18, 0x2000
v_mfma_f32_16x16x32_bf16 v[144:147], a[140:143], a[40:43], v[144:147]
s_add_u32 s44, s50, 0x2002000
s_waitcnt vmcnt(10) lgkmcnt(4)
v_mfma_f32_16x16x32_bf16 v[132:135], a[96:99], a[48:51], v[132:135]
ds_read_b128 a[128:131], v6 offset:53248
v_mfma_f32_16x16x32_bf16 v[148:151], a[96:99], a[52:55], v[148:151]
ds_read_b128 a[132:135], v6 offset:54272
v_mfma_f32_16x16x32_bf16 v[152:155], a[100:103], a[52:55], v[152:155]
buffer_load_dwordx4 v1, s[4:7], s44 offen offset:0 sc1 lds
v_mfma_f32_16x16x32_bf16 v[136:139], a[100:103], a[48:51], v[136:139]
ds_read_b128 a[136:139], v6 offset:55296
v_mfma_f32_16x16x32_bf16 v[140:143], a[104:107], a[48:51], v[140:143]
ds_read_b128 a[140:143], v6 offset:56320
v_mfma_f32_16x16x32_bf16 v[156:159], a[104:107], a[52:55], v[156:159]
v_mfma_f32_16x16x32_bf16 v[160:163], a[108:111], a[52:55], v[160:163]
buffer_load_dwordx4 v1, s[4:7], s44 offen offset:1024 sc1 lds
s_add_u32 m0, s18, 0x4000
v_mfma_f32_16x16x32_bf16 v[144:147], a[108:111], a[48:51], v[144:147]
s_add_u32 s44, s50, 0x2004000
s_waitcnt vmcnt(10) lgkmcnt(4)
v_mfma_f32_16x16x32_bf16 v[132:135], a[112:115], a[0:3], v[132:135]
ds_read_b128 a[96:99], v6 offset:57344
v_mfma_f32_16x16x32_bf16 v[148:151], a[112:115], a[4:7], v[148:151]
ds_read_b128 a[100:103], v6 offset:58368
v_mfma_f32_16x16x32_bf16 v[152:155], a[116:119], a[4:7], v[152:155]
ds_read_b128 a[104:107], v6 offset:59392
v_mfma_f32_16x16x32_bf16 v[136:139], a[116:119], a[0:3], v[136:139]
buffer_load_dwordx4 v1, s[4:7], s44 offen offset:0 sc1 lds
v_mfma_f32_16x16x32_bf16 v[140:143], a[120:123], a[0:3], v[140:143]
ds_read_b128 a[108:111], v6 offset:60416
v_mfma_f32_16x16x32_bf16 v[156:159], a[120:123], a[4:7], v[156:159]
v_mfma_f32_16x16x32_bf16 v[160:163], a[124:127], a[4:7], v[160:163]
v_mfma_f32_16x16x32_bf16 v[144:147], a[124:127], a[0:3], v[144:147]
buffer_load_dwordx4 v1, s[4:7], s44 offen offset:1024 sc1 lds
s_waitcnt vmcnt(10) lgkmcnt(4)
v_mfma_f32_16x16x32_bf16 v[132:135], a[128:131], a[8:11], v[132:135]
s_add_u32 m0, s18, 0x6000
s_add_u32 s44, s50, 0x2006000
v_mfma_f32_16x16x32_bf16 v[148:151], a[128:131], a[12:15], v[148:151]
ds_read_b128 a[112:115], v6 offset:61440
v_mfma_f32_16x16x32_bf16 v[152:155], a[132:135], a[12:15], v[152:155]
ds_read_b128 a[116:119], v6 offset:62464
v_mfma_f32_16x16x32_bf16 v[136:139], a[132:135], a[8:11], v[136:139]
ds_read_b128 a[120:123], v6 offset:63488
v_mfma_f32_16x16x32_bf16 v[140:143], a[136:139], a[8:11], v[140:143]
buffer_load_dwordx4 v1, s[4:7], s44 offen offset:0 sc1 lds
v_mfma_f32_16x16x32_bf16 v[156:159], a[136:139], a[12:15], v[156:159]
ds_read_b128 a[124:127], v6 offset:64512
v_mfma_f32_16x16x32_bf16 v[160:163], a[140:143], a[12:15], v[160:163]
v_mfma_f32_16x16x32_bf16 v[144:147], a[140:143], a[8:11], v[144:147]
s_waitcnt vmcnt(9) lgkmcnt(4)
v_mfma_f32_16x16x32_bf16 v[132:135], a[96:99], a[16:19], v[132:135]
v_mfma_f32_16x16x32_bf16 v[148:151], a[96:99], a[20:23], v[148:151]
buffer_load_dwordx4 v1, s[4:7], s44 offen offset:1024 sc1 lds
v_mfma_f32_16x16x32_bf16 v[152:155], a[100:103], a[20:23], v[152:155]
v_mfma_f32_16x16x32_bf16 v[136:139], a[100:103], a[16:19], v[136:139]
v_mfma_f32_16x16x32_bf16 v[140:143], a[104:107], a[16:19], v[140:143]
v_mfma_f32_16x16x32_bf16 v[156:159], a[104:107], a[20:23], v[156:159]
v_mfma_f32_16x16x32_bf16 v[160:163], a[108:111], a[20:23], v[160:163]
v_mfma_f32_16x16x32_bf16 v[144:147], a[108:111], a[16:19], v[144:147]
s_waitcnt vmcnt(8) lgkmcnt(0)
v_mfma_f32_16x16x32_bf16 v[132:135], a[112:115], a[24:27], v[132:135]
v_mfma_f32_16x16x32_bf16 v[148:151], a[112:115], a[28:31], v[148:151]
v_mfma_f32_16x16x32_bf16 v[152:155], a[116:119], a[28:31], v[152:155]
v_mfma_f32_16x16x32_bf16 v[136:139], a[116:119], a[24:27], v[136:139]
v_mfma_f32_16x16x32_bf16 v[140:143], a[120:123], a[24:27], v[140:143]
v_mfma_f32_16x16x32_bf16 v[156:159], a[120:123], a[28:31], v[156:159]
v_mfma_f32_16x16x32_bf16 v[160:163], a[124:127], a[28:31], v[160:163]
v_mfma_f32_16x16x32_bf16 v[144:147], a[124:127], a[24:27], v[144:147]
s_nop 1
v_cmp_u_f32 vcc, v132, v148
s_nop 0
s_and_b32 vcc_lo, vcc_lo, s95
s_cbranch_scc1 L_k2redo1
v_cvt_pk_bf16_f32 v32, v132, v133
v_cvt_pk_bf16_f32 v33, v134, v135
v_cvt_pk_bf16_f32 v34, v136, v137
v_cvt_pk_bf16_f32 v35, v138, v139
s_add_u32 s36, s45, 0x1000000
buffer_store_dwordx4 v[32:35], v4, s[4:7], s36 offen offset:0 sc1
v_cvt_pk_bf16_f32 v40, v148, v149
v_cvt_pk_bf16_f32 v41, v150, v151
v_cvt_pk_bf16_f32 v42, v152, v153
v_cvt_pk_bf16_f32 v43, v154, v155
v_cvt_pk_bf16_f32 v36, v140, v141
v_cvt_pk_bf16_f32 v37, v142, v143
v_cvt_pk_bf16_f32 v38, v144, v145
v_cvt_pk_bf16_f32 v39, v146, v147
s_add_u32 s37, s36, 4096
v_cvt_pk_bf16_f32 v44, v156, v157
v_cvt_pk_bf16_f32 v45, v158, v159
v_cvt_pk_bf16_f32 v46, v160, v161
buffer_store_dwordx4 v[40:43], v4, s[4:7], s36 offen offset:1024 sc1
v_cvt_pk_bf16_f32 v47, v162, v163
v_mfma_f32_16x16x32_bf16 v[96:99], v[32:35], v[32:35], 0
s_mov_b32 s38, 0x340000
s_add_u32 s92, s78, 0x50000
v_mfma_f32_16x16x32_bf16 v[92:95], v[16:19], v[32:35], 0
s_add_u32 s40, s4, 0x1000000
s_addc_u32 s41, s5, 0
v_mfma_f32_16x16x32_bf16 v[96:99], v[36:39], v[36:39], v[96:99]
buffer_store_dwordx4 v[36:39], v4, s[4:7], s37 offen offset:0 sc1
v_mfma_f32_16x16x32_bf16 v[92:95], v[16:19], v[36:39], v[92:95]
s_nop 5
v_cndmask_b32 v96, v96, v97, s[46:47]
v_cndmask_b32 v98, v98, v99, s[46:47]
v_mfma_f32_16x16x32_bf16 v[104:107], v[40:43], v[40:43], 0
v_mfma_f32_16x16x32_bf16 v[100:103], v[16:19], v[40:43], 0
v_cndmask_b32 v93, v96, v98, s[48:49]
buffer_store_dwordx4 v[44:47], v4, s[4:7], s37 offen offset:1024 sc1
v_mfma_f32_16x16x32_bf16 v[104:107], v[44:47], v[44:47], v[104:107]
v_mfma_f32_16x16x32_bf16 v[100:103], v[16:19], v[44:47], v[100:103]
s_nop 6
v_cndmask_b32 v104, v104, v105, s[46:47]
v_cndmask_b32 v106, v106, v107, s[46:47]
buffer_store_dwordx2 v[92:93], v253, s[4:7], s38 offen offset:0 sc1
v_cndmask_b32 v101, v104, v106, s[48:49]
buffer_store_dwordx2 v[100:101], v253, s[4:7], s38 offen offset:2048 sc1
s_barrier
s_add_u32 m0, s18, 0x8000
s_add_u32 s44, s50, 0x2008000
buffer_load_dwordx4 v1, s[4:7], s44 offen offset:0 sc1 lds
buffer_load_dwordx4 v1, s[4:7], s44 offen offset:1024 sc1 lds
s_add_u32 m0, s18, 0xa000
s_add_u32 s44, s50, 0x200a000
buffer_load_dwordx4 v1, s[4:7], s44 offen offset:0 sc1 lds
buffer_load_dwordx4 v1, s[4:7], s44 offen offset:1024 sc1 lds
v_accvgpr_read_b32 v48, a188
v_accvgpr_read_b32 v49, a189
v_accvgpr_read_b32 v50, a190
v_accvgpr_read_b32 v51, a191
v_accvgpr_read_b32 v52, a192
v_accvgpr_read_b32 v53, a193
v_accvgpr_read_b32 v54, a194
v_accvgpr_read_b32 v55, a195
v_accvgpr_read_b32 v56, a196
v_accvgpr_read_b32 v57, a197
v_accvgpr_read_b32 v58, a198
v_accvgpr_read_b32 v59, a199
v_accvgpr_read_b32 v60, a200
v_accvgpr_read_b32 v61, a201
v_accvgpr_read_b32 v62, a202
v_accvgpr_read_b32 v63, a203
v_accvgpr_read_b32 v64, a204
v_accvgpr_read_b32 v65, a205
v_accvgpr_read_b32 v66, a206
v_accvgpr_read_b32 v67, a207
v_accvgpr_read_b32 v68, a208
v_accvgpr_read_b32 v69, a209
v_accvgpr_read_b32 v70, a210
v_accvgpr_read_b32 v71, a211
s_waitcnt vmcnt(4)
s_barrier
s_cmp_lg_u32 s28, 0
s_cbranch_scc1 Lsg_30
buffer_atomic_add v12, v10, s[4:7], s92 offen sc1
Lsg_30:
s_mov_b64 exec, 0
s_cmp_eq_u32 s28, 0
s_cbranch_scc1 L_stub10
L_wret4:
s_mov_b64 exec, -1
s_cmp_lt_u32 s28, 2
s_cbranch_scc1 Lwd_31
s_add_u32 m0, s19, 0xa000
s_add_u32 s44, s50, 0x200a000
s_add_u32 s44, s44, s18
buffer_load_dwordx4 v1, s[4:7], s44 offen offset:0 sc1 lds
buffer_load_dwordx4 v1, s[4:7], s44 offen offset:1024 sc1 lds
buffer_load_dwordx4 v1, s[4:7], s44 offen offset:2048 sc1 lds
buffer_load_dwordx4 v1, s[4:7], s44 offen offset:3072 sc1 lds
s_add_u32 m0, s19, 0xc000
s_add_u32 s44, s50, 0x200c000
s_add_u32 s44, s44, s18
buffer_load_dwordx4 v1, s[4:7], s44 offen offset:0 sc1 lds
buffer_load_dwordx4 v1, s[4:7], s44 offen offset:1024 sc1 lds
buffer_load_dwordx4 v1, s[4:7], s44 offen offset:2048 sc1 lds
buffer_load_dwordx4 v1, s[4:7], s44 offen offset:3072 sc1 lds
s_add_u32 m0, s19, 0xe000
s_add_u32 s44, s50, 0x200e000
s_add_u32 s44, s44, s18
buffer_load_dwordx4 v1, s[4:7], s44 offen offset:0 sc1 lds
buffer_load_dwordx4 v1, s[4:7], s44 offen offset:1024 sc1 lds
buffer_load_dwordx4 v1, s[4:7], s44 offen offset:2048 sc1 lds
buffer_load_dwordx4 v1, s[4:7], s44 offen offset:3072 sc1 lds
s_add_u32 m0, s19, 0x10000
s_add_u32 s44, s50, 0x2010000
s_add_u32 s44, s44, s18
buffer_load_dwordx4 v1, s[4:7], s44 offen offset:0 sc1 lds
buffer_load_dwordx4 v1, s[4:7], s44 offen offset:1024 sc1 lds
buffer_load_dwordx4 v1, s[4:7], s44 offen offset:2048 sc1 lds
buffer_load_dwordx4 v1, s[4:7], s44 offen offset:3072 sc1 lds
s_add_u32 m0, s19, 0x12000
s_add_u32 s44, s50, 0x2012000
s_add_u32 s44, s44, s18
buffer_load_dwordx4 v1, s[4:7], s44 offen offset:0 sc1 lds
buffer_load_dwordx4 v1, s[4:7], s44 offen offset:1024 sc1 lds
buffer_load_dwordx4 v1, s[4:7], s44 offen offset:2048 sc1 lds
buffer_load_dwordx4 v1, s[4:7], s44 offen offset:3072 sc1 lds
s_add_u32 m0, s19, 0x14000
s_add_u32 s44, s50, 0x2014000
s_add_u32 s44, s44, s18
buffer_load_dwordx4 v1, s[4:7], s44 offen offset:0 sc1 lds
buffer_load_dwordx4 v1, s[4:7], s44 offen offset:1024 sc1 lds
buffer_load_dwordx4 v1, s[4:7], s44 offen offset:2048 sc1 lds
buffer_load_dwordx4 v1, s[4:7], s44 offen offset:3072 sc1 lds
s_add_u32 m0, s19, 0x16000
s_add_u32 s44, s50, 0x2016000
s_add_u32 s44, s44, s18
buffer_load_dwordx4 v1, s[4:7], s44 offen offset:0 sc1 lds
buffer_load_dwordx4 v1, s[4:7], s44 offen offset:1024 sc1 lds
buffer_load_dwordx4 v1, s[4:7], s44 offen offset:2048 sc1 lds
buffer_load_dwordx4 v1, s[4:7], s44 offen offset:3072 sc1 lds
s_add_u32 m0, s19, 0x18000
s_add_u32 s44, s50, 0x2018000
s_add_u32 s44, s44, s18
buffer_load_dwordx4 v1, s[4:7], s44 offen offset:0 sc1 lds
buffer_load_dwordx4 v1, s[4:7], s44 offen offset:1024 sc1 lds
buffer_load_dwordx4 v1, s[4:7], s44 offen offset:2048 sc1 lds
buffer_load_dwordx4 v1, s[4:7], s44 offen offset:3072 sc1 lds
Lwd_31:
s_cmp_lg_u32 s28, 1
s_cbranch_scc1 Lpo_34
s_add_u32 s36, s34, 0x50000
s_mov_b32 s37, 0
v_mov_b32 v11, 0
buffer_atomic_add v11, v251, s[4:7], s36 offen sc0 sc1
s_sleep 4
Lpoll_32:
v_mov_b32 v234, 0
buffer_atomic_add v234, v251, s[4:7], s36 offen sc0 sc1
s_waitcnt vmcnt(1)
v_readfirstlane_b32 s38, v11
s_nop 0
s_cmp_ge_u32 s38, 32
s_cbranch_scc1 Lpe_33
v_mov_b32 v11, 0
buffer_atomic_add v11, v251, s[4:7], s36 offen sc0 sc1
s_waitcnt vmcnt(1)
v_readfirstlane_b32 s38, v234
s_nop 0
s_cmp_ge_u32 s38, 32
s_cbranch_scc1 Lpe_33
s_add_u32 s37, s37, 1
s_cmp_lt_u32 s37, 0x80000
s_cbranch_scc1 Lpoll_32
s_waitcnt vmcnt(0)
Lpo_34:
s_waitcnt vmcnt(32) lgkmcnt(0)
s_cmp_ge_u32 s28, 2
s_cbranch_scc1 Lw_35
s_waitcnt vmcnt(0)
Lw_35:
Lpe_33:
s_barrier
s_add_u32 s94, s71, 0x20080
s_mov_b32 s35, s10
L_stub10:
s_cbranch_execz L_stub11
s_add_u32 s33, s35, 0x1000
buffer_load_dwordx4 a[0:3], v2, s[40:43], s35 offen offset:0 sc1
buffer_load_dwordx4 a[4:7], v2, s[40:43], s33 offen offset:0 sc1
buffer_load_dwordx4 a[8:11], v2, s[40:43], s35 offen offset:1024 sc1
buffer_load_dwordx4 a[12:15], v2, s[40:43], s33 offen offset:1024 sc1
buffer_load_dwordx4 a[16:19], v2, s[40:43], s35 offen offset:2048 sc1
buffer_load_dwordx4 a[20:23], v2, s[40:43], s33 offen offset:2048 sc1
buffer_load_dwordx4 a[24:27], v2, s[40:43], s35 offen offset:3072 sc1
buffer_load_dwordx4 a[28:31], v2, s[40:43], s33 offen offset:3072 sc1
s_add_u32 s35, s35, 0x4000
s_add_u32 s33, s33, 0x4000
buffer_load_dwordx4 a[32:35], v2, s[40:43], s35 offen offset:0 sc1
buffer_load_dwordx4 a[36:39], v2, s[40:43], s33 offen offset:0 sc1
buffer_load_dwordx4 a[40:43], v2, s[40:43], s35 offen offset:1024 sc1
buffer_load_dwordx4 a[44:47], v2, s[40:43], s33 offen offset:1024 sc1
buffer_load_dwordx4 a[48:51], v2, s[40:43], s35 offen offset:2048 sc1
buffer_load_dwordx4 a[52:55], v2, s[40:43], s33 offen offset:2048 sc1
buffer_load_dwordx4 a[56:59], v2, s[40:43], s35 offen offset:3072 sc1
buffer_load_dwordx4 a[60:63], v2, s[40:43], s33 offen offset:3072 sc1
s_add_u32 s35, s35, 0x4000
s_add_u32 s33, s33, 0x4000
v_add_u32 v5, 0, v1
ds_read_b128 a[96:99], v5 offset:2048
ds_read_b128 a[100:103], v5 offset:8192
ds_read_b128 a[104:107], v5 offset:3072
ds_read_b128 a[108:111], v5 offset:9216
ds_read_b128 a[112:115], v5 offset:4096
ds_read_b128 a[116:119], v5 offset:10240
s_waitcnt vmcnt(14) lgkmcnt(4)
v_mfma_f32_16x16x32_bf16 v[140:143], a[96:99], a[0:3], 0
s_add_u32 m0, s18, 0x1c000
s_add_u32 s44, s50, 0x201c000
v_mfma_f32_16x16x32_bf16 v[140:143], a[100:103], a[4:7], v[140:143]
buffer_load_dwordx4 a[64:67], v2, s[40:43], s35 offen offset:0 sc1
s_waitcnt vmcnt(13)
v_mfma_f32_16x16x32_bf16 v[164:167], a[100:103], a[12:15], 0
ds_read_b128 a[128:131], v5 offset:5120
v_mfma_f32_16x16x32_bf16 v[164:167], a[96:99], a[8:11], v[164:167]
ds_read_b128 a[132:135], v5 offset:11264
s_waitcnt vmcnt(12)
v_mfma_f32_16x16x32_bf16 v[188:191], a[96:99], a[16:19], 0
s_waitcnt vmcnt(11)
v_mfma_f32_16x16x32_bf16 v[188:191], a[100:103], a[20:23], v[188:191]
buffer_load_dwordx4 a[68:71], v2, s[40:43], s33 offen offset:0 sc1
s_waitcnt vmcnt(10)
v_mfma_f32_16x16x32_bf16 v[212:215], a[100:103], a[28:31], 0
ds_read_b128 a[136:139], v5 offset:0
v_mfma_f32_16x16x32_bf16 v[212:215], a[96:99], a[24:27], v[212:215]
s_waitcnt lgkmcnt(6)
v_mfma_f32_16x16x32_bf16 v[216:219], a[104:107], a[24:27], 0
ds_read_b128 a[140:143], v5 offset:6144
s_waitcnt lgkmcnt(6)
v_mfma_f32_16x16x32_bf16 v[216:219], a[108:111], a[28:31], v[216:219]
v_mfma_f32_16x16x32_bf16 v[192:195], a[108:111], a[20:23], 0
buffer_load_dwordx4 v1, s[4:7], s44 offen offset:0 sc1 lds
v_mfma_f32_16x16x32_bf16 v[192:195], a[104:107], a[16:19], v[192:195]
ds_read_b128 a[144:147], v5 offset:1024
v_mfma_f32_16x16x32_bf16 v[168:171], a[104:107], a[8:11], 0
v_mfma_f32_16x16x32_bf16 v[168:171], a[108:111], a[12:15], v[168:171]
ds_read_b128 a[148:151], v5 offset:7168
v_mfma_f32_16x16x32_bf16 v[144:147], a[108:111], a[4:7], 0
v_mfma_f32_16x16x32_bf16 v[144:147], a[104:107], a[0:3], v[144:147]
buffer_load_dwordx4 a[72:75], v2, s[40:43], s35 offen offset:1024 sc1
s_waitcnt lgkmcnt(7)
v_mfma_f32_16x16x32_bf16 v[148:151], a[112:115], a[0:3], 0
s_waitcnt lgkmcnt(6)
v_mfma_f32_16x16x32_bf16 v[148:151], a[116:119], a[4:7], v[148:151]
v_mfma_f32_16x16x32_bf16 v[172:175], a[116:119], a[12:15], 0
v_mfma_f32_16x16x32_bf16 v[172:175], a[112:115], a[8:11], v[172:175]
v_mfma_f32_16x16x32_bf16 v[196:199], a[112:115], a[16:19], 0
buffer_load_dwordx4 a[76:79], v2, s[40:43], s33 offen offset:1024 sc1
v_mfma_f32_16x16x32_bf16 v[196:199], a[116:119], a[20:23], v[196:199]
v_mfma_f32_16x16x32_bf16 v[220:223], a[116:119], a[28:31], 0
v_mfma_f32_16x16x32_bf16 v[220:223], a[112:115], a[24:27], v[220:223]
s_waitcnt lgkmcnt(0)
v_mfma_f32_16x16x32_bf16 v[224:227], a[128:131], a[24:27], 0
ds_read_b128 a[96:99], v5 offset:14336
v_mfma_f32_16x16x32_bf16 v[224:227], a[132:135], a[28:31], v[224:227]
buffer_load_dwordx4 a[80:83], v2, s[40:43], s35 offen offset:2048 sc1
v_mfma_f32_16x16x32_bf16 v[200:203], a[132:135], a[20:23], 0
ds_read_b128 a[100:103], v5 offset:20480
v_mfma_f32_16x16x32_bf16 v[200:203], a[128:131], a[16:19], v[200:203]
v_mfma_f32_16x16x32_bf16 v[176:179], a[128:131], a[8:11], 0
v_mfma_f32_16x16x32_bf16 v[176:179], a[132:135], a[12:15], v[176:179]
buffer_load_dwordx4 a[84:87], v2, s[40:43], s33 offen offset:2048 sc1
v_mfma_f32_16x16x32_bf16 v[152:155], a[132:135], a[4:7], 0
ds_read_b128 a[104:107], v5 offset:15360
v_mfma_f32_16x16x32_bf16 v[152:155], a[128:131], a[0:3], v[152:155]
v_mfma_f32_16x16x32_bf16 v[132:135], a[136:139], a[0:3], 0
ds_read_b128 a[108:111], v5 offset:21504
v_mfma_f32_16x16x32_bf16 v[132:135], a[140:143], a[4:7], v[132:135]
v_mfma_f32_16x16x32_bf16 v[156:159], a[140:143], a[12:15], 0
buffer_load_dwordx4 v1, s[4:7], s44 offen offset:1024 sc1 lds
s_add_u32 m0, s18, 0x1e000
v_mfma_f32_16x16x32_bf16 v[156:159], a[136:139], a[8:11], v[156:159]
s_add_u32 s44, s50, 0x201e000
ds_read_b128 a[112:115], v5 offset:16384
v_mfma_f32_16x16x32_bf16 v[180:183], a[136:139], a[16:19], 0
v_mfma_f32_16x16x32_bf16 v[180:183], a[140:143], a[20:23], v[180:183]
ds_read_b128 a[116:119], v5 offset:22528
v_mfma_f32_16x16x32_bf16 v[204:207], a[140:143], a[28:31], 0
v_mfma_f32_16x16x32_bf16 v[204:207], a[136:139], a[24:27], v[204:207]
buffer_load_dwordx4 a[88:91], v2, s[40:43], s35 offen offset:3072 sc1
v_mfma_f32_16x16x32_bf16 v[208:211], a[144:147], a[24:27], 0
v_mfma_f32_16x16x32_bf16 v[208:211], a[148:151], a[28:31], v[208:211]
v_mfma_f32_16x16x32_bf16 v[184:187], a[148:151], a[20:23], 0
v_mfma_f32_16x16x32_bf16 v[184:187], a[144:147], a[16:19], v[184:187]
v_mfma_f32_16x16x32_bf16 v[160:163], a[144:147], a[8:11], 0
buffer_load_dwordx4 a[92:95], v2, s[40:43], s33 offen offset:3072 sc1
s_add_u32 s35, s35, 0x4000
v_mfma_f32_16x16x32_bf16 v[160:163], a[148:151], a[12:15], v[160:163]
s_add_u32 s33, s33, 0x4000
v_mfma_f32_16x16x32_bf16 v[136:139], a[148:151], a[4:7], 0
v_mfma_f32_16x16x32_bf16 v[136:139], a[144:147], a[0:3], v[136:139]
s_waitcnt vmcnt(10) lgkmcnt(0)
v_mfma_f32_16x16x32_bf16 v[140:143], a[96:99], a[32:35], v[140:143]
ds_read_b128 a[128:131], v5 offset:17408
v_mfma_f32_16x16x32_bf16 v[140:143], a[100:103], a[36:39], v[140:143]
buffer_load_dwordx4 a[0:3], v2, s[40:43], s35 offen offset:0 sc1
v_mfma_f32_16x16x32_bf16 v[164:167], a[100:103], a[44:47], v[164:167]
ds_read_b128 a[132:135], v5 offset:23552
v_mfma_f32_16x16x32_bf16 v[164:167], a[96:99], a[40:43], v[164:167]
v_mfma_f32_16x16x32_bf16 v[188:191], a[96:99], a[48:51], v[188:191]
v_mfma_f32_16x16x32_bf16 v[188:191], a[100:103], a[52:55], v[188:191]
buffer_load_dwordx4 a[4:7], v2, s[40:43], s33 offen offset:0 sc1
v_mfma_f32_16x16x32_bf16 v[212:215], a[100:103], a[60:63], v[212:215]
ds_read_b128 a[136:139], v5 offset:12288
v_mfma_f32_16x16x32_bf16 v[212:215], a[96:99], a[56:59], v[212:215]
v_mfma_f32_16x16x32_bf16 v[216:219], a[104:107], a[56:59], v[216:219]
ds_read_b128 a[140:143], v5 offset:18432
v_mfma_f32_16x16x32_bf16 v[216:219], a[108:111], a[60:63], v[216:219]
v_mfma_f32_16x16x32_bf16 v[192:195], a[108:111], a[52:55], v[192:195]
buffer_load_dwordx4 v1, s[4:7], s44 offen offset:0 sc1 lds
v_mfma_f32_16x16x32_bf16 v[192:195], a[104:107], a[48:51], v[192:195]
ds_read_b128 a[144:147], v5 offset:13312
v_mfma_f32_16x16x32_bf16 v[168:171], a[104:107], a[40:43], v[168:171]
v_mfma_f32_16x16x32_bf16 v[168:171], a[108:111], a[44:47], v[168:171]
ds_read_b128 a[148:151], v5 offset:19456
v_mfma_f32_16x16x32_bf16 v[144:147], a[108:111], a[36:39], v[144:147]
v_mfma_f32_16x16x32_bf16 v[144:147], a[104:107], a[32:35], v[144:147]
buffer_load_dwordx4 a[8:11], v2, s[40:43], s35 offen offset:1024 sc1
v_mfma_f32_16x16x32_bf16 v[148:151], a[112:115], a[32:35], v[148:151]
v_mfma_f32_16x16x32_bf16 v[148:151], a[116:119], a[36:39], v[148:151]
v_mfma_f32_16x16x32_bf16 v[172:175], a[116:119], a[44:47], v[172:175]
v_mfma_f32_16x16x32_bf16 v[172:175], a[112:115], a[40:43], v[172:175]
v_mfma_f32_16x16x32_bf16 v[196:199], a[112:115], a[48:51], v[196:199]
buffer_load_dwordx4 a[12:15], v2, s[40:43], s33 offen offset:1024 sc1
v_mfma_f32_16x16x32_bf16 v[196:199], a[116:119], a[52:55], v[196:199]
v_mfma_f32_16x16x32_bf16 v[220:223], a[116:119], a[60:63], v[220:223]
v_mfma_f32_16x16x32_bf16 v[220:223], a[112:115], a[56:59], v[220:223]
s_waitcnt lgkmcnt(0)
v_mfma_f32_16x16x32_bf16 v[224:227], a[128:131], a[56:59], v[224:227]
ds_read_b128 a[96:99], v5 offset:26624
v_mfma_f32_16x16x32_bf16 v[224:227], a[132:135], a[60:63], v[224:227]
buffer_load_dwordx4 a[16:19], v2, s[40:43], s35 offen offset:2048 sc1
v_mfma_f32_16x16x32_bf16 v[200:203], a[132:135], a[52:55], v[200:203]
ds_read_b128 a[100:103], v5 offset:32768
v_mfma_f32_16x16x32_bf16 v[200:203], a[128:131], a[48:51], v[200:203]
v_mfma_f32_16x16x32_bf16 v[176:179], a[128:131], a[40:43], v[176:179]
v_mfma_f32_16x16x32_bf16 v[176:179], a[132:135], a[44:47], v[176:179]
buffer_load_dwordx4 v1, s[4:7], s44 offen offset:1024 sc1 lds
s_add_u32 m0, s18, 0x20000
v_mfma_f32_16x16x32_bf16 v[152:155], a[132:135], a[36:39], v[152:155]
s_add_u32 s44, s50, 0x2020000
ds_read_b128 a[104:107], v5 offset:27648
v_mfma_f32_16x16x32_bf16 v[152:155], a[128:131], a[32:35], v[152:155]
v_mfma_f32_16x16x32_bf16 v[132:135], a[136:139], a[32:35], v[132:135]
ds_read_b128 a[108:111], v5 offset:33792
v_mfma_f32_16x16x32_bf16 v[132:135], a[140:143], a[36:39], v[132:135]
buffer_load_dwordx4 a[20:23], v2, s[40:43], s33 offen offset:2048 sc1
v_mfma_f32_16x16x32_bf16 v[156:159], a[140:143], a[44:47], v[156:159]
ds_read_b128 a[112:115], v5 offset:28672
v_mfma_f32_16x16x32_bf16 v[156:159], a[136:139], a[40:43], v[156:159]
v_mfma_f32_16x16x32_bf16 v[180:183], a[136:139], a[48:51], v[180:183]
v_mfma_f32_16x16x32_bf16 v[180:183], a[140:143], a[52:55], v[180:183]
buffer_load_dwordx4 a[24:27], v2, s[40:43], s35 offen offset:3072 sc1
v_mfma_f32_16x16x32_bf16 v[204:207], a[140:143], a[60:63], v[204:207]
ds_read_b128 a[116:119], v5 offset:34816
v_mfma_f32_16x16x32_bf16 v[204:207], a[136:139], a[56:59], v[204:207]
v_mfma_f32_16x16x32_bf16 v[208:211], a[144:147], a[56:59], v[208:211]
v_mfma_f32_16x16x32_bf16 v[208:211], a[148:151], a[60:63], v[208:211]
buffer_load_dwordx4 v1, s[4:7], s44 offen offset:0 sc1 lds
v_mfma_f32_16x16x32_bf16 v[184:187], a[148:151], a[52:55], v[184:187]
v_mfma_f32_16x16x32_bf16 v[184:187], a[144:147], a[48:51], v[184:187]
v_mfma_f32_16x16x32_bf16 v[160:163], a[144:147], a[40:43], v[160:163]
v_mfma_f32_16x16x32_bf16 v[160:163], a[148:151], a[44:47], v[160:163]
buffer_load_dwordx4 a[28:31], v2, s[40:43], s33 offen offset:3072 sc1
s_add_u32 s35, s35, 0x4000
v_mfma_f32_16x16x32_bf16 v[136:139], a[148:151], a[36:39], v[136:139]
s_add_u32 s33, s33, 0x4000
v_mfma_f32_16x16x32_bf16 v[136:139], a[144:147], a[32:35], v[136:139]
s_waitcnt vmcnt(11) lgkmcnt(0)
v_mfma_f32_16x16x32_bf16 v[140:143], a[96:99], a[64:67], v[140:143]
ds_read_b128 a[128:131], v5 offset:29696
v_mfma_f32_16x16x32_bf16 v[140:143], a[100:103], a[68:71], v[140:143]
buffer_load_dwordx4 a[32:35], v2, s[40:43], s35 offen offset:0 sc1
v_mfma_f32_16x16x32_bf16 v[164:167], a[100:103], a[76:79], v[164:167]
ds_read_b128 a[132:135], v5 offset:35840
v_mfma_f32_16x16x32_bf16 v[164:167], a[96:99], a[72:75], v[164:167]
v_mfma_f32_16x16x32_bf16 v[188:191], a[96:99], a[80:83], v[188:191]
v_mfma_f32_16x16x32_bf16 v[188:191], a[100:103], a[84:87], v[188:191]
buffer_load_dwordx4 a[36:39], v2, s[40:43], s33 offen offset:0 sc1
v_mfma_f32_16x16x32_bf16 v[212:215], a[100:103], a[92:95], v[212:215]
ds_read_b128 a[136:139], v5 offset:24576
v_mfma_f32_16x16x32_bf16 v[212:215], a[96:99], a[88:91], v[212:215]
v_mfma_f32_16x16x32_bf16 v[216:219], a[104:107], a[88:91], v[216:219]
ds_read_b128 a[140:143], v5 offset:30720
v_mfma_f32_16x16x32_bf16 v[216:219], a[108:111], a[92:95], v[216:219]
v_mfma_f32_16x16x32_bf16 v[192:195], a[108:111], a[84:87], v[192:195]
buffer_load_dwordx4 v1, s[4:7], s44 offen offset:1024 sc1 lds
s_add_u32 m0, s18, 0x22000
v_mfma_f32_16x16x32_bf16 v[192:195], a[104:107], a[80:83], v[192:195]
s_add_u32 s44, s50, 0x2022000
ds_read_b128 a[144:147], v5 offset:25600
v_mfma_f32_16x16x32_bf16 v[168:171], a[104:107], a[72:75], v[168:171]
v_mfma_f32_16x16x32_bf16 v[168:171], a[108:111], a[76:79], v[168:171]
ds_read_b128 a[148:151], v5 offset:31744
v_mfma_f32_16x16x32_bf16 v[144:147], a[108:111], a[68:71], v[144:147]
v_mfma_f32_16x16x32_bf16 v[144:147], a[104:107], a[64:67], v[144:147]
buffer_load_dwordx4 a[40:43], v2, s[40:43], s35 offen offset:1024 sc1
v_mfma_f32_16x16x32_bf16 v[148:151], a[112:115], a[64:67], v[148:151]
v_mfma_f32_16x16x32_bf16 v[148:151], a[116:119], a[68:71], v[148:151]
v_mfma_f32_16x16x32_bf16 v[172:175], a[116:119], a[76:79], v[172:175]
v_mfma_f32_16x16x32_bf16 v[172:175], a[112:115], a[72:75], v[172:175]
v_mfma_f32_16x16x32_bf16 v[196:199], a[112:115], a[80:83], v[196:199]
buffer_load_dwordx4 a[44:47], v2, s[40:43], s33 offen offset:1024 sc1
v_mfma_f32_16x16x32_bf16 v[196:199], a[116:119], a[84:87], v[196:199]
v_mfma_f32_16x16x32_bf16 v[220:223], a[116:119], a[92:95], v[220:223]
v_mfma_f32_16x16x32_bf16 v[220:223], a[112:115], a[88:91], v[220:223]
s_waitcnt lgkmcnt(0)
v_mfma_f32_16x16x32_bf16 v[224:227], a[128:131], a[88:91], v[224:227]
ds_read_b128 a[96:99], v5 offset:38912
v_mfma_f32_16x16x32_bf16 v[224:227], a[132:135], a[92:95], v[224:227]
buffer_load_dwordx4 a[48:51], v2, s[40:43], s35 offen offset:2048 sc1
v_mfma_f32_16x16x32_bf16 v[200:203], a[132:135], a[84:87], v[200:203]
ds_read_b128 a[100:103], v5 offset:45056
v_mfma_f32_16x16x32_bf16 v[200:203], a[128:131], a[80:83], v[200:203]
v_mfma_f32_16x16x32_bf16 v[176:179], a[128:131], a[72:75], v[176:179]
v_mfma_f32_16x16x32_bf16 v[176:179], a[132:135], a[76:79], v[176:179]
buffer_load_dwordx4 a[52:55], v2, s[40:43], s33 offen offset:2048 sc1
v_mfma_f32_16x16x32_bf16 v[152:155], a[132:135], a[68:71], v[152:155]
ds_read_b128 a[104:107], v5 offset:39936
v_mfma_f32_16x16x32_bf16 v[152:155], a[128:131], a[64:67], v[152:155]
v_mfma_f32_16x16x32_bf16 v[132:135], a[136:139], a[64:67], v[132:135]
ds_read_b128 a[108:111], v5 offset:46080
v_mfma_f32_16x16x32_bf16 v[132:135], a[140:143], a[68:71], v[132:135]
v_mfma_f32_16x16x32_bf16 v[156:159], a[140:143], a[76:79], v[156:159]
buffer_load_dwordx4 v1, s[4:7], s44 offen offset:0 sc1 lds
v_mfma_f32_16x16x32_bf16 v[156:159], a[136:139], a[72:75], v[156:159]
ds_read_b128 a[112:115], v5 offset:40960
v_mfma_f32_16x16x32_bf16 v[180:183], a[136:139], a[80:83], v[180:183]
v_mfma_f32_16x16x32_bf16 v[180:183], a[140:143], a[84:87], v[180:183]
ds_read_b128 a[116:119], v5 offset:47104
v_mfma_f32_16x16x32_bf16 v[204:207], a[140:143], a[92:95], v[204:207]
v_mfma_f32_16x16x32_bf16 v[204:207], a[136:139], a[88:91], v[204:207]
buffer_load_dwordx4 a[56:59], v2, s[40:43], s35 offen offset:3072 sc1
v_mfma_f32_16x16x32_bf16 v[208:211], a[144:147], a[88:91], v[208:211]
v_mfma_f32_16x16x32_bf16 v[208:211], a[148:151], a[92:95], v[208:211]
v_mfma_f32_16x16x32_bf16 v[184:187], a[148:151], a[84:87], v[184:187]
v_mfma_f32_16x16x32_bf16 v[184:187], a[144:147], a[80:83], v[184:187]
v_mfma_f32_16x16x32_bf16 v[160:163], a[144:147], a[72:75], v[160:163]
buffer_load_dwordx4 a[60:63], v2, s[40:43], s33 offen offset:3072 sc1
s_add_u32 s35, s35, 0x4000
v_mfma_f32_16x16x32_bf16 v[160:163], a[148:151], a[76:79], v[160:163]
s_add_u32 s33, s33, 0x4000
v_mfma_f32_16x16x32_bf16 v[136:139], a[148:151], a[68:71], v[136:139]
v_mfma_f32_16x16x32_bf16 v[136:139], a[144:147], a[64:67], v[136:139]
s_waitcnt vmcnt(10) lgkmcnt(0)
v_mfma_f32_16x16x32_bf16 v[140:143], a[96:99], a[0:3], v[140:143]
ds_read_b128 a[128:131], v5 offset:41984
v_mfma_f32_16x16x32_bf16 v[140:143], a[100:103], a[4:7], v[140:143]
buffer_load_dwordx4 a[64:67], v2, s[40:43], s35 offen offset:0 sc1
v_mfma_f32_16x16x32_bf16 v[164:167], a[100:103], a[12:15], v[164:167]
ds_read_b128 a[132:135], v5 offset:48128
v_mfma_f32_16x16x32_bf16 v[164:167], a[96:99], a[8:11], v[164:167]
v_mfma_f32_16x16x32_bf16 v[188:191], a[96:99], a[16:19], v[188:191]
v_mfma_f32_16x16x32_bf16 v[188:191], a[100:103], a[20:23], v[188:191]
buffer_load_dwordx4 a[68:71], v2, s[40:43], s33 offen offset:0 sc1
v_mfma_f32_16x16x32_bf16 v[212:215], a[100:103], a[28:31], v[212:215]
ds_read_b128 a[136:139], v5 offset:36864
v_mfma_f32_16x16x32_bf16 v[212:215], a[96:99], a[24:27], v[212:215]
v_mfma_f32_16x16x32_bf16 v[216:219], a[104:107], a[24:27], v[216:219]
ds_read_b128 a[140:143], v5 offset:43008
v_mfma_f32_16x16x32_bf16 v[216:219], a[108:111], a[28:31], v[216:219]
v_mfma_f32_16x16x32_bf16 v[192:195], a[108:111], a[20:23], v[192:195]
buffer_load_dwordx4 v1, s[4:7], s44 offen offset:1024 sc1 lds
s_add_u32 s88, s82, 0x340000
v_mfma_f32_16x16x32_bf16 v[192:195], a[104:107], a[16:19], v[192:195]
ds_read_b128 a[144:147], v5 offset:37888
v_mfma_f32_16x16x32_bf16 v[168:171], a[104:107], a[8:11], v[168:171]
v_mfma_f32_16x16x32_bf16 v[168:171], a[108:111], a[12:15], v[168:171]
ds_read_b128 a[148:151], v5 offset:44032
v_mfma_f32_16x16x32_bf16 v[144:147], a[108:111], a[4:7], v[144:147]
v_mfma_f32_16x16x32_bf16 v[144:147], a[104:107], a[0:3], v[144:147]
buffer_load_dwordx4 a[72:75], v2, s[40:43], s35 offen offset:1024 sc1
v_mfma_f32_16x16x32_bf16 v[148:151], a[112:115], a[0:3], v[148:151]
v_mfma_f32_16x16x32_bf16 v[148:151], a[116:119], a[4:7], v[148:151]
v_mfma_f32_16x16x32_bf16 v[172:175], a[116:119], a[12:15], v[172:175]
v_mfma_f32_16x16x32_bf16 v[172:175], a[112:115], a[8:11], v[172:175]
v_mfma_f32_16x16x32_bf16 v[196:199], a[112:115], a[16:19], v[196:199]
buffer_load_dwordx4 a[76:79], v2, s[40:43], s33 offen offset:1024 sc1
v_mfma_f32_16x16x32_bf16 v[196:199], a[116:119], a[20:23], v[196:199]
v_mfma_f32_16x16x32_bf16 v[220:223], a[116:119], a[28:31], v[220:223]
v_mfma_f32_16x16x32_bf16 v[220:223], a[112:115], a[24:27], v[220:223]
s_waitcnt lgkmcnt(0)
s_barrier
v_mfma_f32_16x16x32_bf16 v[224:227], a[128:131], a[24:27], v[224:227]
v_add_u32 v5, 49152, v1
v_mfma_f32_16x16x32_bf16 v[224:227], a[132:135], a[28:31], v[224:227]
buffer_load_dwordx4 a[80:83], v2, s[40:43], s35 offen offset:2048 sc1
v_mfma_f32_16x16x32_bf16 v[200:203], a[132:135], a[20:23], v[200:203]
ds_read_b128 a[96:99], v5 offset:2048
v_mfma_f32_16x16x32_bf16 v[200:203], a[128:131], a[16:19], v[200:203]
ds_read_b128 a[100:103], v5 offset:8192
v_mfma_f32_16x16x32_bf16 v[176:179], a[128:131], a[8:11], v[176:179]
v_mfma_f32_16x16x32_bf16 v[176:179], a[132:135], a[12:15], v[176:179]
buffer_load_dwordx4 a[84:87], v2, s[40:43], s33 offen offset:2048 sc1
v_mfma_f32_16x16x32_bf16 v[152:155], a[132:135], a[4:7], v[152:155]
ds_read_b128 a[104:107], v5 offset:3072
v_mfma_f32_16x16x32_bf16 v[152:155], a[128:131], a[0:3], v[152:155]
v_mfma_f32_16x16x32_bf16 v[132:135], a[136:139], a[0:3], v[132:135]
ds_read_b128 a[108:111], v5 offset:9216
v_mfma_f32_16x16x32_bf16 v[132:135], a[140:143], a[4:7], v[132:135]
v_mfma_f32_16x16x32_bf16 v[156:159], a[140:143], a[12:15], v[156:159]
buffer_load_dwordx4 v[92:95], v1, s[4:7], s88 offen offset:0 sc1
v_mfma_f32_16x16x32_bf16 v[156:159], a[136:139], a[8:11], v[156:159]
ds_read_b128 a[112:115], v5 offset:4096
v_mfma_f32_16x16x32_bf16 v[180:183], a[136:139], a[16:19], v[180:183]
v_mfma_f32_16x16x32_bf16 v[180:183], a[140:143], a[20:23], v[180:183]
ds_read_b128 a[116:119], v5 offset:10240
v_mfma_f32_16x16x32_bf16 v[204:207], a[140:143], a[28:31], v[204:207]
v_mfma_f32_16x16x32_bf16 v[204:207], a[136:139], a[24:27], v[204:207]
buffer_load_dwordx4 a[88:91], v2, s[40:43], s35 offen offset:3072 sc1
v_mfma_f32_16x16x32_bf16 v[208:211], a[144:147], a[24:27], v[208:211]
v_mfma_f32_16x16x32_bf16 v[208:211], a[148:151], a[28:31], v[208:211]
v_mfma_f32_16x16x32_bf16 v[184:187], a[148:151], a[20:23], v[184:187]
v_mfma_f32_16x16x32_bf16 v[184:187], a[144:147], a[16:19], v[184:187]
v_mfma_f32_16x16x32_bf16 v[160:163], a[144:147], a[8:11], v[160:163]
buffer_load_dwordx4 a[92:95], v2, s[40:43], s33 offen offset:3072 sc1
s_add_u32 s35, s35, 0x4000
v_mfma_f32_16x16x32_bf16 v[160:163], a[148:151], a[12:15], v[160:163]
s_add_u32 s33, s33, 0x4000
v_mfma_f32_16x16x32_bf16 v[136:139], a[148:151], a[4:7], v[136:139]
v_mfma_f32_16x16x32_bf16 v[136:139], a[144:147], a[0:3], v[136:139]
s_waitcnt vmcnt(10) lgkmcnt(0)
v_mfma_f32_16x16x32_bf16 v[140:143], a[96:99], a[32:35], v[140:143]
ds_read_b128 a[128:131], v5 offset:5120
v_mfma_f32_16x16x32_bf16 v[140:143], a[100:103], a[36:39], v[140:143]
buffer_load_dwordx4 a[0:3], v2, s[40:43], s35 offen offset:0 sc1
v_mfma_f32_16x16x32_bf16 v[164:167], a[100:103], a[44:47], v[164:167]
ds_read_b128 a[132:135], v5 offset:11264
v_mfma_f32_16x16x32_bf16 v[164:167], a[96:99], a[40:43], v[164:167]
v_mfma_f32_16x16x32_bf16 v[188:191], a[96:99], a[48:51], v[188:191]
v_mfma_f32_16x16x32_bf16 v[188:191], a[100:103], a[52:55], v[188:191]
buffer_load_dwordx4 a[4:7], v2, s[40:43], s33 offen offset:0 sc1
v_mfma_f32_16x16x32_bf16 v[212:215], a[100:103], a[60:63], v[212:215]
ds_read_b128 a[136:139], v5 offset:0
v_mfma_f32_16x16x32_bf16 v[212:215], a[96:99], a[56:59], v[212:215]
v_mfma_f32_16x16x32_bf16 v[216:219], a[104:107], a[56:59], v[216:219]
ds_read_b128 a[140:143], v5 offset:6144
v_mfma_f32_16x16x32_bf16 v[216:219], a[108:111], a[60:63], v[216:219]
v_mfma_f32_16x16x32_bf16 v[192:195], a[108:111], a[52:55], v[192:195]
buffer_load_dwordx4 v[96:99], v1, s[4:7], s88 offen offset:1024 sc1
v_mfma_f32_16x16x32_bf16 v[192:195], a[104:107], a[48:51], v[192:195]
ds_read_b128 a[144:147], v5 offset:1024
v_mfma_f32_16x16x32_bf16 v[168:171], a[104:107], a[40:43], v[168:171]
v_mfma_f32_16x16x32_bf16 v[168:171], a[108:111], a[44:47], v[168:171]
ds_read_b128 a[148:151], v5 offset:7168
v_mfma_f32_16x16x32_bf16 v[144:147], a[108:111], a[36:39], v[144:147]
v_mfma_f32_16x16x32_bf16 v[144:147], a[104:107], a[32:35], v[144:147]
buffer_load_dwordx4 a[8:11], v2, s[40:43], s35 offen offset:1024 sc1
v_mfma_f32_16x16x32_bf16 v[148:151], a[112:115], a[32:35], v[148:151]
v_mfma_f32_16x16x32_bf16 v[148:151], a[116:119], a[36:39], v[148:151]
v_mfma_f32_16x16x32_bf16 v[172:175], a[116:119], a[44:47], v[172:175]
v_mfma_f32_16x16x32_bf16 v[172:175], a[112:115], a[40:43], v[172:175]
v_mfma_f32_16x16x32_bf16 v[196:199], a[112:115], a[48:51], v[196:199]
buffer_load_dwordx4 a[12:15], v2, s[40:43], s33 offen offset:1024 sc1
v_mfma_f32_16x16x32_bf16 v[196:199], a[116:119], a[52:55], v[196:199]
v_mfma_f32_16x16x32_bf16 v[220:223], a[116:119], a[60:63], v[220:223]
v_mfma_f32_16x16x32_bf16 v[220:223], a[112:115], a[56:59], v[220:223]
s_waitcnt lgkmcnt(0)
v_mfma_f32_16x16x32_bf16 v[224:227], a[128:131], a[56:59], v[224:227]
ds_read_b128 a[96:99], v5 offset:14336
v_mfma_f32_16x16x32_bf16 v[224:227], a[132:135], a[60:63], v[224:227]
buffer_load_dwordx4 a[16:19], v2, s[40:43], s35 offen offset:2048 sc1
v_mfma_f32_16x16x32_bf16 v[200:203], a[132:135], a[52:55], v[200:203]
ds_read_b128 a[100:103], v5 offset:20480
v_mfma_f32_16x16x32_bf16 v[200:203], a[128:131], a[48:51], v[200:203]
v_mfma_f32_16x16x32_bf16 v[176:179], a[128:131], a[40:43], v[176:179]
v_mfma_f32_16x16x32_bf16 v[176:179], a[132:135], a[44:47], v[176:179]
buffer_load_dwordx4 v[100:103], v1, s[4:7], s88 offen offset:2048 sc1
v_mfma_f32_16x16x32_bf16 v[152:155], a[132:135], a[36:39], v[152:155]
ds_read_b128 a[104:107], v5 offset:15360
v_mfma_f32_16x16x32_bf16 v[152:155], a[128:131], a[32:35], v[152:155]
v_mfma_f32_16x16x32_bf16 v[132:135], a[136:139], a[32:35], v[132:135]
ds_read_b128 a[108:111], v5 offset:21504
v_mfma_f32_16x16x32_bf16 v[132:135], a[140:143], a[36:39], v[132:135]
buffer_load_dwordx4 a[20:23], v2, s[40:43], s33 offen offset:2048 sc1
v_mfma_f32_16x16x32_bf16 v[156:159], a[140:143], a[44:47], v[156:159]
ds_read_b128 a[112:115], v5 offset:16384
v_mfma_f32_16x16x32_bf16 v[156:159], a[136:139], a[40:43], v[156:159]
v_mfma_f32_16x16x32_bf16 v[180:183], a[136:139], a[48:51], v[180:183]
v_mfma_f32_16x16x32_bf16 v[180:183], a[140:143], a[52:55], v[180:183]
buffer_load_dwordx4 a[24:27], v2, s[40:43], s35 offen offset:3072 sc1
v_mfma_f32_16x16x32_bf16 v[204:207], a[140:143], a[60:63], v[204:207]
ds_read_b128 a[116:119], v5 offset:22528
v_mfma_f32_16x16x32_bf16 v[204:207], a[136:139], a[56:59], v[204:207]
v_mfma_f32_16x16x32_bf16 v[208:211], a[144:147], a[56:59], v[208:211]
v_mfma_f32_16x16x32_bf16 v[208:211], a[148:151], a[60:63], v[208:211]
buffer_load_dwordx4 v[104:107], v1, s[4:7], s88 offen offset:3072 sc1
s_add_u32 s88, s88, 4096
v_mfma_f32_16x16x32_bf16 v[184:187], a[148:151], a[52:55], v[184:187]
v_mfma_f32_16x16x32_bf16 v[184:187], a[144:147], a[48:51], v[184:187]
v_mfma_f32_16x16x32_bf16 v[160:163], a[144:147], a[40:43], v[160:163]
v_mfma_f32_16x16x32_bf16 v[160:163], a[148:151], a[44:47], v[160:163]
buffer_load_dwordx4 a[28:31], v2, s[40:43], s33 offen offset:3072 sc1
s_add_u32 s35, s35, 0x4000
v_mfma_f32_16x16x32_bf16 v[136:139], a[148:151], a[36:39], v[136:139]
s_add_u32 s33, s33, 0x4000
v_mfma_f32_16x16x32_bf16 v[136:139], a[144:147], a[32:35], v[136:139]
s_waitcnt vmcnt(11) lgkmcnt(0)
v_mfma_f32_16x16x32_bf16 v[140:143], a[96:99], a[64:67], v[140:143]
ds_read_b128 a[128:131], v5 offset:17408
v_mfma_f32_16x16x32_bf16 v[140:143], a[100:103], a[68:71], v[140:143]
buffer_load_dwordx4 a[32:35], v2, s[40:43], s35 offen offset:0 sc1
v_mfma_f32_16x16x32_bf16 v[164:167], a[100:103], a[76:79], v[164:167]
ds_read_b128 a[132:135], v5 offset:23552
v_mfma_f32_16x16x32_bf16 v[164:167], a[96:99], a[72:75], v[164:167]
v_mfma_f32_16x16x32_bf16 v[188:191], a[96:99], a[80:83], v[188:191]
v_mfma_f32_16x16x32_bf16 v[188:191], a[100:103], a[84:87], v[188:191]
buffer_load_dwordx4 a[36:39], v2, s[40:43], s33 offen offset:0 sc1
v_mfma_f32_16x16x32_bf16 v[212:215], a[100:103], a[92:95], v[212:215]
ds_read_b128 a[136:139], v5 offset:12288
v_mfma_f32_16x16x32_bf16 v[212:215], a[96:99], a[88:91], v[212:215]
v_mfma_f32_16x16x32_bf16 v[216:219], a[104:107], a[88:91], v[216:219]
ds_read_b128 a[140:143], v5 offset:18432
v_mfma_f32_16x16x32_bf16 v[216:219], a[108:111], a[92:95], v[216:219]
v_mfma_f32_16x16x32_bf16 v[192:195], a[108:111], a[84:87], v[192:195]
buffer_load_dwordx4 v[108:111], v1, s[4:7], s88 offen offset:0 sc1
v_mfma_f32_16x16x32_bf16 v[192:195], a[104:107], a[80:83], v[192:195]
ds_read_b128 a[144:147], v5 offset:13312
v_mfma_f32_16x16x32_bf16 v[168:171], a[104:107], a[72:75], v[168:171]
v_mfma_f32_16x16x32_bf16 v[168:171], a[108:111], a[76:79], v[168:171]
ds_read_b128 a[148:151], v5 offset:19456
v_mfma_f32_16x16x32_bf16 v[144:147], a[108:111], a[68:71], v[144:147]
v_mfma_f32_16x16x32_bf16 v[144:147], a[104:107], a[64:67], v[144:147]
buffer_load_dwordx4 a[40:43], v2, s[40:43], s35 offen offset:1024 sc1
v_mfma_f32_16x16x32_bf16 v[148:151], a[112:115], a[64:67], v[148:151]
v_mfma_f32_16x16x32_bf16 v[148:151], a[116:119], a[68:71], v[148:151]
v_mfma_f32_16x16x32_bf16 v[172:175], a[116:119], a[76:79], v[172:175]
v_mfma_f32_16x16x32_bf16 v[172:175], a[112:115], a[72:75], v[172:175]
v_mfma_f32_16x16x32_bf16 v[196:199], a[112:115], a[80:83], v[196:199]
buffer_load_dwordx4 a[44:47], v2, s[40:43], s33 offen offset:1024 sc1
v_mfma_f32_16x16x32_bf16 v[196:199], a[116:119], a[84:87], v[196:199]
v_mfma_f32_16x16x32_bf16 v[220:223], a[116:119], a[92:95], v[220:223]
v_mfma_f32_16x16x32_bf16 v[220:223], a[112:115], a[88:91], v[220:223]
s_waitcnt lgkmcnt(0)
v_mfma_f32_16x16x32_bf16 v[224:227], a[128:131], a[88:91], v[224:227]
ds_read_b128 a[96:99], v5 offset:26624
v_mfma_f32_16x16x32_bf16 v[224:227], a[132:135], a[92:95], v[224:227]
buffer_load_dwordx4 a[48:51], v2, s[40:43], s35 offen offset:2048 sc1
v_mfma_f32_16x16x32_bf16 v[200:203], a[132:135], a[84:87], v[200:203]
ds_read_b128 a[100:103], v5 offset:32768
v_mfma_f32_16x16x32_bf16 v[200:203], a[128:131], a[80:83], v[200:203]
v_mfma_f32_16x16x32_bf16 v[176:179], a[128:131], a[72:75], v[176:179]
v_mfma_f32_16x16x32_bf16 v[176:179], a[132:135], a[76:79], v[176:179]
buffer_load_dwordx4 a[52:55], v2, s[40:43], s33 offen offset:2048 sc1
v_mfma_f32_16x16x32_bf16 v[152:155], a[132:135], a[68:71], v[152:155]
ds_read_b128 a[104:107], v5 offset:27648
v_mfma_f32_16x16x32_bf16 v[152:155], a[128:131], a[64:67], v[152:155]
v_mfma_f32_16x16x32_bf16 v[132:135], a[136:139], a[64:67], v[132:135]
ds_read_b128 a[108:111], v5 offset:33792
v_mfma_f32_16x16x32_bf16 v[132:135], a[140:143], a[68:71], v[132:135]
v_mfma_f32_16x16x32_bf16 v[156:159], a[140:143], a[76:79], v[156:159]
buffer_load_dwordx4 v[112:115], v1, s[4:7], s88 offen offset:1024 sc1
v_mfma_f32_16x16x32_bf16 v[156:159], a[136:139], a[72:75], v[156:159]
ds_read_b128 a[112:115], v5 offset:28672
v_mfma_f32_16x16x32_bf16 v[180:183], a[136:139], a[80:83], v[180:183]
v_mfma_f32_16x16x32_bf16 v[180:183], a[140:143], a[84:87], v[180:183]
ds_read_b128 a[116:119], v5 offset:34816
v_mfma_f32_16x16x32_bf16 v[204:207], a[140:143], a[92:95], v[204:207]
v_mfma_f32_16x16x32_bf16 v[204:207], a[136:139], a[88:91], v[204:207]
buffer_load_dwordx4 a[56:59], v2, s[40:43], s35 offen offset:3072 sc1
v_mfma_f32_16x16x32_bf16 v[208:211], a[144:147], a[88:91], v[208:211]
v_mfma_f32_16x16x32_bf16 v[208:211], a[148:151], a[92:95], v[208:211]
v_mfma_f32_16x16x32_bf16 v[184:187], a[148:151], a[84:87], v[184:187]
v_mfma_f32_16x16x32_bf16 v[184:187], a[144:147], a[80:83], v[184:187]
v_mfma_f32_16x16x32_bf16 v[160:163], a[144:147], a[72:75], v[160:163]
buffer_load_dwordx4 a[60:63], v2, s[40:43], s33 offen offset:3072 sc1
s_add_u32 s35, s35, 0x64000
v_mfma_f32_16x16x32_bf16 v[160:163], a[148:151], a[76:79], v[160:163]
s_add_u32 s33, s33, 0x64000
v_mfma_f32_16x16x32_bf16 v[136:139], a[148:151], a[68:71], v[136:139]
v_mfma_f32_16x16x32_bf16 v[136:139], a[144:147], a[64:67], v[136:139]
s_waitcnt vmcnt(10) lgkmcnt(0)
v_mfma_f32_16x16x32_bf16 v[140:143], a[96:99], a[0:3], v[140:143]
ds_read_b128 a[128:131], v5 offset:29696
v_mfma_f32_16x16x32_bf16 v[140:143], a[100:103], a[4:7], v[140:143]
buffer_load_dwordx4 a[64:67], v2, s[40:43], s35 offen offset:0 sc1
v_mfma_f32_16x16x32_bf16 v[164:167], a[100:103], a[12:15], v[164:167]
ds_read_b128 a[132:135], v5 offset:35840
v_mfma_f32_16x16x32_bf16 v[164:167], a[96:99], a[8:11], v[164:167]
v_mfma_f32_16x16x32_bf16 v[188:191], a[96:99], a[16:19], v[188:191]
v_mfma_f32_16x16x32_bf16 v[188:191], a[100:103], a[20:23], v[188:191]
buffer_load_dwordx4 a[68:71], v2, s[40:43], s33 offen offset:0 sc1
v_mfma_f32_16x16x32_bf16 v[212:215], a[100:103], a[28:31], v[212:215]
ds_read_b128 a[136:139], v5 offset:24576
v_mfma_f32_16x16x32_bf16 v[212:215], a[96:99], a[24:27], v[212:215]
v_mfma_f32_16x16x32_bf16 v[216:219], a[104:107], a[24:27], v[216:219]
ds_read_b128 a[140:143], v5 offset:30720
v_mfma_f32_16x16x32_bf16 v[216:219], a[108:111], a[28:31], v[216:219]
v_mfma_f32_16x16x32_bf16 v[192:195], a[108:111], a[20:23], v[192:195]
buffer_load_dwordx4 v[116:119], v1, s[4:7], s88 offen offset:2048 sc1
v_mfma_f32_16x16x32_bf16 v[192:195], a[104:107], a[16:19], v[192:195]
ds_read_b128 a[144:147], v5 offset:25600
v_mfma_f32_16x16x32_bf16 v[168:171], a[104:107], a[8:11], v[168:171]
v_mfma_f32_16x16x32_bf16 v[168:171], a[108:111], a[12:15], v[168:171]
ds_read_b128 a[148:151], v5 offset:31744
v_mfma_f32_16x16x32_bf16 v[144:147], a[108:111], a[4:7], v[144:147]
v_mfma_f32_16x16x32_bf16 v[144:147], a[104:107], a[0:3], v[144:147]
buffer_load_dwordx4 a[72:75], v2, s[40:43], s35 offen offset:1024 sc1
v_mfma_f32_16x16x32_bf16 v[148:151], a[112:115], a[0:3], v[148:151]
v_mfma_f32_16x16x32_bf16 v[148:151], a[116:119], a[4:7], v[148:151]
L_stub11:
s_cbranch_execz L_wret4
v_mfma_f32_16x16x32_bf16 v[172:175], a[116:119], a[12:15], v[172:175]
v_mfma_f32_16x16x32_bf16 v[172:175], a[112:115], a[8:11], v[172:175]
v_mfma_f32_16x16x32_bf16 v[196:199], a[112:115], a[16:19], v[196:199]
buffer_load_dwordx4 a[76:79], v2, s[40:43], s33 offen offset:1024 sc1
v_mfma_f32_16x16x32_bf16 v[196:199], a[116:119], a[20:23], v[196:199]
v_mfma_f32_16x16x32_bf16 v[220:223], a[116:119], a[28:31], v[220:223]
v_mfma_f32_16x16x32_bf16 v[220:223], a[112:115], a[24:27], v[220:223]
s_waitcnt lgkmcnt(0)
v_mfma_f32_16x16x32_bf16 v[224:227], a[128:131], a[24:27], v[224:227]
ds_read_b128 a[96:99], v5 offset:38912
v_mfma_f32_16x16x32_bf16 v[224:227], a[132:135], a[28:31], v[224:227]
buffer_load_dwordx4 a[80:83], v2, s[40:43], s35 offen offset:2048 sc1
v_mfma_f32_16x16x32_bf16 v[200:203], a[132:135], a[20:23], v[200:203]
ds_read_b128 a[100:103], v5 offset:45056
v_mfma_f32_16x16x32_bf16 v[200:203], a[128:131], a[16:19], v[200:203]
v_mfma_f32_16x16x32_bf16 v[176:179], a[128:131], a[8:11], v[176:179]
v_mfma_f32_16x16x32_bf16 v[176:179], a[132:135], a[12:15], v[176:179]
buffer_load_dwordx4 a[84:87], v2, s[40:43], s33 offen offset:2048 sc1
v_mfma_f32_16x16x32_bf16 v[152:155], a[132:135], a[4:7], v[152:155]
ds_read_b128 a[104:107], v5 offset:39936
v_mfma_f32_16x16x32_bf16 v[152:155], a[128:131], a[0:3], v[152:155]
v_mfma_f32_16x16x32_bf16 v[132:135], a[136:139], a[0:3], v[132:135]
ds_read_b128 a[108:111], v5 offset:46080
v_mfma_f32_16x16x32_bf16 v[132:135], a[140:143], a[4:7], v[132:135]
v_mfma_f32_16x16x32_bf16 v[156:159], a[140:143], a[12:15], v[156:159]
buffer_load_dwordx4 v[120:123], v1, s[4:7], s88 offen offset:3072 sc1
s_add_u32 m0, s18, 0x0
v_mfma_f32_16x16x32_bf16 v[156:159], a[136:139], a[8:11], v[156:159]
s_add_u32 s44, s50, 0x2024000
ds_read_b128 a[112:115], v5 offset:40960
v_mfma_f32_16x16x32_bf16 v[180:183], a[136:139], a[16:19], v[180:183]
v_mfma_f32_16x16x32_bf16 v[180:183], a[140:143], a[20:23], v[180:183]
ds_read_b128 a[116:119], v5 offset:47104
v_mfma_f32_16x16x32_bf16 v[204:207], a[140:143], a[28:31], v[204:207]
v_mfma_f32_16x16x32_bf16 v[204:207], a[136:139], a[24:27], v[204:207]
buffer_load_dwordx4 a[88:91], v2, s[40:43], s35 offen offset:3072 sc1
v_mfma_f32_16x16x32_bf16 v[208:211], a[144:147], a[24:27], v[208:211]
v_mfma_f32_16x16x32_bf16 v[208:211], a[148:151], a[28:31], v[208:211]
v_mfma_f32_16x16x32_bf16 v[184:187], a[148:151], a[20:23], v[184:187]
v_mfma_f32_16x16x32_bf16 v[184:187], a[144:147], a[16:19], v[184:187]
v_mfma_f32_16x16x32_bf16 v[160:163], a[144:147], a[8:11], v[160:163]
buffer_load_dwordx4 a[92:95], v2, s[40:43], s33 offen offset:3072 sc1
s_add_u32 s35, s35, 0x4000
v_mfma_f32_16x16x32_bf16 v[160:163], a[148:151], a[12:15], v[160:163]
s_add_u32 s33, s33, 0x4000
v_mfma_f32_16x16x32_bf16 v[136:139], a[148:151], a[4:7], v[136:139]
v_mfma_f32_16x16x32_bf16 v[136:139], a[144:147], a[0:3], v[136:139]
s_waitcnt vmcnt(10) lgkmcnt(0)
v_mfma_f32_16x16x32_bf16 v[140:143], a[96:99], a[32:35], v[140:143]
ds_read_b128 a[128:131], v5 offset:41984
v_mfma_f32_16x16x32_bf16 v[140:143], a[100:103], a[36:39], v[140:143]
buffer_load_dwordx4 a[0:3], v2, s[40:43], s35 offen offset:0 sc1
v_mfma_f32_16x16x32_bf16 v[164:167], a[100:103], a[44:47], v[164:167]
ds_read_b128 a[132:135], v5 offset:48128
v_mfma_f32_16x16x32_bf16 v[164:167], a[96:99], a[40:43], v[164:167]
v_mfma_f32_16x16x32_bf16 v[188:191], a[96:99], a[48:51], v[188:191]
v_mfma_f32_16x16x32_bf16 v[188:191], a[100:103], a[52:55], v[188:191]
buffer_load_dwordx4 v1, s[4:7], s44 offen offset:0 sc1 lds
v_mfma_f32_16x16x32_bf16 v[212:215], a[100:103], a[60:63], v[212:215]
ds_read_b128 a[136:139], v5 offset:36864
v_mfma_f32_16x16x32_bf16 v[212:215], a[96:99], a[56:59], v[212:215]
v_mfma_f32_16x16x32_bf16 v[216:219], a[104:107], a[56:59], v[216:219]
ds_read_b128 a[140:143], v5 offset:43008
v_mfma_f32_16x16x32_bf16 v[216:219], a[108:111], a[60:63], v[216:219]
buffer_load_dwordx4 a[4:7], v2, s[40:43], s33 offen offset:0 sc1
v_mfma_f32_16x16x32_bf16 v[192:195], a[108:111], a[52:55], v[192:195]
ds_read_b128 a[144:147], v5 offset:37888
v_mfma_f32_16x16x32_bf16 v[192:195], a[104:107], a[48:51], v[192:195]
v_mfma_f32_16x16x32_bf16 v[168:171], a[104:107], a[40:43], v[168:171]
v_mfma_f32_16x16x32_bf16 v[168:171], a[108:111], a[44:47], v[168:171]
buffer_load_dwordx4 a[8:11], v2, s[40:43], s35 offen offset:1024 sc1
v_mfma_f32_16x16x32_bf16 v[144:147], a[108:111], a[36:39], v[144:147]
ds_read_b128 a[148:151], v5 offset:44032
v_mfma_f32_16x16x32_bf16 v[144:147], a[104:107], a[32:35], v[144:147]
v_mfma_f32_16x16x32_bf16 v[148:151], a[112:115], a[32:35], v[148:151]
v_mfma_f32_16x16x32_bf16 v[148:151], a[116:119], a[36:39], v[148:151]
buffer_load_dwordx4 v1, s[4:7], s44 offen offset:1024 sc1 lds
s_add_u32 m0, s18, 0x2000
v_mfma_f32_16x16x32_bf16 v[172:175], a[116:119], a[44:47], v[172:175]
s_add_u32 s44, s50, 0x2026000
v_mfma_f32_16x16x32_bf16 v[172:175], a[112:115], a[40:43], v[172:175]
v_mfma_f32_16x16x32_bf16 v[196:199], a[112:115], a[48:51], v[196:199]
v_mfma_f32_16x16x32_bf16 v[196:199], a[116:119], a[52:55], v[196:199]
buffer_load_dwordx4 a[12:15], v2, s[40:43], s33 offen offset:1024 sc1
v_mfma_f32_16x16x32_bf16 v[220:223], a[116:119], a[60:63], v[220:223]
v_mfma_f32_16x16x32_bf16 v[220:223], a[112:115], a[56:59], v[220:223]
s_waitcnt lgkmcnt(0)
s_barrier
v_mfma_f32_16x16x32_bf16 v[224:227], a[128:131], a[56:59], v[224:227]
v_add_u32 v5, 98304, v1
v_mfma_f32_16x16x32_bf16 v[224:227], a[132:135], a[60:63], v[224:227]
buffer_load_dwordx4 a[16:19], v2, s[40:43], s35 offen offset:2048 sc1
v_mfma_f32_16x16x32_bf16 v[200:203], a[132:135], a[52:55], v[200:203]
ds_read_b128 a[96:99], v5 offset:2048
v_mfma_f32_16x16x32_bf16 v[200:203], a[128:131], a[48:51], v[200:203]
ds_read_b128 a[100:103], v5 offset:8192
v_mfma_f32_16x16x32_bf16 v[176:179], a[128:131], a[40:43], v[176:179]
v_mfma_f32_16x16x32_bf16 v[176:179], a[132:135], a[44:47], v[176:179]
buffer_load_dwordx4 a[20:23], v2, s[40:43], s33 offen offset:2048 sc1
v_mfma_f32_16x16x32_bf16 v[152:155], a[132:135], a[36:39], v[152:155]
ds_read_b128 a[104:107], v5 offset:3072
v_mfma_f32_16x16x32_bf16 v[152:155], a[128:131], a[32:35], v[152:155]
v_mfma_f32_16x16x32_bf16 v[132:135], a[136:139], a[32:35], v[132:135]
ds_read_b128 a[108:111], v5 offset:9216
v_mfma_f32_16x16x32_bf16 v[132:135], a[140:143], a[36:39], v[132:135]
v_mfma_f32_16x16x32_bf16 v[156:159], a[140:143], a[44:47], v[156:159]
buffer_load_dwordx4 v1, s[4:7], s44 offen offset:0 sc1 lds
v_mfma_f32_16x16x32_bf16 v[156:159], a[136:139], a[40:43], v[156:159]
ds_read_b128 a[112:115], v5 offset:4096
v_mfma_f32_16x16x32_bf16 v[180:183], a[136:139], a[48:51], v[180:183]
v_mfma_f32_16x16x32_bf16 v[180:183], a[140:143], a[52:55], v[180:183]
ds_read_b128 a[116:119], v5 offset:10240
v_mfma_f32_16x16x32_bf16 v[204:207], a[140:143], a[60:63], v[204:207]
v_mfma_f32_16x16x32_bf16 v[204:207], a[136:139], a[56:59], v[204:207]
buffer_load_dwordx4 a[24:27], v2, s[40:43], s35 offen offset:3072 sc1
v_mfma_f32_16x16x32_bf16 v[208:211], a[144:147], a[56:59], v[208:211]
v_mfma_f32_16x16x32_bf16 v[208:211], a[148:151], a[60:63], v[208:211]
v_mfma_f32_16x16x32_bf16 v[184:187], a[148:151], a[52:55], v[184:187]
v_mfma_f32_16x16x32_bf16 v[184:187], a[144:147], a[48:51], v[184:187]
v_mfma_f32_16x16x32_bf16 v[160:163], a[144:147], a[40:43], v[160:163]
buffer_load_dwordx4 a[28:31], v2, s[40:43], s33 offen offset:3072 sc1
s_add_u32 s35, s35, 0x4000
v_mfma_f32_16x16x32_bf16 v[160:163], a[148:151], a[44:47], v[160:163]
s_add_u32 s33, s33, 0x4000
v_mfma_f32_16x16x32_bf16 v[136:139], a[148:151], a[36:39], v[136:139]
v_mfma_f32_16x16x32_bf16 v[136:139], a[144:147], a[32:35], v[136:139]
s_waitcnt vmcnt(11) lgkmcnt(0)
v_mfma_f32_16x16x32_bf16 v[140:143], a[96:99], a[64:67], v[140:143]
ds_read_b128 a[128:131], v5 offset:5120
v_mfma_f32_16x16x32_bf16 v[140:143], a[100:103], a[68:71], v[140:143]
buffer_load_dwordx4 a[32:35], v2, s[40:43], s35 offen offset:0 sc1
v_mfma_f32_16x16x32_bf16 v[164:167], a[100:103], a[76:79], v[164:167]
ds_read_b128 a[132:135], v5 offset:11264
v_mfma_f32_16x16x32_bf16 v[164:167], a[96:99], a[72:75], v[164:167]
v_mfma_f32_16x16x32_bf16 v[188:191], a[96:99], a[80:83], v[188:191]
v_mfma_f32_16x16x32_bf16 v[188:191], a[100:103], a[84:87], v[188:191]
buffer_load_dwordx4 a[36:39], v2, s[40:43], s33 offen offset:0 sc1
v_mfma_f32_16x16x32_bf16 v[212:215], a[100:103], a[92:95], v[212:215]
ds_read_b128 a[136:139], v5 offset:0
v_mfma_f32_16x16x32_bf16 v[212:215], a[96:99], a[88:91], v[212:215]
v_mfma_f32_16x16x32_bf16 v[216:219], a[104:107], a[88:91], v[216:219]
ds_read_b128 a[140:143], v5 offset:6144
v_mfma_f32_16x16x32_bf16 v[216:219], a[108:111], a[92:95], v[216:219]
v_mfma_f32_16x16x32_bf16 v[192:195], a[108:111], a[84:87], v[192:195]
buffer_load_dwordx4 v1, s[4:7], s44 offen offset:1024 sc1 lds
s_add_u32 m0, s18, 0x4000
v_mfma_f32_16x16x32_bf16 v[192:195], a[104:107], a[80:83], v[192:195]
s_add_u32 s44, s50, 0x2028000
ds_read_b128 a[144:147], v5 offset:1024
v_mfma_f32_16x16x32_bf16 v[168:171], a[104:107], a[72:75], v[168:171]
v_mfma_f32_16x16x32_bf16 v[168:171], a[108:111], a[76:79], v[168:171]
ds_read_b128 a[148:151], v5 offset:7168
v_mfma_f32_16x16x32_bf16 v[144:147], a[108:111], a[68:71], v[144:147]
v_mfma_f32_16x16x32_bf16 v[144:147], a[104:107], a[64:67], v[144:147]
buffer_load_dwordx4 a[40:43], v2, s[40:43], s35 offen offset:1024 sc1
v_mfma_f32_16x16x32_bf16 v[148:151], a[112:115], a[64:67], v[148:151]
v_mfma_f32_16x16x32_bf16 v[148:151], a[116:119], a[68:71], v[148:151]
v_mfma_f32_16x16x32_bf16 v[172:175], a[116:119], a[76:79], v[172:175]
v_mfma_f32_16x16x32_bf16 v[172:175], a[112:115], a[72:75], v[172:175]
v_mfma_f32_16x16x32_bf16 v[196:199], a[112:115], a[80:83], v[196:199]
buffer_load_dwordx4 a[44:47], v2, s[40:43], s33 offen offset:1024 sc1
v_mfma_f32_16x16x32_bf16 v[196:199], a[116:119], a[84:87], v[196:199]
v_mfma_f32_16x16x32_bf16 v[220:223], a[116:119], a[92:95], v[220:223]
v_mfma_f32_16x16x32_bf16 v[220:223], a[112:115], a[88:91], v[220:223]
s_waitcnt lgkmcnt(0)
v_mfma_f32_16x16x32_bf16 v[224:227], a[128:131], a[88:91], v[224:227]
ds_read_b128 a[96:99], v5 offset:14336
v_mfma_f32_16x16x32_bf16 v[224:227], a[132:135], a[92:95], v[224:227]
buffer_load_dwordx4 a[48:51], v2, s[40:43], s35 offen offset:2048 sc1
v_mfma_f32_16x16x32_bf16 v[200:203], a[132:135], a[84:87], v[200:203]
ds_read_b128 a[100:103], v5 offset:20480
v_mfma_f32_16x16x32_bf16 v[200:203], a[128:131], a[80:83], v[200:203]
v_mfma_f32_16x16x32_bf16 v[176:179], a[128:131], a[72:75], v[176:179]
v_mfma_f32_16x16x32_bf16 v[176:179], a[132:135], a[76:79], v[176:179]
buffer_load_dwordx4 a[52:55], v2, s[40:43], s33 offen offset:2048 sc1
v_mfma_f32_16x16x32_bf16 v[152:155], a[132:135], a[68:71], v[152:155]
ds_read_b128 a[104:107], v5 offset:15360
v_mfma_f32_16x16x32_bf16 v[152:155], a[128:131], a[64:67], v[152:155]
v_mfma_f32_16x16x32_bf16 v[132:135], a[136:139], a[64:67], v[132:135]
ds_read_b128 a[108:111], v5 offset:21504
v_mfma_f32_16x16x32_bf16 v[132:135], a[140:143], a[68:71], v[132:135]
v_mfma_f32_16x16x32_bf16 v[156:159], a[140:143], a[76:79], v[156:159]
buffer_load_dwordx4 v1, s[4:7], s44 offen offset:0 sc1 lds
v_mfma_f32_16x16x32_bf16 v[156:159], a[136:139], a[72:75], v[156:159]
ds_read_b128 a[112:115], v5 offset:16384
v_mfma_f32_16x16x32_bf16 v[180:183], a[136:139], a[80:83], v[180:183]
v_mfma_f32_16x16x32_bf16 v[180:183], a[140:143], a[84:87], v[180:183]
ds_read_b128 a[116:119], v5 offset:22528
v_mfma_f32_16x16x32_bf16 v[204:207], a[140:143], a[92:95], v[204:207]
v_mfma_f32_16x16x32_bf16 v[204:207], a[136:139], a[88:91], v[204:207]
buffer_load_dwordx4 a[56:59], v2, s[40:43], s35 offen offset:3072 sc1
v_mfma_f32_16x16x32_bf16 v[208:211], a[144:147], a[88:91], v[208:211]
v_mfma_f32_16x16x32_bf16 v[208:211], a[148:151], a[92:95], v[208:211]
v_mfma_f32_16x16x32_bf16 v[184:187], a[148:151], a[84:87], v[184:187]
v_mfma_f32_16x16x32_bf16 v[184:187], a[144:147], a[80:83], v[184:187]
v_mfma_f32_16x16x32_bf16 v[160:163], a[144:147], a[72:75], v[160:163]
buffer_load_dwordx4 a[60:63], v2, s[40:43], s33 offen offset:3072 sc1
s_add_u32 s35, s35, 0x4000
v_mfma_f32_16x16x32_bf16 v[160:163], a[148:151], a[76:79], v[160:163]
s_add_u32 s33, s33, 0x4000
v_mfma_f32_16x16x32_bf16 v[136:139], a[148:151], a[68:71], v[136:139]
v_mfma_f32_16x16x32_bf16 v[136:139], a[144:147], a[64:67], v[136:139]
s_waitcnt vmcnt(10) lgkmcnt(0)
v_mfma_f32_16x16x32_bf16 v[140:143], a[96:99], a[0:3], v[140:143]
ds_read_b128 a[128:131], v5 offset:17408
v_add_f32 v92, v92, v96
v_mfma_f32_16x16x32_bf16 v[140:143], a[100:103], a[4:7], v[140:143]
buffer_load_dwordx4 a[64:67], v2, s[40:43], s35 offen offset:0 sc1
v_mfma_f32_16x16x32_bf16 v[164:167], a[100:103], a[12:15], v[164:167]
ds_read_b128 a[132:135], v5 offset:23552
v_add_f32 v100, v100, v104
v_mfma_f32_16x16x32_bf16 v[164:167], a[96:99], a[8:11], v[164:167]
v_add_f32 v108, v108, v112
v_add_f32 v116, v116, v120
v_mfma_f32_16x16x32_bf16 v[188:191], a[96:99], a[16:19], v[188:191]
v_add_f32 v93, v93, v97
v_add_f32 v101, v101, v105
v_mfma_f32_16x16x32_bf16 v[188:191], a[100:103], a[20:23], v[188:191]
buffer_load_dwordx4 a[68:71], v2, s[40:43], s33 offen offset:0 sc1
v_mfma_f32_16x16x32_bf16 v[212:215], a[100:103], a[28:31], v[212:215]
ds_read_b128 a[136:139], v5 offset:12288
v_add_f32 v109, v109, v113
v_mfma_f32_16x16x32_bf16 v[212:215], a[96:99], a[24:27], v[212:215]
v_add_f32 v117, v117, v121
v_add_f32 v94, v94, v98
v_mfma_f32_16x16x32_bf16 v[216:219], a[104:107], a[24:27], v[216:219]
ds_read_b128 a[140:143], v5 offset:18432
v_add_f32 v102, v102, v106
v_mfma_f32_16x16x32_bf16 v[216:219], a[108:111], a[28:31], v[216:219]
v_add_f32 v110, v110, v114
v_mfma_f32_16x16x32_bf16 v[192:195], a[108:111], a[20:23], v[192:195]
buffer_load_dwordx4 v1, s[4:7], s44 offen offset:1024 sc1 lds
s_add_u32 m0, s18, 0x6000
v_mfma_f32_16x16x32_bf16 v[192:195], a[104:107], a[16:19], v[192:195]
s_add_u32 s44, s50, 0x202a000
ds_read_b128 a[144:147], v5 offset:13312
v_mfma_f32_16x16x32_bf16 v[168:171], a[104:107], a[8:11], v[168:171]
v_add_f32 v118, v118, v122
v_add_f32 v95, v95, v99
v_mfma_f32_16x16x32_bf16 v[168:171], a[108:111], a[12:15], v[168:171]
ds_read_b128 a[148:151], v5 offset:19456
v_add_f32 v103, v103, v107
v_mfma_f32_16x16x32_bf16 v[144:147], a[108:111], a[4:7], v[144:147]
v_add_f32 v111, v111, v115
v_add_f32 v119, v119, v123
v_mfma_f32_16x16x32_bf16 v[144:147], a[104:107], a[0:3], v[144:147]
buffer_load_dwordx4 a[72:75], v2, s[40:43], s35 offen offset:1024 sc1
v_mfma_f32_16x16x32_bf16 v[148:151], a[112:115], a[0:3], v[148:151]
v_add_f32_dpp v92, v92, v92 row_ror:8 row_mask:0xf bank_mask:0xf
v_add_f32_dpp v100, v100, v100 row_ror:8 row_mask:0xf bank_mask:0xf
v_mfma_f32_16x16x32_bf16 v[148:151], a[116:119], a[4:7], v[148:151]
v_add_f32_dpp v108, v108, v108 row_ror:8 row_mask:0xf bank_mask:0xf
v_mfma_f32_16x16x32_bf16 v[172:175], a[116:119], a[12:15], v[172:175]
v_add_f32_dpp v116, v116, v116 row_ror:8 row_mask:0xf bank_mask:0xf
v_mfma_f32_16x16x32_bf16 v[172:175], a[112:115], a[8:11], v[172:175]
v_add_f32_dpp v93, v93, v93 row_ror:8 row_mask:0xf bank_mask:0xf
v_mfma_f32_16x16x32_bf16 v[196:199], a[112:115], a[16:19], v[196:199]
buffer_load_dwordx4 a[76:79], v2, s[40:43], s33 offen offset:1024 sc1
v_mfma_f32_16x16x32_bf16 v[196:199], a[116:119], a[20:23], v[196:199]
v_add_f32_dpp v101, v101, v101 row_ror:8 row_mask:0xf bank_mask:0xf
v_add_f32_dpp v109, v109, v109 row_ror:8 row_mask:0xf bank_mask:0xf
v_mfma_f32_16x16x32_bf16 v[220:223], a[116:119], a[28:31], v[220:223]
v_add_f32_dpp v117, v117, v117 row_ror:8 row_mask:0xf bank_mask:0xf
v_mfma_f32_16x16x32_bf16 v[220:223], a[112:115], a[24:27], v[220:223]
v_add_f32_dpp v92, v94, v94 row_ror:8 row_mask:0xf bank_mask:0xc
s_waitcnt lgkmcnt(0)
v_mfma_f32_16x16x32_bf16 v[224:227], a[128:131], a[24:27], v[224:227]
ds_read_b128 a[96:99], v5 offset:26624
v_add_f32_dpp v100, v102, v102 row_ror:8 row_mask:0xf bank_mask:0xc
v_mfma_f32_16x16x32_bf16 v[224:227], a[132:135], a[28:31], v[224:227]
buffer_load_dwordx4 a[80:83], v2, s[40:43], s35 offen offset:2048 sc1
v_mfma_f32_16x16x32_bf16 v[200:203], a[132:135], a[20:23], v[200:203]
ds_read_b128 a[100:103], v5 offset:32768
v_add_f32_dpp v108, v110, v110 row_ror:8 row_mask:0xf bank_mask:0xc
v_mfma_f32_16x16x32_bf16 v[200:203], a[128:131], a[16:19], v[200:203]
v_add_f32_dpp v116, v118, v118 row_ror:8 row_mask:0xf bank_mask:0xc
v_add_f32_dpp v93, v95, v95 row_ror:8 row_mask:0xf bank_mask:0xc
v_mfma_f32_16x16x32_bf16 v[176:179], a[128:131], a[8:11], v[176:179]
v_add_f32_dpp v101, v103, v103 row_ror:8 row_mask:0xf bank_mask:0xc
v_add_f32_dpp v109, v111, v111 row_ror:8 row_mask:0xf bank_mask:0xc
v_mfma_f32_16x16x32_bf16 v[176:179], a[132:135], a[12:15], v[176:179]
buffer_load_dwordx4 v1, s[4:7], s44 offen offset:0 sc1 lds
v_mfma_f32_16x16x32_bf16 v[152:155], a[132:135], a[4:7], v[152:155]
ds_read_b128 a[104:107], v5 offset:27648
v_add_f32_dpp v117, v119, v119 row_ror:8 row_mask:0xf bank_mask:0xc
v_mfma_f32_16x16x32_bf16 v[152:155], a[128:131], a[0:3], v[152:155]
v_permlane32_swap_b32 v92, v93
v_mfma_f32_16x16x32_bf16 v[132:135], a[136:139], a[0:3], v[132:135]
ds_read_b128 a[108:111], v5 offset:33792
v_mfma_f32_16x16x32_bf16 v[132:135], a[140:143], a[4:7], v[132:135]
buffer_load_dwordx4 a[84:87], v2, s[40:43], s33 offen offset:2048 sc1
v_mfma_f32_16x16x32_bf16 v[156:159], a[140:143], a[12:15], v[156:159]
ds_read_b128 a[112:115], v5 offset:28672
v_mfma_f32_16x16x32_bf16 v[156:159], a[136:139], a[8:11], v[156:159]
v_permlane32_swap_b32 v100, v101
v_mfma_f32_16x16x32_bf16 v[180:183], a[136:139], a[16:19], v[180:183]
v_permlane32_swap_b32 v108, v109
v_mfma_f32_16x16x32_bf16 v[180:183], a[140:143], a[20:23], v[180:183]
buffer_load_dwordx4 a[88:91], v2, s[40:43], s35 offen offset:3072 sc1
v_mfma_f32_16x16x32_bf16 v[204:207], a[140:143], a[28:31], v[204:207]
ds_read_b128 a[116:119], v5 offset:34816
v_mfma_f32_16x16x32_bf16 v[204:207], a[136:139], a[24:27], v[204:207]
v_permlane32_swap_b32 v116, v117
v_mfma_f32_16x16x32_bf16 v[208:211], a[144:147], a[24:27], v[208:211]
v_add_f32 v92, v92, v93
v_add_f32 v100, v100, v101
v_mfma_f32_16x16x32_bf16 v[208:211], a[148:151], a[28:31], v[208:211]
buffer_load_dwordx4 v1, s[4:7], s44 offen offset:1024 sc1 lds
s_add_u32 m0, s18, 0x8000
v_mfma_f32_16x16x32_bf16 v[184:187], a[148:151], a[20:23], v[184:187]
s_add_u32 s44, s50, 0x202c000
v_add_f32 v108, v108, v109
v_mfma_f32_16x16x32_bf16 v[184:187], a[144:147], a[16:19], v[184:187]
v_add_f32 v116, v116, v117
v_mov_b32 v94, v92
v_mfma_f32_16x16x32_bf16 v[160:163], a[144:147], a[8:11], v[160:163]
v_mov_b32 v102, v100
v_mov_b32 v110, v108
v_mfma_f32_16x16x32_bf16 v[160:163], a[148:151], a[12:15], v[160:163]
buffer_load_dwordx4 a[92:95], v2, s[40:43], s33 offen offset:3072 sc1
s_add_u32 s35, s35, 0x4000
v_mfma_f32_16x16x32_bf16 v[136:139], a[148:151], a[4:7], v[136:139]
s_add_u32 s33, s33, 0x4000
v_mov_b32 v118, v116
v_mfma_f32_16x16x32_bf16 v[136:139], a[144:147], a[0:3], v[136:139]
s_waitcnt vmcnt(11) lgkmcnt(0)
v_mfma_f32_16x16x32_bf16 v[140:143], a[96:99], a[32:35], v[140:143]
ds_read_b128 a[128:131], v5 offset:29696
v_mfma_f32_16x16x32_bf16 v[140:143], a[100:103], a[36:39], v[140:143]
buffer_load_dwordx4 a[0:3], v2, s[40:43], s35 offen offset:0 sc1
v_mfma_f32_16x16x32_bf16 v[164:167], a[100:103], a[44:47], v[164:167]
ds_read_b128 a[132:135], v5 offset:35840
v_mfma_f32_16x16x32_bf16 v[164:167], a[96:99], a[40:43], v[164:167]
v_permlane16_swap_b32 v92, v94
v_mfma_f32_16x16x32_bf16 v[188:191], a[96:99], a[48:51], v[188:191]
v_permlane16_swap_b32 v100, v102
v_mfma_f32_16x16x32_bf16 v[188:191], a[100:103], a[52:55], v[188:191]
buffer_load_dwordx4 a[4:7], v2, s[40:43], s33 offen offset:0 sc1
v_mfma_f32_16x16x32_bf16 v[212:215], a[100:103], a[60:63], v[212:215]
ds_read_b128 a[136:139], v5 offset:24576
v_mfma_f32_16x16x32_bf16 v[212:215], a[96:99], a[56:59], v[212:215]
v_permlane16_swap_b32 v108, v110
v_mfma_f32_16x16x32_bf16 v[216:219], a[104:107], a[56:59], v[216:219]
ds_read_b128 a[140:143], v5 offset:30720
v_mfma_f32_16x16x32_bf16 v[216:219], a[108:111], a[60:63], v[216:219]
v_permlane16_swap_b32 v116, v118
v_mfma_f32_16x16x32_bf16 v[192:195], a[108:111], a[52:55], v[192:195]
buffer_load_dwordx4 v1, s[4:7], s44 offen offset:0 sc1 lds
v_mfma_f32_16x16x32_bf16 v[192:195], a[104:107], a[48:51], v[192:195]
ds_read_b128 a[144:147], v5 offset:25600
v_add_f32 v92, v92, v94
v_mfma_f32_16x16x32_bf16 v[168:171], a[104:107], a[40:43], v[168:171]
v_add_f32 v100, v100, v102
v_add_f32 v108, v108, v110
v_mfma_f32_16x16x32_bf16 v[168:171], a[108:111], a[44:47], v[168:171]
ds_read_b128 a[148:151], v5 offset:31744
v_add_f32 v116, v116, v118
v_mfma_f32_16x16x32_bf16 v[144:147], a[108:111], a[36:39], v[144:147]
v_mov_b32 v94, v92
v_mov_b32 v102, v100
v_mfma_f32_16x16x32_bf16 v[144:147], a[104:107], a[32:35], v[144:147]
buffer_load_dwordx4 a[8:11], v2, s[40:43], s35 offen offset:1024 sc1
v_mfma_f32_16x16x32_bf16 v[148:151], a[112:115], a[32:35], v[148:151]
v_mov_b32 v110, v108
v_mov_b32 v118, v116
v_mfma_f32_16x16x32_bf16 v[148:151], a[116:119], a[36:39], v[148:151]
v_permlane32_swap_b32 v92, v94
v_mfma_f32_16x16x32_bf16 v[172:175], a[116:119], a[44:47], v[172:175]
v_permlane32_swap_b32 v100, v102
v_mfma_f32_16x16x32_bf16 v[172:175], a[112:115], a[40:43], v[172:175]
v_permlane32_swap_b32 v108, v110
v_mfma_f32_16x16x32_bf16 v[196:199], a[112:115], a[48:51], v[196:199]
buffer_load_dwordx4 a[12:15], v2, s[40:43], s33 offen offset:1024 sc1
v_mfma_f32_16x16x32_bf16 v[196:199], a[116:119], a[52:55], v[196:199]
v_permlane32_swap_b32 v116, v118
v_mfma_f32_16x16x32_bf16 v[220:223], a[116:119], a[60:63], v[220:223]
v_mul_f32 v82, 0xba800000, v92
v_mul_f32 v84, 0xba800000, v100
v_mfma_f32_16x16x32_bf16 v[220:223], a[112:115], a[56:59], v[220:223]
v_mul_f32 v86, 0xba800000, v108
s_waitcnt lgkmcnt(0)
v_mfma_f32_16x16x32_bf16 v[224:227], a[128:131], a[56:59], v[224:227]
ds_read_b128 a[96:99], v5 offset:38912
v_mul_f32 v88, 0xba800000, v116
v_mfma_f32_16x16x32_bf16 v[224:227], a[132:135], a[60:63], v[224:227]
buffer_load_dwordx4 a[16:19], v2, s[40:43], s35 offen offset:2048 sc1
v_mfma_f32_16x16x32_bf16 v[200:203], a[132:135], a[52:55], v[200:203]
ds_read_b128 a[100:103], v5 offset:45056
v_mul_f32 v94, 0x3a800000, v94
v_mfma_f32_16x16x32_bf16 v[200:203], a[128:131], a[48:51], v[200:203]
v_mul_f32 v102, 0x3a800000, v102
v_mul_f32 v110, 0x3a800000, v110
v_mfma_f32_16x16x32_bf16 v[176:179], a[128:131], a[40:43], v[176:179]
v_mul_f32 v118, 0x3a800000, v118
v_fma_f32 v94, -v82, v82, v94
v_mfma_f32_16x16x32_bf16 v[176:179], a[132:135], a[44:47], v[176:179]
buffer_load_dwordx4 a[20:23], v2, s[40:43], s33 offen offset:2048 sc1
v_mfma_f32_16x16x32_bf16 v[152:155], a[132:135], a[36:39], v[152:155]
ds_read_b128 a[104:107], v5 offset:39936
v_fma_f32 v102, -v84, v84, v102
v_mfma_f32_16x16x32_bf16 v[152:155], a[128:131], a[32:35], v[152:155]
v_fma_f32 v110, -v86, v86, v110
v_fma_f32 v118, -v88, v88, v118
v_mfma_f32_16x16x32_bf16 v[132:135], a[136:139], a[32:35], v[132:135]
ds_read_b128 a[108:111], v5 offset:46080
v_max_f32 v94, 0, v94
v_mfma_f32_16x16x32_bf16 v[132:135], a[140:143], a[36:39], v[132:135]
v_max_f32 v102, 0, v102
v_mfma_f32_16x16x32_bf16 v[156:159], a[140:143], a[44:47], v[156:159]
buffer_load_dwordx4 v1, s[4:7], s44 offen offset:1024 sc1 lds
s_add_u32 m0, s18, 0xa000
v_mfma_f32_16x16x32_bf16 v[156:159], a[136:139], a[40:43], v[156:159]
s_add_u32 s44, s50, 0x202e000
ds_read_b128 a[112:115], v5 offset:40960
v_mfma_f32_16x16x32_bf16 v[180:183], a[136:139], a[48:51], v[180:183]
v_max_f32 v110, 0, v110
v_max_f32 v118, 0, v118
v_mfma_f32_16x16x32_bf16 v[180:183], a[140:143], a[52:55], v[180:183]
ds_read_b128 a[116:119], v5 offset:47104
v_add_f32 v94, 0x3727c5ac, v94
v_mfma_f32_16x16x32_bf16 v[204:207], a[140:143], a[60:63], v[204:207]
v_add_f32 v102, 0x3727c5ac, v102
v_add_f32 v110, 0x3727c5ac, v110
v_mfma_f32_16x16x32_bf16 v[204:207], a[136:139], a[56:59], v[204:207]
buffer_load_dwordx4 a[24:27], v2, s[40:43], s35 offen offset:3072 sc1
v_mfma_f32_16x16x32_bf16 v[208:211], a[144:147], a[56:59], v[208:211]
v_add_f32 v118, 0x3727c5ac, v118
v_mfma_f32_16x16x32_bf16 v[208:211], a[148:151], a[60:63], v[208:211]
v_rsq_f32 v83, v94
v_mfma_f32_16x16x32_bf16 v[184:187], a[148:151], a[52:55], v[184:187]
v_rsq_f32 v85, v102
v_mfma_f32_16x16x32_bf16 v[184:187], a[144:147], a[48:51], v[184:187]
v_mfma_f32_16x16x32_bf16 v[160:163], a[144:147], a[40:43], v[160:163]
buffer_load_dwordx4 a[28:31], v2, s[40:43], s33 offen offset:3072 sc1
s_add_u32 s35, s35, 0x4000
v_mfma_f32_16x16x32_bf16 v[160:163], a[148:151], a[44:47], v[160:163]
s_add_u32 s33, s33, 0x4000
v_mfma_f32_16x16x32_bf16 v[136:139], a[148:151], a[36:39], v[136:139]
v_rsq_f32 v87, v110
v_mfma_f32_16x16x32_bf16 v[136:139], a[144:147], a[32:35], v[136:139]
s_waitcnt vmcnt(10) lgkmcnt(0)
v_mfma_f32_16x16x32_bf16 v[140:143], a[96:99], a[64:67], v[140:143]
ds_read_b128 a[128:131], v5 offset:41984
v_mfma_f32_16x16x32_bf16 v[140:143], a[100:103], a[68:71], v[140:143]
buffer_load_dwordx4 a[32:35], v2, s[40:43], s35 offen offset:0 sc1
v_mfma_f32_16x16x32_bf16 v[164:167], a[100:103], a[76:79], v[164:167]
ds_read_b128 a[132:135], v5 offset:48128
v_mfma_f32_16x16x32_bf16 v[164:167], a[96:99], a[72:75], v[164:167]
v_rsq_f32 v89, v118
v_mfma_f32_16x16x32_bf16 v[188:191], a[96:99], a[80:83], v[188:191]
v_mfma_f32_16x16x32_bf16 v[188:191], a[100:103], a[84:87], v[188:191]
buffer_load_dwordx4 a[36:39], v2, s[40:43], s33 offen offset:0 sc1
v_mfma_f32_16x16x32_bf16 v[212:215], a[100:103], a[92:95], v[212:215]
ds_read_b128 a[136:139], v5 offset:36864
v_mfma_f32_16x16x32_bf16 v[212:215], a[96:99], a[88:91], v[212:215]
v_mfma_f32_16x16x32_bf16 v[216:219], a[104:107], a[88:91], v[216:219]
ds_read_b128 a[140:143], v5 offset:43008
v_mfma_f32_16x16x32_bf16 v[216:219], a[108:111], a[92:95], v[216:219]
v_mfma_f32_16x16x32_bf16 v[192:195], a[108:111], a[84:87], v[192:195]
buffer_load_dwordx4 v1, s[4:7], s44 offen offset:0 sc1 lds
v_mfma_f32_16x16x32_bf16 v[192:195], a[104:107], a[80:83], v[192:195]
ds_read_b128 a[144:147], v5 offset:37888
v_fmac_f32 v140, v56, v82
v_mfma_f32_16x16x32_bf16 v[168:171], a[104:107], a[72:75], v[168:171]
v_fmac_f32 v164, v56, v84
v_mfma_f32_16x16x32_bf16 v[168:171], a[108:111], a[76:79], v[168:171]
ds_read_b128 a[148:151], v5 offset:44032
v_mfma_f32_16x16x32_bf16 v[144:147], a[108:111], a[68:71], v[144:147]
v_fmac_f32 v188, v56, v86
v_mfma_f32_16x16x32_bf16 v[144:147], a[104:107], a[64:67], v[144:147]
buffer_load_dwordx4 a[40:43], v2, s[40:43], s35 offen offset:1024 sc1
v_mfma_f32_16x16x32_bf16 v[148:151], a[112:115], a[64:67], v[148:151]
v_fmac_f32 v212, v56, v88
v_mfma_f32_16x16x32_bf16 v[148:151], a[116:119], a[68:71], v[148:151]
v_mfma_f32_16x16x32_bf16 v[172:175], a[116:119], a[76:79], v[172:175]
v_fmac_f32 v216, v60, v88
v_mfma_f32_16x16x32_bf16 v[172:175], a[112:115], a[72:75], v[172:175]
v_mfma_f32_16x16x32_bf16 v[196:199], a[112:115], a[80:83], v[196:199]
buffer_load_dwordx4 a[44:47], v2, s[40:43], s33 offen offset:1024 sc1
v_mfma_f32_16x16x32_bf16 v[196:199], a[116:119], a[84:87], v[196:199]
v_fmac_f32 v192, v60, v86
v_mfma_f32_16x16x32_bf16 v[220:223], a[116:119], a[92:95], v[220:223]
v_fmac_f32 v168, v60, v84
v_fmac_f32 v141, v57, v82
v_mfma_f32_16x16x32_bf16 v[220:223], a[112:115], a[88:91], v[220:223]
s_waitcnt lgkmcnt(0)
s_barrier
v_mfma_f32_16x16x32_bf16 v[224:227], a[128:131], a[88:91], v[224:227]
v_add_u32 v5, 0, v1
v_fmac_f32 v144, v60, v82
v_mfma_f32_16x16x32_bf16 v[224:227], a[132:135], a[92:95], v[224:227]
buffer_load_dwordx4 a[48:51], v2, s[40:43], s35 offen offset:2048 sc1
v_mfma_f32_16x16x32_bf16 v[200:203], a[132:135], a[84:87], v[200:203]
ds_read_b128 a[96:99], v5 offset:2048
v_fmac_f32 v148, v64, v82
v_mfma_f32_16x16x32_bf16 v[200:203], a[128:131], a[80:83], v[200:203]
ds_read_b128 a[100:103], v5 offset:8192
v_fmac_f32 v165, v57, v84
v_mfma_f32_16x16x32_bf16 v[176:179], a[128:131], a[72:75], v[176:179]
v_fmac_f32 v172, v64, v84
v_fmac_f32 v189, v57, v86
v_mfma_f32_16x16x32_bf16 v[176:179], a[132:135], a[76:79], v[176:179]
buffer_load_dwordx4 a[52:55], v2, s[40:43], s33 offen offset:2048 sc1
v_mfma_f32_16x16x32_bf16 v[152:155], a[132:135], a[68:71], v[152:155]
ds_read_b128 a[104:107], v5 offset:3072
v_fmac_f32 v196, v64, v86
v_mfma_f32_16x16x32_bf16 v[152:155], a[128:131], a[64:67], v[152:155]
v_fmac_f32 v213, v57, v88
v_fmac_f32 v217, v61, v88
v_mfma_f32_16x16x32_bf16 v[132:135], a[136:139], a[64:67], v[132:135]
ds_read_b128 a[108:111], v5 offset:9216
v_fmac_f32 v220, v64, v88
v_mfma_f32_16x16x32_bf16 v[132:135], a[140:143], a[68:71], v[132:135]
v_fmac_f32 v193, v61, v86
v_mfma_f32_16x16x32_bf16 v[156:159], a[140:143], a[76:79], v[156:159]
buffer_load_dwordx4 v1, s[4:7], s44 offen offset:1024 sc1 lds
s_add_u32 m0, s19, 49152
v_mfma_f32_16x16x32_bf16 v[156:159], a[136:139], a[72:75], v[156:159]
s_xor_b32 s44, s84, 16384
ds_read_b128 a[112:115], v5 offset:4096
v_mfma_f32_16x16x32_bf16 v[180:183], a[136:139], a[80:83], v[180:183]
v_fmac_f32 v224, v68, v88
v_fmac_f32 v200, v68, v86
v_mfma_f32_16x16x32_bf16 v[180:183], a[140:143], a[84:87], v[180:183]
ds_read_b128 a[116:119], v5 offset:10240
v_fmac_f32 v169, v61, v84
v_mfma_f32_16x16x32_bf16 v[204:207], a[140:143], a[92:95], v[204:207]
v_fmac_f32 v176, v68, v84
v_fmac_f32 v145, v61, v82
v_mfma_f32_16x16x32_bf16 v[204:207], a[136:139], a[88:91], v[204:207]
buffer_load_dwordx4 a[56:59], v2, s[40:43], s35 offen offset:3072 sc1
v_mfma_f32_16x16x32_bf16 v[208:211], a[144:147], a[88:91], v[208:211]
v_fmac_f32 v152, v68, v82
v_fmac_f32 v149, v65, v82
v_mfma_f32_16x16x32_bf16 v[208:211], a[148:151], a[92:95], v[208:211]
v_fmac_f32 v173, v65, v84
v_mfma_f32_16x16x32_bf16 v[184:187], a[148:151], a[84:87], v[184:187]
v_fmac_f32 v132, v48, v82
v_fmac_f32 v197, v65, v86
v_mfma_f32_16x16x32_bf16 v[184:187], a[144:147], a[80:83], v[184:187]
v_mfma_f32_16x16x32_bf16 v[160:163], a[144:147], a[72:75], v[160:163]
buffer_load_dwordx4 a[60:63], v2, s[40:43], s33 offen offset:3072 sc1
s_add_u32 s35, s35, 0x4000
v_mfma_f32_16x16x32_bf16 v[160:163], a[148:151], a[76:79], v[160:163]
s_add_u32 s33, s33, 0x4000
v_fmac_f32 v156, v48, v84
v_mfma_f32_16x16x32_bf16 v[136:139], a[148:151], a[68:71], v[136:139]
v_fmac_f32 v180, v48, v86
v_fmac_f32 v221, v65, v88
v_mfma_f32_16x16x32_bf16 v[136:139], a[144:147], a[64:67], v[136:139]
v_fmac_f32 v225, v69, v88
s_waitcnt vmcnt(10) lgkmcnt(0)
v_mfma_f32_16x16x32_bf16 v[140:143], a[96:99], a[0:3], v[140:143]
ds_read_b128 a[128:131], v5 offset:5120
v_fmac_f32 v204, v48, v88
v_mfma_f32_16x16x32_bf16 v[140:143], a[100:103], a[4:7], v[140:143]
buffer_load_dwordx4 a[64:67], v2, s[40:43], s35 offen offset:0 sc1
s_lshl_b32 s37, s28, 10
v_mfma_f32_16x16x32_bf16 v[164:167], a[100:103], a[12:15], v[164:167]
ds_read_b128 a[132:135], v5 offset:11264
v_fmac_f32 v208, v52, v88
v_mfma_f32_16x16x32_bf16 v[164:167], a[96:99], a[8:11], v[164:167]
v_fmac_f32 v201, v69, v86
v_fmac_f32 v177, v69, v84
L_stub12:
s_cbranch_execz L_wret3
v_mfma_f32_16x16x32_bf16 v[188:191], a[96:99], a[16:19], v[188:191]
v_fmac_f32 v184, v52, v86
v_fmac_f32 v153, v69, v82
v_mfma_f32_16x16x32_bf16 v[188:191], a[100:103], a[20:23], v[188:191]
buffer_load_dwordx4 a[68:71], v2, s[40:43], s33 offen offset:0 sc1
s_add_u32 s72, s75, 0x800000
v_mfma_f32_16x16x32_bf16 v[212:215], a[100:103], a[28:31], v[212:215]
ds_read_b128 a[136:139], v5 offset:0
v_fmac_f32 v160, v52, v84
v_mfma_f32_16x16x32_bf16 v[212:215], a[96:99], a[24:27], v[212:215]
v_fmac_f32 v133, v49, v82
s_add_u32 s63, s83, 0x280000
v_mfma_f32_16x16x32_bf16 v[216:219], a[104:107], a[24:27], v[216:219]
ds_read_b128 a[140:143], v5 offset:6144
v_fmac_f32 v136, v52, v82
v_mfma_f32_16x16x32_bf16 v[216:219], a[108:111], a[28:31], v[216:219]
buffer_load_dwordx4 a[72:75], v2, s[40:43], s35 offen offset:1024 sc1
s_sub_u32 s55, s63, 131072
v_mfma_f32_16x16x32_bf16 v[192:195], a[108:111], a[20:23], v[192:195]
ds_read_b128 a[144:147], v5 offset:1024
v_fmac_f32 v157, v49, v84
v_mfma_f32_16x16x32_bf16 v[192:195], a[104:107], a[16:19], v[192:195]
v_fmac_f32 v181, v49, v86
v_fmac_f32 v142, v58, v82
v_mfma_f32_16x16x32_bf16 v[168:171], a[104:107], a[8:11], v[168:171]
v_fmac_f32 v205, v49, v88
v_fmac_f32 v166, v58, v84
v_mfma_f32_16x16x32_bf16 v[168:171], a[108:111], a[12:15], v[168:171]
buffer_load_dwordx4 a[76:79], v2, s[40:43], s33 offen offset:1024 sc1
v_mfma_f32_16x16x32_bf16 v[144:147], a[108:111], a[4:7], v[144:147]
ds_read_b128 a[148:151], v5 offset:7168
v_fmac_f32 v209, v53, v88
v_mfma_f32_16x16x32_bf16 v[144:147], a[104:107], a[0:3], v[144:147]
v_fmac_f32 v190, v58, v86
v_add_u32 v233, s37, v1
v_mfma_f32_16x16x32_bf16 v[148:151], a[112:115], a[0:3], v[148:151]
v_fmac_f32 v185, v53, v86
v_fmac_f32 v214, v58, v88
v_mfma_f32_16x16x32_bf16 v[148:151], a[116:119], a[4:7], v[148:151]
buffer_load_dwordx4 a[80:83], v2, s[40:43], s35 offen offset:2048 sc1
v_mfma_f32_16x16x32_bf16 v[172:175], a[116:119], a[12:15], v[172:175]
v_fmac_f32 v161, v53, v84
v_fmac_f32 v218, v62, v88
v_mfma_f32_16x16x32_bf16 v[172:175], a[112:115], a[8:11], v[172:175]
v_add_u32 v232, s19, v7
v_add_u32 v248, s19, v8
v_mfma_f32_16x16x32_bf16 v[196:199], a[112:115], a[16:19], v[196:199]
v_fmac_f32 v137, v53, v82
v_fmac_f32 v194, v62, v86
v_mfma_f32_16x16x32_bf16 v[196:199], a[116:119], a[20:23], v[196:199]
buffer_load_dwordx4 a[84:87], v2, s[40:43], s33 offen offset:2048 sc1
v_mfma_f32_16x16x32_bf16 v[220:223], a[116:119], a[28:31], v[220:223]
v_fmac_f32 v170, v62, v84
v_fmac_f32 v143, v59, v82
v_mfma_f32_16x16x32_bf16 v[220:223], a[112:115], a[24:27], v[220:223]
s_waitcnt lgkmcnt(0)
v_mfma_f32_16x16x32_bf16 v[224:227], a[128:131], a[24:27], v[224:227]
ds_read_b128 a[96:99], v5 offset:14336
v_fmac_f32 v146, v62, v82
v_mfma_f32_16x16x32_bf16 v[224:227], a[132:135], a[28:31], v[224:227]
buffer_load_dwordx4 a[88:91], v2, s[40:43], s35 offen offset:3072 sc1
v_mfma_f32_16x16x32_bf16 v[200:203], a[132:135], a[20:23], v[200:203]
ds_read_b128 a[100:103], v5 offset:20480
v_fmac_f32 v150, v66, v82
v_mfma_f32_16x16x32_bf16 v[200:203], a[128:131], a[16:19], v[200:203]
v_fmac_f32 v167, v59, v84
v_fmac_f32 v191, v59, v86
v_mfma_f32_16x16x32_bf16 v[176:179], a[128:131], a[8:11], v[176:179]
v_fmac_f32 v174, v66, v84
v_fmac_f32 v215, v59, v88
v_mfma_f32_16x16x32_bf16 v[176:179], a[132:135], a[12:15], v[176:179]
ds_read_b128 a[104:107], v5 offset:15360
v_mfma_f32_16x16x32_bf16 v[152:155], a[132:135], a[4:7], v[152:155]
v_fmac_f32 v198, v66, v86
v_fmac_f32 v219, v63, v88
v_mfma_f32_16x16x32_bf16 v[152:155], a[128:131], a[0:3], v[152:155]
buffer_load_dwordx4 v1, s[4:7], s44 offen offset:0 sc1 lds
v_mfma_f32_16x16x32_bf16 v[132:135], a[136:139], a[0:3], v[132:135]
ds_read_b128 a[108:111], v5 offset:21504
v_fmac_f32 v222, v66, v88
v_mfma_f32_16x16x32_bf16 v[132:135], a[140:143], a[4:7], v[132:135]
v_fmac_f32 v195, v63, v86
v_mfma_f32_16x16x32_bf16 v[156:159], a[140:143], a[12:15], v[156:159]
ds_read_b128 a[112:115], v5 offset:16384
v_fmac_f32 v226, v70, v88
v_mfma_f32_16x16x32_bf16 v[156:159], a[136:139], a[8:11], v[156:159]
v_fmac_f32 v171, v63, v84
v_mfma_f32_16x16x32_bf16 v[180:183], a[136:139], a[16:19], v[180:183]
v_fmac_f32 v202, v70, v86
v_fmac_f32 v147, v63, v82
v_mfma_f32_16x16x32_bf16 v[180:183], a[140:143], a[20:23], v[180:183]
buffer_load_dwordx4 a[92:95], v2, s[40:43], s33 offen offset:3072 sc1
s_add_u32 s35, s35, 0x4000
v_mfma_f32_16x16x32_bf16 v[204:207], a[140:143], a[28:31], v[204:207]
s_add_u32 s33, s33, 0x4000
ds_read_b128 a[116:119], v5 offset:22528
v_mfma_f32_16x16x32_bf16 v[204:207], a[136:139], a[24:27], v[204:207]
v_fmac_f32 v178, v70, v84
v_fmac_f32 v151, v67, v82
v_mfma_f32_16x16x32_bf16 v[208:211], a[144:147], a[24:27], v[208:211]
v_fmac_f32 v154, v70, v82
v_fmac_f32 v175, v67, v84
v_mfma_f32_16x16x32_bf16 v[208:211], a[148:151], a[28:31], v[208:211]
v_mfma_f32_16x16x32_bf16 v[184:187], a[148:151], a[20:23], v[184:187]
v_fmac_f32 v134, v50, v82
v_fmac_f32 v199, v67, v86
v_mfma_f32_16x16x32_bf16 v[184:187], a[144:147], a[16:19], v[184:187]
buffer_load_dwordx4 v1, s[4:7], s44 offen offset:1024 sc1 lds
v_mfma_f32_16x16x32_bf16 v[160:163], a[144:147], a[8:11], v[160:163]
v_fmac_f32 v158, v50, v84
v_fmac_f32 v223, v67, v88
v_mfma_f32_16x16x32_bf16 v[160:163], a[148:151], a[12:15], v[160:163]
v_mfma_f32_16x16x32_bf16 v[136:139], a[148:151], a[4:7], v[136:139]
v_fmac_f32 v182, v50, v86
v_fmac_f32 v227, v71, v88
v_mfma_f32_16x16x32_bf16 v[136:139], a[144:147], a[0:3], v[136:139]
s_waitcnt vmcnt(10) lgkmcnt(0)
s_barrier
v_mfma_f32_16x16x32_bf16 v[140:143], a[96:99], a[32:35], v[140:143]
ds_read_b128 a[128:131], v5 offset:17408
v_fmac_f32 v206, v50, v88
v_mfma_f32_16x16x32_bf16 v[140:143], a[100:103], a[36:39], v[140:143]
buffer_load_dwordx4 a[0:3], v2, s[40:43], s35 offen offset:0 sc1
v_mfma_f32_16x16x32_bf16 v[164:167], a[100:103], a[44:47], v[164:167]
ds_read_b128 a[132:135], v5 offset:23552
v_fmac_f32 v210, v54, v88
v_mfma_f32_16x16x32_bf16 v[164:167], a[96:99], a[40:43], v[164:167]
v_fmac_f32 v203, v71, v86
v_fmac_f32 v179, v71, v84
v_mfma_f32_16x16x32_bf16 v[188:191], a[96:99], a[48:51], v[188:191]
buffer_load_dwordx4 a[4:7], v2, s[40:43], s33 offen offset:0 sc1
v_mfma_f32_16x16x32_bf16 v[188:191], a[100:103], a[52:55], v[188:191]
ds_read_b128 a[136:139], v5 offset:26624
v_fmac_f32 v186, v54, v86
v_mfma_f32_16x16x32_bf16 v[212:215], a[100:103], a[60:63], v[212:215]
v_fmac_f32 v162, v54, v84
v_fmac_f32 v155, v71, v82
v_mfma_f32_16x16x32_bf16 v[212:215], a[96:99], a[56:59], v[212:215]
buffer_load_dwordx4 a[8:11], v2, s[40:43], s35 offen offset:1024 sc1
v_mfma_f32_16x16x32_bf16 v[216:219], a[104:107], a[56:59], v[216:219]
ds_read_b128 a[140:143], v5 offset:32768
v_fmac_f32 v138, v54, v82
v_mfma_f32_16x16x32_bf16 v[216:219], a[108:111], a[60:63], v[216:219]
v_fmac_f32 v135, v51, v82
v_fmac_f32 v159, v51, v84
v_mfma_f32_16x16x32_bf16 v[192:195], a[108:111], a[52:55], v[192:195]
buffer_load_dwordx4 a[12:15], v2, s[40:43], s33 offen offset:1024 sc1
v_mfma_f32_16x16x32_bf16 v[192:195], a[104:107], a[48:51], v[192:195]
ds_read_b128 a[144:147], v5 offset:27648
v_fmac_f32 v183, v51, v86
v_mfma_f32_16x16x32_bf16 v[168:171], a[104:107], a[40:43], v[168:171]
v_fmac_f32 v207, v51, v88
v_mfma_f32_16x16x32_bf16 v[168:171], a[108:111], a[44:47], v[168:171]
buffer_load_dwordx4 a[16:19], v2, s[40:43], s35 offen offset:2048 sc1
v_mfma_f32_16x16x32_bf16 v[144:147], a[108:111], a[36:39], v[144:147]
ds_read_b128 a[148:151], v5 offset:33792
v_fmac_f32 v211, v55, v88
v_mfma_f32_16x16x32_bf16 v[144:147], a[104:107], a[32:35], v[144:147]
v_mul_f32 v88, 0x3e8293ee, v89
v_mfma_f32_16x16x32_bf16 v[148:151], a[112:115], a[32:35], v[148:151]
buffer_load_dwordx4 a[20:23], v2, s[40:43], s33 offen offset:2048 sc1
v_mfma_f32_16x16x32_bf16 v[148:151], a[116:119], a[36:39], v[148:151]
v_fmac_f32 v187, v55, v86
v_mfma_f32_16x16x32_bf16 v[172:175], a[116:119], a[44:47], v[172:175]
v_fmac_f32 v163, v55, v84
v_mul_f32 v86, 0x3e8293ee, v87
v_mfma_f32_16x16x32_bf16 v[172:175], a[112:115], a[40:43], v[172:175]
buffer_load_dwordx4 a[24:27], v2, s[40:43], s35 offen offset:3072 sc1
v_mfma_f32_16x16x32_bf16 v[196:199], a[112:115], a[48:51], v[196:199]
v_fmac_f32 v139, v55, v82
v_mul_f32 v84, 0x3e8293ee, v85
v_mfma_f32_16x16x32_bf16 v[196:199], a[116:119], a[52:55], v[196:199]
v_mul_f32 v82, 0x3e8293ee, v83
v_mfma_f32_16x16x32_bf16 v[220:223], a[116:119], a[60:63], v[220:223]
buffer_load_dwordx4 a[28:31], v2, s[40:43], s33 offen offset:3072 sc1
s_add_u32 s35, s35, 0x64000
v_mfma_f32_16x16x32_bf16 v[220:223], a[112:115], a[56:59], v[220:223]
s_add_u32 s33, s33, 0x64000
s_waitcnt lgkmcnt(0)
v_mfma_f32_16x16x32_bf16 v[224:227], a[128:131], a[56:59], v[224:227]
ds_read_b128 a[96:99], v5 offset:28672
v_mfma_f32_16x16x32_bf16 v[224:227], a[132:135], a[60:63], v[224:227]
buffer_load_dwordx4 v1, s[4:7], s44 offen offset:2048 sc1 lds
v_mfma_f32_16x16x32_bf16 v[200:203], a[132:135], a[52:55], v[200:203]
ds_read_b128 a[100:103], v5 offset:34816
v_mfma_f32_16x16x32_bf16 v[200:203], a[128:131], a[48:51], v[200:203]
v_mfma_f32_16x16x32_bf16 v[176:179], a[128:131], a[40:43], v[176:179]
v_mfma_f32_16x16x32_bf16 v[176:179], a[132:135], a[44:47], v[176:179]
ds_read_b128 a[104:107], v5 offset:29696
v_mfma_f32_16x16x32_bf16 v[152:155], a[132:135], a[36:39], v[152:155]
v_mfma_f32_16x16x32_bf16 v[152:155], a[128:131], a[32:35], v[152:155]
s_waitcnt vmcnt(18)
v_mfma_f32_16x16x32_bf16 v[140:143], a[136:139], a[64:67], v[140:143]
ds_read_b128 a[108:111], v5 offset:35840
s_waitcnt vmcnt(17)
v_mfma_f32_16x16x32_bf16 v[140:143], a[140:143], a[68:71], v[140:143]
s_waitcnt vmcnt(15)
v_mfma_f32_16x16x32_bf16 v[164:167], a[140:143], a[76:79], v[164:167]
ds_read_b128 a[112:115], v5 offset:38912
v_mfma_f32_16x16x32_bf16 v[164:167], a[136:139], a[72:75], v[164:167]
s_waitcnt vmcnt(14)
v_mfma_f32_16x16x32_bf16 v[188:191], a[136:139], a[80:83], v[188:191]
s_waitcnt vmcnt(13)
v_mfma_f32_16x16x32_bf16 v[188:191], a[140:143], a[84:87], v[188:191]
buffer_load_dwordx4 v1, s[4:7], s44 offen offset:3072 sc1 lds
s_add_u32 m0, s19, 65536
s_waitcnt vmcnt(11)
v_mfma_f32_16x16x32_bf16 v[212:215], a[140:143], a[92:95], v[212:215]
s_xor_b32 s44, s84, 32768
ds_read_b128 a[116:119], v5 offset:45056
v_mfma_f32_16x16x32_bf16 v[212:215], a[136:139], a[88:91], v[212:215]
v_mfma_f32_16x16x32_bf16 v[216:219], a[144:147], a[88:91], v[216:219]
v_mfma_f32_16x16x32_bf16 v[216:219], a[148:151], a[92:95], v[216:219]
v_mfma_f32_16x16x32_bf16 v[192:195], a[148:151], a[84:87], v[192:195]
v_mfma_f32_16x16x32_bf16 v[192:195], a[144:147], a[80:83], v[192:195]
v_mfma_f32_16x16x32_bf16 v[168:171], a[144:147], a[72:75], v[168:171]
v_mfma_f32_16x16x32_bf16 v[168:171], a[148:151], a[76:79], v[168:171]
v_mfma_f32_16x16x32_bf16 v[144:147], a[148:151], a[68:71], v[144:147]
v_mfma_f32_16x16x32_bf16 v[144:147], a[144:147], a[64:67], v[144:147]
s_waitcnt lgkmcnt(0)
v_mfma_f32_16x16x32_bf16 v[148:151], a[96:99], a[64:67], v[148:151]
ds_read_b128 a[128:131], v5 offset:39936
v_mfma_f32_16x16x32_bf16 v[148:151], a[100:103], a[68:71], v[148:151]
buffer_load_dwordx4 v1, s[4:7], s44 offen offset:0 sc1 lds
v_mfma_f32_16x16x32_bf16 v[172:175], a[100:103], a[76:79], v[172:175]
ds_read_b128 a[132:135], v5 offset:46080
v_mfma_f32_16x16x32_bf16 v[172:175], a[96:99], a[72:75], v[172:175]
v_mfma_f32_16x16x32_bf16 v[196:199], a[96:99], a[80:83], v[196:199]
v_mfma_f32_16x16x32_bf16 v[196:199], a[100:103], a[84:87], v[196:199]
buffer_load_dwordx4 v1, s[4:7], s44 offen offset:1024 sc1 lds
v_mfma_f32_16x16x32_bf16 v[220:223], a[100:103], a[92:95], v[220:223]
ds_read_b128 a[136:139], v5 offset:40960
v_mfma_f32_16x16x32_bf16 v[220:223], a[96:99], a[88:91], v[220:223]
v_mfma_f32_16x16x32_bf16 v[224:227], a[104:107], a[88:91], v[224:227]
ds_read_b128 a[140:143], v5 offset:47104
v_mfma_f32_16x16x32_bf16 v[224:227], a[108:111], a[92:95], v[224:227]
v_mfma_f32_16x16x32_bf16 v[200:203], a[108:111], a[84:87], v[200:203]
buffer_load_dwordx4 v1, s[4:7], s44 offen offset:2048 sc1 lds
v_mfma_f32_16x16x32_bf16 v[200:203], a[104:107], a[80:83], v[200:203]
ds_read_b128 a[144:147], v5 offset:41984
v_mfma_f32_16x16x32_bf16 v[176:179], a[104:107], a[72:75], v[176:179]
v_mfma_f32_16x16x32_bf16 v[176:179], a[108:111], a[76:79], v[176:179]
ds_read_b128 a[148:151], v5 offset:48128
v_mfma_f32_16x16x32_bf16 v[152:155], a[108:111], a[68:71], v[152:155]
v_mfma_f32_16x16x32_bf16 v[152:155], a[104:107], a[64:67], v[152:155]
buffer_load_dwordx4 v1, s[4:7], s44 offen offset:3072 sc1 lds
s_add_u32 m0, s19, 81920
s_waitcnt vmcnt(13)
v_mfma_f32_16x16x32_bf16 v[140:143], a[112:115], a[0:3], v[140:143]
s_xor_b32 s44, s84, 49152
s_waitcnt vmcnt(12)
v_mfma_f32_16x16x32_bf16 v[140:143], a[116:119], a[4:7], v[140:143]
s_waitcnt vmcnt(10)
v_mfma_f32_16x16x32_bf16 v[164:167], a[116:119], a[12:15], v[164:167]
v_mfma_f32_16x16x32_bf16 v[164:167], a[112:115], a[8:11], v[164:167]
s_waitcnt vmcnt(9)
v_mfma_f32_16x16x32_bf16 v[188:191], a[112:115], a[16:19], v[188:191]
buffer_load_dwordx4 v1, s[4:7], s44 offen offset:0 sc1 lds
s_waitcnt vmcnt(9)
v_mfma_f32_16x16x32_bf16 v[188:191], a[116:119], a[20:23], v[188:191]
s_waitcnt vmcnt(7)
v_mfma_f32_16x16x32_bf16 v[212:215], a[116:119], a[28:31], v[212:215]
v_mfma_f32_16x16x32_bf16 v[212:215], a[112:115], a[24:27], v[212:215]
s_waitcnt lgkmcnt(0)
v_mfma_f32_16x16x32_bf16 v[216:219], a[128:131], a[24:27], v[216:219]
ds_read_b128 a[96:99], v5 offset:12288
v_mul_f32 v140, v140, v83
v_mfma_f32_16x16x32_bf16 v[216:219], a[132:135], a[28:31], v[216:219]
buffer_load_dwordx4 v1, s[4:7], s44 offen offset:1024 sc1 lds
v_mfma_f32_16x16x32_bf16 v[192:195], a[132:135], a[20:23], v[192:195]
ds_read_b128 a[100:103], v5 offset:18432
v_mul_f32 v141, v141, v83
v_mfma_f32_16x16x32_bf16 v[192:195], a[128:131], a[16:19], v[192:195]
v_cvt_pk_bf16_f32 v140, v140, v141
v_mul_f32 v164, v164, v85
v_mfma_f32_16x16x32_bf16 v[168:171], a[128:131], a[8:11], v[168:171]
v_mul_f32 v165, v165, v85
v_cvt_pk_bf16_f32 v164, v164, v165
v_mfma_f32_16x16x32_bf16 v[168:171], a[132:135], a[12:15], v[168:171]
buffer_load_dwordx4 v1, s[4:7], s44 offen offset:2048 sc1 lds
v_mfma_f32_16x16x32_bf16 v[144:147], a[132:135], a[4:7], v[144:147]
ds_read_b128 a[104:107], v5 offset:24576
v_mul_f32 v212, v212, v89
v_mfma_f32_16x16x32_bf16 v[144:147], a[128:131], a[0:3], v[144:147]
v_mul_f32 v213, v213, v89
v_mul_f32 v214, v214, v89
v_mfma_f32_16x16x32_bf16 v[148:151], a[136:139], a[0:3], v[148:151]
ds_read_b128 a[108:111], v5 offset:30720
v_mul_f32 v215, v215, v89
v_mfma_f32_16x16x32_bf16 v[148:151], a[140:143], a[4:7], v[148:151]
v_cvt_pk_bf16_f32 v212, v212, v213
v_mul_f32 v216, v216, v89
v_mfma_f32_16x16x32_bf16 v[172:175], a[140:143], a[12:15], v[172:175]
buffer_load_dwordx4 v1, s[4:7], s44 offen offset:3072 sc1 lds
s_add_u32 m0, s19, 147456
v_mfma_f32_16x16x32_bf16 v[172:175], a[136:139], a[8:11], v[172:175]
s_xor_b32 s44, s84, 114688
ds_read_b128 a[112:115], v5 offset:36864
v_mfma_f32_16x16x32_bf16 v[196:199], a[136:139], a[16:19], v[196:199]
v_mul_f32 v217, v217, v89
v_mul_f32 v218, v218, v89
v_mfma_f32_16x16x32_bf16 v[196:199], a[140:143], a[20:23], v[196:199]
ds_read_b128 a[116:119], v5 offset:43008
v_mul_f32 v219, v219, v89
v_mfma_f32_16x16x32_bf16 v[220:223], a[140:143], a[28:31], v[220:223]
v_cvt_pk_bf16_f32 v213, v214, v215
v_cvt_pk_bf16_f32 v214, v216, v217
v_mfma_f32_16x16x32_bf16 v[220:223], a[136:139], a[24:27], v[220:223]
buffer_load_dwordx4 v1, s[4:7], s44 offen offset:0 sc1 lds
v_mfma_f32_16x16x32_bf16 v[224:227], a[144:147], a[24:27], v[224:227]
v_cvt_pk_bf16_f32 v215, v218, v219
v_min_u32 v212, -2, v212
v_mfma_f32_16x16x32_bf16 v[224:227], a[148:151], a[28:31], v[224:227]
v_min_u32 v213, -2, v213
v_min_u32 v214, -2, v214
v_mfma_f32_16x16x32_bf16 v[200:203], a[148:151], a[20:23], v[200:203]
v_min_u32 v215, -2, v215
v_mul_f32 v172, v172, v85
v_mfma_f32_16x16x32_bf16 v[200:203], a[144:147], a[16:19], v[200:203]
buffer_store_dwordx4 v[212:215], v3, s[4:7], s63 offen offset:0 sc1
v_mfma_f32_16x16x32_bf16 v[176:179], a[144:147], a[8:11], v[176:179]
buffer_load_dwordx4 v1, s[4:7], s44 offen offset:1024 sc1 lds
v_mfma_f32_16x16x32_bf16 v[176:179], a[148:151], a[12:15], v[176:179]
v_mul_f32 v173, v173, v85
v_cvt_pk_bf16_f32 v172, v172, v173
v_mfma_f32_16x16x32_bf16 v[152:155], a[148:151], a[4:7], v[152:155]
v_mul_f32 v220, v220, v89
v_mul_f32 v221, v221, v89
v_mfma_f32_16x16x32_bf16 v[152:155], a[144:147], a[0:3], v[152:155]
v_mul_f32 v222, v222, v89
s_waitcnt lgkmcnt(0)
v_mfma_f32_16x16x32_bf16 v[132:135], a[96:99], a[32:35], v[132:135]
ds_read_b128 a[128:131], v5 offset:13312
v_mul_f32 v223, v223, v89
v_mfma_f32_16x16x32_bf16 v[132:135], a[100:103], a[36:39], v[132:135]
buffer_load_dwordx4 v1, s[4:7], s44 offen offset:2048 sc1 lds
v_mfma_f32_16x16x32_bf16 v[156:159], a[100:103], a[44:47], v[156:159]
ds_read_b128 a[132:135], v5 offset:19456
v_cvt_pk_bf16_f32 v220, v220, v221
v_mfma_f32_16x16x32_bf16 v[156:159], a[96:99], a[40:43], v[156:159]
v_mul_f32 v224, v224, v89
v_mul_f32 v225, v225, v89
v_mfma_f32_16x16x32_bf16 v[180:183], a[96:99], a[48:51], v[180:183]
v_mul_f32 v226, v226, v89
v_mul_f32 v227, v227, v89
v_mfma_f32_16x16x32_bf16 v[180:183], a[100:103], a[52:55], v[180:183]
buffer_load_dwordx4 v1, s[4:7], s44 offen offset:3072 sc1 lds
s_add_u32 m0, s19, 98304
v_mfma_f32_16x16x32_bf16 v[204:207], a[100:103], a[60:63], v[204:207]
s_xor_b32 s44, s84, 65536
ds_read_b128 a[136:139], v5 offset:25600
v_mfma_f32_16x16x32_bf16 v[204:207], a[96:99], a[56:59], v[204:207]
v_cvt_pk_bf16_f32 v221, v222, v223
v_cvt_pk_bf16_f32 v222, v224, v225
v_mfma_f32_16x16x32_bf16 v[204:207], a[104:107], a[88:91], v[204:207]
ds_read_b128 a[140:143], v5 offset:31744
v_cvt_pk_bf16_f32 v223, v226, v227
v_mfma_f32_16x16x32_bf16 v[204:207], a[108:111], a[92:95], v[204:207]
v_min_u32 v220, -2, v220
v_min_u32 v221, -2, v221
v_mfma_f32_16x16x32_bf16 v[180:183], a[108:111], a[84:87], v[180:183]
buffer_load_dwordx4 v1, s[4:7], s44 offen offset:0 sc1 lds
v_mfma_f32_16x16x32_bf16 v[180:183], a[104:107], a[80:83], v[180:183]
ds_read_b128 a[144:147], v5 offset:37888
v_min_u32 v222, -2, v222
v_mfma_f32_16x16x32_bf16 v[156:159], a[104:107], a[72:75], v[156:159]
v_min_u32 v223, -2, v223
v_mul_f32 v196, v196, v87
v_mfma_f32_16x16x32_bf16 v[156:159], a[108:111], a[76:79], v[156:159]
ds_read_b128 a[148:151], v5 offset:44032
v_mul_f32 v197, v197, v87
v_mfma_f32_16x16x32_bf16 v[132:135], a[108:111], a[68:71], v[132:135]
buffer_store_dwordx4 v[220:223], v3, s[4:7], s63 offen offset:1024 sc1
v_mfma_f32_16x16x32_bf16 v[132:135], a[104:107], a[64:67], v[132:135]
buffer_load_dwordx4 v1, s[4:7], s44 offen offset:1024 sc1 lds
v_mfma_f32_16x16x32_bf16 v[132:135], a[112:115], a[0:3], v[132:135]
v_cvt_pk_bf16_f32 v196, v196, v197
v_mul_f32 v198, v198, v87
v_mfma_f32_16x16x32_bf16 v[132:135], a[116:119], a[4:7], v[132:135]
v_mul_f32 v199, v199, v87
v_cvt_pk_bf16_f32 v197, v198, v199
v_mfma_f32_16x16x32_bf16 v[156:159], a[116:119], a[12:15], v[156:159]
v_mul_f32 v200, v200, v87
v_mul_f32 v201, v201, v87
v_mfma_f32_16x16x32_bf16 v[156:159], a[112:115], a[8:11], v[156:159]
v_cvt_pk_bf16_f32 v198, v200, v201
v_mul_f32 v202, v202, v87
v_mfma_f32_16x16x32_bf16 v[180:183], a[112:115], a[16:19], v[180:183]
buffer_load_dwordx4 v1, s[4:7], s44 offen offset:2048 sc1 lds
v_mfma_f32_16x16x32_bf16 v[180:183], a[116:119], a[20:23], v[180:183]
v_mul_f32 v203, v203, v87
v_cvt_pk_bf16_f32 v199, v202, v203
v_mfma_f32_16x16x32_bf16 v[204:207], a[116:119], a[28:31], v[204:207]
v_mul_f32 v174, v174, v85
v_mul_f32 v175, v175, v85
v_mfma_f32_16x16x32_bf16 v[204:207], a[112:115], a[24:27], v[204:207]
s_waitcnt lgkmcnt(0)
s_barrier
v_mfma_f32_16x16x32_bf16 v[208:211], a[128:131], a[56:59], v[208:211]
ds_write_b128 v233, v[212:215] offset:21504
v_cvt_pk_bf16_f32 v173, v174, v175
v_mfma_f32_16x16x32_bf16 v[208:211], a[132:135], a[60:63], v[208:211]
buffer_load_dwordx4 v1, s[4:7], s44 offen offset:3072 sc1 lds
s_add_u32 m0, s19, 114688
v_mfma_f32_16x16x32_bf16 v[184:187], a[132:135], a[52:55], v[184:187]
s_xor_b32 s44, s84, 81920
ds_write_b64 v232, v[220:221] offset:4096
v_mfma_f32_16x16x32_bf16 v[184:187], a[128:131], a[48:51], v[184:187]
ds_write_b64 v232, v[222:223] offset:4608
v_cvt_pk_bf16_f32 v132, v132, v133
v_mfma_f32_16x16x32_bf16 v[160:163], a[128:131], a[40:43], v[160:163]
ds_write_b64 v232, v[196:197] offset:3072
v_cvt_pk_bf16_f32 v156, v156, v157
v_mfma_f32_16x16x32_bf16 v[160:163], a[132:135], a[44:47], v[160:163]
buffer_load_dwordx4 v1, s[4:7], s44 offen offset:0 sc1 lds
v_mfma_f32_16x16x32_bf16 v[136:139], a[132:135], a[36:39], v[136:139]
ds_write_b64 v232, v[198:199] offset:3584
v_cvt_pk_bf16_f32 v180, v180, v181
v_mfma_f32_16x16x32_bf16 v[136:139], a[128:131], a[32:35], v[136:139]
ds_write_b64 v232, v[172:173] offset:2048
v_cvt_pk_bf16_f32 v204, v204, v205
v_mfma_f32_16x16x32_bf16 v[136:139], a[136:139], a[64:67], v[136:139]
v_cvt_pk_bf16_f32 v133, v134, v135
v_cvt_pk_bf16_f32 v157, v158, v159
v_mfma_f32_16x16x32_bf16 v[136:139], a[140:143], a[68:71], v[136:139]
v_cvt_pk_bf16_f32 v181, v182, v183
v_cvt_pk_bf16_f32 v205, v206, v207
v_mfma_f32_16x16x32_bf16 v[160:163], a[140:143], a[76:79], v[160:163]
buffer_load_dwordx4 v1, s[4:7], s44 offen offset:1024 sc1 lds
v_mfma_f32_16x16x32_bf16 v[160:163], a[136:139], a[72:75], v[160:163]
v_mul_f32 v176, v176, v85
v_mul_f32 v177, v177, v85
v_mfma_f32_16x16x32_bf16 v[184:187], a[136:139], a[80:83], v[184:187]
v_cvt_pk_bf16_f32 v174, v176, v177
v_mul_f32 v178, v178, v85
v_mfma_f32_16x16x32_bf16 v[184:187], a[140:143], a[84:87], v[184:187]
v_mul_f32 v179, v179, v85
v_cvt_pk_bf16_f32 v175, v178, v179
v_mfma_f32_16x16x32_bf16 v[208:211], a[140:143], a[92:95], v[208:211]
ds_write_b64 v232, v[174:175] offset:2560
v_mul_f32 v148, v148, v83
v_mfma_f32_16x16x32_bf16 v[208:211], a[136:139], a[88:91], v[208:211]
buffer_load_dwordx4 v1, s[4:7], s44 offen offset:2048 sc1 lds
v_mfma_f32_16x16x32_bf16 v[208:211], a[144:147], a[24:27], v[208:211]
v_mul_f32 v149, v149, v83
v_cvt_pk_bf16_f32 v148, v148, v149
v_mfma_f32_16x16x32_bf16 v[208:211], a[148:151], a[28:31], v[208:211]
v_mul_f32 v150, v150, v83
v_mul_f32 v151, v151, v83
v_mfma_f32_16x16x32_bf16 v[184:187], a[148:151], a[20:23], v[184:187]
v_cvt_pk_bf16_f32 v149, v150, v151
v_mul_f32 v152, v152, v83
v_mfma_f32_16x16x32_bf16 v[184:187], a[144:147], a[16:19], v[184:187]
ds_write_b64 v232, v[148:149] offset:1024
v_mul_f32 v153, v153, v83
v_mfma_f32_16x16x32_bf16 v[160:163], a[144:147], a[8:11], v[160:163]
buffer_load_dwordx4 v1, s[4:7], s44 offen offset:3072 sc1 lds
v_mfma_f32_16x16x32_bf16 v[160:163], a[148:151], a[12:15], v[160:163]
v_cvt_pk_bf16_f32 v150, v152, v153
v_mul_f32 v154, v154, v83
v_mfma_f32_16x16x32_bf16 v[136:139], a[148:151], a[4:7], v[136:139]
v_mul_f32 v155, v155, v83
v_cvt_pk_bf16_f32 v151, v154, v155
v_mfma_f32_16x16x32_bf16 v[136:139], a[144:147], a[0:3], v[136:139]
ds_write_b64 v232, v[150:151] offset:1536
v_mul_f32 v188, v188, v87
s_add_u32 m0, s19, 32768
buffer_load_dwordx4 v[228:231], v9, s[4:7], s55 offen sc1
buffer_load_dwordx4 v[72:75], v9, s[4:7], s55 offen offset:1024 sc1
s_xor_b32 s44, s84, 0
buffer_load_dwordx4 v1, s[4:7], s44 offen offset:0 sc1 lds
v_mul_f32 v189, v189, v87
v_pk_mul_f32 v[190:191], v[190:191], v[86:87] op_sel:[0,1] op_sel_hi:[1,1]
v_pk_mul_f32 v[166:167], v[166:167], v[84:85] op_sel:[0,1] op_sel_hi:[1,1]
v_pk_mul_f32 v[142:143], v[142:143], v[82:83] op_sel:[0,1] op_sel_hi:[1,1]
v_cvt_pk_bf16_f32 v188, v188, v189
v_pk_mul_f32 v[192:193], v[192:193], v[86:87] op_sel:[0,1] op_sel_hi:[1,1]
v_pk_mul_f32 v[194:195], v[194:195], v[86:87] op_sel:[0,1] op_sel_hi:[1,1]
v_pk_mul_f32 v[168:169], v[168:169], v[84:85] op_sel:[0,1] op_sel_hi:[1,1]
v_pk_mul_f32 v[170:171], v[170:171], v[84:85] op_sel:[0,1] op_sel_hi:[1,1]
v_pk_mul_f32 v[144:145], v[144:145], v[82:83] op_sel:[0,1] op_sel_hi:[1,1]
v_pk_mul_f32 v[146:147], v[146:147], v[82:83] op_sel:[0,1] op_sel_hi:[1,1]
v_cvt_pk_bf16_f32 v189, v190, v191
v_cvt_pk_bf16_f32 v165, v166, v167
v_cvt_pk_bf16_f32 v141, v142, v143
v_cvt_pk_bf16_f32 v190, v192, v193
v_cvt_pk_bf16_f32 v191, v194, v195
v_cvt_pk_bf16_f32 v166, v168, v169
v_cvt_pk_bf16_f32 v167, v170, v171
v_cvt_pk_bf16_f32 v142, v144, v145
v_cvt_pk_bf16_f32 v143, v146, v147
v_cvt_pk_bf16_f32 v134, v136, v137
v_cvt_pk_bf16_f32 v135, v138, v139
v_cvt_pk_bf16_f32 v158, v160, v161
v_cvt_pk_bf16_f32 v159, v162, v163
v_cvt_pk_bf16_f32 v182, v184, v185
v_cvt_pk_bf16_f32 v183, v186, v187
v_cvt_pk_bf16_f32 v206, v208, v209
buffer_load_dwordx4 v1, s[4:7], s44 offen offset:1024 sc1 lds
v_cvt_pk_bf16_f32 v207, v210, v211
buffer_load_dwordx4 v1, s[4:7], s44 offen offset:2048 sc1 lds
buffer_load_dwordx4 v1, s[4:7], s44 offen offset:3072 sc1 lds
s_waitcnt lgkmcnt(0)
s_barrier
s_add_u32 m0, s19, 131072
s_xor_b32 s44, s84, 98304
buffer_load_dwordx4 v1, s[4:7], s44 offen offset:0 sc1 lds
v_mfma_f32_16x16x32_bf16 v[208:211], v[188:191], v[204:207], v[20:23]
ds_read_b64_tr_b16 a[10:11], v248 offset:3072
v_mfma_f32_16x16x32_bf16 v[224:227], v[212:215], v[204:207], v[24:27]
ds_read_b64_tr_b16 a[12:13], v248 offset:4096
v_mfma_f32_16x16x32_bf16 v[160:163], v[140:143], v[156:159], v[20:23]
ds_read_b64_tr_b16 a[22:23], v248 offset:3584
v_mfma_f32_16x16x32_bf16 v[176:179], v[164:167], v[156:159], v[24:27]
s_nop 3
v_max_f32 v224, v224, v208
v_max_f32 v225, v225, v209
v_max_f32 v226, v226, v210
v_max_f32 v227, v227, v211
v_max3_f32 v239, v224, v225, v226
v_max_f32 v239, v239, v227
ds_read_b64_tr_b16 a[24:25], v248 offset:4608
v_max_f32 v176, v176, v160
v_max_f32 v177, v177, v161
v_max_f32 v178, v178, v162
v_max_f32 v179, v179, v163
v_max3_f32 v237, v176, v177, v178
buffer_load_dwordx4 v1, s[4:7], s44 offen offset:1024 sc1 lds
v_max_f32 v237, v237, v179
v_mfma_f32_16x16x32_bf16 v[184:187], v[164:167], v[180:183], v[20:23]
s_nop 0
v_permlane32_swap_b32 v239, v237
v_max_f32 v239, v239, v237
v_mov_b32 v242, v239
v_mfma_f32_16x16x32_bf16 v[200:203], v[188:191], v[180:183], v[24:27]
s_nop 0
v_permlane16_swap_b32 v239, v242
v_max_f32 v239, v239, v242
v_mov_b32 v242, v239
ds_read_b64_tr_b16 a[6:7], v248 offset:1024
s_nop 0
v_permlane32_swap_b32 v239, v242
v_mul_f32_e64 v89, -v239, v88
v_fma_f32 v224, v224, v88, v89
v_fma_f32 v225, v225, v88, v89
v_fma_f32 v226, v226, v88, v89
v_fma_f32 v227, v227, v88, v89
v_exp_f32 v224, v224
v_exp_f32 v225, v225
v_exp_f32 v226, v226
buffer_load_dwordx4 v1, s[4:7], s44 offen offset:2048 sc1 lds
v_exp_f32 v227, v227
v_cvt_pk_bf16_f32 v224, v224, v225
v_cvt_pk_bf16_f32 v225, v226, v227
v_and_b32 v208, v224, v28
v_and_b32 v209, v225, v29
v_and_b32 v210, v224, v30
v_and_b32 v211, v225, v31
v_max_f32 v200, v200, v184
v_max_f32 v201, v201, v185
v_mfma_f32_16x16x32_bf16 v[216:219], v[16:19], v[208:211], 0
v_max_f32 v202, v202, v186
v_max_f32 v203, v203, v187
s_waitcnt lgkmcnt(3)
v_mfma_f32_16x16x32_bf16 v[116:119], a[10:13], v[208:211], 0
v_max3_f32 v238, v200, v201, v202
ds_read_b64_tr_b16 a[18:19], v248 offset:1536
s_waitcnt lgkmcnt(2)
v_mfma_f32_16x16x32_bf16 v[120:123], a[22:25], v[208:211], 0
v_rcp_f32 v216, v216
ds_read_b64_tr_b16 a[8:9], v248 offset:2048
ds_read_b64_tr_b16 a[20:21], v248 offset:2560
buffer_load_dwordx4 v1, s[4:7], s44 offen offset:3072 sc1 lds
v_pk_mul_f32 v[116:117], v[116:117], v[216:217] op_sel:[0,0] op_sel_hi:[1,0]
v_pk_mul_f32 v[118:119], v[118:119], v[216:217] op_sel:[0,0] op_sel_hi:[1,0]
v_cvt_pk_bf16_f32 v116, v116, v117
s_nop 0
v_pk_mul_f32 v[120:121], v[120:121], v[216:217] op_sel:[0,0] op_sel_hi:[1,0]
v_pk_mul_f32 v[122:123], v[122:123], v[216:217] op_sel:[0,0] op_sel_hi:[1,0]
v_cvt_pk_bf16_f32 v117, v118, v119
v_cvt_pk_bf16_f32 v118, v120, v121
v_cvt_pk_bf16_f32 v119, v122, v123
v_max_f32 v238, v238, v203
buffer_store_dwordx4 v[116:119], v2, s[4:7], s72 offen offset:3072 sc1
s_waitcnt lgkmcnt(0)
s_cmp_lg_u32 s28, 0
s_cbranch_scc1 Lhx_36
s_waitcnt vmcnt(10)
v_max3_u32 v244, v228, v229, v230
s_waitcnt vmcnt(9)
v_max3_u32 v244, v244, v231, v72
v_max3_u32 v244, v244, v73, v74
v_max_u32 v244, v244, v75
v_cmp_eq_u32 vcc, -1, v244
s_cbranch_vccnz L_hxredo2
L_hxback2:
ds_write_b128 v233, v[228:231] offset:20480
ds_write_b64 v232, v[72:73] offset:0
ds_write_b64 v232, v[74:75] offset:512
Lhx_36:
ds_read_b128 a[0:3], v233 offset:20480
v_mfma_f32_16x16x32_bf16 v[152:155], v[140:143], v[132:135], v[24:27]
v_mul_f32_e64 v85, -v242, v84
v_fma_f32 v176, v176, v84, v85
v_fma_f32 v177, v177, v84, v85
v_fma_f32 v178, v178, v84, v85
v_fma_f32 v179, v179, v84, v85
L_stub13:
s_cbranch_execz L_wret3
v_exp_f32 v176, v176
v_exp_f32 v177, v177
v_exp_f32 v178, v178
v_exp_f32 v179, v179
v_cvt_pk_bf16_f32 v176, v176, v177
v_cvt_pk_bf16_f32 v177, v178, v179
v_and_b32 v160, v176, v28
v_and_b32 v161, v177, v29
v_and_b32 v162, v176, v30
v_and_b32 v163, v177, v31
ds_read_b64_tr_b16 a[4:5], v248 offset:0
s_nop 0
v_mfma_f32_16x16x32_bf16 v[168:171], v[16:19], v[160:163], 0
ds_read_b64_tr_b16 a[16:17], v248 offset:512
v_mfma_f32_16x16x32_bf16 v[100:103], a[6:9], v[160:163], 0
buffer_atomic_add v12, v10, s[4:7], s94 offen sc1
s_waitcnt lgkmcnt(2)
v_mfma_f32_16x16x32_bf16 v[136:139], a[0:3], v[132:135], v[76:79]
s_nop 2
v_rcp_f32 v168, v168
v_mfma_f32_16x16x32_bf16 v[104:107], a[18:21], v[160:163], 0
s_nop 2
v_max_f32 v152, v152, v136
v_max_f32 v153, v153, v137
v_max_f32 v154, v154, v138
v_max_f32 v155, v155, v139
v_max3_f32 v236, v152, v153, v154
v_max_f32 v236, v236, v155
v_pk_mul_f32 v[100:101], v[100:101], v[168:169] op_sel:[0,0] op_sel_hi:[1,0]
v_pk_mul_f32 v[102:103], v[102:103], v[168:169] op_sel:[0,0] op_sel_hi:[1,0]
v_permlane32_swap_b32 v238, v236
v_max_f32 v238, v238, v236
v_mov_b32 v243, v238
v_cvt_pk_bf16_f32 v100, v100, v101
v_pk_mul_f32 v[104:105], v[104:105], v[168:169] op_sel:[0,0] op_sel_hi:[1,0]
v_permlane16_swap_b32 v238, v243
v_max_f32 v238, v238, v243
v_mov_b32 v243, v238
v_pk_mul_f32 v[106:107], v[106:107], v[168:169] op_sel:[0,0] op_sel_hi:[1,0]
v_cvt_pk_bf16_f32 v101, v102, v103
v_permlane32_swap_b32 v238, v243
v_mul_f32_e64 v87, -v238, v86
v_fma_f32 v200, v200, v86, v87
v_fma_f32 v201, v201, v86, v87
v_fma_f32 v202, v202, v86, v87
v_fma_f32 v203, v203, v86, v87
v_exp_f32 v200, v200
v_exp_f32 v201, v201
v_exp_f32 v202, v202
v_exp_f32 v203, v203
v_cvt_pk_bf16_f32 v200, v200, v201
v_cvt_pk_bf16_f32 v201, v202, v203
v_and_b32 v184, v200, v28
v_and_b32 v185, v201, v29
v_and_b32 v186, v200, v30
v_and_b32 v187, v201, v31
v_cvt_pk_bf16_f32 v102, v104, v105
v_cvt_pk_bf16_f32 v103, v106, v107
v_mfma_f32_16x16x32_bf16 v[192:195], v[16:19], v[184:187], 0
buffer_store_dwordx4 v[100:103], v2, s[4:7], s72 offen offset:1024 sc1
v_mul_f32_e64 v83, -v243, v82
v_mfma_f32_16x16x32_bf16 v[108:111], a[8:11], v[184:187], 0
v_fma_f32 v152, v152, v82, v83
v_fma_f32 v153, v153, v82, v83
v_fma_f32 v154, v154, v82, v83
v_fma_f32 v155, v155, v82, v83
v_mfma_f32_16x16x32_bf16 v[112:115], a[20:23], v[184:187], 0
v_exp_f32 v152, v152
v_exp_f32 v153, v153
v_exp_f32 v154, v154
v_exp_f32 v155, v155
v_rcp_f32 v192, v192
v_cvt_pk_bf16_f32 v152, v152, v153
v_cvt_pk_bf16_f32 v153, v154, v155
v_and_b32 v136, v152, v80
v_and_b32 v137, v153, v81
v_and_b32 v138, v152, v30
v_and_b32 v139, v153, v31
v_pk_mul_f32 v[108:109], v[108:109], v[192:193] op_sel:[0,0] op_sel_hi:[1,0]
v_pk_mul_f32 v[110:111], v[110:111], v[192:193] op_sel:[0,0] op_sel_hi:[1,0]
v_cvt_pk_bf16_f32 v108, v108, v109
v_pk_mul_f32 v[112:113], v[112:113], v[192:193] op_sel:[0,0] op_sel_hi:[1,0]
v_cvt_pk_bf16_f32 v109, v110, v111
v_pk_mul_f32 v[114:115], v[114:115], v[192:193] op_sel:[0,0] op_sel_hi:[1,0]
v_cvt_pk_bf16_f32 v110, v112, v113
v_mfma_f32_16x16x32_bf16 v[144:147], v[16:19], v[136:139], 0
v_cvt_pk_bf16_f32 v111, v114, v115
buffer_store_dwordx4 v[108:111], v2, s[4:7], s72 offen offset:2048 sc1
s_waitcnt lgkmcnt(1)
v_mfma_f32_16x16x32_bf16 v[92:95], a[4:7], v[136:139], 0
s_nop 3
v_rcp_f32 v144, v144
s_waitcnt lgkmcnt(0)
v_mfma_f32_16x16x32_bf16 v[96:99], a[16:19], v[136:139], 0
s_nop 0
v_pk_mul_f32 v[92:93], v[92:93], v[144:145] op_sel:[0,0] op_sel_hi:[1,0]
v_pk_mul_f32 v[94:95], v[94:95], v[144:145] op_sel:[0,0] op_sel_hi:[1,0]
v_cvt_pk_bf16_f32 v92, v92, v93
v_cvt_pk_bf16_f32 v93, v94, v95
s_nop 2
v_pk_mul_f32 v[96:97], v[96:97], v[144:145] op_sel:[0,0] op_sel_hi:[1,0]
v_pk_mul_f32 v[98:99], v[98:99], v[144:145] op_sel:[0,0] op_sel_hi:[1,0]
v_cvt_pk_bf16_f32 v94, v96, v97
v_cvt_pk_bf16_f32 v95, v98, v99
buffer_store_dwordx4 v[92:95], v2, s[4:7], s72 offen offset:0 sc1
s_add_u32 s92, s71, 0x20000
s_add_u32 s40, s4, 0x800000
s_addc_u32 s41, s5, 0
v_add_u32 v5, 32768, v1
v_add_u32 v6, 98304, v1
s_mov_b32 s35, s77
v_lshlrev_b32 v132, 16, v32
v_and_b32 v133, 0xffff0000, v32
v_lshlrev_b32 v134, 16, v33
v_and_b32 v135, 0xffff0000, v33
v_lshlrev_b32 v136, 16, v34
v_and_b32 v137, 0xffff0000, v34
v_lshlrev_b32 v138, 16, v35
v_and_b32 v139, 0xffff0000, v35
v_lshlrev_b32 v140, 16, v36
v_and_b32 v141, 0xffff0000, v36
v_lshlrev_b32 v142, 16, v37
v_and_b32 v143, 0xffff0000, v37
v_lshlrev_b32 v144, 16, v38
v_and_b32 v145, 0xffff0000, v38
v_lshlrev_b32 v146, 16, v39
v_and_b32 v147, 0xffff0000, v39
v_lshlrev_b32 v148, 16, v40
v_and_b32 v149, 0xffff0000, v40
v_lshlrev_b32 v150, 16, v41
v_and_b32 v151, 0xffff0000, v41
v_lshlrev_b32 v152, 16, v42
v_and_b32 v153, 0xffff0000, v42
v_lshlrev_b32 v154, 16, v43
v_and_b32 v155, 0xffff0000, v43
v_lshlrev_b32 v156, 16, v44
v_and_b32 v157, 0xffff0000, v44
v_lshlrev_b32 v158, 16, v45
v_and_b32 v159, 0xffff0000, v45
v_lshlrev_b32 v160, 16, v46
v_and_b32 v161, 0xffff0000, v46
v_lshlrev_b32 v162, 16, v47
v_and_b32 v163, 0xffff0000, v47
s_mov_b32 s95, -1
s_mov_b64 exec, 0
s_cmp_eq_u32 s28, 3
s_cbranch_scc1 L_stub14
s_cmp_eq_u32 s28, 2
s_cbranch_scc1 L_stub17
s_cmp_eq_u32 s28, 0
s_cbranch_scc1 L_stub18
L_wret5:
s_mov_b64 exec, -1
s_cmp_lg_u32 s28, 1
s_cbranch_scc1 Lpo_39
s_add_u32 s36, s11, 0x20080
s_mov_b32 s37, 0
v_mov_b32 v11, 0
buffer_atomic_add v11, v251, s[4:7], s36 offen sc0 sc1
s_sleep 4
Lpoll_37:
v_mov_b32 v234, 0
buffer_atomic_add v234, v251, s[4:7], s36 offen sc0 sc1
s_waitcnt vmcnt(1)
v_readfirstlane_b32 s38, v11
s_nop 0
s_cmp_ge_u32 s38, 32
s_cbranch_scc1 Lpe_38
v_mov_b32 v11, 0
buffer_atomic_add v11, v251, s[4:7], s36 offen sc0 sc1
s_waitcnt vmcnt(1)
v_readfirstlane_b32 s38, v234
s_nop 0
s_cmp_ge_u32 s38, 32
s_cbranch_scc1 Lpe_38
s_add_u32 s37, s37, 1
s_cmp_lt_u32 s37, 0x80000
s_cbranch_scc1 Lpoll_37
s_waitcnt vmcnt(0)
Lpo_39:
s_waitcnt vmcnt(0)
Lpe_38:
s_barrier
L_k2go2:
buffer_load_dwordx4 a[0:3], v4, s[40:43], s35 offen offset:0 sc1
buffer_load_dwordx4 a[4:7], v4, s[40:43], s35 offen offset:1024 sc1
s_xor_b32 s35, s77, 4096
buffer_load_dwordx4 a[8:11], v4, s[40:43], s35 offen offset:0 sc1
buffer_load_dwordx4 a[12:15], v4, s[40:43], s35 offen offset:1024 sc1
s_xor_b32 s35, s77, 16384
buffer_load_dwordx4 a[16:19], v4, s[40:43], s35 offen offset:0 sc1
buffer_load_dwordx4 a[20:23], v4, s[40:43], s35 offen offset:1024 sc1
s_xor_b32 s35, s77, 20480
buffer_load_dwordx4 a[24:27], v4, s[40:43], s35 offen offset:0 sc1
buffer_load_dwordx4 a[28:31], v4, s[40:43], s35 offen offset:1024 sc1
s_xor_b32 s35, s77, 32768
buffer_load_dwordx4 a[32:35], v4, s[40:43], s35 offen offset:0 sc1
buffer_load_dwordx4 a[36:39], v4, s[40:43], s35 offen offset:1024 sc1
s_xor_b32 s35, s77, 36864
buffer_load_dwordx4 a[40:43], v4, s[40:43], s35 offen offset:0 sc1
buffer_load_dwordx4 a[44:47], v4, s[40:43], s35 offen offset:1024 sc1
s_xor_b32 s35, s77, 49152
ds_read_b128 a[96:99], v5 offset:0
ds_read_b128 a[100:103], v5 offset:1024
ds_read_b128 a[104:107], v5 offset:2048
ds_read_b128 a[108:111], v5 offset:3072
ds_read_b128 a[112:115], v5 offset:4096
ds_read_b128 a[116:119], v5 offset:5120
ds_read_b128 a[120:123], v5 offset:6144
ds_read_b128 a[124:127], v5 offset:7168
s_waitcnt vmcnt(10) lgkmcnt(4)
v_mfma_f32_16x16x32_bf16 v[132:135], a[96:99], a[0:3], v[132:135]
ds_read_b128 a[128:131], v5 offset:8192
v_mfma_f32_16x16x32_bf16 v[148:151], a[96:99], a[4:7], v[148:151]
ds_read_b128 a[132:135], v5 offset:9216
v_mfma_f32_16x16x32_bf16 v[152:155], a[100:103], a[4:7], v[152:155]
buffer_load_dwordx4 a[48:51], v4, s[40:43], s35 offen offset:0 sc1
v_mfma_f32_16x16x32_bf16 v[136:139], a[100:103], a[0:3], v[136:139]
ds_read_b128 a[136:139], v5 offset:10240
v_mfma_f32_16x16x32_bf16 v[140:143], a[104:107], a[0:3], v[140:143]
ds_read_b128 a[140:143], v5 offset:11264
v_mfma_f32_16x16x32_bf16 v[156:159], a[104:107], a[4:7], v[156:159]
v_mfma_f32_16x16x32_bf16 v[160:163], a[108:111], a[4:7], v[160:163]
buffer_load_dwordx4 a[52:55], v4, s[40:43], s35 offen offset:1024 sc1
s_xor_b32 s35, s77, 53248
v_mfma_f32_16x16x32_bf16 v[144:147], a[108:111], a[0:3], v[144:147]
s_waitcnt vmcnt(10) lgkmcnt(4)
v_mfma_f32_16x16x32_bf16 v[132:135], a[112:115], a[8:11], v[132:135]
ds_read_b128 a[96:99], v5 offset:12288
v_mfma_f32_16x16x32_bf16 v[148:151], a[112:115], a[12:15], v[148:151]
ds_read_b128 a[100:103], v5 offset:13312
v_mfma_f32_16x16x32_bf16 v[152:155], a[116:119], a[12:15], v[152:155]
buffer_load_dwordx4 a[0:3], v4, s[40:43], s35 offen offset:0 sc1
v_mfma_f32_16x16x32_bf16 v[136:139], a[116:119], a[8:11], v[136:139]
ds_read_b128 a[104:107], v5 offset:14336
v_mfma_f32_16x16x32_bf16 v[140:143], a[120:123], a[8:11], v[140:143]
ds_read_b128 a[108:111], v5 offset:15360
v_mfma_f32_16x16x32_bf16 v[156:159], a[120:123], a[12:15], v[156:159]
v_mfma_f32_16x16x32_bf16 v[160:163], a[124:127], a[12:15], v[160:163]
buffer_load_dwordx4 a[4:7], v4, s[40:43], s35 offen offset:1024 sc1
s_xor_b32 s35, s77, 65536
v_mfma_f32_16x16x32_bf16 v[144:147], a[124:127], a[8:11], v[144:147]
s_waitcnt vmcnt(10) lgkmcnt(4)
v_mfma_f32_16x16x32_bf16 v[132:135], a[128:131], a[16:19], v[132:135]
ds_read_b128 a[112:115], v5 offset:16384
v_mfma_f32_16x16x32_bf16 v[148:151], a[128:131], a[20:23], v[148:151]
ds_read_b128 a[116:119], v5 offset:17408
v_mfma_f32_16x16x32_bf16 v[152:155], a[132:135], a[20:23], v[152:155]
buffer_load_dwordx4 a[8:11], v4, s[40:43], s35 offen offset:0 sc1
v_mfma_f32_16x16x32_bf16 v[136:139], a[132:135], a[16:19], v[136:139]
ds_read_b128 a[120:123], v5 offset:18432
v_mfma_f32_16x16x32_bf16 v[140:143], a[136:139], a[16:19], v[140:143]
ds_read_b128 a[124:127], v5 offset:19456
v_mfma_f32_16x16x32_bf16 v[156:159], a[136:139], a[20:23], v[156:159]
v_mfma_f32_16x16x32_bf16 v[160:163], a[140:143], a[20:23], v[160:163]
buffer_load_dwordx4 a[12:15], v4, s[40:43], s35 offen offset:1024 sc1
s_xor_b32 s35, s77, 69632
v_mfma_f32_16x16x32_bf16 v[144:147], a[140:143], a[16:19], v[144:147]
s_waitcnt vmcnt(10) lgkmcnt(4)
v_mfma_f32_16x16x32_bf16 v[132:135], a[96:99], a[24:27], v[132:135]
ds_read_b128 a[128:131], v5 offset:20480
v_mfma_f32_16x16x32_bf16 v[148:151], a[96:99], a[28:31], v[148:151]
ds_read_b128 a[132:135], v5 offset:21504
v_mfma_f32_16x16x32_bf16 v[152:155], a[100:103], a[28:31], v[152:155]
buffer_load_dwordx4 a[16:19], v4, s[40:43], s35 offen offset:0 sc1
v_mfma_f32_16x16x32_bf16 v[136:139], a[100:103], a[24:27], v[136:139]
ds_read_b128 a[136:139], v5 offset:22528
v_mfma_f32_16x16x32_bf16 v[140:143], a[104:107], a[24:27], v[140:143]
ds_read_b128 a[140:143], v5 offset:23552
v_mfma_f32_16x16x32_bf16 v[156:159], a[104:107], a[28:31], v[156:159]
v_mfma_f32_16x16x32_bf16 v[160:163], a[108:111], a[28:31], v[160:163]
buffer_load_dwordx4 a[20:23], v4, s[40:43], s35 offen offset:1024 sc1
s_xor_b32 s35, s77, 81920
v_mfma_f32_16x16x32_bf16 v[144:147], a[108:111], a[24:27], v[144:147]
s_waitcnt vmcnt(10) lgkmcnt(4)
v_mfma_f32_16x16x32_bf16 v[132:135], a[112:115], a[32:35], v[132:135]
ds_read_b128 a[96:99], v5 offset:24576
v_mfma_f32_16x16x32_bf16 v[148:151], a[112:115], a[36:39], v[148:151]
ds_read_b128 a[100:103], v5 offset:25600
v_mfma_f32_16x16x32_bf16 v[152:155], a[116:119], a[36:39], v[152:155]
buffer_load_dwordx4 a[24:27], v4, s[40:43], s35 offen offset:0 sc1
v_mfma_f32_16x16x32_bf16 v[136:139], a[116:119], a[32:35], v[136:139]
ds_read_b128 a[104:107], v5 offset:26624
v_mfma_f32_16x16x32_bf16 v[140:143], a[120:123], a[32:35], v[140:143]
ds_read_b128 a[108:111], v5 offset:27648
v_mfma_f32_16x16x32_bf16 v[156:159], a[120:123], a[36:39], v[156:159]
v_mfma_f32_16x16x32_bf16 v[160:163], a[124:127], a[36:39], v[160:163]
buffer_load_dwordx4 a[28:31], v4, s[40:43], s35 offen offset:1024 sc1
s_xor_b32 s35, s77, 86016
v_mfma_f32_16x16x32_bf16 v[144:147], a[124:127], a[32:35], v[144:147]
s_waitcnt vmcnt(10) lgkmcnt(4)
v_mfma_f32_16x16x32_bf16 v[132:135], a[128:131], a[40:43], v[132:135]
ds_read_b128 a[112:115], v5 offset:28672
v_mfma_f32_16x16x32_bf16 v[148:151], a[128:131], a[44:47], v[148:151]
ds_read_b128 a[116:119], v5 offset:29696
v_mfma_f32_16x16x32_bf16 v[152:155], a[132:135], a[44:47], v[152:155]
buffer_load_dwordx4 a[32:35], v4, s[40:43], s35 offen offset:0 sc1
v_mfma_f32_16x16x32_bf16 v[136:139], a[132:135], a[40:43], v[136:139]
ds_read_b128 a[120:123], v5 offset:30720
v_mfma_f32_16x16x32_bf16 v[140:143], a[136:139], a[40:43], v[140:143]
ds_read_b128 a[124:127], v5 offset:31744
v_mfma_f32_16x16x32_bf16 v[156:159], a[136:139], a[44:47], v[156:159]
v_mfma_f32_16x16x32_bf16 v[160:163], a[140:143], a[44:47], v[160:163]
buffer_load_dwordx4 a[36:39], v4, s[40:43], s35 offen offset:1024 sc1
s_xor_b32 s35, s77, 98304
v_mfma_f32_16x16x32_bf16 v[144:147], a[140:143], a[40:43], v[144:147]
s_waitcnt vmcnt(10) lgkmcnt(4)
v_mfma_f32_16x16x32_bf16 v[132:135], a[96:99], a[48:51], v[132:135]
ds_read_b128 a[128:131], v5 offset:32768
v_mfma_f32_16x16x32_bf16 v[148:151], a[96:99], a[52:55], v[148:151]
ds_read_b128 a[132:135], v5 offset:33792
v_mfma_f32_16x16x32_bf16 v[152:155], a[100:103], a[52:55], v[152:155]
buffer_load_dwordx4 a[40:43], v4, s[40:43], s35 offen offset:0 sc1
v_mfma_f32_16x16x32_bf16 v[136:139], a[100:103], a[48:51], v[136:139]
ds_read_b128 a[136:139], v5 offset:34816
v_mfma_f32_16x16x32_bf16 v[140:143], a[104:107], a[48:51], v[140:143]
ds_read_b128 a[140:143], v5 offset:35840
v_mfma_f32_16x16x32_bf16 v[156:159], a[104:107], a[52:55], v[156:159]
v_mfma_f32_16x16x32_bf16 v[160:163], a[108:111], a[52:55], v[160:163]
buffer_load_dwordx4 a[44:47], v4, s[40:43], s35 offen offset:1024 sc1
s_xor_b32 s35, s77, 102400
v_mfma_f32_16x16x32_bf16 v[144:147], a[108:111], a[48:51], v[144:147]
s_waitcnt vmcnt(10) lgkmcnt(4)
v_mfma_f32_16x16x32_bf16 v[132:135], a[112:115], a[0:3], v[132:135]
ds_read_b128 a[96:99], v5 offset:36864
v_mfma_f32_16x16x32_bf16 v[148:151], a[112:115], a[4:7], v[148:151]
ds_read_b128 a[100:103], v5 offset:37888
v_mfma_f32_16x16x32_bf16 v[152:155], a[116:119], a[4:7], v[152:155]
buffer_load_dwordx4 a[48:51], v4, s[40:43], s35 offen offset:0 sc1
v_mfma_f32_16x16x32_bf16 v[136:139], a[116:119], a[0:3], v[136:139]
ds_read_b128 a[104:107], v5 offset:38912
v_mfma_f32_16x16x32_bf16 v[140:143], a[120:123], a[0:3], v[140:143]
ds_read_b128 a[108:111], v5 offset:39936
v_mfma_f32_16x16x32_bf16 v[156:159], a[120:123], a[4:7], v[156:159]
v_mfma_f32_16x16x32_bf16 v[160:163], a[124:127], a[4:7], v[160:163]
buffer_load_dwordx4 a[52:55], v4, s[40:43], s35 offen offset:1024 sc1
s_xor_b32 s35, s77, 114688
v_mfma_f32_16x16x32_bf16 v[144:147], a[124:127], a[0:3], v[144:147]
s_waitcnt vmcnt(10) lgkmcnt(4)
v_mfma_f32_16x16x32_bf16 v[132:135], a[128:131], a[8:11], v[132:135]
ds_read_b128 a[112:115], v5 offset:40960
v_mfma_f32_16x16x32_bf16 v[148:151], a[128:131], a[12:15], v[148:151]
ds_read_b128 a[116:119], v5 offset:41984
v_mfma_f32_16x16x32_bf16 v[152:155], a[132:135], a[12:15], v[152:155]
buffer_load_dwordx4 a[0:3], v4, s[40:43], s35 offen offset:0 sc1
v_mfma_f32_16x16x32_bf16 v[136:139], a[132:135], a[8:11], v[136:139]
ds_read_b128 a[120:123], v5 offset:43008
v_mfma_f32_16x16x32_bf16 v[140:143], a[136:139], a[8:11], v[140:143]
ds_read_b128 a[124:127], v5 offset:44032
v_mfma_f32_16x16x32_bf16 v[156:159], a[136:139], a[12:15], v[156:159]
v_mfma_f32_16x16x32_bf16 v[160:163], a[140:143], a[12:15], v[160:163]
buffer_load_dwordx4 a[4:7], v4, s[40:43], s35 offen offset:1024 sc1
s_xor_b32 s35, s77, 118784
v_mfma_f32_16x16x32_bf16 v[144:147], a[140:143], a[8:11], v[144:147]
s_waitcnt vmcnt(10) lgkmcnt(4)
v_mfma_f32_16x16x32_bf16 v[132:135], a[96:99], a[16:19], v[132:135]
ds_read_b128 a[128:131], v5 offset:45056
v_mfma_f32_16x16x32_bf16 v[148:151], a[96:99], a[20:23], v[148:151]
ds_read_b128 a[132:135], v5 offset:46080
v_mfma_f32_16x16x32_bf16 v[152:155], a[100:103], a[20:23], v[152:155]
buffer_load_dwordx4 a[8:11], v4, s[40:43], s35 offen offset:0 sc1
v_mfma_f32_16x16x32_bf16 v[136:139], a[100:103], a[16:19], v[136:139]
ds_read_b128 a[136:139], v5 offset:47104
v_mfma_f32_16x16x32_bf16 v[140:143], a[104:107], a[16:19], v[140:143]
ds_read_b128 a[140:143], v5 offset:48128
v_mfma_f32_16x16x32_bf16 v[156:159], a[104:107], a[20:23], v[156:159]
v_mfma_f32_16x16x32_bf16 v[160:163], a[108:111], a[20:23], v[160:163]
buffer_load_dwordx4 a[12:15], v4, s[40:43], s35 offen offset:1024 sc1
s_xor_b32 s35, s77, 524288
v_mfma_f32_16x16x32_bf16 v[144:147], a[108:111], a[16:19], v[144:147]
s_waitcnt vmcnt(10) lgkmcnt(4)
v_mfma_f32_16x16x32_bf16 v[132:135], a[112:115], a[24:27], v[132:135]
ds_read_b128 a[96:99], v5 offset:49152
v_mfma_f32_16x16x32_bf16 v[148:151], a[112:115], a[28:31], v[148:151]
ds_read_b128 a[100:103], v5 offset:50176
v_mfma_f32_16x16x32_bf16 v[152:155], a[116:119], a[28:31], v[152:155]
buffer_load_dwordx4 a[16:19], v4, s[40:43], s35 offen offset:0 sc1
v_mfma_f32_16x16x32_bf16 v[136:139], a[116:119], a[24:27], v[136:139]
ds_read_b128 a[104:107], v5 offset:51200
v_mfma_f32_16x16x32_bf16 v[140:143], a[120:123], a[24:27], v[140:143]
ds_read_b128 a[108:111], v5 offset:52224
v_mfma_f32_16x16x32_bf16 v[156:159], a[120:123], a[28:31], v[156:159]
v_mfma_f32_16x16x32_bf16 v[160:163], a[124:127], a[28:31], v[160:163]
buffer_load_dwordx4 a[20:23], v4, s[40:43], s35 offen offset:1024 sc1
s_xor_b32 s35, s77, 528384
v_mfma_f32_16x16x32_bf16 v[144:147], a[124:127], a[24:27], v[144:147]
s_waitcnt vmcnt(10) lgkmcnt(4)
v_mfma_f32_16x16x32_bf16 v[132:135], a[128:131], a[32:35], v[132:135]
ds_read_b128 a[112:115], v5 offset:53248
v_mfma_f32_16x16x32_bf16 v[148:151], a[128:131], a[36:39], v[148:151]
ds_read_b128 a[116:119], v5 offset:54272
v_mfma_f32_16x16x32_bf16 v[152:155], a[132:135], a[36:39], v[152:155]
buffer_load_dwordx4 a[24:27], v4, s[40:43], s35 offen offset:0 sc1
v_mfma_f32_16x16x32_bf16 v[136:139], a[132:135], a[32:35], v[136:139]
ds_read_b128 a[120:123], v5 offset:55296
v_mfma_f32_16x16x32_bf16 v[140:143], a[136:139], a[32:35], v[140:143]
ds_read_b128 a[124:127], v5 offset:56320
v_mfma_f32_16x16x32_bf16 v[156:159], a[136:139], a[36:39], v[156:159]
v_mfma_f32_16x16x32_bf16 v[160:163], a[140:143], a[36:39], v[160:163]
buffer_load_dwordx4 a[28:31], v4, s[40:43], s35 offen offset:1024 sc1
s_xor_b32 s35, s77, 540672
v_mfma_f32_16x16x32_bf16 v[144:147], a[140:143], a[32:35], v[144:147]
s_waitcnt vmcnt(10) lgkmcnt(4)
v_mfma_f32_16x16x32_bf16 v[132:135], a[96:99], a[40:43], v[132:135]
ds_read_b128 a[128:131], v5 offset:57344
v_mfma_f32_16x16x32_bf16 v[148:151], a[96:99], a[44:47], v[148:151]
ds_read_b128 a[132:135], v5 offset:58368
v_mfma_f32_16x16x32_bf16 v[152:155], a[100:103], a[44:47], v[152:155]
buffer_load_dwordx4 a[32:35], v4, s[40:43], s35 offen offset:0 sc1
v_mfma_f32_16x16x32_bf16 v[136:139], a[100:103], a[40:43], v[136:139]
ds_read_b128 a[136:139], v5 offset:59392
v_mfma_f32_16x16x32_bf16 v[140:143], a[104:107], a[40:43], v[140:143]
ds_read_b128 a[140:143], v5 offset:60416
v_mfma_f32_16x16x32_bf16 v[156:159], a[104:107], a[44:47], v[156:159]
v_mfma_f32_16x16x32_bf16 v[160:163], a[108:111], a[44:47], v[160:163]
buffer_load_dwordx4 a[36:39], v4, s[40:43], s35 offen offset:1024 sc1
s_xor_b32 s35, s77, 544768
v_mfma_f32_16x16x32_bf16 v[144:147], a[108:111], a[40:43], v[144:147]
s_waitcnt vmcnt(10) lgkmcnt(4)
v_mfma_f32_16x16x32_bf16 v[132:135], a[112:115], a[48:51], v[132:135]
ds_read_b128 a[96:99], v5 offset:61440
v_mfma_f32_16x16x32_bf16 v[148:151], a[112:115], a[52:55], v[148:151]
ds_read_b128 a[100:103], v5 offset:62464
v_mfma_f32_16x16x32_bf16 v[152:155], a[116:119], a[52:55], v[152:155]
buffer_load_dwordx4 a[40:43], v4, s[40:43], s35 offen offset:0 sc1
v_mfma_f32_16x16x32_bf16 v[136:139], a[116:119], a[48:51], v[136:139]
ds_read_b128 a[104:107], v5 offset:63488
v_mfma_f32_16x16x32_bf16 v[140:143], a[120:123], a[48:51], v[140:143]
ds_read_b128 a[108:111], v5 offset:64512
v_mfma_f32_16x16x32_bf16 v[156:159], a[120:123], a[52:55], v[156:159]
v_mfma_f32_16x16x32_bf16 v[160:163], a[124:127], a[52:55], v[160:163]
buffer_load_dwordx4 a[44:47], v4, s[40:43], s35 offen offset:1024 sc1
s_xor_b32 s35, s77, 557056
v_mfma_f32_16x16x32_bf16 v[144:147], a[124:127], a[48:51], v[144:147]
s_waitcnt vmcnt(10) lgkmcnt(4)
v_mfma_f32_16x16x32_bf16 v[132:135], a[128:131], a[0:3], v[132:135]
ds_read_b128 a[112:115], v6 offset:0
v_mfma_f32_16x16x32_bf16 v[148:151], a[128:131], a[4:7], v[148:151]
ds_read_b128 a[116:119], v6 offset:1024
v_mfma_f32_16x16x32_bf16 v[152:155], a[132:135], a[4:7], v[152:155]
buffer_load_dwordx4 a[48:51], v4, s[40:43], s35 offen offset:0 sc1
v_mfma_f32_16x16x32_bf16 v[136:139], a[132:135], a[0:3], v[136:139]
ds_read_b128 a[120:123], v6 offset:2048
v_mfma_f32_16x16x32_bf16 v[140:143], a[136:139], a[0:3], v[140:143]
ds_read_b128 a[124:127], v6 offset:3072
v_mfma_f32_16x16x32_bf16 v[156:159], a[136:139], a[4:7], v[156:159]
v_mfma_f32_16x16x32_bf16 v[160:163], a[140:143], a[4:7], v[160:163]
buffer_load_dwordx4 a[52:55], v4, s[40:43], s35 offen offset:1024 sc1
s_xor_b32 s35, s77, 561152
v_mfma_f32_16x16x32_bf16 v[144:147], a[140:143], a[0:3], v[144:147]
s_waitcnt vmcnt(10) lgkmcnt(4)
v_mfma_f32_16x16x32_bf16 v[132:135], a[96:99], a[8:11], v[132:135]
ds_read_b128 a[128:131], v6 offset:4096
v_mfma_f32_16x16x32_bf16 v[148:151], a[96:99], a[12:15], v[148:151]
ds_read_b128 a[132:135], v6 offset:5120
v_mfma_f32_16x16x32_bf16 v[152:155], a[100:103], a[12:15], v[152:155]
buffer_load_dwordx4 a[0:3], v4, s[40:43], s35 offen offset:0 sc1
v_mfma_f32_16x16x32_bf16 v[136:139], a[100:103], a[8:11], v[136:139]
ds_read_b128 a[136:139], v6 offset:6144
v_mfma_f32_16x16x32_bf16 v[140:143], a[104:107], a[8:11], v[140:143]
ds_read_b128 a[140:143], v6 offset:7168
v_mfma_f32_16x16x32_bf16 v[156:159], a[104:107], a[12:15], v[156:159]
v_mfma_f32_16x16x32_bf16 v[160:163], a[108:111], a[12:15], v[160:163]
buffer_load_dwordx4 a[4:7], v4, s[40:43], s35 offen offset:1024 sc1
s_xor_b32 s35, s77, 573440
v_mfma_f32_16x16x32_bf16 v[144:147], a[108:111], a[8:11], v[144:147]
s_waitcnt vmcnt(10) lgkmcnt(4)
v_mfma_f32_16x16x32_bf16 v[132:135], a[112:115], a[16:19], v[132:135]
ds_read_b128 a[96:99], v6 offset:8192
v_mfma_f32_16x16x32_bf16 v[148:151], a[112:115], a[20:23], v[148:151]
ds_read_b128 a[100:103], v6 offset:9216
v_mfma_f32_16x16x32_bf16 v[152:155], a[116:119], a[20:23], v[152:155]
buffer_load_dwordx4 a[8:11], v4, s[40:43], s35 offen offset:0 sc1
v_mfma_f32_16x16x32_bf16 v[136:139], a[116:119], a[16:19], v[136:139]
ds_read_b128 a[104:107], v6 offset:10240
v_mfma_f32_16x16x32_bf16 v[140:143], a[120:123], a[16:19], v[140:143]
ds_read_b128 a[108:111], v6 offset:11264
v_mfma_f32_16x16x32_bf16 v[156:159], a[120:123], a[20:23], v[156:159]
v_mfma_f32_16x16x32_bf16 v[160:163], a[124:127], a[20:23], v[160:163]
buffer_load_dwordx4 a[12:15], v4, s[40:43], s35 offen offset:1024 sc1
s_xor_b32 s35, s77, 577536
v_mfma_f32_16x16x32_bf16 v[144:147], a[124:127], a[16:19], v[144:147]
s_waitcnt vmcnt(10) lgkmcnt(4)
v_mfma_f32_16x16x32_bf16 v[132:135], a[128:131], a[24:27], v[132:135]
ds_read_b128 a[112:115], v6 offset:12288
v_mfma_f32_16x16x32_bf16 v[148:151], a[128:131], a[28:31], v[148:151]
ds_read_b128 a[116:119], v6 offset:13312
v_mfma_f32_16x16x32_bf16 v[152:155], a[132:135], a[28:31], v[152:155]
buffer_load_dwordx4 a[16:19], v4, s[40:43], s35 offen offset:0 sc1
v_mfma_f32_16x16x32_bf16 v[136:139], a[132:135], a[24:27], v[136:139]
ds_read_b128 a[120:123], v6 offset:14336
v_mfma_f32_16x16x32_bf16 v[140:143], a[136:139], a[24:27], v[140:143]
ds_read_b128 a[124:127], v6 offset:15360
v_mfma_f32_16x16x32_bf16 v[156:159], a[136:139], a[28:31], v[156:159]
v_mfma_f32_16x16x32_bf16 v[160:163], a[140:143], a[28:31], v[160:163]
buffer_load_dwordx4 a[20:23], v4, s[40:43], s35 offen offset:1024 sc1
s_xor_b32 s35, s77, 589824
v_mfma_f32_16x16x32_bf16 v[144:147], a[140:143], a[24:27], v[144:147]
s_waitcnt vmcnt(10) lgkmcnt(4)
v_mfma_f32_16x16x32_bf16 v[132:135], a[96:99], a[32:35], v[132:135]
ds_read_b128 a[128:131], v6 offset:16384
v_mfma_f32_16x16x32_bf16 v[148:151], a[96:99], a[36:39], v[148:151]
ds_read_b128 a[132:135], v6 offset:17408
v_mfma_f32_16x16x32_bf16 v[152:155], a[100:103], a[36:39], v[152:155]
buffer_load_dwordx4 a[24:27], v4, s[40:43], s35 offen offset:0 sc1
v_mfma_f32_16x16x32_bf16 v[136:139], a[100:103], a[32:35], v[136:139]
ds_read_b128 a[136:139], v6 offset:18432
v_mfma_f32_16x16x32_bf16 v[140:143], a[104:107], a[32:35], v[140:143]
ds_read_b128 a[140:143], v6 offset:19456
v_mfma_f32_16x16x32_bf16 v[156:159], a[104:107], a[36:39], v[156:159]
v_mfma_f32_16x16x32_bf16 v[160:163], a[108:111], a[36:39], v[160:163]
buffer_load_dwordx4 a[28:31], v4, s[40:43], s35 offen offset:1024 sc1
s_xor_b32 s35, s77, 593920
v_mfma_f32_16x16x32_bf16 v[144:147], a[108:111], a[32:35], v[144:147]
s_waitcnt vmcnt(10) lgkmcnt(4)
v_mfma_f32_16x16x32_bf16 v[132:135], a[112:115], a[40:43], v[132:135]
ds_read_b128 a[96:99], v6 offset:20480
v_mfma_f32_16x16x32_bf16 v[148:151], a[112:115], a[44:47], v[148:151]
ds_read_b128 a[100:103], v6 offset:21504
v_mfma_f32_16x16x32_bf16 v[152:155], a[116:119], a[44:47], v[152:155]
buffer_load_dwordx4 a[32:35], v4, s[40:43], s35 offen offset:0 sc1
v_mfma_f32_16x16x32_bf16 v[136:139], a[116:119], a[40:43], v[136:139]
ds_read_b128 a[104:107], v6 offset:22528
v_mfma_f32_16x16x32_bf16 v[140:143], a[120:123], a[40:43], v[140:143]
ds_read_b128 a[108:111], v6 offset:23552
v_mfma_f32_16x16x32_bf16 v[156:159], a[120:123], a[44:47], v[156:159]
v_mfma_f32_16x16x32_bf16 v[160:163], a[124:127], a[44:47], v[160:163]
buffer_load_dwordx4 a[36:39], v4, s[40:43], s35 offen offset:1024 sc1
s_xor_b32 s35, s77, 606208
v_mfma_f32_16x16x32_bf16 v[144:147], a[124:127], a[40:43], v[144:147]
s_waitcnt vmcnt(10) lgkmcnt(4)
v_mfma_f32_16x16x32_bf16 v[132:135], a[128:131], a[48:51], v[132:135]
ds_read_b128 a[112:115], v6 offset:24576
v_mfma_f32_16x16x32_bf16 v[148:151], a[128:131], a[52:55], v[148:151]
ds_read_b128 a[116:119], v6 offset:25600
v_mfma_f32_16x16x32_bf16 v[152:155], a[132:135], a[52:55], v[152:155]
buffer_load_dwordx4 a[40:43], v4, s[40:43], s35 offen offset:0 sc1
v_mfma_f32_16x16x32_bf16 v[136:139], a[132:135], a[48:51], v[136:139]
ds_read_b128 a[120:123], v6 offset:26624
v_mfma_f32_16x16x32_bf16 v[140:143], a[136:139], a[48:51], v[140:143]
ds_read_b128 a[124:127], v6 offset:27648
v_mfma_f32_16x16x32_bf16 v[156:159], a[136:139], a[52:55], v[156:159]
v_mfma_f32_16x16x32_bf16 v[160:163], a[140:143], a[52:55], v[160:163]
buffer_load_dwordx4 a[44:47], v4, s[40:43], s35 offen offset:1024 sc1
s_xor_b32 s35, s77, 610304
v_mfma_f32_16x16x32_bf16 v[144:147], a[140:143], a[48:51], v[144:147]
s_waitcnt vmcnt(10) lgkmcnt(4)
v_mfma_f32_16x16x32_bf16 v[132:135], a[96:99], a[0:3], v[132:135]
ds_read_b128 a[128:131], v6 offset:28672
v_mfma_f32_16x16x32_bf16 v[148:151], a[96:99], a[4:7], v[148:151]
ds_read_b128 a[132:135], v6 offset:29696
v_mfma_f32_16x16x32_bf16 v[152:155], a[100:103], a[4:7], v[152:155]
buffer_load_dwordx4 a[48:51], v4, s[40:43], s35 offen offset:0 sc1
v_mfma_f32_16x16x32_bf16 v[136:139], a[100:103], a[0:3], v[136:139]
ds_read_b128 a[136:139], v6 offset:30720
v_mfma_f32_16x16x32_bf16 v[140:143], a[104:107], a[0:3], v[140:143]
ds_read_b128 a[140:143], v6 offset:31744
v_mfma_f32_16x16x32_bf16 v[156:159], a[104:107], a[4:7], v[156:159]
v_mfma_f32_16x16x32_bf16 v[160:163], a[108:111], a[4:7], v[160:163]
buffer_load_dwordx4 a[52:55], v4, s[40:43], s35 offen offset:1024 sc1
s_xor_b32 s35, s77, 622592
v_mfma_f32_16x16x32_bf16 v[144:147], a[108:111], a[0:3], v[144:147]
s_waitcnt vmcnt(10) lgkmcnt(4)
v_mfma_f32_16x16x32_bf16 v[132:135], a[112:115], a[8:11], v[132:135]
ds_read_b128 a[96:99], v6 offset:32768
v_mfma_f32_16x16x32_bf16 v[148:151], a[112:115], a[12:15], v[148:151]
ds_read_b128 a[100:103], v6 offset:33792
v_mfma_f32_16x16x32_bf16 v[152:155], a[116:119], a[12:15], v[152:155]
buffer_load_dwordx4 a[0:3], v4, s[40:43], s35 offen offset:0 sc1
v_mfma_f32_16x16x32_bf16 v[136:139], a[116:119], a[8:11], v[136:139]
ds_read_b128 a[104:107], v6 offset:34816
v_mfma_f32_16x16x32_bf16 v[140:143], a[120:123], a[8:11], v[140:143]
ds_read_b128 a[108:111], v6 offset:35840
v_mfma_f32_16x16x32_bf16 v[156:159], a[120:123], a[12:15], v[156:159]
v_mfma_f32_16x16x32_bf16 v[160:163], a[124:127], a[12:15], v[160:163]
buffer_load_dwordx4 a[4:7], v4, s[40:43], s35 offen offset:1024 sc1
s_xor_b32 s35, s77, 626688
L_stub14:
s_cbranch_execz L_wret5
v_mfma_f32_16x16x32_bf16 v[144:147], a[124:127], a[8:11], v[144:147]
s_waitcnt vmcnt(10) lgkmcnt(4)
v_mfma_f32_16x16x32_bf16 v[132:135], a[128:131], a[16:19], v[132:135]
ds_read_b128 a[112:115], v6 offset:36864
v_mfma_f32_16x16x32_bf16 v[148:151], a[128:131], a[20:23], v[148:151]
ds_read_b128 a[116:119], v6 offset:37888
v_mfma_f32_16x16x32_bf16 v[152:155], a[132:135], a[20:23], v[152:155]
buffer_load_dwordx4 a[8:11], v4, s[40:43], s35 offen offset:0 sc1
v_mfma_f32_16x16x32_bf16 v[136:139], a[132:135], a[16:19], v[136:139]
ds_read_b128 a[120:123], v6 offset:38912
v_mfma_f32_16x16x32_bf16 v[140:143], a[136:139], a[16:19], v[140:143]
ds_read_b128 a[124:127], v6 offset:39936
v_mfma_f32_16x16x32_bf16 v[156:159], a[136:139], a[20:23], v[156:159]
v_mfma_f32_16x16x32_bf16 v[160:163], a[140:143], a[20:23], v[160:163]
buffer_load_dwordx4 a[12:15], v4, s[40:43], s35 offen offset:1024 sc1
s_xor_b32 s35, s77, 638976
v_mfma_f32_16x16x32_bf16 v[144:147], a[140:143], a[16:19], v[144:147]
s_waitcnt vmcnt(10) lgkmcnt(4)
v_mfma_f32_16x16x32_bf16 v[132:135], a[96:99], a[24:27], v[132:135]
ds_read_b128 a[128:131], v6 offset:40960
v_mfma_f32_16x16x32_bf16 v[148:151], a[96:99], a[28:31], v[148:151]
ds_read_b128 a[132:135], v6 offset:41984
v_mfma_f32_16x16x32_bf16 v[152:155], a[100:103], a[28:31], v[152:155]
buffer_load_dwordx4 a[16:19], v4, s[40:43], s35 offen offset:0 sc1
v_mfma_f32_16x16x32_bf16 v[136:139], a[100:103], a[24:27], v[136:139]
ds_read_b128 a[136:139], v6 offset:43008
v_mfma_f32_16x16x32_bf16 v[140:143], a[104:107], a[24:27], v[140:143]
ds_read_b128 a[140:143], v6 offset:44032
v_mfma_f32_16x16x32_bf16 v[156:159], a[104:107], a[28:31], v[156:159]
v_mfma_f32_16x16x32_bf16 v[160:163], a[108:111], a[28:31], v[160:163]
buffer_load_dwordx4 a[20:23], v4, s[40:43], s35 offen offset:1024 sc1
s_xor_b32 s35, s77, 643072
v_mfma_f32_16x16x32_bf16 v[144:147], a[108:111], a[24:27], v[144:147]
s_waitcnt vmcnt(10) lgkmcnt(4)
v_mfma_f32_16x16x32_bf16 v[132:135], a[112:115], a[32:35], v[132:135]
ds_read_b128 a[96:99], v6 offset:45056
v_mfma_f32_16x16x32_bf16 v[148:151], a[112:115], a[36:39], v[148:151]
ds_read_b128 a[100:103], v6 offset:46080
v_mfma_f32_16x16x32_bf16 v[152:155], a[116:119], a[36:39], v[152:155]
buffer_load_dwordx4 a[24:27], v4, s[40:43], s35 offen offset:0 sc1
v_mfma_f32_16x16x32_bf16 v[136:139], a[116:119], a[32:35], v[136:139]
ds_read_b128 a[104:107], v6 offset:47104
v_mfma_f32_16x16x32_bf16 v[140:143], a[120:123], a[32:35], v[140:143]
ds_read_b128 a[108:111], v6 offset:48128
v_mfma_f32_16x16x32_bf16 v[156:159], a[120:123], a[36:39], v[156:159]
v_mfma_f32_16x16x32_bf16 v[160:163], a[124:127], a[36:39], v[160:163]
buffer_load_dwordx4 a[28:31], v4, s[40:43], s35 offen offset:1024 sc1
s_xor_b32 s35, s77, 0
v_mfma_f32_16x16x32_bf16 v[144:147], a[124:127], a[32:35], v[144:147]
s_waitcnt vmcnt(10) lgkmcnt(4)
v_mfma_f32_16x16x32_bf16 v[132:135], a[128:131], a[40:43], v[132:135]
s_add_u32 m0, s18, 0x0
s_add_u32 s44, s50, 0x2800000
v_mfma_f32_16x16x32_bf16 v[148:151], a[128:131], a[44:47], v[148:151]
ds_read_b128 a[112:115], v6 offset:49152
v_mfma_f32_16x16x32_bf16 v[152:155], a[132:135], a[44:47], v[152:155]
buffer_load_dwordx4 v1, s[4:7], s44 offen offset:0 sc1 lds
v_mfma_f32_16x16x32_bf16 v[136:139], a[132:135], a[40:43], v[136:139]
ds_read_b128 a[116:119], v6 offset:50176
v_mfma_f32_16x16x32_bf16 v[140:143], a[136:139], a[40:43], v[140:143]
ds_read_b128 a[120:123], v6 offset:51200
v_mfma_f32_16x16x32_bf16 v[156:159], a[136:139], a[44:47], v[156:159]
ds_read_b128 a[124:127], v6 offset:52224
v_mfma_f32_16x16x32_bf16 v[160:163], a[140:143], a[44:47], v[160:163]
buffer_load_dwordx4 v1, s[4:7], s44 offen offset:1024 sc1 lds
s_add_u32 m0, s18, 0x2000
v_mfma_f32_16x16x32_bf16 v[144:147], a[140:143], a[40:43], v[144:147]
s_add_u32 s44, s50, 0x2802000
s_waitcnt vmcnt(10) lgkmcnt(4)
v_mfma_f32_16x16x32_bf16 v[132:135], a[96:99], a[48:51], v[132:135]
ds_read_b128 a[128:131], v6 offset:53248
v_mfma_f32_16x16x32_bf16 v[148:151], a[96:99], a[52:55], v[148:151]
ds_read_b128 a[132:135], v6 offset:54272
v_mfma_f32_16x16x32_bf16 v[152:155], a[100:103], a[52:55], v[152:155]
buffer_load_dwordx4 v1, s[4:7], s44 offen offset:0 sc1 lds
v_mfma_f32_16x16x32_bf16 v[136:139], a[100:103], a[48:51], v[136:139]
ds_read_b128 a[136:139], v6 offset:55296
v_mfma_f32_16x16x32_bf16 v[140:143], a[104:107], a[48:51], v[140:143]
ds_read_b128 a[140:143], v6 offset:56320
v_mfma_f32_16x16x32_bf16 v[156:159], a[104:107], a[52:55], v[156:159]
v_mfma_f32_16x16x32_bf16 v[160:163], a[108:111], a[52:55], v[160:163]
buffer_load_dwordx4 v1, s[4:7], s44 offen offset:1024 sc1 lds
s_add_u32 m0, s18, 0x4000
v_mfma_f32_16x16x32_bf16 v[144:147], a[108:111], a[48:51], v[144:147]
s_add_u32 s44, s50, 0x2804000
s_waitcnt vmcnt(10) lgkmcnt(4)
v_mfma_f32_16x16x32_bf16 v[132:135], a[112:115], a[0:3], v[132:135]
ds_read_b128 a[96:99], v6 offset:57344
v_mfma_f32_16x16x32_bf16 v[148:151], a[112:115], a[4:7], v[148:151]
ds_read_b128 a[100:103], v6 offset:58368
v_mfma_f32_16x16x32_bf16 v[152:155], a[116:119], a[4:7], v[152:155]
ds_read_b128 a[104:107], v6 offset:59392
v_mfma_f32_16x16x32_bf16 v[136:139], a[116:119], a[0:3], v[136:139]
buffer_load_dwordx4 v1, s[4:7], s44 offen offset:0 sc1 lds
v_mfma_f32_16x16x32_bf16 v[140:143], a[120:123], a[0:3], v[140:143]
ds_read_b128 a[108:111], v6 offset:60416
v_mfma_f32_16x16x32_bf16 v[156:159], a[120:123], a[4:7], v[156:159]
v_mfma_f32_16x16x32_bf16 v[160:163], a[124:127], a[4:7], v[160:163]
v_mfma_f32_16x16x32_bf16 v[144:147], a[124:127], a[0:3], v[144:147]
buffer_load_dwordx4 v1, s[4:7], s44 offen offset:1024 sc1 lds
s_waitcnt vmcnt(10) lgkmcnt(4)
v_mfma_f32_16x16x32_bf16 v[132:135], a[128:131], a[8:11], v[132:135]
s_add_u32 m0, s18, 0x6000
s_add_u32 s44, s50, 0x2806000
v_mfma_f32_16x16x32_bf16 v[148:151], a[128:131], a[12:15], v[148:151]
ds_read_b128 a[112:115], v6 offset:61440
v_mfma_f32_16x16x32_bf16 v[152:155], a[132:135], a[12:15], v[152:155]
ds_read_b128 a[116:119], v6 offset:62464
v_mfma_f32_16x16x32_bf16 v[136:139], a[132:135], a[8:11], v[136:139]
ds_read_b128 a[120:123], v6 offset:63488
v_mfma_f32_16x16x32_bf16 v[140:143], a[136:139], a[8:11], v[140:143]
buffer_load_dwordx4 v1, s[4:7], s44 offen offset:0 sc1 lds
v_mfma_f32_16x16x32_bf16 v[156:159], a[136:139], a[12:15], v[156:159]
ds_read_b128 a[124:127], v6 offset:64512
v_mfma_f32_16x16x32_bf16 v[160:163], a[140:143], a[12:15], v[160:163]
v_mfma_f32_16x16x32_bf16 v[144:147], a[140:143], a[8:11], v[144:147]
s_waitcnt vmcnt(9) lgkmcnt(4)
v_mfma_f32_16x16x32_bf16 v[132:135], a[96:99], a[16:19], v[132:135]
v_mfma_f32_16x16x32_bf16 v[148:151], a[96:99], a[20:23], v[148:151]
buffer_load_dwordx4 v1, s[4:7], s44 offen offset:1024 sc1 lds
v_mfma_f32_16x16x32_bf16 v[152:155], a[100:103], a[20:23], v[152:155]
v_mfma_f32_16x16x32_bf16 v[136:139], a[100:103], a[16:19], v[136:139]
v_mfma_f32_16x16x32_bf16 v[140:143], a[104:107], a[16:19], v[140:143]
v_mfma_f32_16x16x32_bf16 v[156:159], a[104:107], a[20:23], v[156:159]
v_mfma_f32_16x16x32_bf16 v[160:163], a[108:111], a[20:23], v[160:163]
v_mfma_f32_16x16x32_bf16 v[144:147], a[108:111], a[16:19], v[144:147]
s_waitcnt vmcnt(8) lgkmcnt(0)
v_mfma_f32_16x16x32_bf16 v[132:135], a[112:115], a[24:27], v[132:135]
v_mfma_f32_16x16x32_bf16 v[148:151], a[112:115], a[28:31], v[148:151]
v_mfma_f32_16x16x32_bf16 v[152:155], a[116:119], a[28:31], v[152:155]
v_mfma_f32_16x16x32_bf16 v[136:139], a[116:119], a[24:27], v[136:139]
v_mfma_f32_16x16x32_bf16 v[140:143], a[120:123], a[24:27], v[140:143]
v_mfma_f32_16x16x32_bf16 v[156:159], a[120:123], a[28:31], v[156:159]
v_mfma_f32_16x16x32_bf16 v[160:163], a[124:127], a[28:31], v[160:163]
v_mfma_f32_16x16x32_bf16 v[144:147], a[124:127], a[24:27], v[144:147]
s_nop 1
v_cmp_u_f32 vcc, v132, v148
s_nop 0
s_and_b32 vcc_lo, vcc_lo, s95
s_cbranch_scc1 L_k2redo2
v_cvt_pk_bf16_f32 v32, v132, v133
v_cvt_pk_bf16_f32 v33, v134, v135
v_cvt_pk_bf16_f32 v34, v136, v137
v_cvt_pk_bf16_f32 v35, v138, v139
s_add_u32 s36, s69, 0x400000
buffer_store_dwordx4 v[32:35], v4, s[4:7], s36 offen offset:0 sc1
v_cvt_pk_bf16_f32 v40, v148, v149
v_cvt_pk_bf16_f32 v41, v150, v151
v_cvt_pk_bf16_f32 v42, v152, v153
v_cvt_pk_bf16_f32 v43, v154, v155
v_cvt_pk_bf16_f32 v36, v140, v141
v_cvt_pk_bf16_f32 v37, v142, v143
v_cvt_pk_bf16_f32 v38, v144, v145
v_cvt_pk_bf16_f32 v39, v146, v147
s_add_u32 s37, s36, 4096
v_cvt_pk_bf16_f32 v44, v156, v157
v_cvt_pk_bf16_f32 v45, v158, v159
v_cvt_pk_bf16_f32 v46, v160, v161
buffer_store_dwordx4 v[40:43], v4, s[4:7], s36 offen offset:1024 sc1
v_cvt_pk_bf16_f32 v47, v162, v163
v_mfma_f32_16x16x32_bf16 v[96:99], v[32:35], v[32:35], 0
s_mov_b32 s38, 0x380000
s_add_u32 s92, s78, 0x60000
v_mfma_f32_16x16x32_bf16 v[92:95], v[16:19], v[32:35], 0
s_add_u32 s40, s4, 0x400000
s_addc_u32 s41, s5, 0
v_mfma_f32_16x16x32_bf16 v[96:99], v[36:39], v[36:39], v[96:99]
buffer_store_dwordx4 v[36:39], v4, s[4:7], s37 offen offset:0 sc1
v_mfma_f32_16x16x32_bf16 v[92:95], v[16:19], v[36:39], v[92:95]
s_nop 5
v_cndmask_b32 v96, v96, v97, s[46:47]
v_cndmask_b32 v98, v98, v99, s[46:47]
v_mfma_f32_16x16x32_bf16 v[104:107], v[40:43], v[40:43], 0
v_mfma_f32_16x16x32_bf16 v[100:103], v[16:19], v[40:43], 0
v_cndmask_b32 v93, v96, v98, s[48:49]
buffer_store_dwordx4 v[44:47], v4, s[4:7], s37 offen offset:1024 sc1
v_mfma_f32_16x16x32_bf16 v[104:107], v[44:47], v[44:47], v[104:107]
v_mfma_f32_16x16x32_bf16 v[100:103], v[16:19], v[44:47], v[100:103]
s_nop 6
v_cndmask_b32 v104, v104, v105, s[46:47]
v_cndmask_b32 v106, v106, v107, s[46:47]
buffer_store_dwordx2 v[92:93], v253, s[4:7], s38 offen offset:0 sc1
v_cndmask_b32 v101, v104, v106, s[48:49]
buffer_store_dwordx2 v[100:101], v253, s[4:7], s38 offen offset:2048 sc1
s_barrier
s_add_u32 m0, s18, 0x8000
s_add_u32 s44, s50, 0x2808000
buffer_load_dwordx4 v1, s[4:7], s44 offen offset:0 sc1 lds
buffer_load_dwordx4 v1, s[4:7], s44 offen offset:1024 sc1 lds
s_add_u32 m0, s18, 0xa000
s_add_u32 s44, s50, 0x280a000
buffer_load_dwordx4 v1, s[4:7], s44 offen offset:0 sc1 lds
buffer_load_dwordx4 v1, s[4:7], s44 offen offset:1024 sc1 lds
v_accvgpr_read_b32 v48, a216
v_accvgpr_read_b32 v49, a217
v_accvgpr_read_b32 v50, a218
v_accvgpr_read_b32 v51, a219
v_accvgpr_read_b32 v52, a220
v_accvgpr_read_b32 v53, a221
v_accvgpr_read_b32 v54, a222
v_accvgpr_read_b32 v55, a223
v_accvgpr_read_b32 v56, a224
v_accvgpr_read_b32 v57, a225
v_accvgpr_read_b32 v58, a226
v_accvgpr_read_b32 v59, a227
v_accvgpr_read_b32 v60, a228
v_accvgpr_read_b32 v61, a229
v_accvgpr_read_b32 v62, a230
v_accvgpr_read_b32 v63, a231
v_accvgpr_read_b32 v64, a232
v_accvgpr_read_b32 v65, a233
v_accvgpr_read_b32 v66, a234
v_accvgpr_read_b32 v67, a235
v_accvgpr_read_b32 v68, a236
v_accvgpr_read_b32 v69, a237
v_accvgpr_read_b32 v70, a238
v_accvgpr_read_b32 v71, a239
s_waitcnt vmcnt(4)
s_barrier
s_cmp_lg_u32 s28, 0
s_cbranch_scc1 Lsg_40
buffer_atomic_add v12, v10, s[4:7], s92 offen sc1
Lsg_40:
s_mov_b64 exec, 0
s_cmp_eq_u32 s28, 0
s_cbranch_scc1 L_stub15
L_wret6:
s_mov_b64 exec, -1
s_cmp_lt_u32 s28, 2
s_cbranch_scc1 Lwd_41
s_add_u32 m0, s19, 0xa000
s_add_u32 s44, s50, 0x280a000
s_add_u32 s44, s44, s18
buffer_load_dwordx4 v1, s[4:7], s44 offen offset:0 sc1 lds
buffer_load_dwordx4 v1, s[4:7], s44 offen offset:1024 sc1 lds
buffer_load_dwordx4 v1, s[4:7], s44 offen offset:2048 sc1 lds
buffer_load_dwordx4 v1, s[4:7], s44 offen offset:3072 sc1 lds
s_add_u32 m0, s19, 0xc000
s_add_u32 s44, s50, 0x280c000
s_add_u32 s44, s44, s18
buffer_load_dwordx4 v1, s[4:7], s44 offen offset:0 sc1 lds
buffer_load_dwordx4 v1, s[4:7], s44 offen offset:1024 sc1 lds
buffer_load_dwordx4 v1, s[4:7], s44 offen offset:2048 sc1 lds
buffer_load_dwordx4 v1, s[4:7], s44 offen offset:3072 sc1 lds
s_add_u32 m0, s19, 0xe000
s_add_u32 s44, s50, 0x280e000
s_add_u32 s44, s44, s18
buffer_load_dwordx4 v1, s[4:7], s44 offen offset:0 sc1 lds
buffer_load_dwordx4 v1, s[4:7], s44 offen offset:1024 sc1 lds
buffer_load_dwordx4 v1, s[4:7], s44 offen offset:2048 sc1 lds
buffer_load_dwordx4 v1, s[4:7], s44 offen offset:3072 sc1 lds
s_add_u32 m0, s19, 0x10000
s_add_u32 s44, s50, 0x2810000
s_add_u32 s44, s44, s18
buffer_load_dwordx4 v1, s[4:7], s44 offen offset:0 sc1 lds
buffer_load_dwordx4 v1, s[4:7], s44 offen offset:1024 sc1 lds
buffer_load_dwordx4 v1, s[4:7], s44 offen offset:2048 sc1 lds
buffer_load_dwordx4 v1, s[4:7], s44 offen offset:3072 sc1 lds
s_add_u32 m0, s19, 0x12000
s_add_u32 s44, s50, 0x2812000
s_add_u32 s44, s44, s18
buffer_load_dwordx4 v1, s[4:7], s44 offen offset:0 sc1 lds
buffer_load_dwordx4 v1, s[4:7], s44 offen offset:1024 sc1 lds
buffer_load_dwordx4 v1, s[4:7], s44 offen offset:2048 sc1 lds
buffer_load_dwordx4 v1, s[4:7], s44 offen offset:3072 sc1 lds
s_add_u32 m0, s19, 0x14000
s_add_u32 s44, s50, 0x2814000
s_add_u32 s44, s44, s18
buffer_load_dwordx4 v1, s[4:7], s44 offen offset:0 sc1 lds
buffer_load_dwordx4 v1, s[4:7], s44 offen offset:1024 sc1 lds
buffer_load_dwordx4 v1, s[4:7], s44 offen offset:2048 sc1 lds
buffer_load_dwordx4 v1, s[4:7], s44 offen offset:3072 sc1 lds
s_add_u32 m0, s19, 0x16000
s_add_u32 s44, s50, 0x2816000
s_add_u32 s44, s44, s18
buffer_load_dwordx4 v1, s[4:7], s44 offen offset:0 sc1 lds
buffer_load_dwordx4 v1, s[4:7], s44 offen offset:1024 sc1 lds
buffer_load_dwordx4 v1, s[4:7], s44 offen offset:2048 sc1 lds
buffer_load_dwordx4 v1, s[4:7], s44 offen offset:3072 sc1 lds
s_add_u32 m0, s19, 0x18000
s_add_u32 s44, s50, 0x2818000
s_add_u32 s44, s44, s18
buffer_load_dwordx4 v1, s[4:7], s44 offen offset:0 sc1 lds
buffer_load_dwordx4 v1, s[4:7], s44 offen offset:1024 sc1 lds
buffer_load_dwordx4 v1, s[4:7], s44 offen offset:2048 sc1 lds
buffer_load_dwordx4 v1, s[4:7], s44 offen offset:3072 sc1 lds
Lwd_41:
s_cmp_lg_u32 s28, 1
s_cbranch_scc1 Lpo_44
s_add_u32 s36, s34, 0x60000
s_mov_b32 s37, 0
v_mov_b32 v11, 0
buffer_atomic_add v11, v251, s[4:7], s36 offen sc0 sc1
s_sleep 4
Lpoll_42:
v_mov_b32 v234, 0
buffer_atomic_add v234, v251, s[4:7], s36 offen sc0 sc1
s_waitcnt vmcnt(1)
v_readfirstlane_b32 s38, v11
s_nop 0
s_cmp_ge_u32 s38, 32
s_cbranch_scc1 Lpe_43
v_mov_b32 v11, 0
buffer_atomic_add v11, v251, s[4:7], s36 offen sc0 sc1
s_waitcnt vmcnt(1)
v_readfirstlane_b32 s38, v234
s_nop 0
s_cmp_ge_u32 s38, 32
s_cbranch_scc1 Lpe_43
s_add_u32 s37, s37, 1
s_cmp_lt_u32 s37, 0x80000
s_cbranch_scc1 Lpoll_42
s_waitcnt vmcnt(0)
Lpo_44:
s_waitcnt vmcnt(32) lgkmcnt(0)
s_cmp_ge_u32 s28, 2
s_cbranch_scc1 Lw_45
s_waitcnt vmcnt(0)
Lw_45:
Lpe_43:
s_barrier
s_mov_b32 s35, s68
s_add_u32 s33, s35, 0x1000
buffer_load_dwordx4 a[0:3], v2, s[40:43], s35 offen offset:0 sc1
buffer_load_dwordx4 a[4:7], v2, s[40:43], s33 offen offset:0 sc1
buffer_load_dwordx4 a[8:11], v2, s[40:43], s35 offen offset:1024 sc1
buffer_load_dwordx4 a[12:15], v2, s[40:43], s33 offen offset:1024 sc1
buffer_load_dwordx4 a[16:19], v2, s[40:43], s35 offen offset:2048 sc1
buffer_load_dwordx4 a[20:23], v2, s[40:43], s33 offen offset:2048 sc1
buffer_load_dwordx4 a[24:27], v2, s[40:43], s35 offen offset:3072 sc1
buffer_load_dwordx4 a[28:31], v2, s[40:43], s33 offen offset:3072 sc1
s_add_u32 s35, s35, 0x4000
s_add_u32 s33, s33, 0x4000
buffer_load_dwordx4 a[32:35], v2, s[40:43], s35 offen offset:0 sc1
buffer_load_dwordx4 a[36:39], v2, s[40:43], s33 offen offset:0 sc1
buffer_load_dwordx4 a[40:43], v2, s[40:43], s35 offen offset:1024 sc1
buffer_load_dwordx4 a[44:47], v2, s[40:43], s33 offen offset:1024 sc1
buffer_load_dwordx4 a[48:51], v2, s[40:43], s35 offen offset:2048 sc1
buffer_load_dwordx4 a[52:55], v2, s[40:43], s33 offen offset:2048 sc1
buffer_load_dwordx4 a[56:59], v2, s[40:43], s35 offen offset:3072 sc1
buffer_load_dwordx4 a[60:63], v2, s[40:43], s33 offen offset:3072 sc1
s_add_u32 s35, s35, 0x4000
s_add_u32 s33, s33, 0x4000
v_add_u32 v5, 0, v1
ds_read_b128 a[96:99], v5 offset:2048
ds_read_b128 a[100:103], v5 offset:8192
ds_read_b128 a[104:107], v5 offset:3072
ds_read_b128 a[108:111], v5 offset:9216
ds_read_b128 a[112:115], v5 offset:4096
ds_read_b128 a[116:119], v5 offset:10240
s_waitcnt vmcnt(14) lgkmcnt(4)
v_mfma_f32_16x16x32_bf16 v[140:143], a[96:99], a[0:3], 0
s_add_u32 m0, s18, 0x1c000
s_add_u32 s44, s50, 0x281c000
v_mfma_f32_16x16x32_bf16 v[140:143], a[100:103], a[4:7], v[140:143]
buffer_load_dwordx4 a[64:67], v2, s[40:43], s35 offen offset:0 sc1
s_waitcnt vmcnt(13)
v_mfma_f32_16x16x32_bf16 v[164:167], a[100:103], a[12:15], 0
ds_read_b128 a[128:131], v5 offset:5120
v_mfma_f32_16x16x32_bf16 v[164:167], a[96:99], a[8:11], v[164:167]
ds_read_b128 a[132:135], v5 offset:11264
s_waitcnt vmcnt(12)
v_mfma_f32_16x16x32_bf16 v[188:191], a[96:99], a[16:19], 0
s_waitcnt vmcnt(11)
v_mfma_f32_16x16x32_bf16 v[188:191], a[100:103], a[20:23], v[188:191]
buffer_load_dwordx4 a[68:71], v2, s[40:43], s33 offen offset:0 sc1
s_waitcnt vmcnt(10)
v_mfma_f32_16x16x32_bf16 v[212:215], a[100:103], a[28:31], 0
ds_read_b128 a[136:139], v5 offset:0
v_mfma_f32_16x16x32_bf16 v[212:215], a[96:99], a[24:27], v[212:215]
s_waitcnt lgkmcnt(6)
v_mfma_f32_16x16x32_bf16 v[216:219], a[104:107], a[24:27], 0
ds_read_b128 a[140:143], v5 offset:6144
s_waitcnt lgkmcnt(6)
v_mfma_f32_16x16x32_bf16 v[216:219], a[108:111], a[28:31], v[216:219]
v_mfma_f32_16x16x32_bf16 v[192:195], a[108:111], a[20:23], 0
buffer_load_dwordx4 v1, s[4:7], s44 offen offset:0 sc1 lds
v_mfma_f32_16x16x32_bf16 v[192:195], a[104:107], a[16:19], v[192:195]
ds_read_b128 a[144:147], v5 offset:1024
v_mfma_f32_16x16x32_bf16 v[168:171], a[104:107], a[8:11], 0
v_mfma_f32_16x16x32_bf16 v[168:171], a[108:111], a[12:15], v[168:171]
ds_read_b128 a[148:151], v5 offset:7168
v_mfma_f32_16x16x32_bf16 v[144:147], a[108:111], a[4:7], 0
v_mfma_f32_16x16x32_bf16 v[144:147], a[104:107], a[0:3], v[144:147]
buffer_load_dwordx4 a[72:75], v2, s[40:43], s35 offen offset:1024 sc1
s_waitcnt lgkmcnt(7)
v_mfma_f32_16x16x32_bf16 v[148:151], a[112:115], a[0:3], 0
s_waitcnt lgkmcnt(6)
v_mfma_f32_16x16x32_bf16 v[148:151], a[116:119], a[4:7], v[148:151]
v_mfma_f32_16x16x32_bf16 v[172:175], a[116:119], a[12:15], 0
v_mfma_f32_16x16x32_bf16 v[172:175], a[112:115], a[8:11], v[172:175]
v_mfma_f32_16x16x32_bf16 v[196:199], a[112:115], a[16:19], 0
buffer_load_dwordx4 a[76:79], v2, s[40:43], s33 offen offset:1024 sc1
v_mfma_f32_16x16x32_bf16 v[196:199], a[116:119], a[20:23], v[196:199]
v_mfma_f32_16x16x32_bf16 v[220:223], a[116:119], a[28:31], 0
v_mfma_f32_16x16x32_bf16 v[220:223], a[112:115], a[24:27], v[220:223]
s_waitcnt lgkmcnt(0)
v_mfma_f32_16x16x32_bf16 v[224:227], a[128:131], a[24:27], 0
ds_read_b128 a[96:99], v5 offset:14336
v_mfma_f32_16x16x32_bf16 v[224:227], a[132:135], a[28:31], v[224:227]
buffer_load_dwordx4 a[80:83], v2, s[40:43], s35 offen offset:2048 sc1
v_mfma_f32_16x16x32_bf16 v[200:203], a[132:135], a[20:23], 0
ds_read_b128 a[100:103], v5 offset:20480
v_mfma_f32_16x16x32_bf16 v[200:203], a[128:131], a[16:19], v[200:203]
v_mfma_f32_16x16x32_bf16 v[176:179], a[128:131], a[8:11], 0
v_mfma_f32_16x16x32_bf16 v[176:179], a[132:135], a[12:15], v[176:179]
buffer_load_dwordx4 a[84:87], v2, s[40:43], s33 offen offset:2048 sc1
v_mfma_f32_16x16x32_bf16 v[152:155], a[132:135], a[4:7], 0
ds_read_b128 a[104:107], v5 offset:15360
v_mfma_f32_16x16x32_bf16 v[152:155], a[128:131], a[0:3], v[152:155]
v_mfma_f32_16x16x32_bf16 v[132:135], a[136:139], a[0:3], 0
ds_read_b128 a[108:111], v5 offset:21504
v_mfma_f32_16x16x32_bf16 v[132:135], a[140:143], a[4:7], v[132:135]
v_mfma_f32_16x16x32_bf16 v[156:159], a[140:143], a[12:15], 0
buffer_load_dwordx4 v1, s[4:7], s44 offen offset:1024 sc1 lds
s_add_u32 m0, s18, 0x1e000
v_mfma_f32_16x16x32_bf16 v[156:159], a[136:139], a[8:11], v[156:159]
s_add_u32 s44, s50, 0x281e000
ds_read_b128 a[112:115], v5 offset:16384
v_mfma_f32_16x16x32_bf16 v[180:183], a[136:139], a[16:19], 0
v_mfma_f32_16x16x32_bf16 v[180:183], a[140:143], a[20:23], v[180:183]
ds_read_b128 a[116:119], v5 offset:22528
v_mfma_f32_16x16x32_bf16 v[204:207], a[140:143], a[28:31], 0
v_mfma_f32_16x16x32_bf16 v[204:207], a[136:139], a[24:27], v[204:207]
buffer_load_dwordx4 a[88:91], v2, s[40:43], s35 offen offset:3072 sc1
v_mfma_f32_16x16x32_bf16 v[208:211], a[144:147], a[24:27], 0
v_mfma_f32_16x16x32_bf16 v[208:211], a[148:151], a[28:31], v[208:211]
v_mfma_f32_16x16x32_bf16 v[184:187], a[148:151], a[20:23], 0
v_mfma_f32_16x16x32_bf16 v[184:187], a[144:147], a[16:19], v[184:187]
v_mfma_f32_16x16x32_bf16 v[160:163], a[144:147], a[8:11], 0
buffer_load_dwordx4 a[92:95], v2, s[40:43], s33 offen offset:3072 sc1
s_add_u32 s35, s35, 0x4000
v_mfma_f32_16x16x32_bf16 v[160:163], a[148:151], a[12:15], v[160:163]
s_add_u32 s33, s33, 0x4000
v_mfma_f32_16x16x32_bf16 v[136:139], a[148:151], a[4:7], 0
v_mfma_f32_16x16x32_bf16 v[136:139], a[144:147], a[0:3], v[136:139]
s_waitcnt vmcnt(10) lgkmcnt(0)
v_mfma_f32_16x16x32_bf16 v[140:143], a[96:99], a[32:35], v[140:143]
ds_read_b128 a[128:131], v5 offset:17408
v_mfma_f32_16x16x32_bf16 v[140:143], a[100:103], a[36:39], v[140:143]
buffer_load_dwordx4 a[0:3], v2, s[40:43], s35 offen offset:0 sc1
v_mfma_f32_16x16x32_bf16 v[164:167], a[100:103], a[44:47], v[164:167]
ds_read_b128 a[132:135], v5 offset:23552
v_mfma_f32_16x16x32_bf16 v[164:167], a[96:99], a[40:43], v[164:167]
v_mfma_f32_16x16x32_bf16 v[188:191], a[96:99], a[48:51], v[188:191]
v_mfma_f32_16x16x32_bf16 v[188:191], a[100:103], a[52:55], v[188:191]
buffer_load_dwordx4 a[4:7], v2, s[40:43], s33 offen offset:0 sc1
v_mfma_f32_16x16x32_bf16 v[212:215], a[100:103], a[60:63], v[212:215]
ds_read_b128 a[136:139], v5 offset:12288
v_mfma_f32_16x16x32_bf16 v[212:215], a[96:99], a[56:59], v[212:215]
v_mfma_f32_16x16x32_bf16 v[216:219], a[104:107], a[56:59], v[216:219]
ds_read_b128 a[140:143], v5 offset:18432
v_mfma_f32_16x16x32_bf16 v[216:219], a[108:111], a[60:63], v[216:219]
v_mfma_f32_16x16x32_bf16 v[192:195], a[108:111], a[52:55], v[192:195]
buffer_load_dwordx4 v1, s[4:7], s44 offen offset:0 sc1 lds
v_mfma_f32_16x16x32_bf16 v[192:195], a[104:107], a[48:51], v[192:195]
ds_read_b128 a[144:147], v5 offset:13312
v_mfma_f32_16x16x32_bf16 v[168:171], a[104:107], a[40:43], v[168:171]
v_mfma_f32_16x16x32_bf16 v[168:171], a[108:111], a[44:47], v[168:171]
ds_read_b128 a[148:151], v5 offset:19456
v_mfma_f32_16x16x32_bf16 v[144:147], a[108:111], a[36:39], v[144:147]
v_mfma_f32_16x16x32_bf16 v[144:147], a[104:107], a[32:35], v[144:147]
buffer_load_dwordx4 a[8:11], v2, s[40:43], s35 offen offset:1024 sc1
v_mfma_f32_16x16x32_bf16 v[148:151], a[112:115], a[32:35], v[148:151]
v_mfma_f32_16x16x32_bf16 v[148:151], a[116:119], a[36:39], v[148:151]
v_mfma_f32_16x16x32_bf16 v[172:175], a[116:119], a[44:47], v[172:175]
v_mfma_f32_16x16x32_bf16 v[172:175], a[112:115], a[40:43], v[172:175]
v_mfma_f32_16x16x32_bf16 v[196:199], a[112:115], a[48:51], v[196:199]
buffer_load_dwordx4 a[12:15], v2, s[40:43], s33 offen offset:1024 sc1
v_mfma_f32_16x16x32_bf16 v[196:199], a[116:119], a[52:55], v[196:199]
v_mfma_f32_16x16x32_bf16 v[220:223], a[116:119], a[60:63], v[220:223]
v_mfma_f32_16x16x32_bf16 v[220:223], a[112:115], a[56:59], v[220:223]
s_waitcnt lgkmcnt(0)
v_mfma_f32_16x16x32_bf16 v[224:227], a[128:131], a[56:59], v[224:227]
ds_read_b128 a[96:99], v5 offset:26624
v_mfma_f32_16x16x32_bf16 v[224:227], a[132:135], a[60:63], v[224:227]
buffer_load_dwordx4 a[16:19], v2, s[40:43], s35 offen offset:2048 sc1
v_mfma_f32_16x16x32_bf16 v[200:203], a[132:135], a[52:55], v[200:203]
ds_read_b128 a[100:103], v5 offset:32768
v_mfma_f32_16x16x32_bf16 v[200:203], a[128:131], a[48:51], v[200:203]
v_mfma_f32_16x16x32_bf16 v[176:179], a[128:131], a[40:43], v[176:179]
v_mfma_f32_16x16x32_bf16 v[176:179], a[132:135], a[44:47], v[176:179]
buffer_load_dwordx4 v1, s[4:7], s44 offen offset:1024 sc1 lds
s_add_u32 m0, s18, 0x20000
v_mfma_f32_16x16x32_bf16 v[152:155], a[132:135], a[36:39], v[152:155]
s_add_u32 s44, s50, 0x2820000
ds_read_b128 a[104:107], v5 offset:27648
v_mfma_f32_16x16x32_bf16 v[152:155], a[128:131], a[32:35], v[152:155]
v_mfma_f32_16x16x32_bf16 v[132:135], a[136:139], a[32:35], v[132:135]
ds_read_b128 a[108:111], v5 offset:33792
v_mfma_f32_16x16x32_bf16 v[132:135], a[140:143], a[36:39], v[132:135]
buffer_load_dwordx4 a[20:23], v2, s[40:43], s33 offen offset:2048 sc1
v_mfma_f32_16x16x32_bf16 v[156:159], a[140:143], a[44:47], v[156:159]
ds_read_b128 a[112:115], v5 offset:28672
v_mfma_f32_16x16x32_bf16 v[156:159], a[136:139], a[40:43], v[156:159]
v_mfma_f32_16x16x32_bf16 v[180:183], a[136:139], a[48:51], v[180:183]
v_mfma_f32_16x16x32_bf16 v[180:183], a[140:143], a[52:55], v[180:183]
buffer_load_dwordx4 a[24:27], v2, s[40:43], s35 offen offset:3072 sc1
v_mfma_f32_16x16x32_bf16 v[204:207], a[140:143], a[60:63], v[204:207]
ds_read_b128 a[116:119], v5 offset:34816
v_mfma_f32_16x16x32_bf16 v[204:207], a[136:139], a[56:59], v[204:207]
v_mfma_f32_16x16x32_bf16 v[208:211], a[144:147], a[56:59], v[208:211]
v_mfma_f32_16x16x32_bf16 v[208:211], a[148:151], a[60:63], v[208:211]
buffer_load_dwordx4 v1, s[4:7], s44 offen offset:0 sc1 lds
v_mfma_f32_16x16x32_bf16 v[184:187], a[148:151], a[52:55], v[184:187]
v_mfma_f32_16x16x32_bf16 v[184:187], a[144:147], a[48:51], v[184:187]
v_mfma_f32_16x16x32_bf16 v[160:163], a[144:147], a[40:43], v[160:163]
v_mfma_f32_16x16x32_bf16 v[160:163], a[148:151], a[44:47], v[160:163]
buffer_load_dwordx4 a[28:31], v2, s[40:43], s33 offen offset:3072 sc1
s_add_u32 s35, s35, 0x4000
v_mfma_f32_16x16x32_bf16 v[136:139], a[148:151], a[36:39], v[136:139]
s_add_u32 s33, s33, 0x4000
v_mfma_f32_16x16x32_bf16 v[136:139], a[144:147], a[32:35], v[136:139]
s_waitcnt vmcnt(11) lgkmcnt(0)
v_mfma_f32_16x16x32_bf16 v[140:143], a[96:99], a[64:67], v[140:143]
ds_read_b128 a[128:131], v5 offset:29696
v_mfma_f32_16x16x32_bf16 v[140:143], a[100:103], a[68:71], v[140:143]
buffer_load_dwordx4 a[32:35], v2, s[40:43], s35 offen offset:0 sc1
v_mfma_f32_16x16x32_bf16 v[164:167], a[100:103], a[76:79], v[164:167]
ds_read_b128 a[132:135], v5 offset:35840
v_mfma_f32_16x16x32_bf16 v[164:167], a[96:99], a[72:75], v[164:167]
v_mfma_f32_16x16x32_bf16 v[188:191], a[96:99], a[80:83], v[188:191]
v_mfma_f32_16x16x32_bf16 v[188:191], a[100:103], a[84:87], v[188:191]
buffer_load_dwordx4 a[36:39], v2, s[40:43], s33 offen offset:0 sc1
v_mfma_f32_16x16x32_bf16 v[212:215], a[100:103], a[92:95], v[212:215]
ds_read_b128 a[136:139], v5 offset:24576
v_mfma_f32_16x16x32_bf16 v[212:215], a[96:99], a[88:91], v[212:215]
v_mfma_f32_16x16x32_bf16 v[216:219], a[104:107], a[88:91], v[216:219]
ds_read_b128 a[140:143], v5 offset:30720
v_mfma_f32_16x16x32_bf16 v[216:219], a[108:111], a[92:95], v[216:219]
v_mfma_f32_16x16x32_bf16 v[192:195], a[108:111], a[84:87], v[192:195]
buffer_load_dwordx4 v1, s[4:7], s44 offen offset:1024 sc1 lds
s_add_u32 m0, s18, 0x22000
v_mfma_f32_16x16x32_bf16 v[192:195], a[104:107], a[80:83], v[192:195]
s_add_u32 s44, s50, 0x2822000
ds_read_b128 a[144:147], v5 offset:25600
v_mfma_f32_16x16x32_bf16 v[168:171], a[104:107], a[72:75], v[168:171]
v_mfma_f32_16x16x32_bf16 v[168:171], a[108:111], a[76:79], v[168:171]
ds_read_b128 a[148:151], v5 offset:31744
v_mfma_f32_16x16x32_bf16 v[144:147], a[108:111], a[68:71], v[144:147]
v_mfma_f32_16x16x32_bf16 v[144:147], a[104:107], a[64:67], v[144:147]
buffer_load_dwordx4 a[40:43], v2, s[40:43], s35 offen offset:1024 sc1
v_mfma_f32_16x16x32_bf16 v[148:151], a[112:115], a[64:67], v[148:151]
v_mfma_f32_16x16x32_bf16 v[148:151], a[116:119], a[68:71], v[148:151]
v_mfma_f32_16x16x32_bf16 v[172:175], a[116:119], a[76:79], v[172:175]
v_mfma_f32_16x16x32_bf16 v[172:175], a[112:115], a[72:75], v[172:175]
v_mfma_f32_16x16x32_bf16 v[196:199], a[112:115], a[80:83], v[196:199]
buffer_load_dwordx4 a[44:47], v2, s[40:43], s33 offen offset:1024 sc1
v_mfma_f32_16x16x32_bf16 v[196:199], a[116:119], a[84:87], v[196:199]
v_mfma_f32_16x16x32_bf16 v[220:223], a[116:119], a[92:95], v[220:223]
v_mfma_f32_16x16x32_bf16 v[220:223], a[112:115], a[88:91], v[220:223]
s_waitcnt lgkmcnt(0)
v_mfma_f32_16x16x32_bf16 v[224:227], a[128:131], a[88:91], v[224:227]
ds_read_b128 a[96:99], v5 offset:38912
v_mfma_f32_16x16x32_bf16 v[224:227], a[132:135], a[92:95], v[224:227]
buffer_load_dwordx4 a[48:51], v2, s[40:43], s35 offen offset:2048 sc1
v_mfma_f32_16x16x32_bf16 v[200:203], a[132:135], a[84:87], v[200:203]
ds_read_b128 a[100:103], v5 offset:45056
L_stub15:
s_cbranch_execz L_stub16
v_mfma_f32_16x16x32_bf16 v[200:203], a[128:131], a[80:83], v[200:203]
v_mfma_f32_16x16x32_bf16 v[176:179], a[128:131], a[72:75], v[176:179]
v_mfma_f32_16x16x32_bf16 v[176:179], a[132:135], a[76:79], v[176:179]
buffer_load_dwordx4 a[52:55], v2, s[40:43], s33 offen offset:2048 sc1
v_mfma_f32_16x16x32_bf16 v[152:155], a[132:135], a[68:71], v[152:155]
ds_read_b128 a[104:107], v5 offset:39936
v_mfma_f32_16x16x32_bf16 v[152:155], a[128:131], a[64:67], v[152:155]
v_mfma_f32_16x16x32_bf16 v[132:135], a[136:139], a[64:67], v[132:135]
ds_read_b128 a[108:111], v5 offset:46080
v_mfma_f32_16x16x32_bf16 v[132:135], a[140:143], a[68:71], v[132:135]
v_mfma_f32_16x16x32_bf16 v[156:159], a[140:143], a[76:79], v[156:159]
buffer_load_dwordx4 v1, s[4:7], s44 offen offset:0 sc1 lds
v_mfma_f32_16x16x32_bf16 v[156:159], a[136:139], a[72:75], v[156:159]
ds_read_b128 a[112:115], v5 offset:40960
v_mfma_f32_16x16x32_bf16 v[180:183], a[136:139], a[80:83], v[180:183]
v_mfma_f32_16x16x32_bf16 v[180:183], a[140:143], a[84:87], v[180:183]
ds_read_b128 a[116:119], v5 offset:47104
v_mfma_f32_16x16x32_bf16 v[204:207], a[140:143], a[92:95], v[204:207]
v_mfma_f32_16x16x32_bf16 v[204:207], a[136:139], a[88:91], v[204:207]
buffer_load_dwordx4 a[56:59], v2, s[40:43], s35 offen offset:3072 sc1
v_mfma_f32_16x16x32_bf16 v[208:211], a[144:147], a[88:91], v[208:211]
v_mfma_f32_16x16x32_bf16 v[208:211], a[148:151], a[92:95], v[208:211]
v_mfma_f32_16x16x32_bf16 v[184:187], a[148:151], a[84:87], v[184:187]
v_mfma_f32_16x16x32_bf16 v[184:187], a[144:147], a[80:83], v[184:187]
v_mfma_f32_16x16x32_bf16 v[160:163], a[144:147], a[72:75], v[160:163]
buffer_load_dwordx4 a[60:63], v2, s[40:43], s33 offen offset:3072 sc1
s_add_u32 s35, s35, 0x4000
v_mfma_f32_16x16x32_bf16 v[160:163], a[148:151], a[76:79], v[160:163]
s_add_u32 s33, s33, 0x4000
v_mfma_f32_16x16x32_bf16 v[136:139], a[148:151], a[68:71], v[136:139]
v_mfma_f32_16x16x32_bf16 v[136:139], a[144:147], a[64:67], v[136:139]
s_waitcnt vmcnt(10) lgkmcnt(0)
v_mfma_f32_16x16x32_bf16 v[140:143], a[96:99], a[0:3], v[140:143]
ds_read_b128 a[128:131], v5 offset:41984
v_mfma_f32_16x16x32_bf16 v[140:143], a[100:103], a[4:7], v[140:143]
buffer_load_dwordx4 a[64:67], v2, s[40:43], s35 offen offset:0 sc1
v_mfma_f32_16x16x32_bf16 v[164:167], a[100:103], a[12:15], v[164:167]
ds_read_b128 a[132:135], v5 offset:48128
v_mfma_f32_16x16x32_bf16 v[164:167], a[96:99], a[8:11], v[164:167]
v_mfma_f32_16x16x32_bf16 v[188:191], a[96:99], a[16:19], v[188:191]
v_mfma_f32_16x16x32_bf16 v[188:191], a[100:103], a[20:23], v[188:191]
buffer_load_dwordx4 a[68:71], v2, s[40:43], s33 offen offset:0 sc1
v_mfma_f32_16x16x32_bf16 v[212:215], a[100:103], a[28:31], v[212:215]
ds_read_b128 a[136:139], v5 offset:36864
v_mfma_f32_16x16x32_bf16 v[212:215], a[96:99], a[24:27], v[212:215]
v_mfma_f32_16x16x32_bf16 v[216:219], a[104:107], a[24:27], v[216:219]
ds_read_b128 a[140:143], v5 offset:43008
v_mfma_f32_16x16x32_bf16 v[216:219], a[108:111], a[28:31], v[216:219]
v_mfma_f32_16x16x32_bf16 v[192:195], a[108:111], a[20:23], v[192:195]
buffer_load_dwordx4 v1, s[4:7], s44 offen offset:1024 sc1 lds
s_add_u32 s88, s82, 0x380000
v_mfma_f32_16x16x32_bf16 v[192:195], a[104:107], a[16:19], v[192:195]
ds_read_b128 a[144:147], v5 offset:37888
v_mfma_f32_16x16x32_bf16 v[168:171], a[104:107], a[8:11], v[168:171]
v_mfma_f32_16x16x32_bf16 v[168:171], a[108:111], a[12:15], v[168:171]
ds_read_b128 a[148:151], v5 offset:44032
v_mfma_f32_16x16x32_bf16 v[144:147], a[108:111], a[4:7], v[144:147]
v_mfma_f32_16x16x32_bf16 v[144:147], a[104:107], a[0:3], v[144:147]
buffer_load_dwordx4 a[72:75], v2, s[40:43], s35 offen offset:1024 sc1
v_mfma_f32_16x16x32_bf16 v[148:151], a[112:115], a[0:3], v[148:151]
v_mfma_f32_16x16x32_bf16 v[148:151], a[116:119], a[4:7], v[148:151]
v_mfma_f32_16x16x32_bf16 v[172:175], a[116:119], a[12:15], v[172:175]
v_mfma_f32_16x16x32_bf16 v[172:175], a[112:115], a[8:11], v[172:175]
v_mfma_f32_16x16x32_bf16 v[196:199], a[112:115], a[16:19], v[196:199]
buffer_load_dwordx4 a[76:79], v2, s[40:43], s33 offen offset:1024 sc1
v_mfma_f32_16x16x32_bf16 v[196:199], a[116:119], a[20:23], v[196:199]
v_mfma_f32_16x16x32_bf16 v[220:223], a[116:119], a[28:31], v[220:223]
v_mfma_f32_16x16x32_bf16 v[220:223], a[112:115], a[24:27], v[220:223]
s_waitcnt lgkmcnt(0)
s_barrier
v_mfma_f32_16x16x32_bf16 v[224:227], a[128:131], a[24:27], v[224:227]
v_add_u32 v5, 49152, v1
v_mfma_f32_16x16x32_bf16 v[224:227], a[132:135], a[28:31], v[224:227]
buffer_load_dwordx4 a[80:83], v2, s[40:43], s35 offen offset:2048 sc1
v_mfma_f32_16x16x32_bf16 v[200:203], a[132:135], a[20:23], v[200:203]
ds_read_b128 a[96:99], v5 offset:2048
v_mfma_f32_16x16x32_bf16 v[200:203], a[128:131], a[16:19], v[200:203]
ds_read_b128 a[100:103], v5 offset:8192
v_mfma_f32_16x16x32_bf16 v[176:179], a[128:131], a[8:11], v[176:179]
v_mfma_f32_16x16x32_bf16 v[176:179], a[132:135], a[12:15], v[176:179]
buffer_load_dwordx4 a[84:87], v2, s[40:43], s33 offen offset:2048 sc1
v_mfma_f32_16x16x32_bf16 v[152:155], a[132:135], a[4:7], v[152:155]
ds_read_b128 a[104:107], v5 offset:3072
v_mfma_f32_16x16x32_bf16 v[152:155], a[128:131], a[0:3], v[152:155]
v_mfma_f32_16x16x32_bf16 v[132:135], a[136:139], a[0:3], v[132:135]
ds_read_b128 a[108:111], v5 offset:9216
v_mfma_f32_16x16x32_bf16 v[132:135], a[140:143], a[4:7], v[132:135]
v_mfma_f32_16x16x32_bf16 v[156:159], a[140:143], a[12:15], v[156:159]
buffer_load_dwordx4 v[92:95], v1, s[4:7], s88 offen offset:0 sc1
v_mfma_f32_16x16x32_bf16 v[156:159], a[136:139], a[8:11], v[156:159]
ds_read_b128 a[112:115], v5 offset:4096
v_mfma_f32_16x16x32_bf16 v[180:183], a[136:139], a[16:19], v[180:183]
v_mfma_f32_16x16x32_bf16 v[180:183], a[140:143], a[20:23], v[180:183]
ds_read_b128 a[116:119], v5 offset:10240
v_mfma_f32_16x16x32_bf16 v[204:207], a[140:143], a[28:31], v[204:207]
v_mfma_f32_16x16x32_bf16 v[204:207], a[136:139], a[24:27], v[204:207]
buffer_load_dwordx4 a[88:91], v2, s[40:43], s35 offen offset:3072 sc1
v_mfma_f32_16x16x32_bf16 v[208:211], a[144:147], a[24:27], v[208:211]
v_mfma_f32_16x16x32_bf16 v[208:211], a[148:151], a[28:31], v[208:211]
v_mfma_f32_16x16x32_bf16 v[184:187], a[148:151], a[20:23], v[184:187]
v_mfma_f32_16x16x32_bf16 v[184:187], a[144:147], a[16:19], v[184:187]
v_mfma_f32_16x16x32_bf16 v[160:163], a[144:147], a[8:11], v[160:163]
buffer_load_dwordx4 a[92:95], v2, s[40:43], s33 offen offset:3072 sc1
s_add_u32 s35, s35, 0x4000
v_mfma_f32_16x16x32_bf16 v[160:163], a[148:151], a[12:15], v[160:163]
s_add_u32 s33, s33, 0x4000
v_mfma_f32_16x16x32_bf16 v[136:139], a[148:151], a[4:7], v[136:139]
v_mfma_f32_16x16x32_bf16 v[136:139], a[144:147], a[0:3], v[136:139]
s_waitcnt vmcnt(10) lgkmcnt(0)
v_mfma_f32_16x16x32_bf16 v[140:143], a[96:99], a[32:35], v[140:143]
ds_read_b128 a[128:131], v5 offset:5120
v_mfma_f32_16x16x32_bf16 v[140:143], a[100:103], a[36:39], v[140:143]
buffer_load_dwordx4 a[0:3], v2, s[40:43], s35 offen offset:0 sc1
v_mfma_f32_16x16x32_bf16 v[164:167], a[100:103], a[44:47], v[164:167]
ds_read_b128 a[132:135], v5 offset:11264
v_mfma_f32_16x16x32_bf16 v[164:167], a[96:99], a[40:43], v[164:167]
v_mfma_f32_16x16x32_bf16 v[188:191], a[96:99], a[48:51], v[188:191]
v_mfma_f32_16x16x32_bf16 v[188:191], a[100:103], a[52:55], v[188:191]
buffer_load_dwordx4 a[4:7], v2, s[40:43], s33 offen offset:0 sc1
v_mfma_f32_16x16x32_bf16 v[212:215], a[100:103], a[60:63], v[212:215]
ds_read_b128 a[136:139], v5 offset:0
v_mfma_f32_16x16x32_bf16 v[212:215], a[96:99], a[56:59], v[212:215]
v_mfma_f32_16x16x32_bf16 v[216:219], a[104:107], a[56:59], v[216:219]
ds_read_b128 a[140:143], v5 offset:6144
v_mfma_f32_16x16x32_bf16 v[216:219], a[108:111], a[60:63], v[216:219]
v_mfma_f32_16x16x32_bf16 v[192:195], a[108:111], a[52:55], v[192:195]
buffer_load_dwordx4 v[96:99], v1, s[4:7], s88 offen offset:1024 sc1
v_mfma_f32_16x16x32_bf16 v[192:195], a[104:107], a[48:51], v[192:195]
ds_read_b128 a[144:147], v5 offset:1024
v_mfma_f32_16x16x32_bf16 v[168:171], a[104:107], a[40:43], v[168:171]
v_mfma_f32_16x16x32_bf16 v[168:171], a[108:111], a[44:47], v[168:171]
ds_read_b128 a[148:151], v5 offset:7168
v_mfma_f32_16x16x32_bf16 v[144:147], a[108:111], a[36:39], v[144:147]
v_mfma_f32_16x16x32_bf16 v[144:147], a[104:107], a[32:35], v[144:147]
buffer_load_dwordx4 a[8:11], v2, s[40:43], s35 offen offset:1024 sc1
v_mfma_f32_16x16x32_bf16 v[148:151], a[112:115], a[32:35], v[148:151]
v_mfma_f32_16x16x32_bf16 v[148:151], a[116:119], a[36:39], v[148:151]
v_mfma_f32_16x16x32_bf16 v[172:175], a[116:119], a[44:47], v[172:175]
v_mfma_f32_16x16x32_bf16 v[172:175], a[112:115], a[40:43], v[172:175]
v_mfma_f32_16x16x32_bf16 v[196:199], a[112:115], a[48:51], v[196:199]
buffer_load_dwordx4 a[12:15], v2, s[40:43], s33 offen offset:1024 sc1
v_mfma_f32_16x16x32_bf16 v[196:199], a[116:119], a[52:55], v[196:199]
v_mfma_f32_16x16x32_bf16 v[220:223], a[116:119], a[60:63], v[220:223]
v_mfma_f32_16x16x32_bf16 v[220:223], a[112:115], a[56:59], v[220:223]
s_waitcnt lgkmcnt(0)
v_mfma_f32_16x16x32_bf16 v[224:227], a[128:131], a[56:59], v[224:227]
ds_read_b128 a[96:99], v5 offset:14336
v_mfma_f32_16x16x32_bf16 v[224:227], a[132:135], a[60:63], v[224:227]
buffer_load_dwordx4 a[16:19], v2, s[40:43], s35 offen offset:2048 sc1
v_mfma_f32_16x16x32_bf16 v[200:203], a[132:135], a[52:55], v[200:203]
ds_read_b128 a[100:103], v5 offset:20480
v_mfma_f32_16x16x32_bf16 v[200:203], a[128:131], a[48:51], v[200:203]
v_mfma_f32_16x16x32_bf16 v[176:179], a[128:131], a[40:43], v[176:179]
v_mfma_f32_16x16x32_bf16 v[176:179], a[132:135], a[44:47], v[176:179]
buffer_load_dwordx4 v[100:103], v1, s[4:7], s88 offen offset:2048 sc1
v_mfma_f32_16x16x32_bf16 v[152:155], a[132:135], a[36:39], v[152:155]
ds_read_b128 a[104:107], v5 offset:15360
v_mfma_f32_16x16x32_bf16 v[152:155], a[128:131], a[32:35], v[152:155]
v_mfma_f32_16x16x32_bf16 v[132:135], a[136:139], a[32:35], v[132:135]
ds_read_b128 a[108:111], v5 offset:21504
v_mfma_f32_16x16x32_bf16 v[132:135], a[140:143], a[36:39], v[132:135]
buffer_load_dwordx4 a[20:23], v2, s[40:43], s33 offen offset:2048 sc1
v_mfma_f32_16x16x32_bf16 v[156:159], a[140:143], a[44:47], v[156:159]
ds_read_b128 a[112:115], v5 offset:16384
v_mfma_f32_16x16x32_bf16 v[156:159], a[136:139], a[40:43], v[156:159]
v_mfma_f32_16x16x32_bf16 v[180:183], a[136:139], a[48:51], v[180:183]
v_mfma_f32_16x16x32_bf16 v[180:183], a[140:143], a[52:55], v[180:183]
buffer_load_dwordx4 a[24:27], v2, s[40:43], s35 offen offset:3072 sc1
v_mfma_f32_16x16x32_bf16 v[204:207], a[140:143], a[60:63], v[204:207]
ds_read_b128 a[116:119], v5 offset:22528
v_mfma_f32_16x16x32_bf16 v[204:207], a[136:139], a[56:59], v[204:207]
v_mfma_f32_16x16x32_bf16 v[208:211], a[144:147], a[56:59], v[208:211]
v_mfma_f32_16x16x32_bf16 v[208:211], a[148:151], a[60:63], v[208:211]
buffer_load_dwordx4 v[104:107], v1, s[4:7], s88 offen offset:3072 sc1
s_add_u32 s88, s88, 4096
v_mfma_f32_16x16x32_bf16 v[184:187], a[148:151], a[52:55], v[184:187]
v_mfma_f32_16x16x32_bf16 v[184:187], a[144:147], a[48:51], v[184:187]
v_mfma_f32_16x16x32_bf16 v[160:163], a[144:147], a[40:43], v[160:163]
v_mfma_f32_16x16x32_bf16 v[160:163], a[148:151], a[44:47], v[160:163]
buffer_load_dwordx4 a[28:31], v2, s[40:43], s33 offen offset:3072 sc1
s_add_u32 s35, s35, 0x4000
v_mfma_f32_16x16x32_bf16 v[136:139], a[148:151], a[36:39], v[136:139]
s_add_u32 s33, s33, 0x4000
v_mfma_f32_16x16x32_bf16 v[136:139], a[144:147], a[32:35], v[136:139]
s_waitcnt vmcnt(11) lgkmcnt(0)
v_mfma_f32_16x16x32_bf16 v[140:143], a[96:99], a[64:67], v[140:143]
ds_read_b128 a[128:131], v5 offset:17408
v_mfma_f32_16x16x32_bf16 v[140:143], a[100:103], a[68:71], v[140:143]
buffer_load_dwordx4 a[32:35], v2, s[40:43], s35 offen offset:0 sc1
v_mfma_f32_16x16x32_bf16 v[164:167], a[100:103], a[76:79], v[164:167]
ds_read_b128 a[132:135], v5 offset:23552
v_mfma_f32_16x16x32_bf16 v[164:167], a[96:99], a[72:75], v[164:167]
v_mfma_f32_16x16x32_bf16 v[188:191], a[96:99], a[80:83], v[188:191]
v_mfma_f32_16x16x32_bf16 v[188:191], a[100:103], a[84:87], v[188:191]
buffer_load_dwordx4 a[36:39], v2, s[40:43], s33 offen offset:0 sc1
v_mfma_f32_16x16x32_bf16 v[212:215], a[100:103], a[92:95], v[212:215]
ds_read_b128 a[136:139], v5 offset:12288
v_mfma_f32_16x16x32_bf16 v[212:215], a[96:99], a[88:91], v[212:215]
v_mfma_f32_16x16x32_bf16 v[216:219], a[104:107], a[88:91], v[216:219]
ds_read_b128 a[140:143], v5 offset:18432
v_mfma_f32_16x16x32_bf16 v[216:219], a[108:111], a[92:95], v[216:219]
v_mfma_f32_16x16x32_bf16 v[192:195], a[108:111], a[84:87], v[192:195]
buffer_load_dwordx4 v[108:111], v1, s[4:7], s88 offen offset:0 sc1
v_mfma_f32_16x16x32_bf16 v[192:195], a[104:107], a[80:83], v[192:195]
ds_read_b128 a[144:147], v5 offset:13312
v_mfma_f32_16x16x32_bf16 v[168:171], a[104:107], a[72:75], v[168:171]
v_mfma_f32_16x16x32_bf16 v[168:171], a[108:111], a[76:79], v[168:171]
ds_read_b128 a[148:151], v5 offset:19456
v_mfma_f32_16x16x32_bf16 v[144:147], a[108:111], a[68:71], v[144:147]
v_mfma_f32_16x16x32_bf16 v[144:147], a[104:107], a[64:67], v[144:147]
buffer_load_dwordx4 a[40:43], v2, s[40:43], s35 offen offset:1024 sc1
v_mfma_f32_16x16x32_bf16 v[148:151], a[112:115], a[64:67], v[148:151]
v_mfma_f32_16x16x32_bf16 v[148:151], a[116:119], a[68:71], v[148:151]
v_mfma_f32_16x16x32_bf16 v[172:175], a[116:119], a[76:79], v[172:175]
v_mfma_f32_16x16x32_bf16 v[172:175], a[112:115], a[72:75], v[172:175]
v_mfma_f32_16x16x32_bf16 v[196:199], a[112:115], a[80:83], v[196:199]
buffer_load_dwordx4 a[44:47], v2, s[40:43], s33 offen offset:1024 sc1
v_mfma_f32_16x16x32_bf16 v[196:199], a[116:119], a[84:87], v[196:199]
v_mfma_f32_16x16x32_bf16 v[220:223], a[116:119], a[92:95], v[220:223]
v_mfma_f32_16x16x32_bf16 v[220:223], a[112:115], a[88:91], v[220:223]
s_waitcnt lgkmcnt(0)
v_mfma_f32_16x16x32_bf16 v[224:227], a[128:131], a[88:91], v[224:227]
ds_read_b128 a[96:99], v5 offset:26624
v_mfma_f32_16x16x32_bf16 v[224:227], a[132:135], a[92:95], v[224:227]
buffer_load_dwordx4 a[48:51], v2, s[40:43], s35 offen offset:2048 sc1
v_mfma_f32_16x16x32_bf16 v[200:203], a[132:135], a[84:87], v[200:203]
ds_read_b128 a[100:103], v5 offset:32768
v_mfma_f32_16x16x32_bf16 v[200:203], a[128:131], a[80:83], v[200:203]
v_mfma_f32_16x16x32_bf16 v[176:179], a[128:131], a[72:75], v[176:179]
v_mfma_f32_16x16x32_bf16 v[176:179], a[132:135], a[76:79], v[176:179]
buffer_load_dwordx4 a[52:55], v2, s[40:43], s33 offen offset:2048 sc1
v_mfma_f32_16x16x32_bf16 v[152:155], a[132:135], a[68:71], v[152:155]
ds_read_b128 a[104:107], v5 offset:27648
v_mfma_f32_16x16x32_bf16 v[152:155], a[128:131], a[64:67], v[152:155]
v_mfma_f32_16x16x32_bf16 v[132:135], a[136:139], a[64:67], v[132:135]
ds_read_b128 a[108:111], v5 offset:33792
v_mfma_f32_16x16x32_bf16 v[132:135], a[140:143], a[68:71], v[132:135]
v_mfma_f32_16x16x32_bf16 v[156:159], a[140:143], a[76:79], v[156:159]
buffer_load_dwordx4 v[112:115], v1, s[4:7], s88 offen offset:1024 sc1
v_mfma_f32_16x16x32_bf16 v[156:159], a[136:139], a[72:75], v[156:159]
ds_read_b128 a[112:115], v5 offset:28672
v_mfma_f32_16x16x32_bf16 v[180:183], a[136:139], a[80:83], v[180:183]
v_mfma_f32_16x16x32_bf16 v[180:183], a[140:143], a[84:87], v[180:183]
ds_read_b128 a[116:119], v5 offset:34816
v_mfma_f32_16x16x32_bf16 v[204:207], a[140:143], a[92:95], v[204:207]
v_mfma_f32_16x16x32_bf16 v[204:207], a[136:139], a[88:91], v[204:207]
buffer_load_dwordx4 a[56:59], v2, s[40:43], s35 offen offset:3072 sc1
v_mfma_f32_16x16x32_bf16 v[208:211], a[144:147], a[88:91], v[208:211]
v_mfma_f32_16x16x32_bf16 v[208:211], a[148:151], a[92:95], v[208:211]
v_mfma_f32_16x16x32_bf16 v[184:187], a[148:151], a[84:87], v[184:187]
v_mfma_f32_16x16x32_bf16 v[184:187], a[144:147], a[80:83], v[184:187]
v_mfma_f32_16x16x32_bf16 v[160:163], a[144:147], a[72:75], v[160:163]
buffer_load_dwordx4 a[60:63], v2, s[40:43], s33 offen offset:3072 sc1
s_add_u32 s35, s35, 0x64000
v_mfma_f32_16x16x32_bf16 v[160:163], a[148:151], a[76:79], v[160:163]
s_add_u32 s33, s33, 0x64000
v_mfma_f32_16x16x32_bf16 v[136:139], a[148:151], a[68:71], v[136:139]
v_mfma_f32_16x16x32_bf16 v[136:139], a[144:147], a[64:67], v[136:139]
s_waitcnt vmcnt(10) lgkmcnt(0)
v_mfma_f32_16x16x32_bf16 v[140:143], a[96:99], a[0:3], v[140:143]
ds_read_b128 a[128:131], v5 offset:29696
v_mfma_f32_16x16x32_bf16 v[140:143], a[100:103], a[4:7], v[140:143]
buffer_load_dwordx4 a[64:67], v2, s[40:43], s35 offen offset:0 sc1
v_mfma_f32_16x16x32_bf16 v[164:167], a[100:103], a[12:15], v[164:167]
ds_read_b128 a[132:135], v5 offset:35840
v_mfma_f32_16x16x32_bf16 v[164:167], a[96:99], a[8:11], v[164:167]
v_mfma_f32_16x16x32_bf16 v[188:191], a[96:99], a[16:19], v[188:191]
v_mfma_f32_16x16x32_bf16 v[188:191], a[100:103], a[20:23], v[188:191]
buffer_load_dwordx4 a[68:71], v2, s[40:43], s33 offen offset:0 sc1
v_mfma_f32_16x16x32_bf16 v[212:215], a[100:103], a[28:31], v[212:215]
ds_read_b128 a[136:139], v5 offset:24576
v_mfma_f32_16x16x32_bf16 v[212:215], a[96:99], a[24:27], v[212:215]
v_mfma_f32_16x16x32_bf16 v[216:219], a[104:107], a[24:27], v[216:219]
ds_read_b128 a[140:143], v5 offset:30720
v_mfma_f32_16x16x32_bf16 v[216:219], a[108:111], a[28:31], v[216:219]
v_mfma_f32_16x16x32_bf16 v[192:195], a[108:111], a[20:23], v[192:195]
buffer_load_dwordx4 v[116:119], v1, s[4:7], s88 offen offset:2048 sc1
v_mfma_f32_16x16x32_bf16 v[192:195], a[104:107], a[16:19], v[192:195]
ds_read_b128 a[144:147], v5 offset:25600
v_mfma_f32_16x16x32_bf16 v[168:171], a[104:107], a[8:11], v[168:171]
v_mfma_f32_16x16x32_bf16 v[168:171], a[108:111], a[12:15], v[168:171]
ds_read_b128 a[148:151], v5 offset:31744
v_mfma_f32_16x16x32_bf16 v[144:147], a[108:111], a[4:7], v[144:147]
v_mfma_f32_16x16x32_bf16 v[144:147], a[104:107], a[0:3], v[144:147]
buffer_load_dwordx4 a[72:75], v2, s[40:43], s35 offen offset:1024 sc1
v_mfma_f32_16x16x32_bf16 v[148:151], a[112:115], a[0:3], v[148:151]
v_mfma_f32_16x16x32_bf16 v[148:151], a[116:119], a[4:7], v[148:151]
v_mfma_f32_16x16x32_bf16 v[172:175], a[116:119], a[12:15], v[172:175]
v_mfma_f32_16x16x32_bf16 v[172:175], a[112:115], a[8:11], v[172:175]
v_mfma_f32_16x16x32_bf16 v[196:199], a[112:115], a[16:19], v[196:199]
buffer_load_dwordx4 a[76:79], v2, s[40:43], s33 offen offset:1024 sc1
v_mfma_f32_16x16x32_bf16 v[196:199], a[116:119], a[20:23], v[196:199]
v_mfma_f32_16x16x32_bf16 v[220:223], a[116:119], a[28:31], v[220:223]
v_mfma_f32_16x16x32_bf16 v[220:223], a[112:115], a[24:27], v[220:223]
s_waitcnt lgkmcnt(0)
v_mfma_f32_16x16x32_bf16 v[224:227], a[128:131], a[24:27], v[224:227]
ds_read_b128 a[96:99], v5 offset:38912
v_mfma_f32_16x16x32_bf16 v[224:227], a[132:135], a[28:31], v[224:227]
buffer_load_dwordx4 a[80:83], v2, s[40:43], s35 offen offset:2048 sc1
v_mfma_f32_16x16x32_bf16 v[200:203], a[132:135], a[20:23], v[200:203]
ds_read_b128 a[100:103], v5 offset:45056
v_mfma_f32_16x16x32_bf16 v[200:203], a[128:131], a[16:19], v[200:203]
v_mfma_f32_16x16x32_bf16 v[176:179], a[128:131], a[8:11], v[176:179]
v_mfma_f32_16x16x32_bf16 v[176:179], a[132:135], a[12:15], v[176:179]
buffer_load_dwordx4 a[84:87], v2, s[40:43], s33 offen offset:2048 sc1
v_mfma_f32_16x16x32_bf16 v[152:155], a[132:135], a[4:7], v[152:155]
ds_read_b128 a[104:107], v5 offset:39936
v_mfma_f32_16x16x32_bf16 v[152:155], a[128:131], a[0:3], v[152:155]
v_mfma_f32_16x16x32_bf16 v[132:135], a[136:139], a[0:3], v[132:135]
ds_read_b128 a[108:111], v5 offset:46080
v_mfma_f32_16x16x32_bf16 v[132:135], a[140:143], a[4:7], v[132:135]
v_mfma_f32_16x16x32_bf16 v[156:159], a[140:143], a[12:15], v[156:159]
buffer_load_dwordx4 v[120:123], v1, s[4:7], s88 offen offset:3072 sc1
s_add_u32 m0, s18, 0x0
v_mfma_f32_16x16x32_bf16 v[156:159], a[136:139], a[8:11], v[156:159]
s_add_u32 s44, s50, 0x2824000
ds_read_b128 a[112:115], v5 offset:40960
v_mfma_f32_16x16x32_bf16 v[180:183], a[136:139], a[16:19], v[180:183]
v_mfma_f32_16x16x32_bf16 v[180:183], a[140:143], a[20:23], v[180:183]
ds_read_b128 a[116:119], v5 offset:47104
v_mfma_f32_16x16x32_bf16 v[204:207], a[140:143], a[28:31], v[204:207]
v_mfma_f32_16x16x32_bf16 v[204:207], a[136:139], a[24:27], v[204:207]
buffer_load_dwordx4 a[88:91], v2, s[40:43], s35 offen offset:3072 sc1
v_mfma_f32_16x16x32_bf16 v[208:211], a[144:147], a[24:27], v[208:211]
v_mfma_f32_16x16x32_bf16 v[208:211], a[148:151], a[28:31], v[208:211]
v_mfma_f32_16x16x32_bf16 v[184:187], a[148:151], a[20:23], v[184:187]
v_mfma_f32_16x16x32_bf16 v[184:187], a[144:147], a[16:19], v[184:187]
v_mfma_f32_16x16x32_bf16 v[160:163], a[144:147], a[8:11], v[160:163]
buffer_load_dwordx4 a[92:95], v2, s[40:43], s33 offen offset:3072 sc1
s_add_u32 s35, s35, 0x4000
v_mfma_f32_16x16x32_bf16 v[160:163], a[148:151], a[12:15], v[160:163]
s_add_u32 s33, s33, 0x4000
v_mfma_f32_16x16x32_bf16 v[136:139], a[148:151], a[4:7], v[136:139]
v_mfma_f32_16x16x32_bf16 v[136:139], a[144:147], a[0:3], v[136:139]
s_waitcnt vmcnt(10) lgkmcnt(0)
v_mfma_f32_16x16x32_bf16 v[140:143], a[96:99], a[32:35], v[140:143]
ds_read_b128 a[128:131], v5 offset:41984
v_mfma_f32_16x16x32_bf16 v[140:143], a[100:103], a[36:39], v[140:143]
buffer_load_dwordx4 a[0:3], v2, s[40:43], s35 offen offset:0 sc1
v_mfma_f32_16x16x32_bf16 v[164:167], a[100:103], a[44:47], v[164:167]
ds_read_b128 a[132:135], v5 offset:48128
v_mfma_f32_16x16x32_bf16 v[164:167], a[96:99], a[40:43], v[164:167]
v_mfma_f32_16x16x32_bf16 v[188:191], a[96:99], a[48:51], v[188:191]
v_mfma_f32_16x16x32_bf16 v[188:191], a[100:103], a[52:55], v[188:191]
buffer_load_dwordx4 v1, s[4:7], s44 offen offset:0 sc1 lds
v_mfma_f32_16x16x32_bf16 v[212:215], a[100:103], a[60:63], v[212:215]
ds_read_b128 a[136:139], v5 offset:36864
v_mfma_f32_16x16x32_bf16 v[212:215], a[96:99], a[56:59], v[212:215]
v_mfma_f32_16x16x32_bf16 v[216:219], a[104:107], a[56:59], v[216:219]
ds_read_b128 a[140:143], v5 offset:43008
v_mfma_f32_16x16x32_bf16 v[216:219], a[108:111], a[60:63], v[216:219]
buffer_load_dwordx4 a[4:7], v2, s[40:43], s33 offen offset:0 sc1
v_mfma_f32_16x16x32_bf16 v[192:195], a[108:111], a[52:55], v[192:195]
ds_read_b128 a[144:147], v5 offset:37888
v_mfma_f32_16x16x32_bf16 v[192:195], a[104:107], a[48:51], v[192:195]
v_mfma_f32_16x16x32_bf16 v[168:171], a[104:107], a[40:43], v[168:171]
v_mfma_f32_16x16x32_bf16 v[168:171], a[108:111], a[44:47], v[168:171]
buffer_load_dwordx4 a[8:11], v2, s[40:43], s35 offen offset:1024 sc1
v_mfma_f32_16x16x32_bf16 v[144:147], a[108:111], a[36:39], v[144:147]
ds_read_b128 a[148:151], v5 offset:44032
v_mfma_f32_16x16x32_bf16 v[144:147], a[104:107], a[32:35], v[144:147]
v_mfma_f32_16x16x32_bf16 v[148:151], a[112:115], a[32:35], v[148:151]
v_mfma_f32_16x16x32_bf16 v[148:151], a[116:119], a[36:39], v[148:151]
buffer_load_dwordx4 v1, s[4:7], s44 offen offset:1024 sc1 lds
s_add_u32 m0, s18, 0x2000
v_mfma_f32_16x16x32_bf16 v[172:175], a[116:119], a[44:47], v[172:175]
s_add_u32 s44, s50, 0x2826000
v_mfma_f32_16x16x32_bf16 v[172:175], a[112:115], a[40:43], v[172:175]
v_mfma_f32_16x16x32_bf16 v[196:199], a[112:115], a[48:51], v[196:199]
v_mfma_f32_16x16x32_bf16 v[196:199], a[116:119], a[52:55], v[196:199]
buffer_load_dwordx4 a[12:15], v2, s[40:43], s33 offen offset:1024 sc1
v_mfma_f32_16x16x32_bf16 v[220:223], a[116:119], a[60:63], v[220:223]
v_mfma_f32_16x16x32_bf16 v[220:223], a[112:115], a[56:59], v[220:223]
s_waitcnt lgkmcnt(0)
s_barrier
v_mfma_f32_16x16x32_bf16 v[224:227], a[128:131], a[56:59], v[224:227]
v_add_u32 v5, 98304, v1
v_mfma_f32_16x16x32_bf16 v[224:227], a[132:135], a[60:63], v[224:227]
buffer_load_dwordx4 a[16:19], v2, s[40:43], s35 offen offset:2048 sc1
v_mfma_f32_16x16x32_bf16 v[200:203], a[132:135], a[52:55], v[200:203]
ds_read_b128 a[96:99], v5 offset:2048
v_mfma_f32_16x16x32_bf16 v[200:203], a[128:131], a[48:51], v[200:203]
ds_read_b128 a[100:103], v5 offset:8192
v_mfma_f32_16x16x32_bf16 v[176:179], a[128:131], a[40:43], v[176:179]
v_mfma_f32_16x16x32_bf16 v[176:179], a[132:135], a[44:47], v[176:179]
buffer_load_dwordx4 a[20:23], v2, s[40:43], s33 offen offset:2048 sc1
v_mfma_f32_16x16x32_bf16 v[152:155], a[132:135], a[36:39], v[152:155]
ds_read_b128 a[104:107], v5 offset:3072
v_mfma_f32_16x16x32_bf16 v[152:155], a[128:131], a[32:35], v[152:155]
v_mfma_f32_16x16x32_bf16 v[132:135], a[136:139], a[32:35], v[132:135]
ds_read_b128 a[108:111], v5 offset:9216
v_mfma_f32_16x16x32_bf16 v[132:135], a[140:143], a[36:39], v[132:135]
v_mfma_f32_16x16x32_bf16 v[156:159], a[140:143], a[44:47], v[156:159]
buffer_load_dwordx4 v1, s[4:7], s44 offen offset:0 sc1 lds
v_mfma_f32_16x16x32_bf16 v[156:159], a[136:139], a[40:43], v[156:159]
ds_read_b128 a[112:115], v5 offset:4096
v_mfma_f32_16x16x32_bf16 v[180:183], a[136:139], a[48:51], v[180:183]
v_mfma_f32_16x16x32_bf16 v[180:183], a[140:143], a[52:55], v[180:183]
ds_read_b128 a[116:119], v5 offset:10240
v_mfma_f32_16x16x32_bf16 v[204:207], a[140:143], a[60:63], v[204:207]
v_mfma_f32_16x16x32_bf16 v[204:207], a[136:139], a[56:59], v[204:207]
buffer_load_dwordx4 a[24:27], v2, s[40:43], s35 offen offset:3072 sc1
v_mfma_f32_16x16x32_bf16 v[208:211], a[144:147], a[56:59], v[208:211]
v_mfma_f32_16x16x32_bf16 v[208:211], a[148:151], a[60:63], v[208:211]
v_mfma_f32_16x16x32_bf16 v[184:187], a[148:151], a[52:55], v[184:187]
v_mfma_f32_16x16x32_bf16 v[184:187], a[144:147], a[48:51], v[184:187]
v_mfma_f32_16x16x32_bf16 v[160:163], a[144:147], a[40:43], v[160:163]
buffer_load_dwordx4 a[28:31], v2, s[40:43], s33 offen offset:3072 sc1
s_add_u32 s35, s35, 0x4000
v_mfma_f32_16x16x32_bf16 v[160:163], a[148:151], a[44:47], v[160:163]
s_add_u32 s33, s33, 0x4000
v_mfma_f32_16x16x32_bf16 v[136:139], a[148:151], a[36:39], v[136:139]
v_mfma_f32_16x16x32_bf16 v[136:139], a[144:147], a[32:35], v[136:139]
s_waitcnt vmcnt(11) lgkmcnt(0)
v_mfma_f32_16x16x32_bf16 v[140:143], a[96:99], a[64:67], v[140:143]
ds_read_b128 a[128:131], v5 offset:5120
v_mfma_f32_16x16x32_bf16 v[140:143], a[100:103], a[68:71], v[140:143]
buffer_load_dwordx4 a[32:35], v2, s[40:43], s35 offen offset:0 sc1
v_mfma_f32_16x16x32_bf16 v[164:167], a[100:103], a[76:79], v[164:167]
ds_read_b128 a[132:135], v5 offset:11264
v_mfma_f32_16x16x32_bf16 v[164:167], a[96:99], a[72:75], v[164:167]
v_mfma_f32_16x16x32_bf16 v[188:191], a[96:99], a[80:83], v[188:191]
v_mfma_f32_16x16x32_bf16 v[188:191], a[100:103], a[84:87], v[188:191]
buffer_load_dwordx4 a[36:39], v2, s[40:43], s33 offen offset:0 sc1
v_mfma_f32_16x16x32_bf16 v[212:215], a[100:103], a[92:95], v[212:215]
ds_read_b128 a[136:139], v5 offset:0
v_mfma_f32_16x16x32_bf16 v[212:215], a[96:99], a[88:91], v[212:215]
v_mfma_f32_16x16x32_bf16 v[216:219], a[104:107], a[88:91], v[216:219]
ds_read_b128 a[140:143], v5 offset:6144
v_mfma_f32_16x16x32_bf16 v[216:219], a[108:111], a[92:95], v[216:219]
v_mfma_f32_16x16x32_bf16 v[192:195], a[108:111], a[84:87], v[192:195]
buffer_load_dwordx4 v1, s[4:7], s44 offen offset:1024 sc1 lds
s_add_u32 m0, s18, 0x4000
v_mfma_f32_16x16x32_bf16 v[192:195], a[104:107], a[80:83], v[192:195]
s_add_u32 s44, s50, 0x2828000
ds_read_b128 a[144:147], v5 offset:1024
v_mfma_f32_16x16x32_bf16 v[168:171], a[104:107], a[72:75], v[168:171]
v_mfma_f32_16x16x32_bf16 v[168:171], a[108:111], a[76:79], v[168:171]
ds_read_b128 a[148:151], v5 offset:7168
v_mfma_f32_16x16x32_bf16 v[144:147], a[108:111], a[68:71], v[144:147]
v_mfma_f32_16x16x32_bf16 v[144:147], a[104:107], a[64:67], v[144:147]
buffer_load_dwordx4 a[40:43], v2, s[40:43], s35 offen offset:1024 sc1
v_mfma_f32_16x16x32_bf16 v[148:151], a[112:115], a[64:67], v[148:151]
v_mfma_f32_16x16x32_bf16 v[148:151], a[116:119], a[68:71], v[148:151]
v_mfma_f32_16x16x32_bf16 v[172:175], a[116:119], a[76:79], v[172:175]
v_mfma_f32_16x16x32_bf16 v[172:175], a[112:115], a[72:75], v[172:175]
v_mfma_f32_16x16x32_bf16 v[196:199], a[112:115], a[80:83], v[196:199]
buffer_load_dwordx4 a[44:47], v2, s[40:43], s33 offen offset:1024 sc1
v_mfma_f32_16x16x32_bf16 v[196:199], a[116:119], a[84:87], v[196:199]
v_mfma_f32_16x16x32_bf16 v[220:223], a[116:119], a[92:95], v[220:223]
v_mfma_f32_16x16x32_bf16 v[220:223], a[112:115], a[88:91], v[220:223]
s_waitcnt lgkmcnt(0)
v_mfma_f32_16x16x32_bf16 v[224:227], a[128:131], a[88:91], v[224:227]
ds_read_b128 a[96:99], v5 offset:14336
v_mfma_f32_16x16x32_bf16 v[224:227], a[132:135], a[92:95], v[224:227]
buffer_load_dwordx4 a[48:51], v2, s[40:43], s35 offen offset:2048 sc1
v_mfma_f32_16x16x32_bf16 v[200:203], a[132:135], a[84:87], v[200:203]
ds_read_b128 a[100:103], v5 offset:20480
v_mfma_f32_16x16x32_bf16 v[200:203], a[128:131], a[80:83], v[200:203]
v_mfma_f32_16x16x32_bf16 v[176:179], a[128:131], a[72:75], v[176:179]
v_mfma_f32_16x16x32_bf16 v[176:179], a[132:135], a[76:79], v[176:179]
buffer_load_dwordx4 a[52:55], v2, s[40:43], s33 offen offset:2048 sc1
v_mfma_f32_16x16x32_bf16 v[152:155], a[132:135], a[68:71], v[152:155]
ds_read_b128 a[104:107], v5 offset:15360
v_mfma_f32_16x16x32_bf16 v[152:155], a[128:131], a[64:67], v[152:155]
v_mfma_f32_16x16x32_bf16 v[132:135], a[136:139], a[64:67], v[132:135]
ds_read_b128 a[108:111], v5 offset:21504
v_mfma_f32_16x16x32_bf16 v[132:135], a[140:143], a[68:71], v[132:135]
v_mfma_f32_16x16x32_bf16 v[156:159], a[140:143], a[76:79], v[156:159]
buffer_load_dwordx4 v1, s[4:7], s44 offen offset:0 sc1 lds
v_mfma_f32_16x16x32_bf16 v[156:159], a[136:139], a[72:75], v[156:159]
ds_read_b128 a[112:115], v5 offset:16384
v_mfma_f32_16x16x32_bf16 v[180:183], a[136:139], a[80:83], v[180:183]
v_mfma_f32_16x16x32_bf16 v[180:183], a[140:143], a[84:87], v[180:183]
ds_read_b128 a[116:119], v5 offset:22528
v_mfma_f32_16x16x32_bf16 v[204:207], a[140:143], a[92:95], v[204:207]
v_mfma_f32_16x16x32_bf16 v[204:207], a[136:139], a[88:91], v[204:207]
buffer_load_dwordx4 a[56:59], v2, s[40:43], s35 offen offset:3072 sc1
v_mfma_f32_16x16x32_bf16 v[208:211], a[144:147], a[88:91], v[208:211]
v_mfma_f32_16x16x32_bf16 v[208:211], a[148:151], a[92:95], v[208:211]
v_mfma_f32_16x16x32_bf16 v[184:187], a[148:151], a[84:87], v[184:187]
v_mfma_f32_16x16x32_bf16 v[184:187], a[144:147], a[80:83], v[184:187]
v_mfma_f32_16x16x32_bf16 v[160:163], a[144:147], a[72:75], v[160:163]
buffer_load_dwordx4 a[60:63], v2, s[40:43], s33 offen offset:3072 sc1
s_add_u32 s35, s35, 0x4000
v_mfma_f32_16x16x32_bf16 v[160:163], a[148:151], a[76:79], v[160:163]
s_add_u32 s33, s33, 0x4000
v_mfma_f32_16x16x32_bf16 v[136:139], a[148:151], a[68:71], v[136:139]
v_mfma_f32_16x16x32_bf16 v[136:139], a[144:147], a[64:67], v[136:139]
s_waitcnt vmcnt(10) lgkmcnt(0)
v_mfma_f32_16x16x32_bf16 v[140:143], a[96:99], a[0:3], v[140:143]
ds_read_b128 a[128:131], v5 offset:17408
v_add_f32 v92, v92, v96
v_mfma_f32_16x16x32_bf16 v[140:143], a[100:103], a[4:7], v[140:143]
buffer_load_dwordx4 a[64:67], v2, s[40:43], s35 offen offset:0 sc1
v_mfma_f32_16x16x32_bf16 v[164:167], a[100:103], a[12:15], v[164:167]
ds_read_b128 a[132:135], v5 offset:23552
v_add_f32 v100, v100, v104
v_mfma_f32_16x16x32_bf16 v[164:167], a[96:99], a[8:11], v[164:167]
v_add_f32 v108, v108, v112
v_add_f32 v116, v116, v120
v_mfma_f32_16x16x32_bf16 v[188:191], a[96:99], a[16:19], v[188:191]
v_add_f32 v93, v93, v97
v_add_f32 v101, v101, v105
v_mfma_f32_16x16x32_bf16 v[188:191], a[100:103], a[20:23], v[188:191]
buffer_load_dwordx4 a[68:71], v2, s[40:43], s33 offen offset:0 sc1
v_mfma_f32_16x16x32_bf16 v[212:215], a[100:103], a[28:31], v[212:215]
ds_read_b128 a[136:139], v5 offset:12288
v_add_f32 v109, v109, v113
v_mfma_f32_16x16x32_bf16 v[212:215], a[96:99], a[24:27], v[212:215]
v_add_f32 v117, v117, v121
v_add_f32 v94, v94, v98
v_mfma_f32_16x16x32_bf16 v[216:219], a[104:107], a[24:27], v[216:219]
ds_read_b128 a[140:143], v5 offset:18432
v_add_f32 v102, v102, v106
v_mfma_f32_16x16x32_bf16 v[216:219], a[108:111], a[28:31], v[216:219]
v_add_f32 v110, v110, v114
v_mfma_f32_16x16x32_bf16 v[192:195], a[108:111], a[20:23], v[192:195]
buffer_load_dwordx4 v1, s[4:7], s44 offen offset:1024 sc1 lds
s_add_u32 m0, s18, 0x6000
v_mfma_f32_16x16x32_bf16 v[192:195], a[104:107], a[16:19], v[192:195]
s_add_u32 s44, s50, 0x282a000
ds_read_b128 a[144:147], v5 offset:13312
v_mfma_f32_16x16x32_bf16 v[168:171], a[104:107], a[8:11], v[168:171]
v_add_f32 v118, v118, v122
L_stub16:
s_cbranch_execz L_wret6
v_add_f32 v95, v95, v99
v_mfma_f32_16x16x32_bf16 v[168:171], a[108:111], a[12:15], v[168:171]
ds_read_b128 a[148:151], v5 offset:19456
v_add_f32 v103, v103, v107
v_mfma_f32_16x16x32_bf16 v[144:147], a[108:111], a[4:7], v[144:147]
v_add_f32 v111, v111, v115
v_add_f32 v119, v119, v123
v_mfma_f32_16x16x32_bf16 v[144:147], a[104:107], a[0:3], v[144:147]
buffer_load_dwordx4 a[72:75], v2, s[40:43], s35 offen offset:1024 sc1
v_mfma_f32_16x16x32_bf16 v[148:151], a[112:115], a[0:3], v[148:151]
v_add_f32_dpp v92, v92, v92 row_ror:8 row_mask:0xf bank_mask:0xf
v_add_f32_dpp v100, v100, v100 row_ror:8 row_mask:0xf bank_mask:0xf
v_mfma_f32_16x16x32_bf16 v[148:151], a[116:119], a[4:7], v[148:151]
v_add_f32_dpp v108, v108, v108 row_ror:8 row_mask:0xf bank_mask:0xf
v_mfma_f32_16x16x32_bf16 v[172:175], a[116:119], a[12:15], v[172:175]
v_add_f32_dpp v116, v116, v116 row_ror:8 row_mask:0xf bank_mask:0xf
v_mfma_f32_16x16x32_bf16 v[172:175], a[112:115], a[8:11], v[172:175]
v_add_f32_dpp v93, v93, v93 row_ror:8 row_mask:0xf bank_mask:0xf
v_mfma_f32_16x16x32_bf16 v[196:199], a[112:115], a[16:19], v[196:199]
buffer_load_dwordx4 a[76:79], v2, s[40:43], s33 offen offset:1024 sc1
v_mfma_f32_16x16x32_bf16 v[196:199], a[116:119], a[20:23], v[196:199]
v_add_f32_dpp v101, v101, v101 row_ror:8 row_mask:0xf bank_mask:0xf
v_add_f32_dpp v109, v109, v109 row_ror:8 row_mask:0xf bank_mask:0xf
v_mfma_f32_16x16x32_bf16 v[220:223], a[116:119], a[28:31], v[220:223]
v_add_f32_dpp v117, v117, v117 row_ror:8 row_mask:0xf bank_mask:0xf
v_mfma_f32_16x16x32_bf16 v[220:223], a[112:115], a[24:27], v[220:223]
v_add_f32_dpp v92, v94, v94 row_ror:8 row_mask:0xf bank_mask:0xc
s_waitcnt lgkmcnt(0)
v_mfma_f32_16x16x32_bf16 v[224:227], a[128:131], a[24:27], v[224:227]
ds_read_b128 a[96:99], v5 offset:26624
v_add_f32_dpp v100, v102, v102 row_ror:8 row_mask:0xf bank_mask:0xc
v_mfma_f32_16x16x32_bf16 v[224:227], a[132:135], a[28:31], v[224:227]
buffer_load_dwordx4 a[80:83], v2, s[40:43], s35 offen offset:2048 sc1
v_mfma_f32_16x16x32_bf16 v[200:203], a[132:135], a[20:23], v[200:203]
ds_read_b128 a[100:103], v5 offset:32768
v_add_f32_dpp v108, v110, v110 row_ror:8 row_mask:0xf bank_mask:0xc
v_mfma_f32_16x16x32_bf16 v[200:203], a[128:131], a[16:19], v[200:203]
v_add_f32_dpp v116, v118, v118 row_ror:8 row_mask:0xf bank_mask:0xc
v_add_f32_dpp v93, v95, v95 row_ror:8 row_mask:0xf bank_mask:0xc
v_mfma_f32_16x16x32_bf16 v[176:179], a[128:131], a[8:11], v[176:179]
v_add_f32_dpp v101, v103, v103 row_ror:8 row_mask:0xf bank_mask:0xc
v_add_f32_dpp v109, v111, v111 row_ror:8 row_mask:0xf bank_mask:0xc
v_mfma_f32_16x16x32_bf16 v[176:179], a[132:135], a[12:15], v[176:179]
buffer_load_dwordx4 v1, s[4:7], s44 offen offset:0 sc1 lds
v_mfma_f32_16x16x32_bf16 v[152:155], a[132:135], a[4:7], v[152:155]
ds_read_b128 a[104:107], v5 offset:27648
v_add_f32_dpp v117, v119, v119 row_ror:8 row_mask:0xf bank_mask:0xc
v_mfma_f32_16x16x32_bf16 v[152:155], a[128:131], a[0:3], v[152:155]
v_permlane32_swap_b32 v92, v93
v_mfma_f32_16x16x32_bf16 v[132:135], a[136:139], a[0:3], v[132:135]
ds_read_b128 a[108:111], v5 offset:33792
v_mfma_f32_16x16x32_bf16 v[132:135], a[140:143], a[4:7], v[132:135]
buffer_load_dwordx4 a[84:87], v2, s[40:43], s33 offen offset:2048 sc1
v_mfma_f32_16x16x32_bf16 v[156:159], a[140:143], a[12:15], v[156:159]
ds_read_b128 a[112:115], v5 offset:28672
v_mfma_f32_16x16x32_bf16 v[156:159], a[136:139], a[8:11], v[156:159]
v_permlane32_swap_b32 v100, v101
v_mfma_f32_16x16x32_bf16 v[180:183], a[136:139], a[16:19], v[180:183]
v_permlane32_swap_b32 v108, v109
v_mfma_f32_16x16x32_bf16 v[180:183], a[140:143], a[20:23], v[180:183]
buffer_load_dwordx4 a[88:91], v2, s[40:43], s35 offen offset:3072 sc1
v_mfma_f32_16x16x32_bf16 v[204:207], a[140:143], a[28:31], v[204:207]
ds_read_b128 a[116:119], v5 offset:34816
v_mfma_f32_16x16x32_bf16 v[204:207], a[136:139], a[24:27], v[204:207]
v_permlane32_swap_b32 v116, v117
v_mfma_f32_16x16x32_bf16 v[208:211], a[144:147], a[24:27], v[208:211]
v_add_f32 v92, v92, v93
v_add_f32 v100, v100, v101
v_mfma_f32_16x16x32_bf16 v[208:211], a[148:151], a[28:31], v[208:211]
buffer_load_dwordx4 v1, s[4:7], s44 offen offset:1024 sc1 lds
s_add_u32 m0, s18, 0x8000
v_mfma_f32_16x16x32_bf16 v[184:187], a[148:151], a[20:23], v[184:187]
s_add_u32 s44, s50, 0x282c000
v_add_f32 v108, v108, v109
v_mfma_f32_16x16x32_bf16 v[184:187], a[144:147], a[16:19], v[184:187]
v_add_f32 v116, v116, v117
v_mov_b32 v94, v92
v_mfma_f32_16x16x32_bf16 v[160:163], a[144:147], a[8:11], v[160:163]
v_mov_b32 v102, v100
v_mov_b32 v110, v108
v_mfma_f32_16x16x32_bf16 v[160:163], a[148:151], a[12:15], v[160:163]
buffer_load_dwordx4 a[92:95], v2, s[40:43], s33 offen offset:3072 sc1
s_add_u32 s35, s35, 0x4000
v_mfma_f32_16x16x32_bf16 v[136:139], a[148:151], a[4:7], v[136:139]
s_add_u32 s33, s33, 0x4000
v_mov_b32 v118, v116
v_mfma_f32_16x16x32_bf16 v[136:139], a[144:147], a[0:3], v[136:139]
s_waitcnt vmcnt(11) lgkmcnt(0)
v_mfma_f32_16x16x32_bf16 v[140:143], a[96:99], a[32:35], v[140:143]
ds_read_b128 a[128:131], v5 offset:29696
v_mfma_f32_16x16x32_bf16 v[140:143], a[100:103], a[36:39], v[140:143]
buffer_load_dwordx4 a[0:3], v2, s[40:43], s35 offen offset:0 sc1
v_mfma_f32_16x16x32_bf16 v[164:167], a[100:103], a[44:47], v[164:167]
ds_read_b128 a[132:135], v5 offset:35840
v_mfma_f32_16x16x32_bf16 v[164:167], a[96:99], a[40:43], v[164:167]
v_permlane16_swap_b32 v92, v94
v_mfma_f32_16x16x32_bf16 v[188:191], a[96:99], a[48:51], v[188:191]
v_permlane16_swap_b32 v100, v102
v_mfma_f32_16x16x32_bf16 v[188:191], a[100:103], a[52:55], v[188:191]
buffer_load_dwordx4 a[4:7], v2, s[40:43], s33 offen offset:0 sc1
v_mfma_f32_16x16x32_bf16 v[212:215], a[100:103], a[60:63], v[212:215]
ds_read_b128 a[136:139], v5 offset:24576
v_mfma_f32_16x16x32_bf16 v[212:215], a[96:99], a[56:59], v[212:215]
v_permlane16_swap_b32 v108, v110
v_mfma_f32_16x16x32_bf16 v[216:219], a[104:107], a[56:59], v[216:219]
ds_read_b128 a[140:143], v5 offset:30720
v_mfma_f32_16x16x32_bf16 v[216:219], a[108:111], a[60:63], v[216:219]
v_permlane16_swap_b32 v116, v118
v_mfma_f32_16x16x32_bf16 v[192:195], a[108:111], a[52:55], v[192:195]
buffer_load_dwordx4 v1, s[4:7], s44 offen offset:0 sc1 lds
v_mfma_f32_16x16x32_bf16 v[192:195], a[104:107], a[48:51], v[192:195]
ds_read_b128 a[144:147], v5 offset:25600
v_add_f32 v92, v92, v94
v_mfma_f32_16x16x32_bf16 v[168:171], a[104:107], a[40:43], v[168:171]
v_add_f32 v100, v100, v102
v_add_f32 v108, v108, v110
v_mfma_f32_16x16x32_bf16 v[168:171], a[108:111], a[44:47], v[168:171]
ds_read_b128 a[148:151], v5 offset:31744
v_add_f32 v116, v116, v118
v_mfma_f32_16x16x32_bf16 v[144:147], a[108:111], a[36:39], v[144:147]
v_mov_b32 v94, v92
v_mov_b32 v102, v100
v_mfma_f32_16x16x32_bf16 v[144:147], a[104:107], a[32:35], v[144:147]
buffer_load_dwordx4 a[8:11], v2, s[40:43], s35 offen offset:1024 sc1
v_mfma_f32_16x16x32_bf16 v[148:151], a[112:115], a[32:35], v[148:151]
v_mov_b32 v110, v108
v_mov_b32 v118, v116
v_mfma_f32_16x16x32_bf16 v[148:151], a[116:119], a[36:39], v[148:151]
v_permlane32_swap_b32 v92, v94
v_mfma_f32_16x16x32_bf16 v[172:175], a[116:119], a[44:47], v[172:175]
v_permlane32_swap_b32 v100, v102
v_mfma_f32_16x16x32_bf16 v[172:175], a[112:115], a[40:43], v[172:175]
v_permlane32_swap_b32 v108, v110
v_mfma_f32_16x16x32_bf16 v[196:199], a[112:115], a[48:51], v[196:199]
buffer_load_dwordx4 a[12:15], v2, s[40:43], s33 offen offset:1024 sc1
v_mfma_f32_16x16x32_bf16 v[196:199], a[116:119], a[52:55], v[196:199]
v_permlane32_swap_b32 v116, v118
v_mfma_f32_16x16x32_bf16 v[220:223], a[116:119], a[60:63], v[220:223]
v_mul_f32 v82, 0xba800000, v92
v_mul_f32 v84, 0xba800000, v100
v_mfma_f32_16x16x32_bf16 v[220:223], a[112:115], a[56:59], v[220:223]
v_mul_f32 v86, 0xba800000, v108
s_waitcnt lgkmcnt(0)
v_mfma_f32_16x16x32_bf16 v[224:227], a[128:131], a[56:59], v[224:227]
ds_read_b128 a[96:99], v5 offset:38912
v_mul_f32 v88, 0xba800000, v116
v_mfma_f32_16x16x32_bf16 v[224:227], a[132:135], a[60:63], v[224:227]
buffer_load_dwordx4 a[16:19], v2, s[40:43], s35 offen offset:2048 sc1
v_mfma_f32_16x16x32_bf16 v[200:203], a[132:135], a[52:55], v[200:203]
ds_read_b128 a[100:103], v5 offset:45056
v_mul_f32 v94, 0x3a800000, v94
v_mfma_f32_16x16x32_bf16 v[200:203], a[128:131], a[48:51], v[200:203]
v_mul_f32 v102, 0x3a800000, v102
v_mul_f32 v110, 0x3a800000, v110
v_mfma_f32_16x16x32_bf16 v[176:179], a[128:131], a[40:43], v[176:179]
v_mul_f32 v118, 0x3a800000, v118
v_fma_f32 v94, -v82, v82, v94
v_mfma_f32_16x16x32_bf16 v[176:179], a[132:135], a[44:47], v[176:179]
buffer_load_dwordx4 a[20:23], v2, s[40:43], s33 offen offset:2048 sc1
v_mfma_f32_16x16x32_bf16 v[152:155], a[132:135], a[36:39], v[152:155]
ds_read_b128 a[104:107], v5 offset:39936
v_fma_f32 v102, -v84, v84, v102
v_mfma_f32_16x16x32_bf16 v[152:155], a[128:131], a[32:35], v[152:155]
v_fma_f32 v110, -v86, v86, v110
v_fma_f32 v118, -v88, v88, v118
v_mfma_f32_16x16x32_bf16 v[132:135], a[136:139], a[32:35], v[132:135]
ds_read_b128 a[108:111], v5 offset:46080
v_max_f32 v94, 0, v94
v_mfma_f32_16x16x32_bf16 v[132:135], a[140:143], a[36:39], v[132:135]
v_max_f32 v102, 0, v102
v_mfma_f32_16x16x32_bf16 v[156:159], a[140:143], a[44:47], v[156:159]
buffer_load_dwordx4 v1, s[4:7], s44 offen offset:1024 sc1 lds
s_add_u32 m0, s18, 0xa000
v_mfma_f32_16x16x32_bf16 v[156:159], a[136:139], a[40:43], v[156:159]
s_add_u32 s44, s50, 0x282e000
ds_read_b128 a[112:115], v5 offset:40960
v_mfma_f32_16x16x32_bf16 v[180:183], a[136:139], a[48:51], v[180:183]
v_max_f32 v110, 0, v110
v_max_f32 v118, 0, v118
v_mfma_f32_16x16x32_bf16 v[180:183], a[140:143], a[52:55], v[180:183]
ds_read_b128 a[116:119], v5 offset:47104
v_add_f32 v94, 0x3727c5ac, v94
v_mfma_f32_16x16x32_bf16 v[204:207], a[140:143], a[60:63], v[204:207]
v_add_f32 v102, 0x3727c5ac, v102
v_add_f32 v110, 0x3727c5ac, v110
v_mfma_f32_16x16x32_bf16 v[204:207], a[136:139], a[56:59], v[204:207]
buffer_load_dwordx4 a[24:27], v2, s[40:43], s35 offen offset:3072 sc1
v_mfma_f32_16x16x32_bf16 v[208:211], a[144:147], a[56:59], v[208:211]
v_add_f32 v118, 0x3727c5ac, v118
v_mfma_f32_16x16x32_bf16 v[208:211], a[148:151], a[60:63], v[208:211]
v_rsq_f32 v83, v94
v_mfma_f32_16x16x32_bf16 v[184:187], a[148:151], a[52:55], v[184:187]
v_rsq_f32 v85, v102
v_mfma_f32_16x16x32_bf16 v[184:187], a[144:147], a[48:51], v[184:187]
v_mfma_f32_16x16x32_bf16 v[160:163], a[144:147], a[40:43], v[160:163]
buffer_load_dwordx4 a[28:31], v2, s[40:43], s33 offen offset:3072 sc1
s_add_u32 s35, s35, 0x4000
v_mfma_f32_16x16x32_bf16 v[160:163], a[148:151], a[44:47], v[160:163]
s_add_u32 s33, s33, 0x4000
v_mfma_f32_16x16x32_bf16 v[136:139], a[148:151], a[36:39], v[136:139]
v_rsq_f32 v87, v110
v_mfma_f32_16x16x32_bf16 v[136:139], a[144:147], a[32:35], v[136:139]
s_waitcnt vmcnt(10) lgkmcnt(0)
v_mfma_f32_16x16x32_bf16 v[140:143], a[96:99], a[64:67], v[140:143]
ds_read_b128 a[128:131], v5 offset:41984
v_mfma_f32_16x16x32_bf16 v[140:143], a[100:103], a[68:71], v[140:143]
buffer_load_dwordx4 a[32:35], v2, s[40:43], s35 offen offset:0 sc1
v_mfma_f32_16x16x32_bf16 v[164:167], a[100:103], a[76:79], v[164:167]
ds_read_b128 a[132:135], v5 offset:48128
v_mfma_f32_16x16x32_bf16 v[164:167], a[96:99], a[72:75], v[164:167]
v_rsq_f32 v89, v118
v_mfma_f32_16x16x32_bf16 v[188:191], a[96:99], a[80:83], v[188:191]
v_mfma_f32_16x16x32_bf16 v[188:191], a[100:103], a[84:87], v[188:191]
buffer_load_dwordx4 a[36:39], v2, s[40:43], s33 offen offset:0 sc1
v_mfma_f32_16x16x32_bf16 v[212:215], a[100:103], a[92:95], v[212:215]
ds_read_b128 a[136:139], v5 offset:36864
v_mfma_f32_16x16x32_bf16 v[212:215], a[96:99], a[88:91], v[212:215]
v_mfma_f32_16x16x32_bf16 v[216:219], a[104:107], a[88:91], v[216:219]
ds_read_b128 a[140:143], v5 offset:43008
v_mfma_f32_16x16x32_bf16 v[216:219], a[108:111], a[92:95], v[216:219]
v_mfma_f32_16x16x32_bf16 v[192:195], a[108:111], a[84:87], v[192:195]
buffer_load_dwordx4 v1, s[4:7], s44 offen offset:0 sc1 lds
v_mfma_f32_16x16x32_bf16 v[192:195], a[104:107], a[80:83], v[192:195]
ds_read_b128 a[144:147], v5 offset:37888
v_fmac_f32 v140, v56, v82
v_mfma_f32_16x16x32_bf16 v[168:171], a[104:107], a[72:75], v[168:171]
v_fmac_f32 v164, v56, v84
v_mfma_f32_16x16x32_bf16 v[168:171], a[108:111], a[76:79], v[168:171]
ds_read_b128 a[148:151], v5 offset:44032
v_mfma_f32_16x16x32_bf16 v[144:147], a[108:111], a[68:71], v[144:147]
v_fmac_f32 v188, v56, v86
v_mfma_f32_16x16x32_bf16 v[144:147], a[104:107], a[64:67], v[144:147]
buffer_load_dwordx4 a[40:43], v2, s[40:43], s35 offen offset:1024 sc1
v_mfma_f32_16x16x32_bf16 v[148:151], a[112:115], a[64:67], v[148:151]
v_fmac_f32 v212, v56, v88
v_mfma_f32_16x16x32_bf16 v[148:151], a[116:119], a[68:71], v[148:151]
v_mfma_f32_16x16x32_bf16 v[172:175], a[116:119], a[76:79], v[172:175]
v_fmac_f32 v216, v60, v88
v_mfma_f32_16x16x32_bf16 v[172:175], a[112:115], a[72:75], v[172:175]
v_mfma_f32_16x16x32_bf16 v[196:199], a[112:115], a[80:83], v[196:199]
buffer_load_dwordx4 a[44:47], v2, s[40:43], s33 offen offset:1024 sc1
v_mfma_f32_16x16x32_bf16 v[196:199], a[116:119], a[84:87], v[196:199]
v_fmac_f32 v192, v60, v86
v_mfma_f32_16x16x32_bf16 v[220:223], a[116:119], a[92:95], v[220:223]
v_fmac_f32 v168, v60, v84
v_fmac_f32 v141, v57, v82
v_mfma_f32_16x16x32_bf16 v[220:223], a[112:115], a[88:91], v[220:223]
s_waitcnt lgkmcnt(0)
s_barrier
v_mfma_f32_16x16x32_bf16 v[224:227], a[128:131], a[88:91], v[224:227]
v_add_u32 v5, 0, v1
v_fmac_f32 v144, v60, v82
v_mfma_f32_16x16x32_bf16 v[224:227], a[132:135], a[92:95], v[224:227]
buffer_load_dwordx4 a[48:51], v2, s[40:43], s35 offen offset:2048 sc1
v_mfma_f32_16x16x32_bf16 v[200:203], a[132:135], a[84:87], v[200:203]
ds_read_b128 a[96:99], v5 offset:2048
v_fmac_f32 v148, v64, v82
v_mfma_f32_16x16x32_bf16 v[200:203], a[128:131], a[80:83], v[200:203]
ds_read_b128 a[100:103], v5 offset:8192
v_fmac_f32 v165, v57, v84
v_mfma_f32_16x16x32_bf16 v[176:179], a[128:131], a[72:75], v[176:179]
v_fmac_f32 v172, v64, v84
v_fmac_f32 v189, v57, v86
v_mfma_f32_16x16x32_bf16 v[176:179], a[132:135], a[76:79], v[176:179]
buffer_load_dwordx4 a[52:55], v2, s[40:43], s33 offen offset:2048 sc1
v_mfma_f32_16x16x32_bf16 v[152:155], a[132:135], a[68:71], v[152:155]
ds_read_b128 a[104:107], v5 offset:3072
v_fmac_f32 v196, v64, v86
v_mfma_f32_16x16x32_bf16 v[152:155], a[128:131], a[64:67], v[152:155]
v_fmac_f32 v213, v57, v88
v_fmac_f32 v217, v61, v88
v_mfma_f32_16x16x32_bf16 v[132:135], a[136:139], a[64:67], v[132:135]
ds_read_b128 a[108:111], v5 offset:9216
v_fmac_f32 v220, v64, v88
v_mfma_f32_16x16x32_bf16 v[132:135], a[140:143], a[68:71], v[132:135]
v_fmac_f32 v193, v61, v86
v_mfma_f32_16x16x32_bf16 v[156:159], a[140:143], a[76:79], v[156:159]
buffer_load_dwordx4 v1, s[4:7], s44 offen offset:1024 sc1 lds
s_add_u32 m0, s19, 49152
v_mfma_f32_16x16x32_bf16 v[156:159], a[136:139], a[72:75], v[156:159]
s_xor_b32 s44, s85, 16384
ds_read_b128 a[112:115], v5 offset:4096
v_mfma_f32_16x16x32_bf16 v[180:183], a[136:139], a[80:83], v[180:183]
v_fmac_f32 v224, v68, v88
v_fmac_f32 v200, v68, v86
v_mfma_f32_16x16x32_bf16 v[180:183], a[140:143], a[84:87], v[180:183]
ds_read_b128 a[116:119], v5 offset:10240
v_fmac_f32 v169, v61, v84
v_mfma_f32_16x16x32_bf16 v[204:207], a[140:143], a[92:95], v[204:207]
v_fmac_f32 v176, v68, v84
v_fmac_f32 v145, v61, v82
v_mfma_f32_16x16x32_bf16 v[204:207], a[136:139], a[88:91], v[204:207]
buffer_load_dwordx4 a[56:59], v2, s[40:43], s35 offen offset:3072 sc1
v_mfma_f32_16x16x32_bf16 v[208:211], a[144:147], a[88:91], v[208:211]
v_fmac_f32 v152, v68, v82
v_fmac_f32 v149, v65, v82
v_mfma_f32_16x16x32_bf16 v[208:211], a[148:151], a[92:95], v[208:211]
v_fmac_f32 v173, v65, v84
v_mfma_f32_16x16x32_bf16 v[184:187], a[148:151], a[84:87], v[184:187]
v_fmac_f32 v132, v48, v82
v_fmac_f32 v197, v65, v86
v_mfma_f32_16x16x32_bf16 v[184:187], a[144:147], a[80:83], v[184:187]
v_mfma_f32_16x16x32_bf16 v[160:163], a[144:147], a[72:75], v[160:163]
buffer_load_dwordx4 a[60:63], v2, s[40:43], s33 offen offset:3072 sc1
s_add_u32 s35, s35, 0x4000
v_mfma_f32_16x16x32_bf16 v[160:163], a[148:151], a[76:79], v[160:163]
s_add_u32 s33, s33, 0x4000
v_fmac_f32 v156, v48, v84
v_mfma_f32_16x16x32_bf16 v[136:139], a[148:151], a[68:71], v[136:139]
v_fmac_f32 v180, v48, v86
v_fmac_f32 v221, v65, v88
v_mfma_f32_16x16x32_bf16 v[136:139], a[144:147], a[64:67], v[136:139]
v_fmac_f32 v225, v69, v88
s_waitcnt vmcnt(10) lgkmcnt(0)
v_mfma_f32_16x16x32_bf16 v[140:143], a[96:99], a[0:3], v[140:143]
ds_read_b128 a[128:131], v5 offset:5120
v_fmac_f32 v204, v48, v88
v_mfma_f32_16x16x32_bf16 v[140:143], a[100:103], a[4:7], v[140:143]
buffer_load_dwordx4 a[64:67], v2, s[40:43], s35 offen offset:0 sc1
s_lshl_b32 s36, s28, 9
v_mfma_f32_16x16x32_bf16 v[164:167], a[100:103], a[12:15], v[164:167]
ds_read_b128 a[132:135], v5 offset:11264
v_fmac_f32 v208, v52, v88
v_mfma_f32_16x16x32_bf16 v[164:167], a[96:99], a[8:11], v[164:167]
v_fmac_f32 v201, v69, v86
v_fmac_f32 v177, v69, v84
v_mfma_f32_16x16x32_bf16 v[188:191], a[96:99], a[16:19], v[188:191]
v_fmac_f32 v184, v52, v86
v_fmac_f32 v153, v69, v82
v_mfma_f32_16x16x32_bf16 v[188:191], a[100:103], a[20:23], v[188:191]
buffer_load_dwordx4 a[68:71], v2, s[40:43], s33 offen offset:0 sc1
s_lshl_b32 s37, s30, 2
v_mfma_f32_16x16x32_bf16 v[212:215], a[100:103], a[28:31], v[212:215]
ds_read_b128 a[136:139], v5 offset:0
v_fmac_f32 v160, v52, v84
v_mfma_f32_16x16x32_bf16 v[212:215], a[96:99], a[24:27], v[212:215]
v_fmac_f32 v133, v49, v82
v_add_u32 v232, s19, v7
v_mfma_f32_16x16x32_bf16 v[216:219], a[104:107], a[24:27], v[216:219]
ds_read_b128 a[140:143], v5 offset:6144
v_fmac_f32 v136, v52, v82
v_mfma_f32_16x16x32_bf16 v[216:219], a[108:111], a[28:31], v[216:219]
buffer_load_dwordx4 a[72:75], v2, s[40:43], s35 offen offset:1024 sc1
s_add_u32 s37, s37, s28
v_mfma_f32_16x16x32_bf16 v[192:195], a[108:111], a[20:23], v[192:195]
ds_read_b128 a[144:147], v5 offset:1024
v_fmac_f32 v157, v49, v84
v_mfma_f32_16x16x32_bf16 v[192:195], a[104:107], a[16:19], v[192:195]
v_fmac_f32 v181, v49, v86
v_fmac_f32 v142, v58, v82
v_mfma_f32_16x16x32_bf16 v[168:171], a[104:107], a[8:11], v[168:171]
v_fmac_f32 v205, v49, v88
v_fmac_f32 v166, v58, v84
v_mfma_f32_16x16x32_bf16 v[168:171], a[108:111], a[12:15], v[168:171]
buffer_load_dwordx4 a[76:79], v2, s[40:43], s33 offen offset:1024 sc1
s_lshr_b32 s98, s37, 1
v_mfma_f32_16x16x32_bf16 v[144:147], a[108:111], a[4:7], v[144:147]
ds_read_b128 a[148:151], v5 offset:7168
v_fmac_f32 v209, v53, v88
v_mfma_f32_16x16x32_bf16 v[144:147], a[104:107], a[0:3], v[144:147]
v_fmac_f32 v190, v58, v86
s_lshl_b32 s98, s98, 14
v_mfma_f32_16x16x32_bf16 v[148:151], a[112:115], a[0:3], v[148:151]
v_fmac_f32 v185, v53, v86
v_fmac_f32 v214, v58, v88
v_mfma_f32_16x16x32_bf16 v[148:151], a[116:119], a[4:7], v[148:151]
buffer_load_dwordx4 a[80:83], v2, s[40:43], s35 offen offset:2048 sc1
s_and_b32 s99, s19, 0x1000
v_mfma_f32_16x16x32_bf16 v[172:175], a[116:119], a[12:15], v[172:175]
v_fmac_f32 v161, v53, v84
v_fmac_f32 v218, v62, v88
v_mfma_f32_16x16x32_bf16 v[172:175], a[112:115], a[8:11], v[172:175]
s_add_u32 s98, s98, s99
s_bfe_u32 s90, s51, 0x10005
s_lshl_b32 s90, s90, 13
v_mfma_f32_16x16x32_bf16 v[196:199], a[112:115], a[16:19], v[196:199]
v_fmac_f32 v137, v53, v82
v_fmac_f32 v194, v62, v86
v_mfma_f32_16x16x32_bf16 v[196:199], a[116:119], a[20:23], v[196:199]
buffer_load_dwordx4 a[84:87], v2, s[40:43], s33 offen offset:2048 sc1
s_add_u32 s98, s98, s90
v_mfma_f32_16x16x32_bf16 v[220:223], a[116:119], a[28:31], v[220:223]
v_fmac_f32 v170, v62, v84
v_fmac_f32 v143, v59, v82
v_mfma_f32_16x16x32_bf16 v[220:223], a[112:115], a[24:27], v[220:223]
s_add_u32 s98, s98, 0x1500000
s_waitcnt lgkmcnt(0)
v_mfma_f32_16x16x32_bf16 v[224:227], a[128:131], a[24:27], v[224:227]
ds_read_b128 a[96:99], v5 offset:14336
v_fmac_f32 v146, v62, v82
v_mfma_f32_16x16x32_bf16 v[224:227], a[132:135], a[28:31], v[224:227]
buffer_load_dwordx4 a[88:91], v2, s[40:43], s35 offen offset:3072 sc1
s_xor_b32 s99, s98, 0x2000
v_mfma_f32_16x16x32_bf16 v[200:203], a[132:135], a[20:23], v[200:203]
ds_read_b128 a[100:103], v5 offset:20480
v_fmac_f32 v150, v66, v82
v_mfma_f32_16x16x32_bf16 v[200:203], a[128:131], a[16:19], v[200:203]
v_fmac_f32 v167, v59, v84
v_fmac_f32 v191, v59, v86
v_mfma_f32_16x16x32_bf16 v[176:179], a[128:131], a[8:11], v[176:179]
v_fmac_f32 v174, v66, v84
v_fmac_f32 v215, v59, v88
v_mfma_f32_16x16x32_bf16 v[176:179], a[132:135], a[12:15], v[176:179]
ds_read_b128 a[104:107], v5 offset:15360
s_and_b32 s91, s29, 4
v_mfma_f32_16x16x32_bf16 v[152:155], a[132:135], a[4:7], v[152:155]
v_fmac_f32 v198, v66, v86
v_fmac_f32 v219, v63, v88
v_mfma_f32_16x16x32_bf16 v[152:155], a[128:131], a[0:3], v[152:155]
buffer_load_dwordx4 v1, s[4:7], s44 offen offset:0 sc1 lds
s_lshl_b32 s91, s91, 11
v_mfma_f32_16x16x32_bf16 v[132:135], a[136:139], a[0:3], v[132:135]
ds_read_b128 a[108:111], v5 offset:21504
v_fmac_f32 v222, v66, v88
v_mfma_f32_16x16x32_bf16 v[132:135], a[140:143], a[4:7], v[132:135]
v_fmac_f32 v195, v63, v86
s_xor_b32 s96, s98, s91
v_mfma_f32_16x16x32_bf16 v[156:159], a[140:143], a[12:15], v[156:159]
ds_read_b128 a[112:115], v5 offset:16384
v_fmac_f32 v226, v70, v88
v_mfma_f32_16x16x32_bf16 v[156:159], a[136:139], a[8:11], v[156:159]
v_fmac_f32 v171, v63, v84
s_lshl_b32 s97, s81, 10
v_mfma_f32_16x16x32_bf16 v[180:183], a[136:139], a[16:19], v[180:183]
v_fmac_f32 v202, v70, v86
v_fmac_f32 v147, v63, v82
v_mfma_f32_16x16x32_bf16 v[180:183], a[140:143], a[20:23], v[180:183]
buffer_load_dwordx4 a[92:95], v2, s[40:43], s33 offen offset:3072 sc1
s_add_u32 s35, s35, 0x4000
v_mfma_f32_16x16x32_bf16 v[204:207], a[140:143], a[28:31], v[204:207]
s_add_u32 s33, s33, 0x4000
ds_read_b128 a[116:119], v5 offset:22528
v_mfma_f32_16x16x32_bf16 v[204:207], a[136:139], a[24:27], v[204:207]
v_fmac_f32 v178, v70, v84
v_fmac_f32 v151, v67, v82
v_mfma_f32_16x16x32_bf16 v[208:211], a[144:147], a[24:27], v[208:211]
v_fmac_f32 v154, v70, v82
v_fmac_f32 v175, v67, v84
v_mfma_f32_16x16x32_bf16 v[208:211], a[148:151], a[28:31], v[208:211]
s_add_u32 s96, s96, s97
s_lshr_b32 s100, s37, 4
s_lshl_b32 s100, s100, 14
v_mfma_f32_16x16x32_bf16 v[184:187], a[148:151], a[20:23], v[184:187]
v_fmac_f32 v134, v50, v82
v_fmac_f32 v199, v67, v86
v_mfma_f32_16x16x32_bf16 v[184:187], a[144:147], a[16:19], v[184:187]
buffer_load_dwordx4 v1, s[4:7], s44 offen offset:1024 sc1 lds
s_and_b32 s37, s37, 15
v_mfma_f32_16x16x32_bf16 v[160:163], a[144:147], a[8:11], v[160:163]
v_fmac_f32 v158, v50, v84
v_fmac_f32 v223, v67, v88
v_mfma_f32_16x16x32_bf16 v[160:163], a[148:151], a[12:15], v[160:163]
s_lshl_b32 s37, s37, 9
s_add_u32 s100, s100, s37
s_add_u32 s100, s100, 0x260000
v_mfma_f32_16x16x32_bf16 v[136:139], a[148:151], a[4:7], v[136:139]
v_fmac_f32 v182, v50, v86
v_fmac_f32 v227, v71, v88
v_mfma_f32_16x16x32_bf16 v[136:139], a[144:147], a[0:3], v[136:139]
s_waitcnt vmcnt(10) lgkmcnt(0)
s_barrier
v_mfma_f32_16x16x32_bf16 v[140:143], a[96:99], a[32:35], v[140:143]
ds_read_b128 a[128:131], v5 offset:17408
v_fmac_f32 v206, v50, v88
v_mfma_f32_16x16x32_bf16 v[140:143], a[100:103], a[36:39], v[140:143]
buffer_load_dwordx4 a[0:3], v2, s[40:43], s35 offen offset:0 sc1
s_xor_b32 s90, s91, s79
v_mfma_f32_16x16x32_bf16 v[164:167], a[100:103], a[44:47], v[164:167]
ds_read_b128 a[132:135], v5 offset:23552
v_fmac_f32 v210, v54, v88
v_mfma_f32_16x16x32_bf16 v[164:167], a[96:99], a[40:43], v[164:167]
v_fmac_f32 v203, v71, v86
v_fmac_f32 v179, v71, v84
v_mfma_f32_16x16x32_bf16 v[188:191], a[96:99], a[48:51], v[188:191]
buffer_load_dwordx4 a[4:7], v2, s[40:43], s33 offen offset:0 sc1
s_lshl_b32 s97, s81, 7
v_mfma_f32_16x16x32_bf16 v[188:191], a[100:103], a[52:55], v[188:191]
ds_read_b128 a[136:139], v5 offset:26624
v_fmac_f32 v186, v54, v86
v_mfma_f32_16x16x32_bf16 v[212:215], a[100:103], a[60:63], v[212:215]
v_fmac_f32 v162, v54, v84
v_fmac_f32 v155, v71, v82
v_mfma_f32_16x16x32_bf16 v[212:215], a[96:99], a[56:59], v[212:215]
buffer_load_dwordx4 a[8:11], v2, s[40:43], s35 offen offset:1024 sc1
s_add_u32 s97, s97, s79
v_mfma_f32_16x16x32_bf16 v[216:219], a[104:107], a[56:59], v[216:219]
ds_read_b128 a[140:143], v5 offset:32768
v_fmac_f32 v138, v54, v82
v_mfma_f32_16x16x32_bf16 v[216:219], a[108:111], a[60:63], v[216:219]
v_fmac_f32 v135, v51, v82
v_fmac_f32 v159, v51, v84
v_mfma_f32_16x16x32_bf16 v[192:195], a[108:111], a[52:55], v[192:195]
buffer_load_dwordx4 a[12:15], v2, s[40:43], s33 offen offset:1024 sc1
s_add_u32 s97, s97, s100
v_mfma_f32_16x16x32_bf16 v[192:195], a[104:107], a[48:51], v[192:195]
ds_read_b128 a[144:147], v5 offset:27648
v_fmac_f32 v183, v51, v86
v_mfma_f32_16x16x32_bf16 v[168:171], a[104:107], a[40:43], v[168:171]
v_fmac_f32 v207, v51, v88
s_lshr_b32 s37, s30, 2
v_mfma_f32_16x16x32_bf16 v[168:171], a[108:111], a[44:47], v[168:171]
buffer_load_dwordx4 a[16:19], v2, s[40:43], s35 offen offset:2048 sc1
s_xor_b32 s37, s37, s51
v_mfma_f32_16x16x32_bf16 v[144:147], a[108:111], a[36:39], v[144:147]
ds_read_b128 a[148:151], v5 offset:33792
v_fmac_f32 v211, v55, v88
v_mfma_f32_16x16x32_bf16 v[144:147], a[104:107], a[32:35], v[144:147]
v_mul_f32 v88, 0x3fb8aa3b, v89
s_and_b32 s37, s37, 1
v_mfma_f32_16x16x32_bf16 v[148:151], a[112:115], a[32:35], v[148:151]
buffer_load_dwordx4 a[20:23], v2, s[40:43], s33 offen offset:2048 sc1
s_lshr_b32 s89, s29, 2
v_mfma_f32_16x16x32_bf16 v[148:151], a[116:119], a[36:39], v[148:151]
v_fmac_f32 v187, v55, v86
s_xor_b32 s89, s89, s37
v_mfma_f32_16x16x32_bf16 v[172:175], a[116:119], a[44:47], v[172:175]
v_fmac_f32 v163, v55, v84
v_mul_f32 v86, 0x3fb8aa3b, v87
v_mfma_f32_16x16x32_bf16 v[172:175], a[112:115], a[40:43], v[172:175]
buffer_load_dwordx4 a[24:27], v2, s[40:43], s35 offen offset:3072 sc1
s_lshl_b32 s88, s28, 6
v_mfma_f32_16x16x32_bf16 v[196:199], a[112:115], a[48:51], v[196:199]
v_fmac_f32 v139, v55, v82
v_mul_f32 v84, 0x3fb8aa3b, v85
v_mfma_f32_16x16x32_bf16 v[196:199], a[116:119], a[52:55], v[196:199]
v_mul_f32 v82, 0x3fb8aa3b, v83
s_add_u32 s94, s80, s88
v_mfma_f32_16x16x32_bf16 v[220:223], a[116:119], a[60:63], v[220:223]
buffer_load_dwordx4 a[28:31], v2, s[40:43], s33 offen offset:3072 sc1
s_add_u32 s35, s35, 0x64000
v_mfma_f32_16x16x32_bf16 v[220:223], a[112:115], a[56:59], v[220:223]
s_add_u32 s33, s33, 0x64000
s_waitcnt lgkmcnt(0)
v_mfma_f32_16x16x32_bf16 v[224:227], a[128:131], a[56:59], v[224:227]
ds_read_b128 a[96:99], v5 offset:28672
s_add_u32 s94, s94, 0x90000
v_mfma_f32_16x16x32_bf16 v[224:227], a[132:135], a[60:63], v[224:227]
buffer_load_dwordx4 v1, s[4:7], s44 offen offset:2048 sc1 lds
s_mul_i32 s89, s89, 0x102000
v_mfma_f32_16x16x32_bf16 v[200:203], a[132:135], a[52:55], v[200:203]
ds_read_b128 a[100:103], v5 offset:34816
s_add_u32 s88, s88, s70
v_mfma_f32_16x16x32_bf16 v[200:203], a[128:131], a[48:51], v[200:203]
s_add_u32 s88, s88, s89
s_add_u32 s89, s88, 0x90000
s_add_u32 s74, s71, 0x30080
v_mfma_f32_16x16x32_bf16 v[176:179], a[128:131], a[40:43], v[176:179]
v_add_u32 v233, s19, v232
s_add_u32 s72, s76, 0xc00000
v_mfma_f32_16x16x32_bf16 v[176:179], a[132:135], a[44:47], v[176:179]
ds_read_b128 a[104:107], v5 offset:29696
s_add_u32 s73, s75, 0x800000
v_mfma_f32_16x16x32_bf16 v[152:155], a[132:135], a[36:39], v[152:155]
s_lshr_b32 s38, s28, 1
s_and_b32 s39, s28, 1
s_mul_i32 s38, s38, 3072
v_mfma_f32_16x16x32_bf16 v[152:155], a[128:131], a[32:35], v[152:155]
s_lshl_b32 s39, s39, 3
s_add_u32 s38, s38, s39
s_waitcnt vmcnt(18)
v_mfma_f32_16x16x32_bf16 v[140:143], a[136:139], a[64:67], v[140:143]
ds_read_b128 a[108:111], v5 offset:35840
v_and_b32 v248, 4, v0
s_waitcnt vmcnt(17)
v_mfma_f32_16x16x32_bf16 v[140:143], a[140:143], a[68:71], v[140:143]
v_lshlrev_b32 v248, 11, v248
v_bfe_u32 v235, v0, 2, 1
s_waitcnt vmcnt(15)
v_mfma_f32_16x16x32_bf16 v[164:167], a[140:143], a[76:79], v[164:167]
ds_read_b128 a[112:115], v5 offset:38912
v_xor_b32 v248, s90, v248
v_mfma_f32_16x16x32_bf16 v[164:167], a[136:139], a[72:75], v[164:167]
v_and_b32 v249, 3, v0
v_xor_b32 v235, s37, v235
s_waitcnt vmcnt(14)
v_mfma_f32_16x16x32_bf16 v[188:191], a[136:139], a[80:83], v[188:191]
v_lshl_add_u32 v248, v249, 7, v248
v_mul_u32_u24 v235, 4128, v235
s_waitcnt vmcnt(13)
v_mfma_f32_16x16x32_bf16 v[188:191], a[140:143], a[84:87], v[188:191]
buffer_load_dwordx4 v1, s[4:7], s44 offen offset:3072 sc1 lds
s_add_u32 m0, s19, 65536
s_waitcnt vmcnt(11)
v_mfma_f32_16x16x32_bf16 v[212:215], a[140:143], a[92:95], v[212:215]
s_xor_b32 s44, s85, 32768
ds_read_b128 a[116:119], v5 offset:45056
v_mfma_f32_16x16x32_bf16 v[212:215], a[136:139], a[88:91], v[212:215]
v_lshrrev_b32 v249, 4, v0
v_add_lshl_u32 v235, v235, v0, 8
v_mfma_f32_16x16x32_bf16 v[216:219], a[144:147], a[88:91], v[216:219]
v_lshl_add_u32 v248, v249, 4, v248
v_add_u32 v234, s36, v8
v_mfma_f32_16x16x32_bf16 v[216:219], a[148:151], a[92:95], v[216:219]
v_cndmask_b32 v235, 2.0, v235, s[64:65]
v_mov_b32 v249, 0x3f80
v_mfma_f32_16x16x32_bf16 v[192:195], a[148:151], a[84:87], v[192:195]
v_mov_b32 v250, 1.0
v_add_u32 v252, s38, v1
v_mfma_f32_16x16x32_bf16 v[192:195], a[144:147], a[80:83], v[192:195]
v_mfma_f32_16x16x32_bf16 v[168:171], a[144:147], a[72:75], v[168:171]
v_mfma_f32_16x16x32_bf16 v[168:171], a[148:151], a[76:79], v[168:171]
v_mfma_f32_16x16x32_bf16 v[144:147], a[148:151], a[68:71], v[144:147]
v_mfma_f32_16x16x32_bf16 v[144:147], a[144:147], a[64:67], v[144:147]
s_waitcnt lgkmcnt(0)
v_mfma_f32_16x16x32_bf16 v[148:151], a[96:99], a[64:67], v[148:151]
ds_read_b128 a[128:131], v5 offset:39936
v_mfma_f32_16x16x32_bf16 v[148:151], a[100:103], a[68:71], v[148:151]
buffer_load_dwordx4 v1, s[4:7], s44 offen offset:0 sc1 lds
v_mfma_f32_16x16x32_bf16 v[172:175], a[100:103], a[76:79], v[172:175]
ds_read_b128 a[132:135], v5 offset:46080
v_mfma_f32_16x16x32_bf16 v[172:175], a[96:99], a[72:75], v[172:175]
v_mfma_f32_16x16x32_bf16 v[196:199], a[96:99], a[80:83], v[196:199]
L_stub17:
s_cbranch_execz L_wret5
v_mfma_f32_16x16x32_bf16 v[196:199], a[100:103], a[84:87], v[196:199]
buffer_load_dwordx4 v1, s[4:7], s44 offen offset:1024 sc1 lds
v_mfma_f32_16x16x32_bf16 v[220:223], a[100:103], a[92:95], v[220:223]
ds_read_b128 a[136:139], v5 offset:40960
v_mfma_f32_16x16x32_bf16 v[220:223], a[96:99], a[88:91], v[220:223]
v_mfma_f32_16x16x32_bf16 v[224:227], a[104:107], a[88:91], v[224:227]
ds_read_b128 a[140:143], v5 offset:47104
v_mfma_f32_16x16x32_bf16 v[224:227], a[108:111], a[92:95], v[224:227]
v_mfma_f32_16x16x32_bf16 v[200:203], a[108:111], a[84:87], v[200:203]
buffer_load_dwordx4 v1, s[4:7], s44 offen offset:2048 sc1 lds
v_mfma_f32_16x16x32_bf16 v[200:203], a[104:107], a[80:83], v[200:203]
ds_read_b128 a[144:147], v5 offset:41984
v_mfma_f32_16x16x32_bf16 v[176:179], a[104:107], a[72:75], v[176:179]
v_mfma_f32_16x16x32_bf16 v[176:179], a[108:111], a[76:79], v[176:179]
ds_read_b128 a[148:151], v5 offset:48128
v_mfma_f32_16x16x32_bf16 v[152:155], a[108:111], a[68:71], v[152:155]
v_mfma_f32_16x16x32_bf16 v[152:155], a[104:107], a[64:67], v[152:155]
buffer_load_dwordx4 v1, s[4:7], s44 offen offset:3072 sc1 lds
s_add_u32 m0, s19, 81920
s_waitcnt vmcnt(13)
v_mfma_f32_16x16x32_bf16 v[140:143], a[112:115], a[0:3], v[140:143]
s_xor_b32 s44, s85, 49152
s_waitcnt vmcnt(12)
v_mfma_f32_16x16x32_bf16 v[140:143], a[116:119], a[4:7], v[140:143]
s_waitcnt vmcnt(10)
v_mfma_f32_16x16x32_bf16 v[164:167], a[116:119], a[12:15], v[164:167]
v_mfma_f32_16x16x32_bf16 v[164:167], a[112:115], a[8:11], v[164:167]
s_waitcnt vmcnt(9)
v_mfma_f32_16x16x32_bf16 v[188:191], a[112:115], a[16:19], v[188:191]
buffer_load_dwordx4 v1, s[4:7], s44 offen offset:0 sc1 lds
s_waitcnt vmcnt(9)
v_mfma_f32_16x16x32_bf16 v[188:191], a[116:119], a[20:23], v[188:191]
s_waitcnt vmcnt(7)
v_mfma_f32_16x16x32_bf16 v[212:215], a[116:119], a[28:31], v[212:215]
v_mfma_f32_16x16x32_bf16 v[212:215], a[112:115], a[24:27], v[212:215]
s_waitcnt lgkmcnt(0)
v_mfma_f32_16x16x32_bf16 v[216:219], a[128:131], a[24:27], v[216:219]
ds_read_b128 a[96:99], v5 offset:12288
v_cvt_pk_bf16_f32 v140, v140, v141
v_mfma_f32_16x16x32_bf16 v[216:219], a[132:135], a[28:31], v[216:219]
buffer_load_dwordx4 v1, s[4:7], s44 offen offset:1024 sc1 lds
v_mfma_f32_16x16x32_bf16 v[192:195], a[132:135], a[20:23], v[192:195]
ds_read_b128 a[100:103], v5 offset:18432
v_cvt_pk_bf16_f32 v141, v142, v143
v_mfma_f32_16x16x32_bf16 v[192:195], a[128:131], a[16:19], v[192:195]
v_cvt_pk_bf16_f32 v164, v164, v165
v_cvt_pk_bf16_f32 v165, v166, v167
v_mfma_f32_16x16x32_bf16 v[168:171], a[128:131], a[8:11], v[168:171]
v_cvt_pk_bf16_f32 v188, v188, v189
v_cvt_pk_bf16_f32 v189, v190, v191
v_mfma_f32_16x16x32_bf16 v[168:171], a[132:135], a[12:15], v[168:171]
buffer_load_dwordx4 v1, s[4:7], s44 offen offset:2048 sc1 lds
v_mfma_f32_16x16x32_bf16 v[144:147], a[132:135], a[4:7], v[144:147]
ds_read_b128 a[104:107], v5 offset:24576
v_cvt_pk_bf16_f32 v212, v212, v213
v_mfma_f32_16x16x32_bf16 v[144:147], a[128:131], a[0:3], v[144:147]
v_cvt_pk_bf16_f32 v213, v214, v215
v_mfma_f32_16x16x32_bf16 v[148:151], a[136:139], a[0:3], v[148:151]
ds_read_b128 a[108:111], v5 offset:30720
v_cvt_pk_bf16_f32 v214, v216, v217
v_mfma_f32_16x16x32_bf16 v[148:151], a[140:143], a[4:7], v[148:151]
v_cvt_pk_bf16_f32 v215, v218, v219
v_mfma_f32_16x16x32_bf16 v[172:175], a[140:143], a[12:15], v[172:175]
buffer_load_dwordx4 v1, s[4:7], s44 offen offset:3072 sc1 lds
s_add_u32 m0, s19, 147456
v_mfma_f32_16x16x32_bf16 v[172:175], a[136:139], a[8:11], v[172:175]
s_xor_b32 s44, s85, 114688
ds_read_b128 a[112:115], v5 offset:36864
v_mfma_f32_16x16x32_bf16 v[196:199], a[136:139], a[16:19], v[196:199]
v_cvt_pk_bf16_f32 v166, v168, v169
v_cvt_pk_bf16_f32 v167, v170, v171
v_mfma_f32_16x16x32_bf16 v[196:199], a[140:143], a[20:23], v[196:199]
ds_read_b128 a[116:119], v5 offset:43008
v_cvt_pk_bf16_f32 v190, v192, v193
v_mfma_f32_16x16x32_bf16 v[220:223], a[140:143], a[28:31], v[220:223]
v_cvt_pk_bf16_f32 v142, v144, v145
v_cvt_pk_bf16_f32 v143, v146, v147
v_mfma_f32_16x16x32_bf16 v[220:223], a[136:139], a[24:27], v[220:223]
buffer_load_dwordx4 v1, s[4:7], s44 offen offset:0 sc1 lds
v_mfma_f32_16x16x32_bf16 v[224:227], a[144:147], a[24:27], v[224:227]
v_mfma_f32_16x16x32_bf16 v[92:95], a[240:243], v[140:143], 0
v_mfma_f32_16x16x32_bf16 v[224:227], a[148:151], a[28:31], v[224:227]
v_mfma_f32_16x16x32_bf16 v[96:99], a[244:247], v[140:143], 0
v_mfma_f32_16x16x32_bf16 v[200:203], a[148:151], a[20:23], v[200:203]
v_mfma_f32_16x16x32_bf16 v[100:103], a[240:243], v[164:167], 0
v_mfma_f32_16x16x32_bf16 v[200:203], a[144:147], a[16:19], v[200:203]
v_mfma_f32_16x16x32_bf16 v[104:107], a[244:247], v[164:167], 0
v_mfma_f32_16x16x32_bf16 v[176:179], a[144:147], a[8:11], v[176:179]
buffer_load_dwordx4 v1, s[4:7], s44 offen offset:1024 sc1 lds
v_mfma_f32_16x16x32_bf16 v[176:179], a[148:151], a[12:15], v[176:179]
v_max3_f32 v236, v92, v93, v94
v_max3_f32 v237, -v92, -v93, -v94
v_mfma_f32_16x16x32_bf16 v[152:155], a[148:151], a[4:7], v[152:155]
v_max3_f32 v236, v236, v95, v96
v_max3_f32 v237, v237, -v95, -v96
v_mfma_f32_16x16x32_bf16 v[152:155], a[144:147], a[0:3], v[152:155]
v_max3_f32 v236, v236, v97, v98
s_waitcnt lgkmcnt(0)
v_mfma_f32_16x16x32_bf16 v[132:135], a[96:99], a[32:35], v[132:135]
ds_read_b128 a[128:131], v5 offset:13312
v_max3_f32 v237, v237, -v97, -v98
v_mfma_f32_16x16x32_bf16 v[132:135], a[100:103], a[36:39], v[132:135]
buffer_load_dwordx4 v1, s[4:7], s44 offen offset:2048 sc1 lds
v_mfma_f32_16x16x32_bf16 v[156:159], a[100:103], a[44:47], v[156:159]
ds_read_b128 a[132:135], v5 offset:19456
v_max_f32 v236, v236, v99
v_mfma_f32_16x16x32_bf16 v[156:159], a[96:99], a[40:43], v[156:159]
v_max_f32_e64 v237, v237, -v99
v_max3_f32 v238, v100, v101, v102
v_mfma_f32_16x16x32_bf16 v[180:183], a[96:99], a[48:51], v[180:183]
v_permlane32_swap_b32 v236, v237
v_mfma_f32_16x16x32_bf16 v[180:183], a[100:103], a[52:55], v[180:183]
buffer_load_dwordx4 v1, s[4:7], s44 offen offset:3072 sc1 lds
s_add_u32 m0, s19, 98304
v_mfma_f32_16x16x32_bf16 v[204:207], a[100:103], a[60:63], v[204:207]
s_xor_b32 s44, s85, 65536
ds_read_b128 a[136:139], v5 offset:25600
v_mfma_f32_16x16x32_bf16 v[204:207], a[96:99], a[56:59], v[204:207]
v_max_f32 v236, v236, v237
v_mov_b32 v244, v236
v_mfma_f32_16x16x32_bf16 v[204:207], a[104:107], a[88:91], v[204:207]
ds_read_b128 a[140:143], v5 offset:31744
v_max3_f32 v239, -v100, -v101, -v102
v_mfma_f32_16x16x32_bf16 v[204:207], a[108:111], a[92:95], v[204:207]
v_permlane16_swap_b32 v236, v244
v_mfma_f32_16x16x32_bf16 v[180:183], a[108:111], a[84:87], v[180:183]
buffer_load_dwordx4 v1, s[4:7], s44 offen offset:0 sc1 lds
v_mfma_f32_16x16x32_bf16 v[180:183], a[104:107], a[80:83], v[180:183]
ds_read_b128 a[144:147], v5 offset:37888
v_max_f32 v236, v236, v244
v_mfma_f32_16x16x32_bf16 v[156:159], a[104:107], a[72:75], v[156:159]
v_mov_b32 v244, v236
v_max3_f32 v238, v238, v103, v104
v_mfma_f32_16x16x32_bf16 v[156:159], a[108:111], a[76:79], v[156:159]
ds_read_b128 a[148:151], v5 offset:44032
v_max3_f32 v239, v239, -v103, -v104
v_mfma_f32_16x16x32_bf16 v[132:135], a[108:111], a[68:71], v[132:135]
v_permlane32_swap_b32 v236, v244
v_mfma_f32_16x16x32_bf16 v[132:135], a[104:107], a[64:67], v[132:135]
buffer_load_dwordx4 v1, s[4:7], s44 offen offset:1024 sc1 lds
v_mfma_f32_16x16x32_bf16 v[132:135], a[112:115], a[0:3], v[132:135]
v_mul_f32_e64 v236, -v236, v82
v_mul_f32_e64 v237, -v244, v82
v_mfma_f32_16x16x32_bf16 v[132:135], a[116:119], a[4:7], v[132:135]
v_max3_f32 v238, v238, v105, v106
v_max3_f32 v239, v239, -v105, -v106
v_mfma_f32_16x16x32_bf16 v[156:159], a[116:119], a[12:15], v[156:159]
v_max_f32 v238, v238, v107
v_max_f32_e64 v239, v239, -v107
v_mfma_f32_16x16x32_bf16 v[156:159], a[112:115], a[8:11], v[156:159]
s_nop 0
v_permlane32_swap_b32 v238, v239
v_mfma_f32_16x16x32_bf16 v[180:183], a[112:115], a[16:19], v[180:183]
buffer_load_dwordx4 v1, s[4:7], s44 offen offset:2048 sc1 lds
v_mfma_f32_16x16x32_bf16 v[180:183], a[116:119], a[20:23], v[180:183]
v_max_f32 v238, v238, v239
v_mov_b32 v245, v238
v_mfma_f32_16x16x32_bf16 v[204:207], a[116:119], a[28:31], v[204:207]
s_nop 0
v_permlane16_swap_b32 v238, v245
v_mfma_f32_16x16x32_bf16 v[204:207], a[112:115], a[24:27], v[204:207]
s_waitcnt lgkmcnt(0)
s_barrier
v_mfma_f32_16x16x32_bf16 v[208:211], a[128:131], a[56:59], v[208:211]
v_max_f32 v238, v238, v245
v_mov_b32 v245, v238
v_mfma_f32_16x16x32_bf16 v[208:211], a[132:135], a[60:63], v[208:211]
buffer_load_dwordx4 v1, s[4:7], s44 offen offset:3072 sc1 lds
s_add_u32 m0, s19, 114688
v_mfma_f32_16x16x32_bf16 v[184:187], a[132:135], a[52:55], v[184:187]
s_xor_b32 s44, s85, 81920
v_cvt_pk_bf16_f32 v191, v194, v195
v_mfma_f32_16x16x32_bf16 v[184:187], a[128:131], a[48:51], v[184:187]
v_permlane32_swap_b32 v238, v245
v_mfma_f32_16x16x32_bf16 v[160:163], a[128:131], a[40:43], v[160:163]
v_mul_f32_e64 v238, -v238, v84
v_mul_f32_e64 v239, -v245, v84
v_mfma_f32_16x16x32_bf16 v[160:163], a[132:135], a[44:47], v[160:163]
buffer_load_dwordx4 v1, s[4:7], s44 offen offset:0 sc1 lds
v_mfma_f32_16x16x32_bf16 v[136:139], a[132:135], a[36:39], v[136:139]
v_mfma_f32_16x16x32_bf16 v[108:111], a[240:243], v[188:191], 0
v_mfma_f32_16x16x32_bf16 v[136:139], a[128:131], a[32:35], v[136:139]
v_mfma_f32_16x16x32_bf16 v[112:115], a[244:247], v[188:191], 0
v_mfma_f32_16x16x32_bf16 v[136:139], a[136:139], a[64:67], v[136:139]
v_mfma_f32_16x16x32_bf16 v[116:119], a[240:243], v[212:215], 0
v_mfma_f32_16x16x32_bf16 v[136:139], a[140:143], a[68:71], v[136:139]
v_mfma_f32_16x16x32_bf16 v[120:123], a[244:247], v[212:215], 0
v_mfma_f32_16x16x32_bf16 v[160:163], a[140:143], a[76:79], v[160:163]
buffer_load_dwordx4 v1, s[4:7], s44 offen offset:1024 sc1 lds
v_mfma_f32_16x16x32_bf16 v[160:163], a[136:139], a[72:75], v[160:163]
v_max3_f32 v240, v108, v109, v110
v_max3_f32 v241, -v108, -v109, -v110
v_mfma_f32_16x16x32_bf16 v[184:187], a[136:139], a[80:83], v[184:187]
v_max3_f32 v240, v240, v111, v112
v_max3_f32 v241, v241, -v111, -v112
v_mfma_f32_16x16x32_bf16 v[184:187], a[140:143], a[84:87], v[184:187]
v_max3_f32 v240, v240, v113, v114
v_max3_f32 v241, v241, -v113, -v114
v_mfma_f32_16x16x32_bf16 v[208:211], a[140:143], a[92:95], v[208:211]
v_max_f32 v240, v240, v115
v_max_f32_e64 v241, v241, -v115
v_mfma_f32_16x16x32_bf16 v[208:211], a[136:139], a[88:91], v[208:211]
buffer_load_dwordx4 v1, s[4:7], s44 offen offset:2048 sc1 lds
v_mfma_f32_16x16x32_bf16 v[208:211], a[144:147], a[24:27], v[208:211]
v_permlane32_swap_b32 v240, v241
v_mfma_f32_16x16x32_bf16 v[208:211], a[148:151], a[28:31], v[208:211]
v_max_f32 v240, v240, v241
v_mov_b32 v246, v240
v_mfma_f32_16x16x32_bf16 v[184:187], a[148:151], a[20:23], v[184:187]
s_nop 0
v_permlane16_swap_b32 v240, v246
v_mfma_f32_16x16x32_bf16 v[184:187], a[144:147], a[16:19], v[184:187]
v_max_f32 v240, v240, v246
v_mov_b32 v246, v240
v_mfma_f32_16x16x32_bf16 v[160:163], a[144:147], a[8:11], v[160:163]
buffer_load_dwordx4 v1, s[4:7], s44 offen offset:3072 sc1 lds
v_mfma_f32_16x16x32_bf16 v[160:163], a[148:151], a[12:15], v[160:163]
v_permlane32_swap_b32 v240, v246
v_mfma_f32_16x16x32_bf16 v[136:139], a[148:151], a[4:7], v[136:139]
v_mul_f32_e64 v240, -v240, v86
v_mul_f32_e64 v241, -v246, v86
v_mfma_f32_16x16x32_bf16 v[136:139], a[144:147], a[0:3], v[136:139]
v_max3_f32 v242, v116, v117, v118
v_max3_f32 v243, -v116, -v117, -v118
v_pk_mul_f32 v[148:149], v[148:149], v[82:83] op_sel:[0,1] op_sel_hi:[1,1]
v_pk_mul_f32 v[150:151], v[150:151], v[82:83] op_sel:[0,1] op_sel_hi:[1,1]
v_cvt_pk_bf16_f32 v148, v148, v149
v_cvt_pk_bf16_f32 v149, v150, v151
ds_write_b64 v232, v[148:149] offset:0
v_pk_mul_f32 v[152:153], v[152:153], v[82:83] op_sel:[0,1] op_sel_hi:[1,1]
v_pk_mul_f32 v[154:155], v[154:155], v[82:83] op_sel:[0,1] op_sel_hi:[1,1]
v_cvt_pk_bf16_f32 v150, v152, v153
v_cvt_pk_bf16_f32 v151, v154, v155
v_pk_mul_f32 v[172:173], v[172:173], v[84:85] op_sel:[0,1] op_sel_hi:[1,1]
v_pk_mul_f32 v[174:175], v[174:175], v[84:85] op_sel:[0,1] op_sel_hi:[1,1]
v_cvt_pk_bf16_f32 v172, v172, v173
v_cvt_pk_bf16_f32 v173, v174, v175
v_pk_mul_f32 v[176:177], v[176:177], v[84:85] op_sel:[0,1] op_sel_hi:[1,1]
v_pk_mul_f32 v[178:179], v[178:179], v[84:85] op_sel:[0,1] op_sel_hi:[1,1]
v_cvt_pk_bf16_f32 v174, v176, v177
v_cvt_pk_bf16_f32 v175, v178, v179
ds_write_b64 v232, v[150:151] offset:512
v_pk_mul_f32 v[196:197], v[196:197], v[86:87] op_sel:[0,1] op_sel_hi:[1,1]
v_pk_mul_f32 v[198:199], v[198:199], v[86:87] op_sel:[0,1] op_sel_hi:[1,1]
v_cvt_pk_bf16_f32 v196, v196, v197
v_cvt_pk_bf16_f32 v197, v198, v199
buffer_store_dwordx4 a[248:251], v254, s[4:7], s97 offen offset:0 sc1
v_pk_mul_f32 v[200:201], v[200:201], v[86:87] op_sel:[0,1] op_sel_hi:[1,1]
v_pk_mul_f32 v[202:203], v[202:203], v[86:87] op_sel:[0,1] op_sel_hi:[1,1]
v_cvt_pk_bf16_f32 v198, v200, v201
v_cvt_pk_bf16_f32 v199, v202, v203
ds_write_b64 v232, v[172:173] offset:1024
v_pk_mul_f32 v[220:221], v[220:221], v[88:89] op_sel:[0,1] op_sel_hi:[1,1]
v_pk_mul_f32 v[222:223], v[222:223], v[88:89] op_sel:[0,1] op_sel_hi:[1,1]
v_cvt_pk_bf16_f32 v220, v220, v221
v_cvt_pk_bf16_f32 v221, v222, v223
v_pk_fma_f32 v[48:49], v[92:93], v[82:83], v[236:237] op_sel:[0,0,0] op_sel_hi:[1,0,0]
v_pk_fma_f32 v[50:51], v[94:95], v[82:83], v[236:237] op_sel:[0,0,0] op_sel_hi:[1,0,0]
v_pk_fma_f32 v[52:53], v[96:97], v[82:83], v[236:237] op_sel:[0,0,0] op_sel_hi:[1,0,0]
v_pk_fma_f32 v[54:55], v[98:99], v[82:83], v[236:237] op_sel:[0,0,0] op_sel_hi:[1,0,0]
v_exp_f32 v48, v48
v_exp_f32 v49, v49
ds_write_b64 v232, v[174:175] offset:1536
v_exp_f32 v50, v50
v_exp_f32 v51, v51
v_exp_f32 v52, v52
v_exp_f32 v53, v53
v_exp_f32 v54, v54
v_exp_f32 v55, v55
ds_write_b64 v232, v[196:197] offset:2048
buffer_store_dwordx4 a[248:251], v1, s[4:7], s96 offen offset:0 sc1
v_cvt_pk_bf16_f32 v140, v48, v49
v_cvt_pk_bf16_f32 v141, v50, v51
v_cvt_pk_bf16_f32 v142, v52, v53
v_cvt_pk_bf16_f32 v143, v54, v55
v_pk_mul_f32 v[224:225], v[224:225], v[88:89] op_sel:[0,1] op_sel_hi:[1,1]
v_pk_mul_f32 v[226:227], v[226:227], v[88:89] op_sel:[0,1] op_sel_hi:[1,1]
v_cvt_pk_bf16_f32 v222, v224, v225
v_mfma_f32_16x16x32_bf16 v[148:151], v[16:19], v[140:143], 0
ds_write_b64 v232, v[198:199] offset:2560
v_cvt_pk_bf16_f32 v223, v226, v227
s_add_u32 m0, s19, 131072
v_pk_fma_f32 v[92:93], v[92:93], v[82:83], v[236:237] op_sel:[0,0,1] op_sel_hi:[1,0,1] neg_lo:[1,0,0] neg_hi:[1,0,0]
v_pk_fma_f32 v[94:95], v[94:95], v[82:83], v[236:237] op_sel:[0,0,1] op_sel_hi:[1,0,1] neg_lo:[1,0,0] neg_hi:[1,0,0]
v_pk_fma_f32 v[96:97], v[96:97], v[82:83], v[236:237] op_sel:[0,0,1] op_sel_hi:[1,0,1] neg_lo:[1,0,0] neg_hi:[1,0,0]
s_nop 1
v_rcp_f32 v148, v148
v_pk_fma_f32 v[98:99], v[98:99], v[82:83], v[236:237] op_sel:[0,0,1] op_sel_hi:[1,0,1] neg_lo:[1,0,0] neg_hi:[1,0,0]
v_pk_mul_f32 v[48:49], v[48:49], v[148:149] op_sel:[0,0] op_sel_hi:[1,0]
v_pk_mul_f32 v[50:51], v[50:51], v[148:149] op_sel:[0,0] op_sel_hi:[1,0]
v_cvt_pk_bf16_f32 v140, v48, v49
v_cvt_pk_bf16_f32 v141, v50, v51
ds_write_b64 v232, v[220:221] offset:3072
v_exp_f32 v92, v92
v_exp_f32 v93, v93
v_exp_f32 v94, v94
v_exp_f32 v95, v95
v_exp_f32 v96, v96
v_exp_f32 v97, v97
ds_write_b64 v232, v[222:223] offset:3584
v_exp_f32 v98, v98
v_exp_f32 v99, v99
s_xor_b32 s44, s85, 98304
v_cvt_pk_bf16_f32 v144, v92, v93
v_cvt_pk_bf16_f32 v145, v94, v95
v_cvt_pk_bf16_f32 v146, v96, v97
v_cvt_pk_bf16_f32 v147, v98, v99
buffer_load_dwordx4 v1, s[4:7], s44 offen offset:0 sc1 lds
v_pk_mul_f32 v[52:53], v[52:53], v[148:149] op_sel:[0,0] op_sel_hi:[1,0]
ds_write_b64 v233, v[140:141] offset:16384
v_pk_mul_f32 v[54:55], v[54:55], v[148:149] op_sel:[0,0] op_sel_hi:[1,0]
v_cvt_pk_bf16_f32 v142, v52, v53
v_mfma_f32_16x16x32_bf16 v[152:155], v[16:19], v[144:147], 0
v_cvt_pk_bf16_f32 v143, v54, v55
v_max3_f32 v242, v242, v119, v120
v_max3_f32 v243, v243, -v119, -v120
v_max3_f32 v242, v242, v121, v122
v_max3_f32 v243, v243, -v121, -v122
v_pk_fma_f32 v[56:57], v[100:101], v[84:85], v[238:239] op_sel:[0,0,0] op_sel_hi:[1,0,0]
v_pk_fma_f32 v[58:59], v[102:103], v[84:85], v[238:239] op_sel:[0,0,0] op_sel_hi:[1,0,0]
v_pk_fma_f32 v[60:61], v[104:105], v[84:85], v[238:239] op_sel:[0,0,0] op_sel_hi:[1,0,0]
ds_write_b64 v233, v[142:143] offset:16896
v_rcp_f32 v152, v152
v_pk_fma_f32 v[62:63], v[106:107], v[84:85], v[238:239] op_sel:[0,0,0] op_sel_hi:[1,0,0]
v_pk_mul_f32 v[92:93], v[92:93], v[152:153] op_sel:[0,0] op_sel_hi:[1,0]
v_pk_mul_f32 v[94:95], v[94:95], v[152:153] op_sel:[0,0] op_sel_hi:[1,0]
v_cvt_pk_bf16_f32 v144, v92, v93
v_cvt_pk_bf16_f32 v145, v94, v95
v_exp_f32 v56, v56
v_exp_f32 v57, v57
v_exp_f32 v58, v58
ds_write_b64 v233, v[144:145] offset:17408
v_exp_f32 v59, v59
v_exp_f32 v60, v60
v_exp_f32 v61, v61
v_exp_f32 v62, v62
v_exp_f32 v63, v63
buffer_load_dwordx4 v1, s[4:7], s44 offen offset:1024 sc1 lds
v_cvt_pk_bf16_f32 v164, v56, v57
v_cvt_pk_bf16_f32 v165, v58, v59
v_cvt_pk_bf16_f32 v166, v60, v61
v_cvt_pk_bf16_f32 v167, v62, v63
v_pk_mul_f32 v[96:97], v[96:97], v[152:153] op_sel:[0,0] op_sel_hi:[1,0]
v_pk_mul_f32 v[98:99], v[98:99], v[152:153] op_sel:[0,0] op_sel_hi:[1,0]
v_cvt_pk_bf16_f32 v146, v96, v97
v_mfma_f32_16x16x32_bf16 v[172:175], v[16:19], v[164:167], 0
v_cvt_pk_bf16_f32 v147, v98, v99
ds_write_b64 v233, v[146:147] offset:17920
v_max_f32 v242, v242, v123
v_pk_fma_f32 v[100:101], v[100:101], v[84:85], v[238:239] op_sel:[0,0,1] op_sel_hi:[1,0,1] neg_lo:[1,0,0] neg_hi:[1,0,0]
v_pk_fma_f32 v[102:103], v[102:103], v[84:85], v[238:239] op_sel:[0,0,1] op_sel_hi:[1,0,1] neg_lo:[1,0,0] neg_hi:[1,0,0]
v_pk_fma_f32 v[104:105], v[104:105], v[84:85], v[238:239] op_sel:[0,0,1] op_sel_hi:[1,0,1] neg_lo:[1,0,0] neg_hi:[1,0,0]
s_nop 1
v_rcp_f32 v172, v172
v_pk_fma_f32 v[106:107], v[106:107], v[84:85], v[238:239] op_sel:[0,0,1] op_sel_hi:[1,0,1] neg_lo:[1,0,0] neg_hi:[1,0,0]
v_pk_mul_f32 v[56:57], v[56:57], v[172:173] op_sel:[0,0] op_sel_hi:[1,0]
v_pk_mul_f32 v[58:59], v[58:59], v[172:173] op_sel:[0,0] op_sel_hi:[1,0]
v_cvt_pk_bf16_f32 v164, v56, v57
v_cvt_pk_bf16_f32 v165, v58, v59
v_exp_f32 v100, v100
ds_write_b64 v233, v[164:165] offset:18432
v_exp_f32 v101, v101
v_exp_f32 v102, v102
v_exp_f32 v103, v103
v_exp_f32 v104, v104
v_exp_f32 v105, v105
v_exp_f32 v106, v106
v_exp_f32 v107, v107
buffer_load_dwordx4 v1, s[4:7], s44 offen offset:2048 sc1 lds
v_cvt_pk_bf16_f32 v168, v100, v101
v_cvt_pk_bf16_f32 v169, v102, v103
v_cvt_pk_bf16_f32 v170, v104, v105
v_cvt_pk_bf16_f32 v171, v106, v107
v_pk_mul_f32 v[60:61], v[60:61], v[172:173] op_sel:[0,0] op_sel_hi:[1,0]
v_pk_mul_f32 v[62:63], v[62:63], v[172:173] op_sel:[0,0] op_sel_hi:[1,0]
v_cvt_pk_bf16_f32 v166, v60, v61
v_mfma_f32_16x16x32_bf16 v[176:179], v[16:19], v[168:171], 0
v_cvt_pk_bf16_f32 v167, v62, v63
ds_write_b64 v233, v[166:167] offset:18944
v_max_f32_e64 v243, v243, -v123
v_pk_fma_f32 v[64:65], v[108:109], v[86:87], v[240:241] op_sel:[0,0,0] op_sel_hi:[1,0,0]
v_pk_fma_f32 v[66:67], v[110:111], v[86:87], v[240:241] op_sel:[0,0,0] op_sel_hi:[1,0,0]
v_pk_fma_f32 v[68:69], v[112:113], v[86:87], v[240:241] op_sel:[0,0,0] op_sel_hi:[1,0,0]
s_nop 1
v_rcp_f32 v176, v176
v_pk_fma_f32 v[70:71], v[114:115], v[86:87], v[240:241] op_sel:[0,0,0] op_sel_hi:[1,0,0]
v_pk_mul_f32 v[100:101], v[100:101], v[176:177] op_sel:[0,0] op_sel_hi:[1,0]
v_pk_mul_f32 v[102:103], v[102:103], v[176:177] op_sel:[0,0] op_sel_hi:[1,0]
v_cvt_pk_bf16_f32 v168, v100, v101
v_cvt_pk_bf16_f32 v169, v102, v103
v_exp_f32 v64, v64
ds_write_b64 v233, v[168:169] offset:19456
buffer_load_dwordx4 v1, s[4:7], s44 offen offset:3072 sc1 lds
v_exp_f32 v65, v65
v_exp_f32 v66, v66
v_exp_f32 v67, v67
v_exp_f32 v68, v68
v_exp_f32 v69, v69
v_exp_f32 v70, v70
v_exp_f32 v71, v71
v_cvt_pk_bf16_f32 v188, v64, v65
v_cvt_pk_bf16_f32 v189, v66, v67
v_cvt_pk_bf16_f32 v190, v68, v69
v_cvt_pk_bf16_f32 v191, v70, v71
v_pk_mul_f32 v[104:105], v[104:105], v[176:177] op_sel:[0,0] op_sel_hi:[1,0]
v_pk_mul_f32 v[106:107], v[106:107], v[176:177] op_sel:[0,0] op_sel_hi:[1,0]
v_cvt_pk_bf16_f32 v170, v104, v105
v_mfma_f32_16x16x32_bf16 v[196:199], v[16:19], v[188:191], 0
v_cvt_pk_bf16_f32 v171, v106, v107
ds_write_b64 v233, v[170:171] offset:19968
buffer_store_dwordx4 a[248:251], v2, s[4:7], s72 offen offset:0 sc1
s_nop 4
v_rcp_f32 v196, v196
v_pk_fma_f32 v[108:109], v[108:109], v[86:87], v[240:241] op_sel:[0,0,1] op_sel_hi:[1,0,1] neg_lo:[1,0,0] neg_hi:[1,0,0]
v_pk_mul_f32 v[64:65], v[64:65], v[196:197] op_sel:[0,0] op_sel_hi:[1,0]
v_pk_mul_f32 v[66:67], v[66:67], v[196:197] op_sel:[0,0] op_sel_hi:[1,0]
v_cvt_pk_bf16_f32 v188, v64, v65
v_cvt_pk_bf16_f32 v189, v66, v67
v_pk_fma_f32 v[110:111], v[110:111], v[86:87], v[240:241] op_sel:[0,0,1] op_sel_hi:[1,0,1] neg_lo:[1,0,0] neg_hi:[1,0,0]
ds_write_b64 v233, v[188:189] offset:20480
v_pk_fma_f32 v[112:113], v[112:113], v[86:87], v[240:241] op_sel:[0,0,1] op_sel_hi:[1,0,1] neg_lo:[1,0,0] neg_hi:[1,0,0]
v_pk_fma_f32 v[114:115], v[114:115], v[86:87], v[240:241] op_sel:[0,0,1] op_sel_hi:[1,0,1] neg_lo:[1,0,0] neg_hi:[1,0,0]
v_exp_f32 v108, v108
v_exp_f32 v109, v109
v_exp_f32 v110, v110
v_exp_f32 v111, v111
v_exp_f32 v112, v112
v_exp_f32 v113, v113
v_exp_f32 v114, v114
v_exp_f32 v115, v115
v_cvt_pk_bf16_f32 v192, v108, v109
v_cvt_pk_bf16_f32 v193, v110, v111
v_cvt_pk_bf16_f32 v194, v112, v113
v_cvt_pk_bf16_f32 v195, v114, v115
v_pk_mul_f32 v[68:69], v[68:69], v[196:197] op_sel:[0,0] op_sel_hi:[1,0]
v_pk_mul_f32 v[70:71], v[70:71], v[196:197] op_sel:[0,0] op_sel_hi:[1,0]
v_permlane32_swap_b32 v242, v243
v_mfma_f32_16x16x32_bf16 v[200:203], v[16:19], v[192:195], 0
v_cvt_pk_bf16_f32 v190, v68, v69
v_cvt_pk_bf16_f32 v191, v70, v71
ds_write_b64 v233, v[190:191] offset:20992
v_max_f32 v242, v242, v243
v_mov_b32 v247, v242
buffer_store_dwordx4 a[248:251], v2, s[4:7], s72 offen offset:1024 sc1
s_nop 0
v_permlane16_swap_b32 v242, v247
v_rcp_f32 v200, v200
v_max_f32 v242, v242, v247
v_mov_b32 v247, v242
v_pk_mul_f32 v[108:109], v[108:109], v[200:201] op_sel:[0,0] op_sel_hi:[1,0]
v_pk_mul_f32 v[110:111], v[110:111], v[200:201] op_sel:[0,0] op_sel_hi:[1,0]
v_cvt_pk_bf16_f32 v192, v108, v109
v_cvt_pk_bf16_f32 v193, v110, v111
v_permlane32_swap_b32 v242, v247
ds_write_b64 v233, v[192:193] offset:21504
v_mul_f32_e64 v242, -v242, v88
v_mul_f32_e64 v243, -v247, v88
v_pk_fma_f32 v[124:125], v[116:117], v[88:89], v[242:243] op_sel:[0,0,0] op_sel_hi:[1,0,0]
v_pk_fma_f32 v[126:127], v[118:119], v[88:89], v[242:243] op_sel:[0,0,0] op_sel_hi:[1,0,0]
v_pk_fma_f32 v[128:129], v[120:121], v[88:89], v[242:243] op_sel:[0,0,0] op_sel_hi:[1,0,0]
v_pk_fma_f32 v[130:131], v[122:123], v[88:89], v[242:243] op_sel:[0,0,0] op_sel_hi:[1,0,0]
v_exp_f32 v124, v124
v_exp_f32 v125, v125
v_exp_f32 v126, v126
v_exp_f32 v127, v127
v_exp_f32 v128, v128
v_exp_f32 v129, v129
v_exp_f32 v130, v130
v_exp_f32 v131, v131
v_cvt_pk_bf16_f32 v212, v124, v125
v_cvt_pk_bf16_f32 v213, v126, v127
v_cvt_pk_bf16_f32 v214, v128, v129
v_cvt_pk_bf16_f32 v215, v130, v131
v_pk_mul_f32 v[112:113], v[112:113], v[200:201] op_sel:[0,0] op_sel_hi:[1,0]
v_pk_mul_f32 v[114:115], v[114:115], v[200:201] op_sel:[0,0] op_sel_hi:[1,0]
v_cvt_pk_bf16_f32 v194, v112, v113
v_mfma_f32_16x16x32_bf16 v[220:223], v[16:19], v[212:215], 0
v_cvt_pk_bf16_f32 v195, v114, v115
ds_write_b64 v233, v[194:195] offset:22016
buffer_store_dwordx4 a[248:251], v2, s[4:7], s72 offen offset:2048 sc1
s_nop 4
v_rcp_f32 v220, v220
v_pk_fma_f32 v[116:117], v[116:117], v[88:89], v[242:243] op_sel:[0,0,1] op_sel_hi:[1,0,1] neg_lo:[1,0,0] neg_hi:[1,0,0]
v_pk_mul_f32 v[124:125], v[124:125], v[220:221] op_sel:[0,0] op_sel_hi:[1,0]
v_pk_mul_f32 v[126:127], v[126:127], v[220:221] op_sel:[0,0] op_sel_hi:[1,0]
v_cvt_pk_bf16_f32 v212, v124, v125
v_cvt_pk_bf16_f32 v213, v126, v127
v_pk_fma_f32 v[118:119], v[118:119], v[88:89], v[242:243] op_sel:[0,0,1] op_sel_hi:[1,0,1] neg_lo:[1,0,0] neg_hi:[1,0,0]
ds_write_b64 v233, v[212:213] offset:22528
v_pk_fma_f32 v[120:121], v[120:121], v[88:89], v[242:243] op_sel:[0,0,1] op_sel_hi:[1,0,1] neg_lo:[1,0,0] neg_hi:[1,0,0]
v_pk_fma_f32 v[122:123], v[122:123], v[88:89], v[242:243] op_sel:[0,0,1] op_sel_hi:[1,0,1] neg_lo:[1,0,0] neg_hi:[1,0,0]
v_exp_f32 v116, v116
v_exp_f32 v117, v117
v_exp_f32 v118, v118
v_exp_f32 v119, v119
v_exp_f32 v120, v120
v_exp_f32 v121, v121
v_exp_f32 v122, v122
v_exp_f32 v123, v123
v_cvt_pk_bf16_f32 v216, v116, v117
v_cvt_pk_bf16_f32 v217, v118, v119
v_cvt_pk_bf16_f32 v218, v120, v121
v_cvt_pk_bf16_f32 v219, v122, v123
v_pk_mul_f32 v[128:129], v[128:129], v[220:221] op_sel:[0,0] op_sel_hi:[1,0]
v_pk_mul_f32 v[130:131], v[130:131], v[220:221] op_sel:[0,0] op_sel_hi:[1,0]
v_cvt_pk_bf16_f32 v214, v128, v129
v_mfma_f32_16x16x32_bf16 v[224:227], v[16:19], v[216:219], 0
v_cvt_pk_bf16_f32 v215, v130, v131
ds_write_b64 v233, v[214:215] offset:23040
buffer_store_dwordx4 a[248:251], v2, s[4:7], s72 offen offset:3072 sc1
s_nop 4
v_rcp_f32 v224, v224
s_nop 0
v_pk_mul_f32 v[116:117], v[116:117], v[224:225] op_sel:[0,0] op_sel_hi:[1,0]
v_pk_mul_f32 v[118:119], v[118:119], v[224:225] op_sel:[0,0] op_sel_hi:[1,0]
v_cvt_pk_bf16_f32 v216, v116, v117
v_cvt_pk_bf16_f32 v217, v118, v119
v_pk_mul_f32 v[120:121], v[120:121], v[224:225] op_sel:[0,0] op_sel_hi:[1,0]
ds_write_b64 v233, v[216:217] offset:23552
v_pk_mul_f32 v[122:123], v[122:123], v[224:225] op_sel:[0,0] op_sel_hi:[1,0]
v_cvt_pk_bf16_f32 v218, v120, v121
v_cvt_pk_bf16_f32 v219, v122, v123
ds_write_b64 v233, v[218:219] offset:24064
s_waitcnt vmcnt(8)
s_waitcnt lgkmcnt(0)
s_barrier
ds_read_b64_tr_b16 a[0:1], v234 offset:16384
ds_read_b64_tr_b16 a[2:3], v234 offset:18432
ds_read_b64_tr_b16 a[12:13], v234 offset:20480
ds_read_b64_tr_b16 a[14:15], v234 offset:22528
ds_read_b64_tr_b16 a[24:25], v234 offset:24576
ds_read_b64_tr_b16 a[26:27], v234 offset:26624
ds_read_b64_tr_b16 a[4:5], v8 offset:0
ds_read_b64_tr_b16 a[6:7], v8 offset:1024
ds_read_b64_tr_b16 a[8:9], v8 offset:512
ds_read_b64_tr_b16 a[10:11], v8 offset:1536
ds_read_b64_tr_b16 a[36:37], v234 offset:28672
ds_read_b64_tr_b16 a[38:39], v234 offset:30720
ds_read_b64_tr_b16 a[16:17], v8 offset:2048
ds_read_b64_tr_b16 a[18:19], v8 offset:3072
ds_read_b64_tr_b16 a[20:21], v8 offset:2560
ds_read_b64_tr_b16 a[22:23], v8 offset:3584
ds_read_b64_tr_b16 a[48:49], v234 offset:32768
ds_read_b64_tr_b16 a[50:51], v234 offset:34816
ds_read_b64_tr_b16 a[28:29], v8 offset:4096
ds_read_b64_tr_b16 a[30:31], v8 offset:5120
ds_read_b64_tr_b16 a[32:33], v8 offset:4608
ds_read_b64_tr_b16 a[34:35], v8 offset:5632
ds_read_b64_tr_b16 a[60:61], v234 offset:36864
ds_read_b64_tr_b16 a[62:63], v234 offset:38912
s_waitcnt lgkmcnt(14)
v_mfma_f32_16x16x32_bf16 v[100:103], a[0:3], v[16:19], 0
ds_read_b64_tr_b16 a[40:41], v8 offset:6144
ds_read_b64_tr_b16 a[42:43], v8 offset:7168
ds_read_b64_tr_b16 a[44:45], v8 offset:6656
ds_read_b64_tr_b16 a[46:47], v8 offset:7680
ds_read_b64_tr_b16 a[72:73], v234 offset:40960
ds_read_b64_tr_b16 a[74:75], v234 offset:43008
v_mfma_f32_16x16x32_bf16 v[100:103], a[12:15], v[16:19], v[100:103]
buffer_atomic_add v12, v235, s[4:7], s94 offen sc1
ds_read_b64_tr_b16 a[52:53], v8 offset:8192
ds_read_b64_tr_b16 a[54:55], v8 offset:9216
ds_read_b64_tr_b16 a[56:57], v8 offset:8704
ds_read_b64_tr_b16 a[58:59], v8 offset:9728
ds_read_b64_tr_b16 a[84:85], v234 offset:45056
ds_read_b64_tr_b16 a[86:87], v234 offset:47104
v_mfma_f32_16x16x32_bf16 v[100:103], a[24:27], v[16:19], v[100:103]
ds_read_b64_tr_b16 a[64:65], v8 offset:10240
ds_read_b64_tr_b16 a[66:67], v8 offset:11264
v_mfma_f32_16x16x32_bf16 v[92:95], a[0:3], a[4:7], 0
ds_read_b64_tr_b16 a[68:69], v8 offset:10752
ds_read_b64_tr_b16 a[70:71], v8 offset:11776
v_mfma_f32_16x16x32_bf16 v[96:99], a[0:3], a[8:11], 0
ds_read_b64_tr_b16 a[76:77], v8 offset:12288
s_waitcnt lgkmcnt(14)
v_mfma_f32_16x16x32_bf16 v[100:103], a[36:39], v[16:19], v[100:103]
ds_read_b64_tr_b16 a[78:79], v8 offset:13312
L_stub18:
s_cbranch_execz L_wret5
v_mfma_f32_16x16x32_bf16 v[92:95], a[12:15], a[16:19], v[92:95]
ds_read_b64_tr_b16 a[80:81], v8 offset:12800
ds_read_b64_tr_b16 a[82:83], v8 offset:13824
v_mfma_f32_16x16x32_bf16 v[96:99], a[12:15], a[20:23], v[96:99]
ds_read_b64_tr_b16 a[88:89], v8 offset:14336
v_mfma_f32_16x16x32_bf16 v[100:103], a[48:51], v[16:19], v[100:103]
ds_read_b64_tr_b16 a[90:91], v8 offset:15360
v_mfma_f32_16x16x32_bf16 v[92:95], a[24:27], a[28:31], v[92:95]
ds_read_b64_tr_b16 a[92:93], v8 offset:14848
ds_read_b64_tr_b16 a[94:95], v8 offset:15872
v_mfma_f32_16x16x32_bf16 v[96:99], a[24:27], a[32:35], v[96:99]
v_cvt_pk_bf16_f32 v132, v132, v133
v_cvt_pk_bf16_f32 v156, v156, v157
v_mfma_f32_16x16x32_bf16 v[100:103], a[60:63], v[16:19], v[100:103]
v_cvt_pk_bf16_f32 v180, v180, v181
v_cvt_pk_bf16_f32 v204, v204, v205
v_mfma_f32_16x16x32_bf16 v[92:95], a[36:39], a[40:43], v[92:95]
v_cvt_pk_bf16_f32 v133, v134, v135
v_cvt_pk_bf16_f32 v157, v158, v159
s_waitcnt lgkmcnt(14)
v_mfma_f32_16x16x32_bf16 v[96:99], a[36:39], a[44:47], v[96:99]
v_cvt_pk_bf16_f32 v181, v182, v183
v_cvt_pk_bf16_f32 v205, v206, v207
v_mfma_f32_16x16x32_bf16 v[100:103], a[72:75], v[16:19], v[100:103]
v_cvt_pk_bf16_f32 v134, v136, v137
v_cvt_pk_bf16_f32 v135, v138, v139
v_mfma_f32_16x16x32_bf16 v[92:95], a[48:51], a[52:55], v[92:95]
v_cvt_pk_bf16_f32 v158, v160, v161
v_cvt_pk_bf16_f32 v159, v162, v163
v_mfma_f32_16x16x32_bf16 v[96:99], a[48:51], a[56:59], v[96:99]
v_cvt_pk_bf16_f32 v182, v184, v185
v_cvt_pk_bf16_f32 v183, v186, v187
s_waitcnt lgkmcnt(12)
v_mfma_f32_16x16x32_bf16 v[100:103], a[84:87], v[16:19], v[100:103]
v_cvt_pk_bf16_f32 v206, v208, v209
v_cvt_pk_bf16_f32 v207, v210, v211
s_waitcnt lgkmcnt(10)
v_mfma_f32_16x16x32_bf16 v[92:95], a[60:63], a[64:67], v[92:95]
s_waitcnt lgkmcnt(8)
v_mfma_f32_16x16x32_bf16 v[96:99], a[60:63], a[68:71], v[96:99]
s_nop 1
v_min_u32 v100, -2, v100
v_min_u32 v101, -2, v101
s_waitcnt lgkmcnt(6)
v_mfma_f32_16x16x32_bf16 v[92:95], a[72:75], a[76:79], v[92:95]
v_min_u32 v102, -2, v102
v_min_u32 v103, -2, v103
s_waitcnt lgkmcnt(4)
v_mfma_f32_16x16x32_bf16 v[96:99], a[72:75], a[80:83], v[96:99]
buffer_store_dwordx4 v[100:103], v254, s[4:7], s97 offen sc1
s_waitcnt lgkmcnt(2)
v_mfma_f32_16x16x32_bf16 v[92:95], a[84:87], a[88:91], v[92:95]
s_waitcnt lgkmcnt(0)
v_mfma_f32_16x16x32_bf16 v[96:99], a[84:87], a[92:95], v[96:99]
s_nop 5
v_cvt_pk_bf16_f32 v92, v92, v93
v_cvt_pk_bf16_f32 v93, v94, v95
v_min_u32 v92, -2, v92
v_min_u32 v93, -2, v93
v_cvt_pk_bf16_f32 v94, v96, v97
v_cvt_pk_bf16_f32 v95, v98, v99
v_min_u32 v94, -2, v94
v_min_u32 v95, -2, v95
buffer_store_dwordx4 v[92:95], v1, s[4:7], s96 offen sc1
s_barrier
s_add_u32 m0, s19, 32768
s_xor_b32 s44, s85, 0
buffer_load_dwordx4 v1, s[4:7], s44 offen offset:0 sc1 lds
v_mfma_f32_16x16x32_bf16 v[108:111], a[240:243], v[132:135], 0
v_mfma_f32_16x16x32_bf16 v[172:175], a[240:243], v[156:159], 0
v_mfma_f32_16x16x32_bf16 v[112:115], a[244:247], v[132:135], 0
s_nop 5
v_max3_f32 v236, v108, v109, v110
v_max3_f32 v237, -v108, -v109, -v110
v_mfma_f32_16x16x32_bf16 v[176:179], a[244:247], v[156:159], 0
v_max3_f32 v238, v172, v173, v174
v_max3_f32 v239, -v172, -v173, -v174
v_max3_f32 v236, v236, v111, v112
v_max3_f32 v237, v237, -v111, -v112
v_max3_f32 v236, v236, v113, v114
v_max3_f32 v237, v237, -v113, -v114
s_nop 1
v_max3_f32 v238, v238, v175, v176
v_max3_f32 v239, v239, -v175, -v176
v_max3_f32 v238, v238, v177, v178
v_max3_f32 v239, v239, -v177, -v178
v_max_f32 v236, v236, v115
buffer_load_dwordx4 v1, s[4:7], s44 offen offset:1024 sc1 lds
v_max_f32_e64 v237, v237, -v115
v_max_f32 v238, v238, v179
v_max_f32_e64 v239, v239, -v179
v_permlane32_swap_b32 v236, v237
s_nop 0
v_permlane32_swap_b32 v238, v239
v_mov_b32 v11, 0
buffer_atomic_add v11, v251, s[4:7], s89 offen sc0 sc1
v_max_f32 v236, v236, v237
v_max_f32 v238, v238, v239
v_mov_b32 v244, v236
v_mov_b32 v245, v238
s_nop 0
v_permlane16_swap_b32 v236, v244
v_permlane16_swap_b32 v238, v245
v_max_f32 v236, v236, v244
v_max_f32 v238, v238, v245
v_mov_b32 v244, v236
v_mov_b32 v245, v238
s_nop 0
v_permlane32_swap_b32 v236, v244
v_permlane32_swap_b32 v238, v245
v_mul_f32_e64 v236, -v236, v82
v_mul_f32_e64 v237, -v244, v82
buffer_load_dwordx4 v1, s[4:7], s44 offen offset:2048 sc1 lds
v_mul_f32_e64 v238, -v238, v84
v_mul_f32_e64 v239, -v245, v84
v_pk_fma_f32 v[116:117], v[108:109], v[82:83], v[236:237] op_sel:[0,0,0] op_sel_hi:[1,0,0]
v_pk_fma_f32 v[118:119], v[110:111], v[82:83], v[236:237] op_sel:[0,0,0] op_sel_hi:[1,0,0]
v_pk_fma_f32 v[120:121], v[112:113], v[82:83], v[236:237] op_sel:[0,0,0] op_sel_hi:[1,0,0]
v_pk_fma_f32 v[122:123], v[114:115], v[82:83], v[236:237] op_sel:[0,0,0] op_sel_hi:[1,0,0]
v_pk_fma_f32 v[148:149], v[172:173], v[84:85], v[238:239] op_sel:[0,0,0] op_sel_hi:[1,0,0]
v_pk_fma_f32 v[150:151], v[174:175], v[84:85], v[238:239] op_sel:[0,0,0] op_sel_hi:[1,0,0]
v_pk_fma_f32 v[152:153], v[176:177], v[84:85], v[238:239] op_sel:[0,0,0] op_sel_hi:[1,0,0]
v_pk_fma_f32 v[154:155], v[178:179], v[84:85], v[238:239] op_sel:[0,0,0] op_sel_hi:[1,0,0]
v_pk_fma_f32 v[108:109], v[108:109], v[82:83], v[236:237] op_sel:[0,0,1] op_sel_hi:[1,0,1] neg_lo:[1,0,0] neg_hi:[1,0,0]
v_pk_fma_f32 v[110:111], v[110:111], v[82:83], v[236:237] op_sel:[0,0,1] op_sel_hi:[1,0,1] neg_lo:[1,0,0] neg_hi:[1,0,0]
v_pk_fma_f32 v[112:113], v[112:113], v[82:83], v[236:237] op_sel:[0,0,1] op_sel_hi:[1,0,1] neg_lo:[1,0,0] neg_hi:[1,0,0]
v_pk_fma_f32 v[114:115], v[114:115], v[82:83], v[236:237] op_sel:[0,0,1] op_sel_hi:[1,0,1] neg_lo:[1,0,0] neg_hi:[1,0,0]
v_pk_fma_f32 v[172:173], v[172:173], v[84:85], v[238:239] op_sel:[0,0,1] op_sel_hi:[1,0,1] neg_lo:[1,0,0] neg_hi:[1,0,0]
v_pk_fma_f32 v[174:175], v[174:175], v[84:85], v[238:239] op_sel:[0,0,1] op_sel_hi:[1,0,1] neg_lo:[1,0,0] neg_hi:[1,0,0]
v_pk_fma_f32 v[176:177], v[176:177], v[84:85], v[238:239] op_sel:[0,0,1] op_sel_hi:[1,0,1] neg_lo:[1,0,0] neg_hi:[1,0,0]
v_pk_fma_f32 v[178:179], v[178:179], v[84:85], v[238:239] op_sel:[0,0,1] op_sel_hi:[1,0,1] neg_lo:[1,0,0] neg_hi:[1,0,0]
v_exp_f32 v116, v116
v_exp_f32 v108, v108
v_exp_f32 v117, v117
v_exp_f32 v109, v109
v_exp_f32 v118, v118
v_exp_f32 v110, v110
v_exp_f32 v119, v119
v_exp_f32 v111, v111
v_exp_f32 v120, v120
v_exp_f32 v112, v112
v_exp_f32 v121, v121
v_exp_f32 v113, v113
v_exp_f32 v122, v122
v_exp_f32 v114, v114
v_exp_f32 v123, v123
v_exp_f32 v115, v115
v_exp_f32 v148, v148
v_exp_f32 v172, v172
v_exp_f32 v149, v149
v_exp_f32 v173, v173
v_exp_f32 v150, v150
v_exp_f32 v174, v174
v_exp_f32 v151, v151
v_exp_f32 v175, v175
v_exp_f32 v152, v152
v_exp_f32 v176, v176
v_exp_f32 v153, v153
v_exp_f32 v177, v177
v_exp_f32 v154, v154
v_exp_f32 v178, v178
v_exp_f32 v155, v155
v_exp_f32 v179, v179
buffer_load_dwordx4 v1, s[4:7], s44 offen offset:3072 sc1 lds
v_cvt_pk_bf16_f32 v140, v116, v117
v_cvt_pk_bf16_f32 v141, v118, v119
v_cvt_pk_bf16_f32 v142, v120, v121
v_cvt_pk_bf16_f32 v143, v122, v123
v_cvt_pk_bf16_f32 v144, v108, v109
v_cvt_pk_bf16_f32 v145, v110, v111
v_cvt_pk_bf16_f32 v146, v112, v113
v_cvt_pk_bf16_f32 v147, v114, v115
v_cvt_pk_bf16_f32 v164, v148, v149
v_cvt_pk_bf16_f32 v165, v150, v151
v_cvt_pk_bf16_f32 v166, v152, v153
v_cvt_pk_bf16_f32 v167, v154, v155
v_cvt_pk_bf16_f32 v168, v172, v173
v_cvt_pk_bf16_f32 v169, v174, v175
v_cvt_pk_bf16_f32 v170, v176, v177
v_cvt_pk_bf16_f32 v171, v178, v179
s_waitcnt vmcnt(2)
v_readfirstlane_b32 s38, v11
s_nop 0
s_cmp_ge_u32 s38, 8
s_cbranch_scc1 Lpe_47
s_add_u32 s36, s88, 0x90000
s_mov_b32 s37, 0
Lpoll_46:
v_mov_b32 v11, 0
buffer_atomic_add v11, v251, s[4:7], s36 offen sc0 sc1
s_add_u32 s37, s37, 1
s_waitcnt vmcnt(0)
v_readfirstlane_b32 s38, v11
s_nop 0
s_cmp_ge_u32 s38, 8
s_cbranch_scc1 Lpe_47
s_cmp_lt_u32 s37, 0x100000
s_cbranch_scc1 Lpoll_46
Lpe_47:
buffer_load_dwordx4 v[48:51], v1, s[4:7], s98 offen offset:0 sc1
v_mfma_f32_16x16x32_bf16 v[108:111], a[240:243], v[180:183], 0
v_mfma_f32_16x16x32_bf16 v[220:223], a[240:243], v[204:207], 0
v_mfma_f32_16x16x32_bf16 v[112:115], a[244:247], v[180:183], 0
s_nop 5
v_max3_f32 v240, v108, v109, v110
v_max3_f32 v241, -v108, -v109, -v110
v_mfma_f32_16x16x32_bf16 v[224:227], a[244:247], v[204:207], 0
buffer_load_dwordx4 v[124:127], v248, s[4:7], s100 offen sc1
v_max3_f32 v242, v220, v221, v222
v_max3_f32 v243, -v220, -v221, -v222
v_max3_f32 v240, v240, v111, v112
v_max3_f32 v241, v241, -v111, -v112
v_max3_f32 v240, v240, v113, v114
s_nop 1
v_max3_f32 v242, v242, v223, v224
v_max3_f32 v243, v243, -v223, -v224
v_max3_f32 v241, v241, -v113, -v114
v_max3_f32 v242, v242, v225, v226
v_max3_f32 v243, v243, -v225, -v226
v_max_f32 v240, v240, v115
v_max_f32_e64 v241, v241, -v115
v_max_f32 v242, v242, v227
buffer_load_dwordx4 v[52:55], v1, s[4:7], s98 offen offset:1024 sc1
v_max_f32_e64 v243, v243, -v227
v_permlane32_swap_b32 v240, v241
s_nop 0
v_permlane32_swap_b32 v242, v243
v_max_f32 v240, v240, v241
v_max_f32 v242, v242, v243
v_mov_b32 v246, v240
v_mov_b32 v247, v242
s_nop 0
v_permlane16_swap_b32 v240, v246
v_permlane16_swap_b32 v242, v247
buffer_load_dwordx4 v[56:59], v1, s[4:7], s98 offen offset:2048 sc1
v_max_f32 v240, v240, v246
v_max_f32 v242, v242, v247
v_mov_b32 v246, v240
v_mov_b32 v247, v242
s_nop 0
v_permlane32_swap_b32 v240, v246
v_permlane32_swap_b32 v242, v247
v_mul_f32_e64 v240, -v240, v86
v_mul_f32_e64 v241, -v246, v86
v_mul_f32_e64 v242, -v242, v88
v_mul_f32_e64 v243, -v247, v88
buffer_load_dwordx4 v[60:63], v1, s[4:7], s98 offen offset:3072 sc1
v_pk_fma_f32 v[116:117], v[108:109], v[86:87], v[240:241] op_sel:[0,0,0] op_sel_hi:[1,0,0]
v_pk_fma_f32 v[118:119], v[110:111], v[86:87], v[240:241] op_sel:[0,0,0] op_sel_hi:[1,0,0]
v_pk_fma_f32 v[120:121], v[112:113], v[86:87], v[240:241] op_sel:[0,0,0] op_sel_hi:[1,0,0]
v_pk_fma_f32 v[122:123], v[114:115], v[86:87], v[240:241] op_sel:[0,0,0] op_sel_hi:[1,0,0]
v_pk_fma_f32 v[196:197], v[220:221], v[88:89], v[242:243] op_sel:[0,0,0] op_sel_hi:[1,0,0]
v_pk_fma_f32 v[198:199], v[222:223], v[88:89], v[242:243] op_sel:[0,0,0] op_sel_hi:[1,0,0]
v_pk_fma_f32 v[200:201], v[224:225], v[88:89], v[242:243] op_sel:[0,0,0] op_sel_hi:[1,0,0]
v_pk_fma_f32 v[202:203], v[226:227], v[88:89], v[242:243] op_sel:[0,0,0] op_sel_hi:[1,0,0]
v_pk_fma_f32 v[108:109], v[108:109], v[86:87], v[240:241] op_sel:[0,0,1] op_sel_hi:[1,0,1] neg_lo:[1,0,0] neg_hi:[1,0,0]
v_pk_fma_f32 v[110:111], v[110:111], v[86:87], v[240:241] op_sel:[0,0,1] op_sel_hi:[1,0,1] neg_lo:[1,0,0] neg_hi:[1,0,0]
v_pk_fma_f32 v[112:113], v[112:113], v[86:87], v[240:241] op_sel:[0,0,1] op_sel_hi:[1,0,1] neg_lo:[1,0,0] neg_hi:[1,0,0]
v_pk_fma_f32 v[114:115], v[114:115], v[86:87], v[240:241] op_sel:[0,0,1] op_sel_hi:[1,0,1] neg_lo:[1,0,0] neg_hi:[1,0,0]
v_pk_fma_f32 v[220:221], v[220:221], v[88:89], v[242:243] op_sel:[0,0,1] op_sel_hi:[1,0,1] neg_lo:[1,0,0] neg_hi:[1,0,0]
buffer_load_dwordx4 v[64:67], v1, s[4:7], s99 offen offset:0 sc1
v_pk_fma_f32 v[222:223], v[222:223], v[88:89], v[242:243] op_sel:[0,0,1] op_sel_hi:[1,0,1] neg_lo:[1,0,0] neg_hi:[1,0,0]
v_pk_fma_f32 v[224:225], v[224:225], v[88:89], v[242:243] op_sel:[0,0,1] op_sel_hi:[1,0,1] neg_lo:[1,0,0] neg_hi:[1,0,0]
v_pk_fma_f32 v[226:227], v[226:227], v[88:89], v[242:243] op_sel:[0,0,1] op_sel_hi:[1,0,1] neg_lo:[1,0,0] neg_hi:[1,0,0]
v_exp_f32 v116, v116
v_exp_f32 v108, v108
v_exp_f32 v117, v117
v_exp_f32 v109, v109
v_exp_f32 v118, v118
buffer_load_dwordx4 v[68:71], v1, s[4:7], s99 offen offset:1024 sc1
v_exp_f32 v110, v110
v_exp_f32 v119, v119
v_exp_f32 v111, v111
v_exp_f32 v120, v120
v_exp_f32 v112, v112
v_exp_f32 v121, v121
v_exp_f32 v113, v113
buffer_load_dwordx4 v[100:103], v1, s[4:7], s99 offen offset:2048 sc1
v_exp_f32 v122, v122
v_exp_f32 v114, v114
v_exp_f32 v123, v123
v_exp_f32 v115, v115
v_exp_f32 v196, v196
v_exp_f32 v220, v220
v_exp_f32 v197, v197
buffer_load_dwordx4 v[104:107], v1, s[4:7], s99 offen offset:3072 sc1
v_exp_f32 v221, v221
v_exp_f32 v198, v198
v_exp_f32 v222, v222
v_exp_f32 v199, v199
v_exp_f32 v223, v223
v_exp_f32 v200, v200
v_exp_f32 v224, v224
v_exp_f32 v201, v201
v_exp_f32 v225, v225
v_exp_f32 v202, v202
v_exp_f32 v226, v226
v_exp_f32 v203, v203
v_exp_f32 v227, v227
v_cvt_pk_bf16_f32 v188, v116, v117
v_cvt_pk_bf16_f32 v189, v118, v119
v_cvt_pk_bf16_f32 v190, v120, v121
v_cvt_pk_bf16_f32 v191, v122, v123
v_cvt_pk_bf16_f32 v192, v108, v109
v_cvt_pk_bf16_f32 v193, v110, v111
v_cvt_pk_bf16_f32 v194, v112, v113
v_cvt_pk_bf16_f32 v195, v114, v115
v_cvt_pk_bf16_f32 v212, v196, v197
v_cvt_pk_bf16_f32 v213, v198, v199
v_cvt_pk_bf16_f32 v214, v200, v201
v_cvt_pk_bf16_f32 v215, v202, v203
v_cvt_pk_bf16_f32 v216, v220, v221
v_cvt_pk_bf16_f32 v217, v222, v223
v_cvt_pk_bf16_f32 v218, v224, v225
v_cvt_pk_bf16_f32 v219, v226, v227
s_waitcnt vmcnt(8)
v_lshlrev_b32 v92, 16, v48
v_and_b32 v93, 0xffff0000, v48
v_lshlrev_b32 v94, 16, v49
v_and_b32 v95, 0xffff0000, v49
v_lshlrev_b32 v96, 16, v50
v_and_b32 v97, 0xffff0000, v50
v_lshlrev_b32 v98, 16, v51
v_and_b32 v99, 0xffff0000, v51
s_waitcnt vmcnt(7)
v_add_f32_dpp v128, v124, v124 row_ror:4 row_mask:0xf bank_mask:0xf
v_add_f32_dpp v129, v125, v125 row_ror:4 row_mask:0xf bank_mask:0xf
v_add_f32_dpp v130, v126, v126 row_ror:4 row_mask:0xf bank_mask:0xf
v_add_f32_dpp v131, v127, v127 row_ror:4 row_mask:0xf bank_mask:0xf
v_add_f32_dpp v128, v128, v128 row_ror:2 row_mask:0xf bank_mask:0xf
v_add_f32_dpp v129, v129, v129 row_ror:2 row_mask:0xf bank_mask:0xf
v_add_f32_dpp v130, v130, v130 row_ror:2 row_mask:0xf bank_mask:0xf
v_add_f32_dpp v131, v131, v131 row_ror:2 row_mask:0xf bank_mask:0xf
v_add_f32_dpp v128, v128, v128 row_ror:1 row_mask:0xf bank_mask:0xf
v_add_f32_dpp v129, v129, v129 row_ror:1 row_mask:0xf bank_mask:0xf
v_add_f32_dpp v130, v130, v130 row_ror:1 row_mask:0xf bank_mask:0xf
v_add_f32_dpp v131, v131, v131 row_ror:1 row_mask:0xf bank_mask:0xf
v_fma_f32 v135, v129, v130, v131
s_waitcnt vmcnt(6)
v_dot2c_f32_bf16 v92, v52, v249
v_dot2c_f32_bf16 v93, v52, v250
v_dot2c_f32_bf16 v94, v53, v249
v_dot2c_f32_bf16 v95, v53, v250
v_dot2c_f32_bf16 v96, v54, v249
v_dot2c_f32_bf16 v97, v54, v250
v_dot2c_f32_bf16 v98, v55, v249
v_dot2c_f32_bf16 v99, v55, v250
s_waitcnt vmcnt(5)
v_dot2c_f32_bf16 v92, v56, v249
v_dot2c_f32_bf16 v93, v56, v250
v_dot2c_f32_bf16 v94, v57, v249
v_dot2c_f32_bf16 v95, v57, v250
v_dot2c_f32_bf16 v96, v58, v249
v_dot2c_f32_bf16 v97, v58, v250
v_dot2c_f32_bf16 v98, v59, v249
v_dot2c_f32_bf16 v99, v59, v250
s_waitcnt vmcnt(4)
v_dot2c_f32_bf16 v92, v60, v249
v_dot2c_f32_bf16 v93, v60, v250
v_dot2c_f32_bf16 v94, v61, v249
v_dot2c_f32_bf16 v95, v61, v250
v_dot2c_f32_bf16 v96, v62, v249
v_dot2c_f32_bf16 v97, v62, v250
v_dot2c_f32_bf16 v98, v63, v249
v_dot2c_f32_bf16 v99, v63, v250
s_waitcnt vmcnt(3)
v_dot2c_f32_bf16 v92, v64, v249
v_dot2c_f32_bf16 v93, v64, v250
v_dot2c_f32_bf16 v94, v65, v249
v_dot2c_f32_bf16 v95, v65, v250
v_dot2c_f32_bf16 v96, v66, v249
v_dot2c_f32_bf16 v97, v66, v250
v_dot2c_f32_bf16 v98, v67, v249
v_dot2c_f32_bf16 v99, v67, v250
s_waitcnt vmcnt(2)
v_dot2c_f32_bf16 v92, v68, v249
v_dot2c_f32_bf16 v93, v68, v250
v_dot2c_f32_bf16 v94, v69, v249
v_dot2c_f32_bf16 v95, v69, v250
v_dot2c_f32_bf16 v96, v70, v249
v_dot2c_f32_bf16 v97, v70, v250
v_dot2c_f32_bf16 v98, v71, v249
v_dot2c_f32_bf16 v99, v71, v250
s_waitcnt vmcnt(1)
v_dot2c_f32_bf16 v92, v100, v249
v_dot2c_f32_bf16 v93, v100, v250
v_dot2c_f32_bf16 v94, v101, v249
v_dot2c_f32_bf16 v95, v101, v250
v_dot2c_f32_bf16 v96, v102, v249
v_dot2c_f32_bf16 v97, v102, v250
v_dot2c_f32_bf16 v98, v103, v249
v_dot2c_f32_bf16 v99, v103, v250
s_waitcnt vmcnt(0)
v_dot2c_f32_bf16 v92, v104, v249
v_dot2c_f32_bf16 v93, v104, v250
v_dot2c_f32_bf16 v94, v105, v249
v_dot2c_f32_bf16 v95, v105, v250
v_dot2c_f32_bf16 v96, v106, v249
v_dot2c_f32_bf16 v97, v106, v250
v_dot2c_f32_bf16 v98, v107, v249
v_dot2c_f32_bf16 v99, v107, v250
v_fma_f32 v132, v92, v93, v94
v_fma_f32 v133, v95, v96, v97
s_nop 0
v_fma_f32 v134, v98, v99, v128
v_fma_f32 v132, v132, v133, v134
v_cmp_u_f32 vcc, v132, v135
s_cbranch_vccnz L_kvredo3
L_kvback3:
v_cvt_pk_bf16_f32 v128, v128, v129
v_cvt_pk_bf16_f32 v129, v130, v131
v_cvt_pk_bf16_f32 v92, v92, v93
v_cndmask_b32 v128, 0, v128, s[56:57]
v_cndmask_b32 v129, 0, v129, s[56:57]
v_cvt_pk_bf16_f32 v93, v94, v95
v_cvt_pk_bf16_f32 v94, v96, v97
v_cvt_pk_bf16_f32 v95, v98, v99
v_cndmask_b32 v128, v128, v16, s[58:59]
v_cndmask_b32 v129, v129, v16, s[58:59]
ds_write_b64 v252, v[92:93] offset:0
ds_write_b64 v252, v[94:95] offset:1024
ds_write_b64 v252, v[128:129] offset:2048
s_waitcnt lgkmcnt(0)
s_barrier
ds_read_b128 a[8:11], v1 offset:2048
ds_read_b128 a[20:23], v1 offset:5120
ds_read_b128 a[0:3], v1 offset:0
ds_read_b128 a[12:15], v1 offset:3072
ds_read_b128 a[4:7], v1 offset:1024
ds_read_b128 a[16:19], v1 offset:4096
s_waitcnt lgkmcnt(5)
v_mfma_f32_16x16x32_bf16 v[116:119], a[8:11], v[212:215], 0
s_waitcnt lgkmcnt(4)
v_mfma_f32_16x16x32_bf16 v[120:123], a[20:23], v[216:219], 0
s_waitcnt lgkmcnt(3)
v_mfma_f32_16x16x32_bf16 v[204:207], a[0:3], v[212:215], 0
s_nop 3
v_rcp_f32 v118, v117
s_waitcnt lgkmcnt(2)
v_mfma_f32_16x16x32_bf16 v[220:223], a[12:15], v[216:219], 0
v_rcp_f32 v119, v121
v_mul_f32 v116, v116, v118
v_fmac_f32 v116, v120, v119
v_mfma_f32_16x16x32_bf16 v[100:103], a[8:11], v[164:167], 0
v_add_f32 v116, 0x358637bd, v116
v_rcp_f32 v116, v116
s_waitcnt lgkmcnt(1)
v_mfma_f32_16x16x32_bf16 v[208:211], a[4:7], v[212:215], 0
v_mul_f32 v118, v118, v116
v_mul_f32 v119, v119, v116
v_mfma_f32_16x16x32_bf16 v[104:107], a[20:23], v[168:171], 0
v_mul_f32 v204, v204, v118
v_mul_f32 v205, v205, v118
s_waitcnt lgkmcnt(0)
v_mfma_f32_16x16x32_bf16 v[224:227], a[16:19], v[216:219], 0
v_mul_f32 v206, v206, v118
v_mul_f32 v207, v207, v118
v_fmac_f32 v204, v220, v119
v_fmac_f32 v205, v221, v119
v_rcp_f32 v102, v101
v_mul_f32 v208, v208, v118
v_mul_f32 v209, v209, v118
v_mul_f32 v210, v210, v118
buffer_atomic_add v12, v10, s[4:7], s74 offen sc1
v_mul_f32 v211, v211, v118
v_fmac_f32 v206, v222, v119
v_fmac_f32 v207, v223, v119
v_cvt_pk_bf16_f32 v204, v204, v205
v_rcp_f32 v103, v105
v_fmac_f32 v208, v224, v119
v_fmac_f32 v209, v225, v119
v_fmac_f32 v210, v226, v119
v_fmac_f32 v211, v227, v119
v_cvt_pk_bf16_f32 v205, v206, v207
v_cvt_pk_bf16_f32 v206, v208, v209
v_cvt_pk_bf16_f32 v207, v210, v211
v_mul_f32 v100, v100, v102
v_mfma_f32_16x16x32_bf16 v[156:159], a[0:3], v[164:167], 0
buffer_store_dwordx4 v[204:207], v2, s[4:7], s72 offen offset:3072 sc1
v_fmac_f32 v100, v104, v103
v_mfma_f32_16x16x32_bf16 v[172:175], a[12:15], v[168:171], 0
v_add_f32 v100, 0x358637bd, v100
v_rcp_f32 v100, v100
v_mfma_f32_16x16x32_bf16 v[108:111], a[8:11], v[188:191], 0
v_mul_f32 v102, v102, v100
v_mul_f32 v103, v103, v100
v_mfma_f32_16x16x32_bf16 v[160:163], a[4:7], v[164:167], 0
v_mul_f32 v156, v156, v102
v_mul_f32 v157, v157, v102
v_mfma_f32_16x16x32_bf16 v[112:115], a[20:23], v[192:195], 0
v_mul_f32 v158, v158, v102
v_mul_f32 v159, v159, v102
v_mfma_f32_16x16x32_bf16 v[176:179], a[16:19], v[168:171], 0
v_fmac_f32 v156, v172, v103
v_fmac_f32 v157, v173, v103
v_rcp_f32 v110, v109
v_mul_f32 v160, v160, v102
v_mul_f32 v161, v161, v102
v_mul_f32 v162, v162, v102
v_mul_f32 v163, v163, v102
v_fmac_f32 v158, v174, v103
v_fmac_f32 v159, v175, v103
v_cvt_pk_bf16_f32 v156, v156, v157
v_rcp_f32 v111, v113
v_fmac_f32 v160, v176, v103
v_fmac_f32 v161, v177, v103
v_fmac_f32 v162, v178, v103
v_fmac_f32 v163, v179, v103
v_cvt_pk_bf16_f32 v157, v158, v159
v_cvt_pk_bf16_f32 v158, v160, v161
v_cvt_pk_bf16_f32 v159, v162, v163
v_mul_f32 v108, v108, v110
v_mfma_f32_16x16x32_bf16 v[180:183], a[0:3], v[188:191], 0
buffer_store_dwordx4 v[156:159], v2, s[4:7], s72 offen offset:1024 sc1
v_fmac_f32 v108, v112, v111
v_mfma_f32_16x16x32_bf16 v[196:199], a[12:15], v[192:195], 0
v_add_f32 v108, 0x358637bd, v108
v_rcp_f32 v108, v108
v_mfma_f32_16x16x32_bf16 v[92:95], a[8:11], v[140:143], 0
v_mul_f32 v110, v110, v108
v_mul_f32 v111, v111, v108
v_mfma_f32_16x16x32_bf16 v[184:187], a[4:7], v[188:191], 0
v_mul_f32 v180, v180, v110
v_mul_f32 v181, v181, v110
v_mfma_f32_16x16x32_bf16 v[96:99], a[20:23], v[144:147], 0
v_mul_f32 v182, v182, v110
v_mul_f32 v183, v183, v110
v_mfma_f32_16x16x32_bf16 v[200:203], a[16:19], v[192:195], 0
v_fmac_f32 v180, v196, v111
v_fmac_f32 v181, v197, v111
v_rcp_f32 v94, v93
v_mul_f32 v184, v184, v110
v_mul_f32 v185, v185, v110
v_mul_f32 v186, v186, v110
v_mul_f32 v187, v187, v110
v_fmac_f32 v182, v198, v111
v_fmac_f32 v183, v199, v111
v_cvt_pk_bf16_f32 v180, v180, v181
v_rcp_f32 v95, v97
v_fmac_f32 v184, v200, v111
v_fmac_f32 v185, v201, v111
v_fmac_f32 v186, v202, v111
v_fmac_f32 v187, v203, v111
v_cvt_pk_bf16_f32 v181, v182, v183
v_cvt_pk_bf16_f32 v182, v184, v185
v_cvt_pk_bf16_f32 v183, v186, v187
v_mul_f32 v92, v92, v94
v_mfma_f32_16x16x32_bf16 v[132:135], a[0:3], v[140:143], 0
buffer_store_dwordx4 v[180:183], v2, s[4:7], s72 offen offset:2048 sc1
v_fmac_f32 v92, v96, v95
v_mfma_f32_16x16x32_bf16 v[148:151], a[12:15], v[144:147], 0
v_add_f32 v92, 0x358637bd, v92
v_rcp_f32 v92, v92
v_mfma_f32_16x16x32_bf16 v[136:139], a[4:7], v[140:143], 0
v_mul_f32 v94, v94, v92
v_mul_f32 v95, v95, v92
v_mfma_f32_16x16x32_bf16 v[152:155], a[16:19], v[144:147], 0
v_mul_f32 v132, v132, v94
v_mul_f32 v133, v133, v94
v_mul_f32 v134, v134, v94
v_mul_f32 v135, v135, v94
v_fmac_f32 v132, v148, v95
v_fmac_f32 v133, v149, v95
v_mul_f32 v136, v136, v94
v_mul_f32 v137, v137, v94
v_mul_f32 v138, v138, v94
v_mul_f32 v139, v139, v94
v_fmac_f32 v134, v150, v95
v_fmac_f32 v135, v151, v95
v_cvt_pk_bf16_f32 v132, v132, v133
v_fmac_f32 v136, v152, v95
v_fmac_f32 v137, v153, v95
v_fmac_f32 v138, v154, v95
v_fmac_f32 v139, v155, v95
v_cvt_pk_bf16_f32 v133, v134, v135
v_cvt_pk_bf16_f32 v134, v136, v137
v_cvt_pk_bf16_f32 v135, v138, v139
buffer_store_dwordx4 v[132:135], v2, s[4:7], s72 offen offset:0 sc1
s_add_u32 s92, s71, 0x30000
s_add_u32 s40, s4, 0xc00000
s_addc_u32 s41, s5, 0
v_add_u32 v5, 32768, v1
v_add_u32 v6, 98304, v1
s_mov_b32 s35, s9
v_lshlrev_b32 v132, 16, v32
v_and_b32 v133, 0xffff0000, v32
v_lshlrev_b32 v134, 16, v33
v_and_b32 v135, 0xffff0000, v33
v_lshlrev_b32 v136, 16, v34
v_and_b32 v137, 0xffff0000, v34
v_lshlrev_b32 v138, 16, v35
v_and_b32 v139, 0xffff0000, v35
v_lshlrev_b32 v140, 16, v36
v_and_b32 v141, 0xffff0000, v36
v_lshlrev_b32 v142, 16, v37
v_and_b32 v143, 0xffff0000, v37
v_lshlrev_b32 v144, 16, v38
v_and_b32 v145, 0xffff0000, v38
v_lshlrev_b32 v146, 16, v39
v_and_b32 v147, 0xffff0000, v39
v_lshlrev_b32 v148, 16, v40
v_and_b32 v149, 0xffff0000, v40
v_lshlrev_b32 v150, 16, v41
v_and_b32 v151, 0xffff0000, v41
v_lshlrev_b32 v152, 16, v42
v_and_b32 v153, 0xffff0000, v42
v_lshlrev_b32 v154, 16, v43
v_and_b32 v155, 0xffff0000, v43
v_lshlrev_b32 v156, 16, v44
v_and_b32 v157, 0xffff0000, v44
v_lshlrev_b32 v158, 16, v45
v_and_b32 v159, 0xffff0000, v45
v_lshlrev_b32 v160, 16, v46
v_and_b32 v161, 0xffff0000, v46
v_lshlrev_b32 v162, 16, v47
v_and_b32 v163, 0xffff0000, v47
s_mov_b32 s95, -1
s_mov_b64 exec, 0
s_cmp_eq_u32 s28, 3
s_cbranch_scc1 L_stub19
s_cmp_eq_u32 s28, 2
s_cbranch_scc1 L_wret7
s_cmp_eq_u32 s28, 0
s_cbranch_scc1 L_wret7
L_wret7:
s_mov_b64 exec, -1
s_cmp_lg_u32 s28, 1
s_cbranch_scc1 Lpo_50
s_add_u32 s36, s11, 0x30080
s_mov_b32 s37, 0
v_mov_b32 v11, 0
buffer_atomic_add v11, v251, s[4:7], s36 offen sc0 sc1
s_sleep 4
Lpoll_48:
v_mov_b32 v234, 0
buffer_atomic_add v234, v251, s[4:7], s36 offen sc0 sc1
s_waitcnt vmcnt(1)
v_readfirstlane_b32 s38, v11
s_nop 0
s_cmp_ge_u32 s38, 32
s_cbranch_scc1 Lpe_49
v_mov_b32 v11, 0
buffer_atomic_add v11, v251, s[4:7], s36 offen sc0 sc1
s_waitcnt vmcnt(1)
v_readfirstlane_b32 s38, v234
s_nop 0
s_cmp_ge_u32 s38, 32
s_cbranch_scc1 Lpe_49
s_add_u32 s37, s37, 1
s_cmp_lt_u32 s37, 0x80000
s_cbranch_scc1 Lpoll_48
s_waitcnt vmcnt(0)
Lpo_50:
s_waitcnt vmcnt(0)
Lpe_49:
s_barrier
L_k2go3:
buffer_load_dwordx4 a[0:3], v4, s[40:43], s35 offen offset:0 sc1
buffer_load_dwordx4 a[4:7], v4, s[40:43], s35 offen offset:1024 sc1
s_xor_b32 s35, s9, 4096
buffer_load_dwordx4 a[8:11], v4, s[40:43], s35 offen offset:0 sc1
buffer_load_dwordx4 a[12:15], v4, s[40:43], s35 offen offset:1024 sc1
s_xor_b32 s35, s9, 16384
buffer_load_dwordx4 a[16:19], v4, s[40:43], s35 offen offset:0 sc1
buffer_load_dwordx4 a[20:23], v4, s[40:43], s35 offen offset:1024 sc1
s_xor_b32 s35, s9, 20480
buffer_load_dwordx4 a[24:27], v4, s[40:43], s35 offen offset:0 sc1
buffer_load_dwordx4 a[28:31], v4, s[40:43], s35 offen offset:1024 sc1
s_xor_b32 s35, s9, 32768
buffer_load_dwordx4 a[32:35], v4, s[40:43], s35 offen offset:0 sc1
buffer_load_dwordx4 a[36:39], v4, s[40:43], s35 offen offset:1024 sc1
s_xor_b32 s35, s9, 36864
buffer_load_dwordx4 a[40:43], v4, s[40:43], s35 offen offset:0 sc1
buffer_load_dwordx4 a[44:47], v4, s[40:43], s35 offen offset:1024 sc1
s_xor_b32 s35, s9, 49152
ds_read_b128 a[96:99], v5 offset:0
ds_read_b128 a[100:103], v5 offset:1024
ds_read_b128 a[104:107], v5 offset:2048
ds_read_b128 a[108:111], v5 offset:3072
ds_read_b128 a[112:115], v5 offset:4096
ds_read_b128 a[116:119], v5 offset:5120
ds_read_b128 a[120:123], v5 offset:6144
ds_read_b128 a[124:127], v5 offset:7168
s_waitcnt vmcnt(10) lgkmcnt(4)
v_mfma_f32_16x16x32_bf16 v[132:135], a[96:99], a[0:3], v[132:135]
ds_read_b128 a[128:131], v5 offset:8192
v_mfma_f32_16x16x32_bf16 v[148:151], a[96:99], a[4:7], v[148:151]
ds_read_b128 a[132:135], v5 offset:9216
v_mfma_f32_16x16x32_bf16 v[152:155], a[100:103], a[4:7], v[152:155]
buffer_load_dwordx4 a[48:51], v4, s[40:43], s35 offen offset:0 sc1
v_mfma_f32_16x16x32_bf16 v[136:139], a[100:103], a[0:3], v[136:139]
ds_read_b128 a[136:139], v5 offset:10240
v_mfma_f32_16x16x32_bf16 v[140:143], a[104:107], a[0:3], v[140:143]
ds_read_b128 a[140:143], v5 offset:11264
v_mfma_f32_16x16x32_bf16 v[156:159], a[104:107], a[4:7], v[156:159]
v_mfma_f32_16x16x32_bf16 v[160:163], a[108:111], a[4:7], v[160:163]
buffer_load_dwordx4 a[52:55], v4, s[40:43], s35 offen offset:1024 sc1
s_xor_b32 s35, s9, 53248
v_mfma_f32_16x16x32_bf16 v[144:147], a[108:111], a[0:3], v[144:147]
s_waitcnt vmcnt(10) lgkmcnt(4)
v_mfma_f32_16x16x32_bf16 v[132:135], a[112:115], a[8:11], v[132:135]
ds_read_b128 a[96:99], v5 offset:12288
L_stub19:
s_cbranch_execz L_wret7
v_mfma_f32_16x16x32_bf16 v[148:151], a[112:115], a[12:15], v[148:151]
ds_read_b128 a[100:103], v5 offset:13312
v_mfma_f32_16x16x32_bf16 v[152:155], a[116:119], a[12:15], v[152:155]
buffer_load_dwordx4 a[0:3], v4, s[40:43], s35 offen offset:0 sc1
v_mfma_f32_16x16x32_bf16 v[136:139], a[116:119], a[8:11], v[136:139]
ds_read_b128 a[104:107], v5 offset:14336
v_mfma_f32_16x16x32_bf16 v[140:143], a[120:123], a[8:11], v[140:143]
ds_read_b128 a[108:111], v5 offset:15360
v_mfma_f32_16x16x32_bf16 v[156:159], a[120:123], a[12:15], v[156:159]
v_mfma_f32_16x16x32_bf16 v[160:163], a[124:127], a[12:15], v[160:163]
buffer_load_dwordx4 a[4:7], v4, s[40:43], s35 offen offset:1024 sc1
s_xor_b32 s35, s9, 65536
v_mfma_f32_16x16x32_bf16 v[144:147], a[124:127], a[8:11], v[144:147]
s_waitcnt vmcnt(10) lgkmcnt(4)
v_mfma_f32_16x16x32_bf16 v[132:135], a[128:131], a[16:19], v[132:135]
ds_read_b128 a[112:115], v5 offset:16384
v_mfma_f32_16x16x32_bf16 v[148:151], a[128:131], a[20:23], v[148:151]
ds_read_b128 a[116:119], v5 offset:17408
v_mfma_f32_16x16x32_bf16 v[152:155], a[132:135], a[20:23], v[152:155]
buffer_load_dwordx4 a[8:11], v4, s[40:43], s35 offen offset:0 sc1
v_mfma_f32_16x16x32_bf16 v[136:139], a[132:135], a[16:19], v[136:139]
ds_read_b128 a[120:123], v5 offset:18432
v_mfma_f32_16x16x32_bf16 v[140:143], a[136:139], a[16:19], v[140:143]
ds_read_b128 a[124:127], v5 offset:19456
v_mfma_f32_16x16x32_bf16 v[156:159], a[136:139], a[20:23], v[156:159]
v_mfma_f32_16x16x32_bf16 v[160:163], a[140:143], a[20:23], v[160:163]
buffer_load_dwordx4 a[12:15], v4, s[40:43], s35 offen offset:1024 sc1
s_xor_b32 s35, s9, 69632
v_mfma_f32_16x16x32_bf16 v[144:147], a[140:143], a[16:19], v[144:147]
s_waitcnt vmcnt(10) lgkmcnt(4)
v_mfma_f32_16x16x32_bf16 v[132:135], a[96:99], a[24:27], v[132:135]
ds_read_b128 a[128:131], v5 offset:20480
v_mfma_f32_16x16x32_bf16 v[148:151], a[96:99], a[28:31], v[148:151]
ds_read_b128 a[132:135], v5 offset:21504
v_mfma_f32_16x16x32_bf16 v[152:155], a[100:103], a[28:31], v[152:155]
buffer_load_dwordx4 a[16:19], v4, s[40:43], s35 offen offset:0 sc1
v_mfma_f32_16x16x32_bf16 v[136:139], a[100:103], a[24:27], v[136:139]
ds_read_b128 a[136:139], v5 offset:22528
v_mfma_f32_16x16x32_bf16 v[140:143], a[104:107], a[24:27], v[140:143]
ds_read_b128 a[140:143], v5 offset:23552
v_mfma_f32_16x16x32_bf16 v[156:159], a[104:107], a[28:31], v[156:159]
v_mfma_f32_16x16x32_bf16 v[160:163], a[108:111], a[28:31], v[160:163]
buffer_load_dwordx4 a[20:23], v4, s[40:43], s35 offen offset:1024 sc1
s_xor_b32 s35, s9, 81920
v_mfma_f32_16x16x32_bf16 v[144:147], a[108:111], a[24:27], v[144:147]
s_waitcnt vmcnt(10) lgkmcnt(4)
v_mfma_f32_16x16x32_bf16 v[132:135], a[112:115], a[32:35], v[132:135]
ds_read_b128 a[96:99], v5 offset:24576
v_mfma_f32_16x16x32_bf16 v[148:151], a[112:115], a[36:39], v[148:151]
ds_read_b128 a[100:103], v5 offset:25600
v_mfma_f32_16x16x32_bf16 v[152:155], a[116:119], a[36:39], v[152:155]
buffer_load_dwordx4 a[24:27], v4, s[40:43], s35 offen offset:0 sc1
v_mfma_f32_16x16x32_bf16 v[136:139], a[116:119], a[32:35], v[136:139]
ds_read_b128 a[104:107], v5 offset:26624
v_mfma_f32_16x16x32_bf16 v[140:143], a[120:123], a[32:35], v[140:143]
ds_read_b128 a[108:111], v5 offset:27648
v_mfma_f32_16x16x32_bf16 v[156:159], a[120:123], a[36:39], v[156:159]
v_mfma_f32_16x16x32_bf16 v[160:163], a[124:127], a[36:39], v[160:163]
buffer_load_dwordx4 a[28:31], v4, s[40:43], s35 offen offset:1024 sc1
s_xor_b32 s35, s9, 86016
v_mfma_f32_16x16x32_bf16 v[144:147], a[124:127], a[32:35], v[144:147]
s_waitcnt vmcnt(10) lgkmcnt(4)
v_mfma_f32_16x16x32_bf16 v[132:135], a[128:131], a[40:43], v[132:135]
ds_read_b128 a[112:115], v5 offset:28672
v_mfma_f32_16x16x32_bf16 v[148:151], a[128:131], a[44:47], v[148:151]
ds_read_b128 a[116:119], v5 offset:29696
v_mfma_f32_16x16x32_bf16 v[152:155], a[132:135], a[44:47], v[152:155]
buffer_load_dwordx4 a[32:35], v4, s[40:43], s35 offen offset:0 sc1
v_mfma_f32_16x16x32_bf16 v[136:139], a[132:135], a[40:43], v[136:139]
ds_read_b128 a[120:123], v5 offset:30720
v_mfma_f32_16x16x32_bf16 v[140:143], a[136:139], a[40:43], v[140:143]
ds_read_b128 a[124:127], v5 offset:31744
v_mfma_f32_16x16x32_bf16 v[156:159], a[136:139], a[44:47], v[156:159]
v_mfma_f32_16x16x32_bf16 v[160:163], a[140:143], a[44:47], v[160:163]
buffer_load_dwordx4 a[36:39], v4, s[40:43], s35 offen offset:1024 sc1
s_xor_b32 s35, s9, 98304
v_mfma_f32_16x16x32_bf16 v[144:147], a[140:143], a[40:43], v[144:147]
s_waitcnt vmcnt(10) lgkmcnt(4)
v_mfma_f32_16x16x32_bf16 v[132:135], a[96:99], a[48:51], v[132:135]
ds_read_b128 a[128:131], v5 offset:32768
v_mfma_f32_16x16x32_bf16 v[148:151], a[96:99], a[52:55], v[148:151]
ds_read_b128 a[132:135], v5 offset:33792
v_mfma_f32_16x16x32_bf16 v[152:155], a[100:103], a[52:55], v[152:155]
buffer_load_dwordx4 a[40:43], v4, s[40:43], s35 offen offset:0 sc1
v_mfma_f32_16x16x32_bf16 v[136:139], a[100:103], a[48:51], v[136:139]
ds_read_b128 a[136:139], v5 offset:34816
v_mfma_f32_16x16x32_bf16 v[140:143], a[104:107], a[48:51], v[140:143]
ds_read_b128 a[140:143], v5 offset:35840
v_mfma_f32_16x16x32_bf16 v[156:159], a[104:107], a[52:55], v[156:159]
v_mfma_f32_16x16x32_bf16 v[160:163], a[108:111], a[52:55], v[160:163]
buffer_load_dwordx4 a[44:47], v4, s[40:43], s35 offen offset:1024 sc1
s_xor_b32 s35, s9, 102400
v_mfma_f32_16x16x32_bf16 v[144:147], a[108:111], a[48:51], v[144:147]
s_waitcnt vmcnt(10) lgkmcnt(4)
v_mfma_f32_16x16x32_bf16 v[132:135], a[112:115], a[0:3], v[132:135]
ds_read_b128 a[96:99], v5 offset:36864
v_mfma_f32_16x16x32_bf16 v[148:151], a[112:115], a[4:7], v[148:151]
ds_read_b128 a[100:103], v5 offset:37888
v_mfma_f32_16x16x32_bf16 v[152:155], a[116:119], a[4:7], v[152:155]
buffer_load_dwordx4 a[48:51], v4, s[40:43], s35 offen offset:0 sc1
v_mfma_f32_16x16x32_bf16 v[136:139], a[116:119], a[0:3], v[136:139]
ds_read_b128 a[104:107], v5 offset:38912
v_mfma_f32_16x16x32_bf16 v[140:143], a[120:123], a[0:3], v[140:143]
ds_read_b128 a[108:111], v5 offset:39936
v_mfma_f32_16x16x32_bf16 v[156:159], a[120:123], a[4:7], v[156:159]
v_mfma_f32_16x16x32_bf16 v[160:163], a[124:127], a[4:7], v[160:163]
buffer_load_dwordx4 a[52:55], v4, s[40:43], s35 offen offset:1024 sc1
s_xor_b32 s35, s9, 114688
v_mfma_f32_16x16x32_bf16 v[144:147], a[124:127], a[0:3], v[144:147]
s_waitcnt vmcnt(10) lgkmcnt(4)
v_mfma_f32_16x16x32_bf16 v[132:135], a[128:131], a[8:11], v[132:135]
ds_read_b128 a[112:115], v5 offset:40960
v_mfma_f32_16x16x32_bf16 v[148:151], a[128:131], a[12:15], v[148:151]
ds_read_b128 a[116:119], v5 offset:41984
v_mfma_f32_16x16x32_bf16 v[152:155], a[132:135], a[12:15], v[152:155]
buffer_load_dwordx4 a[0:3], v4, s[40:43], s35 offen offset:0 sc1
v_mfma_f32_16x16x32_bf16 v[136:139], a[132:135], a[8:11], v[136:139]
ds_read_b128 a[120:123], v5 offset:43008
v_mfma_f32_16x16x32_bf16 v[140:143], a[136:139], a[8:11], v[140:143]
ds_read_b128 a[124:127], v5 offset:44032
v_mfma_f32_16x16x32_bf16 v[156:159], a[136:139], a[12:15], v[156:159]
v_mfma_f32_16x16x32_bf16 v[160:163], a[140:143], a[12:15], v[160:163]
buffer_load_dwordx4 a[4:7], v4, s[40:43], s35 offen offset:1024 sc1
s_xor_b32 s35, s9, 118784
v_mfma_f32_16x16x32_bf16 v[144:147], a[140:143], a[8:11], v[144:147]
s_waitcnt vmcnt(10) lgkmcnt(4)
v_mfma_f32_16x16x32_bf16 v[132:135], a[96:99], a[16:19], v[132:135]
ds_read_b128 a[128:131], v5 offset:45056
v_mfma_f32_16x16x32_bf16 v[148:151], a[96:99], a[20:23], v[148:151]
ds_read_b128 a[132:135], v5 offset:46080
v_mfma_f32_16x16x32_bf16 v[152:155], a[100:103], a[20:23], v[152:155]
buffer_load_dwordx4 a[8:11], v4, s[40:43], s35 offen offset:0 sc1
v_mfma_f32_16x16x32_bf16 v[136:139], a[100:103], a[16:19], v[136:139]
ds_read_b128 a[136:139], v5 offset:47104
v_mfma_f32_16x16x32_bf16 v[140:143], a[104:107], a[16:19], v[140:143]
ds_read_b128 a[140:143], v5 offset:48128
v_mfma_f32_16x16x32_bf16 v[156:159], a[104:107], a[20:23], v[156:159]
v_mfma_f32_16x16x32_bf16 v[160:163], a[108:111], a[20:23], v[160:163]
buffer_load_dwordx4 a[12:15], v4, s[40:43], s35 offen offset:1024 sc1
s_xor_b32 s35, s9, 524288
v_mfma_f32_16x16x32_bf16 v[144:147], a[108:111], a[16:19], v[144:147]
s_waitcnt vmcnt(10) lgkmcnt(4)
v_mfma_f32_16x16x32_bf16 v[132:135], a[112:115], a[24:27], v[132:135]
ds_read_b128 a[96:99], v5 offset:49152
v_mfma_f32_16x16x32_bf16 v[148:151], a[112:115], a[28:31], v[148:151]
ds_read_b128 a[100:103], v5 offset:50176
v_mfma_f32_16x16x32_bf16 v[152:155], a[116:119], a[28:31], v[152:155]
buffer_load_dwordx4 a[16:19], v4, s[40:43], s35 offen offset:0 sc1
v_mfma_f32_16x16x32_bf16 v[136:139], a[116:119], a[24:27], v[136:139]
ds_read_b128 a[104:107], v5 offset:51200
v_mfma_f32_16x16x32_bf16 v[140:143], a[120:123], a[24:27], v[140:143]
ds_read_b128 a[108:111], v5 offset:52224
v_mfma_f32_16x16x32_bf16 v[156:159], a[120:123], a[28:31], v[156:159]
v_mfma_f32_16x16x32_bf16 v[160:163], a[124:127], a[28:31], v[160:163]
buffer_load_dwordx4 a[20:23], v4, s[40:43], s35 offen offset:1024 sc1
s_xor_b32 s35, s9, 528384
v_mfma_f32_16x16x32_bf16 v[144:147], a[124:127], a[24:27], v[144:147]
s_waitcnt vmcnt(10) lgkmcnt(4)
v_mfma_f32_16x16x32_bf16 v[132:135], a[128:131], a[32:35], v[132:135]
ds_read_b128 a[112:115], v5 offset:53248
v_mfma_f32_16x16x32_bf16 v[148:151], a[128:131], a[36:39], v[148:151]
ds_read_b128 a[116:119], v5 offset:54272
v_mfma_f32_16x16x32_bf16 v[152:155], a[132:135], a[36:39], v[152:155]
buffer_load_dwordx4 a[24:27], v4, s[40:43], s35 offen offset:0 sc1
v_mfma_f32_16x16x32_bf16 v[136:139], a[132:135], a[32:35], v[136:139]
ds_read_b128 a[120:123], v5 offset:55296
v_mfma_f32_16x16x32_bf16 v[140:143], a[136:139], a[32:35], v[140:143]
ds_read_b128 a[124:127], v5 offset:56320
v_mfma_f32_16x16x32_bf16 v[156:159], a[136:139], a[36:39], v[156:159]
v_mfma_f32_16x16x32_bf16 v[160:163], a[140:143], a[36:39], v[160:163]
buffer_load_dwordx4 a[28:31], v4, s[40:43], s35 offen offset:1024 sc1
s_xor_b32 s35, s9, 540672
v_mfma_f32_16x16x32_bf16 v[144:147], a[140:143], a[32:35], v[144:147]
s_waitcnt vmcnt(10) lgkmcnt(4)
v_mfma_f32_16x16x32_bf16 v[132:135], a[96:99], a[40:43], v[132:135]
ds_read_b128 a[128:131], v5 offset:57344
v_mfma_f32_16x16x32_bf16 v[148:151], a[96:99], a[44:47], v[148:151]
ds_read_b128 a[132:135], v5 offset:58368
v_mfma_f32_16x16x32_bf16 v[152:155], a[100:103], a[44:47], v[152:155]
buffer_load_dwordx4 a[32:35], v4, s[40:43], s35 offen offset:0 sc1
v_mfma_f32_16x16x32_bf16 v[136:139], a[100:103], a[40:43], v[136:139]
ds_read_b128 a[136:139], v5 offset:59392
v_mfma_f32_16x16x32_bf16 v[140:143], a[104:107], a[40:43], v[140:143]
ds_read_b128 a[140:143], v5 offset:60416
v_mfma_f32_16x16x32_bf16 v[156:159], a[104:107], a[44:47], v[156:159]
v_mfma_f32_16x16x32_bf16 v[160:163], a[108:111], a[44:47], v[160:163]
buffer_load_dwordx4 a[36:39], v4, s[40:43], s35 offen offset:1024 sc1
s_xor_b32 s35, s9, 544768
v_mfma_f32_16x16x32_bf16 v[144:147], a[108:111], a[40:43], v[144:147]
s_waitcnt vmcnt(10) lgkmcnt(4)
v_mfma_f32_16x16x32_bf16 v[132:135], a[112:115], a[48:51], v[132:135]
ds_read_b128 a[96:99], v5 offset:61440
v_mfma_f32_16x16x32_bf16 v[148:151], a[112:115], a[52:55], v[148:151]
ds_read_b128 a[100:103], v5 offset:62464
v_mfma_f32_16x16x32_bf16 v[152:155], a[116:119], a[52:55], v[152:155]
buffer_load_dwordx4 a[40:43], v4, s[40:43], s35 offen offset:0 sc1
v_mfma_f32_16x16x32_bf16 v[136:139], a[116:119], a[48:51], v[136:139]
ds_read_b128 a[104:107], v5 offset:63488
v_mfma_f32_16x16x32_bf16 v[140:143], a[120:123], a[48:51], v[140:143]
ds_read_b128 a[108:111], v5 offset:64512
v_mfma_f32_16x16x32_bf16 v[156:159], a[120:123], a[52:55], v[156:159]
v_mfma_f32_16x16x32_bf16 v[160:163], a[124:127], a[52:55], v[160:163]
buffer_load_dwordx4 a[44:47], v4, s[40:43], s35 offen offset:1024 sc1
s_xor_b32 s35, s9, 557056
v_mfma_f32_16x16x32_bf16 v[144:147], a[124:127], a[48:51], v[144:147]
s_waitcnt vmcnt(10) lgkmcnt(4)
v_mfma_f32_16x16x32_bf16 v[132:135], a[128:131], a[0:3], v[132:135]
ds_read_b128 a[112:115], v6 offset:0
v_mfma_f32_16x16x32_bf16 v[148:151], a[128:131], a[4:7], v[148:151]
ds_read_b128 a[116:119], v6 offset:1024
v_mfma_f32_16x16x32_bf16 v[152:155], a[132:135], a[4:7], v[152:155]
buffer_load_dwordx4 a[48:51], v4, s[40:43], s35 offen offset:0 sc1
v_mfma_f32_16x16x32_bf16 v[136:139], a[132:135], a[0:3], v[136:139]
ds_read_b128 a[120:123], v6 offset:2048
v_mfma_f32_16x16x32_bf16 v[140:143], a[136:139], a[0:3], v[140:143]
ds_read_b128 a[124:127], v6 offset:3072
v_mfma_f32_16x16x32_bf16 v[156:159], a[136:139], a[4:7], v[156:159]
v_mfma_f32_16x16x32_bf16 v[160:163], a[140:143], a[4:7], v[160:163]
buffer_load_dwordx4 a[52:55], v4, s[40:43], s35 offen offset:1024 sc1
s_xor_b32 s35, s9, 561152
v_mfma_f32_16x16x32_bf16 v[144:147], a[140:143], a[0:3], v[144:147]
s_waitcnt vmcnt(10) lgkmcnt(4)
v_mfma_f32_16x16x32_bf16 v[132:135], a[96:99], a[8:11], v[132:135]
ds_read_b128 a[128:131], v6 offset:4096
v_mfma_f32_16x16x32_bf16 v[148:151], a[96:99], a[12:15], v[148:151]
ds_read_b128 a[132:135], v6 offset:5120
v_mfma_f32_16x16x32_bf16 v[152:155], a[100:103], a[12:15], v[152:155]
buffer_load_dwordx4 a[0:3], v4, s[40:43], s35 offen offset:0 sc1
v_mfma_f32_16x16x32_bf16 v[136:139], a[100:103], a[8:11], v[136:139]
ds_read_b128 a[136:139], v6 offset:6144
v_mfma_f32_16x16x32_bf16 v[140:143], a[104:107], a[8:11], v[140:143]
ds_read_b128 a[140:143], v6 offset:7168
v_mfma_f32_16x16x32_bf16 v[156:159], a[104:107], a[12:15], v[156:159]
v_mfma_f32_16x16x32_bf16 v[160:163], a[108:111], a[12:15], v[160:163]
buffer_load_dwordx4 a[4:7], v4, s[40:43], s35 offen offset:1024 sc1
s_xor_b32 s35, s9, 573440
v_mfma_f32_16x16x32_bf16 v[144:147], a[108:111], a[8:11], v[144:147]
s_waitcnt vmcnt(10) lgkmcnt(4)
v_mfma_f32_16x16x32_bf16 v[132:135], a[112:115], a[16:19], v[132:135]
ds_read_b128 a[96:99], v6 offset:8192
v_mfma_f32_16x16x32_bf16 v[148:151], a[112:115], a[20:23], v[148:151]
ds_read_b128 a[100:103], v6 offset:9216
v_mfma_f32_16x16x32_bf16 v[152:155], a[116:119], a[20:23], v[152:155]
buffer_load_dwordx4 a[8:11], v4, s[40:43], s35 offen offset:0 sc1
v_mfma_f32_16x16x32_bf16 v[136:139], a[116:119], a[16:19], v[136:139]
ds_read_b128 a[104:107], v6 offset:10240
v_mfma_f32_16x16x32_bf16 v[140:143], a[120:123], a[16:19], v[140:143]
ds_read_b128 a[108:111], v6 offset:11264
v_mfma_f32_16x16x32_bf16 v[156:159], a[120:123], a[20:23], v[156:159]
v_mfma_f32_16x16x32_bf16 v[160:163], a[124:127], a[20:23], v[160:163]
buffer_load_dwordx4 a[12:15], v4, s[40:43], s35 offen offset:1024 sc1
s_xor_b32 s35, s9, 577536
v_mfma_f32_16x16x32_bf16 v[144:147], a[124:127], a[16:19], v[144:147]
s_waitcnt vmcnt(10) lgkmcnt(4)
v_mfma_f32_16x16x32_bf16 v[132:135], a[128:131], a[24:27], v[132:135]
ds_read_b128 a[112:115], v6 offset:12288
v_mfma_f32_16x16x32_bf16 v[148:151], a[128:131], a[28:31], v[148:151]
ds_read_b128 a[116:119], v6 offset:13312
v_mfma_f32_16x16x32_bf16 v[152:155], a[132:135], a[28:31], v[152:155]
buffer_load_dwordx4 a[16:19], v4, s[40:43], s35 offen offset:0 sc1
v_mfma_f32_16x16x32_bf16 v[136:139], a[132:135], a[24:27], v[136:139]
ds_read_b128 a[120:123], v6 offset:14336
v_mfma_f32_16x16x32_bf16 v[140:143], a[136:139], a[24:27], v[140:143]
ds_read_b128 a[124:127], v6 offset:15360
v_mfma_f32_16x16x32_bf16 v[156:159], a[136:139], a[28:31], v[156:159]
v_mfma_f32_16x16x32_bf16 v[160:163], a[140:143], a[28:31], v[160:163]
buffer_load_dwordx4 a[20:23], v4, s[40:43], s35 offen offset:1024 sc1
s_xor_b32 s35, s9, 589824
v_mfma_f32_16x16x32_bf16 v[144:147], a[140:143], a[24:27], v[144:147]
s_waitcnt vmcnt(10) lgkmcnt(4)
v_mfma_f32_16x16x32_bf16 v[132:135], a[96:99], a[32:35], v[132:135]
ds_read_b128 a[128:131], v6 offset:16384
v_mfma_f32_16x16x32_bf16 v[148:151], a[96:99], a[36:39], v[148:151]
ds_read_b128 a[132:135], v6 offset:17408
v_mfma_f32_16x16x32_bf16 v[152:155], a[100:103], a[36:39], v[152:155]
buffer_load_dwordx4 a[24:27], v4, s[40:43], s35 offen offset:0 sc1
v_mfma_f32_16x16x32_bf16 v[136:139], a[100:103], a[32:35], v[136:139]
ds_read_b128 a[136:139], v6 offset:18432
v_mfma_f32_16x16x32_bf16 v[140:143], a[104:107], a[32:35], v[140:143]
ds_read_b128 a[140:143], v6 offset:19456
v_mfma_f32_16x16x32_bf16 v[156:159], a[104:107], a[36:39], v[156:159]
v_mfma_f32_16x16x32_bf16 v[160:163], a[108:111], a[36:39], v[160:163]
buffer_load_dwordx4 a[28:31], v4, s[40:43], s35 offen offset:1024 sc1
s_xor_b32 s35, s9, 593920
v_mfma_f32_16x16x32_bf16 v[144:147], a[108:111], a[32:35], v[144:147]
s_waitcnt vmcnt(10) lgkmcnt(4)
v_mfma_f32_16x16x32_bf16 v[132:135], a[112:115], a[40:43], v[132:135]
ds_read_b128 a[96:99], v6 offset:20480
v_mfma_f32_16x16x32_bf16 v[148:151], a[112:115], a[44:47], v[148:151]
ds_read_b128 a[100:103], v6 offset:21504
v_mfma_f32_16x16x32_bf16 v[152:155], a[116:119], a[44:47], v[152:155]
buffer_load_dwordx4 a[32:35], v4, s[40:43], s35 offen offset:0 sc1
v_mfma_f32_16x16x32_bf16 v[136:139], a[116:119], a[40:43], v[136:139]
ds_read_b128 a[104:107], v6 offset:22528
v_mfma_f32_16x16x32_bf16 v[140:143], a[120:123], a[40:43], v[140:143]
ds_read_b128 a[108:111], v6 offset:23552
v_mfma_f32_16x16x32_bf16 v[156:159], a[120:123], a[44:47], v[156:159]
v_mfma_f32_16x16x32_bf16 v[160:163], a[124:127], a[44:47], v[160:163]
buffer_load_dwordx4 a[36:39], v4, s[40:43], s35 offen offset:1024 sc1
s_xor_b32 s35, s9, 606208
v_mfma_f32_16x16x32_bf16 v[144:147], a[124:127], a[40:43], v[144:147]
s_waitcnt vmcnt(10) lgkmcnt(4)
v_mfma_f32_16x16x32_bf16 v[132:135], a[128:131], a[48:51], v[132:135]
ds_read_b128 a[112:115], v6 offset:24576
v_mfma_f32_16x16x32_bf16 v[148:151], a[128:131], a[52:55], v[148:151]
ds_read_b128 a[116:119], v6 offset:25600
v_mfma_f32_16x16x32_bf16 v[152:155], a[132:135], a[52:55], v[152:155]
buffer_load_dwordx4 a[40:43], v4, s[40:43], s35 offen offset:0 sc1
v_mfma_f32_16x16x32_bf16 v[136:139], a[132:135], a[48:51], v[136:139]
ds_read_b128 a[120:123], v6 offset:26624
v_mfma_f32_16x16x32_bf16 v[140:143], a[136:139], a[48:51], v[140:143]
ds_read_b128 a[124:127], v6 offset:27648
v_mfma_f32_16x16x32_bf16 v[156:159], a[136:139], a[52:55], v[156:159]
v_mfma_f32_16x16x32_bf16 v[160:163], a[140:143], a[52:55], v[160:163]
buffer_load_dwordx4 a[44:47], v4, s[40:43], s35 offen offset:1024 sc1
s_xor_b32 s35, s9, 610304
v_mfma_f32_16x16x32_bf16 v[144:147], a[140:143], a[48:51], v[144:147]
s_waitcnt vmcnt(10) lgkmcnt(4)
v_mfma_f32_16x16x32_bf16 v[132:135], a[96:99], a[0:3], v[132:135]
ds_read_b128 a[128:131], v6 offset:28672
v_mfma_f32_16x16x32_bf16 v[148:151], a[96:99], a[4:7], v[148:151]
ds_read_b128 a[132:135], v6 offset:29696
v_mfma_f32_16x16x32_bf16 v[152:155], a[100:103], a[4:7], v[152:155]
buffer_load_dwordx4 a[48:51], v4, s[40:43], s35 offen offset:0 sc1
v_mfma_f32_16x16x32_bf16 v[136:139], a[100:103], a[0:3], v[136:139]
ds_read_b128 a[136:139], v6 offset:30720
v_mfma_f32_16x16x32_bf16 v[140:143], a[104:107], a[0:3], v[140:143]
ds_read_b128 a[140:143], v6 offset:31744
v_mfma_f32_16x16x32_bf16 v[156:159], a[104:107], a[4:7], v[156:159]
v_mfma_f32_16x16x32_bf16 v[160:163], a[108:111], a[4:7], v[160:163]
buffer_load_dwordx4 a[52:55], v4, s[40:43], s35 offen offset:1024 sc1
s_xor_b32 s35, s9, 622592
v_mfma_f32_16x16x32_bf16 v[144:147], a[108:111], a[0:3], v[144:147]
s_waitcnt vmcnt(10) lgkmcnt(4)
v_mfma_f32_16x16x32_bf16 v[132:135], a[112:115], a[8:11], v[132:135]
ds_read_b128 a[96:99], v6 offset:32768
v_mfma_f32_16x16x32_bf16 v[148:151], a[112:115], a[12:15], v[148:151]
ds_read_b128 a[100:103], v6 offset:33792
v_mfma_f32_16x16x32_bf16 v[152:155], a[116:119], a[12:15], v[152:155]
buffer_load_dwordx4 a[0:3], v4, s[40:43], s35 offen offset:0 sc1
v_mfma_f32_16x16x32_bf16 v[136:139], a[116:119], a[8:11], v[136:139]
ds_read_b128 a[104:107], v6 offset:34816
v_mfma_f32_16x16x32_bf16 v[140:143], a[120:123], a[8:11], v[140:143]
ds_read_b128 a[108:111], v6 offset:35840
v_mfma_f32_16x16x32_bf16 v[156:159], a[120:123], a[12:15], v[156:159]
v_mfma_f32_16x16x32_bf16 v[160:163], a[124:127], a[12:15], v[160:163]
buffer_load_dwordx4 a[4:7], v4, s[40:43], s35 offen offset:1024 sc1
s_xor_b32 s35, s9, 626688
v_mfma_f32_16x16x32_bf16 v[144:147], a[124:127], a[8:11], v[144:147]
s_waitcnt vmcnt(10) lgkmcnt(4)
v_mfma_f32_16x16x32_bf16 v[132:135], a[128:131], a[16:19], v[132:135]
ds_read_b128 a[112:115], v6 offset:36864
v_mfma_f32_16x16x32_bf16 v[148:151], a[128:131], a[20:23], v[148:151]
ds_read_b128 a[116:119], v6 offset:37888
v_mfma_f32_16x16x32_bf16 v[152:155], a[132:135], a[20:23], v[152:155]
buffer_load_dwordx4 a[8:11], v4, s[40:43], s35 offen offset:0 sc1
v_mfma_f32_16x16x32_bf16 v[136:139], a[132:135], a[16:19], v[136:139]
ds_read_b128 a[120:123], v6 offset:38912
v_mfma_f32_16x16x32_bf16 v[140:143], a[136:139], a[16:19], v[140:143]
ds_read_b128 a[124:127], v6 offset:39936
v_mfma_f32_16x16x32_bf16 v[156:159], a[136:139], a[20:23], v[156:159]
v_mfma_f32_16x16x32_bf16 v[160:163], a[140:143], a[20:23], v[160:163]
buffer_load_dwordx4 a[12:15], v4, s[40:43], s35 offen offset:1024 sc1
s_xor_b32 s35, s9, 638976
v_mfma_f32_16x16x32_bf16 v[144:147], a[140:143], a[16:19], v[144:147]
s_waitcnt vmcnt(10) lgkmcnt(4)
v_mfma_f32_16x16x32_bf16 v[132:135], a[96:99], a[24:27], v[132:135]
ds_read_b128 a[128:131], v6 offset:40960
v_mfma_f32_16x16x32_bf16 v[148:151], a[96:99], a[28:31], v[148:151]
ds_read_b128 a[132:135], v6 offset:41984
v_mfma_f32_16x16x32_bf16 v[152:155], a[100:103], a[28:31], v[152:155]
buffer_load_dwordx4 a[16:19], v4, s[40:43], s35 offen offset:0 sc1
v_mfma_f32_16x16x32_bf16 v[136:139], a[100:103], a[24:27], v[136:139]
ds_read_b128 a[136:139], v6 offset:43008
v_mfma_f32_16x16x32_bf16 v[140:143], a[104:107], a[24:27], v[140:143]
ds_read_b128 a[140:143], v6 offset:44032
v_mfma_f32_16x16x32_bf16 v[156:159], a[104:107], a[28:31], v[156:159]
v_mfma_f32_16x16x32_bf16 v[160:163], a[108:111], a[28:31], v[160:163]
buffer_load_dwordx4 a[20:23], v4, s[40:43], s35 offen offset:1024 sc1
s_xor_b32 s35, s9, 643072
v_mfma_f32_16x16x32_bf16 v[144:147], a[108:111], a[24:27], v[144:147]
s_waitcnt vmcnt(10) lgkmcnt(4)
v_mfma_f32_16x16x32_bf16 v[132:135], a[112:115], a[32:35], v[132:135]
ds_read_b128 a[96:99], v6 offset:45056
v_mfma_f32_16x16x32_bf16 v[148:151], a[112:115], a[36:39], v[148:151]
ds_read_b128 a[100:103], v6 offset:46080
v_mfma_f32_16x16x32_bf16 v[152:155], a[116:119], a[36:39], v[152:155]
buffer_load_dwordx4 a[24:27], v4, s[40:43], s35 offen offset:0 sc1
v_mfma_f32_16x16x32_bf16 v[136:139], a[116:119], a[32:35], v[136:139]
ds_read_b128 a[104:107], v6 offset:47104
v_mfma_f32_16x16x32_bf16 v[140:143], a[120:123], a[32:35], v[140:143]
ds_read_b128 a[108:111], v6 offset:48128
v_mfma_f32_16x16x32_bf16 v[156:159], a[120:123], a[36:39], v[156:159]
v_mfma_f32_16x16x32_bf16 v[160:163], a[124:127], a[36:39], v[160:163]
buffer_load_dwordx4 a[28:31], v4, s[40:43], s35 offen offset:1024 sc1
s_xor_b32 s35, s9, 0
v_mfma_f32_16x16x32_bf16 v[144:147], a[124:127], a[32:35], v[144:147]
s_waitcnt vmcnt(10) lgkmcnt(4)
v_mfma_f32_16x16x32_bf16 v[132:135], a[128:131], a[40:43], v[132:135]
ds_read_b128 a[112:115], v6 offset:49152
v_mfma_f32_16x16x32_bf16 v[148:151], a[128:131], a[44:47], v[148:151]
ds_read_b128 a[116:119], v6 offset:50176
v_mfma_f32_16x16x32_bf16 v[152:155], a[132:135], a[44:47], v[152:155]
ds_read_b128 a[120:123], v6 offset:51200
v_mfma_f32_16x16x32_bf16 v[136:139], a[132:135], a[40:43], v[136:139]
ds_read_b128 a[124:127], v6 offset:52224
v_mfma_f32_16x16x32_bf16 v[140:143], a[136:139], a[40:43], v[140:143]
v_mfma_f32_16x16x32_bf16 v[156:159], a[136:139], a[44:47], v[156:159]
v_mfma_f32_16x16x32_bf16 v[160:163], a[140:143], a[44:47], v[160:163]
v_mfma_f32_16x16x32_bf16 v[144:147], a[140:143], a[40:43], v[144:147]
s_waitcnt vmcnt(8) lgkmcnt(4)
v_mfma_f32_16x16x32_bf16 v[132:135], a[96:99], a[48:51], v[132:135]
ds_read_b128 a[128:131], v6 offset:53248
v_mfma_f32_16x16x32_bf16 v[148:151], a[96:99], a[52:55], v[148:151]
ds_read_b128 a[132:135], v6 offset:54272
v_mfma_f32_16x16x32_bf16 v[152:155], a[100:103], a[52:55], v[152:155]
ds_read_b128 a[136:139], v6 offset:55296
v_mfma_f32_16x16x32_bf16 v[136:139], a[100:103], a[48:51], v[136:139]
ds_read_b128 a[140:143], v6 offset:56320
v_mfma_f32_16x16x32_bf16 v[140:143], a[104:107], a[48:51], v[140:143]
v_mfma_f32_16x16x32_bf16 v[156:159], a[104:107], a[52:55], v[156:159]
v_mfma_f32_16x16x32_bf16 v[160:163], a[108:111], a[52:55], v[160:163]
v_mfma_f32_16x16x32_bf16 v[144:147], a[108:111], a[48:51], v[144:147]
s_waitcnt vmcnt(6) lgkmcnt(4)
v_mfma_f32_16x16x32_bf16 v[132:135], a[112:115], a[0:3], v[132:135]
ds_read_b128 a[96:99], v6 offset:57344
v_mfma_f32_16x16x32_bf16 v[148:151], a[112:115], a[4:7], v[148:151]
ds_read_b128 a[100:103], v6 offset:58368
v_mfma_f32_16x16x32_bf16 v[152:155], a[116:119], a[4:7], v[152:155]
ds_read_b128 a[104:107], v6 offset:59392
v_mfma_f32_16x16x32_bf16 v[136:139], a[116:119], a[0:3], v[136:139]
ds_read_b128 a[108:111], v6 offset:60416
v_mfma_f32_16x16x32_bf16 v[140:143], a[120:123], a[0:3], v[140:143]
v_mfma_f32_16x16x32_bf16 v[156:159], a[120:123], a[4:7], v[156:159]
v_mfma_f32_16x16x32_bf16 v[160:163], a[124:127], a[4:7], v[160:163]
v_mfma_f32_16x16x32_bf16 v[144:147], a[124:127], a[0:3], v[144:147]
s_waitcnt vmcnt(4) lgkmcnt(4)
v_mfma_f32_16x16x32_bf16 v[132:135], a[128:131], a[8:11], v[132:135]
ds_read_b128 a[112:115], v6 offset:61440
v_mfma_f32_16x16x32_bf16 v[148:151], a[128:131], a[12:15], v[148:151]
ds_read_b128 a[116:119], v6 offset:62464
v_mfma_f32_16x16x32_bf16 v[152:155], a[132:135], a[12:15], v[152:155]
ds_read_b128 a[120:123], v6 offset:63488
v_mfma_f32_16x16x32_bf16 v[136:139], a[132:135], a[8:11], v[136:139]
ds_read_b128 a[124:127], v6 offset:64512
v_mfma_f32_16x16x32_bf16 v[140:143], a[136:139], a[8:11], v[140:143]
v_mfma_f32_16x16x32_bf16 v[156:159], a[136:139], a[12:15], v[156:159]
v_mfma_f32_16x16x32_bf16 v[160:163], a[140:143], a[12:15], v[160:163]
v_mfma_f32_16x16x32_bf16 v[144:147], a[140:143], a[8:11], v[144:147]
s_waitcnt vmcnt(2) lgkmcnt(4)
v_mfma_f32_16x16x32_bf16 v[132:135], a[96:99], a[16:19], v[132:135]
v_mfma_f32_16x16x32_bf16 v[148:151], a[96:99], a[20:23], v[148:151]
v_mfma_f32_16x16x32_bf16 v[152:155], a[100:103], a[20:23], v[152:155]
v_mfma_f32_16x16x32_bf16 v[136:139], a[100:103], a[16:19], v[136:139]
v_mfma_f32_16x16x32_bf16 v[140:143], a[104:107], a[16:19], v[140:143]
v_mfma_f32_16x16x32_bf16 v[156:159], a[104:107], a[20:23], v[156:159]
v_mfma_f32_16x16x32_bf16 v[160:163], a[108:111], a[20:23], v[160:163]
v_mfma_f32_16x16x32_bf16 v[144:147], a[108:111], a[16:19], v[144:147]
s_waitcnt vmcnt(0) lgkmcnt(0)
v_mfma_f32_16x16x32_bf16 v[132:135], a[112:115], a[24:27], v[132:135]
v_mfma_f32_16x16x32_bf16 v[148:151], a[112:115], a[28:31], v[148:151]
v_mfma_f32_16x16x32_bf16 v[152:155], a[116:119], a[28:31], v[152:155]
v_mfma_f32_16x16x32_bf16 v[136:139], a[116:119], a[24:27], v[136:139]
v_mfma_f32_16x16x32_bf16 v[140:143], a[120:123], a[24:27], v[140:143]
v_mfma_f32_16x16x32_bf16 v[156:159], a[120:123], a[28:31], v[156:159]
v_mfma_f32_16x16x32_bf16 v[160:163], a[124:127], a[28:31], v[160:163]
v_mfma_f32_16x16x32_bf16 v[144:147], a[124:127], a[24:27], v[144:147]
s_nop 1
v_cmp_u_f32 vcc, v132, v148
s_nop 0
s_and_b32 vcc_lo, vcc_lo, s95
s_cbranch_scc1 L_k2redo3
s_and_b32 s36, s31, 7
s_lshl_b32 s36, s36, 7
s_lshl_b32 s37, s28, 5
s_add_u32 s36, s36, s37
s_lshl_b32 s36, s36, 1
s_lshr_b32 s37, s31, 3
s_add_u32 s36, s36, s37
s_lshl_b32 s36, s36, 11
s_lshl_b32 s37, s32, 7
v_and_b32 v234, 15, v0
s_add_u32 s36, s36, s37
v_lshrrev_b32 v233, 4, v0
v_lshl_add_u32 v232, v234, 12, s36
v_cvt_pk_bf16_f32 v32, v132, v133
v_cvt_pk_bf16_f32 v33, v134, v135
v_cvt_pk_bf16_f32 v34, v136, v137
v_cvt_pk_bf16_f32 v35, v138, v139
v_lshl_add_u32 v232, v233, 4, v232
buffer_store_dwordx4 v[32:35], v232, s[12:15], 0 offen offset:0
v_cvt_pk_bf16_f32 v36, v140, v141
v_cvt_pk_bf16_f32 v37, v142, v143
v_cvt_pk_bf16_f32 v38, v144, v145
v_cvt_pk_bf16_f32 v39, v146, v147
v_cvt_pk_bf16_f32 v40, v148, v149
v_cvt_pk_bf16_f32 v41, v150, v151
v_cvt_pk_bf16_f32 v42, v152, v153
v_cvt_pk_bf16_f32 v43, v154, v155
s_mov_b32 s36, 0x10000
v_cvt_pk_bf16_f32 v44, v156, v157
v_cvt_pk_bf16_f32 v45, v158, v159
v_cvt_pk_bf16_f32 v46, v160, v161
buffer_store_dwordx4 v[36:39], v232, s[12:15], 0 offen offset:64
v_cvt_pk_bf16_f32 v47, v162, v163
buffer_store_dwordx4 v[40:43], v232, s[12:15], s36 offen offset:0
buffer_store_dwordx4 v[44:47], v232, s[12:15], s36 offen offset:64
s_or_b32 s36, s2, s28
s_cbranch_scc1 Lep_51
s_mov_b32 s36, 0xf0000
buffer_store_dword v15, off, s[4:7], s36 sc1
Lep_51:
L_end:
s_endpgm
L_rfix:
s_mov_b32 s37, 0
L_rfixb:
s_cmp_lg_u32 s36, 0
s_cbranch_scc1 L_rfixc
s_sleep 2
buffer_load_dword v245, off, s[24:27], 0 offset:252 sc1
s_add_u32 s37, s37, 1
s_waitcnt vmcnt(0)
v_readfirstlane_b32 s36, v245
s_cmp_lt_u32 s37, 0x100000
s_cbranch_scc1 L_rfixb
s_branch L_rok
L_rfixc:
s_cmp_eq_u32 s36, s3
s_cbranch_scc1 L_rok
s_mov_b32 s3, s36
s_waitcnt vmcnt(0)
s_load_dwordx16 s[64:79], s[0:1], 0
s_load_dwordx4 s[80:83], s[0:1], 64
s_waitcnt lgkmcnt(0)
s_branch L_roles
Ltal_6:
s_mov_b32 s53, 0
Ltal_6b:
s_sleep 8
buffer_load_dword v11, v1, s[24:27], 0 offen sc1
s_add_u32 s53, s53, 1
s_waitcnt vmcnt(0)
v_cmp_gt_u32 vcc, 0x100000, v11
s_nop 0
s_and_b32 vcc_lo, vcc_lo, 0x1f3f
s_cbranch_scc0 Ltab_7
s_cmp_lt_u32 s53, 0x100000
s_cbranch_scc1 Ltal_6b
s_branch Ltab_7
L_hxredo0:
s_mov_b32 s37, 0
L_hxredo0b:
s_sleep 2
buffer_load_dwordx4 v[228:231], v9, s[4:7], s55 offen sc1
buffer_load_dwordx4 v[72:75], v9, s[4:7], s55 offen offset:1024 sc1
s_waitcnt vmcnt(1)
v_max3_u32 v244, v228, v229, v230
s_waitcnt vmcnt(0)
v_max3_u32 v244, v244, v231, v72
v_max3_u32 v244, v244, v73, v74
v_max_u32 v244, v244, v75
v_cmp_eq_u32 vcc, -1, v244
s_cbranch_vccz L_hxback0
s_add_u32 s37, s37, 1
s_cmp_lt_u32 s37, 0x100000
s_cbranch_scc1 L_hxredo0b
s_branch L_hxback0
Ltr_13:
s_add_u32 s52, s67, 0xe0000
s_mov_b32 s53, 0
Ltp_14:
s_sleep 2
v_mov_b32 v11, v15
s_mov_b64 exec, 0xffff
v_mov_b32 v11, 0
buffer_atomic_add v11, v255, s[4:7], s52 offen sc0 sc1
s_mov_b64 exec, -1
s_add_u32 s53, s53, 1
s_waitcnt vmcnt(0)
v_cmp_ne_u32 vcc, v11, v15
s_cbranch_vccz Lte_15
s_cmp_lt_u32 s53, 0x100000
s_cbranch_scc1 Ltp_14
s_branch Lte_15
Ltr_16:
s_add_u32 s52, s66, 0xd0040
s_mov_b32 s53, 0
Ltp_17:
s_sleep 2
v_mov_b32 v232, v15
s_mov_b64 exec, 0xffff
v_mov_b32 v232, 0
buffer_atomic_add v232, v255, s[4:7], s52 offen sc0 sc1
s_mov_b64 exec, -1
s_add_u32 s53, s53, 1
s_waitcnt vmcnt(0)
v_cmp_ne_u32 vcc, v232, v15
s_cbranch_vccz Lte_18
s_cmp_lt_u32 s53, 0x100000
s_cbranch_scc1 Ltp_17
s_branch Lte_18
L_kvredo1:
s_mov_b32 s88, 0
L_kvredo1b:
v_max_u32 v132, v48, v49
v_max3_u32 v132, v132, v50, v51
v_max3_u32 v132, v132, v52, v53
v_max3_u32 v132, v132, v54, v55
v_max3_u32 v132, v132, v56, v57
v_max3_u32 v132, v132, v58, v59
v_max3_u32 v132, v132, v60, v61
v_max3_u32 v132, v132, v62, v63
v_max3_u32 v132, v132, v64, v65
v_max3_u32 v132, v132, v66, v67
v_max3_u32 v132, v132, v68, v69
v_max3_u32 v132, v132, v70, v71
v_max3_u32 v132, v132, v100, v101
v_max3_u32 v132, v132, v102, v103
v_max3_u32 v132, v132, v104, v105
v_max3_u32 v132, v132, v106, v107
v_max3_u32 v132, v132, v124, v125
v_max3_u32 v132, v132, v126, v127
v_cmp_eq_u32 vcc, -1, v132
s_cbranch_vccz L_kvback1
s_add_u32 s88, s88, 1
s_cmp_gt_u32 s88, 0x80000
s_cbranch_scc1 L_kvback1
s_sleep 4
buffer_load_dwordx4 v[48:51], v1, s[4:7], s98 offen offset:0 sc1
buffer_load_dwordx4 v[124:127], v248, s[4:7], s100 offen sc1
buffer_load_dwordx4 v[52:55], v1, s[4:7], s98 offen offset:1024 sc1
buffer_load_dwordx4 v[56:59], v1, s[4:7], s98 offen offset:2048 sc1
buffer_load_dwordx4 v[60:63], v1, s[4:7], s98 offen offset:3072 sc1
buffer_load_dwordx4 v[64:67], v1, s[4:7], s99 offen offset:0 sc1
buffer_load_dwordx4 v[68:71], v1, s[4:7], s99 offen offset:1024 sc1
buffer_load_dwordx4 v[100:103], v1, s[4:7], s99 offen offset:2048 sc1
buffer_load_dwordx4 v[104:107], v1, s[4:7], s99 offen offset:3072 sc1
s_waitcnt vmcnt(8)
v_lshlrev_b32 v92, 16, v48
v_and_b32 v93, 0xffff0000, v48
v_lshlrev_b32 v94, 16, v49
v_and_b32 v95, 0xffff0000, v49
v_lshlrev_b32 v96, 16, v50
v_and_b32 v97, 0xffff0000, v50
v_lshlrev_b32 v98, 16, v51
v_and_b32 v99, 0xffff0000, v51
s_waitcnt vmcnt(7)
v_add_f32_dpp v128, v124, v124 row_ror:4 row_mask:0xf bank_mask:0xf
v_add_f32_dpp v129, v125, v125 row_ror:4 row_mask:0xf bank_mask:0xf
v_add_f32_dpp v130, v126, v126 row_ror:4 row_mask:0xf bank_mask:0xf
v_add_f32_dpp v131, v127, v127 row_ror:4 row_mask:0xf bank_mask:0xf
v_add_f32_dpp v128, v128, v128 row_ror:2 row_mask:0xf bank_mask:0xf
v_add_f32_dpp v129, v129, v129 row_ror:2 row_mask:0xf bank_mask:0xf
v_add_f32_dpp v130, v130, v130 row_ror:2 row_mask:0xf bank_mask:0xf
v_add_f32_dpp v131, v131, v131 row_ror:2 row_mask:0xf bank_mask:0xf
v_add_f32_dpp v128, v128, v128 row_ror:1 row_mask:0xf bank_mask:0xf
v_add_f32_dpp v129, v129, v129 row_ror:1 row_mask:0xf bank_mask:0xf
v_add_f32_dpp v130, v130, v130 row_ror:1 row_mask:0xf bank_mask:0xf
v_add_f32_dpp v131, v131, v131 row_ror:1 row_mask:0xf bank_mask:0xf
s_waitcnt vmcnt(6)
v_dot2c_f32_bf16 v92, v52, v249
v_dot2c_f32_bf16 v93, v52, v250
v_dot2c_f32_bf16 v94, v53, v249
v_dot2c_f32_bf16 v95, v53, v250
v_dot2c_f32_bf16 v96, v54, v249
v_dot2c_f32_bf16 v97, v54, v250
v_dot2c_f32_bf16 v98, v55, v249
v_dot2c_f32_bf16 v99, v55, v250
s_waitcnt vmcnt(5)
v_dot2c_f32_bf16 v92, v56, v249
v_dot2c_f32_bf16 v93, v56, v250
v_dot2c_f32_bf16 v94, v57, v249
v_dot2c_f32_bf16 v95, v57, v250
v_dot2c_f32_bf16 v96, v58, v249
v_dot2c_f32_bf16 v97, v58, v250
v_dot2c_f32_bf16 v98, v59, v249
v_dot2c_f32_bf16 v99, v59, v250
s_waitcnt vmcnt(4)
v_dot2c_f32_bf16 v92, v60, v249
v_dot2c_f32_bf16 v93, v60, v250
v_dot2c_f32_bf16 v94, v61, v249
v_dot2c_f32_bf16 v95, v61, v250
v_dot2c_f32_bf16 v96, v62, v249
v_dot2c_f32_bf16 v97, v62, v250
v_dot2c_f32_bf16 v98, v63, v249
v_dot2c_f32_bf16 v99, v63, v250
s_waitcnt vmcnt(3)
v_dot2c_f32_bf16 v92, v64, v249
v_dot2c_f32_bf16 v93, v64, v250
v_dot2c_f32_bf16 v94, v65, v249
v_dot2c_f32_bf16 v95, v65, v250
v_dot2c_f32_bf16 v96, v66, v249
v_dot2c_f32_bf16 v97, v66, v250
v_dot2c_f32_bf16 v98, v67, v249
v_dot2c_f32_bf16 v99, v67, v250
s_waitcnt vmcnt(2)
v_dot2c_f32_bf16 v92, v68, v249
v_dot2c_f32_bf16 v93, v68, v250
v_dot2c_f32_bf16 v94, v69, v249
v_dot2c_f32_bf16 v95, v69, v250
v_dot2c_f32_bf16 v96, v70, v249
v_dot2c_f32_bf16 v97, v70, v250
v_dot2c_f32_bf16 v98, v71, v249
v_dot2c_f32_bf16 v99, v71, v250
s_waitcnt vmcnt(1)
v_dot2c_f32_bf16 v92, v100, v249
v_dot2c_f32_bf16 v93, v100, v250
v_dot2c_f32_bf16 v94, v101, v249
v_dot2c_f32_bf16 v95, v101, v250
v_dot2c_f32_bf16 v96, v102, v249
v_dot2c_f32_bf16 v97, v102, v250
v_dot2c_f32_bf16 v98, v103, v249
v_dot2c_f32_bf16 v99, v103, v250
s_waitcnt vmcnt(0)
v_dot2c_f32_bf16 v92, v104, v249
v_dot2c_f32_bf16 v93, v104, v250
v_dot2c_f32_bf16 v94, v105, v249
v_dot2c_f32_bf16 v95, v105, v250
v_dot2c_f32_bf16 v96, v106, v249
v_dot2c_f32_bf16 v97, v106, v250
v_dot2c_f32_bf16 v98, v107, v249
v_dot2c_f32_bf16 v99, v107, v250
s_nop 2
s_branch L_kvredo1b
L_k2redo1:
s_mov_b32 s95, 0
s_mov_b32 s92, 0x40000000
s_mov_b32 s93, 0x40000000
s_mov_b32 s94, 0x40000000
s_mov_b32 s37, 0
L_k2redo1a:
s_sleep 4
v_mov_b32 v108, 0
s_mov_b32 s36, 0
L_k2redo1b:
s_lshr_b32 s39, s36, 3
s_mul_i32 s39, s39, 524288
s_and_b32 s38, s36, 7
s_lshl_b32 s38, s38, 14
s_add_u32 s38, s38, s39
s_xor_b32 s38, s38, s9
s_add_u32 s39, s38, 4096
buffer_load_dwordx4 v[92:95], v4, s[40:43], s38 offen offset:0 sc1
buffer_load_dwordx4 v[96:99], v4, s[40:43], s38 offen offset:1024 sc1
buffer_load_dwordx4 v[100:103], v4, s[40:43], s39 offen offset:0 sc1
buffer_load_dwordx4 v[104:107], v4, s[40:43], s39 offen offset:1024 sc1
s_waitcnt vmcnt(3)
v_max3_u32 v108, v108, v92, v93
v_max3_u32 v108, v108, v94, v95
s_waitcnt vmcnt(2)
v_max3_u32 v108, v108, v96, v97
v_max3_u32 v108, v108, v98, v99
s_waitcnt vmcnt(1)
v_max3_u32 v108, v108, v100, v101
v_max3_u32 v108, v108, v102, v103
s_waitcnt vmcnt(0)
v_max3_u32 v108, v108, v104, v105
v_max3_u32 v108, v108, v106, v107
s_add_u32 s36, s36, 1
s_cmp_lt_u32 s36, 16
s_cbranch_scc1 L_k2redo1b
v_cmp_eq_u32 vcc, -1, v108
s_cbranch_vccz L_k2redo1c
s_add_u32 s37, s37, 1
s_cmp_lt_u32 s37, 0x8000
s_cbranch_scc1 L_k2redo1a
L_k2redo1c:
s_nop 7
s_mov_b32 s35, s9
v_lshlrev_b32 v132, 16, v32
v_and_b32 v133, 0xffff0000, v32
v_lshlrev_b32 v134, 16, v33
v_and_b32 v135, 0xffff0000, v33
v_lshlrev_b32 v136, 16, v34
v_and_b32 v137, 0xffff0000, v34
v_lshlrev_b32 v138, 16, v35
v_and_b32 v139, 0xffff0000, v35
v_lshlrev_b32 v140, 16, v36
v_and_b32 v141, 0xffff0000, v36
v_lshlrev_b32 v142, 16, v37
v_and_b32 v143, 0xffff0000, v37
v_lshlrev_b32 v144, 16, v38
v_and_b32 v145, 0xffff0000, v38
v_lshlrev_b32 v146, 16, v39
v_and_b32 v147, 0xffff0000, v39
v_lshlrev_b32 v148, 16, v40
v_and_b32 v149, 0xffff0000, v40
v_lshlrev_b32 v150, 16, v41
v_and_b32 v151, 0xffff0000, v41
v_lshlrev_b32 v152, 16, v42
v_and_b32 v153, 0xffff0000, v42
v_lshlrev_b32 v154, 16, v43
v_and_b32 v155, 0xffff0000, v43
v_lshlrev_b32 v156, 16, v44
v_and_b32 v157, 0xffff0000, v44
v_lshlrev_b32 v158, 16, v45
v_and_b32 v159, 0xffff0000, v45
v_lshlrev_b32 v160, 16, v46
v_and_b32 v161, 0xffff0000, v46
v_lshlrev_b32 v162, 16, v47
v_and_b32 v163, 0xffff0000, v47
s_branch L_k2go1
L_hxredo2:
s_mov_b32 s37, 0
L_hxredo2b:
s_sleep 2
buffer_load_dwordx4 v[228:231], v9, s[4:7], s55 offen sc1
buffer_load_dwordx4 v[72:75], v9, s[4:7], s55 offen offset:1024 sc1
s_waitcnt vmcnt(1)
v_max3_u32 v244, v228, v229, v230
s_waitcnt vmcnt(0)
v_max3_u32 v244, v244, v231, v72
v_max3_u32 v244, v244, v73, v74
v_max_u32 v244, v244, v75
v_cmp_eq_u32 vcc, -1, v244
s_cbranch_vccz L_hxback2
s_add_u32 s37, s37, 1
s_cmp_lt_u32 s37, 0x100000
s_cbranch_scc1 L_hxredo2b
s_branch L_hxback2
L_k2redo2:
s_mov_b32 s95, 0
s_mov_b32 s92, 0x40000000
s_mov_b32 s93, 0x40000000
s_mov_b32 s94, 0x40000000
s_mov_b32 s37, 0
L_k2redo2a:
s_sleep 4
v_mov_b32 v108, 0
s_mov_b32 s36, 0
L_k2redo2b:
s_lshr_b32 s39, s36, 3
s_mul_i32 s39, s39, 524288
s_and_b32 s38, s36, 7
s_lshl_b32 s38, s38, 14
s_add_u32 s38, s38, s39
s_xor_b32 s38, s38, s77
s_add_u32 s39, s38, 4096
buffer_load_dwordx4 v[92:95], v4, s[40:43], s38 offen offset:0 sc1
buffer_load_dwordx4 v[96:99], v4, s[40:43], s38 offen offset:1024 sc1
buffer_load_dwordx4 v[100:103], v4, s[40:43], s39 offen offset:0 sc1
buffer_load_dwordx4 v[104:107], v4, s[40:43], s39 offen offset:1024 sc1
s_waitcnt vmcnt(3)
v_max3_u32 v108, v108, v92, v93
v_max3_u32 v108, v108, v94, v95
s_waitcnt vmcnt(2)
v_max3_u32 v108, v108, v96, v97
v_max3_u32 v108, v108, v98, v99
s_waitcnt vmcnt(1)
v_max3_u32 v108, v108, v100, v101
v_max3_u32 v108, v108, v102, v103
s_waitcnt vmcnt(0)
v_max3_u32 v108, v108, v104, v105
v_max3_u32 v108, v108, v106, v107
s_add_u32 s36, s36, 1
s_cmp_lt_u32 s36, 16
s_cbranch_scc1 L_k2redo2b
v_cmp_eq_u32 vcc, -1, v108
s_cbranch_vccz L_k2redo2c
s_add_u32 s37, s37, 1
s_cmp_lt_u32 s37, 0x8000
s_cbranch_scc1 L_k2redo2a
L_k2redo2c:
s_nop 7
s_mov_b32 s35, s77
v_lshlrev_b32 v132, 16, v32
v_and_b32 v133, 0xffff0000, v32
v_lshlrev_b32 v134, 16, v33
v_and_b32 v135, 0xffff0000, v33
v_lshlrev_b32 v136, 16, v34
v_and_b32 v137, 0xffff0000, v34
v_lshlrev_b32 v138, 16, v35
v_and_b32 v139, 0xffff0000, v35
v_lshlrev_b32 v140, 16, v36
v_and_b32 v141, 0xffff0000, v36
v_lshlrev_b32 v142, 16, v37
v_and_b32 v143, 0xffff0000, v37
v_lshlrev_b32 v144, 16, v38
v_and_b32 v145, 0xffff0000, v38
v_lshlrev_b32 v146, 16, v39
v_and_b32 v147, 0xffff0000, v39
v_lshlrev_b32 v148, 16, v40
v_and_b32 v149, 0xffff0000, v40
v_lshlrev_b32 v150, 16, v41
v_and_b32 v151, 0xffff0000, v41
v_lshlrev_b32 v152, 16, v42
v_and_b32 v153, 0xffff0000, v42
v_lshlrev_b32 v154, 16, v43
v_and_b32 v155, 0xffff0000, v43
v_lshlrev_b32 v156, 16, v44
v_and_b32 v157, 0xffff0000, v44
v_lshlrev_b32 v158, 16, v45
v_and_b32 v159, 0xffff0000, v45
v_lshlrev_b32 v160, 16, v46
v_and_b32 v161, 0xffff0000, v46
v_lshlrev_b32 v162, 16, v47
v_and_b32 v163, 0xffff0000, v47
s_branch L_k2go2
L_kvredo3:
s_mov_b32 s88, 0
L_kvredo3b:
v_max_u32 v132, v48, v49
v_max3_u32 v132, v132, v50, v51
v_max3_u32 v132, v132, v52, v53
v_max3_u32 v132, v132, v54, v55
v_max3_u32 v132, v132, v56, v57
v_max3_u32 v132, v132, v58, v59
v_max3_u32 v132, v132, v60, v61
v_max3_u32 v132, v132, v62, v63
v_max3_u32 v132, v132, v64, v65
v_max3_u32 v132, v132, v66, v67
v_max3_u32 v132, v132, v68, v69
v_max3_u32 v132, v132, v70, v71
v_max3_u32 v132, v132, v100, v101
v_max3_u32 v132, v132, v102, v103
v_max3_u32 v132, v132, v104, v105
v_max3_u32 v132, v132, v106, v107
v_max3_u32 v132, v132, v124, v125
v_max3_u32 v132, v132, v126, v127
v_cmp_eq_u32 vcc, -1, v132
s_cbranch_vccz L_kvback3
s_add_u32 s88, s88, 1
s_cmp_gt_u32 s88, 0x80000
s_cbranch_scc1 L_kvback3
s_sleep 4
buffer_load_dwordx4 v[48:51], v1, s[4:7], s98 offen offset:0 sc1
buffer_load_dwordx4 v[124:127], v248, s[4:7], s100 offen sc1
buffer_load_dwordx4 v[52:55], v1, s[4:7], s98 offen offset:1024 sc1
buffer_load_dwordx4 v[56:59], v1, s[4:7], s98 offen offset:2048 sc1
buffer_load_dwordx4 v[60:63], v1, s[4:7], s98 offen offset:3072 sc1
buffer_load_dwordx4 v[64:67], v1, s[4:7], s99 offen offset:0 sc1
buffer_load_dwordx4 v[68:71], v1, s[4:7], s99 offen offset:1024 sc1
buffer_load_dwordx4 v[100:103], v1, s[4:7], s99 offen offset:2048 sc1
buffer_load_dwordx4 v[104:107], v1, s[4:7], s99 offen offset:3072 sc1
s_waitcnt vmcnt(8)
v_lshlrev_b32 v92, 16, v48
v_and_b32 v93, 0xffff0000, v48
v_lshlrev_b32 v94, 16, v49
v_and_b32 v95, 0xffff0000, v49
v_lshlrev_b32 v96, 16, v50
v_and_b32 v97, 0xffff0000, v50
v_lshlrev_b32 v98, 16, v51
v_and_b32 v99, 0xffff0000, v51
s_waitcnt vmcnt(7)
v_add_f32_dpp v128, v124, v124 row_ror:4 row_mask:0xf bank_mask:0xf
v_add_f32_dpp v129, v125, v125 row_ror:4 row_mask:0xf bank_mask:0xf
v_add_f32_dpp v130, v126, v126 row_ror:4 row_mask:0xf bank_mask:0xf
v_add_f32_dpp v131, v127, v127 row_ror:4 row_mask:0xf bank_mask:0xf
v_add_f32_dpp v128, v128, v128 row_ror:2 row_mask:0xf bank_mask:0xf
v_add_f32_dpp v129, v129, v129 row_ror:2 row_mask:0xf bank_mask:0xf
v_add_f32_dpp v130, v130, v130 row_ror:2 row_mask:0xf bank_mask:0xf
v_add_f32_dpp v131, v131, v131 row_ror:2 row_mask:0xf bank_mask:0xf
v_add_f32_dpp v128, v128, v128 row_ror:1 row_mask:0xf bank_mask:0xf
v_add_f32_dpp v129, v129, v129 row_ror:1 row_mask:0xf bank_mask:0xf
v_add_f32_dpp v130, v130, v130 row_ror:1 row_mask:0xf bank_mask:0xf
v_add_f32_dpp v131, v131, v131 row_ror:1 row_mask:0xf bank_mask:0xf
s_waitcnt vmcnt(6)
v_dot2c_f32_bf16 v92, v52, v249
v_dot2c_f32_bf16 v93, v52, v250
v_dot2c_f32_bf16 v94, v53, v249
v_dot2c_f32_bf16 v95, v53, v250
v_dot2c_f32_bf16 v96, v54, v249
v_dot2c_f32_bf16 v97, v54, v250
v_dot2c_f32_bf16 v98, v55, v249
v_dot2c_f32_bf16 v99, v55, v250
s_waitcnt vmcnt(5)
v_dot2c_f32_bf16 v92, v56, v249
v_dot2c_f32_bf16 v93, v56, v250
v_dot2c_f32_bf16 v94, v57, v249
v_dot2c_f32_bf16 v95, v57, v250
v_dot2c_f32_bf16 v96, v58, v249
v_dot2c_f32_bf16 v97, v58, v250
v_dot2c_f32_bf16 v98, v59, v249
v_dot2c_f32_bf16 v99, v59, v250
s_waitcnt vmcnt(4)
v_dot2c_f32_bf16 v92, v60, v249
v_dot2c_f32_bf16 v93, v60, v250
v_dot2c_f32_bf16 v94, v61, v249
v_dot2c_f32_bf16 v95, v61, v250
v_dot2c_f32_bf16 v96, v62, v249
v_dot2c_f32_bf16 v97, v62, v250
v_dot2c_f32_bf16 v98, v63, v249
v_dot2c_f32_bf16 v99, v63, v250
s_waitcnt vmcnt(3)
v_dot2c_f32_bf16 v92, v64, v249
v_dot2c_f32_bf16 v93, v64, v250
v_dot2c_f32_bf16 v94, v65, v249
v_dot2c_f32_bf16 v95, v65, v250
v_dot2c_f32_bf16 v96, v66, v249
v_dot2c_f32_bf16 v97, v66, v250
v_dot2c_f32_bf16 v98, v67, v249
v_dot2c_f32_bf16 v99, v67, v250
s_waitcnt vmcnt(2)
v_dot2c_f32_bf16 v92, v68, v249
v_dot2c_f32_bf16 v93, v68, v250
v_dot2c_f32_bf16 v94, v69, v249
v_dot2c_f32_bf16 v95, v69, v250
v_dot2c_f32_bf16 v96, v70, v249
v_dot2c_f32_bf16 v97, v70, v250
v_dot2c_f32_bf16 v98, v71, v249
v_dot2c_f32_bf16 v99, v71, v250
s_waitcnt vmcnt(1)
v_dot2c_f32_bf16 v92, v100, v249
v_dot2c_f32_bf16 v93, v100, v250
v_dot2c_f32_bf16 v94, v101, v249
v_dot2c_f32_bf16 v95, v101, v250
v_dot2c_f32_bf16 v96, v102, v249
v_dot2c_f32_bf16 v97, v102, v250
v_dot2c_f32_bf16 v98, v103, v249
v_dot2c_f32_bf16 v99, v103, v250
s_waitcnt vmcnt(0)
v_dot2c_f32_bf16 v92, v104, v249
v_dot2c_f32_bf16 v93, v104, v250
v_dot2c_f32_bf16 v94, v105, v249
v_dot2c_f32_bf16 v95, v105, v250
v_dot2c_f32_bf16 v96, v106, v249
v_dot2c_f32_bf16 v97, v106, v250
v_dot2c_f32_bf16 v98, v107, v249
v_dot2c_f32_bf16 v99, v107, v250
s_nop 2
s_branch L_kvredo3b
L_k2redo3:
s_mov_b32 s95, 0
s_mov_b32 s92, 0x40000000
s_mov_b32 s93, 0x40000000
s_mov_b32 s94, 0x40000000
s_mov_b32 s37, 0
L_k2redo3a:
s_sleep 4
v_mov_b32 v108, 0
s_mov_b32 s36, 0
L_k2redo3b:
s_lshr_b32 s39, s36, 3
s_mul_i32 s39, s39, 524288
s_and_b32 s38, s36, 7
s_lshl_b32 s38, s38, 14
s_add_u32 s38, s38, s39
s_xor_b32 s38, s38, s9
s_add_u32 s39, s38, 4096
buffer_load_dwordx4 v[92:95], v4, s[40:43], s38 offen offset:0 sc1
buffer_load_dwordx4 v[96:99], v4, s[40:43], s38 offen offset:1024 sc1
buffer_load_dwordx4 v[100:103], v4, s[40:43], s39 offen offset:0 sc1
buffer_load_dwordx4 v[104:107], v4, s[40:43], s39 offen offset:1024 sc1
s_waitcnt vmcnt(3)
v_max3_u32 v108, v108, v92, v93
v_max3_u32 v108, v108, v94, v95
s_waitcnt vmcnt(2)
v_max3_u32 v108, v108, v96, v97
v_max3_u32 v108, v108, v98, v99
s_waitcnt vmcnt(1)
v_max3_u32 v108, v108, v100, v101
v_max3_u32 v108, v108, v102, v103
s_waitcnt vmcnt(0)
v_max3_u32 v108, v108, v104, v105
v_max3_u32 v108, v108, v106, v107
s_add_u32 s36, s36, 1
s_cmp_lt_u32 s36, 16
s_cbranch_scc1 L_k2redo3b
v_cmp_eq_u32 vcc, -1, v108
s_cbranch_vccz L_k2redo3c
s_add_u32 s37, s37, 1
s_cmp_lt_u32 s37, 0x8000
s_cbranch_scc1 L_k2redo3a
L_k2redo3c:
s_nop 7
s_mov_b32 s35, s9
v_lshlrev_b32 v132, 16, v32
v_and_b32 v133, 0xffff0000, v32
v_lshlrev_b32 v134, 16, v33
v_and_b32 v135, 0xffff0000, v33
v_lshlrev_b32 v136, 16, v34
v_and_b32 v137, 0xffff0000, v34
v_lshlrev_b32 v138, 16, v35
v_and_b32 v139, 0xffff0000, v35
v_lshlrev_b32 v140, 16, v36
v_and_b32 v141, 0xffff0000, v36
v_lshlrev_b32 v142, 16, v37
v_and_b32 v143, 0xffff0000, v37
v_lshlrev_b32 v144, 16, v38
v_and_b32 v145, 0xffff0000, v38
v_lshlrev_b32 v146, 16, v39
v_and_b32 v147, 0xffff0000, v39
v_lshlrev_b32 v148, 16, v40
v_and_b32 v149, 0xffff0000, v40
v_lshlrev_b32 v150, 16, v41
v_and_b32 v151, 0xffff0000, v41
v_lshlrev_b32 v152, 16, v42
v_and_b32 v153, 0xffff0000, v42
v_lshlrev_b32 v154, 16, v43
v_and_b32 v155, 0xffff0000, v43
v_lshlrev_b32 v156, 16, v44
v_and_b32 v157, 0xffff0000, v44
v_lshlrev_b32 v158, 16, v45
v_and_b32 v159, 0xffff0000, v45
v_lshlrev_b32 v160, 16, v46
v_and_b32 v161, 0xffff0000, v46
v_lshlrev_b32 v162, 16, v47
v_and_b32 v163, 0xffff0000, v47
s_branch L_k2go3
L_code_end:
.section .rodata,"a"
.p2align 6
.amdhsa_kernel interleave_layers__sliding_local_dilated__linear_kernel_hedgehog__prompt_kernel
  .amdhsa_next_free_vgpr 512
  .amdhsa_next_free_sgpr 102
  .amdhsa_accum_offset 256
  .amdhsa_group_segment_fixed_size 0
  .amdhsa_kernarg_size 80
  .amdhsa_user_sgpr_count 2
  .amdhsa_user_sgpr_kernarg_segment_ptr 1
  .amdhsa_system_sgpr_workgroup_id_x 1
.end_amdhsa_kernel
```

```asm
; @launch grid=(256,1,1) block=(256,1,1) lds=163840
.amdgcn_target "amdgcn-amd-amdhsa--gfx950"
.text
.globl interleave_layers__sliding_local_dilated__linear_kernel_hedgehog__prompt_kernel
.p2align 8
.type interleave_layers__sliding_local_dilated__linear_kernel_hedgehog__prompt_kernel,@function
interleave_layers__sliding_local_dilated__linear_kernel_hedgehog__prompt_kernel:
s_cmp_ge_u32 s2, 256
s_cbranch_scc1 L_end
s_load_dwordx16 s[64:79], s[0:1], 0
s_load_dwordx4 s[80:83], s[0:1], 64
s_getpc_b64 s[24:25]
s_mov_b32 s26, (L_end - interleave_layers__sliding_local_dilated__linear_kernel_hedgehog__prompt_kernel - 64)
s_mov_b32 s27, 0x20000
v_lshlrev_b32 v1, 5, v0
buffer_load_dword v238, v1, s[24:27], 0 offen
v_lshrrev_b32 v1, 6, v0
v_and_b32 v0, 63, v0
v_readfirstlane_b32 s28, v1
s_getreg_b32 s3, hwreg(HW_REG_XCC_ID, 0, 4)
s_sub_u32 s3, s3, s2
s_and_b32 s3, s3, 7
s_or_b32 s3, s3, 0x100
L_roles:
s_add_u32 s36, s2, s3
s_lshr_b32 s37, s2, 3
s_and_b32 s38, s37, 3
s_lshr_b32 s39, s37, 2
s_and_b32 s29, s36, 4
s_lshl_b32 s31, s29, 1
s_add_u32 s29, s29, s38
s_and_b32 s30, s36, 3
s_lshl_b32 s30, s30, 3
s_add_u32 s30, s30, s39
s_and_b32 s32, s36, 2
s_lshl_b32 s32, s32, 1
s_add_u32 s31, s31, s32
s_add_u32 s31, s31, s38
s_and_b32 s32, s36, 1
s_lshl_b32 s32, s32, 3
s_add_u32 s32, s32, s39
s_and_b32 s35, s2, 7
s_lshl_b32 s35, s35, 5
s_add_u32 s35, s35, s37
v_lshlrev_b32 v1, 4, v0
v_lshrrev_b32 v233, 4, v0
v_and_b32 v234, 15, v0
s_and_b32 s88, s31, 7
s_lshl_b32 s88, s88, 7
s_lshl_b32 s37, s28, 5
s_add_u32 s88, s88, s37
s_lshl_b32 s88, s88, 1
s_lshr_b32 s37, s31, 3
s_add_u32 s88, s88, s37
s_lshl_b32 s88, s88, 11
s_lshl_b32 s37, s32, 7
s_add_u32 s88, s88, s37
v_lshrrev_b32 v235, 3, v0
v_and_b32 v236, 7, v0
v_xor_b32 v232, v236, v233
v_lshlrev_b32 v232, 4, v232
v_lshl_add_u32 v232, v235, 12, v232
v_xor_b32 v246, 64, v232
v_lshlrev_b32 v236, 4, v236
v_lshl_add_u32 v237, v235, 11, v236
v_mul_u32_u24 v235, 6144, v235
v_add_u32 v235, v235, v236
s_lshr_b32 s36, s35, 4
s_lshl_b32 s36, s36, 2
s_add_u32 s36, s36, s28
s_mul_i32 s36, s36, 98304
s_and_b32 s37, s35, 15
s_lshl_b32 s37, s37, 7
s_add_u32 s36, s36, s37
s_lshl_b32 s37, s28, 11
s_mov_b32 s39, 0x10000
s_mov_b32 s10, 0x400000
s_mov_b32 s11, 0x20000
s_mov_b32 s22, 0x600000
s_mov_b32 s23, 0x20000
s_mov_b32 s6, 0x10000000
s_mov_b32 s7, 0x20000
s_mov_b32 s44, 0xf0000
s_waitcnt lgkmcnt(0)
s_lshr_b32 s38, s2, 3
s_or_b32 s38, s38, s28
s_cbranch_scc1 Lrp_1
s_mov_b32 s40, s80
s_mov_b32 s41, s81
s_mov_b32 s42, 0x100
s_mov_b32 s43, 0x20000
v_mov_b32 v240, s3
v_mov_b32 v241, 0
s_mov_b64 exec, 1
buffer_atomic_cmpswap v[240:241], off, s[40:43], 0 offset:252 sc1
s_mov_b64 exec, -1
Lrp_1:
s_mov_b64 s[8:9], s[64:65]
s_mov_b64 s[20:21], s[66:67]
s_lshl_b32 s39, s37, 1
s_add_u32 m0, s37, 0
s_add_u32 s38, s36, 0
buffer_load_dwordx4 v235, s[20:23], s38 offen nt lds
s_add_u32 m0, s37, 1024
s_add_u32 s38, s36, 49152
buffer_load_dwordx4 v235, s[20:23], s38 offen nt lds
s_add_u32 m0, s37, 8192
s_add_u32 s38, s36, 2048
buffer_load_dwordx4 v235, s[20:23], s38 offen nt lds
s_add_u32 m0, s37, 9216
s_add_u32 s38, s36, 51200
buffer_load_dwordx4 v235, s[20:23], s38 offen nt lds
s_add_u32 m0, s37, 16384
s_add_u32 s38, s36, 4096
buffer_load_dwordx4 v235, s[20:23], s38 offen nt lds
s_add_u32 m0, s37, 17408
s_add_u32 s38, s36, 53248
buffer_load_dwordx4 v235, s[20:23], s38 offen nt lds
s_add_u32 m0, s39, 24576
s_add_u32 s38, s88, 0
buffer_load_dwordx4 v232, s[8:11], s38 offen nt lds
s_add_u32 m0, s39, 25600
s_add_u32 s38, s88, 32768
buffer_load_dwordx4 v246, s[8:11], s38 offen nt lds
s_add_u32 m0, s39, 26624
s_add_u32 s38, s88, 65536
buffer_load_dwordx4 v232, s[8:11], s38 offen nt lds
s_add_u32 m0, s39, 27648
s_add_u32 s38, s88, 98304
buffer_load_dwordx4 v246, s[8:11], s38 offen nt lds
s_mov_b32 s37, s39
v_lshrrev_b32 v232, 1, v234
v_xor_b32 v232, v232, v233
v_lshlrev_b32 v232, 4, v232
v_lshl_add_u32 v232, v234, 7, v232
v_add_u32 v232, s37, v232
s_add_u32 s4, s82, 0x0
s_addc_u32 s5, s83, 0
s_mov_b64 s[92:93], s[80:81]
s_mov_b32 s12, s78
s_mov_b32 s13, s79
s_mov_b32 s14, 0x400000
s_mov_b32 s15, 0x20000
s_mov_b32 s42, 0x400000
s_mov_b32 s43, 0x20000
v_mov_b32 v12, 1
s_mov_b64 s[40:41], s[12:13]
s_mov_b32 s64, 0xff
s_mov_b32 s65, 0
s_and_b32 s81, s29, 3
s_lshl_b32 s66, s31, 4
s_add_u32 s66, s66, s32
s_lshl_b32 s66, s66, 8
s_lshl_b32 s67, s29, 5
s_add_u32 s67, s67, s30
s_lshl_b32 s67, s67, 8
s_lshl_b32 s80, s30, 11
s_lshl_b32 s70, s29, 8
s_add_u32 s70, s70, s80
s_lshl_b32 s71, s29, 13
s_lshr_b32 s78, s31, 1
s_lshl_b32 s78, s78, 13
s_add_u32 s79, s78, 8192
s_bitcmp1_b32 s31, 0
s_cselect_b32 s79, s79, 0x40000000
s_and_b32 s36, s31, 7
s_cmp_eq_u32 s36, 7
s_cselect_b32 s79, 0x40000000, s79
v_mov_b32 v240, 0
v_mov_b32 v241, 0
v_mov_b32 v242, 0
v_mov_b32 v243, 0
v_mov_b32 v228, v235
v_mov_b32 v229, v237
s_lshr_b32 s36, s35, 4
s_lshl_b32 s36, s36, 2
s_add_u32 s36, s36, s28
s_and_b32 s37, s35, 15
s_lshl_b32 s37, s37, 7
s_lshl_b32 s16, s36, 15
s_add_u32 s16, s16, s37
s_mul_i32 s17, s36, 98304
s_add_u32 s17, s17, s37
v_mov_b32 v16, 0x3f803f80
v_mov_b32 v17, 0x3f803f80
v_mov_b32 v18, 0x3f803f80
v_mov_b32 v19, 0x3f803f80
s_mov_b32 s46, 0xaaaaaaaa
s_mov_b32 s47, 0xaaaaaaaa
s_mov_b32 s48, 0xcccccccc
s_mov_b32 s49, 0xcccccccc
s_lshl_b32 s36, s31, 1
s_lshr_b32 s37, s28, 1
s_add_u32 s36, s36, s37
s_lshl_b32 s36, s36, 17
s_and_b32 s37, s28, 1
s_lshl_b32 s37, s37, 11
s_add_u32 s36, s36, s37
v_add_u32 v4, s36, v1
s_lshl_b32 s38, s31, 2
s_add_u32 s38, s38, s28
s_lshl_b32 s38, s38, 12
s_lshl_b32 s39, s32, 7
s_add_u32 s38, s38, s39
v_lshrrev_b32 v244, 2, v234
v_cmp_eq_u32 vcc, v244, v233
v_and_b32 v244, 7, v234
v_lshl_add_u32 v244, v244, 4, s38
v_and_b32 v245, 8, v234
v_add_u32 v244, v244, v245
v_cndmask_b32 v253, 2.0, v244, vcc
v_lshlrev_b32 v244, 4, v233
v_lshl_add_u32 v244, v234, 6, v244
v_cmp_gt_u32 vcc, 2, v234
s_nop 1
v_cndmask_b32 v254, 2.0, v244, vcc
v_lshrrev_b32 v248, 4, v0
v_lshlrev_b32 v248, 10, v248
v_bfe_u32 v249, v0, 2, 2
v_lshl_add_u32 v248, v249, 7, v248
v_and_b32 v251, 3, v0
v_lshl_add_u32 v248, v251, 3, v248
s_lshr_b32 s36, s28, 1
s_lshl_b32 s36, s36, 6
s_and_b32 s37, s28, 1
s_mul_i32 s38, s37, 8224
s_add_u32 s38, s38, s36
s_mul_i32 s39, s37, 16352
s_add_u32 s39, s39, s36
v_add_u32 v249, s39, v248
v_add_u32 v248, s38, v248
s_and_b32 s38, s35, 15
s_lshl_b32 s38, s38, 1
s_lshr_b32 s36, s28, 1
s_add_u32 s38, s38, s36
s_lshr_b32 s36, s35, 4
s_mul_i32 s96, s38, 196608
s_lshr_b32 s44, s36, 3
s_mul_i32 s44, s44, 98304
s_add_u32 s96, s96, s44
s_add_u32 s96, s96, 0x2000000
s_and_b32 s44, s36, 7
s_mul_i32 s97, s44, 12288
s_mul_i32 s44, s37, 3072
s_add_u32 s97, s97, s44
s_mul_i32 s38, s38, 6
s_mul_i32 s37, s37, 3
s_add_u32 s38, s38, s37
s_lshl_b32 s38, s38, 11
s_lshl_b32 s36, s36, 7
s_add_u32 s38, s38, s36
s_add_u32 s98, s38, 0x1800000
s_add_u32 s99, s98, 4096
v_lshrrev_b32 v247, 2, v0
v_lshlrev_b32 v250, 7, v247
v_lshl_add_u32 v250, v251, 4, v250
s_lshr_b32 s36, s28, 1
s_lshl_b32 s36, s36, 12
s_and_b32 s37, s28, 1
s_lshl_b32 s37, s37, 6
s_add_u32 s36, s36, s37
s_add_u32 s36, s36, 147456
v_add_u32 v250, s36, v250
v_subrev_u32 v230, 122880, v250
s_and_b32 s36, s35, 15
s_lshl_b32 s36, s36, 17
s_lshr_b32 s37, s35, 4
s_lshl_b32 s37, s37, 13
s_add_u32 s36, s36, s37
s_lshl_b32 s37, s28, 11
s_add_u32 s36, s36, s37
s_add_u32 s100, s36, 0x1a00000
s_add_u32 s101, s36, 0x1c00000
v_lshlrev_b32 v247, 6, v247
v_lshl_add_u32 v251, v251, 3, v247
v_add_u32 v251, 155648, v251
v_xor_b32 v236, 64, v232
s_mov_b32 s94, 256
s_mov_b32 s95, 0x20000
buffer_load_dword v245, off, s[92:95], 0 offset:252 sc1
s_mov_b64 s[20:21], s[68:69]
s_mov_b32 s22, 0x200000
s_lshl_b32 s37, s28, 11
s_add_u32 m0, s37, 147456
s_add_u32 s36, s16, 0
buffer_load_dwordx4 v229, s[20:23], s36 offen nt lds
s_add_u32 m0, s37, 148480
s_add_u32 s36, s16, 16384
buffer_load_dwordx4 v229, s[20:23], s36 offen nt lds
s_add_u32 s36, s67, 0xc0000
s_add_u32 s37, s66, 0xd0000
s_cmp_eq_u32 s28, 2
s_cselect_b32 s36, s37, s36
s_cmp_eq_u32 s28, 1
s_cselect_b32 s37, 128, 0
s_add_u32 s36, s36, s37
s_cmp_eq_u32 s28, 3
s_cselect_b32 s37, 0x20000, 0
s_add_u32 s36, s36, s37
s_mov_b64 exec, 1
buffer_atomic_add v240, off, s[4:7], s36 sc1
s_mov_b64 exec, -1
s_lshr_b32 s36, s2, 3
s_cmp_ge_u32 s36, 11
s_cselect_b32 s37, 11, 0
s_cselect_b32 s38, 8, 0
s_sub_u32 s51, s36, s37
s_and_b32 s37, s2, 7
s_add_u32 s37, s37, s38
s_lshl_b32 s37, s37, 8
s_lshl_b32 s34, s51, 21
s_add_u32 s34, s34, s37
s_add_u32 s34, s34, 0x1e0000
s_cmp_lt_u32 s36, 22
s_cselect_b32 s36, s28, 0
s_cmp_eq_u32 s36, 2
s_cselect_b32 s34, s34, 0x40000000
v_and_b32 v239, 2, v0
v_lshlrev_b32 v239, 12, v239
v_and_b32 v244, 1, v0
v_lshl_add_u32 v239, v244, 7, v239
s_mov_b64 exec, 15
buffer_atomic_add v240, v239, s[4:7], s34 offen sc1
s_mov_b64 exec, -1
s_mov_b32 s36, 0xf0000
buffer_load_dword v11, off, s[4:7], s36 sc1
s_lshr_b32 s36, s2, 3
s_lshl_b32 s36, s36, 2
s_add_u32 s36, s36, s28
s_lshl_b32 s36, s36, 10
buffer_load_dwordx4 a[0:3], v1, s[24:27], s36 offen
s_mov_b64 s[24:25], s[92:93]
s_mov_b32 s26, 256
s_mov_b64 s[20:21], s[74:75]
s_mov_b32 s22, 0x10000
s_and_b32 s36, s28, 1
s_lshl_b32 s36, s36, 10
s_add_u32 m0, s36, 155648
s_lshl_b32 s37, s30, 11
s_add_u32 s36, s36, s37
buffer_load_dwordx4 v1, s[20:23], s36 offen lds
s_waitcnt vmcnt(8)
s_waitcnt vmcnt(7)
v_readfirstlane_b32 s36, v245
s_nop 0
s_cmp_lg_u32 s36, s3
s_cbranch_scc1 L_rfix
L_rok:
ds_read_b128 v[32:35], v232 offset:24576
ds_read_b128 v[36:39], v236 offset:24576
ds_read_b128 v[40:43], v232 offset:26624
ds_read_b128 v[44:47], v236 offset:26624
s_barrier
ds_read_b64_tr_b16 a[188:189], v248 offset:0
ds_read_b64_tr_b16 a[190:191], v248 offset:512
ds_read_b64_tr_b16 a[192:193], v248 offset:4096
ds_read_b64_tr_b16 a[194:195], v248 offset:4608
ds_read_b64_tr_b16 a[196:197], v249 offset:32
ds_read_b64_tr_b16 a[198:199], v249 offset:544
ds_read_b64_tr_b16 a[200:201], v249 offset:4128
ds_read_b64_tr_b16 a[202:203], v249 offset:4640
ds_read_b64_tr_b16 a[204:205], v248 offset:8192
ds_read_b64_tr_b16 a[206:207], v248 offset:8704
ds_read_b64_tr_b16 a[208:209], v248 offset:12288
ds_read_b64_tr_b16 a[210:211], v248 offset:12800
s_lshl_b32 s36, s32, 13
s_add_u32 s37, s36, 4096
s_mov_b32 s38, 0x1700000
s_waitcnt lgkmcnt(14)
v_mfma_f32_16x16x32_bf16 v[96:99], v[32:35], v[32:35], 0
v_mfma_f32_16x16x32_bf16 v[92:95], v[16:19], v[32:35], 0
buffer_store_dwordx4 v[32:35], v4, s[12:15], s36 offen offset:0 sc1
s_waitcnt lgkmcnt(13)
v_mfma_f32_16x16x32_bf16 v[104:107], v[40:43], v[40:43], 0
v_mfma_f32_16x16x32_bf16 v[100:103], v[16:19], v[40:43], 0
buffer_store_dwordx4 v[40:43], v4, s[12:15], s36 offen offset:1024 sc1
v_mfma_f32_16x16x32_bf16 v[96:99], v[36:39], v[36:39], v[96:99]
v_mfma_f32_16x16x32_bf16 v[92:95], v[16:19], v[36:39], v[92:95]
buffer_store_dwordx4 v[36:39], v4, s[12:15], s37 offen offset:0 sc1
s_waitcnt lgkmcnt(12)
v_mfma_f32_16x16x32_bf16 v[104:107], v[44:47], v[44:47], v[104:107]
v_mfma_f32_16x16x32_bf16 v[100:103], v[16:19], v[44:47], v[100:103]
buffer_store_dwordx4 v[44:47], v4, s[12:15], s37 offen offset:1024 sc1
s_nop 1
v_cndmask_b32 v96, v96, v97, s[46:47]
v_cndmask_b32 v98, v98, v99, s[46:47]
v_cndmask_b32 v93, v96, v98, s[48:49]
buffer_store_dwordx2 v[92:93], v253, s[4:7], s38 offen offset:0 sc1
v_cndmask_b32 v104, v104, v105, s[46:47]
v_cndmask_b32 v106, v106, v107, s[46:47]
v_cndmask_b32 v101, v104, v106, s[48:49]
buffer_store_dwordx2 v[100:101], v253, s[4:7], s38 offen offset:2048 sc1
s_waitcnt lgkmcnt(10)
v_mfma_f32_16x16x32_bf16 v[108:111], a[188:191], v[16:19], 0
s_waitcnt lgkmcnt(6)
v_mfma_f32_16x16x32_bf16 v[112:115], a[196:199], v[16:19], 0
s_waitcnt lgkmcnt(2)
v_mfma_f32_16x16x32_bf16 v[116:119], a[204:207], v[16:19], 0
v_mfma_f32_16x16x32_bf16 v[108:111], a[192:195], v[16:19], v[108:111]
v_mfma_f32_16x16x32_bf16 v[112:115], a[200:203], v[16:19], v[112:115]
s_waitcnt lgkmcnt(0)
v_mfma_f32_16x16x32_bf16 v[116:119], a[208:211], v[16:19], v[116:119]
s_add_u32 s36, s97, 0
s_add_u32 s36, s36, s96
buffer_store_dwordx4 a[188:191], v1, s[4:7], s36 offen sc1
s_add_u32 s36, s97, 6144
s_add_u32 s36, s36, s96
buffer_store_dwordx4 a[192:195], v1, s[4:7], s36 offen sc1
s_add_u32 s36, s97, 1024
s_add_u32 s36, s36, s96
buffer_store_dwordx4 a[196:199], v1, s[4:7], s36 offen sc1
s_add_u32 s36, s97, 7168
s_add_u32 s36, s36, s96
buffer_store_dwordx4 a[200:203], v1, s[4:7], s36 offen sc1
s_add_u32 s36, s97, 2048
s_add_u32 s36, s36, s96
buffer_store_dwordx4 a[204:207], v1, s[4:7], s36 offen sc1
s_add_u32 s36, s97, 8192
s_add_u32 s36, s36, s96
buffer_store_dwordx4 a[208:211], v1, s[4:7], s36 offen sc1
buffer_store_dwordx4 v[108:111], v254, s[4:7], s98 offen offset:0 sc1
buffer_store_dwordx4 v[112:115], v254, s[4:7], s98 offen offset:2048 sc1
buffer_store_dwordx4 v[116:119], v254, s[4:7], s99 offen offset:0 sc1
v_lshlrev_b32 v239, 16, v233
v_lshl_add_u32 v239, v234, 4, v239
s_cmp_eq_u32 s28, 0
s_cselect_b32 s36, s66, s67
s_cmp_eq_u32 s28, 2
s_cselect_b32 s36, s70, s36
s_lshl_b32 s37, s28, 18
s_add_u32 s36, s36, s37
s_cmp_eq_u32 s28, 3
s_cselect_b32 s36, 0x40000000, s36
buffer_store_dwordx4 v[240:243], v239, s[4:7], s36 offen sc1
s_add_u32 s36, s36, 0x102000
buffer_store_dwordx4 v[240:243], v239, s[4:7], s36 offen sc1
s_waitcnt vmcnt(22)
s_barrier
ds_read_b64_tr_b16 a[212:213], v250 offset:0
ds_read_b64_tr_b16 a[214:215], v250 offset:2048
ds_read_b64_tr_b16 a[216:217], v250 offset:8
ds_read_b64_tr_b16 a[218:219], v250 offset:2056
s_waitcnt lgkmcnt(2)
buffer_store_dwordx4 a[212:215], v1, s[4:7], s100 offen offset:0 sc1
s_waitcnt lgkmcnt(0)
buffer_store_dwordx4 a[216:219], v1, s[4:7], s100 offen offset:1024 sc1
s_mov_b32 s56, 0x11111111
s_mov_b32 s57, 0x11111111
s_mov_b32 s58, 0x22222222
s_mov_b32 s59, 0x22222222
s_lshl_b32 s18, s28, 11
s_lshl_b32 s19, s28, 12
s_mul_i32 s50, s30, 196608
s_add_u32 s50, s50, s18
s_lshl_b32 s36, s32, 17
s_add_u32 s36, s36, s19
s_lshr_b32 s37, s30, 3
s_lshl_b32 s37, s37, 15
s_add_u32 s36, s36, s37
s_add_u32 s84, s36, 0x1a00000
s_add_u32 s85, s36, 0x1c00000
s_mul_i32 s55, s28, 6144
v_accvgpr_write_b32 a248, -1
v_accvgpr_write_b32 a249, -1
v_accvgpr_write_b32 a250, -1
v_accvgpr_write_b32 a251, -1
s_lshl_b32 s36, s29, 2
s_add_u32 s36, s36, s28
s_mov_b32 s37, s36
s_lshl_b32 s37, s37, 17
v_add_u32 v2, s37, v1
s_lshl_b32 s82, s36, 13
s_and_b32 s38, s29, 3
s_cmp_eq_u32 s38, 0
s_cselect_b32 s38, 0, 0x1f400
s_cselect_b32 s39, 0, 2048
s_cselect_b32 s54, 32, 48
s_lshl_b32 s37, s29, 19
s_sub_u32 s37, s37, s38
v_add_u32 v3, s37, v1
v_cmp_le_u32 vcc, 8, v234
s_nop 1
v_cndmask_b32 v3, 2.0, v3, vcc
s_lshl_b32 s37, s29, 15
s_sub_u32 s83, s37, s39
s_cmp_eq_u32 s28, 0
s_cselect_b32 vcc_lo, -1, 0
s_mov_b32 vcc_hi, 0
v_lshlrev_b32 v244, 8, v0
v_cndmask_b32 v10, 2.0, v244, vcc
v_and_b32 v244, 1, v233
v_lshl_add_u32 v244, v244, 3, v234
v_and_b32 v244, 15, v244
v_lshrrev_b32 v245, 1, v233
v_lshl_add_u32 v244, v245, 4, v244
v_lshrrev_b32 v245, 3, v234
v_lshl_add_u32 v244, v245, 5, v244
v_lshlrev_b32 v7, 3, v244
v_lshrrev_b32 v246, 2, v0
v_and_b32 v247, 3, v0
v_and_b32 v244, 1, v247
v_lshl_add_u32 v244, v244, 3, v246
v_and_b32 v244, 15, v244
v_lshrrev_b32 v245, 1, v247
v_lshl_add_u32 v244, v245, 4, v244
v_lshrrev_b32 v245, 3, v246
v_lshl_add_u32 v244, v245, 5, v244
v_lshlrev_b32 v8, 3, v244
s_and_b32 s36, s28, 1
s_lshl_b32 s37, s36, 3
s_add_u32 s37, s37, 20480
s_lshl_b32 s36, s36, 9
v_add_u32 v244, s37, v1
v_add_u32 v245, s36, v7
s_cmp_lt_u32 s28, 2
s_cselect_b64 vcc, -1, 0
v_cndmask_b32 v9, v245, v244, vcc
s_cmp_eq_u32 s28, 3
s_cselect_b64 vcc, -1, 0
v_cndmask_b32 v3, 2.0, v1, vcc
s_lshl_b32 s83, s67, 3
s_cmp_eq_u32 s54, 32
s_cselect_b32 s36, 1, s28
s_cmp_eq_u32 s36, 0
s_cselect_b64 vcc, -1, 0
v_cndmask_b32 v9, 2.0, v1, vcc
v_lshlrev_b32 v239, 2, v233
v_sub_u32 v239, v239, v234
v_mov_b32 v247, 0xf149f2ca
v_add_u32 v246, 7, v239
v_cmp_gt_u32 vcc, 8, v246
v_mov_b32 v244, 0xffff
s_nop 0
v_cndmask_b32 v24, v247, 0, vcc
v_cndmask_b32 v244, 0, v244, vcc
v_mov_b32 v30, v244
v_add_u32 v246, 0, v239
v_cmp_le_i32 vcc, 9, v246
v_mov_b32 v244, 0xffff
s_nop 0
v_cndmask_b32 v20, v247, 0, vcc
v_cndmask_b32 v244, 0, v244, vcc
v_mov_b32 v28, v244
v_add_u32 v246, 8, v239
v_cmp_gt_u32 vcc, 8, v246
v_mov_b32 v244, 0xffff0000
s_nop 0
v_cndmask_b32 v25, v247, 0, vcc
v_cndmask_b32 v244, 0, v244, vcc
v_or_b32 v30, v30, v244
v_add_u32 v246, 1, v239
v_cmp_le_i32 vcc, 9, v246
v_mov_b32 v244, 0xffff0000
s_nop 0
v_cndmask_b32 v21, v247, 0, vcc
v_cndmask_b32 v244, 0, v244, vcc
v_or_b32 v28, v28, v244
v_add_u32 v246, 9, v239
v_cmp_gt_u32 vcc, 8, v246
v_mov_b32 v244, 0xffff
s_nop 0
v_cndmask_b32 v26, v247, 0, vcc
v_cndmask_b32 v244, 0, v244, vcc
v_mov_b32 v31, v244
v_add_u32 v246, 2, v239
v_cmp_le_i32 vcc, 9, v246
v_mov_b32 v244, 0xffff
s_nop 0
v_cndmask_b32 v22, v247, 0, vcc
v_cndmask_b32 v244, 0, v244, vcc
v_mov_b32 v29, v244
v_add_u32 v246, 10, v239
v_cmp_gt_u32 vcc, 8, v246
v_mov_b32 v244, 0xffff0000
s_nop 0
v_cndmask_b32 v27, v247, 0, vcc
v_cndmask_b32 v244, 0, v244, vcc
v_or_b32 v31, v31, v244
v_add_u32 v246, 3, v239
v_cmp_le_i32 vcc, 9, v246
v_mov_b32 v244, 0xffff0000
s_nop 0
v_cndmask_b32 v23, v247, 0, vcc
v_cndmask_b32 v244, 0, v244, vcc
v_or_b32 v29, v29, v244
s_and_b32 s36, s29, 3
s_or_b32 s36, s36, s28
s_cmp_eq_u32 s36, 0
s_cselect_b64 vcc, -1, 0
v_cndmask_b32 v76, v20, v247, vcc
v_cndmask_b32 v77, v21, v247, vcc
v_cndmask_b32 v78, v22, v247, vcc
v_cndmask_b32 v79, v23, v247, vcc
v_cndmask_b32 v80, v28, 0, vcc
v_cndmask_b32 v81, v29, 0, vcc
s_add_u32 s91, s83, 0x1780000
buffer_store_dwordx4 a[248:251], v3, s[4:7], s91 offen offset:0 sc1
buffer_store_dwordx4 a[248:251], v3, s[4:7], s91 offen offset:1024 sc1
s_mov_b32 s36, 0x9e3779b1
s_waitcnt vmcnt(23)
v_mul_lo_u32 v15, v11, s36
v_add_u32 v15, 0x7f4a7c15, v15
s_and_b32 s36, s31, 1
s_lshl_b32 s36, s36, 4
s_add_u32 s36, s36, s32
s_lshl_b32 s36, s36, 2
s_add_u32 s92, s78, s36
s_add_u32 s92, s92, 0xc0000
s_lshl_b32 s36, s32, 2
s_add_u32 s93, s79, s36
s_add_u32 s93, s93, 0xc0080
s_and_b32 s94, s35, 15
s_lshl_b32 s94, s94, 9
s_lshr_b32 s36, s35, 4
s_lshl_b32 s36, s36, 2
s_add_u32 s94, s94, s36
s_add_u32 s94, s94, 0xc00c0
v_lshrrev_b32 v240, 1, v0
v_lshlrev_b32 v240, 13, v240
v_and_b32 v241, 1, v0
v_lshl_add_u32 v240, v241, 8, v240
s_mov_b32 vcc_lo, 0xffff
s_mov_b32 vcc_hi, 0
v_cndmask_b32 v240, 2.0, v240, vcc
v_lshlrev_b32 v241, 2, v0
v_add_u32 v248, 0, v248
v_add_u32 v249, 0, v249
s_add_u32 s96, s96, 0x400000
s_add_u32 s98, s98, 0x80000
s_add_u32 s96, s96, 0x400000
s_add_u32 s99, s99, 0x80000
s_cmp_eq_u32 s28, 0
s_cselect_b32 vcc_lo, 0xffff, 0
v_lshlrev_b32 v252, 12, v0
v_cndmask_b32 v252, 2.0, v252, vcc
v_cndmask_b32 v14, 2.0, v240, vcc
s_and_b32 s62, s35, 15
s_lshl_b32 s62, s62, 8
s_lshr_b32 s36, s35, 4
s_lshl_b32 s36, s36, 2
s_add_u32 s62, s62, s36
s_add_u32 s62, s62, 0xd0000
s_add_u32 s8, s94, 0x1ff40
v_and_b32 v255, 15, v0
v_lshlrev_b32 v255, 2, v255
s_waitcnt vmcnt(0)
s_barrier
s_cmp_lg_u32 s28, 0
s_cbranch_scc1 Lg1s_2
buffer_atomic_swap v15, v10, s[4:7], s92 offen sc1
s_add_u32 s36, s67, 0xc2080
s_cmp_eq_u32 s81, 3
s_cselect_b32 s36, 0x40000000, s36
s_mov_b64 exec, 1
buffer_atomic_swap v15, off, s[4:7], s36 sc1
s_mov_b64 exec, -1
buffer_atomic_swap v15, v240, s[4:7], s94 offen sc1
buffer_atomic_swap v15, v252, s[4:7], s62 offen sc1
Lg1s_2:
s_branch L_aligned
.p2align 12
L_aligned:
s_mov_b64 s[20:21], s[76:77]
s_mov_b32 s22, 0x200000
s_add_u32 s89, s16, 0
buffer_load_dwordx4 a[220:223], v229, s[20:23], s89 offen nt
s_mov_b64 s[20:21], s[76:77]
s_mov_b32 s22, 0x200000
s_add_u32 s89, s16, 16384
buffer_load_dwordx4 a[224:227], v229, s[20:23], s89 offen nt
s_mov_b64 s[20:21], s[72:73]
s_mov_b32 s22, 0x600000
s_add_u32 s89, s17, 0
buffer_load_dwordx4 a[188:191], v228, s[20:23], s89 offen nt
s_mov_b64 s[20:21], s[72:73]
s_mov_b32 s22, 0x600000
s_add_u32 s89, s17, 49152
buffer_load_dwordx4 a[192:195], v228, s[20:23], s89 offen nt
s_mov_b64 s[20:21], s[72:73]
s_mov_b32 s22, 0x600000
s_add_u32 s89, s17, 2048
buffer_load_dwordx4 a[196:199], v228, s[20:23], s89 offen nt
s_mov_b64 s[20:21], s[72:73]
s_mov_b32 s22, 0x600000
s_add_u32 s89, s17, 51200
buffer_load_dwordx4 a[200:203], v228, s[20:23], s89 offen nt
s_mov_b64 s[20:21], s[72:73]
s_mov_b32 s22, 0x600000
s_add_u32 s89, s17, 4096
buffer_load_dwordx4 a[204:207], v228, s[20:23], s89 offen nt
s_mov_b64 s[20:21], s[72:73]
s_mov_b32 s22, 0x600000
s_add_u32 s89, s17, 53248
buffer_load_dwordx4 a[208:211], v228, s[20:23], s89 offen nt
s_add_u32 s89, s66, 0xd0000
ds_read_b64_tr_b16 a[240:241], v251 offset:0
ds_read_b64_tr_b16 a[242:243], v251 offset:1024
ds_read_b64_tr_b16 a[244:245], v251 offset:32
ds_read_b64_tr_b16 a[246:247], v251 offset:1056
s_lshl_b32 s36, s28, 11
v_add_u32 v231, s36, v1
s_waitcnt lgkmcnt(0)
v_add_u32 v231, 0, v231
v_cmp_eq_u32 vcc, 0, v0
s_nop 1
v_cndmask_b32 v251, 2.0, v0, vcc
s_cmp_eq_u32 s34, 0x40000000
s_cbranch_scc1 Lvote_5
s_add_u32 s36, s34, 0
s_memtime s[52:53]
s_waitcnt lgkmcnt(0)
s_load_dword s37, s[4:5], s36
s_waitcnt lgkmcnt(0)
s_memtime s[60:61]
s_waitcnt lgkmcnt(0)
s_sub_u32 s38, s60, s52
s_add_u32 s36, s34, 8192
s_memtime s[52:53]
s_waitcnt lgkmcnt(0)
s_load_dword s37, s[4:5], s36
s_waitcnt lgkmcnt(0)
s_memtime s[60:61]
s_waitcnt lgkmcnt(0)
s_sub_u32 s39, s60, s52
s_add_u32 s36, s34, 128
s_memtime s[52:53]
s_waitcnt lgkmcnt(0)
s_load_dword s37, s[4:5], s36
s_waitcnt lgkmcnt(0)
s_memtime s[60:61]
s_waitcnt lgkmcnt(0)
s_sub_u32 s37, s60, s52
s_min_u32 s38, s38, s37
s_add_u32 s36, s34, 8320
s_memtime s[52:53]
s_waitcnt lgkmcnt(0)
s_load_dword s37, s[4:5], s36
s_waitcnt lgkmcnt(0)
s_memtime s[60:61]
s_waitcnt lgkmcnt(0)
s_sub_u32 s37, s60, s52
s_min_u32 s39, s39, s37
s_cmp_lt_u32 s38, s39
s_cselect_b32 s36, 0, 1
s_lshr_b32 s37, s29, 2
s_xor_b32 s36, s36, s37
s_add_u32 s36, s36, 0x10000
v_mov_b32 v242, s36
s_and_b32 s36, s51, 1
s_lshl_b32 s36, s36, 7
s_lshr_b32 s37, s51, 1
s_lshl_b32 s37, s37, 4
s_add_u32 s36, s36, s37
buffer_atomic_add v242, v251, s[24:27], s36 offen sc1
Lvote_5:
s_mov_b64 exec, 0
s_cmp_eq_u32 s28, 3
s_cbranch_scc1 L_stub0
s_cmp_eq_u32 s28, 0
s_cbranch_scc1 L_stub1
s_cmp_eq_u32 s28, 2
s_cbranch_scc1 L_stub2
L_wret0:
s_mov_b64 exec, -1
s_cmp_lg_u32 s28, 1
s_cbranch_scc1 Lg1e_4
s_cmp_eq_u32 s54, 32
s_cselect_b32 s39, 0, 1
s_or_b32 s39, s39, 0xffff0000
s_mov_b32 s38, -1
s_add_u32 s36, s67, 0xc0000
s_mov_b32 s37, 0
Lg1p_3:
v_mov_b32 v11, 0
buffer_atomic_add v11, v241, s[4:7], s36 offen sc0 sc1
s_add_u32 s37, s37, 1
v_mov_b32 v242, v15
s_mov_b64 exec, 0xffff
v_mov_b32 v242, 0
buffer_atomic_add v242, v241, s[4:7], s89 offen sc0 sc1
s_mov_b64 exec, -1
s_waitcnt vmcnt(0)
v_cmp_ne_u32 vcc, v11, v15
v_cmp_ne_u32 s[52:53], v242, v15
s_and_b64 vcc, vcc, s[38:39]
s_or_b64 vcc, vcc, s[52:53]
s_cbranch_scc0 Lg1e_4
s_cmp_lt_u32 s37, 0x100000
s_cbranch_scc1 Lg1p_3
Lg1e_4:
s_barrier
s_add_u32 s94, s71, 0x80
s_add_u32 m0, s18, 0x0
s_add_u32 s44, s50, 0x2000000
buffer_load_dwordx4 v1, s[4:7], s44 offen offset:0 sc1 lds
buffer_load_dwordx4 v1, s[4:7], s44 offen offset:1024 sc1 lds
s_add_u32 m0, s18, 0x2000
s_add_u32 s44, s50, 0x2002000
buffer_load_dwordx4 v1, s[4:7], s44 offen offset:0 sc1 lds
buffer_load_dwordx4 v1, s[4:7], s44 offen offset:1024 sc1 lds
s_add_u32 m0, s18, 0x4000
s_add_u32 s44, s50, 0x2004000
buffer_load_dwordx4 v1, s[4:7], s44 offen offset:0 sc1 lds
buffer_load_dwordx4 v1, s[4:7], s44 offen offset:1024 sc1 lds
s_add_u32 m0, s18, 0x6000
s_add_u32 s44, s50, 0x2006000
buffer_load_dwordx4 v1, s[4:7], s44 offen offset:0 sc1 lds
buffer_load_dwordx4 v1, s[4:7], s44 offen offset:1024 sc1 lds
s_add_u32 m0, s18, 0x8000
s_add_u32 s44, s50, 0x2008000
buffer_load_dwordx4 v1, s[4:7], s44 offen offset:0 sc1 lds
buffer_load_dwordx4 v1, s[4:7], s44 offen offset:1024 sc1 lds
s_add_u32 m0, s18, 0xa000
s_add_u32 s44, s50, 0x200a000
buffer_load_dwordx4 v1, s[4:7], s44 offen offset:0 sc1 lds
buffer_load_dwordx4 v1, s[4:7], s44 offen offset:1024 sc1 lds
s_mov_b32 s35, 0
s_add_u32 s33, s35, 0x1000
buffer_load_dwordx4 a[0:3], v2, s[40:43], s35 offen offset:0 sc1
buffer_load_dwordx4 a[4:7], v2, s[40:43], s33 offen offset:0 sc1
buffer_load_dwordx4 a[8:11], v2, s[40:43], s35 offen offset:1024 sc1
buffer_load_dwordx4 a[12:15], v2, s[40:43], s33 offen offset:1024 sc1
buffer_load_dwordx4 a[16:19], v2, s[40:43], s35 offen offset:2048 sc1
buffer_load_dwordx4 a[20:23], v2, s[40:43], s33 offen offset:2048 sc1
buffer_load_dwordx4 a[24:27], v2, s[40:43], s35 offen offset:3072 sc1
buffer_load_dwordx4 a[28:31], v2, s[40:43], s33 offen offset:3072 sc1
s_add_u32 s35, s35, 0x2000
s_add_u32 s33, s33, 0x2000
buffer_load_dwordx4 a[32:35], v2, s[40:43], s35 offen offset:0 sc1
buffer_load_dwordx4 a[36:39], v2, s[40:43], s33 offen offset:0 sc1
buffer_load_dwordx4 a[40:43], v2, s[40:43], s35 offen offset:1024 sc1
buffer_load_dwordx4 a[44:47], v2, s[40:43], s33 offen offset:1024 sc1
buffer_load_dwordx4 a[48:51], v2, s[40:43], s35 offen offset:2048 sc1
buffer_load_dwordx4 a[52:55], v2, s[40:43], s33 offen offset:2048 sc1
buffer_load_dwordx4 a[56:59], v2, s[40:43], s35 offen offset:3072 sc1
buffer_load_dwordx4 a[60:63], v2, s[40:43], s33 offen offset:3072 sc1
s_add_u32 s35, s35, 0x2000
s_add_u32 s33, s33, 0x2000
s_waitcnt vmcnt(16)
s_barrier
v_add_u32 v5, 0, v1
ds_read_b128 a[96:99], v5 offset:2048
ds_read_b128 a[100:103], v5 offset:8192
ds_read_b128 a[104:107], v5 offset:3072
ds_read_b128 a[108:111], v5 offset:9216
ds_read_b128 a[112:115], v5 offset:4096
ds_read_b128 a[116:119], v5 offset:10240
s_waitcnt vmcnt(14) lgkmcnt(4)
v_mfma_f32_16x16x32_bf16 v[140:143], a[96:99], a[0:3], 0
s_add_u32 m0, s18, 0xc000
s_add_u32 s44, s50, 0x200c000
v_mfma_f32_16x16x32_bf16 v[140:143], a[100:103], a[4:7], v[140:143]
buffer_load_dwordx4 a[64:67], v2, s[40:43], s35 offen offset:0 sc1
s_waitcnt vmcnt(13)
v_mfma_f32_16x16x32_bf16 v[164:167], a[100:103], a[12:15], 0
ds_read_b128 a[128:131], v5 offset:5120
v_mfma_f32_16x16x32_bf16 v[164:167], a[96:99], a[8:11], v[164:167]
ds_read_b128 a[132:135], v5 offset:11264
s_waitcnt vmcnt(12)
v_mfma_f32_16x16x32_bf16 v[188:191], a[96:99], a[16:19], 0
s_waitcnt vmcnt(11)
v_mfma_f32_16x16x32_bf16 v[188:191], a[100:103], a[20:23], v[188:191]
buffer_load_dwordx4 v1, s[4:7], s44 offen offset:0 sc1 lds
s_waitcnt vmcnt(10)
v_mfma_f32_16x16x32_bf16 v[212:215], a[100:103], a[28:31], 0
ds_read_b128 a[136:139], v5 offset:0
v_mfma_f32_16x16x32_bf16 v[212:215], a[96:99], a[24:27], v[212:215]
s_waitcnt lgkmcnt(6)
v_mfma_f32_16x16x32_bf16 v[216:219], a[104:107], a[24:27], 0
ds_read_b128 a[140:143], v5 offset:6144
s_waitcnt lgkmcnt(6)
v_mfma_f32_16x16x32_bf16 v[216:219], a[108:111], a[28:31], v[216:219]
buffer_load_dwordx4 a[68:71], v2, s[40:43], s33 offen offset:0 sc1
v_mfma_f32_16x16x32_bf16 v[192:195], a[108:111], a[20:23], 0
ds_read_b128 a[144:147], v5 offset:1024
v_mfma_f32_16x16x32_bf16 v[192:195], a[104:107], a[16:19], v[192:195]
v_mfma_f32_16x16x32_bf16 v[168:171], a[104:107], a[8:11], 0
v_mfma_f32_16x16x32_bf16 v[168:171], a[108:111], a[12:15], v[168:171]
buffer_load_dwordx4 a[72:75], v2, s[40:43], s35 offen offset:1024 sc1
v_mfma_f32_16x16x32_bf16 v[144:147], a[108:111], a[4:7], 0
ds_read_b128 a[148:151], v5 offset:7168
v_mfma_f32_16x16x32_bf16 v[144:147], a[104:107], a[0:3], v[144:147]
s_waitcnt lgkmcnt(7)
v_mfma_f32_16x16x32_bf16 v[148:151], a[112:115], a[0:3], 0
s_waitcnt lgkmcnt(6)
v_mfma_f32_16x16x32_bf16 v[148:151], a[116:119], a[4:7], v[148:151]
buffer_load_dwordx4 v1, s[4:7], s44 offen offset:1024 sc1 lds
s_add_u32 m0, s18, 0xe000
v_mfma_f32_16x16x32_bf16 v[172:175], a[116:119], a[12:15], 0
s_add_u32 s44, s50, 0x200e000
v_mfma_f32_16x16x32_bf16 v[172:175], a[112:115], a[8:11], v[172:175]
v_mfma_f32_16x16x32_bf16 v[196:199], a[112:115], a[16:19], 0
v_mfma_f32_16x16x32_bf16 v[196:199], a[116:119], a[20:23], v[196:199]
buffer_load_dwordx4 a[76:79], v2, s[40:43], s33 offen offset:1024 sc1
v_mfma_f32_16x16x32_bf16 v[220:223], a[116:119], a[28:31], 0
v_mfma_f32_16x16x32_bf16 v[220:223], a[112:115], a[24:27], v[220:223]
s_waitcnt lgkmcnt(0)
v_mfma_f32_16x16x32_bf16 v[224:227], a[128:131], a[24:27], 0
ds_read_b128 a[96:99], v5 offset:14336
v_mfma_f32_16x16x32_bf16 v[224:227], a[132:135], a[28:31], v[224:227]
buffer_load_dwordx4 a[80:83], v2, s[40:43], s35 offen offset:2048 sc1
v_mfma_f32_16x16x32_bf16 v[200:203], a[132:135], a[20:23], 0
ds_read_b128 a[100:103], v5 offset:20480
v_mfma_f32_16x16x32_bf16 v[200:203], a[128:131], a[16:19], v[200:203]
v_mfma_f32_16x16x32_bf16 v[176:179], a[128:131], a[8:11], 0
v_mfma_f32_16x16x32_bf16 v[176:179], a[132:135], a[12:15], v[176:179]
buffer_load_dwordx4 v1, s[4:7], s44 offen offset:0 sc1 lds
v_mfma_f32_16x16x32_bf16 v[152:155], a[132:135], a[4:7], 0
ds_read_b128 a[104:107], v5 offset:15360
v_mfma_f32_16x16x32_bf16 v[152:155], a[128:131], a[0:3], v[152:155]
v_mfma_f32_16x16x32_bf16 v[132:135], a[136:139], a[0:3], 0
ds_read_b128 a[108:111], v5 offset:21504
v_mfma_f32_16x16x32_bf16 v[132:135], a[140:143], a[4:7], v[132:135]
buffer_load_dwordx4 a[84:87], v2, s[40:43], s33 offen offset:2048 sc1
v_mfma_f32_16x16x32_bf16 v[156:159], a[140:143], a[12:15], 0
ds_read_b128 a[112:115], v5 offset:16384
v_mfma_f32_16x16x32_bf16 v[156:159], a[136:139], a[8:11], v[156:159]
v_mfma_f32_16x16x32_bf16 v[180:183], a[136:139], a[16:19], 0
v_mfma_f32_16x16x32_bf16 v[180:183], a[140:143], a[20:23], v[180:183]
buffer_load_dwordx4 a[88:91], v2, s[40:43], s35 offen offset:3072 sc1
v_mfma_f32_16x16x32_bf16 v[204:207], a[140:143], a[28:31], 0
ds_read_b128 a[116:119], v5 offset:22528
v_mfma_f32_16x16x32_bf16 v[204:207], a[136:139], a[24:27], v[204:207]
v_mfma_f32_16x16x32_bf16 v[208:211], a[144:147], a[24:27], 0
v_mfma_f32_16x16x32_bf16 v[208:211], a[148:151], a[28:31], v[208:211]
buffer_load_dwordx4 v1, s[4:7], s44 offen offset:1024 sc1 lds
s_add_u32 m0, s18, 0x10000
v_mfma_f32_16x16x32_bf16 v[184:187], a[148:151], a[20:23], 0
s_add_u32 s44, s50, 0x2010000
v_mfma_f32_16x16x32_bf16 v[184:187], a[144:147], a[16:19], v[184:187]
v_mfma_f32_16x16x32_bf16 v[160:163], a[144:147], a[8:11], 0
v_mfma_f32_16x16x32_bf16 v[160:163], a[148:151], a[12:15], v[160:163]
buffer_load_dwordx4 a[92:95], v2, s[40:43], s33 offen offset:3072 sc1
s_add_u32 s35, s35, 0x2000
v_mfma_f32_16x16x32_bf16 v[136:139], a[148:151], a[4:7], 0
s_add_u32 s33, s33, 0x2000
v_mfma_f32_16x16x32_bf16 v[136:139], a[144:147], a[0:3], v[136:139]
s_waitcnt vmcnt(12) lgkmcnt(0)
v_mfma_f32_16x16x32_bf16 v[140:143], a[96:99], a[32:35], v[140:143]
ds_read_b128 a[128:131], v5 offset:17408
v_mfma_f32_16x16x32_bf16 v[140:143], a[100:103], a[36:39], v[140:143]
buffer_load_dwordx4 a[0:3], v2, s[40:43], s35 offen offset:0 sc1
v_mfma_f32_16x16x32_bf16 v[164:167], a[100:103], a[44:47], v[164:167]
ds_read_b128 a[132:135], v5 offset:23552
v_mfma_f32_16x16x32_bf16 v[164:167], a[96:99], a[40:43], v[164:167]
v_mfma_f32_16x16x32_bf16 v[188:191], a[96:99], a[48:51], v[188:191]
v_mfma_f32_16x16x32_bf16 v[188:191], a[100:103], a[52:55], v[188:191]
buffer_load_dwordx4 v1, s[4:7], s44 offen offset:0 sc1 lds
v_mfma_f32_16x16x32_bf16 v[212:215], a[100:103], a[60:63], v[212:215]
ds_read_b128 a[136:139], v5 offset:12288
v_mfma_f32_16x16x32_bf16 v[212:215], a[96:99], a[56:59], v[212:215]
v_mfma_f32_16x16x32_bf16 v[216:219], a[104:107], a[56:59], v[216:219]
ds_read_b128 a[140:143], v5 offset:18432
v_mfma_f32_16x16x32_bf16 v[216:219], a[108:111], a[60:63], v[216:219]
buffer_load_dwordx4 a[4:7], v2, s[40:43], s33 offen offset:0 sc1
v_mfma_f32_16x16x32_bf16 v[192:195], a[108:111], a[52:55], v[192:195]
ds_read_b128 a[144:147], v5 offset:13312
v_mfma_f32_16x16x32_bf16 v[192:195], a[104:107], a[48:51], v[192:195]
v_mfma_f32_16x16x32_bf16 v[168:171], a[104:107], a[40:43], v[168:171]
v_mfma_f32_16x16x32_bf16 v[168:171], a[108:111], a[44:47], v[168:171]
buffer_load_dwordx4 a[8:11], v2, s[40:43], s35 offen offset:1024 sc1
v_mfma_f32_16x16x32_bf16 v[144:147], a[108:111], a[36:39], v[144:147]
ds_read_b128 a[148:151], v5 offset:19456
v_mfma_f32_16x16x32_bf16 v[144:147], a[104:107], a[32:35], v[144:147]
v_mfma_f32_16x16x32_bf16 v[148:151], a[112:115], a[32:35], v[148:151]
v_mfma_f32_16x16x32_bf16 v[148:151], a[116:119], a[36:39], v[148:151]
buffer_load_dwordx4 v1, s[4:7], s44 offen offset:1024 sc1 lds
s_add_u32 m0, s18, 0x12000
v_mfma_f32_16x16x32_bf16 v[172:175], a[116:119], a[44:47], v[172:175]
s_add_u32 s44, s50, 0x2012000
v_mfma_f32_16x16x32_bf16 v[172:175], a[112:115], a[40:43], v[172:175]
v_mfma_f32_16x16x32_bf16 v[196:199], a[112:115], a[48:51], v[196:199]
v_mfma_f32_16x16x32_bf16 v[196:199], a[116:119], a[52:55], v[196:199]
buffer_load_dwordx4 a[12:15], v2, s[40:43], s33 offen offset:1024 sc1
v_mfma_f32_16x16x32_bf16 v[220:223], a[116:119], a[60:63], v[220:223]
v_mfma_f32_16x16x32_bf16 v[220:223], a[112:115], a[56:59], v[220:223]
s_waitcnt lgkmcnt(0)
v_mfma_f32_16x16x32_bf16 v[224:227], a[128:131], a[56:59], v[224:227]
ds_read_b128 a[96:99], v5 offset:26624
v_mfma_f32_16x16x32_bf16 v[224:227], a[132:135], a[60:63], v[224:227]
buffer_load_dwordx4 a[16:19], v2, s[40:43], s35 offen offset:2048 sc1
v_mfma_f32_16x16x32_bf16 v[200:203], a[132:135], a[52:55], v[200:203]
ds_read_b128 a[100:103], v5 offset:32768
v_mfma_f32_16x16x32_bf16 v[200:203], a[128:131], a[48:51], v[200:203]
v_mfma_f32_16x16x32_bf16 v[176:179], a[128:131], a[40:43], v[176:179]
v_mfma_f32_16x16x32_bf16 v[176:179], a[132:135], a[44:47], v[176:179]
buffer_load_dwordx4 v1, s[4:7], s44 offen offset:0 sc1 lds
v_mfma_f32_16x16x32_bf16 v[152:155], a[132:135], a[36:39], v[152:155]
ds_read_b128 a[104:107], v5 offset:27648
v_mfma_f32_16x16x32_bf16 v[152:155], a[128:131], a[32:35], v[152:155]
v_mfma_f32_16x16x32_bf16 v[132:135], a[136:139], a[32:35], v[132:135]
ds_read_b128 a[108:111], v5 offset:33792
v_mfma_f32_16x16x32_bf16 v[132:135], a[140:143], a[36:39], v[132:135]
buffer_load_dwordx4 a[20:23], v2, s[40:43], s33 offen offset:2048 sc1
v_mfma_f32_16x16x32_bf16 v[156:159], a[140:143], a[44:47], v[156:159]
ds_read_b128 a[112:115], v5 offset:28672
v_mfma_f32_16x16x32_bf16 v[156:159], a[136:139], a[40:43], v[156:159]
v_mfma_f32_16x16x32_bf16 v[180:183], a[136:139], a[48:51], v[180:183]
v_mfma_f32_16x16x32_bf16 v[180:183], a[140:143], a[52:55], v[180:183]
buffer_load_dwordx4 a[24:27], v2, s[40:43], s35 offen offset:3072 sc1
v_mfma_f32_16x16x32_bf16 v[204:207], a[140:143], a[60:63], v[204:207]
ds_read_b128 a[116:119], v5 offset:34816
v_mfma_f32_16x16x32_bf16 v[204:207], a[136:139], a[56:59], v[204:207]
v_mfma_f32_16x16x32_bf16 v[208:211], a[144:147], a[56:59], v[208:211]
v_mfma_f32_16x16x32_bf16 v[208:211], a[148:151], a[60:63], v[208:211]
buffer_load_dwordx4 v1, s[4:7], s44 offen offset:1024 sc1 lds
s_add_u32 m0, s18, 0x14000
v_mfma_f32_16x16x32_bf16 v[184:187], a[148:151], a[52:55], v[184:187]
s_add_u32 s44, s50, 0x2014000
v_mfma_f32_16x16x32_bf16 v[184:187], a[144:147], a[48:51], v[184:187]
v_mfma_f32_16x16x32_bf16 v[160:163], a[144:147], a[40:43], v[160:163]
v_mfma_f32_16x16x32_bf16 v[160:163], a[148:151], a[44:47], v[160:163]
buffer_load_dwordx4 a[28:31], v2, s[40:43], s33 offen offset:3072 sc1
s_add_u32 s35, s35, 0x2000
v_mfma_f32_16x16x32_bf16 v[136:139], a[148:151], a[36:39], v[136:139]
s_add_u32 s33, s33, 0x2000
v_mfma_f32_16x16x32_bf16 v[136:139], a[144:147], a[32:35], v[136:139]
s_waitcnt vmcnt(12) lgkmcnt(0)
v_mfma_f32_16x16x32_bf16 v[140:143], a[96:99], a[64:67], v[140:143]
ds_read_b128 a[128:131], v5 offset:29696
v_mfma_f32_16x16x32_bf16 v[140:143], a[100:103], a[68:71], v[140:143]
buffer_load_dwordx4 a[32:35], v2, s[40:43], s35 offen offset:0 sc1
v_mfma_f32_16x16x32_bf16 v[164:167], a[100:103], a[76:79], v[164:167]
ds_read_b128 a[132:135], v5 offset:35840
v_mfma_f32_16x16x32_bf16 v[164:167], a[96:99], a[72:75], v[164:167]
v_mfma_f32_16x16x32_bf16 v[188:191], a[96:99], a[80:83], v[188:191]
v_mfma_f32_16x16x32_bf16 v[188:191], a[100:103], a[84:87], v[188:191]
buffer_load_dwordx4 v1, s[4:7], s44 offen offset:0 sc1 lds
v_mfma_f32_16x16x32_bf16 v[212:215], a[100:103], a[92:95], v[212:215]
ds_read_b128 a[136:139], v5 offset:24576
v_mfma_f32_16x16x32_bf16 v[212:215], a[96:99], a[88:91], v[212:215]
v_mfma_f32_16x16x32_bf16 v[216:219], a[104:107], a[88:91], v[216:219]
ds_read_b128 a[140:143], v5 offset:30720
v_mfma_f32_16x16x32_bf16 v[216:219], a[108:111], a[92:95], v[216:219]
buffer_load_dwordx4 a[36:39], v2, s[40:43], s33 offen offset:0 sc1
v_mfma_f32_16x16x32_bf16 v[192:195], a[108:111], a[84:87], v[192:195]
ds_read_b128 a[144:147], v5 offset:25600
v_mfma_f32_16x16x32_bf16 v[192:195], a[104:107], a[80:83], v[192:195]
v_mfma_f32_16x16x32_bf16 v[168:171], a[104:107], a[72:75], v[168:171]
v_mfma_f32_16x16x32_bf16 v[168:171], a[108:111], a[76:79], v[168:171]
buffer_load_dwordx4 a[40:43], v2, s[40:43], s35 offen offset:1024 sc1
v_mfma_f32_16x16x32_bf16 v[144:147], a[108:111], a[68:71], v[144:147]
ds_read_b128 a[148:151], v5 offset:31744
v_mfma_f32_16x16x32_bf16 v[144:147], a[104:107], a[64:67], v[144:147]
v_mfma_f32_16x16x32_bf16 v[148:151], a[112:115], a[64:67], v[148:151]
v_mfma_f32_16x16x32_bf16 v[148:151], a[116:119], a[68:71], v[148:151]
buffer_load_dwordx4 v1, s[4:7], s44 offen offset:1024 sc1 lds
s_add_u32 m0, s18, 0x16000
v_mfma_f32_16x16x32_bf16 v[172:175], a[116:119], a[76:79], v[172:175]
s_add_u32 s44, s50, 0x2016000
v_mfma_f32_16x16x32_bf16 v[172:175], a[112:115], a[72:75], v[172:175]
v_mfma_f32_16x16x32_bf16 v[196:199], a[112:115], a[80:83], v[196:199]
v_mfma_f32_16x16x32_bf16 v[196:199], a[116:119], a[84:87], v[196:199]
buffer_load_dwordx4 a[44:47], v2, s[40:43], s33 offen offset:1024 sc1
v_mfma_f32_16x16x32_bf16 v[220:223], a[116:119], a[92:95], v[220:223]
v_mfma_f32_16x16x32_bf16 v[220:223], a[112:115], a[88:91], v[220:223]
s_waitcnt lgkmcnt(0)
v_mfma_f32_16x16x32_bf16 v[224:227], a[128:131], a[88:91], v[224:227]
ds_read_b128 a[96:99], v5 offset:38912
v_mfma_f32_16x16x32_bf16 v[224:227], a[132:135], a[92:95], v[224:227]
buffer_load_dwordx4 a[48:51], v2, s[40:43], s35 offen offset:2048 sc1
v_mfma_f32_16x16x32_bf16 v[200:203], a[132:135], a[84:87], v[200:203]
ds_read_b128 a[100:103], v5 offset:45056
v_mfma_f32_16x16x32_bf16 v[200:203], a[128:131], a[80:83], v[200:203]
v_mfma_f32_16x16x32_bf16 v[176:179], a[128:131], a[72:75], v[176:179]
buffer_load_dwordx4 v1, s[4:7], s44 offen offset:0 sc1 lds
v_mfma_f32_16x16x32_bf16 v[176:179], a[132:135], a[76:79], v[176:179]
ds_read_b128 a[104:107], v5 offset:39936
v_mfma_f32_16x16x32_bf16 v[152:155], a[132:135], a[68:71], v[152:155]
v_mfma_f32_16x16x32_bf16 v[152:155], a[128:131], a[64:67], v[152:155]
buffer_load_dwordx4 a[52:55], v2, s[40:43], s33 offen offset:2048 sc1
v_mfma_f32_16x16x32_bf16 v[132:135], a[136:139], a[64:67], v[132:135]
ds_read_b128 a[108:111], v5 offset:46080
v_mfma_f32_16x16x32_bf16 v[132:135], a[140:143], a[68:71], v[132:135]
v_mfma_f32_16x16x32_bf16 v[156:159], a[140:143], a[76:79], v[156:159]
ds_read_b128 a[112:115], v5 offset:40960
v_mfma_f32_16x16x32_bf16 v[156:159], a[136:139], a[72:75], v[156:159]
buffer_load_dwordx4 v1, s[4:7], s44 offen offset:1024 sc1 lds
v_mfma_f32_16x16x32_bf16 v[180:183], a[136:139], a[80:83], v[180:183]
v_and_b32 v232, 15, v0
v_lshlrev_b32 v232, 7, v232
v_mfma_f32_16x16x32_bf16 v[180:183], a[140:143], a[84:87], v[180:183]
v_lshrrev_b32 v233, 4, v0
v_lshlrev_b32 v233, 4, v233
v_mfma_f32_16x16x32_bf16 v[204:207], a[140:143], a[92:95], v[204:207]
buffer_load_dwordx4 a[56:59], v2, s[40:43], s35 offen offset:3072 sc1
v_mfma_f32_16x16x32_bf16 v[204:207], a[136:139], a[88:91], v[204:207]
v_add_u32 v232, v233, v232
s_mul_i32 s38, s30, 12288
v_mfma_f32_16x16x32_bf16 v[208:211], a[144:147], a[88:91], v[208:211]
s_add_u32 s38, s38, 0x1800000
s_add_u32 s39, s28, 4
s_min_u32 s39, s39, 5
v_mfma_f32_16x16x32_bf16 v[208:211], a[148:151], a[92:95], v[208:211]
s_lshl_b32 s36, s28, 11
s_add_u32 s36, s36, s38
s_lshl_b32 s37, s39, 11
s_add_u32 s37, s37, s38
v_mfma_f32_16x16x32_bf16 v[184:187], a[148:151], a[84:87], v[184:187]
buffer_load_dwordx4 v[48:51], v232, s[4:7], s36 offen sc1
v_mfma_f32_16x16x32_bf16 v[184:187], a[144:147], a[80:83], v[184:187]
ds_read_b128 a[116:119], v5 offset:47104
v_mfma_f32_16x16x32_bf16 v[160:163], a[144:147], a[72:75], v[160:163]
v_mfma_f32_16x16x32_bf16 v[160:163], a[148:151], a[76:79], v[160:163]
buffer_load_dwordx4 a[60:63], v2, s[40:43], s33 offen offset:3072 sc1
s_add_u32 s35, s35, 0x2000
v_mfma_f32_16x16x32_bf16 v[136:139], a[148:151], a[68:71], v[136:139]
s_add_u32 s33, s33, 0x2000
v_mfma_f32_16x16x32_bf16 v[136:139], a[144:147], a[64:67], v[136:139]
s_waitcnt vmcnt(13) lgkmcnt(0)
v_mfma_f32_16x16x32_bf16 v[140:143], a[96:99], a[0:3], v[140:143]
ds_read_b128 a[128:131], v5 offset:41984
v_mfma_f32_16x16x32_bf16 v[140:143], a[100:103], a[4:7], v[140:143]
buffer_load_dwordx4 a[64:67], v2, s[40:43], s35 offen offset:0 sc1
v_mfma_f32_16x16x32_bf16 v[164:167], a[100:103], a[12:15], v[164:167]
ds_read_b128 a[132:135], v5 offset:48128
v_mfma_f32_16x16x32_bf16 v[164:167], a[96:99], a[8:11], v[164:167]
v_mfma_f32_16x16x32_bf16 v[188:191], a[96:99], a[16:19], v[188:191]
v_mfma_f32_16x16x32_bf16 v[188:191], a[100:103], a[20:23], v[188:191]
buffer_load_dwordx4 v[52:55], v232, s[4:7], s37 offen sc1
s_add_u32 m0, s18, 0x18000
v_mfma_f32_16x16x32_bf16 v[212:215], a[100:103], a[28:31], v[212:215]
s_add_u32 s44, s50, 0x2018000
ds_read_b128 a[136:139], v5 offset:36864
v_mfma_f32_16x16x32_bf16 v[212:215], a[96:99], a[24:27], v[212:215]
v_mfma_f32_16x16x32_bf16 v[216:219], a[104:107], a[24:27], v[216:219]
ds_read_b128 a[140:143], v5 offset:43008
v_mfma_f32_16x16x32_bf16 v[216:219], a[108:111], a[28:31], v[216:219]
buffer_load_dwordx4 a[68:71], v2, s[40:43], s33 offen offset:0 sc1
v_mfma_f32_16x16x32_bf16 v[192:195], a[108:111], a[20:23], v[192:195]
ds_read_b128 a[144:147], v5 offset:37888
v_mfma_f32_16x16x32_bf16 v[192:195], a[104:107], a[16:19], v[192:195]
v_mfma_f32_16x16x32_bf16 v[168:171], a[104:107], a[8:11], v[168:171]
v_mfma_f32_16x16x32_bf16 v[168:171], a[108:111], a[12:15], v[168:171]
buffer_load_dwordx4 a[72:75], v2, s[40:43], s35 offen offset:1024 sc1
v_mfma_f32_16x16x32_bf16 v[144:147], a[108:111], a[4:7], v[144:147]
ds_read_b128 a[148:151], v5 offset:44032
v_mfma_f32_16x16x32_bf16 v[144:147], a[104:107], a[0:3], v[144:147]
v_mfma_f32_16x16x32_bf16 v[148:151], a[112:115], a[0:3], v[148:151]
v_mfma_f32_16x16x32_bf16 v[148:151], a[116:119], a[4:7], v[148:151]
buffer_load_dwordx4 v1, s[4:7], s44 offen offset:0 sc1 lds
v_mfma_f32_16x16x32_bf16 v[172:175], a[116:119], a[12:15], v[172:175]
v_mfma_f32_16x16x32_bf16 v[172:175], a[112:115], a[8:11], v[172:175]
v_mfma_f32_16x16x32_bf16 v[196:199], a[112:115], a[16:19], v[196:199]
v_mfma_f32_16x16x32_bf16 v[196:199], a[116:119], a[20:23], v[196:199]
buffer_load_dwordx4 a[76:79], v2, s[40:43], s33 offen offset:1024 sc1
v_mfma_f32_16x16x32_bf16 v[220:223], a[116:119], a[28:31], v[220:223]
v_mfma_f32_16x16x32_bf16 v[220:223], a[112:115], a[24:27], v[220:223]
s_waitcnt lgkmcnt(0)
s_barrier
v_mfma_f32_16x16x32_bf16 v[224:227], a[128:131], a[24:27], v[224:227]
v_add_u32 v5, 49152, v1
v_mfma_f32_16x16x32_bf16 v[224:227], a[132:135], a[28:31], v[224:227]
buffer_load_dwordx4 a[80:83], v2, s[40:43], s35 offen offset:2048 sc1
v_mfma_f32_16x16x32_bf16 v[200:203], a[132:135], a[20:23], v[200:203]
ds_read_b128 a[96:99], v5 offset:2048
v_mfma_f32_16x16x32_bf16 v[200:203], a[128:131], a[16:19], v[200:203]
ds_read_b128 a[100:103], v5 offset:8192
v_mfma_f32_16x16x32_bf16 v[176:179], a[128:131], a[8:11], v[176:179]
ds_write_b128 v231, a[220:223] offset:24576
v_mfma_f32_16x16x32_bf16 v[176:179], a[132:135], a[12:15], v[176:179]
buffer_load_dwordx4 v1, s[4:7], s44 offen offset:1024 sc1 lds
s_add_u32 m0, s18, 0x1a000
v_mfma_f32_16x16x32_bf16 v[152:155], a[132:135], a[4:7], v[152:155]
s_add_u32 s44, s50, 0x201a000
ds_read_b128 a[104:107], v5 offset:3072
v_mfma_f32_16x16x32_bf16 v[152:155], a[128:131], a[0:3], v[152:155]
v_mfma_f32_16x16x32_bf16 v[132:135], a[136:139], a[0:3], v[132:135]
ds_read_b128 a[108:111], v5 offset:9216
v_mfma_f32_16x16x32_bf16 v[132:135], a[140:143], a[4:7], v[132:135]
buffer_load_dwordx4 a[84:87], v2, s[40:43], s33 offen offset:2048 sc1
v_mfma_f32_16x16x32_bf16 v[156:159], a[140:143], a[12:15], v[156:159]
ds_read_b128 a[112:115], v5 offset:4096
v_mfma_f32_16x16x32_bf16 v[156:159], a[136:139], a[8:11], v[156:159]
ds_write_b128 v231, a[224:227] offset:25600
v_mfma_f32_16x16x32_bf16 v[180:183], a[136:139], a[16:19], v[180:183]
v_mfma_f32_16x16x32_bf16 v[180:183], a[140:143], a[20:23], v[180:183]
buffer_load_dwordx4 a[88:91], v2, s[40:43], s35 offen offset:3072 sc1
v_mfma_f32_16x16x32_bf16 v[204:207], a[140:143], a[28:31], v[204:207]
ds_read_b128 a[116:119], v5 offset:10240
v_mfma_f32_16x16x32_bf16 v[204:207], a[136:139], a[24:27], v[204:207]
v_mfma_f32_16x16x32_bf16 v[208:211], a[144:147], a[24:27], v[208:211]
v_mfma_f32_16x16x32_bf16 v[208:211], a[148:151], a[28:31], v[208:211]
buffer_load_dwordx4 v1, s[4:7], s44 offen offset:0 sc1 lds
v_mfma_f32_16x16x32_bf16 v[184:187], a[148:151], a[20:23], v[184:187]
v_mfma_f32_16x16x32_bf16 v[184:187], a[144:147], a[16:19], v[184:187]
v_mfma_f32_16x16x32_bf16 v[160:163], a[144:147], a[8:11], v[160:163]
v_mfma_f32_16x16x32_bf16 v[160:163], a[148:151], a[12:15], v[160:163]
buffer_load_dwordx4 a[92:95], v2, s[40:43], s33 offen offset:3072 sc1
s_add_u32 s35, s35, 0x2000
v_mfma_f32_16x16x32_bf16 v[136:139], a[148:151], a[4:7], v[136:139]
s_add_u32 s33, s33, 0x2000
ds_write_b128 v231, a[188:191] offset:0
v_mfma_f32_16x16x32_bf16 v[136:139], a[144:147], a[0:3], v[136:139]
s_waitcnt vmcnt(12) lgkmcnt(1)
v_mfma_f32_16x16x32_bf16 v[140:143], a[96:99], a[32:35], v[140:143]
ds_read_b128 a[128:131], v5 offset:5120
v_mfma_f32_16x16x32_bf16 v[140:143], a[100:103], a[36:39], v[140:143]
buffer_load_dwordx4 a[0:3], v2, s[40:43], s35 offen offset:0 sc1
v_mfma_f32_16x16x32_bf16 v[164:167], a[100:103], a[44:47], v[164:167]
ds_read_b128 a[132:135], v5 offset:11264
v_mfma_f32_16x16x32_bf16 v[164:167], a[96:99], a[40:43], v[164:167]
v_mfma_f32_16x16x32_bf16 v[188:191], a[96:99], a[48:51], v[188:191]
v_mfma_f32_16x16x32_bf16 v[188:191], a[100:103], a[52:55], v[188:191]
buffer_load_dwordx4 v1, s[4:7], s44 offen offset:1024 sc1 lds
s_add_u32 m0, s18, 0x1c000
v_mfma_f32_16x16x32_bf16 v[212:215], a[100:103], a[60:63], v[212:215]
s_add_u32 s44, s50, 0x201c000
ds_read_b128 a[136:139], v5 offset:0
v_mfma_f32_16x16x32_bf16 v[212:215], a[96:99], a[56:59], v[212:215]
ds_write_b128 v231, a[192:195] offset:1024
v_mfma_f32_16x16x32_bf16 v[216:219], a[104:107], a[56:59], v[216:219]
ds_read_b128 a[140:143], v5 offset:6144
v_mfma_f32_16x16x32_bf16 v[216:219], a[108:111], a[60:63], v[216:219]
buffer_load_dwordx4 a[4:7], v2, s[40:43], s33 offen offset:0 sc1
v_mfma_f32_16x16x32_bf16 v[192:195], a[108:111], a[52:55], v[192:195]
ds_read_b128 a[144:147], v5 offset:1024
v_mfma_f32_16x16x32_bf16 v[192:195], a[104:107], a[48:51], v[192:195]
v_mfma_f32_16x16x32_bf16 v[168:171], a[104:107], a[40:43], v[168:171]
v_mfma_f32_16x16x32_bf16 v[168:171], a[108:111], a[44:47], v[168:171]
buffer_load_dwordx4 a[8:11], v2, s[40:43], s35 offen offset:1024 sc1
v_mfma_f32_16x16x32_bf16 v[144:147], a[108:111], a[36:39], v[144:147]
ds_read_b128 a[148:151], v5 offset:7168
v_mfma_f32_16x16x32_bf16 v[144:147], a[104:107], a[32:35], v[144:147]
v_mfma_f32_16x16x32_bf16 v[148:151], a[112:115], a[32:35], v[148:151]
v_mfma_f32_16x16x32_bf16 v[148:151], a[116:119], a[36:39], v[148:151]
buffer_load_dwordx4 v1, s[4:7], s44 offen offset:0 sc1 lds
v_mfma_f32_16x16x32_bf16 v[172:175], a[116:119], a[44:47], v[172:175]
ds_write_b128 v231, a[196:199] offset:8192
v_mfma_f32_16x16x32_bf16 v[172:175], a[112:115], a[40:43], v[172:175]
v_mfma_f32_16x16x32_bf16 v[196:199], a[112:115], a[48:51], v[196:199]
v_mfma_f32_16x16x32_bf16 v[196:199], a[116:119], a[52:55], v[196:199]
L_stub0:
s_cbranch_execz L_wret0
buffer_load_dwordx4 a[12:15], v2, s[40:43], s33 offen offset:1024 sc1
v_mfma_f32_16x16x32_bf16 v[220:223], a[116:119], a[60:63], v[220:223]
v_mfma_f32_16x16x32_bf16 v[220:223], a[112:115], a[56:59], v[220:223]
s_waitcnt lgkmcnt(1)
v_mfma_f32_16x16x32_bf16 v[224:227], a[128:131], a[56:59], v[224:227]
ds_read_b128 a[96:99], v5 offset:14336
v_mfma_f32_16x16x32_bf16 v[224:227], a[132:135], a[60:63], v[224:227]
buffer_load_dwordx4 a[16:19], v2, s[40:43], s35 offen offset:2048 sc1
v_mfma_f32_16x16x32_bf16 v[200:203], a[132:135], a[52:55], v[200:203]
ds_read_b128 a[100:103], v5 offset:20480
v_mfma_f32_16x16x32_bf16 v[200:203], a[128:131], a[48:51], v[200:203]
v_mfma_f32_16x16x32_bf16 v[176:179], a[128:131], a[40:43], v[176:179]
v_mfma_f32_16x16x32_bf16 v[176:179], a[132:135], a[44:47], v[176:179]
buffer_load_dwordx4 v1, s[4:7], s44 offen offset:1024 sc1 lds
s_add_u32 s88, s82, 0x1700000
v_mfma_f32_16x16x32_bf16 v[152:155], a[132:135], a[36:39], v[152:155]
ds_read_b128 a[104:107], v5 offset:15360
v_mfma_f32_16x16x32_bf16 v[152:155], a[128:131], a[32:35], v[152:155]
ds_write_b128 v231, a[200:203] offset:9216
v_mfma_f32_16x16x32_bf16 v[132:135], a[136:139], a[32:35], v[132:135]
ds_read_b128 a[108:111], v5 offset:21504
v_mfma_f32_16x16x32_bf16 v[132:135], a[140:143], a[36:39], v[132:135]
buffer_load_dwordx4 a[20:23], v2, s[40:43], s33 offen offset:2048 sc1
v_mfma_f32_16x16x32_bf16 v[156:159], a[140:143], a[44:47], v[156:159]
ds_read_b128 a[112:115], v5 offset:16384
v_mfma_f32_16x16x32_bf16 v[156:159], a[136:139], a[40:43], v[156:159]
v_mfma_f32_16x16x32_bf16 v[180:183], a[136:139], a[48:51], v[180:183]
v_mfma_f32_16x16x32_bf16 v[180:183], a[140:143], a[52:55], v[180:183]
buffer_load_dwordx4 a[24:27], v2, s[40:43], s35 offen offset:3072 sc1
v_mfma_f32_16x16x32_bf16 v[204:207], a[140:143], a[60:63], v[204:207]
ds_read_b128 a[116:119], v5 offset:22528
v_mfma_f32_16x16x32_bf16 v[204:207], a[136:139], a[56:59], v[204:207]
ds_write_b128 v231, a[204:207] offset:16384
v_mfma_f32_16x16x32_bf16 v[208:211], a[144:147], a[56:59], v[208:211]
v_mfma_f32_16x16x32_bf16 v[208:211], a[148:151], a[60:63], v[208:211]
buffer_load_dwordx4 v[92:95], v1, s[4:7], s88 offen offset:0 sc1
v_mfma_f32_16x16x32_bf16 v[184:187], a[148:151], a[52:55], v[184:187]
v_mfma_f32_16x16x32_bf16 v[184:187], a[144:147], a[48:51], v[184:187]
v_mfma_f32_16x16x32_bf16 v[160:163], a[144:147], a[40:43], v[160:163]
v_mfma_f32_16x16x32_bf16 v[160:163], a[148:151], a[44:47], v[160:163]
buffer_load_dwordx4 a[28:31], v2, s[40:43], s33 offen offset:3072 sc1
s_add_u32 s35, s35, 0x2000
v_mfma_f32_16x16x32_bf16 v[136:139], a[148:151], a[36:39], v[136:139]
s_add_u32 s33, s33, 0x2000
v_mfma_f32_16x16x32_bf16 v[136:139], a[144:147], a[32:35], v[136:139]
s_waitcnt vmcnt(12) lgkmcnt(1)
v_mfma_f32_16x16x32_bf16 v[140:143], a[96:99], a[64:67], v[140:143]
ds_read_b128 a[128:131], v5 offset:17408
v_mfma_f32_16x16x32_bf16 v[140:143], a[100:103], a[68:71], v[140:143]
buffer_load_dwordx4 a[32:35], v2, s[40:43], s35 offen offset:0 sc1
v_mfma_f32_16x16x32_bf16 v[164:167], a[100:103], a[76:79], v[164:167]
ds_read_b128 a[132:135], v5 offset:23552
v_mfma_f32_16x16x32_bf16 v[164:167], a[96:99], a[72:75], v[164:167]
ds_write_b128 v231, a[208:211] offset:17408
v_mfma_f32_16x16x32_bf16 v[188:191], a[96:99], a[80:83], v[188:191]
v_mfma_f32_16x16x32_bf16 v[188:191], a[100:103], a[84:87], v[188:191]
buffer_load_dwordx4 v[96:99], v1, s[4:7], s88 offen offset:1024 sc1
v_mfma_f32_16x16x32_bf16 v[212:215], a[100:103], a[92:95], v[212:215]
ds_read_b128 a[136:139], v5 offset:12288
v_mfma_f32_16x16x32_bf16 v[212:215], a[96:99], a[88:91], v[212:215]
v_mfma_f32_16x16x32_bf16 v[216:219], a[104:107], a[88:91], v[216:219]
ds_read_b128 a[140:143], v5 offset:18432
v_mfma_f32_16x16x32_bf16 v[216:219], a[108:111], a[92:95], v[216:219]
buffer_load_dwordx4 a[36:39], v2, s[40:43], s33 offen offset:0 sc1
v_mfma_f32_16x16x32_bf16 v[192:195], a[108:111], a[84:87], v[192:195]
ds_read_b128 a[144:147], v5 offset:13312
v_mfma_f32_16x16x32_bf16 v[192:195], a[104:107], a[80:83], v[192:195]
v_mfma_f32_16x16x32_bf16 v[168:171], a[104:107], a[72:75], v[168:171]
v_mfma_f32_16x16x32_bf16 v[168:171], a[108:111], a[76:79], v[168:171]
buffer_load_dwordx4 a[40:43], v2, s[40:43], s35 offen offset:1024 sc1
v_mfma_f32_16x16x32_bf16 v[144:147], a[108:111], a[68:71], v[144:147]
ds_read_b128 a[148:151], v5 offset:19456
v_mfma_f32_16x16x32_bf16 v[144:147], a[104:107], a[64:67], v[144:147]
v_mfma_f32_16x16x32_bf16 v[148:151], a[112:115], a[64:67], v[148:151]
v_mfma_f32_16x16x32_bf16 v[148:151], a[116:119], a[68:71], v[148:151]
buffer_load_dwordx4 v[100:103], v1, s[4:7], s88 offen offset:2048 sc1
v_mfma_f32_16x16x32_bf16 v[172:175], a[116:119], a[76:79], v[172:175]
v_mfma_f32_16x16x32_bf16 v[172:175], a[112:115], a[72:75], v[172:175]
v_mfma_f32_16x16x32_bf16 v[196:199], a[112:115], a[80:83], v[196:199]
v_mfma_f32_16x16x32_bf16 v[196:199], a[116:119], a[84:87], v[196:199]
buffer_load_dwordx4 a[44:47], v2, s[40:43], s33 offen offset:1024 sc1
v_mfma_f32_16x16x32_bf16 v[220:223], a[116:119], a[92:95], v[220:223]
v_mfma_f32_16x16x32_bf16 v[220:223], a[112:115], a[88:91], v[220:223]
s_waitcnt lgkmcnt(0)
s_barrier
v_mfma_f32_16x16x32_bf16 v[224:227], a[128:131], a[88:91], v[224:227]
ds_read_b128 a[96:99], v5 offset:26624
v_mfma_f32_16x16x32_bf16 v[224:227], a[132:135], a[92:95], v[224:227]
buffer_load_dwordx4 a[48:51], v2, s[40:43], s35 offen offset:2048 sc1
v_mfma_f32_16x16x32_bf16 v[200:203], a[132:135], a[84:87], v[200:203]
ds_read_b128 a[100:103], v5 offset:32768
v_mfma_f32_16x16x32_bf16 v[200:203], a[128:131], a[80:83], v[200:203]
ds_read_b64_tr_b16 a[220:221], v230 offset:0
v_mfma_f32_16x16x32_bf16 v[176:179], a[128:131], a[72:75], v[176:179]
v_mfma_f32_16x16x32_bf16 v[176:179], a[132:135], a[76:79], v[176:179]
buffer_load_dwordx4 v[104:107], v1, s[4:7], s88 offen offset:3072 sc1
s_add_u32 s88, s88, 4096
v_mfma_f32_16x16x32_bf16 v[152:155], a[132:135], a[68:71], v[152:155]
ds_read_b128 a[104:107], v5 offset:27648
v_mfma_f32_16x16x32_bf16 v[152:155], a[128:131], a[64:67], v[152:155]
ds_read_b64_tr_b16 a[222:223], v230 offset:2048
v_mfma_f32_16x16x32_bf16 v[132:135], a[136:139], a[64:67], v[132:135]
ds_read_b128 a[108:111], v5 offset:33792
v_mfma_f32_16x16x32_bf16 v[132:135], a[140:143], a[68:71], v[132:135]
buffer_load_dwordx4 a[52:55], v2, s[40:43], s33 offen offset:2048 sc1
v_mfma_f32_16x16x32_bf16 v[156:159], a[140:143], a[76:79], v[156:159]
ds_read_b128 a[112:115], v5 offset:28672
v_mfma_f32_16x16x32_bf16 v[156:159], a[136:139], a[72:75], v[156:159]
ds_read_b64_tr_b16 a[224:225], v230 offset:8
v_mfma_f32_16x16x32_bf16 v[180:183], a[136:139], a[80:83], v[180:183]
v_mfma_f32_16x16x32_bf16 v[180:183], a[140:143], a[84:87], v[180:183]
buffer_load_dwordx4 a[56:59], v2, s[40:43], s35 offen offset:3072 sc1
v_mfma_f32_16x16x32_bf16 v[204:207], a[140:143], a[92:95], v[204:207]
ds_read_b128 a[116:119], v5 offset:34816
v_mfma_f32_16x16x32_bf16 v[204:207], a[136:139], a[88:91], v[204:207]
v_mfma_f32_16x16x32_bf16 v[208:211], a[144:147], a[88:91], v[208:211]
ds_read_b64_tr_b16 a[226:227], v230 offset:2056
v_mfma_f32_16x16x32_bf16 v[208:211], a[148:151], a[92:95], v[208:211]
buffer_load_dwordx4 v[108:111], v1, s[4:7], s88 offen offset:0 sc1
v_mfma_f32_16x16x32_bf16 v[184:187], a[148:151], a[84:87], v[184:187]
v_mfma_f32_16x16x32_bf16 v[184:187], a[144:147], a[80:83], v[184:187]
v_mfma_f32_16x16x32_bf16 v[160:163], a[144:147], a[72:75], v[160:163]
v_mfma_f32_16x16x32_bf16 v[160:163], a[148:151], a[76:79], v[160:163]
buffer_load_dwordx4 a[60:63], v2, s[40:43], s33 offen offset:3072 sc1
s_add_u32 s35, s35, 0x2000
v_mfma_f32_16x16x32_bf16 v[136:139], a[148:151], a[68:71], v[136:139]
s_add_u32 s33, s33, 0x2000
ds_read_b64_tr_b16 a[188:189], v248 offset:0
v_mfma_f32_16x16x32_bf16 v[136:139], a[144:147], a[64:67], v[136:139]
s_waitcnt vmcnt(12) lgkmcnt(2)
v_mfma_f32_16x16x32_bf16 v[140:143], a[96:99], a[0:3], v[140:143]
ds_read_b128 a[128:131], v5 offset:29696
v_add_f32_dpp v48, v48, v48 row_ror:8 row_mask:0xf bank_mask:0xf
v_mfma_f32_16x16x32_bf16 v[140:143], a[100:103], a[4:7], v[140:143]
buffer_load_dwordx4 a[64:67], v2, s[40:43], s35 offen offset:0 sc1
v_mfma_f32_16x16x32_bf16 v[164:167], a[100:103], a[12:15], v[164:167]
ds_read_b128 a[132:135], v5 offset:35840
v_add_f32_dpp v49, v49, v49 row_ror:8 row_mask:0xf bank_mask:0xf
v_mfma_f32_16x16x32_bf16 v[164:167], a[96:99], a[8:11], v[164:167]
ds_read_b64_tr_b16 a[190:191], v248 offset:512
v_add_f32_dpp v50, v50, v50 row_ror:8 row_mask:0xf bank_mask:0xf
v_mfma_f32_16x16x32_bf16 v[188:191], a[96:99], a[16:19], v[188:191]
v_add_f32_dpp v51, v51, v51 row_ror:8 row_mask:0xf bank_mask:0xf
v_add_f32_dpp v52, v52, v52 row_ror:8 row_mask:0xf bank_mask:0xf
v_mfma_f32_16x16x32_bf16 v[188:191], a[100:103], a[20:23], v[188:191]
buffer_load_dwordx4 v[112:115], v1, s[4:7], s88 offen offset:1024 sc1
v_mfma_f32_16x16x32_bf16 v[212:215], a[100:103], a[28:31], v[212:215]
ds_read_b128 a[136:139], v5 offset:24576
v_add_f32_dpp v53, v53, v53 row_ror:8 row_mask:0xf bank_mask:0xf
v_mfma_f32_16x16x32_bf16 v[212:215], a[96:99], a[24:27], v[212:215]
v_add_f32_dpp v54, v54, v54 row_ror:8 row_mask:0xf bank_mask:0xf
v_add_f32_dpp v55, v55, v55 row_ror:8 row_mask:0xf bank_mask:0xf
v_mfma_f32_16x16x32_bf16 v[216:219], a[104:107], a[24:27], v[216:219]
ds_read_b128 a[140:143], v5 offset:30720
v_add_f32_dpp v48, v48, v48 row_ror:4 row_mask:0xf bank_mask:0xf
v_mfma_f32_16x16x32_bf16 v[216:219], a[108:111], a[28:31], v[216:219]
buffer_load_dwordx4 a[68:71], v2, s[40:43], s33 offen offset:0 sc1
v_mfma_f32_16x16x32_bf16 v[192:195], a[108:111], a[20:23], v[192:195]
ds_read_b128 a[144:147], v5 offset:25600
v_add_f32_dpp v49, v49, v49 row_ror:4 row_mask:0xf bank_mask:0xf
v_mfma_f32_16x16x32_bf16 v[192:195], a[104:107], a[16:19], v[192:195]
ds_read_b64_tr_b16 a[192:193], v248 offset:4096
v_add_f32_dpp v50, v50, v50 row_ror:4 row_mask:0xf bank_mask:0xf
v_mfma_f32_16x16x32_bf16 v[168:171], a[104:107], a[8:11], v[168:171]
v_add_f32_dpp v51, v51, v51 row_ror:4 row_mask:0xf bank_mask:0xf
v_add_f32_dpp v52, v52, v52 row_ror:4 row_mask:0xf bank_mask:0xf
v_mfma_f32_16x16x32_bf16 v[168:171], a[108:111], a[12:15], v[168:171]
buffer_load_dwordx4 a[72:75], v2, s[40:43], s35 offen offset:1024 sc1
v_mfma_f32_16x16x32_bf16 v[144:147], a[108:111], a[4:7], v[144:147]
ds_read_b128 a[148:151], v5 offset:31744
v_add_f32_dpp v53, v53, v53 row_ror:4 row_mask:0xf bank_mask:0xf
v_mfma_f32_16x16x32_bf16 v[144:147], a[104:107], a[0:3], v[144:147]
ds_read_b64_tr_b16 a[194:195], v248 offset:4608
v_add_f32_dpp v54, v54, v54 row_ror:4 row_mask:0xf bank_mask:0xf
v_mfma_f32_16x16x32_bf16 v[148:151], a[112:115], a[0:3], v[148:151]
v_add_f32_dpp v55, v55, v55 row_ror:4 row_mask:0xf bank_mask:0xf
v_add_f32_dpp v48, v48, v48 row_ror:2 row_mask:0xf bank_mask:0xf
v_mfma_f32_16x16x32_bf16 v[148:151], a[116:119], a[4:7], v[148:151]
buffer_load_dwordx4 v[116:119], v1, s[4:7], s88 offen offset:2048 sc1
v_mfma_f32_16x16x32_bf16 v[172:175], a[116:119], a[12:15], v[172:175]
v_add_f32_dpp v49, v49, v49 row_ror:2 row_mask:0xf bank_mask:0xf
v_add_f32_dpp v50, v50, v50 row_ror:2 row_mask:0xf bank_mask:0xf
v_mfma_f32_16x16x32_bf16 v[172:175], a[112:115], a[8:11], v[172:175]
v_add_f32_dpp v51, v51, v51 row_ror:2 row_mask:0xf bank_mask:0xf
v_add_f32_dpp v52, v52, v52 row_ror:2 row_mask:0xf bank_mask:0xf
v_mfma_f32_16x16x32_bf16 v[196:199], a[112:115], a[16:19], v[196:199]
ds_read_b64_tr_b16 a[196:197], v249 offset:32
v_add_f32_dpp v53, v53, v53 row_ror:2 row_mask:0xf bank_mask:0xf
v_mfma_f32_16x16x32_bf16 v[196:199], a[116:119], a[20:23], v[196:199]
buffer_load_dwordx4 a[76:79], v2, s[40:43], s33 offen offset:1024 sc1
v_mfma_f32_16x16x32_bf16 v[220:223], a[116:119], a[28:31], v[220:223]
v_add_f32_dpp v54, v54, v54 row_ror:2 row_mask:0xf bank_mask:0xf
v_add_f32_dpp v55, v55, v55 row_ror:2 row_mask:0xf bank_mask:0xf
v_mfma_f32_16x16x32_bf16 v[220:223], a[112:115], a[24:27], v[220:223]
v_add_f32_dpp v48, v48, v48 row_ror:1 row_mask:0xf bank_mask:0xf
s_waitcnt lgkmcnt(2)
v_mfma_f32_16x16x32_bf16 v[224:227], a[128:131], a[24:27], v[224:227]
ds_read_b128 a[96:99], v5 offset:38912
v_add_f32_dpp v49, v49, v49 row_ror:1 row_mask:0xf bank_mask:0xf
v_mfma_f32_16x16x32_bf16 v[224:227], a[132:135], a[28:31], v[224:227]
buffer_load_dwordx4 a[80:83], v2, s[40:43], s35 offen offset:2048 sc1
v_mfma_f32_16x16x32_bf16 v[200:203], a[132:135], a[20:23], v[200:203]
ds_read_b128 a[100:103], v5 offset:45056
v_add_f32_dpp v50, v50, v50 row_ror:1 row_mask:0xf bank_mask:0xf
v_mfma_f32_16x16x32_bf16 v[200:203], a[128:131], a[16:19], v[200:203]
ds_read_b64_tr_b16 a[198:199], v249 offset:544
v_add_f32_dpp v51, v51, v51 row_ror:1 row_mask:0xf bank_mask:0xf
v_mfma_f32_16x16x32_bf16 v[176:179], a[128:131], a[8:11], v[176:179]
buffer_load_dwordx4 v[120:123], v1, s[4:7], s88 offen offset:3072 sc1
s_add_u32 m0, s18, 0x1e000
v_mfma_f32_16x16x32_bf16 v[176:179], a[132:135], a[12:15], v[176:179]
s_add_u32 s44, s50, 0x201e000
ds_read_b128 a[104:107], v5 offset:39936
v_mfma_f32_16x16x32_bf16 v[152:155], a[132:135], a[4:7], v[152:155]
v_add_f32_dpp v52, v52, v52 row_ror:1 row_mask:0xf bank_mask:0xf
v_add_f32_dpp v53, v53, v53 row_ror:1 row_mask:0xf bank_mask:0xf
v_mfma_f32_16x16x32_bf16 v[152:155], a[128:131], a[0:3], v[152:155]
buffer_load_dwordx4 a[84:87], v2, s[40:43], s33 offen offset:2048 sc1
v_mfma_f32_16x16x32_bf16 v[132:135], a[136:139], a[0:3], v[132:135]
ds_read_b128 a[108:111], v5 offset:46080
v_add_f32_dpp v54, v54, v54 row_ror:1 row_mask:0xf bank_mask:0xf
v_mfma_f32_16x16x32_bf16 v[132:135], a[140:143], a[4:7], v[132:135]
ds_read_b64_tr_b16 a[200:201], v249 offset:4128
v_add_f32_dpp v55, v55, v55 row_ror:1 row_mask:0xf bank_mask:0xf
v_mfma_f32_16x16x32_bf16 v[156:159], a[140:143], a[12:15], v[156:159]
ds_read_b128 a[112:115], v5 offset:40960
v_add_u32 v233, 159744, v233
v_mfma_f32_16x16x32_bf16 v[156:159], a[136:139], a[8:11], v[156:159]
buffer_load_dwordx4 v1, s[4:7], s44 offen offset:0 sc1 lds
s_lshl_b32 s36, s28, 6
v_mfma_f32_16x16x32_bf16 v[180:183], a[136:139], a[16:19], v[180:183]
ds_read_b64_tr_b16 a[202:203], v249 offset:4640
s_lshl_b32 s37, s39, 6
v_mfma_f32_16x16x32_bf16 v[180:183], a[140:143], a[20:23], v[180:183]
ds_read_b128 a[116:119], v5 offset:47104
v_add_u32 v232, s36, v233
v_mfma_f32_16x16x32_bf16 v[204:207], a[140:143], a[28:31], v[204:207]
buffer_load_dwordx4 a[88:91], v2, s[40:43], s35 offen offset:3072 sc1
v_mfma_f32_16x16x32_bf16 v[204:207], a[136:139], a[24:27], v[204:207]
v_add_u32 v235, s37, v233
v_mfma_f32_16x16x32_bf16 v[208:211], a[144:147], a[24:27], v[208:211]
v_mfma_f32_16x16x32_bf16 v[208:211], a[148:151], a[28:31], v[208:211]
v_mfma_f32_16x16x32_bf16 v[184:187], a[148:151], a[20:23], v[184:187]
buffer_load_dwordx4 v1, s[4:7], s44 offen offset:1024 sc1 lds
s_add_u32 m0, s18, 0x20000
v_mfma_f32_16x16x32_bf16 v[184:187], a[144:147], a[16:19], v[184:187]
s_add_u32 s44, s50, 0x2020000
ds_read_b64_tr_b16 a[204:205], v248 offset:8192
v_mfma_f32_16x16x32_bf16 v[160:163], a[144:147], a[8:11], v[160:163]
v_mfma_f32_16x16x32_bf16 v[160:163], a[148:151], a[12:15], v[160:163]
buffer_load_dwordx4 a[92:95], v2, s[40:43], s33 offen offset:3072 sc1
s_add_u32 s35, s35, 0x2000
v_mfma_f32_16x16x32_bf16 v[136:139], a[148:151], a[4:7], v[136:139]
s_add_u32 s33, s33, 0x2000
v_mfma_f32_16x16x32_bf16 v[136:139], a[144:147], a[0:3], v[136:139]
ds_read_b64_tr_b16 a[206:207], v248 offset:8704
s_waitcnt vmcnt(13) lgkmcnt(2)
v_mfma_f32_16x16x32_bf16 v[140:143], a[96:99], a[32:35], v[140:143]
ds_read_b128 a[128:131], v5 offset:41984
v_mfma_f32_16x16x32_bf16 v[140:143], a[100:103], a[36:39], v[140:143]
buffer_load_dwordx4 a[0:3], v2, s[40:43], s35 offen offset:0 sc1
v_mfma_f32_16x16x32_bf16 v[164:167], a[100:103], a[44:47], v[164:167]
ds_read_b128 a[132:135], v5 offset:48128
v_mfma_f32_16x16x32_bf16 v[164:167], a[96:99], a[40:43], v[164:167]
ds_write_b128 v232, v[48:51]
v_mfma_f32_16x16x32_bf16 v[188:191], a[96:99], a[48:51], v[188:191]
ds_write_b128 v235, v[52:55]
v_mfma_f32_16x16x32_bf16 v[188:191], a[100:103], a[52:55], v[188:191]
buffer_load_dwordx4 v1, s[4:7], s44 offen offset:0 sc1 lds
v_mfma_f32_16x16x32_bf16 v[212:215], a[100:103], a[60:63], v[212:215]
ds_read_b128 a[136:139], v5 offset:36864
v_mfma_f32_16x16x32_bf16 v[212:215], a[96:99], a[56:59], v[212:215]
ds_read_b64_tr_b16 a[208:209], v248 offset:12288
v_mfma_f32_16x16x32_bf16 v[216:219], a[104:107], a[56:59], v[216:219]
ds_read_b128 a[140:143], v5 offset:43008
v_mfma_f32_16x16x32_bf16 v[216:219], a[108:111], a[60:63], v[216:219]
buffer_load_dwordx4 a[4:7], v2, s[40:43], s33 offen offset:0 sc1
v_mfma_f32_16x16x32_bf16 v[192:195], a[108:111], a[52:55], v[192:195]
ds_read_b128 a[144:147], v5 offset:37888
v_mfma_f32_16x16x32_bf16 v[192:195], a[104:107], a[48:51], v[192:195]
ds_read_b64_tr_b16 a[210:211], v248 offset:12800
v_mfma_f32_16x16x32_bf16 v[168:171], a[104:107], a[40:43], v[168:171]
v_mfma_f32_16x16x32_bf16 v[168:171], a[108:111], a[44:47], v[168:171]
ds_read_b128 a[148:151], v5 offset:44032
v_mfma_f32_16x16x32_bf16 v[144:147], a[108:111], a[36:39], v[144:147]
buffer_load_dwordx4 a[8:11], v2, s[40:43], s35 offen offset:1024 sc1
v_mfma_f32_16x16x32_bf16 v[144:147], a[104:107], a[32:35], v[144:147]
v_mfma_f32_16x16x32_bf16 v[148:151], a[112:115], a[32:35], v[148:151]
v_mfma_f32_16x16x32_bf16 v[148:151], a[116:119], a[36:39], v[148:151]
v_mfma_f32_16x16x32_bf16 v[172:175], a[116:119], a[44:47], v[172:175]
buffer_load_dword v11, v1, s[24:27], 0 offen sc1
v_mfma_f32_16x16x32_bf16 v[172:175], a[112:115], a[40:43], v[172:175]
v_mfma_f32_16x16x32_bf16 v[196:199], a[112:115], a[48:51], v[196:199]
buffer_load_dwordx4 a[12:15], v2, s[40:43], s33 offen offset:1024 sc1
v_mfma_f32_16x16x32_bf16 v[196:199], a[116:119], a[52:55], v[196:199]
v_mfma_f32_16x16x32_bf16 v[220:223], a[116:119], a[60:63], v[220:223]
v_mfma_f32_16x16x32_bf16 v[220:223], a[112:115], a[56:59], v[220:223]
s_waitcnt lgkmcnt(0)
s_barrier
v_mfma_f32_16x16x32_bf16 v[224:227], a[128:131], a[56:59], v[224:227]
v_add_u32 v5, 98304, v1
v_mfma_f32_16x16x32_bf16 v[224:227], a[132:135], a[60:63], v[224:227]
buffer_load_dwordx4 a[16:19], v2, s[40:43], s35 offen offset:2048 sc1
v_mfma_f32_16x16x32_bf16 v[200:203], a[132:135], a[52:55], v[200:203]
ds_read_b128 a[96:99], v5 offset:2048
v_mfma_f32_16x16x32_bf16 v[200:203], a[128:131], a[48:51], v[200:203]
ds_read_b128 a[100:103], v5 offset:8192
v_mfma_f32_16x16x32_bf16 v[176:179], a[128:131], a[40:43], v[176:179]
ds_read_b128 v[48:51], v233 offset:0
v_mfma_f32_16x16x32_bf16 v[176:179], a[132:135], a[44:47], v[176:179]
buffer_load_dwordx4 v1, s[4:7], s44 offen offset:1024 sc1 lds
s_add_u32 m0, s18, 0x22000
v_mfma_f32_16x16x32_bf16 v[152:155], a[132:135], a[36:39], v[152:155]
s_add_u32 s44, s50, 0x2022000
ds_read_b128 a[104:107], v5 offset:3072
v_mfma_f32_16x16x32_bf16 v[152:155], a[128:131], a[32:35], v[152:155]
v_mfma_f32_16x16x32_bf16 v[132:135], a[136:139], a[32:35], v[132:135]
ds_read_b128 a[108:111], v5 offset:9216
v_mfma_f32_16x16x32_bf16 v[132:135], a[140:143], a[36:39], v[132:135]
buffer_load_dwordx4 a[20:23], v2, s[40:43], s33 offen offset:2048 sc1
v_mfma_f32_16x16x32_bf16 v[156:159], a[140:143], a[44:47], v[156:159]
ds_read_b128 a[112:115], v5 offset:4096
v_mfma_f32_16x16x32_bf16 v[156:159], a[136:139], a[40:43], v[156:159]
ds_read_b128 v[52:55], v233 offset:64
v_mfma_f32_16x16x32_bf16 v[180:183], a[136:139], a[48:51], v[180:183]
v_mfma_f32_16x16x32_bf16 v[180:183], a[140:143], a[52:55], v[180:183]
buffer_load_dwordx4 a[24:27], v2, s[40:43], s35 offen offset:3072 sc1
v_mfma_f32_16x16x32_bf16 v[204:207], a[140:143], a[60:63], v[204:207]
ds_read_b128 a[116:119], v5 offset:10240
v_mfma_f32_16x16x32_bf16 v[204:207], a[136:139], a[56:59], v[204:207]
v_mfma_f32_16x16x32_bf16 v[208:211], a[144:147], a[56:59], v[208:211]
v_mfma_f32_16x16x32_bf16 v[208:211], a[148:151], a[60:63], v[208:211]
buffer_load_dwordx4 v1, s[4:7], s44 offen offset:0 sc1 lds
v_mfma_f32_16x16x32_bf16 v[184:187], a[148:151], a[52:55], v[184:187]
v_mfma_f32_16x16x32_bf16 v[184:187], a[144:147], a[48:51], v[184:187]
v_mfma_f32_16x16x32_bf16 v[160:163], a[144:147], a[40:43], v[160:163]
v_mfma_f32_16x16x32_bf16 v[160:163], a[148:151], a[44:47], v[160:163]
buffer_load_dwordx4 a[28:31], v2, s[40:43], s33 offen offset:3072 sc1
s_add_u32 s35, s35, 0x2000
v_mfma_f32_16x16x32_bf16 v[136:139], a[148:151], a[36:39], v[136:139]
s_add_u32 s33, s33, 0x2000
ds_read_b128 v[56:59], v233 offset:128
v_mfma_f32_16x16x32_bf16 v[136:139], a[144:147], a[32:35], v[136:139]
s_waitcnt vmcnt(12) lgkmcnt(1)
v_mfma_f32_16x16x32_bf16 v[140:143], a[96:99], a[64:67], v[140:143]
ds_read_b128 a[128:131], v5 offset:5120
v_mfma_f32_16x16x32_bf16 v[140:143], a[100:103], a[68:71], v[140:143]
buffer_load_dwordx4 a[32:35], v2, s[40:43], s35 offen offset:0 sc1
v_mfma_f32_16x16x32_bf16 v[164:167], a[100:103], a[76:79], v[164:167]
ds_read_b128 a[132:135], v5 offset:11264
v_mfma_f32_16x16x32_bf16 v[164:167], a[96:99], a[72:75], v[164:167]
v_mfma_f32_16x16x32_bf16 v[236:239], a[188:191], v[16:19], 0
v_mfma_f32_16x16x32_bf16 v[188:191], a[96:99], a[80:83], v[188:191]
v_mfma_f32_16x16x32_bf16 v[240:243], a[196:199], v[16:19], 0
v_mfma_f32_16x16x32_bf16 v[188:191], a[100:103], a[84:87], v[188:191]
buffer_load_dwordx4 v1, s[4:7], s44 offen offset:1024 sc1 lds
s_add_u32 m0, s18, 0x0
v_mfma_f32_16x16x32_bf16 v[212:215], a[100:103], a[92:95], v[212:215]
s_add_u32 s44, s50, 0x2024000
ds_read_b128 a[136:139], v5 offset:0
v_mfma_f32_16x16x32_bf16 v[212:215], a[96:99], a[88:91], v[212:215]
v_mfma_f32_16x16x32_bf16 v[216:219], a[104:107], a[88:91], v[216:219]
ds_read_b128 a[140:143], v5 offset:6144
v_mfma_f32_16x16x32_bf16 v[216:219], a[108:111], a[92:95], v[216:219]
buffer_load_dwordx4 a[36:39], v2, s[40:43], s33 offen offset:0 sc1
v_mfma_f32_16x16x32_bf16 v[192:195], a[108:111], a[84:87], v[192:195]
ds_read_b128 a[144:147], v5 offset:1024
v_mfma_f32_16x16x32_bf16 v[192:195], a[104:107], a[80:83], v[192:195]
v_mfma_f32_16x16x32_bf16 v[244:247], a[204:207], v[16:19], 0
v_mfma_f32_16x16x32_bf16 v[168:171], a[104:107], a[72:75], v[168:171]
v_mfma_f32_16x16x32_bf16 v[236:239], a[192:195], v[16:19], v[236:239]
v_mfma_f32_16x16x32_bf16 v[168:171], a[108:111], a[76:79], v[168:171]
buffer_load_dwordx4 a[40:43], v2, s[40:43], s35 offen offset:1024 sc1
v_mfma_f32_16x16x32_bf16 v[144:147], a[108:111], a[68:71], v[144:147]
ds_read_b128 a[148:151], v5 offset:7168
v_mfma_f32_16x16x32_bf16 v[144:147], a[104:107], a[64:67], v[144:147]
ds_read_b128 v[60:63], v233 offset:192
v_mfma_f32_16x16x32_bf16 v[148:151], a[112:115], a[64:67], v[148:151]
v_mfma_f32_16x16x32_bf16 v[240:243], a[200:203], v[16:19], v[240:243]
v_mfma_f32_16x16x32_bf16 v[148:151], a[116:119], a[68:71], v[148:151]
buffer_load_dwordx4 v1, s[4:7], s44 offen offset:0 sc1 lds
v_mfma_f32_16x16x32_bf16 v[172:175], a[116:119], a[76:79], v[172:175]
ds_read_b128 v[64:67], v233 offset:256
v_mfma_f32_16x16x32_bf16 v[172:175], a[112:115], a[72:75], v[172:175]
v_mfma_f32_16x16x32_bf16 v[196:199], a[112:115], a[80:83], v[196:199]
v_mfma_f32_16x16x32_bf16 v[244:247], a[208:211], v[16:19], v[244:247]
v_mfma_f32_16x16x32_bf16 v[196:199], a[116:119], a[84:87], v[196:199]
buffer_load_dwordx4 a[44:47], v2, s[40:43], s33 offen offset:1024 sc1
v_mfma_f32_16x16x32_bf16 v[220:223], a[116:119], a[92:95], v[220:223]
v_mfma_f32_16x16x32_bf16 v[220:223], a[112:115], a[88:91], v[220:223]
s_waitcnt lgkmcnt(2)
v_mfma_f32_16x16x32_bf16 v[224:227], a[128:131], a[88:91], v[224:227]
ds_read_b128 a[96:99], v5 offset:14336
v_mfma_f32_16x16x32_bf16 v[224:227], a[132:135], a[92:95], v[224:227]
buffer_load_dwordx4 a[48:51], v2, s[40:43], s35 offen offset:2048 sc1
v_mfma_f32_16x16x32_bf16 v[200:203], a[132:135], a[84:87], v[200:203]
ds_read_b128 a[100:103], v5 offset:20480
v_mfma_f32_16x16x32_bf16 v[200:203], a[128:131], a[80:83], v[200:203]
v_mfma_f32_16x16x32_bf16 v[176:179], a[128:131], a[72:75], v[176:179]
buffer_load_dwordx4 v1, s[4:7], s44 offen offset:1024 sc1 lds
s_add_u32 m0, s18, 0x2000
v_mfma_f32_16x16x32_bf16 v[176:179], a[132:135], a[76:79], v[176:179]
s_add_u32 s44, s50, 0x2026000
ds_read_b128 a[104:107], v5 offset:15360
v_mfma_f32_16x16x32_bf16 v[152:155], a[132:135], a[68:71], v[152:155]
ds_read_b128 v[68:71], v233 offset:320
v_mfma_f32_16x16x32_bf16 v[152:155], a[128:131], a[64:67], v[152:155]
buffer_load_dwordx4 a[52:55], v2, s[40:43], s33 offen offset:2048 sc1
v_mfma_f32_16x16x32_bf16 v[132:135], a[136:139], a[64:67], v[132:135]
ds_read_b128 a[108:111], v5 offset:21504
v_mfma_f32_16x16x32_bf16 v[132:135], a[140:143], a[68:71], v[132:135]
v_mfma_f32_16x16x32_bf16 v[156:159], a[140:143], a[76:79], v[156:159]
ds_read_b128 a[112:115], v5 offset:16384
v_mfma_f32_16x16x32_bf16 v[156:159], a[136:139], a[72:75], v[156:159]
buffer_load_dwordx4 v1, s[4:7], s44 offen offset:0 sc1 lds
v_mfma_f32_16x16x32_bf16 v[180:183], a[136:139], a[80:83], v[180:183]
v_mfma_f32_16x16x32_bf16 v[180:183], a[140:143], a[84:87], v[180:183]
ds_read_b128 a[116:119], v5 offset:22528
v_mfma_f32_16x16x32_bf16 v[204:207], a[140:143], a[92:95], v[204:207]
buffer_load_dwordx4 a[56:59], v2, s[40:43], s35 offen offset:3072 sc1
v_mfma_f32_16x16x32_bf16 v[204:207], a[136:139], a[88:91], v[204:207]
v_mfma_f32_16x16x32_bf16 v[208:211], a[144:147], a[88:91], v[208:211]
v_mfma_f32_16x16x32_bf16 v[208:211], a[148:151], a[92:95], v[208:211]
v_mfma_f32_16x16x32_bf16 v[184:187], a[148:151], a[84:87], v[184:187]
buffer_load_dwordx4 v1, s[4:7], s44 offen offset:1024 sc1 lds
s_add_u32 m0, s18, 0x4000
v_mfma_f32_16x16x32_bf16 v[184:187], a[144:147], a[80:83], v[184:187]
s_add_u32 s44, s50, 0x2028000
v_mfma_f32_16x16x32_bf16 v[160:163], a[144:147], a[72:75], v[160:163]
v_mfma_f32_16x16x32_bf16 v[160:163], a[148:151], a[76:79], v[160:163]
buffer_load_dwordx4 a[60:63], v2, s[40:43], s33 offen offset:3072 sc1
s_add_u32 s35, s35, 0x2000
v_mfma_f32_16x16x32_bf16 v[136:139], a[148:151], a[68:71], v[136:139]
s_add_u32 s33, s33, 0x2000
v_mfma_f32_16x16x32_bf16 v[136:139], a[144:147], a[64:67], v[136:139]
s_waitcnt vmcnt(13) lgkmcnt(0)
v_mfma_f32_16x16x32_bf16 v[140:143], a[96:99], a[0:3], v[140:143]
ds_read_b128 a[128:131], v5 offset:17408
v_add_f32 v92, v92, v96
v_mfma_f32_16x16x32_bf16 v[140:143], a[100:103], a[4:7], v[140:143]
buffer_load_dwordx4 a[64:67], v2, s[40:43], s35 offen offset:0 sc1
v_mfma_f32_16x16x32_bf16 v[164:167], a[100:103], a[12:15], v[164:167]
ds_read_b128 a[132:135], v5 offset:23552
v_add_f32 v100, v100, v104
v_mfma_f32_16x16x32_bf16 v[164:167], a[96:99], a[8:11], v[164:167]
v_add_f32 v108, v108, v112
v_add_f32 v116, v116, v120
v_mfma_f32_16x16x32_bf16 v[188:191], a[96:99], a[16:19], v[188:191]
v_add_f32 v93, v93, v97
v_add_f32 v101, v101, v105
v_mfma_f32_16x16x32_bf16 v[188:191], a[100:103], a[20:23], v[188:191]
buffer_load_dwordx4 v1, s[4:7], s44 offen offset:0 sc1 lds
v_mfma_f32_16x16x32_bf16 v[212:215], a[100:103], a[28:31], v[212:215]
ds_read_b128 a[136:139], v5 offset:12288
v_add_f32 v109, v109, v113
v_mfma_f32_16x16x32_bf16 v[212:215], a[96:99], a[24:27], v[212:215]
v_add_f32 v117, v117, v121
v_add_f32 v94, v94, v98
v_mfma_f32_16x16x32_bf16 v[216:219], a[104:107], a[24:27], v[216:219]
ds_read_b128 a[140:143], v5 offset:18432
v_add_f32 v102, v102, v106
v_mfma_f32_16x16x32_bf16 v[216:219], a[108:111], a[28:31], v[216:219]
buffer_load_dwordx4 a[68:71], v2, s[40:43], s33 offen offset:0 sc1
v_mfma_f32_16x16x32_bf16 v[192:195], a[108:111], a[20:23], v[192:195]
ds_read_b128 a[144:147], v5 offset:13312
v_add_f32 v110, v110, v114
v_mfma_f32_16x16x32_bf16 v[192:195], a[104:107], a[16:19], v[192:195]
v_add_f32 v118, v118, v122
v_add_f32 v95, v95, v99
v_mfma_f32_16x16x32_bf16 v[168:171], a[104:107], a[8:11], v[168:171]
v_add_f32 v103, v103, v107
v_mfma_f32_16x16x32_bf16 v[168:171], a[108:111], a[12:15], v[168:171]
buffer_load_dwordx4 a[72:75], v2, s[40:43], s35 offen offset:1024 sc1
v_mfma_f32_16x16x32_bf16 v[144:147], a[108:111], a[4:7], v[144:147]
ds_read_b128 a[148:151], v5 offset:19456
v_add_f32 v111, v111, v115
v_mfma_f32_16x16x32_bf16 v[144:147], a[104:107], a[0:3], v[144:147]
v_add_f32 v119, v119, v123
v_add_f32_dpp v92, v92, v92 row_ror:8 row_mask:0xf bank_mask:0xf
v_mfma_f32_16x16x32_bf16 v[148:151], a[112:115], a[0:3], v[148:151]
v_add_f32_dpp v100, v100, v100 row_ror:8 row_mask:0xf bank_mask:0xf
v_mfma_f32_16x16x32_bf16 v[148:151], a[116:119], a[4:7], v[148:151]
buffer_load_dwordx4 v1, s[4:7], s44 offen offset:1024 sc1 lds
s_add_u32 m0, s18, 0x6000
v_mfma_f32_16x16x32_bf16 v[172:175], a[116:119], a[12:15], v[172:175]
s_add_u32 s44, s50, 0x202a000
v_add_f32_dpp v108, v108, v108 row_ror:8 row_mask:0xf bank_mask:0xf
v_mfma_f32_16x16x32_bf16 v[172:175], a[112:115], a[8:11], v[172:175]
v_add_f32_dpp v116, v116, v116 row_ror:8 row_mask:0xf bank_mask:0xf
v_add_f32_dpp v93, v93, v93 row_ror:8 row_mask:0xf bank_mask:0xf
v_mfma_f32_16x16x32_bf16 v[196:199], a[112:115], a[16:19], v[196:199]
v_add_f32_dpp v101, v101, v101 row_ror:8 row_mask:0xf bank_mask:0xf
v_mfma_f32_16x16x32_bf16 v[196:199], a[116:119], a[20:23], v[196:199]
buffer_load_dwordx4 a[76:79], v2, s[40:43], s33 offen offset:1024 sc1
v_mfma_f32_16x16x32_bf16 v[220:223], a[116:119], a[28:31], v[220:223]
v_add_f32_dpp v109, v109, v109 row_ror:8 row_mask:0xf bank_mask:0xf
v_add_f32_dpp v117, v117, v117 row_ror:8 row_mask:0xf bank_mask:0xf
v_mfma_f32_16x16x32_bf16 v[220:223], a[112:115], a[24:27], v[220:223]
s_waitcnt vmcnt(17) lgkmcnt(0)
s_barrier
v_mfma_f32_16x16x32_bf16 v[224:227], a[128:131], a[24:27], v[224:227]
ds_read_b128 a[96:99], v5 offset:26624
v_add_f32_dpp v92, v94, v94 row_ror:8 row_mask:0xf bank_mask:0xc
v_mfma_f32_16x16x32_bf16 v[224:227], a[132:135], a[28:31], v[224:227]
buffer_load_dwordx4 a[80:83], v2, s[40:43], s35 offen offset:2048 sc1
v_mfma_f32_16x16x32_bf16 v[200:203], a[132:135], a[20:23], v[200:203]
ds_read_b128 a[100:103], v5 offset:32768
v_add_f32_dpp v100, v102, v102 row_ror:8 row_mask:0xf bank_mask:0xc
v_mfma_f32_16x16x32_bf16 v[200:203], a[128:131], a[16:19], v[200:203]
v_add_f32_dpp v108, v110, v110 row_ror:8 row_mask:0xf bank_mask:0xc
v_add_f32_dpp v116, v118, v118 row_ror:8 row_mask:0xf bank_mask:0xc
v_mfma_f32_16x16x32_bf16 v[176:179], a[128:131], a[8:11], v[176:179]
v_add_f32_dpp v93, v95, v95 row_ror:8 row_mask:0xf bank_mask:0xc
v_add_f32_dpp v101, v103, v103 row_ror:8 row_mask:0xf bank_mask:0xc
v_mfma_f32_16x16x32_bf16 v[176:179], a[132:135], a[12:15], v[176:179]
buffer_load_dwordx4 v1, s[4:7], s44 offen offset:0 sc1 lds
v_mfma_f32_16x16x32_bf16 v[152:155], a[132:135], a[4:7], v[152:155]
ds_read_b128 a[104:107], v5 offset:27648
v_add_f32_dpp v109, v111, v111 row_ror:8 row_mask:0xf bank_mask:0xc
v_mfma_f32_16x16x32_bf16 v[152:155], a[128:131], a[0:3], v[152:155]
v_add_f32_dpp v117, v119, v119 row_ror:8 row_mask:0xf bank_mask:0xc
v_mfma_f32_16x16x32_bf16 v[132:135], a[136:139], a[0:3], v[132:135]
ds_read_b128 a[108:111], v5 offset:33792
v_mfma_f32_16x16x32_bf16 v[132:135], a[140:143], a[4:7], v[132:135]
buffer_load_dwordx4 a[84:87], v2, s[40:43], s33 offen offset:2048 sc1
v_mfma_f32_16x16x32_bf16 v[156:159], a[140:143], a[12:15], v[156:159]
ds_read_b128 a[112:115], v5 offset:28672
v_mfma_f32_16x16x32_bf16 v[156:159], a[136:139], a[8:11], v[156:159]
v_permlane32_swap_b32 v92, v93
v_mfma_f32_16x16x32_bf16 v[180:183], a[136:139], a[16:19], v[180:183]
L_stub1:
s_cbranch_execz L_wret0
v_permlane32_swap_b32 v100, v101
v_mfma_f32_16x16x32_bf16 v[180:183], a[140:143], a[20:23], v[180:183]
buffer_load_dwordx4 a[88:91], v2, s[40:43], s35 offen offset:3072 sc1
v_mfma_f32_16x16x32_bf16 v[204:207], a[140:143], a[28:31], v[204:207]
ds_read_b128 a[116:119], v5 offset:34816
v_mfma_f32_16x16x32_bf16 v[204:207], a[136:139], a[24:27], v[204:207]
v_permlane32_swap_b32 v108, v109
v_mfma_f32_16x16x32_bf16 v[208:211], a[144:147], a[24:27], v[208:211]
v_permlane32_swap_b32 v116, v117
v_mfma_f32_16x16x32_bf16 v[208:211], a[148:151], a[28:31], v[208:211]
buffer_load_dwordx4 v1, s[4:7], s44 offen offset:1024 sc1 lds
s_add_u32 m0, s18, 0x8000
v_mfma_f32_16x16x32_bf16 v[184:187], a[148:151], a[20:23], v[184:187]
s_add_u32 s44, s50, 0x202c000
v_add_f32 v92, v92, v93
v_mfma_f32_16x16x32_bf16 v[184:187], a[144:147], a[16:19], v[184:187]
v_add_f32 v100, v100, v101
v_add_f32 v108, v108, v109
v_mfma_f32_16x16x32_bf16 v[160:163], a[144:147], a[8:11], v[160:163]
v_add_f32 v116, v116, v117
v_mov_b32 v94, v92
v_mfma_f32_16x16x32_bf16 v[160:163], a[148:151], a[12:15], v[160:163]
buffer_load_dwordx4 a[92:95], v2, s[40:43], s33 offen offset:3072 sc1
s_add_u32 s35, s35, 0x2000
v_mfma_f32_16x16x32_bf16 v[136:139], a[148:151], a[4:7], v[136:139]
s_add_u32 s33, s33, 0x2000
v_mov_b32 v102, v100
v_mfma_f32_16x16x32_bf16 v[136:139], a[144:147], a[0:3], v[136:139]
v_mov_b32 v110, v108
s_waitcnt vmcnt(12) lgkmcnt(0)
v_cmp_gt_u32 vcc, 0x100000, v11
s_nop 0
s_and_b32 vcc_lo, vcc_lo, 0x1f3f
s_cbranch_scc1 Ltal_6
Ltab_7:
v_cmp_lt_u32 vcc, 0x100008, v11
s_nop 0
s_and_b32 s51, vcc_lo, 0x1f3f
v_mfma_f32_16x16x32_bf16 v[140:143], a[96:99], a[32:35], v[140:143]
ds_read_b128 a[128:131], v5 offset:29696
v_mov_b32 v118, v116
v_mfma_f32_16x16x32_bf16 v[140:143], a[100:103], a[36:39], v[140:143]
buffer_load_dwordx4 a[0:3], v2, s[40:43], s35 offen offset:0 sc1
v_mfma_f32_16x16x32_bf16 v[164:167], a[100:103], a[44:47], v[164:167]
ds_read_b128 a[132:135], v5 offset:35840
v_mfma_f32_16x16x32_bf16 v[164:167], a[96:99], a[40:43], v[164:167]
v_permlane16_swap_b32 v92, v94
v_mfma_f32_16x16x32_bf16 v[188:191], a[96:99], a[48:51], v[188:191]
v_permlane16_swap_b32 v100, v102
v_mfma_f32_16x16x32_bf16 v[188:191], a[100:103], a[52:55], v[188:191]
buffer_load_dwordx4 v1, s[4:7], s44 offen offset:0 sc1 lds
v_mfma_f32_16x16x32_bf16 v[212:215], a[100:103], a[60:63], v[212:215]
ds_read_b128 a[136:139], v5 offset:24576
v_mfma_f32_16x16x32_bf16 v[212:215], a[96:99], a[56:59], v[212:215]
v_permlane16_swap_b32 v108, v110
v_mfma_f32_16x16x32_bf16 v[216:219], a[104:107], a[56:59], v[216:219]
ds_read_b128 a[140:143], v5 offset:30720
v_mfma_f32_16x16x32_bf16 v[216:219], a[108:111], a[60:63], v[216:219]
buffer_load_dwordx4 a[4:7], v2, s[40:43], s33 offen offset:0 sc1
v_mfma_f32_16x16x32_bf16 v[192:195], a[108:111], a[52:55], v[192:195]
ds_read_b128 a[144:147], v5 offset:25600
v_mfma_f32_16x16x32_bf16 v[192:195], a[104:107], a[48:51], v[192:195]
v_permlane16_swap_b32 v116, v118
v_mfma_f32_16x16x32_bf16 v[168:171], a[104:107], a[40:43], v[168:171]
v_add_f32 v92, v92, v94
v_add_f32 v100, v100, v102
v_mfma_f32_16x16x32_bf16 v[168:171], a[108:111], a[44:47], v[168:171]
buffer_load_dwordx4 a[8:11], v2, s[40:43], s35 offen offset:1024 sc1
v_mfma_f32_16x16x32_bf16 v[144:147], a[108:111], a[36:39], v[144:147]
ds_read_b128 a[148:151], v5 offset:31744
v_add_f32 v108, v108, v110
v_mfma_f32_16x16x32_bf16 v[144:147], a[104:107], a[32:35], v[144:147]
v_add_f32 v116, v116, v118
v_mov_b32 v94, v92
v_mfma_f32_16x16x32_bf16 v[148:151], a[112:115], a[32:35], v[148:151]
v_mov_b32 v102, v100
v_mov_b32 v110, v108
v_mfma_f32_16x16x32_bf16 v[148:151], a[116:119], a[36:39], v[148:151]
buffer_load_dwordx4 v1, s[4:7], s44 offen offset:1024 sc1 lds
s_add_u32 m0, s18, 0xa000
v_mfma_f32_16x16x32_bf16 v[172:175], a[116:119], a[44:47], v[172:175]
s_add_u32 s44, s50, 0x202e000
v_mov_b32 v118, v116
v_mfma_f32_16x16x32_bf16 v[172:175], a[112:115], a[40:43], v[172:175]
v_permlane32_swap_b32 v92, v94
v_mfma_f32_16x16x32_bf16 v[196:199], a[112:115], a[48:51], v[196:199]
v_permlane32_swap_b32 v100, v102
v_mfma_f32_16x16x32_bf16 v[196:199], a[116:119], a[52:55], v[196:199]
buffer_load_dwordx4 a[12:15], v2, s[40:43], s33 offen offset:1024 sc1
v_mfma_f32_16x16x32_bf16 v[220:223], a[116:119], a[60:63], v[220:223]
v_permlane32_swap_b32 v108, v110
v_mfma_f32_16x16x32_bf16 v[220:223], a[112:115], a[56:59], v[220:223]
s_waitcnt lgkmcnt(0)
v_mfma_f32_16x16x32_bf16 v[224:227], a[128:131], a[56:59], v[224:227]
ds_read_b128 a[96:99], v5 offset:38912
v_mfma_f32_16x16x32_bf16 v[224:227], a[132:135], a[60:63], v[224:227]
buffer_load_dwordx4 a[16:19], v2, s[40:43], s35 offen offset:2048 sc1
v_mfma_f32_16x16x32_bf16 v[200:203], a[132:135], a[52:55], v[200:203]
ds_read_b128 a[100:103], v5 offset:45056
v_mfma_f32_16x16x32_bf16 v[200:203], a[128:131], a[48:51], v[200:203]
v_permlane32_swap_b32 v116, v118
v_mfma_f32_16x16x32_bf16 v[176:179], a[128:131], a[40:43], v[176:179]
v_mul_f32 v82, 0xba800000, v92
v_mul_f32 v84, 0xba800000, v100
v_mfma_f32_16x16x32_bf16 v[176:179], a[132:135], a[44:47], v[176:179]
buffer_load_dwordx4 v1, s[4:7], s44 offen offset:0 sc1 lds
v_mfma_f32_16x16x32_bf16 v[152:155], a[132:135], a[36:39], v[152:155]
ds_read_b128 a[104:107], v5 offset:39936
v_mul_f32 v86, 0xba800000, v108
v_mfma_f32_16x16x32_bf16 v[152:155], a[128:131], a[32:35], v[152:155]
v_mul_f32 v88, 0xba800000, v116
v_mul_f32 v94, 0x3a800000, v94
v_mfma_f32_16x16x32_bf16 v[132:135], a[136:139], a[32:35], v[132:135]
ds_read_b128 a[108:111], v5 offset:46080
v_mul_f32 v102, 0x3a800000, v102
v_mfma_f32_16x16x32_bf16 v[132:135], a[140:143], a[36:39], v[132:135]
buffer_load_dwordx4 a[20:23], v2, s[40:43], s33 offen offset:2048 sc1
v_mfma_f32_16x16x32_bf16 v[156:159], a[140:143], a[44:47], v[156:159]
ds_read_b128 a[112:115], v5 offset:40960
v_mul_f32 v110, 0x3a800000, v110
v_mfma_f32_16x16x32_bf16 v[156:159], a[136:139], a[40:43], v[156:159]
v_mul_f32 v118, 0x3a800000, v118
v_fma_f32 v94, -v82, v82, v94
v_mfma_f32_16x16x32_bf16 v[180:183], a[136:139], a[48:51], v[180:183]
v_fma_f32 v102, -v84, v84, v102
v_fma_f32 v110, -v86, v86, v110
v_mfma_f32_16x16x32_bf16 v[180:183], a[140:143], a[52:55], v[180:183]
buffer_load_dwordx4 a[24:27], v2, s[40:43], s35 offen offset:3072 sc1
v_mfma_f32_16x16x32_bf16 v[204:207], a[140:143], a[60:63], v[204:207]
ds_read_b128 a[116:119], v5 offset:47104
v_fma_f32 v118, -v88, v88, v118
v_mfma_f32_16x16x32_bf16 v[204:207], a[136:139], a[56:59], v[204:207]
v_max_f32 v94, 0, v94
v_max_f32 v102, 0, v102
v_mfma_f32_16x16x32_bf16 v[208:211], a[144:147], a[56:59], v[208:211]
v_max_f32 v110, 0, v110
v_max_f32 v118, 0, v118
v_mfma_f32_16x16x32_bf16 v[208:211], a[148:151], a[60:63], v[208:211]
buffer_load_dwordx4 v1, s[4:7], s44 offen offset:1024 sc1 lds
s_add_u32 m0, s19, 49152
v_mfma_f32_16x16x32_bf16 v[184:187], a[148:151], a[52:55], v[184:187]
s_xor_b32 s44, s84, 16384
v_add_f32 v94, 0x3727c5ac, v94
v_mfma_f32_16x16x32_bf16 v[184:187], a[144:147], a[48:51], v[184:187]
v_add_f32 v102, 0x3727c5ac, v102
v_add_f32 v110, 0x3727c5ac, v110
v_mfma_f32_16x16x32_bf16 v[160:163], a[144:147], a[40:43], v[160:163]
v_add_f32 v118, 0x3727c5ac, v118
v_mfma_f32_16x16x32_bf16 v[160:163], a[148:151], a[44:47], v[160:163]
buffer_load_dwordx4 a[28:31], v2, s[40:43], s33 offen offset:3072 sc1
s_add_u32 s35, s35, 0x2000
v_mfma_f32_16x16x32_bf16 v[136:139], a[148:151], a[36:39], v[136:139]
s_add_u32 s33, s33, 0x2000
v_mfma_f32_16x16x32_bf16 v[136:139], a[144:147], a[32:35], v[136:139]
s_waitcnt vmcnt(12) lgkmcnt(0)
v_mfma_f32_16x16x32_bf16 v[140:143], a[96:99], a[64:67], v[140:143]
ds_read_b128 a[128:131], v5 offset:41984
v_mfma_f32_16x16x32_bf16 v[140:143], a[100:103], a[68:71], v[140:143]
buffer_load_dwordx4 a[32:35], v2, s[40:43], s35 offen offset:0 sc1
v_mfma_f32_16x16x32_bf16 v[164:167], a[100:103], a[76:79], v[164:167]
ds_read_b128 a[132:135], v5 offset:48128
v_mfma_f32_16x16x32_bf16 v[164:167], a[96:99], a[72:75], v[164:167]
v_rsq_f32 v83, v94
v_mfma_f32_16x16x32_bf16 v[188:191], a[96:99], a[80:83], v[188:191]
v_rsq_f32 v85, v102
v_mfma_f32_16x16x32_bf16 v[188:191], a[100:103], a[84:87], v[188:191]
buffer_load_dwordx4 v1, s[4:7], s44 offen offset:0 sc1 lds
v_mfma_f32_16x16x32_bf16 v[212:215], a[100:103], a[92:95], v[212:215]
ds_read_b128 a[136:139], v5 offset:36864
v_mfma_f32_16x16x32_bf16 v[212:215], a[96:99], a[88:91], v[212:215]
v_rsq_f32 v87, v110
v_rsq_f32 v89, v118
v_mfma_f32_16x16x32_bf16 v[216:219], a[104:107], a[88:91], v[216:219]
ds_read_b128 a[140:143], v5 offset:43008
v_mfma_f32_16x16x32_bf16 v[216:219], a[108:111], a[92:95], v[216:219]
buffer_load_dwordx4 a[36:39], v2, s[40:43], s33 offen offset:0 sc1
v_mfma_f32_16x16x32_bf16 v[192:195], a[108:111], a[84:87], v[192:195]
ds_read_b128 a[144:147], v5 offset:37888
v_fmac_f32 v140, v56, v82
v_mfma_f32_16x16x32_bf16 v[192:195], a[104:107], a[80:83], v[192:195]
v_mfma_f32_16x16x32_bf16 v[168:171], a[104:107], a[72:75], v[168:171]
v_fmac_f32 v164, v56, v84
v_mfma_f32_16x16x32_bf16 v[168:171], a[108:111], a[76:79], v[168:171]
buffer_load_dwordx4 a[40:43], v2, s[40:43], s35 offen offset:1024 sc1
v_mfma_f32_16x16x32_bf16 v[144:147], a[108:111], a[68:71], v[144:147]
ds_read_b128 a[148:151], v5 offset:44032
v_fmac_f32 v188, v56, v86
v_mfma_f32_16x16x32_bf16 v[144:147], a[104:107], a[64:67], v[144:147]
v_mfma_f32_16x16x32_bf16 v[148:151], a[112:115], a[64:67], v[148:151]
v_fmac_f32 v212, v56, v88
v_mfma_f32_16x16x32_bf16 v[148:151], a[116:119], a[68:71], v[148:151]
buffer_load_dwordx4 v1, s[4:7], s44 offen offset:1024 sc1 lds
v_mfma_f32_16x16x32_bf16 v[172:175], a[116:119], a[76:79], v[172:175]
v_fmac_f32 v216, v60, v88
v_mfma_f32_16x16x32_bf16 v[172:175], a[112:115], a[72:75], v[172:175]
v_mfma_f32_16x16x32_bf16 v[196:199], a[112:115], a[80:83], v[196:199]
v_fmac_f32 v192, v60, v86
v_mfma_f32_16x16x32_bf16 v[196:199], a[116:119], a[84:87], v[196:199]
buffer_load_dwordx4 a[44:47], v2, s[40:43], s33 offen offset:1024 sc1
v_mfma_f32_16x16x32_bf16 v[220:223], a[116:119], a[92:95], v[220:223]
v_fmac_f32 v168, v60, v84
v_fmac_f32 v141, v57, v82
v_mfma_f32_16x16x32_bf16 v[220:223], a[112:115], a[88:91], v[220:223]
s_waitcnt lgkmcnt(0)
s_barrier
v_mfma_f32_16x16x32_bf16 v[224:227], a[128:131], a[88:91], v[224:227]
v_add_u32 v5, 0, v1
v_fmac_f32 v144, v60, v82
v_mfma_f32_16x16x32_bf16 v[224:227], a[132:135], a[92:95], v[224:227]
buffer_load_dwordx4 a[48:51], v2, s[40:43], s35 offen offset:2048 sc1
v_mfma_f32_16x16x32_bf16 v[200:203], a[132:135], a[84:87], v[200:203]
ds_read_b128 a[96:99], v5 offset:2048
v_fmac_f32 v148, v64, v82
v_mfma_f32_16x16x32_bf16 v[200:203], a[128:131], a[80:83], v[200:203]
ds_read_b128 a[100:103], v5 offset:8192
v_fmac_f32 v165, v57, v84
v_mfma_f32_16x16x32_bf16 v[176:179], a[128:131], a[72:75], v[176:179]
v_fmac_f32 v172, v64, v84
v_fmac_f32 v189, v57, v86
v_mfma_f32_16x16x32_bf16 v[176:179], a[132:135], a[76:79], v[176:179]
buffer_load_dwordx4 v1, s[4:7], s44 offen offset:2048 sc1 lds
v_mfma_f32_16x16x32_bf16 v[152:155], a[132:135], a[68:71], v[152:155]
ds_read_b128 a[104:107], v5 offset:3072
v_fmac_f32 v196, v64, v86
v_mfma_f32_16x16x32_bf16 v[152:155], a[128:131], a[64:67], v[152:155]
v_fmac_f32 v213, v57, v88
v_fmac_f32 v217, v61, v88
v_mfma_f32_16x16x32_bf16 v[132:135], a[136:139], a[64:67], v[132:135]
ds_read_b128 a[108:111], v5 offset:9216
v_fmac_f32 v220, v64, v88
v_mfma_f32_16x16x32_bf16 v[132:135], a[140:143], a[68:71], v[132:135]
buffer_load_dwordx4 a[52:55], v2, s[40:43], s33 offen offset:2048 sc1
v_mfma_f32_16x16x32_bf16 v[156:159], a[140:143], a[76:79], v[156:159]
ds_read_b128 a[112:115], v5 offset:4096
v_fmac_f32 v224, v68, v88
v_mfma_f32_16x16x32_bf16 v[156:159], a[136:139], a[72:75], v[156:159]
v_fmac_f32 v193, v61, v86
v_fmac_f32 v169, v61, v84
v_mfma_f32_16x16x32_bf16 v[180:183], a[136:139], a[80:83], v[180:183]
v_fmac_f32 v200, v68, v86
v_fmac_f32 v145, v61, v82
v_mfma_f32_16x16x32_bf16 v[180:183], a[140:143], a[84:87], v[180:183]
buffer_load_dwordx4 a[56:59], v2, s[40:43], s35 offen offset:3072 sc1
v_mfma_f32_16x16x32_bf16 v[204:207], a[140:143], a[92:95], v[204:207]
ds_read_b128 a[116:119], v5 offset:10240
v_fmac_f32 v176, v68, v84
v_mfma_f32_16x16x32_bf16 v[204:207], a[136:139], a[88:91], v[204:207]
v_fmac_f32 v149, v65, v82
v_mfma_f32_16x16x32_bf16 v[208:211], a[144:147], a[88:91], v[208:211]
v_fmac_f32 v152, v68, v82
v_fmac_f32 v173, v65, v84
v_mfma_f32_16x16x32_bf16 v[208:211], a[148:151], a[92:95], v[208:211]
buffer_load_dwordx4 v1, s[4:7], s44 offen offset:3072 sc1 lds
s_add_u32 m0, s19, 65536
v_mfma_f32_16x16x32_bf16 v[184:187], a[148:151], a[84:87], v[184:187]
s_xor_b32 s44, s84, 32768
v_fmac_f32 v132, v48, v82
v_mfma_f32_16x16x32_bf16 v[184:187], a[144:147], a[80:83], v[184:187]
v_fmac_f32 v197, v65, v86
v_mfma_f32_16x16x32_bf16 v[160:163], a[144:147], a[72:75], v[160:163]
v_fmac_f32 v156, v48, v84
v_fmac_f32 v221, v65, v88
v_mfma_f32_16x16x32_bf16 v[160:163], a[148:151], a[76:79], v[160:163]
buffer_load_dwordx4 a[60:63], v2, s[40:43], s33 offen offset:3072 sc1
s_add_u32 s35, s35, 0x2000
v_mfma_f32_16x16x32_bf16 v[136:139], a[148:151], a[68:71], v[136:139]
s_add_u32 s33, s33, 0x2000
v_fmac_f32 v180, v48, v86
v_mfma_f32_16x16x32_bf16 v[136:139], a[144:147], a[64:67], v[136:139]
v_fmac_f32 v225, v69, v88
s_waitcnt vmcnt(12) lgkmcnt(0)
v_mfma_f32_16x16x32_bf16 v[140:143], a[96:99], a[0:3], v[140:143]
ds_read_b128 a[128:131], v5 offset:5120
v_fmac_f32 v204, v48, v88
v_mfma_f32_16x16x32_bf16 v[140:143], a[100:103], a[4:7], v[140:143]
buffer_load_dwordx4 a[64:67], v2, s[40:43], s35 offen offset:0 sc1
s_lshl_b32 s37, s28, 10
v_mfma_f32_16x16x32_bf16 v[164:167], a[100:103], a[12:15], v[164:167]
ds_read_b128 a[132:135], v5 offset:11264
v_fmac_f32 v208, v52, v88
v_mfma_f32_16x16x32_bf16 v[164:167], a[96:99], a[8:11], v[164:167]
v_fmac_f32 v201, v69, v86
v_fmac_f32 v177, v69, v84
v_mfma_f32_16x16x32_bf16 v[188:191], a[96:99], a[16:19], v[188:191]
v_fmac_f32 v184, v52, v86
v_fmac_f32 v153, v69, v82
v_mfma_f32_16x16x32_bf16 v[188:191], a[100:103], a[20:23], v[188:191]
buffer_load_dwordx4 a[68:71], v2, s[40:43], s33 offen offset:0 sc1
s_lshr_b32 s79, s30, 1
v_mfma_f32_16x16x32_bf16 v[212:215], a[100:103], a[28:31], v[212:215]
ds_read_b128 a[136:139], v5 offset:0
v_fmac_f32 v160, v52, v84
v_mfma_f32_16x16x32_bf16 v[212:215], a[96:99], a[24:27], v[212:215]
v_fmac_f32 v133, v49, v82
s_lshr_b32 s36, s79, 3
v_mfma_f32_16x16x32_bf16 v[216:219], a[104:107], a[24:27], v[216:219]
ds_read_b128 a[140:143], v5 offset:6144
v_fmac_f32 v136, v52, v82
v_mfma_f32_16x16x32_bf16 v[216:219], a[108:111], a[28:31], v[216:219]
buffer_load_dwordx4 a[72:75], v2, s[40:43], s35 offen offset:1024 sc1
s_and_b32 s79, s79, 7
v_mfma_f32_16x16x32_bf16 v[192:195], a[108:111], a[20:23], v[192:195]
ds_read_b128 a[144:147], v5 offset:1024
v_fmac_f32 v157, v49, v84
v_mfma_f32_16x16x32_bf16 v[192:195], a[104:107], a[16:19], v[192:195]
v_fmac_f32 v181, v49, v86
v_fmac_f32 v142, v58, v82
v_mfma_f32_16x16x32_bf16 v[168:171], a[104:107], a[8:11], v[168:171]
v_fmac_f32 v205, v49, v88
v_fmac_f32 v166, v58, v84
v_mfma_f32_16x16x32_bf16 v[168:171], a[108:111], a[12:15], v[168:171]
buffer_load_dwordx4 a[76:79], v2, s[40:43], s33 offen offset:1024 sc1
s_mul_i32 s36, s36, 524288
v_mfma_f32_16x16x32_bf16 v[144:147], a[108:111], a[4:7], v[144:147]
ds_read_b128 a[148:151], v5 offset:7168
v_fmac_f32 v209, v53, v88
v_mfma_f32_16x16x32_bf16 v[144:147], a[104:107], a[0:3], v[144:147]
v_fmac_f32 v190, v58, v86
s_lshl_b32 s79, s79, 14
v_mfma_f32_16x16x32_bf16 v[148:151], a[112:115], a[0:3], v[148:151]
v_fmac_f32 v185, v53, v86
v_fmac_f32 v214, v58, v88
v_mfma_f32_16x16x32_bf16 v[148:151], a[116:119], a[4:7], v[148:151]
buffer_load_dwordx4 a[80:83], v2, s[40:43], s35 offen offset:2048 sc1
s_add_u32 s79, s79, s36
v_mfma_f32_16x16x32_bf16 v[172:175], a[116:119], a[12:15], v[172:175]
v_fmac_f32 v161, v53, v84
v_fmac_f32 v218, v62, v88
v_mfma_f32_16x16x32_bf16 v[172:175], a[112:115], a[8:11], v[172:175]
s_and_b32 s36, s30, 1
s_lshl_b32 s36, s36, 12
s_add_u32 s79, s79, s36
v_mfma_f32_16x16x32_bf16 v[196:199], a[112:115], a[16:19], v[196:199]
v_fmac_f32 v137, v53, v82
v_fmac_f32 v194, v62, v86
v_mfma_f32_16x16x32_bf16 v[196:199], a[116:119], a[20:23], v[196:199]
buffer_load_dwordx4 a[84:87], v2, s[40:43], s33 offen offset:2048 sc1
s_lshr_b32 s39, s29, 2
v_mfma_f32_16x16x32_bf16 v[220:223], a[116:119], a[28:31], v[220:223]
v_fmac_f32 v170, v62, v84
v_fmac_f32 v143, v59, v82
v_mfma_f32_16x16x32_bf16 v[220:223], a[112:115], a[24:27], v[220:223]
s_mul_i32 s39, s39, 0xffff
s_waitcnt lgkmcnt(0)
v_mfma_f32_16x16x32_bf16 v[224:227], a[128:131], a[24:27], v[224:227]
ds_read_b128 a[96:99], v5 offset:14336
v_fmac_f32 v146, v62, v82
v_mfma_f32_16x16x32_bf16 v[224:227], a[132:135], a[28:31], v[224:227]
buffer_load_dwordx4 a[88:91], v2, s[40:43], s35 offen offset:3072 sc1
s_xor_b32 s39, s39, s51
v_mfma_f32_16x16x32_bf16 v[200:203], a[132:135], a[20:23], v[200:203]
ds_read_b128 a[100:103], v5 offset:20480
v_fmac_f32 v150, v66, v82
v_mfma_f32_16x16x32_bf16 v[200:203], a[128:131], a[16:19], v[200:203]
v_fmac_f32 v167, v59, v84
v_fmac_f32 v191, v59, v86
v_mfma_f32_16x16x32_bf16 v[176:179], a[128:131], a[8:11], v[176:179]
buffer_load_dwordx4 v1, s[4:7], s44 offen offset:0 sc1 lds
s_and_b32 s36, s29, 2
v_mfma_f32_16x16x32_bf16 v[176:179], a[132:135], a[12:15], v[176:179]
ds_read_b128 a[104:107], v5 offset:15360
v_fmac_f32 v174, v66, v84
v_mfma_f32_16x16x32_bf16 v[152:155], a[132:135], a[4:7], v[152:155]
v_fmac_f32 v198, v66, v86
v_fmac_f32 v215, v59, v88
v_mfma_f32_16x16x32_bf16 v[152:155], a[128:131], a[0:3], v[152:155]
buffer_load_dwordx4 v1, s[4:7], s44 offen offset:1024 sc1 lds
s_lshl_b32 s36, s36, 2
v_mfma_f32_16x16x32_bf16 v[132:135], a[136:139], a[0:3], v[132:135]
ds_read_b128 a[108:111], v5 offset:21504
v_fmac_f32 v222, v66, v88
v_mfma_f32_16x16x32_bf16 v[132:135], a[140:143], a[4:7], v[132:135]
v_fmac_f32 v219, v63, v88
v_fmac_f32 v195, v63, v86
v_mfma_f32_16x16x32_bf16 v[156:159], a[140:143], a[12:15], v[156:159]
ds_read_b128 a[112:115], v5 offset:16384
v_fmac_f32 v226, v70, v88
v_mfma_f32_16x16x32_bf16 v[156:159], a[136:139], a[8:11], v[156:159]
buffer_load_dwordx4 v1, s[4:7], s44 offen offset:2048 sc1 lds
s_lshr_b32 s36, s39, s36
v_mfma_f32_16x16x32_bf16 v[180:183], a[136:139], a[16:19], v[180:183]
v_fmac_f32 v202, v70, v86
v_fmac_f32 v171, v63, v84
v_mfma_f32_16x16x32_bf16 v[180:183], a[140:143], a[20:23], v[180:183]
ds_read_b128 a[116:119], v5 offset:22528
v_fmac_f32 v147, v63, v82
v_mfma_f32_16x16x32_bf16 v[204:207], a[140:143], a[28:31], v[204:207]
buffer_load_dwordx4 a[92:95], v2, s[40:43], s33 offen offset:3072 sc1
s_add_u32 s35, s35, 0x2000
v_mfma_f32_16x16x32_bf16 v[204:207], a[136:139], a[24:27], v[204:207]
s_add_u32 s33, s33, 0x2000
v_fmac_f32 v178, v70, v84
v_mfma_f32_16x16x32_bf16 v[208:211], a[144:147], a[24:27], v[208:211]
v_fmac_f32 v154, v70, v82
v_fmac_f32 v151, v67, v82
v_mfma_f32_16x16x32_bf16 v[208:211], a[148:151], a[28:31], v[208:211]
v_fmac_f32 v175, v67, v84
s_bfe_u32 s68, s36, 0x10001
v_mfma_f32_16x16x32_bf16 v[184:187], a[148:151], a[20:23], v[184:187]
buffer_load_dwordx4 v1, s[4:7], s44 offen offset:3072 sc1 lds
s_add_u32 m0, s19, 81920
v_mfma_f32_16x16x32_bf16 v[184:187], a[144:147], a[16:19], v[184:187]
s_xor_b32 s44, s84, 49152
v_fmac_f32 v134, v50, v82
v_mfma_f32_16x16x32_bf16 v[160:163], a[144:147], a[8:11], v[160:163]
v_fmac_f32 v158, v50, v84
v_fmac_f32 v199, v67, v86
v_mfma_f32_16x16x32_bf16 v[160:163], a[148:151], a[12:15], v[160:163]
buffer_load_dwordx4 v1, s[4:7], s44 offen offset:0 sc1 lds
s_lshl_b32 s68, s68, 13
v_mfma_f32_16x16x32_bf16 v[136:139], a[148:151], a[4:7], v[136:139]
v_fmac_f32 v182, v50, v86
v_fmac_f32 v223, v67, v88
v_mfma_f32_16x16x32_bf16 v[136:139], a[144:147], a[0:3], v[136:139]
s_waitcnt vmcnt(13) lgkmcnt(0)
s_barrier
v_mfma_f32_16x16x32_bf16 v[140:143], a[96:99], a[32:35], v[140:143]
ds_read_b128 a[128:131], v5 offset:17408
v_fmac_f32 v206, v50, v88
v_mfma_f32_16x16x32_bf16 v[140:143], a[100:103], a[36:39], v[140:143]
buffer_load_dwordx4 a[0:3], v2, s[40:43], s35 offen offset:0 sc1
s_bfe_u32 s10, s36, 0x10004
v_mfma_f32_16x16x32_bf16 v[164:167], a[100:103], a[44:47], v[164:167]
ds_read_b128 a[132:135], v5 offset:23552
v_fmac_f32 v210, v54, v88
v_mfma_f32_16x16x32_bf16 v[164:167], a[96:99], a[40:43], v[164:167]
v_fmac_f32 v227, v71, v88
v_fmac_f32 v203, v71, v86
v_mfma_f32_16x16x32_bf16 v[188:191], a[96:99], a[48:51], v[188:191]
buffer_load_dwordx4 a[4:7], v2, s[40:43], s33 offen offset:0 sc1
s_lshl_b32 s10, s10, 13
v_mfma_f32_16x16x32_bf16 v[188:191], a[100:103], a[52:55], v[188:191]
ds_read_b128 a[136:139], v5 offset:26624
v_fmac_f32 v186, v54, v86
v_mfma_f32_16x16x32_bf16 v[212:215], a[100:103], a[60:63], v[212:215]
v_fmac_f32 v162, v54, v84
v_fmac_f32 v179, v71, v84
v_mfma_f32_16x16x32_bf16 v[212:215], a[96:99], a[56:59], v[212:215]
buffer_load_dwordx4 a[8:11], v2, s[40:43], s35 offen offset:1024 sc1
s_bfe_u32 s75, s36, 0x10002
v_mfma_f32_16x16x32_bf16 v[216:219], a[104:107], a[56:59], v[216:219]
ds_read_b128 a[140:143], v5 offset:32768
v_fmac_f32 v138, v54, v82
v_mfma_f32_16x16x32_bf16 v[216:219], a[108:111], a[60:63], v[216:219]
v_fmac_f32 v155, v71, v82
v_fmac_f32 v135, v51, v82
v_mfma_f32_16x16x32_bf16 v[192:195], a[108:111], a[52:55], v[192:195]
buffer_load_dwordx4 a[12:15], v2, s[40:43], s33 offen offset:1024 sc1
s_lshl_b32 s75, s75, 13
v_mfma_f32_16x16x32_bf16 v[192:195], a[104:107], a[48:51], v[192:195]
ds_read_b128 a[144:147], v5 offset:27648
v_fmac_f32 v159, v51, v84
v_mfma_f32_16x16x32_bf16 v[168:171], a[104:107], a[40:43], v[168:171]
v_fmac_f32 v183, v51, v86
v_fmac_f32 v207, v51, v88
v_mfma_f32_16x16x32_bf16 v[168:171], a[108:111], a[44:47], v[168:171]
buffer_load_dwordx4 a[16:19], v2, s[40:43], s35 offen offset:2048 sc1
s_bfe_u32 s76, s36, 0x10003
v_mfma_f32_16x16x32_bf16 v[144:147], a[108:111], a[36:39], v[144:147]
ds_read_b128 a[148:151], v5 offset:33792
v_fmac_f32 v211, v55, v88
v_mfma_f32_16x16x32_bf16 v[144:147], a[104:107], a[32:35], v[144:147]
s_lshl_b32 s76, s76, 13
s_add_u32 s75, s75, s79
s_add_u32 s76, s76, s79
v_mfma_f32_16x16x32_bf16 v[148:151], a[112:115], a[32:35], v[148:151]
buffer_load_dwordx4 a[20:23], v2, s[40:43], s33 offen offset:2048 sc1
s_and_b32 s36, s31, 4
v_mfma_f32_16x16x32_bf16 v[148:151], a[116:119], a[36:39], v[148:151]
v_fmac_f32 v187, v55, v86
s_lshl_b32 s36, s36, 1
v_mfma_f32_16x16x32_bf16 v[172:175], a[116:119], a[44:47], v[172:175]
v_fmac_f32 v163, v55, v84
s_lshr_b32 s36, s39, s36
v_mfma_f32_16x16x32_bf16 v[172:175], a[112:115], a[40:43], v[172:175]
buffer_load_dwordx4 a[24:27], v2, s[40:43], s35 offen offset:3072 sc1
s_bfe_u32 s69, s36, 0x10001
v_mfma_f32_16x16x32_bf16 v[196:199], a[112:115], a[48:51], v[196:199]
v_fmac_f32 v139, v55, v82
s_lshl_b32 s69, s69, 13
v_mfma_f32_16x16x32_bf16 v[196:199], a[116:119], a[52:55], v[196:199]
s_bfe_u32 s45, s36, 0x10004
s_lshl_b32 s45, s45, 13
s_bfe_u32 s77, s36, 0x10002
v_mfma_f32_16x16x32_bf16 v[220:223], a[116:119], a[60:63], v[220:223]
buffer_load_dwordx4 a[28:31], v2, s[40:43], s33 offen offset:3072 sc1
s_add_u32 s35, s35, 0x2000
v_mfma_f32_16x16x32_bf16 v[220:223], a[112:115], a[56:59], v[220:223]
s_add_u32 s33, s33, 0x2000
s_waitcnt lgkmcnt(0)
v_mfma_f32_16x16x32_bf16 v[224:227], a[128:131], a[56:59], v[224:227]
ds_read_b128 a[96:99], v5 offset:28672
s_lshl_b32 s77, s77, 13
v_mfma_f32_16x16x32_bf16 v[224:227], a[132:135], a[60:63], v[224:227]
buffer_load_dwordx4 v1, s[4:7], s44 offen offset:1024 sc1 lds
s_bfe_u32 s9, s36, 0x10003
v_mfma_f32_16x16x32_bf16 v[200:203], a[132:135], a[52:55], v[200:203]
ds_read_b128 a[100:103], v5 offset:34816
s_lshl_b32 s9, s9, 13
v_mfma_f32_16x16x32_bf16 v[200:203], a[128:131], a[48:51], v[200:203]
s_lshr_b32 s38, s32, 3
s_and_b32 s36, s32, 7
s_mul_i32 s38, s38, 524288
v_mfma_f32_16x16x32_bf16 v[176:179], a[128:131], a[40:43], v[176:179]
s_lshl_b32 s36, s36, 14
s_add_u32 s36, s36, s38
s_add_u32 s45, s45, s36
v_mfma_f32_16x16x32_bf16 v[176:179], a[132:135], a[44:47], v[176:179]
ds_read_b128 a[104:107], v5 offset:29696
s_add_u32 s69, s69, s36
v_mfma_f32_16x16x32_bf16 v[152:155], a[132:135], a[36:39], v[152:155]
s_bfe_u32 s79, s39, 0x10008
s_lshl_b32 s79, s79, 13
s_xor_b32 s38, s29, s39
v_mfma_f32_16x16x32_bf16 v[152:155], a[128:131], a[32:35], v[152:155]
s_and_b32 s38, s38, 1
s_mul_i32 s38, s38, 0x102000
s_add_u32 s71, s71, s38
s_waitcnt vmcnt(21)
v_mfma_f32_16x16x32_bf16 v[140:143], a[136:139], a[64:67], v[140:143]
ds_read_b128 a[108:111], v5 offset:35840
s_add_u32 s34, s67, s38
s_waitcnt vmcnt(20)
v_mfma_f32_16x16x32_bf16 v[140:143], a[140:143], a[68:71], v[140:143]
buffer_load_dwordx4 v1, s[4:7], s44 offen offset:2048 sc1 lds
s_lshr_b32 s38, s31, 1
s_waitcnt vmcnt(19)
v_mfma_f32_16x16x32_bf16 v[164:167], a[140:143], a[76:79], v[164:167]
ds_read_b128 a[112:115], v5 offset:38912
s_xor_b32 s38, s38, s39
v_mfma_f32_16x16x32_bf16 v[164:167], a[136:139], a[72:75], v[164:167]
s_and_b32 s38, s38, 1
s_mul_i32 s38, s38, 0x102000
s_add_u32 s78, s78, s38
s_waitcnt vmcnt(18)
v_mfma_f32_16x16x32_bf16 v[188:191], a[136:139], a[80:83], v[188:191]
s_add_u32 s11, s66, s38
s_and_b32 s38, s30, 8
s_lshl_b32 s38, s38, 13
s_waitcnt vmcnt(17)
v_mfma_f32_16x16x32_bf16 v[188:191], a[140:143], a[84:87], v[188:191]
ds_read_b128 a[116:119], v5 offset:45056
s_and_b32 s36, s30, 16
s_waitcnt vmcnt(12)
v_mfma_f32_16x16x32_bf16 v[212:215], a[140:143], a[92:95], v[212:215]
s_lshl_b32 s36, s36, 15
s_add_u32 s38, s38, s36
s_add_u32 s77, s77, s38
v_mfma_f32_16x16x32_bf16 v[212:215], a[136:139], a[88:91], v[212:215]
s_add_u32 s9, s9, s38
s_lshl_b32 s38, s31, 1
s_lshr_b32 s90, s28, 1
v_mfma_f32_16x16x32_bf16 v[216:219], a[144:147], a[88:91], v[216:219]
s_add_u32 s38, s38, s90
s_lshl_b32 s90, s38, 13
s_sub_u32 s91, s79, s90
v_mfma_f32_16x16x32_bf16 v[216:219], a[148:151], a[92:95], v[216:219]
buffer_load_dwordx4 v1, s[4:7], s44 offen offset:3072 sc1 lds
s_and_b32 s38, s38, 15
v_mfma_f32_16x16x32_bf16 v[192:195], a[148:151], a[84:87], v[192:195]
s_lshl_b32 s90, s38, 14
s_add_u32 s91, s91, s90
s_and_b32 s90, s38, 12
v_mfma_f32_16x16x32_bf16 v[192:195], a[144:147], a[80:83], v[192:195]
s_add_u32 s38, s38, s90
s_lshl_b32 s38, s38, 17
s_and_b32 s90, s18, 0x800
v_mfma_f32_16x16x32_bf16 v[168:171], a[144:147], a[72:75], v[168:171]
s_add_u32 s38, s38, s90
s_lshl_b32 s39, s81, 2
s_add_u32 s39, s39, s28
v_mfma_f32_16x16x32_bf16 v[168:171], a[148:151], a[76:79], v[168:171]
s_lshl_b32 s82, s39, 14
v_mul_f32 v88, 0x3e8293ee, v89
v_mfma_f32_16x16x32_bf16 v[144:147], a[148:151], a[68:71], v[144:147]
s_add_u32 s82, s82, s79
s_and_b32 s90, s39, 12
s_add_u32 s39, s39, s90
v_mfma_f32_16x16x32_bf16 v[144:147], a[144:147], a[64:67], v[144:147]
s_lshl_b32 s39, s39, 17
s_waitcnt lgkmcnt(0)
v_mfma_f32_16x16x32_bf16 v[148:151], a[96:99], a[64:67], v[148:151]
ds_read_b128 a[128:131], v5 offset:39936
s_add_u32 s72, s75, 0x800000
v_mfma_f32_16x16x32_bf16 v[148:151], a[100:103], a[68:71], v[148:151]
buffer_store_dwordx4 a[220:223], v1, s[4:7], s101 offen offset:0 sc1
s_add_u32 s63, s83, 0x1780000
v_mfma_f32_16x16x32_bf16 v[172:175], a[100:103], a[76:79], v[172:175]
ds_read_b128 a[132:135], v5 offset:46080
s_sub_u32 s55, s63, 65536
v_mfma_f32_16x16x32_bf16 v[172:175], a[96:99], a[72:75], v[172:175]
s_bfe_u32 s36, s83, 0x5000d
s_lshl_b32 s36, s36, 14
s_and_b32 s83, s83, 0x1800
v_mfma_f32_16x16x32_bf16 v[196:199], a[96:99], a[80:83], v[196:199]
s_add_u32 s83, s83, s36
s_add_u32 s83, s83, s79
v_mfma_f32_16x16x32_bf16 v[196:199], a[100:103], a[84:87], v[196:199]
ds_read_b128 a[136:139], v5 offset:40960
v_add_u32 v233, s37, v1
v_mfma_f32_16x16x32_bf16 v[220:223], a[100:103], a[92:95], v[220:223]
v_add_u32 v232, s19, v7
v_mul_f32 v86, 0x3e8293ee, v87
v_mfma_f32_16x16x32_bf16 v[220:223], a[96:99], a[88:91], v[220:223]
v_mul_f32 v84, 0x3e8293ee, v85
v_mul_f32 v82, 0x3e8293ee, v83
v_mfma_f32_16x16x32_bf16 v[224:227], a[104:107], a[88:91], v[224:227]
ds_read_b128 a[140:143], v5 offset:47104
v_add_u32 v248, s19, v8
v_mfma_f32_16x16x32_bf16 v[224:227], a[108:111], a[92:95], v[224:227]
buffer_store_dwordx4 a[224:227], v1, s[4:7], s101 offen offset:1024 sc1
s_add_u32 s16, s97, 0
v_mfma_f32_16x16x32_bf16 v[200:203], a[108:111], a[84:87], v[200:203]
s_add_u32 s16, s16, s96
ds_read_b128 a[144:147], v5 offset:41984
v_mfma_f32_16x16x32_bf16 v[200:203], a[104:107], a[80:83], v[200:203]
v_add_u32 v253, s91, v253
v_add_u32 v4, s38, v1
v_mfma_f32_16x16x32_bf16 v[176:179], a[104:107], a[72:75], v[176:179]
v_add_u32 v2, s39, v1
v_mfma_f32_16x16x32_bf16 v[176:179], a[108:111], a[76:79], v[176:179]
ds_read_b128 a[148:151], v5 offset:48128
v_mfma_f32_16x16x32_bf16 v[152:155], a[108:111], a[68:71], v[152:155]
v_mfma_f32_16x16x32_bf16 v[152:155], a[104:107], a[64:67], v[152:155]
s_waitcnt vmcnt(12)
v_mfma_f32_16x16x32_bf16 v[140:143], a[112:115], a[0:3], v[140:143]
s_waitcnt vmcnt(11)
v_mfma_f32_16x16x32_bf16 v[140:143], a[116:119], a[4:7], v[140:143]
buffer_store_dwordx4 a[188:191], v1, s[4:7], s16 offen sc1
L_stub2:
s_cbranch_execz L_wret0
s_add_u32 s16, s97, 6144
s_waitcnt vmcnt(10)
v_mfma_f32_16x16x32_bf16 v[164:167], a[116:119], a[12:15], v[164:167]
s_add_u32 s16, s16, s96
v_mfma_f32_16x16x32_bf16 v[164:167], a[112:115], a[8:11], v[164:167]
s_waitcnt vmcnt(9)
v_mfma_f32_16x16x32_bf16 v[188:191], a[112:115], a[16:19], v[188:191]
s_waitcnt vmcnt(8)
v_mfma_f32_16x16x32_bf16 v[188:191], a[116:119], a[20:23], v[188:191]
s_waitcnt vmcnt(6)
v_mfma_f32_16x16x32_bf16 v[212:215], a[116:119], a[28:31], v[212:215]
v_mfma_f32_16x16x32_bf16 v[212:215], a[112:115], a[24:27], v[212:215]
s_waitcnt lgkmcnt(0)
v_mfma_f32_16x16x32_bf16 v[216:219], a[128:131], a[24:27], v[216:219]
ds_read_b128 a[96:99], v5 offset:12288
v_mul_f32 v140, v140, v83
v_mfma_f32_16x16x32_bf16 v[216:219], a[132:135], a[28:31], v[216:219]
buffer_store_dwordx4 a[192:195], v1, s[4:7], s16 offen sc1
s_add_u32 s16, s97, 1024
v_mfma_f32_16x16x32_bf16 v[192:195], a[132:135], a[20:23], v[192:195]
s_add_u32 s16, s16, s96
ds_read_b128 a[100:103], v5 offset:18432
v_mfma_f32_16x16x32_bf16 v[192:195], a[128:131], a[16:19], v[192:195]
v_mul_f32 v141, v141, v83
v_cvt_pk_bf16_f32 v140, v140, v141
v_mfma_f32_16x16x32_bf16 v[168:171], a[128:131], a[8:11], v[168:171]
v_mul_f32 v188, v188, v87
v_mul_f32 v189, v189, v87
v_mfma_f32_16x16x32_bf16 v[168:171], a[132:135], a[12:15], v[168:171]
ds_read_b128 a[104:107], v5 offset:24576
v_cvt_pk_bf16_f32 v188, v188, v189
v_mfma_f32_16x16x32_bf16 v[144:147], a[132:135], a[4:7], v[144:147]
v_mul_f32 v212, v212, v89
v_mul_f32 v213, v213, v89
v_mfma_f32_16x16x32_bf16 v[144:147], a[128:131], a[0:3], v[144:147]
v_mul_f32 v214, v214, v89
v_mul_f32 v215, v215, v89
v_mfma_f32_16x16x32_bf16 v[148:151], a[136:139], a[0:3], v[148:151]
ds_read_b128 a[108:111], v5 offset:30720
v_cvt_pk_bf16_f32 v212, v212, v213
v_mfma_f32_16x16x32_bf16 v[148:151], a[140:143], a[4:7], v[148:151]
buffer_store_dwordx4 a[196:199], v1, s[4:7], s16 offen sc1
s_add_u32 s16, s97, 7168
v_mfma_f32_16x16x32_bf16 v[172:175], a[140:143], a[12:15], v[172:175]
s_add_u32 s16, s16, s96
ds_read_b128 a[112:115], v5 offset:36864
v_mfma_f32_16x16x32_bf16 v[172:175], a[136:139], a[8:11], v[172:175]
v_mul_f32 v216, v216, v89
v_mul_f32 v217, v217, v89
v_mfma_f32_16x16x32_bf16 v[196:199], a[136:139], a[16:19], v[196:199]
v_mul_f32 v218, v218, v89
v_mul_f32 v219, v219, v89
v_mfma_f32_16x16x32_bf16 v[196:199], a[140:143], a[20:23], v[196:199]
ds_read_b128 a[116:119], v5 offset:43008
v_cvt_pk_bf16_f32 v213, v214, v215
v_mfma_f32_16x16x32_bf16 v[220:223], a[140:143], a[28:31], v[220:223]
v_cvt_pk_bf16_f32 v214, v216, v217
v_cvt_pk_bf16_f32 v215, v218, v219
v_mfma_f32_16x16x32_bf16 v[220:223], a[136:139], a[24:27], v[220:223]
v_min_u32 v212, -2, v212
v_min_u32 v213, -2, v213
v_mfma_f32_16x16x32_bf16 v[224:227], a[144:147], a[24:27], v[224:227]
v_min_u32 v214, -2, v214
v_min_u32 v215, -2, v215
v_mfma_f32_16x16x32_bf16 v[224:227], a[148:151], a[28:31], v[224:227]
buffer_store_dwordx4 a[200:203], v1, s[4:7], s16 offen sc1
s_add_u32 s16, s97, 2048
v_mfma_f32_16x16x32_bf16 v[200:203], a[148:151], a[20:23], v[200:203]
s_add_u32 s16, s16, s96
buffer_store_dwordx4 v[212:215], v3, s[4:7], s63 offen offset:0 sc1
v_mfma_f32_16x16x32_bf16 v[200:203], a[144:147], a[16:19], v[200:203]
v_mul_f32 v172, v172, v85
v_mul_f32 v173, v173, v85
v_mfma_f32_16x16x32_bf16 v[176:179], a[144:147], a[8:11], v[176:179]
v_cvt_pk_bf16_f32 v172, v172, v173
v_mul_f32 v196, v196, v87
v_mfma_f32_16x16x32_bf16 v[176:179], a[148:151], a[12:15], v[176:179]
v_mul_f32 v197, v197, v87
v_cvt_pk_bf16_f32 v196, v196, v197
v_mfma_f32_16x16x32_bf16 v[152:155], a[148:151], a[4:7], v[152:155]
v_mul_f32 v220, v220, v89
v_mul_f32 v221, v221, v89
v_mfma_f32_16x16x32_bf16 v[152:155], a[144:147], a[0:3], v[152:155]
v_mul_f32 v222, v222, v89
s_waitcnt lgkmcnt(0)
v_mfma_f32_16x16x32_bf16 v[132:135], a[96:99], a[32:35], v[132:135]
ds_read_b128 a[128:131], v5 offset:13312
v_mul_f32 v223, v223, v89
v_mfma_f32_16x16x32_bf16 v[132:135], a[100:103], a[36:39], v[132:135]
buffer_store_dwordx4 a[204:207], v1, s[4:7], s16 offen sc1
s_add_u32 s16, s97, 8192
v_mfma_f32_16x16x32_bf16 v[156:159], a[100:103], a[44:47], v[156:159]
s_add_u32 s16, s16, s96
ds_read_b128 a[132:135], v5 offset:19456
v_mfma_f32_16x16x32_bf16 v[156:159], a[96:99], a[40:43], v[156:159]
v_cvt_pk_bf16_f32 v220, v220, v221
v_mul_f32 v224, v224, v89
v_mfma_f32_16x16x32_bf16 v[180:183], a[96:99], a[48:51], v[180:183]
v_mul_f32 v225, v225, v89
v_mul_f32 v226, v226, v89
v_mfma_f32_16x16x32_bf16 v[180:183], a[100:103], a[52:55], v[180:183]
ds_read_b128 a[136:139], v5 offset:25600
v_mul_f32 v227, v227, v89
v_mfma_f32_16x16x32_bf16 v[204:207], a[100:103], a[60:63], v[204:207]
v_cvt_pk_bf16_f32 v221, v222, v223
v_cvt_pk_bf16_f32 v222, v224, v225
v_mfma_f32_16x16x32_bf16 v[204:207], a[96:99], a[56:59], v[204:207]
v_cvt_pk_bf16_f32 v223, v226, v227
v_min_u32 v220, -2, v220
v_mfma_f32_16x16x32_bf16 v[204:207], a[104:107], a[88:91], v[204:207]
ds_read_b128 a[140:143], v5 offset:31744
v_min_u32 v221, -2, v221
v_mfma_f32_16x16x32_bf16 v[204:207], a[108:111], a[92:95], v[204:207]
buffer_store_dwordx4 a[208:211], v1, s[4:7], s16 offen sc1
v_mfma_f32_16x16x32_bf16 v[180:183], a[108:111], a[84:87], v[180:183]
ds_read_b128 a[144:147], v5 offset:37888
v_min_u32 v222, -2, v222
v_mfma_f32_16x16x32_bf16 v[180:183], a[104:107], a[80:83], v[180:183]
v_min_u32 v223, -2, v223
v_mul_f32 v198, v198, v87
v_mfma_f32_16x16x32_bf16 v[156:159], a[104:107], a[72:75], v[156:159]
buffer_store_dwordx4 v[220:223], v3, s[4:7], s63 offen offset:1024 sc1
v_mfma_f32_16x16x32_bf16 v[156:159], a[108:111], a[76:79], v[156:159]
ds_read_b128 a[148:151], v5 offset:44032
v_mul_f32 v199, v199, v87
v_mfma_f32_16x16x32_bf16 v[132:135], a[108:111], a[68:71], v[132:135]
v_cvt_pk_bf16_f32 v197, v198, v199
v_mul_f32 v200, v200, v87
v_mfma_f32_16x16x32_bf16 v[132:135], a[104:107], a[64:67], v[132:135]
v_mul_f32 v201, v201, v87
v_cvt_pk_bf16_f32 v198, v200, v201
v_mfma_f32_16x16x32_bf16 v[132:135], a[112:115], a[0:3], v[132:135]
v_mul_f32 v202, v202, v87
v_mul_f32 v203, v203, v87
v_mfma_f32_16x16x32_bf16 v[132:135], a[116:119], a[4:7], v[132:135]
buffer_store_dwordx4 v[236:239], v254, s[4:7], s98 offen offset:0 sc1
v_mfma_f32_16x16x32_bf16 v[156:159], a[116:119], a[12:15], v[156:159]
v_cvt_pk_bf16_f32 v199, v202, v203
v_mul_f32 v174, v174, v85
v_mfma_f32_16x16x32_bf16 v[156:159], a[112:115], a[8:11], v[156:159]
v_mul_f32 v175, v175, v85
v_cvt_pk_bf16_f32 v173, v174, v175
v_mfma_f32_16x16x32_bf16 v[180:183], a[112:115], a[16:19], v[180:183]
v_mul_f32 v176, v176, v85
v_mul_f32 v177, v177, v85
v_mfma_f32_16x16x32_bf16 v[180:183], a[116:119], a[20:23], v[180:183]
v_cvt_pk_bf16_f32 v174, v176, v177
v_mul_f32 v178, v178, v85
v_mfma_f32_16x16x32_bf16 v[204:207], a[116:119], a[28:31], v[204:207]
v_mul_f32 v179, v179, v85
v_cvt_pk_bf16_f32 v175, v178, v179
v_mfma_f32_16x16x32_bf16 v[204:207], a[112:115], a[24:27], v[204:207]
s_waitcnt lgkmcnt(0)
s_barrier
v_mfma_f32_16x16x32_bf16 v[208:211], a[128:131], a[56:59], v[208:211]
ds_write_b128 v233, v[212:215] offset:21504
v_cvt_pk_bf16_f32 v132, v132, v133
v_mfma_f32_16x16x32_bf16 v[208:211], a[132:135], a[60:63], v[208:211]
buffer_store_dwordx4 v[240:243], v254, s[4:7], s98 offen offset:2048 sc1
v_mfma_f32_16x16x32_bf16 v[184:187], a[132:135], a[52:55], v[184:187]
ds_write_b64 v232, v[220:221] offset:4096
v_cvt_pk_bf16_f32 v156, v156, v157
v_mfma_f32_16x16x32_bf16 v[184:187], a[128:131], a[48:51], v[184:187]
ds_write_b64 v232, v[222:223] offset:4608
v_cvt_pk_bf16_f32 v133, v134, v135
v_mfma_f32_16x16x32_bf16 v[160:163], a[128:131], a[40:43], v[160:163]
ds_write_b64 v232, v[196:197] offset:3072
v_cvt_pk_bf16_f32 v180, v180, v181
v_mfma_f32_16x16x32_bf16 v[160:163], a[132:135], a[44:47], v[160:163]
ds_write_b64 v232, v[198:199] offset:3584
v_cvt_pk_bf16_f32 v157, v158, v159
v_mfma_f32_16x16x32_bf16 v[136:139], a[132:135], a[36:39], v[136:139]
ds_write_b64 v232, v[172:173] offset:2048
v_cvt_pk_bf16_f32 v204, v204, v205
v_mfma_f32_16x16x32_bf16 v[136:139], a[128:131], a[32:35], v[136:139]
ds_write_b64 v232, v[174:175] offset:2560
v_cvt_pk_bf16_f32 v181, v182, v183
v_mfma_f32_16x16x32_bf16 v[136:139], a[136:139], a[64:67], v[136:139]
v_cvt_pk_bf16_f32 v205, v206, v207
v_mul_f32 v148, v148, v83
v_mfma_f32_16x16x32_bf16 v[136:139], a[140:143], a[68:71], v[136:139]
v_mul_f32 v149, v149, v83
v_cvt_pk_bf16_f32 v148, v148, v149
v_mfma_f32_16x16x32_bf16 v[160:163], a[140:143], a[76:79], v[160:163]
v_mul_f32 v150, v150, v83
v_mul_f32 v151, v151, v83
v_mfma_f32_16x16x32_bf16 v[160:163], a[136:139], a[72:75], v[160:163]
v_cvt_pk_bf16_f32 v149, v150, v151
v_mul_f32 v152, v152, v83
v_mfma_f32_16x16x32_bf16 v[184:187], a[136:139], a[80:83], v[184:187]
ds_write_b64 v232, v[148:149] offset:1024
v_mul_f32 v153, v153, v83
v_mfma_f32_16x16x32_bf16 v[184:187], a[140:143], a[84:87], v[184:187]
buffer_store_dwordx4 v[244:247], v254, s[4:7], s99 offen offset:0 sc1
v_mfma_f32_16x16x32_bf16 v[208:211], a[140:143], a[92:95], v[208:211]
v_cvt_pk_bf16_f32 v150, v152, v153
v_mul_f32 v154, v154, v83
v_mfma_f32_16x16x32_bf16 v[208:211], a[136:139], a[88:91], v[208:211]
v_mul_f32 v155, v155, v83
v_cvt_pk_bf16_f32 v151, v154, v155
v_mfma_f32_16x16x32_bf16 v[208:211], a[144:147], a[24:27], v[208:211]
ds_write_b64 v232, v[150:151] offset:1536
v_mul_f32 v164, v164, v85
v_mfma_f32_16x16x32_bf16 v[208:211], a[148:151], a[28:31], v[208:211]
v_mul_f32 v165, v165, v85
v_cvt_pk_bf16_f32 v164, v164, v165
v_mfma_f32_16x16x32_bf16 v[184:187], a[148:151], a[20:23], v[184:187]
v_mul_f32 v190, v190, v87
v_mul_f32 v191, v191, v87
v_mfma_f32_16x16x32_bf16 v[184:187], a[144:147], a[16:19], v[184:187]
v_cvt_pk_bf16_f32 v189, v190, v191
v_mul_f32 v166, v166, v85
v_mfma_f32_16x16x32_bf16 v[160:163], a[144:147], a[8:11], v[160:163]
v_mul_f32 v167, v167, v85
v_cvt_pk_bf16_f32 v165, v166, v167
v_mfma_f32_16x16x32_bf16 v[160:163], a[148:151], a[12:15], v[160:163]
v_mul_f32 v142, v142, v83
v_mul_f32 v143, v143, v83
v_mfma_f32_16x16x32_bf16 v[136:139], a[148:151], a[4:7], v[136:139]
v_cvt_pk_bf16_f32 v141, v142, v143
v_mul_f32 v192, v192, v87
v_mfma_f32_16x16x32_bf16 v[136:139], a[144:147], a[0:3], v[136:139]
v_mul_f32 v193, v193, v87
v_cvt_pk_bf16_f32 v190, v192, v193
s_add_u32 m0, s19, 32768
s_xor_b32 s44, s84, 0
buffer_load_dwordx4 v1, s[4:7], s44 offen offset:0 sc1 lds
v_pk_mul_f32 v[194:195], v[194:195], v[86:87] op_sel:[0,1] op_sel_hi:[1,1]
v_pk_mul_f32 v[168:169], v[168:169], v[84:85] op_sel:[0,1] op_sel_hi:[1,1]
v_pk_mul_f32 v[170:171], v[170:171], v[84:85] op_sel:[0,1] op_sel_hi:[1,1]
v_pk_mul_f32 v[144:145], v[144:145], v[82:83] op_sel:[0,1] op_sel_hi:[1,1]
v_pk_mul_f32 v[146:147], v[146:147], v[82:83] op_sel:[0,1] op_sel_hi:[1,1]
v_cvt_pk_bf16_f32 v191, v194, v195
v_cvt_pk_bf16_f32 v166, v168, v169
v_cvt_pk_bf16_f32 v167, v170, v171
v_cvt_pk_bf16_f32 v142, v144, v145
v_cvt_pk_bf16_f32 v143, v146, v147
v_cvt_pk_bf16_f32 v134, v136, v137
v_cvt_pk_bf16_f32 v135, v138, v139
v_cvt_pk_bf16_f32 v158, v160, v161
v_cvt_pk_bf16_f32 v159, v162, v163
v_cvt_pk_bf16_f32 v182, v184, v185
v_cvt_pk_bf16_f32 v183, v186, v187
v_cvt_pk_bf16_f32 v206, v208, v209
v_cvt_pk_bf16_f32 v207, v210, v211
buffer_load_dwordx4 v1, s[4:7], s44 offen offset:1024 sc1 lds
buffer_load_dwordx4 v1, s[4:7], s44 offen offset:2048 sc1 lds
buffer_load_dwordx4 v1, s[4:7], s44 offen offset:3072 sc1 lds
s_add_u32 m0, s19, 98304
s_xor_b32 s44, s84, 65536
buffer_load_dwordx4 v1, s[4:7], s44 offen offset:0 sc1 lds
buffer_load_dwordx4 v1, s[4:7], s44 offen offset:1024 sc1 lds
buffer_load_dwordx4 v1, s[4:7], s44 offen offset:2048 sc1 lds
buffer_load_dwordx4 v1, s[4:7], s44 offen offset:3072 sc1 lds
s_waitcnt lgkmcnt(0)
s_barrier
s_add_u32 m0, s19, 114688
s_xor_b32 s44, s84, 81920
buffer_load_dwordx4 v1, s[4:7], s44 offen offset:0 sc1 lds
v_mfma_f32_16x16x32_bf16 v[208:211], v[188:191], v[204:207], v[20:23]
ds_read_b64_tr_b16 a[10:11], v248 offset:3072
v_mfma_f32_16x16x32_bf16 v[224:227], v[212:215], v[204:207], v[24:27]
ds_read_b64_tr_b16 a[12:13], v248 offset:4096
v_mfma_f32_16x16x32_bf16 v[160:163], v[140:143], v[156:159], v[20:23]
ds_read_b64_tr_b16 a[22:23], v248 offset:3584
v_mfma_f32_16x16x32_bf16 v[176:179], v[164:167], v[156:159], v[24:27]
s_nop 3
v_max_f32 v224, v224, v208
v_max_f32 v225, v225, v209
v_max_f32 v226, v226, v210
v_max_f32 v227, v227, v211
v_max3_f32 v239, v224, v225, v226
v_max_f32 v239, v239, v227
ds_read_b64_tr_b16 a[24:25], v248 offset:4608
v_max_f32 v176, v176, v160
v_max_f32 v177, v177, v161
v_max_f32 v178, v178, v162
v_max_f32 v179, v179, v163
v_max3_f32 v237, v176, v177, v178
buffer_load_dwordx4 v1, s[4:7], s44 offen offset:1024 sc1 lds
v_max_f32 v237, v237, v179
ds_read_b64_tr_b16 a[6:7], v248 offset:1024
s_nop 0
v_permlane32_swap_b32 v239, v237
v_max_f32 v239, v239, v237
v_mov_b32 v242, v239
ds_read_b64_tr_b16 a[8:9], v248 offset:2048
s_nop 0
v_permlane16_swap_b32 v239, v242
v_max_f32 v239, v239, v242
v_mov_b32 v242, v239
ds_read_b64_tr_b16 a[18:19], v248 offset:1536
s_nop 0
v_permlane32_swap_b32 v239, v242
v_mul_f32_e64 v89, -v239, v88
v_fma_f32 v224, v224, v88, v89
v_fma_f32 v225, v225, v88, v89
v_fma_f32 v226, v226, v88, v89
v_fma_f32 v227, v227, v88, v89
buffer_load_dwordx4 v[228:231], v9, s[4:7], s55 offen sc1
buffer_load_dwordx4 v[72:75], v9, s[4:7], s55 offen offset:1024 sc1
v_exp_f32 v224, v224
v_exp_f32 v225, v225
v_exp_f32 v226, v226
buffer_load_dwordx4 v1, s[4:7], s44 offen offset:2048 sc1 lds
v_exp_f32 v227, v227
v_cvt_pk_bf16_f32 v224, v224, v225
v_cvt_pk_bf16_f32 v225, v226, v227
ds_read_b64_tr_b16 a[20:21], v248 offset:2560
v_and_b32 v208, v224, v28
v_and_b32 v209, v225, v29
v_and_b32 v210, v224, v30
v_and_b32 v211, v225, v31
v_mul_f32_e64 v85, -v242, v84
v_fma_f32 v176, v176, v84, v85
v_mfma_f32_16x16x32_bf16 v[216:219], v[16:19], v[208:211], 0
v_fma_f32 v177, v177, v84, v85
v_fma_f32 v178, v178, v84, v85
s_waitcnt lgkmcnt(6)
v_mfma_f32_16x16x32_bf16 v[116:119], a[10:13], v[208:211], 0
v_fma_f32 v179, v179, v84, v85
v_exp_f32 v176, v176
s_waitcnt lgkmcnt(4)
v_mfma_f32_16x16x32_bf16 v[120:123], a[22:25], v[208:211], 0
v_exp_f32 v177, v177
v_exp_f32 v178, v178
buffer_load_dwordx4 v1, s[4:7], s44 offen offset:3072 sc1 lds
v_exp_f32 v179, v179
v_rcp_f32 v216, v216
v_cvt_pk_bf16_f32 v176, v176, v177
v_cvt_pk_bf16_f32 v177, v178, v179
v_and_b32 v160, v176, v28
v_and_b32 v161, v177, v29
v_and_b32 v162, v176, v30
v_and_b32 v163, v177, v31
v_pk_mul_f32 v[116:117], v[116:117], v[216:217] op_sel:[0,0] op_sel_hi:[1,0]
v_cvt_pk_bf16_f32 v116, v116, v117
v_pk_mul_f32 v[118:119], v[118:119], v[216:217] op_sel:[0,0] op_sel_hi:[1,0]
v_cvt_pk_bf16_f32 v117, v118, v119
v_pk_mul_f32 v[120:121], v[120:121], v[216:217] op_sel:[0,0] op_sel_hi:[1,0]
v_cvt_pk_bf16_f32 v118, v120, v121
v_pk_mul_f32 v[122:123], v[122:123], v[216:217] op_sel:[0,0] op_sel_hi:[1,0]
v_cvt_pk_bf16_f32 v119, v122, v123
v_mfma_f32_16x16x32_bf16 v[168:171], v[16:19], v[160:163], 0
s_waitcnt lgkmcnt(2)
v_mfma_f32_16x16x32_bf16 v[100:103], a[6:9], v[160:163], 0
s_waitcnt lgkmcnt(0)
v_mfma_f32_16x16x32_bf16 v[104:107], a[18:21], v[160:163], 0
buffer_store_dwordx4 v[116:119], v2, s[4:7], s72 offen offset:3072 sc1
v_mfma_f32_16x16x32_bf16 v[184:187], v[164:167], v[180:183], v[20:23]
s_nop 1
v_rcp_f32 v168, v168
v_mfma_f32_16x16x32_bf16 v[200:203], v[188:191], v[180:183], v[24:27]
v_pk_mul_f32 v[100:101], v[100:101], v[168:169] op_sel:[0,0] op_sel_hi:[1,0]
v_pk_mul_f32 v[102:103], v[102:103], v[168:169] op_sel:[0,0] op_sel_hi:[1,0]
v_cvt_pk_bf16_f32 v100, v100, v101
v_pk_mul_f32 v[104:105], v[104:105], v[168:169] op_sel:[0,0] op_sel_hi:[1,0]
v_pk_mul_f32 v[106:107], v[106:107], v[168:169] op_sel:[0,0] op_sel_hi:[1,0]
v_cvt_pk_bf16_f32 v101, v102, v103
v_cvt_pk_bf16_f32 v102, v104, v105
v_cvt_pk_bf16_f32 v103, v106, v107
v_max_f32 v200, v200, v184
v_max_f32 v201, v201, v185
v_max_f32 v202, v202, v186
buffer_store_dwordx4 v[100:103], v2, s[4:7], s72 offen offset:1024 sc1
v_max_f32 v203, v203, v187
v_max3_f32 v238, v200, v201, v202
v_max_f32 v238, v238, v203
s_cmp_lg_u32 s28, 0
s_cbranch_scc1 Lhx_8
s_waitcnt vmcnt(5)
v_max3_u32 v244, v228, v229, v230
s_waitcnt vmcnt(4)
v_max3_u32 v244, v244, v231, v72
v_max3_u32 v244, v244, v73, v74
v_max_u32 v244, v244, v75
v_cmp_eq_u32 vcc, -1, v244
s_cbranch_vccnz L_hxredo0
L_hxback0:
ds_write_b128 v233, v[228:231] offset:20480
ds_write_b64 v232, v[72:73] offset:0
ds_write_b64 v232, v[74:75] offset:512
Lhx_8:
ds_read_b128 a[0:3], v233 offset:20480
v_mfma_f32_16x16x32_bf16 v[152:155], v[140:143], v[132:135], v[24:27]
ds_read_b64_tr_b16 a[4:5], v248 offset:0
ds_read_b64_tr_b16 a[16:17], v248 offset:512
s_waitcnt lgkmcnt(2)
v_mfma_f32_16x16x32_bf16 v[136:139], a[0:3], v[132:135], v[76:79]
s_nop 7
v_max_f32 v152, v152, v136
v_max_f32 v153, v153, v137
v_max_f32 v154, v154, v138
v_max_f32 v155, v155, v139
v_max3_f32 v236, v152, v153, v154
v_max_f32 v236, v236, v155
s_nop 1
v_permlane32_swap_b32 v238, v236
v_max_f32 v238, v238, v236
v_mov_b32 v243, v238
s_nop 1
v_permlane16_swap_b32 v238, v243
v_max_f32 v238, v238, v243
v_mov_b32 v243, v238
s_nop 1
v_permlane32_swap_b32 v238, v243
v_mul_f32_e64 v87, -v238, v86
v_fma_f32 v200, v200, v86, v87
v_fma_f32 v201, v201, v86, v87
v_fma_f32 v202, v202, v86, v87
v_fma_f32 v203, v203, v86, v87
v_exp_f32 v200, v200
v_exp_f32 v201, v201
v_exp_f32 v202, v202
v_exp_f32 v203, v203
v_cvt_pk_bf16_f32 v200, v200, v201
v_cvt_pk_bf16_f32 v201, v202, v203
v_and_b32 v184, v200, v28
v_and_b32 v185, v201, v29
v_and_b32 v186, v200, v30
v_and_b32 v187, v201, v31
v_mul_f32_e64 v83, -v243, v82
v_fma_f32 v152, v152, v82, v83
v_mfma_f32_16x16x32_bf16 v[192:195], v[16:19], v[184:187], 0
v_fma_f32 v153, v153, v82, v83
v_fma_f32 v154, v154, v82, v83
v_mfma_f32_16x16x32_bf16 v[108:111], a[8:11], v[184:187], 0
v_fma_f32 v155, v155, v82, v83
v_exp_f32 v152, v152
v_mfma_f32_16x16x32_bf16 v[112:115], a[20:23], v[184:187], 0
v_exp_f32 v153, v153
v_exp_f32 v154, v154
v_exp_f32 v155, v155
v_rcp_f32 v192, v192
v_cvt_pk_bf16_f32 v152, v152, v153
v_cvt_pk_bf16_f32 v153, v154, v155
v_and_b32 v136, v152, v80
v_and_b32 v137, v153, v81
v_and_b32 v138, v152, v30
v_and_b32 v139, v153, v31
v_pk_mul_f32 v[108:109], v[108:109], v[192:193] op_sel:[0,0] op_sel_hi:[1,0]
v_pk_mul_f32 v[110:111], v[110:111], v[192:193] op_sel:[0,0] op_sel_hi:[1,0]
v_cvt_pk_bf16_f32 v108, v108, v109
v_pk_mul_f32 v[112:113], v[112:113], v[192:193] op_sel:[0,0] op_sel_hi:[1,0]
v_cvt_pk_bf16_f32 v109, v110, v111
v_pk_mul_f32 v[114:115], v[114:115], v[192:193] op_sel:[0,0] op_sel_hi:[1,0]
v_cvt_pk_bf16_f32 v110, v112, v113
v_mfma_f32_16x16x32_bf16 v[144:147], v[16:19], v[136:139], 0
v_cvt_pk_bf16_f32 v111, v114, v115
buffer_store_dwordx4 v[108:111], v2, s[4:7], s72 offen offset:2048 sc1
s_waitcnt lgkmcnt(1)
v_mfma_f32_16x16x32_bf16 v[92:95], a[4:7], v[136:139], 0
s_nop 3
v_rcp_f32 v144, v144
s_waitcnt lgkmcnt(0)
v_mfma_f32_16x16x32_bf16 v[96:99], a[16:19], v[136:139], 0
s_nop 0
v_pk_mul_f32 v[92:93], v[92:93], v[144:145] op_sel:[0,0] op_sel_hi:[1,0]
v_pk_mul_f32 v[94:95], v[94:95], v[144:145] op_sel:[0,0] op_sel_hi:[1,0]
v_cvt_pk_bf16_f32 v92, v92, v93
v_cvt_pk_bf16_f32 v93, v94, v95
s_nop 2
v_pk_mul_f32 v[96:97], v[96:97], v[144:145] op_sel:[0,0] op_sel_hi:[1,0]
v_pk_mul_f32 v[98:99], v[98:99], v[144:145] op_sel:[0,0] op_sel_hi:[1,0]
v_cvt_pk_bf16_f32 v94, v96, v97
v_cvt_pk_bf16_f32 v95, v98, v99
buffer_store_dwordx4 v[92:95], v2, s[4:7], s72 offen offset:0 sc1
s_add_u32 s92, s71, 0x0
v_accvgpr_write_b32 a188, v48
v_accvgpr_write_b32 a189, v49
v_accvgpr_write_b32 a190, v50
v_accvgpr_write_b32 a191, v51
v_accvgpr_write_b32 a192, v52
v_accvgpr_write_b32 a193, v53
v_accvgpr_write_b32 a194, v54
v_accvgpr_write_b32 a195, v55
v_accvgpr_write_b32 a196, v56
v_accvgpr_write_b32 a197, v57
v_accvgpr_write_b32 a198, v58
v_accvgpr_write_b32 a199, v59
v_accvgpr_write_b32 a200, v60
v_accvgpr_write_b32 a201, v61
v_accvgpr_write_b32 a202, v62
v_accvgpr_write_b32 a203, v63
v_accvgpr_write_b32 a204, v64
v_accvgpr_write_b32 a205, v65
v_accvgpr_write_b32 a206, v66
v_accvgpr_write_b32 a207, v67
v_accvgpr_write_b32 a208, v68
v_accvgpr_write_b32 a209, v69
v_accvgpr_write_b32 a210, v70
v_accvgpr_write_b32 a211, v71
s_add_u32 s40, s4, 0x800000
s_addc_u32 s41, s5, 0
v_add_u32 v5, 32768, v1
v_add_u32 v6, 98304, v1
s_mov_b32 s35, s77
v_lshlrev_b32 v132, 16, v32
v_and_b32 v133, 0xffff0000, v32
v_lshlrev_b32 v134, 16, v33
v_and_b32 v135, 0xffff0000, v33
v_lshlrev_b32 v136, 16, v34
v_and_b32 v137, 0xffff0000, v34
v_lshlrev_b32 v138, 16, v35
v_and_b32 v139, 0xffff0000, v35
v_lshlrev_b32 v140, 16, v36
v_and_b32 v141, 0xffff0000, v36
v_lshlrev_b32 v142, 16, v37
v_and_b32 v143, 0xffff0000, v37
v_lshlrev_b32 v144, 16, v38
v_and_b32 v145, 0xffff0000, v38
v_lshlrev_b32 v146, 16, v39
v_and_b32 v147, 0xffff0000, v39
v_lshlrev_b32 v148, 16, v40
v_and_b32 v149, 0xffff0000, v40
v_lshlrev_b32 v150, 16, v41
v_and_b32 v151, 0xffff0000, v41
v_lshlrev_b32 v152, 16, v42
v_and_b32 v153, 0xffff0000, v42
v_lshlrev_b32 v154, 16, v43
v_and_b32 v155, 0xffff0000, v43
v_lshlrev_b32 v156, 16, v44
v_and_b32 v157, 0xffff0000, v44
v_lshlrev_b32 v158, 16, v45
v_and_b32 v159, 0xffff0000, v45
v_lshlrev_b32 v160, 16, v46
v_and_b32 v161, 0xffff0000, v46
v_lshlrev_b32 v162, 16, v47
v_and_b32 v163, 0xffff0000, v47
s_waitcnt vmcnt(0)
s_barrier
s_cmp_lg_u32 s28, 0
s_cbranch_scc1 Lsg_9
buffer_atomic_add v12, v10, s[4:7], s92 offen sc1
buffer_atomic_swap v15, v14, s[4:7], s8 offen sc1
buffer_atomic_swap v15, v252, s[4:7], s62 offen offset:64 sc1
Lsg_9:
s_add_u32 m0, s19, 131072
s_xor_b32 s44, s84, 98304
buffer_load_dwordx4 v1, s[4:7], s44 offen offset:0 sc1 lds
buffer_load_dwordx4 v1, s[4:7], s44 offen offset:1024 sc1 lds
buffer_load_dwordx4 v1, s[4:7], s44 offen offset:2048 sc1 lds
buffer_load_dwordx4 v1, s[4:7], s44 offen offset:3072 sc1 lds
s_add_u32 m0, s19, 147456
s_xor_b32 s44, s84, 114688
buffer_load_dwordx4 v1, s[4:7], s44 offen offset:0 sc1 lds
buffer_load_dwordx4 v1, s[4:7], s44 offen offset:1024 sc1 lds
buffer_load_dwordx4 v1, s[4:7], s44 offen offset:2048 sc1 lds
buffer_load_dwordx4 v1, s[4:7], s44 offen offset:3072 sc1 lds
s_mov_b64 exec, 0
s_cmp_eq_u32 s28, 3
s_cbranch_scc1 L_stub3
s_cmp_eq_u32 s28, 2
s_cbranch_scc1 L_stub4
s_cmp_eq_u32 s28, 0
s_cbranch_scc1 L_stub8
L_wret1:
s_mov_b64 exec, -1
s_cmp_lg_u32 s28, 1
s_cbranch_scc1 Lpo_12
s_add_u32 s36, s11, 0x0
s_mov_b32 s37, 0
v_mov_b32 v11, 0
buffer_atomic_add v11, v251, s[4:7], s36 offen sc0 sc1
s_sleep 4
Lpoll_10:
v_mov_b32 v234, 0
buffer_atomic_add v234, v251, s[4:7], s36 offen sc0 sc1
s_waitcnt vmcnt(1)
v_readfirstlane_b32 s38, v11
s_nop 0
s_cmp_ge_u32 s38, 32
s_cbranch_scc1 Lpe_11
v_mov_b32 v11, 0
buffer_atomic_add v11, v251, s[4:7], s36 offen sc0 sc1
s_waitcnt vmcnt(1)
v_readfirstlane_b32 s38, v234
s_nop 0
s_cmp_ge_u32 s38, 32
s_cbranch_scc1 Lpe_11
s_add_u32 s37, s37, 1
s_cmp_lt_u32 s37, 0x80000
s_cbranch_scc1 Lpoll_10
s_waitcnt vmcnt(0)
Lpo_12:
s_waitcnt vmcnt(0)
Lpe_11:
s_barrier
L_k2go0:
buffer_load_dwordx4 a[0:3], v4, s[40:43], s35 offen offset:0 sc1
buffer_load_dwordx4 a[4:7], v4, s[40:43], s35 offen offset:1024 sc1
s_xor_b32 s35, s77, 4096
buffer_load_dwordx4 a[8:11], v4, s[40:43], s35 offen offset:0 sc1
buffer_load_dwordx4 a[12:15], v4, s[40:43], s35 offen offset:1024 sc1
s_xor_b32 s35, s77, 16384
buffer_load_dwordx4 a[16:19], v4, s[40:43], s35 offen offset:0 sc1
buffer_load_dwordx4 a[20:23], v4, s[40:43], s35 offen offset:1024 sc1
s_xor_b32 s35, s77, 20480
buffer_load_dwordx4 a[24:27], v4, s[40:43], s35 offen offset:0 sc1
buffer_load_dwordx4 a[28:31], v4, s[40:43], s35 offen offset:1024 sc1
s_xor_b32 s35, s77, 32768
buffer_load_dwordx4 a[32:35], v4, s[40:43], s35 offen offset:0 sc1
buffer_load_dwordx4 a[36:39], v4, s[40:43], s35 offen offset:1024 sc1
s_xor_b32 s35, s77, 36864
buffer_load_dwordx4 a[40:43], v4, s[40:43], s35 offen offset:0 sc1
buffer_load_dwordx4 a[44:47], v4, s[40:43], s35 offen offset:1024 sc1
s_xor_b32 s35, s77, 49152
ds_read_b128 a[96:99], v5 offset:0
ds_read_b128 a[100:103], v5 offset:1024
ds_read_b128 a[104:107], v5 offset:2048
ds_read_b128 a[108:111], v5 offset:3072
ds_read_b128 a[112:115], v5 offset:4096
ds_read_b128 a[116:119], v5 offset:5120
ds_read_b128 a[120:123], v5 offset:6144
ds_read_b128 a[124:127], v5 offset:7168
s_waitcnt vmcnt(10) lgkmcnt(4)
v_mfma_f32_16x16x32_bf16 v[132:135], a[96:99], a[0:3], v[132:135]
ds_read_b128 a[128:131], v5 offset:8192
v_mfma_f32_16x16x32_bf16 v[148:151], a[96:99], a[4:7], v[148:151]
ds_read_b128 a[132:135], v5 offset:9216
v_mfma_f32_16x16x32_bf16 v[152:155], a[100:103], a[4:7], v[152:155]
buffer_load_dwordx4 a[48:51], v4, s[40:43], s35 offen offset:0 sc1
v_mfma_f32_16x16x32_bf16 v[136:139], a[100:103], a[0:3], v[136:139]
ds_read_b128 a[136:139], v5 offset:10240
v_mfma_f32_16x16x32_bf16 v[140:143], a[104:107], a[0:3], v[140:143]
ds_read_b128 a[140:143], v5 offset:11264
v_mfma_f32_16x16x32_bf16 v[156:159], a[104:107], a[4:7], v[156:159]
v_mfma_f32_16x16x32_bf16 v[160:163], a[108:111], a[4:7], v[160:163]
buffer_load_dwordx4 a[52:55], v4, s[40:43], s35 offen offset:1024 sc1
s_xor_b32 s35, s77, 53248
v_mfma_f32_16x16x32_bf16 v[144:147], a[108:111], a[0:3], v[144:147]
s_waitcnt vmcnt(10) lgkmcnt(4)
v_mfma_f32_16x16x32_bf16 v[132:135], a[112:115], a[8:11], v[132:135]
ds_read_b128 a[96:99], v5 offset:12288
v_mfma_f32_16x16x32_bf16 v[148:151], a[112:115], a[12:15], v[148:151]
L_stub3:
s_cbranch_execz L_wret1
ds_read_b128 a[100:103], v5 offset:13312
v_mfma_f32_16x16x32_bf16 v[152:155], a[116:119], a[12:15], v[152:155]
buffer_load_dwordx4 a[0:3], v4, s[40:43], s35 offen offset:0 sc1
v_mfma_f32_16x16x32_bf16 v[136:139], a[116:119], a[8:11], v[136:139]
ds_read_b128 a[104:107], v5 offset:14336
v_mfma_f32_16x16x32_bf16 v[140:143], a[120:123], a[8:11], v[140:143]
ds_read_b128 a[108:111], v5 offset:15360
v_mfma_f32_16x16x32_bf16 v[156:159], a[120:123], a[12:15], v[156:159]
v_mfma_f32_16x16x32_bf16 v[160:163], a[124:127], a[12:15], v[160:163]
buffer_load_dwordx4 a[4:7], v4, s[40:43], s35 offen offset:1024 sc1
s_xor_b32 s35, s77, 65536
v_mfma_f32_16x16x32_bf16 v[144:147], a[124:127], a[8:11], v[144:147]
s_waitcnt vmcnt(10) lgkmcnt(4)
v_mfma_f32_16x16x32_bf16 v[132:135], a[128:131], a[16:19], v[132:135]
ds_read_b128 a[112:115], v5 offset:16384
v_mfma_f32_16x16x32_bf16 v[148:151], a[128:131], a[20:23], v[148:151]
ds_read_b128 a[116:119], v5 offset:17408
v_mfma_f32_16x16x32_bf16 v[152:155], a[132:135], a[20:23], v[152:155]
buffer_load_dwordx4 a[8:11], v4, s[40:43], s35 offen offset:0 sc1
v_mfma_f32_16x16x32_bf16 v[136:139], a[132:135], a[16:19], v[136:139]
ds_read_b128 a[120:123], v5 offset:18432
v_mfma_f32_16x16x32_bf16 v[140:143], a[136:139], a[16:19], v[140:143]
ds_read_b128 a[124:127], v5 offset:19456
v_mfma_f32_16x16x32_bf16 v[156:159], a[136:139], a[20:23], v[156:159]
v_mfma_f32_16x16x32_bf16 v[160:163], a[140:143], a[20:23], v[160:163]
buffer_load_dwordx4 a[12:15], v4, s[40:43], s35 offen offset:1024 sc1
s_xor_b32 s35, s77, 69632
v_mfma_f32_16x16x32_bf16 v[144:147], a[140:143], a[16:19], v[144:147]
s_waitcnt vmcnt(10) lgkmcnt(4)
v_mfma_f32_16x16x32_bf16 v[132:135], a[96:99], a[24:27], v[132:135]
ds_read_b128 a[128:131], v5 offset:20480
v_mfma_f32_16x16x32_bf16 v[148:151], a[96:99], a[28:31], v[148:151]
ds_read_b128 a[132:135], v5 offset:21504
v_mfma_f32_16x16x32_bf16 v[152:155], a[100:103], a[28:31], v[152:155]
buffer_load_dwordx4 a[16:19], v4, s[40:43], s35 offen offset:0 sc1
v_mfma_f32_16x16x32_bf16 v[136:139], a[100:103], a[24:27], v[136:139]
ds_read_b128 a[136:139], v5 offset:22528
v_mfma_f32_16x16x32_bf16 v[140:143], a[104:107], a[24:27], v[140:143]
ds_read_b128 a[140:143], v5 offset:23552
v_mfma_f32_16x16x32_bf16 v[156:159], a[104:107], a[28:31], v[156:159]
v_mfma_f32_16x16x32_bf16 v[160:163], a[108:111], a[28:31], v[160:163]
buffer_load_dwordx4 a[20:23], v4, s[40:43], s35 offen offset:1024 sc1
s_xor_b32 s35, s77, 81920
v_mfma_f32_16x16x32_bf16 v[144:147], a[108:111], a[24:27], v[144:147]
s_waitcnt vmcnt(10) lgkmcnt(4)
v_mfma_f32_16x16x32_bf16 v[132:135], a[112:115], a[32:35], v[132:135]
ds_read_b128 a[96:99], v5 offset:24576
v_mfma_f32_16x16x32_bf16 v[148:151], a[112:115], a[36:39], v[148:151]
ds_read_b128 a[100:103], v5 offset:25600
v_mfma_f32_16x16x32_bf16 v[152:155], a[116:119], a[36:39], v[152:155]
buffer_load_dwordx4 a[24:27], v4, s[40:43], s35 offen offset:0 sc1
v_mfma_f32_16x16x32_bf16 v[136:139], a[116:119], a[32:35], v[136:139]
ds_read_b128 a[104:107], v5 offset:26624
v_mfma_f32_16x16x32_bf16 v[140:143], a[120:123], a[32:35], v[140:143]
ds_read_b128 a[108:111], v5 offset:27648
v_mfma_f32_16x16x32_bf16 v[156:159], a[120:123], a[36:39], v[156:159]
v_mfma_f32_16x16x32_bf16 v[160:163], a[124:127], a[36:39], v[160:163]
buffer_load_dwordx4 a[28:31], v4, s[40:43], s35 offen offset:1024 sc1
s_xor_b32 s35, s77, 86016
v_mfma_f32_16x16x32_bf16 v[144:147], a[124:127], a[32:35], v[144:147]
s_waitcnt vmcnt(10) lgkmcnt(4)
v_mfma_f32_16x16x32_bf16 v[132:135], a[128:131], a[40:43], v[132:135]
ds_read_b128 a[112:115], v5 offset:28672
v_mfma_f32_16x16x32_bf16 v[148:151], a[128:131], a[44:47], v[148:151]
ds_read_b128 a[116:119], v5 offset:29696
v_mfma_f32_16x16x32_bf16 v[152:155], a[132:135], a[44:47], v[152:155]
buffer_load_dwordx4 a[32:35], v4, s[40:43], s35 offen offset:0 sc1
v_mfma_f32_16x16x32_bf16 v[136:139], a[132:135], a[40:43], v[136:139]
ds_read_b128 a[120:123], v5 offset:30720
v_mfma_f32_16x16x32_bf16 v[140:143], a[136:139], a[40:43], v[140:143]
ds_read_b128 a[124:127], v5 offset:31744
v_mfma_f32_16x16x32_bf16 v[156:159], a[136:139], a[44:47], v[156:159]
v_mfma_f32_16x16x32_bf16 v[160:163], a[140:143], a[44:47], v[160:163]
buffer_load_dwordx4 a[36:39], v4, s[40:43], s35 offen offset:1024 sc1
s_xor_b32 s35, s77, 98304
v_mfma_f32_16x16x32_bf16 v[144:147], a[140:143], a[40:43], v[144:147]
s_waitcnt vmcnt(10) lgkmcnt(4)
v_mfma_f32_16x16x32_bf16 v[132:135], a[96:99], a[48:51], v[132:135]
ds_read_b128 a[128:131], v5 offset:32768
v_mfma_f32_16x16x32_bf16 v[148:151], a[96:99], a[52:55], v[148:151]
ds_read_b128 a[132:135], v5 offset:33792
v_mfma_f32_16x16x32_bf16 v[152:155], a[100:103], a[52:55], v[152:155]
buffer_load_dwordx4 a[40:43], v4, s[40:43], s35 offen offset:0 sc1
v_mfma_f32_16x16x32_bf16 v[136:139], a[100:103], a[48:51], v[136:139]
ds_read_b128 a[136:139], v5 offset:34816
v_mfma_f32_16x16x32_bf16 v[140:143], a[104:107], a[48:51], v[140:143]
ds_read_b128 a[140:143], v5 offset:35840
v_mfma_f32_16x16x32_bf16 v[156:159], a[104:107], a[52:55], v[156:159]
v_mfma_f32_16x16x32_bf16 v[160:163], a[108:111], a[52:55], v[160:163]
buffer_load_dwordx4 a[44:47], v4, s[40:43], s35 offen offset:1024 sc1
s_xor_b32 s35, s77, 102400
v_mfma_f32_16x16x32_bf16 v[144:147], a[108:111], a[48:51], v[144:147]
s_waitcnt vmcnt(10) lgkmcnt(4)
v_mfma_f32_16x16x32_bf16 v[132:135], a[112:115], a[0:3], v[132:135]
ds_read_b128 a[96:99], v5 offset:36864
v_mfma_f32_16x16x32_bf16 v[148:151], a[112:115], a[4:7], v[148:151]
ds_read_b128 a[100:103], v5 offset:37888
v_mfma_f32_16x16x32_bf16 v[152:155], a[116:119], a[4:7], v[152:155]
buffer_load_dwordx4 a[48:51], v4, s[40:43], s35 offen offset:0 sc1
v_mfma_f32_16x16x32_bf16 v[136:139], a[116:119], a[0:3], v[136:139]
ds_read_b128 a[104:107], v5 offset:38912
v_mfma_f32_16x16x32_bf16 v[140:143], a[120:123], a[0:3], v[140:143]
ds_read_b128 a[108:111], v5 offset:39936
v_mfma_f32_16x16x32_bf16 v[156:159], a[120:123], a[4:7], v[156:159]
v_mfma_f32_16x16x32_bf16 v[160:163], a[124:127], a[4:7], v[160:163]
buffer_load_dwordx4 a[52:55], v4, s[40:43], s35 offen offset:1024 sc1
s_xor_b32 s35, s77, 114688
v_mfma_f32_16x16x32_bf16 v[144:147], a[124:127], a[0:3], v[144:147]
s_waitcnt vmcnt(10) lgkmcnt(4)
v_mfma_f32_16x16x32_bf16 v[132:135], a[128:131], a[8:11], v[132:135]
ds_read_b128 a[112:115], v5 offset:40960
v_mfma_f32_16x16x32_bf16 v[148:151], a[128:131], a[12:15], v[148:151]
ds_read_b128 a[116:119], v5 offset:41984
v_mfma_f32_16x16x32_bf16 v[152:155], a[132:135], a[12:15], v[152:155]
buffer_load_dwordx4 a[0:3], v4, s[40:43], s35 offen offset:0 sc1
v_mfma_f32_16x16x32_bf16 v[136:139], a[132:135], a[8:11], v[136:139]
ds_read_b128 a[120:123], v5 offset:43008
v_mfma_f32_16x16x32_bf16 v[140:143], a[136:139], a[8:11], v[140:143]
ds_read_b128 a[124:127], v5 offset:44032
v_mfma_f32_16x16x32_bf16 v[156:159], a[136:139], a[12:15], v[156:159]
v_mfma_f32_16x16x32_bf16 v[160:163], a[140:143], a[12:15], v[160:163]
buffer_load_dwordx4 a[4:7], v4, s[40:43], s35 offen offset:1024 sc1
s_xor_b32 s35, s77, 118784
v_mfma_f32_16x16x32_bf16 v[144:147], a[140:143], a[8:11], v[144:147]
s_waitcnt vmcnt(10) lgkmcnt(4)
v_mfma_f32_16x16x32_bf16 v[132:135], a[96:99], a[16:19], v[132:135]
ds_read_b128 a[128:131], v5 offset:45056
v_mfma_f32_16x16x32_bf16 v[148:151], a[96:99], a[20:23], v[148:151]
ds_read_b128 a[132:135], v5 offset:46080
v_mfma_f32_16x16x32_bf16 v[152:155], a[100:103], a[20:23], v[152:155]
buffer_load_dwordx4 a[8:11], v4, s[40:43], s35 offen offset:0 sc1
v_mfma_f32_16x16x32_bf16 v[136:139], a[100:103], a[16:19], v[136:139]
ds_read_b128 a[136:139], v5 offset:47104
v_mfma_f32_16x16x32_bf16 v[140:143], a[104:107], a[16:19], v[140:143]
ds_read_b128 a[140:143], v5 offset:48128
v_mfma_f32_16x16x32_bf16 v[156:159], a[104:107], a[20:23], v[156:159]
v_mfma_f32_16x16x32_bf16 v[160:163], a[108:111], a[20:23], v[160:163]
buffer_load_dwordx4 a[12:15], v4, s[40:43], s35 offen offset:1024 sc1
s_xor_b32 s35, s77, 524288
v_mfma_f32_16x16x32_bf16 v[144:147], a[108:111], a[16:19], v[144:147]
s_waitcnt vmcnt(10) lgkmcnt(4)
v_mfma_f32_16x16x32_bf16 v[132:135], a[112:115], a[24:27], v[132:135]
ds_read_b128 a[96:99], v5 offset:49152
v_mfma_f32_16x16x32_bf16 v[148:151], a[112:115], a[28:31], v[148:151]
ds_read_b128 a[100:103], v5 offset:50176
v_mfma_f32_16x16x32_bf16 v[152:155], a[116:119], a[28:31], v[152:155]
buffer_load_dwordx4 a[16:19], v4, s[40:43], s35 offen offset:0 sc1
v_mfma_f32_16x16x32_bf16 v[136:139], a[116:119], a[24:27], v[136:139]
ds_read_b128 a[104:107], v5 offset:51200
v_mfma_f32_16x16x32_bf16 v[140:143], a[120:123], a[24:27], v[140:143]
ds_read_b128 a[108:111], v5 offset:52224
v_mfma_f32_16x16x32_bf16 v[156:159], a[120:123], a[28:31], v[156:159]
v_mfma_f32_16x16x32_bf16 v[160:163], a[124:127], a[28:31], v[160:163]
buffer_load_dwordx4 a[20:23], v4, s[40:43], s35 offen offset:1024 sc1
s_xor_b32 s35, s77, 528384
v_mfma_f32_16x16x32_bf16 v[144:147], a[124:127], a[24:27], v[144:147]
s_waitcnt vmcnt(10) lgkmcnt(4)
v_mfma_f32_16x16x32_bf16 v[132:135], a[128:131], a[32:35], v[132:135]
ds_read_b128 a[112:115], v5 offset:53248
v_mfma_f32_16x16x32_bf16 v[148:151], a[128:131], a[36:39], v[148:151]
ds_read_b128 a[116:119], v5 offset:54272
v_mfma_f32_16x16x32_bf16 v[152:155], a[132:135], a[36:39], v[152:155]
buffer_load_dwordx4 a[24:27], v4, s[40:43], s35 offen offset:0 sc1
v_mfma_f32_16x16x32_bf16 v[136:139], a[132:135], a[32:35], v[136:139]
ds_read_b128 a[120:123], v5 offset:55296
v_mfma_f32_16x16x32_bf16 v[140:143], a[136:139], a[32:35], v[140:143]
ds_read_b128 a[124:127], v5 offset:56320
v_mfma_f32_16x16x32_bf16 v[156:159], a[136:139], a[36:39], v[156:159]
v_mfma_f32_16x16x32_bf16 v[160:163], a[140:143], a[36:39], v[160:163]
buffer_load_dwordx4 a[28:31], v4, s[40:43], s35 offen offset:1024 sc1
s_xor_b32 s35, s77, 540672
v_mfma_f32_16x16x32_bf16 v[144:147], a[140:143], a[32:35], v[144:147]
s_waitcnt vmcnt(10) lgkmcnt(4)
v_mfma_f32_16x16x32_bf16 v[132:135], a[96:99], a[40:43], v[132:135]
ds_read_b128 a[128:131], v5 offset:57344
v_mfma_f32_16x16x32_bf16 v[148:151], a[96:99], a[44:47], v[148:151]
ds_read_b128 a[132:135], v5 offset:58368
v_mfma_f32_16x16x32_bf16 v[152:155], a[100:103], a[44:47], v[152:155]
buffer_load_dwordx4 a[32:35], v4, s[40:43], s35 offen offset:0 sc1
v_mfma_f32_16x16x32_bf16 v[136:139], a[100:103], a[40:43], v[136:139]
ds_read_b128 a[136:139], v5 offset:59392
v_mfma_f32_16x16x32_bf16 v[140:143], a[104:107], a[40:43], v[140:143]
ds_read_b128 a[140:143], v5 offset:60416
v_mfma_f32_16x16x32_bf16 v[156:159], a[104:107], a[44:47], v[156:159]
v_mfma_f32_16x16x32_bf16 v[160:163], a[108:111], a[44:47], v[160:163]
buffer_load_dwordx4 a[36:39], v4, s[40:43], s35 offen offset:1024 sc1
s_xor_b32 s35, s77, 544768
v_mfma_f32_16x16x32_bf16 v[144:147], a[108:111], a[40:43], v[144:147]
s_waitcnt vmcnt(10) lgkmcnt(4)
v_mfma_f32_16x16x32_bf16 v[132:135], a[112:115], a[48:51], v[132:135]
ds_read_b128 a[96:99], v5 offset:61440
v_mfma_f32_16x16x32_bf16 v[148:151], a[112:115], a[52:55], v[148:151]
ds_read_b128 a[100:103], v5 offset:62464
v_mfma_f32_16x16x32_bf16 v[152:155], a[116:119], a[52:55], v[152:155]
buffer_load_dwordx4 a[40:43], v4, s[40:43], s35 offen offset:0 sc1
v_mfma_f32_16x16x32_bf16 v[136:139], a[116:119], a[48:51], v[136:139]
ds_read_b128 a[104:107], v5 offset:63488
v_mfma_f32_16x16x32_bf16 v[140:143], a[120:123], a[48:51], v[140:143]
ds_read_b128 a[108:111], v5 offset:64512
v_mfma_f32_16x16x32_bf16 v[156:159], a[120:123], a[52:55], v[156:159]
v_mfma_f32_16x16x32_bf16 v[160:163], a[124:127], a[52:55], v[160:163]
buffer_load_dwordx4 a[44:47], v4, s[40:43], s35 offen offset:1024 sc1
s_xor_b32 s35, s77, 557056
v_mfma_f32_16x16x32_bf16 v[144:147], a[124:127], a[48:51], v[144:147]
s_waitcnt vmcnt(10) lgkmcnt(4)
v_mfma_f32_16x16x32_bf16 v[132:135], a[128:131], a[0:3], v[132:135]
ds_read_b128 a[112:115], v6 offset:0
v_mfma_f32_16x16x32_bf16 v[148:151], a[128:131], a[4:7], v[148:151]
ds_read_b128 a[116:119], v6 offset:1024
v_mfma_f32_16x16x32_bf16 v[152:155], a[132:135], a[4:7], v[152:155]
buffer_load_dwordx4 a[48:51], v4, s[40:43], s35 offen offset:0 sc1
v_mfma_f32_16x16x32_bf16 v[136:139], a[132:135], a[0:3], v[136:139]
ds_read_b128 a[120:123], v6 offset:2048
v_mfma_f32_16x16x32_bf16 v[140:143], a[136:139], a[0:3], v[140:143]
ds_read_b128 a[124:127], v6 offset:3072
v_mfma_f32_16x16x32_bf16 v[156:159], a[136:139], a[4:7], v[156:159]
v_mfma_f32_16x16x32_bf16 v[160:163], a[140:143], a[4:7], v[160:163]
buffer_load_dwordx4 a[52:55], v4, s[40:43], s35 offen offset:1024 sc1
s_xor_b32 s35, s77, 561152
v_mfma_f32_16x16x32_bf16 v[144:147], a[140:143], a[0:3], v[144:147]
s_waitcnt vmcnt(10) lgkmcnt(4)
v_mfma_f32_16x16x32_bf16 v[132:135], a[96:99], a[8:11], v[132:135]
ds_read_b128 a[128:131], v6 offset:4096
v_mfma_f32_16x16x32_bf16 v[148:151], a[96:99], a[12:15], v[148:151]
ds_read_b128 a[132:135], v6 offset:5120
v_mfma_f32_16x16x32_bf16 v[152:155], a[100:103], a[12:15], v[152:155]
buffer_load_dwordx4 a[0:3], v4, s[40:43], s35 offen offset:0 sc1
v_mfma_f32_16x16x32_bf16 v[136:139], a[100:103], a[8:11], v[136:139]
ds_read_b128 a[136:139], v6 offset:6144
v_mfma_f32_16x16x32_bf16 v[140:143], a[104:107], a[8:11], v[140:143]
ds_read_b128 a[140:143], v6 offset:7168
v_mfma_f32_16x16x32_bf16 v[156:159], a[104:107], a[12:15], v[156:159]
v_mfma_f32_16x16x32_bf16 v[160:163], a[108:111], a[12:15], v[160:163]
buffer_load_dwordx4 a[4:7], v4, s[40:43], s35 offen offset:1024 sc1
s_xor_b32 s35, s77, 573440
v_mfma_f32_16x16x32_bf16 v[144:147], a[108:111], a[8:11], v[144:147]
s_waitcnt vmcnt(10) lgkmcnt(4)
v_mfma_f32_16x16x32_bf16 v[132:135], a[112:115], a[16:19], v[132:135]
ds_read_b128 a[96:99], v6 offset:8192
v_mfma_f32_16x16x32_bf16 v[148:151], a[112:115], a[20:23], v[148:151]
ds_read_b128 a[100:103], v6 offset:9216
v_mfma_f32_16x16x32_bf16 v[152:155], a[116:119], a[20:23], v[152:155]
buffer_load_dwordx4 a[8:11], v4, s[40:43], s35 offen offset:0 sc1
v_mfma_f32_16x16x32_bf16 v[136:139], a[116:119], a[16:19], v[136:139]
ds_read_b128 a[104:107], v6 offset:10240
v_mfma_f32_16x16x32_bf16 v[140:143], a[120:123], a[16:19], v[140:143]
ds_read_b128 a[108:111], v6 offset:11264
v_mfma_f32_16x16x32_bf16 v[156:159], a[120:123], a[20:23], v[156:159]
v_mfma_f32_16x16x32_bf16 v[160:163], a[124:127], a[20:23], v[160:163]
buffer_load_dwordx4 a[12:15], v4, s[40:43], s35 offen offset:1024 sc1
s_xor_b32 s35, s77, 577536
v_mfma_f32_16x16x32_bf16 v[144:147], a[124:127], a[16:19], v[144:147]
s_waitcnt vmcnt(10) lgkmcnt(4)
v_mfma_f32_16x16x32_bf16 v[132:135], a[128:131], a[24:27], v[132:135]
ds_read_b128 a[112:115], v6 offset:12288
v_mfma_f32_16x16x32_bf16 v[148:151], a[128:131], a[28:31], v[148:151]
ds_read_b128 a[116:119], v6 offset:13312
v_mfma_f32_16x16x32_bf16 v[152:155], a[132:135], a[28:31], v[152:155]
buffer_load_dwordx4 a[16:19], v4, s[40:43], s35 offen offset:0 sc1
v_mfma_f32_16x16x32_bf16 v[136:139], a[132:135], a[24:27], v[136:139]
ds_read_b128 a[120:123], v6 offset:14336
v_mfma_f32_16x16x32_bf16 v[140:143], a[136:139], a[24:27], v[140:143]
ds_read_b128 a[124:127], v6 offset:15360
v_mfma_f32_16x16x32_bf16 v[156:159], a[136:139], a[28:31], v[156:159]
v_mfma_f32_16x16x32_bf16 v[160:163], a[140:143], a[28:31], v[160:163]
buffer_load_dwordx4 a[20:23], v4, s[40:43], s35 offen offset:1024 sc1
s_xor_b32 s35, s77, 589824
v_mfma_f32_16x16x32_bf16 v[144:147], a[140:143], a[24:27], v[144:147]
s_waitcnt vmcnt(10) lgkmcnt(4)
v_mfma_f32_16x16x32_bf16 v[132:135], a[96:99], a[32:35], v[132:135]
ds_read_b128 a[128:131], v6 offset:16384
v_mfma_f32_16x16x32_bf16 v[148:151], a[96:99], a[36:39], v[148:151]
ds_read_b128 a[132:135], v6 offset:17408
v_mfma_f32_16x16x32_bf16 v[152:155], a[100:103], a[36:39], v[152:155]
buffer_load_dwordx4 a[24:27], v4, s[40:43], s35 offen offset:0 sc1
v_mfma_f32_16x16x32_bf16 v[136:139], a[100:103], a[32:35], v[136:139]
ds_read_b128 a[136:139], v6 offset:18432
v_mfma_f32_16x16x32_bf16 v[140:143], a[104:107], a[32:35], v[140:143]
ds_read_b128 a[140:143], v6 offset:19456
v_mfma_f32_16x16x32_bf16 v[156:159], a[104:107], a[36:39], v[156:159]
v_mfma_f32_16x16x32_bf16 v[160:163], a[108:111], a[36:39], v[160:163]
buffer_load_dwordx4 a[28:31], v4, s[40:43], s35 offen offset:1024 sc1
s_xor_b32 s35, s77, 593920
v_mfma_f32_16x16x32_bf16 v[144:147], a[108:111], a[32:35], v[144:147]
s_waitcnt vmcnt(10) lgkmcnt(4)
v_mfma_f32_16x16x32_bf16 v[132:135], a[112:115], a[40:43], v[132:135]
ds_read_b128 a[96:99], v6 offset:20480
v_mfma_f32_16x16x32_bf16 v[148:151], a[112:115], a[44:47], v[148:151]
ds_read_b128 a[100:103], v6 offset:21504
v_mfma_f32_16x16x32_bf16 v[152:155], a[116:119], a[44:47], v[152:155]
buffer_load_dwordx4 a[32:35], v4, s[40:43], s35 offen offset:0 sc1
v_mfma_f32_16x16x32_bf16 v[136:139], a[116:119], a[40:43], v[136:139]
ds_read_b128 a[104:107], v6 offset:22528
v_mfma_f32_16x16x32_bf16 v[140:143], a[120:123], a[40:43], v[140:143]
ds_read_b128 a[108:111], v6 offset:23552
v_mfma_f32_16x16x32_bf16 v[156:159], a[120:123], a[44:47], v[156:159]
v_mfma_f32_16x16x32_bf16 v[160:163], a[124:127], a[44:47], v[160:163]
buffer_load_dwordx4 a[36:39], v4, s[40:43], s35 offen offset:1024 sc1
s_xor_b32 s35, s77, 606208
v_mfma_f32_16x16x32_bf16 v[144:147], a[124:127], a[40:43], v[144:147]
s_waitcnt vmcnt(10) lgkmcnt(4)
v_mfma_f32_16x16x32_bf16 v[132:135], a[128:131], a[48:51], v[132:135]
ds_read_b128 a[112:115], v6 offset:24576
v_mfma_f32_16x16x32_bf16 v[148:151], a[128:131], a[52:55], v[148:151]
ds_read_b128 a[116:119], v6 offset:25600
v_mfma_f32_16x16x32_bf16 v[152:155], a[132:135], a[52:55], v[152:155]
buffer_load_dwordx4 a[40:43], v4, s[40:43], s35 offen offset:0 sc1
v_mfma_f32_16x16x32_bf16 v[136:139], a[132:135], a[48:51], v[136:139]
ds_read_b128 a[120:123], v6 offset:26624
v_mfma_f32_16x16x32_bf16 v[140:143], a[136:139], a[48:51], v[140:143]
s_add_u32 s88, s67, 0xe0000
s_add_u32 s89, s66, 0xd0000
v_mfma_f32_16x16x32_bf16 v[156:159], a[136:139], a[52:55], v[156:159]
buffer_load_dword v11, v255, s[4:7], s88 offen sc1
v_mfma_f32_16x16x32_bf16 v[160:163], a[140:143], a[52:55], v[160:163]
buffer_load_dwordx4 a[44:47], v4, s[40:43], s35 offen offset:1024 sc1
s_xor_b32 s35, s77, 610304
v_mfma_f32_16x16x32_bf16 v[144:147], a[140:143], a[48:51], v[144:147]
ds_read_b128 a[124:127], v6 offset:27648
s_waitcnt vmcnt(11) lgkmcnt(4)
v_mfma_f32_16x16x32_bf16 v[132:135], a[96:99], a[0:3], v[132:135]
buffer_load_dword v232, v255, s[4:7], s89 offen offset:64 sc1
v_mfma_f32_16x16x32_bf16 v[148:151], a[96:99], a[4:7], v[148:151]
ds_read_b128 a[128:131], v6 offset:28672
v_mfma_f32_16x16x32_bf16 v[152:155], a[100:103], a[4:7], v[152:155]
buffer_load_dwordx4 a[48:51], v4, s[40:43], s35 offen offset:0 sc1
v_mfma_f32_16x16x32_bf16 v[136:139], a[100:103], a[0:3], v[136:139]
ds_read_b128 a[132:135], v6 offset:29696
v_mfma_f32_16x16x32_bf16 v[140:143], a[104:107], a[0:3], v[140:143]
ds_read_b128 a[136:139], v6 offset:30720
v_mfma_f32_16x16x32_bf16 v[156:159], a[104:107], a[4:7], v[156:159]
ds_read_b128 a[140:143], v6 offset:31744
v_mfma_f32_16x16x32_bf16 v[160:163], a[108:111], a[4:7], v[160:163]
buffer_load_dwordx4 a[52:55], v4, s[40:43], s35 offen offset:1024 sc1
s_xor_b32 s35, s77, 622592
v_mfma_f32_16x16x32_bf16 v[144:147], a[108:111], a[0:3], v[144:147]
s_waitcnt vmcnt(12) lgkmcnt(4)
v_mfma_f32_16x16x32_bf16 v[132:135], a[112:115], a[8:11], v[132:135]
ds_read_b128 a[96:99], v6 offset:32768
v_mfma_f32_16x16x32_bf16 v[148:151], a[112:115], a[12:15], v[148:151]
ds_read_b128 a[100:103], v6 offset:33792
v_mfma_f32_16x16x32_bf16 v[152:155], a[116:119], a[12:15], v[152:155]
buffer_load_dwordx4 a[0:3], v4, s[40:43], s35 offen offset:0 sc1
v_mfma_f32_16x16x32_bf16 v[136:139], a[116:119], a[8:11], v[136:139]
ds_read_b128 a[104:107], v6 offset:34816
v_mfma_f32_16x16x32_bf16 v[140:143], a[120:123], a[8:11], v[140:143]
ds_read_b128 a[108:111], v6 offset:35840
v_mfma_f32_16x16x32_bf16 v[156:159], a[120:123], a[12:15], v[156:159]
v_mfma_f32_16x16x32_bf16 v[160:163], a[124:127], a[12:15], v[160:163]
buffer_load_dwordx4 a[4:7], v4, s[40:43], s35 offen offset:1024 sc1
s_xor_b32 s35, s77, 626688
v_mfma_f32_16x16x32_bf16 v[144:147], a[124:127], a[8:11], v[144:147]
s_waitcnt vmcnt(12) lgkmcnt(4)
v_mfma_f32_16x16x32_bf16 v[132:135], a[128:131], a[16:19], v[132:135]
ds_read_b128 a[112:115], v6 offset:36864
v_mfma_f32_16x16x32_bf16 v[148:151], a[128:131], a[20:23], v[148:151]
ds_read_b128 a[116:119], v6 offset:37888
v_mfma_f32_16x16x32_bf16 v[152:155], a[132:135], a[20:23], v[152:155]
buffer_load_dwordx4 a[8:11], v4, s[40:43], s35 offen offset:0 sc1
v_mfma_f32_16x16x32_bf16 v[136:139], a[132:135], a[16:19], v[136:139]
ds_read_b128 a[120:123], v6 offset:38912
v_mfma_f32_16x16x32_bf16 v[140:143], a[136:139], a[16:19], v[140:143]
ds_read_b128 a[124:127], v6 offset:39936
v_mfma_f32_16x16x32_bf16 v[156:159], a[136:139], a[20:23], v[156:159]
v_mfma_f32_16x16x32_bf16 v[160:163], a[140:143], a[20:23], v[160:163]
buffer_load_dwordx4 a[12:15], v4, s[40:43], s35 offen offset:1024 sc1
s_xor_b32 s35, s77, 638976
v_mfma_f32_16x16x32_bf16 v[144:147], a[140:143], a[16:19], v[144:147]
s_waitcnt vmcnt(12) lgkmcnt(4)
v_mfma_f32_16x16x32_bf16 v[132:135], a[96:99], a[24:27], v[132:135]
ds_read_b128 a[128:131], v6 offset:40960
v_mfma_f32_16x16x32_bf16 v[148:151], a[96:99], a[28:31], v[148:151]
ds_read_b128 a[132:135], v6 offset:41984
v_mfma_f32_16x16x32_bf16 v[152:155], a[100:103], a[28:31], v[152:155]
buffer_load_dwordx4 a[16:19], v4, s[40:43], s35 offen offset:0 sc1
v_mfma_f32_16x16x32_bf16 v[136:139], a[100:103], a[24:27], v[136:139]
ds_read_b128 a[136:139], v6 offset:43008
v_mfma_f32_16x16x32_bf16 v[140:143], a[104:107], a[24:27], v[140:143]
ds_read_b128 a[140:143], v6 offset:44032
v_mfma_f32_16x16x32_bf16 v[156:159], a[104:107], a[28:31], v[156:159]
v_mfma_f32_16x16x32_bf16 v[160:163], a[108:111], a[28:31], v[160:163]
buffer_load_dwordx4 a[20:23], v4, s[40:43], s35 offen offset:1024 sc1
s_xor_b32 s35, s77, 643072
v_mfma_f32_16x16x32_bf16 v[144:147], a[108:111], a[24:27], v[144:147]
s_waitcnt vmcnt(12) lgkmcnt(4)
v_mfma_f32_16x16x32_bf16 v[132:135], a[112:115], a[32:35], v[132:135]
ds_read_b128 a[96:99], v6 offset:45056
v_mfma_f32_16x16x32_bf16 v[148:151], a[112:115], a[36:39], v[148:151]
ds_read_b128 a[100:103], v6 offset:46080
v_mfma_f32_16x16x32_bf16 v[152:155], a[116:119], a[36:39], v[152:155]
buffer_load_dwordx4 a[24:27], v4, s[40:43], s35 offen offset:0 sc1
v_mfma_f32_16x16x32_bf16 v[136:139], a[116:119], a[32:35], v[136:139]
ds_read_b128 a[104:107], v6 offset:47104
v_mfma_f32_16x16x32_bf16 v[140:143], a[120:123], a[32:35], v[140:143]
ds_read_b128 a[108:111], v6 offset:48128
v_mfma_f32_16x16x32_bf16 v[156:159], a[120:123], a[36:39], v[156:159]
v_mfma_f32_16x16x32_bf16 v[160:163], a[124:127], a[36:39], v[160:163]
buffer_load_dwordx4 a[28:31], v4, s[40:43], s35 offen offset:1024 sc1
s_xor_b32 s35, s77, 0
v_mfma_f32_16x16x32_bf16 v[144:147], a[124:127], a[32:35], v[144:147]
s_waitcnt vmcnt(11) lgkmcnt(4)
v_cmp_ne_u32 vcc, v11, v15
s_cbranch_vccnz Ltr_13
Lte_15:
v_mfma_f32_16x16x32_bf16 v[132:135], a[128:131], a[40:43], v[132:135]
s_add_u32 m0, s18, 0x0
s_add_u32 s44, s50, 0x2800000
v_mfma_f32_16x16x32_bf16 v[148:151], a[128:131], a[44:47], v[148:151]
ds_read_b128 a[112:115], v6 offset:49152
v_mfma_f32_16x16x32_bf16 v[152:155], a[132:135], a[44:47], v[152:155]
buffer_load_dwordx4 v1, s[4:7], s44 offen offset:0 sc1 lds
v_mfma_f32_16x16x32_bf16 v[136:139], a[132:135], a[40:43], v[136:139]
ds_read_b128 a[116:119], v6 offset:50176
v_mfma_f32_16x16x32_bf16 v[140:143], a[136:139], a[40:43], v[140:143]
ds_read_b128 a[120:123], v6 offset:51200
v_mfma_f32_16x16x32_bf16 v[156:159], a[136:139], a[44:47], v[156:159]
ds_read_b128 a[124:127], v6 offset:52224
v_mfma_f32_16x16x32_bf16 v[160:163], a[140:143], a[44:47], v[160:163]
buffer_load_dwordx4 v1, s[4:7], s44 offen offset:1024 sc1 lds
s_add_u32 m0, s18, 0x2000
v_mfma_f32_16x16x32_bf16 v[144:147], a[140:143], a[40:43], v[144:147]
s_add_u32 s44, s50, 0x2802000
s_waitcnt vmcnt(10) lgkmcnt(4)
v_mfma_f32_16x16x32_bf16 v[132:135], a[96:99], a[48:51], v[132:135]
ds_read_b128 a[128:131], v6 offset:53248
v_mfma_f32_16x16x32_bf16 v[148:151], a[96:99], a[52:55], v[148:151]
ds_read_b128 a[132:135], v6 offset:54272
v_mfma_f32_16x16x32_bf16 v[152:155], a[100:103], a[52:55], v[152:155]
buffer_load_dwordx4 v1, s[4:7], s44 offen offset:0 sc1 lds
v_mfma_f32_16x16x32_bf16 v[136:139], a[100:103], a[48:51], v[136:139]
ds_read_b128 a[136:139], v6 offset:55296
v_mfma_f32_16x16x32_bf16 v[140:143], a[104:107], a[48:51], v[140:143]
ds_read_b128 a[140:143], v6 offset:56320
v_mfma_f32_16x16x32_bf16 v[156:159], a[104:107], a[52:55], v[156:159]
v_mfma_f32_16x16x32_bf16 v[160:163], a[108:111], a[52:55], v[160:163]
buffer_load_dwordx4 v1, s[4:7], s44 offen offset:1024 sc1 lds
s_add_u32 m0, s18, 0x4000
v_mfma_f32_16x16x32_bf16 v[144:147], a[108:111], a[48:51], v[144:147]
s_add_u32 s44, s50, 0x2804000
s_waitcnt vmcnt(10) lgkmcnt(4)
v_mfma_f32_16x16x32_bf16 v[132:135], a[112:115], a[0:3], v[132:135]
ds_read_b128 a[96:99], v6 offset:57344
v_mfma_f32_16x16x32_bf16 v[148:151], a[112:115], a[4:7], v[148:151]
ds_read_b128 a[100:103], v6 offset:58368
v_mfma_f32_16x16x32_bf16 v[152:155], a[116:119], a[4:7], v[152:155]
ds_read_b128 a[104:107], v6 offset:59392
v_mfma_f32_16x16x32_bf16 v[136:139], a[116:119], a[0:3], v[136:139]
buffer_load_dwordx4 v1, s[4:7], s44 offen offset:0 sc1 lds
v_mfma_f32_16x16x32_bf16 v[140:143], a[120:123], a[0:3], v[140:143]
ds_read_b128 a[108:111], v6 offset:60416
v_mfma_f32_16x16x32_bf16 v[156:159], a[120:123], a[4:7], v[156:159]
v_mfma_f32_16x16x32_bf16 v[160:163], a[124:127], a[4:7], v[160:163]
v_mfma_f32_16x16x32_bf16 v[144:147], a[124:127], a[0:3], v[144:147]
buffer_load_dwordx4 v1, s[4:7], s44 offen offset:1024 sc1 lds
s_waitcnt vmcnt(10) lgkmcnt(4)
v_mfma_f32_16x16x32_bf16 v[132:135], a[128:131], a[8:11], v[132:135]
s_add_u32 m0, s18, 0x6000
s_add_u32 s44, s50, 0x2806000
v_mfma_f32_16x16x32_bf16 v[148:151], a[128:131], a[12:15], v[148:151]
ds_read_b128 a[112:115], v6 offset:61440
v_mfma_f32_16x16x32_bf16 v[152:155], a[132:135], a[12:15], v[152:155]
ds_read_b128 a[116:119], v6 offset:62464
v_mfma_f32_16x16x32_bf16 v[136:139], a[132:135], a[8:11], v[136:139]
ds_read_b128 a[120:123], v6 offset:63488
v_mfma_f32_16x16x32_bf16 v[140:143], a[136:139], a[8:11], v[140:143]
buffer_load_dwordx4 v1, s[4:7], s44 offen offset:0 sc1 lds
v_mfma_f32_16x16x32_bf16 v[156:159], a[136:139], a[12:15], v[156:159]
ds_read_b128 a[124:127], v6 offset:64512
v_mfma_f32_16x16x32_bf16 v[160:163], a[140:143], a[12:15], v[160:163]
v_mfma_f32_16x16x32_bf16 v[144:147], a[140:143], a[8:11], v[144:147]
s_waitcnt vmcnt(9) lgkmcnt(4)
v_mfma_f32_16x16x32_bf16 v[132:135], a[96:99], a[16:19], v[132:135]
v_mfma_f32_16x16x32_bf16 v[148:151], a[96:99], a[20:23], v[148:151]
buffer_load_dwordx4 v1, s[4:7], s44 offen offset:1024 sc1 lds
v_mfma_f32_16x16x32_bf16 v[152:155], a[100:103], a[20:23], v[152:155]
v_mfma_f32_16x16x32_bf16 v[136:139], a[100:103], a[16:19], v[136:139]
v_mfma_f32_16x16x32_bf16 v[140:143], a[104:107], a[16:19], v[140:143]
v_mfma_f32_16x16x32_bf16 v[156:159], a[104:107], a[20:23], v[156:159]
v_mfma_f32_16x16x32_bf16 v[160:163], a[108:111], a[20:23], v[160:163]
v_mfma_f32_16x16x32_bf16 v[144:147], a[108:111], a[16:19], v[144:147]
s_waitcnt vmcnt(8) lgkmcnt(0)
v_mfma_f32_16x16x32_bf16 v[132:135], a[112:115], a[24:27], v[132:135]
v_mfma_f32_16x16x32_bf16 v[148:151], a[112:115], a[28:31], v[148:151]
v_mfma_f32_16x16x32_bf16 v[152:155], a[116:119], a[28:31], v[152:155]
v_mfma_f32_16x16x32_bf16 v[136:139], a[116:119], a[24:27], v[136:139]
v_mfma_f32_16x16x32_bf16 v[140:143], a[120:123], a[24:27], v[140:143]
v_mfma_f32_16x16x32_bf16 v[156:159], a[120:123], a[28:31], v[156:159]
v_mfma_f32_16x16x32_bf16 v[160:163], a[124:127], a[28:31], v[160:163]
v_mfma_f32_16x16x32_bf16 v[144:147], a[124:127], a[24:27], v[144:147]
s_nop 0
v_cvt_pk_bf16_f32 v32, v132, v133
v_cvt_pk_bf16_f32 v33, v134, v135
s_nop 0
v_cvt_pk_bf16_f32 v34, v136, v137
v_cvt_pk_bf16_f32 v35, v138, v139
s_add_u32 s36, s69, 0x400000
buffer_store_dwordx4 v[32:35], v4, s[4:7], s36 offen offset:0 sc1
v_cvt_pk_bf16_f32 v40, v148, v149
v_cvt_pk_bf16_f32 v41, v150, v151
v_cvt_pk_bf16_f32 v42, v152, v153
v_cvt_pk_bf16_f32 v43, v154, v155
v_cvt_pk_bf16_f32 v36, v140, v141
v_cvt_pk_bf16_f32 v37, v142, v143
v_cvt_pk_bf16_f32 v38, v144, v145
v_cvt_pk_bf16_f32 v39, v146, v147
s_add_u32 s37, s36, 4096
v_cvt_pk_bf16_f32 v44, v156, v157
v_cvt_pk_bf16_f32 v45, v158, v159
v_cvt_pk_bf16_f32 v46, v160, v161
buffer_store_dwordx4 v[40:43], v4, s[4:7], s36 offen offset:1024 sc1
v_cvt_pk_bf16_f32 v47, v162, v163
v_mfma_f32_16x16x32_bf16 v[96:99], v[32:35], v[32:35], 0
s_mov_b32 s38, 0x300000
s_add_u32 s92, s78, 0x40000
v_mfma_f32_16x16x32_bf16 v[92:95], v[16:19], v[32:35], 0
s_add_u32 s40, s4, 0x400000
s_addc_u32 s41, s5, 0
v_mfma_f32_16x16x32_bf16 v[96:99], v[36:39], v[36:39], v[96:99]
buffer_store_dwordx4 v[36:39], v4, s[4:7], s37 offen offset:0 sc1
v_mfma_f32_16x16x32_bf16 v[92:95], v[16:19], v[36:39], v[92:95]
s_nop 5
v_cndmask_b32 v96, v96, v97, s[46:47]
v_cndmask_b32 v98, v98, v99, s[46:47]
v_mfma_f32_16x16x32_bf16 v[104:107], v[40:43], v[40:43], 0
v_mfma_f32_16x16x32_bf16 v[100:103], v[16:19], v[40:43], 0
v_cndmask_b32 v93, v96, v98, s[48:49]
buffer_store_dwordx4 v[44:47], v4, s[4:7], s37 offen offset:1024 sc1
v_mfma_f32_16x16x32_bf16 v[104:107], v[44:47], v[44:47], v[104:107]
v_mfma_f32_16x16x32_bf16 v[100:103], v[16:19], v[44:47], v[100:103]
s_nop 6
v_cndmask_b32 v104, v104, v105, s[46:47]
v_cndmask_b32 v106, v106, v107, s[46:47]
L_stub4:
s_cbranch_execz L_wret1
buffer_store_dwordx2 v[92:93], v253, s[4:7], s38 offen offset:0 sc1
v_cndmask_b32 v101, v104, v106, s[48:49]
buffer_store_dwordx2 v[100:101], v253, s[4:7], s38 offen offset:2048 sc1
v_cmp_ne_u32 vcc, v232, v15
s_cbranch_vccnz Ltr_16
Lte_18:
s_barrier
s_add_u32 m0, s18, 0x8000
s_add_u32 s44, s50, 0x2808000
buffer_load_dwordx4 v1, s[4:7], s44 offen offset:0 sc1 lds
buffer_load_dwordx4 v1, s[4:7], s44 offen offset:1024 sc1 lds
s_add_u32 m0, s18, 0xa000
s_add_u32 s44, s50, 0x280a000
buffer_load_dwordx4 v1, s[4:7], s44 offen offset:0 sc1 lds
buffer_load_dwordx4 v1, s[4:7], s44 offen offset:1024 sc1 lds
s_waitcnt vmcnt(4)
s_barrier
s_cmp_lg_u32 s28, 0
s_cbranch_scc1 Lsg_19
buffer_atomic_add v12, v10, s[4:7], s92 offen sc1
Lsg_19:
s_mov_b64 exec, 0
s_cmp_eq_u32 s28, 0
s_cbranch_scc1 L_stub5
L_wret2:
s_mov_b64 exec, -1
s_cmp_lt_u32 s28, 2
s_cbranch_scc1 Lwd_20
s_add_u32 m0, s19, 0xa000
s_add_u32 s44, s50, 0x280a000
s_add_u32 s44, s44, s18
buffer_load_dwordx4 v1, s[4:7], s44 offen offset:0 sc1 lds
buffer_load_dwordx4 v1, s[4:7], s44 offen offset:1024 sc1 lds
buffer_load_dwordx4 v1, s[4:7], s44 offen offset:2048 sc1 lds
buffer_load_dwordx4 v1, s[4:7], s44 offen offset:3072 sc1 lds
s_add_u32 m0, s19, 0xc000
s_add_u32 s44, s50, 0x280c000
s_add_u32 s44, s44, s18
buffer_load_dwordx4 v1, s[4:7], s44 offen offset:0 sc1 lds
buffer_load_dwordx4 v1, s[4:7], s44 offen offset:1024 sc1 lds
buffer_load_dwordx4 v1, s[4:7], s44 offen offset:2048 sc1 lds
buffer_load_dwordx4 v1, s[4:7], s44 offen offset:3072 sc1 lds
s_add_u32 m0, s19, 0xe000
s_add_u32 s44, s50, 0x280e000
s_add_u32 s44, s44, s18
buffer_load_dwordx4 v1, s[4:7], s44 offen offset:0 sc1 lds
buffer_load_dwordx4 v1, s[4:7], s44 offen offset:1024 sc1 lds
buffer_load_dwordx4 v1, s[4:7], s44 offen offset:2048 sc1 lds
buffer_load_dwordx4 v1, s[4:7], s44 offen offset:3072 sc1 lds
s_add_u32 m0, s19, 0x10000
s_add_u32 s44, s50, 0x2810000
s_add_u32 s44, s44, s18
buffer_load_dwordx4 v1, s[4:7], s44 offen offset:0 sc1 lds
buffer_load_dwordx4 v1, s[4:7], s44 offen offset:1024 sc1 lds
buffer_load_dwordx4 v1, s[4:7], s44 offen offset:2048 sc1 lds
buffer_load_dwordx4 v1, s[4:7], s44 offen offset:3072 sc1 lds
s_add_u32 m0, s19, 0x12000
s_add_u32 s44, s50, 0x2812000
s_add_u32 s44, s44, s18
buffer_load_dwordx4 v1, s[4:7], s44 offen offset:0 sc1 lds
buffer_load_dwordx4 v1, s[4:7], s44 offen offset:1024 sc1 lds
buffer_load_dwordx4 v1, s[4:7], s44 offen offset:2048 sc1 lds
buffer_load_dwordx4 v1, s[4:7], s44 offen offset:3072 sc1 lds
s_add_u32 m0, s19, 0x14000
s_add_u32 s44, s50, 0x2814000
s_add_u32 s44, s44, s18
buffer_load_dwordx4 v1, s[4:7], s44 offen offset:0 sc1 lds
buffer_load_dwordx4 v1, s[4:7], s44 offen offset:1024 sc1 lds
buffer_load_dwordx4 v1, s[4:7], s44 offen offset:2048 sc1 lds
buffer_load_dwordx4 v1, s[4:7], s44 offen offset:3072 sc1 lds
s_add_u32 m0, s19, 0x16000
s_add_u32 s44, s50, 0x2816000
s_add_u32 s44, s44, s18
buffer_load_dwordx4 v1, s[4:7], s44 offen offset:0 sc1 lds
buffer_load_dwordx4 v1, s[4:7], s44 offen offset:1024 sc1 lds
buffer_load_dwordx4 v1, s[4:7], s44 offen offset:2048 sc1 lds
buffer_load_dwordx4 v1, s[4:7], s44 offen offset:3072 sc1 lds
s_add_u32 m0, s19, 0x18000
s_add_u32 s44, s50, 0x2818000
s_add_u32 s44, s44, s18
buffer_load_dwordx4 v1, s[4:7], s44 offen offset:0 sc1 lds
buffer_load_dwordx4 v1, s[4:7], s44 offen offset:1024 sc1 lds
buffer_load_dwordx4 v1, s[4:7], s44 offen offset:2048 sc1 lds
buffer_load_dwordx4 v1, s[4:7], s44 offen offset:3072 sc1 lds
Lwd_20:
s_cmp_lg_u32 s28, 1
s_cbranch_scc1 Lpo_23
s_add_u32 s36, s34, 0x40000
s_mov_b32 s37, 0
v_mov_b32 v11, 0
buffer_atomic_add v11, v251, s[4:7], s36 offen sc0 sc1
s_sleep 4
Lpoll_21:
v_mov_b32 v234, 0
buffer_atomic_add v234, v251, s[4:7], s36 offen sc0 sc1
s_waitcnt vmcnt(1)
v_readfirstlane_b32 s38, v11
s_nop 0
s_cmp_ge_u32 s38, 32
s_cbranch_scc1 Lpe_22
v_mov_b32 v11, 0
buffer_atomic_add v11, v251, s[4:7], s36 offen sc0 sc1
s_waitcnt vmcnt(1)
v_readfirstlane_b32 s38, v234
s_nop 0
s_cmp_ge_u32 s38, 32
s_cbranch_scc1 Lpe_22
s_add_u32 s37, s37, 1
s_cmp_lt_u32 s37, 0x80000
s_cbranch_scc1 Lpoll_21
s_waitcnt vmcnt(0)
Lpo_23:
s_waitcnt vmcnt(32) lgkmcnt(0)
s_cmp_ge_u32 s28, 2
s_cbranch_scc1 Lw_24
s_waitcnt vmcnt(0)
Lw_24:
Lpe_22:
s_barrier
s_mov_b32 s35, s68
s_add_u32 s33, s35, 0x1000
buffer_load_dwordx4 a[0:3], v2, s[40:43], s35 offen offset:0 sc1
buffer_load_dwordx4 a[4:7], v2, s[40:43], s33 offen offset:0 sc1
buffer_load_dwordx4 a[8:11], v2, s[40:43], s35 offen offset:1024 sc1
buffer_load_dwordx4 a[12:15], v2, s[40:43], s33 offen offset:1024 sc1
buffer_load_dwordx4 a[16:19], v2, s[40:43], s35 offen offset:2048 sc1
buffer_load_dwordx4 a[20:23], v2, s[40:43], s33 offen offset:2048 sc1
buffer_load_dwordx4 a[24:27], v2, s[40:43], s35 offen offset:3072 sc1
buffer_load_dwordx4 a[28:31], v2, s[40:43], s33 offen offset:3072 sc1
s_add_u32 s35, s35, 0x4000
s_add_u32 s33, s33, 0x4000
buffer_load_dwordx4 a[32:35], v2, s[40:43], s35 offen offset:0 sc1
buffer_load_dwordx4 a[36:39], v2, s[40:43], s33 offen offset:0 sc1
buffer_load_dwordx4 a[40:43], v2, s[40:43], s35 offen offset:1024 sc1
buffer_load_dwordx4 a[44:47], v2, s[40:43], s33 offen offset:1024 sc1
buffer_load_dwordx4 a[48:51], v2, s[40:43], s35 offen offset:2048 sc1
buffer_load_dwordx4 a[52:55], v2, s[40:43], s33 offen offset:2048 sc1
buffer_load_dwordx4 a[56:59], v2, s[40:43], s35 offen offset:3072 sc1
buffer_load_dwordx4 a[60:63], v2, s[40:43], s33 offen offset:3072 sc1
s_add_u32 s35, s35, 0x4000
s_add_u32 s33, s33, 0x4000
v_add_u32 v5, 0, v1
ds_read_b128 a[96:99], v5 offset:2048
ds_read_b128 a[100:103], v5 offset:8192
ds_read_b128 a[104:107], v5 offset:3072
ds_read_b128 a[108:111], v5 offset:9216
ds_read_b128 a[112:115], v5 offset:4096
ds_read_b128 a[116:119], v5 offset:10240
s_waitcnt vmcnt(14) lgkmcnt(4)
v_mfma_f32_16x16x32_bf16 v[140:143], a[96:99], a[0:3], 0
v_and_b32 v232, 15, v0
v_lshlrev_b32 v232, 7, v232
v_mfma_f32_16x16x32_bf16 v[140:143], a[100:103], a[4:7], v[140:143]
buffer_load_dwordx4 a[64:67], v2, s[40:43], s35 offen offset:0 sc1
s_waitcnt vmcnt(13)
v_mfma_f32_16x16x32_bf16 v[164:167], a[100:103], a[12:15], 0
v_lshrrev_b32 v233, 4, v0
v_lshlrev_b32 v233, 4, v233
v_mfma_f32_16x16x32_bf16 v[164:167], a[96:99], a[8:11], v[164:167]
v_add_u32 v232, v233, v232
s_mul_i32 s38, s30, 12288
s_waitcnt vmcnt(12)
v_mfma_f32_16x16x32_bf16 v[188:191], a[96:99], a[16:19], 0
s_add_u32 s38, s38, 0x1880000
s_add_u32 s39, s28, 4
s_min_u32 s39, s39, 5
s_waitcnt vmcnt(11)
v_mfma_f32_16x16x32_bf16 v[188:191], a[100:103], a[20:23], v[188:191]
buffer_load_dwordx4 a[68:71], v2, s[40:43], s33 offen offset:0 sc1
s_lshl_b32 s36, s28, 11
s_waitcnt vmcnt(10)
v_mfma_f32_16x16x32_bf16 v[212:215], a[100:103], a[28:31], 0
s_add_u32 s36, s36, s38
s_lshl_b32 s37, s39, 11
s_add_u32 s37, s37, s38
v_mfma_f32_16x16x32_bf16 v[212:215], a[96:99], a[24:27], v[212:215]
ds_read_b128 a[128:131], v5 offset:5120
s_waitcnt lgkmcnt(4)
v_mfma_f32_16x16x32_bf16 v[216:219], a[104:107], a[24:27], 0
ds_read_b128 a[132:135], v5 offset:11264
s_waitcnt lgkmcnt(4)
v_mfma_f32_16x16x32_bf16 v[216:219], a[108:111], a[28:31], v[216:219]
ds_read_b128 a[136:139], v5 offset:0
v_mfma_f32_16x16x32_bf16 v[192:195], a[108:111], a[20:23], 0
buffer_load_dwordx4 v[48:51], v232, s[4:7], s36 offen sc1
v_mfma_f32_16x16x32_bf16 v[192:195], a[104:107], a[16:19], v[192:195]
ds_read_b128 a[140:143], v5 offset:6144
v_mfma_f32_16x16x32_bf16 v[168:171], a[104:107], a[8:11], 0
ds_read_b128 a[144:147], v5 offset:1024
v_mfma_f32_16x16x32_bf16 v[168:171], a[108:111], a[12:15], v[168:171]
ds_read_b128 a[148:151], v5 offset:7168
v_mfma_f32_16x16x32_bf16 v[144:147], a[108:111], a[4:7], 0
v_mfma_f32_16x16x32_bf16 v[144:147], a[104:107], a[0:3], v[144:147]
buffer_load_dwordx4 a[72:75], v2, s[40:43], s35 offen offset:1024 sc1
s_waitcnt lgkmcnt(7)
v_mfma_f32_16x16x32_bf16 v[148:151], a[112:115], a[0:3], 0
s_waitcnt lgkmcnt(6)
v_mfma_f32_16x16x32_bf16 v[148:151], a[116:119], a[4:7], v[148:151]
v_mfma_f32_16x16x32_bf16 v[172:175], a[116:119], a[12:15], 0
v_mfma_f32_16x16x32_bf16 v[172:175], a[112:115], a[8:11], v[172:175]
v_mfma_f32_16x16x32_bf16 v[196:199], a[112:115], a[16:19], 0
buffer_load_dwordx4 a[76:79], v2, s[40:43], s33 offen offset:1024 sc1
v_mfma_f32_16x16x32_bf16 v[196:199], a[116:119], a[20:23], v[196:199]
v_mfma_f32_16x16x32_bf16 v[220:223], a[116:119], a[28:31], 0
v_mfma_f32_16x16x32_bf16 v[220:223], a[112:115], a[24:27], v[220:223]
s_waitcnt lgkmcnt(0)
v_mfma_f32_16x16x32_bf16 v[224:227], a[128:131], a[24:27], 0
ds_read_b128 a[96:99], v5 offset:14336
v_mfma_f32_16x16x32_bf16 v[224:227], a[132:135], a[28:31], v[224:227]
buffer_load_dwordx4 a[80:83], v2, s[40:43], s35 offen offset:2048 sc1
v_mfma_f32_16x16x32_bf16 v[200:203], a[132:135], a[20:23], 0
ds_read_b128 a[100:103], v5 offset:20480
v_mfma_f32_16x16x32_bf16 v[200:203], a[128:131], a[16:19], v[200:203]
v_mfma_f32_16x16x32_bf16 v[176:179], a[128:131], a[8:11], 0
v_mfma_f32_16x16x32_bf16 v[176:179], a[132:135], a[12:15], v[176:179]
buffer_load_dwordx4 a[84:87], v2, s[40:43], s33 offen offset:2048 sc1
v_mfma_f32_16x16x32_bf16 v[152:155], a[132:135], a[4:7], 0
ds_read_b128 a[104:107], v5 offset:15360
v_mfma_f32_16x16x32_bf16 v[152:155], a[128:131], a[0:3], v[152:155]
v_mfma_f32_16x16x32_bf16 v[132:135], a[136:139], a[0:3], 0
ds_read_b128 a[108:111], v5 offset:21504
v_mfma_f32_16x16x32_bf16 v[132:135], a[140:143], a[4:7], v[132:135]
v_mfma_f32_16x16x32_bf16 v[156:159], a[140:143], a[12:15], 0
buffer_load_dwordx4 v[52:55], v232, s[4:7], s37 offen sc1
s_add_u32 m0, s18, 0x1c000
v_mfma_f32_16x16x32_bf16 v[156:159], a[136:139], a[8:11], v[156:159]
s_add_u32 s44, s50, 0x281c000
ds_read_b128 a[112:115], v5 offset:16384
v_mfma_f32_16x16x32_bf16 v[180:183], a[136:139], a[16:19], 0
v_mfma_f32_16x16x32_bf16 v[180:183], a[140:143], a[20:23], v[180:183]
ds_read_b128 a[116:119], v5 offset:22528
v_mfma_f32_16x16x32_bf16 v[204:207], a[140:143], a[28:31], 0
v_mfma_f32_16x16x32_bf16 v[204:207], a[136:139], a[24:27], v[204:207]
buffer_load_dwordx4 a[88:91], v2, s[40:43], s35 offen offset:3072 sc1
v_mfma_f32_16x16x32_bf16 v[208:211], a[144:147], a[24:27], 0
v_mfma_f32_16x16x32_bf16 v[208:211], a[148:151], a[28:31], v[208:211]
v_mfma_f32_16x16x32_bf16 v[184:187], a[148:151], a[20:23], 0
v_mfma_f32_16x16x32_bf16 v[184:187], a[144:147], a[16:19], v[184:187]
v_mfma_f32_16x16x32_bf16 v[160:163], a[144:147], a[8:11], 0
buffer_load_dwordx4 a[92:95], v2, s[40:43], s33 offen offset:3072 sc1
s_add_u32 s35, s35, 0x4000
v_mfma_f32_16x16x32_bf16 v[160:163], a[148:151], a[12:15], v[160:163]
s_add_u32 s33, s33, 0x4000
v_mfma_f32_16x16x32_bf16 v[136:139], a[148:151], a[4:7], 0
v_mfma_f32_16x16x32_bf16 v[136:139], a[144:147], a[0:3], v[136:139]
s_waitcnt vmcnt(10) lgkmcnt(0)
v_mfma_f32_16x16x32_bf16 v[140:143], a[96:99], a[32:35], v[140:143]
ds_read_b128 a[128:131], v5 offset:17408
v_mfma_f32_16x16x32_bf16 v[140:143], a[100:103], a[36:39], v[140:143]
buffer_load_dwordx4 a[0:3], v2, s[40:43], s35 offen offset:0 sc1
v_mfma_f32_16x16x32_bf16 v[164:167], a[100:103], a[44:47], v[164:167]
ds_read_b128 a[132:135], v5 offset:23552
v_mfma_f32_16x16x32_bf16 v[164:167], a[96:99], a[40:43], v[164:167]
v_mfma_f32_16x16x32_bf16 v[188:191], a[96:99], a[48:51], v[188:191]
v_mfma_f32_16x16x32_bf16 v[188:191], a[100:103], a[52:55], v[188:191]
buffer_load_dwordx4 v1, s[4:7], s44 offen offset:0 sc1 lds
v_mfma_f32_16x16x32_bf16 v[212:215], a[100:103], a[60:63], v[212:215]
ds_read_b128 a[136:139], v5 offset:12288
v_mfma_f32_16x16x32_bf16 v[212:215], a[96:99], a[56:59], v[212:215]
v_mfma_f32_16x16x32_bf16 v[216:219], a[104:107], a[56:59], v[216:219]
ds_read_b128 a[140:143], v5 offset:18432
v_mfma_f32_16x16x32_bf16 v[216:219], a[108:111], a[60:63], v[216:219]
buffer_load_dwordx4 a[4:7], v2, s[40:43], s33 offen offset:0 sc1
v_mfma_f32_16x16x32_bf16 v[192:195], a[108:111], a[52:55], v[192:195]
ds_read_b128 a[144:147], v5 offset:13312
v_mfma_f32_16x16x32_bf16 v[192:195], a[104:107], a[48:51], v[192:195]
v_mfma_f32_16x16x32_bf16 v[168:171], a[104:107], a[40:43], v[168:171]
v_mfma_f32_16x16x32_bf16 v[168:171], a[108:111], a[44:47], v[168:171]
buffer_load_dwordx4 a[8:11], v2, s[40:43], s35 offen offset:1024 sc1
v_mfma_f32_16x16x32_bf16 v[144:147], a[108:111], a[36:39], v[144:147]
ds_read_b128 a[148:151], v5 offset:19456
v_mfma_f32_16x16x32_bf16 v[144:147], a[104:107], a[32:35], v[144:147]
v_mfma_f32_16x16x32_bf16 v[148:151], a[112:115], a[32:35], v[148:151]
v_mfma_f32_16x16x32_bf16 v[148:151], a[116:119], a[36:39], v[148:151]
buffer_load_dwordx4 v1, s[4:7], s44 offen offset:1024 sc1 lds
s_add_u32 m0, s18, 0x1e000
v_mfma_f32_16x16x32_bf16 v[172:175], a[116:119], a[44:47], v[172:175]
s_add_u32 s44, s50, 0x281e000
v_mfma_f32_16x16x32_bf16 v[172:175], a[112:115], a[40:43], v[172:175]
v_mfma_f32_16x16x32_bf16 v[196:199], a[112:115], a[48:51], v[196:199]
v_mfma_f32_16x16x32_bf16 v[196:199], a[116:119], a[52:55], v[196:199]
buffer_load_dwordx4 a[12:15], v2, s[40:43], s33 offen offset:1024 sc1
v_mfma_f32_16x16x32_bf16 v[220:223], a[116:119], a[60:63], v[220:223]
v_mfma_f32_16x16x32_bf16 v[220:223], a[112:115], a[56:59], v[220:223]
s_waitcnt lgkmcnt(0)
v_mfma_f32_16x16x32_bf16 v[224:227], a[128:131], a[56:59], v[224:227]
ds_read_b128 a[96:99], v5 offset:26624
v_mfma_f32_16x16x32_bf16 v[224:227], a[132:135], a[60:63], v[224:227]
buffer_load_dwordx4 a[16:19], v2, s[40:43], s35 offen offset:2048 sc1
v_mfma_f32_16x16x32_bf16 v[200:203], a[132:135], a[52:55], v[200:203]
ds_read_b128 a[100:103], v5 offset:32768
v_mfma_f32_16x16x32_bf16 v[200:203], a[128:131], a[48:51], v[200:203]
v_mfma_f32_16x16x32_bf16 v[176:179], a[128:131], a[40:43], v[176:179]
v_mfma_f32_16x16x32_bf16 v[176:179], a[132:135], a[44:47], v[176:179]
buffer_load_dwordx4 a[20:23], v2, s[40:43], s33 offen offset:2048 sc1
v_mfma_f32_16x16x32_bf16 v[152:155], a[132:135], a[36:39], v[152:155]
ds_read_b128 a[104:107], v5 offset:27648
v_mfma_f32_16x16x32_bf16 v[152:155], a[128:131], a[32:35], v[152:155]
v_mfma_f32_16x16x32_bf16 v[132:135], a[136:139], a[32:35], v[132:135]
ds_read_b128 a[108:111], v5 offset:33792
v_mfma_f32_16x16x32_bf16 v[132:135], a[140:143], a[36:39], v[132:135]
v_mfma_f32_16x16x32_bf16 v[156:159], a[140:143], a[44:47], v[156:159]
buffer_load_dwordx4 v1, s[4:7], s44 offen offset:0 sc1 lds
v_mfma_f32_16x16x32_bf16 v[156:159], a[136:139], a[40:43], v[156:159]
ds_read_b128 a[112:115], v5 offset:28672
v_mfma_f32_16x16x32_bf16 v[180:183], a[136:139], a[48:51], v[180:183]
v_mfma_f32_16x16x32_bf16 v[180:183], a[140:143], a[52:55], v[180:183]
ds_read_b128 a[116:119], v5 offset:34816
v_mfma_f32_16x16x32_bf16 v[204:207], a[140:143], a[60:63], v[204:207]
v_mfma_f32_16x16x32_bf16 v[204:207], a[136:139], a[56:59], v[204:207]
buffer_load_dwordx4 a[24:27], v2, s[40:43], s35 offen offset:3072 sc1
v_mfma_f32_16x16x32_bf16 v[208:211], a[144:147], a[56:59], v[208:211]
v_mfma_f32_16x16x32_bf16 v[208:211], a[148:151], a[60:63], v[208:211]
v_mfma_f32_16x16x32_bf16 v[184:187], a[148:151], a[52:55], v[184:187]
v_mfma_f32_16x16x32_bf16 v[184:187], a[144:147], a[48:51], v[184:187]
v_mfma_f32_16x16x32_bf16 v[160:163], a[144:147], a[40:43], v[160:163]
buffer_load_dwordx4 a[28:31], v2, s[40:43], s33 offen offset:3072 sc1
s_add_u32 s35, s35, 0x4000
v_mfma_f32_16x16x32_bf16 v[160:163], a[148:151], a[44:47], v[160:163]
s_add_u32 s33, s33, 0x4000
v_mfma_f32_16x16x32_bf16 v[136:139], a[148:151], a[36:39], v[136:139]
v_mfma_f32_16x16x32_bf16 v[136:139], a[144:147], a[32:35], v[136:139]
s_waitcnt vmcnt(11) lgkmcnt(0)
v_mfma_f32_16x16x32_bf16 v[140:143], a[96:99], a[64:67], v[140:143]
ds_read_b128 a[128:131], v5 offset:29696
v_mfma_f32_16x16x32_bf16 v[140:143], a[100:103], a[68:71], v[140:143]
buffer_load_dwordx4 a[32:35], v2, s[40:43], s35 offen offset:0 sc1
v_mfma_f32_16x16x32_bf16 v[164:167], a[100:103], a[76:79], v[164:167]
ds_read_b128 a[132:135], v5 offset:35840
v_mfma_f32_16x16x32_bf16 v[164:167], a[96:99], a[72:75], v[164:167]
v_mfma_f32_16x16x32_bf16 v[188:191], a[96:99], a[80:83], v[188:191]
v_mfma_f32_16x16x32_bf16 v[188:191], a[100:103], a[84:87], v[188:191]
buffer_load_dwordx4 a[36:39], v2, s[40:43], s33 offen offset:0 sc1
v_mfma_f32_16x16x32_bf16 v[212:215], a[100:103], a[92:95], v[212:215]
ds_read_b128 a[136:139], v5 offset:24576
v_mfma_f32_16x16x32_bf16 v[212:215], a[96:99], a[88:91], v[212:215]
v_mfma_f32_16x16x32_bf16 v[216:219], a[104:107], a[88:91], v[216:219]
ds_read_b128 a[140:143], v5 offset:30720
v_mfma_f32_16x16x32_bf16 v[216:219], a[108:111], a[92:95], v[216:219]
v_mfma_f32_16x16x32_bf16 v[192:195], a[108:111], a[84:87], v[192:195]
buffer_load_dwordx4 v1, s[4:7], s44 offen offset:1024 sc1 lds
s_add_u32 m0, s18, 0x20000
v_mfma_f32_16x16x32_bf16 v[192:195], a[104:107], a[80:83], v[192:195]
s_add_u32 s44, s50, 0x2820000
ds_read_b128 a[144:147], v5 offset:25600
v_mfma_f32_16x16x32_bf16 v[168:171], a[104:107], a[72:75], v[168:171]
v_mfma_f32_16x16x32_bf16 v[168:171], a[108:111], a[76:79], v[168:171]
ds_read_b128 a[148:151], v5 offset:31744
v_mfma_f32_16x16x32_bf16 v[144:147], a[108:111], a[68:71], v[144:147]
v_mfma_f32_16x16x32_bf16 v[144:147], a[104:107], a[64:67], v[144:147]
buffer_load_dwordx4 a[40:43], v2, s[40:43], s35 offen offset:1024 sc1
v_mfma_f32_16x16x32_bf16 v[148:151], a[112:115], a[64:67], v[148:151]
v_mfma_f32_16x16x32_bf16 v[148:151], a[116:119], a[68:71], v[148:151]
v_mfma_f32_16x16x32_bf16 v[172:175], a[116:119], a[76:79], v[172:175]
v_mfma_f32_16x16x32_bf16 v[172:175], a[112:115], a[72:75], v[172:175]
v_mfma_f32_16x16x32_bf16 v[196:199], a[112:115], a[80:83], v[196:199]
buffer_load_dwordx4 a[44:47], v2, s[40:43], s33 offen offset:1024 sc1
v_mfma_f32_16x16x32_bf16 v[196:199], a[116:119], a[84:87], v[196:199]
v_mfma_f32_16x16x32_bf16 v[220:223], a[116:119], a[92:95], v[220:223]
v_mfma_f32_16x16x32_bf16 v[220:223], a[112:115], a[88:91], v[220:223]
s_waitcnt lgkmcnt(0)
v_mfma_f32_16x16x32_bf16 v[224:227], a[128:131], a[88:91], v[224:227]
ds_read_b128 a[96:99], v5 offset:38912
v_mfma_f32_16x16x32_bf16 v[224:227], a[132:135], a[92:95], v[224:227]
buffer_load_dwordx4 a[48:51], v2, s[40:43], s35 offen offset:2048 sc1
v_mfma_f32_16x16x32_bf16 v[200:203], a[132:135], a[84:87], v[200:203]
ds_read_b128 a[100:103], v5 offset:45056
v_mfma_f32_16x16x32_bf16 v[200:203], a[128:131], a[80:83], v[200:203]
v_mfma_f32_16x16x32_bf16 v[176:179], a[128:131], a[72:75], v[176:179]
v_mfma_f32_16x16x32_bf16 v[176:179], a[132:135], a[76:79], v[176:179]
buffer_load_dwordx4 a[52:55], v2, s[40:43], s33 offen offset:2048 sc1
v_mfma_f32_16x16x32_bf16 v[152:155], a[132:135], a[68:71], v[152:155]
ds_read_b128 a[104:107], v5 offset:39936
v_mfma_f32_16x16x32_bf16 v[152:155], a[128:131], a[64:67], v[152:155]
v_mfma_f32_16x16x32_bf16 v[132:135], a[136:139], a[64:67], v[132:135]
ds_read_b128 a[108:111], v5 offset:46080
v_mfma_f32_16x16x32_bf16 v[132:135], a[140:143], a[68:71], v[132:135]
v_mfma_f32_16x16x32_bf16 v[156:159], a[140:143], a[76:79], v[156:159]
buffer_load_dwordx4 v1, s[4:7], s44 offen offset:0 sc1 lds
v_mfma_f32_16x16x32_bf16 v[156:159], a[136:139], a[72:75], v[156:159]
ds_read_b128 a[112:115], v5 offset:40960
v_mfma_f32_16x16x32_bf16 v[180:183], a[136:139], a[80:83], v[180:183]
v_mfma_f32_16x16x32_bf16 v[180:183], a[140:143], a[84:87], v[180:183]
ds_read_b128 a[116:119], v5 offset:47104
v_mfma_f32_16x16x32_bf16 v[204:207], a[140:143], a[92:95], v[204:207]
v_mfma_f32_16x16x32_bf16 v[204:207], a[136:139], a[88:91], v[204:207]
buffer_load_dwordx4 a[56:59], v2, s[40:43], s35 offen offset:3072 sc1
v_mfma_f32_16x16x32_bf16 v[208:211], a[144:147], a[88:91], v[208:211]
v_mfma_f32_16x16x32_bf16 v[208:211], a[148:151], a[92:95], v[208:211]
v_mfma_f32_16x16x32_bf16 v[184:187], a[148:151], a[84:87], v[184:187]
v_mfma_f32_16x16x32_bf16 v[184:187], a[144:147], a[80:83], v[184:187]
v_mfma_f32_16x16x32_bf16 v[160:163], a[144:147], a[72:75], v[160:163]
buffer_load_dwordx4 a[60:63], v2, s[40:43], s33 offen offset:3072 sc1
s_add_u32 s35, s35, 0x4000
v_mfma_f32_16x16x32_bf16 v[160:163], a[148:151], a[76:79], v[160:163]
s_add_u32 s33, s33, 0x4000
v_mfma_f32_16x16x32_bf16 v[136:139], a[148:151], a[68:71], v[136:139]
v_mfma_f32_16x16x32_bf16 v[136:139], a[144:147], a[64:67], v[136:139]
s_waitcnt vmcnt(10) lgkmcnt(0)
v_mfma_f32_16x16x32_bf16 v[140:143], a[96:99], a[0:3], v[140:143]
ds_read_b128 a[128:131], v5 offset:41984
v_mfma_f32_16x16x32_bf16 v[140:143], a[100:103], a[4:7], v[140:143]
buffer_load_dwordx4 a[64:67], v2, s[40:43], s35 offen offset:0 sc1
v_mfma_f32_16x16x32_bf16 v[164:167], a[100:103], a[12:15], v[164:167]
ds_read_b128 a[132:135], v5 offset:48128
v_mfma_f32_16x16x32_bf16 v[164:167], a[96:99], a[8:11], v[164:167]
v_mfma_f32_16x16x32_bf16 v[188:191], a[96:99], a[16:19], v[188:191]
v_mfma_f32_16x16x32_bf16 v[188:191], a[100:103], a[20:23], v[188:191]
buffer_load_dwordx4 v1, s[4:7], s44 offen offset:1024 sc1 lds
s_add_u32 m0, s18, 0x22000
v_mfma_f32_16x16x32_bf16 v[212:215], a[100:103], a[28:31], v[212:215]
s_add_u32 s44, s50, 0x2822000
ds_read_b128 a[136:139], v5 offset:36864
v_mfma_f32_16x16x32_bf16 v[212:215], a[96:99], a[24:27], v[212:215]
v_mfma_f32_16x16x32_bf16 v[216:219], a[104:107], a[24:27], v[216:219]
ds_read_b128 a[140:143], v5 offset:43008
v_mfma_f32_16x16x32_bf16 v[216:219], a[108:111], a[28:31], v[216:219]
buffer_load_dwordx4 a[68:71], v2, s[40:43], s33 offen offset:0 sc1
v_mfma_f32_16x16x32_bf16 v[192:195], a[108:111], a[20:23], v[192:195]
ds_read_b128 a[144:147], v5 offset:37888
v_mfma_f32_16x16x32_bf16 v[192:195], a[104:107], a[16:19], v[192:195]
v_mfma_f32_16x16x32_bf16 v[168:171], a[104:107], a[8:11], v[168:171]
v_mfma_f32_16x16x32_bf16 v[168:171], a[108:111], a[12:15], v[168:171]
buffer_load_dwordx4 a[72:75], v2, s[40:43], s35 offen offset:1024 sc1
v_mfma_f32_16x16x32_bf16 v[144:147], a[108:111], a[4:7], v[144:147]
ds_read_b128 a[148:151], v5 offset:44032
v_mfma_f32_16x16x32_bf16 v[144:147], a[104:107], a[0:3], v[144:147]
v_mfma_f32_16x16x32_bf16 v[148:151], a[112:115], a[0:3], v[148:151]
v_mfma_f32_16x16x32_bf16 v[148:151], a[116:119], a[4:7], v[148:151]
buffer_load_dwordx4 v1, s[4:7], s44 offen offset:0 sc1 lds
v_mfma_f32_16x16x32_bf16 v[172:175], a[116:119], a[12:15], v[172:175]
v_mfma_f32_16x16x32_bf16 v[172:175], a[112:115], a[8:11], v[172:175]
v_mfma_f32_16x16x32_bf16 v[196:199], a[112:115], a[16:19], v[196:199]
v_mfma_f32_16x16x32_bf16 v[196:199], a[116:119], a[20:23], v[196:199]
buffer_load_dwordx4 a[76:79], v2, s[40:43], s33 offen offset:1024 sc1
v_mfma_f32_16x16x32_bf16 v[220:223], a[116:119], a[28:31], v[220:223]
v_mfma_f32_16x16x32_bf16 v[220:223], a[112:115], a[24:27], v[220:223]
s_waitcnt lgkmcnt(0)
s_barrier
v_mfma_f32_16x16x32_bf16 v[224:227], a[128:131], a[24:27], v[224:227]
v_add_u32 v5, 49152, v1
v_mfma_f32_16x16x32_bf16 v[224:227], a[132:135], a[28:31], v[224:227]
buffer_load_dwordx4 a[80:83], v2, s[40:43], s35 offen offset:2048 sc1
v_mfma_f32_16x16x32_bf16 v[200:203], a[132:135], a[20:23], v[200:203]
ds_read_b128 a[96:99], v5 offset:2048
v_mfma_f32_16x16x32_bf16 v[200:203], a[128:131], a[16:19], v[200:203]
ds_read_b128 a[100:103], v5 offset:8192
v_mfma_f32_16x16x32_bf16 v[176:179], a[128:131], a[8:11], v[176:179]
v_mfma_f32_16x16x32_bf16 v[176:179], a[132:135], a[12:15], v[176:179]
buffer_load_dwordx4 a[84:87], v2, s[40:43], s33 offen offset:2048 sc1
v_mfma_f32_16x16x32_bf16 v[152:155], a[132:135], a[4:7], v[152:155]
ds_read_b128 a[104:107], v5 offset:3072
v_mfma_f32_16x16x32_bf16 v[152:155], a[128:131], a[0:3], v[152:155]
v_mfma_f32_16x16x32_bf16 v[132:135], a[136:139], a[0:3], v[132:135]
ds_read_b128 a[108:111], v5 offset:9216
v_mfma_f32_16x16x32_bf16 v[132:135], a[140:143], a[4:7], v[132:135]
v_mfma_f32_16x16x32_bf16 v[156:159], a[140:143], a[12:15], v[156:159]
buffer_load_dwordx4 v1, s[4:7], s44 offen offset:1024 sc1 lds
s_add_u32 s88, s82, 0x300000
v_mfma_f32_16x16x32_bf16 v[156:159], a[136:139], a[8:11], v[156:159]
ds_read_b128 a[112:115], v5 offset:4096
v_mfma_f32_16x16x32_bf16 v[180:183], a[136:139], a[16:19], v[180:183]
v_mfma_f32_16x16x32_bf16 v[180:183], a[140:143], a[20:23], v[180:183]
ds_read_b128 a[116:119], v5 offset:10240
v_mfma_f32_16x16x32_bf16 v[204:207], a[140:143], a[28:31], v[204:207]
v_mfma_f32_16x16x32_bf16 v[204:207], a[136:139], a[24:27], v[204:207]
buffer_load_dwordx4 a[88:91], v2, s[40:43], s35 offen offset:3072 sc1
v_mfma_f32_16x16x32_bf16 v[208:211], a[144:147], a[24:27], v[208:211]
v_mfma_f32_16x16x32_bf16 v[208:211], a[148:151], a[28:31], v[208:211]
v_mfma_f32_16x16x32_bf16 v[184:187], a[148:151], a[20:23], v[184:187]
v_mfma_f32_16x16x32_bf16 v[184:187], a[144:147], a[16:19], v[184:187]
v_mfma_f32_16x16x32_bf16 v[160:163], a[144:147], a[8:11], v[160:163]
buffer_load_dwordx4 a[92:95], v2, s[40:43], s33 offen offset:3072 sc1
s_add_u32 s35, s35, 0x4000
v_mfma_f32_16x16x32_bf16 v[160:163], a[148:151], a[12:15], v[160:163]
s_add_u32 s33, s33, 0x4000
v_mfma_f32_16x16x32_bf16 v[136:139], a[148:151], a[4:7], v[136:139]
v_mfma_f32_16x16x32_bf16 v[136:139], a[144:147], a[0:3], v[136:139]
s_waitcnt vmcnt(11) lgkmcnt(0)
v_mfma_f32_16x16x32_bf16 v[140:143], a[96:99], a[32:35], v[140:143]
ds_read_b128 a[128:131], v5 offset:5120
v_mfma_f32_16x16x32_bf16 v[140:143], a[100:103], a[36:39], v[140:143]
buffer_load_dwordx4 a[0:3], v2, s[40:43], s35 offen offset:0 sc1
v_mfma_f32_16x16x32_bf16 v[164:167], a[100:103], a[44:47], v[164:167]
ds_read_b128 a[132:135], v5 offset:11264
v_mfma_f32_16x16x32_bf16 v[164:167], a[96:99], a[40:43], v[164:167]
v_mfma_f32_16x16x32_bf16 v[188:191], a[96:99], a[48:51], v[188:191]
v_mfma_f32_16x16x32_bf16 v[188:191], a[100:103], a[52:55], v[188:191]
buffer_load_dwordx4 a[4:7], v2, s[40:43], s33 offen offset:0 sc1
v_mfma_f32_16x16x32_bf16 v[212:215], a[100:103], a[60:63], v[212:215]
ds_read_b128 a[136:139], v5 offset:0
v_mfma_f32_16x16x32_bf16 v[212:215], a[96:99], a[56:59], v[212:215]
v_mfma_f32_16x16x32_bf16 v[216:219], a[104:107], a[56:59], v[216:219]
ds_read_b128 a[140:143], v5 offset:6144
v_mfma_f32_16x16x32_bf16 v[216:219], a[108:111], a[60:63], v[216:219]
v_mfma_f32_16x16x32_bf16 v[192:195], a[108:111], a[52:55], v[192:195]
buffer_load_dwordx4 v[92:95], v1, s[4:7], s88 offen offset:0 sc1
v_mfma_f32_16x16x32_bf16 v[192:195], a[104:107], a[48:51], v[192:195]
ds_read_b128 a[144:147], v5 offset:1024
v_mfma_f32_16x16x32_bf16 v[168:171], a[104:107], a[40:43], v[168:171]
v_mfma_f32_16x16x32_bf16 v[168:171], a[108:111], a[44:47], v[168:171]
ds_read_b128 a[148:151], v5 offset:7168
v_mfma_f32_16x16x32_bf16 v[144:147], a[108:111], a[36:39], v[144:147]
v_mfma_f32_16x16x32_bf16 v[144:147], a[104:107], a[32:35], v[144:147]
buffer_load_dwordx4 a[8:11], v2, s[40:43], s35 offen offset:1024 sc1
v_mfma_f32_16x16x32_bf16 v[148:151], a[112:115], a[32:35], v[148:151]
v_mfma_f32_16x16x32_bf16 v[148:151], a[116:119], a[36:39], v[148:151]
v_mfma_f32_16x16x32_bf16 v[172:175], a[116:119], a[44:47], v[172:175]
v_mfma_f32_16x16x32_bf16 v[172:175], a[112:115], a[40:43], v[172:175]
v_mfma_f32_16x16x32_bf16 v[196:199], a[112:115], a[48:51], v[196:199]
buffer_load_dwordx4 a[12:15], v2, s[40:43], s33 offen offset:1024 sc1
v_mfma_f32_16x16x32_bf16 v[196:199], a[116:119], a[52:55], v[196:199]
v_mfma_f32_16x16x32_bf16 v[220:223], a[116:119], a[60:63], v[220:223]
v_mfma_f32_16x16x32_bf16 v[220:223], a[112:115], a[56:59], v[220:223]
s_waitcnt lgkmcnt(0)
v_mfma_f32_16x16x32_bf16 v[224:227], a[128:131], a[56:59], v[224:227]
ds_read_b128 a[96:99], v5 offset:14336
v_mfma_f32_16x16x32_bf16 v[224:227], a[132:135], a[60:63], v[224:227]
buffer_load_dwordx4 a[16:19], v2, s[40:43], s35 offen offset:2048 sc1
v_mfma_f32_16x16x32_bf16 v[200:203], a[132:135], a[52:55], v[200:203]
ds_read_b128 a[100:103], v5 offset:20480
v_mfma_f32_16x16x32_bf16 v[200:203], a[128:131], a[48:51], v[200:203]
v_mfma_f32_16x16x32_bf16 v[176:179], a[128:131], a[40:43], v[176:179]
v_mfma_f32_16x16x32_bf16 v[176:179], a[132:135], a[44:47], v[176:179]
buffer_load_dwordx4 a[20:23], v2, s[40:43], s33 offen offset:2048 sc1
v_mfma_f32_16x16x32_bf16 v[152:155], a[132:135], a[36:39], v[152:155]
ds_read_b128 a[104:107], v5 offset:15360
v_mfma_f32_16x16x32_bf16 v[152:155], a[128:131], a[32:35], v[152:155]
v_mfma_f32_16x16x32_bf16 v[132:135], a[136:139], a[32:35], v[132:135]
ds_read_b128 a[108:111], v5 offset:21504
v_mfma_f32_16x16x32_bf16 v[132:135], a[140:143], a[36:39], v[132:135]
v_mfma_f32_16x16x32_bf16 v[156:159], a[140:143], a[44:47], v[156:159]
buffer_load_dwordx4 v[96:99], v1, s[4:7], s88 offen offset:1024 sc1
v_mfma_f32_16x16x32_bf16 v[156:159], a[136:139], a[40:43], v[156:159]
ds_read_b128 a[112:115], v5 offset:16384
v_mfma_f32_16x16x32_bf16 v[180:183], a[136:139], a[48:51], v[180:183]
v_mfma_f32_16x16x32_bf16 v[180:183], a[140:143], a[52:55], v[180:183]
ds_read_b128 a[116:119], v5 offset:22528
v_mfma_f32_16x16x32_bf16 v[204:207], a[140:143], a[60:63], v[204:207]
v_mfma_f32_16x16x32_bf16 v[204:207], a[136:139], a[56:59], v[204:207]
buffer_load_dwordx4 a[24:27], v2, s[40:43], s35 offen offset:3072 sc1
v_mfma_f32_16x16x32_bf16 v[208:211], a[144:147], a[56:59], v[208:211]
v_mfma_f32_16x16x32_bf16 v[208:211], a[148:151], a[60:63], v[208:211]
v_mfma_f32_16x16x32_bf16 v[184:187], a[148:151], a[52:55], v[184:187]
v_mfma_f32_16x16x32_bf16 v[184:187], a[144:147], a[48:51], v[184:187]
v_mfma_f32_16x16x32_bf16 v[160:163], a[144:147], a[40:43], v[160:163]
buffer_load_dwordx4 a[28:31], v2, s[40:43], s33 offen offset:3072 sc1
s_add_u32 s35, s35, 0x4000
v_mfma_f32_16x16x32_bf16 v[160:163], a[148:151], a[44:47], v[160:163]
s_add_u32 s33, s33, 0x4000
v_mfma_f32_16x16x32_bf16 v[136:139], a[148:151], a[36:39], v[136:139]
v_mfma_f32_16x16x32_bf16 v[136:139], a[144:147], a[32:35], v[136:139]
s_waitcnt vmcnt(10) lgkmcnt(0)
v_mfma_f32_16x16x32_bf16 v[140:143], a[96:99], a[64:67], v[140:143]
ds_read_b128 a[128:131], v5 offset:17408
v_mfma_f32_16x16x32_bf16 v[140:143], a[100:103], a[68:71], v[140:143]
buffer_load_dwordx4 a[32:35], v2, s[40:43], s35 offen offset:0 sc1
v_mfma_f32_16x16x32_bf16 v[164:167], a[100:103], a[76:79], v[164:167]
ds_read_b128 a[132:135], v5 offset:23552
L_stub5:
s_cbranch_execz L_stub6
v_mfma_f32_16x16x32_bf16 v[164:167], a[96:99], a[72:75], v[164:167]
v_mfma_f32_16x16x32_bf16 v[188:191], a[96:99], a[80:83], v[188:191]
v_mfma_f32_16x16x32_bf16 v[188:191], a[100:103], a[84:87], v[188:191]
buffer_load_dwordx4 v[100:103], v1, s[4:7], s88 offen offset:2048 sc1
v_mfma_f32_16x16x32_bf16 v[212:215], a[100:103], a[92:95], v[212:215]
ds_read_b128 a[136:139], v5 offset:12288
v_mfma_f32_16x16x32_bf16 v[212:215], a[96:99], a[88:91], v[212:215]
v_mfma_f32_16x16x32_bf16 v[216:219], a[104:107], a[88:91], v[216:219]
ds_read_b128 a[140:143], v5 offset:18432
v_mfma_f32_16x16x32_bf16 v[216:219], a[108:111], a[92:95], v[216:219]
buffer_load_dwordx4 a[36:39], v2, s[40:43], s33 offen offset:0 sc1
v_mfma_f32_16x16x32_bf16 v[192:195], a[108:111], a[84:87], v[192:195]
ds_read_b128 a[144:147], v5 offset:13312
v_mfma_f32_16x16x32_bf16 v[192:195], a[104:107], a[80:83], v[192:195]
v_mfma_f32_16x16x32_bf16 v[168:171], a[104:107], a[72:75], v[168:171]
v_mfma_f32_16x16x32_bf16 v[168:171], a[108:111], a[76:79], v[168:171]
buffer_load_dwordx4 a[40:43], v2, s[40:43], s35 offen offset:1024 sc1
v_mfma_f32_16x16x32_bf16 v[144:147], a[108:111], a[68:71], v[144:147]
ds_read_b128 a[148:151], v5 offset:19456
v_mfma_f32_16x16x32_bf16 v[144:147], a[104:107], a[64:67], v[144:147]
v_mfma_f32_16x16x32_bf16 v[148:151], a[112:115], a[64:67], v[148:151]
v_mfma_f32_16x16x32_bf16 v[148:151], a[116:119], a[68:71], v[148:151]
buffer_load_dwordx4 v[104:107], v1, s[4:7], s88 offen offset:3072 sc1
s_add_u32 s88, s88, 4096
v_mfma_f32_16x16x32_bf16 v[172:175], a[116:119], a[76:79], v[172:175]
v_mfma_f32_16x16x32_bf16 v[172:175], a[112:115], a[72:75], v[172:175]
v_mfma_f32_16x16x32_bf16 v[196:199], a[112:115], a[80:83], v[196:199]
v_mfma_f32_16x16x32_bf16 v[196:199], a[116:119], a[84:87], v[196:199]
buffer_load_dwordx4 a[44:47], v2, s[40:43], s33 offen offset:1024 sc1
v_mfma_f32_16x16x32_bf16 v[220:223], a[116:119], a[92:95], v[220:223]
v_mfma_f32_16x16x32_bf16 v[220:223], a[112:115], a[88:91], v[220:223]
s_waitcnt lgkmcnt(0)
v_mfma_f32_16x16x32_bf16 v[224:227], a[128:131], a[88:91], v[224:227]
ds_read_b128 a[96:99], v5 offset:26624
v_mfma_f32_16x16x32_bf16 v[224:227], a[132:135], a[92:95], v[224:227]
buffer_load_dwordx4 a[48:51], v2, s[40:43], s35 offen offset:2048 sc1
v_mfma_f32_16x16x32_bf16 v[200:203], a[132:135], a[84:87], v[200:203]
ds_read_b128 a[100:103], v5 offset:32768
v_mfma_f32_16x16x32_bf16 v[200:203], a[128:131], a[80:83], v[200:203]
v_mfma_f32_16x16x32_bf16 v[176:179], a[128:131], a[72:75], v[176:179]
v_mfma_f32_16x16x32_bf16 v[176:179], a[132:135], a[76:79], v[176:179]
buffer_load_dwordx4 a[52:55], v2, s[40:43], s33 offen offset:2048 sc1
v_mfma_f32_16x16x32_bf16 v[152:155], a[132:135], a[68:71], v[152:155]
ds_read_b128 a[104:107], v5 offset:27648
v_mfma_f32_16x16x32_bf16 v[152:155], a[128:131], a[64:67], v[152:155]
v_mfma_f32_16x16x32_bf16 v[132:135], a[136:139], a[64:67], v[132:135]
ds_read_b128 a[108:111], v5 offset:33792
v_mfma_f32_16x16x32_bf16 v[132:135], a[140:143], a[68:71], v[132:135]
v_mfma_f32_16x16x32_bf16 v[156:159], a[140:143], a[76:79], v[156:159]
buffer_load_dwordx4 v[108:111], v1, s[4:7], s88 offen offset:0 sc1
v_mfma_f32_16x16x32_bf16 v[156:159], a[136:139], a[72:75], v[156:159]
ds_read_b128 a[112:115], v5 offset:28672
v_mfma_f32_16x16x32_bf16 v[180:183], a[136:139], a[80:83], v[180:183]
v_mfma_f32_16x16x32_bf16 v[180:183], a[140:143], a[84:87], v[180:183]
ds_read_b128 a[116:119], v5 offset:34816
v_mfma_f32_16x16x32_bf16 v[204:207], a[140:143], a[92:95], v[204:207]
v_mfma_f32_16x16x32_bf16 v[204:207], a[136:139], a[88:91], v[204:207]
buffer_load_dwordx4 a[56:59], v2, s[40:43], s35 offen offset:3072 sc1
v_mfma_f32_16x16x32_bf16 v[208:211], a[144:147], a[88:91], v[208:211]
v_mfma_f32_16x16x32_bf16 v[208:211], a[148:151], a[92:95], v[208:211]
v_mfma_f32_16x16x32_bf16 v[184:187], a[148:151], a[84:87], v[184:187]
v_mfma_f32_16x16x32_bf16 v[184:187], a[144:147], a[80:83], v[184:187]
v_mfma_f32_16x16x32_bf16 v[160:163], a[144:147], a[72:75], v[160:163]
buffer_load_dwordx4 a[60:63], v2, s[40:43], s33 offen offset:3072 sc1
s_add_u32 s35, s35, 0x64000
v_mfma_f32_16x16x32_bf16 v[160:163], a[148:151], a[76:79], v[160:163]
s_add_u32 s33, s33, 0x64000
v_mfma_f32_16x16x32_bf16 v[136:139], a[148:151], a[68:71], v[136:139]
v_mfma_f32_16x16x32_bf16 v[136:139], a[144:147], a[64:67], v[136:139]
s_waitcnt vmcnt(11) lgkmcnt(0)
v_mfma_f32_16x16x32_bf16 v[140:143], a[96:99], a[0:3], v[140:143]
ds_read_b128 a[128:131], v5 offset:29696
v_add_f32_dpp v48, v48, v48 row_ror:8 row_mask:0xf bank_mask:0xf
v_mfma_f32_16x16x32_bf16 v[140:143], a[100:103], a[4:7], v[140:143]
buffer_load_dwordx4 a[64:67], v2, s[40:43], s35 offen offset:0 sc1
v_mfma_f32_16x16x32_bf16 v[164:167], a[100:103], a[12:15], v[164:167]
ds_read_b128 a[132:135], v5 offset:35840
v_add_f32_dpp v49, v49, v49 row_ror:8 row_mask:0xf bank_mask:0xf
v_mfma_f32_16x16x32_bf16 v[164:167], a[96:99], a[8:11], v[164:167]
v_add_f32_dpp v50, v50, v50 row_ror:8 row_mask:0xf bank_mask:0xf
v_add_f32_dpp v51, v51, v51 row_ror:8 row_mask:0xf bank_mask:0xf
v_mfma_f32_16x16x32_bf16 v[188:191], a[96:99], a[16:19], v[188:191]
v_add_f32_dpp v52, v52, v52 row_ror:8 row_mask:0xf bank_mask:0xf
v_add_f32_dpp v53, v53, v53 row_ror:8 row_mask:0xf bank_mask:0xf
v_mfma_f32_16x16x32_bf16 v[188:191], a[100:103], a[20:23], v[188:191]
buffer_load_dwordx4 a[68:71], v2, s[40:43], s33 offen offset:0 sc1
v_mfma_f32_16x16x32_bf16 v[212:215], a[100:103], a[28:31], v[212:215]
ds_read_b128 a[136:139], v5 offset:24576
v_add_f32_dpp v54, v54, v54 row_ror:8 row_mask:0xf bank_mask:0xf
v_mfma_f32_16x16x32_bf16 v[212:215], a[96:99], a[24:27], v[212:215]
v_add_f32_dpp v55, v55, v55 row_ror:8 row_mask:0xf bank_mask:0xf
v_add_f32_dpp v48, v48, v48 row_ror:4 row_mask:0xf bank_mask:0xf
v_mfma_f32_16x16x32_bf16 v[216:219], a[104:107], a[24:27], v[216:219]
ds_read_b128 a[140:143], v5 offset:30720
v_add_f32_dpp v49, v49, v49 row_ror:4 row_mask:0xf bank_mask:0xf
v_mfma_f32_16x16x32_bf16 v[216:219], a[108:111], a[28:31], v[216:219]
v_add_f32_dpp v50, v50, v50 row_ror:4 row_mask:0xf bank_mask:0xf
v_mfma_f32_16x16x32_bf16 v[192:195], a[108:111], a[20:23], v[192:195]
buffer_load_dwordx4 v[112:115], v1, s[4:7], s88 offen offset:1024 sc1
v_mfma_f32_16x16x32_bf16 v[192:195], a[104:107], a[16:19], v[192:195]
ds_read_b128 a[144:147], v5 offset:25600
v_add_f32_dpp v51, v51, v51 row_ror:4 row_mask:0xf bank_mask:0xf
v_mfma_f32_16x16x32_bf16 v[168:171], a[104:107], a[8:11], v[168:171]
v_add_f32_dpp v52, v52, v52 row_ror:4 row_mask:0xf bank_mask:0xf
v_add_f32_dpp v53, v53, v53 row_ror:4 row_mask:0xf bank_mask:0xf
v_mfma_f32_16x16x32_bf16 v[168:171], a[108:111], a[12:15], v[168:171]
ds_read_b128 a[148:151], v5 offset:31744
v_add_f32_dpp v54, v54, v54 row_ror:4 row_mask:0xf bank_mask:0xf
v_mfma_f32_16x16x32_bf16 v[144:147], a[108:111], a[4:7], v[144:147]
v_add_f32_dpp v55, v55, v55 row_ror:4 row_mask:0xf bank_mask:0xf
v_mfma_f32_16x16x32_bf16 v[144:147], a[104:107], a[0:3], v[144:147]
buffer_load_dwordx4 a[72:75], v2, s[40:43], s35 offen offset:1024 sc1
v_mfma_f32_16x16x32_bf16 v[148:151], a[112:115], a[0:3], v[148:151]
v_add_f32_dpp v48, v48, v48 row_ror:2 row_mask:0xf bank_mask:0xf
v_add_f32_dpp v49, v49, v49 row_ror:2 row_mask:0xf bank_mask:0xf
v_mfma_f32_16x16x32_bf16 v[148:151], a[116:119], a[4:7], v[148:151]
v_add_f32_dpp v50, v50, v50 row_ror:2 row_mask:0xf bank_mask:0xf
v_mfma_f32_16x16x32_bf16 v[172:175], a[116:119], a[12:15], v[172:175]
v_add_f32_dpp v51, v51, v51 row_ror:2 row_mask:0xf bank_mask:0xf
v_mfma_f32_16x16x32_bf16 v[172:175], a[112:115], a[8:11], v[172:175]
v_add_f32_dpp v52, v52, v52 row_ror:2 row_mask:0xf bank_mask:0xf
v_mfma_f32_16x16x32_bf16 v[196:199], a[112:115], a[16:19], v[196:199]
buffer_load_dwordx4 a[76:79], v2, s[40:43], s33 offen offset:1024 sc1
v_mfma_f32_16x16x32_bf16 v[196:199], a[116:119], a[20:23], v[196:199]
v_add_f32_dpp v53, v53, v53 row_ror:2 row_mask:0xf bank_mask:0xf
v_add_f32_dpp v54, v54, v54 row_ror:2 row_mask:0xf bank_mask:0xf
v_mfma_f32_16x16x32_bf16 v[220:223], a[116:119], a[28:31], v[220:223]
v_add_f32_dpp v55, v55, v55 row_ror:2 row_mask:0xf bank_mask:0xf
v_mfma_f32_16x16x32_bf16 v[220:223], a[112:115], a[24:27], v[220:223]
v_add_f32_dpp v48, v48, v48 row_ror:1 row_mask:0xf bank_mask:0xf
s_waitcnt lgkmcnt(0)
v_mfma_f32_16x16x32_bf16 v[224:227], a[128:131], a[24:27], v[224:227]
ds_read_b128 a[96:99], v5 offset:38912
v_add_f32_dpp v49, v49, v49 row_ror:1 row_mask:0xf bank_mask:0xf
v_mfma_f32_16x16x32_bf16 v[224:227], a[132:135], a[28:31], v[224:227]
buffer_load_dwordx4 a[80:83], v2, s[40:43], s35 offen offset:2048 sc1
v_mfma_f32_16x16x32_bf16 v[200:203], a[132:135], a[20:23], v[200:203]
ds_read_b128 a[100:103], v5 offset:45056
v_add_f32_dpp v50, v50, v50 row_ror:1 row_mask:0xf bank_mask:0xf
v_mfma_f32_16x16x32_bf16 v[200:203], a[128:131], a[16:19], v[200:203]
v_add_f32_dpp v51, v51, v51 row_ror:1 row_mask:0xf bank_mask:0xf
v_add_f32_dpp v52, v52, v52 row_ror:1 row_mask:0xf bank_mask:0xf
v_mfma_f32_16x16x32_bf16 v[176:179], a[128:131], a[8:11], v[176:179]
v_add_f32_dpp v53, v53, v53 row_ror:1 row_mask:0xf bank_mask:0xf
v_add_f32_dpp v54, v54, v54 row_ror:1 row_mask:0xf bank_mask:0xf
v_mfma_f32_16x16x32_bf16 v[176:179], a[132:135], a[12:15], v[176:179]
buffer_load_dwordx4 a[84:87], v2, s[40:43], s33 offen offset:2048 sc1
v_mfma_f32_16x16x32_bf16 v[152:155], a[132:135], a[4:7], v[152:155]
ds_read_b128 a[104:107], v5 offset:39936
v_add_f32_dpp v55, v55, v55 row_ror:1 row_mask:0xf bank_mask:0xf
v_mfma_f32_16x16x32_bf16 v[152:155], a[128:131], a[0:3], v[152:155]
v_add_u32 v233, 159744, v233
s_lshl_b32 s36, s28, 6
v_mfma_f32_16x16x32_bf16 v[132:135], a[136:139], a[0:3], v[132:135]
ds_read_b128 a[108:111], v5 offset:46080
s_lshl_b32 s37, s39, 6
v_mfma_f32_16x16x32_bf16 v[132:135], a[140:143], a[4:7], v[132:135]
v_add_u32 v232, s36, v233
v_mfma_f32_16x16x32_bf16 v[156:159], a[140:143], a[12:15], v[156:159]
buffer_load_dwordx4 v[116:119], v1, s[4:7], s88 offen offset:2048 sc1
v_mfma_f32_16x16x32_bf16 v[156:159], a[136:139], a[8:11], v[156:159]
ds_read_b128 a[112:115], v5 offset:40960
v_add_u32 v235, s37, v233
v_mfma_f32_16x16x32_bf16 v[180:183], a[136:139], a[16:19], v[180:183]
v_mfma_f32_16x16x32_bf16 v[180:183], a[140:143], a[20:23], v[180:183]
ds_read_b128 a[116:119], v5 offset:47104
v_mfma_f32_16x16x32_bf16 v[204:207], a[140:143], a[28:31], v[204:207]
v_mfma_f32_16x16x32_bf16 v[204:207], a[136:139], a[24:27], v[204:207]
buffer_load_dwordx4 a[88:91], v2, s[40:43], s35 offen offset:3072 sc1
v_mfma_f32_16x16x32_bf16 v[208:211], a[144:147], a[24:27], v[208:211]
v_mfma_f32_16x16x32_bf16 v[208:211], a[148:151], a[28:31], v[208:211]
v_mfma_f32_16x16x32_bf16 v[184:187], a[148:151], a[20:23], v[184:187]
v_mfma_f32_16x16x32_bf16 v[184:187], a[144:147], a[16:19], v[184:187]
v_mfma_f32_16x16x32_bf16 v[160:163], a[144:147], a[8:11], v[160:163]
buffer_load_dwordx4 a[92:95], v2, s[40:43], s33 offen offset:3072 sc1
s_add_u32 s35, s35, 0x4000
v_mfma_f32_16x16x32_bf16 v[160:163], a[148:151], a[12:15], v[160:163]
s_add_u32 s33, s33, 0x4000
v_mfma_f32_16x16x32_bf16 v[136:139], a[148:151], a[4:7], v[136:139]
v_mfma_f32_16x16x32_bf16 v[136:139], a[144:147], a[0:3], v[136:139]
s_waitcnt vmcnt(10) lgkmcnt(0)
v_mfma_f32_16x16x32_bf16 v[140:143], a[96:99], a[32:35], v[140:143]
ds_read_b128 a[128:131], v5 offset:41984
v_mfma_f32_16x16x32_bf16 v[140:143], a[100:103], a[36:39], v[140:143]
buffer_load_dwordx4 a[0:3], v2, s[40:43], s35 offen offset:0 sc1
v_mfma_f32_16x16x32_bf16 v[164:167], a[100:103], a[44:47], v[164:167]
ds_read_b128 a[132:135], v5 offset:48128
v_mfma_f32_16x16x32_bf16 v[164:167], a[96:99], a[40:43], v[164:167]
ds_write_b128 v232, v[48:51]
v_mfma_f32_16x16x32_bf16 v[188:191], a[96:99], a[48:51], v[188:191]
ds_write_b128 v235, v[52:55]
v_mfma_f32_16x16x32_bf16 v[188:191], a[100:103], a[52:55], v[188:191]
buffer_load_dwordx4 v[120:123], v1, s[4:7], s88 offen offset:3072 sc1
s_add_u32 m0, s18, 0x0
v_mfma_f32_16x16x32_bf16 v[212:215], a[100:103], a[60:63], v[212:215]
s_add_u32 s44, s50, 0x2824000
ds_read_b128 a[136:139], v5 offset:36864
v_mfma_f32_16x16x32_bf16 v[212:215], a[96:99], a[56:59], v[212:215]
v_mfma_f32_16x16x32_bf16 v[216:219], a[104:107], a[56:59], v[216:219]
ds_read_b128 a[140:143], v5 offset:43008
v_mfma_f32_16x16x32_bf16 v[216:219], a[108:111], a[60:63], v[216:219]
buffer_load_dwordx4 a[4:7], v2, s[40:43], s33 offen offset:0 sc1
v_mfma_f32_16x16x32_bf16 v[192:195], a[108:111], a[52:55], v[192:195]
ds_read_b128 a[144:147], v5 offset:37888
v_mfma_f32_16x16x32_bf16 v[192:195], a[104:107], a[48:51], v[192:195]
v_mfma_f32_16x16x32_bf16 v[168:171], a[104:107], a[40:43], v[168:171]
v_mfma_f32_16x16x32_bf16 v[168:171], a[108:111], a[44:47], v[168:171]
buffer_load_dwordx4 a[8:11], v2, s[40:43], s35 offen offset:1024 sc1
v_mfma_f32_16x16x32_bf16 v[144:147], a[108:111], a[36:39], v[144:147]
ds_read_b128 a[148:151], v5 offset:44032
v_mfma_f32_16x16x32_bf16 v[144:147], a[104:107], a[32:35], v[144:147]
v_mfma_f32_16x16x32_bf16 v[148:151], a[112:115], a[32:35], v[148:151]
v_mfma_f32_16x16x32_bf16 v[148:151], a[116:119], a[36:39], v[148:151]
buffer_load_dwordx4 v1, s[4:7], s44 offen offset:0 sc1 lds
v_mfma_f32_16x16x32_bf16 v[172:175], a[116:119], a[44:47], v[172:175]
v_mfma_f32_16x16x32_bf16 v[172:175], a[112:115], a[40:43], v[172:175]
v_mfma_f32_16x16x32_bf16 v[196:199], a[112:115], a[48:51], v[196:199]
v_mfma_f32_16x16x32_bf16 v[196:199], a[116:119], a[52:55], v[196:199]
buffer_load_dwordx4 a[12:15], v2, s[40:43], s33 offen offset:1024 sc1
v_mfma_f32_16x16x32_bf16 v[220:223], a[116:119], a[60:63], v[220:223]
v_mfma_f32_16x16x32_bf16 v[220:223], a[112:115], a[56:59], v[220:223]
s_waitcnt lgkmcnt(0)
s_barrier
v_mfma_f32_16x16x32_bf16 v[224:227], a[128:131], a[56:59], v[224:227]
v_add_u32 v5, 98304, v1
v_mfma_f32_16x16x32_bf16 v[224:227], a[132:135], a[60:63], v[224:227]
buffer_load_dwordx4 a[16:19], v2, s[40:43], s35 offen offset:2048 sc1
v_mfma_f32_16x16x32_bf16 v[200:203], a[132:135], a[52:55], v[200:203]
ds_read_b128 a[96:99], v5 offset:2048
v_mfma_f32_16x16x32_bf16 v[200:203], a[128:131], a[48:51], v[200:203]
ds_read_b128 a[100:103], v5 offset:8192
v_mfma_f32_16x16x32_bf16 v[176:179], a[128:131], a[40:43], v[176:179]
ds_read_b128 v[48:51], v233 offset:0
v_mfma_f32_16x16x32_bf16 v[176:179], a[132:135], a[44:47], v[176:179]
buffer_load_dwordx4 a[20:23], v2, s[40:43], s33 offen offset:2048 sc1
v_mfma_f32_16x16x32_bf16 v[152:155], a[132:135], a[36:39], v[152:155]
ds_read_b128 a[104:107], v5 offset:3072
v_mfma_f32_16x16x32_bf16 v[152:155], a[128:131], a[32:35], v[152:155]
v_mfma_f32_16x16x32_bf16 v[132:135], a[136:139], a[32:35], v[132:135]
ds_read_b128 a[108:111], v5 offset:9216
v_mfma_f32_16x16x32_bf16 v[132:135], a[140:143], a[36:39], v[132:135]
v_mfma_f32_16x16x32_bf16 v[156:159], a[140:143], a[44:47], v[156:159]
buffer_load_dwordx4 v1, s[4:7], s44 offen offset:1024 sc1 lds
s_add_u32 m0, s18, 0x2000
v_mfma_f32_16x16x32_bf16 v[156:159], a[136:139], a[40:43], v[156:159]
s_add_u32 s44, s50, 0x2826000
ds_read_b128 a[112:115], v5 offset:4096
v_mfma_f32_16x16x32_bf16 v[180:183], a[136:139], a[48:51], v[180:183]
ds_read_b128 v[52:55], v233 offset:64
v_mfma_f32_16x16x32_bf16 v[180:183], a[140:143], a[52:55], v[180:183]
ds_read_b128 a[116:119], v5 offset:10240
v_mfma_f32_16x16x32_bf16 v[204:207], a[140:143], a[60:63], v[204:207]
v_mfma_f32_16x16x32_bf16 v[204:207], a[136:139], a[56:59], v[204:207]
buffer_load_dwordx4 a[24:27], v2, s[40:43], s35 offen offset:3072 sc1
v_mfma_f32_16x16x32_bf16 v[208:211], a[144:147], a[56:59], v[208:211]
v_mfma_f32_16x16x32_bf16 v[208:211], a[148:151], a[60:63], v[208:211]
v_mfma_f32_16x16x32_bf16 v[184:187], a[148:151], a[52:55], v[184:187]
v_mfma_f32_16x16x32_bf16 v[184:187], a[144:147], a[48:51], v[184:187]
v_mfma_f32_16x16x32_bf16 v[160:163], a[144:147], a[40:43], v[160:163]
buffer_load_dwordx4 a[28:31], v2, s[40:43], s33 offen offset:3072 sc1
s_add_u32 s35, s35, 0x4000
v_mfma_f32_16x16x32_bf16 v[160:163], a[148:151], a[44:47], v[160:163]
s_add_u32 s33, s33, 0x4000
ds_read_b128 v[56:59], v233 offset:128
v_mfma_f32_16x16x32_bf16 v[136:139], a[148:151], a[36:39], v[136:139]
v_mfma_f32_16x16x32_bf16 v[136:139], a[144:147], a[32:35], v[136:139]
s_waitcnt vmcnt(11) lgkmcnt(1)
v_mfma_f32_16x16x32_bf16 v[140:143], a[96:99], a[64:67], v[140:143]
ds_read_b128 a[128:131], v5 offset:5120
v_mfma_f32_16x16x32_bf16 v[140:143], a[100:103], a[68:71], v[140:143]
buffer_load_dwordx4 a[32:35], v2, s[40:43], s35 offen offset:0 sc1
v_mfma_f32_16x16x32_bf16 v[164:167], a[100:103], a[76:79], v[164:167]
ds_read_b128 a[132:135], v5 offset:11264
v_mfma_f32_16x16x32_bf16 v[164:167], a[96:99], a[72:75], v[164:167]
v_mfma_f32_16x16x32_bf16 v[188:191], a[96:99], a[80:83], v[188:191]
v_mfma_f32_16x16x32_bf16 v[188:191], a[100:103], a[84:87], v[188:191]
buffer_load_dwordx4 a[36:39], v2, s[40:43], s33 offen offset:0 sc1
v_mfma_f32_16x16x32_bf16 v[212:215], a[100:103], a[92:95], v[212:215]
ds_read_b128 a[136:139], v5 offset:0
v_mfma_f32_16x16x32_bf16 v[212:215], a[96:99], a[88:91], v[212:215]
v_mfma_f32_16x16x32_bf16 v[216:219], a[104:107], a[88:91], v[216:219]
ds_read_b128 a[140:143], v5 offset:6144
v_mfma_f32_16x16x32_bf16 v[216:219], a[108:111], a[92:95], v[216:219]
ds_read_b128 v[60:63], v233 offset:192
v_mfma_f32_16x16x32_bf16 v[192:195], a[108:111], a[84:87], v[192:195]
buffer_load_dwordx4 v1, s[4:7], s44 offen offset:0 sc1 lds
v_mfma_f32_16x16x32_bf16 v[192:195], a[104:107], a[80:83], v[192:195]
ds_read_b128 a[144:147], v5 offset:1024
v_mfma_f32_16x16x32_bf16 v[168:171], a[104:107], a[72:75], v[168:171]
v_mfma_f32_16x16x32_bf16 v[168:171], a[108:111], a[76:79], v[168:171]
ds_read_b128 a[148:151], v5 offset:7168
v_mfma_f32_16x16x32_bf16 v[144:147], a[108:111], a[68:71], v[144:147]
v_mfma_f32_16x16x32_bf16 v[144:147], a[104:107], a[64:67], v[144:147]
buffer_load_dwordx4 a[40:43], v2, s[40:43], s35 offen offset:1024 sc1
v_mfma_f32_16x16x32_bf16 v[148:151], a[112:115], a[64:67], v[148:151]
v_mfma_f32_16x16x32_bf16 v[148:151], a[116:119], a[68:71], v[148:151]
v_mfma_f32_16x16x32_bf16 v[172:175], a[116:119], a[76:79], v[172:175]
ds_read_b128 v[64:67], v233 offset:256
v_mfma_f32_16x16x32_bf16 v[172:175], a[112:115], a[72:75], v[172:175]
v_mfma_f32_16x16x32_bf16 v[196:199], a[112:115], a[80:83], v[196:199]
buffer_load_dwordx4 a[44:47], v2, s[40:43], s33 offen offset:1024 sc1
v_mfma_f32_16x16x32_bf16 v[196:199], a[116:119], a[84:87], v[196:199]
v_mfma_f32_16x16x32_bf16 v[220:223], a[116:119], a[92:95], v[220:223]
v_mfma_f32_16x16x32_bf16 v[220:223], a[112:115], a[88:91], v[220:223]
s_waitcnt lgkmcnt(1)
v_mfma_f32_16x16x32_bf16 v[224:227], a[128:131], a[88:91], v[224:227]
ds_read_b128 a[96:99], v5 offset:14336
v_mfma_f32_16x16x32_bf16 v[224:227], a[132:135], a[92:95], v[224:227]
buffer_load_dwordx4 a[48:51], v2, s[40:43], s35 offen offset:2048 sc1
v_mfma_f32_16x16x32_bf16 v[200:203], a[132:135], a[84:87], v[200:203]
ds_read_b128 a[100:103], v5 offset:20480
v_mfma_f32_16x16x32_bf16 v[200:203], a[128:131], a[80:83], v[200:203]
v_mfma_f32_16x16x32_bf16 v[176:179], a[128:131], a[72:75], v[176:179]
v_mfma_f32_16x16x32_bf16 v[176:179], a[132:135], a[76:79], v[176:179]
buffer_load_dwordx4 a[52:55], v2, s[40:43], s33 offen offset:2048 sc1
v_mfma_f32_16x16x32_bf16 v[152:155], a[132:135], a[68:71], v[152:155]
ds_read_b128 a[104:107], v5 offset:15360
v_mfma_f32_16x16x32_bf16 v[152:155], a[128:131], a[64:67], v[152:155]
ds_read_b128 v[68:71], v233 offset:320
v_mfma_f32_16x16x32_bf16 v[132:135], a[136:139], a[64:67], v[132:135]
ds_read_b128 a[108:111], v5 offset:21504
v_mfma_f32_16x16x32_bf16 v[132:135], a[140:143], a[68:71], v[132:135]
v_mfma_f32_16x16x32_bf16 v[156:159], a[140:143], a[76:79], v[156:159]
buffer_load_dwordx4 v1, s[4:7], s44 offen offset:1024 sc1 lds
s_add_u32 m0, s18, 0x4000
v_mfma_f32_16x16x32_bf16 v[156:159], a[136:139], a[72:75], v[156:159]
s_add_u32 s44, s50, 0x2828000
ds_read_b128 a[112:115], v5 offset:16384
v_mfma_f32_16x16x32_bf16 v[180:183], a[136:139], a[80:83], v[180:183]
v_mfma_f32_16x16x32_bf16 v[180:183], a[140:143], a[84:87], v[180:183]
ds_read_b128 a[116:119], v5 offset:22528
v_mfma_f32_16x16x32_bf16 v[204:207], a[140:143], a[92:95], v[204:207]
v_mfma_f32_16x16x32_bf16 v[204:207], a[136:139], a[88:91], v[204:207]
buffer_load_dwordx4 a[56:59], v2, s[40:43], s35 offen offset:3072 sc1
v_mfma_f32_16x16x32_bf16 v[208:211], a[144:147], a[88:91], v[208:211]
v_mfma_f32_16x16x32_bf16 v[208:211], a[148:151], a[92:95], v[208:211]
v_mfma_f32_16x16x32_bf16 v[184:187], a[148:151], a[84:87], v[184:187]
v_mfma_f32_16x16x32_bf16 v[184:187], a[144:147], a[80:83], v[184:187]
v_mfma_f32_16x16x32_bf16 v[160:163], a[144:147], a[72:75], v[160:163]
buffer_load_dwordx4 a[60:63], v2, s[40:43], s33 offen offset:3072 sc1
s_add_u32 s35, s35, 0x4000
v_mfma_f32_16x16x32_bf16 v[160:163], a[148:151], a[76:79], v[160:163]
s_add_u32 s33, s33, 0x4000
v_mfma_f32_16x16x32_bf16 v[136:139], a[148:151], a[68:71], v[136:139]
v_mfma_f32_16x16x32_bf16 v[136:139], a[144:147], a[64:67], v[136:139]
s_waitcnt vmcnt(10) lgkmcnt(0)
v_mfma_f32_16x16x32_bf16 v[140:143], a[96:99], a[0:3], v[140:143]
ds_read_b128 a[128:131], v5 offset:17408
v_add_f32 v92, v92, v96
v_mfma_f32_16x16x32_bf16 v[140:143], a[100:103], a[4:7], v[140:143]
buffer_load_dwordx4 a[64:67], v2, s[40:43], s35 offen offset:0 sc1
v_mfma_f32_16x16x32_bf16 v[164:167], a[100:103], a[12:15], v[164:167]
ds_read_b128 a[132:135], v5 offset:23552
v_add_f32 v100, v100, v104
v_mfma_f32_16x16x32_bf16 v[164:167], a[96:99], a[8:11], v[164:167]
v_add_f32 v108, v108, v112
v_add_f32 v116, v116, v120
v_mfma_f32_16x16x32_bf16 v[188:191], a[96:99], a[16:19], v[188:191]
v_add_f32 v93, v93, v97
v_add_f32 v101, v101, v105
v_mfma_f32_16x16x32_bf16 v[188:191], a[100:103], a[20:23], v[188:191]
buffer_load_dwordx4 v1, s[4:7], s44 offen offset:0 sc1 lds
v_mfma_f32_16x16x32_bf16 v[212:215], a[100:103], a[28:31], v[212:215]
ds_read_b128 a[136:139], v5 offset:12288
v_add_f32 v109, v109, v113
v_mfma_f32_16x16x32_bf16 v[212:215], a[96:99], a[24:27], v[212:215]
v_add_f32 v117, v117, v121
v_add_f32 v94, v94, v98
v_mfma_f32_16x16x32_bf16 v[216:219], a[104:107], a[24:27], v[216:219]
ds_read_b128 a[140:143], v5 offset:18432
v_add_f32 v102, v102, v106
v_mfma_f32_16x16x32_bf16 v[216:219], a[108:111], a[28:31], v[216:219]
buffer_load_dwordx4 a[68:71], v2, s[40:43], s33 offen offset:0 sc1
v_mfma_f32_16x16x32_bf16 v[192:195], a[108:111], a[20:23], v[192:195]
ds_read_b128 a[144:147], v5 offset:13312
v_add_f32 v110, v110, v114
v_mfma_f32_16x16x32_bf16 v[192:195], a[104:107], a[16:19], v[192:195]
v_add_f32 v118, v118, v122
v_add_f32 v95, v95, v99
v_mfma_f32_16x16x32_bf16 v[168:171], a[104:107], a[8:11], v[168:171]
v_add_f32 v103, v103, v107
v_mfma_f32_16x16x32_bf16 v[168:171], a[108:111], a[12:15], v[168:171]
buffer_load_dwordx4 a[72:75], v2, s[40:43], s35 offen offset:1024 sc1
v_mfma_f32_16x16x32_bf16 v[144:147], a[108:111], a[4:7], v[144:147]
ds_read_b128 a[148:151], v5 offset:19456
v_add_f32 v111, v111, v115
v_mfma_f32_16x16x32_bf16 v[144:147], a[104:107], a[0:3], v[144:147]
v_add_f32 v119, v119, v123
v_add_f32_dpp v92, v92, v92 row_ror:8 row_mask:0xf bank_mask:0xf
v_mfma_f32_16x16x32_bf16 v[148:151], a[112:115], a[0:3], v[148:151]
v_add_f32_dpp v100, v100, v100 row_ror:8 row_mask:0xf bank_mask:0xf
v_mfma_f32_16x16x32_bf16 v[148:151], a[116:119], a[4:7], v[148:151]
buffer_load_dwordx4 v1, s[4:7], s44 offen offset:1024 sc1 lds
s_add_u32 m0, s18, 0x6000
v_mfma_f32_16x16x32_bf16 v[172:175], a[116:119], a[12:15], v[172:175]
s_add_u32 s44, s50, 0x282a000
v_add_f32_dpp v108, v108, v108 row_ror:8 row_mask:0xf bank_mask:0xf
v_mfma_f32_16x16x32_bf16 v[172:175], a[112:115], a[8:11], v[172:175]
v_add_f32_dpp v116, v116, v116 row_ror:8 row_mask:0xf bank_mask:0xf
v_add_f32_dpp v93, v93, v93 row_ror:8 row_mask:0xf bank_mask:0xf
v_mfma_f32_16x16x32_bf16 v[196:199], a[112:115], a[16:19], v[196:199]
v_add_f32_dpp v101, v101, v101 row_ror:8 row_mask:0xf bank_mask:0xf
v_mfma_f32_16x16x32_bf16 v[196:199], a[116:119], a[20:23], v[196:199]
buffer_load_dwordx4 a[76:79], v2, s[40:43], s33 offen offset:1024 sc1
v_mfma_f32_16x16x32_bf16 v[220:223], a[116:119], a[28:31], v[220:223]
v_add_f32_dpp v109, v109, v109 row_ror:8 row_mask:0xf bank_mask:0xf
v_add_f32_dpp v117, v117, v117 row_ror:8 row_mask:0xf bank_mask:0xf
v_mfma_f32_16x16x32_bf16 v[220:223], a[112:115], a[24:27], v[220:223]
v_add_f32_dpp v92, v94, v94 row_ror:8 row_mask:0xf bank_mask:0xc
s_waitcnt lgkmcnt(0)
v_mfma_f32_16x16x32_bf16 v[224:227], a[128:131], a[24:27], v[224:227]
ds_read_b128 a[96:99], v5 offset:26624
v_accvgpr_write_b32 a216, v48
v_mfma_f32_16x16x32_bf16 v[224:227], a[132:135], a[28:31], v[224:227]
buffer_load_dwordx4 a[80:83], v2, s[40:43], s35 offen offset:2048 sc1
v_mfma_f32_16x16x32_bf16 v[200:203], a[132:135], a[20:23], v[200:203]
ds_read_b128 a[100:103], v5 offset:32768
v_add_f32_dpp v100, v102, v102 row_ror:8 row_mask:0xf bank_mask:0xc
v_mfma_f32_16x16x32_bf16 v[200:203], a[128:131], a[16:19], v[200:203]
v_accvgpr_write_b32 a217, v49
v_add_f32_dpp v108, v110, v110 row_ror:8 row_mask:0xf bank_mask:0xc
v_mfma_f32_16x16x32_bf16 v[176:179], a[128:131], a[8:11], v[176:179]
v_add_f32_dpp v116, v118, v118 row_ror:8 row_mask:0xf bank_mask:0xc
v_add_f32_dpp v93, v95, v95 row_ror:8 row_mask:0xf bank_mask:0xc
v_mfma_f32_16x16x32_bf16 v[176:179], a[132:135], a[12:15], v[176:179]
buffer_load_dwordx4 a[84:87], v2, s[40:43], s33 offen offset:2048 sc1
v_mfma_f32_16x16x32_bf16 v[152:155], a[132:135], a[4:7], v[152:155]
ds_read_b128 a[104:107], v5 offset:27648
v_accvgpr_write_b32 a218, v50
v_mfma_f32_16x16x32_bf16 v[152:155], a[128:131], a[0:3], v[152:155]
v_add_f32_dpp v101, v103, v103 row_ror:8 row_mask:0xf bank_mask:0xc
v_add_f32_dpp v109, v111, v111 row_ror:8 row_mask:0xf bank_mask:0xc
v_mfma_f32_16x16x32_bf16 v[132:135], a[136:139], a[0:3], v[132:135]
ds_read_b128 a[108:111], v5 offset:33792
v_add_f32_dpp v117, v119, v119 row_ror:8 row_mask:0xf bank_mask:0xc
v_mfma_f32_16x16x32_bf16 v[132:135], a[140:143], a[4:7], v[132:135]
v_accvgpr_write_b32 a219, v51
v_mfma_f32_16x16x32_bf16 v[156:159], a[140:143], a[12:15], v[156:159]
buffer_load_dwordx4 v1, s[4:7], s44 offen offset:0 sc1 lds
v_mfma_f32_16x16x32_bf16 v[156:159], a[136:139], a[8:11], v[156:159]
ds_read_b128 a[112:115], v5 offset:28672
v_mfma_f32_16x16x32_bf16 v[180:183], a[136:139], a[16:19], v[180:183]
v_accvgpr_write_b32 a220, v52
v_mfma_f32_16x16x32_bf16 v[180:183], a[140:143], a[20:23], v[180:183]
ds_read_b128 a[116:119], v5 offset:34816
v_mfma_f32_16x16x32_bf16 v[204:207], a[140:143], a[28:31], v[204:207]
v_permlane32_swap_b32 v92, v93
v_mfma_f32_16x16x32_bf16 v[204:207], a[136:139], a[24:27], v[204:207]
buffer_load_dwordx4 a[88:91], v2, s[40:43], s35 offen offset:3072 sc1
v_mfma_f32_16x16x32_bf16 v[208:211], a[144:147], a[24:27], v[208:211]
v_accvgpr_write_b32 a221, v53
v_mfma_f32_16x16x32_bf16 v[208:211], a[148:151], a[28:31], v[208:211]
v_permlane32_swap_b32 v100, v101
v_mfma_f32_16x16x32_bf16 v[184:187], a[148:151], a[20:23], v[184:187]
v_accvgpr_write_b32 a222, v54
v_mfma_f32_16x16x32_bf16 v[184:187], a[144:147], a[16:19], v[184:187]
v_permlane32_swap_b32 v108, v109
v_mfma_f32_16x16x32_bf16 v[160:163], a[144:147], a[8:11], v[160:163]
buffer_load_dwordx4 a[92:95], v2, s[40:43], s33 offen offset:3072 sc1
s_add_u32 s35, s35, 0x4000
v_mfma_f32_16x16x32_bf16 v[160:163], a[148:151], a[12:15], v[160:163]
s_add_u32 s33, s33, 0x4000
v_accvgpr_write_b32 a223, v55
v_mfma_f32_16x16x32_bf16 v[136:139], a[148:151], a[4:7], v[136:139]
v_permlane32_swap_b32 v116, v117
v_mfma_f32_16x16x32_bf16 v[136:139], a[144:147], a[0:3], v[136:139]
v_add_f32 v92, v92, v93
s_waitcnt vmcnt(11) lgkmcnt(0)
v_mfma_f32_16x16x32_bf16 v[140:143], a[96:99], a[32:35], v[140:143]
ds_read_b128 a[128:131], v5 offset:29696
v_accvgpr_write_b32 a224, v56
v_mfma_f32_16x16x32_bf16 v[140:143], a[100:103], a[36:39], v[140:143]
buffer_load_dwordx4 a[0:3], v2, s[40:43], s35 offen offset:0 sc1
v_mfma_f32_16x16x32_bf16 v[164:167], a[100:103], a[44:47], v[164:167]
ds_read_b128 a[132:135], v5 offset:35840
v_add_f32 v100, v100, v101
v_mfma_f32_16x16x32_bf16 v[164:167], a[96:99], a[40:43], v[164:167]
v_accvgpr_write_b32 a225, v57
v_add_f32 v108, v108, v109
v_mfma_f32_16x16x32_bf16 v[188:191], a[96:99], a[48:51], v[188:191]
v_add_f32 v116, v116, v117
v_mov_b32 v94, v92
v_mfma_f32_16x16x32_bf16 v[188:191], a[100:103], a[52:55], v[188:191]
buffer_load_dwordx4 a[4:7], v2, s[40:43], s33 offen offset:0 sc1
v_mfma_f32_16x16x32_bf16 v[212:215], a[100:103], a[60:63], v[212:215]
ds_read_b128 a[136:139], v5 offset:24576
v_accvgpr_write_b32 a226, v58
v_mfma_f32_16x16x32_bf16 v[212:215], a[96:99], a[56:59], v[212:215]
v_mov_b32 v102, v100
v_mov_b32 v110, v108
v_mfma_f32_16x16x32_bf16 v[216:219], a[104:107], a[56:59], v[216:219]
ds_read_b128 a[140:143], v5 offset:30720
v_mov_b32 v118, v116
v_mfma_f32_16x16x32_bf16 v[216:219], a[108:111], a[60:63], v[216:219]
v_accvgpr_write_b32 a227, v59
v_mfma_f32_16x16x32_bf16 v[192:195], a[108:111], a[52:55], v[192:195]
buffer_load_dwordx4 v1, s[4:7], s44 offen offset:1024 sc1 lds
s_add_u32 m0, s18, 0x8000
v_mfma_f32_16x16x32_bf16 v[192:195], a[104:107], a[48:51], v[192:195]
s_add_u32 s44, s50, 0x282c000
ds_read_b128 a[144:147], v5 offset:25600
v_mfma_f32_16x16x32_bf16 v[168:171], a[104:107], a[40:43], v[168:171]
v_accvgpr_write_b32 a228, v60
v_mfma_f32_16x16x32_bf16 v[168:171], a[108:111], a[44:47], v[168:171]
ds_read_b128 a[148:151], v5 offset:31744
v_mfma_f32_16x16x32_bf16 v[144:147], a[108:111], a[36:39], v[144:147]
v_permlane16_swap_b32 v92, v94
v_mfma_f32_16x16x32_bf16 v[144:147], a[104:107], a[32:35], v[144:147]
buffer_load_dwordx4 a[8:11], v2, s[40:43], s35 offen offset:1024 sc1
v_mfma_f32_16x16x32_bf16 v[148:151], a[112:115], a[32:35], v[148:151]
v_accvgpr_write_b32 a229, v61
v_mfma_f32_16x16x32_bf16 v[148:151], a[116:119], a[36:39], v[148:151]
v_permlane16_swap_b32 v100, v102
v_mfma_f32_16x16x32_bf16 v[172:175], a[116:119], a[44:47], v[172:175]
v_accvgpr_write_b32 a230, v62
v_mfma_f32_16x16x32_bf16 v[172:175], a[112:115], a[40:43], v[172:175]
v_permlane16_swap_b32 v108, v110
v_mfma_f32_16x16x32_bf16 v[196:199], a[112:115], a[48:51], v[196:199]
buffer_load_dwordx4 a[12:15], v2, s[40:43], s33 offen offset:1024 sc1
v_mfma_f32_16x16x32_bf16 v[196:199], a[116:119], a[52:55], v[196:199]
v_accvgpr_write_b32 a231, v63
v_mfma_f32_16x16x32_bf16 v[220:223], a[116:119], a[60:63], v[220:223]
v_permlane16_swap_b32 v116, v118
v_mfma_f32_16x16x32_bf16 v[220:223], a[112:115], a[56:59], v[220:223]
v_add_f32 v92, v92, v94
s_waitcnt lgkmcnt(0)
v_mfma_f32_16x16x32_bf16 v[224:227], a[128:131], a[56:59], v[224:227]
ds_read_b128 a[96:99], v5 offset:38912
v_accvgpr_write_b32 a232, v64
v_mfma_f32_16x16x32_bf16 v[224:227], a[132:135], a[60:63], v[224:227]
buffer_load_dwordx4 a[16:19], v2, s[40:43], s35 offen offset:2048 sc1
v_mfma_f32_16x16x32_bf16 v[200:203], a[132:135], a[52:55], v[200:203]
ds_read_b128 a[100:103], v5 offset:45056
v_add_f32 v100, v100, v102
v_mfma_f32_16x16x32_bf16 v[200:203], a[128:131], a[48:51], v[200:203]
v_accvgpr_write_b32 a233, v65
v_add_f32 v108, v108, v110
L_stub6:
s_cbranch_execz L_stub7
v_mfma_f32_16x16x32_bf16 v[176:179], a[128:131], a[40:43], v[176:179]
v_add_f32 v116, v116, v118
v_mov_b32 v94, v92
v_mfma_f32_16x16x32_bf16 v[176:179], a[132:135], a[44:47], v[176:179]
buffer_load_dwordx4 a[20:23], v2, s[40:43], s33 offen offset:2048 sc1
v_mfma_f32_16x16x32_bf16 v[152:155], a[132:135], a[36:39], v[152:155]
ds_read_b128 a[104:107], v5 offset:39936
v_accvgpr_write_b32 a234, v66
v_mfma_f32_16x16x32_bf16 v[152:155], a[128:131], a[32:35], v[152:155]
v_mov_b32 v102, v100
v_mov_b32 v110, v108
v_mfma_f32_16x16x32_bf16 v[132:135], a[136:139], a[32:35], v[132:135]
ds_read_b128 a[108:111], v5 offset:46080
v_mov_b32 v118, v116
v_mfma_f32_16x16x32_bf16 v[132:135], a[140:143], a[36:39], v[132:135]
v_accvgpr_write_b32 a235, v67
v_mfma_f32_16x16x32_bf16 v[156:159], a[140:143], a[44:47], v[156:159]
buffer_load_dwordx4 v1, s[4:7], s44 offen offset:0 sc1 lds
v_mfma_f32_16x16x32_bf16 v[156:159], a[136:139], a[40:43], v[156:159]
ds_read_b128 a[112:115], v5 offset:40960
v_mfma_f32_16x16x32_bf16 v[180:183], a[136:139], a[48:51], v[180:183]
v_accvgpr_write_b32 a236, v68
v_mfma_f32_16x16x32_bf16 v[180:183], a[140:143], a[52:55], v[180:183]
ds_read_b128 a[116:119], v5 offset:47104
v_mfma_f32_16x16x32_bf16 v[204:207], a[140:143], a[60:63], v[204:207]
v_permlane32_swap_b32 v92, v94
v_mfma_f32_16x16x32_bf16 v[204:207], a[136:139], a[56:59], v[204:207]
buffer_load_dwordx4 a[24:27], v2, s[40:43], s35 offen offset:3072 sc1
v_mfma_f32_16x16x32_bf16 v[208:211], a[144:147], a[56:59], v[208:211]
v_accvgpr_write_b32 a237, v69
v_mfma_f32_16x16x32_bf16 v[208:211], a[148:151], a[60:63], v[208:211]
v_permlane32_swap_b32 v100, v102
v_mfma_f32_16x16x32_bf16 v[184:187], a[148:151], a[52:55], v[184:187]
v_accvgpr_write_b32 a238, v70
v_mfma_f32_16x16x32_bf16 v[184:187], a[144:147], a[48:51], v[184:187]
v_permlane32_swap_b32 v108, v110
v_mfma_f32_16x16x32_bf16 v[160:163], a[144:147], a[40:43], v[160:163]
buffer_load_dwordx4 a[28:31], v2, s[40:43], s33 offen offset:3072 sc1
s_add_u32 s35, s35, 0x4000
v_mfma_f32_16x16x32_bf16 v[160:163], a[148:151], a[44:47], v[160:163]
s_add_u32 s33, s33, 0x4000
v_accvgpr_write_b32 a239, v71
v_mfma_f32_16x16x32_bf16 v[136:139], a[148:151], a[36:39], v[136:139]
v_permlane32_swap_b32 v116, v118
v_mfma_f32_16x16x32_bf16 v[136:139], a[144:147], a[32:35], v[136:139]
v_mul_f32 v82, 0xba800000, v92
s_waitcnt vmcnt(10) lgkmcnt(0)
v_mfma_f32_16x16x32_bf16 v[140:143], a[96:99], a[64:67], v[140:143]
ds_read_b128 a[128:131], v5 offset:41984
v_mul_f32 v84, 0xba800000, v100
v_mfma_f32_16x16x32_bf16 v[140:143], a[100:103], a[68:71], v[140:143]
buffer_load_dwordx4 a[32:35], v2, s[40:43], s35 offen offset:0 sc1
v_mfma_f32_16x16x32_bf16 v[164:167], a[100:103], a[76:79], v[164:167]
ds_read_b128 a[132:135], v5 offset:48128
v_mul_f32 v86, 0xba800000, v108
v_mfma_f32_16x16x32_bf16 v[164:167], a[96:99], a[72:75], v[164:167]
v_mul_f32 v88, 0xba800000, v116
v_mul_f32 v94, 0x3a800000, v94
v_mfma_f32_16x16x32_bf16 v[188:191], a[96:99], a[80:83], v[188:191]
v_mul_f32 v102, 0x3a800000, v102
v_mul_f32 v110, 0x3a800000, v110
v_mfma_f32_16x16x32_bf16 v[188:191], a[100:103], a[84:87], v[188:191]
buffer_load_dwordx4 v1, s[4:7], s44 offen offset:1024 sc1 lds
s_add_u32 m0, s18, 0xa000
v_mfma_f32_16x16x32_bf16 v[212:215], a[100:103], a[92:95], v[212:215]
s_add_u32 s44, s50, 0x282e000
ds_read_b128 a[136:139], v5 offset:36864
v_mfma_f32_16x16x32_bf16 v[212:215], a[96:99], a[88:91], v[212:215]
v_mul_f32 v118, 0x3a800000, v118
v_fma_f32 v94, -v82, v82, v94
v_fma_f32 v102, -v84, v84, v102
v_fma_f32 v110, -v86, v86, v110
v_fma_f32 v118, -v88, v88, v118
v_max_f32 v94, 0, v94
v_max_f32 v102, 0, v102
v_max_f32 v110, 0, v110
v_max_f32 v118, 0, v118
v_add_f32 v94, 0x3727c5ac, v94
v_add_f32 v102, 0x3727c5ac, v102
v_add_f32 v110, 0x3727c5ac, v110
v_add_f32 v118, 0x3727c5ac, v118
v_rsq_f32 v83, v94
v_rsq_f32 v85, v102
v_rsq_f32 v87, v110
v_rsq_f32 v89, v118
v_mfma_f32_16x16x32_bf16 v[216:219], a[104:107], a[88:91], v[216:219]
ds_read_b128 a[140:143], v5 offset:43008
v_mfma_f32_16x16x32_bf16 v[216:219], a[108:111], a[92:95], v[216:219]
buffer_load_dwordx4 a[36:39], v2, s[40:43], s33 offen offset:0 sc1
v_mfma_f32_16x16x32_bf16 v[192:195], a[108:111], a[84:87], v[192:195]
ds_read_b128 a[144:147], v5 offset:37888
v_fmac_f32 v140, v56, v82
v_mfma_f32_16x16x32_bf16 v[192:195], a[104:107], a[80:83], v[192:195]
v_mfma_f32_16x16x32_bf16 v[168:171], a[104:107], a[72:75], v[168:171]
v_fmac_f32 v164, v56, v84
v_mfma_f32_16x16x32_bf16 v[168:171], a[108:111], a[76:79], v[168:171]
buffer_load_dwordx4 a[40:43], v2, s[40:43], s35 offen offset:1024 sc1
v_mfma_f32_16x16x32_bf16 v[144:147], a[108:111], a[68:71], v[144:147]
ds_read_b128 a[148:151], v5 offset:44032
v_fmac_f32 v188, v56, v86
v_mfma_f32_16x16x32_bf16 v[144:147], a[104:107], a[64:67], v[144:147]
v_mfma_f32_16x16x32_bf16 v[148:151], a[112:115], a[64:67], v[148:151]
v_fmac_f32 v212, v56, v88
v_mfma_f32_16x16x32_bf16 v[148:151], a[116:119], a[68:71], v[148:151]
buffer_load_dwordx4 v1, s[4:7], s44 offen offset:0 sc1 lds
v_mfma_f32_16x16x32_bf16 v[172:175], a[116:119], a[76:79], v[172:175]
v_fmac_f32 v216, v60, v88
v_mfma_f32_16x16x32_bf16 v[172:175], a[112:115], a[72:75], v[172:175]
v_mfma_f32_16x16x32_bf16 v[196:199], a[112:115], a[80:83], v[196:199]
v_fmac_f32 v192, v60, v86
v_mfma_f32_16x16x32_bf16 v[196:199], a[116:119], a[84:87], v[196:199]
buffer_load_dwordx4 a[44:47], v2, s[40:43], s33 offen offset:1024 sc1
v_mfma_f32_16x16x32_bf16 v[220:223], a[116:119], a[92:95], v[220:223]
v_fmac_f32 v168, v60, v84
v_fmac_f32 v141, v57, v82
v_mfma_f32_16x16x32_bf16 v[220:223], a[112:115], a[88:91], v[220:223]
s_waitcnt lgkmcnt(0)
s_barrier
v_mfma_f32_16x16x32_bf16 v[224:227], a[128:131], a[88:91], v[224:227]
v_add_u32 v5, 0, v1
v_fmac_f32 v144, v60, v82
v_mfma_f32_16x16x32_bf16 v[224:227], a[132:135], a[92:95], v[224:227]
buffer_load_dwordx4 a[48:51], v2, s[40:43], s35 offen offset:2048 sc1
v_mfma_f32_16x16x32_bf16 v[200:203], a[132:135], a[84:87], v[200:203]
ds_read_b128 a[96:99], v5 offset:2048
v_fmac_f32 v148, v64, v82
v_mfma_f32_16x16x32_bf16 v[200:203], a[128:131], a[80:83], v[200:203]
ds_read_b128 a[100:103], v5 offset:8192
v_fmac_f32 v165, v57, v84
v_mfma_f32_16x16x32_bf16 v[176:179], a[128:131], a[72:75], v[176:179]
v_fmac_f32 v172, v64, v84
v_fmac_f32 v189, v57, v86
v_mfma_f32_16x16x32_bf16 v[176:179], a[132:135], a[76:79], v[176:179]
buffer_load_dwordx4 a[52:55], v2, s[40:43], s33 offen offset:2048 sc1
v_mfma_f32_16x16x32_bf16 v[152:155], a[132:135], a[68:71], v[152:155]
ds_read_b128 a[104:107], v5 offset:3072
v_fmac_f32 v196, v64, v86
v_mfma_f32_16x16x32_bf16 v[152:155], a[128:131], a[64:67], v[152:155]
v_fmac_f32 v213, v57, v88
v_fmac_f32 v217, v61, v88
v_mfma_f32_16x16x32_bf16 v[132:135], a[136:139], a[64:67], v[132:135]
ds_read_b128 a[108:111], v5 offset:9216
v_fmac_f32 v220, v64, v88
v_mfma_f32_16x16x32_bf16 v[132:135], a[140:143], a[68:71], v[132:135]
v_fmac_f32 v193, v61, v86
v_mfma_f32_16x16x32_bf16 v[156:159], a[140:143], a[76:79], v[156:159]
buffer_load_dwordx4 v1, s[4:7], s44 offen offset:1024 sc1 lds
s_add_u32 m0, s19, 49152
v_mfma_f32_16x16x32_bf16 v[156:159], a[136:139], a[72:75], v[156:159]
s_xor_b32 s44, s85, 16384
ds_read_b128 a[112:115], v5 offset:4096
v_mfma_f32_16x16x32_bf16 v[180:183], a[136:139], a[80:83], v[180:183]
v_fmac_f32 v224, v68, v88
v_fmac_f32 v200, v68, v86
v_mfma_f32_16x16x32_bf16 v[180:183], a[140:143], a[84:87], v[180:183]
ds_read_b128 a[116:119], v5 offset:10240
v_fmac_f32 v169, v61, v84
v_mfma_f32_16x16x32_bf16 v[204:207], a[140:143], a[92:95], v[204:207]
v_fmac_f32 v176, v68, v84
v_fmac_f32 v145, v61, v82
v_mfma_f32_16x16x32_bf16 v[204:207], a[136:139], a[88:91], v[204:207]
buffer_load_dwordx4 a[56:59], v2, s[40:43], s35 offen offset:3072 sc1
v_mfma_f32_16x16x32_bf16 v[208:211], a[144:147], a[88:91], v[208:211]
v_fmac_f32 v152, v68, v82
v_fmac_f32 v149, v65, v82
v_mfma_f32_16x16x32_bf16 v[208:211], a[148:151], a[92:95], v[208:211]
v_fmac_f32 v173, v65, v84
v_mfma_f32_16x16x32_bf16 v[184:187], a[148:151], a[84:87], v[184:187]
v_fmac_f32 v132, v48, v82
v_fmac_f32 v197, v65, v86
v_mfma_f32_16x16x32_bf16 v[184:187], a[144:147], a[80:83], v[184:187]
v_mfma_f32_16x16x32_bf16 v[160:163], a[144:147], a[72:75], v[160:163]
buffer_load_dwordx4 a[60:63], v2, s[40:43], s33 offen offset:3072 sc1
s_add_u32 s35, s35, 0x4000
v_mfma_f32_16x16x32_bf16 v[160:163], a[148:151], a[76:79], v[160:163]
s_add_u32 s33, s33, 0x4000
v_fmac_f32 v156, v48, v84
v_mfma_f32_16x16x32_bf16 v[136:139], a[148:151], a[68:71], v[136:139]
v_fmac_f32 v180, v48, v86
v_fmac_f32 v221, v65, v88
v_mfma_f32_16x16x32_bf16 v[136:139], a[144:147], a[64:67], v[136:139]
v_fmac_f32 v225, v69, v88
s_waitcnt vmcnt(11) lgkmcnt(0)
v_mfma_f32_16x16x32_bf16 v[140:143], a[96:99], a[0:3], v[140:143]
ds_read_b128 a[128:131], v5 offset:5120
v_fmac_f32 v204, v48, v88
v_mfma_f32_16x16x32_bf16 v[140:143], a[100:103], a[4:7], v[140:143]
buffer_load_dwordx4 a[64:67], v2, s[40:43], s35 offen offset:0 sc1
s_lshl_b32 s36, s28, 9
v_mfma_f32_16x16x32_bf16 v[164:167], a[100:103], a[12:15], v[164:167]
ds_read_b128 a[132:135], v5 offset:11264
v_fmac_f32 v208, v52, v88
v_mfma_f32_16x16x32_bf16 v[164:167], a[96:99], a[8:11], v[164:167]
v_fmac_f32 v201, v69, v86
v_fmac_f32 v177, v69, v84
v_mfma_f32_16x16x32_bf16 v[188:191], a[96:99], a[16:19], v[188:191]
v_fmac_f32 v184, v52, v86
v_fmac_f32 v153, v69, v82
v_mfma_f32_16x16x32_bf16 v[188:191], a[100:103], a[20:23], v[188:191]
buffer_load_dwordx4 a[68:71], v2, s[40:43], s33 offen offset:0 sc1
s_lshl_b32 s37, s30, 2
v_mfma_f32_16x16x32_bf16 v[212:215], a[100:103], a[28:31], v[212:215]
ds_read_b128 a[136:139], v5 offset:0
v_fmac_f32 v160, v52, v84
v_mfma_f32_16x16x32_bf16 v[212:215], a[96:99], a[24:27], v[212:215]
v_fmac_f32 v133, v49, v82
s_add_u32 s37, s37, s28
v_mfma_f32_16x16x32_bf16 v[216:219], a[104:107], a[24:27], v[216:219]
ds_read_b128 a[140:143], v5 offset:6144
v_fmac_f32 v136, v52, v82
v_mfma_f32_16x16x32_bf16 v[216:219], a[108:111], a[28:31], v[216:219]
buffer_load_dwordx4 a[72:75], v2, s[40:43], s35 offen offset:1024 sc1
s_lshr_b32 s98, s37, 1
v_mfma_f32_16x16x32_bf16 v[192:195], a[108:111], a[20:23], v[192:195]
ds_read_b128 a[144:147], v5 offset:1024
v_fmac_f32 v157, v49, v84
v_mfma_f32_16x16x32_bf16 v[192:195], a[104:107], a[16:19], v[192:195]
v_fmac_f32 v181, v49, v86
v_fmac_f32 v142, v58, v82
v_mfma_f32_16x16x32_bf16 v[168:171], a[104:107], a[8:11], v[168:171]
v_fmac_f32 v205, v49, v88
v_fmac_f32 v166, v58, v84
v_mfma_f32_16x16x32_bf16 v[168:171], a[108:111], a[12:15], v[168:171]
buffer_load_dwordx4 a[76:79], v2, s[40:43], s33 offen offset:1024 sc1
s_lshl_b32 s98, s98, 14
v_mfma_f32_16x16x32_bf16 v[144:147], a[108:111], a[4:7], v[144:147]
ds_read_b128 a[148:151], v5 offset:7168
v_fmac_f32 v209, v53, v88
v_mfma_f32_16x16x32_bf16 v[144:147], a[104:107], a[0:3], v[144:147]
v_fmac_f32 v190, v58, v86
s_and_b32 s99, s19, 0x1000
v_mfma_f32_16x16x32_bf16 v[148:151], a[112:115], a[0:3], v[148:151]
v_fmac_f32 v185, v53, v86
v_fmac_f32 v214, v58, v88
v_mfma_f32_16x16x32_bf16 v[148:151], a[116:119], a[4:7], v[148:151]
buffer_load_dwordx4 a[80:83], v2, s[40:43], s35 offen offset:2048 sc1
s_add_u32 s98, s98, s99
v_mfma_f32_16x16x32_bf16 v[172:175], a[116:119], a[12:15], v[172:175]
v_fmac_f32 v161, v53, v84
v_fmac_f32 v218, v62, v88
v_mfma_f32_16x16x32_bf16 v[172:175], a[112:115], a[8:11], v[172:175]
v_add_u32 v232, s19, v7
s_bfe_u32 s90, s51, 0x10005
v_mfma_f32_16x16x32_bf16 v[196:199], a[112:115], a[16:19], v[196:199]
v_fmac_f32 v137, v53, v82
v_fmac_f32 v194, v62, v86
v_mfma_f32_16x16x32_bf16 v[196:199], a[116:119], a[20:23], v[196:199]
buffer_load_dwordx4 a[84:87], v2, s[40:43], s33 offen offset:2048 sc1
s_lshl_b32 s90, s90, 13
v_mfma_f32_16x16x32_bf16 v[220:223], a[116:119], a[28:31], v[220:223]
v_fmac_f32 v170, v62, v84
v_fmac_f32 v143, v59, v82
v_mfma_f32_16x16x32_bf16 v[220:223], a[112:115], a[24:27], v[220:223]
s_add_u32 s98, s98, s90
s_waitcnt lgkmcnt(0)
v_mfma_f32_16x16x32_bf16 v[224:227], a[128:131], a[24:27], v[224:227]
ds_read_b128 a[96:99], v5 offset:14336
v_fmac_f32 v146, v62, v82
v_mfma_f32_16x16x32_bf16 v[224:227], a[132:135], a[28:31], v[224:227]
buffer_load_dwordx4 a[88:91], v2, s[40:43], s35 offen offset:3072 sc1
s_add_u32 s98, s98, 0x1400000
v_mfma_f32_16x16x32_bf16 v[200:203], a[132:135], a[20:23], v[200:203]
ds_read_b128 a[100:103], v5 offset:20480
v_fmac_f32 v150, v66, v82
v_mfma_f32_16x16x32_bf16 v[200:203], a[128:131], a[16:19], v[200:203]
v_fmac_f32 v167, v59, v84
v_fmac_f32 v191, v59, v86
v_mfma_f32_16x16x32_bf16 v[176:179], a[128:131], a[8:11], v[176:179]
v_fmac_f32 v174, v66, v84
v_fmac_f32 v215, v59, v88
v_mfma_f32_16x16x32_bf16 v[176:179], a[132:135], a[12:15], v[176:179]
ds_read_b128 a[104:107], v5 offset:15360
s_xor_b32 s99, s98, 0x2000
v_mfma_f32_16x16x32_bf16 v[152:155], a[132:135], a[4:7], v[152:155]
v_fmac_f32 v198, v66, v86
v_fmac_f32 v219, v63, v88
v_mfma_f32_16x16x32_bf16 v[152:155], a[128:131], a[0:3], v[152:155]
buffer_load_dwordx4 v1, s[4:7], s44 offen offset:0 sc1 lds
s_and_b32 s91, s29, 4
v_mfma_f32_16x16x32_bf16 v[132:135], a[136:139], a[0:3], v[132:135]
ds_read_b128 a[108:111], v5 offset:21504
v_fmac_f32 v222, v66, v88
v_mfma_f32_16x16x32_bf16 v[132:135], a[140:143], a[4:7], v[132:135]
v_fmac_f32 v195, v63, v86
s_lshl_b32 s91, s91, 11
v_mfma_f32_16x16x32_bf16 v[156:159], a[140:143], a[12:15], v[156:159]
ds_read_b128 a[112:115], v5 offset:16384
v_fmac_f32 v226, v70, v88
v_mfma_f32_16x16x32_bf16 v[156:159], a[136:139], a[8:11], v[156:159]
v_fmac_f32 v171, v63, v84
s_xor_b32 s96, s98, s91
v_mfma_f32_16x16x32_bf16 v[180:183], a[136:139], a[16:19], v[180:183]
v_fmac_f32 v202, v70, v86
v_fmac_f32 v147, v63, v82
v_mfma_f32_16x16x32_bf16 v[180:183], a[140:143], a[20:23], v[180:183]
buffer_load_dwordx4 a[92:95], v2, s[40:43], s33 offen offset:3072 sc1
s_add_u32 s35, s35, 0x4000
v_mfma_f32_16x16x32_bf16 v[204:207], a[140:143], a[28:31], v[204:207]
s_add_u32 s33, s33, 0x4000
ds_read_b128 a[116:119], v5 offset:22528
v_mfma_f32_16x16x32_bf16 v[204:207], a[136:139], a[24:27], v[204:207]
v_fmac_f32 v178, v70, v84
v_fmac_f32 v151, v67, v82
v_mfma_f32_16x16x32_bf16 v[208:211], a[144:147], a[24:27], v[208:211]
v_fmac_f32 v154, v70, v82
v_fmac_f32 v175, v67, v84
v_mfma_f32_16x16x32_bf16 v[208:211], a[148:151], a[28:31], v[208:211]
s_lshl_b32 s97, s81, 10
s_add_u32 s96, s96, s97
s_lshr_b32 s100, s37, 4
v_mfma_f32_16x16x32_bf16 v[184:187], a[148:151], a[20:23], v[184:187]
v_fmac_f32 v134, v50, v82
v_fmac_f32 v199, v67, v86
v_mfma_f32_16x16x32_bf16 v[184:187], a[144:147], a[16:19], v[184:187]
buffer_load_dwordx4 v1, s[4:7], s44 offen offset:1024 sc1 lds
s_lshl_b32 s100, s100, 14
v_mfma_f32_16x16x32_bf16 v[160:163], a[144:147], a[8:11], v[160:163]
v_fmac_f32 v158, v50, v84
v_fmac_f32 v223, v67, v88
v_mfma_f32_16x16x32_bf16 v[160:163], a[148:151], a[12:15], v[160:163]
s_and_b32 s37, s37, 15
s_lshl_b32 s37, s37, 9
s_add_u32 s100, s100, s37
v_mfma_f32_16x16x32_bf16 v[136:139], a[148:151], a[4:7], v[136:139]
v_fmac_f32 v182, v50, v86
v_fmac_f32 v227, v71, v88
v_mfma_f32_16x16x32_bf16 v[136:139], a[144:147], a[0:3], v[136:139]
s_waitcnt vmcnt(10) lgkmcnt(0)
s_barrier
v_mfma_f32_16x16x32_bf16 v[140:143], a[96:99], a[32:35], v[140:143]
ds_read_b128 a[128:131], v5 offset:17408
v_fmac_f32 v206, v50, v88
v_mfma_f32_16x16x32_bf16 v[140:143], a[100:103], a[36:39], v[140:143]
buffer_load_dwordx4 a[0:3], v2, s[40:43], s35 offen offset:0 sc1
s_add_u32 s100, s100, 0x240000
v_mfma_f32_16x16x32_bf16 v[164:167], a[100:103], a[44:47], v[164:167]
ds_read_b128 a[132:135], v5 offset:23552
v_fmac_f32 v210, v54, v88
v_mfma_f32_16x16x32_bf16 v[164:167], a[96:99], a[40:43], v[164:167]
v_fmac_f32 v203, v71, v86
v_fmac_f32 v179, v71, v84
v_mfma_f32_16x16x32_bf16 v[188:191], a[96:99], a[48:51], v[188:191]
buffer_load_dwordx4 a[4:7], v2, s[40:43], s33 offen offset:0 sc1
s_xor_b32 s90, s91, s79
v_mfma_f32_16x16x32_bf16 v[188:191], a[100:103], a[52:55], v[188:191]
ds_read_b128 a[136:139], v5 offset:26624
v_fmac_f32 v186, v54, v86
v_mfma_f32_16x16x32_bf16 v[212:215], a[100:103], a[60:63], v[212:215]
v_fmac_f32 v162, v54, v84
v_fmac_f32 v155, v71, v82
v_mfma_f32_16x16x32_bf16 v[212:215], a[96:99], a[56:59], v[212:215]
buffer_load_dwordx4 a[8:11], v2, s[40:43], s35 offen offset:1024 sc1
s_lshl_b32 s97, s81, 7
v_mfma_f32_16x16x32_bf16 v[216:219], a[104:107], a[56:59], v[216:219]
ds_read_b128 a[140:143], v5 offset:32768
v_fmac_f32 v138, v54, v82
v_mfma_f32_16x16x32_bf16 v[216:219], a[108:111], a[60:63], v[216:219]
v_fmac_f32 v135, v51, v82
v_fmac_f32 v159, v51, v84
v_mfma_f32_16x16x32_bf16 v[192:195], a[108:111], a[52:55], v[192:195]
buffer_load_dwordx4 a[12:15], v2, s[40:43], s33 offen offset:1024 sc1
s_add_u32 s97, s97, s79
v_mfma_f32_16x16x32_bf16 v[192:195], a[104:107], a[48:51], v[192:195]
ds_read_b128 a[144:147], v5 offset:27648
v_fmac_f32 v183, v51, v86
v_mfma_f32_16x16x32_bf16 v[168:171], a[104:107], a[40:43], v[168:171]
v_fmac_f32 v207, v51, v88
s_add_u32 s97, s97, s100
v_mfma_f32_16x16x32_bf16 v[168:171], a[108:111], a[44:47], v[168:171]
buffer_load_dwordx4 a[16:19], v2, s[40:43], s35 offen offset:2048 sc1
s_lshr_b32 s37, s30, 2
v_mfma_f32_16x16x32_bf16 v[144:147], a[108:111], a[36:39], v[144:147]
ds_read_b128 a[148:151], v5 offset:33792
v_fmac_f32 v211, v55, v88
v_mfma_f32_16x16x32_bf16 v[144:147], a[104:107], a[32:35], v[144:147]
s_xor_b32 s37, s37, s51
s_and_b32 s37, s37, 1
s_lshr_b32 s89, s29, 2
v_mfma_f32_16x16x32_bf16 v[148:151], a[112:115], a[32:35], v[148:151]
buffer_load_dwordx4 a[20:23], v2, s[40:43], s33 offen offset:2048 sc1
s_xor_b32 s89, s89, s37
v_mfma_f32_16x16x32_bf16 v[148:151], a[116:119], a[36:39], v[148:151]
v_fmac_f32 v187, v55, v86
s_lshl_b32 s88, s28, 6
v_mfma_f32_16x16x32_bf16 v[172:175], a[116:119], a[44:47], v[172:175]
v_fmac_f32 v163, v55, v84
v_mul_f32 v86, 0x3fb8aa3b, v87
v_mfma_f32_16x16x32_bf16 v[172:175], a[112:115], a[40:43], v[172:175]
buffer_load_dwordx4 a[24:27], v2, s[40:43], s35 offen offset:3072 sc1
s_add_u32 s94, s80, s88
v_mfma_f32_16x16x32_bf16 v[196:199], a[112:115], a[48:51], v[196:199]
v_fmac_f32 v139, v55, v82
v_mul_f32 v84, 0x3fb8aa3b, v85
v_mfma_f32_16x16x32_bf16 v[196:199], a[116:119], a[52:55], v[196:199]
v_mul_f32 v82, 0x3fb8aa3b, v83
s_add_u32 s94, s94, 0x80000
v_mfma_f32_16x16x32_bf16 v[220:223], a[116:119], a[60:63], v[220:223]
buffer_load_dwordx4 a[28:31], v2, s[40:43], s33 offen offset:3072 sc1
s_add_u32 s35, s35, 0x64000
v_mfma_f32_16x16x32_bf16 v[220:223], a[112:115], a[56:59], v[220:223]
s_add_u32 s33, s33, 0x64000
s_waitcnt lgkmcnt(0)
v_mfma_f32_16x16x32_bf16 v[224:227], a[128:131], a[56:59], v[224:227]
ds_read_b128 a[96:99], v5 offset:28672
s_mul_i32 s89, s89, 0x102000
v_mfma_f32_16x16x32_bf16 v[224:227], a[132:135], a[60:63], v[224:227]
buffer_load_dwordx4 v1, s[4:7], s44 offen offset:2048 sc1 lds
s_add_u32 s88, s88, s70
v_mfma_f32_16x16x32_bf16 v[200:203], a[132:135], a[52:55], v[200:203]
ds_read_b128 a[100:103], v5 offset:34816
v_mul_f32 v88, 0x3fb8aa3b, v89
v_mfma_f32_16x16x32_bf16 v[200:203], a[128:131], a[48:51], v[200:203]
s_add_u32 s88, s88, s89
s_add_u32 s89, s88, 0x80000
s_add_u32 s74, s71, 0x10080
v_mfma_f32_16x16x32_bf16 v[176:179], a[128:131], a[40:43], v[176:179]
s_add_u32 s72, s76, 0xc00000
s_add_u32 s73, s75, 0x800000
s_lshr_b32 s38, s28, 1
v_mfma_f32_16x16x32_bf16 v[176:179], a[132:135], a[44:47], v[176:179]
ds_read_b128 a[104:107], v5 offset:29696
s_and_b32 s39, s28, 1
v_mfma_f32_16x16x32_bf16 v[152:155], a[132:135], a[36:39], v[152:155]
s_mul_i32 s38, s38, 3072
s_lshl_b32 s39, s39, 3
s_add_u32 s38, s38, s39
v_mfma_f32_16x16x32_bf16 v[152:155], a[128:131], a[32:35], v[152:155]
s_add_u32 s91, s83, 0x280000
v_add_u32 v233, s19, v232
s_waitcnt vmcnt(18)
v_mfma_f32_16x16x32_bf16 v[140:143], a[136:139], a[64:67], v[140:143]
ds_read_b128 a[108:111], v5 offset:35840
v_and_b32 v248, 4, v0
s_waitcnt vmcnt(17)
v_mfma_f32_16x16x32_bf16 v[140:143], a[140:143], a[68:71], v[140:143]
v_lshlrev_b32 v248, 11, v248
v_bfe_u32 v235, v0, 2, 1
s_waitcnt vmcnt(15)
v_mfma_f32_16x16x32_bf16 v[164:167], a[140:143], a[76:79], v[164:167]
ds_read_b128 a[112:115], v5 offset:38912
v_xor_b32 v248, s90, v248
v_mfma_f32_16x16x32_bf16 v[164:167], a[136:139], a[72:75], v[164:167]
v_and_b32 v249, 3, v0
v_xor_b32 v235, s37, v235
s_waitcnt vmcnt(14)
v_mfma_f32_16x16x32_bf16 v[188:191], a[136:139], a[80:83], v[188:191]
v_lshl_add_u32 v248, v249, 7, v248
v_mul_u32_u24 v235, 4128, v235
s_waitcnt vmcnt(13)
v_mfma_f32_16x16x32_bf16 v[188:191], a[140:143], a[84:87], v[188:191]
buffer_load_dwordx4 v1, s[4:7], s44 offen offset:3072 sc1 lds
s_add_u32 m0, s19, 65536
s_waitcnt vmcnt(11)
v_mfma_f32_16x16x32_bf16 v[212:215], a[140:143], a[92:95], v[212:215]
s_xor_b32 s44, s85, 32768
ds_read_b128 a[116:119], v5 offset:45056
v_mfma_f32_16x16x32_bf16 v[212:215], a[136:139], a[88:91], v[212:215]
v_lshrrev_b32 v249, 4, v0
v_add_lshl_u32 v235, v235, v0, 8
v_mfma_f32_16x16x32_bf16 v[216:219], a[144:147], a[88:91], v[216:219]
v_lshl_add_u32 v248, v249, 4, v248
v_add_u32 v234, s36, v8
v_mfma_f32_16x16x32_bf16 v[216:219], a[148:151], a[92:95], v[216:219]
v_cndmask_b32 v235, 2.0, v235, s[64:65]
v_mov_b32 v249, 0x3f80
v_mfma_f32_16x16x32_bf16 v[192:195], a[148:151], a[84:87], v[192:195]
v_mov_b32 v250, 1.0
v_add_u32 v252, s38, v1
v_mfma_f32_16x16x32_bf16 v[192:195], a[144:147], a[80:83], v[192:195]
v_mfma_f32_16x16x32_bf16 v[168:171], a[144:147], a[72:75], v[168:171]
v_mfma_f32_16x16x32_bf16 v[168:171], a[148:151], a[76:79], v[168:171]
v_mfma_f32_16x16x32_bf16 v[144:147], a[148:151], a[68:71], v[144:147]
v_mfma_f32_16x16x32_bf16 v[144:147], a[144:147], a[64:67], v[144:147]
s_waitcnt lgkmcnt(0)
v_mfma_f32_16x16x32_bf16 v[148:151], a[96:99], a[64:67], v[148:151]
ds_read_b128 a[128:131], v5 offset:39936
v_mfma_f32_16x16x32_bf16 v[148:151], a[100:103], a[68:71], v[148:151]
buffer_load_dwordx4 v1, s[4:7], s44 offen offset:0 sc1 lds
v_mfma_f32_16x16x32_bf16 v[172:175], a[100:103], a[76:79], v[172:175]
ds_read_b128 a[132:135], v5 offset:46080
v_mfma_f32_16x16x32_bf16 v[172:175], a[96:99], a[72:75], v[172:175]
v_mfma_f32_16x16x32_bf16 v[196:199], a[96:99], a[80:83], v[196:199]
v_mfma_f32_16x16x32_bf16 v[196:199], a[100:103], a[84:87], v[196:199]
buffer_load_dwordx4 v1, s[4:7], s44 offen offset:1024 sc1 lds
v_mfma_f32_16x16x32_bf16 v[220:223], a[100:103], a[92:95], v[220:223]
ds_read_b128 a[136:139], v5 offset:40960
v_mfma_f32_16x16x32_bf16 v[220:223], a[96:99], a[88:91], v[220:223]
v_mfma_f32_16x16x32_bf16 v[224:227], a[104:107], a[88:91], v[224:227]
ds_read_b128 a[140:143], v5 offset:47104
v_mfma_f32_16x16x32_bf16 v[224:227], a[108:111], a[92:95], v[224:227]
v_mfma_f32_16x16x32_bf16 v[200:203], a[108:111], a[84:87], v[200:203]
buffer_load_dwordx4 v1, s[4:7], s44 offen offset:2048 sc1 lds
v_mfma_f32_16x16x32_bf16 v[200:203], a[104:107], a[80:83], v[200:203]
ds_read_b128 a[144:147], v5 offset:41984
v_mfma_f32_16x16x32_bf16 v[176:179], a[104:107], a[72:75], v[176:179]
v_mfma_f32_16x16x32_bf16 v[176:179], a[108:111], a[76:79], v[176:179]
ds_read_b128 a[148:151], v5 offset:48128
v_mfma_f32_16x16x32_bf16 v[152:155], a[108:111], a[68:71], v[152:155]
v_mfma_f32_16x16x32_bf16 v[152:155], a[104:107], a[64:67], v[152:155]
buffer_load_dwordx4 v1, s[4:7], s44 offen offset:3072 sc1 lds
s_add_u32 m0, s19, 81920
s_waitcnt vmcnt(13)
v_mfma_f32_16x16x32_bf16 v[140:143], a[112:115], a[0:3], v[140:143]
s_xor_b32 s44, s85, 49152
s_waitcnt vmcnt(12)
v_mfma_f32_16x16x32_bf16 v[140:143], a[116:119], a[4:7], v[140:143]
s_waitcnt vmcnt(10)
v_mfma_f32_16x16x32_bf16 v[164:167], a[116:119], a[12:15], v[164:167]
v_mfma_f32_16x16x32_bf16 v[164:167], a[112:115], a[8:11], v[164:167]
s_waitcnt vmcnt(9)
v_mfma_f32_16x16x32_bf16 v[188:191], a[112:115], a[16:19], v[188:191]
buffer_load_dwordx4 v1, s[4:7], s44 offen offset:0 sc1 lds
s_waitcnt vmcnt(9)
v_mfma_f32_16x16x32_bf16 v[188:191], a[116:119], a[20:23], v[188:191]
s_waitcnt vmcnt(7)
v_mfma_f32_16x16x32_bf16 v[212:215], a[116:119], a[28:31], v[212:215]
v_mfma_f32_16x16x32_bf16 v[212:215], a[112:115], a[24:27], v[212:215]
s_waitcnt lgkmcnt(0)
v_mfma_f32_16x16x32_bf16 v[216:219], a[128:131], a[24:27], v[216:219]
ds_read_b128 a[96:99], v5 offset:12288
v_cvt_pk_bf16_f32 v140, v140, v141
v_mfma_f32_16x16x32_bf16 v[216:219], a[132:135], a[28:31], v[216:219]
buffer_load_dwordx4 v1, s[4:7], s44 offen offset:1024 sc1 lds
v_mfma_f32_16x16x32_bf16 v[192:195], a[132:135], a[20:23], v[192:195]
ds_read_b128 a[100:103], v5 offset:18432
v_cvt_pk_bf16_f32 v141, v142, v143
v_mfma_f32_16x16x32_bf16 v[192:195], a[128:131], a[16:19], v[192:195]
v_cvt_pk_bf16_f32 v164, v164, v165
v_cvt_pk_bf16_f32 v165, v166, v167
v_mfma_f32_16x16x32_bf16 v[168:171], a[128:131], a[8:11], v[168:171]
v_cvt_pk_bf16_f32 v188, v188, v189
v_cvt_pk_bf16_f32 v189, v190, v191
v_mfma_f32_16x16x32_bf16 v[168:171], a[132:135], a[12:15], v[168:171]
buffer_load_dwordx4 v1, s[4:7], s44 offen offset:2048 sc1 lds
v_mfma_f32_16x16x32_bf16 v[144:147], a[132:135], a[4:7], v[144:147]
ds_read_b128 a[104:107], v5 offset:24576
v_cvt_pk_bf16_f32 v212, v212, v213
v_mfma_f32_16x16x32_bf16 v[144:147], a[128:131], a[0:3], v[144:147]
v_cvt_pk_bf16_f32 v213, v214, v215
v_mfma_f32_16x16x32_bf16 v[148:151], a[136:139], a[0:3], v[148:151]
ds_read_b128 a[108:111], v5 offset:30720
v_cvt_pk_bf16_f32 v214, v216, v217
v_mfma_f32_16x16x32_bf16 v[148:151], a[140:143], a[4:7], v[148:151]
v_cvt_pk_bf16_f32 v215, v218, v219
v_mfma_f32_16x16x32_bf16 v[172:175], a[140:143], a[12:15], v[172:175]
buffer_load_dwordx4 v1, s[4:7], s44 offen offset:3072 sc1 lds
s_add_u32 m0, s19, 147456
v_mfma_f32_16x16x32_bf16 v[172:175], a[136:139], a[8:11], v[172:175]
s_xor_b32 s44, s85, 114688
ds_read_b128 a[112:115], v5 offset:36864
v_mfma_f32_16x16x32_bf16 v[196:199], a[136:139], a[16:19], v[196:199]
v_cvt_pk_bf16_f32 v166, v168, v169
v_cvt_pk_bf16_f32 v167, v170, v171
v_mfma_f32_16x16x32_bf16 v[196:199], a[140:143], a[20:23], v[196:199]
ds_read_b128 a[116:119], v5 offset:43008
v_cvt_pk_bf16_f32 v190, v192, v193
v_mfma_f32_16x16x32_bf16 v[220:223], a[140:143], a[28:31], v[220:223]
v_cvt_pk_bf16_f32 v142, v144, v145
v_cvt_pk_bf16_f32 v143, v146, v147
v_mfma_f32_16x16x32_bf16 v[220:223], a[136:139], a[24:27], v[220:223]
buffer_load_dwordx4 v1, s[4:7], s44 offen offset:0 sc1 lds
v_mfma_f32_16x16x32_bf16 v[224:227], a[144:147], a[24:27], v[224:227]
v_mfma_f32_16x16x32_bf16 v[92:95], a[240:243], v[140:143], 0
v_mfma_f32_16x16x32_bf16 v[224:227], a[148:151], a[28:31], v[224:227]
v_mfma_f32_16x16x32_bf16 v[96:99], a[244:247], v[140:143], 0
v_mfma_f32_16x16x32_bf16 v[200:203], a[148:151], a[20:23], v[200:203]
v_mfma_f32_16x16x32_bf16 v[100:103], a[240:243], v[164:167], 0
v_mfma_f32_16x16x32_bf16 v[200:203], a[144:147], a[16:19], v[200:203]
v_mfma_f32_16x16x32_bf16 v[104:107], a[244:247], v[164:167], 0
v_mfma_f32_16x16x32_bf16 v[176:179], a[144:147], a[8:11], v[176:179]
buffer_load_dwordx4 v1, s[4:7], s44 offen offset:1024 sc1 lds
v_mfma_f32_16x16x32_bf16 v[176:179], a[148:151], a[12:15], v[176:179]
v_max3_f32 v236, v92, v93, v94
v_max3_f32 v237, -v92, -v93, -v94
v_mfma_f32_16x16x32_bf16 v[152:155], a[148:151], a[4:7], v[152:155]
v_max3_f32 v236, v236, v95, v96
v_max3_f32 v237, v237, -v95, -v96
v_mfma_f32_16x16x32_bf16 v[152:155], a[144:147], a[0:3], v[152:155]
v_max3_f32 v236, v236, v97, v98
s_waitcnt lgkmcnt(0)
v_mfma_f32_16x16x32_bf16 v[132:135], a[96:99], a[32:35], v[132:135]
ds_read_b128 a[128:131], v5 offset:13312
v_max3_f32 v237, v237, -v97, -v98
v_mfma_f32_16x16x32_bf16 v[132:135], a[100:103], a[36:39], v[132:135]
buffer_load_dwordx4 v1, s[4:7], s44 offen offset:2048 sc1 lds
v_mfma_f32_16x16x32_bf16 v[156:159], a[100:103], a[44:47], v[156:159]
ds_read_b128 a[132:135], v5 offset:19456
v_max_f32 v236, v236, v99
v_mfma_f32_16x16x32_bf16 v[156:159], a[96:99], a[40:43], v[156:159]
v_max_f32_e64 v237, v237, -v99
v_max3_f32 v238, v100, v101, v102
v_mfma_f32_16x16x32_bf16 v[180:183], a[96:99], a[48:51], v[180:183]
v_permlane32_swap_b32 v236, v237
v_mfma_f32_16x16x32_bf16 v[180:183], a[100:103], a[52:55], v[180:183]
buffer_load_dwordx4 v1, s[4:7], s44 offen offset:3072 sc1 lds
s_add_u32 m0, s19, 98304
v_mfma_f32_16x16x32_bf16 v[204:207], a[100:103], a[60:63], v[204:207]
s_xor_b32 s44, s85, 65536
ds_read_b128 a[136:139], v5 offset:25600
v_mfma_f32_16x16x32_bf16 v[204:207], a[96:99], a[56:59], v[204:207]
v_max_f32 v236, v236, v237
v_mov_b32 v244, v236
v_mfma_f32_16x16x32_bf16 v[204:207], a[104:107], a[88:91], v[204:207]
ds_read_b128 a[140:143], v5 offset:31744
v_max3_f32 v239, -v100, -v101, -v102
L_stub7:
s_cbranch_execz L_wret2
v_mfma_f32_16x16x32_bf16 v[204:207], a[108:111], a[92:95], v[204:207]
v_permlane16_swap_b32 v236, v244
v_mfma_f32_16x16x32_bf16 v[180:183], a[108:111], a[84:87], v[180:183]
buffer_load_dwordx4 v1, s[4:7], s44 offen offset:0 sc1 lds
v_mfma_f32_16x16x32_bf16 v[180:183], a[104:107], a[80:83], v[180:183]
ds_read_b128 a[144:147], v5 offset:37888
v_max_f32 v236, v236, v244
v_mfma_f32_16x16x32_bf16 v[156:159], a[104:107], a[72:75], v[156:159]
v_mov_b32 v244, v236
v_max3_f32 v238, v238, v103, v104
v_mfma_f32_16x16x32_bf16 v[156:159], a[108:111], a[76:79], v[156:159]
ds_read_b128 a[148:151], v5 offset:44032
v_max3_f32 v239, v239, -v103, -v104
v_mfma_f32_16x16x32_bf16 v[132:135], a[108:111], a[68:71], v[132:135]
v_permlane32_swap_b32 v236, v244
v_mfma_f32_16x16x32_bf16 v[132:135], a[104:107], a[64:67], v[132:135]
buffer_load_dwordx4 v1, s[4:7], s44 offen offset:1024 sc1 lds
v_mfma_f32_16x16x32_bf16 v[132:135], a[112:115], a[0:3], v[132:135]
v_mul_f32_e64 v236, -v236, v82
v_mul_f32_e64 v237, -v244, v82
v_mfma_f32_16x16x32_bf16 v[132:135], a[116:119], a[4:7], v[132:135]
v_max3_f32 v238, v238, v105, v106
v_max3_f32 v239, v239, -v105, -v106
v_mfma_f32_16x16x32_bf16 v[156:159], a[116:119], a[12:15], v[156:159]
v_max_f32 v238, v238, v107
v_max_f32_e64 v239, v239, -v107
v_mfma_f32_16x16x32_bf16 v[156:159], a[112:115], a[8:11], v[156:159]
s_nop 0
v_permlane32_swap_b32 v238, v239
v_mfma_f32_16x16x32_bf16 v[180:183], a[112:115], a[16:19], v[180:183]
buffer_load_dwordx4 v1, s[4:7], s44 offen offset:2048 sc1 lds
v_mfma_f32_16x16x32_bf16 v[180:183], a[116:119], a[20:23], v[180:183]
v_max_f32 v238, v238, v239
v_mov_b32 v245, v238
v_mfma_f32_16x16x32_bf16 v[204:207], a[116:119], a[28:31], v[204:207]
s_nop 0
v_permlane16_swap_b32 v238, v245
v_mfma_f32_16x16x32_bf16 v[204:207], a[112:115], a[24:27], v[204:207]
s_waitcnt lgkmcnt(0)
s_barrier
v_mfma_f32_16x16x32_bf16 v[208:211], a[128:131], a[56:59], v[208:211]
v_max_f32 v238, v238, v245
v_mov_b32 v245, v238
v_mfma_f32_16x16x32_bf16 v[208:211], a[132:135], a[60:63], v[208:211]
buffer_load_dwordx4 v1, s[4:7], s44 offen offset:3072 sc1 lds
s_add_u32 m0, s19, 114688
v_mfma_f32_16x16x32_bf16 v[184:187], a[132:135], a[52:55], v[184:187]
s_xor_b32 s44, s85, 81920
v_cvt_pk_bf16_f32 v191, v194, v195
v_mfma_f32_16x16x32_bf16 v[184:187], a[128:131], a[48:51], v[184:187]
v_permlane32_swap_b32 v238, v245
v_mfma_f32_16x16x32_bf16 v[160:163], a[128:131], a[40:43], v[160:163]
v_mul_f32_e64 v238, -v238, v84
v_mul_f32_e64 v239, -v245, v84
v_mfma_f32_16x16x32_bf16 v[160:163], a[132:135], a[44:47], v[160:163]
buffer_load_dwordx4 v1, s[4:7], s44 offen offset:0 sc1 lds
v_mfma_f32_16x16x32_bf16 v[136:139], a[132:135], a[36:39], v[136:139]
v_mfma_f32_16x16x32_bf16 v[108:111], a[240:243], v[188:191], 0
v_mfma_f32_16x16x32_bf16 v[136:139], a[128:131], a[32:35], v[136:139]
v_mfma_f32_16x16x32_bf16 v[112:115], a[244:247], v[188:191], 0
v_mfma_f32_16x16x32_bf16 v[136:139], a[136:139], a[64:67], v[136:139]
v_mfma_f32_16x16x32_bf16 v[116:119], a[240:243], v[212:215], 0
v_mfma_f32_16x16x32_bf16 v[136:139], a[140:143], a[68:71], v[136:139]
v_mfma_f32_16x16x32_bf16 v[120:123], a[244:247], v[212:215], 0
v_mfma_f32_16x16x32_bf16 v[160:163], a[140:143], a[76:79], v[160:163]
buffer_load_dwordx4 v1, s[4:7], s44 offen offset:1024 sc1 lds
v_mfma_f32_16x16x32_bf16 v[160:163], a[136:139], a[72:75], v[160:163]
v_max3_f32 v240, v108, v109, v110
v_max3_f32 v241, -v108, -v109, -v110
v_mfma_f32_16x16x32_bf16 v[184:187], a[136:139], a[80:83], v[184:187]
v_max3_f32 v240, v240, v111, v112
v_max3_f32 v241, v241, -v111, -v112
v_mfma_f32_16x16x32_bf16 v[184:187], a[140:143], a[84:87], v[184:187]
v_max3_f32 v240, v240, v113, v114
v_max3_f32 v241, v241, -v113, -v114
v_mfma_f32_16x16x32_bf16 v[208:211], a[140:143], a[92:95], v[208:211]
v_max_f32 v240, v240, v115
v_max_f32_e64 v241, v241, -v115
v_mfma_f32_16x16x32_bf16 v[208:211], a[136:139], a[88:91], v[208:211]
buffer_load_dwordx4 v1, s[4:7], s44 offen offset:2048 sc1 lds
v_mfma_f32_16x16x32_bf16 v[208:211], a[144:147], a[24:27], v[208:211]
v_permlane32_swap_b32 v240, v241
v_mfma_f32_16x16x32_bf16 v[208:211], a[148:151], a[28:31], v[208:211]
v_max_f32 v240, v240, v241
v_mov_b32 v246, v240
v_mfma_f32_16x16x32_bf16 v[184:187], a[148:151], a[20:23], v[184:187]
s_nop 0
v_permlane16_swap_b32 v240, v246
v_mfma_f32_16x16x32_bf16 v[184:187], a[144:147], a[16:19], v[184:187]
v_max_f32 v240, v240, v246
v_mov_b32 v246, v240
v_mfma_f32_16x16x32_bf16 v[160:163], a[144:147], a[8:11], v[160:163]
buffer_load_dwordx4 v1, s[4:7], s44 offen offset:3072 sc1 lds
v_mfma_f32_16x16x32_bf16 v[160:163], a[148:151], a[12:15], v[160:163]
v_permlane32_swap_b32 v240, v246
v_mfma_f32_16x16x32_bf16 v[136:139], a[148:151], a[4:7], v[136:139]
v_mul_f32_e64 v240, -v240, v86
v_mul_f32_e64 v241, -v246, v86
v_mfma_f32_16x16x32_bf16 v[136:139], a[144:147], a[0:3], v[136:139]
v_max3_f32 v242, v116, v117, v118
v_max3_f32 v243, -v116, -v117, -v118
v_pk_mul_f32 v[148:149], v[148:149], v[82:83] op_sel:[0,1] op_sel_hi:[1,1]
v_pk_mul_f32 v[150:151], v[150:151], v[82:83] op_sel:[0,1] op_sel_hi:[1,1]
v_cvt_pk_bf16_f32 v148, v148, v149
v_cvt_pk_bf16_f32 v149, v150, v151
ds_write_b64 v232, v[148:149] offset:0
v_pk_mul_f32 v[152:153], v[152:153], v[82:83] op_sel:[0,1] op_sel_hi:[1,1]
v_pk_mul_f32 v[154:155], v[154:155], v[82:83] op_sel:[0,1] op_sel_hi:[1,1]
v_cvt_pk_bf16_f32 v150, v152, v153
v_cvt_pk_bf16_f32 v151, v154, v155
v_pk_mul_f32 v[172:173], v[172:173], v[84:85] op_sel:[0,1] op_sel_hi:[1,1]
v_pk_mul_f32 v[174:175], v[174:175], v[84:85] op_sel:[0,1] op_sel_hi:[1,1]
v_cvt_pk_bf16_f32 v172, v172, v173
buffer_store_dwordx4 a[248:251], v254, s[4:7], s97 offen offset:0 sc1
v_cvt_pk_bf16_f32 v173, v174, v175
ds_write_b64 v232, v[150:151] offset:512
v_pk_mul_f32 v[176:177], v[176:177], v[84:85] op_sel:[0,1] op_sel_hi:[1,1]
v_pk_mul_f32 v[178:179], v[178:179], v[84:85] op_sel:[0,1] op_sel_hi:[1,1]
v_cvt_pk_bf16_f32 v174, v176, v177
v_cvt_pk_bf16_f32 v175, v178, v179
v_pk_mul_f32 v[196:197], v[196:197], v[86:87] op_sel:[0,1] op_sel_hi:[1,1]
v_pk_mul_f32 v[198:199], v[198:199], v[86:87] op_sel:[0,1] op_sel_hi:[1,1]
v_cvt_pk_bf16_f32 v196, v196, v197
v_cvt_pk_bf16_f32 v197, v198, v199
v_pk_mul_f32 v[200:201], v[200:201], v[86:87] op_sel:[0,1] op_sel_hi:[1,1]
v_pk_mul_f32 v[202:203], v[202:203], v[86:87] op_sel:[0,1] op_sel_hi:[1,1]
v_cvt_pk_bf16_f32 v198, v200, v201
v_cvt_pk_bf16_f32 v199, v202, v203
ds_write_b64 v232, v[172:173] offset:1024
v_pk_mul_f32 v[220:221], v[220:221], v[88:89] op_sel:[0,1] op_sel_hi:[1,1]
v_pk_mul_f32 v[222:223], v[222:223], v[88:89] op_sel:[0,1] op_sel_hi:[1,1]
v_cvt_pk_bf16_f32 v220, v220, v221
v_cvt_pk_bf16_f32 v221, v222, v223
v_pk_fma_f32 v[48:49], v[92:93], v[82:83], v[236:237] op_sel:[0,0,0] op_sel_hi:[1,0,0]
v_pk_fma_f32 v[50:51], v[94:95], v[82:83], v[236:237] op_sel:[0,0,0] op_sel_hi:[1,0,0]
v_pk_fma_f32 v[52:53], v[96:97], v[82:83], v[236:237] op_sel:[0,0,0] op_sel_hi:[1,0,0]
v_pk_fma_f32 v[54:55], v[98:99], v[82:83], v[236:237] op_sel:[0,0,0] op_sel_hi:[1,0,0]
v_exp_f32 v48, v48
v_exp_f32 v49, v49
ds_write_b64 v232, v[174:175] offset:1536
buffer_store_dwordx4 a[248:251], v1, s[4:7], s96 offen offset:0 sc1
v_exp_f32 v50, v50
v_exp_f32 v51, v51
v_exp_f32 v52, v52
v_exp_f32 v53, v53
ds_write_b64 v232, v[196:197] offset:2048
v_exp_f32 v54, v54
v_exp_f32 v55, v55
v_cvt_pk_bf16_f32 v140, v48, v49
v_cvt_pk_bf16_f32 v141, v50, v51
v_cvt_pk_bf16_f32 v142, v52, v53
v_cvt_pk_bf16_f32 v143, v54, v55
v_pk_mul_f32 v[224:225], v[224:225], v[88:89] op_sel:[0,1] op_sel_hi:[1,1]
v_pk_mul_f32 v[226:227], v[226:227], v[88:89] op_sel:[0,1] op_sel_hi:[1,1]
v_cvt_pk_bf16_f32 v222, v224, v225
v_mfma_f32_16x16x32_bf16 v[148:151], v[16:19], v[140:143], 0
ds_write_b64 v232, v[198:199] offset:2560
v_cvt_pk_bf16_f32 v223, v226, v227
s_add_u32 m0, s19, 131072
v_pk_fma_f32 v[92:93], v[92:93], v[82:83], v[236:237] op_sel:[0,0,1] op_sel_hi:[1,0,1] neg_lo:[1,0,0] neg_hi:[1,0,0]
v_pk_fma_f32 v[94:95], v[94:95], v[82:83], v[236:237] op_sel:[0,0,1] op_sel_hi:[1,0,1] neg_lo:[1,0,0] neg_hi:[1,0,0]
v_pk_fma_f32 v[96:97], v[96:97], v[82:83], v[236:237] op_sel:[0,0,1] op_sel_hi:[1,0,1] neg_lo:[1,0,0] neg_hi:[1,0,0]
s_nop 1
v_rcp_f32 v148, v148
buffer_store_dwordx4 a[248:251], v3, s[4:7], s91 offen offset:0 sc1
v_pk_mul_f32 v[48:49], v[48:49], v[148:149] op_sel:[0,0] op_sel_hi:[1,0]
ds_write_b64 v232, v[220:221] offset:3072
v_pk_mul_f32 v[50:51], v[50:51], v[148:149] op_sel:[0,0] op_sel_hi:[1,0]
v_cvt_pk_bf16_f32 v140, v48, v49
v_cvt_pk_bf16_f32 v141, v50, v51
v_pk_fma_f32 v[98:99], v[98:99], v[82:83], v[236:237] op_sel:[0,0,1] op_sel_hi:[1,0,1] neg_lo:[1,0,0] neg_hi:[1,0,0]
v_exp_f32 v92, v92
v_exp_f32 v93, v93
buffer_store_dwordx4 a[248:251], v3, s[4:7], s91 offen offset:1024 sc1
ds_write_b64 v232, v[222:223] offset:3584
v_exp_f32 v94, v94
v_exp_f32 v95, v95
v_exp_f32 v96, v96
v_exp_f32 v97, v97
v_exp_f32 v98, v98
v_exp_f32 v99, v99
ds_write_b64 v233, v[140:141] offset:16384
s_xor_b32 s44, s85, 98304
v_cvt_pk_bf16_f32 v144, v92, v93
v_cvt_pk_bf16_f32 v145, v94, v95
v_cvt_pk_bf16_f32 v146, v96, v97
v_cvt_pk_bf16_f32 v147, v98, v99
buffer_load_dwordx4 v1, s[4:7], s44 offen offset:0 sc1 lds
v_pk_mul_f32 v[52:53], v[52:53], v[148:149] op_sel:[0,0] op_sel_hi:[1,0]
v_cvt_pk_bf16_f32 v142, v52, v53
v_pk_mul_f32 v[54:55], v[54:55], v[148:149] op_sel:[0,0] op_sel_hi:[1,0]
v_cvt_pk_bf16_f32 v143, v54, v55
v_mfma_f32_16x16x32_bf16 v[152:155], v[16:19], v[144:147], 0
ds_write_b64 v233, v[142:143] offset:16896
v_max3_f32 v242, v242, v119, v120
v_max3_f32 v243, v243, -v119, -v120
v_pk_fma_f32 v[56:57], v[100:101], v[84:85], v[238:239] op_sel:[0,0,0] op_sel_hi:[1,0,0]
v_pk_fma_f32 v[58:59], v[102:103], v[84:85], v[238:239] op_sel:[0,0,0] op_sel_hi:[1,0,0]
v_pk_fma_f32 v[60:61], v[104:105], v[84:85], v[238:239] op_sel:[0,0,0] op_sel_hi:[1,0,0]
s_nop 1
v_rcp_f32 v152, v152
v_pk_fma_f32 v[62:63], v[106:107], v[84:85], v[238:239] op_sel:[0,0,0] op_sel_hi:[1,0,0]
v_pk_mul_f32 v[92:93], v[92:93], v[152:153] op_sel:[0,0] op_sel_hi:[1,0]
v_pk_mul_f32 v[94:95], v[94:95], v[152:153] op_sel:[0,0] op_sel_hi:[1,0]
v_cvt_pk_bf16_f32 v144, v92, v93
v_cvt_pk_bf16_f32 v145, v94, v95
ds_write_b64 v233, v[144:145] offset:17408
v_exp_f32 v56, v56
v_exp_f32 v57, v57
v_exp_f32 v58, v58
v_exp_f32 v59, v59
v_exp_f32 v60, v60
v_exp_f32 v61, v61
v_exp_f32 v62, v62
v_exp_f32 v63, v63
buffer_load_dwordx4 v1, s[4:7], s44 offen offset:1024 sc1 lds
v_cvt_pk_bf16_f32 v164, v56, v57
v_cvt_pk_bf16_f32 v165, v58, v59
v_cvt_pk_bf16_f32 v166, v60, v61
v_cvt_pk_bf16_f32 v167, v62, v63
v_pk_mul_f32 v[96:97], v[96:97], v[152:153] op_sel:[0,0] op_sel_hi:[1,0]
v_pk_mul_f32 v[98:99], v[98:99], v[152:153] op_sel:[0,0] op_sel_hi:[1,0]
v_cvt_pk_bf16_f32 v146, v96, v97
v_mfma_f32_16x16x32_bf16 v[172:175], v[16:19], v[164:167], 0
v_cvt_pk_bf16_f32 v147, v98, v99
ds_write_b64 v233, v[146:147] offset:17920
v_max3_f32 v242, v242, v121, v122
v_pk_fma_f32 v[100:101], v[100:101], v[84:85], v[238:239] op_sel:[0,0,1] op_sel_hi:[1,0,1] neg_lo:[1,0,0] neg_hi:[1,0,0]
v_pk_fma_f32 v[102:103], v[102:103], v[84:85], v[238:239] op_sel:[0,0,1] op_sel_hi:[1,0,1] neg_lo:[1,0,0] neg_hi:[1,0,0]
v_pk_fma_f32 v[104:105], v[104:105], v[84:85], v[238:239] op_sel:[0,0,1] op_sel_hi:[1,0,1] neg_lo:[1,0,0] neg_hi:[1,0,0]
s_nop 1
v_rcp_f32 v172, v172
v_pk_fma_f32 v[106:107], v[106:107], v[84:85], v[238:239] op_sel:[0,0,1] op_sel_hi:[1,0,1] neg_lo:[1,0,0] neg_hi:[1,0,0]
v_pk_mul_f32 v[56:57], v[56:57], v[172:173] op_sel:[0,0] op_sel_hi:[1,0]
v_pk_mul_f32 v[58:59], v[58:59], v[172:173] op_sel:[0,0] op_sel_hi:[1,0]
v_cvt_pk_bf16_f32 v164, v56, v57
v_cvt_pk_bf16_f32 v165, v58, v59
v_exp_f32 v100, v100
ds_write_b64 v233, v[164:165] offset:18432
v_exp_f32 v101, v101
v_exp_f32 v102, v102
v_exp_f32 v103, v103
v_exp_f32 v104, v104
v_exp_f32 v105, v105
v_exp_f32 v106, v106
v_exp_f32 v107, v107
buffer_load_dwordx4 v1, s[4:7], s44 offen offset:2048 sc1 lds
v_cvt_pk_bf16_f32 v168, v100, v101
v_cvt_pk_bf16_f32 v169, v102, v103
v_cvt_pk_bf16_f32 v170, v104, v105
v_cvt_pk_bf16_f32 v171, v106, v107
v_pk_mul_f32 v[60:61], v[60:61], v[172:173] op_sel:[0,0] op_sel_hi:[1,0]
v_pk_mul_f32 v[62:63], v[62:63], v[172:173] op_sel:[0,0] op_sel_hi:[1,0]
v_cvt_pk_bf16_f32 v166, v60, v61
v_mfma_f32_16x16x32_bf16 v[176:179], v[16:19], v[168:171], 0
v_cvt_pk_bf16_f32 v167, v62, v63
ds_write_b64 v233, v[166:167] offset:18944
v_max3_f32 v243, v243, -v121, -v122
v_pk_fma_f32 v[64:65], v[108:109], v[86:87], v[240:241] op_sel:[0,0,0] op_sel_hi:[1,0,0]
v_pk_fma_f32 v[66:67], v[110:111], v[86:87], v[240:241] op_sel:[0,0,0] op_sel_hi:[1,0,0]
v_pk_fma_f32 v[68:69], v[112:113], v[86:87], v[240:241] op_sel:[0,0,0] op_sel_hi:[1,0,0]
s_nop 1
v_rcp_f32 v176, v176
v_pk_fma_f32 v[70:71], v[114:115], v[86:87], v[240:241] op_sel:[0,0,0] op_sel_hi:[1,0,0]
v_pk_mul_f32 v[100:101], v[100:101], v[176:177] op_sel:[0,0] op_sel_hi:[1,0]
v_pk_mul_f32 v[102:103], v[102:103], v[176:177] op_sel:[0,0] op_sel_hi:[1,0]
v_cvt_pk_bf16_f32 v168, v100, v101
v_cvt_pk_bf16_f32 v169, v102, v103
v_exp_f32 v64, v64
ds_write_b64 v233, v[168:169] offset:19456
buffer_load_dwordx4 v1, s[4:7], s44 offen offset:3072 sc1 lds
v_exp_f32 v65, v65
v_exp_f32 v66, v66
v_exp_f32 v67, v67
v_exp_f32 v68, v68
v_exp_f32 v69, v69
v_exp_f32 v70, v70
v_exp_f32 v71, v71
v_cvt_pk_bf16_f32 v188, v64, v65
v_cvt_pk_bf16_f32 v189, v66, v67
v_cvt_pk_bf16_f32 v190, v68, v69
v_cvt_pk_bf16_f32 v191, v70, v71
v_pk_mul_f32 v[104:105], v[104:105], v[176:177] op_sel:[0,0] op_sel_hi:[1,0]
v_pk_mul_f32 v[106:107], v[106:107], v[176:177] op_sel:[0,0] op_sel_hi:[1,0]
v_cvt_pk_bf16_f32 v170, v104, v105
v_mfma_f32_16x16x32_bf16 v[196:199], v[16:19], v[188:191], 0
v_cvt_pk_bf16_f32 v171, v106, v107
ds_write_b64 v233, v[170:171] offset:19968
buffer_store_dwordx4 a[248:251], v2, s[4:7], s72 offen offset:0 sc1
s_nop 4
v_rcp_f32 v196, v196
v_pk_fma_f32 v[108:109], v[108:109], v[86:87], v[240:241] op_sel:[0,0,1] op_sel_hi:[1,0,1] neg_lo:[1,0,0] neg_hi:[1,0,0]
v_pk_mul_f32 v[64:65], v[64:65], v[196:197] op_sel:[0,0] op_sel_hi:[1,0]
v_pk_mul_f32 v[66:67], v[66:67], v[196:197] op_sel:[0,0] op_sel_hi:[1,0]
v_cvt_pk_bf16_f32 v188, v64, v65
v_cvt_pk_bf16_f32 v189, v66, v67
v_pk_fma_f32 v[110:111], v[110:111], v[86:87], v[240:241] op_sel:[0,0,1] op_sel_hi:[1,0,1] neg_lo:[1,0,0] neg_hi:[1,0,0]
ds_write_b64 v233, v[188:189] offset:20480
v_pk_fma_f32 v[112:113], v[112:113], v[86:87], v[240:241] op_sel:[0,0,1] op_sel_hi:[1,0,1] neg_lo:[1,0,0] neg_hi:[1,0,0]
v_pk_fma_f32 v[114:115], v[114:115], v[86:87], v[240:241] op_sel:[0,0,1] op_sel_hi:[1,0,1] neg_lo:[1,0,0] neg_hi:[1,0,0]
v_exp_f32 v108, v108
v_exp_f32 v109, v109
v_exp_f32 v110, v110
v_exp_f32 v111, v111
v_exp_f32 v112, v112
v_exp_f32 v113, v113
v_exp_f32 v114, v114
v_exp_f32 v115, v115
v_max_f32 v242, v242, v123
v_max_f32_e64 v243, v243, -v123
v_cvt_pk_bf16_f32 v192, v108, v109
v_cvt_pk_bf16_f32 v193, v110, v111
v_cvt_pk_bf16_f32 v194, v112, v113
v_cvt_pk_bf16_f32 v195, v114, v115
v_pk_mul_f32 v[68:69], v[68:69], v[196:197] op_sel:[0,0] op_sel_hi:[1,0]
v_pk_mul_f32 v[70:71], v[70:71], v[196:197] op_sel:[0,0] op_sel_hi:[1,0]
v_permlane32_swap_b32 v242, v243
v_mfma_f32_16x16x32_bf16 v[200:203], v[16:19], v[192:195], 0
v_cvt_pk_bf16_f32 v190, v68, v69
v_cvt_pk_bf16_f32 v191, v70, v71
ds_write_b64 v233, v[190:191] offset:20992
v_max_f32 v242, v242, v243
v_mov_b32 v247, v242
buffer_store_dwordx4 a[248:251], v2, s[4:7], s72 offen offset:1024 sc1
s_nop 0
v_permlane16_swap_b32 v242, v247
v_rcp_f32 v200, v200
v_max_f32 v242, v242, v247
v_mov_b32 v247, v242
v_pk_mul_f32 v[108:109], v[108:109], v[200:201] op_sel:[0,0] op_sel_hi:[1,0]
v_pk_mul_f32 v[110:111], v[110:111], v[200:201] op_sel:[0,0] op_sel_hi:[1,0]
v_cvt_pk_bf16_f32 v192, v108, v109
v_cvt_pk_bf16_f32 v193, v110, v111
v_permlane32_swap_b32 v242, v247
ds_write_b64 v233, v[192:193] offset:21504
v_mul_f32_e64 v242, -v242, v88
v_mul_f32_e64 v243, -v247, v88
v_pk_fma_f32 v[124:125], v[116:117], v[88:89], v[242:243] op_sel:[0,0,0] op_sel_hi:[1,0,0]
v_pk_fma_f32 v[126:127], v[118:119], v[88:89], v[242:243] op_sel:[0,0,0] op_sel_hi:[1,0,0]
v_pk_fma_f32 v[128:129], v[120:121], v[88:89], v[242:243] op_sel:[0,0,0] op_sel_hi:[1,0,0]
v_pk_fma_f32 v[130:131], v[122:123], v[88:89], v[242:243] op_sel:[0,0,0] op_sel_hi:[1,0,0]
v_exp_f32 v124, v124
v_exp_f32 v125, v125
v_exp_f32 v126, v126
v_exp_f32 v127, v127
v_exp_f32 v128, v128
v_exp_f32 v129, v129
v_exp_f32 v130, v130
v_exp_f32 v131, v131
v_cvt_pk_bf16_f32 v212, v124, v125
v_cvt_pk_bf16_f32 v213, v126, v127
v_cvt_pk_bf16_f32 v214, v128, v129
v_cvt_pk_bf16_f32 v215, v130, v131
v_pk_mul_f32 v[112:113], v[112:113], v[200:201] op_sel:[0,0] op_sel_hi:[1,0]
v_pk_mul_f32 v[114:115], v[114:115], v[200:201] op_sel:[0,0] op_sel_hi:[1,0]
v_cvt_pk_bf16_f32 v194, v112, v113
v_mfma_f32_16x16x32_bf16 v[220:223], v[16:19], v[212:215], 0
v_cvt_pk_bf16_f32 v195, v114, v115
ds_write_b64 v233, v[194:195] offset:22016
buffer_store_dwordx4 a[248:251], v2, s[4:7], s72 offen offset:2048 sc1
s_nop 4
v_rcp_f32 v220, v220
v_pk_fma_f32 v[116:117], v[116:117], v[88:89], v[242:243] op_sel:[0,0,1] op_sel_hi:[1,0,1] neg_lo:[1,0,0] neg_hi:[1,0,0]
v_pk_mul_f32 v[124:125], v[124:125], v[220:221] op_sel:[0,0] op_sel_hi:[1,0]
v_pk_mul_f32 v[126:127], v[126:127], v[220:221] op_sel:[0,0] op_sel_hi:[1,0]
v_cvt_pk_bf16_f32 v212, v124, v125
v_cvt_pk_bf16_f32 v213, v126, v127
v_pk_fma_f32 v[118:119], v[118:119], v[88:89], v[242:243] op_sel:[0,0,1] op_sel_hi:[1,0,1] neg_lo:[1,0,0] neg_hi:[1,0,0]
ds_write_b64 v233, v[212:213] offset:22528
v_pk_fma_f32 v[120:121], v[120:121], v[88:89], v[242:243] op_sel:[0,0,1] op_sel_hi:[1,0,1] neg_lo:[1,0,0] neg_hi:[1,0,0]
v_pk_fma_f32 v[122:123], v[122:123], v[88:89], v[242:243] op_sel:[0,0,1] op_sel_hi:[1,0,1] neg_lo:[1,0,0] neg_hi:[1,0,0]
v_exp_f32 v116, v116
v_exp_f32 v117, v117
v_exp_f32 v118, v118
v_exp_f32 v119, v119
v_exp_f32 v120, v120
v_exp_f32 v121, v121
v_exp_f32 v122, v122
v_exp_f32 v123, v123
v_cvt_pk_bf16_f32 v216, v116, v117
v_cvt_pk_bf16_f32 v217, v118, v119
v_cvt_pk_bf16_f32 v218, v120, v121
v_cvt_pk_bf16_f32 v219, v122, v123
v_pk_mul_f32 v[128:129], v[128:129], v[220:221] op_sel:[0,0] op_sel_hi:[1,0]
v_pk_mul_f32 v[130:131], v[130:131], v[220:221] op_sel:[0,0] op_sel_hi:[1,0]
v_cvt_pk_bf16_f32 v214, v128, v129
v_mfma_f32_16x16x32_bf16 v[224:227], v[16:19], v[216:219], 0
v_cvt_pk_bf16_f32 v215, v130, v131
ds_write_b64 v233, v[214:215] offset:23040
buffer_store_dwordx4 a[248:251], v2, s[4:7], s72 offen offset:3072 sc1
s_nop 4
v_rcp_f32 v224, v224
s_nop 0
v_pk_mul_f32 v[116:117], v[116:117], v[224:225] op_sel:[0,0] op_sel_hi:[1,0]
v_pk_mul_f32 v[118:119], v[118:119], v[224:225] op_sel:[0,0] op_sel_hi:[1,0]
v_cvt_pk_bf16_f32 v216, v116, v117
v_cvt_pk_bf16_f32 v217, v118, v119
v_pk_mul_f32 v[120:121], v[120:121], v[224:225] op_sel:[0,0] op_sel_hi:[1,0]
ds_write_b64 v233, v[216:217] offset:23552
v_pk_mul_f32 v[122:123], v[122:123], v[224:225] op_sel:[0,0] op_sel_hi:[1,0]
v_cvt_pk_bf16_f32 v218, v120, v121
v_cvt_pk_bf16_f32 v219, v122, v123
ds_write_b64 v233, v[218:219] offset:24064
s_waitcnt vmcnt(8)
s_waitcnt lgkmcnt(0)
s_barrier
ds_read_b64_tr_b16 a[0:1], v234 offset:16384
ds_read_b64_tr_b16 a[2:3], v234 offset:18432
ds_read_b64_tr_b16 a[12:13], v234 offset:20480
ds_read_b64_tr_b16 a[14:15], v234 offset:22528
ds_read_b64_tr_b16 a[24:25], v234 offset:24576
ds_read_b64_tr_b16 a[26:27], v234 offset:26624
ds_read_b64_tr_b16 a[4:5], v8 offset:0
ds_read_b64_tr_b16 a[6:7], v8 offset:1024
ds_read_b64_tr_b16 a[8:9], v8 offset:512
ds_read_b64_tr_b16 a[10:11], v8 offset:1536
ds_read_b64_tr_b16 a[36:37], v234 offset:28672
ds_read_b64_tr_b16 a[38:39], v234 offset:30720
ds_read_b64_tr_b16 a[16:17], v8 offset:2048
ds_read_b64_tr_b16 a[18:19], v8 offset:3072
ds_read_b64_tr_b16 a[20:21], v8 offset:2560
ds_read_b64_tr_b16 a[22:23], v8 offset:3584
ds_read_b64_tr_b16 a[48:49], v234 offset:32768
ds_read_b64_tr_b16 a[50:51], v234 offset:34816
ds_read_b64_tr_b16 a[28:29], v8 offset:4096
ds_read_b64_tr_b16 a[30:31], v8 offset:5120
ds_read_b64_tr_b16 a[32:33], v8 offset:4608
ds_read_b64_tr_b16 a[34:35], v8 offset:5632
ds_read_b64_tr_b16 a[60:61], v234 offset:36864
ds_read_b64_tr_b16 a[62:63], v234 offset:38912
s_waitcnt lgkmcnt(14)
v_mfma_f32_16x16x32_bf16 v[100:103], a[0:3], v[16:19], 0
ds_read_b64_tr_b16 a[40:41], v8 offset:6144
ds_read_b64_tr_b16 a[42:43], v8 offset:7168
ds_read_b64_tr_b16 a[44:45], v8 offset:6656
ds_read_b64_tr_b16 a[46:47], v8 offset:7680
ds_read_b64_tr_b16 a[72:73], v234 offset:40960
ds_read_b64_tr_b16 a[74:75], v234 offset:43008
v_mfma_f32_16x16x32_bf16 v[100:103], a[12:15], v[16:19], v[100:103]
buffer_atomic_add v12, v235, s[4:7], s94 offen sc1
ds_read_b64_tr_b16 a[52:53], v8 offset:8192
ds_read_b64_tr_b16 a[54:55], v8 offset:9216
ds_read_b64_tr_b16 a[56:57], v8 offset:8704
ds_read_b64_tr_b16 a[58:59], v8 offset:9728
ds_read_b64_tr_b16 a[84:85], v234 offset:45056
ds_read_b64_tr_b16 a[86:87], v234 offset:47104
v_mfma_f32_16x16x32_bf16 v[100:103], a[24:27], v[16:19], v[100:103]
ds_read_b64_tr_b16 a[64:65], v8 offset:10240
ds_read_b64_tr_b16 a[66:67], v8 offset:11264
v_mfma_f32_16x16x32_bf16 v[92:95], a[0:3], a[4:7], 0
ds_read_b64_tr_b16 a[68:69], v8 offset:10752
ds_read_b64_tr_b16 a[70:71], v8 offset:11776
v_mfma_f32_16x16x32_bf16 v[96:99], a[0:3], a[8:11], 0
ds_read_b64_tr_b16 a[76:77], v8 offset:12288
s_waitcnt lgkmcnt(14)
v_mfma_f32_16x16x32_bf16 v[100:103], a[36:39], v[16:19], v[100:103]
ds_read_b64_tr_b16 a[78:79], v8 offset:13312
v_mfma_f32_16x16x32_bf16 v[92:95], a[12:15], a[16:19], v[92:95]
ds_read_b64_tr_b16 a[80:81], v8 offset:12800
ds_read_b64_tr_b16 a[82:83], v8 offset:13824
v_mfma_f32_16x16x32_bf16 v[96:99], a[12:15], a[20:23], v[96:99]
ds_read_b64_tr_b16 a[88:89], v8 offset:14336
v_mfma_f32_16x16x32_bf16 v[100:103], a[48:51], v[16:19], v[100:103]
ds_read_b64_tr_b16 a[90:91], v8 offset:15360
v_mfma_f32_16x16x32_bf16 v[92:95], a[24:27], a[28:31], v[92:95]
ds_read_b64_tr_b16 a[92:93], v8 offset:14848
ds_read_b64_tr_b16 a[94:95], v8 offset:15872
v_mfma_f32_16x16x32_bf16 v[96:99], a[24:27], a[32:35], v[96:99]
v_cvt_pk_bf16_f32 v132, v132, v133
v_cvt_pk_bf16_f32 v156, v156, v157
v_mfma_f32_16x16x32_bf16 v[100:103], a[60:63], v[16:19], v[100:103]
v_cvt_pk_bf16_f32 v180, v180, v181
v_cvt_pk_bf16_f32 v204, v204, v205
v_mfma_f32_16x16x32_bf16 v[92:95], a[36:39], a[40:43], v[92:95]
v_cvt_pk_bf16_f32 v133, v134, v135
v_cvt_pk_bf16_f32 v157, v158, v159
s_waitcnt lgkmcnt(14)
v_mfma_f32_16x16x32_bf16 v[96:99], a[36:39], a[44:47], v[96:99]
v_cvt_pk_bf16_f32 v181, v182, v183
v_cvt_pk_bf16_f32 v205, v206, v207
v_mfma_f32_16x16x32_bf16 v[100:103], a[72:75], v[16:19], v[100:103]
v_cvt_pk_bf16_f32 v134, v136, v137
v_cvt_pk_bf16_f32 v135, v138, v139
v_mfma_f32_16x16x32_bf16 v[92:95], a[48:51], a[52:55], v[92:95]
v_cvt_pk_bf16_f32 v158, v160, v161
v_cvt_pk_bf16_f32 v159, v162, v163
v_mfma_f32_16x16x32_bf16 v[96:99], a[48:51], a[56:59], v[96:99]
v_cvt_pk_bf16_f32 v182, v184, v185
v_cvt_pk_bf16_f32 v183, v186, v187
s_waitcnt lgkmcnt(12)
v_mfma_f32_16x16x32_bf16 v[100:103], a[84:87], v[16:19], v[100:103]
v_cvt_pk_bf16_f32 v206, v208, v209
v_cvt_pk_bf16_f32 v207, v210, v211
s_waitcnt lgkmcnt(10)
v_mfma_f32_16x16x32_bf16 v[92:95], a[60:63], a[64:67], v[92:95]
s_waitcnt lgkmcnt(8)
v_mfma_f32_16x16x32_bf16 v[96:99], a[60:63], a[68:71], v[96:99]
s_nop 1
v_min_u32 v100, -2, v100
v_min_u32 v101, -2, v101
s_waitcnt lgkmcnt(6)
v_mfma_f32_16x16x32_bf16 v[92:95], a[72:75], a[76:79], v[92:95]
v_min_u32 v102, -2, v102
v_min_u32 v103, -2, v103
s_waitcnt lgkmcnt(4)
v_mfma_f32_16x16x32_bf16 v[96:99], a[72:75], a[80:83], v[96:99]
buffer_store_dwordx4 v[100:103], v254, s[4:7], s97 offen sc1
s_waitcnt lgkmcnt(2)
v_mfma_f32_16x16x32_bf16 v[92:95], a[84:87], a[88:91], v[92:95]
s_waitcnt lgkmcnt(0)
v_mfma_f32_16x16x32_bf16 v[96:99], a[84:87], a[92:95], v[96:99]
s_nop 5
v_cvt_pk_bf16_f32 v92, v92, v93
v_cvt_pk_bf16_f32 v93, v94, v95
v_min_u32 v92, -2, v92
v_min_u32 v93, -2, v93
v_cvt_pk_bf16_f32 v94, v96, v97
v_cvt_pk_bf16_f32 v95, v98, v99
v_min_u32 v94, -2, v94
v_min_u32 v95, -2, v95
buffer_store_dwordx4 v[92:95], v1, s[4:7], s96 offen sc1
s_barrier
s_add_u32 m0, s19, 32768
s_xor_b32 s44, s85, 0
buffer_load_dwordx4 v1, s[4:7], s44 offen offset:0 sc1 lds
v_mfma_f32_16x16x32_bf16 v[108:111], a[240:243], v[132:135], 0
v_mfma_f32_16x16x32_bf16 v[172:175], a[240:243], v[156:159], 0
v_mfma_f32_16x16x32_bf16 v[112:115], a[244:247], v[132:135], 0
s_nop 5
v_max3_f32 v236, v108, v109, v110
v_max3_f32 v237, -v108, -v109, -v110
v_mfma_f32_16x16x32_bf16 v[176:179], a[244:247], v[156:159], 0
v_max3_f32 v238, v172, v173, v174
v_max3_f32 v239, -v172, -v173, -v174
v_max3_f32 v236, v236, v111, v112
v_max3_f32 v237, v237, -v111, -v112
v_max3_f32 v236, v236, v113, v114
v_max3_f32 v237, v237, -v113, -v114
s_nop 1
v_max3_f32 v238, v238, v175, v176
v_max3_f32 v239, v239, -v175, -v176
v_max3_f32 v238, v238, v177, v178
v_max3_f32 v239, v239, -v177, -v178
v_max_f32 v236, v236, v115
buffer_load_dwordx4 v1, s[4:7], s44 offen offset:1024 sc1 lds
v_max_f32_e64 v237, v237, -v115
v_max_f32 v238, v238, v179
v_max_f32_e64 v239, v239, -v179
v_permlane32_swap_b32 v236, v237
s_nop 0
v_permlane32_swap_b32 v238, v239
v_mov_b32 v11, 0
buffer_atomic_add v11, v251, s[4:7], s89 offen sc0 sc1
v_max_f32 v236, v236, v237
v_max_f32 v238, v238, v239
v_mov_b32 v244, v236
v_mov_b32 v245, v238
s_nop 0
v_permlane16_swap_b32 v236, v244
v_permlane16_swap_b32 v238, v245
v_max_f32 v236, v236, v244
v_max_f32 v238, v238, v245
v_mov_b32 v244, v236
v_mov_b32 v245, v238
s_nop 0
v_permlane32_swap_b32 v236, v244
v_permlane32_swap_b32 v238, v245
v_mul_f32_e64 v236, -v236, v82
v_mul_f32_e64 v237, -v244, v82
buffer_load_dwordx4 v1, s[4:7], s44 offen offset:2048 sc1 lds
v_mul_f32_e64 v238, -v238, v84
v_mul_f32_e64 v239, -v245, v84
v_pk_fma_f32 v[116:117], v[108:109], v[82:83], v[236:237] op_sel:[0,0,0] op_sel_hi:[1,0,0]
v_pk_fma_f32 v[118:119], v[110:111], v[82:83], v[236:237] op_sel:[0,0,0] op_sel_hi:[1,0,0]
v_pk_fma_f32 v[120:121], v[112:113], v[82:83], v[236:237] op_sel:[0,0,0] op_sel_hi:[1,0,0]
v_pk_fma_f32 v[122:123], v[114:115], v[82:83], v[236:237] op_sel:[0,0,0] op_sel_hi:[1,0,0]
v_pk_fma_f32 v[148:149], v[172:173], v[84:85], v[238:239] op_sel:[0,0,0] op_sel_hi:[1,0,0]
v_pk_fma_f32 v[150:151], v[174:175], v[84:85], v[238:239] op_sel:[0,0,0] op_sel_hi:[1,0,0]
v_pk_fma_f32 v[152:153], v[176:177], v[84:85], v[238:239] op_sel:[0,0,0] op_sel_hi:[1,0,0]
v_pk_fma_f32 v[154:155], v[178:179], v[84:85], v[238:239] op_sel:[0,0,0] op_sel_hi:[1,0,0]
v_pk_fma_f32 v[108:109], v[108:109], v[82:83], v[236:237] op_sel:[0,0,1] op_sel_hi:[1,0,1] neg_lo:[1,0,0] neg_hi:[1,0,0]
v_pk_fma_f32 v[110:111], v[110:111], v[82:83], v[236:237] op_sel:[0,0,1] op_sel_hi:[1,0,1] neg_lo:[1,0,0] neg_hi:[1,0,0]
v_pk_fma_f32 v[112:113], v[112:113], v[82:83], v[236:237] op_sel:[0,0,1] op_sel_hi:[1,0,1] neg_lo:[1,0,0] neg_hi:[1,0,0]
v_pk_fma_f32 v[114:115], v[114:115], v[82:83], v[236:237] op_sel:[0,0,1] op_sel_hi:[1,0,1] neg_lo:[1,0,0] neg_hi:[1,0,0]
v_pk_fma_f32 v[172:173], v[172:173], v[84:85], v[238:239] op_sel:[0,0,1] op_sel_hi:[1,0,1] neg_lo:[1,0,0] neg_hi:[1,0,0]
v_pk_fma_f32 v[174:175], v[174:175], v[84:85], v[238:239] op_sel:[0,0,1] op_sel_hi:[1,0,1] neg_lo:[1,0,0] neg_hi:[1,0,0]
v_pk_fma_f32 v[176:177], v[176:177], v[84:85], v[238:239] op_sel:[0,0,1] op_sel_hi:[1,0,1] neg_lo:[1,0,0] neg_hi:[1,0,0]
v_pk_fma_f32 v[178:179], v[178:179], v[84:85], v[238:239] op_sel:[0,0,1] op_sel_hi:[1,0,1] neg_lo:[1,0,0] neg_hi:[1,0,0]
v_exp_f32 v116, v116
v_exp_f32 v108, v108
v_exp_f32 v117, v117
v_exp_f32 v109, v109
v_exp_f32 v118, v118
v_exp_f32 v110, v110
v_exp_f32 v119, v119
v_exp_f32 v111, v111
L_stub8:
s_cbranch_execz L_wret1
v_exp_f32 v120, v120
v_exp_f32 v112, v112
v_exp_f32 v121, v121
v_exp_f32 v113, v113
v_exp_f32 v122, v122
v_exp_f32 v114, v114
v_exp_f32 v123, v123
v_exp_f32 v115, v115
v_exp_f32 v148, v148
v_exp_f32 v172, v172
v_exp_f32 v149, v149
v_exp_f32 v173, v173
v_exp_f32 v150, v150
v_exp_f32 v174, v174
v_exp_f32 v151, v151
v_exp_f32 v175, v175
v_exp_f32 v152, v152
v_exp_f32 v176, v176
v_exp_f32 v153, v153
v_exp_f32 v177, v177
v_exp_f32 v154, v154
v_exp_f32 v178, v178
v_exp_f32 v155, v155
v_exp_f32 v179, v179
buffer_load_dwordx4 v1, s[4:7], s44 offen offset:3072 sc1 lds
v_cvt_pk_bf16_f32 v140, v116, v117
v_cvt_pk_bf16_f32 v141, v118, v119
v_cvt_pk_bf16_f32 v142, v120, v121
v_cvt_pk_bf16_f32 v143, v122, v123
v_cvt_pk_bf16_f32 v144, v108, v109
v_cvt_pk_bf16_f32 v145, v110, v111
v_cvt_pk_bf16_f32 v146, v112, v113
v_cvt_pk_bf16_f32 v147, v114, v115
v_cvt_pk_bf16_f32 v164, v148, v149
v_cvt_pk_bf16_f32 v165, v150, v151
v_cvt_pk_bf16_f32 v166, v152, v153
v_cvt_pk_bf16_f32 v167, v154, v155
v_cvt_pk_bf16_f32 v168, v172, v173
v_cvt_pk_bf16_f32 v169, v174, v175
v_cvt_pk_bf16_f32 v170, v176, v177
v_cvt_pk_bf16_f32 v171, v178, v179
s_waitcnt vmcnt(2)
v_readfirstlane_b32 s38, v11
s_nop 0
s_cmp_ge_u32 s38, 8
s_cbranch_scc1 Lpe_26
s_add_u32 s36, s88, 0x80000
s_mov_b32 s37, 0
Lpoll_25:
v_mov_b32 v11, 0
buffer_atomic_add v11, v251, s[4:7], s36 offen sc0 sc1
s_add_u32 s37, s37, 1
s_waitcnt vmcnt(0)
v_readfirstlane_b32 s38, v11
s_nop 0
s_cmp_ge_u32 s38, 8
s_cbranch_scc1 Lpe_26
s_cmp_lt_u32 s37, 0x100000
s_cbranch_scc1 Lpoll_25
Lpe_26:
buffer_load_dwordx4 v[48:51], v1, s[4:7], s98 offen offset:0 sc1
v_mfma_f32_16x16x32_bf16 v[108:111], a[240:243], v[180:183], 0
v_mfma_f32_16x16x32_bf16 v[220:223], a[240:243], v[204:207], 0
v_mfma_f32_16x16x32_bf16 v[112:115], a[244:247], v[180:183], 0
s_nop 5
v_max3_f32 v240, v108, v109, v110
v_max3_f32 v241, -v108, -v109, -v110
v_mfma_f32_16x16x32_bf16 v[224:227], a[244:247], v[204:207], 0
buffer_load_dwordx4 v[124:127], v248, s[4:7], s100 offen sc1
v_max3_f32 v242, v220, v221, v222
v_max3_f32 v243, -v220, -v221, -v222
v_max3_f32 v240, v240, v111, v112
v_max3_f32 v241, v241, -v111, -v112
v_max3_f32 v240, v240, v113, v114
s_nop 1
v_max3_f32 v242, v242, v223, v224
v_max3_f32 v243, v243, -v223, -v224
v_max3_f32 v241, v241, -v113, -v114
v_max3_f32 v242, v242, v225, v226
v_max3_f32 v243, v243, -v225, -v226
v_max_f32 v240, v240, v115
v_max_f32_e64 v241, v241, -v115
v_max_f32 v242, v242, v227
buffer_load_dwordx4 v[52:55], v1, s[4:7], s98 offen offset:1024 sc1
v_max_f32_e64 v243, v243, -v227
v_permlane32_swap_b32 v240, v241
s_nop 0
v_permlane32_swap_b32 v242, v243
v_max_f32 v240, v240, v241
v_max_f32 v242, v242, v243
v_mov_b32 v246, v240
v_mov_b32 v247, v242
s_nop 0
v_permlane16_swap_b32 v240, v246
v_permlane16_swap_b32 v242, v247
buffer_load_dwordx4 v[56:59], v1, s[4:7], s98 offen offset:2048 sc1
v_max_f32 v240, v240, v246
v_max_f32 v242, v242, v247
v_mov_b32 v246, v240
v_mov_b32 v247, v242
s_nop 0
v_permlane32_swap_b32 v240, v246
v_permlane32_swap_b32 v242, v247
v_mul_f32_e64 v240, -v240, v86
v_mul_f32_e64 v241, -v246, v86
v_mul_f32_e64 v242, -v242, v88
v_mul_f32_e64 v243, -v247, v88
buffer_load_dwordx4 v[60:63], v1, s[4:7], s98 offen offset:3072 sc1
v_pk_fma_f32 v[116:117], v[108:109], v[86:87], v[240:241] op_sel:[0,0,0] op_sel_hi:[1,0,0]
v_pk_fma_f32 v[118:119], v[110:111], v[86:87], v[240:241] op_sel:[0,0,0] op_sel_hi:[1,0,0]
v_pk_fma_f32 v[120:121], v[112:113], v[86:87], v[240:241] op_sel:[0,0,0] op_sel_hi:[1,0,0]
v_pk_fma_f32 v[122:123], v[114:115], v[86:87], v[240:241] op_sel:[0,0,0] op_sel_hi:[1,0,0]
v_pk_fma_f32 v[196:197], v[220:221], v[88:89], v[242:243] op_sel:[0,0,0] op_sel_hi:[1,0,0]
v_pk_fma_f32 v[198:199], v[222:223], v[88:89], v[242:243] op_sel:[0,0,0] op_sel_hi:[1,0,0]
v_pk_fma_f32 v[200:201], v[224:225], v[88:89], v[242:243] op_sel:[0,0,0] op_sel_hi:[1,0,0]
v_pk_fma_f32 v[202:203], v[226:227], v[88:89], v[242:243] op_sel:[0,0,0] op_sel_hi:[1,0,0]
v_pk_fma_f32 v[108:109], v[108:109], v[86:87], v[240:241] op_sel:[0,0,1] op_sel_hi:[1,0,1] neg_lo:[1,0,0] neg_hi:[1,0,0]
v_pk_fma_f32 v[110:111], v[110:111], v[86:87], v[240:241] op_sel:[0,0,1] op_sel_hi:[1,0,1] neg_lo:[1,0,0] neg_hi:[1,0,0]
v_pk_fma_f32 v[112:113], v[112:113], v[86:87], v[240:241] op_sel:[0,0,1] op_sel_hi:[1,0,1] neg_lo:[1,0,0] neg_hi:[1,0,0]
v_pk_fma_f32 v[114:115], v[114:115], v[86:87], v[240:241] op_sel:[0,0,1] op_sel_hi:[1,0,1] neg_lo:[1,0,0] neg_hi:[1,0,0]
v_pk_fma_f32 v[220:221], v[220:221], v[88:89], v[242:243] op_sel:[0,0,1] op_sel_hi:[1,0,1] neg_lo:[1,0,0] neg_hi:[1,0,0]
buffer_load_dwordx4 v[64:67], v1, s[4:7], s99 offen offset:0 sc1
v_pk_fma_f32 v[222:223], v[222:223], v[88:89], v[242:243] op_sel:[0,0,1] op_sel_hi:[1,0,1] neg_lo:[1,0,0] neg_hi:[1,0,0]
v_pk_fma_f32 v[224:225], v[224:225], v[88:89], v[242:243] op_sel:[0,0,1] op_sel_hi:[1,0,1] neg_lo:[1,0,0] neg_hi:[1,0,0]
v_pk_fma_f32 v[226:227], v[226:227], v[88:89], v[242:243] op_sel:[0,0,1] op_sel_hi:[1,0,1] neg_lo:[1,0,0] neg_hi:[1,0,0]
v_exp_f32 v116, v116
v_exp_f32 v108, v108
v_exp_f32 v117, v117
v_exp_f32 v109, v109
v_exp_f32 v118, v118
buffer_load_dwordx4 v[68:71], v1, s[4:7], s99 offen offset:1024 sc1
v_exp_f32 v110, v110
v_exp_f32 v119, v119
v_exp_f32 v111, v111
v_exp_f32 v120, v120
v_exp_f32 v112, v112
v_exp_f32 v121, v121
v_exp_f32 v113, v113
buffer_load_dwordx4 v[100:103], v1, s[4:7], s99 offen offset:2048 sc1
v_exp_f32 v122, v122
v_exp_f32 v114, v114
v_exp_f32 v123, v123
v_exp_f32 v115, v115
v_exp_f32 v196, v196
v_exp_f32 v220, v220
v_exp_f32 v197, v197
buffer_load_dwordx4 v[104:107], v1, s[4:7], s99 offen offset:3072 sc1
v_exp_f32 v221, v221
v_exp_f32 v198, v198
v_exp_f32 v222, v222
v_exp_f32 v199, v199
v_exp_f32 v223, v223
v_exp_f32 v200, v200
v_exp_f32 v224, v224
buffer_store_dwordx4 a[248:251], v2, s[4:7], s73 offen offset:0 sc1
v_exp_f32 v201, v201
v_exp_f32 v225, v225
v_exp_f32 v202, v202
v_exp_f32 v226, v226
v_exp_f32 v203, v203
v_exp_f32 v227, v227
v_cvt_pk_bf16_f32 v188, v116, v117
v_cvt_pk_bf16_f32 v189, v118, v119
v_cvt_pk_bf16_f32 v190, v120, v121
v_cvt_pk_bf16_f32 v191, v122, v123
v_cvt_pk_bf16_f32 v192, v108, v109
v_cvt_pk_bf16_f32 v193, v110, v111
v_cvt_pk_bf16_f32 v194, v112, v113
v_cvt_pk_bf16_f32 v195, v114, v115
v_cvt_pk_bf16_f32 v212, v196, v197
v_cvt_pk_bf16_f32 v213, v198, v199
v_cvt_pk_bf16_f32 v214, v200, v201
v_cvt_pk_bf16_f32 v215, v202, v203
v_cvt_pk_bf16_f32 v216, v220, v221
v_cvt_pk_bf16_f32 v217, v222, v223
v_cvt_pk_bf16_f32 v218, v224, v225
v_cvt_pk_bf16_f32 v219, v226, v227
buffer_store_dwordx4 a[248:251], v2, s[4:7], s73 offen offset:1024 sc1
s_waitcnt vmcnt(10)
v_lshlrev_b32 v92, 16, v48
v_and_b32 v93, 0xffff0000, v48
v_lshlrev_b32 v94, 16, v49
v_and_b32 v95, 0xffff0000, v49
v_lshlrev_b32 v96, 16, v50
v_and_b32 v97, 0xffff0000, v50
v_lshlrev_b32 v98, 16, v51
v_and_b32 v99, 0xffff0000, v51
s_waitcnt vmcnt(9)
v_add_f32_dpp v128, v124, v124 row_ror:4 row_mask:0xf bank_mask:0xf
v_add_f32_dpp v129, v125, v125 row_ror:4 row_mask:0xf bank_mask:0xf
v_add_f32_dpp v130, v126, v126 row_ror:4 row_mask:0xf bank_mask:0xf
v_add_f32_dpp v131, v127, v127 row_ror:4 row_mask:0xf bank_mask:0xf
v_add_f32_dpp v128, v128, v128 row_ror:2 row_mask:0xf bank_mask:0xf
v_add_f32_dpp v129, v129, v129 row_ror:2 row_mask:0xf bank_mask:0xf
v_add_f32_dpp v130, v130, v130 row_ror:2 row_mask:0xf bank_mask:0xf
buffer_store_dwordx4 a[248:251], v2, s[4:7], s73 offen offset:2048 sc1
v_add_f32_dpp v131, v131, v131 row_ror:2 row_mask:0xf bank_mask:0xf
v_add_f32_dpp v128, v128, v128 row_ror:1 row_mask:0xf bank_mask:0xf
v_add_f32_dpp v129, v129, v129 row_ror:1 row_mask:0xf bank_mask:0xf
v_add_f32_dpp v130, v130, v130 row_ror:1 row_mask:0xf bank_mask:0xf
v_add_f32_dpp v131, v131, v131 row_ror:1 row_mask:0xf bank_mask:0xf
s_waitcnt vmcnt(9)
v_dot2c_f32_bf16 v92, v52, v249
v_dot2c_f32_bf16 v93, v52, v250
v_dot2c_f32_bf16 v94, v53, v249
v_dot2c_f32_bf16 v95, v53, v250
v_dot2c_f32_bf16 v96, v54, v249
v_dot2c_f32_bf16 v97, v54, v250
v_dot2c_f32_bf16 v98, v55, v249
v_dot2c_f32_bf16 v99, v55, v250
v_fma_f32 v135, v129, v130, v131
s_waitcnt vmcnt(8)
v_dot2c_f32_bf16 v92, v56, v249
v_dot2c_f32_bf16 v93, v56, v250
v_dot2c_f32_bf16 v94, v57, v249
v_dot2c_f32_bf16 v95, v57, v250
v_dot2c_f32_bf16 v96, v58, v249
v_dot2c_f32_bf16 v97, v58, v250
v_dot2c_f32_bf16 v98, v59, v249
v_dot2c_f32_bf16 v99, v59, v250
buffer_store_dwordx4 a[248:251], v2, s[4:7], s73 offen offset:3072 sc1
s_waitcnt vmcnt(8)
v_dot2c_f32_bf16 v92, v60, v249
v_dot2c_f32_bf16 v93, v60, v250
v_dot2c_f32_bf16 v94, v61, v249
v_dot2c_f32_bf16 v95, v61, v250
v_dot2c_f32_bf16 v96, v62, v249
v_dot2c_f32_bf16 v97, v62, v250
v_dot2c_f32_bf16 v98, v63, v249
v_dot2c_f32_bf16 v99, v63, v250
s_waitcnt vmcnt(7)
v_dot2c_f32_bf16 v92, v64, v249
v_dot2c_f32_bf16 v93, v64, v250
v_dot2c_f32_bf16 v94, v65, v249
v_dot2c_f32_bf16 v95, v65, v250
v_dot2c_f32_bf16 v96, v66, v249
v_dot2c_f32_bf16 v97, v66, v250
v_dot2c_f32_bf16 v98, v67, v249
v_dot2c_f32_bf16 v99, v67, v250
s_waitcnt vmcnt(6)
v_dot2c_f32_bf16 v92, v68, v249
v_dot2c_f32_bf16 v93, v68, v250
v_dot2c_f32_bf16 v94, v69, v249
v_dot2c_f32_bf16 v95, v69, v250
v_dot2c_f32_bf16 v96, v70, v249
v_dot2c_f32_bf16 v97, v70, v250
v_dot2c_f32_bf16 v98, v71, v249
v_dot2c_f32_bf16 v99, v71, v250
s_waitcnt vmcnt(5)
v_dot2c_f32_bf16 v92, v100, v249
v_dot2c_f32_bf16 v93, v100, v250
v_dot2c_f32_bf16 v94, v101, v249
v_dot2c_f32_bf16 v95, v101, v250
v_dot2c_f32_bf16 v96, v102, v249
v_dot2c_f32_bf16 v97, v102, v250
v_dot2c_f32_bf16 v98, v103, v249
v_dot2c_f32_bf16 v99, v103, v250
s_waitcnt vmcnt(4)
v_dot2c_f32_bf16 v92, v104, v249
v_dot2c_f32_bf16 v93, v104, v250
v_dot2c_f32_bf16 v94, v105, v249
v_dot2c_f32_bf16 v95, v105, v250
v_dot2c_f32_bf16 v96, v106, v249
v_dot2c_f32_bf16 v97, v106, v250
v_dot2c_f32_bf16 v98, v107, v249
v_dot2c_f32_bf16 v99, v107, v250
v_fma_f32 v132, v92, v93, v94
v_fma_f32 v133, v95, v96, v97
s_nop 0
v_fma_f32 v134, v98, v99, v128
v_fma_f32 v132, v132, v133, v134
v_cmp_u_f32 vcc, v132, v135
s_cbranch_vccnz L_kvredo1
L_kvback1:
v_cvt_pk_bf16_f32 v128, v128, v129
v_cvt_pk_bf16_f32 v129, v130, v131
v_cvt_pk_bf16_f32 v92, v92, v93
v_cndmask_b32 v128, 0, v128, s[56:57]
v_cndmask_b32 v129, 0, v129, s[56:57]
v_cvt_pk_bf16_f32 v93, v94, v95
v_cvt_pk_bf16_f32 v94, v96, v97
v_cvt_pk_bf16_f32 v95, v98, v99
v_cndmask_b32 v128, v128, v16, s[58:59]
v_cndmask_b32 v129, v129, v16, s[58:59]
ds_write_b64 v252, v[92:93] offset:0
ds_write_b64 v252, v[94:95] offset:1024
ds_write_b64 v252, v[128:129] offset:2048
s_waitcnt lgkmcnt(0)
s_barrier
ds_read_b128 a[8:11], v1 offset:2048
ds_read_b128 a[20:23], v1 offset:5120
ds_read_b128 a[0:3], v1 offset:0
ds_read_b128 a[12:15], v1 offset:3072
ds_read_b128 a[4:7], v1 offset:1024
ds_read_b128 a[16:19], v1 offset:4096
s_waitcnt lgkmcnt(5)
v_mfma_f32_16x16x32_bf16 v[116:119], a[8:11], v[212:215], 0
s_waitcnt lgkmcnt(4)
v_mfma_f32_16x16x32_bf16 v[120:123], a[20:23], v[216:219], 0
s_waitcnt lgkmcnt(3)
v_mfma_f32_16x16x32_bf16 v[204:207], a[0:3], v[212:215], 0
s_nop 3
v_rcp_f32 v118, v117
s_waitcnt lgkmcnt(2)
v_mfma_f32_16x16x32_bf16 v[220:223], a[12:15], v[216:219], 0
v_rcp_f32 v119, v121
v_mul_f32 v116, v116, v118
v_fmac_f32 v116, v120, v119
v_mfma_f32_16x16x32_bf16 v[100:103], a[8:11], v[164:167], 0
v_add_f32 v116, 0x358637bd, v116
v_rcp_f32 v116, v116
s_waitcnt lgkmcnt(1)
v_mfma_f32_16x16x32_bf16 v[208:211], a[4:7], v[212:215], 0
v_mul_f32 v118, v118, v116
v_mul_f32 v119, v119, v116
v_mfma_f32_16x16x32_bf16 v[104:107], a[20:23], v[168:171], 0
v_mul_f32 v204, v204, v118
v_mul_f32 v205, v205, v118
s_waitcnt lgkmcnt(0)
v_mfma_f32_16x16x32_bf16 v[224:227], a[16:19], v[216:219], 0
v_mul_f32 v206, v206, v118
v_mul_f32 v207, v207, v118
v_fmac_f32 v204, v220, v119
v_fmac_f32 v205, v221, v119
v_rcp_f32 v102, v101
v_mul_f32 v208, v208, v118
v_mul_f32 v209, v209, v118
v_mul_f32 v210, v210, v118
v_mul_f32 v211, v211, v118
v_fmac_f32 v206, v222, v119
v_fmac_f32 v207, v223, v119
v_cvt_pk_bf16_f32 v204, v204, v205
v_rcp_f32 v103, v105
v_fmac_f32 v208, v224, v119
v_fmac_f32 v209, v225, v119
v_fmac_f32 v210, v226, v119
v_fmac_f32 v211, v227, v119
v_cvt_pk_bf16_f32 v205, v206, v207
v_cvt_pk_bf16_f32 v206, v208, v209
v_cvt_pk_bf16_f32 v207, v210, v211
v_mul_f32 v100, v100, v102
v_mfma_f32_16x16x32_bf16 v[156:159], a[0:3], v[164:167], 0
buffer_store_dwordx4 v[204:207], v2, s[4:7], s72 offen offset:3072 sc1
v_fmac_f32 v100, v104, v103
v_mfma_f32_16x16x32_bf16 v[172:175], a[12:15], v[168:171], 0
v_add_f32 v100, 0x358637bd, v100
v_rcp_f32 v100, v100
buffer_atomic_add v12, v10, s[4:7], s74 offen sc1
v_mfma_f32_16x16x32_bf16 v[108:111], a[8:11], v[188:191], 0
v_mul_f32 v102, v102, v100
v_mul_f32 v103, v103, v100
v_mfma_f32_16x16x32_bf16 v[160:163], a[4:7], v[164:167], 0
v_mul_f32 v156, v156, v102
v_mul_f32 v157, v157, v102
v_mfma_f32_16x16x32_bf16 v[112:115], a[20:23], v[192:195], 0
v_mul_f32 v158, v158, v102
v_mul_f32 v159, v159, v102
v_mfma_f32_16x16x32_bf16 v[176:179], a[16:19], v[168:171], 0
v_fmac_f32 v156, v172, v103
v_fmac_f32 v157, v173, v103
v_rcp_f32 v110, v109
v_mul_f32 v160, v160, v102
v_mul_f32 v161, v161, v102
v_mul_f32 v162, v162, v102
v_mul_f32 v163, v163, v102
v_fmac_f32 v158, v174, v103
v_fmac_f32 v159, v175, v103
v_cvt_pk_bf16_f32 v156, v156, v157
v_rcp_f32 v111, v113
v_fmac_f32 v160, v176, v103
v_fmac_f32 v161, v177, v103
v_fmac_f32 v162, v178, v103
v_fmac_f32 v163, v179, v103
v_cvt_pk_bf16_f32 v157, v158, v159
v_cvt_pk_bf16_f32 v158, v160, v161
v_cvt_pk_bf16_f32 v159, v162, v163
v_mul_f32 v108, v108, v110
v_mfma_f32_16x16x32_bf16 v[180:183], a[0:3], v[188:191], 0
buffer_store_dwordx4 v[156:159], v2, s[4:7], s72 offen offset:1024 sc1
v_fmac_f32 v108, v112, v111
v_mfma_f32_16x16x32_bf16 v[196:199], a[12:15], v[192:195], 0
v_add_f32 v108, 0x358637bd, v108
v_rcp_f32 v108, v108
v_mfma_f32_16x16x32_bf16 v[92:95], a[8:11], v[140:143], 0
v_mul_f32 v110, v110, v108
v_mul_f32 v111, v111, v108
v_mfma_f32_16x16x32_bf16 v[184:187], a[4:7], v[188:191], 0
v_mul_f32 v180, v180, v110
v_mul_f32 v181, v181, v110
v_mfma_f32_16x16x32_bf16 v[96:99], a[20:23], v[144:147], 0
v_mul_f32 v182, v182, v110
v_mul_f32 v183, v183, v110
v_mfma_f32_16x16x32_bf16 v[200:203], a[16:19], v[192:195], 0
v_fmac_f32 v180, v196, v111
v_fmac_f32 v181, v197, v111
v_rcp_f32 v94, v93
v_mul_f32 v184, v184, v110
v_mul_f32 v185, v185, v110
v_mul_f32 v186, v186, v110
v_mul_f32 v187, v187, v110
v_fmac_f32 v182, v198, v111
v_fmac_f32 v183, v199, v111
v_cvt_pk_bf16_f32 v180, v180, v181
v_rcp_f32 v95, v97
v_fmac_f32 v184, v200, v111
v_fmac_f32 v185, v201, v111
v_fmac_f32 v186, v202, v111
v_fmac_f32 v187, v203, v111
v_cvt_pk_bf16_f32 v181, v182, v183
v_cvt_pk_bf16_f32 v182, v184, v185
v_cvt_pk_bf16_f32 v183, v186, v187
v_mul_f32 v92, v92, v94
v_mfma_f32_16x16x32_bf16 v[132:135], a[0:3], v[140:143], 0
buffer_store_dwordx4 v[180:183], v2, s[4:7], s72 offen offset:2048 sc1
v_fmac_f32 v92, v96, v95
v_mfma_f32_16x16x32_bf16 v[148:151], a[12:15], v[144:147], 0
v_add_f32 v92, 0x358637bd, v92
v_rcp_f32 v92, v92
v_mfma_f32_16x16x32_bf16 v[136:139], a[4:7], v[140:143], 0
v_mul_f32 v94, v94, v92
v_mul_f32 v95, v95, v92
v_mfma_f32_16x16x32_bf16 v[152:155], a[16:19], v[144:147], 0
v_mul_f32 v132, v132, v94
v_mul_f32 v133, v133, v94
v_mul_f32 v134, v134, v94
v_mul_f32 v135, v135, v94
v_fmac_f32 v132, v148, v95
v_fmac_f32 v133, v149, v95
v_mul_f32 v136, v136, v94
v_mul_f32 v137, v137, v94
v_mul_f32 v138, v138, v94
v_mul_f32 v139, v139, v94
v_fmac_f32 v134, v150, v95
v_fmac_f32 v135, v151, v95
v_cvt_pk_bf16_f32 v132, v132, v133
v_fmac_f32 v136, v152, v95
v_fmac_f32 v137, v153, v95
v_fmac_f32 v138, v154, v95
v_fmac_f32 v139, v155, v95
v_cvt_pk_bf16_f32 v133, v134, v135
v_cvt_pk_bf16_f32 v134, v136, v137
v_cvt_pk_bf16_f32 v135, v138, v139
buffer_store_dwordx4 v[132:135], v2, s[4:7], s72 offen offset:0 sc1
s_add_u32 s92, s71, 0x10000
s_add_u32 s40, s4, 0xc00000
s_addc_u32 s41, s5, 0
v_add_u32 v5, 32768, v1
v_add_u32 v6, 98304, v1
s_mov_b32 s35, s9
v_lshlrev_b32 v132, 16, v32
v_and_b32 v133, 0xffff0000, v32
v_lshlrev_b32 v134, 16, v33
v_and_b32 v135, 0xffff0000, v33
v_lshlrev_b32 v136, 16, v34
v_and_b32 v137, 0xffff0000, v34
v_lshlrev_b32 v138, 16, v35
v_and_b32 v139, 0xffff0000, v35
v_lshlrev_b32 v140, 16, v36
v_and_b32 v141, 0xffff0000, v36
v_lshlrev_b32 v142, 16, v37
v_and_b32 v143, 0xffff0000, v37
v_lshlrev_b32 v144, 16, v38
v_and_b32 v145, 0xffff0000, v38
v_lshlrev_b32 v146, 16, v39
v_and_b32 v147, 0xffff0000, v39
v_lshlrev_b32 v148, 16, v40
v_and_b32 v149, 0xffff0000, v40
v_lshlrev_b32 v150, 16, v41
v_and_b32 v151, 0xffff0000, v41
v_lshlrev_b32 v152, 16, v42
v_and_b32 v153, 0xffff0000, v42
v_lshlrev_b32 v154, 16, v43
v_and_b32 v155, 0xffff0000, v43
v_lshlrev_b32 v156, 16, v44
v_and_b32 v157, 0xffff0000, v44
v_lshlrev_b32 v158, 16, v45
v_and_b32 v159, 0xffff0000, v45
v_lshlrev_b32 v160, 16, v46
v_and_b32 v161, 0xffff0000, v46
v_lshlrev_b32 v162, 16, v47
v_and_b32 v163, 0xffff0000, v47
s_mov_b32 s95, -1
s_mov_b64 exec, 0
s_cmp_eq_u32 s28, 3
s_cbranch_scc1 L_stub9
s_cmp_eq_u32 s28, 2
s_cbranch_scc1 L_stub12
s_cmp_eq_u32 s28, 0
s_cbranch_scc1 L_stub13
L_wret3:
s_mov_b64 exec, -1
s_cmp_lg_u32 s28, 1
s_cbranch_scc1 Lpo_29
s_add_u32 s36, s11, 0x10080
s_mov_b32 s37, 0
v_mov_b32 v11, 0
buffer_atomic_add v11, v251, s[4:7], s36 offen sc0 sc1
s_sleep 4
Lpoll_27:
v_mov_b32 v234, 0
buffer_atomic_add v234, v251, s[4:7], s36 offen sc0 sc1
s_waitcnt vmcnt(1)
v_readfirstlane_b32 s38, v11
s_nop 0
s_cmp_ge_u32 s38, 32
s_cbranch_scc1 Lpe_28
v_mov_b32 v11, 0
buffer_atomic_add v11, v251, s[4:7], s36 offen sc0 sc1
s_waitcnt vmcnt(1)
v_readfirstlane_b32 s38, v234
s_nop 0
s_cmp_ge_u32 s38, 32
s_cbranch_scc1 Lpe_28
s_add_u32 s37, s37, 1
s_cmp_lt_u32 s37, 0x80000
s_cbranch_scc1 Lpoll_27
s_waitcnt vmcnt(0)
Lpo_29:
s_waitcnt vmcnt(0)
Lpe_28:
s_barrier
L_k2go1:
buffer_load_dwordx4 a[0:3], v4, s[40:43], s35 offen offset:0 sc1
buffer_load_dwordx4 a[4:7], v4, s[40:43], s35 offen offset:1024 sc1
s_xor_b32 s35, s9, 4096
buffer_load_dwordx4 a[8:11], v4, s[40:43], s35 offen offset:0 sc1
buffer_load_dwordx4 a[12:15], v4, s[40:43], s35 offen offset:1024 sc1
s_xor_b32 s35, s9, 16384
buffer_load_dwordx4 a[16:19], v4, s[40:43], s35 offen offset:0 sc1
buffer_load_dwordx4 a[20:23], v4, s[40:43], s35 offen offset:1024 sc1
s_xor_b32 s35, s9, 20480
buffer_load_dwordx4 a[24:27], v4, s[40:43], s35 offen offset:0 sc1
buffer_load_dwordx4 a[28:31], v4, s[40:43], s35 offen offset:1024 sc1
s_xor_b32 s35, s9, 32768
buffer_load_dwordx4 a[32:35], v4, s[40:43], s35 offen offset:0 sc1
buffer_load_dwordx4 a[36:39], v4, s[40:43], s35 offen offset:1024 sc1
s_xor_b32 s35, s9, 36864
buffer_load_dwordx4 a[40:43], v4, s[40:43], s35 offen offset:0 sc1
buffer_load_dwordx4 a[44:47], v4, s[40:43], s35 offen offset:1024 sc1
s_xor_b32 s35, s9, 49152
ds_read_b128 a[96:99], v5 offset:0
ds_read_b128 a[100:103], v5 offset:1024
ds_read_b128 a[104:107], v5 offset:2048
ds_read_b128 a[108:111], v5 offset:3072
ds_read_b128 a[112:115], v5 offset:4096
ds_read_b128 a[116:119], v5 offset:5120
ds_read_b128 a[120:123], v5 offset:6144
ds_read_b128 a[124:127], v5 offset:7168
s_waitcnt vmcnt(10) lgkmcnt(4)
v_mfma_f32_16x16x32_bf16 v[132:135], a[96:99], a[0:3], v[132:135]
ds_read_b128 a[128:131], v5 offset:8192
v_mfma_f32_16x16x32_bf16 v[148:151], a[96:99], a[4:7], v[148:151]
ds_read_b128 a[132:135], v5 offset:9216
v_mfma_f32_16x16x32_bf16 v[152:155], a[100:103], a[4:7], v[152:155]
buffer_load_dwordx4 a[48:51], v4, s[40:43], s35 offen offset:0 sc1
v_mfma_f32_16x16x32_bf16 v[136:139], a[100:103], a[0:3], v[136:139]
ds_read_b128 a[136:139], v5 offset:10240
v_mfma_f32_16x16x32_bf16 v[140:143], a[104:107], a[0:3], v[140:143]
ds_read_b128 a[140:143], v5 offset:11264
v_mfma_f32_16x16x32_bf16 v[156:159], a[104:107], a[4:7], v[156:159]
v_mfma_f32_16x16x32_bf16 v[160:163], a[108:111], a[4:7], v[160:163]
buffer_load_dwordx4 a[52:55], v4, s[40:43], s35 offen offset:1024 sc1
s_xor_b32 s35, s9, 53248
v_mfma_f32_16x16x32_bf16 v[144:147], a[108:111], a[0:3], v[144:147]
s_waitcnt vmcnt(10) lgkmcnt(4)
v_mfma_f32_16x16x32_bf16 v[132:135], a[112:115], a[8:11], v[132:135]
ds_read_b128 a[96:99], v5 offset:12288
v_mfma_f32_16x16x32_bf16 v[148:151], a[112:115], a[12:15], v[148:151]
ds_read_b128 a[100:103], v5 offset:13312
v_mfma_f32_16x16x32_bf16 v[152:155], a[116:119], a[12:15], v[152:155]
buffer_load_dwordx4 a[0:3], v4, s[40:43], s35 offen offset:0 sc1
v_mfma_f32_16x16x32_bf16 v[136:139], a[116:119], a[8:11], v[136:139]
ds_read_b128 a[104:107], v5 offset:14336
v_mfma_f32_16x16x32_bf16 v[140:143], a[120:123], a[8:11], v[140:143]
ds_read_b128 a[108:111], v5 offset:15360
v_mfma_f32_16x16x32_bf16 v[156:159], a[120:123], a[12:15], v[156:159]
v_mfma_f32_16x16x32_bf16 v[160:163], a[124:127], a[12:15], v[160:163]
buffer_load_dwordx4 a[4:7], v4, s[40:43], s35 offen offset:1024 sc1
s_xor_b32 s35, s9, 65536
v_mfma_f32_16x16x32_bf16 v[144:147], a[124:127], a[8:11], v[144:147]
s_waitcnt vmcnt(10) lgkmcnt(4)
v_mfma_f32_16x16x32_bf16 v[132:135], a[128:131], a[16:19], v[132:135]
ds_read_b128 a[112:115], v5 offset:16384
v_mfma_f32_16x16x32_bf16 v[148:151], a[128:131], a[20:23], v[148:151]
ds_read_b128 a[116:119], v5 offset:17408
v_mfma_f32_16x16x32_bf16 v[152:155], a[132:135], a[20:23], v[152:155]
buffer_load_dwordx4 a[8:11], v4, s[40:43], s35 offen offset:0 sc1
v_mfma_f32_16x16x32_bf16 v[136:139], a[132:135], a[16:19], v[136:139]
ds_read_b128 a[120:123], v5 offset:18432
v_mfma_f32_16x16x32_bf16 v[140:143], a[136:139], a[16:19], v[140:143]
ds_read_b128 a[124:127], v5 offset:19456
v_mfma_f32_16x16x32_bf16 v[156:159], a[136:139], a[20:23], v[156:159]
v_mfma_f32_16x16x32_bf16 v[160:163], a[140:143], a[20:23], v[160:163]
buffer_load_dwordx4 a[12:15], v4, s[40:43], s35 offen offset:1024 sc1
s_xor_b32 s35, s9, 69632
v_mfma_f32_16x16x32_bf16 v[144:147], a[140:143], a[16:19], v[144:147]
s_waitcnt vmcnt(10) lgkmcnt(4)
v_mfma_f32_16x16x32_bf16 v[132:135], a[96:99], a[24:27], v[132:135]
ds_read_b128 a[128:131], v5 offset:20480
v_mfma_f32_16x16x32_bf16 v[148:151], a[96:99], a[28:31], v[148:151]
ds_read_b128 a[132:135], v5 offset:21504
v_mfma_f32_16x16x32_bf16 v[152:155], a[100:103], a[28:31], v[152:155]
buffer_load_dwordx4 a[16:19], v4, s[40:43], s35 offen offset:0 sc1
v_mfma_f32_16x16x32_bf16 v[136:139], a[100:103], a[24:27], v[136:139]
ds_read_b128 a[136:139], v5 offset:22528
v_mfma_f32_16x16x32_bf16 v[140:143], a[104:107], a[24:27], v[140:143]
ds_read_b128 a[140:143], v5 offset:23552
v_mfma_f32_16x16x32_bf16 v[156:159], a[104:107], a[28:31], v[156:159]
v_mfma_f32_16x16x32_bf16 v[160:163], a[108:111], a[28:31], v[160:163]
buffer_load_dwordx4 a[20:23], v4, s[40:43], s35 offen offset:1024 sc1
s_xor_b32 s35, s9, 81920
v_mfma_f32_16x16x32_bf16 v[144:147], a[108:111], a[24:27], v[144:147]
s_waitcnt vmcnt(10) lgkmcnt(4)
v_mfma_f32_16x16x32_bf16 v[132:135], a[112:115], a[32:35], v[132:135]
ds_read_b128 a[96:99], v5 offset:24576
v_mfma_f32_16x16x32_bf16 v[148:151], a[112:115], a[36:39], v[148:151]
ds_read_b128 a[100:103], v5 offset:25600
v_mfma_f32_16x16x32_bf16 v[152:155], a[116:119], a[36:39], v[152:155]
buffer_load_dwordx4 a[24:27], v4, s[40:43], s35 offen offset:0 sc1
v_mfma_f32_16x16x32_bf16 v[136:139], a[116:119], a[32:35], v[136:139]
ds_read_b128 a[104:107], v5 offset:26624
v_mfma_f32_16x16x32_bf16 v[140:143], a[120:123], a[32:35], v[140:143]
ds_read_b128 a[108:111], v5 offset:27648
v_mfma_f32_16x16x32_bf16 v[156:159], a[120:123], a[36:39], v[156:159]
v_mfma_f32_16x16x32_bf16 v[160:163], a[124:127], a[36:39], v[160:163]
buffer_load_dwordx4 a[28:31], v4, s[40:43], s35 offen offset:1024 sc1
s_xor_b32 s35, s9, 86016
v_mfma_f32_16x16x32_bf16 v[144:147], a[124:127], a[32:35], v[144:147]
s_waitcnt vmcnt(10) lgkmcnt(4)
v_mfma_f32_16x16x32_bf16 v[132:135], a[128:131], a[40:43], v[132:135]
ds_read_b128 a[112:115], v5 offset:28672
v_mfma_f32_16x16x32_bf16 v[148:151], a[128:131], a[44:47], v[148:151]
ds_read_b128 a[116:119], v5 offset:29696
v_mfma_f32_16x16x32_bf16 v[152:155], a[132:135], a[44:47], v[152:155]
buffer_load_dwordx4 a[32:35], v4, s[40:43], s35 offen offset:0 sc1
v_mfma_f32_16x16x32_bf16 v[136:139], a[132:135], a[40:43], v[136:139]
ds_read_b128 a[120:123], v5 offset:30720
v_mfma_f32_16x16x32_bf16 v[140:143], a[136:139], a[40:43], v[140:143]
ds_read_b128 a[124:127], v5 offset:31744
v_mfma_f32_16x16x32_bf16 v[156:159], a[136:139], a[44:47], v[156:159]
v_mfma_f32_16x16x32_bf16 v[160:163], a[140:143], a[44:47], v[160:163]
buffer_load_dwordx4 a[36:39], v4, s[40:43], s35 offen offset:1024 sc1
s_xor_b32 s35, s9, 98304
v_mfma_f32_16x16x32_bf16 v[144:147], a[140:143], a[40:43], v[144:147]
s_waitcnt vmcnt(10) lgkmcnt(4)
v_mfma_f32_16x16x32_bf16 v[132:135], a[96:99], a[48:51], v[132:135]
ds_read_b128 a[128:131], v5 offset:32768
v_mfma_f32_16x16x32_bf16 v[148:151], a[96:99], a[52:55], v[148:151]
ds_read_b128 a[132:135], v5 offset:33792
v_mfma_f32_16x16x32_bf16 v[152:155], a[100:103], a[52:55], v[152:155]
buffer_load_dwordx4 a[40:43], v4, s[40:43], s35 offen offset:0 sc1
v_mfma_f32_16x16x32_bf16 v[136:139], a[100:103], a[48:51], v[136:139]
ds_read_b128 a[136:139], v5 offset:34816
v_mfma_f32_16x16x32_bf16 v[140:143], a[104:107], a[48:51], v[140:143]
ds_read_b128 a[140:143], v5 offset:35840
v_mfma_f32_16x16x32_bf16 v[156:159], a[104:107], a[52:55], v[156:159]
v_mfma_f32_16x16x32_bf16 v[160:163], a[108:111], a[52:55], v[160:163]
buffer_load_dwordx4 a[44:47], v4, s[40:43], s35 offen offset:1024 sc1
s_xor_b32 s35, s9, 102400
v_mfma_f32_16x16x32_bf16 v[144:147], a[108:111], a[48:51], v[144:147]
s_waitcnt vmcnt(10) lgkmcnt(4)
v_mfma_f32_16x16x32_bf16 v[132:135], a[112:115], a[0:3], v[132:135]
ds_read_b128 a[96:99], v5 offset:36864
v_mfma_f32_16x16x32_bf16 v[148:151], a[112:115], a[4:7], v[148:151]
ds_read_b128 a[100:103], v5 offset:37888
v_mfma_f32_16x16x32_bf16 v[152:155], a[116:119], a[4:7], v[152:155]
buffer_load_dwordx4 a[48:51], v4, s[40:43], s35 offen offset:0 sc1
v_mfma_f32_16x16x32_bf16 v[136:139], a[116:119], a[0:3], v[136:139]
ds_read_b128 a[104:107], v5 offset:38912
v_mfma_f32_16x16x32_bf16 v[140:143], a[120:123], a[0:3], v[140:143]
ds_read_b128 a[108:111], v5 offset:39936
v_mfma_f32_16x16x32_bf16 v[156:159], a[120:123], a[4:7], v[156:159]
v_mfma_f32_16x16x32_bf16 v[160:163], a[124:127], a[4:7], v[160:163]
buffer_load_dwordx4 a[52:55], v4, s[40:43], s35 offen offset:1024 sc1
s_xor_b32 s35, s9, 114688
v_mfma_f32_16x16x32_bf16 v[144:147], a[124:127], a[0:3], v[144:147]
s_waitcnt vmcnt(10) lgkmcnt(4)
v_mfma_f32_16x16x32_bf16 v[132:135], a[128:131], a[8:11], v[132:135]
ds_read_b128 a[112:115], v5 offset:40960
v_mfma_f32_16x16x32_bf16 v[148:151], a[128:131], a[12:15], v[148:151]
ds_read_b128 a[116:119], v5 offset:41984
L_stub9:
s_cbranch_execz L_wret3
v_mfma_f32_16x16x32_bf16 v[152:155], a[132:135], a[12:15], v[152:155]
buffer_load_dwordx4 a[0:3], v4, s[40:43], s35 offen offset:0 sc1
v_mfma_f32_16x16x32_bf16 v[136:139], a[132:135], a[8:11], v[136:139]
ds_read_b128 a[120:123], v5 offset:43008
v_mfma_f32_16x16x32_bf16 v[140:143], a[136:139], a[8:11], v[140:143]
ds_read_b128 a[124:127], v5 offset:44032
v_mfma_f32_16x16x32_bf16 v[156:159], a[136:139], a[12:15], v[156:159]
v_mfma_f32_16x16x32_bf16 v[160:163], a[140:143], a[12:15], v[160:163]
buffer_load_dwordx4 a[4:7], v4, s[40:43], s35 offen offset:1024 sc1
s_xor_b32 s35, s9, 118784
v_mfma_f32_16x16x32_bf16 v[144:147], a[140:143], a[8:11], v[144:147]
s_waitcnt vmcnt(10) lgkmcnt(4)
v_mfma_f32_16x16x32_bf16 v[132:135], a[96:99], a[16:19], v[132:135]
ds_read_b128 a[128:131], v5 offset:45056
v_mfma_f32_16x16x32_bf16 v[148:151], a[96:99], a[20:23], v[148:151]
ds_read_b128 a[132:135], v5 offset:46080
v_mfma_f32_16x16x32_bf16 v[152:155], a[100:103], a[20:23], v[152:155]
buffer_load_dwordx4 a[8:11], v4, s[40:43], s35 offen offset:0 sc1
v_mfma_f32_16x16x32_bf16 v[136:139], a[100:103], a[16:19], v[136:139]
ds_read_b128 a[136:139], v5 offset:47104
v_mfma_f32_16x16x32_bf16 v[140:143], a[104:107], a[16:19], v[140:143]
ds_read_b128 a[140:143], v5 offset:48128
v_mfma_f32_16x16x32_bf16 v[156:159], a[104:107], a[20:23], v[156:159]
v_mfma_f32_16x16x32_bf16 v[160:163], a[108:111], a[20:23], v[160:163]
buffer_load_dwordx4 a[12:15], v4, s[40:43], s35 offen offset:1024 sc1
s_xor_b32 s35, s9, 524288
v_mfma_f32_16x16x32_bf16 v[144:147], a[108:111], a[16:19], v[144:147]
s_waitcnt vmcnt(10) lgkmcnt(4)
v_mfma_f32_16x16x32_bf16 v[132:135], a[112:115], a[24:27], v[132:135]
ds_read_b128 a[96:99], v5 offset:49152
v_mfma_f32_16x16x32_bf16 v[148:151], a[112:115], a[28:31], v[148:151]
ds_read_b128 a[100:103], v5 offset:50176
v_mfma_f32_16x16x32_bf16 v[152:155], a[116:119], a[28:31], v[152:155]
buffer_load_dwordx4 a[16:19], v4, s[40:43], s35 offen offset:0 sc1
v_mfma_f32_16x16x32_bf16 v[136:139], a[116:119], a[24:27], v[136:139]
ds_read_b128 a[104:107], v5 offset:51200
v_mfma_f32_16x16x32_bf16 v[140:143], a[120:123], a[24:27], v[140:143]
ds_read_b128 a[108:111], v5 offset:52224
v_mfma_f32_16x16x32_bf16 v[156:159], a[120:123], a[28:31], v[156:159]
v_mfma_f32_16x16x32_bf16 v[160:163], a[124:127], a[28:31], v[160:163]
buffer_load_dwordx4 a[20:23], v4, s[40:43], s35 offen offset:1024 sc1
s_xor_b32 s35, s9, 528384
v_mfma_f32_16x16x32_bf16 v[144:147], a[124:127], a[24:27], v[144:147]
s_waitcnt vmcnt(10) lgkmcnt(4)
v_mfma_f32_16x16x32_bf16 v[132:135], a[128:131], a[32:35], v[132:135]
ds_read_b128 a[112:115], v5 offset:53248
v_mfma_f32_16x16x32_bf16 v[148:151], a[128:131], a[36:39], v[148:151]
ds_read_b128 a[116:119], v5 offset:54272
v_mfma_f32_16x16x32_bf16 v[152:155], a[132:135], a[36:39], v[152:155]
buffer_load_dwordx4 a[24:27], v4, s[40:43], s35 offen offset:0 sc1
v_mfma_f32_16x16x32_bf16 v[136:139], a[132:135], a[32:35], v[136:139]
ds_read_b128 a[120:123], v5 offset:55296
v_mfma_f32_16x16x32_bf16 v[140:143], a[136:139], a[32:35], v[140:143]
ds_read_b128 a[124:127], v5 offset:56320
v_mfma_f32_16x16x32_bf16 v[156:159], a[136:139], a[36:39], v[156:159]
v_mfma_f32_16x16x32_bf16 v[160:163], a[140:143], a[36:39], v[160:163]
buffer_load_dwordx4 a[28:31], v4, s[40:43], s35 offen offset:1024 sc1
s_xor_b32 s35, s9, 540672
v_mfma_f32_16x16x32_bf16 v[144:147], a[140:143], a[32:35], v[144:147]
s_waitcnt vmcnt(10) lgkmcnt(4)
v_mfma_f32_16x16x32_bf16 v[132:135], a[96:99], a[40:43], v[132:135]
ds_read_b128 a[128:131], v5 offset:57344
v_mfma_f32_16x16x32_bf16 v[148:151], a[96:99], a[44:47], v[148:151]
ds_read_b128 a[132:135], v5 offset:58368
v_mfma_f32_16x16x32_bf16 v[152:155], a[100:103], a[44:47], v[152:155]
buffer_load_dwordx4 a[32:35], v4, s[40:43], s35 offen offset:0 sc1
v_mfma_f32_16x16x32_bf16 v[136:139], a[100:103], a[40:43], v[136:139]
ds_read_b128 a[136:139], v5 offset:59392
v_mfma_f32_16x16x32_bf16 v[140:143], a[104:107], a[40:43], v[140:143]
ds_read_b128 a[140:143], v5 offset:60416
v_mfma_f32_16x16x32_bf16 v[156:159], a[104:107], a[44:47], v[156:159]
v_mfma_f32_16x16x32_bf16 v[160:163], a[108:111], a[44:47], v[160:163]
buffer_load_dwordx4 a[36:39], v4, s[40:43], s35 offen offset:1024 sc1
s_xor_b32 s35, s9, 544768
v_mfma_f32_16x16x32_bf16 v[144:147], a[108:111], a[40:43], v[144:147]
s_waitcnt vmcnt(10) lgkmcnt(4)
v_mfma_f32_16x16x32_bf16 v[132:135], a[112:115], a[48:51], v[132:135]
ds_read_b128 a[96:99], v5 offset:61440
v_mfma_f32_16x16x32_bf16 v[148:151], a[112:115], a[52:55], v[148:151]
ds_read_b128 a[100:103], v5 offset:62464
v_mfma_f32_16x16x32_bf16 v[152:155], a[116:119], a[52:55], v[152:155]
buffer_load_dwordx4 a[40:43], v4, s[40:43], s35 offen offset:0 sc1
v_mfma_f32_16x16x32_bf16 v[136:139], a[116:119], a[48:51], v[136:139]
ds_read_b128 a[104:107], v5 offset:63488
v_mfma_f32_16x16x32_bf16 v[140:143], a[120:123], a[48:51], v[140:143]
ds_read_b128 a[108:111], v5 offset:64512
v_mfma_f32_16x16x32_bf16 v[156:159], a[120:123], a[52:55], v[156:159]
v_mfma_f32_16x16x32_bf16 v[160:163], a[124:127], a[52:55], v[160:163]
buffer_load_dwordx4 a[44:47], v4, s[40:43], s35 offen offset:1024 sc1
s_xor_b32 s35, s9, 557056
v_mfma_f32_16x16x32_bf16 v[144:147], a[124:127], a[48:51], v[144:147]
s_waitcnt vmcnt(10) lgkmcnt(4)
v_mfma_f32_16x16x32_bf16 v[132:135], a[128:131], a[0:3], v[132:135]
ds_read_b128 a[112:115], v6 offset:0
v_mfma_f32_16x16x32_bf16 v[148:151], a[128:131], a[4:7], v[148:151]
ds_read_b128 a[116:119], v6 offset:1024
v_mfma_f32_16x16x32_bf16 v[152:155], a[132:135], a[4:7], v[152:155]
buffer_load_dwordx4 a[48:51], v4, s[40:43], s35 offen offset:0 sc1
v_mfma_f32_16x16x32_bf16 v[136:139], a[132:135], a[0:3], v[136:139]
ds_read_b128 a[120:123], v6 offset:2048
v_mfma_f32_16x16x32_bf16 v[140:143], a[136:139], a[0:3], v[140:143]
ds_read_b128 a[124:127], v6 offset:3072
v_mfma_f32_16x16x32_bf16 v[156:159], a[136:139], a[4:7], v[156:159]
v_mfma_f32_16x16x32_bf16 v[160:163], a[140:143], a[4:7], v[160:163]
buffer_load_dwordx4 a[52:55], v4, s[40:43], s35 offen offset:1024 sc1
s_xor_b32 s35, s9, 561152
v_mfma_f32_16x16x32_bf16 v[144:147], a[140:143], a[0:3], v[144:147]
s_waitcnt vmcnt(10) lgkmcnt(4)
v_mfma_f32_16x16x32_bf16 v[132:135], a[96:99], a[8:11], v[132:135]
ds_read_b128 a[128:131], v6 offset:4096
v_mfma_f32_16x16x32_bf16 v[148:151], a[96:99], a[12:15], v[148:151]
ds_read_b128 a[132:135], v6 offset:5120
v_mfma_f32_16x16x32_bf16 v[152:155], a[100:103], a[12:15], v[152:155]
buffer_load_dwordx4 a[0:3], v4, s[40:43], s35 offen offset:0 sc1
v_mfma_f32_16x16x32_bf16 v[136:139], a[100:103], a[8:11], v[136:139]
ds_read_b128 a[136:139], v6 offset:6144
v_mfma_f32_16x16x32_bf16 v[140:143], a[104:107], a[8:11], v[140:143]
ds_read_b128 a[140:143], v6 offset:7168
v_mfma_f32_16x16x32_bf16 v[156:159], a[104:107], a[12:15], v[156:159]
v_mfma_f32_16x16x32_bf16 v[160:163], a[108:111], a[12:15], v[160:163]
buffer_load_dwordx4 a[4:7], v4, s[40:43], s35 offen offset:1024 sc1
s_xor_b32 s35, s9, 573440
v_mfma_f32_16x16x32_bf16 v[144:147], a[108:111], a[8:11], v[144:147]
s_waitcnt vmcnt(10) lgkmcnt(4)
v_mfma_f32_16x16x32_bf16 v[132:135], a[112:115], a[16:19], v[132:135]
ds_read_b128 a[96:99], v6 offset:8192
v_mfma_f32_16x16x32_bf16 v[148:151], a[112:115], a[20:23], v[148:151]
ds_read_b128 a[100:103], v6 offset:9216
v_mfma_f32_16x16x32_bf16 v[152:155], a[116:119], a[20:23], v[152:155]
buffer_load_dwordx4 a[8:11], v4, s[40:43], s35 offen offset:0 sc1
v_mfma_f32_16x16x32_bf16 v[136:139], a[116:119], a[16:19], v[136:139]
ds_read_b128 a[104:107], v6 offset:10240
v_mfma_f32_16x16x32_bf16 v[140:143], a[120:123], a[16:19], v[140:143]
ds_read_b128 a[108:111], v6 offset:11264
v_mfma_f32_16x16x32_bf16 v[156:159], a[120:123], a[20:23], v[156:159]
v_mfma_f32_16x16x32_bf16 v[160:163], a[124:127], a[20:23], v[160:163]
buffer_load_dwordx4 a[12:15], v4, s[40:43], s35 offen offset:1024 sc1
s_xor_b32 s35, s9, 577536
v_mfma_f32_16x16x32_bf16 v[144:147], a[124:127], a[16:19], v[144:147]
s_waitcnt vmcnt(10) lgkmcnt(4)
v_mfma_f32_16x16x32_bf16 v[132:135], a[128:131], a[24:27], v[132:135]
ds_read_b128 a[112:115], v6 offset:12288
v_mfma_f32_16x16x32_bf16 v[148:151], a[128:131], a[28:31], v[148:151]
ds_read_b128 a[116:119], v6 offset:13312
v_mfma_f32_16x16x32_bf16 v[152:155], a[132:135], a[28:31], v[152:155]
buffer_load_dwordx4 a[16:19], v4, s[40:43], s35 offen offset:0 sc1
v_mfma_f32_16x16x32_bf16 v[136:139], a[132:135], a[24:27], v[136:139]
ds_read_b128 a[120:123], v6 offset:14336
v_mfma_f32_16x16x32_bf16 v[140:143], a[136:139], a[24:27], v[140:143]
ds_read_b128 a[124:127], v6 offset:15360
v_mfma_f32_16x16x32_bf16 v[156:159], a[136:139], a[28:31], v[156:159]
v_mfma_f32_16x16x32_bf16 v[160:163], a[140:143], a[28:31], v[160:163]
buffer_load_dwordx4 a[20:23], v4, s[40:43], s35 offen offset:1024 sc1
s_xor_b32 s35, s9, 589824
v_mfma_f32_16x16x32_bf16 v[144:147], a[140:143], a[24:27], v[144:147]
s_waitcnt vmcnt(10) lgkmcnt(4)
v_mfma_f32_16x16x32_bf16 v[132:135], a[96:99], a[32:35], v[132:135]
ds_read_b128 a[128:131], v6 offset:16384
v_mfma_f32_16x16x32_bf16 v[148:151], a[96:99], a[36:39], v[148:151]
ds_read_b128 a[132:135], v6 offset:17408
v_mfma_f32_16x16x32_bf16 v[152:155], a[100:103], a[36:39], v[152:155]
buffer_load_dwordx4 a[24:27], v4, s[40:43], s35 offen offset:0 sc1
v_mfma_f32_16x16x32_bf16 v[136:139], a[100:103], a[32:35], v[136:139]
ds_read_b128 a[136:139], v6 offset:18432
v_mfma_f32_16x16x32_bf16 v[140:143], a[104:107], a[32:35], v[140:143]
ds_read_b128 a[140:143], v6 offset:19456
v_mfma_f32_16x16x32_bf16 v[156:159], a[104:107], a[36:39], v[156:159]
v_mfma_f32_16x16x32_bf16 v[160:163], a[108:111], a[36:39], v[160:163]
buffer_load_dwordx4 a[28:31], v4, s[40:43], s35 offen offset:1024 sc1
s_xor_b32 s35, s9, 593920
v_mfma_f32_16x16x32_bf16 v[144:147], a[108:111], a[32:35], v[144:147]
s_waitcnt vmcnt(10) lgkmcnt(4)
v_mfma_f32_16x16x32_bf16 v[132:135], a[112:115], a[40:43], v[132:135]
ds_read_b128 a[96:99], v6 offset:20480
v_mfma_f32_16x16x32_bf16 v[148:151], a[112:115], a[44:47], v[148:151]
ds_read_b128 a[100:103], v6 offset:21504
v_mfma_f32_16x16x32_bf16 v[152:155], a[116:119], a[44:47], v[152:155]
buffer_load_dwordx4 a[32:35], v4, s[40:43], s35 offen offset:0 sc1
v_mfma_f32_16x16x32_bf16 v[136:139], a[116:119], a[40:43], v[136:139]
ds_read_b128 a[104:107], v6 offset:22528
v_mfma_f32_16x16x32_bf16 v[140:143], a[120:123], a[40:43], v[140:143]
ds_read_b128 a[108:111], v6 offset:23552
v_mfma_f32_16x16x32_bf16 v[156:159], a[120:123], a[44:47], v[156:159]
v_mfma_f32_16x16x32_bf16 v[160:163], a[124:127], a[44:47], v[160:163]
buffer_load_dwordx4 a[36:39], v4, s[40:43], s35 offen offset:1024 sc1
s_xor_b32 s35, s9, 606208
v_mfma_f32_16x16x32_bf16 v[144:147], a[124:127], a[40:43], v[144:147]
s_waitcnt vmcnt(10) lgkmcnt(4)
v_mfma_f32_16x16x32_bf16 v[132:135], a[128:131], a[48:51], v[132:135]
ds_read_b128 a[112:115], v6 offset:24576
v_mfma_f32_16x16x32_bf16 v[148:151], a[128:131], a[52:55], v[148:151]
ds_read_b128 a[116:119], v6 offset:25600
v_mfma_f32_16x16x32_bf16 v[152:155], a[132:135], a[52:55], v[152:155]
buffer_load_dwordx4 a[40:43], v4, s[40:43], s35 offen offset:0 sc1
v_mfma_f32_16x16x32_bf16 v[136:139], a[132:135], a[48:51], v[136:139]
ds_read_b128 a[120:123], v6 offset:26624
v_mfma_f32_16x16x32_bf16 v[140:143], a[136:139], a[48:51], v[140:143]
ds_read_b128 a[124:127], v6 offset:27648
v_mfma_f32_16x16x32_bf16 v[156:159], a[136:139], a[52:55], v[156:159]
v_mfma_f32_16x16x32_bf16 v[160:163], a[140:143], a[52:55], v[160:163]
buffer_load_dwordx4 a[44:47], v4, s[40:43], s35 offen offset:1024 sc1
s_xor_b32 s35, s9, 610304
v_mfma_f32_16x16x32_bf16 v[144:147], a[140:143], a[48:51], v[144:147]
s_waitcnt vmcnt(10) lgkmcnt(4)
v_mfma_f32_16x16x32_bf16 v[132:135], a[96:99], a[0:3], v[132:135]
ds_read_b128 a[128:131], v6 offset:28672
v_mfma_f32_16x16x32_bf16 v[148:151], a[96:99], a[4:7], v[148:151]
ds_read_b128 a[132:135], v6 offset:29696
v_mfma_f32_16x16x32_bf16 v[152:155], a[100:103], a[4:7], v[152:155]
buffer_load_dwordx4 a[48:51], v4, s[40:43], s35 offen offset:0 sc1
v_mfma_f32_16x16x32_bf16 v[136:139], a[100:103], a[0:3], v[136:139]
ds_read_b128 a[136:139], v6 offset:30720
v_mfma_f32_16x16x32_bf16 v[140:143], a[104:107], a[0:3], v[140:143]
ds_read_b128 a[140:143], v6 offset:31744
v_mfma_f32_16x16x32_bf16 v[156:159], a[104:107], a[4:7], v[156:159]
v_mfma_f32_16x16x32_bf16 v[160:163], a[108:111], a[4:7], v[160:163]
buffer_load_dwordx4 a[52:55], v4, s[40:43], s35 offen offset:1024 sc1
s_xor_b32 s35, s9, 622592
v_mfma_f32_16x16x32_bf16 v[144:147], a[108:111], a[0:3], v[144:147]
s_waitcnt vmcnt(10) lgkmcnt(4)
v_mfma_f32_16x16x32_bf16 v[132:135], a[112:115], a[8:11], v[132:135]
ds_read_b128 a[96:99], v6 offset:32768
v_mfma_f32_16x16x32_bf16 v[148:151], a[112:115], a[12:15], v[148:151]
ds_read_b128 a[100:103], v6 offset:33792
v_mfma_f32_16x16x32_bf16 v[152:155], a[116:119], a[12:15], v[152:155]
buffer_load_dwordx4 a[0:3], v4, s[40:43], s35 offen offset:0 sc1
v_mfma_f32_16x16x32_bf16 v[136:139], a[116:119], a[8:11], v[136:139]
ds_read_b128 a[104:107], v6 offset:34816
v_mfma_f32_16x16x32_bf16 v[140:143], a[120:123], a[8:11], v[140:143]
ds_read_b128 a[108:111], v6 offset:35840
v_mfma_f32_16x16x32_bf16 v[156:159], a[120:123], a[12:15], v[156:159]
v_mfma_f32_16x16x32_bf16 v[160:163], a[124:127], a[12:15], v[160:163]
buffer_load_dwordx4 a[4:7], v4, s[40:43], s35 offen offset:1024 sc1
s_xor_b32 s35, s9, 626688
v_mfma_f32_16x16x32_bf16 v[144:147], a[124:127], a[8:11], v[144:147]
s_waitcnt vmcnt(10) lgkmcnt(4)
v_mfma_f32_16x16x32_bf16 v[132:135], a[128:131], a[16:19], v[132:135]
ds_read_b128 a[112:115], v6 offset:36864
v_mfma_f32_16x16x32_bf16 v[148:151], a[128:131], a[20:23], v[148:151]
ds_read_b128 a[116:119], v6 offset:37888
v_mfma_f32_16x16x32_bf16 v[152:155], a[132:135], a[20:23], v[152:155]
buffer_load_dwordx4 a[8:11], v4, s[40:43], s35 offen offset:0 sc1
v_mfma_f32_16x16x32_bf16 v[136:139], a[132:135], a[16:19], v[136:139]
ds_read_b128 a[120:123], v6 offset:38912
v_mfma_f32_16x16x32_bf16 v[140:143], a[136:139], a[16:19], v[140:143]
ds_read_b128 a[124:127], v6 offset:39936
v_mfma_f32_16x16x32_bf16 v[156:159], a[136:139], a[20:23], v[156:159]
v_mfma_f32_16x16x32_bf16 v[160:163], a[140:143], a[20:23], v[160:163]
buffer_load_dwordx4 a[12:15], v4, s[40:43], s35 offen offset:1024 sc1
s_xor_b32 s35, s9, 638976
v_mfma_f32_16x16x32_bf16 v[144:147], a[140:143], a[16:19], v[144:147]
s_waitcnt vmcnt(10) lgkmcnt(4)
v_mfma_f32_16x16x32_bf16 v[132:135], a[96:99], a[24:27], v[132:135]
ds_read_b128 a[128:131], v6 offset:40960
v_mfma_f32_16x16x32_bf16 v[148:151], a[96:99], a[28:31], v[148:151]
ds_read_b128 a[132:135], v6 offset:41984
v_mfma_f32_16x16x32_bf16 v[152:155], a[100:103], a[28:31], v[152:155]
buffer_load_dwordx4 a[16:19], v4, s[40:43], s35 offen offset:0 sc1
v_mfma_f32_16x16x32_bf16 v[136:139], a[100:103], a[24:27], v[136:139]
ds_read_b128 a[136:139], v6 offset:43008
v_mfma_f32_16x16x32_bf16 v[140:143], a[104:107], a[24:27], v[140:143]
ds_read_b128 a[140:143], v6 offset:44032
v_mfma_f32_16x16x32_bf16 v[156:159], a[104:107], a[28:31], v[156:159]
v_mfma_f32_16x16x32_bf16 v[160:163], a[108:111], a[28:31], v[160:163]
buffer_load_dwordx4 a[20:23], v4, s[40:43], s35 offen offset:1024 sc1
s_xor_b32 s35, s9, 643072
v_mfma_f32_16x16x32_bf16 v[144:147], a[108:111], a[24:27], v[144:147]
s_waitcnt vmcnt(10) lgkmcnt(4)
v_mfma_f32_16x16x32_bf16 v[132:135], a[112:115], a[32:35], v[132:135]
ds_read_b128 a[96:99], v6 offset:45056
v_mfma_f32_16x16x32_bf16 v[148:151], a[112:115], a[36:39], v[148:151]
ds_read_b128 a[100:103], v6 offset:46080
v_mfma_f32_16x16x32_bf16 v[152:155], a[116:119], a[36:39], v[152:155]
buffer_load_dwordx4 a[24:27], v4, s[40:43], s35 offen offset:0 sc1
v_mfma_f32_16x16x32_bf16 v[136:139], a[116:119], a[32:35], v[136:139]
ds_read_b128 a[104:107], v6 offset:47104
v_mfma_f32_16x16x32_bf16 v[140:143], a[120:123], a[32:35], v[140:143]
ds_read_b128 a[108:111], v6 offset:48128
v_mfma_f32_16x16x32_bf16 v[156:159], a[120:123], a[36:39], v[156:159]
v_mfma_f32_16x16x32_bf16 v[160:163], a[124:127], a[36:39], v[160:163]
buffer_load_dwordx4 a[28:31], v4, s[40:43], s35 offen offset:1024 sc1
s_xor_b32 s35, s9, 0
v_mfma_f32_16x16x32_bf16 v[144:147], a[124:127], a[32:35], v[144:147]
s_waitcnt vmcnt(10) lgkmcnt(4)
v_mfma_f32_16x16x32_bf16 v[132:135], a[128:131], a[40:43], v[132:135]
s_add_u32 m0, s18, 0x0
s_add_u32 s44, s50, 0x2000000
v_mfma_f32_16x16x32_bf16 v[148:151], a[128:131], a[44:47], v[148:151]
ds_read_b128 a[112:115], v6 offset:49152
v_mfma_f32_16x16x32_bf16 v[152:155], a[132:135], a[44:47], v[152:155]
buffer_load_dwordx4 v1, s[4:7], s44 offen offset:0 sc1 lds
v_mfma_f32_16x16x32_bf16 v[136:139], a[132:135], a[40:43], v[136:139]
ds_read_b128 a[116:119], v6 offset:50176
v_mfma_f32_16x16x32_bf16 v[140:143], a[136:139], a[40:43], v[140:143]
ds_read_b128 a[120:123], v6 offset:51200
v_mfma_f32_16x16x32_bf16 v[156:159], a[136:139], a[44:47], v[156:159]
ds_read_b128 a[124:127], v6 offset:52224
v_mfma_f32_16x16x32_bf16 v[160:163], a[140:143], a[44:47], v[160:163]
buffer_load_dwordx4 v1, s[4:7], s44 offen offset:1024 sc1 lds
s_add_u32 m0, s18, 0x2000
v_mfma_f32_16x16x32_bf16 v[144:147], a[140:143], a[40:43], v[144:147]
s_add_u32 s44, s50, 0x2002000
s_waitcnt vmcnt(10) lgkmcnt(4)
v_mfma_f32_16x16x32_bf16 v[132:135], a[96:99], a[48:51], v[132:135]
ds_read_b128 a[128:131], v6 offset:53248
v_mfma_f32_16x16x32_bf16 v[148:151], a[96:99], a[52:55], v[148:151]
ds_read_b128 a[132:135], v6 offset:54272
v_mfma_f32_16x16x32_bf16 v[152:155], a[100:103], a[52:55], v[152:155]
buffer_load_dwordx4 v1, s[4:7], s44 offen offset:0 sc1 lds
v_mfma_f32_16x16x32_bf16 v[136:139], a[100:103], a[48:51], v[136:139]
ds_read_b128 a[136:139], v6 offset:55296
v_mfma_f32_16x16x32_bf16 v[140:143], a[104:107], a[48:51], v[140:143]
ds_read_b128 a[140:143], v6 offset:56320
v_mfma_f32_16x16x32_bf16 v[156:159], a[104:107], a[52:55], v[156:159]
v_mfma_f32_16x16x32_bf16 v[160:163], a[108:111], a[52:55], v[160:163]
buffer_load_dwordx4 v1, s[4:7], s44 offen offset:1024 sc1 lds
s_add_u32 m0, s18, 0x4000
v_mfma_f32_16x16x32_bf16 v[144:147], a[108:111], a[48:51], v[144:147]
s_add_u32 s44, s50, 0x2004000
s_waitcnt vmcnt(10) lgkmcnt(4)
v_mfma_f32_16x16x32_bf16 v[132:135], a[112:115], a[0:3], v[132:135]
ds_read_b128 a[96:99], v6 offset:57344
v_mfma_f32_16x16x32_bf16 v[148:151], a[112:115], a[4:7], v[148:151]
ds_read_b128 a[100:103], v6 offset:58368
v_mfma_f32_16x16x32_bf16 v[152:155], a[116:119], a[4:7], v[152:155]
ds_read_b128 a[104:107], v6 offset:59392
v_mfma_f32_16x16x32_bf16 v[136:139], a[116:119], a[0:3], v[136:139]
buffer_load_dwordx4 v1, s[4:7], s44 offen offset:0 sc1 lds
v_mfma_f32_16x16x32_bf16 v[140:143], a[120:123], a[0:3], v[140:143]
ds_read_b128 a[108:111], v6 offset:60416
v_mfma_f32_16x16x32_bf16 v[156:159], a[120:123], a[4:7], v[156:159]
v_mfma_f32_16x16x32_bf16 v[160:163], a[124:127], a[4:7], v[160:163]
v_mfma_f32_16x16x32_bf16 v[144:147], a[124:127], a[0:3], v[144:147]
buffer_load_dwordx4 v1, s[4:7], s44 offen offset:1024 sc1 lds
s_waitcnt vmcnt(10) lgkmcnt(4)
v_mfma_f32_16x16x32_bf16 v[132:135], a[128:131], a[8:11], v[132:135]
s_add_u32 m0, s18, 0x6000
s_add_u32 s44, s50, 0x2006000
v_mfma_f32_16x16x32_bf16 v[148:151], a[128:131], a[12:15], v[148:151]
ds_read_b128 a[112:115], v6 offset:61440
v_mfma_f32_16x16x32_bf16 v[152:155], a[132:135], a[12:15], v[152:155]
ds_read_b128 a[116:119], v6 offset:62464
v_mfma_f32_16x16x32_bf16 v[136:139], a[132:135], a[8:11], v[136:139]
ds_read_b128 a[120:123], v6 offset:63488
v_mfma_f32_16x16x32_bf16 v[140:143], a[136:139], a[8:11], v[140:143]
buffer_load_dwordx4 v1, s[4:7], s44 offen offset:0 sc1 lds
v_mfma_f32_16x16x32_bf16 v[156:159], a[136:139], a[12:15], v[156:159]
ds_read_b128 a[124:127], v6 offset:64512
v_mfma_f32_16x16x32_bf16 v[160:163], a[140:143], a[12:15], v[160:163]
v_mfma_f32_16x16x32_bf16 v[144:147], a[140:143], a[8:11], v[144:147]
s_waitcnt vmcnt(9) lgkmcnt(4)
v_mfma_f32_16x16x32_bf16 v[132:135], a[96:99], a[16:19], v[132:135]
v_mfma_f32_16x16x32_bf16 v[148:151], a[96:99], a[20:23], v[148:151]
buffer_load_dwordx4 v1, s[4:7], s44 offen offset:1024 sc1 lds
v_mfma_f32_16x16x32_bf16 v[152:155], a[100:103], a[20:23], v[152:155]
v_mfma_f32_16x16x32_bf16 v[136:139], a[100:103], a[16:19], v[136:139]
v_mfma_f32_16x16x32_bf16 v[140:143], a[104:107], a[16:19], v[140:143]
v_mfma_f32_16x16x32_bf16 v[156:159], a[104:107], a[20:23], v[156:159]
v_mfma_f32_16x16x32_bf16 v[160:163], a[108:111], a[20:23], v[160:163]
v_mfma_f32_16x16x32_bf16 v[144:147], a[108:111], a[16:19], v[144:147]
s_waitcnt vmcnt(8) lgkmcnt(0)
v_mfma_f32_16x16x32_bf16 v[132:135], a[112:115], a[24:27], v[132:135]
v_mfma_f32_16x16x32_bf16 v[148:151], a[112:115], a[28:31], v[148:151]
v_mfma_f32_16x16x32_bf16 v[152:155], a[116:119], a[28:31], v[152:155]
v_mfma_f32_16x16x32_bf16 v[136:139], a[116:119], a[24:27], v[136:139]
v_mfma_f32_16x16x32_bf16 v[140:143], a[120:123], a[24:27], v[140:143]
v_mfma_f32_16x16x32_bf16 v[156:159], a[120:123], a[28:31], v[156:159]
v_mfma_f32_16x16x32_bf16 v[160:163], a[124:127], a[28:31], v[160:163]
v_mfma_f32_16x16x32_bf16 v[144:147], a[124:127], a[24:27], v[144:147]
s_nop 1
v_cmp_u_f32 vcc, v132, v148
s_nop 0
s_and_b32 vcc_lo, vcc_lo, s95
s_cbranch_scc1 L_k2redo1
v_cvt_pk_bf16_f32 v32, v132, v133
v_cvt_pk_bf16_f32 v33, v134, v135
v_cvt_pk_bf16_f32 v34, v136, v137
v_cvt_pk_bf16_f32 v35, v138, v139
s_add_u32 s36, s45, 0x1000000
buffer_store_dwordx4 v[32:35], v4, s[4:7], s36 offen offset:0 sc1
v_cvt_pk_bf16_f32 v40, v148, v149
v_cvt_pk_bf16_f32 v41, v150, v151
v_cvt_pk_bf16_f32 v42, v152, v153
v_cvt_pk_bf16_f32 v43, v154, v155
v_cvt_pk_bf16_f32 v36, v140, v141
v_cvt_pk_bf16_f32 v37, v142, v143
v_cvt_pk_bf16_f32 v38, v144, v145
v_cvt_pk_bf16_f32 v39, v146, v147
s_add_u32 s37, s36, 4096
v_cvt_pk_bf16_f32 v44, v156, v157
v_cvt_pk_bf16_f32 v45, v158, v159
v_cvt_pk_bf16_f32 v46, v160, v161
buffer_store_dwordx4 v[40:43], v4, s[4:7], s36 offen offset:1024 sc1
v_cvt_pk_bf16_f32 v47, v162, v163
v_mfma_f32_16x16x32_bf16 v[96:99], v[32:35], v[32:35], 0
s_mov_b32 s38, 0x340000
s_add_u32 s92, s78, 0x50000
v_mfma_f32_16x16x32_bf16 v[92:95], v[16:19], v[32:35], 0
s_add_u32 s40, s4, 0x1000000
s_addc_u32 s41, s5, 0
v_mfma_f32_16x16x32_bf16 v[96:99], v[36:39], v[36:39], v[96:99]
buffer_store_dwordx4 v[36:39], v4, s[4:7], s37 offen offset:0 sc1
v_mfma_f32_16x16x32_bf16 v[92:95], v[16:19], v[36:39], v[92:95]
s_nop 5
v_cndmask_b32 v96, v96, v97, s[46:47]
v_cndmask_b32 v98, v98, v99, s[46:47]
v_mfma_f32_16x16x32_bf16 v[104:107], v[40:43], v[40:43], 0
v_mfma_f32_16x16x32_bf16 v[100:103], v[16:19], v[40:43], 0
v_cndmask_b32 v93, v96, v98, s[48:49]
buffer_store_dwordx4 v[44:47], v4, s[4:7], s37 offen offset:1024 sc1
v_mfma_f32_16x16x32_bf16 v[104:107], v[44:47], v[44:47], v[104:107]
v_mfma_f32_16x16x32_bf16 v[100:103], v[16:19], v[44:47], v[100:103]
s_nop 6
v_cndmask_b32 v104, v104, v105, s[46:47]
v_cndmask_b32 v106, v106, v107, s[46:47]
buffer_store_dwordx2 v[92:93], v253, s[4:7], s38 offen offset:0 sc1
v_cndmask_b32 v101, v104, v106, s[48:49]
buffer_store_dwordx2 v[100:101], v253, s[4:7], s38 offen offset:2048 sc1
s_barrier
s_add_u32 m0, s18, 0x8000
s_add_u32 s44, s50, 0x2008000
buffer_load_dwordx4 v1, s[4:7], s44 offen offset:0 sc1 lds
buffer_load_dwordx4 v1, s[4:7], s44 offen offset:1024 sc1 lds
s_add_u32 m0, s18, 0xa000
s_add_u32 s44, s50, 0x200a000
buffer_load_dwordx4 v1, s[4:7], s44 offen offset:0 sc1 lds
buffer_load_dwordx4 v1, s[4:7], s44 offen offset:1024 sc1 lds
v_accvgpr_read_b32 v48, a188
v_accvgpr_read_b32 v49, a189
v_accvgpr_read_b32 v50, a190
v_accvgpr_read_b32 v51, a191
v_accvgpr_read_b32 v52, a192
v_accvgpr_read_b32 v53, a193
v_accvgpr_read_b32 v54, a194
v_accvgpr_read_b32 v55, a195
v_accvgpr_read_b32 v56, a196
v_accvgpr_read_b32 v57, a197
v_accvgpr_read_b32 v58, a198
v_accvgpr_read_b32 v59, a199
v_accvgpr_read_b32 v60, a200
v_accvgpr_read_b32 v61, a201
v_accvgpr_read_b32 v62, a202
v_accvgpr_read_b32 v63, a203
v_accvgpr_read_b32 v64, a204
v_accvgpr_read_b32 v65, a205
v_accvgpr_read_b32 v66, a206
v_accvgpr_read_b32 v67, a207
v_accvgpr_read_b32 v68, a208
v_accvgpr_read_b32 v69, a209
v_accvgpr_read_b32 v70, a210
v_accvgpr_read_b32 v71, a211
s_waitcnt vmcnt(4)
s_barrier
s_cmp_lg_u32 s28, 0
s_cbranch_scc1 Lsg_30
buffer_atomic_add v12, v10, s[4:7], s92 offen sc1
Lsg_30:
s_mov_b64 exec, 0
s_cmp_eq_u32 s28, 0
s_cbranch_scc1 L_stub10
L_wret4:
s_mov_b64 exec, -1
s_cmp_lt_u32 s28, 2
s_cbranch_scc1 Lwd_31
s_add_u32 m0, s19, 0xa000
s_add_u32 s44, s50, 0x200a000
s_add_u32 s44, s44, s18
buffer_load_dwordx4 v1, s[4:7], s44 offen offset:0 sc1 lds
buffer_load_dwordx4 v1, s[4:7], s44 offen offset:1024 sc1 lds
buffer_load_dwordx4 v1, s[4:7], s44 offen offset:2048 sc1 lds
buffer_load_dwordx4 v1, s[4:7], s44 offen offset:3072 sc1 lds
s_add_u32 m0, s19, 0xc000
s_add_u32 s44, s50, 0x200c000
s_add_u32 s44, s44, s18
buffer_load_dwordx4 v1, s[4:7], s44 offen offset:0 sc1 lds
buffer_load_dwordx4 v1, s[4:7], s44 offen offset:1024 sc1 lds
buffer_load_dwordx4 v1, s[4:7], s44 offen offset:2048 sc1 lds
buffer_load_dwordx4 v1, s[4:7], s44 offen offset:3072 sc1 lds
s_add_u32 m0, s19, 0xe000
s_add_u32 s44, s50, 0x200e000
s_add_u32 s44, s44, s18
buffer_load_dwordx4 v1, s[4:7], s44 offen offset:0 sc1 lds
buffer_load_dwordx4 v1, s[4:7], s44 offen offset:1024 sc1 lds
buffer_load_dwordx4 v1, s[4:7], s44 offen offset:2048 sc1 lds
buffer_load_dwordx4 v1, s[4:7], s44 offen offset:3072 sc1 lds
s_add_u32 m0, s19, 0x10000
s_add_u32 s44, s50, 0x2010000
s_add_u32 s44, s44, s18
buffer_load_dwordx4 v1, s[4:7], s44 offen offset:0 sc1 lds
buffer_load_dwordx4 v1, s[4:7], s44 offen offset:1024 sc1 lds
buffer_load_dwordx4 v1, s[4:7], s44 offen offset:2048 sc1 lds
buffer_load_dwordx4 v1, s[4:7], s44 offen offset:3072 sc1 lds
s_add_u32 m0, s19, 0x12000
s_add_u32 s44, s50, 0x2012000
s_add_u32 s44, s44, s18
buffer_load_dwordx4 v1, s[4:7], s44 offen offset:0 sc1 lds
buffer_load_dwordx4 v1, s[4:7], s44 offen offset:1024 sc1 lds
buffer_load_dwordx4 v1, s[4:7], s44 offen offset:2048 sc1 lds
buffer_load_dwordx4 v1, s[4:7], s44 offen offset:3072 sc1 lds
s_add_u32 m0, s19, 0x14000
s_add_u32 s44, s50, 0x2014000
s_add_u32 s44, s44, s18
buffer_load_dwordx4 v1, s[4:7], s44 offen offset:0 sc1 lds
buffer_load_dwordx4 v1, s[4:7], s44 offen offset:1024 sc1 lds
buffer_load_dwordx4 v1, s[4:7], s44 offen offset:2048 sc1 lds
buffer_load_dwordx4 v1, s[4:7], s44 offen offset:3072 sc1 lds
s_add_u32 m0, s19, 0x16000
s_add_u32 s44, s50, 0x2016000
s_add_u32 s44, s44, s18
buffer_load_dwordx4 v1, s[4:7], s44 offen offset:0 sc1 lds
buffer_load_dwordx4 v1, s[4:7], s44 offen offset:1024 sc1 lds
buffer_load_dwordx4 v1, s[4:7], s44 offen offset:2048 sc1 lds
buffer_load_dwordx4 v1, s[4:7], s44 offen offset:3072 sc1 lds
s_add_u32 m0, s19, 0x18000
s_add_u32 s44, s50, 0x2018000
s_add_u32 s44, s44, s18
buffer_load_dwordx4 v1, s[4:7], s44 offen offset:0 sc1 lds
buffer_load_dwordx4 v1, s[4:7], s44 offen offset:1024 sc1 lds
buffer_load_dwordx4 v1, s[4:7], s44 offen offset:2048 sc1 lds
buffer_load_dwordx4 v1, s[4:7], s44 offen offset:3072 sc1 lds
Lwd_31:
s_cmp_lg_u32 s28, 1
s_cbranch_scc1 Lpo_34
s_add_u32 s36, s34, 0x50000
s_mov_b32 s37, 0
v_mov_b32 v11, 0
buffer_atomic_add v11, v251, s[4:7], s36 offen sc0 sc1
s_sleep 4
Lpoll_32:
v_mov_b32 v234, 0
buffer_atomic_add v234, v251, s[4:7], s36 offen sc0 sc1
s_waitcnt vmcnt(1)
v_readfirstlane_b32 s38, v11
s_nop 0
s_cmp_ge_u32 s38, 32
s_cbranch_scc1 Lpe_33
v_mov_b32 v11, 0
buffer_atomic_add v11, v251, s[4:7], s36 offen sc0 sc1
s_waitcnt vmcnt(1)
v_readfirstlane_b32 s38, v234
s_nop 0
s_cmp_ge_u32 s38, 32
s_cbranch_scc1 Lpe_33
s_add_u32 s37, s37, 1
s_cmp_lt_u32 s37, 0x80000
s_cbranch_scc1 Lpoll_32
s_waitcnt vmcnt(0)
Lpo_34:
s_waitcnt vmcnt(32) lgkmcnt(0)
s_cmp_ge_u32 s28, 2
s_cbranch_scc1 Lw_35
s_waitcnt vmcnt(0)
Lw_35:
Lpe_33:
s_barrier
s_add_u32 s94, s71, 0x20080
s_mov_b32 s35, s10
L_stub10:
s_cbranch_execz L_stub11
s_add_u32 s33, s35, 0x1000
buffer_load_dwordx4 a[0:3], v2, s[40:43], s35 offen offset:0 sc1
buffer_load_dwordx4 a[4:7], v2, s[40:43], s33 offen offset:0 sc1
buffer_load_dwordx4 a[8:11], v2, s[40:43], s35 offen offset:1024 sc1
buffer_load_dwordx4 a[12:15], v2, s[40:43], s33 offen offset:1024 sc1
buffer_load_dwordx4 a[16:19], v2, s[40:43], s35 offen offset:2048 sc1
buffer_load_dwordx4 a[20:23], v2, s[40:43], s33 offen offset:2048 sc1
buffer_load_dwordx4 a[24:27], v2, s[40:43], s35 offen offset:3072 sc1
buffer_load_dwordx4 a[28:31], v2, s[40:43], s33 offen offset:3072 sc1
s_add_u32 s35, s35, 0x4000
s_add_u32 s33, s33, 0x4000
buffer_load_dwordx4 a[32:35], v2, s[40:43], s35 offen offset:0 sc1
buffer_load_dwordx4 a[36:39], v2, s[40:43], s33 offen offset:0 sc1
buffer_load_dwordx4 a[40:43], v2, s[40:43], s35 offen offset:1024 sc1
buffer_load_dwordx4 a[44:47], v2, s[40:43], s33 offen offset:1024 sc1
buffer_load_dwordx4 a[48:51], v2, s[40:43], s35 offen offset:2048 sc1
buffer_load_dwordx4 a[52:55], v2, s[40:43], s33 offen offset:2048 sc1
buffer_load_dwordx4 a[56:59], v2, s[40:43], s35 offen offset:3072 sc1
buffer_load_dwordx4 a[60:63], v2, s[40:43], s33 offen offset:3072 sc1
s_add_u32 s35, s35, 0x4000
s_add_u32 s33, s33, 0x4000
v_add_u32 v5, 0, v1
ds_read_b128 a[96:99], v5 offset:2048
ds_read_b128 a[100:103], v5 offset:8192
ds_read_b128 a[104:107], v5 offset:3072
ds_read_b128 a[108:111], v5 offset:9216
ds_read_b128 a[112:115], v5 offset:4096
ds_read_b128 a[116:119], v5 offset:10240
s_waitcnt vmcnt(14) lgkmcnt(4)
v_mfma_f32_16x16x32_bf16 v[140:143], a[96:99], a[0:3], 0
s_add_u32 m0, s18, 0x1c000
s_add_u32 s44, s50, 0x201c000
v_mfma_f32_16x16x32_bf16 v[140:143], a[100:103], a[4:7], v[140:143]
buffer_load_dwordx4 a[64:67], v2, s[40:43], s35 offen offset:0 sc1
s_waitcnt vmcnt(13)
v_mfma_f32_16x16x32_bf16 v[164:167], a[100:103], a[12:15], 0
ds_read_b128 a[128:131], v5 offset:5120
v_mfma_f32_16x16x32_bf16 v[164:167], a[96:99], a[8:11], v[164:167]
ds_read_b128 a[132:135], v5 offset:11264
s_waitcnt vmcnt(12)
v_mfma_f32_16x16x32_bf16 v[188:191], a[96:99], a[16:19], 0
s_waitcnt vmcnt(11)
v_mfma_f32_16x16x32_bf16 v[188:191], a[100:103], a[20:23], v[188:191]
buffer_load_dwordx4 a[68:71], v2, s[40:43], s33 offen offset:0 sc1
s_waitcnt vmcnt(10)
v_mfma_f32_16x16x32_bf16 v[212:215], a[100:103], a[28:31], 0
ds_read_b128 a[136:139], v5 offset:0
v_mfma_f32_16x16x32_bf16 v[212:215], a[96:99], a[24:27], v[212:215]
s_waitcnt lgkmcnt(6)
v_mfma_f32_16x16x32_bf16 v[216:219], a[104:107], a[24:27], 0
ds_read_b128 a[140:143], v5 offset:6144
s_waitcnt lgkmcnt(6)
v_mfma_f32_16x16x32_bf16 v[216:219], a[108:111], a[28:31], v[216:219]
v_mfma_f32_16x16x32_bf16 v[192:195], a[108:111], a[20:23], 0
buffer_load_dwordx4 v1, s[4:7], s44 offen offset:0 sc1 lds
v_mfma_f32_16x16x32_bf16 v[192:195], a[104:107], a[16:19], v[192:195]
ds_read_b128 a[144:147], v5 offset:1024
v_mfma_f32_16x16x32_bf16 v[168:171], a[104:107], a[8:11], 0
v_mfma_f32_16x16x32_bf16 v[168:171], a[108:111], a[12:15], v[168:171]
ds_read_b128 a[148:151], v5 offset:7168
v_mfma_f32_16x16x32_bf16 v[144:147], a[108:111], a[4:7], 0
v_mfma_f32_16x16x32_bf16 v[144:147], a[104:107], a[0:3], v[144:147]
buffer_load_dwordx4 a[72:75], v2, s[40:43], s35 offen offset:1024 sc1
s_waitcnt lgkmcnt(7)
v_mfma_f32_16x16x32_bf16 v[148:151], a[112:115], a[0:3], 0
s_waitcnt lgkmcnt(6)
v_mfma_f32_16x16x32_bf16 v[148:151], a[116:119], a[4:7], v[148:151]
v_mfma_f32_16x16x32_bf16 v[172:175], a[116:119], a[12:15], 0
v_mfma_f32_16x16x32_bf16 v[172:175], a[112:115], a[8:11], v[172:175]
v_mfma_f32_16x16x32_bf16 v[196:199], a[112:115], a[16:19], 0
buffer_load_dwordx4 a[76:79], v2, s[40:43], s33 offen offset:1024 sc1
v_mfma_f32_16x16x32_bf16 v[196:199], a[116:119], a[20:23], v[196:199]
v_mfma_f32_16x16x32_bf16 v[220:223], a[116:119], a[28:31], 0
v_mfma_f32_16x16x32_bf16 v[220:223], a[112:115], a[24:27], v[220:223]
s_waitcnt lgkmcnt(0)
v_mfma_f32_16x16x32_bf16 v[224:227], a[128:131], a[24:27], 0
ds_read_b128 a[96:99], v5 offset:14336
v_mfma_f32_16x16x32_bf16 v[224:227], a[132:135], a[28:31], v[224:227]
buffer_load_dwordx4 a[80:83], v2, s[40:43], s35 offen offset:2048 sc1
v_mfma_f32_16x16x32_bf16 v[200:203], a[132:135], a[20:23], 0
ds_read_b128 a[100:103], v5 offset:20480
v_mfma_f32_16x16x32_bf16 v[200:203], a[128:131], a[16:19], v[200:203]
v_mfma_f32_16x16x32_bf16 v[176:179], a[128:131], a[8:11], 0
v_mfma_f32_16x16x32_bf16 v[176:179], a[132:135], a[12:15], v[176:179]
buffer_load_dwordx4 a[84:87], v2, s[40:43], s33 offen offset:2048 sc1
v_mfma_f32_16x16x32_bf16 v[152:155], a[132:135], a[4:7], 0
ds_read_b128 a[104:107], v5 offset:15360
v_mfma_f32_16x16x32_bf16 v[152:155], a[128:131], a[0:3], v[152:155]
v_mfma_f32_16x16x32_bf16 v[132:135], a[136:139], a[0:3], 0
ds_read_b128 a[108:111], v5 offset:21504
v_mfma_f32_16x16x32_bf16 v[132:135], a[140:143], a[4:7], v[132:135]
v_mfma_f32_16x16x32_bf16 v[156:159], a[140:143], a[12:15], 0
buffer_load_dwordx4 v1, s[4:7], s44 offen offset:1024 sc1 lds
s_add_u32 m0, s18, 0x1e000
v_mfma_f32_16x16x32_bf16 v[156:159], a[136:139], a[8:11], v[156:159]
s_add_u32 s44, s50, 0x201e000
ds_read_b128 a[112:115], v5 offset:16384
v_mfma_f32_16x16x32_bf16 v[180:183], a[136:139], a[16:19], 0
v_mfma_f32_16x16x32_bf16 v[180:183], a[140:143], a[20:23], v[180:183]
ds_read_b128 a[116:119], v5 offset:22528
v_mfma_f32_16x16x32_bf16 v[204:207], a[140:143], a[28:31], 0
v_mfma_f32_16x16x32_bf16 v[204:207], a[136:139], a[24:27], v[204:207]
buffer_load_dwordx4 a[88:91], v2, s[40:43], s35 offen offset:3072 sc1
v_mfma_f32_16x16x32_bf16 v[208:211], a[144:147], a[24:27], 0
v_mfma_f32_16x16x32_bf16 v[208:211], a[148:151], a[28:31], v[208:211]
v_mfma_f32_16x16x32_bf16 v[184:187], a[148:151], a[20:23], 0
v_mfma_f32_16x16x32_bf16 v[184:187], a[144:147], a[16:19], v[184:187]
v_mfma_f32_16x16x32_bf16 v[160:163], a[144:147], a[8:11], 0
buffer_load_dwordx4 a[92:95], v2, s[40:43], s33 offen offset:3072 sc1
s_add_u32 s35, s35, 0x4000
v_mfma_f32_16x16x32_bf16 v[160:163], a[148:151], a[12:15], v[160:163]
s_add_u32 s33, s33, 0x4000
v_mfma_f32_16x16x32_bf16 v[136:139], a[148:151], a[4:7], 0
v_mfma_f32_16x16x32_bf16 v[136:139], a[144:147], a[0:3], v[136:139]
s_waitcnt vmcnt(10) lgkmcnt(0)
v_mfma_f32_16x16x32_bf16 v[140:143], a[96:99], a[32:35], v[140:143]
ds_read_b128 a[128:131], v5 offset:17408
v_mfma_f32_16x16x32_bf16 v[140:143], a[100:103], a[36:39], v[140:143]
buffer_load_dwordx4 a[0:3], v2, s[40:43], s35 offen offset:0 sc1
v_mfma_f32_16x16x32_bf16 v[164:167], a[100:103], a[44:47], v[164:167]
ds_read_b128 a[132:135], v5 offset:23552
v_mfma_f32_16x16x32_bf16 v[164:167], a[96:99], a[40:43], v[164:167]
v_mfma_f32_16x16x32_bf16 v[188:191], a[96:99], a[48:51], v[188:191]
v_mfma_f32_16x16x32_bf16 v[188:191], a[100:103], a[52:55], v[188:191]
buffer_load_dwordx4 a[4:7], v2, s[40:43], s33 offen offset:0 sc1
v_mfma_f32_16x16x32_bf16 v[212:215], a[100:103], a[60:63], v[212:215]
ds_read_b128 a[136:139], v5 offset:12288
v_mfma_f32_16x16x32_bf16 v[212:215], a[96:99], a[56:59], v[212:215]
v_mfma_f32_16x16x32_bf16 v[216:219], a[104:107], a[56:59], v[216:219]
ds_read_b128 a[140:143], v5 offset:18432
v_mfma_f32_16x16x32_bf16 v[216:219], a[108:111], a[60:63], v[216:219]
v_mfma_f32_16x16x32_bf16 v[192:195], a[108:111], a[52:55], v[192:195]
buffer_load_dwordx4 v1, s[4:7], s44 offen offset:0 sc1 lds
v_mfma_f32_16x16x32_bf16 v[192:195], a[104:107], a[48:51], v[192:195]
ds_read_b128 a[144:147], v5 offset:13312
v_mfma_f32_16x16x32_bf16 v[168:171], a[104:107], a[40:43], v[168:171]
v_mfma_f32_16x16x32_bf16 v[168:171], a[108:111], a[44:47], v[168:171]
ds_read_b128 a[148:151], v5 offset:19456
v_mfma_f32_16x16x32_bf16 v[144:147], a[108:111], a[36:39], v[144:147]
v_mfma_f32_16x16x32_bf16 v[144:147], a[104:107], a[32:35], v[144:147]
buffer_load_dwordx4 a[8:11], v2, s[40:43], s35 offen offset:1024 sc1
v_mfma_f32_16x16x32_bf16 v[148:151], a[112:115], a[32:35], v[148:151]
v_mfma_f32_16x16x32_bf16 v[148:151], a[116:119], a[36:39], v[148:151]
v_mfma_f32_16x16x32_bf16 v[172:175], a[116:119], a[44:47], v[172:175]
v_mfma_f32_16x16x32_bf16 v[172:175], a[112:115], a[40:43], v[172:175]
v_mfma_f32_16x16x32_bf16 v[196:199], a[112:115], a[48:51], v[196:199]
buffer_load_dwordx4 a[12:15], v2, s[40:43], s33 offen offset:1024 sc1
v_mfma_f32_16x16x32_bf16 v[196:199], a[116:119], a[52:55], v[196:199]
v_mfma_f32_16x16x32_bf16 v[220:223], a[116:119], a[60:63], v[220:223]
v_mfma_f32_16x16x32_bf16 v[220:223], a[112:115], a[56:59], v[220:223]
s_waitcnt lgkmcnt(0)
v_mfma_f32_16x16x32_bf16 v[224:227], a[128:131], a[56:59], v[224:227]
ds_read_b128 a[96:99], v5 offset:26624
v_mfma_f32_16x16x32_bf16 v[224:227], a[132:135], a[60:63], v[224:227]
buffer_load_dwordx4 a[16:19], v2, s[40:43], s35 offen offset:2048 sc1
v_mfma_f32_16x16x32_bf16 v[200:203], a[132:135], a[52:55], v[200:203]
ds_read_b128 a[100:103], v5 offset:32768
v_mfma_f32_16x16x32_bf16 v[200:203], a[128:131], a[48:51], v[200:203]
v_mfma_f32_16x16x32_bf16 v[176:179], a[128:131], a[40:43], v[176:179]
v_mfma_f32_16x16x32_bf16 v[176:179], a[132:135], a[44:47], v[176:179]
buffer_load_dwordx4 v1, s[4:7], s44 offen offset:1024 sc1 lds
s_add_u32 m0, s18, 0x20000
v_mfma_f32_16x16x32_bf16 v[152:155], a[132:135], a[36:39], v[152:155]
s_add_u32 s44, s50, 0x2020000
ds_read_b128 a[104:107], v5 offset:27648
v_mfma_f32_16x16x32_bf16 v[152:155], a[128:131], a[32:35], v[152:155]
v_mfma_f32_16x16x32_bf16 v[132:135], a[136:139], a[32:35], v[132:135]
ds_read_b128 a[108:111], v5 offset:33792
v_mfma_f32_16x16x32_bf16 v[132:135], a[140:143], a[36:39], v[132:135]
buffer_load_dwordx4 a[20:23], v2, s[40:43], s33 offen offset:2048 sc1
v_mfma_f32_16x16x32_bf16 v[156:159], a[140:143], a[44:47], v[156:159]
ds_read_b128 a[112:115], v5 offset:28672
v_mfma_f32_16x16x32_bf16 v[156:159], a[136:139], a[40:43], v[156:159]
v_mfma_f32_16x16x32_bf16 v[180:183], a[136:139], a[48:51], v[180:183]
v_mfma_f32_16x16x32_bf16 v[180:183], a[140:143], a[52:55], v[180:183]
buffer_load_dwordx4 a[24:27], v2, s[40:43], s35 offen offset:3072 sc1
v_mfma_f32_16x16x32_bf16 v[204:207], a[140:143], a[60:63], v[204:207]
ds_read_b128 a[116:119], v5 offset:34816
v_mfma_f32_16x16x32_bf16 v[204:207], a[136:139], a[56:59], v[204:207]
v_mfma_f32_16x16x32_bf16 v[208:211], a[144:147], a[56:59], v[208:211]
v_mfma_f32_16x16x32_bf16 v[208:211], a[148:151], a[60:63], v[208:211]
buffer_load_dwordx4 v1, s[4:7], s44 offen offset:0 sc1 lds
v_mfma_f32_16x16x32_bf16 v[184:187], a[148:151], a[52:55], v[184:187]
v_mfma_f32_16x16x32_bf16 v[184:187], a[144:147], a[48:51], v[184:187]
v_mfma_f32_16x16x32_bf16 v[160:163], a[144:147], a[40:43], v[160:163]
v_mfma_f32_16x16x32_bf16 v[160:163], a[148:151], a[44:47], v[160:163]
buffer_load_dwordx4 a[28:31], v2, s[40:43], s33 offen offset:3072 sc1
s_add_u32 s35, s35, 0x4000
v_mfma_f32_16x16x32_bf16 v[136:139], a[148:151], a[36:39], v[136:139]
s_add_u32 s33, s33, 0x4000
v_mfma_f32_16x16x32_bf16 v[136:139], a[144:147], a[32:35], v[136:139]
s_waitcnt vmcnt(11) lgkmcnt(0)
v_mfma_f32_16x16x32_bf16 v[140:143], a[96:99], a[64:67], v[140:143]
ds_read_b128 a[128:131], v5 offset:29696
v_mfma_f32_16x16x32_bf16 v[140:143], a[100:103], a[68:71], v[140:143]
buffer_load_dwordx4 a[32:35], v2, s[40:43], s35 offen offset:0 sc1
v_mfma_f32_16x16x32_bf16 v[164:167], a[100:103], a[76:79], v[164:167]
ds_read_b128 a[132:135], v5 offset:35840
v_mfma_f32_16x16x32_bf16 v[164:167], a[96:99], a[72:75], v[164:167]
v_mfma_f32_16x16x32_bf16 v[188:191], a[96:99], a[80:83], v[188:191]
v_mfma_f32_16x16x32_bf16 v[188:191], a[100:103], a[84:87], v[188:191]
buffer_load_dwordx4 a[36:39], v2, s[40:43], s33 offen offset:0 sc1
v_mfma_f32_16x16x32_bf16 v[212:215], a[100:103], a[92:95], v[212:215]
ds_read_b128 a[136:139], v5 offset:24576
v_mfma_f32_16x16x32_bf16 v[212:215], a[96:99], a[88:91], v[212:215]
v_mfma_f32_16x16x32_bf16 v[216:219], a[104:107], a[88:91], v[216:219]
ds_read_b128 a[140:143], v5 offset:30720
v_mfma_f32_16x16x32_bf16 v[216:219], a[108:111], a[92:95], v[216:219]
v_mfma_f32_16x16x32_bf16 v[192:195], a[108:111], a[84:87], v[192:195]
buffer_load_dwordx4 v1, s[4:7], s44 offen offset:1024 sc1 lds
s_add_u32 m0, s18, 0x22000
v_mfma_f32_16x16x32_bf16 v[192:195], a[104:107], a[80:83], v[192:195]
s_add_u32 s44, s50, 0x2022000
ds_read_b128 a[144:147], v5 offset:25600
v_mfma_f32_16x16x32_bf16 v[168:171], a[104:107], a[72:75], v[168:171]
v_mfma_f32_16x16x32_bf16 v[168:171], a[108:111], a[76:79], v[168:171]
ds_read_b128 a[148:151], v5 offset:31744
v_mfma_f32_16x16x32_bf16 v[144:147], a[108:111], a[68:71], v[144:147]
v_mfma_f32_16x16x32_bf16 v[144:147], a[104:107], a[64:67], v[144:147]
buffer_load_dwordx4 a[40:43], v2, s[40:43], s35 offen offset:1024 sc1
v_mfma_f32_16x16x32_bf16 v[148:151], a[112:115], a[64:67], v[148:151]
v_mfma_f32_16x16x32_bf16 v[148:151], a[116:119], a[68:71], v[148:151]
v_mfma_f32_16x16x32_bf16 v[172:175], a[116:119], a[76:79], v[172:175]
v_mfma_f32_16x16x32_bf16 v[172:175], a[112:115], a[72:75], v[172:175]
v_mfma_f32_16x16x32_bf16 v[196:199], a[112:115], a[80:83], v[196:199]
buffer_load_dwordx4 a[44:47], v2, s[40:43], s33 offen offset:1024 sc1
v_mfma_f32_16x16x32_bf16 v[196:199], a[116:119], a[84:87], v[196:199]
v_mfma_f32_16x16x32_bf16 v[220:223], a[116:119], a[92:95], v[220:223]
v_mfma_f32_16x16x32_bf16 v[220:223], a[112:115], a[88:91], v[220:223]
s_waitcnt lgkmcnt(0)
v_mfma_f32_16x16x32_bf16 v[224:227], a[128:131], a[88:91], v[224:227]
ds_read_b128 a[96:99], v5 offset:38912
v_mfma_f32_16x16x32_bf16 v[224:227], a[132:135], a[92:95], v[224:227]
buffer_load_dwordx4 a[48:51], v2, s[40:43], s35 offen offset:2048 sc1
v_mfma_f32_16x16x32_bf16 v[200:203], a[132:135], a[84:87], v[200:203]
ds_read_b128 a[100:103], v5 offset:45056
v_mfma_f32_16x16x32_bf16 v[200:203], a[128:131], a[80:83], v[200:203]
v_mfma_f32_16x16x32_bf16 v[176:179], a[128:131], a[72:75], v[176:179]
v_mfma_f32_16x16x32_bf16 v[176:179], a[132:135], a[76:79], v[176:179]
buffer_load_dwordx4 a[52:55], v2, s[40:43], s33 offen offset:2048 sc1
v_mfma_f32_16x16x32_bf16 v[152:155], a[132:135], a[68:71], v[152:155]
ds_read_b128 a[104:107], v5 offset:39936
v_mfma_f32_16x16x32_bf16 v[152:155], a[128:131], a[64:67], v[152:155]
v_mfma_f32_16x16x32_bf16 v[132:135], a[136:139], a[64:67], v[132:135]
ds_read_b128 a[108:111], v5 offset:46080
v_mfma_f32_16x16x32_bf16 v[132:135], a[140:143], a[68:71], v[132:135]
v_mfma_f32_16x16x32_bf16 v[156:159], a[140:143], a[76:79], v[156:159]
buffer_load_dwordx4 v1, s[4:7], s44 offen offset:0 sc1 lds
v_mfma_f32_16x16x32_bf16 v[156:159], a[136:139], a[72:75], v[156:159]
ds_read_b128 a[112:115], v5 offset:40960
v_mfma_f32_16x16x32_bf16 v[180:183], a[136:139], a[80:83], v[180:183]
v_mfma_f32_16x16x32_bf16 v[180:183], a[140:143], a[84:87], v[180:183]
ds_read_b128 a[116:119], v5 offset:47104
v_mfma_f32_16x16x32_bf16 v[204:207], a[140:143], a[92:95], v[204:207]
v_mfma_f32_16x16x32_bf16 v[204:207], a[136:139], a[88:91], v[204:207]
buffer_load_dwordx4 a[56:59], v2, s[40:43], s35 offen offset:3072 sc1
v_mfma_f32_16x16x32_bf16 v[208:211], a[144:147], a[88:91], v[208:211]
v_mfma_f32_16x16x32_bf16 v[208:211], a[148:151], a[92:95], v[208:211]
v_mfma_f32_16x16x32_bf16 v[184:187], a[148:151], a[84:87], v[184:187]
v_mfma_f32_16x16x32_bf16 v[184:187], a[144:147], a[80:83], v[184:187]
v_mfma_f32_16x16x32_bf16 v[160:163], a[144:147], a[72:75], v[160:163]
buffer_load_dwordx4 a[60:63], v2, s[40:43], s33 offen offset:3072 sc1
s_add_u32 s35, s35, 0x4000
v_mfma_f32_16x16x32_bf16 v[160:163], a[148:151], a[76:79], v[160:163]
s_add_u32 s33, s33, 0x4000
v_mfma_f32_16x16x32_bf16 v[136:139], a[148:151], a[68:71], v[136:139]
v_mfma_f32_16x16x32_bf16 v[136:139], a[144:147], a[64:67], v[136:139]
s_waitcnt vmcnt(10) lgkmcnt(0)
v_mfma_f32_16x16x32_bf16 v[140:143], a[96:99], a[0:3], v[140:143]
ds_read_b128 a[128:131], v5 offset:41984
v_mfma_f32_16x16x32_bf16 v[140:143], a[100:103], a[4:7], v[140:143]
buffer_load_dwordx4 a[64:67], v2, s[40:43], s35 offen offset:0 sc1
v_mfma_f32_16x16x32_bf16 v[164:167], a[100:103], a[12:15], v[164:167]
ds_read_b128 a[132:135], v5 offset:48128
v_mfma_f32_16x16x32_bf16 v[164:167], a[96:99], a[8:11], v[164:167]
v_mfma_f32_16x16x32_bf16 v[188:191], a[96:99], a[16:19], v[188:191]
v_mfma_f32_16x16x32_bf16 v[188:191], a[100:103], a[20:23], v[188:191]
buffer_load_dwordx4 a[68:71], v2, s[40:43], s33 offen offset:0 sc1
v_mfma_f32_16x16x32_bf16 v[212:215], a[100:103], a[28:31], v[212:215]
ds_read_b128 a[136:139], v5 offset:36864
v_mfma_f32_16x16x32_bf16 v[212:215], a[96:99], a[24:27], v[212:215]
v_mfma_f32_16x16x32_bf16 v[216:219], a[104:107], a[24:27], v[216:219]
ds_read_b128 a[140:143], v5 offset:43008
v_mfma_f32_16x16x32_bf16 v[216:219], a[108:111], a[28:31], v[216:219]
v_mfma_f32_16x16x32_bf16 v[192:195], a[108:111], a[20:23], v[192:195]
buffer_load_dwordx4 v1, s[4:7], s44 offen offset:1024 sc1 lds
s_add_u32 s88, s82, 0x340000
v_mfma_f32_16x16x32_bf16 v[192:195], a[104:107], a[16:19], v[192:195]
ds_read_b128 a[144:147], v5 offset:37888
v_mfma_f32_16x16x32_bf16 v[168:171], a[104:107], a[8:11], v[168:171]
v_mfma_f32_16x16x32_bf16 v[168:171], a[108:111], a[12:15], v[168:171]
ds_read_b128 a[148:151], v5 offset:44032
v_mfma_f32_16x16x32_bf16 v[144:147], a[108:111], a[4:7], v[144:147]
v_mfma_f32_16x16x32_bf16 v[144:147], a[104:107], a[0:3], v[144:147]
buffer_load_dwordx4 a[72:75], v2, s[40:43], s35 offen offset:1024 sc1
v_mfma_f32_16x16x32_bf16 v[148:151], a[112:115], a[0:3], v[148:151]
v_mfma_f32_16x16x32_bf16 v[148:151], a[116:119], a[4:7], v[148:151]
v_mfma_f32_16x16x32_bf16 v[172:175], a[116:119], a[12:15], v[172:175]
v_mfma_f32_16x16x32_bf16 v[172:175], a[112:115], a[8:11], v[172:175]
v_mfma_f32_16x16x32_bf16 v[196:199], a[112:115], a[16:19], v[196:199]
buffer_load_dwordx4 a[76:79], v2, s[40:43], s33 offen offset:1024 sc1
v_mfma_f32_16x16x32_bf16 v[196:199], a[116:119], a[20:23], v[196:199]
v_mfma_f32_16x16x32_bf16 v[220:223], a[116:119], a[28:31], v[220:223]
v_mfma_f32_16x16x32_bf16 v[220:223], a[112:115], a[24:27], v[220:223]
s_waitcnt lgkmcnt(0)
s_barrier
v_mfma_f32_16x16x32_bf16 v[224:227], a[128:131], a[24:27], v[224:227]
v_add_u32 v5, 49152, v1
v_mfma_f32_16x16x32_bf16 v[224:227], a[132:135], a[28:31], v[224:227]
buffer_load_dwordx4 a[80:83], v2, s[40:43], s35 offen offset:2048 sc1
v_mfma_f32_16x16x32_bf16 v[200:203], a[132:135], a[20:23], v[200:203]
ds_read_b128 a[96:99], v5 offset:2048
v_mfma_f32_16x16x32_bf16 v[200:203], a[128:131], a[16:19], v[200:203]
ds_read_b128 a[100:103], v5 offset:8192
v_mfma_f32_16x16x32_bf16 v[176:179], a[128:131], a[8:11], v[176:179]
v_mfma_f32_16x16x32_bf16 v[176:179], a[132:135], a[12:15], v[176:179]
buffer_load_dwordx4 a[84:87], v2, s[40:43], s33 offen offset:2048 sc1
v_mfma_f32_16x16x32_bf16 v[152:155], a[132:135], a[4:7], v[152:155]
ds_read_b128 a[104:107], v5 offset:3072
v_mfma_f32_16x16x32_bf16 v[152:155], a[128:131], a[0:3], v[152:155]
v_mfma_f32_16x16x32_bf16 v[132:135], a[136:139], a[0:3], v[132:135]
ds_read_b128 a[108:111], v5 offset:9216
v_mfma_f32_16x16x32_bf16 v[132:135], a[140:143], a[4:7], v[132:135]
v_mfma_f32_16x16x32_bf16 v[156:159], a[140:143], a[12:15], v[156:159]
buffer_load_dwordx4 v[92:95], v1, s[4:7], s88 offen offset:0 sc1
v_mfma_f32_16x16x32_bf16 v[156:159], a[136:139], a[8:11], v[156:159]
ds_read_b128 a[112:115], v5 offset:4096
v_mfma_f32_16x16x32_bf16 v[180:183], a[136:139], a[16:19], v[180:183]
v_mfma_f32_16x16x32_bf16 v[180:183], a[140:143], a[20:23], v[180:183]
ds_read_b128 a[116:119], v5 offset:10240
v_mfma_f32_16x16x32_bf16 v[204:207], a[140:143], a[28:31], v[204:207]
v_mfma_f32_16x16x32_bf16 v[204:207], a[136:139], a[24:27], v[204:207]
buffer_load_dwordx4 a[88:91], v2, s[40:43], s35 offen offset:3072 sc1
v_mfma_f32_16x16x32_bf16 v[208:211], a[144:147], a[24:27], v[208:211]
v_mfma_f32_16x16x32_bf16 v[208:211], a[148:151], a[28:31], v[208:211]
v_mfma_f32_16x16x32_bf16 v[184:187], a[148:151], a[20:23], v[184:187]
v_mfma_f32_16x16x32_bf16 v[184:187], a[144:147], a[16:19], v[184:187]
v_mfma_f32_16x16x32_bf16 v[160:163], a[144:147], a[8:11], v[160:163]
buffer_load_dwordx4 a[92:95], v2, s[40:43], s33 offen offset:3072 sc1
s_add_u32 s35, s35, 0x4000
v_mfma_f32_16x16x32_bf16 v[160:163], a[148:151], a[12:15], v[160:163]
s_add_u32 s33, s33, 0x4000
v_mfma_f32_16x16x32_bf16 v[136:139], a[148:151], a[4:7], v[136:139]
v_mfma_f32_16x16x32_bf16 v[136:139], a[144:147], a[0:3], v[136:139]
s_waitcnt vmcnt(10) lgkmcnt(0)
v_mfma_f32_16x16x32_bf16 v[140:143], a[96:99], a[32:35], v[140:143]
ds_read_b128 a[128:131], v5 offset:5120
v_mfma_f32_16x16x32_bf16 v[140:143], a[100:103], a[36:39], v[140:143]
buffer_load_dwordx4 a[0:3], v2, s[40:43], s35 offen offset:0 sc1
v_mfma_f32_16x16x32_bf16 v[164:167], a[100:103], a[44:47], v[164:167]
ds_read_b128 a[132:135], v5 offset:11264
v_mfma_f32_16x16x32_bf16 v[164:167], a[96:99], a[40:43], v[164:167]
v_mfma_f32_16x16x32_bf16 v[188:191], a[96:99], a[48:51], v[188:191]
v_mfma_f32_16x16x32_bf16 v[188:191], a[100:103], a[52:55], v[188:191]
buffer_load_dwordx4 a[4:7], v2, s[40:43], s33 offen offset:0 sc1
v_mfma_f32_16x16x32_bf16 v[212:215], a[100:103], a[60:63], v[212:215]
ds_read_b128 a[136:139], v5 offset:0
v_mfma_f32_16x16x32_bf16 v[212:215], a[96:99], a[56:59], v[212:215]
v_mfma_f32_16x16x32_bf16 v[216:219], a[104:107], a[56:59], v[216:219]
ds_read_b128 a[140:143], v5 offset:6144
v_mfma_f32_16x16x32_bf16 v[216:219], a[108:111], a[60:63], v[216:219]
v_mfma_f32_16x16x32_bf16 v[192:195], a[108:111], a[52:55], v[192:195]
buffer_load_dwordx4 v[96:99], v1, s[4:7], s88 offen offset:1024 sc1
v_mfma_f32_16x16x32_bf16 v[192:195], a[104:107], a[48:51], v[192:195]
ds_read_b128 a[144:147], v5 offset:1024
v_mfma_f32_16x16x32_bf16 v[168:171], a[104:107], a[40:43], v[168:171]
v_mfma_f32_16x16x32_bf16 v[168:171], a[108:111], a[44:47], v[168:171]
ds_read_b128 a[148:151], v5 offset:7168
v_mfma_f32_16x16x32_bf16 v[144:147], a[108:111], a[36:39], v[144:147]
v_mfma_f32_16x16x32_bf16 v[144:147], a[104:107], a[32:35], v[144:147]
buffer_load_dwordx4 a[8:11], v2, s[40:43], s35 offen offset:1024 sc1
v_mfma_f32_16x16x32_bf16 v[148:151], a[112:115], a[32:35], v[148:151]
v_mfma_f32_16x16x32_bf16 v[148:151], a[116:119], a[36:39], v[148:151]
v_mfma_f32_16x16x32_bf16 v[172:175], a[116:119], a[44:47], v[172:175]
v_mfma_f32_16x16x32_bf16 v[172:175], a[112:115], a[40:43], v[172:175]
v_mfma_f32_16x16x32_bf16 v[196:199], a[112:115], a[48:51], v[196:199]
buffer_load_dwordx4 a[12:15], v2, s[40:43], s33 offen offset:1024 sc1
v_mfma_f32_16x16x32_bf16 v[196:199], a[116:119], a[52:55], v[196:199]
v_mfma_f32_16x16x32_bf16 v[220:223], a[116:119], a[60:63], v[220:223]
v_mfma_f32_16x16x32_bf16 v[220:223], a[112:115], a[56:59], v[220:223]
s_waitcnt lgkmcnt(0)
v_mfma_f32_16x16x32_bf16 v[224:227], a[128:131], a[56:59], v[224:227]
ds_read_b128 a[96:99], v5 offset:14336
v_mfma_f32_16x16x32_bf16 v[224:227], a[132:135], a[60:63], v[224:227]
buffer_load_dwordx4 a[16:19], v2, s[40:43], s35 offen offset:2048 sc1
v_mfma_f32_16x16x32_bf16 v[200:203], a[132:135], a[52:55], v[200:203]
ds_read_b128 a[100:103], v5 offset:20480
v_mfma_f32_16x16x32_bf16 v[200:203], a[128:131], a[48:51], v[200:203]
v_mfma_f32_16x16x32_bf16 v[176:179], a[128:131], a[40:43], v[176:179]
v_mfma_f32_16x16x32_bf16 v[176:179], a[132:135], a[44:47], v[176:179]
buffer_load_dwordx4 v[100:103], v1, s[4:7], s88 offen offset:2048 sc1
v_mfma_f32_16x16x32_bf16 v[152:155], a[132:135], a[36:39], v[152:155]
ds_read_b128 a[104:107], v5 offset:15360
v_mfma_f32_16x16x32_bf16 v[152:155], a[128:131], a[32:35], v[152:155]
v_mfma_f32_16x16x32_bf16 v[132:135], a[136:139], a[32:35], v[132:135]
ds_read_b128 a[108:111], v5 offset:21504
v_mfma_f32_16x16x32_bf16 v[132:135], a[140:143], a[36:39], v[132:135]
buffer_load_dwordx4 a[20:23], v2, s[40:43], s33 offen offset:2048 sc1
v_mfma_f32_16x16x32_bf16 v[156:159], a[140:143], a[44:47], v[156:159]
ds_read_b128 a[112:115], v5 offset:16384
v_mfma_f32_16x16x32_bf16 v[156:159], a[136:139], a[40:43], v[156:159]
v_mfma_f32_16x16x32_bf16 v[180:183], a[136:139], a[48:51], v[180:183]
v_mfma_f32_16x16x32_bf16 v[180:183], a[140:143], a[52:55], v[180:183]
buffer_load_dwordx4 a[24:27], v2, s[40:43], s35 offen offset:3072 sc1
v_mfma_f32_16x16x32_bf16 v[204:207], a[140:143], a[60:63], v[204:207]
ds_read_b128 a[116:119], v5 offset:22528
v_mfma_f32_16x16x32_bf16 v[204:207], a[136:139], a[56:59], v[204:207]
v_mfma_f32_16x16x32_bf16 v[208:211], a[144:147], a[56:59], v[208:211]
v_mfma_f32_16x16x32_bf16 v[208:211], a[148:151], a[60:63], v[208:211]
buffer_load_dwordx4 v[104:107], v1, s[4:7], s88 offen offset:3072 sc1
s_add_u32 s88, s88, 4096
v_mfma_f32_16x16x32_bf16 v[184:187], a[148:151], a[52:55], v[184:187]
v_mfma_f32_16x16x32_bf16 v[184:187], a[144:147], a[48:51], v[184:187]
v_mfma_f32_16x16x32_bf16 v[160:163], a[144:147], a[40:43], v[160:163]
v_mfma_f32_16x16x32_bf16 v[160:163], a[148:151], a[44:47], v[160:163]
buffer_load_dwordx4 a[28:31], v2, s[40:43], s33 offen offset:3072 sc1
s_add_u32 s35, s35, 0x4000
v_mfma_f32_16x16x32_bf16 v[136:139], a[148:151], a[36:39], v[136:139]
s_add_u32 s33, s33, 0x4000
v_mfma_f32_16x16x32_bf16 v[136:139], a[144:147], a[32:35], v[136:139]
s_waitcnt vmcnt(11) lgkmcnt(0)
v_mfma_f32_16x16x32_bf16 v[140:143], a[96:99], a[64:67], v[140:143]
ds_read_b128 a[128:131], v5 offset:17408
v_mfma_f32_16x16x32_bf16 v[140:143], a[100:103], a[68:71], v[140:143]
buffer_load_dwordx4 a[32:35], v2, s[40:43], s35 offen offset:0 sc1
v_mfma_f32_16x16x32_bf16 v[164:167], a[100:103], a[76:79], v[164:167]
ds_read_b128 a[132:135], v5 offset:23552
v_mfma_f32_16x16x32_bf16 v[164:167], a[96:99], a[72:75], v[164:167]
v_mfma_f32_16x16x32_bf16 v[188:191], a[96:99], a[80:83], v[188:191]
v_mfma_f32_16x16x32_bf16 v[188:191], a[100:103], a[84:87], v[188:191]
buffer_load_dwordx4 a[36:39], v2, s[40:43], s33 offen offset:0 sc1
v_mfma_f32_16x16x32_bf16 v[212:215], a[100:103], a[92:95], v[212:215]
ds_read_b128 a[136:139], v5 offset:12288
v_mfma_f32_16x16x32_bf16 v[212:215], a[96:99], a[88:91], v[212:215]
v_mfma_f32_16x16x32_bf16 v[216:219], a[104:107], a[88:91], v[216:219]
ds_read_b128 a[140:143], v5 offset:18432
v_mfma_f32_16x16x32_bf16 v[216:219], a[108:111], a[92:95], v[216:219]
v_mfma_f32_16x16x32_bf16 v[192:195], a[108:111], a[84:87], v[192:195]
buffer_load_dwordx4 v[108:111], v1, s[4:7], s88 offen offset:0 sc1
v_mfma_f32_16x16x32_bf16 v[192:195], a[104:107], a[80:83], v[192:195]
ds_read_b128 a[144:147], v5 offset:13312
v_mfma_f32_16x16x32_bf16 v[168:171], a[104:107], a[72:75], v[168:171]
v_mfma_f32_16x16x32_bf16 v[168:171], a[108:111], a[76:79], v[168:171]
ds_read_b128 a[148:151], v5 offset:19456
v_mfma_f32_16x16x32_bf16 v[144:147], a[108:111], a[68:71], v[144:147]
v_mfma_f32_16x16x32_bf16 v[144:147], a[104:107], a[64:67], v[144:147]
buffer_load_dwordx4 a[40:43], v2, s[40:43], s35 offen offset:1024 sc1
v_mfma_f32_16x16x32_bf16 v[148:151], a[112:115], a[64:67], v[148:151]
v_mfma_f32_16x16x32_bf16 v[148:151], a[116:119], a[68:71], v[148:151]
v_mfma_f32_16x16x32_bf16 v[172:175], a[116:119], a[76:79], v[172:175]
v_mfma_f32_16x16x32_bf16 v[172:175], a[112:115], a[72:75], v[172:175]
v_mfma_f32_16x16x32_bf16 v[196:199], a[112:115], a[80:83], v[196:199]
buffer_load_dwordx4 a[44:47], v2, s[40:43], s33 offen offset:1024 sc1
v_mfma_f32_16x16x32_bf16 v[196:199], a[116:119], a[84:87], v[196:199]
v_mfma_f32_16x16x32_bf16 v[220:223], a[116:119], a[92:95], v[220:223]
v_mfma_f32_16x16x32_bf16 v[220:223], a[112:115], a[88:91], v[220:223]
s_waitcnt lgkmcnt(0)
v_mfma_f32_16x16x32_bf16 v[224:227], a[128:131], a[88:91], v[224:227]
ds_read_b128 a[96:99], v5 offset:26624
v_mfma_f32_16x16x32_bf16 v[224:227], a[132:135], a[92:95], v[224:227]
buffer_load_dwordx4 a[48:51], v2, s[40:43], s35 offen offset:2048 sc1
v_mfma_f32_16x16x32_bf16 v[200:203], a[132:135], a[84:87], v[200:203]
ds_read_b128 a[100:103], v5 offset:32768
v_mfma_f32_16x16x32_bf16 v[200:203], a[128:131], a[80:83], v[200:203]
v_mfma_f32_16x16x32_bf16 v[176:179], a[128:131], a[72:75], v[176:179]
v_mfma_f32_16x16x32_bf16 v[176:179], a[132:135], a[76:79], v[176:179]
buffer_load_dwordx4 a[52:55], v2, s[40:43], s33 offen offset:2048 sc1
v_mfma_f32_16x16x32_bf16 v[152:155], a[132:135], a[68:71], v[152:155]
ds_read_b128 a[104:107], v5 offset:27648
v_mfma_f32_16x16x32_bf16 v[152:155], a[128:131], a[64:67], v[152:155]
v_mfma_f32_16x16x32_bf16 v[132:135], a[136:139], a[64:67], v[132:135]
ds_read_b128 a[108:111], v5 offset:33792
v_mfma_f32_16x16x32_bf16 v[132:135], a[140:143], a[68:71], v[132:135]
v_mfma_f32_16x16x32_bf16 v[156:159], a[140:143], a[76:79], v[156:159]
buffer_load_dwordx4 v[112:115], v1, s[4:7], s88 offen offset:1024 sc1
v_mfma_f32_16x16x32_bf16 v[156:159], a[136:139], a[72:75], v[156:159]
ds_read_b128 a[112:115], v5 offset:28672
v_mfma_f32_16x16x32_bf16 v[180:183], a[136:139], a[80:83], v[180:183]
v_mfma_f32_16x16x32_bf16 v[180:183], a[140:143], a[84:87], v[180:183]
ds_read_b128 a[116:119], v5 offset:34816
v_mfma_f32_16x16x32_bf16 v[204:207], a[140:143], a[92:95], v[204:207]
v_mfma_f32_16x16x32_bf16 v[204:207], a[136:139], a[88:91], v[204:207]
buffer_load_dwordx4 a[56:59], v2, s[40:43], s35 offen offset:3072 sc1
v_mfma_f32_16x16x32_bf16 v[208:211], a[144:147], a[88:91], v[208:211]
v_mfma_f32_16x16x32_bf16 v[208:211], a[148:151], a[92:95], v[208:211]
v_mfma_f32_16x16x32_bf16 v[184:187], a[148:151], a[84:87], v[184:187]
v_mfma_f32_16x16x32_bf16 v[184:187], a[144:147], a[80:83], v[184:187]
v_mfma_f32_16x16x32_bf16 v[160:163], a[144:147], a[72:75], v[160:163]
buffer_load_dwordx4 a[60:63], v2, s[40:43], s33 offen offset:3072 sc1
s_add_u32 s35, s35, 0x64000
v_mfma_f32_16x16x32_bf16 v[160:163], a[148:151], a[76:79], v[160:163]
s_add_u32 s33, s33, 0x64000
v_mfma_f32_16x16x32_bf16 v[136:139], a[148:151], a[68:71], v[136:139]
v_mfma_f32_16x16x32_bf16 v[136:139], a[144:147], a[64:67], v[136:139]
s_waitcnt vmcnt(10) lgkmcnt(0)
v_mfma_f32_16x16x32_bf16 v[140:143], a[96:99], a[0:3], v[140:143]
ds_read_b128 a[128:131], v5 offset:29696
v_mfma_f32_16x16x32_bf16 v[140:143], a[100:103], a[4:7], v[140:143]
buffer_load_dwordx4 a[64:67], v2, s[40:43], s35 offen offset:0 sc1
v_mfma_f32_16x16x32_bf16 v[164:167], a[100:103], a[12:15], v[164:167]
ds_read_b128 a[132:135], v5 offset:35840
v_mfma_f32_16x16x32_bf16 v[164:167], a[96:99], a[8:11], v[164:167]
v_mfma_f32_16x16x32_bf16 v[188:191], a[96:99], a[16:19], v[188:191]
v_mfma_f32_16x16x32_bf16 v[188:191], a[100:103], a[20:23], v[188:191]
buffer_load_dwordx4 a[68:71], v2, s[40:43], s33 offen offset:0 sc1
v_mfma_f32_16x16x32_bf16 v[212:215], a[100:103], a[28:31], v[212:215]
ds_read_b128 a[136:139], v5 offset:24576
v_mfma_f32_16x16x32_bf16 v[212:215], a[96:99], a[24:27], v[212:215]
v_mfma_f32_16x16x32_bf16 v[216:219], a[104:107], a[24:27], v[216:219]
ds_read_b128 a[140:143], v5 offset:30720
v_mfma_f32_16x16x32_bf16 v[216:219], a[108:111], a[28:31], v[216:219]
v_mfma_f32_16x16x32_bf16 v[192:195], a[108:111], a[20:23], v[192:195]
buffer_load_dwordx4 v[116:119], v1, s[4:7], s88 offen offset:2048 sc1
v_mfma_f32_16x16x32_bf16 v[192:195], a[104:107], a[16:19], v[192:195]
ds_read_b128 a[144:147], v5 offset:25600
v_mfma_f32_16x16x32_bf16 v[168:171], a[104:107], a[8:11], v[168:171]
v_mfma_f32_16x16x32_bf16 v[168:171], a[108:111], a[12:15], v[168:171]
ds_read_b128 a[148:151], v5 offset:31744
v_mfma_f32_16x16x32_bf16 v[144:147], a[108:111], a[4:7], v[144:147]
v_mfma_f32_16x16x32_bf16 v[144:147], a[104:107], a[0:3], v[144:147]
buffer_load_dwordx4 a[72:75], v2, s[40:43], s35 offen offset:1024 sc1
v_mfma_f32_16x16x32_bf16 v[148:151], a[112:115], a[0:3], v[148:151]
v_mfma_f32_16x16x32_bf16 v[148:151], a[116:119], a[4:7], v[148:151]
L_stub11:
s_cbranch_execz L_wret4
v_mfma_f32_16x16x32_bf16 v[172:175], a[116:119], a[12:15], v[172:175]
v_mfma_f32_16x16x32_bf16 v[172:175], a[112:115], a[8:11], v[172:175]
v_mfma_f32_16x16x32_bf16 v[196:199], a[112:115], a[16:19], v[196:199]
buffer_load_dwordx4 a[76:79], v2, s[40:43], s33 offen offset:1024 sc1
v_mfma_f32_16x16x32_bf16 v[196:199], a[116:119], a[20:23], v[196:199]
v_mfma_f32_16x16x32_bf16 v[220:223], a[116:119], a[28:31], v[220:223]
v_mfma_f32_16x16x32_bf16 v[220:223], a[112:115], a[24:27], v[220:223]
s_waitcnt lgkmcnt(0)
v_mfma_f32_16x16x32_bf16 v[224:227], a[128:131], a[24:27], v[224:227]
ds_read_b128 a[96:99], v5 offset:38912
v_mfma_f32_16x16x32_bf16 v[224:227], a[132:135], a[28:31], v[224:227]
buffer_load_dwordx4 a[80:83], v2, s[40:43], s35 offen offset:2048 sc1
v_mfma_f32_16x16x32_bf16 v[200:203], a[132:135], a[20:23], v[200:203]
ds_read_b128 a[100:103], v5 offset:45056
v_mfma_f32_16x16x32_bf16 v[200:203], a[128:131], a[16:19], v[200:203]
v_mfma_f32_16x16x32_bf16 v[176:179], a[128:131], a[8:11], v[176:179]
v_mfma_f32_16x16x32_bf16 v[176:179], a[132:135], a[12:15], v[176:179]
buffer_load_dwordx4 a[84:87], v2, s[40:43], s33 offen offset:2048 sc1
v_mfma_f32_16x16x32_bf16 v[152:155], a[132:135], a[4:7], v[152:155]
ds_read_b128 a[104:107], v5 offset:39936
v_mfma_f32_16x16x32_bf16 v[152:155], a[128:131], a[0:3], v[152:155]
v_mfma_f32_16x16x32_bf16 v[132:135], a[136:139], a[0:3], v[132:135]
ds_read_b128 a[108:111], v5 offset:46080
v_mfma_f32_16x16x32_bf16 v[132:135], a[140:143], a[4:7], v[132:135]
v_mfma_f32_16x16x32_bf16 v[156:159], a[140:143], a[12:15], v[156:159]
buffer_load_dwordx4 v[120:123], v1, s[4:7], s88 offen offset:3072 sc1
s_add_u32 m0, s18, 0x0
v_mfma_f32_16x16x32_bf16 v[156:159], a[136:139], a[8:11], v[156:159]
s_add_u32 s44, s50, 0x2024000
ds_read_b128 a[112:115], v5 offset:40960
v_mfma_f32_16x16x32_bf16 v[180:183], a[136:139], a[16:19], v[180:183]
v_mfma_f32_16x16x32_bf16 v[180:183], a[140:143], a[20:23], v[180:183]
ds_read_b128 a[116:119], v5 offset:47104
v_mfma_f32_16x16x32_bf16 v[204:207], a[140:143], a[28:31], v[204:207]
v_mfma_f32_16x16x32_bf16 v[204:207], a[136:139], a[24:27], v[204:207]
buffer_load_dwordx4 a[88:91], v2, s[40:43], s35 offen offset:3072 sc1
v_mfma_f32_16x16x32_bf16 v[208:211], a[144:147], a[24:27], v[208:211]
v_mfma_f32_16x16x32_bf16 v[208:211], a[148:151], a[28:31], v[208:211]
v_mfma_f32_16x16x32_bf16 v[184:187], a[148:151], a[20:23], v[184:187]
v_mfma_f32_16x16x32_bf16 v[184:187], a[144:147], a[16:19], v[184:187]
v_mfma_f32_16x16x32_bf16 v[160:163], a[144:147], a[8:11], v[160:163]
buffer_load_dwordx4 a[92:95], v2, s[40:43], s33 offen offset:3072 sc1
s_add_u32 s35, s35, 0x4000
v_mfma_f32_16x16x32_bf16 v[160:163], a[148:151], a[12:15], v[160:163]
s_add_u32 s33, s33, 0x4000
v_mfma_f32_16x16x32_bf16 v[136:139], a[148:151], a[4:7], v[136:139]
v_mfma_f32_16x16x32_bf16 v[136:139], a[144:147], a[0:3], v[136:139]
s_waitcnt vmcnt(10) lgkmcnt(0)
v_mfma_f32_16x16x32_bf16 v[140:143], a[96:99], a[32:35], v[140:143]
ds_read_b128 a[128:131], v5 offset:41984
v_mfma_f32_16x16x32_bf16 v[140:143], a[100:103], a[36:39], v[140:143]
buffer_load_dwordx4 a[0:3], v2, s[40:43], s35 offen offset:0 sc1
v_mfma_f32_16x16x32_bf16 v[164:167], a[100:103], a[44:47], v[164:167]
ds_read_b128 a[132:135], v5 offset:48128
v_mfma_f32_16x16x32_bf16 v[164:167], a[96:99], a[40:43], v[164:167]
v_mfma_f32_16x16x32_bf16 v[188:191], a[96:99], a[48:51], v[188:191]
v_mfma_f32_16x16x32_bf16 v[188:191], a[100:103], a[52:55], v[188:191]
buffer_load_dwordx4 v1, s[4:7], s44 offen offset:0 sc1 lds
v_mfma_f32_16x16x32_bf16 v[212:215], a[100:103], a[60:63], v[212:215]
ds_read_b128 a[136:139], v5 offset:36864
v_mfma_f32_16x16x32_bf16 v[212:215], a[96:99], a[56:59], v[212:215]
v_mfma_f32_16x16x32_bf16 v[216:219], a[104:107], a[56:59], v[216:219]
ds_read_b128 a[140:143], v5 offset:43008
v_mfma_f32_16x16x32_bf16 v[216:219], a[108:111], a[60:63], v[216:219]
buffer_load_dwordx4 a[4:7], v2, s[40:43], s33 offen offset:0 sc1
v_mfma_f32_16x16x32_bf16 v[192:195], a[108:111], a[52:55], v[192:195]
ds_read_b128 a[144:147], v5 offset:37888
v_mfma_f32_16x16x32_bf16 v[192:195], a[104:107], a[48:51], v[192:195]
v_mfma_f32_16x16x32_bf16 v[168:171], a[104:107], a[40:43], v[168:171]
v_mfma_f32_16x16x32_bf16 v[168:171], a[108:111], a[44:47], v[168:171]
buffer_load_dwordx4 a[8:11], v2, s[40:43], s35 offen offset:1024 sc1
v_mfma_f32_16x16x32_bf16 v[144:147], a[108:111], a[36:39], v[144:147]
ds_read_b128 a[148:151], v5 offset:44032
v_mfma_f32_16x16x32_bf16 v[144:147], a[104:107], a[32:35], v[144:147]
v_mfma_f32_16x16x32_bf16 v[148:151], a[112:115], a[32:35], v[148:151]
v_mfma_f32_16x16x32_bf16 v[148:151], a[116:119], a[36:39], v[148:151]
buffer_load_dwordx4 v1, s[4:7], s44 offen offset:1024 sc1 lds
s_add_u32 m0, s18, 0x2000
v_mfma_f32_16x16x32_bf16 v[172:175], a[116:119], a[44:47], v[172:175]
s_add_u32 s44, s50, 0x2026000
v_mfma_f32_16x16x32_bf16 v[172:175], a[112:115], a[40:43], v[172:175]
v_mfma_f32_16x16x32_bf16 v[196:199], a[112:115], a[48:51], v[196:199]
v_mfma_f32_16x16x32_bf16 v[196:199], a[116:119], a[52:55], v[196:199]
buffer_load_dwordx4 a[12:15], v2, s[40:43], s33 offen offset:1024 sc1
v_mfma_f32_16x16x32_bf16 v[220:223], a[116:119], a[60:63], v[220:223]
v_mfma_f32_16x16x32_bf16 v[220:223], a[112:115], a[56:59], v[220:223]
s_waitcnt lgkmcnt(0)
s_barrier
v_mfma_f32_16x16x32_bf16 v[224:227], a[128:131], a[56:59], v[224:227]
v_add_u32 v5, 98304, v1
v_mfma_f32_16x16x32_bf16 v[224:227], a[132:135], a[60:63], v[224:227]
buffer_load_dwordx4 a[16:19], v2, s[40:43], s35 offen offset:2048 sc1
v_mfma_f32_16x16x32_bf16 v[200:203], a[132:135], a[52:55], v[200:203]
ds_read_b128 a[96:99], v5 offset:2048
v_mfma_f32_16x16x32_bf16 v[200:203], a[128:131], a[48:51], v[200:203]
ds_read_b128 a[100:103], v5 offset:8192
v_mfma_f32_16x16x32_bf16 v[176:179], a[128:131], a[40:43], v[176:179]
v_mfma_f32_16x16x32_bf16 v[176:179], a[132:135], a[44:47], v[176:179]
buffer_load_dwordx4 a[20:23], v2, s[40:43], s33 offen offset:2048 sc1
v_mfma_f32_16x16x32_bf16 v[152:155], a[132:135], a[36:39], v[152:155]
ds_read_b128 a[104:107], v5 offset:3072
v_mfma_f32_16x16x32_bf16 v[152:155], a[128:131], a[32:35], v[152:155]
v_mfma_f32_16x16x32_bf16 v[132:135], a[136:139], a[32:35], v[132:135]
ds_read_b128 a[108:111], v5 offset:9216
v_mfma_f32_16x16x32_bf16 v[132:135], a[140:143], a[36:39], v[132:135]
v_mfma_f32_16x16x32_bf16 v[156:159], a[140:143], a[44:47], v[156:159]
buffer_load_dwordx4 v1, s[4:7], s44 offen offset:0 sc1 lds
v_mfma_f32_16x16x32_bf16 v[156:159], a[136:139], a[40:43], v[156:159]
ds_read_b128 a[112:115], v5 offset:4096
v_mfma_f32_16x16x32_bf16 v[180:183], a[136:139], a[48:51], v[180:183]
v_mfma_f32_16x16x32_bf16 v[180:183], a[140:143], a[52:55], v[180:183]
ds_read_b128 a[116:119], v5 offset:10240
v_mfma_f32_16x16x32_bf16 v[204:207], a[140:143], a[60:63], v[204:207]
v_mfma_f32_16x16x32_bf16 v[204:207], a[136:139], a[56:59], v[204:207]
buffer_load_dwordx4 a[24:27], v2, s[40:43], s35 offen offset:3072 sc1
v_mfma_f32_16x16x32_bf16 v[208:211], a[144:147], a[56:59], v[208:211]
v_mfma_f32_16x16x32_bf16 v[208:211], a[148:151], a[60:63], v[208:211]
v_mfma_f32_16x16x32_bf16 v[184:187], a[148:151], a[52:55], v[184:187]
v_mfma_f32_16x16x32_bf16 v[184:187], a[144:147], a[48:51], v[184:187]
v_mfma_f32_16x16x32_bf16 v[160:163], a[144:147], a[40:43], v[160:163]
buffer_load_dwordx4 a[28:31], v2, s[40:43], s33 offen offset:3072 sc1
s_add_u32 s35, s35, 0x4000
v_mfma_f32_16x16x32_bf16 v[160:163], a[148:151], a[44:47], v[160:163]
s_add_u32 s33, s33, 0x4000
v_mfma_f32_16x16x32_bf16 v[136:139], a[148:151], a[36:39], v[136:139]
v_mfma_f32_16x16x32_bf16 v[136:139], a[144:147], a[32:35], v[136:139]
s_waitcnt vmcnt(11) lgkmcnt(0)
v_mfma_f32_16x16x32_bf16 v[140:143], a[96:99], a[64:67], v[140:143]
ds_read_b128 a[128:131], v5 offset:5120
v_mfma_f32_16x16x32_bf16 v[140:143], a[100:103], a[68:71], v[140:143]
buffer_load_dwordx4 a[32:35], v2, s[40:43], s35 offen offset:0 sc1
v_mfma_f32_16x16x32_bf16 v[164:167], a[100:103], a[76:79], v[164:167]
ds_read_b128 a[132:135], v5 offset:11264
v_mfma_f32_16x16x32_bf16 v[164:167], a[96:99], a[72:75], v[164:167]
v_mfma_f32_16x16x32_bf16 v[188:191], a[96:99], a[80:83], v[188:191]
v_mfma_f32_16x16x32_bf16 v[188:191], a[100:103], a[84:87], v[188:191]
buffer_load_dwordx4 a[36:39], v2, s[40:43], s33 offen offset:0 sc1
v_mfma_f32_16x16x32_bf16 v[212:215], a[100:103], a[92:95], v[212:215]
ds_read_b128 a[136:139], v5 offset:0
v_mfma_f32_16x16x32_bf16 v[212:215], a[96:99], a[88:91], v[212:215]
v_mfma_f32_16x16x32_bf16 v[216:219], a[104:107], a[88:91], v[216:219]
ds_read_b128 a[140:143], v5 offset:6144
v_mfma_f32_16x16x32_bf16 v[216:219], a[108:111], a[92:95], v[216:219]
v_mfma_f32_16x16x32_bf16 v[192:195], a[108:111], a[84:87], v[192:195]
buffer_load_dwordx4 v1, s[4:7], s44 offen offset:1024 sc1 lds
s_add_u32 m0, s18, 0x4000
v_mfma_f32_16x16x32_bf16 v[192:195], a[104:107], a[80:83], v[192:195]
s_add_u32 s44, s50, 0x2028000
ds_read_b128 a[144:147], v5 offset:1024
v_mfma_f32_16x16x32_bf16 v[168:171], a[104:107], a[72:75], v[168:171]
v_mfma_f32_16x16x32_bf16 v[168:171], a[108:111], a[76:79], v[168:171]
ds_read_b128 a[148:151], v5 offset:7168
v_mfma_f32_16x16x32_bf16 v[144:147], a[108:111], a[68:71], v[144:147]
v_mfma_f32_16x16x32_bf16 v[144:147], a[104:107], a[64:67], v[144:147]
buffer_load_dwordx4 a[40:43], v2, s[40:43], s35 offen offset:1024 sc1
v_mfma_f32_16x16x32_bf16 v[148:151], a[112:115], a[64:67], v[148:151]
v_mfma_f32_16x16x32_bf16 v[148:151], a[116:119], a[68:71], v[148:151]
v_mfma_f32_16x16x32_bf16 v[172:175], a[116:119], a[76:79], v[172:175]
v_mfma_f32_16x16x32_bf16 v[172:175], a[112:115], a[72:75], v[172:175]
v_mfma_f32_16x16x32_bf16 v[196:199], a[112:115], a[80:83], v[196:199]
buffer_load_dwordx4 a[44:47], v2, s[40:43], s33 offen offset:1024 sc1
v_mfma_f32_16x16x32_bf16 v[196:199], a[116:119], a[84:87], v[196:199]
v_mfma_f32_16x16x32_bf16 v[220:223], a[116:119], a[92:95], v[220:223]
v_mfma_f32_16x16x32_bf16 v[220:223], a[112:115], a[88:91], v[220:223]
s_waitcnt lgkmcnt(0)
v_mfma_f32_16x16x32_bf16 v[224:227], a[128:131], a[88:91], v[224:227]
ds_read_b128 a[96:99], v5 offset:14336
v_mfma_f32_16x16x32_bf16 v[224:227], a[132:135], a[92:95], v[224:227]
buffer_load_dwordx4 a[48:51], v2, s[40:43], s35 offen offset:2048 sc1
v_mfma_f32_16x16x32_bf16 v[200:203], a[132:135], a[84:87], v[200:203]
ds_read_b128 a[100:103], v5 offset:20480
v_mfma_f32_16x16x32_bf16 v[200:203], a[128:131], a[80:83], v[200:203]
v_mfma_f32_16x16x32_bf16 v[176:179], a[128:131], a[72:75], v[176:179]
v_mfma_f32_16x16x32_bf16 v[176:179], a[132:135], a[76:79], v[176:179]
buffer_load_dwordx4 a[52:55], v2, s[40:43], s33 offen offset:2048 sc1
v_mfma_f32_16x16x32_bf16 v[152:155], a[132:135], a[68:71], v[152:155]
ds_read_b128 a[104:107], v5 offset:15360
v_mfma_f32_16x16x32_bf16 v[152:155], a[128:131], a[64:67], v[152:155]
v_mfma_f32_16x16x32_bf16 v[132:135], a[136:139], a[64:67], v[132:135]
ds_read_b128 a[108:111], v5 offset:21504
v_mfma_f32_16x16x32_bf16 v[132:135], a[140:143], a[68:71], v[132:135]
v_mfma_f32_16x16x32_bf16 v[156:159], a[140:143], a[76:79], v[156:159]
buffer_load_dwordx4 v1, s[4:7], s44 offen offset:0 sc1 lds
v_mfma_f32_16x16x32_bf16 v[156:159], a[136:139], a[72:75], v[156:159]
ds_read_b128 a[112:115], v5 offset:16384
v_mfma_f32_16x16x32_bf16 v[180:183], a[136:139], a[80:83], v[180:183]
v_mfma_f32_16x16x32_bf16 v[180:183], a[140:143], a[84:87], v[180:183]
ds_read_b128 a[116:119], v5 offset:22528
v_mfma_f32_16x16x32_bf16 v[204:207], a[140:143], a[92:95], v[204:207]
v_mfma_f32_16x16x32_bf16 v[204:207], a[136:139], a[88:91], v[204:207]
buffer_load_dwordx4 a[56:59], v2, s[40:43], s35 offen offset:3072 sc1
v_mfma_f32_16x16x32_bf16 v[208:211], a[144:147], a[88:91], v[208:211]
v_mfma_f32_16x16x32_bf16 v[208:211], a[148:151], a[92:95], v[208:211]
v_mfma_f32_16x16x32_bf16 v[184:187], a[148:151], a[84:87], v[184:187]
v_mfma_f32_16x16x32_bf16 v[184:187], a[144:147], a[80:83], v[184:187]
v_mfma_f32_16x16x32_bf16 v[160:163], a[144:147], a[72:75], v[160:163]
buffer_load_dwordx4 a[60:63], v2, s[40:43], s33 offen offset:3072 sc1
s_add_u32 s35, s35, 0x4000
v_mfma_f32_16x16x32_bf16 v[160:163], a[148:151], a[76:79], v[160:163]
s_add_u32 s33, s33, 0x4000
v_mfma_f32_16x16x32_bf16 v[136:139], a[148:151], a[68:71], v[136:139]
v_mfma_f32_16x16x32_bf16 v[136:139], a[144:147], a[64:67], v[136:139]
s_waitcnt vmcnt(10) lgkmcnt(0)
v_mfma_f32_16x16x32_bf16 v[140:143], a[96:99], a[0:3], v[140:143]
ds_read_b128 a[128:131], v5 offset:17408
v_add_f32 v92, v92, v96
v_mfma_f32_16x16x32_bf16 v[140:143], a[100:103], a[4:7], v[140:143]
buffer_load_dwordx4 a[64:67], v2, s[40:43], s35 offen offset:0 sc1
v_mfma_f32_16x16x32_bf16 v[164:167], a[100:103], a[12:15], v[164:167]
ds_read_b128 a[132:135], v5 offset:23552
v_add_f32 v100, v100, v104
v_mfma_f32_16x16x32_bf16 v[164:167], a[96:99], a[8:11], v[164:167]
v_add_f32 v108, v108, v112
v_add_f32 v116, v116, v120
v_mfma_f32_16x16x32_bf16 v[188:191], a[96:99], a[16:19], v[188:191]
v_add_f32 v93, v93, v97
v_add_f32 v101, v101, v105
v_mfma_f32_16x16x32_bf16 v[188:191], a[100:103], a[20:23], v[188:191]
buffer_load_dwordx4 a[68:71], v2, s[40:43], s33 offen offset:0 sc1
v_mfma_f32_16x16x32_bf16 v[212:215], a[100:103], a[28:31], v[212:215]
ds_read_b128 a[136:139], v5 offset:12288
v_add_f32 v109, v109, v113
v_mfma_f32_16x16x32_bf16 v[212:215], a[96:99], a[24:27], v[212:215]
v_add_f32 v117, v117, v121
v_add_f32 v94, v94, v98
v_mfma_f32_16x16x32_bf16 v[216:219], a[104:107], a[24:27], v[216:219]
ds_read_b128 a[140:143], v5 offset:18432
v_add_f32 v102, v102, v106
v_mfma_f32_16x16x32_bf16 v[216:219], a[108:111], a[28:31], v[216:219]
v_add_f32 v110, v110, v114
v_mfma_f32_16x16x32_bf16 v[192:195], a[108:111], a[20:23], v[192:195]
buffer_load_dwordx4 v1, s[4:7], s44 offen offset:1024 sc1 lds
s_add_u32 m0, s18, 0x6000
v_mfma_f32_16x16x32_bf16 v[192:195], a[104:107], a[16:19], v[192:195]
s_add_u32 s44, s50, 0x202a000
ds_read_b128 a[144:147], v5 offset:13312
v_mfma_f32_16x16x32_bf16 v[168:171], a[104:107], a[8:11], v[168:171]
v_add_f32 v118, v118, v122
v_add_f32 v95, v95, v99
v_mfma_f32_16x16x32_bf16 v[168:171], a[108:111], a[12:15], v[168:171]
ds_read_b128 a[148:151], v5 offset:19456
v_add_f32 v103, v103, v107
v_mfma_f32_16x16x32_bf16 v[144:147], a[108:111], a[4:7], v[144:147]
v_add_f32 v111, v111, v115
v_add_f32 v119, v119, v123
v_mfma_f32_16x16x32_bf16 v[144:147], a[104:107], a[0:3], v[144:147]
buffer_load_dwordx4 a[72:75], v2, s[40:43], s35 offen offset:1024 sc1
v_mfma_f32_16x16x32_bf16 v[148:151], a[112:115], a[0:3], v[148:151]
v_add_f32_dpp v92, v92, v92 row_ror:8 row_mask:0xf bank_mask:0xf
v_add_f32_dpp v100, v100, v100 row_ror:8 row_mask:0xf bank_mask:0xf
v_mfma_f32_16x16x32_bf16 v[148:151], a[116:119], a[4:7], v[148:151]
v_add_f32_dpp v108, v108, v108 row_ror:8 row_mask:0xf bank_mask:0xf
v_mfma_f32_16x16x32_bf16 v[172:175], a[116:119], a[12:15], v[172:175]
v_add_f32_dpp v116, v116, v116 row_ror:8 row_mask:0xf bank_mask:0xf
v_mfma_f32_16x16x32_bf16 v[172:175], a[112:115], a[8:11], v[172:175]
v_add_f32_dpp v93, v93, v93 row_ror:8 row_mask:0xf bank_mask:0xf
v_mfma_f32_16x16x32_bf16 v[196:199], a[112:115], a[16:19], v[196:199]
buffer_load_dwordx4 a[76:79], v2, s[40:43], s33 offen offset:1024 sc1
v_mfma_f32_16x16x32_bf16 v[196:199], a[116:119], a[20:23], v[196:199]
v_add_f32_dpp v101, v101, v101 row_ror:8 row_mask:0xf bank_mask:0xf
v_add_f32_dpp v109, v109, v109 row_ror:8 row_mask:0xf bank_mask:0xf
v_mfma_f32_16x16x32_bf16 v[220:223], a[116:119], a[28:31], v[220:223]
v_add_f32_dpp v117, v117, v117 row_ror:8 row_mask:0xf bank_mask:0xf
v_mfma_f32_16x16x32_bf16 v[220:223], a[112:115], a[24:27], v[220:223]
v_add_f32_dpp v92, v94, v94 row_ror:8 row_mask:0xf bank_mask:0xc
s_waitcnt lgkmcnt(0)
v_mfma_f32_16x16x32_bf16 v[224:227], a[128:131], a[24:27], v[224:227]
ds_read_b128 a[96:99], v5 offset:26624
v_add_f32_dpp v100, v102, v102 row_ror:8 row_mask:0xf bank_mask:0xc
v_mfma_f32_16x16x32_bf16 v[224:227], a[132:135], a[28:31], v[224:227]
buffer_load_dwordx4 a[80:83], v2, s[40:43], s35 offen offset:2048 sc1
v_mfma_f32_16x16x32_bf16 v[200:203], a[132:135], a[20:23], v[200:203]
ds_read_b128 a[100:103], v5 offset:32768
v_add_f32_dpp v108, v110, v110 row_ror:8 row_mask:0xf bank_mask:0xc
v_mfma_f32_16x16x32_bf16 v[200:203], a[128:131], a[16:19], v[200:203]
v_add_f32_dpp v116, v118, v118 row_ror:8 row_mask:0xf bank_mask:0xc
v_add_f32_dpp v93, v95, v95 row_ror:8 row_mask:0xf bank_mask:0xc
v_mfma_f32_16x16x32_bf16 v[176:179], a[128:131], a[8:11], v[176:179]
v_add_f32_dpp v101, v103, v103 row_ror:8 row_mask:0xf bank_mask:0xc
v_add_f32_dpp v109, v111, v111 row_ror:8 row_mask:0xf bank_mask:0xc
v_mfma_f32_16x16x32_bf16 v[176:179], a[132:135], a[12:15], v[176:179]
buffer_load_dwordx4 v1, s[4:7], s44 offen offset:0 sc1 lds
v_mfma_f32_16x16x32_bf16 v[152:155], a[132:135], a[4:7], v[152:155]
ds_read_b128 a[104:107], v5 offset:27648
v_add_f32_dpp v117, v119, v119 row_ror:8 row_mask:0xf bank_mask:0xc
v_mfma_f32_16x16x32_bf16 v[152:155], a[128:131], a[0:3], v[152:155]
v_permlane32_swap_b32 v92, v93
v_mfma_f32_16x16x32_bf16 v[132:135], a[136:139], a[0:3], v[132:135]
ds_read_b128 a[108:111], v5 offset:33792
v_mfma_f32_16x16x32_bf16 v[132:135], a[140:143], a[4:7], v[132:135]
buffer_load_dwordx4 a[84:87], v2, s[40:43], s33 offen offset:2048 sc1
v_mfma_f32_16x16x32_bf16 v[156:159], a[140:143], a[12:15], v[156:159]
ds_read_b128 a[112:115], v5 offset:28672
v_mfma_f32_16x16x32_bf16 v[156:159], a[136:139], a[8:11], v[156:159]
v_permlane32_swap_b32 v100, v101
v_mfma_f32_16x16x32_bf16 v[180:183], a[136:139], a[16:19], v[180:183]
v_permlane32_swap_b32 v108, v109
v_mfma_f32_16x16x32_bf16 v[180:183], a[140:143], a[20:23], v[180:183]
buffer_load_dwordx4 a[88:91], v2, s[40:43], s35 offen offset:3072 sc1
v_mfma_f32_16x16x32_bf16 v[204:207], a[140:143], a[28:31], v[204:207]
ds_read_b128 a[116:119], v5 offset:34816
v_mfma_f32_16x16x32_bf16 v[204:207], a[136:139], a[24:27], v[204:207]
v_permlane32_swap_b32 v116, v117
v_mfma_f32_16x16x32_bf16 v[208:211], a[144:147], a[24:27], v[208:211]
v_add_f32 v92, v92, v93
v_add_f32 v100, v100, v101
v_mfma_f32_16x16x32_bf16 v[208:211], a[148:151], a[28:31], v[208:211]
buffer_load_dwordx4 v1, s[4:7], s44 offen offset:1024 sc1 lds
s_add_u32 m0, s18, 0x8000
v_mfma_f32_16x16x32_bf16 v[184:187], a[148:151], a[20:23], v[184:187]
s_add_u32 s44, s50, 0x202c000
v_add_f32 v108, v108, v109
v_mfma_f32_16x16x32_bf16 v[184:187], a[144:147], a[16:19], v[184:187]
v_add_f32 v116, v116, v117
v_mov_b32 v94, v92
v_mfma_f32_16x16x32_bf16 v[160:163], a[144:147], a[8:11], v[160:163]
v_mov_b32 v102, v100
v_mov_b32 v110, v108
v_mfma_f32_16x16x32_bf16 v[160:163], a[148:151], a[12:15], v[160:163]
buffer_load_dwordx4 a[92:95], v2, s[40:43], s33 offen offset:3072 sc1
s_add_u32 s35, s35, 0x4000
v_mfma_f32_16x16x32_bf16 v[136:139], a[148:151], a[4:7], v[136:139]
s_add_u32 s33, s33, 0x4000
v_mov_b32 v118, v116
v_mfma_f32_16x16x32_bf16 v[136:139], a[144:147], a[0:3], v[136:139]
s_waitcnt vmcnt(11) lgkmcnt(0)
v_mfma_f32_16x16x32_bf16 v[140:143], a[96:99], a[32:35], v[140:143]
ds_read_b128 a[128:131], v5 offset:29696
v_mfma_f32_16x16x32_bf16 v[140:143], a[100:103], a[36:39], v[140:143]
buffer_load_dwordx4 a[0:3], v2, s[40:43], s35 offen offset:0 sc1
v_mfma_f32_16x16x32_bf16 v[164:167], a[100:103], a[44:47], v[164:167]
ds_read_b128 a[132:135], v5 offset:35840
v_mfma_f32_16x16x32_bf16 v[164:167], a[96:99], a[40:43], v[164:167]
v_permlane16_swap_b32 v92, v94
v_mfma_f32_16x16x32_bf16 v[188:191], a[96:99], a[48:51], v[188:191]
v_permlane16_swap_b32 v100, v102
v_mfma_f32_16x16x32_bf16 v[188:191], a[100:103], a[52:55], v[188:191]
buffer_load_dwordx4 a[4:7], v2, s[40:43], s33 offen offset:0 sc1
v_mfma_f32_16x16x32_bf16 v[212:215], a[100:103], a[60:63], v[212:215]
ds_read_b128 a[136:139], v5 offset:24576
v_mfma_f32_16x16x32_bf16 v[212:215], a[96:99], a[56:59], v[212:215]
v_permlane16_swap_b32 v108, v110
v_mfma_f32_16x16x32_bf16 v[216:219], a[104:107], a[56:59], v[216:219]
ds_read_b128 a[140:143], v5 offset:30720
v_mfma_f32_16x16x32_bf16 v[216:219], a[108:111], a[60:63], v[216:219]
v_permlane16_swap_b32 v116, v118
v_mfma_f32_16x16x32_bf16 v[192:195], a[108:111], a[52:55], v[192:195]
buffer_load_dwordx4 v1, s[4:7], s44 offen offset:0 sc1 lds
v_mfma_f32_16x16x32_bf16 v[192:195], a[104:107], a[48:51], v[192:195]
ds_read_b128 a[144:147], v5 offset:25600
v_add_f32 v92, v92, v94
v_mfma_f32_16x16x32_bf16 v[168:171], a[104:107], a[40:43], v[168:171]
v_add_f32 v100, v100, v102
v_add_f32 v108, v108, v110
v_mfma_f32_16x16x32_bf16 v[168:171], a[108:111], a[44:47], v[168:171]
ds_read_b128 a[148:151], v5 offset:31744
v_add_f32 v116, v116, v118
v_mfma_f32_16x16x32_bf16 v[144:147], a[108:111], a[36:39], v[144:147]
v_mov_b32 v94, v92
v_mov_b32 v102, v100
v_mfma_f32_16x16x32_bf16 v[144:147], a[104:107], a[32:35], v[144:147]
buffer_load_dwordx4 a[8:11], v2, s[40:43], s35 offen offset:1024 sc1
v_mfma_f32_16x16x32_bf16 v[148:151], a[112:115], a[32:35], v[148:151]
v_mov_b32 v110, v108
v_mov_b32 v118, v116
v_mfma_f32_16x16x32_bf16 v[148:151], a[116:119], a[36:39], v[148:151]
v_permlane32_swap_b32 v92, v94
v_mfma_f32_16x16x32_bf16 v[172:175], a[116:119], a[44:47], v[172:175]
v_permlane32_swap_b32 v100, v102
v_mfma_f32_16x16x32_bf16 v[172:175], a[112:115], a[40:43], v[172:175]
v_permlane32_swap_b32 v108, v110
v_mfma_f32_16x16x32_bf16 v[196:199], a[112:115], a[48:51], v[196:199]
buffer_load_dwordx4 a[12:15], v2, s[40:43], s33 offen offset:1024 sc1
v_mfma_f32_16x16x32_bf16 v[196:199], a[116:119], a[52:55], v[196:199]
v_permlane32_swap_b32 v116, v118
v_mfma_f32_16x16x32_bf16 v[220:223], a[116:119], a[60:63], v[220:223]
v_mul_f32 v82, 0xba800000, v92
v_mul_f32 v84, 0xba800000, v100
v_mfma_f32_16x16x32_bf16 v[220:223], a[112:115], a[56:59], v[220:223]
v_mul_f32 v86, 0xba800000, v108
s_waitcnt lgkmcnt(0)
v_mfma_f32_16x16x32_bf16 v[224:227], a[128:131], a[56:59], v[224:227]
ds_read_b128 a[96:99], v5 offset:38912
v_mul_f32 v88, 0xba800000, v116
v_mfma_f32_16x16x32_bf16 v[224:227], a[132:135], a[60:63], v[224:227]
buffer_load_dwordx4 a[16:19], v2, s[40:43], s35 offen offset:2048 sc1
v_mfma_f32_16x16x32_bf16 v[200:203], a[132:135], a[52:55], v[200:203]
ds_read_b128 a[100:103], v5 offset:45056
v_mul_f32 v94, 0x3a800000, v94
v_mfma_f32_16x16x32_bf16 v[200:203], a[128:131], a[48:51], v[200:203]
v_mul_f32 v102, 0x3a800000, v102
v_mul_f32 v110, 0x3a800000, v110
v_mfma_f32_16x16x32_bf16 v[176:179], a[128:131], a[40:43], v[176:179]
v_mul_f32 v118, 0x3a800000, v118
v_fma_f32 v94, -v82, v82, v94
v_mfma_f32_16x16x32_bf16 v[176:179], a[132:135], a[44:47], v[176:179]
buffer_load_dwordx4 a[20:23], v2, s[40:43], s33 offen offset:2048 sc1
v_mfma_f32_16x16x32_bf16 v[152:155], a[132:135], a[36:39], v[152:155]
ds_read_b128 a[104:107], v5 offset:39936
v_fma_f32 v102, -v84, v84, v102
v_mfma_f32_16x16x32_bf16 v[152:155], a[128:131], a[32:35], v[152:155]
v_fma_f32 v110, -v86, v86, v110
v_fma_f32 v118, -v88, v88, v118
v_mfma_f32_16x16x32_bf16 v[132:135], a[136:139], a[32:35], v[132:135]
ds_read_b128 a[108:111], v5 offset:46080
v_max_f32 v94, 0, v94
v_mfma_f32_16x16x32_bf16 v[132:135], a[140:143], a[36:39], v[132:135]
v_max_f32 v102, 0, v102
v_mfma_f32_16x16x32_bf16 v[156:159], a[140:143], a[44:47], v[156:159]
buffer_load_dwordx4 v1, s[4:7], s44 offen offset:1024 sc1 lds
s_add_u32 m0, s18, 0xa000
v_mfma_f32_16x16x32_bf16 v[156:159], a[136:139], a[40:43], v[156:159]
s_add_u32 s44, s50, 0x202e000
ds_read_b128 a[112:115], v5 offset:40960
v_mfma_f32_16x16x32_bf16 v[180:183], a[136:139], a[48:51], v[180:183]
v_max_f32 v110, 0, v110
v_max_f32 v118, 0, v118
v_mfma_f32_16x16x32_bf16 v[180:183], a[140:143], a[52:55], v[180:183]
ds_read_b128 a[116:119], v5 offset:47104
v_add_f32 v94, 0x3727c5ac, v94
v_mfma_f32_16x16x32_bf16 v[204:207], a[140:143], a[60:63], v[204:207]
v_add_f32 v102, 0x3727c5ac, v102
v_add_f32 v110, 0x3727c5ac, v110
v_mfma_f32_16x16x32_bf16 v[204:207], a[136:139], a[56:59], v[204:207]
buffer_load_dwordx4 a[24:27], v2, s[40:43], s35 offen offset:3072 sc1
v_mfma_f32_16x16x32_bf16 v[208:211], a[144:147], a[56:59], v[208:211]
v_add_f32 v118, 0x3727c5ac, v118
v_mfma_f32_16x16x32_bf16 v[208:211], a[148:151], a[60:63], v[208:211]
v_rsq_f32 v83, v94
v_mfma_f32_16x16x32_bf16 v[184:187], a[148:151], a[52:55], v[184:187]
v_rsq_f32 v85, v102
v_mfma_f32_16x16x32_bf16 v[184:187], a[144:147], a[48:51], v[184:187]
v_mfma_f32_16x16x32_bf16 v[160:163], a[144:147], a[40:43], v[160:163]
buffer_load_dwordx4 a[28:31], v2, s[40:43], s33 offen offset:3072 sc1
s_add_u32 s35, s35, 0x4000
v_mfma_f32_16x16x32_bf16 v[160:163], a[148:151], a[44:47], v[160:163]
s_add_u32 s33, s33, 0x4000
v_mfma_f32_16x16x32_bf16 v[136:139], a[148:151], a[36:39], v[136:139]
v_rsq_f32 v87, v110
v_mfma_f32_16x16x32_bf16 v[136:139], a[144:147], a[32:35], v[136:139]
s_waitcnt vmcnt(10) lgkmcnt(0)
v_mfma_f32_16x16x32_bf16 v[140:143], a[96:99], a[64:67], v[140:143]
ds_read_b128 a[128:131], v5 offset:41984
v_mfma_f32_16x16x32_bf16 v[140:143], a[100:103], a[68:71], v[140:143]
buffer_load_dwordx4 a[32:35], v2, s[40:43], s35 offen offset:0 sc1
v_mfma_f32_16x16x32_bf16 v[164:167], a[100:103], a[76:79], v[164:167]
ds_read_b128 a[132:135], v5 offset:48128
v_mfma_f32_16x16x32_bf16 v[164:167], a[96:99], a[72:75], v[164:167]
v_rsq_f32 v89, v118
v_mfma_f32_16x16x32_bf16 v[188:191], a[96:99], a[80:83], v[188:191]
v_mfma_f32_16x16x32_bf16 v[188:191], a[100:103], a[84:87], v[188:191]
buffer_load_dwordx4 a[36:39], v2, s[40:43], s33 offen offset:0 sc1
v_mfma_f32_16x16x32_bf16 v[212:215], a[100:103], a[92:95], v[212:215]
ds_read_b128 a[136:139], v5 offset:36864
v_mfma_f32_16x16x32_bf16 v[212:215], a[96:99], a[88:91], v[212:215]
v_mfma_f32_16x16x32_bf16 v[216:219], a[104:107], a[88:91], v[216:219]
ds_read_b128 a[140:143], v5 offset:43008
v_mfma_f32_16x16x32_bf16 v[216:219], a[108:111], a[92:95], v[216:219]
v_mfma_f32_16x16x32_bf16 v[192:195], a[108:111], a[84:87], v[192:195]
buffer_load_dwordx4 v1, s[4:7], s44 offen offset:0 sc1 lds
v_mfma_f32_16x16x32_bf16 v[192:195], a[104:107], a[80:83], v[192:195]
ds_read_b128 a[144:147], v5 offset:37888
v_fmac_f32 v140, v56, v82
v_mfma_f32_16x16x32_bf16 v[168:171], a[104:107], a[72:75], v[168:171]
v_fmac_f32 v164, v56, v84
v_mfma_f32_16x16x32_bf16 v[168:171], a[108:111], a[76:79], v[168:171]
ds_read_b128 a[148:151], v5 offset:44032
v_mfma_f32_16x16x32_bf16 v[144:147], a[108:111], a[68:71], v[144:147]
v_fmac_f32 v188, v56, v86
v_mfma_f32_16x16x32_bf16 v[144:147], a[104:107], a[64:67], v[144:147]
buffer_load_dwordx4 a[40:43], v2, s[40:43], s35 offen offset:1024 sc1
v_mfma_f32_16x16x32_bf16 v[148:151], a[112:115], a[64:67], v[148:151]
v_fmac_f32 v212, v56, v88
v_mfma_f32_16x16x32_bf16 v[148:151], a[116:119], a[68:71], v[148:151]
v_mfma_f32_16x16x32_bf16 v[172:175], a[116:119], a[76:79], v[172:175]
v_fmac_f32 v216, v60, v88
v_mfma_f32_16x16x32_bf16 v[172:175], a[112:115], a[72:75], v[172:175]
v_mfma_f32_16x16x32_bf16 v[196:199], a[112:115], a[80:83], v[196:199]
buffer_load_dwordx4 a[44:47], v2, s[40:43], s33 offen offset:1024 sc1
v_mfma_f32_16x16x32_bf16 v[196:199], a[116:119], a[84:87], v[196:199]
v_fmac_f32 v192, v60, v86
v_mfma_f32_16x16x32_bf16 v[220:223], a[116:119], a[92:95], v[220:223]
v_fmac_f32 v168, v60, v84
v_fmac_f32 v141, v57, v82
v_mfma_f32_16x16x32_bf16 v[220:223], a[112:115], a[88:91], v[220:223]
s_waitcnt lgkmcnt(0)
s_barrier
v_mfma_f32_16x16x32_bf16 v[224:227], a[128:131], a[88:91], v[224:227]
v_add_u32 v5, 0, v1
v_fmac_f32 v144, v60, v82
v_mfma_f32_16x16x32_bf16 v[224:227], a[132:135], a[92:95], v[224:227]
buffer_load_dwordx4 a[48:51], v2, s[40:43], s35 offen offset:2048 sc1
v_mfma_f32_16x16x32_bf16 v[200:203], a[132:135], a[84:87], v[200:203]
ds_read_b128 a[96:99], v5 offset:2048
v_fmac_f32 v148, v64, v82
v_mfma_f32_16x16x32_bf16 v[200:203], a[128:131], a[80:83], v[200:203]
ds_read_b128 a[100:103], v5 offset:8192
v_fmac_f32 v165, v57, v84
v_mfma_f32_16x16x32_bf16 v[176:179], a[128:131], a[72:75], v[176:179]
v_fmac_f32 v172, v64, v84
v_fmac_f32 v189, v57, v86
v_mfma_f32_16x16x32_bf16 v[176:179], a[132:135], a[76:79], v[176:179]
buffer_load_dwordx4 a[52:55], v2, s[40:43], s33 offen offset:2048 sc1
v_mfma_f32_16x16x32_bf16 v[152:155], a[132:135], a[68:71], v[152:155]
ds_read_b128 a[104:107], v5 offset:3072
v_fmac_f32 v196, v64, v86
v_mfma_f32_16x16x32_bf16 v[152:155], a[128:131], a[64:67], v[152:155]
v_fmac_f32 v213, v57, v88
v_fmac_f32 v217, v61, v88
v_mfma_f32_16x16x32_bf16 v[132:135], a[136:139], a[64:67], v[132:135]
ds_read_b128 a[108:111], v5 offset:9216
v_fmac_f32 v220, v64, v88
v_mfma_f32_16x16x32_bf16 v[132:135], a[140:143], a[68:71], v[132:135]
v_fmac_f32 v193, v61, v86
v_mfma_f32_16x16x32_bf16 v[156:159], a[140:143], a[76:79], v[156:159]
buffer_load_dwordx4 v1, s[4:7], s44 offen offset:1024 sc1 lds
s_add_u32 m0, s19, 49152
v_mfma_f32_16x16x32_bf16 v[156:159], a[136:139], a[72:75], v[156:159]
s_xor_b32 s44, s84, 16384
ds_read_b128 a[112:115], v5 offset:4096
v_mfma_f32_16x16x32_bf16 v[180:183], a[136:139], a[80:83], v[180:183]
v_fmac_f32 v224, v68, v88
v_fmac_f32 v200, v68, v86
v_mfma_f32_16x16x32_bf16 v[180:183], a[140:143], a[84:87], v[180:183]
ds_read_b128 a[116:119], v5 offset:10240
v_fmac_f32 v169, v61, v84
v_mfma_f32_16x16x32_bf16 v[204:207], a[140:143], a[92:95], v[204:207]
v_fmac_f32 v176, v68, v84
v_fmac_f32 v145, v61, v82
v_mfma_f32_16x16x32_bf16 v[204:207], a[136:139], a[88:91], v[204:207]
buffer_load_dwordx4 a[56:59], v2, s[40:43], s35 offen offset:3072 sc1
v_mfma_f32_16x16x32_bf16 v[208:211], a[144:147], a[88:91], v[208:211]
v_fmac_f32 v152, v68, v82
v_fmac_f32 v149, v65, v82
v_mfma_f32_16x16x32_bf16 v[208:211], a[148:151], a[92:95], v[208:211]
v_fmac_f32 v173, v65, v84
v_mfma_f32_16x16x32_bf16 v[184:187], a[148:151], a[84:87], v[184:187]
v_fmac_f32 v132, v48, v82
v_fmac_f32 v197, v65, v86
v_mfma_f32_16x16x32_bf16 v[184:187], a[144:147], a[80:83], v[184:187]
v_mfma_f32_16x16x32_bf16 v[160:163], a[144:147], a[72:75], v[160:163]
buffer_load_dwordx4 a[60:63], v2, s[40:43], s33 offen offset:3072 sc1
s_add_u32 s35, s35, 0x4000
v_mfma_f32_16x16x32_bf16 v[160:163], a[148:151], a[76:79], v[160:163]
s_add_u32 s33, s33, 0x4000
v_fmac_f32 v156, v48, v84
v_mfma_f32_16x16x32_bf16 v[136:139], a[148:151], a[68:71], v[136:139]
v_fmac_f32 v180, v48, v86
v_fmac_f32 v221, v65, v88
v_mfma_f32_16x16x32_bf16 v[136:139], a[144:147], a[64:67], v[136:139]
v_fmac_f32 v225, v69, v88
s_waitcnt vmcnt(10) lgkmcnt(0)
v_mfma_f32_16x16x32_bf16 v[140:143], a[96:99], a[0:3], v[140:143]
ds_read_b128 a[128:131], v5 offset:5120
v_fmac_f32 v204, v48, v88
v_mfma_f32_16x16x32_bf16 v[140:143], a[100:103], a[4:7], v[140:143]
buffer_load_dwordx4 a[64:67], v2, s[40:43], s35 offen offset:0 sc1
s_lshl_b32 s37, s28, 10
v_mfma_f32_16x16x32_bf16 v[164:167], a[100:103], a[12:15], v[164:167]
ds_read_b128 a[132:135], v5 offset:11264
v_fmac_f32 v208, v52, v88
v_mfma_f32_16x16x32_bf16 v[164:167], a[96:99], a[8:11], v[164:167]
v_fmac_f32 v201, v69, v86
v_fmac_f32 v177, v69, v84
L_stub12:
s_cbranch_execz L_wret3
v_mfma_f32_16x16x32_bf16 v[188:191], a[96:99], a[16:19], v[188:191]
v_fmac_f32 v184, v52, v86
v_fmac_f32 v153, v69, v82
v_mfma_f32_16x16x32_bf16 v[188:191], a[100:103], a[20:23], v[188:191]
buffer_load_dwordx4 a[68:71], v2, s[40:43], s33 offen offset:0 sc1
s_add_u32 s72, s75, 0x800000
v_mfma_f32_16x16x32_bf16 v[212:215], a[100:103], a[28:31], v[212:215]
ds_read_b128 a[136:139], v5 offset:0
v_fmac_f32 v160, v52, v84
v_mfma_f32_16x16x32_bf16 v[212:215], a[96:99], a[24:27], v[212:215]
v_fmac_f32 v133, v49, v82
s_add_u32 s63, s83, 0x280000
v_mfma_f32_16x16x32_bf16 v[216:219], a[104:107], a[24:27], v[216:219]
ds_read_b128 a[140:143], v5 offset:6144
v_fmac_f32 v136, v52, v82
v_mfma_f32_16x16x32_bf16 v[216:219], a[108:111], a[28:31], v[216:219]
buffer_load_dwordx4 a[72:75], v2, s[40:43], s35 offen offset:1024 sc1
s_sub_u32 s55, s63, 131072
v_mfma_f32_16x16x32_bf16 v[192:195], a[108:111], a[20:23], v[192:195]
ds_read_b128 a[144:147], v5 offset:1024
v_fmac_f32 v157, v49, v84
v_mfma_f32_16x16x32_bf16 v[192:195], a[104:107], a[16:19], v[192:195]
v_fmac_f32 v181, v49, v86
v_fmac_f32 v142, v58, v82
v_mfma_f32_16x16x32_bf16 v[168:171], a[104:107], a[8:11], v[168:171]
v_fmac_f32 v205, v49, v88
v_fmac_f32 v166, v58, v84
v_mfma_f32_16x16x32_bf16 v[168:171], a[108:111], a[12:15], v[168:171]
buffer_load_dwordx4 a[76:79], v2, s[40:43], s33 offen offset:1024 sc1
v_mfma_f32_16x16x32_bf16 v[144:147], a[108:111], a[4:7], v[144:147]
ds_read_b128 a[148:151], v5 offset:7168
v_fmac_f32 v209, v53, v88
v_mfma_f32_16x16x32_bf16 v[144:147], a[104:107], a[0:3], v[144:147]
v_fmac_f32 v190, v58, v86
v_add_u32 v233, s37, v1
v_mfma_f32_16x16x32_bf16 v[148:151], a[112:115], a[0:3], v[148:151]
v_fmac_f32 v185, v53, v86
v_fmac_f32 v214, v58, v88
v_mfma_f32_16x16x32_bf16 v[148:151], a[116:119], a[4:7], v[148:151]
buffer_load_dwordx4 a[80:83], v2, s[40:43], s35 offen offset:2048 sc1
v_mfma_f32_16x16x32_bf16 v[172:175], a[116:119], a[12:15], v[172:175]
v_fmac_f32 v161, v53, v84
v_fmac_f32 v218, v62, v88
v_mfma_f32_16x16x32_bf16 v[172:175], a[112:115], a[8:11], v[172:175]
v_add_u32 v232, s19, v7
v_add_u32 v248, s19, v8
v_mfma_f32_16x16x32_bf16 v[196:199], a[112:115], a[16:19], v[196:199]
v_fmac_f32 v137, v53, v82
v_fmac_f32 v194, v62, v86
v_mfma_f32_16x16x32_bf16 v[196:199], a[116:119], a[20:23], v[196:199]
buffer_load_dwordx4 a[84:87], v2, s[40:43], s33 offen offset:2048 sc1
v_mfma_f32_16x16x32_bf16 v[220:223], a[116:119], a[28:31], v[220:223]
v_fmac_f32 v170, v62, v84
v_fmac_f32 v143, v59, v82
v_mfma_f32_16x16x32_bf16 v[220:223], a[112:115], a[24:27], v[220:223]
s_waitcnt lgkmcnt(0)
v_mfma_f32_16x16x32_bf16 v[224:227], a[128:131], a[24:27], v[224:227]
ds_read_b128 a[96:99], v5 offset:14336
v_fmac_f32 v146, v62, v82
v_mfma_f32_16x16x32_bf16 v[224:227], a[132:135], a[28:31], v[224:227]
buffer_load_dwordx4 a[88:91], v2, s[40:43], s35 offen offset:3072 sc1
v_mfma_f32_16x16x32_bf16 v[200:203], a[132:135], a[20:23], v[200:203]
ds_read_b128 a[100:103], v5 offset:20480
v_fmac_f32 v150, v66, v82
v_mfma_f32_16x16x32_bf16 v[200:203], a[128:131], a[16:19], v[200:203]
v_fmac_f32 v167, v59, v84
v_fmac_f32 v191, v59, v86
v_mfma_f32_16x16x32_bf16 v[176:179], a[128:131], a[8:11], v[176:179]
v_fmac_f32 v174, v66, v84
v_fmac_f32 v215, v59, v88
v_mfma_f32_16x16x32_bf16 v[176:179], a[132:135], a[12:15], v[176:179]
ds_read_b128 a[104:107], v5 offset:15360
v_mfma_f32_16x16x32_bf16 v[152:155], a[132:135], a[4:7], v[152:155]
v_fmac_f32 v198, v66, v86
v_fmac_f32 v219, v63, v88
v_mfma_f32_16x16x32_bf16 v[152:155], a[128:131], a[0:3], v[152:155]
buffer_load_dwordx4 v1, s[4:7], s44 offen offset:0 sc1 lds
v_mfma_f32_16x16x32_bf16 v[132:135], a[136:139], a[0:3], v[132:135]
ds_read_b128 a[108:111], v5 offset:21504
v_fmac_f32 v222, v66, v88
v_mfma_f32_16x16x32_bf16 v[132:135], a[140:143], a[4:7], v[132:135]
v_fmac_f32 v195, v63, v86
v_mfma_f32_16x16x32_bf16 v[156:159], a[140:143], a[12:15], v[156:159]
ds_read_b128 a[112:115], v5 offset:16384
v_fmac_f32 v226, v70, v88
v_mfma_f32_16x16x32_bf16 v[156:159], a[136:139], a[8:11], v[156:159]
v_fmac_f32 v171, v63, v84
v_mfma_f32_16x16x32_bf16 v[180:183], a[136:139], a[16:19], v[180:183]
v_fmac_f32 v202, v70, v86
v_fmac_f32 v147, v63, v82
v_mfma_f32_16x16x32_bf16 v[180:183], a[140:143], a[20:23], v[180:183]
buffer_load_dwordx4 a[92:95], v2, s[40:43], s33 offen offset:3072 sc1
s_add_u32 s35, s35, 0x4000
v_mfma_f32_16x16x32_bf16 v[204:207], a[140:143], a[28:31], v[204:207]
s_add_u32 s33, s33, 0x4000
ds_read_b128 a[116:119], v5 offset:22528
v_mfma_f32_16x16x32_bf16 v[204:207], a[136:139], a[24:27], v[204:207]
v_fmac_f32 v178, v70, v84
v_fmac_f32 v151, v67, v82
v_mfma_f32_16x16x32_bf16 v[208:211], a[144:147], a[24:27], v[208:211]
v_fmac_f32 v154, v70, v82
v_fmac_f32 v175, v67, v84
v_mfma_f32_16x16x32_bf16 v[208:211], a[148:151], a[28:31], v[208:211]
v_mfma_f32_16x16x32_bf16 v[184:187], a[148:151], a[20:23], v[184:187]
v_fmac_f32 v134, v50, v82
v_fmac_f32 v199, v67, v86
v_mfma_f32_16x16x32_bf16 v[184:187], a[144:147], a[16:19], v[184:187]
buffer_load_dwordx4 v1, s[4:7], s44 offen offset:1024 sc1 lds
v_mfma_f32_16x16x32_bf16 v[160:163], a[144:147], a[8:11], v[160:163]
v_fmac_f32 v158, v50, v84
v_fmac_f32 v223, v67, v88
v_mfma_f32_16x16x32_bf16 v[160:163], a[148:151], a[12:15], v[160:163]
v_mfma_f32_16x16x32_bf16 v[136:139], a[148:151], a[4:7], v[136:139]
v_fmac_f32 v182, v50, v86
v_fmac_f32 v227, v71, v88
v_mfma_f32_16x16x32_bf16 v[136:139], a[144:147], a[0:3], v[136:139]
s_waitcnt vmcnt(10) lgkmcnt(0)
s_barrier
v_mfma_f32_16x16x32_bf16 v[140:143], a[96:99], a[32:35], v[140:143]
ds_read_b128 a[128:131], v5 offset:17408
v_fmac_f32 v206, v50, v88
v_mfma_f32_16x16x32_bf16 v[140:143], a[100:103], a[36:39], v[140:143]
buffer_load_dwordx4 a[0:3], v2, s[40:43], s35 offen offset:0 sc1
v_mfma_f32_16x16x32_bf16 v[164:167], a[100:103], a[44:47], v[164:167]
ds_read_b128 a[132:135], v5 offset:23552
v_fmac_f32 v210, v54, v88
v_mfma_f32_16x16x32_bf16 v[164:167], a[96:99], a[40:43], v[164:167]
v_fmac_f32 v203, v71, v86
v_fmac_f32 v179, v71, v84
v_mfma_f32_16x16x32_bf16 v[188:191], a[96:99], a[48:51], v[188:191]
buffer_load_dwordx4 a[4:7], v2, s[40:43], s33 offen offset:0 sc1
v_mfma_f32_16x16x32_bf16 v[188:191], a[100:103], a[52:55], v[188:191]
ds_read_b128 a[136:139], v5 offset:26624
v_fmac_f32 v186, v54, v86
v_mfma_f32_16x16x32_bf16 v[212:215], a[100:103], a[60:63], v[212:215]
v_fmac_f32 v162, v54, v84
v_fmac_f32 v155, v71, v82
v_mfma_f32_16x16x32_bf16 v[212:215], a[96:99], a[56:59], v[212:215]
buffer_load_dwordx4 a[8:11], v2, s[40:43], s35 offen offset:1024 sc1
v_mfma_f32_16x16x32_bf16 v[216:219], a[104:107], a[56:59], v[216:219]
ds_read_b128 a[140:143], v5 offset:32768
v_fmac_f32 v138, v54, v82
v_mfma_f32_16x16x32_bf16 v[216:219], a[108:111], a[60:63], v[216:219]
v_fmac_f32 v135, v51, v82
v_fmac_f32 v159, v51, v84
v_mfma_f32_16x16x32_bf16 v[192:195], a[108:111], a[52:55], v[192:195]
buffer_load_dwordx4 a[12:15], v2, s[40:43], s33 offen offset:1024 sc1
v_mfma_f32_16x16x32_bf16 v[192:195], a[104:107], a[48:51], v[192:195]
ds_read_b128 a[144:147], v5 offset:27648
v_fmac_f32 v183, v51, v86
v_mfma_f32_16x16x32_bf16 v[168:171], a[104:107], a[40:43], v[168:171]
v_fmac_f32 v207, v51, v88
v_mfma_f32_16x16x32_bf16 v[168:171], a[108:111], a[44:47], v[168:171]
buffer_load_dwordx4 a[16:19], v2, s[40:43], s35 offen offset:2048 sc1
v_mfma_f32_16x16x32_bf16 v[144:147], a[108:111], a[36:39], v[144:147]
ds_read_b128 a[148:151], v5 offset:33792
v_fmac_f32 v211, v55, v88
v_mfma_f32_16x16x32_bf16 v[144:147], a[104:107], a[32:35], v[144:147]
v_mul_f32 v88, 0x3e8293ee, v89
v_mfma_f32_16x16x32_bf16 v[148:151], a[112:115], a[32:35], v[148:151]
buffer_load_dwordx4 a[20:23], v2, s[40:43], s33 offen offset:2048 sc1
v_mfma_f32_16x16x32_bf16 v[148:151], a[116:119], a[36:39], v[148:151]
v_fmac_f32 v187, v55, v86
v_mfma_f32_16x16x32_bf16 v[172:175], a[116:119], a[44:47], v[172:175]
v_fmac_f32 v163, v55, v84
v_mul_f32 v86, 0x3e8293ee, v87
v_mfma_f32_16x16x32_bf16 v[172:175], a[112:115], a[40:43], v[172:175]
buffer_load_dwordx4 a[24:27], v2, s[40:43], s35 offen offset:3072 sc1
v_mfma_f32_16x16x32_bf16 v[196:199], a[112:115], a[48:51], v[196:199]
v_fmac_f32 v139, v55, v82
v_mul_f32 v84, 0x3e8293ee, v85
v_mfma_f32_16x16x32_bf16 v[196:199], a[116:119], a[52:55], v[196:199]
v_mul_f32 v82, 0x3e8293ee, v83
v_mfma_f32_16x16x32_bf16 v[220:223], a[116:119], a[60:63], v[220:223]
buffer_load_dwordx4 a[28:31], v2, s[40:43], s33 offen offset:3072 sc1
s_add_u32 s35, s35, 0x64000
v_mfma_f32_16x16x32_bf16 v[220:223], a[112:115], a[56:59], v[220:223]
s_add_u32 s33, s33, 0x64000
s_waitcnt lgkmcnt(0)
v_mfma_f32_16x16x32_bf16 v[224:227], a[128:131], a[56:59], v[224:227]
ds_read_b128 a[96:99], v5 offset:28672
v_mfma_f32_16x16x32_bf16 v[224:227], a[132:135], a[60:63], v[224:227]
buffer_load_dwordx4 v1, s[4:7], s44 offen offset:2048 sc1 lds
v_mfma_f32_16x16x32_bf16 v[200:203], a[132:135], a[52:55], v[200:203]
ds_read_b128 a[100:103], v5 offset:34816
v_mfma_f32_16x16x32_bf16 v[200:203], a[128:131], a[48:51], v[200:203]
v_mfma_f32_16x16x32_bf16 v[176:179], a[128:131], a[40:43], v[176:179]
v_mfma_f32_16x16x32_bf16 v[176:179], a[132:135], a[44:47], v[176:179]
ds_read_b128 a[104:107], v5 offset:29696
v_mfma_f32_16x16x32_bf16 v[152:155], a[132:135], a[36:39], v[152:155]
v_mfma_f32_16x16x32_bf16 v[152:155], a[128:131], a[32:35], v[152:155]
s_waitcnt vmcnt(18)
v_mfma_f32_16x16x32_bf16 v[140:143], a[136:139], a[64:67], v[140:143]
ds_read_b128 a[108:111], v5 offset:35840
s_waitcnt vmcnt(17)
v_mfma_f32_16x16x32_bf16 v[140:143], a[140:143], a[68:71], v[140:143]
s_waitcnt vmcnt(15)
v_mfma_f32_16x16x32_bf16 v[164:167], a[140:143], a[76:79], v[164:167]
ds_read_b128 a[112:115], v5 offset:38912
v_mfma_f32_16x16x32_bf16 v[164:167], a[136:139], a[72:75], v[164:167]
s_waitcnt vmcnt(14)
v_mfma_f32_16x16x32_bf16 v[188:191], a[136:139], a[80:83], v[188:191]
s_waitcnt vmcnt(13)
v_mfma_f32_16x16x32_bf16 v[188:191], a[140:143], a[84:87], v[188:191]
buffer_load_dwordx4 v1, s[4:7], s44 offen offset:3072 sc1 lds
s_add_u32 m0, s19, 65536
s_waitcnt vmcnt(11)
v_mfma_f32_16x16x32_bf16 v[212:215], a[140:143], a[92:95], v[212:215]
s_xor_b32 s44, s84, 32768
ds_read_b128 a[116:119], v5 offset:45056
v_mfma_f32_16x16x32_bf16 v[212:215], a[136:139], a[88:91], v[212:215]
v_mfma_f32_16x16x32_bf16 v[216:219], a[144:147], a[88:91], v[216:219]
v_mfma_f32_16x16x32_bf16 v[216:219], a[148:151], a[92:95], v[216:219]
v_mfma_f32_16x16x32_bf16 v[192:195], a[148:151], a[84:87], v[192:195]
v_mfma_f32_16x16x32_bf16 v[192:195], a[144:147], a[80:83], v[192:195]
v_mfma_f32_16x16x32_bf16 v[168:171], a[144:147], a[72:75], v[168:171]
v_mfma_f32_16x16x32_bf16 v[168:171], a[148:151], a[76:79], v[168:171]
v_mfma_f32_16x16x32_bf16 v[144:147], a[148:151], a[68:71], v[144:147]
v_mfma_f32_16x16x32_bf16 v[144:147], a[144:147], a[64:67], v[144:147]
s_waitcnt lgkmcnt(0)
v_mfma_f32_16x16x32_bf16 v[148:151], a[96:99], a[64:67], v[148:151]
ds_read_b128 a[128:131], v5 offset:39936
v_mfma_f32_16x16x32_bf16 v[148:151], a[100:103], a[68:71], v[148:151]
buffer_load_dwordx4 v1, s[4:7], s44 offen offset:0 sc1 lds
v_mfma_f32_16x16x32_bf16 v[172:175], a[100:103], a[76:79], v[172:175]
ds_read_b128 a[132:135], v5 offset:46080
v_mfma_f32_16x16x32_bf16 v[172:175], a[96:99], a[72:75], v[172:175]
v_mfma_f32_16x16x32_bf16 v[196:199], a[96:99], a[80:83], v[196:199]
v_mfma_f32_16x16x32_bf16 v[196:199], a[100:103], a[84:87], v[196:199]
buffer_load_dwordx4 v1, s[4:7], s44 offen offset:1024 sc1 lds
v_mfma_f32_16x16x32_bf16 v[220:223], a[100:103], a[92:95], v[220:223]
ds_read_b128 a[136:139], v5 offset:40960
v_mfma_f32_16x16x32_bf16 v[220:223], a[96:99], a[88:91], v[220:223]
v_mfma_f32_16x16x32_bf16 v[224:227], a[104:107], a[88:91], v[224:227]
ds_read_b128 a[140:143], v5 offset:47104
v_mfma_f32_16x16x32_bf16 v[224:227], a[108:111], a[92:95], v[224:227]
v_mfma_f32_16x16x32_bf16 v[200:203], a[108:111], a[84:87], v[200:203]
buffer_load_dwordx4 v1, s[4:7], s44 offen offset:2048 sc1 lds
v_mfma_f32_16x16x32_bf16 v[200:203], a[104:107], a[80:83], v[200:203]
ds_read_b128 a[144:147], v5 offset:41984
v_mfma_f32_16x16x32_bf16 v[176:179], a[104:107], a[72:75], v[176:179]
v_mfma_f32_16x16x32_bf16 v[176:179], a[108:111], a[76:79], v[176:179]
ds_read_b128 a[148:151], v5 offset:48128
v_mfma_f32_16x16x32_bf16 v[152:155], a[108:111], a[68:71], v[152:155]
v_mfma_f32_16x16x32_bf16 v[152:155], a[104:107], a[64:67], v[152:155]
buffer_load_dwordx4 v1, s[4:7], s44 offen offset:3072 sc1 lds
s_add_u32 m0, s19, 81920
s_waitcnt vmcnt(13)
v_mfma_f32_16x16x32_bf16 v[140:143], a[112:115], a[0:3], v[140:143]
s_xor_b32 s44, s84, 49152
s_waitcnt vmcnt(12)
v_mfma_f32_16x16x32_bf16 v[140:143], a[116:119], a[4:7], v[140:143]
s_waitcnt vmcnt(10)
v_mfma_f32_16x16x32_bf16 v[164:167], a[116:119], a[12:15], v[164:167]
v_mfma_f32_16x16x32_bf16 v[164:167], a[112:115], a[8:11], v[164:167]
s_waitcnt vmcnt(9)
v_mfma_f32_16x16x32_bf16 v[188:191], a[112:115], a[16:19], v[188:191]
buffer_load_dwordx4 v1, s[4:7], s44 offen offset:0 sc1 lds
s_waitcnt vmcnt(9)
v_mfma_f32_16x16x32_bf16 v[188:191], a[116:119], a[20:23], v[188:191]
s_waitcnt vmcnt(7)
v_mfma_f32_16x16x32_bf16 v[212:215], a[116:119], a[28:31], v[212:215]
v_mfma_f32_16x16x32_bf16 v[212:215], a[112:115], a[24:27], v[212:215]
s_waitcnt lgkmcnt(0)
v_mfma_f32_16x16x32_bf16 v[216:219], a[128:131], a[24:27], v[216:219]
ds_read_b128 a[96:99], v5 offset:12288
v_mul_f32 v140, v140, v83
v_mfma_f32_16x16x32_bf16 v[216:219], a[132:135], a[28:31], v[216:219]
buffer_load_dwordx4 v1, s[4:7], s44 offen offset:1024 sc1 lds
v_mfma_f32_16x16x32_bf16 v[192:195], a[132:135], a[20:23], v[192:195]
ds_read_b128 a[100:103], v5 offset:18432
v_mul_f32 v141, v141, v83
v_mfma_f32_16x16x32_bf16 v[192:195], a[128:131], a[16:19], v[192:195]
v_cvt_pk_bf16_f32 v140, v140, v141
v_mul_f32 v164, v164, v85
v_mfma_f32_16x16x32_bf16 v[168:171], a[128:131], a[8:11], v[168:171]
v_mul_f32 v165, v165, v85
v_cvt_pk_bf16_f32 v164, v164, v165
v_mfma_f32_16x16x32_bf16 v[168:171], a[132:135], a[12:15], v[168:171]
buffer_load_dwordx4 v1, s[4:7], s44 offen offset:2048 sc1 lds
v_mfma_f32_16x16x32_bf16 v[144:147], a[132:135], a[4:7], v[144:147]
ds_read_b128 a[104:107], v5 offset:24576
v_mul_f32 v212, v212, v89
v_mfma_f32_16x16x32_bf16 v[144:147], a[128:131], a[0:3], v[144:147]
v_mul_f32 v213, v213, v89
v_mul_f32 v214, v214, v89
v_mfma_f32_16x16x32_bf16 v[148:151], a[136:139], a[0:3], v[148:151]
ds_read_b128 a[108:111], v5 offset:30720
v_mul_f32 v215, v215, v89
v_mfma_f32_16x16x32_bf16 v[148:151], a[140:143], a[4:7], v[148:151]
v_cvt_pk_bf16_f32 v212, v212, v213
v_mul_f32 v216, v216, v89
v_mfma_f32_16x16x32_bf16 v[172:175], a[140:143], a[12:15], v[172:175]
buffer_load_dwordx4 v1, s[4:7], s44 offen offset:3072 sc1 lds
s_add_u32 m0, s19, 147456
v_mfma_f32_16x16x32_bf16 v[172:175], a[136:139], a[8:11], v[172:175]
s_xor_b32 s44, s84, 114688
ds_read_b128 a[112:115], v5 offset:36864
v_mfma_f32_16x16x32_bf16 v[196:199], a[136:139], a[16:19], v[196:199]
v_mul_f32 v217, v217, v89
v_mul_f32 v218, v218, v89
v_mfma_f32_16x16x32_bf16 v[196:199], a[140:143], a[20:23], v[196:199]
ds_read_b128 a[116:119], v5 offset:43008
v_mul_f32 v219, v219, v89
v_mfma_f32_16x16x32_bf16 v[220:223], a[140:143], a[28:31], v[220:223]
v_cvt_pk_bf16_f32 v213, v214, v215
v_cvt_pk_bf16_f32 v214, v216, v217
v_mfma_f32_16x16x32_bf16 v[220:223], a[136:139], a[24:27], v[220:223]
buffer_load_dwordx4 v1, s[4:7], s44 offen offset:0 sc1 lds
v_mfma_f32_16x16x32_bf16 v[224:227], a[144:147], a[24:27], v[224:227]
v_cvt_pk_bf16_f32 v215, v218, v219
v_min_u32 v212, -2, v212
v_mfma_f32_16x16x32_bf16 v[224:227], a[148:151], a[28:31], v[224:227]
v_min_u32 v213, -2, v213
v_min_u32 v214, -2, v214
v_mfma_f32_16x16x32_bf16 v[200:203], a[148:151], a[20:23], v[200:203]
v_min_u32 v215, -2, v215
v_mul_f32 v172, v172, v85
v_mfma_f32_16x16x32_bf16 v[200:203], a[144:147], a[16:19], v[200:203]
buffer_store_dwordx4 v[212:215], v3, s[4:7], s63 offen offset:0 sc1
v_mfma_f32_16x16x32_bf16 v[176:179], a[144:147], a[8:11], v[176:179]
buffer_load_dwordx4 v1, s[4:7], s44 offen offset:1024 sc1 lds
v_mfma_f32_16x16x32_bf16 v[176:179], a[148:151], a[12:15], v[176:179]
v_mul_f32 v173, v173, v85
v_cvt_pk_bf16_f32 v172, v172, v173
v_mfma_f32_16x16x32_bf16 v[152:155], a[148:151], a[4:7], v[152:155]
v_mul_f32 v220, v220, v89
v_mul_f32 v221, v221, v89
v_mfma_f32_16x16x32_bf16 v[152:155], a[144:147], a[0:3], v[152:155]
v_mul_f32 v222, v222, v89
s_waitcnt lgkmcnt(0)
v_mfma_f32_16x16x32_bf16 v[132:135], a[96:99], a[32:35], v[132:135]
ds_read_b128 a[128:131], v5 offset:13312
v_mul_f32 v223, v223, v89
v_mfma_f32_16x16x32_bf16 v[132:135], a[100:103], a[36:39], v[132:135]
buffer_load_dwordx4 v1, s[4:7], s44 offen offset:2048 sc1 lds
v_mfma_f32_16x16x32_bf16 v[156:159], a[100:103], a[44:47], v[156:159]
ds_read_b128 a[132:135], v5 offset:19456
v_cvt_pk_bf16_f32 v220, v220, v221
v_mfma_f32_16x16x32_bf16 v[156:159], a[96:99], a[40:43], v[156:159]
v_mul_f32 v224, v224, v89
v_mul_f32 v225, v225, v89
v_mfma_f32_16x16x32_bf16 v[180:183], a[96:99], a[48:51], v[180:183]
v_mul_f32 v226, v226, v89
v_mul_f32 v227, v227, v89
v_mfma_f32_16x16x32_bf16 v[180:183], a[100:103], a[52:55], v[180:183]
buffer_load_dwordx4 v1, s[4:7], s44 offen offset:3072 sc1 lds
s_add_u32 m0, s19, 98304
v_mfma_f32_16x16x32_bf16 v[204:207], a[100:103], a[60:63], v[204:207]
s_xor_b32 s44, s84, 65536
ds_read_b128 a[136:139], v5 offset:25600
v_mfma_f32_16x16x32_bf16 v[204:207], a[96:99], a[56:59], v[204:207]
v_cvt_pk_bf16_f32 v221, v222, v223
v_cvt_pk_bf16_f32 v222, v224, v225
v_mfma_f32_16x16x32_bf16 v[204:207], a[104:107], a[88:91], v[204:207]
ds_read_b128 a[140:143], v5 offset:31744
v_cvt_pk_bf16_f32 v223, v226, v227
v_mfma_f32_16x16x32_bf16 v[204:207], a[108:111], a[92:95], v[204:207]
v_min_u32 v220, -2, v220
v_min_u32 v221, -2, v221
v_mfma_f32_16x16x32_bf16 v[180:183], a[108:111], a[84:87], v[180:183]
buffer_load_dwordx4 v1, s[4:7], s44 offen offset:0 sc1 lds
v_mfma_f32_16x16x32_bf16 v[180:183], a[104:107], a[80:83], v[180:183]
ds_read_b128 a[144:147], v5 offset:37888
v_min_u32 v222, -2, v222
v_mfma_f32_16x16x32_bf16 v[156:159], a[104:107], a[72:75], v[156:159]
v_min_u32 v223, -2, v223
v_mul_f32 v196, v196, v87
v_mfma_f32_16x16x32_bf16 v[156:159], a[108:111], a[76:79], v[156:159]
ds_read_b128 a[148:151], v5 offset:44032
v_mul_f32 v197, v197, v87
v_mfma_f32_16x16x32_bf16 v[132:135], a[108:111], a[68:71], v[132:135]
buffer_store_dwordx4 v[220:223], v3, s[4:7], s63 offen offset:1024 sc1
v_mfma_f32_16x16x32_bf16 v[132:135], a[104:107], a[64:67], v[132:135]
buffer_load_dwordx4 v1, s[4:7], s44 offen offset:1024 sc1 lds
v_mfma_f32_16x16x32_bf16 v[132:135], a[112:115], a[0:3], v[132:135]
v_cvt_pk_bf16_f32 v196, v196, v197
v_mul_f32 v198, v198, v87
v_mfma_f32_16x16x32_bf16 v[132:135], a[116:119], a[4:7], v[132:135]
v_mul_f32 v199, v199, v87
v_cvt_pk_bf16_f32 v197, v198, v199
v_mfma_f32_16x16x32_bf16 v[156:159], a[116:119], a[12:15], v[156:159]
v_mul_f32 v200, v200, v87
v_mul_f32 v201, v201, v87
v_mfma_f32_16x16x32_bf16 v[156:159], a[112:115], a[8:11], v[156:159]
v_cvt_pk_bf16_f32 v198, v200, v201
v_mul_f32 v202, v202, v87
v_mfma_f32_16x16x32_bf16 v[180:183], a[112:115], a[16:19], v[180:183]
buffer_load_dwordx4 v1, s[4:7], s44 offen offset:2048 sc1 lds
v_mfma_f32_16x16x32_bf16 v[180:183], a[116:119], a[20:23], v[180:183]
v_mul_f32 v203, v203, v87
v_cvt_pk_bf16_f32 v199, v202, v203
v_mfma_f32_16x16x32_bf16 v[204:207], a[116:119], a[28:31], v[204:207]
v_mul_f32 v174, v174, v85
v_mul_f32 v175, v175, v85
v_mfma_f32_16x16x32_bf16 v[204:207], a[112:115], a[24:27], v[204:207]
s_waitcnt lgkmcnt(0)
s_barrier
v_mfma_f32_16x16x32_bf16 v[208:211], a[128:131], a[56:59], v[208:211]
ds_write_b128 v233, v[212:215] offset:21504
v_cvt_pk_bf16_f32 v173, v174, v175
v_mfma_f32_16x16x32_bf16 v[208:211], a[132:135], a[60:63], v[208:211]
buffer_load_dwordx4 v1, s[4:7], s44 offen offset:3072 sc1 lds
s_add_u32 m0, s19, 114688
v_mfma_f32_16x16x32_bf16 v[184:187], a[132:135], a[52:55], v[184:187]
s_xor_b32 s44, s84, 81920
ds_write_b64 v232, v[220:221] offset:4096
v_mfma_f32_16x16x32_bf16 v[184:187], a[128:131], a[48:51], v[184:187]
ds_write_b64 v232, v[222:223] offset:4608
v_cvt_pk_bf16_f32 v132, v132, v133
v_mfma_f32_16x16x32_bf16 v[160:163], a[128:131], a[40:43], v[160:163]
ds_write_b64 v232, v[196:197] offset:3072
v_cvt_pk_bf16_f32 v156, v156, v157
v_mfma_f32_16x16x32_bf16 v[160:163], a[132:135], a[44:47], v[160:163]
buffer_load_dwordx4 v1, s[4:7], s44 offen offset:0 sc1 lds
v_mfma_f32_16x16x32_bf16 v[136:139], a[132:135], a[36:39], v[136:139]
ds_write_b64 v232, v[198:199] offset:3584
v_cvt_pk_bf16_f32 v180, v180, v181
v_mfma_f32_16x16x32_bf16 v[136:139], a[128:131], a[32:35], v[136:139]
ds_write_b64 v232, v[172:173] offset:2048
v_cvt_pk_bf16_f32 v204, v204, v205
v_mfma_f32_16x16x32_bf16 v[136:139], a[136:139], a[64:67], v[136:139]
v_cvt_pk_bf16_f32 v133, v134, v135
v_cvt_pk_bf16_f32 v157, v158, v159
v_mfma_f32_16x16x32_bf16 v[136:139], a[140:143], a[68:71], v[136:139]
v_cvt_pk_bf16_f32 v181, v182, v183
v_cvt_pk_bf16_f32 v205, v206, v207
v_mfma_f32_16x16x32_bf16 v[160:163], a[140:143], a[76:79], v[160:163]
buffer_load_dwordx4 v1, s[4:7], s44 offen offset:1024 sc1 lds
v_mfma_f32_16x16x32_bf16 v[160:163], a[136:139], a[72:75], v[160:163]
v_mul_f32 v176, v176, v85
v_mul_f32 v177, v177, v85
v_mfma_f32_16x16x32_bf16 v[184:187], a[136:139], a[80:83], v[184:187]
v_cvt_pk_bf16_f32 v174, v176, v177
v_mul_f32 v178, v178, v85
v_mfma_f32_16x16x32_bf16 v[184:187], a[140:143], a[84:87], v[184:187]
v_mul_f32 v179, v179, v85
v_cvt_pk_bf16_f32 v175, v178, v179
v_mfma_f32_16x16x32_bf16 v[208:211], a[140:143], a[92:95], v[208:211]
ds_write_b64 v232, v[174:175] offset:2560
v_mul_f32 v148, v148, v83
v_mfma_f32_16x16x32_bf16 v[208:211], a[136:139], a[88:91], v[208:211]
buffer_load_dwordx4 v1, s[4:7], s44 offen offset:2048 sc1 lds
v_mfma_f32_16x16x32_bf16 v[208:211], a[144:147], a[24:27], v[208:211]
v_mul_f32 v149, v149, v83
v_cvt_pk_bf16_f32 v148, v148, v149
v_mfma_f32_16x16x32_bf16 v[208:211], a[148:151], a[28:31], v[208:211]
v_mul_f32 v150, v150, v83
v_mul_f32 v151, v151, v83
v_mfma_f32_16x16x32_bf16 v[184:187], a[148:151], a[20:23], v[184:187]
v_cvt_pk_bf16_f32 v149, v150, v151
v_mul_f32 v152, v152, v83
v_mfma_f32_16x16x32_bf16 v[184:187], a[144:147], a[16:19], v[184:187]
ds_write_b64 v232, v[148:149] offset:1024
v_mul_f32 v153, v153, v83
v_mfma_f32_16x16x32_bf16 v[160:163], a[144:147], a[8:11], v[160:163]
buffer_load_dwordx4 v1, s[4:7], s44 offen offset:3072 sc1 lds
v_mfma_f32_16x16x32_bf16 v[160:163], a[148:151], a[12:15], v[160:163]
v_cvt_pk_bf16_f32 v150, v152, v153
v_mul_f32 v154, v154, v83
v_mfma_f32_16x16x32_bf16 v[136:139], a[148:151], a[4:7], v[136:139]
v_mul_f32 v155, v155, v83
v_cvt_pk_bf16_f32 v151, v154, v155
v_mfma_f32_16x16x32_bf16 v[136:139], a[144:147], a[0:3], v[136:139]
ds_write_b64 v232, v[150:151] offset:1536
v_mul_f32 v188, v188, v87
s_add_u32 m0, s19, 32768
buffer_load_dwordx4 v[228:231], v9, s[4:7], s55 offen sc1
buffer_load_dwordx4 v[72:75], v9, s[4:7], s55 offen offset:1024 sc1
s_xor_b32 s44, s84, 0
buffer_load_dwordx4 v1, s[4:7], s44 offen offset:0 sc1 lds
v_mul_f32 v189, v189, v87
v_pk_mul_f32 v[190:191], v[190:191], v[86:87] op_sel:[0,1] op_sel_hi:[1,1]
v_pk_mul_f32 v[166:167], v[166:167], v[84:85] op_sel:[0,1] op_sel_hi:[1,1]
v_pk_mul_f32 v[142:143], v[142:143], v[82:83] op_sel:[0,1] op_sel_hi:[1,1]
v_cvt_pk_bf16_f32 v188, v188, v189
v_pk_mul_f32 v[192:193], v[192:193], v[86:87] op_sel:[0,1] op_sel_hi:[1,1]
v_pk_mul_f32 v[194:195], v[194:195], v[86:87] op_sel:[0,1] op_sel_hi:[1,1]
v_pk_mul_f32 v[168:169], v[168:169], v[84:85] op_sel:[0,1] op_sel_hi:[1,1]
v_pk_mul_f32 v[170:171], v[170:171], v[84:85] op_sel:[0,1] op_sel_hi:[1,1]
v_pk_mul_f32 v[144:145], v[144:145], v[82:83] op_sel:[0,1] op_sel_hi:[1,1]
v_pk_mul_f32 v[146:147], v[146:147], v[82:83] op_sel:[0,1] op_sel_hi:[1,1]
v_cvt_pk_bf16_f32 v189, v190, v191
v_cvt_pk_bf16_f32 v165, v166, v167
v_cvt_pk_bf16_f32 v141, v142, v143
v_cvt_pk_bf16_f32 v190, v192, v193
v_cvt_pk_bf16_f32 v191, v194, v195
v_cvt_pk_bf16_f32 v166, v168, v169
v_cvt_pk_bf16_f32 v167, v170, v171
v_cvt_pk_bf16_f32 v142, v144, v145
v_cvt_pk_bf16_f32 v143, v146, v147
v_cvt_pk_bf16_f32 v134, v136, v137
v_cvt_pk_bf16_f32 v135, v138, v139
v_cvt_pk_bf16_f32 v158, v160, v161
v_cvt_pk_bf16_f32 v159, v162, v163
v_cvt_pk_bf16_f32 v182, v184, v185
v_cvt_pk_bf16_f32 v183, v186, v187
v_cvt_pk_bf16_f32 v206, v208, v209
buffer_load_dwordx4 v1, s[4:7], s44 offen offset:1024 sc1 lds
v_cvt_pk_bf16_f32 v207, v210, v211
buffer_load_dwordx4 v1, s[4:7], s44 offen offset:2048 sc1 lds
buffer_load_dwordx4 v1, s[4:7], s44 offen offset:3072 sc1 lds
s_waitcnt lgkmcnt(0)
s_barrier
s_add_u32 m0, s19, 131072
s_xor_b32 s44, s84, 98304
buffer_load_dwordx4 v1, s[4:7], s44 offen offset:0 sc1 lds
v_mfma_f32_16x16x32_bf16 v[208:211], v[188:191], v[204:207], v[20:23]
ds_read_b64_tr_b16 a[10:11], v248 offset:3072
v_mfma_f32_16x16x32_bf16 v[224:227], v[212:215], v[204:207], v[24:27]
ds_read_b64_tr_b16 a[12:13], v248 offset:4096
v_mfma_f32_16x16x32_bf16 v[160:163], v[140:143], v[156:159], v[20:23]
ds_read_b64_tr_b16 a[22:23], v248 offset:3584
v_mfma_f32_16x16x32_bf16 v[176:179], v[164:167], v[156:159], v[24:27]
s_nop 3
v_max_f32 v224, v224, v208
v_max_f32 v225, v225, v209
v_max_f32 v226, v226, v210
v_max_f32 v227, v227, v211
v_max3_f32 v239, v224, v225, v226
v_max_f32 v239, v239, v227
ds_read_b64_tr_b16 a[24:25], v248 offset:4608
v_max_f32 v176, v176, v160
v_max_f32 v177, v177, v161
v_max_f32 v178, v178, v162
v_max_f32 v179, v179, v163
v_max3_f32 v237, v176, v177, v178
buffer_load_dwordx4 v1, s[4:7], s44 offen offset:1024 sc1 lds
v_max_f32 v237, v237, v179
v_mfma_f32_16x16x32_bf16 v[184:187], v[164:167], v[180:183], v[20:23]
s_nop 0
v_permlane32_swap_b32 v239, v237
v_max_f32 v239, v239, v237
v_mov_b32 v242, v239
v_mfma_f32_16x16x32_bf16 v[200:203], v[188:191], v[180:183], v[24:27]
s_nop 0
v_permlane16_swap_b32 v239, v242
v_max_f32 v239, v239, v242
v_mov_b32 v242, v239
ds_read_b64_tr_b16 a[6:7], v248 offset:1024
s_nop 0
v_permlane32_swap_b32 v239, v242
v_mul_f32_e64 v89, -v239, v88
v_fma_f32 v224, v224, v88, v89
v_fma_f32 v225, v225, v88, v89
v_fma_f32 v226, v226, v88, v89
v_fma_f32 v227, v227, v88, v89
v_exp_f32 v224, v224
v_exp_f32 v225, v225
v_exp_f32 v226, v226
buffer_load_dwordx4 v1, s[4:7], s44 offen offset:2048 sc1 lds
v_exp_f32 v227, v227
v_cvt_pk_bf16_f32 v224, v224, v225
v_cvt_pk_bf16_f32 v225, v226, v227
v_and_b32 v208, v224, v28
v_and_b32 v209, v225, v29
v_and_b32 v210, v224, v30
v_and_b32 v211, v225, v31
v_max_f32 v200, v200, v184
v_max_f32 v201, v201, v185
v_mfma_f32_16x16x32_bf16 v[216:219], v[16:19], v[208:211], 0
v_max_f32 v202, v202, v186
v_max_f32 v203, v203, v187
s_waitcnt lgkmcnt(3)
v_mfma_f32_16x16x32_bf16 v[116:119], a[10:13], v[208:211], 0
v_max3_f32 v238, v200, v201, v202
ds_read_b64_tr_b16 a[18:19], v248 offset:1536
s_waitcnt lgkmcnt(2)
v_mfma_f32_16x16x32_bf16 v[120:123], a[22:25], v[208:211], 0
v_rcp_f32 v216, v216
ds_read_b64_tr_b16 a[8:9], v248 offset:2048
ds_read_b64_tr_b16 a[20:21], v248 offset:2560
buffer_load_dwordx4 v1, s[4:7], s44 offen offset:3072 sc1 lds
v_pk_mul_f32 v[116:117], v[116:117], v[216:217] op_sel:[0,0] op_sel_hi:[1,0]
v_pk_mul_f32 v[118:119], v[118:119], v[216:217] op_sel:[0,0] op_sel_hi:[1,0]
v_cvt_pk_bf16_f32 v116, v116, v117
s_nop 0
v_pk_mul_f32 v[120:121], v[120:121], v[216:217] op_sel:[0,0] op_sel_hi:[1,0]
v_pk_mul_f32 v[122:123], v[122:123], v[216:217] op_sel:[0,0] op_sel_hi:[1,0]
v_cvt_pk_bf16_f32 v117, v118, v119
v_cvt_pk_bf16_f32 v118, v120, v121
v_cvt_pk_bf16_f32 v119, v122, v123
v_max_f32 v238, v238, v203
buffer_store_dwordx4 v[116:119], v2, s[4:7], s72 offen offset:3072 sc1
s_waitcnt lgkmcnt(0)
s_cmp_lg_u32 s28, 0
s_cbranch_scc1 Lhx_36
s_waitcnt vmcnt(10)
v_max3_u32 v244, v228, v229, v230
s_waitcnt vmcnt(9)
v_max3_u32 v244, v244, v231, v72
v_max3_u32 v244, v244, v73, v74
v_max_u32 v244, v244, v75
v_cmp_eq_u32 vcc, -1, v244
s_cbranch_vccnz L_hxredo2
L_hxback2:
ds_write_b128 v233, v[228:231] offset:20480
ds_write_b64 v232, v[72:73] offset:0
ds_write_b64 v232, v[74:75] offset:512
Lhx_36:
ds_read_b128 a[0:3], v233 offset:20480
v_mfma_f32_16x16x32_bf16 v[152:155], v[140:143], v[132:135], v[24:27]
v_mul_f32_e64 v85, -v242, v84
v_fma_f32 v176, v176, v84, v85
v_fma_f32 v177, v177, v84, v85
v_fma_f32 v178, v178, v84, v85
v_fma_f32 v179, v179, v84, v85
L_stub13:
s_cbranch_execz L_wret3
v_exp_f32 v176, v176
v_exp_f32 v177, v177
v_exp_f32 v178, v178
v_exp_f32 v179, v179
v_cvt_pk_bf16_f32 v176, v176, v177
v_cvt_pk_bf16_f32 v177, v178, v179
v_and_b32 v160, v176, v28
v_and_b32 v161, v177, v29
v_and_b32 v162, v176, v30
v_and_b32 v163, v177, v31
ds_read_b64_tr_b16 a[4:5], v248 offset:0
s_nop 0
v_mfma_f32_16x16x32_bf16 v[168:171], v[16:19], v[160:163], 0
ds_read_b64_tr_b16 a[16:17], v248 offset:512
v_mfma_f32_16x16x32_bf16 v[100:103], a[6:9], v[160:163], 0
s_waitcnt lgkmcnt(2)
v_mfma_f32_16x16x32_bf16 v[136:139], a[0:3], v[132:135], v[76:79]
s_nop 3
v_rcp_f32 v168, v168
v_mfma_f32_16x16x32_bf16 v[104:107], a[18:21], v[160:163], 0
s_nop 1
v_max_f32 v152, v152, v136
v_max_f32 v153, v153, v137
v_max_f32 v154, v154, v138
v_max_f32 v155, v155, v139
v_max3_f32 v236, v152, v153, v154
v_max_f32 v236, v236, v155
v_pk_mul_f32 v[100:101], v[100:101], v[168:169] op_sel:[0,0] op_sel_hi:[1,0]
v_pk_mul_f32 v[102:103], v[102:103], v[168:169] op_sel:[0,0] op_sel_hi:[1,0]
v_permlane32_swap_b32 v238, v236
v_max_f32 v238, v238, v236
v_mov_b32 v243, v238
buffer_atomic_add v12, v10, s[4:7], s94 offen sc1
v_cvt_pk_bf16_f32 v100, v100, v101
v_pk_mul_f32 v[104:105], v[104:105], v[168:169] op_sel:[0,0] op_sel_hi:[1,0]
v_permlane16_swap_b32 v238, v243
v_max_f32 v238, v238, v243
v_mov_b32 v243, v238
v_pk_mul_f32 v[106:107], v[106:107], v[168:169] op_sel:[0,0] op_sel_hi:[1,0]
v_cvt_pk_bf16_f32 v101, v102, v103
v_permlane32_swap_b32 v238, v243
v_mul_f32_e64 v87, -v238, v86
v_fma_f32 v200, v200, v86, v87
v_fma_f32 v201, v201, v86, v87
v_fma_f32 v202, v202, v86, v87
v_fma_f32 v203, v203, v86, v87
v_exp_f32 v200, v200
v_exp_f32 v201, v201
v_exp_f32 v202, v202
v_exp_f32 v203, v203
v_cvt_pk_bf16_f32 v200, v200, v201
v_cvt_pk_bf16_f32 v201, v202, v203
v_and_b32 v184, v200, v28
v_and_b32 v185, v201, v29
v_and_b32 v186, v200, v30
v_and_b32 v187, v201, v31
v_cvt_pk_bf16_f32 v102, v104, v105
v_cvt_pk_bf16_f32 v103, v106, v107
v_mfma_f32_16x16x32_bf16 v[192:195], v[16:19], v[184:187], 0
buffer_store_dwordx4 v[100:103], v2, s[4:7], s72 offen offset:1024 sc1
v_mul_f32_e64 v83, -v243, v82
v_mfma_f32_16x16x32_bf16 v[108:111], a[8:11], v[184:187], 0
v_fma_f32 v152, v152, v82, v83
v_fma_f32 v153, v153, v82, v83
v_fma_f32 v154, v154, v82, v83
v_fma_f32 v155, v155, v82, v83
v_mfma_f32_16x16x32_bf16 v[112:115], a[20:23], v[184:187], 0
v_exp_f32 v152, v152
v_exp_f32 v153, v153
v_exp_f32 v154, v154
v_exp_f32 v155, v155
v_rcp_f32 v192, v192
v_cvt_pk_bf16_f32 v152, v152, v153
v_cvt_pk_bf16_f32 v153, v154, v155
v_and_b32 v136, v152, v80
v_and_b32 v137, v153, v81
v_and_b32 v138, v152, v30
v_and_b32 v139, v153, v31
v_pk_mul_f32 v[108:109], v[108:109], v[192:193] op_sel:[0,0] op_sel_hi:[1,0]
v_pk_mul_f32 v[110:111], v[110:111], v[192:193] op_sel:[0,0] op_sel_hi:[1,0]
v_cvt_pk_bf16_f32 v108, v108, v109
v_pk_mul_f32 v[112:113], v[112:113], v[192:193] op_sel:[0,0] op_sel_hi:[1,0]
v_cvt_pk_bf16_f32 v109, v110, v111
v_pk_mul_f32 v[114:115], v[114:115], v[192:193] op_sel:[0,0] op_sel_hi:[1,0]
v_cvt_pk_bf16_f32 v110, v112, v113
v_mfma_f32_16x16x32_bf16 v[144:147], v[16:19], v[136:139], 0
v_cvt_pk_bf16_f32 v111, v114, v115
buffer_store_dwordx4 v[108:111], v2, s[4:7], s72 offen offset:2048 sc1
s_waitcnt lgkmcnt(1)
v_mfma_f32_16x16x32_bf16 v[92:95], a[4:7], v[136:139], 0
s_nop 3
v_rcp_f32 v144, v144
s_waitcnt lgkmcnt(0)
v_mfma_f32_16x16x32_bf16 v[96:99], a[16:19], v[136:139], 0
s_nop 0
v_pk_mul_f32 v[92:93], v[92:93], v[144:145] op_sel:[0,0] op_sel_hi:[1,0]
v_pk_mul_f32 v[94:95], v[94:95], v[144:145] op_sel:[0,0] op_sel_hi:[1,0]
v_cvt_pk_bf16_f32 v92, v92, v93
v_cvt_pk_bf16_f32 v93, v94, v95
s_nop 2
v_pk_mul_f32 v[96:97], v[96:97], v[144:145] op_sel:[0,0] op_sel_hi:[1,0]
v_pk_mul_f32 v[98:99], v[98:99], v[144:145] op_sel:[0,0] op_sel_hi:[1,0]
v_cvt_pk_bf16_f32 v94, v96, v97
v_cvt_pk_bf16_f32 v95, v98, v99
buffer_store_dwordx4 v[92:95], v2, s[4:7], s72 offen offset:0 sc1
s_add_u32 s92, s71, 0x20000
s_add_u32 s40, s4, 0x800000
s_addc_u32 s41, s5, 0
v_add_u32 v5, 32768, v1
v_add_u32 v6, 98304, v1
s_mov_b32 s35, s77
v_lshlrev_b32 v132, 16, v32
v_and_b32 v133, 0xffff0000, v32
v_lshlrev_b32 v134, 16, v33
v_and_b32 v135, 0xffff0000, v33
v_lshlrev_b32 v136, 16, v34
v_and_b32 v137, 0xffff0000, v34
v_lshlrev_b32 v138, 16, v35
v_and_b32 v139, 0xffff0000, v35
v_lshlrev_b32 v140, 16, v36
v_and_b32 v141, 0xffff0000, v36
v_lshlrev_b32 v142, 16, v37
v_and_b32 v143, 0xffff0000, v37
v_lshlrev_b32 v144, 16, v38
v_and_b32 v145, 0xffff0000, v38
v_lshlrev_b32 v146, 16, v39
v_and_b32 v147, 0xffff0000, v39
v_lshlrev_b32 v148, 16, v40
v_and_b32 v149, 0xffff0000, v40
v_lshlrev_b32 v150, 16, v41
v_and_b32 v151, 0xffff0000, v41
v_lshlrev_b32 v152, 16, v42
v_and_b32 v153, 0xffff0000, v42
v_lshlrev_b32 v154, 16, v43
v_and_b32 v155, 0xffff0000, v43
v_lshlrev_b32 v156, 16, v44
v_and_b32 v157, 0xffff0000, v44
v_lshlrev_b32 v158, 16, v45
v_and_b32 v159, 0xffff0000, v45
v_lshlrev_b32 v160, 16, v46
v_and_b32 v161, 0xffff0000, v46
v_lshlrev_b32 v162, 16, v47
v_and_b32 v163, 0xffff0000, v47
s_mov_b32 s95, -1
s_mov_b64 exec, 0
s_cmp_eq_u32 s28, 3
s_cbranch_scc1 L_stub14
s_cmp_eq_u32 s28, 2
s_cbranch_scc1 L_stub17
s_cmp_eq_u32 s28, 0
s_cbranch_scc1 L_stub18
L_wret5:
s_mov_b64 exec, -1
s_cmp_lg_u32 s28, 1
s_cbranch_scc1 Lpo_39
s_add_u32 s36, s11, 0x20080
s_mov_b32 s37, 0
v_mov_b32 v11, 0
buffer_atomic_add v11, v251, s[4:7], s36 offen sc0 sc1
s_sleep 4
Lpoll_37:
v_mov_b32 v234, 0
buffer_atomic_add v234, v251, s[4:7], s36 offen sc0 sc1
s_waitcnt vmcnt(1)
v_readfirstlane_b32 s38, v11
s_nop 0
s_cmp_ge_u32 s38, 32
s_cbranch_scc1 Lpe_38
v_mov_b32 v11, 0
buffer_atomic_add v11, v251, s[4:7], s36 offen sc0 sc1
s_waitcnt vmcnt(1)
v_readfirstlane_b32 s38, v234
s_nop 0
s_cmp_ge_u32 s38, 32
s_cbranch_scc1 Lpe_38
s_add_u32 s37, s37, 1
s_cmp_lt_u32 s37, 0x80000
s_cbranch_scc1 Lpoll_37
s_waitcnt vmcnt(0)
Lpo_39:
s_waitcnt vmcnt(0)
Lpe_38:
s_barrier
L_k2go2:
buffer_load_dwordx4 a[0:3], v4, s[40:43], s35 offen offset:0 sc1
buffer_load_dwordx4 a[4:7], v4, s[40:43], s35 offen offset:1024 sc1
s_xor_b32 s35, s77, 4096
buffer_load_dwordx4 a[8:11], v4, s[40:43], s35 offen offset:0 sc1
buffer_load_dwordx4 a[12:15], v4, s[40:43], s35 offen offset:1024 sc1
s_xor_b32 s35, s77, 16384
buffer_load_dwordx4 a[16:19], v4, s[40:43], s35 offen offset:0 sc1
buffer_load_dwordx4 a[20:23], v4, s[40:43], s35 offen offset:1024 sc1
s_xor_b32 s35, s77, 20480
buffer_load_dwordx4 a[24:27], v4, s[40:43], s35 offen offset:0 sc1
buffer_load_dwordx4 a[28:31], v4, s[40:43], s35 offen offset:1024 sc1
s_xor_b32 s35, s77, 32768
buffer_load_dwordx4 a[32:35], v4, s[40:43], s35 offen offset:0 sc1
buffer_load_dwordx4 a[36:39], v4, s[40:43], s35 offen offset:1024 sc1
s_xor_b32 s35, s77, 36864
buffer_load_dwordx4 a[40:43], v4, s[40:43], s35 offen offset:0 sc1
buffer_load_dwordx4 a[44:47], v4, s[40:43], s35 offen offset:1024 sc1
s_xor_b32 s35, s77, 49152
ds_read_b128 a[96:99], v5 offset:0
ds_read_b128 a[100:103], v5 offset:1024
ds_read_b128 a[104:107], v5 offset:2048
ds_read_b128 a[108:111], v5 offset:3072
ds_read_b128 a[112:115], v5 offset:4096
ds_read_b128 a[116:119], v5 offset:5120
ds_read_b128 a[120:123], v5 offset:6144
ds_read_b128 a[124:127], v5 offset:7168
s_waitcnt vmcnt(10) lgkmcnt(4)
v_mfma_f32_16x16x32_bf16 v[132:135], a[96:99], a[0:3], v[132:135]
ds_read_b128 a[128:131], v5 offset:8192
v_mfma_f32_16x16x32_bf16 v[148:151], a[96:99], a[4:7], v[148:151]
ds_read_b128 a[132:135], v5 offset:9216
v_mfma_f32_16x16x32_bf16 v[152:155], a[100:103], a[4:7], v[152:155]
buffer_load_dwordx4 a[48:51], v4, s[40:43], s35 offen offset:0 sc1
v_mfma_f32_16x16x32_bf16 v[136:139], a[100:103], a[0:3], v[136:139]
ds_read_b128 a[136:139], v5 offset:10240
v_mfma_f32_16x16x32_bf16 v[140:143], a[104:107], a[0:3], v[140:143]
ds_read_b128 a[140:143], v5 offset:11264
v_mfma_f32_16x16x32_bf16 v[156:159], a[104:107], a[4:7], v[156:159]
v_mfma_f32_16x16x32_bf16 v[160:163], a[108:111], a[4:7], v[160:163]
buffer_load_dwordx4 a[52:55], v4, s[40:43], s35 offen offset:1024 sc1
s_xor_b32 s35, s77, 53248
v_mfma_f32_16x16x32_bf16 v[144:147], a[108:111], a[0:3], v[144:147]
s_waitcnt vmcnt(10) lgkmcnt(4)
v_mfma_f32_16x16x32_bf16 v[132:135], a[112:115], a[8:11], v[132:135]
ds_read_b128 a[96:99], v5 offset:12288
v_mfma_f32_16x16x32_bf16 v[148:151], a[112:115], a[12:15], v[148:151]
ds_read_b128 a[100:103], v5 offset:13312
v_mfma_f32_16x16x32_bf16 v[152:155], a[116:119], a[12:15], v[152:155]
buffer_load_dwordx4 a[0:3], v4, s[40:43], s35 offen offset:0 sc1
v_mfma_f32_16x16x32_bf16 v[136:139], a[116:119], a[8:11], v[136:139]
ds_read_b128 a[104:107], v5 offset:14336
v_mfma_f32_16x16x32_bf16 v[140:143], a[120:123], a[8:11], v[140:143]
ds_read_b128 a[108:111], v5 offset:15360
v_mfma_f32_16x16x32_bf16 v[156:159], a[120:123], a[12:15], v[156:159]
v_mfma_f32_16x16x32_bf16 v[160:163], a[124:127], a[12:15], v[160:163]
buffer_load_dwordx4 a[4:7], v4, s[40:43], s35 offen offset:1024 sc1
s_xor_b32 s35, s77, 65536
v_mfma_f32_16x16x32_bf16 v[144:147], a[124:127], a[8:11], v[144:147]
s_waitcnt vmcnt(10) lgkmcnt(4)
v_mfma_f32_16x16x32_bf16 v[132:135], a[128:131], a[16:19], v[132:135]
ds_read_b128 a[112:115], v5 offset:16384
v_mfma_f32_16x16x32_bf16 v[148:151], a[128:131], a[20:23], v[148:151]
ds_read_b128 a[116:119], v5 offset:17408
v_mfma_f32_16x16x32_bf16 v[152:155], a[132:135], a[20:23], v[152:155]
buffer_load_dwordx4 a[8:11], v4, s[40:43], s35 offen offset:0 sc1
v_mfma_f32_16x16x32_bf16 v[136:139], a[132:135], a[16:19], v[136:139]
ds_read_b128 a[120:123], v5 offset:18432
v_mfma_f32_16x16x32_bf16 v[140:143], a[136:139], a[16:19], v[140:143]
ds_read_b128 a[124:127], v5 offset:19456
v_mfma_f32_16x16x32_bf16 v[156:159], a[136:139], a[20:23], v[156:159]
v_mfma_f32_16x16x32_bf16 v[160:163], a[140:143], a[20:23], v[160:163]
buffer_load_dwordx4 a[12:15], v4, s[40:43], s35 offen offset:1024 sc1
s_xor_b32 s35, s77, 69632
v_mfma_f32_16x16x32_bf16 v[144:147], a[140:143], a[16:19], v[144:147]
s_waitcnt vmcnt(10) lgkmcnt(4)
v_mfma_f32_16x16x32_bf16 v[132:135], a[96:99], a[24:27], v[132:135]
ds_read_b128 a[128:131], v5 offset:20480
v_mfma_f32_16x16x32_bf16 v[148:151], a[96:99], a[28:31], v[148:151]
ds_read_b128 a[132:135], v5 offset:21504
v_mfma_f32_16x16x32_bf16 v[152:155], a[100:103], a[28:31], v[152:155]
buffer_load_dwordx4 a[16:19], v4, s[40:43], s35 offen offset:0 sc1
v_mfma_f32_16x16x32_bf16 v[136:139], a[100:103], a[24:27], v[136:139]
ds_read_b128 a[136:139], v5 offset:22528
v_mfma_f32_16x16x32_bf16 v[140:143], a[104:107], a[24:27], v[140:143]
ds_read_b128 a[140:143], v5 offset:23552
v_mfma_f32_16x16x32_bf16 v[156:159], a[104:107], a[28:31], v[156:159]
v_mfma_f32_16x16x32_bf16 v[160:163], a[108:111], a[28:31], v[160:163]
buffer_load_dwordx4 a[20:23], v4, s[40:43], s35 offen offset:1024 sc1
s_xor_b32 s35, s77, 81920
v_mfma_f32_16x16x32_bf16 v[144:147], a[108:111], a[24:27], v[144:147]
s_waitcnt vmcnt(10) lgkmcnt(4)
v_mfma_f32_16x16x32_bf16 v[132:135], a[112:115], a[32:35], v[132:135]
ds_read_b128 a[96:99], v5 offset:24576
v_mfma_f32_16x16x32_bf16 v[148:151], a[112:115], a[36:39], v[148:151]
ds_read_b128 a[100:103], v5 offset:25600
v_mfma_f32_16x16x32_bf16 v[152:155], a[116:119], a[36:39], v[152:155]
buffer_load_dwordx4 a[24:27], v4, s[40:43], s35 offen offset:0 sc1
v_mfma_f32_16x16x32_bf16 v[136:139], a[116:119], a[32:35], v[136:139]
ds_read_b128 a[104:107], v5 offset:26624
v_mfma_f32_16x16x32_bf16 v[140:143], a[120:123], a[32:35], v[140:143]
ds_read_b128 a[108:111], v5 offset:27648
v_mfma_f32_16x16x32_bf16 v[156:159], a[120:123], a[36:39], v[156:159]
v_mfma_f32_16x16x32_bf16 v[160:163], a[124:127], a[36:39], v[160:163]
buffer_load_dwordx4 a[28:31], v4, s[40:43], s35 offen offset:1024 sc1
s_xor_b32 s35, s77, 86016
v_mfma_f32_16x16x32_bf16 v[144:147], a[124:127], a[32:35], v[144:147]
s_waitcnt vmcnt(10) lgkmcnt(4)
v_mfma_f32_16x16x32_bf16 v[132:135], a[128:131], a[40:43], v[132:135]
ds_read_b128 a[112:115], v5 offset:28672
v_mfma_f32_16x16x32_bf16 v[148:151], a[128:131], a[44:47], v[148:151]
ds_read_b128 a[116:119], v5 offset:29696
v_mfma_f32_16x16x32_bf16 v[152:155], a[132:135], a[44:47], v[152:155]
buffer_load_dwordx4 a[32:35], v4, s[40:43], s35 offen offset:0 sc1
v_mfma_f32_16x16x32_bf16 v[136:139], a[132:135], a[40:43], v[136:139]
ds_read_b128 a[120:123], v5 offset:30720
v_mfma_f32_16x16x32_bf16 v[140:143], a[136:139], a[40:43], v[140:143]
ds_read_b128 a[124:127], v5 offset:31744
v_mfma_f32_16x16x32_bf16 v[156:159], a[136:139], a[44:47], v[156:159]
v_mfma_f32_16x16x32_bf16 v[160:163], a[140:143], a[44:47], v[160:163]
buffer_load_dwordx4 a[36:39], v4, s[40:43], s35 offen offset:1024 sc1
s_xor_b32 s35, s77, 98304
v_mfma_f32_16x16x32_bf16 v[144:147], a[140:143], a[40:43], v[144:147]
s_waitcnt vmcnt(10) lgkmcnt(4)
v_mfma_f32_16x16x32_bf16 v[132:135], a[96:99], a[48:51], v[132:135]
ds_read_b128 a[128:131], v5 offset:32768
v_mfma_f32_16x16x32_bf16 v[148:151], a[96:99], a[52:55], v[148:151]
ds_read_b128 a[132:135], v5 offset:33792
v_mfma_f32_16x16x32_bf16 v[152:155], a[100:103], a[52:55], v[152:155]
buffer_load_dwordx4 a[40:43], v4, s[40:43], s35 offen offset:0 sc1
v_mfma_f32_16x16x32_bf16 v[136:139], a[100:103], a[48:51], v[136:139]
ds_read_b128 a[136:139], v5 offset:34816
v_mfma_f32_16x16x32_bf16 v[140:143], a[104:107], a[48:51], v[140:143]
ds_read_b128 a[140:143], v5 offset:35840
v_mfma_f32_16x16x32_bf16 v[156:159], a[104:107], a[52:55], v[156:159]
v_mfma_f32_16x16x32_bf16 v[160:163], a[108:111], a[52:55], v[160:163]
buffer_load_dwordx4 a[44:47], v4, s[40:43], s35 offen offset:1024 sc1
s_xor_b32 s35, s77, 102400
v_mfma_f32_16x16x32_bf16 v[144:147], a[108:111], a[48:51], v[144:147]
s_waitcnt vmcnt(10) lgkmcnt(4)
v_mfma_f32_16x16x32_bf16 v[132:135], a[112:115], a[0:3], v[132:135]
ds_read_b128 a[96:99], v5 offset:36864
v_mfma_f32_16x16x32_bf16 v[148:151], a[112:115], a[4:7], v[148:151]
ds_read_b128 a[100:103], v5 offset:37888
v_mfma_f32_16x16x32_bf16 v[152:155], a[116:119], a[4:7], v[152:155]
buffer_load_dwordx4 a[48:51], v4, s[40:43], s35 offen offset:0 sc1
v_mfma_f32_16x16x32_bf16 v[136:139], a[116:119], a[0:3], v[136:139]
ds_read_b128 a[104:107], v5 offset:38912
v_mfma_f32_16x16x32_bf16 v[140:143], a[120:123], a[0:3], v[140:143]
ds_read_b128 a[108:111], v5 offset:39936
v_mfma_f32_16x16x32_bf16 v[156:159], a[120:123], a[4:7], v[156:159]
v_mfma_f32_16x16x32_bf16 v[160:163], a[124:127], a[4:7], v[160:163]
buffer_load_dwordx4 a[52:55], v4, s[40:43], s35 offen offset:1024 sc1
s_xor_b32 s35, s77, 114688
v_mfma_f32_16x16x32_bf16 v[144:147], a[124:127], a[0:3], v[144:147]
s_waitcnt vmcnt(10) lgkmcnt(4)
v_mfma_f32_16x16x32_bf16 v[132:135], a[128:131], a[8:11], v[132:135]
ds_read_b128 a[112:115], v5 offset:40960
v_mfma_f32_16x16x32_bf16 v[148:151], a[128:131], a[12:15], v[148:151]
ds_read_b128 a[116:119], v5 offset:41984
v_mfma_f32_16x16x32_bf16 v[152:155], a[132:135], a[12:15], v[152:155]
buffer_load_dwordx4 a[0:3], v4, s[40:43], s35 offen offset:0 sc1
v_mfma_f32_16x16x32_bf16 v[136:139], a[132:135], a[8:11], v[136:139]
ds_read_b128 a[120:123], v5 offset:43008
v_mfma_f32_16x16x32_bf16 v[140:143], a[136:139], a[8:11], v[140:143]
ds_read_b128 a[124:127], v5 offset:44032
v_mfma_f32_16x16x32_bf16 v[156:159], a[136:139], a[12:15], v[156:159]
v_mfma_f32_16x16x32_bf16 v[160:163], a[140:143], a[12:15], v[160:163]
buffer_load_dwordx4 a[4:7], v4, s[40:43], s35 offen offset:1024 sc1
s_xor_b32 s35, s77, 118784
v_mfma_f32_16x16x32_bf16 v[144:147], a[140:143], a[8:11], v[144:147]
s_waitcnt vmcnt(10) lgkmcnt(4)
v_mfma_f32_16x16x32_bf16 v[132:135], a[96:99], a[16:19], v[132:135]
ds_read_b128 a[128:131], v5 offset:45056
v_mfma_f32_16x16x32_bf16 v[148:151], a[96:99], a[20:23], v[148:151]
ds_read_b128 a[132:135], v5 offset:46080
v_mfma_f32_16x16x32_bf16 v[152:155], a[100:103], a[20:23], v[152:155]
buffer_load_dwordx4 a[8:11], v4, s[40:43], s35 offen offset:0 sc1
v_mfma_f32_16x16x32_bf16 v[136:139], a[100:103], a[16:19], v[136:139]
ds_read_b128 a[136:139], v5 offset:47104
v_mfma_f32_16x16x32_bf16 v[140:143], a[104:107], a[16:19], v[140:143]
ds_read_b128 a[140:143], v5 offset:48128
v_mfma_f32_16x16x32_bf16 v[156:159], a[104:107], a[20:23], v[156:159]
v_mfma_f32_16x16x32_bf16 v[160:163], a[108:111], a[20:23], v[160:163]
buffer_load_dwordx4 a[12:15], v4, s[40:43], s35 offen offset:1024 sc1
s_xor_b32 s35, s77, 524288
v_mfma_f32_16x16x32_bf16 v[144:147], a[108:111], a[16:19], v[144:147]
s_waitcnt vmcnt(10) lgkmcnt(4)
v_mfma_f32_16x16x32_bf16 v[132:135], a[112:115], a[24:27], v[132:135]
ds_read_b128 a[96:99], v5 offset:49152
v_mfma_f32_16x16x32_bf16 v[148:151], a[112:115], a[28:31], v[148:151]
ds_read_b128 a[100:103], v5 offset:50176
v_mfma_f32_16x16x32_bf16 v[152:155], a[116:119], a[28:31], v[152:155]
buffer_load_dwordx4 a[16:19], v4, s[40:43], s35 offen offset:0 sc1
v_mfma_f32_16x16x32_bf16 v[136:139], a[116:119], a[24:27], v[136:139]
ds_read_b128 a[104:107], v5 offset:51200
v_mfma_f32_16x16x32_bf16 v[140:143], a[120:123], a[24:27], v[140:143]
ds_read_b128 a[108:111], v5 offset:52224
v_mfma_f32_16x16x32_bf16 v[156:159], a[120:123], a[28:31], v[156:159]
v_mfma_f32_16x16x32_bf16 v[160:163], a[124:127], a[28:31], v[160:163]
buffer_load_dwordx4 a[20:23], v4, s[40:43], s35 offen offset:1024 sc1
s_xor_b32 s35, s77, 528384
v_mfma_f32_16x16x32_bf16 v[144:147], a[124:127], a[24:27], v[144:147]
s_waitcnt vmcnt(10) lgkmcnt(4)
v_mfma_f32_16x16x32_bf16 v[132:135], a[128:131], a[32:35], v[132:135]
ds_read_b128 a[112:115], v5 offset:53248
v_mfma_f32_16x16x32_bf16 v[148:151], a[128:131], a[36:39], v[148:151]
ds_read_b128 a[116:119], v5 offset:54272
v_mfma_f32_16x16x32_bf16 v[152:155], a[132:135], a[36:39], v[152:155]
buffer_load_dwordx4 a[24:27], v4, s[40:43], s35 offen offset:0 sc1
v_mfma_f32_16x16x32_bf16 v[136:139], a[132:135], a[32:35], v[136:139]
ds_read_b128 a[120:123], v5 offset:55296
v_mfma_f32_16x16x32_bf16 v[140:143], a[136:139], a[32:35], v[140:143]
ds_read_b128 a[124:127], v5 offset:56320
v_mfma_f32_16x16x32_bf16 v[156:159], a[136:139], a[36:39], v[156:159]
v_mfma_f32_16x16x32_bf16 v[160:163], a[140:143], a[36:39], v[160:163]
buffer_load_dwordx4 a[28:31], v4, s[40:43], s35 offen offset:1024 sc1
s_xor_b32 s35, s77, 540672
v_mfma_f32_16x16x32_bf16 v[144:147], a[140:143], a[32:35], v[144:147]
s_waitcnt vmcnt(10) lgkmcnt(4)
v_mfma_f32_16x16x32_bf16 v[132:135], a[96:99], a[40:43], v[132:135]
ds_read_b128 a[128:131], v5 offset:57344
v_mfma_f32_16x16x32_bf16 v[148:151], a[96:99], a[44:47], v[148:151]
ds_read_b128 a[132:135], v5 offset:58368
v_mfma_f32_16x16x32_bf16 v[152:155], a[100:103], a[44:47], v[152:155]
buffer_load_dwordx4 a[32:35], v4, s[40:43], s35 offen offset:0 sc1
v_mfma_f32_16x16x32_bf16 v[136:139], a[100:103], a[40:43], v[136:139]
ds_read_b128 a[136:139], v5 offset:59392
v_mfma_f32_16x16x32_bf16 v[140:143], a[104:107], a[40:43], v[140:143]
ds_read_b128 a[140:143], v5 offset:60416
v_mfma_f32_16x16x32_bf16 v[156:159], a[104:107], a[44:47], v[156:159]
v_mfma_f32_16x16x32_bf16 v[160:163], a[108:111], a[44:47], v[160:163]
buffer_load_dwordx4 a[36:39], v4, s[40:43], s35 offen offset:1024 sc1
s_xor_b32 s35, s77, 544768
v_mfma_f32_16x16x32_bf16 v[144:147], a[108:111], a[40:43], v[144:147]
s_waitcnt vmcnt(10) lgkmcnt(4)
v_mfma_f32_16x16x32_bf16 v[132:135], a[112:115], a[48:51], v[132:135]
ds_read_b128 a[96:99], v5 offset:61440
v_mfma_f32_16x16x32_bf16 v[148:151], a[112:115], a[52:55], v[148:151]
ds_read_b128 a[100:103], v5 offset:62464
v_mfma_f32_16x16x32_bf16 v[152:155], a[116:119], a[52:55], v[152:155]
buffer_load_dwordx4 a[40:43], v4, s[40:43], s35 offen offset:0 sc1
v_mfma_f32_16x16x32_bf16 v[136:139], a[116:119], a[48:51], v[136:139]
ds_read_b128 a[104:107], v5 offset:63488
v_mfma_f32_16x16x32_bf16 v[140:143], a[120:123], a[48:51], v[140:143]
ds_read_b128 a[108:111], v5 offset:64512
v_mfma_f32_16x16x32_bf16 v[156:159], a[120:123], a[52:55], v[156:159]
v_mfma_f32_16x16x32_bf16 v[160:163], a[124:127], a[52:55], v[160:163]
buffer_load_dwordx4 a[44:47], v4, s[40:43], s35 offen offset:1024 sc1
s_xor_b32 s35, s77, 557056
v_mfma_f32_16x16x32_bf16 v[144:147], a[124:127], a[48:51], v[144:147]
s_waitcnt vmcnt(10) lgkmcnt(4)
v_mfma_f32_16x16x32_bf16 v[132:135], a[128:131], a[0:3], v[132:135]
ds_read_b128 a[112:115], v6 offset:0
v_mfma_f32_16x16x32_bf16 v[148:151], a[128:131], a[4:7], v[148:151]
ds_read_b128 a[116:119], v6 offset:1024
v_mfma_f32_16x16x32_bf16 v[152:155], a[132:135], a[4:7], v[152:155]
buffer_load_dwordx4 a[48:51], v4, s[40:43], s35 offen offset:0 sc1
v_mfma_f32_16x16x32_bf16 v[136:139], a[132:135], a[0:3], v[136:139]
ds_read_b128 a[120:123], v6 offset:2048
v_mfma_f32_16x16x32_bf16 v[140:143], a[136:139], a[0:3], v[140:143]
ds_read_b128 a[124:127], v6 offset:3072
v_mfma_f32_16x16x32_bf16 v[156:159], a[136:139], a[4:7], v[156:159]
v_mfma_f32_16x16x32_bf16 v[160:163], a[140:143], a[4:7], v[160:163]
buffer_load_dwordx4 a[52:55], v4, s[40:43], s35 offen offset:1024 sc1
s_xor_b32 s35, s77, 561152
v_mfma_f32_16x16x32_bf16 v[144:147], a[140:143], a[0:3], v[144:147]
s_waitcnt vmcnt(10) lgkmcnt(4)
v_mfma_f32_16x16x32_bf16 v[132:135], a[96:99], a[8:11], v[132:135]
ds_read_b128 a[128:131], v6 offset:4096
v_mfma_f32_16x16x32_bf16 v[148:151], a[96:99], a[12:15], v[148:151]
ds_read_b128 a[132:135], v6 offset:5120
v_mfma_f32_16x16x32_bf16 v[152:155], a[100:103], a[12:15], v[152:155]
buffer_load_dwordx4 a[0:3], v4, s[40:43], s35 offen offset:0 sc1
v_mfma_f32_16x16x32_bf16 v[136:139], a[100:103], a[8:11], v[136:139]
ds_read_b128 a[136:139], v6 offset:6144
v_mfma_f32_16x16x32_bf16 v[140:143], a[104:107], a[8:11], v[140:143]
ds_read_b128 a[140:143], v6 offset:7168
v_mfma_f32_16x16x32_bf16 v[156:159], a[104:107], a[12:15], v[156:159]
v_mfma_f32_16x16x32_bf16 v[160:163], a[108:111], a[12:15], v[160:163]
buffer_load_dwordx4 a[4:7], v4, s[40:43], s35 offen offset:1024 sc1
s_xor_b32 s35, s77, 573440
v_mfma_f32_16x16x32_bf16 v[144:147], a[108:111], a[8:11], v[144:147]
s_waitcnt vmcnt(10) lgkmcnt(4)
v_mfma_f32_16x16x32_bf16 v[132:135], a[112:115], a[16:19], v[132:135]
ds_read_b128 a[96:99], v6 offset:8192
v_mfma_f32_16x16x32_bf16 v[148:151], a[112:115], a[20:23], v[148:151]
ds_read_b128 a[100:103], v6 offset:9216
v_mfma_f32_16x16x32_bf16 v[152:155], a[116:119], a[20:23], v[152:155]
buffer_load_dwordx4 a[8:11], v4, s[40:43], s35 offen offset:0 sc1
v_mfma_f32_16x16x32_bf16 v[136:139], a[116:119], a[16:19], v[136:139]
ds_read_b128 a[104:107], v6 offset:10240
v_mfma_f32_16x16x32_bf16 v[140:143], a[120:123], a[16:19], v[140:143]
ds_read_b128 a[108:111], v6 offset:11264
v_mfma_f32_16x16x32_bf16 v[156:159], a[120:123], a[20:23], v[156:159]
v_mfma_f32_16x16x32_bf16 v[160:163], a[124:127], a[20:23], v[160:163]
buffer_load_dwordx4 a[12:15], v4, s[40:43], s35 offen offset:1024 sc1
s_xor_b32 s35, s77, 577536
v_mfma_f32_16x16x32_bf16 v[144:147], a[124:127], a[16:19], v[144:147]
s_waitcnt vmcnt(10) lgkmcnt(4)
v_mfma_f32_16x16x32_bf16 v[132:135], a[128:131], a[24:27], v[132:135]
ds_read_b128 a[112:115], v6 offset:12288
v_mfma_f32_16x16x32_bf16 v[148:151], a[128:131], a[28:31], v[148:151]
ds_read_b128 a[116:119], v6 offset:13312
v_mfma_f32_16x16x32_bf16 v[152:155], a[132:135], a[28:31], v[152:155]
buffer_load_dwordx4 a[16:19], v4, s[40:43], s35 offen offset:0 sc1
v_mfma_f32_16x16x32_bf16 v[136:139], a[132:135], a[24:27], v[136:139]
ds_read_b128 a[120:123], v6 offset:14336
v_mfma_f32_16x16x32_bf16 v[140:143], a[136:139], a[24:27], v[140:143]
ds_read_b128 a[124:127], v6 offset:15360
v_mfma_f32_16x16x32_bf16 v[156:159], a[136:139], a[28:31], v[156:159]
v_mfma_f32_16x16x32_bf16 v[160:163], a[140:143], a[28:31], v[160:163]
buffer_load_dwordx4 a[20:23], v4, s[40:43], s35 offen offset:1024 sc1
s_xor_b32 s35, s77, 589824
v_mfma_f32_16x16x32_bf16 v[144:147], a[140:143], a[24:27], v[144:147]
s_waitcnt vmcnt(10) lgkmcnt(4)
v_mfma_f32_16x16x32_bf16 v[132:135], a[96:99], a[32:35], v[132:135]
ds_read_b128 a[128:131], v6 offset:16384
v_mfma_f32_16x16x32_bf16 v[148:151], a[96:99], a[36:39], v[148:151]
ds_read_b128 a[132:135], v6 offset:17408
v_mfma_f32_16x16x32_bf16 v[152:155], a[100:103], a[36:39], v[152:155]
buffer_load_dwordx4 a[24:27], v4, s[40:43], s35 offen offset:0 sc1
v_mfma_f32_16x16x32_bf16 v[136:139], a[100:103], a[32:35], v[136:139]
ds_read_b128 a[136:139], v6 offset:18432
v_mfma_f32_16x16x32_bf16 v[140:143], a[104:107], a[32:35], v[140:143]
ds_read_b128 a[140:143], v6 offset:19456
v_mfma_f32_16x16x32_bf16 v[156:159], a[104:107], a[36:39], v[156:159]
v_mfma_f32_16x16x32_bf16 v[160:163], a[108:111], a[36:39], v[160:163]
buffer_load_dwordx4 a[28:31], v4, s[40:43], s35 offen offset:1024 sc1
s_xor_b32 s35, s77, 593920
v_mfma_f32_16x16x32_bf16 v[144:147], a[108:111], a[32:35], v[144:147]
s_waitcnt vmcnt(10) lgkmcnt(4)
v_mfma_f32_16x16x32_bf16 v[132:135], a[112:115], a[40:43], v[132:135]
ds_read_b128 a[96:99], v6 offset:20480
v_mfma_f32_16x16x32_bf16 v[148:151], a[112:115], a[44:47], v[148:151]
ds_read_b128 a[100:103], v6 offset:21504
v_mfma_f32_16x16x32_bf16 v[152:155], a[116:119], a[44:47], v[152:155]
buffer_load_dwordx4 a[32:35], v4, s[40:43], s35 offen offset:0 sc1
v_mfma_f32_16x16x32_bf16 v[136:139], a[116:119], a[40:43], v[136:139]
ds_read_b128 a[104:107], v6 offset:22528
v_mfma_f32_16x16x32_bf16 v[140:143], a[120:123], a[40:43], v[140:143]
ds_read_b128 a[108:111], v6 offset:23552
v_mfma_f32_16x16x32_bf16 v[156:159], a[120:123], a[44:47], v[156:159]
v_mfma_f32_16x16x32_bf16 v[160:163], a[124:127], a[44:47], v[160:163]
buffer_load_dwordx4 a[36:39], v4, s[40:43], s35 offen offset:1024 sc1
s_xor_b32 s35, s77, 606208
v_mfma_f32_16x16x32_bf16 v[144:147], a[124:127], a[40:43], v[144:147]
s_waitcnt vmcnt(10) lgkmcnt(4)
v_mfma_f32_16x16x32_bf16 v[132:135], a[128:131], a[48:51], v[132:135]
ds_read_b128 a[112:115], v6 offset:24576
v_mfma_f32_16x16x32_bf16 v[148:151], a[128:131], a[52:55], v[148:151]
ds_read_b128 a[116:119], v6 offset:25600
v_mfma_f32_16x16x32_bf16 v[152:155], a[132:135], a[52:55], v[152:155]
buffer_load_dwordx4 a[40:43], v4, s[40:43], s35 offen offset:0 sc1
v_mfma_f32_16x16x32_bf16 v[136:139], a[132:135], a[48:51], v[136:139]
ds_read_b128 a[120:123], v6 offset:26624
v_mfma_f32_16x16x32_bf16 v[140:143], a[136:139], a[48:51], v[140:143]
ds_read_b128 a[124:127], v6 offset:27648
v_mfma_f32_16x16x32_bf16 v[156:159], a[136:139], a[52:55], v[156:159]
v_mfma_f32_16x16x32_bf16 v[160:163], a[140:143], a[52:55], v[160:163]
buffer_load_dwordx4 a[44:47], v4, s[40:43], s35 offen offset:1024 sc1
s_xor_b32 s35, s77, 610304
v_mfma_f32_16x16x32_bf16 v[144:147], a[140:143], a[48:51], v[144:147]
s_waitcnt vmcnt(10) lgkmcnt(4)
v_mfma_f32_16x16x32_bf16 v[132:135], a[96:99], a[0:3], v[132:135]
ds_read_b128 a[128:131], v6 offset:28672
v_mfma_f32_16x16x32_bf16 v[148:151], a[96:99], a[4:7], v[148:151]
ds_read_b128 a[132:135], v6 offset:29696
v_mfma_f32_16x16x32_bf16 v[152:155], a[100:103], a[4:7], v[152:155]
buffer_load_dwordx4 a[48:51], v4, s[40:43], s35 offen offset:0 sc1
v_mfma_f32_16x16x32_bf16 v[136:139], a[100:103], a[0:3], v[136:139]
ds_read_b128 a[136:139], v6 offset:30720
v_mfma_f32_16x16x32_bf16 v[140:143], a[104:107], a[0:3], v[140:143]
ds_read_b128 a[140:143], v6 offset:31744
v_mfma_f32_16x16x32_bf16 v[156:159], a[104:107], a[4:7], v[156:159]
v_mfma_f32_16x16x32_bf16 v[160:163], a[108:111], a[4:7], v[160:163]
buffer_load_dwordx4 a[52:55], v4, s[40:43], s35 offen offset:1024 sc1
s_xor_b32 s35, s77, 622592
v_mfma_f32_16x16x32_bf16 v[144:147], a[108:111], a[0:3], v[144:147]
s_waitcnt vmcnt(10) lgkmcnt(4)
v_mfma_f32_16x16x32_bf16 v[132:135], a[112:115], a[8:11], v[132:135]
ds_read_b128 a[96:99], v6 offset:32768
v_mfma_f32_16x16x32_bf16 v[148:151], a[112:115], a[12:15], v[148:151]
ds_read_b128 a[100:103], v6 offset:33792
v_mfma_f32_16x16x32_bf16 v[152:155], a[116:119], a[12:15], v[152:155]
buffer_load_dwordx4 a[0:3], v4, s[40:43], s35 offen offset:0 sc1
v_mfma_f32_16x16x32_bf16 v[136:139], a[116:119], a[8:11], v[136:139]
ds_read_b128 a[104:107], v6 offset:34816
v_mfma_f32_16x16x32_bf16 v[140:143], a[120:123], a[8:11], v[140:143]
ds_read_b128 a[108:111], v6 offset:35840
v_mfma_f32_16x16x32_bf16 v[156:159], a[120:123], a[12:15], v[156:159]
v_mfma_f32_16x16x32_bf16 v[160:163], a[124:127], a[12:15], v[160:163]
buffer_load_dwordx4 a[4:7], v4, s[40:43], s35 offen offset:1024 sc1
s_xor_b32 s35, s77, 626688
L_stub14:
s_cbranch_execz L_wret5
v_mfma_f32_16x16x32_bf16 v[144:147], a[124:127], a[8:11], v[144:147]
s_waitcnt vmcnt(10) lgkmcnt(4)
v_mfma_f32_16x16x32_bf16 v[132:135], a[128:131], a[16:19], v[132:135]
ds_read_b128 a[112:115], v6 offset:36864
v_mfma_f32_16x16x32_bf16 v[148:151], a[128:131], a[20:23], v[148:151]
ds_read_b128 a[116:119], v6 offset:37888
v_mfma_f32_16x16x32_bf16 v[152:155], a[132:135], a[20:23], v[152:155]
buffer_load_dwordx4 a[8:11], v4, s[40:43], s35 offen offset:0 sc1
v_mfma_f32_16x16x32_bf16 v[136:139], a[132:135], a[16:19], v[136:139]
ds_read_b128 a[120:123], v6 offset:38912
v_mfma_f32_16x16x32_bf16 v[140:143], a[136:139], a[16:19], v[140:143]
ds_read_b128 a[124:127], v6 offset:39936
v_mfma_f32_16x16x32_bf16 v[156:159], a[136:139], a[20:23], v[156:159]
v_mfma_f32_16x16x32_bf16 v[160:163], a[140:143], a[20:23], v[160:163]
buffer_load_dwordx4 a[12:15], v4, s[40:43], s35 offen offset:1024 sc1
s_xor_b32 s35, s77, 638976
v_mfma_f32_16x16x32_bf16 v[144:147], a[140:143], a[16:19], v[144:147]
s_waitcnt vmcnt(10) lgkmcnt(4)
v_mfma_f32_16x16x32_bf16 v[132:135], a[96:99], a[24:27], v[132:135]
ds_read_b128 a[128:131], v6 offset:40960
v_mfma_f32_16x16x32_bf16 v[148:151], a[96:99], a[28:31], v[148:151]
ds_read_b128 a[132:135], v6 offset:41984
v_mfma_f32_16x16x32_bf16 v[152:155], a[100:103], a[28:31], v[152:155]
buffer_load_dwordx4 a[16:19], v4, s[40:43], s35 offen offset:0 sc1
v_mfma_f32_16x16x32_bf16 v[136:139], a[100:103], a[24:27], v[136:139]
ds_read_b128 a[136:139], v6 offset:43008
v_mfma_f32_16x16x32_bf16 v[140:143], a[104:107], a[24:27], v[140:143]
ds_read_b128 a[140:143], v6 offset:44032
v_mfma_f32_16x16x32_bf16 v[156:159], a[104:107], a[28:31], v[156:159]
v_mfma_f32_16x16x32_bf16 v[160:163], a[108:111], a[28:31], v[160:163]
buffer_load_dwordx4 a[20:23], v4, s[40:43], s35 offen offset:1024 sc1
s_xor_b32 s35, s77, 643072
v_mfma_f32_16x16x32_bf16 v[144:147], a[108:111], a[24:27], v[144:147]
s_waitcnt vmcnt(10) lgkmcnt(4)
v_mfma_f32_16x16x32_bf16 v[132:135], a[112:115], a[32:35], v[132:135]
ds_read_b128 a[96:99], v6 offset:45056
v_mfma_f32_16x16x32_bf16 v[148:151], a[112:115], a[36:39], v[148:151]
ds_read_b128 a[100:103], v6 offset:46080
v_mfma_f32_16x16x32_bf16 v[152:155], a[116:119], a[36:39], v[152:155]
buffer_load_dwordx4 a[24:27], v4, s[40:43], s35 offen offset:0 sc1
v_mfma_f32_16x16x32_bf16 v[136:139], a[116:119], a[32:35], v[136:139]
ds_read_b128 a[104:107], v6 offset:47104
v_mfma_f32_16x16x32_bf16 v[140:143], a[120:123], a[32:35], v[140:143]
ds_read_b128 a[108:111], v6 offset:48128
v_mfma_f32_16x16x32_bf16 v[156:159], a[120:123], a[36:39], v[156:159]
v_mfma_f32_16x16x32_bf16 v[160:163], a[124:127], a[36:39], v[160:163]
buffer_load_dwordx4 a[28:31], v4, s[40:43], s35 offen offset:1024 sc1
s_xor_b32 s35, s77, 0
v_mfma_f32_16x16x32_bf16 v[144:147], a[124:127], a[32:35], v[144:147]
s_waitcnt vmcnt(10) lgkmcnt(4)
v_mfma_f32_16x16x32_bf16 v[132:135], a[128:131], a[40:43], v[132:135]
s_add_u32 m0, s18, 0x0
s_add_u32 s44, s50, 0x2800000
v_mfma_f32_16x16x32_bf16 v[148:151], a[128:131], a[44:47], v[148:151]
ds_read_b128 a[112:115], v6 offset:49152
v_mfma_f32_16x16x32_bf16 v[152:155], a[132:135], a[44:47], v[152:155]
buffer_load_dwordx4 v1, s[4:7], s44 offen offset:0 sc1 lds
v_mfma_f32_16x16x32_bf16 v[136:139], a[132:135], a[40:43], v[136:139]
ds_read_b128 a[116:119], v6 offset:50176
v_mfma_f32_16x16x32_bf16 v[140:143], a[136:139], a[40:43], v[140:143]
ds_read_b128 a[120:123], v6 offset:51200
v_mfma_f32_16x16x32_bf16 v[156:159], a[136:139], a[44:47], v[156:159]
ds_read_b128 a[124:127], v6 offset:52224
v_mfma_f32_16x16x32_bf16 v[160:163], a[140:143], a[44:47], v[160:163]
buffer_load_dwordx4 v1, s[4:7], s44 offen offset:1024 sc1 lds
s_add_u32 m0, s18, 0x2000
v_mfma_f32_16x16x32_bf16 v[144:147], a[140:143], a[40:43], v[144:147]
s_add_u32 s44, s50, 0x2802000
s_waitcnt vmcnt(10) lgkmcnt(4)
v_mfma_f32_16x16x32_bf16 v[132:135], a[96:99], a[48:51], v[132:135]
ds_read_b128 a[128:131], v6 offset:53248
v_mfma_f32_16x16x32_bf16 v[148:151], a[96:99], a[52:55], v[148:151]
ds_read_b128 a[132:135], v6 offset:54272
v_mfma_f32_16x16x32_bf16 v[152:155], a[100:103], a[52:55], v[152:155]
buffer_load_dwordx4 v1, s[4:7], s44 offen offset:0 sc1 lds
v_mfma_f32_16x16x32_bf16 v[136:139], a[100:103], a[48:51], v[136:139]
ds_read_b128 a[136:139], v6 offset:55296
v_mfma_f32_16x16x32_bf16 v[140:143], a[104:107], a[48:51], v[140:143]
ds_read_b128 a[140:143], v6 offset:56320
v_mfma_f32_16x16x32_bf16 v[156:159], a[104:107], a[52:55], v[156:159]
v_mfma_f32_16x16x32_bf16 v[160:163], a[108:111], a[52:55], v[160:163]
buffer_load_dwordx4 v1, s[4:7], s44 offen offset:1024 sc1 lds
s_add_u32 m0, s18, 0x4000
v_mfma_f32_16x16x32_bf16 v[144:147], a[108:111], a[48:51], v[144:147]
s_add_u32 s44, s50, 0x2804000
s_waitcnt vmcnt(10) lgkmcnt(4)
v_mfma_f32_16x16x32_bf16 v[132:135], a[112:115], a[0:3], v[132:135]
ds_read_b128 a[96:99], v6 offset:57344
v_mfma_f32_16x16x32_bf16 v[148:151], a[112:115], a[4:7], v[148:151]
ds_read_b128 a[100:103], v6 offset:58368
v_mfma_f32_16x16x32_bf16 v[152:155], a[116:119], a[4:7], v[152:155]
ds_read_b128 a[104:107], v6 offset:59392
v_mfma_f32_16x16x32_bf16 v[136:139], a[116:119], a[0:3], v[136:139]
buffer_load_dwordx4 v1, s[4:7], s44 offen offset:0 sc1 lds
v_mfma_f32_16x16x32_bf16 v[140:143], a[120:123], a[0:3], v[140:143]
ds_read_b128 a[108:111], v6 offset:60416
v_mfma_f32_16x16x32_bf16 v[156:159], a[120:123], a[4:7], v[156:159]
v_mfma_f32_16x16x32_bf16 v[160:163], a[124:127], a[4:7], v[160:163]
v_mfma_f32_16x16x32_bf16 v[144:147], a[124:127], a[0:3], v[144:147]
buffer_load_dwordx4 v1, s[4:7], s44 offen offset:1024 sc1 lds
s_waitcnt vmcnt(10) lgkmcnt(4)
v_mfma_f32_16x16x32_bf16 v[132:135], a[128:131], a[8:11], v[132:135]
s_add_u32 m0, s18, 0x6000
s_add_u32 s44, s50, 0x2806000
v_mfma_f32_16x16x32_bf16 v[148:151], a[128:131], a[12:15], v[148:151]
ds_read_b128 a[112:115], v6 offset:61440
v_mfma_f32_16x16x32_bf16 v[152:155], a[132:135], a[12:15], v[152:155]
ds_read_b128 a[116:119], v6 offset:62464
v_mfma_f32_16x16x32_bf16 v[136:139], a[132:135], a[8:11], v[136:139]
ds_read_b128 a[120:123], v6 offset:63488
v_mfma_f32_16x16x32_bf16 v[140:143], a[136:139], a[8:11], v[140:143]
buffer_load_dwordx4 v1, s[4:7], s44 offen offset:0 sc1 lds
v_mfma_f32_16x16x32_bf16 v[156:159], a[136:139], a[12:15], v[156:159]
ds_read_b128 a[124:127], v6 offset:64512
v_mfma_f32_16x16x32_bf16 v[160:163], a[140:143], a[12:15], v[160:163]
v_mfma_f32_16x16x32_bf16 v[144:147], a[140:143], a[8:11], v[144:147]
s_waitcnt vmcnt(9) lgkmcnt(4)
v_mfma_f32_16x16x32_bf16 v[132:135], a[96:99], a[16:19], v[132:135]
v_mfma_f32_16x16x32_bf16 v[148:151], a[96:99], a[20:23], v[148:151]
buffer_load_dwordx4 v1, s[4:7], s44 offen offset:1024 sc1 lds
v_mfma_f32_16x16x32_bf16 v[152:155], a[100:103], a[20:23], v[152:155]
v_mfma_f32_16x16x32_bf16 v[136:139], a[100:103], a[16:19], v[136:139]
v_mfma_f32_16x16x32_bf16 v[140:143], a[104:107], a[16:19], v[140:143]
v_mfma_f32_16x16x32_bf16 v[156:159], a[104:107], a[20:23], v[156:159]
v_mfma_f32_16x16x32_bf16 v[160:163], a[108:111], a[20:23], v[160:163]
v_mfma_f32_16x16x32_bf16 v[144:147], a[108:111], a[16:19], v[144:147]
s_waitcnt vmcnt(8) lgkmcnt(0)
v_mfma_f32_16x16x32_bf16 v[132:135], a[112:115], a[24:27], v[132:135]
v_mfma_f32_16x16x32_bf16 v[148:151], a[112:115], a[28:31], v[148:151]
v_mfma_f32_16x16x32_bf16 v[152:155], a[116:119], a[28:31], v[152:155]
v_mfma_f32_16x16x32_bf16 v[136:139], a[116:119], a[24:27], v[136:139]
v_mfma_f32_16x16x32_bf16 v[140:143], a[120:123], a[24:27], v[140:143]
v_mfma_f32_16x16x32_bf16 v[156:159], a[120:123], a[28:31], v[156:159]
v_mfma_f32_16x16x32_bf16 v[160:163], a[124:127], a[28:31], v[160:163]
v_mfma_f32_16x16x32_bf16 v[144:147], a[124:127], a[24:27], v[144:147]
s_nop 1
v_cmp_u_f32 vcc, v132, v148
s_nop 0
s_and_b32 vcc_lo, vcc_lo, s95
s_cbranch_scc1 L_k2redo2
v_cvt_pk_bf16_f32 v32, v132, v133
v_cvt_pk_bf16_f32 v33, v134, v135
v_cvt_pk_bf16_f32 v34, v136, v137
v_cvt_pk_bf16_f32 v35, v138, v139
s_add_u32 s36, s69, 0x400000
buffer_store_dwordx4 v[32:35], v4, s[4:7], s36 offen offset:0 sc1
v_cvt_pk_bf16_f32 v40, v148, v149
v_cvt_pk_bf16_f32 v41, v150, v151
v_cvt_pk_bf16_f32 v42, v152, v153
v_cvt_pk_bf16_f32 v43, v154, v155
v_cvt_pk_bf16_f32 v36, v140, v141
v_cvt_pk_bf16_f32 v37, v142, v143
v_cvt_pk_bf16_f32 v38, v144, v145
v_cvt_pk_bf16_f32 v39, v146, v147
s_add_u32 s37, s36, 4096
v_cvt_pk_bf16_f32 v44, v156, v157
v_cvt_pk_bf16_f32 v45, v158, v159
v_cvt_pk_bf16_f32 v46, v160, v161
buffer_store_dwordx4 v[40:43], v4, s[4:7], s36 offen offset:1024 sc1
v_cvt_pk_bf16_f32 v47, v162, v163
v_mfma_f32_16x16x32_bf16 v[96:99], v[32:35], v[32:35], 0
s_mov_b32 s38, 0x380000
s_add_u32 s92, s78, 0x60000
v_mfma_f32_16x16x32_bf16 v[92:95], v[16:19], v[32:35], 0
s_add_u32 s40, s4, 0x400000
s_addc_u32 s41, s5, 0
v_mfma_f32_16x16x32_bf16 v[96:99], v[36:39], v[36:39], v[96:99]
buffer_store_dwordx4 v[36:39], v4, s[4:7], s37 offen offset:0 sc1
v_mfma_f32_16x16x32_bf16 v[92:95], v[16:19], v[36:39], v[92:95]
s_nop 5
v_cndmask_b32 v96, v96, v97, s[46:47]
v_cndmask_b32 v98, v98, v99, s[46:47]
v_mfma_f32_16x16x32_bf16 v[104:107], v[40:43], v[40:43], 0
v_mfma_f32_16x16x32_bf16 v[100:103], v[16:19], v[40:43], 0
v_cndmask_b32 v93, v96, v98, s[48:49]
buffer_store_dwordx4 v[44:47], v4, s[4:7], s37 offen offset:1024 sc1
v_mfma_f32_16x16x32_bf16 v[104:107], v[44:47], v[44:47], v[104:107]
v_mfma_f32_16x16x32_bf16 v[100:103], v[16:19], v[44:47], v[100:103]
s_nop 6
v_cndmask_b32 v104, v104, v105, s[46:47]
v_cndmask_b32 v106, v106, v107, s[46:47]
buffer_store_dwordx2 v[92:93], v253, s[4:7], s38 offen offset:0 sc1
v_cndmask_b32 v101, v104, v106, s[48:49]
buffer_store_dwordx2 v[100:101], v253, s[4:7], s38 offen offset:2048 sc1
s_barrier
s_add_u32 m0, s18, 0x8000
s_add_u32 s44, s50, 0x2808000
buffer_load_dwordx4 v1, s[4:7], s44 offen offset:0 sc1 lds
buffer_load_dwordx4 v1, s[4:7], s44 offen offset:1024 sc1 lds
s_add_u32 m0, s18, 0xa000
s_add_u32 s44, s50, 0x280a000
buffer_load_dwordx4 v1, s[4:7], s44 offen offset:0 sc1 lds
buffer_load_dwordx4 v1, s[4:7], s44 offen offset:1024 sc1 lds
v_accvgpr_read_b32 v48, a216
v_accvgpr_read_b32 v49, a217
v_accvgpr_read_b32 v50, a218
v_accvgpr_read_b32 v51, a219
v_accvgpr_read_b32 v52, a220
v_accvgpr_read_b32 v53, a221
v_accvgpr_read_b32 v54, a222
v_accvgpr_read_b32 v55, a223
v_accvgpr_read_b32 v56, a224
v_accvgpr_read_b32 v57, a225
v_accvgpr_read_b32 v58, a226
v_accvgpr_read_b32 v59, a227
v_accvgpr_read_b32 v60, a228
v_accvgpr_read_b32 v61, a229
v_accvgpr_read_b32 v62, a230
v_accvgpr_read_b32 v63, a231
v_accvgpr_read_b32 v64, a232
v_accvgpr_read_b32 v65, a233
v_accvgpr_read_b32 v66, a234
v_accvgpr_read_b32 v67, a235
v_accvgpr_read_b32 v68, a236
v_accvgpr_read_b32 v69, a237
v_accvgpr_read_b32 v70, a238
v_accvgpr_read_b32 v71, a239
s_waitcnt vmcnt(4)
s_barrier
s_cmp_lg_u32 s28, 0
s_cbranch_scc1 Lsg_40
buffer_atomic_add v12, v10, s[4:7], s92 offen sc1
Lsg_40:
s_mov_b64 exec, 0
s_cmp_eq_u32 s28, 0
s_cbranch_scc1 L_stub15
L_wret6:
s_mov_b64 exec, -1
s_cmp_lt_u32 s28, 2
s_cbranch_scc1 Lwd_41
s_add_u32 m0, s19, 0xa000
s_add_u32 s44, s50, 0x280a000
s_add_u32 s44, s44, s18
buffer_load_dwordx4 v1, s[4:7], s44 offen offset:0 sc1 lds
buffer_load_dwordx4 v1, s[4:7], s44 offen offset:1024 sc1 lds
buffer_load_dwordx4 v1, s[4:7], s44 offen offset:2048 sc1 lds
buffer_load_dwordx4 v1, s[4:7], s44 offen offset:3072 sc1 lds
s_add_u32 m0, s19, 0xc000
s_add_u32 s44, s50, 0x280c000
s_add_u32 s44, s44, s18
buffer_load_dwordx4 v1, s[4:7], s44 offen offset:0 sc1 lds
buffer_load_dwordx4 v1, s[4:7], s44 offen offset:1024 sc1 lds
buffer_load_dwordx4 v1, s[4:7], s44 offen offset:2048 sc1 lds
buffer_load_dwordx4 v1, s[4:7], s44 offen offset:3072 sc1 lds
s_add_u32 m0, s19, 0xe000
s_add_u32 s44, s50, 0x280e000
s_add_u32 s44, s44, s18
buffer_load_dwordx4 v1, s[4:7], s44 offen offset:0 sc1 lds
buffer_load_dwordx4 v1, s[4:7], s44 offen offset:1024 sc1 lds
buffer_load_dwordx4 v1, s[4:7], s44 offen offset:2048 sc1 lds
buffer_load_dwordx4 v1, s[4:7], s44 offen offset:3072 sc1 lds
s_add_u32 m0, s19, 0x10000
s_add_u32 s44, s50, 0x2810000
s_add_u32 s44, s44, s18
buffer_load_dwordx4 v1, s[4:7], s44 offen offset:0 sc1 lds
buffer_load_dwordx4 v1, s[4:7], s44 offen offset:1024 sc1 lds
buffer_load_dwordx4 v1, s[4:7], s44 offen offset:2048 sc1 lds
buffer_load_dwordx4 v1, s[4:7], s44 offen offset:3072 sc1 lds
s_add_u32 m0, s19, 0x12000
s_add_u32 s44, s50, 0x2812000
s_add_u32 s44, s44, s18
buffer_load_dwordx4 v1, s[4:7], s44 offen offset:0 sc1 lds
buffer_load_dwordx4 v1, s[4:7], s44 offen offset:1024 sc1 lds
buffer_load_dwordx4 v1, s[4:7], s44 offen offset:2048 sc1 lds
buffer_load_dwordx4 v1, s[4:7], s44 offen offset:3072 sc1 lds
s_add_u32 m0, s19, 0x14000
s_add_u32 s44, s50, 0x2814000
s_add_u32 s44, s44, s18
buffer_load_dwordx4 v1, s[4:7], s44 offen offset:0 sc1 lds
buffer_load_dwordx4 v1, s[4:7], s44 offen offset:1024 sc1 lds
buffer_load_dwordx4 v1, s[4:7], s44 offen offset:2048 sc1 lds
buffer_load_dwordx4 v1, s[4:7], s44 offen offset:3072 sc1 lds
s_add_u32 m0, s19, 0x16000
s_add_u32 s44, s50, 0x2816000
s_add_u32 s44, s44, s18
buffer_load_dwordx4 v1, s[4:7], s44 offen offset:0 sc1 lds
buffer_load_dwordx4 v1, s[4:7], s44 offen offset:1024 sc1 lds
buffer_load_dwordx4 v1, s[4:7], s44 offen offset:2048 sc1 lds
buffer_load_dwordx4 v1, s[4:7], s44 offen offset:3072 sc1 lds
s_add_u32 m0, s19, 0x18000
s_add_u32 s44, s50, 0x2818000
s_add_u32 s44, s44, s18
buffer_load_dwordx4 v1, s[4:7], s44 offen offset:0 sc1 lds
buffer_load_dwordx4 v1, s[4:7], s44 offen offset:1024 sc1 lds
buffer_load_dwordx4 v1, s[4:7], s44 offen offset:2048 sc1 lds
buffer_load_dwordx4 v1, s[4:7], s44 offen offset:3072 sc1 lds
Lwd_41:
s_cmp_lg_u32 s28, 1
s_cbranch_scc1 Lpo_44
s_add_u32 s36, s34, 0x60000
s_mov_b32 s37, 0
v_mov_b32 v11, 0
buffer_atomic_add v11, v251, s[4:7], s36 offen sc0 sc1
s_sleep 4
Lpoll_42:
v_mov_b32 v234, 0
buffer_atomic_add v234, v251, s[4:7], s36 offen sc0 sc1
s_waitcnt vmcnt(1)
v_readfirstlane_b32 s38, v11
s_nop 0
s_cmp_ge_u32 s38, 32
s_cbranch_scc1 Lpe_43
v_mov_b32 v11, 0
buffer_atomic_add v11, v251, s[4:7], s36 offen sc0 sc1
s_waitcnt vmcnt(1)
v_readfirstlane_b32 s38, v234
s_nop 0
s_cmp_ge_u32 s38, 32
s_cbranch_scc1 Lpe_43
s_add_u32 s37, s37, 1
s_cmp_lt_u32 s37, 0x80000
s_cbranch_scc1 Lpoll_42
s_waitcnt vmcnt(0)
Lpo_44:
s_waitcnt vmcnt(32) lgkmcnt(0)
s_cmp_ge_u32 s28, 2
s_cbranch_scc1 Lw_45
s_waitcnt vmcnt(0)
Lw_45:
Lpe_43:
s_barrier
s_mov_b32 s35, s68
s_add_u32 s33, s35, 0x1000
buffer_load_dwordx4 a[0:3], v2, s[40:43], s35 offen offset:0 sc1
buffer_load_dwordx4 a[4:7], v2, s[40:43], s33 offen offset:0 sc1
buffer_load_dwordx4 a[8:11], v2, s[40:43], s35 offen offset:1024 sc1
buffer_load_dwordx4 a[12:15], v2, s[40:43], s33 offen offset:1024 sc1
buffer_load_dwordx4 a[16:19], v2, s[40:43], s35 offen offset:2048 sc1
buffer_load_dwordx4 a[20:23], v2, s[40:43], s33 offen offset:2048 sc1
buffer_load_dwordx4 a[24:27], v2, s[40:43], s35 offen offset:3072 sc1
buffer_load_dwordx4 a[28:31], v2, s[40:43], s33 offen offset:3072 sc1
s_add_u32 s35, s35, 0x4000
s_add_u32 s33, s33, 0x4000
buffer_load_dwordx4 a[32:35], v2, s[40:43], s35 offen offset:0 sc1
buffer_load_dwordx4 a[36:39], v2, s[40:43], s33 offen offset:0 sc1
buffer_load_dwordx4 a[40:43], v2, s[40:43], s35 offen offset:1024 sc1
buffer_load_dwordx4 a[44:47], v2, s[40:43], s33 offen offset:1024 sc1
buffer_load_dwordx4 a[48:51], v2, s[40:43], s35 offen offset:2048 sc1
buffer_load_dwordx4 a[52:55], v2, s[40:43], s33 offen offset:2048 sc1
buffer_load_dwordx4 a[56:59], v2, s[40:43], s35 offen offset:3072 sc1
buffer_load_dwordx4 a[60:63], v2, s[40:43], s33 offen offset:3072 sc1
s_add_u32 s35, s35, 0x4000
s_add_u32 s33, s33, 0x4000
v_add_u32 v5, 0, v1
ds_read_b128 a[96:99], v5 offset:2048
ds_read_b128 a[100:103], v5 offset:8192
ds_read_b128 a[104:107], v5 offset:3072
ds_read_b128 a[108:111], v5 offset:9216
ds_read_b128 a[112:115], v5 offset:4096
ds_read_b128 a[116:119], v5 offset:10240
s_waitcnt vmcnt(14) lgkmcnt(4)
v_mfma_f32_16x16x32_bf16 v[140:143], a[96:99], a[0:3], 0
s_add_u32 m0, s18, 0x1c000
s_add_u32 s44, s50, 0x281c000
v_mfma_f32_16x16x32_bf16 v[140:143], a[100:103], a[4:7], v[140:143]
buffer_load_dwordx4 a[64:67], v2, s[40:43], s35 offen offset:0 sc1
s_waitcnt vmcnt(13)
v_mfma_f32_16x16x32_bf16 v[164:167], a[100:103], a[12:15], 0
ds_read_b128 a[128:131], v5 offset:5120
v_mfma_f32_16x16x32_bf16 v[164:167], a[96:99], a[8:11], v[164:167]
ds_read_b128 a[132:135], v5 offset:11264
s_waitcnt vmcnt(12)
v_mfma_f32_16x16x32_bf16 v[188:191], a[96:99], a[16:19], 0
s_waitcnt vmcnt(11)
v_mfma_f32_16x16x32_bf16 v[188:191], a[100:103], a[20:23], v[188:191]
buffer_load_dwordx4 a[68:71], v2, s[40:43], s33 offen offset:0 sc1
s_waitcnt vmcnt(10)
v_mfma_f32_16x16x32_bf16 v[212:215], a[100:103], a[28:31], 0
ds_read_b128 a[136:139], v5 offset:0
v_mfma_f32_16x16x32_bf16 v[212:215], a[96:99], a[24:27], v[212:215]
s_waitcnt lgkmcnt(6)
v_mfma_f32_16x16x32_bf16 v[216:219], a[104:107], a[24:27], 0
ds_read_b128 a[140:143], v5 offset:6144
s_waitcnt lgkmcnt(6)
v_mfma_f32_16x16x32_bf16 v[216:219], a[108:111], a[28:31], v[216:219]
v_mfma_f32_16x16x32_bf16 v[192:195], a[108:111], a[20:23], 0
buffer_load_dwordx4 v1, s[4:7], s44 offen offset:0 sc1 lds
v_mfma_f32_16x16x32_bf16 v[192:195], a[104:107], a[16:19], v[192:195]
ds_read_b128 a[144:147], v5 offset:1024
v_mfma_f32_16x16x32_bf16 v[168:171], a[104:107], a[8:11], 0
v_mfma_f32_16x16x32_bf16 v[168:171], a[108:111], a[12:15], v[168:171]
ds_read_b128 a[148:151], v5 offset:7168
v_mfma_f32_16x16x32_bf16 v[144:147], a[108:111], a[4:7], 0
v_mfma_f32_16x16x32_bf16 v[144:147], a[104:107], a[0:3], v[144:147]
buffer_load_dwordx4 a[72:75], v2, s[40:43], s35 offen offset:1024 sc1
s_waitcnt lgkmcnt(7)
v_mfma_f32_16x16x32_bf16 v[148:151], a[112:115], a[0:3], 0
s_waitcnt lgkmcnt(6)
v_mfma_f32_16x16x32_bf16 v[148:151], a[116:119], a[4:7], v[148:151]
v_mfma_f32_16x16x32_bf16 v[172:175], a[116:119], a[12:15], 0
v_mfma_f32_16x16x32_bf16 v[172:175], a[112:115], a[8:11], v[172:175]
v_mfma_f32_16x16x32_bf16 v[196:199], a[112:115], a[16:19], 0
buffer_load_dwordx4 a[76:79], v2, s[40:43], s33 offen offset:1024 sc1
v_mfma_f32_16x16x32_bf16 v[196:199], a[116:119], a[20:23], v[196:199]
v_mfma_f32_16x16x32_bf16 v[220:223], a[116:119], a[28:31], 0
v_mfma_f32_16x16x32_bf16 v[220:223], a[112:115], a[24:27], v[220:223]
s_waitcnt lgkmcnt(0)
v_mfma_f32_16x16x32_bf16 v[224:227], a[128:131], a[24:27], 0
ds_read_b128 a[96:99], v5 offset:14336
v_mfma_f32_16x16x32_bf16 v[224:227], a[132:135], a[28:31], v[224:227]
buffer_load_dwordx4 a[80:83], v2, s[40:43], s35 offen offset:2048 sc1
v_mfma_f32_16x16x32_bf16 v[200:203], a[132:135], a[20:23], 0
ds_read_b128 a[100:103], v5 offset:20480
v_mfma_f32_16x16x32_bf16 v[200:203], a[128:131], a[16:19], v[200:203]
v_mfma_f32_16x16x32_bf16 v[176:179], a[128:131], a[8:11], 0
v_mfma_f32_16x16x32_bf16 v[176:179], a[132:135], a[12:15], v[176:179]
buffer_load_dwordx4 a[84:87], v2, s[40:43], s33 offen offset:2048 sc1
v_mfma_f32_16x16x32_bf16 v[152:155], a[132:135], a[4:7], 0
ds_read_b128 a[104:107], v5 offset:15360
v_mfma_f32_16x16x32_bf16 v[152:155], a[128:131], a[0:3], v[152:155]
v_mfma_f32_16x16x32_bf16 v[132:135], a[136:139], a[0:3], 0
ds_read_b128 a[108:111], v5 offset:21504
v_mfma_f32_16x16x32_bf16 v[132:135], a[140:143], a[4:7], v[132:135]
v_mfma_f32_16x16x32_bf16 v[156:159], a[140:143], a[12:15], 0
buffer_load_dwordx4 v1, s[4:7], s44 offen offset:1024 sc1 lds
s_add_u32 m0, s18, 0x1e000
v_mfma_f32_16x16x32_bf16 v[156:159], a[136:139], a[8:11], v[156:159]
s_add_u32 s44, s50, 0x281e000
ds_read_b128 a[112:115], v5 offset:16384
v_mfma_f32_16x16x32_bf16 v[180:183], a[136:139], a[16:19], 0
v_mfma_f32_16x16x32_bf16 v[180:183], a[140:143], a[20:23], v[180:183]
ds_read_b128 a[116:119], v5 offset:22528
v_mfma_f32_16x16x32_bf16 v[204:207], a[140:143], a[28:31], 0
v_mfma_f32_16x16x32_bf16 v[204:207], a[136:139], a[24:27], v[204:207]
buffer_load_dwordx4 a[88:91], v2, s[40:43], s35 offen offset:3072 sc1
v_mfma_f32_16x16x32_bf16 v[208:211], a[144:147], a[24:27], 0
v_mfma_f32_16x16x32_bf16 v[208:211], a[148:151], a[28:31], v[208:211]
v_mfma_f32_16x16x32_bf16 v[184:187], a[148:151], a[20:23], 0
v_mfma_f32_16x16x32_bf16 v[184:187], a[144:147], a[16:19], v[184:187]
v_mfma_f32_16x16x32_bf16 v[160:163], a[144:147], a[8:11], 0
buffer_load_dwordx4 a[92:95], v2, s[40:43], s33 offen offset:3072 sc1
s_add_u32 s35, s35, 0x4000
v_mfma_f32_16x16x32_bf16 v[160:163], a[148:151], a[12:15], v[160:163]
s_add_u32 s33, s33, 0x4000
v_mfma_f32_16x16x32_bf16 v[136:139], a[148:151], a[4:7], 0
v_mfma_f32_16x16x32_bf16 v[136:139], a[144:147], a[0:3], v[136:139]
s_waitcnt vmcnt(10) lgkmcnt(0)
v_mfma_f32_16x16x32_bf16 v[140:143], a[96:99], a[32:35], v[140:143]
ds_read_b128 a[128:131], v5 offset:17408
v_mfma_f32_16x16x32_bf16 v[140:143], a[100:103], a[36:39], v[140:143]
buffer_load_dwordx4 a[0:3], v2, s[40:43], s35 offen offset:0 sc1
v_mfma_f32_16x16x32_bf16 v[164:167], a[100:103], a[44:47], v[164:167]
ds_read_b128 a[132:135], v5 offset:23552
v_mfma_f32_16x16x32_bf16 v[164:167], a[96:99], a[40:43], v[164:167]
v_mfma_f32_16x16x32_bf16 v[188:191], a[96:99], a[48:51], v[188:191]
v_mfma_f32_16x16x32_bf16 v[188:191], a[100:103], a[52:55], v[188:191]
buffer_load_dwordx4 a[4:7], v2, s[40:43], s33 offen offset:0 sc1
v_mfma_f32_16x16x32_bf16 v[212:215], a[100:103], a[60:63], v[212:215]
ds_read_b128 a[136:139], v5 offset:12288
v_mfma_f32_16x16x32_bf16 v[212:215], a[96:99], a[56:59], v[212:215]
v_mfma_f32_16x16x32_bf16 v[216:219], a[104:107], a[56:59], v[216:219]
ds_read_b128 a[140:143], v5 offset:18432
v_mfma_f32_16x16x32_bf16 v[216:219], a[108:111], a[60:63], v[216:219]
v_mfma_f32_16x16x32_bf16 v[192:195], a[108:111], a[52:55], v[192:195]
buffer_load_dwordx4 v1, s[4:7], s44 offen offset:0 sc1 lds
v_mfma_f32_16x16x32_bf16 v[192:195], a[104:107], a[48:51], v[192:195]
ds_read_b128 a[144:147], v5 offset:13312
v_mfma_f32_16x16x32_bf16 v[168:171], a[104:107], a[40:43], v[168:171]
v_mfma_f32_16x16x32_bf16 v[168:171], a[108:111], a[44:47], v[168:171]
ds_read_b128 a[148:151], v5 offset:19456
v_mfma_f32_16x16x32_bf16 v[144:147], a[108:111], a[36:39], v[144:147]
v_mfma_f32_16x16x32_bf16 v[144:147], a[104:107], a[32:35], v[144:147]
buffer_load_dwordx4 a[8:11], v2, s[40:43], s35 offen offset:1024 sc1
v_mfma_f32_16x16x32_bf16 v[148:151], a[112:115], a[32:35], v[148:151]
v_mfma_f32_16x16x32_bf16 v[148:151], a[116:119], a[36:39], v[148:151]
v_mfma_f32_16x16x32_bf16 v[172:175], a[116:119], a[44:47], v[172:175]
v_mfma_f32_16x16x32_bf16 v[172:175], a[112:115], a[40:43], v[172:175]
v_mfma_f32_16x16x32_bf16 v[196:199], a[112:115], a[48:51], v[196:199]
buffer_load_dwordx4 a[12:15], v2, s[40:43], s33 offen offset:1024 sc1
v_mfma_f32_16x16x32_bf16 v[196:199], a[116:119], a[52:55], v[196:199]
v_mfma_f32_16x16x32_bf16 v[220:223], a[116:119], a[60:63], v[220:223]
v_mfma_f32_16x16x32_bf16 v[220:223], a[112:115], a[56:59], v[220:223]
s_waitcnt lgkmcnt(0)
v_mfma_f32_16x16x32_bf16 v[224:227], a[128:131], a[56:59], v[224:227]
ds_read_b128 a[96:99], v5 offset:26624
v_mfma_f32_16x16x32_bf16 v[224:227], a[132:135], a[60:63], v[224:227]
buffer_load_dwordx4 a[16:19], v2, s[40:43], s35 offen offset:2048 sc1
v_mfma_f32_16x16x32_bf16 v[200:203], a[132:135], a[52:55], v[200:203]
ds_read_b128 a[100:103], v5 offset:32768
v_mfma_f32_16x16x32_bf16 v[200:203], a[128:131], a[48:51], v[200:203]
v_mfma_f32_16x16x32_bf16 v[176:179], a[128:131], a[40:43], v[176:179]
v_mfma_f32_16x16x32_bf16 v[176:179], a[132:135], a[44:47], v[176:179]
buffer_load_dwordx4 v1, s[4:7], s44 offen offset:1024 sc1 lds
s_add_u32 m0, s18, 0x20000
v_mfma_f32_16x16x32_bf16 v[152:155], a[132:135], a[36:39], v[152:155]
s_add_u32 s44, s50, 0x2820000
ds_read_b128 a[104:107], v5 offset:27648
v_mfma_f32_16x16x32_bf16 v[152:155], a[128:131], a[32:35], v[152:155]
v_mfma_f32_16x16x32_bf16 v[132:135], a[136:139], a[32:35], v[132:135]
ds_read_b128 a[108:111], v5 offset:33792
v_mfma_f32_16x16x32_bf16 v[132:135], a[140:143], a[36:39], v[132:135]
buffer_load_dwordx4 a[20:23], v2, s[40:43], s33 offen offset:2048 sc1
v_mfma_f32_16x16x32_bf16 v[156:159], a[140:143], a[44:47], v[156:159]
ds_read_b128 a[112:115], v5 offset:28672
v_mfma_f32_16x16x32_bf16 v[156:159], a[136:139], a[40:43], v[156:159]
v_mfma_f32_16x16x32_bf16 v[180:183], a[136:139], a[48:51], v[180:183]
v_mfma_f32_16x16x32_bf16 v[180:183], a[140:143], a[52:55], v[180:183]
buffer_load_dwordx4 a[24:27], v2, s[40:43], s35 offen offset:3072 sc1
v_mfma_f32_16x16x32_bf16 v[204:207], a[140:143], a[60:63], v[204:207]
ds_read_b128 a[116:119], v5 offset:34816
v_mfma_f32_16x16x32_bf16 v[204:207], a[136:139], a[56:59], v[204:207]
v_mfma_f32_16x16x32_bf16 v[208:211], a[144:147], a[56:59], v[208:211]
v_mfma_f32_16x16x32_bf16 v[208:211], a[148:151], a[60:63], v[208:211]
buffer_load_dwordx4 v1, s[4:7], s44 offen offset:0 sc1 lds
v_mfma_f32_16x16x32_bf16 v[184:187], a[148:151], a[52:55], v[184:187]
v_mfma_f32_16x16x32_bf16 v[184:187], a[144:147], a[48:51], v[184:187]
v_mfma_f32_16x16x32_bf16 v[160:163], a[144:147], a[40:43], v[160:163]
v_mfma_f32_16x16x32_bf16 v[160:163], a[148:151], a[44:47], v[160:163]
buffer_load_dwordx4 a[28:31], v2, s[40:43], s33 offen offset:3072 sc1
s_add_u32 s35, s35, 0x4000
v_mfma_f32_16x16x32_bf16 v[136:139], a[148:151], a[36:39], v[136:139]
s_add_u32 s33, s33, 0x4000
v_mfma_f32_16x16x32_bf16 v[136:139], a[144:147], a[32:35], v[136:139]
s_waitcnt vmcnt(11) lgkmcnt(0)
v_mfma_f32_16x16x32_bf16 v[140:143], a[96:99], a[64:67], v[140:143]
ds_read_b128 a[128:131], v5 offset:29696
v_mfma_f32_16x16x32_bf16 v[140:143], a[100:103], a[68:71], v[140:143]
buffer_load_dwordx4 a[32:35], v2, s[40:43], s35 offen offset:0 sc1
v_mfma_f32_16x16x32_bf16 v[164:167], a[100:103], a[76:79], v[164:167]
ds_read_b128 a[132:135], v5 offset:35840
v_mfma_f32_16x16x32_bf16 v[164:167], a[96:99], a[72:75], v[164:167]
v_mfma_f32_16x16x32_bf16 v[188:191], a[96:99], a[80:83], v[188:191]
v_mfma_f32_16x16x32_bf16 v[188:191], a[100:103], a[84:87], v[188:191]
buffer_load_dwordx4 a[36:39], v2, s[40:43], s33 offen offset:0 sc1
v_mfma_f32_16x16x32_bf16 v[212:215], a[100:103], a[92:95], v[212:215]
ds_read_b128 a[136:139], v5 offset:24576
v_mfma_f32_16x16x32_bf16 v[212:215], a[96:99], a[88:91], v[212:215]
v_mfma_f32_16x16x32_bf16 v[216:219], a[104:107], a[88:91], v[216:219]
ds_read_b128 a[140:143], v5 offset:30720
v_mfma_f32_16x16x32_bf16 v[216:219], a[108:111], a[92:95], v[216:219]
v_mfma_f32_16x16x32_bf16 v[192:195], a[108:111], a[84:87], v[192:195]
buffer_load_dwordx4 v1, s[4:7], s44 offen offset:1024 sc1 lds
s_add_u32 m0, s18, 0x22000
v_mfma_f32_16x16x32_bf16 v[192:195], a[104:107], a[80:83], v[192:195]
s_add_u32 s44, s50, 0x2822000
ds_read_b128 a[144:147], v5 offset:25600
v_mfma_f32_16x16x32_bf16 v[168:171], a[104:107], a[72:75], v[168:171]
v_mfma_f32_16x16x32_bf16 v[168:171], a[108:111], a[76:79], v[168:171]
ds_read_b128 a[148:151], v5 offset:31744
v_mfma_f32_16x16x32_bf16 v[144:147], a[108:111], a[68:71], v[144:147]
v_mfma_f32_16x16x32_bf16 v[144:147], a[104:107], a[64:67], v[144:147]
buffer_load_dwordx4 a[40:43], v2, s[40:43], s35 offen offset:1024 sc1
v_mfma_f32_16x16x32_bf16 v[148:151], a[112:115], a[64:67], v[148:151]
v_mfma_f32_16x16x32_bf16 v[148:151], a[116:119], a[68:71], v[148:151]
v_mfma_f32_16x16x32_bf16 v[172:175], a[116:119], a[76:79], v[172:175]
v_mfma_f32_16x16x32_bf16 v[172:175], a[112:115], a[72:75], v[172:175]
v_mfma_f32_16x16x32_bf16 v[196:199], a[112:115], a[80:83], v[196:199]
buffer_load_dwordx4 a[44:47], v2, s[40:43], s33 offen offset:1024 sc1
v_mfma_f32_16x16x32_bf16 v[196:199], a[116:119], a[84:87], v[196:199]
v_mfma_f32_16x16x32_bf16 v[220:223], a[116:119], a[92:95], v[220:223]
v_mfma_f32_16x16x32_bf16 v[220:223], a[112:115], a[88:91], v[220:223]
s_waitcnt lgkmcnt(0)
v_mfma_f32_16x16x32_bf16 v[224:227], a[128:131], a[88:91], v[224:227]
ds_read_b128 a[96:99], v5 offset:38912
v_mfma_f32_16x16x32_bf16 v[224:227], a[132:135], a[92:95], v[224:227]
buffer_load_dwordx4 a[48:51], v2, s[40:43], s35 offen offset:2048 sc1
v_mfma_f32_16x16x32_bf16 v[200:203], a[132:135], a[84:87], v[200:203]
ds_read_b128 a[100:103], v5 offset:45056
L_stub15:
s_cbranch_execz L_stub16
v_mfma_f32_16x16x32_bf16 v[200:203], a[128:131], a[80:83], v[200:203]
v_mfma_f32_16x16x32_bf16 v[176:179], a[128:131], a[72:75], v[176:179]
v_mfma_f32_16x16x32_bf16 v[176:179], a[132:135], a[76:79], v[176:179]
buffer_load_dwordx4 a[52:55], v2, s[40:43], s33 offen offset:2048 sc1
v_mfma_f32_16x16x32_bf16 v[152:155], a[132:135], a[68:71], v[152:155]
ds_read_b128 a[104:107], v5 offset:39936
v_mfma_f32_16x16x32_bf16 v[152:155], a[128:131], a[64:67], v[152:155]
v_mfma_f32_16x16x32_bf16 v[132:135], a[136:139], a[64:67], v[132:135]
ds_read_b128 a[108:111], v5 offset:46080
v_mfma_f32_16x16x32_bf16 v[132:135], a[140:143], a[68:71], v[132:135]
v_mfma_f32_16x16x32_bf16 v[156:159], a[140:143], a[76:79], v[156:159]
buffer_load_dwordx4 v1, s[4:7], s44 offen offset:0 sc1 lds
v_mfma_f32_16x16x32_bf16 v[156:159], a[136:139], a[72:75], v[156:159]
ds_read_b128 a[112:115], v5 offset:40960
v_mfma_f32_16x16x32_bf16 v[180:183], a[136:139], a[80:83], v[180:183]
v_mfma_f32_16x16x32_bf16 v[180:183], a[140:143], a[84:87], v[180:183]
ds_read_b128 a[116:119], v5 offset:47104
v_mfma_f32_16x16x32_bf16 v[204:207], a[140:143], a[92:95], v[204:207]
v_mfma_f32_16x16x32_bf16 v[204:207], a[136:139], a[88:91], v[204:207]
buffer_load_dwordx4 a[56:59], v2, s[40:43], s35 offen offset:3072 sc1
v_mfma_f32_16x16x32_bf16 v[208:211], a[144:147], a[88:91], v[208:211]
v_mfma_f32_16x16x32_bf16 v[208:211], a[148:151], a[92:95], v[208:211]
v_mfma_f32_16x16x32_bf16 v[184:187], a[148:151], a[84:87], v[184:187]
v_mfma_f32_16x16x32_bf16 v[184:187], a[144:147], a[80:83], v[184:187]
v_mfma_f32_16x16x32_bf16 v[160:163], a[144:147], a[72:75], v[160:163]
buffer_load_dwordx4 a[60:63], v2, s[40:43], s33 offen offset:3072 sc1
s_add_u32 s35, s35, 0x4000
v_mfma_f32_16x16x32_bf16 v[160:163], a[148:151], a[76:79], v[160:163]
s_add_u32 s33, s33, 0x4000
v_mfma_f32_16x16x32_bf16 v[136:139], a[148:151], a[68:71], v[136:139]
v_mfma_f32_16x16x32_bf16 v[136:139], a[144:147], a[64:67], v[136:139]
s_waitcnt vmcnt(10) lgkmcnt(0)
v_mfma_f32_16x16x32_bf16 v[140:143], a[96:99], a[0:3], v[140:143]
ds_read_b128 a[128:131], v5 offset:41984
v_mfma_f32_16x16x32_bf16 v[140:143], a[100:103], a[4:7], v[140:143]
buffer_load_dwordx4 a[64:67], v2, s[40:43], s35 offen offset:0 sc1
v_mfma_f32_16x16x32_bf16 v[164:167], a[100:103], a[12:15], v[164:167]
ds_read_b128 a[132:135], v5 offset:48128
v_mfma_f32_16x16x32_bf16 v[164:167], a[96:99], a[8:11], v[164:167]
v_mfma_f32_16x16x32_bf16 v[188:191], a[96:99], a[16:19], v[188:191]
v_mfma_f32_16x16x32_bf16 v[188:191], a[100:103], a[20:23], v[188:191]
buffer_load_dwordx4 a[68:71], v2, s[40:43], s33 offen offset:0 sc1
v_mfma_f32_16x16x32_bf16 v[212:215], a[100:103], a[28:31], v[212:215]
ds_read_b128 a[136:139], v5 offset:36864
v_mfma_f32_16x16x32_bf16 v[212:215], a[96:99], a[24:27], v[212:215]
v_mfma_f32_16x16x32_bf16 v[216:219], a[104:107], a[24:27], v[216:219]
ds_read_b128 a[140:143], v5 offset:43008
v_mfma_f32_16x16x32_bf16 v[216:219], a[108:111], a[28:31], v[216:219]
v_mfma_f32_16x16x32_bf16 v[192:195], a[108:111], a[20:23], v[192:195]
buffer_load_dwordx4 v1, s[4:7], s44 offen offset:1024 sc1 lds
s_add_u32 s88, s82, 0x380000
v_mfma_f32_16x16x32_bf16 v[192:195], a[104:107], a[16:19], v[192:195]
ds_read_b128 a[144:147], v5 offset:37888
v_mfma_f32_16x16x32_bf16 v[168:171], a[104:107], a[8:11], v[168:171]
v_mfma_f32_16x16x32_bf16 v[168:171], a[108:111], a[12:15], v[168:171]
ds_read_b128 a[148:151], v5 offset:44032
v_mfma_f32_16x16x32_bf16 v[144:147], a[108:111], a[4:7], v[144:147]
v_mfma_f32_16x16x32_bf16 v[144:147], a[104:107], a[0:3], v[144:147]
buffer_load_dwordx4 a[72:75], v2, s[40:43], s35 offen offset:1024 sc1
v_mfma_f32_16x16x32_bf16 v[148:151], a[112:115], a[0:3], v[148:151]
v_mfma_f32_16x16x32_bf16 v[148:151], a[116:119], a[4:7], v[148:151]
v_mfma_f32_16x16x32_bf16 v[172:175], a[116:119], a[12:15], v[172:175]
v_mfma_f32_16x16x32_bf16 v[172:175], a[112:115], a[8:11], v[172:175]
v_mfma_f32_16x16x32_bf16 v[196:199], a[112:115], a[16:19], v[196:199]
buffer_load_dwordx4 a[76:79], v2, s[40:43], s33 offen offset:1024 sc1
v_mfma_f32_16x16x32_bf16 v[196:199], a[116:119], a[20:23], v[196:199]
v_mfma_f32_16x16x32_bf16 v[220:223], a[116:119], a[28:31], v[220:223]
v_mfma_f32_16x16x32_bf16 v[220:223], a[112:115], a[24:27], v[220:223]
s_waitcnt lgkmcnt(0)
s_barrier
v_mfma_f32_16x16x32_bf16 v[224:227], a[128:131], a[24:27], v[224:227]
v_add_u32 v5, 49152, v1
v_mfma_f32_16x16x32_bf16 v[224:227], a[132:135], a[28:31], v[224:227]
buffer_load_dwordx4 a[80:83], v2, s[40:43], s35 offen offset:2048 sc1
v_mfma_f32_16x16x32_bf16 v[200:203], a[132:135], a[20:23], v[200:203]
ds_read_b128 a[96:99], v5 offset:2048
v_mfma_f32_16x16x32_bf16 v[200:203], a[128:131], a[16:19], v[200:203]
ds_read_b128 a[100:103], v5 offset:8192
v_mfma_f32_16x16x32_bf16 v[176:179], a[128:131], a[8:11], v[176:179]
v_mfma_f32_16x16x32_bf16 v[176:179], a[132:135], a[12:15], v[176:179]
buffer_load_dwordx4 a[84:87], v2, s[40:43], s33 offen offset:2048 sc1
v_mfma_f32_16x16x32_bf16 v[152:155], a[132:135], a[4:7], v[152:155]
ds_read_b128 a[104:107], v5 offset:3072
v_mfma_f32_16x16x32_bf16 v[152:155], a[128:131], a[0:3], v[152:155]
v_mfma_f32_16x16x32_bf16 v[132:135], a[136:139], a[0:3], v[132:135]
ds_read_b128 a[108:111], v5 offset:9216
v_mfma_f32_16x16x32_bf16 v[132:135], a[140:143], a[4:7], v[132:135]
v_mfma_f32_16x16x32_bf16 v[156:159], a[140:143], a[12:15], v[156:159]
buffer_load_dwordx4 v[92:95], v1, s[4:7], s88 offen offset:0 sc1
v_mfma_f32_16x16x32_bf16 v[156:159], a[136:139], a[8:11], v[156:159]
ds_read_b128 a[112:115], v5 offset:4096
v_mfma_f32_16x16x32_bf16 v[180:183], a[136:139], a[16:19], v[180:183]
v_mfma_f32_16x16x32_bf16 v[180:183], a[140:143], a[20:23], v[180:183]
ds_read_b128 a[116:119], v5 offset:10240
v_mfma_f32_16x16x32_bf16 v[204:207], a[140:143], a[28:31], v[204:207]
v_mfma_f32_16x16x32_bf16 v[204:207], a[136:139], a[24:27], v[204:207]
buffer_load_dwordx4 a[88:91], v2, s[40:43], s35 offen offset:3072 sc1
v_mfma_f32_16x16x32_bf16 v[208:211], a[144:147], a[24:27], v[208:211]
v_mfma_f32_16x16x32_bf16 v[208:211], a[148:151], a[28:31], v[208:211]
v_mfma_f32_16x16x32_bf16 v[184:187], a[148:151], a[20:23], v[184:187]
v_mfma_f32_16x16x32_bf16 v[184:187], a[144:147], a[16:19], v[184:187]
v_mfma_f32_16x16x32_bf16 v[160:163], a[144:147], a[8:11], v[160:163]
buffer_load_dwordx4 a[92:95], v2, s[40:43], s33 offen offset:3072 sc1
s_add_u32 s35, s35, 0x4000
v_mfma_f32_16x16x32_bf16 v[160:163], a[148:151], a[12:15], v[160:163]
s_add_u32 s33, s33, 0x4000
v_mfma_f32_16x16x32_bf16 v[136:139], a[148:151], a[4:7], v[136:139]
v_mfma_f32_16x16x32_bf16 v[136:139], a[144:147], a[0:3], v[136:139]
s_waitcnt vmcnt(10) lgkmcnt(0)
v_mfma_f32_16x16x32_bf16 v[140:143], a[96:99], a[32:35], v[140:143]
ds_read_b128 a[128:131], v5 offset:5120
v_mfma_f32_16x16x32_bf16 v[140:143], a[100:103], a[36:39], v[140:143]
buffer_load_dwordx4 a[0:3], v2, s[40:43], s35 offen offset:0 sc1
v_mfma_f32_16x16x32_bf16 v[164:167], a[100:103], a[44:47], v[164:167]
ds_read_b128 a[132:135], v5 offset:11264
v_mfma_f32_16x16x32_bf16 v[164:167], a[96:99], a[40:43], v[164:167]
v_mfma_f32_16x16x32_bf16 v[188:191], a[96:99], a[48:51], v[188:191]
v_mfma_f32_16x16x32_bf16 v[188:191], a[100:103], a[52:55], v[188:191]
buffer_load_dwordx4 a[4:7], v2, s[40:43], s33 offen offset:0 sc1
v_mfma_f32_16x16x32_bf16 v[212:215], a[100:103], a[60:63], v[212:215]
ds_read_b128 a[136:139], v5 offset:0
v_mfma_f32_16x16x32_bf16 v[212:215], a[96:99], a[56:59], v[212:215]
v_mfma_f32_16x16x32_bf16 v[216:219], a[104:107], a[56:59], v[216:219]
ds_read_b128 a[140:143], v5 offset:6144
v_mfma_f32_16x16x32_bf16 v[216:219], a[108:111], a[60:63], v[216:219]
v_mfma_f32_16x16x32_bf16 v[192:195], a[108:111], a[52:55], v[192:195]
buffer_load_dwordx4 v[96:99], v1, s[4:7], s88 offen offset:1024 sc1
v_mfma_f32_16x16x32_bf16 v[192:195], a[104:107], a[48:51], v[192:195]
ds_read_b128 a[144:147], v5 offset:1024
v_mfma_f32_16x16x32_bf16 v[168:171], a[104:107], a[40:43], v[168:171]
v_mfma_f32_16x16x32_bf16 v[168:171], a[108:111], a[44:47], v[168:171]
ds_read_b128 a[148:151], v5 offset:7168
v_mfma_f32_16x16x32_bf16 v[144:147], a[108:111], a[36:39], v[144:147]
v_mfma_f32_16x16x32_bf16 v[144:147], a[104:107], a[32:35], v[144:147]
buffer_load_dwordx4 a[8:11], v2, s[40:43], s35 offen offset:1024 sc1
v_mfma_f32_16x16x32_bf16 v[148:151], a[112:115], a[32:35], v[148:151]
v_mfma_f32_16x16x32_bf16 v[148:151], a[116:119], a[36:39], v[148:151]
v_mfma_f32_16x16x32_bf16 v[172:175], a[116:119], a[44:47], v[172:175]
v_mfma_f32_16x16x32_bf16 v[172:175], a[112:115], a[40:43], v[172:175]
v_mfma_f32_16x16x32_bf16 v[196:199], a[112:115], a[48:51], v[196:199]
buffer_load_dwordx4 a[12:15], v2, s[40:43], s33 offen offset:1024 sc1
v_mfma_f32_16x16x32_bf16 v[196:199], a[116:119], a[52:55], v[196:199]
v_mfma_f32_16x16x32_bf16 v[220:223], a[116:119], a[60:63], v[220:223]
v_mfma_f32_16x16x32_bf16 v[220:223], a[112:115], a[56:59], v[220:223]
s_waitcnt lgkmcnt(0)
v_mfma_f32_16x16x32_bf16 v[224:227], a[128:131], a[56:59], v[224:227]
ds_read_b128 a[96:99], v5 offset:14336
v_mfma_f32_16x16x32_bf16 v[224:227], a[132:135], a[60:63], v[224:227]
buffer_load_dwordx4 a[16:19], v2, s[40:43], s35 offen offset:2048 sc1
v_mfma_f32_16x16x32_bf16 v[200:203], a[132:135], a[52:55], v[200:203]
ds_read_b128 a[100:103], v5 offset:20480
v_mfma_f32_16x16x32_bf16 v[200:203], a[128:131], a[48:51], v[200:203]
v_mfma_f32_16x16x32_bf16 v[176:179], a[128:131], a[40:43], v[176:179]
v_mfma_f32_16x16x32_bf16 v[176:179], a[132:135], a[44:47], v[176:179]
buffer_load_dwordx4 v[100:103], v1, s[4:7], s88 offen offset:2048 sc1
v_mfma_f32_16x16x32_bf16 v[152:155], a[132:135], a[36:39], v[152:155]
ds_read_b128 a[104:107], v5 offset:15360
v_mfma_f32_16x16x32_bf16 v[152:155], a[128:131], a[32:35], v[152:155]
v_mfma_f32_16x16x32_bf16 v[132:135], a[136:139], a[32:35], v[132:135]
ds_read_b128 a[108:111], v5 offset:21504
v_mfma_f32_16x16x32_bf16 v[132:135], a[140:143], a[36:39], v[132:135]
buffer_load_dwordx4 a[20:23], v2, s[40:43], s33 offen offset:2048 sc1
v_mfma_f32_16x16x32_bf16 v[156:159], a[140:143], a[44:47], v[156:159]
ds_read_b128 a[112:115], v5 offset:16384
v_mfma_f32_16x16x32_bf16 v[156:159], a[136:139], a[40:43], v[156:159]
v_mfma_f32_16x16x32_bf16 v[180:183], a[136:139], a[48:51], v[180:183]
v_mfma_f32_16x16x32_bf16 v[180:183], a[140:143], a[52:55], v[180:183]
buffer_load_dwordx4 a[24:27], v2, s[40:43], s35 offen offset:3072 sc1
v_mfma_f32_16x16x32_bf16 v[204:207], a[140:143], a[60:63], v[204:207]
ds_read_b128 a[116:119], v5 offset:22528
v_mfma_f32_16x16x32_bf16 v[204:207], a[136:139], a[56:59], v[204:207]
v_mfma_f32_16x16x32_bf16 v[208:211], a[144:147], a[56:59], v[208:211]
v_mfma_f32_16x16x32_bf16 v[208:211], a[148:151], a[60:63], v[208:211]
buffer_load_dwordx4 v[104:107], v1, s[4:7], s88 offen offset:3072 sc1
s_add_u32 s88, s88, 4096
v_mfma_f32_16x16x32_bf16 v[184:187], a[148:151], a[52:55], v[184:187]
v_mfma_f32_16x16x32_bf16 v[184:187], a[144:147], a[48:51], v[184:187]
v_mfma_f32_16x16x32_bf16 v[160:163], a[144:147], a[40:43], v[160:163]
v_mfma_f32_16x16x32_bf16 v[160:163], a[148:151], a[44:47], v[160:163]
buffer_load_dwordx4 a[28:31], v2, s[40:43], s33 offen offset:3072 sc1
s_add_u32 s35, s35, 0x4000
v_mfma_f32_16x16x32_bf16 v[136:139], a[148:151], a[36:39], v[136:139]
s_add_u32 s33, s33, 0x4000
v_mfma_f32_16x16x32_bf16 v[136:139], a[144:147], a[32:35], v[136:139]
s_waitcnt vmcnt(11) lgkmcnt(0)
v_mfma_f32_16x16x32_bf16 v[140:143], a[96:99], a[64:67], v[140:143]
ds_read_b128 a[128:131], v5 offset:17408
v_mfma_f32_16x16x32_bf16 v[140:143], a[100:103], a[68:71], v[140:143]
buffer_load_dwordx4 a[32:35], v2, s[40:43], s35 offen offset:0 sc1
v_mfma_f32_16x16x32_bf16 v[164:167], a[100:103], a[76:79], v[164:167]
ds_read_b128 a[132:135], v5 offset:23552
v_mfma_f32_16x16x32_bf16 v[164:167], a[96:99], a[72:75], v[164:167]
v_mfma_f32_16x16x32_bf16 v[188:191], a[96:99], a[80:83], v[188:191]
v_mfma_f32_16x16x32_bf16 v[188:191], a[100:103], a[84:87], v[188:191]
buffer_load_dwordx4 a[36:39], v2, s[40:43], s33 offen offset:0 sc1
v_mfma_f32_16x16x32_bf16 v[212:215], a[100:103], a[92:95], v[212:215]
ds_read_b128 a[136:139], v5 offset:12288
v_mfma_f32_16x16x32_bf16 v[212:215], a[96:99], a[88:91], v[212:215]
v_mfma_f32_16x16x32_bf16 v[216:219], a[104:107], a[88:91], v[216:219]
ds_read_b128 a[140:143], v5 offset:18432
v_mfma_f32_16x16x32_bf16 v[216:219], a[108:111], a[92:95], v[216:219]
v_mfma_f32_16x16x32_bf16 v[192:195], a[108:111], a[84:87], v[192:195]
buffer_load_dwordx4 v[108:111], v1, s[4:7], s88 offen offset:0 sc1
v_mfma_f32_16x16x32_bf16 v[192:195], a[104:107], a[80:83], v[192:195]
ds_read_b128 a[144:147], v5 offset:13312
v_mfma_f32_16x16x32_bf16 v[168:171], a[104:107], a[72:75], v[168:171]
v_mfma_f32_16x16x32_bf16 v[168:171], a[108:111], a[76:79], v[168:171]
ds_read_b128 a[148:151], v5 offset:19456
v_mfma_f32_16x16x32_bf16 v[144:147], a[108:111], a[68:71], v[144:147]
v_mfma_f32_16x16x32_bf16 v[144:147], a[104:107], a[64:67], v[144:147]
buffer_load_dwordx4 a[40:43], v2, s[40:43], s35 offen offset:1024 sc1
v_mfma_f32_16x16x32_bf16 v[148:151], a[112:115], a[64:67], v[148:151]
v_mfma_f32_16x16x32_bf16 v[148:151], a[116:119], a[68:71], v[148:151]
v_mfma_f32_16x16x32_bf16 v[172:175], a[116:119], a[76:79], v[172:175]
v_mfma_f32_16x16x32_bf16 v[172:175], a[112:115], a[72:75], v[172:175]
v_mfma_f32_16x16x32_bf16 v[196:199], a[112:115], a[80:83], v[196:199]
buffer_load_dwordx4 a[44:47], v2, s[40:43], s33 offen offset:1024 sc1
v_mfma_f32_16x16x32_bf16 v[196:199], a[116:119], a[84:87], v[196:199]
v_mfma_f32_16x16x32_bf16 v[220:223], a[116:119], a[92:95], v[220:223]
v_mfma_f32_16x16x32_bf16 v[220:223], a[112:115], a[88:91], v[220:223]
s_waitcnt lgkmcnt(0)
v_mfma_f32_16x16x32_bf16 v[224:227], a[128:131], a[88:91], v[224:227]
ds_read_b128 a[96:99], v5 offset:26624
v_mfma_f32_16x16x32_bf16 v[224:227], a[132:135], a[92:95], v[224:227]
buffer_load_dwordx4 a[48:51], v2, s[40:43], s35 offen offset:2048 sc1
v_mfma_f32_16x16x32_bf16 v[200:203], a[132:135], a[84:87], v[200:203]
ds_read_b128 a[100:103], v5 offset:32768
v_mfma_f32_16x16x32_bf16 v[200:203], a[128:131], a[80:83], v[200:203]
v_mfma_f32_16x16x32_bf16 v[176:179], a[128:131], a[72:75], v[176:179]
v_mfma_f32_16x16x32_bf16 v[176:179], a[132:135], a[76:79], v[176:179]
buffer_load_dwordx4 a[52:55], v2, s[40:43], s33 offen offset:2048 sc1
v_mfma_f32_16x16x32_bf16 v[152:155], a[132:135], a[68:71], v[152:155]
ds_read_b128 a[104:107], v5 offset:27648
v_mfma_f32_16x16x32_bf16 v[152:155], a[128:131], a[64:67], v[152:155]
v_mfma_f32_16x16x32_bf16 v[132:135], a[136:139], a[64:67], v[132:135]
ds_read_b128 a[108:111], v5 offset:33792
v_mfma_f32_16x16x32_bf16 v[132:135], a[140:143], a[68:71], v[132:135]
v_mfma_f32_16x16x32_bf16 v[156:159], a[140:143], a[76:79], v[156:159]
buffer_load_dwordx4 v[112:115], v1, s[4:7], s88 offen offset:1024 sc1
v_mfma_f32_16x16x32_bf16 v[156:159], a[136:139], a[72:75], v[156:159]
ds_read_b128 a[112:115], v5 offset:28672
v_mfma_f32_16x16x32_bf16 v[180:183], a[136:139], a[80:83], v[180:183]
v_mfma_f32_16x16x32_bf16 v[180:183], a[140:143], a[84:87], v[180:183]
ds_read_b128 a[116:119], v5 offset:34816
v_mfma_f32_16x16x32_bf16 v[204:207], a[140:143], a[92:95], v[204:207]
v_mfma_f32_16x16x32_bf16 v[204:207], a[136:139], a[88:91], v[204:207]
buffer_load_dwordx4 a[56:59], v2, s[40:43], s35 offen offset:3072 sc1
v_mfma_f32_16x16x32_bf16 v[208:211], a[144:147], a[88:91], v[208:211]
v_mfma_f32_16x16x32_bf16 v[208:211], a[148:151], a[92:95], v[208:211]
v_mfma_f32_16x16x32_bf16 v[184:187], a[148:151], a[84:87], v[184:187]
v_mfma_f32_16x16x32_bf16 v[184:187], a[144:147], a[80:83], v[184:187]
v_mfma_f32_16x16x32_bf16 v[160:163], a[144:147], a[72:75], v[160:163]
buffer_load_dwordx4 a[60:63], v2, s[40:43], s33 offen offset:3072 sc1
s_add_u32 s35, s35, 0x64000
v_mfma_f32_16x16x32_bf16 v[160:163], a[148:151], a[76:79], v[160:163]
s_add_u32 s33, s33, 0x64000
v_mfma_f32_16x16x32_bf16 v[136:139], a[148:151], a[68:71], v[136:139]
v_mfma_f32_16x16x32_bf16 v[136:139], a[144:147], a[64:67], v[136:139]
s_waitcnt vmcnt(10) lgkmcnt(0)
v_mfma_f32_16x16x32_bf16 v[140:143], a[96:99], a[0:3], v[140:143]
ds_read_b128 a[128:131], v5 offset:29696
v_mfma_f32_16x16x32_bf16 v[140:143], a[100:103], a[4:7], v[140:143]
buffer_load_dwordx4 a[64:67], v2, s[40:43], s35 offen offset:0 sc1
v_mfma_f32_16x16x32_bf16 v[164:167], a[100:103], a[12:15], v[164:167]
ds_read_b128 a[132:135], v5 offset:35840
v_mfma_f32_16x16x32_bf16 v[164:167], a[96:99], a[8:11], v[164:167]
v_mfma_f32_16x16x32_bf16 v[188:191], a[96:99], a[16:19], v[188:191]
v_mfma_f32_16x16x32_bf16 v[188:191], a[100:103], a[20:23], v[188:191]
buffer_load_dwordx4 a[68:71], v2, s[40:43], s33 offen offset:0 sc1
v_mfma_f32_16x16x32_bf16 v[212:215], a[100:103], a[28:31], v[212:215]
ds_read_b128 a[136:139], v5 offset:24576
v_mfma_f32_16x16x32_bf16 v[212:215], a[96:99], a[24:27], v[212:215]
v_mfma_f32_16x16x32_bf16 v[216:219], a[104:107], a[24:27], v[216:219]
ds_read_b128 a[140:143], v5 offset:30720
v_mfma_f32_16x16x32_bf16 v[216:219], a[108:111], a[28:31], v[216:219]
v_mfma_f32_16x16x32_bf16 v[192:195], a[108:111], a[20:23], v[192:195]
buffer_load_dwordx4 v[116:119], v1, s[4:7], s88 offen offset:2048 sc1
v_mfma_f32_16x16x32_bf16 v[192:195], a[104:107], a[16:19], v[192:195]
ds_read_b128 a[144:147], v5 offset:25600
v_mfma_f32_16x16x32_bf16 v[168:171], a[104:107], a[8:11], v[168:171]
v_mfma_f32_16x16x32_bf16 v[168:171], a[108:111], a[12:15], v[168:171]
ds_read_b128 a[148:151], v5 offset:31744
v_mfma_f32_16x16x32_bf16 v[144:147], a[108:111], a[4:7], v[144:147]
v_mfma_f32_16x16x32_bf16 v[144:147], a[104:107], a[0:3], v[144:147]
buffer_load_dwordx4 a[72:75], v2, s[40:43], s35 offen offset:1024 sc1
v_mfma_f32_16x16x32_bf16 v[148:151], a[112:115], a[0:3], v[148:151]
v_mfma_f32_16x16x32_bf16 v[148:151], a[116:119], a[4:7], v[148:151]
v_mfma_f32_16x16x32_bf16 v[172:175], a[116:119], a[12:15], v[172:175]
v_mfma_f32_16x16x32_bf16 v[172:175], a[112:115], a[8:11], v[172:175]
v_mfma_f32_16x16x32_bf16 v[196:199], a[112:115], a[16:19], v[196:199]
buffer_load_dwordx4 a[76:79], v2, s[40:43], s33 offen offset:1024 sc1
v_mfma_f32_16x16x32_bf16 v[196:199], a[116:119], a[20:23], v[196:199]
v_mfma_f32_16x16x32_bf16 v[220:223], a[116:119], a[28:31], v[220:223]
v_mfma_f32_16x16x32_bf16 v[220:223], a[112:115], a[24:27], v[220:223]
s_waitcnt lgkmcnt(0)
v_mfma_f32_16x16x32_bf16 v[224:227], a[128:131], a[24:27], v[224:227]
ds_read_b128 a[96:99], v5 offset:38912
v_mfma_f32_16x16x32_bf16 v[224:227], a[132:135], a[28:31], v[224:227]
buffer_load_dwordx4 a[80:83], v2, s[40:43], s35 offen offset:2048 sc1
v_mfma_f32_16x16x32_bf16 v[200:203], a[132:135], a[20:23], v[200:203]
ds_read_b128 a[100:103], v5 offset:45056
v_mfma_f32_16x16x32_bf16 v[200:203], a[128:131], a[16:19], v[200:203]
v_mfma_f32_16x16x32_bf16 v[176:179], a[128:131], a[8:11], v[176:179]
v_mfma_f32_16x16x32_bf16 v[176:179], a[132:135], a[12:15], v[176:179]
buffer_load_dwordx4 a[84:87], v2, s[40:43], s33 offen offset:2048 sc1
v_mfma_f32_16x16x32_bf16 v[152:155], a[132:135], a[4:7], v[152:155]
ds_read_b128 a[104:107], v5 offset:39936
v_mfma_f32_16x16x32_bf16 v[152:155], a[128:131], a[0:3], v[152:155]
v_mfma_f32_16x16x32_bf16 v[132:135], a[136:139], a[0:3], v[132:135]
ds_read_b128 a[108:111], v5 offset:46080
v_mfma_f32_16x16x32_bf16 v[132:135], a[140:143], a[4:7], v[132:135]
v_mfma_f32_16x16x32_bf16 v[156:159], a[140:143], a[12:15], v[156:159]
buffer_load_dwordx4 v[120:123], v1, s[4:7], s88 offen offset:3072 sc1
s_add_u32 m0, s18, 0x0
v_mfma_f32_16x16x32_bf16 v[156:159], a[136:139], a[8:11], v[156:159]
s_add_u32 s44, s50, 0x2824000
ds_read_b128 a[112:115], v5 offset:40960
v_mfma_f32_16x16x32_bf16 v[180:183], a[136:139], a[16:19], v[180:183]
v_mfma_f32_16x16x32_bf16 v[180:183], a[140:143], a[20:23], v[180:183]
ds_read_b128 a[116:119], v5 offset:47104
v_mfma_f32_16x16x32_bf16 v[204:207], a[140:143], a[28:31], v[204:207]
v_mfma_f32_16x16x32_bf16 v[204:207], a[136:139], a[24:27], v[204:207]
buffer_load_dwordx4 a[88:91], v2, s[40:43], s35 offen offset:3072 sc1
v_mfma_f32_16x16x32_bf16 v[208:211], a[144:147], a[24:27], v[208:211]
v_mfma_f32_16x16x32_bf16 v[208:211], a[148:151], a[28:31], v[208:211]
v_mfma_f32_16x16x32_bf16 v[184:187], a[148:151], a[20:23], v[184:187]
v_mfma_f32_16x16x32_bf16 v[184:187], a[144:147], a[16:19], v[184:187]
v_mfma_f32_16x16x32_bf16 v[160:163], a[144:147], a[8:11], v[160:163]
buffer_load_dwordx4 a[92:95], v2, s[40:43], s33 offen offset:3072 sc1
s_add_u32 s35, s35, 0x4000
v_mfma_f32_16x16x32_bf16 v[160:163], a[148:151], a[12:15], v[160:163]
s_add_u32 s33, s33, 0x4000
v_mfma_f32_16x16x32_bf16 v[136:139], a[148:151], a[4:7], v[136:139]
v_mfma_f32_16x16x32_bf16 v[136:139], a[144:147], a[0:3], v[136:139]
s_waitcnt vmcnt(10) lgkmcnt(0)
v_mfma_f32_16x16x32_bf16 v[140:143], a[96:99], a[32:35], v[140:143]
ds_read_b128 a[128:131], v5 offset:41984
v_mfma_f32_16x16x32_bf16 v[140:143], a[100:103], a[36:39], v[140:143]
buffer_load_dwordx4 a[0:3], v2, s[40:43], s35 offen offset:0 sc1
v_mfma_f32_16x16x32_bf16 v[164:167], a[100:103], a[44:47], v[164:167]
ds_read_b128 a[132:135], v5 offset:48128
v_mfma_f32_16x16x32_bf16 v[164:167], a[96:99], a[40:43], v[164:167]
v_mfma_f32_16x16x32_bf16 v[188:191], a[96:99], a[48:51], v[188:191]
v_mfma_f32_16x16x32_bf16 v[188:191], a[100:103], a[52:55], v[188:191]
buffer_load_dwordx4 v1, s[4:7], s44 offen offset:0 sc1 lds
v_mfma_f32_16x16x32_bf16 v[212:215], a[100:103], a[60:63], v[212:215]
ds_read_b128 a[136:139], v5 offset:36864
v_mfma_f32_16x16x32_bf16 v[212:215], a[96:99], a[56:59], v[212:215]
v_mfma_f32_16x16x32_bf16 v[216:219], a[104:107], a[56:59], v[216:219]
ds_read_b128 a[140:143], v5 offset:43008
v_mfma_f32_16x16x32_bf16 v[216:219], a[108:111], a[60:63], v[216:219]
buffer_load_dwordx4 a[4:7], v2, s[40:43], s33 offen offset:0 sc1
v_mfma_f32_16x16x32_bf16 v[192:195], a[108:111], a[52:55], v[192:195]
ds_read_b128 a[144:147], v5 offset:37888
v_mfma_f32_16x16x32_bf16 v[192:195], a[104:107], a[48:51], v[192:195]
v_mfma_f32_16x16x32_bf16 v[168:171], a[104:107], a[40:43], v[168:171]
v_mfma_f32_16x16x32_bf16 v[168:171], a[108:111], a[44:47], v[168:171]
buffer_load_dwordx4 a[8:11], v2, s[40:43], s35 offen offset:1024 sc1
v_mfma_f32_16x16x32_bf16 v[144:147], a[108:111], a[36:39], v[144:147]
ds_read_b128 a[148:151], v5 offset:44032
v_mfma_f32_16x16x32_bf16 v[144:147], a[104:107], a[32:35], v[144:147]
v_mfma_f32_16x16x32_bf16 v[148:151], a[112:115], a[32:35], v[148:151]
v_mfma_f32_16x16x32_bf16 v[148:151], a[116:119], a[36:39], v[148:151]
buffer_load_dwordx4 v1, s[4:7], s44 offen offset:1024 sc1 lds
s_add_u32 m0, s18, 0x2000
v_mfma_f32_16x16x32_bf16 v[172:175], a[116:119], a[44:47], v[172:175]
s_add_u32 s44, s50, 0x2826000
v_mfma_f32_16x16x32_bf16 v[172:175], a[112:115], a[40:43], v[172:175]
v_mfma_f32_16x16x32_bf16 v[196:199], a[112:115], a[48:51], v[196:199]
v_mfma_f32_16x16x32_bf16 v[196:199], a[116:119], a[52:55], v[196:199]
buffer_load_dwordx4 a[12:15], v2, s[40:43], s33 offen offset:1024 sc1
v_mfma_f32_16x16x32_bf16 v[220:223], a[116:119], a[60:63], v[220:223]
v_mfma_f32_16x16x32_bf16 v[220:223], a[112:115], a[56:59], v[220:223]
s_waitcnt lgkmcnt(0)
s_barrier
v_mfma_f32_16x16x32_bf16 v[224:227], a[128:131], a[56:59], v[224:227]
v_add_u32 v5, 98304, v1
v_mfma_f32_16x16x32_bf16 v[224:227], a[132:135], a[60:63], v[224:227]
buffer_load_dwordx4 a[16:19], v2, s[40:43], s35 offen offset:2048 sc1
v_mfma_f32_16x16x32_bf16 v[200:203], a[132:135], a[52:55], v[200:203]
ds_read_b128 a[96:99], v5 offset:2048
v_mfma_f32_16x16x32_bf16 v[200:203], a[128:131], a[48:51], v[200:203]
ds_read_b128 a[100:103], v5 offset:8192
v_mfma_f32_16x16x32_bf16 v[176:179], a[128:131], a[40:43], v[176:179]
v_mfma_f32_16x16x32_bf16 v[176:179], a[132:135], a[44:47], v[176:179]
buffer_load_dwordx4 a[20:23], v2, s[40:43], s33 offen offset:2048 sc1
v_mfma_f32_16x16x32_bf16 v[152:155], a[132:135], a[36:39], v[152:155]
ds_read_b128 a[104:107], v5 offset:3072
v_mfma_f32_16x16x32_bf16 v[152:155], a[128:131], a[32:35], v[152:155]
v_mfma_f32_16x16x32_bf16 v[132:135], a[136:139], a[32:35], v[132:135]
ds_read_b128 a[108:111], v5 offset:9216
v_mfma_f32_16x16x32_bf16 v[132:135], a[140:143], a[36:39], v[132:135]
v_mfma_f32_16x16x32_bf16 v[156:159], a[140:143], a[44:47], v[156:159]
buffer_load_dwordx4 v1, s[4:7], s44 offen offset:0 sc1 lds
v_mfma_f32_16x16x32_bf16 v[156:159], a[136:139], a[40:43], v[156:159]
ds_read_b128 a[112:115], v5 offset:4096
v_mfma_f32_16x16x32_bf16 v[180:183], a[136:139], a[48:51], v[180:183]
v_mfma_f32_16x16x32_bf16 v[180:183], a[140:143], a[52:55], v[180:183]
ds_read_b128 a[116:119], v5 offset:10240
v_mfma_f32_16x16x32_bf16 v[204:207], a[140:143], a[60:63], v[204:207]
v_mfma_f32_16x16x32_bf16 v[204:207], a[136:139], a[56:59], v[204:207]
buffer_load_dwordx4 a[24:27], v2, s[40:43], s35 offen offset:3072 sc1
v_mfma_f32_16x16x32_bf16 v[208:211], a[144:147], a[56:59], v[208:211]
v_mfma_f32_16x16x32_bf16 v[208:211], a[148:151], a[60:63], v[208:211]
v_mfma_f32_16x16x32_bf16 v[184:187], a[148:151], a[52:55], v[184:187]
v_mfma_f32_16x16x32_bf16 v[184:187], a[144:147], a[48:51], v[184:187]
v_mfma_f32_16x16x32_bf16 v[160:163], a[144:147], a[40:43], v[160:163]
buffer_load_dwordx4 a[28:31], v2, s[40:43], s33 offen offset:3072 sc1
s_add_u32 s35, s35, 0x4000
v_mfma_f32_16x16x32_bf16 v[160:163], a[148:151], a[44:47], v[160:163]
s_add_u32 s33, s33, 0x4000
v_mfma_f32_16x16x32_bf16 v[136:139], a[148:151], a[36:39], v[136:139]
v_mfma_f32_16x16x32_bf16 v[136:139], a[144:147], a[32:35], v[136:139]
s_waitcnt vmcnt(11) lgkmcnt(0)
v_mfma_f32_16x16x32_bf16 v[140:143], a[96:99], a[64:67], v[140:143]
ds_read_b128 a[128:131], v5 offset:5120
v_mfma_f32_16x16x32_bf16 v[140:143], a[100:103], a[68:71], v[140:143]
buffer_load_dwordx4 a[32:35], v2, s[40:43], s35 offen offset:0 sc1
v_mfma_f32_16x16x32_bf16 v[164:167], a[100:103], a[76:79], v[164:167]
ds_read_b128 a[132:135], v5 offset:11264
v_mfma_f32_16x16x32_bf16 v[164:167], a[96:99], a[72:75], v[164:167]
v_mfma_f32_16x16x32_bf16 v[188:191], a[96:99], a[80:83], v[188:191]
v_mfma_f32_16x16x32_bf16 v[188:191], a[100:103], a[84:87], v[188:191]
buffer_load_dwordx4 a[36:39], v2, s[40:43], s33 offen offset:0 sc1
v_mfma_f32_16x16x32_bf16 v[212:215], a[100:103], a[92:95], v[212:215]
ds_read_b128 a[136:139], v5 offset:0
v_mfma_f32_16x16x32_bf16 v[212:215], a[96:99], a[88:91], v[212:215]
v_mfma_f32_16x16x32_bf16 v[216:219], a[104:107], a[88:91], v[216:219]
ds_read_b128 a[140:143], v5 offset:6144
v_mfma_f32_16x16x32_bf16 v[216:219], a[108:111], a[92:95], v[216:219]
v_mfma_f32_16x16x32_bf16 v[192:195], a[108:111], a[84:87], v[192:195]
buffer_load_dwordx4 v1, s[4:7], s44 offen offset:1024 sc1 lds
s_add_u32 m0, s18, 0x4000
v_mfma_f32_16x16x32_bf16 v[192:195], a[104:107], a[80:83], v[192:195]
s_add_u32 s44, s50, 0x2828000
ds_read_b128 a[144:147], v5 offset:1024
v_mfma_f32_16x16x32_bf16 v[168:171], a[104:107], a[72:75], v[168:171]
v_mfma_f32_16x16x32_bf16 v[168:171], a[108:111], a[76:79], v[168:171]
ds_read_b128 a[148:151], v5 offset:7168
v_mfma_f32_16x16x32_bf16 v[144:147], a[108:111], a[68:71], v[144:147]
v_mfma_f32_16x16x32_bf16 v[144:147], a[104:107], a[64:67], v[144:147]
buffer_load_dwordx4 a[40:43], v2, s[40:43], s35 offen offset:1024 sc1
v_mfma_f32_16x16x32_bf16 v[148:151], a[112:115], a[64:67], v[148:151]
v_mfma_f32_16x16x32_bf16 v[148:151], a[116:119], a[68:71], v[148:151]
v_mfma_f32_16x16x32_bf16 v[172:175], a[116:119], a[76:79], v[172:175]
v_mfma_f32_16x16x32_bf16 v[172:175], a[112:115], a[72:75], v[172:175]
v_mfma_f32_16x16x32_bf16 v[196:199], a[112:115], a[80:83], v[196:199]
buffer_load_dwordx4 a[44:47], v2, s[40:43], s33 offen offset:1024 sc1
v_mfma_f32_16x16x32_bf16 v[196:199], a[116:119], a[84:87], v[196:199]
v_mfma_f32_16x16x32_bf16 v[220:223], a[116:119], a[92:95], v[220:223]
v_mfma_f32_16x16x32_bf16 v[220:223], a[112:115], a[88:91], v[220:223]
s_waitcnt lgkmcnt(0)
v_mfma_f32_16x16x32_bf16 v[224:227], a[128:131], a[88:91], v[224:227]
ds_read_b128 a[96:99], v5 offset:14336
v_mfma_f32_16x16x32_bf16 v[224:227], a[132:135], a[92:95], v[224:227]
buffer_load_dwordx4 a[48:51], v2, s[40:43], s35 offen offset:2048 sc1
v_mfma_f32_16x16x32_bf16 v[200:203], a[132:135], a[84:87], v[200:203]
ds_read_b128 a[100:103], v5 offset:20480
v_mfma_f32_16x16x32_bf16 v[200:203], a[128:131], a[80:83], v[200:203]
v_mfma_f32_16x16x32_bf16 v[176:179], a[128:131], a[72:75], v[176:179]
v_mfma_f32_16x16x32_bf16 v[176:179], a[132:135], a[76:79], v[176:179]
buffer_load_dwordx4 a[52:55], v2, s[40:43], s33 offen offset:2048 sc1
v_mfma_f32_16x16x32_bf16 v[152:155], a[132:135], a[68:71], v[152:155]
ds_read_b128 a[104:107], v5 offset:15360
v_mfma_f32_16x16x32_bf16 v[152:155], a[128:131], a[64:67], v[152:155]
v_mfma_f32_16x16x32_bf16 v[132:135], a[136:139], a[64:67], v[132:135]
ds_read_b128 a[108:111], v5 offset:21504
v_mfma_f32_16x16x32_bf16 v[132:135], a[140:143], a[68:71], v[132:135]
v_mfma_f32_16x16x32_bf16 v[156:159], a[140:143], a[76:79], v[156:159]
buffer_load_dwordx4 v1, s[4:7], s44 offen offset:0 sc1 lds
v_mfma_f32_16x16x32_bf16 v[156:159], a[136:139], a[72:75], v[156:159]
ds_read_b128 a[112:115], v5 offset:16384
v_mfma_f32_16x16x32_bf16 v[180:183], a[136:139], a[80:83], v[180:183]
v_mfma_f32_16x16x32_bf16 v[180:183], a[140:143], a[84:87], v[180:183]
ds_read_b128 a[116:119], v5 offset:22528
v_mfma_f32_16x16x32_bf16 v[204:207], a[140:143], a[92:95], v[204:207]
v_mfma_f32_16x16x32_bf16 v[204:207], a[136:139], a[88:91], v[204:207]
buffer_load_dwordx4 a[56:59], v2, s[40:43], s35 offen offset:3072 sc1
v_mfma_f32_16x16x32_bf16 v[208:211], a[144:147], a[88:91], v[208:211]
v_mfma_f32_16x16x32_bf16 v[208:211], a[148:151], a[92:95], v[208:211]
v_mfma_f32_16x16x32_bf16 v[184:187], a[148:151], a[84:87], v[184:187]
v_mfma_f32_16x16x32_bf16 v[184:187], a[144:147], a[80:83], v[184:187]
v_mfma_f32_16x16x32_bf16 v[160:163], a[144:147], a[72:75], v[160:163]
buffer_load_dwordx4 a[60:63], v2, s[40:43], s33 offen offset:3072 sc1
s_add_u32 s35, s35, 0x4000
v_mfma_f32_16x16x32_bf16 v[160:163], a[148:151], a[76:79], v[160:163]
s_add_u32 s33, s33, 0x4000
v_mfma_f32_16x16x32_bf16 v[136:139], a[148:151], a[68:71], v[136:139]
v_mfma_f32_16x16x32_bf16 v[136:139], a[144:147], a[64:67], v[136:139]
s_waitcnt vmcnt(10) lgkmcnt(0)
v_mfma_f32_16x16x32_bf16 v[140:143], a[96:99], a[0:3], v[140:143]
ds_read_b128 a[128:131], v5 offset:17408
v_add_f32 v92, v92, v96
v_mfma_f32_16x16x32_bf16 v[140:143], a[100:103], a[4:7], v[140:143]
buffer_load_dwordx4 a[64:67], v2, s[40:43], s35 offen offset:0 sc1
v_mfma_f32_16x16x32_bf16 v[164:167], a[100:103], a[12:15], v[164:167]
ds_read_b128 a[132:135], v5 offset:23552
v_add_f32 v100, v100, v104
v_mfma_f32_16x16x32_bf16 v[164:167], a[96:99], a[8:11], v[164:167]
v_add_f32 v108, v108, v112
v_add_f32 v116, v116, v120
v_mfma_f32_16x16x32_bf16 v[188:191], a[96:99], a[16:19], v[188:191]
v_add_f32 v93, v93, v97
v_add_f32 v101, v101, v105
v_mfma_f32_16x16x32_bf16 v[188:191], a[100:103], a[20:23], v[188:191]
buffer_load_dwordx4 a[68:71], v2, s[40:43], s33 offen offset:0 sc1
v_mfma_f32_16x16x32_bf16 v[212:215], a[100:103], a[28:31], v[212:215]
ds_read_b128 a[136:139], v5 offset:12288
v_add_f32 v109, v109, v113
v_mfma_f32_16x16x32_bf16 v[212:215], a[96:99], a[24:27], v[212:215]
v_add_f32 v117, v117, v121
v_add_f32 v94, v94, v98
v_mfma_f32_16x16x32_bf16 v[216:219], a[104:107], a[24:27], v[216:219]
ds_read_b128 a[140:143], v5 offset:18432
v_add_f32 v102, v102, v106
v_mfma_f32_16x16x32_bf16 v[216:219], a[108:111], a[28:31], v[216:219]
v_add_f32 v110, v110, v114
v_mfma_f32_16x16x32_bf16 v[192:195], a[108:111], a[20:23], v[192:195]
buffer_load_dwordx4 v1, s[4:7], s44 offen offset:1024 sc1 lds
s_add_u32 m0, s18, 0x6000
v_mfma_f32_16x16x32_bf16 v[192:195], a[104:107], a[16:19], v[192:195]
s_add_u32 s44, s50, 0x282a000
ds_read_b128 a[144:147], v5 offset:13312
v_mfma_f32_16x16x32_bf16 v[168:171], a[104:107], a[8:11], v[168:171]
v_add_f32 v118, v118, v122
L_stub16:
s_cbranch_execz L_wret6
v_add_f32 v95, v95, v99
v_mfma_f32_16x16x32_bf16 v[168:171], a[108:111], a[12:15], v[168:171]
ds_read_b128 a[148:151], v5 offset:19456
v_add_f32 v103, v103, v107
v_mfma_f32_16x16x32_bf16 v[144:147], a[108:111], a[4:7], v[144:147]
v_add_f32 v111, v111, v115
v_add_f32 v119, v119, v123
v_mfma_f32_16x16x32_bf16 v[144:147], a[104:107], a[0:3], v[144:147]
buffer_load_dwordx4 a[72:75], v2, s[40:43], s35 offen offset:1024 sc1
v_mfma_f32_16x16x32_bf16 v[148:151], a[112:115], a[0:3], v[148:151]
v_add_f32_dpp v92, v92, v92 row_ror:8 row_mask:0xf bank_mask:0xf
v_add_f32_dpp v100, v100, v100 row_ror:8 row_mask:0xf bank_mask:0xf
v_mfma_f32_16x16x32_bf16 v[148:151], a[116:119], a[4:7], v[148:151]
v_add_f32_dpp v108, v108, v108 row_ror:8 row_mask:0xf bank_mask:0xf
v_mfma_f32_16x16x32_bf16 v[172:175], a[116:119], a[12:15], v[172:175]
v_add_f32_dpp v116, v116, v116 row_ror:8 row_mask:0xf bank_mask:0xf
v_mfma_f32_16x16x32_bf16 v[172:175], a[112:115], a[8:11], v[172:175]
v_add_f32_dpp v93, v93, v93 row_ror:8 row_mask:0xf bank_mask:0xf
v_mfma_f32_16x16x32_bf16 v[196:199], a[112:115], a[16:19], v[196:199]
buffer_load_dwordx4 a[76:79], v2, s[40:43], s33 offen offset:1024 sc1
v_mfma_f32_16x16x32_bf16 v[196:199], a[116:119], a[20:23], v[196:199]
v_add_f32_dpp v101, v101, v101 row_ror:8 row_mask:0xf bank_mask:0xf
v_add_f32_dpp v109, v109, v109 row_ror:8 row_mask:0xf bank_mask:0xf
v_mfma_f32_16x16x32_bf16 v[220:223], a[116:119], a[28:31], v[220:223]
v_add_f32_dpp v117, v117, v117 row_ror:8 row_mask:0xf bank_mask:0xf
v_mfma_f32_16x16x32_bf16 v[220:223], a[112:115], a[24:27], v[220:223]
v_add_f32_dpp v92, v94, v94 row_ror:8 row_mask:0xf bank_mask:0xc
s_waitcnt lgkmcnt(0)
v_mfma_f32_16x16x32_bf16 v[224:227], a[128:131], a[24:27], v[224:227]
ds_read_b128 a[96:99], v5 offset:26624
v_add_f32_dpp v100, v102, v102 row_ror:8 row_mask:0xf bank_mask:0xc
v_mfma_f32_16x16x32_bf16 v[224:227], a[132:135], a[28:31], v[224:227]
buffer_load_dwordx4 a[80:83], v2, s[40:43], s35 offen offset:2048 sc1
v_mfma_f32_16x16x32_bf16 v[200:203], a[132:135], a[20:23], v[200:203]
ds_read_b128 a[100:103], v5 offset:32768
v_add_f32_dpp v108, v110, v110 row_ror:8 row_mask:0xf bank_mask:0xc
v_mfma_f32_16x16x32_bf16 v[200:203], a[128:131], a[16:19], v[200:203]
v_add_f32_dpp v116, v118, v118 row_ror:8 row_mask:0xf bank_mask:0xc
v_add_f32_dpp v93, v95, v95 row_ror:8 row_mask:0xf bank_mask:0xc
v_mfma_f32_16x16x32_bf16 v[176:179], a[128:131], a[8:11], v[176:179]
v_add_f32_dpp v101, v103, v103 row_ror:8 row_mask:0xf bank_mask:0xc
v_add_f32_dpp v109, v111, v111 row_ror:8 row_mask:0xf bank_mask:0xc
v_mfma_f32_16x16x32_bf16 v[176:179], a[132:135], a[12:15], v[176:179]
buffer_load_dwordx4 v1, s[4:7], s44 offen offset:0 sc1 lds
v_mfma_f32_16x16x32_bf16 v[152:155], a[132:135], a[4:7], v[152:155]
ds_read_b128 a[104:107], v5 offset:27648
v_add_f32_dpp v117, v119, v119 row_ror:8 row_mask:0xf bank_mask:0xc
v_mfma_f32_16x16x32_bf16 v[152:155], a[128:131], a[0:3], v[152:155]
v_permlane32_swap_b32 v92, v93
v_mfma_f32_16x16x32_bf16 v[132:135], a[136:139], a[0:3], v[132:135]
ds_read_b128 a[108:111], v5 offset:33792
v_mfma_f32_16x16x32_bf16 v[132:135], a[140:143], a[4:7], v[132:135]
buffer_load_dwordx4 a[84:87], v2, s[40:43], s33 offen offset:2048 sc1
v_mfma_f32_16x16x32_bf16 v[156:159], a[140:143], a[12:15], v[156:159]
ds_read_b128 a[112:115], v5 offset:28672
v_mfma_f32_16x16x32_bf16 v[156:159], a[136:139], a[8:11], v[156:159]
v_permlane32_swap_b32 v100, v101
v_mfma_f32_16x16x32_bf16 v[180:183], a[136:139], a[16:19], v[180:183]
v_permlane32_swap_b32 v108, v109
v_mfma_f32_16x16x32_bf16 v[180:183], a[140:143], a[20:23], v[180:183]
buffer_load_dwordx4 a[88:91], v2, s[40:43], s35 offen offset:3072 sc1
v_mfma_f32_16x16x32_bf16 v[204:207], a[140:143], a[28:31], v[204:207]
ds_read_b128 a[116:119], v5 offset:34816
v_mfma_f32_16x16x32_bf16 v[204:207], a[136:139], a[24:27], v[204:207]
v_permlane32_swap_b32 v116, v117
v_mfma_f32_16x16x32_bf16 v[208:211], a[144:147], a[24:27], v[208:211]
v_add_f32 v92, v92, v93
v_add_f32 v100, v100, v101
v_mfma_f32_16x16x32_bf16 v[208:211], a[148:151], a[28:31], v[208:211]
buffer_load_dwordx4 v1, s[4:7], s44 offen offset:1024 sc1 lds
s_add_u32 m0, s18, 0x8000
v_mfma_f32_16x16x32_bf16 v[184:187], a[148:151], a[20:23], v[184:187]
s_add_u32 s44, s50, 0x282c000
v_add_f32 v108, v108, v109
v_mfma_f32_16x16x32_bf16 v[184:187], a[144:147], a[16:19], v[184:187]
v_add_f32 v116, v116, v117
v_mov_b32 v94, v92
v_mfma_f32_16x16x32_bf16 v[160:163], a[144:147], a[8:11], v[160:163]
v_mov_b32 v102, v100
v_mov_b32 v110, v108
v_mfma_f32_16x16x32_bf16 v[160:163], a[148:151], a[12:15], v[160:163]
buffer_load_dwordx4 a[92:95], v2, s[40:43], s33 offen offset:3072 sc1
s_add_u32 s35, s35, 0x4000
v_mfma_f32_16x16x32_bf16 v[136:139], a[148:151], a[4:7], v[136:139]
s_add_u32 s33, s33, 0x4000
v_mov_b32 v118, v116
v_mfma_f32_16x16x32_bf16 v[136:139], a[144:147], a[0:3], v[136:139]
s_waitcnt vmcnt(11) lgkmcnt(0)
v_mfma_f32_16x16x32_bf16 v[140:143], a[96:99], a[32:35], v[140:143]
ds_read_b128 a[128:131], v5 offset:29696
v_mfma_f32_16x16x32_bf16 v[140:143], a[100:103], a[36:39], v[140:143]
buffer_load_dwordx4 a[0:3], v2, s[40:43], s35 offen offset:0 sc1
v_mfma_f32_16x16x32_bf16 v[164:167], a[100:103], a[44:47], v[164:167]
ds_read_b128 a[132:135], v5 offset:35840
v_mfma_f32_16x16x32_bf16 v[164:167], a[96:99], a[40:43], v[164:167]
v_permlane16_swap_b32 v92, v94
v_mfma_f32_16x16x32_bf16 v[188:191], a[96:99], a[48:51], v[188:191]
v_permlane16_swap_b32 v100, v102
v_mfma_f32_16x16x32_bf16 v[188:191], a[100:103], a[52:55], v[188:191]
buffer_load_dwordx4 a[4:7], v2, s[40:43], s33 offen offset:0 sc1
v_mfma_f32_16x16x32_bf16 v[212:215], a[100:103], a[60:63], v[212:215]
ds_read_b128 a[136:139], v5 offset:24576
v_mfma_f32_16x16x32_bf16 v[212:215], a[96:99], a[56:59], v[212:215]
v_permlane16_swap_b32 v108, v110
v_mfma_f32_16x16x32_bf16 v[216:219], a[104:107], a[56:59], v[216:219]
ds_read_b128 a[140:143], v5 offset:30720
v_mfma_f32_16x16x32_bf16 v[216:219], a[108:111], a[60:63], v[216:219]
v_permlane16_swap_b32 v116, v118
v_mfma_f32_16x16x32_bf16 v[192:195], a[108:111], a[52:55], v[192:195]
buffer_load_dwordx4 v1, s[4:7], s44 offen offset:0 sc1 lds
v_mfma_f32_16x16x32_bf16 v[192:195], a[104:107], a[48:51], v[192:195]
ds_read_b128 a[144:147], v5 offset:25600
v_add_f32 v92, v92, v94
v_mfma_f32_16x16x32_bf16 v[168:171], a[104:107], a[40:43], v[168:171]
v_add_f32 v100, v100, v102
v_add_f32 v108, v108, v110
v_mfma_f32_16x16x32_bf16 v[168:171], a[108:111], a[44:47], v[168:171]
ds_read_b128 a[148:151], v5 offset:31744
v_add_f32 v116, v116, v118
v_mfma_f32_16x16x32_bf16 v[144:147], a[108:111], a[36:39], v[144:147]
v_mov_b32 v94, v92
v_mov_b32 v102, v100
v_mfma_f32_16x16x32_bf16 v[144:147], a[104:107], a[32:35], v[144:147]
buffer_load_dwordx4 a[8:11], v2, s[40:43], s35 offen offset:1024 sc1
v_mfma_f32_16x16x32_bf16 v[148:151], a[112:115], a[32:35], v[148:151]
v_mov_b32 v110, v108
v_mov_b32 v118, v116
v_mfma_f32_16x16x32_bf16 v[148:151], a[116:119], a[36:39], v[148:151]
v_permlane32_swap_b32 v92, v94
v_mfma_f32_16x16x32_bf16 v[172:175], a[116:119], a[44:47], v[172:175]
v_permlane32_swap_b32 v100, v102
v_mfma_f32_16x16x32_bf16 v[172:175], a[112:115], a[40:43], v[172:175]
v_permlane32_swap_b32 v108, v110
v_mfma_f32_16x16x32_bf16 v[196:199], a[112:115], a[48:51], v[196:199]
buffer_load_dwordx4 a[12:15], v2, s[40:43], s33 offen offset:1024 sc1
v_mfma_f32_16x16x32_bf16 v[196:199], a[116:119], a[52:55], v[196:199]
v_permlane32_swap_b32 v116, v118
v_mfma_f32_16x16x32_bf16 v[220:223], a[116:119], a[60:63], v[220:223]
v_mul_f32 v82, 0xba800000, v92
v_mul_f32 v84, 0xba800000, v100
v_mfma_f32_16x16x32_bf16 v[220:223], a[112:115], a[56:59], v[220:223]
v_mul_f32 v86, 0xba800000, v108
s_waitcnt lgkmcnt(0)
v_mfma_f32_16x16x32_bf16 v[224:227], a[128:131], a[56:59], v[224:227]
ds_read_b128 a[96:99], v5 offset:38912
v_mul_f32 v88, 0xba800000, v116
v_mfma_f32_16x16x32_bf16 v[224:227], a[132:135], a[60:63], v[224:227]
buffer_load_dwordx4 a[16:19], v2, s[40:43], s35 offen offset:2048 sc1
v_mfma_f32_16x16x32_bf16 v[200:203], a[132:135], a[52:55], v[200:203]
ds_read_b128 a[100:103], v5 offset:45056
v_mul_f32 v94, 0x3a800000, v94
v_mfma_f32_16x16x32_bf16 v[200:203], a[128:131], a[48:51], v[200:203]
v_mul_f32 v102, 0x3a800000, v102
v_mul_f32 v110, 0x3a800000, v110
v_mfma_f32_16x16x32_bf16 v[176:179], a[128:131], a[40:43], v[176:179]
v_mul_f32 v118, 0x3a800000, v118
v_fma_f32 v94, -v82, v82, v94
v_mfma_f32_16x16x32_bf16 v[176:179], a[132:135], a[44:47], v[176:179]
buffer_load_dwordx4 a[20:23], v2, s[40:43], s33 offen offset:2048 sc1
v_mfma_f32_16x16x32_bf16 v[152:155], a[132:135], a[36:39], v[152:155]
ds_read_b128 a[104:107], v5 offset:39936
v_fma_f32 v102, -v84, v84, v102
v_mfma_f32_16x16x32_bf16 v[152:155], a[128:131], a[32:35], v[152:155]
v_fma_f32 v110, -v86, v86, v110
v_fma_f32 v118, -v88, v88, v118
v_mfma_f32_16x16x32_bf16 v[132:135], a[136:139], a[32:35], v[132:135]
ds_read_b128 a[108:111], v5 offset:46080
v_max_f32 v94, 0, v94
v_mfma_f32_16x16x32_bf16 v[132:135], a[140:143], a[36:39], v[132:135]
v_max_f32 v102, 0, v102
v_mfma_f32_16x16x32_bf16 v[156:159], a[140:143], a[44:47], v[156:159]
buffer_load_dwordx4 v1, s[4:7], s44 offen offset:1024 sc1 lds
s_add_u32 m0, s18, 0xa000
v_mfma_f32_16x16x32_bf16 v[156:159], a[136:139], a[40:43], v[156:159]
s_add_u32 s44, s50, 0x282e000
ds_read_b128 a[112:115], v5 offset:40960
v_mfma_f32_16x16x32_bf16 v[180:183], a[136:139], a[48:51], v[180:183]
v_max_f32 v110, 0, v110
v_max_f32 v118, 0, v118
v_mfma_f32_16x16x32_bf16 v[180:183], a[140:143], a[52:55], v[180:183]
ds_read_b128 a[116:119], v5 offset:47104
v_add_f32 v94, 0x3727c5ac, v94
v_mfma_f32_16x16x32_bf16 v[204:207], a[140:143], a[60:63], v[204:207]
v_add_f32 v102, 0x3727c5ac, v102
v_add_f32 v110, 0x3727c5ac, v110
v_mfma_f32_16x16x32_bf16 v[204:207], a[136:139], a[56:59], v[204:207]
buffer_load_dwordx4 a[24:27], v2, s[40:43], s35 offen offset:3072 sc1
v_mfma_f32_16x16x32_bf16 v[208:211], a[144:147], a[56:59], v[208:211]
v_add_f32 v118, 0x3727c5ac, v118
v_mfma_f32_16x16x32_bf16 v[208:211], a[148:151], a[60:63], v[208:211]
v_rsq_f32 v83, v94
v_mfma_f32_16x16x32_bf16 v[184:187], a[148:151], a[52:55], v[184:187]
v_rsq_f32 v85, v102
v_mfma_f32_16x16x32_bf16 v[184:187], a[144:147], a[48:51], v[184:187]
v_mfma_f32_16x16x32_bf16 v[160:163], a[144:147], a[40:43], v[160:163]
buffer_load_dwordx4 a[28:31], v2, s[40:43], s33 offen offset:3072 sc1
s_add_u32 s35, s35, 0x4000
v_mfma_f32_16x16x32_bf16 v[160:163], a[148:151], a[44:47], v[160:163]
s_add_u32 s33, s33, 0x4000
v_mfma_f32_16x16x32_bf16 v[136:139], a[148:151], a[36:39], v[136:139]
v_rsq_f32 v87, v110
v_mfma_f32_16x16x32_bf16 v[136:139], a[144:147], a[32:35], v[136:139]
s_waitcnt vmcnt(10) lgkmcnt(0)
v_mfma_f32_16x16x32_bf16 v[140:143], a[96:99], a[64:67], v[140:143]
ds_read_b128 a[128:131], v5 offset:41984
v_mfma_f32_16x16x32_bf16 v[140:143], a[100:103], a[68:71], v[140:143]
buffer_load_dwordx4 a[32:35], v2, s[40:43], s35 offen offset:0 sc1
v_mfma_f32_16x16x32_bf16 v[164:167], a[100:103], a[76:79], v[164:167]
ds_read_b128 a[132:135], v5 offset:48128
v_mfma_f32_16x16x32_bf16 v[164:167], a[96:99], a[72:75], v[164:167]
v_rsq_f32 v89, v118
v_mfma_f32_16x16x32_bf16 v[188:191], a[96:99], a[80:83], v[188:191]
v_mfma_f32_16x16x32_bf16 v[188:191], a[100:103], a[84:87], v[188:191]
buffer_load_dwordx4 a[36:39], v2, s[40:43], s33 offen offset:0 sc1
v_mfma_f32_16x16x32_bf16 v[212:215], a[100:103], a[92:95], v[212:215]
ds_read_b128 a[136:139], v5 offset:36864
v_mfma_f32_16x16x32_bf16 v[212:215], a[96:99], a[88:91], v[212:215]
v_mfma_f32_16x16x32_bf16 v[216:219], a[104:107], a[88:91], v[216:219]
ds_read_b128 a[140:143], v5 offset:43008
v_mfma_f32_16x16x32_bf16 v[216:219], a[108:111], a[92:95], v[216:219]
v_mfma_f32_16x16x32_bf16 v[192:195], a[108:111], a[84:87], v[192:195]
buffer_load_dwordx4 v1, s[4:7], s44 offen offset:0 sc1 lds
v_mfma_f32_16x16x32_bf16 v[192:195], a[104:107], a[80:83], v[192:195]
ds_read_b128 a[144:147], v5 offset:37888
v_fmac_f32 v140, v56, v82
v_mfma_f32_16x16x32_bf16 v[168:171], a[104:107], a[72:75], v[168:171]
v_fmac_f32 v164, v56, v84
v_mfma_f32_16x16x32_bf16 v[168:171], a[108:111], a[76:79], v[168:171]
ds_read_b128 a[148:151], v5 offset:44032
v_mfma_f32_16x16x32_bf16 v[144:147], a[108:111], a[68:71], v[144:147]
v_fmac_f32 v188, v56, v86
v_mfma_f32_16x16x32_bf16 v[144:147], a[104:107], a[64:67], v[144:147]
buffer_load_dwordx4 a[40:43], v2, s[40:43], s35 offen offset:1024 sc1
v_mfma_f32_16x16x32_bf16 v[148:151], a[112:115], a[64:67], v[148:151]
v_fmac_f32 v212, v56, v88
v_mfma_f32_16x16x32_bf16 v[148:151], a[116:119], a[68:71], v[148:151]
v_mfma_f32_16x16x32_bf16 v[172:175], a[116:119], a[76:79], v[172:175]
v_fmac_f32 v216, v60, v88
v_mfma_f32_16x16x32_bf16 v[172:175], a[112:115], a[72:75], v[172:175]
v_mfma_f32_16x16x32_bf16 v[196:199], a[112:115], a[80:83], v[196:199]
buffer_load_dwordx4 a[44:47], v2, s[40:43], s33 offen offset:1024 sc1
v_mfma_f32_16x16x32_bf16 v[196:199], a[116:119], a[84:87], v[196:199]
v_fmac_f32 v192, v60, v86
v_mfma_f32_16x16x32_bf16 v[220:223], a[116:119], a[92:95], v[220:223]
v_fmac_f32 v168, v60, v84
v_fmac_f32 v141, v57, v82
v_mfma_f32_16x16x32_bf16 v[220:223], a[112:115], a[88:91], v[220:223]
s_waitcnt lgkmcnt(0)
s_barrier
v_mfma_f32_16x16x32_bf16 v[224:227], a[128:131], a[88:91], v[224:227]
v_add_u32 v5, 0, v1
v_fmac_f32 v144, v60, v82
v_mfma_f32_16x16x32_bf16 v[224:227], a[132:135], a[92:95], v[224:227]
buffer_load_dwordx4 a[48:51], v2, s[40:43], s35 offen offset:2048 sc1
v_mfma_f32_16x16x32_bf16 v[200:203], a[132:135], a[84:87], v[200:203]
ds_read_b128 a[96:99], v5 offset:2048
v_fmac_f32 v148, v64, v82
v_mfma_f32_16x16x32_bf16 v[200:203], a[128:131], a[80:83], v[200:203]
ds_read_b128 a[100:103], v5 offset:8192
v_fmac_f32 v165, v57, v84
v_mfma_f32_16x16x32_bf16 v[176:179], a[128:131], a[72:75], v[176:179]
v_fmac_f32 v172, v64, v84
v_fmac_f32 v189, v57, v86
v_mfma_f32_16x16x32_bf16 v[176:179], a[132:135], a[76:79], v[176:179]
buffer_load_dwordx4 a[52:55], v2, s[40:43], s33 offen offset:2048 sc1
v_mfma_f32_16x16x32_bf16 v[152:155], a[132:135], a[68:71], v[152:155]
ds_read_b128 a[104:107], v5 offset:3072
v_fmac_f32 v196, v64, v86
v_mfma_f32_16x16x32_bf16 v[152:155], a[128:131], a[64:67], v[152:155]
v_fmac_f32 v213, v57, v88
v_fmac_f32 v217, v61, v88
v_mfma_f32_16x16x32_bf16 v[132:135], a[136:139], a[64:67], v[132:135]
ds_read_b128 a[108:111], v5 offset:9216
v_fmac_f32 v220, v64, v88
v_mfma_f32_16x16x32_bf16 v[132:135], a[140:143], a[68:71], v[132:135]
v_fmac_f32 v193, v61, v86
v_mfma_f32_16x16x32_bf16 v[156:159], a[140:143], a[76:79], v[156:159]
buffer_load_dwordx4 v1, s[4:7], s44 offen offset:1024 sc1 lds
s_add_u32 m0, s19, 49152
v_mfma_f32_16x16x32_bf16 v[156:159], a[136:139], a[72:75], v[156:159]
s_xor_b32 s44, s85, 16384
ds_read_b128 a[112:115], v5 offset:4096
v_mfma_f32_16x16x32_bf16 v[180:183], a[136:139], a[80:83], v[180:183]
v_fmac_f32 v224, v68, v88
v_fmac_f32 v200, v68, v86
v_mfma_f32_16x16x32_bf16 v[180:183], a[140:143], a[84:87], v[180:183]
ds_read_b128 a[116:119], v5 offset:10240
v_fmac_f32 v169, v61, v84
v_mfma_f32_16x16x32_bf16 v[204:207], a[140:143], a[92:95], v[204:207]
v_fmac_f32 v176, v68, v84
v_fmac_f32 v145, v61, v82
v_mfma_f32_16x16x32_bf16 v[204:207], a[136:139], a[88:91], v[204:207]
buffer_load_dwordx4 a[56:59], v2, s[40:43], s35 offen offset:3072 sc1
v_mfma_f32_16x16x32_bf16 v[208:211], a[144:147], a[88:91], v[208:211]
v_fmac_f32 v152, v68, v82
v_fmac_f32 v149, v65, v82
v_mfma_f32_16x16x32_bf16 v[208:211], a[148:151], a[92:95], v[208:211]
v_fmac_f32 v173, v65, v84
v_mfma_f32_16x16x32_bf16 v[184:187], a[148:151], a[84:87], v[184:187]
v_fmac_f32 v132, v48, v82
v_fmac_f32 v197, v65, v86
v_mfma_f32_16x16x32_bf16 v[184:187], a[144:147], a[80:83], v[184:187]
v_mfma_f32_16x16x32_bf16 v[160:163], a[144:147], a[72:75], v[160:163]
buffer_load_dwordx4 a[60:63], v2, s[40:43], s33 offen offset:3072 sc1
s_add_u32 s35, s35, 0x4000
v_mfma_f32_16x16x32_bf16 v[160:163], a[148:151], a[76:79], v[160:163]
s_add_u32 s33, s33, 0x4000
v_fmac_f32 v156, v48, v84
v_mfma_f32_16x16x32_bf16 v[136:139], a[148:151], a[68:71], v[136:139]
v_fmac_f32 v180, v48, v86
v_fmac_f32 v221, v65, v88
v_mfma_f32_16x16x32_bf16 v[136:139], a[144:147], a[64:67], v[136:139]
v_fmac_f32 v225, v69, v88
s_waitcnt vmcnt(10) lgkmcnt(0)
v_mfma_f32_16x16x32_bf16 v[140:143], a[96:99], a[0:3], v[140:143]
ds_read_b128 a[128:131], v5 offset:5120
v_fmac_f32 v204, v48, v88
v_mfma_f32_16x16x32_bf16 v[140:143], a[100:103], a[4:7], v[140:143]
buffer_load_dwordx4 a[64:67], v2, s[40:43], s35 offen offset:0 sc1
s_lshl_b32 s36, s28, 9
v_mfma_f32_16x16x32_bf16 v[164:167], a[100:103], a[12:15], v[164:167]
ds_read_b128 a[132:135], v5 offset:11264
v_fmac_f32 v208, v52, v88
v_mfma_f32_16x16x32_bf16 v[164:167], a[96:99], a[8:11], v[164:167]
v_fmac_f32 v201, v69, v86
v_fmac_f32 v177, v69, v84
v_mfma_f32_16x16x32_bf16 v[188:191], a[96:99], a[16:19], v[188:191]
v_fmac_f32 v184, v52, v86
v_fmac_f32 v153, v69, v82
v_mfma_f32_16x16x32_bf16 v[188:191], a[100:103], a[20:23], v[188:191]
buffer_load_dwordx4 a[68:71], v2, s[40:43], s33 offen offset:0 sc1
s_lshl_b32 s37, s30, 2
v_mfma_f32_16x16x32_bf16 v[212:215], a[100:103], a[28:31], v[212:215]
ds_read_b128 a[136:139], v5 offset:0
v_fmac_f32 v160, v52, v84
v_mfma_f32_16x16x32_bf16 v[212:215], a[96:99], a[24:27], v[212:215]
v_fmac_f32 v133, v49, v82
v_add_u32 v232, s19, v7
v_mfma_f32_16x16x32_bf16 v[216:219], a[104:107], a[24:27], v[216:219]
ds_read_b128 a[140:143], v5 offset:6144
v_fmac_f32 v136, v52, v82
v_mfma_f32_16x16x32_bf16 v[216:219], a[108:111], a[28:31], v[216:219]
buffer_load_dwordx4 a[72:75], v2, s[40:43], s35 offen offset:1024 sc1
s_add_u32 s37, s37, s28
v_mfma_f32_16x16x32_bf16 v[192:195], a[108:111], a[20:23], v[192:195]
ds_read_b128 a[144:147], v5 offset:1024
v_fmac_f32 v157, v49, v84
v_mfma_f32_16x16x32_bf16 v[192:195], a[104:107], a[16:19], v[192:195]
v_fmac_f32 v181, v49, v86
v_fmac_f32 v142, v58, v82
v_mfma_f32_16x16x32_bf16 v[168:171], a[104:107], a[8:11], v[168:171]
v_fmac_f32 v205, v49, v88
v_fmac_f32 v166, v58, v84
v_mfma_f32_16x16x32_bf16 v[168:171], a[108:111], a[12:15], v[168:171]
buffer_load_dwordx4 a[76:79], v2, s[40:43], s33 offen offset:1024 sc1
s_lshr_b32 s98, s37, 1
v_mfma_f32_16x16x32_bf16 v[144:147], a[108:111], a[4:7], v[144:147]
ds_read_b128 a[148:151], v5 offset:7168
v_fmac_f32 v209, v53, v88
v_mfma_f32_16x16x32_bf16 v[144:147], a[104:107], a[0:3], v[144:147]
v_fmac_f32 v190, v58, v86
s_lshl_b32 s98, s98, 14
v_mfma_f32_16x16x32_bf16 v[148:151], a[112:115], a[0:3], v[148:151]
v_fmac_f32 v185, v53, v86
v_fmac_f32 v214, v58, v88
v_mfma_f32_16x16x32_bf16 v[148:151], a[116:119], a[4:7], v[148:151]
buffer_load_dwordx4 a[80:83], v2, s[40:43], s35 offen offset:2048 sc1
s_and_b32 s99, s19, 0x1000
v_mfma_f32_16x16x32_bf16 v[172:175], a[116:119], a[12:15], v[172:175]
v_fmac_f32 v161, v53, v84
v_fmac_f32 v218, v62, v88
v_mfma_f32_16x16x32_bf16 v[172:175], a[112:115], a[8:11], v[172:175]
s_add_u32 s98, s98, s99
s_bfe_u32 s90, s51, 0x10005
s_lshl_b32 s90, s90, 13
v_mfma_f32_16x16x32_bf16 v[196:199], a[112:115], a[16:19], v[196:199]
v_fmac_f32 v137, v53, v82
v_fmac_f32 v194, v62, v86
v_mfma_f32_16x16x32_bf16 v[196:199], a[116:119], a[20:23], v[196:199]
buffer_load_dwordx4 a[84:87], v2, s[40:43], s33 offen offset:2048 sc1
s_add_u32 s98, s98, s90
v_mfma_f32_16x16x32_bf16 v[220:223], a[116:119], a[28:31], v[220:223]
v_fmac_f32 v170, v62, v84
v_fmac_f32 v143, v59, v82
v_mfma_f32_16x16x32_bf16 v[220:223], a[112:115], a[24:27], v[220:223]
s_add_u32 s98, s98, 0x1500000
s_waitcnt lgkmcnt(0)
v_mfma_f32_16x16x32_bf16 v[224:227], a[128:131], a[24:27], v[224:227]
ds_read_b128 a[96:99], v5 offset:14336
v_fmac_f32 v146, v62, v82
v_mfma_f32_16x16x32_bf16 v[224:227], a[132:135], a[28:31], v[224:227]
buffer_load_dwordx4 a[88:91], v2, s[40:43], s35 offen offset:3072 sc1
s_xor_b32 s99, s98, 0x2000
v_mfma_f32_16x16x32_bf16 v[200:203], a[132:135], a[20:23], v[200:203]
ds_read_b128 a[100:103], v5 offset:20480
v_fmac_f32 v150, v66, v82
v_mfma_f32_16x16x32_bf16 v[200:203], a[128:131], a[16:19], v[200:203]
v_fmac_f32 v167, v59, v84
v_fmac_f32 v191, v59, v86
v_mfma_f32_16x16x32_bf16 v[176:179], a[128:131], a[8:11], v[176:179]
v_fmac_f32 v174, v66, v84
v_fmac_f32 v215, v59, v88
v_mfma_f32_16x16x32_bf16 v[176:179], a[132:135], a[12:15], v[176:179]
ds_read_b128 a[104:107], v5 offset:15360
s_and_b32 s91, s29, 4
v_mfma_f32_16x16x32_bf16 v[152:155], a[132:135], a[4:7], v[152:155]
v_fmac_f32 v198, v66, v86
v_fmac_f32 v219, v63, v88
v_mfma_f32_16x16x32_bf16 v[152:155], a[128:131], a[0:3], v[152:155]
buffer_load_dwordx4 v1, s[4:7], s44 offen offset:0 sc1 lds
s_lshl_b32 s91, s91, 11
v_mfma_f32_16x16x32_bf16 v[132:135], a[136:139], a[0:3], v[132:135]
ds_read_b128 a[108:111], v5 offset:21504
v_fmac_f32 v222, v66, v88
v_mfma_f32_16x16x32_bf16 v[132:135], a[140:143], a[4:7], v[132:135]
v_fmac_f32 v195, v63, v86
s_xor_b32 s96, s98, s91
v_mfma_f32_16x16x32_bf16 v[156:159], a[140:143], a[12:15], v[156:159]
ds_read_b128 a[112:115], v5 offset:16384
v_fmac_f32 v226, v70, v88
v_mfma_f32_16x16x32_bf16 v[156:159], a[136:139], a[8:11], v[156:159]
v_fmac_f32 v171, v63, v84
s_lshl_b32 s97, s81, 10
v_mfma_f32_16x16x32_bf16 v[180:183], a[136:139], a[16:19], v[180:183]
v_fmac_f32 v202, v70, v86
v_fmac_f32 v147, v63, v82
v_mfma_f32_16x16x32_bf16 v[180:183], a[140:143], a[20:23], v[180:183]
buffer_load_dwordx4 a[92:95], v2, s[40:43], s33 offen offset:3072 sc1
s_add_u32 s35, s35, 0x4000
v_mfma_f32_16x16x32_bf16 v[204:207], a[140:143], a[28:31], v[204:207]
s_add_u32 s33, s33, 0x4000
ds_read_b128 a[116:119], v5 offset:22528
v_mfma_f32_16x16x32_bf16 v[204:207], a[136:139], a[24:27], v[204:207]
v_fmac_f32 v178, v70, v84
v_fmac_f32 v151, v67, v82
v_mfma_f32_16x16x32_bf16 v[208:211], a[144:147], a[24:27], v[208:211]
v_fmac_f32 v154, v70, v82
v_fmac_f32 v175, v67, v84
v_mfma_f32_16x16x32_bf16 v[208:211], a[148:151], a[28:31], v[208:211]
s_add_u32 s96, s96, s97
s_lshr_b32 s100, s37, 4
s_lshl_b32 s100, s100, 14
v_mfma_f32_16x16x32_bf16 v[184:187], a[148:151], a[20:23], v[184:187]
v_fmac_f32 v134, v50, v82
v_fmac_f32 v199, v67, v86
v_mfma_f32_16x16x32_bf16 v[184:187], a[144:147], a[16:19], v[184:187]
buffer_load_dwordx4 v1, s[4:7], s44 offen offset:1024 sc1 lds
s_and_b32 s37, s37, 15
v_mfma_f32_16x16x32_bf16 v[160:163], a[144:147], a[8:11], v[160:163]
v_fmac_f32 v158, v50, v84
v_fmac_f32 v223, v67, v88
v_mfma_f32_16x16x32_bf16 v[160:163], a[148:151], a[12:15], v[160:163]
s_lshl_b32 s37, s37, 9
s_add_u32 s100, s100, s37
s_add_u32 s100, s100, 0x260000
v_mfma_f32_16x16x32_bf16 v[136:139], a[148:151], a[4:7], v[136:139]
v_fmac_f32 v182, v50, v86
v_fmac_f32 v227, v71, v88
v_mfma_f32_16x16x32_bf16 v[136:139], a[144:147], a[0:3], v[136:139]
s_waitcnt vmcnt(10) lgkmcnt(0)
s_barrier
v_mfma_f32_16x16x32_bf16 v[140:143], a[96:99], a[32:35], v[140:143]
ds_read_b128 a[128:131], v5 offset:17408
v_fmac_f32 v206, v50, v88
v_mfma_f32_16x16x32_bf16 v[140:143], a[100:103], a[36:39], v[140:143]
buffer_load_dwordx4 a[0:3], v2, s[40:43], s35 offen offset:0 sc1
s_xor_b32 s90, s91, s79
v_mfma_f32_16x16x32_bf16 v[164:167], a[100:103], a[44:47], v[164:167]
ds_read_b128 a[132:135], v5 offset:23552
v_fmac_f32 v210, v54, v88
v_mfma_f32_16x16x32_bf16 v[164:167], a[96:99], a[40:43], v[164:167]
v_fmac_f32 v203, v71, v86
v_fmac_f32 v179, v71, v84
v_mfma_f32_16x16x32_bf16 v[188:191], a[96:99], a[48:51], v[188:191]
buffer_load_dwordx4 a[4:7], v2, s[40:43], s33 offen offset:0 sc1
s_lshl_b32 s97, s81, 7
v_mfma_f32_16x16x32_bf16 v[188:191], a[100:103], a[52:55], v[188:191]
ds_read_b128 a[136:139], v5 offset:26624
v_fmac_f32 v186, v54, v86
v_mfma_f32_16x16x32_bf16 v[212:215], a[100:103], a[60:63], v[212:215]
v_fmac_f32 v162, v54, v84
v_fmac_f32 v155, v71, v82
v_mfma_f32_16x16x32_bf16 v[212:215], a[96:99], a[56:59], v[212:215]
buffer_load_dwordx4 a[8:11], v2, s[40:43], s35 offen offset:1024 sc1
s_add_u32 s97, s97, s79
v_mfma_f32_16x16x32_bf16 v[216:219], a[104:107], a[56:59], v[216:219]
ds_read_b128 a[140:143], v5 offset:32768
v_fmac_f32 v138, v54, v82
v_mfma_f32_16x16x32_bf16 v[216:219], a[108:111], a[60:63], v[216:219]
v_fmac_f32 v135, v51, v82
v_fmac_f32 v159, v51, v84
v_mfma_f32_16x16x32_bf16 v[192:195], a[108:111], a[52:55], v[192:195]
buffer_load_dwordx4 a[12:15], v2, s[40:43], s33 offen offset:1024 sc1
s_add_u32 s97, s97, s100
v_mfma_f32_16x16x32_bf16 v[192:195], a[104:107], a[48:51], v[192:195]
ds_read_b128 a[144:147], v5 offset:27648
v_fmac_f32 v183, v51, v86
v_mfma_f32_16x16x32_bf16 v[168:171], a[104:107], a[40:43], v[168:171]
v_fmac_f32 v207, v51, v88
s_lshr_b32 s37, s30, 2
v_mfma_f32_16x16x32_bf16 v[168:171], a[108:111], a[44:47], v[168:171]
buffer_load_dwordx4 a[16:19], v2, s[40:43], s35 offen offset:2048 sc1
s_xor_b32 s37, s37, s51
v_mfma_f32_16x16x32_bf16 v[144:147], a[108:111], a[36:39], v[144:147]
ds_read_b128 a[148:151], v5 offset:33792
v_fmac_f32 v211, v55, v88
v_mfma_f32_16x16x32_bf16 v[144:147], a[104:107], a[32:35], v[144:147]
v_mul_f32 v88, 0x3fb8aa3b, v89
s_and_b32 s37, s37, 1
v_mfma_f32_16x16x32_bf16 v[148:151], a[112:115], a[32:35], v[148:151]
buffer_load_dwordx4 a[20:23], v2, s[40:43], s33 offen offset:2048 sc1
s_lshr_b32 s89, s29, 2
v_mfma_f32_16x16x32_bf16 v[148:151], a[116:119], a[36:39], v[148:151]
v_fmac_f32 v187, v55, v86
s_xor_b32 s89, s89, s37
v_mfma_f32_16x16x32_bf16 v[172:175], a[116:119], a[44:47], v[172:175]
v_fmac_f32 v163, v55, v84
v_mul_f32 v86, 0x3fb8aa3b, v87
v_mfma_f32_16x16x32_bf16 v[172:175], a[112:115], a[40:43], v[172:175]
buffer_load_dwordx4 a[24:27], v2, s[40:43], s35 offen offset:3072 sc1
s_lshl_b32 s88, s28, 6
v_mfma_f32_16x16x32_bf16 v[196:199], a[112:115], a[48:51], v[196:199]
v_fmac_f32 v139, v55, v82
v_mul_f32 v84, 0x3fb8aa3b, v85
v_mfma_f32_16x16x32_bf16 v[196:199], a[116:119], a[52:55], v[196:199]
v_mul_f32 v82, 0x3fb8aa3b, v83
s_add_u32 s94, s80, s88
v_mfma_f32_16x16x32_bf16 v[220:223], a[116:119], a[60:63], v[220:223]
buffer_load_dwordx4 a[28:31], v2, s[40:43], s33 offen offset:3072 sc1
s_add_u32 s35, s35, 0x64000
v_mfma_f32_16x16x32_bf16 v[220:223], a[112:115], a[56:59], v[220:223]
s_add_u32 s33, s33, 0x64000
s_waitcnt lgkmcnt(0)
v_mfma_f32_16x16x32_bf16 v[224:227], a[128:131], a[56:59], v[224:227]
ds_read_b128 a[96:99], v5 offset:28672
s_add_u32 s94, s94, 0x90000
v_mfma_f32_16x16x32_bf16 v[224:227], a[132:135], a[60:63], v[224:227]
buffer_load_dwordx4 v1, s[4:7], s44 offen offset:2048 sc1 lds
s_mul_i32 s89, s89, 0x102000
v_mfma_f32_16x16x32_bf16 v[200:203], a[132:135], a[52:55], v[200:203]
ds_read_b128 a[100:103], v5 offset:34816
s_add_u32 s88, s88, s70
v_mfma_f32_16x16x32_bf16 v[200:203], a[128:131], a[48:51], v[200:203]
s_add_u32 s88, s88, s89
s_add_u32 s89, s88, 0x90000
s_add_u32 s74, s71, 0x30080
v_mfma_f32_16x16x32_bf16 v[176:179], a[128:131], a[40:43], v[176:179]
v_add_u32 v233, s19, v232
s_add_u32 s72, s76, 0xc00000
v_mfma_f32_16x16x32_bf16 v[176:179], a[132:135], a[44:47], v[176:179]
ds_read_b128 a[104:107], v5 offset:29696
s_add_u32 s73, s75, 0x800000
v_mfma_f32_16x16x32_bf16 v[152:155], a[132:135], a[36:39], v[152:155]
s_lshr_b32 s38, s28, 1
s_and_b32 s39, s28, 1
s_mul_i32 s38, s38, 3072
v_mfma_f32_16x16x32_bf16 v[152:155], a[128:131], a[32:35], v[152:155]
s_lshl_b32 s39, s39, 3
s_add_u32 s38, s38, s39
s_waitcnt vmcnt(18)
v_mfma_f32_16x16x32_bf16 v[140:143], a[136:139], a[64:67], v[140:143]
ds_read_b128 a[108:111], v5 offset:35840
v_and_b32 v248, 4, v0
s_waitcnt vmcnt(17)
v_mfma_f32_16x16x32_bf16 v[140:143], a[140:143], a[68:71], v[140:143]
v_lshlrev_b32 v248, 11, v248
v_bfe_u32 v235, v0, 2, 1
s_waitcnt vmcnt(15)
v_mfma_f32_16x16x32_bf16 v[164:167], a[140:143], a[76:79], v[164:167]
ds_read_b128 a[112:115], v5 offset:38912
v_xor_b32 v248, s90, v248
v_mfma_f32_16x16x32_bf16 v[164:167], a[136:139], a[72:75], v[164:167]
v_and_b32 v249, 3, v0
v_xor_b32 v235, s37, v235
s_waitcnt vmcnt(14)
v_mfma_f32_16x16x32_bf16 v[188:191], a[136:139], a[80:83], v[188:191]
v_lshl_add_u32 v248, v249, 7, v248
v_mul_u32_u24 v235, 4128, v235
s_waitcnt vmcnt(13)
v_mfma_f32_16x16x32_bf16 v[188:191], a[140:143], a[84:87], v[188:191]
buffer_load_dwordx4 v1, s[4:7], s44 offen offset:3072 sc1 lds
s_add_u32 m0, s19, 65536
s_waitcnt vmcnt(11)
v_mfma_f32_16x16x32_bf16 v[212:215], a[140:143], a[92:95], v[212:215]
s_xor_b32 s44, s85, 32768
ds_read_b128 a[116:119], v5 offset:45056
v_mfma_f32_16x16x32_bf16 v[212:215], a[136:139], a[88:91], v[212:215]
v_lshrrev_b32 v249, 4, v0
v_add_lshl_u32 v235, v235, v0, 8
v_mfma_f32_16x16x32_bf16 v[216:219], a[144:147], a[88:91], v[216:219]
v_lshl_add_u32 v248, v249, 4, v248
v_add_u32 v234, s36, v8
v_mfma_f32_16x16x32_bf16 v[216:219], a[148:151], a[92:95], v[216:219]
v_cndmask_b32 v235, 2.0, v235, s[64:65]
v_mov_b32 v249, 0x3f80
v_mfma_f32_16x16x32_bf16 v[192:195], a[148:151], a[84:87], v[192:195]
v_mov_b32 v250, 1.0
v_add_u32 v252, s38, v1
v_mfma_f32_16x16x32_bf16 v[192:195], a[144:147], a[80:83], v[192:195]
v_mfma_f32_16x16x32_bf16 v[168:171], a[144:147], a[72:75], v[168:171]
v_mfma_f32_16x16x32_bf16 v[168:171], a[148:151], a[76:79], v[168:171]
v_mfma_f32_16x16x32_bf16 v[144:147], a[148:151], a[68:71], v[144:147]
v_mfma_f32_16x16x32_bf16 v[144:147], a[144:147], a[64:67], v[144:147]
s_waitcnt lgkmcnt(0)
v_mfma_f32_16x16x32_bf16 v[148:151], a[96:99], a[64:67], v[148:151]
ds_read_b128 a[128:131], v5 offset:39936
v_mfma_f32_16x16x32_bf16 v[148:151], a[100:103], a[68:71], v[148:151]
buffer_load_dwordx4 v1, s[4:7], s44 offen offset:0 sc1 lds
v_mfma_f32_16x16x32_bf16 v[172:175], a[100:103], a[76:79], v[172:175]
ds_read_b128 a[132:135], v5 offset:46080
v_mfma_f32_16x16x32_bf16 v[172:175], a[96:99], a[72:75], v[172:175]
v_mfma_f32_16x16x32_bf16 v[196:199], a[96:99], a[80:83], v[196:199]
L_stub17:
s_cbranch_execz L_wret5
v_mfma_f32_16x16x32_bf16 v[196:199], a[100:103], a[84:87], v[196:199]
buffer_load_dwordx4 v1, s[4:7], s44 offen offset:1024 sc1 lds
v_mfma_f32_16x16x32_bf16 v[220:223], a[100:103], a[92:95], v[220:223]
ds_read_b128 a[136:139], v5 offset:40960
v_mfma_f32_16x16x32_bf16 v[220:223], a[96:99], a[88:91], v[220:223]
v_mfma_f32_16x16x32_bf16 v[224:227], a[104:107], a[88:91], v[224:227]
ds_read_b128 a[140:143], v5 offset:47104
v_mfma_f32_16x16x32_bf16 v[224:227], a[108:111], a[92:95], v[224:227]
v_mfma_f32_16x16x32_bf16 v[200:203], a[108:111], a[84:87], v[200:203]
buffer_load_dwordx4 v1, s[4:7], s44 offen offset:2048 sc1 lds
v_mfma_f32_16x16x32_bf16 v[200:203], a[104:107], a[80:83], v[200:203]
ds_read_b128 a[144:147], v5 offset:41984
v_mfma_f32_16x16x32_bf16 v[176:179], a[104:107], a[72:75], v[176:179]
v_mfma_f32_16x16x32_bf16 v[176:179], a[108:111], a[76:79], v[176:179]
ds_read_b128 a[148:151], v5 offset:48128
v_mfma_f32_16x16x32_bf16 v[152:155], a[108:111], a[68:71], v[152:155]
v_mfma_f32_16x16x32_bf16 v[152:155], a[104:107], a[64:67], v[152:155]
buffer_load_dwordx4 v1, s[4:7], s44 offen offset:3072 sc1 lds
s_add_u32 m0, s19, 81920
s_waitcnt vmcnt(13)
v_mfma_f32_16x16x32_bf16 v[140:143], a[112:115], a[0:3], v[140:143]
s_xor_b32 s44, s85, 49152
s_waitcnt vmcnt(12)
v_mfma_f32_16x16x32_bf16 v[140:143], a[116:119], a[4:7], v[140:143]
s_waitcnt vmcnt(10)
v_mfma_f32_16x16x32_bf16 v[164:167], a[116:119], a[12:15], v[164:167]
v_mfma_f32_16x16x32_bf16 v[164:167], a[112:115], a[8:11], v[164:167]
s_waitcnt vmcnt(9)
v_mfma_f32_16x16x32_bf16 v[188:191], a[112:115], a[16:19], v[188:191]
buffer_load_dwordx4 v1, s[4:7], s44 offen offset:0 sc1 lds
s_waitcnt vmcnt(9)
v_mfma_f32_16x16x32_bf16 v[188:191], a[116:119], a[20:23], v[188:191]
s_waitcnt vmcnt(7)
v_mfma_f32_16x16x32_bf16 v[212:215], a[116:119], a[28:31], v[212:215]
v_mfma_f32_16x16x32_bf16 v[212:215], a[112:115], a[24:27], v[212:215]
s_waitcnt lgkmcnt(0)
v_mfma_f32_16x16x32_bf16 v[216:219], a[128:131], a[24:27], v[216:219]
ds_read_b128 a[96:99], v5 offset:12288
v_cvt_pk_bf16_f32 v140, v140, v141
v_mfma_f32_16x16x32_bf16 v[216:219], a[132:135], a[28:31], v[216:219]
buffer_load_dwordx4 v1, s[4:7], s44 offen offset:1024 sc1 lds
v_mfma_f32_16x16x32_bf16 v[192:195], a[132:135], a[20:23], v[192:195]
ds_read_b128 a[100:103], v5 offset:18432
v_cvt_pk_bf16_f32 v141, v142, v143
v_mfma_f32_16x16x32_bf16 v[192:195], a[128:131], a[16:19], v[192:195]
v_cvt_pk_bf16_f32 v164, v164, v165
v_cvt_pk_bf16_f32 v165, v166, v167
v_mfma_f32_16x16x32_bf16 v[168:171], a[128:131], a[8:11], v[168:171]
v_cvt_pk_bf16_f32 v188, v188, v189
v_cvt_pk_bf16_f32 v189, v190, v191
v_mfma_f32_16x16x32_bf16 v[168:171], a[132:135], a[12:15], v[168:171]
buffer_load_dwordx4 v1, s[4:7], s44 offen offset:2048 sc1 lds
v_mfma_f32_16x16x32_bf16 v[144:147], a[132:135], a[4:7], v[144:147]
ds_read_b128 a[104:107], v5 offset:24576
v_cvt_pk_bf16_f32 v212, v212, v213
v_mfma_f32_16x16x32_bf16 v[144:147], a[128:131], a[0:3], v[144:147]
v_cvt_pk_bf16_f32 v213, v214, v215
v_mfma_f32_16x16x32_bf16 v[148:151], a[136:139], a[0:3], v[148:151]
ds_read_b128 a[108:111], v5 offset:30720
v_cvt_pk_bf16_f32 v214, v216, v217
v_mfma_f32_16x16x32_bf16 v[148:151], a[140:143], a[4:7], v[148:151]
v_cvt_pk_bf16_f32 v215, v218, v219
v_mfma_f32_16x16x32_bf16 v[172:175], a[140:143], a[12:15], v[172:175]
buffer_load_dwordx4 v1, s[4:7], s44 offen offset:3072 sc1 lds
s_add_u32 m0, s19, 147456
v_mfma_f32_16x16x32_bf16 v[172:175], a[136:139], a[8:11], v[172:175]
s_xor_b32 s44, s85, 114688
ds_read_b128 a[112:115], v5 offset:36864
v_mfma_f32_16x16x32_bf16 v[196:199], a[136:139], a[16:19], v[196:199]
v_cvt_pk_bf16_f32 v166, v168, v169
v_cvt_pk_bf16_f32 v167, v170, v171
v_mfma_f32_16x16x32_bf16 v[196:199], a[140:143], a[20:23], v[196:199]
ds_read_b128 a[116:119], v5 offset:43008
v_cvt_pk_bf16_f32 v190, v192, v193
v_mfma_f32_16x16x32_bf16 v[220:223], a[140:143], a[28:31], v[220:223]
v_cvt_pk_bf16_f32 v142, v144, v145
v_cvt_pk_bf16_f32 v143, v146, v147
v_mfma_f32_16x16x32_bf16 v[220:223], a[136:139], a[24:27], v[220:223]
buffer_load_dwordx4 v1, s[4:7], s44 offen offset:0 sc1 lds
v_mfma_f32_16x16x32_bf16 v[224:227], a[144:147], a[24:27], v[224:227]
v_mfma_f32_16x16x32_bf16 v[92:95], a[240:243], v[140:143], 0
v_mfma_f32_16x16x32_bf16 v[224:227], a[148:151], a[28:31], v[224:227]
v_mfma_f32_16x16x32_bf16 v[96:99], a[244:247], v[140:143], 0
v_mfma_f32_16x16x32_bf16 v[200:203], a[148:151], a[20:23], v[200:203]
v_mfma_f32_16x16x32_bf16 v[100:103], a[240:243], v[164:167], 0
v_mfma_f32_16x16x32_bf16 v[200:203], a[144:147], a[16:19], v[200:203]
v_mfma_f32_16x16x32_bf16 v[104:107], a[244:247], v[164:167], 0
v_mfma_f32_16x16x32_bf16 v[176:179], a[144:147], a[8:11], v[176:179]
buffer_load_dwordx4 v1, s[4:7], s44 offen offset:1024 sc1 lds
v_mfma_f32_16x16x32_bf16 v[176:179], a[148:151], a[12:15], v[176:179]
v_max3_f32 v236, v92, v93, v94
v_max3_f32 v237, -v92, -v93, -v94
v_mfma_f32_16x16x32_bf16 v[152:155], a[148:151], a[4:7], v[152:155]
v_max3_f32 v236, v236, v95, v96
v_max3_f32 v237, v237, -v95, -v96
v_mfma_f32_16x16x32_bf16 v[152:155], a[144:147], a[0:3], v[152:155]
v_max3_f32 v236, v236, v97, v98
s_waitcnt lgkmcnt(0)
v_mfma_f32_16x16x32_bf16 v[132:135], a[96:99], a[32:35], v[132:135]
ds_read_b128 a[128:131], v5 offset:13312
v_max3_f32 v237, v237, -v97, -v98
v_mfma_f32_16x16x32_bf16 v[132:135], a[100:103], a[36:39], v[132:135]
buffer_load_dwordx4 v1, s[4:7], s44 offen offset:2048 sc1 lds
v_mfma_f32_16x16x32_bf16 v[156:159], a[100:103], a[44:47], v[156:159]
ds_read_b128 a[132:135], v5 offset:19456
v_max_f32 v236, v236, v99
v_mfma_f32_16x16x32_bf16 v[156:159], a[96:99], a[40:43], v[156:159]
v_max_f32_e64 v237, v237, -v99
v_max3_f32 v238, v100, v101, v102
v_mfma_f32_16x16x32_bf16 v[180:183], a[96:99], a[48:51], v[180:183]
v_permlane32_swap_b32 v236, v237
v_mfma_f32_16x16x32_bf16 v[180:183], a[100:103], a[52:55], v[180:183]
buffer_load_dwordx4 v1, s[4:7], s44 offen offset:3072 sc1 lds
s_add_u32 m0, s19, 98304
v_mfma_f32_16x16x32_bf16 v[204:207], a[100:103], a[60:63], v[204:207]
s_xor_b32 s44, s85, 65536
ds_read_b128 a[136:139], v5 offset:25600
v_mfma_f32_16x16x32_bf16 v[204:207], a[96:99], a[56:59], v[204:207]
v_max_f32 v236, v236, v237
v_mov_b32 v244, v236
v_mfma_f32_16x16x32_bf16 v[204:207], a[104:107], a[88:91], v[204:207]
ds_read_b128 a[140:143], v5 offset:31744
v_max3_f32 v239, -v100, -v101, -v102
v_mfma_f32_16x16x32_bf16 v[204:207], a[108:111], a[92:95], v[204:207]
v_permlane16_swap_b32 v236, v244
v_mfma_f32_16x16x32_bf16 v[180:183], a[108:111], a[84:87], v[180:183]
buffer_load_dwordx4 v1, s[4:7], s44 offen offset:0 sc1 lds
v_mfma_f32_16x16x32_bf16 v[180:183], a[104:107], a[80:83], v[180:183]
ds_read_b128 a[144:147], v5 offset:37888
v_max_f32 v236, v236, v244
v_mfma_f32_16x16x32_bf16 v[156:159], a[104:107], a[72:75], v[156:159]
v_mov_b32 v244, v236
v_max3_f32 v238, v238, v103, v104
v_mfma_f32_16x16x32_bf16 v[156:159], a[108:111], a[76:79], v[156:159]
ds_read_b128 a[148:151], v5 offset:44032
v_max3_f32 v239, v239, -v103, -v104
v_mfma_f32_16x16x32_bf16 v[132:135], a[108:111], a[68:71], v[132:135]
v_permlane32_swap_b32 v236, v244
v_mfma_f32_16x16x32_bf16 v[132:135], a[104:107], a[64:67], v[132:135]
buffer_load_dwordx4 v1, s[4:7], s44 offen offset:1024 sc1 lds
v_mfma_f32_16x16x32_bf16 v[132:135], a[112:115], a[0:3], v[132:135]
v_mul_f32_e64 v236, -v236, v82
v_mul_f32_e64 v237, -v244, v82
v_mfma_f32_16x16x32_bf16 v[132:135], a[116:119], a[4:7], v[132:135]
v_max3_f32 v238, v238, v105, v106
v_max3_f32 v239, v239, -v105, -v106
v_mfma_f32_16x16x32_bf16 v[156:159], a[116:119], a[12:15], v[156:159]
v_max_f32 v238, v238, v107
v_max_f32_e64 v239, v239, -v107
v_mfma_f32_16x16x32_bf16 v[156:159], a[112:115], a[8:11], v[156:159]
s_nop 0
v_permlane32_swap_b32 v238, v239
v_mfma_f32_16x16x32_bf16 v[180:183], a[112:115], a[16:19], v[180:183]
buffer_load_dwordx4 v1, s[4:7], s44 offen offset:2048 sc1 lds
v_mfma_f32_16x16x32_bf16 v[180:183], a[116:119], a[20:23], v[180:183]
v_max_f32 v238, v238, v239
v_mov_b32 v245, v238
v_mfma_f32_16x16x32_bf16 v[204:207], a[116:119], a[28:31], v[204:207]
s_nop 0
v_permlane16_swap_b32 v238, v245
v_mfma_f32_16x16x32_bf16 v[204:207], a[112:115], a[24:27], v[204:207]
s_waitcnt lgkmcnt(0)
s_barrier
v_mfma_f32_16x16x32_bf16 v[208:211], a[128:131], a[56:59], v[208:211]
v_max_f32 v238, v238, v245
v_mov_b32 v245, v238
v_mfma_f32_16x16x32_bf16 v[208:211], a[132:135], a[60:63], v[208:211]
buffer_load_dwordx4 v1, s[4:7], s44 offen offset:3072 sc1 lds
s_add_u32 m0, s19, 114688
v_mfma_f32_16x16x32_bf16 v[184:187], a[132:135], a[52:55], v[184:187]
s_xor_b32 s44, s85, 81920
v_cvt_pk_bf16_f32 v191, v194, v195
v_mfma_f32_16x16x32_bf16 v[184:187], a[128:131], a[48:51], v[184:187]
v_permlane32_swap_b32 v238, v245
v_mfma_f32_16x16x32_bf16 v[160:163], a[128:131], a[40:43], v[160:163]
v_mul_f32_e64 v238, -v238, v84
v_mul_f32_e64 v239, -v245, v84
v_mfma_f32_16x16x32_bf16 v[160:163], a[132:135], a[44:47], v[160:163]
buffer_load_dwordx4 v1, s[4:7], s44 offen offset:0 sc1 lds
v_mfma_f32_16x16x32_bf16 v[136:139], a[132:135], a[36:39], v[136:139]
v_mfma_f32_16x16x32_bf16 v[108:111], a[240:243], v[188:191], 0
v_mfma_f32_16x16x32_bf16 v[136:139], a[128:131], a[32:35], v[136:139]
v_mfma_f32_16x16x32_bf16 v[112:115], a[244:247], v[188:191], 0
v_mfma_f32_16x16x32_bf16 v[136:139], a[136:139], a[64:67], v[136:139]
v_mfma_f32_16x16x32_bf16 v[116:119], a[240:243], v[212:215], 0
v_mfma_f32_16x16x32_bf16 v[136:139], a[140:143], a[68:71], v[136:139]
v_mfma_f32_16x16x32_bf16 v[120:123], a[244:247], v[212:215], 0
v_mfma_f32_16x16x32_bf16 v[160:163], a[140:143], a[76:79], v[160:163]
buffer_load_dwordx4 v1, s[4:7], s44 offen offset:1024 sc1 lds
v_mfma_f32_16x16x32_bf16 v[160:163], a[136:139], a[72:75], v[160:163]
v_max3_f32 v240, v108, v109, v110
v_max3_f32 v241, -v108, -v109, -v110
v_mfma_f32_16x16x32_bf16 v[184:187], a[136:139], a[80:83], v[184:187]
v_max3_f32 v240, v240, v111, v112
v_max3_f32 v241, v241, -v111, -v112
v_mfma_f32_16x16x32_bf16 v[184:187], a[140:143], a[84:87], v[184:187]
v_max3_f32 v240, v240, v113, v114
v_max3_f32 v241, v241, -v113, -v114
v_mfma_f32_16x16x32_bf16 v[208:211], a[140:143], a[92:95], v[208:211]
v_max_f32 v240, v240, v115
v_max_f32_e64 v241, v241, -v115
v_mfma_f32_16x16x32_bf16 v[208:211], a[136:139], a[88:91], v[208:211]
buffer_load_dwordx4 v1, s[4:7], s44 offen offset:2048 sc1 lds
v_mfma_f32_16x16x32_bf16 v[208:211], a[144:147], a[24:27], v[208:211]
v_permlane32_swap_b32 v240, v241
v_mfma_f32_16x16x32_bf16 v[208:211], a[148:151], a[28:31], v[208:211]
v_max_f32 v240, v240, v241
v_mov_b32 v246, v240
v_mfma_f32_16x16x32_bf16 v[184:187], a[148:151], a[20:23], v[184:187]
s_nop 0
v_permlane16_swap_b32 v240, v246
v_mfma_f32_16x16x32_bf16 v[184:187], a[144:147], a[16:19], v[184:187]
v_max_f32 v240, v240, v246
v_mov_b32 v246, v240
v_mfma_f32_16x16x32_bf16 v[160:163], a[144:147], a[8:11], v[160:163]
buffer_load_dwordx4 v1, s[4:7], s44 offen offset:3072 sc1 lds
v_mfma_f32_16x16x32_bf16 v[160:163], a[148:151], a[12:15], v[160:163]
v_permlane32_swap_b32 v240, v246
v_mfma_f32_16x16x32_bf16 v[136:139], a[148:151], a[4:7], v[136:139]
v_mul_f32_e64 v240, -v240, v86
v_mul_f32_e64 v241, -v246, v86
v_mfma_f32_16x16x32_bf16 v[136:139], a[144:147], a[0:3], v[136:139]
v_max3_f32 v242, v116, v117, v118
v_max3_f32 v243, -v116, -v117, -v118
v_pk_mul_f32 v[148:149], v[148:149], v[82:83] op_sel:[0,1] op_sel_hi:[1,1]
v_pk_mul_f32 v[150:151], v[150:151], v[82:83] op_sel:[0,1] op_sel_hi:[1,1]
v_cvt_pk_bf16_f32 v148, v148, v149
v_cvt_pk_bf16_f32 v149, v150, v151
ds_write_b64 v232, v[148:149] offset:0
v_pk_mul_f32 v[152:153], v[152:153], v[82:83] op_sel:[0,1] op_sel_hi:[1,1]
v_pk_mul_f32 v[154:155], v[154:155], v[82:83] op_sel:[0,1] op_sel_hi:[1,1]
v_cvt_pk_bf16_f32 v150, v152, v153
v_cvt_pk_bf16_f32 v151, v154, v155
v_pk_mul_f32 v[172:173], v[172:173], v[84:85] op_sel:[0,1] op_sel_hi:[1,1]
v_pk_mul_f32 v[174:175], v[174:175], v[84:85] op_sel:[0,1] op_sel_hi:[1,1]
v_cvt_pk_bf16_f32 v172, v172, v173
v_cvt_pk_bf16_f32 v173, v174, v175
v_pk_mul_f32 v[176:177], v[176:177], v[84:85] op_sel:[0,1] op_sel_hi:[1,1]
v_pk_mul_f32 v[178:179], v[178:179], v[84:85] op_sel:[0,1] op_sel_hi:[1,1]
v_cvt_pk_bf16_f32 v174, v176, v177
v_cvt_pk_bf16_f32 v175, v178, v179
ds_write_b64 v232, v[150:151] offset:512
v_pk_mul_f32 v[196:197], v[196:197], v[86:87] op_sel:[0,1] op_sel_hi:[1,1]
v_pk_mul_f32 v[198:199], v[198:199], v[86:87] op_sel:[0,1] op_sel_hi:[1,1]
v_cvt_pk_bf16_f32 v196, v196, v197
v_cvt_pk_bf16_f32 v197, v198, v199
buffer_store_dwordx4 a[248:251], v254, s[4:7], s97 offen offset:0 sc1
v_pk_mul_f32 v[200:201], v[200:201], v[86:87] op_sel:[0,1] op_sel_hi:[1,1]
v_pk_mul_f32 v[202:203], v[202:203], v[86:87] op_sel:[0,1] op_sel_hi:[1,1]
v_cvt_pk_bf16_f32 v198, v200, v201
v_cvt_pk_bf16_f32 v199, v202, v203
ds_write_b64 v232, v[172:173] offset:1024
v_pk_mul_f32 v[220:221], v[220:221], v[88:89] op_sel:[0,1] op_sel_hi:[1,1]
v_pk_mul_f32 v[222:223], v[222:223], v[88:89] op_sel:[0,1] op_sel_hi:[1,1]
v_cvt_pk_bf16_f32 v220, v220, v221
v_cvt_pk_bf16_f32 v221, v222, v223
v_pk_fma_f32 v[48:49], v[92:93], v[82:83], v[236:237] op_sel:[0,0,0] op_sel_hi:[1,0,0]
v_pk_fma_f32 v[50:51], v[94:95], v[82:83], v[236:237] op_sel:[0,0,0] op_sel_hi:[1,0,0]
v_pk_fma_f32 v[52:53], v[96:97], v[82:83], v[236:237] op_sel:[0,0,0] op_sel_hi:[1,0,0]
v_pk_fma_f32 v[54:55], v[98:99], v[82:83], v[236:237] op_sel:[0,0,0] op_sel_hi:[1,0,0]
v_exp_f32 v48, v48
v_exp_f32 v49, v49
ds_write_b64 v232, v[174:175] offset:1536
v_exp_f32 v50, v50
v_exp_f32 v51, v51
v_exp_f32 v52, v52
v_exp_f32 v53, v53
v_exp_f32 v54, v54
v_exp_f32 v55, v55
ds_write_b64 v232, v[196:197] offset:2048
buffer_store_dwordx4 a[248:251], v1, s[4:7], s96 offen offset:0 sc1
v_cvt_pk_bf16_f32 v140, v48, v49
v_cvt_pk_bf16_f32 v141, v50, v51
v_cvt_pk_bf16_f32 v142, v52, v53
v_cvt_pk_bf16_f32 v143, v54, v55
v_pk_mul_f32 v[224:225], v[224:225], v[88:89] op_sel:[0,1] op_sel_hi:[1,1]
v_pk_mul_f32 v[226:227], v[226:227], v[88:89] op_sel:[0,1] op_sel_hi:[1,1]
v_cvt_pk_bf16_f32 v222, v224, v225
v_mfma_f32_16x16x32_bf16 v[148:151], v[16:19], v[140:143], 0
ds_write_b64 v232, v[198:199] offset:2560
v_cvt_pk_bf16_f32 v223, v226, v227
s_add_u32 m0, s19, 131072
v_pk_fma_f32 v[92:93], v[92:93], v[82:83], v[236:237] op_sel:[0,0,1] op_sel_hi:[1,0,1] neg_lo:[1,0,0] neg_hi:[1,0,0]
v_pk_fma_f32 v[94:95], v[94:95], v[82:83], v[236:237] op_sel:[0,0,1] op_sel_hi:[1,0,1] neg_lo:[1,0,0] neg_hi:[1,0,0]
v_pk_fma_f32 v[96:97], v[96:97], v[82:83], v[236:237] op_sel:[0,0,1] op_sel_hi:[1,0,1] neg_lo:[1,0,0] neg_hi:[1,0,0]
s_nop 1
v_rcp_f32 v148, v148
v_pk_fma_f32 v[98:99], v[98:99], v[82:83], v[236:237] op_sel:[0,0,1] op_sel_hi:[1,0,1] neg_lo:[1,0,0] neg_hi:[1,0,0]
v_pk_mul_f32 v[48:49], v[48:49], v[148:149] op_sel:[0,0] op_sel_hi:[1,0]
v_pk_mul_f32 v[50:51], v[50:51], v[148:149] op_sel:[0,0] op_sel_hi:[1,0]
v_cvt_pk_bf16_f32 v140, v48, v49
v_cvt_pk_bf16_f32 v141, v50, v51
ds_write_b64 v232, v[220:221] offset:3072
v_exp_f32 v92, v92
v_exp_f32 v93, v93
v_exp_f32 v94, v94
v_exp_f32 v95, v95
v_exp_f32 v96, v96
v_exp_f32 v97, v97
ds_write_b64 v232, v[222:223] offset:3584
v_exp_f32 v98, v98
v_exp_f32 v99, v99
s_xor_b32 s44, s85, 98304
v_cvt_pk_bf16_f32 v144, v92, v93
v_cvt_pk_bf16_f32 v145, v94, v95
v_cvt_pk_bf16_f32 v146, v96, v97
v_cvt_pk_bf16_f32 v147, v98, v99
buffer_load_dwordx4 v1, s[4:7], s44 offen offset:0 sc1 lds
v_pk_mul_f32 v[52:53], v[52:53], v[148:149] op_sel:[0,0] op_sel_hi:[1,0]
ds_write_b64 v233, v[140:141] offset:16384
v_pk_mul_f32 v[54:55], v[54:55], v[148:149] op_sel:[0,0] op_sel_hi:[1,0]
v_cvt_pk_bf16_f32 v142, v52, v53
v_mfma_f32_16x16x32_bf16 v[152:155], v[16:19], v[144:147], 0
v_cvt_pk_bf16_f32 v143, v54, v55
v_max3_f32 v242, v242, v119, v120
v_max3_f32 v243, v243, -v119, -v120
v_max3_f32 v242, v242, v121, v122
v_max3_f32 v243, v243, -v121, -v122
v_pk_fma_f32 v[56:57], v[100:101], v[84:85], v[238:239] op_sel:[0,0,0] op_sel_hi:[1,0,0]
v_pk_fma_f32 v[58:59], v[102:103], v[84:85], v[238:239] op_sel:[0,0,0] op_sel_hi:[1,0,0]
v_pk_fma_f32 v[60:61], v[104:105], v[84:85], v[238:239] op_sel:[0,0,0] op_sel_hi:[1,0,0]
ds_write_b64 v233, v[142:143] offset:16896
v_rcp_f32 v152, v152
v_pk_fma_f32 v[62:63], v[106:107], v[84:85], v[238:239] op_sel:[0,0,0] op_sel_hi:[1,0,0]
v_pk_mul_f32 v[92:93], v[92:93], v[152:153] op_sel:[0,0] op_sel_hi:[1,0]
v_pk_mul_f32 v[94:95], v[94:95], v[152:153] op_sel:[0,0] op_sel_hi:[1,0]
v_cvt_pk_bf16_f32 v144, v92, v93
v_cvt_pk_bf16_f32 v145, v94, v95
v_exp_f32 v56, v56
v_exp_f32 v57, v57
v_exp_f32 v58, v58
ds_write_b64 v233, v[144:145] offset:17408
v_exp_f32 v59, v59
v_exp_f32 v60, v60
v_exp_f32 v61, v61
v_exp_f32 v62, v62
v_exp_f32 v63, v63
buffer_load_dwordx4 v1, s[4:7], s44 offen offset:1024 sc1 lds
v_cvt_pk_bf16_f32 v164, v56, v57
v_cvt_pk_bf16_f32 v165, v58, v59
v_cvt_pk_bf16_f32 v166, v60, v61
v_cvt_pk_bf16_f32 v167, v62, v63
v_pk_mul_f32 v[96:97], v[96:97], v[152:153] op_sel:[0,0] op_sel_hi:[1,0]
v_pk_mul_f32 v[98:99], v[98:99], v[152:153] op_sel:[0,0] op_sel_hi:[1,0]
v_cvt_pk_bf16_f32 v146, v96, v97
v_mfma_f32_16x16x32_bf16 v[172:175], v[16:19], v[164:167], 0
v_cvt_pk_bf16_f32 v147, v98, v99
ds_write_b64 v233, v[146:147] offset:17920
v_max_f32 v242, v242, v123
v_pk_fma_f32 v[100:101], v[100:101], v[84:85], v[238:239] op_sel:[0,0,1] op_sel_hi:[1,0,1] neg_lo:[1,0,0] neg_hi:[1,0,0]
v_pk_fma_f32 v[102:103], v[102:103], v[84:85], v[238:239] op_sel:[0,0,1] op_sel_hi:[1,0,1] neg_lo:[1,0,0] neg_hi:[1,0,0]
v_pk_fma_f32 v[104:105], v[104:105], v[84:85], v[238:239] op_sel:[0,0,1] op_sel_hi:[1,0,1] neg_lo:[1,0,0] neg_hi:[1,0,0]
s_nop 1
v_rcp_f32 v172, v172
v_pk_fma_f32 v[106:107], v[106:107], v[84:85], v[238:239] op_sel:[0,0,1] op_sel_hi:[1,0,1] neg_lo:[1,0,0] neg_hi:[1,0,0]
v_pk_mul_f32 v[56:57], v[56:57], v[172:173] op_sel:[0,0] op_sel_hi:[1,0]
v_pk_mul_f32 v[58:59], v[58:59], v[172:173] op_sel:[0,0] op_sel_hi:[1,0]
v_cvt_pk_bf16_f32 v164, v56, v57
v_cvt_pk_bf16_f32 v165, v58, v59
v_exp_f32 v100, v100
ds_write_b64 v233, v[164:165] offset:18432
v_exp_f32 v101, v101
v_exp_f32 v102, v102
v_exp_f32 v103, v103
v_exp_f32 v104, v104
v_exp_f32 v105, v105
v_exp_f32 v106, v106
v_exp_f32 v107, v107
buffer_load_dwordx4 v1, s[4:7], s44 offen offset:2048 sc1 lds
v_cvt_pk_bf16_f32 v168, v100, v101
v_cvt_pk_bf16_f32 v169, v102, v103
v_cvt_pk_bf16_f32 v170, v104, v105
v_cvt_pk_bf16_f32 v171, v106, v107
v_pk_mul_f32 v[60:61], v[60:61], v[172:173] op_sel:[0,0] op_sel_hi:[1,0]
v_pk_mul_f32 v[62:63], v[62:63], v[172:173] op_sel:[0,0] op_sel_hi:[1,0]
v_cvt_pk_bf16_f32 v166, v60, v61
v_mfma_f32_16x16x32_bf16 v[176:179], v[16:19], v[168:171], 0
v_cvt_pk_bf16_f32 v167, v62, v63
ds_write_b64 v233, v[166:167] offset:18944
v_max_f32_e64 v243, v243, -v123
v_pk_fma_f32 v[64:65], v[108:109], v[86:87], v[240:241] op_sel:[0,0,0] op_sel_hi:[1,0,0]
v_pk_fma_f32 v[66:67], v[110:111], v[86:87], v[240:241] op_sel:[0,0,0] op_sel_hi:[1,0,0]
v_pk_fma_f32 v[68:69], v[112:113], v[86:87], v[240:241] op_sel:[0,0,0] op_sel_hi:[1,0,0]
s_nop 1
v_rcp_f32 v176, v176
v_pk_fma_f32 v[70:71], v[114:115], v[86:87], v[240:241] op_sel:[0,0,0] op_sel_hi:[1,0,0]
v_pk_mul_f32 v[100:101], v[100:101], v[176:177] op_sel:[0,0] op_sel_hi:[1,0]
v_pk_mul_f32 v[102:103], v[102:103], v[176:177] op_sel:[0,0] op_sel_hi:[1,0]
v_cvt_pk_bf16_f32 v168, v100, v101
v_cvt_pk_bf16_f32 v169, v102, v103
v_exp_f32 v64, v64
ds_write_b64 v233, v[168:169] offset:19456
buffer_load_dwordx4 v1, s[4:7], s44 offen offset:3072 sc1 lds
v_exp_f32 v65, v65
v_exp_f32 v66, v66
v_exp_f32 v67, v67
v_exp_f32 v68, v68
v_exp_f32 v69, v69
v_exp_f32 v70, v70
v_exp_f32 v71, v71
v_cvt_pk_bf16_f32 v188, v64, v65
v_cvt_pk_bf16_f32 v189, v66, v67
v_cvt_pk_bf16_f32 v190, v68, v69
v_cvt_pk_bf16_f32 v191, v70, v71
v_pk_mul_f32 v[104:105], v[104:105], v[176:177] op_sel:[0,0] op_sel_hi:[1,0]
v_pk_mul_f32 v[106:107], v[106:107], v[176:177] op_sel:[0,0] op_sel_hi:[1,0]
v_cvt_pk_bf16_f32 v170, v104, v105
v_mfma_f32_16x16x32_bf16 v[196:199], v[16:19], v[188:191], 0
v_cvt_pk_bf16_f32 v171, v106, v107
ds_write_b64 v233, v[170:171] offset:19968
buffer_store_dwordx4 a[248:251], v2, s[4:7], s72 offen offset:0 sc1
s_nop 4
v_rcp_f32 v196, v196
v_pk_fma_f32 v[108:109], v[108:109], v[86:87], v[240:241] op_sel:[0,0,1] op_sel_hi:[1,0,1] neg_lo:[1,0,0] neg_hi:[1,0,0]
v_pk_mul_f32 v[64:65], v[64:65], v[196:197] op_sel:[0,0] op_sel_hi:[1,0]
v_pk_mul_f32 v[66:67], v[66:67], v[196:197] op_sel:[0,0] op_sel_hi:[1,0]
v_cvt_pk_bf16_f32 v188, v64, v65
v_cvt_pk_bf16_f32 v189, v66, v67
v_pk_fma_f32 v[110:111], v[110:111], v[86:87], v[240:241] op_sel:[0,0,1] op_sel_hi:[1,0,1] neg_lo:[1,0,0] neg_hi:[1,0,0]
ds_write_b64 v233, v[188:189] offset:20480
v_pk_fma_f32 v[112:113], v[112:113], v[86:87], v[240:241] op_sel:[0,0,1] op_sel_hi:[1,0,1] neg_lo:[1,0,0] neg_hi:[1,0,0]
v_pk_fma_f32 v[114:115], v[114:115], v[86:87], v[240:241] op_sel:[0,0,1] op_sel_hi:[1,0,1] neg_lo:[1,0,0] neg_hi:[1,0,0]
v_exp_f32 v108, v108
v_exp_f32 v109, v109
v_exp_f32 v110, v110
v_exp_f32 v111, v111
v_exp_f32 v112, v112
v_exp_f32 v113, v113
v_exp_f32 v114, v114
v_exp_f32 v115, v115
v_cvt_pk_bf16_f32 v192, v108, v109
v_cvt_pk_bf16_f32 v193, v110, v111
v_cvt_pk_bf16_f32 v194, v112, v113
v_cvt_pk_bf16_f32 v195, v114, v115
v_pk_mul_f32 v[68:69], v[68:69], v[196:197] op_sel:[0,0] op_sel_hi:[1,0]
v_pk_mul_f32 v[70:71], v[70:71], v[196:197] op_sel:[0,0] op_sel_hi:[1,0]
v_permlane32_swap_b32 v242, v243
v_mfma_f32_16x16x32_bf16 v[200:203], v[16:19], v[192:195], 0
v_cvt_pk_bf16_f32 v190, v68, v69
v_cvt_pk_bf16_f32 v191, v70, v71
ds_write_b64 v233, v[190:191] offset:20992
v_max_f32 v242, v242, v243
v_mov_b32 v247, v242
buffer_store_dwordx4 a[248:251], v2, s[4:7], s72 offen offset:1024 sc1
s_nop 0
v_permlane16_swap_b32 v242, v247
v_rcp_f32 v200, v200
v_max_f32 v242, v242, v247
v_mov_b32 v247, v242
v_pk_mul_f32 v[108:109], v[108:109], v[200:201] op_sel:[0,0] op_sel_hi:[1,0]
v_pk_mul_f32 v[110:111], v[110:111], v[200:201] op_sel:[0,0] op_sel_hi:[1,0]
v_cvt_pk_bf16_f32 v192, v108, v109
v_cvt_pk_bf16_f32 v193, v110, v111
v_permlane32_swap_b32 v242, v247
ds_write_b64 v233, v[192:193] offset:21504
v_mul_f32_e64 v242, -v242, v88
v_mul_f32_e64 v243, -v247, v88
v_pk_fma_f32 v[124:125], v[116:117], v[88:89], v[242:243] op_sel:[0,0,0] op_sel_hi:[1,0,0]
v_pk_fma_f32 v[126:127], v[118:119], v[88:89], v[242:243] op_sel:[0,0,0] op_sel_hi:[1,0,0]
v_pk_fma_f32 v[128:129], v[120:121], v[88:89], v[242:243] op_sel:[0,0,0] op_sel_hi:[1,0,0]
v_pk_fma_f32 v[130:131], v[122:123], v[88:89], v[242:243] op_sel:[0,0,0] op_sel_hi:[1,0,0]
v_exp_f32 v124, v124
v_exp_f32 v125, v125
v_exp_f32 v126, v126
v_exp_f32 v127, v127
v_exp_f32 v128, v128
v_exp_f32 v129, v129
v_exp_f32 v130, v130
v_exp_f32 v131, v131
v_cvt_pk_bf16_f32 v212, v124, v125
v_cvt_pk_bf16_f32 v213, v126, v127
v_cvt_pk_bf16_f32 v214, v128, v129
v_cvt_pk_bf16_f32 v215, v130, v131
v_pk_mul_f32 v[112:113], v[112:113], v[200:201] op_sel:[0,0] op_sel_hi:[1,0]
v_pk_mul_f32 v[114:115], v[114:115], v[200:201] op_sel:[0,0] op_sel_hi:[1,0]
v_cvt_pk_bf16_f32 v194, v112, v113
v_mfma_f32_16x16x32_bf16 v[220:223], v[16:19], v[212:215], 0
v_cvt_pk_bf16_f32 v195, v114, v115
ds_write_b64 v233, v[194:195] offset:22016
buffer_store_dwordx4 a[248:251], v2, s[4:7], s72 offen offset:2048 sc1
s_nop 4
v_rcp_f32 v220, v220
v_pk_fma_f32 v[116:117], v[116:117], v[88:89], v[242:243] op_sel:[0,0,1] op_sel_hi:[1,0,1] neg_lo:[1,0,0] neg_hi:[1,0,0]
v_pk_mul_f32 v[124:125], v[124:125], v[220:221] op_sel:[0,0] op_sel_hi:[1,0]
v_pk_mul_f32 v[126:127], v[126:127], v[220:221] op_sel:[0,0] op_sel_hi:[1,0]
v_cvt_pk_bf16_f32 v212, v124, v125
v_cvt_pk_bf16_f32 v213, v126, v127
v_pk_fma_f32 v[118:119], v[118:119], v[88:89], v[242:243] op_sel:[0,0,1] op_sel_hi:[1,0,1] neg_lo:[1,0,0] neg_hi:[1,0,0]
ds_write_b64 v233, v[212:213] offset:22528
v_pk_fma_f32 v[120:121], v[120:121], v[88:89], v[242:243] op_sel:[0,0,1] op_sel_hi:[1,0,1] neg_lo:[1,0,0] neg_hi:[1,0,0]
v_pk_fma_f32 v[122:123], v[122:123], v[88:89], v[242:243] op_sel:[0,0,1] op_sel_hi:[1,0,1] neg_lo:[1,0,0] neg_hi:[1,0,0]
v_exp_f32 v116, v116
v_exp_f32 v117, v117
v_exp_f32 v118, v118
v_exp_f32 v119, v119
v_exp_f32 v120, v120
v_exp_f32 v121, v121
v_exp_f32 v122, v122
v_exp_f32 v123, v123
v_cvt_pk_bf16_f32 v216, v116, v117
v_cvt_pk_bf16_f32 v217, v118, v119
v_cvt_pk_bf16_f32 v218, v120, v121
v_cvt_pk_bf16_f32 v219, v122, v123
v_pk_mul_f32 v[128:129], v[128:129], v[220:221] op_sel:[0,0] op_sel_hi:[1,0]
v_pk_mul_f32 v[130:131], v[130:131], v[220:221] op_sel:[0,0] op_sel_hi:[1,0]
v_cvt_pk_bf16_f32 v214, v128, v129
v_mfma_f32_16x16x32_bf16 v[224:227], v[16:19], v[216:219], 0
v_cvt_pk_bf16_f32 v215, v130, v131
ds_write_b64 v233, v[214:215] offset:23040
buffer_store_dwordx4 a[248:251], v2, s[4:7], s72 offen offset:3072 sc1
s_nop 4
v_rcp_f32 v224, v224
s_nop 0
v_pk_mul_f32 v[116:117], v[116:117], v[224:225] op_sel:[0,0] op_sel_hi:[1,0]
v_pk_mul_f32 v[118:119], v[118:119], v[224:225] op_sel:[0,0] op_sel_hi:[1,0]
v_cvt_pk_bf16_f32 v216, v116, v117
v_cvt_pk_bf16_f32 v217, v118, v119
v_pk_mul_f32 v[120:121], v[120:121], v[224:225] op_sel:[0,0] op_sel_hi:[1,0]
ds_write_b64 v233, v[216:217] offset:23552
v_pk_mul_f32 v[122:123], v[122:123], v[224:225] op_sel:[0,0] op_sel_hi:[1,0]
v_cvt_pk_bf16_f32 v218, v120, v121
v_cvt_pk_bf16_f32 v219, v122, v123
ds_write_b64 v233, v[218:219] offset:24064
s_waitcnt vmcnt(8)
s_waitcnt lgkmcnt(0)
s_barrier
ds_read_b64_tr_b16 a[0:1], v234 offset:16384
ds_read_b64_tr_b16 a[2:3], v234 offset:18432
ds_read_b64_tr_b16 a[12:13], v234 offset:20480
ds_read_b64_tr_b16 a[14:15], v234 offset:22528
ds_read_b64_tr_b16 a[24:25], v234 offset:24576
ds_read_b64_tr_b16 a[26:27], v234 offset:26624
ds_read_b64_tr_b16 a[4:5], v8 offset:0
ds_read_b64_tr_b16 a[6:7], v8 offset:1024
ds_read_b64_tr_b16 a[8:9], v8 offset:512
ds_read_b64_tr_b16 a[10:11], v8 offset:1536
ds_read_b64_tr_b16 a[36:37], v234 offset:28672
ds_read_b64_tr_b16 a[38:39], v234 offset:30720
ds_read_b64_tr_b16 a[16:17], v8 offset:2048
ds_read_b64_tr_b16 a[18:19], v8 offset:3072
ds_read_b64_tr_b16 a[20:21], v8 offset:2560
ds_read_b64_tr_b16 a[22:23], v8 offset:3584
ds_read_b64_tr_b16 a[48:49], v234 offset:32768
ds_read_b64_tr_b16 a[50:51], v234 offset:34816
ds_read_b64_tr_b16 a[28:29], v8 offset:4096
ds_read_b64_tr_b16 a[30:31], v8 offset:5120
ds_read_b64_tr_b16 a[32:33], v8 offset:4608
ds_read_b64_tr_b16 a[34:35], v8 offset:5632
ds_read_b64_tr_b16 a[60:61], v234 offset:36864
ds_read_b64_tr_b16 a[62:63], v234 offset:38912
s_waitcnt lgkmcnt(14)
v_mfma_f32_16x16x32_bf16 v[100:103], a[0:3], v[16:19], 0
ds_read_b64_tr_b16 a[40:41], v8 offset:6144
ds_read_b64_tr_b16 a[42:43], v8 offset:7168
ds_read_b64_tr_b16 a[44:45], v8 offset:6656
ds_read_b64_tr_b16 a[46:47], v8 offset:7680
ds_read_b64_tr_b16 a[72:73], v234 offset:40960
ds_read_b64_tr_b16 a[74:75], v234 offset:43008
v_mfma_f32_16x16x32_bf16 v[100:103], a[12:15], v[16:19], v[100:103]
buffer_atomic_add v12, v235, s[4:7], s94 offen sc1
ds_read_b64_tr_b16 a[52:53], v8 offset:8192
ds_read_b64_tr_b16 a[54:55], v8 offset:9216
ds_read_b64_tr_b16 a[56:57], v8 offset:8704
ds_read_b64_tr_b16 a[58:59], v8 offset:9728
ds_read_b64_tr_b16 a[84:85], v234 offset:45056
ds_read_b64_tr_b16 a[86:87], v234 offset:47104
v_mfma_f32_16x16x32_bf16 v[100:103], a[24:27], v[16:19], v[100:103]
ds_read_b64_tr_b16 a[64:65], v8 offset:10240
ds_read_b64_tr_b16 a[66:67], v8 offset:11264
v_mfma_f32_16x16x32_bf16 v[92:95], a[0:3], a[4:7], 0
ds_read_b64_tr_b16 a[68:69], v8 offset:10752
ds_read_b64_tr_b16 a[70:71], v8 offset:11776
v_mfma_f32_16x16x32_bf16 v[96:99], a[0:3], a[8:11], 0
ds_read_b64_tr_b16 a[76:77], v8 offset:12288
s_waitcnt lgkmcnt(14)
v_mfma_f32_16x16x32_bf16 v[100:103], a[36:39], v[16:19], v[100:103]
ds_read_b64_tr_b16 a[78:79], v8 offset:13312
L_stub18:
s_cbranch_execz L_wret5
v_mfma_f32_16x16x32_bf16 v[92:95], a[12:15], a[16:19], v[92:95]
ds_read_b64_tr_b16 a[80:81], v8 offset:12800
ds_read_b64_tr_b16 a[82:83], v8 offset:13824
v_mfma_f32_16x16x32_bf16 v[96:99], a[12:15], a[20:23], v[96:99]
ds_read_b64_tr_b16 a[88:89], v8 offset:14336
v_mfma_f32_16x16x32_bf16 v[100:103], a[48:51], v[16:19], v[100:103]
ds_read_b64_tr_b16 a[90:91], v8 offset:15360
v_mfma_f32_16x16x32_bf16 v[92:95], a[24:27], a[28:31], v[92:95]
ds_read_b64_tr_b16 a[92:93], v8 offset:14848
ds_read_b64_tr_b16 a[94:95], v8 offset:15872
v_mfma_f32_16x16x32_bf16 v[96:99], a[24:27], a[32:35], v[96:99]
v_cvt_pk_bf16_f32 v132, v132, v133
v_cvt_pk_bf16_f32 v156, v156, v157
v_mfma_f32_16x16x32_bf16 v[100:103], a[60:63], v[16:19], v[100:103]
v_cvt_pk_bf16_f32 v180, v180, v181
v_cvt_pk_bf16_f32 v204, v204, v205
v_mfma_f32_16x16x32_bf16 v[92:95], a[36:39], a[40:43], v[92:95]
v_cvt_pk_bf16_f32 v133, v134, v135
v_cvt_pk_bf16_f32 v157, v158, v159
s_waitcnt lgkmcnt(14)
v_mfma_f32_16x16x32_bf16 v[96:99], a[36:39], a[44:47], v[96:99]
v_cvt_pk_bf16_f32 v181, v182, v183
v_cvt_pk_bf16_f32 v205, v206, v207
v_mfma_f32_16x16x32_bf16 v[100:103], a[72:75], v[16:19], v[100:103]
v_cvt_pk_bf16_f32 v134, v136, v137
v_cvt_pk_bf16_f32 v135, v138, v139
v_mfma_f32_16x16x32_bf16 v[92:95], a[48:51], a[52:55], v[92:95]
v_cvt_pk_bf16_f32 v158, v160, v161
v_cvt_pk_bf16_f32 v159, v162, v163
v_mfma_f32_16x16x32_bf16 v[96:99], a[48:51], a[56:59], v[96:99]
v_cvt_pk_bf16_f32 v182, v184, v185
v_cvt_pk_bf16_f32 v183, v186, v187
s_waitcnt lgkmcnt(12)
v_mfma_f32_16x16x32_bf16 v[100:103], a[84:87], v[16:19], v[100:103]
v_cvt_pk_bf16_f32 v206, v208, v209
v_cvt_pk_bf16_f32 v207, v210, v211
s_waitcnt lgkmcnt(10)
v_mfma_f32_16x16x32_bf16 v[92:95], a[60:63], a[64:67], v[92:95]
s_waitcnt lgkmcnt(8)
v_mfma_f32_16x16x32_bf16 v[96:99], a[60:63], a[68:71], v[96:99]
s_nop 1
v_min_u32 v100, -2, v100
v_min_u32 v101, -2, v101
s_waitcnt lgkmcnt(6)
v_mfma_f32_16x16x32_bf16 v[92:95], a[72:75], a[76:79], v[92:95]
v_min_u32 v102, -2, v102
v_min_u32 v103, -2, v103
s_waitcnt lgkmcnt(4)
v_mfma_f32_16x16x32_bf16 v[96:99], a[72:75], a[80:83], v[96:99]
buffer_store_dwordx4 v[100:103], v254, s[4:7], s97 offen sc1
s_waitcnt lgkmcnt(2)
v_mfma_f32_16x16x32_bf16 v[92:95], a[84:87], a[88:91], v[92:95]
s_waitcnt lgkmcnt(0)
v_mfma_f32_16x16x32_bf16 v[96:99], a[84:87], a[92:95], v[96:99]
s_nop 5
v_cvt_pk_bf16_f32 v92, v92, v93
v_cvt_pk_bf16_f32 v93, v94, v95
v_min_u32 v92, -2, v92
v_min_u32 v93, -2, v93
v_cvt_pk_bf16_f32 v94, v96, v97
v_cvt_pk_bf16_f32 v95, v98, v99
v_min_u32 v94, -2, v94
v_min_u32 v95, -2, v95
buffer_store_dwordx4 v[92:95], v1, s[4:7], s96 offen sc1
s_barrier
s_add_u32 m0, s19, 32768
s_xor_b32 s44, s85, 0
buffer_load_dwordx4 v1, s[4:7], s44 offen offset:0 sc1 lds
v_mfma_f32_16x16x32_bf16 v[108:111], a[240:243], v[132:135], 0
v_mfma_f32_16x16x32_bf16 v[172:175], a[240:243], v[156:159], 0
v_mfma_f32_16x16x32_bf16 v[112:115], a[244:247], v[132:135], 0
s_nop 5
v_max3_f32 v236, v108, v109, v110
v_max3_f32 v237, -v108, -v109, -v110
v_mfma_f32_16x16x32_bf16 v[176:179], a[244:247], v[156:159], 0
v_max3_f32 v238, v172, v173, v174
v_max3_f32 v239, -v172, -v173, -v174
v_max3_f32 v236, v236, v111, v112
v_max3_f32 v237, v237, -v111, -v112
v_max3_f32 v236, v236, v113, v114
v_max3_f32 v237, v237, -v113, -v114
s_nop 1
v_max3_f32 v238, v238, v175, v176
v_max3_f32 v239, v239, -v175, -v176
v_max3_f32 v238, v238, v177, v178
v_max3_f32 v239, v239, -v177, -v178
v_max_f32 v236, v236, v115
buffer_load_dwordx4 v1, s[4:7], s44 offen offset:1024 sc1 lds
v_max_f32_e64 v237, v237, -v115
v_max_f32 v238, v238, v179
v_max_f32_e64 v239, v239, -v179
v_permlane32_swap_b32 v236, v237
s_nop 0
v_permlane32_swap_b32 v238, v239
v_mov_b32 v11, 0
buffer_atomic_add v11, v251, s[4:7], s89 offen sc0 sc1
v_max_f32 v236, v236, v237
v_max_f32 v238, v238, v239
v_mov_b32 v244, v236
v_mov_b32 v245, v238
s_nop 0
v_permlane16_swap_b32 v236, v244
v_permlane16_swap_b32 v238, v245
v_max_f32 v236, v236, v244
v_max_f32 v238, v238, v245
v_mov_b32 v244, v236
v_mov_b32 v245, v238
s_nop 0
v_permlane32_swap_b32 v236, v244
v_permlane32_swap_b32 v238, v245
v_mul_f32_e64 v236, -v236, v82
v_mul_f32_e64 v237, -v244, v82
buffer_load_dwordx4 v1, s[4:7], s44 offen offset:2048 sc1 lds
v_mul_f32_e64 v238, -v238, v84
v_mul_f32_e64 v239, -v245, v84
v_pk_fma_f32 v[116:117], v[108:109], v[82:83], v[236:237] op_sel:[0,0,0] op_sel_hi:[1,0,0]
v_pk_fma_f32 v[118:119], v[110:111], v[82:83], v[236:237] op_sel:[0,0,0] op_sel_hi:[1,0,0]
v_pk_fma_f32 v[120:121], v[112:113], v[82:83], v[236:237] op_sel:[0,0,0] op_sel_hi:[1,0,0]
v_pk_fma_f32 v[122:123], v[114:115], v[82:83], v[236:237] op_sel:[0,0,0] op_sel_hi:[1,0,0]
v_pk_fma_f32 v[148:149], v[172:173], v[84:85], v[238:239] op_sel:[0,0,0] op_sel_hi:[1,0,0]
v_pk_fma_f32 v[150:151], v[174:175], v[84:85], v[238:239] op_sel:[0,0,0] op_sel_hi:[1,0,0]
v_pk_fma_f32 v[152:153], v[176:177], v[84:85], v[238:239] op_sel:[0,0,0] op_sel_hi:[1,0,0]
v_pk_fma_f32 v[154:155], v[178:179], v[84:85], v[238:239] op_sel:[0,0,0] op_sel_hi:[1,0,0]
v_pk_fma_f32 v[108:109], v[108:109], v[82:83], v[236:237] op_sel:[0,0,1] op_sel_hi:[1,0,1] neg_lo:[1,0,0] neg_hi:[1,0,0]
v_pk_fma_f32 v[110:111], v[110:111], v[82:83], v[236:237] op_sel:[0,0,1] op_sel_hi:[1,0,1] neg_lo:[1,0,0] neg_hi:[1,0,0]
v_pk_fma_f32 v[112:113], v[112:113], v[82:83], v[236:237] op_sel:[0,0,1] op_sel_hi:[1,0,1] neg_lo:[1,0,0] neg_hi:[1,0,0]
v_pk_fma_f32 v[114:115], v[114:115], v[82:83], v[236:237] op_sel:[0,0,1] op_sel_hi:[1,0,1] neg_lo:[1,0,0] neg_hi:[1,0,0]
v_pk_fma_f32 v[172:173], v[172:173], v[84:85], v[238:239] op_sel:[0,0,1] op_sel_hi:[1,0,1] neg_lo:[1,0,0] neg_hi:[1,0,0]
v_pk_fma_f32 v[174:175], v[174:175], v[84:85], v[238:239] op_sel:[0,0,1] op_sel_hi:[1,0,1] neg_lo:[1,0,0] neg_hi:[1,0,0]
v_pk_fma_f32 v[176:177], v[176:177], v[84:85], v[238:239] op_sel:[0,0,1] op_sel_hi:[1,0,1] neg_lo:[1,0,0] neg_hi:[1,0,0]
v_pk_fma_f32 v[178:179], v[178:179], v[84:85], v[238:239] op_sel:[0,0,1] op_sel_hi:[1,0,1] neg_lo:[1,0,0] neg_hi:[1,0,0]
v_exp_f32 v116, v116
v_exp_f32 v108, v108
v_exp_f32 v117, v117
v_exp_f32 v109, v109
v_exp_f32 v118, v118
v_exp_f32 v110, v110
v_exp_f32 v119, v119
v_exp_f32 v111, v111
v_exp_f32 v120, v120
v_exp_f32 v112, v112
v_exp_f32 v121, v121
v_exp_f32 v113, v113
v_exp_f32 v122, v122
v_exp_f32 v114, v114
v_exp_f32 v123, v123
v_exp_f32 v115, v115
v_exp_f32 v148, v148
v_exp_f32 v172, v172
v_exp_f32 v149, v149
v_exp_f32 v173, v173
v_exp_f32 v150, v150
v_exp_f32 v174, v174
v_exp_f32 v151, v151
v_exp_f32 v175, v175
v_exp_f32 v152, v152
v_exp_f32 v176, v176
v_exp_f32 v153, v153
v_exp_f32 v177, v177
v_exp_f32 v154, v154
v_exp_f32 v178, v178
v_exp_f32 v155, v155
v_exp_f32 v179, v179
buffer_load_dwordx4 v1, s[4:7], s44 offen offset:3072 sc1 lds
v_cvt_pk_bf16_f32 v140, v116, v117
v_cvt_pk_bf16_f32 v141, v118, v119
v_cvt_pk_bf16_f32 v142, v120, v121
v_cvt_pk_bf16_f32 v143, v122, v123
v_cvt_pk_bf16_f32 v144, v108, v109
v_cvt_pk_bf16_f32 v145, v110, v111
v_cvt_pk_bf16_f32 v146, v112, v113
v_cvt_pk_bf16_f32 v147, v114, v115
v_cvt_pk_bf16_f32 v164, v148, v149
v_cvt_pk_bf16_f32 v165, v150, v151
v_cvt_pk_bf16_f32 v166, v152, v153
v_cvt_pk_bf16_f32 v167, v154, v155
v_cvt_pk_bf16_f32 v168, v172, v173
v_cvt_pk_bf16_f32 v169, v174, v175
v_cvt_pk_bf16_f32 v170, v176, v177
v_cvt_pk_bf16_f32 v171, v178, v179
s_waitcnt vmcnt(2)
v_readfirstlane_b32 s38, v11
s_nop 0
s_cmp_ge_u32 s38, 8
s_cbranch_scc1 Lpe_47
s_add_u32 s36, s88, 0x90000
s_mov_b32 s37, 0
Lpoll_46:
v_mov_b32 v11, 0
buffer_atomic_add v11, v251, s[4:7], s36 offen sc0 sc1
s_add_u32 s37, s37, 1
s_waitcnt vmcnt(0)
v_readfirstlane_b32 s38, v11
s_nop 0
s_cmp_ge_u32 s38, 8
s_cbranch_scc1 Lpe_47
s_cmp_lt_u32 s37, 0x100000
s_cbranch_scc1 Lpoll_46
Lpe_47:
buffer_load_dwordx4 v[48:51], v1, s[4:7], s98 offen offset:0 sc1
v_mfma_f32_16x16x32_bf16 v[108:111], a[240:243], v[180:183], 0
v_mfma_f32_16x16x32_bf16 v[220:223], a[240:243], v[204:207], 0
v_mfma_f32_16x16x32_bf16 v[112:115], a[244:247], v[180:183], 0
s_nop 5
v_max3_f32 v240, v108, v109, v110
v_max3_f32 v241, -v108, -v109, -v110
v_mfma_f32_16x16x32_bf16 v[224:227], a[244:247], v[204:207], 0
buffer_load_dwordx4 v[124:127], v248, s[4:7], s100 offen sc1
v_max3_f32 v242, v220, v221, v222
v_max3_f32 v243, -v220, -v221, -v222
v_max3_f32 v240, v240, v111, v112
v_max3_f32 v241, v241, -v111, -v112
v_max3_f32 v240, v240, v113, v114
s_nop 1
v_max3_f32 v242, v242, v223, v224
v_max3_f32 v243, v243, -v223, -v224
v_max3_f32 v241, v241, -v113, -v114
v_max3_f32 v242, v242, v225, v226
v_max3_f32 v243, v243, -v225, -v226
v_max_f32 v240, v240, v115
v_max_f32_e64 v241, v241, -v115
v_max_f32 v242, v242, v227
buffer_load_dwordx4 v[52:55], v1, s[4:7], s98 offen offset:1024 sc1
v_max_f32_e64 v243, v243, -v227
v_permlane32_swap_b32 v240, v241
s_nop 0
v_permlane32_swap_b32 v242, v243
v_max_f32 v240, v240, v241
v_max_f32 v242, v242, v243
v_mov_b32 v246, v240
v_mov_b32 v247, v242
s_nop 0
v_permlane16_swap_b32 v240, v246
v_permlane16_swap_b32 v242, v247
buffer_load_dwordx4 v[56:59], v1, s[4:7], s98 offen offset:2048 sc1
v_max_f32 v240, v240, v246
v_max_f32 v242, v242, v247
v_mov_b32 v246, v240
v_mov_b32 v247, v242
s_nop 0
v_permlane32_swap_b32 v240, v246
v_permlane32_swap_b32 v242, v247
v_mul_f32_e64 v240, -v240, v86
v_mul_f32_e64 v241, -v246, v86
v_mul_f32_e64 v242, -v242, v88
v_mul_f32_e64 v243, -v247, v88
buffer_load_dwordx4 v[60:63], v1, s[4:7], s98 offen offset:3072 sc1
v_pk_fma_f32 v[116:117], v[108:109], v[86:87], v[240:241] op_sel:[0,0,0] op_sel_hi:[1,0,0]
v_pk_fma_f32 v[118:119], v[110:111], v[86:87], v[240:241] op_sel:[0,0,0] op_sel_hi:[1,0,0]
v_pk_fma_f32 v[120:121], v[112:113], v[86:87], v[240:241] op_sel:[0,0,0] op_sel_hi:[1,0,0]
v_pk_fma_f32 v[122:123], v[114:115], v[86:87], v[240:241] op_sel:[0,0,0] op_sel_hi:[1,0,0]
v_pk_fma_f32 v[196:197], v[220:221], v[88:89], v[242:243] op_sel:[0,0,0] op_sel_hi:[1,0,0]
v_pk_fma_f32 v[198:199], v[222:223], v[88:89], v[242:243] op_sel:[0,0,0] op_sel_hi:[1,0,0]
v_pk_fma_f32 v[200:201], v[224:225], v[88:89], v[242:243] op_sel:[0,0,0] op_sel_hi:[1,0,0]
v_pk_fma_f32 v[202:203], v[226:227], v[88:89], v[242:243] op_sel:[0,0,0] op_sel_hi:[1,0,0]
v_pk_fma_f32 v[108:109], v[108:109], v[86:87], v[240:241] op_sel:[0,0,1] op_sel_hi:[1,0,1] neg_lo:[1,0,0] neg_hi:[1,0,0]
v_pk_fma_f32 v[110:111], v[110:111], v[86:87], v[240:241] op_sel:[0,0,1] op_sel_hi:[1,0,1] neg_lo:[1,0,0] neg_hi:[1,0,0]
v_pk_fma_f32 v[112:113], v[112:113], v[86:87], v[240:241] op_sel:[0,0,1] op_sel_hi:[1,0,1] neg_lo:[1,0,0] neg_hi:[1,0,0]
v_pk_fma_f32 v[114:115], v[114:115], v[86:87], v[240:241] op_sel:[0,0,1] op_sel_hi:[1,0,1] neg_lo:[1,0,0] neg_hi:[1,0,0]
v_pk_fma_f32 v[220:221], v[220:221], v[88:89], v[242:243] op_sel:[0,0,1] op_sel_hi:[1,0,1] neg_lo:[1,0,0] neg_hi:[1,0,0]
buffer_load_dwordx4 v[64:67], v1, s[4:7], s99 offen offset:0 sc1
v_pk_fma_f32 v[222:223], v[222:223], v[88:89], v[242:243] op_sel:[0,0,1] op_sel_hi:[1,0,1] neg_lo:[1,0,0] neg_hi:[1,0,0]
v_pk_fma_f32 v[224:225], v[224:225], v[88:89], v[242:243] op_sel:[0,0,1] op_sel_hi:[1,0,1] neg_lo:[1,0,0] neg_hi:[1,0,0]
v_pk_fma_f32 v[226:227], v[226:227], v[88:89], v[242:243] op_sel:[0,0,1] op_sel_hi:[1,0,1] neg_lo:[1,0,0] neg_hi:[1,0,0]
v_exp_f32 v116, v116
v_exp_f32 v108, v108
v_exp_f32 v117, v117
v_exp_f32 v109, v109
v_exp_f32 v118, v118
buffer_load_dwordx4 v[68:71], v1, s[4:7], s99 offen offset:1024 sc1
v_exp_f32 v110, v110
v_exp_f32 v119, v119
v_exp_f32 v111, v111
v_exp_f32 v120, v120
v_exp_f32 v112, v112
v_exp_f32 v121, v121
v_exp_f32 v113, v113
buffer_load_dwordx4 v[100:103], v1, s[4:7], s99 offen offset:2048 sc1
v_exp_f32 v122, v122
v_exp_f32 v114, v114
v_exp_f32 v123, v123
v_exp_f32 v115, v115
v_exp_f32 v196, v196
v_exp_f32 v220, v220
v_exp_f32 v197, v197
buffer_load_dwordx4 v[104:107], v1, s[4:7], s99 offen offset:3072 sc1
v_exp_f32 v221, v221
v_exp_f32 v198, v198
v_exp_f32 v222, v222
v_exp_f32 v199, v199
v_exp_f32 v223, v223
v_exp_f32 v200, v200
v_exp_f32 v224, v224
v_exp_f32 v201, v201
v_exp_f32 v225, v225
v_exp_f32 v202, v202
v_exp_f32 v226, v226
v_exp_f32 v203, v203
v_exp_f32 v227, v227
v_cvt_pk_bf16_f32 v188, v116, v117
v_cvt_pk_bf16_f32 v189, v118, v119
v_cvt_pk_bf16_f32 v190, v120, v121
v_cvt_pk_bf16_f32 v191, v122, v123
v_cvt_pk_bf16_f32 v192, v108, v109
v_cvt_pk_bf16_f32 v193, v110, v111
v_cvt_pk_bf16_f32 v194, v112, v113
v_cvt_pk_bf16_f32 v195, v114, v115
v_cvt_pk_bf16_f32 v212, v196, v197
v_cvt_pk_bf16_f32 v213, v198, v199
v_cvt_pk_bf16_f32 v214, v200, v201
v_cvt_pk_bf16_f32 v215, v202, v203
v_cvt_pk_bf16_f32 v216, v220, v221
v_cvt_pk_bf16_f32 v217, v222, v223
v_cvt_pk_bf16_f32 v218, v224, v225
v_cvt_pk_bf16_f32 v219, v226, v227
s_waitcnt vmcnt(8)
v_lshlrev_b32 v92, 16, v48
v_and_b32 v93, 0xffff0000, v48
v_lshlrev_b32 v94, 16, v49
v_and_b32 v95, 0xffff0000, v49
v_lshlrev_b32 v96, 16, v50
v_and_b32 v97, 0xffff0000, v50
v_lshlrev_b32 v98, 16, v51
v_and_b32 v99, 0xffff0000, v51
s_waitcnt vmcnt(7)
v_add_f32_dpp v128, v124, v124 row_ror:4 row_mask:0xf bank_mask:0xf
v_add_f32_dpp v129, v125, v125 row_ror:4 row_mask:0xf bank_mask:0xf
v_add_f32_dpp v130, v126, v126 row_ror:4 row_mask:0xf bank_mask:0xf
v_add_f32_dpp v131, v127, v127 row_ror:4 row_mask:0xf bank_mask:0xf
v_add_f32_dpp v128, v128, v128 row_ror:2 row_mask:0xf bank_mask:0xf
v_add_f32_dpp v129, v129, v129 row_ror:2 row_mask:0xf bank_mask:0xf
v_add_f32_dpp v130, v130, v130 row_ror:2 row_mask:0xf bank_mask:0xf
v_add_f32_dpp v131, v131, v131 row_ror:2 row_mask:0xf bank_mask:0xf
v_add_f32_dpp v128, v128, v128 row_ror:1 row_mask:0xf bank_mask:0xf
v_add_f32_dpp v129, v129, v129 row_ror:1 row_mask:0xf bank_mask:0xf
v_add_f32_dpp v130, v130, v130 row_ror:1 row_mask:0xf bank_mask:0xf
v_add_f32_dpp v131, v131, v131 row_ror:1 row_mask:0xf bank_mask:0xf
v_fma_f32 v135, v129, v130, v131
s_waitcnt vmcnt(6)
v_dot2c_f32_bf16 v92, v52, v249
v_dot2c_f32_bf16 v93, v52, v250
v_dot2c_f32_bf16 v94, v53, v249
v_dot2c_f32_bf16 v95, v53, v250
v_dot2c_f32_bf16 v96, v54, v249
v_dot2c_f32_bf16 v97, v54, v250
v_dot2c_f32_bf16 v98, v55, v249
v_dot2c_f32_bf16 v99, v55, v250
s_waitcnt vmcnt(5)
v_dot2c_f32_bf16 v92, v56, v249
v_dot2c_f32_bf16 v93, v56, v250
v_dot2c_f32_bf16 v94, v57, v249
v_dot2c_f32_bf16 v95, v57, v250
v_dot2c_f32_bf16 v96, v58, v249
v_dot2c_f32_bf16 v97, v58, v250
v_dot2c_f32_bf16 v98, v59, v249
v_dot2c_f32_bf16 v99, v59, v250
s_waitcnt vmcnt(4)
v_dot2c_f32_bf16 v92, v60, v249
v_dot2c_f32_bf16 v93, v60, v250
v_dot2c_f32_bf16 v94, v61, v249
v_dot2c_f32_bf16 v95, v61, v250
v_dot2c_f32_bf16 v96, v62, v249
v_dot2c_f32_bf16 v97, v62, v250
v_dot2c_f32_bf16 v98, v63, v249
v_dot2c_f32_bf16 v99, v63, v250
s_waitcnt vmcnt(3)
v_dot2c_f32_bf16 v92, v64, v249
v_dot2c_f32_bf16 v93, v64, v250
v_dot2c_f32_bf16 v94, v65, v249
v_dot2c_f32_bf16 v95, v65, v250
v_dot2c_f32_bf16 v96, v66, v249
v_dot2c_f32_bf16 v97, v66, v250
v_dot2c_f32_bf16 v98, v67, v249
v_dot2c_f32_bf16 v99, v67, v250
s_waitcnt vmcnt(2)
v_dot2c_f32_bf16 v92, v68, v249
v_dot2c_f32_bf16 v93, v68, v250
v_dot2c_f32_bf16 v94, v69, v249
v_dot2c_f32_bf16 v95, v69, v250
v_dot2c_f32_bf16 v96, v70, v249
v_dot2c_f32_bf16 v97, v70, v250
v_dot2c_f32_bf16 v98, v71, v249
v_dot2c_f32_bf16 v99, v71, v250
s_waitcnt vmcnt(1)
v_dot2c_f32_bf16 v92, v100, v249
v_dot2c_f32_bf16 v93, v100, v250
v_dot2c_f32_bf16 v94, v101, v249
v_dot2c_f32_bf16 v95, v101, v250
v_dot2c_f32_bf16 v96, v102, v249
v_dot2c_f32_bf16 v97, v102, v250
v_dot2c_f32_bf16 v98, v103, v249
v_dot2c_f32_bf16 v99, v103, v250
s_waitcnt vmcnt(0)
v_dot2c_f32_bf16 v92, v104, v249
v_dot2c_f32_bf16 v93, v104, v250
v_dot2c_f32_bf16 v94, v105, v249
v_dot2c_f32_bf16 v95, v105, v250
v_dot2c_f32_bf16 v96, v106, v249
v_dot2c_f32_bf16 v97, v106, v250
v_dot2c_f32_bf16 v98, v107, v249
v_dot2c_f32_bf16 v99, v107, v250
v_fma_f32 v132, v92, v93, v94
v_fma_f32 v133, v95, v96, v97
s_nop 0
v_fma_f32 v134, v98, v99, v128
v_fma_f32 v132, v132, v133, v134
v_cmp_u_f32 vcc, v132, v135
s_cbranch_vccnz L_kvredo3
L_kvback3:
v_cvt_pk_bf16_f32 v128, v128, v129
v_cvt_pk_bf16_f32 v129, v130, v131
v_cvt_pk_bf16_f32 v92, v92, v93
v_cndmask_b32 v128, 0, v128, s[56:57]
v_cndmask_b32 v129, 0, v129, s[56:57]
v_cvt_pk_bf16_f32 v93, v94, v95
v_cvt_pk_bf16_f32 v94, v96, v97
v_cvt_pk_bf16_f32 v95, v98, v99
v_cndmask_b32 v128, v128, v16, s[58:59]
v_cndmask_b32 v129, v129, v16, s[58:59]
ds_write_b64 v252, v[92:93] offset:0
ds_write_b64 v252, v[94:95] offset:1024
ds_write_b64 v252, v[128:129] offset:2048
s_waitcnt lgkmcnt(0)
s_barrier
ds_read_b128 a[8:11], v1 offset:2048
ds_read_b128 a[20:23], v1 offset:5120
ds_read_b128 a[0:3], v1 offset:0
ds_read_b128 a[12:15], v1 offset:3072
ds_read_b128 a[4:7], v1 offset:1024
ds_read_b128 a[16:19], v1 offset:4096
s_waitcnt lgkmcnt(5)
v_mfma_f32_16x16x32_bf16 v[116:119], a[8:11], v[212:215], 0
s_waitcnt lgkmcnt(4)
v_mfma_f32_16x16x32_bf16 v[120:123], a[20:23], v[216:219], 0
s_waitcnt lgkmcnt(3)
v_mfma_f32_16x16x32_bf16 v[204:207], a[0:3], v[212:215], 0
s_nop 3
v_rcp_f32 v118, v117
s_waitcnt lgkmcnt(2)
v_mfma_f32_16x16x32_bf16 v[220:223], a[12:15], v[216:219], 0
v_rcp_f32 v119, v121
v_mul_f32 v116, v116, v118
v_fmac_f32 v116, v120, v119
v_mfma_f32_16x16x32_bf16 v[100:103], a[8:11], v[164:167], 0
v_add_f32 v116, 0x358637bd, v116
v_rcp_f32 v116, v116
s_waitcnt lgkmcnt(1)
v_mfma_f32_16x16x32_bf16 v[208:211], a[4:7], v[212:215], 0
v_mul_f32 v118, v118, v116
v_mul_f32 v119, v119, v116
v_mfma_f32_16x16x32_bf16 v[104:107], a[20:23], v[168:171], 0
v_mul_f32 v204, v204, v118
v_mul_f32 v205, v205, v118
s_waitcnt lgkmcnt(0)
v_mfma_f32_16x16x32_bf16 v[224:227], a[16:19], v[216:219], 0
v_mul_f32 v206, v206, v118
v_mul_f32 v207, v207, v118
v_fmac_f32 v204, v220, v119
v_fmac_f32 v205, v221, v119
v_rcp_f32 v102, v101
v_mul_f32 v208, v208, v118
v_mul_f32 v209, v209, v118
v_mul_f32 v210, v210, v118
v_mul_f32 v211, v211, v118
v_fmac_f32 v206, v222, v119
v_fmac_f32 v207, v223, v119
v_cvt_pk_bf16_f32 v204, v204, v205
v_rcp_f32 v103, v105
v_fmac_f32 v208, v224, v119
v_fmac_f32 v209, v225, v119
v_fmac_f32 v210, v226, v119
v_fmac_f32 v211, v227, v119
v_cvt_pk_bf16_f32 v205, v206, v207
v_cvt_pk_bf16_f32 v206, v208, v209
v_cvt_pk_bf16_f32 v207, v210, v211
v_mul_f32 v100, v100, v102
v_mfma_f32_16x16x32_bf16 v[156:159], a[0:3], v[164:167], 0
buffer_store_dwordx4 v[204:207], v2, s[4:7], s72 offen offset:3072 sc1
v_fmac_f32 v100, v104, v103
v_mfma_f32_16x16x32_bf16 v[172:175], a[12:15], v[168:171], 0
v_add_f32 v100, 0x358637bd, v100
v_rcp_f32 v100, v100
buffer_atomic_add v12, v10, s[4:7], s74 offen sc1
v_mfma_f32_16x16x32_bf16 v[108:111], a[8:11], v[188:191], 0
v_mul_f32 v102, v102, v100
v_mul_f32 v103, v103, v100
v_mfma_f32_16x16x32_bf16 v[160:163], a[4:7], v[164:167], 0
v_mul_f32 v156, v156, v102
v_mul_f32 v157, v157, v102
v_mfma_f32_16x16x32_bf16 v[112:115], a[20:23], v[192:195], 0
v_mul_f32 v158, v158, v102
v_mul_f32 v159, v159, v102
v_mfma_f32_16x16x32_bf16 v[176:179], a[16:19], v[168:171], 0
v_fmac_f32 v156, v172, v103
v_fmac_f32 v157, v173, v103
v_rcp_f32 v110, v109
v_mul_f32 v160, v160, v102
v_mul_f32 v161, v161, v102
v_mul_f32 v162, v162, v102
v_mul_f32 v163, v163, v102
v_fmac_f32 v158, v174, v103
v_fmac_f32 v159, v175, v103
v_cvt_pk_bf16_f32 v156, v156, v157
v_rcp_f32 v111, v113
v_fmac_f32 v160, v176, v103
v_fmac_f32 v161, v177, v103
v_fmac_f32 v162, v178, v103
v_fmac_f32 v163, v179, v103
v_cvt_pk_bf16_f32 v157, v158, v159
v_cvt_pk_bf16_f32 v158, v160, v161
v_cvt_pk_bf16_f32 v159, v162, v163
v_mul_f32 v108, v108, v110
v_mfma_f32_16x16x32_bf16 v[180:183], a[0:3], v[188:191], 0
buffer_store_dwordx4 v[156:159], v2, s[4:7], s72 offen offset:1024 sc1
v_fmac_f32 v108, v112, v111
v_mfma_f32_16x16x32_bf16 v[196:199], a[12:15], v[192:195], 0
v_add_f32 v108, 0x358637bd, v108
v_rcp_f32 v108, v108
v_mfma_f32_16x16x32_bf16 v[92:95], a[8:11], v[140:143], 0
v_mul_f32 v110, v110, v108
v_mul_f32 v111, v111, v108
v_mfma_f32_16x16x32_bf16 v[184:187], a[4:7], v[188:191], 0
v_mul_f32 v180, v180, v110
v_mul_f32 v181, v181, v110
v_mfma_f32_16x16x32_bf16 v[96:99], a[20:23], v[144:147], 0
v_mul_f32 v182, v182, v110
v_mul_f32 v183, v183, v110
v_mfma_f32_16x16x32_bf16 v[200:203], a[16:19], v[192:195], 0
v_fmac_f32 v180, v196, v111
v_fmac_f32 v181, v197, v111
v_rcp_f32 v94, v93
v_mul_f32 v184, v184, v110
v_mul_f32 v185, v185, v110
v_mul_f32 v186, v186, v110
v_mul_f32 v187, v187, v110
v_fmac_f32 v182, v198, v111
v_fmac_f32 v183, v199, v111
v_cvt_pk_bf16_f32 v180, v180, v181
v_rcp_f32 v95, v97
v_fmac_f32 v184, v200, v111
v_fmac_f32 v185, v201, v111
v_fmac_f32 v186, v202, v111
v_fmac_f32 v187, v203, v111
v_cvt_pk_bf16_f32 v181, v182, v183
v_cvt_pk_bf16_f32 v182, v184, v185
v_cvt_pk_bf16_f32 v183, v186, v187
v_mul_f32 v92, v92, v94
v_mfma_f32_16x16x32_bf16 v[132:135], a[0:3], v[140:143], 0
buffer_store_dwordx4 v[180:183], v2, s[4:7], s72 offen offset:2048 sc1
v_fmac_f32 v92, v96, v95
v_mfma_f32_16x16x32_bf16 v[148:151], a[12:15], v[144:147], 0
v_add_f32 v92, 0x358637bd, v92
v_rcp_f32 v92, v92
v_mfma_f32_16x16x32_bf16 v[136:139], a[4:7], v[140:143], 0
v_mul_f32 v94, v94, v92
v_mul_f32 v95, v95, v92
v_mfma_f32_16x16x32_bf16 v[152:155], a[16:19], v[144:147], 0
v_mul_f32 v132, v132, v94
v_mul_f32 v133, v133, v94
v_mul_f32 v134, v134, v94
v_mul_f32 v135, v135, v94
v_fmac_f32 v132, v148, v95
v_fmac_f32 v133, v149, v95
v_mul_f32 v136, v136, v94
v_mul_f32 v137, v137, v94
v_mul_f32 v138, v138, v94
v_mul_f32 v139, v139, v94
v_fmac_f32 v134, v150, v95
v_fmac_f32 v135, v151, v95
v_cvt_pk_bf16_f32 v132, v132, v133
v_fmac_f32 v136, v152, v95
v_fmac_f32 v137, v153, v95
v_fmac_f32 v138, v154, v95
v_fmac_f32 v139, v155, v95
v_cvt_pk_bf16_f32 v133, v134, v135
v_cvt_pk_bf16_f32 v134, v136, v137
v_cvt_pk_bf16_f32 v135, v138, v139
buffer_store_dwordx4 v[132:135], v2, s[4:7], s72 offen offset:0 sc1
s_add_u32 s92, s71, 0x30000
s_add_u32 s40, s4, 0xc00000
s_addc_u32 s41, s5, 0
v_add_u32 v5, 32768, v1
v_add_u32 v6, 98304, v1
s_mov_b32 s35, s9
v_lshlrev_b32 v132, 16, v32
v_and_b32 v133, 0xffff0000, v32
v_lshlrev_b32 v134, 16, v33
v_and_b32 v135, 0xffff0000, v33
v_lshlrev_b32 v136, 16, v34
v_and_b32 v137, 0xffff0000, v34
v_lshlrev_b32 v138, 16, v35
v_and_b32 v139, 0xffff0000, v35
v_lshlrev_b32 v140, 16, v36
v_and_b32 v141, 0xffff0000, v36
v_lshlrev_b32 v142, 16, v37
v_and_b32 v143, 0xffff0000, v37
v_lshlrev_b32 v144, 16, v38
v_and_b32 v145, 0xffff0000, v38
v_lshlrev_b32 v146, 16, v39
v_and_b32 v147, 0xffff0000, v39
v_lshlrev_b32 v148, 16, v40
v_and_b32 v149, 0xffff0000, v40
v_lshlrev_b32 v150, 16, v41
v_and_b32 v151, 0xffff0000, v41
v_lshlrev_b32 v152, 16, v42
v_and_b32 v153, 0xffff0000, v42
v_lshlrev_b32 v154, 16, v43
v_and_b32 v155, 0xffff0000, v43
v_lshlrev_b32 v156, 16, v44
v_and_b32 v157, 0xffff0000, v44
v_lshlrev_b32 v158, 16, v45
v_and_b32 v159, 0xffff0000, v45
v_lshlrev_b32 v160, 16, v46
v_and_b32 v161, 0xffff0000, v46
v_lshlrev_b32 v162, 16, v47
v_and_b32 v163, 0xffff0000, v47
s_and_b32 s88, s31, 7
s_lshl_b32 s88, s88, 7
s_lshl_b32 s37, s28, 5
s_add_u32 s88, s88, s37
s_lshl_b32 s88, s88, 1
s_lshr_b32 s37, s31, 3
s_add_u32 s88, s88, s37
s_lshl_b32 s88, s88, 11
s_lshl_b32 s37, s32, 7
s_add_u32 s88, s88, s37
v_lshrrev_b32 v240, 4, v0
v_and_b32 v236, 7, v0
v_xor_b32 v236, v236, v240
v_lshlrev_b32 v236, 4, v236
v_and_b32 v240, 15, v0
v_lshl_add_u32 v236, v240, 7, v236
v_add_u32 v236, s19, v236
v_xor_b32 v237, 64, v236
v_add_u32 v238, s19, v1
v_lshrrev_b32 v240, 3, v0
v_and_b32 v239, 7, v0
v_xor_b32 v239, v239, v240
v_lshlrev_b32 v239, 4, v239
v_lshl_add_u32 v239, v240, 12, v239
s_mov_b32 s95, -1
s_mov_b64 exec, 0
s_cmp_eq_u32 s28, 3
s_cbranch_scc1 L_stub19
s_cmp_eq_u32 s28, 2
s_cbranch_scc1 L_wret7
s_cmp_eq_u32 s28, 0
s_cbranch_scc1 L_wret7
L_wret7:
s_mov_b64 exec, -1
s_cmp_lg_u32 s28, 1
s_cbranch_scc1 Lpo_50
s_add_u32 s36, s11, 0x30080
s_mov_b32 s37, 0
v_mov_b32 v11, 0
buffer_atomic_add v11, v251, s[4:7], s36 offen sc0 sc1
s_sleep 4
Lpoll_48:
v_mov_b32 v234, 0
buffer_atomic_add v234, v251, s[4:7], s36 offen sc0 sc1
s_waitcnt vmcnt(1)
v_readfirstlane_b32 s38, v11
s_nop 0
s_cmp_ge_u32 s38, 32
s_cbranch_scc1 Lpe_49
v_mov_b32 v11, 0
buffer_atomic_add v11, v251, s[4:7], s36 offen sc0 sc1
s_waitcnt vmcnt(1)
v_readfirstlane_b32 s38, v234
s_nop 0
s_cmp_ge_u32 s38, 32
s_cbranch_scc1 Lpe_49
s_add_u32 s37, s37, 1
s_cmp_lt_u32 s37, 0x80000
s_cbranch_scc1 Lpoll_48
s_waitcnt vmcnt(0)
Lpo_50:
s_waitcnt vmcnt(0)
Lpe_49:
s_barrier
L_k2go3:
buffer_load_dwordx4 a[0:3], v4, s[40:43], s35 offen offset:0 sc1
buffer_load_dwordx4 a[4:7], v4, s[40:43], s35 offen offset:1024 sc1
s_xor_b32 s35, s9, 4096
buffer_load_dwordx4 a[8:11], v4, s[40:43], s35 offen offset:0 sc1
buffer_load_dwordx4 a[12:15], v4, s[40:43], s35 offen offset:1024 sc1
s_xor_b32 s35, s9, 16384
buffer_load_dwordx4 a[16:19], v4, s[40:43], s35 offen offset:0 sc1
buffer_load_dwordx4 a[20:23], v4, s[40:43], s35 offen offset:1024 sc1
s_xor_b32 s35, s9, 20480
buffer_load_dwordx4 a[24:27], v4, s[40:43], s35 offen offset:0 sc1
buffer_load_dwordx4 a[28:31], v4, s[40:43], s35 offen offset:1024 sc1
s_xor_b32 s35, s9, 32768
buffer_load_dwordx4 a[32:35], v4, s[40:43], s35 offen offset:0 sc1
buffer_load_dwordx4 a[36:39], v4, s[40:43], s35 offen offset:1024 sc1
s_xor_b32 s35, s9, 36864
buffer_load_dwordx4 a[40:43], v4, s[40:43], s35 offen offset:0 sc1
buffer_load_dwordx4 a[44:47], v4, s[40:43], s35 offen offset:1024 sc1
s_xor_b32 s35, s9, 49152
ds_read_b128 a[96:99], v5 offset:0
ds_read_b128 a[100:103], v5 offset:1024
ds_read_b128 a[104:107], v5 offset:2048
ds_read_b128 a[108:111], v5 offset:3072
ds_read_b128 a[112:115], v5 offset:4096
ds_read_b128 a[116:119], v5 offset:5120
ds_read_b128 a[120:123], v5 offset:6144
ds_read_b128 a[124:127], v5 offset:7168
s_waitcnt vmcnt(10) lgkmcnt(4)
v_mfma_f32_16x16x32_bf16 v[132:135], a[96:99], a[0:3], v[132:135]
ds_read_b128 a[128:131], v5 offset:8192
v_mfma_f32_16x16x32_bf16 v[148:151], a[96:99], a[4:7], v[148:151]
ds_read_b128 a[132:135], v5 offset:9216
L_stub19:
s_cbranch_execz L_wret7
v_mfma_f32_16x16x32_bf16 v[152:155], a[100:103], a[4:7], v[152:155]
buffer_load_dwordx4 a[48:51], v4, s[40:43], s35 offen offset:0 sc1
v_mfma_f32_16x16x32_bf16 v[136:139], a[100:103], a[0:3], v[136:139]
ds_read_b128 a[136:139], v5 offset:10240
v_mfma_f32_16x16x32_bf16 v[140:143], a[104:107], a[0:3], v[140:143]
ds_read_b128 a[140:143], v5 offset:11264
v_mfma_f32_16x16x32_bf16 v[156:159], a[104:107], a[4:7], v[156:159]
v_mfma_f32_16x16x32_bf16 v[160:163], a[108:111], a[4:7], v[160:163]
buffer_load_dwordx4 a[52:55], v4, s[40:43], s35 offen offset:1024 sc1
s_xor_b32 s35, s9, 53248
v_mfma_f32_16x16x32_bf16 v[144:147], a[108:111], a[0:3], v[144:147]
s_waitcnt vmcnt(10) lgkmcnt(4)
v_mfma_f32_16x16x32_bf16 v[132:135], a[112:115], a[8:11], v[132:135]
ds_read_b128 a[96:99], v5 offset:12288
v_mfma_f32_16x16x32_bf16 v[148:151], a[112:115], a[12:15], v[148:151]
ds_read_b128 a[100:103], v5 offset:13312
v_mfma_f32_16x16x32_bf16 v[152:155], a[116:119], a[12:15], v[152:155]
buffer_load_dwordx4 a[0:3], v4, s[40:43], s35 offen offset:0 sc1
v_mfma_f32_16x16x32_bf16 v[136:139], a[116:119], a[8:11], v[136:139]
ds_read_b128 a[104:107], v5 offset:14336
v_mfma_f32_16x16x32_bf16 v[140:143], a[120:123], a[8:11], v[140:143]
ds_read_b128 a[108:111], v5 offset:15360
v_mfma_f32_16x16x32_bf16 v[156:159], a[120:123], a[12:15], v[156:159]
v_mfma_f32_16x16x32_bf16 v[160:163], a[124:127], a[12:15], v[160:163]
buffer_load_dwordx4 a[4:7], v4, s[40:43], s35 offen offset:1024 sc1
s_xor_b32 s35, s9, 65536
v_mfma_f32_16x16x32_bf16 v[144:147], a[124:127], a[8:11], v[144:147]
s_waitcnt vmcnt(10) lgkmcnt(4)
v_mfma_f32_16x16x32_bf16 v[132:135], a[128:131], a[16:19], v[132:135]
ds_read_b128 a[112:115], v5 offset:16384
v_mfma_f32_16x16x32_bf16 v[148:151], a[128:131], a[20:23], v[148:151]
ds_read_b128 a[116:119], v5 offset:17408
v_mfma_f32_16x16x32_bf16 v[152:155], a[132:135], a[20:23], v[152:155]
buffer_load_dwordx4 a[8:11], v4, s[40:43], s35 offen offset:0 sc1
v_mfma_f32_16x16x32_bf16 v[136:139], a[132:135], a[16:19], v[136:139]
ds_read_b128 a[120:123], v5 offset:18432
v_mfma_f32_16x16x32_bf16 v[140:143], a[136:139], a[16:19], v[140:143]
ds_read_b128 a[124:127], v5 offset:19456
v_mfma_f32_16x16x32_bf16 v[156:159], a[136:139], a[20:23], v[156:159]
v_mfma_f32_16x16x32_bf16 v[160:163], a[140:143], a[20:23], v[160:163]
buffer_load_dwordx4 a[12:15], v4, s[40:43], s35 offen offset:1024 sc1
s_xor_b32 s35, s9, 69632
v_mfma_f32_16x16x32_bf16 v[144:147], a[140:143], a[16:19], v[144:147]
s_waitcnt vmcnt(10) lgkmcnt(4)
v_mfma_f32_16x16x32_bf16 v[132:135], a[96:99], a[24:27], v[132:135]
ds_read_b128 a[128:131], v5 offset:20480
v_mfma_f32_16x16x32_bf16 v[148:151], a[96:99], a[28:31], v[148:151]
ds_read_b128 a[132:135], v5 offset:21504
v_mfma_f32_16x16x32_bf16 v[152:155], a[100:103], a[28:31], v[152:155]
buffer_load_dwordx4 a[16:19], v4, s[40:43], s35 offen offset:0 sc1
v_mfma_f32_16x16x32_bf16 v[136:139], a[100:103], a[24:27], v[136:139]
ds_read_b128 a[136:139], v5 offset:22528
v_mfma_f32_16x16x32_bf16 v[140:143], a[104:107], a[24:27], v[140:143]
ds_read_b128 a[140:143], v5 offset:23552
v_mfma_f32_16x16x32_bf16 v[156:159], a[104:107], a[28:31], v[156:159]
v_mfma_f32_16x16x32_bf16 v[160:163], a[108:111], a[28:31], v[160:163]
buffer_load_dwordx4 a[20:23], v4, s[40:43], s35 offen offset:1024 sc1
s_xor_b32 s35, s9, 81920
v_mfma_f32_16x16x32_bf16 v[144:147], a[108:111], a[24:27], v[144:147]
s_waitcnt vmcnt(10) lgkmcnt(4)
v_mfma_f32_16x16x32_bf16 v[132:135], a[112:115], a[32:35], v[132:135]
ds_read_b128 a[96:99], v5 offset:24576
v_mfma_f32_16x16x32_bf16 v[148:151], a[112:115], a[36:39], v[148:151]
ds_read_b128 a[100:103], v5 offset:25600
v_mfma_f32_16x16x32_bf16 v[152:155], a[116:119], a[36:39], v[152:155]
buffer_load_dwordx4 a[24:27], v4, s[40:43], s35 offen offset:0 sc1
v_mfma_f32_16x16x32_bf16 v[136:139], a[116:119], a[32:35], v[136:139]
ds_read_b128 a[104:107], v5 offset:26624
v_mfma_f32_16x16x32_bf16 v[140:143], a[120:123], a[32:35], v[140:143]
ds_read_b128 a[108:111], v5 offset:27648
v_mfma_f32_16x16x32_bf16 v[156:159], a[120:123], a[36:39], v[156:159]
v_mfma_f32_16x16x32_bf16 v[160:163], a[124:127], a[36:39], v[160:163]
buffer_load_dwordx4 a[28:31], v4, s[40:43], s35 offen offset:1024 sc1
s_xor_b32 s35, s9, 86016
v_mfma_f32_16x16x32_bf16 v[144:147], a[124:127], a[32:35], v[144:147]
s_waitcnt vmcnt(10) lgkmcnt(4)
v_mfma_f32_16x16x32_bf16 v[132:135], a[128:131], a[40:43], v[132:135]
ds_read_b128 a[112:115], v5 offset:28672
v_mfma_f32_16x16x32_bf16 v[148:151], a[128:131], a[44:47], v[148:151]
ds_read_b128 a[116:119], v5 offset:29696
v_mfma_f32_16x16x32_bf16 v[152:155], a[132:135], a[44:47], v[152:155]
buffer_load_dwordx4 a[32:35], v4, s[40:43], s35 offen offset:0 sc1
v_mfma_f32_16x16x32_bf16 v[136:139], a[132:135], a[40:43], v[136:139]
ds_read_b128 a[120:123], v5 offset:30720
v_mfma_f32_16x16x32_bf16 v[140:143], a[136:139], a[40:43], v[140:143]
ds_read_b128 a[124:127], v5 offset:31744
v_mfma_f32_16x16x32_bf16 v[156:159], a[136:139], a[44:47], v[156:159]
v_mfma_f32_16x16x32_bf16 v[160:163], a[140:143], a[44:47], v[160:163]
buffer_load_dwordx4 a[36:39], v4, s[40:43], s35 offen offset:1024 sc1
s_xor_b32 s35, s9, 98304
v_mfma_f32_16x16x32_bf16 v[144:147], a[140:143], a[40:43], v[144:147]
s_waitcnt vmcnt(10) lgkmcnt(4)
v_mfma_f32_16x16x32_bf16 v[132:135], a[96:99], a[48:51], v[132:135]
ds_read_b128 a[128:131], v5 offset:32768
v_mfma_f32_16x16x32_bf16 v[148:151], a[96:99], a[52:55], v[148:151]
ds_read_b128 a[132:135], v5 offset:33792
v_mfma_f32_16x16x32_bf16 v[152:155], a[100:103], a[52:55], v[152:155]
buffer_load_dwordx4 a[40:43], v4, s[40:43], s35 offen offset:0 sc1
v_mfma_f32_16x16x32_bf16 v[136:139], a[100:103], a[48:51], v[136:139]
ds_read_b128 a[136:139], v5 offset:34816
v_mfma_f32_16x16x32_bf16 v[140:143], a[104:107], a[48:51], v[140:143]
ds_read_b128 a[140:143], v5 offset:35840
v_mfma_f32_16x16x32_bf16 v[156:159], a[104:107], a[52:55], v[156:159]
v_mfma_f32_16x16x32_bf16 v[160:163], a[108:111], a[52:55], v[160:163]
buffer_load_dwordx4 a[44:47], v4, s[40:43], s35 offen offset:1024 sc1
s_xor_b32 s35, s9, 102400
v_mfma_f32_16x16x32_bf16 v[144:147], a[108:111], a[48:51], v[144:147]
s_waitcnt vmcnt(10) lgkmcnt(4)
v_mfma_f32_16x16x32_bf16 v[132:135], a[112:115], a[0:3], v[132:135]
ds_read_b128 a[96:99], v5 offset:36864
v_mfma_f32_16x16x32_bf16 v[148:151], a[112:115], a[4:7], v[148:151]
ds_read_b128 a[100:103], v5 offset:37888
v_mfma_f32_16x16x32_bf16 v[152:155], a[116:119], a[4:7], v[152:155]
buffer_load_dwordx4 a[48:51], v4, s[40:43], s35 offen offset:0 sc1
v_mfma_f32_16x16x32_bf16 v[136:139], a[116:119], a[0:3], v[136:139]
ds_read_b128 a[104:107], v5 offset:38912
v_mfma_f32_16x16x32_bf16 v[140:143], a[120:123], a[0:3], v[140:143]
ds_read_b128 a[108:111], v5 offset:39936
v_mfma_f32_16x16x32_bf16 v[156:159], a[120:123], a[4:7], v[156:159]
v_mfma_f32_16x16x32_bf16 v[160:163], a[124:127], a[4:7], v[160:163]
buffer_load_dwordx4 a[52:55], v4, s[40:43], s35 offen offset:1024 sc1
s_xor_b32 s35, s9, 114688
v_mfma_f32_16x16x32_bf16 v[144:147], a[124:127], a[0:3], v[144:147]
s_waitcnt vmcnt(10) lgkmcnt(4)
v_mfma_f32_16x16x32_bf16 v[132:135], a[128:131], a[8:11], v[132:135]
ds_read_b128 a[112:115], v5 offset:40960
v_mfma_f32_16x16x32_bf16 v[148:151], a[128:131], a[12:15], v[148:151]
ds_read_b128 a[116:119], v5 offset:41984
v_mfma_f32_16x16x32_bf16 v[152:155], a[132:135], a[12:15], v[152:155]
buffer_load_dwordx4 a[0:3], v4, s[40:43], s35 offen offset:0 sc1
v_mfma_f32_16x16x32_bf16 v[136:139], a[132:135], a[8:11], v[136:139]
ds_read_b128 a[120:123], v5 offset:43008
v_mfma_f32_16x16x32_bf16 v[140:143], a[136:139], a[8:11], v[140:143]
ds_read_b128 a[124:127], v5 offset:44032
v_mfma_f32_16x16x32_bf16 v[156:159], a[136:139], a[12:15], v[156:159]
v_mfma_f32_16x16x32_bf16 v[160:163], a[140:143], a[12:15], v[160:163]
buffer_load_dwordx4 a[4:7], v4, s[40:43], s35 offen offset:1024 sc1
s_xor_b32 s35, s9, 118784
v_mfma_f32_16x16x32_bf16 v[144:147], a[140:143], a[8:11], v[144:147]
s_waitcnt vmcnt(10) lgkmcnt(4)
v_mfma_f32_16x16x32_bf16 v[132:135], a[96:99], a[16:19], v[132:135]
ds_read_b128 a[128:131], v5 offset:45056
v_mfma_f32_16x16x32_bf16 v[148:151], a[96:99], a[20:23], v[148:151]
ds_read_b128 a[132:135], v5 offset:46080
v_mfma_f32_16x16x32_bf16 v[152:155], a[100:103], a[20:23], v[152:155]
buffer_load_dwordx4 a[8:11], v4, s[40:43], s35 offen offset:0 sc1
v_mfma_f32_16x16x32_bf16 v[136:139], a[100:103], a[16:19], v[136:139]
ds_read_b128 a[136:139], v5 offset:47104
v_mfma_f32_16x16x32_bf16 v[140:143], a[104:107], a[16:19], v[140:143]
ds_read_b128 a[140:143], v5 offset:48128
v_mfma_f32_16x16x32_bf16 v[156:159], a[104:107], a[20:23], v[156:159]
v_mfma_f32_16x16x32_bf16 v[160:163], a[108:111], a[20:23], v[160:163]
buffer_load_dwordx4 a[12:15], v4, s[40:43], s35 offen offset:1024 sc1
s_xor_b32 s35, s9, 524288
v_mfma_f32_16x16x32_bf16 v[144:147], a[108:111], a[16:19], v[144:147]
s_waitcnt vmcnt(10) lgkmcnt(4)
v_mfma_f32_16x16x32_bf16 v[132:135], a[112:115], a[24:27], v[132:135]
ds_read_b128 a[96:99], v5 offset:49152
v_mfma_f32_16x16x32_bf16 v[148:151], a[112:115], a[28:31], v[148:151]
ds_read_b128 a[100:103], v5 offset:50176
v_mfma_f32_16x16x32_bf16 v[152:155], a[116:119], a[28:31], v[152:155]
buffer_load_dwordx4 a[16:19], v4, s[40:43], s35 offen offset:0 sc1
v_mfma_f32_16x16x32_bf16 v[136:139], a[116:119], a[24:27], v[136:139]
ds_read_b128 a[104:107], v5 offset:51200
v_mfma_f32_16x16x32_bf16 v[140:143], a[120:123], a[24:27], v[140:143]
ds_read_b128 a[108:111], v5 offset:52224
v_mfma_f32_16x16x32_bf16 v[156:159], a[120:123], a[28:31], v[156:159]
v_mfma_f32_16x16x32_bf16 v[160:163], a[124:127], a[28:31], v[160:163]
buffer_load_dwordx4 a[20:23], v4, s[40:43], s35 offen offset:1024 sc1
s_xor_b32 s35, s9, 528384
v_mfma_f32_16x16x32_bf16 v[144:147], a[124:127], a[24:27], v[144:147]
s_waitcnt vmcnt(10) lgkmcnt(4)
v_mfma_f32_16x16x32_bf16 v[132:135], a[128:131], a[32:35], v[132:135]
ds_read_b128 a[112:115], v5 offset:53248
v_mfma_f32_16x16x32_bf16 v[148:151], a[128:131], a[36:39], v[148:151]
ds_read_b128 a[116:119], v5 offset:54272
v_mfma_f32_16x16x32_bf16 v[152:155], a[132:135], a[36:39], v[152:155]
buffer_load_dwordx4 a[24:27], v4, s[40:43], s35 offen offset:0 sc1
v_mfma_f32_16x16x32_bf16 v[136:139], a[132:135], a[32:35], v[136:139]
ds_read_b128 a[120:123], v5 offset:55296
v_mfma_f32_16x16x32_bf16 v[140:143], a[136:139], a[32:35], v[140:143]
ds_read_b128 a[124:127], v5 offset:56320
v_mfma_f32_16x16x32_bf16 v[156:159], a[136:139], a[36:39], v[156:159]
v_mfma_f32_16x16x32_bf16 v[160:163], a[140:143], a[36:39], v[160:163]
buffer_load_dwordx4 a[28:31], v4, s[40:43], s35 offen offset:1024 sc1
s_xor_b32 s35, s9, 540672
v_mfma_f32_16x16x32_bf16 v[144:147], a[140:143], a[32:35], v[144:147]
s_waitcnt vmcnt(10) lgkmcnt(4)
v_mfma_f32_16x16x32_bf16 v[132:135], a[96:99], a[40:43], v[132:135]
ds_read_b128 a[128:131], v5 offset:57344
v_mfma_f32_16x16x32_bf16 v[148:151], a[96:99], a[44:47], v[148:151]
ds_read_b128 a[132:135], v5 offset:58368
v_mfma_f32_16x16x32_bf16 v[152:155], a[100:103], a[44:47], v[152:155]
buffer_load_dwordx4 a[32:35], v4, s[40:43], s35 offen offset:0 sc1
v_mfma_f32_16x16x32_bf16 v[136:139], a[100:103], a[40:43], v[136:139]
ds_read_b128 a[136:139], v5 offset:59392
v_mfma_f32_16x16x32_bf16 v[140:143], a[104:107], a[40:43], v[140:143]
ds_read_b128 a[140:143], v5 offset:60416
v_mfma_f32_16x16x32_bf16 v[156:159], a[104:107], a[44:47], v[156:159]
v_mfma_f32_16x16x32_bf16 v[160:163], a[108:111], a[44:47], v[160:163]
buffer_load_dwordx4 a[36:39], v4, s[40:43], s35 offen offset:1024 sc1
s_xor_b32 s35, s9, 544768
v_mfma_f32_16x16x32_bf16 v[144:147], a[108:111], a[40:43], v[144:147]
s_waitcnt vmcnt(10) lgkmcnt(4)
v_mfma_f32_16x16x32_bf16 v[132:135], a[112:115], a[48:51], v[132:135]
ds_read_b128 a[96:99], v5 offset:61440
v_mfma_f32_16x16x32_bf16 v[148:151], a[112:115], a[52:55], v[148:151]
ds_read_b128 a[100:103], v5 offset:62464
v_mfma_f32_16x16x32_bf16 v[152:155], a[116:119], a[52:55], v[152:155]
buffer_load_dwordx4 a[40:43], v4, s[40:43], s35 offen offset:0 sc1
v_mfma_f32_16x16x32_bf16 v[136:139], a[116:119], a[48:51], v[136:139]
ds_read_b128 a[104:107], v5 offset:63488
v_mfma_f32_16x16x32_bf16 v[140:143], a[120:123], a[48:51], v[140:143]
ds_read_b128 a[108:111], v5 offset:64512
v_mfma_f32_16x16x32_bf16 v[156:159], a[120:123], a[52:55], v[156:159]
v_mfma_f32_16x16x32_bf16 v[160:163], a[124:127], a[52:55], v[160:163]
buffer_load_dwordx4 a[44:47], v4, s[40:43], s35 offen offset:1024 sc1
s_xor_b32 s35, s9, 557056
v_mfma_f32_16x16x32_bf16 v[144:147], a[124:127], a[48:51], v[144:147]
s_waitcnt vmcnt(10) lgkmcnt(4)
v_mfma_f32_16x16x32_bf16 v[132:135], a[128:131], a[0:3], v[132:135]
ds_read_b128 a[112:115], v6 offset:0
v_mfma_f32_16x16x32_bf16 v[148:151], a[128:131], a[4:7], v[148:151]
ds_read_b128 a[116:119], v6 offset:1024
v_mfma_f32_16x16x32_bf16 v[152:155], a[132:135], a[4:7], v[152:155]
buffer_load_dwordx4 a[48:51], v4, s[40:43], s35 offen offset:0 sc1
v_mfma_f32_16x16x32_bf16 v[136:139], a[132:135], a[0:3], v[136:139]
ds_read_b128 a[120:123], v6 offset:2048
v_mfma_f32_16x16x32_bf16 v[140:143], a[136:139], a[0:3], v[140:143]
ds_read_b128 a[124:127], v6 offset:3072
v_mfma_f32_16x16x32_bf16 v[156:159], a[136:139], a[4:7], v[156:159]
v_mfma_f32_16x16x32_bf16 v[160:163], a[140:143], a[4:7], v[160:163]
buffer_load_dwordx4 a[52:55], v4, s[40:43], s35 offen offset:1024 sc1
s_xor_b32 s35, s9, 561152
v_mfma_f32_16x16x32_bf16 v[144:147], a[140:143], a[0:3], v[144:147]
s_waitcnt vmcnt(10) lgkmcnt(4)
v_mfma_f32_16x16x32_bf16 v[132:135], a[96:99], a[8:11], v[132:135]
ds_read_b128 a[128:131], v6 offset:4096
v_mfma_f32_16x16x32_bf16 v[148:151], a[96:99], a[12:15], v[148:151]
ds_read_b128 a[132:135], v6 offset:5120
v_mfma_f32_16x16x32_bf16 v[152:155], a[100:103], a[12:15], v[152:155]
buffer_load_dwordx4 a[0:3], v4, s[40:43], s35 offen offset:0 sc1
v_mfma_f32_16x16x32_bf16 v[136:139], a[100:103], a[8:11], v[136:139]
ds_read_b128 a[136:139], v6 offset:6144
v_mfma_f32_16x16x32_bf16 v[140:143], a[104:107], a[8:11], v[140:143]
ds_read_b128 a[140:143], v6 offset:7168
v_mfma_f32_16x16x32_bf16 v[156:159], a[104:107], a[12:15], v[156:159]
v_mfma_f32_16x16x32_bf16 v[160:163], a[108:111], a[12:15], v[160:163]
buffer_load_dwordx4 a[4:7], v4, s[40:43], s35 offen offset:1024 sc1
s_xor_b32 s35, s9, 573440
v_mfma_f32_16x16x32_bf16 v[144:147], a[108:111], a[8:11], v[144:147]
s_waitcnt vmcnt(10) lgkmcnt(4)
v_mfma_f32_16x16x32_bf16 v[132:135], a[112:115], a[16:19], v[132:135]
ds_read_b128 a[96:99], v6 offset:8192
v_mfma_f32_16x16x32_bf16 v[148:151], a[112:115], a[20:23], v[148:151]
ds_read_b128 a[100:103], v6 offset:9216
v_mfma_f32_16x16x32_bf16 v[152:155], a[116:119], a[20:23], v[152:155]
buffer_load_dwordx4 a[8:11], v4, s[40:43], s35 offen offset:0 sc1
v_mfma_f32_16x16x32_bf16 v[136:139], a[116:119], a[16:19], v[136:139]
ds_read_b128 a[104:107], v6 offset:10240
v_mfma_f32_16x16x32_bf16 v[140:143], a[120:123], a[16:19], v[140:143]
ds_read_b128 a[108:111], v6 offset:11264
v_mfma_f32_16x16x32_bf16 v[156:159], a[120:123], a[20:23], v[156:159]
v_mfma_f32_16x16x32_bf16 v[160:163], a[124:127], a[20:23], v[160:163]
buffer_load_dwordx4 a[12:15], v4, s[40:43], s35 offen offset:1024 sc1
s_xor_b32 s35, s9, 577536
v_mfma_f32_16x16x32_bf16 v[144:147], a[124:127], a[16:19], v[144:147]
s_waitcnt vmcnt(10) lgkmcnt(4)
v_mfma_f32_16x16x32_bf16 v[132:135], a[128:131], a[24:27], v[132:135]
ds_read_b128 a[112:115], v6 offset:12288
v_mfma_f32_16x16x32_bf16 v[148:151], a[128:131], a[28:31], v[148:151]
ds_read_b128 a[116:119], v6 offset:13312
v_mfma_f32_16x16x32_bf16 v[152:155], a[132:135], a[28:31], v[152:155]
buffer_load_dwordx4 a[16:19], v4, s[40:43], s35 offen offset:0 sc1
v_mfma_f32_16x16x32_bf16 v[136:139], a[132:135], a[24:27], v[136:139]
ds_read_b128 a[120:123], v6 offset:14336
v_mfma_f32_16x16x32_bf16 v[140:143], a[136:139], a[24:27], v[140:143]
ds_read_b128 a[124:127], v6 offset:15360
v_mfma_f32_16x16x32_bf16 v[156:159], a[136:139], a[28:31], v[156:159]
v_mfma_f32_16x16x32_bf16 v[160:163], a[140:143], a[28:31], v[160:163]
buffer_load_dwordx4 a[20:23], v4, s[40:43], s35 offen offset:1024 sc1
s_xor_b32 s35, s9, 589824
v_mfma_f32_16x16x32_bf16 v[144:147], a[140:143], a[24:27], v[144:147]
s_waitcnt vmcnt(10) lgkmcnt(4)
v_mfma_f32_16x16x32_bf16 v[132:135], a[96:99], a[32:35], v[132:135]
ds_read_b128 a[128:131], v6 offset:16384
v_mfma_f32_16x16x32_bf16 v[148:151], a[96:99], a[36:39], v[148:151]
ds_read_b128 a[132:135], v6 offset:17408
v_mfma_f32_16x16x32_bf16 v[152:155], a[100:103], a[36:39], v[152:155]
buffer_load_dwordx4 a[24:27], v4, s[40:43], s35 offen offset:0 sc1
v_mfma_f32_16x16x32_bf16 v[136:139], a[100:103], a[32:35], v[136:139]
ds_read_b128 a[136:139], v6 offset:18432
v_mfma_f32_16x16x32_bf16 v[140:143], a[104:107], a[32:35], v[140:143]
ds_read_b128 a[140:143], v6 offset:19456
v_mfma_f32_16x16x32_bf16 v[156:159], a[104:107], a[36:39], v[156:159]
v_mfma_f32_16x16x32_bf16 v[160:163], a[108:111], a[36:39], v[160:163]
buffer_load_dwordx4 a[28:31], v4, s[40:43], s35 offen offset:1024 sc1
s_xor_b32 s35, s9, 593920
v_mfma_f32_16x16x32_bf16 v[144:147], a[108:111], a[32:35], v[144:147]
s_waitcnt vmcnt(10) lgkmcnt(4)
v_mfma_f32_16x16x32_bf16 v[132:135], a[112:115], a[40:43], v[132:135]
ds_read_b128 a[96:99], v6 offset:20480
v_mfma_f32_16x16x32_bf16 v[148:151], a[112:115], a[44:47], v[148:151]
ds_read_b128 a[100:103], v6 offset:21504
v_mfma_f32_16x16x32_bf16 v[152:155], a[116:119], a[44:47], v[152:155]
buffer_load_dwordx4 a[32:35], v4, s[40:43], s35 offen offset:0 sc1
v_mfma_f32_16x16x32_bf16 v[136:139], a[116:119], a[40:43], v[136:139]
ds_read_b128 a[104:107], v6 offset:22528
v_mfma_f32_16x16x32_bf16 v[140:143], a[120:123], a[40:43], v[140:143]
ds_read_b128 a[108:111], v6 offset:23552
v_mfma_f32_16x16x32_bf16 v[156:159], a[120:123], a[44:47], v[156:159]
v_mfma_f32_16x16x32_bf16 v[160:163], a[124:127], a[44:47], v[160:163]
buffer_load_dwordx4 a[36:39], v4, s[40:43], s35 offen offset:1024 sc1
s_xor_b32 s35, s9, 606208
v_mfma_f32_16x16x32_bf16 v[144:147], a[124:127], a[40:43], v[144:147]
s_waitcnt vmcnt(10) lgkmcnt(4)
v_mfma_f32_16x16x32_bf16 v[132:135], a[128:131], a[48:51], v[132:135]
ds_read_b128 a[112:115], v6 offset:24576
v_mfma_f32_16x16x32_bf16 v[148:151], a[128:131], a[52:55], v[148:151]
ds_read_b128 a[116:119], v6 offset:25600
v_mfma_f32_16x16x32_bf16 v[152:155], a[132:135], a[52:55], v[152:155]
buffer_load_dwordx4 a[40:43], v4, s[40:43], s35 offen offset:0 sc1
v_mfma_f32_16x16x32_bf16 v[136:139], a[132:135], a[48:51], v[136:139]
ds_read_b128 a[120:123], v6 offset:26624
v_mfma_f32_16x16x32_bf16 v[140:143], a[136:139], a[48:51], v[140:143]
ds_read_b128 a[124:127], v6 offset:27648
v_mfma_f32_16x16x32_bf16 v[156:159], a[136:139], a[52:55], v[156:159]
v_mfma_f32_16x16x32_bf16 v[160:163], a[140:143], a[52:55], v[160:163]
buffer_load_dwordx4 a[44:47], v4, s[40:43], s35 offen offset:1024 sc1
s_xor_b32 s35, s9, 610304
v_mfma_f32_16x16x32_bf16 v[144:147], a[140:143], a[48:51], v[144:147]
s_waitcnt vmcnt(10) lgkmcnt(4)
v_mfma_f32_16x16x32_bf16 v[132:135], a[96:99], a[0:3], v[132:135]
ds_read_b128 a[128:131], v6 offset:28672
v_mfma_f32_16x16x32_bf16 v[148:151], a[96:99], a[4:7], v[148:151]
ds_read_b128 a[132:135], v6 offset:29696
v_mfma_f32_16x16x32_bf16 v[152:155], a[100:103], a[4:7], v[152:155]
buffer_load_dwordx4 a[48:51], v4, s[40:43], s35 offen offset:0 sc1
v_mfma_f32_16x16x32_bf16 v[136:139], a[100:103], a[0:3], v[136:139]
ds_read_b128 a[136:139], v6 offset:30720
v_mfma_f32_16x16x32_bf16 v[140:143], a[104:107], a[0:3], v[140:143]
ds_read_b128 a[140:143], v6 offset:31744
v_mfma_f32_16x16x32_bf16 v[156:159], a[104:107], a[4:7], v[156:159]
v_mfma_f32_16x16x32_bf16 v[160:163], a[108:111], a[4:7], v[160:163]
buffer_load_dwordx4 a[52:55], v4, s[40:43], s35 offen offset:1024 sc1
s_xor_b32 s35, s9, 622592
v_mfma_f32_16x16x32_bf16 v[144:147], a[108:111], a[0:3], v[144:147]
s_waitcnt vmcnt(10) lgkmcnt(4)
v_mfma_f32_16x16x32_bf16 v[132:135], a[112:115], a[8:11], v[132:135]
ds_read_b128 a[96:99], v6 offset:32768
v_mfma_f32_16x16x32_bf16 v[148:151], a[112:115], a[12:15], v[148:151]
ds_read_b128 a[100:103], v6 offset:33792
v_mfma_f32_16x16x32_bf16 v[152:155], a[116:119], a[12:15], v[152:155]
buffer_load_dwordx4 a[0:3], v4, s[40:43], s35 offen offset:0 sc1
v_mfma_f32_16x16x32_bf16 v[136:139], a[116:119], a[8:11], v[136:139]
ds_read_b128 a[104:107], v6 offset:34816
v_mfma_f32_16x16x32_bf16 v[140:143], a[120:123], a[8:11], v[140:143]
ds_read_b128 a[108:111], v6 offset:35840
v_mfma_f32_16x16x32_bf16 v[156:159], a[120:123], a[12:15], v[156:159]
v_mfma_f32_16x16x32_bf16 v[160:163], a[124:127], a[12:15], v[160:163]
buffer_load_dwordx4 a[4:7], v4, s[40:43], s35 offen offset:1024 sc1
s_xor_b32 s35, s9, 626688
v_mfma_f32_16x16x32_bf16 v[144:147], a[124:127], a[8:11], v[144:147]
s_waitcnt vmcnt(10) lgkmcnt(4)
v_mfma_f32_16x16x32_bf16 v[132:135], a[128:131], a[16:19], v[132:135]
ds_read_b128 a[112:115], v6 offset:36864
v_mfma_f32_16x16x32_bf16 v[148:151], a[128:131], a[20:23], v[148:151]
ds_read_b128 a[116:119], v6 offset:37888
v_mfma_f32_16x16x32_bf16 v[152:155], a[132:135], a[20:23], v[152:155]
buffer_load_dwordx4 a[8:11], v4, s[40:43], s35 offen offset:0 sc1
v_mfma_f32_16x16x32_bf16 v[136:139], a[132:135], a[16:19], v[136:139]
ds_read_b128 a[120:123], v6 offset:38912
v_mfma_f32_16x16x32_bf16 v[140:143], a[136:139], a[16:19], v[140:143]
ds_read_b128 a[124:127], v6 offset:39936
v_mfma_f32_16x16x32_bf16 v[156:159], a[136:139], a[20:23], v[156:159]
v_mfma_f32_16x16x32_bf16 v[160:163], a[140:143], a[20:23], v[160:163]
buffer_load_dwordx4 a[12:15], v4, s[40:43], s35 offen offset:1024 sc1
s_xor_b32 s35, s9, 638976
v_mfma_f32_16x16x32_bf16 v[144:147], a[140:143], a[16:19], v[144:147]
s_waitcnt vmcnt(10) lgkmcnt(4)
v_mfma_f32_16x16x32_bf16 v[132:135], a[96:99], a[24:27], v[132:135]
ds_read_b128 a[128:131], v6 offset:40960
v_mfma_f32_16x16x32_bf16 v[148:151], a[96:99], a[28:31], v[148:151]
ds_read_b128 a[132:135], v6 offset:41984
v_mfma_f32_16x16x32_bf16 v[152:155], a[100:103], a[28:31], v[152:155]
buffer_load_dwordx4 a[16:19], v4, s[40:43], s35 offen offset:0 sc1
v_mfma_f32_16x16x32_bf16 v[136:139], a[100:103], a[24:27], v[136:139]
ds_read_b128 a[136:139], v6 offset:43008
v_mfma_f32_16x16x32_bf16 v[140:143], a[104:107], a[24:27], v[140:143]
ds_read_b128 a[140:143], v6 offset:44032
v_mfma_f32_16x16x32_bf16 v[156:159], a[104:107], a[28:31], v[156:159]
v_mfma_f32_16x16x32_bf16 v[160:163], a[108:111], a[28:31], v[160:163]
buffer_load_dwordx4 a[20:23], v4, s[40:43], s35 offen offset:1024 sc1
s_xor_b32 s35, s9, 643072
v_mfma_f32_16x16x32_bf16 v[144:147], a[108:111], a[24:27], v[144:147]
s_waitcnt vmcnt(10) lgkmcnt(4)
v_mfma_f32_16x16x32_bf16 v[132:135], a[112:115], a[32:35], v[132:135]
ds_read_b128 a[96:99], v6 offset:45056
v_mfma_f32_16x16x32_bf16 v[148:151], a[112:115], a[36:39], v[148:151]
ds_read_b128 a[100:103], v6 offset:46080
v_mfma_f32_16x16x32_bf16 v[152:155], a[116:119], a[36:39], v[152:155]
buffer_load_dwordx4 a[24:27], v4, s[40:43], s35 offen offset:0 sc1
v_mfma_f32_16x16x32_bf16 v[136:139], a[116:119], a[32:35], v[136:139]
ds_read_b128 a[104:107], v6 offset:47104
v_mfma_f32_16x16x32_bf16 v[140:143], a[120:123], a[32:35], v[140:143]
ds_read_b128 a[108:111], v6 offset:48128
v_mfma_f32_16x16x32_bf16 v[156:159], a[120:123], a[36:39], v[156:159]
v_mfma_f32_16x16x32_bf16 v[160:163], a[124:127], a[36:39], v[160:163]
buffer_load_dwordx4 a[28:31], v4, s[40:43], s35 offen offset:1024 sc1
s_xor_b32 s35, s9, 0
v_mfma_f32_16x16x32_bf16 v[144:147], a[124:127], a[32:35], v[144:147]
s_waitcnt vmcnt(10) lgkmcnt(4)
v_mfma_f32_16x16x32_bf16 v[132:135], a[128:131], a[40:43], v[132:135]
ds_read_b128 a[112:115], v6 offset:49152
v_mfma_f32_16x16x32_bf16 v[148:151], a[128:131], a[44:47], v[148:151]
ds_read_b128 a[116:119], v6 offset:50176
v_mfma_f32_16x16x32_bf16 v[152:155], a[132:135], a[44:47], v[152:155]
ds_read_b128 a[120:123], v6 offset:51200
v_mfma_f32_16x16x32_bf16 v[136:139], a[132:135], a[40:43], v[136:139]
ds_read_b128 a[124:127], v6 offset:52224
v_mfma_f32_16x16x32_bf16 v[140:143], a[136:139], a[40:43], v[140:143]
v_mfma_f32_16x16x32_bf16 v[156:159], a[136:139], a[44:47], v[156:159]
v_mfma_f32_16x16x32_bf16 v[160:163], a[140:143], a[44:47], v[160:163]
v_mfma_f32_16x16x32_bf16 v[144:147], a[140:143], a[40:43], v[144:147]
s_waitcnt vmcnt(8) lgkmcnt(4)
v_mfma_f32_16x16x32_bf16 v[132:135], a[96:99], a[48:51], v[132:135]
ds_read_b128 a[128:131], v6 offset:53248
v_mfma_f32_16x16x32_bf16 v[148:151], a[96:99], a[52:55], v[148:151]
ds_read_b128 a[132:135], v6 offset:54272
v_mfma_f32_16x16x32_bf16 v[152:155], a[100:103], a[52:55], v[152:155]
ds_read_b128 a[136:139], v6 offset:55296
v_mfma_f32_16x16x32_bf16 v[136:139], a[100:103], a[48:51], v[136:139]
ds_read_b128 a[140:143], v6 offset:56320
v_mfma_f32_16x16x32_bf16 v[140:143], a[104:107], a[48:51], v[140:143]
v_mfma_f32_16x16x32_bf16 v[156:159], a[104:107], a[52:55], v[156:159]
v_mfma_f32_16x16x32_bf16 v[160:163], a[108:111], a[52:55], v[160:163]
v_mfma_f32_16x16x32_bf16 v[144:147], a[108:111], a[48:51], v[144:147]
s_waitcnt vmcnt(6) lgkmcnt(4)
v_mfma_f32_16x16x32_bf16 v[132:135], a[112:115], a[0:3], v[132:135]
ds_read_b128 a[96:99], v6 offset:57344
v_mfma_f32_16x16x32_bf16 v[148:151], a[112:115], a[4:7], v[148:151]
ds_read_b128 a[100:103], v6 offset:58368
v_mfma_f32_16x16x32_bf16 v[152:155], a[116:119], a[4:7], v[152:155]
ds_read_b128 a[104:107], v6 offset:59392
v_mfma_f32_16x16x32_bf16 v[136:139], a[116:119], a[0:3], v[136:139]
ds_read_b128 a[108:111], v6 offset:60416
v_mfma_f32_16x16x32_bf16 v[140:143], a[120:123], a[0:3], v[140:143]
v_mfma_f32_16x16x32_bf16 v[156:159], a[120:123], a[4:7], v[156:159]
v_mfma_f32_16x16x32_bf16 v[160:163], a[124:127], a[4:7], v[160:163]
v_mfma_f32_16x16x32_bf16 v[144:147], a[124:127], a[0:3], v[144:147]
s_waitcnt vmcnt(4) lgkmcnt(4)
v_mfma_f32_16x16x32_bf16 v[132:135], a[128:131], a[8:11], v[132:135]
ds_read_b128 a[112:115], v6 offset:61440
v_mfma_f32_16x16x32_bf16 v[148:151], a[128:131], a[12:15], v[148:151]
ds_read_b128 a[116:119], v6 offset:62464
v_mfma_f32_16x16x32_bf16 v[152:155], a[132:135], a[12:15], v[152:155]
ds_read_b128 a[120:123], v6 offset:63488
v_mfma_f32_16x16x32_bf16 v[136:139], a[132:135], a[8:11], v[136:139]
ds_read_b128 a[124:127], v6 offset:64512
v_mfma_f32_16x16x32_bf16 v[140:143], a[136:139], a[8:11], v[140:143]
v_mfma_f32_16x16x32_bf16 v[156:159], a[136:139], a[12:15], v[156:159]
v_mfma_f32_16x16x32_bf16 v[160:163], a[140:143], a[12:15], v[160:163]
v_mfma_f32_16x16x32_bf16 v[144:147], a[140:143], a[8:11], v[144:147]
s_waitcnt vmcnt(2) lgkmcnt(4)
v_mfma_f32_16x16x32_bf16 v[132:135], a[96:99], a[16:19], v[132:135]
v_mfma_f32_16x16x32_bf16 v[148:151], a[96:99], a[20:23], v[148:151]
v_mfma_f32_16x16x32_bf16 v[152:155], a[100:103], a[20:23], v[152:155]
v_mfma_f32_16x16x32_bf16 v[136:139], a[100:103], a[16:19], v[136:139]
v_mfma_f32_16x16x32_bf16 v[140:143], a[104:107], a[16:19], v[140:143]
v_mfma_f32_16x16x32_bf16 v[156:159], a[104:107], a[20:23], v[156:159]
v_mfma_f32_16x16x32_bf16 v[160:163], a[108:111], a[20:23], v[160:163]
v_mfma_f32_16x16x32_bf16 v[144:147], a[108:111], a[16:19], v[144:147]
s_waitcnt vmcnt(0) lgkmcnt(0)
v_mfma_f32_16x16x32_bf16 v[132:135], a[112:115], a[24:27], v[132:135]
v_mfma_f32_16x16x32_bf16 v[148:151], a[112:115], a[28:31], v[148:151]
v_mfma_f32_16x16x32_bf16 v[152:155], a[116:119], a[28:31], v[152:155]
v_mfma_f32_16x16x32_bf16 v[136:139], a[116:119], a[24:27], v[136:139]
v_mfma_f32_16x16x32_bf16 v[140:143], a[120:123], a[24:27], v[140:143]
v_mfma_f32_16x16x32_bf16 v[156:159], a[120:123], a[28:31], v[156:159]
v_mfma_f32_16x16x32_bf16 v[160:163], a[124:127], a[28:31], v[160:163]
v_mfma_f32_16x16x32_bf16 v[144:147], a[124:127], a[24:27], v[144:147]
s_nop 1
v_cmp_u_f32 vcc, v132, v148
s_nop 0
s_and_b32 vcc_lo, vcc_lo, s95
s_cbranch_scc1 L_k2redo3
v_cvt_pk_bf16_f32 v32, v132, v133
v_cvt_pk_bf16_f32 v33, v134, v135
v_cvt_pk_bf16_f32 v34, v136, v137
v_cvt_pk_bf16_f32 v35, v138, v139
v_cvt_pk_bf16_f32 v36, v140, v141
v_cvt_pk_bf16_f32 v37, v142, v143
v_cvt_pk_bf16_f32 v38, v144, v145
v_cvt_pk_bf16_f32 v39, v146, v147
ds_write_b128 v236, v[32:35] offset:0
s_add_u32 s36, s88, 0
v_cvt_pk_bf16_f32 v40, v148, v149
v_cvt_pk_bf16_f32 v41, v150, v151
v_cvt_pk_bf16_f32 v42, v152, v153
ds_write_b128 v237, v[36:39] offset:0
v_cvt_pk_bf16_f32 v43, v154, v155
v_cvt_pk_bf16_f32 v44, v156, v157
v_cvt_pk_bf16_f32 v45, v158, v159
v_cvt_pk_bf16_f32 v46, v160, v161
v_cvt_pk_bf16_f32 v47, v162, v163
s_add_u32 s37, s88, 32768
s_add_u32 s38, s88, 65536
s_add_u32 s39, s88, 98304
ds_read_b128 v[92:95], v238 offset:0
ds_read_b128 v[96:99], v238 offset:1024
ds_write_b128 v236, v[40:43] offset:2048
ds_write_b128 v237, v[44:47] offset:2048
s_waitcnt lgkmcnt(3)
buffer_store_dwordx4 v[92:95], v239, s[12:15], s36 offen sc1
ds_read_b128 v[100:103], v238 offset:2048
ds_read_b128 v[104:107], v238 offset:3072
s_waitcnt lgkmcnt(4)
buffer_store_dwordx4 v[96:99], v239, s[12:15], s37 offen sc1
s_waitcnt lgkmcnt(1)
buffer_store_dwordx4 v[100:103], v239, s[12:15], s38 offen sc1
s_waitcnt lgkmcnt(0)
buffer_store_dwordx4 v[104:107], v239, s[12:15], s39 offen sc1
s_or_b32 s36, s2, s28
s_cbranch_scc1 Lep_51
s_mov_b32 s36, 0xf0000
buffer_store_dword v15, off, s[4:7], s36 sc1
Lep_51:
L_end:
s_endpgm
L_rfix:
s_mov_b32 s37, 0
L_rfixb:
s_cmp_lg_u32 s36, 0
s_cbranch_scc1 L_rfixc
s_sleep 2
buffer_load_dword v245, off, s[24:27], 0 offset:252 sc1
s_add_u32 s37, s37, 1
s_waitcnt vmcnt(0)
v_readfirstlane_b32 s36, v245
s_cmp_lt_u32 s37, 0x100000
s_cbranch_scc1 L_rfixb
s_branch L_rok
L_rfixc:
s_cmp_eq_u32 s36, s3
s_cbranch_scc1 L_rok
s_mov_b32 s3, s36
s_waitcnt vmcnt(0)
s_load_dwordx16 s[64:79], s[0:1], 0
s_load_dwordx4 s[80:83], s[0:1], 64
s_waitcnt lgkmcnt(0)
s_branch L_roles
Ltal_6:
s_mov_b32 s53, 0
Ltal_6b:
s_sleep 8
buffer_load_dword v11, v1, s[24:27], 0 offen sc1
s_add_u32 s53, s53, 1
s_waitcnt vmcnt(0)
v_cmp_gt_u32 vcc, 0x100000, v11
s_nop 0
s_and_b32 vcc_lo, vcc_lo, 0x1f3f
s_cbranch_scc0 Ltab_7
s_cmp_lt_u32 s53, 0x100000
s_cbranch_scc1 Ltal_6b
s_branch Ltab_7
L_hxredo0:
s_mov_b32 s37, 0
L_hxredo0b:
s_sleep 2
buffer_load_dwordx4 v[228:231], v9, s[4:7], s55 offen sc1
buffer_load_dwordx4 v[72:75], v9, s[4:7], s55 offen offset:1024 sc1
s_waitcnt vmcnt(1)
v_max3_u32 v244, v228, v229, v230
s_waitcnt vmcnt(0)
v_max3_u32 v244, v244, v231, v72
v_max3_u32 v244, v244, v73, v74
v_max_u32 v244, v244, v75
v_cmp_eq_u32 vcc, -1, v244
s_cbranch_vccz L_hxback0
s_add_u32 s37, s37, 1
s_cmp_lt_u32 s37, 0x100000
s_cbranch_scc1 L_hxredo0b
s_branch L_hxback0
Ltr_13:
s_add_u32 s52, s67, 0xe0000
s_mov_b32 s53, 0
Ltp_14:
s_sleep 2
v_mov_b32 v11, v15
s_mov_b64 exec, 0xffff
v_mov_b32 v11, 0
buffer_atomic_add v11, v255, s[4:7], s52 offen sc0 sc1
s_mov_b64 exec, -1
s_add_u32 s53, s53, 1
s_waitcnt vmcnt(0)
v_cmp_ne_u32 vcc, v11, v15
s_cbranch_vccz Lte_15
s_cmp_lt_u32 s53, 0x100000
s_cbranch_scc1 Ltp_14
s_branch Lte_15
Ltr_16:
s_add_u32 s52, s66, 0xd0040
s_mov_b32 s53, 0
Ltp_17:
s_sleep 2
v_mov_b32 v232, v15
s_mov_b64 exec, 0xffff
v_mov_b32 v232, 0
buffer_atomic_add v232, v255, s[4:7], s52 offen sc0 sc1
s_mov_b64 exec, -1
s_add_u32 s53, s53, 1
s_waitcnt vmcnt(0)
v_cmp_ne_u32 vcc, v232, v15
s_cbranch_vccz Lte_18
s_cmp_lt_u32 s53, 0x100000
s_cbranch_scc1 Ltp_17
s_branch Lte_18
L_kvredo1:
s_mov_b32 s88, 0
L_kvredo1b:
v_max_u32 v132, v48, v49
v_max3_u32 v132, v132, v50, v51
v_max3_u32 v132, v132, v52, v53
v_max3_u32 v132, v132, v54, v55
v_max3_u32 v132, v132, v56, v57
v_max3_u32 v132, v132, v58, v59
v_max3_u32 v132, v132, v60, v61
v_max3_u32 v132, v132, v62, v63
v_max3_u32 v132, v132, v64, v65
v_max3_u32 v132, v132, v66, v67
v_max3_u32 v132, v132, v68, v69
v_max3_u32 v132, v132, v70, v71
v_max3_u32 v132, v132, v100, v101
v_max3_u32 v132, v132, v102, v103
v_max3_u32 v132, v132, v104, v105
v_max3_u32 v132, v132, v106, v107
v_max3_u32 v132, v132, v124, v125
v_max3_u32 v132, v132, v126, v127
v_cmp_eq_u32 vcc, -1, v132
s_cbranch_vccz L_kvback1
s_add_u32 s88, s88, 1
s_cmp_gt_u32 s88, 0x80000
s_cbranch_scc1 L_kvback1
s_sleep 4
buffer_load_dwordx4 v[48:51], v1, s[4:7], s98 offen offset:0 sc1
buffer_load_dwordx4 v[124:127], v248, s[4:7], s100 offen sc1
buffer_load_dwordx4 v[52:55], v1, s[4:7], s98 offen offset:1024 sc1
buffer_load_dwordx4 v[56:59], v1, s[4:7], s98 offen offset:2048 sc1
buffer_load_dwordx4 v[60:63], v1, s[4:7], s98 offen offset:3072 sc1
buffer_load_dwordx4 v[64:67], v1, s[4:7], s99 offen offset:0 sc1
buffer_load_dwordx4 v[68:71], v1, s[4:7], s99 offen offset:1024 sc1
buffer_load_dwordx4 v[100:103], v1, s[4:7], s99 offen offset:2048 sc1
buffer_load_dwordx4 v[104:107], v1, s[4:7], s99 offen offset:3072 sc1
s_waitcnt vmcnt(8)
v_lshlrev_b32 v92, 16, v48
v_and_b32 v93, 0xffff0000, v48
v_lshlrev_b32 v94, 16, v49
v_and_b32 v95, 0xffff0000, v49
v_lshlrev_b32 v96, 16, v50
v_and_b32 v97, 0xffff0000, v50
v_lshlrev_b32 v98, 16, v51
v_and_b32 v99, 0xffff0000, v51
s_waitcnt vmcnt(7)
v_add_f32_dpp v128, v124, v124 row_ror:4 row_mask:0xf bank_mask:0xf
v_add_f32_dpp v129, v125, v125 row_ror:4 row_mask:0xf bank_mask:0xf
v_add_f32_dpp v130, v126, v126 row_ror:4 row_mask:0xf bank_mask:0xf
v_add_f32_dpp v131, v127, v127 row_ror:4 row_mask:0xf bank_mask:0xf
v_add_f32_dpp v128, v128, v128 row_ror:2 row_mask:0xf bank_mask:0xf
v_add_f32_dpp v129, v129, v129 row_ror:2 row_mask:0xf bank_mask:0xf
v_add_f32_dpp v130, v130, v130 row_ror:2 row_mask:0xf bank_mask:0xf
v_add_f32_dpp v131, v131, v131 row_ror:2 row_mask:0xf bank_mask:0xf
v_add_f32_dpp v128, v128, v128 row_ror:1 row_mask:0xf bank_mask:0xf
v_add_f32_dpp v129, v129, v129 row_ror:1 row_mask:0xf bank_mask:0xf
v_add_f32_dpp v130, v130, v130 row_ror:1 row_mask:0xf bank_mask:0xf
v_add_f32_dpp v131, v131, v131 row_ror:1 row_mask:0xf bank_mask:0xf
s_waitcnt vmcnt(6)
v_dot2c_f32_bf16 v92, v52, v249
v_dot2c_f32_bf16 v93, v52, v250
v_dot2c_f32_bf16 v94, v53, v249
v_dot2c_f32_bf16 v95, v53, v250
v_dot2c_f32_bf16 v96, v54, v249
v_dot2c_f32_bf16 v97, v54, v250
v_dot2c_f32_bf16 v98, v55, v249
v_dot2c_f32_bf16 v99, v55, v250
s_waitcnt vmcnt(5)
v_dot2c_f32_bf16 v92, v56, v249
v_dot2c_f32_bf16 v93, v56, v250
v_dot2c_f32_bf16 v94, v57, v249
v_dot2c_f32_bf16 v95, v57, v250
v_dot2c_f32_bf16 v96, v58, v249
v_dot2c_f32_bf16 v97, v58, v250
v_dot2c_f32_bf16 v98, v59, v249
v_dot2c_f32_bf16 v99, v59, v250
s_waitcnt vmcnt(4)
v_dot2c_f32_bf16 v92, v60, v249
v_dot2c_f32_bf16 v93, v60, v250
v_dot2c_f32_bf16 v94, v61, v249
v_dot2c_f32_bf16 v95, v61, v250
v_dot2c_f32_bf16 v96, v62, v249
v_dot2c_f32_bf16 v97, v62, v250
v_dot2c_f32_bf16 v98, v63, v249
v_dot2c_f32_bf16 v99, v63, v250
s_waitcnt vmcnt(3)
v_dot2c_f32_bf16 v92, v64, v249
v_dot2c_f32_bf16 v93, v64, v250
v_dot2c_f32_bf16 v94, v65, v249
v_dot2c_f32_bf16 v95, v65, v250
v_dot2c_f32_bf16 v96, v66, v249
v_dot2c_f32_bf16 v97, v66, v250
v_dot2c_f32_bf16 v98, v67, v249
v_dot2c_f32_bf16 v99, v67, v250
s_waitcnt vmcnt(2)
v_dot2c_f32_bf16 v92, v68, v249
v_dot2c_f32_bf16 v93, v68, v250
v_dot2c_f32_bf16 v94, v69, v249
v_dot2c_f32_bf16 v95, v69, v250
v_dot2c_f32_bf16 v96, v70, v249
v_dot2c_f32_bf16 v97, v70, v250
v_dot2c_f32_bf16 v98, v71, v249
v_dot2c_f32_bf16 v99, v71, v250
s_waitcnt vmcnt(1)
v_dot2c_f32_bf16 v92, v100, v249
v_dot2c_f32_bf16 v93, v100, v250
v_dot2c_f32_bf16 v94, v101, v249
v_dot2c_f32_bf16 v95, v101, v250
v_dot2c_f32_bf16 v96, v102, v249
v_dot2c_f32_bf16 v97, v102, v250
v_dot2c_f32_bf16 v98, v103, v249
v_dot2c_f32_bf16 v99, v103, v250
s_waitcnt vmcnt(0)
v_dot2c_f32_bf16 v92, v104, v249
v_dot2c_f32_bf16 v93, v104, v250
v_dot2c_f32_bf16 v94, v105, v249
v_dot2c_f32_bf16 v95, v105, v250
v_dot2c_f32_bf16 v96, v106, v249
v_dot2c_f32_bf16 v97, v106, v250
v_dot2c_f32_bf16 v98, v107, v249
v_dot2c_f32_bf16 v99, v107, v250
s_nop 2
s_branch L_kvredo1b
L_k2redo1:
s_mov_b32 s95, 0
s_mov_b32 s92, 0x40000000
s_mov_b32 s93, 0x40000000
s_mov_b32 s94, 0x40000000
s_mov_b32 s37, 0
L_k2redo1a:
s_sleep 4
v_mov_b32 v108, 0
s_mov_b32 s36, 0
L_k2redo1b:
s_lshr_b32 s39, s36, 3
s_mul_i32 s39, s39, 524288
s_and_b32 s38, s36, 7
s_lshl_b32 s38, s38, 14
s_add_u32 s38, s38, s39
s_xor_b32 s38, s38, s9
s_add_u32 s39, s38, 4096
buffer_load_dwordx4 v[92:95], v4, s[40:43], s38 offen offset:0 sc1
buffer_load_dwordx4 v[96:99], v4, s[40:43], s38 offen offset:1024 sc1
buffer_load_dwordx4 v[100:103], v4, s[40:43], s39 offen offset:0 sc1
buffer_load_dwordx4 v[104:107], v4, s[40:43], s39 offen offset:1024 sc1
s_waitcnt vmcnt(3)
v_max3_u32 v108, v108, v92, v93
v_max3_u32 v108, v108, v94, v95
s_waitcnt vmcnt(2)
v_max3_u32 v108, v108, v96, v97
v_max3_u32 v108, v108, v98, v99
s_waitcnt vmcnt(1)
v_max3_u32 v108, v108, v100, v101
v_max3_u32 v108, v108, v102, v103
s_waitcnt vmcnt(0)
v_max3_u32 v108, v108, v104, v105
v_max3_u32 v108, v108, v106, v107
s_add_u32 s36, s36, 1
s_cmp_lt_u32 s36, 16
s_cbranch_scc1 L_k2redo1b
v_cmp_eq_u32 vcc, -1, v108
s_cbranch_vccz L_k2redo1c
s_add_u32 s37, s37, 1
s_cmp_lt_u32 s37, 0x8000
s_cbranch_scc1 L_k2redo1a
L_k2redo1c:
s_nop 7
s_mov_b32 s35, s9
v_lshlrev_b32 v132, 16, v32
v_and_b32 v133, 0xffff0000, v32
v_lshlrev_b32 v134, 16, v33
v_and_b32 v135, 0xffff0000, v33
v_lshlrev_b32 v136, 16, v34
v_and_b32 v137, 0xffff0000, v34
v_lshlrev_b32 v138, 16, v35
v_and_b32 v139, 0xffff0000, v35
v_lshlrev_b32 v140, 16, v36
v_and_b32 v141, 0xffff0000, v36
v_lshlrev_b32 v142, 16, v37
v_and_b32 v143, 0xffff0000, v37
v_lshlrev_b32 v144, 16, v38
v_and_b32 v145, 0xffff0000, v38
v_lshlrev_b32 v146, 16, v39
v_and_b32 v147, 0xffff0000, v39
v_lshlrev_b32 v148, 16, v40
v_and_b32 v149, 0xffff0000, v40
v_lshlrev_b32 v150, 16, v41
v_and_b32 v151, 0xffff0000, v41
v_lshlrev_b32 v152, 16, v42
v_and_b32 v153, 0xffff0000, v42
v_lshlrev_b32 v154, 16, v43
v_and_b32 v155, 0xffff0000, v43
v_lshlrev_b32 v156, 16, v44
v_and_b32 v157, 0xffff0000, v44
v_lshlrev_b32 v158, 16, v45
v_and_b32 v159, 0xffff0000, v45
v_lshlrev_b32 v160, 16, v46
v_and_b32 v161, 0xffff0000, v46
v_lshlrev_b32 v162, 16, v47
v_and_b32 v163, 0xffff0000, v47
s_branch L_k2go1
L_hxredo2:
s_mov_b32 s37, 0
L_hxredo2b:
s_sleep 2
buffer_load_dwordx4 v[228:231], v9, s[4:7], s55 offen sc1
buffer_load_dwordx4 v[72:75], v9, s[4:7], s55 offen offset:1024 sc1
s_waitcnt vmcnt(1)
v_max3_u32 v244, v228, v229, v230
s_waitcnt vmcnt(0)
v_max3_u32 v244, v244, v231, v72
v_max3_u32 v244, v244, v73, v74
v_max_u32 v244, v244, v75
v_cmp_eq_u32 vcc, -1, v244
s_cbranch_vccz L_hxback2
s_add_u32 s37, s37, 1
s_cmp_lt_u32 s37, 0x100000
s_cbranch_scc1 L_hxredo2b
s_branch L_hxback2
L_k2redo2:
s_mov_b32 s95, 0
s_mov_b32 s92, 0x40000000
s_mov_b32 s93, 0x40000000
s_mov_b32 s94, 0x40000000
s_mov_b32 s37, 0
L_k2redo2a:
s_sleep 4
v_mov_b32 v108, 0
s_mov_b32 s36, 0
L_k2redo2b:
s_lshr_b32 s39, s36, 3
s_mul_i32 s39, s39, 524288
s_and_b32 s38, s36, 7
s_lshl_b32 s38, s38, 14
s_add_u32 s38, s38, s39
s_xor_b32 s38, s38, s77
s_add_u32 s39, s38, 4096
buffer_load_dwordx4 v[92:95], v4, s[40:43], s38 offen offset:0 sc1
buffer_load_dwordx4 v[96:99], v4, s[40:43], s38 offen offset:1024 sc1
buffer_load_dwordx4 v[100:103], v4, s[40:43], s39 offen offset:0 sc1
buffer_load_dwordx4 v[104:107], v4, s[40:43], s39 offen offset:1024 sc1
s_waitcnt vmcnt(3)
v_max3_u32 v108, v108, v92, v93
v_max3_u32 v108, v108, v94, v95
s_waitcnt vmcnt(2)
v_max3_u32 v108, v108, v96, v97
v_max3_u32 v108, v108, v98, v99
s_waitcnt vmcnt(1)
v_max3_u32 v108, v108, v100, v101
v_max3_u32 v108, v108, v102, v103
s_waitcnt vmcnt(0)
v_max3_u32 v108, v108, v104, v105
v_max3_u32 v108, v108, v106, v107
s_add_u32 s36, s36, 1
s_cmp_lt_u32 s36, 16
s_cbranch_scc1 L_k2redo2b
v_cmp_eq_u32 vcc, -1, v108
s_cbranch_vccz L_k2redo2c
s_add_u32 s37, s37, 1
s_cmp_lt_u32 s37, 0x8000
s_cbranch_scc1 L_k2redo2a
L_k2redo2c:
s_nop 7
s_mov_b32 s35, s77
v_lshlrev_b32 v132, 16, v32
v_and_b32 v133, 0xffff0000, v32
v_lshlrev_b32 v134, 16, v33
v_and_b32 v135, 0xffff0000, v33
v_lshlrev_b32 v136, 16, v34
v_and_b32 v137, 0xffff0000, v34
v_lshlrev_b32 v138, 16, v35
v_and_b32 v139, 0xffff0000, v35
v_lshlrev_b32 v140, 16, v36
v_and_b32 v141, 0xffff0000, v36
v_lshlrev_b32 v142, 16, v37
v_and_b32 v143, 0xffff0000, v37
v_lshlrev_b32 v144, 16, v38
v_and_b32 v145, 0xffff0000, v38
v_lshlrev_b32 v146, 16, v39
v_and_b32 v147, 0xffff0000, v39
v_lshlrev_b32 v148, 16, v40
v_and_b32 v149, 0xffff0000, v40
v_lshlrev_b32 v150, 16, v41
v_and_b32 v151, 0xffff0000, v41
v_lshlrev_b32 v152, 16, v42
v_and_b32 v153, 0xffff0000, v42
v_lshlrev_b32 v154, 16, v43
v_and_b32 v155, 0xffff0000, v43
v_lshlrev_b32 v156, 16, v44
v_and_b32 v157, 0xffff0000, v44
v_lshlrev_b32 v158, 16, v45
v_and_b32 v159, 0xffff0000, v45
v_lshlrev_b32 v160, 16, v46
v_and_b32 v161, 0xffff0000, v46
v_lshlrev_b32 v162, 16, v47
v_and_b32 v163, 0xffff0000, v47
s_branch L_k2go2
L_kvredo3:
s_mov_b32 s88, 0
L_kvredo3b:
v_max_u32 v132, v48, v49
v_max3_u32 v132, v132, v50, v51
v_max3_u32 v132, v132, v52, v53
v_max3_u32 v132, v132, v54, v55
v_max3_u32 v132, v132, v56, v57
v_max3_u32 v132, v132, v58, v59
v_max3_u32 v132, v132, v60, v61
v_max3_u32 v132, v132, v62, v63
v_max3_u32 v132, v132, v64, v65
v_max3_u32 v132, v132, v66, v67
v_max3_u32 v132, v132, v68, v69
v_max3_u32 v132, v132, v70, v71
v_max3_u32 v132, v132, v100, v101
v_max3_u32 v132, v132, v102, v103
v_max3_u32 v132, v132, v104, v105
v_max3_u32 v132, v132, v106, v107
v_max3_u32 v132, v132, v124, v125
v_max3_u32 v132, v132, v126, v127
v_cmp_eq_u32 vcc, -1, v132
s_cbranch_vccz L_kvback3
s_add_u32 s88, s88, 1
s_cmp_gt_u32 s88, 0x80000
s_cbranch_scc1 L_kvback3
s_sleep 4
buffer_load_dwordx4 v[48:51], v1, s[4:7], s98 offen offset:0 sc1
buffer_load_dwordx4 v[124:127], v248, s[4:7], s100 offen sc1
buffer_load_dwordx4 v[52:55], v1, s[4:7], s98 offen offset:1024 sc1
buffer_load_dwordx4 v[56:59], v1, s[4:7], s98 offen offset:2048 sc1
buffer_load_dwordx4 v[60:63], v1, s[4:7], s98 offen offset:3072 sc1
buffer_load_dwordx4 v[64:67], v1, s[4:7], s99 offen offset:0 sc1
buffer_load_dwordx4 v[68:71], v1, s[4:7], s99 offen offset:1024 sc1
buffer_load_dwordx4 v[100:103], v1, s[4:7], s99 offen offset:2048 sc1
buffer_load_dwordx4 v[104:107], v1, s[4:7], s99 offen offset:3072 sc1
s_waitcnt vmcnt(8)
v_lshlrev_b32 v92, 16, v48
v_and_b32 v93, 0xffff0000, v48
v_lshlrev_b32 v94, 16, v49
v_and_b32 v95, 0xffff0000, v49
v_lshlrev_b32 v96, 16, v50
v_and_b32 v97, 0xffff0000, v50
v_lshlrev_b32 v98, 16, v51
v_and_b32 v99, 0xffff0000, v51
s_waitcnt vmcnt(7)
v_add_f32_dpp v128, v124, v124 row_ror:4 row_mask:0xf bank_mask:0xf
v_add_f32_dpp v129, v125, v125 row_ror:4 row_mask:0xf bank_mask:0xf
v_add_f32_dpp v130, v126, v126 row_ror:4 row_mask:0xf bank_mask:0xf
v_add_f32_dpp v131, v127, v127 row_ror:4 row_mask:0xf bank_mask:0xf
v_add_f32_dpp v128, v128, v128 row_ror:2 row_mask:0xf bank_mask:0xf
v_add_f32_dpp v129, v129, v129 row_ror:2 row_mask:0xf bank_mask:0xf
v_add_f32_dpp v130, v130, v130 row_ror:2 row_mask:0xf bank_mask:0xf
v_add_f32_dpp v131, v131, v131 row_ror:2 row_mask:0xf bank_mask:0xf
v_add_f32_dpp v128, v128, v128 row_ror:1 row_mask:0xf bank_mask:0xf
v_add_f32_dpp v129, v129, v129 row_ror:1 row_mask:0xf bank_mask:0xf
v_add_f32_dpp v130, v130, v130 row_ror:1 row_mask:0xf bank_mask:0xf
v_add_f32_dpp v131, v131, v131 row_ror:1 row_mask:0xf bank_mask:0xf
s_waitcnt vmcnt(6)
v_dot2c_f32_bf16 v92, v52, v249
v_dot2c_f32_bf16 v93, v52, v250
v_dot2c_f32_bf16 v94, v53, v249
v_dot2c_f32_bf16 v95, v53, v250
v_dot2c_f32_bf16 v96, v54, v249
v_dot2c_f32_bf16 v97, v54, v250
v_dot2c_f32_bf16 v98, v55, v249
v_dot2c_f32_bf16 v99, v55, v250
s_waitcnt vmcnt(5)
v_dot2c_f32_bf16 v92, v56, v249
v_dot2c_f32_bf16 v93, v56, v250
v_dot2c_f32_bf16 v94, v57, v249
v_dot2c_f32_bf16 v95, v57, v250
v_dot2c_f32_bf16 v96, v58, v249
v_dot2c_f32_bf16 v97, v58, v250
v_dot2c_f32_bf16 v98, v59, v249
v_dot2c_f32_bf16 v99, v59, v250
s_waitcnt vmcnt(4)
v_dot2c_f32_bf16 v92, v60, v249
v_dot2c_f32_bf16 v93, v60, v250
v_dot2c_f32_bf16 v94, v61, v249
v_dot2c_f32_bf16 v95, v61, v250
v_dot2c_f32_bf16 v96, v62, v249
v_dot2c_f32_bf16 v97, v62, v250
v_dot2c_f32_bf16 v98, v63, v249
v_dot2c_f32_bf16 v99, v63, v250
s_waitcnt vmcnt(3)
v_dot2c_f32_bf16 v92, v64, v249
v_dot2c_f32_bf16 v93, v64, v250
v_dot2c_f32_bf16 v94, v65, v249
v_dot2c_f32_bf16 v95, v65, v250
v_dot2c_f32_bf16 v96, v66, v249
v_dot2c_f32_bf16 v97, v66, v250
v_dot2c_f32_bf16 v98, v67, v249
v_dot2c_f32_bf16 v99, v67, v250
s_waitcnt vmcnt(2)
v_dot2c_f32_bf16 v92, v68, v249
v_dot2c_f32_bf16 v93, v68, v250
v_dot2c_f32_bf16 v94, v69, v249
v_dot2c_f32_bf16 v95, v69, v250
v_dot2c_f32_bf16 v96, v70, v249
v_dot2c_f32_bf16 v97, v70, v250
v_dot2c_f32_bf16 v98, v71, v249
v_dot2c_f32_bf16 v99, v71, v250
s_waitcnt vmcnt(1)
v_dot2c_f32_bf16 v92, v100, v249
v_dot2c_f32_bf16 v93, v100, v250
v_dot2c_f32_bf16 v94, v101, v249
v_dot2c_f32_bf16 v95, v101, v250
v_dot2c_f32_bf16 v96, v102, v249
v_dot2c_f32_bf16 v97, v102, v250
v_dot2c_f32_bf16 v98, v103, v249
v_dot2c_f32_bf16 v99, v103, v250
s_waitcnt vmcnt(0)
v_dot2c_f32_bf16 v92, v104, v249
v_dot2c_f32_bf16 v93, v104, v250
v_dot2c_f32_bf16 v94, v105, v249
v_dot2c_f32_bf16 v95, v105, v250
v_dot2c_f32_bf16 v96, v106, v249
v_dot2c_f32_bf16 v97, v106, v250
v_dot2c_f32_bf16 v98, v107, v249
v_dot2c_f32_bf16 v99, v107, v250
s_nop 2
s_branch L_kvredo3b
L_k2redo3:
s_mov_b32 s95, 0
s_mov_b32 s92, 0x40000000
s_mov_b32 s93, 0x40000000
s_mov_b32 s94, 0x40000000
s_mov_b32 s37, 0
L_k2redo3a:
s_sleep 4
v_mov_b32 v108, 0
s_mov_b32 s36, 0
L_k2redo3b:
s_lshr_b32 s39, s36, 3
s_mul_i32 s39, s39, 524288
s_and_b32 s38, s36, 7
s_lshl_b32 s38, s38, 14
s_add_u32 s38, s38, s39
s_xor_b32 s38, s38, s9
s_add_u32 s39, s38, 4096
buffer_load_dwordx4 v[92:95], v4, s[40:43], s38 offen offset:0 sc1
buffer_load_dwordx4 v[96:99], v4, s[40:43], s38 offen offset:1024 sc1
buffer_load_dwordx4 v[100:103], v4, s[40:43], s39 offen offset:0 sc1
buffer_load_dwordx4 v[104:107], v4, s[40:43], s39 offen offset:1024 sc1
s_waitcnt vmcnt(3)
v_max3_u32 v108, v108, v92, v93
v_max3_u32 v108, v108, v94, v95
s_waitcnt vmcnt(2)
v_max3_u32 v108, v108, v96, v97
v_max3_u32 v108, v108, v98, v99
s_waitcnt vmcnt(1)
v_max3_u32 v108, v108, v100, v101
v_max3_u32 v108, v108, v102, v103
s_waitcnt vmcnt(0)
v_max3_u32 v108, v108, v104, v105
v_max3_u32 v108, v108, v106, v107
s_add_u32 s36, s36, 1
s_cmp_lt_u32 s36, 16
s_cbranch_scc1 L_k2redo3b
v_cmp_eq_u32 vcc, -1, v108
s_cbranch_vccz L_k2redo3c
s_add_u32 s37, s37, 1
s_cmp_lt_u32 s37, 0x8000
s_cbranch_scc1 L_k2redo3a
L_k2redo3c:
s_nop 7
s_mov_b32 s35, s9
v_lshlrev_b32 v132, 16, v32
v_and_b32 v133, 0xffff0000, v32
v_lshlrev_b32 v134, 16, v33
v_and_b32 v135, 0xffff0000, v33
v_lshlrev_b32 v136, 16, v34
v_and_b32 v137, 0xffff0000, v34
v_lshlrev_b32 v138, 16, v35
v_and_b32 v139, 0xffff0000, v35
v_lshlrev_b32 v140, 16, v36
v_and_b32 v141, 0xffff0000, v36
v_lshlrev_b32 v142, 16, v37
v_and_b32 v143, 0xffff0000, v37
v_lshlrev_b32 v144, 16, v38
v_and_b32 v145, 0xffff0000, v38
v_lshlrev_b32 v146, 16, v39
v_and_b32 v147, 0xffff0000, v39
v_lshlrev_b32 v148, 16, v40
v_and_b32 v149, 0xffff0000, v40
v_lshlrev_b32 v150, 16, v41
v_and_b32 v151, 0xffff0000, v41
v_lshlrev_b32 v152, 16, v42
v_and_b32 v153, 0xffff0000, v42
v_lshlrev_b32 v154, 16, v43
v_and_b32 v155, 0xffff0000, v43
v_lshlrev_b32 v156, 16, v44
v_and_b32 v157, 0xffff0000, v44
v_lshlrev_b32 v158, 16, v45
v_and_b32 v159, 0xffff0000, v45
v_lshlrev_b32 v160, 16, v46
v_and_b32 v161, 0xffff0000, v46
v_lshlrev_b32 v162, 16, v47
v_and_b32 v163, 0xffff0000, v47
s_branch L_k2go3
L_code_end:
.section .rodata,"a"
.p2align 6
.amdhsa_kernel interleave_layers__sliding_local_dilated__linear_kernel_hedgehog__prompt_kernel
  .amdhsa_next_free_vgpr 512
  .amdhsa_next_free_sgpr 102
  .amdhsa_accum_offset 256
  .amdhsa_group_segment_fixed_size 0
  .amdhsa_kernarg_size 80
  .amdhsa_user_sgpr_count 2
  .amdhsa_user_sgpr_kernarg_segment_ptr 1
  .amdhsa_system_sgpr_workgroup_id_x 1
.end_amdhsa_kernel
```
